```python
import torch

def _softmax(x, axis=-1):
    return torch.softmax(x, dim=axis)
def _gelu(x):
    return torch.nn.functional.gelu(x, approximate="tanh")
def _silu(x):
    return torch.nn.functional.silu(x)
def _sigmoid(x):
    return torch.sigmoid(x)
def _layernorm(x, axis=-1, eps=1e-5):
    m = x.mean(dim=axis, keepdim=True)
    v = x.var(dim=axis, keepdim=True, unbiased=False)
    return (x - m) / torch.sqrt(v + eps)
def _scatter_add(tgt, idx, src, axis=0):
    return tgt.clone().index_add_(axis, idx, src)
def _segment_sum(src, seg, n):
    out = torch.zeros((n,) + src.shape[1:], dtype=src.dtype)
    return out.index_add_(0, seg, src)
def _pad(x, pw):
    flat = tuple(v for pair in reversed(pw) for v in pair)
    return torch.nn.functional.pad(x, flat)

kernel_name = 'standalone__gqa_softmax__near_ridge'

def setup_inputs():

    _w = (lambda a: (lambda t: t.to(torch.bfloat16) if t.is_floating_point() else t)(torch.as_tensor(a)))
    B, Hq, Hkv, Sq, Sk, D = 16, 32, 32, 848, 512, 192
    return {
        "q": _w((lambda *s: torch.randn(*s, dtype=torch.bfloat16) * 0.8)(B, Hq, Sq, D)),
        "k": _w((lambda *s: torch.randn(*s, dtype=torch.bfloat16) * 0.8)(B, Hkv, Sk, D)),
        "v": _w((lambda *s: torch.randn(*s, dtype=torch.bfloat16) * 0.05)(B, Hkv, Sk, D)),
    }

def reference(q, k, v):
    B, Hq, Sq, D = q.shape
    Hkv = k.shape[1]
    rep = Hq // Hkv
    k = (lambda x, n, axis: torch.repeat_interleave(x, n, dim=axis))(k, rep, axis=1)
    v = (lambda x, n, axis: torch.repeat_interleave(x, n, dim=axis))(v, rep, axis=1)
    scale = D ** -0.5
    scores = torch.einsum("bhqd,bhkd->bhqk", q, k) * scale
    p = _softmax(scores, axis=-1)
    return torch.einsum("bhqk,bhkd->bhqd", p, v)
```

```asm
; @launch grid=(256,1,1) block=(256,1,1) lds=147456
.amdgcn_target "amdgcn-amd-amdhsa--gfx950"
.text
.globl standalone__gqa_softmax__near_ridge_kernel
.p2align 8
.type standalone__gqa_softmax__near_ridge_kernel,@function
standalone__gqa_softmax__near_ridge_kernel:
    s_cmp_ge_u32 s2, 256
    s_cbranch_scc1 L_end
    s_load_dwordx4 s[84:87], s[0:1], 0
    s_load_dwordx4 s[88:91], s[0:1], 16
    v_lshrrev_b32 v28, 6, v0
    v_and_b32 v0, 63, v0
    v_readfirstlane_b32 s3, v28
    v_lshrrev_b32 v128, 3, v0
    v_mul_u32_u24 v10, 384, v128
    v_lshrrev_b32 v129, 1, v128
    v_lshlrev_b32 v129, 1, v129
    v_and_b32 v130, 7, v0
    v_xor_b32 v129, v129, v130
    v_lshl_add_u32 v10, v129, 4, v10
    s_and_b32 s42, s3, 1
    s_mul_i32 s42, s42, 80
    v_xor_b32 v9, s42, v10
    v_xor_b32 v11, 80, v10
    v_add_u32 v11, 3072, v11
    s_mov_b32 s28, 0x3dd53b95
    s_mov_b32 s29, 0x47800000
    s_mov_b32 s49, 6016
    s_mov_b32 s39, 4096
    s_mov_b32 s46, 0
    s_mov_b32 s47, 0xffff0000
    s_and_b32 s42, s2, 7
    s_lshr_b32 s43, s2, 3
    s_and_b32 s36, s43, 3
    s_lshr_b32 s43, s43, 2
    s_lshl_b32 s42, s42, 3
    s_add_u32 s42, s42, s43
    s_lshl_b32 s44, s42, 3
    s_mul_i32 s45, s44, 196608
    s_mul_i32 s35, s44, 325632
    s_mul_i32 s22, s3, 3072
    s_mul_i32 s38, s3, 24576
    s_add_u32 s38, s38, 49152
    s_add_u32 s20, s45, s22
    s_mov_b32 s21, s20
    s_add_u32 s6, s45, 1572864
    s_mov_b32 s10, s6
    s_mov_b32 s14, 166723584
    s_mov_b32 s18, 0
    s_mov_b32 s24, 128
    s_mov_b32 s37, 0
    s_mov_b32 s60, 0xe11e7b24
    s_mov_b32 s61, 0x1b87b44b
    s_mov_b32 s62, 0xcb49e724
    s_mov_b32 s63, 0x2e71b613
    s_lshr_b32 s42, s43, 1
    s_cmp_eq_u32 s42, 1
    s_cselect_b32 s60, s61, s60
    s_cmp_eq_u32 s42, 2
    s_cselect_b32 s60, s62, s60
    s_cmp_eq_u32 s42, 3
    s_cselect_b32 s60, s63, s60
    s_and_b32 s42, s43, 1
    s_lshl_b32 s42, s42, 4
    s_lshr_b32 s31, s60, s42
    s_lshl_b32 s42, s37, 1
    s_lshr_b32 s42, s31, s42
    s_xor_b32 s42, s42, s36
    s_and_b32 s42, s42, 3
    s_mul_i32 s43, s3, 3
    s_lshl_b32 s44, s3, 2
    s_mov_b32 s32, 1
    s_add_u32 s45, s43, 17
    s_cmp_eq_u32 s3, 0
    s_cselect_b32 s45, 16, s45
    s_cselect_b32 s34, 1, 0
    s_cmp_eq_u32 s42, 1
    s_cselect_b32 s44, s45, s44
    s_cselect_b32 s32, s34, s32
    s_add_u32 s45, s43, 29
    s_cmp_eq_u32 s42, 2
    s_cselect_b32 s44, s45, s44
    s_cselect_b32 s32, 0, s32
    s_add_u32 s45, s43, 41
    s_cmp_eq_u32 s42, 3
    s_cselect_b32 s44, s45, s44
    s_cselect_b32 s32, 0, s32
    s_mul_i32 s44, s44, 6144
    s_add_u32 s34, s35, s44
    s_waitcnt lgkmcnt(0)
    s_mov_b32 s12, s84
    s_and_b32 s13, s85, 0xffff
    s_mov_b32 s15, 0x20000
    s_mov_b32 s4, s86
    s_and_b32 s5, s87, 0xffff
    s_mov_b32 s7, 0x20000
    s_mov_b32 s8, s88
    s_and_b32 s9, s89, 0xffff
    s_mov_b32 s11, 0x20000
    s_mov_b32 s16, s90
    s_and_b32 s17, s91, 0xffff
    s_mov_b32 s19, 0x20000
    s_cmp_eq_u32 s32, 0
    s_cbranch_scc1 L_start3
L_start4:
    s_add_u32 m0, s22, 0
    s_nop 0
    buffer_load_dwordx4 v9, s[4:7], s20 offen lds
    s_add_u32 s20, s20, 128
    s_add_u32 m0, s22, 1024
    s_nop 0
    buffer_load_dwordx4 v9, s[4:7], s20 offen lds
    s_add_u32 s20, s20, 128
    s_add_u32 m0, s22, 2048
    s_nop 0
    buffer_load_dwordx4 v9, s[4:7], s20 offen lds
    s_add_u32 s20, s20, 12032
    s_add_u32 s48, s34, 0
    s_add_u32 m0, s38, 0
    s_nop 0
    buffer_load_dwordx4 v10, s[12:15], s48 offen nt lds
    s_add_u32 m0, s38, 1024
    s_nop 0
    buffer_load_dwordx4 v11, s[12:15], s48 offen nt lds
    s_add_u32 s48, s34, 128
    s_add_u32 m0, s38, 2048
    s_nop 0
    buffer_load_dwordx4 v10, s[12:15], s48 offen nt lds
    s_add_u32 m0, s38, 3072
    s_nop 0
    buffer_load_dwordx4 v11, s[12:15], s48 offen nt lds
    s_add_u32 s48, s34, 256
    s_add_u32 m0, s38, 4096
    s_nop 0
    buffer_load_dwordx4 v10, s[12:15], s48 offen nt lds
    s_add_u32 m0, s38, 5120
    s_nop 0
    buffer_load_dwordx4 v11, s[12:15], s48 offen nt lds
    s_add_u32 s48, s34, 6144
    s_add_u32 m0, s38, 6144
    s_nop 0
    buffer_load_dwordx4 v10, s[12:15], s48 offen nt lds
    s_add_u32 m0, s38, 7168
    s_nop 0
    buffer_load_dwordx4 v11, s[12:15], s48 offen nt lds
    s_add_u32 s48, s34, 6272
    s_add_u32 m0, s38, 8192
    s_nop 0
    buffer_load_dwordx4 v10, s[12:15], s48 offen nt lds
    s_add_u32 m0, s38, 9216
    s_nop 0
    buffer_load_dwordx4 v11, s[12:15], s48 offen nt lds
    s_add_u32 s48, s34, 6400
    s_add_u32 m0, s38, 10240
    s_nop 0
    buffer_load_dwordx4 v10, s[12:15], s48 offen nt lds
    s_add_u32 m0, s38, 11264
    s_nop 0
    buffer_load_dwordx4 v11, s[12:15], s48 offen nt lds
    v_and_b32 v128, 15, v0
    v_lshrrev_b32 v129, 4, v0
    v_lshrrev_b32 v130, 3, v128
    v_and_b32 v131, 7, v128
    v_lshlrev_b32 v1, 7, v131
    v_bfe_u32 v131, v128, 1, 2
    v_lshlrev_b32 v131, 1, v131
    v_mul_u32_u24 v132, 5, v130
    v_xor_b32 v131, v131, v132
    v_xor_b32 v131, v131, v129
    v_lshl_add_u32 v1, v131, 4, v1
    v_lshl_add_u32 v7, v130, 10, v1
    v_add_u32 v7, s38, v7
    v_mul_u32_u24 v132, 3072, v130
    v_add_u32 v1, v132, v1
    v_xor_b32 v2, 64, v1
    v_xor_b32 v8, 64, v7
    v_lshrrev_b32 v130, 1, v129
    v_mul_u32_u24 v3, 3072, v130
    v_and_b32 v131, 1, v129
    v_bfe_u32 v132, v0, 2, 2
    v_lshl_add_u32 v128, v131, 2, v132
    v_lshl_add_u32 v3, v128, 7, v3
    v_lshrrev_b32 v128, 1, v128
    v_lshlrev_b32 v128, 1, v128
    v_mul_u32_u24 v130, 5, v130
    v_xor_b32 v128, v128, v130
    v_bfe_u32 v131, v0, 1, 1
    v_xor_b32 v128, v128, v131
    v_lshl_add_u32 v3, v128, 4, v3
    v_and_b32 v131, 1, v0
    v_lshl_add_u32 v3, v131, 3, v3
    v_add_u32 v3, 24576, v3
    v_xor_b32 v4, 32, v3
    v_xor_b32 v5, 64, v3
    v_xor_b32 v6, 96, v3
    v_lshrrev_b32 v128, 3, v0
    v_and_b32 v129, 15, v0
    v_lshrrev_b32 v130, 4, v0
    v_lshrrev_b32 v131, 1, v130
    v_and_b32 v132, 7, v129
    v_xor_b32 v131, v131, v132
    v_lshlrev_b32 v14, 7, v129
    v_lshl_add_u32 v14, v131, 4, v14
    v_and_b32 v130, 1, v130
    v_lshl_add_u32 v14, v130, 3, v14
    v_add_u32 v14, s38, v14
    v_and_b32 v129, 7, v0
    v_xor_b32 v130, v129, v128
    v_lshlrev_b32 v13, 7, v128
    v_lshl_add_u32 v13, v130, 4, v13
    v_add_u32 v13, s38, v13
    v_add_u32 v13, 2048, v13
    v_mul_u32_u24 v12, 384, v128
    v_lshl_add_u32 v12, v129, 4, v12
    v_and_b32 v128, 15, v0
    v_and_b32 v129, 3, v0
    v_mov_b32 v131, 0x3f803f80
    v_cmp_eq_u32 s[42:43], 12, v128
    v_cmp_eq_u32 vcc, 0, v129
    s_nop 3
    s_or_b64 vcc, vcc, s[42:43]
    v_cndmask_b32 v130, 0, v131, vcc
    v_accvgpr_write_b32 a240, v130
    v_accvgpr_write_b32 a241, v130
    v_accvgpr_write_b32 a242, v130
    v_accvgpr_write_b32 a243, v130
    v_cmp_eq_u32 vcc, 1, v129
    s_nop 3
    s_or_b64 vcc, vcc, s[42:43]
    v_cndmask_b32 v130, 0, v131, vcc
    v_accvgpr_write_b32 a244, v130
    v_accvgpr_write_b32 a245, v130
    v_accvgpr_write_b32 a246, v130
    v_accvgpr_write_b32 a247, v130
    v_cmp_eq_u32 vcc, 2, v129
    s_nop 3
    s_or_b64 vcc, vcc, s[42:43]
    v_cndmask_b32 v130, 0, v131, vcc
    v_accvgpr_write_b32 a248, v130
    v_accvgpr_write_b32 a249, v130
    v_accvgpr_write_b32 a250, v130
    v_accvgpr_write_b32 a251, v130
    v_cmp_eq_u32 vcc, 3, v129
    s_nop 3
    s_or_b64 vcc, vcc, s[42:43]
    v_cndmask_b32 v130, 0, v131, vcc
    v_accvgpr_write_b32 a252, v130
    v_accvgpr_write_b32 a253, v130
    v_accvgpr_write_b32 a254, v130
    v_accvgpr_write_b32 a255, v130
    s_waitcnt vmcnt(12)
    s_barrier
    ds_read_b128 a[192:195], v1 offset:0
    ds_read_b128 a[196:199], v2 offset:0
    ds_read_b128 a[200:203], v1 offset:1024
    ds_read_b128 a[204:207], v2 offset:1024
    ds_read_b128 a[208:211], v1 offset:2048
    ds_read_b128 a[212:215], v2 offset:2048
    ds_read_b128 a[216:219], v1 offset:6144
    ds_read_b128 a[220:223], v2 offset:6144
    ds_read_b128 a[224:227], v1 offset:7168
    ds_read_b128 a[228:231], v2 offset:7168
    ds_read_b128 a[232:235], v1 offset:8192
    ds_read_b128 a[236:239], v2 offset:8192
    s_waitcnt vmcnt(6)
    ds_read_b128 a[96:99], v7 offset:0
    s_add_u32 s48, s34, 12288
    s_add_u32 m0, s38, 12288
    ds_read_b128 a[100:103], v8 offset:0
    ds_read_b128 a[104:107], v7 offset:2048
    ds_read_b128 a[108:111], v8 offset:2048
    ds_read_b128 a[112:115], v7 offset:4096
    ds_read_b128 a[116:119], v8 offset:4096
    s_waitcnt lgkmcnt(5)
    v_mfma_f32_16x16x32_bf16 v[32:35], a[192:195], a[96:99], 0
    buffer_load_dwordx4 v10, s[12:15], s48 offen nt lds
    s_add_u32 m0, s38, 13312
    s_waitcnt lgkmcnt(4)
    v_mfma_f32_16x16x32_bf16 v[32:35], a[196:199], a[100:103], v[32:35]
    buffer_load_dwordx4 v11, s[12:15], s48 offen nt lds
    s_add_u32 s48, s34, 12416
    s_add_u32 m0, s38, 14336
    s_waitcnt lgkmcnt(3)
    v_mfma_f32_16x16x32_bf16 v[32:35], a[200:203], a[104:107], v[32:35]
    buffer_load_dwordx4 v10, s[12:15], s48 offen nt lds
    s_add_u32 m0, s38, 15360
    s_waitcnt lgkmcnt(2)
    v_mfma_f32_16x16x32_bf16 v[32:35], a[204:207], a[108:111], v[32:35]
    buffer_load_dwordx4 v11, s[12:15], s48 offen nt lds
    s_add_u32 s48, s34, 12544
    s_add_u32 m0, s38, 16384
    s_waitcnt lgkmcnt(1)
    v_mfma_f32_16x16x32_bf16 v[32:35], a[208:211], a[112:115], v[32:35]
    buffer_load_dwordx4 v10, s[12:15], s48 offen nt lds
    s_add_u32 m0, s38, 17408
    s_waitcnt lgkmcnt(0)
    v_mfma_f32_16x16x32_bf16 v[32:35], a[212:215], a[116:119], v[32:35]
    buffer_load_dwordx4 v11, s[12:15], s48 offen nt lds
    s_add_u32 s48, s34, 18432
    s_add_u32 m0, s38, 18432
    v_mfma_f32_16x16x32_bf16 v[36:39], a[216:219], a[96:99], 0
    v_mfma_f32_16x16x32_bf16 v[36:39], a[220:223], a[100:103], v[36:39]
    v_mfma_f32_16x16x32_bf16 v[36:39], a[224:227], a[104:107], v[36:39]
    v_mfma_f32_16x16x32_bf16 v[36:39], a[228:231], a[108:111], v[36:39]
    v_mfma_f32_16x16x32_bf16 v[36:39], a[232:235], a[112:115], v[36:39]
    v_mfma_f32_16x16x32_bf16 v[36:39], a[236:239], a[116:119], v[36:39]
    s_waitcnt vmcnt(6)
    ds_read_b128 a[120:123], v7 offset:6144
    ds_read_b128 a[124:127], v8 offset:6144
    ds_read_b128 a[128:131], v7 offset:8192
    ds_read_b128 a[132:135], v8 offset:8192
    ds_read_b128 a[136:139], v7 offset:10240
    ds_read_b128 a[140:143], v8 offset:10240
    s_waitcnt lgkmcnt(5)
    v_mfma_f32_16x16x32_bf16 v[40:43], a[192:195], a[120:123], 0
    buffer_load_dwordx4 v10, s[12:15], s48 offen nt lds
    s_add_u32 m0, s38, 19456
    s_waitcnt lgkmcnt(4)
    v_mfma_f32_16x16x32_bf16 v[40:43], a[196:199], a[124:127], v[40:43]
    buffer_load_dwordx4 v11, s[12:15], s48 offen nt lds
    s_add_u32 s48, s34, 18560
    s_add_u32 m0, s38, 20480
    s_waitcnt lgkmcnt(3)
    v_mfma_f32_16x16x32_bf16 v[40:43], a[200:203], a[128:131], v[40:43]
    buffer_load_dwordx4 v10, s[12:15], s48 offen nt lds
    s_add_u32 m0, s38, 21504
    s_waitcnt lgkmcnt(2)
    v_mfma_f32_16x16x32_bf16 v[40:43], a[204:207], a[132:135], v[40:43]
    buffer_load_dwordx4 v11, s[12:15], s48 offen nt lds
    s_add_u32 s48, s34, 18688
    s_add_u32 m0, s38, 22528
    s_waitcnt lgkmcnt(1)
    v_mfma_f32_16x16x32_bf16 v[40:43], a[208:211], a[136:139], v[40:43]
    buffer_load_dwordx4 v10, s[12:15], s48 offen nt lds
    s_add_u32 m0, s38, 23552
    s_waitcnt lgkmcnt(0)
    v_mfma_f32_16x16x32_bf16 v[40:43], a[212:215], a[140:143], v[40:43]
    buffer_load_dwordx4 v11, s[12:15], s48 offen nt lds
    s_add_u32 m0, s22, 12288
    v_mfma_f32_16x16x32_bf16 v[44:47], a[216:219], a[120:123], 0
    v_mfma_f32_16x16x32_bf16 v[44:47], a[220:223], a[124:127], v[44:47]
    v_mfma_f32_16x16x32_bf16 v[44:47], a[224:227], a[128:131], v[44:47]
    v_mfma_f32_16x16x32_bf16 v[44:47], a[228:231], a[132:135], v[44:47]
    v_mfma_f32_16x16x32_bf16 v[44:47], a[232:235], a[136:139], v[44:47]
    v_mfma_f32_16x16x32_bf16 v[44:47], a[236:239], a[140:143], v[44:47]
    s_waitcnt vmcnt(6)
    ds_read_b128 a[144:147], v7 offset:12288
    ds_read_b128 a[148:151], v8 offset:12288
    ds_read_b128 a[152:155], v7 offset:14336
    ds_read_b128 a[156:159], v8 offset:14336
    ds_read_b128 a[160:163], v7 offset:16384
    ds_read_b128 a[164:167], v8 offset:16384
    s_waitcnt lgkmcnt(5)
    v_mfma_f32_16x16x32_bf16 v[48:51], a[192:195], a[144:147], 0
    buffer_load_dwordx4 v9, s[4:7], s20 offen lds
    s_add_u32 s20, s20, 128
    s_add_u32 m0, s22, 13312
    s_waitcnt lgkmcnt(4)
    v_mfma_f32_16x16x32_bf16 v[48:51], a[196:199], a[148:151], v[48:51]
    buffer_load_dwordx4 v9, s[4:7], s20 offen lds
    s_add_u32 s20, s20, 128
    s_add_u32 m0, s22, 14336
    s_waitcnt lgkmcnt(3)
    v_mfma_f32_16x16x32_bf16 v[48:51], a[200:203], a[152:155], v[48:51]
    buffer_load_dwordx4 v9, s[4:7], s20 offen lds
    s_add_u32 s20, s20, 12032
    s_add_u32 m0, s22, 24576
    s_waitcnt lgkmcnt(2)
    v_mfma_f32_16x16x32_bf16 v[48:51], a[204:207], a[156:159], v[48:51]
    s_waitcnt lgkmcnt(1)
    v_mfma_f32_16x16x32_bf16 v[48:51], a[208:211], a[160:163], v[48:51]
    s_waitcnt lgkmcnt(0)
    v_mfma_f32_16x16x32_bf16 v[48:51], a[212:215], a[164:167], v[48:51]
    v_mfma_f32_16x16x32_bf16 v[52:55], a[216:219], a[144:147], 0
    v_mfma_f32_16x16x32_bf16 v[52:55], a[220:223], a[148:151], v[52:55]
    v_mfma_f32_16x16x32_bf16 v[52:55], a[224:227], a[152:155], v[52:55]
    v_mfma_f32_16x16x32_bf16 v[52:55], a[228:231], a[156:159], v[52:55]
    v_mfma_f32_16x16x32_bf16 v[52:55], a[232:235], a[160:163], v[52:55]
    v_mfma_f32_16x16x32_bf16 v[52:55], a[236:239], a[164:167], v[52:55]
    s_waitcnt vmcnt(3)
    ds_read_b128 a[168:171], v7 offset:18432
    ds_read_b128 a[172:175], v8 offset:18432
    ds_read_b128 a[176:179], v7 offset:20480
    ds_read_b128 a[180:183], v8 offset:20480
    ds_read_b128 a[184:187], v7 offset:22528
    ds_read_b128 a[188:191], v8 offset:22528
    s_waitcnt lgkmcnt(5)
    v_mfma_f32_16x16x32_bf16 v[56:59], a[192:195], a[168:171], 0
    buffer_load_dwordx4 v9, s[8:11], s21 offen lds
    s_add_u32 s21, s21, 128
    s_add_u32 m0, s22, 25600
    s_waitcnt lgkmcnt(4)
    v_mfma_f32_16x16x32_bf16 v[56:59], a[196:199], a[172:175], v[56:59]
    buffer_load_dwordx4 v9, s[8:11], s21 offen lds
    s_add_u32 s21, s21, 128
    s_add_u32 m0, s22, 26624
    s_waitcnt lgkmcnt(3)
    v_mfma_f32_16x16x32_bf16 v[56:59], a[200:203], a[176:179], v[56:59]
    buffer_load_dwordx4 v9, s[8:11], s21 offen lds
    s_add_u32 s21, s21, 12032
    s_add_u32 m0, s22, 36864
    s_waitcnt lgkmcnt(2)
    v_mfma_f32_16x16x32_bf16 v[56:59], a[204:207], a[180:183], v[56:59]
    buffer_load_dwordx4 v9, s[8:11], s21 offen lds
    s_add_u32 s21, s21, 128
    s_add_u32 m0, s22, 37888
    s_waitcnt lgkmcnt(1)
    v_mfma_f32_16x16x32_bf16 v[56:59], a[208:211], a[184:187], v[56:59]
    buffer_load_dwordx4 v9, s[8:11], s21 offen lds
    s_add_u32 s21, s21, 128
    s_add_u32 m0, s22, 38912
    s_waitcnt lgkmcnt(0)
    v_mfma_f32_16x16x32_bf16 v[56:59], a[212:215], a[188:191], v[56:59]
    buffer_load_dwordx4 v9, s[8:11], s21 offen lds
    s_add_u32 s21, s21, 12032
    v_mfma_f32_16x16x32_bf16 v[60:63], a[216:219], a[168:171], 0
    v_mfma_f32_16x16x32_bf16 v[60:63], a[220:223], a[172:175], v[60:63]
    v_mfma_f32_16x16x32_bf16 v[60:63], a[224:227], a[176:179], v[60:63]
    v_mfma_f32_16x16x32_bf16 v[60:63], a[228:231], a[180:183], v[60:63]
    v_mfma_f32_16x16x32_bf16 v[60:63], a[232:235], a[184:187], v[60:63]
    v_mfma_f32_16x16x32_bf16 v[60:63], a[236:239], a[188:191], v[60:63]
    s_waitcnt vmcnt(6)
    s_barrier
    s_add_u32 m0, s22, 0
    ds_read_b128 a[200:203], v1 offset:13312
    ds_read_b128 a[196:199], v2 offset:12288
    ds_read_b128 a[192:195], v1 offset:12288
    buffer_load_dwordx4 v9, s[4:7], s20 offen lds
    ds_read_b128 a[204:207], v2 offset:13312
    v_max3_f32 v28, v32, v33, v34
    v_max3_f32 v28, v28, v35, v36
    v_max3_f32 v30, v40, v41, v42
    v_max3_f32 v28, v28, v37, v38
    v_max3_f32 v30, v30, v43, v44
    v_max_f32 v28, v28, v39
    v_mov_b32 v29, v28
    v_max3_f32 v30, v30, v45, v46
    v_max_f32 v30, v30, v47
    v_mov_b32 v31, v30
    v_permlane32_swap_b32 v29, v28
    v_max_f32 v28, v28, v29
    v_mov_b32 v29, v28
    v_permlane32_swap_b32 v31, v30
    v_max_f32 v30, v30, v31
    v_mov_b32 v31, v30
    v_permlane16_swap_b32 v29, v28
    v_max_f32 v28, v28, v29
    v_permlane16_swap_b32 v31, v30
    s_add_u32 s20, s20, 128
    v_mul_f32_e64 v16, -s28, v28
    v_max_f32 v30, v30, v31
    v_max3_f32 v28, v48, v49, v50
    v_mul_f32_e64 v17, -s28, v30
    v_max3_f32 v28, v28, v51, v52
    v_fma_f32 v34, v34, s28, v16
    v_fma_f32 v35, v35, s28, v16
    v_exp_f32 v131, v35
    v_max3_f32 v30, v56, v57, v58
    v_fma_f32 v36, v36, s28, v16
    s_waitcnt lgkmcnt(1)
    v_mfma_f32_16x16x32_bf16 v[64:67], a[192:195], a[96:99], 0
    s_add_u32 m0, s22, 1024
    ds_read_b128 a[208:211], v1 offset:14336
    buffer_load_dwordx4 v9, s[4:7], s20 offen lds
    v_fma_f32 v46, v46, s28, v17
    v_fma_f32 v32, v32, s28, v16
    s_add_u32 s20, s20, 128
    v_mfma_f32_16x16x32_bf16 v[64:67], a[196:199], a[100:103], v[64:67]
    s_add_u32 m0, s22, 2048
    ds_read_b128 a[212:215], v2 offset:14336
    buffer_load_dwordx4 v9, s[4:7], s20 offen lds
    v_fma_f32 v33, v33, s28, v16
    v_exp_f32 v128, v32
    v_exp_f32 v134, v36
    v_max3_f32 v30, v30, v59, v60
    v_max3_f32 v28, v28, v53, v54
    v_fma_f32 v38, v38, s28, v16
    v_max_f32 v28, v28, v55
    v_fma_f32 v40, v40, s28, v17
    v_max3_f32 v30, v30, v61, v62
    v_max_f32 v30, v30, v63
    v_fma_f32 v37, v37, s28, v16
    v_fma_f32 v39, v39, s28, v16
    v_mov_b32 v29, v28
    v_exp_f32 v135, v37
    v_mov_b32 v31, v30
    v_fma_f32 v43, v43, s28, v17
    v_exp_f32 v129, v33
    v_permlane32_swap_b32 v29, v28
    v_permlane32_swap_b32 v31, v30
    v_max_f32 v28, v28, v29
    v_mfma_f32_16x16x32_bf16 v[64:67], a[200:203], a[104:107], v[64:67]
    s_waitcnt lgkmcnt(1)
    ds_read_b128 a[224:227], v1 offset:19456
    v_fma_f32 v47, v47, s28, v17
    v_mfma_f32_16x16x32_bf16 v[64:67], a[204:207], a[108:111], v[64:67]
    s_add_u32 s20, s20, 12032
    ds_read_b128 a[220:223], v2 offset:18432
    v_cvt_pk_bf16_f32 v96, v128, v129
    v_mfma_f32_16x16x32_bf16 v[64:67], a[208:211], a[112:115], v[64:67]
    s_waitcnt lgkmcnt(2)
    v_fma_f32 v44, v44, s28, v17
    v_mov_b32 v29, v28
    v_cvt_pk_bf16_f32 v98, v134, v135
    v_mfma_f32_16x16x32_bf16 v[64:67], a[212:215], a[116:119], v[64:67]
    s_add_u32 s37, s37, 1
    ds_read_b128 a[232:235], v1 offset:20480
    v_max_f32 v30, v30, v31
    v_permlane16_swap_b32 v29, v28
    v_mfma_f32_16x16x32_bf16 v[72:75], a[192:195], a[120:123], 0
    s_add_u32 s35, s35, 325632
    v_fma_f32 v42, v42, s28, v17
    v_fma_f32 v41, v41, s28, v17
    v_max_f32 v28, v28, v29
    v_mfma_f32_16x16x32_bf16 v[72:75], a[196:199], a[124:127], v[72:75]
    s_lshl_b32 s42, s37, 1
    v_exp_f32 v128, v38
    v_mfma_f32_16x16x32_bf16 v[72:75], a[200:203], a[128:131], v[72:75]
    s_lshr_b32 s42, s31, s42
    ds_read_b128 a[236:239], v2 offset:20480
    v_mul_f32_e64 v18, -s28, v28
    v_mov_b32 v31, v30
    v_mfma_f32_16x16x32_bf16 v[72:75], a[204:207], a[132:135], v[72:75]
    s_xor_b32 s42, s42, s36
    v_permlane16_swap_b32 v31, v30
    v_exp_f32 v132, v40
    v_exp_f32 v129, v39
    v_max_f32 v30, v30, v31
    v_fma_f32 v49, v49, s28, v18
    v_mfma_f32_16x16x32_bf16 v[72:75], a[208:211], a[136:139], v[72:75]
    s_and_b32 s42, s42, 3
    ds_read_b128 a[228:231], v2 offset:19456
    v_cvt_pk_bf16_f32 v99, v128, v129
    v_mfma_f32_16x16x32_bf16 v[72:75], a[212:215], a[140:143], v[72:75]
    s_mul_i32 s43, s3, 3
    v_exp_f32 v133, v41
    v_fma_f32 v53, v53, s28, v18
    v_fma_f32 v48, v48, s28, v18
    s_lshl_b32 s44, s3, 2
    v_mfma_f32_16x16x32_bf16 v[80:83], a[192:195], a[144:147], 0
    s_mov_b32 s32, 1
    v_exp_f32 v130, v34
    v_cvt_pk_bf16_f32 v100, v132, v133
    v_mfma_f32_16x16x32_bf16 v[80:83], a[196:199], a[148:151], v[80:83]
    s_add_u32 s45, s43, 17
    v_exp_f32 v128, v48
    v_mfma_f32_16x16x32_bf16 v[80:83], a[200:203], a[152:155], v[80:83]
    s_cmp_eq_u32 s3, 0
    v_exp_f32 v132, v44
    v_mfma_f32_16x16x32_bf16 v[80:83], a[204:207], a[156:159], v[80:83]
    s_cselect_b32 s45, 16, s45
    ds_read_b128 a[216:219], v1 offset:18432
    v_fma_f32 v45, v45, s28, v17
    v_mfma_f32_16x16x32_bf16 v[80:83], a[208:211], a[160:163], v[80:83]
    s_cselect_b32 s33, 1, 0
    v_exp_f32 v133, v45
    v_mfma_f32_16x16x32_bf16 v[80:83], a[212:215], a[164:167], v[80:83]
    s_cmp_eq_u32 s42, 1
    v_fma_f32 v54, v54, s28, v18
    v_exp_f32 v134, v46
    v_fma_f32 v52, v52, s28, v18
    v_cvt_pk_bf16_f32 v97, v130, v131
    v_mfma_f32_16x16x32_bf16 v[88:91], a[192:195], a[168:171], 0
    s_cselect_b32 s44, s45, s44
    v_fma_f32 v64, v64, s28, v16
    v_fma_f32 v51, v51, s28, v18
    v_mul_f32_e64 v19, -s28, v30
    v_mfma_f32_16x16x32_bf16 v[88:91], a[196:199], a[172:175], v[88:91]
    s_cselect_b32 s32, s33, s32
    v_exp_f32 v135, v47
    v_mfma_f32_16x16x32_bf16 v[88:91], a[200:203], a[176:179], v[88:91]
    s_add_u32 s45, s43, 29
    v_cvt_pk_bf16_f32 v103, v134, v135
    v_cvt_pk_bf16_f32 v102, v132, v133
    v_fma_f32 v59, v59, s28, v19
    v_mfma_f32_16x16x32_bf16 v[88:91], a[204:207], a[180:183], v[88:91]
    s_cmp_eq_u32 s42, 2
    v_exp_f32 v130, v42
    v_mfma_f32_16x16x32_bf16 v[88:91], a[208:211], a[184:187], v[88:91]
    s_cselect_b32 s44, s45, s44
    v_exp_f32 v133, v53
    v_fma_f32 v50, v50, s28, v18
    v_mfma_f32_16x16x32_bf16 v[20:23], a[240:243], v[96:99], 0
    s_cselect_b32 s32, 0, s32
    v_fma_f32 v62, v62, s28, v19
    v_fma_f32 v65, v65, s28, v16
    v_fma_f32 v57, v57, s28, v19
    v_fma_f32 v66, v66, s28, v16
    v_mfma_f32_16x16x32_bf16 v[88:91], a[212:215], a[188:191], v[88:91]
    s_waitcnt lgkmcnt(0)
    v_fma_f32 v56, v56, s28, v19
    v_exp_f32 v134, v54
    v_mfma_f32_16x16x32_bf16 v[68:71], a[216:219], a[96:99], 0
    s_add_u32 s45, s43, 41
    v_fma_f32 v73, v73, s28, v17
    v_fma_f32 v61, v61, s28, v19
    v_fma_f32 v55, v55, s28, v18
    v_exp_f32 v131, v43
    v_mfma_f32_16x16x32_bf16 v[68:71], a[220:223], a[100:103], v[68:71]
    s_cmp_eq_u32 s42, 3
    v_exp_f32 v135, v55
    v_mfma_f32_16x16x32_bf16 v[68:71], a[224:227], a[104:107], v[68:71]
    s_cselect_b32 s44, s45, s44
    v_cvt_pk_bf16_f32 v101, v130, v131
    s_cselect_b32 s32, 0, s32
    v_mfma_f32_16x16x32_bf16 v[68:71], a[228:231], a[108:111], v[68:71]
    s_mul_i32 s44, s44, 6144
    v_exp_f32 v132, v52
    v_mfma_f32_16x16x32_bf16 v[68:71], a[232:235], a[112:115], v[68:71]
    s_add_u32 s33, s35, s44
    v_cvt_pk_bf16_f32 v107, v134, v135
    v_fma_f32 v58, v58, s28, v19
    v_exp_f32 v129, v49
    v_exp_f32 v130, v50
    v_mfma_f32_16x16x32_bf16 v[68:71], a[236:239], a[116:119], v[68:71]
    s_mul_i32 s42, s32, 6144
    v_fma_f32 v63, v63, s28, v19
    v_cvt_pk_bf16_f32 v106, v132, v133
    v_mfma_f32_16x16x32_bf16 v[76:79], a[216:219], a[120:123], 0
    s_add_u32 s42, s42, 18432
    v_exp_f32 v133, v61
    v_cvt_pk_bf16_f32 v104, v128, v129
    v_exp_f32 v129, v57
    s_add_u32 s42, s42, s33
    v_mfma_f32_16x16x32_bf16 v[76:79], a[220:223], a[124:127], v[76:79]
    s_cmp_ge_u32 s37, 8
    v_exp_f32 v131, v51
    v_mfma_f32_16x16x32_bf16 v[76:79], a[224:227], a[128:131], v[76:79]
    s_cselect_b32 s14, 0, s42
    v_exp_f32 v128, v56
    v_mfma_f32_16x16x32_bf16 v[76:79], a[228:231], a[132:135], v[76:79]
    s_add_u32 s25, s33, 128
    v_fma_f32 v72, v72, s28, v17
    v_fma_f32 v60, v60, s28, v19
    v_mfma_f32_16x16x32_bf16 v[76:79], a[232:235], a[136:139], v[76:79]
    s_add_u32 s23, s38, 2048
    v_exp_f32 v132, v60
    v_cvt_pk_bf16_f32 v105, v130, v131
    v_mfma_f32_16x16x32_bf16 v[76:79], a[236:239], a[140:143], v[76:79]
    s_mov_b32 s30, 0
    v_exp_f32 v130, v58
    s_waitcnt vmcnt(6)
    v_mfma_f32_16x16x32_bf16 v[84:87], a[216:219], a[144:147], 0
    s_barrier
    ds_read_b64_tr_b16 a[192:193], v3 offset:0
    v_mfma_f32_16x16x32_bf16 v[84:87], a[220:223], a[148:151], v[84:87]
    s_add_u32 m0, s22, 12288
    ds_read_b64_tr_b16 a[194:195], v3 offset:6144
    v_cvt_pk_bf16_f32 v110, v132, v133
    v_mfma_f32_16x16x32_bf16 v[84:87], a[224:227], a[152:155], v[84:87]
    ds_read_b64_tr_b16 a[196:197], v4 offset:0
    v_cvt_pk_bf16_f32 v108, v128, v129
    v_mfma_f32_16x16x32_bf16 v[84:87], a[228:231], a[156:159], v[84:87]
    ds_read_b64_tr_b16 a[198:199], v4 offset:6144
    v_exp_f32 v128, v64
    v_mfma_f32_16x16x32_bf16 v[84:87], a[232:235], a[160:163], v[84:87]
    ds_read_b64_tr_b16 a[200:201], v5 offset:0
    v_exp_f32 v134, v62
    v_mfma_f32_16x16x32_bf16 v[84:87], a[236:239], a[164:167], v[84:87]
    buffer_load_dwordx4 v9, s[4:7], s20 offen lds
    ds_read_b64_tr_b16 a[202:203], v5 offset:6144
    v_mfma_f32_16x16x32_bf16 v[92:95], a[216:219], a[168:171], 0
    s_add_u32 s20, s20, 128
    v_exp_f32 v129, v65
    v_mfma_f32_16x16x32_bf16 v[20:23], a[244:247], v[100:103], v[20:23]
    ds_read_b64_tr_b16 a[204:205], v6 offset:0
    v_cvt_pk_bf16_f32 v112, v128, v129
    v_fma_f32 v67, v67, s28, v16
    v_mfma_f32_16x16x32_bf16 v[92:95], a[220:223], a[172:175], v[92:95]
    s_add_u32 m0, s22, 13312
    ds_read_b64_tr_b16 a[206:207], v6 offset:6144
    buffer_load_dwordx4 v9, s[4:7], s20 offen lds
    v_exp_f32 v131, v59
    v_mfma_f32_16x16x32_bf16 v[92:95], a[224:227], a[176:179], v[92:95]
    ds_read_b64_tr_b16 a[208:209], v3 offset:1024
    v_exp_f32 v135, v63
    v_mfma_f32_16x16x32_bf16 v[20:23], a[248:251], v[104:107], v[20:23]
    ds_read_b64_tr_b16 a[210:211], v3 offset:7168
    v_exp_f32 v132, v72
    v_mfma_f32_16x16x32_bf16 v[92:95], a[228:231], a[180:183], v[92:95]
    s_add_u32 s20, s20, 128
    ds_read_b64_tr_b16 a[212:213], v4 offset:1024
    v_cvt_pk_bf16_f32 v109, v130, v131
    v_exp_f32 v130, v66
    v_cvt_pk_bf16_f32 v111, v134, v135
    v_mfma_f32_16x16x32_bf16 v[92:95], a[232:235], a[184:187], v[92:95]
    s_add_u32 m0, s22, 14336
    v_exp_f32 v133, v73
    v_exp_f32 v131, v67
    v_mfma_f32_16x16x32_bf16 v[20:23], a[252:255], v[108:111], v[20:23]
    ds_read_b64_tr_b16 a[214:215], v4 offset:7168
    buffer_load_dwordx4 v9, s[4:7], s20 offen lds
    v_mfma_f32_16x16x32_bf16 v[92:95], a[236:239], a[188:191], v[92:95]
    s_add_u32 s20, s20, 12032
    v_cvt_pk_bf16_f32 v113, v130, v131
    v_cvt_pk_bf16_f32 v116, v132, v133
    v_fma_f32 v71, v71, s28, v16
    s_waitcnt lgkmcnt(10)
    v_mfma_f32_16x16x32_bf16 v[160:163], a[192:195], v[96:99], 0
    ds_read_b64_tr_b16 a[224:225], v3 offset:2048
    v_fma_f32 v68, v68, s28, v16
    v_mfma_f32_16x16x32_bf16 v[208:211], a[192:195], v[100:103], 0
    v_exp_f32 v134, v68
    v_mfma_f32_16x16x32_bf16 a[0:3], a[192:195], v[104:107], 0
    ds_read_b64_tr_b16 a[234:235], v5 offset:8192
    v_fma_f32 v70, v70, s28, v16
    v_fma_f32 v86, v86, s28, v18
    v_mfma_f32_16x16x32_bf16 a[48:51], a[192:195], v[108:111], 0
    s_waitcnt lgkmcnt(10)
    ds_read_b64_tr_b16 a[222:223], v6 offset:7168
    v_fma_f32 v79, v79, s28, v17
    v_mfma_f32_16x16x32_bf16 v[164:167], a[196:199], v[96:99], 0
    ds_read_b64_tr_b16 a[220:221], v6 offset:1024
    v_fma_f32 v89, v89, s28, v19
    v_mfma_f32_16x16x32_bf16 v[212:215], a[196:199], v[100:103], 0
    v_fma_f32 v81, v81, s28, v18
    v_fma_f32 v69, v69, s28, v16
    v_mfma_f32_16x16x32_bf16 a[4:7], a[196:199], v[104:107], 0
    ds_read_b64_tr_b16 a[216:217], v5 offset:1024
    v_fma_f32 v78, v78, s28, v17
    v_mfma_f32_16x16x32_bf16 a[52:55], a[196:199], v[108:111], 0
    s_waitcnt lgkmcnt(10)
    ds_read_b64_tr_b16 a[228:229], v4 offset:2048
    v_fma_f32 v75, v75, s28, v17
    v_mfma_f32_16x16x32_bf16 v[168:171], a[200:203], v[96:99], 0
    v_exp_f32 v135, v69
    v_mfma_f32_16x16x32_bf16 v[216:219], a[200:203], v[100:103], 0
    ds_read_b64_tr_b16 a[232:233], v5 offset:2048
    v_fma_f32 v90, v90, s28, v19
    v_mfma_f32_16x16x32_bf16 a[8:11], a[200:203], v[104:107], 0
    ds_read_b64_tr_b16 a[218:219], v5 offset:7168
    v_fma_f32 v76, v76, s28, v17
    v_mfma_f32_16x16x32_bf16 a[56:59], a[200:203], v[108:111], 0
    s_waitcnt lgkmcnt(7)
    v_exp_f32 v128, v70
    v_mfma_f32_16x16x32_bf16 v[172:175], a[204:207], v[96:99], 0
    ds_read_b64_tr_b16 a[226:227], v3 offset:8192
    v_fma_f32 v83, v83, s28, v18
    v_mfma_f32_16x16x32_bf16 v[220:223], a[204:207], v[100:103], 0
    ds_read_b64_tr_b16 a[236:237], v6 offset:2048
    v_fma_f32 v77, v77, s28, v17
    v_mfma_f32_16x16x32_bf16 a[12:15], a[204:207], v[104:107], 0
    ds_read_b64_tr_b16 a[238:239], v6 offset:8192
    v_cvt_pk_bf16_f32 v114, v134, v135
    v_mfma_f32_16x16x32_bf16 a[60:63], a[204:207], v[108:111], 0
    ds_read_b64_tr_b16 a[230:231], v4 offset:8192
    v_fma_f32 v74, v74, s28, v17
    v_mfma_f32_16x16x32_bf16 v[176:179], a[208:211], v[96:99], 0
    v_exp_f32 v129, v71
    v_mfma_f32_16x16x32_bf16 v[224:227], a[208:211], v[100:103], 0
    v_exp_f32 v134, v78
    v_mfma_f32_16x16x32_bf16 a[16:19], a[208:211], v[104:107], 0
    v_exp_f32 v135, v79
    v_mfma_f32_16x16x32_bf16 a[64:67], a[208:211], v[108:111], 0
    v_fma_f32 v82, v82, s28, v18
    v_cvt_pk_bf16_f32 v119, v134, v135
    v_mfma_f32_16x16x32_bf16 v[180:183], a[212:215], v[96:99], 0
    v_fma_f32 v88, v88, s28, v19
    v_cvt_pk_bf16_f32 v115, v128, v129
    v_mfma_f32_16x16x32_bf16 v[228:231], a[212:215], v[100:103], 0
    v_exp_f32 v133, v77
    v_mfma_f32_16x16x32_bf16 a[20:23], a[212:215], v[104:107], 0
    v_exp_f32 v131, v75
    v_mfma_f32_16x16x32_bf16 a[68:71], a[212:215], v[108:111], 0
    s_waitcnt lgkmcnt(2)
    v_exp_f32 v132, v76
    v_mfma_f32_16x16x32_bf16 v[184:187], a[216:219], v[96:99], 0
    v_exp_f32 v130, v74
    v_mfma_f32_16x16x32_bf16 v[232:235], a[216:219], v[100:103], 0
    s_waitcnt vmcnt(3) lgkmcnt(0)
    v_cvt_pk_bf16_f32 v117, v130, v131
    v_cvt_pk_bf16_f32 v118, v132, v133
    v_mfma_f32_16x16x32_bf16 a[24:27], a[216:219], v[104:107], 0
    v_fma_f32 v80, v80, s28, v18
    v_fma_f32 v91, v91, s28, v19
    v_mfma_f32_16x16x32_bf16 v[24:27], a[240:243], v[112:115], v[20:23]
    v_exp_f32 v128, v80
    v_mfma_f32_16x16x32_bf16 v[24:27], a[244:247], v[116:119], v[24:27]
    s_barrier
    v_mfma_f32_16x16x32_bf16 a[72:75], a[216:219], v[108:111], 0
    ds_read_b128 a[212:215], v2 offset:2048
    v_fma_f32 v84, v84, s28, v18
    v_mfma_f32_16x16x32_bf16 v[188:191], a[220:223], v[96:99], 0
    v_exp_f32 v134, v86
    v_mfma_f32_16x16x32_bf16 v[236:239], a[220:223], v[100:103], 0
    v_exp_f32 v131, v83
    v_mfma_f32_16x16x32_bf16 a[28:31], a[220:223], v[104:107], 0
    ds_read_b128 a[192:195], v1 offset:0
    v_fma_f32 v92, v92, s28, v19
    v_mfma_f32_16x16x32_bf16 a[76:79], a[220:223], v[108:111], 0
    s_add_u32 m0, s22, 24576
    v_exp_f32 v129, v81
    v_mfma_f32_16x16x32_bf16 v[192:195], a[224:227], v[96:99], 0
    ds_read_b128 a[220:223], v2 offset:6144
    v_mfma_f32_16x16x32_bf16 v[240:243], a[224:227], v[100:103], 0
    buffer_load_dwordx4 v9, s[8:11], s21 offen lds
    v_mfma_f32_16x16x32_bf16 a[32:35], a[224:227], v[104:107], 0
    s_add_u32 s21, s21, 128
    ds_read_b128 a[196:199], v2 offset:0
    v_fma_f32 v87, v87, s28, v18
    v_mfma_f32_16x16x32_bf16 a[80:83], a[224:227], v[108:111], 0
    ds_read_b128 a[208:211], v1 offset:2048
    v_fma_f32 v85, v85, s28, v18
    v_mfma_f32_16x16x32_bf16 v[196:199], a[228:231], v[96:99], 0
    s_add_u32 m0, s22, 25600
    v_fma_f32 v93, v93, s28, v19
    v_cvt_pk_bf16_f32 v120, v128, v129
    v_mfma_f32_16x16x32_bf16 v[244:247], a[228:231], v[100:103], 0
    buffer_load_dwordx4 v9, s[8:11], s21 offen lds
    v_mfma_f32_16x16x32_bf16 a[36:39], a[228:231], v[104:107], 0
    ds_read_b128 a[200:203], v1 offset:1024
    v_fma_f32 v94, v94, s28, v19
    v_mfma_f32_16x16x32_bf16 a[84:87], a[228:231], v[108:111], 0
    v_exp_f32 v133, v85
    v_mfma_f32_16x16x32_bf16 v[200:203], a[232:235], v[96:99], 0
    ds_read_b128 a[204:207], v2 offset:1024
    s_add_u32 s21, s21, 128
    v_mfma_f32_16x16x32_bf16 v[248:251], a[232:235], v[100:103], 0
    s_add_u32 m0, s22, 26624
    v_exp_f32 v135, v87
    v_mfma_f32_16x16x32_bf16 a[40:43], a[232:235], v[104:107], 0
    buffer_load_dwordx4 v9, s[8:11], s21 offen lds
    v_mfma_f32_16x16x32_bf16 a[88:91], a[232:235], v[108:111], 0
    s_add_u32 s21, s21, 12032
    v_exp_f32 v132, v84
    v_mfma_f32_16x16x32_bf16 v[204:207], a[236:239], v[96:99], 0
    s_add_u32 s58, s25, 4294967168
    v_exp_f32 v129, v89
    v_mfma_f32_16x16x32_bf16 v[252:255], a[236:239], v[100:103], 0
    s_add_u32 m0, s38, 0
    v_exp_f32 v128, v88
    v_mfma_f32_16x16x32_bf16 a[44:47], a[236:239], v[104:107], 0
    buffer_load_dwordx4 v10, s[12:15], s58 offen nt lds
    v_mfma_f32_16x16x32_bf16 a[92:95], a[236:239], v[108:111], 0
    s_waitcnt lgkmcnt(2)
    ds_read_b128 a[228:231], v2 offset:7168
    v_mfma_f32_16x16x32_bf16 v[32:35], a[192:195], a[96:99], 0
    s_add_u32 m0, s38, 1024
    ds_read_b128 a[232:235], v1 offset:8192
    v_cvt_pk_bf16_f32 v124, v128, v129
    v_mfma_f32_16x16x32_bf16 v[32:35], a[196:199], a[100:103], v[32:35]
    s_waitcnt lgkmcnt(3)
    ds_read_b128 a[224:227], v1 offset:7168
    v_mfma_f32_16x16x32_bf16 v[32:35], a[200:203], a[104:107], v[32:35]
    s_waitcnt lgkmcnt(3)
    v_exp_f32 v130, v82
    v_mfma_f32_16x16x32_bf16 v[32:35], a[204:207], a[108:111], v[32:35]
    buffer_load_dwordx4 v11, s[12:15], s58 offen nt lds
    v_mfma_f32_16x16x32_bf16 v[32:35], a[208:211], a[112:115], v[32:35]
    v_cvt_pk_bf16_f32 v123, v134, v135
    v_fma_f32 v95, v95, s28, v19
    v_mfma_f32_16x16x32_bf16 v[32:35], a[212:215], a[116:119], v[32:35]
    s_add_u32 s59, s25, 6016
    v_cvt_pk_bf16_f32 v122, v132, v133
    v_cvt_pk_bf16_f32 v121, v130, v131
    v_mfma_f32_16x16x32_bf16 v[40:43], a[192:195], a[120:123], 0
    ds_read_b128 a[216:219], v1 offset:6144
    v_mfma_f32_16x16x32_bf16 v[40:43], a[196:199], a[124:127], v[40:43]
    v_exp_f32 v134, v94
    v_mfma_f32_16x16x32_bf16 v[40:43], a[200:203], a[128:131], v[40:43]
    s_add_u32 m0, s38, 6144
    v_exp_f32 v133, v93
    v_mfma_f32_16x16x32_bf16 v[40:43], a[204:207], a[132:135], v[40:43]
    buffer_load_dwordx4 v10, s[12:15], s59 offen nt lds
    v_mfma_f32_16x16x32_bf16 v[40:43], a[208:211], a[136:139], v[40:43]
    v_exp_f32 v135, v95
    v_mfma_f32_16x16x32_bf16 v[40:43], a[212:215], a[140:143], v[40:43]
    v_exp_f32 v130, v90
    v_mfma_f32_16x16x32_bf16 v[48:51], a[192:195], a[144:147], 0
    s_add_u32 m0, s38, 7168
    v_exp_f32 v132, v92
    v_mfma_f32_16x16x32_bf16 v[48:51], a[196:199], a[148:151], v[48:51]
    buffer_load_dwordx4 v11, s[12:15], s59 offen nt lds
    v_mfma_f32_16x16x32_bf16 v[48:51], a[200:203], a[152:155], v[48:51]
    s_add_u32 s58, s25, 12160
    ds_read_b128 a[236:239], v2 offset:8192
    v_cvt_pk_bf16_f32 v127, v134, v135
    v_mfma_f32_16x16x32_bf16 v[48:51], a[204:207], a[156:159], v[48:51]
    s_add_u32 m0, s38, 12288
    v_exp_f32 v131, v91
    v_mfma_f32_16x16x32_bf16 v[48:51], a[208:211], a[160:163], v[48:51]
    buffer_load_dwordx4 v10, s[12:15], s58 offen nt lds
    v_mfma_f32_16x16x32_bf16 v[48:51], a[212:215], a[164:167], v[48:51]
    s_add_u32 m0, s38, 13312
    v_cvt_pk_bf16_f32 v126, v132, v133
    v_cvt_pk_bf16_f32 v125, v130, v131
    v_mfma_f32_16x16x32_bf16 v[24:27], a[248:251], v[120:123], v[24:27]
    buffer_load_dwordx4 v11, s[12:15], s58 offen nt lds
    v_mfma_f32_16x16x32_bf16 v[24:27], a[252:255], v[124:127], v[24:27]
    s_add_u32 s59, s25, 18304
    s_add_u32 m0, s38, 18432
    v_mfma_f32_16x16x32_bf16 v[56:59], a[192:195], a[168:171], 0
    buffer_load_dwordx4 v10, s[12:15], s59 offen nt lds
    v_mfma_f32_16x16x32_bf16 v[56:59], a[196:199], a[172:175], v[56:59]
    s_add_u32 m0, s38, 19456
    v_mfma_f32_16x16x32_bf16 v[56:59], a[200:203], a[176:179], v[56:59]
    buffer_load_dwordx4 v11, s[12:15], s59 offen nt lds
    v_mfma_f32_16x16x32_bf16 v[56:59], a[204:207], a[180:183], v[56:59]
    v_cmp_lt_f32 vcc, s29, v24
    s_waitcnt vmcnt(17) lgkmcnt(0)
    v_mfma_f32_16x16x32_bf16 v[56:59], a[208:211], a[184:187], v[56:59]
    s_barrier
    v_mfma_f32_16x16x32_bf16 v[56:59], a[212:215], a[188:191], v[56:59]
    ds_read_b64_tr_b16 a[192:193], v3 offset:12288
    s_add_u32 m0, s22, 0
    v_mfma_f32_16x16x32_bf16 v[36:39], a[216:219], a[96:99], 0
    s_cbranch_vccnz L_rs_start4b
L_ret_start4b:
    ds_read_b64_tr_b16 a[194:195], v3 offset:18432
    v_mfma_f32_16x16x32_bf16 v[36:39], a[220:223], a[100:103], v[36:39]
    v_fma_f32 v35, v35, s28, v16
    v_mfma_f32_16x16x32_bf16 v[36:39], a[224:227], a[104:107], v[36:39]
    buffer_load_dwordx4 v9, s[4:7], s20 offen lds
    v_mfma_f32_16x16x32_bf16 v[36:39], a[228:231], a[108:111], v[36:39]
    v_fma_f32 v40, v40, s28, v17
    v_mfma_f32_16x16x32_bf16 v[36:39], a[232:235], a[112:115], v[36:39]
    ds_read_b64_tr_b16 a[196:197], v4 offset:12288
    v_fma_f32 v34, v34, s28, v16
    v_mfma_f32_16x16x32_bf16 v[36:39], a[236:239], a[116:119], v[36:39]
    v_fma_f32 v32, v32, s28, v16
    v_fma_f32 v33, v33, s28, v16
    v_mfma_f32_16x16x32_bf16 v[44:47], a[216:219], a[120:123], 0
    ds_read_b64_tr_b16 a[198:199], v4 offset:18432
    v_mfma_f32_16x16x32_bf16 v[44:47], a[220:223], a[124:127], v[44:47]
    v_exp_f32 v131, v35
    v_mfma_f32_16x16x32_bf16 v[44:47], a[224:227], a[128:131], v[44:47]
    s_add_u32 s20, s20, 128
    ds_read_b64_tr_b16 a[200:201], v5 offset:12288
    v_fma_f32 v41, v41, s28, v17
    v_mfma_f32_16x16x32_bf16 v[44:47], a[228:231], a[132:135], v[44:47]
    v_exp_f32 v130, v34
    v_mfma_f32_16x16x32_bf16 v[44:47], a[232:235], a[136:139], v[44:47]
    s_add_u32 m0, s22, 1024
    v_exp_f32 v133, v41
    v_mfma_f32_16x16x32_bf16 v[44:47], a[236:239], a[140:143], v[44:47]
    ds_read_b64_tr_b16 a[202:203], v5 offset:18432
    v_mfma_f32_16x16x32_bf16 v[52:55], a[216:219], a[144:147], 0
    buffer_load_dwordx4 v9, s[4:7], s20 offen lds
    v_mfma_f32_16x16x32_bf16 v[52:55], a[220:223], a[148:151], v[52:55]
    s_add_u32 s20, s20, 128
    ds_read_b64_tr_b16 a[204:205], v6 offset:12288
    v_mfma_f32_16x16x32_bf16 v[52:55], a[224:227], a[152:155], v[52:55]
    s_add_u32 m0, s22, 2048
    v_exp_f32 v128, v32
    v_mfma_f32_16x16x32_bf16 v[52:55], a[228:231], a[156:159], v[52:55]
    buffer_load_dwordx4 v9, s[4:7], s20 offen lds
    v_mfma_f32_16x16x32_bf16 v[52:55], a[232:235], a[160:163], v[52:55]
    v_exp_f32 v132, v40
    v_mfma_f32_16x16x32_bf16 v[52:55], a[236:239], a[164:167], v[52:55]
    ds_read_b64_tr_b16 a[206:207], v6 offset:18432
    v_mfma_f32_16x16x32_bf16 v[60:63], a[216:219], a[168:171], 0
    v_exp_f32 v129, v33
    v_mfma_f32_16x16x32_bf16 v[60:63], a[220:223], a[172:175], v[60:63]
    ds_read_b64_tr_b16 a[208:209], v3 offset:13312
    v_mfma_f32_16x16x32_bf16 v[60:63], a[224:227], a[176:179], v[60:63]
    ds_read_b64_tr_b16 a[210:211], v3 offset:19456
    s_add_u32 s20, s20, 12032
    v_mfma_f32_16x16x32_bf16 v[60:63], a[228:231], a[180:183], v[60:63]
    ds_read_b64_tr_b16 a[212:213], v4 offset:13312
    v_cvt_pk_bf16_f32 v96, v128, v129
    v_mfma_f32_16x16x32_bf16 v[60:63], a[232:235], a[184:187], v[60:63]
    ds_read_b64_tr_b16 a[214:215], v4 offset:19456
    v_cvt_pk_bf16_f32 v97, v130, v131
    v_mfma_f32_16x16x32_bf16 v[60:63], a[236:239], a[188:191], v[60:63]
    v_cvt_pk_bf16_f32 v100, v132, v133
    s_branch L_loop4
L_start3:
    s_add_u32 m0, s22, 0
    s_nop 0
    buffer_load_dwordx4 v9, s[4:7], s20 offen lds
    s_add_u32 s20, s20, 128
    s_add_u32 m0, s22, 1024
    s_nop 0
    buffer_load_dwordx4 v9, s[4:7], s20 offen lds
    s_add_u32 s20, s20, 128
    s_add_u32 m0, s22, 2048
    s_nop 0
    buffer_load_dwordx4 v9, s[4:7], s20 offen lds
    s_add_u32 s20, s20, 12032
    s_add_u32 s48, s34, 0
    s_add_u32 m0, s38, 0
    s_nop 0
    buffer_load_dwordx4 v10, s[12:15], s48 offen nt lds
    s_add_u32 m0, s38, 1024
    s_nop 0
    buffer_load_dwordx4 v11, s[12:15], s48 offen nt lds
    s_add_u32 s48, s34, 128
    s_add_u32 m0, s38, 2048
    s_nop 0
    buffer_load_dwordx4 v10, s[12:15], s48 offen nt lds
    s_add_u32 m0, s38, 3072
    s_nop 0
    buffer_load_dwordx4 v11, s[12:15], s48 offen nt lds
    s_add_u32 s48, s34, 256
    s_add_u32 m0, s38, 4096
    s_nop 0
    buffer_load_dwordx4 v10, s[12:15], s48 offen nt lds
    s_add_u32 m0, s38, 5120
    s_nop 0
    buffer_load_dwordx4 v11, s[12:15], s48 offen nt lds
    s_add_u32 s48, s34, 6144
    s_add_u32 m0, s38, 6144
    s_nop 0
    buffer_load_dwordx4 v10, s[12:15], s48 offen nt lds
    s_add_u32 m0, s38, 7168
    s_nop 0
    buffer_load_dwordx4 v11, s[12:15], s48 offen nt lds
    s_add_u32 s48, s34, 6272
    s_add_u32 m0, s38, 8192
    s_nop 0
    buffer_load_dwordx4 v10, s[12:15], s48 offen nt lds
    s_add_u32 m0, s38, 9216
    s_nop 0
    buffer_load_dwordx4 v11, s[12:15], s48 offen nt lds
    s_add_u32 s48, s34, 6400
    s_add_u32 m0, s38, 10240
    s_nop 0
    buffer_load_dwordx4 v10, s[12:15], s48 offen nt lds
    s_add_u32 m0, s38, 11264
    s_nop 0
    buffer_load_dwordx4 v11, s[12:15], s48 offen nt lds
    v_and_b32 v128, 15, v0
    v_lshrrev_b32 v129, 4, v0
    v_lshrrev_b32 v130, 3, v128
    v_and_b32 v131, 7, v128
    v_lshlrev_b32 v1, 7, v131
    v_bfe_u32 v131, v128, 1, 2
    v_lshlrev_b32 v131, 1, v131
    v_mul_u32_u24 v132, 5, v130
    v_xor_b32 v131, v131, v132
    v_xor_b32 v131, v131, v129
    v_lshl_add_u32 v1, v131, 4, v1
    v_lshl_add_u32 v7, v130, 10, v1
    v_add_u32 v7, s38, v7
    v_mul_u32_u24 v132, 3072, v130
    v_add_u32 v1, v132, v1
    v_xor_b32 v2, 64, v1
    v_xor_b32 v8, 64, v7
    v_lshrrev_b32 v130, 1, v129
    v_mul_u32_u24 v3, 3072, v130
    v_and_b32 v131, 1, v129
    v_bfe_u32 v132, v0, 2, 2
    v_lshl_add_u32 v128, v131, 2, v132
    v_lshl_add_u32 v3, v128, 7, v3
    v_lshrrev_b32 v128, 1, v128
    v_lshlrev_b32 v128, 1, v128
    v_mul_u32_u24 v130, 5, v130
    v_xor_b32 v128, v128, v130
    v_bfe_u32 v131, v0, 1, 1
    v_xor_b32 v128, v128, v131
    v_lshl_add_u32 v3, v128, 4, v3
    v_and_b32 v131, 1, v0
    v_lshl_add_u32 v3, v131, 3, v3
    v_add_u32 v3, 24576, v3
    v_xor_b32 v4, 32, v3
    v_xor_b32 v5, 64, v3
    v_xor_b32 v6, 96, v3
    v_lshrrev_b32 v128, 3, v0
    v_and_b32 v129, 15, v0
    v_lshrrev_b32 v130, 4, v0
    v_lshrrev_b32 v131, 1, v130
    v_and_b32 v132, 7, v129
    v_xor_b32 v131, v131, v132
    v_lshlrev_b32 v14, 7, v129
    v_lshl_add_u32 v14, v131, 4, v14
    v_and_b32 v130, 1, v130
    v_lshl_add_u32 v14, v130, 3, v14
    v_add_u32 v14, s38, v14
    v_and_b32 v129, 7, v0
    v_xor_b32 v130, v129, v128
    v_lshlrev_b32 v13, 7, v128
    v_lshl_add_u32 v13, v130, 4, v13
    v_add_u32 v13, s38, v13
    v_add_u32 v13, 2048, v13
    v_mul_u32_u24 v12, 384, v128
    v_lshl_add_u32 v12, v129, 4, v12
    v_and_b32 v128, 15, v0
    v_and_b32 v129, 3, v0
    v_mov_b32 v131, 0x3f803f80
    v_cmp_eq_u32 s[42:43], 12, v128
    v_cmp_eq_u32 vcc, 0, v129
    s_nop 3
    s_or_b64 vcc, vcc, s[42:43]
    v_cndmask_b32 v130, 0, v131, vcc
    v_accvgpr_write_b32 a240, v130
    v_accvgpr_write_b32 a241, v130
    v_accvgpr_write_b32 a242, v130
    v_accvgpr_write_b32 a243, v130
    v_cmp_eq_u32 vcc, 1, v129
    s_nop 3
    s_or_b64 vcc, vcc, s[42:43]
    v_cndmask_b32 v130, 0, v131, vcc
    v_accvgpr_write_b32 a244, v130
    v_accvgpr_write_b32 a245, v130
    v_accvgpr_write_b32 a246, v130
    v_accvgpr_write_b32 a247, v130
    v_cmp_eq_u32 vcc, 2, v129
    s_nop 3
    s_or_b64 vcc, vcc, s[42:43]
    v_cndmask_b32 v130, 0, v131, vcc
    v_accvgpr_write_b32 a248, v130
    v_accvgpr_write_b32 a249, v130
    v_accvgpr_write_b32 a250, v130
    v_accvgpr_write_b32 a251, v130
    v_cmp_eq_u32 vcc, 3, v129
    s_nop 3
    s_or_b64 vcc, vcc, s[42:43]
    v_cndmask_b32 v130, 0, v131, vcc
    v_accvgpr_write_b32 a252, v130
    v_accvgpr_write_b32 a253, v130
    v_accvgpr_write_b32 a254, v130
    v_accvgpr_write_b32 a255, v130
    s_waitcnt vmcnt(12)
    s_barrier
    ds_read_b128 a[192:195], v1 offset:0
    ds_read_b128 a[196:199], v2 offset:0
    ds_read_b128 a[200:203], v1 offset:1024
    ds_read_b128 a[204:207], v2 offset:1024
    ds_read_b128 a[208:211], v1 offset:2048
    ds_read_b128 a[212:215], v2 offset:2048
    ds_read_b128 a[216:219], v1 offset:6144
    ds_read_b128 a[220:223], v2 offset:6144
    ds_read_b128 a[224:227], v1 offset:7168
    ds_read_b128 a[228:231], v2 offset:7168
    ds_read_b128 a[232:235], v1 offset:8192
    ds_read_b128 a[236:239], v2 offset:8192
    s_waitcnt vmcnt(6)
    ds_read_b128 a[96:99], v7 offset:0
    s_add_u32 s48, s34, 12288
    s_add_u32 m0, s38, 12288
    ds_read_b128 a[100:103], v8 offset:0
    ds_read_b128 a[104:107], v7 offset:2048
    ds_read_b128 a[108:111], v8 offset:2048
    ds_read_b128 a[112:115], v7 offset:4096
    ds_read_b128 a[116:119], v8 offset:4096
    s_waitcnt lgkmcnt(5)
    v_mfma_f32_16x16x32_bf16 v[32:35], a[192:195], a[96:99], 0
    buffer_load_dwordx4 v10, s[12:15], s48 offen nt lds
    s_add_u32 m0, s38, 13312
    s_waitcnt lgkmcnt(4)
    v_mfma_f32_16x16x32_bf16 v[32:35], a[196:199], a[100:103], v[32:35]
    buffer_load_dwordx4 v11, s[12:15], s48 offen nt lds
    s_add_u32 s48, s34, 12416
    s_add_u32 m0, s38, 14336
    s_waitcnt lgkmcnt(3)
    v_mfma_f32_16x16x32_bf16 v[32:35], a[200:203], a[104:107], v[32:35]
    buffer_load_dwordx4 v10, s[12:15], s48 offen nt lds
    s_add_u32 m0, s38, 15360
    s_waitcnt lgkmcnt(2)
    v_mfma_f32_16x16x32_bf16 v[32:35], a[204:207], a[108:111], v[32:35]
    buffer_load_dwordx4 v11, s[12:15], s48 offen nt lds
    s_add_u32 s48, s34, 12544
    s_add_u32 m0, s38, 16384
    s_waitcnt lgkmcnt(1)
    v_mfma_f32_16x16x32_bf16 v[32:35], a[208:211], a[112:115], v[32:35]
    buffer_load_dwordx4 v10, s[12:15], s48 offen nt lds
    s_add_u32 m0, s38, 17408
    s_waitcnt lgkmcnt(0)
    v_mfma_f32_16x16x32_bf16 v[32:35], a[212:215], a[116:119], v[32:35]
    buffer_load_dwordx4 v11, s[12:15], s48 offen nt lds
    s_add_u32 m0, s22, 12288
    v_mfma_f32_16x16x32_bf16 v[36:39], a[216:219], a[96:99], 0
    v_mfma_f32_16x16x32_bf16 v[36:39], a[220:223], a[100:103], v[36:39]
    v_mfma_f32_16x16x32_bf16 v[36:39], a[224:227], a[104:107], v[36:39]
    v_mfma_f32_16x16x32_bf16 v[36:39], a[228:231], a[108:111], v[36:39]
    v_mfma_f32_16x16x32_bf16 v[36:39], a[232:235], a[112:115], v[36:39]
    v_mfma_f32_16x16x32_bf16 v[36:39], a[236:239], a[116:119], v[36:39]
    s_waitcnt vmcnt(6)
    ds_read_b128 a[120:123], v7 offset:6144
    ds_read_b128 a[124:127], v8 offset:6144
    ds_read_b128 a[128:131], v7 offset:8192
    ds_read_b128 a[132:135], v8 offset:8192
    ds_read_b128 a[136:139], v7 offset:10240
    ds_read_b128 a[140:143], v8 offset:10240
    s_waitcnt lgkmcnt(5)
    v_mfma_f32_16x16x32_bf16 v[40:43], a[192:195], a[120:123], 0
    buffer_load_dwordx4 v9, s[4:7], s20 offen lds
    s_add_u32 s20, s20, 128
    s_add_u32 m0, s22, 13312
    s_waitcnt lgkmcnt(4)
    v_mfma_f32_16x16x32_bf16 v[40:43], a[196:199], a[124:127], v[40:43]
    buffer_load_dwordx4 v9, s[4:7], s20 offen lds
    s_add_u32 s20, s20, 128
    s_add_u32 m0, s22, 14336
    s_waitcnt lgkmcnt(3)
    v_mfma_f32_16x16x32_bf16 v[40:43], a[200:203], a[128:131], v[40:43]
    buffer_load_dwordx4 v9, s[4:7], s20 offen lds
    s_add_u32 s20, s20, 12032
    s_add_u32 m0, s22, 24576
    s_waitcnt lgkmcnt(2)
    v_mfma_f32_16x16x32_bf16 v[40:43], a[204:207], a[132:135], v[40:43]
    s_waitcnt lgkmcnt(1)
    v_mfma_f32_16x16x32_bf16 v[40:43], a[208:211], a[136:139], v[40:43]
    s_waitcnt lgkmcnt(0)
    v_mfma_f32_16x16x32_bf16 v[40:43], a[212:215], a[140:143], v[40:43]
    v_mfma_f32_16x16x32_bf16 v[44:47], a[216:219], a[120:123], 0
    v_mfma_f32_16x16x32_bf16 v[44:47], a[220:223], a[124:127], v[44:47]
    v_mfma_f32_16x16x32_bf16 v[44:47], a[224:227], a[128:131], v[44:47]
    v_mfma_f32_16x16x32_bf16 v[44:47], a[228:231], a[132:135], v[44:47]
    v_mfma_f32_16x16x32_bf16 v[44:47], a[232:235], a[136:139], v[44:47]
    v_mfma_f32_16x16x32_bf16 v[44:47], a[236:239], a[140:143], v[44:47]
    s_waitcnt vmcnt(3)
    ds_read_b128 a[144:147], v7 offset:12288
    ds_read_b128 a[148:151], v8 offset:12288
    ds_read_b128 a[152:155], v7 offset:14336
    ds_read_b128 a[156:159], v8 offset:14336
    ds_read_b128 a[160:163], v7 offset:16384
    ds_read_b128 a[164:167], v8 offset:16384
    s_waitcnt lgkmcnt(5)
    v_mfma_f32_16x16x32_bf16 v[48:51], a[192:195], a[144:147], 0
    buffer_load_dwordx4 v9, s[8:11], s21 offen lds
    s_add_u32 s21, s21, 128
    s_add_u32 m0, s22, 25600
    s_waitcnt lgkmcnt(4)
    v_mfma_f32_16x16x32_bf16 v[48:51], a[196:199], a[148:151], v[48:51]
    buffer_load_dwordx4 v9, s[8:11], s21 offen lds
    s_add_u32 s21, s21, 128
    s_add_u32 m0, s22, 26624
    s_waitcnt lgkmcnt(3)
    v_mfma_f32_16x16x32_bf16 v[48:51], a[200:203], a[152:155], v[48:51]
    buffer_load_dwordx4 v9, s[8:11], s21 offen lds
    s_add_u32 s21, s21, 12032
    s_add_u32 m0, s22, 36864
    s_waitcnt lgkmcnt(2)
    v_mfma_f32_16x16x32_bf16 v[48:51], a[204:207], a[156:159], v[48:51]
    buffer_load_dwordx4 v9, s[8:11], s21 offen lds
    s_add_u32 s21, s21, 128
    s_add_u32 m0, s22, 37888
    s_waitcnt lgkmcnt(1)
    v_mfma_f32_16x16x32_bf16 v[48:51], a[208:211], a[160:163], v[48:51]
    buffer_load_dwordx4 v9, s[8:11], s21 offen lds
    s_add_u32 s21, s21, 128
    s_add_u32 m0, s22, 38912
    s_waitcnt lgkmcnt(0)
    v_mfma_f32_16x16x32_bf16 v[48:51], a[212:215], a[164:167], v[48:51]
    buffer_load_dwordx4 v9, s[8:11], s21 offen lds
    s_add_u32 s21, s21, 12032
    v_mfma_f32_16x16x32_bf16 v[52:55], a[216:219], a[144:147], 0
    v_mfma_f32_16x16x32_bf16 v[52:55], a[220:223], a[148:151], v[52:55]
    v_mfma_f32_16x16x32_bf16 v[52:55], a[224:227], a[152:155], v[52:55]
    v_mfma_f32_16x16x32_bf16 v[52:55], a[228:231], a[156:159], v[52:55]
    v_mfma_f32_16x16x32_bf16 v[52:55], a[232:235], a[160:163], v[52:55]
    v_mfma_f32_16x16x32_bf16 v[52:55], a[236:239], a[164:167], v[52:55]
    s_waitcnt vmcnt(6)
    s_barrier
    ds_read_b128 a[196:199], v2 offset:12288
    ds_read_b128 a[204:207], v2 offset:13312
    ds_read_b128 a[200:203], v1 offset:13312
    ds_read_b128 a[192:195], v1 offset:12288
    v_max3_f32 v28, v32, v33, v34
    v_max3_f32 v30, v40, v41, v42
    v_max3_f32 v28, v28, v35, v36
    v_max3_f32 v28, v28, v37, v38
    v_max_f32 v28, v28, v39
    v_max3_f32 v30, v30, v43, v44
    v_mov_b32 v29, v28
    v_max3_f32 v30, v30, v45, v46
    v_max_f32 v30, v30, v47
    v_mov_b32 v31, v30
    v_permlane32_swap_b32 v29, v28
    v_max_f32 v28, v28, v29
    v_mov_b32 v29, v28
    v_permlane32_swap_b32 v31, v30
    s_add_u32 m0, s22, 0
    v_max_f32 v30, v30, v31
    v_permlane16_swap_b32 v29, v28
    v_max_f32 v28, v28, v29
    v_mul_f32_e64 v16, -s28, v28
    v_max3_f32 v28, v48, v49, v50
    v_max3_f32 v28, v28, v51, v52
    v_mov_b32 v31, v30
    v_fma_f32 v36, v36, s28, v16
    v_max3_f32 v28, v28, v53, v54
    v_fma_f32 v35, v35, s28, v16
    v_fma_f32 v32, v32, s28, v16
    v_permlane16_swap_b32 v31, v30
    v_max_f32 v28, v28, v55
    v_fma_f32 v39, v39, s28, v16
    v_fma_f32 v34, v34, s28, v16
    v_max_f32 v30, v30, v31
    v_exp_f32 v131, v35
    v_mov_b32 v29, v28
    v_mul_f32_e64 v17, -s28, v30
    s_waitcnt lgkmcnt(0)
    v_mfma_f32_16x16x32_bf16 v[64:67], a[192:195], a[96:99], 0
    ds_read_b128 a[208:211], v1 offset:14336
    buffer_load_dwordx4 v9, s[4:7], s20 offen lds
    v_exp_f32 v130, v34
    v_mfma_f32_16x16x32_bf16 v[64:67], a[196:199], a[100:103], v[64:67]
    s_add_u32 s20, s20, 128
    ds_read_b128 a[212:215], v2 offset:14336
    v_permlane32_swap_b32 v29, v28
    v_max_f32 v28, v28, v29
    v_fma_f32 v41, v41, s28, v17
    v_fma_f32 v40, v40, s28, v17
    v_exp_f32 v128, v32
    v_fma_f32 v37, v37, s28, v16
    v_fma_f32 v47, v47, s28, v17
    v_fma_f32 v33, v33, s28, v16
    v_mov_b32 v29, v28
    v_exp_f32 v135, v37
    v_exp_f32 v132, v40
    v_fma_f32 v38, v38, s28, v16
    v_exp_f32 v129, v33
    v_exp_f32 v133, v41
    v_permlane16_swap_b32 v29, v28
    v_cvt_pk_bf16_f32 v96, v128, v129
    v_exp_f32 v129, v39
    v_mfma_f32_16x16x32_bf16 v[64:67], a[200:203], a[104:107], v[64:67]
    s_add_u32 m0, s22, 1024
    ds_read_b128 a[228:231], v2 offset:19456
    buffer_load_dwordx4 v9, s[4:7], s20 offen lds
    v_cvt_pk_bf16_f32 v97, v130, v131
    v_mfma_f32_16x16x32_bf16 v[64:67], a[204:207], a[108:111], v[64:67]
    s_add_u32 s20, s20, 128
    ds_read_b128 a[216:219], v1 offset:18432
    v_fma_f32 v45, v45, s28, v17
    v_fma_f32 v42, v42, s28, v17
    v_max_f32 v28, v28, v29
    v_mul_f32_e64 v18, -s28, v28
    s_waitcnt lgkmcnt(2)
    v_mfma_f32_16x16x32_bf16 v[64:67], a[208:211], a[112:115], v[64:67]
    s_add_u32 m0, s22, 2048
    v_exp_f32 v134, v36
    v_mfma_f32_16x16x32_bf16 v[64:67], a[212:215], a[116:119], v[64:67]
    ds_read_b128 a[220:223], v2 offset:18432
    buffer_load_dwordx4 v9, s[4:7], s20 offen lds
    v_fma_f32 v43, v43, s28, v17
    v_mfma_f32_16x16x32_bf16 v[72:75], a[192:195], a[120:123], 0
    s_add_u32 s20, s20, 12032
    ds_read_b128 a[232:235], v1 offset:20480
    v_exp_f32 v128, v38
    v_fma_f32 v53, v53, s28, v18
    v_mfma_f32_16x16x32_bf16 v[72:75], a[196:199], a[124:127], v[72:75]
    s_add_u32 s37, s37, 1
    v_exp_f32 v131, v43
    v_fma_f32 v51, v51, s28, v18
    v_cvt_pk_bf16_f32 v98, v134, v135
    v_mfma_f32_16x16x32_bf16 v[72:75], a[200:203], a[128:131], v[72:75]
    s_add_u32 s35, s35, 325632
    s_lshl_b32 s42, s37, 1
    v_fma_f32 v46, v46, s28, v17
    s_lshr_b32 s42, s31, s42
    v_mfma_f32_16x16x32_bf16 v[72:75], a[204:207], a[132:135], v[72:75]
    s_xor_b32 s42, s42, s36
    s_and_b32 s42, s42, 3
    ds_read_b128 a[224:227], v1 offset:19456
    v_mfma_f32_16x16x32_bf16 v[72:75], a[208:211], a[136:139], v[72:75]
    s_mul_i32 s43, s3, 3
    s_lshl_b32 s44, s3, 2
    v_fma_f32 v52, v52, s28, v18
    v_cvt_pk_bf16_f32 v100, v132, v133
    v_mfma_f32_16x16x32_bf16 v[72:75], a[212:215], a[140:143], v[72:75]
    s_mov_b32 s32, 1
    ds_read_b128 a[236:239], v2 offset:20480
    v_exp_f32 v135, v47
    v_mfma_f32_16x16x32_bf16 v[80:83], a[192:195], a[144:147], 0
    s_add_u32 s45, s43, 17
    v_fma_f32 v49, v49, s28, v18
    v_fma_f32 v55, v55, s28, v18
    v_cvt_pk_bf16_f32 v99, v128, v129
    s_cmp_eq_u32 s3, 0
    v_mfma_f32_16x16x32_bf16 v[80:83], a[196:199], a[148:151], v[80:83]
    s_cselect_b32 s45, 16, s45
    v_exp_f32 v130, v42
    v_mfma_f32_16x16x32_bf16 v[80:83], a[200:203], a[152:155], v[80:83]
    s_cselect_b32 s33, 1, 0
    v_fma_f32 v50, v50, s28, v18
    v_exp_f32 v133, v45
    v_mfma_f32_16x16x32_bf16 v[80:83], a[204:207], a[156:159], v[80:83]
    s_cmp_eq_u32 s42, 1
    v_fma_f32 v44, v44, s28, v17
    v_exp_f32 v134, v46
    v_mfma_f32_16x16x32_bf16 v[80:83], a[208:211], a[160:163], v[80:83]
    s_cselect_b32 s44, s45, s44
    v_fma_f32 v66, v66, s28, v16
    v_exp_f32 v132, v44
    v_mfma_f32_16x16x32_bf16 v[20:23], a[240:243], v[96:99], 0
    s_cselect_b32 s32, s33, s32
    s_add_u32 s45, s43, 29
    v_cvt_pk_bf16_f32 v101, v130, v131
    v_exp_f32 v130, v50
    v_exp_f32 v129, v49
    v_exp_f32 v131, v51
    v_mfma_f32_16x16x32_bf16 v[80:83], a[212:215], a[164:167], v[80:83]
    s_waitcnt lgkmcnt(0)
    v_fma_f32 v65, v65, s28, v16
    v_fma_f32 v67, v67, s28, v16
    v_mfma_f32_16x16x32_bf16 v[68:71], a[216:219], a[96:99], 0
    s_cmp_eq_u32 s42, 2
    v_cvt_pk_bf16_f32 v102, v132, v133
    v_fma_f32 v48, v48, s28, v18
    v_mfma_f32_16x16x32_bf16 v[68:71], a[220:223], a[100:103], v[68:71]
    s_cselect_b32 s44, s45, s44
    v_exp_f32 v128, v48
    v_mfma_f32_16x16x32_bf16 v[68:71], a[224:227], a[104:107], v[68:71]
    s_cselect_b32 s32, 0, s32
    v_cvt_pk_bf16_f32 v104, v128, v129
    v_exp_f32 v132, v52
    v_mfma_f32_16x16x32_bf16 v[68:71], a[228:231], a[108:111], v[68:71]
    s_add_u32 s45, s43, 41
    s_cmp_eq_u32 s42, 3
    v_exp_f32 v129, v65
    v_cvt_pk_bf16_f32 v103, v134, v135
    s_cselect_b32 s44, s45, s44
    s_cselect_b32 s32, 0, s32
    s_mul_i32 s44, s44, 6144
    v_exp_f32 v133, v53
    v_mfma_f32_16x16x32_bf16 v[68:71], a[232:235], a[112:115], v[68:71]
    s_add_u32 s33, s35, s44
    v_fma_f32 v73, v73, s28, v17
    v_fma_f32 v72, v72, s28, v17
    v_mfma_f32_16x16x32_bf16 v[68:71], a[236:239], a[116:119], v[68:71]
    s_mul_i32 s42, s32, 6144
    v_exp_f32 v135, v55
    v_mfma_f32_16x16x32_bf16 v[20:23], a[244:247], v[100:103], v[20:23]
    s_add_u32 s42, s42, 18432
    v_cvt_pk_bf16_f32 v106, v132, v133
    v_cvt_pk_bf16_f32 v105, v130, v131
    v_exp_f32 v131, v67
    v_mfma_f32_16x16x32_bf16 v[76:79], a[216:219], a[120:123], 0
    s_add_u32 s42, s42, s33
    v_exp_f32 v133, v73
    s_cmp_ge_u32 s37, 8
    v_mfma_f32_16x16x32_bf16 v[76:79], a[220:223], a[124:127], v[76:79]
    s_cselect_b32 s14, 0, s42
    v_exp_f32 v132, v72
    s_add_u32 s25, s33, 128
    v_mfma_f32_16x16x32_bf16 v[76:79], a[224:227], a[128:131], v[76:79]
    s_add_u32 s23, s38, 2048
    v_fma_f32 v64, v64, s28, v16
    s_mov_b32 s30, 0
    s_waitcnt vmcnt(6)
    v_fma_f32 v54, v54, s28, v18
    v_exp_f32 v128, v64
    v_mfma_f32_16x16x32_bf16 v[76:79], a[228:231], a[132:135], v[76:79]
    s_barrier
    ds_read_b64_tr_b16 a[192:193], v3 offset:0
    v_mfma_f32_16x16x32_bf16 v[76:79], a[232:235], a[136:139], v[76:79]
    s_add_u32 m0, s22, 12288
    ds_read_b64_tr_b16 a[194:195], v3 offset:6144
    buffer_load_dwordx4 v9, s[4:7], s20 offen lds
    v_exp_f32 v130, v66
    v_exp_f32 v134, v54
    v_mfma_f32_16x16x32_bf16 v[76:79], a[236:239], a[140:143], v[76:79]
    ds_read_b64_tr_b16 a[196:197], v4 offset:0
    ds_read_b64_tr_b16 a[198:199], v4 offset:6144
    v_mfma_f32_16x16x32_bf16 v[84:87], a[216:219], a[144:147], 0
    s_add_u32 s20, s20, 128
    ds_read_b64_tr_b16 a[200:201], v5 offset:0
    ds_read_b64_tr_b16 a[202:203], v5 offset:6144
    v_mfma_f32_16x16x32_bf16 v[84:87], a[220:223], a[148:151], v[84:87]
    ds_read_b64_tr_b16 a[204:205], v6 offset:0
    v_cvt_pk_bf16_f32 v107, v134, v135
    v_mfma_f32_16x16x32_bf16 v[84:87], a[224:227], a[152:155], v[84:87]
    s_add_u32 m0, s22, 13312
    ds_read_b64_tr_b16 a[206:207], v6 offset:6144
    v_cvt_pk_bf16_f32 v116, v132, v133
    v_mfma_f32_16x16x32_bf16 v[84:87], a[228:231], a[156:159], v[84:87]
    ds_read_b64_tr_b16 a[208:209], v3 offset:1024
    buffer_load_dwordx4 v9, s[4:7], s20 offen lds
    v_mfma_f32_16x16x32_bf16 v[84:87], a[232:235], a[160:163], v[84:87]
    s_add_u32 s20, s20, 128
    ds_read_b64_tr_b16 a[210:211], v3 offset:7168
    ds_read_b64_tr_b16 a[212:213], v4 offset:1024
    v_mfma_f32_16x16x32_bf16 v[84:87], a[236:239], a[164:167], v[84:87]
    s_add_u32 m0, s22, 14336
    ds_read_b64_tr_b16 a[214:215], v4 offset:7168
    buffer_load_dwordx4 v9, s[4:7], s20 offen lds
    v_mfma_f32_16x16x32_bf16 v[20:23], a[248:251], v[104:107], v[20:23]
    s_add_u32 s20, s20, 12032
    v_cvt_pk_bf16_f32 v112, v128, v129
    v_cvt_pk_bf16_f32 v113, v130, v131
    v_fma_f32 v68, v68, s28, v16
    s_waitcnt lgkmcnt(10)
    v_mfma_f32_16x16x32_bf16 v[160:163], a[192:195], v[96:99], 0
    ds_read_b64_tr_b16 a[218:219], v5 offset:7168
    v_fma_f32 v69, v69, s28, v16
    v_fma_f32 v74, v74, s28, v17
    v_mfma_f32_16x16x32_bf16 v[208:211], a[192:195], v[100:103], 0
    ds_read_b64_tr_b16 a[238:239], v6 offset:8192
    v_fma_f32 v78, v78, s28, v17
    v_mfma_f32_16x16x32_bf16 a[0:3], a[192:195], v[104:107], 0
    s_waitcnt lgkmcnt(10)
    ds_read_b64_tr_b16 a[216:217], v5 offset:1024
    v_fma_f32 v77, v77, s28, v17
    v_mfma_f32_16x16x32_bf16 v[164:167], a[196:199], v[96:99], 0
    ds_read_b64_tr_b16 a[234:235], v5 offset:8192
    v_fma_f32 v76, v76, s28, v17
    v_mfma_f32_16x16x32_bf16 v[212:215], a[196:199], v[100:103], 0
    ds_read_b64_tr_b16 a[220:221], v6 offset:1024
    v_fma_f32 v82, v82, s28, v18
    v_mfma_f32_16x16x32_bf16 a[4:7], a[196:199], v[104:107], 0
    s_waitcnt lgkmcnt(11)
    ds_read_b64_tr_b16 a[228:229], v4 offset:2048
    v_fma_f32 v70, v70, s28, v16
    v_mfma_f32_16x16x32_bf16 v[168:171], a[200:203], v[96:99], 0
    ds_read_b64_tr_b16 a[236:237], v6 offset:2048
    v_fma_f32 v83, v83, s28, v18
    v_mfma_f32_16x16x32_bf16 v[216:219], a[200:203], v[100:103], 0
    ds_read_b64_tr_b16 a[230:231], v4 offset:8192
    v_mfma_f32_16x16x32_bf16 a[8:11], a[200:203], v[104:107], 0
    s_waitcnt lgkmcnt(9)
    ds_read_b64_tr_b16 a[226:227], v3 offset:8192
    v_fma_f32 v71, v71, s28, v16
    v_mfma_f32_16x16x32_bf16 v[172:175], a[204:207], v[96:99], 0
    ds_read_b64_tr_b16 a[232:233], v5 offset:2048
    v_fma_f32 v75, v75, s28, v17
    v_mfma_f32_16x16x32_bf16 v[220:223], a[204:207], v[100:103], 0
    ds_read_b64_tr_b16 a[224:225], v3 offset:2048
    v_fma_f32 v84, v84, s28, v18
    v_mfma_f32_16x16x32_bf16 a[12:15], a[204:207], v[104:107], 0
    ds_read_b64_tr_b16 a[222:223], v6 offset:7168
    v_fma_f32 v87, v87, s28, v18
    v_mfma_f32_16x16x32_bf16 v[176:179], a[208:211], v[96:99], 0
    v_exp_f32 v129, v71
    v_mfma_f32_16x16x32_bf16 v[224:227], a[208:211], v[100:103], 0
    v_exp_f32 v134, v68
    v_mfma_f32_16x16x32_bf16 a[16:19], a[208:211], v[104:107], 0
    s_waitcnt lgkmcnt(7)
    v_exp_f32 v128, v70
    v_mfma_f32_16x16x32_bf16 v[180:183], a[212:215], v[96:99], 0
    v_exp_f32 v135, v69
    v_mfma_f32_16x16x32_bf16 v[228:231], a[212:215], v[100:103], 0
    v_cvt_pk_bf16_f32 v114, v134, v135
    v_cvt_pk_bf16_f32 v115, v128, v129
    v_mfma_f32_16x16x32_bf16 a[20:23], a[212:215], v[104:107], 0
    v_exp_f32 v132, v76
    v_mfma_f32_16x16x32_bf16 v[24:27], a[240:243], v[112:115], v[20:23]
    v_exp_f32 v130, v74
    v_mfma_f32_16x16x32_bf16 v[184:187], a[216:219], v[96:99], 0
    v_exp_f32 v131, v75
    v_mfma_f32_16x16x32_bf16 v[232:235], a[216:219], v[100:103], 0
    v_exp_f32 v134, v78
    s_waitcnt vmcnt(3) lgkmcnt(0)
    v_mfma_f32_16x16x32_bf16 a[24:27], a[216:219], v[104:107], 0
    s_barrier
    v_mfma_f32_16x16x32_bf16 v[188:191], a[220:223], v[96:99], 0
    s_add_u32 m0, s22, 24576
    ds_read_b128 a[208:211], v1 offset:2048
    v_fma_f32 v81, v81, s28, v18
    v_mfma_f32_16x16x32_bf16 v[236:239], a[220:223], v[100:103], 0
    buffer_load_dwordx4 v9, s[8:11], s21 offen lds
    ds_read_b128 a[216:219], v1 offset:6144
    v_mfma_f32_16x16x32_bf16 a[28:31], a[220:223], v[104:107], 0
    s_add_u32 s21, s21, 128
    ds_read_b128 a[196:199], v2 offset:0
    v_cvt_pk_bf16_f32 v117, v130, v131
    v_mfma_f32_16x16x32_bf16 v[192:195], a[224:227], v[96:99], 0
    ds_read_b128 a[192:195], v1 offset:0
    v_fma_f32 v86, v86, s28, v18
    v_mfma_f32_16x16x32_bf16 v[240:243], a[224:227], v[100:103], 0
    s_add_u32 m0, s22, 25600
    ds_read_b128 a[200:203], v1 offset:1024
    v_fma_f32 v79, v79, s28, v17
    v_mfma_f32_16x16x32_bf16 a[32:35], a[224:227], v[104:107], 0
    buffer_load_dwordx4 v9, s[8:11], s21 offen lds
    v_mfma_f32_16x16x32_bf16 v[196:199], a[228:231], v[96:99], 0
    s_add_u32 s21, s21, 128
    ds_read_b128 a[212:215], v2 offset:2048
    v_exp_f32 v133, v77
    v_mfma_f32_16x16x32_bf16 v[244:247], a[228:231], v[100:103], 0
    s_add_u32 m0, s22, 26624
    v_exp_f32 v135, v79
    v_mfma_f32_16x16x32_bf16 a[36:39], a[228:231], v[104:107], 0
    ds_read_b128 a[204:207], v2 offset:1024
    buffer_load_dwordx4 v9, s[8:11], s21 offen lds
    v_mfma_f32_16x16x32_bf16 v[200:203], a[232:235], v[96:99], 0
    ds_read_b128 a[224:227], v1 offset:7168
    v_cvt_pk_bf16_f32 v118, v132, v133
    v_mfma_f32_16x16x32_bf16 v[248:251], a[232:235], v[100:103], 0
    s_add_u32 s21, s21, 12032
    v_exp_f32 v131, v83
    v_mfma_f32_16x16x32_bf16 a[40:43], a[232:235], v[104:107], 0
    s_add_u32 s58, s25, 4294967168
    ds_read_b128 a[220:223], v2 offset:6144
    v_fma_f32 v85, v85, s28, v18
    v_mfma_f32_16x16x32_bf16 v[204:207], a[236:239], v[96:99], 0
    s_add_u32 m0, s38, 0
    v_exp_f32 v130, v82
    v_mfma_f32_16x16x32_bf16 v[252:255], a[236:239], v[100:103], 0
    buffer_load_dwordx4 v10, s[12:15], s58 offen nt lds
    v_mfma_f32_16x16x32_bf16 a[44:47], a[236:239], v[104:107], 0
    s_waitcnt lgkmcnt(4)
    ds_read_b128 a[228:231], v2 offset:7168
    v_fma_f32 v80, v80, s28, v18
    v_mfma_f32_16x16x32_bf16 v[32:35], a[192:195], a[96:99], 0
    s_add_u32 m0, s38, 1024
    ds_read_b128 a[236:239], v2 offset:8192
    v_mfma_f32_16x16x32_bf16 v[32:35], a[196:199], a[100:103], v[32:35]
    buffer_load_dwordx4 v11, s[12:15], s58 offen nt lds
    v_mfma_f32_16x16x32_bf16 v[32:35], a[200:203], a[104:107], v[32:35]
    s_add_u32 s59, s25, 6016
    ds_read_b128 a[232:235], v1 offset:8192
    s_waitcnt lgkmcnt(5)
    v_mfma_f32_16x16x32_bf16 v[32:35], a[204:207], a[108:111], v[32:35]
    s_add_u32 m0, s38, 6144
    v_cvt_pk_bf16_f32 v121, v130, v131
    v_cvt_pk_bf16_f32 v119, v134, v135
    v_mfma_f32_16x16x32_bf16 v[32:35], a[208:211], a[112:115], v[32:35]
    buffer_load_dwordx4 v10, s[12:15], s59 offen nt lds
    v_mfma_f32_16x16x32_bf16 v[32:35], a[212:215], a[116:119], v[32:35]
    s_add_u32 m0, s38, 7168
    v_exp_f32 v129, v81
    v_mfma_f32_16x16x32_bf16 v[40:43], a[192:195], a[120:123], 0
    buffer_load_dwordx4 v11, s[12:15], s59 offen nt lds
    v_mfma_f32_16x16x32_bf16 v[40:43], a[196:199], a[124:127], v[40:43]
    s_add_u32 s58, s25, 12160
    v_exp_f32 v134, v86
    v_mfma_f32_16x16x32_bf16 v[40:43], a[200:203], a[128:131], v[40:43]
    s_add_u32 m0, s38, 12288
    v_exp_f32 v128, v80
    v_mfma_f32_16x16x32_bf16 v[40:43], a[204:207], a[132:135], v[40:43]
    buffer_load_dwordx4 v10, s[12:15], s58 offen nt lds
    v_mfma_f32_16x16x32_bf16 v[40:43], a[208:211], a[136:139], v[40:43]
    s_add_u32 m0, s38, 13312
    v_exp_f32 v133, v85
    v_mfma_f32_16x16x32_bf16 v[40:43], a[212:215], a[140:143], v[40:43]
    buffer_load_dwordx4 v11, s[12:15], s58 offen nt lds
    v_mfma_f32_16x16x32_bf16 v[48:51], a[192:195], a[144:147], 0
    s_add_u32 s59, s25, 18304
    v_cvt_pk_bf16_f32 v120, v128, v129
    s_add_u32 m0, s38, 18432
    v_mfma_f32_16x16x32_bf16 v[48:51], a[196:199], a[148:151], v[48:51]
    buffer_load_dwordx4 v10, s[12:15], s59 offen nt lds
    v_mfma_f32_16x16x32_bf16 v[24:27], a[244:247], v[116:119], v[24:27]
    v_exp_f32 v135, v87
    v_mfma_f32_16x16x32_bf16 v[48:51], a[200:203], a[152:155], v[48:51]
    s_add_u32 m0, s38, 19456
    v_exp_f32 v132, v84
    v_mfma_f32_16x16x32_bf16 v[48:51], a[204:207], a[156:159], v[48:51]
    buffer_load_dwordx4 v11, s[12:15], s59 offen nt lds
    v_mfma_f32_16x16x32_bf16 v[48:51], a[208:211], a[160:163], v[48:51]
    s_waitcnt vmcnt(17) lgkmcnt(0)
    v_cvt_pk_bf16_f32 v122, v132, v133
    v_cvt_pk_bf16_f32 v123, v134, v135
    v_mfma_f32_16x16x32_bf16 v[48:51], a[212:215], a[164:167], v[48:51]
    s_barrier
    v_mfma_f32_16x16x32_bf16 v[24:27], a[248:251], v[120:123], v[24:27]
    ds_read_b64_tr_b16 a[192:193], v3 offset:12288
    s_add_u32 m0, s22, 0
    v_mfma_f32_16x16x32_bf16 v[36:39], a[216:219], a[96:99], 0
    buffer_load_dwordx4 v9, s[4:7], s20 offen lds
    v_mfma_f32_16x16x32_bf16 v[36:39], a[220:223], a[100:103], v[36:39]
    s_add_u32 s20, s20, 128
    ds_read_b64_tr_b16 a[194:195], v3 offset:18432
    v_mfma_f32_16x16x32_bf16 v[36:39], a[224:227], a[104:107], v[36:39]
    ds_read_b64_tr_b16 a[196:197], v4 offset:12288
    v_cmp_lt_f32 vcc, s29, v24
    v_mfma_f32_16x16x32_bf16 v[36:39], a[228:231], a[108:111], v[36:39]
    s_add_u32 m0, s22, 1024
    ds_read_b64_tr_b16 a[198:199], v4 offset:18432
    buffer_load_dwordx4 v9, s[4:7], s20 offen lds
    v_mfma_f32_16x16x32_bf16 v[36:39], a[232:235], a[112:115], v[36:39]
    s_cbranch_vccnz L_rs_start3b
L_ret_start3b:
    ds_read_b64_tr_b16 a[200:201], v5 offset:12288
    v_mfma_f32_16x16x32_bf16 v[36:39], a[236:239], a[116:119], v[36:39]
    ds_read_b64_tr_b16 a[202:203], v5 offset:18432
    v_fma_f32 v40, v40, s28, v17
    v_mfma_f32_16x16x32_bf16 v[44:47], a[216:219], a[120:123], 0
    ds_read_b64_tr_b16 a[204:205], v6 offset:12288
    v_fma_f32 v32, v32, s28, v16
    v_mfma_f32_16x16x32_bf16 v[44:47], a[220:223], a[124:127], v[44:47]
    ds_read_b64_tr_b16 a[206:207], v6 offset:18432
    v_fma_f32 v33, v33, s28, v16
    v_mfma_f32_16x16x32_bf16 v[44:47], a[224:227], a[128:131], v[44:47]
    v_fma_f32 v34, v34, s28, v16
    v_exp_f32 v132, v40
    v_mfma_f32_16x16x32_bf16 v[44:47], a[228:231], a[132:135], v[44:47]
    v_exp_f32 v129, v33
    v_mfma_f32_16x16x32_bf16 v[44:47], a[232:235], a[136:139], v[44:47]
    s_add_u32 s20, s20, 128
    v_exp_f32 v130, v34
    v_mfma_f32_16x16x32_bf16 v[44:47], a[236:239], a[140:143], v[44:47]
    s_add_u32 m0, s22, 2048
    v_exp_f32 v128, v32
    v_mfma_f32_16x16x32_bf16 v[52:55], a[216:219], a[144:147], 0
    ds_read_b64_tr_b16 a[208:209], v3 offset:13312
    v_fma_f32 v35, v35, s28, v16
    v_mfma_f32_16x16x32_bf16 v[52:55], a[220:223], a[148:151], v[52:55]
    v_fma_f32 v41, v41, s28, v17
    v_exp_f32 v131, v35
    v_mfma_f32_16x16x32_bf16 v[52:55], a[224:227], a[152:155], v[52:55]
    v_exp_f32 v133, v41
    v_mfma_f32_16x16x32_bf16 v[52:55], a[228:231], a[156:159], v[52:55]
    ds_read_b64_tr_b16 a[210:211], v3 offset:19456
    buffer_load_dwordx4 v9, s[4:7], s20 offen lds
    v_mfma_f32_16x16x32_bf16 v[52:55], a[232:235], a[160:163], v[52:55]
    s_add_u32 s20, s20, 12032
    ds_read_b64_tr_b16 a[212:213], v4 offset:13312
    v_cvt_pk_bf16_f32 v100, v132, v133
    v_mfma_f32_16x16x32_bf16 v[52:55], a[236:239], a[164:167], v[52:55]
    ds_read_b64_tr_b16 a[214:215], v4 offset:19456
    v_cvt_pk_bf16_f32 v97, v130, v131
    v_cvt_pk_bf16_f32 v96, v128, v129
    s_branch L_loop3
L_loop4:
    s_bitcmp1_b32 s3, 1
    s_cbranch_scc1 L_loop4w1
    .p2align 6
L_loop4w0:
    s_waitcnt lgkmcnt(10)
    v_mfma_f32_16x16x32_bf16 v[160:163], a[192:195], v[112:115], v[160:163]
    v_fma_f32 v37, v37, s28, v16
    v_fma_f32 v38, v38, s28, v16
    v_mfma_f32_16x16x32_bf16 v[208:211], a[192:195], v[116:119], v[208:211]
    v_fma_f32 v45, v45, s28, v17
    v_fma_f32 v43, v43, s28, v17
    v_mfma_f32_16x16x32_bf16 a[0:3], a[192:195], v[120:123], a[0:3]
    v_exp_f32 v128, v38
    v_mfma_f32_16x16x32_bf16 a[48:51], a[192:195], v[124:127], a[48:51]
    ds_read_b64_tr_b16 a[234:235], v5 offset:20480
    s_waitcnt lgkmcnt(9)
    v_mfma_f32_16x16x32_bf16 v[164:167], a[196:199], v[112:115], v[164:167]
    v_fma_f32 v60, v60, s28, v19
    v_fma_f32 v39, v39, s28, v16
    v_fma_f32 v59, v59, s28, v19
    v_mfma_f32_16x16x32_bf16 v[212:215], a[196:199], v[116:119], v[212:215]
    ds_read_b64_tr_b16 a[218:219], v5 offset:19456
    ds_read_b64_tr_b16 a[228:229], v4 offset:14336
    v_mfma_f32_16x16x32_bf16 a[4:7], a[196:199], v[120:123], a[4:7]
    v_fma_f32 v36, v36, s28, v16
    v_fma_f32 v52, v52, s28, v18
    v_mfma_f32_16x16x32_bf16 a[52:55], a[196:199], v[124:127], a[52:55]
    s_waitcnt lgkmcnt(9)
    v_exp_f32 v131, v43
    v_mfma_f32_16x16x32_bf16 v[168:171], a[200:203], v[112:115], v[168:171]
    ds_read_b64_tr_b16 a[238:239], v6 offset:20480
    v_fma_f32 v50, v50, s28, v18
    v_mfma_f32_16x16x32_bf16 v[216:219], a[200:203], v[116:119], v[216:219]
    ds_read_b64_tr_b16 a[236:237], v6 offset:14336
    ds_read_b64_tr_b16 a[222:223], v6 offset:19456
    v_mfma_f32_16x16x32_bf16 a[8:11], a[200:203], v[120:123], a[8:11]
    v_exp_f32 v134, v36
    v_mfma_f32_16x16x32_bf16 a[56:59], a[200:203], v[124:127], a[56:59]
    s_waitcnt lgkmcnt(6)
    v_exp_f32 v135, v37
    v_mfma_f32_16x16x32_bf16 v[172:175], a[204:207], v[112:115], v[172:175]
    ds_read_b64_tr_b16 a[220:221], v6 offset:13312
    ds_read_b64_tr_b16 a[224:225], v3 offset:14336
    v_mfma_f32_16x16x32_bf16 v[220:223], a[204:207], v[116:119], v[220:223]
    ds_read_b64_tr_b16 a[216:217], v5 offset:13312
    ds_read_b64_tr_b16 a[232:233], v5 offset:14336
    v_mfma_f32_16x16x32_bf16 a[12:15], a[204:207], v[120:123], a[12:15]
    ds_read_b64_tr_b16 a[226:227], v3 offset:20480
    ds_read_b64_tr_b16 a[230:231], v4 offset:20480
    v_mfma_f32_16x16x32_bf16 a[60:63], a[204:207], v[124:127], a[60:63]
    v_fma_f32 v46, v46, s28, v17
    v_fma_f32 v61, v61, s28, v19
    v_mfma_f32_16x16x32_bf16 v[176:179], a[208:211], v[112:115], v[176:179]
    v_exp_f32 v129, v39
    v_mfma_f32_16x16x32_bf16 v[224:227], a[208:211], v[116:119], v[224:227]
    v_fma_f32 v47, v47, s28, v17
    v_fma_f32 v42, v42, s28, v17
    v_mfma_f32_16x16x32_bf16 a[16:19], a[208:211], v[120:123], a[16:19]
    v_cvt_pk_bf16_f32 v99, v128, v129
    v_fma_f32 v48, v48, s28, v18
    v_mfma_f32_16x16x32_bf16 a[64:67], a[208:211], v[124:127], a[64:67]
    v_cvt_pk_bf16_f32 v98, v134, v135
    v_fma_f32 v51, v51, s28, v18
    v_mfma_f32_16x16x32_bf16 v[180:183], a[212:215], v[112:115], v[180:183]
    v_exp_f32 v134, v46
    v_mfma_f32_16x16x32_bf16 v[228:231], a[212:215], v[116:119], v[228:231]
    v_exp_f32 v130, v42
    v_mfma_f32_16x16x32_bf16 a[20:23], a[212:215], v[120:123], a[20:23]
    v_cvt_pk_bf16_f32 v101, v130, v131
    v_fma_f32 v44, v44, s28, v17
    v_mfma_f32_16x16x32_bf16 a[68:71], a[212:215], v[124:127], a[68:71]
    s_waitcnt lgkmcnt(2)
    v_exp_f32 v133, v45
    v_mfma_f32_16x16x32_bf16 v[184:187], a[216:219], v[112:115], v[184:187]
    v_exp_f32 v135, v47
    v_mfma_f32_16x16x32_bf16 v[232:235], a[216:219], v[116:119], v[232:235]
    s_waitcnt vmcnt(10) lgkmcnt(0)
    v_exp_f32 v132, v44
    v_mfma_f32_16x16x32_bf16 v[20:23], a[240:243], v[96:99], v[24:27]
    s_add_u32 m0, s22, 36864
    v_cvt_pk_bf16_f32 v102, v132, v133
    v_cvt_pk_bf16_f32 v103, v134, v135
    v_mfma_f32_16x16x32_bf16 a[24:27], a[216:219], v[120:123], a[24:27]
    v_exp_f32 v131, v51
    v_mfma_f32_16x16x32_bf16 v[20:23], a[244:247], v[100:103], v[20:23]
    s_barrier
    v_mfma_f32_16x16x32_bf16 a[72:75], a[216:219], v[124:127], a[72:75]
    ds_read_b128 a[200:203], v1 offset:13312
    v_fma_f32 v54, v54, s28, v18
    v_mfma_f32_16x16x32_bf16 v[188:191], a[220:223], v[112:115], v[188:191]
    buffer_load_dwordx4 v9, s[8:11], s21 offen lds
    v_mfma_f32_16x16x32_bf16 v[236:239], a[220:223], v[116:119], v[236:239]
    s_add_u32 s21, s21, 128
    v_fma_f32 v55, v55, s28, v18
    s_add_u32 m0, s22, 37888
    v_mfma_f32_16x16x32_bf16 a[28:31], a[220:223], v[120:123], a[28:31]
    ds_read_b128 a[192:195], v1 offset:12288
    v_fma_f32 v53, v53, s28, v18
    v_mfma_f32_16x16x32_bf16 a[76:79], a[220:223], v[124:127], a[76:79]
    buffer_load_dwordx4 v9, s[8:11], s21 offen lds
    v_mfma_f32_16x16x32_bf16 v[192:195], a[224:227], v[112:115], v[192:195]
    v_exp_f32 v132, v52
    v_mfma_f32_16x16x32_bf16 v[240:243], a[224:227], v[116:119], v[240:243]
    v_fma_f32 v58, v58, s28, v19
    v_mfma_f32_16x16x32_bf16 a[32:35], a[224:227], v[120:123], a[32:35]
    v_exp_f32 v128, v48
    v_mfma_f32_16x16x32_bf16 a[80:83], a[224:227], v[124:127], a[80:83]
    ds_read_b128 a[196:199], v2 offset:12288
    s_add_u32 s21, s21, 128
    v_mfma_f32_16x16x32_bf16 v[196:199], a[228:231], v[112:115], v[196:199]
    ds_read_b128 a[212:215], v2 offset:14336
    v_mfma_f32_16x16x32_bf16 v[244:247], a[228:231], v[116:119], v[244:247]
    v_mfma_f32_16x16x32_bf16 a[36:39], a[228:231], v[120:123], a[36:39]
    v_exp_f32 v133, v53
    v_mfma_f32_16x16x32_bf16 a[84:87], a[228:231], v[124:127], a[84:87]
    s_add_u32 m0, s22, 38912
    ds_read_b128 a[208:211], v1 offset:14336
    v_mfma_f32_16x16x32_bf16 v[200:203], a[232:235], v[112:115], v[200:203]
    ds_read_b128 a[204:207], v2 offset:13312
    v_cvt_pk_bf16_f32 v106, v132, v133
    v_mfma_f32_16x16x32_bf16 v[248:251], a[232:235], v[116:119], v[248:251]
    v_exp_f32 v130, v50
    v_mfma_f32_16x16x32_bf16 a[40:43], a[232:235], v[120:123], a[40:43]
    ds_read_b128 a[216:219], v1 offset:18432
    v_fma_f32 v49, v49, s28, v18
    v_mfma_f32_16x16x32_bf16 a[88:91], a[232:235], v[124:127], a[88:91]
    buffer_load_dwordx4 v9, s[8:11], s21 offen lds
    v_mfma_f32_16x16x32_bf16 v[204:207], a[236:239], v[112:115], v[204:207]
    v_exp_f32 v135, v55
    v_mfma_f32_16x16x32_bf16 v[252:255], a[236:239], v[116:119], v[252:255]
    v_exp_f32 v134, v54
    v_mfma_f32_16x16x32_bf16 a[44:47], a[236:239], v[120:123], a[44:47]
    v_exp_f32 v129, v49
    v_mfma_f32_16x16x32_bf16 a[92:95], a[236:239], v[124:127], a[92:95]
    s_waitcnt lgkmcnt(3)
    ds_read_b128 a[232:235], v1 offset:20480
    v_cvt_pk_bf16_f32 v105, v130, v131
    v_mfma_f32_16x16x32_bf16 v[64:67], a[192:195], a[96:99], 0
    v_cvt_pk_bf16_f32 v107, v134, v135
    v_cvt_pk_bf16_f32 v104, v128, v129
    v_mfma_f32_16x16x32_bf16 v[64:67], a[196:199], a[100:103], v[64:67]
    ds_read_b128 a[220:223], v2 offset:18432
    v_mfma_f32_16x16x32_bf16 v[64:67], a[200:203], a[104:107], v[64:67]
    s_waitcnt lgkmcnt(3)
    ds_read_b128 a[224:227], v1 offset:19456
    v_mfma_f32_16x16x32_bf16 v[64:67], a[204:207], a[108:111], v[64:67]
    v_exp_f32 v130, v58
    v_mfma_f32_16x16x32_bf16 v[64:67], a[208:211], a[112:115], v[64:67]
    v_mfma_f32_16x16x32_bf16 v[20:23], a[248:251], v[104:107], v[20:23]
    v_mfma_f32_16x16x32_bf16 v[64:67], a[212:215], a[116:119], v[64:67]
    v_exp_f32 v132, v60
    v_mfma_f32_16x16x32_bf16 v[72:75], a[192:195], a[120:123], 0
    v_fma_f32 v56, v56, s28, v19
    v_fma_f32 v63, v63, s28, v19
    v_mfma_f32_16x16x32_bf16 v[72:75], a[196:199], a[124:127], v[72:75]
    v_exp_f32 v133, v61
    v_mfma_f32_16x16x32_bf16 v[72:75], a[200:203], a[128:131], v[72:75]
    v_fma_f32 v57, v57, s28, v19
    v_mfma_f32_16x16x32_bf16 v[72:75], a[204:207], a[132:135], v[72:75]
    ds_read_b128 a[236:239], v2 offset:20480
    v_fma_f32 v62, v62, s28, v19
    v_mfma_f32_16x16x32_bf16 v[72:75], a[208:211], a[136:139], v[72:75]
    s_add_u32 s21, s21, 12032
    ds_read_b128 a[228:231], v2 offset:19456
    v_mfma_f32_16x16x32_bf16 v[72:75], a[212:215], a[140:143], v[72:75]
    v_exp_f32 v134, v62
    v_mfma_f32_16x16x32_bf16 v[80:83], a[192:195], a[144:147], 0
    v_exp_f32 v128, v56
    v_mfma_f32_16x16x32_bf16 v[80:83], a[196:199], a[148:151], v[80:83]
    v_exp_f32 v129, v57
    v_mfma_f32_16x16x32_bf16 v[80:83], a[200:203], a[152:155], v[80:83]
    v_exp_f32 v135, v63
    v_mfma_f32_16x16x32_bf16 v[80:83], a[204:207], a[156:159], v[80:83]
    v_exp_f32 v131, v59
    v_mfma_f32_16x16x32_bf16 v[80:83], a[208:211], a[160:163], v[80:83]
    v_cvt_pk_bf16_f32 v108, v128, v129
    v_cvt_pk_bf16_f32 v111, v134, v135
    v_mfma_f32_16x16x32_bf16 v[80:83], a[212:215], a[164:167], v[80:83]
    v_cvt_pk_bf16_f32 v110, v132, v133
    v_mfma_f32_16x16x32_bf16 v[88:91], a[192:195], a[168:171], 0
    v_cvt_pk_bf16_f32 v109, v130, v131
    v_mfma_f32_16x16x32_bf16 v[88:91], a[196:199], a[172:175], v[88:91]
    v_mfma_f32_16x16x32_bf16 v[88:91], a[200:203], a[176:179], v[88:91]
    s_waitcnt vmcnt(9) lgkmcnt(0)
    v_mfma_f32_16x16x32_bf16 v[20:23], a[252:255], v[108:111], v[20:23]
    v_mfma_f32_16x16x32_bf16 v[88:91], a[204:207], a[180:183], v[88:91]
    v_mfma_f32_16x16x32_bf16 v[88:91], a[208:211], a[184:187], v[88:91]
    s_barrier
    v_mfma_f32_16x16x32_bf16 v[88:91], a[212:215], a[188:191], v[88:91]
    s_add_u32 m0, s22, 12288
    ds_read_b64_tr_b16 a[192:193], v3 offset:0
    v_mfma_f32_16x16x32_bf16 v[68:71], a[216:219], a[96:99], 0
    buffer_load_dwordx4 v9, s[4:7], s20 offen lds
    v_mfma_f32_16x16x32_bf16 v[68:71], a[220:223], a[100:103], v[68:71]
    s_add_u32 s20, s20, 128
    v_cmp_lt_f32 vcc, s29, v20
    v_mfma_f32_16x16x32_bf16 v[68:71], a[224:227], a[104:107], v[68:71]
    s_add_u32 m0, s22, 13312
    ds_read_b64_tr_b16 a[194:195], v3 offset:6144
    ds_read_b64_tr_b16 a[196:197], v4 offset:0
    v_mfma_f32_16x16x32_bf16 v[68:71], a[228:231], a[108:111], v[68:71]
    s_cbranch_vccnz L_rs_loop4w0a
L_ret_loop4w0a:
    v_mfma_f32_16x16x32_bf16 v[68:71], a[232:235], a[112:115], v[68:71]
    v_fma_f32 v64, v64, s28, v16
    v_mfma_f32_16x16x32_bf16 v[68:71], a[236:239], a[116:119], v[68:71]
    ds_read_b64_tr_b16 a[198:199], v4 offset:6144
    v_fma_f32 v66, v66, s28, v16
    v_mfma_f32_16x16x32_bf16 v[76:79], a[216:219], a[120:123], 0
    ds_read_b64_tr_b16 a[200:201], v5 offset:0
    v_fma_f32 v72, v72, s28, v17
    v_mfma_f32_16x16x32_bf16 v[76:79], a[220:223], a[124:127], v[76:79]
    buffer_load_dwordx4 v9, s[4:7], s20 offen lds
    v_mfma_f32_16x16x32_bf16 v[76:79], a[224:227], a[128:131], v[76:79]
    ds_read_b64_tr_b16 a[202:203], v5 offset:6144
    v_mfma_f32_16x16x32_bf16 v[76:79], a[228:231], a[132:135], v[76:79]
    v_exp_f32 v132, v72
    v_mfma_f32_16x16x32_bf16 v[76:79], a[232:235], a[136:139], v[76:79]
    v_fma_f32 v65, v65, s28, v16
    s_add_u32 s20, s20, 128
    v_mfma_f32_16x16x32_bf16 v[76:79], a[236:239], a[140:143], v[76:79]
    v_exp_f32 v129, v65
    v_mfma_f32_16x16x32_bf16 v[84:87], a[216:219], a[144:147], 0
    ds_read_b64_tr_b16 a[204:205], v6 offset:0
    v_fma_f32 v73, v73, s28, v17
    v_mfma_f32_16x16x32_bf16 v[84:87], a[220:223], a[148:151], v[84:87]
    v_exp_f32 v128, v64
    v_mfma_f32_16x16x32_bf16 v[84:87], a[224:227], a[152:155], v[84:87]
    s_add_u32 m0, s22, 14336
    v_fma_f32 v67, v67, s28, v16
    v_cvt_pk_bf16_f32 v112, v128, v129
    v_mfma_f32_16x16x32_bf16 v[84:87], a[228:231], a[156:159], v[84:87]
    buffer_load_dwordx4 v9, s[4:7], s20 offen lds
    v_mfma_f32_16x16x32_bf16 v[84:87], a[232:235], a[160:163], v[84:87]
    s_add_u32 s20, s20, 12032
    ds_read_b64_tr_b16 a[206:207], v6 offset:6144
    ds_read_b64_tr_b16 a[208:209], v3 offset:1024
    v_mfma_f32_16x16x32_bf16 v[84:87], a[236:239], a[164:167], v[84:87]
    v_exp_f32 v131, v67
    v_mfma_f32_16x16x32_bf16 v[92:95], a[216:219], a[168:171], 0
    ds_read_b64_tr_b16 a[210:211], v3 offset:7168
    v_mfma_f32_16x16x32_bf16 v[92:95], a[220:223], a[172:175], v[92:95]
    v_exp_f32 v133, v73
    v_mfma_f32_16x16x32_bf16 v[92:95], a[224:227], a[176:179], v[92:95]
    v_exp_f32 v130, v66
    v_mfma_f32_16x16x32_bf16 v[92:95], a[228:231], a[180:183], v[92:95]
    v_cvt_pk_bf16_f32 v113, v130, v131
    v_cvt_pk_bf16_f32 v116, v132, v133
    v_mfma_f32_16x16x32_bf16 v[92:95], a[232:235], a[184:187], v[92:95]
    ds_read_b64_tr_b16 a[212:213], v4 offset:1024
    v_mfma_f32_16x16x32_bf16 v[92:95], a[236:239], a[188:191], v[92:95]
    ds_read_b64_tr_b16 a[214:215], v4 offset:7168
    v_fma_f32 v70, v70, s28, v16
    s_waitcnt lgkmcnt(10)
    v_mfma_f32_16x16x32_bf16 v[160:163], a[192:195], v[96:99], v[160:163]
    ds_read_b64_tr_b16 a[224:225], v3 offset:2048
    v_fma_f32 v69, v69, s28, v16
    v_mfma_f32_16x16x32_bf16 v[208:211], a[192:195], v[100:103], v[208:211]
    v_fma_f32 v78, v78, s28, v17
    v_fma_f32 v74, v74, s28, v17
    v_mfma_f32_16x16x32_bf16 a[0:3], a[192:195], v[104:107], a[0:3]
    v_exp_f32 v128, v70
    v_mfma_f32_16x16x32_bf16 a[48:51], a[192:195], v[108:111], a[48:51]
    ds_read_b64_tr_b16 a[226:227], v3 offset:8192
    s_waitcnt lgkmcnt(10)
    v_mfma_f32_16x16x32_bf16 v[164:167], a[196:199], v[96:99], v[164:167]
    ds_read_b64_tr_b16 a[234:235], v5 offset:8192
    ds_read_b64_tr_b16 a[232:233], v5 offset:2048
    v_mfma_f32_16x16x32_bf16 v[212:215], a[196:199], v[100:103], v[212:215]
    ds_read_b64_tr_b16 a[216:217], v5 offset:1024
    ds_read_b64_tr_b16 a[236:237], v6 offset:2048
    v_mfma_f32_16x16x32_bf16 a[4:7], a[196:199], v[104:107], a[4:7]
    ds_read_b64_tr_b16 a[230:231], v4 offset:8192
    v_fma_f32 v83, v83, s28, v18
    v_mfma_f32_16x16x32_bf16 a[52:55], a[196:199], v[108:111], a[52:55]
    s_waitcnt lgkmcnt(13)
    ds_read_b64_tr_b16 a[218:219], v5 offset:7168
    v_fma_f32 v77, v77, s28, v17
    v_mfma_f32_16x16x32_bf16 v[168:171], a[200:203], v[96:99], v[168:171]
    v_exp_f32 v130, v74
    v_mfma_f32_16x16x32_bf16 v[216:219], a[200:203], v[100:103], v[216:219]
    v_fma_f32 v79, v79, s28, v17
    v_fma_f32 v71, v71, s28, v16
    v_mfma_f32_16x16x32_bf16 a[8:11], a[200:203], v[104:107], a[8:11]
    v_fma_f32 v93, v93, s28, v19
    v_fma_f32 v76, v76, s28, v17
    v_mfma_f32_16x16x32_bf16 a[56:59], a[200:203], v[108:111], a[56:59]
    s_waitcnt lgkmcnt(7)
    v_exp_f32 v135, v69
    v_mfma_f32_16x16x32_bf16 v[172:175], a[204:207], v[96:99], v[172:175]
    ds_read_b64_tr_b16 a[222:223], v6 offset:7168
    v_fma_f32 v75, v75, s28, v17
    v_mfma_f32_16x16x32_bf16 v[220:223], a[204:207], v[100:103], v[220:223]
    ds_read_b64_tr_b16 a[228:229], v4 offset:2048
    v_fma_f32 v82, v82, s28, v18
    v_mfma_f32_16x16x32_bf16 a[12:15], a[204:207], v[104:107], a[12:15]
    v_exp_f32 v129, v71
    v_mfma_f32_16x16x32_bf16 a[60:63], a[204:207], v[108:111], a[60:63]
    ds_read_b64_tr_b16 a[238:239], v6 offset:8192
    ds_read_b64_tr_b16 a[220:221], v6 offset:1024
    v_mfma_f32_16x16x32_bf16 v[176:179], a[208:211], v[96:99], v[176:179]
    v_fma_f32 v92, v92, s28, v19
    v_fma_f32 v68, v68, s28, v16
    v_mfma_f32_16x16x32_bf16 v[224:227], a[208:211], v[100:103], v[224:227]
    v_exp_f32 v132, v76
    v_mfma_f32_16x16x32_bf16 a[16:19], a[208:211], v[104:107], a[16:19]
    v_exp_f32 v131, v75
    v_mfma_f32_16x16x32_bf16 a[64:67], a[208:211], v[108:111], a[64:67]
    v_exp_f32 v134, v68
    v_mfma_f32_16x16x32_bf16 v[180:183], a[212:215], v[96:99], v[180:183]
    v_exp_f32 v133, v77
    v_mfma_f32_16x16x32_bf16 v[228:231], a[212:215], v[100:103], v[228:231]
    v_fma_f32 v87, v87, s28, v18
    v_cvt_pk_bf16_f32 v114, v134, v135
    v_mfma_f32_16x16x32_bf16 a[20:23], a[212:215], v[104:107], a[20:23]
    v_exp_f32 v135, v79
    v_mfma_f32_16x16x32_bf16 a[68:71], a[212:215], v[108:111], a[68:71]
    s_waitcnt lgkmcnt(2)
    v_cvt_pk_bf16_f32 v118, v132, v133
    v_cvt_pk_bf16_f32 v115, v128, v129
    v_mfma_f32_16x16x32_bf16 v[184:187], a[216:219], v[96:99], v[184:187]
    v_exp_f32 v134, v78
    v_mfma_f32_16x16x32_bf16 v[232:235], a[216:219], v[100:103], v[232:235]
    s_waitcnt vmcnt(6) lgkmcnt(0)
    v_cvt_pk_bf16_f32 v117, v130, v131
    v_cvt_pk_bf16_f32 v119, v134, v135
    v_mfma_f32_16x16x32_bf16 v[24:27], a[240:243], v[112:115], v[20:23]
    v_exp_f32 v131, v83
    v_mfma_f32_16x16x32_bf16 v[24:27], a[244:247], v[116:119], v[24:27]
    v_fma_f32 v85, v85, s28, v18
    v_fma_f32 v88, v88, s28, v19
    v_mfma_f32_16x16x32_bf16 a[24:27], a[216:219], v[104:107], a[24:27]
    s_barrier
    v_mfma_f32_16x16x32_bf16 a[72:75], a[216:219], v[108:111], a[72:75]
    ds_read_b128 a[192:195], v1 offset:0
    v_mfma_f32_16x16x32_bf16 v[188:191], a[220:223], v[96:99], v[188:191]
    ds_read_b128 a[212:215], v2 offset:2048
    v_fma_f32 v90, v90, s28, v19
    v_mfma_f32_16x16x32_bf16 v[236:239], a[220:223], v[100:103], v[236:239]
    ds_read_b128 a[208:211], v1 offset:2048
    v_fma_f32 v89, v89, s28, v19
    v_mfma_f32_16x16x32_bf16 a[28:31], a[220:223], v[104:107], a[28:31]
    s_add_u32 m0, s22, 24576
    ds_read_b128 a[200:203], v1 offset:1024
    v_fma_f32 v81, v81, s28, v18
    v_mfma_f32_16x16x32_bf16 a[76:79], a[220:223], v[108:111], a[76:79]
    buffer_load_dwordx4 v9, s[8:11], s21 offen lds
    v_mfma_f32_16x16x32_bf16 v[192:195], a[224:227], v[96:99], v[192:195]
    s_add_u32 s21, s21, 128
    v_exp_f32 v130, v82
    v_mfma_f32_16x16x32_bf16 v[240:243], a[224:227], v[100:103], v[240:243]
    ds_read_b128 v[136:139], v13 offset:0
    v_mfma_f32_16x16x32_bf16 a[32:35], a[224:227], v[104:107], a[32:35]
    s_add_u32 m0, s22, 25600
    ds_read_b128 v[140:143], v13 offset:1024
    v_fma_f32 v84, v84, s28, v18
    v_mfma_f32_16x16x32_bf16 a[80:83], a[224:227], v[108:111], a[80:83]
    v_fma_f32 v80, v80, s28, v18
    v_cvt_pk_bf16_f32 v121, v130, v131
    v_mfma_f32_16x16x32_bf16 v[196:199], a[228:231], v[96:99], v[196:199]
    v_exp_f32 v128, v80
    v_mfma_f32_16x16x32_bf16 v[244:247], a[228:231], v[100:103], v[244:247]
    ds_read_b128 a[196:199], v2 offset:0
    v_mfma_f32_16x16x32_bf16 a[36:39], a[228:231], v[104:107], a[36:39]
    buffer_load_dwordx4 v9, s[8:11], s21 offen lds
    v_mfma_f32_16x16x32_bf16 a[84:87], a[228:231], v[108:111], a[84:87]
    ds_read_b128 a[204:207], v2 offset:1024
    v_mfma_f32_16x16x32_bf16 v[200:203], a[232:235], v[96:99], v[200:203]
    s_add_u32 s21, s21, 128
    ds_read_b128 a[224:227], v1 offset:7168
    v_mfma_f32_16x16x32_bf16 v[248:251], a[232:235], v[100:103], v[248:251]
    s_add_u32 m0, s22, 26624
    v_fma_f32 v94, v94, s28, v19
    v_fma_f32 v86, v86, s28, v18
    v_mfma_f32_16x16x32_bf16 a[40:43], a[232:235], v[104:107], a[40:43]
    buffer_load_dwordx4 v9, s[8:11], s21 offen lds
    v_mfma_f32_16x16x32_bf16 a[88:91], a[232:235], v[108:111], a[88:91]
    v_exp_f32 v135, v87
    v_mfma_f32_16x16x32_bf16 v[204:207], a[236:239], v[96:99], v[204:207]
    v_exp_f32 v134, v86
    v_mfma_f32_16x16x32_bf16 v[252:255], a[236:239], v[100:103], v[252:255]
    v_exp_f32 v132, v84
    v_mfma_f32_16x16x32_bf16 a[44:47], a[236:239], v[104:107], a[44:47]
    v_fma_f32 v91, v91, s28, v19
    v_mfma_f32_16x16x32_bf16 a[92:95], a[236:239], v[108:111], a[92:95]
    s_waitcnt lgkmcnt(2)
    v_exp_f32 v133, v85
    v_mfma_f32_16x16x32_bf16 v[32:35], a[192:195], a[96:99], 0
    v_exp_f32 v129, v81
    v_mfma_f32_16x16x32_bf16 v[32:35], a[196:199], a[100:103], v[32:35]
    v_cvt_pk_bf16_f32 v123, v134, v135
    v_cvt_pk_bf16_f32 v122, v132, v133
    v_mfma_f32_16x16x32_bf16 v[32:35], a[200:203], a[104:107], v[32:35]
    s_waitcnt lgkmcnt(0)
    ds_read_b128 a[220:223], v2 offset:6144
    s_add_u32 s21, s21, 12032
    v_mfma_f32_16x16x32_bf16 v[32:35], a[204:207], a[108:111], v[32:35]
    ds_read_b128 a[216:219], v1 offset:6144
    v_mfma_f32_16x16x32_bf16 v[32:35], a[208:211], a[112:115], v[32:35]
    buffer_store_dwordx4 v[136:139], v12, s[16:19], s24 offen offset:0 nt
    ds_read_b128 a[228:231], v2 offset:7168
    v_exp_f32 v130, v90
    v_mfma_f32_16x16x32_bf16 v[32:35], a[212:215], a[116:119], v[32:35]
    s_add_u32 m0, s23, 0
    v_exp_f32 v134, v94
    v_mfma_f32_16x16x32_bf16 v[40:43], a[192:195], a[120:123], 0
    ds_read_b128 a[236:239], v2 offset:8192
    v_mfma_f32_16x16x32_bf16 v[40:43], a[196:199], a[124:127], v[40:43]
    v_cvt_pk_bf16_f32 v120, v128, v129
    v_mfma_f32_16x16x32_bf16 v[40:43], a[200:203], a[128:131], v[40:43]
    buffer_store_dwordx4 v[140:143], v12, s[16:19], s24 offen offset:3072 nt
    ds_read_b128 a[232:235], v1 offset:8192
    v_exp_f32 v132, v92
    v_mfma_f32_16x16x32_bf16 v[40:43], a[204:207], a[132:135], v[40:43]
    v_exp_f32 v133, v93
    v_mfma_f32_16x16x32_bf16 v[40:43], a[208:211], a[136:139], v[40:43]
    v_fma_f32 v95, v95, s28, v19
    v_cvt_pk_bf16_f32 v126, v132, v133
    v_mfma_f32_16x16x32_bf16 v[40:43], a[212:215], a[140:143], v[40:43]
    buffer_load_dwordx4 v10, s[12:15], s25 offen nt lds
    v_mfma_f32_16x16x32_bf16 v[48:51], a[192:195], a[144:147], 0
    v_exp_f32 v129, v89
    v_mfma_f32_16x16x32_bf16 v[24:27], a[248:251], v[120:123], v[24:27]
    v_exp_f32 v135, v95
    v_mfma_f32_16x16x32_bf16 v[48:51], a[196:199], a[148:151], v[48:51]
    v_exp_f32 v128, v88
    v_mfma_f32_16x16x32_bf16 v[48:51], a[200:203], a[152:155], v[48:51]
    v_exp_f32 v131, v91
    v_mfma_f32_16x16x32_bf16 v[48:51], a[204:207], a[156:159], v[48:51]
    v_cvt_pk_bf16_f32 v124, v128, v129
    v_cvt_pk_bf16_f32 v125, v130, v131
    v_mfma_f32_16x16x32_bf16 v[48:51], a[208:211], a[160:163], v[48:51]
    s_add_u32 m0, s23, 1024
    v_cvt_pk_bf16_f32 v127, v134, v135
    v_mfma_f32_16x16x32_bf16 v[48:51], a[212:215], a[164:167], v[48:51]
    buffer_load_dwordx4 v11, s[12:15], s25 offen nt lds
    v_mfma_f32_16x16x32_bf16 v[24:27], a[252:255], v[124:127], v[24:27]
    s_bitcmp1_b32 s30, 0
    s_cselect_b32 s26, s49, 128
    s_cselect_b32 s27, s39, 2048
    v_mfma_f32_16x16x32_bf16 v[56:59], a[192:195], a[168:171], 0
    s_add_u32 s24, s24, s26
    s_add_u32 s25, s25, s26
    s_add_u32 s23, s23, s27
    v_mfma_f32_16x16x32_bf16 v[56:59], a[196:199], a[172:175], v[56:59]
    v_cmp_lt_f32 vcc, s29, v24
    v_mfma_f32_16x16x32_bf16 v[56:59], a[200:203], a[176:179], v[56:59]
    s_waitcnt vmcnt(10) lgkmcnt(0)
    v_mfma_f32_16x16x32_bf16 v[56:59], a[204:207], a[180:183], v[56:59]
    s_add_u32 m0, s22, 0
    v_mfma_f32_16x16x32_bf16 v[56:59], a[208:211], a[184:187], v[56:59]
    s_barrier
    v_mfma_f32_16x16x32_bf16 v[56:59], a[212:215], a[188:191], v[56:59]
    s_cbranch_vccnz L_rs_loop4w0b
L_ret_loop4w0b:
    v_mfma_f32_16x16x32_bf16 v[36:39], a[216:219], a[96:99], 0
    v_fma_f32 v41, v41, s28, v17
    v_fma_f32 v32, v32, s28, v16
    v_mfma_f32_16x16x32_bf16 v[36:39], a[220:223], a[100:103], v[36:39]
    ds_read_b64_tr_b16 a[192:193], v3 offset:12288
    v_fma_f32 v40, v40, s28, v17
    v_mfma_f32_16x16x32_bf16 v[36:39], a[224:227], a[104:107], v[36:39]
    v_fma_f32 v34, v34, s28, v16
    v_fma_f32 v33, v33, s28, v16
    v_mfma_f32_16x16x32_bf16 v[36:39], a[228:231], a[108:111], v[36:39]
    ds_read_b64_tr_b16 a[194:195], v3 offset:18432
    v_fma_f32 v35, v35, s28, v16
    v_mfma_f32_16x16x32_bf16 v[36:39], a[232:235], a[112:115], v[36:39]
    v_add_u32 v13, s27, v13
    v_mfma_f32_16x16x32_bf16 v[36:39], a[236:239], a[116:119], v[36:39]
    v_exp_f32 v130, v34
    v_mfma_f32_16x16x32_bf16 v[44:47], a[216:219], a[120:123], 0
    buffer_load_dwordx4 v9, s[4:7], s20 offen lds
    v_mfma_f32_16x16x32_bf16 v[44:47], a[220:223], a[124:127], v[44:47]
    v_exp_f32 v131, v35
    v_mfma_f32_16x16x32_bf16 v[44:47], a[224:227], a[128:131], v[44:47]
    s_add_u32 s20, s20, 128
    s_add_u32 m0, s22, 1024
    ds_read_b64_tr_b16 a[196:197], v4 offset:12288
    v_mfma_f32_16x16x32_bf16 v[44:47], a[228:231], a[132:135], v[44:47]
    v_cvt_pk_bf16_f32 v97, v130, v131
    v_mfma_f32_16x16x32_bf16 v[44:47], a[232:235], a[136:139], v[44:47]
    v_exp_f32 v133, v41
    v_mfma_f32_16x16x32_bf16 v[44:47], a[236:239], a[140:143], v[44:47]
    buffer_load_dwordx4 v9, s[4:7], s20 offen lds
    v_mfma_f32_16x16x32_bf16 v[52:55], a[216:219], a[144:147], 0
    s_add_u32 s20, s20, 128
    v_exp_f32 v129, v33
    v_mfma_f32_16x16x32_bf16 v[52:55], a[220:223], a[148:151], v[52:55]
    v_exp_f32 v132, v40
    v_mfma_f32_16x16x32_bf16 v[52:55], a[224:227], a[152:155], v[52:55]
    s_add_u32 m0, s22, 2048
    ds_read_b64_tr_b16 a[198:199], v4 offset:18432
    v_mfma_f32_16x16x32_bf16 v[52:55], a[228:231], a[156:159], v[52:55]
    ds_read_b64_tr_b16 a[200:201], v5 offset:12288
    v_mfma_f32_16x16x32_bf16 v[52:55], a[232:235], a[160:163], v[52:55]
    buffer_load_dwordx4 v9, s[4:7], s20 offen lds
    v_mfma_f32_16x16x32_bf16 v[52:55], a[236:239], a[164:167], v[52:55]
    ds_read_b64_tr_b16 a[202:203], v5 offset:18432
    v_cvt_pk_bf16_f32 v100, v132, v133
    v_mfma_f32_16x16x32_bf16 v[60:63], a[216:219], a[168:171], 0
    s_add_u32 s20, s20, 12032
    ds_read_b64_tr_b16 a[204:205], v6 offset:12288
    ds_read_b64_tr_b16 a[206:207], v6 offset:18432
    v_mfma_f32_16x16x32_bf16 v[60:63], a[220:223], a[172:175], v[60:63]
    v_exp_f32 v128, v32
    v_mfma_f32_16x16x32_bf16 v[60:63], a[224:227], a[176:179], v[60:63]
    ds_read_b64_tr_b16 a[208:209], v3 offset:13312
    s_add_u32 s30, s30, 1
    v_mfma_f32_16x16x32_bf16 v[60:63], a[228:231], a[180:183], v[60:63]
    ds_read_b64_tr_b16 a[210:211], v3 offset:19456
    v_cvt_pk_bf16_f32 v96, v128, v129
    v_mfma_f32_16x16x32_bf16 v[60:63], a[232:235], a[184:187], v[60:63]
    ds_read_b64_tr_b16 a[212:213], v4 offset:13312
    ds_read_b64_tr_b16 a[214:215], v4 offset:19456
    v_mfma_f32_16x16x32_bf16 v[60:63], a[236:239], a[188:191], v[60:63]
    s_cmp_lt_u32 s30, 6
    s_cbranch_scc1 L_loop4w0
    s_cmp_ge_u32 s37, 8
    s_cbranch_scc1 L_end4
    s_cmp_eq_u32 s32, 0
    s_cbranch_scc1 L_tr43
    s_branch L_tr44
    .p2align 6
L_loop4w1:
    s_waitcnt lgkmcnt(10)
    v_mfma_f32_16x16x32_bf16 v[160:163], a[192:195], v[112:115], v[160:163]
    ds_read_b64_tr_b16 a[218:219], v5 offset:19456
    v_fma_f32 v44, v44, s28, v17
    v_mfma_f32_16x16x32_bf16 v[208:211], a[192:195], v[116:119], v[208:211]
    ds_read_b64_tr_b16 a[226:227], v3 offset:20480
    v_fma_f32 v37, v37, s28, v16
    v_fma_f32 v47, v47, s28, v17
    v_mfma_f32_16x16x32_bf16 a[0:3], a[192:195], v[120:123], a[0:3]
    v_fma_f32 v36, v36, s28, v16
    v_fma_f32 v38, v38, s28, v16
    v_mfma_f32_16x16x32_bf16 a[48:51], a[192:195], v[124:127], a[48:51]
    ds_read_b64_tr_b16 a[222:223], v6 offset:19456
    s_waitcnt lgkmcnt(11)
    v_mfma_f32_16x16x32_bf16 v[164:167], a[196:199], v[112:115], v[164:167]
    v_exp_f32 v134, v36
    v_mfma_f32_16x16x32_bf16 v[212:215], a[196:199], v[116:119], v[212:215]
    v_exp_f32 v135, v37
    v_mfma_f32_16x16x32_bf16 a[4:7], a[196:199], v[120:123], a[4:7]
    ds_read_b64_tr_b16 a[216:217], v5 offset:13312
    v_fma_f32 v39, v39, s28, v16
    v_mfma_f32_16x16x32_bf16 a[52:55], a[196:199], v[124:127], a[52:55]
    s_waitcnt lgkmcnt(10)
    ds_read_b64_tr_b16 a[220:221], v6 offset:13312
    v_fma_f32 v42, v42, s28, v17
    v_mfma_f32_16x16x32_bf16 v[168:171], a[200:203], v[112:115], v[168:171]
    ds_read_b64_tr_b16 a[232:233], v5 offset:14336
    ds_read_b64_tr_b16 a[234:235], v5 offset:20480
    v_mfma_f32_16x16x32_bf16 v[216:219], a[200:203], v[116:119], v[216:219]
    v_exp_f32 v128, v38
    v_mfma_f32_16x16x32_bf16 a[8:11], a[200:203], v[120:123], a[8:11]
    v_exp_f32 v132, v44
    v_mfma_f32_16x16x32_bf16 a[56:59], a[200:203], v[124:127], a[56:59]
    s_waitcnt lgkmcnt(5)
    ds_read_b64_tr_b16 a[238:239], v6 offset:20480
    v_cvt_pk_bf16_f32 v98, v134, v135
    v_mfma_f32_16x16x32_bf16 v[172:175], a[204:207], v[112:115], v[172:175]
    ds_read_b64_tr_b16 a[230:231], v4 offset:20480
    v_fma_f32 v43, v43, s28, v17
    v_mfma_f32_16x16x32_bf16 v[220:223], a[204:207], v[116:119], v[220:223]
    ds_read_b64_tr_b16 a[228:229], v4 offset:14336
    ds_read_b64_tr_b16 a[224:225], v3 offset:14336
    v_mfma_f32_16x16x32_bf16 a[12:15], a[204:207], v[120:123], a[12:15]
    ds_read_b64_tr_b16 a[236:237], v6 offset:14336
    v_fma_f32 v45, v45, s28, v17
    v_mfma_f32_16x16x32_bf16 a[60:63], a[204:207], v[124:127], a[60:63]
    v_exp_f32 v129, v39
    v_mfma_f32_16x16x32_bf16 v[176:179], a[208:211], v[112:115], v[176:179]
    v_exp_f32 v133, v45
    v_mfma_f32_16x16x32_bf16 v[224:227], a[208:211], v[116:119], v[224:227]
    v_fma_f32 v48, v48, s28, v18
    v_cvt_pk_bf16_f32 v102, v132, v133
    v_mfma_f32_16x16x32_bf16 a[16:19], a[208:211], v[120:123], a[16:19]
    v_fma_f32 v46, v46, s28, v17
    v_cvt_pk_bf16_f32 v99, v128, v129
    v_mfma_f32_16x16x32_bf16 a[64:67], a[208:211], v[124:127], a[64:67]
    v_exp_f32 v130, v42
    v_mfma_f32_16x16x32_bf16 v[20:23], a[240:243], v[96:99], v[24:27]
    v_exp_f32 v131, v43
    v_mfma_f32_16x16x32_bf16 v[180:183], a[212:215], v[112:115], v[180:183]
    v_exp_f32 v135, v47
    v_mfma_f32_16x16x32_bf16 v[228:231], a[212:215], v[116:119], v[228:231]
    v_exp_f32 v134, v46
    v_mfma_f32_16x16x32_bf16 a[20:23], a[212:215], v[120:123], a[20:23]
    v_fma_f32 v55, v55, s28, v18
    v_cvt_pk_bf16_f32 v101, v130, v131
    v_mfma_f32_16x16x32_bf16 a[68:71], a[212:215], v[124:127], a[68:71]
    s_waitcnt vmcnt(10) lgkmcnt(0)
    v_cvt_pk_bf16_f32 v103, v134, v135
    v_fma_f32 v54, v54, s28, v18
    v_mfma_f32_16x16x32_bf16 v[184:187], a[216:219], v[112:115], v[184:187]
    s_add_u32 m0, s22, 36864
    v_fma_f32 v62, v62, s28, v19
    v_fma_f32 v50, v50, s28, v18
    v_mfma_f32_16x16x32_bf16 v[20:23], a[244:247], v[100:103], v[20:23]
    s_barrier
    v_mfma_f32_16x16x32_bf16 v[232:235], a[216:219], v[116:119], v[232:235]
    v_fma_f32 v59, v59, s28, v19
    v_fma_f32 v56, v56, s28, v19
    v_mfma_f32_16x16x32_bf16 a[24:27], a[216:219], v[120:123], a[24:27]
    ds_read_b128 a[212:215], v2 offset:14336
    v_mfma_f32_16x16x32_bf16 a[72:75], a[216:219], v[124:127], a[72:75]
    buffer_load_dwordx4 v9, s[8:11], s21 offen lds
    v_mfma_f32_16x16x32_bf16 v[188:191], a[220:223], v[112:115], v[188:191]
    s_add_u32 s21, s21, 128
    v_exp_f32 v135, v55
    v_mfma_f32_16x16x32_bf16 v[236:239], a[220:223], v[116:119], v[236:239]
    ds_read_b128 a[196:199], v2 offset:12288
    v_fma_f32 v51, v51, s28, v18
    v_mfma_f32_16x16x32_bf16 a[28:31], a[220:223], v[120:123], a[28:31]
    v_fma_f32 v58, v58, s28, v19
    v_fma_f32 v53, v53, s28, v18
    v_mfma_f32_16x16x32_bf16 a[76:79], a[220:223], v[124:127], a[76:79]
    s_add_u32 m0, s22, 37888
    ds_read_b128 a[200:203], v1 offset:13312
    v_fma_f32 v52, v52, s28, v18
    v_mfma_f32_16x16x32_bf16 v[192:195], a[224:227], v[112:115], v[192:195]
    ds_read_b128 a[208:211], v1 offset:14336
    v_mfma_f32_16x16x32_bf16 v[240:243], a[224:227], v[116:119], v[240:243]
    buffer_load_dwordx4 v9, s[8:11], s21 offen lds
    v_mfma_f32_16x16x32_bf16 a[32:35], a[224:227], v[120:123], a[32:35]
    v_fma_f32 v49, v49, s28, v18
    v_mfma_f32_16x16x32_bf16 a[80:83], a[224:227], v[124:127], a[80:83]
    ds_read_b128 a[204:207], v2 offset:13312
    v_mfma_f32_16x16x32_bf16 v[196:199], a[228:231], v[112:115], v[196:199]
    ds_read_b128 a[192:195], v1 offset:12288
    v_fma_f32 v57, v57, s28, v19
    v_mfma_f32_16x16x32_bf16 v[244:247], a[228:231], v[116:119], v[244:247]
    v_exp_f32 v133, v53
    v_mfma_f32_16x16x32_bf16 a[36:39], a[228:231], v[120:123], a[36:39]
    v_mfma_f32_16x16x32_bf16 a[84:87], a[228:231], v[124:127], a[84:87]
    v_exp_f32 v130, v50
    v_mfma_f32_16x16x32_bf16 v[200:203], a[232:235], v[112:115], v[200:203]
    s_add_u32 s21, s21, 128
    v_exp_f32 v134, v54
    v_mfma_f32_16x16x32_bf16 v[248:251], a[232:235], v[116:119], v[248:251]
    v_cvt_pk_bf16_f32 v107, v134, v135
    v_fma_f32 v61, v61, s28, v19
    v_mfma_f32_16x16x32_bf16 a[40:43], a[232:235], v[120:123], a[40:43]
    s_add_u32 m0, s22, 38912
    v_fma_f32 v63, v63, s28, v19
    v_mfma_f32_16x16x32_bf16 a[88:91], a[232:235], v[124:127], a[88:91]
    buffer_load_dwordx4 v9, s[8:11], s21 offen lds
    v_mfma_f32_16x16x32_bf16 v[204:207], a[236:239], v[112:115], v[204:207]
    ds_read_b128 a[232:235], v1 offset:20480
    v_mfma_f32_16x16x32_bf16 v[252:255], a[236:239], v[116:119], v[252:255]
    v_exp_f32 v131, v51
    v_mfma_f32_16x16x32_bf16 a[44:47], a[236:239], v[120:123], a[44:47]
    v_exp_f32 v132, v52
    v_mfma_f32_16x16x32_bf16 a[92:95], a[236:239], v[124:127], a[92:95]
    s_waitcnt lgkmcnt(1)
    v_exp_f32 v134, v62
    v_mfma_f32_16x16x32_bf16 v[64:67], a[192:195], a[96:99], 0
    v_cvt_pk_bf16_f32 v106, v132, v133
    v_mfma_f32_16x16x32_bf16 v[64:67], a[196:199], a[100:103], v[64:67]
    v_exp_f32 v128, v48
    v_mfma_f32_16x16x32_bf16 v[64:67], a[200:203], a[104:107], v[64:67]
    ds_read_b128 a[220:223], v2 offset:18432
    v_mfma_f32_16x16x32_bf16 v[64:67], a[204:207], a[108:111], v[64:67]
    v_exp_f32 v129, v49
    v_mfma_f32_16x16x32_bf16 v[64:67], a[208:211], a[112:115], v[64:67]
    ds_read_b128 a[236:239], v2 offset:20480
    v_fma_f32 v60, v60, s28, v19
    v_mfma_f32_16x16x32_bf16 v[64:67], a[212:215], a[116:119], v[64:67]
    ds_read_b128 a[224:227], v1 offset:19456
    v_cvt_pk_bf16_f32 v105, v130, v131
    v_mfma_f32_16x16x32_bf16 v[72:75], a[192:195], a[120:123], 0
    v_exp_f32 v130, v58
    v_mfma_f32_16x16x32_bf16 v[72:75], a[196:199], a[124:127], v[72:75]
    ds_read_b128 a[216:219], v1 offset:18432
    v_cvt_pk_bf16_f32 v104, v128, v129
    v_mfma_f32_16x16x32_bf16 v[72:75], a[200:203], a[128:131], v[72:75]
    v_exp_f32 v131, v59
    v_mfma_f32_16x16x32_bf16 v[72:75], a[204:207], a[132:135], v[72:75]
    v_mfma_f32_16x16x32_bf16 v[72:75], a[208:211], a[136:139], v[72:75]
    ds_read_b128 a[228:231], v2 offset:19456
    v_mfma_f32_16x16x32_bf16 v[72:75], a[212:215], a[140:143], v[72:75]
    v_exp_f32 v135, v63
    v_mfma_f32_16x16x32_bf16 v[80:83], a[192:195], a[144:147], 0
    v_exp_f32 v132, v60
    v_mfma_f32_16x16x32_bf16 v[80:83], a[196:199], a[148:151], v[80:83]
    v_cvt_pk_bf16_f32 v109, v130, v131
    v_mfma_f32_16x16x32_bf16 v[80:83], a[200:203], a[152:155], v[80:83]
    s_add_u32 s21, s21, 12032
    v_exp_f32 v129, v57
    v_mfma_f32_16x16x32_bf16 v[80:83], a[204:207], a[156:159], v[80:83]
    v_cvt_pk_bf16_f32 v111, v134, v135
    v_mfma_f32_16x16x32_bf16 v[80:83], a[208:211], a[160:163], v[80:83]
    v_exp_f32 v133, v61
    v_mfma_f32_16x16x32_bf16 v[80:83], a[212:215], a[164:167], v[80:83]
    v_cvt_pk_bf16_f32 v110, v132, v133
    v_mfma_f32_16x16x32_bf16 v[20:23], a[248:251], v[104:107], v[20:23]
    v_mfma_f32_16x16x32_bf16 v[88:91], a[192:195], a[168:171], 0
    v_exp_f32 v128, v56
    v_mfma_f32_16x16x32_bf16 v[88:91], a[196:199], a[172:175], v[88:91]
    v_cvt_pk_bf16_f32 v108, v128, v129
    v_mfma_f32_16x16x32_bf16 v[88:91], a[200:203], a[176:179], v[88:91]
    s_waitcnt vmcnt(9) lgkmcnt(0)
    v_mfma_f32_16x16x32_bf16 v[20:23], a[252:255], v[108:111], v[20:23]
    s_barrier
    v_mfma_f32_16x16x32_bf16 v[88:91], a[204:207], a[180:183], v[88:91]
    s_add_u32 m0, s22, 12288
    ds_read_b64_tr_b16 a[192:193], v3 offset:0
    v_mfma_f32_16x16x32_bf16 v[88:91], a[208:211], a[184:187], v[88:91]
    ds_read_b64_tr_b16 a[194:195], v3 offset:6144
    ds_read_b64_tr_b16 a[196:197], v4 offset:0
    v_mfma_f32_16x16x32_bf16 v[88:91], a[212:215], a[188:191], v[88:91]
    ds_read_b64_tr_b16 a[198:199], v4 offset:6144
    v_cmp_lt_f32 vcc, s29, v20
    v_mfma_f32_16x16x32_bf16 v[68:71], a[216:219], a[96:99], 0
    ds_read_b64_tr_b16 a[200:201], v5 offset:0
    v_mfma_f32_16x16x32_bf16 v[68:71], a[220:223], a[100:103], v[68:71]
    buffer_load_dwordx4 v9, s[4:7], s20 offen lds
    v_mfma_f32_16x16x32_bf16 v[68:71], a[224:227], a[104:107], v[68:71]
    s_cbranch_vccnz L_rs_loop4w1a
L_ret_loop4w1a:
    v_fma_f32 v65, v65, s28, v16
    v_mfma_f32_16x16x32_bf16 v[68:71], a[228:231], a[108:111], v[68:71]
    v_fma_f32 v66, v66, s28, v16
    s_add_u32 s20, s20, 128
    v_mfma_f32_16x16x32_bf16 v[68:71], a[232:235], a[112:115], v[68:71]
    s_add_u32 m0, s22, 13312
    v_fma_f32 v64, v64, s28, v16
    v_fma_f32 v73, v73, s28, v17
    v_mfma_f32_16x16x32_bf16 v[68:71], a[236:239], a[116:119], v[68:71]
    v_exp_f32 v129, v65
    v_mfma_f32_16x16x32_bf16 v[76:79], a[216:219], a[120:123], 0
    ds_read_b64_tr_b16 a[202:203], v5 offset:6144
    ds_read_b64_tr_b16 a[204:205], v6 offset:0
    v_mfma_f32_16x16x32_bf16 v[76:79], a[220:223], a[124:127], v[76:79]
    v_exp_f32 v133, v73
    v_mfma_f32_16x16x32_bf16 v[76:79], a[224:227], a[128:131], v[76:79]
    v_fma_f32 v67, v67, s28, v16
    v_fma_f32 v72, v72, s28, v17
    v_mfma_f32_16x16x32_bf16 v[76:79], a[228:231], a[132:135], v[76:79]
    v_exp_f32 v131, v67
    v_mfma_f32_16x16x32_bf16 v[76:79], a[232:235], a[136:139], v[76:79]
    v_exp_f32 v128, v64
    v_mfma_f32_16x16x32_bf16 v[76:79], a[236:239], a[140:143], v[76:79]
    buffer_load_dwordx4 v9, s[4:7], s20 offen lds
    v_mfma_f32_16x16x32_bf16 v[84:87], a[216:219], a[144:147], 0
    ds_read_b64_tr_b16 a[206:207], v6 offset:6144
    v_mfma_f32_16x16x32_bf16 v[84:87], a[220:223], a[148:151], v[84:87]
    s_add_u32 s20, s20, 128
    v_exp_f32 v132, v72
    v_mfma_f32_16x16x32_bf16 v[84:87], a[224:227], a[152:155], v[84:87]
    v_mfma_f32_16x16x32_bf16 v[84:87], a[228:231], a[156:159], v[84:87]
    ds_read_b64_tr_b16 a[208:209], v3 offset:1024
    v_mfma_f32_16x16x32_bf16 v[84:87], a[232:235], a[160:163], v[84:87]
    s_add_u32 m0, s22, 14336
    v_cvt_pk_bf16_f32 v116, v132, v133
    v_mfma_f32_16x16x32_bf16 v[84:87], a[236:239], a[164:167], v[84:87]
    v_exp_f32 v130, v66
    v_mfma_f32_16x16x32_bf16 v[92:95], a[216:219], a[168:171], 0
    buffer_load_dwordx4 v9, s[4:7], s20 offen lds
    v_mfma_f32_16x16x32_bf16 v[92:95], a[220:223], a[172:175], v[92:95]
    v_cvt_pk_bf16_f32 v112, v128, v129
    v_mfma_f32_16x16x32_bf16 v[92:95], a[224:227], a[176:179], v[92:95]
    ds_read_b64_tr_b16 a[210:211], v3 offset:7168
    v_cvt_pk_bf16_f32 v113, v130, v131
    v_mfma_f32_16x16x32_bf16 v[92:95], a[228:231], a[180:183], v[92:95]
    ds_read_b64_tr_b16 a[212:213], v4 offset:1024
    s_add_u32 s20, s20, 12032
    v_mfma_f32_16x16x32_bf16 v[92:95], a[232:235], a[184:187], v[92:95]
    v_mfma_f32_16x16x32_bf16 v[92:95], a[236:239], a[188:191], v[92:95]
    ds_read_b64_tr_b16 a[214:215], v4 offset:7168
    s_waitcnt lgkmcnt(10)
    v_mfma_f32_16x16x32_bf16 v[160:163], a[192:195], v[96:99], v[160:163]
    v_fma_f32 v76, v76, s28, v17
    v_fma_f32 v71, v71, s28, v16
    v_mfma_f32_16x16x32_bf16 v[208:211], a[192:195], v[100:103], v[208:211]
    ds_read_b128 v[136:139], v13 offset:0
    v_fma_f32 v80, v80, s28, v18
    v_fma_f32 v68, v68, s28, v16
    v_mfma_f32_16x16x32_bf16 a[0:3], a[192:195], v[104:107], a[0:3]
    ds_read_b64_tr_b16 a[220:221], v6 offset:1024
    v_fma_f32 v69, v69, s28, v16
    v_fma_f32 v77, v77, s28, v17
    v_mfma_f32_16x16x32_bf16 a[48:51], a[192:195], v[108:111], a[48:51]
    s_waitcnt lgkmcnt(10)
    v_exp_f32 v135, v69
    v_mfma_f32_16x16x32_bf16 v[164:167], a[196:199], v[96:99], v[164:167]
    v_exp_f32 v134, v68
    v_mfma_f32_16x16x32_bf16 v[212:215], a[196:199], v[100:103], v[212:215]
    ds_read_b64_tr_b16 a[226:227], v3 offset:8192
    v_cvt_pk_bf16_f32 v114, v134, v135
    v_mfma_f32_16x16x32_bf16 a[4:7], a[196:199], v[104:107], a[4:7]
    ds_read_b64_tr_b16 a[218:219], v5 offset:7168
    ds_read_b64_tr_b16 a[224:225], v3 offset:2048
    v_mfma_f32_16x16x32_bf16 a[52:55], a[196:199], v[108:111], a[52:55]
    s_waitcnt lgkmcnt(10)
    v_fma_f32 v79, v79, s28, v17
    v_fma_f32 v75, v75, s28, v17
    v_mfma_f32_16x16x32_bf16 v[168:171], a[200:203], v[96:99], v[168:171]
    ds_read_b64_tr_b16 a[232:233], v5 offset:2048
    v_fma_f32 v70, v70, s28, v16
    v_mfma_f32_16x16x32_bf16 v[216:219], a[200:203], v[100:103], v[216:219]
    ds_read_b64_tr_b16 a[216:217], v5 offset:1024
    v_fma_f32 v86, v86, s28, v18
    v_mfma_f32_16x16x32_bf16 a[8:11], a[200:203], v[104:107], a[8:11]
    v_exp_f32 v133, v77
    v_mfma_f32_16x16x32_bf16 a[56:59], a[200:203], v[108:111], a[56:59]
    s_waitcnt lgkmcnt(6)
    ds_read_b64_tr_b16 a[222:223], v6 offset:7168
    ds_read_b64_tr_b16 a[230:231], v4 offset:8192
    v_mfma_f32_16x16x32_bf16 v[172:175], a[204:207], v[96:99], v[172:175]
    v_fma_f32 v89, v89, s28, v19
    v_fma_f32 v78, v78, s28, v17
    v_mfma_f32_16x16x32_bf16 v[220:223], a[204:207], v[100:103], v[220:223]
    v_exp_f32 v132, v76
    v_mfma_f32_16x16x32_bf16 a[12:15], a[204:207], v[104:107], a[12:15]
    v_exp_f32 v131, v75
    v_mfma_f32_16x16x32_bf16 a[60:63], a[204:207], v[108:111], a[60:63]
    ds_read_b64_tr_b16 a[236:237], v6 offset:2048
    ds_read_b64_tr_b16 a[238:239], v6 offset:8192
    v_mfma_f32_16x16x32_bf16 v[176:179], a[208:211], v[96:99], v[176:179]
    ds_read_b64_tr_b16 a[228:229], v4 offset:2048
    ds_read_b64_tr_b16 a[234:235], v5 offset:8192
    v_mfma_f32_16x16x32_bf16 v[224:227], a[208:211], v[100:103], v[224:227]
    ds_read_b128 v[140:143], v13 offset:1024
    v_fma_f32 v74, v74, s28, v17
    v_mfma_f32_16x16x32_bf16 a[16:19], a[208:211], v[104:107], a[16:19]
    v_exp_f32 v128, v70
    v_mfma_f32_16x16x32_bf16 a[64:67], a[208:211], v[108:111], a[64:67]
    v_exp_f32 v129, v71
    v_mfma_f32_16x16x32_bf16 v[180:183], a[212:215], v[96:99], v[180:183]
    v_cvt_pk_bf16_f32 v118, v132, v133
    v_cvt_pk_bf16_f32 v115, v128, v129
    v_mfma_f32_16x16x32_bf16 v[228:231], a[212:215], v[100:103], v[228:231]
    v_exp_f32 v130, v74
    v_mfma_f32_16x16x32_bf16 a[20:23], a[212:215], v[104:107], a[20:23]
    v_exp_f32 v135, v79
    v_mfma_f32_16x16x32_bf16 a[68:71], a[212:215], v[108:111], a[68:71]
    s_waitcnt lgkmcnt(5)
    v_exp_f32 v134, v78
    v_mfma_f32_16x16x32_bf16 v[184:187], a[216:219], v[96:99], v[184:187]
    v_cvt_pk_bf16_f32 v119, v134, v135
    v_cvt_pk_bf16_f32 v117, v130, v131
    v_mfma_f32_16x16x32_bf16 v[24:27], a[240:243], v[112:115], v[20:23]
    v_fma_f32 v81, v81, s28, v18
    v_mfma_f32_16x16x32_bf16 v[24:27], a[244:247], v[116:119], v[24:27]
    buffer_store_dwordx4 v[136:139], v12, s[16:19], s24 offen offset:0 nt
    s_waitcnt vmcnt(7) lgkmcnt(0)
    s_barrier
    ds_read_b128 a[192:195], v1 offset:0
    v_mfma_f32_16x16x32_bf16 v[232:235], a[216:219], v[100:103], v[232:235]
    s_add_u32 m0, s22, 24576
    v_exp_f32 v129, v81
    v_mfma_f32_16x16x32_bf16 a[24:27], a[216:219], v[104:107], a[24:27]
    buffer_load_dwordx4 v9, s[8:11], s21 offen lds
    v_mfma_f32_16x16x32_bf16 a[72:75], a[216:219], v[108:111], a[72:75]
    v_fma_f32 v84, v84, s28, v18
    v_fma_f32 v85, v85, s28, v18
    v_mfma_f32_16x16x32_bf16 v[188:191], a[220:223], v[96:99], v[188:191]
    v_exp_f32 v133, v85
    v_mfma_f32_16x16x32_bf16 v[236:239], a[220:223], v[100:103], v[236:239]
    s_add_u32 s21, s21, 128
    ds_read_b128 a[208:211], v1 offset:2048
    v_fma_f32 v88, v88, s28, v19
    v_mfma_f32_16x16x32_bf16 a[28:31], a[220:223], v[104:107], a[28:31]
    ds_read_b128 a[196:199], v2 offset:0
    v_fma_f32 v95, v95, s28, v19
    v_mfma_f32_16x16x32_bf16 a[76:79], a[220:223], v[108:111], a[76:79]
    v_fma_f32 v83, v83, s28, v18
    v_fma_f32 v93, v93, s28, v19
    v_mfma_f32_16x16x32_bf16 v[192:195], a[224:227], v[96:99], v[192:195]
    v_exp_f32 v132, v84
    v_mfma_f32_16x16x32_bf16 v[240:243], a[224:227], v[100:103], v[240:243]
    ds_read_b128 a[216:219], v1 offset:6144
    v_cvt_pk_bf16_f32 v122, v132, v133
    v_mfma_f32_16x16x32_bf16 a[32:35], a[224:227], v[104:107], a[32:35]
    s_add_u32 m0, s22, 25600
    ds_read_b128 a[200:203], v1 offset:1024
    v_fma_f32 v91, v91, s28, v19
    v_mfma_f32_16x16x32_bf16 a[80:83], a[224:227], v[108:111], a[80:83]
    buffer_load_dwordx4 v9, s[8:11], s21 offen lds
    v_mfma_f32_16x16x32_bf16 v[196:199], a[228:231], v[96:99], v[196:199]
    v_exp_f32 v134, v86
    v_mfma_f32_16x16x32_bf16 v[244:247], a[228:231], v[100:103], v[244:247]
    s_add_u32 s21, s21, 128
    v_exp_f32 v131, v83
    v_mfma_f32_16x16x32_bf16 a[36:39], a[228:231], v[104:107], a[36:39]
    v_fma_f32 v82, v82, s28, v18
    v_fma_f32 v92, v92, s28, v19
    v_mfma_f32_16x16x32_bf16 a[84:87], a[228:231], v[108:111], a[84:87]
    s_add_u32 m0, s22, 26624
    ds_read_b128 a[212:215], v2 offset:2048
    v_mfma_f32_16x16x32_bf16 v[200:203], a[232:235], v[96:99], v[200:203]
    ds_read_b128 a[204:207], v2 offset:1024
    v_fma_f32 v87, v87, s28, v18
    v_mfma_f32_16x16x32_bf16 v[248:251], a[232:235], v[100:103], v[248:251]
    buffer_load_dwordx4 v9, s[8:11], s21 offen lds
    v_mfma_f32_16x16x32_bf16 a[40:43], a[232:235], v[104:107], a[40:43]
    v_exp_f32 v130, v82
    v_mfma_f32_16x16x32_bf16 a[88:91], a[232:235], v[108:111], a[88:91]
    s_add_u32 s21, s21, 12032
    ds_read_b128 a[224:227], v1 offset:7168
    v_fma_f32 v90, v90, s28, v19
    v_mfma_f32_16x16x32_bf16 v[204:207], a[236:239], v[96:99], v[204:207]
    s_add_u32 m0, s23, 0
    ds_read_b128 a[220:223], v2 offset:6144
    v_mfma_f32_16x16x32_bf16 v[252:255], a[236:239], v[100:103], v[252:255]
    ds_read_b128 a[232:235], v1 offset:8192
    v_mfma_f32_16x16x32_bf16 a[44:47], a[236:239], v[104:107], a[44:47]
    v_exp_f32 v135, v87
    v_mfma_f32_16x16x32_bf16 a[92:95], a[236:239], v[108:111], a[92:95]
    buffer_store_dwordx4 v[140:143], v12, s[16:19], s24 offen offset:3072 nt
    v_cvt_pk_bf16_f32 v121, v130, v131
    s_waitcnt lgkmcnt(5)
    v_mfma_f32_16x16x32_bf16 v[32:35], a[192:195], a[96:99], 0
    v_exp_f32 v128, v80
    v_mfma_f32_16x16x32_bf16 v[32:35], a[196:199], a[100:103], v[32:35]
    buffer_load_dwordx4 v10, s[12:15], s25 offen nt lds
    v_mfma_f32_16x16x32_bf16 v[32:35], a[200:203], a[104:107], v[32:35]
    s_waitcnt lgkmcnt(3)
    v_cvt_pk_bf16_f32 v123, v134, v135
    v_cvt_pk_bf16_f32 v120, v128, v129
    v_mfma_f32_16x16x32_bf16 v[32:35], a[204:207], a[108:111], v[32:35]
    v_exp_f32 v132, v92
    v_mfma_f32_16x16x32_bf16 v[32:35], a[208:211], a[112:115], v[32:35]
    v_exp_f32 v128, v88
    v_mfma_f32_16x16x32_bf16 v[32:35], a[212:215], a[116:119], v[32:35]
    v_exp_f32 v133, v93
    v_mfma_f32_16x16x32_bf16 v[24:27], a[248:251], v[120:123], v[24:27]
    s_add_u32 m0, s23, 1024
    v_mfma_f32_16x16x32_bf16 v[40:43], a[192:195], a[120:123], 0
    v_exp_f32 v130, v90
    v_mfma_f32_16x16x32_bf16 v[40:43], a[196:199], a[124:127], v[40:43]
    v_exp_f32 v135, v95
    v_mfma_f32_16x16x32_bf16 v[40:43], a[200:203], a[128:131], v[40:43]
    ds_read_b128 a[236:239], v2 offset:8192
    v_fma_f32 v94, v94, s28, v19
    v_mfma_f32_16x16x32_bf16 v[40:43], a[204:207], a[132:135], v[40:43]
    ds_read_b128 a[228:231], v2 offset:7168
    v_mfma_f32_16x16x32_bf16 v[40:43], a[208:211], a[136:139], v[40:43]
    buffer_load_dwordx4 v11, s[12:15], s25 offen nt lds
    v_mfma_f32_16x16x32_bf16 v[40:43], a[212:215], a[140:143], v[40:43]
    v_exp_f32 v131, v91
    v_mfma_f32_16x16x32_bf16 v[48:51], a[192:195], a[144:147], 0
    s_bitcmp1_b32 s30, 0
    v_exp_f32 v129, v89
    v_mfma_f32_16x16x32_bf16 v[48:51], a[196:199], a[148:151], v[48:51]
    v_cvt_pk_bf16_f32 v126, v132, v133
    v_mfma_f32_16x16x32_bf16 v[48:51], a[200:203], a[152:155], v[48:51]
    v_exp_f32 v134, v94
    v_mfma_f32_16x16x32_bf16 v[48:51], a[204:207], a[156:159], v[48:51]
    v_mfma_f32_16x16x32_bf16 v[48:51], a[208:211], a[160:163], v[48:51]
    v_cvt_pk_bf16_f32 v124, v128, v129
    v_mfma_f32_16x16x32_bf16 v[48:51], a[212:215], a[164:167], v[48:51]
    v_cvt_pk_bf16_f32 v125, v130, v131
    v_cvt_pk_bf16_f32 v127, v134, v135
    v_mfma_f32_16x16x32_bf16 v[56:59], a[192:195], a[168:171], 0
    s_cselect_b32 s26, s49, 128
    s_cselect_b32 s27, s39, 2048
    v_mfma_f32_16x16x32_bf16 v[24:27], a[252:255], v[124:127], v[24:27]
    s_add_u32 s24, s24, s26
    s_add_u32 s25, s25, s26
    v_mfma_f32_16x16x32_bf16 v[56:59], a[196:199], a[172:175], v[56:59]
    s_add_u32 s23, s23, s27
    s_waitcnt vmcnt(10) lgkmcnt(0)
    s_add_u32 m0, s22, 0
    v_mfma_f32_16x16x32_bf16 v[56:59], a[200:203], a[176:179], v[56:59]
    s_barrier
    v_mfma_f32_16x16x32_bf16 v[56:59], a[204:207], a[180:183], v[56:59]
    v_cmp_lt_f32 vcc, s29, v24
    v_mfma_f32_16x16x32_bf16 v[56:59], a[208:211], a[184:187], v[56:59]
    buffer_load_dwordx4 v9, s[4:7], s20 offen lds
    v_mfma_f32_16x16x32_bf16 v[56:59], a[212:215], a[188:191], v[56:59]
    s_add_u32 s20, s20, 128
    ds_read_b64_tr_b16 a[192:193], v3 offset:12288
    v_mfma_f32_16x16x32_bf16 v[36:39], a[216:219], a[96:99], 0
    s_cbranch_vccnz L_rs_loop4w1b
L_ret_loop4w1b:
    v_mfma_f32_16x16x32_bf16 v[36:39], a[220:223], a[100:103], v[36:39]
    v_fma_f32 v40, v40, s28, v17
    v_fma_f32 v35, v35, s28, v16
    v_mfma_f32_16x16x32_bf16 v[36:39], a[224:227], a[104:107], v[36:39]
    ds_read_b64_tr_b16 a[194:195], v3 offset:18432
    v_fma_f32 v41, v41, s28, v17
    v_mfma_f32_16x16x32_bf16 v[36:39], a[228:231], a[108:111], v[36:39]
    ds_read_b64_tr_b16 a[196:197], v4 offset:12288
    v_mfma_f32_16x16x32_bf16 v[36:39], a[232:235], a[112:115], v[36:39]
    v_mfma_f32_16x16x32_bf16 v[36:39], a[236:239], a[116:119], v[36:39]
    s_add_u32 m0, s22, 1024
    v_exp_f32 v131, v35
    v_mfma_f32_16x16x32_bf16 v[44:47], a[216:219], a[120:123], 0
    ds_read_b64_tr_b16 a[198:199], v4 offset:18432
    v_fma_f32 v32, v32, s28, v16
    v_mfma_f32_16x16x32_bf16 v[44:47], a[220:223], a[124:127], v[44:47]
    buffer_load_dwordx4 v9, s[4:7], s20 offen lds
    v_mfma_f32_16x16x32_bf16 v[44:47], a[224:227], a[128:131], v[44:47]
    v_fma_f32 v34, v34, s28, v16
    v_fma_f32 v33, v33, s28, v16
    v_mfma_f32_16x16x32_bf16 v[44:47], a[228:231], a[132:135], v[44:47]
    ds_read_b64_tr_b16 a[200:201], v5 offset:12288
    v_mfma_f32_16x16x32_bf16 v[44:47], a[232:235], a[136:139], v[44:47]
    s_add_u32 s20, s20, 128
    ds_read_b64_tr_b16 a[202:203], v5 offset:18432
    v_mfma_f32_16x16x32_bf16 v[44:47], a[236:239], a[140:143], v[44:47]
    ds_read_b64_tr_b16 a[204:205], v6 offset:12288
    ds_read_b64_tr_b16 a[206:207], v6 offset:18432
    v_mfma_f32_16x16x32_bf16 v[52:55], a[216:219], a[144:147], 0
    s_add_u32 m0, s22, 2048
    v_exp_f32 v132, v40
    v_mfma_f32_16x16x32_bf16 v[52:55], a[220:223], a[148:151], v[52:55]
    v_add_u32 v13, s27, v13
    v_mfma_f32_16x16x32_bf16 v[52:55], a[224:227], a[152:155], v[52:55]
    v_exp_f32 v129, v33
    v_mfma_f32_16x16x32_bf16 v[52:55], a[228:231], a[156:159], v[52:55]
    v_exp_f32 v133, v41
    v_mfma_f32_16x16x32_bf16 v[52:55], a[232:235], a[160:163], v[52:55]
    buffer_load_dwordx4 v9, s[4:7], s20 offen lds
    v_mfma_f32_16x16x32_bf16 v[52:55], a[236:239], a[164:167], v[52:55]
    s_add_u32 s20, s20, 12032
    ds_read_b64_tr_b16 a[208:209], v3 offset:13312
    s_add_u32 s30, s30, 1
    v_mfma_f32_16x16x32_bf16 v[60:63], a[216:219], a[168:171], 0
    v_exp_f32 v130, v34
    v_mfma_f32_16x16x32_bf16 v[60:63], a[220:223], a[172:175], v[60:63]
    ds_read_b64_tr_b16 a[210:211], v3 offset:19456
    v_cvt_pk_bf16_f32 v97, v130, v131
    v_mfma_f32_16x16x32_bf16 v[60:63], a[224:227], a[176:179], v[60:63]
    s_cmp_lt_u32 s30, 6
    v_exp_f32 v128, v32
    v_mfma_f32_16x16x32_bf16 v[60:63], a[228:231], a[180:183], v[60:63]
    ds_read_b64_tr_b16 a[212:213], v4 offset:13312
    v_mfma_f32_16x16x32_bf16 v[60:63], a[232:235], a[184:187], v[60:63]
    ds_read_b64_tr_b16 a[214:215], v4 offset:19456
    v_mfma_f32_16x16x32_bf16 v[60:63], a[236:239], a[188:191], v[60:63]
    v_cvt_pk_bf16_f32 v100, v132, v133
    v_cvt_pk_bf16_f32 v96, v128, v129
    s_cbranch_scc1 L_loop4w1
    s_cmp_ge_u32 s37, 8
    s_cbranch_scc1 L_end4
    s_cmp_eq_u32 s32, 0
    s_cbranch_scc1 L_tr43
    s_branch L_tr44
L_tr43:
    s_waitcnt lgkmcnt(10)
    v_mfma_f32_16x16x32_bf16 v[160:163], a[192:195], v[112:115], v[160:163]
    ds_read_b64_tr_b16 a[220:221], v6 offset:13312
    v_fma_f32 v48, v48, s28, v18
    v_mfma_f32_16x16x32_bf16 v[208:211], a[192:195], v[116:119], v[208:211]
    ds_read_b64_tr_b16 a[228:229], v4 offset:14336
    v_fma_f32 v43, v43, s28, v17
    v_mfma_f32_16x16x32_bf16 a[0:3], a[192:195], v[120:123], a[0:3]
    ds_read_b64_tr_b16 a[216:217], v5 offset:13312
    v_fma_f32 v39, v39, s28, v16
    v_mfma_f32_16x16x32_bf16 a[48:51], a[192:195], v[124:127], a[48:51]
    ds_read_b64_tr_b16 a[218:219], v5 offset:19456
    s_waitcnt lgkmcnt(12)
    v_mfma_f32_16x16x32_bf16 v[164:167], a[196:199], v[112:115], v[164:167]
    ds_read_b64_tr_b16 a[238:239], v6 offset:20480
    v_fma_f32 v36, v36, s28, v16
    v_mfma_f32_16x16x32_bf16 v[212:215], a[196:199], v[116:119], v[212:215]
    v_fma_f32 v38, v38, s28, v16
    v_fma_f32 v37, v37, s28, v16
    v_mfma_f32_16x16x32_bf16 a[4:7], a[196:199], v[120:123], a[4:7]
    v_exp_f32 v129, v39
    v_mfma_f32_16x16x32_bf16 a[52:55], a[196:199], v[124:127], a[52:55]
    ds_read_b64_tr_b16 a[230:231], v4 offset:20480
    s_waitcnt lgkmcnt(11)
    v_mfma_f32_16x16x32_bf16 v[168:171], a[200:203], v[112:115], v[168:171]
    ds_read_b64_tr_b16 a[236:237], v6 offset:14336
    v_fma_f32 v46, v46, s28, v17
    v_mfma_f32_16x16x32_bf16 v[216:219], a[200:203], v[116:119], v[216:219]
    v_fma_f32 v57, v57, s28, v19
    v_mfma_f32_16x16x32_bf16 a[8:11], a[200:203], v[120:123], a[8:11]
    ds_read_b64_tr_b16 a[234:235], v5 offset:20480
    v_fma_f32 v45, v45, s28, v17
    v_mfma_f32_16x16x32_bf16 a[56:59], a[200:203], v[124:127], a[56:59]
    s_waitcnt lgkmcnt(6)
    v_exp_f32 v134, v36
    v_mfma_f32_16x16x32_bf16 v[172:175], a[204:207], v[112:115], v[172:175]
    v_exp_f32 v135, v37
    v_mfma_f32_16x16x32_bf16 v[220:223], a[204:207], v[116:119], v[220:223]
    ds_read_b64_tr_b16 a[224:225], v3 offset:14336
    v_fma_f32 v44, v44, s28, v17
    v_mfma_f32_16x16x32_bf16 a[12:15], a[204:207], v[120:123], a[12:15]
    ds_read_b64_tr_b16 a[226:227], v3 offset:20480
    v_fma_f32 v62, v62, s28, v19
    v_mfma_f32_16x16x32_bf16 a[60:63], a[204:207], v[124:127], a[60:63]
    ds_read_b64_tr_b16 a[222:223], v6 offset:19456
    v_fma_f32 v49, v49, s28, v18
    v_mfma_f32_16x16x32_bf16 v[176:179], a[208:211], v[112:115], v[176:179]
    v_exp_f32 v128, v38
    v_mfma_f32_16x16x32_bf16 v[224:227], a[208:211], v[116:119], v[224:227]
    ds_read_b64_tr_b16 a[232:233], v5 offset:14336
    v_fma_f32 v56, v56, s28, v19
    v_mfma_f32_16x16x32_bf16 a[16:19], a[208:211], v[120:123], a[16:19]
    v_cvt_pk_bf16_f32 v99, v128, v129
    v_cvt_pk_bf16_f32 v98, v134, v135
    v_mfma_f32_16x16x32_bf16 a[64:67], a[208:211], v[124:127], a[64:67]
    v_exp_f32 v128, v48
    v_mfma_f32_16x16x32_bf16 v[180:183], a[212:215], v[112:115], v[180:183]
    v_exp_f32 v129, v49
    v_mfma_f32_16x16x32_bf16 v[228:231], a[212:215], v[116:119], v[228:231]
    v_exp_f32 v133, v45
    v_mfma_f32_16x16x32_bf16 a[20:23], a[212:215], v[120:123], a[20:23]
    ds_read_b128 v[136:139], v13 offset:0
    v_cvt_pk_bf16_f32 v104, v128, v129
    v_mfma_f32_16x16x32_bf16 a[68:71], a[212:215], v[124:127], a[68:71]
    s_waitcnt lgkmcnt(4)
    v_exp_f32 v132, v44
    v_mfma_f32_16x16x32_bf16 v[184:187], a[216:219], v[112:115], v[184:187]
    v_fma_f32 v42, v42, s28, v17
    v_mfma_f32_16x16x32_bf16 v[232:235], a[216:219], v[116:119], v[232:235]
    v_exp_f32 v134, v46
    v_mfma_f32_16x16x32_bf16 a[24:27], a[216:219], v[120:123], a[24:27]
    v_fma_f32 v53, v53, s28, v18
    v_fma_f32 v59, v59, s28, v19
    v_mfma_f32_16x16x32_bf16 a[72:75], a[216:219], v[124:127], a[72:75]
    v_fma_f32 v52, v52, s28, v18
    s_waitcnt vmcnt(10) lgkmcnt(1)
    v_mfma_f32_16x16x32_bf16 v[20:23], a[240:243], v[96:99], v[24:27]
    s_barrier
    v_mfma_f32_16x16x32_bf16 v[188:191], a[220:223], v[112:115], v[188:191]
    s_add_u32 m0, s22, 36864
    v_fma_f32 v55, v55, s28, v18
    v_fma_f32 v51, v51, s28, v18
    v_mfma_f32_16x16x32_bf16 v[236:239], a[220:223], v[116:119], v[236:239]
    v_exp_f32 v131, v43
    v_mfma_f32_16x16x32_bf16 a[28:31], a[220:223], v[120:123], a[28:31]
    buffer_load_dwordx4 v9, s[8:11], s21 offen lds
    v_mfma_f32_16x16x32_bf16 a[76:79], a[220:223], v[124:127], a[76:79]
    v_exp_f32 v130, v42
    v_mfma_f32_16x16x32_bf16 v[192:195], a[224:227], v[112:115], v[192:195]
    v_exp_f32 v128, v56
    v_mfma_f32_16x16x32_bf16 v[240:243], a[224:227], v[116:119], v[240:243]
    s_add_u32 s21, s21, 128
    ds_read_b128 a[212:215], v2 offset:14336
    v_cvt_pk_bf16_f32 v102, v132, v133
    v_mfma_f32_16x16x32_bf16 a[32:35], a[224:227], v[120:123], a[32:35]
    ds_read_b128 a[196:199], v2 offset:12288
    v_fma_f32 v61, v61, s28, v19
    v_mfma_f32_16x16x32_bf16 a[80:83], a[224:227], v[124:127], a[80:83]
    s_add_u32 m0, s22, 37888
    ds_read_b128 a[192:195], v1 offset:12288
    v_fma_f32 v50, v50, s28, v18
    v_mfma_f32_16x16x32_bf16 v[196:199], a[228:231], v[112:115], v[196:199]
    buffer_load_dwordx4 v9, s[8:11], s21 offen lds
    v_mfma_f32_16x16x32_bf16 v[244:247], a[228:231], v[116:119], v[244:247]
    ds_read_b128 a[200:203], v1 offset:13312
    v_mfma_f32_16x16x32_bf16 a[36:39], a[228:231], v[120:123], a[36:39]
    v_fma_f32 v54, v54, s28, v18
    v_cvt_pk_bf16_f32 v101, v130, v131
    v_mfma_f32_16x16x32_bf16 a[84:87], a[228:231], v[124:127], a[84:87]
    ds_read_b128 a[208:211], v1 offset:14336
    s_add_u32 s21, s21, 128
    v_mfma_f32_16x16x32_bf16 v[200:203], a[232:235], v[112:115], v[200:203]
    ds_read_b128 a[204:207], v2 offset:13312
    v_mfma_f32_16x16x32_bf16 v[248:251], a[232:235], v[116:119], v[248:251]
    v_fma_f32 v47, v47, s28, v17
    v_mfma_f32_16x16x32_bf16 a[40:43], a[232:235], v[120:123], a[40:43]
    ds_read_b128 a[224:227], v1 offset:19456
    v_mfma_f32_16x16x32_bf16 a[88:91], a[232:235], v[124:127], a[88:91]
    ds_read_b128 a[232:235], v1 offset:20480
    v_mfma_f32_16x16x32_bf16 v[204:207], a[236:239], v[112:115], v[204:207]
    s_add_u32 m0, s22, 38912
    v_exp_f32 v132, v52
    v_mfma_f32_16x16x32_bf16 v[252:255], a[236:239], v[116:119], v[252:255]
    buffer_load_dwordx4 v9, s[8:11], s21 offen lds
    v_mfma_f32_16x16x32_bf16 a[44:47], a[236:239], v[120:123], a[44:47]
    v_exp_f32 v133, v53
    v_mfma_f32_16x16x32_bf16 a[92:95], a[236:239], v[124:127], a[92:95]
    s_waitcnt lgkmcnt(4)
    ds_read_b128 a[220:223], v2 offset:18432
    v_fma_f32 v63, v63, s28, v19
    v_mfma_f32_16x16x32_bf16 v[64:67], a[192:195], a[96:99], 0
    s_add_u32 s21, s21, 12032
    v_exp_f32 v131, v51
    v_mfma_f32_16x16x32_bf16 v[64:67], a[196:199], a[100:103], v[64:67]
    v_exp_f32 v135, v47
    v_mfma_f32_16x16x32_bf16 v[64:67], a[200:203], a[104:107], v[64:67]
    s_waitcnt lgkmcnt(3)
    ds_read_b128 v[140:143], v13 offset:1024
    v_mfma_f32_16x16x32_bf16 v[64:67], a[204:207], a[108:111], v[64:67]
    ds_read_b128 a[236:239], v2 offset:20480
    v_cvt_pk_bf16_f32 v103, v134, v135
    v_mfma_f32_16x16x32_bf16 v[64:67], a[208:211], a[112:115], v[64:67]
    ds_read_b128 a[216:219], v1 offset:18432
    v_cvt_pk_bf16_f32 v106, v132, v133
    v_mfma_f32_16x16x32_bf16 v[64:67], a[212:215], a[116:119], v[64:67]
    v_exp_f32 v130, v50
    v_mfma_f32_16x16x32_bf16 v[72:75], a[192:195], a[120:123], 0
    buffer_store_dwordx4 v[136:139], v12, s[16:19], s24 offen offset:0 nt
    ds_read_b128 a[228:231], v2 offset:19456
    v_exp_f32 v134, v54
    v_mfma_f32_16x16x32_bf16 v[72:75], a[196:199], a[124:127], v[72:75]
    v_fma_f32 v60, v60, s28, v19
    v_cvt_pk_bf16_f32 v105, v130, v131
    v_mfma_f32_16x16x32_bf16 v[72:75], a[200:203], a[128:131], v[72:75]
    v_exp_f32 v135, v55
    v_mfma_f32_16x16x32_bf16 v[72:75], a[204:207], a[132:135], v[72:75]
    ds_read_b128 v[136:139], v13 offset:2048
    v_cvt_pk_bf16_f32 v107, v134, v135
    v_mfma_f32_16x16x32_bf16 v[72:75], a[208:211], a[136:139], v[72:75]
    v_exp_f32 v131, v59
    v_mfma_f32_16x16x32_bf16 v[20:23], a[244:247], v[100:103], v[20:23]
    v_exp_f32 v133, v61
    v_mfma_f32_16x16x32_bf16 v[72:75], a[212:215], a[140:143], v[72:75]
    v_exp_f32 v129, v57
    v_mfma_f32_16x16x32_bf16 v[80:83], a[192:195], a[144:147], 0
    v_exp_f32 v134, v62
    v_mfma_f32_16x16x32_bf16 v[80:83], a[196:199], a[148:151], v[80:83]
    v_cvt_pk_bf16_f32 v108, v128, v129
    v_mfma_f32_16x16x32_bf16 v[80:83], a[200:203], a[152:155], v[80:83]
    v_fma_f32 v58, v58, s28, v19
    v_mfma_f32_16x16x32_bf16 v[80:83], a[204:207], a[156:159], v[80:83]
    v_mfma_f32_16x16x32_bf16 v[80:83], a[208:211], a[160:163], v[80:83]
    v_exp_f32 v130, v58
    v_mfma_f32_16x16x32_bf16 v[80:83], a[212:215], a[164:167], v[80:83]
    v_exp_f32 v132, v60
    v_mfma_f32_16x16x32_bf16 v[88:91], a[192:195], a[168:171], 0
    v_exp_f32 v135, v63
    v_mfma_f32_16x16x32_bf16 v[20:23], a[248:251], v[104:107], v[20:23]
    s_add_u32 s57, s24, 128
    v_cvt_pk_bf16_f32 v109, v130, v131
    v_mfma_f32_16x16x32_bf16 v[88:91], a[196:199], a[172:175], v[88:91]
    s_waitcnt vmcnt(7) lgkmcnt(0)
    v_mfma_f32_16x16x32_bf16 v[88:91], a[200:203], a[176:179], v[88:91]
    v_cvt_pk_bf16_f32 v110, v132, v133
    v_cvt_pk_bf16_f32 v111, v134, v135
    v_mfma_f32_16x16x32_bf16 v[88:91], a[204:207], a[180:183], v[88:91]
    v_mfma_f32_16x16x32_bf16 v[88:91], a[208:211], a[184:187], v[88:91]
    v_mfma_f32_16x16x32_bf16 v[20:23], a[252:255], v[108:111], v[20:23]
    buffer_store_dwordx4 v[140:143], v12, s[16:19], s24 offen offset:3072 nt
    s_barrier
    ds_read_b64_tr_b16 a[192:193], v3 offset:0
    v_mfma_f32_16x16x32_bf16 v[88:91], a[212:215], a[188:191], v[88:91]
    s_add_u32 m0, s22, 12288
    ds_read_b128 v[140:143], v13 offset:3072
    v_mfma_f32_16x16x32_bf16 v[68:71], a[216:219], a[96:99], 0
    buffer_load_dwordx4 v9, s[4:7], s20 offen lds
    v_mfma_f32_16x16x32_bf16 v[68:71], a[220:223], a[100:103], v[68:71]
    ds_read_b64_tr_b16 a[194:195], v3 offset:6144
    v_cmp_lt_f32 vcc, s29, v20
    v_mfma_f32_16x16x32_bf16 v[68:71], a[224:227], a[104:107], v[68:71]
    ds_read_b64_tr_b16 a[196:197], v4 offset:0
    s_add_u32 s20, s20, 128
    v_mfma_f32_16x16x32_bf16 v[68:71], a[228:231], a[108:111], v[68:71]
    buffer_store_dwordx4 v[136:139], v12, s[16:19], s57 offen offset:0 nt
    s_cbranch_vccnz L_rs_tr43a
L_ret_tr43a:
    ds_read_b64_tr_b16 a[198:199], v4 offset:6144
    v_fma_f32 v65, v65, s28, v16
    v_mfma_f32_16x16x32_bf16 v[68:71], a[232:235], a[112:115], v[68:71]
    v_fma_f32 v66, v66, s28, v16
    s_add_u32 m0, s22, 13312
    v_mfma_f32_16x16x32_bf16 v[68:71], a[236:239], a[116:119], v[68:71]
    v_exp_f32 v130, v66
    v_mfma_f32_16x16x32_bf16 v[76:79], a[216:219], a[120:123], 0
    buffer_load_dwordx4 v9, s[4:7], s20 offen lds
    v_mfma_f32_16x16x32_bf16 v[76:79], a[220:223], a[124:127], v[76:79]
    v_fma_f32 v67, v67, s28, v16
    v_fma_f32 v64, v64, s28, v16
    v_mfma_f32_16x16x32_bf16 v[76:79], a[224:227], a[128:131], v[76:79]
    ds_read_b64_tr_b16 a[200:201], v5 offset:0
    v_mfma_f32_16x16x32_bf16 v[76:79], a[228:231], a[132:135], v[76:79]
    ds_read_b64_tr_b16 a[202:203], v5 offset:6144
    v_mfma_f32_16x16x32_bf16 v[76:79], a[232:235], a[136:139], v[76:79]
    v_exp_f32 v131, v67
    v_mfma_f32_16x16x32_bf16 v[76:79], a[236:239], a[140:143], v[76:79]
    v_exp_f32 v129, v65
    v_mfma_f32_16x16x32_bf16 v[84:87], a[216:219], a[144:147], 0
    ds_read_b64_tr_b16 a[204:205], v6 offset:0
    v_fma_f32 v73, v73, s28, v17
    v_mfma_f32_16x16x32_bf16 v[84:87], a[220:223], a[148:151], v[84:87]
    s_add_u32 s20, s20, 128
    v_fma_f32 v72, v72, s28, v17
    v_mfma_f32_16x16x32_bf16 v[84:87], a[224:227], a[152:155], v[84:87]
    ds_read_b64_tr_b16 a[206:207], v6 offset:6144
    v_mfma_f32_16x16x32_bf16 v[84:87], a[228:231], a[156:159], v[84:87]
    s_waitcnt lgkmcnt(4)
    buffer_store_dwordx4 v[140:143], v12, s[16:19], s57 offen offset:3072 nt
    ds_read_b64_tr_b16 a[208:209], v3 offset:1024
    v_exp_f32 v133, v73
    v_mfma_f32_16x16x32_bf16 v[84:87], a[232:235], a[160:163], v[84:87]
    v_exp_f32 v128, v64
    v_mfma_f32_16x16x32_bf16 v[84:87], a[236:239], a[164:167], v[84:87]
    ds_read_b64_tr_b16 a[210:211], v3 offset:7168
    v_mfma_f32_16x16x32_bf16 v[92:95], a[216:219], a[168:171], 0
    s_add_u32 m0, s22, 14336
    v_exp_f32 v132, v72
    v_mfma_f32_16x16x32_bf16 v[92:95], a[220:223], a[172:175], v[92:95]
    buffer_load_dwordx4 v9, s[4:7], s20 offen lds
    v_mfma_f32_16x16x32_bf16 v[92:95], a[224:227], a[176:179], v[92:95]
    s_add_u32 s20, s20, 12032
    v_cvt_pk_bf16_f32 v112, v128, v129
    v_mfma_f32_16x16x32_bf16 v[92:95], a[228:231], a[180:183], v[92:95]
    ds_read_b64_tr_b16 a[212:213], v4 offset:1024
    v_mfma_f32_16x16x32_bf16 v[92:95], a[232:235], a[184:187], v[92:95]
    v_cvt_pk_bf16_f32 v116, v132, v133
    v_cvt_pk_bf16_f32 v113, v130, v131
    v_mfma_f32_16x16x32_bf16 v[92:95], a[236:239], a[188:191], v[92:95]
    ds_read_b64_tr_b16 a[214:215], v4 offset:7168
    s_waitcnt lgkmcnt(10)
    v_mfma_f32_16x16x32_bf16 v[160:163], a[192:195], v[96:99], v[160:163]
    ds_read_b64_tr_b16 a[232:233], v5 offset:2048
    v_fma_f32 v77, v77, s28, v17
    v_mfma_f32_16x16x32_bf16 v[208:211], a[192:195], v[100:103], v[208:211]
    ds_read_b64_tr_b16 a[236:237], v6 offset:2048
    v_xor_b32 v8, 64, v7
    v_mfma_f32_16x16x32_bf16 a[0:3], a[192:195], v[104:107], a[0:3]
    ds_read_b128 a[128:131], v7 offset:8192
    v_exp_f32 v133, v77
    v_mfma_f32_16x16x32_bf16 a[48:51], a[192:195], v[108:111], a[48:51]
    ds_read_b64_tr_b16 a[234:235], v5 offset:8192
    s_waitcnt lgkmcnt(12)
    v_mfma_f32_16x16x32_bf16 v[164:167], a[196:199], v[96:99], v[164:167]
    ds_read_b128 a[144:147], v7 offset:12288
    v_fma_f32 v68, v68, s28, v16
    v_mfma_f32_16x16x32_bf16 v[212:215], a[196:199], v[100:103], v[212:215]
    ds_read_b64_tr_b16 a[226:227], v3 offset:8192
    v_fma_f32 v89, v89, s28, v19
    v_mfma_f32_16x16x32_bf16 a[4:7], a[196:199], v[104:107], a[4:7]
    ds_read_b64_tr_b16 a[238:239], v6 offset:8192
    v_fma_f32 v75, v75, s28, v17
    v_mfma_f32_16x16x32_bf16 a[52:55], a[196:199], v[108:111], a[52:55]
    s_waitcnt lgkmcnt(13)
    ds_read_b64_tr_b16 a[228:229], v4 offset:2048
    v_fma_f32 v87, v87, s28, v18
    v_mfma_f32_16x16x32_bf16 v[168:171], a[200:203], v[96:99], v[168:171]
    ds_read_b128 a[132:135], v8 offset:8192
    v_fma_f32 v95, v95, s28, v19
    v_mfma_f32_16x16x32_bf16 v[216:219], a[200:203], v[100:103], v[216:219]
    ds_read_b64_tr_b16 a[216:217], v5 offset:1024
    v_fma_f32 v71, v71, s28, v16
    v_mfma_f32_16x16x32_bf16 a[8:11], a[200:203], v[104:107], a[8:11]
    ds_read_b64_tr_b16 a[218:219], v5 offset:7168
    v_fma_f32 v91, v91, s28, v19
    v_mfma_f32_16x16x32_bf16 a[56:59], a[200:203], v[108:111], a[56:59]
    s_waitcnt lgkmcnt(9)
    ds_read_b64_tr_b16 a[222:223], v6 offset:7168
    v_fma_f32 v70, v70, s28, v16
    v_mfma_f32_16x16x32_bf16 v[172:175], a[204:207], v[96:99], v[172:175]
    ds_read_b128 a[104:107], v7 offset:2048
    v_fma_f32 v85, v85, s28, v18
    v_mfma_f32_16x16x32_bf16 v[220:223], a[204:207], v[100:103], v[220:223]
    ds_read_b64_tr_b16 a[224:225], v3 offset:2048
    v_fma_f32 v76, v76, s28, v17
    v_mfma_f32_16x16x32_bf16 a[12:15], a[204:207], v[104:107], a[12:15]
    v_exp_f32 v134, v68
    v_mfma_f32_16x16x32_bf16 a[60:63], a[204:207], v[108:111], a[60:63]
    ds_read_b64_tr_b16 a[230:231], v4 offset:8192
    v_fma_f32 v81, v81, s28, v18
    v_mfma_f32_16x16x32_bf16 v[176:179], a[208:211], v[96:99], v[176:179]
    ds_read_b64_tr_b16 a[220:221], v6 offset:1024
    v_fma_f32 v69, v69, s28, v16
    v_mfma_f32_16x16x32_bf16 v[224:227], a[208:211], v[100:103], v[224:227]
    ds_read_b128 a[120:123], v7 offset:6144
    v_fma_f32 v80, v80, s28, v18
    v_mfma_f32_16x16x32_bf16 a[16:19], a[208:211], v[104:107], a[16:19]
    ds_read_b128 a[100:103], v8 offset:0
    v_fma_f32 v78, v78, s28, v17
    v_mfma_f32_16x16x32_bf16 a[64:67], a[208:211], v[108:111], a[64:67]
    ds_read_b128 a[96:99], v7 offset:0
    v_fma_f32 v74, v74, s28, v17
    v_mfma_f32_16x16x32_bf16 v[180:183], a[212:215], v[96:99], v[180:183]
    v_exp_f32 v135, v69
    v_mfma_f32_16x16x32_bf16 v[228:231], a[212:215], v[100:103], v[228:231]
    ds_read_b128 a[108:111], v8 offset:2048
    v_fma_f32 v86, v86, s28, v18
    v_mfma_f32_16x16x32_bf16 a[20:23], a[212:215], v[104:107], a[20:23]
    v_exp_f32 v129, v71
    v_mfma_f32_16x16x32_bf16 a[68:71], a[212:215], v[108:111], a[68:71]
    s_waitcnt lgkmcnt(6)
    v_cvt_pk_bf16_f32 v114, v134, v135
    v_fma_f32 v79, v79, s28, v17
    v_mfma_f32_16x16x32_bf16 v[184:187], a[216:219], v[96:99], v[184:187]
    v_exp_f32 v134, v78
    v_mfma_f32_16x16x32_bf16 v[232:235], a[216:219], v[100:103], v[232:235]
    v_exp_f32 v132, v76
    v_mfma_f32_16x16x32_bf16 a[24:27], a[216:219], v[104:107], a[24:27]
    ds_read_b128 a[140:143], v8 offset:10240
    v_fma_f32 v84, v84, s28, v18
    v_mfma_f32_16x16x32_bf16 a[72:75], a[216:219], v[108:111], a[72:75]
    s_waitcnt vmcnt(10) lgkmcnt(4)
    ds_read_b128 a[112:115], v7 offset:4096
    v_fma_f32 v94, v94, s28, v19
    v_mfma_f32_16x16x32_bf16 v[188:191], a[220:223], v[96:99], v[188:191]
    s_barrier
    v_mfma_f32_16x16x32_bf16 v[236:239], a[220:223], v[100:103], v[236:239]
    s_add_u32 m0, s22, 24576
    v_exp_f32 v130, v74
    v_mfma_f32_16x16x32_bf16 a[28:31], a[220:223], v[104:107], a[28:31]
    ds_read_b128 a[196:199], v2 offset:0
    v_cvt_pk_bf16_f32 v118, v132, v133
    v_mfma_f32_16x16x32_bf16 a[76:79], a[220:223], v[108:111], a[76:79]
    v_exp_f32 v128, v70
    v_mfma_f32_16x16x32_bf16 v[192:195], a[224:227], v[96:99], v[192:195]
    ds_read_b128 a[204:207], v2 offset:1024
    buffer_load_dwordx4 v9, s[8:11], s21 offen lds
    v_mfma_f32_16x16x32_bf16 v[240:243], a[224:227], v[100:103], v[240:243]
    ds_read_b128 a[136:139], v7 offset:10240
    v_cvt_pk_bf16_f32 v115, v128, v129
    v_mfma_f32_16x16x32_bf16 a[32:35], a[224:227], v[104:107], a[32:35]
    ds_read_b128 a[164:167], v8 offset:16384
    v_fma_f32 v83, v83, s28, v18
    v_mfma_f32_16x16x32_bf16 a[80:83], a[224:227], v[108:111], a[80:83]
    v_exp_f32 v131, v75
    v_mfma_f32_16x16x32_bf16 v[196:199], a[228:231], v[96:99], v[196:199]
    s_add_u32 s21, s21, 128
    ds_read_b128 a[200:203], v1 offset:1024
    v_fma_f32 v93, v93, s28, v19
    v_mfma_f32_16x16x32_bf16 v[244:247], a[228:231], v[100:103], v[244:247]
    ds_read_b128 a[192:195], v1 offset:0
    v_fma_f32 v82, v82, s28, v18
    v_mfma_f32_16x16x32_bf16 v[24:27], a[240:243], v[112:115], v[20:23]
    s_add_u32 m0, s22, 25600
    ds_read_b128 a[116:119], v8 offset:4096
    v_cvt_pk_bf16_f32 v117, v130, v131
    v_mfma_f32_16x16x32_bf16 a[36:39], a[228:231], v[104:107], a[36:39]
    v_exp_f32 v133, v85
    v_mfma_f32_16x16x32_bf16 a[84:87], a[228:231], v[108:111], a[84:87]
    buffer_load_dwordx4 v9, s[8:11], s21 offen lds
    v_mfma_f32_16x16x32_bf16 v[200:203], a[232:235], v[96:99], v[200:203]
    ds_read_b128 a[212:215], v2 offset:2048
    v_mfma_f32_16x16x32_bf16 v[248:251], a[232:235], v[100:103], v[248:251]
    v_exp_f32 v135, v79
    v_mfma_f32_16x16x32_bf16 a[40:43], a[232:235], v[104:107], a[40:43]
    s_add_u32 s21, s21, 128
    ds_read_b128 a[124:127], v8 offset:6144
    s_add_u32 m0, s22, 26624
    v_mfma_f32_16x16x32_bf16 a[88:91], a[232:235], v[108:111], a[88:91]
    ds_read_b128 a[208:211], v1 offset:2048
    v_cvt_pk_bf16_f32 v119, v134, v135
    v_mfma_f32_16x16x32_bf16 v[204:207], a[236:239], v[96:99], v[204:207]
    buffer_load_dwordx4 v9, s[8:11], s21 offen lds
    ds_read_b128 a[148:151], v8 offset:12288
    v_mfma_f32_16x16x32_bf16 v[24:27], a[244:247], v[116:119], v[24:27]
    v_exp_f32 v128, v80
    v_mfma_f32_16x16x32_bf16 v[252:255], a[236:239], v[100:103], v[252:255]
    ds_read_b128 a[220:223], v2 offset:6144
    v_exp_f32 v132, v84
    v_mfma_f32_16x16x32_bf16 a[44:47], a[236:239], v[104:107], a[44:47]
    v_exp_f32 v131, v83
    v_mfma_f32_16x16x32_bf16 a[92:95], a[236:239], v[108:111], a[92:95]
    s_waitcnt lgkmcnt(5)
    ds_read_b128 a[152:155], v7 offset:14336
    v_fma_f32 v90, v90, s28, v19
    v_mfma_f32_16x16x32_bf16 v[32:35], a[192:195], a[96:99], 0
    ds_read_b128 a[232:235], v1 offset:8192
    v_fma_f32 v88, v88, s28, v19
    v_mfma_f32_16x16x32_bf16 v[32:35], a[196:199], a[100:103], v[32:35]
    ds_read_b128 a[160:163], v7 offset:16384
    v_exp_f32 v130, v82
    v_mfma_f32_16x16x32_bf16 v[32:35], a[200:203], a[104:107], v[32:35]
    ds_read_b128 a[228:231], v2 offset:7168
    v_mfma_f32_16x16x32_bf16 v[32:35], a[204:207], a[108:111], v[32:35]
    s_waitcnt lgkmcnt(6)
    ds_read_b128 a[156:159], v8 offset:14336
    v_fma_f32 v92, v92, s28, v19
    v_mfma_f32_16x16x32_bf16 v[32:35], a[208:211], a[112:115], v[32:35]
    ds_read_b128 a[236:239], v2 offset:8192
    v_mfma_f32_16x16x32_bf16 v[32:35], a[212:215], a[116:119], v[32:35]
    ds_read_b128 a[224:227], v1 offset:7168
    v_cvt_pk_bf16_f32 v121, v130, v131
    v_mfma_f32_16x16x32_bf16 v[40:43], a[192:195], a[120:123], 0
    ds_read_b128 a[216:219], v1 offset:6144
    v_mfma_f32_16x16x32_bf16 v[40:43], a[196:199], a[124:127], v[40:43]
    v_exp_f32 v129, v81
    v_mfma_f32_16x16x32_bf16 v[40:43], a[200:203], a[128:131], v[40:43]
    v_cvt_pk_bf16_f32 v122, v132, v133
    v_mfma_f32_16x16x32_bf16 v[40:43], a[204:207], a[132:135], v[40:43]
    v_exp_f32 v134, v86
    v_mfma_f32_16x16x32_bf16 v[40:43], a[208:211], a[136:139], v[40:43]
    v_exp_f32 v132, v92
    v_mfma_f32_16x16x32_bf16 v[40:43], a[212:215], a[140:143], v[40:43]
    s_add_u32 s21, s21, 12032
    v_exp_f32 v135, v87
    v_mfma_f32_16x16x32_bf16 v[48:51], a[192:195], a[144:147], 0
    s_waitcnt lgkmcnt(4)
    v_cvt_pk_bf16_f32 v120, v128, v129
    v_cvt_pk_bf16_f32 v123, v134, v135
    v_mfma_f32_16x16x32_bf16 v[48:51], a[196:199], a[148:151], v[48:51]
    v_exp_f32 v130, v90
    v_mfma_f32_16x16x32_bf16 v[48:51], a[200:203], a[152:155], v[48:51]
    s_waitcnt lgkmcnt(2)
    v_exp_f32 v129, v89
    v_mfma_f32_16x16x32_bf16 v[48:51], a[204:207], a[156:159], v[48:51]
    v_exp_f32 v135, v95
    v_mfma_f32_16x16x32_bf16 v[48:51], a[208:211], a[160:163], v[48:51]
    v_exp_f32 v133, v93
    v_mfma_f32_16x16x32_bf16 v[48:51], a[212:215], a[164:167], v[48:51]
    s_waitcnt vmcnt(10) lgkmcnt(0)
    v_exp_f32 v134, v94
    v_mfma_f32_16x16x32_bf16 v[24:27], a[248:251], v[120:123], v[24:27]
    s_barrier
    v_mfma_f32_16x16x32_bf16 v[36:39], a[216:219], a[96:99], 0
    s_add_u32 m0, s22, 0
    v_exp_f32 v128, v88
    v_mfma_f32_16x16x32_bf16 v[36:39], a[220:223], a[100:103], v[36:39]
    buffer_load_dwordx4 v9, s[4:7], s20 offen lds
    v_mfma_f32_16x16x32_bf16 v[36:39], a[224:227], a[104:107], v[36:39]
    ds_read_b64_tr_b16 a[192:193], v3 offset:12288
    v_mfma_f32_16x16x32_bf16 v[36:39], a[228:231], a[108:111], v[36:39]
    v_cvt_pk_bf16_f32 v127, v134, v135
    v_cvt_pk_bf16_f32 v126, v132, v133
    v_mfma_f32_16x16x32_bf16 v[36:39], a[232:235], a[112:115], v[36:39]
    ds_read_b64_tr_b16 a[194:195], v3 offset:18432
    v_mfma_f32_16x16x32_bf16 v[36:39], a[236:239], a[116:119], v[36:39]
    v_exp_f32 v131, v91
    v_mfma_f32_16x16x32_bf16 v[44:47], a[216:219], a[120:123], 0
    ds_read_b64_tr_b16 a[196:197], v4 offset:12288
    v_cvt_pk_bf16_f32 v124, v128, v129
    v_mfma_f32_16x16x32_bf16 v[44:47], a[220:223], a[124:127], v[44:47]
    ds_read_b64_tr_b16 a[198:199], v4 offset:18432
    s_add_u32 s20, s20, 128
    v_mfma_f32_16x16x32_bf16 v[44:47], a[224:227], a[128:131], v[44:47]
    v_cvt_pk_bf16_f32 v125, v130, v131
    v_mfma_f32_16x16x32_bf16 v[44:47], a[228:231], a[132:135], v[44:47]
    s_add_u32 m0, s22, 1024
    ds_read_b64_tr_b16 a[200:201], v5 offset:12288
    v_mfma_f32_16x16x32_bf16 v[44:47], a[232:235], a[136:139], v[44:47]
    buffer_load_dwordx4 v9, s[4:7], s20 offen lds
    v_mfma_f32_16x16x32_bf16 v[24:27], a[252:255], v[124:127], v[24:27]
    ds_read_b64_tr_b16 a[202:203], v5 offset:18432
    s_add_u32 s20, s20, 128
    v_mfma_f32_16x16x32_bf16 v[44:47], a[236:239], a[140:143], v[44:47]
    ds_read_b64_tr_b16 a[204:205], v6 offset:12288
    s_add_u32 m0, s22, 2048
    v_mfma_f32_16x16x32_bf16 v[52:55], a[216:219], a[144:147], 0
    ds_read_b64_tr_b16 a[206:207], v6 offset:18432
    v_mfma_f32_16x16x32_bf16 v[52:55], a[220:223], a[148:151], v[52:55]
    ds_read_b64_tr_b16 a[208:209], v3 offset:13312
    v_cmp_lt_f32 vcc, s29, v24
    v_mfma_f32_16x16x32_bf16 v[52:55], a[224:227], a[152:155], v[52:55]
    buffer_load_dwordx4 v9, s[4:7], s20 offen lds
    v_mfma_f32_16x16x32_bf16 v[52:55], a[228:231], a[156:159], v[52:55]
    ds_read_b64_tr_b16 a[210:211], v3 offset:19456
    v_mfma_f32_16x16x32_bf16 v[52:55], a[232:235], a[160:163], v[52:55]
    s_cbranch_vccnz L_rs_tr43b
L_ret_tr43b:
    ds_read_b64_tr_b16 a[212:213], v4 offset:13312
    v_mfma_f32_16x16x32_bf16 v[52:55], a[236:239], a[164:167], v[52:55]
    ds_read_b64_tr_b16 a[214:215], v4 offset:19456
    s_add_u32 s20, s20, 12032
    v_max3_f32 v30, v40, v41, v42
    s_waitcnt lgkmcnt(10)
    v_mfma_f32_16x16x32_bf16 v[160:163], a[192:195], v[112:115], v[160:163]
    ds_read_b64_tr_b16 a[226:227], v3 offset:20480
    v_max3_f32 v30, v30, v43, v44
    v_mfma_f32_16x16x32_bf16 v[208:211], a[192:195], v[116:119], v[208:211]
    v_max3_f32 v28, v32, v33, v34
    v_max3_f32 v28, v28, v35, v36
    v_mfma_f32_16x16x32_bf16 a[0:3], a[192:195], v[120:123], a[0:3]
    s_add_u32 s24, s34, 128
    ds_read_b64_tr_b16 a[230:231], v4 offset:20480
    v_max3_f32 v30, v30, v45, v46
    v_max3_f32 v28, v28, v37, v38
    v_mov_b32 v153, v24
    v_mov_b32 v152, v24
    v_mfma_f32_16x16x32_bf16 a[48:51], a[192:195], v[124:127], a[48:51]
    s_waitcnt lgkmcnt(10)
    ds_read_b64_tr_b16 a[216:217], v5 offset:13312
    v_max_f32 v28, v28, v39
    v_mfma_f32_16x16x32_bf16 v[164:167], a[196:199], v[112:115], v[164:167]
    v_mov_b32 v29, v28
    v_max_f32 v30, v30, v47
    v_mfma_f32_16x16x32_bf16 v[212:215], a[196:199], v[116:119], v[212:215]
    s_add_u32 s18, s34, 24576
    v_permlane32_swap_b32 v29, v28
    v_max_f32 v28, v28, v29
    v_mov_b32 v31, v30
    v_mfma_f32_16x16x32_bf16 a[4:7], a[196:199], v[120:123], a[4:7]
    s_mov_b32 s34, s33
    ds_read_b64_tr_b16 a[220:221], v6 offset:13312
    v_accvgpr_read_b32 v151, a51
    v_mov_b32 v29, v28
    v_mfma_f32_16x16x32_bf16 a[52:55], a[196:199], v[124:127], a[52:55]
    s_waitcnt lgkmcnt(4)
    v_permlane32_swap_b32 v31, v30
    v_mfma_f32_16x16x32_bf16 v[168:171], a[200:203], v[112:115], v[168:171]
    s_add_u32 s37, s37, 1
    v_permlane16_swap_b32 v29, v28
    v_mfma_f32_16x16x32_bf16 v[216:219], a[200:203], v[116:119], v[216:219]
    ds_read_b64_tr_b16 a[232:233], v5 offset:14336
    v_max_f32 v28, v28, v29
    v_mfma_f32_16x16x32_bf16 a[8:11], a[200:203], v[120:123], a[8:11]
    ds_read_b64_tr_b16 a[236:237], v6 offset:14336
    v_max_f32 v30, v30, v31
    v_mfma_f32_16x16x32_bf16 a[56:59], a[200:203], v[124:127], a[56:59]
    s_add_u32 s35, s35, 325632
    ds_read_b64_tr_b16 a[218:219], v5 offset:19456
    v_mul_f32_e64 v16, -s28, v28
    v_mfma_f32_16x16x32_bf16 v[172:175], a[204:207], v[112:115], v[172:175]
    ds_read_b64_tr_b16 a[228:229], v4 offset:14336
    v_fma_f32 v34, v34, s28, v16
    v_mfma_f32_16x16x32_bf16 v[220:223], a[204:207], v[116:119], v[220:223]
    s_lshl_b32 s42, s37, 1
    ds_read_b64_tr_b16 a[234:235], v5 offset:20480
    v_permlane16_swap_b32 v152, v153
    v_mfma_f32_16x16x32_bf16 a[12:15], a[204:207], v[120:123], a[12:15]
    s_lshr_b32 s42, s31, s42
    ds_read_b64_tr_b16 a[222:223], v6 offset:19456
    v_mov_b32 v31, v30
    v_fma_f32 v37, v37, s28, v16
    v_mfma_f32_16x16x32_bf16 a[60:63], a[204:207], v[124:127], a[60:63]
    s_xor_b32 s42, s42, s36
    ds_read_b64_tr_b16 a[224:225], v3 offset:14336
    v_max3_f32 v28, v48, v49, v50
    v_accvgpr_read_b32 v147, a3
    v_mfma_f32_16x16x32_bf16 v[176:179], a[208:211], v[112:115], v[176:179]
    s_and_b32 s42, s42, 3
    v_accvgpr_read_b32 v148, a48
    v_accvgpr_read_b32 v150, a50
    v_mfma_f32_16x16x32_bf16 v[224:227], a[208:211], v[116:119], v[224:227]
    s_mul_i32 s43, s3, 3
    v_rcp_f32 v156, v26
    v_fma_f32 v33, v33, s28, v16
    v_mfma_f32_16x16x32_bf16 a[16:19], a[208:211], v[120:123], a[16:19]
    s_lshl_b32 s44, s3, 2
    v_accvgpr_read_b32 v144, a0
    v_accvgpr_read_b32 v149, a49
    v_accvgpr_read_b32 v145, a1
    v_mfma_f32_16x16x32_bf16 a[64:67], a[208:211], v[124:127], a[64:67]
    s_mov_b32 s32, 1
    v_max3_f32 v28, v28, v51, v52
    v_permlane16_swap_b32 v31, v30
    v_mfma_f32_16x16x32_bf16 v[180:183], a[212:215], v[112:115], v[180:183]
    v_exp_f32 v135, v37
    v_mfma_f32_16x16x32_bf16 v[228:231], a[212:215], v[116:119], v[228:231]
    s_add_u32 s45, s43, 17
    v_max_f32 v30, v30, v31
    v_fma_f32 v32, v32, s28, v16
    v_fma_f32 v36, v36, s28, v16
    v_mfma_f32_16x16x32_bf16 a[20:23], a[212:215], v[120:123], a[20:23]
    s_cmp_eq_u32 s3, 0
    v_mul_f32_e64 v17, -s28, v30
    v_max3_f32 v28, v28, v53, v54
    v_mfma_f32_16x16x32_bf16 a[68:71], a[212:215], v[124:127], a[68:71]
    s_cselect_b32 s45, 16, s45
    v_fma_f32 v40, v40, s28, v17
    s_waitcnt lgkmcnt(0)
    v_mfma_f32_16x16x32_bf16 v[184:187], a[216:219], v[112:115], v[184:187]
    s_cselect_b32 s33, 1, 0
    ds_read_b64_tr_b16 a[238:239], v6 offset:20480
    v_xor_b32 v0, 32, v14
    v_mfma_f32_16x16x32_bf16 v[232:235], a[216:219], v[116:119], v[232:235]
    s_cmp_eq_u32 s42, 1
    v_max_f32 v28, v28, v55
    v_mov_b32 v29, v28
    v_mfma_f32_16x16x32_bf16 a[24:27], a[216:219], v[120:123], a[24:27]
    s_cselect_b32 s44, s45, s44
    v_fma_f32 v35, v35, s28, v16
    v_xor_b32 v15, 64, v14
    v_mfma_f32_16x16x32_bf16 a[72:75], a[216:219], v[124:127], a[72:75]
    s_cselect_b32 s32, s33, s32
    v_exp_f32 v132, v40
    v_mfma_f32_16x16x32_bf16 v[188:191], a[220:223], v[112:115], v[188:191]
    s_add_u32 s45, s43, 29
    v_exp_f32 v130, v34
    v_mfma_f32_16x16x32_bf16 v[236:239], a[220:223], v[116:119], v[236:239]
    s_cmp_eq_u32 s42, 2
    s_cselect_b32 s44, s45, s44
    v_fma_f32 v42, v42, s28, v17
    v_mfma_f32_16x16x32_bf16 a[28:31], a[220:223], v[120:123], a[28:31]
    s_cselect_b32 s32, 0, s32
    v_permlane32_swap_b32 v29, v28
    v_fma_f32 v43, v43, s28, v17
    v_mfma_f32_16x16x32_bf16 a[76:79], a[220:223], v[124:127], a[76:79]
    s_add_u32 s45, s43, 41
    v_accvgpr_read_b32 v146, a2
    s_cmp_eq_u32 s42, 3
    v_mfma_f32_16x16x32_bf16 v[192:195], a[224:227], v[112:115], v[192:195]
    s_cselect_b32 s44, s45, s44
    v_rcp_f32 v154, v25
    s_cselect_b32 s32, 0, s32
    v_mfma_f32_16x16x32_bf16 v[240:243], a[224:227], v[116:119], v[240:243]
    s_mul_i32 s44, s44, 6144
    v_exp_f32 v131, v35
    v_mfma_f32_16x16x32_bf16 a[32:35], a[224:227], v[120:123], a[32:35]
    s_add_u32 s33, s35, s44
    v_max_f32 v28, v28, v29
    v_exp_f32 v129, v33
    v_mfma_f32_16x16x32_bf16 a[80:83], a[224:227], v[124:127], a[80:83]
    s_mul_i32 s42, s32, 6144
    v_rcp_f32 v152, v152
    v_mfma_f32_16x16x32_bf16 v[196:199], a[228:231], v[112:115], v[196:199]
    s_add_u32 s42, s42, 18432
    v_fma_f32 v41, v41, s28, v17
    v_fma_f32 v44, v44, s28, v17
    s_add_u32 s42, s42, s33
    v_mfma_f32_16x16x32_bf16 v[244:247], a[228:231], v[116:119], v[244:247]
    s_cmp_ge_u32 s37, 8
    v_rcp_f32 v158, v27
    s_cselect_b32 s14, 0, s42
    v_mfma_f32_16x16x32_bf16 a[36:39], a[228:231], v[120:123], a[36:39]
    s_add_u32 s25, s33, 128
    v_cvt_pk_bf16_f32 v97, v130, v131
    v_fma_f32 v39, v39, s28, v16
    v_mov_b32 v29, v28
    v_mfma_f32_16x16x32_bf16 a[84:87], a[228:231], v[124:127], a[84:87]
    s_add_u32 s23, s38, 2048
    v_exp_f32 v133, v41
    v_mfma_f32_16x16x32_bf16 v[200:203], a[232:235], v[112:115], v[200:203]
    s_mov_b32 s30, 0
    v_permlane16_swap_b32 v29, v28
    v_max_f32 v28, v28, v29
    s_waitcnt vmcnt(6) lgkmcnt(0)
    v_mfma_f32_16x16x32_bf16 v[248:251], a[232:235], v[116:119], v[248:251]
    s_barrier
    ds_read_b128 a[212:215], v2 offset:14336
    v_mul_f32_e64 v18, -s28, v28
    v_mfma_f32_16x16x32_bf16 a[40:43], a[232:235], v[120:123], a[40:43]
    s_add_u32 m0, s22, 36864
    ds_read_b128 a[208:211], v1 offset:14336
    v_fma_f32 v50, v50, s28, v18
    v_mfma_f32_16x16x32_bf16 a[88:91], a[232:235], v[124:127], a[88:91]
    ds_read_b128 a[204:207], v2 offset:13312
    v_fma_f32 v47, v47, s28, v17
    v_fma_f32 v45, v45, s28, v17
    v_mfma_f32_16x16x32_bf16 v[204:207], a[236:239], v[112:115], v[204:207]
    ds_read_b128 a[200:203], v1 offset:13312
    v_cvt_pk_bf16_f32 v100, v132, v133
    v_mfma_f32_16x16x32_bf16 v[252:255], a[236:239], v[116:119], v[252:255]
    ds_read_b128 a[192:195], v1 offset:12288
    v_exp_f32 v134, v36
    v_mfma_f32_16x16x32_bf16 a[44:47], a[236:239], v[120:123], a[44:47]
    buffer_load_dwordx4 v9, s[8:11], s21 offen lds
    ds_read_b128 a[196:199], v2 offset:12288
    v_exp_f32 v128, v32
    v_pk_mul_f32 v[196:197], v[196:197], v[152:153] op_sel_hi:[1,0]
    v_pk_mul_f32 v[186:187], v[186:187], v[152:153] op_sel_hi:[1,0]
    v_pk_mul_f32 v[210:211], v[210:211], v[154:155] op_sel_hi:[1,0]
    v_pk_mul_f32 v[146:147], v[146:147], v[156:157] op_sel_hi:[1,0]
    v_pk_mul_f32 v[144:145], v[144:145], v[156:157] op_sel_hi:[1,0]
    v_pk_mul_f32 v[168:169], v[168:169], v[152:153] op_sel_hi:[1,0]
    v_pk_mul_f32 v[184:185], v[184:185], v[152:153] op_sel_hi:[1,0]
    v_pk_mul_f32 v[166:167], v[166:167], v[152:153] op_sel_hi:[1,0]
    v_cvt_pk_bf16_f32 v184, v184, v185
    v_pk_mul_f32 v[252:253], v[252:253], v[154:155] op_sel_hi:[1,0]
    v_cvt_pk_bf16_f32 v98, v134, v135
    v_pk_mul_f32 v[240:241], v[240:241], v[154:155] op_sel_hi:[1,0]
    v_pk_mul_f32 v[170:171], v[170:171], v[152:153] op_sel_hi:[1,0]
    v_pk_mul_f32 v[214:215], v[214:215], v[154:155] op_sel_hi:[1,0]
    v_pk_mul_f32 v[216:217], v[216:217], v[154:155] op_sel_hi:[1,0]
    v_pk_mul_f32 v[148:149], v[148:149], v[158:159] op_sel_hi:[1,0]
    v_pk_mul_f32 v[222:223], v[222:223], v[154:155] op_sel_hi:[1,0]
    v_cvt_pk_bf16_f32 v144, v144, v145
    v_pk_mul_f32 v[212:213], v[212:213], v[154:155] op_sel_hi:[1,0]
    v_pk_mul_f32 v[162:163], v[162:163], v[152:153] op_sel_hi:[1,0]
    v_pk_mul_f32 v[172:173], v[172:173], v[152:153] op_sel_hi:[1,0]
    v_pk_mul_f32 v[208:209], v[208:209], v[154:155] op_sel_hi:[1,0]
    v_pk_mul_f32 v[150:151], v[150:151], v[158:159] op_sel_hi:[1,0]
    v_cvt_pk_bf16_f32 v208, v208, v209
    v_pk_mul_f32 v[160:161], v[160:161], v[152:153] op_sel_hi:[1,0]
    v_pk_mul_f32 v[220:221], v[220:221], v[154:155] op_sel_hi:[1,0]
    v_fma_f32 v46, v46, s28, v17
    v_fma_f32 v51, v51, s28, v18
    v_fma_f32 v54, v54, s28, v18
    v_pk_mul_f32 v[164:165], v[164:165], v[152:153] op_sel_hi:[1,0]
    v_fma_f32 v38, v38, s28, v16
    v_cvt_pk_bf16_f32 v164, v164, v165
    v_cvt_pk_bf16_f32 v209, v210, v211
    v_mfma_f32_16x16x32_bf16 a[92:95], a[236:239], v[124:127], a[92:95]
    s_waitcnt lgkmcnt(1)
    v_exp_f32 v132, v44
    v_mfma_f32_16x16x32_bf16 v[64:67], a[192:195], a[96:99], 0
    s_waitcnt lgkmcnt(0)
    v_exp_f32 v134, v46
    v_mfma_f32_16x16x32_bf16 v[64:67], a[196:199], a[100:103], v[64:67]
    s_add_u32 s21, s21, 128
    v_cvt_pk_bf16_f32 v148, v148, v149
    v_cvt_pk_bf16_f32 v96, v128, v129
    v_mfma_f32_16x16x32_bf16 v[64:67], a[200:203], a[104:107], v[64:67]
    v_cvt_pk_bf16_f32 v145, v146, v147
    v_fma_f32 v55, v55, s28, v18
    v_exp_f32 v135, v47
    v_accvgpr_read_b32 v146, a6
    v_mfma_f32_16x16x32_bf16 v[64:67], a[204:207], a[108:111], v[64:67]
    v_accvgpr_read_b32 v147, a7
    v_cvt_pk_bf16_f32 v160, v160, v161
    v_mfma_f32_16x16x32_bf16 v[64:67], a[208:211], a[112:115], v[64:67]
    ds_read_b128 a[216:219], v1 offset:18432
    v_exp_f32 v131, v43
    v_mfma_f32_16x16x32_bf16 v[64:67], a[212:215], a[116:119], v[64:67]
    ds_read_b128 a[236:239], v2 offset:20480
    v_exp_f32 v130, v42
    v_cvt_pk_bf16_f32 v103, v134, v135
    v_mfma_f32_16x16x32_bf16 v[72:75], a[192:195], a[120:123], 0
    s_add_u32 m0, s22, 37888
    ds_read_b128 a[232:235], v1 offset:20480
    v_cvt_pk_bf16_f32 v101, v130, v131
    v_cvt_pk_bf16_f32 v161, v162, v163
    v_cvt_pk_bf16_f32 v212, v212, v213
    v_exp_f32 v134, v54
    v_mfma_f32_16x16x32_bf16 v[72:75], a[196:199], a[124:127], v[72:75]
    ds_read_b128 a[220:223], v2 offset:18432
    buffer_load_dwordx4 v9, s[8:11], s21 offen lds
    v_mfma_f32_16x16x32_bf16 v[72:75], a[200:203], a[128:131], v[72:75]
    v_exp_f32 v131, v51
    v_exp_f32 v135, v55
    v_mfma_f32_16x16x32_bf16 v[72:75], a[204:207], a[132:135], v[72:75]
    ds_read_b128 a[224:227], v1 offset:19456
    v_cvt_pk_bf16_f32 v165, v166, v167
    v_mfma_f32_16x16x32_bf16 v[72:75], a[208:211], a[136:139], v[72:75]
    ds_read_b128 a[228:231], v2 offset:19456
    v_exp_f32 v128, v38
    v_mfma_f32_16x16x32_bf16 v[72:75], a[212:215], a[140:143], v[72:75]
    v_exp_f32 v133, v45
    v_cvt_pk_bf16_f32 v149, v150, v151
    v_mfma_f32_16x16x32_bf16 v[80:83], a[192:195], a[144:147], 0
    ds_write2st64_b64 v14, v[160:161], v[208:209] offset0:0 offset1:12
    v_exp_f32 v130, v50
    v_pk_mul_f32 v[226:227], v[226:227], v[154:155] op_sel_hi:[1,0]
    v_pk_mul_f32 v[146:147], v[146:147], v[156:157] op_sel_hi:[1,0]
    v_fma_f32 v52, v52, s28, v18
    v_cvt_pk_bf16_f32 v107, v134, v135
    v_mfma_f32_16x16x32_bf16 v[80:83], a[196:199], a[148:151], v[80:83]
    s_add_u32 s21, s21, 128
    v_exp_f32 v129, v39
    v_mfma_f32_16x16x32_bf16 v[80:83], a[200:203], a[152:155], v[80:83]
    s_add_u32 m0, s22, 38912
    v_fma_f32 v48, v48, s28, v18
    v_fma_f32 v74, v74, s28, v17
    v_cvt_pk_bf16_f32 v105, v130, v131
    v_mfma_f32_16x16x32_bf16 v[80:83], a[204:207], a[156:159], v[80:83]
    buffer_load_dwordx4 v9, s[8:11], s21 offen lds
    v_cvt_pk_bf16_f32 v99, v128, v129
    v_mfma_f32_16x16x32_bf16 v[80:83], a[208:211], a[160:163], v[80:83]
    s_add_u32 s21, s21, 12032
    v_subrev_u32 v13, 20480, v13
    v_fma_f32 v49, v49, s28, v18
    v_mfma_f32_16x16x32_bf16 v[80:83], a[212:215], a[164:167], v[80:83]
    s_waitcnt vmcnt(6) lgkmcnt(1)
    ds_write2st64_b64 v14, v[144:145], v[148:149] offset0:24 offset1:36
    v_mfma_f32_16x16x32_bf16 v[68:71], a[216:219], a[96:99], 0
    s_barrier
    v_fma_f32 v64, v64, s28, v16
    v_cvt_pk_bf16_f32 v185, v186, v187
    v_mfma_f32_16x16x32_bf16 v[68:71], a[220:223], a[100:103], v[68:71]
    v_fma_f32 v53, v53, s28, v18
    v_fma_f32 v66, v66, s28, v16
    v_cvt_pk_bf16_f32 v216, v216, v217
    v_accvgpr_read_b32 v149, a53
    v_mfma_f32_16x16x32_bf16 v[68:71], a[224:227], a[104:107], v[68:71]
    ds_read_b64_tr_b16 a[192:193], v3 offset:0
    v_fma_f32 v67, v67, s28, v16
    v_mfma_f32_16x16x32_bf16 v[68:71], a[228:231], a[108:111], v[68:71]
    v_cvt_pk_bf16_f32 v102, v132, v133
    v_fma_f32 v82, v82, s28, v18
    v_mfma_f32_16x16x32_bf16 v[68:71], a[232:235], a[112:115], v[68:71]
    ds_read_b64_tr_b16 a[194:195], v3 offset:6144
    v_accvgpr_read_b32 v148, a52
    v_mfma_f32_16x16x32_bf16 v[68:71], a[236:239], a[116:119], v[68:71]
    ds_read_b64_tr_b16 a[196:197], v4 offset:0
    v_accvgpr_read_b32 v151, a55
    v_mfma_f32_16x16x32_bf16 v[76:79], a[216:219], a[120:123], 0
    ds_read_b64_tr_b16 a[198:199], v4 offset:6144
    v_cvt_pk_bf16_f32 v168, v168, v169
    v_mfma_f32_16x16x32_bf16 v[76:79], a[220:223], a[124:127], v[76:79]
    v_accvgpr_read_b32 v145, a5
    v_fma_f32 v73, v73, s28, v17
    v_mfma_f32_16x16x32_bf16 v[76:79], a[224:227], a[128:131], v[76:79]
    s_add_u32 m0, s22, 12288
    ds_read_b64_tr_b16 a[200:201], v5 offset:0
    buffer_load_dwordx4 v9, s[4:7], s20 offen lds
    v_mfma_f32_16x16x32_bf16 v[76:79], a[228:231], a[132:135], v[76:79]
    ds_read_b64_tr_b16 a[202:203], v5 offset:6144
    v_fma_f32 v68, v68, s28, v16
    v_mfma_f32_16x16x32_bf16 v[76:79], a[232:235], a[136:139], v[76:79]
    v_exp_f32 v130, v66
    v_mfma_f32_16x16x32_bf16 v[76:79], a[236:239], a[140:143], v[76:79]
    v_exp_f32 v128, v48
    v_exp_f32 v132, v52
    v_accvgpr_read_b32 v144, a4
    v_pk_mul_f32 v[180:181], v[180:181], v[152:153] op_sel_hi:[1,0]
    v_pk_mul_f32 v[144:145], v[144:145], v[156:157] op_sel_hi:[1,0]
    v_pk_mul_f32 v[224:225], v[224:225], v[154:155] op_sel_hi:[1,0]
    v_accvgpr_read_b32 v150, a54
    v_pk_mul_f32 v[174:175], v[174:175], v[152:153] op_sel_hi:[1,0]
    v_pk_mul_f32 v[254:255], v[254:255], v[154:155] op_sel_hi:[1,0]
    v_pk_mul_f32 v[250:251], v[250:251], v[154:155] op_sel_hi:[1,0]
    v_pk_mul_f32 v[148:149], v[148:149], v[158:159] op_sel_hi:[1,0]
    v_pk_mul_f32 v[204:205], v[204:205], v[152:153] op_sel_hi:[1,0]
    v_pk_mul_f32 v[176:177], v[176:177], v[152:153] op_sel_hi:[1,0]
    v_pk_mul_f32 v[218:219], v[218:219], v[154:155] op_sel_hi:[1,0]
    v_pk_mul_f32 v[150:151], v[150:151], v[158:159] op_sel_hi:[1,0]
    v_pk_mul_f32 v[182:183], v[182:183], v[152:153] op_sel_hi:[1,0]
    v_pk_mul_f32 v[190:191], v[190:191], v[152:153] op_sel_hi:[1,0]
    v_exp_f32 v134, v68
    v_cvt_pk_bf16_f32 v144, v144, v145
    v_exp_f32 v129, v49
    v_cvt_pk_bf16_f32 v213, v214, v215
    v_cvt_pk_bf16_f32 v104, v128, v129
    v_fma_f32 v69, v69, s28, v16
    v_mfma_f32_16x16x32_bf16 v[84:87], a[216:219], a[144:147], 0
    ds_read_b64_tr_b16 a[204:205], v6 offset:0
    v_cvt_pk_bf16_f32 v148, v148, v149
    v_cvt_pk_bf16_f32 v169, v170, v171
    v_mfma_f32_16x16x32_bf16 v[84:87], a[220:223], a[148:151], v[84:87]
    ds_write2st64_b64 v0, v[164:165], v[212:213] offset0:0 offset1:12
    v_mfma_f32_16x16x32_bf16 v[84:87], a[224:227], a[152:155], v[84:87]
    ds_read_b64_tr_b16 a[222:223], v6 offset:7168
    v_cvt_pk_bf16_f32 v145, v146, v147
    v_mfma_f32_16x16x32_bf16 v[84:87], a[228:231], a[156:159], v[84:87]
    ds_read_b64_tr_b16 a[206:207], v6 offset:6144
    v_cvt_pk_bf16_f32 v149, v150, v151
    v_fma_f32 v83, v83, s28, v18
    v_exp_f32 v133, v53
    v_cvt_pk_bf16_f32 v172, v172, v173
    v_pk_mul_f32 v[246:247], v[246:247], v[154:155] op_sel_hi:[1,0]
    v_pk_mul_f32 v[232:233], v[232:233], v[154:155] op_sel_hi:[1,0]
    v_accvgpr_read_b32 v146, a10
    v_pk_mul_f32 v[192:193], v[192:193], v[152:153] op_sel_hi:[1,0]
    v_pk_mul_f32 v[248:249], v[248:249], v[154:155] op_sel_hi:[1,0]
    v_exp_f32 v131, v67
    v_fma_f32 v70, v70, s28, v16
    v_cvt_pk_bf16_f32 v180, v180, v181
    v_mfma_f32_16x16x32_bf16 v[84:87], a[232:235], a[160:163], v[84:87]
    ds_read_b64_tr_b16 a[208:209], v3 offset:1024
    v_xor_b32 v8, 96, v14
    v_cvt_pk_bf16_f32 v220, v220, v221
    v_mfma_f32_16x16x32_bf16 v[84:87], a[236:239], a[164:167], v[84:87]
    s_waitcnt lgkmcnt(5)
    v_accvgpr_read_b32 v151, a59
    v_fma_f32 v81, v81, s28, v18
    v_fma_f32 v65, v65, s28, v16
    v_mfma_f32_16x16x32_bf16 v[160:163], a[192:195], v[96:99], 0
    s_add_u32 s20, s20, 128
    ds_write2st64_b64 v0, v[144:145], v[148:149] offset0:24 offset1:36
    v_accvgpr_read_b32 v148, a56
    v_pk_mul_f32 v[244:245], v[244:245], v[154:155] op_sel_hi:[1,0]
    v_fma_f32 v76, v76, s28, v17
    v_fma_f32 v77, v77, s28, v17
    v_exp_f32 v135, v69
    v_cvt_pk_bf16_f32 v113, v130, v131
    v_fma_f32 v78, v78, s28, v17
    v_cvt_pk_bf16_f32 v114, v134, v135
    v_accvgpr_read_b32 v147, a11
    v_pk_mul_f32 v[242:243], v[242:243], v[154:155] op_sel_hi:[1,0]
    v_pk_mul_f32 v[236:237], v[236:237], v[154:155] op_sel_hi:[1,0]
    v_pk_mul_f32 v[188:189], v[188:189], v[152:153] op_sel_hi:[1,0]
    v_exp_f32 v129, v65
    v_cvt_pk_bf16_f32 v196, v196, v197
    v_cvt_pk_bf16_f32 v106, v132, v133
    v_accvgpr_read_b32 v145, a9
    v_mfma_f32_16x16x32_bf16 v[208:211], a[192:195], v[100:103], 0
    ds_read_b64_tr_b16 a[210:211], v3 offset:7168
    v_accvgpr_read_b32 v144, a8
    v_mfma_f32_16x16x32_bf16 a[0:3], a[192:195], v[104:107], 0
    s_add_u32 m0, s22, 13312
    ds_read_b64_tr_b16 a[226:227], v3 offset:8192
    v_accvgpr_read_b32 v149, a57
    v_cvt_pk_bf16_f32 v240, v240, v241
    v_exp_f32 v133, v73
    v_exp_f32 v128, v64
    v_fma_f32 v79, v79, s28, v17
    v_pk_mul_f32 v[200:201], v[200:201], v[152:153] op_sel_hi:[1,0]
    v_cvt_pk_bf16_f32 v224, v224, v225
    v_cvt_pk_bf16_f32 v217, v218, v219
    v_cvt_pk_bf16_f32 v236, v236, v237
    v_mfma_f32_16x16x32_bf16 v[164:167], a[196:199], v[96:99], 0
    buffer_load_dwordx4 v9, s[4:7], s20 offen lds
    ds_read_b64_tr_b16 a[218:219], v5 offset:7168
    v_cvt_pk_bf16_f32 v204, v204, v205
    v_fma_f32 v71, v71, s28, v16
    v_pk_mul_f32 v[148:149], v[148:149], v[158:159] op_sel_hi:[1,0]
    v_fma_f32 v75, v75, s28, v17
    v_pk_mul_f32 v[144:145], v[144:145], v[156:157] op_sel_hi:[1,0]
    v_pk_mul_f32 v[178:179], v[178:179], v[152:153] op_sel_hi:[1,0]
    v_pk_mul_f32 v[146:147], v[146:147], v[156:157] op_sel_hi:[1,0]
    v_cvt_pk_bf16_f32 v176, v176, v177
    v_accvgpr_read_b32 v150, a58
    v_cvt_pk_bf16_f32 v144, v144, v145
    v_fma_f32 v86, v86, s28, v18
    v_cvt_pk_bf16_f32 v252, v252, v253
    v_cvt_pk_bf16_f32 v145, v146, v147
    v_mfma_f32_16x16x32_bf16 v[212:215], a[196:199], v[100:103], 0
    ds_write2st64_b64 v15, v[168:169], v[216:217] offset0:0 offset1:12
    v_pk_mul_f32 v[150:151], v[150:151], v[158:159] op_sel_hi:[1,0]
    v_cvt_pk_bf16_f32 v173, v174, v175
    v_cvt_pk_bf16_f32 v148, v148, v149
    v_cvt_pk_bf16_f32 v177, v178, v179
    v_cvt_pk_bf16_f32 v192, v192, v193
    v_pk_mul_f32 v[228:229], v[228:229], v[154:155] op_sel_hi:[1,0]
    v_accvgpr_read_b32 v147, a15
    v_accvgpr_read_b32 v146, a14
    v_pk_mul_f32 v[238:239], v[238:239], v[154:155] op_sel_hi:[1,0]
    v_cvt_pk_bf16_f32 v149, v150, v151
    v_accvgpr_read_b32 v150, a62
    v_accvgpr_read_b32 v151, a63
    v_fma_f32 v72, v72, s28, v17
    v_mfma_f32_16x16x32_bf16 v[20:23], a[240:243], v[96:99], 0
    s_add_u32 s20, s20, 128
    ds_write2st64_b64 v15, v[144:145], v[148:149] offset0:24 offset1:36
    v_cvt_pk_bf16_f32 v248, v248, v249
    v_accvgpr_read_b32 v145, a13
    v_cvt_pk_bf16_f32 v200, v200, v201
    v_fma_f32 v80, v80, s28, v18
    v_accvgpr_read_b32 v149, a61
    v_pk_mul_f32 v[230:231], v[230:231], v[154:155] op_sel_hi:[1,0]
    v_exp_f32 v130, v74
    v_pk_mul_f32 v[202:203], v[202:203], v[152:153] op_sel_hi:[1,0]
    v_accvgpr_read_b32 v148, a60
    v_accvgpr_read_b32 v144, a12
    v_pk_mul_f32 v[194:195], v[194:195], v[152:153] op_sel_hi:[1,0]
    v_exp_f32 v132, v72
    v_pk_mul_f32 v[150:151], v[150:151], v[158:159] op_sel_hi:[1,0]
    v_cvt_pk_bf16_f32 v232, v232, v233
    v_cvt_pk_bf16_f32 v221, v222, v223
    v_pk_mul_f32 v[146:147], v[146:147], v[156:157] op_sel_hi:[1,0]
    v_cvt_pk_bf16_f32 v112, v128, v129
    v_cvt_pk_bf16_f32 v181, v182, v183
    v_pk_mul_f32 v[144:145], v[144:145], v[156:157] op_sel_hi:[1,0]
    v_exp_f32 v135, v79
    v_exp_f32 v134, v78
    v_pk_mul_f32 v[234:235], v[234:235], v[154:155] op_sel_hi:[1,0]
    v_cvt_pk_bf16_f32 v144, v144, v145
    v_cvt_pk_bf16_f32 v145, v146, v147
    v_pk_mul_f32 v[148:149], v[148:149], v[158:159] op_sel_hi:[1,0]
    v_cvt_pk_bf16_f32 v253, v254, v255
    v_cvt_pk_bf16_f32 v116, v132, v133
    v_mfma_f32_16x16x32_bf16 v[20:23], a[244:247], v[100:103], v[20:23]
    s_add_u32 m0, s22, 14336
    ds_read_b64_tr_b16 a[216:217], v5 offset:1024
    ds_read_b64_tr_b16 a[212:213], v4 offset:1024
    buffer_load_dwordx4 v9, s[4:7], s20 offen lds
    v_cvt_pk_bf16_f32 v225, v226, v227
    v_cvt_pk_bf16_f32 v148, v148, v149
    v_cvt_pk_bf16_f32 v149, v150, v151
    v_accvgpr_read_b32 v150, a66
    v_accvgpr_read_b32 v146, a18
    v_accvgpr_read_b32 v147, a19
    v_accvgpr_read_b32 v151, a67
    v_mfma_f32_16x16x32_bf16 a[4:7], a[196:199], v[104:107], 0
    ds_write2st64_b64 v8, v[172:173], v[220:221] offset0:0 offset1:12
    v_exp_f32 v128, v70
    v_cvt_pk_bf16_f32 v188, v188, v189
    v_mfma_f32_16x16x32_bf16 v[168:171], a[200:203], v[96:99], 0
    s_add_u32 s20, s20, 12032
    ds_read_b64_tr_b16 a[214:215], v4 offset:7168
    ds_read_b64_tr_b16 a[228:229], v4 offset:2048
    v_mfma_f32_16x16x32_bf16 v[216:219], a[200:203], v[100:103], 0
    ds_write2st64_b64 v8, v[144:145], v[148:149] offset0:24 offset1:36
    v_exp_f32 v133, v77
    v_accvgpr_read_b32 v148, a64
    v_cvt_pk_bf16_f32 v228, v228, v229
    v_mfma_f32_16x16x32_bf16 a[8:11], a[200:203], v[104:107], 0
    s_waitcnt lgkmcnt(6)
    ds_read_b64_tr_b16 a[224:225], v3 offset:2048
    v_accvgpr_read_b32 v149, a65
    v_mfma_f32_16x16x32_bf16 v[172:175], a[204:207], v[96:99], 0
    s_add_u32 s56, s24, 4294967168
    ds_read_b128 v[136:139], v13 offset:0
    v_exp_f32 v129, v71
    v_accvgpr_read_b32 v144, a16
    v_cvt_pk_bf16_f32 v229, v230, v231
    v_fma_f32 v84, v84, s28, v18
    v_pk_mul_f32 v[150:151], v[150:151], v[158:159] op_sel_hi:[1,0]
    v_cvt_pk_bf16_f32 v241, v242, v243
    v_pk_mul_f32 v[148:149], v[148:149], v[158:159] op_sel_hi:[1,0]
    v_pk_mul_f32 v[146:147], v[146:147], v[156:157] op_sel_hi:[1,0]
    v_accvgpr_read_b32 v145, a17
    v_cvt_pk_bf16_f32 v148, v148, v149
    v_pk_mul_f32 v[144:145], v[144:145], v[156:157] op_sel_hi:[1,0]
    v_exp_f32 v131, v75
    v_cvt_pk_bf16_f32 v144, v144, v145
    v_cvt_pk_bf16_f32 v149, v150, v151
    v_mfma_f32_16x16x32_bf16 v[220:223], a[204:207], v[100:103], 0
    s_add_u32 s58, s25, 4294967168
    ds_read_b64_tr_b16 a[220:221], v6 offset:1024
    v_accvgpr_read_b32 v150, a70
    v_mfma_f32_16x16x32_bf16 a[12:15], a[204:207], v[104:107], 0
    ds_write2st64_b64 v14, v[176:177], v[224:225] offset0:4 offset1:16
    v_cvt_pk_bf16_f32 v115, v128, v129
    v_cvt_pk_bf16_f32 v145, v146, v147
    v_fma_f32 v85, v85, s28, v18
    v_fma_f32 v87, v87, s28, v18
    v_mfma_f32_16x16x32_bf16 v[176:179], a[208:211], v[96:99], 0
    s_add_u32 m0, s38, 0
    ds_write2st64_b64 v14, v[144:145], v[148:149] offset0:28 offset1:40
    v_pk_mul_f32 v[198:199], v[198:199], v[152:153] op_sel_hi:[1,0]
    v_accvgpr_read_b32 v149, a69
    v_accvgpr_read_b32 v144, a20
    v_cvt_pk_bf16_f32 v244, v244, v245
    v_accvgpr_read_b32 v146, a22
    v_accvgpr_read_b32 v148, a68
    v_cvt_pk_bf16_f32 v189, v190, v191
    v_accvgpr_read_b32 v147, a23
    v_accvgpr_read_b32 v145, a21
    v_pk_mul_f32 v[144:145], v[144:145], v[156:157] op_sel_hi:[1,0]
    v_pk_mul_f32 v[146:147], v[146:147], v[156:157] op_sel_hi:[1,0]
    v_accvgpr_read_b32 v151, a71
    v_cvt_pk_bf16_f32 v144, v144, v145
    v_mfma_f32_16x16x32_bf16 v[224:227], a[208:211], v[100:103], 0
    s_waitcnt lgkmcnt(3)
    ds_read_b128 v[140:143], v13 offset:1024
    buffer_load_dwordx4 v10, s[12:15], s58 offen nt lds
    v_cvt_pk_bf16_f32 v193, v194, v195
    v_cvt_pk_bf16_f32 v245, v246, v247
    v_cvt_pk_bf16_f32 v233, v234, v235
    v_pk_mul_f32 v[148:149], v[148:149], v[158:159] op_sel_hi:[1,0]
    v_pk_mul_f32 v[150:151], v[150:151], v[158:159] op_sel_hi:[1,0]
    v_exp_f32 v132, v76
    v_pk_mul_f32 v[206:207], v[206:207], v[152:153] op_sel_hi:[1,0]
    v_cvt_pk_bf16_f32 v145, v146, v147
    v_cvt_pk_bf16_f32 v119, v134, v135
    v_mfma_f32_16x16x32_bf16 a[16:19], a[208:211], v[104:107], 0
    s_add_u32 m0, s38, 1024
    ds_write2st64_b64 v0, v[180:181], v[228:229] offset0:4 offset1:16
    v_cvt_pk_bf16_f32 v148, v148, v149
    v_exp_f32 v135, v87
    v_cvt_pk_bf16_f32 v149, v150, v151
    v_mfma_f32_16x16x32_bf16 v[20:23], a[248:251], v[104:107], v[20:23]
    ds_write2st64_b64 v0, v[144:145], v[148:149] offset0:28 offset1:40
    v_accvgpr_read_b32 v146, a26
    v_accvgpr_read_b32 v149, a73
    v_mfma_f32_16x16x32_bf16 v[180:183], a[212:215], v[96:99], 0
    ds_write2st64_b64 v15, v[184:185], v[232:233] offset0:4 offset1:16
    v_accvgpr_read_b32 v145, a25
    v_accvgpr_read_b32 v148, a72
    v_pk_mul_f32 v[148:149], v[148:149], v[158:159] op_sel_hi:[1,0]
    v_accvgpr_read_b32 v147, a27
    v_cvt_pk_bf16_f32 v249, v250, v251
    v_accvgpr_read_b32 v144, a24
    v_pk_mul_f32 v[146:147], v[146:147], v[156:157] op_sel_hi:[1,0]
    v_pk_mul_f32 v[144:145], v[144:145], v[156:157] op_sel_hi:[1,0]
    v_cvt_pk_bf16_f32 v148, v148, v149
    v_accvgpr_read_b32 v150, a74
    v_mfma_f32_16x16x32_bf16 v[228:231], a[212:215], v[100:103], 0
    ds_read_b64_tr_b16 a[230:231], v4 offset:8192
    v_cvt_pk_bf16_f32 v144, v144, v145
    v_accvgpr_read_b32 v151, a75
    v_exp_f32 v128, v80
    v_mfma_f32_16x16x32_bf16 v[24:27], a[240:243], v[112:115], v[20:23]
    buffer_store_dwordx4 v[136:139], v12, s[16:19], s56 offen offset:0 nt
    s_nop 0
    ds_read_b128 v[136:139], v13 offset:6144
    v_cvt_pk_bf16_f32 v118, v132, v133
    v_pk_mul_f32 v[150:151], v[150:151], v[158:159] op_sel_hi:[1,0]
    v_cvt_pk_bf16_f32 v237, v238, v239
    v_cvt_pk_bf16_f32 v145, v146, v147
    v_cvt_pk_bf16_f32 v205, v206, v207
    v_cvt_pk_bf16_f32 v149, v150, v151
    v_mfma_f32_16x16x32_bf16 a[20:23], a[212:215], v[104:107], 0
    ds_write2st64_b64 v15, v[144:145], v[148:149] offset0:28 offset1:40
    v_accvgpr_read_b32 v151, a79
    v_accvgpr_read_b32 v147, a31
    v_accvgpr_read_b32 v150, a78
    v_accvgpr_read_b32 v144, a28
    v_accvgpr_read_b32 v146, a30
    v_accvgpr_read_b32 v148, a76
    v_pk_mul_f32 v[150:151], v[150:151], v[158:159] op_sel_hi:[1,0]
    v_accvgpr_read_b32 v145, a29
    v_pk_mul_f32 v[144:145], v[144:145], v[156:157] op_sel_hi:[1,0]
    v_accvgpr_read_b32 v149, a77
    v_pk_mul_f32 v[148:149], v[148:149], v[158:159] op_sel_hi:[1,0]
    v_pk_mul_f32 v[146:147], v[146:147], v[156:157] op_sel_hi:[1,0]
    v_cvt_pk_bf16_f32 v117, v130, v131
    v_cvt_pk_bf16_f32 v148, v148, v149
    v_cvt_pk_bf16_f32 v144, v144, v145
    v_cvt_pk_bf16_f32 v145, v146, v147
    v_cvt_pk_bf16_f32 v149, v150, v151
    v_mfma_f32_16x16x32_bf16 v[184:187], a[216:219], v[96:99], 0
    s_waitcnt lgkmcnt(2)
    ds_read_b64_tr_b16 a[232:233], v5 offset:2048
    ds_read_b64_tr_b16 a[236:237], v6 offset:2048
    buffer_load_dwordx4 v11, s[12:15], s58 offen nt lds
    v_mfma_f32_16x16x32_bf16 v[232:235], a[216:219], v[100:103], 0
    buffer_store_dwordx4 v[140:143], v12, s[16:19], s56 offen offset:3072 nt
    s_add_u32 s57, s24, 6016
    ds_write2st64_b64 v8, v[188:189], v[236:237] offset0:4 offset1:16
    v_accvgpr_read_b32 v151, a83
    v_exp_f32 v133, v85
    v_mfma_f32_16x16x32_bf16 a[24:27], a[216:219], v[104:107], 0
    s_add_u32 s59, s25, 6016
    ds_write2st64_b64 v8, v[144:145], v[148:149] offset0:28 offset1:40
    v_accvgpr_read_b32 v150, a82
    v_accvgpr_read_b32 v144, a32
    v_mfma_f32_16x16x32_bf16 v[188:191], a[220:223], v[96:99], 0
    s_add_u32 m0, s38, 6144
    ds_read_b128 v[140:143], v13 offset:7168
    v_accvgpr_read_b32 v148, a80
    v_exp_f32 v134, v86
    v_cvt_pk_bf16_f32 v197, v198, v199
    v_accvgpr_read_b32 v145, a33
    v_mfma_f32_16x16x32_bf16 v[236:239], a[220:223], v[100:103], 0
    s_waitcnt lgkmcnt(5)
    ds_read_b64_tr_b16 a[234:235], v5 offset:8192
    ds_read_b64_tr_b16 a[238:239], v6 offset:8192
    buffer_load_dwordx4 v10, s[12:15], s59 offen nt lds
    v_accvgpr_read_b32 v147, a35
    v_accvgpr_read_b32 v149, a81
    v_pk_mul_f32 v[148:149], v[148:149], v[158:159] op_sel_hi:[1,0]
    v_pk_mul_f32 v[150:151], v[150:151], v[158:159] op_sel_hi:[1,0]
    v_cvt_pk_bf16_f32 v148, v148, v149
    v_accvgpr_read_b32 v146, a34
    v_pk_mul_f32 v[146:147], v[146:147], v[156:157] op_sel_hi:[1,0]
    v_pk_mul_f32 v[144:145], v[144:145], v[156:157] op_sel_hi:[1,0]
    v_cvt_pk_bf16_f32 v149, v150, v151
    v_cvt_pk_bf16_f32 v144, v144, v145
    v_accvgpr_read_b32 v150, a86
    v_exp_f32 v129, v81
    v_mfma_f32_16x16x32_bf16 a[28:31], a[220:223], v[104:107], 0
    buffer_store_dwordx4 v[136:139], v12, s[16:19], s57 offen offset:0 nt
    s_add_u32 m0, s38, 7168
    ds_write2st64_b64 v14, v[192:193], v[240:241] offset0:8 offset1:20
    v_cvt_pk_bf16_f32 v145, v146, v147
    v_cvt_pk_bf16_f32 v201, v202, v203
    v_mfma_f32_16x16x32_bf16 v[192:195], a[224:227], v[96:99], 0
    ds_write2st64_b64 v14, v[144:145], v[148:149] offset0:32 offset1:44
    v_accvgpr_read_b32 v151, a87
    v_accvgpr_read_b32 v145, a37
    v_accvgpr_read_b32 v146, a38
    v_mfma_f32_16x16x32_bf16 v[240:243], a[224:227], v[100:103], 0
    s_waitcnt lgkmcnt(2)
    ds_read_b128 v[136:139], v13 offset:12288
    buffer_load_dwordx4 v11, s[12:15], s59 offen nt lds
    v_accvgpr_read_b32 v147, a39
    v_mfma_f32_16x16x32_bf16 a[32:35], a[224:227], v[104:107], 0
    ds_write2st64_b64 v0, v[196:197], v[244:245] offset0:8 offset1:20
    v_mfma_f32_16x16x32_bf16 v[196:199], a[228:231], v[96:99], 0
    buffer_store_dwordx4 v[140:143], v12, s[16:19], s57 offen offset:3072 nt
    s_add_u32 s56, s24, 12160
    s_add_u32 s58, s25, 12160
    ds_read_b128 v[140:143], v13 offset:13312
    v_accvgpr_read_b32 v149, a85
    v_accvgpr_read_b32 v148, a84
    v_accvgpr_read_b32 v144, a36
    v_pk_mul_f32 v[144:145], v[144:145], v[156:157] op_sel_hi:[1,0]
    v_pk_mul_f32 v[150:151], v[150:151], v[158:159] op_sel_hi:[1,0]
    v_pk_mul_f32 v[148:149], v[148:149], v[158:159] op_sel_hi:[1,0]
    v_exp_f32 v130, v82
    v_cvt_pk_bf16_f32 v144, v144, v145
    v_pk_mul_f32 v[146:147], v[146:147], v[156:157] op_sel_hi:[1,0]
    v_cvt_pk_bf16_f32 v148, v148, v149
    v_cvt_pk_bf16_f32 v149, v150, v151
    v_cvt_pk_bf16_f32 v145, v146, v147
    v_mfma_f32_16x16x32_bf16 v[244:247], a[228:231], v[100:103], 0
    s_add_u32 m0, s38, 12288
    ds_write2st64_b64 v0, v[144:145], v[148:149] offset0:32 offset1:44
    v_accvgpr_read_b32 v146, a42
    v_accvgpr_read_b32 v145, a41
    v_accvgpr_read_b32 v148, a88
    v_exp_f32 v132, v84
    v_accvgpr_read_b32 v149, a89
    v_accvgpr_read_b32 v144, a40
    v_pk_mul_f32 v[144:145], v[144:145], v[156:157] op_sel_hi:[1,0]
    v_accvgpr_read_b32 v151, a91
    v_cvt_pk_bf16_f32 v120, v128, v129
    v_accvgpr_read_b32 v147, a43
    v_pk_mul_f32 v[148:149], v[148:149], v[158:159] op_sel_hi:[1,0]
    v_accvgpr_read_b32 v150, a90
    v_pk_mul_f32 v[150:151], v[150:151], v[158:159] op_sel_hi:[1,0]
    v_cvt_pk_bf16_f32 v144, v144, v145
    v_pk_mul_f32 v[146:147], v[146:147], v[156:157] op_sel_hi:[1,0]
    v_cvt_pk_bf16_f32 v148, v148, v149
    v_cvt_pk_bf16_f32 v149, v150, v151
    v_cvt_pk_bf16_f32 v145, v146, v147
    v_mfma_f32_16x16x32_bf16 a[36:39], a[228:231], v[104:107], 0
    s_waitcnt lgkmcnt(1)
    buffer_load_dwordx4 v10, s[12:15], s58 offen nt lds
    ds_write2st64_b64 v15, v[200:201], v[248:249] offset0:8 offset1:20
    v_cvt_pk_bf16_f32 v123, v134, v135
    v_mfma_f32_16x16x32_bf16 v[200:203], a[232:235], v[96:99], 0
    s_add_u32 m0, s38, 13312
    ds_write2st64_b64 v15, v[144:145], v[148:149] offset0:32 offset1:44
    v_exp_f32 v131, v83
    v_mfma_f32_16x16x32_bf16 v[248:251], a[232:235], v[100:103], 0
    buffer_load_dwordx4 v11, s[12:15], s58 offen nt lds
    s_waitcnt vmcnt(16)
    ds_write2st64_b64 v8, v[204:205], v[252:253] offset0:8 offset1:20
    v_mfma_f32_16x16x32_bf16 a[40:43], a[232:235], v[104:107], 0
    s_barrier
    ds_read_b128 a[196:199], v2 offset:0
    ds_read_b128 a[192:195], v1 offset:0
    v_mfma_f32_16x16x32_bf16 v[204:207], a[236:239], v[96:99], 0
    ds_read_b128 a[200:203], v1 offset:1024
    v_cvt_pk_bf16_f32 v121, v130, v131
    v_mfma_f32_16x16x32_bf16 v[24:27], a[244:247], v[116:119], v[24:27]
    s_add_u32 m0, s22, 24576
    ds_read_b128 a[204:207], v2 offset:1024
    buffer_load_dwordx4 v9, s[8:11], s21 offen lds
    v_cvt_pk_bf16_f32 v122, v132, v133
    v_mfma_f32_16x16x32_bf16 v[252:255], a[236:239], v[100:103], 0
    buffer_store_dwordx4 v[136:139], v12, s[16:19], s56 offen offset:0 nt
    s_add_u32 s21, s21, 128
    s_add_u32 m0, s22, 25600
    ds_read_b128 a[208:211], v1 offset:2048
    v_accvgpr_read_b32 v148, a92
    v_accvgpr_read_b32 v149, a93
    v_mfma_f32_16x16x32_bf16 v[24:27], a[248:251], v[120:123], v[24:27]
    ds_read_b128 a[212:215], v2 offset:2048
    v_accvgpr_read_b32 v144, a44
    v_accvgpr_read_b32 v147, a47
    v_accvgpr_read_b32 v146, a46
    v_accvgpr_read_b32 v145, a45
    v_mfma_f32_16x16x32_bf16 a[44:47], a[236:239], v[104:107], 0
    buffer_store_dwordx4 v[140:143], v12, s[16:19], s56 offen offset:3072 nt
    s_nop 0
    ds_read_b128 v[140:143], v13 offset:19456
    v_cmp_lt_f32 vcc, s29, v24
    v_pk_mul_f32 v[146:147], v[146:147], v[156:157] op_sel_hi:[1,0]
    v_pk_mul_f32 v[144:145], v[144:145], v[156:157] op_sel_hi:[1,0]
    s_waitcnt lgkmcnt(5)
    s_nop 0
    v_mfma_f32_16x16x32_bf16 v[32:35], a[192:195], a[96:99], 0
    s_cbranch_vccnz L_rs_tr43d
L_ret_tr43d:
    ds_read_b128 a[232:235], v1 offset:8192
    v_mfma_f32_16x16x32_bf16 v[32:35], a[196:199], a[100:103], v[32:35]
    s_waitcnt lgkmcnt(4)
    ds_read_b128 v[136:139], v13 offset:18432
    buffer_load_dwordx4 v9, s[8:11], s21 offen lds
    v_mfma_f32_16x16x32_bf16 v[32:35], a[200:203], a[104:107], v[32:35]
    ds_read_b128 a[228:231], v2 offset:7168
    s_add_u32 s21, s21, 128
    v_mfma_f32_16x16x32_bf16 v[32:35], a[204:207], a[108:111], v[32:35]
    s_add_u32 m0, s22, 26624
    ds_read_b128 a[220:223], v2 offset:6144
    s_waitcnt lgkmcnt(6)
    v_mfma_f32_16x16x32_bf16 v[32:35], a[208:211], a[112:115], v[32:35]
    ds_read_b128 a[236:239], v2 offset:8192
    s_waitcnt lgkmcnt(6)
    v_mfma_f32_16x16x32_bf16 v[32:35], a[212:215], a[116:119], v[32:35]
    buffer_load_dwordx4 v9, s[8:11], s21 offen lds
    v_mfma_f32_16x16x32_bf16 v[40:43], a[192:195], a[120:123], 0
    s_add_u32 s21, s21, 12032
    ds_read_b128 a[216:219], v1 offset:6144
    v_add_u32 v13, 2048, v13
    v_mfma_f32_16x16x32_bf16 v[40:43], a[196:199], a[124:127], v[40:43]
    v_accvgpr_read_b32 v151, a95
    v_mfma_f32_16x16x32_bf16 v[40:43], a[200:203], a[128:131], v[40:43]
    s_add_u32 s56, s24, 18304
    s_add_u32 s58, s25, 18304
    ds_read_b128 a[224:227], v1 offset:7168
    v_mfma_f32_16x16x32_bf16 v[40:43], a[204:207], a[132:135], v[40:43]
    v_accvgpr_read_b32 v150, a94
    v_fma_f32 v35, v35, s28, v16
    v_mfma_f32_16x16x32_bf16 v[40:43], a[208:211], a[136:139], v[40:43]
    s_add_u32 m0, s38, 18432
    v_exp_f32 v131, v35
    v_mfma_f32_16x16x32_bf16 v[40:43], a[212:215], a[140:143], v[40:43]
    v_fma_f32 v34, v34, s28, v16
    v_cvt_pk_bf16_f32 v144, v144, v145
    v_mfma_f32_16x16x32_bf16 v[48:51], a[192:195], a[144:147], 0
    v_fma_f32 v33, v33, s28, v16
    v_cvt_pk_bf16_f32 v145, v146, v147
    v_mfma_f32_16x16x32_bf16 v[48:51], a[196:199], a[148:151], v[48:51]
    s_waitcnt lgkmcnt(3)
    buffer_load_dwordx4 v10, s[12:15], s58 offen nt lds
    v_mfma_f32_16x16x32_bf16 v[48:51], a[200:203], a[152:155], v[48:51]
    buffer_store_dwordx4 v[136:139], v12, s[16:19], s56 offen offset:0 nt
    v_fma_f32 v40, v40, s28, v17
    v_pk_mul_f32 v[148:149], v[148:149], v[158:159] op_sel_hi:[1,0]
    v_pk_mul_f32 v[150:151], v[150:151], v[158:159] op_sel_hi:[1,0]
    v_fma_f32 v32, v32, s28, v16
    v_fma_f32 v41, v41, s28, v17
    v_mfma_f32_16x16x32_bf16 v[48:51], a[204:207], a[156:159], v[48:51]
    s_add_u32 m0, s38, 19456
    v_exp_f32 v130, v34
    v_mfma_f32_16x16x32_bf16 v[48:51], a[208:211], a[160:163], v[48:51]
    buffer_load_dwordx4 v11, s[12:15], s58 offen nt lds
    v_mfma_f32_16x16x32_bf16 v[48:51], a[212:215], a[164:167], v[48:51]
    s_waitcnt vmcnt(21) lgkmcnt(0)
    v_exp_f32 v128, v32
    v_mfma_f32_16x16x32_bf16 v[36:39], a[216:219], a[96:99], 0
    s_barrier
    v_mfma_f32_16x16x32_bf16 v[36:39], a[220:223], a[100:103], v[36:39]
    v_exp_f32 v132, v40
    v_mfma_f32_16x16x32_bf16 v[36:39], a[224:227], a[104:107], v[36:39]
    v_exp_f32 v129, v33
    v_mfma_f32_16x16x32_bf16 v[36:39], a[228:231], a[108:111], v[36:39]
    s_add_u32 m0, s22, 0
    ds_read_b64_tr_b16 a[192:193], v3 offset:12288
    v_cvt_pk_bf16_f32 v96, v128, v129
    v_mfma_f32_16x16x32_bf16 v[36:39], a[232:235], a[112:115], v[36:39]
    buffer_load_dwordx4 v9, s[4:7], s20 offen lds
    ds_read_b64_tr_b16 a[194:195], v3 offset:18432
    v_mfma_f32_16x16x32_bf16 v[36:39], a[236:239], a[116:119], v[36:39]
    ds_read_b64_tr_b16 a[196:197], v4 offset:12288
    v_cvt_pk_bf16_f32 v148, v148, v149
    v_mfma_f32_16x16x32_bf16 v[44:47], a[216:219], a[120:123], 0
    ds_read_b64_tr_b16 a[198:199], v4 offset:18432
    v_mfma_f32_16x16x32_bf16 v[44:47], a[220:223], a[124:127], v[44:47]
    s_add_u32 s20, s20, 128
    v_exp_f32 v133, v41
    v_mfma_f32_16x16x32_bf16 v[44:47], a[224:227], a[128:131], v[44:47]
    s_add_u32 m0, s22, 1024
    ds_read_b64_tr_b16 a[200:201], v5 offset:12288
    v_cvt_pk_bf16_f32 v100, v132, v133
    v_mfma_f32_16x16x32_bf16 v[44:47], a[228:231], a[132:135], v[44:47]
    ds_read_b64_tr_b16 a[202:203], v5 offset:18432
    buffer_load_dwordx4 v9, s[4:7], s20 offen lds
    v_mfma_f32_16x16x32_bf16 v[44:47], a[232:235], a[136:139], v[44:47]
    ds_read_b64_tr_b16 a[204:205], v6 offset:12288
    v_mfma_f32_16x16x32_bf16 v[44:47], a[236:239], a[140:143], v[44:47]
    s_add_u32 s20, s20, 128
    ds_read_b64_tr_b16 a[206:207], v6 offset:18432
    v_cvt_pk_bf16_f32 v149, v150, v151
    v_mfma_f32_16x16x32_bf16 v[52:55], a[216:219], a[144:147], 0
    buffer_store_dwordx4 v[140:143], v12, s[16:19], s56 offen offset:3072 nt
    ds_write2st64_b64 v8, v[144:145], v[148:149] offset0:32 offset1:44
    v_mfma_f32_16x16x32_bf16 v[52:55], a[220:223], a[148:151], v[52:55]
    ds_read_b64_tr_b16 a[208:209], v3 offset:13312
    v_mfma_f32_16x16x32_bf16 v[52:55], a[224:227], a[152:155], v[52:55]
    ds_read_b64_tr_b16 a[210:211], v3 offset:19456
    v_cvt_pk_bf16_f32 v97, v130, v131
    v_mfma_f32_16x16x32_bf16 v[52:55], a[228:231], a[156:159], v[52:55]
    s_add_u32 m0, s22, 2048
    ds_read_b64_tr_b16 a[212:213], v4 offset:13312
    v_mfma_f32_16x16x32_bf16 v[52:55], a[232:235], a[160:163], v[52:55]
    buffer_load_dwordx4 v9, s[4:7], s20 offen lds
    v_mfma_f32_16x16x32_bf16 v[52:55], a[236:239], a[164:167], v[52:55]
    s_add_u32 s20, s20, 12032
    ds_read_b64_tr_b16 a[214:215], v4 offset:19456
    s_branch L_loop3
L_tr44:
    s_waitcnt lgkmcnt(10)
    v_mfma_f32_16x16x32_bf16 v[160:163], a[192:195], v[112:115], v[160:163]
    ds_read_b128 v[136:139], v13 offset:0
    v_fma_f32 v43, v43, s28, v17
    v_mfma_f32_16x16x32_bf16 v[208:211], a[192:195], v[116:119], v[208:211]
    ds_read_b64_tr_b16 a[218:219], v5 offset:19456
    v_fma_f32 v39, v39, s28, v16
    v_mfma_f32_16x16x32_bf16 a[0:3], a[192:195], v[120:123], a[0:3]
    ds_read_b64_tr_b16 a[236:237], v6 offset:14336
    v_fma_f32 v49, v49, s28, v18
    v_fma_f32 v44, v44, s28, v17
    v_fma_f32 v36, v36, s28, v16
    v_mfma_f32_16x16x32_bf16 a[48:51], a[192:195], v[124:127], a[48:51]
    s_waitcnt lgkmcnt(11)
    ds_read_b64_tr_b16 a[230:231], v4 offset:20480
    v_fma_f32 v58, v58, s28, v19
    v_mfma_f32_16x16x32_bf16 v[164:167], a[196:199], v[112:115], v[164:167]
    ds_read_b64_tr_b16 a[226:227], v3 offset:20480
    v_fma_f32 v42, v42, s28, v17
    v_mfma_f32_16x16x32_bf16 v[212:215], a[196:199], v[116:119], v[212:215]
    ds_read_b64_tr_b16 a[222:223], v6 offset:19456
    v_fma_f32 v48, v48, s28, v18
    v_mfma_f32_16x16x32_bf16 a[4:7], a[196:199], v[120:123], a[4:7]
    ds_read_b64_tr_b16 a[232:233], v5 offset:14336
    v_fma_f32 v46, v46, s28, v17
    v_mfma_f32_16x16x32_bf16 a[52:55], a[196:199], v[124:127], a[52:55]
    s_waitcnt lgkmcnt(12)
    ds_read_b64_tr_b16 a[216:217], v5 offset:13312
    v_fma_f32 v62, v62, s28, v19
    v_mfma_f32_16x16x32_bf16 v[168:171], a[200:203], v[112:115], v[168:171]
    ds_read_b64_tr_b16 a[238:239], v6 offset:20480
    v_fma_f32 v37, v37, s28, v16
    v_mfma_f32_16x16x32_bf16 v[216:219], a[200:203], v[116:119], v[216:219]
    v_exp_f32 v134, v36
    v_mfma_f32_16x16x32_bf16 a[8:11], a[200:203], v[120:123], a[8:11]
    v_exp_f32 v132, v44
    v_mfma_f32_16x16x32_bf16 a[56:59], a[200:203], v[124:127], a[56:59]
    s_waitcnt lgkmcnt(7)
    ds_read_b64_tr_b16 a[234:235], v5 offset:20480
    v_fma_f32 v54, v54, s28, v18
    v_mfma_f32_16x16x32_bf16 v[172:175], a[204:207], v[112:115], v[172:175]
    ds_read_b64_tr_b16 a[224:225], v3 offset:14336
    v_fma_f32 v51, v51, s28, v18
    v_mfma_f32_16x16x32_bf16 v[220:223], a[204:207], v[116:119], v[220:223]
    v_fma_f32 v52, v52, s28, v18
    v_fma_f32 v47, v47, s28, v17
    v_mfma_f32_16x16x32_bf16 a[12:15], a[204:207], v[120:123], a[12:15]
    ds_read_b64_tr_b16 a[220:221], v6 offset:13312
    v_fma_f32 v61, v61, s28, v19
    v_mfma_f32_16x16x32_bf16 a[60:63], a[204:207], v[124:127], a[60:63]
    ds_read_b64_tr_b16 a[228:229], v4 offset:14336
    v_fma_f32 v38, v38, s28, v16
    v_mfma_f32_16x16x32_bf16 v[176:179], a[208:211], v[112:115], v[176:179]
    v_exp_f32 v135, v37
    v_mfma_f32_16x16x32_bf16 v[224:227], a[208:211], v[116:119], v[224:227]
    v_cvt_pk_bf16_f32 v98, v134, v135
    v_fma_f32 v45, v45, s28, v17
    v_mfma_f32_16x16x32_bf16 a[16:19], a[208:211], v[120:123], a[16:19]
    v_exp_f32 v134, v46
    v_mfma_f32_16x16x32_bf16 a[64:67], a[208:211], v[124:127], a[64:67]
    v_exp_f32 v128, v38
    v_mfma_f32_16x16x32_bf16 v[180:183], a[212:215], v[112:115], v[180:183]
    v_exp_f32 v130, v42
    v_mfma_f32_16x16x32_bf16 v[228:231], a[212:215], v[116:119], v[228:231]
    v_exp_f32 v135, v47
    v_mfma_f32_16x16x32_bf16 a[20:23], a[212:215], v[120:123], a[20:23]
    v_exp_f32 v129, v39
    v_mfma_f32_16x16x32_bf16 a[68:71], a[212:215], v[124:127], a[68:71]
    s_waitcnt lgkmcnt(2)
    v_cvt_pk_bf16_f32 v99, v128, v129
    v_exp_f32 v131, v43
    v_mfma_f32_16x16x32_bf16 v[184:187], a[216:219], v[112:115], v[184:187]
    v_cvt_pk_bf16_f32 v101, v130, v131
    v_cvt_pk_bf16_f32 v103, v134, v135
    v_mfma_f32_16x16x32_bf16 v[20:23], a[240:243], v[96:99], v[24:27]
    v_exp_f32 v133, v45
    v_mfma_f32_16x16x32_bf16 v[232:235], a[216:219], v[116:119], v[232:235]
    s_waitcnt vmcnt(10) lgkmcnt(0)
    v_cvt_pk_bf16_f32 v102, v132, v133
    v_fma_f32 v55, v55, s28, v18
    v_mfma_f32_16x16x32_bf16 a[24:27], a[216:219], v[120:123], a[24:27]
    v_exp_f32 v128, v48
    v_mfma_f32_16x16x32_bf16 v[20:23], a[244:247], v[100:103], v[20:23]
    s_barrier
    v_mfma_f32_16x16x32_bf16 a[72:75], a[216:219], v[124:127], a[72:75]
    s_add_u32 m0, s22, 36864
    v_exp_f32 v129, v49
    v_mfma_f32_16x16x32_bf16 v[188:191], a[220:223], v[112:115], v[188:191]
    v_exp_f32 v134, v54
    v_mfma_f32_16x16x32_bf16 v[236:239], a[220:223], v[116:119], v[236:239]
    v_cvt_pk_bf16_f32 v104, v128, v129
    v_fma_f32 v53, v53, s28, v18
    v_mfma_f32_16x16x32_bf16 a[28:31], a[220:223], v[120:123], a[28:31]
    ds_read_b128 a[192:195], v1 offset:12288
    v_fma_f32 v50, v50, s28, v18
    v_mfma_f32_16x16x32_bf16 a[76:79], a[220:223], v[124:127], a[76:79]
    buffer_load_dwordx4 v9, s[8:11], s21 offen lds
    v_mfma_f32_16x16x32_bf16 v[192:195], a[224:227], v[112:115], v[192:195]
    ds_read_b128 a[200:203], v1 offset:13312
    v_mfma_f32_16x16x32_bf16 v[240:243], a[224:227], v[116:119], v[240:243]
    ds_read_b128 v[140:143], v13 offset:1024
    v_fma_f32 v60, v60, s28, v19
    v_mfma_f32_16x16x32_bf16 a[32:35], a[224:227], v[120:123], a[32:35]
    s_add_u32 s21, s21, 128
    ds_read_b128 a[208:211], v1 offset:14336
    s_add_u32 m0, s22, 37888
    v_mfma_f32_16x16x32_bf16 a[80:83], a[224:227], v[124:127], a[80:83]
    ds_read_b128 a[204:207], v2 offset:13312
    v_fma_f32 v59, v59, s28, v19
    v_mfma_f32_16x16x32_bf16 v[196:199], a[228:231], v[112:115], v[196:199]
    buffer_load_dwordx4 v9, s[8:11], s21 offen lds
    v_mfma_f32_16x16x32_bf16 v[244:247], a[228:231], v[116:119], v[244:247]
    buffer_store_dwordx4 v[136:139], v12, s[16:19], s24 offen offset:0 nt
    ds_read_b128 a[196:199], v2 offset:12288
    s_add_u32 s21, s21, 128
    s_add_u32 m0, s22, 38912
    v_mfma_f32_16x16x32_bf16 a[36:39], a[228:231], v[120:123], a[36:39]
    v_exp_f32 v135, v55
    v_mfma_f32_16x16x32_bf16 a[84:87], a[228:231], v[124:127], a[84:87]
    v_exp_f32 v130, v50
    v_mfma_f32_16x16x32_bf16 v[200:203], a[232:235], v[112:115], v[200:203]
    buffer_load_dwordx4 v9, s[8:11], s21 offen lds
    v_mfma_f32_16x16x32_bf16 v[248:251], a[232:235], v[116:119], v[248:251]
    v_fma_f32 v56, v56, s28, v19
    v_fma_f32 v57, v57, s28, v19
    v_mfma_f32_16x16x32_bf16 a[40:43], a[232:235], v[120:123], a[40:43]
    s_add_u32 s21, s21, 12032
    v_exp_f32 v132, v52
    v_mfma_f32_16x16x32_bf16 a[88:91], a[232:235], v[124:127], a[88:91]
    s_add_u32 m0, s38, 20480
    v_exp_f32 v131, v51
    v_mfma_f32_16x16x32_bf16 v[204:207], a[236:239], v[112:115], v[204:207]
    ds_read_b128 a[212:215], v2 offset:14336
    v_fma_f32 v63, v63, s28, v19
    v_mfma_f32_16x16x32_bf16 v[252:255], a[236:239], v[116:119], v[252:255]
    v_exp_f32 v129, v57
    v_mfma_f32_16x16x32_bf16 a[44:47], a[236:239], v[120:123], a[44:47]
    buffer_load_dwordx4 v10, s[12:15], s25 offen nt lds
    v_mfma_f32_16x16x32_bf16 a[92:95], a[236:239], v[124:127], a[92:95]
    s_waitcnt lgkmcnt(1)
    ds_read_b128 a[220:223], v2 offset:18432
    v_mfma_f32_16x16x32_bf16 v[64:67], a[192:195], a[96:99], 0
    v_exp_f32 v133, v53
    v_mfma_f32_16x16x32_bf16 v[64:67], a[196:199], a[100:103], v[64:67]
    ds_read_b128 v[136:139], v13 offset:2048
    v_cvt_pk_bf16_f32 v106, v132, v133
    v_mfma_f32_16x16x32_bf16 v[64:67], a[200:203], a[104:107], v[64:67]
    v_cvt_pk_bf16_f32 v107, v134, v135
    v_cvt_pk_bf16_f32 v105, v130, v131
    v_mfma_f32_16x16x32_bf16 v[64:67], a[204:207], a[108:111], v[64:67]
    buffer_store_dwordx4 v[140:143], v12, s[16:19], s24 offen offset:3072 nt
    s_add_u32 m0, s38, 21504
    ds_read_b128 a[224:227], v1 offset:19456
    v_exp_f32 v132, v60
    v_mfma_f32_16x16x32_bf16 v[64:67], a[208:211], a[112:115], v[64:67]
    ds_read_b128 a[236:239], v2 offset:20480
    s_waitcnt lgkmcnt(4)
    v_mfma_f32_16x16x32_bf16 v[64:67], a[212:215], a[116:119], v[64:67]
    buffer_load_dwordx4 v11, s[12:15], s25 offen nt lds
    v_mfma_f32_16x16x32_bf16 v[72:75], a[192:195], a[120:123], 0
    s_add_u32 s57, s24, 128
    ds_read_b128 v[140:143], v13 offset:3072
    s_add_u32 s59, s25, 128
    v_mfma_f32_16x16x32_bf16 v[72:75], a[196:199], a[124:127], v[72:75]
    v_exp_f32 v128, v56
    v_mfma_f32_16x16x32_bf16 v[72:75], a[200:203], a[128:131], v[72:75]
    ds_read_b128 a[216:219], v1 offset:18432
    s_add_u32 m0, s38, 22528
    v_mfma_f32_16x16x32_bf16 v[72:75], a[204:207], a[132:135], v[72:75]
    v_exp_f32 v134, v62
    v_mfma_f32_16x16x32_bf16 v[72:75], a[208:211], a[136:139], v[72:75]
    ds_read_b128 a[232:235], v1 offset:20480
    v_mfma_f32_16x16x32_bf16 v[72:75], a[212:215], a[140:143], v[72:75]
    ds_read_b128 a[228:231], v2 offset:19456
    v_mfma_f32_16x16x32_bf16 v[80:83], a[192:195], a[144:147], 0
    v_exp_f32 v135, v63
    v_mfma_f32_16x16x32_bf16 v[80:83], a[196:199], a[148:151], v[80:83]
    v_exp_f32 v131, v59
    v_mfma_f32_16x16x32_bf16 v[20:23], a[248:251], v[104:107], v[20:23]
    v_exp_f32 v130, v58
    v_mfma_f32_16x16x32_bf16 v[80:83], a[200:203], a[152:155], v[80:83]
    v_exp_f32 v133, v61
    v_mfma_f32_16x16x32_bf16 v[80:83], a[204:207], a[156:159], v[80:83]
    v_cvt_pk_bf16_f32 v108, v128, v129
    v_cvt_pk_bf16_f32 v110, v132, v133
    v_mfma_f32_16x16x32_bf16 v[80:83], a[208:211], a[160:163], v[80:83]
    v_mfma_f32_16x16x32_bf16 v[80:83], a[212:215], a[164:167], v[80:83]
    v_cvt_pk_bf16_f32 v109, v130, v131
    v_cvt_pk_bf16_f32 v111, v134, v135
    v_mfma_f32_16x16x32_bf16 v[88:91], a[192:195], a[168:171], 0
    s_waitcnt lgkmcnt(2)
    buffer_load_dwordx4 v10, s[12:15], s59 offen nt lds
    v_mfma_f32_16x16x32_bf16 v[20:23], a[252:255], v[108:111], v[20:23]
    s_add_u32 m0, s38, 23552
    v_mfma_f32_16x16x32_bf16 v[88:91], a[196:199], a[172:175], v[88:91]
    buffer_load_dwordx4 v11, s[12:15], s59 offen nt lds
    v_mfma_f32_16x16x32_bf16 v[88:91], a[200:203], a[176:179], v[88:91]
    buffer_store_dwordx4 v[136:139], v12, s[16:19], s57 offen offset:0 nt
    s_nop 2
    v_cmp_lt_f32 vcc, s29, v20
    s_waitcnt vmcnt(13) lgkmcnt(0)
    v_mfma_f32_16x16x32_bf16 v[88:91], a[204:207], a[180:183], v[88:91]
    v_mfma_f32_16x16x32_bf16 v[88:91], a[208:211], a[184:187], v[88:91]
    s_barrier
    v_mfma_f32_16x16x32_bf16 v[88:91], a[212:215], a[188:191], v[88:91]
    ds_read_b64_tr_b16 a[192:193], v3 offset:0
    v_mfma_f32_16x16x32_bf16 v[68:71], a[216:219], a[96:99], 0
    s_cbranch_vccnz L_rs_tr44a
L_ret_tr44a:
    s_add_u32 m0, s22, 12288
    v_mfma_f32_16x16x32_bf16 v[68:71], a[220:223], a[100:103], v[68:71]
    v_fma_f32 v66, v66, s28, v16
    v_fma_f32 v67, v67, s28, v16
    v_mfma_f32_16x16x32_bf16 v[68:71], a[224:227], a[104:107], v[68:71]
    ds_read_b64_tr_b16 a[194:195], v3 offset:6144
    v_mfma_f32_16x16x32_bf16 v[68:71], a[228:231], a[108:111], v[68:71]
    v_exp_f32 v130, v66
    v_mfma_f32_16x16x32_bf16 v[68:71], a[232:235], a[112:115], v[68:71]
    ds_read_b64_tr_b16 a[196:197], v4 offset:0
    v_fma_f32 v73, v73, s28, v17
    v_mfma_f32_16x16x32_bf16 v[68:71], a[236:239], a[116:119], v[68:71]
    v_exp_f32 v133, v73
    v_mfma_f32_16x16x32_bf16 v[76:79], a[216:219], a[120:123], 0
    buffer_load_dwordx4 v9, s[4:7], s20 offen lds
    v_mfma_f32_16x16x32_bf16 v[76:79], a[220:223], a[124:127], v[76:79]
    v_fma_f32 v64, v64, s28, v16
    v_fma_f32 v72, v72, s28, v17
    v_mfma_f32_16x16x32_bf16 v[76:79], a[224:227], a[128:131], v[76:79]
    ds_read_b64_tr_b16 a[198:199], v4 offset:6144
    v_mfma_f32_16x16x32_bf16 v[76:79], a[228:231], a[132:135], v[76:79]
    ds_read_b64_tr_b16 a[200:201], v5 offset:0
    v_fma_f32 v65, v65, s28, v16
    v_mfma_f32_16x16x32_bf16 v[76:79], a[232:235], a[136:139], v[76:79]
    v_exp_f32 v128, v64
    v_mfma_f32_16x16x32_bf16 v[76:79], a[236:239], a[140:143], v[76:79]
    buffer_store_dwordx4 v[140:143], v12, s[16:19], s57 offen offset:3072 nt
    v_exp_f32 v129, v65
    s_add_u32 s20, s20, 128
    v_mfma_f32_16x16x32_bf16 v[84:87], a[216:219], a[144:147], 0
    ds_read_b64_tr_b16 a[202:203], v5 offset:6144
    v_mfma_f32_16x16x32_bf16 v[84:87], a[220:223], a[148:151], v[84:87]
    s_add_u32 m0, s22, 13312
    ds_read_b64_tr_b16 a[204:205], v6 offset:0
    v_cvt_pk_bf16_f32 v112, v128, v129
    v_mfma_f32_16x16x32_bf16 v[84:87], a[224:227], a[152:155], v[84:87]
    buffer_load_dwordx4 v9, s[4:7], s20 offen lds
    v_mfma_f32_16x16x32_bf16 v[84:87], a[228:231], a[156:159], v[84:87]
    v_exp_f32 v131, v67
    v_mfma_f32_16x16x32_bf16 v[84:87], a[232:235], a[160:163], v[84:87]
    ds_read_b64_tr_b16 a[206:207], v6 offset:6144
    v_mfma_f32_16x16x32_bf16 v[84:87], a[236:239], a[164:167], v[84:87]
    s_add_u32 s20, s20, 128
    ds_read_b64_tr_b16 a[208:209], v3 offset:1024
    v_mfma_f32_16x16x32_bf16 v[92:95], a[216:219], a[168:171], 0
    s_add_u32 m0, s22, 14336
    v_cvt_pk_bf16_f32 v113, v130, v131
    v_mfma_f32_16x16x32_bf16 v[92:95], a[220:223], a[172:175], v[92:95]
    v_exp_f32 v132, v72
    v_mfma_f32_16x16x32_bf16 v[92:95], a[224:227], a[176:179], v[92:95]
    buffer_load_dwordx4 v9, s[4:7], s20 offen lds
    v_mfma_f32_16x16x32_bf16 v[92:95], a[228:231], a[180:183], v[92:95]
    ds_read_b64_tr_b16 a[210:211], v3 offset:7168
    v_mfma_f32_16x16x32_bf16 v[92:95], a[232:235], a[184:187], v[92:95]
    ds_read_b64_tr_b16 a[212:213], v4 offset:1024
    v_cvt_pk_bf16_f32 v116, v132, v133
    v_mfma_f32_16x16x32_bf16 v[92:95], a[236:239], a[188:191], v[92:95]
    s_add_u32 s20, s20, 12032
    ds_read_b64_tr_b16 a[214:215], v4 offset:7168
    s_waitcnt lgkmcnt(10)
    v_mfma_f32_16x16x32_bf16 v[160:163], a[192:195], v[96:99], v[160:163]
    ds_read_b64_tr_b16 a[224:225], v3 offset:2048
    v_fma_f32 v71, v71, s28, v16
    v_mfma_f32_16x16x32_bf16 v[208:211], a[192:195], v[100:103], v[208:211]
    ds_read_b64_tr_b16 a[230:231], v4 offset:8192
    v_xor_b32 v8, 64, v7
    v_mfma_f32_16x16x32_bf16 a[0:3], a[192:195], v[104:107], a[0:3]
    ds_read_b64_tr_b16 a[220:221], v6 offset:1024
    v_fma_f32 v76, v76, s28, v17
    v_mfma_f32_16x16x32_bf16 a[48:51], a[192:195], v[108:111], a[48:51]
    ds_read_b128 a[108:111], v8 offset:2048
    s_waitcnt lgkmcnt(12)
    v_mfma_f32_16x16x32_bf16 v[164:167], a[196:199], v[96:99], v[164:167]
    ds_read_b64_tr_b16 a[216:217], v5 offset:1024
    v_fma_f32 v70, v70, s28, v16
    v_mfma_f32_16x16x32_bf16 v[212:215], a[196:199], v[100:103], v[212:215]
    ds_read_b128 a[144:147], v7 offset:12288
    v_exp_f32 v132, v76
    v_mfma_f32_16x16x32_bf16 a[4:7], a[196:199], v[104:107], a[4:7]
    ds_read_b64_tr_b16 a[226:227], v3 offset:8192
    v_fma_f32 v95, v95, s28, v19
    v_mfma_f32_16x16x32_bf16 a[52:55], a[196:199], v[108:111], a[52:55]
    s_waitcnt lgkmcnt(13)
    ds_read_b64_tr_b16 a[232:233], v5 offset:2048
    v_fma_f32 v85, v85, s28, v18
    v_mfma_f32_16x16x32_bf16 v[168:171], a[200:203], v[96:99], v[168:171]
    ds_read_b64_tr_b16 a[234:235], v5 offset:8192
    v_exp_f32 v129, v71
    v_mfma_f32_16x16x32_bf16 v[216:219], a[200:203], v[100:103], v[216:219]
    ds_read_b128 a[124:127], v8 offset:6144
    v_fma_f32 v68, v68, s28, v16
    v_mfma_f32_16x16x32_bf16 a[8:11], a[200:203], v[104:107], a[8:11]
    ds_read_b128 a[132:135], v8 offset:8192
    v_fma_f32 v88, v88, s28, v19
    v_mfma_f32_16x16x32_bf16 a[56:59], a[200:203], v[108:111], a[56:59]
    s_waitcnt lgkmcnt(9)
    ds_read_b64_tr_b16 a[222:223], v6 offset:7168
    v_fma_f32 v69, v69, s28, v16
    v_mfma_f32_16x16x32_bf16 v[172:175], a[204:207], v[96:99], v[172:175]
    ds_read_b64_tr_b16 a[228:229], v4 offset:2048
    v_fma_f32 v75, v75, s28, v17
    v_mfma_f32_16x16x32_bf16 v[220:223], a[204:207], v[100:103], v[220:223]
    ds_read_b64_tr_b16 a[238:239], v6 offset:8192
    v_fma_f32 v77, v77, s28, v17
    v_mfma_f32_16x16x32_bf16 a[12:15], a[204:207], v[104:107], a[12:15]
    ds_read_b64_tr_b16 a[218:219], v5 offset:7168
    v_fma_f32 v74, v74, s28, v17
    v_mfma_f32_16x16x32_bf16 a[60:63], a[204:207], v[108:111], a[60:63]
    v_exp_f32 v128, v70
    v_mfma_f32_16x16x32_bf16 v[176:179], a[208:211], v[96:99], v[176:179]
    ds_read_b64_tr_b16 a[236:237], v6 offset:2048
    v_exp_f32 v134, v68
    v_mfma_f32_16x16x32_bf16 v[224:227], a[208:211], v[100:103], v[224:227]
    v_exp_f32 v133, v77
    v_mfma_f32_16x16x32_bf16 a[16:19], a[208:211], v[104:107], a[16:19]
    ds_read_b128 a[112:115], v7 offset:4096
    v_fma_f32 v84, v84, s28, v18
    v_mfma_f32_16x16x32_bf16 a[64:67], a[208:211], v[108:111], a[64:67]
    v_exp_f32 v135, v69
    v_mfma_f32_16x16x32_bf16 v[180:183], a[212:215], v[96:99], v[180:183]
    ds_read_b128 a[104:107], v7 offset:2048
    v_cvt_pk_bf16_f32 v115, v128, v129
    v_mfma_f32_16x16x32_bf16 v[228:231], a[212:215], v[100:103], v[228:231]
    ds_read_b128 a[140:143], v8 offset:10240
    v_cvt_pk_bf16_f32 v114, v134, v135
    v_mfma_f32_16x16x32_bf16 a[20:23], a[212:215], v[104:107], a[20:23]
    ds_read_b128 a[100:103], v8 offset:0
    v_fma_f32 v78, v78, s28, v17
    v_mfma_f32_16x16x32_bf16 v[24:27], a[240:243], v[112:115], v[20:23]
    ds_read_b128 a[148:151], v8 offset:12288
    v_fma_f32 v89, v89, s28, v19
    v_mfma_f32_16x16x32_bf16 a[68:71], a[212:215], v[108:111], a[68:71]
    s_waitcnt lgkmcnt(6)
    ds_read_b128 a[152:155], v7 offset:14336
    v_cvt_pk_bf16_f32 v118, v132, v133
    v_mfma_f32_16x16x32_bf16 v[184:187], a[216:219], v[96:99], v[184:187]
    ds_read_b128 a[96:99], v7 offset:0
    v_fma_f32 v93, v93, s28, v19
    v_mfma_f32_16x16x32_bf16 v[232:235], a[216:219], v[100:103], v[232:235]
    s_waitcnt vmcnt(14) lgkmcnt(7)
    ds_read_b128 a[156:159], v8 offset:14336
    v_fma_f32 v81, v81, s28, v18
    v_mfma_f32_16x16x32_bf16 a[24:27], a[216:219], v[104:107], a[24:27]
    v_exp_f32 v131, v75
    v_mfma_f32_16x16x32_bf16 a[72:75], a[216:219], v[108:111], a[72:75]
    s_barrier
    v_mfma_f32_16x16x32_bf16 v[188:191], a[220:223], v[96:99], v[188:191]
    s_add_u32 m0, s22, 24576
    ds_read_b128 a[192:195], v1 offset:0
    v_mfma_f32_16x16x32_bf16 v[236:239], a[220:223], v[100:103], v[236:239]
    v_exp_f32 v132, v84
    v_mfma_f32_16x16x32_bf16 a[28:31], a[220:223], v[104:107], a[28:31]
    ds_read_b128 a[216:219], v1 offset:6144
    buffer_load_dwordx4 v9, s[8:11], s21 offen lds
    v_mfma_f32_16x16x32_bf16 a[76:79], a[220:223], v[108:111], a[76:79]
    v_exp_f32 v134, v78
    v_mfma_f32_16x16x32_bf16 v[192:195], a[224:227], v[96:99], v[192:195]
    ds_read_b128 a[204:207], v2 offset:1024
    v_fma_f32 v83, v83, s28, v18
    v_mfma_f32_16x16x32_bf16 v[240:243], a[224:227], v[100:103], v[240:243]
    ds_read_b128 a[208:211], v1 offset:2048
    v_mfma_f32_16x16x32_bf16 a[32:35], a[224:227], v[104:107], a[32:35]
    s_add_u32 s21, s21, 128
    s_add_u32 m0, s22, 25600
    ds_read_b128 a[136:139], v7 offset:10240
    v_mfma_f32_16x16x32_bf16 a[80:83], a[224:227], v[108:111], a[80:83]
    v_exp_f32 v130, v74
    v_mfma_f32_16x16x32_bf16 v[196:199], a[228:231], v[96:99], v[196:199]
    buffer_load_dwordx4 v9, s[8:11], s21 offen lds
    v_mfma_f32_16x16x32_bf16 v[244:247], a[228:231], v[100:103], v[244:247]
    ds_read_b128 a[200:203], v1 offset:1024
    v_fma_f32 v86, v86, s28, v18
    v_mfma_f32_16x16x32_bf16 a[36:39], a[228:231], v[104:107], a[36:39]
    s_add_u32 s21, s21, 128
    ds_read_b128 a[116:119], v8 offset:4096
    v_mfma_f32_16x16x32_bf16 a[84:87], a[228:231], v[108:111], a[84:87]
    s_add_u32 m0, s22, 26624
    ds_read_b128 a[196:199], v2 offset:0
    v_mfma_f32_16x16x32_bf16 v[200:203], a[232:235], v[96:99], v[200:203]
    ds_read_b128 a[160:163], v7 offset:16384
    v_fma_f32 v79, v79, s28, v17
    v_mfma_f32_16x16x32_bf16 v[248:251], a[232:235], v[100:103], v[248:251]
    buffer_load_dwordx4 v9, s[8:11], s21 offen lds
    v_mfma_f32_16x16x32_bf16 a[40:43], a[232:235], v[104:107], a[40:43]
    s_add_u32 s21, s21, 12032
    ds_read_b128 a[212:215], v2 offset:2048
    v_cvt_pk_bf16_f32 v117, v130, v131
    v_mfma_f32_16x16x32_bf16 a[88:91], a[232:235], v[108:111], a[88:91]
    v_exp_f32 v135, v79
    v_mfma_f32_16x16x32_bf16 v[204:207], a[236:239], v[96:99], v[204:207]
    ds_read_b128 a[120:123], v7 offset:6144
    v_fma_f32 v94, v94, s28, v19
    v_mfma_f32_16x16x32_bf16 v[252:255], a[236:239], v[100:103], v[252:255]
    ds_read_b128 a[220:223], v2 offset:6144
    v_cvt_pk_bf16_f32 v119, v134, v135
    v_mfma_f32_16x16x32_bf16 a[44:47], a[236:239], v[104:107], a[44:47]
    s_waitcnt vmcnt(8)
    ds_read_b128 a[128:131], v7 offset:8192
    v_fma_f32 v90, v90, s28, v19
    v_mfma_f32_16x16x32_bf16 a[92:95], a[236:239], v[108:111], a[92:95]
    s_waitcnt lgkmcnt(7)
    ds_read_b128 a[180:183], v8 offset:20480
    v_fma_f32 v92, v92, s28, v19
    v_mfma_f32_16x16x32_bf16 v[32:35], a[192:195], a[96:99], 0
    v_exp_f32 v131, v83
    v_mfma_f32_16x16x32_bf16 v[24:27], a[244:247], v[116:119], v[24:27]
    s_waitcnt lgkmcnt(6)
    v_exp_f32 v133, v85
    v_mfma_f32_16x16x32_bf16 v[32:35], a[196:199], a[100:103], v[32:35]
    ds_read_b128 a[172:175], v8 offset:18432
    v_fma_f32 v91, v91, s28, v19
    v_mfma_f32_16x16x32_bf16 v[32:35], a[200:203], a[104:107], v[32:35]
    ds_read_b128 a[168:171], v7 offset:18432
    v_mfma_f32_16x16x32_bf16 v[32:35], a[204:207], a[108:111], v[32:35]
    ds_read_b128 a[228:231], v2 offset:7168
    v_fma_f32 v82, v82, s28, v18
    v_mfma_f32_16x16x32_bf16 v[32:35], a[208:211], a[112:115], v[32:35]
    s_waitcnt lgkmcnt(7)
    ds_read_b128 a[236:239], v2 offset:8192
    v_mfma_f32_16x16x32_bf16 v[32:35], a[212:215], a[116:119], v[32:35]
    s_waitcnt lgkmcnt(7)
    ds_read_b128 a[164:167], v8 offset:16384
    v_mfma_f32_16x16x32_bf16 v[40:43], a[192:195], a[120:123], 0
    ds_read_b128 a[176:179], v7 offset:20480
    v_mfma_f32_16x16x32_bf16 v[40:43], a[196:199], a[124:127], v[40:43]
    s_waitcnt lgkmcnt(7)
    ds_read_b128 a[184:187], v7 offset:22528
    v_mfma_f32_16x16x32_bf16 v[40:43], a[200:203], a[128:131], v[40:43]
    ds_read_b128 a[224:227], v1 offset:7168
    v_fma_f32 v80, v80, s28, v18
    v_mfma_f32_16x16x32_bf16 v[40:43], a[204:207], a[132:135], v[40:43]
    v_exp_f32 v129, v81
    v_mfma_f32_16x16x32_bf16 v[40:43], a[208:211], a[136:139], v[40:43]
    ds_read_b128 a[232:235], v1 offset:8192
    v_cvt_pk_bf16_f32 v122, v132, v133
    v_mfma_f32_16x16x32_bf16 v[40:43], a[212:215], a[140:143], v[40:43]
    ds_read_b128 a[188:191], v8 offset:22528
    v_mfma_f32_16x16x32_bf16 v[48:51], a[192:195], a[144:147], 0
    v_exp_f32 v128, v80
    v_mfma_f32_16x16x32_bf16 v[48:51], a[196:199], a[148:151], v[48:51]
    v_exp_f32 v130, v82
    v_mfma_f32_16x16x32_bf16 v[48:51], a[200:203], a[152:155], v[48:51]
    v_fma_f32 v87, v87, s28, v18
    v_mfma_f32_16x16x32_bf16 v[48:51], a[204:207], a[156:159], v[48:51]
    v_exp_f32 v134, v86
    v_mfma_f32_16x16x32_bf16 v[48:51], a[208:211], a[160:163], v[48:51]
    s_waitcnt lgkmcnt(4)
    v_cvt_pk_bf16_f32 v121, v130, v131
    v_mfma_f32_16x16x32_bf16 v[48:51], a[212:215], a[164:167], v[48:51]
    v_cvt_pk_bf16_f32 v120, v128, v129
    v_mfma_f32_16x16x32_bf16 v[56:59], a[192:195], a[168:171], 0
    v_exp_f32 v135, v87
    v_mfma_f32_16x16x32_bf16 v[56:59], a[196:199], a[172:175], v[56:59]
    v_cvt_pk_bf16_f32 v123, v134, v135
    v_mfma_f32_16x16x32_bf16 v[56:59], a[200:203], a[176:179], v[56:59]
    s_waitcnt vmcnt(13) lgkmcnt(1)
    v_exp_f32 v133, v93
    v_mfma_f32_16x16x32_bf16 v[56:59], a[204:207], a[180:183], v[56:59]
    v_exp_f32 v132, v92
    v_mfma_f32_16x16x32_bf16 v[24:27], a[248:251], v[120:123], v[24:27]
    v_exp_f32 v135, v95
    v_mfma_f32_16x16x32_bf16 v[56:59], a[208:211], a[184:187], v[56:59]
    s_waitcnt lgkmcnt(0)
    v_exp_f32 v129, v89
    v_mfma_f32_16x16x32_bf16 v[56:59], a[212:215], a[188:191], v[56:59]
    s_barrier
    v_mfma_f32_16x16x32_bf16 v[36:39], a[216:219], a[96:99], 0
    v_exp_f32 v128, v88
    v_mfma_f32_16x16x32_bf16 v[36:39], a[220:223], a[100:103], v[36:39]
    v_cvt_pk_bf16_f32 v126, v132, v133
    v_mfma_f32_16x16x32_bf16 v[36:39], a[224:227], a[104:107], v[36:39]
    v_exp_f32 v130, v90
    v_mfma_f32_16x16x32_bf16 v[36:39], a[228:231], a[108:111], v[36:39]
    ds_read_b64_tr_b16 a[192:193], v3 offset:12288
    s_add_u32 m0, s22, 0
    v_mfma_f32_16x16x32_bf16 v[36:39], a[232:235], a[112:115], v[36:39]
    v_mfma_f32_16x16x32_bf16 v[36:39], a[236:239], a[116:119], v[36:39]
    ds_read_b64_tr_b16 a[194:195], v3 offset:18432
    v_mfma_f32_16x16x32_bf16 v[44:47], a[216:219], a[120:123], 0
    buffer_load_dwordx4 v9, s[4:7], s20 offen lds
    v_mfma_f32_16x16x32_bf16 v[44:47], a[220:223], a[124:127], v[44:47]
    s_add_u32 s20, s20, 128
    ds_read_b64_tr_b16 a[196:197], v4 offset:12288
    s_add_u32 m0, s22, 1024
    v_mfma_f32_16x16x32_bf16 v[44:47], a[224:227], a[128:131], v[44:47]
    buffer_load_dwordx4 v9, s[4:7], s20 offen lds
    v_mfma_f32_16x16x32_bf16 v[44:47], a[228:231], a[132:135], v[44:47]
    s_add_u32 s20, s20, 128
    v_mfma_f32_16x16x32_bf16 v[44:47], a[232:235], a[136:139], v[44:47]
    v_exp_f32 v131, v91
    v_mfma_f32_16x16x32_bf16 v[44:47], a[236:239], a[140:143], v[44:47]
    v_exp_f32 v134, v94
    v_mfma_f32_16x16x32_bf16 v[52:55], a[216:219], a[144:147], 0
    s_add_u32 m0, s22, 2048
    v_cvt_pk_bf16_f32 v124, v128, v129
    v_cvt_pk_bf16_f32 v127, v134, v135
    v_mfma_f32_16x16x32_bf16 v[52:55], a[220:223], a[148:151], v[52:55]
    buffer_load_dwordx4 v9, s[4:7], s20 offen lds
    v_mfma_f32_16x16x32_bf16 v[52:55], a[224:227], a[152:155], v[52:55]
    ds_read_b64_tr_b16 a[198:199], v4 offset:18432
    v_mfma_f32_16x16x32_bf16 v[52:55], a[228:231], a[156:159], v[52:55]
    ds_read_b64_tr_b16 a[200:201], v5 offset:12288
    v_cvt_pk_bf16_f32 v125, v130, v131
    v_mfma_f32_16x16x32_bf16 v[52:55], a[232:235], a[160:163], v[52:55]
    ds_read_b64_tr_b16 a[202:203], v5 offset:18432
    v_mfma_f32_16x16x32_bf16 v[24:27], a[252:255], v[124:127], v[24:27]
    ds_read_b64_tr_b16 a[204:205], v6 offset:12288
    v_mfma_f32_16x16x32_bf16 v[52:55], a[236:239], a[164:167], v[52:55]
    ds_read_b64_tr_b16 a[206:207], v6 offset:18432
    v_mfma_f32_16x16x32_bf16 v[60:63], a[216:219], a[168:171], 0
    ds_read_b64_tr_b16 a[208:209], v3 offset:13312
    v_mfma_f32_16x16x32_bf16 v[60:63], a[220:223], a[172:175], v[60:63]
    s_add_u32 s20, s20, 12032
    v_mfma_f32_16x16x32_bf16 v[60:63], a[224:227], a[176:179], v[60:63]
    ds_read_b64_tr_b16 a[210:211], v3 offset:19456
    v_cmp_lt_f32 vcc, s29, v24
    v_mfma_f32_16x16x32_bf16 v[60:63], a[228:231], a[180:183], v[60:63]
    ds_read_b64_tr_b16 a[212:213], v4 offset:13312
    v_mfma_f32_16x16x32_bf16 v[60:63], a[232:235], a[184:187], v[60:63]
    ds_read_b64_tr_b16 a[214:215], v4 offset:19456
    v_mfma_f32_16x16x32_bf16 v[60:63], a[236:239], a[188:191], v[60:63]
    s_cbranch_vccnz L_rs_tr44b
L_ret_tr44b:
    v_max3_f32 v28, v32, v33, v34
    s_waitcnt lgkmcnt(10)
    v_mfma_f32_16x16x32_bf16 v[160:163], a[192:195], v[112:115], v[160:163]
    s_add_u32 s24, s34, 128
    ds_read_b64_tr_b16 a[218:219], v5 offset:19456
    v_max3_f32 v30, v40, v41, v42
    v_rcp_f32 v154, v25
    v_mfma_f32_16x16x32_bf16 v[208:211], a[192:195], v[116:119], v[208:211]
    ds_read_b64_tr_b16 a[222:223], v6 offset:19456
    v_max3_f32 v28, v28, v35, v36
    v_mfma_f32_16x16x32_bf16 a[0:3], a[192:195], v[120:123], a[0:3]
    v_max3_f32 v30, v30, v43, v44
    v_max3_f32 v28, v28, v37, v38
    v_mfma_f32_16x16x32_bf16 a[48:51], a[192:195], v[124:127], a[48:51]
    s_waitcnt lgkmcnt(10)
    ds_read_b64_tr_b16 a[226:227], v3 offset:20480
    v_max3_f32 v30, v30, v45, v46
    v_mfma_f32_16x16x32_bf16 v[164:167], a[196:199], v[112:115], v[164:167]
    s_add_u32 s18, s34, 24576
    v_mov_b32 v153, v24
    v_max_f32 v28, v28, v39
    v_mfma_f32_16x16x32_bf16 v[212:215], a[196:199], v[116:119], v[212:215]
    s_mov_b32 s34, s33
    ds_read_b64_tr_b16 a[220:221], v6 offset:13312
    v_max_f32 v30, v30, v47
    v_mfma_f32_16x16x32_bf16 a[4:7], a[196:199], v[120:123], a[4:7]
    v_mov_b32 v29, v28
    v_mov_b32 v31, v30
    v_mfma_f32_16x16x32_bf16 a[52:55], a[196:199], v[124:127], a[52:55]
    s_waitcnt lgkmcnt(8)
    v_permlane32_swap_b32 v29, v28
    v_mfma_f32_16x16x32_bf16 v[168:171], a[200:203], v[112:115], v[168:171]
    s_add_u32 s37, s37, 1
    v_permlane32_swap_b32 v31, v30
    v_max_f32 v30, v30, v31
    v_max_f32 v28, v28, v29
    v_mfma_f32_16x16x32_bf16 v[216:219], a[200:203], v[116:119], v[216:219]
    s_add_u32 s35, s35, 325632
    v_mov_b32 v29, v28
    v_mov_b32 v31, v30
    v_mfma_f32_16x16x32_bf16 a[8:11], a[200:203], v[120:123], a[8:11]
    s_lshl_b32 s42, s37, 1
    v_mov_b32 v152, v24
    v_xor_b32 v8, 96, v14
    v_mfma_f32_16x16x32_bf16 a[56:59], a[200:203], v[124:127], a[56:59]
    s_lshr_b32 s42, s31, s42
    ds_read_b64_tr_b16 a[216:217], v5 offset:13312
    v_permlane16_swap_b32 v29, v28
    v_max_f32 v28, v28, v29
    v_mfma_f32_16x16x32_bf16 v[172:175], a[204:207], v[112:115], v[172:175]
    s_xor_b32 s42, s42, s36
    ds_read_b64_tr_b16 a[224:225], v3 offset:14336
    s_and_b32 s42, s42, 3
    v_mfma_f32_16x16x32_bf16 v[220:223], a[204:207], v[116:119], v[220:223]
    s_mul_i32 s43, s3, 3
    ds_read_b64_tr_b16 a[230:231], v4 offset:20480
    v_permlane16_swap_b32 v31, v30
    v_mul_f32_e64 v16, -s28, v28
    v_mfma_f32_16x16x32_bf16 a[12:15], a[204:207], v[120:123], a[12:15]
    s_lshl_b32 s44, s3, 2
    ds_read_b64_tr_b16 a[228:229], v4 offset:14336
    v_max_f32 v30, v30, v31
    v_mfma_f32_16x16x32_bf16 a[60:63], a[204:207], v[124:127], a[60:63]
    s_waitcnt lgkmcnt(4)
    v_mul_f32_e64 v17, -s28, v30
    v_max3_f32 v30, v56, v57, v58
    v_mfma_f32_16x16x32_bf16 v[176:179], a[208:211], v[112:115], v[176:179]
    s_mov_b32 s32, 1
    ds_read_b64_tr_b16 a[234:235], v5 offset:20480
    v_max3_f32 v28, v48, v49, v50
    v_fma_f32 v35, v35, s28, v16
    v_mfma_f32_16x16x32_bf16 v[224:227], a[208:211], v[116:119], v[224:227]
    s_add_u32 s45, s43, 17
    v_max3_f32 v30, v30, v59, v60
    v_accvgpr_read_b32 v149, a49
    v_mfma_f32_16x16x32_bf16 a[16:19], a[208:211], v[120:123], a[16:19]
    s_cmp_eq_u32 s3, 0
    ds_read_b64_tr_b16 a[236:237], v6 offset:14336
    v_fma_f32 v34, v34, s28, v16
    v_mfma_f32_16x16x32_bf16 a[64:67], a[208:211], v[124:127], a[64:67]
    s_cselect_b32 s45, 16, s45
    v_max3_f32 v30, v30, v61, v62
    v_fma_f32 v43, v43, s28, v17
    v_mfma_f32_16x16x32_bf16 v[180:183], a[212:215], v[112:115], v[180:183]
    s_cselect_b32 s33, 1, 0
    ds_read_b64_tr_b16 a[238:239], v6 offset:20480
    v_fma_f32 v38, v38, s28, v16
    v_mfma_f32_16x16x32_bf16 v[228:231], a[212:215], v[116:119], v[228:231]
    s_cmp_eq_u32 s42, 1
    v_accvgpr_read_b32 v145, a1
    v_fma_f32 v45, v45, s28, v17
    v_mfma_f32_16x16x32_bf16 a[20:23], a[212:215], v[120:123], a[20:23]
    s_cselect_b32 s44, s45, s44
    v_rcp_f32 v156, v26
    v_mfma_f32_16x16x32_bf16 a[68:71], a[212:215], v[124:127], a[68:71]
    s_cselect_b32 s32, s33, s32
    v_max_f32 v30, v30, v63
    s_waitcnt lgkmcnt(3)
    v_mfma_f32_16x16x32_bf16 v[184:187], a[216:219], v[112:115], v[184:187]
    s_add_u32 s45, s43, 29
    v_accvgpr_read_b32 v148, a48
    v_max3_f32 v28, v28, v51, v52
    v_mfma_f32_16x16x32_bf16 v[232:235], a[216:219], v[116:119], v[232:235]
    s_cmp_eq_u32 s42, 2
    v_mov_b32 v31, v30
    v_max3_f32 v28, v28, v53, v54
    v_mfma_f32_16x16x32_bf16 a[24:27], a[216:219], v[120:123], a[24:27]
    s_cselect_b32 s44, s45, s44
    ds_read_b64_tr_b16 a[232:233], v5 offset:14336
    v_fma_f32 v33, v33, s28, v16
    v_mfma_f32_16x16x32_bf16 a[72:75], a[216:219], v[124:127], a[72:75]
    s_cselect_b32 s32, 0, s32
    v_permlane16_swap_b32 v152, v153
    v_mfma_f32_16x16x32_bf16 v[188:191], a[220:223], v[112:115], v[188:191]
    s_add_u32 s45, s43, 41
    v_rcp_f32 v158, v27
    v_rcp_f32 v152, v152
    v_max_f32 v28, v28, v55
    v_pk_mul_f32 v[166:167], v[166:167], v[152:153] op_sel_hi:[1,0]
    v_pk_mul_f32 v[162:163], v[162:163], v[152:153] op_sel_hi:[1,0]
    v_fma_f32 v32, v32, s28, v16
    v_fma_f32 v44, v44, s28, v17
    v_permlane32_swap_b32 v31, v30
    v_mfma_f32_16x16x32_bf16 v[236:239], a[220:223], v[116:119], v[236:239]
    s_cmp_eq_u32 s42, 3
    v_mov_b32 v29, v28
    v_fma_f32 v46, v46, s28, v17
    v_mfma_f32_16x16x32_bf16 a[28:31], a[220:223], v[120:123], a[28:31]
    s_cselect_b32 s44, s45, s44
    v_exp_f32 v128, v32
    v_mfma_f32_16x16x32_bf16 a[76:79], a[220:223], v[124:127], a[76:79]
    s_cselect_b32 s32, 0, s32
    s_mul_i32 s44, s44, 6144
    v_permlane32_swap_b32 v29, v28
    v_mfma_f32_16x16x32_bf16 v[192:195], a[224:227], v[112:115], v[192:195]
    s_add_u32 s33, s35, s44
    v_fma_f32 v36, v36, s28, v16
    v_max_f32 v30, v30, v31
    v_mfma_f32_16x16x32_bf16 v[240:243], a[224:227], v[116:119], v[240:243]
    s_mul_i32 s42, s32, 6144
    v_fma_f32 v42, v42, s28, v17
    v_fma_f32 v40, v40, s28, v17
    v_mfma_f32_16x16x32_bf16 a[32:35], a[224:227], v[120:123], a[32:35]
    s_add_u32 s42, s42, 18432
    v_accvgpr_read_b32 v147, a3
    v_mov_b32 v31, v30
    v_max_f32 v28, v28, v29
    v_mfma_f32_16x16x32_bf16 a[80:83], a[224:227], v[124:127], a[80:83]
    s_add_u32 s42, s42, s33
    v_exp_f32 v130, v34
    v_mfma_f32_16x16x32_bf16 v[196:199], a[228:231], v[112:115], v[196:199]
    s_cmp_ge_u32 s37, 8
    v_exp_f32 v131, v35
    v_mfma_f32_16x16x32_bf16 v[244:247], a[228:231], v[116:119], v[244:247]
    s_cselect_b32 s14, 0, s42
    v_mov_b32 v29, v28
    v_exp_f32 v134, v36
    v_mfma_f32_16x16x32_bf16 a[36:39], a[228:231], v[120:123], a[36:39]
    s_add_u32 s25, s33, 128
    s_add_u32 s23, s38, 2048
    v_permlane16_swap_b32 v29, v28
    v_fma_f32 v39, v39, s28, v16
    v_mfma_f32_16x16x32_bf16 a[84:87], a[228:231], v[124:127], a[84:87]
    s_mov_b32 s30, 0
    v_subrev_u32 v13, 20480, v13
    s_waitcnt vmcnt(6) lgkmcnt(0)
    v_mfma_f32_16x16x32_bf16 v[200:203], a[232:235], v[112:115], v[200:203]
    s_barrier
    ds_read_b128 a[196:199], v2 offset:12288
    v_mfma_f32_16x16x32_bf16 v[248:251], a[232:235], v[116:119], v[248:251]
    ds_read_b128 a[192:195], v1 offset:12288
    v_permlane16_swap_b32 v31, v30
    v_mfma_f32_16x16x32_bf16 a[40:43], a[232:235], v[120:123], a[40:43]
    ds_read_b128 a[204:207], v2 offset:13312
    v_max_f32 v30, v30, v31
    v_mfma_f32_16x16x32_bf16 a[88:91], a[232:235], v[124:127], a[88:91]
    ds_read_b128 a[208:211], v1 offset:14336
    v_fma_f32 v41, v41, s28, v17
    v_mfma_f32_16x16x32_bf16 v[204:207], a[236:239], v[112:115], v[204:207]
    s_add_u32 m0, s22, 36864
    ds_read_b128 a[200:203], v1 offset:13312
    v_mul_f32_e64 v19, -s28, v30
    v_cvt_pk_bf16_f32 v97, v130, v131
    v_exp_f32 v130, v42
    v_exp_f32 v129, v33
    v_mfma_f32_16x16x32_bf16 v[252:255], a[236:239], v[116:119], v[252:255]
    ds_read_b128 a[212:215], v2 offset:14336
    v_fma_f32 v57, v57, s28, v19
    v_exp_f32 v131, v43
    v_max_f32 v28, v28, v29
    v_pk_mul_f32 v[212:213], v[212:213], v[154:155] op_sel_hi:[1,0]
    v_cvt_pk_bf16_f32 v96, v128, v129
    v_pk_mul_f32 v[170:171], v[170:171], v[152:153] op_sel_hi:[1,0]
    v_pk_mul_f32 v[216:217], v[216:217], v[154:155] op_sel_hi:[1,0]
    v_exp_f32 v132, v40
    v_exp_f32 v133, v41
    v_mfma_f32_16x16x32_bf16 a[44:47], a[236:239], v[120:123], a[44:47]
    v_mul_f32_e64 v18, -s28, v28
    v_fma_f32 v55, v55, s28, v18
    v_cvt_pk_bf16_f32 v100, v132, v133
    v_mfma_f32_16x16x32_bf16 a[92:95], a[236:239], v[124:127], a[92:95]
    s_waitcnt lgkmcnt(4)
    ds_read_b128 a[220:223], v2 offset:18432
    buffer_load_dwordx4 v9, s[8:11], s21 offen lds
    v_mfma_f32_16x16x32_bf16 v[64:67], a[192:195], a[96:99], 0
    v_fma_f32 v47, v47, s28, v17
    v_fma_f32 v58, v58, s28, v19
    v_fma_f32 v37, v37, s28, v16
    v_mfma_f32_16x16x32_bf16 v[64:67], a[196:199], a[100:103], v[64:67]
    s_waitcnt lgkmcnt(2)
    v_exp_f32 v128, v38
    v_mfma_f32_16x16x32_bf16 v[64:67], a[200:203], a[104:107], v[64:67]
    v_cvt_pk_bf16_f32 v101, v130, v131
    v_fma_f32 v48, v48, s28, v18
    v_exp_f32 v135, v37
    v_mfma_f32_16x16x32_bf16 v[64:67], a[204:207], a[108:111], v[64:67]
    s_add_u32 s21, s21, 128
    v_cvt_pk_bf16_f32 v98, v134, v135
    v_accvgpr_read_b32 v151, a51
    v_mfma_f32_16x16x32_bf16 v[64:67], a[208:211], a[112:115], v[64:67]
    s_waitcnt lgkmcnt(1)
    v_accvgpr_read_b32 v150, a50
    v_accvgpr_read_b32 v146, a2
    v_mfma_f32_16x16x32_bf16 v[64:67], a[212:215], a[116:119], v[64:67]
    v_exp_f32 v134, v46
    v_mfma_f32_16x16x32_bf16 v[72:75], a[192:195], a[120:123], 0
    ds_read_b128 a[216:219], v1 offset:18432
    v_exp_f32 v133, v45
    v_mfma_f32_16x16x32_bf16 v[72:75], a[196:199], a[124:127], v[72:75]
    s_add_u32 m0, s22, 37888
    v_fma_f32 v51, v51, s28, v18
    v_accvgpr_read_b32 v144, a0
    v_mfma_f32_16x16x32_bf16 v[72:75], a[200:203], a[128:131], v[72:75]
    v_fma_f32 v64, v64, s28, v16
    v_fma_f32 v53, v53, s28, v18
    v_mfma_f32_16x16x32_bf16 v[72:75], a[204:207], a[132:135], v[72:75]
    buffer_load_dwordx4 v9, s[8:11], s21 offen lds
    v_fma_f32 v52, v52, s28, v18
    v_mfma_f32_16x16x32_bf16 v[72:75], a[208:211], a[136:139], v[72:75]
    v_exp_f32 v129, v39
    v_mfma_f32_16x16x32_bf16 v[72:75], a[212:215], a[140:143], v[72:75]
    v_exp_f32 v132, v44
    v_mfma_f32_16x16x32_bf16 v[80:83], a[192:195], a[144:147], 0
    v_cvt_pk_bf16_f32 v99, v128, v129
    v_fma_f32 v50, v50, s28, v18
    v_fma_f32 v56, v56, s28, v19
    v_mfma_f32_16x16x32_bf16 v[80:83], a[196:199], a[148:151], v[80:83]
    s_add_u32 s21, s21, 128
    ds_read_b128 a[224:227], v1 offset:19456
    v_fma_f32 v49, v49, s28, v18
    v_mfma_f32_16x16x32_bf16 v[80:83], a[200:203], a[152:155], v[80:83]
    v_exp_f32 v129, v49
    v_mfma_f32_16x16x32_bf16 v[80:83], a[204:207], a[156:159], v[80:83]
    v_xor_b32 v0, 32, v14
    v_cvt_pk_bf16_f32 v216, v216, v217
    v_exp_f32 v135, v47
    v_mfma_f32_16x16x32_bf16 v[80:83], a[208:211], a[160:163], v[80:83]
    ds_read_b128 a[236:239], v2 offset:20480
    v_cvt_pk_bf16_f32 v102, v132, v133
    v_mfma_f32_16x16x32_bf16 v[80:83], a[212:215], a[164:167], v[80:83]
    ds_read_b128 a[228:231], v2 offset:19456
    v_cvt_pk_bf16_f32 v212, v212, v213
    v_mfma_f32_16x16x32_bf16 v[88:91], a[192:195], a[168:171], 0
    ds_read_b128 a[232:235], v1 offset:20480
    v_fma_f32 v59, v59, s28, v19
    v_exp_f32 v131, v51
    v_cvt_pk_bf16_f32 v103, v134, v135
    v_pk_mul_f32 v[208:209], v[208:209], v[154:155] op_sel_hi:[1,0]
    v_pk_mul_f32 v[190:191], v[190:191], v[152:153] op_sel_hi:[1,0]
    v_pk_mul_f32 v[160:161], v[160:161], v[152:153] op_sel_hi:[1,0]
    v_pk_mul_f32 v[148:149], v[148:149], v[158:159] op_sel_hi:[1,0]
    v_pk_mul_f32 v[226:227], v[226:227], v[154:155] op_sel_hi:[1,0]
    v_cvt_pk_bf16_f32 v160, v160, v161
    v_pk_mul_f32 v[146:147], v[146:147], v[156:157] op_sel_hi:[1,0]
    v_pk_mul_f32 v[150:151], v[150:151], v[158:159] op_sel_hi:[1,0]
    v_pk_mul_f32 v[164:165], v[164:165], v[152:153] op_sel_hi:[1,0]
    v_fma_f32 v67, v67, s28, v16
    v_pk_mul_f32 v[220:221], v[220:221], v[154:155] op_sel_hi:[1,0]
    v_cvt_pk_bf16_f32 v161, v162, v163
    v_fma_f32 v60, v60, s28, v19
    v_pk_mul_f32 v[144:145], v[144:145], v[156:157] op_sel_hi:[1,0]
    v_pk_mul_f32 v[248:249], v[248:249], v[154:155] op_sel_hi:[1,0]
    v_pk_mul_f32 v[176:177], v[176:177], v[152:153] op_sel_hi:[1,0]
    v_fma_f32 v54, v54, s28, v18
    v_fma_f32 v62, v62, s28, v19
    v_pk_mul_f32 v[214:215], v[214:215], v[154:155] op_sel_hi:[1,0]
    v_fma_f32 v83, v83, s28, v18
    v_cvt_pk_bf16_f32 v148, v148, v149
    v_mfma_f32_16x16x32_bf16 v[88:91], a[196:199], a[172:175], v[88:91]
    s_add_u32 m0, s22, 38912
    v_exp_f32 v128, v48
    v_mfma_f32_16x16x32_bf16 v[88:91], a[200:203], a[176:179], v[88:91]
    buffer_load_dwordx4 v9, s[8:11], s21 offen lds
    v_mfma_f32_16x16x32_bf16 v[88:91], a[204:207], a[180:183], v[88:91]
    s_add_u32 s21, s21, 12032
    v_exp_f32 v133, v53
    v_cvt_pk_bf16_f32 v104, v128, v129
    v_mfma_f32_16x16x32_bf16 v[88:91], a[208:211], a[184:187], v[88:91]
    v_exp_f32 v130, v50
    v_cvt_pk_bf16_f32 v220, v220, v221
    v_mfma_f32_16x16x32_bf16 v[88:91], a[212:215], a[188:191], v[88:91]
    s_waitcnt lgkmcnt(0)
    v_fma_f32 v75, v75, s28, v17
    v_cvt_pk_bf16_f32 v213, v214, v215
    v_mfma_f32_16x16x32_bf16 v[68:71], a[216:219], a[96:99], 0
    s_waitcnt vmcnt(6)
    v_exp_f32 v128, v56
    v_fma_f32 v65, v65, s28, v16
    v_cvt_pk_bf16_f32 v144, v144, v145
    v_mfma_f32_16x16x32_bf16 v[68:71], a[220:223], a[100:103], v[68:71]
    s_barrier
    v_mfma_f32_16x16x32_bf16 v[68:71], a[224:227], a[104:107], v[68:71]
    ds_read_b64_tr_b16 a[192:193], v3 offset:0
    v_cvt_pk_bf16_f32 v105, v130, v131
    v_mfma_f32_16x16x32_bf16 v[68:71], a[228:231], a[108:111], v[68:71]
    v_exp_f32 v132, v52
    v_mfma_f32_16x16x32_bf16 v[68:71], a[232:235], a[112:115], v[68:71]
    v_exp_f32 v135, v55
    v_mfma_f32_16x16x32_bf16 v[68:71], a[236:239], a[116:119], v[68:71]
    v_cvt_pk_bf16_f32 v164, v164, v165
    v_fma_f32 v73, v73, s28, v17
    v_cvt_pk_bf16_f32 v106, v132, v133
    v_fma_f32 v61, v61, s28, v19
    v_mfma_f32_16x16x32_bf16 v[76:79], a[216:219], a[120:123], 0
    v_fma_f32 v89, v89, s28, v19
    v_fma_f32 v63, v63, s28, v19
    v_exp_f32 v132, v60
    v_mfma_f32_16x16x32_bf16 v[76:79], a[220:223], a[124:127], v[76:79]
    s_add_u32 m0, s22, 12288
    v_exp_f32 v134, v54
    v_mfma_f32_16x16x32_bf16 v[76:79], a[224:227], a[128:131], v[76:79]
    ds_read_b64_tr_b16 a[194:195], v3 offset:6144
    v_exp_f32 v129, v57
    v_mfma_f32_16x16x32_bf16 v[76:79], a[228:231], a[132:135], v[76:79]
    ds_read_b64_tr_b16 a[196:197], v4 offset:0
    v_cvt_pk_bf16_f32 v208, v208, v209
    v_mfma_f32_16x16x32_bf16 v[76:79], a[232:235], a[136:139], v[76:79]
    v_fma_f32 v70, v70, s28, v16
    v_fma_f32 v81, v81, s28, v18
    v_mfma_f32_16x16x32_bf16 v[76:79], a[236:239], a[140:143], v[76:79]
    ds_read_b64_tr_b16 a[198:199], v4 offset:6144
    v_exp_f32 v133, v61
    v_mfma_f32_16x16x32_bf16 v[20:23], a[240:243], v[96:99], 0
    buffer_load_dwordx4 v9, s[4:7], s20 offen lds
    v_mfma_f32_16x16x32_bf16 v[84:87], a[216:219], a[144:147], 0
    v_exp_f32 v130, v58
    v_mfma_f32_16x16x32_bf16 v[84:87], a[220:223], a[148:151], v[84:87]
    ds_read_b64_tr_b16 a[200:201], v5 offset:0
    v_cvt_pk_bf16_f32 v108, v128, v129
    v_mfma_f32_16x16x32_bf16 v[84:87], a[224:227], a[152:155], v[84:87]
    ds_read_b64_tr_b16 a[202:203], v5 offset:6144
    v_fma_f32 v72, v72, s28, v17
    v_mfma_f32_16x16x32_bf16 v[84:87], a[228:231], a[156:159], v[84:87]
    ds_read_b64_tr_b16 a[204:205], v6 offset:0
    v_cvt_pk_bf16_f32 v165, v166, v167
    v_mfma_f32_16x16x32_bf16 v[84:87], a[232:235], a[160:163], v[84:87]
    ds_read_b64_tr_b16 a[206:207], v6 offset:6144
    v_cvt_pk_bf16_f32 v149, v150, v151
    v_cvt_pk_bf16_f32 v110, v132, v133
    v_exp_f32 v131, v59
    v_pk_mul_f32 v[184:185], v[184:185], v[152:153] op_sel_hi:[1,0]
    v_pk_mul_f32 v[200:201], v[200:201], v[152:153] op_sel_hi:[1,0]
    v_pk_mul_f32 v[188:189], v[188:189], v[152:153] op_sel_hi:[1,0]
    v_exp_f32 v128, v64
    v_pk_mul_f32 v[222:223], v[222:223], v[154:155] op_sel_hi:[1,0]
    v_pk_mul_f32 v[172:173], v[172:173], v[152:153] op_sel_hi:[1,0]
    v_pk_mul_f32 v[252:253], v[252:253], v[154:155] op_sel_hi:[1,0]
    v_cvt_pk_bf16_f32 v248, v248, v249
    v_cvt_pk_bf16_f32 v109, v130, v131
    v_exp_f32 v129, v65
    v_pk_mul_f32 v[210:211], v[210:211], v[154:155] op_sel_hi:[1,0]
    v_pk_mul_f32 v[168:169], v[168:169], v[152:153] op_sel_hi:[1,0]
    v_pk_mul_f32 v[196:197], v[196:197], v[152:153] op_sel_hi:[1,0]
    v_fma_f32 v79, v79, s28, v17
    v_pk_mul_f32 v[180:181], v[180:181], v[152:153] op_sel_hi:[1,0]
    v_cvt_pk_bf16_f32 v145, v146, v147
    v_pk_mul_f32 v[240:241], v[240:241], v[154:155] op_sel_hi:[1,0]
    v_pk_mul_f32 v[228:229], v[228:229], v[154:155] op_sel_hi:[1,0]
    v_pk_mul_f32 v[174:175], v[174:175], v[152:153] op_sel_hi:[1,0]
    v_cvt_pk_bf16_f32 v172, v172, v173
    v_cvt_pk_bf16_f32 v209, v210, v211
    v_mfma_f32_16x16x32_bf16 v[84:87], a[236:239], a[164:167], v[84:87]
    ds_write2st64_b64 v14, v[160:161], v[208:209] offset0:0 offset1:12
    v_fma_f32 v74, v74, s28, v17
    v_cvt_pk_bf16_f32 v107, v134, v135
    v_accvgpr_read_b32 v150, a54
    v_accvgpr_read_b32 v151, a55
    v_mfma_f32_16x16x32_bf16 v[92:95], a[216:219], a[168:171], 0
    ds_write2st64_b64 v14, v[144:145], v[148:149] offset0:24 offset1:36
    v_pk_mul_f32 v[236:237], v[236:237], v[154:155] op_sel_hi:[1,0]
    v_accvgpr_read_b32 v144, a4
    v_pk_mul_f32 v[182:183], v[182:183], v[152:153] op_sel_hi:[1,0]
    v_pk_mul_f32 v[150:151], v[150:151], v[158:159] op_sel_hi:[1,0]
    v_pk_mul_f32 v[244:245], v[244:245], v[154:155] op_sel_hi:[1,0]
    v_accvgpr_read_b32 v147, a7
    v_accvgpr_read_b32 v149, a53
    v_mfma_f32_16x16x32_bf16 v[92:95], a[220:223], a[172:175], v[92:95]
    ds_write2st64_b64 v0, v[164:165], v[212:213] offset0:0 offset1:12
    v_cvt_pk_bf16_f32 v188, v188, v189
    v_fma_f32 v71, v71, s28, v16
    v_mfma_f32_16x16x32_bf16 v[92:95], a[224:227], a[176:179], v[92:95]
    v_accvgpr_read_b32 v145, a5
    v_cvt_pk_bf16_f32 v168, v168, v169
    v_exp_f32 v134, v62
    v_accvgpr_read_b32 v148, a52
    v_pk_mul_f32 v[230:231], v[230:231], v[154:155] op_sel_hi:[1,0]
    v_fma_f32 v85, v85, s28, v18
    v_pk_mul_f32 v[218:219], v[218:219], v[154:155] op_sel_hi:[1,0]
    v_pk_mul_f32 v[254:255], v[254:255], v[154:155] op_sel_hi:[1,0]
    v_pk_mul_f32 v[238:239], v[238:239], v[154:155] op_sel_hi:[1,0]
    v_cvt_pk_bf16_f32 v200, v200, v201
    v_exp_f32 v132, v72
    v_cvt_pk_bf16_f32 v112, v128, v129
    v_exp_f32 v133, v73
    v_fma_f32 v76, v76, s28, v17
    v_pk_mul_f32 v[224:225], v[224:225], v[154:155] op_sel_hi:[1,0]
    v_cvt_pk_bf16_f32 v228, v228, v229
    v_pk_mul_f32 v[144:145], v[144:145], v[156:157] op_sel_hi:[1,0]
    v_accvgpr_read_b32 v146, a6
    v_pk_mul_f32 v[178:179], v[178:179], v[152:153] op_sel_hi:[1,0]
    v_pk_mul_f32 v[148:149], v[148:149], v[158:159] op_sel_hi:[1,0]
    v_pk_mul_f32 v[146:147], v[146:147], v[156:157] op_sel_hi:[1,0]
    v_cvt_pk_bf16_f32 v240, v240, v241
    v_fma_f32 v86, v86, s28, v18
    v_mfma_f32_16x16x32_bf16 v[92:95], a[228:231], a[180:183], v[92:95]
    ds_read_b64_tr_b16 a[208:209], v3 offset:1024
    v_cvt_pk_bf16_f32 v184, v184, v185
    v_cvt_pk_bf16_f32 v144, v144, v145
    v_cvt_pk_bf16_f32 v145, v146, v147
    v_cvt_pk_bf16_f32 v148, v148, v149
    v_fma_f32 v77, v77, s28, v17
    v_accvgpr_read_b32 v146, a10
    v_exp_f32 v128, v70
    v_cvt_pk_bf16_f32 v149, v150, v151
    v_fma_f32 v69, v69, s28, v16
    v_mfma_f32_16x16x32_bf16 v[20:23], a[244:247], v[100:103], v[20:23]
    s_add_u32 s20, s20, 128
    v_cvt_pk_bf16_f32 v252, v252, v253
    v_exp_f32 v135, v63
    v_mfma_f32_16x16x32_bf16 v[92:95], a[232:235], a[184:187], v[92:95]
    s_add_u32 m0, s22, 13312
    ds_read_b64_tr_b16 a[218:219], v5 offset:7168
    v_cvt_pk_bf16_f32 v116, v132, v133
    v_accvgpr_read_b32 v147, a11
    v_mfma_f32_16x16x32_bf16 v[92:95], a[236:239], a[188:191], v[92:95]
    s_waitcnt lgkmcnt(2)
    ds_write2st64_b64 v0, v[144:145], v[148:149] offset0:24 offset1:36
    v_mfma_f32_16x16x32_bf16 v[160:163], a[192:195], v[96:99], 0
    v_exp_f32 v131, v67
    v_mfma_f32_16x16x32_bf16 v[208:211], a[192:195], v[100:103], 0
    ds_read_b64_tr_b16 a[210:211], v3 offset:7168
    v_xor_b32 v15, 64, v14
    v_cvt_pk_bf16_f32 v176, v176, v177
    v_fma_f32 v66, v66, s28, v16
    v_accvgpr_read_b32 v144, a8
    v_mfma_f32_16x16x32_bf16 a[0:3], a[192:195], v[104:107], 0
    ds_read_b64_tr_b16 a[230:231], v4 offset:8192
    buffer_load_dwordx4 v9, s[4:7], s20 offen lds
    v_exp_f32 v130, v66
    v_accvgpr_read_b32 v151, a59
    v_accvgpr_read_b32 v148, a56
    v_accvgpr_read_b32 v150, a58
    v_cvt_pk_bf16_f32 v169, v170, v171
    v_fma_f32 v87, v87, s28, v18
    v_cvt_pk_bf16_f32 v224, v224, v225
    v_fma_f32 v68, v68, s28, v16
    v_exp_f32 v129, v71
    v_cvt_pk_bf16_f32 v180, v180, v181
    v_fma_f32 v84, v84, s28, v18
    v_cvt_pk_bf16_f32 v225, v226, v227
    v_cvt_pk_bf16_f32 v111, v134, v135
    v_accvgpr_read_b32 v149, a57
    v_cvt_pk_bf16_f32 v221, v222, v223
    v_mfma_f32_16x16x32_bf16 a[48:51], a[192:195], v[108:111], 0
    s_add_u32 s20, s20, 128
    ds_read_b64_tr_b16 a[212:213], v4 offset:1024
    v_cvt_pk_bf16_f32 v217, v218, v219
    v_mfma_f32_16x16x32_bf16 v[20:23], a[248:251], v[104:107], v[20:23]
    ds_read_b64_tr_b16 a[220:221], v6 offset:1024
    v_cvt_pk_bf16_f32 v113, v130, v131
    v_accvgpr_read_b32 v145, a9
    v_cvt_pk_bf16_f32 v173, v174, v175
    v_mfma_f32_16x16x32_bf16 v[164:167], a[196:199], v[96:99], 0
    ds_read_b64_tr_b16 a[228:229], v4 offset:2048
    v_fma_f32 v78, v78, s28, v17
    v_mfma_f32_16x16x32_bf16 v[212:215], a[196:199], v[100:103], 0
    s_add_u32 m0, s22, 14336
    ds_write2st64_b64 v15, v[168:169], v[216:217] offset0:0 offset1:12
    v_exp_f32 v132, v76
    v_pk_mul_f32 v[186:187], v[186:187], v[152:153] op_sel_hi:[1,0]
    v_pk_mul_f32 v[148:149], v[148:149], v[158:159] op_sel_hi:[1,0]
    v_pk_mul_f32 v[146:147], v[146:147], v[156:157] op_sel_hi:[1,0]
    v_pk_mul_f32 v[206:207], v[206:207], v[152:153] op_sel_hi:[1,0]
    v_pk_mul_f32 v[144:145], v[144:145], v[156:157] op_sel_hi:[1,0]
    v_cvt_pk_bf16_f32 v253, v254, v255
    v_pk_mul_f32 v[150:151], v[150:151], v[158:159] op_sel_hi:[1,0]
    v_pk_mul_f32 v[202:203], v[202:203], v[152:153] op_sel_hi:[1,0]
    v_cvt_pk_bf16_f32 v148, v148, v149
    v_cvt_pk_bf16_f32 v181, v182, v183
    v_cvt_pk_bf16_f32 v144, v144, v145
    v_cvt_pk_bf16_f32 v149, v150, v151
    v_exp_f32 v135, v69
    v_mfma_f32_16x16x32_bf16 a[4:7], a[196:199], v[104:107], 0
    buffer_load_dwordx4 v9, s[4:7], s20 offen lds
    ds_read_b64_tr_b16 a[214:215], v4 offset:7168
    v_fma_f32 v88, v88, s28, v19
    v_exp_f32 v134, v68
    v_exp_f32 v130, v74
    v_cvt_pk_bf16_f32 v145, v146, v147
    v_accvgpr_read_b32 v146, a14
    v_mfma_f32_16x16x32_bf16 a[52:55], a[196:199], v[108:111], 0
    s_add_u32 s20, s20, 12032
    ds_write2st64_b64 v15, v[144:145], v[148:149] offset0:24 offset1:36
    v_cvt_pk_bf16_f32 v185, v186, v187
    v_accvgpr_read_b32 v150, a62
    v_fma_f32 v94, v94, s28, v19
    v_fma_f32 v92, v92, s28, v19
    v_accvgpr_read_b32 v151, a63
    v_fma_f32 v80, v80, s28, v18
    v_cvt_pk_bf16_f32 v115, v128, v129
    v_mfma_f32_16x16x32_bf16 v[168:171], a[200:203], v[96:99], 0
    ds_write2st64_b64 v8, v[172:173], v[220:221] offset0:0 offset1:12
    v_exp_f32 v131, v75
    v_accvgpr_read_b32 v148, a60
    v_accvgpr_read_b32 v145, a13
    v_accvgpr_read_b32 v144, a12
    v_cvt_pk_bf16_f32 v114, v134, v135
    v_accvgpr_read_b32 v149, a61
    v_cvt_pk_bf16_f32 v117, v130, v131
    v_accvgpr_read_b32 v147, a15
    v_pk_mul_f32 v[144:145], v[144:145], v[156:157] op_sel_hi:[1,0]
    v_cvt_pk_bf16_f32 v177, v178, v179
    v_pk_mul_f32 v[150:151], v[150:151], v[158:159] op_sel_hi:[1,0]
    v_cvt_pk_bf16_f32 v244, v244, v245
    v_pk_mul_f32 v[192:193], v[192:193], v[152:153] op_sel_hi:[1,0]
    v_pk_mul_f32 v[146:147], v[146:147], v[156:157] op_sel_hi:[1,0]
    v_pk_mul_f32 v[242:243], v[242:243], v[154:155] op_sel_hi:[1,0]
    v_pk_mul_f32 v[148:149], v[148:149], v[158:159] op_sel_hi:[1,0]
    v_cvt_pk_bf16_f32 v229, v230, v231
    v_cvt_pk_bf16_f32 v144, v144, v145
    v_mfma_f32_16x16x32_bf16 v[216:219], a[200:203], v[100:103], 0
    ds_read_b128 v[136:139], v13 offset:0
    v_cvt_pk_bf16_f32 v148, v148, v149
    v_mfma_f32_16x16x32_bf16 a[8:11], a[200:203], v[104:107], 0
    s_add_u32 s56, s24, 4294967168
    ds_read_b64_tr_b16 a[216:217], v5 offset:1024
    v_cvt_pk_bf16_f32 v145, v146, v147
    v_cvt_pk_bf16_f32 v149, v150, v151
    v_accvgpr_read_b32 v147, a19
    v_mfma_f32_16x16x32_bf16 a[56:59], a[200:203], v[108:111], 0
    ds_read_b128 v[140:143], v13 offset:1024
    v_accvgpr_read_b32 v151, a67
    v_mfma_f32_16x16x32_bf16 v[172:175], a[204:207], v[96:99], 0
    ds_write2st64_b64 v8, v[144:145], v[148:149] offset0:24 offset1:36
    v_mfma_f32_16x16x32_bf16 v[220:223], a[204:207], v[100:103], 0
    s_add_u32 s58, s25, 4294967168
    ds_write2st64_b64 v14, v[176:177], v[224:225] offset0:4 offset1:16
    v_exp_f32 v131, v83
    v_accvgpr_read_b32 v146, a18
    v_pk_mul_f32 v[204:205], v[204:205], v[152:153] op_sel_hi:[1,0]
    v_accvgpr_read_b32 v150, a66
    v_exp_f32 v134, v78
    v_pk_mul_f32 v[232:233], v[232:233], v[154:155] op_sel_hi:[1,0]
    v_exp_f32 v133, v77
    v_accvgpr_read_b32 v144, a16
    v_pk_mul_f32 v[250:251], v[250:251], v[154:155] op_sel_hi:[1,0]
    v_cvt_pk_bf16_f32 v236, v236, v237
    v_cvt_pk_bf16_f32 v189, v190, v191
    v_exp_f32 v135, v79
    v_pk_mul_f32 v[146:147], v[146:147], v[156:157] op_sel_hi:[1,0]
    v_accvgpr_read_b32 v145, a17
    v_accvgpr_read_b32 v148, a64
    v_fma_f32 v82, v82, s28, v18
    v_fma_f32 v91, v91, s28, v19
    v_pk_mul_f32 v[234:235], v[234:235], v[154:155] op_sel_hi:[1,0]
    v_pk_mul_f32 v[150:151], v[150:151], v[158:159] op_sel_hi:[1,0]
    v_cvt_pk_bf16_f32 v204, v204, v205
    v_exp_f32 v128, v80
    v_accvgpr_read_b32 v149, a65
    v_cvt_pk_bf16_f32 v192, v192, v193
    v_pk_mul_f32 v[246:247], v[246:247], v[154:155] op_sel_hi:[1,0]
    v_pk_mul_f32 v[144:145], v[144:145], v[156:157] op_sel_hi:[1,0]
    v_fma_f32 v95, v95, s28, v19
    v_pk_mul_f32 v[148:149], v[148:149], v[158:159] op_sel_hi:[1,0]
    v_cvt_pk_bf16_f32 v118, v132, v133
    v_cvt_pk_bf16_f32 v144, v144, v145
    v_cvt_pk_bf16_f32 v145, v146, v147
    v_mfma_f32_16x16x32_bf16 a[12:15], a[204:207], v[104:107], 0
    s_add_u32 m0, s38, 0
    ds_read_b64_tr_b16 a[226:227], v3 offset:8192
    v_cvt_pk_bf16_f32 v148, v148, v149
    v_cvt_pk_bf16_f32 v149, v150, v151
    v_mfma_f32_16x16x32_bf16 v[20:23], a[252:255], v[108:111], v[20:23]
    ds_write2st64_b64 v14, v[144:145], v[148:149] offset0:28 offset1:40
    v_accvgpr_read_b32 v144, a20
    v_cvt_pk_bf16_f32 v119, v134, v135
    v_accvgpr_read_b32 v145, a21
    v_cvt_pk_bf16_f32 v232, v232, v233
    v_pk_mul_f32 v[194:195], v[194:195], v[152:153] op_sel_hi:[1,0]
    v_accvgpr_read_b32 v150, a70
    v_accvgpr_read_b32 v149, a69
    v_accvgpr_read_b32 v148, a68
    v_mfma_f32_16x16x32_bf16 a[60:63], a[204:207], v[108:111], 0
    s_waitcnt lgkmcnt(2)
    ds_read_b64_tr_b16 a[222:223], v6 offset:7168
    buffer_load_dwordx4 v10, s[12:15], s58 offen nt lds
    v_accvgpr_read_b32 v147, a23
    v_cvt_pk_bf16_f32 v237, v238, v239
    v_pk_mul_f32 v[144:145], v[144:145], v[156:157] op_sel_hi:[1,0]
    v_cvt_pk_bf16_f32 v233, v234, v235
    v_accvgpr_read_b32 v151, a71
    v_mfma_f32_16x16x32_bf16 v[176:179], a[208:211], v[96:99], 0
    buffer_store_dwordx4 v[136:139], v12, s[16:19], s56 offen offset:0 nt
    s_add_u32 m0, s38, 1024
    ds_read_b64_tr_b16 a[238:239], v6 offset:8192
    v_accvgpr_read_b32 v146, a22
    v_pk_mul_f32 v[198:199], v[198:199], v[152:153] op_sel_hi:[1,0]
    v_pk_mul_f32 v[150:151], v[150:151], v[158:159] op_sel_hi:[1,0]
    v_exp_f32 v134, v86
    v_pk_mul_f32 v[146:147], v[146:147], v[156:157] op_sel_hi:[1,0]
    v_pk_mul_f32 v[148:149], v[148:149], v[158:159] op_sel_hi:[1,0]
    v_cvt_pk_bf16_f32 v144, v144, v145
    v_exp_f32 v130, v82
    v_cvt_pk_bf16_f32 v145, v146, v147
    v_mfma_f32_16x16x32_bf16 v[224:227], a[208:211], v[100:103], 0
    ds_write2st64_b64 v0, v[180:181], v[228:229] offset0:4 offset1:16
    v_cvt_pk_bf16_f32 v148, v148, v149
    v_cvt_pk_bf16_f32 v149, v150, v151
    v_mfma_f32_16x16x32_bf16 a[16:19], a[208:211], v[104:107], 0
    ds_read_b64_tr_b16 a[232:233], v5 offset:2048
    v_cvt_pk_bf16_f32 v241, v242, v243
    v_mfma_f32_16x16x32_bf16 v[24:27], a[240:243], v[112:115], v[20:23]
    buffer_store_dwordx4 v[140:143], v12, s[16:19], s56 offen offset:3072 nt
    ds_write2st64_b64 v0, v[144:145], v[148:149] offset0:28 offset1:40
    v_accvgpr_read_b32 v144, a24
    v_accvgpr_read_b32 v150, a74
    v_accvgpr_read_b32 v151, a75
    v_cvt_pk_bf16_f32 v193, v194, v195
    v_cvt_pk_bf16_f32 v249, v250, v251
    v_accvgpr_read_b32 v149, a73
    v_accvgpr_read_b32 v146, a26
    v_accvgpr_read_b32 v145, a25
    v_cvt_pk_bf16_f32 v245, v246, v247
    v_accvgpr_read_b32 v148, a72
    v_pk_mul_f32 v[144:145], v[144:145], v[156:157] op_sel_hi:[1,0]
    v_cvt_pk_bf16_f32 v196, v196, v197
    v_accvgpr_read_b32 v147, a27
    v_pk_mul_f32 v[148:149], v[148:149], v[158:159] op_sel_hi:[1,0]
    v_pk_mul_f32 v[146:147], v[146:147], v[156:157] op_sel_hi:[1,0]
    v_cvt_pk_bf16_f32 v201, v202, v203
    v_fma_f32 v93, v93, s28, v19
    v_exp_f32 v133, v85
    v_mfma_f32_16x16x32_bf16 a[64:67], a[208:211], v[108:111], 0
    ds_read_b128 v[136:139], v13 offset:6144
    v_fma_f32 v90, v90, s28, v19
    v_exp_f32 v135, v87
    v_cvt_pk_bf16_f32 v144, v144, v145
    v_cvt_pk_bf16_f32 v145, v146, v147
    v_accvgpr_read_b32 v146, a30
    v_pk_mul_f32 v[150:151], v[150:151], v[158:159] op_sel_hi:[1,0]
    v_cvt_pk_bf16_f32 v148, v148, v149
    v_exp_f32 v132, v84
    v_cvt_pk_bf16_f32 v149, v150, v151
    v_mfma_f32_16x16x32_bf16 v[180:183], a[212:215], v[96:99], 0
    buffer_load_dwordx4 v11, s[12:15], s58 offen nt lds
    ds_read_b128 v[140:143], v13 offset:7168
    v_mfma_f32_16x16x32_bf16 v[228:231], a[212:215], v[100:103], 0
    s_add_u32 s57, s24, 6016
    ds_write2st64_b64 v15, v[184:185], v[232:233] offset0:4 offset1:16
    v_accvgpr_read_b32 v151, a79
    v_mfma_f32_16x16x32_bf16 a[20:23], a[212:215], v[104:107], 0
    s_add_u32 s59, s25, 6016
    ds_write2st64_b64 v15, v[144:145], v[148:149] offset0:28 offset1:40
    v_mfma_f32_16x16x32_bf16 a[68:71], a[212:215], v[108:111], 0
    s_add_u32 m0, s38, 6144
    v_accvgpr_read_b32 v150, a78
    v_exp_f32 v129, v81
    v_accvgpr_read_b32 v144, a28
    v_mfma_f32_16x16x32_bf16 v[184:187], a[216:219], v[96:99], 0
    ds_read_b64_tr_b16 a[236:237], v6 offset:2048
    v_cvt_pk_bf16_f32 v121, v130, v131
    v_accvgpr_read_b32 v149, a77
    v_accvgpr_read_b32 v147, a31
    v_accvgpr_read_b32 v148, a76
    v_pk_mul_f32 v[148:149], v[148:149], v[158:159] op_sel_hi:[1,0]
    v_accvgpr_read_b32 v145, a29
    v_cvt_pk_bf16_f32 v148, v148, v149
    v_pk_mul_f32 v[146:147], v[146:147], v[156:157] op_sel_hi:[1,0]
    v_pk_mul_f32 v[144:145], v[144:145], v[156:157] op_sel_hi:[1,0]
    v_pk_mul_f32 v[150:151], v[150:151], v[158:159] op_sel_hi:[1,0]
    v_cvt_pk_bf16_f32 v144, v144, v145
    v_cvt_pk_bf16_f32 v149, v150, v151
    v_mfma_f32_16x16x32_bf16 v[232:235], a[216:219], v[100:103], 0
    ds_write2st64_b64 v8, v[188:189], v[236:237] offset0:4 offset1:16
    v_cvt_pk_bf16_f32 v145, v146, v147
    v_mfma_f32_16x16x32_bf16 a[24:27], a[216:219], v[104:107], 0
    ds_write2st64_b64 v8, v[144:145], v[148:149] offset0:28 offset1:40
    v_accvgpr_read_b32 v146, a34
    v_accvgpr_read_b32 v148, a80
    v_cvt_pk_bf16_f32 v123, v134, v135
    v_mfma_f32_16x16x32_bf16 a[72:75], a[216:219], v[108:111], 0
    s_waitcnt lgkmcnt(3)
    ds_read_b64_tr_b16 a[224:225], v3 offset:2048
    v_accvgpr_read_b32 v145, a33
    v_mfma_f32_16x16x32_bf16 v[188:191], a[220:223], v[96:99], 0
    buffer_load_dwordx4 v10, s[12:15], s59 offen nt lds
    ds_read_b64_tr_b16 a[234:235], v5 offset:8192
    v_accvgpr_read_b32 v147, a35
    v_mfma_f32_16x16x32_bf16 v[236:239], a[220:223], v[100:103], 0
    v_accvgpr_read_b32 v150, a82
    v_accvgpr_read_b32 v149, a81
    v_accvgpr_read_b32 v144, a32
    v_accvgpr_read_b32 v151, a83
    v_cvt_pk_bf16_f32 v122, v132, v133
    v_pk_mul_f32 v[144:145], v[144:145], v[156:157] op_sel_hi:[1,0]
    v_pk_mul_f32 v[146:147], v[146:147], v[156:157] op_sel_hi:[1,0]
    v_pk_mul_f32 v[150:151], v[150:151], v[158:159] op_sel_hi:[1,0]
    v_cvt_pk_bf16_f32 v144, v144, v145
    v_exp_f32 v131, v91
    v_pk_mul_f32 v[148:149], v[148:149], v[158:159] op_sel_hi:[1,0]
    v_exp_f32 v132, v92
    v_cvt_pk_bf16_f32 v197, v198, v199
    v_cvt_pk_bf16_f32 v145, v146, v147
    v_mfma_f32_16x16x32_bf16 v[24:27], a[244:247], v[116:119], v[24:27]
    ds_write2st64_b64 v14, v[192:193], v[240:241] offset0:8 offset1:20
    v_mfma_f32_16x16x32_bf16 a[28:31], a[220:223], v[104:107], 0
    buffer_store_dwordx4 v[136:139], v12, s[16:19], s57 offen offset:0 nt
    s_add_u32 m0, s38, 7168
    v_cvt_pk_bf16_f32 v120, v128, v129
    v_cvt_pk_bf16_f32 v148, v148, v149
    v_accvgpr_read_b32 v147, a39
    v_cvt_pk_bf16_f32 v149, v150, v151
    v_exp_f32 v130, v90
    v_mfma_f32_16x16x32_bf16 a[76:79], a[220:223], v[108:111], 0
    s_waitcnt lgkmcnt(1)
    v_exp_f32 v134, v94
    v_mfma_f32_16x16x32_bf16 v[192:195], a[224:227], v[96:99], 0
    buffer_load_dwordx4 v11, s[12:15], s59 offen nt lds
    ds_read_b128 v[136:139], v13 offset:12288
    v_mfma_f32_16x16x32_bf16 v[240:243], a[224:227], v[100:103], 0
    s_add_u32 s56, s24, 12160
    ds_write2st64_b64 v14, v[144:145], v[148:149] offset0:32 offset1:44
    v_accvgpr_read_b32 v144, a36
    v_accvgpr_read_b32 v148, a84
    v_accvgpr_read_b32 v149, a85
    v_accvgpr_read_b32 v150, a86
    v_accvgpr_read_b32 v151, a87
    v_accvgpr_read_b32 v145, a37
    v_exp_f32 v135, v95
    v_mfma_f32_16x16x32_bf16 a[32:35], a[224:227], v[104:107], 0
    buffer_store_dwordx4 v[140:143], v12, s[16:19], s57 offen offset:3072 nt
    s_add_u32 s58, s25, 12160
    s_add_u32 m0, s38, 12288
    ds_read_b128 v[140:143], v13 offset:13312
    v_accvgpr_read_b32 v146, a38
    v_pk_mul_f32 v[144:145], v[144:145], v[156:157] op_sel_hi:[1,0]
    v_pk_mul_f32 v[148:149], v[148:149], v[158:159] op_sel_hi:[1,0]
    v_exp_f32 v128, v88
    v_pk_mul_f32 v[150:151], v[150:151], v[158:159] op_sel_hi:[1,0]
    v_cvt_pk_bf16_f32 v148, v148, v149
    v_cvt_pk_bf16_f32 v144, v144, v145
    v_pk_mul_f32 v[146:147], v[146:147], v[156:157] op_sel_hi:[1,0]
    v_cvt_pk_bf16_f32 v149, v150, v151
    v_cvt_pk_bf16_f32 v205, v206, v207
    v_cvt_pk_bf16_f32 v145, v146, v147
    v_exp_f32 v129, v89
    v_accvgpr_read_b32 v147, a43
    v_mfma_f32_16x16x32_bf16 a[80:83], a[224:227], v[108:111], 0
    ds_write2st64_b64 v0, v[196:197], v[244:245] offset0:8 offset1:20
    v_mfma_f32_16x16x32_bf16 v[196:199], a[228:231], v[96:99], 0
    s_waitcnt lgkmcnt(2)
    ds_write2st64_b64 v0, v[144:145], v[148:149] offset0:32 offset1:44
    buffer_load_dwordx4 v10, s[12:15], s58 offen nt lds
    v_accvgpr_read_b32 v148, a88
    v_mfma_f32_16x16x32_bf16 v[244:247], a[228:231], v[100:103], 0
    s_add_u32 m0, s38, 13312
    ds_write2st64_b64 v15, v[200:201], v[248:249] offset0:8 offset1:20
    v_cvt_pk_bf16_f32 v127, v134, v135
    v_accvgpr_read_b32 v151, a91
    v_accvgpr_read_b32 v145, a41
    v_mfma_f32_16x16x32_bf16 a[36:39], a[228:231], v[104:107], 0
    s_waitcnt lgkmcnt(3)
    buffer_load_dwordx4 v11, s[12:15], s58 offen nt lds
    v_cvt_pk_bf16_f32 v125, v130, v131
    v_accvgpr_read_b32 v146, a42
    v_exp_f32 v133, v93
    v_accvgpr_read_b32 v144, a40
    v_pk_mul_f32 v[144:145], v[144:145], v[156:157] op_sel_hi:[1,0]
    s_waitcnt vmcnt(16)
    v_accvgpr_read_b32 v149, a89
    v_accvgpr_read_b32 v150, a90
    v_mfma_f32_16x16x32_bf16 v[24:27], a[248:251], v[120:123], v[24:27]
    buffer_store_dwordx4 v[136:139], v12, s[16:19], s56 offen offset:0 nt
    s_barrier
    ds_read_b128 a[200:203], v1 offset:1024
    v_pk_mul_f32 v[148:149], v[148:149], v[158:159] op_sel_hi:[1,0]
    v_pk_mul_f32 v[146:147], v[146:147], v[156:157] op_sel_hi:[1,0]
    v_cvt_pk_bf16_f32 v148, v148, v149
    v_cvt_pk_bf16_f32 v144, v144, v145
    v_pk_mul_f32 v[150:151], v[150:151], v[158:159] op_sel_hi:[1,0]
    v_cvt_pk_bf16_f32 v145, v146, v147
    v_cvt_pk_bf16_f32 v149, v150, v151
    v_mfma_f32_16x16x32_bf16 a[84:87], a[228:231], v[108:111], 0
    ds_write2st64_b64 v15, v[144:145], v[148:149] offset0:32 offset1:44
    v_mfma_f32_16x16x32_bf16 v[200:203], a[232:235], v[96:99], 0
    ds_read_b128 a[204:207], v2 offset:1024
    v_cvt_pk_bf16_f32 v124, v128, v129
    v_mfma_f32_16x16x32_bf16 v[248:251], a[232:235], v[100:103], 0
    ds_read_b128 a[192:195], v1 offset:0
    v_cvt_pk_bf16_f32 v126, v132, v133
    v_mfma_f32_16x16x32_bf16 a[40:43], a[232:235], v[104:107], 0
    ds_read_b128 a[196:199], v2 offset:0
    v_accvgpr_read_b32 v145, a45
    v_accvgpr_read_b32 v147, a47
    v_mfma_f32_16x16x32_bf16 a[88:91], a[232:235], v[108:111], 0
    ds_write2st64_b64 v8, v[204:205], v[252:253] offset0:8 offset1:20
    v_accvgpr_read_b32 v144, a44
    v_mfma_f32_16x16x32_bf16 v[204:207], a[236:239], v[96:99], 0
    s_add_u32 m0, s22, 24576
    ds_read_b128 a[208:211], v1 offset:2048
    v_accvgpr_read_b32 v146, a46
    v_mfma_f32_16x16x32_bf16 v[252:255], a[236:239], v[100:103], 0
    v_accvgpr_read_b32 v151, a95
    v_accvgpr_read_b32 v149, a93
    v_mfma_f32_16x16x32_bf16 a[44:47], a[236:239], v[104:107], 0
    ds_read_b128 a[212:215], v2 offset:2048
    v_accvgpr_read_b32 v148, a92
    v_mfma_f32_16x16x32_bf16 v[24:27], a[252:255], v[124:127], v[24:27]
    buffer_load_dwordx4 v9, s[8:11], s21 offen lds
    v_accvgpr_read_b32 v150, a94
    v_mfma_f32_16x16x32_bf16 a[92:95], a[236:239], v[108:111], 0
    buffer_store_dwordx4 v[140:143], v12, s[16:19], s56 offen offset:3072 nt
    s_nop 0
    ds_read_b128 v[140:143], v13 offset:19456
    v_pk_mul_f32 v[146:147], v[146:147], v[156:157] op_sel_hi:[1,0]
    v_pk_mul_f32 v[144:145], v[144:145], v[156:157] op_sel_hi:[1,0]
    v_pk_mul_f32 v[150:151], v[150:151], v[158:159] op_sel_hi:[1,0]
    v_pk_mul_f32 v[148:149], v[148:149], v[158:159] op_sel_hi:[1,0]
    v_cmp_lt_f32 vcc, s29, v24
    s_waitcnt lgkmcnt(4)
    v_mfma_f32_16x16x32_bf16 v[32:35], a[192:195], a[96:99], 0
    ds_read_b128 v[136:139], v13 offset:18432
    v_mfma_f32_16x16x32_bf16 v[32:35], a[196:199], a[100:103], v[32:35]
    ds_read_b128 a[232:235], v1 offset:8192
    s_add_u32 s21, s21, 128
    v_mfma_f32_16x16x32_bf16 v[32:35], a[200:203], a[104:107], v[32:35]
    ds_read_b128 a[236:239], v2 offset:8192
    v_cvt_pk_bf16_f32 v148, v148, v149
    v_mfma_f32_16x16x32_bf16 v[32:35], a[204:207], a[108:111], v[32:35]
    s_add_u32 m0, s22, 25600
    s_waitcnt lgkmcnt(5)
    v_mfma_f32_16x16x32_bf16 v[32:35], a[208:211], a[112:115], v[32:35]
    s_waitcnt lgkmcnt(4)
    v_mfma_f32_16x16x32_bf16 v[32:35], a[212:215], a[116:119], v[32:35]
    s_cbranch_vccnz L_rs_tr44d
L_ret_tr44d:
    v_mfma_f32_16x16x32_bf16 v[40:43], a[192:195], a[120:123], 0
    buffer_load_dwordx4 v9, s[8:11], s21 offen lds
    v_mfma_f32_16x16x32_bf16 v[40:43], a[196:199], a[124:127], v[40:43]
    s_add_u32 s21, s21, 128
    ds_read_b128 a[216:219], v1 offset:6144
    s_add_u32 m0, s22, 26624
    v_mfma_f32_16x16x32_bf16 v[40:43], a[200:203], a[128:131], v[40:43]
    buffer_load_dwordx4 v9, s[8:11], s21 offen lds
    v_mfma_f32_16x16x32_bf16 v[40:43], a[204:207], a[132:135], v[40:43]
    s_add_u32 s21, s21, 12032
    ds_read_b128 a[220:223], v2 offset:6144
    v_mfma_f32_16x16x32_bf16 v[40:43], a[208:211], a[136:139], v[40:43]
    v_fma_f32 v34, v34, s28, v16
    v_add_u32 v13, 2048, v13
    v_mfma_f32_16x16x32_bf16 v[40:43], a[212:215], a[140:143], v[40:43]
    ds_read_b128 a[228:231], v2 offset:7168
    s_add_u32 s56, s24, 18304
    v_mfma_f32_16x16x32_bf16 v[48:51], a[192:195], a[144:147], 0
    v_mfma_f32_16x16x32_bf16 v[48:51], a[196:199], a[148:151], v[48:51]
    ds_read_b128 a[224:227], v1 offset:7168
    v_cvt_pk_bf16_f32 v149, v150, v151
    v_mfma_f32_16x16x32_bf16 v[48:51], a[200:203], a[152:155], v[48:51]
    s_nop 0
    v_fma_f32 v40, v40, s28, v17
    v_mfma_f32_16x16x32_bf16 v[48:51], a[204:207], a[156:159], v[48:51]
    v_cvt_pk_bf16_f32 v144, v144, v145
    v_mfma_f32_16x16x32_bf16 v[48:51], a[208:211], a[160:163], v[48:51]
    v_mfma_f32_16x16x32_bf16 v[48:51], a[212:215], a[164:167], v[48:51]
    v_fma_f32 v35, v35, s28, v16
    s_add_u32 s58, s25, 18304
    v_mfma_f32_16x16x32_bf16 v[56:59], a[192:195], a[168:171], 0
    v_fma_f32 v32, v32, s28, v16
    s_add_u32 m0, s38, 18432
    v_mfma_f32_16x16x32_bf16 v[56:59], a[196:199], a[172:175], v[56:59]
    v_fma_f32 v33, v33, s28, v16
    v_mfma_f32_16x16x32_bf16 v[56:59], a[200:203], a[176:179], v[56:59]
    s_waitcnt lgkmcnt(2)
    buffer_load_dwordx4 v10, s[12:15], s58 offen nt lds
    v_mfma_f32_16x16x32_bf16 v[56:59], a[204:207], a[180:183], v[56:59]
    s_add_u32 m0, s38, 19456
    v_exp_f32 v130, v34
    v_mfma_f32_16x16x32_bf16 v[56:59], a[208:211], a[184:187], v[56:59]
    buffer_load_dwordx4 v11, s[12:15], s58 offen nt lds
    v_mfma_f32_16x16x32_bf16 v[56:59], a[212:215], a[188:191], v[56:59]
    v_fma_f32 v41, v41, s28, v17
    v_mfma_f32_16x16x32_bf16 v[36:39], a[216:219], a[96:99], 0
    v_exp_f32 v128, v32
    v_mfma_f32_16x16x32_bf16 v[36:39], a[220:223], a[100:103], v[36:39]
    s_waitcnt lgkmcnt(0)
    v_mfma_f32_16x16x32_bf16 v[36:39], a[224:227], a[104:107], v[36:39]
    v_exp_f32 v132, v40
    v_mfma_f32_16x16x32_bf16 v[36:39], a[228:231], a[108:111], v[36:39]
    s_waitcnt vmcnt(20)
    v_exp_f32 v131, v35
    v_mfma_f32_16x16x32_bf16 v[36:39], a[232:235], a[112:115], v[36:39]
    s_barrier
    v_mfma_f32_16x16x32_bf16 v[36:39], a[236:239], a[116:119], v[36:39]
    s_add_u32 m0, s22, 0
    v_exp_f32 v129, v33
    v_mfma_f32_16x16x32_bf16 v[44:47], a[216:219], a[120:123], 0
    ds_read_b64_tr_b16 a[192:193], v3 offset:12288
    v_cvt_pk_bf16_f32 v96, v128, v129
    v_mfma_f32_16x16x32_bf16 v[44:47], a[220:223], a[124:127], v[44:47]
    buffer_load_dwordx4 v9, s[4:7], s20 offen lds
    v_mfma_f32_16x16x32_bf16 v[44:47], a[224:227], a[128:131], v[44:47]
    v_exp_f32 v133, v41
    v_mfma_f32_16x16x32_bf16 v[44:47], a[228:231], a[132:135], v[44:47]
    ds_read_b64_tr_b16 a[194:195], v3 offset:18432
    v_mfma_f32_16x16x32_bf16 v[44:47], a[232:235], a[136:139], v[44:47]
    s_add_u32 s20, s20, 128
    ds_read_b64_tr_b16 a[196:197], v4 offset:12288
    v_mfma_f32_16x16x32_bf16 v[44:47], a[236:239], a[140:143], v[44:47]
    ds_read_b64_tr_b16 a[198:199], v4 offset:18432
    v_cvt_pk_bf16_f32 v145, v146, v147
    v_mfma_f32_16x16x32_bf16 v[52:55], a[216:219], a[144:147], 0
    buffer_store_dwordx4 v[136:139], v12, s[16:19], s56 offen offset:0 nt
    s_add_u32 m0, s22, 1024
    ds_write2st64_b64 v8, v[144:145], v[148:149] offset0:32 offset1:44
    v_mfma_f32_16x16x32_bf16 v[52:55], a[220:223], a[148:151], v[52:55]
    ds_read_b64_tr_b16 a[200:201], v5 offset:12288
    v_mfma_f32_16x16x32_bf16 v[52:55], a[224:227], a[152:155], v[52:55]
    buffer_load_dwordx4 v9, s[4:7], s20 offen lds
    v_mfma_f32_16x16x32_bf16 v[52:55], a[228:231], a[156:159], v[52:55]
    ds_read_b64_tr_b16 a[202:203], v5 offset:18432
    v_mfma_f32_16x16x32_bf16 v[52:55], a[232:235], a[160:163], v[52:55]
    v_mfma_f32_16x16x32_bf16 v[52:55], a[236:239], a[164:167], v[52:55]
    buffer_store_dwordx4 v[140:143], v12, s[16:19], s56 offen offset:3072 nt
    s_add_u32 s20, s20, 128
    s_add_u32 m0, s22, 2048
    ds_read_b64_tr_b16 a[204:205], v6 offset:12288
    v_cvt_pk_bf16_f32 v97, v130, v131
    v_mfma_f32_16x16x32_bf16 v[60:63], a[216:219], a[168:171], 0
    ds_read_b64_tr_b16 a[206:207], v6 offset:18432
    v_mfma_f32_16x16x32_bf16 v[60:63], a[220:223], a[172:175], v[60:63]
    ds_read_b64_tr_b16 a[208:209], v3 offset:13312
    v_cvt_pk_bf16_f32 v100, v132, v133
    v_mfma_f32_16x16x32_bf16 v[60:63], a[224:227], a[176:179], v[60:63]
    ds_read_b64_tr_b16 a[210:211], v3 offset:19456
    v_mfma_f32_16x16x32_bf16 v[60:63], a[228:231], a[180:183], v[60:63]
    buffer_load_dwordx4 v9, s[4:7], s20 offen lds
    v_mfma_f32_16x16x32_bf16 v[60:63], a[232:235], a[184:187], v[60:63]
    ds_read_b64_tr_b16 a[212:213], v4 offset:13312
    v_mfma_f32_16x16x32_bf16 v[60:63], a[236:239], a[188:191], v[60:63]
    ds_read_b64_tr_b16 a[214:215], v4 offset:19456
    s_add_u32 s20, s20, 12032
    s_branch L_loop4
L_loop3:
    s_bitcmp1_b32 s3, 1
    s_cbranch_scc1 L_loop3w1
    .p2align 6
L_loop3w0:
    s_waitcnt lgkmcnt(10)
    v_mfma_f32_16x16x32_bf16 v[160:163], a[192:195], v[112:115], v[160:163]
    v_fma_f32 v39, v39, s28, v16
    v_fma_f32 v36, v36, s28, v16
    v_mfma_f32_16x16x32_bf16 v[208:211], a[192:195], v[116:119], v[208:211]
    v_fma_f32 v43, v43, s28, v17
    v_fma_f32 v46, v46, s28, v17
    v_mfma_f32_16x16x32_bf16 a[0:3], a[192:195], v[120:123], a[0:3]
    ds_read_b64_tr_b16 a[218:219], v5 offset:19456
    s_waitcnt lgkmcnt(9)
    v_mfma_f32_16x16x32_bf16 v[164:167], a[196:199], v[112:115], v[164:167]
    ds_read_b64_tr_b16 a[228:229], v4 offset:14336
    v_fma_f32 v38, v38, s28, v16
    v_mfma_f32_16x16x32_bf16 v[212:215], a[196:199], v[116:119], v[212:215]
    v_exp_f32 v129, v39
    v_mfma_f32_16x16x32_bf16 a[4:7], a[196:199], v[120:123], a[4:7]
    ds_read_b64_tr_b16 a[230:231], v4 offset:20480
    s_waitcnt lgkmcnt(9)
    v_mfma_f32_16x16x32_bf16 v[168:171], a[200:203], v[112:115], v[168:171]
    ds_read_b64_tr_b16 a[232:233], v5 offset:14336
    v_fma_f32 v51, v51, s28, v18
    v_mfma_f32_16x16x32_bf16 v[216:219], a[200:203], v[116:119], v[216:219]
    ds_read_b64_tr_b16 a[236:237], v6 offset:14336
    ds_read_b64_tr_b16 a[216:217], v5 offset:13312
    v_mfma_f32_16x16x32_bf16 a[8:11], a[200:203], v[120:123], a[8:11]
    s_waitcnt lgkmcnt(9)
    ds_read_b64_tr_b16 a[234:235], v5 offset:20480
    ds_read_b64_tr_b16 a[220:221], v6 offset:13312
    v_mfma_f32_16x16x32_bf16 v[172:175], a[204:207], v[112:115], v[172:175]
    ds_read_b64_tr_b16 a[224:225], v3 offset:14336
    ds_read_b64_tr_b16 a[238:239], v6 offset:20480
    v_mfma_f32_16x16x32_bf16 v[220:223], a[204:207], v[116:119], v[220:223]
    ds_read_b64_tr_b16 a[226:227], v3 offset:20480
    ds_read_b64_tr_b16 a[222:223], v6 offset:19456
    v_mfma_f32_16x16x32_bf16 a[12:15], a[204:207], v[120:123], a[12:15]
    s_waitcnt lgkmcnt(12)
    v_exp_f32 v128, v38
    v_mfma_f32_16x16x32_bf16 v[176:179], a[208:211], v[112:115], v[176:179]
    v_fma_f32 v37, v37, s28, v16
    v_fma_f32 v45, v45, s28, v17
    v_mfma_f32_16x16x32_bf16 v[224:227], a[208:211], v[116:119], v[224:227]
    v_exp_f32 v134, v36
    v_mfma_f32_16x16x32_bf16 a[16:19], a[208:211], v[120:123], a[16:19]
    v_fma_f32 v42, v42, s28, v17
    v_fma_f32 v47, v47, s28, v17
    v_mfma_f32_16x16x32_bf16 v[180:183], a[212:215], v[112:115], v[180:183]
    v_exp_f32 v135, v37
    v_mfma_f32_16x16x32_bf16 v[228:231], a[212:215], v[116:119], v[228:231]
    v_cvt_pk_bf16_f32 v98, v134, v135
    v_mfma_f32_16x16x32_bf16 a[20:23], a[212:215], v[120:123], a[20:23]
    s_waitcnt lgkmcnt(6)
    v_exp_f32 v130, v42
    v_mfma_f32_16x16x32_bf16 v[184:187], a[216:219], v[112:115], v[184:187]
    v_cvt_pk_bf16_f32 v99, v128, v129
    v_fma_f32 v54, v54, s28, v18
    v_mfma_f32_16x16x32_bf16 v[232:235], a[216:219], v[116:119], v[232:235]
    v_exp_f32 v131, v43
    v_mfma_f32_16x16x32_bf16 a[24:27], a[216:219], v[120:123], a[24:27]
    v_fma_f32 v53, v53, s28, v18
    s_waitcnt vmcnt(10) lgkmcnt(0)
    v_mfma_f32_16x16x32_bf16 v[20:23], a[240:243], v[96:99], v[24:27]
    s_barrier
    v_mfma_f32_16x16x32_bf16 v[188:191], a[220:223], v[112:115], v[188:191]
    ds_read_b128 a[204:207], v2 offset:13312
    v_fma_f32 v55, v55, s28, v18
    v_mfma_f32_16x16x32_bf16 v[236:239], a[220:223], v[116:119], v[236:239]
    s_add_u32 m0, s22, 36864
    ds_read_b128 a[200:203], v1 offset:13312
    v_fma_f32 v48, v48, s28, v18
    v_mfma_f32_16x16x32_bf16 a[28:31], a[220:223], v[120:123], a[28:31]
    buffer_load_dwordx4 v9, s[8:11], s21 offen lds
    v_mfma_f32_16x16x32_bf16 v[192:195], a[224:227], v[112:115], v[192:195]
    ds_read_b128 a[192:195], v1 offset:12288
    v_fma_f32 v44, v44, s28, v17
    v_mfma_f32_16x16x32_bf16 v[240:243], a[224:227], v[116:119], v[240:243]
    s_add_u32 s21, s21, 128
    ds_read_b128 a[196:199], v2 offset:12288
    v_mfma_f32_16x16x32_bf16 a[32:35], a[224:227], v[120:123], a[32:35]
    ds_read_b128 a[208:211], v1 offset:14336
    v_cvt_pk_bf16_f32 v101, v130, v131
    v_mfma_f32_16x16x32_bf16 v[196:199], a[228:231], v[112:115], v[196:199]
    ds_read_b128 a[212:215], v2 offset:14336
    v_fma_f32 v52, v52, s28, v18
    v_mfma_f32_16x16x32_bf16 v[244:247], a[228:231], v[116:119], v[244:247]
    s_add_u32 m0, s22, 37888
    v_fma_f32 v50, v50, s28, v18
    v_fma_f32 v49, v49, s28, v18
    v_mfma_f32_16x16x32_bf16 a[36:39], a[228:231], v[120:123], a[36:39]
    v_exp_f32 v133, v45
    v_mfma_f32_16x16x32_bf16 v[200:203], a[232:235], v[112:115], v[200:203]
    buffer_load_dwordx4 v9, s[8:11], s21 offen lds
    v_mfma_f32_16x16x32_bf16 v[248:251], a[232:235], v[116:119], v[248:251]
    s_add_u32 s21, s21, 128
    ds_read_b128 a[216:219], v1 offset:18432
    v_mfma_f32_16x16x32_bf16 a[40:43], a[232:235], v[120:123], a[40:43]
    s_add_u32 m0, s22, 38912
    v_exp_f32 v135, v47
    v_mfma_f32_16x16x32_bf16 v[204:207], a[236:239], v[112:115], v[204:207]
    v_exp_f32 v131, v51
    v_mfma_f32_16x16x32_bf16 v[252:255], a[236:239], v[116:119], v[252:255]
    buffer_load_dwordx4 v9, s[8:11], s21 offen lds
    v_mfma_f32_16x16x32_bf16 a[44:47], a[236:239], v[120:123], a[44:47]
    s_waitcnt lgkmcnt(3)
    v_exp_f32 v132, v44
    v_mfma_f32_16x16x32_bf16 v[64:67], a[192:195], a[96:99], 0
    v_exp_f32 v134, v46
    v_mfma_f32_16x16x32_bf16 v[64:67], a[196:199], a[100:103], v[64:67]
    ds_read_b128 a[220:223], v2 offset:18432
    v_cvt_pk_bf16_f32 v102, v132, v133
    v_mfma_f32_16x16x32_bf16 v[64:67], a[200:203], a[104:107], v[64:67]
    ds_read_b128 a[236:239], v2 offset:20480
    v_cvt_pk_bf16_f32 v103, v134, v135
    v_mfma_f32_16x16x32_bf16 v[64:67], a[204:207], a[108:111], v[64:67]
    s_waitcnt lgkmcnt(3)
    ds_read_b128 a[224:227], v1 offset:19456
    v_mfma_f32_16x16x32_bf16 v[64:67], a[208:211], a[112:115], v[64:67]
    v_exp_f32 v134, v54
    v_mfma_f32_16x16x32_bf16 v[64:67], a[212:215], a[116:119], v[64:67]
    ds_read_b128 a[228:231], v2 offset:19456
    v_mfma_f32_16x16x32_bf16 v[72:75], a[192:195], a[120:123], 0
    ds_read_b128 a[232:235], v1 offset:20480
    v_mfma_f32_16x16x32_bf16 v[72:75], a[196:199], a[124:127], v[72:75]
    v_exp_f32 v130, v50
    v_mfma_f32_16x16x32_bf16 v[72:75], a[200:203], a[128:131], v[72:75]
    v_exp_f32 v128, v48
    v_mfma_f32_16x16x32_bf16 v[20:23], a[244:247], v[100:103], v[20:23]
    v_exp_f32 v129, v49
    v_mfma_f32_16x16x32_bf16 v[72:75], a[204:207], a[132:135], v[72:75]
    v_mfma_f32_16x16x32_bf16 v[72:75], a[208:211], a[136:139], v[72:75]
    v_exp_f32 v132, v52
    v_mfma_f32_16x16x32_bf16 v[72:75], a[212:215], a[140:143], v[72:75]
    v_exp_f32 v135, v55
    v_mfma_f32_16x16x32_bf16 v[80:83], a[192:195], a[144:147], 0
    v_cvt_pk_bf16_f32 v107, v134, v135
    v_cvt_pk_bf16_f32 v104, v128, v129
    v_mfma_f32_16x16x32_bf16 v[80:83], a[196:199], a[148:151], v[80:83]
    v_exp_f32 v133, v53
    v_mfma_f32_16x16x32_bf16 v[80:83], a[200:203], a[152:155], v[80:83]
    v_cvt_pk_bf16_f32 v105, v130, v131
    v_mfma_f32_16x16x32_bf16 v[80:83], a[204:207], a[156:159], v[80:83]
    s_add_u32 s21, s21, 12032
    v_cvt_pk_bf16_f32 v106, v132, v133
    v_mfma_f32_16x16x32_bf16 v[80:83], a[208:211], a[160:163], v[80:83]
    s_waitcnt vmcnt(8) lgkmcnt(0)
    v_mfma_f32_16x16x32_bf16 v[20:23], a[248:251], v[104:107], v[20:23]
    s_barrier
    v_mfma_f32_16x16x32_bf16 v[80:83], a[212:215], a[164:167], v[80:83]
    s_add_u32 m0, s22, 12288
    ds_read_b64_tr_b16 a[192:193], v3 offset:0
    ds_read_b64_tr_b16 a[194:195], v3 offset:6144
    v_mfma_f32_16x16x32_bf16 v[68:71], a[216:219], a[96:99], 0
    buffer_load_dwordx4 v9, s[4:7], s20 offen lds
    v_mfma_f32_16x16x32_bf16 v[68:71], a[220:223], a[100:103], v[68:71]
    s_add_u32 s20, s20, 128
    ds_read_b64_tr_b16 a[196:197], v4 offset:0
    v_cmp_lt_f32 vcc, s29, v20
    v_mfma_f32_16x16x32_bf16 v[68:71], a[224:227], a[104:107], v[68:71]
    s_add_u32 m0, s22, 13312
    ds_read_b64_tr_b16 a[198:199], v4 offset:6144
    buffer_load_dwordx4 v9, s[4:7], s20 offen lds
    v_mfma_f32_16x16x32_bf16 v[68:71], a[228:231], a[108:111], v[68:71]
    s_cbranch_vccnz L_rs_loop3w0a
L_ret_loop3w0a:
    v_fma_f32 v66, v66, s28, v16
    v_mfma_f32_16x16x32_bf16 v[68:71], a[232:235], a[112:115], v[68:71]
    v_fma_f32 v73, v73, s28, v17
    v_fma_f32 v67, v67, s28, v16
    v_mfma_f32_16x16x32_bf16 v[68:71], a[236:239], a[116:119], v[68:71]
    ds_read_b64_tr_b16 a[200:201], v5 offset:0
    v_fma_f32 v65, v65, s28, v16
    v_mfma_f32_16x16x32_bf16 v[76:79], a[216:219], a[120:123], 0
    s_add_u32 s20, s20, 128
    ds_read_b64_tr_b16 a[202:203], v5 offset:6144
    v_fma_f32 v72, v72, s28, v17
    v_mfma_f32_16x16x32_bf16 v[76:79], a[220:223], a[124:127], v[76:79]
    v_exp_f32 v132, v72
    v_mfma_f32_16x16x32_bf16 v[76:79], a[224:227], a[128:131], v[76:79]
    s_add_u32 m0, s22, 14336
    v_fma_f32 v64, v64, s28, v16
    v_exp_f32 v128, v64
    v_mfma_f32_16x16x32_bf16 v[76:79], a[228:231], a[132:135], v[76:79]
    v_exp_f32 v130, v66
    v_mfma_f32_16x16x32_bf16 v[76:79], a[232:235], a[136:139], v[76:79]
    v_exp_f32 v129, v65
    v_mfma_f32_16x16x32_bf16 v[76:79], a[236:239], a[140:143], v[76:79]
    buffer_load_dwordx4 v9, s[4:7], s20 offen lds
    v_mfma_f32_16x16x32_bf16 v[84:87], a[216:219], a[144:147], 0
    v_exp_f32 v131, v67
    v_mfma_f32_16x16x32_bf16 v[84:87], a[220:223], a[148:151], v[84:87]
    s_add_u32 s20, s20, 12032
    ds_read_b64_tr_b16 a[204:205], v6 offset:0
    v_cvt_pk_bf16_f32 v113, v130, v131
    v_mfma_f32_16x16x32_bf16 v[84:87], a[224:227], a[152:155], v[84:87]
    ds_read_b64_tr_b16 a[206:207], v6 offset:6144
    v_exp_f32 v133, v73
    v_mfma_f32_16x16x32_bf16 v[84:87], a[228:231], a[156:159], v[84:87]
    ds_read_b64_tr_b16 a[208:209], v3 offset:1024
    v_cvt_pk_bf16_f32 v116, v132, v133
    v_mfma_f32_16x16x32_bf16 v[84:87], a[232:235], a[160:163], v[84:87]
    ds_read_b64_tr_b16 a[210:211], v3 offset:7168
    ds_read_b64_tr_b16 a[212:213], v4 offset:1024
    v_mfma_f32_16x16x32_bf16 v[84:87], a[236:239], a[164:167], v[84:87]
    ds_read_b64_tr_b16 a[214:215], v4 offset:7168
    v_cvt_pk_bf16_f32 v112, v128, v129
    s_waitcnt lgkmcnt(10)
    v_mfma_f32_16x16x32_bf16 v[160:163], a[192:195], v[96:99], v[160:163]
    ds_read_b64_tr_b16 a[228:229], v4 offset:2048
    v_fma_f32 v76, v76, s28, v17
    v_mfma_f32_16x16x32_bf16 v[208:211], a[192:195], v[100:103], v[208:211]
    s_nop 0
    v_fma_f32 v86, v86, s28, v18
    v_fma_f32 v69, v69, s28, v16
    v_mfma_f32_16x16x32_bf16 a[0:3], a[192:195], v[104:107], a[0:3]
    ds_read_b64_tr_b16 a[218:219], v5 offset:7168
    s_waitcnt lgkmcnt(10)
    v_mfma_f32_16x16x32_bf16 v[164:167], a[196:199], v[96:99], v[164:167]
    ds_read_b64_tr_b16 a[216:217], v5 offset:1024
    ds_read_b64_tr_b16 a[222:223], v6 offset:7168
    v_mfma_f32_16x16x32_bf16 v[212:215], a[196:199], v[100:103], v[212:215]
    v_exp_f32 v135, v69
    v_mfma_f32_16x16x32_bf16 a[4:7], a[196:199], v[104:107], a[4:7]
    ds_read_b128 v[136:139], v13 offset:0
    s_waitcnt lgkmcnt(11)
    v_mfma_f32_16x16x32_bf16 v[168:171], a[200:203], v[96:99], v[168:171]
    ds_read_b64_tr_b16 a[230:231], v4 offset:8192
    v_fma_f32 v70, v70, s28, v16
    v_mfma_f32_16x16x32_bf16 v[216:219], a[200:203], v[100:103], v[216:219]
    ds_read_b64_tr_b16 a[238:239], v6 offset:8192
    ds_read_b64_tr_b16 a[220:221], v6 offset:1024
    v_mfma_f32_16x16x32_bf16 a[8:11], a[200:203], v[104:107], a[8:11]
    s_waitcnt lgkmcnt(11)
    ds_read_b64_tr_b16 a[232:233], v5 offset:2048
    ds_read_b64_tr_b16 a[226:227], v3 offset:8192
    v_mfma_f32_16x16x32_bf16 v[172:175], a[204:207], v[96:99], v[172:175]
    ds_read_b64_tr_b16 a[234:235], v5 offset:8192
    ds_read_b64_tr_b16 a[236:237], v6 offset:2048
    v_mfma_f32_16x16x32_bf16 v[220:223], a[204:207], v[100:103], v[220:223]
    ds_read_b64_tr_b16 a[224:225], v3 offset:2048
    v_fma_f32 v68, v68, s28, v16
    v_mfma_f32_16x16x32_bf16 a[12:15], a[204:207], v[104:107], a[12:15]
    s_waitcnt lgkmcnt(12)
    ds_read_b128 v[140:143], v13 offset:1024
    v_fma_f32 v78, v78, s28, v17
    v_mfma_f32_16x16x32_bf16 v[176:179], a[208:211], v[96:99], v[176:179]
    v_exp_f32 v134, v68
    v_mfma_f32_16x16x32_bf16 v[224:227], a[208:211], v[100:103], v[224:227]
    v_fma_f32 v71, v71, s28, v16
    v_fma_f32 v87, v87, s28, v18
    v_mfma_f32_16x16x32_bf16 a[16:19], a[208:211], v[104:107], a[16:19]
    v_exp_f32 v128, v70
    v_mfma_f32_16x16x32_bf16 v[180:183], a[212:215], v[96:99], v[180:183]
    v_exp_f32 v129, v71
    v_mfma_f32_16x16x32_bf16 v[228:231], a[212:215], v[100:103], v[228:231]
    v_cvt_pk_bf16_f32 v115, v128, v129
    v_mfma_f32_16x16x32_bf16 a[20:23], a[212:215], v[104:107], a[20:23]
    s_waitcnt lgkmcnt(6)
    v_fma_f32 v81, v81, s28, v18
    v_cvt_pk_bf16_f32 v114, v134, v135
    v_mfma_f32_16x16x32_bf16 v[184:187], a[216:219], v[96:99], v[184:187]
    v_exp_f32 v132, v76
    v_mfma_f32_16x16x32_bf16 v[232:235], a[216:219], v[100:103], v[232:235]
    buffer_store_dwordx4 v[136:139], v12, s[16:19], s24 offen offset:0 nt
    v_fma_f32 v80, v80, s28, v18
    v_exp_f32 v134, v78
    v_mfma_f32_16x16x32_bf16 v[24:27], a[240:243], v[112:115], v[20:23]
    s_waitcnt vmcnt(7) lgkmcnt(0)
    v_fma_f32 v83, v83, s28, v18
    v_fma_f32 v74, v74, s28, v17
    v_mfma_f32_16x16x32_bf16 a[24:27], a[216:219], v[104:107], a[24:27]
    s_barrier
    v_mfma_f32_16x16x32_bf16 v[188:191], a[220:223], v[96:99], v[188:191]
    ds_read_b128 a[208:211], v1 offset:2048
    v_fma_f32 v82, v82, s28, v18
    v_mfma_f32_16x16x32_bf16 v[236:239], a[220:223], v[100:103], v[236:239]
    s_add_u32 m0, s22, 24576
    ds_read_b128 a[204:207], v2 offset:1024
    v_fma_f32 v77, v77, s28, v17
    v_mfma_f32_16x16x32_bf16 a[28:31], a[220:223], v[104:107], a[28:31]
    buffer_load_dwordx4 v9, s[8:11], s21 offen lds
    v_mfma_f32_16x16x32_bf16 v[192:195], a[224:227], v[96:99], v[192:195]
    ds_read_b128 a[196:199], v2 offset:0
    v_mfma_f32_16x16x32_bf16 v[240:243], a[224:227], v[100:103], v[240:243]
    v_exp_f32 v129, v81
    v_mfma_f32_16x16x32_bf16 a[32:35], a[224:227], v[104:107], a[32:35]
    s_add_u32 s21, s21, 128
    ds_read_b128 a[192:195], v1 offset:0
    v_fma_f32 v75, v75, s28, v17
    v_mfma_f32_16x16x32_bf16 v[196:199], a[228:231], v[96:99], v[196:199]
    s_add_u32 m0, s22, 25600
    ds_read_b128 a[212:215], v2 offset:2048
    v_fma_f32 v79, v79, s28, v17
    v_mfma_f32_16x16x32_bf16 v[244:247], a[228:231], v[100:103], v[244:247]
    ds_read_b128 a[200:203], v1 offset:1024
    v_fma_f32 v85, v85, s28, v18
    v_mfma_f32_16x16x32_bf16 a[36:39], a[228:231], v[104:107], a[36:39]
    buffer_load_dwordx4 v9, s[8:11], s21 offen lds
    v_mfma_f32_16x16x32_bf16 v[200:203], a[232:235], v[96:99], v[200:203]
    v_exp_f32 v130, v74
    v_mfma_f32_16x16x32_bf16 v[248:251], a[232:235], v[100:103], v[248:251]
    buffer_store_dwordx4 v[140:143], v12, s[16:19], s24 offen offset:3072 nt
    s_add_u32 s21, s21, 128
    s_add_u32 m0, s22, 26624
    ds_read_b128 a[220:223], v2 offset:6144
    v_exp_f32 v131, v75
    v_mfma_f32_16x16x32_bf16 a[40:43], a[232:235], v[104:107], a[40:43]
    ds_read_b128 a[224:227], v1 offset:7168
    v_cvt_pk_bf16_f32 v117, v130, v131
    v_mfma_f32_16x16x32_bf16 v[204:207], a[236:239], v[96:99], v[204:207]
    buffer_load_dwordx4 v9, s[8:11], s21 offen lds
    v_mfma_f32_16x16x32_bf16 v[252:255], a[236:239], v[100:103], v[252:255]
    s_add_u32 s21, s21, 12032
    v_exp_f32 v133, v77
    v_mfma_f32_16x16x32_bf16 a[44:47], a[236:239], v[104:107], a[44:47]
    s_waitcnt lgkmcnt(4)
    v_exp_f32 v135, v79
    v_mfma_f32_16x16x32_bf16 v[32:35], a[192:195], a[96:99], 0
    s_add_u32 m0, s23, 0
    v_cvt_pk_bf16_f32 v118, v132, v133
    v_mfma_f32_16x16x32_bf16 v[32:35], a[196:199], a[100:103], v[32:35]
    s_waitcnt lgkmcnt(2)
    ds_read_b128 a[228:231], v2 offset:7168
    v_cvt_pk_bf16_f32 v119, v134, v135
    v_mfma_f32_16x16x32_bf16 v[32:35], a[200:203], a[104:107], v[32:35]
    buffer_load_dwordx4 v10, s[12:15], s25 offen nt lds
    v_mfma_f32_16x16x32_bf16 v[32:35], a[204:207], a[108:111], v[32:35]
    v_exp_f32 v128, v80
    v_mfma_f32_16x16x32_bf16 v[32:35], a[208:211], a[112:115], v[32:35]
    s_add_u32 m0, s23, 1024
    v_exp_f32 v134, v86
    v_mfma_f32_16x16x32_bf16 v[32:35], a[212:215], a[116:119], v[32:35]
    ds_read_b128 a[232:235], v1 offset:8192
    v_cvt_pk_bf16_f32 v120, v128, v129
    v_mfma_f32_16x16x32_bf16 v[40:43], a[192:195], a[120:123], 0
    ds_read_b128 a[216:219], v1 offset:6144
    v_fma_f32 v84, v84, s28, v18
    v_mfma_f32_16x16x32_bf16 v[40:43], a[196:199], a[124:127], v[40:43]
    ds_read_b128 a[236:239], v2 offset:8192
    v_mfma_f32_16x16x32_bf16 v[40:43], a[200:203], a[128:131], v[40:43]
    v_exp_f32 v132, v84
    v_mfma_f32_16x16x32_bf16 v[40:43], a[204:207], a[132:135], v[40:43]
    buffer_load_dwordx4 v11, s[12:15], s25 offen nt lds
    v_mfma_f32_16x16x32_bf16 v[40:43], a[208:211], a[136:139], v[40:43]
    s_bitcmp1_b32 s30, 0
    v_exp_f32 v131, v83
    v_mfma_f32_16x16x32_bf16 v[40:43], a[212:215], a[140:143], v[40:43]
    s_cselect_b32 s26, s49, 128
    v_exp_f32 v133, v85
    v_mfma_f32_16x16x32_bf16 v[48:51], a[192:195], a[144:147], 0
    s_cselect_b32 s27, s39, 2048
    s_add_u32 s24, s24, s26
    v_cvt_pk_bf16_f32 v122, v132, v133
    v_mfma_f32_16x16x32_bf16 v[48:51], a[196:199], a[148:151], v[48:51]
    v_exp_f32 v130, v82
    v_mfma_f32_16x16x32_bf16 v[48:51], a[200:203], a[152:155], v[48:51]
    v_exp_f32 v135, v87
    v_mfma_f32_16x16x32_bf16 v[48:51], a[204:207], a[156:159], v[48:51]
    s_add_u32 s25, s25, s26
    v_cvt_pk_bf16_f32 v121, v130, v131
    v_cvt_pk_bf16_f32 v123, v134, v135
    v_mfma_f32_16x16x32_bf16 v[48:51], a[208:211], a[160:163], v[48:51]
    s_add_u32 s23, s23, s27
    v_mfma_f32_16x16x32_bf16 v[24:27], a[244:247], v[116:119], v[24:27]
    s_waitcnt vmcnt(10) lgkmcnt(0)
    v_mfma_f32_16x16x32_bf16 v[24:27], a[248:251], v[120:123], v[24:27]
    s_barrier
    v_mfma_f32_16x16x32_bf16 v[48:51], a[212:215], a[164:167], v[48:51]
    s_add_u32 m0, s22, 0
    ds_read_b64_tr_b16 a[192:193], v3 offset:12288
    buffer_load_dwordx4 v9, s[4:7], s20 offen lds
    v_mfma_f32_16x16x32_bf16 v[36:39], a[216:219], a[96:99], 0
    s_add_u32 s20, s20, 128
    ds_read_b64_tr_b16 a[194:195], v3 offset:18432
    v_cmp_lt_f32 vcc, s29, v24
    v_mfma_f32_16x16x32_bf16 v[36:39], a[220:223], a[100:103], v[36:39]
    ds_read_b64_tr_b16 a[196:197], v4 offset:12288
    ds_read_b64_tr_b16 a[198:199], v4 offset:18432
    ds_read_b64_tr_b16 a[200:201], v5 offset:12288
    v_mfma_f32_16x16x32_bf16 v[36:39], a[224:227], a[104:107], v[36:39]
    s_cbranch_vccnz L_rs_loop3w0b
L_ret_loop3w0b:
    v_fma_f32 v32, v32, s28, v16
    v_mfma_f32_16x16x32_bf16 v[36:39], a[228:231], a[108:111], v[36:39]
    ds_read_b64_tr_b16 a[202:203], v5 offset:18432
    v_fma_f32 v41, v41, s28, v17
    v_mfma_f32_16x16x32_bf16 v[36:39], a[232:235], a[112:115], v[36:39]
    v_fma_f32 v34, v34, s28, v16
    v_fma_f32 v40, v40, s28, v17
    v_mfma_f32_16x16x32_bf16 v[36:39], a[236:239], a[116:119], v[36:39]
    v_exp_f32 v130, v34
    v_mfma_f32_16x16x32_bf16 v[44:47], a[216:219], a[120:123], 0
    s_add_u32 m0, s22, 1024
    ds_read_b64_tr_b16 a[204:205], v6 offset:12288
    ds_read_b64_tr_b16 a[206:207], v6 offset:18432
    v_mfma_f32_16x16x32_bf16 v[44:47], a[220:223], a[124:127], v[44:47]
    buffer_load_dwordx4 v9, s[4:7], s20 offen lds
    v_mfma_f32_16x16x32_bf16 v[44:47], a[224:227], a[128:131], v[44:47]
    ds_read_b64_tr_b16 a[208:209], v3 offset:13312
    v_fma_f32 v33, v33, s28, v16
    v_mfma_f32_16x16x32_bf16 v[44:47], a[228:231], a[132:135], v[44:47]
    v_exp_f32 v133, v41
    v_mfma_f32_16x16x32_bf16 v[44:47], a[232:235], a[136:139], v[44:47]
    ds_read_b64_tr_b16 a[210:211], v3 offset:19456
    v_fma_f32 v35, v35, s28, v16
    v_mfma_f32_16x16x32_bf16 v[44:47], a[236:239], a[140:143], v[44:47]
    s_add_u32 s20, s20, 128
    v_exp_f32 v129, v33
    v_mfma_f32_16x16x32_bf16 v[52:55], a[216:219], a[144:147], 0
    s_add_u32 m0, s22, 2048
    v_exp_f32 v128, v32
    v_mfma_f32_16x16x32_bf16 v[52:55], a[220:223], a[148:151], v[52:55]
    buffer_load_dwordx4 v9, s[4:7], s20 offen lds
    v_add_u32 v13, s27, v13
    v_mfma_f32_16x16x32_bf16 v[52:55], a[224:227], a[152:155], v[52:55]
    v_exp_f32 v131, v35
    v_mfma_f32_16x16x32_bf16 v[52:55], a[228:231], a[156:159], v[52:55]
    s_add_u32 s20, s20, 12032
    v_cvt_pk_bf16_f32 v97, v130, v131
    v_exp_f32 v132, v40
    v_mfma_f32_16x16x32_bf16 v[52:55], a[232:235], a[160:163], v[52:55]
    s_add_u32 s30, s30, 1
    ds_read_b64_tr_b16 a[212:213], v4 offset:13312
    ds_read_b64_tr_b16 a[214:215], v4 offset:19456
    v_mfma_f32_16x16x32_bf16 v[52:55], a[236:239], a[164:167], v[52:55]
    s_cmp_lt_u32 s30, 6
    v_cvt_pk_bf16_f32 v96, v128, v129
    v_cvt_pk_bf16_f32 v100, v132, v133
    s_cbranch_scc1 L_loop3w0
    s_cmp_ge_u32 s37, 8
    s_cbranch_scc1 L_end3
    s_cmp_eq_u32 s32, 0
    s_cbranch_scc1 L_tr33
    s_branch L_tr34
    .p2align 6
L_loop3w1:
    s_waitcnt lgkmcnt(10)
    v_mfma_f32_16x16x32_bf16 v[160:163], a[192:195], v[112:115], v[160:163]
    ds_read_b64_tr_b16 a[232:233], v5 offset:14336
    ds_read_b64_tr_b16 a[228:229], v4 offset:14336
    v_mfma_f32_16x16x32_bf16 v[208:211], a[192:195], v[116:119], v[208:211]
    ds_read_b64_tr_b16 a[230:231], v4 offset:20480
    ds_read_b64_tr_b16 a[226:227], v3 offset:20480
    v_mfma_f32_16x16x32_bf16 a[0:3], a[192:195], v[120:123], a[0:3]
    ds_read_b64_tr_b16 a[236:237], v6 offset:14336
    s_waitcnt lgkmcnt(13)
    v_mfma_f32_16x16x32_bf16 v[164:167], a[196:199], v[112:115], v[164:167]
    ds_read_b64_tr_b16 a[238:239], v6 offset:20480
    ds_read_b64_tr_b16 a[220:221], v6 offset:13312
    v_mfma_f32_16x16x32_bf16 v[212:215], a[196:199], v[116:119], v[212:215]
    ds_read_b64_tr_b16 a[234:235], v5 offset:20480
    ds_read_b64_tr_b16 a[222:223], v6 offset:19456
    v_mfma_f32_16x16x32_bf16 a[4:7], a[196:199], v[120:123], a[4:7]
    ds_read_b64_tr_b16 a[216:217], v5 offset:13312
    s_waitcnt lgkmcnt(15)
    v_mfma_f32_16x16x32_bf16 v[168:171], a[200:203], v[112:115], v[168:171]
    ds_read_b64_tr_b16 a[218:219], v5 offset:19456
    v_fma_f32 v36, v36, s28, v16
    v_mfma_f32_16x16x32_bf16 v[216:219], a[200:203], v[116:119], v[216:219]
    ds_read_b64_tr_b16 a[224:225], v3 offset:14336
    v_fma_f32 v44, v44, s28, v17
    v_mfma_f32_16x16x32_bf16 a[8:11], a[200:203], v[120:123], a[8:11]
    s_waitcnt lgkmcnt(15)
    v_fma_f32 v49, v49, s28, v18
    v_fma_f32 v42, v42, s28, v17
    v_mfma_f32_16x16x32_bf16 v[172:175], a[204:207], v[112:115], v[172:175]
    v_fma_f32 v37, v37, s28, v16
    v_fma_f32 v45, v45, s28, v17
    v_mfma_f32_16x16x32_bf16 v[220:223], a[204:207], v[116:119], v[220:223]
    v_exp_f32 v133, v45
    v_mfma_f32_16x16x32_bf16 a[12:15], a[204:207], v[120:123], a[12:15]
    s_waitcnt lgkmcnt(8)
    v_fma_f32 v47, v47, s28, v17
    v_fma_f32 v54, v54, s28, v18
    v_mfma_f32_16x16x32_bf16 v[176:179], a[208:211], v[112:115], v[176:179]
    v_fma_f32 v39, v39, s28, v16
    v_fma_f32 v52, v52, s28, v18
    v_mfma_f32_16x16x32_bf16 v[224:227], a[208:211], v[116:119], v[224:227]
    v_exp_f32 v135, v37
    v_mfma_f32_16x16x32_bf16 a[16:19], a[208:211], v[120:123], a[16:19]
    v_exp_f32 v129, v39
    v_mfma_f32_16x16x32_bf16 v[180:183], a[212:215], v[112:115], v[180:183]
    v_exp_f32 v132, v44
    v_mfma_f32_16x16x32_bf16 v[228:231], a[212:215], v[116:119], v[228:231]
    v_exp_f32 v130, v42
    v_mfma_f32_16x16x32_bf16 a[20:23], a[212:215], v[120:123], a[20:23]
    s_waitcnt vmcnt(10) lgkmcnt(0)
    v_exp_f32 v134, v36
    v_mfma_f32_16x16x32_bf16 v[184:187], a[216:219], v[112:115], v[184:187]
    v_cvt_pk_bf16_f32 v98, v134, v135
    v_fma_f32 v55, v55, s28, v18
    v_mfma_f32_16x16x32_bf16 v[232:235], a[216:219], v[116:119], v[232:235]
    s_barrier
    v_mfma_f32_16x16x32_bf16 a[24:27], a[216:219], v[120:123], a[24:27]
    s_add_u32 m0, s22, 36864
    v_fma_f32 v50, v50, s28, v18
    v_fma_f32 v51, v51, s28, v18
    v_mfma_f32_16x16x32_bf16 v[188:191], a[220:223], v[112:115], v[188:191]
    ds_read_b128 a[192:195], v1 offset:12288
    v_fma_f32 v43, v43, s28, v17
    v_mfma_f32_16x16x32_bf16 v[236:239], a[220:223], v[116:119], v[236:239]
    ds_read_b128 a[196:199], v2 offset:12288
    v_fma_f32 v38, v38, s28, v16
    v_mfma_f32_16x16x32_bf16 a[28:31], a[220:223], v[120:123], a[28:31]
    buffer_load_dwordx4 v9, s[8:11], s21 offen lds
    v_mfma_f32_16x16x32_bf16 v[192:195], a[224:227], v[112:115], v[192:195]
    v_exp_f32 v135, v47
    v_mfma_f32_16x16x32_bf16 v[240:243], a[224:227], v[116:119], v[240:243]
    s_add_u32 s21, s21, 128
    v_exp_f32 v131, v43
    v_mfma_f32_16x16x32_bf16 a[32:35], a[224:227], v[120:123], a[32:35]
    v_exp_f32 v128, v38
    v_mfma_f32_16x16x32_bf16 v[196:199], a[228:231], v[112:115], v[196:199]
    s_add_u32 m0, s22, 37888
    ds_read_b128 a[200:203], v1 offset:13312
    v_mfma_f32_16x16x32_bf16 v[244:247], a[228:231], v[116:119], v[244:247]
    ds_read_b128 a[208:211], v1 offset:14336
    v_cvt_pk_bf16_f32 v101, v130, v131
    v_mfma_f32_16x16x32_bf16 a[36:39], a[228:231], v[120:123], a[36:39]
    ds_read_b128 a[204:207], v2 offset:13312
    v_cvt_pk_bf16_f32 v102, v132, v133
    v_mfma_f32_16x16x32_bf16 v[200:203], a[232:235], v[112:115], v[200:203]
    buffer_load_dwordx4 v9, s[8:11], s21 offen lds
    v_mfma_f32_16x16x32_bf16 v[248:251], a[232:235], v[116:119], v[248:251]
    ds_read_b128 a[212:215], v2 offset:14336
    v_fma_f32 v46, v46, s28, v17
    v_mfma_f32_16x16x32_bf16 a[40:43], a[232:235], v[120:123], a[40:43]
    ds_read_b128 a[220:223], v2 offset:18432
    v_fma_f32 v53, v53, s28, v18
    v_mfma_f32_16x16x32_bf16 v[204:207], a[236:239], v[112:115], v[204:207]
    ds_read_b128 a[216:219], v1 offset:18432
    v_cvt_pk_bf16_f32 v99, v128, v129
    v_mfma_f32_16x16x32_bf16 v[252:255], a[236:239], v[116:119], v[252:255]
    ds_read_b128 a[228:231], v2 offset:19456
    v_mfma_f32_16x16x32_bf16 a[44:47], a[236:239], v[120:123], a[44:47]
    s_waitcnt lgkmcnt(7)
    ds_read_b128 a[232:235], v1 offset:20480
    v_fma_f32 v48, v48, s28, v18
    v_mfma_f32_16x16x32_bf16 v[64:67], a[192:195], a[96:99], 0
    s_add_u32 s21, s21, 128
    v_exp_f32 v134, v46
    v_mfma_f32_16x16x32_bf16 v[64:67], a[196:199], a[100:103], v[64:67]
    s_add_u32 m0, s22, 38912
    v_cvt_pk_bf16_f32 v103, v134, v135
    s_waitcnt lgkmcnt(7)
    v_mfma_f32_16x16x32_bf16 v[64:67], a[200:203], a[104:107], v[64:67]
    buffer_load_dwordx4 v9, s[8:11], s21 offen lds
    v_mfma_f32_16x16x32_bf16 v[20:23], a[240:243], v[96:99], v[24:27]
    s_waitcnt lgkmcnt(5)
    ds_read_b128 a[224:227], v1 offset:19456
    v_mfma_f32_16x16x32_bf16 v[64:67], a[204:207], a[108:111], v[64:67]
    v_exp_f32 v133, v53
    v_mfma_f32_16x16x32_bf16 v[64:67], a[208:211], a[112:115], v[64:67]
    s_waitcnt lgkmcnt(5)
    v_exp_f32 v128, v48
    v_mfma_f32_16x16x32_bf16 v[64:67], a[212:215], a[116:119], v[64:67]
    ds_read_b128 a[236:239], v2 offset:20480
    v_mfma_f32_16x16x32_bf16 v[72:75], a[192:195], a[120:123], 0
    v_exp_f32 v130, v50
    v_mfma_f32_16x16x32_bf16 v[72:75], a[196:199], a[124:127], v[72:75]
    v_exp_f32 v131, v51
    v_mfma_f32_16x16x32_bf16 v[20:23], a[244:247], v[100:103], v[20:23]
    v_exp_f32 v129, v49
    v_mfma_f32_16x16x32_bf16 v[72:75], a[200:203], a[128:131], v[72:75]
    v_exp_f32 v132, v52
    v_mfma_f32_16x16x32_bf16 v[72:75], a[204:207], a[132:135], v[72:75]
    v_exp_f32 v135, v55
    v_mfma_f32_16x16x32_bf16 v[72:75], a[208:211], a[136:139], v[72:75]
    v_cvt_pk_bf16_f32 v104, v128, v129
    v_cvt_pk_bf16_f32 v106, v132, v133
    v_mfma_f32_16x16x32_bf16 v[72:75], a[212:215], a[140:143], v[72:75]
    v_exp_f32 v134, v54
    v_mfma_f32_16x16x32_bf16 v[80:83], a[192:195], a[144:147], 0
    v_cvt_pk_bf16_f32 v105, v130, v131
    v_mfma_f32_16x16x32_bf16 v[80:83], a[196:199], a[148:151], v[80:83]
    s_add_u32 s21, s21, 12032
    v_cvt_pk_bf16_f32 v107, v134, v135
    v_mfma_f32_16x16x32_bf16 v[80:83], a[200:203], a[152:155], v[80:83]
    s_waitcnt vmcnt(9) lgkmcnt(0)
    s_add_u32 m0, s22, 12288
    v_mfma_f32_16x16x32_bf16 v[20:23], a[248:251], v[104:107], v[20:23]
    s_barrier
    v_mfma_f32_16x16x32_bf16 v[80:83], a[204:207], a[156:159], v[80:83]
    buffer_load_dwordx4 v9, s[4:7], s20 offen lds
    v_mfma_f32_16x16x32_bf16 v[80:83], a[208:211], a[160:163], v[80:83]
    ds_read_b64_tr_b16 a[192:193], v3 offset:0
    ds_read_b64_tr_b16 a[194:195], v3 offset:6144
    v_mfma_f32_16x16x32_bf16 v[80:83], a[212:215], a[164:167], v[80:83]
    s_add_u32 s20, s20, 128
    ds_read_b64_tr_b16 a[196:197], v4 offset:0
    v_cmp_lt_f32 vcc, s29, v20
    v_mfma_f32_16x16x32_bf16 v[68:71], a[216:219], a[96:99], 0
    ds_read_b64_tr_b16 a[198:199], v4 offset:6144
    ds_read_b64_tr_b16 a[200:201], v5 offset:0
    v_mfma_f32_16x16x32_bf16 v[68:71], a[220:223], a[100:103], v[68:71]
    ds_read_b64_tr_b16 a[202:203], v5 offset:6144
    ds_read_b64_tr_b16 a[204:205], v6 offset:0
    v_mfma_f32_16x16x32_bf16 v[68:71], a[224:227], a[104:107], v[68:71]
    s_cbranch_vccnz L_rs_loop3w1a
L_ret_loop3w1a:
    v_fma_f32 v73, v73, s28, v17
    v_mfma_f32_16x16x32_bf16 v[68:71], a[228:231], a[108:111], v[68:71]
    v_fma_f32 v65, v65, s28, v16
    v_fma_f32 v64, v64, s28, v16
    v_mfma_f32_16x16x32_bf16 v[68:71], a[232:235], a[112:115], v[68:71]
    s_add_u32 m0, s22, 13312
    v_exp_f32 v129, v65
    v_mfma_f32_16x16x32_bf16 v[68:71], a[236:239], a[116:119], v[68:71]
    v_fma_f32 v67, v67, s28, v16
    v_fma_f32 v66, v66, s28, v16
    v_mfma_f32_16x16x32_bf16 v[76:79], a[216:219], a[120:123], 0
    ds_read_b64_tr_b16 a[206:207], v6 offset:6144
    ds_read_b64_tr_b16 a[208:209], v3 offset:1024
    v_mfma_f32_16x16x32_bf16 v[76:79], a[220:223], a[124:127], v[76:79]
    v_exp_f32 v131, v67
    v_mfma_f32_16x16x32_bf16 v[76:79], a[224:227], a[128:131], v[76:79]
    buffer_load_dwordx4 v9, s[4:7], s20 offen lds
    v_mfma_f32_16x16x32_bf16 v[76:79], a[228:231], a[132:135], v[76:79]
    s_add_u32 s20, s20, 128
    v_exp_f32 v128, v64
    v_mfma_f32_16x16x32_bf16 v[76:79], a[232:235], a[136:139], v[76:79]
    v_exp_f32 v130, v66
    v_mfma_f32_16x16x32_bf16 v[76:79], a[236:239], a[140:143], v[76:79]
    s_add_u32 m0, s22, 14336
    v_fma_f32 v72, v72, s28, v17
    v_cvt_pk_bf16_f32 v113, v130, v131
    v_mfma_f32_16x16x32_bf16 v[84:87], a[216:219], a[144:147], 0
    ds_read_b64_tr_b16 a[210:211], v3 offset:7168
    v_mfma_f32_16x16x32_bf16 v[84:87], a[220:223], a[148:151], v[84:87]
    v_exp_f32 v133, v73
    v_mfma_f32_16x16x32_bf16 v[84:87], a[224:227], a[152:155], v[84:87]
    buffer_load_dwordx4 v9, s[4:7], s20 offen lds
    v_mfma_f32_16x16x32_bf16 v[84:87], a[228:231], a[156:159], v[84:87]
    ds_read_b64_tr_b16 a[212:213], v4 offset:1024
    ds_read_b64_tr_b16 a[214:215], v4 offset:7168
    v_mfma_f32_16x16x32_bf16 v[84:87], a[232:235], a[160:163], v[84:87]
    v_exp_f32 v132, v72
    v_mfma_f32_16x16x32_bf16 v[84:87], a[236:239], a[164:167], v[84:87]
    s_add_u32 s20, s20, 12032
    v_cvt_pk_bf16_f32 v116, v132, v133
    v_cvt_pk_bf16_f32 v112, v128, v129
    ds_read_b128 v[136:139], v13 offset:0
    s_waitcnt lgkmcnt(11)
    v_mfma_f32_16x16x32_bf16 v[160:163], a[192:195], v[96:99], v[160:163]
    ds_read_b64_tr_b16 a[222:223], v6 offset:7168
    ds_read_b64_tr_b16 a[232:233], v5 offset:2048
    v_fma_f32 v80, v80, s28, v18
    v_fma_f32 v69, v69, s28, v16
    v_mfma_f32_16x16x32_bf16 v[208:211], a[192:195], v[100:103], v[208:211]
    ds_read_b64_tr_b16 a[236:237], v6 offset:2048
    v_fma_f32 v77, v77, s28, v17
    v_mfma_f32_16x16x32_bf16 a[0:3], a[192:195], v[104:107], a[0:3]
    s_waitcnt lgkmcnt(12)
    ds_read_b64_tr_b16 a[230:231], v4 offset:8192
    ds_read_b64_tr_b16 a[228:229], v4 offset:2048
    v_mfma_f32_16x16x32_bf16 v[164:167], a[196:199], v[96:99], v[164:167]
    ds_read_b64_tr_b16 a[216:217], v5 offset:1024
    v_fma_f32 v84, v84, s28, v18
    v_fma_f32 v70, v70, s28, v16
    v_mfma_f32_16x16x32_bf16 v[212:215], a[196:199], v[100:103], v[212:215]
    ds_read_b64_tr_b16 a[238:239], v6 offset:8192
    v_fma_f32 v79, v79, s28, v17
    v_mfma_f32_16x16x32_bf16 a[4:7], a[196:199], v[104:107], a[4:7]
    s_waitcnt lgkmcnt(14)
    v_exp_f32 v133, v77
    v_mfma_f32_16x16x32_bf16 v[168:171], a[200:203], v[96:99], v[168:171]
    v_exp_f32 v128, v70
    v_mfma_f32_16x16x32_bf16 v[216:219], a[200:203], v[100:103], v[216:219]
    ds_read_b64_tr_b16 a[218:219], v5 offset:7168
    v_fma_f32 v74, v74, s28, v17
    v_mfma_f32_16x16x32_bf16 a[8:11], a[200:203], v[104:107], a[8:11]
    s_waitcnt lgkmcnt(8)
    ds_read_b64_tr_b16 a[224:225], v3 offset:2048
    ds_read_b64_tr_b16 a[220:221], v6 offset:1024
    v_mfma_f32_16x16x32_bf16 v[172:175], a[204:207], v[96:99], v[172:175]
    ds_read_b64_tr_b16 a[226:227], v3 offset:8192
    v_fma_f32 v83, v83, s28, v18
    v_mfma_f32_16x16x32_bf16 v[220:223], a[204:207], v[100:103], v[220:223]
    ds_read_b64_tr_b16 a[234:235], v5 offset:8192
    ds_read_b128 v[140:143], v13 offset:1024
    v_mfma_f32_16x16x32_bf16 a[12:15], a[204:207], v[104:107], a[12:15]
    v_fma_f32 v71, v71, s28, v16
    v_fma_f32 v68, v68, s28, v16
    v_exp_f32 v134, v68
    v_mfma_f32_16x16x32_bf16 v[176:179], a[208:211], v[96:99], v[176:179]
    v_exp_f32 v135, v69
    v_mfma_f32_16x16x32_bf16 v[224:227], a[208:211], v[100:103], v[224:227]
    v_fma_f32 v75, v75, s28, v17
    v_exp_f32 v129, v71
    v_mfma_f32_16x16x32_bf16 a[16:19], a[208:211], v[104:107], a[16:19]
    v_exp_f32 v130, v74
    v_mfma_f32_16x16x32_bf16 v[180:183], a[212:215], v[96:99], v[180:183]
    buffer_store_dwordx4 v[136:139], v12, s[16:19], s24 offen offset:0 nt
    v_exp_f32 v131, v75
    v_cvt_pk_bf16_f32 v115, v128, v129
    v_cvt_pk_bf16_f32 v114, v134, v135
    v_mfma_f32_16x16x32_bf16 v[228:231], a[212:215], v[100:103], v[228:231]
    v_fma_f32 v85, v85, s28, v18
    v_fma_f32 v78, v78, s28, v17
    v_mfma_f32_16x16x32_bf16 a[20:23], a[212:215], v[104:107], a[20:23]
    s_waitcnt lgkmcnt(2)
    v_exp_f32 v135, v79
    v_mfma_f32_16x16x32_bf16 v[184:187], a[216:219], v[96:99], v[184:187]
    s_waitcnt vmcnt(7) lgkmcnt(0)
    v_exp_f32 v128, v80
    v_mfma_f32_16x16x32_bf16 v[24:27], a[240:243], v[112:115], v[20:23]
    s_barrier
    ds_read_b128 a[208:211], v1 offset:2048
    v_mfma_f32_16x16x32_bf16 v[232:235], a[216:219], v[100:103], v[232:235]
    v_exp_f32 v134, v78
    v_mfma_f32_16x16x32_bf16 a[24:27], a[216:219], v[104:107], a[24:27]
    ds_read_b128 a[196:199], v2 offset:0
    v_fma_f32 v76, v76, s28, v17
    v_mfma_f32_16x16x32_bf16 v[188:191], a[220:223], v[96:99], v[188:191]
    ds_read_b128 a[192:195], v1 offset:0
    v_cvt_pk_bf16_f32 v117, v130, v131
    v_mfma_f32_16x16x32_bf16 v[236:239], a[220:223], v[100:103], v[236:239]
    v_fma_f32 v87, v87, s28, v18
    v_fma_f32 v82, v82, s28, v18
    v_mfma_f32_16x16x32_bf16 a[28:31], a[220:223], v[104:107], a[28:31]
    s_add_u32 m0, s22, 24576
    ds_read_b128 a[200:203], v1 offset:1024
    v_cvt_pk_bf16_f32 v119, v134, v135
    v_mfma_f32_16x16x32_bf16 v[192:195], a[224:227], v[96:99], v[192:195]
    buffer_load_dwordx4 v9, s[8:11], s21 offen lds
    v_mfma_f32_16x16x32_bf16 v[240:243], a[224:227], v[100:103], v[240:243]
    s_add_u32 s21, s21, 128
    v_exp_f32 v135, v87
    v_mfma_f32_16x16x32_bf16 a[32:35], a[224:227], v[104:107], a[32:35]
    v_exp_f32 v132, v76
    v_mfma_f32_16x16x32_bf16 v[196:199], a[228:231], v[96:99], v[196:199]
    s_add_u32 m0, s22, 25600
    ds_read_b128 a[204:207], v2 offset:1024
    v_fma_f32 v81, v81, s28, v18
    v_mfma_f32_16x16x32_bf16 v[244:247], a[228:231], v[100:103], v[244:247]
    buffer_load_dwordx4 v9, s[8:11], s21 offen lds
    v_mfma_f32_16x16x32_bf16 a[36:39], a[228:231], v[104:107], a[36:39]
    s_add_u32 s21, s21, 128
    v_exp_f32 v131, v83
    v_mfma_f32_16x16x32_bf16 v[200:203], a[232:235], v[96:99], v[200:203]
    s_add_u32 m0, s22, 26624
    v_exp_f32 v129, v81
    v_mfma_f32_16x16x32_bf16 v[248:251], a[232:235], v[100:103], v[248:251]
    ds_read_b128 a[212:215], v2 offset:2048
    v_cvt_pk_bf16_f32 v118, v132, v133
    v_mfma_f32_16x16x32_bf16 a[40:43], a[232:235], v[104:107], a[40:43]
    ds_read_b128 a[228:231], v2 offset:7168
    v_exp_f32 v132, v84
    v_mfma_f32_16x16x32_bf16 v[204:207], a[236:239], v[96:99], v[204:207]
    buffer_load_dwordx4 v9, s[8:11], s21 offen lds
    v_mfma_f32_16x16x32_bf16 v[252:255], a[236:239], v[100:103], v[252:255]
    buffer_store_dwordx4 v[140:143], v12, s[16:19], s24 offen offset:3072 nt
    ds_read_b128 a[220:223], v2 offset:6144
    v_exp_f32 v133, v85
    v_mfma_f32_16x16x32_bf16 v[24:27], a[244:247], v[116:119], v[24:27]
    v_exp_f32 v130, v82
    v_mfma_f32_16x16x32_bf16 a[44:47], a[236:239], v[104:107], a[44:47]
    s_waitcnt lgkmcnt(3)
    ds_read_b128 a[236:239], v2 offset:8192
    ds_read_b128 a[216:219], v1 offset:6144
    v_mfma_f32_16x16x32_bf16 v[32:35], a[192:195], a[96:99], 0
    ds_read_b128 a[232:235], v1 offset:8192
    v_fma_f32 v86, v86, s28, v18
    v_mfma_f32_16x16x32_bf16 v[32:35], a[196:199], a[100:103], v[32:35]
    v_exp_f32 v134, v86
    v_mfma_f32_16x16x32_bf16 v[32:35], a[200:203], a[104:107], v[32:35]
    v_cvt_pk_bf16_f32 v120, v128, v129
    v_cvt_pk_bf16_f32 v123, v134, v135
    v_mfma_f32_16x16x32_bf16 v[32:35], a[204:207], a[108:111], v[32:35]
    v_cvt_pk_bf16_f32 v121, v130, v131
    v_cvt_pk_bf16_f32 v122, v132, v133
    v_mfma_f32_16x16x32_bf16 v[32:35], a[208:211], a[112:115], v[32:35]
    s_add_u32 s21, s21, 12032
    v_mfma_f32_16x16x32_bf16 v[24:27], a[248:251], v[120:123], v[24:27]
    s_add_u32 m0, s23, 0
    ds_read_b128 a[224:227], v1 offset:7168
    s_waitcnt lgkmcnt(5)
    v_mfma_f32_16x16x32_bf16 v[32:35], a[212:215], a[116:119], v[32:35]
    v_mfma_f32_16x16x32_bf16 v[40:43], a[192:195], a[120:123], 0
    buffer_load_dwordx4 v10, s[12:15], s25 offen nt lds
    v_mfma_f32_16x16x32_bf16 v[40:43], a[196:199], a[124:127], v[40:43]
    s_nop 0
    v_cmp_lt_f32 vcc, s29, v24
    s_add_u32 m0, s23, 1024
    v_mfma_f32_16x16x32_bf16 v[40:43], a[200:203], a[128:131], v[40:43]
    buffer_load_dwordx4 v11, s[12:15], s25 offen nt lds
    v_mfma_f32_16x16x32_bf16 v[40:43], a[204:207], a[132:135], v[40:43]
    s_nop 0
    s_cbranch_vccnz L_rs_loop3w1b
L_ret_loop3w1b:
    v_mfma_f32_16x16x32_bf16 v[40:43], a[208:211], a[136:139], v[40:43]
    s_bitcmp1_b32 s30, 0
    v_fma_f32 v35, v35, s28, v16
    v_mfma_f32_16x16x32_bf16 v[40:43], a[212:215], a[140:143], v[40:43]
    s_cselect_b32 s26, s49, 128
    v_fma_f32 v33, v33, s28, v16
    s_cselect_b32 s27, s39, 2048
    v_mfma_f32_16x16x32_bf16 v[48:51], a[192:195], a[144:147], 0
    s_add_u32 s24, s24, s26
    v_exp_f32 v129, v33
    v_mfma_f32_16x16x32_bf16 v[48:51], a[196:199], a[148:151], v[48:51]
    s_add_u32 s25, s25, s26
    s_add_u32 s23, s23, s27
    s_waitcnt vmcnt(10) lgkmcnt(0)
    v_mfma_f32_16x16x32_bf16 v[48:51], a[200:203], a[152:155], v[48:51]
    s_barrier
    v_mfma_f32_16x16x32_bf16 v[48:51], a[204:207], a[156:159], v[48:51]
    v_exp_f32 v131, v35
    v_mfma_f32_16x16x32_bf16 v[48:51], a[208:211], a[160:163], v[48:51]
    v_add_u32 v13, s27, v13
    v_fma_f32 v40, v40, s28, v17
    v_mfma_f32_16x16x32_bf16 v[48:51], a[212:215], a[164:167], v[48:51]
    v_fma_f32 v34, v34, s28, v16
    v_mfma_f32_16x16x32_bf16 v[36:39], a[216:219], a[96:99], 0
    ds_read_b64_tr_b16 a[192:193], v3 offset:12288
    ds_read_b64_tr_b16 a[194:195], v3 offset:18432
    v_mfma_f32_16x16x32_bf16 v[36:39], a[220:223], a[100:103], v[36:39]
    s_add_u32 m0, s22, 0
    v_exp_f32 v130, v34
    v_mfma_f32_16x16x32_bf16 v[36:39], a[224:227], a[104:107], v[36:39]
    buffer_load_dwordx4 v9, s[4:7], s20 offen lds
    v_mfma_f32_16x16x32_bf16 v[36:39], a[228:231], a[108:111], v[36:39]
    ds_read_b64_tr_b16 a[196:197], v4 offset:12288
    s_add_u32 s20, s20, 128
    v_mfma_f32_16x16x32_bf16 v[36:39], a[232:235], a[112:115], v[36:39]
    v_fma_f32 v41, v41, s28, v17
    v_mfma_f32_16x16x32_bf16 v[36:39], a[236:239], a[116:119], v[36:39]
    s_add_u32 m0, s22, 1024
    ds_read_b64_tr_b16 a[198:199], v4 offset:18432
    ds_read_b64_tr_b16 a[200:201], v5 offset:12288
    v_mfma_f32_16x16x32_bf16 v[44:47], a[216:219], a[120:123], 0
    buffer_load_dwordx4 v9, s[4:7], s20 offen lds
    v_mfma_f32_16x16x32_bf16 v[44:47], a[220:223], a[124:127], v[44:47]
    s_add_u32 s20, s20, 128
    ds_read_b64_tr_b16 a[202:203], v5 offset:18432
    v_mfma_f32_16x16x32_bf16 v[44:47], a[224:227], a[128:131], v[44:47]
    s_add_u32 m0, s22, 2048
    v_exp_f32 v132, v40
    v_mfma_f32_16x16x32_bf16 v[44:47], a[228:231], a[132:135], v[44:47]
    v_exp_f32 v133, v41
    v_mfma_f32_16x16x32_bf16 v[44:47], a[232:235], a[136:139], v[44:47]
    buffer_load_dwordx4 v9, s[4:7], s20 offen lds
    v_mfma_f32_16x16x32_bf16 v[44:47], a[236:239], a[140:143], v[44:47]
    ds_read_b64_tr_b16 a[204:205], v6 offset:12288
    v_fma_f32 v32, v32, s28, v16
    v_mfma_f32_16x16x32_bf16 v[52:55], a[216:219], a[144:147], 0
    v_exp_f32 v128, v32
    v_mfma_f32_16x16x32_bf16 v[52:55], a[220:223], a[148:151], v[52:55]
    ds_read_b64_tr_b16 a[206:207], v6 offset:18432
    ds_read_b64_tr_b16 a[208:209], v3 offset:13312
    v_mfma_f32_16x16x32_bf16 v[52:55], a[224:227], a[152:155], v[52:55]
    s_add_u32 s20, s20, 12032
    v_cvt_pk_bf16_f32 v100, v132, v133
    v_cvt_pk_bf16_f32 v96, v128, v129
    v_mfma_f32_16x16x32_bf16 v[52:55], a[228:231], a[156:159], v[52:55]
    s_add_u32 s30, s30, 1
    ds_read_b64_tr_b16 a[210:211], v3 offset:19456
    v_cvt_pk_bf16_f32 v97, v130, v131
    v_mfma_f32_16x16x32_bf16 v[52:55], a[232:235], a[160:163], v[52:55]
    ds_read_b64_tr_b16 a[212:213], v4 offset:13312
    ds_read_b64_tr_b16 a[214:215], v4 offset:19456
    v_mfma_f32_16x16x32_bf16 v[52:55], a[236:239], a[164:167], v[52:55]
    s_cmp_lt_u32 s30, 6
    s_cbranch_scc1 L_loop3w1
    s_cmp_ge_u32 s37, 8
    s_cbranch_scc1 L_end3
    s_cmp_eq_u32 s32, 0
    s_cbranch_scc1 L_tr33
    s_branch L_tr34
L_tr34:
    s_waitcnt lgkmcnt(10)
    v_mfma_f32_16x16x32_bf16 v[160:163], a[192:195], v[112:115], v[160:163]
    ds_read_b64_tr_b16 a[224:225], v3 offset:14336
    v_fma_f32 v36, v36, s28, v16
    v_fma_f32 v37, v37, s28, v16
    v_fma_f32 v39, v39, s28, v16
    v_mfma_f32_16x16x32_bf16 v[208:211], a[192:195], v[116:119], v[208:211]
    ds_read_b64_tr_b16 a[216:217], v5 offset:13312
    v_fma_f32 v38, v38, s28, v16
    v_mfma_f32_16x16x32_bf16 a[0:3], a[192:195], v[120:123], a[0:3]
    s_waitcnt lgkmcnt(10)
    ds_read_b64_tr_b16 a[220:221], v6 offset:13312
    v_fma_f32 v55, v55, s28, v18
    v_mfma_f32_16x16x32_bf16 v[164:167], a[196:199], v[112:115], v[164:167]
    ds_read_b64_tr_b16 a[238:239], v6 offset:20480
    v_fma_f32 v47, v47, s28, v17
    v_mfma_f32_16x16x32_bf16 v[212:215], a[196:199], v[116:119], v[212:215]
    ds_read_b64_tr_b16 a[218:219], v5 offset:19456
    ds_read_b64_tr_b16 a[236:237], v6 offset:14336
    v_mfma_f32_16x16x32_bf16 a[4:7], a[196:199], v[120:123], a[4:7]
    s_waitcnt lgkmcnt(12)
    ds_read_b64_tr_b16 a[232:233], v5 offset:14336
    v_exp_f32 v128, v38
    v_mfma_f32_16x16x32_bf16 v[168:171], a[200:203], v[112:115], v[168:171]
    ds_read_b64_tr_b16 a[222:223], v6 offset:19456
    v_fma_f32 v45, v45, s28, v17
    v_mfma_f32_16x16x32_bf16 v[216:219], a[200:203], v[116:119], v[216:219]
    ds_read_b64_tr_b16 a[234:235], v5 offset:20480
    v_fma_f32 v54, v54, s28, v18
    v_mfma_f32_16x16x32_bf16 a[8:11], a[200:203], v[120:123], a[8:11]
    s_waitcnt lgkmcnt(9)
    ds_read_b64_tr_b16 a[228:229], v4 offset:14336
    v_fma_f32 v43, v43, s28, v17
    v_mfma_f32_16x16x32_bf16 v[172:175], a[204:207], v[112:115], v[172:175]
    ds_read_b64_tr_b16 a[226:227], v3 offset:20480
    v_fma_f32 v44, v44, s28, v17
    v_mfma_f32_16x16x32_bf16 v[220:223], a[204:207], v[116:119], v[220:223]
    ds_read_b64_tr_b16 a[230:231], v4 offset:20480
    v_exp_f32 v131, v43
    v_mfma_f32_16x16x32_bf16 a[12:15], a[204:207], v[120:123], a[12:15]
    ds_read_b128 v[136:139], v13 offset:0
    v_exp_f32 v134, v36
    v_mfma_f32_16x16x32_bf16 v[176:179], a[208:211], v[112:115], v[176:179]
    v_exp_f32 v129, v39
    v_mfma_f32_16x16x32_bf16 v[224:227], a[208:211], v[116:119], v[224:227]
    v_exp_f32 v133, v45
    v_fma_f32 v42, v42, s28, v17
    v_mfma_f32_16x16x32_bf16 a[16:19], a[208:211], v[120:123], a[16:19]
    v_exp_f32 v132, v44
    v_mfma_f32_16x16x32_bf16 v[180:183], a[212:215], v[112:115], v[180:183]
    v_exp_f32 v130, v42
    v_mfma_f32_16x16x32_bf16 v[228:231], a[212:215], v[116:119], v[228:231]
    v_fma_f32 v51, v51, s28, v18
    v_cvt_pk_bf16_f32 v99, v128, v129
    v_exp_f32 v135, v37
    v_mfma_f32_16x16x32_bf16 a[20:23], a[212:215], v[120:123], a[20:23]
    s_waitcnt lgkmcnt(3)
    ds_read_b128 v[140:143], v13 offset:1024
    v_cvt_pk_bf16_f32 v102, v132, v133
    v_mfma_f32_16x16x32_bf16 v[184:187], a[216:219], v[112:115], v[184:187]
    v_fma_f32 v53, v53, s28, v18
    v_cvt_pk_bf16_f32 v98, v134, v135
    v_mfma_f32_16x16x32_bf16 v[232:235], a[216:219], v[116:119], v[232:235]
    v_cvt_pk_bf16_f32 v101, v130, v131
    v_fma_f32 v46, v46, s28, v17
    v_exp_f32 v134, v46
    v_mfma_f32_16x16x32_bf16 v[20:23], a[240:243], v[96:99], v[24:27]
    s_waitcnt vmcnt(10) lgkmcnt(1)
    v_exp_f32 v135, v47
    v_mfma_f32_16x16x32_bf16 a[24:27], a[216:219], v[120:123], a[24:27]
    buffer_store_dwordx4 v[136:139], v12, s[16:19], s24 offen offset:0 nt
    s_barrier
    ds_read_b128 a[196:199], v2 offset:12288
    v_fma_f32 v50, v50, s28, v18
    v_mfma_f32_16x16x32_bf16 v[188:191], a[220:223], v[112:115], v[188:191]
    ds_read_b128 a[192:195], v1 offset:12288
    v_fma_f32 v49, v49, s28, v18
    v_mfma_f32_16x16x32_bf16 v[236:239], a[220:223], v[116:119], v[236:239]
    s_add_u32 m0, s22, 36864
    ds_read_b128 a[204:207], v2 offset:13312
    v_fma_f32 v52, v52, s28, v18
    v_mfma_f32_16x16x32_bf16 a[28:31], a[220:223], v[120:123], a[28:31]
    buffer_load_dwordx4 v9, s[8:11], s21 offen lds
    v_mfma_f32_16x16x32_bf16 v[192:195], a[224:227], v[112:115], v[192:195]
    ds_read_b128 a[200:203], v1 offset:13312
    v_cvt_pk_bf16_f32 v103, v134, v135
    v_mfma_f32_16x16x32_bf16 v[240:243], a[224:227], v[116:119], v[240:243]
    s_add_u32 s21, s21, 128
    v_exp_f32 v132, v52
    v_mfma_f32_16x16x32_bf16 a[32:35], a[224:227], v[120:123], a[32:35]
    s_add_u32 m0, s22, 37888
    v_exp_f32 v135, v55
    v_mfma_f32_16x16x32_bf16 v[196:199], a[228:231], v[112:115], v[196:199]
    v_exp_f32 v134, v54
    v_mfma_f32_16x16x32_bf16 v[244:247], a[228:231], v[116:119], v[244:247]
    buffer_load_dwordx4 v9, s[8:11], s21 offen lds
    v_mfma_f32_16x16x32_bf16 v[20:23], a[244:247], v[100:103], v[20:23]
    ds_read_b128 a[212:215], v2 offset:14336
    v_fma_f32 v48, v48, s28, v18
    v_mfma_f32_16x16x32_bf16 a[36:39], a[228:231], v[120:123], a[36:39]
    s_add_u32 s21, s21, 128
    ds_read_b128 a[208:211], v1 offset:14336
    v_cvt_pk_bf16_f32 v107, v134, v135
    v_mfma_f32_16x16x32_bf16 v[200:203], a[232:235], v[112:115], v[200:203]
    s_add_u32 m0, s22, 38912
    v_exp_f32 v130, v50
    v_mfma_f32_16x16x32_bf16 v[248:251], a[232:235], v[116:119], v[248:251]
    buffer_load_dwordx4 v9, s[8:11], s21 offen lds
    v_mfma_f32_16x16x32_bf16 a[40:43], a[232:235], v[120:123], a[40:43]
    v_exp_f32 v128, v48
    v_mfma_f32_16x16x32_bf16 v[204:207], a[236:239], v[112:115], v[204:207]
    s_add_u32 s21, s21, 12032
    ds_read_b128 a[228:231], v2 offset:19456
    v_mfma_f32_16x16x32_bf16 v[252:255], a[236:239], v[116:119], v[252:255]
    s_add_u32 m0, s38, 20480
    v_exp_f32 v133, v53
    v_mfma_f32_16x16x32_bf16 a[44:47], a[236:239], v[120:123], a[44:47]
    s_waitcnt lgkmcnt(3)
    v_exp_f32 v131, v51
    v_mfma_f32_16x16x32_bf16 v[64:67], a[192:195], a[96:99], 0
    buffer_load_dwordx4 v10, s[12:15], s25 offen nt lds
    v_mfma_f32_16x16x32_bf16 v[64:67], a[196:199], a[100:103], v[64:67]
    buffer_store_dwordx4 v[140:143], v12, s[16:19], s24 offen offset:3072 nt
    ds_read_b128 v[136:139], v13 offset:2048
    v_exp_f32 v129, v49
    v_mfma_f32_16x16x32_bf16 v[64:67], a[200:203], a[104:107], v[64:67]
    s_add_u32 m0, s38, 21504
    ds_read_b128 a[236:239], v2 offset:20480
    v_cvt_pk_bf16_f32 v106, v132, v133
    v_mfma_f32_16x16x32_bf16 v[64:67], a[204:207], a[108:111], v[64:67]
    s_waitcnt lgkmcnt(3)
    v_cvt_pk_bf16_f32 v104, v128, v129
    v_cvt_pk_bf16_f32 v105, v130, v131
    v_mfma_f32_16x16x32_bf16 v[64:67], a[208:211], a[112:115], v[64:67]
    buffer_load_dwordx4 v11, s[12:15], s25 offen nt lds
    v_mfma_f32_16x16x32_bf16 v[20:23], a[248:251], v[104:107], v[20:23]
    ds_read_b128 a[232:235], v1 offset:20480
    v_mfma_f32_16x16x32_bf16 v[64:67], a[212:215], a[116:119], v[64:67]
    s_add_u32 s57, s24, 128
    ds_read_b128 v[140:143], v13 offset:3072
    v_mfma_f32_16x16x32_bf16 v[72:75], a[192:195], a[120:123], 0
    ds_read_b128 a[216:219], v1 offset:18432
    v_mfma_f32_16x16x32_bf16 v[72:75], a[196:199], a[124:127], v[72:75]
    ds_read_b128 a[220:223], v2 offset:18432
    v_cmp_lt_f32 vcc, s29, v20
    v_mfma_f32_16x16x32_bf16 v[72:75], a[200:203], a[128:131], v[72:75]
    s_add_u32 s59, s25, 128
    ds_read_b128 a[224:227], v1 offset:19456
    s_add_u32 m0, s38, 22528
    v_mfma_f32_16x16x32_bf16 v[72:75], a[204:207], a[132:135], v[72:75]
    s_cbranch_vccnz L_rs_tr34a
L_ret_tr34a:
    v_mfma_f32_16x16x32_bf16 v[72:75], a[208:211], a[136:139], v[72:75]
    s_waitcnt lgkmcnt(6)
    buffer_load_dwordx4 v10, s[12:15], s59 offen nt lds
    v_mfma_f32_16x16x32_bf16 v[72:75], a[212:215], a[140:143], v[72:75]
    v_fma_f32 v65, v65, s28, v16
    v_fma_f32 v64, v64, s28, v16
    v_mfma_f32_16x16x32_bf16 v[80:83], a[192:195], a[144:147], 0
    v_fma_f32 v67, v67, s28, v16
    s_add_u32 m0, s38, 23552
    v_mfma_f32_16x16x32_bf16 v[80:83], a[196:199], a[148:151], v[80:83]
    s_nop 1
    v_fma_f32 v73, v73, s28, v17
    v_mfma_f32_16x16x32_bf16 v[80:83], a[200:203], a[152:155], v[80:83]
    v_exp_f32 v128, v64
    v_mfma_f32_16x16x32_bf16 v[80:83], a[204:207], a[156:159], v[80:83]
    s_waitcnt lgkmcnt(3)
    buffer_load_dwordx4 v11, s[12:15], s59 offen nt lds
    v_mfma_f32_16x16x32_bf16 v[80:83], a[208:211], a[160:163], v[80:83]
    buffer_store_dwordx4 v[136:139], v12, s[16:19], s57 offen offset:0 nt
    s_waitcnt vmcnt(13) lgkmcnt(0)
    s_barrier
    v_mfma_f32_16x16x32_bf16 v[80:83], a[212:215], a[164:167], v[80:83]
    s_add_u32 m0, s22, 12288
    v_exp_f32 v129, v65
    v_mfma_f32_16x16x32_bf16 v[68:71], a[216:219], a[96:99], 0
    buffer_load_dwordx4 v9, s[4:7], s20 offen lds
    v_mfma_f32_16x16x32_bf16 v[68:71], a[220:223], a[100:103], v[68:71]
    ds_read_b64_tr_b16 a[192:193], v3 offset:0
    v_fma_f32 v72, v72, s28, v17
    v_mfma_f32_16x16x32_bf16 v[68:71], a[224:227], a[104:107], v[68:71]
    s_add_u32 s20, s20, 128
    ds_read_b64_tr_b16 a[194:195], v3 offset:6144
    s_add_u32 m0, s22, 13312
    v_mfma_f32_16x16x32_bf16 v[68:71], a[228:231], a[108:111], v[68:71]
    ds_read_b64_tr_b16 a[196:197], v4 offset:0
    v_mfma_f32_16x16x32_bf16 v[68:71], a[232:235], a[112:115], v[68:71]
    buffer_load_dwordx4 v9, s[4:7], s20 offen lds
    v_mfma_f32_16x16x32_bf16 v[68:71], a[236:239], a[116:119], v[68:71]
    ds_read_b64_tr_b16 a[198:199], v4 offset:6144
    v_mfma_f32_16x16x32_bf16 v[76:79], a[216:219], a[120:123], 0
    s_add_u32 s20, s20, 128
    ds_read_b64_tr_b16 a[200:201], v5 offset:0
    v_fma_f32 v66, v66, s28, v16
    v_mfma_f32_16x16x32_bf16 v[76:79], a[220:223], a[124:127], v[76:79]
    v_exp_f32 v130, v66
    v_mfma_f32_16x16x32_bf16 v[76:79], a[224:227], a[128:131], v[76:79]
    s_add_u32 m0, s22, 14336
    ds_read_b64_tr_b16 a[202:203], v5 offset:6144
    v_mfma_f32_16x16x32_bf16 v[76:79], a[228:231], a[132:135], v[76:79]
    buffer_load_dwordx4 v9, s[4:7], s20 offen lds
    v_mfma_f32_16x16x32_bf16 v[76:79], a[232:235], a[136:139], v[76:79]
    v_exp_f32 v132, v72
    v_mfma_f32_16x16x32_bf16 v[76:79], a[236:239], a[140:143], v[76:79]
    ds_read_b64_tr_b16 a[204:205], v6 offset:0
    v_cvt_pk_bf16_f32 v112, v128, v129
    v_mfma_f32_16x16x32_bf16 v[84:87], a[216:219], a[144:147], 0
    s_add_u32 s20, s20, 12032
    ds_read_b64_tr_b16 a[206:207], v6 offset:6144
    v_mfma_f32_16x16x32_bf16 v[84:87], a[220:223], a[148:151], v[84:87]
    buffer_store_dwordx4 v[140:143], v12, s[16:19], s57 offen offset:3072 nt
    ds_read_b64_tr_b16 a[208:209], v3 offset:1024
    v_exp_f32 v133, v73
    v_mfma_f32_16x16x32_bf16 v[84:87], a[224:227], a[152:155], v[84:87]
    v_exp_f32 v131, v67
    v_mfma_f32_16x16x32_bf16 v[84:87], a[228:231], a[156:159], v[84:87]
    ds_read_b64_tr_b16 a[210:211], v3 offset:7168
    v_cvt_pk_bf16_f32 v116, v132, v133
    v_mfma_f32_16x16x32_bf16 v[84:87], a[232:235], a[160:163], v[84:87]
    ds_read_b64_tr_b16 a[212:213], v4 offset:1024
    v_mfma_f32_16x16x32_bf16 v[84:87], a[236:239], a[164:167], v[84:87]
    ds_read_b64_tr_b16 a[214:215], v4 offset:7168
    v_cvt_pk_bf16_f32 v113, v130, v131
    ds_read_b64_tr_b16 a[224:225], v3 offset:2048
    s_waitcnt lgkmcnt(11)
    v_mfma_f32_16x16x32_bf16 v[160:163], a[192:195], v[96:99], v[160:163]
    ds_read_b128 a[96:99], v7 offset:0
    v_fma_f32 v70, v70, s28, v16
    v_mfma_f32_16x16x32_bf16 v[208:211], a[192:195], v[100:103], v[208:211]
    ds_read_b64_tr_b16 a[238:239], v6 offset:8192
    v_exp_f32 v128, v70
    v_mfma_f32_16x16x32_bf16 a[0:3], a[192:195], v[104:107], a[0:3]
    s_waitcnt lgkmcnt(11)
    ds_read_b64_tr_b16 a[222:223], v6 offset:7168
    v_xor_b32 v8, 64, v7
    v_mfma_f32_16x16x32_bf16 v[164:167], a[196:199], v[96:99], v[164:167]
    ds_read_b64_tr_b16 a[218:219], v5 offset:7168
    v_mfma_f32_16x16x32_bf16 v[212:215], a[196:199], v[100:103], v[212:215]
    ds_read_b64_tr_b16 a[216:217], v5 offset:1024
    v_fma_f32 v69, v69, s28, v16
    v_mfma_f32_16x16x32_bf16 a[4:7], a[196:199], v[104:107], a[4:7]
    s_waitcnt lgkmcnt(12)
    ds_read_b64_tr_b16 a[234:235], v5 offset:8192
    v_fma_f32 v77, v77, s28, v17
    v_mfma_f32_16x16x32_bf16 v[168:171], a[200:203], v[96:99], v[168:171]
    ds_read_b64_tr_b16 a[228:229], v4 offset:2048
    v_fma_f32 v68, v68, s28, v16
    v_mfma_f32_16x16x32_bf16 v[216:219], a[200:203], v[100:103], v[216:219]
    ds_read_b64_tr_b16 a[226:227], v3 offset:8192
    ds_read_b64_tr_b16 a[220:221], v6 offset:1024
    v_mfma_f32_16x16x32_bf16 a[8:11], a[200:203], v[104:107], a[8:11]
    s_waitcnt lgkmcnt(11)
    ds_read_b128 a[116:119], v8 offset:4096
    v_fma_f32 v86, v86, s28, v18
    v_mfma_f32_16x16x32_bf16 v[172:175], a[204:207], v[96:99], v[172:175]
    ds_read_b64_tr_b16 a[236:237], v6 offset:2048
    v_exp_f32 v135, v69
    v_mfma_f32_16x16x32_bf16 v[220:223], a[204:207], v[100:103], v[220:223]
    ds_read_b64_tr_b16 a[230:231], v4 offset:8192
    v_mfma_f32_16x16x32_bf16 a[12:15], a[204:207], v[104:107], a[12:15]
    ds_read_b64_tr_b16 a[232:233], v5 offset:2048
    v_fma_f32 v85, v85, s28, v18
    v_mfma_f32_16x16x32_bf16 v[176:179], a[208:211], v[96:99], v[176:179]
    ds_read_b128 a[124:127], v8 offset:6144
    v_fma_f32 v71, v71, s28, v16
    v_mfma_f32_16x16x32_bf16 v[224:227], a[208:211], v[100:103], v[224:227]
    ds_read_b128 a[132:135], v8 offset:8192
    v_exp_f32 v129, v71
    v_mfma_f32_16x16x32_bf16 a[16:19], a[208:211], v[104:107], a[16:19]
    s_waitcnt lgkmcnt(10)
    ds_read_b128 a[100:103], v8 offset:0
    v_fma_f32 v74, v74, s28, v17
    v_mfma_f32_16x16x32_bf16 v[180:183], a[212:215], v[96:99], v[180:183]
    ds_read_b128 a[128:131], v7 offset:8192
    v_fma_f32 v79, v79, s28, v17
    v_mfma_f32_16x16x32_bf16 v[228:231], a[212:215], v[100:103], v[228:231]
    ds_read_b128 a[168:171], v7 offset:18432
    v_exp_f32 v130, v74
    v_mfma_f32_16x16x32_bf16 a[20:23], a[212:215], v[104:107], a[20:23]
    ds_read_b128 a[104:107], v7 offset:2048
    v_exp_f32 v134, v68
    v_mfma_f32_16x16x32_bf16 v[184:187], a[216:219], v[96:99], v[184:187]
    ds_read_b128 a[108:111], v8 offset:2048
    v_fma_f32 v75, v75, s28, v17
    v_mfma_f32_16x16x32_bf16 v[232:235], a[216:219], v[100:103], v[232:235]
    ds_read_b128 a[136:139], v7 offset:10240
    v_mfma_f32_16x16x32_bf16 a[24:27], a[216:219], v[104:107], a[24:27]
    s_waitcnt vmcnt(14) lgkmcnt(8)
    ds_read_b128 a[156:159], v8 offset:14336
    v_fma_f32 v78, v78, s28, v17
    v_mfma_f32_16x16x32_bf16 v[188:191], a[220:223], v[96:99], v[188:191]
    s_barrier
    ds_read_b128 a[192:195], v1 offset:0
    v_mfma_f32_16x16x32_bf16 v[236:239], a[220:223], v[100:103], v[236:239]
    ds_read_b128 a[204:207], v2 offset:1024
    v_mfma_f32_16x16x32_bf16 a[28:31], a[220:223], v[104:107], a[28:31]
    ds_read_b128 a[112:115], v7 offset:4096
    v_cvt_pk_bf16_f32 v114, v134, v135
    v_mfma_f32_16x16x32_bf16 v[192:195], a[224:227], v[96:99], v[192:195]
    ds_read_b128 a[196:199], v2 offset:0
    v_mfma_f32_16x16x32_bf16 v[240:243], a[224:227], v[100:103], v[240:243]
    s_add_u32 m0, s22, 24576
    ds_read_b128 a[200:203], v1 offset:1024
    v_fma_f32 v81, v81, s28, v18
    v_mfma_f32_16x16x32_bf16 a[32:35], a[224:227], v[104:107], a[32:35]
    buffer_load_dwordx4 v9, s[8:11], s21 offen lds
    ds_read_b128 a[212:215], v2 offset:2048
    v_mfma_f32_16x16x32_bf16 v[196:199], a[228:231], v[96:99], v[196:199]
    s_add_u32 s21, s21, 128
    ds_read_b128 a[208:211], v1 offset:2048
    v_fma_f32 v82, v82, s28, v18
    v_mfma_f32_16x16x32_bf16 v[244:247], a[228:231], v[100:103], v[244:247]
    s_add_u32 m0, s22, 25600
    ds_read_b128 a[164:167], v8 offset:16384
    v_fma_f32 v83, v83, s28, v18
    v_mfma_f32_16x16x32_bf16 a[36:39], a[228:231], v[104:107], a[36:39]
    ds_read_b128 a[152:155], v7 offset:14336
    v_cvt_pk_bf16_f32 v115, v128, v129
    v_mfma_f32_16x16x32_bf16 v[200:203], a[232:235], v[96:99], v[200:203]
    buffer_load_dwordx4 v9, s[8:11], s21 offen lds
    ds_read_b128 a[160:163], v7 offset:16384
    v_mfma_f32_16x16x32_bf16 v[248:251], a[232:235], v[100:103], v[248:251]
    ds_read_b128 a[140:143], v8 offset:10240
    v_mfma_f32_16x16x32_bf16 a[40:43], a[232:235], v[104:107], a[40:43]
    ds_read_b128 a[120:123], v7 offset:6144
    v_mfma_f32_16x16x32_bf16 v[204:207], a[236:239], v[96:99], v[204:207]
    s_add_u32 s21, s21, 128
    ds_read_b128 a[144:147], v7 offset:12288
    v_fma_f32 v80, v80, s28, v18
    v_mfma_f32_16x16x32_bf16 v[24:27], a[240:243], v[112:115], v[20:23]
    s_add_u32 m0, s22, 26624
    ds_read_b128 a[172:175], v8 offset:18432
    buffer_load_dwordx4 v9, s[8:11], s21 offen lds
    v_mfma_f32_16x16x32_bf16 v[252:255], a[236:239], v[100:103], v[252:255]
    v_exp_f32 v135, v79
    v_mfma_f32_16x16x32_bf16 a[44:47], a[236:239], v[104:107], a[44:47]
    s_waitcnt lgkmcnt(8)
    ds_read_b128 a[220:223], v2 offset:6144
    v_fma_f32 v76, v76, s28, v17
    v_mfma_f32_16x16x32_bf16 v[32:35], a[192:195], a[96:99], 0
    s_add_u32 s21, s21, 12032
    ds_read_b128 a[148:151], v8 offset:12288
    v_fma_f32 v87, v87, s28, v18
    v_mfma_f32_16x16x32_bf16 v[32:35], a[196:199], a[100:103], v[32:35]
    v_exp_f32 v132, v76
    v_mfma_f32_16x16x32_bf16 v[32:35], a[200:203], a[104:107], v[32:35]
    s_waitcnt vmcnt(8)
    v_exp_f32 v134, v78
    v_mfma_f32_16x16x32_bf16 v[32:35], a[204:207], a[108:111], v[32:35]
    s_waitcnt lgkmcnt(6)
    ds_read_b128 a[216:219], v1 offset:6144
    v_mfma_f32_16x16x32_bf16 v[32:35], a[208:211], a[112:115], v[32:35]
    ds_read_b128 a[184:187], v7 offset:22528
    v_mfma_f32_16x16x32_bf16 v[32:35], a[212:215], a[116:119], v[32:35]
    s_waitcnt lgkmcnt(6)
    v_exp_f32 v131, v75
    v_mfma_f32_16x16x32_bf16 v[40:43], a[192:195], a[120:123], 0
    ds_read_b128 a[180:183], v8 offset:20480
    v_cvt_pk_bf16_f32 v117, v130, v131
    v_mfma_f32_16x16x32_bf16 v[40:43], a[196:199], a[124:127], v[40:43]
    ds_read_b128 a[188:191], v8 offset:22528
    v_fma_f32 v84, v84, s28, v18
    v_mfma_f32_16x16x32_bf16 v[40:43], a[200:203], a[128:131], v[40:43]
    v_exp_f32 v133, v77
    v_mfma_f32_16x16x32_bf16 v[40:43], a[204:207], a[132:135], v[40:43]
    ds_read_b128 a[228:231], v2 offset:7168
    v_cvt_pk_bf16_f32 v118, v132, v133
    v_mfma_f32_16x16x32_bf16 v[40:43], a[208:211], a[136:139], v[40:43]
    ds_read_b128 a[176:179], v7 offset:20480
    v_cvt_pk_bf16_f32 v119, v134, v135
    v_mfma_f32_16x16x32_bf16 v[40:43], a[212:215], a[140:143], v[40:43]
    ds_read_b128 a[232:235], v1 offset:8192
    v_mfma_f32_16x16x32_bf16 v[24:27], a[244:247], v[116:119], v[24:27]
    s_waitcnt lgkmcnt(7)
    v_exp_f32 v130, v82
    v_mfma_f32_16x16x32_bf16 v[48:51], a[192:195], a[144:147], 0
    ds_read_b128 a[236:239], v2 offset:8192
    v_mfma_f32_16x16x32_bf16 v[48:51], a[196:199], a[148:151], v[48:51]
    ds_read_b128 a[224:227], v1 offset:7168
    v_exp_f32 v131, v83
    v_mfma_f32_16x16x32_bf16 v[48:51], a[200:203], a[152:155], v[48:51]
    v_exp_f32 v134, v86
    v_mfma_f32_16x16x32_bf16 v[48:51], a[204:207], a[156:159], v[48:51]
    v_exp_f32 v135, v87
    v_mfma_f32_16x16x32_bf16 v[48:51], a[208:211], a[160:163], v[48:51]
    v_exp_f32 v128, v80
    v_mfma_f32_16x16x32_bf16 v[48:51], a[212:215], a[164:167], v[48:51]
    v_exp_f32 v132, v84
    v_mfma_f32_16x16x32_bf16 v[56:59], a[192:195], a[168:171], 0
    v_cvt_pk_bf16_f32 v121, v130, v131
    v_cvt_pk_bf16_f32 v123, v134, v135
    v_mfma_f32_16x16x32_bf16 v[56:59], a[196:199], a[172:175], v[56:59]
    s_waitcnt lgkmcnt(3)
    v_exp_f32 v129, v81
    v_mfma_f32_16x16x32_bf16 v[56:59], a[200:203], a[176:179], v[56:59]
    v_exp_f32 v133, v85
    v_mfma_f32_16x16x32_bf16 v[56:59], a[204:207], a[180:183], v[56:59]
    v_cvt_pk_bf16_f32 v120, v128, v129
    v_cvt_pk_bf16_f32 v122, v132, v133
    v_mfma_f32_16x16x32_bf16 v[56:59], a[208:211], a[184:187], v[56:59]
    s_waitcnt vmcnt(13) lgkmcnt(0)
    v_mfma_f32_16x16x32_bf16 v[24:27], a[248:251], v[120:123], v[24:27]
    s_barrier
    v_mfma_f32_16x16x32_bf16 v[56:59], a[212:215], a[188:191], v[56:59]
    v_mfma_f32_16x16x32_bf16 v[36:39], a[216:219], a[96:99], 0
    s_add_u32 m0, s22, 0
    v_mfma_f32_16x16x32_bf16 v[36:39], a[220:223], a[100:103], v[36:39]
    buffer_load_dwordx4 v9, s[4:7], s20 offen lds
    v_mfma_f32_16x16x32_bf16 v[36:39], a[224:227], a[104:107], v[36:39]
    v_mfma_f32_16x16x32_bf16 v[36:39], a[228:231], a[108:111], v[36:39]
    ds_read_b64_tr_b16 a[192:193], v3 offset:12288
    v_mfma_f32_16x16x32_bf16 v[36:39], a[232:235], a[112:115], v[36:39]
    ds_read_b64_tr_b16 a[194:195], v3 offset:18432
    v_mfma_f32_16x16x32_bf16 v[36:39], a[236:239], a[116:119], v[36:39]
    ds_read_b64_tr_b16 a[196:197], v4 offset:12288
    v_mfma_f32_16x16x32_bf16 v[44:47], a[216:219], a[120:123], 0
    s_add_u32 s20, s20, 128
    v_mfma_f32_16x16x32_bf16 v[44:47], a[220:223], a[124:127], v[44:47]
    ds_read_b64_tr_b16 a[198:199], v4 offset:18432
    v_cmp_lt_f32 vcc, s29, v24
    v_mfma_f32_16x16x32_bf16 v[44:47], a[224:227], a[128:131], v[44:47]
    v_mfma_f32_16x16x32_bf16 v[44:47], a[228:231], a[132:135], v[44:47]
    ds_read_b64_tr_b16 a[200:201], v5 offset:12288
    v_mfma_f32_16x16x32_bf16 v[44:47], a[232:235], a[136:139], v[44:47]
    v_mfma_f32_16x16x32_bf16 v[44:47], a[236:239], a[140:143], v[44:47]
    s_add_u32 m0, s22, 1024
    ds_read_b64_tr_b16 a[202:203], v5 offset:18432
    v_mfma_f32_16x16x32_bf16 v[52:55], a[216:219], a[144:147], 0
    buffer_load_dwordx4 v9, s[4:7], s20 offen lds
    v_mfma_f32_16x16x32_bf16 v[52:55], a[220:223], a[148:151], v[52:55]
    ds_read_b64_tr_b16 a[204:205], v6 offset:12288
    v_mfma_f32_16x16x32_bf16 v[52:55], a[224:227], a[152:155], v[52:55]
    s_cbranch_vccnz L_rs_tr34b
L_ret_tr34b:
    ds_read_b64_tr_b16 a[206:207], v6 offset:18432
    v_mfma_f32_16x16x32_bf16 v[52:55], a[228:231], a[156:159], v[52:55]
    s_add_u32 s20, s20, 128
    ds_read_b64_tr_b16 a[208:209], v3 offset:13312
    v_mfma_f32_16x16x32_bf16 v[52:55], a[232:235], a[160:163], v[52:55]
    ds_read_b64_tr_b16 a[210:211], v3 offset:19456
    v_mfma_f32_16x16x32_bf16 v[52:55], a[236:239], a[164:167], v[52:55]
    s_add_u32 m0, s22, 2048
    ds_read_b64_tr_b16 a[212:213], v4 offset:13312
    v_mfma_f32_16x16x32_bf16 v[60:63], a[216:219], a[168:171], 0
    buffer_load_dwordx4 v9, s[4:7], s20 offen lds
    v_mfma_f32_16x16x32_bf16 v[60:63], a[220:223], a[172:175], v[60:63]
    s_add_u32 s20, s20, 12032
    v_mfma_f32_16x16x32_bf16 v[60:63], a[224:227], a[176:179], v[60:63]
    v_mfma_f32_16x16x32_bf16 v[60:63], a[228:231], a[180:183], v[60:63]
    v_mfma_f32_16x16x32_bf16 v[60:63], a[232:235], a[184:187], v[60:63]
    ds_read_b64_tr_b16 a[214:215], v4 offset:19456
    v_mfma_f32_16x16x32_bf16 v[60:63], a[236:239], a[188:191], v[60:63]
    s_waitcnt lgkmcnt(10)
    v_mfma_f32_16x16x32_bf16 v[160:163], a[192:195], v[112:115], v[160:163]
    s_add_u32 s24, s34, 128
    ds_read_b64_tr_b16 a[226:227], v3 offset:20480
    v_max3_f32 v28, v32, v33, v34
    v_max3_f32 v30, v40, v41, v42
    v_max3_f32 v28, v28, v35, v36
    v_max3_f32 v30, v30, v43, v44
    v_max3_f32 v30, v30, v45, v46
    v_max3_f32 v28, v28, v37, v38
    v_mfma_f32_16x16x32_bf16 v[208:211], a[192:195], v[116:119], v[208:211]
    s_add_u32 s18, s34, 18432
    v_max_f32 v28, v28, v39
    v_max_f32 v30, v30, v47
    v_mov_b32 v29, v28
    v_mfma_f32_16x16x32_bf16 a[0:3], a[192:195], v[120:123], a[0:3]
    s_waitcnt lgkmcnt(9)
    ds_read_b64_tr_b16 a[220:221], v6 offset:13312
    v_permlane32_swap_b32 v29, v28
    v_mov_b32 v31, v30
    v_mfma_f32_16x16x32_bf16 v[164:167], a[196:199], v[112:115], v[164:167]
    s_mov_b32 s34, s33
    ds_read_b64_tr_b16 a[218:219], v5 offset:19456
    v_max_f32 v28, v28, v29
    v_mfma_f32_16x16x32_bf16 v[212:215], a[196:199], v[116:119], v[212:215]
    s_add_u32 s37, s37, 1
    ds_read_b64_tr_b16 a[222:223], v6 offset:19456
    v_mov_b32 v29, v28
    v_permlane32_swap_b32 v31, v30
    v_mfma_f32_16x16x32_bf16 a[4:7], a[196:199], v[120:123], a[4:7]
    s_waitcnt lgkmcnt(9)
    ds_read_b64_tr_b16 a[228:229], v4 offset:14336
    v_mov_b32 v152, v24
    v_mfma_f32_16x16x32_bf16 v[168:171], a[200:203], v[112:115], v[168:171]
    s_add_u32 s35, s35, 325632
    ds_read_b64_tr_b16 a[232:233], v5 offset:14336
    v_max_f32 v30, v30, v31
    v_mfma_f32_16x16x32_bf16 v[216:219], a[200:203], v[116:119], v[216:219]
    s_lshl_b32 s42, s37, 1
    ds_read_b64_tr_b16 a[216:217], v5 offset:13312
    v_permlane16_swap_b32 v29, v28
    v_mov_b32 v31, v30
    v_mfma_f32_16x16x32_bf16 a[8:11], a[200:203], v[120:123], a[8:11]
    s_waitcnt lgkmcnt(6)
    ds_read_b64_tr_b16 a[224:225], v3 offset:14336
    v_max_f32 v28, v28, v29
    v_mfma_f32_16x16x32_bf16 v[172:175], a[204:207], v[112:115], v[172:175]
    s_lshr_b32 s42, s31, s42
    v_permlane16_swap_b32 v31, v30
    v_mul_f32_e64 v16, -s28, v28
    v_mfma_f32_16x16x32_bf16 v[220:223], a[204:207], v[116:119], v[220:223]
    s_xor_b32 s42, s42, s36
    v_max3_f32 v28, v48, v49, v50
    v_max_f32 v30, v30, v31
    v_max3_f32 v28, v28, v51, v52
    v_accvgpr_read_b32 v148, a4
    v_fma_f32 v36, v36, s28, v16
    v_mfma_f32_16x16x32_bf16 a[12:15], a[204:207], v[120:123], a[12:15]
    s_and_b32 s42, s42, 3
    ds_read_b64_tr_b16 a[236:237], v6 offset:14336
    s_mul_i32 s43, s3, 3
    v_mfma_f32_16x16x32_bf16 v[176:179], a[208:211], v[112:115], v[176:179]
    s_lshl_b32 s44, s3, 2
    ds_read_b64_tr_b16 a[234:235], v5 offset:20480
    v_accvgpr_read_b32 v145, a1
    v_mfma_f32_16x16x32_bf16 v[224:227], a[208:211], v[116:119], v[224:227]
    s_mov_b32 s32, 1
    v_fma_f32 v34, v34, s28, v16
    v_mul_f32_e64 v17, -s28, v30
    v_fma_f32 v37, v37, s28, v16
    v_mfma_f32_16x16x32_bf16 a[16:19], a[208:211], v[120:123], a[16:19]
    s_add_u32 s45, s43, 17
    ds_read_b64_tr_b16 a[238:239], v6 offset:20480
    v_fma_f32 v42, v42, s28, v17
    v_mfma_f32_16x16x32_bf16 v[180:183], a[212:215], v[112:115], v[180:183]
    s_cmp_eq_u32 s3, 0
    v_fma_f32 v44, v44, s28, v17
    v_mov_b32 v153, v24
    v_mfma_f32_16x16x32_bf16 v[228:231], a[212:215], v[116:119], v[228:231]
    s_cselect_b32 s45, 16, s45
    v_rcp_f32 v156, v26
    v_fma_f32 v35, v35, s28, v16
    v_mfma_f32_16x16x32_bf16 a[20:23], a[212:215], v[120:123], a[20:23]
    s_waitcnt lgkmcnt(3)
    ds_read_b64_tr_b16 a[230:231], v4 offset:20480
    s_cselect_b32 s33, 1, 0
    v_mfma_f32_16x16x32_bf16 v[184:187], a[216:219], v[112:115], v[184:187]
    s_cmp_eq_u32 s42, 1
    v_fma_f32 v38, v38, s28, v16
    v_accvgpr_read_b32 v146, a2
    v_mfma_f32_16x16x32_bf16 v[232:235], a[216:219], v[116:119], v[232:235]
    s_cselect_b32 s44, s45, s44
    s_cselect_b32 s32, s33, s32
    s_add_u32 s45, s43, 29
    v_mfma_f32_16x16x32_bf16 a[24:27], a[216:219], v[120:123], a[24:27]
    s_cmp_eq_u32 s42, 2
    v_max3_f32 v28, v28, v53, v54
    v_fma_f32 v33, v33, s28, v16
    v_mfma_f32_16x16x32_bf16 v[188:191], a[220:223], v[112:115], v[188:191]
    s_cselect_b32 s44, s45, s44
    v_permlane16_swap_b32 v152, v153
    s_cselect_b32 s32, 0, s32
    v_max_f32 v28, v28, v55
    s_add_u32 s45, s43, 41
    s_cmp_eq_u32 s42, 3
    v_mov_b32 v29, v28
    v_xor_b32 v0, 32, v14
    v_mfma_f32_16x16x32_bf16 v[236:239], a[220:223], v[116:119], v[236:239]
    s_cselect_b32 s44, s45, s44
    v_exp_f32 v131, v35
    v_mfma_f32_16x16x32_bf16 a[28:31], a[220:223], v[120:123], a[28:31]
    s_cselect_b32 s32, 0, s32
    v_fma_f32 v41, v41, s28, v17
    s_mul_i32 s44, s44, 6144
    v_accvgpr_read_b32 v149, a5
    s_add_u32 s33, s35, s44
    v_mfma_f32_16x16x32_bf16 v[192:195], a[224:227], v[112:115], v[192:195]
    s_mul_i32 s42, s32, 6144
    v_permlane32_swap_b32 v29, v28
    v_fma_f32 v32, v32, s28, v16
    v_xor_b32 v8, 96, v14
    v_mfma_f32_16x16x32_bf16 v[240:243], a[224:227], v[116:119], v[240:243]
    s_add_u32 s42, s42, 18432
    s_add_u32 s42, s42, s33
    s_cmp_ge_u32 s37, 8
    s_cselect_b32 s14, 0, s42
    v_max_f32 v28, v28, v29
    v_max3_f32 v30, v56, v57, v58
    s_add_u32 s25, s33, 128
    v_mfma_f32_16x16x32_bf16 a[32:35], a[224:227], v[120:123], a[32:35]
    s_add_u32 s23, s38, 2048
    s_mov_b32 s30, 0
    s_waitcnt vmcnt(7) lgkmcnt(0)
    v_fma_f32 v40, v40, s28, v17
    v_mfma_f32_16x16x32_bf16 v[196:199], a[228:231], v[112:115], v[196:199]
    s_barrier
    ds_read_b128 a[192:195], v1 offset:12288
    v_exp_f32 v133, v41
    v_mfma_f32_16x16x32_bf16 v[244:247], a[228:231], v[116:119], v[244:247]
    ds_read_b128 a[196:199], v2 offset:12288
    v_exp_f32 v132, v40
    v_fma_f32 v47, v47, s28, v17
    v_mfma_f32_16x16x32_bf16 a[36:39], a[228:231], v[120:123], a[36:39]
    s_add_u32 m0, s22, 36864
    ds_read_b128 a[200:203], v1 offset:13312
    v_fma_f32 v39, v39, s28, v16
    v_mfma_f32_16x16x32_bf16 v[200:203], a[232:235], v[112:115], v[200:203]
    ds_read_b128 a[204:207], v2 offset:13312
    v_rcp_f32 v152, v152
    v_mfma_f32_16x16x32_bf16 v[248:251], a[232:235], v[116:119], v[248:251]
    ds_read_b128 a[208:211], v1 offset:14336
    v_mov_b32 v29, v28
    v_mfma_f32_16x16x32_bf16 a[40:43], a[232:235], v[120:123], a[40:43]
    ds_read_b128 a[212:215], v2 offset:14336
    v_max3_f32 v30, v30, v59, v60
    v_mfma_f32_16x16x32_bf16 v[204:207], a[236:239], v[112:115], v[204:207]
    v_permlane16_swap_b32 v29, v28
    v_exp_f32 v130, v34
    v_accvgpr_read_b32 v147, a3
    v_cvt_pk_bf16_f32 v100, v132, v133
    v_max_f32 v28, v28, v29
    v_exp_f32 v134, v36
    v_mfma_f32_16x16x32_bf16 v[252:255], a[236:239], v[116:119], v[252:255]
    v_max3_f32 v30, v30, v61, v62
    v_max_f32 v30, v30, v63
    v_mfma_f32_16x16x32_bf16 a[44:47], a[236:239], v[120:123], a[44:47]
    s_waitcnt lgkmcnt(5)
    v_exp_f32 v128, v32
    v_mfma_f32_16x16x32_bf16 v[64:67], a[192:195], a[96:99], 0
    s_waitcnt lgkmcnt(4)
    v_exp_f32 v135, v37
    v_exp_f32 v129, v33
    v_mfma_f32_16x16x32_bf16 v[64:67], a[196:199], a[100:103], v[64:67]
    s_waitcnt lgkmcnt(3)
    ds_read_b128 a[220:223], v2 offset:18432
    v_accvgpr_read_b32 v151, a7
    v_mfma_f32_16x16x32_bf16 v[64:67], a[200:203], a[104:107], v[64:67]
    s_waitcnt lgkmcnt(3)
    ds_read_b128 a[224:227], v1 offset:19456
    v_mov_b32 v31, v30
    v_mfma_f32_16x16x32_bf16 v[64:67], a[204:207], a[108:111], v[64:67]
    s_waitcnt lgkmcnt(3)
    v_accvgpr_read_b32 v144, a0
    v_rcp_f32 v154, v25
    v_mfma_f32_16x16x32_bf16 v[64:67], a[208:211], a[112:115], v[64:67]
    s_waitcnt lgkmcnt(2)
    v_permlane32_swap_b32 v31, v30
    v_cvt_pk_bf16_f32 v96, v128, v129
    v_mfma_f32_16x16x32_bf16 v[64:67], a[212:215], a[116:119], v[64:67]
    buffer_load_dwordx4 v9, s[8:11], s21 offen lds
    v_mfma_f32_16x16x32_bf16 v[72:75], a[192:195], a[120:123], 0
    ds_read_b128 a[228:231], v2 offset:19456
    v_fma_f32 v43, v43, s28, v17
    v_mfma_f32_16x16x32_bf16 v[72:75], a[196:199], a[124:127], v[72:75]
    s_add_u32 s21, s21, 128
    v_fma_f32 v45, v45, s28, v17
    v_mul_f32_e64 v18, -s28, v28
    v_mfma_f32_16x16x32_bf16 v[72:75], a[200:203], a[128:131], v[72:75]
    v_cvt_pk_bf16_f32 v97, v130, v131
    v_max_f32 v30, v30, v31
    v_mfma_f32_16x16x32_bf16 v[72:75], a[204:207], a[132:135], v[72:75]
    s_add_u32 m0, s22, 37888
    v_accvgpr_read_b32 v150, a6
    v_exp_f32 v130, v42
    v_exp_f32 v131, v43
    v_pk_mul_f32 v[160:161], v[160:161], v[152:153] op_sel_hi:[1,0]
    v_pk_mul_f32 v[246:247], v[246:247], v[154:155] op_sel_hi:[1,0]
    v_pk_mul_f32 v[164:165], v[164:165], v[152:153] op_sel_hi:[1,0]
    v_cvt_pk_bf16_f32 v98, v134, v135
    v_pk_mul_f32 v[212:213], v[212:213], v[154:155] op_sel_hi:[1,0]
    v_pk_mul_f32 v[144:145], v[144:145], v[156:157] op_sel_hi:[1,0]
    v_pk_mul_f32 v[188:189], v[188:189], v[152:153] op_sel_hi:[1,0]
    v_pk_mul_f32 v[148:149], v[148:149], v[156:157] op_sel_hi:[1,0]
    v_pk_mul_f32 v[216:217], v[216:217], v[154:155] op_sel_hi:[1,0]
    v_pk_mul_f32 v[208:209], v[208:209], v[154:155] op_sel_hi:[1,0]
    v_pk_mul_f32 v[172:173], v[172:173], v[152:153] op_sel_hi:[1,0]
    v_fma_f32 v54, v54, s28, v18
    v_mov_b32 v31, v30
    v_mfma_f32_16x16x32_bf16 v[72:75], a[208:211], a[136:139], v[72:75]
    buffer_load_dwordx4 v9, s[8:11], s21 offen lds
    v_mfma_f32_16x16x32_bf16 v[72:75], a[212:215], a[140:143], v[72:75]
    v_fma_f32 v51, v51, s28, v18
    v_cvt_pk_bf16_f32 v144, v144, v145
    v_mfma_f32_16x16x32_bf16 v[80:83], a[192:195], a[144:147], 0
    ds_read_b128 a[236:239], v2 offset:20480
    v_fma_f32 v55, v55, s28, v18
    v_mfma_f32_16x16x32_bf16 v[80:83], a[196:199], a[148:151], v[80:83]
    v_fma_f32 v46, v46, s28, v17
    v_fma_f32 v52, v52, s28, v18
    v_mfma_f32_16x16x32_bf16 v[80:83], a[200:203], a[152:155], v[80:83]
    v_exp_f32 v133, v45
    v_xor_b32 v15, 64, v14
    v_mfma_f32_16x16x32_bf16 v[80:83], a[204:207], a[156:159], v[80:83]
    v_cvt_pk_bf16_f32 v148, v148, v149
    v_cvt_pk_bf16_f32 v212, v212, v213
    v_mfma_f32_16x16x32_bf16 v[80:83], a[208:211], a[160:163], v[80:83]
    s_add_u32 s21, s21, 128
    v_permlane16_swap_b32 v31, v30
    v_mfma_f32_16x16x32_bf16 v[80:83], a[212:215], a[164:167], v[80:83]
    v_fma_f32 v72, v72, s28, v17
    v_fma_f32 v48, v48, s28, v18
    v_fma_f32 v49, v49, s28, v18
    v_mfma_f32_16x16x32_bf16 v[88:91], a[192:195], a[168:171], 0
    ds_read_b128 a[216:219], v1 offset:18432
    v_exp_f32 v129, v39
    v_max_f32 v30, v30, v31
    v_mfma_f32_16x16x32_bf16 v[88:91], a[196:199], a[172:175], v[88:91]
    s_add_u32 m0, s22, 38912
    v_exp_f32 v128, v38
    v_exp_f32 v135, v47
    v_exp_f32 v134, v46
    v_fma_f32 v53, v53, s28, v18
    v_pk_mul_f32 v[150:151], v[150:151], v[156:157] op_sel_hi:[1,0]
    v_cvt_pk_bf16_f32 v160, v160, v161
    v_pk_mul_f32 v[254:255], v[254:255], v[154:155] op_sel_hi:[1,0]
    v_pk_mul_f32 v[214:215], v[214:215], v[154:155] op_sel_hi:[1,0]
    v_mul_f32_e64 v19, -s28, v30
    v_pk_mul_f32 v[176:177], v[176:177], v[152:153] op_sel_hi:[1,0]
    v_cvt_pk_bf16_f32 v101, v130, v131
    v_pk_mul_f32 v[162:163], v[162:163], v[152:153] op_sel_hi:[1,0]
    v_pk_mul_f32 v[238:239], v[238:239], v[154:155] op_sel_hi:[1,0]
    v_pk_mul_f32 v[210:211], v[210:211], v[154:155] op_sel_hi:[1,0]
    v_cvt_pk_bf16_f32 v99, v128, v129
    v_pk_mul_f32 v[168:169], v[168:169], v[152:153] op_sel_hi:[1,0]
    v_pk_mul_f32 v[232:233], v[232:233], v[154:155] op_sel_hi:[1,0]
    v_pk_mul_f32 v[236:237], v[236:237], v[154:155] op_sel_hi:[1,0]
    v_pk_mul_f32 v[180:181], v[180:181], v[152:153] op_sel_hi:[1,0]
    v_fma_f32 v50, v50, s28, v18
    v_pk_mul_f32 v[190:191], v[190:191], v[152:153] op_sel_hi:[1,0]
    v_pk_mul_f32 v[182:183], v[182:183], v[152:153] op_sel_hi:[1,0]
    v_pk_mul_f32 v[204:205], v[204:205], v[152:153] op_sel_hi:[1,0]
    v_fma_f32 v59, v59, s28, v19
    v_cvt_pk_bf16_f32 v208, v208, v209
    v_pk_mul_f32 v[146:147], v[146:147], v[156:157] op_sel_hi:[1,0]
    v_exp_f32 v132, v44
    v_fma_f32 v60, v60, s28, v19
    v_mfma_f32_16x16x32_bf16 v[88:91], a[200:203], a[176:179], v[88:91]
    ds_read_b128 a[232:235], v1 offset:20480
    v_fma_f32 v64, v64, s28, v16
    v_mfma_f32_16x16x32_bf16 v[88:91], a[204:207], a[180:183], v[88:91]
    v_exp_f32 v128, v48
    v_mfma_f32_16x16x32_bf16 v[88:91], a[208:211], a[184:187], v[88:91]
    v_exp_f32 v129, v49
    v_cvt_pk_bf16_f32 v103, v134, v135
    v_exp_f32 v130, v50
    v_mfma_f32_16x16x32_bf16 v[88:91], a[212:215], a[188:191], v[88:91]
    s_waitcnt lgkmcnt(1)
    v_cvt_pk_bf16_f32 v145, v146, v147
    v_fma_f32 v80, v80, s28, v18
    v_mfma_f32_16x16x32_bf16 v[68:71], a[216:219], a[96:99], 0
    buffer_load_dwordx4 v9, s[8:11], s21 offen lds
    v_cvt_pk_bf16_f32 v149, v150, v151
    v_exp_f32 v134, v54
    v_cvt_pk_bf16_f32 v102, v132, v133
    v_cvt_pk_bf16_f32 v216, v216, v217
    v_cvt_pk_bf16_f32 v161, v162, v163
    v_pk_mul_f32 v[226:227], v[226:227], v[154:155] op_sel_hi:[1,0]
    v_pk_mul_f32 v[218:219], v[218:219], v[154:155] op_sel_hi:[1,0]
    v_pk_mul_f32 v[166:167], v[166:167], v[152:153] op_sel_hi:[1,0]
    v_exp_f32 v131, v51
    v_exp_f32 v133, v53
    v_mfma_f32_16x16x32_bf16 v[68:71], a[220:223], a[100:103], v[68:71]
    v_exp_f32 v132, v52
    v_mfma_f32_16x16x32_bf16 v[68:71], a[224:227], a[104:107], v[68:71]
    s_add_u32 s21, s21, 12032
    v_fma_f32 v61, v61, s28, v19
    v_cvt_pk_bf16_f32 v106, v132, v133
    v_mfma_f32_16x16x32_bf16 v[68:71], a[228:231], a[108:111], v[68:71]
    s_waitcnt vmcnt(6) lgkmcnt(0)
    v_cvt_pk_bf16_f32 v209, v210, v211
    v_cvt_pk_bf16_f32 v172, v172, v173
    v_mfma_f32_16x16x32_bf16 v[68:71], a[232:235], a[112:115], v[68:71]
    s_barrier
    v_mfma_f32_16x16x32_bf16 v[68:71], a[236:239], a[116:119], v[68:71]
    v_cvt_pk_bf16_f32 v217, v218, v219
    v_fma_f32 v63, v63, s28, v19
    v_mfma_f32_16x16x32_bf16 v[76:79], a[216:219], a[120:123], 0
    ds_read_b64_tr_b16 a[192:193], v3 offset:0
    v_fma_f32 v56, v56, s28, v19
    v_mfma_f32_16x16x32_bf16 v[76:79], a[220:223], a[124:127], v[76:79]
    v_cvt_pk_bf16_f32 v164, v164, v165
    v_cvt_pk_bf16_f32 v165, v166, v167
    v_mfma_f32_16x16x32_bf16 v[76:79], a[224:227], a[128:131], v[76:79]
    v_fma_f32 v82, v82, s28, v18
    v_fma_f32 v69, v69, s28, v16
    v_exp_f32 v135, v55
    v_mfma_f32_16x16x32_bf16 v[76:79], a[228:231], a[132:135], v[76:79]
    s_add_u32 m0, s22, 12288
    ds_read_b64_tr_b16 a[194:195], v3 offset:6144
    v_fma_f32 v57, v57, s28, v19
    v_mfma_f32_16x16x32_bf16 v[76:79], a[232:235], a[136:139], v[76:79]
    buffer_load_dwordx4 v9, s[4:7], s20 offen lds
    v_cvt_pk_bf16_f32 v213, v214, v215
    v_fma_f32 v81, v81, s28, v18
    v_cvt_pk_bf16_f32 v104, v128, v129
    v_mfma_f32_16x16x32_bf16 v[76:79], a[236:239], a[140:143], v[76:79]
    ds_read_b64_tr_b16 a[196:197], v4 offset:0
    v_cvt_pk_bf16_f32 v188, v188, v189
    v_mfma_f32_16x16x32_bf16 v[84:87], a[216:219], a[144:147], 0
    s_add_u32 s20, s20, 128
    ds_write2st64_b64 v14, v[160:161], v[208:209] offset0:0 offset1:12
    v_pk_mul_f32 v[196:197], v[196:197], v[152:153] op_sel_hi:[1,0]
    v_accvgpr_read_b32 v147, a11
    v_pk_mul_f32 v[178:179], v[178:179], v[152:153] op_sel_hi:[1,0]
    v_pk_mul_f32 v[186:187], v[186:187], v[152:153] op_sel_hi:[1,0]
    v_fma_f32 v75, v75, s28, v17
    v_pk_mul_f32 v[192:193], v[192:193], v[152:153] op_sel_hi:[1,0]
    v_cvt_pk_bf16_f32 v105, v130, v131
    v_pk_mul_f32 v[174:175], v[174:175], v[152:153] op_sel_hi:[1,0]
    v_pk_mul_f32 v[198:199], v[198:199], v[152:153] op_sel_hi:[1,0]
    v_exp_f32 v128, v56
    v_cvt_pk_bf16_f32 v107, v134, v135
    v_mfma_f32_16x16x32_bf16 v[84:87], a[220:223], a[148:151], v[84:87]
    ds_write_b64 v14, v[144:145] offset:12288
    v_cvt_pk_bf16_f32 v232, v232, v233
    v_mfma_f32_16x16x32_bf16 v[84:87], a[224:227], a[152:155], v[84:87]
    v_fma_f32 v90, v90, s28, v19
    v_fma_f32 v62, v62, s28, v19
    v_accvgpr_read_b32 v151, a15
    v_cvt_pk_bf16_f32 v180, v180, v181
    v_fma_f32 v68, v68, s28, v16
    v_pk_mul_f32 v[234:235], v[234:235], v[154:155] op_sel_hi:[1,0]
    v_fma_f32 v91, v91, s28, v19
    v_pk_mul_f32 v[244:245], v[244:245], v[154:155] op_sel_hi:[1,0]
    v_pk_mul_f32 v[230:231], v[230:231], v[154:155] op_sel_hi:[1,0]
    v_accvgpr_read_b32 v146, a10
    v_pk_mul_f32 v[170:171], v[170:171], v[152:153] op_sel_hi:[1,0]
    v_accvgpr_read_b32 v144, a8
    v_fma_f32 v65, v65, s28, v16
    v_cvt_pk_bf16_f32 v196, v196, v197
    v_mfma_f32_16x16x32_bf16 v[84:87], a[228:231], a[156:159], v[84:87]
    ds_read_b64_tr_b16 a[198:199], v4 offset:6144
    v_accvgpr_read_b32 v145, a9
    v_mfma_f32_16x16x32_bf16 v[84:87], a[232:235], a[160:163], v[84:87]
    v_cvt_pk_bf16_f32 v168, v168, v169
    v_exp_f32 v129, v57
    v_mfma_f32_16x16x32_bf16 v[84:87], a[236:239], a[164:167], v[84:87]
    v_exp_f32 v132, v60
    v_mfma_f32_16x16x32_bf16 v[20:23], a[240:243], v[96:99], 0
    ds_write2st64_b64 v0, v[164:165], v[212:213] offset0:0 offset1:12
    v_fma_f32 v71, v71, s28, v16
    v_fma_f32 v67, v67, s28, v16
    v_fma_f32 v58, v58, s28, v19
    v_fma_f32 v76, v76, s28, v17
    v_pk_mul_f32 v[200:201], v[200:201], v[152:153] op_sel_hi:[1,0]
    v_exp_f32 v133, v61
    v_accvgpr_read_b32 v150, a14
    v_pk_mul_f32 v[224:225], v[224:225], v[154:155] op_sel_hi:[1,0]
    v_pk_mul_f32 v[144:145], v[144:145], v[156:157] op_sel_hi:[1,0]
    v_cvt_pk_bf16_f32 v108, v128, v129
    v_cvt_pk_bf16_f32 v176, v176, v177
    v_mfma_f32_16x16x32_bf16 v[92:95], a[216:219], a[168:171], 0
    ds_read_b64_tr_b16 a[200:201], v5 offset:0
    v_fma_f32 v77, v77, s28, v17
    v_cvt_pk_bf16_f32 v224, v224, v225
    v_cvt_pk_bf16_f32 v169, v170, v171
    v_cvt_pk_bf16_f32 v144, v144, v145
    v_mfma_f32_16x16x32_bf16 v[92:95], a[220:223], a[172:175], v[92:95]
    s_add_u32 m0, s22, 13312
    ds_read_b64_tr_b16 a[202:203], v5 offset:6144
    v_exp_f32 v129, v65
    v_fma_f32 v85, v85, s28, v18
    v_cvt_pk_bf16_f32 v173, v174, v175
    v_pk_mul_f32 v[220:221], v[220:221], v[154:155] op_sel_hi:[1,0]
    v_cvt_pk_bf16_f32 v110, v132, v133
    v_fma_f32 v66, v66, s28, v16
    v_pk_mul_f32 v[228:229], v[228:229], v[154:155] op_sel_hi:[1,0]
    v_pk_mul_f32 v[146:147], v[146:147], v[156:157] op_sel_hi:[1,0]
    v_fma_f32 v73, v73, s28, v17
    v_exp_f32 v128, v64
    v_fma_f32 v87, v87, s28, v18
    v_fma_f32 v78, v78, s28, v17
    v_mfma_f32_16x16x32_bf16 v[92:95], a[224:227], a[176:179], v[92:95]
    ds_read_b64_tr_b16 a[204:205], v6 offset:0
    v_cvt_pk_bf16_f32 v145, v146, v147
    v_cvt_pk_bf16_f32 v200, v200, v201
    v_mfma_f32_16x16x32_bf16 v[92:95], a[228:231], a[180:183], v[92:95]
    buffer_load_dwordx4 v9, s[4:7], s20 offen lds
    v_exp_f32 v130, v58
    v_mfma_f32_16x16x32_bf16 v[92:95], a[232:235], a[184:187], v[92:95]
    ds_write_b64 v0, v[148:149] offset:12288
    v_mfma_f32_16x16x32_bf16 v[92:95], a[236:239], a[188:191], v[92:95]
    s_waitcnt lgkmcnt(3)
    ds_write2st64_b64 v15, v[168:169], v[216:217] offset0:0 offset1:12
    v_cvt_pk_bf16_f32 v220, v220, v221
    v_fma_f32 v70, v70, s28, v16
    v_mfma_f32_16x16x32_bf16 v[160:163], a[192:195], v[96:99], 0
    ds_write_b64 v15, v[144:145] offset:12288
    v_accvgpr_read_b32 v148, a12
    v_mfma_f32_16x16x32_bf16 v[208:211], a[192:195], v[100:103], 0
    ds_read_b64_tr_b16 a[222:223], v6 offset:7168
    v_exp_f32 v134, v62
    v_exp_f32 v131, v59
    v_exp_f32 v135, v63
    v_pk_mul_f32 v[150:151], v[150:151], v[156:157] op_sel_hi:[1,0]
    v_pk_mul_f32 v[240:241], v[240:241], v[154:155] op_sel_hi:[1,0]
    v_pk_mul_f32 v[206:207], v[206:207], v[152:153] op_sel_hi:[1,0]
    v_cvt_pk_bf16_f32 v225, v226, v227
    v_accvgpr_read_b32 v146, a18
    v_pk_mul_f32 v[184:185], v[184:185], v[152:153] op_sel_hi:[1,0]
    v_cvt_pk_bf16_f32 v109, v130, v131
    v_subrev_u32 v13, 20480, v13
    v_accvgpr_read_b32 v144, a16
    v_pk_mul_f32 v[222:223], v[222:223], v[154:155] op_sel_hi:[1,0]
    v_cvt_pk_bf16_f32 v240, v240, v241
    v_cvt_pk_bf16_f32 v236, v236, v237
    v_accvgpr_read_b32 v147, a19
    v_pk_mul_f32 v[242:243], v[242:243], v[154:155] op_sel_hi:[1,0]
    v_accvgpr_read_b32 v149, a13
    v_exp_f32 v133, v73
    v_cvt_pk_bf16_f32 v221, v222, v223
    v_mfma_f32_16x16x32_bf16 v[20:23], a[244:247], v[100:103], v[20:23]
    ds_read_b64_tr_b16 a[206:207], v6 offset:6144
    v_accvgpr_read_b32 v145, a17
    v_mfma_f32_16x16x32_bf16 a[0:3], a[192:195], v[104:107], 0
    ds_write2st64_b64 v8, v[172:173], v[220:221] offset0:0 offset1:12
    v_pk_mul_f32 v[252:253], v[252:253], v[154:155] op_sel_hi:[1,0]
    v_pk_mul_f32 v[144:145], v[144:145], v[156:157] op_sel_hi:[1,0]
    v_cvt_pk_bf16_f32 v112, v128, v129
    v_pk_mul_f32 v[194:195], v[194:195], v[152:153] op_sel_hi:[1,0]
    v_exp_f32 v130, v66
    v_cvt_pk_bf16_f32 v111, v134, v135
    v_fma_f32 v79, v79, s28, v17
    v_pk_mul_f32 v[148:149], v[148:149], v[156:157] op_sel_hi:[1,0]
    v_pk_mul_f32 v[146:147], v[146:147], v[156:157] op_sel_hi:[1,0]
    v_cvt_pk_bf16_f32 v237, v238, v239
    v_exp_f32 v132, v72
    v_cvt_pk_bf16_f32 v144, v144, v145
    v_pk_mul_f32 v[248:249], v[248:249], v[154:155] op_sel_hi:[1,0]
    v_fma_f32 v83, v83, s28, v18
    v_cvt_pk_bf16_f32 v148, v148, v149
    v_mfma_f32_16x16x32_bf16 a[48:51], a[192:195], v[108:111], 0
    ds_read_b64_tr_b16 a[208:209], v3 offset:1024
    v_exp_f32 v135, v69
    v_mfma_f32_16x16x32_bf16 v[164:167], a[196:199], v[96:99], 0
    s_add_u32 s20, s20, 128
    ds_read_b64_tr_b16 a[218:219], v5 offset:7168
    v_cvt_pk_bf16_f32 v145, v146, v147
    v_mfma_f32_16x16x32_bf16 v[212:215], a[196:199], v[100:103], 0
    s_add_u32 m0, s22, 14336
    ds_read_b128 v[140:143], v13 offset:1024
    v_cvt_pk_bf16_f32 v116, v132, v133
    v_cvt_pk_bf16_f32 v233, v234, v235
    v_mfma_f32_16x16x32_bf16 a[4:7], a[196:199], v[104:107], 0
    ds_read_b64_tr_b16 a[210:211], v3 offset:7168
    v_exp_f32 v128, v70
    v_exp_f32 v129, v71
    v_mfma_f32_16x16x32_bf16 a[52:55], a[196:199], v[108:111], 0
    s_waitcnt lgkmcnt(4)
    ds_read_b64_tr_b16 a[212:213], v4 offset:1024
    v_cvt_pk_bf16_f32 v149, v150, v151
    v_mfma_f32_16x16x32_bf16 v[168:171], a[200:203], v[96:99], 0
    ds_write_b64 v8, v[148:149] offset:12288
    v_mfma_f32_16x16x32_bf16 v[216:219], a[200:203], v[100:103], 0
    ds_read_b64_tr_b16 a[224:225], v3 offset:2048
    v_exp_f32 v131, v67
    v_mfma_f32_16x16x32_bf16 v[20:23], a[248:251], v[104:107], v[20:23]
    ds_read_b128 v[136:139], v13 offset:0
    buffer_load_dwordx4 v9, s[4:7], s20 offen lds
    v_fma_f32 v93, v93, s28, v19
    v_mfma_f32_16x16x32_bf16 a[8:11], a[200:203], v[104:107], 0
    s_add_u32 s20, s20, 12032
    ds_read_b64_tr_b16 a[214:215], v4 offset:7168
    v_accvgpr_read_b32 v150, a22
    v_cvt_pk_bf16_f32 v197, v198, v199
    v_mfma_f32_16x16x32_bf16 a[56:59], a[200:203], v[108:111], 0
    ds_read_b64_tr_b16 a[228:229], v4 offset:2048
    v_cvt_pk_bf16_f32 v177, v178, v179
    v_cvt_pk_bf16_f32 v204, v204, v205
    v_accvgpr_read_b32 v148, a20
    v_mfma_f32_16x16x32_bf16 v[172:175], a[204:207], v[96:99], 0
    s_add_u32 s56, s24, 4294967168
    ds_write2st64_b64 v14, v[176:177], v[224:225] offset0:4 offset1:16
    v_exp_f32 v134, v68
    v_accvgpr_read_b32 v149, a21
    v_pk_mul_f32 v[250:251], v[250:251], v[154:155] op_sel_hi:[1,0]
    v_exp_f32 v133, v77
    v_cvt_pk_bf16_f32 v228, v228, v229
    v_cvt_pk_bf16_f32 v184, v184, v185
    v_accvgpr_read_b32 v146, a26
    v_exp_f32 v132, v76
    v_mfma_f32_16x16x32_bf16 v[220:223], a[204:207], v[100:103], 0
    s_add_u32 s58, s25, 4294967168
    ds_read_b64_tr_b16 a[216:217], v5 offset:1024
    v_accvgpr_read_b32 v151, a23
    v_mfma_f32_16x16x32_bf16 a[12:15], a[204:207], v[104:107], 0
    ds_write_b64 v14, v[144:145] offset:14336
    v_cvt_pk_bf16_f32 v192, v192, v193
    v_cvt_pk_bf16_f32 v229, v230, v231
    v_pk_mul_f32 v[148:149], v[148:149], v[156:157] op_sel_hi:[1,0]
    v_cvt_pk_bf16_f32 v113, v130, v131
    v_fma_f32 v84, v84, s28, v18
    v_cvt_pk_bf16_f32 v185, v186, v187
    v_pk_mul_f32 v[150:151], v[150:151], v[156:157] op_sel_hi:[1,0]
    v_cvt_pk_bf16_f32 v241, v242, v243
    v_cvt_pk_bf16_f32 v244, v244, v245
    v_cvt_pk_bf16_f32 v118, v132, v133
    v_cvt_pk_bf16_f32 v115, v128, v129
    v_cvt_pk_bf16_f32 v181, v182, v183
    v_mfma_f32_16x16x32_bf16 a[60:63], a[204:207], v[108:111], 0
    s_waitcnt lgkmcnt(2)
    ds_read_b64_tr_b16 a[226:227], v3 offset:8192
    v_cvt_pk_bf16_f32 v189, v190, v191
    v_cvt_pk_bf16_f32 v248, v248, v249
    v_mfma_f32_16x16x32_bf16 v[176:179], a[208:211], v[96:99], 0
    v_cvt_pk_bf16_f32 v252, v252, v253
    v_accvgpr_read_b32 v147, a27
    v_cvt_pk_bf16_f32 v148, v148, v149
    v_cvt_pk_bf16_f32 v149, v150, v151
    v_fma_f32 v74, v74, s28, v17
    v_accvgpr_read_b32 v145, a25
    v_exp_f32 v131, v75
    v_accvgpr_read_b32 v144, a24
    v_mfma_f32_16x16x32_bf16 v[224:227], a[208:211], v[100:103], 0
    buffer_store_dwordx4 v[136:139], v12, s[16:19], s56 offen offset:0 nt
    s_add_u32 m0, s38, 0
    ds_write2st64_b64 v0, v[180:181], v[228:229] offset0:4 offset1:16
    v_mfma_f32_16x16x32_bf16 a[16:19], a[208:211], v[104:107], 0
    ds_write_b64 v0, v[148:149] offset:14336
    v_exp_f32 v130, v74
    v_mfma_f32_16x16x32_bf16 a[64:67], a[208:211], v[108:111], 0
    ds_read_b64_tr_b16 a[220:221], v6 offset:1024
    buffer_load_dwordx4 v10, s[12:15], s58 offen nt lds
    v_cvt_pk_bf16_f32 v114, v134, v135
    v_mfma_f32_16x16x32_bf16 v[180:183], a[212:215], v[96:99], 0
    ds_read_b128 v[136:139], v13 offset:6144
    v_accvgpr_read_b32 v150, a30
    v_cvt_pk_bf16_f32 v245, v246, v247
    v_accvgpr_read_b32 v151, a31
    v_mfma_f32_16x16x32_bf16 v[228:231], a[212:215], v[100:103], 0
    s_add_u32 m0, s38, 1024
    ds_read_b64_tr_b16 a[238:239], v6 offset:8192
    buffer_load_dwordx4 v11, s[12:15], s58 offen nt lds
    v_accvgpr_read_b32 v149, a29
    v_accvgpr_read_b32 v148, a28
    v_mfma_f32_16x16x32_bf16 a[20:23], a[212:215], v[104:107], 0
    buffer_store_dwordx4 v[140:143], v12, s[16:19], s56 offen offset:3072 nt
    s_nop 0
    ds_read_b128 v[140:143], v13 offset:7168
    v_pk_mul_f32 v[148:149], v[148:149], v[156:157] op_sel_hi:[1,0]
    v_pk_mul_f32 v[146:147], v[146:147], v[156:157] op_sel_hi:[1,0]
    v_pk_mul_f32 v[150:151], v[150:151], v[156:157] op_sel_hi:[1,0]
    v_pk_mul_f32 v[144:145], v[144:145], v[156:157] op_sel_hi:[1,0]
    v_cvt_pk_bf16_f32 v253, v254, v255
    v_cvt_pk_bf16_f32 v148, v148, v149
    v_mfma_f32_16x16x32_bf16 v[20:23], a[252:255], v[108:111], v[20:23]
    s_add_u32 s57, s24, 6016
    ds_read_b64_tr_b16 a[232:233], v5 offset:2048
    v_cvt_pk_bf16_f32 v144, v144, v145
    v_cvt_pk_bf16_f32 v145, v146, v147
    v_cvt_pk_bf16_f32 v149, v150, v151
    v_mfma_f32_16x16x32_bf16 a[68:71], a[212:215], v[108:111], 0
    s_waitcnt lgkmcnt(5)
    ds_write2st64_b64 v15, v[184:185], v[232:233] offset0:4 offset1:16
    v_cvt_pk_bf16_f32 v193, v194, v195
    v_mfma_f32_16x16x32_bf16 v[184:187], a[216:219], v[96:99], 0
    s_add_u32 s59, s25, 6016
    ds_write_b64 v15, v[144:145] offset:14336
    v_cvt_pk_bf16_f32 v205, v206, v207
    v_mfma_f32_16x16x32_bf16 v[232:235], a[216:219], v[100:103], 0
    s_add_u32 m0, s38, 6144
    ds_read_b64_tr_b16 a[236:237], v6 offset:2048
    v_accvgpr_read_b32 v144, a32
    v_cvt_pk_bf16_f32 v117, v130, v131
    v_mfma_f32_16x16x32_bf16 a[24:27], a[216:219], v[104:107], 0
    ds_write2st64_b64 v8, v[188:189], v[236:237] offset0:4 offset1:16
    v_exp_f32 v134, v78
    v_accvgpr_read_b32 v151, a39
    v_mfma_f32_16x16x32_bf16 a[72:75], a[216:219], v[108:111], 0
    s_waitcnt lgkmcnt(5)
    ds_write_b64 v8, v[148:149] offset:14336
    v_mfma_f32_16x16x32_bf16 v[188:191], a[220:223], v[96:99], 0
    buffer_load_dwordx4 v10, s[12:15], s59 offen nt lds
    ds_write2st64_b64 v14, v[192:193], v[240:241] offset0:8 offset1:20
    v_exp_f32 v128, v80
    v_accvgpr_read_b32 v145, a33
    v_accvgpr_read_b32 v148, a36
    v_pk_mul_f32 v[144:145], v[144:145], v[156:157] op_sel_hi:[1,0]
    v_pk_mul_f32 v[202:203], v[202:203], v[152:153] op_sel_hi:[1,0]
    v_accvgpr_read_b32 v146, a34
    v_accvgpr_read_b32 v149, a37
    v_accvgpr_read_b32 v147, a35
    v_exp_f32 v130, v82
    v_mfma_f32_16x16x32_bf16 v[236:239], a[220:223], v[100:103], 0
    buffer_store_dwordx4 v[136:139], v12, s[16:19], s57 offen offset:0 nt
    s_nop 0
    ds_read_b128 v[136:139], v13 offset:12288
    v_exp_f32 v135, v79
    v_exp_f32 v131, v83
    v_pk_mul_f32 v[146:147], v[146:147], v[156:157] op_sel_hi:[1,0]
    v_cvt_pk_bf16_f32 v144, v144, v145
    v_pk_mul_f32 v[148:149], v[148:149], v[156:157] op_sel_hi:[1,0]
    v_accvgpr_read_b32 v150, a38
    v_cvt_pk_bf16_f32 v145, v146, v147
    v_mfma_f32_16x16x32_bf16 a[28:31], a[220:223], v[104:107], 0
    s_add_u32 m0, s38, 7168
    ds_write_b64 v14, v[144:145] offset:16384
    v_mfma_f32_16x16x32_bf16 a[76:79], a[220:223], v[108:111], 0
    buffer_load_dwordx4 v11, s[12:15], s59 offen nt lds
    v_mfma_f32_16x16x32_bf16 v[24:27], a[240:243], v[112:115], v[20:23]
    ds_read_b64_tr_b16 a[230:231], v4 offset:8192
    v_accvgpr_read_b32 v145, a41
    v_cvt_pk_bf16_f32 v119, v134, v135
    v_accvgpr_read_b32 v146, a42
    v_mfma_f32_16x16x32_bf16 v[192:195], a[224:227], v[96:99], 0
    buffer_store_dwordx4 v[140:143], v12, s[16:19], s57 offen offset:3072 nt
    s_add_u32 s56, s24, 12160
    ds_read_b64_tr_b16 a[234:235], v5 offset:8192
    v_cvt_pk_bf16_f32 v201, v202, v203
    v_exp_f32 v129, v81
    v_accvgpr_read_b32 v144, a40
    v_mfma_f32_16x16x32_bf16 v[240:243], a[224:227], v[100:103], 0
    s_add_u32 s58, s25, 12160
    ds_read_b128 v[140:143], v13 offset:13312
    v_accvgpr_read_b32 v147, a43
    v_mfma_f32_16x16x32_bf16 a[32:35], a[224:227], v[104:107], 0
    s_add_u32 m0, s38, 12288
    ds_write2st64_b64 v0, v[196:197], v[244:245] offset0:8 offset1:20
    v_pk_mul_f32 v[144:145], v[144:145], v[156:157] op_sel_hi:[1,0]
    v_pk_mul_f32 v[150:151], v[150:151], v[156:157] op_sel_hi:[1,0]
    v_cvt_pk_bf16_f32 v249, v250, v251
    v_fma_f32 v86, v86, s28, v18
    v_cvt_pk_bf16_f32 v148, v148, v149
    v_cvt_pk_bf16_f32 v149, v150, v151
    v_pk_mul_f32 v[146:147], v[146:147], v[156:157] op_sel_hi:[1,0]
    v_exp_f32 v133, v85
    v_exp_f32 v132, v84
    v_cvt_pk_bf16_f32 v144, v144, v145
    v_mfma_f32_16x16x32_bf16 a[80:83], a[224:227], v[108:111], 0
    s_waitcnt lgkmcnt(3)
    ds_write_b64 v0, v[148:149] offset:16384
    v_mfma_f32_16x16x32_bf16 v[196:199], a[228:231], v[96:99], 0
    buffer_load_dwordx4 v10, s[12:15], s58 offen nt lds
    v_cvt_pk_bf16_f32 v145, v146, v147
    v_mfma_f32_16x16x32_bf16 v[244:247], a[228:231], v[100:103], 0
    s_add_u32 m0, s38, 13312
    ds_write2st64_b64 v15, v[200:201], v[248:249] offset0:8 offset1:20
    v_cvt_pk_bf16_f32 v121, v130, v131
    v_mfma_f32_16x16x32_bf16 a[36:39], a[228:231], v[104:107], 0
    s_waitcnt lgkmcnt(3)
    buffer_load_dwordx4 v11, s[12:15], s58 offen nt lds
    ds_write_b64 v15, v[144:145] offset:16384
    v_mfma_f32_16x16x32_bf16 a[84:87], a[228:231], v[108:111], 0
    s_waitcnt vmcnt(16)
    v_exp_f32 v134, v86
    v_accvgpr_read_b32 v150, a46
    v_mfma_f32_16x16x32_bf16 v[200:203], a[232:235], v[96:99], 0
    s_barrier
    ds_read_b128 a[196:199], v2 offset:0
    v_mfma_f32_16x16x32_bf16 v[24:27], a[244:247], v[116:119], v[24:27]
    s_add_u32 m0, s22, 24576
    ds_read_b128 a[204:207], v2 offset:1024
    v_accvgpr_read_b32 v151, a47
    v_mfma_f32_16x16x32_bf16 v[248:251], a[232:235], v[100:103], 0
    ds_read_b128 a[192:195], v1 offset:0
    buffer_load_dwordx4 v9, s[8:11], s21 offen lds
    v_mfma_f32_16x16x32_bf16 a[40:43], a[232:235], v[104:107], 0
    ds_read_b128 a[200:203], v1 offset:1024
    v_exp_f32 v135, v87
    v_mfma_f32_16x16x32_bf16 a[88:91], a[232:235], v[108:111], 0
    s_add_u32 s21, s21, 128
    ds_write2st64_b64 v8, v[204:205], v[252:253] offset0:8 offset1:20
    v_accvgpr_read_b32 v149, a45
    v_mfma_f32_16x16x32_bf16 v[204:207], a[236:239], v[96:99], 0
    ds_read_b128 a[208:211], v1 offset:2048
    v_cvt_pk_bf16_f32 v123, v134, v135
    v_mfma_f32_16x16x32_bf16 v[252:255], a[236:239], v[100:103], 0
    s_add_u32 m0, s22, 25600
    ds_read_b128 a[212:215], v2 offset:2048
    v_accvgpr_read_b32 v148, a44
    v_mfma_f32_16x16x32_bf16 a[44:47], a[236:239], v[104:107], 0
    ds_read_b128 a[232:235], v1 offset:8192
    v_cvt_pk_bf16_f32 v122, v132, v133
    v_cvt_pk_bf16_f32 v120, v128, v129
    v_mfma_f32_16x16x32_bf16 a[92:95], a[236:239], v[108:111], 0
    buffer_store_dwordx4 v[136:139], v12, s[16:19], s56 offen offset:0 nt
    ds_read_b128 a[236:239], v2 offset:8192
    v_pk_mul_f32 v[148:149], v[148:149], v[156:157] op_sel_hi:[1,0]
    v_pk_mul_f32 v[150:151], v[150:151], v[156:157] op_sel_hi:[1,0]
    v_fma_f32 v88, v88, s28, v19
    s_nop 0
    v_mfma_f32_16x16x32_bf16 v[24:27], a[248:251], v[120:123], v[24:27]
    s_waitcnt lgkmcnt(6)
    ds_read_b128 a[216:219], v1 offset:6144
    v_fma_f32 v95, v95, s28, v19
    v_mfma_f32_16x16x32_bf16 v[32:35], a[192:195], a[96:99], 0
    buffer_load_dwordx4 v9, s[8:11], s21 offen lds
    v_mfma_f32_16x16x32_bf16 v[32:35], a[196:199], a[100:103], v[32:35]
    s_waitcnt lgkmcnt(5)
    v_exp_f32 v133, v93
    v_mfma_f32_16x16x32_bf16 v[32:35], a[200:203], a[104:107], v[32:35]
    ds_read_b128 a[228:231], v2 offset:7168
    v_fma_f32 v89, v89, s28, v19
    v_mfma_f32_16x16x32_bf16 v[32:35], a[204:207], a[108:111], v[32:35]
    s_waitcnt lgkmcnt(5)
    v_fma_f32 v92, v92, s28, v19
    v_fma_f32 v94, v94, s28, v19
    v_mfma_f32_16x16x32_bf16 v[32:35], a[208:211], a[112:115], v[32:35]
    s_waitcnt lgkmcnt(4)
    ds_read_b128 a[224:227], v1 offset:7168
    v_mfma_f32_16x16x32_bf16 v[32:35], a[212:215], a[116:119], v[32:35]
    ds_read_b128 a[220:223], v2 offset:6144
    s_add_u32 s21, s21, 128
    v_mfma_f32_16x16x32_bf16 v[40:43], a[192:195], a[120:123], 0
    v_exp_f32 v135, v95
    v_mfma_f32_16x16x32_bf16 v[40:43], a[196:199], a[124:127], v[40:43]
    s_add_u32 m0, s22, 26624
    v_exp_f32 v134, v94
    v_mfma_f32_16x16x32_bf16 v[40:43], a[200:203], a[128:131], v[40:43]
    v_exp_f32 v128, v88
    v_mfma_f32_16x16x32_bf16 v[40:43], a[204:207], a[132:135], v[40:43]
    buffer_load_dwordx4 v9, s[8:11], s21 offen lds
    v_mfma_f32_16x16x32_bf16 v[40:43], a[208:211], a[136:139], v[40:43]
    v_exp_f32 v130, v90
    v_mfma_f32_16x16x32_bf16 v[40:43], a[212:215], a[140:143], v[40:43]
    s_add_u32 s21, s21, 12032
    v_cvt_pk_bf16_f32 v127, v134, v135
    s_add_u32 s58, s25, 18304
    v_mfma_f32_16x16x32_bf16 v[48:51], a[192:195], a[144:147], 0
    s_add_u32 m0, s38, 18432
    v_exp_f32 v131, v91
    v_mfma_f32_16x16x32_bf16 v[48:51], a[196:199], a[148:151], v[48:51]
    v_exp_f32 v129, v89
    v_mfma_f32_16x16x32_bf16 v[48:51], a[200:203], a[152:155], v[48:51]
    buffer_load_dwordx4 v10, s[12:15], s58 offen nt lds
    v_mfma_f32_16x16x32_bf16 v[48:51], a[204:207], a[156:159], v[48:51]
    s_add_u32 m0, s38, 19456
    v_cvt_pk_bf16_f32 v148, v148, v149
    v_cvt_pk_bf16_f32 v125, v130, v131
    v_mfma_f32_16x16x32_bf16 v[48:51], a[208:211], a[160:163], v[48:51]
    buffer_load_dwordx4 v11, s[12:15], s58 offen nt lds
    v_mfma_f32_16x16x32_bf16 v[48:51], a[212:215], a[164:167], v[48:51]
    s_waitcnt vmcnt(19) lgkmcnt(0)
    v_exp_f32 v132, v92
    v_mfma_f32_16x16x32_bf16 v[56:59], a[192:195], a[168:171], 0
    v_cvt_pk_bf16_f32 v126, v132, v133
    s_add_u32 m0, s22, 0
    v_mfma_f32_16x16x32_bf16 v[56:59], a[196:199], a[172:175], v[56:59]
    v_cvt_pk_bf16_f32 v124, v128, v129
    v_mfma_f32_16x16x32_bf16 v[56:59], a[200:203], a[176:179], v[56:59]
    s_barrier
    v_mfma_f32_16x16x32_bf16 v[56:59], a[204:207], a[180:183], v[56:59]
    buffer_load_dwordx4 v9, s[4:7], s20 offen lds
    v_mfma_f32_16x16x32_bf16 v[24:27], a[252:255], v[124:127], v[24:27]
    ds_read_b64_tr_b16 a[192:193], v3 offset:12288
    s_add_u32 s20, s20, 128
    v_mfma_f32_16x16x32_bf16 v[56:59], a[208:211], a[184:187], v[56:59]
    ds_read_b64_tr_b16 a[194:195], v3 offset:18432
    v_add_u32 v13, 2048, v13
    v_mfma_f32_16x16x32_bf16 v[56:59], a[212:215], a[188:191], v[56:59]
    s_nop 1
    v_cmp_lt_f32 vcc, s29, v24
    v_mfma_f32_16x16x32_bf16 v[36:39], a[216:219], a[96:99], 0
    ds_read_b64_tr_b16 a[196:197], v4 offset:12288
    v_mfma_f32_16x16x32_bf16 v[36:39], a[220:223], a[100:103], v[36:39]
    ds_read_b64_tr_b16 a[198:199], v4 offset:18432
    v_mfma_f32_16x16x32_bf16 v[36:39], a[224:227], a[104:107], v[36:39]
    s_add_u32 m0, s22, 1024
    ds_read_b64_tr_b16 a[200:201], v5 offset:12288
    v_cvt_pk_bf16_f32 v149, v150, v151
    v_mfma_f32_16x16x32_bf16 v[36:39], a[228:231], a[108:111], v[36:39]
    s_cbranch_vccnz L_rs_tr34d
L_ret_tr34d:
    v_fma_f32 v34, v34, s28, v16
    v_mfma_f32_16x16x32_bf16 v[36:39], a[232:235], a[112:115], v[36:39]
    ds_read_b64_tr_b16 a[202:203], v5 offset:18432
    v_fma_f32 v32, v32, s28, v16
    v_mfma_f32_16x16x32_bf16 v[36:39], a[236:239], a[116:119], v[36:39]
    ds_read_b64_tr_b16 a[204:205], v6 offset:12288
    v_mfma_f32_16x16x32_bf16 v[44:47], a[216:219], a[120:123], 0
    v_fma_f32 v40, v40, s28, v17
    v_mfma_f32_16x16x32_bf16 v[44:47], a[220:223], a[124:127], v[44:47]
    buffer_load_dwordx4 v9, s[4:7], s20 offen lds
    v_mfma_f32_16x16x32_bf16 v[44:47], a[224:227], a[128:131], v[44:47]
    v_fma_f32 v33, v33, s28, v16
    v_fma_f32 v35, v35, s28, v16
    v_mfma_f32_16x16x32_bf16 v[44:47], a[228:231], a[132:135], v[44:47]
    buffer_store_dwordx4 v[140:143], v12, s[16:19], s56 offen offset:3072 nt
    ds_write_b64 v8, v[148:149] offset:16384
    v_mfma_f32_16x16x32_bf16 v[44:47], a[232:235], a[136:139], v[44:47]
    ds_read_b64_tr_b16 a[206:207], v6 offset:18432
    v_mfma_f32_16x16x32_bf16 v[44:47], a[236:239], a[140:143], v[44:47]
    v_exp_f32 v131, v35
    v_mfma_f32_16x16x32_bf16 v[52:55], a[216:219], a[144:147], 0
    v_exp_f32 v130, v34
    v_mfma_f32_16x16x32_bf16 v[52:55], a[220:223], a[148:151], v[52:55]
    s_add_u32 s20, s20, 128
    ds_read_b64_tr_b16 a[208:209], v3 offset:13312
    v_fma_f32 v41, v41, s28, v17
    v_mfma_f32_16x16x32_bf16 v[52:55], a[224:227], a[152:155], v[52:55]
    v_mfma_f32_16x16x32_bf16 v[52:55], a[228:231], a[156:159], v[52:55]
    v_exp_f32 v133, v41
    v_mfma_f32_16x16x32_bf16 v[52:55], a[232:235], a[160:163], v[52:55]
    s_add_u32 m0, s22, 2048
    v_exp_f32 v129, v33
    v_mfma_f32_16x16x32_bf16 v[52:55], a[236:239], a[164:167], v[52:55]
    buffer_load_dwordx4 v9, s[4:7], s20 offen lds
    v_mfma_f32_16x16x32_bf16 v[60:63], a[216:219], a[168:171], 0
    v_mfma_f32_16x16x32_bf16 v[60:63], a[220:223], a[172:175], v[60:63]
    s_add_u32 s20, s20, 12032
    v_exp_f32 v128, v32
    v_mfma_f32_16x16x32_bf16 v[60:63], a[224:227], a[176:179], v[60:63]
    ds_read_b64_tr_b16 a[210:211], v3 offset:19456
    v_cvt_pk_bf16_f32 v96, v128, v129
    v_mfma_f32_16x16x32_bf16 v[60:63], a[228:231], a[180:183], v[60:63]
    v_exp_f32 v132, v40
    v_mfma_f32_16x16x32_bf16 v[60:63], a[232:235], a[184:187], v[60:63]
    ds_read_b64_tr_b16 a[212:213], v4 offset:13312
    v_cvt_pk_bf16_f32 v100, v132, v133
    v_mfma_f32_16x16x32_bf16 v[60:63], a[236:239], a[188:191], v[60:63]
    ds_read_b64_tr_b16 a[214:215], v4 offset:19456
    v_cvt_pk_bf16_f32 v97, v130, v131
    s_branch L_loop4
L_tr33:
    s_waitcnt lgkmcnt(10)
    v_mfma_f32_16x16x32_bf16 v[160:163], a[192:195], v[112:115], v[160:163]
    ds_read_b64_tr_b16 a[222:223], v6 offset:19456
    v_fma_f32 v44, v44, s28, v17
    v_fma_f32 v49, v49, s28, v18
    v_mfma_f32_16x16x32_bf16 v[208:211], a[192:195], v[116:119], v[208:211]
    ds_read_b64_tr_b16 a[216:217], v5 offset:13312
    v_fma_f32 v38, v38, s28, v16
    v_fma_f32 v47, v47, s28, v17
    v_mfma_f32_16x16x32_bf16 a[0:3], a[192:195], v[120:123], a[0:3]
    s_waitcnt lgkmcnt(10)
    ds_read_b64_tr_b16 a[230:231], v4 offset:20480
    v_fma_f32 v42, v42, s28, v17
    v_mfma_f32_16x16x32_bf16 v[164:167], a[196:199], v[112:115], v[164:167]
    ds_read_b64_tr_b16 a[218:219], v5 offset:19456
    v_fma_f32 v54, v54, s28, v18
    v_mfma_f32_16x16x32_bf16 v[212:215], a[196:199], v[116:119], v[212:215]
    ds_read_b64_tr_b16 a[226:227], v3 offset:20480
    v_fma_f32 v46, v46, s28, v17
    v_mfma_f32_16x16x32_bf16 a[4:7], a[196:199], v[120:123], a[4:7]
    s_waitcnt lgkmcnt(11)
    ds_read_b64_tr_b16 a[234:235], v5 offset:20480
    v_fma_f32 v39, v39, s28, v16
    v_mfma_f32_16x16x32_bf16 v[168:171], a[200:203], v[112:115], v[168:171]
    ds_read_b64_tr_b16 a[232:233], v5 offset:14336
    v_exp_f32 v129, v39
    v_mfma_f32_16x16x32_bf16 v[216:219], a[200:203], v[116:119], v[216:219]
    ds_read_b64_tr_b16 a[238:239], v6 offset:20480
    v_fma_f32 v36, v36, s28, v16
    v_mfma_f32_16x16x32_bf16 a[8:11], a[200:203], v[120:123], a[8:11]
    s_waitcnt lgkmcnt(8)
    ds_read_b64_tr_b16 a[220:221], v6 offset:13312
    v_fma_f32 v37, v37, s28, v16
    v_mfma_f32_16x16x32_bf16 v[172:175], a[204:207], v[112:115], v[172:175]
    ds_read_b64_tr_b16 a[228:229], v4 offset:14336
    v_fma_f32 v52, v52, s28, v18
    v_mfma_f32_16x16x32_bf16 v[220:223], a[204:207], v[116:119], v[220:223]
    ds_read_b64_tr_b16 a[236:237], v6 offset:14336
    v_fma_f32 v43, v43, s28, v17
    v_mfma_f32_16x16x32_bf16 a[12:15], a[204:207], v[120:123], a[12:15]
    ds_read_b64_tr_b16 a[224:225], v3 offset:14336
    v_exp_f32 v130, v42
    v_mfma_f32_16x16x32_bf16 v[176:179], a[208:211], v[112:115], v[176:179]
    v_exp_f32 v134, v36
    v_mfma_f32_16x16x32_bf16 v[224:227], a[208:211], v[116:119], v[224:227]
    v_exp_f32 v128, v38
    v_mfma_f32_16x16x32_bf16 a[16:19], a[208:211], v[120:123], a[16:19]
    ds_read_b128 v[140:143], v13 offset:1024
    v_exp_f32 v135, v37
    v_mfma_f32_16x16x32_bf16 v[180:183], a[212:215], v[112:115], v[180:183]
    ds_read_b128 v[136:139], v13 offset:0
    v_cvt_pk_bf16_f32 v98, v134, v135
    v_mfma_f32_16x16x32_bf16 v[228:231], a[212:215], v[116:119], v[228:231]
    v_exp_f32 v131, v43
    v_mfma_f32_16x16x32_bf16 a[20:23], a[212:215], v[120:123], a[20:23]
    s_waitcnt lgkmcnt(6)
    v_fma_f32 v55, v55, s28, v18
    v_fma_f32 v45, v45, s28, v17
    v_mfma_f32_16x16x32_bf16 v[184:187], a[216:219], v[112:115], v[184:187]
    v_exp_f32 v134, v46
    v_cvt_pk_bf16_f32 v99, v128, v129
    v_mfma_f32_16x16x32_bf16 v[232:235], a[216:219], v[116:119], v[232:235]
    v_exp_f32 v129, v49
    v_mfma_f32_16x16x32_bf16 v[20:23], a[240:243], v[96:99], v[24:27]
    s_waitcnt vmcnt(10) lgkmcnt(2)
    v_exp_f32 v133, v45
    v_mfma_f32_16x16x32_bf16 a[24:27], a[216:219], v[120:123], a[24:27]
    s_barrier
    v_mfma_f32_16x16x32_bf16 v[188:191], a[220:223], v[112:115], v[188:191]
    v_exp_f32 v135, v47
    v_mfma_f32_16x16x32_bf16 v[236:239], a[220:223], v[116:119], v[236:239]
    s_add_u32 m0, s22, 36864
    ds_read_b128 a[192:195], v1 offset:12288
    v_cvt_pk_bf16_f32 v103, v134, v135
    v_mfma_f32_16x16x32_bf16 a[28:31], a[220:223], v[120:123], a[28:31]
    buffer_load_dwordx4 v9, s[8:11], s21 offen lds
    v_mfma_f32_16x16x32_bf16 v[192:195], a[224:227], v[112:115], v[192:195]
    ds_read_b128 a[196:199], v2 offset:12288
    v_fma_f32 v48, v48, s28, v18
    v_mfma_f32_16x16x32_bf16 v[240:243], a[224:227], v[116:119], v[240:243]
    s_add_u32 s21, s21, 128
    ds_read_b128 a[204:207], v2 offset:13312
    v_fma_f32 v53, v53, s28, v18
    v_mfma_f32_16x16x32_bf16 a[32:35], a[224:227], v[120:123], a[32:35]
    s_add_u32 m0, s22, 37888
    ds_read_b128 a[200:203], v1 offset:13312
    v_cvt_pk_bf16_f32 v101, v130, v131
    v_mfma_f32_16x16x32_bf16 v[196:199], a[228:231], v[112:115], v[196:199]
    v_exp_f32 v132, v44
    v_mfma_f32_16x16x32_bf16 v[244:247], a[228:231], v[116:119], v[244:247]
    ds_read_b128 a[208:211], v1 offset:14336
    v_cvt_pk_bf16_f32 v102, v132, v133
    v_mfma_f32_16x16x32_bf16 a[36:39], a[228:231], v[120:123], a[36:39]
    buffer_load_dwordx4 v9, s[8:11], s21 offen lds
    v_mfma_f32_16x16x32_bf16 v[200:203], a[232:235], v[112:115], v[200:203]
    s_add_u32 s21, s21, 128
    v_exp_f32 v132, v52
    v_mfma_f32_16x16x32_bf16 v[248:251], a[232:235], v[116:119], v[248:251]
    s_add_u32 m0, s22, 38912
    ds_read_b128 a[212:215], v2 offset:14336
    v_fma_f32 v50, v50, s28, v18
    v_fma_f32 v51, v51, s28, v18
    v_mfma_f32_16x16x32_bf16 a[40:43], a[232:235], v[120:123], a[40:43]
    v_exp_f32 v131, v51
    v_mfma_f32_16x16x32_bf16 v[204:207], a[236:239], v[112:115], v[204:207]
    buffer_load_dwordx4 v9, s[8:11], s21 offen lds
    v_mfma_f32_16x16x32_bf16 v[252:255], a[236:239], v[116:119], v[252:255]
    v_exp_f32 v135, v55
    v_mfma_f32_16x16x32_bf16 a[44:47], a[236:239], v[120:123], a[44:47]
    s_waitcnt lgkmcnt(3)
    v_exp_f32 v128, v48
    v_mfma_f32_16x16x32_bf16 v[64:67], a[192:195], a[96:99], 0
    ds_read_b128 a[224:227], v1 offset:19456
    s_add_u32 s21, s21, 12032
    v_mfma_f32_16x16x32_bf16 v[64:67], a[196:199], a[100:103], v[64:67]
    v_exp_f32 v134, v54
    v_mfma_f32_16x16x32_bf16 v[20:23], a[244:247], v[100:103], v[20:23]
    s_waitcnt lgkmcnt(2)
    v_exp_f32 v133, v53
    v_mfma_f32_16x16x32_bf16 v[64:67], a[200:203], a[104:107], v[64:67]
    v_cvt_pk_bf16_f32 v104, v128, v129
    v_cvt_pk_bf16_f32 v107, v134, v135
    v_mfma_f32_16x16x32_bf16 v[64:67], a[204:207], a[108:111], v[64:67]
    buffer_store_dwordx4 v[136:139], v12, s[16:19], s24 offen offset:0 nt
    ds_read_b128 a[228:231], v2 offset:19456
    v_exp_f32 v130, v50
    v_mfma_f32_16x16x32_bf16 v[64:67], a[208:211], a[112:115], v[64:67]
    s_waitcnt lgkmcnt(2)
    ds_read_b128 a[236:239], v2 offset:20480
    v_mfma_f32_16x16x32_bf16 v[64:67], a[212:215], a[116:119], v[64:67]
    v_cvt_pk_bf16_f32 v106, v132, v133
    v_cvt_pk_bf16_f32 v105, v130, v131
    v_mfma_f32_16x16x32_bf16 v[72:75], a[192:195], a[120:123], 0
    ds_read_b128 a[220:223], v2 offset:18432
    v_mfma_f32_16x16x32_bf16 v[20:23], a[248:251], v[104:107], v[20:23]
    ds_read_b128 a[216:219], v1 offset:18432
    v_mfma_f32_16x16x32_bf16 v[72:75], a[196:199], a[124:127], v[72:75]
    ds_read_b128 a[232:235], v1 offset:20480
    v_mfma_f32_16x16x32_bf16 v[72:75], a[200:203], a[128:131], v[72:75]
    buffer_store_dwordx4 v[140:143], v12, s[16:19], s24 offen offset:3072 nt
    s_nop 2
    v_cmp_lt_f32 vcc, s29, v20
    v_mfma_f32_16x16x32_bf16 v[72:75], a[204:207], a[132:135], v[72:75]
    ds_read_b128 v[136:139], v13 offset:2048
    v_mfma_f32_16x16x32_bf16 v[72:75], a[208:211], a[136:139], v[72:75]
    ds_read_b128 v[140:143], v13 offset:3072
    v_mfma_f32_16x16x32_bf16 v[72:75], a[212:215], a[140:143], v[72:75]
    s_cbranch_vccnz L_rs_tr33a
L_ret_tr33a:
    v_fma_f32 v64, v64, s28, v16
    v_mfma_f32_16x16x32_bf16 v[80:83], a[192:195], a[144:147], 0
    v_fma_f32 v67, v67, s28, v16
    v_fma_f32 v66, v66, s28, v16
    v_mfma_f32_16x16x32_bf16 v[80:83], a[196:199], a[148:151], v[80:83]
    v_exp_f32 v128, v64
    v_mfma_f32_16x16x32_bf16 v[80:83], a[200:203], a[152:155], v[80:83]
    s_add_u32 s57, s24, 128
    v_exp_f32 v130, v66
    v_mfma_f32_16x16x32_bf16 v[80:83], a[204:207], a[156:159], v[80:83]
    v_fma_f32 v65, v65, s28, v16
    s_waitcnt vmcnt(8) lgkmcnt(2)
    v_mfma_f32_16x16x32_bf16 v[80:83], a[208:211], a[160:163], v[80:83]
    s_barrier
    v_mfma_f32_16x16x32_bf16 v[80:83], a[212:215], a[164:167], v[80:83]
    s_add_u32 m0, s22, 12288
    ds_read_b64_tr_b16 a[192:193], v3 offset:0
    v_mfma_f32_16x16x32_bf16 v[68:71], a[216:219], a[96:99], 0
    ds_read_b64_tr_b16 a[194:195], v3 offset:6144
    v_fma_f32 v73, v73, s28, v17
    v_mfma_f32_16x16x32_bf16 v[68:71], a[220:223], a[100:103], v[68:71]
    buffer_load_dwordx4 v9, s[4:7], s20 offen lds
    v_mfma_f32_16x16x32_bf16 v[68:71], a[224:227], a[104:107], v[68:71]
    s_waitcnt lgkmcnt(2)
    buffer_store_dwordx4 v[136:139], v12, s[16:19], s57 offen offset:0 nt
    ds_read_b64_tr_b16 a[196:197], v4 offset:0
    v_exp_f32 v129, v65
    v_mfma_f32_16x16x32_bf16 v[68:71], a[228:231], a[108:111], v[68:71]
    v_mfma_f32_16x16x32_bf16 v[68:71], a[232:235], a[112:115], v[68:71]
    s_add_u32 s20, s20, 128
    s_add_u32 m0, s22, 13312
    ds_read_b64_tr_b16 a[198:199], v4 offset:6144
    v_mfma_f32_16x16x32_bf16 v[68:71], a[236:239], a[116:119], v[68:71]
    buffer_load_dwordx4 v9, s[4:7], s20 offen lds
    v_mfma_f32_16x16x32_bf16 v[76:79], a[216:219], a[120:123], 0
    ds_read_b64_tr_b16 a[200:201], v5 offset:0
    v_mfma_f32_16x16x32_bf16 v[76:79], a[220:223], a[124:127], v[76:79]
    ds_read_b64_tr_b16 a[202:203], v5 offset:6144
    v_mfma_f32_16x16x32_bf16 v[76:79], a[224:227], a[128:131], v[76:79]
    ds_read_b64_tr_b16 a[204:205], v6 offset:0
    v_cvt_pk_bf16_f32 v112, v128, v129
    v_mfma_f32_16x16x32_bf16 v[76:79], a[228:231], a[132:135], v[76:79]
    ds_read_b64_tr_b16 a[206:207], v6 offset:6144
    v_fma_f32 v72, v72, s28, v17
    v_mfma_f32_16x16x32_bf16 v[76:79], a[232:235], a[136:139], v[76:79]
    v_exp_f32 v132, v72
    v_mfma_f32_16x16x32_bf16 v[76:79], a[236:239], a[140:143], v[76:79]
    s_add_u32 s20, s20, 128
    ds_read_b64_tr_b16 a[208:209], v3 offset:1024
    v_mfma_f32_16x16x32_bf16 v[84:87], a[216:219], a[144:147], 0
    v_exp_f32 v131, v67
    v_mfma_f32_16x16x32_bf16 v[84:87], a[220:223], a[148:151], v[84:87]
    v_cvt_pk_bf16_f32 v113, v130, v131
    v_mfma_f32_16x16x32_bf16 v[84:87], a[224:227], a[152:155], v[84:87]
    buffer_store_dwordx4 v[140:143], v12, s[16:19], s57 offen offset:3072 nt
    ds_read_b64_tr_b16 a[210:211], v3 offset:7168
    v_exp_f32 v133, v73
    v_mfma_f32_16x16x32_bf16 v[84:87], a[228:231], a[156:159], v[84:87]
    s_add_u32 m0, s22, 14336
    ds_read_b64_tr_b16 a[212:213], v4 offset:1024
    v_cvt_pk_bf16_f32 v116, v132, v133
    v_mfma_f32_16x16x32_bf16 v[84:87], a[232:235], a[160:163], v[84:87]
    buffer_load_dwordx4 v9, s[4:7], s20 offen lds
    v_mfma_f32_16x16x32_bf16 v[84:87], a[236:239], a[164:167], v[84:87]
    ds_read_b64_tr_b16 a[214:215], v4 offset:7168
    s_add_u32 s20, s20, 12032
    s_waitcnt lgkmcnt(10)
    v_mfma_f32_16x16x32_bf16 v[160:163], a[192:195], v[96:99], v[160:163]
    ds_read_b64_tr_b16 a[218:219], v5 offset:7168
    v_fma_f32 v69, v69, s28, v16
    v_mfma_f32_16x16x32_bf16 v[208:211], a[192:195], v[100:103], v[208:211]
    ds_read_b64_tr_b16 a[238:239], v6 offset:8192
    v_xor_b32 v8, 64, v7
    v_mfma_f32_16x16x32_bf16 a[0:3], a[192:195], v[104:107], a[0:3]
    ds_read_b64_tr_b16 a[216:217], v5 offset:1024
    s_waitcnt lgkmcnt(11)
    v_mfma_f32_16x16x32_bf16 v[164:167], a[196:199], v[96:99], v[164:167]
    ds_read_b128 a[116:119], v8 offset:4096
    v_fma_f32 v70, v70, s28, v16
    v_mfma_f32_16x16x32_bf16 v[212:215], a[196:199], v[100:103], v[212:215]
    ds_read_b64_tr_b16 a[224:225], v3 offset:2048
    v_mfma_f32_16x16x32_bf16 a[4:7], a[196:199], v[104:107], a[4:7]
    ds_read_b64_tr_b16 a[232:233], v5 offset:2048
    s_waitcnt lgkmcnt(12)
    v_mfma_f32_16x16x32_bf16 v[168:171], a[200:203], v[96:99], v[168:171]
    ds_read_b64_tr_b16 a[230:231], v4 offset:8192
    ds_read_b64_tr_b16 a[220:221], v6 offset:1024
    v_mfma_f32_16x16x32_bf16 v[216:219], a[200:203], v[100:103], v[216:219]
    ds_read_b64_tr_b16 a[236:237], v6 offset:2048
    v_fma_f32 v86, v86, s28, v18
    v_mfma_f32_16x16x32_bf16 a[8:11], a[200:203], v[104:107], a[8:11]
    s_waitcnt lgkmcnt(12)
    ds_read_b128 a[140:143], v8 offset:10240
    v_fma_f32 v76, v76, s28, v17
    v_mfma_f32_16x16x32_bf16 v[172:175], a[204:207], v[96:99], v[172:175]
    ds_read_b64_tr_b16 a[228:229], v4 offset:2048
    ds_read_b64_tr_b16 a[222:223], v6 offset:7168
    v_mfma_f32_16x16x32_bf16 v[220:223], a[204:207], v[100:103], v[220:223]
    ds_read_b64_tr_b16 a[234:235], v5 offset:8192
    ds_read_b64_tr_b16 a[226:227], v3 offset:8192
    v_mfma_f32_16x16x32_bf16 a[12:15], a[204:207], v[104:107], a[12:15]
    s_waitcnt lgkmcnt(12)
    ds_read_b128 a[120:123], v7 offset:6144
    v_fma_f32 v81, v81, s28, v18
    v_mfma_f32_16x16x32_bf16 v[176:179], a[208:211], v[96:99], v[176:179]
    ds_read_b128 a[128:131], v7 offset:8192
    v_fma_f32 v68, v68, s28, v16
    v_mfma_f32_16x16x32_bf16 v[224:227], a[208:211], v[100:103], v[224:227]
    ds_read_b128 a[124:127], v8 offset:6144
    v_fma_f32 v78, v78, s28, v17
    v_mfma_f32_16x16x32_bf16 a[16:19], a[208:211], v[104:107], a[16:19]
    ds_read_b128 a[144:147], v7 offset:12288
    v_fma_f32 v87, v87, s28, v18
    v_mfma_f32_16x16x32_bf16 v[180:183], a[212:215], v[96:99], v[180:183]
    ds_read_b128 a[96:99], v7 offset:0
    v_exp_f32 v135, v69
    v_mfma_f32_16x16x32_bf16 v[228:231], a[212:215], v[100:103], v[228:231]
    ds_read_b128 a[104:107], v7 offset:2048
    v_exp_f32 v134, v68
    v_mfma_f32_16x16x32_bf16 a[20:23], a[212:215], v[104:107], a[20:23]
    s_waitcnt lgkmcnt(11)
    ds_read_b128 a[108:111], v8 offset:2048
    v_fma_f32 v71, v71, s28, v16
    v_mfma_f32_16x16x32_bf16 v[184:187], a[216:219], v[96:99], v[184:187]
    v_exp_f32 v132, v76
    v_mfma_f32_16x16x32_bf16 v[232:235], a[216:219], v[100:103], v[232:235]
    ds_read_b128 a[152:155], v7 offset:14336
    v_fma_f32 v82, v82, s28, v18
    v_mfma_f32_16x16x32_bf16 a[24:27], a[216:219], v[104:107], a[24:27]
    ds_read_b128 a[100:103], v8 offset:0
    s_waitcnt vmcnt(10) lgkmcnt(8)
    v_mfma_f32_16x16x32_bf16 v[188:191], a[220:223], v[96:99], v[188:191]
    s_barrier
    ds_read_b128 a[208:211], v1 offset:2048
    v_mfma_f32_16x16x32_bf16 v[236:239], a[220:223], v[100:103], v[236:239]
    v_exp_f32 v128, v70
    v_mfma_f32_16x16x32_bf16 a[28:31], a[220:223], v[104:107], a[28:31]
    s_add_u32 m0, s22, 24576
    ds_read_b128 a[192:195], v1 offset:0
    v_fma_f32 v80, v80, s28, v18
    v_mfma_f32_16x16x32_bf16 v[192:195], a[224:227], v[96:99], v[192:195]
    ds_read_b128 a[220:223], v2 offset:6144
    v_exp_f32 v129, v71
    v_mfma_f32_16x16x32_bf16 v[240:243], a[224:227], v[100:103], v[240:243]
    ds_read_b128 a[200:203], v1 offset:1024
    buffer_load_dwordx4 v9, s[8:11], s21 offen lds
    v_mfma_f32_16x16x32_bf16 a[32:35], a[224:227], v[104:107], a[32:35]
    ds_read_b128 a[196:199], v2 offset:0
    v_fma_f32 v79, v79, s28, v17
    v_mfma_f32_16x16x32_bf16 v[196:199], a[228:231], v[96:99], v[196:199]
    s_add_u32 s21, s21, 128
    ds_read_b128 a[160:163], v7 offset:16384
    v_fma_f32 v77, v77, s28, v17
    v_mfma_f32_16x16x32_bf16 v[244:247], a[228:231], v[100:103], v[244:247]
    ds_read_b128 a[204:207], v2 offset:1024
    v_cvt_pk_bf16_f32 v115, v128, v129
    v_mfma_f32_16x16x32_bf16 a[36:39], a[228:231], v[104:107], a[36:39]
    s_add_u32 m0, s22, 25600
    ds_read_b128 a[216:219], v1 offset:6144
    v_cvt_pk_bf16_f32 v114, v134, v135
    v_mfma_f32_16x16x32_bf16 v[200:203], a[232:235], v[96:99], v[200:203]
    ds_read_b128 a[112:115], v7 offset:4096
    buffer_load_dwordx4 v9, s[8:11], s21 offen lds
    v_mfma_f32_16x16x32_bf16 v[248:251], a[232:235], v[100:103], v[248:251]
    ds_read_b128 a[212:215], v2 offset:2048
    v_fma_f32 v84, v84, s28, v18
    v_mfma_f32_16x16x32_bf16 a[40:43], a[232:235], v[104:107], a[40:43]
    s_add_u32 s21, s21, 128
    ds_read_b128 a[132:135], v8 offset:8192
    v_fma_f32 v74, v74, s28, v17
    v_mfma_f32_16x16x32_bf16 v[204:207], a[236:239], v[96:99], v[204:207]
    ds_read_b128 a[148:151], v8 offset:12288
    v_fma_f32 v75, v75, s28, v17
    v_mfma_f32_16x16x32_bf16 v[252:255], a[236:239], v[100:103], v[252:255]
    ds_read_b128 a[136:139], v7 offset:10240
    s_add_u32 m0, s22, 26624
    v_mfma_f32_16x16x32_bf16 a[44:47], a[236:239], v[104:107], a[44:47]
    s_waitcnt lgkmcnt(9)
    v_exp_f32 v134, v78
    v_mfma_f32_16x16x32_bf16 v[32:35], a[192:195], a[96:99], 0
    s_waitcnt lgkmcnt(8)
    v_exp_f32 v135, v79
    v_mfma_f32_16x16x32_bf16 v[32:35], a[196:199], a[100:103], v[32:35]
    buffer_load_dwordx4 v9, s[8:11], s21 offen lds
    v_mfma_f32_16x16x32_bf16 v[32:35], a[200:203], a[104:107], v[32:35]
    s_waitcnt lgkmcnt(6)
    ds_read_b128 a[164:167], v8 offset:16384
    v_fma_f32 v85, v85, s28, v18
    v_mfma_f32_16x16x32_bf16 v[32:35], a[204:207], a[108:111], v[32:35]
    ds_read_b128 a[156:159], v8 offset:14336
    s_waitcnt lgkmcnt(6)
    v_mfma_f32_16x16x32_bf16 v[32:35], a[208:211], a[112:115], v[32:35]
    ds_read_b128 a[228:231], v2 offset:7168
    s_waitcnt lgkmcnt(6)
    v_mfma_f32_16x16x32_bf16 v[32:35], a[212:215], a[116:119], v[32:35]
    ds_read_b128 a[236:239], v2 offset:8192
    v_fma_f32 v83, v83, s28, v18
    v_mfma_f32_16x16x32_bf16 v[40:43], a[192:195], a[120:123], 0
    ds_read_b128 a[232:235], v1 offset:8192
    v_cvt_pk_bf16_f32 v119, v134, v135
    v_mfma_f32_16x16x32_bf16 v[40:43], a[196:199], a[124:127], v[40:43]
    v_exp_f32 v129, v81
    v_mfma_f32_16x16x32_bf16 v[40:43], a[200:203], a[128:131], v[40:43]
    s_waitcnt lgkmcnt(5)
    ds_read_b128 a[224:227], v1 offset:7168
    v_mfma_f32_16x16x32_bf16 v[40:43], a[204:207], a[132:135], v[40:43]
    v_exp_f32 v130, v74
    v_mfma_f32_16x16x32_bf16 v[40:43], a[208:211], a[136:139], v[40:43]
    v_exp_f32 v131, v75
    v_mfma_f32_16x16x32_bf16 v[40:43], a[212:215], a[140:143], v[40:43]
    v_exp_f32 v135, v87
    v_mfma_f32_16x16x32_bf16 v[24:27], a[240:243], v[112:115], v[20:23]
    s_add_u32 s21, s21, 12032
    v_exp_f32 v128, v80
    v_mfma_f32_16x16x32_bf16 v[48:51], a[192:195], a[144:147], 0
    v_exp_f32 v133, v77
    v_mfma_f32_16x16x32_bf16 v[48:51], a[196:199], a[148:151], v[48:51]
    v_cvt_pk_bf16_f32 v118, v132, v133
    v_cvt_pk_bf16_f32 v117, v130, v131
    v_mfma_f32_16x16x32_bf16 v[48:51], a[200:203], a[152:155], v[48:51]
    s_waitcnt lgkmcnt(2)
    v_exp_f32 v130, v82
    v_mfma_f32_16x16x32_bf16 v[48:51], a[204:207], a[156:159], v[48:51]
    v_exp_f32 v131, v83
    v_mfma_f32_16x16x32_bf16 v[24:27], a[244:247], v[116:119], v[24:27]
    v_exp_f32 v132, v84
    v_mfma_f32_16x16x32_bf16 v[48:51], a[208:211], a[160:163], v[48:51]
    s_waitcnt vmcnt(10) lgkmcnt(0)
    v_cvt_pk_bf16_f32 v121, v130, v131
    v_mfma_f32_16x16x32_bf16 v[48:51], a[212:215], a[164:167], v[48:51]
    s_barrier
    v_mfma_f32_16x16x32_bf16 v[36:39], a[216:219], a[96:99], 0
    v_exp_f32 v133, v85
    v_mfma_f32_16x16x32_bf16 v[36:39], a[220:223], a[100:103], v[36:39]
    ds_read_b64_tr_b16 a[192:193], v3 offset:12288
    v_mfma_f32_16x16x32_bf16 v[36:39], a[224:227], a[104:107], v[36:39]
    ds_read_b64_tr_b16 a[194:195], v3 offset:18432
    v_cvt_pk_bf16_f32 v122, v132, v133
    v_mfma_f32_16x16x32_bf16 v[36:39], a[228:231], a[108:111], v[36:39]
    v_exp_f32 v134, v86
    v_mfma_f32_16x16x32_bf16 v[36:39], a[232:235], a[112:115], v[36:39]
    ds_read_b64_tr_b16 a[196:197], v4 offset:12288
    v_mfma_f32_16x16x32_bf16 v[36:39], a[236:239], a[116:119], v[36:39]
    ds_read_b64_tr_b16 a[198:199], v4 offset:18432
    s_add_u32 m0, s22, 0
    v_mfma_f32_16x16x32_bf16 v[44:47], a[216:219], a[120:123], 0
    ds_read_b64_tr_b16 a[200:201], v5 offset:12288
    v_mfma_f32_16x16x32_bf16 v[44:47], a[220:223], a[124:127], v[44:47]
    v_cvt_pk_bf16_f32 v123, v134, v135
    v_cvt_pk_bf16_f32 v120, v128, v129
    v_mfma_f32_16x16x32_bf16 v[44:47], a[224:227], a[128:131], v[44:47]
    buffer_load_dwordx4 v9, s[4:7], s20 offen lds
    v_mfma_f32_16x16x32_bf16 v[24:27], a[248:251], v[120:123], v[24:27]
    s_add_u32 s20, s20, 128
    s_add_u32 m0, s22, 1024
    ds_read_b64_tr_b16 a[202:203], v5 offset:18432
    v_mfma_f32_16x16x32_bf16 v[44:47], a[228:231], a[132:135], v[44:47]
    buffer_load_dwordx4 v9, s[4:7], s20 offen lds
    v_mfma_f32_16x16x32_bf16 v[44:47], a[232:235], a[136:139], v[44:47]
    ds_read_b64_tr_b16 a[204:205], v6 offset:12288
    v_mfma_f32_16x16x32_bf16 v[44:47], a[236:239], a[140:143], v[44:47]
    ds_read_b64_tr_b16 a[206:207], v6 offset:18432
    v_mfma_f32_16x16x32_bf16 v[52:55], a[216:219], a[144:147], 0
    s_add_u32 s20, s20, 128
    ds_read_b64_tr_b16 a[208:209], v3 offset:13312
    s_add_u32 m0, s22, 2048
    v_mfma_f32_16x16x32_bf16 v[52:55], a[220:223], a[148:151], v[52:55]
    ds_read_b64_tr_b16 a[210:211], v3 offset:19456
    v_cmp_lt_f32 vcc, s29, v24
    v_mfma_f32_16x16x32_bf16 v[52:55], a[224:227], a[152:155], v[52:55]
    buffer_load_dwordx4 v9, s[4:7], s20 offen lds
    v_mfma_f32_16x16x32_bf16 v[52:55], a[228:231], a[156:159], v[52:55]
    ds_read_b64_tr_b16 a[212:213], v4 offset:13312
    v_mfma_f32_16x16x32_bf16 v[52:55], a[232:235], a[160:163], v[52:55]
    s_cbranch_vccnz L_rs_tr33b
L_ret_tr33b:
    ds_read_b64_tr_b16 a[214:215], v4 offset:19456
    v_mfma_f32_16x16x32_bf16 v[52:55], a[236:239], a[164:167], v[52:55]
    s_add_u32 s20, s20, 12032
    s_waitcnt lgkmcnt(10)
    v_mfma_f32_16x16x32_bf16 v[160:163], a[192:195], v[112:115], v[160:163]
    s_add_u32 s24, s34, 128
    ds_read_b64_tr_b16 a[228:229], v4 offset:14336
    v_max3_f32 v30, v40, v41, v42
    v_mov_b32 v153, v24
    v_max3_f32 v28, v32, v33, v34
    v_max3_f32 v28, v28, v35, v36
    v_max3_f32 v28, v28, v37, v38
    v_mfma_f32_16x16x32_bf16 v[208:211], a[192:195], v[116:119], v[208:211]
    s_add_u32 s18, s34, 18432
    ds_read_b64_tr_b16 a[218:219], v5 offset:19456
    v_max3_f32 v30, v30, v43, v44
    v_mfma_f32_16x16x32_bf16 a[0:3], a[192:195], v[120:123], a[0:3]
    s_waitcnt lgkmcnt(10)
    v_max3_f32 v30, v30, v45, v46
    v_max_f32 v28, v28, v39
    v_mfma_f32_16x16x32_bf16 v[164:167], a[196:199], v[112:115], v[164:167]
    s_mov_b32 s34, s33
    ds_read_b64_tr_b16 a[222:223], v6 offset:19456
    v_mov_b32 v29, v28
    v_mfma_f32_16x16x32_bf16 v[212:215], a[196:199], v[116:119], v[212:215]
    s_add_u32 s37, s37, 1
    v_accvgpr_read_b32 v145, a1
    v_max_f32 v30, v30, v47
    v_permlane32_swap_b32 v29, v28
    s_add_u32 s35, s35, 325632
    v_mfma_f32_16x16x32_bf16 a[4:7], a[196:199], v[120:123], a[4:7]
    s_waitcnt lgkmcnt(9)
    ds_read_b64_tr_b16 a[220:221], v6 offset:13312
    v_max_f32 v28, v28, v29
    v_mfma_f32_16x16x32_bf16 v[168:171], a[200:203], v[112:115], v[168:171]
    s_lshl_b32 s42, s37, 1
    ds_read_b64_tr_b16 a[216:217], v5 offset:13312
    s_lshr_b32 s42, s31, s42
    s_xor_b32 s42, s42, s36
    v_mfma_f32_16x16x32_bf16 v[216:219], a[200:203], v[116:119], v[216:219]
    s_and_b32 s42, s42, 3
    v_rcp_f32 v154, v25
    v_mfma_f32_16x16x32_bf16 a[8:11], a[200:203], v[120:123], a[8:11]
    s_waitcnt lgkmcnt(4)
    ds_read_b64_tr_b16 a[238:239], v6 offset:20480
    v_mov_b32 v31, v30
    v_mov_b32 v29, v28
    v_mfma_f32_16x16x32_bf16 v[172:175], a[204:207], v[112:115], v[172:175]
    s_mul_i32 s43, s3, 3
    v_permlane32_swap_b32 v31, v30
    v_permlane16_swap_b32 v29, v28
    v_mfma_f32_16x16x32_bf16 v[220:223], a[204:207], v[116:119], v[220:223]
    s_lshl_b32 s44, s3, 2
    v_max_f32 v30, v30, v31
    v_max_f32 v28, v28, v29
    v_mfma_f32_16x16x32_bf16 a[12:15], a[204:207], v[120:123], a[12:15]
    s_mov_b32 s32, 1
    ds_read_b64_tr_b16 a[236:237], v6 offset:14336
    v_mul_f32_e64 v16, -s28, v28
    v_mfma_f32_16x16x32_bf16 v[176:179], a[208:211], v[112:115], v[176:179]
    s_add_u32 s45, s43, 17
    ds_read_b64_tr_b16 a[226:227], v3 offset:20480
    v_fma_f32 v35, v35, s28, v16
    v_accvgpr_read_b32 v149, a5
    v_mfma_f32_16x16x32_bf16 v[224:227], a[208:211], v[116:119], v[224:227]
    s_cmp_eq_u32 s3, 0
    ds_read_b64_tr_b16 a[234:235], v5 offset:20480
    v_max3_f32 v28, v48, v49, v50
    v_mfma_f32_16x16x32_bf16 a[16:19], a[208:211], v[120:123], a[16:19]
    s_cselect_b32 s45, 16, s45
    v_max3_f32 v28, v28, v51, v52
    v_fma_f32 v36, v36, s28, v16
    s_cselect_b32 s33, 1, 0
    v_mfma_f32_16x16x32_bf16 v[180:183], a[212:215], v[112:115], v[180:183]
    s_cmp_eq_u32 s42, 1
    ds_read_b64_tr_b16 a[232:233], v5 offset:14336
    v_fma_f32 v34, v34, s28, v16
    v_mfma_f32_16x16x32_bf16 v[228:231], a[212:215], v[116:119], v[228:231]
    s_cselect_b32 s44, s45, s44
    ds_read_b64_tr_b16 a[224:225], v3 offset:14336
    v_mov_b32 v31, v30
    v_mfma_f32_16x16x32_bf16 a[20:23], a[212:215], v[120:123], a[20:23]
    s_waitcnt lgkmcnt(5)
    ds_read_b64_tr_b16 a[230:231], v4 offset:20480
    v_max3_f32 v28, v28, v53, v54
    v_mfma_f32_16x16x32_bf16 v[184:187], a[216:219], v[112:115], v[184:187]
    s_cselect_b32 s32, s33, s32
    v_permlane16_swap_b32 v31, v30
    v_mfma_f32_16x16x32_bf16 v[232:235], a[216:219], v[116:119], v[232:235]
    s_add_u32 s45, s43, 29
    v_max_f32 v28, v28, v55
    v_fma_f32 v38, v38, s28, v16
    v_mfma_f32_16x16x32_bf16 a[24:27], a[216:219], v[120:123], a[24:27]
    s_cmp_eq_u32 s42, 2
    v_rcp_f32 v156, v26
    v_mfma_f32_16x16x32_bf16 v[188:191], a[220:223], v[112:115], v[188:191]
    s_cselect_b32 s44, s45, s44
    v_max_f32 v30, v30, v31
    v_mov_b32 v152, v24
    s_cselect_b32 s32, 0, s32
    s_add_u32 s45, s43, 41
    v_fma_f32 v37, v37, s28, v16
    v_pk_mul_f32 v[228:229], v[228:229], v[154:155] op_sel_hi:[1,0]
    v_pk_mul_f32 v[208:209], v[208:209], v[154:155] op_sel_hi:[1,0]
    v_mov_b32 v29, v28
    v_pk_mul_f32 v[212:213], v[212:213], v[154:155] op_sel_hi:[1,0]
    v_pk_mul_f32 v[210:211], v[210:211], v[154:155] op_sel_hi:[1,0]
    v_mul_f32_e64 v17, -s28, v30
    v_permlane16_swap_b32 v152, v153
    s_cmp_eq_u32 s42, 3
    v_mfma_f32_16x16x32_bf16 v[236:239], a[220:223], v[116:119], v[236:239]
    s_cselect_b32 s44, s45, s44
    v_permlane32_swap_b32 v29, v28
    v_fma_f32 v41, v41, s28, v17
    v_max_f32 v28, v28, v29
    s_cselect_b32 s32, 0, s32
    v_accvgpr_read_b32 v146, a2
    v_fma_f32 v44, v44, s28, v17
    v_rcp_f32 v152, v152
    v_mfma_f32_16x16x32_bf16 a[28:31], a[220:223], v[120:123], a[28:31]
    s_mul_i32 s44, s44, 6144
    s_add_u32 s33, s35, s44
    s_waitcnt lgkmcnt(0)
    v_mfma_f32_16x16x32_bf16 v[192:195], a[224:227], v[112:115], v[192:195]
    s_mul_i32 s42, s32, 6144
    s_add_u32 s42, s42, 18432
    v_fma_f32 v42, v42, s28, v17
    v_mfma_f32_16x16x32_bf16 v[240:243], a[224:227], v[116:119], v[240:243]
    s_add_u32 s42, s42, s33
    v_mov_b32 v29, v28
    v_accvgpr_read_b32 v144, a0
    s_cmp_ge_u32 s37, 8
    v_mfma_f32_16x16x32_bf16 a[32:35], a[224:227], v[120:123], a[32:35]
    s_cselect_b32 s14, 0, s42
    v_fma_f32 v33, v33, s28, v16
    v_exp_f32 v129, v33
    v_subrev_u32 v13, 20480, v13
    v_mfma_f32_16x16x32_bf16 v[196:199], a[228:231], v[112:115], v[196:199]
    s_add_u32 s25, s33, 128
    v_accvgpr_read_b32 v151, a7
    s_add_u32 s23, s38, 2048
    s_mov_b32 s30, 0
    v_mfma_f32_16x16x32_bf16 v[244:247], a[228:231], v[116:119], v[244:247]
    s_waitcnt vmcnt(6)
    v_fma_f32 v32, v32, s28, v16
    v_permlane16_swap_b32 v29, v28
    v_cvt_pk_bf16_f32 v228, v228, v229
    v_mfma_f32_16x16x32_bf16 a[36:39], a[228:231], v[120:123], a[36:39]
    s_barrier
    ds_read_b128 a[208:211], v1 offset:14336
    v_mfma_f32_16x16x32_bf16 v[200:203], a[232:235], v[112:115], v[200:203]
    ds_read_b128 a[212:215], v2 offset:14336
    v_exp_f32 v134, v36
    v_fma_f32 v40, v40, s28, v17
    v_exp_f32 v132, v40
    v_mfma_f32_16x16x32_bf16 v[248:251], a[232:235], v[116:119], v[248:251]
    s_add_u32 m0, s22, 36864
    ds_read_b128 a[200:203], v1 offset:13312
    v_fma_f32 v39, v39, s28, v16
    v_xor_b32 v8, 96, v14
    v_mfma_f32_16x16x32_bf16 a[40:43], a[232:235], v[120:123], a[40:43]
    ds_read_b128 a[196:199], v2 offset:12288
    v_exp_f32 v128, v32
    v_mfma_f32_16x16x32_bf16 v[204:207], a[236:239], v[112:115], v[204:207]
    ds_read_b128 a[192:195], v1 offset:12288
    v_max_f32 v28, v28, v29
    v_exp_f32 v131, v35
    v_mfma_f32_16x16x32_bf16 v[252:255], a[236:239], v[116:119], v[252:255]
    buffer_load_dwordx4 v9, s[8:11], s21 offen lds
    ds_read_b128 a[204:207], v2 offset:13312
    v_exp_f32 v135, v37
    v_mfma_f32_16x16x32_bf16 a[44:47], a[236:239], v[120:123], a[44:47]
    ds_read_b128 a[224:227], v1 offset:19456
    v_exp_f32 v133, v41
    v_accvgpr_read_b32 v150, a6
    v_fma_f32 v47, v47, s28, v17
    v_pk_mul_f32 v[172:173], v[172:173], v[152:153] op_sel_hi:[1,0]
    v_pk_mul_f32 v[176:177], v[176:177], v[152:153] op_sel_hi:[1,0]
    v_pk_mul_f32 v[162:163], v[162:163], v[152:153] op_sel_hi:[1,0]
    v_accvgpr_read_b32 v147, a3
    v_pk_mul_f32 v[182:183], v[182:183], v[152:153] op_sel_hi:[1,0]
    v_pk_mul_f32 v[190:191], v[190:191], v[152:153] op_sel_hi:[1,0]
    v_pk_mul_f32 v[206:207], v[206:207], v[152:153] op_sel_hi:[1,0]
    v_pk_mul_f32 v[164:165], v[164:165], v[152:153] op_sel_hi:[1,0]
    v_pk_mul_f32 v[240:241], v[240:241], v[154:155] op_sel_hi:[1,0]
    v_pk_mul_f32 v[214:215], v[214:215], v[154:155] op_sel_hi:[1,0]
    v_pk_mul_f32 v[252:253], v[252:253], v[154:155] op_sel_hi:[1,0]
    v_pk_mul_f32 v[222:223], v[222:223], v[154:155] op_sel_hi:[1,0]
    v_pk_mul_f32 v[180:181], v[180:181], v[152:153] op_sel_hi:[1,0]
    v_pk_mul_f32 v[146:147], v[146:147], v[156:157] op_sel_hi:[1,0]
    v_exp_f32 v130, v34
    v_pk_mul_f32 v[144:145], v[144:145], v[156:157] op_sel_hi:[1,0]
    v_pk_mul_f32 v[188:189], v[188:189], v[152:153] op_sel_hi:[1,0]
    v_pk_mul_f32 v[242:243], v[242:243], v[154:155] op_sel_hi:[1,0]
    v_mul_f32_e64 v18, -s28, v28
    s_waitcnt lgkmcnt(2)
    v_mfma_f32_16x16x32_bf16 v[64:67], a[192:195], a[96:99], 0
    ds_read_b128 a[232:235], v1 offset:20480
    v_cvt_pk_bf16_f32 v100, v132, v133
    v_mfma_f32_16x16x32_bf16 v[64:67], a[196:199], a[100:103], v[64:67]
    v_fma_f32 v46, v46, s28, v17
    v_cvt_pk_bf16_f32 v98, v134, v135
    v_cvt_pk_bf16_f32 v96, v128, v129
    v_mfma_f32_16x16x32_bf16 v[64:67], a[200:203], a[104:107], v[64:67]
    s_waitcnt lgkmcnt(2)
    v_cvt_pk_bf16_f32 v208, v208, v209
    v_fma_f32 v45, v45, s28, v17
    v_cvt_pk_bf16_f32 v212, v212, v213
    v_mfma_f32_16x16x32_bf16 v[64:67], a[204:207], a[108:111], v[64:67]
    ds_read_b128 a[220:223], v2 offset:18432
    v_cvt_pk_bf16_f32 v180, v180, v181
    v_mfma_f32_16x16x32_bf16 v[64:67], a[208:211], a[112:115], v[64:67]
    v_cvt_pk_bf16_f32 v144, v144, v145
    v_exp_f32 v132, v44
    v_mfma_f32_16x16x32_bf16 v[64:67], a[212:215], a[116:119], v[64:67]
    v_exp_f32 v134, v46
    v_fma_f32 v54, v54, s28, v18
    v_mfma_f32_16x16x32_bf16 v[72:75], a[192:195], a[120:123], 0
    v_cvt_pk_bf16_f32 v145, v146, v147
    v_cvt_pk_bf16_f32 v188, v188, v189
    v_mfma_f32_16x16x32_bf16 v[72:75], a[196:199], a[124:127], v[72:75]
    s_add_u32 s21, s21, 128
    v_cvt_pk_bf16_f32 v97, v130, v131
    v_exp_f32 v133, v45
    v_accvgpr_read_b32 v148, a4
    v_mfma_f32_16x16x32_bf16 v[72:75], a[200:203], a[128:131], v[72:75]
    ds_read_b128 a[228:231], v2 offset:19456
    v_fma_f32 v48, v48, s28, v18
    v_mfma_f32_16x16x32_bf16 v[72:75], a[204:207], a[132:135], v[72:75]
    v_accvgpr_read_b32 v146, a10
    v_accvgpr_read_b32 v147, a11
    v_fma_f32 v50, v50, s28, v18
    v_mfma_f32_16x16x32_bf16 v[72:75], a[208:211], a[136:139], v[72:75]
    v_exp_f32 v129, v39
    v_mfma_f32_16x16x32_bf16 v[72:75], a[212:215], a[140:143], v[72:75]
    v_xor_b32 v15, 64, v14
    v_fma_f32 v53, v53, s28, v18
    v_mfma_f32_16x16x32_bf16 v[80:83], a[192:195], a[144:147], 0
    s_add_u32 m0, s22, 37888
    ds_read_b128 a[216:219], v1 offset:18432
    v_cvt_pk_bf16_f32 v172, v172, v173
    v_fma_f32 v52, v52, s28, v18
    v_cvt_pk_bf16_f32 v252, v252, v253
    v_mfma_f32_16x16x32_bf16 v[80:83], a[196:199], a[148:151], v[80:83]
    v_exp_f32 v135, v47
    v_mfma_f32_16x16x32_bf16 v[80:83], a[200:203], a[152:155], v[80:83]
    buffer_load_dwordx4 v9, s[8:11], s21 offen lds
    v_cvt_pk_bf16_f32 v102, v132, v133
    v_mfma_f32_16x16x32_bf16 v[80:83], a[204:207], a[156:159], v[80:83]
    s_add_u32 s21, s21, 128
    v_fma_f32 v73, v73, s28, v17
    v_fma_f32 v55, v55, s28, v18
    v_fma_f32 v49, v49, s28, v18
    v_exp_f32 v133, v53
    v_cvt_pk_bf16_f32 v103, v134, v135
    v_pk_mul_f32 v[192:193], v[192:193], v[152:153] op_sel_hi:[1,0]
    v_pk_mul_f32 v[194:195], v[194:195], v[152:153] op_sel_hi:[1,0]
    v_pk_mul_f32 v[178:179], v[178:179], v[152:153] op_sel_hi:[1,0]
    v_exp_f32 v128, v38
    v_pk_mul_f32 v[250:251], v[250:251], v[154:155] op_sel_hi:[1,0]
    v_pk_mul_f32 v[146:147], v[146:147], v[156:157] op_sel_hi:[1,0]
    v_pk_mul_f32 v[148:149], v[148:149], v[156:157] op_sel_hi:[1,0]
    v_pk_mul_f32 v[160:161], v[160:161], v[152:153] op_sel_hi:[1,0]
    v_fma_f32 v64, v64, s28, v16
    v_pk_mul_f32 v[186:187], v[186:187], v[152:153] op_sel_hi:[1,0]
    v_fma_f32 v51, v51, s28, v18
    v_pk_mul_f32 v[196:197], v[196:197], v[152:153] op_sel_hi:[1,0]
    v_cvt_pk_bf16_f32 v99, v128, v129
    v_pk_mul_f32 v[168:169], v[168:169], v[152:153] op_sel_hi:[1,0]
    v_pk_mul_f32 v[226:227], v[226:227], v[154:155] op_sel_hi:[1,0]
    v_exp_f32 v132, v52
    v_pk_mul_f32 v[220:221], v[220:221], v[154:155] op_sel_hi:[1,0]
    v_pk_mul_f32 v[150:151], v[150:151], v[156:157] op_sel_hi:[1,0]
    v_pk_mul_f32 v[236:237], v[236:237], v[154:155] op_sel_hi:[1,0]
    v_pk_mul_f32 v[224:225], v[224:225], v[154:155] op_sel_hi:[1,0]
    v_cvt_pk_bf16_f32 v192, v192, v193
    v_fma_f32 v43, v43, s28, v17
    v_mfma_f32_16x16x32_bf16 v[80:83], a[208:211], a[160:163], v[80:83]
    ds_read_b128 a[236:239], v2 offset:20480
    v_exp_f32 v131, v43
    v_mfma_f32_16x16x32_bf16 v[80:83], a[212:215], a[164:167], v[80:83]
    s_waitcnt lgkmcnt(1)
    v_exp_f32 v135, v55
    v_mfma_f32_16x16x32_bf16 v[68:71], a[216:219], a[96:99], 0
    s_add_u32 m0, s22, 38912
    v_fma_f32 v72, v72, s28, v17
    v_exp_f32 v130, v42
    v_cvt_pk_bf16_f32 v160, v160, v161
    v_mfma_f32_16x16x32_bf16 v[68:71], a[220:223], a[100:103], v[68:71]
    buffer_load_dwordx4 v9, s[8:11], s21 offen lds
    v_cvt_pk_bf16_f32 v106, v132, v133
    v_fma_f32 v66, v66, s28, v16
    v_cvt_pk_bf16_f32 v209, v210, v211
    v_pk_mul_f32 v[218:219], v[218:219], v[154:155] op_sel_hi:[1,0]
    v_pk_mul_f32 v[170:171], v[170:171], v[152:153] op_sel_hi:[1,0]
    v_pk_mul_f32 v[216:217], v[216:217], v[154:155] op_sel_hi:[1,0]
    v_pk_mul_f32 v[166:167], v[166:167], v[152:153] op_sel_hi:[1,0]
    v_exp_f32 v129, v49
    v_exp_f32 v134, v54
    v_fma_f32 v65, v65, s28, v16
    v_cvt_pk_bf16_f32 v224, v224, v225
    v_cvt_pk_bf16_f32 v216, v216, v217
    v_cvt_pk_bf16_f32 v107, v134, v135
    v_fma_f32 v81, v81, s28, v18
    v_mfma_f32_16x16x32_bf16 v[68:71], a[224:227], a[104:107], v[68:71]
    s_add_u32 s21, s21, 12032
    v_cvt_pk_bf16_f32 v161, v162, v163
    v_cvt_pk_bf16_f32 v148, v148, v149
    v_mfma_f32_16x16x32_bf16 v[68:71], a[228:231], a[108:111], v[68:71]
    v_cvt_pk_bf16_f32 v236, v236, v237
    v_exp_f32 v128, v48
    v_mfma_f32_16x16x32_bf16 v[68:71], a[232:235], a[112:115], v[68:71]
    s_waitcnt vmcnt(6) lgkmcnt(0)
    ds_write2st64_b64 v14, v[160:161], v[208:209] offset0:0 offset1:12
    v_cvt_pk_bf16_f32 v220, v220, v221
    v_cvt_pk_bf16_f32 v101, v130, v131
    v_mfma_f32_16x16x32_bf16 v[68:71], a[236:239], a[116:119], v[68:71]
    s_barrier
    ds_read_b64_tr_b16 a[192:193], v3 offset:0
    v_mfma_f32_16x16x32_bf16 v[76:79], a[216:219], a[120:123], 0
    ds_read_b64_tr_b16 a[194:195], v3 offset:6144
    v_cvt_pk_bf16_f32 v149, v150, v151
    v_mfma_f32_16x16x32_bf16 v[76:79], a[220:223], a[124:127], v[76:79]
    ds_read_b64_tr_b16 a[196:197], v4 offset:0
    v_cvt_pk_bf16_f32 v164, v164, v165
    v_cvt_pk_bf16_f32 v221, v222, v223
    v_accvgpr_read_b32 v150, a14
    v_fma_f32 v69, v69, s28, v16
    v_mfma_f32_16x16x32_bf16 v[76:79], a[224:227], a[128:131], v[76:79]
    ds_write_b64 v14, v[144:145] offset:12288
    v_mfma_f32_16x16x32_bf16 v[76:79], a[228:231], a[132:135], v[76:79]
    ds_read_b64_tr_b16 a[198:199], v4 offset:6144
    v_cvt_pk_bf16_f32 v165, v166, v167
    v_mfma_f32_16x16x32_bf16 v[76:79], a[232:235], a[136:139], v[76:79]
    ds_read_b64_tr_b16 a[200:201], v5 offset:0
    v_fma_f32 v68, v68, s28, v16
    v_mfma_f32_16x16x32_bf16 v[76:79], a[236:239], a[140:143], v[76:79]
    s_add_u32 m0, s22, 12288
    ds_read_b64_tr_b16 a[202:203], v5 offset:6144
    v_exp_f32 v131, v51
    v_accvgpr_read_b32 v151, a15
    v_mfma_f32_16x16x32_bf16 v[84:87], a[216:219], a[144:147], 0
    ds_read_b64_tr_b16 a[204:205], v6 offset:0
    v_exp_f32 v130, v50
    v_mfma_f32_16x16x32_bf16 v[84:87], a[220:223], a[148:151], v[84:87]
    ds_read_b64_tr_b16 a[206:207], v6 offset:6144
    buffer_load_dwordx4 v9, s[4:7], s20 offen lds
    v_cvt_pk_bf16_f32 v168, v168, v169
    v_xor_b32 v0, 32, v14
    v_pk_mul_f32 v[232:233], v[232:233], v[154:155] op_sel_hi:[1,0]
    v_fma_f32 v74, v74, s28, v17
    v_accvgpr_read_b32 v145, a9
    v_pk_mul_f32 v[174:175], v[174:175], v[152:153] op_sel_hi:[1,0]
    v_accvgpr_read_b32 v144, a8
    v_exp_f32 v133, v73
    v_fma_f32 v75, v75, s28, v17
    v_pk_mul_f32 v[198:199], v[198:199], v[152:153] op_sel_hi:[1,0]
    v_pk_mul_f32 v[184:185], v[184:185], v[152:153] op_sel_hi:[1,0]
    v_pk_mul_f32 v[144:145], v[144:145], v[156:157] op_sel_hi:[1,0]
    v_fma_f32 v80, v80, s28, v18
    v_cvt_pk_bf16_f32 v169, v170, v171
    v_mfma_f32_16x16x32_bf16 v[84:87], a[224:227], a[152:155], v[84:87]
    s_add_u32 s20, s20, 128
    ds_read_b64_tr_b16 a[216:217], v5 offset:1024
    v_cvt_pk_bf16_f32 v104, v128, v129
    v_cvt_pk_bf16_f32 v144, v144, v145
    v_cvt_pk_bf16_f32 v213, v214, v215
    v_mfma_f32_16x16x32_bf16 v[84:87], a[228:231], a[156:159], v[84:87]
    s_add_u32 m0, s22, 13312
    ds_read_b64_tr_b16 a[208:209], v3 offset:1024
    v_cvt_pk_bf16_f32 v145, v146, v147
    v_fma_f32 v78, v78, s28, v17
    v_exp_f32 v135, v69
    v_pk_mul_f32 v[200:201], v[200:201], v[152:153] op_sel_hi:[1,0]
    v_cvt_pk_bf16_f32 v225, v226, v227
    v_fma_f32 v70, v70, s28, v16
    v_pk_mul_f32 v[230:231], v[230:231], v[154:155] op_sel_hi:[1,0]
    v_exp_f32 v134, v68
    v_pk_mul_f32 v[254:255], v[254:255], v[154:155] op_sel_hi:[1,0]
    v_cvt_pk_bf16_f32 v105, v130, v131
    v_pk_mul_f32 v[234:235], v[234:235], v[154:155] op_sel_hi:[1,0]
    v_cvt_pk_bf16_f32 v217, v218, v219
    v_exp_f32 v129, v65
    v_mfma_f32_16x16x32_bf16 v[84:87], a[232:235], a[160:163], v[84:87]
    ds_read_b64_tr_b16 a[224:225], v3 offset:2048
    buffer_load_dwordx4 v9, s[4:7], s20 offen lds
    v_mfma_f32_16x16x32_bf16 v[84:87], a[236:239], a[164:167], v[84:87]
    s_waitcnt lgkmcnt(3)
    ds_write2st64_b64 v0, v[164:165], v[212:213] offset0:0 offset1:12
    v_mfma_f32_16x16x32_bf16 v[160:163], a[192:195], v[96:99], 0
    s_add_u32 s20, s20, 128
    ds_write_b64 v0, v[148:149] offset:12288
    v_cvt_pk_bf16_f32 v176, v176, v177
    v_mfma_f32_16x16x32_bf16 v[208:211], a[192:195], v[100:103], 0
    ds_write2st64_b64 v15, v[168:169], v[216:217] offset0:0 offset1:12
    v_cvt_pk_bf16_f32 v177, v178, v179
    v_accvgpr_read_b32 v149, a13
    v_fma_f32 v82, v82, s28, v18
    v_pk_mul_f32 v[202:203], v[202:203], v[152:153] op_sel_hi:[1,0]
    v_pk_mul_f32 v[238:239], v[238:239], v[154:155] op_sel_hi:[1,0]
    v_exp_f32 v132, v72
    v_cvt_pk_bf16_f32 v184, v184, v185
    v_cvt_pk_bf16_f32 v173, v174, v175
    v_fma_f32 v83, v83, s28, v18
    v_fma_f32 v77, v77, s28, v17
    v_cvt_pk_bf16_f32 v229, v230, v231
    v_mfma_f32_16x16x32_bf16 a[0:3], a[192:195], v[104:107], 0
    ds_write_b64 v15, v[144:145] offset:12288
    v_mfma_f32_16x16x32_bf16 v[164:167], a[196:199], v[96:99], 0
    s_add_u32 m0, s22, 14336
    ds_read_b64_tr_b16 a[210:211], v3 offset:7168
    v_cvt_pk_bf16_f32 v116, v132, v133
    v_fma_f32 v71, v71, s28, v16
    v_mfma_f32_16x16x32_bf16 v[212:215], a[196:199], v[100:103], 0
    buffer_load_dwordx4 v9, s[4:7], s20 offen lds
    ds_read_b64_tr_b16 a[220:221], v6 offset:1024
    v_fma_f32 v87, v87, s28, v18
    v_accvgpr_read_b32 v146, a18
    v_cvt_pk_bf16_f32 v253, v254, v255
    v_mfma_f32_16x16x32_bf16 v[20:23], a[240:243], v[96:99], 0
    ds_write2st64_b64 v8, v[172:173], v[220:221] offset0:0 offset1:12
    v_fma_f32 v76, v76, s28, v17
    v_exp_f32 v128, v64
    v_mfma_f32_16x16x32_bf16 a[4:7], a[196:199], v[104:107], 0
    ds_read_b128 v[140:143], v13 offset:1024
    v_fma_f32 v67, v67, s28, v16
    v_exp_f32 v131, v67
    v_mfma_f32_16x16x32_bf16 v[168:171], a[200:203], v[96:99], 0
    ds_read_b128 v[136:139], v13 offset:0
    v_accvgpr_read_b32 v147, a19
    v_accvgpr_read_b32 v148, a12
    v_accvgpr_read_b32 v145, a17
    v_exp_f32 v130, v66
    v_pk_mul_f32 v[146:147], v[146:147], v[156:157] op_sel_hi:[1,0]
    v_accvgpr_read_b32 v144, a16
    v_pk_mul_f32 v[144:145], v[144:145], v[156:157] op_sel_hi:[1,0]
    v_pk_mul_f32 v[148:149], v[148:149], v[156:157] op_sel_hi:[1,0]
    v_pk_mul_f32 v[244:245], v[244:245], v[154:155] op_sel_hi:[1,0]
    v_pk_mul_f32 v[248:249], v[248:249], v[154:155] op_sel_hi:[1,0]
    v_cvt_pk_bf16_f32 v232, v232, v233
    v_cvt_pk_bf16_f32 v148, v148, v149
    v_pk_mul_f32 v[150:151], v[150:151], v[156:157] op_sel_hi:[1,0]
    v_cvt_pk_bf16_f32 v144, v144, v145
    v_pk_mul_f32 v[204:205], v[204:205], v[152:153] op_sel_hi:[1,0]
    v_cvt_pk_bf16_f32 v113, v130, v131
    v_cvt_pk_bf16_f32 v240, v240, v241
    v_cvt_pk_bf16_f32 v193, v194, v195
    v_cvt_pk_bf16_f32 v149, v150, v151
    v_cvt_pk_bf16_f32 v185, v186, v187
    v_cvt_pk_bf16_f32 v145, v146, v147
    v_pk_mul_f32 v[246:247], v[246:247], v[154:155] op_sel_hi:[1,0]
    v_accvgpr_read_b32 v151, a23
    v_cvt_pk_bf16_f32 v181, v182, v183
    v_mfma_f32_16x16x32_bf16 v[216:219], a[200:203], v[100:103], 0
    s_add_u32 s20, s20, 12032
    ds_write_b64 v8, v[148:149] offset:12288
    v_cvt_pk_bf16_f32 v196, v196, v197
    v_accvgpr_read_b32 v146, a26
    v_cvt_pk_bf16_f32 v189, v190, v191
    v_accvgpr_read_b32 v147, a27
    v_cvt_pk_bf16_f32 v244, v244, v245
    v_mfma_f32_16x16x32_bf16 a[8:11], a[200:203], v[104:107], 0
    s_add_u32 s56, s24, 4294967168
    ds_read_b64_tr_b16 a[218:219], v5 offset:7168
    ds_read_b64_tr_b16 a[212:213], v4 offset:1024
    v_mfma_f32_16x16x32_bf16 v[172:175], a[204:207], v[96:99], 0
    s_add_u32 s58, s25, 4294967168
    ds_write2st64_b64 v14, v[176:177], v[224:225] offset0:4 offset1:16
    v_cvt_pk_bf16_f32 v237, v238, v239
    v_mfma_f32_16x16x32_bf16 v[220:223], a[204:207], v[100:103], 0
    s_add_u32 m0, s38, 0
    ds_write_b64 v14, v[144:145] offset:14336
    v_accvgpr_read_b32 v150, a22
    v_mfma_f32_16x16x32_bf16 v[20:23], a[244:247], v[100:103], v[20:23]
    s_waitcnt lgkmcnt(5)
    ds_read_b64_tr_b16 a[234:235], v5 offset:8192
    buffer_load_dwordx4 v10, s[12:15], s58 offen nt lds
    ds_read_b64_tr_b16 a[214:215], v4 offset:7168
    v_mfma_f32_16x16x32_bf16 a[12:15], a[204:207], v[104:107], 0
    s_add_u32 m0, s38, 1024
    ds_read_b64_tr_b16 a[238:239], v6 offset:8192
    buffer_load_dwordx4 v11, s[12:15], s58 offen nt lds
    ds_read_b64_tr_b16 a[222:223], v6 offset:7168
    v_accvgpr_read_b32 v144, a24
    v_accvgpr_read_b32 v149, a21
    v_pk_mul_f32 v[146:147], v[146:147], v[156:157] op_sel_hi:[1,0]
    v_cvt_pk_bf16_f32 v233, v234, v235
    v_accvgpr_read_b32 v145, a25
    v_cvt_pk_bf16_f32 v204, v204, v205
    v_mfma_f32_16x16x32_bf16 v[176:179], a[208:211], v[96:99], 0
    buffer_store_dwordx4 v[136:139], v12, s[16:19], s56 offen offset:0 nt
    ds_write2st64_b64 v0, v[180:181], v[228:229] offset0:4 offset1:16
    v_exp_f32 v131, v75
    v_pk_mul_f32 v[144:145], v[144:145], v[156:157] op_sel_hi:[1,0]
    v_cvt_pk_bf16_f32 v200, v200, v201
    v_accvgpr_read_b32 v148, a20
    v_pk_mul_f32 v[148:149], v[148:149], v[156:157] op_sel_hi:[1,0]
    v_cvt_pk_bf16_f32 v144, v144, v145
    v_cvt_pk_bf16_f32 v145, v146, v147
    v_cvt_pk_bf16_f32 v114, v134, v135
    v_cvt_pk_bf16_f32 v112, v128, v129
    v_exp_f32 v129, v71
    v_pk_mul_f32 v[150:151], v[150:151], v[156:157] op_sel_hi:[1,0]
    v_exp_f32 v128, v70
    v_cvt_pk_bf16_f32 v148, v148, v149
    v_cvt_pk_bf16_f32 v149, v150, v151
    v_mfma_f32_16x16x32_bf16 v[224:227], a[208:211], v[100:103], 0
    ds_write_b64 v0, v[148:149] offset:14336
    v_fma_f32 v86, v86, s28, v18
    v_cvt_pk_bf16_f32 v115, v128, v129
    v_mfma_f32_16x16x32_bf16 a[16:19], a[208:211], v[104:107], 0
    s_waitcnt lgkmcnt(2)
    ds_read_b64_tr_b16 a[236:237], v6 offset:2048
    v_accvgpr_read_b32 v151, a31
    v_mfma_f32_16x16x32_bf16 v[180:183], a[212:215], v[96:99], 0
    ds_read_b128 v[136:139], v13 offset:6144
    v_accvgpr_read_b32 v147, a35
    v_mfma_f32_16x16x32_bf16 v[228:231], a[212:215], v[100:103], 0
    s_add_u32 s57, s24, 6016
    ds_write2st64_b64 v15, v[184:185], v[232:233] offset0:4 offset1:16
    v_mfma_f32_16x16x32_bf16 a[20:23], a[212:215], v[104:107], 0
    ds_write_b64 v15, v[144:145] offset:14336
    v_accvgpr_read_b32 v146, a34
    v_mfma_f32_16x16x32_bf16 v[20:23], a[248:251], v[104:107], v[20:23]
    buffer_store_dwordx4 v[140:143], v12, s[16:19], s56 offen offset:3072 nt
    s_add_u32 s59, s25, 6016
    ds_write2st64_b64 v8, v[188:189], v[236:237] offset0:4 offset1:16
    v_mfma_f32_16x16x32_bf16 v[184:187], a[216:219], v[96:99], 0
    s_add_u32 m0, s38, 6144
    ds_read_b128 v[140:143], v13 offset:7168
    v_accvgpr_read_b32 v148, a28
    v_accvgpr_read_b32 v144, a32
    v_cvt_pk_bf16_f32 v201, v202, v203
    v_accvgpr_read_b32 v149, a29
    v_exp_f32 v129, v81
    v_accvgpr_read_b32 v145, a33
    v_accvgpr_read_b32 v150, a30
    v_exp_f32 v132, v76
    v_pk_mul_f32 v[144:145], v[144:145], v[156:157] op_sel_hi:[1,0]
    v_pk_mul_f32 v[148:149], v[148:149], v[156:157] op_sel_hi:[1,0]
    v_cvt_pk_bf16_f32 v245, v246, v247
    v_fma_f32 v85, v85, s28, v18
    v_mfma_f32_16x16x32_bf16 v[232:235], a[216:219], v[100:103], 0
    s_waitcnt lgkmcnt(3)
    ds_read_b64_tr_b16 a[226:227], v3 offset:8192
    ds_read_b64_tr_b16 a[230:231], v4 offset:8192
    buffer_load_dwordx4 v10, s[12:15], s59 offen nt lds
    v_exp_f32 v130, v74
    v_cvt_pk_bf16_f32 v148, v148, v149
    v_pk_mul_f32 v[150:151], v[150:151], v[156:157] op_sel_hi:[1,0]
    v_pk_mul_f32 v[146:147], v[146:147], v[156:157] op_sel_hi:[1,0]
    v_cvt_pk_bf16_f32 v248, v248, v249
    v_exp_f32 v134, v78
    v_cvt_pk_bf16_f32 v149, v150, v151
    v_mfma_f32_16x16x32_bf16 a[24:27], a[216:219], v[104:107], 0
    buffer_store_dwordx4 v[136:139], v12, s[16:19], s57 offen offset:0 nt
    s_nop 0
    ds_read_b128 v[136:139], v13 offset:12288
    v_cvt_pk_bf16_f32 v144, v144, v145
    v_cvt_pk_bf16_f32 v241, v242, v243
    v_cvt_pk_bf16_f32 v249, v250, v251
    v_cvt_pk_bf16_f32 v205, v206, v207
    v_mfma_f32_16x16x32_bf16 v[188:191], a[220:223], v[96:99], 0
    ds_write_b64 v8, v[148:149] offset:14336
    v_mfma_f32_16x16x32_bf16 v[236:239], a[220:223], v[100:103], 0
    s_add_u32 m0, s38, 7168
    ds_write2st64_b64 v14, v[192:193], v[240:241] offset0:8 offset1:20
    v_accvgpr_read_b32 v148, a36
    v_mfma_f32_16x16x32_bf16 v[24:27], a[240:243], v[112:115], v[20:23]
    ds_read_b64_tr_b16 a[232:233], v5 offset:2048
    v_exp_f32 v133, v77
    v_mfma_f32_16x16x32_bf16 a[28:31], a[220:223], v[104:107], 0
    s_waitcnt lgkmcnt(4)
    ds_read_b64_tr_b16 a[228:229], v4 offset:2048
    buffer_load_dwordx4 v11, s[12:15], s59 offen nt lds
    v_accvgpr_read_b32 v149, a37
    v_cvt_pk_bf16_f32 v145, v146, v147
    v_fma_f32 v79, v79, s28, v17
    v_mfma_f32_16x16x32_bf16 v[192:195], a[224:227], v[96:99], 0
    s_add_u32 s56, s24, 12160
    ds_write_b64 v14, v[144:145] offset:16384
    v_mfma_f32_16x16x32_bf16 v[240:243], a[224:227], v[100:103], 0
    buffer_store_dwordx4 v[140:143], v12, s[16:19], s57 offen offset:3072 nt
    s_add_u32 s58, s25, 12160
    s_add_u32 m0, s38, 12288
    ds_read_b128 v[140:143], v13 offset:13312
    v_accvgpr_read_b32 v151, a39
    v_accvgpr_read_b32 v150, a38
    v_fma_f32 v84, v84, s28, v18
    v_accvgpr_read_b32 v145, a41
    v_pk_mul_f32 v[150:151], v[150:151], v[156:157] op_sel_hi:[1,0]
    v_cvt_pk_bf16_f32 v197, v198, v199
    v_accvgpr_read_b32 v146, a42
    v_pk_mul_f32 v[148:149], v[148:149], v[156:157] op_sel_hi:[1,0]
    v_accvgpr_read_b32 v147, a43
    v_pk_mul_f32 v[146:147], v[146:147], v[156:157] op_sel_hi:[1,0]
    v_cvt_pk_bf16_f32 v117, v130, v131
    v_accvgpr_read_b32 v144, a40
    v_cvt_pk_bf16_f32 v148, v148, v149
    v_exp_f32 v135, v79
    v_pk_mul_f32 v[144:145], v[144:145], v[156:157] op_sel_hi:[1,0]
    v_exp_f32 v131, v83
    v_cvt_pk_bf16_f32 v149, v150, v151
    v_cvt_pk_bf16_f32 v144, v144, v145
    v_mfma_f32_16x16x32_bf16 a[32:35], a[224:227], v[104:107], 0
    s_waitcnt lgkmcnt(2)
    ds_write2st64_b64 v0, v[196:197], v[244:245] offset0:8 offset1:20
    v_mfma_f32_16x16x32_bf16 v[196:199], a[228:231], v[96:99], 0
    buffer_load_dwordx4 v10, s[12:15], s58 offen nt lds
    ds_write_b64 v0, v[148:149] offset:16384
    v_cvt_pk_bf16_f32 v145, v146, v147
    v_mfma_f32_16x16x32_bf16 v[244:247], a[228:231], v[100:103], 0
    s_add_u32 m0, s38, 13312
    ds_write2st64_b64 v15, v[200:201], v[248:249] offset0:8 offset1:20
    v_mfma_f32_16x16x32_bf16 a[36:39], a[228:231], v[104:107], 0
    s_waitcnt lgkmcnt(3)
    buffer_load_dwordx4 v11, s[12:15], s58 offen nt lds
    ds_write_b64 v15, v[144:145] offset:16384
    v_mfma_f32_16x16x32_bf16 v[200:203], a[232:235], v[96:99], 0
    s_waitcnt vmcnt(16)
    ds_write2st64_b64 v8, v[204:205], v[252:253] offset0:8 offset1:20
    v_mfma_f32_16x16x32_bf16 v[248:251], a[232:235], v[100:103], 0
    s_barrier
    ds_read_b128 a[192:195], v1 offset:0
    v_mfma_f32_16x16x32_bf16 a[40:43], a[232:235], v[104:107], 0
    ds_read_b128 a[196:199], v2 offset:0
    v_accvgpr_read_b32 v151, a47
    v_cvt_pk_bf16_f32 v118, v132, v133
    v_mfma_f32_16x16x32_bf16 v[204:207], a[236:239], v[96:99], 0
    ds_read_b128 a[200:203], v1 offset:1024
    v_cvt_pk_bf16_f32 v119, v134, v135
    v_accvgpr_read_b32 v150, a46
    v_accvgpr_read_b32 v148, a44
    v_mfma_f32_16x16x32_bf16 v[24:27], a[244:247], v[116:119], v[24:27]
    s_add_u32 m0, s22, 24576
    ds_read_b128 a[204:207], v2 offset:1024
    buffer_load_dwordx4 v9, s[8:11], s21 offen lds
    v_mfma_f32_16x16x32_bf16 v[252:255], a[236:239], v[100:103], 0
    s_add_u32 s21, s21, 128
    ds_read_b128 a[208:211], v1 offset:2048
    v_accvgpr_read_b32 v149, a45
    v_mfma_f32_16x16x32_bf16 a[44:47], a[236:239], v[104:107], 0
    buffer_store_dwordx4 v[136:139], v12, s[16:19], s56 offen offset:0 nt
    ds_read_b128 a[212:215], v2 offset:2048
    v_exp_f32 v133, v85
    v_exp_f32 v130, v82
    v_exp_f32 v128, v80
    v_pk_mul_f32 v[150:151], v[150:151], v[156:157] op_sel_hi:[1,0]
    v_cvt_pk_bf16_f32 v120, v128, v129
    v_pk_mul_f32 v[148:149], v[148:149], v[156:157] op_sel_hi:[1,0]
    v_exp_f32 v132, v84
    v_exp_f32 v134, v86
    s_waitcnt lgkmcnt(4)
    v_mfma_f32_16x16x32_bf16 v[32:35], a[192:195], a[96:99], 0
    s_add_u32 m0, s22, 25600
    v_exp_f32 v135, v87
    v_cvt_pk_bf16_f32 v122, v132, v133
    v_mfma_f32_16x16x32_bf16 v[32:35], a[196:199], a[100:103], v[32:35]
    s_waitcnt lgkmcnt(3)
    v_cvt_pk_bf16_f32 v121, v130, v131
    v_cvt_pk_bf16_f32 v123, v134, v135
    v_mfma_f32_16x16x32_bf16 v[32:35], a[200:203], a[104:107], v[32:35]
    buffer_load_dwordx4 v9, s[8:11], s21 offen lds
    v_mfma_f32_16x16x32_bf16 v[24:27], a[248:251], v[120:123], v[24:27]
    s_waitcnt lgkmcnt(2)
    ds_read_b128 a[224:227], v1 offset:7168
    v_mfma_f32_16x16x32_bf16 v[32:35], a[204:207], a[108:111], v[32:35]
    s_add_u32 s21, s21, 128
    ds_read_b128 a[216:219], v1 offset:6144
    s_waitcnt lgkmcnt(3)
    v_mfma_f32_16x16x32_bf16 v[32:35], a[208:211], a[112:115], v[32:35]
    ds_read_b128 a[236:239], v2 offset:8192
    s_waitcnt lgkmcnt(3)
    v_mfma_f32_16x16x32_bf16 v[32:35], a[212:215], a[116:119], v[32:35]
    s_add_u32 m0, s22, 26624
    ds_read_b128 a[232:235], v1 offset:8192
    v_cmp_lt_f32 vcc, s29, v24
    v_mfma_f32_16x16x32_bf16 v[40:43], a[192:195], a[120:123], 0
    ds_read_b128 a[220:223], v2 offset:6144
    v_cvt_pk_bf16_f32 v148, v148, v149
    v_mfma_f32_16x16x32_bf16 v[40:43], a[196:199], a[124:127], v[40:43]
    buffer_load_dwordx4 v9, s[8:11], s21 offen lds
    v_mfma_f32_16x16x32_bf16 v[40:43], a[200:203], a[128:131], v[40:43]
    s_add_u32 s21, s21, 12032
    v_add_u32 v13, 2048, v13
    v_cvt_pk_bf16_f32 v149, v150, v151
    v_mfma_f32_16x16x32_bf16 v[40:43], a[204:207], a[132:135], v[40:43]
    s_cbranch_vccnz L_rs_tr33d
L_ret_tr33d:
    ds_read_b128 a[228:231], v2 offset:7168
    v_mfma_f32_16x16x32_bf16 v[40:43], a[208:211], a[136:139], v[40:43]
    s_add_u32 s58, s25, 18304
    v_fma_f32 v35, v35, s28, v16
    s_add_u32 m0, s38, 18432
    v_mfma_f32_16x16x32_bf16 v[40:43], a[212:215], a[140:143], v[40:43]
    v_exp_f32 v131, v35
    v_mfma_f32_16x16x32_bf16 v[48:51], a[192:195], a[144:147], 0
    buffer_load_dwordx4 v10, s[12:15], s58 offen nt lds
    v_mfma_f32_16x16x32_bf16 v[48:51], a[196:199], a[148:151], v[48:51]
    buffer_store_dwordx4 v[140:143], v12, s[16:19], s56 offen offset:3072 nt
    ds_write_b64 v8, v[148:149] offset:16384
    v_mfma_f32_16x16x32_bf16 v[48:51], a[200:203], a[152:155], v[48:51]
    s_add_u32 m0, s38, 19456
    v_fma_f32 v40, v40, s28, v17
    v_mfma_f32_16x16x32_bf16 v[48:51], a[204:207], a[156:159], v[48:51]
    v_fma_f32 v34, v34, s28, v16
    v_fma_f32 v32, v32, s28, v16
    v_mfma_f32_16x16x32_bf16 v[48:51], a[208:211], a[160:163], v[48:51]
    buffer_load_dwordx4 v11, s[12:15], s58 offen nt lds
    v_mfma_f32_16x16x32_bf16 v[48:51], a[212:215], a[164:167], v[48:51]
    s_waitcnt lgkmcnt(2)
    v_exp_f32 v130, v34
    v_mfma_f32_16x16x32_bf16 v[36:39], a[216:219], a[96:99], 0
    s_waitcnt vmcnt(20) lgkmcnt(1)
    v_exp_f32 v132, v40
    v_mfma_f32_16x16x32_bf16 v[36:39], a[220:223], a[100:103], v[36:39]
    s_barrier
    v_mfma_f32_16x16x32_bf16 v[36:39], a[224:227], a[104:107], v[36:39]
    v_fma_f32 v41, v41, s28, v17
    v_mfma_f32_16x16x32_bf16 v[36:39], a[228:231], a[108:111], v[36:39]
    s_add_u32 m0, s22, 0
    v_exp_f32 v128, v32
    v_mfma_f32_16x16x32_bf16 v[36:39], a[232:235], a[112:115], v[36:39]
    ds_read_b64_tr_b16 a[192:193], v3 offset:12288
    v_fma_f32 v33, v33, s28, v16
    v_mfma_f32_16x16x32_bf16 v[36:39], a[236:239], a[116:119], v[36:39]
    v_exp_f32 v129, v33
    v_mfma_f32_16x16x32_bf16 v[44:47], a[216:219], a[120:123], 0
    v_exp_f32 v133, v41
    v_mfma_f32_16x16x32_bf16 v[44:47], a[220:223], a[124:127], v[44:47]
    ds_read_b64_tr_b16 a[194:195], v3 offset:18432
    v_cvt_pk_bf16_f32 v97, v130, v131
    v_mfma_f32_16x16x32_bf16 v[44:47], a[224:227], a[128:131], v[44:47]
    ds_read_b64_tr_b16 a[196:197], v4 offset:12288
    v_mfma_f32_16x16x32_bf16 v[44:47], a[228:231], a[132:135], v[44:47]
    buffer_load_dwordx4 v9, s[4:7], s20 offen lds
    ds_read_b64_tr_b16 a[198:199], v4 offset:18432
    v_mfma_f32_16x16x32_bf16 v[44:47], a[232:235], a[136:139], v[44:47]
    ds_read_b64_tr_b16 a[200:201], v5 offset:12288
    s_add_u32 s20, s20, 128
    v_mfma_f32_16x16x32_bf16 v[44:47], a[236:239], a[140:143], v[44:47]
    s_add_u32 m0, s22, 1024
    ds_read_b64_tr_b16 a[202:203], v5 offset:18432
    v_cvt_pk_bf16_f32 v100, v132, v133
    v_mfma_f32_16x16x32_bf16 v[52:55], a[216:219], a[144:147], 0
    buffer_load_dwordx4 v9, s[4:7], s20 offen lds
    ds_read_b64_tr_b16 a[204:205], v6 offset:12288
    v_mfma_f32_16x16x32_bf16 v[52:55], a[220:223], a[148:151], v[52:55]
    ds_read_b64_tr_b16 a[206:207], v6 offset:18432
    v_cvt_pk_bf16_f32 v96, v128, v129
    v_mfma_f32_16x16x32_bf16 v[52:55], a[224:227], a[152:155], v[52:55]
    s_add_u32 s20, s20, 128
    s_add_u32 m0, s22, 2048
    ds_read_b64_tr_b16 a[208:209], v3 offset:13312
    v_mfma_f32_16x16x32_bf16 v[52:55], a[228:231], a[156:159], v[52:55]
    ds_read_b64_tr_b16 a[210:211], v3 offset:19456
    buffer_load_dwordx4 v9, s[4:7], s20 offen lds
    v_mfma_f32_16x16x32_bf16 v[52:55], a[232:235], a[160:163], v[52:55]
    ds_read_b64_tr_b16 a[212:213], v4 offset:13312
    v_mfma_f32_16x16x32_bf16 v[52:55], a[236:239], a[164:167], v[52:55]
    s_add_u32 s20, s20, 12032
    ds_read_b64_tr_b16 a[214:215], v4 offset:19456
    s_branch L_loop3
L_end4:
    s_waitcnt lgkmcnt(10)
    v_mfma_f32_16x16x32_bf16 v[160:163], a[192:195], v[112:115], v[160:163]
    ds_read_b128 v[136:139], v13 offset:0
    v_fma_f32 v47, v47, s28, v17
    v_mfma_f32_16x16x32_bf16 v[208:211], a[192:195], v[116:119], v[208:211]
    ds_read_b64_tr_b16 a[228:229], v4 offset:14336
    v_fma_f32 v46, v46, s28, v17
    v_fma_f32 v37, v37, s28, v16
    v_mfma_f32_16x16x32_bf16 a[0:3], a[192:195], v[120:123], a[0:3]
    ds_read_b64_tr_b16 a[218:219], v5 offset:19456
    v_fma_f32 v43, v43, s28, v17
    v_mfma_f32_16x16x32_bf16 a[48:51], a[192:195], v[124:127], a[48:51]
    ds_read_b64_tr_b16 a[238:239], v6 offset:20480
    s_waitcnt lgkmcnt(12)
    v_mfma_f32_16x16x32_bf16 v[164:167], a[196:199], v[112:115], v[164:167]
    ds_read_b64_tr_b16 a[226:227], v3 offset:20480
    v_fma_f32 v50, v50, s28, v18
    v_mfma_f32_16x16x32_bf16 v[212:215], a[196:199], v[116:119], v[212:215]
    v_fma_f32 v36, v36, s28, v16
    v_fma_f32 v39, v39, s28, v16
    v_mfma_f32_16x16x32_bf16 a[4:7], a[196:199], v[120:123], a[4:7]
    v_exp_f32 v135, v37
    v_mfma_f32_16x16x32_bf16 a[52:55], a[196:199], v[124:127], a[52:55]
    s_waitcnt lgkmcnt(11)
    v_exp_f32 v134, v36
    v_mfma_f32_16x16x32_bf16 v[168:171], a[200:203], v[112:115], v[168:171]
    ds_read_b64_tr_b16 a[232:233], v5 offset:14336
    v_fma_f32 v57, v57, s28, v19
    v_mfma_f32_16x16x32_bf16 v[216:219], a[200:203], v[116:119], v[216:219]
    ds_read_b64_tr_b16 a[234:235], v5 offset:20480
    v_fma_f32 v53, v53, s28, v18
    v_mfma_f32_16x16x32_bf16 a[8:11], a[200:203], v[120:123], a[8:11]
    ds_read_b64_tr_b16 a[236:237], v6 offset:14336
    v_fma_f32 v48, v48, s28, v18
    v_mfma_f32_16x16x32_bf16 a[56:59], a[200:203], v[124:127], a[56:59]
    s_waitcnt lgkmcnt(6)
    ds_read_b64_tr_b16 a[230:231], v4 offset:20480
    v_fma_f32 v42, v42, s28, v17
    v_mfma_f32_16x16x32_bf16 v[172:175], a[204:207], v[112:115], v[172:175]
    ds_read_b64_tr_b16 a[224:225], v3 offset:14336
    v_fma_f32 v38, v38, s28, v16
    v_mfma_f32_16x16x32_bf16 v[220:223], a[204:207], v[116:119], v[220:223]
    ds_read_b64_tr_b16 a[216:217], v5 offset:13312
    v_fma_f32 v44, v44, s28, v17
    v_mfma_f32_16x16x32_bf16 a[12:15], a[204:207], v[120:123], a[12:15]
    v_exp_f32 v130, v42
    v_mfma_f32_16x16x32_bf16 a[60:63], a[204:207], v[124:127], a[60:63]
    ds_read_b64_tr_b16 a[220:221], v6 offset:13312
    v_fma_f32 v45, v45, s28, v17
    v_mfma_f32_16x16x32_bf16 v[176:179], a[208:211], v[112:115], v[176:179]
    ds_read_b64_tr_b16 a[222:223], v6 offset:19456
    v_mfma_f32_16x16x32_bf16 v[224:227], a[208:211], v[116:119], v[224:227]
    buffer_store_dwordx4 v[136:139], v12, s[16:19], s24 offen offset:0 nt
    v_exp_f32 v129, v39
    v_cvt_pk_bf16_f32 v98, v134, v135
    v_mfma_f32_16x16x32_bf16 a[16:19], a[208:211], v[120:123], a[16:19]
    v_exp_f32 v128, v38
    v_mfma_f32_16x16x32_bf16 a[64:67], a[208:211], v[124:127], a[64:67]
    v_exp_f32 v132, v44
    v_mfma_f32_16x16x32_bf16 v[180:183], a[212:215], v[112:115], v[180:183]
    v_exp_f32 v135, v47
    v_mfma_f32_16x16x32_bf16 v[228:231], a[212:215], v[116:119], v[228:231]
    v_exp_f32 v131, v43
    v_mfma_f32_16x16x32_bf16 a[20:23], a[212:215], v[120:123], a[20:23]
    ds_read_b128 v[140:143], v13 offset:1024
    v_cvt_pk_bf16_f32 v99, v128, v129
    v_mfma_f32_16x16x32_bf16 a[68:71], a[212:215], v[124:127], a[68:71]
    s_waitcnt lgkmcnt(3)
    v_exp_f32 v134, v46
    v_mfma_f32_16x16x32_bf16 v[184:187], a[216:219], v[112:115], v[184:187]
    v_exp_f32 v133, v45
    v_mfma_f32_16x16x32_bf16 v[232:235], a[216:219], v[116:119], v[232:235]
    v_fma_f32 v49, v49, s28, v18
    v_cvt_pk_bf16_f32 v103, v134, v135
    v_mfma_f32_16x16x32_bf16 v[20:23], a[240:243], v[96:99], v[24:27]
    s_waitcnt vmcnt(11) lgkmcnt(1)
    v_cvt_pk_bf16_f32 v102, v132, v133
    v_cvt_pk_bf16_f32 v101, v130, v131
    v_mfma_f32_16x16x32_bf16 a[24:27], a[216:219], v[120:123], a[24:27]
    v_exp_f32 v133, v53
    v_mfma_f32_16x16x32_bf16 v[20:23], a[244:247], v[100:103], v[20:23]
    s_barrier
    v_mfma_f32_16x16x32_bf16 a[72:75], a[216:219], v[124:127], a[72:75]
    ds_read_b128 a[208:211], v1 offset:14336
    v_fma_f32 v54, v54, s28, v18
    v_mfma_f32_16x16x32_bf16 v[188:191], a[220:223], v[112:115], v[188:191]
    v_fma_f32 v62, v62, s28, v19
    v_mfma_f32_16x16x32_bf16 v[236:239], a[220:223], v[116:119], v[236:239]
    ds_read_b128 a[192:195], v1 offset:12288
    v_mfma_f32_16x16x32_bf16 a[28:31], a[220:223], v[120:123], a[28:31]
    s_add_u32 m0, s22, 36864
    ds_read_b128 v[136:139], v13 offset:2048
    v_fma_f32 v55, v55, s28, v18
    v_mfma_f32_16x16x32_bf16 a[76:79], a[220:223], v[124:127], a[76:79]
    buffer_load_dwordx4 v9, s[8:11], s21 offen lds
    v_mfma_f32_16x16x32_bf16 v[192:195], a[224:227], v[112:115], v[192:195]
    s_add_u32 s21, s21, 128
    ds_read_b128 a[212:215], v2 offset:14336
    v_fma_f32 v52, v52, s28, v18
    v_mfma_f32_16x16x32_bf16 v[240:243], a[224:227], v[116:119], v[240:243]
    s_add_u32 m0, s22, 37888
    ds_read_b128 a[204:207], v2 offset:13312
    v_fma_f32 v51, v51, s28, v18
    v_mfma_f32_16x16x32_bf16 a[32:35], a[224:227], v[120:123], a[32:35]
    v_exp_f32 v129, v49
    v_mfma_f32_16x16x32_bf16 a[80:83], a[224:227], v[124:127], a[80:83]
    ds_read_b128 a[196:199], v2 offset:12288
    v_fma_f32 v56, v56, s28, v19
    v_mfma_f32_16x16x32_bf16 v[196:199], a[228:231], v[112:115], v[196:199]
    ds_read_b128 a[200:203], v1 offset:13312
    v_fma_f32 v63, v63, s28, v19
    v_mfma_f32_16x16x32_bf16 v[244:247], a[228:231], v[116:119], v[244:247]
    buffer_load_dwordx4 v9, s[8:11], s21 offen lds
    v_mfma_f32_16x16x32_bf16 a[36:39], a[228:231], v[120:123], a[36:39]
    v_fma_f32 v58, v58, s28, v19
    v_mfma_f32_16x16x32_bf16 a[84:87], a[228:231], v[124:127], a[84:87]
    s_add_u32 s21, s21, 128
    ds_read_b128 a[216:219], v1 offset:18432
    v_fma_f32 v60, v60, s28, v19
    v_mfma_f32_16x16x32_bf16 v[200:203], a[232:235], v[112:115], v[200:203]
    v_exp_f32 v135, v55
    v_mfma_f32_16x16x32_bf16 v[248:251], a[232:235], v[116:119], v[248:251]
    s_add_u32 m0, s22, 38912
    v_mfma_f32_16x16x32_bf16 a[40:43], a[232:235], v[120:123], a[40:43]
    buffer_load_dwordx4 v9, s[8:11], s21 offen lds
    v_mfma_f32_16x16x32_bf16 a[88:91], a[232:235], v[124:127], a[88:91]
    v_exp_f32 v128, v48
    v_mfma_f32_16x16x32_bf16 v[204:207], a[236:239], v[112:115], v[204:207]
    v_exp_f32 v134, v54
    v_mfma_f32_16x16x32_bf16 v[252:255], a[236:239], v[116:119], v[252:255]
    v_exp_f32 v130, v50
    v_mfma_f32_16x16x32_bf16 a[44:47], a[236:239], v[120:123], a[44:47]
    v_cvt_pk_bf16_f32 v104, v128, v129
    v_mfma_f32_16x16x32_bf16 a[92:95], a[236:239], v[124:127], a[92:95]
    s_waitcnt lgkmcnt(1)
    v_exp_f32 v128, v56
    v_mfma_f32_16x16x32_bf16 v[64:67], a[192:195], a[96:99], 0
    ds_read_b128 a[220:223], v2 offset:18432
    v_fma_f32 v61, v61, s28, v19
    v_mfma_f32_16x16x32_bf16 v[64:67], a[196:199], a[100:103], v[64:67]
    ds_read_b128 a[236:239], v2 offset:20480
    v_cvt_pk_bf16_f32 v107, v134, v135
    v_mfma_f32_16x16x32_bf16 v[64:67], a[200:203], a[104:107], v[64:67]
    v_exp_f32 v132, v52
    v_mfma_f32_16x16x32_bf16 v[64:67], a[204:207], a[108:111], v[64:67]
    v_fma_f32 v59, v59, s28, v19
    v_mfma_f32_16x16x32_bf16 v[64:67], a[208:211], a[112:115], v[64:67]
    v_mfma_f32_16x16x32_bf16 v[64:67], a[212:215], a[116:119], v[64:67]
    v_exp_f32 v131, v51
    v_mfma_f32_16x16x32_bf16 v[72:75], a[192:195], a[120:123], 0
    buffer_store_dwordx4 v[140:143], v12, s[16:19], s24 offen offset:3072 nt
    ds_read_b128 a[228:231], v2 offset:19456
    v_mfma_f32_16x16x32_bf16 v[72:75], a[196:199], a[124:127], v[72:75]
    v_exp_f32 v129, v57
    v_mfma_f32_16x16x32_bf16 v[72:75], a[200:203], a[128:131], v[72:75]
    s_add_u32 s21, s21, 12032
    ds_read_b128 v[140:143], v13 offset:3072
    v_mfma_f32_16x16x32_bf16 v[72:75], a[204:207], a[132:135], v[72:75]
    ds_read_b128 a[232:235], v1 offset:20480
    v_cvt_pk_bf16_f32 v105, v130, v131
    v_mfma_f32_16x16x32_bf16 v[72:75], a[208:211], a[136:139], v[72:75]
    v_exp_f32 v135, v63
    v_mfma_f32_16x16x32_bf16 v[72:75], a[212:215], a[140:143], v[72:75]
    ds_read_b128 a[224:227], v1 offset:19456
    v_mfma_f32_16x16x32_bf16 v[80:83], a[192:195], a[144:147], 0
    v_exp_f32 v130, v58
    v_mfma_f32_16x16x32_bf16 v[80:83], a[196:199], a[148:151], v[80:83]
    v_exp_f32 v131, v59
    v_mfma_f32_16x16x32_bf16 v[80:83], a[200:203], a[152:155], v[80:83]
    v_cvt_pk_bf16_f32 v106, v132, v133
    v_mfma_f32_16x16x32_bf16 v[80:83], a[204:207], a[156:159], v[80:83]
    v_exp_f32 v134, v62
    v_mfma_f32_16x16x32_bf16 v[80:83], a[208:211], a[160:163], v[80:83]
    v_exp_f32 v133, v61
    v_mfma_f32_16x16x32_bf16 v[80:83], a[212:215], a[164:167], v[80:83]
    v_cvt_pk_bf16_f32 v108, v128, v129
    v_mfma_f32_16x16x32_bf16 v[88:91], a[192:195], a[168:171], 0
    v_cvt_pk_bf16_f32 v109, v130, v131
    v_mfma_f32_16x16x32_bf16 v[20:23], a[248:251], v[104:107], v[20:23]
    v_mfma_f32_16x16x32_bf16 v[88:91], a[196:199], a[172:175], v[88:91]
    v_exp_f32 v132, v60
    v_mfma_f32_16x16x32_bf16 v[88:91], a[200:203], a[176:179], v[88:91]
    s_add_u32 s57, s24, 128
    v_cvt_pk_bf16_f32 v110, v132, v133
    v_cvt_pk_bf16_f32 v111, v134, v135
    v_mfma_f32_16x16x32_bf16 v[88:91], a[204:207], a[180:183], v[88:91]
    v_mfma_f32_16x16x32_bf16 v[88:91], a[208:211], a[184:187], v[88:91]
    s_waitcnt vmcnt(8) lgkmcnt(0)
    v_mfma_f32_16x16x32_bf16 v[20:23], a[252:255], v[108:111], v[20:23]
    s_barrier
    v_mfma_f32_16x16x32_bf16 v[88:91], a[212:215], a[188:191], v[88:91]
    ds_read_b64_tr_b16 a[192:193], v3 offset:0
    v_mfma_f32_16x16x32_bf16 v[68:71], a[216:219], a[96:99], 0
    ds_read_b64_tr_b16 a[194:195], v3 offset:6144
    v_mfma_f32_16x16x32_bf16 v[68:71], a[220:223], a[100:103], v[68:71]
    s_nop 1
    v_cmp_lt_f32 vcc, s29, v20
    v_mfma_f32_16x16x32_bf16 v[68:71], a[224:227], a[104:107], v[68:71]
    ds_read_b64_tr_b16 a[196:197], v4 offset:0
    v_mfma_f32_16x16x32_bf16 v[68:71], a[228:231], a[108:111], v[68:71]
    v_mfma_f32_16x16x32_bf16 v[68:71], a[232:235], a[112:115], v[68:71]
    s_nop 0
    s_cbranch_vccnz L_rs_end4a
L_ret_end4a:
    v_mfma_f32_16x16x32_bf16 v[68:71], a[236:239], a[116:119], v[68:71]
    v_fma_f32 v65, v65, s28, v16
    v_fma_f32 v67, v67, s28, v16
    v_mfma_f32_16x16x32_bf16 v[76:79], a[216:219], a[120:123], 0
    ds_read_b64_tr_b16 a[198:199], v4 offset:6144
    v_fma_f32 v64, v64, s28, v16
    v_mfma_f32_16x16x32_bf16 v[76:79], a[220:223], a[124:127], v[76:79]
    v_fma_f32 v72, v72, s28, v17
    v_fma_f32 v73, v73, s28, v17
    v_mfma_f32_16x16x32_bf16 v[76:79], a[224:227], a[128:131], v[76:79]
    v_fma_f32 v66, v66, s28, v16
    v_mfma_f32_16x16x32_bf16 v[76:79], a[228:231], a[132:135], v[76:79]
    v_exp_f32 v132, v72
    v_mfma_f32_16x16x32_bf16 v[76:79], a[232:235], a[136:139], v[76:79]
    ds_read_b64_tr_b16 a[200:201], v5 offset:0
    v_mfma_f32_16x16x32_bf16 v[76:79], a[236:239], a[140:143], v[76:79]
    ds_read_b64_tr_b16 a[202:203], v5 offset:6144
    v_mfma_f32_16x16x32_bf16 v[84:87], a[216:219], a[144:147], 0
    v_exp_f32 v131, v67
    v_mfma_f32_16x16x32_bf16 v[84:87], a[220:223], a[148:151], v[84:87]
    v_mfma_f32_16x16x32_bf16 v[84:87], a[224:227], a[152:155], v[84:87]
    v_exp_f32 v130, v66
    v_mfma_f32_16x16x32_bf16 v[84:87], a[228:231], a[156:159], v[84:87]
    buffer_store_dwordx4 v[136:139], v12, s[16:19], s57 offen offset:0 nt
    ds_read_b64_tr_b16 a[204:205], v6 offset:0
    v_exp_f32 v129, v65
    v_mfma_f32_16x16x32_bf16 v[84:87], a[232:235], a[160:163], v[84:87]
    v_exp_f32 v128, v64
    v_mfma_f32_16x16x32_bf16 v[84:87], a[236:239], a[164:167], v[84:87]
    ds_read_b64_tr_b16 a[206:207], v6 offset:6144
    v_mfma_f32_16x16x32_bf16 v[92:95], a[216:219], a[168:171], 0
    buffer_store_dwordx4 v[140:143], v12, s[16:19], s57 offen offset:3072 nt
    ds_read_b64_tr_b16 a[208:209], v3 offset:1024
    v_exp_f32 v133, v73
    v_mfma_f32_16x16x32_bf16 v[92:95], a[220:223], a[172:175], v[92:95]
    ds_read_b64_tr_b16 a[210:211], v3 offset:7168
    v_cvt_pk_bf16_f32 v113, v130, v131
    v_mfma_f32_16x16x32_bf16 v[92:95], a[224:227], a[176:179], v[92:95]
    v_mfma_f32_16x16x32_bf16 v[92:95], a[228:231], a[180:183], v[92:95]
    v_cvt_pk_bf16_f32 v116, v132, v133
    v_mfma_f32_16x16x32_bf16 v[92:95], a[232:235], a[184:187], v[92:95]
    ds_read_b64_tr_b16 a[212:213], v4 offset:1024
    v_cvt_pk_bf16_f32 v112, v128, v129
    v_mfma_f32_16x16x32_bf16 v[92:95], a[236:239], a[188:191], v[92:95]
    ds_read_b64_tr_b16 a[214:215], v4 offset:7168
    s_waitcnt lgkmcnt(10)
    v_mfma_f32_16x16x32_bf16 v[160:163], a[192:195], v[96:99], v[160:163]
    v_fma_f32 v76, v76, s28, v17
    s_nop 3
    v_fma_f32 v92, v92, s28, v19
    v_fma_f32 v68, v68, s28, v16
    v_fma_f32 v83, v83, s28, v18
    v_mfma_f32_16x16x32_bf16 v[208:211], a[192:195], v[100:103], v[208:211]
    ds_read_b64_tr_b16 a[216:217], v5 offset:1024
    v_fma_f32 v87, v87, s28, v18
    v_mfma_f32_16x16x32_bf16 a[0:3], a[192:195], v[104:107], a[0:3]
    v_fma_f32 v90, v90, s28, v19
    v_fma_f32 v86, v86, s28, v18
    v_mfma_f32_16x16x32_bf16 a[48:51], a[192:195], v[108:111], a[48:51]
    s_waitcnt lgkmcnt(9)
    v_fma_f32 v71, v71, s28, v16
    v_exp_f32 v132, v76
    v_fma_f32 v77, v77, s28, v17
    v_mfma_f32_16x16x32_bf16 v[164:167], a[196:199], v[96:99], v[164:167]
    s_waitcnt vmcnt(3)
    ds_read_b64_tr_b16 a[232:233], v5 offset:2048
    v_fma_f32 v85, v85, s28, v18
    v_mfma_f32_16x16x32_bf16 v[212:215], a[196:199], v[100:103], v[212:215]
    v_exp_f32 v133, v77
    v_mfma_f32_16x16x32_bf16 a[4:7], a[196:199], v[104:107], a[4:7]
    v_fma_f32 v88, v88, s28, v19
    v_fma_f32 v70, v70, s28, v16
    v_mfma_f32_16x16x32_bf16 a[52:55], a[196:199], v[108:111], a[52:55]
    s_waitcnt lgkmcnt(5)
    v_exp_f32 v129, v71
    v_mfma_f32_16x16x32_bf16 v[168:171], a[200:203], v[96:99], v[168:171]
    v_fma_f32 v79, v79, s28, v17
    v_fma_f32 v94, v94, s28, v19
    v_mfma_f32_16x16x32_bf16 v[216:219], a[200:203], v[100:103], v[216:219]
    ds_read_b64_tr_b16 a[220:221], v6 offset:1024
    v_fma_f32 v78, v78, s28, v17
    v_exp_f32 v134, v68
    v_mfma_f32_16x16x32_bf16 a[8:11], a[200:203], v[104:107], a[8:11]
    ds_read_b64_tr_b16 a[218:219], v5 offset:7168
    v_fma_f32 v81, v81, s28, v18
    v_mfma_f32_16x16x32_bf16 a[56:59], a[200:203], v[108:111], a[56:59]
    ds_read_b64_tr_b16 a[224:225], v3 offset:2048
    v_fma_f32 v75, v75, s28, v17
    v_cvt_pk_bf16_f32 v118, v132, v133
    v_mfma_f32_16x16x32_bf16 v[172:175], a[204:207], v[96:99], v[172:175]
    ds_read_b64_tr_b16 a[222:223], v6 offset:7168
    v_fma_f32 v69, v69, s28, v16
    v_mfma_f32_16x16x32_bf16 v[220:223], a[204:207], v[100:103], v[220:223]
    s_barrier
    ds_read_b64_tr_b16 a[230:231], v4 offset:8192
    v_mfma_f32_16x16x32_bf16 a[12:15], a[204:207], v[104:107], a[12:15]
    ds_read_b64_tr_b16 a[226:227], v3 offset:8192
    v_fma_f32 v82, v82, s28, v18
    v_mfma_f32_16x16x32_bf16 a[60:63], a[204:207], v[108:111], a[60:63]
    s_waitcnt lgkmcnt(6)
    v_exp_f32 v135, v69
    v_mfma_f32_16x16x32_bf16 v[176:179], a[208:211], v[96:99], v[176:179]
    v_exp_f32 v128, v70
    v_mfma_f32_16x16x32_bf16 v[224:227], a[208:211], v[100:103], v[224:227]
    ds_read_b64_tr_b16 a[192:193], v3 offset:12288
    v_cvt_pk_bf16_f32 v114, v134, v135
    v_mfma_f32_16x16x32_bf16 a[16:19], a[208:211], v[104:107], a[16:19]
    ds_read_b64_tr_b16 a[194:195], v3 offset:18432
    v_exp_f32 v133, v85
    v_mfma_f32_16x16x32_bf16 a[64:67], a[208:211], v[108:111], a[64:67]
    v_exp_f32 v135, v79
    v_mfma_f32_16x16x32_bf16 v[180:183], a[212:215], v[96:99], v[180:183]
    ds_read_b64_tr_b16 a[196:197], v4 offset:12288
    v_fma_f32 v84, v84, s28, v18
    v_mfma_f32_16x16x32_bf16 v[228:231], a[212:215], v[100:103], v[228:231]
    ds_read_b64_tr_b16 a[228:229], v4 offset:2048
    v_fma_f32 v74, v74, s28, v17
    v_cvt_pk_bf16_f32 v115, v128, v129
    v_mfma_f32_16x16x32_bf16 a[20:23], a[212:215], v[104:107], a[20:23]
    v_fma_f32 v80, v80, s28, v18
    v_exp_f32 v134, v78
    v_mfma_f32_16x16x32_bf16 v[24:27], a[240:243], v[112:115], v[20:23]
    v_exp_f32 v131, v75
    v_mfma_f32_16x16x32_bf16 a[68:71], a[212:215], v[108:111], a[68:71]
    s_waitcnt lgkmcnt(4)
    ds_read_b64_tr_b16 a[198:199], v4 offset:18432
    v_exp_f32 v130, v74
    v_mfma_f32_16x16x32_bf16 v[184:187], a[216:219], v[96:99], v[184:187]
    v_fma_f32 v93, v93, s28, v19
    v_cvt_pk_bf16_f32 v117, v130, v131
    v_mfma_f32_16x16x32_bf16 v[232:235], a[216:219], v[100:103], v[232:235]
    v_cvt_pk_bf16_f32 v119, v134, v135
    v_exp_f32 v131, v83
    v_mfma_f32_16x16x32_bf16 a[24:27], a[216:219], v[104:107], a[24:27]
    v_exp_f32 v128, v80
    v_mfma_f32_16x16x32_bf16 a[72:75], a[216:219], v[108:111], a[72:75]
    v_exp_f32 v132, v84
    v_mfma_f32_16x16x32_bf16 v[188:191], a[220:223], v[96:99], v[188:191]
    v_exp_f32 v134, v86
    v_fma_f32 v89, v89, s28, v19
    v_mfma_f32_16x16x32_bf16 v[236:239], a[220:223], v[100:103], v[236:239]
    v_exp_f32 v129, v81
    v_mfma_f32_16x16x32_bf16 a[28:31], a[220:223], v[104:107], a[28:31]
    v_cvt_pk_bf16_f32 v120, v128, v129
    v_fma_f32 v91, v91, s28, v19
    v_mfma_f32_16x16x32_bf16 a[76:79], a[220:223], v[108:111], a[76:79]
    v_exp_f32 v130, v82
    v_mfma_f32_16x16x32_bf16 v[192:195], a[224:227], v[96:99], v[192:195]
    ds_read_b64_tr_b16 a[234:235], v5 offset:8192
    v_exp_f32 v135, v87
    v_mfma_f32_16x16x32_bf16 v[240:243], a[224:227], v[100:103], v[240:243]
    ds_read_b64_tr_b16 a[236:237], v6 offset:2048
    v_cvt_pk_bf16_f32 v123, v134, v135
    v_mfma_f32_16x16x32_bf16 v[24:27], a[244:247], v[116:119], v[24:27]
    ds_read_b64_tr_b16 a[238:239], v6 offset:8192
    v_cvt_pk_bf16_f32 v122, v132, v133
    v_mfma_f32_16x16x32_bf16 a[32:35], a[224:227], v[104:107], a[32:35]
    v_exp_f32 v129, v89
    v_fma_f32 v95, v95, s28, v19
    v_exp_f32 v135, v95
    v_mfma_f32_16x16x32_bf16 a[80:83], a[224:227], v[108:111], a[80:83]
    s_waitcnt lgkmcnt(3)
    v_exp_f32 v133, v93
    v_mfma_f32_16x16x32_bf16 v[196:199], a[228:231], v[96:99], v[196:199]
    v_cvt_pk_bf16_f32 v121, v130, v131
    v_exp_f32 v128, v88
    v_mfma_f32_16x16x32_bf16 v[244:247], a[228:231], v[100:103], v[244:247]
    v_exp_f32 v130, v90
    v_mfma_f32_16x16x32_bf16 a[36:39], a[228:231], v[104:107], a[36:39]
    v_exp_f32 v131, v91
    v_mfma_f32_16x16x32_bf16 v[24:27], a[248:251], v[120:123], v[24:27]
    v_exp_f32 v132, v92
    v_mfma_f32_16x16x32_bf16 a[84:87], a[228:231], v[108:111], a[84:87]
    s_waitcnt lgkmcnt(2)
    ds_read_b64_tr_b16 a[200:201], v5 offset:12288
    v_exp_f32 v134, v94
    v_mfma_f32_16x16x32_bf16 v[200:203], a[232:235], v[96:99], v[200:203]
    ds_read_b64_tr_b16 a[202:203], v5 offset:18432
    v_cvt_pk_bf16_f32 v125, v130, v131
    v_mfma_f32_16x16x32_bf16 v[248:251], a[232:235], v[100:103], v[248:251]
    ds_read_b64_tr_b16 a[204:205], v6 offset:12288
    v_cvt_pk_bf16_f32 v126, v132, v133
    v_mfma_f32_16x16x32_bf16 a[40:43], a[232:235], v[104:107], a[40:43]
    v_cvt_pk_bf16_f32 v124, v128, v129
    v_cvt_pk_bf16_f32 v127, v134, v135
    v_mfma_f32_16x16x32_bf16 a[88:91], a[232:235], v[108:111], a[88:91]
    ds_read_b64_tr_b16 a[206:207], v6 offset:18432
    v_mfma_f32_16x16x32_bf16 v[24:27], a[252:255], v[124:127], v[24:27]
    s_waitcnt lgkmcnt(4)
    ds_read_b64_tr_b16 a[208:209], v3 offset:13312
    v_mfma_f32_16x16x32_bf16 v[204:207], a[236:239], v[96:99], v[204:207]
    ds_read_b64_tr_b16 a[210:211], v3 offset:19456
    v_mfma_f32_16x16x32_bf16 v[252:255], a[236:239], v[100:103], v[252:255]
    ds_read_b64_tr_b16 a[212:213], v4 offset:13312
    v_mfma_f32_16x16x32_bf16 a[44:47], a[236:239], v[104:107], a[44:47]
    ds_read_b64_tr_b16 a[214:215], v4 offset:19456
    v_mfma_f32_16x16x32_bf16 a[92:95], a[236:239], v[108:111], a[92:95]
    v_cmp_lt_f32 vcc, s29, v24
    s_nop 4
    s_cbranch_vccnz L_rs_end4b
L_ret_end4b:
    s_waitcnt lgkmcnt(10)
    v_mfma_f32_16x16x32_bf16 v[160:163], a[192:195], v[112:115], v[160:163]
    ds_read_b64_tr_b16 a[216:217], v5 offset:13312
    v_mfma_f32_16x16x32_bf16 v[208:211], a[192:195], v[116:119], v[208:211]
    ds_read_b64_tr_b16 a[226:227], v3 offset:20480
    v_mfma_f32_16x16x32_bf16 a[0:3], a[192:195], v[120:123], a[0:3]
    ds_read_b64_tr_b16 a[220:221], v6 offset:13312
    v_mov_b32 v153, v24
    v_mfma_f32_16x16x32_bf16 a[48:51], a[192:195], v[124:127], a[48:51]
    ds_read_b64_tr_b16 a[230:231], v4 offset:20480
    s_waitcnt lgkmcnt(12)
    v_mfma_f32_16x16x32_bf16 v[164:167], a[196:199], v[112:115], v[164:167]
    v_mfma_f32_16x16x32_bf16 v[212:215], a[196:199], v[116:119], v[212:215]
    v_mfma_f32_16x16x32_bf16 a[4:7], a[196:199], v[120:123], a[4:7]
    v_mfma_f32_16x16x32_bf16 a[52:55], a[196:199], v[124:127], a[52:55]
    s_waitcnt lgkmcnt(10)
    v_mfma_f32_16x16x32_bf16 v[168:171], a[200:203], v[112:115], v[168:171]
    ds_read_b64_tr_b16 a[238:239], v6 offset:20480
    v_mfma_f32_16x16x32_bf16 v[216:219], a[200:203], v[116:119], v[216:219]
    ds_read_b64_tr_b16 a[218:219], v5 offset:19456
    v_mfma_f32_16x16x32_bf16 a[8:11], a[200:203], v[120:123], a[8:11]
    v_rcp_f32 v158, v27
    v_mfma_f32_16x16x32_bf16 a[56:59], a[200:203], v[124:127], a[56:59]
    s_add_u32 s84, s34, 0
    v_accvgpr_read_b32 v149, a49
    s_waitcnt lgkmcnt(4)
    v_mfma_f32_16x16x32_bf16 v[172:175], a[204:207], v[112:115], v[172:175]
    v_mfma_f32_16x16x32_bf16 v[220:223], a[204:207], v[116:119], v[220:223]
    ds_read_b64_tr_b16 a[222:223], v6 offset:19456
    v_accvgpr_read_b32 v129, a5
    v_mfma_f32_16x16x32_bf16 a[12:15], a[204:207], v[120:123], a[12:15]
    v_mfma_f32_16x16x32_bf16 a[60:63], a[204:207], v[124:127], a[60:63]
    v_mov_b32 v152, v24
    v_mfma_f32_16x16x32_bf16 v[176:179], a[208:211], v[112:115], v[176:179]
    ds_read_b64_tr_b16 a[232:233], v5 offset:14336
    v_mfma_f32_16x16x32_bf16 v[224:227], a[208:211], v[116:119], v[224:227]
    v_accvgpr_read_b32 v133, a53
    v_mfma_f32_16x16x32_bf16 a[16:19], a[208:211], v[120:123], a[16:19]
    ds_read_b64_tr_b16 a[224:225], v3 offset:14336
    v_accvgpr_read_b32 v145, a1
    v_mfma_f32_16x16x32_bf16 a[64:67], a[208:211], v[124:127], a[64:67]
    v_rcp_f32 v156, v26
    v_mfma_f32_16x16x32_bf16 v[180:183], a[212:215], v[112:115], v[180:183]
    ds_read_b64_tr_b16 a[228:229], v4 offset:14336
    v_accvgpr_read_b32 v144, a0
    v_mfma_f32_16x16x32_bf16 v[228:231], a[212:215], v[116:119], v[228:231]
    v_permlane16_swap_b32 v152, v153
    v_mfma_f32_16x16x32_bf16 a[20:23], a[212:215], v[120:123], a[20:23]
    v_accvgpr_read_b32 v147, a3
    v_mfma_f32_16x16x32_bf16 a[68:71], a[212:215], v[124:127], a[68:71]
    s_waitcnt lgkmcnt(3)
    v_subrev_u32 v13, 20480, v13
    v_mfma_f32_16x16x32_bf16 v[184:187], a[216:219], v[112:115], v[184:187]
    v_accvgpr_read_b32 v131, a7
    v_mfma_f32_16x16x32_bf16 v[232:235], a[216:219], v[116:119], v[232:235]
    v_xor_b32 v0, 32, v14
    v_accvgpr_read_b32 v146, a2
    v_mfma_f32_16x16x32_bf16 a[24:27], a[216:219], v[120:123], a[24:27]
    v_mfma_f32_16x16x32_bf16 a[72:75], a[216:219], v[124:127], a[72:75]
    v_accvgpr_read_b32 v134, a54
    v_mfma_f32_16x16x32_bf16 v[188:191], a[220:223], v[112:115], v[188:191]
    ds_read_b64_tr_b16 a[234:235], v5 offset:20480
    v_accvgpr_read_b32 v148, a48
    v_mfma_f32_16x16x32_bf16 v[236:239], a[220:223], v[116:119], v[236:239]
    s_add_u32 s85, s34, 6144
    v_mfma_f32_16x16x32_bf16 a[28:31], a[220:223], v[120:123], a[28:31]
    v_mfma_f32_16x16x32_bf16 a[76:79], a[220:223], v[124:127], a[76:79]
    s_waitcnt lgkmcnt(1)
    v_mfma_f32_16x16x32_bf16 v[192:195], a[224:227], v[112:115], v[192:195]
    v_accvgpr_read_b32 v135, a55
    v_accvgpr_read_b32 v130, a6
    v_mfma_f32_16x16x32_bf16 v[240:243], a[224:227], v[116:119], v[240:243]
    v_accvgpr_read_b32 v132, a52
    v_accvgpr_read_b32 v150, a50
    v_mfma_f32_16x16x32_bf16 a[32:35], a[224:227], v[120:123], a[32:35]
    v_xor_b32 v15, 64, v14
    v_mfma_f32_16x16x32_bf16 a[80:83], a[224:227], v[124:127], a[80:83]
    v_rcp_f32 v152, v152
    v_mfma_f32_16x16x32_bf16 v[196:199], a[228:231], v[112:115], v[196:199]
    ds_read_b64_tr_b16 a[236:237], v6 offset:14336
    v_accvgpr_read_b32 v128, a4
    v_mfma_f32_16x16x32_bf16 v[244:247], a[228:231], v[116:119], v[244:247]
    v_accvgpr_read_b32 v151, a51
    v_rcp_f32 v154, v25
    v_xor_b32 v8, 96, v14
    v_pk_mul_f32 v[212:213], v[212:213], v[154:155] op_sel_hi:[1,0]
    v_pk_mul_f32 v[144:145], v[144:145], v[156:157] op_sel_hi:[1,0]
    v_pk_mul_f32 v[148:149], v[148:149], v[158:159] op_sel_hi:[1,0]
    v_pk_mul_f32 v[220:221], v[220:221], v[154:155] op_sel_hi:[1,0]
    v_pk_mul_f32 v[146:147], v[146:147], v[156:157] op_sel_hi:[1,0]
    v_pk_mul_f32 v[186:187], v[186:187], v[152:153] op_sel_hi:[1,0]
    v_pk_mul_f32 v[132:133], v[132:133], v[158:159] op_sel_hi:[1,0]
    v_pk_mul_f32 v[150:151], v[150:151], v[158:159] op_sel_hi:[1,0]
    v_cvt_pk_bf16_f32 v132, v132, v133
    v_pk_mul_f32 v[128:129], v[128:129], v[156:157] op_sel_hi:[1,0]
    v_pk_mul_f32 v[184:185], v[184:185], v[152:153] op_sel_hi:[1,0]
    v_pk_mul_f32 v[182:183], v[182:183], v[152:153] op_sel_hi:[1,0]
    v_pk_mul_f32 v[192:193], v[192:193], v[152:153] op_sel_hi:[1,0]
    v_pk_mul_f32 v[236:237], v[236:237], v[154:155] op_sel_hi:[1,0]
    v_pk_mul_f32 v[196:197], v[196:197], v[152:153] op_sel_hi:[1,0]
    v_pk_mul_f32 v[164:165], v[164:165], v[152:153] op_sel_hi:[1,0]
    v_pk_mul_f32 v[168:169], v[168:169], v[152:153] op_sel_hi:[1,0]
    v_pk_mul_f32 v[208:209], v[208:209], v[154:155] op_sel_hi:[1,0]
    v_cvt_pk_bf16_f32 v220, v220, v221
    v_pk_mul_f32 v[210:211], v[210:211], v[154:155] op_sel_hi:[1,0]
    v_pk_mul_f32 v[228:229], v[228:229], v[154:155] op_sel_hi:[1,0]
    v_cvt_pk_bf16_f32 v212, v212, v213
    v_pk_mul_f32 v[190:191], v[190:191], v[152:153] op_sel_hi:[1,0]
    v_pk_mul_f32 v[230:231], v[230:231], v[154:155] op_sel_hi:[1,0]
    v_pk_mul_f32 v[216:217], v[216:217], v[154:155] op_sel_hi:[1,0]
    v_pk_mul_f32 v[194:195], v[194:195], v[152:153] op_sel_hi:[1,0]
    v_cvt_pk_bf16_f32 v144, v144, v145
    v_cvt_pk_bf16_f32 v128, v128, v129
    v_cvt_pk_bf16_f32 v145, v146, v147
    v_pk_mul_f32 v[160:161], v[160:161], v[152:153] op_sel_hi:[1,0]
    v_pk_mul_f32 v[162:163], v[162:163], v[152:153] op_sel_hi:[1,0]
    v_cvt_pk_bf16_f32 v164, v164, v165
    v_cvt_pk_bf16_f32 v208, v208, v209
    v_cvt_pk_bf16_f32 v228, v228, v229
    v_pk_mul_f32 v[134:135], v[134:135], v[158:159] op_sel_hi:[1,0]
    v_pk_mul_f32 v[180:181], v[180:181], v[152:153] op_sel_hi:[1,0]
    v_pk_mul_f32 v[174:175], v[174:175], v[152:153] op_sel_hi:[1,0]
    v_cvt_pk_bf16_f32 v133, v134, v135
    v_cvt_pk_bf16_f32 v148, v148, v149
    v_pk_mul_f32 v[166:167], v[166:167], v[152:153] op_sel_hi:[1,0]
    v_pk_mul_f32 v[178:179], v[178:179], v[152:153] op_sel_hi:[1,0]
    v_pk_mul_f32 v[222:223], v[222:223], v[154:155] op_sel_hi:[1,0]
    v_pk_mul_f32 v[224:225], v[224:225], v[154:155] op_sel_hi:[1,0]
    v_pk_mul_f32 v[246:247], v[246:247], v[154:155] op_sel_hi:[1,0]
    v_pk_mul_f32 v[130:131], v[130:131], v[156:157] op_sel_hi:[1,0]
    v_pk_mul_f32 v[218:219], v[218:219], v[154:155] op_sel_hi:[1,0]
    v_cvt_pk_bf16_f32 v180, v180, v181
    v_cvt_pk_bf16_f32 v160, v160, v161
    v_pk_mul_f32 v[214:215], v[214:215], v[154:155] op_sel_hi:[1,0]
    v_cvt_pk_bf16_f32 v149, v150, v151
    v_cvt_pk_bf16_f32 v216, v216, v217
    v_cvt_pk_bf16_f32 v161, v162, v163
    v_pk_mul_f32 v[238:239], v[238:239], v[154:155] op_sel_hi:[1,0]
    v_pk_mul_f32 v[172:173], v[172:173], v[152:153] op_sel_hi:[1,0]
    v_pk_mul_f32 v[226:227], v[226:227], v[154:155] op_sel_hi:[1,0]
    v_accvgpr_read_b32 v146, a10
    v_cvt_pk_bf16_f32 v165, v166, v167
    v_accvgpr_read_b32 v135, a63
    v_mfma_f32_16x16x32_bf16 a[36:39], a[228:231], v[120:123], a[36:39]
    v_cvt_pk_bf16_f32 v209, v210, v211
    v_cvt_pk_bf16_f32 v236, v236, v237
    v_accvgpr_read_b32 v151, a59
    v_cvt_pk_bf16_f32 v217, v218, v219
    v_accvgpr_read_b32 v150, a58
    v_cvt_pk_bf16_f32 v129, v130, v131
    v_mfma_f32_16x16x32_bf16 a[84:87], a[228:231], v[124:127], a[84:87]
    s_waitcnt lgkmcnt(0)
    v_cvt_pk_bf16_f32 v213, v214, v215
    v_cvt_pk_bf16_f32 v184, v184, v185
    v_mfma_f32_16x16x32_bf16 v[200:203], a[232:235], v[112:115], v[200:203]
    ds_write2st64_b64 v14, v[160:161], v[208:209] offset0:0 offset1:12
    v_cvt_pk_bf16_f32 v192, v192, v193
    v_mfma_f32_16x16x32_bf16 v[248:251], a[232:235], v[116:119], v[248:251]
    ds_write2st64_b64 v14, v[144:145], v[148:149] offset0:24 offset1:36
    v_mfma_f32_16x16x32_bf16 a[40:43], a[232:235], v[120:123], a[40:43]
    ds_write2st64_b64 v0, v[164:165], v[212:213] offset0:0 offset1:12
    v_mfma_f32_16x16x32_bf16 a[88:91], a[232:235], v[124:127], a[88:91]
    ds_write2st64_b64 v0, v[128:129], v[132:133] offset0:24 offset1:36
    v_accvgpr_read_b32 v134, a62
    v_mfma_f32_16x16x32_bf16 v[204:207], a[236:239], v[112:115], v[204:207]
    v_accvgpr_read_b32 v128, a12
    v_cvt_pk_bf16_f32 v172, v172, v173
    v_mfma_f32_16x16x32_bf16 v[252:255], a[236:239], v[116:119], v[252:255]
    v_accvgpr_read_b32 v130, a14
    v_cvt_pk_bf16_f32 v173, v174, v175
    v_accvgpr_read_b32 v145, a9
    v_mfma_f32_16x16x32_bf16 a[44:47], a[236:239], v[120:123], a[44:47]
    v_accvgpr_read_b32 v133, a61
    v_cvt_pk_bf16_f32 v168, v168, v169
    v_mfma_f32_16x16x32_bf16 a[92:95], a[236:239], v[124:127], a[92:95]
    s_add_u32 s86, s34, 12288
    v_cvt_pk_bf16_f32 v224, v224, v225
    v_accvgpr_read_b32 v149, a57
    v_cvt_pk_bf16_f32 v221, v222, v223
    v_accvgpr_read_b32 v131, a15
    v_accvgpr_read_b32 v129, a13
    v_accvgpr_read_b32 v147, a11
    v_accvgpr_read_b32 v148, a56
    v_pk_mul_f32 v[232:233], v[232:233], v[154:155] op_sel_hi:[1,0]
    v_pk_mul_f32 v[244:245], v[244:245], v[154:155] op_sel_hi:[1,0]
    v_pk_mul_f32 v[150:151], v[150:151], v[158:159] op_sel_hi:[1,0]
    v_accvgpr_read_b32 v132, a60
    v_accvgpr_read_b32 v144, a8
    v_pk_mul_f32 v[148:149], v[148:149], v[158:159] op_sel_hi:[1,0]
    v_pk_mul_f32 v[204:205], v[204:205], v[152:153] op_sel_hi:[1,0]
    v_cvt_pk_bf16_f32 v148, v148, v149
    v_pk_mul_f32 v[188:189], v[188:189], v[152:153] op_sel_hi:[1,0]
    v_pk_mul_f32 v[128:129], v[128:129], v[156:157] op_sel_hi:[1,0]
    v_pk_mul_f32 v[144:145], v[144:145], v[156:157] op_sel_hi:[1,0]
    v_pk_mul_f32 v[132:133], v[132:133], v[158:159] op_sel_hi:[1,0]
    v_pk_mul_f32 v[198:199], v[198:199], v[152:153] op_sel_hi:[1,0]
    v_pk_mul_f32 v[146:147], v[146:147], v[156:157] op_sel_hi:[1,0]
    v_pk_mul_f32 v[170:171], v[170:171], v[152:153] op_sel_hi:[1,0]
    v_cvt_pk_bf16_f32 v196, v196, v197
    v_cvt_pk_bf16_f32 v144, v144, v145
    v_pk_mul_f32 v[130:131], v[130:131], v[156:157] op_sel_hi:[1,0]
    v_pk_mul_f32 v[134:135], v[134:135], v[158:159] op_sel_hi:[1,0]
    v_cvt_pk_bf16_f32 v132, v132, v133
    v_cvt_pk_bf16_f32 v229, v230, v231
    v_cvt_pk_bf16_f32 v145, v146, v147
    v_pk_mul_f32 v[254:255], v[254:255], v[154:155] op_sel_hi:[1,0]
    v_cvt_pk_bf16_f32 v133, v134, v135
    v_cvt_pk_bf16_f32 v169, v170, v171
    v_cvt_pk_bf16_f32 v149, v150, v151
    v_accvgpr_read_b32 v135, a71
    v_pk_mul_f32 v[176:177], v[176:177], v[152:153] op_sel_hi:[1,0]
    v_cvt_pk_bf16_f32 v128, v128, v129
    v_cvt_pk_bf16_f32 v129, v130, v131
    s_add_u32 s87, s34, 18432
    s_add_u32 s18, s34, 24576
    ds_write2st64_b64 v15, v[168:169], v[216:217] offset0:0 offset1:12
    ds_write2st64_b64 v15, v[144:145], v[148:149] offset0:24 offset1:36
    ds_write2st64_b64 v8, v[172:173], v[220:221] offset0:0 offset1:12
    ds_write2st64_b64 v8, v[128:129], v[132:133] offset0:24 offset1:36
    ds_read_b128 v[136:139], v13 offset:0
    ds_read_b128 v[140:143], v13 offset:1024
    v_accvgpr_read_b32 v147, a19
    v_accvgpr_read_b32 v149, a65
    v_accvgpr_read_b32 v129, a21
    v_accvgpr_read_b32 v130, a22
    v_accvgpr_read_b32 v132, a68
    v_accvgpr_read_b32 v148, a64
    v_accvgpr_read_b32 v150, a66
    v_accvgpr_read_b32 v146, a18
    v_accvgpr_read_b32 v133, a69
    v_accvgpr_read_b32 v128, a20
    v_accvgpr_read_b32 v151, a67
    v_pk_mul_f32 v[148:149], v[148:149], v[158:159] op_sel_hi:[1,0]
    v_pk_mul_f32 v[132:133], v[132:133], v[158:159] op_sel_hi:[1,0]
    v_cvt_pk_bf16_f32 v232, v232, v233
    v_accvgpr_read_b32 v144, a16
    v_accvgpr_read_b32 v145, a17
    v_pk_mul_f32 v[234:235], v[234:235], v[154:155] op_sel_hi:[1,0]
    v_accvgpr_read_b32 v134, a70
    v_pk_mul_f32 v[134:135], v[134:135], v[158:159] op_sel_hi:[1,0]
    v_cvt_pk_bf16_f32 v188, v188, v189
    v_pk_mul_f32 v[150:151], v[150:151], v[158:159] op_sel_hi:[1,0]
    v_accvgpr_read_b32 v131, a23
    v_cvt_pk_bf16_f32 v185, v186, v187
    v_cvt_pk_bf16_f32 v233, v234, v235
    v_cvt_pk_bf16_f32 v197, v198, v199
    v_cvt_pk_bf16_f32 v176, v176, v177
    v_cvt_pk_bf16_f32 v132, v132, v133
    v_cvt_pk_bf16_f32 v148, v148, v149
    v_cvt_pk_bf16_f32 v225, v226, v227
    v_pk_mul_f32 v[146:147], v[146:147], v[156:157] op_sel_hi:[1,0]
    v_pk_mul_f32 v[144:145], v[144:145], v[156:157] op_sel_hi:[1,0]
    v_cvt_pk_bf16_f32 v133, v134, v135
    v_pk_mul_f32 v[128:129], v[128:129], v[156:157] op_sel_hi:[1,0]
    v_pk_mul_f32 v[130:131], v[130:131], v[156:157] op_sel_hi:[1,0]
    v_pk_mul_f32 v[252:253], v[252:253], v[154:155] op_sel_hi:[1,0]
    v_pk_mul_f32 v[200:201], v[200:201], v[152:153] op_sel_hi:[1,0]
    v_accvgpr_read_b32 v135, a79
    v_pk_mul_f32 v[240:241], v[240:241], v[154:155] op_sel_hi:[1,0]
    v_accvgpr_read_b32 v134, a78
    v_cvt_pk_bf16_f32 v128, v128, v129
    v_cvt_pk_bf16_f32 v177, v178, v179
    v_cvt_pk_bf16_f32 v181, v182, v183
    v_cvt_pk_bf16_f32 v129, v130, v131
    v_cvt_pk_bf16_f32 v144, v144, v145
    v_cvt_pk_bf16_f32 v149, v150, v151
    v_accvgpr_read_b32 v150, a74
    v_cvt_pk_bf16_f32 v145, v146, v147
    v_accvgpr_read_b32 v131, a31
    ds_read_b128 v[32:35], v13 offset:6144
    ds_read_b128 v[36:39], v13 offset:7168
    ds_read_b128 v[40:43], v13 offset:12288
    ds_read_b128 v[44:47], v13 offset:13312
    ds_read_b128 v[48:51], v13 offset:18432
    ds_read_b128 v[52:55], v13 offset:19456
    ds_write2st64_b64 v14, v[176:177], v[224:225] offset0:4 offset1:16
    ds_write2st64_b64 v14, v[144:145], v[148:149] offset0:28 offset1:40
    ds_write2st64_b64 v0, v[180:181], v[228:229] offset0:4 offset1:16
    ds_write2st64_b64 v0, v[128:129], v[132:133] offset0:28 offset1:40
    ds_write2st64_b64 v15, v[184:185], v[232:233] offset0:4 offset1:16
    v_pk_mul_f32 v[206:207], v[206:207], v[152:153] op_sel_hi:[1,0]
    v_accvgpr_read_b32 v133, a77
    v_accvgpr_read_b32 v132, a76
    v_pk_mul_f32 v[134:135], v[134:135], v[158:159] op_sel_hi:[1,0]
    v_cvt_pk_bf16_f32 v244, v244, v245
    v_accvgpr_read_b32 v151, a75
    v_pk_mul_f32 v[150:151], v[150:151], v[158:159] op_sel_hi:[1,0]
    v_accvgpr_read_b32 v145, a25
    v_accvgpr_read_b32 v129, a29
    v_cvt_pk_bf16_f32 v204, v204, v205
    v_accvgpr_read_b32 v147, a27
    v_accvgpr_read_b32 v149, a73
    v_pk_mul_f32 v[132:133], v[132:133], v[158:159] op_sel_hi:[1,0]
    v_accvgpr_read_b32 v148, a72
    v_accvgpr_read_b32 v128, a28
    v_pk_mul_f32 v[242:243], v[242:243], v[154:155] op_sel_hi:[1,0]
    v_pk_mul_f32 v[250:251], v[250:251], v[154:155] op_sel_hi:[1,0]
    v_pk_mul_f32 v[148:149], v[148:149], v[158:159] op_sel_hi:[1,0]
    v_pk_mul_f32 v[128:129], v[128:129], v[156:157] op_sel_hi:[1,0]
    v_cvt_pk_bf16_f32 v148, v148, v149
    v_cvt_pk_bf16_f32 v128, v128, v129
    v_accvgpr_read_b32 v144, a24
    v_cvt_pk_bf16_f32 v132, v132, v133
    v_accvgpr_read_b32 v130, a30
    v_cvt_pk_bf16_f32 v240, v240, v241
    v_cvt_pk_bf16_f32 v252, v252, v253
    v_pk_mul_f32 v[144:145], v[144:145], v[156:157] op_sel_hi:[1,0]
    v_pk_mul_f32 v[130:131], v[130:131], v[156:157] op_sel_hi:[1,0]
    v_cvt_pk_bf16_f32 v237, v238, v239
    v_cvt_pk_bf16_f32 v205, v206, v207
    v_cvt_pk_bf16_f32 v149, v150, v151
    v_accvgpr_read_b32 v150, a82
    v_cvt_pk_bf16_f32 v129, v130, v131
    v_accvgpr_read_b32 v146, a26
    v_pk_mul_f32 v[146:147], v[146:147], v[156:157] op_sel_hi:[1,0]
    v_accvgpr_read_b32 v131, a39
    v_cvt_pk_bf16_f32 v144, v144, v145
    v_accvgpr_read_b32 v130, a38
    v_cvt_pk_bf16_f32 v133, v134, v135
    v_cvt_pk_bf16_f32 v189, v190, v191
    v_cvt_pk_bf16_f32 v193, v194, v195
    v_cvt_pk_bf16_f32 v145, v146, v147
    v_accvgpr_read_b32 v151, a83
    ds_write2st64_b64 v15, v[144:145], v[148:149] offset0:28 offset1:40
    ds_write2st64_b64 v8, v[188:189], v[236:237] offset0:4 offset1:16
    ds_write2st64_b64 v8, v[128:129], v[132:133] offset0:28 offset1:40
    v_accvgpr_read_b32 v149, a81
    v_cvt_pk_bf16_f32 v245, v246, v247
    v_accvgpr_read_b32 v134, a86
    v_accvgpr_read_b32 v133, a85
    v_pk_mul_f32 v[248:249], v[248:249], v[154:155] op_sel_hi:[1,0]
    v_accvgpr_read_b32 v129, a37
    v_accvgpr_read_b32 v147, a35
    v_accvgpr_read_b32 v132, a84
    v_accvgpr_read_b32 v128, a36
    v_cvt_pk_bf16_f32 v253, v254, v255
    v_pk_mul_f32 v[128:129], v[128:129], v[156:157] op_sel_hi:[1,0]
    v_pk_mul_f32 v[150:151], v[150:151], v[158:159] op_sel_hi:[1,0]
    v_accvgpr_read_b32 v144, a32
    v_pk_mul_f32 v[132:133], v[132:133], v[158:159] op_sel_hi:[1,0]
    v_pk_mul_f32 v[130:131], v[130:131], v[156:157] op_sel_hi:[1,0]
    v_accvgpr_read_b32 v135, a87
    v_cvt_pk_bf16_f32 v241, v242, v243
    v_accvgpr_read_b32 v148, a80
    v_accvgpr_read_b32 v145, a33
    v_pk_mul_f32 v[144:145], v[144:145], v[156:157] op_sel_hi:[1,0]
    v_accvgpr_read_b32 v146, a34
    s_waitcnt lgkmcnt(3)
    buffer_store_dwordx4 v[136:139], v12, s[16:19], s84 offen offset:0 nt
    buffer_store_dwordx4 v[140:143], v12, s[16:19], s84 offen offset:3072 nt
    buffer_store_dwordx4 v[32:35], v12, s[16:19], s85 offen offset:0 nt
    buffer_store_dwordx4 v[36:39], v12, s[16:19], s85 offen offset:3072 nt
    buffer_store_dwordx4 v[40:43], v12, s[16:19], s86 offen offset:0 nt
    buffer_store_dwordx4 v[44:47], v12, s[16:19], s86 offen offset:3072 nt
    buffer_store_dwordx4 v[48:51], v12, s[16:19], s87 offen offset:0 nt
    buffer_store_dwordx4 v[52:55], v12, s[16:19], s87 offen offset:3072 nt
    v_cvt_pk_bf16_f32 v128, v128, v129
    v_pk_mul_f32 v[134:135], v[134:135], v[158:159] op_sel_hi:[1,0]
    v_pk_mul_f32 v[148:149], v[148:149], v[158:159] op_sel_hi:[1,0]
    v_cvt_pk_bf16_f32 v200, v200, v201
    v_cvt_pk_bf16_f32 v144, v144, v145
    v_cvt_pk_bf16_f32 v129, v130, v131
    v_cvt_pk_bf16_f32 v148, v148, v149
    v_pk_mul_f32 v[146:147], v[146:147], v[156:157] op_sel_hi:[1,0]
    v_cvt_pk_bf16_f32 v248, v248, v249
    v_cvt_pk_bf16_f32 v132, v132, v133
    v_accvgpr_read_b32 v130, a46
    v_cvt_pk_bf16_f32 v149, v150, v151
    v_cvt_pk_bf16_f32 v133, v134, v135
    v_cvt_pk_bf16_f32 v145, v146, v147
    ds_read_b128 v[136:139], v13 offset:2048
    ds_read_b128 v[140:143], v13 offset:3072
    ds_read_b128 v[32:35], v13 offset:8192
    ds_read_b128 v[36:39], v13 offset:9216
    ds_read_b128 v[40:43], v13 offset:14336
    ds_read_b128 v[44:47], v13 offset:15360
    ds_read_b128 v[48:51], v13 offset:20480
    ds_read_b128 v[52:55], v13 offset:21504
    ds_write2st64_b64 v14, v[192:193], v[240:241] offset0:8 offset1:20
    ds_write2st64_b64 v14, v[144:145], v[148:149] offset0:32 offset1:44
    ds_write2st64_b64 v0, v[196:197], v[244:245] offset0:8 offset1:20
    ds_write2st64_b64 v0, v[128:129], v[132:133] offset0:32 offset1:44
    v_accvgpr_read_b32 v131, a47
    v_cvt_pk_bf16_f32 v249, v250, v251
    v_accvgpr_read_b32 v148, a88
    v_accvgpr_read_b32 v134, a94
    v_accvgpr_read_b32 v146, a42
    v_accvgpr_read_b32 v151, a91
    v_accvgpr_read_b32 v147, a43
    v_accvgpr_read_b32 v149, a89
    v_accvgpr_read_b32 v145, a41
    v_accvgpr_read_b32 v150, a90
    v_pk_mul_f32 v[150:151], v[150:151], v[158:159] op_sel_hi:[1,0]
    v_accvgpr_read_b32 v128, a44
    v_pk_mul_f32 v[148:149], v[148:149], v[158:159] op_sel_hi:[1,0]
    v_pk_mul_f32 v[202:203], v[202:203], v[152:153] op_sel_hi:[1,0]
    v_cvt_pk_bf16_f32 v148, v148, v149
    v_accvgpr_read_b32 v129, a45
    v_accvgpr_read_b32 v132, a92
    v_pk_mul_f32 v[146:147], v[146:147], v[156:157] op_sel_hi:[1,0]
    v_accvgpr_read_b32 v144, a40
    v_pk_mul_f32 v[144:145], v[144:145], v[156:157] op_sel_hi:[1,0]
    v_accvgpr_read_b32 v135, a95
    v_accvgpr_read_b32 v133, a93
    v_cvt_pk_bf16_f32 v144, v144, v145
    v_pk_mul_f32 v[128:129], v[128:129], v[156:157] op_sel_hi:[1,0]
    v_cvt_pk_bf16_f32 v149, v150, v151
    v_pk_mul_f32 v[132:133], v[132:133], v[158:159] op_sel_hi:[1,0]
    v_cvt_pk_bf16_f32 v145, v146, v147
    v_pk_mul_f32 v[130:131], v[130:131], v[156:157] op_sel_hi:[1,0]
    v_pk_mul_f32 v[134:135], v[134:135], v[158:159] op_sel_hi:[1,0]
    v_cvt_pk_bf16_f32 v128, v128, v129
    v_cvt_pk_bf16_f32 v132, v132, v133
    v_cvt_pk_bf16_f32 v201, v202, v203
    v_cvt_pk_bf16_f32 v133, v134, v135
    v_cvt_pk_bf16_f32 v129, v130, v131
    s_waitcnt lgkmcnt(0)
    buffer_store_dwordx4 v[136:139], v12, s[16:19], s84 offen offset:128 nt
    buffer_store_dwordx4 v[140:143], v12, s[16:19], s84 offen offset:3200 nt
    buffer_store_dwordx4 v[32:35], v12, s[16:19], s85 offen offset:128 nt
    buffer_store_dwordx4 v[36:39], v12, s[16:19], s85 offen offset:3200 nt
    ds_write2st64_b64 v15, v[200:201], v[248:249] offset0:8 offset1:20
    ds_write2st64_b64 v15, v[144:145], v[148:149] offset0:32 offset1:44
    ds_write2st64_b64 v8, v[204:205], v[252:253] offset0:8 offset1:20
    ds_write2st64_b64 v8, v[128:129], v[132:133] offset0:32 offset1:44
    ds_read_b128 v[136:139], v13 offset:4096
    ds_read_b128 v[140:143], v13 offset:5120
    ds_read_b128 v[32:35], v13 offset:10240
    ds_read_b128 v[36:39], v13 offset:11264
    buffer_store_dwordx4 v[40:43], v12, s[16:19], s86 offen offset:128 nt
    buffer_store_dwordx4 v[44:47], v12, s[16:19], s86 offen offset:3200 nt
    ds_read_b128 v[40:43], v13 offset:16384
    ds_read_b128 v[44:47], v13 offset:17408
    buffer_store_dwordx4 v[48:51], v12, s[16:19], s87 offen offset:128 nt
    s_nop 0
    ds_read_b128 v[48:51], v13 offset:22528
    buffer_store_dwordx4 v[52:55], v12, s[16:19], s87 offen offset:3200 nt
    s_nop 0
    ds_read_b128 v[52:55], v13 offset:23552
    s_waitcnt lgkmcnt(7)
    buffer_store_dwordx4 v[136:139], v12, s[16:19], s84 offen offset:256 nt
    s_waitcnt lgkmcnt(4)
    buffer_store_dwordx4 v[140:143], v12, s[16:19], s84 offen offset:3328 nt
    buffer_store_dwordx4 v[32:35], v12, s[16:19], s85 offen offset:256 nt
    buffer_store_dwordx4 v[36:39], v12, s[16:19], s85 offen offset:3328 nt
    s_waitcnt lgkmcnt(2)
    buffer_store_dwordx4 v[40:43], v12, s[16:19], s86 offen offset:256 nt
    buffer_store_dwordx4 v[44:47], v12, s[16:19], s86 offen offset:3328 nt
    s_waitcnt lgkmcnt(1)
    buffer_store_dwordx4 v[48:51], v12, s[16:19], s87 offen offset:256 nt
    s_waitcnt lgkmcnt(0)
    buffer_store_dwordx4 v[52:55], v12, s[16:19], s87 offen offset:3328 nt
    s_branch L_fin
L_end3:
    ds_read_b64_tr_b16 a[222:223], v6 offset:19456
    s_waitcnt lgkmcnt(11)
    v_mfma_f32_16x16x32_bf16 v[160:163], a[192:195], v[112:115], v[160:163]
    ds_read_b64_tr_b16 a[232:233], v5 offset:14336
    v_fma_f32 v44, v44, s28, v17
    v_mfma_f32_16x16x32_bf16 v[208:211], a[192:195], v[116:119], v[208:211]
    ds_read_b64_tr_b16 a[220:221], v6 offset:13312
    v_fma_f32 v54, v54, s28, v18
    v_fma_f32 v39, v39, s28, v16
    v_mfma_f32_16x16x32_bf16 a[0:3], a[192:195], v[120:123], a[0:3]
    s_waitcnt lgkmcnt(11)
    ds_read_b64_tr_b16 a[218:219], v5 offset:19456
    v_fma_f32 v46, v46, s28, v17
    v_mfma_f32_16x16x32_bf16 v[164:167], a[196:199], v[112:115], v[164:167]
    ds_read_b64_tr_b16 a[228:229], v4 offset:14336
    v_fma_f32 v43, v43, s28, v17
    v_mfma_f32_16x16x32_bf16 v[212:215], a[196:199], v[116:119], v[212:215]
    ds_read_b64_tr_b16 a[216:217], v5 offset:13312
    v_fma_f32 v36, v36, s28, v16
    v_mfma_f32_16x16x32_bf16 a[4:7], a[196:199], v[120:123], a[4:7]
    s_waitcnt lgkmcnt(12)
    ds_read_b64_tr_b16 a[236:237], v6 offset:14336
    v_fma_f32 v45, v45, s28, v17
    v_mfma_f32_16x16x32_bf16 v[168:171], a[200:203], v[112:115], v[168:171]
    ds_read_b64_tr_b16 a[226:227], v3 offset:20480
    v_fma_f32 v37, v37, s28, v16
    v_mfma_f32_16x16x32_bf16 v[216:219], a[200:203], v[116:119], v[216:219]
    ds_read_b64_tr_b16 a[224:225], v3 offset:14336
    v_exp_f32 v134, v36
    v_mfma_f32_16x16x32_bf16 a[8:11], a[200:203], v[120:123], a[8:11]
    s_waitcnt lgkmcnt(9)
    ds_read_b64_tr_b16 a[238:239], v6 offset:20480
    v_fma_f32 v53, v53, s28, v18
    v_mfma_f32_16x16x32_bf16 v[172:175], a[204:207], v[112:115], v[172:175]
    ds_read_b64_tr_b16 a[234:235], v5 offset:20480
    v_fma_f32 v51, v51, s28, v18
    v_mfma_f32_16x16x32_bf16 v[220:223], a[204:207], v[116:119], v[220:223]
    ds_read_b64_tr_b16 a[230:231], v4 offset:20480
    v_exp_f32 v131, v43
    v_mfma_f32_16x16x32_bf16 a[12:15], a[204:207], v[120:123], a[12:15]
    v_exp_f32 v135, v37
    v_mfma_f32_16x16x32_bf16 v[176:179], a[208:211], v[112:115], v[176:179]
    v_fma_f32 v38, v38, s28, v16
    v_fma_f32 v42, v42, s28, v17
    v_mfma_f32_16x16x32_bf16 v[224:227], a[208:211], v[116:119], v[224:227]
    v_fma_f32 v48, v48, s28, v18
    v_fma_f32 v50, v50, s28, v18
    v_mfma_f32_16x16x32_bf16 a[16:19], a[208:211], v[120:123], a[16:19]
    v_exp_f32 v129, v39
    v_mfma_f32_16x16x32_bf16 v[180:183], a[212:215], v[112:115], v[180:183]
    v_exp_f32 v128, v38
    v_mfma_f32_16x16x32_bf16 v[228:231], a[212:215], v[116:119], v[228:231]
    v_exp_f32 v133, v45
    v_mfma_f32_16x16x32_bf16 a[20:23], a[212:215], v[120:123], a[20:23]
    s_waitcnt lgkmcnt(3)
    ds_read_b128 v[136:139], v13 offset:0
    v_fma_f32 v47, v47, s28, v17
    v_mfma_f32_16x16x32_bf16 v[184:187], a[216:219], v[112:115], v[184:187]
    v_cvt_pk_bf16_f32 v99, v128, v129
    v_cvt_pk_bf16_f32 v98, v134, v135
    v_mfma_f32_16x16x32_bf16 v[232:235], a[216:219], v[116:119], v[232:235]
    v_exp_f32 v134, v46
    v_mfma_f32_16x16x32_bf16 a[24:27], a[216:219], v[120:123], a[24:27]
    s_waitcnt vmcnt(10) lgkmcnt(1)
    v_exp_f32 v135, v47
    v_mfma_f32_16x16x32_bf16 v[20:23], a[240:243], v[96:99], v[24:27]
    s_barrier
    v_mfma_f32_16x16x32_bf16 v[188:191], a[220:223], v[112:115], v[188:191]
    s_add_u32 m0, s22, 36864
    ds_read_b128 a[196:199], v2 offset:12288
    v_fma_f32 v55, v55, s28, v18
    v_mfma_f32_16x16x32_bf16 v[236:239], a[220:223], v[116:119], v[236:239]
    v_exp_f32 v132, v44
    v_mfma_f32_16x16x32_bf16 a[28:31], a[220:223], v[120:123], a[28:31]
    buffer_load_dwordx4 v9, s[8:11], s21 offen lds
    v_mfma_f32_16x16x32_bf16 v[192:195], a[224:227], v[112:115], v[192:195]
    v_exp_f32 v130, v42
    v_mfma_f32_16x16x32_bf16 v[240:243], a[224:227], v[116:119], v[240:243]
    ds_read_b128 v[140:143], v13 offset:1024
    v_cvt_pk_bf16_f32 v103, v134, v135
    v_mfma_f32_16x16x32_bf16 a[32:35], a[224:227], v[120:123], a[32:35]
    s_add_u32 s21, s21, 128
    ds_read_b128 a[192:195], v1 offset:12288
    v_cvt_pk_bf16_f32 v102, v132, v133
    v_mfma_f32_16x16x32_bf16 v[196:199], a[228:231], v[112:115], v[196:199]
    ds_read_b128 a[200:203], v1 offset:13312
    v_cvt_pk_bf16_f32 v101, v130, v131
    v_mfma_f32_16x16x32_bf16 v[244:247], a[228:231], v[116:119], v[244:247]
    s_add_u32 m0, s22, 37888
    ds_read_b128 a[212:215], v2 offset:14336
    v_exp_f32 v133, v53
    v_mfma_f32_16x16x32_bf16 a[36:39], a[228:231], v[120:123], a[36:39]
    ds_read_b128 a[204:207], v2 offset:13312
    v_fma_f32 v49, v49, s28, v18
    v_mfma_f32_16x16x32_bf16 v[200:203], a[232:235], v[112:115], v[200:203]
    buffer_load_dwordx4 v9, s[8:11], s21 offen lds
    v_mfma_f32_16x16x32_bf16 v[248:251], a[232:235], v[116:119], v[248:251]
    s_add_u32 s21, s21, 128
    ds_read_b128 a[208:211], v1 offset:14336
    v_fma_f32 v52, v52, s28, v18
    v_mfma_f32_16x16x32_bf16 a[40:43], a[232:235], v[120:123], a[40:43]
    s_add_u32 m0, s22, 38912
    v_exp_f32 v129, v49
    v_mfma_f32_16x16x32_bf16 v[204:207], a[236:239], v[112:115], v[204:207]
    v_exp_f32 v132, v52
    v_mfma_f32_16x16x32_bf16 v[20:23], a[244:247], v[100:103], v[20:23]
    v_exp_f32 v131, v51
    v_mfma_f32_16x16x32_bf16 v[252:255], a[236:239], v[116:119], v[252:255]
    buffer_load_dwordx4 v9, s[8:11], s21 offen lds
    v_mfma_f32_16x16x32_bf16 a[44:47], a[236:239], v[120:123], a[44:47]
    s_waitcnt lgkmcnt(4)
    v_exp_f32 v130, v50
    v_mfma_f32_16x16x32_bf16 v[64:67], a[192:195], a[96:99], 0
    buffer_store_dwordx4 v[136:139], v12, s[16:19], s24 offen offset:0 nt
    ds_read_b128 a[232:235], v1 offset:20480
    v_exp_f32 v135, v55
    v_mfma_f32_16x16x32_bf16 v[64:67], a[196:199], a[100:103], v[64:67]
    s_waitcnt lgkmcnt(2)
    v_exp_f32 v134, v54
    v_mfma_f32_16x16x32_bf16 v[64:67], a[200:203], a[104:107], v[64:67]
    v_cvt_pk_bf16_f32 v107, v134, v135
    v_cvt_pk_bf16_f32 v105, v130, v131
    v_mfma_f32_16x16x32_bf16 v[64:67], a[204:207], a[108:111], v[64:67]
    s_waitcnt lgkmcnt(1)
    v_exp_f32 v128, v48
    v_mfma_f32_16x16x32_bf16 v[64:67], a[208:211], a[112:115], v[64:67]
    ds_read_b128 a[216:219], v1 offset:18432
    v_cvt_pk_bf16_f32 v106, v132, v133
    v_mfma_f32_16x16x32_bf16 v[64:67], a[212:215], a[116:119], v[64:67]
    ds_read_b128 a[220:223], v2 offset:18432
    v_cvt_pk_bf16_f32 v104, v128, v129
    v_mfma_f32_16x16x32_bf16 v[72:75], a[192:195], a[120:123], 0
    ds_read_b128 a[236:239], v2 offset:20480
    v_mfma_f32_16x16x32_bf16 v[20:23], a[248:251], v[104:107], v[20:23]
    s_add_u32 s21, s21, 12032
    ds_read_b128 a[228:231], v2 offset:19456
    v_mfma_f32_16x16x32_bf16 v[72:75], a[196:199], a[124:127], v[72:75]
    ds_read_b128 a[224:227], v1 offset:19456
    v_mfma_f32_16x16x32_bf16 v[72:75], a[200:203], a[128:131], v[72:75]
    v_mfma_f32_16x16x32_bf16 v[72:75], a[204:207], a[132:135], v[72:75]
    buffer_store_dwordx4 v[140:143], v12, s[16:19], s24 offen offset:3072 nt
    s_nop 0
    v_cmp_lt_f32 vcc, s29, v20
    v_mfma_f32_16x16x32_bf16 v[72:75], a[208:211], a[136:139], v[72:75]
    ds_read_b128 v[136:139], v13 offset:2048
    s_add_u32 s57, s24, 128
    v_mfma_f32_16x16x32_bf16 v[72:75], a[212:215], a[140:143], v[72:75]
    s_nop 0
    s_cbranch_vccnz L_rs_end3a
L_ret_end3a:
    v_mfma_f32_16x16x32_bf16 v[80:83], a[192:195], a[144:147], 0
    v_fma_f32 v64, v64, s28, v16
    v_mfma_f32_16x16x32_bf16 v[80:83], a[196:199], a[148:151], v[80:83]
    v_mfma_f32_16x16x32_bf16 v[80:83], a[200:203], a[152:155], v[80:83]
    ds_read_b128 v[140:143], v13 offset:3072
    v_mfma_f32_16x16x32_bf16 v[80:83], a[204:207], a[156:159], v[80:83]
    v_fma_f32 v72, v72, s28, v17
    s_waitcnt vmcnt(8) lgkmcnt(2)
    v_mfma_f32_16x16x32_bf16 v[80:83], a[208:211], a[160:163], v[80:83]
    s_barrier
    v_mfma_f32_16x16x32_bf16 v[80:83], a[212:215], a[164:167], v[80:83]
    ds_read_b64_tr_b16 a[192:193], v3 offset:0
    v_fma_f32 v66, v66, s28, v16
    v_mfma_f32_16x16x32_bf16 v[68:71], a[216:219], a[96:99], 0
    ds_read_b64_tr_b16 a[194:195], v3 offset:6144
    v_mfma_f32_16x16x32_bf16 v[68:71], a[220:223], a[100:103], v[68:71]
    ds_read_b64_tr_b16 a[196:197], v4 offset:0
    v_fma_f32 v65, v65, s28, v16
    v_mfma_f32_16x16x32_bf16 v[68:71], a[224:227], a[104:107], v[68:71]
    v_exp_f32 v128, v64
    v_mfma_f32_16x16x32_bf16 v[68:71], a[228:231], a[108:111], v[68:71]
    ds_read_b64_tr_b16 a[198:199], v4 offset:6144
    v_mfma_f32_16x16x32_bf16 v[68:71], a[232:235], a[112:115], v[68:71]
    ds_read_b64_tr_b16 a[200:201], v5 offset:0
    v_fma_f32 v73, v73, s28, v17
    v_mfma_f32_16x16x32_bf16 v[68:71], a[236:239], a[116:119], v[68:71]
    v_exp_f32 v133, v73
    v_mfma_f32_16x16x32_bf16 v[76:79], a[216:219], a[120:123], 0
    s_waitcnt lgkmcnt(5)
    buffer_store_dwordx4 v[136:139], v12, s[16:19], s57 offen offset:0 nt
    ds_read_b64_tr_b16 a[202:203], v5 offset:6144
    v_exp_f32 v132, v72
    v_mfma_f32_16x16x32_bf16 v[76:79], a[220:223], a[124:127], v[76:79]
    ds_read_b64_tr_b16 a[204:205], v6 offset:0
    v_mfma_f32_16x16x32_bf16 v[76:79], a[224:227], a[128:131], v[76:79]
    v_mfma_f32_16x16x32_bf16 v[76:79], a[228:231], a[132:135], v[76:79]
    v_cvt_pk_bf16_f32 v116, v132, v133
    v_mfma_f32_16x16x32_bf16 v[76:79], a[232:235], a[136:139], v[76:79]
    ds_read_b64_tr_b16 a[206:207], v6 offset:6144
    v_fma_f32 v67, v67, s28, v16
    v_mfma_f32_16x16x32_bf16 v[76:79], a[236:239], a[140:143], v[76:79]
    buffer_store_dwordx4 v[140:143], v12, s[16:19], s57 offen offset:3072 nt
    ds_read_b64_tr_b16 a[208:209], v3 offset:1024
    v_exp_f32 v129, v65
    v_mfma_f32_16x16x32_bf16 v[84:87], a[216:219], a[144:147], 0
    ds_read_b64_tr_b16 a[210:211], v3 offset:7168
    v_mfma_f32_16x16x32_bf16 v[84:87], a[220:223], a[148:151], v[84:87]
    v_exp_f32 v131, v67
    v_mfma_f32_16x16x32_bf16 v[84:87], a[224:227], a[152:155], v[84:87]
    v_exp_f32 v130, v66
    v_mfma_f32_16x16x32_bf16 v[84:87], a[228:231], a[156:159], v[84:87]
    ds_read_b64_tr_b16 a[212:213], v4 offset:1024
    v_mfma_f32_16x16x32_bf16 v[84:87], a[232:235], a[160:163], v[84:87]
    ds_read_b64_tr_b16 a[214:215], v4 offset:7168
    v_cvt_pk_bf16_f32 v113, v130, v131
    v_mfma_f32_16x16x32_bf16 v[84:87], a[236:239], a[164:167], v[84:87]
    v_cvt_pk_bf16_f32 v112, v128, v129
    ds_read_b64_tr_b16 a[220:221], v6 offset:1024
    v_fma_f32 v69, v69, s28, v16
    s_waitcnt lgkmcnt(11)
    v_mfma_f32_16x16x32_bf16 v[160:163], a[192:195], v[96:99], v[160:163]
    v_fma_f32 v80, v80, s28, v18
    v_fma_f32 v75, v75, s28, v17
    v_mfma_f32_16x16x32_bf16 v[208:211], a[192:195], v[100:103], v[208:211]
    v_fma_f32 v70, v70, s28, v16
    v_exp_f32 v128, v70
    v_mfma_f32_16x16x32_bf16 a[0:3], a[192:195], v[104:107], a[0:3]
    s_waitcnt lgkmcnt(9)
    ds_read_b64_tr_b16 a[222:223], v6 offset:7168
    v_fma_f32 v76, v76, s28, v17
    v_mfma_f32_16x16x32_bf16 v[164:167], a[196:199], v[96:99], v[164:167]
    s_waitcnt vmcnt(4)
    ds_read_b64_tr_b16 a[218:219], v5 offset:7168
    v_exp_f32 v135, v69
    v_mfma_f32_16x16x32_bf16 v[212:215], a[196:199], v[100:103], v[212:215]
    v_fma_f32 v82, v82, s28, v18
    v_fma_f32 v71, v71, s28, v16
    v_exp_f32 v132, v76
    v_mfma_f32_16x16x32_bf16 a[4:7], a[196:199], v[104:107], a[4:7]
    s_waitcnt lgkmcnt(9)
    ds_read_b64_tr_b16 a[216:217], v5 offset:1024
    v_fma_f32 v74, v74, s28, v17
    v_mfma_f32_16x16x32_bf16 v[168:171], a[200:203], v[96:99], v[168:171]
    v_fma_f32 v83, v83, s28, v18
    v_fma_f32 v78, v78, s28, v17
    v_mfma_f32_16x16x32_bf16 v[216:219], a[200:203], v[100:103], v[216:219]
    ds_read_b64_tr_b16 a[228:229], v4 offset:2048
    v_fma_f32 v77, v77, s28, v17
    v_exp_f32 v129, v71
    v_mfma_f32_16x16x32_bf16 a[8:11], a[200:203], v[104:107], a[8:11]
    s_waitcnt lgkmcnt(4)
    ds_read_b64_tr_b16 a[224:225], v3 offset:2048
    v_cvt_pk_bf16_f32 v115, v128, v129
    v_mfma_f32_16x16x32_bf16 v[172:175], a[204:207], v[96:99], v[172:175]
    v_exp_f32 v130, v74
    v_mfma_f32_16x16x32_bf16 v[220:223], a[204:207], v[100:103], v[220:223]
    v_exp_f32 v133, v77
    v_mfma_f32_16x16x32_bf16 a[12:15], a[204:207], v[104:107], a[12:15]
    ds_read_b64_tr_b16 a[234:235], v5 offset:8192
    v_fma_f32 v68, v68, s28, v16
    v_mfma_f32_16x16x32_bf16 v[176:179], a[208:211], v[96:99], v[176:179]
    s_barrier
    v_exp_f32 v134, v68
    v_mfma_f32_16x16x32_bf16 v[224:227], a[208:211], v[100:103], v[224:227]
    ds_read_b64_tr_b16 a[192:193], v3 offset:12288
    v_fma_f32 v81, v81, s28, v18
    v_mfma_f32_16x16x32_bf16 a[16:19], a[208:211], v[104:107], a[16:19]
    ds_read_b64_tr_b16 a[226:227], v3 offset:8192
    v_exp_f32 v131, v75
    v_mfma_f32_16x16x32_bf16 v[180:183], a[212:215], v[96:99], v[180:183]
    v_fma_f32 v87, v87, s28, v18
    v_fma_f32 v84, v84, s28, v18
    v_cvt_pk_bf16_f32 v114, v134, v135
    v_mfma_f32_16x16x32_bf16 v[228:231], a[212:215], v[100:103], v[228:231]
    v_exp_f32 v134, v78
    v_mfma_f32_16x16x32_bf16 a[20:23], a[212:215], v[104:107], a[20:23]
    s_waitcnt lgkmcnt(3)
    v_exp_f32 v128, v80
    v_mfma_f32_16x16x32_bf16 v[184:187], a[216:219], v[96:99], v[184:187]
    ds_read_b64_tr_b16 a[230:231], v4 offset:8192
    v_fma_f32 v79, v79, s28, v17
    v_mfma_f32_16x16x32_bf16 v[232:235], a[216:219], v[100:103], v[232:235]
    ds_read_b64_tr_b16 a[232:233], v5 offset:2048
    v_cvt_pk_bf16_f32 v118, v132, v133
    v_mfma_f32_16x16x32_bf16 a[24:27], a[216:219], v[104:107], a[24:27]
    ds_read_b64_tr_b16 a[194:195], v3 offset:18432
    v_cvt_pk_bf16_f32 v117, v130, v131
    v_mfma_f32_16x16x32_bf16 v[24:27], a[240:243], v[112:115], v[20:23]
    v_exp_f32 v135, v79
    v_mfma_f32_16x16x32_bf16 v[188:191], a[220:223], v[96:99], v[188:191]
    ds_read_b64_tr_b16 a[236:237], v6 offset:2048
    v_cvt_pk_bf16_f32 v119, v134, v135
    v_mfma_f32_16x16x32_bf16 v[236:239], a[220:223], v[100:103], v[236:239]
    v_exp_f32 v130, v82
    v_mfma_f32_16x16x32_bf16 a[28:31], a[220:223], v[104:107], a[28:31]
    s_waitcnt lgkmcnt(4)
    v_exp_f32 v135, v87
    v_mfma_f32_16x16x32_bf16 v[192:195], a[224:227], v[96:99], v[192:195]
    ds_read_b64_tr_b16 a[196:197], v4 offset:12288
    v_fma_f32 v86, v86, s28, v18
    v_mfma_f32_16x16x32_bf16 v[240:243], a[224:227], v[100:103], v[240:243]
    ds_read_b64_tr_b16 a[238:239], v6 offset:8192
    v_exp_f32 v129, v81
    v_mfma_f32_16x16x32_bf16 v[24:27], a[244:247], v[116:119], v[24:27]
    v_exp_f32 v134, v86
    v_mfma_f32_16x16x32_bf16 a[32:35], a[224:227], v[104:107], a[32:35]
    s_waitcnt lgkmcnt(5)
    v_exp_f32 v131, v83
    v_mfma_f32_16x16x32_bf16 v[196:199], a[228:231], v[96:99], v[196:199]
    ds_read_b64_tr_b16 a[198:199], v4 offset:18432
    v_fma_f32 v85, v85, s28, v18
    v_exp_f32 v132, v84
    v_mfma_f32_16x16x32_bf16 v[244:247], a[228:231], v[100:103], v[244:247]
    ds_read_b64_tr_b16 a[200:201], v5 offset:12288
    v_cvt_pk_bf16_f32 v121, v130, v131
    v_mfma_f32_16x16x32_bf16 a[36:39], a[228:231], v[104:107], a[36:39]
    s_waitcnt lgkmcnt(4)
    v_exp_f32 v133, v85
    v_mfma_f32_16x16x32_bf16 v[200:203], a[232:235], v[96:99], v[200:203]
    ds_read_b64_tr_b16 a[202:203], v5 offset:18432
    v_cvt_pk_bf16_f32 v120, v128, v129
    v_mfma_f32_16x16x32_bf16 v[248:251], a[232:235], v[100:103], v[248:251]
    ds_read_b64_tr_b16 a[204:205], v6 offset:12288
    v_cvt_pk_bf16_f32 v123, v134, v135
    v_cvt_pk_bf16_f32 v122, v132, v133
    v_mfma_f32_16x16x32_bf16 a[40:43], a[232:235], v[104:107], a[40:43]
    ds_read_b64_tr_b16 a[206:207], v6 offset:18432
    v_mfma_f32_16x16x32_bf16 v[24:27], a[248:251], v[120:123], v[24:27]
    s_waitcnt lgkmcnt(5)
    ds_read_b64_tr_b16 a[208:209], v3 offset:13312
    ds_read_b64_tr_b16 a[210:211], v3 offset:19456
    v_mfma_f32_16x16x32_bf16 v[204:207], a[236:239], v[96:99], v[204:207]
    ds_read_b64_tr_b16 a[212:213], v4 offset:13312
    v_mfma_f32_16x16x32_bf16 v[252:255], a[236:239], v[100:103], v[252:255]
    ds_read_b64_tr_b16 a[214:215], v4 offset:19456
    v_mfma_f32_16x16x32_bf16 a[44:47], a[236:239], v[104:107], a[44:47]
    v_cmp_lt_f32 vcc, s29, v24
    s_nop 4
    s_cbranch_vccnz L_rs_end3b
L_ret_end3b:
    s_waitcnt lgkmcnt(10)
    v_mfma_f32_16x16x32_bf16 v[160:163], a[192:195], v[112:115], v[160:163]
    v_xor_b32 v8, 96, v14
    v_mfma_f32_16x16x32_bf16 v[208:211], a[192:195], v[116:119], v[208:211]
    ds_read_b64_tr_b16 a[218:219], v5 offset:19456
    v_mfma_f32_16x16x32_bf16 a[0:3], a[192:195], v[120:123], a[0:3]
    ds_read_b64_tr_b16 a[216:217], v5 offset:13312
    s_waitcnt lgkmcnt(10)
    v_mfma_f32_16x16x32_bf16 v[164:167], a[196:199], v[112:115], v[164:167]
    v_rcp_f32 v154, v25
    v_mfma_f32_16x16x32_bf16 v[212:215], a[196:199], v[116:119], v[212:215]
    ds_read_b64_tr_b16 a[228:229], v4 offset:14336
    v_xor_b32 v0, 32, v14
    v_mfma_f32_16x16x32_bf16 a[4:7], a[196:199], v[120:123], a[4:7]
    ds_read_b64_tr_b16 a[226:227], v3 offset:20480
    s_waitcnt lgkmcnt(10)
    v_mfma_f32_16x16x32_bf16 v[168:171], a[200:203], v[112:115], v[168:171]
    ds_read_b64_tr_b16 a[238:239], v6 offset:20480
    v_mfma_f32_16x16x32_bf16 v[216:219], a[200:203], v[116:119], v[216:219]
    ds_read_b64_tr_b16 a[230:231], v4 offset:20480
    v_mfma_f32_16x16x32_bf16 a[8:11], a[200:203], v[120:123], a[8:11]
    s_waitcnt lgkmcnt(9)
    ds_read_b64_tr_b16 a[220:221], v6 offset:13312
    v_mfma_f32_16x16x32_bf16 v[172:175], a[204:207], v[112:115], v[172:175]
    ds_read_b64_tr_b16 a[222:223], v6 offset:19456
    v_mfma_f32_16x16x32_bf16 v[220:223], a[204:207], v[116:119], v[220:223]
    v_mfma_f32_16x16x32_bf16 a[12:15], a[204:207], v[120:123], a[12:15]
    s_waitcnt lgkmcnt(7)
    ds_read_b64_tr_b16 a[224:225], v3 offset:14336
    v_mfma_f32_16x16x32_bf16 v[176:179], a[208:211], v[112:115], v[176:179]
    v_rcp_f32 v156, v26
    v_mfma_f32_16x16x32_bf16 v[224:227], a[208:211], v[116:119], v[224:227]
    ds_read_b64_tr_b16 a[232:233], v5 offset:14336
    v_mfma_f32_16x16x32_bf16 a[16:19], a[208:211], v[120:123], a[16:19]
    v_mfma_f32_16x16x32_bf16 v[180:183], a[212:215], v[112:115], v[180:183]
    s_add_u32 s84, s34, 0
    v_mov_b32 v153, v24
    v_accvgpr_read_b32 v135, a15
    v_mfma_f32_16x16x32_bf16 v[228:231], a[212:215], v[116:119], v[228:231]
    s_add_u32 s85, s34, 6144
    v_accvgpr_read_b32 v147, a3
    v_mfma_f32_16x16x32_bf16 a[20:23], a[212:215], v[120:123], a[20:23]
    s_waitcnt lgkmcnt(4)
    ds_read_b64_tr_b16 a[234:235], v5 offset:20480
    v_mfma_f32_16x16x32_bf16 v[184:187], a[216:219], v[112:115], v[184:187]
    v_mfma_f32_16x16x32_bf16 v[232:235], a[216:219], v[116:119], v[232:235]
    v_accvgpr_read_b32 v134, a14
    v_subrev_u32 v13, 20480, v13
    v_mfma_f32_16x16x32_bf16 a[24:27], a[216:219], v[120:123], a[24:27]
    s_waitcnt lgkmcnt(3)
    v_accvgpr_read_b32 v128, a8
    v_accvgpr_read_b32 v146, a2
    v_mfma_f32_16x16x32_bf16 v[188:191], a[220:223], v[112:115], v[188:191]
    v_accvgpr_read_b32 v148, a4
    v_accvgpr_read_b32 v151, a7
    v_mfma_f32_16x16x32_bf16 v[236:239], a[220:223], v[116:119], v[236:239]
    v_accvgpr_read_b32 v130, a10
    v_mfma_f32_16x16x32_bf16 a[28:31], a[220:223], v[120:123], a[28:31]
    s_waitcnt lgkmcnt(1)
    v_xor_b32 v15, 64, v14
    v_mov_b32 v152, v24
    v_mfma_f32_16x16x32_bf16 v[192:195], a[224:227], v[112:115], v[192:195]
    v_mfma_f32_16x16x32_bf16 v[240:243], a[224:227], v[116:119], v[240:243]
    ds_read_b64_tr_b16 a[236:237], v6 offset:14336
    v_mfma_f32_16x16x32_bf16 a[32:35], a[224:227], v[120:123], a[32:35]
    v_accvgpr_read_b32 v145, a1
    v_accvgpr_read_b32 v132, a12
    v_mfma_f32_16x16x32_bf16 v[196:199], a[228:231], v[112:115], v[196:199]
    v_accvgpr_read_b32 v149, a5
    v_accvgpr_read_b32 v150, a6
    v_mfma_f32_16x16x32_bf16 v[244:247], a[228:231], v[116:119], v[244:247]
    v_permlane16_swap_b32 v152, v153
    v_mfma_f32_16x16x32_bf16 a[36:39], a[228:231], v[120:123], a[36:39]
    s_add_u32 s86, s34, 12288
    v_accvgpr_read_b32 v133, a13
    s_waitcnt lgkmcnt(1)
    v_mfma_f32_16x16x32_bf16 v[200:203], a[232:235], v[112:115], v[200:203]
    v_accvgpr_read_b32 v131, a11
    v_mfma_f32_16x16x32_bf16 v[248:251], a[232:235], v[116:119], v[248:251]
    v_accvgpr_read_b32 v129, a9
    v_rcp_f32 v152, v152
    v_accvgpr_read_b32 v144, a0
    v_pk_mul_f32 v[212:213], v[212:213], v[154:155] op_sel_hi:[1,0]
    v_pk_mul_f32 v[164:165], v[164:165], v[152:153] op_sel_hi:[1,0]
    v_pk_mul_f32 v[232:233], v[232:233], v[154:155] op_sel_hi:[1,0]
    v_pk_mul_f32 v[132:133], v[132:133], v[156:157] op_sel_hi:[1,0]
    v_pk_mul_f32 v[178:179], v[178:179], v[152:153] op_sel_hi:[1,0]
    v_pk_mul_f32 v[160:161], v[160:161], v[152:153] op_sel_hi:[1,0]
    v_pk_mul_f32 v[184:185], v[184:185], v[152:153] op_sel_hi:[1,0]
    v_pk_mul_f32 v[176:177], v[176:177], v[152:153] op_sel_hi:[1,0]
    v_pk_mul_f32 v[180:181], v[180:181], v[152:153] op_sel_hi:[1,0]
    v_pk_mul_f32 v[218:219], v[218:219], v[154:155] op_sel_hi:[1,0]
    v_pk_mul_f32 v[208:209], v[208:209], v[154:155] op_sel_hi:[1,0]
    v_pk_mul_f32 v[128:129], v[128:129], v[156:157] op_sel_hi:[1,0]
    v_pk_mul_f32 v[166:167], v[166:167], v[152:153] op_sel_hi:[1,0]
    v_pk_mul_f32 v[196:197], v[196:197], v[152:153] op_sel_hi:[1,0]
    v_pk_mul_f32 v[174:175], v[174:175], v[152:153] op_sel_hi:[1,0]
    v_pk_mul_f32 v[144:145], v[144:145], v[156:157] op_sel_hi:[1,0]
    v_pk_mul_f32 v[224:225], v[224:225], v[154:155] op_sel_hi:[1,0]
    v_cvt_pk_bf16_f32 v164, v164, v165
    v_pk_mul_f32 v[240:241], v[240:241], v[154:155] op_sel_hi:[1,0]
    v_cvt_pk_bf16_f32 v208, v208, v209
    v_cvt_pk_bf16_f32 v240, v240, v241
    v_pk_mul_f32 v[130:131], v[130:131], v[156:157] op_sel_hi:[1,0]
    v_pk_mul_f32 v[198:199], v[198:199], v[152:153] op_sel_hi:[1,0]
    v_cvt_pk_bf16_f32 v232, v232, v233
    v_cvt_pk_bf16_f32 v180, v180, v181
    v_cvt_pk_bf16_f32 v224, v224, v225
    v_pk_mul_f32 v[210:211], v[210:211], v[154:155] op_sel_hi:[1,0]
    v_pk_mul_f32 v[248:249], v[248:249], v[154:155] op_sel_hi:[1,0]
    v_pk_mul_f32 v[148:149], v[148:149], v[156:157] op_sel_hi:[1,0]
    v_pk_mul_f32 v[150:151], v[150:151], v[156:157] op_sel_hi:[1,0]
    v_cvt_pk_bf16_f32 v148, v148, v149
    v_pk_mul_f32 v[216:217], v[216:217], v[154:155] op_sel_hi:[1,0]
    v_pk_mul_f32 v[238:239], v[238:239], v[154:155] op_sel_hi:[1,0]
    v_cvt_pk_bf16_f32 v196, v196, v197
    v_pk_mul_f32 v[244:245], v[244:245], v[154:155] op_sel_hi:[1,0]
    v_pk_mul_f32 v[242:243], v[242:243], v[154:155] op_sel_hi:[1,0]
    v_cvt_pk_bf16_f32 v212, v212, v213
    v_pk_mul_f32 v[188:189], v[188:189], v[152:153] op_sel_hi:[1,0]
    v_pk_mul_f32 v[220:221], v[220:221], v[154:155] op_sel_hi:[1,0]
    v_cvt_pk_bf16_f32 v209, v210, v211
    v_pk_mul_f32 v[222:223], v[222:223], v[154:155] op_sel_hi:[1,0]
    v_pk_mul_f32 v[168:169], v[168:169], v[152:153] op_sel_hi:[1,0]
    v_cvt_pk_bf16_f32 v176, v176, v177
    v_cvt_pk_bf16_f32 v244, v244, v245
    v_cvt_pk_bf16_f32 v168, v168, v169
    v_pk_mul_f32 v[134:135], v[134:135], v[156:157] op_sel_hi:[1,0]
    v_cvt_pk_bf16_f32 v188, v188, v189
    v_pk_mul_f32 v[162:163], v[162:163], v[152:153] op_sel_hi:[1,0]
    v_pk_mul_f32 v[226:227], v[226:227], v[154:155] op_sel_hi:[1,0]
    v_pk_mul_f32 v[192:193], v[192:193], v[152:153] op_sel_hi:[1,0]
    v_cvt_pk_bf16_f32 v216, v216, v217
    v_cvt_pk_bf16_f32 v220, v220, v221
    v_pk_mul_f32 v[170:171], v[170:171], v[152:153] op_sel_hi:[1,0]
    v_cvt_pk_bf16_f32 v144, v144, v145
    v_cvt_pk_bf16_f32 v132, v132, v133
    v_cvt_pk_bf16_f32 v128, v128, v129
    v_cvt_pk_bf16_f32 v160, v160, v161
    v_pk_mul_f32 v[190:191], v[190:191], v[152:153] op_sel_hi:[1,0]
    v_pk_mul_f32 v[230:231], v[230:231], v[154:155] op_sel_hi:[1,0]
    v_cvt_pk_bf16_f32 v149, v150, v151
    v_pk_mul_f32 v[214:215], v[214:215], v[154:155] op_sel_hi:[1,0]
    v_pk_mul_f32 v[146:147], v[146:147], v[156:157] op_sel_hi:[1,0]
    v_cvt_pk_bf16_f32 v165, v166, v167
    v_cvt_pk_bf16_f32 v217, v218, v219
    v_cvt_pk_bf16_f32 v145, v146, v147
    v_pk_mul_f32 v[236:237], v[236:237], v[154:155] op_sel_hi:[1,0]
    v_cvt_pk_bf16_f32 v169, v170, v171
    v_accvgpr_read_b32 v146, a18
    v_pk_mul_f32 v[228:229], v[228:229], v[154:155] op_sel_hi:[1,0]
    v_cvt_pk_bf16_f32 v161, v162, v163
    v_pk_mul_f32 v[172:173], v[172:173], v[152:153] op_sel_hi:[1,0]
    v_cvt_pk_bf16_f32 v129, v130, v131
    v_cvt_pk_bf16_f32 v172, v172, v173
    v_pk_mul_f32 v[200:201], v[200:201], v[152:153] op_sel_hi:[1,0]
    v_cvt_pk_bf16_f32 v213, v214, v215
    v_cvt_pk_bf16_f32 v221, v222, v223
    v_cvt_pk_bf16_f32 v173, v174, v175
    v_pk_mul_f32 v[194:195], v[194:195], v[152:153] op_sel_hi:[1,0]
    s_add_u32 s18, s34, 18432
    ds_write2st64_b64 v14, v[160:161], v[208:209] offset0:0 offset1:12
    ds_write_b64 v14, v[144:145] offset:12288
    ds_write2st64_b64 v0, v[164:165], v[212:213] offset0:0 offset1:12
    ds_write_b64 v0, v[148:149] offset:12288
    v_accvgpr_read_b32 v145, a17
    v_cvt_pk_bf16_f32 v236, v236, v237
    v_accvgpr_read_b32 v147, a19
    v_accvgpr_read_b32 v131, a27
    v_pk_mul_f32 v[186:187], v[186:187], v[152:153] op_sel_hi:[1,0]
    v_pk_mul_f32 v[234:235], v[234:235], v[154:155] op_sel_hi:[1,0]
    v_cvt_pk_bf16_f32 v237, v238, v239
    v_accvgpr_read_b32 v151, a23
    v_cvt_pk_bf16_f32 v228, v228, v229
    v_cvt_pk_bf16_f32 v133, v134, v135
    v_mfma_f32_16x16x32_bf16 a[40:43], a[232:235], v[120:123], a[40:43]
    s_waitcnt lgkmcnt(4)
    ds_write2st64_b64 v15, v[168:169], v[216:217] offset0:0 offset1:12
    ds_write_b64 v15, v[128:129] offset:12288
    ds_write2st64_b64 v8, v[172:173], v[220:221] offset0:0 offset1:12
    v_mfma_f32_16x16x32_bf16 v[204:207], a[236:239], v[112:115], v[204:207]
    ds_write_b64 v8, v[132:133] offset:12288
    v_accvgpr_read_b32 v128, a24
    v_accvgpr_read_b32 v148, a20
    v_cvt_pk_bf16_f32 v189, v190, v191
    v_mfma_f32_16x16x32_bf16 v[252:255], a[236:239], v[116:119], v[252:255]
    ds_read_b128 v[136:139], v13 offset:0
    ds_read_b128 v[140:143], v13 offset:1024
    v_cvt_pk_bf16_f32 v177, v178, v179
    v_mfma_f32_16x16x32_bf16 a[44:47], a[236:239], v[120:123], a[44:47]
    ds_read_b128 v[32:35], v13 offset:6144
    ds_read_b128 v[36:39], v13 offset:7168
    ds_read_b128 v[40:43], v13 offset:12288
    ds_read_b128 v[44:47], v13 offset:13312
    v_accvgpr_read_b32 v129, a25
    v_accvgpr_read_b32 v130, a26
    v_cvt_pk_bf16_f32 v241, v242, v243
    v_accvgpr_read_b32 v149, a21
    v_cvt_pk_bf16_f32 v248, v248, v249
    v_accvgpr_read_b32 v144, a16
    v_pk_mul_f32 v[146:147], v[146:147], v[156:157] op_sel_hi:[1,0]
    v_accvgpr_read_b32 v150, a22
    v_pk_mul_f32 v[252:253], v[252:253], v[154:155] op_sel_hi:[1,0]
    v_cvt_pk_bf16_f32 v192, v192, v193
    v_pk_mul_f32 v[246:247], v[246:247], v[154:155] op_sel_hi:[1,0]
    v_cvt_pk_bf16_f32 v184, v184, v185
    v_accvgpr_read_b32 v135, a31
    v_cvt_pk_bf16_f32 v233, v234, v235
    v_cvt_pk_bf16_f32 v225, v226, v227
    v_accvgpr_read_b32 v132, a28
    v_cvt_pk_bf16_f32 v229, v230, v231
    v_pk_mul_f32 v[128:129], v[128:129], v[156:157] op_sel_hi:[1,0]
    v_accvgpr_read_b32 v133, a29
    v_pk_mul_f32 v[148:149], v[148:149], v[156:157] op_sel_hi:[1,0]
    v_pk_mul_f32 v[130:131], v[130:131], v[156:157] op_sel_hi:[1,0]
    v_pk_mul_f32 v[132:133], v[132:133], v[156:157] op_sel_hi:[1,0]
    v_pk_mul_f32 v[150:151], v[150:151], v[156:157] op_sel_hi:[1,0]
    v_pk_mul_f32 v[204:205], v[204:205], v[152:153] op_sel_hi:[1,0]
    v_pk_mul_f32 v[144:145], v[144:145], v[156:157] op_sel_hi:[1,0]
    v_cvt_pk_bf16_f32 v252, v252, v253
    v_cvt_pk_bf16_f32 v132, v132, v133
    v_accvgpr_read_b32 v134, a30
    v_cvt_pk_bf16_f32 v148, v148, v149
    v_cvt_pk_bf16_f32 v245, v246, v247
    v_cvt_pk_bf16_f32 v144, v144, v145
    v_cvt_pk_bf16_f32 v128, v128, v129
    v_pk_mul_f32 v[134:135], v[134:135], v[156:157] op_sel_hi:[1,0]
    v_pk_mul_f32 v[182:183], v[182:183], v[152:153] op_sel_hi:[1,0]
    v_cvt_pk_bf16_f32 v145, v146, v147
    v_cvt_pk_bf16_f32 v133, v134, v135
    v_accvgpr_read_b32 v147, a35
    v_cvt_pk_bf16_f32 v193, v194, v195
    v_pk_mul_f32 v[206:207], v[206:207], v[152:153] op_sel_hi:[1,0]
    v_cvt_pk_bf16_f32 v197, v198, v199
    v_cvt_pk_bf16_f32 v129, v130, v131
    v_cvt_pk_bf16_f32 v185, v186, v187
    v_cvt_pk_bf16_f32 v149, v150, v151
    v_cvt_pk_bf16_f32 v181, v182, v183
    v_pk_mul_f32 v[254:255], v[254:255], v[154:155] op_sel_hi:[1,0]
    v_accvgpr_read_b32 v135, a47
    v_pk_mul_f32 v[202:203], v[202:203], v[152:153] op_sel_hi:[1,0]
    s_waitcnt lgkmcnt(0)
    buffer_store_dwordx4 v[136:139], v12, s[16:19], s84 offen offset:0 nt
    buffer_store_dwordx4 v[140:143], v12, s[16:19], s84 offen offset:3072 nt
    buffer_store_dwordx4 v[32:35], v12, s[16:19], s85 offen offset:0 nt
    buffer_store_dwordx4 v[36:39], v12, s[16:19], s85 offen offset:3072 nt
    buffer_store_dwordx4 v[40:43], v12, s[16:19], s86 offen offset:0 nt
    buffer_store_dwordx4 v[44:47], v12, s[16:19], s86 offen offset:3072 nt
    ds_write2st64_b64 v14, v[176:177], v[224:225] offset0:4 offset1:16
    ds_write_b64 v14, v[144:145] offset:14336
    ds_write2st64_b64 v0, v[180:181], v[228:229] offset0:4 offset1:16
    ds_write_b64 v0, v[148:149] offset:14336
    ds_write2st64_b64 v15, v[184:185], v[232:233] offset0:4 offset1:16
    ds_write_b64 v15, v[128:129] offset:14336
    ds_write2st64_b64 v8, v[188:189], v[236:237] offset0:4 offset1:16
    ds_write_b64 v8, v[132:133] offset:14336
    ds_read_b128 v[136:139], v13 offset:2048
    ds_read_b128 v[140:143], v13 offset:3072
    ds_read_b128 v[32:35], v13 offset:8192
    ds_read_b128 v[36:39], v13 offset:9216
    ds_read_b128 v[40:43], v13 offset:14336
    ds_read_b128 v[44:47], v13 offset:15360
    v_accvgpr_read_b32 v150, a38
    v_accvgpr_read_b32 v146, a34
    v_accvgpr_read_b32 v148, a36
    v_accvgpr_read_b32 v132, a44
    v_accvgpr_read_b32 v131, a43
    v_cvt_pk_bf16_f32 v204, v204, v205
    v_accvgpr_read_b32 v128, a40
    v_pk_mul_f32 v[250:251], v[250:251], v[154:155] op_sel_hi:[1,0]
    v_accvgpr_read_b32 v151, a39
    v_pk_mul_f32 v[146:147], v[146:147], v[156:157] op_sel_hi:[1,0]
    v_accvgpr_read_b32 v133, a45
    v_cvt_pk_bf16_f32 v249, v250, v251
    v_accvgpr_read_b32 v144, a32
    v_accvgpr_read_b32 v130, a42
    v_pk_mul_f32 v[150:151], v[150:151], v[156:157] op_sel_hi:[1,0]
    v_accvgpr_read_b32 v145, a33
    v_pk_mul_f32 v[144:145], v[144:145], v[156:157] op_sel_hi:[1,0]
    v_cvt_pk_bf16_f32 v253, v254, v255
    v_pk_mul_f32 v[132:133], v[132:133], v[156:157] op_sel_hi:[1,0]
    v_accvgpr_read_b32 v129, a41
    v_pk_mul_f32 v[130:131], v[130:131], v[156:157] op_sel_hi:[1,0]
    v_cvt_pk_bf16_f32 v200, v200, v201
    v_accvgpr_read_b32 v149, a37
    v_cvt_pk_bf16_f32 v201, v202, v203
    v_cvt_pk_bf16_f32 v144, v144, v145
    v_pk_mul_f32 v[128:129], v[128:129], v[156:157] op_sel_hi:[1,0]
    v_pk_mul_f32 v[148:149], v[148:149], v[156:157] op_sel_hi:[1,0]
    v_accvgpr_read_b32 v134, a46
    v_cvt_pk_bf16_f32 v128, v128, v129
    v_cvt_pk_bf16_f32 v132, v132, v133
    v_pk_mul_f32 v[134:135], v[134:135], v[156:157] op_sel_hi:[1,0]
    v_cvt_pk_bf16_f32 v148, v148, v149
    v_cvt_pk_bf16_f32 v145, v146, v147
    v_cvt_pk_bf16_f32 v149, v150, v151
    v_cvt_pk_bf16_f32 v129, v130, v131
    v_cvt_pk_bf16_f32 v205, v206, v207
    v_cvt_pk_bf16_f32 v133, v134, v135
    s_waitcnt lgkmcnt(0)
    buffer_store_dwordx4 v[136:139], v12, s[16:19], s84 offen offset:128 nt
    buffer_store_dwordx4 v[140:143], v12, s[16:19], s84 offen offset:3200 nt
    buffer_store_dwordx4 v[32:35], v12, s[16:19], s85 offen offset:128 nt
    ds_write2st64_b64 v14, v[192:193], v[240:241] offset0:8 offset1:20
    ds_write_b64 v14, v[144:145] offset:16384
    ds_write2st64_b64 v0, v[196:197], v[244:245] offset0:8 offset1:20
    ds_write_b64 v0, v[148:149] offset:16384
    ds_write2st64_b64 v15, v[200:201], v[248:249] offset0:8 offset1:20
    ds_write_b64 v15, v[128:129] offset:16384
    ds_write2st64_b64 v8, v[204:205], v[252:253] offset0:8 offset1:20
    ds_write_b64 v8, v[132:133] offset:16384
    ds_read_b128 v[136:139], v13 offset:4096
    ds_read_b128 v[140:143], v13 offset:5120
    ds_read_b128 v[32:35], v13 offset:10240
    buffer_store_dwordx4 v[36:39], v12, s[16:19], s85 offen offset:3200 nt
    buffer_store_dwordx4 v[40:43], v12, s[16:19], s86 offen offset:128 nt
    ds_read_b128 v[36:39], v13 offset:11264
    ds_read_b128 v[40:43], v13 offset:16384
    buffer_store_dwordx4 v[44:47], v12, s[16:19], s86 offen offset:3200 nt
    s_nop 0
    ds_read_b128 v[44:47], v13 offset:17408
    s_waitcnt lgkmcnt(5)
    buffer_store_dwordx4 v[136:139], v12, s[16:19], s84 offen offset:256 nt
    s_waitcnt lgkmcnt(3)
    buffer_store_dwordx4 v[140:143], v12, s[16:19], s84 offen offset:3328 nt
    buffer_store_dwordx4 v[32:35], v12, s[16:19], s85 offen offset:256 nt
    s_waitcnt lgkmcnt(2)
    buffer_store_dwordx4 v[36:39], v12, s[16:19], s85 offen offset:3328 nt
    s_waitcnt lgkmcnt(1)
    buffer_store_dwordx4 v[40:43], v12, s[16:19], s86 offen offset:256 nt
    s_waitcnt lgkmcnt(0)
    buffer_store_dwordx4 v[44:47], v12, s[16:19], s86 offen offset:3328 nt
    s_branch L_fin
L_fin:
    s_waitcnt vmcnt(0)
L_end:
    s_endpgm
L_rare4_0:
    s_nop 15
    v_max3_f32 v28, v32, v33, v34
    v_max3_f32 v28, v28, v35, v36
    v_max3_f32 v28, v28, v37, v38
    v_max_f32 v28, v28, v39
    v_mov_b32 v29, v28
    s_nop 1
    v_permlane32_swap_b32 v29, v28
    v_max_f32 v28, v28, v29
    v_mov_b32 v29, v28
    s_nop 1
    v_permlane16_swap_b32 v29, v28
    v_max_f32 v28, v28, v29
    v_max_f32 v30, 0, v28
    v_sub_f32 v16, v16, v30
    v_sub_f32 v31, 0, v30
    v_exp_f32 v31, v31
    s_nop 0
    v_mul_f32 v24, v24, v31
    v_cndmask_b32_e64 v24, v24, 0, s[46:47]
    v_mul_f32 v160, v160, v31
    v_mul_f32 v161, v161, v31
    v_mul_f32 v162, v162, v31
    v_mul_f32 v163, v163, v31
    v_mul_f32 v164, v164, v31
    v_mul_f32 v165, v165, v31
    v_mul_f32 v166, v166, v31
    v_mul_f32 v167, v167, v31
    v_mul_f32 v168, v168, v31
    v_mul_f32 v169, v169, v31
    v_mul_f32 v170, v170, v31
    v_mul_f32 v171, v171, v31
    v_mul_f32 v172, v172, v31
    v_mul_f32 v173, v173, v31
    v_mul_f32 v174, v174, v31
    v_mul_f32 v175, v175, v31
    v_mul_f32 v176, v176, v31
    v_mul_f32 v177, v177, v31
    v_mul_f32 v178, v178, v31
    v_mul_f32 v179, v179, v31
    v_mul_f32 v180, v180, v31
    v_mul_f32 v181, v181, v31
    v_mul_f32 v182, v182, v31
    v_mul_f32 v183, v183, v31
    v_mul_f32 v184, v184, v31
    v_mul_f32 v185, v185, v31
    v_mul_f32 v186, v186, v31
    v_mul_f32 v187, v187, v31
    v_mul_f32 v188, v188, v31
    v_mul_f32 v189, v189, v31
    v_mul_f32 v190, v190, v31
    v_mul_f32 v191, v191, v31
    v_mul_f32 v192, v192, v31
    v_mul_f32 v193, v193, v31
    v_mul_f32 v194, v194, v31
    v_mul_f32 v195, v195, v31
    v_mul_f32 v196, v196, v31
    v_mul_f32 v197, v197, v31
    v_mul_f32 v198, v198, v31
    v_mul_f32 v199, v199, v31
    v_mul_f32 v200, v200, v31
    v_mul_f32 v201, v201, v31
    v_mul_f32 v202, v202, v31
    v_mul_f32 v203, v203, v31
    v_mul_f32 v204, v204, v31
    v_mul_f32 v205, v205, v31
    v_mul_f32 v206, v206, v31
    v_mul_f32 v207, v207, v31
    v_sub_f32 v32, v32, v30
    v_sub_f32 v33, v33, v30
    v_exp_f32 v128, v32
    v_exp_f32 v129, v33
    s_nop 0
    v_cvt_pk_bf16_f32 v96, v128, v129
    v_sub_f32 v34, v34, v30
    v_sub_f32 v35, v35, v30
    v_exp_f32 v128, v34
    v_exp_f32 v129, v35
    s_nop 0
    v_cvt_pk_bf16_f32 v97, v128, v129
    v_sub_f32 v36, v36, v30
    v_sub_f32 v37, v37, v30
    v_exp_f32 v128, v36
    v_exp_f32 v129, v37
    s_nop 0
    v_cvt_pk_bf16_f32 v98, v128, v129
    v_sub_f32 v38, v38, v30
    v_sub_f32 v39, v39, v30
    v_exp_f32 v128, v38
    v_exp_f32 v129, v39
    s_nop 0
    v_cvt_pk_bf16_f32 v99, v128, v129
    v_max3_f32 v28, v40, v41, v42
    v_max3_f32 v28, v28, v43, v44
    v_max3_f32 v28, v28, v45, v46
    v_max_f32 v28, v28, v47
    v_mov_b32 v29, v28
    s_nop 1
    v_permlane32_swap_b32 v29, v28
    v_max_f32 v28, v28, v29
    v_mov_b32 v29, v28
    s_nop 1
    v_permlane16_swap_b32 v29, v28
    v_max_f32 v28, v28, v29
    v_max_f32 v30, 0, v28
    v_sub_f32 v17, v17, v30
    v_sub_f32 v31, 0, v30
    v_exp_f32 v31, v31
    s_nop 0
    v_mul_f32 v25, v25, v31
    v_mul_f32 v208, v208, v31
    v_mul_f32 v209, v209, v31
    v_mul_f32 v210, v210, v31
    v_mul_f32 v211, v211, v31
    v_mul_f32 v212, v212, v31
    v_mul_f32 v213, v213, v31
    v_mul_f32 v214, v214, v31
    v_mul_f32 v215, v215, v31
    v_mul_f32 v216, v216, v31
    v_mul_f32 v217, v217, v31
    v_mul_f32 v218, v218, v31
    v_mul_f32 v219, v219, v31
    v_mul_f32 v220, v220, v31
    v_mul_f32 v221, v221, v31
    v_mul_f32 v222, v222, v31
    v_mul_f32 v223, v223, v31
    v_mul_f32 v224, v224, v31
    v_mul_f32 v225, v225, v31
    v_mul_f32 v226, v226, v31
    v_mul_f32 v227, v227, v31
    v_mul_f32 v228, v228, v31
    v_mul_f32 v229, v229, v31
    v_mul_f32 v230, v230, v31
    v_mul_f32 v231, v231, v31
    v_mul_f32 v232, v232, v31
    v_mul_f32 v233, v233, v31
    v_mul_f32 v234, v234, v31
    v_mul_f32 v235, v235, v31
    v_mul_f32 v236, v236, v31
    v_mul_f32 v237, v237, v31
    v_mul_f32 v238, v238, v31
    v_mul_f32 v239, v239, v31
    v_mul_f32 v240, v240, v31
    v_mul_f32 v241, v241, v31
    v_mul_f32 v242, v242, v31
    v_mul_f32 v243, v243, v31
    v_mul_f32 v244, v244, v31
    v_mul_f32 v245, v245, v31
    v_mul_f32 v246, v246, v31
    v_mul_f32 v247, v247, v31
    v_mul_f32 v248, v248, v31
    v_mul_f32 v249, v249, v31
    v_mul_f32 v250, v250, v31
    v_mul_f32 v251, v251, v31
    v_mul_f32 v252, v252, v31
    v_mul_f32 v253, v253, v31
    v_mul_f32 v254, v254, v31
    v_mul_f32 v255, v255, v31
    v_sub_f32 v40, v40, v30
    v_sub_f32 v41, v41, v30
    v_exp_f32 v128, v40
    v_exp_f32 v129, v41
    s_nop 0
    v_cvt_pk_bf16_f32 v100, v128, v129
    v_sub_f32 v42, v42, v30
    v_sub_f32 v43, v43, v30
    v_exp_f32 v128, v42
    v_exp_f32 v129, v43
    s_nop 0
    v_cvt_pk_bf16_f32 v101, v128, v129
    v_sub_f32 v44, v44, v30
    v_sub_f32 v45, v45, v30
    v_exp_f32 v128, v44
    v_exp_f32 v129, v45
    s_nop 0
    v_cvt_pk_bf16_f32 v102, v128, v129
    v_sub_f32 v46, v46, v30
    v_sub_f32 v47, v47, v30
    v_exp_f32 v128, v46
    v_exp_f32 v129, v47
    s_nop 0
    v_cvt_pk_bf16_f32 v103, v128, v129
    v_max3_f32 v28, v48, v49, v50
    v_max3_f32 v28, v28, v51, v52
    v_max3_f32 v28, v28, v53, v54
    v_max_f32 v28, v28, v55
    v_mov_b32 v29, v28
    s_nop 1
    v_permlane32_swap_b32 v29, v28
    v_max_f32 v28, v28, v29
    v_mov_b32 v29, v28
    s_nop 1
    v_permlane16_swap_b32 v29, v28
    v_max_f32 v28, v28, v29
    v_max_f32 v30, 0, v28
    v_sub_f32 v18, v18, v30
    v_sub_f32 v31, 0, v30
    v_exp_f32 v31, v31
    s_nop 0
    v_mul_f32 v26, v26, v31
    v_accvgpr_read_b32 v132, a0
    v_accvgpr_read_b32 v133, a1
    v_accvgpr_read_b32 v134, a2
    v_accvgpr_read_b32 v135, a3
    v_mul_f32 v132, v132, v31
    v_mul_f32 v133, v133, v31
    v_mul_f32 v134, v134, v31
    v_mul_f32 v135, v135, v31
    v_accvgpr_write_b32 a0, v132
    v_accvgpr_write_b32 a1, v133
    v_accvgpr_write_b32 a2, v134
    v_accvgpr_write_b32 a3, v135
    v_accvgpr_read_b32 v132, a4
    v_accvgpr_read_b32 v133, a5
    v_accvgpr_read_b32 v134, a6
    v_accvgpr_read_b32 v135, a7
    v_mul_f32 v132, v132, v31
    v_mul_f32 v133, v133, v31
    v_mul_f32 v134, v134, v31
    v_mul_f32 v135, v135, v31
    v_accvgpr_write_b32 a4, v132
    v_accvgpr_write_b32 a5, v133
    v_accvgpr_write_b32 a6, v134
    v_accvgpr_write_b32 a7, v135
    v_accvgpr_read_b32 v132, a8
    v_accvgpr_read_b32 v133, a9
    v_accvgpr_read_b32 v134, a10
    v_accvgpr_read_b32 v135, a11
    v_mul_f32 v132, v132, v31
    v_mul_f32 v133, v133, v31
    v_mul_f32 v134, v134, v31
    v_mul_f32 v135, v135, v31
    v_accvgpr_write_b32 a8, v132
    v_accvgpr_write_b32 a9, v133
    v_accvgpr_write_b32 a10, v134
    v_accvgpr_write_b32 a11, v135
    v_accvgpr_read_b32 v132, a12
    v_accvgpr_read_b32 v133, a13
    v_accvgpr_read_b32 v134, a14
    v_accvgpr_read_b32 v135, a15
    v_mul_f32 v132, v132, v31
    v_mul_f32 v133, v133, v31
    v_mul_f32 v134, v134, v31
    v_mul_f32 v135, v135, v31
    v_accvgpr_write_b32 a12, v132
    v_accvgpr_write_b32 a13, v133
    v_accvgpr_write_b32 a14, v134
    v_accvgpr_write_b32 a15, v135
    v_accvgpr_read_b32 v132, a16
    v_accvgpr_read_b32 v133, a17
    v_accvgpr_read_b32 v134, a18
    v_accvgpr_read_b32 v135, a19
    v_mul_f32 v132, v132, v31
    v_mul_f32 v133, v133, v31
    v_mul_f32 v134, v134, v31
    v_mul_f32 v135, v135, v31
    v_accvgpr_write_b32 a16, v132
    v_accvgpr_write_b32 a17, v133
    v_accvgpr_write_b32 a18, v134
    v_accvgpr_write_b32 a19, v135
    v_accvgpr_read_b32 v132, a20
    v_accvgpr_read_b32 v133, a21
    v_accvgpr_read_b32 v134, a22
    v_accvgpr_read_b32 v135, a23
    v_mul_f32 v132, v132, v31
    v_mul_f32 v133, v133, v31
    v_mul_f32 v134, v134, v31
    v_mul_f32 v135, v135, v31
    v_accvgpr_write_b32 a20, v132
    v_accvgpr_write_b32 a21, v133
    v_accvgpr_write_b32 a22, v134
    v_accvgpr_write_b32 a23, v135
    v_accvgpr_read_b32 v132, a24
    v_accvgpr_read_b32 v133, a25
    v_accvgpr_read_b32 v134, a26
    v_accvgpr_read_b32 v135, a27
    v_mul_f32 v132, v132, v31
    v_mul_f32 v133, v133, v31
    v_mul_f32 v134, v134, v31
    v_mul_f32 v135, v135, v31
    v_accvgpr_write_b32 a24, v132
    v_accvgpr_write_b32 a25, v133
    v_accvgpr_write_b32 a26, v134
    v_accvgpr_write_b32 a27, v135
    v_accvgpr_read_b32 v132, a28
    v_accvgpr_read_b32 v133, a29
    v_accvgpr_read_b32 v134, a30
    v_accvgpr_read_b32 v135, a31
    v_mul_f32 v132, v132, v31
    v_mul_f32 v133, v133, v31
    v_mul_f32 v134, v134, v31
    v_mul_f32 v135, v135, v31
    v_accvgpr_write_b32 a28, v132
    v_accvgpr_write_b32 a29, v133
    v_accvgpr_write_b32 a30, v134
    v_accvgpr_write_b32 a31, v135
    v_accvgpr_read_b32 v132, a32
    v_accvgpr_read_b32 v133, a33
    v_accvgpr_read_b32 v134, a34
    v_accvgpr_read_b32 v135, a35
    v_mul_f32 v132, v132, v31
    v_mul_f32 v133, v133, v31
    v_mul_f32 v134, v134, v31
    v_mul_f32 v135, v135, v31
    v_accvgpr_write_b32 a32, v132
    v_accvgpr_write_b32 a33, v133
    v_accvgpr_write_b32 a34, v134
    v_accvgpr_write_b32 a35, v135
    v_accvgpr_read_b32 v132, a36
    v_accvgpr_read_b32 v133, a37
    v_accvgpr_read_b32 v134, a38
    v_accvgpr_read_b32 v135, a39
    v_mul_f32 v132, v132, v31
    v_mul_f32 v133, v133, v31
    v_mul_f32 v134, v134, v31
    v_mul_f32 v135, v135, v31
    v_accvgpr_write_b32 a36, v132
    v_accvgpr_write_b32 a37, v133
    v_accvgpr_write_b32 a38, v134
    v_accvgpr_write_b32 a39, v135
    v_accvgpr_read_b32 v132, a40
    v_accvgpr_read_b32 v133, a41
    v_accvgpr_read_b32 v134, a42
    v_accvgpr_read_b32 v135, a43
    v_mul_f32 v132, v132, v31
    v_mul_f32 v133, v133, v31
    v_mul_f32 v134, v134, v31
    v_mul_f32 v135, v135, v31
    v_accvgpr_write_b32 a40, v132
    v_accvgpr_write_b32 a41, v133
    v_accvgpr_write_b32 a42, v134
    v_accvgpr_write_b32 a43, v135
    v_accvgpr_read_b32 v132, a44
    v_accvgpr_read_b32 v133, a45
    v_accvgpr_read_b32 v134, a46
    v_accvgpr_read_b32 v135, a47
    v_mul_f32 v132, v132, v31
    v_mul_f32 v133, v133, v31
    v_mul_f32 v134, v134, v31
    v_mul_f32 v135, v135, v31
    v_accvgpr_write_b32 a44, v132
    v_accvgpr_write_b32 a45, v133
    v_accvgpr_write_b32 a46, v134
    v_accvgpr_write_b32 a47, v135
    v_sub_f32 v48, v48, v30
    v_sub_f32 v49, v49, v30
    v_exp_f32 v128, v48
    v_exp_f32 v129, v49
    s_nop 0
    v_cvt_pk_bf16_f32 v104, v128, v129
    v_sub_f32 v50, v50, v30
    v_sub_f32 v51, v51, v30
    v_exp_f32 v128, v50
    v_exp_f32 v129, v51
    s_nop 0
    v_cvt_pk_bf16_f32 v105, v128, v129
    v_sub_f32 v52, v52, v30
    v_sub_f32 v53, v53, v30
    v_exp_f32 v128, v52
    v_exp_f32 v129, v53
    s_nop 0
    v_cvt_pk_bf16_f32 v106, v128, v129
    v_sub_f32 v54, v54, v30
    v_sub_f32 v55, v55, v30
    v_exp_f32 v128, v54
    v_exp_f32 v129, v55
    s_nop 0
    v_cvt_pk_bf16_f32 v107, v128, v129
    v_max3_f32 v28, v56, v57, v58
    v_max3_f32 v28, v28, v59, v60
    v_max3_f32 v28, v28, v61, v62
    v_max_f32 v28, v28, v63
    v_mov_b32 v29, v28
    s_nop 1
    v_permlane32_swap_b32 v29, v28
    v_max_f32 v28, v28, v29
    v_mov_b32 v29, v28
    s_nop 1
    v_permlane16_swap_b32 v29, v28
    v_max_f32 v28, v28, v29
    v_max_f32 v30, 0, v28
    v_sub_f32 v19, v19, v30
    v_sub_f32 v31, 0, v30
    v_exp_f32 v31, v31
    s_nop 0
    v_mul_f32 v27, v27, v31
    v_accvgpr_read_b32 v132, a48
    v_accvgpr_read_b32 v133, a49
    v_accvgpr_read_b32 v134, a50
    v_accvgpr_read_b32 v135, a51
    v_mul_f32 v132, v132, v31
    v_mul_f32 v133, v133, v31
    v_mul_f32 v134, v134, v31
    v_mul_f32 v135, v135, v31
    v_accvgpr_write_b32 a48, v132
    v_accvgpr_write_b32 a49, v133
    v_accvgpr_write_b32 a50, v134
    v_accvgpr_write_b32 a51, v135
    v_accvgpr_read_b32 v132, a52
    v_accvgpr_read_b32 v133, a53
    v_accvgpr_read_b32 v134, a54
    v_accvgpr_read_b32 v135, a55
    v_mul_f32 v132, v132, v31
    v_mul_f32 v133, v133, v31
    v_mul_f32 v134, v134, v31
    v_mul_f32 v135, v135, v31
    v_accvgpr_write_b32 a52, v132
    v_accvgpr_write_b32 a53, v133
    v_accvgpr_write_b32 a54, v134
    v_accvgpr_write_b32 a55, v135
    v_accvgpr_read_b32 v132, a56
    v_accvgpr_read_b32 v133, a57
    v_accvgpr_read_b32 v134, a58
    v_accvgpr_read_b32 v135, a59
    v_mul_f32 v132, v132, v31
    v_mul_f32 v133, v133, v31
    v_mul_f32 v134, v134, v31
    v_mul_f32 v135, v135, v31
    v_accvgpr_write_b32 a56, v132
    v_accvgpr_write_b32 a57, v133
    v_accvgpr_write_b32 a58, v134
    v_accvgpr_write_b32 a59, v135
    v_accvgpr_read_b32 v132, a60
    v_accvgpr_read_b32 v133, a61
    v_accvgpr_read_b32 v134, a62
    v_accvgpr_read_b32 v135, a63
    v_mul_f32 v132, v132, v31
    v_mul_f32 v133, v133, v31
    v_mul_f32 v134, v134, v31
    v_mul_f32 v135, v135, v31
    v_accvgpr_write_b32 a60, v132
    v_accvgpr_write_b32 a61, v133
    v_accvgpr_write_b32 a62, v134
    v_accvgpr_write_b32 a63, v135
    v_accvgpr_read_b32 v132, a64
    v_accvgpr_read_b32 v133, a65
    v_accvgpr_read_b32 v134, a66
    v_accvgpr_read_b32 v135, a67
    v_mul_f32 v132, v132, v31
    v_mul_f32 v133, v133, v31
    v_mul_f32 v134, v134, v31
    v_mul_f32 v135, v135, v31
    v_accvgpr_write_b32 a64, v132
    v_accvgpr_write_b32 a65, v133
    v_accvgpr_write_b32 a66, v134
    v_accvgpr_write_b32 a67, v135
    v_accvgpr_read_b32 v132, a68
    v_accvgpr_read_b32 v133, a69
    v_accvgpr_read_b32 v134, a70
    v_accvgpr_read_b32 v135, a71
    v_mul_f32 v132, v132, v31
    v_mul_f32 v133, v133, v31
    v_mul_f32 v134, v134, v31
    v_mul_f32 v135, v135, v31
    v_accvgpr_write_b32 a68, v132
    v_accvgpr_write_b32 a69, v133
    v_accvgpr_write_b32 a70, v134
    v_accvgpr_write_b32 a71, v135
    v_accvgpr_read_b32 v132, a72
    v_accvgpr_read_b32 v133, a73
    v_accvgpr_read_b32 v134, a74
    v_accvgpr_read_b32 v135, a75
    v_mul_f32 v132, v132, v31
    v_mul_f32 v133, v133, v31
    v_mul_f32 v134, v134, v31
    v_mul_f32 v135, v135, v31
    v_accvgpr_write_b32 a72, v132
    v_accvgpr_write_b32 a73, v133
    v_accvgpr_write_b32 a74, v134
    v_accvgpr_write_b32 a75, v135
    v_accvgpr_read_b32 v132, a76
    v_accvgpr_read_b32 v133, a77
    v_accvgpr_read_b32 v134, a78
    v_accvgpr_read_b32 v135, a79
    v_mul_f32 v132, v132, v31
    v_mul_f32 v133, v133, v31
    v_mul_f32 v134, v134, v31
    v_mul_f32 v135, v135, v31
    v_accvgpr_write_b32 a76, v132
    v_accvgpr_write_b32 a77, v133
    v_accvgpr_write_b32 a78, v134
    v_accvgpr_write_b32 a79, v135
    v_accvgpr_read_b32 v132, a80
    v_accvgpr_read_b32 v133, a81
    v_accvgpr_read_b32 v134, a82
    v_accvgpr_read_b32 v135, a83
    v_mul_f32 v132, v132, v31
    v_mul_f32 v133, v133, v31
    v_mul_f32 v134, v134, v31
    v_mul_f32 v135, v135, v31
    v_accvgpr_write_b32 a80, v132
    v_accvgpr_write_b32 a81, v133
    v_accvgpr_write_b32 a82, v134
    v_accvgpr_write_b32 a83, v135
    v_accvgpr_read_b32 v132, a84
    v_accvgpr_read_b32 v133, a85
    v_accvgpr_read_b32 v134, a86
    v_accvgpr_read_b32 v135, a87
    v_mul_f32 v132, v132, v31
    v_mul_f32 v133, v133, v31
    v_mul_f32 v134, v134, v31
    v_mul_f32 v135, v135, v31
    v_accvgpr_write_b32 a84, v132
    v_accvgpr_write_b32 a85, v133
    v_accvgpr_write_b32 a86, v134
    v_accvgpr_write_b32 a87, v135
    v_accvgpr_read_b32 v132, a88
    v_accvgpr_read_b32 v133, a89
    v_accvgpr_read_b32 v134, a90
    v_accvgpr_read_b32 v135, a91
    v_mul_f32 v132, v132, v31
    v_mul_f32 v133, v133, v31
    v_mul_f32 v134, v134, v31
    v_mul_f32 v135, v135, v31
    v_accvgpr_write_b32 a88, v132
    v_accvgpr_write_b32 a89, v133
    v_accvgpr_write_b32 a90, v134
    v_accvgpr_write_b32 a91, v135
    v_accvgpr_read_b32 v132, a92
    v_accvgpr_read_b32 v133, a93
    v_accvgpr_read_b32 v134, a94
    v_accvgpr_read_b32 v135, a95
    v_mul_f32 v132, v132, v31
    v_mul_f32 v133, v133, v31
    v_mul_f32 v134, v134, v31
    v_mul_f32 v135, v135, v31
    v_accvgpr_write_b32 a92, v132
    v_accvgpr_write_b32 a93, v133
    v_accvgpr_write_b32 a94, v134
    v_accvgpr_write_b32 a95, v135
    v_sub_f32 v56, v56, v30
    v_sub_f32 v57, v57, v30
    v_exp_f32 v128, v56
    v_exp_f32 v129, v57
    s_nop 0
    v_cvt_pk_bf16_f32 v108, v128, v129
    v_sub_f32 v58, v58, v30
    v_sub_f32 v59, v59, v30
    v_exp_f32 v128, v58
    v_exp_f32 v129, v59
    s_nop 0
    v_cvt_pk_bf16_f32 v109, v128, v129
    v_sub_f32 v60, v60, v30
    v_sub_f32 v61, v61, v30
    v_exp_f32 v128, v60
    v_exp_f32 v129, v61
    s_nop 0
    v_cvt_pk_bf16_f32 v110, v128, v129
    v_sub_f32 v62, v62, v30
    v_sub_f32 v63, v63, v30
    v_exp_f32 v128, v62
    v_exp_f32 v129, v63
    s_nop 0
    v_cvt_pk_bf16_f32 v111, v128, v129
    v_mfma_f32_16x16x32_bf16 v[20:23], a[240:243], v[96:99], v[24:27]
    v_mfma_f32_16x16x32_bf16 v[20:23], a[244:247], v[100:103], v[20:23]
    v_mfma_f32_16x16x32_bf16 v[20:23], a[248:251], v[104:107], v[20:23]
    v_mfma_f32_16x16x32_bf16 v[20:23], a[252:255], v[108:111], v[20:23]
    s_nop 15
    s_setpc_b64 s[40:41]
L_rare4_1:
    s_nop 15
    v_max3_f32 v28, v64, v65, v66
    v_max3_f32 v28, v28, v67, v68
    v_max3_f32 v28, v28, v69, v70
    v_max_f32 v28, v28, v71
    v_mov_b32 v29, v28
    s_nop 1
    v_permlane32_swap_b32 v29, v28
    v_max_f32 v28, v28, v29
    v_mov_b32 v29, v28
    s_nop 1
    v_permlane16_swap_b32 v29, v28
    v_max_f32 v28, v28, v29
    v_max_f32 v30, 0, v28
    v_sub_f32 v16, v16, v30
    v_sub_f32 v31, 0, v30
    v_exp_f32 v31, v31
    s_nop 0
    v_mul_f32 v20, v20, v31
    v_cndmask_b32_e64 v20, v20, 0, s[46:47]
    v_mul_f32 v160, v160, v31
    v_mul_f32 v161, v161, v31
    v_mul_f32 v162, v162, v31
    v_mul_f32 v163, v163, v31
    v_mul_f32 v164, v164, v31
    v_mul_f32 v165, v165, v31
    v_mul_f32 v166, v166, v31
    v_mul_f32 v167, v167, v31
    v_mul_f32 v168, v168, v31
    v_mul_f32 v169, v169, v31
    v_mul_f32 v170, v170, v31
    v_mul_f32 v171, v171, v31
    v_mul_f32 v172, v172, v31
    v_mul_f32 v173, v173, v31
    v_mul_f32 v174, v174, v31
    v_mul_f32 v175, v175, v31
    v_mul_f32 v176, v176, v31
    v_mul_f32 v177, v177, v31
    v_mul_f32 v178, v178, v31
    v_mul_f32 v179, v179, v31
    v_mul_f32 v180, v180, v31
    v_mul_f32 v181, v181, v31
    v_mul_f32 v182, v182, v31
    v_mul_f32 v183, v183, v31
    v_mul_f32 v184, v184, v31
    v_mul_f32 v185, v185, v31
    v_mul_f32 v186, v186, v31
    v_mul_f32 v187, v187, v31
    v_mul_f32 v188, v188, v31
    v_mul_f32 v189, v189, v31
    v_mul_f32 v190, v190, v31
    v_mul_f32 v191, v191, v31
    v_mul_f32 v192, v192, v31
    v_mul_f32 v193, v193, v31
    v_mul_f32 v194, v194, v31
    v_mul_f32 v195, v195, v31
    v_mul_f32 v196, v196, v31
    v_mul_f32 v197, v197, v31
    v_mul_f32 v198, v198, v31
    v_mul_f32 v199, v199, v31
    v_mul_f32 v200, v200, v31
    v_mul_f32 v201, v201, v31
    v_mul_f32 v202, v202, v31
    v_mul_f32 v203, v203, v31
    v_mul_f32 v204, v204, v31
    v_mul_f32 v205, v205, v31
    v_mul_f32 v206, v206, v31
    v_mul_f32 v207, v207, v31
    v_sub_f32 v64, v64, v30
    v_sub_f32 v65, v65, v30
    v_exp_f32 v128, v64
    v_exp_f32 v129, v65
    s_nop 0
    v_cvt_pk_bf16_f32 v112, v128, v129
    v_sub_f32 v66, v66, v30
    v_sub_f32 v67, v67, v30
    v_exp_f32 v128, v66
    v_exp_f32 v129, v67
    s_nop 0
    v_cvt_pk_bf16_f32 v113, v128, v129
    v_sub_f32 v68, v68, v30
    v_sub_f32 v69, v69, v30
    v_exp_f32 v128, v68
    v_exp_f32 v129, v69
    s_nop 0
    v_cvt_pk_bf16_f32 v114, v128, v129
    v_sub_f32 v70, v70, v30
    v_sub_f32 v71, v71, v30
    v_exp_f32 v128, v70
    v_exp_f32 v129, v71
    s_nop 0
    v_cvt_pk_bf16_f32 v115, v128, v129
    v_max3_f32 v28, v72, v73, v74
    v_max3_f32 v28, v28, v75, v76
    v_max3_f32 v28, v28, v77, v78
    v_max_f32 v28, v28, v79
    v_mov_b32 v29, v28
    s_nop 1
    v_permlane32_swap_b32 v29, v28
    v_max_f32 v28, v28, v29
    v_mov_b32 v29, v28
    s_nop 1
    v_permlane16_swap_b32 v29, v28
    v_max_f32 v28, v28, v29
    v_max_f32 v30, 0, v28
    v_sub_f32 v17, v17, v30
    v_sub_f32 v31, 0, v30
    v_exp_f32 v31, v31
    s_nop 0
    v_mul_f32 v21, v21, v31
    v_mul_f32 v208, v208, v31
    v_mul_f32 v209, v209, v31
    v_mul_f32 v210, v210, v31
    v_mul_f32 v211, v211, v31
    v_mul_f32 v212, v212, v31
    v_mul_f32 v213, v213, v31
    v_mul_f32 v214, v214, v31
    v_mul_f32 v215, v215, v31
    v_mul_f32 v216, v216, v31
    v_mul_f32 v217, v217, v31
    v_mul_f32 v218, v218, v31
    v_mul_f32 v219, v219, v31
    v_mul_f32 v220, v220, v31
    v_mul_f32 v221, v221, v31
    v_mul_f32 v222, v222, v31
    v_mul_f32 v223, v223, v31
    v_mul_f32 v224, v224, v31
    v_mul_f32 v225, v225, v31
    v_mul_f32 v226, v226, v31
    v_mul_f32 v227, v227, v31
    v_mul_f32 v228, v228, v31
    v_mul_f32 v229, v229, v31
    v_mul_f32 v230, v230, v31
    v_mul_f32 v231, v231, v31
    v_mul_f32 v232, v232, v31
    v_mul_f32 v233, v233, v31
    v_mul_f32 v234, v234, v31
    v_mul_f32 v235, v235, v31
    v_mul_f32 v236, v236, v31
    v_mul_f32 v237, v237, v31
    v_mul_f32 v238, v238, v31
    v_mul_f32 v239, v239, v31
    v_mul_f32 v240, v240, v31
    v_mul_f32 v241, v241, v31
    v_mul_f32 v242, v242, v31
    v_mul_f32 v243, v243, v31
    v_mul_f32 v244, v244, v31
    v_mul_f32 v245, v245, v31
    v_mul_f32 v246, v246, v31
    v_mul_f32 v247, v247, v31
    v_mul_f32 v248, v248, v31
    v_mul_f32 v249, v249, v31
    v_mul_f32 v250, v250, v31
    v_mul_f32 v251, v251, v31
    v_mul_f32 v252, v252, v31
    v_mul_f32 v253, v253, v31
    v_mul_f32 v254, v254, v31
    v_mul_f32 v255, v255, v31
    v_sub_f32 v72, v72, v30
    v_sub_f32 v73, v73, v30
    v_exp_f32 v128, v72
    v_exp_f32 v129, v73
    s_nop 0
    v_cvt_pk_bf16_f32 v116, v128, v129
    v_sub_f32 v74, v74, v30
    v_sub_f32 v75, v75, v30
    v_exp_f32 v128, v74
    v_exp_f32 v129, v75
    s_nop 0
    v_cvt_pk_bf16_f32 v117, v128, v129
    v_sub_f32 v76, v76, v30
    v_sub_f32 v77, v77, v30
    v_exp_f32 v128, v76
    v_exp_f32 v129, v77
    s_nop 0
    v_cvt_pk_bf16_f32 v118, v128, v129
    v_sub_f32 v78, v78, v30
    v_sub_f32 v79, v79, v30
    v_exp_f32 v128, v78
    v_exp_f32 v129, v79
    s_nop 0
    v_cvt_pk_bf16_f32 v119, v128, v129
    v_max3_f32 v28, v80, v81, v82
    v_max3_f32 v28, v28, v83, v84
    v_max3_f32 v28, v28, v85, v86
    v_max_f32 v28, v28, v87
    v_mov_b32 v29, v28
    s_nop 1
    v_permlane32_swap_b32 v29, v28
    v_max_f32 v28, v28, v29
    v_mov_b32 v29, v28
    s_nop 1
    v_permlane16_swap_b32 v29, v28
    v_max_f32 v28, v28, v29
    v_max_f32 v30, 0, v28
    v_sub_f32 v18, v18, v30
    v_sub_f32 v31, 0, v30
    v_exp_f32 v31, v31
    s_nop 0
    v_mul_f32 v22, v22, v31
    v_accvgpr_read_b32 v132, a0
    v_accvgpr_read_b32 v133, a1
    v_accvgpr_read_b32 v134, a2
    v_accvgpr_read_b32 v135, a3
    v_mul_f32 v132, v132, v31
    v_mul_f32 v133, v133, v31
    v_mul_f32 v134, v134, v31
    v_mul_f32 v135, v135, v31
    v_accvgpr_write_b32 a0, v132
    v_accvgpr_write_b32 a1, v133
    v_accvgpr_write_b32 a2, v134
    v_accvgpr_write_b32 a3, v135
    v_accvgpr_read_b32 v132, a4
    v_accvgpr_read_b32 v133, a5
    v_accvgpr_read_b32 v134, a6
    v_accvgpr_read_b32 v135, a7
    v_mul_f32 v132, v132, v31
    v_mul_f32 v133, v133, v31
    v_mul_f32 v134, v134, v31
    v_mul_f32 v135, v135, v31
    v_accvgpr_write_b32 a4, v132
    v_accvgpr_write_b32 a5, v133
    v_accvgpr_write_b32 a6, v134
    v_accvgpr_write_b32 a7, v135
    v_accvgpr_read_b32 v132, a8
    v_accvgpr_read_b32 v133, a9
    v_accvgpr_read_b32 v134, a10
    v_accvgpr_read_b32 v135, a11
    v_mul_f32 v132, v132, v31
    v_mul_f32 v133, v133, v31
    v_mul_f32 v134, v134, v31
    v_mul_f32 v135, v135, v31
    v_accvgpr_write_b32 a8, v132
    v_accvgpr_write_b32 a9, v133
    v_accvgpr_write_b32 a10, v134
    v_accvgpr_write_b32 a11, v135
    v_accvgpr_read_b32 v132, a12
    v_accvgpr_read_b32 v133, a13
    v_accvgpr_read_b32 v134, a14
    v_accvgpr_read_b32 v135, a15
    v_mul_f32 v132, v132, v31
    v_mul_f32 v133, v133, v31
    v_mul_f32 v134, v134, v31
    v_mul_f32 v135, v135, v31
    v_accvgpr_write_b32 a12, v132
    v_accvgpr_write_b32 a13, v133
    v_accvgpr_write_b32 a14, v134
    v_accvgpr_write_b32 a15, v135
    v_accvgpr_read_b32 v132, a16
    v_accvgpr_read_b32 v133, a17
    v_accvgpr_read_b32 v134, a18
    v_accvgpr_read_b32 v135, a19
    v_mul_f32 v132, v132, v31
    v_mul_f32 v133, v133, v31
    v_mul_f32 v134, v134, v31
    v_mul_f32 v135, v135, v31
    v_accvgpr_write_b32 a16, v132
    v_accvgpr_write_b32 a17, v133
    v_accvgpr_write_b32 a18, v134
    v_accvgpr_write_b32 a19, v135
    v_accvgpr_read_b32 v132, a20
    v_accvgpr_read_b32 v133, a21
    v_accvgpr_read_b32 v134, a22
    v_accvgpr_read_b32 v135, a23
    v_mul_f32 v132, v132, v31
    v_mul_f32 v133, v133, v31
    v_mul_f32 v134, v134, v31
    v_mul_f32 v135, v135, v31
    v_accvgpr_write_b32 a20, v132
    v_accvgpr_write_b32 a21, v133
    v_accvgpr_write_b32 a22, v134
    v_accvgpr_write_b32 a23, v135
    v_accvgpr_read_b32 v132, a24
    v_accvgpr_read_b32 v133, a25
    v_accvgpr_read_b32 v134, a26
    v_accvgpr_read_b32 v135, a27
    v_mul_f32 v132, v132, v31
    v_mul_f32 v133, v133, v31
    v_mul_f32 v134, v134, v31
    v_mul_f32 v135, v135, v31
    v_accvgpr_write_b32 a24, v132
    v_accvgpr_write_b32 a25, v133
    v_accvgpr_write_b32 a26, v134
    v_accvgpr_write_b32 a27, v135
    v_accvgpr_read_b32 v132, a28
    v_accvgpr_read_b32 v133, a29
    v_accvgpr_read_b32 v134, a30
    v_accvgpr_read_b32 v135, a31
    v_mul_f32 v132, v132, v31
    v_mul_f32 v133, v133, v31
    v_mul_f32 v134, v134, v31
    v_mul_f32 v135, v135, v31
    v_accvgpr_write_b32 a28, v132
    v_accvgpr_write_b32 a29, v133
    v_accvgpr_write_b32 a30, v134
    v_accvgpr_write_b32 a31, v135
    v_accvgpr_read_b32 v132, a32
    v_accvgpr_read_b32 v133, a33
    v_accvgpr_read_b32 v134, a34
    v_accvgpr_read_b32 v135, a35
    v_mul_f32 v132, v132, v31
    v_mul_f32 v133, v133, v31
    v_mul_f32 v134, v134, v31
    v_mul_f32 v135, v135, v31
    v_accvgpr_write_b32 a32, v132
    v_accvgpr_write_b32 a33, v133
    v_accvgpr_write_b32 a34, v134
    v_accvgpr_write_b32 a35, v135
    v_accvgpr_read_b32 v132, a36
    v_accvgpr_read_b32 v133, a37
    v_accvgpr_read_b32 v134, a38
    v_accvgpr_read_b32 v135, a39
    v_mul_f32 v132, v132, v31
    v_mul_f32 v133, v133, v31
    v_mul_f32 v134, v134, v31
    v_mul_f32 v135, v135, v31
    v_accvgpr_write_b32 a36, v132
    v_accvgpr_write_b32 a37, v133
    v_accvgpr_write_b32 a38, v134
    v_accvgpr_write_b32 a39, v135
    v_accvgpr_read_b32 v132, a40
    v_accvgpr_read_b32 v133, a41
    v_accvgpr_read_b32 v134, a42
    v_accvgpr_read_b32 v135, a43
    v_mul_f32 v132, v132, v31
    v_mul_f32 v133, v133, v31
    v_mul_f32 v134, v134, v31
    v_mul_f32 v135, v135, v31
    v_accvgpr_write_b32 a40, v132
    v_accvgpr_write_b32 a41, v133
    v_accvgpr_write_b32 a42, v134
    v_accvgpr_write_b32 a43, v135
    v_accvgpr_read_b32 v132, a44
    v_accvgpr_read_b32 v133, a45
    v_accvgpr_read_b32 v134, a46
    v_accvgpr_read_b32 v135, a47
    v_mul_f32 v132, v132, v31
    v_mul_f32 v133, v133, v31
    v_mul_f32 v134, v134, v31
    v_mul_f32 v135, v135, v31
    v_accvgpr_write_b32 a44, v132
    v_accvgpr_write_b32 a45, v133
    v_accvgpr_write_b32 a46, v134
    v_accvgpr_write_b32 a47, v135
    v_sub_f32 v80, v80, v30
    v_sub_f32 v81, v81, v30
    v_exp_f32 v128, v80
    v_exp_f32 v129, v81
    s_nop 0
    v_cvt_pk_bf16_f32 v120, v128, v129
    v_sub_f32 v82, v82, v30
    v_sub_f32 v83, v83, v30
    v_exp_f32 v128, v82
    v_exp_f32 v129, v83
    s_nop 0
    v_cvt_pk_bf16_f32 v121, v128, v129
    v_sub_f32 v84, v84, v30
    v_sub_f32 v85, v85, v30
    v_exp_f32 v128, v84
    v_exp_f32 v129, v85
    s_nop 0
    v_cvt_pk_bf16_f32 v122, v128, v129
    v_sub_f32 v86, v86, v30
    v_sub_f32 v87, v87, v30
    v_exp_f32 v128, v86
    v_exp_f32 v129, v87
    s_nop 0
    v_cvt_pk_bf16_f32 v123, v128, v129
    v_max3_f32 v28, v88, v89, v90
    v_max3_f32 v28, v28, v91, v92
    v_max3_f32 v28, v28, v93, v94
    v_max_f32 v28, v28, v95
    v_mov_b32 v29, v28
    s_nop 1
    v_permlane32_swap_b32 v29, v28
    v_max_f32 v28, v28, v29
    v_mov_b32 v29, v28
    s_nop 1
    v_permlane16_swap_b32 v29, v28
    v_max_f32 v28, v28, v29
    v_max_f32 v30, 0, v28
    v_sub_f32 v19, v19, v30
    v_sub_f32 v31, 0, v30
    v_exp_f32 v31, v31
    s_nop 0
    v_mul_f32 v23, v23, v31
    v_accvgpr_read_b32 v132, a48
    v_accvgpr_read_b32 v133, a49
    v_accvgpr_read_b32 v134, a50
    v_accvgpr_read_b32 v135, a51
    v_mul_f32 v132, v132, v31
    v_mul_f32 v133, v133, v31
    v_mul_f32 v134, v134, v31
    v_mul_f32 v135, v135, v31
    v_accvgpr_write_b32 a48, v132
    v_accvgpr_write_b32 a49, v133
    v_accvgpr_write_b32 a50, v134
    v_accvgpr_write_b32 a51, v135
    v_accvgpr_read_b32 v132, a52
    v_accvgpr_read_b32 v133, a53
    v_accvgpr_read_b32 v134, a54
    v_accvgpr_read_b32 v135, a55
    v_mul_f32 v132, v132, v31
    v_mul_f32 v133, v133, v31
    v_mul_f32 v134, v134, v31
    v_mul_f32 v135, v135, v31
    v_accvgpr_write_b32 a52, v132
    v_accvgpr_write_b32 a53, v133
    v_accvgpr_write_b32 a54, v134
    v_accvgpr_write_b32 a55, v135
    v_accvgpr_read_b32 v132, a56
    v_accvgpr_read_b32 v133, a57
    v_accvgpr_read_b32 v134, a58
    v_accvgpr_read_b32 v135, a59
    v_mul_f32 v132, v132, v31
    v_mul_f32 v133, v133, v31
    v_mul_f32 v134, v134, v31
    v_mul_f32 v135, v135, v31
    v_accvgpr_write_b32 a56, v132
    v_accvgpr_write_b32 a57, v133
    v_accvgpr_write_b32 a58, v134
    v_accvgpr_write_b32 a59, v135
    v_accvgpr_read_b32 v132, a60
    v_accvgpr_read_b32 v133, a61
    v_accvgpr_read_b32 v134, a62
    v_accvgpr_read_b32 v135, a63
    v_mul_f32 v132, v132, v31
    v_mul_f32 v133, v133, v31
    v_mul_f32 v134, v134, v31
    v_mul_f32 v135, v135, v31
    v_accvgpr_write_b32 a60, v132
    v_accvgpr_write_b32 a61, v133
    v_accvgpr_write_b32 a62, v134
    v_accvgpr_write_b32 a63, v135
    v_accvgpr_read_b32 v132, a64
    v_accvgpr_read_b32 v133, a65
    v_accvgpr_read_b32 v134, a66
    v_accvgpr_read_b32 v135, a67
    v_mul_f32 v132, v132, v31
    v_mul_f32 v133, v133, v31
    v_mul_f32 v134, v134, v31
    v_mul_f32 v135, v135, v31
    v_accvgpr_write_b32 a64, v132
    v_accvgpr_write_b32 a65, v133
    v_accvgpr_write_b32 a66, v134
    v_accvgpr_write_b32 a67, v135
    v_accvgpr_read_b32 v132, a68
    v_accvgpr_read_b32 v133, a69
    v_accvgpr_read_b32 v134, a70
    v_accvgpr_read_b32 v135, a71
    v_mul_f32 v132, v132, v31
    v_mul_f32 v133, v133, v31
    v_mul_f32 v134, v134, v31
    v_mul_f32 v135, v135, v31
    v_accvgpr_write_b32 a68, v132
    v_accvgpr_write_b32 a69, v133
    v_accvgpr_write_b32 a70, v134
    v_accvgpr_write_b32 a71, v135
    v_accvgpr_read_b32 v132, a72
    v_accvgpr_read_b32 v133, a73
    v_accvgpr_read_b32 v134, a74
    v_accvgpr_read_b32 v135, a75
    v_mul_f32 v132, v132, v31
    v_mul_f32 v133, v133, v31
    v_mul_f32 v134, v134, v31
    v_mul_f32 v135, v135, v31
    v_accvgpr_write_b32 a72, v132
    v_accvgpr_write_b32 a73, v133
    v_accvgpr_write_b32 a74, v134
    v_accvgpr_write_b32 a75, v135
    v_accvgpr_read_b32 v132, a76
    v_accvgpr_read_b32 v133, a77
    v_accvgpr_read_b32 v134, a78
    v_accvgpr_read_b32 v135, a79
    v_mul_f32 v132, v132, v31
    v_mul_f32 v133, v133, v31
    v_mul_f32 v134, v134, v31
    v_mul_f32 v135, v135, v31
    v_accvgpr_write_b32 a76, v132
    v_accvgpr_write_b32 a77, v133
    v_accvgpr_write_b32 a78, v134
    v_accvgpr_write_b32 a79, v135
    v_accvgpr_read_b32 v132, a80
    v_accvgpr_read_b32 v133, a81
    v_accvgpr_read_b32 v134, a82
    v_accvgpr_read_b32 v135, a83
    v_mul_f32 v132, v132, v31
    v_mul_f32 v133, v133, v31
    v_mul_f32 v134, v134, v31
    v_mul_f32 v135, v135, v31
    v_accvgpr_write_b32 a80, v132
    v_accvgpr_write_b32 a81, v133
    v_accvgpr_write_b32 a82, v134
    v_accvgpr_write_b32 a83, v135
    v_accvgpr_read_b32 v132, a84
    v_accvgpr_read_b32 v133, a85
    v_accvgpr_read_b32 v134, a86
    v_accvgpr_read_b32 v135, a87
    v_mul_f32 v132, v132, v31
    v_mul_f32 v133, v133, v31
    v_mul_f32 v134, v134, v31
    v_mul_f32 v135, v135, v31
    v_accvgpr_write_b32 a84, v132
    v_accvgpr_write_b32 a85, v133
    v_accvgpr_write_b32 a86, v134
    v_accvgpr_write_b32 a87, v135
    v_accvgpr_read_b32 v132, a88
    v_accvgpr_read_b32 v133, a89
    v_accvgpr_read_b32 v134, a90
    v_accvgpr_read_b32 v135, a91
    v_mul_f32 v132, v132, v31
    v_mul_f32 v133, v133, v31
    v_mul_f32 v134, v134, v31
    v_mul_f32 v135, v135, v31
    v_accvgpr_write_b32 a88, v132
    v_accvgpr_write_b32 a89, v133
    v_accvgpr_write_b32 a90, v134
    v_accvgpr_write_b32 a91, v135
    v_accvgpr_read_b32 v132, a92
    v_accvgpr_read_b32 v133, a93
    v_accvgpr_read_b32 v134, a94
    v_accvgpr_read_b32 v135, a95
    v_mul_f32 v132, v132, v31
    v_mul_f32 v133, v133, v31
    v_mul_f32 v134, v134, v31
    v_mul_f32 v135, v135, v31
    v_accvgpr_write_b32 a92, v132
    v_accvgpr_write_b32 a93, v133
    v_accvgpr_write_b32 a94, v134
    v_accvgpr_write_b32 a95, v135
    v_sub_f32 v88, v88, v30
    v_sub_f32 v89, v89, v30
    v_exp_f32 v128, v88
    v_exp_f32 v129, v89
    s_nop 0
    v_cvt_pk_bf16_f32 v124, v128, v129
    v_sub_f32 v90, v90, v30
    v_sub_f32 v91, v91, v30
    v_exp_f32 v128, v90
    v_exp_f32 v129, v91
    s_nop 0
    v_cvt_pk_bf16_f32 v125, v128, v129
    v_sub_f32 v92, v92, v30
    v_sub_f32 v93, v93, v30
    v_exp_f32 v128, v92
    v_exp_f32 v129, v93
    s_nop 0
    v_cvt_pk_bf16_f32 v126, v128, v129
    v_sub_f32 v94, v94, v30
    v_sub_f32 v95, v95, v30
    v_exp_f32 v128, v94
    v_exp_f32 v129, v95
    s_nop 0
    v_cvt_pk_bf16_f32 v127, v128, v129
    v_mfma_f32_16x16x32_bf16 v[24:27], a[240:243], v[112:115], v[20:23]
    v_mfma_f32_16x16x32_bf16 v[24:27], a[244:247], v[116:119], v[24:27]
    v_mfma_f32_16x16x32_bf16 v[24:27], a[248:251], v[120:123], v[24:27]
    v_mfma_f32_16x16x32_bf16 v[24:27], a[252:255], v[124:127], v[24:27]
    s_nop 15
    s_setpc_b64 s[40:41]
L_rare3_0:
    s_nop 15
    v_max3_f32 v28, v32, v33, v34
    v_max3_f32 v28, v28, v35, v36
    v_max3_f32 v28, v28, v37, v38
    v_max_f32 v28, v28, v39
    v_mov_b32 v29, v28
    s_nop 1
    v_permlane32_swap_b32 v29, v28
    v_max_f32 v28, v28, v29
    v_mov_b32 v29, v28
    s_nop 1
    v_permlane16_swap_b32 v29, v28
    v_max_f32 v28, v28, v29
    v_max_f32 v30, 0, v28
    v_sub_f32 v16, v16, v30
    v_sub_f32 v31, 0, v30
    v_exp_f32 v31, v31
    s_nop 0
    v_mul_f32 v24, v24, v31
    v_cndmask_b32_e64 v24, v24, 0, s[46:47]
    v_mul_f32 v160, v160, v31
    v_mul_f32 v161, v161, v31
    v_mul_f32 v162, v162, v31
    v_mul_f32 v163, v163, v31
    v_mul_f32 v164, v164, v31
    v_mul_f32 v165, v165, v31
    v_mul_f32 v166, v166, v31
    v_mul_f32 v167, v167, v31
    v_mul_f32 v168, v168, v31
    v_mul_f32 v169, v169, v31
    v_mul_f32 v170, v170, v31
    v_mul_f32 v171, v171, v31
    v_mul_f32 v172, v172, v31
    v_mul_f32 v173, v173, v31
    v_mul_f32 v174, v174, v31
    v_mul_f32 v175, v175, v31
    v_mul_f32 v176, v176, v31
    v_mul_f32 v177, v177, v31
    v_mul_f32 v178, v178, v31
    v_mul_f32 v179, v179, v31
    v_mul_f32 v180, v180, v31
    v_mul_f32 v181, v181, v31
    v_mul_f32 v182, v182, v31
    v_mul_f32 v183, v183, v31
    v_mul_f32 v184, v184, v31
    v_mul_f32 v185, v185, v31
    v_mul_f32 v186, v186, v31
    v_mul_f32 v187, v187, v31
    v_mul_f32 v188, v188, v31
    v_mul_f32 v189, v189, v31
    v_mul_f32 v190, v190, v31
    v_mul_f32 v191, v191, v31
    v_mul_f32 v192, v192, v31
    v_mul_f32 v193, v193, v31
    v_mul_f32 v194, v194, v31
    v_mul_f32 v195, v195, v31
    v_mul_f32 v196, v196, v31
    v_mul_f32 v197, v197, v31
    v_mul_f32 v198, v198, v31
    v_mul_f32 v199, v199, v31
    v_mul_f32 v200, v200, v31
    v_mul_f32 v201, v201, v31
    v_mul_f32 v202, v202, v31
    v_mul_f32 v203, v203, v31
    v_mul_f32 v204, v204, v31
    v_mul_f32 v205, v205, v31
    v_mul_f32 v206, v206, v31
    v_mul_f32 v207, v207, v31
    v_sub_f32 v32, v32, v30
    v_sub_f32 v33, v33, v30
    v_exp_f32 v128, v32
    v_exp_f32 v129, v33
    s_nop 0
    v_cvt_pk_bf16_f32 v96, v128, v129
    v_sub_f32 v34, v34, v30
    v_sub_f32 v35, v35, v30
    v_exp_f32 v128, v34
    v_exp_f32 v129, v35
    s_nop 0
    v_cvt_pk_bf16_f32 v97, v128, v129
    v_sub_f32 v36, v36, v30
    v_sub_f32 v37, v37, v30
    v_exp_f32 v128, v36
    v_exp_f32 v129, v37
    s_nop 0
    v_cvt_pk_bf16_f32 v98, v128, v129
    v_sub_f32 v38, v38, v30
    v_sub_f32 v39, v39, v30
    v_exp_f32 v128, v38
    v_exp_f32 v129, v39
    s_nop 0
    v_cvt_pk_bf16_f32 v99, v128, v129
    v_max3_f32 v28, v40, v41, v42
    v_max3_f32 v28, v28, v43, v44
    v_max3_f32 v28, v28, v45, v46
    v_max_f32 v28, v28, v47
    v_mov_b32 v29, v28
    s_nop 1
    v_permlane32_swap_b32 v29, v28
    v_max_f32 v28, v28, v29
    v_mov_b32 v29, v28
    s_nop 1
    v_permlane16_swap_b32 v29, v28
    v_max_f32 v28, v28, v29
    v_max_f32 v30, 0, v28
    v_sub_f32 v17, v17, v30
    v_sub_f32 v31, 0, v30
    v_exp_f32 v31, v31
    s_nop 0
    v_mul_f32 v25, v25, v31
    v_mul_f32 v208, v208, v31
    v_mul_f32 v209, v209, v31
    v_mul_f32 v210, v210, v31
    v_mul_f32 v211, v211, v31
    v_mul_f32 v212, v212, v31
    v_mul_f32 v213, v213, v31
    v_mul_f32 v214, v214, v31
    v_mul_f32 v215, v215, v31
    v_mul_f32 v216, v216, v31
    v_mul_f32 v217, v217, v31
    v_mul_f32 v218, v218, v31
    v_mul_f32 v219, v219, v31
    v_mul_f32 v220, v220, v31
    v_mul_f32 v221, v221, v31
    v_mul_f32 v222, v222, v31
    v_mul_f32 v223, v223, v31
    v_mul_f32 v224, v224, v31
    v_mul_f32 v225, v225, v31
    v_mul_f32 v226, v226, v31
    v_mul_f32 v227, v227, v31
    v_mul_f32 v228, v228, v31
    v_mul_f32 v229, v229, v31
    v_mul_f32 v230, v230, v31
    v_mul_f32 v231, v231, v31
    v_mul_f32 v232, v232, v31
    v_mul_f32 v233, v233, v31
    v_mul_f32 v234, v234, v31
    v_mul_f32 v235, v235, v31
    v_mul_f32 v236, v236, v31
    v_mul_f32 v237, v237, v31
    v_mul_f32 v238, v238, v31
    v_mul_f32 v239, v239, v31
    v_mul_f32 v240, v240, v31
    v_mul_f32 v241, v241, v31
    v_mul_f32 v242, v242, v31
    v_mul_f32 v243, v243, v31
    v_mul_f32 v244, v244, v31
    v_mul_f32 v245, v245, v31
    v_mul_f32 v246, v246, v31
    v_mul_f32 v247, v247, v31
    v_mul_f32 v248, v248, v31
    v_mul_f32 v249, v249, v31
    v_mul_f32 v250, v250, v31
    v_mul_f32 v251, v251, v31
    v_mul_f32 v252, v252, v31
    v_mul_f32 v253, v253, v31
    v_mul_f32 v254, v254, v31
    v_mul_f32 v255, v255, v31
    v_sub_f32 v40, v40, v30
    v_sub_f32 v41, v41, v30
    v_exp_f32 v128, v40
    v_exp_f32 v129, v41
    s_nop 0
    v_cvt_pk_bf16_f32 v100, v128, v129
    v_sub_f32 v42, v42, v30
    v_sub_f32 v43, v43, v30
    v_exp_f32 v128, v42
    v_exp_f32 v129, v43
    s_nop 0
    v_cvt_pk_bf16_f32 v101, v128, v129
    v_sub_f32 v44, v44, v30
    v_sub_f32 v45, v45, v30
    v_exp_f32 v128, v44
    v_exp_f32 v129, v45
    s_nop 0
    v_cvt_pk_bf16_f32 v102, v128, v129
    v_sub_f32 v46, v46, v30
    v_sub_f32 v47, v47, v30
    v_exp_f32 v128, v46
    v_exp_f32 v129, v47
    s_nop 0
    v_cvt_pk_bf16_f32 v103, v128, v129
    v_max3_f32 v28, v48, v49, v50
    v_max3_f32 v28, v28, v51, v52
    v_max3_f32 v28, v28, v53, v54
    v_max_f32 v28, v28, v55
    v_mov_b32 v29, v28
    s_nop 1
    v_permlane32_swap_b32 v29, v28
    v_max_f32 v28, v28, v29
    v_mov_b32 v29, v28
    s_nop 1
    v_permlane16_swap_b32 v29, v28
    v_max_f32 v28, v28, v29
    v_max_f32 v30, 0, v28
    v_sub_f32 v18, v18, v30
    v_sub_f32 v31, 0, v30
    v_exp_f32 v31, v31
    s_nop 0
    v_mul_f32 v26, v26, v31
    v_accvgpr_read_b32 v132, a0
    v_accvgpr_read_b32 v133, a1
    v_accvgpr_read_b32 v134, a2
    v_accvgpr_read_b32 v135, a3
    v_mul_f32 v132, v132, v31
    v_mul_f32 v133, v133, v31
    v_mul_f32 v134, v134, v31
    v_mul_f32 v135, v135, v31
    v_accvgpr_write_b32 a0, v132
    v_accvgpr_write_b32 a1, v133
    v_accvgpr_write_b32 a2, v134
    v_accvgpr_write_b32 a3, v135
    v_accvgpr_read_b32 v132, a4
    v_accvgpr_read_b32 v133, a5
    v_accvgpr_read_b32 v134, a6
    v_accvgpr_read_b32 v135, a7
    v_mul_f32 v132, v132, v31
    v_mul_f32 v133, v133, v31
    v_mul_f32 v134, v134, v31
    v_mul_f32 v135, v135, v31
    v_accvgpr_write_b32 a4, v132
    v_accvgpr_write_b32 a5, v133
    v_accvgpr_write_b32 a6, v134
    v_accvgpr_write_b32 a7, v135
    v_accvgpr_read_b32 v132, a8
    v_accvgpr_read_b32 v133, a9
    v_accvgpr_read_b32 v134, a10
    v_accvgpr_read_b32 v135, a11
    v_mul_f32 v132, v132, v31
    v_mul_f32 v133, v133, v31
    v_mul_f32 v134, v134, v31
    v_mul_f32 v135, v135, v31
    v_accvgpr_write_b32 a8, v132
    v_accvgpr_write_b32 a9, v133
    v_accvgpr_write_b32 a10, v134
    v_accvgpr_write_b32 a11, v135
    v_accvgpr_read_b32 v132, a12
    v_accvgpr_read_b32 v133, a13
    v_accvgpr_read_b32 v134, a14
    v_accvgpr_read_b32 v135, a15
    v_mul_f32 v132, v132, v31
    v_mul_f32 v133, v133, v31
    v_mul_f32 v134, v134, v31
    v_mul_f32 v135, v135, v31
    v_accvgpr_write_b32 a12, v132
    v_accvgpr_write_b32 a13, v133
    v_accvgpr_write_b32 a14, v134
    v_accvgpr_write_b32 a15, v135
    v_accvgpr_read_b32 v132, a16
    v_accvgpr_read_b32 v133, a17
    v_accvgpr_read_b32 v134, a18
    v_accvgpr_read_b32 v135, a19
    v_mul_f32 v132, v132, v31
    v_mul_f32 v133, v133, v31
    v_mul_f32 v134, v134, v31
    v_mul_f32 v135, v135, v31
    v_accvgpr_write_b32 a16, v132
    v_accvgpr_write_b32 a17, v133
    v_accvgpr_write_b32 a18, v134
    v_accvgpr_write_b32 a19, v135
    v_accvgpr_read_b32 v132, a20
    v_accvgpr_read_b32 v133, a21
    v_accvgpr_read_b32 v134, a22
    v_accvgpr_read_b32 v135, a23
    v_mul_f32 v132, v132, v31
    v_mul_f32 v133, v133, v31
    v_mul_f32 v134, v134, v31
    v_mul_f32 v135, v135, v31
    v_accvgpr_write_b32 a20, v132
    v_accvgpr_write_b32 a21, v133
    v_accvgpr_write_b32 a22, v134
    v_accvgpr_write_b32 a23, v135
    v_accvgpr_read_b32 v132, a24
    v_accvgpr_read_b32 v133, a25
    v_accvgpr_read_b32 v134, a26
    v_accvgpr_read_b32 v135, a27
    v_mul_f32 v132, v132, v31
    v_mul_f32 v133, v133, v31
    v_mul_f32 v134, v134, v31
    v_mul_f32 v135, v135, v31
    v_accvgpr_write_b32 a24, v132
    v_accvgpr_write_b32 a25, v133
    v_accvgpr_write_b32 a26, v134
    v_accvgpr_write_b32 a27, v135
    v_accvgpr_read_b32 v132, a28
    v_accvgpr_read_b32 v133, a29
    v_accvgpr_read_b32 v134, a30
    v_accvgpr_read_b32 v135, a31
    v_mul_f32 v132, v132, v31
    v_mul_f32 v133, v133, v31
    v_mul_f32 v134, v134, v31
    v_mul_f32 v135, v135, v31
    v_accvgpr_write_b32 a28, v132
    v_accvgpr_write_b32 a29, v133
    v_accvgpr_write_b32 a30, v134
    v_accvgpr_write_b32 a31, v135
    v_accvgpr_read_b32 v132, a32
    v_accvgpr_read_b32 v133, a33
    v_accvgpr_read_b32 v134, a34
    v_accvgpr_read_b32 v135, a35
    v_mul_f32 v132, v132, v31
    v_mul_f32 v133, v133, v31
    v_mul_f32 v134, v134, v31
    v_mul_f32 v135, v135, v31
    v_accvgpr_write_b32 a32, v132
    v_accvgpr_write_b32 a33, v133
    v_accvgpr_write_b32 a34, v134
    v_accvgpr_write_b32 a35, v135
    v_accvgpr_read_b32 v132, a36
    v_accvgpr_read_b32 v133, a37
    v_accvgpr_read_b32 v134, a38
    v_accvgpr_read_b32 v135, a39
    v_mul_f32 v132, v132, v31
    v_mul_f32 v133, v133, v31
    v_mul_f32 v134, v134, v31
    v_mul_f32 v135, v135, v31
    v_accvgpr_write_b32 a36, v132
    v_accvgpr_write_b32 a37, v133
    v_accvgpr_write_b32 a38, v134
    v_accvgpr_write_b32 a39, v135
    v_accvgpr_read_b32 v132, a40
    v_accvgpr_read_b32 v133, a41
    v_accvgpr_read_b32 v134, a42
    v_accvgpr_read_b32 v135, a43
    v_mul_f32 v132, v132, v31
    v_mul_f32 v133, v133, v31
    v_mul_f32 v134, v134, v31
    v_mul_f32 v135, v135, v31
    v_accvgpr_write_b32 a40, v132
    v_accvgpr_write_b32 a41, v133
    v_accvgpr_write_b32 a42, v134
    v_accvgpr_write_b32 a43, v135
    v_accvgpr_read_b32 v132, a44
    v_accvgpr_read_b32 v133, a45
    v_accvgpr_read_b32 v134, a46
    v_accvgpr_read_b32 v135, a47
    v_mul_f32 v132, v132, v31
    v_mul_f32 v133, v133, v31
    v_mul_f32 v134, v134, v31
    v_mul_f32 v135, v135, v31
    v_accvgpr_write_b32 a44, v132
    v_accvgpr_write_b32 a45, v133
    v_accvgpr_write_b32 a46, v134
    v_accvgpr_write_b32 a47, v135
    v_sub_f32 v48, v48, v30
    v_sub_f32 v49, v49, v30
    v_exp_f32 v128, v48
    v_exp_f32 v129, v49
    s_nop 0
    v_cvt_pk_bf16_f32 v104, v128, v129
    v_sub_f32 v50, v50, v30
    v_sub_f32 v51, v51, v30
    v_exp_f32 v128, v50
    v_exp_f32 v129, v51
    s_nop 0
    v_cvt_pk_bf16_f32 v105, v128, v129
    v_sub_f32 v52, v52, v30
    v_sub_f32 v53, v53, v30
    v_exp_f32 v128, v52
    v_exp_f32 v129, v53
    s_nop 0
    v_cvt_pk_bf16_f32 v106, v128, v129
    v_sub_f32 v54, v54, v30
    v_sub_f32 v55, v55, v30
    v_exp_f32 v128, v54
    v_exp_f32 v129, v55
    s_nop 0
    v_cvt_pk_bf16_f32 v107, v128, v129
    v_mfma_f32_16x16x32_bf16 v[20:23], a[240:243], v[96:99], v[24:27]
    v_mfma_f32_16x16x32_bf16 v[20:23], a[244:247], v[100:103], v[20:23]
    v_mfma_f32_16x16x32_bf16 v[20:23], a[248:251], v[104:107], v[20:23]
    s_nop 15
    s_setpc_b64 s[40:41]
L_rare3_1:
    s_nop 15
    v_max3_f32 v28, v64, v65, v66
    v_max3_f32 v28, v28, v67, v68
    v_max3_f32 v28, v28, v69, v70
    v_max_f32 v28, v28, v71
    v_mov_b32 v29, v28
    s_nop 1
    v_permlane32_swap_b32 v29, v28
    v_max_f32 v28, v28, v29
    v_mov_b32 v29, v28
    s_nop 1
    v_permlane16_swap_b32 v29, v28
    v_max_f32 v28, v28, v29
    v_max_f32 v30, 0, v28
    v_sub_f32 v16, v16, v30
    v_sub_f32 v31, 0, v30
    v_exp_f32 v31, v31
    s_nop 0
    v_mul_f32 v20, v20, v31
    v_cndmask_b32_e64 v20, v20, 0, s[46:47]
    v_mul_f32 v160, v160, v31
    v_mul_f32 v161, v161, v31
    v_mul_f32 v162, v162, v31
    v_mul_f32 v163, v163, v31
    v_mul_f32 v164, v164, v31
    v_mul_f32 v165, v165, v31
    v_mul_f32 v166, v166, v31
    v_mul_f32 v167, v167, v31
    v_mul_f32 v168, v168, v31
    v_mul_f32 v169, v169, v31
    v_mul_f32 v170, v170, v31
    v_mul_f32 v171, v171, v31
    v_mul_f32 v172, v172, v31
    v_mul_f32 v173, v173, v31
    v_mul_f32 v174, v174, v31
    v_mul_f32 v175, v175, v31
    v_mul_f32 v176, v176, v31
    v_mul_f32 v177, v177, v31
    v_mul_f32 v178, v178, v31
    v_mul_f32 v179, v179, v31
    v_mul_f32 v180, v180, v31
    v_mul_f32 v181, v181, v31
    v_mul_f32 v182, v182, v31
    v_mul_f32 v183, v183, v31
    v_mul_f32 v184, v184, v31
    v_mul_f32 v185, v185, v31
    v_mul_f32 v186, v186, v31
    v_mul_f32 v187, v187, v31
    v_mul_f32 v188, v188, v31
    v_mul_f32 v189, v189, v31
    v_mul_f32 v190, v190, v31
    v_mul_f32 v191, v191, v31
    v_mul_f32 v192, v192, v31
    v_mul_f32 v193, v193, v31
    v_mul_f32 v194, v194, v31
    v_mul_f32 v195, v195, v31
    v_mul_f32 v196, v196, v31
    v_mul_f32 v197, v197, v31
    v_mul_f32 v198, v198, v31
    v_mul_f32 v199, v199, v31
    v_mul_f32 v200, v200, v31
    v_mul_f32 v201, v201, v31
    v_mul_f32 v202, v202, v31
    v_mul_f32 v203, v203, v31
    v_mul_f32 v204, v204, v31
    v_mul_f32 v205, v205, v31
    v_mul_f32 v206, v206, v31
    v_mul_f32 v207, v207, v31
    v_sub_f32 v64, v64, v30
    v_sub_f32 v65, v65, v30
    v_exp_f32 v128, v64
    v_exp_f32 v129, v65
    s_nop 0
    v_cvt_pk_bf16_f32 v112, v128, v129
    v_sub_f32 v66, v66, v30
    v_sub_f32 v67, v67, v30
    v_exp_f32 v128, v66
    v_exp_f32 v129, v67
    s_nop 0
    v_cvt_pk_bf16_f32 v113, v128, v129
    v_sub_f32 v68, v68, v30
    v_sub_f32 v69, v69, v30
    v_exp_f32 v128, v68
    v_exp_f32 v129, v69
    s_nop 0
    v_cvt_pk_bf16_f32 v114, v128, v129
    v_sub_f32 v70, v70, v30
    v_sub_f32 v71, v71, v30
    v_exp_f32 v128, v70
    v_exp_f32 v129, v71
    s_nop 0
    v_cvt_pk_bf16_f32 v115, v128, v129
    v_max3_f32 v28, v72, v73, v74
    v_max3_f32 v28, v28, v75, v76
    v_max3_f32 v28, v28, v77, v78
    v_max_f32 v28, v28, v79
    v_mov_b32 v29, v28
    s_nop 1
    v_permlane32_swap_b32 v29, v28
    v_max_f32 v28, v28, v29
    v_mov_b32 v29, v28
    s_nop 1
    v_permlane16_swap_b32 v29, v28
    v_max_f32 v28, v28, v29
    v_max_f32 v30, 0, v28
    v_sub_f32 v17, v17, v30
    v_sub_f32 v31, 0, v30
    v_exp_f32 v31, v31
    s_nop 0
    v_mul_f32 v21, v21, v31
    v_mul_f32 v208, v208, v31
    v_mul_f32 v209, v209, v31
    v_mul_f32 v210, v210, v31
    v_mul_f32 v211, v211, v31
    v_mul_f32 v212, v212, v31
    v_mul_f32 v213, v213, v31
    v_mul_f32 v214, v214, v31
    v_mul_f32 v215, v215, v31
    v_mul_f32 v216, v216, v31
    v_mul_f32 v217, v217, v31
    v_mul_f32 v218, v218, v31
    v_mul_f32 v219, v219, v31
    v_mul_f32 v220, v220, v31
    v_mul_f32 v221, v221, v31
    v_mul_f32 v222, v222, v31
    v_mul_f32 v223, v223, v31
    v_mul_f32 v224, v224, v31
    v_mul_f32 v225, v225, v31
    v_mul_f32 v226, v226, v31
    v_mul_f32 v227, v227, v31
    v_mul_f32 v228, v228, v31
    v_mul_f32 v229, v229, v31
    v_mul_f32 v230, v230, v31
    v_mul_f32 v231, v231, v31
    v_mul_f32 v232, v232, v31
    v_mul_f32 v233, v233, v31
    v_mul_f32 v234, v234, v31
    v_mul_f32 v235, v235, v31
    v_mul_f32 v236, v236, v31
    v_mul_f32 v237, v237, v31
    v_mul_f32 v238, v238, v31
    v_mul_f32 v239, v239, v31
    v_mul_f32 v240, v240, v31
    v_mul_f32 v241, v241, v31
    v_mul_f32 v242, v242, v31
    v_mul_f32 v243, v243, v31
    v_mul_f32 v244, v244, v31
    v_mul_f32 v245, v245, v31
    v_mul_f32 v246, v246, v31
    v_mul_f32 v247, v247, v31
    v_mul_f32 v248, v248, v31
    v_mul_f32 v249, v249, v31
    v_mul_f32 v250, v250, v31
    v_mul_f32 v251, v251, v31
    v_mul_f32 v252, v252, v31
    v_mul_f32 v253, v253, v31
    v_mul_f32 v254, v254, v31
    v_mul_f32 v255, v255, v31
    v_sub_f32 v72, v72, v30
    v_sub_f32 v73, v73, v30
    v_exp_f32 v128, v72
    v_exp_f32 v129, v73
    s_nop 0
    v_cvt_pk_bf16_f32 v116, v128, v129
    v_sub_f32 v74, v74, v30
    v_sub_f32 v75, v75, v30
    v_exp_f32 v128, v74
    v_exp_f32 v129, v75
    s_nop 0
    v_cvt_pk_bf16_f32 v117, v128, v129
    v_sub_f32 v76, v76, v30
    v_sub_f32 v77, v77, v30
    v_exp_f32 v128, v76
    v_exp_f32 v129, v77
    s_nop 0
    v_cvt_pk_bf16_f32 v118, v128, v129
    v_sub_f32 v78, v78, v30
    v_sub_f32 v79, v79, v30
    v_exp_f32 v128, v78
    v_exp_f32 v129, v79
    s_nop 0
    v_cvt_pk_bf16_f32 v119, v128, v129
    v_max3_f32 v28, v80, v81, v82
    v_max3_f32 v28, v28, v83, v84
    v_max3_f32 v28, v28, v85, v86
    v_max_f32 v28, v28, v87
    v_mov_b32 v29, v28
    s_nop 1
    v_permlane32_swap_b32 v29, v28
    v_max_f32 v28, v28, v29
    v_mov_b32 v29, v28
    s_nop 1
    v_permlane16_swap_b32 v29, v28
    v_max_f32 v28, v28, v29
    v_max_f32 v30, 0, v28
    v_sub_f32 v18, v18, v30
    v_sub_f32 v31, 0, v30
    v_exp_f32 v31, v31
    s_nop 0
    v_mul_f32 v22, v22, v31
    v_accvgpr_read_b32 v132, a0
    v_accvgpr_read_b32 v133, a1
    v_accvgpr_read_b32 v134, a2
    v_accvgpr_read_b32 v135, a3
    v_mul_f32 v132, v132, v31
    v_mul_f32 v133, v133, v31
    v_mul_f32 v134, v134, v31
    v_mul_f32 v135, v135, v31
    v_accvgpr_write_b32 a0, v132
    v_accvgpr_write_b32 a1, v133
    v_accvgpr_write_b32 a2, v134
    v_accvgpr_write_b32 a3, v135
    v_accvgpr_read_b32 v132, a4
    v_accvgpr_read_b32 v133, a5
    v_accvgpr_read_b32 v134, a6
    v_accvgpr_read_b32 v135, a7
    v_mul_f32 v132, v132, v31
    v_mul_f32 v133, v133, v31
    v_mul_f32 v134, v134, v31
    v_mul_f32 v135, v135, v31
    v_accvgpr_write_b32 a4, v132
    v_accvgpr_write_b32 a5, v133
    v_accvgpr_write_b32 a6, v134
    v_accvgpr_write_b32 a7, v135
    v_accvgpr_read_b32 v132, a8
    v_accvgpr_read_b32 v133, a9
    v_accvgpr_read_b32 v134, a10
    v_accvgpr_read_b32 v135, a11
    v_mul_f32 v132, v132, v31
    v_mul_f32 v133, v133, v31
    v_mul_f32 v134, v134, v31
    v_mul_f32 v135, v135, v31
    v_accvgpr_write_b32 a8, v132
    v_accvgpr_write_b32 a9, v133
    v_accvgpr_write_b32 a10, v134
    v_accvgpr_write_b32 a11, v135
    v_accvgpr_read_b32 v132, a12
    v_accvgpr_read_b32 v133, a13
    v_accvgpr_read_b32 v134, a14
    v_accvgpr_read_b32 v135, a15
    v_mul_f32 v132, v132, v31
    v_mul_f32 v133, v133, v31
    v_mul_f32 v134, v134, v31
    v_mul_f32 v135, v135, v31
    v_accvgpr_write_b32 a12, v132
    v_accvgpr_write_b32 a13, v133
    v_accvgpr_write_b32 a14, v134
    v_accvgpr_write_b32 a15, v135
    v_accvgpr_read_b32 v132, a16
    v_accvgpr_read_b32 v133, a17
    v_accvgpr_read_b32 v134, a18
    v_accvgpr_read_b32 v135, a19
    v_mul_f32 v132, v132, v31
    v_mul_f32 v133, v133, v31
    v_mul_f32 v134, v134, v31
    v_mul_f32 v135, v135, v31
    v_accvgpr_write_b32 a16, v132
    v_accvgpr_write_b32 a17, v133
    v_accvgpr_write_b32 a18, v134
    v_accvgpr_write_b32 a19, v135
    v_accvgpr_read_b32 v132, a20
    v_accvgpr_read_b32 v133, a21
    v_accvgpr_read_b32 v134, a22
    v_accvgpr_read_b32 v135, a23
    v_mul_f32 v132, v132, v31
    v_mul_f32 v133, v133, v31
    v_mul_f32 v134, v134, v31
    v_mul_f32 v135, v135, v31
    v_accvgpr_write_b32 a20, v132
    v_accvgpr_write_b32 a21, v133
    v_accvgpr_write_b32 a22, v134
    v_accvgpr_write_b32 a23, v135
    v_accvgpr_read_b32 v132, a24
    v_accvgpr_read_b32 v133, a25
    v_accvgpr_read_b32 v134, a26
    v_accvgpr_read_b32 v135, a27
    v_mul_f32 v132, v132, v31
    v_mul_f32 v133, v133, v31
    v_mul_f32 v134, v134, v31
    v_mul_f32 v135, v135, v31
    v_accvgpr_write_b32 a24, v132
    v_accvgpr_write_b32 a25, v133
    v_accvgpr_write_b32 a26, v134
    v_accvgpr_write_b32 a27, v135
    v_accvgpr_read_b32 v132, a28
    v_accvgpr_read_b32 v133, a29
    v_accvgpr_read_b32 v134, a30
    v_accvgpr_read_b32 v135, a31
    v_mul_f32 v132, v132, v31
    v_mul_f32 v133, v133, v31
    v_mul_f32 v134, v134, v31
    v_mul_f32 v135, v135, v31
    v_accvgpr_write_b32 a28, v132
    v_accvgpr_write_b32 a29, v133
    v_accvgpr_write_b32 a30, v134
    v_accvgpr_write_b32 a31, v135
    v_accvgpr_read_b32 v132, a32
    v_accvgpr_read_b32 v133, a33
    v_accvgpr_read_b32 v134, a34
    v_accvgpr_read_b32 v135, a35
    v_mul_f32 v132, v132, v31
    v_mul_f32 v133, v133, v31
    v_mul_f32 v134, v134, v31
    v_mul_f32 v135, v135, v31
    v_accvgpr_write_b32 a32, v132
    v_accvgpr_write_b32 a33, v133
    v_accvgpr_write_b32 a34, v134
    v_accvgpr_write_b32 a35, v135
    v_accvgpr_read_b32 v132, a36
    v_accvgpr_read_b32 v133, a37
    v_accvgpr_read_b32 v134, a38
    v_accvgpr_read_b32 v135, a39
    v_mul_f32 v132, v132, v31
    v_mul_f32 v133, v133, v31
    v_mul_f32 v134, v134, v31
    v_mul_f32 v135, v135, v31
    v_accvgpr_write_b32 a36, v132
    v_accvgpr_write_b32 a37, v133
    v_accvgpr_write_b32 a38, v134
    v_accvgpr_write_b32 a39, v135
    v_accvgpr_read_b32 v132, a40
    v_accvgpr_read_b32 v133, a41
    v_accvgpr_read_b32 v134, a42
    v_accvgpr_read_b32 v135, a43
    v_mul_f32 v132, v132, v31
    v_mul_f32 v133, v133, v31
    v_mul_f32 v134, v134, v31
    v_mul_f32 v135, v135, v31
    v_accvgpr_write_b32 a40, v132
    v_accvgpr_write_b32 a41, v133
    v_accvgpr_write_b32 a42, v134
    v_accvgpr_write_b32 a43, v135
    v_accvgpr_read_b32 v132, a44
    v_accvgpr_read_b32 v133, a45
    v_accvgpr_read_b32 v134, a46
    v_accvgpr_read_b32 v135, a47
    v_mul_f32 v132, v132, v31
    v_mul_f32 v133, v133, v31
    v_mul_f32 v134, v134, v31
    v_mul_f32 v135, v135, v31
    v_accvgpr_write_b32 a44, v132
    v_accvgpr_write_b32 a45, v133
    v_accvgpr_write_b32 a46, v134
    v_accvgpr_write_b32 a47, v135
    v_sub_f32 v80, v80, v30
    v_sub_f32 v81, v81, v30
    v_exp_f32 v128, v80
    v_exp_f32 v129, v81
    s_nop 0
    v_cvt_pk_bf16_f32 v120, v128, v129
    v_sub_f32 v82, v82, v30
    v_sub_f32 v83, v83, v30
    v_exp_f32 v128, v82
    v_exp_f32 v129, v83
    s_nop 0
    v_cvt_pk_bf16_f32 v121, v128, v129
    v_sub_f32 v84, v84, v30
    v_sub_f32 v85, v85, v30
    v_exp_f32 v128, v84
    v_exp_f32 v129, v85
    s_nop 0
    v_cvt_pk_bf16_f32 v122, v128, v129
    v_sub_f32 v86, v86, v30
    v_sub_f32 v87, v87, v30
    v_exp_f32 v128, v86
    v_exp_f32 v129, v87
    s_nop 0
    v_cvt_pk_bf16_f32 v123, v128, v129
    v_mfma_f32_16x16x32_bf16 v[24:27], a[240:243], v[112:115], v[20:23]
    v_mfma_f32_16x16x32_bf16 v[24:27], a[244:247], v[116:119], v[24:27]
    v_mfma_f32_16x16x32_bf16 v[24:27], a[248:251], v[120:123], v[24:27]
    s_nop 15
    s_setpc_b64 s[40:41]
L_rs_start4b:
    s_call_b64 s[40:41], L_rare4_1
    s_branch L_ret_start4b
L_rs_loop4w0a:
    s_call_b64 s[40:41], L_rare4_0
    s_branch L_ret_loop4w0a
L_rs_loop4w0b:
    s_call_b64 s[40:41], L_rare4_1
    s_branch L_ret_loop4w0b
L_rs_loop4w1a:
    s_call_b64 s[40:41], L_rare4_0
    s_branch L_ret_loop4w1a
L_rs_loop4w1b:
    s_call_b64 s[40:41], L_rare4_1
    s_branch L_ret_loop4w1b
L_rs_end4a:
    s_call_b64 s[40:41], L_rare4_0
    s_branch L_ret_end4a
L_rs_end4b:
    s_call_b64 s[40:41], L_rare4_1
    s_branch L_ret_end4b
L_rs_start3b:
    s_call_b64 s[40:41], L_rare3_1
    s_branch L_ret_start3b
L_rs_loop3w0a:
    s_call_b64 s[40:41], L_rare3_0
    s_branch L_ret_loop3w0a
L_rs_loop3w0b:
    s_call_b64 s[40:41], L_rare3_1
    s_branch L_ret_loop3w0b
L_rs_loop3w1a:
    s_call_b64 s[40:41], L_rare3_0
    s_branch L_ret_loop3w1a
L_rs_loop3w1b:
    s_call_b64 s[40:41], L_rare3_1
    s_branch L_ret_loop3w1b
L_rs_end3a:
    s_call_b64 s[40:41], L_rare3_0
    s_branch L_ret_end3a
L_rs_end3b:
    s_call_b64 s[40:41], L_rare3_1
    s_branch L_ret_end3b
L_rs_tr43a:
    s_call_b64 s[40:41], L_rare4_0
    s_branch L_ret_tr43a
L_rs_tr43b:
    s_call_b64 s[40:41], L_rare4_1
    s_branch L_ret_tr43b
L_rs_tr43d:
    s_call_b64 s[40:41], L_rare3_1
    s_branch L_ret_tr43d
L_rs_tr34a:
    s_call_b64 s[40:41], L_rare3_0
    s_branch L_ret_tr34a
L_rs_tr34b:
    s_call_b64 s[40:41], L_rare3_1
    s_branch L_ret_tr34b
L_rs_tr34d:
    s_call_b64 s[40:41], L_rare4_1
    s_branch L_ret_tr34d
L_rs_tr33a:
    s_call_b64 s[40:41], L_rare3_0
    s_branch L_ret_tr33a
L_rs_tr33b:
    s_call_b64 s[40:41], L_rare3_1
    s_branch L_ret_tr33b
L_rs_tr33d:
    s_call_b64 s[40:41], L_rare3_1
    s_branch L_ret_tr33d
L_rs_tr44a:
    s_call_b64 s[40:41], L_rare4_0
    s_branch L_ret_tr44a
L_rs_tr44b:
    s_call_b64 s[40:41], L_rare4_1
    s_branch L_ret_tr44b
L_rs_tr44d:
    s_call_b64 s[40:41], L_rare4_1
    s_branch L_ret_tr44d
.section .rodata,"a"
.p2align 6
.amdhsa_kernel standalone__gqa_softmax__near_ridge_kernel
  .amdhsa_next_free_vgpr 512
  .amdhsa_next_free_sgpr 102
  .amdhsa_accum_offset 256
  .amdhsa_group_segment_fixed_size 0
  .amdhsa_kernarg_size 48
  .amdhsa_user_sgpr_count 2
  .amdhsa_user_sgpr_kernarg_segment_ptr 1
  .amdhsa_system_sgpr_workgroup_id_x 1
.end_amdhsa_kernel
```

```asm
; @launch grid=(256,1,1) block=(256,1,1) lds=147456
.amdgcn_target "amdgcn-amd-amdhsa--gfx950"
.text
.globl standalone__gqa_softmax__near_ridge_kernel
.p2align 8
.type standalone__gqa_softmax__near_ridge_kernel,@function
standalone__gqa_softmax__near_ridge_kernel:
    s_cmp_ge_u32 s2, 256
    s_cbranch_scc1 L_end
    s_load_dwordx4 s[84:87], s[0:1], 0
    s_load_dwordx4 s[88:91], s[0:1], 16
    s_getpc_b64 s[60:61]
L_pc:
    v_lshrrev_b32 v28, 6, v0
    s_lshr_b32 s62, s2, 3
    v_and_b32 v0, 63, v0
    v_lshl_add_u32 v146, s62, 2, v28
    v_min_u32 v144, ((L_codeend-L_pc+16383)/16384)-1, v0
    v_mul_u32_u24 v146, ((L_codeend-L_pc+16383)/16384), v146
    v_add_lshl_u32 v144, v144, v146, 7
    v_min_u32 v144, L_codeend-L_pc-4, v144
    global_load_dword v145, v144, s[60:61]
    v_readfirstlane_b32 s3, v28
    v_lshrrev_b32 v128, 3, v0
    v_mul_u32_u24 v10, 384, v128
    v_lshrrev_b32 v129, 1, v128
    v_lshlrev_b32 v129, 1, v129
    v_and_b32 v130, 7, v0
    v_xor_b32 v129, v129, v130
    v_lshl_add_u32 v10, v129, 4, v10
    s_and_b32 s42, s3, 1
    s_mul_i32 s42, s42, 80
    v_xor_b32 v9, s42, v10
    v_xor_b32 v11, 80, v10
    v_add_u32 v11, 3072, v11
    s_mov_b32 s28, 0x3dd53b95
    s_mov_b32 s29, 0x47800000
    s_mov_b32 s49, 6016
    s_mov_b32 s39, 4096
    s_mov_b32 s46, 0
    s_mov_b32 s47, 0xffff0000
    s_and_b32 s42, s2, 7
    s_lshr_b32 s43, s2, 3
    s_and_b32 s36, s43, 3
    s_lshr_b32 s43, s43, 2
    s_lshl_b32 s42, s42, 3
    s_add_u32 s42, s42, s43
    s_lshl_b32 s44, s42, 3
    s_mul_i32 s45, s44, 196608
    s_mul_i32 s35, s44, 325632
    s_mul_i32 s22, s3, 3072
    s_mul_i32 s38, s3, 24576
    s_add_u32 s38, s38, 49152
    s_add_u32 s20, s45, s22
    s_mov_b32 s21, s20
    s_add_u32 s6, s45, 1572864
    s_mov_b32 s10, s6
    s_mov_b32 s14, 166723584
    s_mov_b32 s18, 0
    s_mov_b32 s24, 128
    s_mov_b32 s37, 0
    s_mov_b32 s60, 0xe11e7b24
    s_mov_b32 s61, 0x1b87b44b
    s_mov_b32 s62, 0xcb49e724
    s_mov_b32 s63, 0x2e71b613
    s_lshr_b32 s42, s43, 1
    s_cmp_eq_u32 s42, 1
    s_cselect_b32 s60, s61, s60
    s_cmp_eq_u32 s42, 2
    s_cselect_b32 s60, s62, s60
    s_cmp_eq_u32 s42, 3
    s_cselect_b32 s60, s63, s60
    s_and_b32 s42, s43, 1
    s_lshl_b32 s42, s42, 4
    s_lshr_b32 s31, s60, s42
    s_lshl_b32 s42, s37, 1
    s_lshr_b32 s42, s31, s42
    s_xor_b32 s42, s42, s36
    s_and_b32 s42, s42, 3
    s_mul_i32 s43, s3, 3
    s_lshl_b32 s44, s3, 2
    s_mov_b32 s32, 1
    s_add_u32 s45, s43, 17
    s_cmp_eq_u32 s3, 0
    s_cselect_b32 s45, 16, s45
    s_cselect_b32 s34, 1, 0
    s_cmp_eq_u32 s42, 1
    s_cselect_b32 s44, s45, s44
    s_cselect_b32 s32, s34, s32
    s_add_u32 s45, s43, 29
    s_cmp_eq_u32 s42, 2
    s_cselect_b32 s44, s45, s44
    s_cselect_b32 s32, 0, s32
    s_add_u32 s45, s43, 41
    s_cmp_eq_u32 s42, 3
    s_cselect_b32 s44, s45, s44
    s_cselect_b32 s32, 0, s32
    s_mul_i32 s44, s44, 6144
    s_add_u32 s34, s35, s44
    s_waitcnt lgkmcnt(0)
    s_mov_b32 s12, s84
    s_and_b32 s13, s85, 0xffff
    s_mov_b32 s15, 0x20000
    s_mov_b32 s4, s86
    s_and_b32 s5, s87, 0xffff
    s_mov_b32 s7, 0x20000
    s_mov_b32 s8, s88
    s_and_b32 s9, s89, 0xffff
    s_mov_b32 s11, 0x20000
    s_mov_b32 s16, s90
    s_and_b32 s17, s91, 0xffff
    s_mov_b32 s19, 0x20000
    s_cmp_eq_u32 s32, 0
    s_cbranch_scc1 L_start3
L_start4:
    s_add_u32 m0, s22, 0
    s_nop 0
    buffer_load_dwordx4 v9, s[4:7], s20 offen lds
    s_add_u32 s20, s20, 128
    s_add_u32 m0, s22, 1024
    s_nop 0
    buffer_load_dwordx4 v9, s[4:7], s20 offen lds
    s_add_u32 s20, s20, 128
    s_add_u32 m0, s22, 2048
    s_nop 0
    buffer_load_dwordx4 v9, s[4:7], s20 offen lds
    s_add_u32 s20, s20, 12032
    s_add_u32 s48, s34, 0
    s_add_u32 m0, s38, 0
    s_nop 0
    buffer_load_dwordx4 v10, s[12:15], s48 offen nt lds
    s_add_u32 m0, s38, 1024
    s_nop 0
    buffer_load_dwordx4 v11, s[12:15], s48 offen nt lds
    s_add_u32 s48, s34, 128
    s_add_u32 m0, s38, 2048
    s_nop 0
    buffer_load_dwordx4 v10, s[12:15], s48 offen nt lds
    s_add_u32 m0, s38, 3072
    s_nop 0
    buffer_load_dwordx4 v11, s[12:15], s48 offen nt lds
    s_add_u32 s48, s34, 256
    s_add_u32 m0, s38, 4096
    s_nop 0
    buffer_load_dwordx4 v10, s[12:15], s48 offen nt lds
    s_add_u32 m0, s38, 5120
    s_nop 0
    buffer_load_dwordx4 v11, s[12:15], s48 offen nt lds
    s_add_u32 s48, s34, 6144
    s_add_u32 m0, s38, 6144
    s_nop 0
    buffer_load_dwordx4 v10, s[12:15], s48 offen nt lds
    s_add_u32 m0, s38, 7168
    s_nop 0
    buffer_load_dwordx4 v11, s[12:15], s48 offen nt lds
    s_add_u32 s48, s34, 6272
    s_add_u32 m0, s38, 8192
    s_nop 0
    buffer_load_dwordx4 v10, s[12:15], s48 offen nt lds
    s_add_u32 m0, s38, 9216
    s_nop 0
    buffer_load_dwordx4 v11, s[12:15], s48 offen nt lds
    s_add_u32 s48, s34, 6400
    s_add_u32 m0, s38, 10240
    s_nop 0
    buffer_load_dwordx4 v10, s[12:15], s48 offen nt lds
    s_add_u32 m0, s38, 11264
    s_nop 0
    buffer_load_dwordx4 v11, s[12:15], s48 offen nt lds
    v_and_b32 v128, 15, v0
    v_lshrrev_b32 v129, 4, v0
    v_lshrrev_b32 v130, 3, v128
    v_and_b32 v131, 7, v128
    v_lshlrev_b32 v1, 7, v131
    v_bfe_u32 v131, v128, 1, 2
    v_lshlrev_b32 v131, 1, v131
    v_mul_u32_u24 v132, 5, v130
    v_xor_b32 v131, v131, v132
    v_xor_b32 v131, v131, v129
    v_lshl_add_u32 v1, v131, 4, v1
    v_lshl_add_u32 v7, v130, 10, v1
    v_add_u32 v7, s38, v7
    v_mul_u32_u24 v132, 3072, v130
    v_add_u32 v1, v132, v1
    v_xor_b32 v2, 64, v1
    v_xor_b32 v8, 64, v7
    v_lshrrev_b32 v130, 1, v129
    v_mul_u32_u24 v3, 3072, v130
    v_and_b32 v131, 1, v129
    v_bfe_u32 v132, v0, 2, 2
    v_lshl_add_u32 v128, v131, 2, v132
    v_lshl_add_u32 v3, v128, 7, v3
    v_lshrrev_b32 v128, 1, v128
    v_lshlrev_b32 v128, 1, v128
    v_mul_u32_u24 v130, 5, v130
    v_xor_b32 v128, v128, v130
    v_bfe_u32 v131, v0, 1, 1
    v_xor_b32 v128, v128, v131
    v_lshl_add_u32 v3, v128, 4, v3
    v_and_b32 v131, 1, v0
    v_lshl_add_u32 v3, v131, 3, v3
    v_add_u32 v3, 24576, v3
    v_xor_b32 v4, 32, v3
    v_xor_b32 v5, 64, v3
    v_xor_b32 v6, 96, v3
    v_lshrrev_b32 v128, 3, v0
    v_and_b32 v129, 15, v0
    v_lshrrev_b32 v130, 4, v0
    v_lshrrev_b32 v131, 1, v130
    v_and_b32 v132, 7, v129
    v_xor_b32 v131, v131, v132
    v_lshlrev_b32 v14, 7, v129
    v_lshl_add_u32 v14, v131, 4, v14
    v_and_b32 v130, 1, v130
    v_lshl_add_u32 v14, v130, 3, v14
    v_add_u32 v14, s38, v14
    v_and_b32 v129, 7, v0
    v_xor_b32 v130, v129, v128
    v_lshlrev_b32 v13, 7, v128
    v_lshl_add_u32 v13, v130, 4, v13
    v_add_u32 v13, s38, v13
    v_add_u32 v13, 2048, v13
    v_mul_u32_u24 v12, 384, v128
    v_lshl_add_u32 v12, v129, 4, v12
    v_and_b32 v128, 15, v0
    v_and_b32 v129, 3, v0
    v_mov_b32 v131, 0x3f803f80
    v_cmp_eq_u32 s[42:43], 12, v128
    v_cmp_eq_u32 vcc, 0, v129
    s_nop 3
    s_or_b64 vcc, vcc, s[42:43]
    v_cndmask_b32 v130, 0, v131, vcc
    v_accvgpr_write_b32 a240, v130
    v_accvgpr_write_b32 a241, v130
    v_accvgpr_write_b32 a242, v130
    v_accvgpr_write_b32 a243, v130
    v_cmp_eq_u32 vcc, 1, v129
    s_nop 3
    s_or_b64 vcc, vcc, s[42:43]
    v_cndmask_b32 v130, 0, v131, vcc
    v_accvgpr_write_b32 a244, v130
    v_accvgpr_write_b32 a245, v130
    v_accvgpr_write_b32 a246, v130
    v_accvgpr_write_b32 a247, v130
    v_cmp_eq_u32 vcc, 2, v129
    s_nop 3
    s_or_b64 vcc, vcc, s[42:43]
    v_cndmask_b32 v130, 0, v131, vcc
    v_accvgpr_write_b32 a248, v130
    v_accvgpr_write_b32 a249, v130
    v_accvgpr_write_b32 a250, v130
    v_accvgpr_write_b32 a251, v130
    v_cmp_eq_u32 vcc, 3, v129
    s_nop 3
    s_or_b64 vcc, vcc, s[42:43]
    v_cndmask_b32 v130, 0, v131, vcc
    v_accvgpr_write_b32 a252, v130
    v_accvgpr_write_b32 a253, v130
    v_accvgpr_write_b32 a254, v130
    v_accvgpr_write_b32 a255, v130
    s_waitcnt vmcnt(12)
    s_barrier
    ds_read_b128 a[192:195], v1 offset:0
    ds_read_b128 a[196:199], v2 offset:0
    ds_read_b128 a[200:203], v1 offset:1024
    ds_read_b128 a[204:207], v2 offset:1024
    ds_read_b128 a[208:211], v1 offset:2048
    ds_read_b128 a[212:215], v2 offset:2048
    ds_read_b128 a[216:219], v1 offset:6144
    ds_read_b128 a[220:223], v2 offset:6144
    ds_read_b128 a[224:227], v1 offset:7168
    ds_read_b128 a[228:231], v2 offset:7168
    ds_read_b128 a[232:235], v1 offset:8192
    ds_read_b128 a[236:239], v2 offset:8192
    s_waitcnt vmcnt(6)
    ds_read_b128 a[96:99], v7 offset:0
    s_add_u32 s48, s34, 12288
    s_add_u32 m0, s38, 12288
    ds_read_b128 a[100:103], v8 offset:0
    ds_read_b128 a[104:107], v7 offset:2048
    ds_read_b128 a[108:111], v8 offset:2048
    ds_read_b128 a[112:115], v7 offset:4096
    ds_read_b128 a[116:119], v8 offset:4096
    s_waitcnt lgkmcnt(5)
    v_mfma_f32_16x16x32_bf16 v[32:35], a[192:195], a[96:99], 0
    buffer_load_dwordx4 v10, s[12:15], s48 offen nt lds
    s_add_u32 m0, s38, 13312
    s_waitcnt lgkmcnt(4)
    v_mfma_f32_16x16x32_bf16 v[32:35], a[196:199], a[100:103], v[32:35]
    buffer_load_dwordx4 v11, s[12:15], s48 offen nt lds
    s_add_u32 s48, s34, 12416
    s_add_u32 m0, s38, 14336
    s_waitcnt lgkmcnt(3)
    v_mfma_f32_16x16x32_bf16 v[32:35], a[200:203], a[104:107], v[32:35]
    buffer_load_dwordx4 v10, s[12:15], s48 offen nt lds
    s_add_u32 m0, s38, 15360
    s_waitcnt lgkmcnt(2)
    v_mfma_f32_16x16x32_bf16 v[32:35], a[204:207], a[108:111], v[32:35]
    buffer_load_dwordx4 v11, s[12:15], s48 offen nt lds
    s_add_u32 s48, s34, 12544
    s_add_u32 m0, s38, 16384
    s_waitcnt lgkmcnt(1)
    v_mfma_f32_16x16x32_bf16 v[32:35], a[208:211], a[112:115], v[32:35]
    buffer_load_dwordx4 v10, s[12:15], s48 offen nt lds
    s_add_u32 m0, s38, 17408
    s_waitcnt lgkmcnt(0)
    v_mfma_f32_16x16x32_bf16 v[32:35], a[212:215], a[116:119], v[32:35]
    buffer_load_dwordx4 v11, s[12:15], s48 offen nt lds
    s_add_u32 s48, s34, 18432
    s_add_u32 m0, s38, 18432
    v_mfma_f32_16x16x32_bf16 v[36:39], a[216:219], a[96:99], 0
    v_mfma_f32_16x16x32_bf16 v[36:39], a[220:223], a[100:103], v[36:39]
    v_mfma_f32_16x16x32_bf16 v[36:39], a[224:227], a[104:107], v[36:39]
    v_mfma_f32_16x16x32_bf16 v[36:39], a[228:231], a[108:111], v[36:39]
    v_mfma_f32_16x16x32_bf16 v[36:39], a[232:235], a[112:115], v[36:39]
    v_mfma_f32_16x16x32_bf16 v[36:39], a[236:239], a[116:119], v[36:39]
    s_waitcnt vmcnt(6)
    ds_read_b128 a[120:123], v7 offset:6144
    ds_read_b128 a[124:127], v8 offset:6144
    ds_read_b128 a[128:131], v7 offset:8192
    ds_read_b128 a[132:135], v8 offset:8192
    ds_read_b128 a[136:139], v7 offset:10240
    ds_read_b128 a[140:143], v8 offset:10240
    s_waitcnt lgkmcnt(5)
    v_mfma_f32_16x16x32_bf16 v[40:43], a[192:195], a[120:123], 0
    buffer_load_dwordx4 v10, s[12:15], s48 offen nt lds
    s_add_u32 m0, s38, 19456
    s_waitcnt lgkmcnt(4)
    v_mfma_f32_16x16x32_bf16 v[40:43], a[196:199], a[124:127], v[40:43]
    buffer_load_dwordx4 v11, s[12:15], s48 offen nt lds
    s_add_u32 s48, s34, 18560
    s_add_u32 m0, s38, 20480
    s_waitcnt lgkmcnt(3)
    v_mfma_f32_16x16x32_bf16 v[40:43], a[200:203], a[128:131], v[40:43]
    buffer_load_dwordx4 v10, s[12:15], s48 offen nt lds
    s_add_u32 m0, s38, 21504
    s_waitcnt lgkmcnt(2)
    v_mfma_f32_16x16x32_bf16 v[40:43], a[204:207], a[132:135], v[40:43]
    buffer_load_dwordx4 v11, s[12:15], s48 offen nt lds
    s_add_u32 s48, s34, 18688
    s_add_u32 m0, s38, 22528
    s_waitcnt lgkmcnt(1)
    v_mfma_f32_16x16x32_bf16 v[40:43], a[208:211], a[136:139], v[40:43]
    buffer_load_dwordx4 v10, s[12:15], s48 offen nt lds
    s_add_u32 m0, s38, 23552
    s_waitcnt lgkmcnt(0)
    v_mfma_f32_16x16x32_bf16 v[40:43], a[212:215], a[140:143], v[40:43]
    buffer_load_dwordx4 v11, s[12:15], s48 offen nt lds
    s_add_u32 m0, s22, 12288
    v_mfma_f32_16x16x32_bf16 v[44:47], a[216:219], a[120:123], 0
    v_mfma_f32_16x16x32_bf16 v[44:47], a[220:223], a[124:127], v[44:47]
    v_mfma_f32_16x16x32_bf16 v[44:47], a[224:227], a[128:131], v[44:47]
    v_mfma_f32_16x16x32_bf16 v[44:47], a[228:231], a[132:135], v[44:47]
    v_mfma_f32_16x16x32_bf16 v[44:47], a[232:235], a[136:139], v[44:47]
    v_mfma_f32_16x16x32_bf16 v[44:47], a[236:239], a[140:143], v[44:47]
    s_waitcnt vmcnt(6)
    ds_read_b128 a[144:147], v7 offset:12288
    ds_read_b128 a[148:151], v8 offset:12288
    ds_read_b128 a[152:155], v7 offset:14336
    ds_read_b128 a[156:159], v8 offset:14336
    ds_read_b128 a[160:163], v7 offset:16384
    ds_read_b128 a[164:167], v8 offset:16384
    s_waitcnt lgkmcnt(5)
    v_mfma_f32_16x16x32_bf16 v[48:51], a[192:195], a[144:147], 0
    buffer_load_dwordx4 v9, s[4:7], s20 offen lds
    s_add_u32 s20, s20, 128
    s_add_u32 m0, s22, 13312
    s_waitcnt lgkmcnt(4)
    v_mfma_f32_16x16x32_bf16 v[48:51], a[196:199], a[148:151], v[48:51]
    buffer_load_dwordx4 v9, s[4:7], s20 offen lds
    s_add_u32 s20, s20, 128
    s_add_u32 m0, s22, 14336
    s_waitcnt lgkmcnt(3)
    v_mfma_f32_16x16x32_bf16 v[48:51], a[200:203], a[152:155], v[48:51]
    buffer_load_dwordx4 v9, s[4:7], s20 offen lds
    s_add_u32 s20, s20, 12032
    s_add_u32 m0, s22, 24576
    s_waitcnt lgkmcnt(2)
    v_mfma_f32_16x16x32_bf16 v[48:51], a[204:207], a[156:159], v[48:51]
    s_waitcnt lgkmcnt(1)
    v_mfma_f32_16x16x32_bf16 v[48:51], a[208:211], a[160:163], v[48:51]
    s_waitcnt lgkmcnt(0)
    v_mfma_f32_16x16x32_bf16 v[48:51], a[212:215], a[164:167], v[48:51]
    v_mfma_f32_16x16x32_bf16 v[52:55], a[216:219], a[144:147], 0
    v_mfma_f32_16x16x32_bf16 v[52:55], a[220:223], a[148:151], v[52:55]
    v_mfma_f32_16x16x32_bf16 v[52:55], a[224:227], a[152:155], v[52:55]
    v_mfma_f32_16x16x32_bf16 v[52:55], a[228:231], a[156:159], v[52:55]
    v_mfma_f32_16x16x32_bf16 v[52:55], a[232:235], a[160:163], v[52:55]
    v_mfma_f32_16x16x32_bf16 v[52:55], a[236:239], a[164:167], v[52:55]
    s_waitcnt vmcnt(3)
    ds_read_b128 a[168:171], v7 offset:18432
    ds_read_b128 a[172:175], v8 offset:18432
    ds_read_b128 a[176:179], v7 offset:20480
    ds_read_b128 a[180:183], v8 offset:20480
    ds_read_b128 a[184:187], v7 offset:22528
    ds_read_b128 a[188:191], v8 offset:22528
    s_waitcnt lgkmcnt(5)
    v_mfma_f32_16x16x32_bf16 v[56:59], a[192:195], a[168:171], 0
    buffer_load_dwordx4 v9, s[8:11], s21 offen lds
    s_add_u32 s21, s21, 128
    s_add_u32 m0, s22, 25600
    s_waitcnt lgkmcnt(4)
    v_mfma_f32_16x16x32_bf16 v[56:59], a[196:199], a[172:175], v[56:59]
    buffer_load_dwordx4 v9, s[8:11], s21 offen lds
    s_add_u32 s21, s21, 128
    s_add_u32 m0, s22, 26624
    s_waitcnt lgkmcnt(3)
    v_mfma_f32_16x16x32_bf16 v[56:59], a[200:203], a[176:179], v[56:59]
    buffer_load_dwordx4 v9, s[8:11], s21 offen lds
    s_add_u32 s21, s21, 12032
    s_add_u32 m0, s22, 36864
    s_waitcnt lgkmcnt(2)
    v_mfma_f32_16x16x32_bf16 v[56:59], a[204:207], a[180:183], v[56:59]
    buffer_load_dwordx4 v9, s[8:11], s21 offen lds
    s_add_u32 s21, s21, 128
    s_add_u32 m0, s22, 37888
    s_waitcnt lgkmcnt(1)
    v_mfma_f32_16x16x32_bf16 v[56:59], a[208:211], a[184:187], v[56:59]
    buffer_load_dwordx4 v9, s[8:11], s21 offen lds
    s_add_u32 s21, s21, 128
    s_add_u32 m0, s22, 38912
    s_waitcnt lgkmcnt(0)
    v_mfma_f32_16x16x32_bf16 v[56:59], a[212:215], a[188:191], v[56:59]
    buffer_load_dwordx4 v9, s[8:11], s21 offen lds
    s_add_u32 s21, s21, 12032
    v_mfma_f32_16x16x32_bf16 v[60:63], a[216:219], a[168:171], 0
    v_mfma_f32_16x16x32_bf16 v[60:63], a[220:223], a[172:175], v[60:63]
    v_mfma_f32_16x16x32_bf16 v[60:63], a[224:227], a[176:179], v[60:63]
    v_mfma_f32_16x16x32_bf16 v[60:63], a[228:231], a[180:183], v[60:63]
    v_mfma_f32_16x16x32_bf16 v[60:63], a[232:235], a[184:187], v[60:63]
    v_mfma_f32_16x16x32_bf16 v[60:63], a[236:239], a[188:191], v[60:63]
    s_waitcnt vmcnt(6)
    s_barrier
    s_add_u32 m0, s22, 0
    ds_read_b128 a[200:203], v1 offset:13312
    ds_read_b128 a[196:199], v2 offset:12288
    ds_read_b128 a[192:195], v1 offset:12288
    buffer_load_dwordx4 v9, s[4:7], s20 offen lds
    ds_read_b128 a[204:207], v2 offset:13312
    v_max3_f32 v28, v32, v33, v34
    v_max3_f32 v28, v28, v35, v36
    v_max3_f32 v30, v40, v41, v42
    v_max3_f32 v28, v28, v37, v38
    v_max3_f32 v30, v30, v43, v44
    v_max_f32 v28, v28, v39
    v_mov_b32 v29, v28
    v_max3_f32 v30, v30, v45, v46
    v_max_f32 v30, v30, v47
    v_mov_b32 v31, v30
    v_permlane32_swap_b32 v29, v28
    v_max_f32 v28, v28, v29
    v_mov_b32 v29, v28
    v_permlane32_swap_b32 v31, v30
    v_max_f32 v30, v30, v31
    v_mov_b32 v31, v30
    v_permlane16_swap_b32 v29, v28
    v_max_f32 v28, v28, v29
    v_permlane16_swap_b32 v31, v30
    s_add_u32 s20, s20, 128
    v_mul_f32_e64 v16, -s28, v28
    v_max_f32 v30, v30, v31
    v_max3_f32 v28, v48, v49, v50
    v_mul_f32_e64 v17, -s28, v30
    v_max3_f32 v28, v28, v51, v52
    v_fma_f32 v34, v34, s28, v16
    v_fma_f32 v35, v35, s28, v16
    v_exp_f32 v131, v35
    v_max3_f32 v30, v56, v57, v58
    v_fma_f32 v36, v36, s28, v16
    s_waitcnt lgkmcnt(1)
    v_mfma_f32_16x16x32_bf16 v[64:67], a[192:195], a[96:99], 0
    s_add_u32 m0, s22, 1024
    ds_read_b128 a[208:211], v1 offset:14336
    buffer_load_dwordx4 v9, s[4:7], s20 offen lds
    v_fma_f32 v46, v46, s28, v17
    v_fma_f32 v32, v32, s28, v16
    s_add_u32 s20, s20, 128
    v_mfma_f32_16x16x32_bf16 v[64:67], a[196:199], a[100:103], v[64:67]
    s_add_u32 m0, s22, 2048
    ds_read_b128 a[212:215], v2 offset:14336
    buffer_load_dwordx4 v9, s[4:7], s20 offen lds
    v_fma_f32 v33, v33, s28, v16
    v_exp_f32 v128, v32
    v_exp_f32 v134, v36
    v_max3_f32 v30, v30, v59, v60
    v_max3_f32 v28, v28, v53, v54
    v_fma_f32 v38, v38, s28, v16
    v_max_f32 v28, v28, v55
    v_fma_f32 v40, v40, s28, v17
    v_max3_f32 v30, v30, v61, v62
    v_max_f32 v30, v30, v63
    v_fma_f32 v37, v37, s28, v16
    v_fma_f32 v39, v39, s28, v16
    v_mov_b32 v29, v28
    v_exp_f32 v135, v37
    v_mov_b32 v31, v30
    v_fma_f32 v43, v43, s28, v17
    v_exp_f32 v129, v33
    v_permlane32_swap_b32 v29, v28
    v_permlane32_swap_b32 v31, v30
    v_max_f32 v28, v28, v29
    v_mfma_f32_16x16x32_bf16 v[64:67], a[200:203], a[104:107], v[64:67]
    s_waitcnt lgkmcnt(1)
    ds_read_b128 a[224:227], v1 offset:19456
    v_fma_f32 v47, v47, s28, v17
    v_mfma_f32_16x16x32_bf16 v[64:67], a[204:207], a[108:111], v[64:67]
    s_add_u32 s20, s20, 12032
    ds_read_b128 a[220:223], v2 offset:18432
    v_cvt_pk_bf16_f32 v96, v128, v129
    v_mfma_f32_16x16x32_bf16 v[64:67], a[208:211], a[112:115], v[64:67]
    s_waitcnt lgkmcnt(2)
    v_fma_f32 v44, v44, s28, v17
    v_mov_b32 v29, v28
    v_cvt_pk_bf16_f32 v98, v134, v135
    v_mfma_f32_16x16x32_bf16 v[64:67], a[212:215], a[116:119], v[64:67]
    s_add_u32 s37, s37, 1
    ds_read_b128 a[232:235], v1 offset:20480
    v_max_f32 v30, v30, v31
    v_permlane16_swap_b32 v29, v28
    v_mfma_f32_16x16x32_bf16 v[72:75], a[192:195], a[120:123], 0
    s_add_u32 s35, s35, 325632
    v_fma_f32 v42, v42, s28, v17
    v_fma_f32 v41, v41, s28, v17
    v_max_f32 v28, v28, v29
    v_mfma_f32_16x16x32_bf16 v[72:75], a[196:199], a[124:127], v[72:75]
    s_lshl_b32 s42, s37, 1
    v_exp_f32 v128, v38
    v_mfma_f32_16x16x32_bf16 v[72:75], a[200:203], a[128:131], v[72:75]
    s_lshr_b32 s42, s31, s42
    ds_read_b128 a[236:239], v2 offset:20480
    v_mul_f32_e64 v18, -s28, v28
    v_mov_b32 v31, v30
    v_mfma_f32_16x16x32_bf16 v[72:75], a[204:207], a[132:135], v[72:75]
    s_xor_b32 s42, s42, s36
    v_permlane16_swap_b32 v31, v30
    v_exp_f32 v132, v40
    v_exp_f32 v129, v39
    v_max_f32 v30, v30, v31
    v_fma_f32 v49, v49, s28, v18
    v_mfma_f32_16x16x32_bf16 v[72:75], a[208:211], a[136:139], v[72:75]
    s_and_b32 s42, s42, 3
    ds_read_b128 a[228:231], v2 offset:19456
    v_cvt_pk_bf16_f32 v99, v128, v129
    v_mfma_f32_16x16x32_bf16 v[72:75], a[212:215], a[140:143], v[72:75]
    s_mul_i32 s43, s3, 3
    v_exp_f32 v133, v41
    v_fma_f32 v53, v53, s28, v18
    v_fma_f32 v48, v48, s28, v18
    s_lshl_b32 s44, s3, 2
    v_mfma_f32_16x16x32_bf16 v[80:83], a[192:195], a[144:147], 0
    s_mov_b32 s32, 1
    v_exp_f32 v130, v34
    v_cvt_pk_bf16_f32 v100, v132, v133
    v_mfma_f32_16x16x32_bf16 v[80:83], a[196:199], a[148:151], v[80:83]
    s_add_u32 s45, s43, 17
    v_exp_f32 v128, v48
    v_mfma_f32_16x16x32_bf16 v[80:83], a[200:203], a[152:155], v[80:83]
    s_cmp_eq_u32 s3, 0
    v_exp_f32 v132, v44
    v_mfma_f32_16x16x32_bf16 v[80:83], a[204:207], a[156:159], v[80:83]
    s_cselect_b32 s45, 16, s45
    ds_read_b128 a[216:219], v1 offset:18432
    v_fma_f32 v45, v45, s28, v17
    v_mfma_f32_16x16x32_bf16 v[80:83], a[208:211], a[160:163], v[80:83]
    s_cselect_b32 s33, 1, 0
    v_exp_f32 v133, v45
    v_mfma_f32_16x16x32_bf16 v[80:83], a[212:215], a[164:167], v[80:83]
    s_cmp_eq_u32 s42, 1
    v_fma_f32 v54, v54, s28, v18
    v_exp_f32 v134, v46
    v_fma_f32 v52, v52, s28, v18
    v_cvt_pk_bf16_f32 v97, v130, v131
    v_mfma_f32_16x16x32_bf16 v[88:91], a[192:195], a[168:171], 0
    s_cselect_b32 s44, s45, s44
    v_fma_f32 v64, v64, s28, v16
    v_fma_f32 v51, v51, s28, v18
    v_mul_f32_e64 v19, -s28, v30
    v_mfma_f32_16x16x32_bf16 v[88:91], a[196:199], a[172:175], v[88:91]
    s_cselect_b32 s32, s33, s32
    v_exp_f32 v135, v47
    v_mfma_f32_16x16x32_bf16 v[88:91], a[200:203], a[176:179], v[88:91]
    s_add_u32 s45, s43, 29
    v_cvt_pk_bf16_f32 v103, v134, v135
    v_cvt_pk_bf16_f32 v102, v132, v133
    v_fma_f32 v59, v59, s28, v19
    v_mfma_f32_16x16x32_bf16 v[88:91], a[204:207], a[180:183], v[88:91]
    s_cmp_eq_u32 s42, 2
    v_exp_f32 v130, v42
    v_mfma_f32_16x16x32_bf16 v[88:91], a[208:211], a[184:187], v[88:91]
    s_cselect_b32 s44, s45, s44
    v_exp_f32 v133, v53
    v_fma_f32 v50, v50, s28, v18
    v_mfma_f32_16x16x32_bf16 v[20:23], a[240:243], v[96:99], 0
    s_cselect_b32 s32, 0, s32
    v_fma_f32 v62, v62, s28, v19
    v_fma_f32 v65, v65, s28, v16
    v_fma_f32 v57, v57, s28, v19
    v_fma_f32 v66, v66, s28, v16
    v_mfma_f32_16x16x32_bf16 v[88:91], a[212:215], a[188:191], v[88:91]
    s_waitcnt lgkmcnt(0)
    v_fma_f32 v56, v56, s28, v19
    v_exp_f32 v134, v54
    v_mfma_f32_16x16x32_bf16 v[68:71], a[216:219], a[96:99], 0
    s_add_u32 s45, s43, 41
    v_fma_f32 v73, v73, s28, v17
    v_fma_f32 v61, v61, s28, v19
    v_fma_f32 v55, v55, s28, v18
    v_exp_f32 v131, v43
    v_mfma_f32_16x16x32_bf16 v[68:71], a[220:223], a[100:103], v[68:71]
    s_cmp_eq_u32 s42, 3
    v_exp_f32 v135, v55
    v_mfma_f32_16x16x32_bf16 v[68:71], a[224:227], a[104:107], v[68:71]
    s_cselect_b32 s44, s45, s44
    v_cvt_pk_bf16_f32 v101, v130, v131
    s_cselect_b32 s32, 0, s32
    v_mfma_f32_16x16x32_bf16 v[68:71], a[228:231], a[108:111], v[68:71]
    s_mul_i32 s44, s44, 6144
    v_exp_f32 v132, v52
    v_mfma_f32_16x16x32_bf16 v[68:71], a[232:235], a[112:115], v[68:71]
    s_add_u32 s33, s35, s44
    v_cvt_pk_bf16_f32 v107, v134, v135
    v_fma_f32 v58, v58, s28, v19
    v_exp_f32 v129, v49
    v_exp_f32 v130, v50
    v_mfma_f32_16x16x32_bf16 v[68:71], a[236:239], a[116:119], v[68:71]
    s_mul_i32 s42, s32, 6144
    v_fma_f32 v63, v63, s28, v19
    v_cvt_pk_bf16_f32 v106, v132, v133
    v_mfma_f32_16x16x32_bf16 v[76:79], a[216:219], a[120:123], 0
    s_add_u32 s42, s42, 18432
    v_exp_f32 v133, v61
    v_cvt_pk_bf16_f32 v104, v128, v129
    v_exp_f32 v129, v57
    s_add_u32 s42, s42, s33
    v_mfma_f32_16x16x32_bf16 v[76:79], a[220:223], a[124:127], v[76:79]
    s_cmp_ge_u32 s37, 8
    v_exp_f32 v131, v51
    v_mfma_f32_16x16x32_bf16 v[76:79], a[224:227], a[128:131], v[76:79]
    s_cselect_b32 s14, 0, s42
    v_exp_f32 v128, v56
    v_mfma_f32_16x16x32_bf16 v[76:79], a[228:231], a[132:135], v[76:79]
    s_add_u32 s25, s33, 128
    v_fma_f32 v72, v72, s28, v17
    v_fma_f32 v60, v60, s28, v19
    v_mfma_f32_16x16x32_bf16 v[76:79], a[232:235], a[136:139], v[76:79]
    s_add_u32 s23, s38, 2048
    v_exp_f32 v132, v60
    v_cvt_pk_bf16_f32 v105, v130, v131
    v_mfma_f32_16x16x32_bf16 v[76:79], a[236:239], a[140:143], v[76:79]
    s_mov_b32 s30, 0
    v_exp_f32 v130, v58
    s_waitcnt vmcnt(6)
    v_mfma_f32_16x16x32_bf16 v[84:87], a[216:219], a[144:147], 0
    s_barrier
    ds_read_b64_tr_b16 a[192:193], v3 offset:0
    v_mfma_f32_16x16x32_bf16 v[84:87], a[220:223], a[148:151], v[84:87]
    s_add_u32 m0, s22, 12288
    ds_read_b64_tr_b16 a[194:195], v3 offset:6144
    v_cvt_pk_bf16_f32 v110, v132, v133
    v_mfma_f32_16x16x32_bf16 v[84:87], a[224:227], a[152:155], v[84:87]
    ds_read_b64_tr_b16 a[196:197], v4 offset:0
    v_cvt_pk_bf16_f32 v108, v128, v129
    v_mfma_f32_16x16x32_bf16 v[84:87], a[228:231], a[156:159], v[84:87]
    ds_read_b64_tr_b16 a[198:199], v4 offset:6144
    v_exp_f32 v128, v64
    v_mfma_f32_16x16x32_bf16 v[84:87], a[232:235], a[160:163], v[84:87]
    ds_read_b64_tr_b16 a[200:201], v5 offset:0
    v_exp_f32 v134, v62
    v_mfma_f32_16x16x32_bf16 v[84:87], a[236:239], a[164:167], v[84:87]
    buffer_load_dwordx4 v9, s[4:7], s20 offen lds
    ds_read_b64_tr_b16 a[202:203], v5 offset:6144
    v_mfma_f32_16x16x32_bf16 v[92:95], a[216:219], a[168:171], 0
    s_add_u32 s20, s20, 128
    v_exp_f32 v129, v65
    v_mfma_f32_16x16x32_bf16 v[20:23], a[244:247], v[100:103], v[20:23]
    ds_read_b64_tr_b16 a[204:205], v6 offset:0
    v_cvt_pk_bf16_f32 v112, v128, v129
    v_fma_f32 v67, v67, s28, v16
    v_mfma_f32_16x16x32_bf16 v[92:95], a[220:223], a[172:175], v[92:95]
    s_add_u32 m0, s22, 13312
    ds_read_b64_tr_b16 a[206:207], v6 offset:6144
    buffer_load_dwordx4 v9, s[4:7], s20 offen lds
    v_exp_f32 v131, v59
    v_mfma_f32_16x16x32_bf16 v[92:95], a[224:227], a[176:179], v[92:95]
    ds_read_b64_tr_b16 a[208:209], v3 offset:1024
    v_exp_f32 v135, v63
    v_mfma_f32_16x16x32_bf16 v[20:23], a[248:251], v[104:107], v[20:23]
    ds_read_b64_tr_b16 a[210:211], v3 offset:7168
    v_exp_f32 v132, v72
    v_mfma_f32_16x16x32_bf16 v[92:95], a[228:231], a[180:183], v[92:95]
    s_add_u32 s20, s20, 128
    ds_read_b64_tr_b16 a[212:213], v4 offset:1024
    v_cvt_pk_bf16_f32 v109, v130, v131
    v_exp_f32 v130, v66
    v_cvt_pk_bf16_f32 v111, v134, v135
    v_mfma_f32_16x16x32_bf16 v[92:95], a[232:235], a[184:187], v[92:95]
    s_add_u32 m0, s22, 14336
    v_exp_f32 v133, v73
    v_exp_f32 v131, v67
    v_mfma_f32_16x16x32_bf16 v[20:23], a[252:255], v[108:111], v[20:23]
    ds_read_b64_tr_b16 a[214:215], v4 offset:7168
    buffer_load_dwordx4 v9, s[4:7], s20 offen lds
    v_mfma_f32_16x16x32_bf16 v[92:95], a[236:239], a[188:191], v[92:95]
    s_add_u32 s20, s20, 12032
    v_cvt_pk_bf16_f32 v113, v130, v131
    v_cvt_pk_bf16_f32 v116, v132, v133
    v_fma_f32 v71, v71, s28, v16
    s_waitcnt lgkmcnt(10)
    v_mfma_f32_16x16x32_bf16 v[160:163], a[192:195], v[96:99], 0
    ds_read_b64_tr_b16 a[224:225], v3 offset:2048
    v_fma_f32 v68, v68, s28, v16
    v_mfma_f32_16x16x32_bf16 v[208:211], a[192:195], v[100:103], 0
    v_exp_f32 v134, v68
    v_mfma_f32_16x16x32_bf16 a[0:3], a[192:195], v[104:107], 0
    ds_read_b64_tr_b16 a[234:235], v5 offset:8192
    v_fma_f32 v70, v70, s28, v16
    v_fma_f32 v86, v86, s28, v18
    v_mfma_f32_16x16x32_bf16 a[48:51], a[192:195], v[108:111], 0
    s_waitcnt lgkmcnt(10)
    ds_read_b64_tr_b16 a[222:223], v6 offset:7168
    v_fma_f32 v79, v79, s28, v17
    v_mfma_f32_16x16x32_bf16 v[164:167], a[196:199], v[96:99], 0
    ds_read_b64_tr_b16 a[220:221], v6 offset:1024
    v_fma_f32 v89, v89, s28, v19
    v_mfma_f32_16x16x32_bf16 v[212:215], a[196:199], v[100:103], 0
    v_fma_f32 v81, v81, s28, v18
    v_fma_f32 v69, v69, s28, v16
    v_mfma_f32_16x16x32_bf16 a[4:7], a[196:199], v[104:107], 0
    ds_read_b64_tr_b16 a[216:217], v5 offset:1024
    v_fma_f32 v78, v78, s28, v17
    v_mfma_f32_16x16x32_bf16 a[52:55], a[196:199], v[108:111], 0
    s_waitcnt lgkmcnt(10)
    ds_read_b64_tr_b16 a[228:229], v4 offset:2048
    v_fma_f32 v75, v75, s28, v17
    v_mfma_f32_16x16x32_bf16 v[168:171], a[200:203], v[96:99], 0
    v_exp_f32 v135, v69
    v_mfma_f32_16x16x32_bf16 v[216:219], a[200:203], v[100:103], 0
    ds_read_b64_tr_b16 a[232:233], v5 offset:2048
    v_fma_f32 v90, v90, s28, v19
    v_mfma_f32_16x16x32_bf16 a[8:11], a[200:203], v[104:107], 0
    ds_read_b64_tr_b16 a[218:219], v5 offset:7168
    v_fma_f32 v76, v76, s28, v17
    v_mfma_f32_16x16x32_bf16 a[56:59], a[200:203], v[108:111], 0
    s_waitcnt lgkmcnt(7)
    v_exp_f32 v128, v70
    v_mfma_f32_16x16x32_bf16 v[172:175], a[204:207], v[96:99], 0
    ds_read_b64_tr_b16 a[226:227], v3 offset:8192
    v_fma_f32 v83, v83, s28, v18
    v_mfma_f32_16x16x32_bf16 v[220:223], a[204:207], v[100:103], 0
    ds_read_b64_tr_b16 a[236:237], v6 offset:2048
    v_fma_f32 v77, v77, s28, v17
    v_mfma_f32_16x16x32_bf16 a[12:15], a[204:207], v[104:107], 0
    ds_read_b64_tr_b16 a[238:239], v6 offset:8192
    v_cvt_pk_bf16_f32 v114, v134, v135
    v_mfma_f32_16x16x32_bf16 a[60:63], a[204:207], v[108:111], 0
    ds_read_b64_tr_b16 a[230:231], v4 offset:8192
    v_fma_f32 v74, v74, s28, v17
    v_mfma_f32_16x16x32_bf16 v[176:179], a[208:211], v[96:99], 0
    v_exp_f32 v129, v71
    v_mfma_f32_16x16x32_bf16 v[224:227], a[208:211], v[100:103], 0
    v_exp_f32 v134, v78
    v_mfma_f32_16x16x32_bf16 a[16:19], a[208:211], v[104:107], 0
    v_exp_f32 v135, v79
    v_mfma_f32_16x16x32_bf16 a[64:67], a[208:211], v[108:111], 0
    v_fma_f32 v82, v82, s28, v18
    v_cvt_pk_bf16_f32 v119, v134, v135
    v_mfma_f32_16x16x32_bf16 v[180:183], a[212:215], v[96:99], 0
    v_fma_f32 v88, v88, s28, v19
    v_cvt_pk_bf16_f32 v115, v128, v129
    v_mfma_f32_16x16x32_bf16 v[228:231], a[212:215], v[100:103], 0
    v_exp_f32 v133, v77
    v_mfma_f32_16x16x32_bf16 a[20:23], a[212:215], v[104:107], 0
    v_exp_f32 v131, v75
    v_mfma_f32_16x16x32_bf16 a[68:71], a[212:215], v[108:111], 0
    s_waitcnt lgkmcnt(2)
    v_exp_f32 v132, v76
    v_mfma_f32_16x16x32_bf16 v[184:187], a[216:219], v[96:99], 0
    v_exp_f32 v130, v74
    v_mfma_f32_16x16x32_bf16 v[232:235], a[216:219], v[100:103], 0
    s_waitcnt vmcnt(3) lgkmcnt(0)
    v_cvt_pk_bf16_f32 v117, v130, v131
    v_cvt_pk_bf16_f32 v118, v132, v133
    v_mfma_f32_16x16x32_bf16 a[24:27], a[216:219], v[104:107], 0
    v_fma_f32 v80, v80, s28, v18
    v_fma_f32 v91, v91, s28, v19
    v_mfma_f32_16x16x32_bf16 v[24:27], a[240:243], v[112:115], v[20:23]
    v_exp_f32 v128, v80
    v_mfma_f32_16x16x32_bf16 v[24:27], a[244:247], v[116:119], v[24:27]
    s_barrier
    v_mfma_f32_16x16x32_bf16 a[72:75], a[216:219], v[108:111], 0
    ds_read_b128 a[212:215], v2 offset:2048
    v_fma_f32 v84, v84, s28, v18
    v_mfma_f32_16x16x32_bf16 v[188:191], a[220:223], v[96:99], 0
    v_exp_f32 v134, v86
    v_mfma_f32_16x16x32_bf16 v[236:239], a[220:223], v[100:103], 0
    v_exp_f32 v131, v83
    v_mfma_f32_16x16x32_bf16 a[28:31], a[220:223], v[104:107], 0
    ds_read_b128 a[192:195], v1 offset:0
    v_fma_f32 v92, v92, s28, v19
    v_mfma_f32_16x16x32_bf16 a[76:79], a[220:223], v[108:111], 0
    s_add_u32 m0, s22, 24576
    v_exp_f32 v129, v81
    v_mfma_f32_16x16x32_bf16 v[192:195], a[224:227], v[96:99], 0
    ds_read_b128 a[220:223], v2 offset:6144
    v_mfma_f32_16x16x32_bf16 v[240:243], a[224:227], v[100:103], 0
    buffer_load_dwordx4 v9, s[8:11], s21 offen lds
    v_mfma_f32_16x16x32_bf16 a[32:35], a[224:227], v[104:107], 0
    s_add_u32 s21, s21, 128
    ds_read_b128 a[196:199], v2 offset:0
    v_fma_f32 v87, v87, s28, v18
    v_mfma_f32_16x16x32_bf16 a[80:83], a[224:227], v[108:111], 0
    ds_read_b128 a[208:211], v1 offset:2048
    v_fma_f32 v85, v85, s28, v18
    v_mfma_f32_16x16x32_bf16 v[196:199], a[228:231], v[96:99], 0
    s_add_u32 m0, s22, 25600
    v_fma_f32 v93, v93, s28, v19
    v_cvt_pk_bf16_f32 v120, v128, v129
    v_mfma_f32_16x16x32_bf16 v[244:247], a[228:231], v[100:103], 0
    buffer_load_dwordx4 v9, s[8:11], s21 offen lds
    v_mfma_f32_16x16x32_bf16 a[36:39], a[228:231], v[104:107], 0
    ds_read_b128 a[200:203], v1 offset:1024
    v_fma_f32 v94, v94, s28, v19
    v_mfma_f32_16x16x32_bf16 a[84:87], a[228:231], v[108:111], 0
    v_exp_f32 v133, v85
    v_mfma_f32_16x16x32_bf16 v[200:203], a[232:235], v[96:99], 0
    ds_read_b128 a[204:207], v2 offset:1024
    s_add_u32 s21, s21, 128
    v_mfma_f32_16x16x32_bf16 v[248:251], a[232:235], v[100:103], 0
    s_add_u32 m0, s22, 26624
    v_exp_f32 v135, v87
    v_mfma_f32_16x16x32_bf16 a[40:43], a[232:235], v[104:107], 0
    buffer_load_dwordx4 v9, s[8:11], s21 offen lds
    v_mfma_f32_16x16x32_bf16 a[88:91], a[232:235], v[108:111], 0
    s_add_u32 s21, s21, 12032
    v_exp_f32 v132, v84
    v_mfma_f32_16x16x32_bf16 v[204:207], a[236:239], v[96:99], 0
    s_add_u32 s58, s25, 4294967168
    v_exp_f32 v129, v89
    v_mfma_f32_16x16x32_bf16 v[252:255], a[236:239], v[100:103], 0
    s_add_u32 m0, s38, 0
    v_exp_f32 v128, v88
    v_mfma_f32_16x16x32_bf16 a[44:47], a[236:239], v[104:107], 0
    buffer_load_dwordx4 v10, s[12:15], s58 offen nt lds
    v_mfma_f32_16x16x32_bf16 a[92:95], a[236:239], v[108:111], 0
    s_waitcnt lgkmcnt(2)
    ds_read_b128 a[228:231], v2 offset:7168
    v_mfma_f32_16x16x32_bf16 v[32:35], a[192:195], a[96:99], 0
    s_add_u32 m0, s38, 1024
    ds_read_b128 a[232:235], v1 offset:8192
    v_cvt_pk_bf16_f32 v124, v128, v129
    v_mfma_f32_16x16x32_bf16 v[32:35], a[196:199], a[100:103], v[32:35]
    s_waitcnt lgkmcnt(3)
    ds_read_b128 a[224:227], v1 offset:7168
    v_mfma_f32_16x16x32_bf16 v[32:35], a[200:203], a[104:107], v[32:35]
    s_waitcnt lgkmcnt(3)
    v_exp_f32 v130, v82
    v_mfma_f32_16x16x32_bf16 v[32:35], a[204:207], a[108:111], v[32:35]
    buffer_load_dwordx4 v11, s[12:15], s58 offen nt lds
    v_mfma_f32_16x16x32_bf16 v[32:35], a[208:211], a[112:115], v[32:35]
    v_cvt_pk_bf16_f32 v123, v134, v135
    v_fma_f32 v95, v95, s28, v19
    v_mfma_f32_16x16x32_bf16 v[32:35], a[212:215], a[116:119], v[32:35]
    s_add_u32 s59, s25, 6016
    v_cvt_pk_bf16_f32 v122, v132, v133
    v_cvt_pk_bf16_f32 v121, v130, v131
    v_mfma_f32_16x16x32_bf16 v[40:43], a[192:195], a[120:123], 0
    ds_read_b128 a[216:219], v1 offset:6144
    v_mfma_f32_16x16x32_bf16 v[40:43], a[196:199], a[124:127], v[40:43]
    v_exp_f32 v134, v94
    v_mfma_f32_16x16x32_bf16 v[40:43], a[200:203], a[128:131], v[40:43]
    s_add_u32 m0, s38, 6144
    v_exp_f32 v133, v93
    v_mfma_f32_16x16x32_bf16 v[40:43], a[204:207], a[132:135], v[40:43]
    buffer_load_dwordx4 v10, s[12:15], s59 offen nt lds
    v_mfma_f32_16x16x32_bf16 v[40:43], a[208:211], a[136:139], v[40:43]
    v_exp_f32 v135, v95
    v_mfma_f32_16x16x32_bf16 v[40:43], a[212:215], a[140:143], v[40:43]
    v_exp_f32 v130, v90
    v_mfma_f32_16x16x32_bf16 v[48:51], a[192:195], a[144:147], 0
    s_add_u32 m0, s38, 7168
    v_exp_f32 v132, v92
    v_mfma_f32_16x16x32_bf16 v[48:51], a[196:199], a[148:151], v[48:51]
    buffer_load_dwordx4 v11, s[12:15], s59 offen nt lds
    v_mfma_f32_16x16x32_bf16 v[48:51], a[200:203], a[152:155], v[48:51]
    s_add_u32 s58, s25, 12160
    ds_read_b128 a[236:239], v2 offset:8192
    v_cvt_pk_bf16_f32 v127, v134, v135
    v_mfma_f32_16x16x32_bf16 v[48:51], a[204:207], a[156:159], v[48:51]
    s_add_u32 m0, s38, 12288
    v_exp_f32 v131, v91
    v_mfma_f32_16x16x32_bf16 v[48:51], a[208:211], a[160:163], v[48:51]
    buffer_load_dwordx4 v10, s[12:15], s58 offen nt lds
    v_mfma_f32_16x16x32_bf16 v[48:51], a[212:215], a[164:167], v[48:51]
    s_add_u32 m0, s38, 13312
    v_cvt_pk_bf16_f32 v126, v132, v133
    v_cvt_pk_bf16_f32 v125, v130, v131
    v_mfma_f32_16x16x32_bf16 v[24:27], a[248:251], v[120:123], v[24:27]
    buffer_load_dwordx4 v11, s[12:15], s58 offen nt lds
    v_mfma_f32_16x16x32_bf16 v[24:27], a[252:255], v[124:127], v[24:27]
    s_add_u32 s59, s25, 18304
    s_add_u32 m0, s38, 18432
    v_mfma_f32_16x16x32_bf16 v[56:59], a[192:195], a[168:171], 0
    buffer_load_dwordx4 v10, s[12:15], s59 offen nt lds
    v_mfma_f32_16x16x32_bf16 v[56:59], a[196:199], a[172:175], v[56:59]
    s_add_u32 m0, s38, 19456
    v_mfma_f32_16x16x32_bf16 v[56:59], a[200:203], a[176:179], v[56:59]
    buffer_load_dwordx4 v11, s[12:15], s59 offen nt lds
    v_mfma_f32_16x16x32_bf16 v[56:59], a[204:207], a[180:183], v[56:59]
    v_cmp_lt_f32 vcc, s29, v24
    s_waitcnt vmcnt(17) lgkmcnt(0)
    v_mfma_f32_16x16x32_bf16 v[56:59], a[208:211], a[184:187], v[56:59]
    s_barrier
    v_mfma_f32_16x16x32_bf16 v[56:59], a[212:215], a[188:191], v[56:59]
    ds_read_b64_tr_b16 a[192:193], v3 offset:12288
    s_add_u32 m0, s22, 0
    v_mfma_f32_16x16x32_bf16 v[36:39], a[216:219], a[96:99], 0
    s_cbranch_vccnz L_rs_start4b
L_ret_start4b:
    ds_read_b64_tr_b16 a[194:195], v3 offset:18432
    v_mfma_f32_16x16x32_bf16 v[36:39], a[220:223], a[100:103], v[36:39]
    v_fma_f32 v35, v35, s28, v16
    v_mfma_f32_16x16x32_bf16 v[36:39], a[224:227], a[104:107], v[36:39]
    buffer_load_dwordx4 v9, s[4:7], s20 offen lds
    v_mfma_f32_16x16x32_bf16 v[36:39], a[228:231], a[108:111], v[36:39]
    v_fma_f32 v40, v40, s28, v17
    v_mfma_f32_16x16x32_bf16 v[36:39], a[232:235], a[112:115], v[36:39]
    ds_read_b64_tr_b16 a[196:197], v4 offset:12288
    v_fma_f32 v34, v34, s28, v16
    v_mfma_f32_16x16x32_bf16 v[36:39], a[236:239], a[116:119], v[36:39]
    v_fma_f32 v32, v32, s28, v16
    v_fma_f32 v33, v33, s28, v16
    v_mfma_f32_16x16x32_bf16 v[44:47], a[216:219], a[120:123], 0
    ds_read_b64_tr_b16 a[198:199], v4 offset:18432
    v_mfma_f32_16x16x32_bf16 v[44:47], a[220:223], a[124:127], v[44:47]
    v_exp_f32 v131, v35
    v_mfma_f32_16x16x32_bf16 v[44:47], a[224:227], a[128:131], v[44:47]
    s_add_u32 s20, s20, 128
    ds_read_b64_tr_b16 a[200:201], v5 offset:12288
    v_fma_f32 v41, v41, s28, v17
    v_mfma_f32_16x16x32_bf16 v[44:47], a[228:231], a[132:135], v[44:47]
    v_exp_f32 v130, v34
    v_mfma_f32_16x16x32_bf16 v[44:47], a[232:235], a[136:139], v[44:47]
    s_add_u32 m0, s22, 1024
    v_exp_f32 v133, v41
    v_mfma_f32_16x16x32_bf16 v[44:47], a[236:239], a[140:143], v[44:47]
    ds_read_b64_tr_b16 a[202:203], v5 offset:18432
    v_mfma_f32_16x16x32_bf16 v[52:55], a[216:219], a[144:147], 0
    buffer_load_dwordx4 v9, s[4:7], s20 offen lds
    v_mfma_f32_16x16x32_bf16 v[52:55], a[220:223], a[148:151], v[52:55]
    s_add_u32 s20, s20, 128
    ds_read_b64_tr_b16 a[204:205], v6 offset:12288
    v_mfma_f32_16x16x32_bf16 v[52:55], a[224:227], a[152:155], v[52:55]
    s_add_u32 m0, s22, 2048
    v_exp_f32 v128, v32
    v_mfma_f32_16x16x32_bf16 v[52:55], a[228:231], a[156:159], v[52:55]
    buffer_load_dwordx4 v9, s[4:7], s20 offen lds
    v_mfma_f32_16x16x32_bf16 v[52:55], a[232:235], a[160:163], v[52:55]
    v_exp_f32 v132, v40
    v_mfma_f32_16x16x32_bf16 v[52:55], a[236:239], a[164:167], v[52:55]
    ds_read_b64_tr_b16 a[206:207], v6 offset:18432
    v_mfma_f32_16x16x32_bf16 v[60:63], a[216:219], a[168:171], 0
    v_exp_f32 v129, v33
    v_mfma_f32_16x16x32_bf16 v[60:63], a[220:223], a[172:175], v[60:63]
    ds_read_b64_tr_b16 a[208:209], v3 offset:13312
    v_mfma_f32_16x16x32_bf16 v[60:63], a[224:227], a[176:179], v[60:63]
    ds_read_b64_tr_b16 a[210:211], v3 offset:19456
    s_add_u32 s20, s20, 12032
    v_mfma_f32_16x16x32_bf16 v[60:63], a[228:231], a[180:183], v[60:63]
    ds_read_b64_tr_b16 a[212:213], v4 offset:13312
    v_cvt_pk_bf16_f32 v96, v128, v129
    v_mfma_f32_16x16x32_bf16 v[60:63], a[232:235], a[184:187], v[60:63]
    ds_read_b64_tr_b16 a[214:215], v4 offset:19456
    v_cvt_pk_bf16_f32 v97, v130, v131
    v_mfma_f32_16x16x32_bf16 v[60:63], a[236:239], a[188:191], v[60:63]
    v_cvt_pk_bf16_f32 v100, v132, v133
    s_branch L_loop4
L_start3:
    s_add_u32 m0, s22, 0
    s_nop 0
    buffer_load_dwordx4 v9, s[4:7], s20 offen lds
    s_add_u32 s20, s20, 128
    s_add_u32 m0, s22, 1024
    s_nop 0
    buffer_load_dwordx4 v9, s[4:7], s20 offen lds
    s_add_u32 s20, s20, 128
    s_add_u32 m0, s22, 2048
    s_nop 0
    buffer_load_dwordx4 v9, s[4:7], s20 offen lds
    s_add_u32 s20, s20, 12032
    s_add_u32 s48, s34, 0
    s_add_u32 m0, s38, 0
    s_nop 0
    buffer_load_dwordx4 v10, s[12:15], s48 offen nt lds
    s_add_u32 m0, s38, 1024
    s_nop 0
    buffer_load_dwordx4 v11, s[12:15], s48 offen nt lds
    s_add_u32 s48, s34, 128
    s_add_u32 m0, s38, 2048
    s_nop 0
    buffer_load_dwordx4 v10, s[12:15], s48 offen nt lds
    s_add_u32 m0, s38, 3072
    s_nop 0
    buffer_load_dwordx4 v11, s[12:15], s48 offen nt lds
    s_add_u32 s48, s34, 256
    s_add_u32 m0, s38, 4096
    s_nop 0
    buffer_load_dwordx4 v10, s[12:15], s48 offen nt lds
    s_add_u32 m0, s38, 5120
    s_nop 0
    buffer_load_dwordx4 v11, s[12:15], s48 offen nt lds
    s_add_u32 s48, s34, 6144
    s_add_u32 m0, s38, 6144
    s_nop 0
    buffer_load_dwordx4 v10, s[12:15], s48 offen nt lds
    s_add_u32 m0, s38, 7168
    s_nop 0
    buffer_load_dwordx4 v11, s[12:15], s48 offen nt lds
    s_add_u32 s48, s34, 6272
    s_add_u32 m0, s38, 8192
    s_nop 0
    buffer_load_dwordx4 v10, s[12:15], s48 offen nt lds
    s_add_u32 m0, s38, 9216
    s_nop 0
    buffer_load_dwordx4 v11, s[12:15], s48 offen nt lds
    s_add_u32 s48, s34, 6400
    s_add_u32 m0, s38, 10240
    s_nop 0
    buffer_load_dwordx4 v10, s[12:15], s48 offen nt lds
    s_add_u32 m0, s38, 11264
    s_nop 0
    buffer_load_dwordx4 v11, s[12:15], s48 offen nt lds
    v_and_b32 v128, 15, v0
    v_lshrrev_b32 v129, 4, v0
    v_lshrrev_b32 v130, 3, v128
    v_and_b32 v131, 7, v128
    v_lshlrev_b32 v1, 7, v131
    v_bfe_u32 v131, v128, 1, 2
    v_lshlrev_b32 v131, 1, v131
    v_mul_u32_u24 v132, 5, v130
    v_xor_b32 v131, v131, v132
    v_xor_b32 v131, v131, v129
    v_lshl_add_u32 v1, v131, 4, v1
    v_lshl_add_u32 v7, v130, 10, v1
    v_add_u32 v7, s38, v7
    v_mul_u32_u24 v132, 3072, v130
    v_add_u32 v1, v132, v1
    v_xor_b32 v2, 64, v1
    v_xor_b32 v8, 64, v7
    v_lshrrev_b32 v130, 1, v129
    v_mul_u32_u24 v3, 3072, v130
    v_and_b32 v131, 1, v129
    v_bfe_u32 v132, v0, 2, 2
    v_lshl_add_u32 v128, v131, 2, v132
    v_lshl_add_u32 v3, v128, 7, v3
    v_lshrrev_b32 v128, 1, v128
    v_lshlrev_b32 v128, 1, v128
    v_mul_u32_u24 v130, 5, v130
    v_xor_b32 v128, v128, v130
    v_bfe_u32 v131, v0, 1, 1
    v_xor_b32 v128, v128, v131
    v_lshl_add_u32 v3, v128, 4, v3
    v_and_b32 v131, 1, v0
    v_lshl_add_u32 v3, v131, 3, v3
    v_add_u32 v3, 24576, v3
    v_xor_b32 v4, 32, v3
    v_xor_b32 v5, 64, v3
    v_xor_b32 v6, 96, v3
    v_lshrrev_b32 v128, 3, v0
    v_and_b32 v129, 15, v0
    v_lshrrev_b32 v130, 4, v0
    v_lshrrev_b32 v131, 1, v130
    v_and_b32 v132, 7, v129
    v_xor_b32 v131, v131, v132
    v_lshlrev_b32 v14, 7, v129
    v_lshl_add_u32 v14, v131, 4, v14
    v_and_b32 v130, 1, v130
    v_lshl_add_u32 v14, v130, 3, v14
    v_add_u32 v14, s38, v14
    v_and_b32 v129, 7, v0
    v_xor_b32 v130, v129, v128
    v_lshlrev_b32 v13, 7, v128
    v_lshl_add_u32 v13, v130, 4, v13
    v_add_u32 v13, s38, v13
    v_add_u32 v13, 2048, v13
    v_mul_u32_u24 v12, 384, v128
    v_lshl_add_u32 v12, v129, 4, v12
    v_and_b32 v128, 15, v0
    v_and_b32 v129, 3, v0
    v_mov_b32 v131, 0x3f803f80
    v_cmp_eq_u32 s[42:43], 12, v128
    v_cmp_eq_u32 vcc, 0, v129
    s_nop 3
    s_or_b64 vcc, vcc, s[42:43]
    v_cndmask_b32 v130, 0, v131, vcc
    v_accvgpr_write_b32 a240, v130
    v_accvgpr_write_b32 a241, v130
    v_accvgpr_write_b32 a242, v130
    v_accvgpr_write_b32 a243, v130
    v_cmp_eq_u32 vcc, 1, v129
    s_nop 3
    s_or_b64 vcc, vcc, s[42:43]
    v_cndmask_b32 v130, 0, v131, vcc
    v_accvgpr_write_b32 a244, v130
    v_accvgpr_write_b32 a245, v130
    v_accvgpr_write_b32 a246, v130
    v_accvgpr_write_b32 a247, v130
    v_cmp_eq_u32 vcc, 2, v129
    s_nop 3
    s_or_b64 vcc, vcc, s[42:43]
    v_cndmask_b32 v130, 0, v131, vcc
    v_accvgpr_write_b32 a248, v130
    v_accvgpr_write_b32 a249, v130
    v_accvgpr_write_b32 a250, v130
    v_accvgpr_write_b32 a251, v130
    v_cmp_eq_u32 vcc, 3, v129
    s_nop 3
    s_or_b64 vcc, vcc, s[42:43]
    v_cndmask_b32 v130, 0, v131, vcc
    v_accvgpr_write_b32 a252, v130
    v_accvgpr_write_b32 a253, v130
    v_accvgpr_write_b32 a254, v130
    v_accvgpr_write_b32 a255, v130
    s_waitcnt vmcnt(12)
    s_barrier
    ds_read_b128 a[192:195], v1 offset:0
    ds_read_b128 a[196:199], v2 offset:0
    ds_read_b128 a[200:203], v1 offset:1024
    ds_read_b128 a[204:207], v2 offset:1024
    ds_read_b128 a[208:211], v1 offset:2048
    ds_read_b128 a[212:215], v2 offset:2048
    ds_read_b128 a[216:219], v1 offset:6144
    ds_read_b128 a[220:223], v2 offset:6144
    ds_read_b128 a[224:227], v1 offset:7168
    ds_read_b128 a[228:231], v2 offset:7168
    ds_read_b128 a[232:235], v1 offset:8192
    ds_read_b128 a[236:239], v2 offset:8192
    s_waitcnt vmcnt(6)
    ds_read_b128 a[96:99], v7 offset:0
    s_add_u32 s48, s34, 12288
    s_add_u32 m0, s38, 12288
    ds_read_b128 a[100:103], v8 offset:0
    ds_read_b128 a[104:107], v7 offset:2048
    ds_read_b128 a[108:111], v8 offset:2048
    ds_read_b128 a[112:115], v7 offset:4096
    ds_read_b128 a[116:119], v8 offset:4096
    s_waitcnt lgkmcnt(5)
    v_mfma_f32_16x16x32_bf16 v[32:35], a[192:195], a[96:99], 0
    buffer_load_dwordx4 v10, s[12:15], s48 offen nt lds
    s_add_u32 m0, s38, 13312
    s_waitcnt lgkmcnt(4)
    v_mfma_f32_16x16x32_bf16 v[32:35], a[196:199], a[100:103], v[32:35]
    buffer_load_dwordx4 v11, s[12:15], s48 offen nt lds
    s_add_u32 s48, s34, 12416
    s_add_u32 m0, s38, 14336
    s_waitcnt lgkmcnt(3)
    v_mfma_f32_16x16x32_bf16 v[32:35], a[200:203], a[104:107], v[32:35]
    buffer_load_dwordx4 v10, s[12:15], s48 offen nt lds
    s_add_u32 m0, s38, 15360
    s_waitcnt lgkmcnt(2)
    v_mfma_f32_16x16x32_bf16 v[32:35], a[204:207], a[108:111], v[32:35]
    buffer_load_dwordx4 v11, s[12:15], s48 offen nt lds
    s_add_u32 s48, s34, 12544
    s_add_u32 m0, s38, 16384
    s_waitcnt lgkmcnt(1)
    v_mfma_f32_16x16x32_bf16 v[32:35], a[208:211], a[112:115], v[32:35]
    buffer_load_dwordx4 v10, s[12:15], s48 offen nt lds
    s_add_u32 m0, s38, 17408
    s_waitcnt lgkmcnt(0)
    v_mfma_f32_16x16x32_bf16 v[32:35], a[212:215], a[116:119], v[32:35]
    buffer_load_dwordx4 v11, s[12:15], s48 offen nt lds
    s_add_u32 m0, s22, 12288
    v_mfma_f32_16x16x32_bf16 v[36:39], a[216:219], a[96:99], 0
    v_mfma_f32_16x16x32_bf16 v[36:39], a[220:223], a[100:103], v[36:39]
    v_mfma_f32_16x16x32_bf16 v[36:39], a[224:227], a[104:107], v[36:39]
    v_mfma_f32_16x16x32_bf16 v[36:39], a[228:231], a[108:111], v[36:39]
    v_mfma_f32_16x16x32_bf16 v[36:39], a[232:235], a[112:115], v[36:39]
    v_mfma_f32_16x16x32_bf16 v[36:39], a[236:239], a[116:119], v[36:39]
    s_waitcnt vmcnt(6)
    ds_read_b128 a[120:123], v7 offset:6144
    ds_read_b128 a[124:127], v8 offset:6144
    ds_read_b128 a[128:131], v7 offset:8192
    ds_read_b128 a[132:135], v8 offset:8192
    ds_read_b128 a[136:139], v7 offset:10240
    ds_read_b128 a[140:143], v8 offset:10240
    s_waitcnt lgkmcnt(5)
    v_mfma_f32_16x16x32_bf16 v[40:43], a[192:195], a[120:123], 0
    buffer_load_dwordx4 v9, s[4:7], s20 offen lds
    s_add_u32 s20, s20, 128
    s_add_u32 m0, s22, 13312
    s_waitcnt lgkmcnt(4)
    v_mfma_f32_16x16x32_bf16 v[40:43], a[196:199], a[124:127], v[40:43]
    buffer_load_dwordx4 v9, s[4:7], s20 offen lds
    s_add_u32 s20, s20, 128
    s_add_u32 m0, s22, 14336
    s_waitcnt lgkmcnt(3)
    v_mfma_f32_16x16x32_bf16 v[40:43], a[200:203], a[128:131], v[40:43]
    buffer_load_dwordx4 v9, s[4:7], s20 offen lds
    s_add_u32 s20, s20, 12032
    s_add_u32 m0, s22, 24576
    s_waitcnt lgkmcnt(2)
    v_mfma_f32_16x16x32_bf16 v[40:43], a[204:207], a[132:135], v[40:43]
    s_waitcnt lgkmcnt(1)
    v_mfma_f32_16x16x32_bf16 v[40:43], a[208:211], a[136:139], v[40:43]
    s_waitcnt lgkmcnt(0)
    v_mfma_f32_16x16x32_bf16 v[40:43], a[212:215], a[140:143], v[40:43]
    v_mfma_f32_16x16x32_bf16 v[44:47], a[216:219], a[120:123], 0
    v_mfma_f32_16x16x32_bf16 v[44:47], a[220:223], a[124:127], v[44:47]
    v_mfma_f32_16x16x32_bf16 v[44:47], a[224:227], a[128:131], v[44:47]
    v_mfma_f32_16x16x32_bf16 v[44:47], a[228:231], a[132:135], v[44:47]
    v_mfma_f32_16x16x32_bf16 v[44:47], a[232:235], a[136:139], v[44:47]
    v_mfma_f32_16x16x32_bf16 v[44:47], a[236:239], a[140:143], v[44:47]
    s_waitcnt vmcnt(3)
    ds_read_b128 a[144:147], v7 offset:12288
    ds_read_b128 a[148:151], v8 offset:12288
    ds_read_b128 a[152:155], v7 offset:14336
    ds_read_b128 a[156:159], v8 offset:14336
    ds_read_b128 a[160:163], v7 offset:16384
    ds_read_b128 a[164:167], v8 offset:16384
    s_waitcnt lgkmcnt(5)
    v_mfma_f32_16x16x32_bf16 v[48:51], a[192:195], a[144:147], 0
    buffer_load_dwordx4 v9, s[8:11], s21 offen lds
    s_add_u32 s21, s21, 128
    s_add_u32 m0, s22, 25600
    s_waitcnt lgkmcnt(4)
    v_mfma_f32_16x16x32_bf16 v[48:51], a[196:199], a[148:151], v[48:51]
    buffer_load_dwordx4 v9, s[8:11], s21 offen lds
    s_add_u32 s21, s21, 128
    s_add_u32 m0, s22, 26624
    s_waitcnt lgkmcnt(3)
    v_mfma_f32_16x16x32_bf16 v[48:51], a[200:203], a[152:155], v[48:51]
    buffer_load_dwordx4 v9, s[8:11], s21 offen lds
    s_add_u32 s21, s21, 12032
    s_add_u32 m0, s22, 36864
    s_waitcnt lgkmcnt(2)
    v_mfma_f32_16x16x32_bf16 v[48:51], a[204:207], a[156:159], v[48:51]
    buffer_load_dwordx4 v9, s[8:11], s21 offen lds
    s_add_u32 s21, s21, 128
    s_add_u32 m0, s22, 37888
    s_waitcnt lgkmcnt(1)
    v_mfma_f32_16x16x32_bf16 v[48:51], a[208:211], a[160:163], v[48:51]
    buffer_load_dwordx4 v9, s[8:11], s21 offen lds
    s_add_u32 s21, s21, 128
    s_add_u32 m0, s22, 38912
    s_waitcnt lgkmcnt(0)
    v_mfma_f32_16x16x32_bf16 v[48:51], a[212:215], a[164:167], v[48:51]
    buffer_load_dwordx4 v9, s[8:11], s21 offen lds
    s_add_u32 s21, s21, 12032
    v_mfma_f32_16x16x32_bf16 v[52:55], a[216:219], a[144:147], 0
    v_mfma_f32_16x16x32_bf16 v[52:55], a[220:223], a[148:151], v[52:55]
    v_mfma_f32_16x16x32_bf16 v[52:55], a[224:227], a[152:155], v[52:55]
    v_mfma_f32_16x16x32_bf16 v[52:55], a[228:231], a[156:159], v[52:55]
    v_mfma_f32_16x16x32_bf16 v[52:55], a[232:235], a[160:163], v[52:55]
    v_mfma_f32_16x16x32_bf16 v[52:55], a[236:239], a[164:167], v[52:55]
    s_waitcnt vmcnt(6)
    s_barrier
    ds_read_b128 a[196:199], v2 offset:12288
    ds_read_b128 a[204:207], v2 offset:13312
    ds_read_b128 a[200:203], v1 offset:13312
    ds_read_b128 a[192:195], v1 offset:12288
    v_max3_f32 v28, v32, v33, v34
    v_max3_f32 v30, v40, v41, v42
    v_max3_f32 v28, v28, v35, v36
    v_max3_f32 v28, v28, v37, v38
    v_max_f32 v28, v28, v39
    v_max3_f32 v30, v30, v43, v44
    v_mov_b32 v29, v28
    v_max3_f32 v30, v30, v45, v46
    v_max_f32 v30, v30, v47
    v_mov_b32 v31, v30
    v_permlane32_swap_b32 v29, v28
    v_max_f32 v28, v28, v29
    v_mov_b32 v29, v28
    v_permlane32_swap_b32 v31, v30
    s_add_u32 m0, s22, 0
    v_max_f32 v30, v30, v31
    v_permlane16_swap_b32 v29, v28
    v_max_f32 v28, v28, v29
    v_mul_f32_e64 v16, -s28, v28
    v_max3_f32 v28, v48, v49, v50
    v_max3_f32 v28, v28, v51, v52
    v_mov_b32 v31, v30
    v_fma_f32 v36, v36, s28, v16
    v_max3_f32 v28, v28, v53, v54
    v_fma_f32 v35, v35, s28, v16
    v_fma_f32 v32, v32, s28, v16
    v_permlane16_swap_b32 v31, v30
    v_max_f32 v28, v28, v55
    v_fma_f32 v39, v39, s28, v16
    v_fma_f32 v34, v34, s28, v16
    v_max_f32 v30, v30, v31
    v_exp_f32 v131, v35
    v_mov_b32 v29, v28
    v_mul_f32_e64 v17, -s28, v30
    s_waitcnt lgkmcnt(0)
    v_mfma_f32_16x16x32_bf16 v[64:67], a[192:195], a[96:99], 0
    ds_read_b128 a[208:211], v1 offset:14336
    buffer_load_dwordx4 v9, s[4:7], s20 offen lds
    v_exp_f32 v130, v34
    v_mfma_f32_16x16x32_bf16 v[64:67], a[196:199], a[100:103], v[64:67]
    s_add_u32 s20, s20, 128
    ds_read_b128 a[212:215], v2 offset:14336
    v_permlane32_swap_b32 v29, v28
    v_max_f32 v28, v28, v29
    v_fma_f32 v41, v41, s28, v17
    v_fma_f32 v40, v40, s28, v17
    v_exp_f32 v128, v32
    v_fma_f32 v37, v37, s28, v16
    v_fma_f32 v47, v47, s28, v17
    v_fma_f32 v33, v33, s28, v16
    v_mov_b32 v29, v28
    v_exp_f32 v135, v37
    v_exp_f32 v132, v40
    v_fma_f32 v38, v38, s28, v16
    v_exp_f32 v129, v33
    v_exp_f32 v133, v41
    v_permlane16_swap_b32 v29, v28
    v_cvt_pk_bf16_f32 v96, v128, v129
    v_exp_f32 v129, v39
    v_mfma_f32_16x16x32_bf16 v[64:67], a[200:203], a[104:107], v[64:67]
    s_add_u32 m0, s22, 1024
    ds_read_b128 a[228:231], v2 offset:19456
    buffer_load_dwordx4 v9, s[4:7], s20 offen lds
    v_cvt_pk_bf16_f32 v97, v130, v131
    v_mfma_f32_16x16x32_bf16 v[64:67], a[204:207], a[108:111], v[64:67]
    s_add_u32 s20, s20, 128
    ds_read_b128 a[216:219], v1 offset:18432
    v_fma_f32 v45, v45, s28, v17
    v_fma_f32 v42, v42, s28, v17
    v_max_f32 v28, v28, v29
    v_mul_f32_e64 v18, -s28, v28
    s_waitcnt lgkmcnt(2)
    v_mfma_f32_16x16x32_bf16 v[64:67], a[208:211], a[112:115], v[64:67]
    s_add_u32 m0, s22, 2048
    v_exp_f32 v134, v36
    v_mfma_f32_16x16x32_bf16 v[64:67], a[212:215], a[116:119], v[64:67]
    ds_read_b128 a[220:223], v2 offset:18432
    buffer_load_dwordx4 v9, s[4:7], s20 offen lds
    v_fma_f32 v43, v43, s28, v17
    v_mfma_f32_16x16x32_bf16 v[72:75], a[192:195], a[120:123], 0
    s_add_u32 s20, s20, 12032
    ds_read_b128 a[232:235], v1 offset:20480
    v_exp_f32 v128, v38
    v_fma_f32 v53, v53, s28, v18
    v_mfma_f32_16x16x32_bf16 v[72:75], a[196:199], a[124:127], v[72:75]
    s_add_u32 s37, s37, 1
    v_exp_f32 v131, v43
    v_fma_f32 v51, v51, s28, v18
    v_cvt_pk_bf16_f32 v98, v134, v135
    v_mfma_f32_16x16x32_bf16 v[72:75], a[200:203], a[128:131], v[72:75]
    s_add_u32 s35, s35, 325632
    s_lshl_b32 s42, s37, 1
    v_fma_f32 v46, v46, s28, v17
    s_lshr_b32 s42, s31, s42
    v_mfma_f32_16x16x32_bf16 v[72:75], a[204:207], a[132:135], v[72:75]
    s_xor_b32 s42, s42, s36
    s_and_b32 s42, s42, 3
    ds_read_b128 a[224:227], v1 offset:19456
    v_mfma_f32_16x16x32_bf16 v[72:75], a[208:211], a[136:139], v[72:75]
    s_mul_i32 s43, s3, 3
    s_lshl_b32 s44, s3, 2
    v_fma_f32 v52, v52, s28, v18
    v_cvt_pk_bf16_f32 v100, v132, v133
    v_mfma_f32_16x16x32_bf16 v[72:75], a[212:215], a[140:143], v[72:75]
    s_mov_b32 s32, 1
    ds_read_b128 a[236:239], v2 offset:20480
    v_exp_f32 v135, v47
    v_mfma_f32_16x16x32_bf16 v[80:83], a[192:195], a[144:147], 0
    s_add_u32 s45, s43, 17
    v_fma_f32 v49, v49, s28, v18
    v_fma_f32 v55, v55, s28, v18
    v_cvt_pk_bf16_f32 v99, v128, v129
    s_cmp_eq_u32 s3, 0
    v_mfma_f32_16x16x32_bf16 v[80:83], a[196:199], a[148:151], v[80:83]
    s_cselect_b32 s45, 16, s45
    v_exp_f32 v130, v42
    v_mfma_f32_16x16x32_bf16 v[80:83], a[200:203], a[152:155], v[80:83]
    s_cselect_b32 s33, 1, 0
    v_fma_f32 v50, v50, s28, v18
    v_exp_f32 v133, v45
    v_mfma_f32_16x16x32_bf16 v[80:83], a[204:207], a[156:159], v[80:83]
    s_cmp_eq_u32 s42, 1
    v_fma_f32 v44, v44, s28, v17
    v_exp_f32 v134, v46
    v_mfma_f32_16x16x32_bf16 v[80:83], a[208:211], a[160:163], v[80:83]
    s_cselect_b32 s44, s45, s44
    v_fma_f32 v66, v66, s28, v16
    v_exp_f32 v132, v44
    v_mfma_f32_16x16x32_bf16 v[20:23], a[240:243], v[96:99], 0
    s_cselect_b32 s32, s33, s32
    s_add_u32 s45, s43, 29
    v_cvt_pk_bf16_f32 v101, v130, v131
    v_exp_f32 v130, v50
    v_exp_f32 v129, v49
    v_exp_f32 v131, v51
    v_mfma_f32_16x16x32_bf16 v[80:83], a[212:215], a[164:167], v[80:83]
    s_waitcnt lgkmcnt(0)
    v_fma_f32 v65, v65, s28, v16
    v_fma_f32 v67, v67, s28, v16
    v_mfma_f32_16x16x32_bf16 v[68:71], a[216:219], a[96:99], 0
    s_cmp_eq_u32 s42, 2
    v_cvt_pk_bf16_f32 v102, v132, v133
    v_fma_f32 v48, v48, s28, v18
    v_mfma_f32_16x16x32_bf16 v[68:71], a[220:223], a[100:103], v[68:71]
    s_cselect_b32 s44, s45, s44
    v_exp_f32 v128, v48
    v_mfma_f32_16x16x32_bf16 v[68:71], a[224:227], a[104:107], v[68:71]
    s_cselect_b32 s32, 0, s32
    v_cvt_pk_bf16_f32 v104, v128, v129
    v_exp_f32 v132, v52
    v_mfma_f32_16x16x32_bf16 v[68:71], a[228:231], a[108:111], v[68:71]
    s_add_u32 s45, s43, 41
    s_cmp_eq_u32 s42, 3
    v_exp_f32 v129, v65
    v_cvt_pk_bf16_f32 v103, v134, v135
    s_cselect_b32 s44, s45, s44
    s_cselect_b32 s32, 0, s32
    s_mul_i32 s44, s44, 6144
    v_exp_f32 v133, v53
    v_mfma_f32_16x16x32_bf16 v[68:71], a[232:235], a[112:115], v[68:71]
    s_add_u32 s33, s35, s44
    v_fma_f32 v73, v73, s28, v17
    v_fma_f32 v72, v72, s28, v17
    v_mfma_f32_16x16x32_bf16 v[68:71], a[236:239], a[116:119], v[68:71]
    s_mul_i32 s42, s32, 6144
    v_exp_f32 v135, v55
    v_mfma_f32_16x16x32_bf16 v[20:23], a[244:247], v[100:103], v[20:23]
    s_add_u32 s42, s42, 18432
    v_cvt_pk_bf16_f32 v106, v132, v133
    v_cvt_pk_bf16_f32 v105, v130, v131
    v_exp_f32 v131, v67
    v_mfma_f32_16x16x32_bf16 v[76:79], a[216:219], a[120:123], 0
    s_add_u32 s42, s42, s33
    v_exp_f32 v133, v73
    s_cmp_ge_u32 s37, 8
    v_mfma_f32_16x16x32_bf16 v[76:79], a[220:223], a[124:127], v[76:79]
    s_cselect_b32 s14, 0, s42
    v_exp_f32 v132, v72
    s_add_u32 s25, s33, 128
    v_mfma_f32_16x16x32_bf16 v[76:79], a[224:227], a[128:131], v[76:79]
    s_add_u32 s23, s38, 2048
    v_fma_f32 v64, v64, s28, v16
    s_mov_b32 s30, 0
    s_waitcnt vmcnt(6)
    v_fma_f32 v54, v54, s28, v18
    v_exp_f32 v128, v64
    v_mfma_f32_16x16x32_bf16 v[76:79], a[228:231], a[132:135], v[76:79]
    s_barrier
    ds_read_b64_tr_b16 a[192:193], v3 offset:0
    v_mfma_f32_16x16x32_bf16 v[76:79], a[232:235], a[136:139], v[76:79]
    s_add_u32 m0, s22, 12288
    ds_read_b64_tr_b16 a[194:195], v3 offset:6144
    buffer_load_dwordx4 v9, s[4:7], s20 offen lds
    v_exp_f32 v130, v66
    v_exp_f32 v134, v54
    v_mfma_f32_16x16x32_bf16 v[76:79], a[236:239], a[140:143], v[76:79]
    ds_read_b64_tr_b16 a[196:197], v4 offset:0
    ds_read_b64_tr_b16 a[198:199], v4 offset:6144
    v_mfma_f32_16x16x32_bf16 v[84:87], a[216:219], a[144:147], 0
    s_add_u32 s20, s20, 128
    ds_read_b64_tr_b16 a[200:201], v5 offset:0
    ds_read_b64_tr_b16 a[202:203], v5 offset:6144
    v_mfma_f32_16x16x32_bf16 v[84:87], a[220:223], a[148:151], v[84:87]
    ds_read_b64_tr_b16 a[204:205], v6 offset:0
    v_cvt_pk_bf16_f32 v107, v134, v135
    v_mfma_f32_16x16x32_bf16 v[84:87], a[224:227], a[152:155], v[84:87]
    s_add_u32 m0, s22, 13312
    ds_read_b64_tr_b16 a[206:207], v6 offset:6144
    v_cvt_pk_bf16_f32 v116, v132, v133
    v_mfma_f32_16x16x32_bf16 v[84:87], a[228:231], a[156:159], v[84:87]
    ds_read_b64_tr_b16 a[208:209], v3 offset:1024
    buffer_load_dwordx4 v9, s[4:7], s20 offen lds
    v_mfma_f32_16x16x32_bf16 v[84:87], a[232:235], a[160:163], v[84:87]
    s_add_u32 s20, s20, 128
    ds_read_b64_tr_b16 a[210:211], v3 offset:7168
    ds_read_b64_tr_b16 a[212:213], v4 offset:1024
    v_mfma_f32_16x16x32_bf16 v[84:87], a[236:239], a[164:167], v[84:87]
    s_add_u32 m0, s22, 14336
    ds_read_b64_tr_b16 a[214:215], v4 offset:7168
    buffer_load_dwordx4 v9, s[4:7], s20 offen lds
    v_mfma_f32_16x16x32_bf16 v[20:23], a[248:251], v[104:107], v[20:23]
    s_add_u32 s20, s20, 12032
    v_cvt_pk_bf16_f32 v112, v128, v129
    v_cvt_pk_bf16_f32 v113, v130, v131
    v_fma_f32 v68, v68, s28, v16
    s_waitcnt lgkmcnt(10)
    v_mfma_f32_16x16x32_bf16 v[160:163], a[192:195], v[96:99], 0
    ds_read_b64_tr_b16 a[218:219], v5 offset:7168
    v_fma_f32 v69, v69, s28, v16
    v_fma_f32 v74, v74, s28, v17
    v_mfma_f32_16x16x32_bf16 v[208:211], a[192:195], v[100:103], 0
    ds_read_b64_tr_b16 a[238:239], v6 offset:8192
    v_fma_f32 v78, v78, s28, v17
    v_mfma_f32_16x16x32_bf16 a[0:3], a[192:195], v[104:107], 0
    s_waitcnt lgkmcnt(10)
    ds_read_b64_tr_b16 a[216:217], v5 offset:1024
    v_fma_f32 v77, v77, s28, v17
    v_mfma_f32_16x16x32_bf16 v[164:167], a[196:199], v[96:99], 0
    ds_read_b64_tr_b16 a[234:235], v5 offset:8192
    v_fma_f32 v76, v76, s28, v17
    v_mfma_f32_16x16x32_bf16 v[212:215], a[196:199], v[100:103], 0
    ds_read_b64_tr_b16 a[220:221], v6 offset:1024
    v_fma_f32 v82, v82, s28, v18
    v_mfma_f32_16x16x32_bf16 a[4:7], a[196:199], v[104:107], 0
    s_waitcnt lgkmcnt(11)
    ds_read_b64_tr_b16 a[228:229], v4 offset:2048
    v_fma_f32 v70, v70, s28, v16
    v_mfma_f32_16x16x32_bf16 v[168:171], a[200:203], v[96:99], 0
    ds_read_b64_tr_b16 a[236:237], v6 offset:2048
    v_fma_f32 v83, v83, s28, v18
    v_mfma_f32_16x16x32_bf16 v[216:219], a[200:203], v[100:103], 0
    ds_read_b64_tr_b16 a[230:231], v4 offset:8192
    v_mfma_f32_16x16x32_bf16 a[8:11], a[200:203], v[104:107], 0
    s_waitcnt lgkmcnt(9)
    ds_read_b64_tr_b16 a[226:227], v3 offset:8192
    v_fma_f32 v71, v71, s28, v16
    v_mfma_f32_16x16x32_bf16 v[172:175], a[204:207], v[96:99], 0
    ds_read_b64_tr_b16 a[232:233], v5 offset:2048
    v_fma_f32 v75, v75, s28, v17
    v_mfma_f32_16x16x32_bf16 v[220:223], a[204:207], v[100:103], 0
    ds_read_b64_tr_b16 a[224:225], v3 offset:2048
    v_fma_f32 v84, v84, s28, v18
    v_mfma_f32_16x16x32_bf16 a[12:15], a[204:207], v[104:107], 0
    ds_read_b64_tr_b16 a[222:223], v6 offset:7168
    v_fma_f32 v87, v87, s28, v18
    v_mfma_f32_16x16x32_bf16 v[176:179], a[208:211], v[96:99], 0
    v_exp_f32 v129, v71
    v_mfma_f32_16x16x32_bf16 v[224:227], a[208:211], v[100:103], 0
    v_exp_f32 v134, v68
    v_mfma_f32_16x16x32_bf16 a[16:19], a[208:211], v[104:107], 0
    s_waitcnt lgkmcnt(7)
    v_exp_f32 v128, v70
    v_mfma_f32_16x16x32_bf16 v[180:183], a[212:215], v[96:99], 0
    v_exp_f32 v135, v69
    v_mfma_f32_16x16x32_bf16 v[228:231], a[212:215], v[100:103], 0
    v_cvt_pk_bf16_f32 v114, v134, v135
    v_cvt_pk_bf16_f32 v115, v128, v129
    v_mfma_f32_16x16x32_bf16 a[20:23], a[212:215], v[104:107], 0
    v_exp_f32 v132, v76
    v_mfma_f32_16x16x32_bf16 v[24:27], a[240:243], v[112:115], v[20:23]
    v_exp_f32 v130, v74
    v_mfma_f32_16x16x32_bf16 v[184:187], a[216:219], v[96:99], 0
    v_exp_f32 v131, v75
    v_mfma_f32_16x16x32_bf16 v[232:235], a[216:219], v[100:103], 0
    v_exp_f32 v134, v78
    s_waitcnt vmcnt(3) lgkmcnt(0)
    v_mfma_f32_16x16x32_bf16 a[24:27], a[216:219], v[104:107], 0
    s_barrier
    v_mfma_f32_16x16x32_bf16 v[188:191], a[220:223], v[96:99], 0
    s_add_u32 m0, s22, 24576
    ds_read_b128 a[208:211], v1 offset:2048
    v_fma_f32 v81, v81, s28, v18
    v_mfma_f32_16x16x32_bf16 v[236:239], a[220:223], v[100:103], 0
    buffer_load_dwordx4 v9, s[8:11], s21 offen lds
    ds_read_b128 a[216:219], v1 offset:6144
    v_mfma_f32_16x16x32_bf16 a[28:31], a[220:223], v[104:107], 0
    s_add_u32 s21, s21, 128
    ds_read_b128 a[196:199], v2 offset:0
    v_cvt_pk_bf16_f32 v117, v130, v131
    v_mfma_f32_16x16x32_bf16 v[192:195], a[224:227], v[96:99], 0
    ds_read_b128 a[192:195], v1 offset:0
    v_fma_f32 v86, v86, s28, v18
    v_mfma_f32_16x16x32_bf16 v[240:243], a[224:227], v[100:103], 0
    s_add_u32 m0, s22, 25600
    ds_read_b128 a[200:203], v1 offset:1024
    v_fma_f32 v79, v79, s28, v17
    v_mfma_f32_16x16x32_bf16 a[32:35], a[224:227], v[104:107], 0
    buffer_load_dwordx4 v9, s[8:11], s21 offen lds
    v_mfma_f32_16x16x32_bf16 v[196:199], a[228:231], v[96:99], 0
    s_add_u32 s21, s21, 128
    ds_read_b128 a[212:215], v2 offset:2048
    v_exp_f32 v133, v77
    v_mfma_f32_16x16x32_bf16 v[244:247], a[228:231], v[100:103], 0
    s_add_u32 m0, s22, 26624
    v_exp_f32 v135, v79
    v_mfma_f32_16x16x32_bf16 a[36:39], a[228:231], v[104:107], 0
    ds_read_b128 a[204:207], v2 offset:1024
    buffer_load_dwordx4 v9, s[8:11], s21 offen lds
    v_mfma_f32_16x16x32_bf16 v[200:203], a[232:235], v[96:99], 0
    ds_read_b128 a[224:227], v1 offset:7168
    v_cvt_pk_bf16_f32 v118, v132, v133
    v_mfma_f32_16x16x32_bf16 v[248:251], a[232:235], v[100:103], 0
    s_add_u32 s21, s21, 12032
    v_exp_f32 v131, v83
    v_mfma_f32_16x16x32_bf16 a[40:43], a[232:235], v[104:107], 0
    s_add_u32 s58, s25, 4294967168
    ds_read_b128 a[220:223], v2 offset:6144
    v_fma_f32 v85, v85, s28, v18
    v_mfma_f32_16x16x32_bf16 v[204:207], a[236:239], v[96:99], 0
    s_add_u32 m0, s38, 0
    v_exp_f32 v130, v82
    v_mfma_f32_16x16x32_bf16 v[252:255], a[236:239], v[100:103], 0
    buffer_load_dwordx4 v10, s[12:15], s58 offen nt lds
    v_mfma_f32_16x16x32_bf16 a[44:47], a[236:239], v[104:107], 0
    s_waitcnt lgkmcnt(4)
    ds_read_b128 a[228:231], v2 offset:7168
    v_fma_f32 v80, v80, s28, v18
    v_mfma_f32_16x16x32_bf16 v[32:35], a[192:195], a[96:99], 0
    s_add_u32 m0, s38, 1024
    ds_read_b128 a[236:239], v2 offset:8192
    v_mfma_f32_16x16x32_bf16 v[32:35], a[196:199], a[100:103], v[32:35]
    buffer_load_dwordx4 v11, s[12:15], s58 offen nt lds
    v_mfma_f32_16x16x32_bf16 v[32:35], a[200:203], a[104:107], v[32:35]
    s_add_u32 s59, s25, 6016
    ds_read_b128 a[232:235], v1 offset:8192
    s_waitcnt lgkmcnt(5)
    v_mfma_f32_16x16x32_bf16 v[32:35], a[204:207], a[108:111], v[32:35]
    s_add_u32 m0, s38, 6144
    v_cvt_pk_bf16_f32 v121, v130, v131
    v_cvt_pk_bf16_f32 v119, v134, v135
    v_mfma_f32_16x16x32_bf16 v[32:35], a[208:211], a[112:115], v[32:35]
    buffer_load_dwordx4 v10, s[12:15], s59 offen nt lds
    v_mfma_f32_16x16x32_bf16 v[32:35], a[212:215], a[116:119], v[32:35]
    s_add_u32 m0, s38, 7168
    v_exp_f32 v129, v81
    v_mfma_f32_16x16x32_bf16 v[40:43], a[192:195], a[120:123], 0
    buffer_load_dwordx4 v11, s[12:15], s59 offen nt lds
    v_mfma_f32_16x16x32_bf16 v[40:43], a[196:199], a[124:127], v[40:43]
    s_add_u32 s58, s25, 12160
    v_exp_f32 v134, v86
    v_mfma_f32_16x16x32_bf16 v[40:43], a[200:203], a[128:131], v[40:43]
    s_add_u32 m0, s38, 12288
    v_exp_f32 v128, v80
    v_mfma_f32_16x16x32_bf16 v[40:43], a[204:207], a[132:135], v[40:43]
    buffer_load_dwordx4 v10, s[12:15], s58 offen nt lds
    v_mfma_f32_16x16x32_bf16 v[40:43], a[208:211], a[136:139], v[40:43]
    s_add_u32 m0, s38, 13312
    v_exp_f32 v133, v85
    v_mfma_f32_16x16x32_bf16 v[40:43], a[212:215], a[140:143], v[40:43]
    buffer_load_dwordx4 v11, s[12:15], s58 offen nt lds
    v_mfma_f32_16x16x32_bf16 v[48:51], a[192:195], a[144:147], 0
    s_add_u32 s59, s25, 18304
    v_cvt_pk_bf16_f32 v120, v128, v129
    s_add_u32 m0, s38, 18432
    v_mfma_f32_16x16x32_bf16 v[48:51], a[196:199], a[148:151], v[48:51]
    buffer_load_dwordx4 v10, s[12:15], s59 offen nt lds
    v_mfma_f32_16x16x32_bf16 v[24:27], a[244:247], v[116:119], v[24:27]
    v_exp_f32 v135, v87
    v_mfma_f32_16x16x32_bf16 v[48:51], a[200:203], a[152:155], v[48:51]
    s_add_u32 m0, s38, 19456
    v_exp_f32 v132, v84
    v_mfma_f32_16x16x32_bf16 v[48:51], a[204:207], a[156:159], v[48:51]
    buffer_load_dwordx4 v11, s[12:15], s59 offen nt lds
    v_mfma_f32_16x16x32_bf16 v[48:51], a[208:211], a[160:163], v[48:51]
    s_waitcnt vmcnt(17) lgkmcnt(0)
    v_cvt_pk_bf16_f32 v122, v132, v133
    v_cvt_pk_bf16_f32 v123, v134, v135
    v_mfma_f32_16x16x32_bf16 v[48:51], a[212:215], a[164:167], v[48:51]
    s_barrier
    v_mfma_f32_16x16x32_bf16 v[24:27], a[248:251], v[120:123], v[24:27]
    ds_read_b64_tr_b16 a[192:193], v3 offset:12288
    s_add_u32 m0, s22, 0
    v_mfma_f32_16x16x32_bf16 v[36:39], a[216:219], a[96:99], 0
    buffer_load_dwordx4 v9, s[4:7], s20 offen lds
    v_mfma_f32_16x16x32_bf16 v[36:39], a[220:223], a[100:103], v[36:39]
    s_add_u32 s20, s20, 128
    ds_read_b64_tr_b16 a[194:195], v3 offset:18432
    v_mfma_f32_16x16x32_bf16 v[36:39], a[224:227], a[104:107], v[36:39]
    ds_read_b64_tr_b16 a[196:197], v4 offset:12288
    v_cmp_lt_f32 vcc, s29, v24
    v_mfma_f32_16x16x32_bf16 v[36:39], a[228:231], a[108:111], v[36:39]
    s_add_u32 m0, s22, 1024
    ds_read_b64_tr_b16 a[198:199], v4 offset:18432
    buffer_load_dwordx4 v9, s[4:7], s20 offen lds
    v_mfma_f32_16x16x32_bf16 v[36:39], a[232:235], a[112:115], v[36:39]
    s_cbranch_vccnz L_rs_start3b
L_ret_start3b:
    ds_read_b64_tr_b16 a[200:201], v5 offset:12288
    v_mfma_f32_16x16x32_bf16 v[36:39], a[236:239], a[116:119], v[36:39]
    ds_read_b64_tr_b16 a[202:203], v5 offset:18432
    v_fma_f32 v40, v40, s28, v17
    v_mfma_f32_16x16x32_bf16 v[44:47], a[216:219], a[120:123], 0
    ds_read_b64_tr_b16 a[204:205], v6 offset:12288
    v_fma_f32 v32, v32, s28, v16
    v_mfma_f32_16x16x32_bf16 v[44:47], a[220:223], a[124:127], v[44:47]
    ds_read_b64_tr_b16 a[206:207], v6 offset:18432
    v_fma_f32 v33, v33, s28, v16
    v_mfma_f32_16x16x32_bf16 v[44:47], a[224:227], a[128:131], v[44:47]
    v_fma_f32 v34, v34, s28, v16
    v_exp_f32 v132, v40
    v_mfma_f32_16x16x32_bf16 v[44:47], a[228:231], a[132:135], v[44:47]
    v_exp_f32 v129, v33
    v_mfma_f32_16x16x32_bf16 v[44:47], a[232:235], a[136:139], v[44:47]
    s_add_u32 s20, s20, 128
    v_exp_f32 v130, v34
    v_mfma_f32_16x16x32_bf16 v[44:47], a[236:239], a[140:143], v[44:47]
    s_add_u32 m0, s22, 2048
    v_exp_f32 v128, v32
    v_mfma_f32_16x16x32_bf16 v[52:55], a[216:219], a[144:147], 0
    ds_read_b64_tr_b16 a[208:209], v3 offset:13312
    v_fma_f32 v35, v35, s28, v16
    v_mfma_f32_16x16x32_bf16 v[52:55], a[220:223], a[148:151], v[52:55]
    v_fma_f32 v41, v41, s28, v17
    v_exp_f32 v131, v35
    v_mfma_f32_16x16x32_bf16 v[52:55], a[224:227], a[152:155], v[52:55]
    v_exp_f32 v133, v41
    v_mfma_f32_16x16x32_bf16 v[52:55], a[228:231], a[156:159], v[52:55]
    ds_read_b64_tr_b16 a[210:211], v3 offset:19456
    buffer_load_dwordx4 v9, s[4:7], s20 offen lds
    v_mfma_f32_16x16x32_bf16 v[52:55], a[232:235], a[160:163], v[52:55]
    s_add_u32 s20, s20, 12032
    ds_read_b64_tr_b16 a[212:213], v4 offset:13312
    v_cvt_pk_bf16_f32 v100, v132, v133
    v_mfma_f32_16x16x32_bf16 v[52:55], a[236:239], a[164:167], v[52:55]
    ds_read_b64_tr_b16 a[214:215], v4 offset:19456
    v_cvt_pk_bf16_f32 v97, v130, v131
    v_cvt_pk_bf16_f32 v96, v128, v129
    s_branch L_loop3
L_loop4:
    s_bitcmp1_b32 s3, 1
    s_cbranch_scc1 L_loop4w1
    .p2align 6
L_loop4w0:
    s_waitcnt lgkmcnt(10)
    v_mfma_f32_16x16x32_bf16 v[160:163], a[192:195], v[112:115], v[160:163]
    v_fma_f32 v37, v37, s28, v16
    v_fma_f32 v38, v38, s28, v16
    v_mfma_f32_16x16x32_bf16 v[208:211], a[192:195], v[116:119], v[208:211]
    v_fma_f32 v45, v45, s28, v17
    v_fma_f32 v43, v43, s28, v17
    v_mfma_f32_16x16x32_bf16 a[0:3], a[192:195], v[120:123], a[0:3]
    v_exp_f32 v128, v38
    v_mfma_f32_16x16x32_bf16 a[48:51], a[192:195], v[124:127], a[48:51]
    ds_read_b64_tr_b16 a[234:235], v5 offset:20480
    s_waitcnt lgkmcnt(9)
    v_mfma_f32_16x16x32_bf16 v[164:167], a[196:199], v[112:115], v[164:167]
    v_fma_f32 v60, v60, s28, v19
    v_fma_f32 v39, v39, s28, v16
    v_fma_f32 v59, v59, s28, v19
    v_mfma_f32_16x16x32_bf16 v[212:215], a[196:199], v[116:119], v[212:215]
    ds_read_b64_tr_b16 a[218:219], v5 offset:19456
    ds_read_b64_tr_b16 a[228:229], v4 offset:14336
    v_mfma_f32_16x16x32_bf16 a[4:7], a[196:199], v[120:123], a[4:7]
    v_fma_f32 v36, v36, s28, v16
    v_fma_f32 v52, v52, s28, v18
    v_mfma_f32_16x16x32_bf16 a[52:55], a[196:199], v[124:127], a[52:55]
    s_waitcnt lgkmcnt(9)
    v_exp_f32 v131, v43
    v_mfma_f32_16x16x32_bf16 v[168:171], a[200:203], v[112:115], v[168:171]
    ds_read_b64_tr_b16 a[238:239], v6 offset:20480
    v_fma_f32 v50, v50, s28, v18
    v_mfma_f32_16x16x32_bf16 v[216:219], a[200:203], v[116:119], v[216:219]
    ds_read_b64_tr_b16 a[236:237], v6 offset:14336
    ds_read_b64_tr_b16 a[222:223], v6 offset:19456
    v_mfma_f32_16x16x32_bf16 a[8:11], a[200:203], v[120:123], a[8:11]
    v_exp_f32 v134, v36
    v_mfma_f32_16x16x32_bf16 a[56:59], a[200:203], v[124:127], a[56:59]
    s_waitcnt lgkmcnt(6)
    v_exp_f32 v135, v37
    v_mfma_f32_16x16x32_bf16 v[172:175], a[204:207], v[112:115], v[172:175]
    ds_read_b64_tr_b16 a[220:221], v6 offset:13312
    ds_read_b64_tr_b16 a[224:225], v3 offset:14336
    v_mfma_f32_16x16x32_bf16 v[220:223], a[204:207], v[116:119], v[220:223]
    ds_read_b64_tr_b16 a[216:217], v5 offset:13312
    ds_read_b64_tr_b16 a[232:233], v5 offset:14336
    v_mfma_f32_16x16x32_bf16 a[12:15], a[204:207], v[120:123], a[12:15]
    ds_read_b64_tr_b16 a[226:227], v3 offset:20480
    ds_read_b64_tr_b16 a[230:231], v4 offset:20480
    v_mfma_f32_16x16x32_bf16 a[60:63], a[204:207], v[124:127], a[60:63]
    v_fma_f32 v46, v46, s28, v17
    v_fma_f32 v61, v61, s28, v19
    v_mfma_f32_16x16x32_bf16 v[176:179], a[208:211], v[112:115], v[176:179]
    v_exp_f32 v129, v39
    v_mfma_f32_16x16x32_bf16 v[224:227], a[208:211], v[116:119], v[224:227]
    v_fma_f32 v47, v47, s28, v17
    v_fma_f32 v42, v42, s28, v17
    v_mfma_f32_16x16x32_bf16 a[16:19], a[208:211], v[120:123], a[16:19]
    v_cvt_pk_bf16_f32 v99, v128, v129
    v_fma_f32 v48, v48, s28, v18
    v_mfma_f32_16x16x32_bf16 a[64:67], a[208:211], v[124:127], a[64:67]
    v_cvt_pk_bf16_f32 v98, v134, v135
    v_fma_f32 v51, v51, s28, v18
    v_mfma_f32_16x16x32_bf16 v[180:183], a[212:215], v[112:115], v[180:183]
    v_exp_f32 v134, v46
    v_mfma_f32_16x16x32_bf16 v[228:231], a[212:215], v[116:119], v[228:231]
    v_exp_f32 v130, v42
    v_mfma_f32_16x16x32_bf16 a[20:23], a[212:215], v[120:123], a[20:23]
    v_cvt_pk_bf16_f32 v101, v130, v131
    v_fma_f32 v44, v44, s28, v17
    v_mfma_f32_16x16x32_bf16 a[68:71], a[212:215], v[124:127], a[68:71]
    s_waitcnt lgkmcnt(2)
    v_exp_f32 v133, v45
    v_mfma_f32_16x16x32_bf16 v[184:187], a[216:219], v[112:115], v[184:187]
    v_exp_f32 v135, v47
    v_mfma_f32_16x16x32_bf16 v[232:235], a[216:219], v[116:119], v[232:235]
    s_waitcnt vmcnt(10) lgkmcnt(0)
    v_exp_f32 v132, v44
    v_mfma_f32_16x16x32_bf16 v[20:23], a[240:243], v[96:99], v[24:27]
    s_add_u32 m0, s22, 36864
    v_cvt_pk_bf16_f32 v102, v132, v133
    v_cvt_pk_bf16_f32 v103, v134, v135
    v_mfma_f32_16x16x32_bf16 a[24:27], a[216:219], v[120:123], a[24:27]
    v_exp_f32 v131, v51
    v_mfma_f32_16x16x32_bf16 v[20:23], a[244:247], v[100:103], v[20:23]
    s_barrier
    v_mfma_f32_16x16x32_bf16 a[72:75], a[216:219], v[124:127], a[72:75]
    ds_read_b128 a[200:203], v1 offset:13312
    v_fma_f32 v54, v54, s28, v18
    v_mfma_f32_16x16x32_bf16 v[188:191], a[220:223], v[112:115], v[188:191]
    buffer_load_dwordx4 v9, s[8:11], s21 offen lds
    v_mfma_f32_16x16x32_bf16 v[236:239], a[220:223], v[116:119], v[236:239]
    s_add_u32 s21, s21, 128
    v_fma_f32 v55, v55, s28, v18
    s_add_u32 m0, s22, 37888
    v_mfma_f32_16x16x32_bf16 a[28:31], a[220:223], v[120:123], a[28:31]
    ds_read_b128 a[192:195], v1 offset:12288
    v_fma_f32 v53, v53, s28, v18
    v_mfma_f32_16x16x32_bf16 a[76:79], a[220:223], v[124:127], a[76:79]
    buffer_load_dwordx4 v9, s[8:11], s21 offen lds
    v_mfma_f32_16x16x32_bf16 v[192:195], a[224:227], v[112:115], v[192:195]
    v_exp_f32 v132, v52
    v_mfma_f32_16x16x32_bf16 v[240:243], a[224:227], v[116:119], v[240:243]
    v_fma_f32 v58, v58, s28, v19
    v_mfma_f32_16x16x32_bf16 a[32:35], a[224:227], v[120:123], a[32:35]
    v_exp_f32 v128, v48
    v_mfma_f32_16x16x32_bf16 a[80:83], a[224:227], v[124:127], a[80:83]
    ds_read_b128 a[196:199], v2 offset:12288
    s_add_u32 s21, s21, 128
    v_mfma_f32_16x16x32_bf16 v[196:199], a[228:231], v[112:115], v[196:199]
    ds_read_b128 a[212:215], v2 offset:14336
    v_mfma_f32_16x16x32_bf16 v[244:247], a[228:231], v[116:119], v[244:247]
    v_mfma_f32_16x16x32_bf16 a[36:39], a[228:231], v[120:123], a[36:39]
    v_exp_f32 v133, v53
    v_mfma_f32_16x16x32_bf16 a[84:87], a[228:231], v[124:127], a[84:87]
    s_add_u32 m0, s22, 38912
    ds_read_b128 a[208:211], v1 offset:14336
    v_mfma_f32_16x16x32_bf16 v[200:203], a[232:235], v[112:115], v[200:203]
    ds_read_b128 a[204:207], v2 offset:13312
    v_cvt_pk_bf16_f32 v106, v132, v133
    v_mfma_f32_16x16x32_bf16 v[248:251], a[232:235], v[116:119], v[248:251]
    v_exp_f32 v130, v50
    v_mfma_f32_16x16x32_bf16 a[40:43], a[232:235], v[120:123], a[40:43]
    ds_read_b128 a[216:219], v1 offset:18432
    v_fma_f32 v49, v49, s28, v18
    v_mfma_f32_16x16x32_bf16 a[88:91], a[232:235], v[124:127], a[88:91]
    buffer_load_dwordx4 v9, s[8:11], s21 offen lds
    v_mfma_f32_16x16x32_bf16 v[204:207], a[236:239], v[112:115], v[204:207]
    v_exp_f32 v135, v55
    v_mfma_f32_16x16x32_bf16 v[252:255], a[236:239], v[116:119], v[252:255]
    v_exp_f32 v134, v54
    v_mfma_f32_16x16x32_bf16 a[44:47], a[236:239], v[120:123], a[44:47]
    v_exp_f32 v129, v49
    v_mfma_f32_16x16x32_bf16 a[92:95], a[236:239], v[124:127], a[92:95]
    s_waitcnt lgkmcnt(3)
    ds_read_b128 a[232:235], v1 offset:20480
    v_cvt_pk_bf16_f32 v105, v130, v131
    v_mfma_f32_16x16x32_bf16 v[64:67], a[192:195], a[96:99], 0
    v_cvt_pk_bf16_f32 v107, v134, v135
    v_cvt_pk_bf16_f32 v104, v128, v129
    v_mfma_f32_16x16x32_bf16 v[64:67], a[196:199], a[100:103], v[64:67]
    ds_read_b128 a[220:223], v2 offset:18432
    v_mfma_f32_16x16x32_bf16 v[64:67], a[200:203], a[104:107], v[64:67]
    s_waitcnt lgkmcnt(3)
    ds_read_b128 a[224:227], v1 offset:19456
    v_mfma_f32_16x16x32_bf16 v[64:67], a[204:207], a[108:111], v[64:67]
    v_exp_f32 v130, v58
    v_mfma_f32_16x16x32_bf16 v[64:67], a[208:211], a[112:115], v[64:67]
    v_mfma_f32_16x16x32_bf16 v[20:23], a[248:251], v[104:107], v[20:23]
    v_mfma_f32_16x16x32_bf16 v[64:67], a[212:215], a[116:119], v[64:67]
    v_exp_f32 v132, v60
    v_mfma_f32_16x16x32_bf16 v[72:75], a[192:195], a[120:123], 0
    v_fma_f32 v56, v56, s28, v19
    v_fma_f32 v63, v63, s28, v19
    v_mfma_f32_16x16x32_bf16 v[72:75], a[196:199], a[124:127], v[72:75]
    v_exp_f32 v133, v61
    v_mfma_f32_16x16x32_bf16 v[72:75], a[200:203], a[128:131], v[72:75]
    v_fma_f32 v57, v57, s28, v19
    v_mfma_f32_16x16x32_bf16 v[72:75], a[204:207], a[132:135], v[72:75]
    ds_read_b128 a[236:239], v2 offset:20480
    v_fma_f32 v62, v62, s28, v19
    v_mfma_f32_16x16x32_bf16 v[72:75], a[208:211], a[136:139], v[72:75]
    s_add_u32 s21, s21, 12032
    ds_read_b128 a[228:231], v2 offset:19456
    v_mfma_f32_16x16x32_bf16 v[72:75], a[212:215], a[140:143], v[72:75]
    v_exp_f32 v134, v62
    v_mfma_f32_16x16x32_bf16 v[80:83], a[192:195], a[144:147], 0
    v_exp_f32 v128, v56
    v_mfma_f32_16x16x32_bf16 v[80:83], a[196:199], a[148:151], v[80:83]
    v_exp_f32 v129, v57
    v_mfma_f32_16x16x32_bf16 v[80:83], a[200:203], a[152:155], v[80:83]
    v_exp_f32 v135, v63
    v_mfma_f32_16x16x32_bf16 v[80:83], a[204:207], a[156:159], v[80:83]
    v_exp_f32 v131, v59
    v_mfma_f32_16x16x32_bf16 v[80:83], a[208:211], a[160:163], v[80:83]
    v_cvt_pk_bf16_f32 v108, v128, v129
    v_cvt_pk_bf16_f32 v111, v134, v135
    v_mfma_f32_16x16x32_bf16 v[80:83], a[212:215], a[164:167], v[80:83]
    v_cvt_pk_bf16_f32 v110, v132, v133
    v_mfma_f32_16x16x32_bf16 v[88:91], a[192:195], a[168:171], 0
    v_cvt_pk_bf16_f32 v109, v130, v131
    v_mfma_f32_16x16x32_bf16 v[88:91], a[196:199], a[172:175], v[88:91]
    v_mfma_f32_16x16x32_bf16 v[88:91], a[200:203], a[176:179], v[88:91]
    s_waitcnt vmcnt(9) lgkmcnt(0)
    v_mfma_f32_16x16x32_bf16 v[20:23], a[252:255], v[108:111], v[20:23]
    v_mfma_f32_16x16x32_bf16 v[88:91], a[204:207], a[180:183], v[88:91]
    v_mfma_f32_16x16x32_bf16 v[88:91], a[208:211], a[184:187], v[88:91]
    s_barrier
    v_mfma_f32_16x16x32_bf16 v[88:91], a[212:215], a[188:191], v[88:91]
    s_add_u32 m0, s22, 12288
    ds_read_b64_tr_b16 a[192:193], v3 offset:0
    v_mfma_f32_16x16x32_bf16 v[68:71], a[216:219], a[96:99], 0
    buffer_load_dwordx4 v9, s[4:7], s20 offen lds
    v_mfma_f32_16x16x32_bf16 v[68:71], a[220:223], a[100:103], v[68:71]
    s_add_u32 s20, s20, 128
    v_cmp_lt_f32 vcc, s29, v20
    v_mfma_f32_16x16x32_bf16 v[68:71], a[224:227], a[104:107], v[68:71]
    s_add_u32 m0, s22, 13312
    ds_read_b64_tr_b16 a[194:195], v3 offset:6144
    ds_read_b64_tr_b16 a[196:197], v4 offset:0
    v_mfma_f32_16x16x32_bf16 v[68:71], a[228:231], a[108:111], v[68:71]
    s_cbranch_vccnz L_rs_loop4w0a
L_ret_loop4w0a:
    v_mfma_f32_16x16x32_bf16 v[68:71], a[232:235], a[112:115], v[68:71]
    v_fma_f32 v64, v64, s28, v16
    v_mfma_f32_16x16x32_bf16 v[68:71], a[236:239], a[116:119], v[68:71]
    ds_read_b64_tr_b16 a[198:199], v4 offset:6144
    v_fma_f32 v66, v66, s28, v16
    v_mfma_f32_16x16x32_bf16 v[76:79], a[216:219], a[120:123], 0
    ds_read_b64_tr_b16 a[200:201], v5 offset:0
    v_fma_f32 v72, v72, s28, v17
    v_mfma_f32_16x16x32_bf16 v[76:79], a[220:223], a[124:127], v[76:79]
    buffer_load_dwordx4 v9, s[4:7], s20 offen lds
    v_mfma_f32_16x16x32_bf16 v[76:79], a[224:227], a[128:131], v[76:79]
    ds_read_b64_tr_b16 a[202:203], v5 offset:6144
    v_mfma_f32_16x16x32_bf16 v[76:79], a[228:231], a[132:135], v[76:79]
    v_exp_f32 v132, v72
    v_mfma_f32_16x16x32_bf16 v[76:79], a[232:235], a[136:139], v[76:79]
    v_fma_f32 v65, v65, s28, v16
    s_add_u32 s20, s20, 128
    v_mfma_f32_16x16x32_bf16 v[76:79], a[236:239], a[140:143], v[76:79]
    v_exp_f32 v129, v65
    v_mfma_f32_16x16x32_bf16 v[84:87], a[216:219], a[144:147], 0
    ds_read_b64_tr_b16 a[204:205], v6 offset:0
    v_fma_f32 v73, v73, s28, v17
    v_mfma_f32_16x16x32_bf16 v[84:87], a[220:223], a[148:151], v[84:87]
    v_exp_f32 v128, v64
    v_mfma_f32_16x16x32_bf16 v[84:87], a[224:227], a[152:155], v[84:87]
    s_add_u32 m0, s22, 14336
    v_fma_f32 v67, v67, s28, v16
    v_cvt_pk_bf16_f32 v112, v128, v129
    v_mfma_f32_16x16x32_bf16 v[84:87], a[228:231], a[156:159], v[84:87]
    buffer_load_dwordx4 v9, s[4:7], s20 offen lds
    v_mfma_f32_16x16x32_bf16 v[84:87], a[232:235], a[160:163], v[84:87]
    s_add_u32 s20, s20, 12032
    ds_read_b64_tr_b16 a[206:207], v6 offset:6144
    ds_read_b64_tr_b16 a[208:209], v3 offset:1024
    v_mfma_f32_16x16x32_bf16 v[84:87], a[236:239], a[164:167], v[84:87]
    v_exp_f32 v131, v67
    v_mfma_f32_16x16x32_bf16 v[92:95], a[216:219], a[168:171], 0
    ds_read_b64_tr_b16 a[210:211], v3 offset:7168
    v_mfma_f32_16x16x32_bf16 v[92:95], a[220:223], a[172:175], v[92:95]
    v_exp_f32 v133, v73
    v_mfma_f32_16x16x32_bf16 v[92:95], a[224:227], a[176:179], v[92:95]
    v_exp_f32 v130, v66
    v_mfma_f32_16x16x32_bf16 v[92:95], a[228:231], a[180:183], v[92:95]
    v_cvt_pk_bf16_f32 v113, v130, v131
    v_cvt_pk_bf16_f32 v116, v132, v133
    v_mfma_f32_16x16x32_bf16 v[92:95], a[232:235], a[184:187], v[92:95]
    ds_read_b64_tr_b16 a[212:213], v4 offset:1024
    v_mfma_f32_16x16x32_bf16 v[92:95], a[236:239], a[188:191], v[92:95]
    ds_read_b64_tr_b16 a[214:215], v4 offset:7168
    v_fma_f32 v70, v70, s28, v16
    s_waitcnt lgkmcnt(10)
    v_mfma_f32_16x16x32_bf16 v[160:163], a[192:195], v[96:99], v[160:163]
    ds_read_b64_tr_b16 a[224:225], v3 offset:2048
    v_fma_f32 v69, v69, s28, v16
    v_mfma_f32_16x16x32_bf16 v[208:211], a[192:195], v[100:103], v[208:211]
    v_fma_f32 v78, v78, s28, v17
    v_fma_f32 v74, v74, s28, v17
    v_mfma_f32_16x16x32_bf16 a[0:3], a[192:195], v[104:107], a[0:3]
    v_exp_f32 v128, v70
    v_mfma_f32_16x16x32_bf16 a[48:51], a[192:195], v[108:111], a[48:51]
    ds_read_b64_tr_b16 a[226:227], v3 offset:8192
    s_waitcnt lgkmcnt(10)
    v_mfma_f32_16x16x32_bf16 v[164:167], a[196:199], v[96:99], v[164:167]
    ds_read_b64_tr_b16 a[234:235], v5 offset:8192
    ds_read_b64_tr_b16 a[232:233], v5 offset:2048
    v_mfma_f32_16x16x32_bf16 v[212:215], a[196:199], v[100:103], v[212:215]
    ds_read_b64_tr_b16 a[216:217], v5 offset:1024
    ds_read_b64_tr_b16 a[236:237], v6 offset:2048
    v_mfma_f32_16x16x32_bf16 a[4:7], a[196:199], v[104:107], a[4:7]
    ds_read_b64_tr_b16 a[230:231], v4 offset:8192
    v_fma_f32 v83, v83, s28, v18
    v_mfma_f32_16x16x32_bf16 a[52:55], a[196:199], v[108:111], a[52:55]
    s_waitcnt lgkmcnt(13)
    ds_read_b64_tr_b16 a[218:219], v5 offset:7168
    v_fma_f32 v77, v77, s28, v17
    v_mfma_f32_16x16x32_bf16 v[168:171], a[200:203], v[96:99], v[168:171]
    v_exp_f32 v130, v74
    v_mfma_f32_16x16x32_bf16 v[216:219], a[200:203], v[100:103], v[216:219]
    v_fma_f32 v79, v79, s28, v17
    v_fma_f32 v71, v71, s28, v16
    v_mfma_f32_16x16x32_bf16 a[8:11], a[200:203], v[104:107], a[8:11]
    v_fma_f32 v93, v93, s28, v19
    v_fma_f32 v76, v76, s28, v17
    v_mfma_f32_16x16x32_bf16 a[56:59], a[200:203], v[108:111], a[56:59]
    s_waitcnt lgkmcnt(7)
    v_exp_f32 v135, v69
    v_mfma_f32_16x16x32_bf16 v[172:175], a[204:207], v[96:99], v[172:175]
    ds_read_b64_tr_b16 a[222:223], v6 offset:7168
    v_fma_f32 v75, v75, s28, v17
    v_mfma_f32_16x16x32_bf16 v[220:223], a[204:207], v[100:103], v[220:223]
    ds_read_b64_tr_b16 a[228:229], v4 offset:2048
    v_fma_f32 v82, v82, s28, v18
    v_mfma_f32_16x16x32_bf16 a[12:15], a[204:207], v[104:107], a[12:15]
    v_exp_f32 v129, v71
    v_mfma_f32_16x16x32_bf16 a[60:63], a[204:207], v[108:111], a[60:63]
    ds_read_b64_tr_b16 a[238:239], v6 offset:8192
    ds_read_b64_tr_b16 a[220:221], v6 offset:1024
    v_mfma_f32_16x16x32_bf16 v[176:179], a[208:211], v[96:99], v[176:179]
    v_fma_f32 v92, v92, s28, v19
    v_fma_f32 v68, v68, s28, v16
    v_mfma_f32_16x16x32_bf16 v[224:227], a[208:211], v[100:103], v[224:227]
    v_exp_f32 v132, v76
    v_mfma_f32_16x16x32_bf16 a[16:19], a[208:211], v[104:107], a[16:19]
    v_exp_f32 v131, v75
    v_mfma_f32_16x16x32_bf16 a[64:67], a[208:211], v[108:111], a[64:67]
    v_exp_f32 v134, v68
    v_mfma_f32_16x16x32_bf16 v[180:183], a[212:215], v[96:99], v[180:183]
    v_exp_f32 v133, v77
    v_mfma_f32_16x16x32_bf16 v[228:231], a[212:215], v[100:103], v[228:231]
    v_fma_f32 v87, v87, s28, v18
    v_cvt_pk_bf16_f32 v114, v134, v135
    v_mfma_f32_16x16x32_bf16 a[20:23], a[212:215], v[104:107], a[20:23]
    v_exp_f32 v135, v79
    v_mfma_f32_16x16x32_bf16 a[68:71], a[212:215], v[108:111], a[68:71]
    s_waitcnt lgkmcnt(2)
    v_cvt_pk_bf16_f32 v118, v132, v133
    v_cvt_pk_bf16_f32 v115, v128, v129
    v_mfma_f32_16x16x32_bf16 v[184:187], a[216:219], v[96:99], v[184:187]
    v_exp_f32 v134, v78
    v_mfma_f32_16x16x32_bf16 v[232:235], a[216:219], v[100:103], v[232:235]
    s_waitcnt vmcnt(6) lgkmcnt(0)
    v_cvt_pk_bf16_f32 v117, v130, v131
    v_cvt_pk_bf16_f32 v119, v134, v135
    v_mfma_f32_16x16x32_bf16 v[24:27], a[240:243], v[112:115], v[20:23]
    v_exp_f32 v131, v83
    v_mfma_f32_16x16x32_bf16 v[24:27], a[244:247], v[116:119], v[24:27]
    v_fma_f32 v85, v85, s28, v18
    v_fma_f32 v88, v88, s28, v19
    v_mfma_f32_16x16x32_bf16 a[24:27], a[216:219], v[104:107], a[24:27]
    s_barrier
    v_mfma_f32_16x16x32_bf16 a[72:75], a[216:219], v[108:111], a[72:75]
    ds_read_b128 a[192:195], v1 offset:0
    v_mfma_f32_16x16x32_bf16 v[188:191], a[220:223], v[96:99], v[188:191]
    ds_read_b128 a[212:215], v2 offset:2048
    v_fma_f32 v90, v90, s28, v19
    v_mfma_f32_16x16x32_bf16 v[236:239], a[220:223], v[100:103], v[236:239]
    ds_read_b128 a[208:211], v1 offset:2048
    v_fma_f32 v89, v89, s28, v19
    v_mfma_f32_16x16x32_bf16 a[28:31], a[220:223], v[104:107], a[28:31]
    s_add_u32 m0, s22, 24576
    ds_read_b128 a[200:203], v1 offset:1024
    v_fma_f32 v81, v81, s28, v18
    v_mfma_f32_16x16x32_bf16 a[76:79], a[220:223], v[108:111], a[76:79]
    buffer_load_dwordx4 v9, s[8:11], s21 offen lds
    v_mfma_f32_16x16x32_bf16 v[192:195], a[224:227], v[96:99], v[192:195]
    s_add_u32 s21, s21, 128
    v_exp_f32 v130, v82
    v_mfma_f32_16x16x32_bf16 v[240:243], a[224:227], v[100:103], v[240:243]
    ds_read_b128 v[136:139], v13 offset:0
    v_mfma_f32_16x16x32_bf16 a[32:35], a[224:227], v[104:107], a[32:35]
    s_add_u32 m0, s22, 25600
    ds_read_b128 v[140:143], v13 offset:1024
    v_fma_f32 v84, v84, s28, v18
    v_mfma_f32_16x16x32_bf16 a[80:83], a[224:227], v[108:111], a[80:83]
    v_fma_f32 v80, v80, s28, v18
    v_cvt_pk_bf16_f32 v121, v130, v131
    v_mfma_f32_16x16x32_bf16 v[196:199], a[228:231], v[96:99], v[196:199]
    v_exp_f32 v128, v80
    v_mfma_f32_16x16x32_bf16 v[244:247], a[228:231], v[100:103], v[244:247]
    ds_read_b128 a[196:199], v2 offset:0
    v_mfma_f32_16x16x32_bf16 a[36:39], a[228:231], v[104:107], a[36:39]
    buffer_load_dwordx4 v9, s[8:11], s21 offen lds
    v_mfma_f32_16x16x32_bf16 a[84:87], a[228:231], v[108:111], a[84:87]
    ds_read_b128 a[204:207], v2 offset:1024
    v_mfma_f32_16x16x32_bf16 v[200:203], a[232:235], v[96:99], v[200:203]
    s_add_u32 s21, s21, 128
    ds_read_b128 a[224:227], v1 offset:7168
    v_mfma_f32_16x16x32_bf16 v[248:251], a[232:235], v[100:103], v[248:251]
    s_add_u32 m0, s22, 26624
    v_fma_f32 v94, v94, s28, v19
    v_fma_f32 v86, v86, s28, v18
    v_mfma_f32_16x16x32_bf16 a[40:43], a[232:235], v[104:107], a[40:43]
    buffer_load_dwordx4 v9, s[8:11], s21 offen lds
    v_mfma_f32_16x16x32_bf16 a[88:91], a[232:235], v[108:111], a[88:91]
    v_exp_f32 v135, v87
    v_mfma_f32_16x16x32_bf16 v[204:207], a[236:239], v[96:99], v[204:207]
    v_exp_f32 v134, v86
    v_mfma_f32_16x16x32_bf16 v[252:255], a[236:239], v[100:103], v[252:255]
    v_exp_f32 v132, v84
    v_mfma_f32_16x16x32_bf16 a[44:47], a[236:239], v[104:107], a[44:47]
    v_fma_f32 v91, v91, s28, v19
    v_mfma_f32_16x16x32_bf16 a[92:95], a[236:239], v[108:111], a[92:95]
    s_waitcnt lgkmcnt(2)
    v_exp_f32 v133, v85
    v_mfma_f32_16x16x32_bf16 v[32:35], a[192:195], a[96:99], 0
    v_exp_f32 v129, v81
    v_mfma_f32_16x16x32_bf16 v[32:35], a[196:199], a[100:103], v[32:35]
    v_cvt_pk_bf16_f32 v123, v134, v135
    v_cvt_pk_bf16_f32 v122, v132, v133
    v_mfma_f32_16x16x32_bf16 v[32:35], a[200:203], a[104:107], v[32:35]
    s_waitcnt lgkmcnt(0)
    ds_read_b128 a[220:223], v2 offset:6144
    s_add_u32 s21, s21, 12032
    v_mfma_f32_16x16x32_bf16 v[32:35], a[204:207], a[108:111], v[32:35]
    ds_read_b128 a[216:219], v1 offset:6144
    v_mfma_f32_16x16x32_bf16 v[32:35], a[208:211], a[112:115], v[32:35]
    buffer_store_dwordx4 v[136:139], v12, s[16:19], s24 offen offset:0 sc0 sc1 nt
    ds_read_b128 a[228:231], v2 offset:7168
    v_exp_f32 v130, v90
    v_mfma_f32_16x16x32_bf16 v[32:35], a[212:215], a[116:119], v[32:35]
    s_add_u32 m0, s23, 0
    v_exp_f32 v134, v94
    v_mfma_f32_16x16x32_bf16 v[40:43], a[192:195], a[120:123], 0
    ds_read_b128 a[236:239], v2 offset:8192
    v_mfma_f32_16x16x32_bf16 v[40:43], a[196:199], a[124:127], v[40:43]
    v_cvt_pk_bf16_f32 v120, v128, v129
    v_mfma_f32_16x16x32_bf16 v[40:43], a[200:203], a[128:131], v[40:43]
    buffer_store_dwordx4 v[140:143], v12, s[16:19], s24 offen offset:3072 sc0 sc1 nt
    ds_read_b128 a[232:235], v1 offset:8192
    v_exp_f32 v132, v92
    v_mfma_f32_16x16x32_bf16 v[40:43], a[204:207], a[132:135], v[40:43]
    v_exp_f32 v133, v93
    v_mfma_f32_16x16x32_bf16 v[40:43], a[208:211], a[136:139], v[40:43]
    v_fma_f32 v95, v95, s28, v19
    v_cvt_pk_bf16_f32 v126, v132, v133
    v_mfma_f32_16x16x32_bf16 v[40:43], a[212:215], a[140:143], v[40:43]
    buffer_load_dwordx4 v10, s[12:15], s25 offen nt lds
    v_mfma_f32_16x16x32_bf16 v[48:51], a[192:195], a[144:147], 0
    v_exp_f32 v129, v89
    v_mfma_f32_16x16x32_bf16 v[24:27], a[248:251], v[120:123], v[24:27]
    v_exp_f32 v135, v95
    v_mfma_f32_16x16x32_bf16 v[48:51], a[196:199], a[148:151], v[48:51]
    v_exp_f32 v128, v88
    v_mfma_f32_16x16x32_bf16 v[48:51], a[200:203], a[152:155], v[48:51]
    v_exp_f32 v131, v91
    v_mfma_f32_16x16x32_bf16 v[48:51], a[204:207], a[156:159], v[48:51]
    v_cvt_pk_bf16_f32 v124, v128, v129
    v_cvt_pk_bf16_f32 v125, v130, v131
    v_mfma_f32_16x16x32_bf16 v[48:51], a[208:211], a[160:163], v[48:51]
    s_add_u32 m0, s23, 1024
    v_cvt_pk_bf16_f32 v127, v134, v135
    v_mfma_f32_16x16x32_bf16 v[48:51], a[212:215], a[164:167], v[48:51]
    buffer_load_dwordx4 v11, s[12:15], s25 offen nt lds
    v_mfma_f32_16x16x32_bf16 v[24:27], a[252:255], v[124:127], v[24:27]
    s_bitcmp1_b32 s30, 0
    s_cselect_b32 s26, s49, 128
    s_cselect_b32 s27, s39, 2048
    v_mfma_f32_16x16x32_bf16 v[56:59], a[192:195], a[168:171], 0
    s_add_u32 s24, s24, s26
    s_add_u32 s25, s25, s26
    s_add_u32 s23, s23, s27
    v_mfma_f32_16x16x32_bf16 v[56:59], a[196:199], a[172:175], v[56:59]
    v_cmp_lt_f32 vcc, s29, v24
    v_mfma_f32_16x16x32_bf16 v[56:59], a[200:203], a[176:179], v[56:59]
    s_waitcnt vmcnt(10) lgkmcnt(0)
    v_mfma_f32_16x16x32_bf16 v[56:59], a[204:207], a[180:183], v[56:59]
    s_add_u32 m0, s22, 0
    v_mfma_f32_16x16x32_bf16 v[56:59], a[208:211], a[184:187], v[56:59]
    s_barrier
    v_mfma_f32_16x16x32_bf16 v[56:59], a[212:215], a[188:191], v[56:59]
    s_cbranch_vccnz L_rs_loop4w0b
L_ret_loop4w0b:
    v_mfma_f32_16x16x32_bf16 v[36:39], a[216:219], a[96:99], 0
    v_fma_f32 v41, v41, s28, v17
    v_fma_f32 v32, v32, s28, v16
    v_mfma_f32_16x16x32_bf16 v[36:39], a[220:223], a[100:103], v[36:39]
    ds_read_b64_tr_b16 a[192:193], v3 offset:12288
    v_fma_f32 v40, v40, s28, v17
    v_mfma_f32_16x16x32_bf16 v[36:39], a[224:227], a[104:107], v[36:39]
    v_fma_f32 v34, v34, s28, v16
    v_fma_f32 v33, v33, s28, v16
    v_mfma_f32_16x16x32_bf16 v[36:39], a[228:231], a[108:111], v[36:39]
    ds_read_b64_tr_b16 a[194:195], v3 offset:18432
    v_fma_f32 v35, v35, s28, v16
    v_mfma_f32_16x16x32_bf16 v[36:39], a[232:235], a[112:115], v[36:39]
    v_add_u32 v13, s27, v13
    v_mfma_f32_16x16x32_bf16 v[36:39], a[236:239], a[116:119], v[36:39]
    v_exp_f32 v130, v34
    v_mfma_f32_16x16x32_bf16 v[44:47], a[216:219], a[120:123], 0
    buffer_load_dwordx4 v9, s[4:7], s20 offen lds
    v_mfma_f32_16x16x32_bf16 v[44:47], a[220:223], a[124:127], v[44:47]
    v_exp_f32 v131, v35
    v_mfma_f32_16x16x32_bf16 v[44:47], a[224:227], a[128:131], v[44:47]
    s_add_u32 s20, s20, 128
    s_add_u32 m0, s22, 1024
    ds_read_b64_tr_b16 a[196:197], v4 offset:12288
    v_mfma_f32_16x16x32_bf16 v[44:47], a[228:231], a[132:135], v[44:47]
    v_cvt_pk_bf16_f32 v97, v130, v131
    v_mfma_f32_16x16x32_bf16 v[44:47], a[232:235], a[136:139], v[44:47]
    v_exp_f32 v133, v41
    v_mfma_f32_16x16x32_bf16 v[44:47], a[236:239], a[140:143], v[44:47]
    buffer_load_dwordx4 v9, s[4:7], s20 offen lds
    v_mfma_f32_16x16x32_bf16 v[52:55], a[216:219], a[144:147], 0
    s_add_u32 s20, s20, 128
    v_exp_f32 v129, v33
    v_mfma_f32_16x16x32_bf16 v[52:55], a[220:223], a[148:151], v[52:55]
    v_exp_f32 v132, v40
    v_mfma_f32_16x16x32_bf16 v[52:55], a[224:227], a[152:155], v[52:55]
    s_add_u32 m0, s22, 2048
    ds_read_b64_tr_b16 a[198:199], v4 offset:18432
    v_mfma_f32_16x16x32_bf16 v[52:55], a[228:231], a[156:159], v[52:55]
    ds_read_b64_tr_b16 a[200:201], v5 offset:12288
    v_mfma_f32_16x16x32_bf16 v[52:55], a[232:235], a[160:163], v[52:55]
    buffer_load_dwordx4 v9, s[4:7], s20 offen lds
    v_mfma_f32_16x16x32_bf16 v[52:55], a[236:239], a[164:167], v[52:55]
    ds_read_b64_tr_b16 a[202:203], v5 offset:18432
    v_cvt_pk_bf16_f32 v100, v132, v133
    v_mfma_f32_16x16x32_bf16 v[60:63], a[216:219], a[168:171], 0
    s_add_u32 s20, s20, 12032
    ds_read_b64_tr_b16 a[204:205], v6 offset:12288
    ds_read_b64_tr_b16 a[206:207], v6 offset:18432
    v_mfma_f32_16x16x32_bf16 v[60:63], a[220:223], a[172:175], v[60:63]
    v_exp_f32 v128, v32
    v_mfma_f32_16x16x32_bf16 v[60:63], a[224:227], a[176:179], v[60:63]
    ds_read_b64_tr_b16 a[208:209], v3 offset:13312
    s_add_u32 s30, s30, 1
    v_mfma_f32_16x16x32_bf16 v[60:63], a[228:231], a[180:183], v[60:63]
    ds_read_b64_tr_b16 a[210:211], v3 offset:19456
    v_cvt_pk_bf16_f32 v96, v128, v129
    v_mfma_f32_16x16x32_bf16 v[60:63], a[232:235], a[184:187], v[60:63]
    ds_read_b64_tr_b16 a[212:213], v4 offset:13312
    ds_read_b64_tr_b16 a[214:215], v4 offset:19456
    v_mfma_f32_16x16x32_bf16 v[60:63], a[236:239], a[188:191], v[60:63]
    s_cmp_lt_u32 s30, 6
    s_cbranch_scc1 L_loop4w0
    s_cmp_ge_u32 s37, 8
    s_cbranch_scc1 L_end4
    s_cmp_eq_u32 s32, 0
    s_cbranch_scc1 L_tr43
    s_branch L_tr44
    .p2align 6
L_loop4w1:
    s_waitcnt lgkmcnt(10)
    v_mfma_f32_16x16x32_bf16 v[160:163], a[192:195], v[112:115], v[160:163]
    ds_read_b64_tr_b16 a[218:219], v5 offset:19456
    v_fma_f32 v44, v44, s28, v17
    v_mfma_f32_16x16x32_bf16 v[208:211], a[192:195], v[116:119], v[208:211]
    ds_read_b64_tr_b16 a[226:227], v3 offset:20480
    v_fma_f32 v37, v37, s28, v16
    v_fma_f32 v47, v47, s28, v17
    v_mfma_f32_16x16x32_bf16 a[0:3], a[192:195], v[120:123], a[0:3]
    v_fma_f32 v36, v36, s28, v16
    v_fma_f32 v38, v38, s28, v16
    v_mfma_f32_16x16x32_bf16 a[48:51], a[192:195], v[124:127], a[48:51]
    ds_read_b64_tr_b16 a[222:223], v6 offset:19456
    s_waitcnt lgkmcnt(11)
    v_mfma_f32_16x16x32_bf16 v[164:167], a[196:199], v[112:115], v[164:167]
    v_exp_f32 v134, v36
    v_mfma_f32_16x16x32_bf16 v[212:215], a[196:199], v[116:119], v[212:215]
    v_exp_f32 v135, v37
    v_mfma_f32_16x16x32_bf16 a[4:7], a[196:199], v[120:123], a[4:7]
    ds_read_b64_tr_b16 a[216:217], v5 offset:13312
    v_fma_f32 v39, v39, s28, v16
    v_mfma_f32_16x16x32_bf16 a[52:55], a[196:199], v[124:127], a[52:55]
    s_waitcnt lgkmcnt(10)
    ds_read_b64_tr_b16 a[220:221], v6 offset:13312
    v_fma_f32 v42, v42, s28, v17
    v_mfma_f32_16x16x32_bf16 v[168:171], a[200:203], v[112:115], v[168:171]
    ds_read_b64_tr_b16 a[232:233], v5 offset:14336
    ds_read_b64_tr_b16 a[234:235], v5 offset:20480
    v_mfma_f32_16x16x32_bf16 v[216:219], a[200:203], v[116:119], v[216:219]
    v_exp_f32 v128, v38
    v_mfma_f32_16x16x32_bf16 a[8:11], a[200:203], v[120:123], a[8:11]
    v_exp_f32 v132, v44
    v_mfma_f32_16x16x32_bf16 a[56:59], a[200:203], v[124:127], a[56:59]
    s_waitcnt lgkmcnt(5)
    ds_read_b64_tr_b16 a[238:239], v6 offset:20480
    v_cvt_pk_bf16_f32 v98, v134, v135
    v_mfma_f32_16x16x32_bf16 v[172:175], a[204:207], v[112:115], v[172:175]
    ds_read_b64_tr_b16 a[230:231], v4 offset:20480
    v_fma_f32 v43, v43, s28, v17
    v_mfma_f32_16x16x32_bf16 v[220:223], a[204:207], v[116:119], v[220:223]
    ds_read_b64_tr_b16 a[228:229], v4 offset:14336
    ds_read_b64_tr_b16 a[224:225], v3 offset:14336
    v_mfma_f32_16x16x32_bf16 a[12:15], a[204:207], v[120:123], a[12:15]
    ds_read_b64_tr_b16 a[236:237], v6 offset:14336
    v_fma_f32 v45, v45, s28, v17
    v_mfma_f32_16x16x32_bf16 a[60:63], a[204:207], v[124:127], a[60:63]
    v_exp_f32 v129, v39
    v_mfma_f32_16x16x32_bf16 v[176:179], a[208:211], v[112:115], v[176:179]
    v_exp_f32 v133, v45
    v_mfma_f32_16x16x32_bf16 v[224:227], a[208:211], v[116:119], v[224:227]
    v_fma_f32 v48, v48, s28, v18
    v_cvt_pk_bf16_f32 v102, v132, v133
    v_mfma_f32_16x16x32_bf16 a[16:19], a[208:211], v[120:123], a[16:19]
    v_fma_f32 v46, v46, s28, v17
    v_cvt_pk_bf16_f32 v99, v128, v129
    v_mfma_f32_16x16x32_bf16 a[64:67], a[208:211], v[124:127], a[64:67]
    v_exp_f32 v130, v42
    v_mfma_f32_16x16x32_bf16 v[20:23], a[240:243], v[96:99], v[24:27]
    v_exp_f32 v131, v43
    v_mfma_f32_16x16x32_bf16 v[180:183], a[212:215], v[112:115], v[180:183]
    v_exp_f32 v135, v47
    v_mfma_f32_16x16x32_bf16 v[228:231], a[212:215], v[116:119], v[228:231]
    v_exp_f32 v134, v46
    v_mfma_f32_16x16x32_bf16 a[20:23], a[212:215], v[120:123], a[20:23]
    v_fma_f32 v55, v55, s28, v18
    v_cvt_pk_bf16_f32 v101, v130, v131
    v_mfma_f32_16x16x32_bf16 a[68:71], a[212:215], v[124:127], a[68:71]
    s_waitcnt vmcnt(10) lgkmcnt(0)
    v_cvt_pk_bf16_f32 v103, v134, v135
    v_fma_f32 v54, v54, s28, v18
    v_mfma_f32_16x16x32_bf16 v[184:187], a[216:219], v[112:115], v[184:187]
    s_add_u32 m0, s22, 36864
    v_fma_f32 v62, v62, s28, v19
    v_fma_f32 v50, v50, s28, v18
    v_mfma_f32_16x16x32_bf16 v[20:23], a[244:247], v[100:103], v[20:23]
    s_barrier
    v_mfma_f32_16x16x32_bf16 v[232:235], a[216:219], v[116:119], v[232:235]
    v_fma_f32 v59, v59, s28, v19
    v_fma_f32 v56, v56, s28, v19
    v_mfma_f32_16x16x32_bf16 a[24:27], a[216:219], v[120:123], a[24:27]
    ds_read_b128 a[212:215], v2 offset:14336
    v_mfma_f32_16x16x32_bf16 a[72:75], a[216:219], v[124:127], a[72:75]
    buffer_load_dwordx4 v9, s[8:11], s21 offen lds
    v_mfma_f32_16x16x32_bf16 v[188:191], a[220:223], v[112:115], v[188:191]
    s_add_u32 s21, s21, 128
    v_exp_f32 v135, v55
    v_mfma_f32_16x16x32_bf16 v[236:239], a[220:223], v[116:119], v[236:239]
    ds_read_b128 a[196:199], v2 offset:12288
    v_fma_f32 v51, v51, s28, v18
    v_mfma_f32_16x16x32_bf16 a[28:31], a[220:223], v[120:123], a[28:31]
    v_fma_f32 v58, v58, s28, v19
    v_fma_f32 v53, v53, s28, v18
    v_mfma_f32_16x16x32_bf16 a[76:79], a[220:223], v[124:127], a[76:79]
    s_add_u32 m0, s22, 37888
    ds_read_b128 a[200:203], v1 offset:13312
    v_fma_f32 v52, v52, s28, v18
    v_mfma_f32_16x16x32_bf16 v[192:195], a[224:227], v[112:115], v[192:195]
    ds_read_b128 a[208:211], v1 offset:14336
    v_mfma_f32_16x16x32_bf16 v[240:243], a[224:227], v[116:119], v[240:243]
    buffer_load_dwordx4 v9, s[8:11], s21 offen lds
    v_mfma_f32_16x16x32_bf16 a[32:35], a[224:227], v[120:123], a[32:35]
    v_fma_f32 v49, v49, s28, v18
    v_mfma_f32_16x16x32_bf16 a[80:83], a[224:227], v[124:127], a[80:83]
    ds_read_b128 a[204:207], v2 offset:13312
    v_mfma_f32_16x16x32_bf16 v[196:199], a[228:231], v[112:115], v[196:199]
    ds_read_b128 a[192:195], v1 offset:12288
    v_fma_f32 v57, v57, s28, v19
    v_mfma_f32_16x16x32_bf16 v[244:247], a[228:231], v[116:119], v[244:247]
    v_exp_f32 v133, v53
    v_mfma_f32_16x16x32_bf16 a[36:39], a[228:231], v[120:123], a[36:39]
    v_mfma_f32_16x16x32_bf16 a[84:87], a[228:231], v[124:127], a[84:87]
    v_exp_f32 v130, v50
    v_mfma_f32_16x16x32_bf16 v[200:203], a[232:235], v[112:115], v[200:203]
    s_add_u32 s21, s21, 128
    v_exp_f32 v134, v54
    v_mfma_f32_16x16x32_bf16 v[248:251], a[232:235], v[116:119], v[248:251]
    v_cvt_pk_bf16_f32 v107, v134, v135
    v_fma_f32 v61, v61, s28, v19
    v_mfma_f32_16x16x32_bf16 a[40:43], a[232:235], v[120:123], a[40:43]
    s_add_u32 m0, s22, 38912
    v_fma_f32 v63, v63, s28, v19
    v_mfma_f32_16x16x32_bf16 a[88:91], a[232:235], v[124:127], a[88:91]
    buffer_load_dwordx4 v9, s[8:11], s21 offen lds
    v_mfma_f32_16x16x32_bf16 v[204:207], a[236:239], v[112:115], v[204:207]
    ds_read_b128 a[232:235], v1 offset:20480
    v_mfma_f32_16x16x32_bf16 v[252:255], a[236:239], v[116:119], v[252:255]
    v_exp_f32 v131, v51
    v_mfma_f32_16x16x32_bf16 a[44:47], a[236:239], v[120:123], a[44:47]
    v_exp_f32 v132, v52
    v_mfma_f32_16x16x32_bf16 a[92:95], a[236:239], v[124:127], a[92:95]
    s_waitcnt lgkmcnt(1)
    v_exp_f32 v134, v62
    v_mfma_f32_16x16x32_bf16 v[64:67], a[192:195], a[96:99], 0
    v_cvt_pk_bf16_f32 v106, v132, v133
    v_mfma_f32_16x16x32_bf16 v[64:67], a[196:199], a[100:103], v[64:67]
    v_exp_f32 v128, v48
    v_mfma_f32_16x16x32_bf16 v[64:67], a[200:203], a[104:107], v[64:67]
    ds_read_b128 a[220:223], v2 offset:18432
    v_mfma_f32_16x16x32_bf16 v[64:67], a[204:207], a[108:111], v[64:67]
    v_exp_f32 v129, v49
    v_mfma_f32_16x16x32_bf16 v[64:67], a[208:211], a[112:115], v[64:67]
    ds_read_b128 a[236:239], v2 offset:20480
    v_fma_f32 v60, v60, s28, v19
    v_mfma_f32_16x16x32_bf16 v[64:67], a[212:215], a[116:119], v[64:67]
    ds_read_b128 a[224:227], v1 offset:19456
    v_cvt_pk_bf16_f32 v105, v130, v131
    v_mfma_f32_16x16x32_bf16 v[72:75], a[192:195], a[120:123], 0
    v_exp_f32 v130, v58
    v_mfma_f32_16x16x32_bf16 v[72:75], a[196:199], a[124:127], v[72:75]
    ds_read_b128 a[216:219], v1 offset:18432
    v_cvt_pk_bf16_f32 v104, v128, v129
    v_mfma_f32_16x16x32_bf16 v[72:75], a[200:203], a[128:131], v[72:75]
    v_exp_f32 v131, v59
    v_mfma_f32_16x16x32_bf16 v[72:75], a[204:207], a[132:135], v[72:75]
    v_mfma_f32_16x16x32_bf16 v[72:75], a[208:211], a[136:139], v[72:75]
    ds_read_b128 a[228:231], v2 offset:19456
    v_mfma_f32_16x16x32_bf16 v[72:75], a[212:215], a[140:143], v[72:75]
    v_exp_f32 v135, v63
    v_mfma_f32_16x16x32_bf16 v[80:83], a[192:195], a[144:147], 0
    v_exp_f32 v132, v60
    v_mfma_f32_16x16x32_bf16 v[80:83], a[196:199], a[148:151], v[80:83]
    v_cvt_pk_bf16_f32 v109, v130, v131
    v_mfma_f32_16x16x32_bf16 v[80:83], a[200:203], a[152:155], v[80:83]
    s_add_u32 s21, s21, 12032
    v_exp_f32 v129, v57
    v_mfma_f32_16x16x32_bf16 v[80:83], a[204:207], a[156:159], v[80:83]
    v_cvt_pk_bf16_f32 v111, v134, v135
    v_mfma_f32_16x16x32_bf16 v[80:83], a[208:211], a[160:163], v[80:83]
    v_exp_f32 v133, v61
    v_mfma_f32_16x16x32_bf16 v[80:83], a[212:215], a[164:167], v[80:83]
    v_cvt_pk_bf16_f32 v110, v132, v133
    v_mfma_f32_16x16x32_bf16 v[20:23], a[248:251], v[104:107], v[20:23]
    v_mfma_f32_16x16x32_bf16 v[88:91], a[192:195], a[168:171], 0
    v_exp_f32 v128, v56
    v_mfma_f32_16x16x32_bf16 v[88:91], a[196:199], a[172:175], v[88:91]
    v_cvt_pk_bf16_f32 v108, v128, v129
    v_mfma_f32_16x16x32_bf16 v[88:91], a[200:203], a[176:179], v[88:91]
    s_waitcnt vmcnt(9) lgkmcnt(0)
    v_mfma_f32_16x16x32_bf16 v[20:23], a[252:255], v[108:111], v[20:23]
    s_barrier
    v_mfma_f32_16x16x32_bf16 v[88:91], a[204:207], a[180:183], v[88:91]
    s_add_u32 m0, s22, 12288
    ds_read_b64_tr_b16 a[192:193], v3 offset:0
    v_mfma_f32_16x16x32_bf16 v[88:91], a[208:211], a[184:187], v[88:91]
    ds_read_b64_tr_b16 a[194:195], v3 offset:6144
    ds_read_b64_tr_b16 a[196:197], v4 offset:0
    v_mfma_f32_16x16x32_bf16 v[88:91], a[212:215], a[188:191], v[88:91]
    ds_read_b64_tr_b16 a[198:199], v4 offset:6144
    v_cmp_lt_f32 vcc, s29, v20
    v_mfma_f32_16x16x32_bf16 v[68:71], a[216:219], a[96:99], 0
    ds_read_b64_tr_b16 a[200:201], v5 offset:0
    v_mfma_f32_16x16x32_bf16 v[68:71], a[220:223], a[100:103], v[68:71]
    buffer_load_dwordx4 v9, s[4:7], s20 offen lds
    v_mfma_f32_16x16x32_bf16 v[68:71], a[224:227], a[104:107], v[68:71]
    s_cbranch_vccnz L_rs_loop4w1a
L_ret_loop4w1a:
    v_fma_f32 v65, v65, s28, v16
    v_mfma_f32_16x16x32_bf16 v[68:71], a[228:231], a[108:111], v[68:71]
    v_fma_f32 v66, v66, s28, v16
    s_add_u32 s20, s20, 128
    v_mfma_f32_16x16x32_bf16 v[68:71], a[232:235], a[112:115], v[68:71]
    s_add_u32 m0, s22, 13312
    v_fma_f32 v64, v64, s28, v16
    v_fma_f32 v73, v73, s28, v17
    v_mfma_f32_16x16x32_bf16 v[68:71], a[236:239], a[116:119], v[68:71]
    v_exp_f32 v129, v65
    v_mfma_f32_16x16x32_bf16 v[76:79], a[216:219], a[120:123], 0
    ds_read_b64_tr_b16 a[202:203], v5 offset:6144
    ds_read_b64_tr_b16 a[204:205], v6 offset:0
    v_mfma_f32_16x16x32_bf16 v[76:79], a[220:223], a[124:127], v[76:79]
    v_exp_f32 v133, v73
    v_mfma_f32_16x16x32_bf16 v[76:79], a[224:227], a[128:131], v[76:79]
    v_fma_f32 v67, v67, s28, v16
    v_fma_f32 v72, v72, s28, v17
    v_mfma_f32_16x16x32_bf16 v[76:79], a[228:231], a[132:135], v[76:79]
    v_exp_f32 v131, v67
    v_mfma_f32_16x16x32_bf16 v[76:79], a[232:235], a[136:139], v[76:79]
    v_exp_f32 v128, v64
    v_mfma_f32_16x16x32_bf16 v[76:79], a[236:239], a[140:143], v[76:79]
    buffer_load_dwordx4 v9, s[4:7], s20 offen lds
    v_mfma_f32_16x16x32_bf16 v[84:87], a[216:219], a[144:147], 0
    ds_read_b64_tr_b16 a[206:207], v6 offset:6144
    v_mfma_f32_16x16x32_bf16 v[84:87], a[220:223], a[148:151], v[84:87]
    s_add_u32 s20, s20, 128
    v_exp_f32 v132, v72
    v_mfma_f32_16x16x32_bf16 v[84:87], a[224:227], a[152:155], v[84:87]
    v_mfma_f32_16x16x32_bf16 v[84:87], a[228:231], a[156:159], v[84:87]
    ds_read_b64_tr_b16 a[208:209], v3 offset:1024
    v_mfma_f32_16x16x32_bf16 v[84:87], a[232:235], a[160:163], v[84:87]
    s_add_u32 m0, s22, 14336
    v_cvt_pk_bf16_f32 v116, v132, v133
    v_mfma_f32_16x16x32_bf16 v[84:87], a[236:239], a[164:167], v[84:87]
    v_exp_f32 v130, v66
    v_mfma_f32_16x16x32_bf16 v[92:95], a[216:219], a[168:171], 0
    buffer_load_dwordx4 v9, s[4:7], s20 offen lds
    v_mfma_f32_16x16x32_bf16 v[92:95], a[220:223], a[172:175], v[92:95]
    v_cvt_pk_bf16_f32 v112, v128, v129
    v_mfma_f32_16x16x32_bf16 v[92:95], a[224:227], a[176:179], v[92:95]
    ds_read_b64_tr_b16 a[210:211], v3 offset:7168
    v_cvt_pk_bf16_f32 v113, v130, v131
    v_mfma_f32_16x16x32_bf16 v[92:95], a[228:231], a[180:183], v[92:95]
    ds_read_b64_tr_b16 a[212:213], v4 offset:1024
    s_add_u32 s20, s20, 12032
    v_mfma_f32_16x16x32_bf16 v[92:95], a[232:235], a[184:187], v[92:95]
    v_mfma_f32_16x16x32_bf16 v[92:95], a[236:239], a[188:191], v[92:95]
    ds_read_b64_tr_b16 a[214:215], v4 offset:7168
    s_waitcnt lgkmcnt(10)
    v_mfma_f32_16x16x32_bf16 v[160:163], a[192:195], v[96:99], v[160:163]
    v_fma_f32 v76, v76, s28, v17
    v_fma_f32 v71, v71, s28, v16
    v_mfma_f32_16x16x32_bf16 v[208:211], a[192:195], v[100:103], v[208:211]
    ds_read_b128 v[136:139], v13 offset:0
    v_fma_f32 v80, v80, s28, v18
    v_fma_f32 v68, v68, s28, v16
    v_mfma_f32_16x16x32_bf16 a[0:3], a[192:195], v[104:107], a[0:3]
    ds_read_b64_tr_b16 a[220:221], v6 offset:1024
    v_fma_f32 v69, v69, s28, v16
    v_fma_f32 v77, v77, s28, v17
    v_mfma_f32_16x16x32_bf16 a[48:51], a[192:195], v[108:111], a[48:51]
    s_waitcnt lgkmcnt(10)
    v_exp_f32 v135, v69
    v_mfma_f32_16x16x32_bf16 v[164:167], a[196:199], v[96:99], v[164:167]
    v_exp_f32 v134, v68
    v_mfma_f32_16x16x32_bf16 v[212:215], a[196:199], v[100:103], v[212:215]
    ds_read_b64_tr_b16 a[226:227], v3 offset:8192
    v_cvt_pk_bf16_f32 v114, v134, v135
    v_mfma_f32_16x16x32_bf16 a[4:7], a[196:199], v[104:107], a[4:7]
    ds_read_b64_tr_b16 a[218:219], v5 offset:7168
    ds_read_b64_tr_b16 a[224:225], v3 offset:2048
    v_mfma_f32_16x16x32_bf16 a[52:55], a[196:199], v[108:111], a[52:55]
    s_waitcnt lgkmcnt(10)
    v_fma_f32 v79, v79, s28, v17
    v_fma_f32 v75, v75, s28, v17
    v_mfma_f32_16x16x32_bf16 v[168:171], a[200:203], v[96:99], v[168:171]
    ds_read_b64_tr_b16 a[232:233], v5 offset:2048
    v_fma_f32 v70, v70, s28, v16
    v_mfma_f32_16x16x32_bf16 v[216:219], a[200:203], v[100:103], v[216:219]
    ds_read_b64_tr_b16 a[216:217], v5 offset:1024
    v_fma_f32 v86, v86, s28, v18
    v_mfma_f32_16x16x32_bf16 a[8:11], a[200:203], v[104:107], a[8:11]
    v_exp_f32 v133, v77
    v_mfma_f32_16x16x32_bf16 a[56:59], a[200:203], v[108:111], a[56:59]
    s_waitcnt lgkmcnt(6)
    ds_read_b64_tr_b16 a[222:223], v6 offset:7168
    ds_read_b64_tr_b16 a[230:231], v4 offset:8192
    v_mfma_f32_16x16x32_bf16 v[172:175], a[204:207], v[96:99], v[172:175]
    v_fma_f32 v89, v89, s28, v19
    v_fma_f32 v78, v78, s28, v17
    v_mfma_f32_16x16x32_bf16 v[220:223], a[204:207], v[100:103], v[220:223]
    v_exp_f32 v132, v76
    v_mfma_f32_16x16x32_bf16 a[12:15], a[204:207], v[104:107], a[12:15]
    v_exp_f32 v131, v75
    v_mfma_f32_16x16x32_bf16 a[60:63], a[204:207], v[108:111], a[60:63]
    ds_read_b64_tr_b16 a[236:237], v6 offset:2048
    ds_read_b64_tr_b16 a[238:239], v6 offset:8192
    v_mfma_f32_16x16x32_bf16 v[176:179], a[208:211], v[96:99], v[176:179]
    ds_read_b64_tr_b16 a[228:229], v4 offset:2048
    ds_read_b64_tr_b16 a[234:235], v5 offset:8192
    v_mfma_f32_16x16x32_bf16 v[224:227], a[208:211], v[100:103], v[224:227]
    ds_read_b128 v[140:143], v13 offset:1024
    v_fma_f32 v74, v74, s28, v17
    v_mfma_f32_16x16x32_bf16 a[16:19], a[208:211], v[104:107], a[16:19]
    v_exp_f32 v128, v70
    v_mfma_f32_16x16x32_bf16 a[64:67], a[208:211], v[108:111], a[64:67]
    v_exp_f32 v129, v71
    v_mfma_f32_16x16x32_bf16 v[180:183], a[212:215], v[96:99], v[180:183]
    v_cvt_pk_bf16_f32 v118, v132, v133
    v_cvt_pk_bf16_f32 v115, v128, v129
    v_mfma_f32_16x16x32_bf16 v[228:231], a[212:215], v[100:103], v[228:231]
    v_exp_f32 v130, v74
    v_mfma_f32_16x16x32_bf16 a[20:23], a[212:215], v[104:107], a[20:23]
    v_exp_f32 v135, v79
    v_mfma_f32_16x16x32_bf16 a[68:71], a[212:215], v[108:111], a[68:71]
    s_waitcnt lgkmcnt(5)
    v_exp_f32 v134, v78
    v_mfma_f32_16x16x32_bf16 v[184:187], a[216:219], v[96:99], v[184:187]
    v_cvt_pk_bf16_f32 v119, v134, v135
    v_cvt_pk_bf16_f32 v117, v130, v131
    v_mfma_f32_16x16x32_bf16 v[24:27], a[240:243], v[112:115], v[20:23]
    v_fma_f32 v81, v81, s28, v18
    v_mfma_f32_16x16x32_bf16 v[24:27], a[244:247], v[116:119], v[24:27]
    buffer_store_dwordx4 v[136:139], v12, s[16:19], s24 offen offset:0 sc0 sc1 nt
    s_waitcnt vmcnt(7) lgkmcnt(0)
    s_barrier
    ds_read_b128 a[192:195], v1 offset:0
    v_mfma_f32_16x16x32_bf16 v[232:235], a[216:219], v[100:103], v[232:235]
    s_add_u32 m0, s22, 24576
    v_exp_f32 v129, v81
    v_mfma_f32_16x16x32_bf16 a[24:27], a[216:219], v[104:107], a[24:27]
    buffer_load_dwordx4 v9, s[8:11], s21 offen lds
    v_mfma_f32_16x16x32_bf16 a[72:75], a[216:219], v[108:111], a[72:75]
    v_fma_f32 v84, v84, s28, v18
    v_fma_f32 v85, v85, s28, v18
    v_mfma_f32_16x16x32_bf16 v[188:191], a[220:223], v[96:99], v[188:191]
    v_exp_f32 v133, v85
    v_mfma_f32_16x16x32_bf16 v[236:239], a[220:223], v[100:103], v[236:239]
    s_add_u32 s21, s21, 128
    ds_read_b128 a[208:211], v1 offset:2048
    v_fma_f32 v88, v88, s28, v19
    v_mfma_f32_16x16x32_bf16 a[28:31], a[220:223], v[104:107], a[28:31]
    ds_read_b128 a[196:199], v2 offset:0
    v_fma_f32 v95, v95, s28, v19
    v_mfma_f32_16x16x32_bf16 a[76:79], a[220:223], v[108:111], a[76:79]
    v_fma_f32 v83, v83, s28, v18
    v_fma_f32 v93, v93, s28, v19
    v_mfma_f32_16x16x32_bf16 v[192:195], a[224:227], v[96:99], v[192:195]
    v_exp_f32 v132, v84
    v_mfma_f32_16x16x32_bf16 v[240:243], a[224:227], v[100:103], v[240:243]
    ds_read_b128 a[216:219], v1 offset:6144
    v_cvt_pk_bf16_f32 v122, v132, v133
    v_mfma_f32_16x16x32_bf16 a[32:35], a[224:227], v[104:107], a[32:35]
    s_add_u32 m0, s22, 25600
    ds_read_b128 a[200:203], v1 offset:1024
    v_fma_f32 v91, v91, s28, v19
    v_mfma_f32_16x16x32_bf16 a[80:83], a[224:227], v[108:111], a[80:83]
    buffer_load_dwordx4 v9, s[8:11], s21 offen lds
    v_mfma_f32_16x16x32_bf16 v[196:199], a[228:231], v[96:99], v[196:199]
    v_exp_f32 v134, v86
    v_mfma_f32_16x16x32_bf16 v[244:247], a[228:231], v[100:103], v[244:247]
    s_add_u32 s21, s21, 128
    v_exp_f32 v131, v83
    v_mfma_f32_16x16x32_bf16 a[36:39], a[228:231], v[104:107], a[36:39]
    v_fma_f32 v82, v82, s28, v18
    v_fma_f32 v92, v92, s28, v19
    v_mfma_f32_16x16x32_bf16 a[84:87], a[228:231], v[108:111], a[84:87]
    s_add_u32 m0, s22, 26624
    ds_read_b128 a[212:215], v2 offset:2048
    v_mfma_f32_16x16x32_bf16 v[200:203], a[232:235], v[96:99], v[200:203]
    ds_read_b128 a[204:207], v2 offset:1024
    v_fma_f32 v87, v87, s28, v18
    v_mfma_f32_16x16x32_bf16 v[248:251], a[232:235], v[100:103], v[248:251]
    buffer_load_dwordx4 v9, s[8:11], s21 offen lds
    v_mfma_f32_16x16x32_bf16 a[40:43], a[232:235], v[104:107], a[40:43]
    v_exp_f32 v130, v82
    v_mfma_f32_16x16x32_bf16 a[88:91], a[232:235], v[108:111], a[88:91]
    s_add_u32 s21, s21, 12032
    ds_read_b128 a[224:227], v1 offset:7168
    v_fma_f32 v90, v90, s28, v19
    v_mfma_f32_16x16x32_bf16 v[204:207], a[236:239], v[96:99], v[204:207]
    s_add_u32 m0, s23, 0
    ds_read_b128 a[220:223], v2 offset:6144
    v_mfma_f32_16x16x32_bf16 v[252:255], a[236:239], v[100:103], v[252:255]
    ds_read_b128 a[232:235], v1 offset:8192
    v_mfma_f32_16x16x32_bf16 a[44:47], a[236:239], v[104:107], a[44:47]
    v_exp_f32 v135, v87
    v_mfma_f32_16x16x32_bf16 a[92:95], a[236:239], v[108:111], a[92:95]
    buffer_store_dwordx4 v[140:143], v12, s[16:19], s24 offen offset:3072 sc0 sc1 nt
    v_cvt_pk_bf16_f32 v121, v130, v131
    s_waitcnt lgkmcnt(5)
    v_mfma_f32_16x16x32_bf16 v[32:35], a[192:195], a[96:99], 0
    v_exp_f32 v128, v80
    v_mfma_f32_16x16x32_bf16 v[32:35], a[196:199], a[100:103], v[32:35]
    buffer_load_dwordx4 v10, s[12:15], s25 offen nt lds
    v_mfma_f32_16x16x32_bf16 v[32:35], a[200:203], a[104:107], v[32:35]
    s_waitcnt lgkmcnt(3)
    v_cvt_pk_bf16_f32 v123, v134, v135
    v_cvt_pk_bf16_f32 v120, v128, v129
    v_mfma_f32_16x16x32_bf16 v[32:35], a[204:207], a[108:111], v[32:35]
    v_exp_f32 v132, v92
    v_mfma_f32_16x16x32_bf16 v[32:35], a[208:211], a[112:115], v[32:35]
    v_exp_f32 v128, v88
    v_mfma_f32_16x16x32_bf16 v[32:35], a[212:215], a[116:119], v[32:35]
    v_exp_f32 v133, v93
    v_mfma_f32_16x16x32_bf16 v[24:27], a[248:251], v[120:123], v[24:27]
    s_add_u32 m0, s23, 1024
    v_mfma_f32_16x16x32_bf16 v[40:43], a[192:195], a[120:123], 0
    v_exp_f32 v130, v90
    v_mfma_f32_16x16x32_bf16 v[40:43], a[196:199], a[124:127], v[40:43]
    v_exp_f32 v135, v95
    v_mfma_f32_16x16x32_bf16 v[40:43], a[200:203], a[128:131], v[40:43]
    ds_read_b128 a[236:239], v2 offset:8192
    v_fma_f32 v94, v94, s28, v19
    v_mfma_f32_16x16x32_bf16 v[40:43], a[204:207], a[132:135], v[40:43]
    ds_read_b128 a[228:231], v2 offset:7168
    v_mfma_f32_16x16x32_bf16 v[40:43], a[208:211], a[136:139], v[40:43]
    buffer_load_dwordx4 v11, s[12:15], s25 offen nt lds
    v_mfma_f32_16x16x32_bf16 v[40:43], a[212:215], a[140:143], v[40:43]
    v_exp_f32 v131, v91
    v_mfma_f32_16x16x32_bf16 v[48:51], a[192:195], a[144:147], 0
    s_bitcmp1_b32 s30, 0
    v_exp_f32 v129, v89
    v_mfma_f32_16x16x32_bf16 v[48:51], a[196:199], a[148:151], v[48:51]
    v_cvt_pk_bf16_f32 v126, v132, v133
    v_mfma_f32_16x16x32_bf16 v[48:51], a[200:203], a[152:155], v[48:51]
    v_exp_f32 v134, v94
    v_mfma_f32_16x16x32_bf16 v[48:51], a[204:207], a[156:159], v[48:51]
    v_mfma_f32_16x16x32_bf16 v[48:51], a[208:211], a[160:163], v[48:51]
    v_cvt_pk_bf16_f32 v124, v128, v129
    v_mfma_f32_16x16x32_bf16 v[48:51], a[212:215], a[164:167], v[48:51]
    v_cvt_pk_bf16_f32 v125, v130, v131
    v_cvt_pk_bf16_f32 v127, v134, v135
    v_mfma_f32_16x16x32_bf16 v[56:59], a[192:195], a[168:171], 0
    s_cselect_b32 s26, s49, 128
    s_cselect_b32 s27, s39, 2048
    v_mfma_f32_16x16x32_bf16 v[24:27], a[252:255], v[124:127], v[24:27]
    s_add_u32 s24, s24, s26
    s_add_u32 s25, s25, s26
    v_mfma_f32_16x16x32_bf16 v[56:59], a[196:199], a[172:175], v[56:59]
    s_add_u32 s23, s23, s27
    s_waitcnt vmcnt(10) lgkmcnt(0)
    s_add_u32 m0, s22, 0
    v_mfma_f32_16x16x32_bf16 v[56:59], a[200:203], a[176:179], v[56:59]
    s_barrier
    v_mfma_f32_16x16x32_bf16 v[56:59], a[204:207], a[180:183], v[56:59]
    v_cmp_lt_f32 vcc, s29, v24
    v_mfma_f32_16x16x32_bf16 v[56:59], a[208:211], a[184:187], v[56:59]
    buffer_load_dwordx4 v9, s[4:7], s20 offen lds
    v_mfma_f32_16x16x32_bf16 v[56:59], a[212:215], a[188:191], v[56:59]
    s_add_u32 s20, s20, 128
    ds_read_b64_tr_b16 a[192:193], v3 offset:12288
    v_mfma_f32_16x16x32_bf16 v[36:39], a[216:219], a[96:99], 0
    s_cbranch_vccnz L_rs_loop4w1b
L_ret_loop4w1b:
    v_mfma_f32_16x16x32_bf16 v[36:39], a[220:223], a[100:103], v[36:39]
    v_fma_f32 v40, v40, s28, v17
    v_fma_f32 v35, v35, s28, v16
    v_mfma_f32_16x16x32_bf16 v[36:39], a[224:227], a[104:107], v[36:39]
    ds_read_b64_tr_b16 a[194:195], v3 offset:18432
    v_fma_f32 v41, v41, s28, v17
    v_mfma_f32_16x16x32_bf16 v[36:39], a[228:231], a[108:111], v[36:39]
    ds_read_b64_tr_b16 a[196:197], v4 offset:12288
    v_mfma_f32_16x16x32_bf16 v[36:39], a[232:235], a[112:115], v[36:39]
    v_mfma_f32_16x16x32_bf16 v[36:39], a[236:239], a[116:119], v[36:39]
    s_add_u32 m0, s22, 1024
    v_exp_f32 v131, v35
    v_mfma_f32_16x16x32_bf16 v[44:47], a[216:219], a[120:123], 0
    ds_read_b64_tr_b16 a[198:199], v4 offset:18432
    v_fma_f32 v32, v32, s28, v16
    v_mfma_f32_16x16x32_bf16 v[44:47], a[220:223], a[124:127], v[44:47]
    buffer_load_dwordx4 v9, s[4:7], s20 offen lds
    v_mfma_f32_16x16x32_bf16 v[44:47], a[224:227], a[128:131], v[44:47]
    v_fma_f32 v34, v34, s28, v16
    v_fma_f32 v33, v33, s28, v16
    v_mfma_f32_16x16x32_bf16 v[44:47], a[228:231], a[132:135], v[44:47]
    ds_read_b64_tr_b16 a[200:201], v5 offset:12288
    v_mfma_f32_16x16x32_bf16 v[44:47], a[232:235], a[136:139], v[44:47]
    s_add_u32 s20, s20, 128
    ds_read_b64_tr_b16 a[202:203], v5 offset:18432
    v_mfma_f32_16x16x32_bf16 v[44:47], a[236:239], a[140:143], v[44:47]
    ds_read_b64_tr_b16 a[204:205], v6 offset:12288
    ds_read_b64_tr_b16 a[206:207], v6 offset:18432
    v_mfma_f32_16x16x32_bf16 v[52:55], a[216:219], a[144:147], 0
    s_add_u32 m0, s22, 2048
    v_exp_f32 v132, v40
    v_mfma_f32_16x16x32_bf16 v[52:55], a[220:223], a[148:151], v[52:55]
    v_add_u32 v13, s27, v13
    v_mfma_f32_16x16x32_bf16 v[52:55], a[224:227], a[152:155], v[52:55]
    v_exp_f32 v129, v33
    v_mfma_f32_16x16x32_bf16 v[52:55], a[228:231], a[156:159], v[52:55]
    v_exp_f32 v133, v41
    v_mfma_f32_16x16x32_bf16 v[52:55], a[232:235], a[160:163], v[52:55]
    buffer_load_dwordx4 v9, s[4:7], s20 offen lds
    v_mfma_f32_16x16x32_bf16 v[52:55], a[236:239], a[164:167], v[52:55]
    s_add_u32 s20, s20, 12032
    ds_read_b64_tr_b16 a[208:209], v3 offset:13312
    s_add_u32 s30, s30, 1
    v_mfma_f32_16x16x32_bf16 v[60:63], a[216:219], a[168:171], 0
    v_exp_f32 v130, v34
    v_mfma_f32_16x16x32_bf16 v[60:63], a[220:223], a[172:175], v[60:63]
    ds_read_b64_tr_b16 a[210:211], v3 offset:19456
    v_cvt_pk_bf16_f32 v97, v130, v131
    v_mfma_f32_16x16x32_bf16 v[60:63], a[224:227], a[176:179], v[60:63]
    s_cmp_lt_u32 s30, 6
    v_exp_f32 v128, v32
    v_mfma_f32_16x16x32_bf16 v[60:63], a[228:231], a[180:183], v[60:63]
    ds_read_b64_tr_b16 a[212:213], v4 offset:13312
    v_mfma_f32_16x16x32_bf16 v[60:63], a[232:235], a[184:187], v[60:63]
    ds_read_b64_tr_b16 a[214:215], v4 offset:19456
    v_mfma_f32_16x16x32_bf16 v[60:63], a[236:239], a[188:191], v[60:63]
    v_cvt_pk_bf16_f32 v100, v132, v133
    v_cvt_pk_bf16_f32 v96, v128, v129
    s_cbranch_scc1 L_loop4w1
    s_cmp_ge_u32 s37, 8
    s_cbranch_scc1 L_end4
    s_cmp_eq_u32 s32, 0
    s_cbranch_scc1 L_tr43
    s_branch L_tr44
L_tr43:
    s_waitcnt lgkmcnt(10)
    v_mfma_f32_16x16x32_bf16 v[160:163], a[192:195], v[112:115], v[160:163]
    ds_read_b64_tr_b16 a[220:221], v6 offset:13312
    v_fma_f32 v48, v48, s28, v18
    v_mfma_f32_16x16x32_bf16 v[208:211], a[192:195], v[116:119], v[208:211]
    ds_read_b64_tr_b16 a[228:229], v4 offset:14336
    v_fma_f32 v43, v43, s28, v17
    v_mfma_f32_16x16x32_bf16 a[0:3], a[192:195], v[120:123], a[0:3]
    ds_read_b64_tr_b16 a[216:217], v5 offset:13312
    v_fma_f32 v39, v39, s28, v16
    v_mfma_f32_16x16x32_bf16 a[48:51], a[192:195], v[124:127], a[48:51]
    ds_read_b64_tr_b16 a[218:219], v5 offset:19456
    s_waitcnt lgkmcnt(12)
    v_mfma_f32_16x16x32_bf16 v[164:167], a[196:199], v[112:115], v[164:167]
    ds_read_b64_tr_b16 a[238:239], v6 offset:20480
    v_fma_f32 v36, v36, s28, v16
    v_mfma_f32_16x16x32_bf16 v[212:215], a[196:199], v[116:119], v[212:215]
    v_fma_f32 v38, v38, s28, v16
    v_fma_f32 v37, v37, s28, v16
    v_mfma_f32_16x16x32_bf16 a[4:7], a[196:199], v[120:123], a[4:7]
    v_exp_f32 v129, v39
    v_mfma_f32_16x16x32_bf16 a[52:55], a[196:199], v[124:127], a[52:55]
    ds_read_b64_tr_b16 a[230:231], v4 offset:20480
    s_waitcnt lgkmcnt(11)
    v_mfma_f32_16x16x32_bf16 v[168:171], a[200:203], v[112:115], v[168:171]
    ds_read_b64_tr_b16 a[236:237], v6 offset:14336
    v_fma_f32 v46, v46, s28, v17
    v_mfma_f32_16x16x32_bf16 v[216:219], a[200:203], v[116:119], v[216:219]
    v_fma_f32 v57, v57, s28, v19
    v_mfma_f32_16x16x32_bf16 a[8:11], a[200:203], v[120:123], a[8:11]
    ds_read_b64_tr_b16 a[234:235], v5 offset:20480
    v_fma_f32 v45, v45, s28, v17
    v_mfma_f32_16x16x32_bf16 a[56:59], a[200:203], v[124:127], a[56:59]
    s_waitcnt lgkmcnt(6)
    v_exp_f32 v134, v36
    v_mfma_f32_16x16x32_bf16 v[172:175], a[204:207], v[112:115], v[172:175]
    v_exp_f32 v135, v37
    v_mfma_f32_16x16x32_bf16 v[220:223], a[204:207], v[116:119], v[220:223]
    ds_read_b64_tr_b16 a[224:225], v3 offset:14336
    v_fma_f32 v44, v44, s28, v17
    v_mfma_f32_16x16x32_bf16 a[12:15], a[204:207], v[120:123], a[12:15]
    ds_read_b64_tr_b16 a[226:227], v3 offset:20480
    v_fma_f32 v62, v62, s28, v19
    v_mfma_f32_16x16x32_bf16 a[60:63], a[204:207], v[124:127], a[60:63]
    ds_read_b64_tr_b16 a[222:223], v6 offset:19456
    v_fma_f32 v49, v49, s28, v18
    v_mfma_f32_16x16x32_bf16 v[176:179], a[208:211], v[112:115], v[176:179]
    v_exp_f32 v128, v38
    v_mfma_f32_16x16x32_bf16 v[224:227], a[208:211], v[116:119], v[224:227]
    ds_read_b64_tr_b16 a[232:233], v5 offset:14336
    v_fma_f32 v56, v56, s28, v19
    v_mfma_f32_16x16x32_bf16 a[16:19], a[208:211], v[120:123], a[16:19]
    v_cvt_pk_bf16_f32 v99, v128, v129
    v_cvt_pk_bf16_f32 v98, v134, v135
    v_mfma_f32_16x16x32_bf16 a[64:67], a[208:211], v[124:127], a[64:67]
    v_exp_f32 v128, v48
    v_mfma_f32_16x16x32_bf16 v[180:183], a[212:215], v[112:115], v[180:183]
    v_exp_f32 v129, v49
    v_mfma_f32_16x16x32_bf16 v[228:231], a[212:215], v[116:119], v[228:231]
    v_exp_f32 v133, v45
    v_mfma_f32_16x16x32_bf16 a[20:23], a[212:215], v[120:123], a[20:23]
    ds_read_b128 v[136:139], v13 offset:0
    v_cvt_pk_bf16_f32 v104, v128, v129
    v_mfma_f32_16x16x32_bf16 a[68:71], a[212:215], v[124:127], a[68:71]
    s_waitcnt lgkmcnt(4)
    v_exp_f32 v132, v44
    v_mfma_f32_16x16x32_bf16 v[184:187], a[216:219], v[112:115], v[184:187]
    v_fma_f32 v42, v42, s28, v17
    v_mfma_f32_16x16x32_bf16 v[232:235], a[216:219], v[116:119], v[232:235]
    v_exp_f32 v134, v46
    v_mfma_f32_16x16x32_bf16 a[24:27], a[216:219], v[120:123], a[24:27]
    v_fma_f32 v53, v53, s28, v18
    v_fma_f32 v59, v59, s28, v19
    v_mfma_f32_16x16x32_bf16 a[72:75], a[216:219], v[124:127], a[72:75]
    v_fma_f32 v52, v52, s28, v18
    s_waitcnt vmcnt(10) lgkmcnt(1)
    v_mfma_f32_16x16x32_bf16 v[20:23], a[240:243], v[96:99], v[24:27]
    s_barrier
    v_mfma_f32_16x16x32_bf16 v[188:191], a[220:223], v[112:115], v[188:191]
    s_add_u32 m0, s22, 36864
    v_fma_f32 v55, v55, s28, v18
    v_fma_f32 v51, v51, s28, v18
    v_mfma_f32_16x16x32_bf16 v[236:239], a[220:223], v[116:119], v[236:239]
    v_exp_f32 v131, v43
    v_mfma_f32_16x16x32_bf16 a[28:31], a[220:223], v[120:123], a[28:31]
    buffer_load_dwordx4 v9, s[8:11], s21 offen lds
    v_mfma_f32_16x16x32_bf16 a[76:79], a[220:223], v[124:127], a[76:79]
    v_exp_f32 v130, v42
    v_mfma_f32_16x16x32_bf16 v[192:195], a[224:227], v[112:115], v[192:195]
    v_exp_f32 v128, v56
    v_mfma_f32_16x16x32_bf16 v[240:243], a[224:227], v[116:119], v[240:243]
    s_add_u32 s21, s21, 128
    ds_read_b128 a[212:215], v2 offset:14336
    v_cvt_pk_bf16_f32 v102, v132, v133
    v_mfma_f32_16x16x32_bf16 a[32:35], a[224:227], v[120:123], a[32:35]
    ds_read_b128 a[196:199], v2 offset:12288
    v_fma_f32 v61, v61, s28, v19
    v_mfma_f32_16x16x32_bf16 a[80:83], a[224:227], v[124:127], a[80:83]
    s_add_u32 m0, s22, 37888
    ds_read_b128 a[192:195], v1 offset:12288
    v_fma_f32 v50, v50, s28, v18
    v_mfma_f32_16x16x32_bf16 v[196:199], a[228:231], v[112:115], v[196:199]
    buffer_load_dwordx4 v9, s[8:11], s21 offen lds
    v_mfma_f32_16x16x32_bf16 v[244:247], a[228:231], v[116:119], v[244:247]
    ds_read_b128 a[200:203], v1 offset:13312
    v_mfma_f32_16x16x32_bf16 a[36:39], a[228:231], v[120:123], a[36:39]
    v_fma_f32 v54, v54, s28, v18
    v_cvt_pk_bf16_f32 v101, v130, v131
    v_mfma_f32_16x16x32_bf16 a[84:87], a[228:231], v[124:127], a[84:87]
    ds_read_b128 a[208:211], v1 offset:14336
    s_add_u32 s21, s21, 128
    v_mfma_f32_16x16x32_bf16 v[200:203], a[232:235], v[112:115], v[200:203]
    ds_read_b128 a[204:207], v2 offset:13312
    v_mfma_f32_16x16x32_bf16 v[248:251], a[232:235], v[116:119], v[248:251]
    v_fma_f32 v47, v47, s28, v17
    v_mfma_f32_16x16x32_bf16 a[40:43], a[232:235], v[120:123], a[40:43]
    ds_read_b128 a[224:227], v1 offset:19456
    v_mfma_f32_16x16x32_bf16 a[88:91], a[232:235], v[124:127], a[88:91]
    ds_read_b128 a[232:235], v1 offset:20480
    v_mfma_f32_16x16x32_bf16 v[204:207], a[236:239], v[112:115], v[204:207]
    s_add_u32 m0, s22, 38912
    v_exp_f32 v132, v52
    v_mfma_f32_16x16x32_bf16 v[252:255], a[236:239], v[116:119], v[252:255]
    buffer_load_dwordx4 v9, s[8:11], s21 offen lds
    v_mfma_f32_16x16x32_bf16 a[44:47], a[236:239], v[120:123], a[44:47]
    v_exp_f32 v133, v53
    v_mfma_f32_16x16x32_bf16 a[92:95], a[236:239], v[124:127], a[92:95]
    s_waitcnt lgkmcnt(4)
    ds_read_b128 a[220:223], v2 offset:18432
    v_fma_f32 v63, v63, s28, v19
    v_mfma_f32_16x16x32_bf16 v[64:67], a[192:195], a[96:99], 0
    s_add_u32 s21, s21, 12032
    v_exp_f32 v131, v51
    v_mfma_f32_16x16x32_bf16 v[64:67], a[196:199], a[100:103], v[64:67]
    v_exp_f32 v135, v47
    v_mfma_f32_16x16x32_bf16 v[64:67], a[200:203], a[104:107], v[64:67]
    s_waitcnt lgkmcnt(3)
    ds_read_b128 v[140:143], v13 offset:1024
    v_mfma_f32_16x16x32_bf16 v[64:67], a[204:207], a[108:111], v[64:67]
    ds_read_b128 a[236:239], v2 offset:20480
    v_cvt_pk_bf16_f32 v103, v134, v135
    v_mfma_f32_16x16x32_bf16 v[64:67], a[208:211], a[112:115], v[64:67]
    ds_read_b128 a[216:219], v1 offset:18432
    v_cvt_pk_bf16_f32 v106, v132, v133
    v_mfma_f32_16x16x32_bf16 v[64:67], a[212:215], a[116:119], v[64:67]
    v_exp_f32 v130, v50
    v_mfma_f32_16x16x32_bf16 v[72:75], a[192:195], a[120:123], 0
    buffer_store_dwordx4 v[136:139], v12, s[16:19], s24 offen offset:0 sc0 sc1 nt
    ds_read_b128 a[228:231], v2 offset:19456
    v_exp_f32 v134, v54
    v_mfma_f32_16x16x32_bf16 v[72:75], a[196:199], a[124:127], v[72:75]
    v_fma_f32 v60, v60, s28, v19
    v_cvt_pk_bf16_f32 v105, v130, v131
    v_mfma_f32_16x16x32_bf16 v[72:75], a[200:203], a[128:131], v[72:75]
    v_exp_f32 v135, v55
    v_mfma_f32_16x16x32_bf16 v[72:75], a[204:207], a[132:135], v[72:75]
    ds_read_b128 v[136:139], v13 offset:2048
    v_cvt_pk_bf16_f32 v107, v134, v135
    v_mfma_f32_16x16x32_bf16 v[72:75], a[208:211], a[136:139], v[72:75]
    v_exp_f32 v131, v59
    v_mfma_f32_16x16x32_bf16 v[20:23], a[244:247], v[100:103], v[20:23]
    v_exp_f32 v133, v61
    v_mfma_f32_16x16x32_bf16 v[72:75], a[212:215], a[140:143], v[72:75]
    v_exp_f32 v129, v57
    v_mfma_f32_16x16x32_bf16 v[80:83], a[192:195], a[144:147], 0
    v_exp_f32 v134, v62
    v_mfma_f32_16x16x32_bf16 v[80:83], a[196:199], a[148:151], v[80:83]
    v_cvt_pk_bf16_f32 v108, v128, v129
    v_mfma_f32_16x16x32_bf16 v[80:83], a[200:203], a[152:155], v[80:83]
    v_fma_f32 v58, v58, s28, v19
    v_mfma_f32_16x16x32_bf16 v[80:83], a[204:207], a[156:159], v[80:83]
    v_mfma_f32_16x16x32_bf16 v[80:83], a[208:211], a[160:163], v[80:83]
    v_exp_f32 v130, v58
    v_mfma_f32_16x16x32_bf16 v[80:83], a[212:215], a[164:167], v[80:83]
    v_exp_f32 v132, v60
    v_mfma_f32_16x16x32_bf16 v[88:91], a[192:195], a[168:171], 0
    v_exp_f32 v135, v63
    v_mfma_f32_16x16x32_bf16 v[20:23], a[248:251], v[104:107], v[20:23]
    s_add_u32 s57, s24, 128
    v_cvt_pk_bf16_f32 v109, v130, v131
    v_mfma_f32_16x16x32_bf16 v[88:91], a[196:199], a[172:175], v[88:91]
    s_waitcnt vmcnt(7) lgkmcnt(0)
    v_mfma_f32_16x16x32_bf16 v[88:91], a[200:203], a[176:179], v[88:91]
    v_cvt_pk_bf16_f32 v110, v132, v133
    v_cvt_pk_bf16_f32 v111, v134, v135
    v_mfma_f32_16x16x32_bf16 v[88:91], a[204:207], a[180:183], v[88:91]
    v_mfma_f32_16x16x32_bf16 v[88:91], a[208:211], a[184:187], v[88:91]
    v_mfma_f32_16x16x32_bf16 v[20:23], a[252:255], v[108:111], v[20:23]
    buffer_store_dwordx4 v[140:143], v12, s[16:19], s24 offen offset:3072 sc0 sc1 nt
    s_barrier
    ds_read_b64_tr_b16 a[192:193], v3 offset:0
    v_mfma_f32_16x16x32_bf16 v[88:91], a[212:215], a[188:191], v[88:91]
    s_add_u32 m0, s22, 12288
    ds_read_b128 v[140:143], v13 offset:3072
    v_mfma_f32_16x16x32_bf16 v[68:71], a[216:219], a[96:99], 0
    buffer_load_dwordx4 v9, s[4:7], s20 offen lds
    v_mfma_f32_16x16x32_bf16 v[68:71], a[220:223], a[100:103], v[68:71]
    ds_read_b64_tr_b16 a[194:195], v3 offset:6144
    v_cmp_lt_f32 vcc, s29, v20
    v_mfma_f32_16x16x32_bf16 v[68:71], a[224:227], a[104:107], v[68:71]
    ds_read_b64_tr_b16 a[196:197], v4 offset:0
    s_add_u32 s20, s20, 128
    v_mfma_f32_16x16x32_bf16 v[68:71], a[228:231], a[108:111], v[68:71]
    buffer_store_dwordx4 v[136:139], v12, s[16:19], s57 offen offset:0 sc0 sc1 nt
    s_cbranch_vccnz L_rs_tr43a
L_ret_tr43a:
    ds_read_b64_tr_b16 a[198:199], v4 offset:6144
    v_fma_f32 v65, v65, s28, v16
    v_mfma_f32_16x16x32_bf16 v[68:71], a[232:235], a[112:115], v[68:71]
    v_fma_f32 v66, v66, s28, v16
    s_add_u32 m0, s22, 13312
    v_mfma_f32_16x16x32_bf16 v[68:71], a[236:239], a[116:119], v[68:71]
    v_exp_f32 v130, v66
    v_mfma_f32_16x16x32_bf16 v[76:79], a[216:219], a[120:123], 0
    buffer_load_dwordx4 v9, s[4:7], s20 offen lds
    v_mfma_f32_16x16x32_bf16 v[76:79], a[220:223], a[124:127], v[76:79]
    v_fma_f32 v67, v67, s28, v16
    v_fma_f32 v64, v64, s28, v16
    v_mfma_f32_16x16x32_bf16 v[76:79], a[224:227], a[128:131], v[76:79]
    ds_read_b64_tr_b16 a[200:201], v5 offset:0
    v_mfma_f32_16x16x32_bf16 v[76:79], a[228:231], a[132:135], v[76:79]
    ds_read_b64_tr_b16 a[202:203], v5 offset:6144
    v_mfma_f32_16x16x32_bf16 v[76:79], a[232:235], a[136:139], v[76:79]
    v_exp_f32 v131, v67
    v_mfma_f32_16x16x32_bf16 v[76:79], a[236:239], a[140:143], v[76:79]
    v_exp_f32 v129, v65
    v_mfma_f32_16x16x32_bf16 v[84:87], a[216:219], a[144:147], 0
    ds_read_b64_tr_b16 a[204:205], v6 offset:0
    v_fma_f32 v73, v73, s28, v17
    v_mfma_f32_16x16x32_bf16 v[84:87], a[220:223], a[148:151], v[84:87]
    s_add_u32 s20, s20, 128
    v_fma_f32 v72, v72, s28, v17
    v_mfma_f32_16x16x32_bf16 v[84:87], a[224:227], a[152:155], v[84:87]
    ds_read_b64_tr_b16 a[206:207], v6 offset:6144
    v_mfma_f32_16x16x32_bf16 v[84:87], a[228:231], a[156:159], v[84:87]
    s_waitcnt lgkmcnt(4)
    buffer_store_dwordx4 v[140:143], v12, s[16:19], s57 offen offset:3072 sc0 sc1 nt
    ds_read_b64_tr_b16 a[208:209], v3 offset:1024
    v_exp_f32 v133, v73
    v_mfma_f32_16x16x32_bf16 v[84:87], a[232:235], a[160:163], v[84:87]
    v_exp_f32 v128, v64
    v_mfma_f32_16x16x32_bf16 v[84:87], a[236:239], a[164:167], v[84:87]
    ds_read_b64_tr_b16 a[210:211], v3 offset:7168
    v_mfma_f32_16x16x32_bf16 v[92:95], a[216:219], a[168:171], 0
    s_add_u32 m0, s22, 14336
    v_exp_f32 v132, v72
    v_mfma_f32_16x16x32_bf16 v[92:95], a[220:223], a[172:175], v[92:95]
    buffer_load_dwordx4 v9, s[4:7], s20 offen lds
    v_mfma_f32_16x16x32_bf16 v[92:95], a[224:227], a[176:179], v[92:95]
    s_add_u32 s20, s20, 12032
    v_cvt_pk_bf16_f32 v112, v128, v129
    v_mfma_f32_16x16x32_bf16 v[92:95], a[228:231], a[180:183], v[92:95]
    ds_read_b64_tr_b16 a[212:213], v4 offset:1024
    v_mfma_f32_16x16x32_bf16 v[92:95], a[232:235], a[184:187], v[92:95]
    v_cvt_pk_bf16_f32 v116, v132, v133
    v_cvt_pk_bf16_f32 v113, v130, v131
    v_mfma_f32_16x16x32_bf16 v[92:95], a[236:239], a[188:191], v[92:95]
    ds_read_b64_tr_b16 a[214:215], v4 offset:7168
    s_waitcnt lgkmcnt(10)
    v_mfma_f32_16x16x32_bf16 v[160:163], a[192:195], v[96:99], v[160:163]
    ds_read_b64_tr_b16 a[232:233], v5 offset:2048
    v_fma_f32 v77, v77, s28, v17
    v_mfma_f32_16x16x32_bf16 v[208:211], a[192:195], v[100:103], v[208:211]
    ds_read_b64_tr_b16 a[236:237], v6 offset:2048
    v_xor_b32 v8, 64, v7
    v_mfma_f32_16x16x32_bf16 a[0:3], a[192:195], v[104:107], a[0:3]
    ds_read_b128 a[128:131], v7 offset:8192
    v_exp_f32 v133, v77
    v_mfma_f32_16x16x32_bf16 a[48:51], a[192:195], v[108:111], a[48:51]
    ds_read_b64_tr_b16 a[234:235], v5 offset:8192
    s_waitcnt lgkmcnt(12)
    v_mfma_f32_16x16x32_bf16 v[164:167], a[196:199], v[96:99], v[164:167]
    ds_read_b128 a[144:147], v7 offset:12288
    v_fma_f32 v68, v68, s28, v16
    v_mfma_f32_16x16x32_bf16 v[212:215], a[196:199], v[100:103], v[212:215]
    ds_read_b64_tr_b16 a[226:227], v3 offset:8192
    v_fma_f32 v89, v89, s28, v19
    v_mfma_f32_16x16x32_bf16 a[4:7], a[196:199], v[104:107], a[4:7]
    ds_read_b64_tr_b16 a[238:239], v6 offset:8192
    v_fma_f32 v75, v75, s28, v17
    v_mfma_f32_16x16x32_bf16 a[52:55], a[196:199], v[108:111], a[52:55]
    s_waitcnt lgkmcnt(13)
    ds_read_b64_tr_b16 a[228:229], v4 offset:2048
    v_fma_f32 v87, v87, s28, v18
    v_mfma_f32_16x16x32_bf16 v[168:171], a[200:203], v[96:99], v[168:171]
    ds_read_b128 a[132:135], v8 offset:8192
    v_fma_f32 v95, v95, s28, v19
    v_mfma_f32_16x16x32_bf16 v[216:219], a[200:203], v[100:103], v[216:219]
    ds_read_b64_tr_b16 a[216:217], v5 offset:1024
    v_fma_f32 v71, v71, s28, v16
    v_mfma_f32_16x16x32_bf16 a[8:11], a[200:203], v[104:107], a[8:11]
    ds_read_b64_tr_b16 a[218:219], v5 offset:7168
    v_fma_f32 v91, v91, s28, v19
    v_mfma_f32_16x16x32_bf16 a[56:59], a[200:203], v[108:111], a[56:59]
    s_waitcnt lgkmcnt(9)
    ds_read_b64_tr_b16 a[222:223], v6 offset:7168
    v_fma_f32 v70, v70, s28, v16
    v_mfma_f32_16x16x32_bf16 v[172:175], a[204:207], v[96:99], v[172:175]
    ds_read_b128 a[104:107], v7 offset:2048
    v_fma_f32 v85, v85, s28, v18
    v_mfma_f32_16x16x32_bf16 v[220:223], a[204:207], v[100:103], v[220:223]
    ds_read_b64_tr_b16 a[224:225], v3 offset:2048
    v_fma_f32 v76, v76, s28, v17
    v_mfma_f32_16x16x32_bf16 a[12:15], a[204:207], v[104:107], a[12:15]
    v_exp_f32 v134, v68
    v_mfma_f32_16x16x32_bf16 a[60:63], a[204:207], v[108:111], a[60:63]
    ds_read_b64_tr_b16 a[230:231], v4 offset:8192
    v_fma_f32 v81, v81, s28, v18
    v_mfma_f32_16x16x32_bf16 v[176:179], a[208:211], v[96:99], v[176:179]
    ds_read_b64_tr_b16 a[220:221], v6 offset:1024
    v_fma_f32 v69, v69, s28, v16
    v_mfma_f32_16x16x32_bf16 v[224:227], a[208:211], v[100:103], v[224:227]
    ds_read_b128 a[120:123], v7 offset:6144
    v_fma_f32 v80, v80, s28, v18
    v_mfma_f32_16x16x32_bf16 a[16:19], a[208:211], v[104:107], a[16:19]
    ds_read_b128 a[100:103], v8 offset:0
    v_fma_f32 v78, v78, s28, v17
    v_mfma_f32_16x16x32_bf16 a[64:67], a[208:211], v[108:111], a[64:67]
    ds_read_b128 a[96:99], v7 offset:0
    v_fma_f32 v74, v74, s28, v17
    v_mfma_f32_16x16x32_bf16 v[180:183], a[212:215], v[96:99], v[180:183]
    v_exp_f32 v135, v69
    v_mfma_f32_16x16x32_bf16 v[228:231], a[212:215], v[100:103], v[228:231]
    ds_read_b128 a[108:111], v8 offset:2048
    v_fma_f32 v86, v86, s28, v18
    v_mfma_f32_16x16x32_bf16 a[20:23], a[212:215], v[104:107], a[20:23]
    v_exp_f32 v129, v71
    v_mfma_f32_16x16x32_bf16 a[68:71], a[212:215], v[108:111], a[68:71]
    s_waitcnt lgkmcnt(6)
    v_cvt_pk_bf16_f32 v114, v134, v135
    v_fma_f32 v79, v79, s28, v17
    v_mfma_f32_16x16x32_bf16 v[184:187], a[216:219], v[96:99], v[184:187]
    v_exp_f32 v134, v78
    v_mfma_f32_16x16x32_bf16 v[232:235], a[216:219], v[100:103], v[232:235]
    v_exp_f32 v132, v76
    v_mfma_f32_16x16x32_bf16 a[24:27], a[216:219], v[104:107], a[24:27]
    ds_read_b128 a[140:143], v8 offset:10240
    v_fma_f32 v84, v84, s28, v18
    v_mfma_f32_16x16x32_bf16 a[72:75], a[216:219], v[108:111], a[72:75]
    s_waitcnt vmcnt(10) lgkmcnt(4)
    ds_read_b128 a[112:115], v7 offset:4096
    v_fma_f32 v94, v94, s28, v19
    v_mfma_f32_16x16x32_bf16 v[188:191], a[220:223], v[96:99], v[188:191]
    s_barrier
    v_mfma_f32_16x16x32_bf16 v[236:239], a[220:223], v[100:103], v[236:239]
    s_add_u32 m0, s22, 24576
    v_exp_f32 v130, v74
    v_mfma_f32_16x16x32_bf16 a[28:31], a[220:223], v[104:107], a[28:31]
    ds_read_b128 a[196:199], v2 offset:0
    v_cvt_pk_bf16_f32 v118, v132, v133
    v_mfma_f32_16x16x32_bf16 a[76:79], a[220:223], v[108:111], a[76:79]
    v_exp_f32 v128, v70
    v_mfma_f32_16x16x32_bf16 v[192:195], a[224:227], v[96:99], v[192:195]
    ds_read_b128 a[204:207], v2 offset:1024
    buffer_load_dwordx4 v9, s[8:11], s21 offen lds
    v_mfma_f32_16x16x32_bf16 v[240:243], a[224:227], v[100:103], v[240:243]
    ds_read_b128 a[136:139], v7 offset:10240
    v_cvt_pk_bf16_f32 v115, v128, v129
    v_mfma_f32_16x16x32_bf16 a[32:35], a[224:227], v[104:107], a[32:35]
    ds_read_b128 a[164:167], v8 offset:16384
    v_fma_f32 v83, v83, s28, v18
    v_mfma_f32_16x16x32_bf16 a[80:83], a[224:227], v[108:111], a[80:83]
    v_exp_f32 v131, v75
    v_mfma_f32_16x16x32_bf16 v[196:199], a[228:231], v[96:99], v[196:199]
    s_add_u32 s21, s21, 128
    ds_read_b128 a[200:203], v1 offset:1024
    v_fma_f32 v93, v93, s28, v19
    v_mfma_f32_16x16x32_bf16 v[244:247], a[228:231], v[100:103], v[244:247]
    ds_read_b128 a[192:195], v1 offset:0
    v_fma_f32 v82, v82, s28, v18
    v_mfma_f32_16x16x32_bf16 v[24:27], a[240:243], v[112:115], v[20:23]
    s_add_u32 m0, s22, 25600
    ds_read_b128 a[116:119], v8 offset:4096
    v_cvt_pk_bf16_f32 v117, v130, v131
    v_mfma_f32_16x16x32_bf16 a[36:39], a[228:231], v[104:107], a[36:39]
    v_exp_f32 v133, v85
    v_mfma_f32_16x16x32_bf16 a[84:87], a[228:231], v[108:111], a[84:87]
    buffer_load_dwordx4 v9, s[8:11], s21 offen lds
    v_mfma_f32_16x16x32_bf16 v[200:203], a[232:235], v[96:99], v[200:203]
    ds_read_b128 a[212:215], v2 offset:2048
    v_mfma_f32_16x16x32_bf16 v[248:251], a[232:235], v[100:103], v[248:251]
    v_exp_f32 v135, v79
    v_mfma_f32_16x16x32_bf16 a[40:43], a[232:235], v[104:107], a[40:43]
    s_add_u32 s21, s21, 128
    ds_read_b128 a[124:127], v8 offset:6144
    s_add_u32 m0, s22, 26624
    v_mfma_f32_16x16x32_bf16 a[88:91], a[232:235], v[108:111], a[88:91]
    ds_read_b128 a[208:211], v1 offset:2048
    v_cvt_pk_bf16_f32 v119, v134, v135
    v_mfma_f32_16x16x32_bf16 v[204:207], a[236:239], v[96:99], v[204:207]
    buffer_load_dwordx4 v9, s[8:11], s21 offen lds
    ds_read_b128 a[148:151], v8 offset:12288
    v_mfma_f32_16x16x32_bf16 v[24:27], a[244:247], v[116:119], v[24:27]
    v_exp_f32 v128, v80
    v_mfma_f32_16x16x32_bf16 v[252:255], a[236:239], v[100:103], v[252:255]
    ds_read_b128 a[220:223], v2 offset:6144
    v_exp_f32 v132, v84
    v_mfma_f32_16x16x32_bf16 a[44:47], a[236:239], v[104:107], a[44:47]
    v_exp_f32 v131, v83
    v_mfma_f32_16x16x32_bf16 a[92:95], a[236:239], v[108:111], a[92:95]
    s_waitcnt lgkmcnt(5)
    ds_read_b128 a[152:155], v7 offset:14336
    v_fma_f32 v90, v90, s28, v19
    v_mfma_f32_16x16x32_bf16 v[32:35], a[192:195], a[96:99], 0
    ds_read_b128 a[232:235], v1 offset:8192
    v_fma_f32 v88, v88, s28, v19
    v_mfma_f32_16x16x32_bf16 v[32:35], a[196:199], a[100:103], v[32:35]
    ds_read_b128 a[160:163], v7 offset:16384
    v_exp_f32 v130, v82
    v_mfma_f32_16x16x32_bf16 v[32:35], a[200:203], a[104:107], v[32:35]
    ds_read_b128 a[228:231], v2 offset:7168
    v_mfma_f32_16x16x32_bf16 v[32:35], a[204:207], a[108:111], v[32:35]
    s_waitcnt lgkmcnt(6)
    ds_read_b128 a[156:159], v8 offset:14336
    v_fma_f32 v92, v92, s28, v19
    v_mfma_f32_16x16x32_bf16 v[32:35], a[208:211], a[112:115], v[32:35]
    ds_read_b128 a[236:239], v2 offset:8192
    v_mfma_f32_16x16x32_bf16 v[32:35], a[212:215], a[116:119], v[32:35]
    ds_read_b128 a[224:227], v1 offset:7168
    v_cvt_pk_bf16_f32 v121, v130, v131
    v_mfma_f32_16x16x32_bf16 v[40:43], a[192:195], a[120:123], 0
    ds_read_b128 a[216:219], v1 offset:6144
    v_mfma_f32_16x16x32_bf16 v[40:43], a[196:199], a[124:127], v[40:43]
    v_exp_f32 v129, v81
    v_mfma_f32_16x16x32_bf16 v[40:43], a[200:203], a[128:131], v[40:43]
    v_cvt_pk_bf16_f32 v122, v132, v133
    v_mfma_f32_16x16x32_bf16 v[40:43], a[204:207], a[132:135], v[40:43]
    v_exp_f32 v134, v86
    v_mfma_f32_16x16x32_bf16 v[40:43], a[208:211], a[136:139], v[40:43]
    v_exp_f32 v132, v92
    v_mfma_f32_16x16x32_bf16 v[40:43], a[212:215], a[140:143], v[40:43]
    s_add_u32 s21, s21, 12032
    v_exp_f32 v135, v87
    v_mfma_f32_16x16x32_bf16 v[48:51], a[192:195], a[144:147], 0
    s_waitcnt lgkmcnt(4)
    v_cvt_pk_bf16_f32 v120, v128, v129
    v_cvt_pk_bf16_f32 v123, v134, v135
    v_mfma_f32_16x16x32_bf16 v[48:51], a[196:199], a[148:151], v[48:51]
    v_exp_f32 v130, v90
    v_mfma_f32_16x16x32_bf16 v[48:51], a[200:203], a[152:155], v[48:51]
    s_waitcnt lgkmcnt(2)
    v_exp_f32 v129, v89
    v_mfma_f32_16x16x32_bf16 v[48:51], a[204:207], a[156:159], v[48:51]
    v_exp_f32 v135, v95
    v_mfma_f32_16x16x32_bf16 v[48:51], a[208:211], a[160:163], v[48:51]
    v_exp_f32 v133, v93
    v_mfma_f32_16x16x32_bf16 v[48:51], a[212:215], a[164:167], v[48:51]
    s_waitcnt vmcnt(10) lgkmcnt(0)
    v_exp_f32 v134, v94
    v_mfma_f32_16x16x32_bf16 v[24:27], a[248:251], v[120:123], v[24:27]
    s_barrier
    v_mfma_f32_16x16x32_bf16 v[36:39], a[216:219], a[96:99], 0
    s_add_u32 m0, s22, 0
    v_exp_f32 v128, v88
    v_mfma_f32_16x16x32_bf16 v[36:39], a[220:223], a[100:103], v[36:39]
    buffer_load_dwordx4 v9, s[4:7], s20 offen lds
    v_mfma_f32_16x16x32_bf16 v[36:39], a[224:227], a[104:107], v[36:39]
    ds_read_b64_tr_b16 a[192:193], v3 offset:12288
    v_mfma_f32_16x16x32_bf16 v[36:39], a[228:231], a[108:111], v[36:39]
    v_cvt_pk_bf16_f32 v127, v134, v135
    v_cvt_pk_bf16_f32 v126, v132, v133
    v_mfma_f32_16x16x32_bf16 v[36:39], a[232:235], a[112:115], v[36:39]
    ds_read_b64_tr_b16 a[194:195], v3 offset:18432
    v_mfma_f32_16x16x32_bf16 v[36:39], a[236:239], a[116:119], v[36:39]
    v_exp_f32 v131, v91
    v_mfma_f32_16x16x32_bf16 v[44:47], a[216:219], a[120:123], 0
    ds_read_b64_tr_b16 a[196:197], v4 offset:12288
    v_cvt_pk_bf16_f32 v124, v128, v129
    v_mfma_f32_16x16x32_bf16 v[44:47], a[220:223], a[124:127], v[44:47]
    ds_read_b64_tr_b16 a[198:199], v4 offset:18432
    s_add_u32 s20, s20, 128
    v_mfma_f32_16x16x32_bf16 v[44:47], a[224:227], a[128:131], v[44:47]
    v_cvt_pk_bf16_f32 v125, v130, v131
    v_mfma_f32_16x16x32_bf16 v[44:47], a[228:231], a[132:135], v[44:47]
    s_add_u32 m0, s22, 1024
    ds_read_b64_tr_b16 a[200:201], v5 offset:12288
    v_mfma_f32_16x16x32_bf16 v[44:47], a[232:235], a[136:139], v[44:47]
    buffer_load_dwordx4 v9, s[4:7], s20 offen lds
    v_mfma_f32_16x16x32_bf16 v[24:27], a[252:255], v[124:127], v[24:27]
    ds_read_b64_tr_b16 a[202:203], v5 offset:18432
    s_add_u32 s20, s20, 128
    v_mfma_f32_16x16x32_bf16 v[44:47], a[236:239], a[140:143], v[44:47]
    ds_read_b64_tr_b16 a[204:205], v6 offset:12288
    s_add_u32 m0, s22, 2048
    v_mfma_f32_16x16x32_bf16 v[52:55], a[216:219], a[144:147], 0
    ds_read_b64_tr_b16 a[206:207], v6 offset:18432
    v_mfma_f32_16x16x32_bf16 v[52:55], a[220:223], a[148:151], v[52:55]
    ds_read_b64_tr_b16 a[208:209], v3 offset:13312
    v_cmp_lt_f32 vcc, s29, v24
    v_mfma_f32_16x16x32_bf16 v[52:55], a[224:227], a[152:155], v[52:55]
    buffer_load_dwordx4 v9, s[4:7], s20 offen lds
    v_mfma_f32_16x16x32_bf16 v[52:55], a[228:231], a[156:159], v[52:55]
    ds_read_b64_tr_b16 a[210:211], v3 offset:19456
    v_mfma_f32_16x16x32_bf16 v[52:55], a[232:235], a[160:163], v[52:55]
    s_cbranch_vccnz L_rs_tr43b
L_ret_tr43b:
    ds_read_b64_tr_b16 a[212:213], v4 offset:13312
    v_mfma_f32_16x16x32_bf16 v[52:55], a[236:239], a[164:167], v[52:55]
    ds_read_b64_tr_b16 a[214:215], v4 offset:19456
    s_add_u32 s20, s20, 12032
    v_max3_f32 v30, v40, v41, v42
    s_waitcnt lgkmcnt(10)
    v_mfma_f32_16x16x32_bf16 v[160:163], a[192:195], v[112:115], v[160:163]
    ds_read_b64_tr_b16 a[226:227], v3 offset:20480
    v_max3_f32 v30, v30, v43, v44
    v_mfma_f32_16x16x32_bf16 v[208:211], a[192:195], v[116:119], v[208:211]
    v_max3_f32 v28, v32, v33, v34
    v_max3_f32 v28, v28, v35, v36
    v_mfma_f32_16x16x32_bf16 a[0:3], a[192:195], v[120:123], a[0:3]
    s_add_u32 s24, s34, 128
    ds_read_b64_tr_b16 a[230:231], v4 offset:20480
    v_max3_f32 v30, v30, v45, v46
    v_max3_f32 v28, v28, v37, v38
    v_mov_b32 v153, v24
    v_mov_b32 v152, v24
    v_mfma_f32_16x16x32_bf16 a[48:51], a[192:195], v[124:127], a[48:51]
    s_waitcnt lgkmcnt(10)
    ds_read_b64_tr_b16 a[216:217], v5 offset:13312
    v_max_f32 v28, v28, v39
    v_mfma_f32_16x16x32_bf16 v[164:167], a[196:199], v[112:115], v[164:167]
    v_mov_b32 v29, v28
    v_max_f32 v30, v30, v47
    v_mfma_f32_16x16x32_bf16 v[212:215], a[196:199], v[116:119], v[212:215]
    s_add_u32 s18, s34, 24576
    v_permlane32_swap_b32 v29, v28
    v_max_f32 v28, v28, v29
    v_mov_b32 v31, v30
    v_mfma_f32_16x16x32_bf16 a[4:7], a[196:199], v[120:123], a[4:7]
    s_mov_b32 s34, s33
    ds_read_b64_tr_b16 a[220:221], v6 offset:13312
    v_accvgpr_read_b32 v151, a51
    v_mov_b32 v29, v28
    v_mfma_f32_16x16x32_bf16 a[52:55], a[196:199], v[124:127], a[52:55]
    s_waitcnt lgkmcnt(4)
    v_permlane32_swap_b32 v31, v30
    v_mfma_f32_16x16x32_bf16 v[168:171], a[200:203], v[112:115], v[168:171]
    s_add_u32 s37, s37, 1
    v_permlane16_swap_b32 v29, v28
    v_mfma_f32_16x16x32_bf16 v[216:219], a[200:203], v[116:119], v[216:219]
    ds_read_b64_tr_b16 a[232:233], v5 offset:14336
    v_max_f32 v28, v28, v29
    v_mfma_f32_16x16x32_bf16 a[8:11], a[200:203], v[120:123], a[8:11]
    ds_read_b64_tr_b16 a[236:237], v6 offset:14336
    v_max_f32 v30, v30, v31
    v_mfma_f32_16x16x32_bf16 a[56:59], a[200:203], v[124:127], a[56:59]
    s_add_u32 s35, s35, 325632
    ds_read_b64_tr_b16 a[218:219], v5 offset:19456
    v_mul_f32_e64 v16, -s28, v28
    v_mfma_f32_16x16x32_bf16 v[172:175], a[204:207], v[112:115], v[172:175]
    ds_read_b64_tr_b16 a[228:229], v4 offset:14336
    v_fma_f32 v34, v34, s28, v16
    v_mfma_f32_16x16x32_bf16 v[220:223], a[204:207], v[116:119], v[220:223]
    s_lshl_b32 s42, s37, 1
    ds_read_b64_tr_b16 a[234:235], v5 offset:20480
    v_permlane16_swap_b32 v152, v153
    v_mfma_f32_16x16x32_bf16 a[12:15], a[204:207], v[120:123], a[12:15]
    s_lshr_b32 s42, s31, s42
    ds_read_b64_tr_b16 a[222:223], v6 offset:19456
    v_mov_b32 v31, v30
    v_fma_f32 v37, v37, s28, v16
    v_mfma_f32_16x16x32_bf16 a[60:63], a[204:207], v[124:127], a[60:63]
    s_xor_b32 s42, s42, s36
    ds_read_b64_tr_b16 a[224:225], v3 offset:14336
    v_max3_f32 v28, v48, v49, v50
    v_accvgpr_read_b32 v147, a3
    v_mfma_f32_16x16x32_bf16 v[176:179], a[208:211], v[112:115], v[176:179]
    s_and_b32 s42, s42, 3
    v_accvgpr_read_b32 v148, a48
    v_accvgpr_read_b32 v150, a50
    v_mfma_f32_16x16x32_bf16 v[224:227], a[208:211], v[116:119], v[224:227]
    s_mul_i32 s43, s3, 3
    v_rcp_f32 v156, v26
    v_fma_f32 v33, v33, s28, v16
    v_mfma_f32_16x16x32_bf16 a[16:19], a[208:211], v[120:123], a[16:19]
    s_lshl_b32 s44, s3, 2
    v_accvgpr_read_b32 v144, a0
    v_accvgpr_read_b32 v149, a49
    v_accvgpr_read_b32 v145, a1
    v_mfma_f32_16x16x32_bf16 a[64:67], a[208:211], v[124:127], a[64:67]
    s_mov_b32 s32, 1
    v_max3_f32 v28, v28, v51, v52
    v_permlane16_swap_b32 v31, v30
    v_mfma_f32_16x16x32_bf16 v[180:183], a[212:215], v[112:115], v[180:183]
    v_exp_f32 v135, v37
    v_mfma_f32_16x16x32_bf16 v[228:231], a[212:215], v[116:119], v[228:231]
    s_add_u32 s45, s43, 17
    v_max_f32 v30, v30, v31
    v_fma_f32 v32, v32, s28, v16
    v_fma_f32 v36, v36, s28, v16
    v_mfma_f32_16x16x32_bf16 a[20:23], a[212:215], v[120:123], a[20:23]
    s_cmp_eq_u32 s3, 0
    v_mul_f32_e64 v17, -s28, v30
    v_max3_f32 v28, v28, v53, v54
    v_mfma_f32_16x16x32_bf16 a[68:71], a[212:215], v[124:127], a[68:71]
    s_cselect_b32 s45, 16, s45
    v_fma_f32 v40, v40, s28, v17
    s_waitcnt lgkmcnt(0)
    v_mfma_f32_16x16x32_bf16 v[184:187], a[216:219], v[112:115], v[184:187]
    s_cselect_b32 s33, 1, 0
    ds_read_b64_tr_b16 a[238:239], v6 offset:20480
    v_xor_b32 v0, 32, v14
    v_mfma_f32_16x16x32_bf16 v[232:235], a[216:219], v[116:119], v[232:235]
    s_cmp_eq_u32 s42, 1
    v_max_f32 v28, v28, v55
    v_mov_b32 v29, v28
    v_mfma_f32_16x16x32_bf16 a[24:27], a[216:219], v[120:123], a[24:27]
    s_cselect_b32 s44, s45, s44
    v_fma_f32 v35, v35, s28, v16
    v_xor_b32 v15, 64, v14
    v_mfma_f32_16x16x32_bf16 a[72:75], a[216:219], v[124:127], a[72:75]
    s_cselect_b32 s32, s33, s32
    v_exp_f32 v132, v40
    v_mfma_f32_16x16x32_bf16 v[188:191], a[220:223], v[112:115], v[188:191]
    s_add_u32 s45, s43, 29
    v_exp_f32 v130, v34
    v_mfma_f32_16x16x32_bf16 v[236:239], a[220:223], v[116:119], v[236:239]
    s_cmp_eq_u32 s42, 2
    s_cselect_b32 s44, s45, s44
    v_fma_f32 v42, v42, s28, v17
    v_mfma_f32_16x16x32_bf16 a[28:31], a[220:223], v[120:123], a[28:31]
    s_cselect_b32 s32, 0, s32
    v_permlane32_swap_b32 v29, v28
    v_fma_f32 v43, v43, s28, v17
    v_mfma_f32_16x16x32_bf16 a[76:79], a[220:223], v[124:127], a[76:79]
    s_add_u32 s45, s43, 41
    v_accvgpr_read_b32 v146, a2
    s_cmp_eq_u32 s42, 3
    v_mfma_f32_16x16x32_bf16 v[192:195], a[224:227], v[112:115], v[192:195]
    s_cselect_b32 s44, s45, s44
    v_rcp_f32 v154, v25
    s_cselect_b32 s32, 0, s32
    v_mfma_f32_16x16x32_bf16 v[240:243], a[224:227], v[116:119], v[240:243]
    s_mul_i32 s44, s44, 6144
    v_exp_f32 v131, v35
    v_mfma_f32_16x16x32_bf16 a[32:35], a[224:227], v[120:123], a[32:35]
    s_add_u32 s33, s35, s44
    v_max_f32 v28, v28, v29
    v_exp_f32 v129, v33
    v_mfma_f32_16x16x32_bf16 a[80:83], a[224:227], v[124:127], a[80:83]
    s_mul_i32 s42, s32, 6144
    v_rcp_f32 v152, v152
    v_mfma_f32_16x16x32_bf16 v[196:199], a[228:231], v[112:115], v[196:199]
    s_add_u32 s42, s42, 18432
    v_fma_f32 v41, v41, s28, v17
    v_fma_f32 v44, v44, s28, v17
    s_add_u32 s42, s42, s33
    v_mfma_f32_16x16x32_bf16 v[244:247], a[228:231], v[116:119], v[244:247]
    s_cmp_ge_u32 s37, 8
    v_rcp_f32 v158, v27
    s_cselect_b32 s14, 0, s42
    v_mfma_f32_16x16x32_bf16 a[36:39], a[228:231], v[120:123], a[36:39]
    s_add_u32 s25, s33, 128
    v_cvt_pk_bf16_f32 v97, v130, v131
    v_fma_f32 v39, v39, s28, v16
    v_mov_b32 v29, v28
    v_mfma_f32_16x16x32_bf16 a[84:87], a[228:231], v[124:127], a[84:87]
    s_add_u32 s23, s38, 2048
    v_exp_f32 v133, v41
    v_mfma_f32_16x16x32_bf16 v[200:203], a[232:235], v[112:115], v[200:203]
    s_mov_b32 s30, 0
    v_permlane16_swap_b32 v29, v28
    v_max_f32 v28, v28, v29
    s_waitcnt vmcnt(6) lgkmcnt(0)
    v_mfma_f32_16x16x32_bf16 v[248:251], a[232:235], v[116:119], v[248:251]
    s_barrier
    ds_read_b128 a[212:215], v2 offset:14336
    v_mul_f32_e64 v18, -s28, v28
    v_mfma_f32_16x16x32_bf16 a[40:43], a[232:235], v[120:123], a[40:43]
    s_add_u32 m0, s22, 36864
    ds_read_b128 a[208:211], v1 offset:14336
    v_fma_f32 v50, v50, s28, v18
    v_mfma_f32_16x16x32_bf16 a[88:91], a[232:235], v[124:127], a[88:91]
    ds_read_b128 a[204:207], v2 offset:13312
    v_fma_f32 v47, v47, s28, v17
    v_fma_f32 v45, v45, s28, v17
    v_mfma_f32_16x16x32_bf16 v[204:207], a[236:239], v[112:115], v[204:207]
    ds_read_b128 a[200:203], v1 offset:13312
    v_cvt_pk_bf16_f32 v100, v132, v133
    v_mfma_f32_16x16x32_bf16 v[252:255], a[236:239], v[116:119], v[252:255]
    ds_read_b128 a[192:195], v1 offset:12288
    v_exp_f32 v134, v36
    v_mfma_f32_16x16x32_bf16 a[44:47], a[236:239], v[120:123], a[44:47]
    buffer_load_dwordx4 v9, s[8:11], s21 offen lds
    ds_read_b128 a[196:199], v2 offset:12288
    v_exp_f32 v128, v32
    v_pk_mul_f32 v[196:197], v[196:197], v[152:153] op_sel_hi:[1,0]
    v_pk_mul_f32 v[186:187], v[186:187], v[152:153] op_sel_hi:[1,0]
    v_pk_mul_f32 v[210:211], v[210:211], v[154:155] op_sel_hi:[1,0]
    v_pk_mul_f32 v[146:147], v[146:147], v[156:157] op_sel_hi:[1,0]
    v_pk_mul_f32 v[144:145], v[144:145], v[156:157] op_sel_hi:[1,0]
    v_pk_mul_f32 v[168:169], v[168:169], v[152:153] op_sel_hi:[1,0]
    v_pk_mul_f32 v[184:185], v[184:185], v[152:153] op_sel_hi:[1,0]
    v_pk_mul_f32 v[166:167], v[166:167], v[152:153] op_sel_hi:[1,0]
    v_cvt_pk_bf16_f32 v184, v184, v185
    v_pk_mul_f32 v[252:253], v[252:253], v[154:155] op_sel_hi:[1,0]
    v_cvt_pk_bf16_f32 v98, v134, v135
    v_pk_mul_f32 v[240:241], v[240:241], v[154:155] op_sel_hi:[1,0]
    v_pk_mul_f32 v[170:171], v[170:171], v[152:153] op_sel_hi:[1,0]
    v_pk_mul_f32 v[214:215], v[214:215], v[154:155] op_sel_hi:[1,0]
    v_pk_mul_f32 v[216:217], v[216:217], v[154:155] op_sel_hi:[1,0]
    v_pk_mul_f32 v[148:149], v[148:149], v[158:159] op_sel_hi:[1,0]
    v_pk_mul_f32 v[222:223], v[222:223], v[154:155] op_sel_hi:[1,0]
    v_cvt_pk_bf16_f32 v144, v144, v145
    v_pk_mul_f32 v[212:213], v[212:213], v[154:155] op_sel_hi:[1,0]
    v_pk_mul_f32 v[162:163], v[162:163], v[152:153] op_sel_hi:[1,0]
    v_pk_mul_f32 v[172:173], v[172:173], v[152:153] op_sel_hi:[1,0]
    v_pk_mul_f32 v[208:209], v[208:209], v[154:155] op_sel_hi:[1,0]
    v_pk_mul_f32 v[150:151], v[150:151], v[158:159] op_sel_hi:[1,0]
    v_cvt_pk_bf16_f32 v208, v208, v209
    v_pk_mul_f32 v[160:161], v[160:161], v[152:153] op_sel_hi:[1,0]
    v_pk_mul_f32 v[220:221], v[220:221], v[154:155] op_sel_hi:[1,0]
    v_fma_f32 v46, v46, s28, v17
    v_fma_f32 v51, v51, s28, v18
    v_fma_f32 v54, v54, s28, v18
    v_pk_mul_f32 v[164:165], v[164:165], v[152:153] op_sel_hi:[1,0]
    v_fma_f32 v38, v38, s28, v16
    v_cvt_pk_bf16_f32 v164, v164, v165
    v_cvt_pk_bf16_f32 v209, v210, v211
    v_mfma_f32_16x16x32_bf16 a[92:95], a[236:239], v[124:127], a[92:95]
    s_waitcnt lgkmcnt(1)
    v_exp_f32 v132, v44
    v_mfma_f32_16x16x32_bf16 v[64:67], a[192:195], a[96:99], 0
    s_waitcnt lgkmcnt(0)
    v_exp_f32 v134, v46
    v_mfma_f32_16x16x32_bf16 v[64:67], a[196:199], a[100:103], v[64:67]
    s_add_u32 s21, s21, 128
    v_cvt_pk_bf16_f32 v148, v148, v149
    v_cvt_pk_bf16_f32 v96, v128, v129
    v_mfma_f32_16x16x32_bf16 v[64:67], a[200:203], a[104:107], v[64:67]
    v_cvt_pk_bf16_f32 v145, v146, v147
    v_fma_f32 v55, v55, s28, v18
    v_exp_f32 v135, v47
    v_accvgpr_read_b32 v146, a6
    v_mfma_f32_16x16x32_bf16 v[64:67], a[204:207], a[108:111], v[64:67]
    v_accvgpr_read_b32 v147, a7
    v_cvt_pk_bf16_f32 v160, v160, v161
    v_mfma_f32_16x16x32_bf16 v[64:67], a[208:211], a[112:115], v[64:67]
    ds_read_b128 a[216:219], v1 offset:18432
    v_exp_f32 v131, v43
    v_mfma_f32_16x16x32_bf16 v[64:67], a[212:215], a[116:119], v[64:67]
    ds_read_b128 a[236:239], v2 offset:20480
    v_exp_f32 v130, v42
    v_cvt_pk_bf16_f32 v103, v134, v135
    v_mfma_f32_16x16x32_bf16 v[72:75], a[192:195], a[120:123], 0
    s_add_u32 m0, s22, 37888
    ds_read_b128 a[232:235], v1 offset:20480
    v_cvt_pk_bf16_f32 v101, v130, v131
    v_cvt_pk_bf16_f32 v161, v162, v163
    v_cvt_pk_bf16_f32 v212, v212, v213
    v_exp_f32 v134, v54
    v_mfma_f32_16x16x32_bf16 v[72:75], a[196:199], a[124:127], v[72:75]
    ds_read_b128 a[220:223], v2 offset:18432
    buffer_load_dwordx4 v9, s[8:11], s21 offen lds
    v_mfma_f32_16x16x32_bf16 v[72:75], a[200:203], a[128:131], v[72:75]
    v_exp_f32 v131, v51
    v_exp_f32 v135, v55
    v_mfma_f32_16x16x32_bf16 v[72:75], a[204:207], a[132:135], v[72:75]
    ds_read_b128 a[224:227], v1 offset:19456
    v_cvt_pk_bf16_f32 v165, v166, v167
    v_mfma_f32_16x16x32_bf16 v[72:75], a[208:211], a[136:139], v[72:75]
    ds_read_b128 a[228:231], v2 offset:19456
    v_exp_f32 v128, v38
    v_mfma_f32_16x16x32_bf16 v[72:75], a[212:215], a[140:143], v[72:75]
    v_exp_f32 v133, v45
    v_cvt_pk_bf16_f32 v149, v150, v151
    v_mfma_f32_16x16x32_bf16 v[80:83], a[192:195], a[144:147], 0
    ds_write2st64_b64 v14, v[160:161], v[208:209] offset0:0 offset1:12
    v_exp_f32 v130, v50
    v_pk_mul_f32 v[226:227], v[226:227], v[154:155] op_sel_hi:[1,0]
    v_pk_mul_f32 v[146:147], v[146:147], v[156:157] op_sel_hi:[1,0]
    v_fma_f32 v52, v52, s28, v18
    v_cvt_pk_bf16_f32 v107, v134, v135
    v_mfma_f32_16x16x32_bf16 v[80:83], a[196:199], a[148:151], v[80:83]
    s_add_u32 s21, s21, 128
    v_exp_f32 v129, v39
    v_mfma_f32_16x16x32_bf16 v[80:83], a[200:203], a[152:155], v[80:83]
    s_add_u32 m0, s22, 38912
    v_fma_f32 v48, v48, s28, v18
    v_fma_f32 v74, v74, s28, v17
    v_cvt_pk_bf16_f32 v105, v130, v131
    v_mfma_f32_16x16x32_bf16 v[80:83], a[204:207], a[156:159], v[80:83]
    buffer_load_dwordx4 v9, s[8:11], s21 offen lds
    v_cvt_pk_bf16_f32 v99, v128, v129
    v_mfma_f32_16x16x32_bf16 v[80:83], a[208:211], a[160:163], v[80:83]
    s_add_u32 s21, s21, 12032
    v_subrev_u32 v13, 20480, v13
    v_fma_f32 v49, v49, s28, v18
    v_mfma_f32_16x16x32_bf16 v[80:83], a[212:215], a[164:167], v[80:83]
    s_waitcnt vmcnt(6) lgkmcnt(1)
    ds_write2st64_b64 v14, v[144:145], v[148:149] offset0:24 offset1:36
    v_mfma_f32_16x16x32_bf16 v[68:71], a[216:219], a[96:99], 0
    s_barrier
    v_fma_f32 v64, v64, s28, v16
    v_cvt_pk_bf16_f32 v185, v186, v187
    v_mfma_f32_16x16x32_bf16 v[68:71], a[220:223], a[100:103], v[68:71]
    v_fma_f32 v53, v53, s28, v18
    v_fma_f32 v66, v66, s28, v16
    v_cvt_pk_bf16_f32 v216, v216, v217
    v_accvgpr_read_b32 v149, a53
    v_mfma_f32_16x16x32_bf16 v[68:71], a[224:227], a[104:107], v[68:71]
    ds_read_b64_tr_b16 a[192:193], v3 offset:0
    v_fma_f32 v67, v67, s28, v16
    v_mfma_f32_16x16x32_bf16 v[68:71], a[228:231], a[108:111], v[68:71]
    v_cvt_pk_bf16_f32 v102, v132, v133
    v_fma_f32 v82, v82, s28, v18
    v_mfma_f32_16x16x32_bf16 v[68:71], a[232:235], a[112:115], v[68:71]
    ds_read_b64_tr_b16 a[194:195], v3 offset:6144
    v_accvgpr_read_b32 v148, a52
    v_mfma_f32_16x16x32_bf16 v[68:71], a[236:239], a[116:119], v[68:71]
    ds_read_b64_tr_b16 a[196:197], v4 offset:0
    v_accvgpr_read_b32 v151, a55
    v_mfma_f32_16x16x32_bf16 v[76:79], a[216:219], a[120:123], 0
    ds_read_b64_tr_b16 a[198:199], v4 offset:6144
    v_cvt_pk_bf16_f32 v168, v168, v169
    v_mfma_f32_16x16x32_bf16 v[76:79], a[220:223], a[124:127], v[76:79]
    v_accvgpr_read_b32 v145, a5
    v_fma_f32 v73, v73, s28, v17
    v_mfma_f32_16x16x32_bf16 v[76:79], a[224:227], a[128:131], v[76:79]
    s_add_u32 m0, s22, 12288
    ds_read_b64_tr_b16 a[200:201], v5 offset:0
    buffer_load_dwordx4 v9, s[4:7], s20 offen lds
    v_mfma_f32_16x16x32_bf16 v[76:79], a[228:231], a[132:135], v[76:79]
    ds_read_b64_tr_b16 a[202:203], v5 offset:6144
    v_fma_f32 v68, v68, s28, v16
    v_mfma_f32_16x16x32_bf16 v[76:79], a[232:235], a[136:139], v[76:79]
    v_exp_f32 v130, v66
    v_mfma_f32_16x16x32_bf16 v[76:79], a[236:239], a[140:143], v[76:79]
    v_exp_f32 v128, v48
    v_exp_f32 v132, v52
    v_accvgpr_read_b32 v144, a4
    v_pk_mul_f32 v[180:181], v[180:181], v[152:153] op_sel_hi:[1,0]
    v_pk_mul_f32 v[144:145], v[144:145], v[156:157] op_sel_hi:[1,0]
    v_pk_mul_f32 v[224:225], v[224:225], v[154:155] op_sel_hi:[1,0]
    v_accvgpr_read_b32 v150, a54
    v_pk_mul_f32 v[174:175], v[174:175], v[152:153] op_sel_hi:[1,0]
    v_pk_mul_f32 v[254:255], v[254:255], v[154:155] op_sel_hi:[1,0]
    v_pk_mul_f32 v[250:251], v[250:251], v[154:155] op_sel_hi:[1,0]
    v_pk_mul_f32 v[148:149], v[148:149], v[158:159] op_sel_hi:[1,0]
    v_pk_mul_f32 v[204:205], v[204:205], v[152:153] op_sel_hi:[1,0]
    v_pk_mul_f32 v[176:177], v[176:177], v[152:153] op_sel_hi:[1,0]
    v_pk_mul_f32 v[218:219], v[218:219], v[154:155] op_sel_hi:[1,0]
    v_pk_mul_f32 v[150:151], v[150:151], v[158:159] op_sel_hi:[1,0]
    v_pk_mul_f32 v[182:183], v[182:183], v[152:153] op_sel_hi:[1,0]
    v_pk_mul_f32 v[190:191], v[190:191], v[152:153] op_sel_hi:[1,0]
    v_exp_f32 v134, v68
    v_cvt_pk_bf16_f32 v144, v144, v145
    v_exp_f32 v129, v49
    v_cvt_pk_bf16_f32 v213, v214, v215
    v_cvt_pk_bf16_f32 v104, v128, v129
    v_fma_f32 v69, v69, s28, v16
    v_mfma_f32_16x16x32_bf16 v[84:87], a[216:219], a[144:147], 0
    ds_read_b64_tr_b16 a[204:205], v6 offset:0
    v_cvt_pk_bf16_f32 v148, v148, v149
    v_cvt_pk_bf16_f32 v169, v170, v171
    v_mfma_f32_16x16x32_bf16 v[84:87], a[220:223], a[148:151], v[84:87]
    ds_write2st64_b64 v0, v[164:165], v[212:213] offset0:0 offset1:12
    v_mfma_f32_16x16x32_bf16 v[84:87], a[224:227], a[152:155], v[84:87]
    ds_read_b64_tr_b16 a[222:223], v6 offset:7168
    v_cvt_pk_bf16_f32 v145, v146, v147
    v_mfma_f32_16x16x32_bf16 v[84:87], a[228:231], a[156:159], v[84:87]
    ds_read_b64_tr_b16 a[206:207], v6 offset:6144
    v_cvt_pk_bf16_f32 v149, v150, v151
    v_fma_f32 v83, v83, s28, v18
    v_exp_f32 v133, v53
    v_cvt_pk_bf16_f32 v172, v172, v173
    v_pk_mul_f32 v[246:247], v[246:247], v[154:155] op_sel_hi:[1,0]
    v_pk_mul_f32 v[232:233], v[232:233], v[154:155] op_sel_hi:[1,0]
    v_accvgpr_read_b32 v146, a10
    v_pk_mul_f32 v[192:193], v[192:193], v[152:153] op_sel_hi:[1,0]
    v_pk_mul_f32 v[248:249], v[248:249], v[154:155] op_sel_hi:[1,0]
    v_exp_f32 v131, v67
    v_fma_f32 v70, v70, s28, v16
    v_cvt_pk_bf16_f32 v180, v180, v181
    v_mfma_f32_16x16x32_bf16 v[84:87], a[232:235], a[160:163], v[84:87]
    ds_read_b64_tr_b16 a[208:209], v3 offset:1024
    v_xor_b32 v8, 96, v14
    v_cvt_pk_bf16_f32 v220, v220, v221
    v_mfma_f32_16x16x32_bf16 v[84:87], a[236:239], a[164:167], v[84:87]
    s_waitcnt lgkmcnt(5)
    v_accvgpr_read_b32 v151, a59
    v_fma_f32 v81, v81, s28, v18
    v_fma_f32 v65, v65, s28, v16
    v_mfma_f32_16x16x32_bf16 v[160:163], a[192:195], v[96:99], 0
    s_add_u32 s20, s20, 128
    ds_write2st64_b64 v0, v[144:145], v[148:149] offset0:24 offset1:36
    v_accvgpr_read_b32 v148, a56
    v_pk_mul_f32 v[244:245], v[244:245], v[154:155] op_sel_hi:[1,0]
    v_fma_f32 v76, v76, s28, v17
    v_fma_f32 v77, v77, s28, v17
    v_exp_f32 v135, v69
    v_cvt_pk_bf16_f32 v113, v130, v131
    v_fma_f32 v78, v78, s28, v17
    v_cvt_pk_bf16_f32 v114, v134, v135
    v_accvgpr_read_b32 v147, a11
    v_pk_mul_f32 v[242:243], v[242:243], v[154:155] op_sel_hi:[1,0]
    v_pk_mul_f32 v[236:237], v[236:237], v[154:155] op_sel_hi:[1,0]
    v_pk_mul_f32 v[188:189], v[188:189], v[152:153] op_sel_hi:[1,0]
    v_exp_f32 v129, v65
    v_cvt_pk_bf16_f32 v196, v196, v197
    v_cvt_pk_bf16_f32 v106, v132, v133
    v_accvgpr_read_b32 v145, a9
    v_mfma_f32_16x16x32_bf16 v[208:211], a[192:195], v[100:103], 0
    ds_read_b64_tr_b16 a[210:211], v3 offset:7168
    v_accvgpr_read_b32 v144, a8
    v_mfma_f32_16x16x32_bf16 a[0:3], a[192:195], v[104:107], 0
    s_add_u32 m0, s22, 13312
    ds_read_b64_tr_b16 a[226:227], v3 offset:8192
    v_accvgpr_read_b32 v149, a57
    v_cvt_pk_bf16_f32 v240, v240, v241
    v_exp_f32 v133, v73
    v_exp_f32 v128, v64
    v_fma_f32 v79, v79, s28, v17
    v_pk_mul_f32 v[200:201], v[200:201], v[152:153] op_sel_hi:[1,0]
    v_cvt_pk_bf16_f32 v224, v224, v225
    v_cvt_pk_bf16_f32 v217, v218, v219
    v_cvt_pk_bf16_f32 v236, v236, v237
    v_mfma_f32_16x16x32_bf16 v[164:167], a[196:199], v[96:99], 0
    buffer_load_dwordx4 v9, s[4:7], s20 offen lds
    ds_read_b64_tr_b16 a[218:219], v5 offset:7168
    v_cvt_pk_bf16_f32 v204, v204, v205
    v_fma_f32 v71, v71, s28, v16
    v_pk_mul_f32 v[148:149], v[148:149], v[158:159] op_sel_hi:[1,0]
    v_fma_f32 v75, v75, s28, v17
    v_pk_mul_f32 v[144:145], v[144:145], v[156:157] op_sel_hi:[1,0]
    v_pk_mul_f32 v[178:179], v[178:179], v[152:153] op_sel_hi:[1,0]
    v_pk_mul_f32 v[146:147], v[146:147], v[156:157] op_sel_hi:[1,0]
    v_cvt_pk_bf16_f32 v176, v176, v177
    v_accvgpr_read_b32 v150, a58
    v_cvt_pk_bf16_f32 v144, v144, v145
    v_fma_f32 v86, v86, s28, v18
    v_cvt_pk_bf16_f32 v252, v252, v253
    v_cvt_pk_bf16_f32 v145, v146, v147
    v_mfma_f32_16x16x32_bf16 v[212:215], a[196:199], v[100:103], 0
    ds_write2st64_b64 v15, v[168:169], v[216:217] offset0:0 offset1:12
    v_pk_mul_f32 v[150:151], v[150:151], v[158:159] op_sel_hi:[1,0]
    v_cvt_pk_bf16_f32 v173, v174, v175
    v_cvt_pk_bf16_f32 v148, v148, v149
    v_cvt_pk_bf16_f32 v177, v178, v179
    v_cvt_pk_bf16_f32 v192, v192, v193
    v_pk_mul_f32 v[228:229], v[228:229], v[154:155] op_sel_hi:[1,0]
    v_accvgpr_read_b32 v147, a15
    v_accvgpr_read_b32 v146, a14
    v_pk_mul_f32 v[238:239], v[238:239], v[154:155] op_sel_hi:[1,0]
    v_cvt_pk_bf16_f32 v149, v150, v151
    v_accvgpr_read_b32 v150, a62
    v_accvgpr_read_b32 v151, a63
    v_fma_f32 v72, v72, s28, v17
    v_mfma_f32_16x16x32_bf16 v[20:23], a[240:243], v[96:99], 0
    s_add_u32 s20, s20, 128
    ds_write2st64_b64 v15, v[144:145], v[148:149] offset0:24 offset1:36
    v_cvt_pk_bf16_f32 v248, v248, v249
    v_accvgpr_read_b32 v145, a13
    v_cvt_pk_bf16_f32 v200, v200, v201
    v_fma_f32 v80, v80, s28, v18
    v_accvgpr_read_b32 v149, a61
    v_pk_mul_f32 v[230:231], v[230:231], v[154:155] op_sel_hi:[1,0]
    v_exp_f32 v130, v74
    v_pk_mul_f32 v[202:203], v[202:203], v[152:153] op_sel_hi:[1,0]
    v_accvgpr_read_b32 v148, a60
    v_accvgpr_read_b32 v144, a12
    v_pk_mul_f32 v[194:195], v[194:195], v[152:153] op_sel_hi:[1,0]
    v_exp_f32 v132, v72
    v_pk_mul_f32 v[150:151], v[150:151], v[158:159] op_sel_hi:[1,0]
    v_cvt_pk_bf16_f32 v232, v232, v233
    v_cvt_pk_bf16_f32 v221, v222, v223
    v_pk_mul_f32 v[146:147], v[146:147], v[156:157] op_sel_hi:[1,0]
    v_cvt_pk_bf16_f32 v112, v128, v129
    v_cvt_pk_bf16_f32 v181, v182, v183
    v_pk_mul_f32 v[144:145], v[144:145], v[156:157] op_sel_hi:[1,0]
    v_exp_f32 v135, v79
    v_exp_f32 v134, v78
    v_pk_mul_f32 v[234:235], v[234:235], v[154:155] op_sel_hi:[1,0]
    v_cvt_pk_bf16_f32 v144, v144, v145
    v_cvt_pk_bf16_f32 v145, v146, v147
    v_pk_mul_f32 v[148:149], v[148:149], v[158:159] op_sel_hi:[1,0]
    v_cvt_pk_bf16_f32 v253, v254, v255
    v_cvt_pk_bf16_f32 v116, v132, v133
    v_mfma_f32_16x16x32_bf16 v[20:23], a[244:247], v[100:103], v[20:23]
    s_add_u32 m0, s22, 14336
    ds_read_b64_tr_b16 a[216:217], v5 offset:1024
    ds_read_b64_tr_b16 a[212:213], v4 offset:1024
    buffer_load_dwordx4 v9, s[4:7], s20 offen lds
    v_cvt_pk_bf16_f32 v225, v226, v227
    v_cvt_pk_bf16_f32 v148, v148, v149
    v_cvt_pk_bf16_f32 v149, v150, v151
    v_accvgpr_read_b32 v150, a66
    v_accvgpr_read_b32 v146, a18
    v_accvgpr_read_b32 v147, a19
    v_accvgpr_read_b32 v151, a67
    v_mfma_f32_16x16x32_bf16 a[4:7], a[196:199], v[104:107], 0
    ds_write2st64_b64 v8, v[172:173], v[220:221] offset0:0 offset1:12
    v_exp_f32 v128, v70
    v_cvt_pk_bf16_f32 v188, v188, v189
    v_mfma_f32_16x16x32_bf16 v[168:171], a[200:203], v[96:99], 0
    s_add_u32 s20, s20, 12032
    ds_read_b64_tr_b16 a[214:215], v4 offset:7168
    ds_read_b64_tr_b16 a[228:229], v4 offset:2048
    v_mfma_f32_16x16x32_bf16 v[216:219], a[200:203], v[100:103], 0
    ds_write2st64_b64 v8, v[144:145], v[148:149] offset0:24 offset1:36
    v_exp_f32 v133, v77
    v_accvgpr_read_b32 v148, a64
    v_cvt_pk_bf16_f32 v228, v228, v229
    v_mfma_f32_16x16x32_bf16 a[8:11], a[200:203], v[104:107], 0
    s_waitcnt lgkmcnt(6)
    ds_read_b64_tr_b16 a[224:225], v3 offset:2048
    v_accvgpr_read_b32 v149, a65
    v_mfma_f32_16x16x32_bf16 v[172:175], a[204:207], v[96:99], 0
    s_add_u32 s56, s24, 4294967168
    ds_read_b128 v[136:139], v13 offset:0
    v_exp_f32 v129, v71
    v_accvgpr_read_b32 v144, a16
    v_cvt_pk_bf16_f32 v229, v230, v231
    v_fma_f32 v84, v84, s28, v18
    v_pk_mul_f32 v[150:151], v[150:151], v[158:159] op_sel_hi:[1,0]
    v_cvt_pk_bf16_f32 v241, v242, v243
    v_pk_mul_f32 v[148:149], v[148:149], v[158:159] op_sel_hi:[1,0]
    v_pk_mul_f32 v[146:147], v[146:147], v[156:157] op_sel_hi:[1,0]
    v_accvgpr_read_b32 v145, a17
    v_cvt_pk_bf16_f32 v148, v148, v149
    v_pk_mul_f32 v[144:145], v[144:145], v[156:157] op_sel_hi:[1,0]
    v_exp_f32 v131, v75
    v_cvt_pk_bf16_f32 v144, v144, v145
    v_cvt_pk_bf16_f32 v149, v150, v151
    v_mfma_f32_16x16x32_bf16 v[220:223], a[204:207], v[100:103], 0
    s_add_u32 s58, s25, 4294967168
    ds_read_b64_tr_b16 a[220:221], v6 offset:1024
    v_accvgpr_read_b32 v150, a70
    v_mfma_f32_16x16x32_bf16 a[12:15], a[204:207], v[104:107], 0
    ds_write2st64_b64 v14, v[176:177], v[224:225] offset0:4 offset1:16
    v_cvt_pk_bf16_f32 v115, v128, v129
    v_cvt_pk_bf16_f32 v145, v146, v147
    v_fma_f32 v85, v85, s28, v18
    v_fma_f32 v87, v87, s28, v18
    v_mfma_f32_16x16x32_bf16 v[176:179], a[208:211], v[96:99], 0
    s_add_u32 m0, s38, 0
    ds_write2st64_b64 v14, v[144:145], v[148:149] offset0:28 offset1:40
    v_pk_mul_f32 v[198:199], v[198:199], v[152:153] op_sel_hi:[1,0]
    v_accvgpr_read_b32 v149, a69
    v_accvgpr_read_b32 v144, a20
    v_cvt_pk_bf16_f32 v244, v244, v245
    v_accvgpr_read_b32 v146, a22
    v_accvgpr_read_b32 v148, a68
    v_cvt_pk_bf16_f32 v189, v190, v191
    v_accvgpr_read_b32 v147, a23
    v_accvgpr_read_b32 v145, a21
    v_pk_mul_f32 v[144:145], v[144:145], v[156:157] op_sel_hi:[1,0]
    v_pk_mul_f32 v[146:147], v[146:147], v[156:157] op_sel_hi:[1,0]
    v_accvgpr_read_b32 v151, a71
    v_cvt_pk_bf16_f32 v144, v144, v145
    v_mfma_f32_16x16x32_bf16 v[224:227], a[208:211], v[100:103], 0
    s_waitcnt lgkmcnt(3)
    ds_read_b128 v[140:143], v13 offset:1024
    buffer_load_dwordx4 v10, s[12:15], s58 offen nt lds
    v_cvt_pk_bf16_f32 v193, v194, v195
    v_cvt_pk_bf16_f32 v245, v246, v247
    v_cvt_pk_bf16_f32 v233, v234, v235
    v_pk_mul_f32 v[148:149], v[148:149], v[158:159] op_sel_hi:[1,0]
    v_pk_mul_f32 v[150:151], v[150:151], v[158:159] op_sel_hi:[1,0]
    v_exp_f32 v132, v76
    v_pk_mul_f32 v[206:207], v[206:207], v[152:153] op_sel_hi:[1,0]
    v_cvt_pk_bf16_f32 v145, v146, v147
    v_cvt_pk_bf16_f32 v119, v134, v135
    v_mfma_f32_16x16x32_bf16 a[16:19], a[208:211], v[104:107], 0
    s_add_u32 m0, s38, 1024
    ds_write2st64_b64 v0, v[180:181], v[228:229] offset0:4 offset1:16
    v_cvt_pk_bf16_f32 v148, v148, v149
    v_exp_f32 v135, v87
    v_cvt_pk_bf16_f32 v149, v150, v151
    v_mfma_f32_16x16x32_bf16 v[20:23], a[248:251], v[104:107], v[20:23]
    ds_write2st64_b64 v0, v[144:145], v[148:149] offset0:28 offset1:40
    v_accvgpr_read_b32 v146, a26
    v_accvgpr_read_b32 v149, a73
    v_mfma_f32_16x16x32_bf16 v[180:183], a[212:215], v[96:99], 0
    ds_write2st64_b64 v15, v[184:185], v[232:233] offset0:4 offset1:16
    v_accvgpr_read_b32 v145, a25
    v_accvgpr_read_b32 v148, a72
    v_pk_mul_f32 v[148:149], v[148:149], v[158:159] op_sel_hi:[1,0]
    v_accvgpr_read_b32 v147, a27
    v_cvt_pk_bf16_f32 v249, v250, v251
    v_accvgpr_read_b32 v144, a24
    v_pk_mul_f32 v[146:147], v[146:147], v[156:157] op_sel_hi:[1,0]
    v_pk_mul_f32 v[144:145], v[144:145], v[156:157] op_sel_hi:[1,0]
    v_cvt_pk_bf16_f32 v148, v148, v149
    v_accvgpr_read_b32 v150, a74
    v_mfma_f32_16x16x32_bf16 v[228:231], a[212:215], v[100:103], 0
    ds_read_b64_tr_b16 a[230:231], v4 offset:8192
    v_cvt_pk_bf16_f32 v144, v144, v145
    v_accvgpr_read_b32 v151, a75
    v_exp_f32 v128, v80
    v_mfma_f32_16x16x32_bf16 v[24:27], a[240:243], v[112:115], v[20:23]
    buffer_store_dwordx4 v[136:139], v12, s[16:19], s56 offen offset:0 sc0 sc1 nt
    s_nop 0
    ds_read_b128 v[136:139], v13 offset:6144
    v_cvt_pk_bf16_f32 v118, v132, v133
    v_pk_mul_f32 v[150:151], v[150:151], v[158:159] op_sel_hi:[1,0]
    v_cvt_pk_bf16_f32 v237, v238, v239
    v_cvt_pk_bf16_f32 v145, v146, v147
    v_cvt_pk_bf16_f32 v205, v206, v207
    v_cvt_pk_bf16_f32 v149, v150, v151
    v_mfma_f32_16x16x32_bf16 a[20:23], a[212:215], v[104:107], 0
    ds_write2st64_b64 v15, v[144:145], v[148:149] offset0:28 offset1:40
    v_accvgpr_read_b32 v151, a79
    v_accvgpr_read_b32 v147, a31
    v_accvgpr_read_b32 v150, a78
    v_accvgpr_read_b32 v144, a28
    v_accvgpr_read_b32 v146, a30
    v_accvgpr_read_b32 v148, a76
    v_pk_mul_f32 v[150:151], v[150:151], v[158:159] op_sel_hi:[1,0]
    v_accvgpr_read_b32 v145, a29
    v_pk_mul_f32 v[144:145], v[144:145], v[156:157] op_sel_hi:[1,0]
    v_accvgpr_read_b32 v149, a77
    v_pk_mul_f32 v[148:149], v[148:149], v[158:159] op_sel_hi:[1,0]
    v_pk_mul_f32 v[146:147], v[146:147], v[156:157] op_sel_hi:[1,0]
    v_cvt_pk_bf16_f32 v117, v130, v131
    v_cvt_pk_bf16_f32 v148, v148, v149
    v_cvt_pk_bf16_f32 v144, v144, v145
    v_cvt_pk_bf16_f32 v145, v146, v147
    v_cvt_pk_bf16_f32 v149, v150, v151
    v_mfma_f32_16x16x32_bf16 v[184:187], a[216:219], v[96:99], 0
    s_waitcnt lgkmcnt(2)
    ds_read_b64_tr_b16 a[232:233], v5 offset:2048
    ds_read_b64_tr_b16 a[236:237], v6 offset:2048
    buffer_load_dwordx4 v11, s[12:15], s58 offen nt lds
    v_mfma_f32_16x16x32_bf16 v[232:235], a[216:219], v[100:103], 0
    buffer_store_dwordx4 v[140:143], v12, s[16:19], s56 offen offset:3072 sc0 sc1 nt
    s_add_u32 s57, s24, 6016
    ds_write2st64_b64 v8, v[188:189], v[236:237] offset0:4 offset1:16
    v_accvgpr_read_b32 v151, a83
    v_exp_f32 v133, v85
    v_mfma_f32_16x16x32_bf16 a[24:27], a[216:219], v[104:107], 0
    s_add_u32 s59, s25, 6016
    ds_write2st64_b64 v8, v[144:145], v[148:149] offset0:28 offset1:40
    v_accvgpr_read_b32 v150, a82
    v_accvgpr_read_b32 v144, a32
    v_mfma_f32_16x16x32_bf16 v[188:191], a[220:223], v[96:99], 0
    s_add_u32 m0, s38, 6144
    ds_read_b128 v[140:143], v13 offset:7168
    v_accvgpr_read_b32 v148, a80
    v_exp_f32 v134, v86
    v_cvt_pk_bf16_f32 v197, v198, v199
    v_accvgpr_read_b32 v145, a33
    v_mfma_f32_16x16x32_bf16 v[236:239], a[220:223], v[100:103], 0
    s_waitcnt lgkmcnt(5)
    ds_read_b64_tr_b16 a[234:235], v5 offset:8192
    ds_read_b64_tr_b16 a[238:239], v6 offset:8192
    buffer_load_dwordx4 v10, s[12:15], s59 offen nt lds
    v_accvgpr_read_b32 v147, a35
    v_accvgpr_read_b32 v149, a81
    v_pk_mul_f32 v[148:149], v[148:149], v[158:159] op_sel_hi:[1,0]
    v_pk_mul_f32 v[150:151], v[150:151], v[158:159] op_sel_hi:[1,0]
    v_cvt_pk_bf16_f32 v148, v148, v149
    v_accvgpr_read_b32 v146, a34
    v_pk_mul_f32 v[146:147], v[146:147], v[156:157] op_sel_hi:[1,0]
    v_pk_mul_f32 v[144:145], v[144:145], v[156:157] op_sel_hi:[1,0]
    v_cvt_pk_bf16_f32 v149, v150, v151
    v_cvt_pk_bf16_f32 v144, v144, v145
    v_accvgpr_read_b32 v150, a86
    v_exp_f32 v129, v81
    v_mfma_f32_16x16x32_bf16 a[28:31], a[220:223], v[104:107], 0
    buffer_store_dwordx4 v[136:139], v12, s[16:19], s57 offen offset:0 sc0 sc1 nt
    s_add_u32 m0, s38, 7168
    ds_write2st64_b64 v14, v[192:193], v[240:241] offset0:8 offset1:20
    v_cvt_pk_bf16_f32 v145, v146, v147
    v_cvt_pk_bf16_f32 v201, v202, v203
    v_mfma_f32_16x16x32_bf16 v[192:195], a[224:227], v[96:99], 0
    ds_write2st64_b64 v14, v[144:145], v[148:149] offset0:32 offset1:44
    v_accvgpr_read_b32 v151, a87
    v_accvgpr_read_b32 v145, a37
    v_accvgpr_read_b32 v146, a38
    v_mfma_f32_16x16x32_bf16 v[240:243], a[224:227], v[100:103], 0
    s_waitcnt lgkmcnt(2)
    ds_read_b128 v[136:139], v13 offset:12288
    buffer_load_dwordx4 v11, s[12:15], s59 offen nt lds
    v_accvgpr_read_b32 v147, a39
    v_mfma_f32_16x16x32_bf16 a[32:35], a[224:227], v[104:107], 0
    ds_write2st64_b64 v0, v[196:197], v[244:245] offset0:8 offset1:20
    v_mfma_f32_16x16x32_bf16 v[196:199], a[228:231], v[96:99], 0
    buffer_store_dwordx4 v[140:143], v12, s[16:19], s57 offen offset:3072 sc0 sc1 nt
    s_add_u32 s56, s24, 12160
    s_add_u32 s58, s25, 12160
    ds_read_b128 v[140:143], v13 offset:13312
    v_accvgpr_read_b32 v149, a85
    v_accvgpr_read_b32 v148, a84
    v_accvgpr_read_b32 v144, a36
    v_pk_mul_f32 v[144:145], v[144:145], v[156:157] op_sel_hi:[1,0]
    v_pk_mul_f32 v[150:151], v[150:151], v[158:159] op_sel_hi:[1,0]
    v_pk_mul_f32 v[148:149], v[148:149], v[158:159] op_sel_hi:[1,0]
    v_exp_f32 v130, v82
    v_cvt_pk_bf16_f32 v144, v144, v145
    v_pk_mul_f32 v[146:147], v[146:147], v[156:157] op_sel_hi:[1,0]
    v_cvt_pk_bf16_f32 v148, v148, v149
    v_cvt_pk_bf16_f32 v149, v150, v151
    v_cvt_pk_bf16_f32 v145, v146, v147
    v_mfma_f32_16x16x32_bf16 v[244:247], a[228:231], v[100:103], 0
    s_add_u32 m0, s38, 12288
    ds_write2st64_b64 v0, v[144:145], v[148:149] offset0:32 offset1:44
    v_accvgpr_read_b32 v146, a42
    v_accvgpr_read_b32 v145, a41
    v_accvgpr_read_b32 v148, a88
    v_exp_f32 v132, v84
    v_accvgpr_read_b32 v149, a89
    v_accvgpr_read_b32 v144, a40
    v_pk_mul_f32 v[144:145], v[144:145], v[156:157] op_sel_hi:[1,0]
    v_accvgpr_read_b32 v151, a91
    v_cvt_pk_bf16_f32 v120, v128, v129
    v_accvgpr_read_b32 v147, a43
    v_pk_mul_f32 v[148:149], v[148:149], v[158:159] op_sel_hi:[1,0]
    v_accvgpr_read_b32 v150, a90
    v_pk_mul_f32 v[150:151], v[150:151], v[158:159] op_sel_hi:[1,0]
    v_cvt_pk_bf16_f32 v144, v144, v145
    v_pk_mul_f32 v[146:147], v[146:147], v[156:157] op_sel_hi:[1,0]
    v_cvt_pk_bf16_f32 v148, v148, v149
    v_cvt_pk_bf16_f32 v149, v150, v151
    v_cvt_pk_bf16_f32 v145, v146, v147
    v_mfma_f32_16x16x32_bf16 a[36:39], a[228:231], v[104:107], 0
    s_waitcnt lgkmcnt(1)
    buffer_load_dwordx4 v10, s[12:15], s58 offen nt lds
    ds_write2st64_b64 v15, v[200:201], v[248:249] offset0:8 offset1:20
    v_cvt_pk_bf16_f32 v123, v134, v135
    v_mfma_f32_16x16x32_bf16 v[200:203], a[232:235], v[96:99], 0
    s_add_u32 m0, s38, 13312
    ds_write2st64_b64 v15, v[144:145], v[148:149] offset0:32 offset1:44
    v_exp_f32 v131, v83
    v_mfma_f32_16x16x32_bf16 v[248:251], a[232:235], v[100:103], 0
    buffer_load_dwordx4 v11, s[12:15], s58 offen nt lds
    s_waitcnt vmcnt(16)
    ds_write2st64_b64 v8, v[204:205], v[252:253] offset0:8 offset1:20
    v_mfma_f32_16x16x32_bf16 a[40:43], a[232:235], v[104:107], 0
    s_barrier
    ds_read_b128 a[196:199], v2 offset:0
    ds_read_b128 a[192:195], v1 offset:0
    v_mfma_f32_16x16x32_bf16 v[204:207], a[236:239], v[96:99], 0
    ds_read_b128 a[200:203], v1 offset:1024
    v_cvt_pk_bf16_f32 v121, v130, v131
    v_mfma_f32_16x16x32_bf16 v[24:27], a[244:247], v[116:119], v[24:27]
    s_add_u32 m0, s22, 24576
    ds_read_b128 a[204:207], v2 offset:1024
    buffer_load_dwordx4 v9, s[8:11], s21 offen lds
    v_cvt_pk_bf16_f32 v122, v132, v133
    v_mfma_f32_16x16x32_bf16 v[252:255], a[236:239], v[100:103], 0
    buffer_store_dwordx4 v[136:139], v12, s[16:19], s56 offen offset:0 sc0 sc1 nt
    s_add_u32 s21, s21, 128
    s_add_u32 m0, s22, 25600
    ds_read_b128 a[208:211], v1 offset:2048
    v_accvgpr_read_b32 v148, a92
    v_accvgpr_read_b32 v149, a93
    v_mfma_f32_16x16x32_bf16 v[24:27], a[248:251], v[120:123], v[24:27]
    ds_read_b128 a[212:215], v2 offset:2048
    v_accvgpr_read_b32 v144, a44
    v_accvgpr_read_b32 v147, a47
    v_accvgpr_read_b32 v146, a46
    v_accvgpr_read_b32 v145, a45
    v_mfma_f32_16x16x32_bf16 a[44:47], a[236:239], v[104:107], 0
    buffer_store_dwordx4 v[140:143], v12, s[16:19], s56 offen offset:3072 sc0 sc1 nt
    s_nop 0
    ds_read_b128 v[140:143], v13 offset:19456
    v_cmp_lt_f32 vcc, s29, v24
    v_pk_mul_f32 v[146:147], v[146:147], v[156:157] op_sel_hi:[1,0]
    v_pk_mul_f32 v[144:145], v[144:145], v[156:157] op_sel_hi:[1,0]
    s_waitcnt lgkmcnt(5)
    s_nop 0
    v_mfma_f32_16x16x32_bf16 v[32:35], a[192:195], a[96:99], 0
    s_cbranch_vccnz L_rs_tr43d
L_ret_tr43d:
    ds_read_b128 a[232:235], v1 offset:8192
    v_mfma_f32_16x16x32_bf16 v[32:35], a[196:199], a[100:103], v[32:35]
    s_waitcnt lgkmcnt(4)
    ds_read_b128 v[136:139], v13 offset:18432
    buffer_load_dwordx4 v9, s[8:11], s21 offen lds
    v_mfma_f32_16x16x32_bf16 v[32:35], a[200:203], a[104:107], v[32:35]
    ds_read_b128 a[228:231], v2 offset:7168
    s_add_u32 s21, s21, 128
    v_mfma_f32_16x16x32_bf16 v[32:35], a[204:207], a[108:111], v[32:35]
    s_add_u32 m0, s22, 26624
    ds_read_b128 a[220:223], v2 offset:6144
    s_waitcnt lgkmcnt(6)
    v_mfma_f32_16x16x32_bf16 v[32:35], a[208:211], a[112:115], v[32:35]
    ds_read_b128 a[236:239], v2 offset:8192
    s_waitcnt lgkmcnt(6)
    v_mfma_f32_16x16x32_bf16 v[32:35], a[212:215], a[116:119], v[32:35]
    buffer_load_dwordx4 v9, s[8:11], s21 offen lds
    v_mfma_f32_16x16x32_bf16 v[40:43], a[192:195], a[120:123], 0
    s_add_u32 s21, s21, 12032
    ds_read_b128 a[216:219], v1 offset:6144
    v_add_u32 v13, 2048, v13
    v_mfma_f32_16x16x32_bf16 v[40:43], a[196:199], a[124:127], v[40:43]
    v_accvgpr_read_b32 v151, a95
    v_mfma_f32_16x16x32_bf16 v[40:43], a[200:203], a[128:131], v[40:43]
    s_add_u32 s56, s24, 18304
    s_add_u32 s58, s25, 18304
    ds_read_b128 a[224:227], v1 offset:7168
    v_mfma_f32_16x16x32_bf16 v[40:43], a[204:207], a[132:135], v[40:43]
    v_accvgpr_read_b32 v150, a94
    v_fma_f32 v35, v35, s28, v16
    v_mfma_f32_16x16x32_bf16 v[40:43], a[208:211], a[136:139], v[40:43]
    s_add_u32 m0, s38, 18432
    v_exp_f32 v131, v35
    v_mfma_f32_16x16x32_bf16 v[40:43], a[212:215], a[140:143], v[40:43]
    v_fma_f32 v34, v34, s28, v16
    v_cvt_pk_bf16_f32 v144, v144, v145
    v_mfma_f32_16x16x32_bf16 v[48:51], a[192:195], a[144:147], 0
    v_fma_f32 v33, v33, s28, v16
    v_cvt_pk_bf16_f32 v145, v146, v147
    v_mfma_f32_16x16x32_bf16 v[48:51], a[196:199], a[148:151], v[48:51]
    s_waitcnt lgkmcnt(3)
    buffer_load_dwordx4 v10, s[12:15], s58 offen nt lds
    v_mfma_f32_16x16x32_bf16 v[48:51], a[200:203], a[152:155], v[48:51]
    buffer_store_dwordx4 v[136:139], v12, s[16:19], s56 offen offset:0 sc0 sc1 nt
    v_fma_f32 v40, v40, s28, v17
    v_pk_mul_f32 v[148:149], v[148:149], v[158:159] op_sel_hi:[1,0]
    v_pk_mul_f32 v[150:151], v[150:151], v[158:159] op_sel_hi:[1,0]
    v_fma_f32 v32, v32, s28, v16
    v_fma_f32 v41, v41, s28, v17
    v_mfma_f32_16x16x32_bf16 v[48:51], a[204:207], a[156:159], v[48:51]
    s_add_u32 m0, s38, 19456
    v_exp_f32 v130, v34
    v_mfma_f32_16x16x32_bf16 v[48:51], a[208:211], a[160:163], v[48:51]
    buffer_load_dwordx4 v11, s[12:15], s58 offen nt lds
    v_mfma_f32_16x16x32_bf16 v[48:51], a[212:215], a[164:167], v[48:51]
    s_waitcnt vmcnt(21) lgkmcnt(0)
    v_exp_f32 v128, v32
    v_mfma_f32_16x16x32_bf16 v[36:39], a[216:219], a[96:99], 0
    s_barrier
    v_mfma_f32_16x16x32_bf16 v[36:39], a[220:223], a[100:103], v[36:39]
    v_exp_f32 v132, v40
    v_mfma_f32_16x16x32_bf16 v[36:39], a[224:227], a[104:107], v[36:39]
    v_exp_f32 v129, v33
    v_mfma_f32_16x16x32_bf16 v[36:39], a[228:231], a[108:111], v[36:39]
    s_add_u32 m0, s22, 0
    ds_read_b64_tr_b16 a[192:193], v3 offset:12288
    v_cvt_pk_bf16_f32 v96, v128, v129
    v_mfma_f32_16x16x32_bf16 v[36:39], a[232:235], a[112:115], v[36:39]
    buffer_load_dwordx4 v9, s[4:7], s20 offen lds
    ds_read_b64_tr_b16 a[194:195], v3 offset:18432
    v_mfma_f32_16x16x32_bf16 v[36:39], a[236:239], a[116:119], v[36:39]
    ds_read_b64_tr_b16 a[196:197], v4 offset:12288
    v_cvt_pk_bf16_f32 v148, v148, v149
    v_mfma_f32_16x16x32_bf16 v[44:47], a[216:219], a[120:123], 0
    ds_read_b64_tr_b16 a[198:199], v4 offset:18432
    v_mfma_f32_16x16x32_bf16 v[44:47], a[220:223], a[124:127], v[44:47]
    s_add_u32 s20, s20, 128
    v_exp_f32 v133, v41
    v_mfma_f32_16x16x32_bf16 v[44:47], a[224:227], a[128:131], v[44:47]
    s_add_u32 m0, s22, 1024
    ds_read_b64_tr_b16 a[200:201], v5 offset:12288
    v_cvt_pk_bf16_f32 v100, v132, v133
    v_mfma_f32_16x16x32_bf16 v[44:47], a[228:231], a[132:135], v[44:47]
    ds_read_b64_tr_b16 a[202:203], v5 offset:18432
    buffer_load_dwordx4 v9, s[4:7], s20 offen lds
    v_mfma_f32_16x16x32_bf16 v[44:47], a[232:235], a[136:139], v[44:47]
    ds_read_b64_tr_b16 a[204:205], v6 offset:12288
    v_mfma_f32_16x16x32_bf16 v[44:47], a[236:239], a[140:143], v[44:47]
    s_add_u32 s20, s20, 128
    ds_read_b64_tr_b16 a[206:207], v6 offset:18432
    v_cvt_pk_bf16_f32 v149, v150, v151
    v_mfma_f32_16x16x32_bf16 v[52:55], a[216:219], a[144:147], 0
    buffer_store_dwordx4 v[140:143], v12, s[16:19], s56 offen offset:3072 sc0 sc1 nt
    ds_write2st64_b64 v8, v[144:145], v[148:149] offset0:32 offset1:44
    v_mfma_f32_16x16x32_bf16 v[52:55], a[220:223], a[148:151], v[52:55]
    ds_read_b64_tr_b16 a[208:209], v3 offset:13312
    v_mfma_f32_16x16x32_bf16 v[52:55], a[224:227], a[152:155], v[52:55]
    ds_read_b64_tr_b16 a[210:211], v3 offset:19456
    v_cvt_pk_bf16_f32 v97, v130, v131
    v_mfma_f32_16x16x32_bf16 v[52:55], a[228:231], a[156:159], v[52:55]
    s_add_u32 m0, s22, 2048
    ds_read_b64_tr_b16 a[212:213], v4 offset:13312
    v_mfma_f32_16x16x32_bf16 v[52:55], a[232:235], a[160:163], v[52:55]
    buffer_load_dwordx4 v9, s[4:7], s20 offen lds
    v_mfma_f32_16x16x32_bf16 v[52:55], a[236:239], a[164:167], v[52:55]
    s_add_u32 s20, s20, 12032
    ds_read_b64_tr_b16 a[214:215], v4 offset:19456
    s_branch L_loop3
L_tr44:
    s_waitcnt lgkmcnt(10)
    v_mfma_f32_16x16x32_bf16 v[160:163], a[192:195], v[112:115], v[160:163]
    ds_read_b128 v[136:139], v13 offset:0
    v_fma_f32 v43, v43, s28, v17
    v_mfma_f32_16x16x32_bf16 v[208:211], a[192:195], v[116:119], v[208:211]
    ds_read_b64_tr_b16 a[218:219], v5 offset:19456
    v_fma_f32 v39, v39, s28, v16
    v_mfma_f32_16x16x32_bf16 a[0:3], a[192:195], v[120:123], a[0:3]
    ds_read_b64_tr_b16 a[236:237], v6 offset:14336
    v_fma_f32 v49, v49, s28, v18
    v_fma_f32 v44, v44, s28, v17
    v_fma_f32 v36, v36, s28, v16
    v_mfma_f32_16x16x32_bf16 a[48:51], a[192:195], v[124:127], a[48:51]
    s_waitcnt lgkmcnt(11)
    ds_read_b64_tr_b16 a[230:231], v4 offset:20480
    v_fma_f32 v58, v58, s28, v19
    v_mfma_f32_16x16x32_bf16 v[164:167], a[196:199], v[112:115], v[164:167]
    ds_read_b64_tr_b16 a[226:227], v3 offset:20480
    v_fma_f32 v42, v42, s28, v17
    v_mfma_f32_16x16x32_bf16 v[212:215], a[196:199], v[116:119], v[212:215]
    ds_read_b64_tr_b16 a[222:223], v6 offset:19456
    v_fma_f32 v48, v48, s28, v18
    v_mfma_f32_16x16x32_bf16 a[4:7], a[196:199], v[120:123], a[4:7]
    ds_read_b64_tr_b16 a[232:233], v5 offset:14336
    v_fma_f32 v46, v46, s28, v17
    v_mfma_f32_16x16x32_bf16 a[52:55], a[196:199], v[124:127], a[52:55]
    s_waitcnt lgkmcnt(12)
    ds_read_b64_tr_b16 a[216:217], v5 offset:13312
    v_fma_f32 v62, v62, s28, v19
    v_mfma_f32_16x16x32_bf16 v[168:171], a[200:203], v[112:115], v[168:171]
    ds_read_b64_tr_b16 a[238:239], v6 offset:20480
    v_fma_f32 v37, v37, s28, v16
    v_mfma_f32_16x16x32_bf16 v[216:219], a[200:203], v[116:119], v[216:219]
    v_exp_f32 v134, v36
    v_mfma_f32_16x16x32_bf16 a[8:11], a[200:203], v[120:123], a[8:11]
    v_exp_f32 v132, v44
    v_mfma_f32_16x16x32_bf16 a[56:59], a[200:203], v[124:127], a[56:59]
    s_waitcnt lgkmcnt(7)
    ds_read_b64_tr_b16 a[234:235], v5 offset:20480
    v_fma_f32 v54, v54, s28, v18
    v_mfma_f32_16x16x32_bf16 v[172:175], a[204:207], v[112:115], v[172:175]
    ds_read_b64_tr_b16 a[224:225], v3 offset:14336
    v_fma_f32 v51, v51, s28, v18
    v_mfma_f32_16x16x32_bf16 v[220:223], a[204:207], v[116:119], v[220:223]
    v_fma_f32 v52, v52, s28, v18
    v_fma_f32 v47, v47, s28, v17
    v_mfma_f32_16x16x32_bf16 a[12:15], a[204:207], v[120:123], a[12:15]
    ds_read_b64_tr_b16 a[220:221], v6 offset:13312
    v_fma_f32 v61, v61, s28, v19
    v_mfma_f32_16x16x32_bf16 a[60:63], a[204:207], v[124:127], a[60:63]
    ds_read_b64_tr_b16 a[228:229], v4 offset:14336
    v_fma_f32 v38, v38, s28, v16
    v_mfma_f32_16x16x32_bf16 v[176:179], a[208:211], v[112:115], v[176:179]
    v_exp_f32 v135, v37
    v_mfma_f32_16x16x32_bf16 v[224:227], a[208:211], v[116:119], v[224:227]
    v_cvt_pk_bf16_f32 v98, v134, v135
    v_fma_f32 v45, v45, s28, v17
    v_mfma_f32_16x16x32_bf16 a[16:19], a[208:211], v[120:123], a[16:19]
    v_exp_f32 v134, v46
    v_mfma_f32_16x16x32_bf16 a[64:67], a[208:211], v[124:127], a[64:67]
    v_exp_f32 v128, v38
    v_mfma_f32_16x16x32_bf16 v[180:183], a[212:215], v[112:115], v[180:183]
    v_exp_f32 v130, v42
    v_mfma_f32_16x16x32_bf16 v[228:231], a[212:215], v[116:119], v[228:231]
    v_exp_f32 v135, v47
    v_mfma_f32_16x16x32_bf16 a[20:23], a[212:215], v[120:123], a[20:23]
    v_exp_f32 v129, v39
    v_mfma_f32_16x16x32_bf16 a[68:71], a[212:215], v[124:127], a[68:71]
    s_waitcnt lgkmcnt(2)
    v_cvt_pk_bf16_f32 v99, v128, v129
    v_exp_f32 v131, v43
    v_mfma_f32_16x16x32_bf16 v[184:187], a[216:219], v[112:115], v[184:187]
    v_cvt_pk_bf16_f32 v101, v130, v131
    v_cvt_pk_bf16_f32 v103, v134, v135
    v_mfma_f32_16x16x32_bf16 v[20:23], a[240:243], v[96:99], v[24:27]
    v_exp_f32 v133, v45
    v_mfma_f32_16x16x32_bf16 v[232:235], a[216:219], v[116:119], v[232:235]
    s_waitcnt vmcnt(10) lgkmcnt(0)
    v_cvt_pk_bf16_f32 v102, v132, v133
    v_fma_f32 v55, v55, s28, v18
    v_mfma_f32_16x16x32_bf16 a[24:27], a[216:219], v[120:123], a[24:27]
    v_exp_f32 v128, v48
    v_mfma_f32_16x16x32_bf16 v[20:23], a[244:247], v[100:103], v[20:23]
    s_barrier
    v_mfma_f32_16x16x32_bf16 a[72:75], a[216:219], v[124:127], a[72:75]
    s_add_u32 m0, s22, 36864
    v_exp_f32 v129, v49
    v_mfma_f32_16x16x32_bf16 v[188:191], a[220:223], v[112:115], v[188:191]
    v_exp_f32 v134, v54
    v_mfma_f32_16x16x32_bf16 v[236:239], a[220:223], v[116:119], v[236:239]
    v_cvt_pk_bf16_f32 v104, v128, v129
    v_fma_f32 v53, v53, s28, v18
    v_mfma_f32_16x16x32_bf16 a[28:31], a[220:223], v[120:123], a[28:31]
    ds_read_b128 a[192:195], v1 offset:12288
    v_fma_f32 v50, v50, s28, v18
    v_mfma_f32_16x16x32_bf16 a[76:79], a[220:223], v[124:127], a[76:79]
    buffer_load_dwordx4 v9, s[8:11], s21 offen lds
    v_mfma_f32_16x16x32_bf16 v[192:195], a[224:227], v[112:115], v[192:195]
    ds_read_b128 a[200:203], v1 offset:13312
    v_mfma_f32_16x16x32_bf16 v[240:243], a[224:227], v[116:119], v[240:243]
    ds_read_b128 v[140:143], v13 offset:1024
    v_fma_f32 v60, v60, s28, v19
    v_mfma_f32_16x16x32_bf16 a[32:35], a[224:227], v[120:123], a[32:35]
    s_add_u32 s21, s21, 128
    ds_read_b128 a[208:211], v1 offset:14336
    s_add_u32 m0, s22, 37888
    v_mfma_f32_16x16x32_bf16 a[80:83], a[224:227], v[124:127], a[80:83]
    ds_read_b128 a[204:207], v2 offset:13312
    v_fma_f32 v59, v59, s28, v19
    v_mfma_f32_16x16x32_bf16 v[196:199], a[228:231], v[112:115], v[196:199]
    buffer_load_dwordx4 v9, s[8:11], s21 offen lds
    v_mfma_f32_16x16x32_bf16 v[244:247], a[228:231], v[116:119], v[244:247]
    buffer_store_dwordx4 v[136:139], v12, s[16:19], s24 offen offset:0 sc0 sc1 nt
    ds_read_b128 a[196:199], v2 offset:12288
    s_add_u32 s21, s21, 128
    s_add_u32 m0, s22, 38912
    v_mfma_f32_16x16x32_bf16 a[36:39], a[228:231], v[120:123], a[36:39]
    v_exp_f32 v135, v55
    v_mfma_f32_16x16x32_bf16 a[84:87], a[228:231], v[124:127], a[84:87]
    v_exp_f32 v130, v50
    v_mfma_f32_16x16x32_bf16 v[200:203], a[232:235], v[112:115], v[200:203]
    buffer_load_dwordx4 v9, s[8:11], s21 offen lds
    v_mfma_f32_16x16x32_bf16 v[248:251], a[232:235], v[116:119], v[248:251]
    v_fma_f32 v56, v56, s28, v19
    v_fma_f32 v57, v57, s28, v19
    v_mfma_f32_16x16x32_bf16 a[40:43], a[232:235], v[120:123], a[40:43]
    s_add_u32 s21, s21, 12032
    v_exp_f32 v132, v52
    v_mfma_f32_16x16x32_bf16 a[88:91], a[232:235], v[124:127], a[88:91]
    s_add_u32 m0, s38, 20480
    v_exp_f32 v131, v51
    v_mfma_f32_16x16x32_bf16 v[204:207], a[236:239], v[112:115], v[204:207]
    ds_read_b128 a[212:215], v2 offset:14336
    v_fma_f32 v63, v63, s28, v19
    v_mfma_f32_16x16x32_bf16 v[252:255], a[236:239], v[116:119], v[252:255]
    v_exp_f32 v129, v57
    v_mfma_f32_16x16x32_bf16 a[44:47], a[236:239], v[120:123], a[44:47]
    buffer_load_dwordx4 v10, s[12:15], s25 offen nt lds
    v_mfma_f32_16x16x32_bf16 a[92:95], a[236:239], v[124:127], a[92:95]
    s_waitcnt lgkmcnt(1)
    ds_read_b128 a[220:223], v2 offset:18432
    v_mfma_f32_16x16x32_bf16 v[64:67], a[192:195], a[96:99], 0
    v_exp_f32 v133, v53
    v_mfma_f32_16x16x32_bf16 v[64:67], a[196:199], a[100:103], v[64:67]
    ds_read_b128 v[136:139], v13 offset:2048
    v_cvt_pk_bf16_f32 v106, v132, v133
    v_mfma_f32_16x16x32_bf16 v[64:67], a[200:203], a[104:107], v[64:67]
    v_cvt_pk_bf16_f32 v107, v134, v135
    v_cvt_pk_bf16_f32 v105, v130, v131
    v_mfma_f32_16x16x32_bf16 v[64:67], a[204:207], a[108:111], v[64:67]
    buffer_store_dwordx4 v[140:143], v12, s[16:19], s24 offen offset:3072 sc0 sc1 nt
    s_add_u32 m0, s38, 21504
    ds_read_b128 a[224:227], v1 offset:19456
    v_exp_f32 v132, v60
    v_mfma_f32_16x16x32_bf16 v[64:67], a[208:211], a[112:115], v[64:67]
    ds_read_b128 a[236:239], v2 offset:20480
    s_waitcnt lgkmcnt(4)
    v_mfma_f32_16x16x32_bf16 v[64:67], a[212:215], a[116:119], v[64:67]
    buffer_load_dwordx4 v11, s[12:15], s25 offen nt lds
    v_mfma_f32_16x16x32_bf16 v[72:75], a[192:195], a[120:123], 0
    s_add_u32 s57, s24, 128
    ds_read_b128 v[140:143], v13 offset:3072
    s_add_u32 s59, s25, 128
    v_mfma_f32_16x16x32_bf16 v[72:75], a[196:199], a[124:127], v[72:75]
    v_exp_f32 v128, v56
    v_mfma_f32_16x16x32_bf16 v[72:75], a[200:203], a[128:131], v[72:75]
    ds_read_b128 a[216:219], v1 offset:18432
    s_add_u32 m0, s38, 22528
    v_mfma_f32_16x16x32_bf16 v[72:75], a[204:207], a[132:135], v[72:75]
    v_exp_f32 v134, v62
    v_mfma_f32_16x16x32_bf16 v[72:75], a[208:211], a[136:139], v[72:75]
    ds_read_b128 a[232:235], v1 offset:20480
    v_mfma_f32_16x16x32_bf16 v[72:75], a[212:215], a[140:143], v[72:75]
    ds_read_b128 a[228:231], v2 offset:19456
    v_mfma_f32_16x16x32_bf16 v[80:83], a[192:195], a[144:147], 0
    v_exp_f32 v135, v63
    v_mfma_f32_16x16x32_bf16 v[80:83], a[196:199], a[148:151], v[80:83]
    v_exp_f32 v131, v59
    v_mfma_f32_16x16x32_bf16 v[20:23], a[248:251], v[104:107], v[20:23]
    v_exp_f32 v130, v58
    v_mfma_f32_16x16x32_bf16 v[80:83], a[200:203], a[152:155], v[80:83]
    v_exp_f32 v133, v61
    v_mfma_f32_16x16x32_bf16 v[80:83], a[204:207], a[156:159], v[80:83]
    v_cvt_pk_bf16_f32 v108, v128, v129
    v_cvt_pk_bf16_f32 v110, v132, v133
    v_mfma_f32_16x16x32_bf16 v[80:83], a[208:211], a[160:163], v[80:83]
    v_mfma_f32_16x16x32_bf16 v[80:83], a[212:215], a[164:167], v[80:83]
    v_cvt_pk_bf16_f32 v109, v130, v131
    v_cvt_pk_bf16_f32 v111, v134, v135
    v_mfma_f32_16x16x32_bf16 v[88:91], a[192:195], a[168:171], 0
    s_waitcnt lgkmcnt(2)
    buffer_load_dwordx4 v10, s[12:15], s59 offen nt lds
    v_mfma_f32_16x16x32_bf16 v[20:23], a[252:255], v[108:111], v[20:23]
    s_add_u32 m0, s38, 23552
    v_mfma_f32_16x16x32_bf16 v[88:91], a[196:199], a[172:175], v[88:91]
    buffer_load_dwordx4 v11, s[12:15], s59 offen nt lds
    v_mfma_f32_16x16x32_bf16 v[88:91], a[200:203], a[176:179], v[88:91]
    buffer_store_dwordx4 v[136:139], v12, s[16:19], s57 offen offset:0 sc0 sc1 nt
    s_nop 2
    v_cmp_lt_f32 vcc, s29, v20
    s_waitcnt vmcnt(13) lgkmcnt(0)
    v_mfma_f32_16x16x32_bf16 v[88:91], a[204:207], a[180:183], v[88:91]
    v_mfma_f32_16x16x32_bf16 v[88:91], a[208:211], a[184:187], v[88:91]
    s_barrier
    v_mfma_f32_16x16x32_bf16 v[88:91], a[212:215], a[188:191], v[88:91]
    ds_read_b64_tr_b16 a[192:193], v3 offset:0
    v_mfma_f32_16x16x32_bf16 v[68:71], a[216:219], a[96:99], 0
    s_cbranch_vccnz L_rs_tr44a
L_ret_tr44a:
    s_add_u32 m0, s22, 12288
    v_mfma_f32_16x16x32_bf16 v[68:71], a[220:223], a[100:103], v[68:71]
    v_fma_f32 v66, v66, s28, v16
    v_fma_f32 v67, v67, s28, v16
    v_mfma_f32_16x16x32_bf16 v[68:71], a[224:227], a[104:107], v[68:71]
    ds_read_b64_tr_b16 a[194:195], v3 offset:6144
    v_mfma_f32_16x16x32_bf16 v[68:71], a[228:231], a[108:111], v[68:71]
    v_exp_f32 v130, v66
    v_mfma_f32_16x16x32_bf16 v[68:71], a[232:235], a[112:115], v[68:71]
    ds_read_b64_tr_b16 a[196:197], v4 offset:0
    v_fma_f32 v73, v73, s28, v17
    v_mfma_f32_16x16x32_bf16 v[68:71], a[236:239], a[116:119], v[68:71]
    v_exp_f32 v133, v73
    v_mfma_f32_16x16x32_bf16 v[76:79], a[216:219], a[120:123], 0
    buffer_load_dwordx4 v9, s[4:7], s20 offen lds
    v_mfma_f32_16x16x32_bf16 v[76:79], a[220:223], a[124:127], v[76:79]
    v_fma_f32 v64, v64, s28, v16
    v_fma_f32 v72, v72, s28, v17
    v_mfma_f32_16x16x32_bf16 v[76:79], a[224:227], a[128:131], v[76:79]
    ds_read_b64_tr_b16 a[198:199], v4 offset:6144
    v_mfma_f32_16x16x32_bf16 v[76:79], a[228:231], a[132:135], v[76:79]
    ds_read_b64_tr_b16 a[200:201], v5 offset:0
    v_fma_f32 v65, v65, s28, v16
    v_mfma_f32_16x16x32_bf16 v[76:79], a[232:235], a[136:139], v[76:79]
    v_exp_f32 v128, v64
    v_mfma_f32_16x16x32_bf16 v[76:79], a[236:239], a[140:143], v[76:79]
    buffer_store_dwordx4 v[140:143], v12, s[16:19], s57 offen offset:3072 sc0 sc1 nt
    v_exp_f32 v129, v65
    s_add_u32 s20, s20, 128
    v_mfma_f32_16x16x32_bf16 v[84:87], a[216:219], a[144:147], 0
    ds_read_b64_tr_b16 a[202:203], v5 offset:6144
    v_mfma_f32_16x16x32_bf16 v[84:87], a[220:223], a[148:151], v[84:87]
    s_add_u32 m0, s22, 13312
    ds_read_b64_tr_b16 a[204:205], v6 offset:0
    v_cvt_pk_bf16_f32 v112, v128, v129
    v_mfma_f32_16x16x32_bf16 v[84:87], a[224:227], a[152:155], v[84:87]
    buffer_load_dwordx4 v9, s[4:7], s20 offen lds
    v_mfma_f32_16x16x32_bf16 v[84:87], a[228:231], a[156:159], v[84:87]
    v_exp_f32 v131, v67
    v_mfma_f32_16x16x32_bf16 v[84:87], a[232:235], a[160:163], v[84:87]
    ds_read_b64_tr_b16 a[206:207], v6 offset:6144
    v_mfma_f32_16x16x32_bf16 v[84:87], a[236:239], a[164:167], v[84:87]
    s_add_u32 s20, s20, 128
    ds_read_b64_tr_b16 a[208:209], v3 offset:1024
    v_mfma_f32_16x16x32_bf16 v[92:95], a[216:219], a[168:171], 0
    s_add_u32 m0, s22, 14336
    v_cvt_pk_bf16_f32 v113, v130, v131
    v_mfma_f32_16x16x32_bf16 v[92:95], a[220:223], a[172:175], v[92:95]
    v_exp_f32 v132, v72
    v_mfma_f32_16x16x32_bf16 v[92:95], a[224:227], a[176:179], v[92:95]
    buffer_load_dwordx4 v9, s[4:7], s20 offen lds
    v_mfma_f32_16x16x32_bf16 v[92:95], a[228:231], a[180:183], v[92:95]
    ds_read_b64_tr_b16 a[210:211], v3 offset:7168
    v_mfma_f32_16x16x32_bf16 v[92:95], a[232:235], a[184:187], v[92:95]
    ds_read_b64_tr_b16 a[212:213], v4 offset:1024
    v_cvt_pk_bf16_f32 v116, v132, v133
    v_mfma_f32_16x16x32_bf16 v[92:95], a[236:239], a[188:191], v[92:95]
    s_add_u32 s20, s20, 12032
    ds_read_b64_tr_b16 a[214:215], v4 offset:7168
    s_waitcnt lgkmcnt(10)
    v_mfma_f32_16x16x32_bf16 v[160:163], a[192:195], v[96:99], v[160:163]
    ds_read_b64_tr_b16 a[224:225], v3 offset:2048
    v_fma_f32 v71, v71, s28, v16
    v_mfma_f32_16x16x32_bf16 v[208:211], a[192:195], v[100:103], v[208:211]
    ds_read_b64_tr_b16 a[230:231], v4 offset:8192
    v_xor_b32 v8, 64, v7
    v_mfma_f32_16x16x32_bf16 a[0:3], a[192:195], v[104:107], a[0:3]
    ds_read_b64_tr_b16 a[220:221], v6 offset:1024
    v_fma_f32 v76, v76, s28, v17
    v_mfma_f32_16x16x32_bf16 a[48:51], a[192:195], v[108:111], a[48:51]
    ds_read_b128 a[108:111], v8 offset:2048
    s_waitcnt lgkmcnt(12)
    v_mfma_f32_16x16x32_bf16 v[164:167], a[196:199], v[96:99], v[164:167]
    ds_read_b64_tr_b16 a[216:217], v5 offset:1024
    v_fma_f32 v70, v70, s28, v16
    v_mfma_f32_16x16x32_bf16 v[212:215], a[196:199], v[100:103], v[212:215]
    ds_read_b128 a[144:147], v7 offset:12288
    v_exp_f32 v132, v76
    v_mfma_f32_16x16x32_bf16 a[4:7], a[196:199], v[104:107], a[4:7]
    ds_read_b64_tr_b16 a[226:227], v3 offset:8192
    v_fma_f32 v95, v95, s28, v19
    v_mfma_f32_16x16x32_bf16 a[52:55], a[196:199], v[108:111], a[52:55]
    s_waitcnt lgkmcnt(13)
    ds_read_b64_tr_b16 a[232:233], v5 offset:2048
    v_fma_f32 v85, v85, s28, v18
    v_mfma_f32_16x16x32_bf16 v[168:171], a[200:203], v[96:99], v[168:171]
    ds_read_b64_tr_b16 a[234:235], v5 offset:8192
    v_exp_f32 v129, v71
    v_mfma_f32_16x16x32_bf16 v[216:219], a[200:203], v[100:103], v[216:219]
    ds_read_b128 a[124:127], v8 offset:6144
    v_fma_f32 v68, v68, s28, v16
    v_mfma_f32_16x16x32_bf16 a[8:11], a[200:203], v[104:107], a[8:11]
    ds_read_b128 a[132:135], v8 offset:8192
    v_fma_f32 v88, v88, s28, v19
    v_mfma_f32_16x16x32_bf16 a[56:59], a[200:203], v[108:111], a[56:59]
    s_waitcnt lgkmcnt(9)
    ds_read_b64_tr_b16 a[222:223], v6 offset:7168
    v_fma_f32 v69, v69, s28, v16
    v_mfma_f32_16x16x32_bf16 v[172:175], a[204:207], v[96:99], v[172:175]
    ds_read_b64_tr_b16 a[228:229], v4 offset:2048
    v_fma_f32 v75, v75, s28, v17
    v_mfma_f32_16x16x32_bf16 v[220:223], a[204:207], v[100:103], v[220:223]
    ds_read_b64_tr_b16 a[238:239], v6 offset:8192
    v_fma_f32 v77, v77, s28, v17
    v_mfma_f32_16x16x32_bf16 a[12:15], a[204:207], v[104:107], a[12:15]
    ds_read_b64_tr_b16 a[218:219], v5 offset:7168
    v_fma_f32 v74, v74, s28, v17
    v_mfma_f32_16x16x32_bf16 a[60:63], a[204:207], v[108:111], a[60:63]
    v_exp_f32 v128, v70
    v_mfma_f32_16x16x32_bf16 v[176:179], a[208:211], v[96:99], v[176:179]
    ds_read_b64_tr_b16 a[236:237], v6 offset:2048
    v_exp_f32 v134, v68
    v_mfma_f32_16x16x32_bf16 v[224:227], a[208:211], v[100:103], v[224:227]
    v_exp_f32 v133, v77
    v_mfma_f32_16x16x32_bf16 a[16:19], a[208:211], v[104:107], a[16:19]
    ds_read_b128 a[112:115], v7 offset:4096
    v_fma_f32 v84, v84, s28, v18
    v_mfma_f32_16x16x32_bf16 a[64:67], a[208:211], v[108:111], a[64:67]
    v_exp_f32 v135, v69
    v_mfma_f32_16x16x32_bf16 v[180:183], a[212:215], v[96:99], v[180:183]
    ds_read_b128 a[104:107], v7 offset:2048
    v_cvt_pk_bf16_f32 v115, v128, v129
    v_mfma_f32_16x16x32_bf16 v[228:231], a[212:215], v[100:103], v[228:231]
    ds_read_b128 a[140:143], v8 offset:10240
    v_cvt_pk_bf16_f32 v114, v134, v135
    v_mfma_f32_16x16x32_bf16 a[20:23], a[212:215], v[104:107], a[20:23]
    ds_read_b128 a[100:103], v8 offset:0
    v_fma_f32 v78, v78, s28, v17
    v_mfma_f32_16x16x32_bf16 v[24:27], a[240:243], v[112:115], v[20:23]
    ds_read_b128 a[148:151], v8 offset:12288
    v_fma_f32 v89, v89, s28, v19
    v_mfma_f32_16x16x32_bf16 a[68:71], a[212:215], v[108:111], a[68:71]
    s_waitcnt lgkmcnt(6)
    ds_read_b128 a[152:155], v7 offset:14336
    v_cvt_pk_bf16_f32 v118, v132, v133
    v_mfma_f32_16x16x32_bf16 v[184:187], a[216:219], v[96:99], v[184:187]
    ds_read_b128 a[96:99], v7 offset:0
    v_fma_f32 v93, v93, s28, v19
    v_mfma_f32_16x16x32_bf16 v[232:235], a[216:219], v[100:103], v[232:235]
    s_waitcnt vmcnt(14) lgkmcnt(7)
    ds_read_b128 a[156:159], v8 offset:14336
    v_fma_f32 v81, v81, s28, v18
    v_mfma_f32_16x16x32_bf16 a[24:27], a[216:219], v[104:107], a[24:27]
    v_exp_f32 v131, v75
    v_mfma_f32_16x16x32_bf16 a[72:75], a[216:219], v[108:111], a[72:75]
    s_barrier
    v_mfma_f32_16x16x32_bf16 v[188:191], a[220:223], v[96:99], v[188:191]
    s_add_u32 m0, s22, 24576
    ds_read_b128 a[192:195], v1 offset:0
    v_mfma_f32_16x16x32_bf16 v[236:239], a[220:223], v[100:103], v[236:239]
    v_exp_f32 v132, v84
    v_mfma_f32_16x16x32_bf16 a[28:31], a[220:223], v[104:107], a[28:31]
    ds_read_b128 a[216:219], v1 offset:6144
    buffer_load_dwordx4 v9, s[8:11], s21 offen lds
    v_mfma_f32_16x16x32_bf16 a[76:79], a[220:223], v[108:111], a[76:79]
    v_exp_f32 v134, v78
    v_mfma_f32_16x16x32_bf16 v[192:195], a[224:227], v[96:99], v[192:195]
    ds_read_b128 a[204:207], v2 offset:1024
    v_fma_f32 v83, v83, s28, v18
    v_mfma_f32_16x16x32_bf16 v[240:243], a[224:227], v[100:103], v[240:243]
    ds_read_b128 a[208:211], v1 offset:2048
    v_mfma_f32_16x16x32_bf16 a[32:35], a[224:227], v[104:107], a[32:35]
    s_add_u32 s21, s21, 128
    s_add_u32 m0, s22, 25600
    ds_read_b128 a[136:139], v7 offset:10240
    v_mfma_f32_16x16x32_bf16 a[80:83], a[224:227], v[108:111], a[80:83]
    v_exp_f32 v130, v74
    v_mfma_f32_16x16x32_bf16 v[196:199], a[228:231], v[96:99], v[196:199]
    buffer_load_dwordx4 v9, s[8:11], s21 offen lds
    v_mfma_f32_16x16x32_bf16 v[244:247], a[228:231], v[100:103], v[244:247]
    ds_read_b128 a[200:203], v1 offset:1024
    v_fma_f32 v86, v86, s28, v18
    v_mfma_f32_16x16x32_bf16 a[36:39], a[228:231], v[104:107], a[36:39]
    s_add_u32 s21, s21, 128
    ds_read_b128 a[116:119], v8 offset:4096
    v_mfma_f32_16x16x32_bf16 a[84:87], a[228:231], v[108:111], a[84:87]
    s_add_u32 m0, s22, 26624
    ds_read_b128 a[196:199], v2 offset:0
    v_mfma_f32_16x16x32_bf16 v[200:203], a[232:235], v[96:99], v[200:203]
    ds_read_b128 a[160:163], v7 offset:16384
    v_fma_f32 v79, v79, s28, v17
    v_mfma_f32_16x16x32_bf16 v[248:251], a[232:235], v[100:103], v[248:251]
    buffer_load_dwordx4 v9, s[8:11], s21 offen lds
    v_mfma_f32_16x16x32_bf16 a[40:43], a[232:235], v[104:107], a[40:43]
    s_add_u32 s21, s21, 12032
    ds_read_b128 a[212:215], v2 offset:2048
    v_cvt_pk_bf16_f32 v117, v130, v131
    v_mfma_f32_16x16x32_bf16 a[88:91], a[232:235], v[108:111], a[88:91]
    v_exp_f32 v135, v79
    v_mfma_f32_16x16x32_bf16 v[204:207], a[236:239], v[96:99], v[204:207]
    ds_read_b128 a[120:123], v7 offset:6144
    v_fma_f32 v94, v94, s28, v19
    v_mfma_f32_16x16x32_bf16 v[252:255], a[236:239], v[100:103], v[252:255]
    ds_read_b128 a[220:223], v2 offset:6144
    v_cvt_pk_bf16_f32 v119, v134, v135
    v_mfma_f32_16x16x32_bf16 a[44:47], a[236:239], v[104:107], a[44:47]
    s_waitcnt vmcnt(8)
    ds_read_b128 a[128:131], v7 offset:8192
    v_fma_f32 v90, v90, s28, v19
    v_mfma_f32_16x16x32_bf16 a[92:95], a[236:239], v[108:111], a[92:95]
    s_waitcnt lgkmcnt(7)
    ds_read_b128 a[180:183], v8 offset:20480
    v_fma_f32 v92, v92, s28, v19
    v_mfma_f32_16x16x32_bf16 v[32:35], a[192:195], a[96:99], 0
    v_exp_f32 v131, v83
    v_mfma_f32_16x16x32_bf16 v[24:27], a[244:247], v[116:119], v[24:27]
    s_waitcnt lgkmcnt(6)
    v_exp_f32 v133, v85
    v_mfma_f32_16x16x32_bf16 v[32:35], a[196:199], a[100:103], v[32:35]
    ds_read_b128 a[172:175], v8 offset:18432
    v_fma_f32 v91, v91, s28, v19
    v_mfma_f32_16x16x32_bf16 v[32:35], a[200:203], a[104:107], v[32:35]
    ds_read_b128 a[168:171], v7 offset:18432
    v_mfma_f32_16x16x32_bf16 v[32:35], a[204:207], a[108:111], v[32:35]
    ds_read_b128 a[228:231], v2 offset:7168
    v_fma_f32 v82, v82, s28, v18
    v_mfma_f32_16x16x32_bf16 v[32:35], a[208:211], a[112:115], v[32:35]
    s_waitcnt lgkmcnt(7)
    ds_read_b128 a[236:239], v2 offset:8192
    v_mfma_f32_16x16x32_bf16 v[32:35], a[212:215], a[116:119], v[32:35]
    s_waitcnt lgkmcnt(7)
    ds_read_b128 a[164:167], v8 offset:16384
    v_mfma_f32_16x16x32_bf16 v[40:43], a[192:195], a[120:123], 0
    ds_read_b128 a[176:179], v7 offset:20480
    v_mfma_f32_16x16x32_bf16 v[40:43], a[196:199], a[124:127], v[40:43]
    s_waitcnt lgkmcnt(7)
    ds_read_b128 a[184:187], v7 offset:22528
    v_mfma_f32_16x16x32_bf16 v[40:43], a[200:203], a[128:131], v[40:43]
    ds_read_b128 a[224:227], v1 offset:7168
    v_fma_f32 v80, v80, s28, v18
    v_mfma_f32_16x16x32_bf16 v[40:43], a[204:207], a[132:135], v[40:43]
    v_exp_f32 v129, v81
    v_mfma_f32_16x16x32_bf16 v[40:43], a[208:211], a[136:139], v[40:43]
    ds_read_b128 a[232:235], v1 offset:8192
    v_cvt_pk_bf16_f32 v122, v132, v133
    v_mfma_f32_16x16x32_bf16 v[40:43], a[212:215], a[140:143], v[40:43]
    ds_read_b128 a[188:191], v8 offset:22528
    v_mfma_f32_16x16x32_bf16 v[48:51], a[192:195], a[144:147], 0
    v_exp_f32 v128, v80
    v_mfma_f32_16x16x32_bf16 v[48:51], a[196:199], a[148:151], v[48:51]
    v_exp_f32 v130, v82
    v_mfma_f32_16x16x32_bf16 v[48:51], a[200:203], a[152:155], v[48:51]
    v_fma_f32 v87, v87, s28, v18
    v_mfma_f32_16x16x32_bf16 v[48:51], a[204:207], a[156:159], v[48:51]
    v_exp_f32 v134, v86
    v_mfma_f32_16x16x32_bf16 v[48:51], a[208:211], a[160:163], v[48:51]
    s_waitcnt lgkmcnt(4)
    v_cvt_pk_bf16_f32 v121, v130, v131
    v_mfma_f32_16x16x32_bf16 v[48:51], a[212:215], a[164:167], v[48:51]
    v_cvt_pk_bf16_f32 v120, v128, v129
    v_mfma_f32_16x16x32_bf16 v[56:59], a[192:195], a[168:171], 0
    v_exp_f32 v135, v87
    v_mfma_f32_16x16x32_bf16 v[56:59], a[196:199], a[172:175], v[56:59]
    v_cvt_pk_bf16_f32 v123, v134, v135
    v_mfma_f32_16x16x32_bf16 v[56:59], a[200:203], a[176:179], v[56:59]
    s_waitcnt vmcnt(13) lgkmcnt(1)
    v_exp_f32 v133, v93
    v_mfma_f32_16x16x32_bf16 v[56:59], a[204:207], a[180:183], v[56:59]
    v_exp_f32 v132, v92
    v_mfma_f32_16x16x32_bf16 v[24:27], a[248:251], v[120:123], v[24:27]
    v_exp_f32 v135, v95
    v_mfma_f32_16x16x32_bf16 v[56:59], a[208:211], a[184:187], v[56:59]
    s_waitcnt lgkmcnt(0)
    v_exp_f32 v129, v89
    v_mfma_f32_16x16x32_bf16 v[56:59], a[212:215], a[188:191], v[56:59]
    s_barrier
    v_mfma_f32_16x16x32_bf16 v[36:39], a[216:219], a[96:99], 0
    v_exp_f32 v128, v88
    v_mfma_f32_16x16x32_bf16 v[36:39], a[220:223], a[100:103], v[36:39]
    v_cvt_pk_bf16_f32 v126, v132, v133
    v_mfma_f32_16x16x32_bf16 v[36:39], a[224:227], a[104:107], v[36:39]
    v_exp_f32 v130, v90
    v_mfma_f32_16x16x32_bf16 v[36:39], a[228:231], a[108:111], v[36:39]
    ds_read_b64_tr_b16 a[192:193], v3 offset:12288
    s_add_u32 m0, s22, 0
    v_mfma_f32_16x16x32_bf16 v[36:39], a[232:235], a[112:115], v[36:39]
    v_mfma_f32_16x16x32_bf16 v[36:39], a[236:239], a[116:119], v[36:39]
    ds_read_b64_tr_b16 a[194:195], v3 offset:18432
    v_mfma_f32_16x16x32_bf16 v[44:47], a[216:219], a[120:123], 0
    buffer_load_dwordx4 v9, s[4:7], s20 offen lds
    v_mfma_f32_16x16x32_bf16 v[44:47], a[220:223], a[124:127], v[44:47]
    s_add_u32 s20, s20, 128
    ds_read_b64_tr_b16 a[196:197], v4 offset:12288
    s_add_u32 m0, s22, 1024
    v_mfma_f32_16x16x32_bf16 v[44:47], a[224:227], a[128:131], v[44:47]
    buffer_load_dwordx4 v9, s[4:7], s20 offen lds
    v_mfma_f32_16x16x32_bf16 v[44:47], a[228:231], a[132:135], v[44:47]
    s_add_u32 s20, s20, 128
    v_mfma_f32_16x16x32_bf16 v[44:47], a[232:235], a[136:139], v[44:47]
    v_exp_f32 v131, v91
    v_mfma_f32_16x16x32_bf16 v[44:47], a[236:239], a[140:143], v[44:47]
    v_exp_f32 v134, v94
    v_mfma_f32_16x16x32_bf16 v[52:55], a[216:219], a[144:147], 0
    s_add_u32 m0, s22, 2048
    v_cvt_pk_bf16_f32 v124, v128, v129
    v_cvt_pk_bf16_f32 v127, v134, v135
    v_mfma_f32_16x16x32_bf16 v[52:55], a[220:223], a[148:151], v[52:55]
    buffer_load_dwordx4 v9, s[4:7], s20 offen lds
    v_mfma_f32_16x16x32_bf16 v[52:55], a[224:227], a[152:155], v[52:55]
    ds_read_b64_tr_b16 a[198:199], v4 offset:18432
    v_mfma_f32_16x16x32_bf16 v[52:55], a[228:231], a[156:159], v[52:55]
    ds_read_b64_tr_b16 a[200:201], v5 offset:12288
    v_cvt_pk_bf16_f32 v125, v130, v131
    v_mfma_f32_16x16x32_bf16 v[52:55], a[232:235], a[160:163], v[52:55]
    ds_read_b64_tr_b16 a[202:203], v5 offset:18432
    v_mfma_f32_16x16x32_bf16 v[24:27], a[252:255], v[124:127], v[24:27]
    ds_read_b64_tr_b16 a[204:205], v6 offset:12288
    v_mfma_f32_16x16x32_bf16 v[52:55], a[236:239], a[164:167], v[52:55]
    ds_read_b64_tr_b16 a[206:207], v6 offset:18432
    v_mfma_f32_16x16x32_bf16 v[60:63], a[216:219], a[168:171], 0
    ds_read_b64_tr_b16 a[208:209], v3 offset:13312
    v_mfma_f32_16x16x32_bf16 v[60:63], a[220:223], a[172:175], v[60:63]
    s_add_u32 s20, s20, 12032
    v_mfma_f32_16x16x32_bf16 v[60:63], a[224:227], a[176:179], v[60:63]
    ds_read_b64_tr_b16 a[210:211], v3 offset:19456
    v_cmp_lt_f32 vcc, s29, v24
    v_mfma_f32_16x16x32_bf16 v[60:63], a[228:231], a[180:183], v[60:63]
    ds_read_b64_tr_b16 a[212:213], v4 offset:13312
    v_mfma_f32_16x16x32_bf16 v[60:63], a[232:235], a[184:187], v[60:63]
    ds_read_b64_tr_b16 a[214:215], v4 offset:19456
    v_mfma_f32_16x16x32_bf16 v[60:63], a[236:239], a[188:191], v[60:63]
    s_cbranch_vccnz L_rs_tr44b
L_ret_tr44b:
    v_max3_f32 v28, v32, v33, v34
    s_waitcnt lgkmcnt(10)
    v_mfma_f32_16x16x32_bf16 v[160:163], a[192:195], v[112:115], v[160:163]
    s_add_u32 s24, s34, 128
    ds_read_b64_tr_b16 a[218:219], v5 offset:19456
    v_max3_f32 v30, v40, v41, v42
    v_rcp_f32 v154, v25
    v_mfma_f32_16x16x32_bf16 v[208:211], a[192:195], v[116:119], v[208:211]
    ds_read_b64_tr_b16 a[222:223], v6 offset:19456
    v_max3_f32 v28, v28, v35, v36
    v_mfma_f32_16x16x32_bf16 a[0:3], a[192:195], v[120:123], a[0:3]
    v_max3_f32 v30, v30, v43, v44
    v_max3_f32 v28, v28, v37, v38
    v_mfma_f32_16x16x32_bf16 a[48:51], a[192:195], v[124:127], a[48:51]
    s_waitcnt lgkmcnt(10)
    ds_read_b64_tr_b16 a[226:227], v3 offset:20480
    v_max3_f32 v30, v30, v45, v46
    v_mfma_f32_16x16x32_bf16 v[164:167], a[196:199], v[112:115], v[164:167]
    s_add_u32 s18, s34, 24576
    v_mov_b32 v153, v24
    v_max_f32 v28, v28, v39
    v_mfma_f32_16x16x32_bf16 v[212:215], a[196:199], v[116:119], v[212:215]
    s_mov_b32 s34, s33
    ds_read_b64_tr_b16 a[220:221], v6 offset:13312
    v_max_f32 v30, v30, v47
    v_mfma_f32_16x16x32_bf16 a[4:7], a[196:199], v[120:123], a[4:7]
    v_mov_b32 v29, v28
    v_mov_b32 v31, v30
    v_mfma_f32_16x16x32_bf16 a[52:55], a[196:199], v[124:127], a[52:55]
    s_waitcnt lgkmcnt(8)
    v_permlane32_swap_b32 v29, v28
    v_mfma_f32_16x16x32_bf16 v[168:171], a[200:203], v[112:115], v[168:171]
    s_add_u32 s37, s37, 1
    v_permlane32_swap_b32 v31, v30
    v_max_f32 v30, v30, v31
    v_max_f32 v28, v28, v29
    v_mfma_f32_16x16x32_bf16 v[216:219], a[200:203], v[116:119], v[216:219]
    s_add_u32 s35, s35, 325632
    v_mov_b32 v29, v28
    v_mov_b32 v31, v30
    v_mfma_f32_16x16x32_bf16 a[8:11], a[200:203], v[120:123], a[8:11]
    s_lshl_b32 s42, s37, 1
    v_mov_b32 v152, v24
    v_xor_b32 v8, 96, v14
    v_mfma_f32_16x16x32_bf16 a[56:59], a[200:203], v[124:127], a[56:59]
    s_lshr_b32 s42, s31, s42
    ds_read_b64_tr_b16 a[216:217], v5 offset:13312
    v_permlane16_swap_b32 v29, v28
    v_max_f32 v28, v28, v29
    v_mfma_f32_16x16x32_bf16 v[172:175], a[204:207], v[112:115], v[172:175]
    s_xor_b32 s42, s42, s36
    ds_read_b64_tr_b16 a[224:225], v3 offset:14336
    s_and_b32 s42, s42, 3
    v_mfma_f32_16x16x32_bf16 v[220:223], a[204:207], v[116:119], v[220:223]
    s_mul_i32 s43, s3, 3
    ds_read_b64_tr_b16 a[230:231], v4 offset:20480
    v_permlane16_swap_b32 v31, v30
    v_mul_f32_e64 v16, -s28, v28
    v_mfma_f32_16x16x32_bf16 a[12:15], a[204:207], v[120:123], a[12:15]
    s_lshl_b32 s44, s3, 2
    ds_read_b64_tr_b16 a[228:229], v4 offset:14336
    v_max_f32 v30, v30, v31
    v_mfma_f32_16x16x32_bf16 a[60:63], a[204:207], v[124:127], a[60:63]
    s_waitcnt lgkmcnt(4)
    v_mul_f32_e64 v17, -s28, v30
    v_max3_f32 v30, v56, v57, v58
    v_mfma_f32_16x16x32_bf16 v[176:179], a[208:211], v[112:115], v[176:179]
    s_mov_b32 s32, 1
    ds_read_b64_tr_b16 a[234:235], v5 offset:20480
    v_max3_f32 v28, v48, v49, v50
    v_fma_f32 v35, v35, s28, v16
    v_mfma_f32_16x16x32_bf16 v[224:227], a[208:211], v[116:119], v[224:227]
    s_add_u32 s45, s43, 17
    v_max3_f32 v30, v30, v59, v60
    v_accvgpr_read_b32 v149, a49
    v_mfma_f32_16x16x32_bf16 a[16:19], a[208:211], v[120:123], a[16:19]
    s_cmp_eq_u32 s3, 0
    ds_read_b64_tr_b16 a[236:237], v6 offset:14336
    v_fma_f32 v34, v34, s28, v16
    v_mfma_f32_16x16x32_bf16 a[64:67], a[208:211], v[124:127], a[64:67]
    s_cselect_b32 s45, 16, s45
    v_max3_f32 v30, v30, v61, v62
    v_fma_f32 v43, v43, s28, v17
    v_mfma_f32_16x16x32_bf16 v[180:183], a[212:215], v[112:115], v[180:183]
    s_cselect_b32 s33, 1, 0
    ds_read_b64_tr_b16 a[238:239], v6 offset:20480
    v_fma_f32 v38, v38, s28, v16
    v_mfma_f32_16x16x32_bf16 v[228:231], a[212:215], v[116:119], v[228:231]
    s_cmp_eq_u32 s42, 1
    v_accvgpr_read_b32 v145, a1
    v_fma_f32 v45, v45, s28, v17
    v_mfma_f32_16x16x32_bf16 a[20:23], a[212:215], v[120:123], a[20:23]
    s_cselect_b32 s44, s45, s44
    v_rcp_f32 v156, v26
    v_mfma_f32_16x16x32_bf16 a[68:71], a[212:215], v[124:127], a[68:71]
    s_cselect_b32 s32, s33, s32
    v_max_f32 v30, v30, v63
    s_waitcnt lgkmcnt(3)
    v_mfma_f32_16x16x32_bf16 v[184:187], a[216:219], v[112:115], v[184:187]
    s_add_u32 s45, s43, 29
    v_accvgpr_read_b32 v148, a48
    v_max3_f32 v28, v28, v51, v52
    v_mfma_f32_16x16x32_bf16 v[232:235], a[216:219], v[116:119], v[232:235]
    s_cmp_eq_u32 s42, 2
    v_mov_b32 v31, v30
    v_max3_f32 v28, v28, v53, v54
    v_mfma_f32_16x16x32_bf16 a[24:27], a[216:219], v[120:123], a[24:27]
    s_cselect_b32 s44, s45, s44
    ds_read_b64_tr_b16 a[232:233], v5 offset:14336
    v_fma_f32 v33, v33, s28, v16
    v_mfma_f32_16x16x32_bf16 a[72:75], a[216:219], v[124:127], a[72:75]
    s_cselect_b32 s32, 0, s32
    v_permlane16_swap_b32 v152, v153
    v_mfma_f32_16x16x32_bf16 v[188:191], a[220:223], v[112:115], v[188:191]
    s_add_u32 s45, s43, 41
    v_rcp_f32 v158, v27
    v_rcp_f32 v152, v152
    v_max_f32 v28, v28, v55
    v_pk_mul_f32 v[166:167], v[166:167], v[152:153] op_sel_hi:[1,0]
    v_pk_mul_f32 v[162:163], v[162:163], v[152:153] op_sel_hi:[1,0]
    v_fma_f32 v32, v32, s28, v16
    v_fma_f32 v44, v44, s28, v17
    v_permlane32_swap_b32 v31, v30
    v_mfma_f32_16x16x32_bf16 v[236:239], a[220:223], v[116:119], v[236:239]
    s_cmp_eq_u32 s42, 3
    v_mov_b32 v29, v28
    v_fma_f32 v46, v46, s28, v17
    v_mfma_f32_16x16x32_bf16 a[28:31], a[220:223], v[120:123], a[28:31]
    s_cselect_b32 s44, s45, s44
    v_exp_f32 v128, v32
    v_mfma_f32_16x16x32_bf16 a[76:79], a[220:223], v[124:127], a[76:79]
    s_cselect_b32 s32, 0, s32
    s_mul_i32 s44, s44, 6144
    v_permlane32_swap_b32 v29, v28
    v_mfma_f32_16x16x32_bf16 v[192:195], a[224:227], v[112:115], v[192:195]
    s_add_u32 s33, s35, s44
    v_fma_f32 v36, v36, s28, v16
    v_max_f32 v30, v30, v31
    v_mfma_f32_16x16x32_bf16 v[240:243], a[224:227], v[116:119], v[240:243]
    s_mul_i32 s42, s32, 6144
    v_fma_f32 v42, v42, s28, v17
    v_fma_f32 v40, v40, s28, v17
    v_mfma_f32_16x16x32_bf16 a[32:35], a[224:227], v[120:123], a[32:35]
    s_add_u32 s42, s42, 18432
    v_accvgpr_read_b32 v147, a3
    v_mov_b32 v31, v30
    v_max_f32 v28, v28, v29
    v_mfma_f32_16x16x32_bf16 a[80:83], a[224:227], v[124:127], a[80:83]
    s_add_u32 s42, s42, s33
    v_exp_f32 v130, v34
    v_mfma_f32_16x16x32_bf16 v[196:199], a[228:231], v[112:115], v[196:199]
    s_cmp_ge_u32 s37, 8
    v_exp_f32 v131, v35
    v_mfma_f32_16x16x32_bf16 v[244:247], a[228:231], v[116:119], v[244:247]
    s_cselect_b32 s14, 0, s42
    v_mov_b32 v29, v28
    v_exp_f32 v134, v36
    v_mfma_f32_16x16x32_bf16 a[36:39], a[228:231], v[120:123], a[36:39]
    s_add_u32 s25, s33, 128
    s_add_u32 s23, s38, 2048
    v_permlane16_swap_b32 v29, v28
    v_fma_f32 v39, v39, s28, v16
    v_mfma_f32_16x16x32_bf16 a[84:87], a[228:231], v[124:127], a[84:87]
    s_mov_b32 s30, 0
    v_subrev_u32 v13, 20480, v13
    s_waitcnt vmcnt(6) lgkmcnt(0)
    v_mfma_f32_16x16x32_bf16 v[200:203], a[232:235], v[112:115], v[200:203]
    s_barrier
    ds_read_b128 a[196:199], v2 offset:12288
    v_mfma_f32_16x16x32_bf16 v[248:251], a[232:235], v[116:119], v[248:251]
    ds_read_b128 a[192:195], v1 offset:12288
    v_permlane16_swap_b32 v31, v30
    v_mfma_f32_16x16x32_bf16 a[40:43], a[232:235], v[120:123], a[40:43]
    ds_read_b128 a[204:207], v2 offset:13312
    v_max_f32 v30, v30, v31
    v_mfma_f32_16x16x32_bf16 a[88:91], a[232:235], v[124:127], a[88:91]
    ds_read_b128 a[208:211], v1 offset:14336
    v_fma_f32 v41, v41, s28, v17
    v_mfma_f32_16x16x32_bf16 v[204:207], a[236:239], v[112:115], v[204:207]
    s_add_u32 m0, s22, 36864
    ds_read_b128 a[200:203], v1 offset:13312
    v_mul_f32_e64 v19, -s28, v30
    v_cvt_pk_bf16_f32 v97, v130, v131
    v_exp_f32 v130, v42
    v_exp_f32 v129, v33
    v_mfma_f32_16x16x32_bf16 v[252:255], a[236:239], v[116:119], v[252:255]
    ds_read_b128 a[212:215], v2 offset:14336
    v_fma_f32 v57, v57, s28, v19
    v_exp_f32 v131, v43
    v_max_f32 v28, v28, v29
    v_pk_mul_f32 v[212:213], v[212:213], v[154:155] op_sel_hi:[1,0]
    v_cvt_pk_bf16_f32 v96, v128, v129
    v_pk_mul_f32 v[170:171], v[170:171], v[152:153] op_sel_hi:[1,0]
    v_pk_mul_f32 v[216:217], v[216:217], v[154:155] op_sel_hi:[1,0]
    v_exp_f32 v132, v40
    v_exp_f32 v133, v41
    v_mfma_f32_16x16x32_bf16 a[44:47], a[236:239], v[120:123], a[44:47]
    v_mul_f32_e64 v18, -s28, v28
    v_fma_f32 v55, v55, s28, v18
    v_cvt_pk_bf16_f32 v100, v132, v133
    v_mfma_f32_16x16x32_bf16 a[92:95], a[236:239], v[124:127], a[92:95]
    s_waitcnt lgkmcnt(4)
    ds_read_b128 a[220:223], v2 offset:18432
    buffer_load_dwordx4 v9, s[8:11], s21 offen lds
    v_mfma_f32_16x16x32_bf16 v[64:67], a[192:195], a[96:99], 0
    v_fma_f32 v47, v47, s28, v17
    v_fma_f32 v58, v58, s28, v19
    v_fma_f32 v37, v37, s28, v16
    v_mfma_f32_16x16x32_bf16 v[64:67], a[196:199], a[100:103], v[64:67]
    s_waitcnt lgkmcnt(2)
    v_exp_f32 v128, v38
    v_mfma_f32_16x16x32_bf16 v[64:67], a[200:203], a[104:107], v[64:67]
    v_cvt_pk_bf16_f32 v101, v130, v131
    v_fma_f32 v48, v48, s28, v18
    v_exp_f32 v135, v37
    v_mfma_f32_16x16x32_bf16 v[64:67], a[204:207], a[108:111], v[64:67]
    s_add_u32 s21, s21, 128
    v_cvt_pk_bf16_f32 v98, v134, v135
    v_accvgpr_read_b32 v151, a51
    v_mfma_f32_16x16x32_bf16 v[64:67], a[208:211], a[112:115], v[64:67]
    s_waitcnt lgkmcnt(1)
    v_accvgpr_read_b32 v150, a50
    v_accvgpr_read_b32 v146, a2
    v_mfma_f32_16x16x32_bf16 v[64:67], a[212:215], a[116:119], v[64:67]
    v_exp_f32 v134, v46
    v_mfma_f32_16x16x32_bf16 v[72:75], a[192:195], a[120:123], 0
    ds_read_b128 a[216:219], v1 offset:18432
    v_exp_f32 v133, v45
    v_mfma_f32_16x16x32_bf16 v[72:75], a[196:199], a[124:127], v[72:75]
    s_add_u32 m0, s22, 37888
    v_fma_f32 v51, v51, s28, v18
    v_accvgpr_read_b32 v144, a0
    v_mfma_f32_16x16x32_bf16 v[72:75], a[200:203], a[128:131], v[72:75]
    v_fma_f32 v64, v64, s28, v16
    v_fma_f32 v53, v53, s28, v18
    v_mfma_f32_16x16x32_bf16 v[72:75], a[204:207], a[132:135], v[72:75]
    buffer_load_dwordx4 v9, s[8:11], s21 offen lds
    v_fma_f32 v52, v52, s28, v18
    v_mfma_f32_16x16x32_bf16 v[72:75], a[208:211], a[136:139], v[72:75]
    v_exp_f32 v129, v39
    v_mfma_f32_16x16x32_bf16 v[72:75], a[212:215], a[140:143], v[72:75]
    v_exp_f32 v132, v44
    v_mfma_f32_16x16x32_bf16 v[80:83], a[192:195], a[144:147], 0
    v_cvt_pk_bf16_f32 v99, v128, v129
    v_fma_f32 v50, v50, s28, v18
    v_fma_f32 v56, v56, s28, v19
    v_mfma_f32_16x16x32_bf16 v[80:83], a[196:199], a[148:151], v[80:83]
    s_add_u32 s21, s21, 128
    ds_read_b128 a[224:227], v1 offset:19456
    v_fma_f32 v49, v49, s28, v18
    v_mfma_f32_16x16x32_bf16 v[80:83], a[200:203], a[152:155], v[80:83]
    v_exp_f32 v129, v49
    v_mfma_f32_16x16x32_bf16 v[80:83], a[204:207], a[156:159], v[80:83]
    v_xor_b32 v0, 32, v14
    v_cvt_pk_bf16_f32 v216, v216, v217
    v_exp_f32 v135, v47
    v_mfma_f32_16x16x32_bf16 v[80:83], a[208:211], a[160:163], v[80:83]
    ds_read_b128 a[236:239], v2 offset:20480
    v_cvt_pk_bf16_f32 v102, v132, v133
    v_mfma_f32_16x16x32_bf16 v[80:83], a[212:215], a[164:167], v[80:83]
    ds_read_b128 a[228:231], v2 offset:19456
    v_cvt_pk_bf16_f32 v212, v212, v213
    v_mfma_f32_16x16x32_bf16 v[88:91], a[192:195], a[168:171], 0
    ds_read_b128 a[232:235], v1 offset:20480
    v_fma_f32 v59, v59, s28, v19
    v_exp_f32 v131, v51
    v_cvt_pk_bf16_f32 v103, v134, v135
    v_pk_mul_f32 v[208:209], v[208:209], v[154:155] op_sel_hi:[1,0]
    v_pk_mul_f32 v[190:191], v[190:191], v[152:153] op_sel_hi:[1,0]
    v_pk_mul_f32 v[160:161], v[160:161], v[152:153] op_sel_hi:[1,0]
    v_pk_mul_f32 v[148:149], v[148:149], v[158:159] op_sel_hi:[1,0]
    v_pk_mul_f32 v[226:227], v[226:227], v[154:155] op_sel_hi:[1,0]
    v_cvt_pk_bf16_f32 v160, v160, v161
    v_pk_mul_f32 v[146:147], v[146:147], v[156:157] op_sel_hi:[1,0]
    v_pk_mul_f32 v[150:151], v[150:151], v[158:159] op_sel_hi:[1,0]
    v_pk_mul_f32 v[164:165], v[164:165], v[152:153] op_sel_hi:[1,0]
    v_fma_f32 v67, v67, s28, v16
    v_pk_mul_f32 v[220:221], v[220:221], v[154:155] op_sel_hi:[1,0]
    v_cvt_pk_bf16_f32 v161, v162, v163
    v_fma_f32 v60, v60, s28, v19
    v_pk_mul_f32 v[144:145], v[144:145], v[156:157] op_sel_hi:[1,0]
    v_pk_mul_f32 v[248:249], v[248:249], v[154:155] op_sel_hi:[1,0]
    v_pk_mul_f32 v[176:177], v[176:177], v[152:153] op_sel_hi:[1,0]
    v_fma_f32 v54, v54, s28, v18
    v_fma_f32 v62, v62, s28, v19
    v_pk_mul_f32 v[214:215], v[214:215], v[154:155] op_sel_hi:[1,0]
    v_fma_f32 v83, v83, s28, v18
    v_cvt_pk_bf16_f32 v148, v148, v149
    v_mfma_f32_16x16x32_bf16 v[88:91], a[196:199], a[172:175], v[88:91]
    s_add_u32 m0, s22, 38912
    v_exp_f32 v128, v48
    v_mfma_f32_16x16x32_bf16 v[88:91], a[200:203], a[176:179], v[88:91]
    buffer_load_dwordx4 v9, s[8:11], s21 offen lds
    v_mfma_f32_16x16x32_bf16 v[88:91], a[204:207], a[180:183], v[88:91]
    s_add_u32 s21, s21, 12032
    v_exp_f32 v133, v53
    v_cvt_pk_bf16_f32 v104, v128, v129
    v_mfma_f32_16x16x32_bf16 v[88:91], a[208:211], a[184:187], v[88:91]
    v_exp_f32 v130, v50
    v_cvt_pk_bf16_f32 v220, v220, v221
    v_mfma_f32_16x16x32_bf16 v[88:91], a[212:215], a[188:191], v[88:91]
    s_waitcnt lgkmcnt(0)
    v_fma_f32 v75, v75, s28, v17
    v_cvt_pk_bf16_f32 v213, v214, v215
    v_mfma_f32_16x16x32_bf16 v[68:71], a[216:219], a[96:99], 0
    s_waitcnt vmcnt(6)
    v_exp_f32 v128, v56
    v_fma_f32 v65, v65, s28, v16
    v_cvt_pk_bf16_f32 v144, v144, v145
    v_mfma_f32_16x16x32_bf16 v[68:71], a[220:223], a[100:103], v[68:71]
    s_barrier
    v_mfma_f32_16x16x32_bf16 v[68:71], a[224:227], a[104:107], v[68:71]
    ds_read_b64_tr_b16 a[192:193], v3 offset:0
    v_cvt_pk_bf16_f32 v105, v130, v131
    v_mfma_f32_16x16x32_bf16 v[68:71], a[228:231], a[108:111], v[68:71]
    v_exp_f32 v132, v52
    v_mfma_f32_16x16x32_bf16 v[68:71], a[232:235], a[112:115], v[68:71]
    v_exp_f32 v135, v55
    v_mfma_f32_16x16x32_bf16 v[68:71], a[236:239], a[116:119], v[68:71]
    v_cvt_pk_bf16_f32 v164, v164, v165
    v_fma_f32 v73, v73, s28, v17
    v_cvt_pk_bf16_f32 v106, v132, v133
    v_fma_f32 v61, v61, s28, v19
    v_mfma_f32_16x16x32_bf16 v[76:79], a[216:219], a[120:123], 0
    v_fma_f32 v89, v89, s28, v19
    v_fma_f32 v63, v63, s28, v19
    v_exp_f32 v132, v60
    v_mfma_f32_16x16x32_bf16 v[76:79], a[220:223], a[124:127], v[76:79]
    s_add_u32 m0, s22, 12288
    v_exp_f32 v134, v54
    v_mfma_f32_16x16x32_bf16 v[76:79], a[224:227], a[128:131], v[76:79]
    ds_read_b64_tr_b16 a[194:195], v3 offset:6144
    v_exp_f32 v129, v57
    v_mfma_f32_16x16x32_bf16 v[76:79], a[228:231], a[132:135], v[76:79]
    ds_read_b64_tr_b16 a[196:197], v4 offset:0
    v_cvt_pk_bf16_f32 v208, v208, v209
    v_mfma_f32_16x16x32_bf16 v[76:79], a[232:235], a[136:139], v[76:79]
    v_fma_f32 v70, v70, s28, v16
    v_fma_f32 v81, v81, s28, v18
    v_mfma_f32_16x16x32_bf16 v[76:79], a[236:239], a[140:143], v[76:79]
    ds_read_b64_tr_b16 a[198:199], v4 offset:6144
    v_exp_f32 v133, v61
    v_mfma_f32_16x16x32_bf16 v[20:23], a[240:243], v[96:99], 0
    buffer_load_dwordx4 v9, s[4:7], s20 offen lds
    v_mfma_f32_16x16x32_bf16 v[84:87], a[216:219], a[144:147], 0
    v_exp_f32 v130, v58
    v_mfma_f32_16x16x32_bf16 v[84:87], a[220:223], a[148:151], v[84:87]
    ds_read_b64_tr_b16 a[200:201], v5 offset:0
    v_cvt_pk_bf16_f32 v108, v128, v129
    v_mfma_f32_16x16x32_bf16 v[84:87], a[224:227], a[152:155], v[84:87]
    ds_read_b64_tr_b16 a[202:203], v5 offset:6144
    v_fma_f32 v72, v72, s28, v17
    v_mfma_f32_16x16x32_bf16 v[84:87], a[228:231], a[156:159], v[84:87]
    ds_read_b64_tr_b16 a[204:205], v6 offset:0
    v_cvt_pk_bf16_f32 v165, v166, v167
    v_mfma_f32_16x16x32_bf16 v[84:87], a[232:235], a[160:163], v[84:87]
    ds_read_b64_tr_b16 a[206:207], v6 offset:6144
    v_cvt_pk_bf16_f32 v149, v150, v151
    v_cvt_pk_bf16_f32 v110, v132, v133
    v_exp_f32 v131, v59
    v_pk_mul_f32 v[184:185], v[184:185], v[152:153] op_sel_hi:[1,0]
    v_pk_mul_f32 v[200:201], v[200:201], v[152:153] op_sel_hi:[1,0]
    v_pk_mul_f32 v[188:189], v[188:189], v[152:153] op_sel_hi:[1,0]
    v_exp_f32 v128, v64
    v_pk_mul_f32 v[222:223], v[222:223], v[154:155] op_sel_hi:[1,0]
    v_pk_mul_f32 v[172:173], v[172:173], v[152:153] op_sel_hi:[1,0]
    v_pk_mul_f32 v[252:253], v[252:253], v[154:155] op_sel_hi:[1,0]
    v_cvt_pk_bf16_f32 v248, v248, v249
    v_cvt_pk_bf16_f32 v109, v130, v131
    v_exp_f32 v129, v65
    v_pk_mul_f32 v[210:211], v[210:211], v[154:155] op_sel_hi:[1,0]
    v_pk_mul_f32 v[168:169], v[168:169], v[152:153] op_sel_hi:[1,0]
    v_pk_mul_f32 v[196:197], v[196:197], v[152:153] op_sel_hi:[1,0]
    v_fma_f32 v79, v79, s28, v17
    v_pk_mul_f32 v[180:181], v[180:181], v[152:153] op_sel_hi:[1,0]
    v_cvt_pk_bf16_f32 v145, v146, v147
    v_pk_mul_f32 v[240:241], v[240:241], v[154:155] op_sel_hi:[1,0]
    v_pk_mul_f32 v[228:229], v[228:229], v[154:155] op_sel_hi:[1,0]
    v_pk_mul_f32 v[174:175], v[174:175], v[152:153] op_sel_hi:[1,0]
    v_cvt_pk_bf16_f32 v172, v172, v173
    v_cvt_pk_bf16_f32 v209, v210, v211
    v_mfma_f32_16x16x32_bf16 v[84:87], a[236:239], a[164:167], v[84:87]
    ds_write2st64_b64 v14, v[160:161], v[208:209] offset0:0 offset1:12
    v_fma_f32 v74, v74, s28, v17
    v_cvt_pk_bf16_f32 v107, v134, v135
    v_accvgpr_read_b32 v150, a54
    v_accvgpr_read_b32 v151, a55
    v_mfma_f32_16x16x32_bf16 v[92:95], a[216:219], a[168:171], 0
    ds_write2st64_b64 v14, v[144:145], v[148:149] offset0:24 offset1:36
    v_pk_mul_f32 v[236:237], v[236:237], v[154:155] op_sel_hi:[1,0]
    v_accvgpr_read_b32 v144, a4
    v_pk_mul_f32 v[182:183], v[182:183], v[152:153] op_sel_hi:[1,0]
    v_pk_mul_f32 v[150:151], v[150:151], v[158:159] op_sel_hi:[1,0]
    v_pk_mul_f32 v[244:245], v[244:245], v[154:155] op_sel_hi:[1,0]
    v_accvgpr_read_b32 v147, a7
    v_accvgpr_read_b32 v149, a53
    v_mfma_f32_16x16x32_bf16 v[92:95], a[220:223], a[172:175], v[92:95]
    ds_write2st64_b64 v0, v[164:165], v[212:213] offset0:0 offset1:12
    v_cvt_pk_bf16_f32 v188, v188, v189
    v_fma_f32 v71, v71, s28, v16
    v_mfma_f32_16x16x32_bf16 v[92:95], a[224:227], a[176:179], v[92:95]
    v_accvgpr_read_b32 v145, a5
    v_cvt_pk_bf16_f32 v168, v168, v169
    v_exp_f32 v134, v62
    v_accvgpr_read_b32 v148, a52
    v_pk_mul_f32 v[230:231], v[230:231], v[154:155] op_sel_hi:[1,0]
    v_fma_f32 v85, v85, s28, v18
    v_pk_mul_f32 v[218:219], v[218:219], v[154:155] op_sel_hi:[1,0]
    v_pk_mul_f32 v[254:255], v[254:255], v[154:155] op_sel_hi:[1,0]
    v_pk_mul_f32 v[238:239], v[238:239], v[154:155] op_sel_hi:[1,0]
    v_cvt_pk_bf16_f32 v200, v200, v201
    v_exp_f32 v132, v72
    v_cvt_pk_bf16_f32 v112, v128, v129
    v_exp_f32 v133, v73
    v_fma_f32 v76, v76, s28, v17
    v_pk_mul_f32 v[224:225], v[224:225], v[154:155] op_sel_hi:[1,0]
    v_cvt_pk_bf16_f32 v228, v228, v229
    v_pk_mul_f32 v[144:145], v[144:145], v[156:157] op_sel_hi:[1,0]
    v_accvgpr_read_b32 v146, a6
    v_pk_mul_f32 v[178:179], v[178:179], v[152:153] op_sel_hi:[1,0]
    v_pk_mul_f32 v[148:149], v[148:149], v[158:159] op_sel_hi:[1,0]
    v_pk_mul_f32 v[146:147], v[146:147], v[156:157] op_sel_hi:[1,0]
    v_cvt_pk_bf16_f32 v240, v240, v241
    v_fma_f32 v86, v86, s28, v18
    v_mfma_f32_16x16x32_bf16 v[92:95], a[228:231], a[180:183], v[92:95]
    ds_read_b64_tr_b16 a[208:209], v3 offset:1024
    v_cvt_pk_bf16_f32 v184, v184, v185
    v_cvt_pk_bf16_f32 v144, v144, v145
    v_cvt_pk_bf16_f32 v145, v146, v147
    v_cvt_pk_bf16_f32 v148, v148, v149
    v_fma_f32 v77, v77, s28, v17
    v_accvgpr_read_b32 v146, a10
    v_exp_f32 v128, v70
    v_cvt_pk_bf16_f32 v149, v150, v151
    v_fma_f32 v69, v69, s28, v16
    v_mfma_f32_16x16x32_bf16 v[20:23], a[244:247], v[100:103], v[20:23]
    s_add_u32 s20, s20, 128
    v_cvt_pk_bf16_f32 v252, v252, v253
    v_exp_f32 v135, v63
    v_mfma_f32_16x16x32_bf16 v[92:95], a[232:235], a[184:187], v[92:95]
    s_add_u32 m0, s22, 13312
    ds_read_b64_tr_b16 a[218:219], v5 offset:7168
    v_cvt_pk_bf16_f32 v116, v132, v133
    v_accvgpr_read_b32 v147, a11
    v_mfma_f32_16x16x32_bf16 v[92:95], a[236:239], a[188:191], v[92:95]
    s_waitcnt lgkmcnt(2)
    ds_write2st64_b64 v0, v[144:145], v[148:149] offset0:24 offset1:36
    v_mfma_f32_16x16x32_bf16 v[160:163], a[192:195], v[96:99], 0
    v_exp_f32 v131, v67
    v_mfma_f32_16x16x32_bf16 v[208:211], a[192:195], v[100:103], 0
    ds_read_b64_tr_b16 a[210:211], v3 offset:7168
    v_xor_b32 v15, 64, v14
    v_cvt_pk_bf16_f32 v176, v176, v177
    v_fma_f32 v66, v66, s28, v16
    v_accvgpr_read_b32 v144, a8
    v_mfma_f32_16x16x32_bf16 a[0:3], a[192:195], v[104:107], 0
    ds_read_b64_tr_b16 a[230:231], v4 offset:8192
    buffer_load_dwordx4 v9, s[4:7], s20 offen lds
    v_exp_f32 v130, v66
    v_accvgpr_read_b32 v151, a59
    v_accvgpr_read_b32 v148, a56
    v_accvgpr_read_b32 v150, a58
    v_cvt_pk_bf16_f32 v169, v170, v171
    v_fma_f32 v87, v87, s28, v18
    v_cvt_pk_bf16_f32 v224, v224, v225
    v_fma_f32 v68, v68, s28, v16
    v_exp_f32 v129, v71
    v_cvt_pk_bf16_f32 v180, v180, v181
    v_fma_f32 v84, v84, s28, v18
    v_cvt_pk_bf16_f32 v225, v226, v227
    v_cvt_pk_bf16_f32 v111, v134, v135
    v_accvgpr_read_b32 v149, a57
    v_cvt_pk_bf16_f32 v221, v222, v223
    v_mfma_f32_16x16x32_bf16 a[48:51], a[192:195], v[108:111], 0
    s_add_u32 s20, s20, 128
    ds_read_b64_tr_b16 a[212:213], v4 offset:1024
    v_cvt_pk_bf16_f32 v217, v218, v219
    v_mfma_f32_16x16x32_bf16 v[20:23], a[248:251], v[104:107], v[20:23]
    ds_read_b64_tr_b16 a[220:221], v6 offset:1024
    v_cvt_pk_bf16_f32 v113, v130, v131
    v_accvgpr_read_b32 v145, a9
    v_cvt_pk_bf16_f32 v173, v174, v175
    v_mfma_f32_16x16x32_bf16 v[164:167], a[196:199], v[96:99], 0
    ds_read_b64_tr_b16 a[228:229], v4 offset:2048
    v_fma_f32 v78, v78, s28, v17
    v_mfma_f32_16x16x32_bf16 v[212:215], a[196:199], v[100:103], 0
    s_add_u32 m0, s22, 14336
    ds_write2st64_b64 v15, v[168:169], v[216:217] offset0:0 offset1:12
    v_exp_f32 v132, v76
    v_pk_mul_f32 v[186:187], v[186:187], v[152:153] op_sel_hi:[1,0]
    v_pk_mul_f32 v[148:149], v[148:149], v[158:159] op_sel_hi:[1,0]
    v_pk_mul_f32 v[146:147], v[146:147], v[156:157] op_sel_hi:[1,0]
    v_pk_mul_f32 v[206:207], v[206:207], v[152:153] op_sel_hi:[1,0]
    v_pk_mul_f32 v[144:145], v[144:145], v[156:157] op_sel_hi:[1,0]
    v_cvt_pk_bf16_f32 v253, v254, v255
    v_pk_mul_f32 v[150:151], v[150:151], v[158:159] op_sel_hi:[1,0]
    v_pk_mul_f32 v[202:203], v[202:203], v[152:153] op_sel_hi:[1,0]
    v_cvt_pk_bf16_f32 v148, v148, v149
    v_cvt_pk_bf16_f32 v181, v182, v183
    v_cvt_pk_bf16_f32 v144, v144, v145
    v_cvt_pk_bf16_f32 v149, v150, v151
    v_exp_f32 v135, v69
    v_mfma_f32_16x16x32_bf16 a[4:7], a[196:199], v[104:107], 0
    buffer_load_dwordx4 v9, s[4:7], s20 offen lds
    ds_read_b64_tr_b16 a[214:215], v4 offset:7168
    v_fma_f32 v88, v88, s28, v19
    v_exp_f32 v134, v68
    v_exp_f32 v130, v74
    v_cvt_pk_bf16_f32 v145, v146, v147
    v_accvgpr_read_b32 v146, a14
    v_mfma_f32_16x16x32_bf16 a[52:55], a[196:199], v[108:111], 0
    s_add_u32 s20, s20, 12032
    ds_write2st64_b64 v15, v[144:145], v[148:149] offset0:24 offset1:36
    v_cvt_pk_bf16_f32 v185, v186, v187
    v_accvgpr_read_b32 v150, a62
    v_fma_f32 v94, v94, s28, v19
    v_fma_f32 v92, v92, s28, v19
    v_accvgpr_read_b32 v151, a63
    v_fma_f32 v80, v80, s28, v18
    v_cvt_pk_bf16_f32 v115, v128, v129
    v_mfma_f32_16x16x32_bf16 v[168:171], a[200:203], v[96:99], 0
    ds_write2st64_b64 v8, v[172:173], v[220:221] offset0:0 offset1:12
    v_exp_f32 v131, v75
    v_accvgpr_read_b32 v148, a60
    v_accvgpr_read_b32 v145, a13
    v_accvgpr_read_b32 v144, a12
    v_cvt_pk_bf16_f32 v114, v134, v135
    v_accvgpr_read_b32 v149, a61
    v_cvt_pk_bf16_f32 v117, v130, v131
    v_accvgpr_read_b32 v147, a15
    v_pk_mul_f32 v[144:145], v[144:145], v[156:157] op_sel_hi:[1,0]
    v_cvt_pk_bf16_f32 v177, v178, v179
    v_pk_mul_f32 v[150:151], v[150:151], v[158:159] op_sel_hi:[1,0]
    v_cvt_pk_bf16_f32 v244, v244, v245
    v_pk_mul_f32 v[192:193], v[192:193], v[152:153] op_sel_hi:[1,0]
    v_pk_mul_f32 v[146:147], v[146:147], v[156:157] op_sel_hi:[1,0]
    v_pk_mul_f32 v[242:243], v[242:243], v[154:155] op_sel_hi:[1,0]
    v_pk_mul_f32 v[148:149], v[148:149], v[158:159] op_sel_hi:[1,0]
    v_cvt_pk_bf16_f32 v229, v230, v231
    v_cvt_pk_bf16_f32 v144, v144, v145
    v_mfma_f32_16x16x32_bf16 v[216:219], a[200:203], v[100:103], 0
    ds_read_b128 v[136:139], v13 offset:0
    v_cvt_pk_bf16_f32 v148, v148, v149
    v_mfma_f32_16x16x32_bf16 a[8:11], a[200:203], v[104:107], 0
    s_add_u32 s56, s24, 4294967168
    ds_read_b64_tr_b16 a[216:217], v5 offset:1024
    v_cvt_pk_bf16_f32 v145, v146, v147
    v_cvt_pk_bf16_f32 v149, v150, v151
    v_accvgpr_read_b32 v147, a19
    v_mfma_f32_16x16x32_bf16 a[56:59], a[200:203], v[108:111], 0
    ds_read_b128 v[140:143], v13 offset:1024
    v_accvgpr_read_b32 v151, a67
    v_mfma_f32_16x16x32_bf16 v[172:175], a[204:207], v[96:99], 0
    ds_write2st64_b64 v8, v[144:145], v[148:149] offset0:24 offset1:36
    v_mfma_f32_16x16x32_bf16 v[220:223], a[204:207], v[100:103], 0
    s_add_u32 s58, s25, 4294967168
    ds_write2st64_b64 v14, v[176:177], v[224:225] offset0:4 offset1:16
    v_exp_f32 v131, v83
    v_accvgpr_read_b32 v146, a18
    v_pk_mul_f32 v[204:205], v[204:205], v[152:153] op_sel_hi:[1,0]
    v_accvgpr_read_b32 v150, a66
    v_exp_f32 v134, v78
    v_pk_mul_f32 v[232:233], v[232:233], v[154:155] op_sel_hi:[1,0]
    v_exp_f32 v133, v77
    v_accvgpr_read_b32 v144, a16
    v_pk_mul_f32 v[250:251], v[250:251], v[154:155] op_sel_hi:[1,0]
    v_cvt_pk_bf16_f32 v236, v236, v237
    v_cvt_pk_bf16_f32 v189, v190, v191
    v_exp_f32 v135, v79
    v_pk_mul_f32 v[146:147], v[146:147], v[156:157] op_sel_hi:[1,0]
    v_accvgpr_read_b32 v145, a17
    v_accvgpr_read_b32 v148, a64
    v_fma_f32 v82, v82, s28, v18
    v_fma_f32 v91, v91, s28, v19
    v_pk_mul_f32 v[234:235], v[234:235], v[154:155] op_sel_hi:[1,0]
    v_pk_mul_f32 v[150:151], v[150:151], v[158:159] op_sel_hi:[1,0]
    v_cvt_pk_bf16_f32 v204, v204, v205
    v_exp_f32 v128, v80
    v_accvgpr_read_b32 v149, a65
    v_cvt_pk_bf16_f32 v192, v192, v193
    v_pk_mul_f32 v[246:247], v[246:247], v[154:155] op_sel_hi:[1,0]
    v_pk_mul_f32 v[144:145], v[144:145], v[156:157] op_sel_hi:[1,0]
    v_fma_f32 v95, v95, s28, v19
    v_pk_mul_f32 v[148:149], v[148:149], v[158:159] op_sel_hi:[1,0]
    v_cvt_pk_bf16_f32 v118, v132, v133
    v_cvt_pk_bf16_f32 v144, v144, v145
    v_cvt_pk_bf16_f32 v145, v146, v147
    v_mfma_f32_16x16x32_bf16 a[12:15], a[204:207], v[104:107], 0
    s_add_u32 m0, s38, 0
    ds_read_b64_tr_b16 a[226:227], v3 offset:8192
    v_cvt_pk_bf16_f32 v148, v148, v149
    v_cvt_pk_bf16_f32 v149, v150, v151
    v_mfma_f32_16x16x32_bf16 v[20:23], a[252:255], v[108:111], v[20:23]
    ds_write2st64_b64 v14, v[144:145], v[148:149] offset0:28 offset1:40
    v_accvgpr_read_b32 v144, a20
    v_cvt_pk_bf16_f32 v119, v134, v135
    v_accvgpr_read_b32 v145, a21
    v_cvt_pk_bf16_f32 v232, v232, v233
    v_pk_mul_f32 v[194:195], v[194:195], v[152:153] op_sel_hi:[1,0]
    v_accvgpr_read_b32 v150, a70
    v_accvgpr_read_b32 v149, a69
    v_accvgpr_read_b32 v148, a68
    v_mfma_f32_16x16x32_bf16 a[60:63], a[204:207], v[108:111], 0
    s_waitcnt lgkmcnt(2)
    ds_read_b64_tr_b16 a[222:223], v6 offset:7168
    buffer_load_dwordx4 v10, s[12:15], s58 offen nt lds
    v_accvgpr_read_b32 v147, a23
    v_cvt_pk_bf16_f32 v237, v238, v239
    v_pk_mul_f32 v[144:145], v[144:145], v[156:157] op_sel_hi:[1,0]
    v_cvt_pk_bf16_f32 v233, v234, v235
    v_accvgpr_read_b32 v151, a71
    v_mfma_f32_16x16x32_bf16 v[176:179], a[208:211], v[96:99], 0
    buffer_store_dwordx4 v[136:139], v12, s[16:19], s56 offen offset:0 sc0 sc1 nt
    s_add_u32 m0, s38, 1024
    ds_read_b64_tr_b16 a[238:239], v6 offset:8192
    v_accvgpr_read_b32 v146, a22
    v_pk_mul_f32 v[198:199], v[198:199], v[152:153] op_sel_hi:[1,0]
    v_pk_mul_f32 v[150:151], v[150:151], v[158:159] op_sel_hi:[1,0]
    v_exp_f32 v134, v86
    v_pk_mul_f32 v[146:147], v[146:147], v[156:157] op_sel_hi:[1,0]
    v_pk_mul_f32 v[148:149], v[148:149], v[158:159] op_sel_hi:[1,0]
    v_cvt_pk_bf16_f32 v144, v144, v145
    v_exp_f32 v130, v82
    v_cvt_pk_bf16_f32 v145, v146, v147
    v_mfma_f32_16x16x32_bf16 v[224:227], a[208:211], v[100:103], 0
    ds_write2st64_b64 v0, v[180:181], v[228:229] offset0:4 offset1:16
    v_cvt_pk_bf16_f32 v148, v148, v149
    v_cvt_pk_bf16_f32 v149, v150, v151
    v_mfma_f32_16x16x32_bf16 a[16:19], a[208:211], v[104:107], 0
    ds_read_b64_tr_b16 a[232:233], v5 offset:2048
    v_cvt_pk_bf16_f32 v241, v242, v243
    v_mfma_f32_16x16x32_bf16 v[24:27], a[240:243], v[112:115], v[20:23]
    buffer_store_dwordx4 v[140:143], v12, s[16:19], s56 offen offset:3072 sc0 sc1 nt
    ds_write2st64_b64 v0, v[144:145], v[148:149] offset0:28 offset1:40
    v_accvgpr_read_b32 v144, a24
    v_accvgpr_read_b32 v150, a74
    v_accvgpr_read_b32 v151, a75
    v_cvt_pk_bf16_f32 v193, v194, v195
    v_cvt_pk_bf16_f32 v249, v250, v251
    v_accvgpr_read_b32 v149, a73
    v_accvgpr_read_b32 v146, a26
    v_accvgpr_read_b32 v145, a25
    v_cvt_pk_bf16_f32 v245, v246, v247
    v_accvgpr_read_b32 v148, a72
    v_pk_mul_f32 v[144:145], v[144:145], v[156:157] op_sel_hi:[1,0]
    v_cvt_pk_bf16_f32 v196, v196, v197
    v_accvgpr_read_b32 v147, a27
    v_pk_mul_f32 v[148:149], v[148:149], v[158:159] op_sel_hi:[1,0]
    v_pk_mul_f32 v[146:147], v[146:147], v[156:157] op_sel_hi:[1,0]
    v_cvt_pk_bf16_f32 v201, v202, v203
    v_fma_f32 v93, v93, s28, v19
    v_exp_f32 v133, v85
    v_mfma_f32_16x16x32_bf16 a[64:67], a[208:211], v[108:111], 0
    ds_read_b128 v[136:139], v13 offset:6144
    v_fma_f32 v90, v90, s28, v19
    v_exp_f32 v135, v87
    v_cvt_pk_bf16_f32 v144, v144, v145
    v_cvt_pk_bf16_f32 v145, v146, v147
    v_accvgpr_read_b32 v146, a30
    v_pk_mul_f32 v[150:151], v[150:151], v[158:159] op_sel_hi:[1,0]
    v_cvt_pk_bf16_f32 v148, v148, v149
    v_exp_f32 v132, v84
    v_cvt_pk_bf16_f32 v149, v150, v151
    v_mfma_f32_16x16x32_bf16 v[180:183], a[212:215], v[96:99], 0
    buffer_load_dwordx4 v11, s[12:15], s58 offen nt lds
    ds_read_b128 v[140:143], v13 offset:7168
    v_mfma_f32_16x16x32_bf16 v[228:231], a[212:215], v[100:103], 0
    s_add_u32 s57, s24, 6016
    ds_write2st64_b64 v15, v[184:185], v[232:233] offset0:4 offset1:16
    v_accvgpr_read_b32 v151, a79
    v_mfma_f32_16x16x32_bf16 a[20:23], a[212:215], v[104:107], 0
    s_add_u32 s59, s25, 6016
    ds_write2st64_b64 v15, v[144:145], v[148:149] offset0:28 offset1:40
    v_mfma_f32_16x16x32_bf16 a[68:71], a[212:215], v[108:111], 0
    s_add_u32 m0, s38, 6144
    v_accvgpr_read_b32 v150, a78
    v_exp_f32 v129, v81
    v_accvgpr_read_b32 v144, a28
    v_mfma_f32_16x16x32_bf16 v[184:187], a[216:219], v[96:99], 0
    ds_read_b64_tr_b16 a[236:237], v6 offset:2048
    v_cvt_pk_bf16_f32 v121, v130, v131
    v_accvgpr_read_b32 v149, a77
    v_accvgpr_read_b32 v147, a31
    v_accvgpr_read_b32 v148, a76
    v_pk_mul_f32 v[148:149], v[148:149], v[158:159] op_sel_hi:[1,0]
    v_accvgpr_read_b32 v145, a29
    v_cvt_pk_bf16_f32 v148, v148, v149
    v_pk_mul_f32 v[146:147], v[146:147], v[156:157] op_sel_hi:[1,0]
    v_pk_mul_f32 v[144:145], v[144:145], v[156:157] op_sel_hi:[1,0]
    v_pk_mul_f32 v[150:151], v[150:151], v[158:159] op_sel_hi:[1,0]
    v_cvt_pk_bf16_f32 v144, v144, v145
    v_cvt_pk_bf16_f32 v149, v150, v151
    v_mfma_f32_16x16x32_bf16 v[232:235], a[216:219], v[100:103], 0
    ds_write2st64_b64 v8, v[188:189], v[236:237] offset0:4 offset1:16
    v_cvt_pk_bf16_f32 v145, v146, v147
    v_mfma_f32_16x16x32_bf16 a[24:27], a[216:219], v[104:107], 0
    ds_write2st64_b64 v8, v[144:145], v[148:149] offset0:28 offset1:40
    v_accvgpr_read_b32 v146, a34
    v_accvgpr_read_b32 v148, a80
    v_cvt_pk_bf16_f32 v123, v134, v135
    v_mfma_f32_16x16x32_bf16 a[72:75], a[216:219], v[108:111], 0
    s_waitcnt lgkmcnt(3)
    ds_read_b64_tr_b16 a[224:225], v3 offset:2048
    v_accvgpr_read_b32 v145, a33
    v_mfma_f32_16x16x32_bf16 v[188:191], a[220:223], v[96:99], 0
    buffer_load_dwordx4 v10, s[12:15], s59 offen nt lds
    ds_read_b64_tr_b16 a[234:235], v5 offset:8192
    v_accvgpr_read_b32 v147, a35
    v_mfma_f32_16x16x32_bf16 v[236:239], a[220:223], v[100:103], 0
    v_accvgpr_read_b32 v150, a82
    v_accvgpr_read_b32 v149, a81
    v_accvgpr_read_b32 v144, a32
    v_accvgpr_read_b32 v151, a83
    v_cvt_pk_bf16_f32 v122, v132, v133
    v_pk_mul_f32 v[144:145], v[144:145], v[156:157] op_sel_hi:[1,0]
    v_pk_mul_f32 v[146:147], v[146:147], v[156:157] op_sel_hi:[1,0]
    v_pk_mul_f32 v[150:151], v[150:151], v[158:159] op_sel_hi:[1,0]
    v_cvt_pk_bf16_f32 v144, v144, v145
    v_exp_f32 v131, v91
    v_pk_mul_f32 v[148:149], v[148:149], v[158:159] op_sel_hi:[1,0]
    v_exp_f32 v132, v92
    v_cvt_pk_bf16_f32 v197, v198, v199
    v_cvt_pk_bf16_f32 v145, v146, v147
    v_mfma_f32_16x16x32_bf16 v[24:27], a[244:247], v[116:119], v[24:27]
    ds_write2st64_b64 v14, v[192:193], v[240:241] offset0:8 offset1:20
    v_mfma_f32_16x16x32_bf16 a[28:31], a[220:223], v[104:107], 0
    buffer_store_dwordx4 v[136:139], v12, s[16:19], s57 offen offset:0 sc0 sc1 nt
    s_add_u32 m0, s38, 7168
    v_cvt_pk_bf16_f32 v120, v128, v129
    v_cvt_pk_bf16_f32 v148, v148, v149
    v_accvgpr_read_b32 v147, a39
    v_cvt_pk_bf16_f32 v149, v150, v151
    v_exp_f32 v130, v90
    v_mfma_f32_16x16x32_bf16 a[76:79], a[220:223], v[108:111], 0
    s_waitcnt lgkmcnt(1)
    v_exp_f32 v134, v94
    v_mfma_f32_16x16x32_bf16 v[192:195], a[224:227], v[96:99], 0
    buffer_load_dwordx4 v11, s[12:15], s59 offen nt lds
    ds_read_b128 v[136:139], v13 offset:12288
    v_mfma_f32_16x16x32_bf16 v[240:243], a[224:227], v[100:103], 0
    s_add_u32 s56, s24, 12160
    ds_write2st64_b64 v14, v[144:145], v[148:149] offset0:32 offset1:44
    v_accvgpr_read_b32 v144, a36
    v_accvgpr_read_b32 v148, a84
    v_accvgpr_read_b32 v149, a85
    v_accvgpr_read_b32 v150, a86
    v_accvgpr_read_b32 v151, a87
    v_accvgpr_read_b32 v145, a37
    v_exp_f32 v135, v95
    v_mfma_f32_16x16x32_bf16 a[32:35], a[224:227], v[104:107], 0
    buffer_store_dwordx4 v[140:143], v12, s[16:19], s57 offen offset:3072 sc0 sc1 nt
    s_add_u32 s58, s25, 12160
    s_add_u32 m0, s38, 12288
    ds_read_b128 v[140:143], v13 offset:13312
    v_accvgpr_read_b32 v146, a38
    v_pk_mul_f32 v[144:145], v[144:145], v[156:157] op_sel_hi:[1,0]
    v_pk_mul_f32 v[148:149], v[148:149], v[158:159] op_sel_hi:[1,0]
    v_exp_f32 v128, v88
    v_pk_mul_f32 v[150:151], v[150:151], v[158:159] op_sel_hi:[1,0]
    v_cvt_pk_bf16_f32 v148, v148, v149
    v_cvt_pk_bf16_f32 v144, v144, v145
    v_pk_mul_f32 v[146:147], v[146:147], v[156:157] op_sel_hi:[1,0]
    v_cvt_pk_bf16_f32 v149, v150, v151
    v_cvt_pk_bf16_f32 v205, v206, v207
    v_cvt_pk_bf16_f32 v145, v146, v147
    v_exp_f32 v129, v89
    v_accvgpr_read_b32 v147, a43
    v_mfma_f32_16x16x32_bf16 a[80:83], a[224:227], v[108:111], 0
    ds_write2st64_b64 v0, v[196:197], v[244:245] offset0:8 offset1:20
    v_mfma_f32_16x16x32_bf16 v[196:199], a[228:231], v[96:99], 0
    s_waitcnt lgkmcnt(2)
    ds_write2st64_b64 v0, v[144:145], v[148:149] offset0:32 offset1:44
    buffer_load_dwordx4 v10, s[12:15], s58 offen nt lds
    v_accvgpr_read_b32 v148, a88
    v_mfma_f32_16x16x32_bf16 v[244:247], a[228:231], v[100:103], 0
    s_add_u32 m0, s38, 13312
    ds_write2st64_b64 v15, v[200:201], v[248:249] offset0:8 offset1:20
    v_cvt_pk_bf16_f32 v127, v134, v135
    v_accvgpr_read_b32 v151, a91
    v_accvgpr_read_b32 v145, a41
    v_mfma_f32_16x16x32_bf16 a[36:39], a[228:231], v[104:107], 0
    s_waitcnt lgkmcnt(3)
    buffer_load_dwordx4 v11, s[12:15], s58 offen nt lds
    v_cvt_pk_bf16_f32 v125, v130, v131
    v_accvgpr_read_b32 v146, a42
    v_exp_f32 v133, v93
    v_accvgpr_read_b32 v144, a40
    v_pk_mul_f32 v[144:145], v[144:145], v[156:157] op_sel_hi:[1,0]
    s_waitcnt vmcnt(16)
    v_accvgpr_read_b32 v149, a89
    v_accvgpr_read_b32 v150, a90
    v_mfma_f32_16x16x32_bf16 v[24:27], a[248:251], v[120:123], v[24:27]
    buffer_store_dwordx4 v[136:139], v12, s[16:19], s56 offen offset:0 sc0 sc1 nt
    s_barrier
    ds_read_b128 a[200:203], v1 offset:1024
    v_pk_mul_f32 v[148:149], v[148:149], v[158:159] op_sel_hi:[1,0]
    v_pk_mul_f32 v[146:147], v[146:147], v[156:157] op_sel_hi:[1,0]
    v_cvt_pk_bf16_f32 v148, v148, v149
    v_cvt_pk_bf16_f32 v144, v144, v145
    v_pk_mul_f32 v[150:151], v[150:151], v[158:159] op_sel_hi:[1,0]
    v_cvt_pk_bf16_f32 v145, v146, v147
    v_cvt_pk_bf16_f32 v149, v150, v151
    v_mfma_f32_16x16x32_bf16 a[84:87], a[228:231], v[108:111], 0
    ds_write2st64_b64 v15, v[144:145], v[148:149] offset0:32 offset1:44
    v_mfma_f32_16x16x32_bf16 v[200:203], a[232:235], v[96:99], 0
    ds_read_b128 a[204:207], v2 offset:1024
    v_cvt_pk_bf16_f32 v124, v128, v129
    v_mfma_f32_16x16x32_bf16 v[248:251], a[232:235], v[100:103], 0
    ds_read_b128 a[192:195], v1 offset:0
    v_cvt_pk_bf16_f32 v126, v132, v133
    v_mfma_f32_16x16x32_bf16 a[40:43], a[232:235], v[104:107], 0
    ds_read_b128 a[196:199], v2 offset:0
    v_accvgpr_read_b32 v145, a45
    v_accvgpr_read_b32 v147, a47
    v_mfma_f32_16x16x32_bf16 a[88:91], a[232:235], v[108:111], 0
    ds_write2st64_b64 v8, v[204:205], v[252:253] offset0:8 offset1:20
    v_accvgpr_read_b32 v144, a44
    v_mfma_f32_16x16x32_bf16 v[204:207], a[236:239], v[96:99], 0
    s_add_u32 m0, s22, 24576
    ds_read_b128 a[208:211], v1 offset:2048
    v_accvgpr_read_b32 v146, a46
    v_mfma_f32_16x16x32_bf16 v[252:255], a[236:239], v[100:103], 0
    v_accvgpr_read_b32 v151, a95
    v_accvgpr_read_b32 v149, a93
    v_mfma_f32_16x16x32_bf16 a[44:47], a[236:239], v[104:107], 0
    ds_read_b128 a[212:215], v2 offset:2048
    v_accvgpr_read_b32 v148, a92
    v_mfma_f32_16x16x32_bf16 v[24:27], a[252:255], v[124:127], v[24:27]
    buffer_load_dwordx4 v9, s[8:11], s21 offen lds
    v_accvgpr_read_b32 v150, a94
    v_mfma_f32_16x16x32_bf16 a[92:95], a[236:239], v[108:111], 0
    buffer_store_dwordx4 v[140:143], v12, s[16:19], s56 offen offset:3072 sc0 sc1 nt
    s_nop 0
    ds_read_b128 v[140:143], v13 offset:19456
    v_pk_mul_f32 v[146:147], v[146:147], v[156:157] op_sel_hi:[1,0]
    v_pk_mul_f32 v[144:145], v[144:145], v[156:157] op_sel_hi:[1,0]
    v_pk_mul_f32 v[150:151], v[150:151], v[158:159] op_sel_hi:[1,0]
    v_pk_mul_f32 v[148:149], v[148:149], v[158:159] op_sel_hi:[1,0]
    v_cmp_lt_f32 vcc, s29, v24
    s_waitcnt lgkmcnt(4)
    v_mfma_f32_16x16x32_bf16 v[32:35], a[192:195], a[96:99], 0
    ds_read_b128 v[136:139], v13 offset:18432
    v_mfma_f32_16x16x32_bf16 v[32:35], a[196:199], a[100:103], v[32:35]
    ds_read_b128 a[232:235], v1 offset:8192
    s_add_u32 s21, s21, 128
    v_mfma_f32_16x16x32_bf16 v[32:35], a[200:203], a[104:107], v[32:35]
    ds_read_b128 a[236:239], v2 offset:8192
    v_cvt_pk_bf16_f32 v148, v148, v149
    v_mfma_f32_16x16x32_bf16 v[32:35], a[204:207], a[108:111], v[32:35]
    s_add_u32 m0, s22, 25600
    s_waitcnt lgkmcnt(5)
    v_mfma_f32_16x16x32_bf16 v[32:35], a[208:211], a[112:115], v[32:35]
    s_waitcnt lgkmcnt(4)
    v_mfma_f32_16x16x32_bf16 v[32:35], a[212:215], a[116:119], v[32:35]
    s_cbranch_vccnz L_rs_tr44d
L_ret_tr44d:
    v_mfma_f32_16x16x32_bf16 v[40:43], a[192:195], a[120:123], 0
    buffer_load_dwordx4 v9, s[8:11], s21 offen lds
    v_mfma_f32_16x16x32_bf16 v[40:43], a[196:199], a[124:127], v[40:43]
    s_add_u32 s21, s21, 128
    ds_read_b128 a[216:219], v1 offset:6144
    s_add_u32 m0, s22, 26624
    v_mfma_f32_16x16x32_bf16 v[40:43], a[200:203], a[128:131], v[40:43]
    buffer_load_dwordx4 v9, s[8:11], s21 offen lds
    v_mfma_f32_16x16x32_bf16 v[40:43], a[204:207], a[132:135], v[40:43]
    s_add_u32 s21, s21, 12032
    ds_read_b128 a[220:223], v2 offset:6144
    v_mfma_f32_16x16x32_bf16 v[40:43], a[208:211], a[136:139], v[40:43]
    v_fma_f32 v34, v34, s28, v16
    v_add_u32 v13, 2048, v13
    v_mfma_f32_16x16x32_bf16 v[40:43], a[212:215], a[140:143], v[40:43]
    ds_read_b128 a[228:231], v2 offset:7168
    s_add_u32 s56, s24, 18304
    v_mfma_f32_16x16x32_bf16 v[48:51], a[192:195], a[144:147], 0
    v_mfma_f32_16x16x32_bf16 v[48:51], a[196:199], a[148:151], v[48:51]
    ds_read_b128 a[224:227], v1 offset:7168
    v_cvt_pk_bf16_f32 v149, v150, v151
    v_mfma_f32_16x16x32_bf16 v[48:51], a[200:203], a[152:155], v[48:51]
    s_nop 0
    v_fma_f32 v40, v40, s28, v17
    v_mfma_f32_16x16x32_bf16 v[48:51], a[204:207], a[156:159], v[48:51]
    v_cvt_pk_bf16_f32 v144, v144, v145
    v_mfma_f32_16x16x32_bf16 v[48:51], a[208:211], a[160:163], v[48:51]
    v_mfma_f32_16x16x32_bf16 v[48:51], a[212:215], a[164:167], v[48:51]
    v_fma_f32 v35, v35, s28, v16
    s_add_u32 s58, s25, 18304
    v_mfma_f32_16x16x32_bf16 v[56:59], a[192:195], a[168:171], 0
    v_fma_f32 v32, v32, s28, v16
    s_add_u32 m0, s38, 18432
    v_mfma_f32_16x16x32_bf16 v[56:59], a[196:199], a[172:175], v[56:59]
    v_fma_f32 v33, v33, s28, v16
    v_mfma_f32_16x16x32_bf16 v[56:59], a[200:203], a[176:179], v[56:59]
    s_waitcnt lgkmcnt(2)
    buffer_load_dwordx4 v10, s[12:15], s58 offen nt lds
    v_mfma_f32_16x16x32_bf16 v[56:59], a[204:207], a[180:183], v[56:59]
    s_add_u32 m0, s38, 19456
    v_exp_f32 v130, v34
    v_mfma_f32_16x16x32_bf16 v[56:59], a[208:211], a[184:187], v[56:59]
    buffer_load_dwordx4 v11, s[12:15], s58 offen nt lds
    v_mfma_f32_16x16x32_bf16 v[56:59], a[212:215], a[188:191], v[56:59]
    v_fma_f32 v41, v41, s28, v17
    v_mfma_f32_16x16x32_bf16 v[36:39], a[216:219], a[96:99], 0
    v_exp_f32 v128, v32
    v_mfma_f32_16x16x32_bf16 v[36:39], a[220:223], a[100:103], v[36:39]
    s_waitcnt lgkmcnt(0)
    v_mfma_f32_16x16x32_bf16 v[36:39], a[224:227], a[104:107], v[36:39]
    v_exp_f32 v132, v40
    v_mfma_f32_16x16x32_bf16 v[36:39], a[228:231], a[108:111], v[36:39]
    s_waitcnt vmcnt(20)
    v_exp_f32 v131, v35
    v_mfma_f32_16x16x32_bf16 v[36:39], a[232:235], a[112:115], v[36:39]
    s_barrier
    v_mfma_f32_16x16x32_bf16 v[36:39], a[236:239], a[116:119], v[36:39]
    s_add_u32 m0, s22, 0
    v_exp_f32 v129, v33
    v_mfma_f32_16x16x32_bf16 v[44:47], a[216:219], a[120:123], 0
    ds_read_b64_tr_b16 a[192:193], v3 offset:12288
    v_cvt_pk_bf16_f32 v96, v128, v129
    v_mfma_f32_16x16x32_bf16 v[44:47], a[220:223], a[124:127], v[44:47]
    buffer_load_dwordx4 v9, s[4:7], s20 offen lds
    v_mfma_f32_16x16x32_bf16 v[44:47], a[224:227], a[128:131], v[44:47]
    v_exp_f32 v133, v41
    v_mfma_f32_16x16x32_bf16 v[44:47], a[228:231], a[132:135], v[44:47]
    ds_read_b64_tr_b16 a[194:195], v3 offset:18432
    v_mfma_f32_16x16x32_bf16 v[44:47], a[232:235], a[136:139], v[44:47]
    s_add_u32 s20, s20, 128
    ds_read_b64_tr_b16 a[196:197], v4 offset:12288
    v_mfma_f32_16x16x32_bf16 v[44:47], a[236:239], a[140:143], v[44:47]
    ds_read_b64_tr_b16 a[198:199], v4 offset:18432
    v_cvt_pk_bf16_f32 v145, v146, v147
    v_mfma_f32_16x16x32_bf16 v[52:55], a[216:219], a[144:147], 0
    buffer_store_dwordx4 v[136:139], v12, s[16:19], s56 offen offset:0 sc0 sc1 nt
    s_add_u32 m0, s22, 1024
    ds_write2st64_b64 v8, v[144:145], v[148:149] offset0:32 offset1:44
    v_mfma_f32_16x16x32_bf16 v[52:55], a[220:223], a[148:151], v[52:55]
    ds_read_b64_tr_b16 a[200:201], v5 offset:12288
    v_mfma_f32_16x16x32_bf16 v[52:55], a[224:227], a[152:155], v[52:55]
    buffer_load_dwordx4 v9, s[4:7], s20 offen lds
    v_mfma_f32_16x16x32_bf16 v[52:55], a[228:231], a[156:159], v[52:55]
    ds_read_b64_tr_b16 a[202:203], v5 offset:18432
    v_mfma_f32_16x16x32_bf16 v[52:55], a[232:235], a[160:163], v[52:55]
    v_mfma_f32_16x16x32_bf16 v[52:55], a[236:239], a[164:167], v[52:55]
    buffer_store_dwordx4 v[140:143], v12, s[16:19], s56 offen offset:3072 sc0 sc1 nt
    s_add_u32 s20, s20, 128
    s_add_u32 m0, s22, 2048
    ds_read_b64_tr_b16 a[204:205], v6 offset:12288
    v_cvt_pk_bf16_f32 v97, v130, v131
    v_mfma_f32_16x16x32_bf16 v[60:63], a[216:219], a[168:171], 0
    ds_read_b64_tr_b16 a[206:207], v6 offset:18432
    v_mfma_f32_16x16x32_bf16 v[60:63], a[220:223], a[172:175], v[60:63]
    ds_read_b64_tr_b16 a[208:209], v3 offset:13312
    v_cvt_pk_bf16_f32 v100, v132, v133
    v_mfma_f32_16x16x32_bf16 v[60:63], a[224:227], a[176:179], v[60:63]
    ds_read_b64_tr_b16 a[210:211], v3 offset:19456
    v_mfma_f32_16x16x32_bf16 v[60:63], a[228:231], a[180:183], v[60:63]
    buffer_load_dwordx4 v9, s[4:7], s20 offen lds
    v_mfma_f32_16x16x32_bf16 v[60:63], a[232:235], a[184:187], v[60:63]
    ds_read_b64_tr_b16 a[212:213], v4 offset:13312
    v_mfma_f32_16x16x32_bf16 v[60:63], a[236:239], a[188:191], v[60:63]
    ds_read_b64_tr_b16 a[214:215], v4 offset:19456
    s_add_u32 s20, s20, 12032
    s_branch L_loop4
L_loop3:
    s_bitcmp1_b32 s3, 1
    s_cbranch_scc1 L_loop3w1
    .p2align 6
L_loop3w0:
    s_waitcnt lgkmcnt(10)
    v_mfma_f32_16x16x32_bf16 v[160:163], a[192:195], v[112:115], v[160:163]
    v_fma_f32 v39, v39, s28, v16
    v_fma_f32 v36, v36, s28, v16
    v_mfma_f32_16x16x32_bf16 v[208:211], a[192:195], v[116:119], v[208:211]
    v_fma_f32 v43, v43, s28, v17
    v_fma_f32 v46, v46, s28, v17
    v_mfma_f32_16x16x32_bf16 a[0:3], a[192:195], v[120:123], a[0:3]
    ds_read_b64_tr_b16 a[218:219], v5 offset:19456
    s_waitcnt lgkmcnt(9)
    v_mfma_f32_16x16x32_bf16 v[164:167], a[196:199], v[112:115], v[164:167]
    ds_read_b64_tr_b16 a[228:229], v4 offset:14336
    v_fma_f32 v38, v38, s28, v16
    v_mfma_f32_16x16x32_bf16 v[212:215], a[196:199], v[116:119], v[212:215]
    v_exp_f32 v129, v39
    v_mfma_f32_16x16x32_bf16 a[4:7], a[196:199], v[120:123], a[4:7]
    ds_read_b64_tr_b16 a[230:231], v4 offset:20480
    s_waitcnt lgkmcnt(9)
    v_mfma_f32_16x16x32_bf16 v[168:171], a[200:203], v[112:115], v[168:171]
    ds_read_b64_tr_b16 a[232:233], v5 offset:14336
    v_fma_f32 v51, v51, s28, v18
    v_mfma_f32_16x16x32_bf16 v[216:219], a[200:203], v[116:119], v[216:219]
    ds_read_b64_tr_b16 a[236:237], v6 offset:14336
    ds_read_b64_tr_b16 a[216:217], v5 offset:13312
    v_mfma_f32_16x16x32_bf16 a[8:11], a[200:203], v[120:123], a[8:11]
    s_waitcnt lgkmcnt(9)
    ds_read_b64_tr_b16 a[234:235], v5 offset:20480
    ds_read_b64_tr_b16 a[220:221], v6 offset:13312
    v_mfma_f32_16x16x32_bf16 v[172:175], a[204:207], v[112:115], v[172:175]
    ds_read_b64_tr_b16 a[224:225], v3 offset:14336
    ds_read_b64_tr_b16 a[238:239], v6 offset:20480
    v_mfma_f32_16x16x32_bf16 v[220:223], a[204:207], v[116:119], v[220:223]
    ds_read_b64_tr_b16 a[226:227], v3 offset:20480
    ds_read_b64_tr_b16 a[222:223], v6 offset:19456
    v_mfma_f32_16x16x32_bf16 a[12:15], a[204:207], v[120:123], a[12:15]
    s_waitcnt lgkmcnt(12)
    v_exp_f32 v128, v38
    v_mfma_f32_16x16x32_bf16 v[176:179], a[208:211], v[112:115], v[176:179]
    v_fma_f32 v37, v37, s28, v16
    v_fma_f32 v45, v45, s28, v17
    v_mfma_f32_16x16x32_bf16 v[224:227], a[208:211], v[116:119], v[224:227]
    v_exp_f32 v134, v36
    v_mfma_f32_16x16x32_bf16 a[16:19], a[208:211], v[120:123], a[16:19]
    v_fma_f32 v42, v42, s28, v17
    v_fma_f32 v47, v47, s28, v17
    v_mfma_f32_16x16x32_bf16 v[180:183], a[212:215], v[112:115], v[180:183]
    v_exp_f32 v135, v37
    v_mfma_f32_16x16x32_bf16 v[228:231], a[212:215], v[116:119], v[228:231]
    v_cvt_pk_bf16_f32 v98, v134, v135
    v_mfma_f32_16x16x32_bf16 a[20:23], a[212:215], v[120:123], a[20:23]
    s_waitcnt lgkmcnt(6)
    v_exp_f32 v130, v42
    v_mfma_f32_16x16x32_bf16 v[184:187], a[216:219], v[112:115], v[184:187]
    v_cvt_pk_bf16_f32 v99, v128, v129
    v_fma_f32 v54, v54, s28, v18
    v_mfma_f32_16x16x32_bf16 v[232:235], a[216:219], v[116:119], v[232:235]
    v_exp_f32 v131, v43
    v_mfma_f32_16x16x32_bf16 a[24:27], a[216:219], v[120:123], a[24:27]
    v_fma_f32 v53, v53, s28, v18
    s_waitcnt vmcnt(10) lgkmcnt(0)
    v_mfma_f32_16x16x32_bf16 v[20:23], a[240:243], v[96:99], v[24:27]
    s_barrier
    v_mfma_f32_16x16x32_bf16 v[188:191], a[220:223], v[112:115], v[188:191]
    ds_read_b128 a[204:207], v2 offset:13312
    v_fma_f32 v55, v55, s28, v18
    v_mfma_f32_16x16x32_bf16 v[236:239], a[220:223], v[116:119], v[236:239]
    s_add_u32 m0, s22, 36864
    ds_read_b128 a[200:203], v1 offset:13312
    v_fma_f32 v48, v48, s28, v18
    v_mfma_f32_16x16x32_bf16 a[28:31], a[220:223], v[120:123], a[28:31]
    buffer_load_dwordx4 v9, s[8:11], s21 offen lds
    v_mfma_f32_16x16x32_bf16 v[192:195], a[224:227], v[112:115], v[192:195]
    ds_read_b128 a[192:195], v1 offset:12288
    v_fma_f32 v44, v44, s28, v17
    v_mfma_f32_16x16x32_bf16 v[240:243], a[224:227], v[116:119], v[240:243]
    s_add_u32 s21, s21, 128
    ds_read_b128 a[196:199], v2 offset:12288
    v_mfma_f32_16x16x32_bf16 a[32:35], a[224:227], v[120:123], a[32:35]
    ds_read_b128 a[208:211], v1 offset:14336
    v_cvt_pk_bf16_f32 v101, v130, v131
    v_mfma_f32_16x16x32_bf16 v[196:199], a[228:231], v[112:115], v[196:199]
    ds_read_b128 a[212:215], v2 offset:14336
    v_fma_f32 v52, v52, s28, v18
    v_mfma_f32_16x16x32_bf16 v[244:247], a[228:231], v[116:119], v[244:247]
    s_add_u32 m0, s22, 37888
    v_fma_f32 v50, v50, s28, v18
    v_fma_f32 v49, v49, s28, v18
    v_mfma_f32_16x16x32_bf16 a[36:39], a[228:231], v[120:123], a[36:39]
    v_exp_f32 v133, v45
    v_mfma_f32_16x16x32_bf16 v[200:203], a[232:235], v[112:115], v[200:203]
    buffer_load_dwordx4 v9, s[8:11], s21 offen lds
    v_mfma_f32_16x16x32_bf16 v[248:251], a[232:235], v[116:119], v[248:251]
    s_add_u32 s21, s21, 128
    ds_read_b128 a[216:219], v1 offset:18432
    v_mfma_f32_16x16x32_bf16 a[40:43], a[232:235], v[120:123], a[40:43]
    s_add_u32 m0, s22, 38912
    v_exp_f32 v135, v47
    v_mfma_f32_16x16x32_bf16 v[204:207], a[236:239], v[112:115], v[204:207]
    v_exp_f32 v131, v51
    v_mfma_f32_16x16x32_bf16 v[252:255], a[236:239], v[116:119], v[252:255]
    buffer_load_dwordx4 v9, s[8:11], s21 offen lds
    v_mfma_f32_16x16x32_bf16 a[44:47], a[236:239], v[120:123], a[44:47]
    s_waitcnt lgkmcnt(3)
    v_exp_f32 v132, v44
    v_mfma_f32_16x16x32_bf16 v[64:67], a[192:195], a[96:99], 0
    v_exp_f32 v134, v46
    v_mfma_f32_16x16x32_bf16 v[64:67], a[196:199], a[100:103], v[64:67]
    ds_read_b128 a[220:223], v2 offset:18432
    v_cvt_pk_bf16_f32 v102, v132, v133
    v_mfma_f32_16x16x32_bf16 v[64:67], a[200:203], a[104:107], v[64:67]
    ds_read_b128 a[236:239], v2 offset:20480
    v_cvt_pk_bf16_f32 v103, v134, v135
    v_mfma_f32_16x16x32_bf16 v[64:67], a[204:207], a[108:111], v[64:67]
    s_waitcnt lgkmcnt(3)
    ds_read_b128 a[224:227], v1 offset:19456
    v_mfma_f32_16x16x32_bf16 v[64:67], a[208:211], a[112:115], v[64:67]
    v_exp_f32 v134, v54
    v_mfma_f32_16x16x32_bf16 v[64:67], a[212:215], a[116:119], v[64:67]
    ds_read_b128 a[228:231], v2 offset:19456
    v_mfma_f32_16x16x32_bf16 v[72:75], a[192:195], a[120:123], 0
    ds_read_b128 a[232:235], v1 offset:20480
    v_mfma_f32_16x16x32_bf16 v[72:75], a[196:199], a[124:127], v[72:75]
    v_exp_f32 v130, v50
    v_mfma_f32_16x16x32_bf16 v[72:75], a[200:203], a[128:131], v[72:75]
    v_exp_f32 v128, v48
    v_mfma_f32_16x16x32_bf16 v[20:23], a[244:247], v[100:103], v[20:23]
    v_exp_f32 v129, v49
    v_mfma_f32_16x16x32_bf16 v[72:75], a[204:207], a[132:135], v[72:75]
    v_mfma_f32_16x16x32_bf16 v[72:75], a[208:211], a[136:139], v[72:75]
    v_exp_f32 v132, v52
    v_mfma_f32_16x16x32_bf16 v[72:75], a[212:215], a[140:143], v[72:75]
    v_exp_f32 v135, v55
    v_mfma_f32_16x16x32_bf16 v[80:83], a[192:195], a[144:147], 0
    v_cvt_pk_bf16_f32 v107, v134, v135
    v_cvt_pk_bf16_f32 v104, v128, v129
    v_mfma_f32_16x16x32_bf16 v[80:83], a[196:199], a[148:151], v[80:83]
    v_exp_f32 v133, v53
    v_mfma_f32_16x16x32_bf16 v[80:83], a[200:203], a[152:155], v[80:83]
    v_cvt_pk_bf16_f32 v105, v130, v131
    v_mfma_f32_16x16x32_bf16 v[80:83], a[204:207], a[156:159], v[80:83]
    s_add_u32 s21, s21, 12032
    v_cvt_pk_bf16_f32 v106, v132, v133
    v_mfma_f32_16x16x32_bf16 v[80:83], a[208:211], a[160:163], v[80:83]
    s_waitcnt vmcnt(8) lgkmcnt(0)
    v_mfma_f32_16x16x32_bf16 v[20:23], a[248:251], v[104:107], v[20:23]
    s_barrier
    v_mfma_f32_16x16x32_bf16 v[80:83], a[212:215], a[164:167], v[80:83]
    s_add_u32 m0, s22, 12288
    ds_read_b64_tr_b16 a[192:193], v3 offset:0
    ds_read_b64_tr_b16 a[194:195], v3 offset:6144
    v_mfma_f32_16x16x32_bf16 v[68:71], a[216:219], a[96:99], 0
    buffer_load_dwordx4 v9, s[4:7], s20 offen lds
    v_mfma_f32_16x16x32_bf16 v[68:71], a[220:223], a[100:103], v[68:71]
    s_add_u32 s20, s20, 128
    ds_read_b64_tr_b16 a[196:197], v4 offset:0
    v_cmp_lt_f32 vcc, s29, v20
    v_mfma_f32_16x16x32_bf16 v[68:71], a[224:227], a[104:107], v[68:71]
    s_add_u32 m0, s22, 13312
    ds_read_b64_tr_b16 a[198:199], v4 offset:6144
    buffer_load_dwordx4 v9, s[4:7], s20 offen lds
    v_mfma_f32_16x16x32_bf16 v[68:71], a[228:231], a[108:111], v[68:71]
    s_cbranch_vccnz L_rs_loop3w0a
L_ret_loop3w0a:
    v_fma_f32 v66, v66, s28, v16
    v_mfma_f32_16x16x32_bf16 v[68:71], a[232:235], a[112:115], v[68:71]
    v_fma_f32 v73, v73, s28, v17
    v_fma_f32 v67, v67, s28, v16
    v_mfma_f32_16x16x32_bf16 v[68:71], a[236:239], a[116:119], v[68:71]
    ds_read_b64_tr_b16 a[200:201], v5 offset:0
    v_fma_f32 v65, v65, s28, v16
    v_mfma_f32_16x16x32_bf16 v[76:79], a[216:219], a[120:123], 0
    s_add_u32 s20, s20, 128
    ds_read_b64_tr_b16 a[202:203], v5 offset:6144
    v_fma_f32 v72, v72, s28, v17
    v_mfma_f32_16x16x32_bf16 v[76:79], a[220:223], a[124:127], v[76:79]
    v_exp_f32 v132, v72
    v_mfma_f32_16x16x32_bf16 v[76:79], a[224:227], a[128:131], v[76:79]
    s_add_u32 m0, s22, 14336
    v_fma_f32 v64, v64, s28, v16
    v_exp_f32 v128, v64
    v_mfma_f32_16x16x32_bf16 v[76:79], a[228:231], a[132:135], v[76:79]
    v_exp_f32 v130, v66
    v_mfma_f32_16x16x32_bf16 v[76:79], a[232:235], a[136:139], v[76:79]
    v_exp_f32 v129, v65
    v_mfma_f32_16x16x32_bf16 v[76:79], a[236:239], a[140:143], v[76:79]
    buffer_load_dwordx4 v9, s[4:7], s20 offen lds
    v_mfma_f32_16x16x32_bf16 v[84:87], a[216:219], a[144:147], 0
    v_exp_f32 v131, v67
    v_mfma_f32_16x16x32_bf16 v[84:87], a[220:223], a[148:151], v[84:87]
    s_add_u32 s20, s20, 12032
    ds_read_b64_tr_b16 a[204:205], v6 offset:0
    v_cvt_pk_bf16_f32 v113, v130, v131
    v_mfma_f32_16x16x32_bf16 v[84:87], a[224:227], a[152:155], v[84:87]
    ds_read_b64_tr_b16 a[206:207], v6 offset:6144
    v_exp_f32 v133, v73
    v_mfma_f32_16x16x32_bf16 v[84:87], a[228:231], a[156:159], v[84:87]
    ds_read_b64_tr_b16 a[208:209], v3 offset:1024
    v_cvt_pk_bf16_f32 v116, v132, v133
    v_mfma_f32_16x16x32_bf16 v[84:87], a[232:235], a[160:163], v[84:87]
    ds_read_b64_tr_b16 a[210:211], v3 offset:7168
    ds_read_b64_tr_b16 a[212:213], v4 offset:1024
    v_mfma_f32_16x16x32_bf16 v[84:87], a[236:239], a[164:167], v[84:87]
    ds_read_b64_tr_b16 a[214:215], v4 offset:7168
    v_cvt_pk_bf16_f32 v112, v128, v129
    s_waitcnt lgkmcnt(10)
    v_mfma_f32_16x16x32_bf16 v[160:163], a[192:195], v[96:99], v[160:163]
    ds_read_b64_tr_b16 a[228:229], v4 offset:2048
    v_fma_f32 v76, v76, s28, v17
    v_mfma_f32_16x16x32_bf16 v[208:211], a[192:195], v[100:103], v[208:211]
    s_nop 0
    v_fma_f32 v86, v86, s28, v18
    v_fma_f32 v69, v69, s28, v16
    v_mfma_f32_16x16x32_bf16 a[0:3], a[192:195], v[104:107], a[0:3]
    ds_read_b64_tr_b16 a[218:219], v5 offset:7168
    s_waitcnt lgkmcnt(10)
    v_mfma_f32_16x16x32_bf16 v[164:167], a[196:199], v[96:99], v[164:167]
    ds_read_b64_tr_b16 a[216:217], v5 offset:1024
    ds_read_b64_tr_b16 a[222:223], v6 offset:7168
    v_mfma_f32_16x16x32_bf16 v[212:215], a[196:199], v[100:103], v[212:215]
    v_exp_f32 v135, v69
    v_mfma_f32_16x16x32_bf16 a[4:7], a[196:199], v[104:107], a[4:7]
    ds_read_b128 v[136:139], v13 offset:0
    s_waitcnt lgkmcnt(11)
    v_mfma_f32_16x16x32_bf16 v[168:171], a[200:203], v[96:99], v[168:171]
    ds_read_b64_tr_b16 a[230:231], v4 offset:8192
    v_fma_f32 v70, v70, s28, v16
    v_mfma_f32_16x16x32_bf16 v[216:219], a[200:203], v[100:103], v[216:219]
    ds_read_b64_tr_b16 a[238:239], v6 offset:8192
    ds_read_b64_tr_b16 a[220:221], v6 offset:1024
    v_mfma_f32_16x16x32_bf16 a[8:11], a[200:203], v[104:107], a[8:11]
    s_waitcnt lgkmcnt(11)
    ds_read_b64_tr_b16 a[232:233], v5 offset:2048
    ds_read_b64_tr_b16 a[226:227], v3 offset:8192
    v_mfma_f32_16x16x32_bf16 v[172:175], a[204:207], v[96:99], v[172:175]
    ds_read_b64_tr_b16 a[234:235], v5 offset:8192
    ds_read_b64_tr_b16 a[236:237], v6 offset:2048
    v_mfma_f32_16x16x32_bf16 v[220:223], a[204:207], v[100:103], v[220:223]
    ds_read_b64_tr_b16 a[224:225], v3 offset:2048
    v_fma_f32 v68, v68, s28, v16
    v_mfma_f32_16x16x32_bf16 a[12:15], a[204:207], v[104:107], a[12:15]
    s_waitcnt lgkmcnt(12)
    ds_read_b128 v[140:143], v13 offset:1024
    v_fma_f32 v78, v78, s28, v17
    v_mfma_f32_16x16x32_bf16 v[176:179], a[208:211], v[96:99], v[176:179]
    v_exp_f32 v134, v68
    v_mfma_f32_16x16x32_bf16 v[224:227], a[208:211], v[100:103], v[224:227]
    v_fma_f32 v71, v71, s28, v16
    v_fma_f32 v87, v87, s28, v18
    v_mfma_f32_16x16x32_bf16 a[16:19], a[208:211], v[104:107], a[16:19]
    v_exp_f32 v128, v70
    v_mfma_f32_16x16x32_bf16 v[180:183], a[212:215], v[96:99], v[180:183]
    v_exp_f32 v129, v71
    v_mfma_f32_16x16x32_bf16 v[228:231], a[212:215], v[100:103], v[228:231]
    v_cvt_pk_bf16_f32 v115, v128, v129
    v_mfma_f32_16x16x32_bf16 a[20:23], a[212:215], v[104:107], a[20:23]
    s_waitcnt lgkmcnt(6)
    v_fma_f32 v81, v81, s28, v18
    v_cvt_pk_bf16_f32 v114, v134, v135
    v_mfma_f32_16x16x32_bf16 v[184:187], a[216:219], v[96:99], v[184:187]
    v_exp_f32 v132, v76
    v_mfma_f32_16x16x32_bf16 v[232:235], a[216:219], v[100:103], v[232:235]
    buffer_store_dwordx4 v[136:139], v12, s[16:19], s24 offen offset:0 sc0 sc1 nt
    v_fma_f32 v80, v80, s28, v18
    v_exp_f32 v134, v78
    v_mfma_f32_16x16x32_bf16 v[24:27], a[240:243], v[112:115], v[20:23]
    s_waitcnt vmcnt(7) lgkmcnt(0)
    v_fma_f32 v83, v83, s28, v18
    v_fma_f32 v74, v74, s28, v17
    v_mfma_f32_16x16x32_bf16 a[24:27], a[216:219], v[104:107], a[24:27]
    s_barrier
    v_mfma_f32_16x16x32_bf16 v[188:191], a[220:223], v[96:99], v[188:191]
    ds_read_b128 a[208:211], v1 offset:2048
    v_fma_f32 v82, v82, s28, v18
    v_mfma_f32_16x16x32_bf16 v[236:239], a[220:223], v[100:103], v[236:239]
    s_add_u32 m0, s22, 24576
    ds_read_b128 a[204:207], v2 offset:1024
    v_fma_f32 v77, v77, s28, v17
    v_mfma_f32_16x16x32_bf16 a[28:31], a[220:223], v[104:107], a[28:31]
    buffer_load_dwordx4 v9, s[8:11], s21 offen lds
    v_mfma_f32_16x16x32_bf16 v[192:195], a[224:227], v[96:99], v[192:195]
    ds_read_b128 a[196:199], v2 offset:0
    v_mfma_f32_16x16x32_bf16 v[240:243], a[224:227], v[100:103], v[240:243]
    v_exp_f32 v129, v81
    v_mfma_f32_16x16x32_bf16 a[32:35], a[224:227], v[104:107], a[32:35]
    s_add_u32 s21, s21, 128
    ds_read_b128 a[192:195], v1 offset:0
    v_fma_f32 v75, v75, s28, v17
    v_mfma_f32_16x16x32_bf16 v[196:199], a[228:231], v[96:99], v[196:199]
    s_add_u32 m0, s22, 25600
    ds_read_b128 a[212:215], v2 offset:2048
    v_fma_f32 v79, v79, s28, v17
    v_mfma_f32_16x16x32_bf16 v[244:247], a[228:231], v[100:103], v[244:247]
    ds_read_b128 a[200:203], v1 offset:1024
    v_fma_f32 v85, v85, s28, v18
    v_mfma_f32_16x16x32_bf16 a[36:39], a[228:231], v[104:107], a[36:39]
    buffer_load_dwordx4 v9, s[8:11], s21 offen lds
    v_mfma_f32_16x16x32_bf16 v[200:203], a[232:235], v[96:99], v[200:203]
    v_exp_f32 v130, v74
    v_mfma_f32_16x16x32_bf16 v[248:251], a[232:235], v[100:103], v[248:251]
    buffer_store_dwordx4 v[140:143], v12, s[16:19], s24 offen offset:3072 sc0 sc1 nt
    s_add_u32 s21, s21, 128
    s_add_u32 m0, s22, 26624
    ds_read_b128 a[220:223], v2 offset:6144
    v_exp_f32 v131, v75
    v_mfma_f32_16x16x32_bf16 a[40:43], a[232:235], v[104:107], a[40:43]
    ds_read_b128 a[224:227], v1 offset:7168
    v_cvt_pk_bf16_f32 v117, v130, v131
    v_mfma_f32_16x16x32_bf16 v[204:207], a[236:239], v[96:99], v[204:207]
    buffer_load_dwordx4 v9, s[8:11], s21 offen lds
    v_mfma_f32_16x16x32_bf16 v[252:255], a[236:239], v[100:103], v[252:255]
    s_add_u32 s21, s21, 12032
    v_exp_f32 v133, v77
    v_mfma_f32_16x16x32_bf16 a[44:47], a[236:239], v[104:107], a[44:47]
    s_waitcnt lgkmcnt(4)
    v_exp_f32 v135, v79
    v_mfma_f32_16x16x32_bf16 v[32:35], a[192:195], a[96:99], 0
    s_add_u32 m0, s23, 0
    v_cvt_pk_bf16_f32 v118, v132, v133
    v_mfma_f32_16x16x32_bf16 v[32:35], a[196:199], a[100:103], v[32:35]
    s_waitcnt lgkmcnt(2)
    ds_read_b128 a[228:231], v2 offset:7168
    v_cvt_pk_bf16_f32 v119, v134, v135
    v_mfma_f32_16x16x32_bf16 v[32:35], a[200:203], a[104:107], v[32:35]
    buffer_load_dwordx4 v10, s[12:15], s25 offen nt lds
    v_mfma_f32_16x16x32_bf16 v[32:35], a[204:207], a[108:111], v[32:35]
    v_exp_f32 v128, v80
    v_mfma_f32_16x16x32_bf16 v[32:35], a[208:211], a[112:115], v[32:35]
    s_add_u32 m0, s23, 1024
    v_exp_f32 v134, v86
    v_mfma_f32_16x16x32_bf16 v[32:35], a[212:215], a[116:119], v[32:35]
    ds_read_b128 a[232:235], v1 offset:8192
    v_cvt_pk_bf16_f32 v120, v128, v129
    v_mfma_f32_16x16x32_bf16 v[40:43], a[192:195], a[120:123], 0
    ds_read_b128 a[216:219], v1 offset:6144
    v_fma_f32 v84, v84, s28, v18
    v_mfma_f32_16x16x32_bf16 v[40:43], a[196:199], a[124:127], v[40:43]
    ds_read_b128 a[236:239], v2 offset:8192
    v_mfma_f32_16x16x32_bf16 v[40:43], a[200:203], a[128:131], v[40:43]
    v_exp_f32 v132, v84
    v_mfma_f32_16x16x32_bf16 v[40:43], a[204:207], a[132:135], v[40:43]
    buffer_load_dwordx4 v11, s[12:15], s25 offen nt lds
    v_mfma_f32_16x16x32_bf16 v[40:43], a[208:211], a[136:139], v[40:43]
    s_bitcmp1_b32 s30, 0
    v_exp_f32 v131, v83
    v_mfma_f32_16x16x32_bf16 v[40:43], a[212:215], a[140:143], v[40:43]
    s_cselect_b32 s26, s49, 128
    v_exp_f32 v133, v85
    v_mfma_f32_16x16x32_bf16 v[48:51], a[192:195], a[144:147], 0
    s_cselect_b32 s27, s39, 2048
    s_add_u32 s24, s24, s26
    v_cvt_pk_bf16_f32 v122, v132, v133
    v_mfma_f32_16x16x32_bf16 v[48:51], a[196:199], a[148:151], v[48:51]
    v_exp_f32 v130, v82
    v_mfma_f32_16x16x32_bf16 v[48:51], a[200:203], a[152:155], v[48:51]
    v_exp_f32 v135, v87
    v_mfma_f32_16x16x32_bf16 v[48:51], a[204:207], a[156:159], v[48:51]
    s_add_u32 s25, s25, s26
    v_cvt_pk_bf16_f32 v121, v130, v131
    v_cvt_pk_bf16_f32 v123, v134, v135
    v_mfma_f32_16x16x32_bf16 v[48:51], a[208:211], a[160:163], v[48:51]
    s_add_u32 s23, s23, s27
    v_mfma_f32_16x16x32_bf16 v[24:27], a[244:247], v[116:119], v[24:27]
    s_waitcnt vmcnt(10) lgkmcnt(0)
    v_mfma_f32_16x16x32_bf16 v[24:27], a[248:251], v[120:123], v[24:27]
    s_barrier
    v_mfma_f32_16x16x32_bf16 v[48:51], a[212:215], a[164:167], v[48:51]
    s_add_u32 m0, s22, 0
    ds_read_b64_tr_b16 a[192:193], v3 offset:12288
    buffer_load_dwordx4 v9, s[4:7], s20 offen lds
    v_mfma_f32_16x16x32_bf16 v[36:39], a[216:219], a[96:99], 0
    s_add_u32 s20, s20, 128
    ds_read_b64_tr_b16 a[194:195], v3 offset:18432
    v_cmp_lt_f32 vcc, s29, v24
    v_mfma_f32_16x16x32_bf16 v[36:39], a[220:223], a[100:103], v[36:39]
    ds_read_b64_tr_b16 a[196:197], v4 offset:12288
    ds_read_b64_tr_b16 a[198:199], v4 offset:18432
    ds_read_b64_tr_b16 a[200:201], v5 offset:12288
    v_mfma_f32_16x16x32_bf16 v[36:39], a[224:227], a[104:107], v[36:39]
    s_cbranch_vccnz L_rs_loop3w0b
L_ret_loop3w0b:
    v_fma_f32 v32, v32, s28, v16
    v_mfma_f32_16x16x32_bf16 v[36:39], a[228:231], a[108:111], v[36:39]
    ds_read_b64_tr_b16 a[202:203], v5 offset:18432
    v_fma_f32 v41, v41, s28, v17
    v_mfma_f32_16x16x32_bf16 v[36:39], a[232:235], a[112:115], v[36:39]
    v_fma_f32 v34, v34, s28, v16
    v_fma_f32 v40, v40, s28, v17
    v_mfma_f32_16x16x32_bf16 v[36:39], a[236:239], a[116:119], v[36:39]
    v_exp_f32 v130, v34
    v_mfma_f32_16x16x32_bf16 v[44:47], a[216:219], a[120:123], 0
    s_add_u32 m0, s22, 1024
    ds_read_b64_tr_b16 a[204:205], v6 offset:12288
    ds_read_b64_tr_b16 a[206:207], v6 offset:18432
    v_mfma_f32_16x16x32_bf16 v[44:47], a[220:223], a[124:127], v[44:47]
    buffer_load_dwordx4 v9, s[4:7], s20 offen lds
    v_mfma_f32_16x16x32_bf16 v[44:47], a[224:227], a[128:131], v[44:47]
    ds_read_b64_tr_b16 a[208:209], v3 offset:13312
    v_fma_f32 v33, v33, s28, v16
    v_mfma_f32_16x16x32_bf16 v[44:47], a[228:231], a[132:135], v[44:47]
    v_exp_f32 v133, v41
    v_mfma_f32_16x16x32_bf16 v[44:47], a[232:235], a[136:139], v[44:47]
    ds_read_b64_tr_b16 a[210:211], v3 offset:19456
    v_fma_f32 v35, v35, s28, v16
    v_mfma_f32_16x16x32_bf16 v[44:47], a[236:239], a[140:143], v[44:47]
    s_add_u32 s20, s20, 128
    v_exp_f32 v129, v33
    v_mfma_f32_16x16x32_bf16 v[52:55], a[216:219], a[144:147], 0
    s_add_u32 m0, s22, 2048
    v_exp_f32 v128, v32
    v_mfma_f32_16x16x32_bf16 v[52:55], a[220:223], a[148:151], v[52:55]
    buffer_load_dwordx4 v9, s[4:7], s20 offen lds
    v_add_u32 v13, s27, v13
    v_mfma_f32_16x16x32_bf16 v[52:55], a[224:227], a[152:155], v[52:55]
    v_exp_f32 v131, v35
    v_mfma_f32_16x16x32_bf16 v[52:55], a[228:231], a[156:159], v[52:55]
    s_add_u32 s20, s20, 12032
    v_cvt_pk_bf16_f32 v97, v130, v131
    v_exp_f32 v132, v40
    v_mfma_f32_16x16x32_bf16 v[52:55], a[232:235], a[160:163], v[52:55]
    s_add_u32 s30, s30, 1
    ds_read_b64_tr_b16 a[212:213], v4 offset:13312
    ds_read_b64_tr_b16 a[214:215], v4 offset:19456
    v_mfma_f32_16x16x32_bf16 v[52:55], a[236:239], a[164:167], v[52:55]
    s_cmp_lt_u32 s30, 6
    v_cvt_pk_bf16_f32 v96, v128, v129
    v_cvt_pk_bf16_f32 v100, v132, v133
    s_cbranch_scc1 L_loop3w0
    s_cmp_ge_u32 s37, 8
    s_cbranch_scc1 L_end3
    s_cmp_eq_u32 s32, 0
    s_cbranch_scc1 L_tr33
    s_branch L_tr34
    .p2align 6
L_loop3w1:
    s_waitcnt lgkmcnt(10)
    v_mfma_f32_16x16x32_bf16 v[160:163], a[192:195], v[112:115], v[160:163]
    ds_read_b64_tr_b16 a[232:233], v5 offset:14336
    ds_read_b64_tr_b16 a[228:229], v4 offset:14336
    v_mfma_f32_16x16x32_bf16 v[208:211], a[192:195], v[116:119], v[208:211]
    ds_read_b64_tr_b16 a[230:231], v4 offset:20480
    ds_read_b64_tr_b16 a[226:227], v3 offset:20480
    v_mfma_f32_16x16x32_bf16 a[0:3], a[192:195], v[120:123], a[0:3]
    ds_read_b64_tr_b16 a[236:237], v6 offset:14336
    s_waitcnt lgkmcnt(13)
    v_mfma_f32_16x16x32_bf16 v[164:167], a[196:199], v[112:115], v[164:167]
    ds_read_b64_tr_b16 a[238:239], v6 offset:20480
    ds_read_b64_tr_b16 a[220:221], v6 offset:13312
    v_mfma_f32_16x16x32_bf16 v[212:215], a[196:199], v[116:119], v[212:215]
    ds_read_b64_tr_b16 a[234:235], v5 offset:20480
    ds_read_b64_tr_b16 a[222:223], v6 offset:19456
    v_mfma_f32_16x16x32_bf16 a[4:7], a[196:199], v[120:123], a[4:7]
    ds_read_b64_tr_b16 a[216:217], v5 offset:13312
    s_waitcnt lgkmcnt(15)
    v_mfma_f32_16x16x32_bf16 v[168:171], a[200:203], v[112:115], v[168:171]
    ds_read_b64_tr_b16 a[218:219], v5 offset:19456
    v_fma_f32 v36, v36, s28, v16
    v_mfma_f32_16x16x32_bf16 v[216:219], a[200:203], v[116:119], v[216:219]
    ds_read_b64_tr_b16 a[224:225], v3 offset:14336
    v_fma_f32 v44, v44, s28, v17
    v_mfma_f32_16x16x32_bf16 a[8:11], a[200:203], v[120:123], a[8:11]
    s_waitcnt lgkmcnt(15)
    v_fma_f32 v49, v49, s28, v18
    v_fma_f32 v42, v42, s28, v17
    v_mfma_f32_16x16x32_bf16 v[172:175], a[204:207], v[112:115], v[172:175]
    v_fma_f32 v37, v37, s28, v16
    v_fma_f32 v45, v45, s28, v17
    v_mfma_f32_16x16x32_bf16 v[220:223], a[204:207], v[116:119], v[220:223]
    v_exp_f32 v133, v45
    v_mfma_f32_16x16x32_bf16 a[12:15], a[204:207], v[120:123], a[12:15]
    s_waitcnt lgkmcnt(8)
    v_fma_f32 v47, v47, s28, v17
    v_fma_f32 v54, v54, s28, v18
    v_mfma_f32_16x16x32_bf16 v[176:179], a[208:211], v[112:115], v[176:179]
    v_fma_f32 v39, v39, s28, v16
    v_fma_f32 v52, v52, s28, v18
    v_mfma_f32_16x16x32_bf16 v[224:227], a[208:211], v[116:119], v[224:227]
    v_exp_f32 v135, v37
    v_mfma_f32_16x16x32_bf16 a[16:19], a[208:211], v[120:123], a[16:19]
    v_exp_f32 v129, v39
    v_mfma_f32_16x16x32_bf16 v[180:183], a[212:215], v[112:115], v[180:183]
    v_exp_f32 v132, v44
    v_mfma_f32_16x16x32_bf16 v[228:231], a[212:215], v[116:119], v[228:231]
    v_exp_f32 v130, v42
    v_mfma_f32_16x16x32_bf16 a[20:23], a[212:215], v[120:123], a[20:23]
    s_waitcnt vmcnt(10) lgkmcnt(0)
    v_exp_f32 v134, v36
    v_mfma_f32_16x16x32_bf16 v[184:187], a[216:219], v[112:115], v[184:187]
    v_cvt_pk_bf16_f32 v98, v134, v135
    v_fma_f32 v55, v55, s28, v18
    v_mfma_f32_16x16x32_bf16 v[232:235], a[216:219], v[116:119], v[232:235]
    s_barrier
    v_mfma_f32_16x16x32_bf16 a[24:27], a[216:219], v[120:123], a[24:27]
    s_add_u32 m0, s22, 36864
    v_fma_f32 v50, v50, s28, v18
    v_fma_f32 v51, v51, s28, v18
    v_mfma_f32_16x16x32_bf16 v[188:191], a[220:223], v[112:115], v[188:191]
    ds_read_b128 a[192:195], v1 offset:12288
    v_fma_f32 v43, v43, s28, v17
    v_mfma_f32_16x16x32_bf16 v[236:239], a[220:223], v[116:119], v[236:239]
    ds_read_b128 a[196:199], v2 offset:12288
    v_fma_f32 v38, v38, s28, v16
    v_mfma_f32_16x16x32_bf16 a[28:31], a[220:223], v[120:123], a[28:31]
    buffer_load_dwordx4 v9, s[8:11], s21 offen lds
    v_mfma_f32_16x16x32_bf16 v[192:195], a[224:227], v[112:115], v[192:195]
    v_exp_f32 v135, v47
    v_mfma_f32_16x16x32_bf16 v[240:243], a[224:227], v[116:119], v[240:243]
    s_add_u32 s21, s21, 128
    v_exp_f32 v131, v43
    v_mfma_f32_16x16x32_bf16 a[32:35], a[224:227], v[120:123], a[32:35]
    v_exp_f32 v128, v38
    v_mfma_f32_16x16x32_bf16 v[196:199], a[228:231], v[112:115], v[196:199]
    s_add_u32 m0, s22, 37888
    ds_read_b128 a[200:203], v1 offset:13312
    v_mfma_f32_16x16x32_bf16 v[244:247], a[228:231], v[116:119], v[244:247]
    ds_read_b128 a[208:211], v1 offset:14336
    v_cvt_pk_bf16_f32 v101, v130, v131
    v_mfma_f32_16x16x32_bf16 a[36:39], a[228:231], v[120:123], a[36:39]
    ds_read_b128 a[204:207], v2 offset:13312
    v_cvt_pk_bf16_f32 v102, v132, v133
    v_mfma_f32_16x16x32_bf16 v[200:203], a[232:235], v[112:115], v[200:203]
    buffer_load_dwordx4 v9, s[8:11], s21 offen lds
    v_mfma_f32_16x16x32_bf16 v[248:251], a[232:235], v[116:119], v[248:251]
    ds_read_b128 a[212:215], v2 offset:14336
    v_fma_f32 v46, v46, s28, v17
    v_mfma_f32_16x16x32_bf16 a[40:43], a[232:235], v[120:123], a[40:43]
    ds_read_b128 a[220:223], v2 offset:18432
    v_fma_f32 v53, v53, s28, v18
    v_mfma_f32_16x16x32_bf16 v[204:207], a[236:239], v[112:115], v[204:207]
    ds_read_b128 a[216:219], v1 offset:18432
    v_cvt_pk_bf16_f32 v99, v128, v129
    v_mfma_f32_16x16x32_bf16 v[252:255], a[236:239], v[116:119], v[252:255]
    ds_read_b128 a[228:231], v2 offset:19456
    v_mfma_f32_16x16x32_bf16 a[44:47], a[236:239], v[120:123], a[44:47]
    s_waitcnt lgkmcnt(7)
    ds_read_b128 a[232:235], v1 offset:20480
    v_fma_f32 v48, v48, s28, v18
    v_mfma_f32_16x16x32_bf16 v[64:67], a[192:195], a[96:99], 0
    s_add_u32 s21, s21, 128
    v_exp_f32 v134, v46
    v_mfma_f32_16x16x32_bf16 v[64:67], a[196:199], a[100:103], v[64:67]
    s_add_u32 m0, s22, 38912
    v_cvt_pk_bf16_f32 v103, v134, v135
    s_waitcnt lgkmcnt(7)
    v_mfma_f32_16x16x32_bf16 v[64:67], a[200:203], a[104:107], v[64:67]
    buffer_load_dwordx4 v9, s[8:11], s21 offen lds
    v_mfma_f32_16x16x32_bf16 v[20:23], a[240:243], v[96:99], v[24:27]
    s_waitcnt lgkmcnt(5)
    ds_read_b128 a[224:227], v1 offset:19456
    v_mfma_f32_16x16x32_bf16 v[64:67], a[204:207], a[108:111], v[64:67]
    v_exp_f32 v133, v53
    v_mfma_f32_16x16x32_bf16 v[64:67], a[208:211], a[112:115], v[64:67]
    s_waitcnt lgkmcnt(5)
    v_exp_f32 v128, v48
    v_mfma_f32_16x16x32_bf16 v[64:67], a[212:215], a[116:119], v[64:67]
    ds_read_b128 a[236:239], v2 offset:20480
    v_mfma_f32_16x16x32_bf16 v[72:75], a[192:195], a[120:123], 0
    v_exp_f32 v130, v50
    v_mfma_f32_16x16x32_bf16 v[72:75], a[196:199], a[124:127], v[72:75]
    v_exp_f32 v131, v51
    v_mfma_f32_16x16x32_bf16 v[20:23], a[244:247], v[100:103], v[20:23]
    v_exp_f32 v129, v49
    v_mfma_f32_16x16x32_bf16 v[72:75], a[200:203], a[128:131], v[72:75]
    v_exp_f32 v132, v52
    v_mfma_f32_16x16x32_bf16 v[72:75], a[204:207], a[132:135], v[72:75]
    v_exp_f32 v135, v55
    v_mfma_f32_16x16x32_bf16 v[72:75], a[208:211], a[136:139], v[72:75]
    v_cvt_pk_bf16_f32 v104, v128, v129
    v_cvt_pk_bf16_f32 v106, v132, v133
    v_mfma_f32_16x16x32_bf16 v[72:75], a[212:215], a[140:143], v[72:75]
    v_exp_f32 v134, v54
    v_mfma_f32_16x16x32_bf16 v[80:83], a[192:195], a[144:147], 0
    v_cvt_pk_bf16_f32 v105, v130, v131
    v_mfma_f32_16x16x32_bf16 v[80:83], a[196:199], a[148:151], v[80:83]
    s_add_u32 s21, s21, 12032
    v_cvt_pk_bf16_f32 v107, v134, v135
    v_mfma_f32_16x16x32_bf16 v[80:83], a[200:203], a[152:155], v[80:83]
    s_waitcnt vmcnt(9) lgkmcnt(0)
    s_add_u32 m0, s22, 12288
    v_mfma_f32_16x16x32_bf16 v[20:23], a[248:251], v[104:107], v[20:23]
    s_barrier
    v_mfma_f32_16x16x32_bf16 v[80:83], a[204:207], a[156:159], v[80:83]
    buffer_load_dwordx4 v9, s[4:7], s20 offen lds
    v_mfma_f32_16x16x32_bf16 v[80:83], a[208:211], a[160:163], v[80:83]
    ds_read_b64_tr_b16 a[192:193], v3 offset:0
    ds_read_b64_tr_b16 a[194:195], v3 offset:6144
    v_mfma_f32_16x16x32_bf16 v[80:83], a[212:215], a[164:167], v[80:83]
    s_add_u32 s20, s20, 128
    ds_read_b64_tr_b16 a[196:197], v4 offset:0
    v_cmp_lt_f32 vcc, s29, v20
    v_mfma_f32_16x16x32_bf16 v[68:71], a[216:219], a[96:99], 0
    ds_read_b64_tr_b16 a[198:199], v4 offset:6144
    ds_read_b64_tr_b16 a[200:201], v5 offset:0
    v_mfma_f32_16x16x32_bf16 v[68:71], a[220:223], a[100:103], v[68:71]
    ds_read_b64_tr_b16 a[202:203], v5 offset:6144
    ds_read_b64_tr_b16 a[204:205], v6 offset:0
    v_mfma_f32_16x16x32_bf16 v[68:71], a[224:227], a[104:107], v[68:71]
    s_cbranch_vccnz L_rs_loop3w1a
L_ret_loop3w1a:
    v_fma_f32 v73, v73, s28, v17
    v_mfma_f32_16x16x32_bf16 v[68:71], a[228:231], a[108:111], v[68:71]
    v_fma_f32 v65, v65, s28, v16
    v_fma_f32 v64, v64, s28, v16
    v_mfma_f32_16x16x32_bf16 v[68:71], a[232:235], a[112:115], v[68:71]
    s_add_u32 m0, s22, 13312
    v_exp_f32 v129, v65
    v_mfma_f32_16x16x32_bf16 v[68:71], a[236:239], a[116:119], v[68:71]
    v_fma_f32 v67, v67, s28, v16
    v_fma_f32 v66, v66, s28, v16
    v_mfma_f32_16x16x32_bf16 v[76:79], a[216:219], a[120:123], 0
    ds_read_b64_tr_b16 a[206:207], v6 offset:6144
    ds_read_b64_tr_b16 a[208:209], v3 offset:1024
    v_mfma_f32_16x16x32_bf16 v[76:79], a[220:223], a[124:127], v[76:79]
    v_exp_f32 v131, v67
    v_mfma_f32_16x16x32_bf16 v[76:79], a[224:227], a[128:131], v[76:79]
    buffer_load_dwordx4 v9, s[4:7], s20 offen lds
    v_mfma_f32_16x16x32_bf16 v[76:79], a[228:231], a[132:135], v[76:79]
    s_add_u32 s20, s20, 128
    v_exp_f32 v128, v64
    v_mfma_f32_16x16x32_bf16 v[76:79], a[232:235], a[136:139], v[76:79]
    v_exp_f32 v130, v66
    v_mfma_f32_16x16x32_bf16 v[76:79], a[236:239], a[140:143], v[76:79]
    s_add_u32 m0, s22, 14336
    v_fma_f32 v72, v72, s28, v17
    v_cvt_pk_bf16_f32 v113, v130, v131
    v_mfma_f32_16x16x32_bf16 v[84:87], a[216:219], a[144:147], 0
    ds_read_b64_tr_b16 a[210:211], v3 offset:7168
    v_mfma_f32_16x16x32_bf16 v[84:87], a[220:223], a[148:151], v[84:87]
    v_exp_f32 v133, v73
    v_mfma_f32_16x16x32_bf16 v[84:87], a[224:227], a[152:155], v[84:87]
    buffer_load_dwordx4 v9, s[4:7], s20 offen lds
    v_mfma_f32_16x16x32_bf16 v[84:87], a[228:231], a[156:159], v[84:87]
    ds_read_b64_tr_b16 a[212:213], v4 offset:1024
    ds_read_b64_tr_b16 a[214:215], v4 offset:7168
    v_mfma_f32_16x16x32_bf16 v[84:87], a[232:235], a[160:163], v[84:87]
    v_exp_f32 v132, v72
    v_mfma_f32_16x16x32_bf16 v[84:87], a[236:239], a[164:167], v[84:87]
    s_add_u32 s20, s20, 12032
    v_cvt_pk_bf16_f32 v116, v132, v133
    v_cvt_pk_bf16_f32 v112, v128, v129
    ds_read_b128 v[136:139], v13 offset:0
    s_waitcnt lgkmcnt(11)
    v_mfma_f32_16x16x32_bf16 v[160:163], a[192:195], v[96:99], v[160:163]
    ds_read_b64_tr_b16 a[222:223], v6 offset:7168
    ds_read_b64_tr_b16 a[232:233], v5 offset:2048
    v_fma_f32 v80, v80, s28, v18
    v_fma_f32 v69, v69, s28, v16
    v_mfma_f32_16x16x32_bf16 v[208:211], a[192:195], v[100:103], v[208:211]
    ds_read_b64_tr_b16 a[236:237], v6 offset:2048
    v_fma_f32 v77, v77, s28, v17
    v_mfma_f32_16x16x32_bf16 a[0:3], a[192:195], v[104:107], a[0:3]
    s_waitcnt lgkmcnt(12)
    ds_read_b64_tr_b16 a[230:231], v4 offset:8192
    ds_read_b64_tr_b16 a[228:229], v4 offset:2048
    v_mfma_f32_16x16x32_bf16 v[164:167], a[196:199], v[96:99], v[164:167]
    ds_read_b64_tr_b16 a[216:217], v5 offset:1024
    v_fma_f32 v84, v84, s28, v18
    v_fma_f32 v70, v70, s28, v16
    v_mfma_f32_16x16x32_bf16 v[212:215], a[196:199], v[100:103], v[212:215]
    ds_read_b64_tr_b16 a[238:239], v6 offset:8192
    v_fma_f32 v79, v79, s28, v17
    v_mfma_f32_16x16x32_bf16 a[4:7], a[196:199], v[104:107], a[4:7]
    s_waitcnt lgkmcnt(14)
    v_exp_f32 v133, v77
    v_mfma_f32_16x16x32_bf16 v[168:171], a[200:203], v[96:99], v[168:171]
    v_exp_f32 v128, v70
    v_mfma_f32_16x16x32_bf16 v[216:219], a[200:203], v[100:103], v[216:219]
    ds_read_b64_tr_b16 a[218:219], v5 offset:7168
    v_fma_f32 v74, v74, s28, v17
    v_mfma_f32_16x16x32_bf16 a[8:11], a[200:203], v[104:107], a[8:11]
    s_waitcnt lgkmcnt(8)
    ds_read_b64_tr_b16 a[224:225], v3 offset:2048
    ds_read_b64_tr_b16 a[220:221], v6 offset:1024
    v_mfma_f32_16x16x32_bf16 v[172:175], a[204:207], v[96:99], v[172:175]
    ds_read_b64_tr_b16 a[226:227], v3 offset:8192
    v_fma_f32 v83, v83, s28, v18
    v_mfma_f32_16x16x32_bf16 v[220:223], a[204:207], v[100:103], v[220:223]
    ds_read_b64_tr_b16 a[234:235], v5 offset:8192
    ds_read_b128 v[140:143], v13 offset:1024
    v_mfma_f32_16x16x32_bf16 a[12:15], a[204:207], v[104:107], a[12:15]
    v_fma_f32 v71, v71, s28, v16
    v_fma_f32 v68, v68, s28, v16
    v_exp_f32 v134, v68
    v_mfma_f32_16x16x32_bf16 v[176:179], a[208:211], v[96:99], v[176:179]
    v_exp_f32 v135, v69
    v_mfma_f32_16x16x32_bf16 v[224:227], a[208:211], v[100:103], v[224:227]
    v_fma_f32 v75, v75, s28, v17
    v_exp_f32 v129, v71
    v_mfma_f32_16x16x32_bf16 a[16:19], a[208:211], v[104:107], a[16:19]
    v_exp_f32 v130, v74
    v_mfma_f32_16x16x32_bf16 v[180:183], a[212:215], v[96:99], v[180:183]
    buffer_store_dwordx4 v[136:139], v12, s[16:19], s24 offen offset:0 sc0 sc1 nt
    v_exp_f32 v131, v75
    v_cvt_pk_bf16_f32 v115, v128, v129
    v_cvt_pk_bf16_f32 v114, v134, v135
    v_mfma_f32_16x16x32_bf16 v[228:231], a[212:215], v[100:103], v[228:231]
    v_fma_f32 v85, v85, s28, v18
    v_fma_f32 v78, v78, s28, v17
    v_mfma_f32_16x16x32_bf16 a[20:23], a[212:215], v[104:107], a[20:23]
    s_waitcnt lgkmcnt(2)
    v_exp_f32 v135, v79
    v_mfma_f32_16x16x32_bf16 v[184:187], a[216:219], v[96:99], v[184:187]
    s_waitcnt vmcnt(7) lgkmcnt(0)
    v_exp_f32 v128, v80
    v_mfma_f32_16x16x32_bf16 v[24:27], a[240:243], v[112:115], v[20:23]
    s_barrier
    ds_read_b128 a[208:211], v1 offset:2048
    v_mfma_f32_16x16x32_bf16 v[232:235], a[216:219], v[100:103], v[232:235]
    v_exp_f32 v134, v78
    v_mfma_f32_16x16x32_bf16 a[24:27], a[216:219], v[104:107], a[24:27]
    ds_read_b128 a[196:199], v2 offset:0
    v_fma_f32 v76, v76, s28, v17
    v_mfma_f32_16x16x32_bf16 v[188:191], a[220:223], v[96:99], v[188:191]
    ds_read_b128 a[192:195], v1 offset:0
    v_cvt_pk_bf16_f32 v117, v130, v131
    v_mfma_f32_16x16x32_bf16 v[236:239], a[220:223], v[100:103], v[236:239]
    v_fma_f32 v87, v87, s28, v18
    v_fma_f32 v82, v82, s28, v18
    v_mfma_f32_16x16x32_bf16 a[28:31], a[220:223], v[104:107], a[28:31]
    s_add_u32 m0, s22, 24576
    ds_read_b128 a[200:203], v1 offset:1024
    v_cvt_pk_bf16_f32 v119, v134, v135
    v_mfma_f32_16x16x32_bf16 v[192:195], a[224:227], v[96:99], v[192:195]
    buffer_load_dwordx4 v9, s[8:11], s21 offen lds
    v_mfma_f32_16x16x32_bf16 v[240:243], a[224:227], v[100:103], v[240:243]
    s_add_u32 s21, s21, 128
    v_exp_f32 v135, v87
    v_mfma_f32_16x16x32_bf16 a[32:35], a[224:227], v[104:107], a[32:35]
    v_exp_f32 v132, v76
    v_mfma_f32_16x16x32_bf16 v[196:199], a[228:231], v[96:99], v[196:199]
    s_add_u32 m0, s22, 25600
    ds_read_b128 a[204:207], v2 offset:1024
    v_fma_f32 v81, v81, s28, v18
    v_mfma_f32_16x16x32_bf16 v[244:247], a[228:231], v[100:103], v[244:247]
    buffer_load_dwordx4 v9, s[8:11], s21 offen lds
    v_mfma_f32_16x16x32_bf16 a[36:39], a[228:231], v[104:107], a[36:39]
    s_add_u32 s21, s21, 128
    v_exp_f32 v131, v83
    v_mfma_f32_16x16x32_bf16 v[200:203], a[232:235], v[96:99], v[200:203]
    s_add_u32 m0, s22, 26624
    v_exp_f32 v129, v81
    v_mfma_f32_16x16x32_bf16 v[248:251], a[232:235], v[100:103], v[248:251]
    ds_read_b128 a[212:215], v2 offset:2048
    v_cvt_pk_bf16_f32 v118, v132, v133
    v_mfma_f32_16x16x32_bf16 a[40:43], a[232:235], v[104:107], a[40:43]
    ds_read_b128 a[228:231], v2 offset:7168
    v_exp_f32 v132, v84
    v_mfma_f32_16x16x32_bf16 v[204:207], a[236:239], v[96:99], v[204:207]
    buffer_load_dwordx4 v9, s[8:11], s21 offen lds
    v_mfma_f32_16x16x32_bf16 v[252:255], a[236:239], v[100:103], v[252:255]
    buffer_store_dwordx4 v[140:143], v12, s[16:19], s24 offen offset:3072 sc0 sc1 nt
    ds_read_b128 a[220:223], v2 offset:6144
    v_exp_f32 v133, v85
    v_mfma_f32_16x16x32_bf16 v[24:27], a[244:247], v[116:119], v[24:27]
    v_exp_f32 v130, v82
    v_mfma_f32_16x16x32_bf16 a[44:47], a[236:239], v[104:107], a[44:47]
    s_waitcnt lgkmcnt(3)
    ds_read_b128 a[236:239], v2 offset:8192
    ds_read_b128 a[216:219], v1 offset:6144
    v_mfma_f32_16x16x32_bf16 v[32:35], a[192:195], a[96:99], 0
    ds_read_b128 a[232:235], v1 offset:8192
    v_fma_f32 v86, v86, s28, v18
    v_mfma_f32_16x16x32_bf16 v[32:35], a[196:199], a[100:103], v[32:35]
    v_exp_f32 v134, v86
    v_mfma_f32_16x16x32_bf16 v[32:35], a[200:203], a[104:107], v[32:35]
    v_cvt_pk_bf16_f32 v120, v128, v129
    v_cvt_pk_bf16_f32 v123, v134, v135
    v_mfma_f32_16x16x32_bf16 v[32:35], a[204:207], a[108:111], v[32:35]
    v_cvt_pk_bf16_f32 v121, v130, v131
    v_cvt_pk_bf16_f32 v122, v132, v133
    v_mfma_f32_16x16x32_bf16 v[32:35], a[208:211], a[112:115], v[32:35]
    s_add_u32 s21, s21, 12032
    v_mfma_f32_16x16x32_bf16 v[24:27], a[248:251], v[120:123], v[24:27]
    s_add_u32 m0, s23, 0
    ds_read_b128 a[224:227], v1 offset:7168
    s_waitcnt lgkmcnt(5)
    v_mfma_f32_16x16x32_bf16 v[32:35], a[212:215], a[116:119], v[32:35]
    v_mfma_f32_16x16x32_bf16 v[40:43], a[192:195], a[120:123], 0
    buffer_load_dwordx4 v10, s[12:15], s25 offen nt lds
    v_mfma_f32_16x16x32_bf16 v[40:43], a[196:199], a[124:127], v[40:43]
    s_nop 0
    v_cmp_lt_f32 vcc, s29, v24
    s_add_u32 m0, s23, 1024
    v_mfma_f32_16x16x32_bf16 v[40:43], a[200:203], a[128:131], v[40:43]
    buffer_load_dwordx4 v11, s[12:15], s25 offen nt lds
    v_mfma_f32_16x16x32_bf16 v[40:43], a[204:207], a[132:135], v[40:43]
    s_nop 0
    s_cbranch_vccnz L_rs_loop3w1b
L_ret_loop3w1b:
    v_mfma_f32_16x16x32_bf16 v[40:43], a[208:211], a[136:139], v[40:43]
    s_bitcmp1_b32 s30, 0
    v_fma_f32 v35, v35, s28, v16
    v_mfma_f32_16x16x32_bf16 v[40:43], a[212:215], a[140:143], v[40:43]
    s_cselect_b32 s26, s49, 128
    v_fma_f32 v33, v33, s28, v16
    s_cselect_b32 s27, s39, 2048
    v_mfma_f32_16x16x32_bf16 v[48:51], a[192:195], a[144:147], 0
    s_add_u32 s24, s24, s26
    v_exp_f32 v129, v33
    v_mfma_f32_16x16x32_bf16 v[48:51], a[196:199], a[148:151], v[48:51]
    s_add_u32 s25, s25, s26
    s_add_u32 s23, s23, s27
    s_waitcnt vmcnt(10) lgkmcnt(0)
    v_mfma_f32_16x16x32_bf16 v[48:51], a[200:203], a[152:155], v[48:51]
    s_barrier
    v_mfma_f32_16x16x32_bf16 v[48:51], a[204:207], a[156:159], v[48:51]
    v_exp_f32 v131, v35
    v_mfma_f32_16x16x32_bf16 v[48:51], a[208:211], a[160:163], v[48:51]
    v_add_u32 v13, s27, v13
    v_fma_f32 v40, v40, s28, v17
    v_mfma_f32_16x16x32_bf16 v[48:51], a[212:215], a[164:167], v[48:51]
    v_fma_f32 v34, v34, s28, v16
    v_mfma_f32_16x16x32_bf16 v[36:39], a[216:219], a[96:99], 0
    ds_read_b64_tr_b16 a[192:193], v3 offset:12288
    ds_read_b64_tr_b16 a[194:195], v3 offset:18432
    v_mfma_f32_16x16x32_bf16 v[36:39], a[220:223], a[100:103], v[36:39]
    s_add_u32 m0, s22, 0
    v_exp_f32 v130, v34
    v_mfma_f32_16x16x32_bf16 v[36:39], a[224:227], a[104:107], v[36:39]
    buffer_load_dwordx4 v9, s[4:7], s20 offen lds
    v_mfma_f32_16x16x32_bf16 v[36:39], a[228:231], a[108:111], v[36:39]
    ds_read_b64_tr_b16 a[196:197], v4 offset:12288
    s_add_u32 s20, s20, 128
    v_mfma_f32_16x16x32_bf16 v[36:39], a[232:235], a[112:115], v[36:39]
    v_fma_f32 v41, v41, s28, v17
    v_mfma_f32_16x16x32_bf16 v[36:39], a[236:239], a[116:119], v[36:39]
    s_add_u32 m0, s22, 1024
    ds_read_b64_tr_b16 a[198:199], v4 offset:18432
    ds_read_b64_tr_b16 a[200:201], v5 offset:12288
    v_mfma_f32_16x16x32_bf16 v[44:47], a[216:219], a[120:123], 0
    buffer_load_dwordx4 v9, s[4:7], s20 offen lds
    v_mfma_f32_16x16x32_bf16 v[44:47], a[220:223], a[124:127], v[44:47]
    s_add_u32 s20, s20, 128
    ds_read_b64_tr_b16 a[202:203], v5 offset:18432
    v_mfma_f32_16x16x32_bf16 v[44:47], a[224:227], a[128:131], v[44:47]
    s_add_u32 m0, s22, 2048
    v_exp_f32 v132, v40
    v_mfma_f32_16x16x32_bf16 v[44:47], a[228:231], a[132:135], v[44:47]
    v_exp_f32 v133, v41
    v_mfma_f32_16x16x32_bf16 v[44:47], a[232:235], a[136:139], v[44:47]
    buffer_load_dwordx4 v9, s[4:7], s20 offen lds
    v_mfma_f32_16x16x32_bf16 v[44:47], a[236:239], a[140:143], v[44:47]
    ds_read_b64_tr_b16 a[204:205], v6 offset:12288
    v_fma_f32 v32, v32, s28, v16
    v_mfma_f32_16x16x32_bf16 v[52:55], a[216:219], a[144:147], 0
    v_exp_f32 v128, v32
    v_mfma_f32_16x16x32_bf16 v[52:55], a[220:223], a[148:151], v[52:55]
    ds_read_b64_tr_b16 a[206:207], v6 offset:18432
    ds_read_b64_tr_b16 a[208:209], v3 offset:13312
    v_mfma_f32_16x16x32_bf16 v[52:55], a[224:227], a[152:155], v[52:55]
    s_add_u32 s20, s20, 12032
    v_cvt_pk_bf16_f32 v100, v132, v133
    v_cvt_pk_bf16_f32 v96, v128, v129
    v_mfma_f32_16x16x32_bf16 v[52:55], a[228:231], a[156:159], v[52:55]
    s_add_u32 s30, s30, 1
    ds_read_b64_tr_b16 a[210:211], v3 offset:19456
    v_cvt_pk_bf16_f32 v97, v130, v131
    v_mfma_f32_16x16x32_bf16 v[52:55], a[232:235], a[160:163], v[52:55]
    ds_read_b64_tr_b16 a[212:213], v4 offset:13312
    ds_read_b64_tr_b16 a[214:215], v4 offset:19456
    v_mfma_f32_16x16x32_bf16 v[52:55], a[236:239], a[164:167], v[52:55]
    s_cmp_lt_u32 s30, 6
    s_cbranch_scc1 L_loop3w1
    s_cmp_ge_u32 s37, 8
    s_cbranch_scc1 L_end3
    s_cmp_eq_u32 s32, 0
    s_cbranch_scc1 L_tr33
    s_branch L_tr34
L_tr34:
    s_waitcnt lgkmcnt(10)
    v_mfma_f32_16x16x32_bf16 v[160:163], a[192:195], v[112:115], v[160:163]
    ds_read_b64_tr_b16 a[224:225], v3 offset:14336
    v_fma_f32 v36, v36, s28, v16
    v_fma_f32 v37, v37, s28, v16
    v_fma_f32 v39, v39, s28, v16
    v_mfma_f32_16x16x32_bf16 v[208:211], a[192:195], v[116:119], v[208:211]
    ds_read_b64_tr_b16 a[216:217], v5 offset:13312
    v_fma_f32 v38, v38, s28, v16
    v_mfma_f32_16x16x32_bf16 a[0:3], a[192:195], v[120:123], a[0:3]
    s_waitcnt lgkmcnt(10)
    ds_read_b64_tr_b16 a[220:221], v6 offset:13312
    v_fma_f32 v55, v55, s28, v18
    v_mfma_f32_16x16x32_bf16 v[164:167], a[196:199], v[112:115], v[164:167]
    ds_read_b64_tr_b16 a[238:239], v6 offset:20480
    v_fma_f32 v47, v47, s28, v17
    v_mfma_f32_16x16x32_bf16 v[212:215], a[196:199], v[116:119], v[212:215]
    ds_read_b64_tr_b16 a[218:219], v5 offset:19456
    ds_read_b64_tr_b16 a[236:237], v6 offset:14336
    v_mfma_f32_16x16x32_bf16 a[4:7], a[196:199], v[120:123], a[4:7]
    s_waitcnt lgkmcnt(12)
    ds_read_b64_tr_b16 a[232:233], v5 offset:14336
    v_exp_f32 v128, v38
    v_mfma_f32_16x16x32_bf16 v[168:171], a[200:203], v[112:115], v[168:171]
    ds_read_b64_tr_b16 a[222:223], v6 offset:19456
    v_fma_f32 v45, v45, s28, v17
    v_mfma_f32_16x16x32_bf16 v[216:219], a[200:203], v[116:119], v[216:219]
    ds_read_b64_tr_b16 a[234:235], v5 offset:20480
    v_fma_f32 v54, v54, s28, v18
    v_mfma_f32_16x16x32_bf16 a[8:11], a[200:203], v[120:123], a[8:11]
    s_waitcnt lgkmcnt(9)
    ds_read_b64_tr_b16 a[228:229], v4 offset:14336
    v_fma_f32 v43, v43, s28, v17
    v_mfma_f32_16x16x32_bf16 v[172:175], a[204:207], v[112:115], v[172:175]
    ds_read_b64_tr_b16 a[226:227], v3 offset:20480
    v_fma_f32 v44, v44, s28, v17
    v_mfma_f32_16x16x32_bf16 v[220:223], a[204:207], v[116:119], v[220:223]
    ds_read_b64_tr_b16 a[230:231], v4 offset:20480
    v_exp_f32 v131, v43
    v_mfma_f32_16x16x32_bf16 a[12:15], a[204:207], v[120:123], a[12:15]
    ds_read_b128 v[136:139], v13 offset:0
    v_exp_f32 v134, v36
    v_mfma_f32_16x16x32_bf16 v[176:179], a[208:211], v[112:115], v[176:179]
    v_exp_f32 v129, v39
    v_mfma_f32_16x16x32_bf16 v[224:227], a[208:211], v[116:119], v[224:227]
    v_exp_f32 v133, v45
    v_fma_f32 v42, v42, s28, v17
    v_mfma_f32_16x16x32_bf16 a[16:19], a[208:211], v[120:123], a[16:19]
    v_exp_f32 v132, v44
    v_mfma_f32_16x16x32_bf16 v[180:183], a[212:215], v[112:115], v[180:183]
    v_exp_f32 v130, v42
    v_mfma_f32_16x16x32_bf16 v[228:231], a[212:215], v[116:119], v[228:231]
    v_fma_f32 v51, v51, s28, v18
    v_cvt_pk_bf16_f32 v99, v128, v129
    v_exp_f32 v135, v37
    v_mfma_f32_16x16x32_bf16 a[20:23], a[212:215], v[120:123], a[20:23]
    s_waitcnt lgkmcnt(3)
    ds_read_b128 v[140:143], v13 offset:1024
    v_cvt_pk_bf16_f32 v102, v132, v133
    v_mfma_f32_16x16x32_bf16 v[184:187], a[216:219], v[112:115], v[184:187]
    v_fma_f32 v53, v53, s28, v18
    v_cvt_pk_bf16_f32 v98, v134, v135
    v_mfma_f32_16x16x32_bf16 v[232:235], a[216:219], v[116:119], v[232:235]
    v_cvt_pk_bf16_f32 v101, v130, v131
    v_fma_f32 v46, v46, s28, v17
    v_exp_f32 v134, v46
    v_mfma_f32_16x16x32_bf16 v[20:23], a[240:243], v[96:99], v[24:27]
    s_waitcnt vmcnt(10) lgkmcnt(1)
    v_exp_f32 v135, v47
    v_mfma_f32_16x16x32_bf16 a[24:27], a[216:219], v[120:123], a[24:27]
    buffer_store_dwordx4 v[136:139], v12, s[16:19], s24 offen offset:0 sc0 sc1 nt
    s_barrier
    ds_read_b128 a[196:199], v2 offset:12288
    v_fma_f32 v50, v50, s28, v18
    v_mfma_f32_16x16x32_bf16 v[188:191], a[220:223], v[112:115], v[188:191]
    ds_read_b128 a[192:195], v1 offset:12288
    v_fma_f32 v49, v49, s28, v18
    v_mfma_f32_16x16x32_bf16 v[236:239], a[220:223], v[116:119], v[236:239]
    s_add_u32 m0, s22, 36864
    ds_read_b128 a[204:207], v2 offset:13312
    v_fma_f32 v52, v52, s28, v18
    v_mfma_f32_16x16x32_bf16 a[28:31], a[220:223], v[120:123], a[28:31]
    buffer_load_dwordx4 v9, s[8:11], s21 offen lds
    v_mfma_f32_16x16x32_bf16 v[192:195], a[224:227], v[112:115], v[192:195]
    ds_read_b128 a[200:203], v1 offset:13312
    v_cvt_pk_bf16_f32 v103, v134, v135
    v_mfma_f32_16x16x32_bf16 v[240:243], a[224:227], v[116:119], v[240:243]
    s_add_u32 s21, s21, 128
    v_exp_f32 v132, v52
    v_mfma_f32_16x16x32_bf16 a[32:35], a[224:227], v[120:123], a[32:35]
    s_add_u32 m0, s22, 37888
    v_exp_f32 v135, v55
    v_mfma_f32_16x16x32_bf16 v[196:199], a[228:231], v[112:115], v[196:199]
    v_exp_f32 v134, v54
    v_mfma_f32_16x16x32_bf16 v[244:247], a[228:231], v[116:119], v[244:247]
    buffer_load_dwordx4 v9, s[8:11], s21 offen lds
    v_mfma_f32_16x16x32_bf16 v[20:23], a[244:247], v[100:103], v[20:23]
    ds_read_b128 a[212:215], v2 offset:14336
    v_fma_f32 v48, v48, s28, v18
    v_mfma_f32_16x16x32_bf16 a[36:39], a[228:231], v[120:123], a[36:39]
    s_add_u32 s21, s21, 128
    ds_read_b128 a[208:211], v1 offset:14336
    v_cvt_pk_bf16_f32 v107, v134, v135
    v_mfma_f32_16x16x32_bf16 v[200:203], a[232:235], v[112:115], v[200:203]
    s_add_u32 m0, s22, 38912
    v_exp_f32 v130, v50
    v_mfma_f32_16x16x32_bf16 v[248:251], a[232:235], v[116:119], v[248:251]
    buffer_load_dwordx4 v9, s[8:11], s21 offen lds
    v_mfma_f32_16x16x32_bf16 a[40:43], a[232:235], v[120:123], a[40:43]
    v_exp_f32 v128, v48
    v_mfma_f32_16x16x32_bf16 v[204:207], a[236:239], v[112:115], v[204:207]
    s_add_u32 s21, s21, 12032
    ds_read_b128 a[228:231], v2 offset:19456
    v_mfma_f32_16x16x32_bf16 v[252:255], a[236:239], v[116:119], v[252:255]
    s_add_u32 m0, s38, 20480
    v_exp_f32 v133, v53
    v_mfma_f32_16x16x32_bf16 a[44:47], a[236:239], v[120:123], a[44:47]
    s_waitcnt lgkmcnt(3)
    v_exp_f32 v131, v51
    v_mfma_f32_16x16x32_bf16 v[64:67], a[192:195], a[96:99], 0
    buffer_load_dwordx4 v10, s[12:15], s25 offen nt lds
    v_mfma_f32_16x16x32_bf16 v[64:67], a[196:199], a[100:103], v[64:67]
    buffer_store_dwordx4 v[140:143], v12, s[16:19], s24 offen offset:3072 sc0 sc1 nt
    ds_read_b128 v[136:139], v13 offset:2048
    v_exp_f32 v129, v49
    v_mfma_f32_16x16x32_bf16 v[64:67], a[200:203], a[104:107], v[64:67]
    s_add_u32 m0, s38, 21504
    ds_read_b128 a[236:239], v2 offset:20480
    v_cvt_pk_bf16_f32 v106, v132, v133
    v_mfma_f32_16x16x32_bf16 v[64:67], a[204:207], a[108:111], v[64:67]
    s_waitcnt lgkmcnt(3)
    v_cvt_pk_bf16_f32 v104, v128, v129
    v_cvt_pk_bf16_f32 v105, v130, v131
    v_mfma_f32_16x16x32_bf16 v[64:67], a[208:211], a[112:115], v[64:67]
    buffer_load_dwordx4 v11, s[12:15], s25 offen nt lds
    v_mfma_f32_16x16x32_bf16 v[20:23], a[248:251], v[104:107], v[20:23]
    ds_read_b128 a[232:235], v1 offset:20480
    v_mfma_f32_16x16x32_bf16 v[64:67], a[212:215], a[116:119], v[64:67]
    s_add_u32 s57, s24, 128
    ds_read_b128 v[140:143], v13 offset:3072
    v_mfma_f32_16x16x32_bf16 v[72:75], a[192:195], a[120:123], 0
    ds_read_b128 a[216:219], v1 offset:18432
    v_mfma_f32_16x16x32_bf16 v[72:75], a[196:199], a[124:127], v[72:75]
    ds_read_b128 a[220:223], v2 offset:18432
    v_cmp_lt_f32 vcc, s29, v20
    v_mfma_f32_16x16x32_bf16 v[72:75], a[200:203], a[128:131], v[72:75]
    s_add_u32 s59, s25, 128
    ds_read_b128 a[224:227], v1 offset:19456
    s_add_u32 m0, s38, 22528
    v_mfma_f32_16x16x32_bf16 v[72:75], a[204:207], a[132:135], v[72:75]
    s_cbranch_vccnz L_rs_tr34a
L_ret_tr34a:
    v_mfma_f32_16x16x32_bf16 v[72:75], a[208:211], a[136:139], v[72:75]
    s_waitcnt lgkmcnt(6)
    buffer_load_dwordx4 v10, s[12:15], s59 offen nt lds
    v_mfma_f32_16x16x32_bf16 v[72:75], a[212:215], a[140:143], v[72:75]
    v_fma_f32 v65, v65, s28, v16
    v_fma_f32 v64, v64, s28, v16
    v_mfma_f32_16x16x32_bf16 v[80:83], a[192:195], a[144:147], 0
    v_fma_f32 v67, v67, s28, v16
    s_add_u32 m0, s38, 23552
    v_mfma_f32_16x16x32_bf16 v[80:83], a[196:199], a[148:151], v[80:83]
    s_nop 1
    v_fma_f32 v73, v73, s28, v17
    v_mfma_f32_16x16x32_bf16 v[80:83], a[200:203], a[152:155], v[80:83]
    v_exp_f32 v128, v64
    v_mfma_f32_16x16x32_bf16 v[80:83], a[204:207], a[156:159], v[80:83]
    s_waitcnt lgkmcnt(3)
    buffer_load_dwordx4 v11, s[12:15], s59 offen nt lds
    v_mfma_f32_16x16x32_bf16 v[80:83], a[208:211], a[160:163], v[80:83]
    buffer_store_dwordx4 v[136:139], v12, s[16:19], s57 offen offset:0 sc0 sc1 nt
    s_waitcnt vmcnt(13) lgkmcnt(0)
    s_barrier
    v_mfma_f32_16x16x32_bf16 v[80:83], a[212:215], a[164:167], v[80:83]
    s_add_u32 m0, s22, 12288
    v_exp_f32 v129, v65
    v_mfma_f32_16x16x32_bf16 v[68:71], a[216:219], a[96:99], 0
    buffer_load_dwordx4 v9, s[4:7], s20 offen lds
    v_mfma_f32_16x16x32_bf16 v[68:71], a[220:223], a[100:103], v[68:71]
    ds_read_b64_tr_b16 a[192:193], v3 offset:0
    v_fma_f32 v72, v72, s28, v17
    v_mfma_f32_16x16x32_bf16 v[68:71], a[224:227], a[104:107], v[68:71]
    s_add_u32 s20, s20, 128
    ds_read_b64_tr_b16 a[194:195], v3 offset:6144
    s_add_u32 m0, s22, 13312
    v_mfma_f32_16x16x32_bf16 v[68:71], a[228:231], a[108:111], v[68:71]
    ds_read_b64_tr_b16 a[196:197], v4 offset:0
    v_mfma_f32_16x16x32_bf16 v[68:71], a[232:235], a[112:115], v[68:71]
    buffer_load_dwordx4 v9, s[4:7], s20 offen lds
    v_mfma_f32_16x16x32_bf16 v[68:71], a[236:239], a[116:119], v[68:71]
    ds_read_b64_tr_b16 a[198:199], v4 offset:6144
    v_mfma_f32_16x16x32_bf16 v[76:79], a[216:219], a[120:123], 0
    s_add_u32 s20, s20, 128
    ds_read_b64_tr_b16 a[200:201], v5 offset:0
    v_fma_f32 v66, v66, s28, v16
    v_mfma_f32_16x16x32_bf16 v[76:79], a[220:223], a[124:127], v[76:79]
    v_exp_f32 v130, v66
    v_mfma_f32_16x16x32_bf16 v[76:79], a[224:227], a[128:131], v[76:79]
    s_add_u32 m0, s22, 14336
    ds_read_b64_tr_b16 a[202:203], v5 offset:6144
    v_mfma_f32_16x16x32_bf16 v[76:79], a[228:231], a[132:135], v[76:79]
    buffer_load_dwordx4 v9, s[4:7], s20 offen lds
    v_mfma_f32_16x16x32_bf16 v[76:79], a[232:235], a[136:139], v[76:79]
    v_exp_f32 v132, v72
    v_mfma_f32_16x16x32_bf16 v[76:79], a[236:239], a[140:143], v[76:79]
    ds_read_b64_tr_b16 a[204:205], v6 offset:0
    v_cvt_pk_bf16_f32 v112, v128, v129
    v_mfma_f32_16x16x32_bf16 v[84:87], a[216:219], a[144:147], 0
    s_add_u32 s20, s20, 12032
    ds_read_b64_tr_b16 a[206:207], v6 offset:6144
    v_mfma_f32_16x16x32_bf16 v[84:87], a[220:223], a[148:151], v[84:87]
    buffer_store_dwordx4 v[140:143], v12, s[16:19], s57 offen offset:3072 sc0 sc1 nt
    ds_read_b64_tr_b16 a[208:209], v3 offset:1024
    v_exp_f32 v133, v73
    v_mfma_f32_16x16x32_bf16 v[84:87], a[224:227], a[152:155], v[84:87]
    v_exp_f32 v131, v67
    v_mfma_f32_16x16x32_bf16 v[84:87], a[228:231], a[156:159], v[84:87]
    ds_read_b64_tr_b16 a[210:211], v3 offset:7168
    v_cvt_pk_bf16_f32 v116, v132, v133
    v_mfma_f32_16x16x32_bf16 v[84:87], a[232:235], a[160:163], v[84:87]
    ds_read_b64_tr_b16 a[212:213], v4 offset:1024
    v_mfma_f32_16x16x32_bf16 v[84:87], a[236:239], a[164:167], v[84:87]
    ds_read_b64_tr_b16 a[214:215], v4 offset:7168
    v_cvt_pk_bf16_f32 v113, v130, v131
    ds_read_b64_tr_b16 a[224:225], v3 offset:2048
    s_waitcnt lgkmcnt(11)
    v_mfma_f32_16x16x32_bf16 v[160:163], a[192:195], v[96:99], v[160:163]
    ds_read_b128 a[96:99], v7 offset:0
    v_fma_f32 v70, v70, s28, v16
    v_mfma_f32_16x16x32_bf16 v[208:211], a[192:195], v[100:103], v[208:211]
    ds_read_b64_tr_b16 a[238:239], v6 offset:8192
    v_exp_f32 v128, v70
    v_mfma_f32_16x16x32_bf16 a[0:3], a[192:195], v[104:107], a[0:3]
    s_waitcnt lgkmcnt(11)
    ds_read_b64_tr_b16 a[222:223], v6 offset:7168
    v_xor_b32 v8, 64, v7
    v_mfma_f32_16x16x32_bf16 v[164:167], a[196:199], v[96:99], v[164:167]
    ds_read_b64_tr_b16 a[218:219], v5 offset:7168
    v_mfma_f32_16x16x32_bf16 v[212:215], a[196:199], v[100:103], v[212:215]
    ds_read_b64_tr_b16 a[216:217], v5 offset:1024
    v_fma_f32 v69, v69, s28, v16
    v_mfma_f32_16x16x32_bf16 a[4:7], a[196:199], v[104:107], a[4:7]
    s_waitcnt lgkmcnt(12)
    ds_read_b64_tr_b16 a[234:235], v5 offset:8192
    v_fma_f32 v77, v77, s28, v17
    v_mfma_f32_16x16x32_bf16 v[168:171], a[200:203], v[96:99], v[168:171]
    ds_read_b64_tr_b16 a[228:229], v4 offset:2048
    v_fma_f32 v68, v68, s28, v16
    v_mfma_f32_16x16x32_bf16 v[216:219], a[200:203], v[100:103], v[216:219]
    ds_read_b64_tr_b16 a[226:227], v3 offset:8192
    ds_read_b64_tr_b16 a[220:221], v6 offset:1024
    v_mfma_f32_16x16x32_bf16 a[8:11], a[200:203], v[104:107], a[8:11]
    s_waitcnt lgkmcnt(11)
    ds_read_b128 a[116:119], v8 offset:4096
    v_fma_f32 v86, v86, s28, v18
    v_mfma_f32_16x16x32_bf16 v[172:175], a[204:207], v[96:99], v[172:175]
    ds_read_b64_tr_b16 a[236:237], v6 offset:2048
    v_exp_f32 v135, v69
    v_mfma_f32_16x16x32_bf16 v[220:223], a[204:207], v[100:103], v[220:223]
    ds_read_b64_tr_b16 a[230:231], v4 offset:8192
    v_mfma_f32_16x16x32_bf16 a[12:15], a[204:207], v[104:107], a[12:15]
    ds_read_b64_tr_b16 a[232:233], v5 offset:2048
    v_fma_f32 v85, v85, s28, v18
    v_mfma_f32_16x16x32_bf16 v[176:179], a[208:211], v[96:99], v[176:179]
    ds_read_b128 a[124:127], v8 offset:6144
    v_fma_f32 v71, v71, s28, v16
    v_mfma_f32_16x16x32_bf16 v[224:227], a[208:211], v[100:103], v[224:227]
    ds_read_b128 a[132:135], v8 offset:8192
    v_exp_f32 v129, v71
    v_mfma_f32_16x16x32_bf16 a[16:19], a[208:211], v[104:107], a[16:19]
    s_waitcnt lgkmcnt(10)
    ds_read_b128 a[100:103], v8 offset:0
    v_fma_f32 v74, v74, s28, v17
    v_mfma_f32_16x16x32_bf16 v[180:183], a[212:215], v[96:99], v[180:183]
    ds_read_b128 a[128:131], v7 offset:8192
    v_fma_f32 v79, v79, s28, v17
    v_mfma_f32_16x16x32_bf16 v[228:231], a[212:215], v[100:103], v[228:231]
    ds_read_b128 a[168:171], v7 offset:18432
    v_exp_f32 v130, v74
    v_mfma_f32_16x16x32_bf16 a[20:23], a[212:215], v[104:107], a[20:23]
    ds_read_b128 a[104:107], v7 offset:2048
    v_exp_f32 v134, v68
    v_mfma_f32_16x16x32_bf16 v[184:187], a[216:219], v[96:99], v[184:187]
    ds_read_b128 a[108:111], v8 offset:2048
    v_fma_f32 v75, v75, s28, v17
    v_mfma_f32_16x16x32_bf16 v[232:235], a[216:219], v[100:103], v[232:235]
    ds_read_b128 a[136:139], v7 offset:10240
    v_mfma_f32_16x16x32_bf16 a[24:27], a[216:219], v[104:107], a[24:27]
    s_waitcnt vmcnt(14) lgkmcnt(8)
    ds_read_b128 a[156:159], v8 offset:14336
    v_fma_f32 v78, v78, s28, v17
    v_mfma_f32_16x16x32_bf16 v[188:191], a[220:223], v[96:99], v[188:191]
    s_barrier
    ds_read_b128 a[192:195], v1 offset:0
    v_mfma_f32_16x16x32_bf16 v[236:239], a[220:223], v[100:103], v[236:239]
    ds_read_b128 a[204:207], v2 offset:1024
    v_mfma_f32_16x16x32_bf16 a[28:31], a[220:223], v[104:107], a[28:31]
    ds_read_b128 a[112:115], v7 offset:4096
    v_cvt_pk_bf16_f32 v114, v134, v135
    v_mfma_f32_16x16x32_bf16 v[192:195], a[224:227], v[96:99], v[192:195]
    ds_read_b128 a[196:199], v2 offset:0
    v_mfma_f32_16x16x32_bf16 v[240:243], a[224:227], v[100:103], v[240:243]
    s_add_u32 m0, s22, 24576
    ds_read_b128 a[200:203], v1 offset:1024
    v_fma_f32 v81, v81, s28, v18
    v_mfma_f32_16x16x32_bf16 a[32:35], a[224:227], v[104:107], a[32:35]
    buffer_load_dwordx4 v9, s[8:11], s21 offen lds
    ds_read_b128 a[212:215], v2 offset:2048
    v_mfma_f32_16x16x32_bf16 v[196:199], a[228:231], v[96:99], v[196:199]
    s_add_u32 s21, s21, 128
    ds_read_b128 a[208:211], v1 offset:2048
    v_fma_f32 v82, v82, s28, v18
    v_mfma_f32_16x16x32_bf16 v[244:247], a[228:231], v[100:103], v[244:247]
    s_add_u32 m0, s22, 25600
    ds_read_b128 a[164:167], v8 offset:16384
    v_fma_f32 v83, v83, s28, v18
    v_mfma_f32_16x16x32_bf16 a[36:39], a[228:231], v[104:107], a[36:39]
    ds_read_b128 a[152:155], v7 offset:14336
    v_cvt_pk_bf16_f32 v115, v128, v129
    v_mfma_f32_16x16x32_bf16 v[200:203], a[232:235], v[96:99], v[200:203]
    buffer_load_dwordx4 v9, s[8:11], s21 offen lds
    ds_read_b128 a[160:163], v7 offset:16384
    v_mfma_f32_16x16x32_bf16 v[248:251], a[232:235], v[100:103], v[248:251]
    ds_read_b128 a[140:143], v8 offset:10240
    v_mfma_f32_16x16x32_bf16 a[40:43], a[232:235], v[104:107], a[40:43]
    ds_read_b128 a[120:123], v7 offset:6144
    v_mfma_f32_16x16x32_bf16 v[204:207], a[236:239], v[96:99], v[204:207]
    s_add_u32 s21, s21, 128
    ds_read_b128 a[144:147], v7 offset:12288
    v_fma_f32 v80, v80, s28, v18
    v_mfma_f32_16x16x32_bf16 v[24:27], a[240:243], v[112:115], v[20:23]
    s_add_u32 m0, s22, 26624
    ds_read_b128 a[172:175], v8 offset:18432
    buffer_load_dwordx4 v9, s[8:11], s21 offen lds
    v_mfma_f32_16x16x32_bf16 v[252:255], a[236:239], v[100:103], v[252:255]
    v_exp_f32 v135, v79
    v_mfma_f32_16x16x32_bf16 a[44:47], a[236:239], v[104:107], a[44:47]
    s_waitcnt lgkmcnt(8)
    ds_read_b128 a[220:223], v2 offset:6144
    v_fma_f32 v76, v76, s28, v17
    v_mfma_f32_16x16x32_bf16 v[32:35], a[192:195], a[96:99], 0
    s_add_u32 s21, s21, 12032
    ds_read_b128 a[148:151], v8 offset:12288
    v_fma_f32 v87, v87, s28, v18
    v_mfma_f32_16x16x32_bf16 v[32:35], a[196:199], a[100:103], v[32:35]
    v_exp_f32 v132, v76
    v_mfma_f32_16x16x32_bf16 v[32:35], a[200:203], a[104:107], v[32:35]
    s_waitcnt vmcnt(8)
    v_exp_f32 v134, v78
    v_mfma_f32_16x16x32_bf16 v[32:35], a[204:207], a[108:111], v[32:35]
    s_waitcnt lgkmcnt(6)
    ds_read_b128 a[216:219], v1 offset:6144
    v_mfma_f32_16x16x32_bf16 v[32:35], a[208:211], a[112:115], v[32:35]
    ds_read_b128 a[184:187], v7 offset:22528
    v_mfma_f32_16x16x32_bf16 v[32:35], a[212:215], a[116:119], v[32:35]
    s_waitcnt lgkmcnt(6)
    v_exp_f32 v131, v75
    v_mfma_f32_16x16x32_bf16 v[40:43], a[192:195], a[120:123], 0
    ds_read_b128 a[180:183], v8 offset:20480
    v_cvt_pk_bf16_f32 v117, v130, v131
    v_mfma_f32_16x16x32_bf16 v[40:43], a[196:199], a[124:127], v[40:43]
    ds_read_b128 a[188:191], v8 offset:22528
    v_fma_f32 v84, v84, s28, v18
    v_mfma_f32_16x16x32_bf16 v[40:43], a[200:203], a[128:131], v[40:43]
    v_exp_f32 v133, v77
    v_mfma_f32_16x16x32_bf16 v[40:43], a[204:207], a[132:135], v[40:43]
    ds_read_b128 a[228:231], v2 offset:7168
    v_cvt_pk_bf16_f32 v118, v132, v133
    v_mfma_f32_16x16x32_bf16 v[40:43], a[208:211], a[136:139], v[40:43]
    ds_read_b128 a[176:179], v7 offset:20480
    v_cvt_pk_bf16_f32 v119, v134, v135
    v_mfma_f32_16x16x32_bf16 v[40:43], a[212:215], a[140:143], v[40:43]
    ds_read_b128 a[232:235], v1 offset:8192
    v_mfma_f32_16x16x32_bf16 v[24:27], a[244:247], v[116:119], v[24:27]
    s_waitcnt lgkmcnt(7)
    v_exp_f32 v130, v82
    v_mfma_f32_16x16x32_bf16 v[48:51], a[192:195], a[144:147], 0
    ds_read_b128 a[236:239], v2 offset:8192
    v_mfma_f32_16x16x32_bf16 v[48:51], a[196:199], a[148:151], v[48:51]
    ds_read_b128 a[224:227], v1 offset:7168
    v_exp_f32 v131, v83
    v_mfma_f32_16x16x32_bf16 v[48:51], a[200:203], a[152:155], v[48:51]
    v_exp_f32 v134, v86
    v_mfma_f32_16x16x32_bf16 v[48:51], a[204:207], a[156:159], v[48:51]
    v_exp_f32 v135, v87
    v_mfma_f32_16x16x32_bf16 v[48:51], a[208:211], a[160:163], v[48:51]
    v_exp_f32 v128, v80
    v_mfma_f32_16x16x32_bf16 v[48:51], a[212:215], a[164:167], v[48:51]
    v_exp_f32 v132, v84
    v_mfma_f32_16x16x32_bf16 v[56:59], a[192:195], a[168:171], 0
    v_cvt_pk_bf16_f32 v121, v130, v131
    v_cvt_pk_bf16_f32 v123, v134, v135
    v_mfma_f32_16x16x32_bf16 v[56:59], a[196:199], a[172:175], v[56:59]
    s_waitcnt lgkmcnt(3)
    v_exp_f32 v129, v81
    v_mfma_f32_16x16x32_bf16 v[56:59], a[200:203], a[176:179], v[56:59]
    v_exp_f32 v133, v85
    v_mfma_f32_16x16x32_bf16 v[56:59], a[204:207], a[180:183], v[56:59]
    v_cvt_pk_bf16_f32 v120, v128, v129
    v_cvt_pk_bf16_f32 v122, v132, v133
    v_mfma_f32_16x16x32_bf16 v[56:59], a[208:211], a[184:187], v[56:59]
    s_waitcnt vmcnt(13) lgkmcnt(0)
    v_mfma_f32_16x16x32_bf16 v[24:27], a[248:251], v[120:123], v[24:27]
    s_barrier
    v_mfma_f32_16x16x32_bf16 v[56:59], a[212:215], a[188:191], v[56:59]
    v_mfma_f32_16x16x32_bf16 v[36:39], a[216:219], a[96:99], 0
    s_add_u32 m0, s22, 0
    v_mfma_f32_16x16x32_bf16 v[36:39], a[220:223], a[100:103], v[36:39]
    buffer_load_dwordx4 v9, s[4:7], s20 offen lds
    v_mfma_f32_16x16x32_bf16 v[36:39], a[224:227], a[104:107], v[36:39]
    v_mfma_f32_16x16x32_bf16 v[36:39], a[228:231], a[108:111], v[36:39]
    ds_read_b64_tr_b16 a[192:193], v3 offset:12288
    v_mfma_f32_16x16x32_bf16 v[36:39], a[232:235], a[112:115], v[36:39]
    ds_read_b64_tr_b16 a[194:195], v3 offset:18432
    v_mfma_f32_16x16x32_bf16 v[36:39], a[236:239], a[116:119], v[36:39]
    ds_read_b64_tr_b16 a[196:197], v4 offset:12288
    v_mfma_f32_16x16x32_bf16 v[44:47], a[216:219], a[120:123], 0
    s_add_u32 s20, s20, 128
    v_mfma_f32_16x16x32_bf16 v[44:47], a[220:223], a[124:127], v[44:47]
    ds_read_b64_tr_b16 a[198:199], v4 offset:18432
    v_cmp_lt_f32 vcc, s29, v24
    v_mfma_f32_16x16x32_bf16 v[44:47], a[224:227], a[128:131], v[44:47]
    v_mfma_f32_16x16x32_bf16 v[44:47], a[228:231], a[132:135], v[44:47]
    ds_read_b64_tr_b16 a[200:201], v5 offset:12288
    v_mfma_f32_16x16x32_bf16 v[44:47], a[232:235], a[136:139], v[44:47]
    v_mfma_f32_16x16x32_bf16 v[44:47], a[236:239], a[140:143], v[44:47]
    s_add_u32 m0, s22, 1024
    ds_read_b64_tr_b16 a[202:203], v5 offset:18432
    v_mfma_f32_16x16x32_bf16 v[52:55], a[216:219], a[144:147], 0
    buffer_load_dwordx4 v9, s[4:7], s20 offen lds
    v_mfma_f32_16x16x32_bf16 v[52:55], a[220:223], a[148:151], v[52:55]
    ds_read_b64_tr_b16 a[204:205], v6 offset:12288
    v_mfma_f32_16x16x32_bf16 v[52:55], a[224:227], a[152:155], v[52:55]
    s_cbranch_vccnz L_rs_tr34b
L_ret_tr34b:
    ds_read_b64_tr_b16 a[206:207], v6 offset:18432
    v_mfma_f32_16x16x32_bf16 v[52:55], a[228:231], a[156:159], v[52:55]
    s_add_u32 s20, s20, 128
    ds_read_b64_tr_b16 a[208:209], v3 offset:13312
    v_mfma_f32_16x16x32_bf16 v[52:55], a[232:235], a[160:163], v[52:55]
    ds_read_b64_tr_b16 a[210:211], v3 offset:19456
    v_mfma_f32_16x16x32_bf16 v[52:55], a[236:239], a[164:167], v[52:55]
    s_add_u32 m0, s22, 2048
    ds_read_b64_tr_b16 a[212:213], v4 offset:13312
    v_mfma_f32_16x16x32_bf16 v[60:63], a[216:219], a[168:171], 0
    buffer_load_dwordx4 v9, s[4:7], s20 offen lds
    v_mfma_f32_16x16x32_bf16 v[60:63], a[220:223], a[172:175], v[60:63]
    s_add_u32 s20, s20, 12032
    v_mfma_f32_16x16x32_bf16 v[60:63], a[224:227], a[176:179], v[60:63]
    v_mfma_f32_16x16x32_bf16 v[60:63], a[228:231], a[180:183], v[60:63]
    v_mfma_f32_16x16x32_bf16 v[60:63], a[232:235], a[184:187], v[60:63]
    ds_read_b64_tr_b16 a[214:215], v4 offset:19456
    v_mfma_f32_16x16x32_bf16 v[60:63], a[236:239], a[188:191], v[60:63]
    s_waitcnt lgkmcnt(10)
    v_mfma_f32_16x16x32_bf16 v[160:163], a[192:195], v[112:115], v[160:163]
    s_add_u32 s24, s34, 128
    ds_read_b64_tr_b16 a[226:227], v3 offset:20480
    v_max3_f32 v28, v32, v33, v34
    v_max3_f32 v30, v40, v41, v42
    v_max3_f32 v28, v28, v35, v36
    v_max3_f32 v30, v30, v43, v44
    v_max3_f32 v30, v30, v45, v46
    v_max3_f32 v28, v28, v37, v38
    v_mfma_f32_16x16x32_bf16 v[208:211], a[192:195], v[116:119], v[208:211]
    s_add_u32 s18, s34, 18432
    v_max_f32 v28, v28, v39
    v_max_f32 v30, v30, v47
    v_mov_b32 v29, v28
    v_mfma_f32_16x16x32_bf16 a[0:3], a[192:195], v[120:123], a[0:3]
    s_waitcnt lgkmcnt(9)
    ds_read_b64_tr_b16 a[220:221], v6 offset:13312
    v_permlane32_swap_b32 v29, v28
    v_mov_b32 v31, v30
    v_mfma_f32_16x16x32_bf16 v[164:167], a[196:199], v[112:115], v[164:167]
    s_mov_b32 s34, s33
    ds_read_b64_tr_b16 a[218:219], v5 offset:19456
    v_max_f32 v28, v28, v29
    v_mfma_f32_16x16x32_bf16 v[212:215], a[196:199], v[116:119], v[212:215]
    s_add_u32 s37, s37, 1
    ds_read_b64_tr_b16 a[222:223], v6 offset:19456
    v_mov_b32 v29, v28
    v_permlane32_swap_b32 v31, v30
    v_mfma_f32_16x16x32_bf16 a[4:7], a[196:199], v[120:123], a[4:7]
    s_waitcnt lgkmcnt(9)
    ds_read_b64_tr_b16 a[228:229], v4 offset:14336
    v_mov_b32 v152, v24
    v_mfma_f32_16x16x32_bf16 v[168:171], a[200:203], v[112:115], v[168:171]
    s_add_u32 s35, s35, 325632
    ds_read_b64_tr_b16 a[232:233], v5 offset:14336
    v_max_f32 v30, v30, v31
    v_mfma_f32_16x16x32_bf16 v[216:219], a[200:203], v[116:119], v[216:219]
    s_lshl_b32 s42, s37, 1
    ds_read_b64_tr_b16 a[216:217], v5 offset:13312
    v_permlane16_swap_b32 v29, v28
    v_mov_b32 v31, v30
    v_mfma_f32_16x16x32_bf16 a[8:11], a[200:203], v[120:123], a[8:11]
    s_waitcnt lgkmcnt(6)
    ds_read_b64_tr_b16 a[224:225], v3 offset:14336
    v_max_f32 v28, v28, v29
    v_mfma_f32_16x16x32_bf16 v[172:175], a[204:207], v[112:115], v[172:175]
    s_lshr_b32 s42, s31, s42
    v_permlane16_swap_b32 v31, v30
    v_mul_f32_e64 v16, -s28, v28
    v_mfma_f32_16x16x32_bf16 v[220:223], a[204:207], v[116:119], v[220:223]
    s_xor_b32 s42, s42, s36
    v_max3_f32 v28, v48, v49, v50
    v_max_f32 v30, v30, v31
    v_max3_f32 v28, v28, v51, v52
    v_accvgpr_read_b32 v148, a4
    v_fma_f32 v36, v36, s28, v16
    v_mfma_f32_16x16x32_bf16 a[12:15], a[204:207], v[120:123], a[12:15]
    s_and_b32 s42, s42, 3
    ds_read_b64_tr_b16 a[236:237], v6 offset:14336
    s_mul_i32 s43, s3, 3
    v_mfma_f32_16x16x32_bf16 v[176:179], a[208:211], v[112:115], v[176:179]
    s_lshl_b32 s44, s3, 2
    ds_read_b64_tr_b16 a[234:235], v5 offset:20480
    v_accvgpr_read_b32 v145, a1
    v_mfma_f32_16x16x32_bf16 v[224:227], a[208:211], v[116:119], v[224:227]
    s_mov_b32 s32, 1
    v_fma_f32 v34, v34, s28, v16
    v_mul_f32_e64 v17, -s28, v30
    v_fma_f32 v37, v37, s28, v16
    v_mfma_f32_16x16x32_bf16 a[16:19], a[208:211], v[120:123], a[16:19]
    s_add_u32 s45, s43, 17
    ds_read_b64_tr_b16 a[238:239], v6 offset:20480
    v_fma_f32 v42, v42, s28, v17
    v_mfma_f32_16x16x32_bf16 v[180:183], a[212:215], v[112:115], v[180:183]
    s_cmp_eq_u32 s3, 0
    v_fma_f32 v44, v44, s28, v17
    v_mov_b32 v153, v24
    v_mfma_f32_16x16x32_bf16 v[228:231], a[212:215], v[116:119], v[228:231]
    s_cselect_b32 s45, 16, s45
    v_rcp_f32 v156, v26
    v_fma_f32 v35, v35, s28, v16
    v_mfma_f32_16x16x32_bf16 a[20:23], a[212:215], v[120:123], a[20:23]
    s_waitcnt lgkmcnt(3)
    ds_read_b64_tr_b16 a[230:231], v4 offset:20480
    s_cselect_b32 s33, 1, 0
    v_mfma_f32_16x16x32_bf16 v[184:187], a[216:219], v[112:115], v[184:187]
    s_cmp_eq_u32 s42, 1
    v_fma_f32 v38, v38, s28, v16
    v_accvgpr_read_b32 v146, a2
    v_mfma_f32_16x16x32_bf16 v[232:235], a[216:219], v[116:119], v[232:235]
    s_cselect_b32 s44, s45, s44
    s_cselect_b32 s32, s33, s32
    s_add_u32 s45, s43, 29
    v_mfma_f32_16x16x32_bf16 a[24:27], a[216:219], v[120:123], a[24:27]
    s_cmp_eq_u32 s42, 2
    v_max3_f32 v28, v28, v53, v54
    v_fma_f32 v33, v33, s28, v16
    v_mfma_f32_16x16x32_bf16 v[188:191], a[220:223], v[112:115], v[188:191]
    s_cselect_b32 s44, s45, s44
    v_permlane16_swap_b32 v152, v153
    s_cselect_b32 s32, 0, s32
    v_max_f32 v28, v28, v55
    s_add_u32 s45, s43, 41
    s_cmp_eq_u32 s42, 3
    v_mov_b32 v29, v28
    v_xor_b32 v0, 32, v14
    v_mfma_f32_16x16x32_bf16 v[236:239], a[220:223], v[116:119], v[236:239]
    s_cselect_b32 s44, s45, s44
    v_exp_f32 v131, v35
    v_mfma_f32_16x16x32_bf16 a[28:31], a[220:223], v[120:123], a[28:31]
    s_cselect_b32 s32, 0, s32
    v_fma_f32 v41, v41, s28, v17
    s_mul_i32 s44, s44, 6144
    v_accvgpr_read_b32 v149, a5
    s_add_u32 s33, s35, s44
    v_mfma_f32_16x16x32_bf16 v[192:195], a[224:227], v[112:115], v[192:195]
    s_mul_i32 s42, s32, 6144
    v_permlane32_swap_b32 v29, v28
    v_fma_f32 v32, v32, s28, v16
    v_xor_b32 v8, 96, v14
    v_mfma_f32_16x16x32_bf16 v[240:243], a[224:227], v[116:119], v[240:243]
    s_add_u32 s42, s42, 18432
    s_add_u32 s42, s42, s33
    s_cmp_ge_u32 s37, 8
    s_cselect_b32 s14, 0, s42
    v_max_f32 v28, v28, v29
    v_max3_f32 v30, v56, v57, v58
    s_add_u32 s25, s33, 128
    v_mfma_f32_16x16x32_bf16 a[32:35], a[224:227], v[120:123], a[32:35]
    s_add_u32 s23, s38, 2048
    s_mov_b32 s30, 0
    s_waitcnt vmcnt(7) lgkmcnt(0)
    v_fma_f32 v40, v40, s28, v17
    v_mfma_f32_16x16x32_bf16 v[196:199], a[228:231], v[112:115], v[196:199]
    s_barrier
    ds_read_b128 a[192:195], v1 offset:12288
    v_exp_f32 v133, v41
    v_mfma_f32_16x16x32_bf16 v[244:247], a[228:231], v[116:119], v[244:247]
    ds_read_b128 a[196:199], v2 offset:12288
    v_exp_f32 v132, v40
    v_fma_f32 v47, v47, s28, v17
    v_mfma_f32_16x16x32_bf16 a[36:39], a[228:231], v[120:123], a[36:39]
    s_add_u32 m0, s22, 36864
    ds_read_b128 a[200:203], v1 offset:13312
    v_fma_f32 v39, v39, s28, v16
    v_mfma_f32_16x16x32_bf16 v[200:203], a[232:235], v[112:115], v[200:203]
    ds_read_b128 a[204:207], v2 offset:13312
    v_rcp_f32 v152, v152
    v_mfma_f32_16x16x32_bf16 v[248:251], a[232:235], v[116:119], v[248:251]
    ds_read_b128 a[208:211], v1 offset:14336
    v_mov_b32 v29, v28
    v_mfma_f32_16x16x32_bf16 a[40:43], a[232:235], v[120:123], a[40:43]
    ds_read_b128 a[212:215], v2 offset:14336
    v_max3_f32 v30, v30, v59, v60
    v_mfma_f32_16x16x32_bf16 v[204:207], a[236:239], v[112:115], v[204:207]
    v_permlane16_swap_b32 v29, v28
    v_exp_f32 v130, v34
    v_accvgpr_read_b32 v147, a3
    v_cvt_pk_bf16_f32 v100, v132, v133
    v_max_f32 v28, v28, v29
    v_exp_f32 v134, v36
    v_mfma_f32_16x16x32_bf16 v[252:255], a[236:239], v[116:119], v[252:255]
    v_max3_f32 v30, v30, v61, v62
    v_max_f32 v30, v30, v63
    v_mfma_f32_16x16x32_bf16 a[44:47], a[236:239], v[120:123], a[44:47]
    s_waitcnt lgkmcnt(5)
    v_exp_f32 v128, v32
    v_mfma_f32_16x16x32_bf16 v[64:67], a[192:195], a[96:99], 0
    s_waitcnt lgkmcnt(4)
    v_exp_f32 v135, v37
    v_exp_f32 v129, v33
    v_mfma_f32_16x16x32_bf16 v[64:67], a[196:199], a[100:103], v[64:67]
    s_waitcnt lgkmcnt(3)
    ds_read_b128 a[220:223], v2 offset:18432
    v_accvgpr_read_b32 v151, a7
    v_mfma_f32_16x16x32_bf16 v[64:67], a[200:203], a[104:107], v[64:67]
    s_waitcnt lgkmcnt(3)
    ds_read_b128 a[224:227], v1 offset:19456
    v_mov_b32 v31, v30
    v_mfma_f32_16x16x32_bf16 v[64:67], a[204:207], a[108:111], v[64:67]
    s_waitcnt lgkmcnt(3)
    v_accvgpr_read_b32 v144, a0
    v_rcp_f32 v154, v25
    v_mfma_f32_16x16x32_bf16 v[64:67], a[208:211], a[112:115], v[64:67]
    s_waitcnt lgkmcnt(2)
    v_permlane32_swap_b32 v31, v30
    v_cvt_pk_bf16_f32 v96, v128, v129
    v_mfma_f32_16x16x32_bf16 v[64:67], a[212:215], a[116:119], v[64:67]
    buffer_load_dwordx4 v9, s[8:11], s21 offen lds
    v_mfma_f32_16x16x32_bf16 v[72:75], a[192:195], a[120:123], 0
    ds_read_b128 a[228:231], v2 offset:19456
    v_fma_f32 v43, v43, s28, v17
    v_mfma_f32_16x16x32_bf16 v[72:75], a[196:199], a[124:127], v[72:75]
    s_add_u32 s21, s21, 128
    v_fma_f32 v45, v45, s28, v17
    v_mul_f32_e64 v18, -s28, v28
    v_mfma_f32_16x16x32_bf16 v[72:75], a[200:203], a[128:131], v[72:75]
    v_cvt_pk_bf16_f32 v97, v130, v131
    v_max_f32 v30, v30, v31
    v_mfma_f32_16x16x32_bf16 v[72:75], a[204:207], a[132:135], v[72:75]
    s_add_u32 m0, s22, 37888
    v_accvgpr_read_b32 v150, a6
    v_exp_f32 v130, v42
    v_exp_f32 v131, v43
    v_pk_mul_f32 v[160:161], v[160:161], v[152:153] op_sel_hi:[1,0]
    v_pk_mul_f32 v[246:247], v[246:247], v[154:155] op_sel_hi:[1,0]
    v_pk_mul_f32 v[164:165], v[164:165], v[152:153] op_sel_hi:[1,0]
    v_cvt_pk_bf16_f32 v98, v134, v135
    v_pk_mul_f32 v[212:213], v[212:213], v[154:155] op_sel_hi:[1,0]
    v_pk_mul_f32 v[144:145], v[144:145], v[156:157] op_sel_hi:[1,0]
    v_pk_mul_f32 v[188:189], v[188:189], v[152:153] op_sel_hi:[1,0]
    v_pk_mul_f32 v[148:149], v[148:149], v[156:157] op_sel_hi:[1,0]
    v_pk_mul_f32 v[216:217], v[216:217], v[154:155] op_sel_hi:[1,0]
    v_pk_mul_f32 v[208:209], v[208:209], v[154:155] op_sel_hi:[1,0]
    v_pk_mul_f32 v[172:173], v[172:173], v[152:153] op_sel_hi:[1,0]
    v_fma_f32 v54, v54, s28, v18
    v_mov_b32 v31, v30
    v_mfma_f32_16x16x32_bf16 v[72:75], a[208:211], a[136:139], v[72:75]
    buffer_load_dwordx4 v9, s[8:11], s21 offen lds
    v_mfma_f32_16x16x32_bf16 v[72:75], a[212:215], a[140:143], v[72:75]
    v_fma_f32 v51, v51, s28, v18
    v_cvt_pk_bf16_f32 v144, v144, v145
    v_mfma_f32_16x16x32_bf16 v[80:83], a[192:195], a[144:147], 0
    ds_read_b128 a[236:239], v2 offset:20480
    v_fma_f32 v55, v55, s28, v18
    v_mfma_f32_16x16x32_bf16 v[80:83], a[196:199], a[148:151], v[80:83]
    v_fma_f32 v46, v46, s28, v17
    v_fma_f32 v52, v52, s28, v18
    v_mfma_f32_16x16x32_bf16 v[80:83], a[200:203], a[152:155], v[80:83]
    v_exp_f32 v133, v45
    v_xor_b32 v15, 64, v14
    v_mfma_f32_16x16x32_bf16 v[80:83], a[204:207], a[156:159], v[80:83]
    v_cvt_pk_bf16_f32 v148, v148, v149
    v_cvt_pk_bf16_f32 v212, v212, v213
    v_mfma_f32_16x16x32_bf16 v[80:83], a[208:211], a[160:163], v[80:83]
    s_add_u32 s21, s21, 128
    v_permlane16_swap_b32 v31, v30
    v_mfma_f32_16x16x32_bf16 v[80:83], a[212:215], a[164:167], v[80:83]
    v_fma_f32 v72, v72, s28, v17
    v_fma_f32 v48, v48, s28, v18
    v_fma_f32 v49, v49, s28, v18
    v_mfma_f32_16x16x32_bf16 v[88:91], a[192:195], a[168:171], 0
    ds_read_b128 a[216:219], v1 offset:18432
    v_exp_f32 v129, v39
    v_max_f32 v30, v30, v31
    v_mfma_f32_16x16x32_bf16 v[88:91], a[196:199], a[172:175], v[88:91]
    s_add_u32 m0, s22, 38912
    v_exp_f32 v128, v38
    v_exp_f32 v135, v47
    v_exp_f32 v134, v46
    v_fma_f32 v53, v53, s28, v18
    v_pk_mul_f32 v[150:151], v[150:151], v[156:157] op_sel_hi:[1,0]
    v_cvt_pk_bf16_f32 v160, v160, v161
    v_pk_mul_f32 v[254:255], v[254:255], v[154:155] op_sel_hi:[1,0]
    v_pk_mul_f32 v[214:215], v[214:215], v[154:155] op_sel_hi:[1,0]
    v_mul_f32_e64 v19, -s28, v30
    v_pk_mul_f32 v[176:177], v[176:177], v[152:153] op_sel_hi:[1,0]
    v_cvt_pk_bf16_f32 v101, v130, v131
    v_pk_mul_f32 v[162:163], v[162:163], v[152:153] op_sel_hi:[1,0]
    v_pk_mul_f32 v[238:239], v[238:239], v[154:155] op_sel_hi:[1,0]
    v_pk_mul_f32 v[210:211], v[210:211], v[154:155] op_sel_hi:[1,0]
    v_cvt_pk_bf16_f32 v99, v128, v129
    v_pk_mul_f32 v[168:169], v[168:169], v[152:153] op_sel_hi:[1,0]
    v_pk_mul_f32 v[232:233], v[232:233], v[154:155] op_sel_hi:[1,0]
    v_pk_mul_f32 v[236:237], v[236:237], v[154:155] op_sel_hi:[1,0]
    v_pk_mul_f32 v[180:181], v[180:181], v[152:153] op_sel_hi:[1,0]
    v_fma_f32 v50, v50, s28, v18
    v_pk_mul_f32 v[190:191], v[190:191], v[152:153] op_sel_hi:[1,0]
    v_pk_mul_f32 v[182:183], v[182:183], v[152:153] op_sel_hi:[1,0]
    v_pk_mul_f32 v[204:205], v[204:205], v[152:153] op_sel_hi:[1,0]
    v_fma_f32 v59, v59, s28, v19
    v_cvt_pk_bf16_f32 v208, v208, v209
    v_pk_mul_f32 v[146:147], v[146:147], v[156:157] op_sel_hi:[1,0]
    v_exp_f32 v132, v44
    v_fma_f32 v60, v60, s28, v19
    v_mfma_f32_16x16x32_bf16 v[88:91], a[200:203], a[176:179], v[88:91]
    ds_read_b128 a[232:235], v1 offset:20480
    v_fma_f32 v64, v64, s28, v16
    v_mfma_f32_16x16x32_bf16 v[88:91], a[204:207], a[180:183], v[88:91]
    v_exp_f32 v128, v48
    v_mfma_f32_16x16x32_bf16 v[88:91], a[208:211], a[184:187], v[88:91]
    v_exp_f32 v129, v49
    v_cvt_pk_bf16_f32 v103, v134, v135
    v_exp_f32 v130, v50
    v_mfma_f32_16x16x32_bf16 v[88:91], a[212:215], a[188:191], v[88:91]
    s_waitcnt lgkmcnt(1)
    v_cvt_pk_bf16_f32 v145, v146, v147
    v_fma_f32 v80, v80, s28, v18
    v_mfma_f32_16x16x32_bf16 v[68:71], a[216:219], a[96:99], 0
    buffer_load_dwordx4 v9, s[8:11], s21 offen lds
    v_cvt_pk_bf16_f32 v149, v150, v151
    v_exp_f32 v134, v54
    v_cvt_pk_bf16_f32 v102, v132, v133
    v_cvt_pk_bf16_f32 v216, v216, v217
    v_cvt_pk_bf16_f32 v161, v162, v163
    v_pk_mul_f32 v[226:227], v[226:227], v[154:155] op_sel_hi:[1,0]
    v_pk_mul_f32 v[218:219], v[218:219], v[154:155] op_sel_hi:[1,0]
    v_pk_mul_f32 v[166:167], v[166:167], v[152:153] op_sel_hi:[1,0]
    v_exp_f32 v131, v51
    v_exp_f32 v133, v53
    v_mfma_f32_16x16x32_bf16 v[68:71], a[220:223], a[100:103], v[68:71]
    v_exp_f32 v132, v52
    v_mfma_f32_16x16x32_bf16 v[68:71], a[224:227], a[104:107], v[68:71]
    s_add_u32 s21, s21, 12032
    v_fma_f32 v61, v61, s28, v19
    v_cvt_pk_bf16_f32 v106, v132, v133
    v_mfma_f32_16x16x32_bf16 v[68:71], a[228:231], a[108:111], v[68:71]
    s_waitcnt vmcnt(6) lgkmcnt(0)
    v_cvt_pk_bf16_f32 v209, v210, v211
    v_cvt_pk_bf16_f32 v172, v172, v173
    v_mfma_f32_16x16x32_bf16 v[68:71], a[232:235], a[112:115], v[68:71]
    s_barrier
    v_mfma_f32_16x16x32_bf16 v[68:71], a[236:239], a[116:119], v[68:71]
    v_cvt_pk_bf16_f32 v217, v218, v219
    v_fma_f32 v63, v63, s28, v19
    v_mfma_f32_16x16x32_bf16 v[76:79], a[216:219], a[120:123], 0
    ds_read_b64_tr_b16 a[192:193], v3 offset:0
    v_fma_f32 v56, v56, s28, v19
    v_mfma_f32_16x16x32_bf16 v[76:79], a[220:223], a[124:127], v[76:79]
    v_cvt_pk_bf16_f32 v164, v164, v165
    v_cvt_pk_bf16_f32 v165, v166, v167
    v_mfma_f32_16x16x32_bf16 v[76:79], a[224:227], a[128:131], v[76:79]
    v_fma_f32 v82, v82, s28, v18
    v_fma_f32 v69, v69, s28, v16
    v_exp_f32 v135, v55
    v_mfma_f32_16x16x32_bf16 v[76:79], a[228:231], a[132:135], v[76:79]
    s_add_u32 m0, s22, 12288
    ds_read_b64_tr_b16 a[194:195], v3 offset:6144
    v_fma_f32 v57, v57, s28, v19
    v_mfma_f32_16x16x32_bf16 v[76:79], a[232:235], a[136:139], v[76:79]
    buffer_load_dwordx4 v9, s[4:7], s20 offen lds
    v_cvt_pk_bf16_f32 v213, v214, v215
    v_fma_f32 v81, v81, s28, v18
    v_cvt_pk_bf16_f32 v104, v128, v129
    v_mfma_f32_16x16x32_bf16 v[76:79], a[236:239], a[140:143], v[76:79]
    ds_read_b64_tr_b16 a[196:197], v4 offset:0
    v_cvt_pk_bf16_f32 v188, v188, v189
    v_mfma_f32_16x16x32_bf16 v[84:87], a[216:219], a[144:147], 0
    s_add_u32 s20, s20, 128
    ds_write2st64_b64 v14, v[160:161], v[208:209] offset0:0 offset1:12
    v_pk_mul_f32 v[196:197], v[196:197], v[152:153] op_sel_hi:[1,0]
    v_accvgpr_read_b32 v147, a11
    v_pk_mul_f32 v[178:179], v[178:179], v[152:153] op_sel_hi:[1,0]
    v_pk_mul_f32 v[186:187], v[186:187], v[152:153] op_sel_hi:[1,0]
    v_fma_f32 v75, v75, s28, v17
    v_pk_mul_f32 v[192:193], v[192:193], v[152:153] op_sel_hi:[1,0]
    v_cvt_pk_bf16_f32 v105, v130, v131
    v_pk_mul_f32 v[174:175], v[174:175], v[152:153] op_sel_hi:[1,0]
    v_pk_mul_f32 v[198:199], v[198:199], v[152:153] op_sel_hi:[1,0]
    v_exp_f32 v128, v56
    v_cvt_pk_bf16_f32 v107, v134, v135
    v_mfma_f32_16x16x32_bf16 v[84:87], a[220:223], a[148:151], v[84:87]
    ds_write_b64 v14, v[144:145] offset:12288
    v_cvt_pk_bf16_f32 v232, v232, v233
    v_mfma_f32_16x16x32_bf16 v[84:87], a[224:227], a[152:155], v[84:87]
    v_fma_f32 v90, v90, s28, v19
    v_fma_f32 v62, v62, s28, v19
    v_accvgpr_read_b32 v151, a15
    v_cvt_pk_bf16_f32 v180, v180, v181
    v_fma_f32 v68, v68, s28, v16
    v_pk_mul_f32 v[234:235], v[234:235], v[154:155] op_sel_hi:[1,0]
    v_fma_f32 v91, v91, s28, v19
    v_pk_mul_f32 v[244:245], v[244:245], v[154:155] op_sel_hi:[1,0]
    v_pk_mul_f32 v[230:231], v[230:231], v[154:155] op_sel_hi:[1,0]
    v_accvgpr_read_b32 v146, a10
    v_pk_mul_f32 v[170:171], v[170:171], v[152:153] op_sel_hi:[1,0]
    v_accvgpr_read_b32 v144, a8
    v_fma_f32 v65, v65, s28, v16
    v_cvt_pk_bf16_f32 v196, v196, v197
    v_mfma_f32_16x16x32_bf16 v[84:87], a[228:231], a[156:159], v[84:87]
    ds_read_b64_tr_b16 a[198:199], v4 offset:6144
    v_accvgpr_read_b32 v145, a9
    v_mfma_f32_16x16x32_bf16 v[84:87], a[232:235], a[160:163], v[84:87]
    v_cvt_pk_bf16_f32 v168, v168, v169
    v_exp_f32 v129, v57
    v_mfma_f32_16x16x32_bf16 v[84:87], a[236:239], a[164:167], v[84:87]
    v_exp_f32 v132, v60
    v_mfma_f32_16x16x32_bf16 v[20:23], a[240:243], v[96:99], 0
    ds_write2st64_b64 v0, v[164:165], v[212:213] offset0:0 offset1:12
    v_fma_f32 v71, v71, s28, v16
    v_fma_f32 v67, v67, s28, v16
    v_fma_f32 v58, v58, s28, v19
    v_fma_f32 v76, v76, s28, v17
    v_pk_mul_f32 v[200:201], v[200:201], v[152:153] op_sel_hi:[1,0]
    v_exp_f32 v133, v61
    v_accvgpr_read_b32 v150, a14
    v_pk_mul_f32 v[224:225], v[224:225], v[154:155] op_sel_hi:[1,0]
    v_pk_mul_f32 v[144:145], v[144:145], v[156:157] op_sel_hi:[1,0]
    v_cvt_pk_bf16_f32 v108, v128, v129
    v_cvt_pk_bf16_f32 v176, v176, v177
    v_mfma_f32_16x16x32_bf16 v[92:95], a[216:219], a[168:171], 0
    ds_read_b64_tr_b16 a[200:201], v5 offset:0
    v_fma_f32 v77, v77, s28, v17
    v_cvt_pk_bf16_f32 v224, v224, v225
    v_cvt_pk_bf16_f32 v169, v170, v171
    v_cvt_pk_bf16_f32 v144, v144, v145
    v_mfma_f32_16x16x32_bf16 v[92:95], a[220:223], a[172:175], v[92:95]
    s_add_u32 m0, s22, 13312
    ds_read_b64_tr_b16 a[202:203], v5 offset:6144
    v_exp_f32 v129, v65
    v_fma_f32 v85, v85, s28, v18
    v_cvt_pk_bf16_f32 v173, v174, v175
    v_pk_mul_f32 v[220:221], v[220:221], v[154:155] op_sel_hi:[1,0]
    v_cvt_pk_bf16_f32 v110, v132, v133
    v_fma_f32 v66, v66, s28, v16
    v_pk_mul_f32 v[228:229], v[228:229], v[154:155] op_sel_hi:[1,0]
    v_pk_mul_f32 v[146:147], v[146:147], v[156:157] op_sel_hi:[1,0]
    v_fma_f32 v73, v73, s28, v17
    v_exp_f32 v128, v64
    v_fma_f32 v87, v87, s28, v18
    v_fma_f32 v78, v78, s28, v17
    v_mfma_f32_16x16x32_bf16 v[92:95], a[224:227], a[176:179], v[92:95]
    ds_read_b64_tr_b16 a[204:205], v6 offset:0
    v_cvt_pk_bf16_f32 v145, v146, v147
    v_cvt_pk_bf16_f32 v200, v200, v201
    v_mfma_f32_16x16x32_bf16 v[92:95], a[228:231], a[180:183], v[92:95]
    buffer_load_dwordx4 v9, s[4:7], s20 offen lds
    v_exp_f32 v130, v58
    v_mfma_f32_16x16x32_bf16 v[92:95], a[232:235], a[184:187], v[92:95]
    ds_write_b64 v0, v[148:149] offset:12288
    v_mfma_f32_16x16x32_bf16 v[92:95], a[236:239], a[188:191], v[92:95]
    s_waitcnt lgkmcnt(3)
    ds_write2st64_b64 v15, v[168:169], v[216:217] offset0:0 offset1:12
    v_cvt_pk_bf16_f32 v220, v220, v221
    v_fma_f32 v70, v70, s28, v16
    v_mfma_f32_16x16x32_bf16 v[160:163], a[192:195], v[96:99], 0
    ds_write_b64 v15, v[144:145] offset:12288
    v_accvgpr_read_b32 v148, a12
    v_mfma_f32_16x16x32_bf16 v[208:211], a[192:195], v[100:103], 0
    ds_read_b64_tr_b16 a[222:223], v6 offset:7168
    v_exp_f32 v134, v62
    v_exp_f32 v131, v59
    v_exp_f32 v135, v63
    v_pk_mul_f32 v[150:151], v[150:151], v[156:157] op_sel_hi:[1,0]
    v_pk_mul_f32 v[240:241], v[240:241], v[154:155] op_sel_hi:[1,0]
    v_pk_mul_f32 v[206:207], v[206:207], v[152:153] op_sel_hi:[1,0]
    v_cvt_pk_bf16_f32 v225, v226, v227
    v_accvgpr_read_b32 v146, a18
    v_pk_mul_f32 v[184:185], v[184:185], v[152:153] op_sel_hi:[1,0]
    v_cvt_pk_bf16_f32 v109, v130, v131
    v_subrev_u32 v13, 20480, v13
    v_accvgpr_read_b32 v144, a16
    v_pk_mul_f32 v[222:223], v[222:223], v[154:155] op_sel_hi:[1,0]
    v_cvt_pk_bf16_f32 v240, v240, v241
    v_cvt_pk_bf16_f32 v236, v236, v237
    v_accvgpr_read_b32 v147, a19
    v_pk_mul_f32 v[242:243], v[242:243], v[154:155] op_sel_hi:[1,0]
    v_accvgpr_read_b32 v149, a13
    v_exp_f32 v133, v73
    v_cvt_pk_bf16_f32 v221, v222, v223
    v_mfma_f32_16x16x32_bf16 v[20:23], a[244:247], v[100:103], v[20:23]
    ds_read_b64_tr_b16 a[206:207], v6 offset:6144
    v_accvgpr_read_b32 v145, a17
    v_mfma_f32_16x16x32_bf16 a[0:3], a[192:195], v[104:107], 0
    ds_write2st64_b64 v8, v[172:173], v[220:221] offset0:0 offset1:12
    v_pk_mul_f32 v[252:253], v[252:253], v[154:155] op_sel_hi:[1,0]
    v_pk_mul_f32 v[144:145], v[144:145], v[156:157] op_sel_hi:[1,0]
    v_cvt_pk_bf16_f32 v112, v128, v129
    v_pk_mul_f32 v[194:195], v[194:195], v[152:153] op_sel_hi:[1,0]
    v_exp_f32 v130, v66
    v_cvt_pk_bf16_f32 v111, v134, v135
    v_fma_f32 v79, v79, s28, v17
    v_pk_mul_f32 v[148:149], v[148:149], v[156:157] op_sel_hi:[1,0]
    v_pk_mul_f32 v[146:147], v[146:147], v[156:157] op_sel_hi:[1,0]
    v_cvt_pk_bf16_f32 v237, v238, v239
    v_exp_f32 v132, v72
    v_cvt_pk_bf16_f32 v144, v144, v145
    v_pk_mul_f32 v[248:249], v[248:249], v[154:155] op_sel_hi:[1,0]
    v_fma_f32 v83, v83, s28, v18
    v_cvt_pk_bf16_f32 v148, v148, v149
    v_mfma_f32_16x16x32_bf16 a[48:51], a[192:195], v[108:111], 0
    ds_read_b64_tr_b16 a[208:209], v3 offset:1024
    v_exp_f32 v135, v69
    v_mfma_f32_16x16x32_bf16 v[164:167], a[196:199], v[96:99], 0
    s_add_u32 s20, s20, 128
    ds_read_b64_tr_b16 a[218:219], v5 offset:7168
    v_cvt_pk_bf16_f32 v145, v146, v147
    v_mfma_f32_16x16x32_bf16 v[212:215], a[196:199], v[100:103], 0
    s_add_u32 m0, s22, 14336
    ds_read_b128 v[140:143], v13 offset:1024
    v_cvt_pk_bf16_f32 v116, v132, v133
    v_cvt_pk_bf16_f32 v233, v234, v235
    v_mfma_f32_16x16x32_bf16 a[4:7], a[196:199], v[104:107], 0
    ds_read_b64_tr_b16 a[210:211], v3 offset:7168
    v_exp_f32 v128, v70
    v_exp_f32 v129, v71
    v_mfma_f32_16x16x32_bf16 a[52:55], a[196:199], v[108:111], 0
    s_waitcnt lgkmcnt(4)
    ds_read_b64_tr_b16 a[212:213], v4 offset:1024
    v_cvt_pk_bf16_f32 v149, v150, v151
    v_mfma_f32_16x16x32_bf16 v[168:171], a[200:203], v[96:99], 0
    ds_write_b64 v8, v[148:149] offset:12288
    v_mfma_f32_16x16x32_bf16 v[216:219], a[200:203], v[100:103], 0
    ds_read_b64_tr_b16 a[224:225], v3 offset:2048
    v_exp_f32 v131, v67
    v_mfma_f32_16x16x32_bf16 v[20:23], a[248:251], v[104:107], v[20:23]
    ds_read_b128 v[136:139], v13 offset:0
    buffer_load_dwordx4 v9, s[4:7], s20 offen lds
    v_fma_f32 v93, v93, s28, v19
    v_mfma_f32_16x16x32_bf16 a[8:11], a[200:203], v[104:107], 0
    s_add_u32 s20, s20, 12032
    ds_read_b64_tr_b16 a[214:215], v4 offset:7168
    v_accvgpr_read_b32 v150, a22
    v_cvt_pk_bf16_f32 v197, v198, v199
    v_mfma_f32_16x16x32_bf16 a[56:59], a[200:203], v[108:111], 0
    ds_read_b64_tr_b16 a[228:229], v4 offset:2048
    v_cvt_pk_bf16_f32 v177, v178, v179
    v_cvt_pk_bf16_f32 v204, v204, v205
    v_accvgpr_read_b32 v148, a20
    v_mfma_f32_16x16x32_bf16 v[172:175], a[204:207], v[96:99], 0
    s_add_u32 s56, s24, 4294967168
    ds_write2st64_b64 v14, v[176:177], v[224:225] offset0:4 offset1:16
    v_exp_f32 v134, v68
    v_accvgpr_read_b32 v149, a21
    v_pk_mul_f32 v[250:251], v[250:251], v[154:155] op_sel_hi:[1,0]
    v_exp_f32 v133, v77
    v_cvt_pk_bf16_f32 v228, v228, v229
    v_cvt_pk_bf16_f32 v184, v184, v185
    v_accvgpr_read_b32 v146, a26
    v_exp_f32 v132, v76
    v_mfma_f32_16x16x32_bf16 v[220:223], a[204:207], v[100:103], 0
    s_add_u32 s58, s25, 4294967168
    ds_read_b64_tr_b16 a[216:217], v5 offset:1024
    v_accvgpr_read_b32 v151, a23
    v_mfma_f32_16x16x32_bf16 a[12:15], a[204:207], v[104:107], 0
    ds_write_b64 v14, v[144:145] offset:14336
    v_cvt_pk_bf16_f32 v192, v192, v193
    v_cvt_pk_bf16_f32 v229, v230, v231
    v_pk_mul_f32 v[148:149], v[148:149], v[156:157] op_sel_hi:[1,0]
    v_cvt_pk_bf16_f32 v113, v130, v131
    v_fma_f32 v84, v84, s28, v18
    v_cvt_pk_bf16_f32 v185, v186, v187
    v_pk_mul_f32 v[150:151], v[150:151], v[156:157] op_sel_hi:[1,0]
    v_cvt_pk_bf16_f32 v241, v242, v243
    v_cvt_pk_bf16_f32 v244, v244, v245
    v_cvt_pk_bf16_f32 v118, v132, v133
    v_cvt_pk_bf16_f32 v115, v128, v129
    v_cvt_pk_bf16_f32 v181, v182, v183
    v_mfma_f32_16x16x32_bf16 a[60:63], a[204:207], v[108:111], 0
    s_waitcnt lgkmcnt(2)
    ds_read_b64_tr_b16 a[226:227], v3 offset:8192
    v_cvt_pk_bf16_f32 v189, v190, v191
    v_cvt_pk_bf16_f32 v248, v248, v249
    v_mfma_f32_16x16x32_bf16 v[176:179], a[208:211], v[96:99], 0
    v_cvt_pk_bf16_f32 v252, v252, v253
    v_accvgpr_read_b32 v147, a27
    v_cvt_pk_bf16_f32 v148, v148, v149
    v_cvt_pk_bf16_f32 v149, v150, v151
    v_fma_f32 v74, v74, s28, v17
    v_accvgpr_read_b32 v145, a25
    v_exp_f32 v131, v75
    v_accvgpr_read_b32 v144, a24
    v_mfma_f32_16x16x32_bf16 v[224:227], a[208:211], v[100:103], 0
    buffer_store_dwordx4 v[136:139], v12, s[16:19], s56 offen offset:0 sc0 sc1 nt
    s_add_u32 m0, s38, 0
    ds_write2st64_b64 v0, v[180:181], v[228:229] offset0:4 offset1:16
    v_mfma_f32_16x16x32_bf16 a[16:19], a[208:211], v[104:107], 0
    ds_write_b64 v0, v[148:149] offset:14336
    v_exp_f32 v130, v74
    v_mfma_f32_16x16x32_bf16 a[64:67], a[208:211], v[108:111], 0
    ds_read_b64_tr_b16 a[220:221], v6 offset:1024
    buffer_load_dwordx4 v10, s[12:15], s58 offen nt lds
    v_cvt_pk_bf16_f32 v114, v134, v135
    v_mfma_f32_16x16x32_bf16 v[180:183], a[212:215], v[96:99], 0
    ds_read_b128 v[136:139], v13 offset:6144
    v_accvgpr_read_b32 v150, a30
    v_cvt_pk_bf16_f32 v245, v246, v247
    v_accvgpr_read_b32 v151, a31
    v_mfma_f32_16x16x32_bf16 v[228:231], a[212:215], v[100:103], 0
    s_add_u32 m0, s38, 1024
    ds_read_b64_tr_b16 a[238:239], v6 offset:8192
    buffer_load_dwordx4 v11, s[12:15], s58 offen nt lds
    v_accvgpr_read_b32 v149, a29
    v_accvgpr_read_b32 v148, a28
    v_mfma_f32_16x16x32_bf16 a[20:23], a[212:215], v[104:107], 0
    buffer_store_dwordx4 v[140:143], v12, s[16:19], s56 offen offset:3072 sc0 sc1 nt
    s_nop 0
    ds_read_b128 v[140:143], v13 offset:7168
    v_pk_mul_f32 v[148:149], v[148:149], v[156:157] op_sel_hi:[1,0]
    v_pk_mul_f32 v[146:147], v[146:147], v[156:157] op_sel_hi:[1,0]
    v_pk_mul_f32 v[150:151], v[150:151], v[156:157] op_sel_hi:[1,0]
    v_pk_mul_f32 v[144:145], v[144:145], v[156:157] op_sel_hi:[1,0]
    v_cvt_pk_bf16_f32 v253, v254, v255
    v_cvt_pk_bf16_f32 v148, v148, v149
    v_mfma_f32_16x16x32_bf16 v[20:23], a[252:255], v[108:111], v[20:23]
    s_add_u32 s57, s24, 6016
    ds_read_b64_tr_b16 a[232:233], v5 offset:2048
    v_cvt_pk_bf16_f32 v144, v144, v145
    v_cvt_pk_bf16_f32 v145, v146, v147
    v_cvt_pk_bf16_f32 v149, v150, v151
    v_mfma_f32_16x16x32_bf16 a[68:71], a[212:215], v[108:111], 0
    s_waitcnt lgkmcnt(5)
    ds_write2st64_b64 v15, v[184:185], v[232:233] offset0:4 offset1:16
    v_cvt_pk_bf16_f32 v193, v194, v195
    v_mfma_f32_16x16x32_bf16 v[184:187], a[216:219], v[96:99], 0
    s_add_u32 s59, s25, 6016
    ds_write_b64 v15, v[144:145] offset:14336
    v_cvt_pk_bf16_f32 v205, v206, v207
    v_mfma_f32_16x16x32_bf16 v[232:235], a[216:219], v[100:103], 0
    s_add_u32 m0, s38, 6144
    ds_read_b64_tr_b16 a[236:237], v6 offset:2048
    v_accvgpr_read_b32 v144, a32
    v_cvt_pk_bf16_f32 v117, v130, v131
    v_mfma_f32_16x16x32_bf16 a[24:27], a[216:219], v[104:107], 0
    ds_write2st64_b64 v8, v[188:189], v[236:237] offset0:4 offset1:16
    v_exp_f32 v134, v78
    v_accvgpr_read_b32 v151, a39
    v_mfma_f32_16x16x32_bf16 a[72:75], a[216:219], v[108:111], 0
    s_waitcnt lgkmcnt(5)
    ds_write_b64 v8, v[148:149] offset:14336
    v_mfma_f32_16x16x32_bf16 v[188:191], a[220:223], v[96:99], 0
    buffer_load_dwordx4 v10, s[12:15], s59 offen nt lds
    ds_write2st64_b64 v14, v[192:193], v[240:241] offset0:8 offset1:20
    v_exp_f32 v128, v80
    v_accvgpr_read_b32 v145, a33
    v_accvgpr_read_b32 v148, a36
    v_pk_mul_f32 v[144:145], v[144:145], v[156:157] op_sel_hi:[1,0]
    v_pk_mul_f32 v[202:203], v[202:203], v[152:153] op_sel_hi:[1,0]
    v_accvgpr_read_b32 v146, a34
    v_accvgpr_read_b32 v149, a37
    v_accvgpr_read_b32 v147, a35
    v_exp_f32 v130, v82
    v_mfma_f32_16x16x32_bf16 v[236:239], a[220:223], v[100:103], 0
    buffer_store_dwordx4 v[136:139], v12, s[16:19], s57 offen offset:0 sc0 sc1 nt
    s_nop 0
    ds_read_b128 v[136:139], v13 offset:12288
    v_exp_f32 v135, v79
    v_exp_f32 v131, v83
    v_pk_mul_f32 v[146:147], v[146:147], v[156:157] op_sel_hi:[1,0]
    v_cvt_pk_bf16_f32 v144, v144, v145
    v_pk_mul_f32 v[148:149], v[148:149], v[156:157] op_sel_hi:[1,0]
    v_accvgpr_read_b32 v150, a38
    v_cvt_pk_bf16_f32 v145, v146, v147
    v_mfma_f32_16x16x32_bf16 a[28:31], a[220:223], v[104:107], 0
    s_add_u32 m0, s38, 7168
    ds_write_b64 v14, v[144:145] offset:16384
    v_mfma_f32_16x16x32_bf16 a[76:79], a[220:223], v[108:111], 0
    buffer_load_dwordx4 v11, s[12:15], s59 offen nt lds
    v_mfma_f32_16x16x32_bf16 v[24:27], a[240:243], v[112:115], v[20:23]
    ds_read_b64_tr_b16 a[230:231], v4 offset:8192
    v_accvgpr_read_b32 v145, a41
    v_cvt_pk_bf16_f32 v119, v134, v135
    v_accvgpr_read_b32 v146, a42
    v_mfma_f32_16x16x32_bf16 v[192:195], a[224:227], v[96:99], 0
    buffer_store_dwordx4 v[140:143], v12, s[16:19], s57 offen offset:3072 sc0 sc1 nt
    s_add_u32 s56, s24, 12160
    ds_read_b64_tr_b16 a[234:235], v5 offset:8192
    v_cvt_pk_bf16_f32 v201, v202, v203
    v_exp_f32 v129, v81
    v_accvgpr_read_b32 v144, a40
    v_mfma_f32_16x16x32_bf16 v[240:243], a[224:227], v[100:103], 0
    s_add_u32 s58, s25, 12160
    ds_read_b128 v[140:143], v13 offset:13312
    v_accvgpr_read_b32 v147, a43
    v_mfma_f32_16x16x32_bf16 a[32:35], a[224:227], v[104:107], 0
    s_add_u32 m0, s38, 12288
    ds_write2st64_b64 v0, v[196:197], v[244:245] offset0:8 offset1:20
    v_pk_mul_f32 v[144:145], v[144:145], v[156:157] op_sel_hi:[1,0]
    v_pk_mul_f32 v[150:151], v[150:151], v[156:157] op_sel_hi:[1,0]
    v_cvt_pk_bf16_f32 v249, v250, v251
    v_fma_f32 v86, v86, s28, v18
    v_cvt_pk_bf16_f32 v148, v148, v149
    v_cvt_pk_bf16_f32 v149, v150, v151
    v_pk_mul_f32 v[146:147], v[146:147], v[156:157] op_sel_hi:[1,0]
    v_exp_f32 v133, v85
    v_exp_f32 v132, v84
    v_cvt_pk_bf16_f32 v144, v144, v145
    v_mfma_f32_16x16x32_bf16 a[80:83], a[224:227], v[108:111], 0
    s_waitcnt lgkmcnt(3)
    ds_write_b64 v0, v[148:149] offset:16384
    v_mfma_f32_16x16x32_bf16 v[196:199], a[228:231], v[96:99], 0
    buffer_load_dwordx4 v10, s[12:15], s58 offen nt lds
    v_cvt_pk_bf16_f32 v145, v146, v147
    v_mfma_f32_16x16x32_bf16 v[244:247], a[228:231], v[100:103], 0
    s_add_u32 m0, s38, 13312
    ds_write2st64_b64 v15, v[200:201], v[248:249] offset0:8 offset1:20
    v_cvt_pk_bf16_f32 v121, v130, v131
    v_mfma_f32_16x16x32_bf16 a[36:39], a[228:231], v[104:107], 0
    s_waitcnt lgkmcnt(3)
    buffer_load_dwordx4 v11, s[12:15], s58 offen nt lds
    ds_write_b64 v15, v[144:145] offset:16384
    v_mfma_f32_16x16x32_bf16 a[84:87], a[228:231], v[108:111], 0
    s_waitcnt vmcnt(16)
    v_exp_f32 v134, v86
    v_accvgpr_read_b32 v150, a46
    v_mfma_f32_16x16x32_bf16 v[200:203], a[232:235], v[96:99], 0
    s_barrier
    ds_read_b128 a[196:199], v2 offset:0
    v_mfma_f32_16x16x32_bf16 v[24:27], a[244:247], v[116:119], v[24:27]
    s_add_u32 m0, s22, 24576
    ds_read_b128 a[204:207], v2 offset:1024
    v_accvgpr_read_b32 v151, a47
    v_mfma_f32_16x16x32_bf16 v[248:251], a[232:235], v[100:103], 0
    ds_read_b128 a[192:195], v1 offset:0
    buffer_load_dwordx4 v9, s[8:11], s21 offen lds
    v_mfma_f32_16x16x32_bf16 a[40:43], a[232:235], v[104:107], 0
    ds_read_b128 a[200:203], v1 offset:1024
    v_exp_f32 v135, v87
    v_mfma_f32_16x16x32_bf16 a[88:91], a[232:235], v[108:111], 0
    s_add_u32 s21, s21, 128
    ds_write2st64_b64 v8, v[204:205], v[252:253] offset0:8 offset1:20
    v_accvgpr_read_b32 v149, a45
    v_mfma_f32_16x16x32_bf16 v[204:207], a[236:239], v[96:99], 0
    ds_read_b128 a[208:211], v1 offset:2048
    v_cvt_pk_bf16_f32 v123, v134, v135
    v_mfma_f32_16x16x32_bf16 v[252:255], a[236:239], v[100:103], 0
    s_add_u32 m0, s22, 25600
    ds_read_b128 a[212:215], v2 offset:2048
    v_accvgpr_read_b32 v148, a44
    v_mfma_f32_16x16x32_bf16 a[44:47], a[236:239], v[104:107], 0
    ds_read_b128 a[232:235], v1 offset:8192
    v_cvt_pk_bf16_f32 v122, v132, v133
    v_cvt_pk_bf16_f32 v120, v128, v129
    v_mfma_f32_16x16x32_bf16 a[92:95], a[236:239], v[108:111], 0
    buffer_store_dwordx4 v[136:139], v12, s[16:19], s56 offen offset:0 sc0 sc1 nt
    ds_read_b128 a[236:239], v2 offset:8192
    v_pk_mul_f32 v[148:149], v[148:149], v[156:157] op_sel_hi:[1,0]
    v_pk_mul_f32 v[150:151], v[150:151], v[156:157] op_sel_hi:[1,0]
    v_fma_f32 v88, v88, s28, v19
    s_nop 0
    v_mfma_f32_16x16x32_bf16 v[24:27], a[248:251], v[120:123], v[24:27]
    s_waitcnt lgkmcnt(6)
    ds_read_b128 a[216:219], v1 offset:6144
    v_fma_f32 v95, v95, s28, v19
    v_mfma_f32_16x16x32_bf16 v[32:35], a[192:195], a[96:99], 0
    buffer_load_dwordx4 v9, s[8:11], s21 offen lds
    v_mfma_f32_16x16x32_bf16 v[32:35], a[196:199], a[100:103], v[32:35]
    s_waitcnt lgkmcnt(5)
    v_exp_f32 v133, v93
    v_mfma_f32_16x16x32_bf16 v[32:35], a[200:203], a[104:107], v[32:35]
    ds_read_b128 a[228:231], v2 offset:7168
    v_fma_f32 v89, v89, s28, v19
    v_mfma_f32_16x16x32_bf16 v[32:35], a[204:207], a[108:111], v[32:35]
    s_waitcnt lgkmcnt(5)
    v_fma_f32 v92, v92, s28, v19
    v_fma_f32 v94, v94, s28, v19
    v_mfma_f32_16x16x32_bf16 v[32:35], a[208:211], a[112:115], v[32:35]
    s_waitcnt lgkmcnt(4)
    ds_read_b128 a[224:227], v1 offset:7168
    v_mfma_f32_16x16x32_bf16 v[32:35], a[212:215], a[116:119], v[32:35]
    ds_read_b128 a[220:223], v2 offset:6144
    s_add_u32 s21, s21, 128
    v_mfma_f32_16x16x32_bf16 v[40:43], a[192:195], a[120:123], 0
    v_exp_f32 v135, v95
    v_mfma_f32_16x16x32_bf16 v[40:43], a[196:199], a[124:127], v[40:43]
    s_add_u32 m0, s22, 26624
    v_exp_f32 v134, v94
    v_mfma_f32_16x16x32_bf16 v[40:43], a[200:203], a[128:131], v[40:43]
    v_exp_f32 v128, v88
    v_mfma_f32_16x16x32_bf16 v[40:43], a[204:207], a[132:135], v[40:43]
    buffer_load_dwordx4 v9, s[8:11], s21 offen lds
    v_mfma_f32_16x16x32_bf16 v[40:43], a[208:211], a[136:139], v[40:43]
    v_exp_f32 v130, v90
    v_mfma_f32_16x16x32_bf16 v[40:43], a[212:215], a[140:143], v[40:43]
    s_add_u32 s21, s21, 12032
    v_cvt_pk_bf16_f32 v127, v134, v135
    s_add_u32 s58, s25, 18304
    v_mfma_f32_16x16x32_bf16 v[48:51], a[192:195], a[144:147], 0
    s_add_u32 m0, s38, 18432
    v_exp_f32 v131, v91
    v_mfma_f32_16x16x32_bf16 v[48:51], a[196:199], a[148:151], v[48:51]
    v_exp_f32 v129, v89
    v_mfma_f32_16x16x32_bf16 v[48:51], a[200:203], a[152:155], v[48:51]
    buffer_load_dwordx4 v10, s[12:15], s58 offen nt lds
    v_mfma_f32_16x16x32_bf16 v[48:51], a[204:207], a[156:159], v[48:51]
    s_add_u32 m0, s38, 19456
    v_cvt_pk_bf16_f32 v148, v148, v149
    v_cvt_pk_bf16_f32 v125, v130, v131
    v_mfma_f32_16x16x32_bf16 v[48:51], a[208:211], a[160:163], v[48:51]
    buffer_load_dwordx4 v11, s[12:15], s58 offen nt lds
    v_mfma_f32_16x16x32_bf16 v[48:51], a[212:215], a[164:167], v[48:51]
    s_waitcnt vmcnt(19) lgkmcnt(0)
    v_exp_f32 v132, v92
    v_mfma_f32_16x16x32_bf16 v[56:59], a[192:195], a[168:171], 0
    v_cvt_pk_bf16_f32 v126, v132, v133
    s_add_u32 m0, s22, 0
    v_mfma_f32_16x16x32_bf16 v[56:59], a[196:199], a[172:175], v[56:59]
    v_cvt_pk_bf16_f32 v124, v128, v129
    v_mfma_f32_16x16x32_bf16 v[56:59], a[200:203], a[176:179], v[56:59]
    s_barrier
    v_mfma_f32_16x16x32_bf16 v[56:59], a[204:207], a[180:183], v[56:59]
    buffer_load_dwordx4 v9, s[4:7], s20 offen lds
    v_mfma_f32_16x16x32_bf16 v[24:27], a[252:255], v[124:127], v[24:27]
    ds_read_b64_tr_b16 a[192:193], v3 offset:12288
    s_add_u32 s20, s20, 128
    v_mfma_f32_16x16x32_bf16 v[56:59], a[208:211], a[184:187], v[56:59]
    ds_read_b64_tr_b16 a[194:195], v3 offset:18432
    v_add_u32 v13, 2048, v13
    v_mfma_f32_16x16x32_bf16 v[56:59], a[212:215], a[188:191], v[56:59]
    s_nop 1
    v_cmp_lt_f32 vcc, s29, v24
    v_mfma_f32_16x16x32_bf16 v[36:39], a[216:219], a[96:99], 0
    ds_read_b64_tr_b16 a[196:197], v4 offset:12288
    v_mfma_f32_16x16x32_bf16 v[36:39], a[220:223], a[100:103], v[36:39]
    ds_read_b64_tr_b16 a[198:199], v4 offset:18432
    v_mfma_f32_16x16x32_bf16 v[36:39], a[224:227], a[104:107], v[36:39]
    s_add_u32 m0, s22, 1024
    ds_read_b64_tr_b16 a[200:201], v5 offset:12288
    v_cvt_pk_bf16_f32 v149, v150, v151
    v_mfma_f32_16x16x32_bf16 v[36:39], a[228:231], a[108:111], v[36:39]
    s_cbranch_vccnz L_rs_tr34d
L_ret_tr34d:
    v_fma_f32 v34, v34, s28, v16
    v_mfma_f32_16x16x32_bf16 v[36:39], a[232:235], a[112:115], v[36:39]
    ds_read_b64_tr_b16 a[202:203], v5 offset:18432
    v_fma_f32 v32, v32, s28, v16
    v_mfma_f32_16x16x32_bf16 v[36:39], a[236:239], a[116:119], v[36:39]
    ds_read_b64_tr_b16 a[204:205], v6 offset:12288
    v_mfma_f32_16x16x32_bf16 v[44:47], a[216:219], a[120:123], 0
    v_fma_f32 v40, v40, s28, v17
    v_mfma_f32_16x16x32_bf16 v[44:47], a[220:223], a[124:127], v[44:47]
    buffer_load_dwordx4 v9, s[4:7], s20 offen lds
    v_mfma_f32_16x16x32_bf16 v[44:47], a[224:227], a[128:131], v[44:47]
    v_fma_f32 v33, v33, s28, v16
    v_fma_f32 v35, v35, s28, v16
    v_mfma_f32_16x16x32_bf16 v[44:47], a[228:231], a[132:135], v[44:47]
    buffer_store_dwordx4 v[140:143], v12, s[16:19], s56 offen offset:3072 sc0 sc1 nt
    ds_write_b64 v8, v[148:149] offset:16384
    v_mfma_f32_16x16x32_bf16 v[44:47], a[232:235], a[136:139], v[44:47]
    ds_read_b64_tr_b16 a[206:207], v6 offset:18432
    v_mfma_f32_16x16x32_bf16 v[44:47], a[236:239], a[140:143], v[44:47]
    v_exp_f32 v131, v35
    v_mfma_f32_16x16x32_bf16 v[52:55], a[216:219], a[144:147], 0
    v_exp_f32 v130, v34
    v_mfma_f32_16x16x32_bf16 v[52:55], a[220:223], a[148:151], v[52:55]
    s_add_u32 s20, s20, 128
    ds_read_b64_tr_b16 a[208:209], v3 offset:13312
    v_fma_f32 v41, v41, s28, v17
    v_mfma_f32_16x16x32_bf16 v[52:55], a[224:227], a[152:155], v[52:55]
    v_mfma_f32_16x16x32_bf16 v[52:55], a[228:231], a[156:159], v[52:55]
    v_exp_f32 v133, v41
    v_mfma_f32_16x16x32_bf16 v[52:55], a[232:235], a[160:163], v[52:55]
    s_add_u32 m0, s22, 2048
    v_exp_f32 v129, v33
    v_mfma_f32_16x16x32_bf16 v[52:55], a[236:239], a[164:167], v[52:55]
    buffer_load_dwordx4 v9, s[4:7], s20 offen lds
    v_mfma_f32_16x16x32_bf16 v[60:63], a[216:219], a[168:171], 0
    v_mfma_f32_16x16x32_bf16 v[60:63], a[220:223], a[172:175], v[60:63]
    s_add_u32 s20, s20, 12032
    v_exp_f32 v128, v32
    v_mfma_f32_16x16x32_bf16 v[60:63], a[224:227], a[176:179], v[60:63]
    ds_read_b64_tr_b16 a[210:211], v3 offset:19456
    v_cvt_pk_bf16_f32 v96, v128, v129
    v_mfma_f32_16x16x32_bf16 v[60:63], a[228:231], a[180:183], v[60:63]
    v_exp_f32 v132, v40
    v_mfma_f32_16x16x32_bf16 v[60:63], a[232:235], a[184:187], v[60:63]
    ds_read_b64_tr_b16 a[212:213], v4 offset:13312
    v_cvt_pk_bf16_f32 v100, v132, v133
    v_mfma_f32_16x16x32_bf16 v[60:63], a[236:239], a[188:191], v[60:63]
    ds_read_b64_tr_b16 a[214:215], v4 offset:19456
    v_cvt_pk_bf16_f32 v97, v130, v131
    s_branch L_loop4
L_tr33:
    s_waitcnt lgkmcnt(10)
    v_mfma_f32_16x16x32_bf16 v[160:163], a[192:195], v[112:115], v[160:163]
    ds_read_b64_tr_b16 a[222:223], v6 offset:19456
    v_fma_f32 v44, v44, s28, v17
    v_fma_f32 v49, v49, s28, v18
    v_mfma_f32_16x16x32_bf16 v[208:211], a[192:195], v[116:119], v[208:211]
    ds_read_b64_tr_b16 a[216:217], v5 offset:13312
    v_fma_f32 v38, v38, s28, v16
    v_fma_f32 v47, v47, s28, v17
    v_mfma_f32_16x16x32_bf16 a[0:3], a[192:195], v[120:123], a[0:3]
    s_waitcnt lgkmcnt(10)
    ds_read_b64_tr_b16 a[230:231], v4 offset:20480
    v_fma_f32 v42, v42, s28, v17
    v_mfma_f32_16x16x32_bf16 v[164:167], a[196:199], v[112:115], v[164:167]
    ds_read_b64_tr_b16 a[218:219], v5 offset:19456
    v_fma_f32 v54, v54, s28, v18
    v_mfma_f32_16x16x32_bf16 v[212:215], a[196:199], v[116:119], v[212:215]
    ds_read_b64_tr_b16 a[226:227], v3 offset:20480
    v_fma_f32 v46, v46, s28, v17
    v_mfma_f32_16x16x32_bf16 a[4:7], a[196:199], v[120:123], a[4:7]
    s_waitcnt lgkmcnt(11)
    ds_read_b64_tr_b16 a[234:235], v5 offset:20480
    v_fma_f32 v39, v39, s28, v16
    v_mfma_f32_16x16x32_bf16 v[168:171], a[200:203], v[112:115], v[168:171]
    ds_read_b64_tr_b16 a[232:233], v5 offset:14336
    v_exp_f32 v129, v39
    v_mfma_f32_16x16x32_bf16 v[216:219], a[200:203], v[116:119], v[216:219]
    ds_read_b64_tr_b16 a[238:239], v6 offset:20480
    v_fma_f32 v36, v36, s28, v16
    v_mfma_f32_16x16x32_bf16 a[8:11], a[200:203], v[120:123], a[8:11]
    s_waitcnt lgkmcnt(8)
    ds_read_b64_tr_b16 a[220:221], v6 offset:13312
    v_fma_f32 v37, v37, s28, v16
    v_mfma_f32_16x16x32_bf16 v[172:175], a[204:207], v[112:115], v[172:175]
    ds_read_b64_tr_b16 a[228:229], v4 offset:14336
    v_fma_f32 v52, v52, s28, v18
    v_mfma_f32_16x16x32_bf16 v[220:223], a[204:207], v[116:119], v[220:223]
    ds_read_b64_tr_b16 a[236:237], v6 offset:14336
    v_fma_f32 v43, v43, s28, v17
    v_mfma_f32_16x16x32_bf16 a[12:15], a[204:207], v[120:123], a[12:15]
    ds_read_b64_tr_b16 a[224:225], v3 offset:14336
    v_exp_f32 v130, v42
    v_mfma_f32_16x16x32_bf16 v[176:179], a[208:211], v[112:115], v[176:179]
    v_exp_f32 v134, v36
    v_mfma_f32_16x16x32_bf16 v[224:227], a[208:211], v[116:119], v[224:227]
    v_exp_f32 v128, v38
    v_mfma_f32_16x16x32_bf16 a[16:19], a[208:211], v[120:123], a[16:19]
    ds_read_b128 v[140:143], v13 offset:1024
    v_exp_f32 v135, v37
    v_mfma_f32_16x16x32_bf16 v[180:183], a[212:215], v[112:115], v[180:183]
    ds_read_b128 v[136:139], v13 offset:0
    v_cvt_pk_bf16_f32 v98, v134, v135
    v_mfma_f32_16x16x32_bf16 v[228:231], a[212:215], v[116:119], v[228:231]
    v_exp_f32 v131, v43
    v_mfma_f32_16x16x32_bf16 a[20:23], a[212:215], v[120:123], a[20:23]
    s_waitcnt lgkmcnt(6)
    v_fma_f32 v55, v55, s28, v18
    v_fma_f32 v45, v45, s28, v17
    v_mfma_f32_16x16x32_bf16 v[184:187], a[216:219], v[112:115], v[184:187]
    v_exp_f32 v134, v46
    v_cvt_pk_bf16_f32 v99, v128, v129
    v_mfma_f32_16x16x32_bf16 v[232:235], a[216:219], v[116:119], v[232:235]
    v_exp_f32 v129, v49
    v_mfma_f32_16x16x32_bf16 v[20:23], a[240:243], v[96:99], v[24:27]
    s_waitcnt vmcnt(10) lgkmcnt(2)
    v_exp_f32 v133, v45
    v_mfma_f32_16x16x32_bf16 a[24:27], a[216:219], v[120:123], a[24:27]
    s_barrier
    v_mfma_f32_16x16x32_bf16 v[188:191], a[220:223], v[112:115], v[188:191]
    v_exp_f32 v135, v47
    v_mfma_f32_16x16x32_bf16 v[236:239], a[220:223], v[116:119], v[236:239]
    s_add_u32 m0, s22, 36864
    ds_read_b128 a[192:195], v1 offset:12288
    v_cvt_pk_bf16_f32 v103, v134, v135
    v_mfma_f32_16x16x32_bf16 a[28:31], a[220:223], v[120:123], a[28:31]
    buffer_load_dwordx4 v9, s[8:11], s21 offen lds
    v_mfma_f32_16x16x32_bf16 v[192:195], a[224:227], v[112:115], v[192:195]
    ds_read_b128 a[196:199], v2 offset:12288
    v_fma_f32 v48, v48, s28, v18
    v_mfma_f32_16x16x32_bf16 v[240:243], a[224:227], v[116:119], v[240:243]
    s_add_u32 s21, s21, 128
    ds_read_b128 a[204:207], v2 offset:13312
    v_fma_f32 v53, v53, s28, v18
    v_mfma_f32_16x16x32_bf16 a[32:35], a[224:227], v[120:123], a[32:35]
    s_add_u32 m0, s22, 37888
    ds_read_b128 a[200:203], v1 offset:13312
    v_cvt_pk_bf16_f32 v101, v130, v131
    v_mfma_f32_16x16x32_bf16 v[196:199], a[228:231], v[112:115], v[196:199]
    v_exp_f32 v132, v44
    v_mfma_f32_16x16x32_bf16 v[244:247], a[228:231], v[116:119], v[244:247]
    ds_read_b128 a[208:211], v1 offset:14336
    v_cvt_pk_bf16_f32 v102, v132, v133
    v_mfma_f32_16x16x32_bf16 a[36:39], a[228:231], v[120:123], a[36:39]
    buffer_load_dwordx4 v9, s[8:11], s21 offen lds
    v_mfma_f32_16x16x32_bf16 v[200:203], a[232:235], v[112:115], v[200:203]
    s_add_u32 s21, s21, 128
    v_exp_f32 v132, v52
    v_mfma_f32_16x16x32_bf16 v[248:251], a[232:235], v[116:119], v[248:251]
    s_add_u32 m0, s22, 38912
    ds_read_b128 a[212:215], v2 offset:14336
    v_fma_f32 v50, v50, s28, v18
    v_fma_f32 v51, v51, s28, v18
    v_mfma_f32_16x16x32_bf16 a[40:43], a[232:235], v[120:123], a[40:43]
    v_exp_f32 v131, v51
    v_mfma_f32_16x16x32_bf16 v[204:207], a[236:239], v[112:115], v[204:207]
    buffer_load_dwordx4 v9, s[8:11], s21 offen lds
    v_mfma_f32_16x16x32_bf16 v[252:255], a[236:239], v[116:119], v[252:255]
    v_exp_f32 v135, v55
    v_mfma_f32_16x16x32_bf16 a[44:47], a[236:239], v[120:123], a[44:47]
    s_waitcnt lgkmcnt(3)
    v_exp_f32 v128, v48
    v_mfma_f32_16x16x32_bf16 v[64:67], a[192:195], a[96:99], 0
    ds_read_b128 a[224:227], v1 offset:19456
    s_add_u32 s21, s21, 12032
    v_mfma_f32_16x16x32_bf16 v[64:67], a[196:199], a[100:103], v[64:67]
    v_exp_f32 v134, v54
    v_mfma_f32_16x16x32_bf16 v[20:23], a[244:247], v[100:103], v[20:23]
    s_waitcnt lgkmcnt(2)
    v_exp_f32 v133, v53
    v_mfma_f32_16x16x32_bf16 v[64:67], a[200:203], a[104:107], v[64:67]
    v_cvt_pk_bf16_f32 v104, v128, v129
    v_cvt_pk_bf16_f32 v107, v134, v135
    v_mfma_f32_16x16x32_bf16 v[64:67], a[204:207], a[108:111], v[64:67]
    buffer_store_dwordx4 v[136:139], v12, s[16:19], s24 offen offset:0 sc0 sc1 nt
    ds_read_b128 a[228:231], v2 offset:19456
    v_exp_f32 v130, v50
    v_mfma_f32_16x16x32_bf16 v[64:67], a[208:211], a[112:115], v[64:67]
    s_waitcnt lgkmcnt(2)
    ds_read_b128 a[236:239], v2 offset:20480
    v_mfma_f32_16x16x32_bf16 v[64:67], a[212:215], a[116:119], v[64:67]
    v_cvt_pk_bf16_f32 v106, v132, v133
    v_cvt_pk_bf16_f32 v105, v130, v131
    v_mfma_f32_16x16x32_bf16 v[72:75], a[192:195], a[120:123], 0
    ds_read_b128 a[220:223], v2 offset:18432
    v_mfma_f32_16x16x32_bf16 v[20:23], a[248:251], v[104:107], v[20:23]
    ds_read_b128 a[216:219], v1 offset:18432
    v_mfma_f32_16x16x32_bf16 v[72:75], a[196:199], a[124:127], v[72:75]
    ds_read_b128 a[232:235], v1 offset:20480
    v_mfma_f32_16x16x32_bf16 v[72:75], a[200:203], a[128:131], v[72:75]
    buffer_store_dwordx4 v[140:143], v12, s[16:19], s24 offen offset:3072 sc0 sc1 nt
    s_nop 2
    v_cmp_lt_f32 vcc, s29, v20
    v_mfma_f32_16x16x32_bf16 v[72:75], a[204:207], a[132:135], v[72:75]
    ds_read_b128 v[136:139], v13 offset:2048
    v_mfma_f32_16x16x32_bf16 v[72:75], a[208:211], a[136:139], v[72:75]
    ds_read_b128 v[140:143], v13 offset:3072
    v_mfma_f32_16x16x32_bf16 v[72:75], a[212:215], a[140:143], v[72:75]
    s_cbranch_vccnz L_rs_tr33a
L_ret_tr33a:
    v_fma_f32 v64, v64, s28, v16
    v_mfma_f32_16x16x32_bf16 v[80:83], a[192:195], a[144:147], 0
    v_fma_f32 v67, v67, s28, v16
    v_fma_f32 v66, v66, s28, v16
    v_mfma_f32_16x16x32_bf16 v[80:83], a[196:199], a[148:151], v[80:83]
    v_exp_f32 v128, v64
    v_mfma_f32_16x16x32_bf16 v[80:83], a[200:203], a[152:155], v[80:83]
    s_add_u32 s57, s24, 128
    v_exp_f32 v130, v66
    v_mfma_f32_16x16x32_bf16 v[80:83], a[204:207], a[156:159], v[80:83]
    v_fma_f32 v65, v65, s28, v16
    s_waitcnt vmcnt(8) lgkmcnt(2)
    v_mfma_f32_16x16x32_bf16 v[80:83], a[208:211], a[160:163], v[80:83]
    s_barrier
    v_mfma_f32_16x16x32_bf16 v[80:83], a[212:215], a[164:167], v[80:83]
    s_add_u32 m0, s22, 12288
    ds_read_b64_tr_b16 a[192:193], v3 offset:0
    v_mfma_f32_16x16x32_bf16 v[68:71], a[216:219], a[96:99], 0
    ds_read_b64_tr_b16 a[194:195], v3 offset:6144
    v_fma_f32 v73, v73, s28, v17
    v_mfma_f32_16x16x32_bf16 v[68:71], a[220:223], a[100:103], v[68:71]
    buffer_load_dwordx4 v9, s[4:7], s20 offen lds
    v_mfma_f32_16x16x32_bf16 v[68:71], a[224:227], a[104:107], v[68:71]
    s_waitcnt lgkmcnt(2)
    buffer_store_dwordx4 v[136:139], v12, s[16:19], s57 offen offset:0 sc0 sc1 nt
    ds_read_b64_tr_b16 a[196:197], v4 offset:0
    v_exp_f32 v129, v65
    v_mfma_f32_16x16x32_bf16 v[68:71], a[228:231], a[108:111], v[68:71]
    v_mfma_f32_16x16x32_bf16 v[68:71], a[232:235], a[112:115], v[68:71]
    s_add_u32 s20, s20, 128
    s_add_u32 m0, s22, 13312
    ds_read_b64_tr_b16 a[198:199], v4 offset:6144
    v_mfma_f32_16x16x32_bf16 v[68:71], a[236:239], a[116:119], v[68:71]
    buffer_load_dwordx4 v9, s[4:7], s20 offen lds
    v_mfma_f32_16x16x32_bf16 v[76:79], a[216:219], a[120:123], 0
    ds_read_b64_tr_b16 a[200:201], v5 offset:0
    v_mfma_f32_16x16x32_bf16 v[76:79], a[220:223], a[124:127], v[76:79]
    ds_read_b64_tr_b16 a[202:203], v5 offset:6144
    v_mfma_f32_16x16x32_bf16 v[76:79], a[224:227], a[128:131], v[76:79]
    ds_read_b64_tr_b16 a[204:205], v6 offset:0
    v_cvt_pk_bf16_f32 v112, v128, v129
    v_mfma_f32_16x16x32_bf16 v[76:79], a[228:231], a[132:135], v[76:79]
    ds_read_b64_tr_b16 a[206:207], v6 offset:6144
    v_fma_f32 v72, v72, s28, v17
    v_mfma_f32_16x16x32_bf16 v[76:79], a[232:235], a[136:139], v[76:79]
    v_exp_f32 v132, v72
    v_mfma_f32_16x16x32_bf16 v[76:79], a[236:239], a[140:143], v[76:79]
    s_add_u32 s20, s20, 128
    ds_read_b64_tr_b16 a[208:209], v3 offset:1024
    v_mfma_f32_16x16x32_bf16 v[84:87], a[216:219], a[144:147], 0
    v_exp_f32 v131, v67
    v_mfma_f32_16x16x32_bf16 v[84:87], a[220:223], a[148:151], v[84:87]
    v_cvt_pk_bf16_f32 v113, v130, v131
    v_mfma_f32_16x16x32_bf16 v[84:87], a[224:227], a[152:155], v[84:87]
    buffer_store_dwordx4 v[140:143], v12, s[16:19], s57 offen offset:3072 sc0 sc1 nt
    ds_read_b64_tr_b16 a[210:211], v3 offset:7168
    v_exp_f32 v133, v73
    v_mfma_f32_16x16x32_bf16 v[84:87], a[228:231], a[156:159], v[84:87]
    s_add_u32 m0, s22, 14336
    ds_read_b64_tr_b16 a[212:213], v4 offset:1024
    v_cvt_pk_bf16_f32 v116, v132, v133
    v_mfma_f32_16x16x32_bf16 v[84:87], a[232:235], a[160:163], v[84:87]
    buffer_load_dwordx4 v9, s[4:7], s20 offen lds
    v_mfma_f32_16x16x32_bf16 v[84:87], a[236:239], a[164:167], v[84:87]
    ds_read_b64_tr_b16 a[214:215], v4 offset:7168
    s_add_u32 s20, s20, 12032
    s_waitcnt lgkmcnt(10)
    v_mfma_f32_16x16x32_bf16 v[160:163], a[192:195], v[96:99], v[160:163]
    ds_read_b64_tr_b16 a[218:219], v5 offset:7168
    v_fma_f32 v69, v69, s28, v16
    v_mfma_f32_16x16x32_bf16 v[208:211], a[192:195], v[100:103], v[208:211]
    ds_read_b64_tr_b16 a[238:239], v6 offset:8192
    v_xor_b32 v8, 64, v7
    v_mfma_f32_16x16x32_bf16 a[0:3], a[192:195], v[104:107], a[0:3]
    ds_read_b64_tr_b16 a[216:217], v5 offset:1024
    s_waitcnt lgkmcnt(11)
    v_mfma_f32_16x16x32_bf16 v[164:167], a[196:199], v[96:99], v[164:167]
    ds_read_b128 a[116:119], v8 offset:4096
    v_fma_f32 v70, v70, s28, v16
    v_mfma_f32_16x16x32_bf16 v[212:215], a[196:199], v[100:103], v[212:215]
    ds_read_b64_tr_b16 a[224:225], v3 offset:2048
    v_mfma_f32_16x16x32_bf16 a[4:7], a[196:199], v[104:107], a[4:7]
    ds_read_b64_tr_b16 a[232:233], v5 offset:2048
    s_waitcnt lgkmcnt(12)
    v_mfma_f32_16x16x32_bf16 v[168:171], a[200:203], v[96:99], v[168:171]
    ds_read_b64_tr_b16 a[230:231], v4 offset:8192
    ds_read_b64_tr_b16 a[220:221], v6 offset:1024
    v_mfma_f32_16x16x32_bf16 v[216:219], a[200:203], v[100:103], v[216:219]
    ds_read_b64_tr_b16 a[236:237], v6 offset:2048
    v_fma_f32 v86, v86, s28, v18
    v_mfma_f32_16x16x32_bf16 a[8:11], a[200:203], v[104:107], a[8:11]
    s_waitcnt lgkmcnt(12)
    ds_read_b128 a[140:143], v8 offset:10240
    v_fma_f32 v76, v76, s28, v17
    v_mfma_f32_16x16x32_bf16 v[172:175], a[204:207], v[96:99], v[172:175]
    ds_read_b64_tr_b16 a[228:229], v4 offset:2048
    ds_read_b64_tr_b16 a[222:223], v6 offset:7168
    v_mfma_f32_16x16x32_bf16 v[220:223], a[204:207], v[100:103], v[220:223]
    ds_read_b64_tr_b16 a[234:235], v5 offset:8192
    ds_read_b64_tr_b16 a[226:227], v3 offset:8192
    v_mfma_f32_16x16x32_bf16 a[12:15], a[204:207], v[104:107], a[12:15]
    s_waitcnt lgkmcnt(12)
    ds_read_b128 a[120:123], v7 offset:6144
    v_fma_f32 v81, v81, s28, v18
    v_mfma_f32_16x16x32_bf16 v[176:179], a[208:211], v[96:99], v[176:179]
    ds_read_b128 a[128:131], v7 offset:8192
    v_fma_f32 v68, v68, s28, v16
    v_mfma_f32_16x16x32_bf16 v[224:227], a[208:211], v[100:103], v[224:227]
    ds_read_b128 a[124:127], v8 offset:6144
    v_fma_f32 v78, v78, s28, v17
    v_mfma_f32_16x16x32_bf16 a[16:19], a[208:211], v[104:107], a[16:19]
    ds_read_b128 a[144:147], v7 offset:12288
    v_fma_f32 v87, v87, s28, v18
    v_mfma_f32_16x16x32_bf16 v[180:183], a[212:215], v[96:99], v[180:183]
    ds_read_b128 a[96:99], v7 offset:0
    v_exp_f32 v135, v69
    v_mfma_f32_16x16x32_bf16 v[228:231], a[212:215], v[100:103], v[228:231]
    ds_read_b128 a[104:107], v7 offset:2048
    v_exp_f32 v134, v68
    v_mfma_f32_16x16x32_bf16 a[20:23], a[212:215], v[104:107], a[20:23]
    s_waitcnt lgkmcnt(11)
    ds_read_b128 a[108:111], v8 offset:2048
    v_fma_f32 v71, v71, s28, v16
    v_mfma_f32_16x16x32_bf16 v[184:187], a[216:219], v[96:99], v[184:187]
    v_exp_f32 v132, v76
    v_mfma_f32_16x16x32_bf16 v[232:235], a[216:219], v[100:103], v[232:235]
    ds_read_b128 a[152:155], v7 offset:14336
    v_fma_f32 v82, v82, s28, v18
    v_mfma_f32_16x16x32_bf16 a[24:27], a[216:219], v[104:107], a[24:27]
    ds_read_b128 a[100:103], v8 offset:0
    s_waitcnt vmcnt(10) lgkmcnt(8)
    v_mfma_f32_16x16x32_bf16 v[188:191], a[220:223], v[96:99], v[188:191]
    s_barrier
    ds_read_b128 a[208:211], v1 offset:2048
    v_mfma_f32_16x16x32_bf16 v[236:239], a[220:223], v[100:103], v[236:239]
    v_exp_f32 v128, v70
    v_mfma_f32_16x16x32_bf16 a[28:31], a[220:223], v[104:107], a[28:31]
    s_add_u32 m0, s22, 24576
    ds_read_b128 a[192:195], v1 offset:0
    v_fma_f32 v80, v80, s28, v18
    v_mfma_f32_16x16x32_bf16 v[192:195], a[224:227], v[96:99], v[192:195]
    ds_read_b128 a[220:223], v2 offset:6144
    v_exp_f32 v129, v71
    v_mfma_f32_16x16x32_bf16 v[240:243], a[224:227], v[100:103], v[240:243]
    ds_read_b128 a[200:203], v1 offset:1024
    buffer_load_dwordx4 v9, s[8:11], s21 offen lds
    v_mfma_f32_16x16x32_bf16 a[32:35], a[224:227], v[104:107], a[32:35]
    ds_read_b128 a[196:199], v2 offset:0
    v_fma_f32 v79, v79, s28, v17
    v_mfma_f32_16x16x32_bf16 v[196:199], a[228:231], v[96:99], v[196:199]
    s_add_u32 s21, s21, 128
    ds_read_b128 a[160:163], v7 offset:16384
    v_fma_f32 v77, v77, s28, v17
    v_mfma_f32_16x16x32_bf16 v[244:247], a[228:231], v[100:103], v[244:247]
    ds_read_b128 a[204:207], v2 offset:1024
    v_cvt_pk_bf16_f32 v115, v128, v129
    v_mfma_f32_16x16x32_bf16 a[36:39], a[228:231], v[104:107], a[36:39]
    s_add_u32 m0, s22, 25600
    ds_read_b128 a[216:219], v1 offset:6144
    v_cvt_pk_bf16_f32 v114, v134, v135
    v_mfma_f32_16x16x32_bf16 v[200:203], a[232:235], v[96:99], v[200:203]
    ds_read_b128 a[112:115], v7 offset:4096
    buffer_load_dwordx4 v9, s[8:11], s21 offen lds
    v_mfma_f32_16x16x32_bf16 v[248:251], a[232:235], v[100:103], v[248:251]
    ds_read_b128 a[212:215], v2 offset:2048
    v_fma_f32 v84, v84, s28, v18
    v_mfma_f32_16x16x32_bf16 a[40:43], a[232:235], v[104:107], a[40:43]
    s_add_u32 s21, s21, 128
    ds_read_b128 a[132:135], v8 offset:8192
    v_fma_f32 v74, v74, s28, v17
    v_mfma_f32_16x16x32_bf16 v[204:207], a[236:239], v[96:99], v[204:207]
    ds_read_b128 a[148:151], v8 offset:12288
    v_fma_f32 v75, v75, s28, v17
    v_mfma_f32_16x16x32_bf16 v[252:255], a[236:239], v[100:103], v[252:255]
    ds_read_b128 a[136:139], v7 offset:10240
    s_add_u32 m0, s22, 26624
    v_mfma_f32_16x16x32_bf16 a[44:47], a[236:239], v[104:107], a[44:47]
    s_waitcnt lgkmcnt(9)
    v_exp_f32 v134, v78
    v_mfma_f32_16x16x32_bf16 v[32:35], a[192:195], a[96:99], 0
    s_waitcnt lgkmcnt(8)
    v_exp_f32 v135, v79
    v_mfma_f32_16x16x32_bf16 v[32:35], a[196:199], a[100:103], v[32:35]
    buffer_load_dwordx4 v9, s[8:11], s21 offen lds
    v_mfma_f32_16x16x32_bf16 v[32:35], a[200:203], a[104:107], v[32:35]
    s_waitcnt lgkmcnt(6)
    ds_read_b128 a[164:167], v8 offset:16384
    v_fma_f32 v85, v85, s28, v18
    v_mfma_f32_16x16x32_bf16 v[32:35], a[204:207], a[108:111], v[32:35]
    ds_read_b128 a[156:159], v8 offset:14336
    s_waitcnt lgkmcnt(6)
    v_mfma_f32_16x16x32_bf16 v[32:35], a[208:211], a[112:115], v[32:35]
    ds_read_b128 a[228:231], v2 offset:7168
    s_waitcnt lgkmcnt(6)
    v_mfma_f32_16x16x32_bf16 v[32:35], a[212:215], a[116:119], v[32:35]
    ds_read_b128 a[236:239], v2 offset:8192
    v_fma_f32 v83, v83, s28, v18
    v_mfma_f32_16x16x32_bf16 v[40:43], a[192:195], a[120:123], 0
    ds_read_b128 a[232:235], v1 offset:8192
    v_cvt_pk_bf16_f32 v119, v134, v135
    v_mfma_f32_16x16x32_bf16 v[40:43], a[196:199], a[124:127], v[40:43]
    v_exp_f32 v129, v81
    v_mfma_f32_16x16x32_bf16 v[40:43], a[200:203], a[128:131], v[40:43]
    s_waitcnt lgkmcnt(5)
    ds_read_b128 a[224:227], v1 offset:7168
    v_mfma_f32_16x16x32_bf16 v[40:43], a[204:207], a[132:135], v[40:43]
    v_exp_f32 v130, v74
    v_mfma_f32_16x16x32_bf16 v[40:43], a[208:211], a[136:139], v[40:43]
    v_exp_f32 v131, v75
    v_mfma_f32_16x16x32_bf16 v[40:43], a[212:215], a[140:143], v[40:43]
    v_exp_f32 v135, v87
    v_mfma_f32_16x16x32_bf16 v[24:27], a[240:243], v[112:115], v[20:23]
    s_add_u32 s21, s21, 12032
    v_exp_f32 v128, v80
    v_mfma_f32_16x16x32_bf16 v[48:51], a[192:195], a[144:147], 0
    v_exp_f32 v133, v77
    v_mfma_f32_16x16x32_bf16 v[48:51], a[196:199], a[148:151], v[48:51]
    v_cvt_pk_bf16_f32 v118, v132, v133
    v_cvt_pk_bf16_f32 v117, v130, v131
    v_mfma_f32_16x16x32_bf16 v[48:51], a[200:203], a[152:155], v[48:51]
    s_waitcnt lgkmcnt(2)
    v_exp_f32 v130, v82
    v_mfma_f32_16x16x32_bf16 v[48:51], a[204:207], a[156:159], v[48:51]
    v_exp_f32 v131, v83
    v_mfma_f32_16x16x32_bf16 v[24:27], a[244:247], v[116:119], v[24:27]
    v_exp_f32 v132, v84
    v_mfma_f32_16x16x32_bf16 v[48:51], a[208:211], a[160:163], v[48:51]
    s_waitcnt vmcnt(10) lgkmcnt(0)
    v_cvt_pk_bf16_f32 v121, v130, v131
    v_mfma_f32_16x16x32_bf16 v[48:51], a[212:215], a[164:167], v[48:51]
    s_barrier
    v_mfma_f32_16x16x32_bf16 v[36:39], a[216:219], a[96:99], 0
    v_exp_f32 v133, v85
    v_mfma_f32_16x16x32_bf16 v[36:39], a[220:223], a[100:103], v[36:39]
    ds_read_b64_tr_b16 a[192:193], v3 offset:12288
    v_mfma_f32_16x16x32_bf16 v[36:39], a[224:227], a[104:107], v[36:39]
    ds_read_b64_tr_b16 a[194:195], v3 offset:18432
    v_cvt_pk_bf16_f32 v122, v132, v133
    v_mfma_f32_16x16x32_bf16 v[36:39], a[228:231], a[108:111], v[36:39]
    v_exp_f32 v134, v86
    v_mfma_f32_16x16x32_bf16 v[36:39], a[232:235], a[112:115], v[36:39]
    ds_read_b64_tr_b16 a[196:197], v4 offset:12288
    v_mfma_f32_16x16x32_bf16 v[36:39], a[236:239], a[116:119], v[36:39]
    ds_read_b64_tr_b16 a[198:199], v4 offset:18432
    s_add_u32 m0, s22, 0
    v_mfma_f32_16x16x32_bf16 v[44:47], a[216:219], a[120:123], 0
    ds_read_b64_tr_b16 a[200:201], v5 offset:12288
    v_mfma_f32_16x16x32_bf16 v[44:47], a[220:223], a[124:127], v[44:47]
    v_cvt_pk_bf16_f32 v123, v134, v135
    v_cvt_pk_bf16_f32 v120, v128, v129
    v_mfma_f32_16x16x32_bf16 v[44:47], a[224:227], a[128:131], v[44:47]
    buffer_load_dwordx4 v9, s[4:7], s20 offen lds
    v_mfma_f32_16x16x32_bf16 v[24:27], a[248:251], v[120:123], v[24:27]
    s_add_u32 s20, s20, 128
    s_add_u32 m0, s22, 1024
    ds_read_b64_tr_b16 a[202:203], v5 offset:18432
    v_mfma_f32_16x16x32_bf16 v[44:47], a[228:231], a[132:135], v[44:47]
    buffer_load_dwordx4 v9, s[4:7], s20 offen lds
    v_mfma_f32_16x16x32_bf16 v[44:47], a[232:235], a[136:139], v[44:47]
    ds_read_b64_tr_b16 a[204:205], v6 offset:12288
    v_mfma_f32_16x16x32_bf16 v[44:47], a[236:239], a[140:143], v[44:47]
    ds_read_b64_tr_b16 a[206:207], v6 offset:18432
    v_mfma_f32_16x16x32_bf16 v[52:55], a[216:219], a[144:147], 0
    s_add_u32 s20, s20, 128
    ds_read_b64_tr_b16 a[208:209], v3 offset:13312
    s_add_u32 m0, s22, 2048
    v_mfma_f32_16x16x32_bf16 v[52:55], a[220:223], a[148:151], v[52:55]
    ds_read_b64_tr_b16 a[210:211], v3 offset:19456
    v_cmp_lt_f32 vcc, s29, v24
    v_mfma_f32_16x16x32_bf16 v[52:55], a[224:227], a[152:155], v[52:55]
    buffer_load_dwordx4 v9, s[4:7], s20 offen lds
    v_mfma_f32_16x16x32_bf16 v[52:55], a[228:231], a[156:159], v[52:55]
    ds_read_b64_tr_b16 a[212:213], v4 offset:13312
    v_mfma_f32_16x16x32_bf16 v[52:55], a[232:235], a[160:163], v[52:55]
    s_cbranch_vccnz L_rs_tr33b
L_ret_tr33b:
    ds_read_b64_tr_b16 a[214:215], v4 offset:19456
    v_mfma_f32_16x16x32_bf16 v[52:55], a[236:239], a[164:167], v[52:55]
    s_add_u32 s20, s20, 12032
    s_waitcnt lgkmcnt(10)
    v_mfma_f32_16x16x32_bf16 v[160:163], a[192:195], v[112:115], v[160:163]
    s_add_u32 s24, s34, 128
    ds_read_b64_tr_b16 a[228:229], v4 offset:14336
    v_max3_f32 v30, v40, v41, v42
    v_mov_b32 v153, v24
    v_max3_f32 v28, v32, v33, v34
    v_max3_f32 v28, v28, v35, v36
    v_max3_f32 v28, v28, v37, v38
    v_mfma_f32_16x16x32_bf16 v[208:211], a[192:195], v[116:119], v[208:211]
    s_add_u32 s18, s34, 18432
    ds_read_b64_tr_b16 a[218:219], v5 offset:19456
    v_max3_f32 v30, v30, v43, v44
    v_mfma_f32_16x16x32_bf16 a[0:3], a[192:195], v[120:123], a[0:3]
    s_waitcnt lgkmcnt(10)
    v_max3_f32 v30, v30, v45, v46
    v_max_f32 v28, v28, v39
    v_mfma_f32_16x16x32_bf16 v[164:167], a[196:199], v[112:115], v[164:167]
    s_mov_b32 s34, s33
    ds_read_b64_tr_b16 a[222:223], v6 offset:19456
    v_mov_b32 v29, v28
    v_mfma_f32_16x16x32_bf16 v[212:215], a[196:199], v[116:119], v[212:215]
    s_add_u32 s37, s37, 1
    v_accvgpr_read_b32 v145, a1
    v_max_f32 v30, v30, v47
    v_permlane32_swap_b32 v29, v28
    s_add_u32 s35, s35, 325632
    v_mfma_f32_16x16x32_bf16 a[4:7], a[196:199], v[120:123], a[4:7]
    s_waitcnt lgkmcnt(9)
    ds_read_b64_tr_b16 a[220:221], v6 offset:13312
    v_max_f32 v28, v28, v29
    v_mfma_f32_16x16x32_bf16 v[168:171], a[200:203], v[112:115], v[168:171]
    s_lshl_b32 s42, s37, 1
    ds_read_b64_tr_b16 a[216:217], v5 offset:13312
    s_lshr_b32 s42, s31, s42
    s_xor_b32 s42, s42, s36
    v_mfma_f32_16x16x32_bf16 v[216:219], a[200:203], v[116:119], v[216:219]
    s_and_b32 s42, s42, 3
    v_rcp_f32 v154, v25
    v_mfma_f32_16x16x32_bf16 a[8:11], a[200:203], v[120:123], a[8:11]
    s_waitcnt lgkmcnt(4)
    ds_read_b64_tr_b16 a[238:239], v6 offset:20480
    v_mov_b32 v31, v30
    v_mov_b32 v29, v28
    v_mfma_f32_16x16x32_bf16 v[172:175], a[204:207], v[112:115], v[172:175]
    s_mul_i32 s43, s3, 3
    v_permlane32_swap_b32 v31, v30
    v_permlane16_swap_b32 v29, v28
    v_mfma_f32_16x16x32_bf16 v[220:223], a[204:207], v[116:119], v[220:223]
    s_lshl_b32 s44, s3, 2
    v_max_f32 v30, v30, v31
    v_max_f32 v28, v28, v29
    v_mfma_f32_16x16x32_bf16 a[12:15], a[204:207], v[120:123], a[12:15]
    s_mov_b32 s32, 1
    ds_read_b64_tr_b16 a[236:237], v6 offset:14336
    v_mul_f32_e64 v16, -s28, v28
    v_mfma_f32_16x16x32_bf16 v[176:179], a[208:211], v[112:115], v[176:179]
    s_add_u32 s45, s43, 17
    ds_read_b64_tr_b16 a[226:227], v3 offset:20480
    v_fma_f32 v35, v35, s28, v16
    v_accvgpr_read_b32 v149, a5
    v_mfma_f32_16x16x32_bf16 v[224:227], a[208:211], v[116:119], v[224:227]
    s_cmp_eq_u32 s3, 0
    ds_read_b64_tr_b16 a[234:235], v5 offset:20480
    v_max3_f32 v28, v48, v49, v50
    v_mfma_f32_16x16x32_bf16 a[16:19], a[208:211], v[120:123], a[16:19]
    s_cselect_b32 s45, 16, s45
    v_max3_f32 v28, v28, v51, v52
    v_fma_f32 v36, v36, s28, v16
    s_cselect_b32 s33, 1, 0
    v_mfma_f32_16x16x32_bf16 v[180:183], a[212:215], v[112:115], v[180:183]
    s_cmp_eq_u32 s42, 1
    ds_read_b64_tr_b16 a[232:233], v5 offset:14336
    v_fma_f32 v34, v34, s28, v16
    v_mfma_f32_16x16x32_bf16 v[228:231], a[212:215], v[116:119], v[228:231]
    s_cselect_b32 s44, s45, s44
    ds_read_b64_tr_b16 a[224:225], v3 offset:14336
    v_mov_b32 v31, v30
    v_mfma_f32_16x16x32_bf16 a[20:23], a[212:215], v[120:123], a[20:23]
    s_waitcnt lgkmcnt(5)
    ds_read_b64_tr_b16 a[230:231], v4 offset:20480
    v_max3_f32 v28, v28, v53, v54
    v_mfma_f32_16x16x32_bf16 v[184:187], a[216:219], v[112:115], v[184:187]
    s_cselect_b32 s32, s33, s32
    v_permlane16_swap_b32 v31, v30
    v_mfma_f32_16x16x32_bf16 v[232:235], a[216:219], v[116:119], v[232:235]
    s_add_u32 s45, s43, 29
    v_max_f32 v28, v28, v55
    v_fma_f32 v38, v38, s28, v16
    v_mfma_f32_16x16x32_bf16 a[24:27], a[216:219], v[120:123], a[24:27]
    s_cmp_eq_u32 s42, 2
    v_rcp_f32 v156, v26
    v_mfma_f32_16x16x32_bf16 v[188:191], a[220:223], v[112:115], v[188:191]
    s_cselect_b32 s44, s45, s44
    v_max_f32 v30, v30, v31
    v_mov_b32 v152, v24
    s_cselect_b32 s32, 0, s32
    s_add_u32 s45, s43, 41
    v_fma_f32 v37, v37, s28, v16
    v_pk_mul_f32 v[228:229], v[228:229], v[154:155] op_sel_hi:[1,0]
    v_pk_mul_f32 v[208:209], v[208:209], v[154:155] op_sel_hi:[1,0]
    v_mov_b32 v29, v28
    v_pk_mul_f32 v[212:213], v[212:213], v[154:155] op_sel_hi:[1,0]
    v_pk_mul_f32 v[210:211], v[210:211], v[154:155] op_sel_hi:[1,0]
    v_mul_f32_e64 v17, -s28, v30
    v_permlane16_swap_b32 v152, v153
    s_cmp_eq_u32 s42, 3
    v_mfma_f32_16x16x32_bf16 v[236:239], a[220:223], v[116:119], v[236:239]
    s_cselect_b32 s44, s45, s44
    v_permlane32_swap_b32 v29, v28
    v_fma_f32 v41, v41, s28, v17
    v_max_f32 v28, v28, v29
    s_cselect_b32 s32, 0, s32
    v_accvgpr_read_b32 v146, a2
    v_fma_f32 v44, v44, s28, v17
    v_rcp_f32 v152, v152
    v_mfma_f32_16x16x32_bf16 a[28:31], a[220:223], v[120:123], a[28:31]
    s_mul_i32 s44, s44, 6144
    s_add_u32 s33, s35, s44
    s_waitcnt lgkmcnt(0)
    v_mfma_f32_16x16x32_bf16 v[192:195], a[224:227], v[112:115], v[192:195]
    s_mul_i32 s42, s32, 6144
    s_add_u32 s42, s42, 18432
    v_fma_f32 v42, v42, s28, v17
    v_mfma_f32_16x16x32_bf16 v[240:243], a[224:227], v[116:119], v[240:243]
    s_add_u32 s42, s42, s33
    v_mov_b32 v29, v28
    v_accvgpr_read_b32 v144, a0
    s_cmp_ge_u32 s37, 8
    v_mfma_f32_16x16x32_bf16 a[32:35], a[224:227], v[120:123], a[32:35]
    s_cselect_b32 s14, 0, s42
    v_fma_f32 v33, v33, s28, v16
    v_exp_f32 v129, v33
    v_subrev_u32 v13, 20480, v13
    v_mfma_f32_16x16x32_bf16 v[196:199], a[228:231], v[112:115], v[196:199]
    s_add_u32 s25, s33, 128
    v_accvgpr_read_b32 v151, a7
    s_add_u32 s23, s38, 2048
    s_mov_b32 s30, 0
    v_mfma_f32_16x16x32_bf16 v[244:247], a[228:231], v[116:119], v[244:247]
    s_waitcnt vmcnt(6)
    v_fma_f32 v32, v32, s28, v16
    v_permlane16_swap_b32 v29, v28
    v_cvt_pk_bf16_f32 v228, v228, v229
    v_mfma_f32_16x16x32_bf16 a[36:39], a[228:231], v[120:123], a[36:39]
    s_barrier
    ds_read_b128 a[208:211], v1 offset:14336
    v_mfma_f32_16x16x32_bf16 v[200:203], a[232:235], v[112:115], v[200:203]
    ds_read_b128 a[212:215], v2 offset:14336
    v_exp_f32 v134, v36
    v_fma_f32 v40, v40, s28, v17
    v_exp_f32 v132, v40
    v_mfma_f32_16x16x32_bf16 v[248:251], a[232:235], v[116:119], v[248:251]
    s_add_u32 m0, s22, 36864
    ds_read_b128 a[200:203], v1 offset:13312
    v_fma_f32 v39, v39, s28, v16
    v_xor_b32 v8, 96, v14
    v_mfma_f32_16x16x32_bf16 a[40:43], a[232:235], v[120:123], a[40:43]
    ds_read_b128 a[196:199], v2 offset:12288
    v_exp_f32 v128, v32
    v_mfma_f32_16x16x32_bf16 v[204:207], a[236:239], v[112:115], v[204:207]
    ds_read_b128 a[192:195], v1 offset:12288
    v_max_f32 v28, v28, v29
    v_exp_f32 v131, v35
    v_mfma_f32_16x16x32_bf16 v[252:255], a[236:239], v[116:119], v[252:255]
    buffer_load_dwordx4 v9, s[8:11], s21 offen lds
    ds_read_b128 a[204:207], v2 offset:13312
    v_exp_f32 v135, v37
    v_mfma_f32_16x16x32_bf16 a[44:47], a[236:239], v[120:123], a[44:47]
    ds_read_b128 a[224:227], v1 offset:19456
    v_exp_f32 v133, v41
    v_accvgpr_read_b32 v150, a6
    v_fma_f32 v47, v47, s28, v17
    v_pk_mul_f32 v[172:173], v[172:173], v[152:153] op_sel_hi:[1,0]
    v_pk_mul_f32 v[176:177], v[176:177], v[152:153] op_sel_hi:[1,0]
    v_pk_mul_f32 v[162:163], v[162:163], v[152:153] op_sel_hi:[1,0]
    v_accvgpr_read_b32 v147, a3
    v_pk_mul_f32 v[182:183], v[182:183], v[152:153] op_sel_hi:[1,0]
    v_pk_mul_f32 v[190:191], v[190:191], v[152:153] op_sel_hi:[1,0]
    v_pk_mul_f32 v[206:207], v[206:207], v[152:153] op_sel_hi:[1,0]
    v_pk_mul_f32 v[164:165], v[164:165], v[152:153] op_sel_hi:[1,0]
    v_pk_mul_f32 v[240:241], v[240:241], v[154:155] op_sel_hi:[1,0]
    v_pk_mul_f32 v[214:215], v[214:215], v[154:155] op_sel_hi:[1,0]
    v_pk_mul_f32 v[252:253], v[252:253], v[154:155] op_sel_hi:[1,0]
    v_pk_mul_f32 v[222:223], v[222:223], v[154:155] op_sel_hi:[1,0]
    v_pk_mul_f32 v[180:181], v[180:181], v[152:153] op_sel_hi:[1,0]
    v_pk_mul_f32 v[146:147], v[146:147], v[156:157] op_sel_hi:[1,0]
    v_exp_f32 v130, v34
    v_pk_mul_f32 v[144:145], v[144:145], v[156:157] op_sel_hi:[1,0]
    v_pk_mul_f32 v[188:189], v[188:189], v[152:153] op_sel_hi:[1,0]
    v_pk_mul_f32 v[242:243], v[242:243], v[154:155] op_sel_hi:[1,0]
    v_mul_f32_e64 v18, -s28, v28
    s_waitcnt lgkmcnt(2)
    v_mfma_f32_16x16x32_bf16 v[64:67], a[192:195], a[96:99], 0
    ds_read_b128 a[232:235], v1 offset:20480
    v_cvt_pk_bf16_f32 v100, v132, v133
    v_mfma_f32_16x16x32_bf16 v[64:67], a[196:199], a[100:103], v[64:67]
    v_fma_f32 v46, v46, s28, v17
    v_cvt_pk_bf16_f32 v98, v134, v135
    v_cvt_pk_bf16_f32 v96, v128, v129
    v_mfma_f32_16x16x32_bf16 v[64:67], a[200:203], a[104:107], v[64:67]
    s_waitcnt lgkmcnt(2)
    v_cvt_pk_bf16_f32 v208, v208, v209
    v_fma_f32 v45, v45, s28, v17
    v_cvt_pk_bf16_f32 v212, v212, v213
    v_mfma_f32_16x16x32_bf16 v[64:67], a[204:207], a[108:111], v[64:67]
    ds_read_b128 a[220:223], v2 offset:18432
    v_cvt_pk_bf16_f32 v180, v180, v181
    v_mfma_f32_16x16x32_bf16 v[64:67], a[208:211], a[112:115], v[64:67]
    v_cvt_pk_bf16_f32 v144, v144, v145
    v_exp_f32 v132, v44
    v_mfma_f32_16x16x32_bf16 v[64:67], a[212:215], a[116:119], v[64:67]
    v_exp_f32 v134, v46
    v_fma_f32 v54, v54, s28, v18
    v_mfma_f32_16x16x32_bf16 v[72:75], a[192:195], a[120:123], 0
    v_cvt_pk_bf16_f32 v145, v146, v147
    v_cvt_pk_bf16_f32 v188, v188, v189
    v_mfma_f32_16x16x32_bf16 v[72:75], a[196:199], a[124:127], v[72:75]
    s_add_u32 s21, s21, 128
    v_cvt_pk_bf16_f32 v97, v130, v131
    v_exp_f32 v133, v45
    v_accvgpr_read_b32 v148, a4
    v_mfma_f32_16x16x32_bf16 v[72:75], a[200:203], a[128:131], v[72:75]
    ds_read_b128 a[228:231], v2 offset:19456
    v_fma_f32 v48, v48, s28, v18
    v_mfma_f32_16x16x32_bf16 v[72:75], a[204:207], a[132:135], v[72:75]
    v_accvgpr_read_b32 v146, a10
    v_accvgpr_read_b32 v147, a11
    v_fma_f32 v50, v50, s28, v18
    v_mfma_f32_16x16x32_bf16 v[72:75], a[208:211], a[136:139], v[72:75]
    v_exp_f32 v129, v39
    v_mfma_f32_16x16x32_bf16 v[72:75], a[212:215], a[140:143], v[72:75]
    v_xor_b32 v15, 64, v14
    v_fma_f32 v53, v53, s28, v18
    v_mfma_f32_16x16x32_bf16 v[80:83], a[192:195], a[144:147], 0
    s_add_u32 m0, s22, 37888
    ds_read_b128 a[216:219], v1 offset:18432
    v_cvt_pk_bf16_f32 v172, v172, v173
    v_fma_f32 v52, v52, s28, v18
    v_cvt_pk_bf16_f32 v252, v252, v253
    v_mfma_f32_16x16x32_bf16 v[80:83], a[196:199], a[148:151], v[80:83]
    v_exp_f32 v135, v47
    v_mfma_f32_16x16x32_bf16 v[80:83], a[200:203], a[152:155], v[80:83]
    buffer_load_dwordx4 v9, s[8:11], s21 offen lds
    v_cvt_pk_bf16_f32 v102, v132, v133
    v_mfma_f32_16x16x32_bf16 v[80:83], a[204:207], a[156:159], v[80:83]
    s_add_u32 s21, s21, 128
    v_fma_f32 v73, v73, s28, v17
    v_fma_f32 v55, v55, s28, v18
    v_fma_f32 v49, v49, s28, v18
    v_exp_f32 v133, v53
    v_cvt_pk_bf16_f32 v103, v134, v135
    v_pk_mul_f32 v[192:193], v[192:193], v[152:153] op_sel_hi:[1,0]
    v_pk_mul_f32 v[194:195], v[194:195], v[152:153] op_sel_hi:[1,0]
    v_pk_mul_f32 v[178:179], v[178:179], v[152:153] op_sel_hi:[1,0]
    v_exp_f32 v128, v38
    v_pk_mul_f32 v[250:251], v[250:251], v[154:155] op_sel_hi:[1,0]
    v_pk_mul_f32 v[146:147], v[146:147], v[156:157] op_sel_hi:[1,0]
    v_pk_mul_f32 v[148:149], v[148:149], v[156:157] op_sel_hi:[1,0]
    v_pk_mul_f32 v[160:161], v[160:161], v[152:153] op_sel_hi:[1,0]
    v_fma_f32 v64, v64, s28, v16
    v_pk_mul_f32 v[186:187], v[186:187], v[152:153] op_sel_hi:[1,0]
    v_fma_f32 v51, v51, s28, v18
    v_pk_mul_f32 v[196:197], v[196:197], v[152:153] op_sel_hi:[1,0]
    v_cvt_pk_bf16_f32 v99, v128, v129
    v_pk_mul_f32 v[168:169], v[168:169], v[152:153] op_sel_hi:[1,0]
    v_pk_mul_f32 v[226:227], v[226:227], v[154:155] op_sel_hi:[1,0]
    v_exp_f32 v132, v52
    v_pk_mul_f32 v[220:221], v[220:221], v[154:155] op_sel_hi:[1,0]
    v_pk_mul_f32 v[150:151], v[150:151], v[156:157] op_sel_hi:[1,0]
    v_pk_mul_f32 v[236:237], v[236:237], v[154:155] op_sel_hi:[1,0]
    v_pk_mul_f32 v[224:225], v[224:225], v[154:155] op_sel_hi:[1,0]
    v_cvt_pk_bf16_f32 v192, v192, v193
    v_fma_f32 v43, v43, s28, v17
    v_mfma_f32_16x16x32_bf16 v[80:83], a[208:211], a[160:163], v[80:83]
    ds_read_b128 a[236:239], v2 offset:20480
    v_exp_f32 v131, v43
    v_mfma_f32_16x16x32_bf16 v[80:83], a[212:215], a[164:167], v[80:83]
    s_waitcnt lgkmcnt(1)
    v_exp_f32 v135, v55
    v_mfma_f32_16x16x32_bf16 v[68:71], a[216:219], a[96:99], 0
    s_add_u32 m0, s22, 38912
    v_fma_f32 v72, v72, s28, v17
    v_exp_f32 v130, v42
    v_cvt_pk_bf16_f32 v160, v160, v161
    v_mfma_f32_16x16x32_bf16 v[68:71], a[220:223], a[100:103], v[68:71]
    buffer_load_dwordx4 v9, s[8:11], s21 offen lds
    v_cvt_pk_bf16_f32 v106, v132, v133
    v_fma_f32 v66, v66, s28, v16
    v_cvt_pk_bf16_f32 v209, v210, v211
    v_pk_mul_f32 v[218:219], v[218:219], v[154:155] op_sel_hi:[1,0]
    v_pk_mul_f32 v[170:171], v[170:171], v[152:153] op_sel_hi:[1,0]
    v_pk_mul_f32 v[216:217], v[216:217], v[154:155] op_sel_hi:[1,0]
    v_pk_mul_f32 v[166:167], v[166:167], v[152:153] op_sel_hi:[1,0]
    v_exp_f32 v129, v49
    v_exp_f32 v134, v54
    v_fma_f32 v65, v65, s28, v16
    v_cvt_pk_bf16_f32 v224, v224, v225
    v_cvt_pk_bf16_f32 v216, v216, v217
    v_cvt_pk_bf16_f32 v107, v134, v135
    v_fma_f32 v81, v81, s28, v18
    v_mfma_f32_16x16x32_bf16 v[68:71], a[224:227], a[104:107], v[68:71]
    s_add_u32 s21, s21, 12032
    v_cvt_pk_bf16_f32 v161, v162, v163
    v_cvt_pk_bf16_f32 v148, v148, v149
    v_mfma_f32_16x16x32_bf16 v[68:71], a[228:231], a[108:111], v[68:71]
    v_cvt_pk_bf16_f32 v236, v236, v237
    v_exp_f32 v128, v48
    v_mfma_f32_16x16x32_bf16 v[68:71], a[232:235], a[112:115], v[68:71]
    s_waitcnt vmcnt(6) lgkmcnt(0)
    ds_write2st64_b64 v14, v[160:161], v[208:209] offset0:0 offset1:12
    v_cvt_pk_bf16_f32 v220, v220, v221
    v_cvt_pk_bf16_f32 v101, v130, v131
    v_mfma_f32_16x16x32_bf16 v[68:71], a[236:239], a[116:119], v[68:71]
    s_barrier
    ds_read_b64_tr_b16 a[192:193], v3 offset:0
    v_mfma_f32_16x16x32_bf16 v[76:79], a[216:219], a[120:123], 0
    ds_read_b64_tr_b16 a[194:195], v3 offset:6144
    v_cvt_pk_bf16_f32 v149, v150, v151
    v_mfma_f32_16x16x32_bf16 v[76:79], a[220:223], a[124:127], v[76:79]
    ds_read_b64_tr_b16 a[196:197], v4 offset:0
    v_cvt_pk_bf16_f32 v164, v164, v165
    v_cvt_pk_bf16_f32 v221, v222, v223
    v_accvgpr_read_b32 v150, a14
    v_fma_f32 v69, v69, s28, v16
    v_mfma_f32_16x16x32_bf16 v[76:79], a[224:227], a[128:131], v[76:79]
    ds_write_b64 v14, v[144:145] offset:12288
    v_mfma_f32_16x16x32_bf16 v[76:79], a[228:231], a[132:135], v[76:79]
    ds_read_b64_tr_b16 a[198:199], v4 offset:6144
    v_cvt_pk_bf16_f32 v165, v166, v167
    v_mfma_f32_16x16x32_bf16 v[76:79], a[232:235], a[136:139], v[76:79]
    ds_read_b64_tr_b16 a[200:201], v5 offset:0
    v_fma_f32 v68, v68, s28, v16
    v_mfma_f32_16x16x32_bf16 v[76:79], a[236:239], a[140:143], v[76:79]
    s_add_u32 m0, s22, 12288
    ds_read_b64_tr_b16 a[202:203], v5 offset:6144
    v_exp_f32 v131, v51
    v_accvgpr_read_b32 v151, a15
    v_mfma_f32_16x16x32_bf16 v[84:87], a[216:219], a[144:147], 0
    ds_read_b64_tr_b16 a[204:205], v6 offset:0
    v_exp_f32 v130, v50
    v_mfma_f32_16x16x32_bf16 v[84:87], a[220:223], a[148:151], v[84:87]
    ds_read_b64_tr_b16 a[206:207], v6 offset:6144
    buffer_load_dwordx4 v9, s[4:7], s20 offen lds
    v_cvt_pk_bf16_f32 v168, v168, v169
    v_xor_b32 v0, 32, v14
    v_pk_mul_f32 v[232:233], v[232:233], v[154:155] op_sel_hi:[1,0]
    v_fma_f32 v74, v74, s28, v17
    v_accvgpr_read_b32 v145, a9
    v_pk_mul_f32 v[174:175], v[174:175], v[152:153] op_sel_hi:[1,0]
    v_accvgpr_read_b32 v144, a8
    v_exp_f32 v133, v73
    v_fma_f32 v75, v75, s28, v17
    v_pk_mul_f32 v[198:199], v[198:199], v[152:153] op_sel_hi:[1,0]
    v_pk_mul_f32 v[184:185], v[184:185], v[152:153] op_sel_hi:[1,0]
    v_pk_mul_f32 v[144:145], v[144:145], v[156:157] op_sel_hi:[1,0]
    v_fma_f32 v80, v80, s28, v18
    v_cvt_pk_bf16_f32 v169, v170, v171
    v_mfma_f32_16x16x32_bf16 v[84:87], a[224:227], a[152:155], v[84:87]
    s_add_u32 s20, s20, 128
    ds_read_b64_tr_b16 a[216:217], v5 offset:1024
    v_cvt_pk_bf16_f32 v104, v128, v129
    v_cvt_pk_bf16_f32 v144, v144, v145
    v_cvt_pk_bf16_f32 v213, v214, v215
    v_mfma_f32_16x16x32_bf16 v[84:87], a[228:231], a[156:159], v[84:87]
    s_add_u32 m0, s22, 13312
    ds_read_b64_tr_b16 a[208:209], v3 offset:1024
    v_cvt_pk_bf16_f32 v145, v146, v147
    v_fma_f32 v78, v78, s28, v17
    v_exp_f32 v135, v69
    v_pk_mul_f32 v[200:201], v[200:201], v[152:153] op_sel_hi:[1,0]
    v_cvt_pk_bf16_f32 v225, v226, v227
    v_fma_f32 v70, v70, s28, v16
    v_pk_mul_f32 v[230:231], v[230:231], v[154:155] op_sel_hi:[1,0]
    v_exp_f32 v134, v68
    v_pk_mul_f32 v[254:255], v[254:255], v[154:155] op_sel_hi:[1,0]
    v_cvt_pk_bf16_f32 v105, v130, v131
    v_pk_mul_f32 v[234:235], v[234:235], v[154:155] op_sel_hi:[1,0]
    v_cvt_pk_bf16_f32 v217, v218, v219
    v_exp_f32 v129, v65
    v_mfma_f32_16x16x32_bf16 v[84:87], a[232:235], a[160:163], v[84:87]
    ds_read_b64_tr_b16 a[224:225], v3 offset:2048
    buffer_load_dwordx4 v9, s[4:7], s20 offen lds
    v_mfma_f32_16x16x32_bf16 v[84:87], a[236:239], a[164:167], v[84:87]
    s_waitcnt lgkmcnt(3)
    ds_write2st64_b64 v0, v[164:165], v[212:213] offset0:0 offset1:12
    v_mfma_f32_16x16x32_bf16 v[160:163], a[192:195], v[96:99], 0
    s_add_u32 s20, s20, 128
    ds_write_b64 v0, v[148:149] offset:12288
    v_cvt_pk_bf16_f32 v176, v176, v177
    v_mfma_f32_16x16x32_bf16 v[208:211], a[192:195], v[100:103], 0
    ds_write2st64_b64 v15, v[168:169], v[216:217] offset0:0 offset1:12
    v_cvt_pk_bf16_f32 v177, v178, v179
    v_accvgpr_read_b32 v149, a13
    v_fma_f32 v82, v82, s28, v18
    v_pk_mul_f32 v[202:203], v[202:203], v[152:153] op_sel_hi:[1,0]
    v_pk_mul_f32 v[238:239], v[238:239], v[154:155] op_sel_hi:[1,0]
    v_exp_f32 v132, v72
    v_cvt_pk_bf16_f32 v184, v184, v185
    v_cvt_pk_bf16_f32 v173, v174, v175
    v_fma_f32 v83, v83, s28, v18
    v_fma_f32 v77, v77, s28, v17
    v_cvt_pk_bf16_f32 v229, v230, v231
    v_mfma_f32_16x16x32_bf16 a[0:3], a[192:195], v[104:107], 0
    ds_write_b64 v15, v[144:145] offset:12288
    v_mfma_f32_16x16x32_bf16 v[164:167], a[196:199], v[96:99], 0
    s_add_u32 m0, s22, 14336
    ds_read_b64_tr_b16 a[210:211], v3 offset:7168
    v_cvt_pk_bf16_f32 v116, v132, v133
    v_fma_f32 v71, v71, s28, v16
    v_mfma_f32_16x16x32_bf16 v[212:215], a[196:199], v[100:103], 0
    buffer_load_dwordx4 v9, s[4:7], s20 offen lds
    ds_read_b64_tr_b16 a[220:221], v6 offset:1024
    v_fma_f32 v87, v87, s28, v18
    v_accvgpr_read_b32 v146, a18
    v_cvt_pk_bf16_f32 v253, v254, v255
    v_mfma_f32_16x16x32_bf16 v[20:23], a[240:243], v[96:99], 0
    ds_write2st64_b64 v8, v[172:173], v[220:221] offset0:0 offset1:12
    v_fma_f32 v76, v76, s28, v17
    v_exp_f32 v128, v64
    v_mfma_f32_16x16x32_bf16 a[4:7], a[196:199], v[104:107], 0
    ds_read_b128 v[140:143], v13 offset:1024
    v_fma_f32 v67, v67, s28, v16
    v_exp_f32 v131, v67
    v_mfma_f32_16x16x32_bf16 v[168:171], a[200:203], v[96:99], 0
    ds_read_b128 v[136:139], v13 offset:0
    v_accvgpr_read_b32 v147, a19
    v_accvgpr_read_b32 v148, a12
    v_accvgpr_read_b32 v145, a17
    v_exp_f32 v130, v66
    v_pk_mul_f32 v[146:147], v[146:147], v[156:157] op_sel_hi:[1,0]
    v_accvgpr_read_b32 v144, a16
    v_pk_mul_f32 v[144:145], v[144:145], v[156:157] op_sel_hi:[1,0]
    v_pk_mul_f32 v[148:149], v[148:149], v[156:157] op_sel_hi:[1,0]
    v_pk_mul_f32 v[244:245], v[244:245], v[154:155] op_sel_hi:[1,0]
    v_pk_mul_f32 v[248:249], v[248:249], v[154:155] op_sel_hi:[1,0]
    v_cvt_pk_bf16_f32 v232, v232, v233
    v_cvt_pk_bf16_f32 v148, v148, v149
    v_pk_mul_f32 v[150:151], v[150:151], v[156:157] op_sel_hi:[1,0]
    v_cvt_pk_bf16_f32 v144, v144, v145
    v_pk_mul_f32 v[204:205], v[204:205], v[152:153] op_sel_hi:[1,0]
    v_cvt_pk_bf16_f32 v113, v130, v131
    v_cvt_pk_bf16_f32 v240, v240, v241
    v_cvt_pk_bf16_f32 v193, v194, v195
    v_cvt_pk_bf16_f32 v149, v150, v151
    v_cvt_pk_bf16_f32 v185, v186, v187
    v_cvt_pk_bf16_f32 v145, v146, v147
    v_pk_mul_f32 v[246:247], v[246:247], v[154:155] op_sel_hi:[1,0]
    v_accvgpr_read_b32 v151, a23
    v_cvt_pk_bf16_f32 v181, v182, v183
    v_mfma_f32_16x16x32_bf16 v[216:219], a[200:203], v[100:103], 0
    s_add_u32 s20, s20, 12032
    ds_write_b64 v8, v[148:149] offset:12288
    v_cvt_pk_bf16_f32 v196, v196, v197
    v_accvgpr_read_b32 v146, a26
    v_cvt_pk_bf16_f32 v189, v190, v191
    v_accvgpr_read_b32 v147, a27
    v_cvt_pk_bf16_f32 v244, v244, v245
    v_mfma_f32_16x16x32_bf16 a[8:11], a[200:203], v[104:107], 0
    s_add_u32 s56, s24, 4294967168
    ds_read_b64_tr_b16 a[218:219], v5 offset:7168
    ds_read_b64_tr_b16 a[212:213], v4 offset:1024
    v_mfma_f32_16x16x32_bf16 v[172:175], a[204:207], v[96:99], 0
    s_add_u32 s58, s25, 4294967168
    ds_write2st64_b64 v14, v[176:177], v[224:225] offset0:4 offset1:16
    v_cvt_pk_bf16_f32 v237, v238, v239
    v_mfma_f32_16x16x32_bf16 v[220:223], a[204:207], v[100:103], 0
    s_add_u32 m0, s38, 0
    ds_write_b64 v14, v[144:145] offset:14336
    v_accvgpr_read_b32 v150, a22
    v_mfma_f32_16x16x32_bf16 v[20:23], a[244:247], v[100:103], v[20:23]
    s_waitcnt lgkmcnt(5)
    ds_read_b64_tr_b16 a[234:235], v5 offset:8192
    buffer_load_dwordx4 v10, s[12:15], s58 offen nt lds
    ds_read_b64_tr_b16 a[214:215], v4 offset:7168
    v_mfma_f32_16x16x32_bf16 a[12:15], a[204:207], v[104:107], 0
    s_add_u32 m0, s38, 1024
    ds_read_b64_tr_b16 a[238:239], v6 offset:8192
    buffer_load_dwordx4 v11, s[12:15], s58 offen nt lds
    ds_read_b64_tr_b16 a[222:223], v6 offset:7168
    v_accvgpr_read_b32 v144, a24
    v_accvgpr_read_b32 v149, a21
    v_pk_mul_f32 v[146:147], v[146:147], v[156:157] op_sel_hi:[1,0]
    v_cvt_pk_bf16_f32 v233, v234, v235
    v_accvgpr_read_b32 v145, a25
    v_cvt_pk_bf16_f32 v204, v204, v205
    v_mfma_f32_16x16x32_bf16 v[176:179], a[208:211], v[96:99], 0
    buffer_store_dwordx4 v[136:139], v12, s[16:19], s56 offen offset:0 sc0 sc1 nt
    ds_write2st64_b64 v0, v[180:181], v[228:229] offset0:4 offset1:16
    v_exp_f32 v131, v75
    v_pk_mul_f32 v[144:145], v[144:145], v[156:157] op_sel_hi:[1,0]
    v_cvt_pk_bf16_f32 v200, v200, v201
    v_accvgpr_read_b32 v148, a20
    v_pk_mul_f32 v[148:149], v[148:149], v[156:157] op_sel_hi:[1,0]
    v_cvt_pk_bf16_f32 v144, v144, v145
    v_cvt_pk_bf16_f32 v145, v146, v147
    v_cvt_pk_bf16_f32 v114, v134, v135
    v_cvt_pk_bf16_f32 v112, v128, v129
    v_exp_f32 v129, v71
    v_pk_mul_f32 v[150:151], v[150:151], v[156:157] op_sel_hi:[1,0]
    v_exp_f32 v128, v70
    v_cvt_pk_bf16_f32 v148, v148, v149
    v_cvt_pk_bf16_f32 v149, v150, v151
    v_mfma_f32_16x16x32_bf16 v[224:227], a[208:211], v[100:103], 0
    ds_write_b64 v0, v[148:149] offset:14336
    v_fma_f32 v86, v86, s28, v18
    v_cvt_pk_bf16_f32 v115, v128, v129
    v_mfma_f32_16x16x32_bf16 a[16:19], a[208:211], v[104:107], 0
    s_waitcnt lgkmcnt(2)
    ds_read_b64_tr_b16 a[236:237], v6 offset:2048
    v_accvgpr_read_b32 v151, a31
    v_mfma_f32_16x16x32_bf16 v[180:183], a[212:215], v[96:99], 0
    ds_read_b128 v[136:139], v13 offset:6144
    v_accvgpr_read_b32 v147, a35
    v_mfma_f32_16x16x32_bf16 v[228:231], a[212:215], v[100:103], 0
    s_add_u32 s57, s24, 6016
    ds_write2st64_b64 v15, v[184:185], v[232:233] offset0:4 offset1:16
    v_mfma_f32_16x16x32_bf16 a[20:23], a[212:215], v[104:107], 0
    ds_write_b64 v15, v[144:145] offset:14336
    v_accvgpr_read_b32 v146, a34
    v_mfma_f32_16x16x32_bf16 v[20:23], a[248:251], v[104:107], v[20:23]
    buffer_store_dwordx4 v[140:143], v12, s[16:19], s56 offen offset:3072 sc0 sc1 nt
    s_add_u32 s59, s25, 6016
    ds_write2st64_b64 v8, v[188:189], v[236:237] offset0:4 offset1:16
    v_mfma_f32_16x16x32_bf16 v[184:187], a[216:219], v[96:99], 0
    s_add_u32 m0, s38, 6144
    ds_read_b128 v[140:143], v13 offset:7168
    v_accvgpr_read_b32 v148, a28
    v_accvgpr_read_b32 v144, a32
    v_cvt_pk_bf16_f32 v201, v202, v203
    v_accvgpr_read_b32 v149, a29
    v_exp_f32 v129, v81
    v_accvgpr_read_b32 v145, a33
    v_accvgpr_read_b32 v150, a30
    v_exp_f32 v132, v76
    v_pk_mul_f32 v[144:145], v[144:145], v[156:157] op_sel_hi:[1,0]
    v_pk_mul_f32 v[148:149], v[148:149], v[156:157] op_sel_hi:[1,0]
    v_cvt_pk_bf16_f32 v245, v246, v247
    v_fma_f32 v85, v85, s28, v18
    v_mfma_f32_16x16x32_bf16 v[232:235], a[216:219], v[100:103], 0
    s_waitcnt lgkmcnt(3)
    ds_read_b64_tr_b16 a[226:227], v3 offset:8192
    ds_read_b64_tr_b16 a[230:231], v4 offset:8192
    buffer_load_dwordx4 v10, s[12:15], s59 offen nt lds
    v_exp_f32 v130, v74
    v_cvt_pk_bf16_f32 v148, v148, v149
    v_pk_mul_f32 v[150:151], v[150:151], v[156:157] op_sel_hi:[1,0]
    v_pk_mul_f32 v[146:147], v[146:147], v[156:157] op_sel_hi:[1,0]
    v_cvt_pk_bf16_f32 v248, v248, v249
    v_exp_f32 v134, v78
    v_cvt_pk_bf16_f32 v149, v150, v151
    v_mfma_f32_16x16x32_bf16 a[24:27], a[216:219], v[104:107], 0
    buffer_store_dwordx4 v[136:139], v12, s[16:19], s57 offen offset:0 sc0 sc1 nt
    s_nop 0
    ds_read_b128 v[136:139], v13 offset:12288
    v_cvt_pk_bf16_f32 v144, v144, v145
    v_cvt_pk_bf16_f32 v241, v242, v243
    v_cvt_pk_bf16_f32 v249, v250, v251
    v_cvt_pk_bf16_f32 v205, v206, v207
    v_mfma_f32_16x16x32_bf16 v[188:191], a[220:223], v[96:99], 0
    ds_write_b64 v8, v[148:149] offset:14336
    v_mfma_f32_16x16x32_bf16 v[236:239], a[220:223], v[100:103], 0
    s_add_u32 m0, s38, 7168
    ds_write2st64_b64 v14, v[192:193], v[240:241] offset0:8 offset1:20
    v_accvgpr_read_b32 v148, a36
    v_mfma_f32_16x16x32_bf16 v[24:27], a[240:243], v[112:115], v[20:23]
    ds_read_b64_tr_b16 a[232:233], v5 offset:2048
    v_exp_f32 v133, v77
    v_mfma_f32_16x16x32_bf16 a[28:31], a[220:223], v[104:107], 0
    s_waitcnt lgkmcnt(4)
    ds_read_b64_tr_b16 a[228:229], v4 offset:2048
    buffer_load_dwordx4 v11, s[12:15], s59 offen nt lds
    v_accvgpr_read_b32 v149, a37
    v_cvt_pk_bf16_f32 v145, v146, v147
    v_fma_f32 v79, v79, s28, v17
    v_mfma_f32_16x16x32_bf16 v[192:195], a[224:227], v[96:99], 0
    s_add_u32 s56, s24, 12160
    ds_write_b64 v14, v[144:145] offset:16384
    v_mfma_f32_16x16x32_bf16 v[240:243], a[224:227], v[100:103], 0
    buffer_store_dwordx4 v[140:143], v12, s[16:19], s57 offen offset:3072 sc0 sc1 nt
    s_add_u32 s58, s25, 12160
    s_add_u32 m0, s38, 12288
    ds_read_b128 v[140:143], v13 offset:13312
    v_accvgpr_read_b32 v151, a39
    v_accvgpr_read_b32 v150, a38
    v_fma_f32 v84, v84, s28, v18
    v_accvgpr_read_b32 v145, a41
    v_pk_mul_f32 v[150:151], v[150:151], v[156:157] op_sel_hi:[1,0]
    v_cvt_pk_bf16_f32 v197, v198, v199
    v_accvgpr_read_b32 v146, a42
    v_pk_mul_f32 v[148:149], v[148:149], v[156:157] op_sel_hi:[1,0]
    v_accvgpr_read_b32 v147, a43
    v_pk_mul_f32 v[146:147], v[146:147], v[156:157] op_sel_hi:[1,0]
    v_cvt_pk_bf16_f32 v117, v130, v131
    v_accvgpr_read_b32 v144, a40
    v_cvt_pk_bf16_f32 v148, v148, v149
    v_exp_f32 v135, v79
    v_pk_mul_f32 v[144:145], v[144:145], v[156:157] op_sel_hi:[1,0]
    v_exp_f32 v131, v83
    v_cvt_pk_bf16_f32 v149, v150, v151
    v_cvt_pk_bf16_f32 v144, v144, v145
    v_mfma_f32_16x16x32_bf16 a[32:35], a[224:227], v[104:107], 0
    s_waitcnt lgkmcnt(2)
    ds_write2st64_b64 v0, v[196:197], v[244:245] offset0:8 offset1:20
    v_mfma_f32_16x16x32_bf16 v[196:199], a[228:231], v[96:99], 0
    buffer_load_dwordx4 v10, s[12:15], s58 offen nt lds
    ds_write_b64 v0, v[148:149] offset:16384
    v_cvt_pk_bf16_f32 v145, v146, v147
    v_mfma_f32_16x16x32_bf16 v[244:247], a[228:231], v[100:103], 0
    s_add_u32 m0, s38, 13312
    ds_write2st64_b64 v15, v[200:201], v[248:249] offset0:8 offset1:20
    v_mfma_f32_16x16x32_bf16 a[36:39], a[228:231], v[104:107], 0
    s_waitcnt lgkmcnt(3)
    buffer_load_dwordx4 v11, s[12:15], s58 offen nt lds
    ds_write_b64 v15, v[144:145] offset:16384
    v_mfma_f32_16x16x32_bf16 v[200:203], a[232:235], v[96:99], 0
    s_waitcnt vmcnt(16)
    ds_write2st64_b64 v8, v[204:205], v[252:253] offset0:8 offset1:20
    v_mfma_f32_16x16x32_bf16 v[248:251], a[232:235], v[100:103], 0
    s_barrier
    ds_read_b128 a[192:195], v1 offset:0
    v_mfma_f32_16x16x32_bf16 a[40:43], a[232:235], v[104:107], 0
    ds_read_b128 a[196:199], v2 offset:0
    v_accvgpr_read_b32 v151, a47
    v_cvt_pk_bf16_f32 v118, v132, v133
    v_mfma_f32_16x16x32_bf16 v[204:207], a[236:239], v[96:99], 0
    ds_read_b128 a[200:203], v1 offset:1024
    v_cvt_pk_bf16_f32 v119, v134, v135
    v_accvgpr_read_b32 v150, a46
    v_accvgpr_read_b32 v148, a44
    v_mfma_f32_16x16x32_bf16 v[24:27], a[244:247], v[116:119], v[24:27]
    s_add_u32 m0, s22, 24576
    ds_read_b128 a[204:207], v2 offset:1024
    buffer_load_dwordx4 v9, s[8:11], s21 offen lds
    v_mfma_f32_16x16x32_bf16 v[252:255], a[236:239], v[100:103], 0
    s_add_u32 s21, s21, 128
    ds_read_b128 a[208:211], v1 offset:2048
    v_accvgpr_read_b32 v149, a45
    v_mfma_f32_16x16x32_bf16 a[44:47], a[236:239], v[104:107], 0
    buffer_store_dwordx4 v[136:139], v12, s[16:19], s56 offen offset:0 sc0 sc1 nt
    ds_read_b128 a[212:215], v2 offset:2048
    v_exp_f32 v133, v85
    v_exp_f32 v130, v82
    v_exp_f32 v128, v80
    v_pk_mul_f32 v[150:151], v[150:151], v[156:157] op_sel_hi:[1,0]
    v_cvt_pk_bf16_f32 v120, v128, v129
    v_pk_mul_f32 v[148:149], v[148:149], v[156:157] op_sel_hi:[1,0]
    v_exp_f32 v132, v84
    v_exp_f32 v134, v86
    s_waitcnt lgkmcnt(4)
    v_mfma_f32_16x16x32_bf16 v[32:35], a[192:195], a[96:99], 0
    s_add_u32 m0, s22, 25600
    v_exp_f32 v135, v87
    v_cvt_pk_bf16_f32 v122, v132, v133
    v_mfma_f32_16x16x32_bf16 v[32:35], a[196:199], a[100:103], v[32:35]
    s_waitcnt lgkmcnt(3)
    v_cvt_pk_bf16_f32 v121, v130, v131
    v_cvt_pk_bf16_f32 v123, v134, v135
    v_mfma_f32_16x16x32_bf16 v[32:35], a[200:203], a[104:107], v[32:35]
    buffer_load_dwordx4 v9, s[8:11], s21 offen lds
    v_mfma_f32_16x16x32_bf16 v[24:27], a[248:251], v[120:123], v[24:27]
    s_waitcnt lgkmcnt(2)
    ds_read_b128 a[224:227], v1 offset:7168
    v_mfma_f32_16x16x32_bf16 v[32:35], a[204:207], a[108:111], v[32:35]
    s_add_u32 s21, s21, 128
    ds_read_b128 a[216:219], v1 offset:6144
    s_waitcnt lgkmcnt(3)
    v_mfma_f32_16x16x32_bf16 v[32:35], a[208:211], a[112:115], v[32:35]
    ds_read_b128 a[236:239], v2 offset:8192
    s_waitcnt lgkmcnt(3)
    v_mfma_f32_16x16x32_bf16 v[32:35], a[212:215], a[116:119], v[32:35]
    s_add_u32 m0, s22, 26624
    ds_read_b128 a[232:235], v1 offset:8192
    v_cmp_lt_f32 vcc, s29, v24
    v_mfma_f32_16x16x32_bf16 v[40:43], a[192:195], a[120:123], 0
    ds_read_b128 a[220:223], v2 offset:6144
    v_cvt_pk_bf16_f32 v148, v148, v149
    v_mfma_f32_16x16x32_bf16 v[40:43], a[196:199], a[124:127], v[40:43]
    buffer_load_dwordx4 v9, s[8:11], s21 offen lds
    v_mfma_f32_16x16x32_bf16 v[40:43], a[200:203], a[128:131], v[40:43]
    s_add_u32 s21, s21, 12032
    v_add_u32 v13, 2048, v13
    v_cvt_pk_bf16_f32 v149, v150, v151
    v_mfma_f32_16x16x32_bf16 v[40:43], a[204:207], a[132:135], v[40:43]
    s_cbranch_vccnz L_rs_tr33d
L_ret_tr33d:
    ds_read_b128 a[228:231], v2 offset:7168
    v_mfma_f32_16x16x32_bf16 v[40:43], a[208:211], a[136:139], v[40:43]
    s_add_u32 s58, s25, 18304
    v_fma_f32 v35, v35, s28, v16
    s_add_u32 m0, s38, 18432
    v_mfma_f32_16x16x32_bf16 v[40:43], a[212:215], a[140:143], v[40:43]
    v_exp_f32 v131, v35
    v_mfma_f32_16x16x32_bf16 v[48:51], a[192:195], a[144:147], 0
    buffer_load_dwordx4 v10, s[12:15], s58 offen nt lds
    v_mfma_f32_16x16x32_bf16 v[48:51], a[196:199], a[148:151], v[48:51]
    buffer_store_dwordx4 v[140:143], v12, s[16:19], s56 offen offset:3072 sc0 sc1 nt
    ds_write_b64 v8, v[148:149] offset:16384
    v_mfma_f32_16x16x32_bf16 v[48:51], a[200:203], a[152:155], v[48:51]
    s_add_u32 m0, s38, 19456
    v_fma_f32 v40, v40, s28, v17
    v_mfma_f32_16x16x32_bf16 v[48:51], a[204:207], a[156:159], v[48:51]
    v_fma_f32 v34, v34, s28, v16
    v_fma_f32 v32, v32, s28, v16
    v_mfma_f32_16x16x32_bf16 v[48:51], a[208:211], a[160:163], v[48:51]
    buffer_load_dwordx4 v11, s[12:15], s58 offen nt lds
    v_mfma_f32_16x16x32_bf16 v[48:51], a[212:215], a[164:167], v[48:51]
    s_waitcnt lgkmcnt(2)
    v_exp_f32 v130, v34
    v_mfma_f32_16x16x32_bf16 v[36:39], a[216:219], a[96:99], 0
    s_waitcnt vmcnt(20) lgkmcnt(1)
    v_exp_f32 v132, v40
    v_mfma_f32_16x16x32_bf16 v[36:39], a[220:223], a[100:103], v[36:39]
    s_barrier
    v_mfma_f32_16x16x32_bf16 v[36:39], a[224:227], a[104:107], v[36:39]
    v_fma_f32 v41, v41, s28, v17
    v_mfma_f32_16x16x32_bf16 v[36:39], a[228:231], a[108:111], v[36:39]
    s_add_u32 m0, s22, 0
    v_exp_f32 v128, v32
    v_mfma_f32_16x16x32_bf16 v[36:39], a[232:235], a[112:115], v[36:39]
    ds_read_b64_tr_b16 a[192:193], v3 offset:12288
    v_fma_f32 v33, v33, s28, v16
    v_mfma_f32_16x16x32_bf16 v[36:39], a[236:239], a[116:119], v[36:39]
    v_exp_f32 v129, v33
    v_mfma_f32_16x16x32_bf16 v[44:47], a[216:219], a[120:123], 0
    v_exp_f32 v133, v41
    v_mfma_f32_16x16x32_bf16 v[44:47], a[220:223], a[124:127], v[44:47]
    ds_read_b64_tr_b16 a[194:195], v3 offset:18432
    v_cvt_pk_bf16_f32 v97, v130, v131
    v_mfma_f32_16x16x32_bf16 v[44:47], a[224:227], a[128:131], v[44:47]
    ds_read_b64_tr_b16 a[196:197], v4 offset:12288
    v_mfma_f32_16x16x32_bf16 v[44:47], a[228:231], a[132:135], v[44:47]
    buffer_load_dwordx4 v9, s[4:7], s20 offen lds
    ds_read_b64_tr_b16 a[198:199], v4 offset:18432
    v_mfma_f32_16x16x32_bf16 v[44:47], a[232:235], a[136:139], v[44:47]
    ds_read_b64_tr_b16 a[200:201], v5 offset:12288
    s_add_u32 s20, s20, 128
    v_mfma_f32_16x16x32_bf16 v[44:47], a[236:239], a[140:143], v[44:47]
    s_add_u32 m0, s22, 1024
    ds_read_b64_tr_b16 a[202:203], v5 offset:18432
    v_cvt_pk_bf16_f32 v100, v132, v133
    v_mfma_f32_16x16x32_bf16 v[52:55], a[216:219], a[144:147], 0
    buffer_load_dwordx4 v9, s[4:7], s20 offen lds
    ds_read_b64_tr_b16 a[204:205], v6 offset:12288
    v_mfma_f32_16x16x32_bf16 v[52:55], a[220:223], a[148:151], v[52:55]
    ds_read_b64_tr_b16 a[206:207], v6 offset:18432
    v_cvt_pk_bf16_f32 v96, v128, v129
    v_mfma_f32_16x16x32_bf16 v[52:55], a[224:227], a[152:155], v[52:55]
    s_add_u32 s20, s20, 128
    s_add_u32 m0, s22, 2048
    ds_read_b64_tr_b16 a[208:209], v3 offset:13312
    v_mfma_f32_16x16x32_bf16 v[52:55], a[228:231], a[156:159], v[52:55]
    ds_read_b64_tr_b16 a[210:211], v3 offset:19456
    buffer_load_dwordx4 v9, s[4:7], s20 offen lds
    v_mfma_f32_16x16x32_bf16 v[52:55], a[232:235], a[160:163], v[52:55]
    ds_read_b64_tr_b16 a[212:213], v4 offset:13312
    v_mfma_f32_16x16x32_bf16 v[52:55], a[236:239], a[164:167], v[52:55]
    s_add_u32 s20, s20, 12032
    ds_read_b64_tr_b16 a[214:215], v4 offset:19456
    s_branch L_loop3
L_end4:
    s_waitcnt lgkmcnt(10)
    v_mfma_f32_16x16x32_bf16 v[160:163], a[192:195], v[112:115], v[160:163]
    ds_read_b128 v[136:139], v13 offset:0
    v_fma_f32 v47, v47, s28, v17
    v_mfma_f32_16x16x32_bf16 v[208:211], a[192:195], v[116:119], v[208:211]
    ds_read_b64_tr_b16 a[228:229], v4 offset:14336
    v_fma_f32 v46, v46, s28, v17
    v_fma_f32 v37, v37, s28, v16
    v_mfma_f32_16x16x32_bf16 a[0:3], a[192:195], v[120:123], a[0:3]
    ds_read_b64_tr_b16 a[218:219], v5 offset:19456
    v_fma_f32 v43, v43, s28, v17
    v_mfma_f32_16x16x32_bf16 a[48:51], a[192:195], v[124:127], a[48:51]
    ds_read_b64_tr_b16 a[238:239], v6 offset:20480
    s_waitcnt lgkmcnt(12)
    v_mfma_f32_16x16x32_bf16 v[164:167], a[196:199], v[112:115], v[164:167]
    ds_read_b64_tr_b16 a[226:227], v3 offset:20480
    v_fma_f32 v50, v50, s28, v18
    v_mfma_f32_16x16x32_bf16 v[212:215], a[196:199], v[116:119], v[212:215]
    v_fma_f32 v36, v36, s28, v16
    v_fma_f32 v39, v39, s28, v16
    v_mfma_f32_16x16x32_bf16 a[4:7], a[196:199], v[120:123], a[4:7]
    v_exp_f32 v135, v37
    v_mfma_f32_16x16x32_bf16 a[52:55], a[196:199], v[124:127], a[52:55]
    s_waitcnt lgkmcnt(11)
    v_exp_f32 v134, v36
    v_mfma_f32_16x16x32_bf16 v[168:171], a[200:203], v[112:115], v[168:171]
    ds_read_b64_tr_b16 a[232:233], v5 offset:14336
    v_fma_f32 v57, v57, s28, v19
    v_mfma_f32_16x16x32_bf16 v[216:219], a[200:203], v[116:119], v[216:219]
    ds_read_b64_tr_b16 a[234:235], v5 offset:20480
    v_fma_f32 v53, v53, s28, v18
    v_mfma_f32_16x16x32_bf16 a[8:11], a[200:203], v[120:123], a[8:11]
    ds_read_b64_tr_b16 a[236:237], v6 offset:14336
    v_fma_f32 v48, v48, s28, v18
    v_mfma_f32_16x16x32_bf16 a[56:59], a[200:203], v[124:127], a[56:59]
    s_waitcnt lgkmcnt(6)
    ds_read_b64_tr_b16 a[230:231], v4 offset:20480
    v_fma_f32 v42, v42, s28, v17
    v_mfma_f32_16x16x32_bf16 v[172:175], a[204:207], v[112:115], v[172:175]
    ds_read_b64_tr_b16 a[224:225], v3 offset:14336
    v_fma_f32 v38, v38, s28, v16
    v_mfma_f32_16x16x32_bf16 v[220:223], a[204:207], v[116:119], v[220:223]
    ds_read_b64_tr_b16 a[216:217], v5 offset:13312
    v_fma_f32 v44, v44, s28, v17
    v_mfma_f32_16x16x32_bf16 a[12:15], a[204:207], v[120:123], a[12:15]
    v_exp_f32 v130, v42
    v_mfma_f32_16x16x32_bf16 a[60:63], a[204:207], v[124:127], a[60:63]
    ds_read_b64_tr_b16 a[220:221], v6 offset:13312
    v_fma_f32 v45, v45, s28, v17
    v_mfma_f32_16x16x32_bf16 v[176:179], a[208:211], v[112:115], v[176:179]
    ds_read_b64_tr_b16 a[222:223], v6 offset:19456
    v_mfma_f32_16x16x32_bf16 v[224:227], a[208:211], v[116:119], v[224:227]
    buffer_store_dwordx4 v[136:139], v12, s[16:19], s24 offen offset:0 sc0 sc1 nt
    v_exp_f32 v129, v39
    v_cvt_pk_bf16_f32 v98, v134, v135
    v_mfma_f32_16x16x32_bf16 a[16:19], a[208:211], v[120:123], a[16:19]
    v_exp_f32 v128, v38
    v_mfma_f32_16x16x32_bf16 a[64:67], a[208:211], v[124:127], a[64:67]
    v_exp_f32 v132, v44
    v_mfma_f32_16x16x32_bf16 v[180:183], a[212:215], v[112:115], v[180:183]
    v_exp_f32 v135, v47
    v_mfma_f32_16x16x32_bf16 v[228:231], a[212:215], v[116:119], v[228:231]
    v_exp_f32 v131, v43
    v_mfma_f32_16x16x32_bf16 a[20:23], a[212:215], v[120:123], a[20:23]
    ds_read_b128 v[140:143], v13 offset:1024
    v_cvt_pk_bf16_f32 v99, v128, v129
    v_mfma_f32_16x16x32_bf16 a[68:71], a[212:215], v[124:127], a[68:71]
    s_waitcnt lgkmcnt(3)
    v_exp_f32 v134, v46
    v_mfma_f32_16x16x32_bf16 v[184:187], a[216:219], v[112:115], v[184:187]
    v_exp_f32 v133, v45
    v_mfma_f32_16x16x32_bf16 v[232:235], a[216:219], v[116:119], v[232:235]
    v_fma_f32 v49, v49, s28, v18
    v_cvt_pk_bf16_f32 v103, v134, v135
    v_mfma_f32_16x16x32_bf16 v[20:23], a[240:243], v[96:99], v[24:27]
    s_waitcnt vmcnt(11) lgkmcnt(1)
    v_cvt_pk_bf16_f32 v102, v132, v133
    v_cvt_pk_bf16_f32 v101, v130, v131
    v_mfma_f32_16x16x32_bf16 a[24:27], a[216:219], v[120:123], a[24:27]
    v_exp_f32 v133, v53
    v_mfma_f32_16x16x32_bf16 v[20:23], a[244:247], v[100:103], v[20:23]
    s_barrier
    v_mfma_f32_16x16x32_bf16 a[72:75], a[216:219], v[124:127], a[72:75]
    ds_read_b128 a[208:211], v1 offset:14336
    v_fma_f32 v54, v54, s28, v18
    v_mfma_f32_16x16x32_bf16 v[188:191], a[220:223], v[112:115], v[188:191]
    v_fma_f32 v62, v62, s28, v19
    v_mfma_f32_16x16x32_bf16 v[236:239], a[220:223], v[116:119], v[236:239]
    ds_read_b128 a[192:195], v1 offset:12288
    v_mfma_f32_16x16x32_bf16 a[28:31], a[220:223], v[120:123], a[28:31]
    s_add_u32 m0, s22, 36864
    ds_read_b128 v[136:139], v13 offset:2048
    v_fma_f32 v55, v55, s28, v18
    v_mfma_f32_16x16x32_bf16 a[76:79], a[220:223], v[124:127], a[76:79]
    buffer_load_dwordx4 v9, s[8:11], s21 offen lds
    v_mfma_f32_16x16x32_bf16 v[192:195], a[224:227], v[112:115], v[192:195]
    s_add_u32 s21, s21, 128
    ds_read_b128 a[212:215], v2 offset:14336
    v_fma_f32 v52, v52, s28, v18
    v_mfma_f32_16x16x32_bf16 v[240:243], a[224:227], v[116:119], v[240:243]
    s_add_u32 m0, s22, 37888
    ds_read_b128 a[204:207], v2 offset:13312
    v_fma_f32 v51, v51, s28, v18
    v_mfma_f32_16x16x32_bf16 a[32:35], a[224:227], v[120:123], a[32:35]
    v_exp_f32 v129, v49
    v_mfma_f32_16x16x32_bf16 a[80:83], a[224:227], v[124:127], a[80:83]
    ds_read_b128 a[196:199], v2 offset:12288
    v_fma_f32 v56, v56, s28, v19
    v_mfma_f32_16x16x32_bf16 v[196:199], a[228:231], v[112:115], v[196:199]
    ds_read_b128 a[200:203], v1 offset:13312
    v_fma_f32 v63, v63, s28, v19
    v_mfma_f32_16x16x32_bf16 v[244:247], a[228:231], v[116:119], v[244:247]
    buffer_load_dwordx4 v9, s[8:11], s21 offen lds
    v_mfma_f32_16x16x32_bf16 a[36:39], a[228:231], v[120:123], a[36:39]
    v_fma_f32 v58, v58, s28, v19
    v_mfma_f32_16x16x32_bf16 a[84:87], a[228:231], v[124:127], a[84:87]
    s_add_u32 s21, s21, 128
    ds_read_b128 a[216:219], v1 offset:18432
    v_fma_f32 v60, v60, s28, v19
    v_mfma_f32_16x16x32_bf16 v[200:203], a[232:235], v[112:115], v[200:203]
    v_exp_f32 v135, v55
    v_mfma_f32_16x16x32_bf16 v[248:251], a[232:235], v[116:119], v[248:251]
    s_add_u32 m0, s22, 38912
    v_mfma_f32_16x16x32_bf16 a[40:43], a[232:235], v[120:123], a[40:43]
    buffer_load_dwordx4 v9, s[8:11], s21 offen lds
    v_mfma_f32_16x16x32_bf16 a[88:91], a[232:235], v[124:127], a[88:91]
    v_exp_f32 v128, v48
    v_mfma_f32_16x16x32_bf16 v[204:207], a[236:239], v[112:115], v[204:207]
    v_exp_f32 v134, v54
    v_mfma_f32_16x16x32_bf16 v[252:255], a[236:239], v[116:119], v[252:255]
    v_exp_f32 v130, v50
    v_mfma_f32_16x16x32_bf16 a[44:47], a[236:239], v[120:123], a[44:47]
    v_cvt_pk_bf16_f32 v104, v128, v129
    v_mfma_f32_16x16x32_bf16 a[92:95], a[236:239], v[124:127], a[92:95]
    s_waitcnt lgkmcnt(1)
    v_exp_f32 v128, v56
    v_mfma_f32_16x16x32_bf16 v[64:67], a[192:195], a[96:99], 0
    ds_read_b128 a[220:223], v2 offset:18432
    v_fma_f32 v61, v61, s28, v19
    v_mfma_f32_16x16x32_bf16 v[64:67], a[196:199], a[100:103], v[64:67]
    ds_read_b128 a[236:239], v2 offset:20480
    v_cvt_pk_bf16_f32 v107, v134, v135
    v_mfma_f32_16x16x32_bf16 v[64:67], a[200:203], a[104:107], v[64:67]
    v_exp_f32 v132, v52
    v_mfma_f32_16x16x32_bf16 v[64:67], a[204:207], a[108:111], v[64:67]
    v_fma_f32 v59, v59, s28, v19
    v_mfma_f32_16x16x32_bf16 v[64:67], a[208:211], a[112:115], v[64:67]
    v_mfma_f32_16x16x32_bf16 v[64:67], a[212:215], a[116:119], v[64:67]
    v_exp_f32 v131, v51
    v_mfma_f32_16x16x32_bf16 v[72:75], a[192:195], a[120:123], 0
    buffer_store_dwordx4 v[140:143], v12, s[16:19], s24 offen offset:3072 sc0 sc1 nt
    ds_read_b128 a[228:231], v2 offset:19456
    v_mfma_f32_16x16x32_bf16 v[72:75], a[196:199], a[124:127], v[72:75]
    v_exp_f32 v129, v57
    v_mfma_f32_16x16x32_bf16 v[72:75], a[200:203], a[128:131], v[72:75]
    s_add_u32 s21, s21, 12032
    ds_read_b128 v[140:143], v13 offset:3072
    v_mfma_f32_16x16x32_bf16 v[72:75], a[204:207], a[132:135], v[72:75]
    ds_read_b128 a[232:235], v1 offset:20480
    v_cvt_pk_bf16_f32 v105, v130, v131
    v_mfma_f32_16x16x32_bf16 v[72:75], a[208:211], a[136:139], v[72:75]
    v_exp_f32 v135, v63
    v_mfma_f32_16x16x32_bf16 v[72:75], a[212:215], a[140:143], v[72:75]
    ds_read_b128 a[224:227], v1 offset:19456
    v_mfma_f32_16x16x32_bf16 v[80:83], a[192:195], a[144:147], 0
    v_exp_f32 v130, v58
    v_mfma_f32_16x16x32_bf16 v[80:83], a[196:199], a[148:151], v[80:83]
    v_exp_f32 v131, v59
    v_mfma_f32_16x16x32_bf16 v[80:83], a[200:203], a[152:155], v[80:83]
    v_cvt_pk_bf16_f32 v106, v132, v133
    v_mfma_f32_16x16x32_bf16 v[80:83], a[204:207], a[156:159], v[80:83]
    v_exp_f32 v134, v62
    v_mfma_f32_16x16x32_bf16 v[80:83], a[208:211], a[160:163], v[80:83]
    v_exp_f32 v133, v61
    v_mfma_f32_16x16x32_bf16 v[80:83], a[212:215], a[164:167], v[80:83]
    v_cvt_pk_bf16_f32 v108, v128, v129
    v_mfma_f32_16x16x32_bf16 v[88:91], a[192:195], a[168:171], 0
    v_cvt_pk_bf16_f32 v109, v130, v131
    v_mfma_f32_16x16x32_bf16 v[20:23], a[248:251], v[104:107], v[20:23]
    v_mfma_f32_16x16x32_bf16 v[88:91], a[196:199], a[172:175], v[88:91]
    v_exp_f32 v132, v60
    v_mfma_f32_16x16x32_bf16 v[88:91], a[200:203], a[176:179], v[88:91]
    s_add_u32 s57, s24, 128
    v_cvt_pk_bf16_f32 v110, v132, v133
    v_cvt_pk_bf16_f32 v111, v134, v135
    v_mfma_f32_16x16x32_bf16 v[88:91], a[204:207], a[180:183], v[88:91]
    v_mfma_f32_16x16x32_bf16 v[88:91], a[208:211], a[184:187], v[88:91]
    s_waitcnt vmcnt(8) lgkmcnt(0)
    v_mfma_f32_16x16x32_bf16 v[20:23], a[252:255], v[108:111], v[20:23]
    s_barrier
    v_mfma_f32_16x16x32_bf16 v[88:91], a[212:215], a[188:191], v[88:91]
    ds_read_b64_tr_b16 a[192:193], v3 offset:0
    v_mfma_f32_16x16x32_bf16 v[68:71], a[216:219], a[96:99], 0
    ds_read_b64_tr_b16 a[194:195], v3 offset:6144
    v_mfma_f32_16x16x32_bf16 v[68:71], a[220:223], a[100:103], v[68:71]
    s_nop 1
    v_cmp_lt_f32 vcc, s29, v20
    v_mfma_f32_16x16x32_bf16 v[68:71], a[224:227], a[104:107], v[68:71]
    ds_read_b64_tr_b16 a[196:197], v4 offset:0
    v_mfma_f32_16x16x32_bf16 v[68:71], a[228:231], a[108:111], v[68:71]
    v_mfma_f32_16x16x32_bf16 v[68:71], a[232:235], a[112:115], v[68:71]
    s_nop 0
    s_cbranch_vccnz L_rs_end4a
L_ret_end4a:
    v_mfma_f32_16x16x32_bf16 v[68:71], a[236:239], a[116:119], v[68:71]
    v_fma_f32 v65, v65, s28, v16
    v_fma_f32 v67, v67, s28, v16
    v_mfma_f32_16x16x32_bf16 v[76:79], a[216:219], a[120:123], 0
    ds_read_b64_tr_b16 a[198:199], v4 offset:6144
    v_fma_f32 v64, v64, s28, v16
    v_mfma_f32_16x16x32_bf16 v[76:79], a[220:223], a[124:127], v[76:79]
    v_fma_f32 v72, v72, s28, v17
    v_fma_f32 v73, v73, s28, v17
    v_mfma_f32_16x16x32_bf16 v[76:79], a[224:227], a[128:131], v[76:79]
    v_fma_f32 v66, v66, s28, v16
    v_mfma_f32_16x16x32_bf16 v[76:79], a[228:231], a[132:135], v[76:79]
    v_exp_f32 v132, v72
    v_mfma_f32_16x16x32_bf16 v[76:79], a[232:235], a[136:139], v[76:79]
    ds_read_b64_tr_b16 a[200:201], v5 offset:0
    v_mfma_f32_16x16x32_bf16 v[76:79], a[236:239], a[140:143], v[76:79]
    ds_read_b64_tr_b16 a[202:203], v5 offset:6144
    v_mfma_f32_16x16x32_bf16 v[84:87], a[216:219], a[144:147], 0
    v_exp_f32 v131, v67
    v_mfma_f32_16x16x32_bf16 v[84:87], a[220:223], a[148:151], v[84:87]
    v_mfma_f32_16x16x32_bf16 v[84:87], a[224:227], a[152:155], v[84:87]
    v_exp_f32 v130, v66
    v_mfma_f32_16x16x32_bf16 v[84:87], a[228:231], a[156:159], v[84:87]
    buffer_store_dwordx4 v[136:139], v12, s[16:19], s57 offen offset:0 sc0 sc1 nt
    ds_read_b64_tr_b16 a[204:205], v6 offset:0
    v_exp_f32 v129, v65
    v_mfma_f32_16x16x32_bf16 v[84:87], a[232:235], a[160:163], v[84:87]
    v_exp_f32 v128, v64
    v_mfma_f32_16x16x32_bf16 v[84:87], a[236:239], a[164:167], v[84:87]
    ds_read_b64_tr_b16 a[206:207], v6 offset:6144
    v_mfma_f32_16x16x32_bf16 v[92:95], a[216:219], a[168:171], 0
    buffer_store_dwordx4 v[140:143], v12, s[16:19], s57 offen offset:3072 sc0 sc1 nt
    ds_read_b64_tr_b16 a[208:209], v3 offset:1024
    v_exp_f32 v133, v73
    v_mfma_f32_16x16x32_bf16 v[92:95], a[220:223], a[172:175], v[92:95]
    ds_read_b64_tr_b16 a[210:211], v3 offset:7168
    v_cvt_pk_bf16_f32 v113, v130, v131
    v_mfma_f32_16x16x32_bf16 v[92:95], a[224:227], a[176:179], v[92:95]
    v_mfma_f32_16x16x32_bf16 v[92:95], a[228:231], a[180:183], v[92:95]
    v_cvt_pk_bf16_f32 v116, v132, v133
    v_mfma_f32_16x16x32_bf16 v[92:95], a[232:235], a[184:187], v[92:95]
    ds_read_b64_tr_b16 a[212:213], v4 offset:1024
    v_cvt_pk_bf16_f32 v112, v128, v129
    v_mfma_f32_16x16x32_bf16 v[92:95], a[236:239], a[188:191], v[92:95]
    ds_read_b64_tr_b16 a[214:215], v4 offset:7168
    s_waitcnt lgkmcnt(10)
    v_mfma_f32_16x16x32_bf16 v[160:163], a[192:195], v[96:99], v[160:163]
    v_fma_f32 v76, v76, s28, v17
    s_nop 3
    v_fma_f32 v92, v92, s28, v19
    v_fma_f32 v68, v68, s28, v16
    v_fma_f32 v83, v83, s28, v18
    v_mfma_f32_16x16x32_bf16 v[208:211], a[192:195], v[100:103], v[208:211]
    ds_read_b64_tr_b16 a[216:217], v5 offset:1024
    v_fma_f32 v87, v87, s28, v18
    v_mfma_f32_16x16x32_bf16 a[0:3], a[192:195], v[104:107], a[0:3]
    v_fma_f32 v90, v90, s28, v19
    v_fma_f32 v86, v86, s28, v18
    v_mfma_f32_16x16x32_bf16 a[48:51], a[192:195], v[108:111], a[48:51]
    s_waitcnt lgkmcnt(9)
    v_fma_f32 v71, v71, s28, v16
    v_exp_f32 v132, v76
    v_fma_f32 v77, v77, s28, v17
    v_mfma_f32_16x16x32_bf16 v[164:167], a[196:199], v[96:99], v[164:167]
    s_waitcnt vmcnt(3)
    ds_read_b64_tr_b16 a[232:233], v5 offset:2048
    v_fma_f32 v85, v85, s28, v18
    v_mfma_f32_16x16x32_bf16 v[212:215], a[196:199], v[100:103], v[212:215]
    v_exp_f32 v133, v77
    v_mfma_f32_16x16x32_bf16 a[4:7], a[196:199], v[104:107], a[4:7]
    v_fma_f32 v88, v88, s28, v19
    v_fma_f32 v70, v70, s28, v16
    v_mfma_f32_16x16x32_bf16 a[52:55], a[196:199], v[108:111], a[52:55]
    s_waitcnt lgkmcnt(5)
    v_exp_f32 v129, v71
    v_mfma_f32_16x16x32_bf16 v[168:171], a[200:203], v[96:99], v[168:171]
    v_fma_f32 v79, v79, s28, v17
    v_fma_f32 v94, v94, s28, v19
    v_mfma_f32_16x16x32_bf16 v[216:219], a[200:203], v[100:103], v[216:219]
    ds_read_b64_tr_b16 a[220:221], v6 offset:1024
    v_fma_f32 v78, v78, s28, v17
    v_exp_f32 v134, v68
    v_mfma_f32_16x16x32_bf16 a[8:11], a[200:203], v[104:107], a[8:11]
    ds_read_b64_tr_b16 a[218:219], v5 offset:7168
    v_fma_f32 v81, v81, s28, v18
    v_mfma_f32_16x16x32_bf16 a[56:59], a[200:203], v[108:111], a[56:59]
    ds_read_b64_tr_b16 a[224:225], v3 offset:2048
    v_fma_f32 v75, v75, s28, v17
    v_cvt_pk_bf16_f32 v118, v132, v133
    v_mfma_f32_16x16x32_bf16 v[172:175], a[204:207], v[96:99], v[172:175]
    ds_read_b64_tr_b16 a[222:223], v6 offset:7168
    v_fma_f32 v69, v69, s28, v16
    v_mfma_f32_16x16x32_bf16 v[220:223], a[204:207], v[100:103], v[220:223]
    s_barrier
    ds_read_b64_tr_b16 a[230:231], v4 offset:8192
    v_mfma_f32_16x16x32_bf16 a[12:15], a[204:207], v[104:107], a[12:15]
    ds_read_b64_tr_b16 a[226:227], v3 offset:8192
    v_fma_f32 v82, v82, s28, v18
    v_mfma_f32_16x16x32_bf16 a[60:63], a[204:207], v[108:111], a[60:63]
    s_waitcnt lgkmcnt(6)
    v_exp_f32 v135, v69
    v_mfma_f32_16x16x32_bf16 v[176:179], a[208:211], v[96:99], v[176:179]
    v_exp_f32 v128, v70
    v_mfma_f32_16x16x32_bf16 v[224:227], a[208:211], v[100:103], v[224:227]
    ds_read_b64_tr_b16 a[192:193], v3 offset:12288
    v_cvt_pk_bf16_f32 v114, v134, v135
    v_mfma_f32_16x16x32_bf16 a[16:19], a[208:211], v[104:107], a[16:19]
    ds_read_b64_tr_b16 a[194:195], v3 offset:18432
    v_exp_f32 v133, v85
    v_mfma_f32_16x16x32_bf16 a[64:67], a[208:211], v[108:111], a[64:67]
    v_exp_f32 v135, v79
    v_mfma_f32_16x16x32_bf16 v[180:183], a[212:215], v[96:99], v[180:183]
    ds_read_b64_tr_b16 a[196:197], v4 offset:12288
    v_fma_f32 v84, v84, s28, v18
    v_mfma_f32_16x16x32_bf16 v[228:231], a[212:215], v[100:103], v[228:231]
    ds_read_b64_tr_b16 a[228:229], v4 offset:2048
    v_fma_f32 v74, v74, s28, v17
    v_cvt_pk_bf16_f32 v115, v128, v129
    v_mfma_f32_16x16x32_bf16 a[20:23], a[212:215], v[104:107], a[20:23]
    v_fma_f32 v80, v80, s28, v18
    v_exp_f32 v134, v78
    v_mfma_f32_16x16x32_bf16 v[24:27], a[240:243], v[112:115], v[20:23]
    v_exp_f32 v131, v75
    v_mfma_f32_16x16x32_bf16 a[68:71], a[212:215], v[108:111], a[68:71]
    s_waitcnt lgkmcnt(4)
    ds_read_b64_tr_b16 a[198:199], v4 offset:18432
    v_exp_f32 v130, v74
    v_mfma_f32_16x16x32_bf16 v[184:187], a[216:219], v[96:99], v[184:187]
    v_fma_f32 v93, v93, s28, v19
    v_cvt_pk_bf16_f32 v117, v130, v131
    v_mfma_f32_16x16x32_bf16 v[232:235], a[216:219], v[100:103], v[232:235]
    v_cvt_pk_bf16_f32 v119, v134, v135
    v_exp_f32 v131, v83
    v_mfma_f32_16x16x32_bf16 a[24:27], a[216:219], v[104:107], a[24:27]
    v_exp_f32 v128, v80
    v_mfma_f32_16x16x32_bf16 a[72:75], a[216:219], v[108:111], a[72:75]
    v_exp_f32 v132, v84
    v_mfma_f32_16x16x32_bf16 v[188:191], a[220:223], v[96:99], v[188:191]
    v_exp_f32 v134, v86
    v_fma_f32 v89, v89, s28, v19
    v_mfma_f32_16x16x32_bf16 v[236:239], a[220:223], v[100:103], v[236:239]
    v_exp_f32 v129, v81
    v_mfma_f32_16x16x32_bf16 a[28:31], a[220:223], v[104:107], a[28:31]
    v_cvt_pk_bf16_f32 v120, v128, v129
    v_fma_f32 v91, v91, s28, v19
    v_mfma_f32_16x16x32_bf16 a[76:79], a[220:223], v[108:111], a[76:79]
    v_exp_f32 v130, v82
    v_mfma_f32_16x16x32_bf16 v[192:195], a[224:227], v[96:99], v[192:195]
    ds_read_b64_tr_b16 a[234:235], v5 offset:8192
    v_exp_f32 v135, v87
    v_mfma_f32_16x16x32_bf16 v[240:243], a[224:227], v[100:103], v[240:243]
    ds_read_b64_tr_b16 a[236:237], v6 offset:2048
    v_cvt_pk_bf16_f32 v123, v134, v135
    v_mfma_f32_16x16x32_bf16 v[24:27], a[244:247], v[116:119], v[24:27]
    ds_read_b64_tr_b16 a[238:239], v6 offset:8192
    v_cvt_pk_bf16_f32 v122, v132, v133
    v_mfma_f32_16x16x32_bf16 a[32:35], a[224:227], v[104:107], a[32:35]
    v_exp_f32 v129, v89
    v_fma_f32 v95, v95, s28, v19
    v_exp_f32 v135, v95
    v_mfma_f32_16x16x32_bf16 a[80:83], a[224:227], v[108:111], a[80:83]
    s_waitcnt lgkmcnt(3)
    v_exp_f32 v133, v93
    v_mfma_f32_16x16x32_bf16 v[196:199], a[228:231], v[96:99], v[196:199]
    v_cvt_pk_bf16_f32 v121, v130, v131
    v_exp_f32 v128, v88
    v_mfma_f32_16x16x32_bf16 v[244:247], a[228:231], v[100:103], v[244:247]
    v_exp_f32 v130, v90
    v_mfma_f32_16x16x32_bf16 a[36:39], a[228:231], v[104:107], a[36:39]
    v_exp_f32 v131, v91
    v_mfma_f32_16x16x32_bf16 v[24:27], a[248:251], v[120:123], v[24:27]
    v_exp_f32 v132, v92
    v_mfma_f32_16x16x32_bf16 a[84:87], a[228:231], v[108:111], a[84:87]
    s_waitcnt lgkmcnt(2)
    ds_read_b64_tr_b16 a[200:201], v5 offset:12288
    v_exp_f32 v134, v94
    v_mfma_f32_16x16x32_bf16 v[200:203], a[232:235], v[96:99], v[200:203]
    ds_read_b64_tr_b16 a[202:203], v5 offset:18432
    v_cvt_pk_bf16_f32 v125, v130, v131
    v_mfma_f32_16x16x32_bf16 v[248:251], a[232:235], v[100:103], v[248:251]
    ds_read_b64_tr_b16 a[204:205], v6 offset:12288
    v_cvt_pk_bf16_f32 v126, v132, v133
    v_mfma_f32_16x16x32_bf16 a[40:43], a[232:235], v[104:107], a[40:43]
    v_cvt_pk_bf16_f32 v124, v128, v129
    v_cvt_pk_bf16_f32 v127, v134, v135
    v_mfma_f32_16x16x32_bf16 a[88:91], a[232:235], v[108:111], a[88:91]
    ds_read_b64_tr_b16 a[206:207], v6 offset:18432
    v_mfma_f32_16x16x32_bf16 v[24:27], a[252:255], v[124:127], v[24:27]
    s_waitcnt lgkmcnt(4)
    ds_read_b64_tr_b16 a[208:209], v3 offset:13312
    v_mfma_f32_16x16x32_bf16 v[204:207], a[236:239], v[96:99], v[204:207]
    ds_read_b64_tr_b16 a[210:211], v3 offset:19456
    v_mfma_f32_16x16x32_bf16 v[252:255], a[236:239], v[100:103], v[252:255]
    ds_read_b64_tr_b16 a[212:213], v4 offset:13312
    v_mfma_f32_16x16x32_bf16 a[44:47], a[236:239], v[104:107], a[44:47]
    ds_read_b64_tr_b16 a[214:215], v4 offset:19456
    v_mfma_f32_16x16x32_bf16 a[92:95], a[236:239], v[108:111], a[92:95]
    v_cmp_lt_f32 vcc, s29, v24
    s_nop 4
    s_cbranch_vccnz L_rs_end4b
L_ret_end4b:
    s_waitcnt lgkmcnt(10)
    v_mfma_f32_16x16x32_bf16 v[160:163], a[192:195], v[112:115], v[160:163]
    ds_read_b64_tr_b16 a[216:217], v5 offset:13312
    v_mfma_f32_16x16x32_bf16 v[208:211], a[192:195], v[116:119], v[208:211]
    ds_read_b64_tr_b16 a[226:227], v3 offset:20480
    v_mfma_f32_16x16x32_bf16 a[0:3], a[192:195], v[120:123], a[0:3]
    ds_read_b64_tr_b16 a[220:221], v6 offset:13312
    v_mov_b32 v153, v24
    v_mfma_f32_16x16x32_bf16 a[48:51], a[192:195], v[124:127], a[48:51]
    ds_read_b64_tr_b16 a[230:231], v4 offset:20480
    s_waitcnt lgkmcnt(12)
    v_mfma_f32_16x16x32_bf16 v[164:167], a[196:199], v[112:115], v[164:167]
    v_mfma_f32_16x16x32_bf16 v[212:215], a[196:199], v[116:119], v[212:215]
    v_mfma_f32_16x16x32_bf16 a[4:7], a[196:199], v[120:123], a[4:7]
    v_mfma_f32_16x16x32_bf16 a[52:55], a[196:199], v[124:127], a[52:55]
    s_waitcnt lgkmcnt(10)
    v_mfma_f32_16x16x32_bf16 v[168:171], a[200:203], v[112:115], v[168:171]
    ds_read_b64_tr_b16 a[238:239], v6 offset:20480
    v_mfma_f32_16x16x32_bf16 v[216:219], a[200:203], v[116:119], v[216:219]
    ds_read_b64_tr_b16 a[218:219], v5 offset:19456
    v_mfma_f32_16x16x32_bf16 a[8:11], a[200:203], v[120:123], a[8:11]
    v_rcp_f32 v158, v27
    v_mfma_f32_16x16x32_bf16 a[56:59], a[200:203], v[124:127], a[56:59]
    s_add_u32 s84, s34, 0
    v_accvgpr_read_b32 v149, a49
    s_waitcnt lgkmcnt(4)
    v_mfma_f32_16x16x32_bf16 v[172:175], a[204:207], v[112:115], v[172:175]
    v_mfma_f32_16x16x32_bf16 v[220:223], a[204:207], v[116:119], v[220:223]
    ds_read_b64_tr_b16 a[222:223], v6 offset:19456
    v_accvgpr_read_b32 v129, a5
    v_mfma_f32_16x16x32_bf16 a[12:15], a[204:207], v[120:123], a[12:15]
    v_mfma_f32_16x16x32_bf16 a[60:63], a[204:207], v[124:127], a[60:63]
    v_mov_b32 v152, v24
    v_mfma_f32_16x16x32_bf16 v[176:179], a[208:211], v[112:115], v[176:179]
    ds_read_b64_tr_b16 a[232:233], v5 offset:14336
    v_mfma_f32_16x16x32_bf16 v[224:227], a[208:211], v[116:119], v[224:227]
    v_accvgpr_read_b32 v133, a53
    v_mfma_f32_16x16x32_bf16 a[16:19], a[208:211], v[120:123], a[16:19]
    ds_read_b64_tr_b16 a[224:225], v3 offset:14336
    v_accvgpr_read_b32 v145, a1
    v_mfma_f32_16x16x32_bf16 a[64:67], a[208:211], v[124:127], a[64:67]
    v_rcp_f32 v156, v26
    v_mfma_f32_16x16x32_bf16 v[180:183], a[212:215], v[112:115], v[180:183]
    ds_read_b64_tr_b16 a[228:229], v4 offset:14336
    v_accvgpr_read_b32 v144, a0
    v_mfma_f32_16x16x32_bf16 v[228:231], a[212:215], v[116:119], v[228:231]
    v_permlane16_swap_b32 v152, v153
    v_mfma_f32_16x16x32_bf16 a[20:23], a[212:215], v[120:123], a[20:23]
    v_accvgpr_read_b32 v147, a3
    v_mfma_f32_16x16x32_bf16 a[68:71], a[212:215], v[124:127], a[68:71]
    s_waitcnt lgkmcnt(3)
    v_subrev_u32 v13, 20480, v13
    v_mfma_f32_16x16x32_bf16 v[184:187], a[216:219], v[112:115], v[184:187]
    v_accvgpr_read_b32 v131, a7
    v_mfma_f32_16x16x32_bf16 v[232:235], a[216:219], v[116:119], v[232:235]
    v_xor_b32 v0, 32, v14
    v_accvgpr_read_b32 v146, a2
    v_mfma_f32_16x16x32_bf16 a[24:27], a[216:219], v[120:123], a[24:27]
    v_mfma_f32_16x16x32_bf16 a[72:75], a[216:219], v[124:127], a[72:75]
    v_accvgpr_read_b32 v134, a54
    v_mfma_f32_16x16x32_bf16 v[188:191], a[220:223], v[112:115], v[188:191]
    ds_read_b64_tr_b16 a[234:235], v5 offset:20480
    v_accvgpr_read_b32 v148, a48
    v_mfma_f32_16x16x32_bf16 v[236:239], a[220:223], v[116:119], v[236:239]
    s_add_u32 s85, s34, 6144
    v_mfma_f32_16x16x32_bf16 a[28:31], a[220:223], v[120:123], a[28:31]
    v_mfma_f32_16x16x32_bf16 a[76:79], a[220:223], v[124:127], a[76:79]
    s_waitcnt lgkmcnt(1)
    v_mfma_f32_16x16x32_bf16 v[192:195], a[224:227], v[112:115], v[192:195]
    v_accvgpr_read_b32 v135, a55
    v_accvgpr_read_b32 v130, a6
    v_mfma_f32_16x16x32_bf16 v[240:243], a[224:227], v[116:119], v[240:243]
    v_accvgpr_read_b32 v132, a52
    v_accvgpr_read_b32 v150, a50
    v_mfma_f32_16x16x32_bf16 a[32:35], a[224:227], v[120:123], a[32:35]
    v_xor_b32 v15, 64, v14
    v_mfma_f32_16x16x32_bf16 a[80:83], a[224:227], v[124:127], a[80:83]
    v_rcp_f32 v152, v152
    v_mfma_f32_16x16x32_bf16 v[196:199], a[228:231], v[112:115], v[196:199]
    ds_read_b64_tr_b16 a[236:237], v6 offset:14336
    v_accvgpr_read_b32 v128, a4
    v_mfma_f32_16x16x32_bf16 v[244:247], a[228:231], v[116:119], v[244:247]
    v_accvgpr_read_b32 v151, a51
    v_rcp_f32 v154, v25
    v_xor_b32 v8, 96, v14
    v_pk_mul_f32 v[212:213], v[212:213], v[154:155] op_sel_hi:[1,0]
    v_pk_mul_f32 v[144:145], v[144:145], v[156:157] op_sel_hi:[1,0]
    v_pk_mul_f32 v[148:149], v[148:149], v[158:159] op_sel_hi:[1,0]
    v_pk_mul_f32 v[220:221], v[220:221], v[154:155] op_sel_hi:[1,0]
    v_pk_mul_f32 v[146:147], v[146:147], v[156:157] op_sel_hi:[1,0]
    v_pk_mul_f32 v[186:187], v[186:187], v[152:153] op_sel_hi:[1,0]
    v_pk_mul_f32 v[132:133], v[132:133], v[158:159] op_sel_hi:[1,0]
    v_pk_mul_f32 v[150:151], v[150:151], v[158:159] op_sel_hi:[1,0]
    v_cvt_pk_bf16_f32 v132, v132, v133
    v_pk_mul_f32 v[128:129], v[128:129], v[156:157] op_sel_hi:[1,0]
    v_pk_mul_f32 v[184:185], v[184:185], v[152:153] op_sel_hi:[1,0]
    v_pk_mul_f32 v[182:183], v[182:183], v[152:153] op_sel_hi:[1,0]
    v_pk_mul_f32 v[192:193], v[192:193], v[152:153] op_sel_hi:[1,0]
    v_pk_mul_f32 v[236:237], v[236:237], v[154:155] op_sel_hi:[1,0]
    v_pk_mul_f32 v[196:197], v[196:197], v[152:153] op_sel_hi:[1,0]
    v_pk_mul_f32 v[164:165], v[164:165], v[152:153] op_sel_hi:[1,0]
    v_pk_mul_f32 v[168:169], v[168:169], v[152:153] op_sel_hi:[1,0]
    v_pk_mul_f32 v[208:209], v[208:209], v[154:155] op_sel_hi:[1,0]
    v_cvt_pk_bf16_f32 v220, v220, v221
    v_pk_mul_f32 v[210:211], v[210:211], v[154:155] op_sel_hi:[1,0]
    v_pk_mul_f32 v[228:229], v[228:229], v[154:155] op_sel_hi:[1,0]
    v_cvt_pk_bf16_f32 v212, v212, v213
    v_pk_mul_f32 v[190:191], v[190:191], v[152:153] op_sel_hi:[1,0]
    v_pk_mul_f32 v[230:231], v[230:231], v[154:155] op_sel_hi:[1,0]
    v_pk_mul_f32 v[216:217], v[216:217], v[154:155] op_sel_hi:[1,0]
    v_pk_mul_f32 v[194:195], v[194:195], v[152:153] op_sel_hi:[1,0]
    v_cvt_pk_bf16_f32 v144, v144, v145
    v_cvt_pk_bf16_f32 v128, v128, v129
    v_cvt_pk_bf16_f32 v145, v146, v147
    v_pk_mul_f32 v[160:161], v[160:161], v[152:153] op_sel_hi:[1,0]
    v_pk_mul_f32 v[162:163], v[162:163], v[152:153] op_sel_hi:[1,0]
    v_cvt_pk_bf16_f32 v164, v164, v165
    v_cvt_pk_bf16_f32 v208, v208, v209
    v_cvt_pk_bf16_f32 v228, v228, v229
    v_pk_mul_f32 v[134:135], v[134:135], v[158:159] op_sel_hi:[1,0]
    v_pk_mul_f32 v[180:181], v[180:181], v[152:153] op_sel_hi:[1,0]
    v_pk_mul_f32 v[174:175], v[174:175], v[152:153] op_sel_hi:[1,0]
    v_cvt_pk_bf16_f32 v133, v134, v135
    v_cvt_pk_bf16_f32 v148, v148, v149
    v_pk_mul_f32 v[166:167], v[166:167], v[152:153] op_sel_hi:[1,0]
    v_pk_mul_f32 v[178:179], v[178:179], v[152:153] op_sel_hi:[1,0]
    v_pk_mul_f32 v[222:223], v[222:223], v[154:155] op_sel_hi:[1,0]
    v_pk_mul_f32 v[224:225], v[224:225], v[154:155] op_sel_hi:[1,0]
    v_pk_mul_f32 v[246:247], v[246:247], v[154:155] op_sel_hi:[1,0]
    v_pk_mul_f32 v[130:131], v[130:131], v[156:157] op_sel_hi:[1,0]
    v_pk_mul_f32 v[218:219], v[218:219], v[154:155] op_sel_hi:[1,0]
    v_cvt_pk_bf16_f32 v180, v180, v181
    v_cvt_pk_bf16_f32 v160, v160, v161
    v_pk_mul_f32 v[214:215], v[214:215], v[154:155] op_sel_hi:[1,0]
    v_cvt_pk_bf16_f32 v149, v150, v151
    v_cvt_pk_bf16_f32 v216, v216, v217
    v_cvt_pk_bf16_f32 v161, v162, v163
    v_pk_mul_f32 v[238:239], v[238:239], v[154:155] op_sel_hi:[1,0]
    v_pk_mul_f32 v[172:173], v[172:173], v[152:153] op_sel_hi:[1,0]
    v_pk_mul_f32 v[226:227], v[226:227], v[154:155] op_sel_hi:[1,0]
    v_accvgpr_read_b32 v146, a10
    v_cvt_pk_bf16_f32 v165, v166, v167
    v_accvgpr_read_b32 v135, a63
    v_mfma_f32_16x16x32_bf16 a[36:39], a[228:231], v[120:123], a[36:39]
    v_cvt_pk_bf16_f32 v209, v210, v211
    v_cvt_pk_bf16_f32 v236, v236, v237
    v_accvgpr_read_b32 v151, a59
    v_cvt_pk_bf16_f32 v217, v218, v219
    v_accvgpr_read_b32 v150, a58
    v_cvt_pk_bf16_f32 v129, v130, v131
    v_mfma_f32_16x16x32_bf16 a[84:87], a[228:231], v[124:127], a[84:87]
    s_waitcnt lgkmcnt(0)
    v_cvt_pk_bf16_f32 v213, v214, v215
    v_cvt_pk_bf16_f32 v184, v184, v185
    v_mfma_f32_16x16x32_bf16 v[200:203], a[232:235], v[112:115], v[200:203]
    ds_write2st64_b64 v14, v[160:161], v[208:209] offset0:0 offset1:12
    v_cvt_pk_bf16_f32 v192, v192, v193
    v_mfma_f32_16x16x32_bf16 v[248:251], a[232:235], v[116:119], v[248:251]
    ds_write2st64_b64 v14, v[144:145], v[148:149] offset0:24 offset1:36
    v_mfma_f32_16x16x32_bf16 a[40:43], a[232:235], v[120:123], a[40:43]
    ds_write2st64_b64 v0, v[164:165], v[212:213] offset0:0 offset1:12
    v_mfma_f32_16x16x32_bf16 a[88:91], a[232:235], v[124:127], a[88:91]
    ds_write2st64_b64 v0, v[128:129], v[132:133] offset0:24 offset1:36
    v_accvgpr_read_b32 v134, a62
    v_mfma_f32_16x16x32_bf16 v[204:207], a[236:239], v[112:115], v[204:207]
    v_accvgpr_read_b32 v128, a12
    v_cvt_pk_bf16_f32 v172, v172, v173
    v_mfma_f32_16x16x32_bf16 v[252:255], a[236:239], v[116:119], v[252:255]
    v_accvgpr_read_b32 v130, a14
    v_cvt_pk_bf16_f32 v173, v174, v175
    v_accvgpr_read_b32 v145, a9
    v_mfma_f32_16x16x32_bf16 a[44:47], a[236:239], v[120:123], a[44:47]
    v_accvgpr_read_b32 v133, a61
    v_cvt_pk_bf16_f32 v168, v168, v169
    v_mfma_f32_16x16x32_bf16 a[92:95], a[236:239], v[124:127], a[92:95]
    s_add_u32 s86, s34, 12288
    v_cvt_pk_bf16_f32 v224, v224, v225
    v_accvgpr_read_b32 v149, a57
    v_cvt_pk_bf16_f32 v221, v222, v223
    v_accvgpr_read_b32 v131, a15
    v_accvgpr_read_b32 v129, a13
    v_accvgpr_read_b32 v147, a11
    v_accvgpr_read_b32 v148, a56
    v_pk_mul_f32 v[232:233], v[232:233], v[154:155] op_sel_hi:[1,0]
    v_pk_mul_f32 v[244:245], v[244:245], v[154:155] op_sel_hi:[1,0]
    v_pk_mul_f32 v[150:151], v[150:151], v[158:159] op_sel_hi:[1,0]
    v_accvgpr_read_b32 v132, a60
    v_accvgpr_read_b32 v144, a8
    v_pk_mul_f32 v[148:149], v[148:149], v[158:159] op_sel_hi:[1,0]
    v_pk_mul_f32 v[204:205], v[204:205], v[152:153] op_sel_hi:[1,0]
    v_cvt_pk_bf16_f32 v148, v148, v149
    v_pk_mul_f32 v[188:189], v[188:189], v[152:153] op_sel_hi:[1,0]
    v_pk_mul_f32 v[128:129], v[128:129], v[156:157] op_sel_hi:[1,0]
    v_pk_mul_f32 v[144:145], v[144:145], v[156:157] op_sel_hi:[1,0]
    v_pk_mul_f32 v[132:133], v[132:133], v[158:159] op_sel_hi:[1,0]
    v_pk_mul_f32 v[198:199], v[198:199], v[152:153] op_sel_hi:[1,0]
    v_pk_mul_f32 v[146:147], v[146:147], v[156:157] op_sel_hi:[1,0]
    v_pk_mul_f32 v[170:171], v[170:171], v[152:153] op_sel_hi:[1,0]
    v_cvt_pk_bf16_f32 v196, v196, v197
    v_cvt_pk_bf16_f32 v144, v144, v145
    v_pk_mul_f32 v[130:131], v[130:131], v[156:157] op_sel_hi:[1,0]
    v_pk_mul_f32 v[134:135], v[134:135], v[158:159] op_sel_hi:[1,0]
    v_cvt_pk_bf16_f32 v132, v132, v133
    v_cvt_pk_bf16_f32 v229, v230, v231
    v_cvt_pk_bf16_f32 v145, v146, v147
    v_pk_mul_f32 v[254:255], v[254:255], v[154:155] op_sel_hi:[1,0]
    v_cvt_pk_bf16_f32 v133, v134, v135
    v_cvt_pk_bf16_f32 v169, v170, v171
    v_cvt_pk_bf16_f32 v149, v150, v151
    v_accvgpr_read_b32 v135, a71
    v_pk_mul_f32 v[176:177], v[176:177], v[152:153] op_sel_hi:[1,0]
    v_cvt_pk_bf16_f32 v128, v128, v129
    v_cvt_pk_bf16_f32 v129, v130, v131
    s_add_u32 s87, s34, 18432
    s_add_u32 s18, s34, 24576
    ds_write2st64_b64 v15, v[168:169], v[216:217] offset0:0 offset1:12
    ds_write2st64_b64 v15, v[144:145], v[148:149] offset0:24 offset1:36
    ds_write2st64_b64 v8, v[172:173], v[220:221] offset0:0 offset1:12
    ds_write2st64_b64 v8, v[128:129], v[132:133] offset0:24 offset1:36
    ds_read_b128 v[136:139], v13 offset:0
    ds_read_b128 v[140:143], v13 offset:1024
    v_accvgpr_read_b32 v147, a19
    v_accvgpr_read_b32 v149, a65
    v_accvgpr_read_b32 v129, a21
    v_accvgpr_read_b32 v130, a22
    v_accvgpr_read_b32 v132, a68
    v_accvgpr_read_b32 v148, a64
    v_accvgpr_read_b32 v150, a66
    v_accvgpr_read_b32 v146, a18
    v_accvgpr_read_b32 v133, a69
    v_accvgpr_read_b32 v128, a20
    v_accvgpr_read_b32 v151, a67
    v_pk_mul_f32 v[148:149], v[148:149], v[158:159] op_sel_hi:[1,0]
    v_pk_mul_f32 v[132:133], v[132:133], v[158:159] op_sel_hi:[1,0]
    v_cvt_pk_bf16_f32 v232, v232, v233
    v_accvgpr_read_b32 v144, a16
    v_accvgpr_read_b32 v145, a17
    v_pk_mul_f32 v[234:235], v[234:235], v[154:155] op_sel_hi:[1,0]
    v_accvgpr_read_b32 v134, a70
    v_pk_mul_f32 v[134:135], v[134:135], v[158:159] op_sel_hi:[1,0]
    v_cvt_pk_bf16_f32 v188, v188, v189
    v_pk_mul_f32 v[150:151], v[150:151], v[158:159] op_sel_hi:[1,0]
    v_accvgpr_read_b32 v131, a23
    v_cvt_pk_bf16_f32 v185, v186, v187
    v_cvt_pk_bf16_f32 v233, v234, v235
    v_cvt_pk_bf16_f32 v197, v198, v199
    v_cvt_pk_bf16_f32 v176, v176, v177
    v_cvt_pk_bf16_f32 v132, v132, v133
    v_cvt_pk_bf16_f32 v148, v148, v149
    v_cvt_pk_bf16_f32 v225, v226, v227
    v_pk_mul_f32 v[146:147], v[146:147], v[156:157] op_sel_hi:[1,0]
    v_pk_mul_f32 v[144:145], v[144:145], v[156:157] op_sel_hi:[1,0]
    v_cvt_pk_bf16_f32 v133, v134, v135
    v_pk_mul_f32 v[128:129], v[128:129], v[156:157] op_sel_hi:[1,0]
    v_pk_mul_f32 v[130:131], v[130:131], v[156:157] op_sel_hi:[1,0]
    v_pk_mul_f32 v[252:253], v[252:253], v[154:155] op_sel_hi:[1,0]
    v_pk_mul_f32 v[200:201], v[200:201], v[152:153] op_sel_hi:[1,0]
    v_accvgpr_read_b32 v135, a79
    v_pk_mul_f32 v[240:241], v[240:241], v[154:155] op_sel_hi:[1,0]
    v_accvgpr_read_b32 v134, a78
    v_cvt_pk_bf16_f32 v128, v128, v129
    v_cvt_pk_bf16_f32 v177, v178, v179
    v_cvt_pk_bf16_f32 v181, v182, v183
    v_cvt_pk_bf16_f32 v129, v130, v131
    v_cvt_pk_bf16_f32 v144, v144, v145
    v_cvt_pk_bf16_f32 v149, v150, v151
    v_accvgpr_read_b32 v150, a74
    v_cvt_pk_bf16_f32 v145, v146, v147
    v_accvgpr_read_b32 v131, a31
    ds_read_b128 v[32:35], v13 offset:6144
    ds_read_b128 v[36:39], v13 offset:7168
    ds_read_b128 v[40:43], v13 offset:12288
    ds_read_b128 v[44:47], v13 offset:13312
    ds_read_b128 v[48:51], v13 offset:18432
    ds_read_b128 v[52:55], v13 offset:19456
    ds_write2st64_b64 v14, v[176:177], v[224:225] offset0:4 offset1:16
    ds_write2st64_b64 v14, v[144:145], v[148:149] offset0:28 offset1:40
    ds_write2st64_b64 v0, v[180:181], v[228:229] offset0:4 offset1:16
    ds_write2st64_b64 v0, v[128:129], v[132:133] offset0:28 offset1:40
    ds_write2st64_b64 v15, v[184:185], v[232:233] offset0:4 offset1:16
    v_pk_mul_f32 v[206:207], v[206:207], v[152:153] op_sel_hi:[1,0]
    v_accvgpr_read_b32 v133, a77
    v_accvgpr_read_b32 v132, a76
    v_pk_mul_f32 v[134:135], v[134:135], v[158:159] op_sel_hi:[1,0]
    v_cvt_pk_bf16_f32 v244, v244, v245
    v_accvgpr_read_b32 v151, a75
    v_pk_mul_f32 v[150:151], v[150:151], v[158:159] op_sel_hi:[1,0]
    v_accvgpr_read_b32 v145, a25
    v_accvgpr_read_b32 v129, a29
    v_cvt_pk_bf16_f32 v204, v204, v205
    v_accvgpr_read_b32 v147, a27
    v_accvgpr_read_b32 v149, a73
    v_pk_mul_f32 v[132:133], v[132:133], v[158:159] op_sel_hi:[1,0]
    v_accvgpr_read_b32 v148, a72
    v_accvgpr_read_b32 v128, a28
    v_pk_mul_f32 v[242:243], v[242:243], v[154:155] op_sel_hi:[1,0]
    v_pk_mul_f32 v[250:251], v[250:251], v[154:155] op_sel_hi:[1,0]
    v_pk_mul_f32 v[148:149], v[148:149], v[158:159] op_sel_hi:[1,0]
    v_pk_mul_f32 v[128:129], v[128:129], v[156:157] op_sel_hi:[1,0]
    v_cvt_pk_bf16_f32 v148, v148, v149
    v_cvt_pk_bf16_f32 v128, v128, v129
    v_accvgpr_read_b32 v144, a24
    v_cvt_pk_bf16_f32 v132, v132, v133
    v_accvgpr_read_b32 v130, a30
    v_cvt_pk_bf16_f32 v240, v240, v241
    v_cvt_pk_bf16_f32 v252, v252, v253
    v_pk_mul_f32 v[144:145], v[144:145], v[156:157] op_sel_hi:[1,0]
    v_pk_mul_f32 v[130:131], v[130:131], v[156:157] op_sel_hi:[1,0]
    v_cvt_pk_bf16_f32 v237, v238, v239
    v_cvt_pk_bf16_f32 v205, v206, v207
    v_cvt_pk_bf16_f32 v149, v150, v151
    v_accvgpr_read_b32 v150, a82
    v_cvt_pk_bf16_f32 v129, v130, v131
    v_accvgpr_read_b32 v146, a26
    v_pk_mul_f32 v[146:147], v[146:147], v[156:157] op_sel_hi:[1,0]
    v_accvgpr_read_b32 v131, a39
    v_cvt_pk_bf16_f32 v144, v144, v145
    v_accvgpr_read_b32 v130, a38
    v_cvt_pk_bf16_f32 v133, v134, v135
    v_cvt_pk_bf16_f32 v189, v190, v191
    v_cvt_pk_bf16_f32 v193, v194, v195
    v_cvt_pk_bf16_f32 v145, v146, v147
    v_accvgpr_read_b32 v151, a83
    ds_write2st64_b64 v15, v[144:145], v[148:149] offset0:28 offset1:40
    ds_write2st64_b64 v8, v[188:189], v[236:237] offset0:4 offset1:16
    ds_write2st64_b64 v8, v[128:129], v[132:133] offset0:28 offset1:40
    v_accvgpr_read_b32 v149, a81
    v_cvt_pk_bf16_f32 v245, v246, v247
    v_accvgpr_read_b32 v134, a86
    v_accvgpr_read_b32 v133, a85
    v_pk_mul_f32 v[248:249], v[248:249], v[154:155] op_sel_hi:[1,0]
    v_accvgpr_read_b32 v129, a37
    v_accvgpr_read_b32 v147, a35
    v_accvgpr_read_b32 v132, a84
    v_accvgpr_read_b32 v128, a36
    v_cvt_pk_bf16_f32 v253, v254, v255
    v_pk_mul_f32 v[128:129], v[128:129], v[156:157] op_sel_hi:[1,0]
    v_pk_mul_f32 v[150:151], v[150:151], v[158:159] op_sel_hi:[1,0]
    v_accvgpr_read_b32 v144, a32
    v_pk_mul_f32 v[132:133], v[132:133], v[158:159] op_sel_hi:[1,0]
    v_pk_mul_f32 v[130:131], v[130:131], v[156:157] op_sel_hi:[1,0]
    v_accvgpr_read_b32 v135, a87
    v_cvt_pk_bf16_f32 v241, v242, v243
    v_accvgpr_read_b32 v148, a80
    v_accvgpr_read_b32 v145, a33
    v_pk_mul_f32 v[144:145], v[144:145], v[156:157] op_sel_hi:[1,0]
    v_accvgpr_read_b32 v146, a34
    s_waitcnt lgkmcnt(3)
    buffer_store_dwordx4 v[136:139], v12, s[16:19], s84 offen offset:0 sc0 sc1 nt
    buffer_store_dwordx4 v[140:143], v12, s[16:19], s84 offen offset:3072 sc0 sc1 nt
    buffer_store_dwordx4 v[32:35], v12, s[16:19], s85 offen offset:0 sc0 sc1 nt
    buffer_store_dwordx4 v[36:39], v12, s[16:19], s85 offen offset:3072 sc0 sc1 nt
    buffer_store_dwordx4 v[40:43], v12, s[16:19], s86 offen offset:0 sc0 sc1 nt
    buffer_store_dwordx4 v[44:47], v12, s[16:19], s86 offen offset:3072 sc0 sc1 nt
    buffer_store_dwordx4 v[48:51], v12, s[16:19], s87 offen offset:0 sc0 sc1 nt
    buffer_store_dwordx4 v[52:55], v12, s[16:19], s87 offen offset:3072 sc0 sc1 nt
    v_cvt_pk_bf16_f32 v128, v128, v129
    v_pk_mul_f32 v[134:135], v[134:135], v[158:159] op_sel_hi:[1,0]
    v_pk_mul_f32 v[148:149], v[148:149], v[158:159] op_sel_hi:[1,0]
    v_cvt_pk_bf16_f32 v200, v200, v201
    v_cvt_pk_bf16_f32 v144, v144, v145
    v_cvt_pk_bf16_f32 v129, v130, v131
    v_cvt_pk_bf16_f32 v148, v148, v149
    v_pk_mul_f32 v[146:147], v[146:147], v[156:157] op_sel_hi:[1,0]
    v_cvt_pk_bf16_f32 v248, v248, v249
    v_cvt_pk_bf16_f32 v132, v132, v133
    v_accvgpr_read_b32 v130, a46
    v_cvt_pk_bf16_f32 v149, v150, v151
    v_cvt_pk_bf16_f32 v133, v134, v135
    v_cvt_pk_bf16_f32 v145, v146, v147
    ds_read_b128 v[136:139], v13 offset:2048
    ds_read_b128 v[140:143], v13 offset:3072
    ds_read_b128 v[32:35], v13 offset:8192
    ds_read_b128 v[36:39], v13 offset:9216
    ds_read_b128 v[40:43], v13 offset:14336
    ds_read_b128 v[44:47], v13 offset:15360
    ds_read_b128 v[48:51], v13 offset:20480
    ds_read_b128 v[52:55], v13 offset:21504
    ds_write2st64_b64 v14, v[192:193], v[240:241] offset0:8 offset1:20
    ds_write2st64_b64 v14, v[144:145], v[148:149] offset0:32 offset1:44
    ds_write2st64_b64 v0, v[196:197], v[244:245] offset0:8 offset1:20
    ds_write2st64_b64 v0, v[128:129], v[132:133] offset0:32 offset1:44
    v_accvgpr_read_b32 v131, a47
    v_cvt_pk_bf16_f32 v249, v250, v251
    v_accvgpr_read_b32 v148, a88
    v_accvgpr_read_b32 v134, a94
    v_accvgpr_read_b32 v146, a42
    v_accvgpr_read_b32 v151, a91
    v_accvgpr_read_b32 v147, a43
    v_accvgpr_read_b32 v149, a89
    v_accvgpr_read_b32 v145, a41
    v_accvgpr_read_b32 v150, a90
    v_pk_mul_f32 v[150:151], v[150:151], v[158:159] op_sel_hi:[1,0]
    v_accvgpr_read_b32 v128, a44
    v_pk_mul_f32 v[148:149], v[148:149], v[158:159] op_sel_hi:[1,0]
    v_pk_mul_f32 v[202:203], v[202:203], v[152:153] op_sel_hi:[1,0]
    v_cvt_pk_bf16_f32 v148, v148, v149
    v_accvgpr_read_b32 v129, a45
    v_accvgpr_read_b32 v132, a92
    v_pk_mul_f32 v[146:147], v[146:147], v[156:157] op_sel_hi:[1,0]
    v_accvgpr_read_b32 v144, a40
    v_pk_mul_f32 v[144:145], v[144:145], v[156:157] op_sel_hi:[1,0]
    v_accvgpr_read_b32 v135, a95
    v_accvgpr_read_b32 v133, a93
    v_cvt_pk_bf16_f32 v144, v144, v145
    v_pk_mul_f32 v[128:129], v[128:129], v[156:157] op_sel_hi:[1,0]
    v_cvt_pk_bf16_f32 v149, v150, v151
    v_pk_mul_f32 v[132:133], v[132:133], v[158:159] op_sel_hi:[1,0]
    v_cvt_pk_bf16_f32 v145, v146, v147
    v_pk_mul_f32 v[130:131], v[130:131], v[156:157] op_sel_hi:[1,0]
    v_pk_mul_f32 v[134:135], v[134:135], v[158:159] op_sel_hi:[1,0]
    v_cvt_pk_bf16_f32 v128, v128, v129
    v_cvt_pk_bf16_f32 v132, v132, v133
    v_cvt_pk_bf16_f32 v201, v202, v203
    v_cvt_pk_bf16_f32 v133, v134, v135
    v_cvt_pk_bf16_f32 v129, v130, v131
    s_waitcnt lgkmcnt(0)
    buffer_store_dwordx4 v[136:139], v12, s[16:19], s84 offen offset:128 sc0 sc1 nt
    buffer_store_dwordx4 v[140:143], v12, s[16:19], s84 offen offset:3200 sc0 sc1 nt
    buffer_store_dwordx4 v[32:35], v12, s[16:19], s85 offen offset:128 sc0 sc1 nt
    buffer_store_dwordx4 v[36:39], v12, s[16:19], s85 offen offset:3200 sc0 sc1 nt
    ds_write2st64_b64 v15, v[200:201], v[248:249] offset0:8 offset1:20
    ds_write2st64_b64 v15, v[144:145], v[148:149] offset0:32 offset1:44
    ds_write2st64_b64 v8, v[204:205], v[252:253] offset0:8 offset1:20
    ds_write2st64_b64 v8, v[128:129], v[132:133] offset0:32 offset1:44
    ds_read_b128 v[136:139], v13 offset:4096
    ds_read_b128 v[140:143], v13 offset:5120
    ds_read_b128 v[32:35], v13 offset:10240
    ds_read_b128 v[36:39], v13 offset:11264
    buffer_store_dwordx4 v[40:43], v12, s[16:19], s86 offen offset:128 sc0 sc1 nt
    buffer_store_dwordx4 v[44:47], v12, s[16:19], s86 offen offset:3200 sc0 sc1 nt
    ds_read_b128 v[40:43], v13 offset:16384
    ds_read_b128 v[44:47], v13 offset:17408
    buffer_store_dwordx4 v[48:51], v12, s[16:19], s87 offen offset:128 sc0 sc1 nt
    s_nop 0
    ds_read_b128 v[48:51], v13 offset:22528
    buffer_store_dwordx4 v[52:55], v12, s[16:19], s87 offen offset:3200 sc0 sc1 nt
    s_nop 0
    ds_read_b128 v[52:55], v13 offset:23552
    s_waitcnt lgkmcnt(7)
    buffer_store_dwordx4 v[136:139], v12, s[16:19], s84 offen offset:256 sc0 sc1 nt
    s_waitcnt lgkmcnt(4)
    buffer_store_dwordx4 v[140:143], v12, s[16:19], s84 offen offset:3328 sc0 sc1 nt
    buffer_store_dwordx4 v[32:35], v12, s[16:19], s85 offen offset:256 sc0 sc1 nt
    buffer_store_dwordx4 v[36:39], v12, s[16:19], s85 offen offset:3328 sc0 sc1 nt
    s_waitcnt lgkmcnt(2)
    buffer_store_dwordx4 v[40:43], v12, s[16:19], s86 offen offset:256 sc0 sc1 nt
    buffer_store_dwordx4 v[44:47], v12, s[16:19], s86 offen offset:3328 sc0 sc1 nt
    s_waitcnt lgkmcnt(1)
    buffer_store_dwordx4 v[48:51], v12, s[16:19], s87 offen offset:256 sc0 sc1 nt
    s_waitcnt lgkmcnt(0)
    buffer_store_dwordx4 v[52:55], v12, s[16:19], s87 offen offset:3328 sc0 sc1 nt
    s_branch L_fin
L_end3:
    ds_read_b64_tr_b16 a[222:223], v6 offset:19456
    s_waitcnt lgkmcnt(11)
    v_mfma_f32_16x16x32_bf16 v[160:163], a[192:195], v[112:115], v[160:163]
    ds_read_b64_tr_b16 a[232:233], v5 offset:14336
    v_fma_f32 v44, v44, s28, v17
    v_mfma_f32_16x16x32_bf16 v[208:211], a[192:195], v[116:119], v[208:211]
    ds_read_b64_tr_b16 a[220:221], v6 offset:13312
    v_fma_f32 v54, v54, s28, v18
    v_fma_f32 v39, v39, s28, v16
    v_mfma_f32_16x16x32_bf16 a[0:3], a[192:195], v[120:123], a[0:3]
    s_waitcnt lgkmcnt(11)
    ds_read_b64_tr_b16 a[218:219], v5 offset:19456
    v_fma_f32 v46, v46, s28, v17
    v_mfma_f32_16x16x32_bf16 v[164:167], a[196:199], v[112:115], v[164:167]
    ds_read_b64_tr_b16 a[228:229], v4 offset:14336
    v_fma_f32 v43, v43, s28, v17
    v_mfma_f32_16x16x32_bf16 v[212:215], a[196:199], v[116:119], v[212:215]
    ds_read_b64_tr_b16 a[216:217], v5 offset:13312
    v_fma_f32 v36, v36, s28, v16
    v_mfma_f32_16x16x32_bf16 a[4:7], a[196:199], v[120:123], a[4:7]
    s_waitcnt lgkmcnt(12)
    ds_read_b64_tr_b16 a[236:237], v6 offset:14336
    v_fma_f32 v45, v45, s28, v17
    v_mfma_f32_16x16x32_bf16 v[168:171], a[200:203], v[112:115], v[168:171]
    ds_read_b64_tr_b16 a[226:227], v3 offset:20480
    v_fma_f32 v37, v37, s28, v16
    v_mfma_f32_16x16x32_bf16 v[216:219], a[200:203], v[116:119], v[216:219]
    ds_read_b64_tr_b16 a[224:225], v3 offset:14336
    v_exp_f32 v134, v36
    v_mfma_f32_16x16x32_bf16 a[8:11], a[200:203], v[120:123], a[8:11]
    s_waitcnt lgkmcnt(9)
    ds_read_b64_tr_b16 a[238:239], v6 offset:20480
    v_fma_f32 v53, v53, s28, v18
    v_mfma_f32_16x16x32_bf16 v[172:175], a[204:207], v[112:115], v[172:175]
    ds_read_b64_tr_b16 a[234:235], v5 offset:20480
    v_fma_f32 v51, v51, s28, v18
    v_mfma_f32_16x16x32_bf16 v[220:223], a[204:207], v[116:119], v[220:223]
    ds_read_b64_tr_b16 a[230:231], v4 offset:20480
    v_exp_f32 v131, v43
    v_mfma_f32_16x16x32_bf16 a[12:15], a[204:207], v[120:123], a[12:15]
    v_exp_f32 v135, v37
    v_mfma_f32_16x16x32_bf16 v[176:179], a[208:211], v[112:115], v[176:179]
    v_fma_f32 v38, v38, s28, v16
    v_fma_f32 v42, v42, s28, v17
    v_mfma_f32_16x16x32_bf16 v[224:227], a[208:211], v[116:119], v[224:227]
    v_fma_f32 v48, v48, s28, v18
    v_fma_f32 v50, v50, s28, v18
    v_mfma_f32_16x16x32_bf16 a[16:19], a[208:211], v[120:123], a[16:19]
    v_exp_f32 v129, v39
    v_mfma_f32_16x16x32_bf16 v[180:183], a[212:215], v[112:115], v[180:183]
    v_exp_f32 v128, v38
    v_mfma_f32_16x16x32_bf16 v[228:231], a[212:215], v[116:119], v[228:231]
    v_exp_f32 v133, v45
    v_mfma_f32_16x16x32_bf16 a[20:23], a[212:215], v[120:123], a[20:23]
    s_waitcnt lgkmcnt(3)
    ds_read_b128 v[136:139], v13 offset:0
    v_fma_f32 v47, v47, s28, v17
    v_mfma_f32_16x16x32_bf16 v[184:187], a[216:219], v[112:115], v[184:187]
    v_cvt_pk_bf16_f32 v99, v128, v129
    v_cvt_pk_bf16_f32 v98, v134, v135
    v_mfma_f32_16x16x32_bf16 v[232:235], a[216:219], v[116:119], v[232:235]
    v_exp_f32 v134, v46
    v_mfma_f32_16x16x32_bf16 a[24:27], a[216:219], v[120:123], a[24:27]
    s_waitcnt vmcnt(10) lgkmcnt(1)
    v_exp_f32 v135, v47
    v_mfma_f32_16x16x32_bf16 v[20:23], a[240:243], v[96:99], v[24:27]
    s_barrier
    v_mfma_f32_16x16x32_bf16 v[188:191], a[220:223], v[112:115], v[188:191]
    s_add_u32 m0, s22, 36864
    ds_read_b128 a[196:199], v2 offset:12288
    v_fma_f32 v55, v55, s28, v18
    v_mfma_f32_16x16x32_bf16 v[236:239], a[220:223], v[116:119], v[236:239]
    v_exp_f32 v132, v44
    v_mfma_f32_16x16x32_bf16 a[28:31], a[220:223], v[120:123], a[28:31]
    buffer_load_dwordx4 v9, s[8:11], s21 offen lds
    v_mfma_f32_16x16x32_bf16 v[192:195], a[224:227], v[112:115], v[192:195]
    v_exp_f32 v130, v42
    v_mfma_f32_16x16x32_bf16 v[240:243], a[224:227], v[116:119], v[240:243]
    ds_read_b128 v[140:143], v13 offset:1024
    v_cvt_pk_bf16_f32 v103, v134, v135
    v_mfma_f32_16x16x32_bf16 a[32:35], a[224:227], v[120:123], a[32:35]
    s_add_u32 s21, s21, 128
    ds_read_b128 a[192:195], v1 offset:12288
    v_cvt_pk_bf16_f32 v102, v132, v133
    v_mfma_f32_16x16x32_bf16 v[196:199], a[228:231], v[112:115], v[196:199]
    ds_read_b128 a[200:203], v1 offset:13312
    v_cvt_pk_bf16_f32 v101, v130, v131
    v_mfma_f32_16x16x32_bf16 v[244:247], a[228:231], v[116:119], v[244:247]
    s_add_u32 m0, s22, 37888
    ds_read_b128 a[212:215], v2 offset:14336
    v_exp_f32 v133, v53
    v_mfma_f32_16x16x32_bf16 a[36:39], a[228:231], v[120:123], a[36:39]
    ds_read_b128 a[204:207], v2 offset:13312
    v_fma_f32 v49, v49, s28, v18
    v_mfma_f32_16x16x32_bf16 v[200:203], a[232:235], v[112:115], v[200:203]
    buffer_load_dwordx4 v9, s[8:11], s21 offen lds
    v_mfma_f32_16x16x32_bf16 v[248:251], a[232:235], v[116:119], v[248:251]
    s_add_u32 s21, s21, 128
    ds_read_b128 a[208:211], v1 offset:14336
    v_fma_f32 v52, v52, s28, v18
    v_mfma_f32_16x16x32_bf16 a[40:43], a[232:235], v[120:123], a[40:43]
    s_add_u32 m0, s22, 38912
    v_exp_f32 v129, v49
    v_mfma_f32_16x16x32_bf16 v[204:207], a[236:239], v[112:115], v[204:207]
    v_exp_f32 v132, v52
    v_mfma_f32_16x16x32_bf16 v[20:23], a[244:247], v[100:103], v[20:23]
    v_exp_f32 v131, v51
    v_mfma_f32_16x16x32_bf16 v[252:255], a[236:239], v[116:119], v[252:255]
    buffer_load_dwordx4 v9, s[8:11], s21 offen lds
    v_mfma_f32_16x16x32_bf16 a[44:47], a[236:239], v[120:123], a[44:47]
    s_waitcnt lgkmcnt(4)
    v_exp_f32 v130, v50
    v_mfma_f32_16x16x32_bf16 v[64:67], a[192:195], a[96:99], 0
    buffer_store_dwordx4 v[136:139], v12, s[16:19], s24 offen offset:0 sc0 sc1 nt
    ds_read_b128 a[232:235], v1 offset:20480
    v_exp_f32 v135, v55
    v_mfma_f32_16x16x32_bf16 v[64:67], a[196:199], a[100:103], v[64:67]
    s_waitcnt lgkmcnt(2)
    v_exp_f32 v134, v54
    v_mfma_f32_16x16x32_bf16 v[64:67], a[200:203], a[104:107], v[64:67]
    v_cvt_pk_bf16_f32 v107, v134, v135
    v_cvt_pk_bf16_f32 v105, v130, v131
    v_mfma_f32_16x16x32_bf16 v[64:67], a[204:207], a[108:111], v[64:67]
    s_waitcnt lgkmcnt(1)
    v_exp_f32 v128, v48
    v_mfma_f32_16x16x32_bf16 v[64:67], a[208:211], a[112:115], v[64:67]
    ds_read_b128 a[216:219], v1 offset:18432
    v_cvt_pk_bf16_f32 v106, v132, v133
    v_mfma_f32_16x16x32_bf16 v[64:67], a[212:215], a[116:119], v[64:67]
    ds_read_b128 a[220:223], v2 offset:18432
    v_cvt_pk_bf16_f32 v104, v128, v129
    v_mfma_f32_16x16x32_bf16 v[72:75], a[192:195], a[120:123], 0
    ds_read_b128 a[236:239], v2 offset:20480
    v_mfma_f32_16x16x32_bf16 v[20:23], a[248:251], v[104:107], v[20:23]
    s_add_u32 s21, s21, 12032
    ds_read_b128 a[228:231], v2 offset:19456
    v_mfma_f32_16x16x32_bf16 v[72:75], a[196:199], a[124:127], v[72:75]
    ds_read_b128 a[224:227], v1 offset:19456
    v_mfma_f32_16x16x32_bf16 v[72:75], a[200:203], a[128:131], v[72:75]
    v_mfma_f32_16x16x32_bf16 v[72:75], a[204:207], a[132:135], v[72:75]
    buffer_store_dwordx4 v[140:143], v12, s[16:19], s24 offen offset:3072 sc0 sc1 nt
    s_nop 0
    v_cmp_lt_f32 vcc, s29, v20
    v_mfma_f32_16x16x32_bf16 v[72:75], a[208:211], a[136:139], v[72:75]
    ds_read_b128 v[136:139], v13 offset:2048
    s_add_u32 s57, s24, 128
    v_mfma_f32_16x16x32_bf16 v[72:75], a[212:215], a[140:143], v[72:75]
    s_nop 0
    s_cbranch_vccnz L_rs_end3a
L_ret_end3a:
    v_mfma_f32_16x16x32_bf16 v[80:83], a[192:195], a[144:147], 0
    v_fma_f32 v64, v64, s28, v16
    v_mfma_f32_16x16x32_bf16 v[80:83], a[196:199], a[148:151], v[80:83]
    v_mfma_f32_16x16x32_bf16 v[80:83], a[200:203], a[152:155], v[80:83]
    ds_read_b128 v[140:143], v13 offset:3072
    v_mfma_f32_16x16x32_bf16 v[80:83], a[204:207], a[156:159], v[80:83]
    v_fma_f32 v72, v72, s28, v17
    s_waitcnt vmcnt(8) lgkmcnt(2)
    v_mfma_f32_16x16x32_bf16 v[80:83], a[208:211], a[160:163], v[80:83]
    s_barrier
    v_mfma_f32_16x16x32_bf16 v[80:83], a[212:215], a[164:167], v[80:83]
    ds_read_b64_tr_b16 a[192:193], v3 offset:0
    v_fma_f32 v66, v66, s28, v16
    v_mfma_f32_16x16x32_bf16 v[68:71], a[216:219], a[96:99], 0
    ds_read_b64_tr_b16 a[194:195], v3 offset:6144
    v_mfma_f32_16x16x32_bf16 v[68:71], a[220:223], a[100:103], v[68:71]
    ds_read_b64_tr_b16 a[196:197], v4 offset:0
    v_fma_f32 v65, v65, s28, v16
    v_mfma_f32_16x16x32_bf16 v[68:71], a[224:227], a[104:107], v[68:71]
    v_exp_f32 v128, v64
    v_mfma_f32_16x16x32_bf16 v[68:71], a[228:231], a[108:111], v[68:71]
    ds_read_b64_tr_b16 a[198:199], v4 offset:6144
    v_mfma_f32_16x16x32_bf16 v[68:71], a[232:235], a[112:115], v[68:71]
    ds_read_b64_tr_b16 a[200:201], v5 offset:0
    v_fma_f32 v73, v73, s28, v17
    v_mfma_f32_16x16x32_bf16 v[68:71], a[236:239], a[116:119], v[68:71]
    v_exp_f32 v133, v73
    v_mfma_f32_16x16x32_bf16 v[76:79], a[216:219], a[120:123], 0
    s_waitcnt lgkmcnt(5)
    buffer_store_dwordx4 v[136:139], v12, s[16:19], s57 offen offset:0 sc0 sc1 nt
    ds_read_b64_tr_b16 a[202:203], v5 offset:6144
    v_exp_f32 v132, v72
    v_mfma_f32_16x16x32_bf16 v[76:79], a[220:223], a[124:127], v[76:79]
    ds_read_b64_tr_b16 a[204:205], v6 offset:0
    v_mfma_f32_16x16x32_bf16 v[76:79], a[224:227], a[128:131], v[76:79]
    v_mfma_f32_16x16x32_bf16 v[76:79], a[228:231], a[132:135], v[76:79]
    v_cvt_pk_bf16_f32 v116, v132, v133
    v_mfma_f32_16x16x32_bf16 v[76:79], a[232:235], a[136:139], v[76:79]
    ds_read_b64_tr_b16 a[206:207], v6 offset:6144
    v_fma_f32 v67, v67, s28, v16
    v_mfma_f32_16x16x32_bf16 v[76:79], a[236:239], a[140:143], v[76:79]
    buffer_store_dwordx4 v[140:143], v12, s[16:19], s57 offen offset:3072 sc0 sc1 nt
    ds_read_b64_tr_b16 a[208:209], v3 offset:1024
    v_exp_f32 v129, v65
    v_mfma_f32_16x16x32_bf16 v[84:87], a[216:219], a[144:147], 0
    ds_read_b64_tr_b16 a[210:211], v3 offset:7168
    v_mfma_f32_16x16x32_bf16 v[84:87], a[220:223], a[148:151], v[84:87]
    v_exp_f32 v131, v67
    v_mfma_f32_16x16x32_bf16 v[84:87], a[224:227], a[152:155], v[84:87]
    v_exp_f32 v130, v66
    v_mfma_f32_16x16x32_bf16 v[84:87], a[228:231], a[156:159], v[84:87]
    ds_read_b64_tr_b16 a[212:213], v4 offset:1024
    v_mfma_f32_16x16x32_bf16 v[84:87], a[232:235], a[160:163], v[84:87]
    ds_read_b64_tr_b16 a[214:215], v4 offset:7168
    v_cvt_pk_bf16_f32 v113, v130, v131
    v_mfma_f32_16x16x32_bf16 v[84:87], a[236:239], a[164:167], v[84:87]
    v_cvt_pk_bf16_f32 v112, v128, v129
    ds_read_b64_tr_b16 a[220:221], v6 offset:1024
    v_fma_f32 v69, v69, s28, v16
    s_waitcnt lgkmcnt(11)
    v_mfma_f32_16x16x32_bf16 v[160:163], a[192:195], v[96:99], v[160:163]
    v_fma_f32 v80, v80, s28, v18
    v_fma_f32 v75, v75, s28, v17
    v_mfma_f32_16x16x32_bf16 v[208:211], a[192:195], v[100:103], v[208:211]
    v_fma_f32 v70, v70, s28, v16
    v_exp_f32 v128, v70
    v_mfma_f32_16x16x32_bf16 a[0:3], a[192:195], v[104:107], a[0:3]
    s_waitcnt lgkmcnt(9)
    ds_read_b64_tr_b16 a[222:223], v6 offset:7168
    v_fma_f32 v76, v76, s28, v17
    v_mfma_f32_16x16x32_bf16 v[164:167], a[196:199], v[96:99], v[164:167]
    s_waitcnt vmcnt(4)
    ds_read_b64_tr_b16 a[218:219], v5 offset:7168
    v_exp_f32 v135, v69
    v_mfma_f32_16x16x32_bf16 v[212:215], a[196:199], v[100:103], v[212:215]
    v_fma_f32 v82, v82, s28, v18
    v_fma_f32 v71, v71, s28, v16
    v_exp_f32 v132, v76
    v_mfma_f32_16x16x32_bf16 a[4:7], a[196:199], v[104:107], a[4:7]
    s_waitcnt lgkmcnt(9)
    ds_read_b64_tr_b16 a[216:217], v5 offset:1024
    v_fma_f32 v74, v74, s28, v17
    v_mfma_f32_16x16x32_bf16 v[168:171], a[200:203], v[96:99], v[168:171]
    v_fma_f32 v83, v83, s28, v18
    v_fma_f32 v78, v78, s28, v17
    v_mfma_f32_16x16x32_bf16 v[216:219], a[200:203], v[100:103], v[216:219]
    ds_read_b64_tr_b16 a[228:229], v4 offset:2048
    v_fma_f32 v77, v77, s28, v17
    v_exp_f32 v129, v71
    v_mfma_f32_16x16x32_bf16 a[8:11], a[200:203], v[104:107], a[8:11]
    s_waitcnt lgkmcnt(4)
    ds_read_b64_tr_b16 a[224:225], v3 offset:2048
    v_cvt_pk_bf16_f32 v115, v128, v129
    v_mfma_f32_16x16x32_bf16 v[172:175], a[204:207], v[96:99], v[172:175]
    v_exp_f32 v130, v74
    v_mfma_f32_16x16x32_bf16 v[220:223], a[204:207], v[100:103], v[220:223]
    v_exp_f32 v133, v77
    v_mfma_f32_16x16x32_bf16 a[12:15], a[204:207], v[104:107], a[12:15]
    ds_read_b64_tr_b16 a[234:235], v5 offset:8192
    v_fma_f32 v68, v68, s28, v16
    v_mfma_f32_16x16x32_bf16 v[176:179], a[208:211], v[96:99], v[176:179]
    s_barrier
    v_exp_f32 v134, v68
    v_mfma_f32_16x16x32_bf16 v[224:227], a[208:211], v[100:103], v[224:227]
    ds_read_b64_tr_b16 a[192:193], v3 offset:12288
    v_fma_f32 v81, v81, s28, v18
    v_mfma_f32_16x16x32_bf16 a[16:19], a[208:211], v[104:107], a[16:19]
    ds_read_b64_tr_b16 a[226:227], v3 offset:8192
    v_exp_f32 v131, v75
    v_mfma_f32_16x16x32_bf16 v[180:183], a[212:215], v[96:99], v[180:183]
    v_fma_f32 v87, v87, s28, v18
    v_fma_f32 v84, v84, s28, v18
    v_cvt_pk_bf16_f32 v114, v134, v135
    v_mfma_f32_16x16x32_bf16 v[228:231], a[212:215], v[100:103], v[228:231]
    v_exp_f32 v134, v78
    v_mfma_f32_16x16x32_bf16 a[20:23], a[212:215], v[104:107], a[20:23]
    s_waitcnt lgkmcnt(3)
    v_exp_f32 v128, v80
    v_mfma_f32_16x16x32_bf16 v[184:187], a[216:219], v[96:99], v[184:187]
    ds_read_b64_tr_b16 a[230:231], v4 offset:8192
    v_fma_f32 v79, v79, s28, v17
    v_mfma_f32_16x16x32_bf16 v[232:235], a[216:219], v[100:103], v[232:235]
    ds_read_b64_tr_b16 a[232:233], v5 offset:2048
    v_cvt_pk_bf16_f32 v118, v132, v133
    v_mfma_f32_16x16x32_bf16 a[24:27], a[216:219], v[104:107], a[24:27]
    ds_read_b64_tr_b16 a[194:195], v3 offset:18432
    v_cvt_pk_bf16_f32 v117, v130, v131
    v_mfma_f32_16x16x32_bf16 v[24:27], a[240:243], v[112:115], v[20:23]
    v_exp_f32 v135, v79
    v_mfma_f32_16x16x32_bf16 v[188:191], a[220:223], v[96:99], v[188:191]
    ds_read_b64_tr_b16 a[236:237], v6 offset:2048
    v_cvt_pk_bf16_f32 v119, v134, v135
    v_mfma_f32_16x16x32_bf16 v[236:239], a[220:223], v[100:103], v[236:239]
    v_exp_f32 v130, v82
    v_mfma_f32_16x16x32_bf16 a[28:31], a[220:223], v[104:107], a[28:31]
    s_waitcnt lgkmcnt(4)
    v_exp_f32 v135, v87
    v_mfma_f32_16x16x32_bf16 v[192:195], a[224:227], v[96:99], v[192:195]
    ds_read_b64_tr_b16 a[196:197], v4 offset:12288
    v_fma_f32 v86, v86, s28, v18
    v_mfma_f32_16x16x32_bf16 v[240:243], a[224:227], v[100:103], v[240:243]
    ds_read_b64_tr_b16 a[238:239], v6 offset:8192
    v_exp_f32 v129, v81
    v_mfma_f32_16x16x32_bf16 v[24:27], a[244:247], v[116:119], v[24:27]
    v_exp_f32 v134, v86
    v_mfma_f32_16x16x32_bf16 a[32:35], a[224:227], v[104:107], a[32:35]
    s_waitcnt lgkmcnt(5)
    v_exp_f32 v131, v83
    v_mfma_f32_16x16x32_bf16 v[196:199], a[228:231], v[96:99], v[196:199]
    ds_read_b64_tr_b16 a[198:199], v4 offset:18432
    v_fma_f32 v85, v85, s28, v18
    v_exp_f32 v132, v84
    v_mfma_f32_16x16x32_bf16 v[244:247], a[228:231], v[100:103], v[244:247]
    ds_read_b64_tr_b16 a[200:201], v5 offset:12288
    v_cvt_pk_bf16_f32 v121, v130, v131
    v_mfma_f32_16x16x32_bf16 a[36:39], a[228:231], v[104:107], a[36:39]
    s_waitcnt lgkmcnt(4)
    v_exp_f32 v133, v85
    v_mfma_f32_16x16x32_bf16 v[200:203], a[232:235], v[96:99], v[200:203]
    ds_read_b64_tr_b16 a[202:203], v5 offset:18432
    v_cvt_pk_bf16_f32 v120, v128, v129
    v_mfma_f32_16x16x32_bf16 v[248:251], a[232:235], v[100:103], v[248:251]
    ds_read_b64_tr_b16 a[204:205], v6 offset:12288
    v_cvt_pk_bf16_f32 v123, v134, v135
    v_cvt_pk_bf16_f32 v122, v132, v133
    v_mfma_f32_16x16x32_bf16 a[40:43], a[232:235], v[104:107], a[40:43]
    ds_read_b64_tr_b16 a[206:207], v6 offset:18432
    v_mfma_f32_16x16x32_bf16 v[24:27], a[248:251], v[120:123], v[24:27]
    s_waitcnt lgkmcnt(5)
    ds_read_b64_tr_b16 a[208:209], v3 offset:13312
    ds_read_b64_tr_b16 a[210:211], v3 offset:19456
    v_mfma_f32_16x16x32_bf16 v[204:207], a[236:239], v[96:99], v[204:207]
    ds_read_b64_tr_b16 a[212:213], v4 offset:13312
    v_mfma_f32_16x16x32_bf16 v[252:255], a[236:239], v[100:103], v[252:255]
    ds_read_b64_tr_b16 a[214:215], v4 offset:19456
    v_mfma_f32_16x16x32_bf16 a[44:47], a[236:239], v[104:107], a[44:47]
    v_cmp_lt_f32 vcc, s29, v24
    s_nop 4
    s_cbranch_vccnz L_rs_end3b
L_ret_end3b:
    s_waitcnt lgkmcnt(10)
    v_mfma_f32_16x16x32_bf16 v[160:163], a[192:195], v[112:115], v[160:163]
    v_xor_b32 v8, 96, v14
    v_mfma_f32_16x16x32_bf16 v[208:211], a[192:195], v[116:119], v[208:211]
    ds_read_b64_tr_b16 a[218:219], v5 offset:19456
    v_mfma_f32_16x16x32_bf16 a[0:3], a[192:195], v[120:123], a[0:3]
    ds_read_b64_tr_b16 a[216:217], v5 offset:13312
    s_waitcnt lgkmcnt(10)
    v_mfma_f32_16x16x32_bf16 v[164:167], a[196:199], v[112:115], v[164:167]
    v_rcp_f32 v154, v25
    v_mfma_f32_16x16x32_bf16 v[212:215], a[196:199], v[116:119], v[212:215]
    ds_read_b64_tr_b16 a[228:229], v4 offset:14336
    v_xor_b32 v0, 32, v14
    v_mfma_f32_16x16x32_bf16 a[4:7], a[196:199], v[120:123], a[4:7]
    ds_read_b64_tr_b16 a[226:227], v3 offset:20480
    s_waitcnt lgkmcnt(10)
    v_mfma_f32_16x16x32_bf16 v[168:171], a[200:203], v[112:115], v[168:171]
    ds_read_b64_tr_b16 a[238:239], v6 offset:20480
    v_mfma_f32_16x16x32_bf16 v[216:219], a[200:203], v[116:119], v[216:219]
    ds_read_b64_tr_b16 a[230:231], v4 offset:20480
    v_mfma_f32_16x16x32_bf16 a[8:11], a[200:203], v[120:123], a[8:11]
    s_waitcnt lgkmcnt(9)
    ds_read_b64_tr_b16 a[220:221], v6 offset:13312
    v_mfma_f32_16x16x32_bf16 v[172:175], a[204:207], v[112:115], v[172:175]
    ds_read_b64_tr_b16 a[222:223], v6 offset:19456
    v_mfma_f32_16x16x32_bf16 v[220:223], a[204:207], v[116:119], v[220:223]
    v_mfma_f32_16x16x32_bf16 a[12:15], a[204:207], v[120:123], a[12:15]
    s_waitcnt lgkmcnt(7)
    ds_read_b64_tr_b16 a[224:225], v3 offset:14336
    v_mfma_f32_16x16x32_bf16 v[176:179], a[208:211], v[112:115], v[176:179]
    v_rcp_f32 v156, v26
    v_mfma_f32_16x16x32_bf16 v[224:227], a[208:211], v[116:119], v[224:227]
    ds_read_b64_tr_b16 a[232:233], v5 offset:14336
    v_mfma_f32_16x16x32_bf16 a[16:19], a[208:211], v[120:123], a[16:19]
    v_mfma_f32_16x16x32_bf16 v[180:183], a[212:215], v[112:115], v[180:183]
    s_add_u32 s84, s34, 0
    v_mov_b32 v153, v24
    v_accvgpr_read_b32 v135, a15
    v_mfma_f32_16x16x32_bf16 v[228:231], a[212:215], v[116:119], v[228:231]
    s_add_u32 s85, s34, 6144
    v_accvgpr_read_b32 v147, a3
    v_mfma_f32_16x16x32_bf16 a[20:23], a[212:215], v[120:123], a[20:23]
    s_waitcnt lgkmcnt(4)
    ds_read_b64_tr_b16 a[234:235], v5 offset:20480
    v_mfma_f32_16x16x32_bf16 v[184:187], a[216:219], v[112:115], v[184:187]
    v_mfma_f32_16x16x32_bf16 v[232:235], a[216:219], v[116:119], v[232:235]
    v_accvgpr_read_b32 v134, a14
    v_subrev_u32 v13, 20480, v13
    v_mfma_f32_16x16x32_bf16 a[24:27], a[216:219], v[120:123], a[24:27]
    s_waitcnt lgkmcnt(3)
    v_accvgpr_read_b32 v128, a8
    v_accvgpr_read_b32 v146, a2
    v_mfma_f32_16x16x32_bf16 v[188:191], a[220:223], v[112:115], v[188:191]
    v_accvgpr_read_b32 v148, a4
    v_accvgpr_read_b32 v151, a7
    v_mfma_f32_16x16x32_bf16 v[236:239], a[220:223], v[116:119], v[236:239]
    v_accvgpr_read_b32 v130, a10
    v_mfma_f32_16x16x32_bf16 a[28:31], a[220:223], v[120:123], a[28:31]
    s_waitcnt lgkmcnt(1)
    v_xor_b32 v15, 64, v14
    v_mov_b32 v152, v24
    v_mfma_f32_16x16x32_bf16 v[192:195], a[224:227], v[112:115], v[192:195]
    v_mfma_f32_16x16x32_bf16 v[240:243], a[224:227], v[116:119], v[240:243]
    ds_read_b64_tr_b16 a[236:237], v6 offset:14336
    v_mfma_f32_16x16x32_bf16 a[32:35], a[224:227], v[120:123], a[32:35]
    v_accvgpr_read_b32 v145, a1
    v_accvgpr_read_b32 v132, a12
    v_mfma_f32_16x16x32_bf16 v[196:199], a[228:231], v[112:115], v[196:199]
    v_accvgpr_read_b32 v149, a5
    v_accvgpr_read_b32 v150, a6
    v_mfma_f32_16x16x32_bf16 v[244:247], a[228:231], v[116:119], v[244:247]
    v_permlane16_swap_b32 v152, v153
    v_mfma_f32_16x16x32_bf16 a[36:39], a[228:231], v[120:123], a[36:39]
    s_add_u32 s86, s34, 12288
    v_accvgpr_read_b32 v133, a13
    s_waitcnt lgkmcnt(1)
    v_mfma_f32_16x16x32_bf16 v[200:203], a[232:235], v[112:115], v[200:203]
    v_accvgpr_read_b32 v131, a11
    v_mfma_f32_16x16x32_bf16 v[248:251], a[232:235], v[116:119], v[248:251]
    v_accvgpr_read_b32 v129, a9
    v_rcp_f32 v152, v152
    v_accvgpr_read_b32 v144, a0
    v_pk_mul_f32 v[212:213], v[212:213], v[154:155] op_sel_hi:[1,0]
    v_pk_mul_f32 v[164:165], v[164:165], v[152:153] op_sel_hi:[1,0]
    v_pk_mul_f32 v[232:233], v[232:233], v[154:155] op_sel_hi:[1,0]
    v_pk_mul_f32 v[132:133], v[132:133], v[156:157] op_sel_hi:[1,0]
    v_pk_mul_f32 v[178:179], v[178:179], v[152:153] op_sel_hi:[1,0]
    v_pk_mul_f32 v[160:161], v[160:161], v[152:153] op_sel_hi:[1,0]
    v_pk_mul_f32 v[184:185], v[184:185], v[152:153] op_sel_hi:[1,0]
    v_pk_mul_f32 v[176:177], v[176:177], v[152:153] op_sel_hi:[1,0]
    v_pk_mul_f32 v[180:181], v[180:181], v[152:153] op_sel_hi:[1,0]
    v_pk_mul_f32 v[218:219], v[218:219], v[154:155] op_sel_hi:[1,0]
    v_pk_mul_f32 v[208:209], v[208:209], v[154:155] op_sel_hi:[1,0]
    v_pk_mul_f32 v[128:129], v[128:129], v[156:157] op_sel_hi:[1,0]
    v_pk_mul_f32 v[166:167], v[166:167], v[152:153] op_sel_hi:[1,0]
    v_pk_mul_f32 v[196:197], v[196:197], v[152:153] op_sel_hi:[1,0]
    v_pk_mul_f32 v[174:175], v[174:175], v[152:153] op_sel_hi:[1,0]
    v_pk_mul_f32 v[144:145], v[144:145], v[156:157] op_sel_hi:[1,0]
    v_pk_mul_f32 v[224:225], v[224:225], v[154:155] op_sel_hi:[1,0]
    v_cvt_pk_bf16_f32 v164, v164, v165
    v_pk_mul_f32 v[240:241], v[240:241], v[154:155] op_sel_hi:[1,0]
    v_cvt_pk_bf16_f32 v208, v208, v209
    v_cvt_pk_bf16_f32 v240, v240, v241
    v_pk_mul_f32 v[130:131], v[130:131], v[156:157] op_sel_hi:[1,0]
    v_pk_mul_f32 v[198:199], v[198:199], v[152:153] op_sel_hi:[1,0]
    v_cvt_pk_bf16_f32 v232, v232, v233
    v_cvt_pk_bf16_f32 v180, v180, v181
    v_cvt_pk_bf16_f32 v224, v224, v225
    v_pk_mul_f32 v[210:211], v[210:211], v[154:155] op_sel_hi:[1,0]
    v_pk_mul_f32 v[248:249], v[248:249], v[154:155] op_sel_hi:[1,0]
    v_pk_mul_f32 v[148:149], v[148:149], v[156:157] op_sel_hi:[1,0]
    v_pk_mul_f32 v[150:151], v[150:151], v[156:157] op_sel_hi:[1,0]
    v_cvt_pk_bf16_f32 v148, v148, v149
    v_pk_mul_f32 v[216:217], v[216:217], v[154:155] op_sel_hi:[1,0]
    v_pk_mul_f32 v[238:239], v[238:239], v[154:155] op_sel_hi:[1,0]
    v_cvt_pk_bf16_f32 v196, v196, v197
    v_pk_mul_f32 v[244:245], v[244:245], v[154:155] op_sel_hi:[1,0]
    v_pk_mul_f32 v[242:243], v[242:243], v[154:155] op_sel_hi:[1,0]
    v_cvt_pk_bf16_f32 v212, v212, v213
    v_pk_mul_f32 v[188:189], v[188:189], v[152:153] op_sel_hi:[1,0]
    v_pk_mul_f32 v[220:221], v[220:221], v[154:155] op_sel_hi:[1,0]
    v_cvt_pk_bf16_f32 v209, v210, v211
    v_pk_mul_f32 v[222:223], v[222:223], v[154:155] op_sel_hi:[1,0]
    v_pk_mul_f32 v[168:169], v[168:169], v[152:153] op_sel_hi:[1,0]
    v_cvt_pk_bf16_f32 v176, v176, v177
    v_cvt_pk_bf16_f32 v244, v244, v245
    v_cvt_pk_bf16_f32 v168, v168, v169
    v_pk_mul_f32 v[134:135], v[134:135], v[156:157] op_sel_hi:[1,0]
    v_cvt_pk_bf16_f32 v188, v188, v189
    v_pk_mul_f32 v[162:163], v[162:163], v[152:153] op_sel_hi:[1,0]
    v_pk_mul_f32 v[226:227], v[226:227], v[154:155] op_sel_hi:[1,0]
    v_pk_mul_f32 v[192:193], v[192:193], v[152:153] op_sel_hi:[1,0]
    v_cvt_pk_bf16_f32 v216, v216, v217
    v_cvt_pk_bf16_f32 v220, v220, v221
    v_pk_mul_f32 v[170:171], v[170:171], v[152:153] op_sel_hi:[1,0]
    v_cvt_pk_bf16_f32 v144, v144, v145
    v_cvt_pk_bf16_f32 v132, v132, v133
    v_cvt_pk_bf16_f32 v128, v128, v129
    v_cvt_pk_bf16_f32 v160, v160, v161
    v_pk_mul_f32 v[190:191], v[190:191], v[152:153] op_sel_hi:[1,0]
    v_pk_mul_f32 v[230:231], v[230:231], v[154:155] op_sel_hi:[1,0]
    v_cvt_pk_bf16_f32 v149, v150, v151
    v_pk_mul_f32 v[214:215], v[214:215], v[154:155] op_sel_hi:[1,0]
    v_pk_mul_f32 v[146:147], v[146:147], v[156:157] op_sel_hi:[1,0]
    v_cvt_pk_bf16_f32 v165, v166, v167
    v_cvt_pk_bf16_f32 v217, v218, v219
    v_cvt_pk_bf16_f32 v145, v146, v147
    v_pk_mul_f32 v[236:237], v[236:237], v[154:155] op_sel_hi:[1,0]
    v_cvt_pk_bf16_f32 v169, v170, v171
    v_accvgpr_read_b32 v146, a18
    v_pk_mul_f32 v[228:229], v[228:229], v[154:155] op_sel_hi:[1,0]
    v_cvt_pk_bf16_f32 v161, v162, v163
    v_pk_mul_f32 v[172:173], v[172:173], v[152:153] op_sel_hi:[1,0]
    v_cvt_pk_bf16_f32 v129, v130, v131
    v_cvt_pk_bf16_f32 v172, v172, v173
    v_pk_mul_f32 v[200:201], v[200:201], v[152:153] op_sel_hi:[1,0]
    v_cvt_pk_bf16_f32 v213, v214, v215
    v_cvt_pk_bf16_f32 v221, v222, v223
    v_cvt_pk_bf16_f32 v173, v174, v175
    v_pk_mul_f32 v[194:195], v[194:195], v[152:153] op_sel_hi:[1,0]
    s_add_u32 s18, s34, 18432
    ds_write2st64_b64 v14, v[160:161], v[208:209] offset0:0 offset1:12
    ds_write_b64 v14, v[144:145] offset:12288
    ds_write2st64_b64 v0, v[164:165], v[212:213] offset0:0 offset1:12
    ds_write_b64 v0, v[148:149] offset:12288
    v_accvgpr_read_b32 v145, a17
    v_cvt_pk_bf16_f32 v236, v236, v237
    v_accvgpr_read_b32 v147, a19
    v_accvgpr_read_b32 v131, a27
    v_pk_mul_f32 v[186:187], v[186:187], v[152:153] op_sel_hi:[1,0]
    v_pk_mul_f32 v[234:235], v[234:235], v[154:155] op_sel_hi:[1,0]
    v_cvt_pk_bf16_f32 v237, v238, v239
    v_accvgpr_read_b32 v151, a23
    v_cvt_pk_bf16_f32 v228, v228, v229
    v_cvt_pk_bf16_f32 v133, v134, v135
    v_mfma_f32_16x16x32_bf16 a[40:43], a[232:235], v[120:123], a[40:43]
    s_waitcnt lgkmcnt(4)
    ds_write2st64_b64 v15, v[168:169], v[216:217] offset0:0 offset1:12
    ds_write_b64 v15, v[128:129] offset:12288
    ds_write2st64_b64 v8, v[172:173], v[220:221] offset0:0 offset1:12
    v_mfma_f32_16x16x32_bf16 v[204:207], a[236:239], v[112:115], v[204:207]
    ds_write_b64 v8, v[132:133] offset:12288
    v_accvgpr_read_b32 v128, a24
    v_accvgpr_read_b32 v148, a20
    v_cvt_pk_bf16_f32 v189, v190, v191
    v_mfma_f32_16x16x32_bf16 v[252:255], a[236:239], v[116:119], v[252:255]
    ds_read_b128 v[136:139], v13 offset:0
    ds_read_b128 v[140:143], v13 offset:1024
    v_cvt_pk_bf16_f32 v177, v178, v179
    v_mfma_f32_16x16x32_bf16 a[44:47], a[236:239], v[120:123], a[44:47]
    ds_read_b128 v[32:35], v13 offset:6144
    ds_read_b128 v[36:39], v13 offset:7168
    ds_read_b128 v[40:43], v13 offset:12288
    ds_read_b128 v[44:47], v13 offset:13312
    v_accvgpr_read_b32 v129, a25
    v_accvgpr_read_b32 v130, a26
    v_cvt_pk_bf16_f32 v241, v242, v243
    v_accvgpr_read_b32 v149, a21
    v_cvt_pk_bf16_f32 v248, v248, v249
    v_accvgpr_read_b32 v144, a16
    v_pk_mul_f32 v[146:147], v[146:147], v[156:157] op_sel_hi:[1,0]
    v_accvgpr_read_b32 v150, a22
    v_pk_mul_f32 v[252:253], v[252:253], v[154:155] op_sel_hi:[1,0]
    v_cvt_pk_bf16_f32 v192, v192, v193
    v_pk_mul_f32 v[246:247], v[246:247], v[154:155] op_sel_hi:[1,0]
    v_cvt_pk_bf16_f32 v184, v184, v185
    v_accvgpr_read_b32 v135, a31
    v_cvt_pk_bf16_f32 v233, v234, v235
    v_cvt_pk_bf16_f32 v225, v226, v227
    v_accvgpr_read_b32 v132, a28
    v_cvt_pk_bf16_f32 v229, v230, v231
    v_pk_mul_f32 v[128:129], v[128:129], v[156:157] op_sel_hi:[1,0]
    v_accvgpr_read_b32 v133, a29
    v_pk_mul_f32 v[148:149], v[148:149], v[156:157] op_sel_hi:[1,0]
    v_pk_mul_f32 v[130:131], v[130:131], v[156:157] op_sel_hi:[1,0]
    v_pk_mul_f32 v[132:133], v[132:133], v[156:157] op_sel_hi:[1,0]
    v_pk_mul_f32 v[150:151], v[150:151], v[156:157] op_sel_hi:[1,0]
    v_pk_mul_f32 v[204:205], v[204:205], v[152:153] op_sel_hi:[1,0]
    v_pk_mul_f32 v[144:145], v[144:145], v[156:157] op_sel_hi:[1,0]
    v_cvt_pk_bf16_f32 v252, v252, v253
    v_cvt_pk_bf16_f32 v132, v132, v133
    v_accvgpr_read_b32 v134, a30
    v_cvt_pk_bf16_f32 v148, v148, v149
    v_cvt_pk_bf16_f32 v245, v246, v247
    v_cvt_pk_bf16_f32 v144, v144, v145
    v_cvt_pk_bf16_f32 v128, v128, v129
    v_pk_mul_f32 v[134:135], v[134:135], v[156:157] op_sel_hi:[1,0]
    v_pk_mul_f32 v[182:183], v[182:183], v[152:153] op_sel_hi:[1,0]
    v_cvt_pk_bf16_f32 v145, v146, v147
    v_cvt_pk_bf16_f32 v133, v134, v135
    v_accvgpr_read_b32 v147, a35
    v_cvt_pk_bf16_f32 v193, v194, v195
    v_pk_mul_f32 v[206:207], v[206:207], v[152:153] op_sel_hi:[1,0]
    v_cvt_pk_bf16_f32 v197, v198, v199
    v_cvt_pk_bf16_f32 v129, v130, v131
    v_cvt_pk_bf16_f32 v185, v186, v187
    v_cvt_pk_bf16_f32 v149, v150, v151
    v_cvt_pk_bf16_f32 v181, v182, v183
    v_pk_mul_f32 v[254:255], v[254:255], v[154:155] op_sel_hi:[1,0]
    v_accvgpr_read_b32 v135, a47
    v_pk_mul_f32 v[202:203], v[202:203], v[152:153] op_sel_hi:[1,0]
    s_waitcnt lgkmcnt(0)
    buffer_store_dwordx4 v[136:139], v12, s[16:19], s84 offen offset:0 sc0 sc1 nt
    buffer_store_dwordx4 v[140:143], v12, s[16:19], s84 offen offset:3072 sc0 sc1 nt
    buffer_store_dwordx4 v[32:35], v12, s[16:19], s85 offen offset:0 sc0 sc1 nt
    buffer_store_dwordx4 v[36:39], v12, s[16:19], s85 offen offset:3072 sc0 sc1 nt
    buffer_store_dwordx4 v[40:43], v12, s[16:19], s86 offen offset:0 sc0 sc1 nt
    buffer_store_dwordx4 v[44:47], v12, s[16:19], s86 offen offset:3072 sc0 sc1 nt
    ds_write2st64_b64 v14, v[176:177], v[224:225] offset0:4 offset1:16
    ds_write_b64 v14, v[144:145] offset:14336
    ds_write2st64_b64 v0, v[180:181], v[228:229] offset0:4 offset1:16
    ds_write_b64 v0, v[148:149] offset:14336
    ds_write2st64_b64 v15, v[184:185], v[232:233] offset0:4 offset1:16
    ds_write_b64 v15, v[128:129] offset:14336
    ds_write2st64_b64 v8, v[188:189], v[236:237] offset0:4 offset1:16
    ds_write_b64 v8, v[132:133] offset:14336
    ds_read_b128 v[136:139], v13 offset:2048
    ds_read_b128 v[140:143], v13 offset:3072
    ds_read_b128 v[32:35], v13 offset:8192
    ds_read_b128 v[36:39], v13 offset:9216
    ds_read_b128 v[40:43], v13 offset:14336
    ds_read_b128 v[44:47], v13 offset:15360
    v_accvgpr_read_b32 v150, a38
    v_accvgpr_read_b32 v146, a34
    v_accvgpr_read_b32 v148, a36
    v_accvgpr_read_b32 v132, a44
    v_accvgpr_read_b32 v131, a43
    v_cvt_pk_bf16_f32 v204, v204, v205
    v_accvgpr_read_b32 v128, a40
    v_pk_mul_f32 v[250:251], v[250:251], v[154:155] op_sel_hi:[1,0]
    v_accvgpr_read_b32 v151, a39
    v_pk_mul_f32 v[146:147], v[146:147], v[156:157] op_sel_hi:[1,0]
    v_accvgpr_read_b32 v133, a45
    v_cvt_pk_bf16_f32 v249, v250, v251
    v_accvgpr_read_b32 v144, a32
    v_accvgpr_read_b32 v130, a42
    v_pk_mul_f32 v[150:151], v[150:151], v[156:157] op_sel_hi:[1,0]
    v_accvgpr_read_b32 v145, a33
    v_pk_mul_f32 v[144:145], v[144:145], v[156:157] op_sel_hi:[1,0]
    v_cvt_pk_bf16_f32 v253, v254, v255
    v_pk_mul_f32 v[132:133], v[132:133], v[156:157] op_sel_hi:[1,0]
    v_accvgpr_read_b32 v129, a41
    v_pk_mul_f32 v[130:131], v[130:131], v[156:157] op_sel_hi:[1,0]
    v_cvt_pk_bf16_f32 v200, v200, v201
    v_accvgpr_read_b32 v149, a37
    v_cvt_pk_bf16_f32 v201, v202, v203
    v_cvt_pk_bf16_f32 v144, v144, v145
    v_pk_mul_f32 v[128:129], v[128:129], v[156:157] op_sel_hi:[1,0]
    v_pk_mul_f32 v[148:149], v[148:149], v[156:157] op_sel_hi:[1,0]
    v_accvgpr_read_b32 v134, a46
    v_cvt_pk_bf16_f32 v128, v128, v129
    v_cvt_pk_bf16_f32 v132, v132, v133
    v_pk_mul_f32 v[134:135], v[134:135], v[156:157] op_sel_hi:[1,0]
    v_cvt_pk_bf16_f32 v148, v148, v149
    v_cvt_pk_bf16_f32 v145, v146, v147
    v_cvt_pk_bf16_f32 v149, v150, v151
    v_cvt_pk_bf16_f32 v129, v130, v131
    v_cvt_pk_bf16_f32 v205, v206, v207
    v_cvt_pk_bf16_f32 v133, v134, v135
    s_waitcnt lgkmcnt(0)
    buffer_store_dwordx4 v[136:139], v12, s[16:19], s84 offen offset:128 sc0 sc1 nt
    buffer_store_dwordx4 v[140:143], v12, s[16:19], s84 offen offset:3200 sc0 sc1 nt
    buffer_store_dwordx4 v[32:35], v12, s[16:19], s85 offen offset:128 sc0 sc1 nt
    ds_write2st64_b64 v14, v[192:193], v[240:241] offset0:8 offset1:20
    ds_write_b64 v14, v[144:145] offset:16384
    ds_write2st64_b64 v0, v[196:197], v[244:245] offset0:8 offset1:20
    ds_write_b64 v0, v[148:149] offset:16384
    ds_write2st64_b64 v15, v[200:201], v[248:249] offset0:8 offset1:20
    ds_write_b64 v15, v[128:129] offset:16384
    ds_write2st64_b64 v8, v[204:205], v[252:253] offset0:8 offset1:20
    ds_write_b64 v8, v[132:133] offset:16384
    ds_read_b128 v[136:139], v13 offset:4096
    ds_read_b128 v[140:143], v13 offset:5120
    ds_read_b128 v[32:35], v13 offset:10240
    buffer_store_dwordx4 v[36:39], v12, s[16:19], s85 offen offset:3200 sc0 sc1 nt
    buffer_store_dwordx4 v[40:43], v12, s[16:19], s86 offen offset:128 sc0 sc1 nt
    ds_read_b128 v[36:39], v13 offset:11264
    ds_read_b128 v[40:43], v13 offset:16384
    buffer_store_dwordx4 v[44:47], v12, s[16:19], s86 offen offset:3200 sc0 sc1 nt
    s_nop 0
    ds_read_b128 v[44:47], v13 offset:17408
    s_waitcnt lgkmcnt(5)
    buffer_store_dwordx4 v[136:139], v12, s[16:19], s84 offen offset:256 sc0 sc1 nt
    s_waitcnt lgkmcnt(3)
    buffer_store_dwordx4 v[140:143], v12, s[16:19], s84 offen offset:3328 sc0 sc1 nt
    buffer_store_dwordx4 v[32:35], v12, s[16:19], s85 offen offset:256 sc0 sc1 nt
    s_waitcnt lgkmcnt(2)
    buffer_store_dwordx4 v[36:39], v12, s[16:19], s85 offen offset:3328 sc0 sc1 nt
    s_waitcnt lgkmcnt(1)
    buffer_store_dwordx4 v[40:43], v12, s[16:19], s86 offen offset:256 sc0 sc1 nt
    s_waitcnt lgkmcnt(0)
    buffer_store_dwordx4 v[44:47], v12, s[16:19], s86 offen offset:3328 sc0 sc1 nt
    s_branch L_fin
L_fin:
    s_waitcnt vmcnt(0)
L_end:
    s_endpgm
L_codeend:
L_rare4_0:
    s_nop 15
    v_max3_f32 v28, v32, v33, v34
    v_max3_f32 v28, v28, v35, v36
    v_max3_f32 v28, v28, v37, v38
    v_max_f32 v28, v28, v39
    v_mov_b32 v29, v28
    s_nop 1
    v_permlane32_swap_b32 v29, v28
    v_max_f32 v28, v28, v29
    v_mov_b32 v29, v28
    s_nop 1
    v_permlane16_swap_b32 v29, v28
    v_max_f32 v28, v28, v29
    v_max_f32 v30, 0, v28
    v_sub_f32 v16, v16, v30
    v_sub_f32 v31, 0, v30
    v_exp_f32 v31, v31
    s_nop 0
    v_mul_f32 v24, v24, v31
    v_cndmask_b32_e64 v24, v24, 0, s[46:47]
    v_mul_f32 v160, v160, v31
    v_mul_f32 v161, v161, v31
    v_mul_f32 v162, v162, v31
    v_mul_f32 v163, v163, v31
    v_mul_f32 v164, v164, v31
    v_mul_f32 v165, v165, v31
    v_mul_f32 v166, v166, v31
    v_mul_f32 v167, v167, v31
    v_mul_f32 v168, v168, v31
    v_mul_f32 v169, v169, v31
    v_mul_f32 v170, v170, v31
    v_mul_f32 v171, v171, v31
    v_mul_f32 v172, v172, v31
    v_mul_f32 v173, v173, v31
    v_mul_f32 v174, v174, v31
    v_mul_f32 v175, v175, v31
    v_mul_f32 v176, v176, v31
    v_mul_f32 v177, v177, v31
    v_mul_f32 v178, v178, v31
    v_mul_f32 v179, v179, v31
    v_mul_f32 v180, v180, v31
    v_mul_f32 v181, v181, v31
    v_mul_f32 v182, v182, v31
    v_mul_f32 v183, v183, v31
    v_mul_f32 v184, v184, v31
    v_mul_f32 v185, v185, v31
    v_mul_f32 v186, v186, v31
    v_mul_f32 v187, v187, v31
    v_mul_f32 v188, v188, v31
    v_mul_f32 v189, v189, v31
    v_mul_f32 v190, v190, v31
    v_mul_f32 v191, v191, v31
    v_mul_f32 v192, v192, v31
    v_mul_f32 v193, v193, v31
    v_mul_f32 v194, v194, v31
    v_mul_f32 v195, v195, v31
    v_mul_f32 v196, v196, v31
    v_mul_f32 v197, v197, v31
    v_mul_f32 v198, v198, v31
    v_mul_f32 v199, v199, v31
    v_mul_f32 v200, v200, v31
    v_mul_f32 v201, v201, v31
    v_mul_f32 v202, v202, v31
    v_mul_f32 v203, v203, v31
    v_mul_f32 v204, v204, v31
    v_mul_f32 v205, v205, v31
    v_mul_f32 v206, v206, v31
    v_mul_f32 v207, v207, v31
    v_sub_f32 v32, v32, v30
    v_sub_f32 v33, v33, v30
    v_exp_f32 v128, v32
    v_exp_f32 v129, v33
    s_nop 0
    v_cvt_pk_bf16_f32 v96, v128, v129
    v_sub_f32 v34, v34, v30
    v_sub_f32 v35, v35, v30
    v_exp_f32 v128, v34
    v_exp_f32 v129, v35
    s_nop 0
    v_cvt_pk_bf16_f32 v97, v128, v129
    v_sub_f32 v36, v36, v30
    v_sub_f32 v37, v37, v30
    v_exp_f32 v128, v36
    v_exp_f32 v129, v37
    s_nop 0
    v_cvt_pk_bf16_f32 v98, v128, v129
    v_sub_f32 v38, v38, v30
    v_sub_f32 v39, v39, v30
    v_exp_f32 v128, v38
    v_exp_f32 v129, v39
    s_nop 0
    v_cvt_pk_bf16_f32 v99, v128, v129
    v_max3_f32 v28, v40, v41, v42
    v_max3_f32 v28, v28, v43, v44
    v_max3_f32 v28, v28, v45, v46
    v_max_f32 v28, v28, v47
    v_mov_b32 v29, v28
    s_nop 1
    v_permlane32_swap_b32 v29, v28
    v_max_f32 v28, v28, v29
    v_mov_b32 v29, v28
    s_nop 1
    v_permlane16_swap_b32 v29, v28
    v_max_f32 v28, v28, v29
    v_max_f32 v30, 0, v28
    v_sub_f32 v17, v17, v30
    v_sub_f32 v31, 0, v30
    v_exp_f32 v31, v31
    s_nop 0
    v_mul_f32 v25, v25, v31
    v_mul_f32 v208, v208, v31
    v_mul_f32 v209, v209, v31
    v_mul_f32 v210, v210, v31
    v_mul_f32 v211, v211, v31
    v_mul_f32 v212, v212, v31
    v_mul_f32 v213, v213, v31
    v_mul_f32 v214, v214, v31
    v_mul_f32 v215, v215, v31
    v_mul_f32 v216, v216, v31
    v_mul_f32 v217, v217, v31
    v_mul_f32 v218, v218, v31
    v_mul_f32 v219, v219, v31
    v_mul_f32 v220, v220, v31
    v_mul_f32 v221, v221, v31
    v_mul_f32 v222, v222, v31
    v_mul_f32 v223, v223, v31
    v_mul_f32 v224, v224, v31
    v_mul_f32 v225, v225, v31
    v_mul_f32 v226, v226, v31
    v_mul_f32 v227, v227, v31
    v_mul_f32 v228, v228, v31
    v_mul_f32 v229, v229, v31
    v_mul_f32 v230, v230, v31
    v_mul_f32 v231, v231, v31
    v_mul_f32 v232, v232, v31
    v_mul_f32 v233, v233, v31
    v_mul_f32 v234, v234, v31
    v_mul_f32 v235, v235, v31
    v_mul_f32 v236, v236, v31
    v_mul_f32 v237, v237, v31
    v_mul_f32 v238, v238, v31
    v_mul_f32 v239, v239, v31
    v_mul_f32 v240, v240, v31
    v_mul_f32 v241, v241, v31
    v_mul_f32 v242, v242, v31
    v_mul_f32 v243, v243, v31
    v_mul_f32 v244, v244, v31
    v_mul_f32 v245, v245, v31
    v_mul_f32 v246, v246, v31
    v_mul_f32 v247, v247, v31
    v_mul_f32 v248, v248, v31
    v_mul_f32 v249, v249, v31
    v_mul_f32 v250, v250, v31
    v_mul_f32 v251, v251, v31
    v_mul_f32 v252, v252, v31
    v_mul_f32 v253, v253, v31
    v_mul_f32 v254, v254, v31
    v_mul_f32 v255, v255, v31
    v_sub_f32 v40, v40, v30
    v_sub_f32 v41, v41, v30
    v_exp_f32 v128, v40
    v_exp_f32 v129, v41
    s_nop 0
    v_cvt_pk_bf16_f32 v100, v128, v129
    v_sub_f32 v42, v42, v30
    v_sub_f32 v43, v43, v30
    v_exp_f32 v128, v42
    v_exp_f32 v129, v43
    s_nop 0
    v_cvt_pk_bf16_f32 v101, v128, v129
    v_sub_f32 v44, v44, v30
    v_sub_f32 v45, v45, v30
    v_exp_f32 v128, v44
    v_exp_f32 v129, v45
    s_nop 0
    v_cvt_pk_bf16_f32 v102, v128, v129
    v_sub_f32 v46, v46, v30
    v_sub_f32 v47, v47, v30
    v_exp_f32 v128, v46
    v_exp_f32 v129, v47
    s_nop 0
    v_cvt_pk_bf16_f32 v103, v128, v129
    v_max3_f32 v28, v48, v49, v50
    v_max3_f32 v28, v28, v51, v52
    v_max3_f32 v28, v28, v53, v54
    v_max_f32 v28, v28, v55
    v_mov_b32 v29, v28
    s_nop 1
    v_permlane32_swap_b32 v29, v28
    v_max_f32 v28, v28, v29
    v_mov_b32 v29, v28
    s_nop 1
    v_permlane16_swap_b32 v29, v28
    v_max_f32 v28, v28, v29
    v_max_f32 v30, 0, v28
    v_sub_f32 v18, v18, v30
    v_sub_f32 v31, 0, v30
    v_exp_f32 v31, v31
    s_nop 0
    v_mul_f32 v26, v26, v31
    v_accvgpr_read_b32 v132, a0
    v_accvgpr_read_b32 v133, a1
    v_accvgpr_read_b32 v134, a2
    v_accvgpr_read_b32 v135, a3
    v_mul_f32 v132, v132, v31
    v_mul_f32 v133, v133, v31
    v_mul_f32 v134, v134, v31
    v_mul_f32 v135, v135, v31
    v_accvgpr_write_b32 a0, v132
    v_accvgpr_write_b32 a1, v133
    v_accvgpr_write_b32 a2, v134
    v_accvgpr_write_b32 a3, v135
    v_accvgpr_read_b32 v132, a4
    v_accvgpr_read_b32 v133, a5
    v_accvgpr_read_b32 v134, a6
    v_accvgpr_read_b32 v135, a7
    v_mul_f32 v132, v132, v31
    v_mul_f32 v133, v133, v31
    v_mul_f32 v134, v134, v31
    v_mul_f32 v135, v135, v31
    v_accvgpr_write_b32 a4, v132
    v_accvgpr_write_b32 a5, v133
    v_accvgpr_write_b32 a6, v134
    v_accvgpr_write_b32 a7, v135
    v_accvgpr_read_b32 v132, a8
    v_accvgpr_read_b32 v133, a9
    v_accvgpr_read_b32 v134, a10
    v_accvgpr_read_b32 v135, a11
    v_mul_f32 v132, v132, v31
    v_mul_f32 v133, v133, v31
    v_mul_f32 v134, v134, v31
    v_mul_f32 v135, v135, v31
    v_accvgpr_write_b32 a8, v132
    v_accvgpr_write_b32 a9, v133
    v_accvgpr_write_b32 a10, v134
    v_accvgpr_write_b32 a11, v135
    v_accvgpr_read_b32 v132, a12
    v_accvgpr_read_b32 v133, a13
    v_accvgpr_read_b32 v134, a14
    v_accvgpr_read_b32 v135, a15
    v_mul_f32 v132, v132, v31
    v_mul_f32 v133, v133, v31
    v_mul_f32 v134, v134, v31
    v_mul_f32 v135, v135, v31
    v_accvgpr_write_b32 a12, v132
    v_accvgpr_write_b32 a13, v133
    v_accvgpr_write_b32 a14, v134
    v_accvgpr_write_b32 a15, v135
    v_accvgpr_read_b32 v132, a16
    v_accvgpr_read_b32 v133, a17
    v_accvgpr_read_b32 v134, a18
    v_accvgpr_read_b32 v135, a19
    v_mul_f32 v132, v132, v31
    v_mul_f32 v133, v133, v31
    v_mul_f32 v134, v134, v31
    v_mul_f32 v135, v135, v31
    v_accvgpr_write_b32 a16, v132
    v_accvgpr_write_b32 a17, v133
    v_accvgpr_write_b32 a18, v134
    v_accvgpr_write_b32 a19, v135
    v_accvgpr_read_b32 v132, a20
    v_accvgpr_read_b32 v133, a21
    v_accvgpr_read_b32 v134, a22
    v_accvgpr_read_b32 v135, a23
    v_mul_f32 v132, v132, v31
    v_mul_f32 v133, v133, v31
    v_mul_f32 v134, v134, v31
    v_mul_f32 v135, v135, v31
    v_accvgpr_write_b32 a20, v132
    v_accvgpr_write_b32 a21, v133
    v_accvgpr_write_b32 a22, v134
    v_accvgpr_write_b32 a23, v135
    v_accvgpr_read_b32 v132, a24
    v_accvgpr_read_b32 v133, a25
    v_accvgpr_read_b32 v134, a26
    v_accvgpr_read_b32 v135, a27
    v_mul_f32 v132, v132, v31
    v_mul_f32 v133, v133, v31
    v_mul_f32 v134, v134, v31
    v_mul_f32 v135, v135, v31
    v_accvgpr_write_b32 a24, v132
    v_accvgpr_write_b32 a25, v133
    v_accvgpr_write_b32 a26, v134
    v_accvgpr_write_b32 a27, v135
    v_accvgpr_read_b32 v132, a28
    v_accvgpr_read_b32 v133, a29
    v_accvgpr_read_b32 v134, a30
    v_accvgpr_read_b32 v135, a31
    v_mul_f32 v132, v132, v31
    v_mul_f32 v133, v133, v31
    v_mul_f32 v134, v134, v31
    v_mul_f32 v135, v135, v31
    v_accvgpr_write_b32 a28, v132
    v_accvgpr_write_b32 a29, v133
    v_accvgpr_write_b32 a30, v134
    v_accvgpr_write_b32 a31, v135
    v_accvgpr_read_b32 v132, a32
    v_accvgpr_read_b32 v133, a33
    v_accvgpr_read_b32 v134, a34
    v_accvgpr_read_b32 v135, a35
    v_mul_f32 v132, v132, v31
    v_mul_f32 v133, v133, v31
    v_mul_f32 v134, v134, v31
    v_mul_f32 v135, v135, v31
    v_accvgpr_write_b32 a32, v132
    v_accvgpr_write_b32 a33, v133
    v_accvgpr_write_b32 a34, v134
    v_accvgpr_write_b32 a35, v135
    v_accvgpr_read_b32 v132, a36
    v_accvgpr_read_b32 v133, a37
    v_accvgpr_read_b32 v134, a38
    v_accvgpr_read_b32 v135, a39
    v_mul_f32 v132, v132, v31
    v_mul_f32 v133, v133, v31
    v_mul_f32 v134, v134, v31
    v_mul_f32 v135, v135, v31
    v_accvgpr_write_b32 a36, v132
    v_accvgpr_write_b32 a37, v133
    v_accvgpr_write_b32 a38, v134
    v_accvgpr_write_b32 a39, v135
    v_accvgpr_read_b32 v132, a40
    v_accvgpr_read_b32 v133, a41
    v_accvgpr_read_b32 v134, a42
    v_accvgpr_read_b32 v135, a43
    v_mul_f32 v132, v132, v31
    v_mul_f32 v133, v133, v31
    v_mul_f32 v134, v134, v31
    v_mul_f32 v135, v135, v31
    v_accvgpr_write_b32 a40, v132
    v_accvgpr_write_b32 a41, v133
    v_accvgpr_write_b32 a42, v134
    v_accvgpr_write_b32 a43, v135
    v_accvgpr_read_b32 v132, a44
    v_accvgpr_read_b32 v133, a45
    v_accvgpr_read_b32 v134, a46
    v_accvgpr_read_b32 v135, a47
    v_mul_f32 v132, v132, v31
    v_mul_f32 v133, v133, v31
    v_mul_f32 v134, v134, v31
    v_mul_f32 v135, v135, v31
    v_accvgpr_write_b32 a44, v132
    v_accvgpr_write_b32 a45, v133
    v_accvgpr_write_b32 a46, v134
    v_accvgpr_write_b32 a47, v135
    v_sub_f32 v48, v48, v30
    v_sub_f32 v49, v49, v30
    v_exp_f32 v128, v48
    v_exp_f32 v129, v49
    s_nop 0
    v_cvt_pk_bf16_f32 v104, v128, v129
    v_sub_f32 v50, v50, v30
    v_sub_f32 v51, v51, v30
    v_exp_f32 v128, v50
    v_exp_f32 v129, v51
    s_nop 0
    v_cvt_pk_bf16_f32 v105, v128, v129
    v_sub_f32 v52, v52, v30
    v_sub_f32 v53, v53, v30
    v_exp_f32 v128, v52
    v_exp_f32 v129, v53
    s_nop 0
    v_cvt_pk_bf16_f32 v106, v128, v129
    v_sub_f32 v54, v54, v30
    v_sub_f32 v55, v55, v30
    v_exp_f32 v128, v54
    v_exp_f32 v129, v55
    s_nop 0
    v_cvt_pk_bf16_f32 v107, v128, v129
    v_max3_f32 v28, v56, v57, v58
    v_max3_f32 v28, v28, v59, v60
    v_max3_f32 v28, v28, v61, v62
    v_max_f32 v28, v28, v63
    v_mov_b32 v29, v28
    s_nop 1
    v_permlane32_swap_b32 v29, v28
    v_max_f32 v28, v28, v29
    v_mov_b32 v29, v28
    s_nop 1
    v_permlane16_swap_b32 v29, v28
    v_max_f32 v28, v28, v29
    v_max_f32 v30, 0, v28
    v_sub_f32 v19, v19, v30
    v_sub_f32 v31, 0, v30
    v_exp_f32 v31, v31
    s_nop 0
    v_mul_f32 v27, v27, v31
    v_accvgpr_read_b32 v132, a48
    v_accvgpr_read_b32 v133, a49
    v_accvgpr_read_b32 v134, a50
    v_accvgpr_read_b32 v135, a51
    v_mul_f32 v132, v132, v31
    v_mul_f32 v133, v133, v31
    v_mul_f32 v134, v134, v31
    v_mul_f32 v135, v135, v31
    v_accvgpr_write_b32 a48, v132
    v_accvgpr_write_b32 a49, v133
    v_accvgpr_write_b32 a50, v134
    v_accvgpr_write_b32 a51, v135
    v_accvgpr_read_b32 v132, a52
    v_accvgpr_read_b32 v133, a53
    v_accvgpr_read_b32 v134, a54
    v_accvgpr_read_b32 v135, a55
    v_mul_f32 v132, v132, v31
    v_mul_f32 v133, v133, v31
    v_mul_f32 v134, v134, v31
    v_mul_f32 v135, v135, v31
    v_accvgpr_write_b32 a52, v132
    v_accvgpr_write_b32 a53, v133
    v_accvgpr_write_b32 a54, v134
    v_accvgpr_write_b32 a55, v135
    v_accvgpr_read_b32 v132, a56
    v_accvgpr_read_b32 v133, a57
    v_accvgpr_read_b32 v134, a58
    v_accvgpr_read_b32 v135, a59
    v_mul_f32 v132, v132, v31
    v_mul_f32 v133, v133, v31
    v_mul_f32 v134, v134, v31
    v_mul_f32 v135, v135, v31
    v_accvgpr_write_b32 a56, v132
    v_accvgpr_write_b32 a57, v133
    v_accvgpr_write_b32 a58, v134
    v_accvgpr_write_b32 a59, v135
    v_accvgpr_read_b32 v132, a60
    v_accvgpr_read_b32 v133, a61
    v_accvgpr_read_b32 v134, a62
    v_accvgpr_read_b32 v135, a63
    v_mul_f32 v132, v132, v31
    v_mul_f32 v133, v133, v31
    v_mul_f32 v134, v134, v31
    v_mul_f32 v135, v135, v31
    v_accvgpr_write_b32 a60, v132
    v_accvgpr_write_b32 a61, v133
    v_accvgpr_write_b32 a62, v134
    v_accvgpr_write_b32 a63, v135
    v_accvgpr_read_b32 v132, a64
    v_accvgpr_read_b32 v133, a65
    v_accvgpr_read_b32 v134, a66
    v_accvgpr_read_b32 v135, a67
    v_mul_f32 v132, v132, v31
    v_mul_f32 v133, v133, v31
    v_mul_f32 v134, v134, v31
    v_mul_f32 v135, v135, v31
    v_accvgpr_write_b32 a64, v132
    v_accvgpr_write_b32 a65, v133
    v_accvgpr_write_b32 a66, v134
    v_accvgpr_write_b32 a67, v135
    v_accvgpr_read_b32 v132, a68
    v_accvgpr_read_b32 v133, a69
    v_accvgpr_read_b32 v134, a70
    v_accvgpr_read_b32 v135, a71
    v_mul_f32 v132, v132, v31
    v_mul_f32 v133, v133, v31
    v_mul_f32 v134, v134, v31
    v_mul_f32 v135, v135, v31
    v_accvgpr_write_b32 a68, v132
    v_accvgpr_write_b32 a69, v133
    v_accvgpr_write_b32 a70, v134
    v_accvgpr_write_b32 a71, v135
    v_accvgpr_read_b32 v132, a72
    v_accvgpr_read_b32 v133, a73
    v_accvgpr_read_b32 v134, a74
    v_accvgpr_read_b32 v135, a75
    v_mul_f32 v132, v132, v31
    v_mul_f32 v133, v133, v31
    v_mul_f32 v134, v134, v31
    v_mul_f32 v135, v135, v31
    v_accvgpr_write_b32 a72, v132
    v_accvgpr_write_b32 a73, v133
    v_accvgpr_write_b32 a74, v134
    v_accvgpr_write_b32 a75, v135
    v_accvgpr_read_b32 v132, a76
    v_accvgpr_read_b32 v133, a77
    v_accvgpr_read_b32 v134, a78
    v_accvgpr_read_b32 v135, a79
    v_mul_f32 v132, v132, v31
    v_mul_f32 v133, v133, v31
    v_mul_f32 v134, v134, v31
    v_mul_f32 v135, v135, v31
    v_accvgpr_write_b32 a76, v132
    v_accvgpr_write_b32 a77, v133
    v_accvgpr_write_b32 a78, v134
    v_accvgpr_write_b32 a79, v135
    v_accvgpr_read_b32 v132, a80
    v_accvgpr_read_b32 v133, a81
    v_accvgpr_read_b32 v134, a82
    v_accvgpr_read_b32 v135, a83
    v_mul_f32 v132, v132, v31
    v_mul_f32 v133, v133, v31
    v_mul_f32 v134, v134, v31
    v_mul_f32 v135, v135, v31
    v_accvgpr_write_b32 a80, v132
    v_accvgpr_write_b32 a81, v133
    v_accvgpr_write_b32 a82, v134
    v_accvgpr_write_b32 a83, v135
    v_accvgpr_read_b32 v132, a84
    v_accvgpr_read_b32 v133, a85
    v_accvgpr_read_b32 v134, a86
    v_accvgpr_read_b32 v135, a87
    v_mul_f32 v132, v132, v31
    v_mul_f32 v133, v133, v31
    v_mul_f32 v134, v134, v31
    v_mul_f32 v135, v135, v31
    v_accvgpr_write_b32 a84, v132
    v_accvgpr_write_b32 a85, v133
    v_accvgpr_write_b32 a86, v134
    v_accvgpr_write_b32 a87, v135
    v_accvgpr_read_b32 v132, a88
    v_accvgpr_read_b32 v133, a89
    v_accvgpr_read_b32 v134, a90
    v_accvgpr_read_b32 v135, a91
    v_mul_f32 v132, v132, v31
    v_mul_f32 v133, v133, v31
    v_mul_f32 v134, v134, v31
    v_mul_f32 v135, v135, v31
    v_accvgpr_write_b32 a88, v132
    v_accvgpr_write_b32 a89, v133
    v_accvgpr_write_b32 a90, v134
    v_accvgpr_write_b32 a91, v135
    v_accvgpr_read_b32 v132, a92
    v_accvgpr_read_b32 v133, a93
    v_accvgpr_read_b32 v134, a94
    v_accvgpr_read_b32 v135, a95
    v_mul_f32 v132, v132, v31
    v_mul_f32 v133, v133, v31
    v_mul_f32 v134, v134, v31
    v_mul_f32 v135, v135, v31
    v_accvgpr_write_b32 a92, v132
    v_accvgpr_write_b32 a93, v133
    v_accvgpr_write_b32 a94, v134
    v_accvgpr_write_b32 a95, v135
    v_sub_f32 v56, v56, v30
    v_sub_f32 v57, v57, v30
    v_exp_f32 v128, v56
    v_exp_f32 v129, v57
    s_nop 0
    v_cvt_pk_bf16_f32 v108, v128, v129
    v_sub_f32 v58, v58, v30
    v_sub_f32 v59, v59, v30
    v_exp_f32 v128, v58
    v_exp_f32 v129, v59
    s_nop 0
    v_cvt_pk_bf16_f32 v109, v128, v129
    v_sub_f32 v60, v60, v30
    v_sub_f32 v61, v61, v30
    v_exp_f32 v128, v60
    v_exp_f32 v129, v61
    s_nop 0
    v_cvt_pk_bf16_f32 v110, v128, v129
    v_sub_f32 v62, v62, v30
    v_sub_f32 v63, v63, v30
    v_exp_f32 v128, v62
    v_exp_f32 v129, v63
    s_nop 0
    v_cvt_pk_bf16_f32 v111, v128, v129
    v_mfma_f32_16x16x32_bf16 v[20:23], a[240:243], v[96:99], v[24:27]
    v_mfma_f32_16x16x32_bf16 v[20:23], a[244:247], v[100:103], v[20:23]
    v_mfma_f32_16x16x32_bf16 v[20:23], a[248:251], v[104:107], v[20:23]
    v_mfma_f32_16x16x32_bf16 v[20:23], a[252:255], v[108:111], v[20:23]
    s_nop 15
    s_setpc_b64 s[40:41]
L_rare4_1:
    s_nop 15
    v_max3_f32 v28, v64, v65, v66
    v_max3_f32 v28, v28, v67, v68
    v_max3_f32 v28, v28, v69, v70
    v_max_f32 v28, v28, v71
    v_mov_b32 v29, v28
    s_nop 1
    v_permlane32_swap_b32 v29, v28
    v_max_f32 v28, v28, v29
    v_mov_b32 v29, v28
    s_nop 1
    v_permlane16_swap_b32 v29, v28
    v_max_f32 v28, v28, v29
    v_max_f32 v30, 0, v28
    v_sub_f32 v16, v16, v30
    v_sub_f32 v31, 0, v30
    v_exp_f32 v31, v31
    s_nop 0
    v_mul_f32 v20, v20, v31
    v_cndmask_b32_e64 v20, v20, 0, s[46:47]
    v_mul_f32 v160, v160, v31
    v_mul_f32 v161, v161, v31
    v_mul_f32 v162, v162, v31
    v_mul_f32 v163, v163, v31
    v_mul_f32 v164, v164, v31
    v_mul_f32 v165, v165, v31
    v_mul_f32 v166, v166, v31
    v_mul_f32 v167, v167, v31
    v_mul_f32 v168, v168, v31
    v_mul_f32 v169, v169, v31
    v_mul_f32 v170, v170, v31
    v_mul_f32 v171, v171, v31
    v_mul_f32 v172, v172, v31
    v_mul_f32 v173, v173, v31
    v_mul_f32 v174, v174, v31
    v_mul_f32 v175, v175, v31
    v_mul_f32 v176, v176, v31
    v_mul_f32 v177, v177, v31
    v_mul_f32 v178, v178, v31
    v_mul_f32 v179, v179, v31
    v_mul_f32 v180, v180, v31
    v_mul_f32 v181, v181, v31
    v_mul_f32 v182, v182, v31
    v_mul_f32 v183, v183, v31
    v_mul_f32 v184, v184, v31
    v_mul_f32 v185, v185, v31
    v_mul_f32 v186, v186, v31
    v_mul_f32 v187, v187, v31
    v_mul_f32 v188, v188, v31
    v_mul_f32 v189, v189, v31
    v_mul_f32 v190, v190, v31
    v_mul_f32 v191, v191, v31
    v_mul_f32 v192, v192, v31
    v_mul_f32 v193, v193, v31
    v_mul_f32 v194, v194, v31
    v_mul_f32 v195, v195, v31
    v_mul_f32 v196, v196, v31
    v_mul_f32 v197, v197, v31
    v_mul_f32 v198, v198, v31
    v_mul_f32 v199, v199, v31
    v_mul_f32 v200, v200, v31
    v_mul_f32 v201, v201, v31
    v_mul_f32 v202, v202, v31
    v_mul_f32 v203, v203, v31
    v_mul_f32 v204, v204, v31
    v_mul_f32 v205, v205, v31
    v_mul_f32 v206, v206, v31
    v_mul_f32 v207, v207, v31
    v_sub_f32 v64, v64, v30
    v_sub_f32 v65, v65, v30
    v_exp_f32 v128, v64
    v_exp_f32 v129, v65
    s_nop 0
    v_cvt_pk_bf16_f32 v112, v128, v129
    v_sub_f32 v66, v66, v30
    v_sub_f32 v67, v67, v30
    v_exp_f32 v128, v66
    v_exp_f32 v129, v67
    s_nop 0
    v_cvt_pk_bf16_f32 v113, v128, v129
    v_sub_f32 v68, v68, v30
    v_sub_f32 v69, v69, v30
    v_exp_f32 v128, v68
    v_exp_f32 v129, v69
    s_nop 0
    v_cvt_pk_bf16_f32 v114, v128, v129
    v_sub_f32 v70, v70, v30
    v_sub_f32 v71, v71, v30
    v_exp_f32 v128, v70
    v_exp_f32 v129, v71
    s_nop 0
    v_cvt_pk_bf16_f32 v115, v128, v129
    v_max3_f32 v28, v72, v73, v74
    v_max3_f32 v28, v28, v75, v76
    v_max3_f32 v28, v28, v77, v78
    v_max_f32 v28, v28, v79
    v_mov_b32 v29, v28
    s_nop 1
    v_permlane32_swap_b32 v29, v28
    v_max_f32 v28, v28, v29
    v_mov_b32 v29, v28
    s_nop 1
    v_permlane16_swap_b32 v29, v28
    v_max_f32 v28, v28, v29
    v_max_f32 v30, 0, v28
    v_sub_f32 v17, v17, v30
    v_sub_f32 v31, 0, v30
    v_exp_f32 v31, v31
    s_nop 0
    v_mul_f32 v21, v21, v31
    v_mul_f32 v208, v208, v31
    v_mul_f32 v209, v209, v31
    v_mul_f32 v210, v210, v31
    v_mul_f32 v211, v211, v31
    v_mul_f32 v212, v212, v31
    v_mul_f32 v213, v213, v31
    v_mul_f32 v214, v214, v31
    v_mul_f32 v215, v215, v31
    v_mul_f32 v216, v216, v31
    v_mul_f32 v217, v217, v31
    v_mul_f32 v218, v218, v31
    v_mul_f32 v219, v219, v31
    v_mul_f32 v220, v220, v31
    v_mul_f32 v221, v221, v31
    v_mul_f32 v222, v222, v31
    v_mul_f32 v223, v223, v31
    v_mul_f32 v224, v224, v31
    v_mul_f32 v225, v225, v31
    v_mul_f32 v226, v226, v31
    v_mul_f32 v227, v227, v31
    v_mul_f32 v228, v228, v31
    v_mul_f32 v229, v229, v31
    v_mul_f32 v230, v230, v31
    v_mul_f32 v231, v231, v31
    v_mul_f32 v232, v232, v31
    v_mul_f32 v233, v233, v31
    v_mul_f32 v234, v234, v31
    v_mul_f32 v235, v235, v31
    v_mul_f32 v236, v236, v31
    v_mul_f32 v237, v237, v31
    v_mul_f32 v238, v238, v31
    v_mul_f32 v239, v239, v31
    v_mul_f32 v240, v240, v31
    v_mul_f32 v241, v241, v31
    v_mul_f32 v242, v242, v31
    v_mul_f32 v243, v243, v31
    v_mul_f32 v244, v244, v31
    v_mul_f32 v245, v245, v31
    v_mul_f32 v246, v246, v31
    v_mul_f32 v247, v247, v31
    v_mul_f32 v248, v248, v31
    v_mul_f32 v249, v249, v31
    v_mul_f32 v250, v250, v31
    v_mul_f32 v251, v251, v31
    v_mul_f32 v252, v252, v31
    v_mul_f32 v253, v253, v31
    v_mul_f32 v254, v254, v31
    v_mul_f32 v255, v255, v31
    v_sub_f32 v72, v72, v30
    v_sub_f32 v73, v73, v30
    v_exp_f32 v128, v72
    v_exp_f32 v129, v73
    s_nop 0
    v_cvt_pk_bf16_f32 v116, v128, v129
    v_sub_f32 v74, v74, v30
    v_sub_f32 v75, v75, v30
    v_exp_f32 v128, v74
    v_exp_f32 v129, v75
    s_nop 0
    v_cvt_pk_bf16_f32 v117, v128, v129
    v_sub_f32 v76, v76, v30
    v_sub_f32 v77, v77, v30
    v_exp_f32 v128, v76
    v_exp_f32 v129, v77
    s_nop 0
    v_cvt_pk_bf16_f32 v118, v128, v129
    v_sub_f32 v78, v78, v30
    v_sub_f32 v79, v79, v30
    v_exp_f32 v128, v78
    v_exp_f32 v129, v79
    s_nop 0
    v_cvt_pk_bf16_f32 v119, v128, v129
    v_max3_f32 v28, v80, v81, v82
    v_max3_f32 v28, v28, v83, v84
    v_max3_f32 v28, v28, v85, v86
    v_max_f32 v28, v28, v87
    v_mov_b32 v29, v28
    s_nop 1
    v_permlane32_swap_b32 v29, v28
    v_max_f32 v28, v28, v29
    v_mov_b32 v29, v28
    s_nop 1
    v_permlane16_swap_b32 v29, v28
    v_max_f32 v28, v28, v29
    v_max_f32 v30, 0, v28
    v_sub_f32 v18, v18, v30
    v_sub_f32 v31, 0, v30
    v_exp_f32 v31, v31
    s_nop 0
    v_mul_f32 v22, v22, v31
    v_accvgpr_read_b32 v132, a0
    v_accvgpr_read_b32 v133, a1
    v_accvgpr_read_b32 v134, a2
    v_accvgpr_read_b32 v135, a3
    v_mul_f32 v132, v132, v31
    v_mul_f32 v133, v133, v31
    v_mul_f32 v134, v134, v31
    v_mul_f32 v135, v135, v31
    v_accvgpr_write_b32 a0, v132
    v_accvgpr_write_b32 a1, v133
    v_accvgpr_write_b32 a2, v134
    v_accvgpr_write_b32 a3, v135
    v_accvgpr_read_b32 v132, a4
    v_accvgpr_read_b32 v133, a5
    v_accvgpr_read_b32 v134, a6
    v_accvgpr_read_b32 v135, a7
    v_mul_f32 v132, v132, v31
    v_mul_f32 v133, v133, v31
    v_mul_f32 v134, v134, v31
    v_mul_f32 v135, v135, v31
    v_accvgpr_write_b32 a4, v132
    v_accvgpr_write_b32 a5, v133
    v_accvgpr_write_b32 a6, v134
    v_accvgpr_write_b32 a7, v135
    v_accvgpr_read_b32 v132, a8
    v_accvgpr_read_b32 v133, a9
    v_accvgpr_read_b32 v134, a10
    v_accvgpr_read_b32 v135, a11
    v_mul_f32 v132, v132, v31
    v_mul_f32 v133, v133, v31
    v_mul_f32 v134, v134, v31
    v_mul_f32 v135, v135, v31
    v_accvgpr_write_b32 a8, v132
    v_accvgpr_write_b32 a9, v133
    v_accvgpr_write_b32 a10, v134
    v_accvgpr_write_b32 a11, v135
    v_accvgpr_read_b32 v132, a12
    v_accvgpr_read_b32 v133, a13
    v_accvgpr_read_b32 v134, a14
    v_accvgpr_read_b32 v135, a15
    v_mul_f32 v132, v132, v31
    v_mul_f32 v133, v133, v31
    v_mul_f32 v134, v134, v31
    v_mul_f32 v135, v135, v31
    v_accvgpr_write_b32 a12, v132
    v_accvgpr_write_b32 a13, v133
    v_accvgpr_write_b32 a14, v134
    v_accvgpr_write_b32 a15, v135
    v_accvgpr_read_b32 v132, a16
    v_accvgpr_read_b32 v133, a17
    v_accvgpr_read_b32 v134, a18
    v_accvgpr_read_b32 v135, a19
    v_mul_f32 v132, v132, v31
    v_mul_f32 v133, v133, v31
    v_mul_f32 v134, v134, v31
    v_mul_f32 v135, v135, v31
    v_accvgpr_write_b32 a16, v132
    v_accvgpr_write_b32 a17, v133
    v_accvgpr_write_b32 a18, v134
    v_accvgpr_write_b32 a19, v135
    v_accvgpr_read_b32 v132, a20
    v_accvgpr_read_b32 v133, a21
    v_accvgpr_read_b32 v134, a22
    v_accvgpr_read_b32 v135, a23
    v_mul_f32 v132, v132, v31
    v_mul_f32 v133, v133, v31
    v_mul_f32 v134, v134, v31
    v_mul_f32 v135, v135, v31
    v_accvgpr_write_b32 a20, v132
    v_accvgpr_write_b32 a21, v133
    v_accvgpr_write_b32 a22, v134
    v_accvgpr_write_b32 a23, v135
    v_accvgpr_read_b32 v132, a24
    v_accvgpr_read_b32 v133, a25
    v_accvgpr_read_b32 v134, a26
    v_accvgpr_read_b32 v135, a27
    v_mul_f32 v132, v132, v31
    v_mul_f32 v133, v133, v31
    v_mul_f32 v134, v134, v31
    v_mul_f32 v135, v135, v31
    v_accvgpr_write_b32 a24, v132
    v_accvgpr_write_b32 a25, v133
    v_accvgpr_write_b32 a26, v134
    v_accvgpr_write_b32 a27, v135
    v_accvgpr_read_b32 v132, a28
    v_accvgpr_read_b32 v133, a29
    v_accvgpr_read_b32 v134, a30
    v_accvgpr_read_b32 v135, a31
    v_mul_f32 v132, v132, v31
    v_mul_f32 v133, v133, v31
    v_mul_f32 v134, v134, v31
    v_mul_f32 v135, v135, v31
    v_accvgpr_write_b32 a28, v132
    v_accvgpr_write_b32 a29, v133
    v_accvgpr_write_b32 a30, v134
    v_accvgpr_write_b32 a31, v135
    v_accvgpr_read_b32 v132, a32
    v_accvgpr_read_b32 v133, a33
    v_accvgpr_read_b32 v134, a34
    v_accvgpr_read_b32 v135, a35
    v_mul_f32 v132, v132, v31
    v_mul_f32 v133, v133, v31
    v_mul_f32 v134, v134, v31
    v_mul_f32 v135, v135, v31
    v_accvgpr_write_b32 a32, v132
    v_accvgpr_write_b32 a33, v133
    v_accvgpr_write_b32 a34, v134
    v_accvgpr_write_b32 a35, v135
    v_accvgpr_read_b32 v132, a36
    v_accvgpr_read_b32 v133, a37
    v_accvgpr_read_b32 v134, a38
    v_accvgpr_read_b32 v135, a39
    v_mul_f32 v132, v132, v31
    v_mul_f32 v133, v133, v31
    v_mul_f32 v134, v134, v31
    v_mul_f32 v135, v135, v31
    v_accvgpr_write_b32 a36, v132
    v_accvgpr_write_b32 a37, v133
    v_accvgpr_write_b32 a38, v134
    v_accvgpr_write_b32 a39, v135
    v_accvgpr_read_b32 v132, a40
    v_accvgpr_read_b32 v133, a41
    v_accvgpr_read_b32 v134, a42
    v_accvgpr_read_b32 v135, a43
    v_mul_f32 v132, v132, v31
    v_mul_f32 v133, v133, v31
    v_mul_f32 v134, v134, v31
    v_mul_f32 v135, v135, v31
    v_accvgpr_write_b32 a40, v132
    v_accvgpr_write_b32 a41, v133
    v_accvgpr_write_b32 a42, v134
    v_accvgpr_write_b32 a43, v135
    v_accvgpr_read_b32 v132, a44
    v_accvgpr_read_b32 v133, a45
    v_accvgpr_read_b32 v134, a46
    v_accvgpr_read_b32 v135, a47
    v_mul_f32 v132, v132, v31
    v_mul_f32 v133, v133, v31
    v_mul_f32 v134, v134, v31
    v_mul_f32 v135, v135, v31
    v_accvgpr_write_b32 a44, v132
    v_accvgpr_write_b32 a45, v133
    v_accvgpr_write_b32 a46, v134
    v_accvgpr_write_b32 a47, v135
    v_sub_f32 v80, v80, v30
    v_sub_f32 v81, v81, v30
    v_exp_f32 v128, v80
    v_exp_f32 v129, v81
    s_nop 0
    v_cvt_pk_bf16_f32 v120, v128, v129
    v_sub_f32 v82, v82, v30
    v_sub_f32 v83, v83, v30
    v_exp_f32 v128, v82
    v_exp_f32 v129, v83
    s_nop 0
    v_cvt_pk_bf16_f32 v121, v128, v129
    v_sub_f32 v84, v84, v30
    v_sub_f32 v85, v85, v30
    v_exp_f32 v128, v84
    v_exp_f32 v129, v85
    s_nop 0
    v_cvt_pk_bf16_f32 v122, v128, v129
    v_sub_f32 v86, v86, v30
    v_sub_f32 v87, v87, v30
    v_exp_f32 v128, v86
    v_exp_f32 v129, v87
    s_nop 0
    v_cvt_pk_bf16_f32 v123, v128, v129
    v_max3_f32 v28, v88, v89, v90
    v_max3_f32 v28, v28, v91, v92
    v_max3_f32 v28, v28, v93, v94
    v_max_f32 v28, v28, v95
    v_mov_b32 v29, v28
    s_nop 1
    v_permlane32_swap_b32 v29, v28
    v_max_f32 v28, v28, v29
    v_mov_b32 v29, v28
    s_nop 1
    v_permlane16_swap_b32 v29, v28
    v_max_f32 v28, v28, v29
    v_max_f32 v30, 0, v28
    v_sub_f32 v19, v19, v30
    v_sub_f32 v31, 0, v30
    v_exp_f32 v31, v31
    s_nop 0
    v_mul_f32 v23, v23, v31
    v_accvgpr_read_b32 v132, a48
    v_accvgpr_read_b32 v133, a49
    v_accvgpr_read_b32 v134, a50
    v_accvgpr_read_b32 v135, a51
    v_mul_f32 v132, v132, v31
    v_mul_f32 v133, v133, v31
    v_mul_f32 v134, v134, v31
    v_mul_f32 v135, v135, v31
    v_accvgpr_write_b32 a48, v132
    v_accvgpr_write_b32 a49, v133
    v_accvgpr_write_b32 a50, v134
    v_accvgpr_write_b32 a51, v135
    v_accvgpr_read_b32 v132, a52
    v_accvgpr_read_b32 v133, a53
    v_accvgpr_read_b32 v134, a54
    v_accvgpr_read_b32 v135, a55
    v_mul_f32 v132, v132, v31
    v_mul_f32 v133, v133, v31
    v_mul_f32 v134, v134, v31
    v_mul_f32 v135, v135, v31
    v_accvgpr_write_b32 a52, v132
    v_accvgpr_write_b32 a53, v133
    v_accvgpr_write_b32 a54, v134
    v_accvgpr_write_b32 a55, v135
    v_accvgpr_read_b32 v132, a56
    v_accvgpr_read_b32 v133, a57
    v_accvgpr_read_b32 v134, a58
    v_accvgpr_read_b32 v135, a59
    v_mul_f32 v132, v132, v31
    v_mul_f32 v133, v133, v31
    v_mul_f32 v134, v134, v31
    v_mul_f32 v135, v135, v31
    v_accvgpr_write_b32 a56, v132
    v_accvgpr_write_b32 a57, v133
    v_accvgpr_write_b32 a58, v134
    v_accvgpr_write_b32 a59, v135
    v_accvgpr_read_b32 v132, a60
    v_accvgpr_read_b32 v133, a61
    v_accvgpr_read_b32 v134, a62
    v_accvgpr_read_b32 v135, a63
    v_mul_f32 v132, v132, v31
    v_mul_f32 v133, v133, v31
    v_mul_f32 v134, v134, v31
    v_mul_f32 v135, v135, v31
    v_accvgpr_write_b32 a60, v132
    v_accvgpr_write_b32 a61, v133
    v_accvgpr_write_b32 a62, v134
    v_accvgpr_write_b32 a63, v135
    v_accvgpr_read_b32 v132, a64
    v_accvgpr_read_b32 v133, a65
    v_accvgpr_read_b32 v134, a66
    v_accvgpr_read_b32 v135, a67
    v_mul_f32 v132, v132, v31
    v_mul_f32 v133, v133, v31
    v_mul_f32 v134, v134, v31
    v_mul_f32 v135, v135, v31
    v_accvgpr_write_b32 a64, v132
    v_accvgpr_write_b32 a65, v133
    v_accvgpr_write_b32 a66, v134
    v_accvgpr_write_b32 a67, v135
    v_accvgpr_read_b32 v132, a68
    v_accvgpr_read_b32 v133, a69
    v_accvgpr_read_b32 v134, a70
    v_accvgpr_read_b32 v135, a71
    v_mul_f32 v132, v132, v31
    v_mul_f32 v133, v133, v31
    v_mul_f32 v134, v134, v31
    v_mul_f32 v135, v135, v31
    v_accvgpr_write_b32 a68, v132
    v_accvgpr_write_b32 a69, v133
    v_accvgpr_write_b32 a70, v134
    v_accvgpr_write_b32 a71, v135
    v_accvgpr_read_b32 v132, a72
    v_accvgpr_read_b32 v133, a73
    v_accvgpr_read_b32 v134, a74
    v_accvgpr_read_b32 v135, a75
    v_mul_f32 v132, v132, v31
    v_mul_f32 v133, v133, v31
    v_mul_f32 v134, v134, v31
    v_mul_f32 v135, v135, v31
    v_accvgpr_write_b32 a72, v132
    v_accvgpr_write_b32 a73, v133
    v_accvgpr_write_b32 a74, v134
    v_accvgpr_write_b32 a75, v135
    v_accvgpr_read_b32 v132, a76
    v_accvgpr_read_b32 v133, a77
    v_accvgpr_read_b32 v134, a78
    v_accvgpr_read_b32 v135, a79
    v_mul_f32 v132, v132, v31
    v_mul_f32 v133, v133, v31
    v_mul_f32 v134, v134, v31
    v_mul_f32 v135, v135, v31
    v_accvgpr_write_b32 a76, v132
    v_accvgpr_write_b32 a77, v133
    v_accvgpr_write_b32 a78, v134
    v_accvgpr_write_b32 a79, v135
    v_accvgpr_read_b32 v132, a80
    v_accvgpr_read_b32 v133, a81
    v_accvgpr_read_b32 v134, a82
    v_accvgpr_read_b32 v135, a83
    v_mul_f32 v132, v132, v31
    v_mul_f32 v133, v133, v31
    v_mul_f32 v134, v134, v31
    v_mul_f32 v135, v135, v31
    v_accvgpr_write_b32 a80, v132
    v_accvgpr_write_b32 a81, v133
    v_accvgpr_write_b32 a82, v134
    v_accvgpr_write_b32 a83, v135
    v_accvgpr_read_b32 v132, a84
    v_accvgpr_read_b32 v133, a85
    v_accvgpr_read_b32 v134, a86
    v_accvgpr_read_b32 v135, a87
    v_mul_f32 v132, v132, v31
    v_mul_f32 v133, v133, v31
    v_mul_f32 v134, v134, v31
    v_mul_f32 v135, v135, v31
    v_accvgpr_write_b32 a84, v132
    v_accvgpr_write_b32 a85, v133
    v_accvgpr_write_b32 a86, v134
    v_accvgpr_write_b32 a87, v135
    v_accvgpr_read_b32 v132, a88
    v_accvgpr_read_b32 v133, a89
    v_accvgpr_read_b32 v134, a90
    v_accvgpr_read_b32 v135, a91
    v_mul_f32 v132, v132, v31
    v_mul_f32 v133, v133, v31
    v_mul_f32 v134, v134, v31
    v_mul_f32 v135, v135, v31
    v_accvgpr_write_b32 a88, v132
    v_accvgpr_write_b32 a89, v133
    v_accvgpr_write_b32 a90, v134
    v_accvgpr_write_b32 a91, v135
    v_accvgpr_read_b32 v132, a92
    v_accvgpr_read_b32 v133, a93
    v_accvgpr_read_b32 v134, a94
    v_accvgpr_read_b32 v135, a95
    v_mul_f32 v132, v132, v31
    v_mul_f32 v133, v133, v31
    v_mul_f32 v134, v134, v31
    v_mul_f32 v135, v135, v31
    v_accvgpr_write_b32 a92, v132
    v_accvgpr_write_b32 a93, v133
    v_accvgpr_write_b32 a94, v134
    v_accvgpr_write_b32 a95, v135
    v_sub_f32 v88, v88, v30
    v_sub_f32 v89, v89, v30
    v_exp_f32 v128, v88
    v_exp_f32 v129, v89
    s_nop 0
    v_cvt_pk_bf16_f32 v124, v128, v129
    v_sub_f32 v90, v90, v30
    v_sub_f32 v91, v91, v30
    v_exp_f32 v128, v90
    v_exp_f32 v129, v91
    s_nop 0
    v_cvt_pk_bf16_f32 v125, v128, v129
    v_sub_f32 v92, v92, v30
    v_sub_f32 v93, v93, v30
    v_exp_f32 v128, v92
    v_exp_f32 v129, v93
    s_nop 0
    v_cvt_pk_bf16_f32 v126, v128, v129
    v_sub_f32 v94, v94, v30
    v_sub_f32 v95, v95, v30
    v_exp_f32 v128, v94
    v_exp_f32 v129, v95
    s_nop 0
    v_cvt_pk_bf16_f32 v127, v128, v129
    v_mfma_f32_16x16x32_bf16 v[24:27], a[240:243], v[112:115], v[20:23]
    v_mfma_f32_16x16x32_bf16 v[24:27], a[244:247], v[116:119], v[24:27]
    v_mfma_f32_16x16x32_bf16 v[24:27], a[248:251], v[120:123], v[24:27]
    v_mfma_f32_16x16x32_bf16 v[24:27], a[252:255], v[124:127], v[24:27]
    s_nop 15
    s_setpc_b64 s[40:41]
L_rare3_0:
    s_nop 15
    v_max3_f32 v28, v32, v33, v34
    v_max3_f32 v28, v28, v35, v36
    v_max3_f32 v28, v28, v37, v38
    v_max_f32 v28, v28, v39
    v_mov_b32 v29, v28
    s_nop 1
    v_permlane32_swap_b32 v29, v28
    v_max_f32 v28, v28, v29
    v_mov_b32 v29, v28
    s_nop 1
    v_permlane16_swap_b32 v29, v28
    v_max_f32 v28, v28, v29
    v_max_f32 v30, 0, v28
    v_sub_f32 v16, v16, v30
    v_sub_f32 v31, 0, v30
    v_exp_f32 v31, v31
    s_nop 0
    v_mul_f32 v24, v24, v31
    v_cndmask_b32_e64 v24, v24, 0, s[46:47]
    v_mul_f32 v160, v160, v31
    v_mul_f32 v161, v161, v31
    v_mul_f32 v162, v162, v31
    v_mul_f32 v163, v163, v31
    v_mul_f32 v164, v164, v31
    v_mul_f32 v165, v165, v31
    v_mul_f32 v166, v166, v31
    v_mul_f32 v167, v167, v31
    v_mul_f32 v168, v168, v31
    v_mul_f32 v169, v169, v31
    v_mul_f32 v170, v170, v31
    v_mul_f32 v171, v171, v31
    v_mul_f32 v172, v172, v31
    v_mul_f32 v173, v173, v31
    v_mul_f32 v174, v174, v31
    v_mul_f32 v175, v175, v31
    v_mul_f32 v176, v176, v31
    v_mul_f32 v177, v177, v31
    v_mul_f32 v178, v178, v31
    v_mul_f32 v179, v179, v31
    v_mul_f32 v180, v180, v31
    v_mul_f32 v181, v181, v31
    v_mul_f32 v182, v182, v31
    v_mul_f32 v183, v183, v31
    v_mul_f32 v184, v184, v31
    v_mul_f32 v185, v185, v31
    v_mul_f32 v186, v186, v31
    v_mul_f32 v187, v187, v31
    v_mul_f32 v188, v188, v31
    v_mul_f32 v189, v189, v31
    v_mul_f32 v190, v190, v31
    v_mul_f32 v191, v191, v31
    v_mul_f32 v192, v192, v31
    v_mul_f32 v193, v193, v31
    v_mul_f32 v194, v194, v31
    v_mul_f32 v195, v195, v31
    v_mul_f32 v196, v196, v31
    v_mul_f32 v197, v197, v31
    v_mul_f32 v198, v198, v31
    v_mul_f32 v199, v199, v31
    v_mul_f32 v200, v200, v31
    v_mul_f32 v201, v201, v31
    v_mul_f32 v202, v202, v31
    v_mul_f32 v203, v203, v31
    v_mul_f32 v204, v204, v31
    v_mul_f32 v205, v205, v31
    v_mul_f32 v206, v206, v31
    v_mul_f32 v207, v207, v31
    v_sub_f32 v32, v32, v30
    v_sub_f32 v33, v33, v30
    v_exp_f32 v128, v32
    v_exp_f32 v129, v33
    s_nop 0
    v_cvt_pk_bf16_f32 v96, v128, v129
    v_sub_f32 v34, v34, v30
    v_sub_f32 v35, v35, v30
    v_exp_f32 v128, v34
    v_exp_f32 v129, v35
    s_nop 0
    v_cvt_pk_bf16_f32 v97, v128, v129
    v_sub_f32 v36, v36, v30
    v_sub_f32 v37, v37, v30
    v_exp_f32 v128, v36
    v_exp_f32 v129, v37
    s_nop 0
    v_cvt_pk_bf16_f32 v98, v128, v129
    v_sub_f32 v38, v38, v30
    v_sub_f32 v39, v39, v30
    v_exp_f32 v128, v38
    v_exp_f32 v129, v39
    s_nop 0
    v_cvt_pk_bf16_f32 v99, v128, v129
    v_max3_f32 v28, v40, v41, v42
    v_max3_f32 v28, v28, v43, v44
    v_max3_f32 v28, v28, v45, v46
    v_max_f32 v28, v28, v47
    v_mov_b32 v29, v28
    s_nop 1
    v_permlane32_swap_b32 v29, v28
    v_max_f32 v28, v28, v29
    v_mov_b32 v29, v28
    s_nop 1
    v_permlane16_swap_b32 v29, v28
    v_max_f32 v28, v28, v29
    v_max_f32 v30, 0, v28
    v_sub_f32 v17, v17, v30
    v_sub_f32 v31, 0, v30
    v_exp_f32 v31, v31
    s_nop 0
    v_mul_f32 v25, v25, v31
    v_mul_f32 v208, v208, v31
    v_mul_f32 v209, v209, v31
    v_mul_f32 v210, v210, v31
    v_mul_f32 v211, v211, v31
    v_mul_f32 v212, v212, v31
    v_mul_f32 v213, v213, v31
    v_mul_f32 v214, v214, v31
    v_mul_f32 v215, v215, v31
    v_mul_f32 v216, v216, v31
    v_mul_f32 v217, v217, v31
    v_mul_f32 v218, v218, v31
    v_mul_f32 v219, v219, v31
    v_mul_f32 v220, v220, v31
    v_mul_f32 v221, v221, v31
    v_mul_f32 v222, v222, v31
    v_mul_f32 v223, v223, v31
    v_mul_f32 v224, v224, v31
    v_mul_f32 v225, v225, v31
    v_mul_f32 v226, v226, v31
    v_mul_f32 v227, v227, v31
    v_mul_f32 v228, v228, v31
    v_mul_f32 v229, v229, v31
    v_mul_f32 v230, v230, v31
    v_mul_f32 v231, v231, v31
    v_mul_f32 v232, v232, v31
    v_mul_f32 v233, v233, v31
    v_mul_f32 v234, v234, v31
    v_mul_f32 v235, v235, v31
    v_mul_f32 v236, v236, v31
    v_mul_f32 v237, v237, v31
    v_mul_f32 v238, v238, v31
    v_mul_f32 v239, v239, v31
    v_mul_f32 v240, v240, v31
    v_mul_f32 v241, v241, v31
    v_mul_f32 v242, v242, v31
    v_mul_f32 v243, v243, v31
    v_mul_f32 v244, v244, v31
    v_mul_f32 v245, v245, v31
    v_mul_f32 v246, v246, v31
    v_mul_f32 v247, v247, v31
    v_mul_f32 v248, v248, v31
    v_mul_f32 v249, v249, v31
    v_mul_f32 v250, v250, v31
    v_mul_f32 v251, v251, v31
    v_mul_f32 v252, v252, v31
    v_mul_f32 v253, v253, v31
    v_mul_f32 v254, v254, v31
    v_mul_f32 v255, v255, v31
    v_sub_f32 v40, v40, v30
    v_sub_f32 v41, v41, v30
    v_exp_f32 v128, v40
    v_exp_f32 v129, v41
    s_nop 0
    v_cvt_pk_bf16_f32 v100, v128, v129
    v_sub_f32 v42, v42, v30
    v_sub_f32 v43, v43, v30
    v_exp_f32 v128, v42
    v_exp_f32 v129, v43
    s_nop 0
    v_cvt_pk_bf16_f32 v101, v128, v129
    v_sub_f32 v44, v44, v30
    v_sub_f32 v45, v45, v30
    v_exp_f32 v128, v44
    v_exp_f32 v129, v45
    s_nop 0
    v_cvt_pk_bf16_f32 v102, v128, v129
    v_sub_f32 v46, v46, v30
    v_sub_f32 v47, v47, v30
    v_exp_f32 v128, v46
    v_exp_f32 v129, v47
    s_nop 0
    v_cvt_pk_bf16_f32 v103, v128, v129
    v_max3_f32 v28, v48, v49, v50
    v_max3_f32 v28, v28, v51, v52
    v_max3_f32 v28, v28, v53, v54
    v_max_f32 v28, v28, v55
    v_mov_b32 v29, v28
    s_nop 1
    v_permlane32_swap_b32 v29, v28
    v_max_f32 v28, v28, v29
    v_mov_b32 v29, v28
    s_nop 1
    v_permlane16_swap_b32 v29, v28
    v_max_f32 v28, v28, v29
    v_max_f32 v30, 0, v28
    v_sub_f32 v18, v18, v30
    v_sub_f32 v31, 0, v30
    v_exp_f32 v31, v31
    s_nop 0
    v_mul_f32 v26, v26, v31
    v_accvgpr_read_b32 v132, a0
    v_accvgpr_read_b32 v133, a1
    v_accvgpr_read_b32 v134, a2
    v_accvgpr_read_b32 v135, a3
    v_mul_f32 v132, v132, v31
    v_mul_f32 v133, v133, v31
    v_mul_f32 v134, v134, v31
    v_mul_f32 v135, v135, v31
    v_accvgpr_write_b32 a0, v132
    v_accvgpr_write_b32 a1, v133
    v_accvgpr_write_b32 a2, v134
    v_accvgpr_write_b32 a3, v135
    v_accvgpr_read_b32 v132, a4
    v_accvgpr_read_b32 v133, a5
    v_accvgpr_read_b32 v134, a6
    v_accvgpr_read_b32 v135, a7
    v_mul_f32 v132, v132, v31
    v_mul_f32 v133, v133, v31
    v_mul_f32 v134, v134, v31
    v_mul_f32 v135, v135, v31
    v_accvgpr_write_b32 a4, v132
    v_accvgpr_write_b32 a5, v133
    v_accvgpr_write_b32 a6, v134
    v_accvgpr_write_b32 a7, v135
    v_accvgpr_read_b32 v132, a8
    v_accvgpr_read_b32 v133, a9
    v_accvgpr_read_b32 v134, a10
    v_accvgpr_read_b32 v135, a11
    v_mul_f32 v132, v132, v31
    v_mul_f32 v133, v133, v31
    v_mul_f32 v134, v134, v31
    v_mul_f32 v135, v135, v31
    v_accvgpr_write_b32 a8, v132
    v_accvgpr_write_b32 a9, v133
    v_accvgpr_write_b32 a10, v134
    v_accvgpr_write_b32 a11, v135
    v_accvgpr_read_b32 v132, a12
    v_accvgpr_read_b32 v133, a13
    v_accvgpr_read_b32 v134, a14
    v_accvgpr_read_b32 v135, a15
    v_mul_f32 v132, v132, v31
    v_mul_f32 v133, v133, v31
    v_mul_f32 v134, v134, v31
    v_mul_f32 v135, v135, v31
    v_accvgpr_write_b32 a12, v132
    v_accvgpr_write_b32 a13, v133
    v_accvgpr_write_b32 a14, v134
    v_accvgpr_write_b32 a15, v135
    v_accvgpr_read_b32 v132, a16
    v_accvgpr_read_b32 v133, a17
    v_accvgpr_read_b32 v134, a18
    v_accvgpr_read_b32 v135, a19
    v_mul_f32 v132, v132, v31
    v_mul_f32 v133, v133, v31
    v_mul_f32 v134, v134, v31
    v_mul_f32 v135, v135, v31
    v_accvgpr_write_b32 a16, v132
    v_accvgpr_write_b32 a17, v133
    v_accvgpr_write_b32 a18, v134
    v_accvgpr_write_b32 a19, v135
    v_accvgpr_read_b32 v132, a20
    v_accvgpr_read_b32 v133, a21
    v_accvgpr_read_b32 v134, a22
    v_accvgpr_read_b32 v135, a23
    v_mul_f32 v132, v132, v31
    v_mul_f32 v133, v133, v31
    v_mul_f32 v134, v134, v31
    v_mul_f32 v135, v135, v31
    v_accvgpr_write_b32 a20, v132
    v_accvgpr_write_b32 a21, v133
    v_accvgpr_write_b32 a22, v134
    v_accvgpr_write_b32 a23, v135
    v_accvgpr_read_b32 v132, a24
    v_accvgpr_read_b32 v133, a25
    v_accvgpr_read_b32 v134, a26
    v_accvgpr_read_b32 v135, a27
    v_mul_f32 v132, v132, v31
    v_mul_f32 v133, v133, v31
    v_mul_f32 v134, v134, v31
    v_mul_f32 v135, v135, v31
    v_accvgpr_write_b32 a24, v132
    v_accvgpr_write_b32 a25, v133
    v_accvgpr_write_b32 a26, v134
    v_accvgpr_write_b32 a27, v135
    v_accvgpr_read_b32 v132, a28
    v_accvgpr_read_b32 v133, a29
    v_accvgpr_read_b32 v134, a30
    v_accvgpr_read_b32 v135, a31
    v_mul_f32 v132, v132, v31
    v_mul_f32 v133, v133, v31
    v_mul_f32 v134, v134, v31
    v_mul_f32 v135, v135, v31
    v_accvgpr_write_b32 a28, v132
    v_accvgpr_write_b32 a29, v133
    v_accvgpr_write_b32 a30, v134
    v_accvgpr_write_b32 a31, v135
    v_accvgpr_read_b32 v132, a32
    v_accvgpr_read_b32 v133, a33
    v_accvgpr_read_b32 v134, a34
    v_accvgpr_read_b32 v135, a35
    v_mul_f32 v132, v132, v31
    v_mul_f32 v133, v133, v31
    v_mul_f32 v134, v134, v31
    v_mul_f32 v135, v135, v31
    v_accvgpr_write_b32 a32, v132
    v_accvgpr_write_b32 a33, v133
    v_accvgpr_write_b32 a34, v134
    v_accvgpr_write_b32 a35, v135
    v_accvgpr_read_b32 v132, a36
    v_accvgpr_read_b32 v133, a37
    v_accvgpr_read_b32 v134, a38
    v_accvgpr_read_b32 v135, a39
    v_mul_f32 v132, v132, v31
    v_mul_f32 v133, v133, v31
    v_mul_f32 v134, v134, v31
    v_mul_f32 v135, v135, v31
    v_accvgpr_write_b32 a36, v132
    v_accvgpr_write_b32 a37, v133
    v_accvgpr_write_b32 a38, v134
    v_accvgpr_write_b32 a39, v135
    v_accvgpr_read_b32 v132, a40
    v_accvgpr_read_b32 v133, a41
    v_accvgpr_read_b32 v134, a42
    v_accvgpr_read_b32 v135, a43
    v_mul_f32 v132, v132, v31
    v_mul_f32 v133, v133, v31
    v_mul_f32 v134, v134, v31
    v_mul_f32 v135, v135, v31
    v_accvgpr_write_b32 a40, v132
    v_accvgpr_write_b32 a41, v133
    v_accvgpr_write_b32 a42, v134
    v_accvgpr_write_b32 a43, v135
    v_accvgpr_read_b32 v132, a44
    v_accvgpr_read_b32 v133, a45
    v_accvgpr_read_b32 v134, a46
    v_accvgpr_read_b32 v135, a47
    v_mul_f32 v132, v132, v31
    v_mul_f32 v133, v133, v31
    v_mul_f32 v134, v134, v31
    v_mul_f32 v135, v135, v31
    v_accvgpr_write_b32 a44, v132
    v_accvgpr_write_b32 a45, v133
    v_accvgpr_write_b32 a46, v134
    v_accvgpr_write_b32 a47, v135
    v_sub_f32 v48, v48, v30
    v_sub_f32 v49, v49, v30
    v_exp_f32 v128, v48
    v_exp_f32 v129, v49
    s_nop 0
    v_cvt_pk_bf16_f32 v104, v128, v129
    v_sub_f32 v50, v50, v30
    v_sub_f32 v51, v51, v30
    v_exp_f32 v128, v50
    v_exp_f32 v129, v51
    s_nop 0
    v_cvt_pk_bf16_f32 v105, v128, v129
    v_sub_f32 v52, v52, v30
    v_sub_f32 v53, v53, v30
    v_exp_f32 v128, v52
    v_exp_f32 v129, v53
    s_nop 0
    v_cvt_pk_bf16_f32 v106, v128, v129
    v_sub_f32 v54, v54, v30
    v_sub_f32 v55, v55, v30
    v_exp_f32 v128, v54
    v_exp_f32 v129, v55
    s_nop 0
    v_cvt_pk_bf16_f32 v107, v128, v129
    v_mfma_f32_16x16x32_bf16 v[20:23], a[240:243], v[96:99], v[24:27]
    v_mfma_f32_16x16x32_bf16 v[20:23], a[244:247], v[100:103], v[20:23]
    v_mfma_f32_16x16x32_bf16 v[20:23], a[248:251], v[104:107], v[20:23]
    s_nop 15
    s_setpc_b64 s[40:41]
L_rare3_1:
    s_nop 15
    v_max3_f32 v28, v64, v65, v66
    v_max3_f32 v28, v28, v67, v68
    v_max3_f32 v28, v28, v69, v70
    v_max_f32 v28, v28, v71
    v_mov_b32 v29, v28
    s_nop 1
    v_permlane32_swap_b32 v29, v28
    v_max_f32 v28, v28, v29
    v_mov_b32 v29, v28
    s_nop 1
    v_permlane16_swap_b32 v29, v28
    v_max_f32 v28, v28, v29
    v_max_f32 v30, 0, v28
    v_sub_f32 v16, v16, v30
    v_sub_f32 v31, 0, v30
    v_exp_f32 v31, v31
    s_nop 0
    v_mul_f32 v20, v20, v31
    v_cndmask_b32_e64 v20, v20, 0, s[46:47]
    v_mul_f32 v160, v160, v31
    v_mul_f32 v161, v161, v31
    v_mul_f32 v162, v162, v31
    v_mul_f32 v163, v163, v31
    v_mul_f32 v164, v164, v31
    v_mul_f32 v165, v165, v31
    v_mul_f32 v166, v166, v31
    v_mul_f32 v167, v167, v31
    v_mul_f32 v168, v168, v31
    v_mul_f32 v169, v169, v31
    v_mul_f32 v170, v170, v31
    v_mul_f32 v171, v171, v31
    v_mul_f32 v172, v172, v31
    v_mul_f32 v173, v173, v31
    v_mul_f32 v174, v174, v31
    v_mul_f32 v175, v175, v31
    v_mul_f32 v176, v176, v31
    v_mul_f32 v177, v177, v31
    v_mul_f32 v178, v178, v31
    v_mul_f32 v179, v179, v31
    v_mul_f32 v180, v180, v31
    v_mul_f32 v181, v181, v31
    v_mul_f32 v182, v182, v31
    v_mul_f32 v183, v183, v31
    v_mul_f32 v184, v184, v31
    v_mul_f32 v185, v185, v31
    v_mul_f32 v186, v186, v31
    v_mul_f32 v187, v187, v31
    v_mul_f32 v188, v188, v31
    v_mul_f32 v189, v189, v31
    v_mul_f32 v190, v190, v31
    v_mul_f32 v191, v191, v31
    v_mul_f32 v192, v192, v31
    v_mul_f32 v193, v193, v31
    v_mul_f32 v194, v194, v31
    v_mul_f32 v195, v195, v31
    v_mul_f32 v196, v196, v31
    v_mul_f32 v197, v197, v31
    v_mul_f32 v198, v198, v31
    v_mul_f32 v199, v199, v31
    v_mul_f32 v200, v200, v31
    v_mul_f32 v201, v201, v31
    v_mul_f32 v202, v202, v31
    v_mul_f32 v203, v203, v31
    v_mul_f32 v204, v204, v31
    v_mul_f32 v205, v205, v31
    v_mul_f32 v206, v206, v31
    v_mul_f32 v207, v207, v31
    v_sub_f32 v64, v64, v30
    v_sub_f32 v65, v65, v30
    v_exp_f32 v128, v64
    v_exp_f32 v129, v65
    s_nop 0
    v_cvt_pk_bf16_f32 v112, v128, v129
    v_sub_f32 v66, v66, v30
    v_sub_f32 v67, v67, v30
    v_exp_f32 v128, v66
    v_exp_f32 v129, v67
    s_nop 0
    v_cvt_pk_bf16_f32 v113, v128, v129
    v_sub_f32 v68, v68, v30
    v_sub_f32 v69, v69, v30
    v_exp_f32 v128, v68
    v_exp_f32 v129, v69
    s_nop 0
    v_cvt_pk_bf16_f32 v114, v128, v129
    v_sub_f32 v70, v70, v30
    v_sub_f32 v71, v71, v30
    v_exp_f32 v128, v70
    v_exp_f32 v129, v71
    s_nop 0
    v_cvt_pk_bf16_f32 v115, v128, v129
    v_max3_f32 v28, v72, v73, v74
    v_max3_f32 v28, v28, v75, v76
    v_max3_f32 v28, v28, v77, v78
    v_max_f32 v28, v28, v79
    v_mov_b32 v29, v28
    s_nop 1
    v_permlane32_swap_b32 v29, v28
    v_max_f32 v28, v28, v29
    v_mov_b32 v29, v28
    s_nop 1
    v_permlane16_swap_b32 v29, v28
    v_max_f32 v28, v28, v29
    v_max_f32 v30, 0, v28
    v_sub_f32 v17, v17, v30
    v_sub_f32 v31, 0, v30
    v_exp_f32 v31, v31
    s_nop 0
    v_mul_f32 v21, v21, v31
    v_mul_f32 v208, v208, v31
    v_mul_f32 v209, v209, v31
    v_mul_f32 v210, v210, v31
    v_mul_f32 v211, v211, v31
    v_mul_f32 v212, v212, v31
    v_mul_f32 v213, v213, v31
    v_mul_f32 v214, v214, v31
    v_mul_f32 v215, v215, v31
    v_mul_f32 v216, v216, v31
    v_mul_f32 v217, v217, v31
    v_mul_f32 v218, v218, v31
    v_mul_f32 v219, v219, v31
    v_mul_f32 v220, v220, v31
    v_mul_f32 v221, v221, v31
    v_mul_f32 v222, v222, v31
    v_mul_f32 v223, v223, v31
    v_mul_f32 v224, v224, v31
    v_mul_f32 v225, v225, v31
    v_mul_f32 v226, v226, v31
    v_mul_f32 v227, v227, v31
    v_mul_f32 v228, v228, v31
    v_mul_f32 v229, v229, v31
    v_mul_f32 v230, v230, v31
    v_mul_f32 v231, v231, v31
    v_mul_f32 v232, v232, v31
    v_mul_f32 v233, v233, v31
    v_mul_f32 v234, v234, v31
    v_mul_f32 v235, v235, v31
    v_mul_f32 v236, v236, v31
    v_mul_f32 v237, v237, v31
    v_mul_f32 v238, v238, v31
    v_mul_f32 v239, v239, v31
    v_mul_f32 v240, v240, v31
    v_mul_f32 v241, v241, v31
    v_mul_f32 v242, v242, v31
    v_mul_f32 v243, v243, v31
    v_mul_f32 v244, v244, v31
    v_mul_f32 v245, v245, v31
    v_mul_f32 v246, v246, v31
    v_mul_f32 v247, v247, v31
    v_mul_f32 v248, v248, v31
    v_mul_f32 v249, v249, v31
    v_mul_f32 v250, v250, v31
    v_mul_f32 v251, v251, v31
    v_mul_f32 v252, v252, v31
    v_mul_f32 v253, v253, v31
    v_mul_f32 v254, v254, v31
    v_mul_f32 v255, v255, v31
    v_sub_f32 v72, v72, v30
    v_sub_f32 v73, v73, v30
    v_exp_f32 v128, v72
    v_exp_f32 v129, v73
    s_nop 0
    v_cvt_pk_bf16_f32 v116, v128, v129
    v_sub_f32 v74, v74, v30
    v_sub_f32 v75, v75, v30
    v_exp_f32 v128, v74
    v_exp_f32 v129, v75
    s_nop 0
    v_cvt_pk_bf16_f32 v117, v128, v129
    v_sub_f32 v76, v76, v30
    v_sub_f32 v77, v77, v30
    v_exp_f32 v128, v76
    v_exp_f32 v129, v77
    s_nop 0
    v_cvt_pk_bf16_f32 v118, v128, v129
    v_sub_f32 v78, v78, v30
    v_sub_f32 v79, v79, v30
    v_exp_f32 v128, v78
    v_exp_f32 v129, v79
    s_nop 0
    v_cvt_pk_bf16_f32 v119, v128, v129
    v_max3_f32 v28, v80, v81, v82
    v_max3_f32 v28, v28, v83, v84
    v_max3_f32 v28, v28, v85, v86
    v_max_f32 v28, v28, v87
    v_mov_b32 v29, v28
    s_nop 1
    v_permlane32_swap_b32 v29, v28
    v_max_f32 v28, v28, v29
    v_mov_b32 v29, v28
    s_nop 1
    v_permlane16_swap_b32 v29, v28
    v_max_f32 v28, v28, v29
    v_max_f32 v30, 0, v28
    v_sub_f32 v18, v18, v30
    v_sub_f32 v31, 0, v30
    v_exp_f32 v31, v31
    s_nop 0
    v_mul_f32 v22, v22, v31
    v_accvgpr_read_b32 v132, a0
    v_accvgpr_read_b32 v133, a1
    v_accvgpr_read_b32 v134, a2
    v_accvgpr_read_b32 v135, a3
    v_mul_f32 v132, v132, v31
    v_mul_f32 v133, v133, v31
    v_mul_f32 v134, v134, v31
    v_mul_f32 v135, v135, v31
    v_accvgpr_write_b32 a0, v132
    v_accvgpr_write_b32 a1, v133
    v_accvgpr_write_b32 a2, v134
    v_accvgpr_write_b32 a3, v135
    v_accvgpr_read_b32 v132, a4
    v_accvgpr_read_b32 v133, a5
    v_accvgpr_read_b32 v134, a6
    v_accvgpr_read_b32 v135, a7
    v_mul_f32 v132, v132, v31
    v_mul_f32 v133, v133, v31
    v_mul_f32 v134, v134, v31
    v_mul_f32 v135, v135, v31
    v_accvgpr_write_b32 a4, v132
    v_accvgpr_write_b32 a5, v133
    v_accvgpr_write_b32 a6, v134
    v_accvgpr_write_b32 a7, v135
    v_accvgpr_read_b32 v132, a8
    v_accvgpr_read_b32 v133, a9
    v_accvgpr_read_b32 v134, a10
    v_accvgpr_read_b32 v135, a11
    v_mul_f32 v132, v132, v31
    v_mul_f32 v133, v133, v31
    v_mul_f32 v134, v134, v31
    v_mul_f32 v135, v135, v31
    v_accvgpr_write_b32 a8, v132
    v_accvgpr_write_b32 a9, v133
    v_accvgpr_write_b32 a10, v134
    v_accvgpr_write_b32 a11, v135
    v_accvgpr_read_b32 v132, a12
    v_accvgpr_read_b32 v133, a13
    v_accvgpr_read_b32 v134, a14
    v_accvgpr_read_b32 v135, a15
    v_mul_f32 v132, v132, v31
    v_mul_f32 v133, v133, v31
    v_mul_f32 v134, v134, v31
    v_mul_f32 v135, v135, v31
    v_accvgpr_write_b32 a12, v132
    v_accvgpr_write_b32 a13, v133
    v_accvgpr_write_b32 a14, v134
    v_accvgpr_write_b32 a15, v135
    v_accvgpr_read_b32 v132, a16
    v_accvgpr_read_b32 v133, a17
    v_accvgpr_read_b32 v134, a18
    v_accvgpr_read_b32 v135, a19
    v_mul_f32 v132, v132, v31
    v_mul_f32 v133, v133, v31
    v_mul_f32 v134, v134, v31
    v_mul_f32 v135, v135, v31
    v_accvgpr_write_b32 a16, v132
    v_accvgpr_write_b32 a17, v133
    v_accvgpr_write_b32 a18, v134
    v_accvgpr_write_b32 a19, v135
    v_accvgpr_read_b32 v132, a20
    v_accvgpr_read_b32 v133, a21
    v_accvgpr_read_b32 v134, a22
    v_accvgpr_read_b32 v135, a23
    v_mul_f32 v132, v132, v31
    v_mul_f32 v133, v133, v31
    v_mul_f32 v134, v134, v31
    v_mul_f32 v135, v135, v31
    v_accvgpr_write_b32 a20, v132
    v_accvgpr_write_b32 a21, v133
    v_accvgpr_write_b32 a22, v134
    v_accvgpr_write_b32 a23, v135
    v_accvgpr_read_b32 v132, a24
    v_accvgpr_read_b32 v133, a25
    v_accvgpr_read_b32 v134, a26
    v_accvgpr_read_b32 v135, a27
    v_mul_f32 v132, v132, v31
    v_mul_f32 v133, v133, v31
    v_mul_f32 v134, v134, v31
    v_mul_f32 v135, v135, v31
    v_accvgpr_write_b32 a24, v132
    v_accvgpr_write_b32 a25, v133
    v_accvgpr_write_b32 a26, v134
    v_accvgpr_write_b32 a27, v135
    v_accvgpr_read_b32 v132, a28
    v_accvgpr_read_b32 v133, a29
    v_accvgpr_read_b32 v134, a30
    v_accvgpr_read_b32 v135, a31
    v_mul_f32 v132, v132, v31
    v_mul_f32 v133, v133, v31
    v_mul_f32 v134, v134, v31
    v_mul_f32 v135, v135, v31
    v_accvgpr_write_b32 a28, v132
    v_accvgpr_write_b32 a29, v133
    v_accvgpr_write_b32 a30, v134
    v_accvgpr_write_b32 a31, v135
    v_accvgpr_read_b32 v132, a32
    v_accvgpr_read_b32 v133, a33
    v_accvgpr_read_b32 v134, a34
    v_accvgpr_read_b32 v135, a35
    v_mul_f32 v132, v132, v31
    v_mul_f32 v133, v133, v31
    v_mul_f32 v134, v134, v31
    v_mul_f32 v135, v135, v31
    v_accvgpr_write_b32 a32, v132
    v_accvgpr_write_b32 a33, v133
    v_accvgpr_write_b32 a34, v134
    v_accvgpr_write_b32 a35, v135
    v_accvgpr_read_b32 v132, a36
    v_accvgpr_read_b32 v133, a37
    v_accvgpr_read_b32 v134, a38
    v_accvgpr_read_b32 v135, a39
    v_mul_f32 v132, v132, v31
    v_mul_f32 v133, v133, v31
    v_mul_f32 v134, v134, v31
    v_mul_f32 v135, v135, v31
    v_accvgpr_write_b32 a36, v132
    v_accvgpr_write_b32 a37, v133
    v_accvgpr_write_b32 a38, v134
    v_accvgpr_write_b32 a39, v135
    v_accvgpr_read_b32 v132, a40
    v_accvgpr_read_b32 v133, a41
    v_accvgpr_read_b32 v134, a42
    v_accvgpr_read_b32 v135, a43
    v_mul_f32 v132, v132, v31
    v_mul_f32 v133, v133, v31
    v_mul_f32 v134, v134, v31
    v_mul_f32 v135, v135, v31
    v_accvgpr_write_b32 a40, v132
    v_accvgpr_write_b32 a41, v133
    v_accvgpr_write_b32 a42, v134
    v_accvgpr_write_b32 a43, v135
    v_accvgpr_read_b32 v132, a44
    v_accvgpr_read_b32 v133, a45
    v_accvgpr_read_b32 v134, a46
    v_accvgpr_read_b32 v135, a47
    v_mul_f32 v132, v132, v31
    v_mul_f32 v133, v133, v31
    v_mul_f32 v134, v134, v31
    v_mul_f32 v135, v135, v31
    v_accvgpr_write_b32 a44, v132
    v_accvgpr_write_b32 a45, v133
    v_accvgpr_write_b32 a46, v134
    v_accvgpr_write_b32 a47, v135
    v_sub_f32 v80, v80, v30
    v_sub_f32 v81, v81, v30
    v_exp_f32 v128, v80
    v_exp_f32 v129, v81
    s_nop 0
    v_cvt_pk_bf16_f32 v120, v128, v129
    v_sub_f32 v82, v82, v30
    v_sub_f32 v83, v83, v30
    v_exp_f32 v128, v82
    v_exp_f32 v129, v83
    s_nop 0
    v_cvt_pk_bf16_f32 v121, v128, v129
    v_sub_f32 v84, v84, v30
    v_sub_f32 v85, v85, v30
    v_exp_f32 v128, v84
    v_exp_f32 v129, v85
    s_nop 0
    v_cvt_pk_bf16_f32 v122, v128, v129
    v_sub_f32 v86, v86, v30
    v_sub_f32 v87, v87, v30
    v_exp_f32 v128, v86
    v_exp_f32 v129, v87
    s_nop 0
    v_cvt_pk_bf16_f32 v123, v128, v129
    v_mfma_f32_16x16x32_bf16 v[24:27], a[240:243], v[112:115], v[20:23]
    v_mfma_f32_16x16x32_bf16 v[24:27], a[244:247], v[116:119], v[24:27]
    v_mfma_f32_16x16x32_bf16 v[24:27], a[248:251], v[120:123], v[24:27]
    s_nop 15
    s_setpc_b64 s[40:41]
L_rs_start4b:
    s_call_b64 s[40:41], L_rare4_1
    s_branch L_ret_start4b
L_rs_loop4w0a:
    s_call_b64 s[40:41], L_rare4_0
    s_branch L_ret_loop4w0a
L_rs_loop4w0b:
    s_call_b64 s[40:41], L_rare4_1
    s_branch L_ret_loop4w0b
L_rs_loop4w1a:
    s_call_b64 s[40:41], L_rare4_0
    s_branch L_ret_loop4w1a
L_rs_loop4w1b:
    s_call_b64 s[40:41], L_rare4_1
    s_branch L_ret_loop4w1b
L_rs_end4a:
    s_call_b64 s[40:41], L_rare4_0
    s_branch L_ret_end4a
L_rs_end4b:
    s_call_b64 s[40:41], L_rare4_1
    s_branch L_ret_end4b
L_rs_start3b:
    s_call_b64 s[40:41], L_rare3_1
    s_branch L_ret_start3b
L_rs_loop3w0a:
    s_call_b64 s[40:41], L_rare3_0
    s_branch L_ret_loop3w0a
L_rs_loop3w0b:
    s_call_b64 s[40:41], L_rare3_1
    s_branch L_ret_loop3w0b
L_rs_loop3w1a:
    s_call_b64 s[40:41], L_rare3_0
    s_branch L_ret_loop3w1a
L_rs_loop3w1b:
    s_call_b64 s[40:41], L_rare3_1
    s_branch L_ret_loop3w1b
L_rs_end3a:
    s_call_b64 s[40:41], L_rare3_0
    s_branch L_ret_end3a
L_rs_end3b:
    s_call_b64 s[40:41], L_rare3_1
    s_branch L_ret_end3b
L_rs_tr43a:
    s_call_b64 s[40:41], L_rare4_0
    s_branch L_ret_tr43a
L_rs_tr43b:
    s_call_b64 s[40:41], L_rare4_1
    s_branch L_ret_tr43b
L_rs_tr43d:
    s_call_b64 s[40:41], L_rare3_1
    s_branch L_ret_tr43d
L_rs_tr34a:
    s_call_b64 s[40:41], L_rare3_0
    s_branch L_ret_tr34a
L_rs_tr34b:
    s_call_b64 s[40:41], L_rare3_1
    s_branch L_ret_tr34b
L_rs_tr34d:
    s_call_b64 s[40:41], L_rare4_1
    s_branch L_ret_tr34d
L_rs_tr33a:
    s_call_b64 s[40:41], L_rare3_0
    s_branch L_ret_tr33a
L_rs_tr33b:
    s_call_b64 s[40:41], L_rare3_1
    s_branch L_ret_tr33b
L_rs_tr33d:
    s_call_b64 s[40:41], L_rare3_1
    s_branch L_ret_tr33d
L_rs_tr44a:
    s_call_b64 s[40:41], L_rare4_0
    s_branch L_ret_tr44a
L_rs_tr44b:
    s_call_b64 s[40:41], L_rare4_1
    s_branch L_ret_tr44b
L_rs_tr44d:
    s_call_b64 s[40:41], L_rare4_1
    s_branch L_ret_tr44d
.section .rodata,"a"
.p2align 6
.amdhsa_kernel standalone__gqa_softmax__near_ridge_kernel
  .amdhsa_next_free_vgpr 512
  .amdhsa_next_free_sgpr 102
  .amdhsa_accum_offset 256
  .amdhsa_group_segment_fixed_size 0
  .amdhsa_kernarg_size 48
  .amdhsa_user_sgpr_count 2
  .amdhsa_user_sgpr_kernarg_segment_ptr 1
  .amdhsa_system_sgpr_workgroup_id_x 1
.end_amdhsa_kernel
```

```asm
; @launch grid=(256,1,1) block=(256,1,1) lds=163840
.amdgcn_target "amdgcn-amd-amdhsa--gfx950"
.text
.globl standalone__gqa_softmax__near_ridge_kernel
.p2align 8
.type standalone__gqa_softmax__near_ridge_kernel,@function
standalone__gqa_softmax__near_ridge_kernel:
    s_cmp_ge_u32 s2, 256
    s_cbranch_scc1 L_end
    s_load_dwordx4 s[84:87], s[0:1], 0
    s_load_dwordx4 s[88:91], s[0:1], 16
    v_lshrrev_b32 v150, 6, v0
    v_and_b32 v151, 63, v0
    s_getpc_b64 s[60:61]
L_pc:
    s_lshr_b32 s62, s2, 3
    v_lshl_add_u32 v73, s62, 2, v150
    v_min_u32 v72, ((L_codeend-L_pc+16383)/16384)-1, v151
    v_mul_u32_u24 v73, ((L_codeend-L_pc+16383)/16384), v73
    v_add_lshl_u32 v72, v72, v73, 7
    v_min_u32 v72, L_codeend-L_pc-4, v72
    global_load_dword v73, v72, s[60:61]
    v_readfirstlane_b32 s3, v150
    v_lshrrev_b32 v144, 3, v151
    v_mul_u32_u24 v7, 384, v144
    v_lshrrev_b32 v145, 1, v144
    v_lshlrev_b32 v145, 1, v145
    v_and_b32 v146, 7, v151
    v_xor_b32 v145, v145, v146
    v_lshl_add_u32 v7, v145, 4, v7
    s_and_b32 s65, s3, 1
    s_mul_i32 s42, s65, 80
    s_mul_i32 s43, s65, 3072
    v_xor_b32 v6, s42, v7
    v_xor_b32 v7, 80, v6
    v_add_u32 v6, s43, v6
    s_sub_u32 s43, 3072, s43
    v_add_u32 v7, s43, v7
    s_mov_b32 s28, 0x3dd53b95
    s_mov_b32 s29, 0x47800000
    s_mov_b32 s49, 5888
    s_mov_b32 s66, 0x28301800
    s_mov_b32 s46, 0
    s_mov_b32 s47, 0xffff0000
    s_and_b32 s42, s2, 7
    s_lshr_b32 s43, s2, 3
    s_mul_i32 s44, s43, 43
    s_lshr_b32 s44, s44, 7
    s_mul_i32 s45, s44, 3
    s_sub_u32 s36, s43, s45
    s_lshl_b32 s42, s42, 6
    s_lshl_b32 s45, s45, 1
    s_add_u32 s42, s42, s45
    s_mul_i32 s64, s42, 196608
    s_mul_i32 s35, s42, 325632
    s_lshr_b32 s42, s44, 1
    s_mov_b32 s31, 0x6900924
    s_cmp_eq_u32 s42, 1
    s_cselect_b32 s31, 0x14a0489, s31
    s_cmp_eq_u32 s42, 2
    s_cselect_b32 s31, 0x8250258, s31
    s_cmp_eq_u32 s42, 3
    s_cselect_b32 s31, 0x8940912, s31
    s_cmp_eq_u32 s42, 4
    s_cselect_b32 s31, 0x1a10606, s31
    s_and_b32 s42, s44, 1
    s_lshl_b32 s42, s42, 4
    s_lshr_b32 s31, s31, s42
    s_and_b32 s31, s31, 0xffff
    s_cmp_eq_u32 s43, 30
    s_cselect_b32 s31, 0x120648, s31
    s_cmp_eq_u32 s43, 31
    s_cselect_b32 s31, 0x240219, s31
    s_lshr_b32 s63, s31, 16
    s_cmp_ge_u32 s43, 30
    s_cselect_b32 s36, 0, s36
    s_cselect_b32 s42, 4, 6
    s_mul_i32 s42, s42, 196608
    s_add_u32 s6, s64, s42
    s_mov_b32 s10, s6
    s_mul_i32 s22, s3, 3072
    s_mul_i32 s38, s3, 28672
    s_add_u32 s38, s38, 49152
    s_and_b32 s42, s3, 2
    s_mul_i32 s42, s42, 3072
    s_add_u32 s20, s64, s42
    s_mov_b32 s21, s20
    s_mov_b32 s14, 166723584
    s_mov_b32 s18, 0
    s_mov_b32 s67, 0
    s_mov_b32 s37, 0
    s_mov_b32 s60, 0
    s_mov_b32 s61, 0xffff
    s_lshl_b32 s42, s37, 1
    s_lshr_b32 s42, s31, s42
    s_and_b32 s42, s42, 3
    s_add_u32 s42, s42, s36
    s_sub_u32 s43, s42, 3
    s_cmp_ge_u32 s42, 3
    s_cselect_b32 s42, s43, s42
    s_mul_i32 s44, s3, 5
    s_mov_b32 s32, 1
    s_lshl_b32 s43, s3, 2
    s_add_u32 s45, s43, 21
    s_cmp_eq_u32 s3, 0
    s_cselect_b32 s45, 20, s45
    s_cselect_b32 s34, 1, 0
    s_cmp_eq_u32 s42, 1
    s_cselect_b32 s44, s45, s44
    s_cselect_b32 s32, s34, s32
    s_add_u32 s45, s43, 37
    s_cmp_eq_u32 s42, 2
    s_cselect_b32 s44, s45, s44
    s_cselect_b32 s32, 0, s32
    s_mul_i32 s44, s44, 6144
    s_add_u32 s34, s35, s44
    s_waitcnt lgkmcnt(0)
    s_mov_b32 s12, s84
    s_and_b32 s13, s85, 0xffff
    s_mov_b32 s15, 0x20000
    s_mov_b32 s4, s86
    s_and_b32 s5, s87, 0xffff
    s_mov_b32 s7, 0x20000
    s_mov_b32 s8, s88
    s_and_b32 s9, s89, 0xffff
    s_mov_b32 s11, 0x20000
    s_mov_b32 s16, s90
    s_and_b32 s17, s91, 0xffff
    s_mov_b32 s19, 0x20000
    s_cmp_eq_u32 s32, 0
    s_cbranch_scc1 L_start4
L_start5:
    s_add_u32 m0, s22, 0
    s_nop 0
    buffer_load_dwordx4 v6, s[4:7], s20 offen lds
    s_add_u32 s20, s20, 128
    s_add_u32 m0, s22, 1024
    s_nop 0
    buffer_load_dwordx4 v6, s[4:7], s20 offen lds
    s_add_u32 s20, s20, 128
    s_add_u32 m0, s22, 2048
    s_nop 0
    buffer_load_dwordx4 v6, s[4:7], s20 offen lds
    s_add_u32 s20, s20, 12032
    s_add_u32 s48, s34, 0
    s_add_u32 m0, s38, 0
    s_nop 0
    buffer_load_dwordx4 v6, s[12:15], s48 offen nt lds
    s_add_u32 m0, s38, 1024
    s_nop 0
    buffer_load_dwordx4 v7, s[12:15], s48 offen nt lds
    s_add_u32 s48, s34, 128
    s_add_u32 m0, s38, 2048
    s_nop 0
    buffer_load_dwordx4 v6, s[12:15], s48 offen nt lds
    s_add_u32 m0, s38, 3072
    s_nop 0
    buffer_load_dwordx4 v7, s[12:15], s48 offen nt lds
    s_add_u32 s48, s34, 256
    s_add_u32 m0, s38, 4096
    s_nop 0
    buffer_load_dwordx4 v6, s[12:15], s48 offen nt lds
    s_add_u32 m0, s38, 5120
    s_nop 0
    buffer_load_dwordx4 v7, s[12:15], s48 offen nt lds
    s_add_u32 s48, s34, 6144
    s_add_u32 m0, s38, 6144
    s_nop 0
    buffer_load_dwordx4 v6, s[12:15], s48 offen nt lds
    s_add_u32 m0, s38, 7168
    s_nop 0
    buffer_load_dwordx4 v7, s[12:15], s48 offen nt lds
    s_add_u32 s48, s34, 6272
    s_add_u32 m0, s38, 8192
    s_nop 0
    buffer_load_dwordx4 v6, s[12:15], s48 offen nt lds
    s_add_u32 m0, s38, 9216
    s_nop 0
    buffer_load_dwordx4 v7, s[12:15], s48 offen nt lds
    s_add_u32 s48, s34, 6400
    s_add_u32 m0, s38, 10240
    s_nop 0
    buffer_load_dwordx4 v6, s[12:15], s48 offen nt lds
    s_add_u32 m0, s38, 11264
    s_nop 0
    buffer_load_dwordx4 v7, s[12:15], s48 offen nt lds
    v_and_b32 v144, 15, v151
    v_lshrrev_b32 v145, 4, v151
    v_lshrrev_b32 v146, 3, v144
    v_and_b32 v147, 7, v144
    v_lshlrev_b32 v0, 7, v147
    v_bfe_u32 v147, v144, 1, 2
    v_lshlrev_b32 v147, 1, v147
    v_mul_u32_u24 v148, 5, v146
    v_xor_b32 v147, v147, v148
    v_xor_b32 v147, v147, v145
    v_lshl_add_u32 v0, v147, 4, v0
    v_mul_u32_u24 v148, 3072, v146
    v_add_u32 v0, v148, v0
    v_xor_b32 v1, 64, v0
    v_lshrrev_b32 v146, 1, v145
    v_mul_u32_u24 v2, 3072, v146
    v_and_b32 v147, 1, v145
    v_bfe_u32 v148, v151, 2, 2
    v_lshl_add_u32 v144, v147, 2, v148
    v_lshl_add_u32 v2, v144, 7, v2
    v_lshrrev_b32 v144, 1, v144
    v_lshlrev_b32 v144, 1, v144
    v_mul_u32_u24 v146, 5, v146
    v_xor_b32 v144, v144, v146
    v_bfe_u32 v147, v151, 1, 1
    v_xor_b32 v144, v144, v147
    v_lshl_add_u32 v2, v144, 4, v2
    v_and_b32 v147, 1, v151
    v_lshl_add_u32 v2, v147, 3, v2
    v_add_u32 v2, 24576, v2
    v_xor_b32 v3, 32, v2
    v_xor_b32 v4, 64, v2
    v_xor_b32 v5, 96, v2
    v_lshl_add_u32 v8, v151, 4, s38
    v_and_b32 v144, 15, v151
    s_mov_b32 s42, 0x1011
    v_bfe_i32 v145, s42, v144, 1
    v_and_b32 v52, 0x3f803f80, v145
    v_and_b32 v53, 0x3f803f80, v145
    v_and_b32 v54, 0x3f803f80, v145
    v_and_b32 v55, 0x3f803f80, v145
    s_mov_b32 s42, 0x3222
    v_bfe_i32 v145, s42, v144, 1
    v_and_b32 v56, 0x3f803f80, v145
    v_and_b32 v57, 0x3f803f80, v145
    v_and_b32 v58, 0x3f803f80, v145
    v_and_b32 v59, 0x3f803f80, v145
    s_mov_b32 s42, 0x5444
    v_bfe_i32 v145, s42, v144, 1
    v_and_b32 v60, 0x3f803f80, v145
    v_and_b32 v61, 0x3f803f80, v145
    v_and_b32 v62, 0x3f803f80, v145
    v_and_b32 v63, 0x3f803f80, v145
    s_mov_b32 s42, 0x9888
    v_bfe_i32 v145, s42, v144, 1
    v_and_b32 v64, 0x3f803f80, v145
    v_and_b32 v65, 0x3f803f80, v145
    v_and_b32 v66, 0x3f803f80, v145
    v_and_b32 v67, 0x3f803f80, v145
    s_mov_b32 s42, 0x1100
    v_bfe_i32 v145, s42, v144, 1
    v_and_b32 v68, 0x3f803f80, v145
    v_and_b32 v69, 0x3f803f80, v145
    v_and_b32 v70, 0x3f803f80, v145
    v_and_b32 v71, 0x3f803f80, v145
    s_waitcnt vmcnt(12)
    s_barrier
    ds_read_b128 v[112:115], v0 offset:0
    ds_read_b128 v[116:119], v1 offset:0
    ds_read_b128 v[120:123], v0 offset:1024
    ds_read_b128 v[124:127], v1 offset:1024
    ds_read_b128 v[128:131], v0 offset:2048
    ds_read_b128 v[132:135], v1 offset:2048
    s_waitcnt vmcnt(6)
    v_lshrrev_b32 v153, 11, v0
    v_and_b32 v152, 0x3ff, v0
    v_xor_b32 v153, s65, v153
    v_lshl_add_u32 v152, v153, 10, v152
    v_add_u32 v152, s38, v152
    ds_read_b128 a[144:147], v152 offset:0
    s_add_u32 s48, s34, 12288
    s_add_u32 m0, s38, 12288
    v_mbcnt_lo_u32_b32 v155, -1, 0
    v_mbcnt_hi_u32_b32 v155, -1, v155
    v_and_b32 v154, 15, v155
    v_mul_u32_u24 v154, 384, v154
    v_lshrrev_b32 v155, 4, v155
    v_lshl_add_u32 v154, v155, 4, v154
    ds_read_b128 a[152:155], v152 offset:2048
    ds_read_b128 a[160:163], v152 offset:4096
    v_xor_b32 v153, 64, v152
    ds_read_b128 a[148:151], v153 offset:0
    ds_read_b128 a[156:159], v153 offset:2048
    ds_read_b128 a[164:167], v153 offset:4096
    s_waitcnt lgkmcnt(5)
    v_mfma_f32_16x16x32_bf16 v[72:75], v[112:115], a[144:147], 0
    buffer_load_dwordx4 v6, s[12:15], s48 offen nt lds
    ds_read_b128 v[112:115], v0 offset:6144
    s_add_u32 m0, s38, 13312
    s_waitcnt lgkmcnt(3)
    v_mfma_f32_16x16x32_bf16 v[72:75], v[116:119], a[148:151], v[72:75]
    buffer_load_dwordx4 v7, s[12:15], s48 offen nt lds
    ds_read_b128 v[116:119], v1 offset:6144
    s_add_u32 s48, s34, 12416
    s_add_u32 m0, s38, 14336
    v_mfma_f32_16x16x32_bf16 v[72:75], v[120:123], a[152:155], v[72:75]
    buffer_load_dwordx4 v6, s[12:15], s48 offen nt lds
    ds_read_b128 v[120:123], v0 offset:7168
    s_add_u32 m0, s38, 15360
    s_waitcnt lgkmcnt(4)
    v_mfma_f32_16x16x32_bf16 v[72:75], v[124:127], a[156:159], v[72:75]
    buffer_load_dwordx4 v7, s[12:15], s48 offen nt lds
    ds_read_b128 v[124:127], v1 offset:7168
    s_add_u32 s48, s34, 12544
    s_add_u32 m0, s38, 16384
    v_mfma_f32_16x16x32_bf16 v[72:75], v[128:131], a[160:163], v[72:75]
    buffer_load_dwordx4 v6, s[12:15], s48 offen nt lds
    ds_read_b128 v[128:131], v0 offset:8192
    s_add_u32 m0, s38, 17408
    s_waitcnt lgkmcnt(5)
    v_mfma_f32_16x16x32_bf16 v[72:75], v[132:135], a[164:167], v[72:75]
    buffer_load_dwordx4 v7, s[12:15], s48 offen nt lds
    ds_read_b128 v[132:135], v1 offset:8192
    s_add_u32 s48, s34, 18432
    s_add_u32 m0, s38, 18432
    s_waitcnt lgkmcnt(5)
    v_mfma_f32_16x16x32_bf16 v[76:79], v[112:115], a[144:147], 0
    s_waitcnt lgkmcnt(4)
    ds_read_b128 v[112:115], v0 offset:0
    v_mfma_f32_16x16x32_bf16 v[76:79], v[116:119], a[148:151], v[76:79]
    s_waitcnt lgkmcnt(4)
    ds_read_b128 v[116:119], v1 offset:0
    v_mfma_f32_16x16x32_bf16 v[76:79], v[120:123], a[152:155], v[76:79]
    s_waitcnt lgkmcnt(4)
    ds_read_b128 v[120:123], v0 offset:1024
    v_mfma_f32_16x16x32_bf16 v[76:79], v[124:127], a[156:159], v[76:79]
    s_waitcnt lgkmcnt(4)
    ds_read_b128 v[124:127], v1 offset:1024
    v_mfma_f32_16x16x32_bf16 v[76:79], v[128:131], a[160:163], v[76:79]
    s_waitcnt lgkmcnt(4)
    ds_read_b128 v[128:131], v0 offset:2048
    v_mfma_f32_16x16x32_bf16 v[76:79], v[132:135], a[164:167], v[76:79]
    ds_read_b128 v[132:135], v1 offset:2048
    s_waitcnt vmcnt(6)
    ds_read_b128 a[168:171], v152 offset:6144
    ds_read_b128 a[172:175], v153 offset:6144
    ds_read_b128 a[176:179], v152 offset:8192
    ds_read_b128 a[180:183], v153 offset:8192
    ds_read_b128 a[184:187], v152 offset:10240
    ds_read_b128 a[188:191], v153 offset:10240
    s_waitcnt lgkmcnt(5)
    v_mfma_f32_16x16x32_bf16 v[80:83], v[112:115], a[168:171], 0
    buffer_load_dwordx4 v6, s[12:15], s48 offen nt lds
    ds_read_b128 v[112:115], v0 offset:6144
    s_add_u32 m0, s38, 19456
    s_waitcnt lgkmcnt(5)
    v_mfma_f32_16x16x32_bf16 v[80:83], v[116:119], a[172:175], v[80:83]
    buffer_load_dwordx4 v7, s[12:15], s48 offen nt lds
    ds_read_b128 v[116:119], v1 offset:6144
    s_add_u32 s48, s34, 18560
    s_add_u32 m0, s38, 20480
    s_waitcnt lgkmcnt(5)
    v_mfma_f32_16x16x32_bf16 v[80:83], v[120:123], a[176:179], v[80:83]
    buffer_load_dwordx4 v6, s[12:15], s48 offen nt lds
    ds_read_b128 v[120:123], v0 offset:7168
    s_add_u32 m0, s38, 21504
    s_waitcnt lgkmcnt(5)
    v_mfma_f32_16x16x32_bf16 v[80:83], v[124:127], a[180:183], v[80:83]
    buffer_load_dwordx4 v7, s[12:15], s48 offen nt lds
    ds_read_b128 v[124:127], v1 offset:7168
    s_add_u32 s48, s34, 18688
    s_add_u32 m0, s38, 22528
    s_waitcnt lgkmcnt(5)
    v_mfma_f32_16x16x32_bf16 v[80:83], v[128:131], a[184:187], v[80:83]
    buffer_load_dwordx4 v6, s[12:15], s48 offen nt lds
    ds_read_b128 v[128:131], v0 offset:8192
    s_add_u32 m0, s38, 23552
    s_waitcnt lgkmcnt(5)
    v_mfma_f32_16x16x32_bf16 v[80:83], v[132:135], a[188:191], v[80:83]
    buffer_load_dwordx4 v7, s[12:15], s48 offen nt lds
    ds_read_b128 v[132:135], v1 offset:8192
    s_add_u32 s48, s34, 24576
    s_add_u32 m0, s38, 24576
    s_waitcnt lgkmcnt(5)
    v_mfma_f32_16x16x32_bf16 v[84:87], v[112:115], a[168:171], 0
    s_waitcnt lgkmcnt(4)
    ds_read_b128 v[112:115], v0 offset:0
    v_mfma_f32_16x16x32_bf16 v[84:87], v[116:119], a[172:175], v[84:87]
    s_waitcnt lgkmcnt(4)
    ds_read_b128 v[116:119], v1 offset:0
    v_mfma_f32_16x16x32_bf16 v[84:87], v[120:123], a[176:179], v[84:87]
    s_waitcnt lgkmcnt(4)
    ds_read_b128 v[120:123], v0 offset:1024
    v_mfma_f32_16x16x32_bf16 v[84:87], v[124:127], a[180:183], v[84:87]
    s_waitcnt lgkmcnt(4)
    ds_read_b128 v[124:127], v1 offset:1024
    v_mfma_f32_16x16x32_bf16 v[84:87], v[128:131], a[184:187], v[84:87]
    s_waitcnt lgkmcnt(4)
    ds_read_b128 v[128:131], v0 offset:2048
    v_mfma_f32_16x16x32_bf16 v[84:87], v[132:135], a[188:191], v[84:87]
    ds_read_b128 v[132:135], v1 offset:2048
    s_waitcnt vmcnt(6)
    ds_read_b128 a[192:195], v152 offset:12288
    ds_read_b128 a[196:199], v153 offset:12288
    ds_read_b128 a[200:203], v152 offset:14336
    ds_read_b128 a[204:207], v153 offset:14336
    ds_read_b128 a[208:211], v152 offset:16384
    ds_read_b128 a[212:215], v153 offset:16384
    s_waitcnt lgkmcnt(5)
    v_mfma_f32_16x16x32_bf16 v[88:91], v[112:115], a[192:195], 0
    buffer_load_dwordx4 v6, s[12:15], s48 offen nt lds
    ds_read_b128 v[112:115], v0 offset:6144
    s_add_u32 m0, s38, 25600
    s_waitcnt lgkmcnt(5)
    v_mfma_f32_16x16x32_bf16 v[88:91], v[116:119], a[196:199], v[88:91]
    buffer_load_dwordx4 v7, s[12:15], s48 offen nt lds
    ds_read_b128 v[116:119], v1 offset:6144
    s_add_u32 s48, s34, 24704
    s_add_u32 m0, s38, 26624
    s_waitcnt lgkmcnt(5)
    v_mfma_f32_16x16x32_bf16 v[88:91], v[120:123], a[200:203], v[88:91]
    buffer_load_dwordx4 v6, s[12:15], s48 offen nt lds
    ds_read_b128 v[120:123], v0 offset:7168
    s_add_u32 m0, s38, 27648
    s_waitcnt lgkmcnt(5)
    v_mfma_f32_16x16x32_bf16 v[88:91], v[124:127], a[204:207], v[88:91]
    buffer_load_dwordx4 v7, s[12:15], s48 offen nt lds
    ds_read_b128 v[124:127], v1 offset:7168
    s_add_u32 s48, s34, 24576
    s_waitcnt lgkmcnt(5)
    v_mfma_f32_16x16x32_bf16 v[88:91], v[128:131], a[208:211], v[88:91]
    buffer_load_dwordx4 v[136:139], v154, s[12:15], s48 offen offset:256 nt
    ds_read_b128 v[128:131], v0 offset:8192
    s_waitcnt lgkmcnt(5)
    v_mfma_f32_16x16x32_bf16 v[88:91], v[132:135], a[212:215], v[88:91]
    buffer_load_dwordx4 v[140:143], v154, s[12:15], s48 offen offset:320 nt
    ds_read_b128 v[132:135], v1 offset:8192
    s_add_u32 m0, s22, 12288
    s_waitcnt lgkmcnt(5)
    v_mfma_f32_16x16x32_bf16 v[92:95], v[112:115], a[192:195], 0
    s_waitcnt lgkmcnt(4)
    ds_read_b128 v[112:115], v0 offset:0
    v_mfma_f32_16x16x32_bf16 v[92:95], v[116:119], a[196:199], v[92:95]
    s_waitcnt lgkmcnt(4)
    ds_read_b128 v[116:119], v1 offset:0
    v_mfma_f32_16x16x32_bf16 v[92:95], v[120:123], a[200:203], v[92:95]
    s_waitcnt lgkmcnt(4)
    ds_read_b128 v[120:123], v0 offset:1024
    v_mfma_f32_16x16x32_bf16 v[92:95], v[124:127], a[204:207], v[92:95]
    s_waitcnt lgkmcnt(4)
    ds_read_b128 v[124:127], v1 offset:1024
    v_mfma_f32_16x16x32_bf16 v[92:95], v[128:131], a[208:211], v[92:95]
    s_waitcnt lgkmcnt(4)
    ds_read_b128 v[128:131], v0 offset:2048
    v_mfma_f32_16x16x32_bf16 v[92:95], v[132:135], a[212:215], v[92:95]
    ds_read_b128 v[132:135], v1 offset:2048
    s_waitcnt vmcnt(6)
    ds_read_b128 a[216:219], v152 offset:18432
    ds_read_b128 a[220:223], v153 offset:18432
    ds_read_b128 a[224:227], v152 offset:20480
    ds_read_b128 a[228:231], v153 offset:20480
    ds_read_b128 a[232:235], v152 offset:22528
    ds_read_b128 a[236:239], v153 offset:22528
    s_waitcnt lgkmcnt(5)
    v_mfma_f32_16x16x32_bf16 v[96:99], v[112:115], a[216:219], 0
    buffer_load_dwordx4 v6, s[4:7], s20 offen lds
    ds_read_b128 v[112:115], v0 offset:6144
    s_add_u32 s20, s20, 128
    s_add_u32 m0, s22, 13312
    s_waitcnt lgkmcnt(5)
    v_mfma_f32_16x16x32_bf16 v[96:99], v[116:119], a[220:223], v[96:99]
    buffer_load_dwordx4 v6, s[4:7], s20 offen lds
    ds_read_b128 v[116:119], v1 offset:6144
    s_add_u32 s20, s20, 128
    s_add_u32 m0, s22, 14336
    s_waitcnt lgkmcnt(5)
    v_mfma_f32_16x16x32_bf16 v[96:99], v[120:123], a[224:227], v[96:99]
    buffer_load_dwordx4 v6, s[4:7], s20 offen lds
    ds_read_b128 v[120:123], v0 offset:7168
    s_add_u32 s20, s20, 12032
    s_add_u32 m0, s22, 24576
    s_waitcnt lgkmcnt(5)
    v_mfma_f32_16x16x32_bf16 v[96:99], v[124:127], a[228:231], v[96:99]
    s_waitcnt lgkmcnt(4)
    ds_read_b128 v[124:127], v1 offset:7168
    v_mfma_f32_16x16x32_bf16 v[96:99], v[128:131], a[232:235], v[96:99]
    s_waitcnt lgkmcnt(4)
    ds_read_b128 v[128:131], v0 offset:8192
    v_mfma_f32_16x16x32_bf16 v[96:99], v[132:135], a[236:239], v[96:99]
    s_waitcnt lgkmcnt(4)
    ds_read_b128 v[132:135], v1 offset:8192
    v_mfma_f32_16x16x32_bf16 v[100:103], v[112:115], a[216:219], 0
    s_waitcnt lgkmcnt(4)
    ds_read_b128 v[112:115], v0 offset:0
    v_mfma_f32_16x16x32_bf16 v[100:103], v[116:119], a[220:223], v[100:103]
    s_waitcnt lgkmcnt(4)
    ds_read_b128 v[116:119], v1 offset:0
    v_mfma_f32_16x16x32_bf16 v[100:103], v[120:123], a[224:227], v[100:103]
    s_waitcnt lgkmcnt(4)
    ds_read_b128 v[120:123], v0 offset:1024
    v_mfma_f32_16x16x32_bf16 v[100:103], v[124:127], a[228:231], v[100:103]
    s_waitcnt lgkmcnt(4)
    ds_read_b128 v[124:127], v1 offset:1024
    v_mfma_f32_16x16x32_bf16 v[100:103], v[128:131], a[232:235], v[100:103]
    s_waitcnt lgkmcnt(4)
    ds_read_b128 v[128:131], v0 offset:2048
    v_mfma_f32_16x16x32_bf16 v[100:103], v[132:135], a[236:239], v[100:103]
    ds_read_b128 v[132:135], v1 offset:2048
    s_waitcnt vmcnt(3)
    ds_read_b128 a[240:243], v152 offset:24576
    ds_read_b128 a[244:247], v153 offset:24576
    ds_read_b128 a[248:251], v152 offset:26624
    ds_read_b128 a[252:255], v153 offset:26624
    s_waitcnt lgkmcnt(3)
    v_mfma_f32_16x16x32_bf16 v[104:107], v[112:115], a[240:243], 0
    buffer_load_dwordx4 v6, s[8:11], s21 offen lds
    ds_read_b128 v[112:115], v0 offset:6144
    s_add_u32 s21, s21, 128
    s_add_u32 m0, s22, 25600
    s_waitcnt lgkmcnt(3)
    v_mfma_f32_16x16x32_bf16 v[104:107], v[116:119], a[244:247], v[104:107]
    buffer_load_dwordx4 v6, s[8:11], s21 offen lds
    ds_read_b128 v[116:119], v1 offset:6144
    s_add_u32 s21, s21, 128
    s_add_u32 m0, s22, 26624
    s_waitcnt lgkmcnt(3)
    v_mfma_f32_16x16x32_bf16 v[104:107], v[120:123], a[248:251], v[104:107]
    buffer_load_dwordx4 v6, s[8:11], s21 offen lds
    ds_read_b128 v[120:123], v0 offset:7168
    s_add_u32 s21, s21, 12032
    s_add_u32 m0, s22, 36864
    s_waitcnt lgkmcnt(3)
    v_mfma_f32_16x16x32_bf16 v[104:107], v[124:127], a[252:255], v[104:107]
    buffer_load_dwordx4 v6, s[8:11], s21 offen lds
    ds_read_b128 v[124:127], v1 offset:7168
    s_add_u32 s21, s21, 128
    s_add_u32 m0, s22, 37888
    v_mfma_f32_16x16x32_bf16 v[104:107], v[128:131], v[136:139], v[104:107]
    buffer_load_dwordx4 v6, s[8:11], s21 offen lds
    ds_read_b128 v[128:131], v0 offset:8192
    s_add_u32 s21, s21, 128
    s_add_u32 m0, s22, 38912
    v_mfma_f32_16x16x32_bf16 v[104:107], v[132:135], v[140:143], v[104:107]
    buffer_load_dwordx4 v6, s[8:11], s21 offen lds
    ds_read_b128 v[132:135], v1 offset:8192
    s_add_u32 s21, s21, 12032
    s_waitcnt lgkmcnt(5)
    v_mfma_f32_16x16x32_bf16 v[108:111], v[112:115], a[240:243], 0
    s_waitcnt lgkmcnt(4)
    v_mfma_f32_16x16x32_bf16 v[108:111], v[116:119], a[244:247], v[108:111]
    s_waitcnt lgkmcnt(3)
    v_mfma_f32_16x16x32_bf16 v[108:111], v[120:123], a[248:251], v[108:111]
    s_waitcnt lgkmcnt(2)
    v_mfma_f32_16x16x32_bf16 v[108:111], v[124:127], a[252:255], v[108:111]
    s_waitcnt lgkmcnt(1)
    v_mfma_f32_16x16x32_bf16 v[108:111], v[128:131], v[136:139], v[108:111]
    s_waitcnt lgkmcnt(0)
    v_mfma_f32_16x16x32_bf16 v[108:111], v[132:135], v[140:143], v[108:111]
    s_waitcnt vmcnt(6)
    s_barrier
    s_add_u32 m0, s22, 0
    ds_read_b128 v[116:119], v1 offset:12288
    buffer_load_dwordx4 v6, s[4:7], s20 offen lds
    ds_read_b128 v[120:123], v0 offset:13312
    ds_read_b128 v[112:115], v0 offset:12288
    v_max3_f32 v146, v80, v81, v82
    v_max3_f32 v146, v146, v83, v84
    v_max3_f32 v146, v146, v85, v86
    v_max3_f32 v144, v72, v73, v74
    v_max3_f32 v144, v144, v75, v76
    v_max3_f32 v144, v144, v77, v78
    v_max_f32 v144, v144, v79
    v_mov_b32 v145, v144
    v_max_f32 v146, v146, v87
    v_mov_b32 v147, v146
    v_permlane32_swap_b32 v145, v144
    v_max_f32 v144, v144, v145
    v_mov_b32 v145, v144
    v_permlane32_swap_b32 v147, v146
    v_max_f32 v146, v146, v147
    v_permlane16_swap_b32 v145, v144
    v_max_f32 v144, v144, v145
    v_mov_b32 v147, v146
    v_mul_f32_e64 v9, -s28, v144
    v_max3_f32 v144, v88, v89, v90
    v_permlane16_swap_b32 v147, v146
    v_max3_f32 v144, v144, v91, v92
    v_max3_f32 v144, v144, v93, v94
    v_max_f32 v146, v146, v147
    v_mul_f32_e64 v10, -s28, v146
    v_max_f32 v144, v144, v95
    v_mov_b32 v145, v144
    v_max3_f32 v146, v96, v97, v98
    v_fma_f32 v78, v78, s28, v9
    v_permlane32_swap_b32 v145, v144
    v_max_f32 v144, v144, v145
    v_fma_f32 v74, v74, s28, v9
    v_max3_f32 v146, v146, v99, v100
    v_mov_b32 v145, v144
    v_exp_f32 v74, v74
    v_fma_f32 v81, v81, s28, v10
    v_permlane16_swap_b32 v145, v144
    v_max3_f32 v146, v146, v101, v102
    v_max_f32 v144, v144, v145
    v_mul_f32_e64 v11, -s28, v144
    v_max3_f32 v144, v104, v105, v106
    v_fma_f32 v83, v83, s28, v10
    v_fma_f32 v90, v90, s28, v11
    v_max3_f32 v144, v144, v107, v108
    v_fma_f32 v84, v84, s28, v10
    v_fma_f32 v73, v73, s28, v9
    v_fma_f32 v91, v91, s28, v11
    v_max_f32 v146, v146, v103
    v_fma_f32 v82, v82, s28, v10
    v_fma_f32 v72, v72, s28, v9
    v_exp_f32 v82, v82
    v_exp_f32 v91, v91
    v_fma_f32 v75, v75, s28, v9
    v_max3_f32 v144, v144, v109, v110
    v_mov_b32 v147, v146
    v_exp_f32 v81, v81
    v_exp_f32 v73, v73
    v_fma_f32 v80, v80, s28, v10
    v_fma_f32 v89, v89, s28, v11
    v_permlane32_swap_b32 v147, v146
    v_max_f32 v146, v146, v147
    v_fma_f32 v86, v86, s28, v10
    v_max_f32 v144, v144, v111
    v_exp_f32 v83, v83
    v_exp_f32 v80, v80
    v_fma_f32 v77, v77, s28, v9
    v_mov_b32 v145, v144
    v_mov_b32 v147, v146
    v_exp_f32 v90, v90
    v_fma_f32 v95, v95, s28, v11
    v_exp_f32 v75, v75
    v_permlane32_swap_b32 v145, v144
    v_exp_f32 v72, v72
    v_permlane16_swap_b32 v147, v146
    v_cvt_pk_bf16_f32 v14, v72, v73
    v_fma_f32 v85, v85, s28, v10
    v_max_f32 v144, v144, v145
    v_cvt_pk_bf16_f32 v15, v74, v75
    v_max_f32 v146, v146, v147
    v_mov_b32 v145, v144
    v_fma_f32 v87, v87, s28, v10
    v_mul_f32_e64 v12, -s28, v146
    v_fma_f32 v97, v97, s28, v12
    s_waitcnt lgkmcnt(0)
    v_mfma_f32_16x16x32_bf16 v[72:75], v[112:115], a[144:147], 0
    s_add_u32 s20, s20, 128
    ds_read_b128 v[128:131], v0 offset:14336
    v_fma_f32 v88, v88, s28, v11
    v_permlane16_swap_b32 v145, v144
    v_fma_f32 v98, v98, s28, v12
    v_fma_f32 v96, v96, s28, v12
    v_fma_f32 v79, v79, s28, v9
    v_fma_f32 v99, v99, s28, v12
    v_max_f32 v144, v144, v145
    v_mul_f32_e64 v13, -s28, v144
    v_fma_f32 v105, v105, s28, v13
    v_cvt_pk_bf16_f32 v20, v80, v81
    v_exp_f32 v97, v97
    v_exp_f32 v96, v96
    v_mfma_f32_16x16x32_bf16 v[72:75], v[116:119], a[148:151], v[72:75]
    v_fma_f32 v104, v104, s28, v13
    v_fma_f32 v107, v107, s28, v13
    v_cvt_pk_bf16_f32 v21, v82, v83
    v_exp_f32 v89, v89
    v_exp_f32 v88, v88
    v_exp_f32 v98, v98
    v_mfma_f32_16x16x32_bf16 v[72:75], v[120:123], a[152:155], v[72:75]
    s_add_u32 m0, s22, 1024
    v_exp_f32 v107, v107
    v_mfma_f32_16x16x32_bf16 v[80:83], v[112:115], a[168:171], 0
    buffer_load_dwordx4 v6, s[4:7], s20 offen lds
    v_fma_f32 v103, v103, s28, v12
    v_exp_f32 v99, v99
    v_exp_f32 v104, v104
    v_mfma_f32_16x16x32_bf16 v[80:83], v[116:119], a[172:175], v[80:83]
    ds_read_b128 v[132:135], v1 offset:14336
    v_cvt_pk_bf16_f32 v27, v90, v91
    v_cvt_pk_bf16_f32 v26, v88, v89
    v_mfma_f32_16x16x32_bf16 v[80:83], v[120:123], a[176:179], v[80:83]
    ds_read_b128 v[124:127], v1 offset:13312
    v_fma_f32 v93, v93, s28, v11
    v_mfma_f32_16x16x32_bf16 v[88:91], v[112:115], a[192:195], 0
    s_add_u32 s20, s20, 128
    v_fma_f32 v111, v111, s28, v13
    v_fma_f32 v106, v106, s28, v13
    v_cvt_pk_bf16_f32 v33, v98, v99
    v_mfma_f32_16x16x32_bf16 v[88:91], v[116:119], a[196:199], v[88:91]
    s_add_u32 m0, s22, 2048
    v_fma_f32 v94, v94, s28, v11
    v_cvt_pk_bf16_f32 v32, v96, v97
    v_mfma_f32_16x16x32_bf16 v[88:91], v[120:123], a[200:203], v[88:91]
    buffer_load_dwordx4 v6, s[4:7], s20 offen lds
    v_mfma_f32_16x16x32_bf16 v[96:99], v[112:115], a[216:219], 0
    s_add_u32 s20, s20, 12032
    v_exp_f32 v106, v106
    v_mfma_f32_16x16x32_bf16 v[96:99], v[116:119], a[220:223], v[96:99]
    v_exp_f32 v105, v105
    v_cvt_pk_bf16_f32 v39, v106, v107
    v_mfma_f32_16x16x32_bf16 v[96:99], v[120:123], a[224:227], v[96:99]
    s_mov_b32 s39, s64
    v_fma_f32 v92, v92, s28, v11
    v_cvt_pk_bf16_f32 v38, v104, v105
    v_exp_f32 v78, v78
    v_mfma_f32_16x16x32_bf16 v[104:107], v[112:115], a[240:243], 0
    s_add_u32 s37, s37, 1
    v_exp_f32 v77, v77
    v_mfma_f32_16x16x32_bf16 v[104:107], v[116:119], a[244:247], v[104:107]
    s_bitcmp1_b32 s63, s37
    ds_read_b128 v[112:115], v0 offset:18432
    v_fma_f32 v76, v76, s28, v9
    v_mfma_f32_16x16x32_bf16 v[104:107], v[120:123], a[248:251], v[104:107]
    s_waitcnt lgkmcnt(1)
    v_exp_f32 v93, v93
    v_mfma_f32_16x16x32_bf16 v[72:75], v[124:127], a[156:159], v[72:75]
    s_cselect_b32 s62, 4294770688, 0
    v_exp_f32 v86, v86
    v_mfma_f32_16x16x32_bf16 v[72:75], v[128:131], a[160:163], v[72:75]
    s_cselect_b32 s42, 0, 325632
    v_exp_f32 v79, v79
    v_mfma_f32_16x16x32_bf16 v[72:75], v[132:135], a[164:167], v[72:75]
    s_add_u32 s35, s35, s42
    ds_read_b128 v[120:123], v0 offset:19456
    v_exp_f32 v85, v85
    v_mfma_f32_16x16x32_bf16 v[80:83], v[124:127], a[180:183], v[80:83]
    s_lshl_b32 s42, s37, 1
    ds_read_b128 v[116:119], v1 offset:18432
    v_fma_f32 v108, v108, s28, v13
    v_mfma_f32_16x16x32_bf16 v[80:83], v[128:131], a[184:187], v[80:83]
    v_exp_f32 v84, v84
    v_mfma_f32_16x16x32_bf16 v[80:83], v[132:135], a[188:191], v[80:83]
    v_exp_f32 v76, v76
    v_mfma_f32_16x16x32_bf16 v[88:91], v[124:127], a[204:207], v[88:91]
    s_lshr_b32 s42, s31, s42
    v_cvt_pk_bf16_f32 v16, v76, v77
    v_exp_f32 v111, v111
    v_mfma_f32_16x16x32_bf16 v[88:91], v[128:131], a[208:211], v[88:91]
    s_and_b32 s42, s42, 3
    v_exp_f32 v103, v103
    v_mfma_f32_16x16x32_bf16 v[88:91], v[132:135], a[212:215], v[88:91]
    s_add_u32 s42, s42, s36
    v_fma_f32 v110, v110, s28, v13
    v_fma_f32 v73, v73, s28, v9
    v_mfma_f32_16x16x32_bf16 v[96:99], v[124:127], a[228:231], v[96:99]
    s_sub_u32 s43, s42, 3
    v_cvt_pk_bf16_f32 v17, v78, v79
    v_fma_f32 v102, v102, s28, v12
    v_mfma_f32_16x16x32_bf16 v[96:99], v[128:131], a[232:235], v[96:99]
    s_cmp_ge_u32 s42, 3
    v_exp_f32 v108, v108
    v_fma_f32 v101, v101, s28, v12
    v_mfma_f32_16x16x32_bf16 v[96:99], v[132:135], a[236:239], v[96:99]
    s_cselect_b32 s42, s43, s42
    v_exp_f32 v87, v87
    v_mfma_f32_16x16x32_bf16 v[44:47], v[52:55], v[14:17], 0
    s_mul_i32 s44, s3, 5
    v_exp_f32 v94, v94
    v_mfma_f32_16x16x32_bf16 v[104:107], v[124:127], a[252:255], v[104:107]
    s_mov_b32 s32, 1
    v_cvt_pk_bf16_f32 v22, v84, v85
    v_exp_f32 v92, v92
    v_mfma_f32_16x16x32_bf16 v[104:107], v[128:131], v[136:139], v[104:107]
    s_lshl_b32 s43, s3, 2
    v_cvt_pk_bf16_f32 v23, v86, v87
    v_cvt_pk_bf16_f32 v28, v92, v93
    v_mfma_f32_16x16x32_bf16 v[104:107], v[132:135], v[140:143], v[104:107]
    s_add_u32 s45, s43, 21
    s_cmp_eq_u32 s3, 0
    v_fma_f32 v81, v81, s28, v10
    v_mfma_f32_16x16x32_bf16 v[44:47], v[56:59], v[20:23], v[44:47]
    s_waitcnt lgkmcnt(0)
    v_exp_f32 v95, v95
    v_mfma_f32_16x16x32_bf16 v[76:79], v[112:115], a[144:147], 0
    s_cselect_b32 s45, 20, s45
    s_cselect_b32 s33, 1, 0
    ds_read_b128 v[128:131], v0 offset:20480
    v_mfma_f32_16x16x32_bf16 v[76:79], v[116:119], a[148:151], v[76:79]
    s_cmp_eq_u32 s42, 1
    ds_read_b128 v[124:127], v1 offset:19456
    v_fma_f32 v80, v80, s28, v10
    v_mfma_f32_16x16x32_bf16 v[76:79], v[120:123], a[152:155], v[76:79]
    s_cselect_b32 s44, s45, s44
    v_fma_f32 v100, v100, s28, v12
    v_exp_f32 v102, v102
    v_mfma_f32_16x16x32_bf16 v[84:87], v[112:115], a[168:171], 0
    s_cselect_b32 s32, s33, s32
    ds_read_b128 v[132:135], v1 offset:20480
    v_cvt_pk_bf16_f32 v29, v94, v95
    v_mfma_f32_16x16x32_bf16 v[84:87], v[116:119], a[172:175], v[84:87]
    s_add_u32 s45, s43, 37
    v_exp_f32 v100, v100
    v_mfma_f32_16x16x32_bf16 v[84:87], v[120:123], a[176:179], v[84:87]
    s_cmp_eq_u32 s42, 2
    v_fma_f32 v83, v83, s28, v10
    v_fma_f32 v109, v109, s28, v13
    v_mfma_f32_16x16x32_bf16 v[92:95], v[112:115], a[192:195], 0
    s_cselect_b32 s44, s45, s44
    v_exp_f32 v110, v110
    v_mfma_f32_16x16x32_bf16 v[92:95], v[116:119], a[196:199], v[92:95]
    s_cselect_b32 s32, 0, s32
    v_exp_f32 v101, v101
    v_mfma_f32_16x16x32_bf16 v[92:95], v[120:123], a[200:203], v[92:95]
    s_mul_i32 s44, s44, 6144
    v_cvt_pk_bf16_f32 v34, v100, v101
    v_fma_f32 v75, v75, s28, v9
    v_mfma_f32_16x16x32_bf16 v[44:47], v[60:63], v[26:29], v[44:47]
    s_add_u32 s33, s35, s44
    v_cvt_pk_bf16_f32 v35, v102, v103
    v_fma_f32 v72, v72, s28, v9
    v_mfma_f32_16x16x32_bf16 v[100:103], v[112:115], a[216:219], 0
    s_mul_i32 s42, s32, 6144
    v_exp_f32 v109, v109
    v_mfma_f32_16x16x32_bf16 v[100:103], v[116:119], a[220:223], v[100:103]
    s_add_u32 s42, s42, 24576
    v_fma_f32 v74, v74, s28, v9
    v_cvt_pk_bf16_f32 v40, v108, v109
    v_mfma_f32_16x16x32_bf16 v[100:103], v[120:123], a[224:227], v[100:103]
    s_add_u32 s42, s42, s33
    v_cvt_pk_bf16_f32 v41, v110, v111
    v_fma_f32 v82, v82, s28, v10
    v_mfma_f32_16x16x32_bf16 v[108:111], v[112:115], a[240:243], 0
    s_cmp_ge_u32 s37, 6
    v_exp_f32 v80, v80
    v_mfma_f32_16x16x32_bf16 v[108:111], v[116:119], a[244:247], v[108:111]
    s_cselect_b32 s14, 0, s42
    v_exp_f32 v83, v83
    v_mfma_f32_16x16x32_bf16 v[108:111], v[120:123], a[248:251], v[108:111]
    s_waitcnt lgkmcnt(0)
    v_exp_f32 v73, v73
    v_mfma_f32_16x16x32_bf16 v[76:79], v[124:127], a[156:159], v[76:79]
    s_add_u32 s24, s67, 256
    v_exp_f32 v82, v82
    v_mfma_f32_16x16x32_bf16 v[76:79], v[128:131], a[160:163], v[76:79]
    s_add_u32 s25, s33, 256
    v_exp_f32 v74, v74
    s_add_u32 s23, s38, 4096
    v_mfma_f32_16x16x32_bf16 v[76:79], v[132:135], a[164:167], v[76:79]
    s_mov_b32 s27, 0x49249249
    v_exp_f32 v81, v81
    v_mfma_f32_16x16x32_bf16 v[84:87], v[124:127], a[180:183], v[84:87]
    s_mov_b32 s30, 0
    v_exp_f32 v75, v75
    v_mfma_f32_16x16x32_bf16 v[84:87], v[128:131], a[184:187], v[84:87]
    s_waitcnt vmcnt(6)
    v_exp_f32 v72, v72
    v_mfma_f32_16x16x32_bf16 v[84:87], v[132:135], a[188:191], v[84:87]
    s_barrier
    v_mfma_f32_16x16x32_bf16 v[92:95], v[124:127], a[204:207], v[92:95]
    ds_read_b64_tr_b16 v[112:113], v2 offset:0
    v_cvt_pk_bf16_f32 v18, v72, v73
    v_mfma_f32_16x16x32_bf16 v[92:95], v[128:131], a[208:211], v[92:95]
    s_add_u32 m0, s22, 12288
    ds_read_b64_tr_b16 v[114:115], v2 offset:6144
    v_mfma_f32_16x16x32_bf16 v[92:95], v[132:135], a[212:215], v[92:95]
    buffer_load_dwordx4 v6, s[4:7], s20 offen lds
    v_mfma_f32_16x16x32_bf16 v[100:103], v[124:127], a[228:231], v[100:103]
    ds_read_b64_tr_b16 v[116:117], v3 offset:0
    v_cvt_pk_bf16_f32 v19, v74, v75
    v_mfma_f32_16x16x32_bf16 v[100:103], v[128:131], a[232:235], v[100:103]
    s_add_u32 s20, s20, 128
    ds_read_b64_tr_b16 v[118:119], v3 offset:6144
    s_add_u32 m0, s22, 13312
    v_mfma_f32_16x16x32_bf16 v[44:47], v[64:67], v[32:35], v[44:47]
    ds_read_b64_tr_b16 v[120:121], v4 offset:0
    v_mfma_f32_16x16x32_bf16 v[100:103], v[132:135], a[236:239], v[100:103]
    ds_read_b64_tr_b16 v[122:123], v4 offset:6144
    v_mfma_f32_16x16x32_bf16 v[108:111], v[124:127], a[252:255], v[108:111]
    buffer_load_dwordx4 v6, s[4:7], s20 offen lds
    v_mfma_f32_16x16x32_bf16 v[108:111], v[128:131], v[136:139], v[108:111]
    s_add_u32 s20, s20, 128
    s_add_u32 m0, s22, 14336
    ds_read_b64_tr_b16 v[124:125], v5 offset:0
    v_mfma_f32_16x16x32_bf16 v[108:111], v[132:135], v[140:143], v[108:111]
    ds_read_b64_tr_b16 v[126:127], v5 offset:6144
    buffer_load_dwordx4 v6, s[4:7], s20 offen lds
    v_mfma_f32_16x16x32_bf16 v[44:47], v[68:71], v[38:41], v[44:47]
    s_add_u32 s20, s20, 12032
    v_cvt_pk_bf16_f32 v24, v80, v81
    v_cvt_pk_bf16_f32 v25, v82, v83
    s_waitcnt lgkmcnt(6)
    v_mfma_f32_16x16x32_bf16 v[160:163], v[112:115], v[14:17], 0
    ds_read_b64_tr_b16 v[130:131], v2 offset:7168
    v_mfma_f32_16x16x32_bf16 v[208:211], v[112:115], v[20:23], 0
    ds_read_b64_tr_b16 v[134:135], v3 offset:7168
    v_mfma_f32_16x16x32_bf16 a[0:3], v[112:115], v[26:29], 0
    ds_read_b64_tr_b16 v[132:133], v3 offset:1024
    v_fma_f32 v90, v90, s28, v11
    v_mfma_f32_16x16x32_bf16 a[48:51], v[112:115], v[32:35], 0
    v_fma_f32 v76, v76, s28, v9
    v_fma_f32 v96, v96, s28, v12
    v_mfma_f32_16x16x32_bf16 a[96:99], v[112:115], v[38:41], 0
    ds_read_b64_tr_b16 v[114:115], v4 offset:7168
    s_waitcnt lgkmcnt(8)
    v_mfma_f32_16x16x32_bf16 v[164:167], v[116:119], v[14:17], 0
    ds_read_b64_tr_b16 v[128:129], v2 offset:1024
    v_mfma_f32_16x16x32_bf16 v[212:215], v[116:119], v[20:23], 0
    v_fma_f32 v91, v91, s28, v11
    v_mfma_f32_16x16x32_bf16 a[4:7], v[116:119], v[26:29], 0
    v_mfma_f32_16x16x32_bf16 a[52:55], v[116:119], v[32:35], 0
    v_fma_f32 v95, v95, s28, v11
    v_fma_f32 v94, v94, s28, v11
    v_mfma_f32_16x16x32_bf16 a[100:103], v[116:119], v[38:41], 0
    s_waitcnt lgkmcnt(5)
    v_fma_f32 v107, v107, s28, v13
    v_fma_f32 v106, v106, s28, v13
    v_mfma_f32_16x16x32_bf16 v[168:171], v[120:123], v[14:17], 0
    ds_read_b64_tr_b16 v[118:119], v5 offset:7168
    v_fma_f32 v109, v109, s28, v13
    v_mfma_f32_16x16x32_bf16 v[216:219], v[120:123], v[20:23], 0
    v_fma_f32 v108, v108, s28, v13
    v_fma_f32 v105, v105, s28, v13
    v_mfma_f32_16x16x32_bf16 a[8:11], v[120:123], v[26:29], 0
    v_fma_f32 v104, v104, s28, v13
    v_fma_f32 v93, v93, s28, v11
    v_mfma_f32_16x16x32_bf16 a[56:59], v[120:123], v[32:35], 0
    v_fma_f32 v100, v100, s28, v12
    v_mfma_f32_16x16x32_bf16 a[104:107], v[120:123], v[38:41], 0
    ds_read_b64_tr_b16 v[112:113], v4 offset:1024
    v_fma_f32 v88, v88, s28, v11
    v_mfma_f32_16x16x32_bf16 v[172:175], v[124:127], v[14:17], 0
    ds_read_b64_tr_b16 v[122:123], v2 offset:8192
    v_fma_f32 v102, v102, s28, v12
    v_mfma_f32_16x16x32_bf16 v[220:223], v[124:127], v[20:23], 0
    ds_read_b64_tr_b16 v[116:117], v5 offset:1024
    v_fma_f32 v99, v99, s28, v12
    v_mfma_f32_16x16x32_bf16 a[12:15], v[124:127], v[26:29], 0
    v_exp_f32 v109, v109
    v_mfma_f32_16x16x32_bf16 a[60:63], v[124:127], v[32:35], 0
    v_fma_f32 v92, v92, s28, v11
    v_fma_f32 v87, v87, s28, v10
    v_mfma_f32_16x16x32_bf16 a[108:111], v[124:127], v[38:41], 0
    s_waitcnt lgkmcnt(4)
    ds_read_b64_tr_b16 v[126:127], v3 offset:8192
    v_fma_f32 v98, v98, s28, v12
    v_mfma_f32_16x16x32_bf16 v[176:179], v[128:131], v[14:17], 0
    v_mfma_f32_16x16x32_bf16 v[224:227], v[128:131], v[20:23], 0
    v_exp_f32 v107, v107
    v_mfma_f32_16x16x32_bf16 a[16:19], v[128:131], v[26:29], 0
    v_exp_f32 v93, v93
    v_mfma_f32_16x16x32_bf16 a[64:67], v[128:131], v[32:35], 0
    v_fma_f32 v84, v84, s28, v10
    v_mfma_f32_16x16x32_bf16 a[112:115], v[128:131], v[38:41], 0
    ds_read_b64_tr_b16 v[120:121], v2 offset:2048
    v_fma_f32 v79, v79, s28, v9
    v_mfma_f32_16x16x32_bf16 v[180:183], v[132:135], v[14:17], 0
    ds_read_b64_tr_b16 v[124:125], v3 offset:2048
    v_mfma_f32_16x16x32_bf16 v[228:231], v[132:135], v[20:23], 0
    ds_read_b64_tr_b16 v[130:131], v4 offset:8192
    v_mfma_f32_16x16x32_bf16 a[20:23], v[132:135], v[26:29], 0
    v_mfma_f32_16x16x32_bf16 a[68:71], v[132:135], v[32:35], 0
    v_exp_f32 v88, v88
    v_mfma_f32_16x16x32_bf16 a[116:119], v[132:135], v[38:41], 0
    s_waitcnt lgkmcnt(3)
    ds_read_b64_tr_b16 v[128:129], v4 offset:2048
    v_fma_f32 v89, v89, s28, v11
    v_mfma_f32_16x16x32_bf16 v[184:187], v[112:115], v[14:17], 0
    ds_read_b64_tr_b16 v[134:135], v5 offset:8192
    v_mfma_f32_16x16x32_bf16 v[232:235], v[112:115], v[20:23], 0
    ds_read_b64_tr_b16 v[132:133], v5 offset:2048
    v_fma_f32 v85, v85, s28, v10
    v_mfma_f32_16x16x32_bf16 a[24:27], v[112:115], v[26:29], 0
    s_add_u32 s39, s39, 12288
    v_fma_f32 v97, v97, s28, v12
    v_fma_f32 v110, v110, s28, v13
    v_mfma_f32_16x16x32_bf16 a[72:75], v[112:115], v[32:35], 0
    v_exp_f32 v110, v110
    v_mfma_f32_16x16x32_bf16 a[120:123], v[112:115], v[38:41], 0
    v_exp_f32 v104, v104
    v_mfma_f32_16x16x32_bf16 v[188:191], v[116:119], v[14:17], 0
    v_exp_f32 v97, v97
    v_mfma_f32_16x16x32_bf16 v[236:239], v[116:119], v[20:23], 0
    v_exp_f32 v91, v91
    v_mfma_f32_16x16x32_bf16 a[28:31], v[116:119], v[26:29], 0
    v_exp_f32 v92, v92
    v_mfma_f32_16x16x32_bf16 a[76:79], v[116:119], v[32:35], 0
    v_exp_f32 v105, v105
    v_mfma_f32_16x16x32_bf16 a[124:127], v[116:119], v[38:41], 0
    s_waitcnt lgkmcnt(2)
    v_exp_f32 v106, v106
    v_mfma_f32_16x16x32_bf16 v[192:195], v[120:123], v[14:17], 0
    v_exp_f32 v100, v100
    v_mfma_f32_16x16x32_bf16 v[240:243], v[120:123], v[20:23], 0
    v_exp_f32 v96, v96
    v_mfma_f32_16x16x32_bf16 a[32:35], v[120:123], v[26:29], 0
    s_waitcnt vmcnt(3) lgkmcnt(0)
    v_exp_f32 v90, v90
    v_mfma_f32_16x16x32_bf16 a[80:83], v[120:123], v[32:35], 0
    s_barrier
    v_mfma_f32_16x16x32_bf16 a[128:131], v[120:123], v[38:41], 0
    v_exp_f32 v89, v89
    v_mfma_f32_16x16x32_bf16 v[196:199], v[124:127], v[14:17], 0
    ds_read_b128 v[112:115], v0 offset:0
    v_mfma_f32_16x16x32_bf16 v[244:247], v[124:127], v[20:23], 0
    ds_read_b128 v[116:119], v1 offset:0
    v_cvt_pk_bf16_f32 v36, v96, v97
    v_mfma_f32_16x16x32_bf16 a[36:39], v[124:127], v[26:29], 0
    s_add_u32 m0, s22, 24576
    v_exp_f32 v98, v98
    v_mfma_f32_16x16x32_bf16 a[84:87], v[124:127], v[32:35], 0
    buffer_load_dwordx4 v6, s[8:11], s21 offen lds
    v_mfma_f32_16x16x32_bf16 a[132:135], v[124:127], v[38:41], 0
    ds_read_b128 v[120:123], v0 offset:1024
    v_fma_f32 v111, v111, s28, v13
    v_mfma_f32_16x16x32_bf16 v[200:203], v[128:131], v[14:17], 0
    ds_read_b128 v[124:127], v1 offset:1024
    v_mfma_f32_16x16x32_bf16 v[248:251], v[128:131], v[20:23], 0
    v_exp_f32 v99, v99
    v_mfma_f32_16x16x32_bf16 a[40:43], v[128:131], v[26:29], 0
    s_add_u32 s21, s21, 128
    v_exp_f32 v79, v79
    v_mfma_f32_16x16x32_bf16 a[88:91], v[128:131], v[32:35], 0
    s_add_u32 m0, s22, 25600
    v_cvt_pk_bf16_f32 v30, v88, v89
    v_fma_f32 v101, v101, s28, v12
    v_mfma_f32_16x16x32_bf16 a[136:139], v[128:131], v[38:41], 0
    buffer_load_dwordx4 v6, s[8:11], s21 offen lds
    v_mfma_f32_16x16x32_bf16 v[204:207], v[132:135], v[14:17], 0
    s_add_u32 s21, s21, 128
    v_exp_f32 v94, v94
    v_mfma_f32_16x16x32_bf16 v[252:255], v[132:135], v[20:23], 0
    v_mfma_f32_16x16x32_bf16 a[44:47], v[132:135], v[26:29], 0
    v_add_u32 v8, 4096, v8
    v_cvt_pk_bf16_f32 v31, v90, v91
    v_mfma_f32_16x16x32_bf16 a[92:95], v[132:135], v[32:35], 0
    s_add_u32 m0, s22, 26624
    v_cvt_pk_bf16_f32 v43, v106, v107
    v_cvt_pk_bf16_f32 v37, v98, v99
    v_mfma_f32_16x16x32_bf16 a[140:143], v[132:135], v[38:41], 0
    s_waitcnt lgkmcnt(1)
    v_fma_f32 v77, v77, s28, v9
    v_fma_f32 v103, v103, s28, v12
    v_mfma_f32_16x16x32_bf16 v[72:75], v[112:115], a[144:147], 0
    buffer_load_dwordx4 v6, s[8:11], s21 offen lds
    v_mfma_f32_16x16x32_bf16 v[72:75], v[116:119], a[148:151], v[72:75]
    s_add_u32 s21, s21, 12032
    v_cvt_pk_bf16_f32 v28, v92, v93
    v_mfma_f32_16x16x32_bf16 v[72:75], v[120:123], a[152:155], v[72:75]
    v_exp_f32 v103, v103
    v_mfma_f32_16x16x32_bf16 v[80:83], v[112:115], a[168:171], 0
    v_exp_f32 v87, v87
    v_mfma_f32_16x16x32_bf16 v[80:83], v[116:119], a[172:175], v[80:83]
    ds_read_b128 v[128:131], v0 offset:2048
    v_cvt_pk_bf16_f32 v42, v104, v105
    v_mfma_f32_16x16x32_bf16 v[80:83], v[120:123], a[176:179], v[80:83]
    v_exp_f32 v108, v108
    v_mfma_f32_16x16x32_bf16 v[88:91], v[112:115], a[192:195], 0
    ds_read_b128 v[132:135], v1 offset:2048
    v_fma_f32 v86, v86, s28, v10
    v_mfma_f32_16x16x32_bf16 v[88:91], v[116:119], a[196:199], v[88:91]
    v_exp_f32 v95, v95
    v_mfma_f32_16x16x32_bf16 v[88:91], v[120:123], a[200:203], v[88:91]
    v_exp_f32 v77, v77
    v_mfma_f32_16x16x32_bf16 v[96:99], v[112:115], a[216:219], 0
    v_fma_f32 v78, v78, s28, v9
    v_mfma_f32_16x16x32_bf16 v[96:99], v[116:119], a[220:223], v[96:99]
    v_exp_f32 v102, v102
    v_mfma_f32_16x16x32_bf16 v[96:99], v[120:123], a[224:227], v[96:99]
    v_exp_f32 v78, v78
    v_mfma_f32_16x16x32_bf16 v[104:107], v[112:115], a[240:243], 0
    v_exp_f32 v111, v111
    v_mfma_f32_16x16x32_bf16 v[104:107], v[116:119], a[244:247], v[104:107]
    ds_read_b128 v[112:115], v0 offset:6144
    v_mfma_f32_16x16x32_bf16 v[104:107], v[120:123], a[248:251], v[104:107]
    s_waitcnt lgkmcnt(2)
    ds_read_b128 v[120:123], v0 offset:7168
    v_cvt_pk_bf16_f32 v41, v110, v111
    v_mfma_f32_16x16x32_bf16 v[72:75], v[124:127], a[156:159], v[72:75]
    v_exp_f32 v84, v84
    v_mfma_f32_16x16x32_bf16 v[72:75], v[128:131], a[160:163], v[72:75]
    s_waitcnt lgkmcnt(2)
    v_exp_f32 v76, v76
    v_mfma_f32_16x16x32_bf16 v[72:75], v[132:135], a[164:167], v[72:75]
    s_add_u32 m0, s38, 0
    v_cvt_pk_bf16_f32 v17, v78, v79
    v_mfma_f32_16x16x32_bf16 v[80:83], v[124:127], a[180:183], v[80:83]
    v_cvt_pk_bf16_f32 v35, v102, v103
    v_cvt_pk_bf16_f32 v29, v94, v95
    v_mfma_f32_16x16x32_bf16 v[80:83], v[128:131], a[184:187], v[80:83]
    v_mfma_f32_16x16x32_bf16 v[80:83], v[132:135], a[188:191], v[80:83]
    v_exp_f32 v86, v86
    v_mfma_f32_16x16x32_bf16 v[88:91], v[124:127], a[204:207], v[88:91]
    v_cvt_pk_bf16_f32 v40, v108, v109
    v_mfma_f32_16x16x32_bf16 v[88:91], v[128:131], a[208:211], v[88:91]
    v_exp_f32 v85, v85
    v_mfma_f32_16x16x32_bf16 v[88:91], v[132:135], a[212:215], v[88:91]
    buffer_load_dwordx4 v6, s[12:15], s33 offen nt lds
    v_mfma_f32_16x16x32_bf16 v[96:99], v[124:127], a[228:231], v[96:99]
    v_cvt_pk_bf16_f32 v22, v84, v85
    v_cvt_pk_bf16_f32 v23, v86, v87
    v_mfma_f32_16x16x32_bf16 v[96:99], v[128:131], a[232:235], v[96:99]
    ds_read_b128 v[116:119], v1 offset:6144
    v_cvt_pk_bf16_f32 v16, v76, v77
    v_mfma_f32_16x16x32_bf16 v[96:99], v[132:135], a[236:239], v[96:99]
    s_add_u32 m0, s38, 1024
    v_exp_f32 v101, v101
    v_mfma_f32_16x16x32_bf16 v[104:107], v[124:127], a[252:255], v[104:107]
    ds_read_b128 v[124:127], v1 offset:7168
    v_cvt_pk_bf16_f32 v34, v100, v101
    v_mfma_f32_16x16x32_bf16 v[104:107], v[128:131], v[136:139], v[104:107]
    buffer_load_dwordx4 v7, s[12:15], s33 offen nt lds
    v_mfma_f32_16x16x32_bf16 v[104:107], v[132:135], v[140:143], v[104:107]
    ds_read_b128 v[128:131], v0 offset:8192
    v_mfma_f32_16x16x32_bf16 v[48:51], v[52:55], v[16:19], v[44:47]
    ds_read_b128 v[132:135], v1 offset:8192
    v_mfma_f32_16x16x32_bf16 v[48:51], v[56:59], v[22:25], v[48:51]
    s_add_u32 s59, s33, 128
    s_add_u32 m0, s38, 2048
    s_waitcnt lgkmcnt(4)
    v_mfma_f32_16x16x32_bf16 v[76:79], v[112:115], a[144:147], 0
    v_mfma_f32_16x16x32_bf16 v[48:51], v[60:63], v[28:31], v[48:51]
    buffer_load_dwordx4 v6, s[12:15], s59 offen nt lds
    v_mfma_f32_16x16x32_bf16 v[48:51], v[64:67], v[34:37], v[48:51]
    s_add_u32 m0, s38, 3072
    v_mfma_f32_16x16x32_bf16 v[48:51], v[68:71], v[40:43], v[48:51]
    s_waitcnt lgkmcnt(3)
    v_mfma_f32_16x16x32_bf16 v[76:79], v[116:119], a[148:151], v[76:79]
    v_mfma_f32_16x16x32_bf16 v[76:79], v[120:123], a[152:155], v[76:79]
    v_mfma_f32_16x16x32_bf16 v[84:87], v[112:115], a[168:171], 0
    buffer_load_dwordx4 v7, s[12:15], s59 offen nt lds
    v_mfma_f32_16x16x32_bf16 v[84:87], v[116:119], a[172:175], v[84:87]
    s_nop 1
    v_cmp_lt_f32 vcc, s29, v48
    v_mfma_f32_16x16x32_bf16 v[84:87], v[120:123], a[176:179], v[84:87]
    s_waitcnt vmcnt(13) lgkmcnt(0)
    v_mfma_f32_16x16x32_bf16 v[92:95], v[112:115], a[192:195], 0
    s_barrier
    v_mfma_f32_16x16x32_bf16 v[92:95], v[116:119], a[196:199], v[92:95]
    s_cbranch_vccnz L_rs_start5b
L_ret_start5b:
    v_fma_f32 v73, v73, s28, v9
    v_mfma_f32_16x16x32_bf16 v[92:95], v[120:123], a[200:203], v[92:95]
    v_fma_f32 v81, v81, s28, v10
    v_fma_f32 v74, v74, s28, v9
    v_mfma_f32_16x16x32_bf16 v[100:103], v[112:115], a[216:219], 0
    s_add_u32 m0, s22, 0
    v_exp_f32 v81, v81
    v_mfma_f32_16x16x32_bf16 v[100:103], v[116:119], a[220:223], v[100:103]
    buffer_load_dwordx4 v6, s[4:7], s20 offen lds
    v_mfma_f32_16x16x32_bf16 v[100:103], v[120:123], a[224:227], v[100:103]
    v_exp_f32 v74, v74
    v_mfma_f32_16x16x32_bf16 v[108:111], v[112:115], a[240:243], 0
    ds_read_b64_tr_b16 v[112:113], v2 offset:18432
    v_fma_f32 v82, v82, s28, v10
    v_mfma_f32_16x16x32_bf16 v[108:111], v[116:119], a[244:247], v[108:111]
    ds_read_b64_tr_b16 v[114:115], v2 offset:12288
    v_fma_f32 v72, v72, s28, v9
    v_mfma_f32_16x16x32_bf16 v[108:111], v[120:123], a[248:251], v[108:111]
    ds_read_b64_tr_b16 v[116:117], v3 offset:18432
    v_fma_f32 v80, v80, s28, v10
    v_mfma_f32_16x16x32_bf16 v[76:79], v[124:127], a[156:159], v[76:79]
    s_add_u32 s20, s20, 128
    ds_read_b64_tr_b16 v[118:119], v3 offset:12288
    v_mfma_f32_16x16x32_bf16 v[76:79], v[128:131], a[160:163], v[76:79]
    v_exp_f32 v82, v82
    v_mfma_f32_16x16x32_bf16 v[76:79], v[132:135], a[164:167], v[76:79]
    v_exp_f32 v72, v72
    v_mfma_f32_16x16x32_bf16 v[84:87], v[124:127], a[180:183], v[84:87]
    s_add_u32 m0, s22, 1024
    v_fma_f32 v75, v75, s28, v9
    v_fma_f32 v83, v83, s28, v10
    v_mfma_f32_16x16x32_bf16 v[84:87], v[128:131], a[184:187], v[84:87]
    v_exp_f32 v83, v83
    v_mfma_f32_16x16x32_bf16 v[84:87], v[132:135], a[188:191], v[84:87]
    ds_read_b64_tr_b16 v[120:121], v4 offset:18432
    v_cvt_pk_bf16_f32 v21, v82, v83
    v_mfma_f32_16x16x32_bf16 v[92:95], v[124:127], a[204:207], v[92:95]
    v_exp_f32 v80, v80
    v_mfma_f32_16x16x32_bf16 v[92:95], v[128:131], a[208:211], v[92:95]
    buffer_load_dwordx4 v6, s[4:7], s20 offen lds
    v_mfma_f32_16x16x32_bf16 v[92:95], v[132:135], a[212:215], v[92:95]
    s_add_u32 s20, s20, 128
    v_exp_f32 v75, v75
    v_mfma_f32_16x16x32_bf16 v[100:103], v[124:127], a[228:231], v[100:103]
    v_cvt_pk_bf16_f32 v20, v80, v81
    v_mfma_f32_16x16x32_bf16 v[100:103], v[128:131], a[232:235], v[100:103]
    s_add_u32 m0, s22, 2048
    ds_read_b64_tr_b16 v[122:123], v4 offset:12288
    v_cvt_pk_bf16_f32 v15, v74, v75
    v_mfma_f32_16x16x32_bf16 v[100:103], v[132:135], a[236:239], v[100:103]
    v_exp_f32 v73, v73
    v_mfma_f32_16x16x32_bf16 v[108:111], v[124:127], a[252:255], v[108:111]
    buffer_load_dwordx4 v6, s[4:7], s20 offen lds
    v_mfma_f32_16x16x32_bf16 v[108:111], v[128:131], v[136:139], v[108:111]
    s_add_u32 s20, s20, 12032
    ds_read_b64_tr_b16 v[124:125], v5 offset:18432
    v_cvt_pk_bf16_f32 v14, v72, v73
    v_mfma_f32_16x16x32_bf16 v[108:111], v[132:135], v[140:143], v[108:111]
    ds_read_b64_tr_b16 v[126:127], v5 offset:12288
    s_branch L_loop5
L_start4:
    s_add_u32 m0, s22, 0
    s_nop 0
    buffer_load_dwordx4 v6, s[4:7], s20 offen lds
    s_add_u32 s20, s20, 128
    s_add_u32 m0, s22, 1024
    s_nop 0
    buffer_load_dwordx4 v6, s[4:7], s20 offen lds
    s_add_u32 s20, s20, 128
    s_add_u32 m0, s22, 2048
    s_nop 0
    buffer_load_dwordx4 v6, s[4:7], s20 offen lds
    s_add_u32 s20, s20, 12032
    s_add_u32 s48, s34, 0
    s_add_u32 m0, s38, 0
    s_nop 0
    buffer_load_dwordx4 v6, s[12:15], s48 offen nt lds
    s_add_u32 m0, s38, 1024
    s_nop 0
    buffer_load_dwordx4 v7, s[12:15], s48 offen nt lds
    s_add_u32 s48, s34, 128
    s_add_u32 m0, s38, 2048
    s_nop 0
    buffer_load_dwordx4 v6, s[12:15], s48 offen nt lds
    s_add_u32 m0, s38, 3072
    s_nop 0
    buffer_load_dwordx4 v7, s[12:15], s48 offen nt lds
    s_add_u32 s48, s34, 256
    s_add_u32 m0, s38, 4096
    s_nop 0
    buffer_load_dwordx4 v6, s[12:15], s48 offen nt lds
    s_add_u32 m0, s38, 5120
    s_nop 0
    buffer_load_dwordx4 v7, s[12:15], s48 offen nt lds
    s_add_u32 s48, s34, 6144
    s_add_u32 m0, s38, 6144
    s_nop 0
    buffer_load_dwordx4 v6, s[12:15], s48 offen nt lds
    s_add_u32 m0, s38, 7168
    s_nop 0
    buffer_load_dwordx4 v7, s[12:15], s48 offen nt lds
    s_add_u32 s48, s34, 6272
    s_add_u32 m0, s38, 8192
    s_nop 0
    buffer_load_dwordx4 v6, s[12:15], s48 offen nt lds
    s_add_u32 m0, s38, 9216
    s_nop 0
    buffer_load_dwordx4 v7, s[12:15], s48 offen nt lds
    s_add_u32 s48, s34, 6400
    s_add_u32 m0, s38, 10240
    s_nop 0
    buffer_load_dwordx4 v6, s[12:15], s48 offen nt lds
    s_add_u32 m0, s38, 11264
    s_nop 0
    buffer_load_dwordx4 v7, s[12:15], s48 offen nt lds
    v_and_b32 v144, 15, v151
    v_lshrrev_b32 v145, 4, v151
    v_lshrrev_b32 v146, 3, v144
    v_and_b32 v147, 7, v144
    v_lshlrev_b32 v0, 7, v147
    v_bfe_u32 v147, v144, 1, 2
    v_lshlrev_b32 v147, 1, v147
    v_mul_u32_u24 v148, 5, v146
    v_xor_b32 v147, v147, v148
    v_xor_b32 v147, v147, v145
    v_lshl_add_u32 v0, v147, 4, v0
    v_mul_u32_u24 v148, 3072, v146
    v_add_u32 v0, v148, v0
    v_xor_b32 v1, 64, v0
    v_lshrrev_b32 v146, 1, v145
    v_mul_u32_u24 v2, 3072, v146
    v_and_b32 v147, 1, v145
    v_bfe_u32 v148, v151, 2, 2
    v_lshl_add_u32 v144, v147, 2, v148
    v_lshl_add_u32 v2, v144, 7, v2
    v_lshrrev_b32 v144, 1, v144
    v_lshlrev_b32 v144, 1, v144
    v_mul_u32_u24 v146, 5, v146
    v_xor_b32 v144, v144, v146
    v_bfe_u32 v147, v151, 1, 1
    v_xor_b32 v144, v144, v147
    v_lshl_add_u32 v2, v144, 4, v2
    v_and_b32 v147, 1, v151
    v_lshl_add_u32 v2, v147, 3, v2
    v_add_u32 v2, 24576, v2
    v_xor_b32 v3, 32, v2
    v_xor_b32 v4, 64, v2
    v_xor_b32 v5, 96, v2
    v_lshl_add_u32 v8, v151, 4, s38
    v_and_b32 v144, 15, v151
    s_mov_b32 s42, 0x1011
    v_bfe_i32 v145, s42, v144, 1
    v_and_b32 v52, 0x3f803f80, v145
    v_and_b32 v53, 0x3f803f80, v145
    v_and_b32 v54, 0x3f803f80, v145
    v_and_b32 v55, 0x3f803f80, v145
    s_mov_b32 s42, 0x3222
    v_bfe_i32 v145, s42, v144, 1
    v_and_b32 v56, 0x3f803f80, v145
    v_and_b32 v57, 0x3f803f80, v145
    v_and_b32 v58, 0x3f803f80, v145
    v_and_b32 v59, 0x3f803f80, v145
    s_mov_b32 s42, 0x5444
    v_bfe_i32 v145, s42, v144, 1
    v_and_b32 v60, 0x3f803f80, v145
    v_and_b32 v61, 0x3f803f80, v145
    v_and_b32 v62, 0x3f803f80, v145
    v_and_b32 v63, 0x3f803f80, v145
    s_mov_b32 s42, 0x9888
    v_bfe_i32 v145, s42, v144, 1
    v_and_b32 v64, 0x3f803f80, v145
    v_and_b32 v65, 0x3f803f80, v145
    v_and_b32 v66, 0x3f803f80, v145
    v_and_b32 v67, 0x3f803f80, v145
    s_mov_b32 s42, 0x1100
    v_bfe_i32 v145, s42, v144, 1
    v_and_b32 v68, 0x3f803f80, v145
    v_and_b32 v69, 0x3f803f80, v145
    v_and_b32 v70, 0x3f803f80, v145
    v_and_b32 v71, 0x3f803f80, v145
    s_waitcnt vmcnt(12)
    s_barrier
    ds_read_b128 v[112:115], v0 offset:0
    ds_read_b128 v[116:119], v1 offset:0
    ds_read_b128 v[120:123], v0 offset:1024
    ds_read_b128 v[124:127], v1 offset:1024
    ds_read_b128 v[128:131], v0 offset:2048
    ds_read_b128 v[132:135], v1 offset:2048
    s_waitcnt vmcnt(6)
    v_lshrrev_b32 v153, 11, v0
    v_and_b32 v152, 0x3ff, v0
    v_xor_b32 v153, s65, v153
    v_lshl_add_u32 v152, v153, 10, v152
    v_add_u32 v152, s38, v152
    ds_read_b128 a[144:147], v152 offset:0
    s_add_u32 s48, s34, 12288
    s_add_u32 m0, s38, 12288
    ds_read_b128 a[152:155], v152 offset:2048
    ds_read_b128 a[160:163], v152 offset:4096
    v_xor_b32 v153, 64, v152
    ds_read_b128 a[148:151], v153 offset:0
    ds_read_b128 a[156:159], v153 offset:2048
    ds_read_b128 a[164:167], v153 offset:4096
    s_waitcnt lgkmcnt(5)
    v_mfma_f32_16x16x32_bf16 v[72:75], v[112:115], a[144:147], 0
    buffer_load_dwordx4 v6, s[12:15], s48 offen nt lds
    ds_read_b128 v[112:115], v0 offset:6144
    s_add_u32 m0, s38, 13312
    s_waitcnt lgkmcnt(3)
    v_mfma_f32_16x16x32_bf16 v[72:75], v[116:119], a[148:151], v[72:75]
    buffer_load_dwordx4 v7, s[12:15], s48 offen nt lds
    ds_read_b128 v[116:119], v1 offset:6144
    s_add_u32 s48, s34, 12416
    s_add_u32 m0, s38, 14336
    v_mfma_f32_16x16x32_bf16 v[72:75], v[120:123], a[152:155], v[72:75]
    buffer_load_dwordx4 v6, s[12:15], s48 offen nt lds
    ds_read_b128 v[120:123], v0 offset:7168
    s_add_u32 m0, s38, 15360
    s_waitcnt lgkmcnt(4)
    v_mfma_f32_16x16x32_bf16 v[72:75], v[124:127], a[156:159], v[72:75]
    buffer_load_dwordx4 v7, s[12:15], s48 offen nt lds
    ds_read_b128 v[124:127], v1 offset:7168
    s_add_u32 s48, s34, 12544
    s_add_u32 m0, s38, 16384
    v_mfma_f32_16x16x32_bf16 v[72:75], v[128:131], a[160:163], v[72:75]
    buffer_load_dwordx4 v6, s[12:15], s48 offen nt lds
    ds_read_b128 v[128:131], v0 offset:8192
    s_add_u32 m0, s38, 17408
    s_waitcnt lgkmcnt(5)
    v_mfma_f32_16x16x32_bf16 v[72:75], v[132:135], a[164:167], v[72:75]
    buffer_load_dwordx4 v7, s[12:15], s48 offen nt lds
    ds_read_b128 v[132:135], v1 offset:8192
    s_add_u32 s48, s34, 18432
    s_add_u32 m0, s38, 18432
    s_waitcnt lgkmcnt(5)
    v_mfma_f32_16x16x32_bf16 v[76:79], v[112:115], a[144:147], 0
    s_waitcnt lgkmcnt(4)
    ds_read_b128 v[112:115], v0 offset:0
    v_mfma_f32_16x16x32_bf16 v[76:79], v[116:119], a[148:151], v[76:79]
    s_waitcnt lgkmcnt(4)
    ds_read_b128 v[116:119], v1 offset:0
    v_mfma_f32_16x16x32_bf16 v[76:79], v[120:123], a[152:155], v[76:79]
    s_waitcnt lgkmcnt(4)
    ds_read_b128 v[120:123], v0 offset:1024
    v_mfma_f32_16x16x32_bf16 v[76:79], v[124:127], a[156:159], v[76:79]
    s_waitcnt lgkmcnt(4)
    ds_read_b128 v[124:127], v1 offset:1024
    v_mfma_f32_16x16x32_bf16 v[76:79], v[128:131], a[160:163], v[76:79]
    s_waitcnt lgkmcnt(4)
    ds_read_b128 v[128:131], v0 offset:2048
    v_mfma_f32_16x16x32_bf16 v[76:79], v[132:135], a[164:167], v[76:79]
    ds_read_b128 v[132:135], v1 offset:2048
    s_waitcnt vmcnt(6)
    ds_read_b128 a[168:171], v152 offset:6144
    ds_read_b128 a[172:175], v153 offset:6144
    ds_read_b128 a[176:179], v152 offset:8192
    ds_read_b128 a[180:183], v153 offset:8192
    ds_read_b128 a[184:187], v152 offset:10240
    ds_read_b128 a[188:191], v153 offset:10240
    s_waitcnt lgkmcnt(5)
    v_mfma_f32_16x16x32_bf16 v[80:83], v[112:115], a[168:171], 0
    buffer_load_dwordx4 v6, s[12:15], s48 offen nt lds
    ds_read_b128 v[112:115], v0 offset:6144
    s_add_u32 m0, s38, 19456
    s_waitcnt lgkmcnt(5)
    v_mfma_f32_16x16x32_bf16 v[80:83], v[116:119], a[172:175], v[80:83]
    buffer_load_dwordx4 v7, s[12:15], s48 offen nt lds
    ds_read_b128 v[116:119], v1 offset:6144
    s_add_u32 s48, s34, 18560
    s_add_u32 m0, s38, 20480
    s_waitcnt lgkmcnt(5)
    v_mfma_f32_16x16x32_bf16 v[80:83], v[120:123], a[176:179], v[80:83]
    buffer_load_dwordx4 v6, s[12:15], s48 offen nt lds
    ds_read_b128 v[120:123], v0 offset:7168
    s_add_u32 m0, s38, 21504
    s_waitcnt lgkmcnt(5)
    v_mfma_f32_16x16x32_bf16 v[80:83], v[124:127], a[180:183], v[80:83]
    buffer_load_dwordx4 v7, s[12:15], s48 offen nt lds
    ds_read_b128 v[124:127], v1 offset:7168
    s_add_u32 s48, s34, 18688
    s_add_u32 m0, s38, 22528
    s_waitcnt lgkmcnt(5)
    v_mfma_f32_16x16x32_bf16 v[80:83], v[128:131], a[184:187], v[80:83]
    buffer_load_dwordx4 v6, s[12:15], s48 offen nt lds
    ds_read_b128 v[128:131], v0 offset:8192
    s_add_u32 m0, s38, 23552
    s_waitcnt lgkmcnt(5)
    v_mfma_f32_16x16x32_bf16 v[80:83], v[132:135], a[188:191], v[80:83]
    buffer_load_dwordx4 v7, s[12:15], s48 offen nt lds
    ds_read_b128 v[132:135], v1 offset:8192
    s_add_u32 m0, s22, 12288
    s_waitcnt lgkmcnt(5)
    v_mfma_f32_16x16x32_bf16 v[84:87], v[112:115], a[168:171], 0
    s_waitcnt lgkmcnt(4)
    ds_read_b128 v[112:115], v0 offset:0
    v_mfma_f32_16x16x32_bf16 v[84:87], v[116:119], a[172:175], v[84:87]
    s_waitcnt lgkmcnt(4)
    ds_read_b128 v[116:119], v1 offset:0
    v_mfma_f32_16x16x32_bf16 v[84:87], v[120:123], a[176:179], v[84:87]
    s_waitcnt lgkmcnt(4)
    ds_read_b128 v[120:123], v0 offset:1024
    v_mfma_f32_16x16x32_bf16 v[84:87], v[124:127], a[180:183], v[84:87]
    s_waitcnt lgkmcnt(4)
    ds_read_b128 v[124:127], v1 offset:1024
    v_mfma_f32_16x16x32_bf16 v[84:87], v[128:131], a[184:187], v[84:87]
    s_waitcnt lgkmcnt(4)
    ds_read_b128 v[128:131], v0 offset:2048
    v_mfma_f32_16x16x32_bf16 v[84:87], v[132:135], a[188:191], v[84:87]
    ds_read_b128 v[132:135], v1 offset:2048
    s_waitcnt vmcnt(6)
    ds_read_b128 a[192:195], v152 offset:12288
    ds_read_b128 a[196:199], v153 offset:12288
    ds_read_b128 a[200:203], v152 offset:14336
    ds_read_b128 a[204:207], v153 offset:14336
    ds_read_b128 a[208:211], v152 offset:16384
    ds_read_b128 a[212:215], v153 offset:16384
    s_waitcnt lgkmcnt(5)
    v_mfma_f32_16x16x32_bf16 v[88:91], v[112:115], a[192:195], 0
    buffer_load_dwordx4 v6, s[4:7], s20 offen lds
    ds_read_b128 v[112:115], v0 offset:6144
    s_add_u32 s20, s20, 128
    s_add_u32 m0, s22, 13312
    s_waitcnt lgkmcnt(5)
    v_mfma_f32_16x16x32_bf16 v[88:91], v[116:119], a[196:199], v[88:91]
    buffer_load_dwordx4 v6, s[4:7], s20 offen lds
    ds_read_b128 v[116:119], v1 offset:6144
    s_add_u32 s20, s20, 128
    s_add_u32 m0, s22, 14336
    s_waitcnt lgkmcnt(5)
    v_mfma_f32_16x16x32_bf16 v[88:91], v[120:123], a[200:203], v[88:91]
    buffer_load_dwordx4 v6, s[4:7], s20 offen lds
    ds_read_b128 v[120:123], v0 offset:7168
    s_add_u32 s20, s20, 12032
    s_add_u32 m0, s22, 24576
    s_waitcnt lgkmcnt(5)
    v_mfma_f32_16x16x32_bf16 v[88:91], v[124:127], a[204:207], v[88:91]
    s_waitcnt lgkmcnt(4)
    ds_read_b128 v[124:127], v1 offset:7168
    v_mfma_f32_16x16x32_bf16 v[88:91], v[128:131], a[208:211], v[88:91]
    s_waitcnt lgkmcnt(4)
    ds_read_b128 v[128:131], v0 offset:8192
    v_mfma_f32_16x16x32_bf16 v[88:91], v[132:135], a[212:215], v[88:91]
    s_waitcnt lgkmcnt(4)
    ds_read_b128 v[132:135], v1 offset:8192
    v_mfma_f32_16x16x32_bf16 v[92:95], v[112:115], a[192:195], 0
    s_waitcnt lgkmcnt(4)
    ds_read_b128 v[112:115], v0 offset:0
    v_mfma_f32_16x16x32_bf16 v[92:95], v[116:119], a[196:199], v[92:95]
    s_waitcnt lgkmcnt(4)
    ds_read_b128 v[116:119], v1 offset:0
    v_mfma_f32_16x16x32_bf16 v[92:95], v[120:123], a[200:203], v[92:95]
    s_waitcnt lgkmcnt(4)
    ds_read_b128 v[120:123], v0 offset:1024
    v_mfma_f32_16x16x32_bf16 v[92:95], v[124:127], a[204:207], v[92:95]
    s_waitcnt lgkmcnt(4)
    ds_read_b128 v[124:127], v1 offset:1024
    v_mfma_f32_16x16x32_bf16 v[92:95], v[128:131], a[208:211], v[92:95]
    s_waitcnt lgkmcnt(4)
    ds_read_b128 v[128:131], v0 offset:2048
    v_mfma_f32_16x16x32_bf16 v[92:95], v[132:135], a[212:215], v[92:95]
    ds_read_b128 v[132:135], v1 offset:2048
    s_waitcnt vmcnt(3)
    ds_read_b128 a[216:219], v152 offset:18432
    ds_read_b128 a[220:223], v153 offset:18432
    ds_read_b128 a[224:227], v152 offset:20480
    ds_read_b128 a[228:231], v153 offset:20480
    ds_read_b128 a[232:235], v152 offset:22528
    ds_read_b128 a[236:239], v153 offset:22528
    s_waitcnt lgkmcnt(5)
    v_mfma_f32_16x16x32_bf16 v[96:99], v[112:115], a[216:219], 0
    buffer_load_dwordx4 v6, s[8:11], s21 offen lds
    ds_read_b128 v[112:115], v0 offset:6144
    s_add_u32 s21, s21, 128
    s_add_u32 m0, s22, 25600
    s_waitcnt lgkmcnt(5)
    v_mfma_f32_16x16x32_bf16 v[96:99], v[116:119], a[220:223], v[96:99]
    buffer_load_dwordx4 v6, s[8:11], s21 offen lds
    ds_read_b128 v[116:119], v1 offset:6144
    s_add_u32 s21, s21, 128
    s_add_u32 m0, s22, 26624
    s_waitcnt lgkmcnt(5)
    v_mfma_f32_16x16x32_bf16 v[96:99], v[120:123], a[224:227], v[96:99]
    buffer_load_dwordx4 v6, s[8:11], s21 offen lds
    ds_read_b128 v[120:123], v0 offset:7168
    s_add_u32 s21, s21, 12032
    s_add_u32 m0, s22, 36864
    s_waitcnt lgkmcnt(5)
    v_mfma_f32_16x16x32_bf16 v[96:99], v[124:127], a[228:231], v[96:99]
    buffer_load_dwordx4 v6, s[8:11], s21 offen lds
    ds_read_b128 v[124:127], v1 offset:7168
    s_add_u32 s21, s21, 128
    s_add_u32 m0, s22, 37888
    s_waitcnt lgkmcnt(5)
    v_mfma_f32_16x16x32_bf16 v[96:99], v[128:131], a[232:235], v[96:99]
    buffer_load_dwordx4 v6, s[8:11], s21 offen lds
    ds_read_b128 v[128:131], v0 offset:8192
    s_add_u32 s21, s21, 128
    s_add_u32 m0, s22, 38912
    s_waitcnt lgkmcnt(4)
    v_mfma_f32_16x16x32_bf16 v[96:99], v[132:135], a[236:239], v[96:99]
    buffer_load_dwordx4 v6, s[8:11], s21 offen lds
    ds_read_b128 v[132:135], v1 offset:8192
    s_add_u32 s21, s21, 12032
    v_mfma_f32_16x16x32_bf16 v[100:103], v[112:115], a[216:219], 0
    s_waitcnt lgkmcnt(4)
    v_mfma_f32_16x16x32_bf16 v[100:103], v[116:119], a[220:223], v[100:103]
    s_waitcnt lgkmcnt(3)
    v_mfma_f32_16x16x32_bf16 v[100:103], v[120:123], a[224:227], v[100:103]
    s_waitcnt lgkmcnt(2)
    v_mfma_f32_16x16x32_bf16 v[100:103], v[124:127], a[228:231], v[100:103]
    s_waitcnt lgkmcnt(1)
    v_mfma_f32_16x16x32_bf16 v[100:103], v[128:131], a[232:235], v[100:103]
    s_waitcnt lgkmcnt(0)
    v_mfma_f32_16x16x32_bf16 v[100:103], v[132:135], a[236:239], v[100:103]
    s_waitcnt vmcnt(6)
    s_barrier
    ds_read_b128 v[120:123], v0 offset:13312
    ds_read_b128 v[116:119], v1 offset:12288
    v_max3_f32 v146, v80, v81, v82
    v_max3_f32 v144, v72, v73, v74
    v_max3_f32 v146, v146, v83, v84
    v_max3_f32 v146, v146, v85, v86
    v_max3_f32 v144, v144, v75, v76
    v_max3_f32 v144, v144, v77, v78
    v_max_f32 v144, v144, v79
    v_mov_b32 v145, v144
    v_max_f32 v146, v146, v87
    v_mov_b32 v147, v146
    v_permlane32_swap_b32 v145, v144
    v_max_f32 v144, v144, v145
    v_mov_b32 v145, v144
    v_permlane32_swap_b32 v147, v146
    v_max_f32 v146, v146, v147
    v_mov_b32 v147, v146
    v_permlane16_swap_b32 v145, v144
    s_add_u32 m0, s22, 0
    ds_read_b128 v[112:115], v0 offset:12288
    buffer_load_dwordx4 v6, s[4:7], s20 offen lds
    v_max_f32 v144, v144, v145
    v_permlane16_swap_b32 v147, v146
    v_max_f32 v146, v146, v147
    v_mul_f32_e64 v9, -s28, v144
    v_fma_f32 v73, v73, s28, v9
    v_mul_f32_e64 v10, -s28, v146
    v_max3_f32 v144, v88, v89, v90
    v_max3_f32 v146, v96, v97, v98
    v_fma_f32 v82, v82, s28, v10
    v_fma_f32 v72, v72, s28, v9
    v_fma_f32 v74, v74, s28, v9
    v_fma_f32 v75, v75, s28, v9
    v_max3_f32 v146, v146, v99, v100
    v_max3_f32 v146, v146, v101, v102
    v_max_f32 v146, v146, v103
    v_max3_f32 v144, v144, v91, v92
    v_max3_f32 v144, v144, v93, v94
    v_exp_f32 v72, v72
    v_max_f32 v144, v144, v95
    v_fma_f32 v79, v79, s28, v9
    v_exp_f32 v75, v75
    v_mov_b32 v147, v146
    v_fma_f32 v83, v83, s28, v10
    v_fma_f32 v81, v81, s28, v10
    v_exp_f32 v73, v73
    v_permlane32_swap_b32 v147, v146
    v_mov_b32 v145, v144
    v_max_f32 v146, v146, v147
    v_fma_f32 v85, v85, s28, v10
    v_mov_b32 v147, v146
    v_fma_f32 v77, v77, s28, v9
    v_permlane32_swap_b32 v145, v144
    v_max_f32 v144, v144, v145
    v_exp_f32 v74, v74
    v_mov_b32 v145, v144
    v_fma_f32 v80, v80, s28, v10
    v_exp_f32 v80, v80
    v_permlane16_swap_b32 v147, v146
    v_exp_f32 v85, v85
    v_fma_f32 v86, v86, s28, v10
    v_permlane16_swap_b32 v145, v144
    v_max_f32 v146, v146, v147
    v_cvt_pk_bf16_f32 v14, v72, v73
    v_fma_f32 v78, v78, s28, v9
    v_mul_f32_e64 v12, -s28, v146
    v_cvt_pk_bf16_f32 v15, v74, v75
    v_exp_f32 v81, v81
    v_fma_f32 v96, v96, s28, v12
    v_max_f32 v144, v144, v145
    v_fma_f32 v97, v97, s28, v12
    v_mul_f32_e64 v11, -s28, v144
    v_exp_f32 v83, v83
    s_waitcnt lgkmcnt(0)
    v_mfma_f32_16x16x32_bf16 v[72:75], v[112:115], a[144:147], 0
    v_fma_f32 v87, v87, s28, v10
    v_cvt_pk_bf16_f32 v20, v80, v81
    v_fma_f32 v90, v90, s28, v11
    v_fma_f32 v98, v98, s28, v12
    v_mfma_f32_16x16x32_bf16 v[72:75], v[116:119], a[148:151], v[72:75]
    s_add_u32 s20, s20, 128
    ds_read_b128 v[128:131], v0 offset:14336
    v_fma_f32 v89, v89, s28, v11
    v_mfma_f32_16x16x32_bf16 v[72:75], v[120:123], a[152:155], v[72:75]
    v_exp_f32 v96, v96
    v_exp_f32 v82, v82
    v_exp_f32 v90, v90
    v_cvt_pk_bf16_f32 v21, v82, v83
    v_fma_f32 v103, v103, s28, v12
    v_fma_f32 v88, v88, s28, v11
    v_exp_f32 v89, v89
    v_mfma_f32_16x16x32_bf16 v[80:83], v[112:115], a[168:171], 0
    s_add_u32 m0, s22, 1024
    ds_read_b128 v[132:135], v1 offset:14336
    v_fma_f32 v91, v91, s28, v11
    v_exp_f32 v97, v97
    v_exp_f32 v88, v88
    v_mfma_f32_16x16x32_bf16 v[80:83], v[116:119], a[172:175], v[80:83]
    buffer_load_dwordx4 v6, s[4:7], s20 offen lds
    ds_read_b128 v[124:127], v1 offset:13312
    v_cvt_pk_bf16_f32 v26, v88, v89
    v_mfma_f32_16x16x32_bf16 v[80:83], v[120:123], a[176:179], v[80:83]
    v_exp_f32 v91, v91
    v_fma_f32 v99, v99, s28, v12
    v_cvt_pk_bf16_f32 v27, v90, v91
    v_fma_f32 v102, v102, s28, v12
    v_mfma_f32_16x16x32_bf16 v[88:91], v[112:115], a[192:195], 0
    s_add_u32 s20, s20, 128
    v_fma_f32 v93, v93, s28, v11
    v_exp_f32 v98, v98
    v_exp_f32 v99, v99
    v_mfma_f32_16x16x32_bf16 v[88:91], v[116:119], a[196:199], v[88:91]
    s_add_u32 m0, s22, 2048
    v_fma_f32 v95, v95, s28, v11
    v_exp_f32 v87, v87
    v_exp_f32 v95, v95
    v_cvt_pk_bf16_f32 v32, v96, v97
    v_fma_f32 v94, v94, s28, v11
    v_mfma_f32_16x16x32_bf16 v[88:91], v[120:123], a[200:203], v[88:91]
    v_fma_f32 v101, v101, s28, v12
    v_cvt_pk_bf16_f32 v33, v98, v99
    v_mfma_f32_16x16x32_bf16 v[96:99], v[112:115], a[216:219], 0
    buffer_load_dwordx4 v6, s[4:7], s20 offen lds
    v_mfma_f32_16x16x32_bf16 v[96:99], v[116:119], a[220:223], v[96:99]
    s_add_u32 s20, s20, 12032
    ds_read_b128 v[112:115], v0 offset:18432
    v_fma_f32 v84, v84, s28, v10
    v_mfma_f32_16x16x32_bf16 v[96:99], v[120:123], a[224:227], v[96:99]
    s_waitcnt lgkmcnt(1)
    v_fma_f32 v100, v100, s28, v12
    v_exp_f32 v103, v103
    v_mfma_f32_16x16x32_bf16 v[72:75], v[124:127], a[156:159], v[72:75]
    s_mov_b32 s39, s64
    v_exp_f32 v94, v94
    v_mfma_f32_16x16x32_bf16 v[72:75], v[128:131], a[160:163], v[72:75]
    s_add_u32 s37, s37, 1
    ds_read_b128 v[120:123], v0 offset:19456
    v_fma_f32 v92, v92, s28, v11
    v_fma_f32 v76, v76, s28, v9
    v_mfma_f32_16x16x32_bf16 v[72:75], v[132:135], a[164:167], v[72:75]
    s_bitcmp1_b32 s63, s37
    v_exp_f32 v84, v84
    v_mfma_f32_16x16x32_bf16 v[80:83], v[124:127], a[180:183], v[80:83]
    s_cselect_b32 s62, 4294770688, 0
    ds_read_b128 v[116:119], v1 offset:18432
    v_exp_f32 v78, v78
    v_mfma_f32_16x16x32_bf16 v[80:83], v[128:131], a[184:187], v[80:83]
    s_cselect_b32 s42, 0, 325632
    v_exp_f32 v76, v76
    v_mfma_f32_16x16x32_bf16 v[80:83], v[132:135], a[188:191], v[80:83]
    s_add_u32 s35, s35, s42
    v_exp_f32 v79, v79
    v_mfma_f32_16x16x32_bf16 v[88:91], v[124:127], a[204:207], v[88:91]
    s_lshl_b32 s42, s37, 1
    v_exp_f32 v77, v77
    v_mfma_f32_16x16x32_bf16 v[88:91], v[128:131], a[208:211], v[88:91]
    s_lshr_b32 s42, s31, s42
    v_exp_f32 v100, v100
    v_mfma_f32_16x16x32_bf16 v[88:91], v[132:135], a[212:215], v[88:91]
    s_and_b32 s42, s42, 3
    v_cvt_pk_bf16_f32 v22, v84, v85
    v_cvt_pk_bf16_f32 v17, v78, v79
    v_cvt_pk_bf16_f32 v16, v76, v77
    v_mfma_f32_16x16x32_bf16 v[96:99], v[124:127], a[228:231], v[96:99]
    s_add_u32 s42, s42, s36
    v_fma_f32 v80, v80, s28, v10
    v_cvt_pk_bf16_f32 v29, v94, v95
    v_mfma_f32_16x16x32_bf16 v[96:99], v[128:131], a[232:235], v[96:99]
    s_sub_u32 s43, s42, 3
    s_cmp_ge_u32 s42, 3
    v_exp_f32 v86, v86
    v_mfma_f32_16x16x32_bf16 v[96:99], v[132:135], a[236:239], v[96:99]
    s_cselect_b32 s42, s43, s42
    v_fma_f32 v75, v75, s28, v9
    v_fma_f32 v74, v74, s28, v9
    v_cvt_pk_bf16_f32 v23, v86, v87
    s_mul_i32 s44, s3, 5
    v_mfma_f32_16x16x32_bf16 v[44:47], v[52:55], v[14:17], 0
    s_waitcnt lgkmcnt(0)
    ds_read_b128 v[124:127], v1 offset:19456
    v_fma_f32 v72, v72, s28, v9
    v_mfma_f32_16x16x32_bf16 v[76:79], v[112:115], a[144:147], 0
    s_mov_b32 s32, 1
    v_exp_f32 v93, v93
    v_mfma_f32_16x16x32_bf16 v[44:47], v[56:59], v[20:23], v[44:47]
    s_lshl_b32 s43, s3, 2
    v_exp_f32 v102, v102
    v_mfma_f32_16x16x32_bf16 v[76:79], v[116:119], a[148:151], v[76:79]
    s_add_u32 s45, s43, 21
    v_exp_f32 v92, v92
    v_mfma_f32_16x16x32_bf16 v[76:79], v[120:123], a[152:155], v[76:79]
    s_cmp_eq_u32 s3, 0
    ds_read_b128 v[132:135], v1 offset:20480
    v_cvt_pk_bf16_f32 v28, v92, v93
    v_mfma_f32_16x16x32_bf16 v[84:87], v[112:115], a[168:171], 0
    s_cselect_b32 s45, 20, s45
    ds_read_b128 v[128:131], v0 offset:20480
    v_exp_f32 v72, v72
    v_mfma_f32_16x16x32_bf16 v[84:87], v[116:119], a[172:175], v[84:87]
    s_cselect_b32 s33, 1, 0
    v_exp_f32 v75, v75
    v_mfma_f32_16x16x32_bf16 v[84:87], v[120:123], a[176:179], v[84:87]
    s_cmp_eq_u32 s42, 1
    s_cselect_b32 s44, s45, s44
    v_fma_f32 v73, v73, s28, v9
    v_mfma_f32_16x16x32_bf16 v[92:95], v[112:115], a[192:195], 0
    s_cselect_b32 s32, s33, s32
    v_exp_f32 v80, v80
    v_mfma_f32_16x16x32_bf16 v[44:47], v[60:63], v[26:29], v[44:47]
    s_add_u32 s45, s43, 37
    v_exp_f32 v101, v101
    v_mfma_f32_16x16x32_bf16 v[92:95], v[116:119], a[196:199], v[92:95]
    s_cmp_eq_u32 s42, 2
    v_fma_f32 v81, v81, s28, v10
    s_cselect_b32 s44, s45, s44
    v_mfma_f32_16x16x32_bf16 v[92:95], v[120:123], a[200:203], v[92:95]
    s_cselect_b32 s32, 0, s32
    v_cvt_pk_bf16_f32 v35, v102, v103
    v_cvt_pk_bf16_f32 v34, v100, v101
    v_mfma_f32_16x16x32_bf16 v[100:103], v[112:115], a[216:219], 0
    s_mul_i32 s44, s44, 6144
    s_add_u32 s33, s35, s44
    s_mul_i32 s42, s32, 6144
    v_mfma_f32_16x16x32_bf16 v[100:103], v[116:119], a[220:223], v[100:103]
    s_add_u32 s42, s42, 24576
    s_add_u32 s42, s42, s33
    s_cmp_ge_u32 s37, 6
    v_mfma_f32_16x16x32_bf16 v[100:103], v[120:123], a[224:227], v[100:103]
    s_cselect_b32 s14, 0, s42
    s_add_u32 s24, s67, 6400
    s_waitcnt lgkmcnt(0)
    v_mfma_f32_16x16x32_bf16 v[76:79], v[124:127], a[156:159], v[76:79]
    s_add_u32 s25, s33, 6400
    s_add_u32 s23, s38, 10240
    s_mov_b32 s27, 0x49249249
    v_mfma_f32_16x16x32_bf16 v[76:79], v[128:131], a[160:163], v[76:79]
    s_mov_b32 s30, 0
    v_exp_f32 v73, v73
    v_mfma_f32_16x16x32_bf16 v[76:79], v[132:135], a[164:167], v[76:79]
    s_waitcnt vmcnt(6)
    s_barrier
    ds_read_b64_tr_b16 v[112:113], v2 offset:0
    v_mfma_f32_16x16x32_bf16 v[84:87], v[124:127], a[180:183], v[84:87]
    s_add_u32 m0, s22, 12288
    ds_read_b64_tr_b16 v[114:115], v2 offset:6144
    v_cvt_pk_bf16_f32 v18, v72, v73
    v_mfma_f32_16x16x32_bf16 v[84:87], v[128:131], a[184:187], v[84:87]
    buffer_load_dwordx4 v6, s[4:7], s20 offen lds
    ds_read_b64_tr_b16 v[116:117], v3 offset:0
    v_mfma_f32_16x16x32_bf16 v[84:87], v[132:135], a[188:191], v[84:87]
    s_add_u32 s20, s20, 128
    ds_read_b64_tr_b16 v[118:119], v3 offset:6144
    v_exp_f32 v74, v74
    v_mfma_f32_16x16x32_bf16 v[92:95], v[124:127], a[204:207], v[92:95]
    v_exp_f32 v81, v81
    v_mfma_f32_16x16x32_bf16 v[92:95], v[128:131], a[208:211], v[92:95]
    s_add_u32 m0, s22, 13312
    ds_read_b64_tr_b16 v[120:121], v4 offset:0
    ds_read_b64_tr_b16 v[122:123], v4 offset:6144
    v_mfma_f32_16x16x32_bf16 v[92:95], v[132:135], a[212:215], v[92:95]
    buffer_load_dwordx4 v6, s[4:7], s20 offen lds
    v_mfma_f32_16x16x32_bf16 v[100:103], v[124:127], a[228:231], v[100:103]
    s_add_u32 s20, s20, 128
    ds_read_b64_tr_b16 v[124:125], v5 offset:0
    v_mfma_f32_16x16x32_bf16 v[44:47], v[64:67], v[32:35], v[44:47]
    s_add_u32 m0, s22, 14336
    ds_read_b64_tr_b16 v[126:127], v5 offset:6144
    v_cvt_pk_bf16_f32 v24, v80, v81
    v_mfma_f32_16x16x32_bf16 v[100:103], v[128:131], a[232:235], v[100:103]
    buffer_load_dwordx4 v6, s[4:7], s20 offen lds
    v_mfma_f32_16x16x32_bf16 v[100:103], v[132:135], a[236:239], v[100:103]
    v_cvt_pk_bf16_f32 v19, v74, v75
    s_add_u32 s20, s20, 12032
    s_waitcnt lgkmcnt(6)
    v_mfma_f32_16x16x32_bf16 v[160:163], v[112:115], v[14:17], 0
    v_fma_f32 v91, v91, s28, v11
    v_fma_f32 v92, v92, s28, v11
    v_mfma_f32_16x16x32_bf16 v[208:211], v[112:115], v[20:23], 0
    v_exp_f32 v91, v91
    v_mfma_f32_16x16x32_bf16 a[0:3], v[112:115], v[26:29], 0
    v_fma_f32 v90, v90, s28, v11
    v_fma_f32 v88, v88, s28, v11
    v_mfma_f32_16x16x32_bf16 a[48:51], v[112:115], v[32:35], 0
    ds_read_b64_tr_b16 v[130:131], v2 offset:7168
    s_waitcnt lgkmcnt(5)
    v_mfma_f32_16x16x32_bf16 v[164:167], v[116:119], v[14:17], 0
    ds_read_b64_tr_b16 v[128:129], v2 offset:1024
    v_fma_f32 v94, v94, s28, v11
    v_mfma_f32_16x16x32_bf16 v[212:215], v[116:119], v[20:23], 0
    ds_read_b64_tr_b16 v[112:113], v4 offset:1024
    v_fma_f32 v84, v84, s28, v10
    v_mfma_f32_16x16x32_bf16 a[4:7], v[116:119], v[26:29], 0
    ds_read_b64_tr_b16 v[134:135], v3 offset:7168
    v_fma_f32 v101, v101, s28, v12
    v_mfma_f32_16x16x32_bf16 a[52:55], v[116:119], v[32:35], 0
    ds_read_b64_tr_b16 v[132:133], v3 offset:1024
    s_waitcnt lgkmcnt(7)
    v_mfma_f32_16x16x32_bf16 v[168:171], v[120:123], v[14:17], 0
    v_exp_f32 v90, v90
    v_mfma_f32_16x16x32_bf16 v[216:219], v[120:123], v[20:23], 0
    ds_read_b64_tr_b16 v[116:117], v5 offset:1024
    v_fma_f32 v98, v98, s28, v12
    v_mfma_f32_16x16x32_bf16 a[8:11], v[120:123], v[26:29], 0
    ds_read_b64_tr_b16 v[114:115], v4 offset:7168
    v_mfma_f32_16x16x32_bf16 a[56:59], v[120:123], v[32:35], 0
    s_waitcnt lgkmcnt(7)
    ds_read_b64_tr_b16 v[118:119], v5 offset:7168
    v_fma_f32 v82, v82, s28, v10
    v_mfma_f32_16x16x32_bf16 v[172:175], v[124:127], v[14:17], 0
    v_fma_f32 v100, v100, s28, v12
    v_fma_f32 v79, v79, s28, v9
    v_mfma_f32_16x16x32_bf16 v[220:223], v[124:127], v[20:23], 0
    v_fma_f32 v93, v93, s28, v11
    v_fma_f32 v86, v86, s28, v10
    v_mfma_f32_16x16x32_bf16 a[12:15], v[124:127], v[26:29], 0
    s_add_u32 s39, s39, 12288
    ds_read_b64_tr_b16 v[122:123], v2 offset:8192
    v_fma_f32 v99, v99, s28, v12
    v_mfma_f32_16x16x32_bf16 a[60:63], v[124:127], v[32:35], 0
    s_waitcnt lgkmcnt(6)
    v_exp_f32 v88, v88
    v_mfma_f32_16x16x32_bf16 v[176:179], v[128:131], v[14:17], 0
    ds_read_b64_tr_b16 v[126:127], v3 offset:8192
    v_fma_f32 v96, v96, s28, v12
    v_mfma_f32_16x16x32_bf16 v[224:227], v[128:131], v[20:23], 0
    ds_read_b64_tr_b16 v[120:121], v2 offset:2048
    v_fma_f32 v77, v77, s28, v9
    v_mfma_f32_16x16x32_bf16 a[16:19], v[128:131], v[26:29], 0
    v_fma_f32 v83, v83, s28, v10
    v_fma_f32 v85, v85, s28, v10
    v_mfma_f32_16x16x32_bf16 a[64:67], v[128:131], v[32:35], 0
    s_waitcnt lgkmcnt(5)
    ds_read_b64_tr_b16 v[130:131], v4 offset:8192
    v_fma_f32 v103, v103, s28, v12
    v_mfma_f32_16x16x32_bf16 v[180:183], v[132:135], v[14:17], 0
    ds_read_b64_tr_b16 v[124:125], v3 offset:2048
    v_fma_f32 v89, v89, s28, v11
    v_mfma_f32_16x16x32_bf16 v[228:231], v[132:135], v[20:23], 0
    v_exp_f32 v83, v83
    v_mfma_f32_16x16x32_bf16 a[20:23], v[132:135], v[26:29], 0
    ds_read_b64_tr_b16 v[128:129], v4 offset:2048
    v_fma_f32 v102, v102, s28, v12
    v_mfma_f32_16x16x32_bf16 a[68:71], v[132:135], v[32:35], 0
    s_waitcnt lgkmcnt(6)
    ds_read_b64_tr_b16 v[134:135], v5 offset:8192
    v_fma_f32 v87, v87, s28, v10
    v_mfma_f32_16x16x32_bf16 v[184:187], v[112:115], v[14:17], 0
    ds_read_b64_tr_b16 v[132:133], v5 offset:2048
    v_cvt_pk_bf16_f32 v31, v90, v91
    v_mfma_f32_16x16x32_bf16 v[232:235], v[112:115], v[20:23], 0
    v_exp_f32 v92, v92
    v_mfma_f32_16x16x32_bf16 a[24:27], v[112:115], v[26:29], 0
    v_exp_f32 v103, v103
    v_mfma_f32_16x16x32_bf16 a[72:75], v[112:115], v[32:35], 0
    v_exp_f32 v98, v98
    v_mfma_f32_16x16x32_bf16 v[188:191], v[116:119], v[14:17], 0
    v_exp_f32 v77, v77
    v_mfma_f32_16x16x32_bf16 v[236:239], v[116:119], v[20:23], 0
    v_exp_f32 v96, v96
    v_mfma_f32_16x16x32_bf16 a[28:31], v[116:119], v[26:29], 0
    v_exp_f32 v86, v86
    v_mfma_f32_16x16x32_bf16 a[76:79], v[116:119], v[32:35], 0
    s_waitcnt lgkmcnt(3)
    v_exp_f32 v82, v82
    v_mfma_f32_16x16x32_bf16 v[192:195], v[120:123], v[14:17], 0
    v_exp_f32 v87, v87
    v_mfma_f32_16x16x32_bf16 v[240:243], v[120:123], v[20:23], 0
    v_fma_f32 v78, v78, s28, v9
    s_waitcnt vmcnt(3) lgkmcnt(0)
    v_mfma_f32_16x16x32_bf16 a[32:35], v[120:123], v[26:29], 0
    s_barrier
    v_mfma_f32_16x16x32_bf16 a[80:83], v[120:123], v[32:35], 0
    s_add_u32 m0, s22, 24576
    ds_read_b128 v[120:123], v0 offset:1024
    v_fma_f32 v95, v95, s28, v11
    v_mfma_f32_16x16x32_bf16 v[196:199], v[124:127], v[14:17], 0
    buffer_load_dwordx4 v6, s[8:11], s21 offen lds
    v_mfma_f32_16x16x32_bf16 v[244:247], v[124:127], v[20:23], 0
    s_add_u32 s21, s21, 128
    ds_read_b128 v[112:115], v0 offset:0
    v_fma_f32 v97, v97, s28, v12
    v_mfma_f32_16x16x32_bf16 a[36:39], v[124:127], v[26:29], 0
    s_add_u32 m0, s22, 25600
    ds_read_b128 v[116:119], v1 offset:0
    v_exp_f32 v100, v100
    v_mfma_f32_16x16x32_bf16 a[84:87], v[124:127], v[32:35], 0
    v_exp_f32 v85, v85
    v_mfma_f32_16x16x32_bf16 v[200:203], v[128:131], v[14:17], 0
    v_exp_f32 v89, v89
    v_mfma_f32_16x16x32_bf16 v[248:251], v[128:131], v[20:23], 0
    v_exp_f32 v97, v97
    v_mfma_f32_16x16x32_bf16 a[40:43], v[128:131], v[26:29], 0
    v_exp_f32 v79, v79
    v_mfma_f32_16x16x32_bf16 a[88:91], v[128:131], v[32:35], 0
    v_exp_f32 v101, v101
    v_mfma_f32_16x16x32_bf16 v[204:207], v[132:135], v[14:17], 0
    ds_read_b128 v[128:131], v0 offset:2048
    v_fma_f32 v76, v76, s28, v9
    v_mfma_f32_16x16x32_bf16 v[252:255], v[132:135], v[20:23], 0
    buffer_load_dwordx4 v6, s[8:11], s21 offen lds
    v_mfma_f32_16x16x32_bf16 a[44:47], v[132:135], v[26:29], 0
    s_add_u32 s21, s21, 128
    v_cvt_pk_bf16_f32 v30, v88, v89
    v_cvt_pk_bf16_f32 v25, v82, v83
    v_mfma_f32_16x16x32_bf16 a[92:95], v[132:135], v[32:35], 0
    s_waitcnt lgkmcnt(2)
    ds_read_b128 v[132:135], v1 offset:2048
    v_cvt_pk_bf16_f32 v36, v96, v97
    v_mfma_f32_16x16x32_bf16 v[72:75], v[112:115], a[144:147], 0
    s_add_u32 m0, s22, 26624
    ds_read_b128 v[124:127], v1 offset:1024
    s_waitcnt lgkmcnt(3)
    v_mfma_f32_16x16x32_bf16 v[72:75], v[116:119], a[148:151], v[72:75]
    buffer_load_dwordx4 v6, s[8:11], s21 offen lds
    v_mfma_f32_16x16x32_bf16 v[72:75], v[120:123], a[152:155], v[72:75]
    s_add_u32 s21, s21, 12032
    v_exp_f32 v102, v102
    v_mfma_f32_16x16x32_bf16 v[80:83], v[112:115], a[168:171], 0
    v_exp_f32 v94, v94
    v_mfma_f32_16x16x32_bf16 v[80:83], v[116:119], a[172:175], v[80:83]
    v_exp_f32 v78, v78
    v_mfma_f32_16x16x32_bf16 v[80:83], v[120:123], a[176:179], v[80:83]
    v_exp_f32 v99, v99
    v_mfma_f32_16x16x32_bf16 v[88:91], v[112:115], a[192:195], 0
    v_exp_f32 v84, v84
    v_mfma_f32_16x16x32_bf16 v[88:91], v[116:119], a[196:199], v[88:91]
    v_cvt_pk_bf16_f32 v23, v86, v87
    v_cvt_pk_bf16_f32 v37, v98, v99
    v_mfma_f32_16x16x32_bf16 v[88:91], v[120:123], a[200:203], v[88:91]
    s_add_u32 m0, s38, 0
    v_exp_f32 v76, v76
    v_mfma_f32_16x16x32_bf16 v[96:99], v[112:115], a[216:219], 0
    buffer_load_dwordx4 v6, s[12:15], s33 offen nt lds
    v_mfma_f32_16x16x32_bf16 v[96:99], v[116:119], a[220:223], v[96:99]
    s_add_u32 m0, s38, 1024
    ds_read_b128 v[112:115], v0 offset:6144
    v_cvt_pk_bf16_f32 v22, v84, v85
    v_mfma_f32_16x16x32_bf16 v[96:99], v[120:123], a[224:227], v[96:99]
    s_waitcnt lgkmcnt(1)
    v_exp_f32 v95, v95
    v_mfma_f32_16x16x32_bf16 v[72:75], v[124:127], a[156:159], v[72:75]
    buffer_load_dwordx4 v7, s[12:15], s33 offen nt lds
    v_mfma_f32_16x16x32_bf16 v[72:75], v[128:131], a[160:163], v[72:75]
    s_add_u32 s59, s33, 6144
    s_add_u32 m0, s38, 6144
    ds_read_b128 v[116:119], v1 offset:6144
    v_mfma_f32_16x16x32_bf16 v[72:75], v[132:135], a[164:167], v[72:75]
    v_mfma_f32_16x16x32_bf16 v[80:83], v[124:127], a[180:183], v[80:83]
    buffer_load_dwordx4 v6, s[12:15], s59 offen nt lds
    v_mfma_f32_16x16x32_bf16 v[80:83], v[128:131], a[184:187], v[80:83]
    s_add_u32 m0, s38, 7168
    v_cvt_pk_bf16_f32 v29, v94, v95
    v_cvt_pk_bf16_f32 v16, v76, v77
    v_mfma_f32_16x16x32_bf16 v[80:83], v[132:135], a[188:191], v[80:83]
    buffer_load_dwordx4 v7, s[12:15], s59 offen nt lds
    v_mfma_f32_16x16x32_bf16 v[88:91], v[124:127], a[204:207], v[88:91]
    ds_read_b128 v[120:123], v0 offset:7168
    s_add_u32 s58, s33, 128
    v_mfma_f32_16x16x32_bf16 v[88:91], v[128:131], a[208:211], v[88:91]
    s_add_u32 m0, s38, 2048
    v_exp_f32 v93, v93
    v_mfma_f32_16x16x32_bf16 v[88:91], v[132:135], a[212:215], v[88:91]
    buffer_load_dwordx4 v6, s[12:15], s58 offen nt lds
    v_mfma_f32_16x16x32_bf16 v[96:99], v[124:127], a[228:231], v[96:99]
    ds_read_b128 v[124:127], v1 offset:7168
    v_cvt_pk_bf16_f32 v17, v78, v79
    v_mfma_f32_16x16x32_bf16 v[96:99], v[128:131], a[232:235], v[96:99]
    ds_read_b128 v[128:131], v0 offset:8192
    v_cvt_pk_bf16_f32 v28, v92, v93
    v_mfma_f32_16x16x32_bf16 v[96:99], v[132:135], a[236:239], v[96:99]
    s_add_u32 m0, s38, 3072
    ds_read_b128 v[132:135], v1 offset:8192
    s_waitcnt lgkmcnt(4)
    v_mfma_f32_16x16x32_bf16 v[76:79], v[112:115], a[144:147], 0
    buffer_load_dwordx4 v7, s[12:15], s58 offen nt lds
    v_mfma_f32_16x16x32_bf16 v[76:79], v[116:119], a[148:151], v[76:79]
    s_add_u32 s59, s33, 6272
    v_cvt_pk_bf16_f32 v34, v100, v101
    s_add_u32 m0, s38, 8192
    v_mfma_f32_16x16x32_bf16 v[48:51], v[52:55], v[16:19], v[44:47]
    buffer_load_dwordx4 v6, s[12:15], s59 offen nt lds
    v_mfma_f32_16x16x32_bf16 v[48:51], v[56:59], v[22:25], v[48:51]
    s_add_u32 m0, s38, 9216
    v_cvt_pk_bf16_f32 v35, v102, v103
    v_mfma_f32_16x16x32_bf16 v[48:51], v[60:63], v[28:31], v[48:51]
    buffer_load_dwordx4 v7, s[12:15], s59 offen nt lds
    v_mfma_f32_16x16x32_bf16 v[48:51], v[64:67], v[34:37], v[48:51]
    s_add_u32 s58, s33, 256
    s_add_u32 m0, s38, 4096
    s_waitcnt lgkmcnt(3)
    v_mfma_f32_16x16x32_bf16 v[76:79], v[120:123], a[152:155], v[76:79]
    buffer_load_dwordx4 v6, s[12:15], s58 offen nt lds
    v_mfma_f32_16x16x32_bf16 v[84:87], v[112:115], a[168:171], 0
    s_add_u32 m0, s38, 5120
    v_add_u32 v8, 10240, v8
    v_cmp_lt_f32 vcc, s29, v48
    v_mfma_f32_16x16x32_bf16 v[84:87], v[116:119], a[172:175], v[84:87]
    buffer_load_dwordx4 v7, s[12:15], s58 offen nt lds
    v_mfma_f32_16x16x32_bf16 v[84:87], v[120:123], a[176:179], v[84:87]
    s_waitcnt vmcnt(19) lgkmcnt(0)
    s_barrier
    v_mfma_f32_16x16x32_bf16 v[92:95], v[112:115], a[192:195], 0
    s_cbranch_vccnz L_rs_start4b
L_ret_start4b:
    v_fma_f32 v75, v75, s28, v9
    v_mfma_f32_16x16x32_bf16 v[92:95], v[116:119], a[196:199], v[92:95]
    v_fma_f32 v72, v72, s28, v9
    v_fma_f32 v80, v80, s28, v10
    v_mfma_f32_16x16x32_bf16 v[92:95], v[120:123], a[200:203], v[92:95]
    s_add_u32 m0, s22, 0
    v_exp_f32 v80, v80
    v_mfma_f32_16x16x32_bf16 v[100:103], v[112:115], a[216:219], 0
    v_exp_f32 v72, v72
    v_mfma_f32_16x16x32_bf16 v[100:103], v[116:119], a[220:223], v[100:103]
    ds_read_b64_tr_b16 v[112:113], v2 offset:18432
    v_mfma_f32_16x16x32_bf16 v[100:103], v[120:123], a[224:227], v[100:103]
    ds_read_b64_tr_b16 v[114:115], v2 offset:12288
    buffer_load_dwordx4 v6, s[4:7], s20 offen lds
    v_mfma_f32_16x16x32_bf16 v[76:79], v[124:127], a[156:159], v[76:79]
    ds_read_b64_tr_b16 v[116:117], v3 offset:18432
    v_fma_f32 v81, v81, s28, v10
    v_mfma_f32_16x16x32_bf16 v[76:79], v[128:131], a[160:163], v[76:79]
    v_exp_f32 v81, v81
    v_mfma_f32_16x16x32_bf16 v[76:79], v[132:135], a[164:167], v[76:79]
    ds_read_b64_tr_b16 v[118:119], v3 offset:12288
    v_fma_f32 v73, v73, s28, v9
    v_mfma_f32_16x16x32_bf16 v[84:87], v[124:127], a[180:183], v[84:87]
    s_add_u32 s20, s20, 128
    v_exp_f32 v73, v73
    v_mfma_f32_16x16x32_bf16 v[84:87], v[128:131], a[184:187], v[84:87]
    s_add_u32 m0, s22, 1024
    v_exp_f32 v75, v75
    v_mfma_f32_16x16x32_bf16 v[84:87], v[132:135], a[188:191], v[84:87]
    buffer_load_dwordx4 v6, s[4:7], s20 offen lds
    v_mfma_f32_16x16x32_bf16 v[92:95], v[124:127], a[204:207], v[92:95]
    ds_read_b64_tr_b16 v[120:121], v4 offset:18432
    v_fma_f32 v74, v74, s28, v9
    v_mfma_f32_16x16x32_bf16 v[92:95], v[128:131], a[208:211], v[92:95]
    s_add_u32 s20, s20, 128
    v_exp_f32 v74, v74
    v_mfma_f32_16x16x32_bf16 v[92:95], v[132:135], a[212:215], v[92:95]
    s_add_u32 m0, s22, 2048
    ds_read_b64_tr_b16 v[122:123], v4 offset:12288
    v_cvt_pk_bf16_f32 v20, v80, v81
    v_mfma_f32_16x16x32_bf16 v[100:103], v[124:127], a[228:231], v[100:103]
    buffer_load_dwordx4 v6, s[4:7], s20 offen lds
    v_mfma_f32_16x16x32_bf16 v[100:103], v[128:131], a[232:235], v[100:103]
    ds_read_b64_tr_b16 v[124:125], v5 offset:18432
    v_cvt_pk_bf16_f32 v14, v72, v73
    v_mfma_f32_16x16x32_bf16 v[100:103], v[132:135], a[236:239], v[100:103]
    s_add_u32 s20, s20, 12032
    ds_read_b64_tr_b16 v[126:127], v5 offset:12288
    v_cvt_pk_bf16_f32 v15, v74, v75
    s_branch L_loop4
L_loop5:
    .p2align 6
L_loop5w0:
    s_waitcnt lgkmcnt(6)
    v_mfma_f32_16x16x32_bf16 v[160:163], v[112:115], v[16:19], v[160:163]
    ds_read_b64_tr_b16 v[132:133], v3 offset:19456
    v_fma_f32 v98, v98, s28, v12
    v_mfma_f32_16x16x32_bf16 v[208:211], v[112:115], v[22:25], v[208:211]
    ds_read_b64_tr_b16 v[130:131], v2 offset:13312
    v_mfma_f32_16x16x32_bf16 a[0:3], v[112:115], v[28:31], a[0:3]
    v_fma_f32 v108, v108, s28, v13
    v_fma_f32 v79, v79, s28, v9
    v_mfma_f32_16x16x32_bf16 a[48:51], v[112:115], v[34:37], a[48:51]
    v_fma_f32 v96, v96, s28, v12
    v_mfma_f32_16x16x32_bf16 a[96:99], v[112:115], v[40:43], a[96:99]
    ds_read_b128 v[144:147], v8 offset:0
    s_waitcnt lgkmcnt(7)
    v_mfma_f32_16x16x32_bf16 v[164:167], v[116:119], v[16:19], v[164:167]
    ds_read_b64_tr_b16 v[114:115], v4 offset:13312
    v_fma_f32 v90, v90, s28, v11
    v_mfma_f32_16x16x32_bf16 v[212:215], v[116:119], v[22:25], v[212:215]
    ds_read_b64_tr_b16 v[112:113], v4 offset:19456
    v_fma_f32 v91, v91, s28, v11
    v_mfma_f32_16x16x32_bf16 a[4:7], v[116:119], v[28:31], a[4:7]
    v_fma_f32 v89, v89, s28, v11
    v_fma_f32 v101, v101, s28, v12
    v_mfma_f32_16x16x32_bf16 a[52:55], v[116:119], v[34:37], a[52:55]
    v_fma_f32 v76, v76, s28, v9
    v_fma_f32 v100, v100, s28, v12
    v_mfma_f32_16x16x32_bf16 a[100:103], v[116:119], v[40:43], a[100:103]
    s_waitcnt lgkmcnt(5)
    ds_read_b64_tr_b16 v[128:129], v2 offset:19456
    v_fma_f32 v97, v97, s28, v12
    v_mfma_f32_16x16x32_bf16 v[168:171], v[120:123], v[16:19], v[168:171]
    ds_read_b128 v[148:151], v8 offset:1024
    v_fma_f32 v106, v106, s28, v13
    v_mfma_f32_16x16x32_bf16 v[216:219], v[120:123], v[22:25], v[216:219]
    ds_read_b64_tr_b16 v[134:135], v3 offset:13312
    v_fma_f32 v84, v84, s28, v10
    v_mfma_f32_16x16x32_bf16 a[8:11], v[120:123], v[28:31], a[8:11]
    ds_read_b64_tr_b16 v[118:119], v5 offset:13312
    v_fma_f32 v105, v105, s28, v13
    v_mfma_f32_16x16x32_bf16 a[56:59], v[120:123], v[34:37], a[56:59]
    v_fma_f32 v107, v107, s28, v13
    v_fma_f32 v109, v109, s28, v13
    v_mfma_f32_16x16x32_bf16 a[104:107], v[120:123], v[40:43], a[104:107]
    v_exp_f32 v90, v90
    v_mfma_f32_16x16x32_bf16 v[172:175], v[124:127], v[16:19], v[172:175]
    v_fma_f32 v88, v88, s28, v11
    v_fma_f32 v93, v93, s28, v11
    v_mfma_f32_16x16x32_bf16 v[220:223], v[124:127], v[22:25], v[220:223]
    s_add_u32 s39, s39, 12288
    ds_read_b64_tr_b16 v[116:117], v5 offset:19456
    v_fma_f32 v77, v77, s28, v9
    v_mfma_f32_16x16x32_bf16 a[12:15], v[124:127], v[28:31], a[12:15]
    v_exp_f32 v89, v89
    v_mfma_f32_16x16x32_bf16 a[60:63], v[124:127], v[34:37], a[60:63]
    v_exp_f32 v106, v106
    v_mfma_f32_16x16x32_bf16 a[108:111], v[124:127], v[40:43], a[108:111]
    s_waitcnt lgkmcnt(4)
    v_exp_f32 v105, v105
    v_mfma_f32_16x16x32_bf16 v[176:179], v[128:131], v[16:19], v[176:179]
    v_fma_f32 v92, v92, s28, v11
    v_mfma_f32_16x16x32_bf16 v[224:227], v[128:131], v[22:25], v[224:227]
    v_fma_f32 v86, v86, s28, v10
    v_fma_f32 v87, v87, s28, v10
    v_mfma_f32_16x16x32_bf16 a[16:19], v[128:131], v[28:31], a[16:19]
    v_mfma_f32_16x16x32_bf16 a[64:67], v[128:131], v[34:37], a[64:67]
    v_exp_f32 v109, v109
    v_mfma_f32_16x16x32_bf16 a[112:115], v[128:131], v[40:43], a[112:115]
    s_waitcnt lgkmcnt(1)
    ds_read_b64_tr_b16 v[122:123], v2 offset:14336
    v_mfma_f32_16x16x32_bf16 v[180:183], v[132:135], v[16:19], v[180:183]
    ds_read_b64_tr_b16 v[124:125], v3 offset:20480
    v_mfma_f32_16x16x32_bf16 v[228:231], v[132:135], v[22:25], v[228:231]
    v_fma_f32 v78, v78, s28, v9
    v_mfma_f32_16x16x32_bf16 a[20:23], v[132:135], v[28:31], a[20:23]
    ds_read_b64_tr_b16 v[120:121], v2 offset:20480
    v_fma_f32 v102, v102, s28, v12
    v_mfma_f32_16x16x32_bf16 a[68:71], v[132:135], v[34:37], a[68:71]
    ds_read_b64_tr_b16 v[130:131], v4 offset:14336
    v_fma_f32 v85, v85, s28, v10
    v_mfma_f32_16x16x32_bf16 a[116:119], v[132:135], v[40:43], a[116:119]
    v_mfma_f32_16x16x32_bf16 v[184:187], v[112:115], v[16:19], v[184:187]
    ds_read_b64_tr_b16 v[132:133], v5 offset:20480
    v_mfma_f32_16x16x32_bf16 v[232:235], v[112:115], v[22:25], v[232:235]
    ds_read_b64_tr_b16 v[134:135], v5 offset:14336
    v_mfma_f32_16x16x32_bf16 a[24:27], v[112:115], v[28:31], a[24:27]
    ds_read_b64_tr_b16 v[128:129], v4 offset:20480
    v_fma_f32 v103, v103, s28, v12
    v_mfma_f32_16x16x32_bf16 a[72:75], v[112:115], v[34:37], a[72:75]
    ds_read_b64_tr_b16 v[126:127], v3 offset:14336
    v_mfma_f32_16x16x32_bf16 a[120:123], v[112:115], v[40:43], a[120:123]
    s_waitcnt lgkmcnt(7)
    v_exp_f32 v96, v96
    v_mfma_f32_16x16x32_bf16 v[188:191], v[116:119], v[16:19], v[188:191]
    v_exp_f32 v76, v76
    v_mfma_f32_16x16x32_bf16 v[236:239], v[116:119], v[22:25], v[236:239]
    v_exp_f32 v97, v97
    v_mfma_f32_16x16x32_bf16 a[28:31], v[116:119], v[28:31], a[28:31]
    buffer_store_dwordx4 v[144:147], v6, s[16:19], s24 offen sc0 sc1 nt
    v_exp_f32 v98, v98
    v_mfma_f32_16x16x32_bf16 a[76:79], v[116:119], v[34:37], a[76:79]
    v_exp_f32 v84, v84
    v_mfma_f32_16x16x32_bf16 a[124:127], v[116:119], v[40:43], a[124:127]
    s_waitcnt lgkmcnt(3)
    v_exp_f32 v101, v101
    v_mfma_f32_16x16x32_bf16 v[192:195], v[120:123], v[16:19], v[192:195]
    v_exp_f32 v79, v79
    v_mfma_f32_16x16x32_bf16 v[240:243], v[120:123], v[22:25], v[240:243]
    v_fma_f32 v99, v99, s28, v12
    s_waitcnt vmcnt(11) lgkmcnt(0)
    v_mfma_f32_16x16x32_bf16 a[32:35], v[120:123], v[28:31], a[32:35]
    s_add_u32 m0, s22, 36864
    v_fma_f32 v95, v95, s28, v11
    v_mfma_f32_16x16x32_bf16 a[80:83], v[120:123], v[34:37], a[80:83]
    s_barrier
    v_mfma_f32_16x16x32_bf16 a[128:131], v[120:123], v[40:43], a[128:131]
    buffer_load_dwordx4 v6, s[8:11], s21 offen lds
    v_mfma_f32_16x16x32_bf16 v[196:199], v[124:127], v[16:19], v[196:199]
    s_add_u32 s21, s21, 128
    s_add_u32 m0, s22, 37888
    ds_read_b128 v[116:119], v1 offset:12288
    v_mfma_f32_16x16x32_bf16 v[244:247], v[124:127], v[22:25], v[244:247]
    buffer_load_dwordx4 v6, s[8:11], s21 offen lds
    v_mfma_f32_16x16x32_bf16 a[36:39], v[124:127], v[28:31], a[36:39]
    v_fma_f32 v111, v111, s28, v13
    v_mfma_f32_16x16x32_bf16 a[84:87], v[124:127], v[34:37], a[84:87]
    ds_read_b128 v[112:115], v0 offset:12288
    v_mfma_f32_16x16x32_bf16 a[132:135], v[124:127], v[40:43], a[132:135]
    v_exp_f32 v91, v91
    v_mfma_f32_16x16x32_bf16 v[200:203], v[128:131], v[16:19], v[200:203]
    v_exp_f32 v92, v92
    v_mfma_f32_16x16x32_bf16 v[248:251], v[128:131], v[22:25], v[248:251]
    ds_read_b128 v[120:123], v0 offset:13312
    v_fma_f32 v104, v104, s28, v13
    v_mfma_f32_16x16x32_bf16 a[40:43], v[128:131], v[28:31], a[40:43]
    v_exp_f32 v88, v88
    v_mfma_f32_16x16x32_bf16 a[88:91], v[128:131], v[34:37], a[88:91]
    v_exp_f32 v93, v93
    v_mfma_f32_16x16x32_bf16 a[136:139], v[128:131], v[40:43], a[136:139]
    v_exp_f32 v104, v104
    v_mfma_f32_16x16x32_bf16 v[204:207], v[132:135], v[16:19], v[204:207]
    s_add_u32 s21, s21, 128
    v_exp_f32 v85, v85
    v_mfma_f32_16x16x32_bf16 v[252:255], v[132:135], v[22:25], v[252:255]
    s_add_u32 m0, s22, 38912
    v_exp_f32 v107, v107
    v_mfma_f32_16x16x32_bf16 a[44:47], v[132:135], v[28:31], a[44:47]
    ds_read_b128 v[128:131], v0 offset:14336
    v_mfma_f32_16x16x32_bf16 a[92:95], v[132:135], v[34:37], a[92:95]
    buffer_load_dwordx4 v6, s[8:11], s21 offen lds
    v_mfma_f32_16x16x32_bf16 a[140:143], v[132:135], v[40:43], a[140:143]
    s_waitcnt lgkmcnt(2)
    v_exp_f32 v78, v78
    v_mfma_f32_16x16x32_bf16 v[72:75], v[112:115], a[144:147], 0
    v_fma_f32 v110, v110, s28, v13
    v_mfma_f32_16x16x32_bf16 v[72:75], v[116:119], a[148:151], v[72:75]
    s_waitcnt lgkmcnt(1)
    v_cvt_pk_bf16_f32 v26, v88, v89
    v_mfma_f32_16x16x32_bf16 v[72:75], v[120:123], a[152:155], v[72:75]
    v_cvt_pk_bf16_f32 v27, v90, v91
    v_cvt_pk_bf16_f32 v28, v92, v93
    v_mfma_f32_16x16x32_bf16 v[80:83], v[112:115], a[168:171], 0
    v_exp_f32 v99, v99
    v_mfma_f32_16x16x32_bf16 v[80:83], v[116:119], a[172:175], v[80:83]
    ds_read_b128 v[124:127], v1 offset:13312
    v_mfma_f32_16x16x32_bf16 v[80:83], v[120:123], a[176:179], v[80:83]
    v_exp_f32 v108, v108
    v_mfma_f32_16x16x32_bf16 v[88:91], v[112:115], a[192:195], 0
    ds_read_b128 v[132:135], v1 offset:14336
    v_cvt_pk_bf16_f32 v32, v96, v97
    v_mfma_f32_16x16x32_bf16 v[88:91], v[116:119], a[196:199], v[88:91]
    buffer_store_dwordx4 v[148:151], v7, s[16:19], s24 offen sc0 sc1 nt
    v_cvt_pk_bf16_f32 v33, v98, v99
    v_mfma_f32_16x16x32_bf16 v[88:91], v[120:123], a[200:203], v[88:91]
    v_exp_f32 v102, v102
    v_mfma_f32_16x16x32_bf16 v[96:99], v[112:115], a[216:219], 0
    v_exp_f32 v86, v86
    v_mfma_f32_16x16x32_bf16 v[96:99], v[116:119], a[220:223], v[96:99]
    v_exp_f32 v77, v77
    v_mfma_f32_16x16x32_bf16 v[96:99], v[120:123], a[224:227], v[96:99]
    v_cvt_pk_bf16_f32 v39, v106, v107
    v_cvt_pk_bf16_f32 v38, v104, v105
    v_mfma_f32_16x16x32_bf16 v[104:107], v[112:115], a[240:243], 0
    v_mfma_f32_16x16x32_bf16 v[104:107], v[116:119], a[244:247], v[104:107]
    s_add_u32 s21, s21, 12032
    v_exp_f32 v110, v110
    v_mfma_f32_16x16x32_bf16 v[104:107], v[120:123], a[248:251], v[104:107]
    s_waitcnt lgkmcnt(1)
    v_exp_f32 v103, v103
    v_mfma_f32_16x16x32_bf16 v[72:75], v[124:127], a[156:159], v[72:75]
    v_fma_f32 v94, v94, s28, v11
    v_cvt_pk_bf16_f32 v35, v102, v103
    v_mfma_f32_16x16x32_bf16 v[72:75], v[128:131], a[160:163], v[72:75]
    s_waitcnt lgkmcnt(0)
    ds_read_b128 v[116:119], v1 offset:18432
    v_mfma_f32_16x16x32_bf16 v[72:75], v[132:135], a[164:167], v[72:75]
    v_exp_f32 v87, v87
    v_mfma_f32_16x16x32_bf16 v[80:83], v[124:127], a[180:183], v[80:83]
    v_cvt_pk_bf16_f32 v17, v78, v79
    v_cvt_pk_bf16_f32 v16, v76, v77
    v_mfma_f32_16x16x32_bf16 v[80:83], v[128:131], a[184:187], v[80:83]
    ds_read_b128 v[112:115], v0 offset:18432
    v_mfma_f32_16x16x32_bf16 v[80:83], v[132:135], a[188:191], v[80:83]
    v_exp_f32 v95, v95
    v_mfma_f32_16x16x32_bf16 v[88:91], v[124:127], a[204:207], v[88:91]
    v_cvt_pk_bf16_f32 v22, v84, v85
    v_mfma_f32_16x16x32_bf16 v[88:91], v[128:131], a[208:211], v[88:91]
    v_mfma_f32_16x16x32_bf16 v[88:91], v[132:135], a[212:215], v[88:91]
    v_exp_f32 v111, v111
    v_mfma_f32_16x16x32_bf16 v[96:99], v[124:127], a[228:231], v[96:99]
    v_mfma_f32_16x16x32_bf16 v[96:99], v[128:131], a[232:235], v[96:99]
    ds_read_b128 v[120:123], v0 offset:19456
    v_mfma_f32_16x16x32_bf16 v[96:99], v[132:135], a[236:239], v[96:99]
    s_add_u32 m0, s23, 0
    v_exp_f32 v100, v100
    v_mfma_f32_16x16x32_bf16 v[44:47], v[52:55], v[14:17], v[48:51]
    v_exp_f32 v94, v94
    v_mfma_f32_16x16x32_bf16 v[104:107], v[124:127], a[252:255], v[104:107]
    ds_read_b128 v[124:127], v1 offset:19456
    v_cvt_pk_bf16_f32 v40, v108, v109
    v_mfma_f32_16x16x32_bf16 v[104:107], v[128:131], v[136:139], v[104:107]
    ds_read_b128 v[128:131], v0 offset:20480
    v_cvt_pk_bf16_f32 v23, v86, v87
    v_mfma_f32_16x16x32_bf16 v[104:107], v[132:135], v[140:143], v[104:107]
    s_waitcnt lgkmcnt(3)
    ds_read_b128 v[132:135], v1 offset:20480
    v_cvt_pk_bf16_f32 v29, v94, v95
    v_mfma_f32_16x16x32_bf16 v[76:79], v[112:115], a[144:147], 0
    buffer_load_dwordx4 v6, s[12:15], s25 offen nt lds
    v_mfma_f32_16x16x32_bf16 v[44:47], v[56:59], v[20:23], v[44:47]
    s_add_u32 m0, s23, 1024
    v_cvt_pk_bf16_f32 v34, v100, v101
    v_mfma_f32_16x16x32_bf16 v[44:47], v[60:63], v[26:29], v[44:47]
    v_cvt_pk_bf16_f32 v41, v110, v111
    v_mfma_f32_16x16x32_bf16 v[76:79], v[116:119], a[148:151], v[76:79]
    buffer_load_dwordx4 v7, s[12:15], s25 offen nt lds
    v_mfma_f32_16x16x32_bf16 v[44:47], v[64:67], v[32:35], v[44:47]
    s_bitcmp1_b32 s27, 0
    v_mfma_f32_16x16x32_bf16 v[44:47], v[68:71], v[38:41], v[44:47]
    s_waitcnt lgkmcnt(3)
    v_mfma_f32_16x16x32_bf16 v[76:79], v[120:123], a[152:155], v[76:79]
    v_mfma_f32_16x16x32_bf16 v[84:87], v[112:115], a[168:171], 0
    s_cselect_b32 s26, s49, 128
    s_lshr_b32 s27, s27, 1
    v_mfma_f32_16x16x32_bf16 v[84:87], v[116:119], a[172:175], v[84:87]
    s_nop 1
    v_cmp_lt_f32 vcc, s29, v44
    v_mfma_f32_16x16x32_bf16 v[84:87], v[120:123], a[176:179], v[84:87]
    s_add_u32 s24, s24, s26
    s_add_u32 s25, s25, s26
    s_waitcnt vmcnt(14) lgkmcnt(0)
    v_mfma_f32_16x16x32_bf16 v[92:95], v[112:115], a[192:195], 0
    s_barrier
    v_mfma_f32_16x16x32_bf16 v[92:95], v[116:119], a[196:199], v[92:95]
    s_cbranch_vccnz L_rs_loop5w0a
L_ret_loop5w0a:
    v_fma_f32 v75, v75, s28, v9
    v_mfma_f32_16x16x32_bf16 v[92:95], v[120:123], a[200:203], v[92:95]
    v_exp_f32 v75, v75
    v_mfma_f32_16x16x32_bf16 v[100:103], v[112:115], a[216:219], 0
    v_fma_f32 v83, v83, s28, v10
    v_fma_f32 v74, v74, s28, v9
    v_mfma_f32_16x16x32_bf16 v[100:103], v[116:119], a[220:223], v[100:103]
    v_fma_f32 v81, v81, s28, v10
    v_fma_f32 v72, v72, s28, v9
    v_mfma_f32_16x16x32_bf16 v[100:103], v[120:123], a[224:227], v[100:103]
    v_exp_f32 v74, v74
    v_mfma_f32_16x16x32_bf16 v[108:111], v[112:115], a[240:243], 0
    v_exp_f32 v81, v81
    v_mfma_f32_16x16x32_bf16 v[108:111], v[116:119], a[244:247], v[108:111]
    ds_read_b64_tr_b16 v[112:113], v2 offset:0
    v_fma_f32 v80, v80, s28, v10
    v_mfma_f32_16x16x32_bf16 v[108:111], v[120:123], a[248:251], v[108:111]
    s_add_u32 m0, s22, 12288
    ds_read_b64_tr_b16 v[114:115], v2 offset:6144
    v_fma_f32 v82, v82, s28, v10
    v_mfma_f32_16x16x32_bf16 v[76:79], v[124:127], a[156:159], v[76:79]
    buffer_load_dwordx4 v6, s[4:7], s20 offen lds
    v_mfma_f32_16x16x32_bf16 v[76:79], v[128:131], a[160:163], v[76:79]
    s_add_u32 s20, s20, 128
    v_exp_f32 v80, v80
    v_mfma_f32_16x16x32_bf16 v[76:79], v[132:135], a[164:167], v[76:79]
    s_add_u32 m0, s22, 13312
    ds_read_b64_tr_b16 v[116:117], v3 offset:0
    v_mfma_f32_16x16x32_bf16 v[84:87], v[124:127], a[180:183], v[84:87]
    v_exp_f32 v83, v83
    v_mfma_f32_16x16x32_bf16 v[84:87], v[128:131], a[184:187], v[84:87]
    buffer_load_dwordx4 v6, s[4:7], s20 offen lds
    v_mfma_f32_16x16x32_bf16 v[84:87], v[132:135], a[188:191], v[84:87]
    s_add_u32 s20, s20, 128
    ds_read_b64_tr_b16 v[118:119], v3 offset:6144
    v_cvt_pk_bf16_f32 v24, v80, v81
    v_mfma_f32_16x16x32_bf16 v[92:95], v[124:127], a[204:207], v[92:95]
    s_add_u32 m0, s22, 14336
    v_exp_f32 v82, v82
    v_mfma_f32_16x16x32_bf16 v[92:95], v[128:131], a[208:211], v[92:95]
    ds_read_b64_tr_b16 v[120:121], v4 offset:0
    v_fma_f32 v73, v73, s28, v9
    v_mfma_f32_16x16x32_bf16 v[92:95], v[132:135], a[212:215], v[92:95]
    ds_read_b64_tr_b16 v[122:123], v4 offset:6144
    v_cvt_pk_bf16_f32 v25, v82, v83
    v_mfma_f32_16x16x32_bf16 v[100:103], v[124:127], a[228:231], v[100:103]
    v_exp_f32 v72, v72
    v_mfma_f32_16x16x32_bf16 v[100:103], v[128:131], a[232:235], v[100:103]
    v_exp_f32 v73, v73
    v_mfma_f32_16x16x32_bf16 v[100:103], v[132:135], a[236:239], v[100:103]
    buffer_load_dwordx4 v6, s[4:7], s20 offen lds
    v_mfma_f32_16x16x32_bf16 v[108:111], v[124:127], a[252:255], v[108:111]
    ds_read_b64_tr_b16 v[124:125], v5 offset:0
    v_cvt_pk_bf16_f32 v18, v72, v73
    v_mfma_f32_16x16x32_bf16 v[108:111], v[128:131], v[136:139], v[108:111]
    s_add_u32 s20, s20, 12032
    v_mfma_f32_16x16x32_bf16 v[108:111], v[132:135], v[140:143], v[108:111]
    ds_read_b64_tr_b16 v[126:127], v5 offset:6144
    v_cvt_pk_bf16_f32 v19, v74, v75
    s_waitcnt lgkmcnt(6)
    v_mfma_f32_16x16x32_bf16 v[160:163], v[112:115], v[14:17], v[160:163]
    ds_read_b64_tr_b16 v[130:131], v2 offset:7168
    v_mfma_f32_16x16x32_bf16 v[208:211], v[112:115], v[20:23], v[208:211]
    v_fma_f32 v88, v88, s28, v11
    v_fma_f32 v85, v85, s28, v10
    v_mfma_f32_16x16x32_bf16 a[0:3], v[112:115], v[26:29], a[0:3]
    v_fma_f32 v105, v105, s28, v13
    v_fma_f32 v99, v99, s28, v12
    v_mfma_f32_16x16x32_bf16 a[48:51], v[112:115], v[32:35], a[48:51]
    ds_read_b64_tr_b16 v[132:133], v3 offset:1024
    v_mfma_f32_16x16x32_bf16 a[96:99], v[112:115], v[38:41], a[96:99]
    ds_read_b64_tr_b16 v[112:113], v4 offset:1024
    s_waitcnt lgkmcnt(7)
    v_mfma_f32_16x16x32_bf16 v[164:167], v[116:119], v[14:17], v[164:167]
    ds_read_b64_tr_b16 v[134:135], v3 offset:7168
    v_fma_f32 v90, v90, s28, v11
    v_mfma_f32_16x16x32_bf16 v[212:215], v[116:119], v[20:23], v[212:215]
    v_fma_f32 v89, v89, s28, v11
    v_mfma_f32_16x16x32_bf16 a[4:7], v[116:119], v[26:29], a[4:7]
    v_fma_f32 v106, v106, s28, v13
    v_fma_f32 v98, v98, s28, v12
    v_mfma_f32_16x16x32_bf16 a[52:55], v[116:119], v[32:35], a[52:55]
    v_exp_f32 v99, v99
    v_mfma_f32_16x16x32_bf16 a[100:103], v[116:119], v[38:41], a[100:103]
    s_waitcnt lgkmcnt(4)
    ds_read_b64_tr_b16 v[128:129], v2 offset:1024
    v_fma_f32 v101, v101, s28, v12
    v_mfma_f32_16x16x32_bf16 v[168:171], v[120:123], v[14:17], v[168:171]
    ds_read_b64_tr_b16 v[116:117], v5 offset:1024
    v_mfma_f32_16x16x32_bf16 v[216:219], v[120:123], v[20:23], v[216:219]
    v_fma_f32 v97, v97, s28, v12
    v_mfma_f32_16x16x32_bf16 a[8:11], v[120:123], v[26:29], a[8:11]
    v_fma_f32 v109, v109, s28, v13
    v_mfma_f32_16x16x32_bf16 a[56:59], v[120:123], v[32:35], a[56:59]
    v_fma_f32 v77, v77, s28, v9
    v_fma_f32 v93, v93, s28, v11
    v_mfma_f32_16x16x32_bf16 a[104:107], v[120:123], v[38:41], a[104:107]
    ds_read_b64_tr_b16 v[120:121], v2 offset:2048
    v_fma_f32 v111, v111, s28, v13
    v_mfma_f32_16x16x32_bf16 v[172:175], v[124:127], v[14:17], v[172:175]
    v_exp_f32 v98, v98
    v_mfma_f32_16x16x32_bf16 v[220:223], v[124:127], v[20:23], v[220:223]
    s_add_u32 s39, s39, 12288
    ds_read_b128 v[144:147], v8 offset:2048
    v_fma_f32 v108, v108, s28, v13
    v_mfma_f32_16x16x32_bf16 a[12:15], v[124:127], v[26:29], a[12:15]
    ds_read_b64_tr_b16 v[114:115], v4 offset:7168
    v_fma_f32 v103, v103, s28, v12
    v_mfma_f32_16x16x32_bf16 a[60:63], v[124:127], v[32:35], a[60:63]
    ds_read_b128 v[148:151], v8 offset:3072
    v_fma_f32 v100, v100, s28, v12
    v_mfma_f32_16x16x32_bf16 a[108:111], v[124:127], v[38:41], a[108:111]
    s_waitcnt lgkmcnt(5)
    ds_read_b64_tr_b16 v[126:127], v3 offset:8192
    v_fma_f32 v96, v96, s28, v12
    v_mfma_f32_16x16x32_bf16 v[176:179], v[128:131], v[14:17], v[176:179]
    ds_read_b64_tr_b16 v[124:125], v3 offset:2048
    v_fma_f32 v107, v107, s28, v13
    v_mfma_f32_16x16x32_bf16 v[224:227], v[128:131], v[20:23], v[224:227]
    ds_read_b64_tr_b16 v[118:119], v5 offset:7168
    v_mfma_f32_16x16x32_bf16 a[16:19], v[128:131], v[26:29], a[16:19]
    v_exp_f32 v90, v90
    v_mfma_f32_16x16x32_bf16 a[64:67], v[128:131], v[32:35], a[64:67]
    v_fma_f32 v76, v76, s28, v9
    v_fma_f32 v86, v86, s28, v10
    v_mfma_f32_16x16x32_bf16 a[112:115], v[128:131], v[38:41], a[112:115]
    ds_read_b64_tr_b16 v[128:129], v4 offset:2048
    v_mfma_f32_16x16x32_bf16 v[180:183], v[132:135], v[14:17], v[180:183]
    v_fma_f32 v92, v92, s28, v11
    v_fma_f32 v79, v79, s28, v9
    v_mfma_f32_16x16x32_bf16 v[228:231], v[132:135], v[20:23], v[228:231]
    ds_read_b64_tr_b16 v[122:123], v2 offset:8192
    v_fma_f32 v95, v95, s28, v11
    v_mfma_f32_16x16x32_bf16 a[20:23], v[132:135], v[26:29], a[20:23]
    v_exp_f32 v103, v103
    v_mfma_f32_16x16x32_bf16 a[68:71], v[132:135], v[32:35], a[68:71]
    ds_read_b64_tr_b16 v[130:131], v4 offset:8192
    v_mfma_f32_16x16x32_bf16 a[116:119], v[132:135], v[38:41], a[116:119]
    s_waitcnt lgkmcnt(5)
    v_exp_f32 v109, v109
    v_mfma_f32_16x16x32_bf16 v[184:187], v[112:115], v[14:17], v[184:187]
    ds_read_b64_tr_b16 v[134:135], v5 offset:8192
    v_mfma_f32_16x16x32_bf16 v[232:235], v[112:115], v[20:23], v[232:235]
    ds_read_b64_tr_b16 v[132:133], v5 offset:2048
    v_mfma_f32_16x16x32_bf16 a[24:27], v[112:115], v[26:29], a[24:27]
    v_exp_f32 v97, v97
    v_mfma_f32_16x16x32_bf16 a[72:75], v[112:115], v[32:35], a[72:75]
    v_cvt_pk_bf16_f32 v37, v98, v99
    v_mfma_f32_16x16x32_bf16 a[120:123], v[112:115], v[38:41], a[120:123]
    s_waitcnt lgkmcnt(4)
    v_fma_f32 v78, v78, s28, v9
    v_fma_f32 v91, v91, s28, v11
    v_mfma_f32_16x16x32_bf16 v[188:191], v[116:119], v[14:17], v[188:191]
    v_exp_f32 v88, v88
    v_mfma_f32_16x16x32_bf16 v[236:239], v[116:119], v[20:23], v[236:239]
    v_fma_f32 v84, v84, s28, v10
    v_fma_f32 v110, v110, s28, v13
    v_mfma_f32_16x16x32_bf16 a[28:31], v[116:119], v[26:29], a[28:31]
    v_fma_f32 v104, v104, s28, v13
    v_fma_f32 v94, v94, s28, v11
    v_mfma_f32_16x16x32_bf16 a[76:79], v[116:119], v[32:35], a[76:79]
    v_exp_f32 v111, v111
    v_mfma_f32_16x16x32_bf16 a[124:127], v[116:119], v[38:41], a[124:127]
    s_waitcnt lgkmcnt(2)
    v_exp_f32 v96, v96
    v_mfma_f32_16x16x32_bf16 v[192:195], v[120:123], v[14:17], v[192:195]
    v_exp_f32 v91, v91
    v_mfma_f32_16x16x32_bf16 v[240:243], v[120:123], v[20:23], v[240:243]
    v_exp_f32 v104, v104
    v_mfma_f32_16x16x32_bf16 a[32:35], v[120:123], v[26:29], a[32:35]
    v_fma_f32 v102, v102, s28, v12
    s_waitcnt vmcnt(10) lgkmcnt(0)
    v_mfma_f32_16x16x32_bf16 a[80:83], v[120:123], v[32:35], a[80:83]
    s_barrier
    v_mfma_f32_16x16x32_bf16 a[128:131], v[120:123], v[38:41], a[128:131]
    v_exp_f32 v108, v108
    v_mfma_f32_16x16x32_bf16 v[196:199], v[124:127], v[14:17], v[196:199]
    ds_read_b128 v[116:119], v1 offset:0
    v_mfma_f32_16x16x32_bf16 v[244:247], v[124:127], v[20:23], v[244:247]
    s_add_u32 m0, s22, 24576
    v_exp_f32 v92, v92
    v_mfma_f32_16x16x32_bf16 a[36:39], v[124:127], v[26:29], a[36:39]
    buffer_load_dwordx4 v6, s[8:11], s21 offen lds
    v_mfma_f32_16x16x32_bf16 a[84:87], v[124:127], v[32:35], a[84:87]
    ds_read_b128 v[112:115], v0 offset:0
    v_fma_f32 v87, v87, s28, v10
    v_mfma_f32_16x16x32_bf16 a[132:135], v[124:127], v[38:41], a[132:135]
    s_add_u32 s21, s21, 128
    v_exp_f32 v107, v107
    v_mfma_f32_16x16x32_bf16 v[200:203], v[128:131], v[14:17], v[200:203]
    v_mfma_f32_16x16x32_bf16 v[248:251], v[128:131], v[20:23], v[248:251]
    v_exp_f32 v100, v100
    v_mfma_f32_16x16x32_bf16 a[40:43], v[128:131], v[26:29], a[40:43]
    s_add_u32 m0, s22, 25600
    ds_read_b128 v[120:123], v0 offset:1024
    v_mfma_f32_16x16x32_bf16 a[88:91], v[128:131], v[32:35], a[88:91]
    v_cvt_pk_bf16_f32 v36, v96, v97
    v_cvt_pk_bf16_f32 v31, v90, v91
    v_mfma_f32_16x16x32_bf16 a[136:139], v[128:131], v[38:41], a[136:139]
    v_exp_f32 v106, v106
    v_mfma_f32_16x16x32_bf16 v[204:207], v[132:135], v[14:17], v[204:207]
    buffer_load_dwordx4 v6, s[8:11], s21 offen lds
    v_mfma_f32_16x16x32_bf16 v[252:255], v[132:135], v[20:23], v[252:255]
    ds_read_b128 v[124:127], v1 offset:1024
    v_mfma_f32_16x16x32_bf16 a[44:47], v[132:135], v[26:29], a[44:47]
    v_exp_f32 v101, v101
    v_mfma_f32_16x16x32_bf16 a[92:95], v[132:135], v[32:35], a[92:95]
    s_add_u32 s21, s21, 128
    v_cvt_pk_bf16_f32 v43, v106, v107
    s_add_u32 m0, s22, 26624
    v_mfma_f32_16x16x32_bf16 a[140:143], v[132:135], v[38:41], a[140:143]
    s_waitcnt lgkmcnt(2)
    v_exp_f32 v87, v87
    v_mfma_f32_16x16x32_bf16 v[72:75], v[112:115], a[144:147], 0
    buffer_load_dwordx4 v6, s[8:11], s21 offen lds
    v_mfma_f32_16x16x32_bf16 v[72:75], v[116:119], a[148:151], v[72:75]
    buffer_store_dwordx4 v[144:147], v6, s[16:19], s24 offen sc0 sc1 nt
    v_exp_f32 v89, v89
    s_waitcnt lgkmcnt(1)
    v_mfma_f32_16x16x32_bf16 v[72:75], v[120:123], a[152:155], v[72:75]
    v_exp_f32 v105, v105
    v_mfma_f32_16x16x32_bf16 v[80:83], v[112:115], a[168:171], 0
    ds_read_b128 v[128:131], v0 offset:2048
    v_mfma_f32_16x16x32_bf16 v[80:83], v[116:119], a[172:175], v[80:83]
    ds_read_b128 v[132:135], v1 offset:2048
    v_cvt_pk_bf16_f32 v42, v104, v105
    v_mfma_f32_16x16x32_bf16 v[80:83], v[120:123], a[176:179], v[80:83]
    buffer_store_dwordx4 v[148:151], v7, s[16:19], s24 offen sc0 sc1 nt
    s_add_u32 s21, s21, 12032
    v_cvt_pk_bf16_f32 v30, v88, v89
    v_exp_f32 v79, v79
    v_mfma_f32_16x16x32_bf16 v[88:91], v[112:115], a[192:195], 0
    v_mfma_f32_16x16x32_bf16 v[88:91], v[116:119], a[196:199], v[88:91]
    v_exp_f32 v86, v86
    v_mfma_f32_16x16x32_bf16 v[88:91], v[120:123], a[200:203], v[88:91]
    v_mfma_f32_16x16x32_bf16 v[96:99], v[112:115], a[216:219], 0
    v_exp_f32 v78, v78
    v_mfma_f32_16x16x32_bf16 v[96:99], v[116:119], a[220:223], v[96:99]
    v_exp_f32 v102, v102
    v_mfma_f32_16x16x32_bf16 v[96:99], v[120:123], a[224:227], v[96:99]
    v_cvt_pk_bf16_f32 v35, v102, v103
    v_cvt_pk_bf16_f32 v40, v108, v109
    v_mfma_f32_16x16x32_bf16 v[104:107], v[112:115], a[240:243], 0
    ds_read_b128 v[112:115], v0 offset:6144
    v_mfma_f32_16x16x32_bf16 v[104:107], v[116:119], a[244:247], v[104:107]
    v_exp_f32 v76, v76
    v_mfma_f32_16x16x32_bf16 v[104:107], v[120:123], a[248:251], v[104:107]
    s_waitcnt lgkmcnt(1)
    v_exp_f32 v94, v94
    v_mfma_f32_16x16x32_bf16 v[72:75], v[124:127], a[156:159], v[72:75]
    s_add_u32 m0, s23, 2048
    v_exp_f32 v93, v93
    v_mfma_f32_16x16x32_bf16 v[72:75], v[128:131], a[160:163], v[72:75]
    v_exp_f32 v110, v110
    v_mfma_f32_16x16x32_bf16 v[72:75], v[132:135], a[164:167], v[72:75]
    v_exp_f32 v85, v85
    v_mfma_f32_16x16x32_bf16 v[80:83], v[124:127], a[180:183], v[80:83]
    v_exp_f32 v77, v77
    v_mfma_f32_16x16x32_bf16 v[80:83], v[128:131], a[184:187], v[80:83]
    ds_read_b128 v[120:123], v0 offset:7168
    v_cvt_pk_bf16_f32 v28, v92, v93
    v_mfma_f32_16x16x32_bf16 v[80:83], v[132:135], a[188:191], v[80:83]
    v_exp_f32 v84, v84
    v_mfma_f32_16x16x32_bf16 v[88:91], v[124:127], a[204:207], v[88:91]
    v_exp_f32 v95, v95
    v_mfma_f32_16x16x32_bf16 v[88:91], v[128:131], a[208:211], v[88:91]
    v_cvt_pk_bf16_f32 v41, v110, v111
    v_mfma_f32_16x16x32_bf16 v[88:91], v[132:135], a[212:215], v[88:91]
    ds_read_b128 v[116:119], v1 offset:6144
    v_cvt_pk_bf16_f32 v34, v100, v101
    v_mfma_f32_16x16x32_bf16 v[96:99], v[124:127], a[228:231], v[96:99]
    v_cvt_pk_bf16_f32 v22, v84, v85
    v_cvt_pk_bf16_f32 v29, v94, v95
    v_mfma_f32_16x16x32_bf16 v[96:99], v[128:131], a[232:235], v[96:99]
    buffer_load_dwordx4 v6, s[12:15], s25 offen nt lds
    v_mfma_f32_16x16x32_bf16 v[96:99], v[132:135], a[236:239], v[96:99]
    v_cvt_pk_bf16_f32 v16, v76, v77
    v_cvt_pk_bf16_f32 v17, v78, v79
    v_mfma_f32_16x16x32_bf16 v[104:107], v[124:127], a[252:255], v[104:107]
    v_cvt_pk_bf16_f32 v23, v86, v87
    v_mfma_f32_16x16x32_bf16 v[104:107], v[128:131], v[136:139], v[104:107]
    ds_read_b128 v[128:131], v0 offset:8192
    v_mfma_f32_16x16x32_bf16 v[104:107], v[132:135], v[140:143], v[104:107]
    ds_read_b128 v[124:127], v1 offset:7168
    v_mfma_f32_16x16x32_bf16 v[48:51], v[52:55], v[16:19], v[44:47]
    s_add_u32 m0, s23, 3072
    ds_read_b128 v[132:135], v1 offset:8192
    v_mfma_f32_16x16x32_bf16 v[48:51], v[56:59], v[22:25], v[48:51]
    v_mfma_f32_16x16x32_bf16 v[48:51], v[60:63], v[28:31], v[48:51]
    s_waitcnt lgkmcnt(4)
    v_mfma_f32_16x16x32_bf16 v[76:79], v[112:115], a[144:147], 0
    buffer_load_dwordx4 v7, s[12:15], s25 offen nt lds
    v_mfma_f32_16x16x32_bf16 v[48:51], v[64:67], v[34:37], v[48:51]
    s_bitcmp1_b32 s27, 0
    v_mfma_f32_16x16x32_bf16 v[48:51], v[68:71], v[40:43], v[48:51]
    s_waitcnt lgkmcnt(3)
    v_add_u32 v8, 4096, v8
    v_mfma_f32_16x16x32_bf16 v[76:79], v[116:119], a[148:151], v[76:79]
    s_cselect_b32 s26, s49, 128
    s_lshr_b32 s27, s27, 1
    v_mfma_f32_16x16x32_bf16 v[76:79], v[120:123], a[152:155], v[76:79]
    s_nop 1
    v_cmp_lt_f32 vcc, s29, v48
    v_mfma_f32_16x16x32_bf16 v[84:87], v[112:115], a[168:171], 0
    s_add_u32 s24, s24, s26
    s_add_u32 s25, s25, s26
    s_add_u32 s23, s23, 4096
    v_mfma_f32_16x16x32_bf16 v[84:87], v[116:119], a[172:175], v[84:87]
    s_cbranch_vccnz L_rs_loop5w0b
L_ret_loop5w0b:
    v_fma_f32 v75, v75, s28, v9
    v_mfma_f32_16x16x32_bf16 v[84:87], v[120:123], a[176:179], v[84:87]
    s_waitcnt vmcnt(13) lgkmcnt(0)
    v_fma_f32 v82, v82, s28, v10
    v_fma_f32 v73, v73, s28, v9
    v_mfma_f32_16x16x32_bf16 v[92:95], v[112:115], a[192:195], 0
    s_barrier
    v_mfma_f32_16x16x32_bf16 v[92:95], v[116:119], a[196:199], v[92:95]
    v_exp_f32 v73, v73
    v_mfma_f32_16x16x32_bf16 v[92:95], v[120:123], a[200:203], v[92:95]
    v_fma_f32 v81, v81, s28, v10
    v_mfma_f32_16x16x32_bf16 v[100:103], v[112:115], a[216:219], 0
    s_cmp_eq_u32 s30, 5
    v_exp_f32 v82, v82
    v_mfma_f32_16x16x32_bf16 v[100:103], v[116:119], a[220:223], v[100:103]
    v_exp_f32 v75, v75
    v_mfma_f32_16x16x32_bf16 v[100:103], v[120:123], a[224:227], v[100:103]
    s_cselect_b32 s26, s62, 0
    v_fma_f32 v83, v83, s28, v10
    v_fma_f32 v74, v74, s28, v9
    v_mfma_f32_16x16x32_bf16 v[108:111], v[112:115], a[240:243], 0
    s_add_u32 s20, s20, s26
    v_fma_f32 v80, v80, s28, v10
    v_fma_f32 v72, v72, s28, v9
    v_mfma_f32_16x16x32_bf16 v[108:111], v[116:119], a[244:247], v[108:111]
    s_add_u32 m0, s22, 0
    ds_read_b64_tr_b16 v[112:113], v2 offset:18432
    v_mfma_f32_16x16x32_bf16 v[108:111], v[120:123], a[248:251], v[108:111]
    buffer_load_dwordx4 v6, s[4:7], s20 offen lds
    v_mfma_f32_16x16x32_bf16 v[76:79], v[124:127], a[156:159], v[76:79]
    v_exp_f32 v72, v72
    v_mfma_f32_16x16x32_bf16 v[76:79], v[128:131], a[160:163], v[76:79]
    s_add_u32 s20, s20, 128
    s_add_u32 m0, s22, 1024
    ds_read_b64_tr_b16 v[114:115], v2 offset:12288
    v_mfma_f32_16x16x32_bf16 v[76:79], v[132:135], a[164:167], v[76:79]
    ds_read_b64_tr_b16 v[116:117], v3 offset:18432
    v_mfma_f32_16x16x32_bf16 v[84:87], v[124:127], a[180:183], v[84:87]
    v_exp_f32 v81, v81
    v_mfma_f32_16x16x32_bf16 v[84:87], v[128:131], a[184:187], v[84:87]
    buffer_load_dwordx4 v6, s[4:7], s20 offen lds
    v_mfma_f32_16x16x32_bf16 v[84:87], v[132:135], a[188:191], v[84:87]
    v_exp_f32 v83, v83
    v_mfma_f32_16x16x32_bf16 v[92:95], v[124:127], a[204:207], v[92:95]
    v_exp_f32 v74, v74
    v_mfma_f32_16x16x32_bf16 v[92:95], v[128:131], a[208:211], v[92:95]
    ds_read_b64_tr_b16 v[118:119], v3 offset:12288
    v_mfma_f32_16x16x32_bf16 v[92:95], v[132:135], a[212:215], v[92:95]
    ds_read_b64_tr_b16 v[120:121], v4 offset:18432
    s_add_u32 s20, s20, 128
    v_mfma_f32_16x16x32_bf16 v[100:103], v[124:127], a[228:231], v[100:103]
    ds_read_b64_tr_b16 v[122:123], v4 offset:12288
    s_add_u32 m0, s22, 2048
    v_mfma_f32_16x16x32_bf16 v[100:103], v[128:131], a[232:235], v[100:103]
    buffer_load_dwordx4 v6, s[4:7], s20 offen lds
    v_mfma_f32_16x16x32_bf16 v[100:103], v[132:135], a[236:239], v[100:103]
    s_add_u32 s20, s20, 12032
    v_exp_f32 v80, v80
    v_mfma_f32_16x16x32_bf16 v[108:111], v[124:127], a[252:255], v[108:111]
    s_add_u32 s30, s30, 1
    v_cvt_pk_bf16_f32 v21, v82, v83
    v_cvt_pk_bf16_f32 v15, v74, v75
    v_mfma_f32_16x16x32_bf16 v[108:111], v[128:131], v[136:139], v[108:111]
    ds_read_b64_tr_b16 v[124:125], v5 offset:18432
    v_cvt_pk_bf16_f32 v20, v80, v81
    v_mfma_f32_16x16x32_bf16 v[108:111], v[132:135], v[140:143], v[108:111]
    s_cmp_lt_u32 s30, 6
    ds_read_b64_tr_b16 v[126:127], v5 offset:12288
    v_cvt_pk_bf16_f32 v14, v72, v73
    s_cbranch_scc1 L_loop5w0
    s_cmp_ge_u32 s37, 6
    s_cbranch_scc1 L_end5
    s_cmp_eq_u32 s32, 0
    s_cbranch_scc1 L_tr54
    s_branch L_tr55
L_tr54:
    s_waitcnt lgkmcnt(6)
    v_mfma_f32_16x16x32_bf16 v[160:163], v[112:115], v[16:19], v[160:163]
    v_mfma_f32_16x16x32_bf16 v[208:211], v[112:115], v[22:25], v[208:211]
    ds_read_b64_tr_b16 v[128:129], v2 offset:19456
    v_fma_f32 v98, v98, s28, v12
    v_mfma_f32_16x16x32_bf16 a[0:3], v[112:115], v[28:31], a[0:3]
    v_fma_f32 v99, v99, s28, v12
    v_fma_f32 v79, v79, s28, v9
    v_mfma_f32_16x16x32_bf16 a[48:51], v[112:115], v[34:37], a[48:51]
    v_fma_f32 v104, v104, s28, v13
    v_fma_f32 v101, v101, s28, v12
    v_mfma_f32_16x16x32_bf16 a[96:99], v[112:115], v[40:43], a[96:99]
    v_fma_f32 v89, v89, s28, v11
    s_waitcnt lgkmcnt(5)
    v_mfma_f32_16x16x32_bf16 v[164:167], v[116:119], v[16:19], v[164:167]
    v_exp_f32 v104, v104
    v_mfma_f32_16x16x32_bf16 v[212:215], v[116:119], v[22:25], v[212:215]
    v_mfma_f32_16x16x32_bf16 a[4:7], v[116:119], v[28:31], a[4:7]
    ds_read_b64_tr_b16 v[130:131], v2 offset:13312
    v_fma_f32 v85, v85, s28, v10
    v_mfma_f32_16x16x32_bf16 a[52:55], v[116:119], v[34:37], a[52:55]
    ds_read_b64_tr_b16 v[132:133], v3 offset:19456
    v_mfma_f32_16x16x32_bf16 a[100:103], v[116:119], v[40:43], a[100:103]
    s_waitcnt lgkmcnt(3)
    ds_read_b64_tr_b16 v[134:135], v3 offset:13312
    v_mfma_f32_16x16x32_bf16 v[168:171], v[120:123], v[16:19], v[168:171]
    ds_read_b64_tr_b16 v[118:119], v5 offset:13312
    v_fma_f32 v97, v97, s28, v12
    v_mfma_f32_16x16x32_bf16 v[216:219], v[120:123], v[22:25], v[216:219]
    v_exp_f32 v79, v79
    v_mfma_f32_16x16x32_bf16 a[8:11], v[120:123], v[28:31], a[8:11]
    ds_read_b64_tr_b16 v[114:115], v4 offset:13312
    v_fma_f32 v102, v102, s28, v12
    v_mfma_f32_16x16x32_bf16 a[56:59], v[120:123], v[34:37], a[56:59]
    v_fma_f32 v107, v107, s28, v13
    v_fma_f32 v76, v76, s28, v9
    v_mfma_f32_16x16x32_bf16 a[104:107], v[120:123], v[40:43], a[104:107]
    ds_read_b64_tr_b16 v[112:113], v4 offset:19456
    v_fma_f32 v91, v91, s28, v11
    v_mfma_f32_16x16x32_bf16 v[172:175], v[124:127], v[16:19], v[172:175]
    v_exp_f32 v101, v101
    v_mfma_f32_16x16x32_bf16 v[220:223], v[124:127], v[22:25], v[220:223]
    v_fma_f32 v100, v100, s28, v12
    v_fma_f32 v95, v95, s28, v11
    v_mfma_f32_16x16x32_bf16 a[12:15], v[124:127], v[28:31], a[12:15]
    v_fma_f32 v88, v88, s28, v11
    v_fma_f32 v90, v90, s28, v11
    v_mfma_f32_16x16x32_bf16 a[60:63], v[124:127], v[34:37], a[60:63]
    s_add_u32 s39, s39, 12288
    ds_read_b64_tr_b16 v[122:123], v2 offset:14336
    v_fma_f32 v108, v108, s28, v13
    v_mfma_f32_16x16x32_bf16 a[108:111], v[124:127], v[40:43], a[108:111]
    s_waitcnt lgkmcnt(4)
    v_exp_f32 v85, v85
    v_mfma_f32_16x16x32_bf16 v[176:179], v[128:131], v[16:19], v[176:179]
    v_fma_f32 v92, v92, s28, v11
    v_fma_f32 v111, v111, s28, v13
    v_mfma_f32_16x16x32_bf16 v[224:227], v[128:131], v[22:25], v[224:227]
    v_exp_f32 v91, v91
    v_mfma_f32_16x16x32_bf16 a[16:19], v[128:131], v[28:31], a[16:19]
    ds_read_b64_tr_b16 v[116:117], v5 offset:19456
    v_mfma_f32_16x16x32_bf16 a[64:67], v[128:131], v[34:37], a[64:67]
    ds_read_b64_tr_b16 v[120:121], v2 offset:20480
    v_fma_f32 v109, v109, s28, v13
    v_mfma_f32_16x16x32_bf16 a[112:115], v[128:131], v[40:43], a[112:115]
    ds_read_b64_tr_b16 v[128:129], v4 offset:20480
    v_fma_f32 v77, v77, s28, v9
    v_mfma_f32_16x16x32_bf16 v[180:183], v[132:135], v[16:19], v[180:183]
    ds_read_b64_tr_b16 v[130:131], v4 offset:14336
    v_fma_f32 v106, v106, s28, v13
    v_mfma_f32_16x16x32_bf16 v[228:231], v[132:135], v[22:25], v[228:231]
    ds_read_b64_tr_b16 v[126:127], v3 offset:14336
    v_fma_f32 v86, v86, s28, v10
    v_mfma_f32_16x16x32_bf16 a[20:23], v[132:135], v[28:31], a[20:23]
    v_exp_f32 v77, v77
    v_mfma_f32_16x16x32_bf16 a[68:71], v[132:135], v[34:37], a[68:71]
    v_exp_f32 v88, v88
    v_mfma_f32_16x16x32_bf16 a[116:119], v[132:135], v[40:43], a[116:119]
    s_waitcnt lgkmcnt(5)
    ds_read_b64_tr_b16 v[132:133], v5 offset:20480
    v_fma_f32 v96, v96, s28, v12
    v_mfma_f32_16x16x32_bf16 v[184:187], v[112:115], v[16:19], v[184:187]
    v_exp_f32 v98, v98
    v_mfma_f32_16x16x32_bf16 v[232:235], v[112:115], v[22:25], v[232:235]
    ds_read_b64_tr_b16 v[124:125], v3 offset:20480
    v_mfma_f32_16x16x32_bf16 a[24:27], v[112:115], v[28:31], a[24:27]
    ds_read_b64_tr_b16 v[134:135], v5 offset:14336
    v_fma_f32 v78, v78, s28, v9
    v_mfma_f32_16x16x32_bf16 a[72:75], v[112:115], v[34:37], a[72:75]
    v_exp_f32 v78, v78
    v_mfma_f32_16x16x32_bf16 a[120:123], v[112:115], v[40:43], a[120:123]
    s_waitcnt lgkmcnt(5)
    v_exp_f32 v99, v99
    v_mfma_f32_16x16x32_bf16 v[188:191], v[116:119], v[16:19], v[188:191]
    v_exp_f32 v89, v89
    v_mfma_f32_16x16x32_bf16 v[236:239], v[116:119], v[22:25], v[236:239]
    v_exp_f32 v106, v106
    v_mfma_f32_16x16x32_bf16 a[28:31], v[116:119], v[28:31], a[28:31]
    v_exp_f32 v108, v108
    v_mfma_f32_16x16x32_bf16 a[76:79], v[116:119], v[34:37], a[76:79]
    v_exp_f32 v90, v90
    v_mfma_f32_16x16x32_bf16 a[124:127], v[116:119], v[40:43], a[124:127]
    v_cvt_pk_bf16_f32 v26, v88, v89
    v_cvt_pk_bf16_f32 v27, v90, v91
    v_mfma_f32_16x16x32_bf16 v[192:195], v[120:123], v[16:19], v[192:195]
    v_exp_f32 v92, v92
    v_mfma_f32_16x16x32_bf16 v[240:243], v[120:123], v[22:25], v[240:243]
    v_exp_f32 v76, v76
    v_mfma_f32_16x16x32_bf16 a[32:35], v[120:123], v[28:31], a[32:35]
    s_waitcnt vmcnt(10) lgkmcnt(0)
    v_exp_f32 v107, v107
    v_mfma_f32_16x16x32_bf16 a[80:83], v[120:123], v[34:37], a[80:83]
    s_barrier
    v_mfma_f32_16x16x32_bf16 a[128:131], v[120:123], v[40:43], a[128:131]
    s_add_u32 m0, s22, 36864
    v_fma_f32 v84, v84, s28, v10
    v_fma_f32 v110, v110, s28, v13
    v_mfma_f32_16x16x32_bf16 v[196:199], v[124:127], v[16:19], v[196:199]
    buffer_load_dwordx4 v6, s[8:11], s21 offen lds
    v_mfma_f32_16x16x32_bf16 v[244:247], v[124:127], v[22:25], v[244:247]
    ds_read_b128 v[116:119], v1 offset:12288
    v_fma_f32 v105, v105, s28, v13
    v_mfma_f32_16x16x32_bf16 a[36:39], v[124:127], v[28:31], a[36:39]
    ds_read_b128 v[120:123], v0 offset:13312
    v_mfma_f32_16x16x32_bf16 a[84:87], v[124:127], v[34:37], a[84:87]
    v_exp_f32 v84, v84
    v_mfma_f32_16x16x32_bf16 a[132:135], v[124:127], v[40:43], a[132:135]
    ds_read_b128 v[112:115], v0 offset:12288
    v_mfma_f32_16x16x32_bf16 v[200:203], v[128:131], v[16:19], v[200:203]
    ds_read_b128 v[124:127], v1 offset:13312
    v_mfma_f32_16x16x32_bf16 v[248:251], v[128:131], v[22:25], v[248:251]
    s_add_u32 s21, s21, 128
    v_exp_f32 v96, v96
    v_mfma_f32_16x16x32_bf16 a[40:43], v[128:131], v[28:31], a[40:43]
    s_add_u32 m0, s22, 37888
    v_cvt_pk_bf16_f32 v33, v98, v99
    v_fma_f32 v87, v87, s28, v10
    v_mfma_f32_16x16x32_bf16 a[88:91], v[128:131], v[34:37], a[88:91]
    v_exp_f32 v97, v97
    v_mfma_f32_16x16x32_bf16 a[136:139], v[128:131], v[40:43], a[136:139]
    v_fma_f32 v103, v103, s28, v12
    v_fma_f32 v94, v94, s28, v11
    v_mfma_f32_16x16x32_bf16 v[204:207], v[132:135], v[16:19], v[204:207]
    buffer_load_dwordx4 v6, s[8:11], s21 offen lds
    v_mfma_f32_16x16x32_bf16 v[252:255], v[132:135], v[22:25], v[252:255]
    v_exp_f32 v103, v103
    v_mfma_f32_16x16x32_bf16 a[44:47], v[132:135], v[28:31], a[44:47]
    v_exp_f32 v105, v105
    v_mfma_f32_16x16x32_bf16 a[92:95], v[132:135], v[34:37], a[92:95]
    s_add_u32 s21, s21, 128
    s_add_u32 m0, s22, 38912
    v_mfma_f32_16x16x32_bf16 a[140:143], v[132:135], v[40:43], a[140:143]
    s_waitcnt lgkmcnt(1)
    v_exp_f32 v87, v87
    v_mfma_f32_16x16x32_bf16 v[72:75], v[112:115], a[144:147], 0
    buffer_load_dwordx4 v6, s[8:11], s21 offen lds
    v_mfma_f32_16x16x32_bf16 v[72:75], v[116:119], a[148:151], v[72:75]
    ds_read_b128 v[132:135], v1 offset:14336
    v_mfma_f32_16x16x32_bf16 v[72:75], v[120:123], a[152:155], v[72:75]
    v_exp_f32 v95, v95
    v_mfma_f32_16x16x32_bf16 v[80:83], v[112:115], a[168:171], 0
    v_exp_f32 v109, v109
    v_mfma_f32_16x16x32_bf16 v[80:83], v[116:119], a[172:175], v[80:83]
    v_fma_f32 v93, v93, s28, v11
    v_cvt_pk_bf16_f32 v39, v106, v107
    v_mfma_f32_16x16x32_bf16 v[80:83], v[120:123], a[176:179], v[80:83]
    ds_read_b128 v[128:131], v0 offset:14336
    v_mfma_f32_16x16x32_bf16 v[88:91], v[112:115], a[192:195], 0
    v_cvt_pk_bf16_f32 v32, v96, v97
    v_cvt_pk_bf16_f32 v38, v104, v105
    v_mfma_f32_16x16x32_bf16 v[88:91], v[116:119], a[196:199], v[88:91]
    v_exp_f32 v110, v110
    v_mfma_f32_16x16x32_bf16 v[88:91], v[120:123], a[200:203], v[88:91]
    v_cvt_pk_bf16_f32 v17, v78, v79
    v_mfma_f32_16x16x32_bf16 v[96:99], v[112:115], a[216:219], 0
    v_mfma_f32_16x16x32_bf16 v[96:99], v[116:119], a[220:223], v[96:99]
    v_cvt_pk_bf16_f32 v40, v108, v109
    v_mfma_f32_16x16x32_bf16 v[96:99], v[120:123], a[224:227], v[96:99]
    v_mfma_f32_16x16x32_bf16 v[104:107], v[112:115], a[240:243], 0
    v_exp_f32 v93, v93
    v_mfma_f32_16x16x32_bf16 v[104:107], v[116:119], a[244:247], v[104:107]
    v_exp_f32 v94, v94
    v_mfma_f32_16x16x32_bf16 v[104:107], v[120:123], a[248:251], v[104:107]
    s_waitcnt lgkmcnt(1)
    v_mfma_f32_16x16x32_bf16 v[72:75], v[124:127], a[156:159], v[72:75]
    s_waitcnt lgkmcnt(0)
    v_exp_f32 v100, v100
    v_mfma_f32_16x16x32_bf16 v[72:75], v[128:131], a[160:163], v[72:75]
    ds_read_b128 v[112:115], v0 offset:18432
    v_mfma_f32_16x16x32_bf16 v[72:75], v[132:135], a[164:167], v[72:75]
    v_exp_f32 v102, v102
    v_mfma_f32_16x16x32_bf16 v[80:83], v[124:127], a[180:183], v[80:83]
    s_add_u32 s21, s21, 12032
    v_cvt_pk_bf16_f32 v29, v94, v95
    v_mfma_f32_16x16x32_bf16 v[80:83], v[128:131], a[184:187], v[80:83]
    v_exp_f32 v111, v111
    v_mfma_f32_16x16x32_bf16 v[80:83], v[132:135], a[188:191], v[80:83]
    v_cvt_pk_bf16_f32 v16, v76, v77
    v_mfma_f32_16x16x32_bf16 v[88:91], v[124:127], a[204:207], v[88:91]
    v_cvt_pk_bf16_f32 v22, v84, v85
    v_mfma_f32_16x16x32_bf16 v[88:91], v[128:131], a[208:211], v[88:91]
    ds_read_b128 v[116:119], v1 offset:18432
    v_mfma_f32_16x16x32_bf16 v[88:91], v[132:135], a[212:215], v[88:91]
    v_cvt_pk_bf16_f32 v35, v102, v103
    v_mfma_f32_16x16x32_bf16 v[96:99], v[124:127], a[228:231], v[96:99]
    v_cvt_pk_bf16_f32 v41, v110, v111
    v_mfma_f32_16x16x32_bf16 v[96:99], v[128:131], a[232:235], v[96:99]
    ds_read_b128 v[120:123], v0 offset:19456
    v_mfma_f32_16x16x32_bf16 v[96:99], v[132:135], a[236:239], v[96:99]
    v_exp_f32 v86, v86
    v_mfma_f32_16x16x32_bf16 v[104:107], v[124:127], a[252:255], v[104:107]
    v_cvt_pk_bf16_f32 v28, v92, v93
    v_mfma_f32_16x16x32_bf16 v[104:107], v[128:131], v[136:139], v[104:107]
    ds_read_b128 v[128:131], v0 offset:20480
    v_mfma_f32_16x16x32_bf16 v[104:107], v[132:135], v[140:143], v[104:107]
    ds_read_b128 v[132:135], v1 offset:20480
    v_cvt_pk_bf16_f32 v23, v86, v87
    v_mfma_f32_16x16x32_bf16 v[44:47], v[52:55], v[14:17], v[48:51]
    ds_read_b128 v[124:127], v1 offset:19456
    v_cvt_pk_bf16_f32 v34, v100, v101
    v_mfma_f32_16x16x32_bf16 v[44:47], v[56:59], v[20:23], v[44:47]
    v_mfma_f32_16x16x32_bf16 v[44:47], v[60:63], v[26:29], v[44:47]
    v_mfma_f32_16x16x32_bf16 v[44:47], v[64:67], v[32:35], v[44:47]
    v_mfma_f32_16x16x32_bf16 v[44:47], v[68:71], v[38:41], v[44:47]
    s_waitcnt lgkmcnt(4)
    v_mfma_f32_16x16x32_bf16 v[76:79], v[112:115], a[144:147], 0
    v_mfma_f32_16x16x32_bf16 v[76:79], v[116:119], a[148:151], v[76:79]
    s_waitcnt lgkmcnt(3)
    v_mfma_f32_16x16x32_bf16 v[76:79], v[120:123], a[152:155], v[76:79]
    v_mfma_f32_16x16x32_bf16 v[84:87], v[112:115], a[168:171], 0
    s_nop 1
    v_cmp_lt_f32 vcc, s29, v44
    v_mfma_f32_16x16x32_bf16 v[84:87], v[116:119], a[172:175], v[84:87]
    v_mfma_f32_16x16x32_bf16 v[84:87], v[120:123], a[176:179], v[84:87]
    s_waitcnt vmcnt(6) lgkmcnt(0)
    v_mfma_f32_16x16x32_bf16 v[92:95], v[112:115], a[192:195], 0
    s_barrier
    v_mfma_f32_16x16x32_bf16 v[92:95], v[116:119], a[196:199], v[92:95]
    s_cbranch_vccnz L_rs_tr54a
L_ret_tr54a:
    v_fma_f32 v82, v82, s28, v10
    v_mfma_f32_16x16x32_bf16 v[92:95], v[120:123], a[200:203], v[92:95]
    v_exp_f32 v82, v82
    v_mfma_f32_16x16x32_bf16 v[100:103], v[112:115], a[216:219], 0
    v_fma_f32 v75, v75, s28, v9
    v_fma_f32 v83, v83, s28, v10
    v_mfma_f32_16x16x32_bf16 v[100:103], v[116:119], a[220:223], v[100:103]
    s_add_u32 m0, s22, 12288
    v_fma_f32 v80, v80, s28, v10
    v_fma_f32 v81, v81, s28, v10
    v_mfma_f32_16x16x32_bf16 v[100:103], v[120:123], a[224:227], v[100:103]
    v_exp_f32 v80, v80
    v_mfma_f32_16x16x32_bf16 v[108:111], v[112:115], a[240:243], 0
    ds_read_b64_tr_b16 v[112:113], v2 offset:0
    v_fma_f32 v72, v72, s28, v9
    v_mfma_f32_16x16x32_bf16 v[108:111], v[116:119], a[244:247], v[108:111]
    buffer_load_dwordx4 v6, s[4:7], s20 offen lds
    v_mfma_f32_16x16x32_bf16 v[108:111], v[120:123], a[248:251], v[108:111]
    ds_read_b64_tr_b16 v[114:115], v2 offset:6144
    v_fma_f32 v74, v74, s28, v9
    v_mfma_f32_16x16x32_bf16 v[76:79], v[124:127], a[156:159], v[76:79]
    v_exp_f32 v72, v72
    v_mfma_f32_16x16x32_bf16 v[76:79], v[128:131], a[160:163], v[76:79]
    ds_read_b64_tr_b16 v[116:117], v3 offset:0
    s_add_u32 s20, s20, 128
    v_mfma_f32_16x16x32_bf16 v[76:79], v[132:135], a[164:167], v[76:79]
    v_exp_f32 v83, v83
    v_mfma_f32_16x16x32_bf16 v[84:87], v[124:127], a[180:183], v[84:87]
    s_add_u32 m0, s22, 13312
    v_exp_f32 v81, v81
    v_mfma_f32_16x16x32_bf16 v[84:87], v[128:131], a[184:187], v[84:87]
    buffer_load_dwordx4 v6, s[4:7], s20 offen lds
    v_mfma_f32_16x16x32_bf16 v[84:87], v[132:135], a[188:191], v[84:87]
    s_add_u32 s20, s20, 128
    ds_read_b64_tr_b16 v[118:119], v3 offset:6144
    v_cvt_pk_bf16_f32 v24, v80, v81
    v_mfma_f32_16x16x32_bf16 v[92:95], v[124:127], a[204:207], v[92:95]
    s_add_u32 m0, s22, 14336
    ds_read_b64_tr_b16 v[120:121], v4 offset:0
    v_fma_f32 v73, v73, s28, v9
    v_mfma_f32_16x16x32_bf16 v[92:95], v[128:131], a[208:211], v[92:95]
    v_exp_f32 v74, v74
    v_mfma_f32_16x16x32_bf16 v[92:95], v[132:135], a[212:215], v[92:95]
    v_exp_f32 v75, v75
    v_mfma_f32_16x16x32_bf16 v[100:103], v[124:127], a[228:231], v[100:103]
    ds_read_b64_tr_b16 v[122:123], v4 offset:6144
    v_cvt_pk_bf16_f32 v19, v74, v75
    v_mfma_f32_16x16x32_bf16 v[100:103], v[128:131], a[232:235], v[100:103]
    buffer_load_dwordx4 v6, s[4:7], s20 offen lds
    v_mfma_f32_16x16x32_bf16 v[100:103], v[132:135], a[236:239], v[100:103]
    s_add_u32 s20, s20, 12032
    v_mfma_f32_16x16x32_bf16 v[108:111], v[124:127], a[252:255], v[108:111]
    v_exp_f32 v73, v73
    v_mfma_f32_16x16x32_bf16 v[108:111], v[128:131], v[136:139], v[108:111]
    ds_read_b64_tr_b16 v[124:125], v5 offset:0
    v_cvt_pk_bf16_f32 v18, v72, v73
    v_mfma_f32_16x16x32_bf16 v[108:111], v[132:135], v[140:143], v[108:111]
    ds_read_b64_tr_b16 v[126:127], v5 offset:6144
    v_cvt_pk_bf16_f32 v25, v82, v83
    s_waitcnt lgkmcnt(6)
    v_mfma_f32_16x16x32_bf16 v[160:163], v[112:115], v[14:17], v[160:163]
    ds_read_b64_tr_b16 v[128:129], v2 offset:1024
    v_lshrrev_b32 v153, 11, v0
    v_mfma_f32_16x16x32_bf16 v[208:211], v[112:115], v[20:23], v[208:211]
    v_fma_f32 v91, v91, s28, v11
    v_fma_f32 v101, v101, s28, v12
    v_mfma_f32_16x16x32_bf16 a[0:3], v[112:115], v[26:29], a[0:3]
    v_xor_b32 v153, s65, v153
    v_fma_f32 v98, v98, s28, v12
    v_mfma_f32_16x16x32_bf16 a[48:51], v[112:115], v[32:35], a[48:51]
    ds_read_b64_tr_b16 v[132:133], v3 offset:1024
    v_fma_f32 v97, v97, s28, v12
    v_mfma_f32_16x16x32_bf16 a[96:99], v[112:115], v[38:41], a[96:99]
    ds_read_b64_tr_b16 v[130:131], v2 offset:7168
    s_waitcnt lgkmcnt(7)
    v_mfma_f32_16x16x32_bf16 v[164:167], v[116:119], v[14:17], v[164:167]
    v_and_b32 v152, 0x3ff, v0
    v_lshl_add_u32 v152, v153, 10, v152
    v_mfma_f32_16x16x32_bf16 v[212:215], v[116:119], v[20:23], v[212:215]
    ds_read_b64_tr_b16 v[134:135], v3 offset:7168
    v_fma_f32 v76, v76, s28, v9
    v_mfma_f32_16x16x32_bf16 a[4:7], v[116:119], v[26:29], a[4:7]
    v_fma_f32 v92, v92, s28, v11
    v_add_u32 v152, s38, v152
    v_mfma_f32_16x16x32_bf16 a[52:55], v[116:119], v[32:35], a[52:55]
    ds_read_b64_tr_b16 v[114:115], v4 offset:7168
    v_fma_f32 v88, v88, s28, v11
    v_mfma_f32_16x16x32_bf16 a[100:103], v[116:119], v[38:41], a[100:103]
    s_waitcnt lgkmcnt(5)
    ds_read_b64_tr_b16 v[116:117], v5 offset:1024
    v_xor_b32 v153, 64, v152
    v_mfma_f32_16x16x32_bf16 v[168:171], v[120:123], v[14:17], v[168:171]
    v_exp_f32 v88, v88
    v_mfma_f32_16x16x32_bf16 v[216:219], v[120:123], v[20:23], v[216:219]
    ds_read_b64_tr_b16 v[112:113], v4 offset:1024
    v_mfma_f32_16x16x32_bf16 a[8:11], v[120:123], v[26:29], a[8:11]
    ds_read_b128 a[216:219], v152 offset:18432
    v_fma_f32 v96, v96, s28, v12
    v_mfma_f32_16x16x32_bf16 a[56:59], v[120:123], v[32:35], a[56:59]
    v_fma_f32 v89, v89, s28, v11
    v_fma_f32 v103, v103, s28, v12
    v_mfma_f32_16x16x32_bf16 a[104:107], v[120:123], v[38:41], a[104:107]
    ds_read_b128 a[148:151], v153 offset:0
    v_fma_f32 v77, v77, s28, v9
    v_mfma_f32_16x16x32_bf16 v[172:175], v[124:127], v[14:17], v[172:175]
    ds_read_b128 a[156:159], v153 offset:2048
    v_fma_f32 v87, v87, s28, v10
    v_mfma_f32_16x16x32_bf16 v[220:223], v[124:127], v[20:23], v[220:223]
    ds_read_b128 a[144:147], v152 offset:0
    v_fma_f32 v107, v107, s28, v13
    v_mfma_f32_16x16x32_bf16 a[12:15], v[124:127], v[26:29], a[12:15]
    v_fma_f32 v94, v94, s28, v11
    v_fma_f32 v85, v85, s28, v10
    v_mfma_f32_16x16x32_bf16 a[60:63], v[124:127], v[32:35], a[60:63]
    ds_read_b128 a[220:223], v153 offset:18432
    v_fma_f32 v78, v78, s28, v9
    v_mfma_f32_16x16x32_bf16 a[108:111], v[124:127], v[38:41], a[108:111]
    s_waitcnt lgkmcnt(6)
    ds_read_b64_tr_b16 v[118:119], v5 offset:7168
    v_fma_f32 v79, v79, s28, v9
    v_mfma_f32_16x16x32_bf16 v[176:179], v[128:131], v[14:17], v[176:179]
    v_exp_f32 v96, v96
    v_mfma_f32_16x16x32_bf16 v[224:227], v[128:131], v[20:23], v[224:227]
    ds_read_b128 a[224:227], v152 offset:20480
    v_fma_f32 v86, v86, s28, v10
    v_mfma_f32_16x16x32_bf16 a[16:19], v[128:131], v[26:29], a[16:19]
    ds_read_b128 a[184:187], v152 offset:10240
    v_fma_f32 v102, v102, s28, v12
    v_mfma_f32_16x16x32_bf16 a[64:67], v[128:131], v[32:35], a[64:67]
    ds_read_b64_tr_b16 v[124:125], v3 offset:2048
    v_fma_f32 v109, v109, s28, v13
    v_mfma_f32_16x16x32_bf16 a[112:115], v[128:131], v[38:41], a[112:115]
    ds_read_b64_tr_b16 v[122:123], v2 offset:8192
    v_fma_f32 v111, v111, s28, v13
    v_mfma_f32_16x16x32_bf16 v[180:183], v[132:135], v[14:17], v[180:183]
    ds_read_b64_tr_b16 v[128:129], v4 offset:2048
    v_fma_f32 v110, v110, s28, v13
    v_mfma_f32_16x16x32_bf16 v[228:231], v[132:135], v[20:23], v[228:231]
    ds_read_b64_tr_b16 v[126:127], v3 offset:8192
    v_mfma_f32_16x16x32_bf16 a[20:23], v[132:135], v[26:29], a[20:23]
    ds_read_b64_tr_b16 v[120:121], v2 offset:2048
    v_fma_f32 v90, v90, s28, v11
    v_mfma_f32_16x16x32_bf16 a[68:71], v[132:135], v[32:35], a[68:71]
    s_add_u32 s39, s39, 12288
    v_exp_f32 v103, v103
    v_mfma_f32_16x16x32_bf16 a[116:119], v[132:135], v[38:41], a[116:119]
    s_waitcnt lgkmcnt(7)
    ds_read_b64_tr_b16 v[132:133], v5 offset:2048
    v_exp_f32 v102, v102
    v_mfma_f32_16x16x32_bf16 v[184:187], v[112:115], v[14:17], v[184:187]
    ds_read_b64_tr_b16 v[134:135], v5 offset:8192
    v_fma_f32 v99, v99, s28, v12
    v_mfma_f32_16x16x32_bf16 v[232:235], v[112:115], v[20:23], v[232:235]
    ds_read_b64_tr_b16 v[130:131], v4 offset:8192
    v_fma_f32 v100, v100, s28, v12
    v_mfma_f32_16x16x32_bf16 a[24:27], v[112:115], v[26:29], a[24:27]
    v_exp_f32 v89, v89
    v_mfma_f32_16x16x32_bf16 a[72:75], v[112:115], v[32:35], a[72:75]
    v_exp_f32 v85, v85
    v_mfma_f32_16x16x32_bf16 a[120:123], v[112:115], v[38:41], a[120:123]
    v_exp_f32 v109, v109
    v_mfma_f32_16x16x32_bf16 v[188:191], v[116:119], v[14:17], v[188:191]
    v_exp_f32 v97, v97
    v_mfma_f32_16x16x32_bf16 v[236:239], v[116:119], v[20:23], v[236:239]
    ds_read_b128 a[196:199], v153 offset:12288
    v_fma_f32 v84, v84, s28, v10
    v_mfma_f32_16x16x32_bf16 a[28:31], v[116:119], v[26:29], a[28:31]
    v_exp_f32 v91, v91
    v_mfma_f32_16x16x32_bf16 a[76:79], v[116:119], v[32:35], a[76:79]
    v_exp_f32 v86, v86
    v_mfma_f32_16x16x32_bf16 a[124:127], v[116:119], v[38:41], a[124:127]
    s_waitcnt lgkmcnt(3)
    v_exp_f32 v99, v99
    v_mfma_f32_16x16x32_bf16 v[192:195], v[120:123], v[14:17], v[192:195]
    ds_read_b128 a[172:175], v153 offset:6144
    v_fma_f32 v93, v93, s28, v11
    v_mfma_f32_16x16x32_bf16 v[240:243], v[120:123], v[20:23], v[240:243]
    s_waitcnt vmcnt(6) lgkmcnt(2)
    v_exp_f32 v76, v76
    v_mfma_f32_16x16x32_bf16 a[32:35], v[120:123], v[26:29], a[32:35]
    v_exp_f32 v77, v77
    v_mfma_f32_16x16x32_bf16 a[80:83], v[120:123], v[32:35], a[80:83]
    s_barrier
    v_mfma_f32_16x16x32_bf16 a[128:131], v[120:123], v[38:41], a[128:131]
    s_add_u32 s21, s21, s62
    ds_read_b128 a[164:167], v153 offset:4096
    v_fma_f32 v104, v104, s28, v13
    v_mfma_f32_16x16x32_bf16 v[196:199], v[124:127], v[14:17], v[196:199]
    ds_read_b128 v[112:115], v0 offset:0
    v_exp_f32 v90, v90
    v_mfma_f32_16x16x32_bf16 v[244:247], v[124:127], v[20:23], v[244:247]
    s_add_u32 m0, s22, 24576
    ds_read_b128 a[168:171], v152 offset:6144
    v_fma_f32 v108, v108, s28, v13
    v_mfma_f32_16x16x32_bf16 a[36:39], v[124:127], v[26:29], a[36:39]
    buffer_load_dwordx4 v6, s[8:11], s21 offen lds
    v_mfma_f32_16x16x32_bf16 a[84:87], v[124:127], v[32:35], a[84:87]
    ds_read_b128 v[120:123], v0 offset:1024
    v_exp_f32 v98, v98
    v_mfma_f32_16x16x32_bf16 a[132:135], v[124:127], v[38:41], a[132:135]
    ds_read_b128 a[152:155], v152 offset:2048
    v_cvt_pk_bf16_f32 v37, v98, v99
    v_mfma_f32_16x16x32_bf16 v[200:203], v[128:131], v[14:17], v[200:203]
    s_add_u32 s21, s21, 128
    ds_read_b128 a[188:191], v153 offset:10240
    v_fma_f32 v106, v106, s28, v13
    v_mfma_f32_16x16x32_bf16 v[248:251], v[128:131], v[20:23], v[248:251]
    ds_read_b128 v[116:119], v1 offset:0
    v_cvt_pk_bf16_f32 v31, v90, v91
    v_mfma_f32_16x16x32_bf16 a[40:43], v[128:131], v[26:29], a[40:43]
    ds_read_b128 a[192:195], v152 offset:12288
    s_add_u32 m0, s22, 25600
    v_mfma_f32_16x16x32_bf16 a[88:91], v[128:131], v[32:35], a[88:91]
    ds_read_b128 a[180:183], v153 offset:8192
    v_exp_f32 v87, v87
    v_mfma_f32_16x16x32_bf16 a[136:139], v[128:131], v[38:41], a[136:139]
    ds_read_b128 a[176:179], v152 offset:8192
    buffer_load_dwordx4 v6, s[8:11], s21 offen lds
    v_mfma_f32_16x16x32_bf16 v[204:207], v[132:135], v[14:17], v[204:207]
    s_add_u32 s21, s21, 128
    ds_read_b128 a[200:203], v152 offset:14336
    s_add_u32 m0, s22, 26624
    v_mfma_f32_16x16x32_bf16 v[252:255], v[132:135], v[20:23], v[252:255]
    buffer_load_dwordx4 v6, s[8:11], s21 offen lds
    v_mfma_f32_16x16x32_bf16 a[44:47], v[132:135], v[26:29], a[44:47]
    ds_read_b128 a[204:207], v153 offset:14336
    v_cvt_pk_bf16_f32 v23, v86, v87
    v_mfma_f32_16x16x32_bf16 a[92:95], v[132:135], v[32:35], a[92:95]
    ds_read_b128 a[212:215], v153 offset:16384
    v_mfma_f32_16x16x32_bf16 a[140:143], v[132:135], v[38:41], a[140:143]
    s_waitcnt lgkmcnt(8)
    ds_read_b128 v[124:127], v1 offset:1024
    v_mfma_f32_16x16x32_bf16 v[72:75], v[112:115], a[144:147], 0
    ds_read_b128 v[132:135], v1 offset:2048
    s_waitcnt lgkmcnt(8)
    v_mfma_f32_16x16x32_bf16 v[72:75], v[116:119], a[148:151], v[72:75]
    ds_read_b128 a[160:163], v152 offset:4096
    v_cvt_pk_bf16_f32 v36, v96, v97
    v_mfma_f32_16x16x32_bf16 v[72:75], v[120:123], a[152:155], v[72:75]
    ds_read_b128 v[128:131], v0 offset:2048
    v_cvt_pk_bf16_f32 v30, v88, v89
    v_mfma_f32_16x16x32_bf16 v[80:83], v[112:115], a[168:171], 0
    ds_read_b128 a[208:211], v152 offset:16384
    v_mfma_f32_16x16x32_bf16 v[80:83], v[116:119], a[172:175], v[80:83]
    s_waitcnt lgkmcnt(8)
    ds_read_b128 a[232:235], v152 offset:22528
    v_mfma_f32_16x16x32_bf16 v[80:83], v[120:123], a[176:179], v[80:83]
    v_exp_f32 v79, v79
    v_mfma_f32_16x16x32_bf16 v[88:91], v[112:115], a[192:195], 0
    s_add_u32 s21, s21, 12032
    v_exp_f32 v93, v93
    v_mfma_f32_16x16x32_bf16 v[88:91], v[116:119], a[196:199], v[88:91]
    s_waitcnt lgkmcnt(7)
    v_exp_f32 v94, v94
    v_mfma_f32_16x16x32_bf16 v[88:91], v[120:123], a[200:203], v[88:91]
    ds_read_b128 a[236:239], v153 offset:22528
    v_cvt_pk_bf16_f32 v16, v76, v77
    v_mfma_f32_16x16x32_bf16 v[96:99], v[112:115], a[216:219], 0
    ds_read_b128 a[228:231], v153 offset:20480
    v_mfma_f32_16x16x32_bf16 v[96:99], v[116:119], a[220:223], v[96:99]
    v_exp_f32 v84, v84
    v_mfma_f32_16x16x32_bf16 v[96:99], v[120:123], a[224:227], v[96:99]
    s_waitcnt lgkmcnt(5)
    ds_read_b128 v[112:115], v0 offset:6144
    v_cvt_pk_bf16_f32 v35, v102, v103
    v_mfma_f32_16x16x32_bf16 v[72:75], v[124:127], a[156:159], v[72:75]
    s_waitcnt lgkmcnt(5)
    v_exp_f32 v101, v101
    v_mfma_f32_16x16x32_bf16 v[72:75], v[128:131], a[160:163], v[72:75]
    ds_read_b128 v[120:123], v0 offset:7168
    v_mfma_f32_16x16x32_bf16 v[72:75], v[132:135], a[164:167], v[72:75]
    v_exp_f32 v100, v100
    v_mfma_f32_16x16x32_bf16 v[80:83], v[124:127], a[180:183], v[80:83]
    ds_read_b128 v[116:119], v1 offset:6144
    v_fma_f32 v95, v95, s28, v11
    v_mfma_f32_16x16x32_bf16 v[80:83], v[128:131], a[184:187], v[80:83]
    v_exp_f32 v110, v110
    v_mfma_f32_16x16x32_bf16 v[80:83], v[132:135], a[188:191], v[80:83]
    v_exp_f32 v108, v108
    v_mfma_f32_16x16x32_bf16 v[88:91], v[124:127], a[204:207], v[88:91]
    s_waitcnt lgkmcnt(4)
    v_exp_f32 v78, v78
    v_mfma_f32_16x16x32_bf16 v[88:91], v[128:131], a[208:211], v[88:91]
    v_exp_f32 v95, v95
    v_mfma_f32_16x16x32_bf16 v[88:91], v[132:135], a[212:215], v[88:91]
    s_waitcnt lgkmcnt(3)
    v_exp_f32 v92, v92
    v_mfma_f32_16x16x32_bf16 v[96:99], v[124:127], a[228:231], v[96:99]
    ds_read_b128 v[124:127], v1 offset:7168
    v_cvt_pk_bf16_f32 v17, v78, v79
    v_mfma_f32_16x16x32_bf16 v[96:99], v[128:131], a[232:235], v[96:99]
    ds_read_b128 v[128:131], v0 offset:8192
    v_cvt_pk_bf16_f32 v28, v92, v93
    v_mfma_f32_16x16x32_bf16 v[96:99], v[132:135], a[236:239], v[96:99]
    s_waitcnt lgkmcnt(3)
    ds_read_b128 v[132:135], v1 offset:8192
    v_mfma_f32_16x16x32_bf16 v[76:79], v[112:115], a[144:147], 0
    v_cvt_pk_bf16_f32 v22, v84, v85
    v_fma_f32 v105, v105, s28, v13
    v_mfma_f32_16x16x32_bf16 v[48:51], v[52:55], v[16:19], v[44:47]
    s_waitcnt lgkmcnt(3)
    v_exp_f32 v104, v104
    v_mfma_f32_16x16x32_bf16 v[76:79], v[116:119], a[148:151], v[76:79]
    v_cvt_pk_bf16_f32 v34, v100, v101
    v_cvt_pk_bf16_f32 v29, v94, v95
    v_mfma_f32_16x16x32_bf16 v[48:51], v[56:59], v[22:25], v[48:51]
    v_exp_f32 v106, v106
    v_mfma_f32_16x16x32_bf16 v[48:51], v[60:63], v[28:31], v[48:51]
    v_mfma_f32_16x16x32_bf16 v[76:79], v[120:123], a[152:155], v[76:79]
    v_exp_f32 v105, v105
    v_mfma_f32_16x16x32_bf16 v[84:87], v[112:115], a[168:171], 0
    v_exp_f32 v111, v111
    v_mfma_f32_16x16x32_bf16 v[84:87], v[116:119], a[172:175], v[84:87]
    v_exp_f32 v107, v107
    v_mfma_f32_16x16x32_bf16 v[84:87], v[120:123], a[176:179], v[84:87]
    v_cvt_pk_bf16_f32 v41, v110, v111
    s_waitcnt vmcnt(6) lgkmcnt(0)
    v_mfma_f32_16x16x32_bf16 v[48:51], v[64:67], v[34:37], v[48:51]
    s_barrier
    v_mfma_f32_16x16x32_bf16 v[92:95], v[112:115], a[192:195], 0
    v_cvt_pk_bf16_f32 v43, v106, v107
    v_mfma_f32_16x16x32_bf16 v[92:95], v[116:119], a[196:199], v[92:95]
    v_cvt_pk_bf16_f32 v42, v104, v105
    v_cvt_pk_bf16_f32 v40, v108, v109
    v_mfma_f32_16x16x32_bf16 v[92:95], v[120:123], a[200:203], v[92:95]
    s_nop 0
    v_mfma_f32_16x16x32_bf16 v[48:51], v[68:71], v[40:43], v[48:51]
    v_mfma_f32_16x16x32_bf16 v[100:103], v[112:115], a[216:219], 0
    ds_read_b64_tr_b16 v[112:113], v2 offset:18432
    v_mfma_f32_16x16x32_bf16 v[100:103], v[116:119], a[220:223], v[100:103]
    v_mfma_f32_16x16x32_bf16 v[100:103], v[120:123], a[224:227], v[100:103]
    ds_read_b64_tr_b16 v[114:115], v2 offset:12288
    v_mfma_f32_16x16x32_bf16 v[76:79], v[124:127], a[156:159], v[76:79]
    s_nop 1
    v_cmp_lt_f32 vcc, s29, v48
    v_mfma_f32_16x16x32_bf16 v[76:79], v[128:131], a[160:163], v[76:79]
    v_mfma_f32_16x16x32_bf16 v[76:79], v[132:135], a[164:167], v[76:79]
    ds_read_b64_tr_b16 v[116:117], v3 offset:18432
    v_mfma_f32_16x16x32_bf16 v[84:87], v[124:127], a[180:183], v[84:87]
    s_nop 0
    s_cbranch_vccnz L_rs_tr54b
L_ret_tr54b:
    v_mfma_f32_16x16x32_bf16 v[84:87], v[128:131], a[184:187], v[84:87]
    ds_read_b64_tr_b16 v[118:119], v3 offset:12288
    v_mfma_f32_16x16x32_bf16 v[84:87], v[132:135], a[188:191], v[84:87]
    ds_read_b64_tr_b16 v[120:121], v4 offset:18432
    s_add_u32 m0, s22, 0
    v_mfma_f32_16x16x32_bf16 v[92:95], v[124:127], a[204:207], v[92:95]
    buffer_load_dwordx4 v6, s[4:7], s20 offen lds
    v_mfma_f32_16x16x32_bf16 v[92:95], v[128:131], a[208:211], v[92:95]
    s_add_u32 s20, s20, 128
    s_add_u32 m0, s22, 1024
    ds_read_b64_tr_b16 v[122:123], v4 offset:12288
    v_mfma_f32_16x16x32_bf16 v[92:95], v[132:135], a[212:215], v[92:95]
    buffer_load_dwordx4 v6, s[4:7], s20 offen lds
    v_mfma_f32_16x16x32_bf16 v[100:103], v[124:127], a[228:231], v[100:103]
    s_add_u32 s20, s20, 128
    s_add_u32 m0, s22, 2048
    ds_read_b64_tr_b16 v[124:125], v5 offset:18432
    v_mfma_f32_16x16x32_bf16 v[100:103], v[128:131], a[232:235], v[100:103]
    buffer_load_dwordx4 v6, s[4:7], s20 offen lds
    v_mfma_f32_16x16x32_bf16 v[100:103], v[132:135], a[236:239], v[100:103]
    ds_read_b64_tr_b16 v[126:127], v5 offset:12288
    s_add_u32 s20, s20, 12032
    v_lshrrev_b32 v152, 11, v0
    s_waitcnt lgkmcnt(6)
    v_mfma_f32_16x16x32_bf16 v[160:163], v[112:115], v[16:19], v[160:163]
    s_mov_b32 s67, s34
    v_max3_f32 v150, v72, v73, v74
    v_max3_f32 v150, v150, v75, v76
    v_subrev_u32 v8, 28672, v8
    v_max3_f32 v150, v150, v77, v78
    v_max_f32 v150, v150, v79
    v_mov_b32 v151, v150
    v_mfma_f32_16x16x32_bf16 v[208:211], v[112:115], v[22:25], v[208:211]
    s_add_u32 s18, s34, 30720
    v_permlane32_swap_b32 v151, v150
    v_max_f32 v150, v150, v151
    v_mov_b32 v151, v150
    v_mfma_f32_16x16x32_bf16 a[0:3], v[112:115], v[28:31], a[0:3]
    s_mov_b32 s34, s33
    v_permlane16_swap_b32 v151, v150
    v_max_f32 v150, v150, v151
    v_mul_f32_e64 v9, -s28, v150
    v_max3_f32 v150, v80, v81, v82
    v_max3_f32 v150, v150, v83, v84
    v_max3_f32 v150, v150, v85, v86
    v_mfma_f32_16x16x32_bf16 a[48:51], v[112:115], v[34:37], a[48:51]
    s_add_u32 s64, s64, s62
    ds_read_b64_tr_b16 v[130:131], v2 offset:13312
    v_max_f32 v150, v150, v87
    v_mov_b32 v151, v150
    v_accvgpr_read_b32 v154, a2
    v_mfma_f32_16x16x32_bf16 a[96:99], v[112:115], v[40:43], a[96:99]
    s_waitcnt lgkmcnt(5)
    ds_read_b64_tr_b16 v[128:129], v2 offset:19456
    v_permlane32_swap_b32 v151, v150
    v_mfma_f32_16x16x32_bf16 v[164:167], v[116:119], v[16:19], v[164:167]
    s_add_u32 s64, s64, 196608
    v_max_f32 v150, v150, v151
    v_fma_f32 v77, v77, s28, v9
    v_mfma_f32_16x16x32_bf16 v[212:215], v[116:119], v[22:25], v[212:215]
    s_mov_b32 s39, s64
    v_mov_b32 v151, v150
    v_fma_f32 v75, v75, s28, v9
    v_mfma_f32_16x16x32_bf16 a[4:7], v[116:119], v[28:31], a[4:7]
    ds_read_b64_tr_b16 v[134:135], v3 offset:13312
    v_fma_f32 v72, v72, s28, v9
    v_mfma_f32_16x16x32_bf16 a[52:55], v[116:119], v[34:37], a[52:55]
    s_add_u32 s37, s37, 1
    v_permlane16_swap_b32 v151, v150
    v_max_f32 v150, v150, v151
    v_mul_f32_e64 v10, -s28, v150
    v_max3_f32 v150, v88, v89, v90
    v_mfma_f32_16x16x32_bf16 a[100:103], v[116:119], v[40:43], a[100:103]
    s_waitcnt lgkmcnt(3)
    v_fma_f32 v83, v83, s28, v10
    v_fma_f32 v73, v73, s28, v9
    v_rcp_f32 v49, v49
    v_mfma_f32_16x16x32_bf16 v[168:171], v[120:123], v[16:19], v[168:171]
    s_bitcmp1_b32 s63, s37
    ds_read_b64_tr_b16 v[132:133], v3 offset:19456
    v_fma_f32 v74, v74, s28, v9
    v_max3_f32 v150, v150, v91, v92
    v_mul_f32 v213, v213, v49
    v_mfma_f32_16x16x32_bf16 v[216:219], v[120:123], v[22:25], v[216:219]
    s_cselect_b32 s62, 4294770688, 0
    ds_read_b64_tr_b16 v[114:115], v4 offset:13312
    v_max3_f32 v150, v150, v93, v94
    v_mfma_f32_16x16x32_bf16 a[8:11], v[120:123], v[28:31], a[8:11]
    s_cselect_b32 s42, 0, 325632
    ds_read_b64_tr_b16 v[118:119], v5 offset:13312
    v_max_f32 v150, v150, v95
    v_mov_b32 v151, v150
    v_mfma_f32_16x16x32_bf16 a[56:59], v[120:123], v[34:37], a[56:59]
    s_add_u32 s35, s35, s42
    v_rcp_f32 v51, v51
    v_permlane32_swap_b32 v151, v150
    v_mfma_f32_16x16x32_bf16 a[104:107], v[120:123], v[40:43], a[104:107]
    s_lshl_b32 s42, s37, 1
    v_accvgpr_read_b32 v109, a5
    v_max_f32 v150, v150, v151
    v_mfma_f32_16x16x32_bf16 v[172:175], v[124:127], v[16:19], v[172:175]
    s_lshr_b32 s42, s31, s42
    ds_read_b64_tr_b16 v[116:117], v5 offset:19456
    v_exp_f32 v77, v77
    v_mov_b32 v151, v150
    v_mov_b32 v148, v48
    v_mfma_f32_16x16x32_bf16 v[220:223], v[124:127], v[22:25], v[220:223]
    s_and_b32 s42, s42, 3
    v_and_b32 v149, 0x3ff, v0
    v_xor_b32 v152, s65, v152
    v_fma_f32 v81, v81, s28, v10
    v_mfma_f32_16x16x32_bf16 a[12:15], v[124:127], v[28:31], a[12:15]
    s_add_u32 s42, s42, s36
    v_permlane16_swap_b32 v151, v150
    v_max_f32 v150, v150, v151
    v_permlane32_swap_b32 v48, v148
    v_mfma_f32_16x16x32_bf16 a[60:63], v[124:127], v[34:37], a[60:63]
    s_sub_u32 s43, s42, 3
    v_exp_f32 v75, v75
    v_mul_f32_e64 v11, -s28, v150
    v_max3_f32 v150, v96, v97, v98
    v_mfma_f32_16x16x32_bf16 a[108:111], v[124:127], v[40:43], a[108:111]
    s_waitcnt lgkmcnt(1)
    ds_read_b64_tr_b16 v[112:113], v4 offset:19456
    v_fma_f32 v86, v86, s28, v10
    v_fma_f32 v90, v90, s28, v11
    v_mfma_f32_16x16x32_bf16 v[176:179], v[128:131], v[16:19], v[176:179]
    s_cmp_ge_u32 s42, 3
    ds_read_b64_tr_b16 v[122:123], v2 offset:14336
    v_accvgpr_read_b32 v158, a50
    v_mfma_f32_16x16x32_bf16 v[224:227], v[128:131], v[22:25], v[224:227]
    s_cselect_b32 s42, s43, s42
    ds_read_b64_tr_b16 v[120:121], v2 offset:20480
    v_max3_f32 v150, v150, v99, v100
    v_fma_f32 v93, v93, s28, v11
    v_accvgpr_read_b32 v155, a3
    v_mfma_f32_16x16x32_bf16 a[16:19], v[128:131], v[28:31], a[16:19]
    s_mul_i32 s44, s3, 5
    v_lshl_add_u32 v149, v152, 10, v149
    v_fma_f32 v76, v76, s28, v9
    v_fma_f32 v84, v84, s28, v10
    v_mfma_f32_16x16x32_bf16 a[64:67], v[128:131], v[34:37], a[64:67]
    s_mov_b32 s32, 1
    v_accvgpr_read_b32 v156, a48
    v_accvgpr_read_b32 v105, a97
    v_mfma_f32_16x16x32_bf16 a[112:115], v[128:131], v[40:43], a[112:115]
    s_lshl_b32 s43, s3, 2
    ds_read_b64_tr_b16 v[130:131], v4 offset:14336
    v_exp_f32 v74, v74
    v_mfma_f32_16x16x32_bf16 v[180:183], v[132:135], v[16:19], v[180:183]
    s_add_u32 s45, s43, 21
    v_accvgpr_read_b32 v111, a7
    v_accvgpr_read_b32 v153, a1
    v_max3_f32 v150, v150, v101, v102
    v_fma_f32 v89, v89, s28, v11
    v_mfma_f32_16x16x32_bf16 v[228:231], v[132:135], v[22:25], v[228:231]
    s_cmp_eq_u32 s3, 0
    v_accvgpr_read_b32 v110, a6
    v_fma_f32 v95, v95, s28, v11
    v_mfma_f32_16x16x32_bf16 a[20:23], v[132:135], v[28:31], a[20:23]
    s_cselect_b32 s45, 20, s45
    v_fma_f32 v82, v82, s28, v10
    v_max_f32 v150, v150, v103
    v_mfma_f32_16x16x32_bf16 a[68:71], v[132:135], v[34:37], a[68:71]
    s_cselect_b32 s33, 1, 0
    ds_read_b64_tr_b16 v[124:125], v3 offset:20480
    v_mbcnt_lo_u32_b32 v152, -1, 0
    v_mul_f32 v208, v208, v49
    v_mfma_f32_16x16x32_bf16 a[116:119], v[132:135], v[40:43], a[116:119]
    s_waitcnt lgkmcnt(2)
    v_fma_f32 v88, v88, s28, v11
    v_rcp_f32 v48, v48
    v_mfma_f32_16x16x32_bf16 v[184:187], v[112:115], v[16:19], v[184:187]
    s_cmp_eq_u32 s42, 1
    v_exp_f32 v93, v93
    v_exp_f32 v73, v73
    v_mfma_f32_16x16x32_bf16 v[232:235], v[112:115], v[22:25], v[232:235]
    s_cselect_b32 s44, s45, s44
    v_mov_b32 v151, v150
    v_exp_f32 v81, v81
    v_fma_f32 v79, v79, s28, v9
    v_mfma_f32_16x16x32_bf16 a[24:27], v[112:115], v[28:31], a[24:27]
    s_cselect_b32 s32, s33, s32
    ds_read_b64_tr_b16 v[134:135], v5 offset:14336
    v_rcp_f32 v50, v50
    v_mfma_f32_16x16x32_bf16 a[72:75], v[112:115], v[34:37], a[72:75]
    s_add_u32 s45, s43, 37
    v_exp_f32 v72, v72
    v_mfma_f32_16x16x32_bf16 a[120:123], v[112:115], v[40:43], a[120:123]
    s_cmp_eq_u32 s42, 2
    ds_read_b64_tr_b16 v[126:127], v3 offset:14336
    v_cvt_pk_bf16_f32 v14, v72, v73
    v_mfma_f32_16x16x32_bf16 v[188:191], v[116:119], v[16:19], v[188:191]
    s_cselect_b32 s44, s45, s44
    v_permlane32_swap_b32 v151, v150
    v_mul_f32 v209, v209, v49
    v_mfma_f32_16x16x32_bf16 v[236:239], v[116:119], v[22:25], v[236:239]
    s_cselect_b32 s32, 0, s32
    ds_read_b64_tr_b16 v[128:129], v4 offset:20480
    v_accvgpr_read_b32 v108, a4
    v_mfma_f32_16x16x32_bf16 a[28:31], v[116:119], v[28:31], a[28:31]
    v_accvgpr_read_b32 v159, a51
    v_mul_f32 v214, v214, v49
    v_max_f32 v150, v150, v151
    v_mul_f32 v158, v158, v51
    v_mfma_f32_16x16x32_bf16 a[76:79], v[116:119], v[34:37], a[76:79]
    s_mul_i32 s44, s44, 6144
    v_exp_f32 v84, v84
    v_mov_b32 v151, v150
    v_mfma_f32_16x16x32_bf16 a[124:127], v[116:119], v[40:43], a[124:127]
    s_add_u32 s33, s35, s44
    v_fma_f32 v85, v85, s28, v10
    v_mul_f32 v215, v215, v49
    v_exp_f32 v82, v82
    v_mfma_f32_16x16x32_bf16 v[192:195], v[120:123], v[16:19], v[192:195]
    s_mul_i32 s42, s32, 6144
    v_mul_f32 v231, v231, v49
    v_mbcnt_hi_u32_b32 v152, -1, v152
    v_exp_f32 v79, v79
    v_mfma_f32_16x16x32_bf16 v[240:243], v[120:123], v[22:25], v[240:243]
    s_add_u32 s42, s42, 24576
    v_fma_f32 v92, v92, s28, v11
    v_permlane16_swap_b32 v151, v150
    v_mul_f32 v239, v239, v49
    v_max_f32 v150, v150, v151
    v_mfma_f32_16x16x32_bf16 a[32:35], v[120:123], v[28:31], a[32:35]
    s_add_u32 s42, s42, s33
    ds_read_b64_tr_b16 v[132:133], v5 offset:20480
    v_mul_f32 v230, v230, v49
    v_mfma_f32_16x16x32_bf16 a[80:83], v[120:123], v[34:37], a[80:83]
    s_cmp_ge_u32 s37, 6
    v_fma_f32 v78, v78, s28, v9
    v_fma_f32 v91, v91, s28, v11
    v_mfma_f32_16x16x32_bf16 a[128:131], v[120:123], v[40:43], a[128:131]
    s_waitcnt lgkmcnt(1)
    v_exp_f32 v83, v83
    v_mfma_f32_16x16x32_bf16 v[196:199], v[124:127], v[16:19], v[196:199]
    s_cselect_b32 s14, 0, s42
    v_mul_f32 v221, v221, v49
    v_mul_f32 v156, v156, v51
    v_lshrrev_b32 v152, 1, v152
    v_mfma_f32_16x16x32_bf16 v[244:247], v[124:127], v[22:25], v[244:247]
    s_add_u32 s24, s67, 6400
    v_mul_f32 v243, v243, v49
    v_exp_f32 v89, v89
    v_mfma_f32_16x16x32_bf16 a[36:39], v[124:127], v[28:31], a[36:39]
    s_add_u32 s25, s33, 6400
    v_mul_f32_e64 v12, -s28, v150
    v_mul_f32 v216, v216, v49
    v_accvgpr_read_b32 v157, a49
    v_mfma_f32_16x16x32_bf16 a[84:87], v[124:127], v[34:37], a[84:87]
    s_add_u32 s23, s38, 10240
    v_fma_f32 v99, v99, s28, v12
    v_accvgpr_read_b32 v107, a99
    v_mfma_f32_16x16x32_bf16 a[132:135], v[124:127], v[40:43], a[132:135]
    s_mov_b32 s27, 0x49249249
    v_mul_f32 v210, v210, v49
    v_mul_f32 v217, v217, v49
    v_mfma_f32_16x16x32_bf16 v[200:203], v[128:131], v[16:19], v[200:203]
    s_mov_b32 s30, 0
    v_fma_f32 v97, v97, s28, v12
    v_fma_f32 v80, v80, s28, v10
    v_mfma_f32_16x16x32_bf16 v[248:251], v[128:131], v[22:25], v[248:251]
    s_waitcnt vmcnt(6) lgkmcnt(0)
    v_mul_f32 v228, v228, v49
    v_cvt_pk_bf16_f32 v21, v82, v83
    v_mfma_f32_16x16x32_bf16 a[40:43], v[128:131], v[28:31], a[40:43]
    s_barrier
    ds_read_b128 v[112:115], v0 offset:12288
    v_fma_f32 v100, v100, s28, v12
    v_mul_f32 v241, v241, v49
    v_fma_f32 v87, v87, s28, v10
    v_mfma_f32_16x16x32_bf16 a[88:91], v[128:131], v[34:37], a[88:91]
    ds_read_b128 v[120:123], v0 offset:13312
    v_fma_f32 v96, v96, s28, v12
    v_mul_f32 v223, v223, v49
    v_mfma_f32_16x16x32_bf16 a[136:139], v[128:131], v[40:43], a[136:139]
    ds_read_b128 v[116:119], v1 offset:12288
    v_exp_f32 v80, v80
    v_exp_f32 v91, v91
    v_pk_mul_f32 v[172:173], v[172:173], v[48:49] op_sel_hi:[1,0]
    v_mul_f32 v218, v218, v49
    v_pk_mul_f32 v[110:111], v[110:111], v[50:51] op_sel_hi:[1,0]
    v_add_u32 v149, s38, v149
    v_exp_f32 v88, v88
    v_pk_mul_f32 v[166:167], v[166:167], v[48:49] op_sel_hi:[1,0]
    v_mul_f32 v237, v237, v49
    v_pk_mul_f32 v[188:189], v[188:189], v[48:49] op_sel_hi:[1,0]
    v_cvt_pk_bf16_f32 v20, v80, v81
    v_and_b32 v152, 24, v152
    v_cvt_pk_bf16_f32 v26, v88, v89
    v_mul_f32 v222, v222, v49
    v_pk_mul_f32 v[170:171], v[170:171], v[48:49] op_sel_hi:[1,0]
    v_bfe_u32 v152, s66, v152, 8
    v_exp_f32 v96, v96
    v_fma_f32 v94, v94, s28, v11
    v_pk_mul_f32 v[160:161], v[160:161], v[48:49] op_sel_hi:[1,0]
    v_mul_f32 v244, v244, v49
    v_mul_f32 v157, v157, v51
    v_mul_f32 v225, v225, v49
    v_mfma_f32_16x16x32_bf16 v[204:207], v[132:135], v[16:19], v[204:207]
    v_xor_b32 v149, v149, v152
    v_mul_f32 v227, v227, v49
    v_cvt_pk_bf16_f32 v15, v74, v75
    v_mfma_f32_16x16x32_bf16 v[252:255], v[132:135], v[22:25], v[252:255]
    v_exp_f32 v97, v97
    v_mfma_f32_16x16x32_bf16 a[44:47], v[132:135], v[28:31], a[44:47]
    v_exp_f32 v87, v87
    v_mfma_f32_16x16x32_bf16 a[92:95], v[132:135], v[34:37], a[92:95]
    v_accvgpr_read_b32 v104, a96
    v_mov_b32 v152, v148
    v_exp_f32 v92, v92
    v_mfma_f32_16x16x32_bf16 a[140:143], v[132:135], v[40:43], a[140:143]
    s_waitcnt lgkmcnt(0)
    ds_read_b128 v[124:127], v1 offset:13312
    v_exp_f32 v86, v86
    v_mfma_f32_16x16x32_bf16 v[72:75], v[112:115], a[144:147], 0
    v_exp_f32 v100, v100
    v_fma_f32 v98, v98, s28, v12
    v_mul_f32 v235, v235, v49
    v_mfma_f32_16x16x32_bf16 v[72:75], v[116:119], a[148:151], v[72:75]
    ds_read_b128 v[128:131], v0 offset:14336
    v_mul_f32 v252, v252, v49
    v_mfma_f32_16x16x32_bf16 v[72:75], v[120:123], a[152:155], v[72:75]
    v_mul_f32 v240, v240, v49
    v_exp_f32 v90, v90
    v_mfma_f32_16x16x32_bf16 v[80:83], v[112:115], a[168:171], 0
    v_exp_f32 v85, v85
    v_exp_f32 v99, v99
    v_mfma_f32_16x16x32_bf16 v[80:83], v[116:119], a[172:175], v[80:83]
    v_exp_f32 v98, v98
    v_mfma_f32_16x16x32_bf16 v[80:83], v[120:123], a[176:179], v[80:83]
    s_add_u32 m0, s22, 36864
    ds_read_b128 v[132:135], v1 offset:14336
    v_cvt_pk_bf16_f32 v33, v98, v99
    v_mul_f32 v159, v159, v51
    v_permlane16_swap_b32 v148, v152
    v_mul_f32 v238, v238, v49
    v_pk_mul_f32 v[164:165], v[164:165], v[48:49] op_sel_hi:[1,0]
    v_mul_f32 v251, v251, v49
    v_pk_mul_f32 v[154:155], v[154:155], v[50:51] op_sel_hi:[1,0]
    v_fma_f32 v102, v102, s28, v12
    v_exp_f32 v76, v76
    v_mul_f32 v212, v212, v49
    v_cvt_pk_bf16_f32 v23, v86, v87
    v_pk_mul_f32 v[174:175], v[174:175], v[48:49] op_sel_hi:[1,0]
    v_pk_mul_f32 v[108:109], v[108:109], v[50:51] op_sel_hi:[1,0]
    v_mul_f32 v250, v250, v49
    v_cvt_pk_bf16_f32 v27, v90, v91
    v_fma_f32 v101, v101, s28, v12
    v_pk_mul_f32 v[162:163], v[162:163], v[48:49] op_sel_hi:[1,0]
    v_mul_f32 v224, v224, v49
    v_cvt_pk_bf16_f32 v32, v96, v97
    v_exp_f32 v94, v94
    v_mul_f32 v236, v236, v49
    v_exp_f32 v101, v101
    v_mfma_f32_16x16x32_bf16 v[88:91], v[112:115], a[192:195], 0
    buffer_load_dwordx4 v6, s[8:11], s21 offen lds
    v_mfma_f32_16x16x32_bf16 v[88:91], v[116:119], a[196:199], v[88:91]
    v_cvt_pk_bf16_f32 v108, v108, v109
    v_mul_f32 v211, v211, v49
    v_mfma_f32_16x16x32_bf16 v[88:91], v[120:123], a[200:203], v[88:91]
    v_cvt_pk_bf16_f32 v156, v156, v157
    v_exp_f32 v95, v95
    v_mfma_f32_16x16x32_bf16 v[96:99], v[112:115], a[216:219], 0
    s_add_u32 s21, s21, 128
    v_cvt_pk_bf16_f32 v172, v172, v173
    v_mul_f32 v253, v253, v49
    v_accvgpr_read_b32 v152, a0
    v_cvt_pk_bf16_f32 v164, v164, v165
    v_mfma_f32_16x16x32_bf16 v[96:99], v[116:119], a[220:223], v[96:99]
    ds_read_b128 v[116:119], v1 offset:18432
    v_cvt_pk_bf16_f32 v157, v158, v159
    v_mfma_f32_16x16x32_bf16 v[96:99], v[120:123], a[224:227], v[96:99]
    s_waitcnt lgkmcnt(1)
    v_rcp_f32 v148, v148
    v_mfma_f32_16x16x32_bf16 v[72:75], v[124:127], a[156:159], v[72:75]
    v_cvt_pk_bf16_f32 v252, v252, v253
    v_mul_f32 v220, v220, v49
    v_exp_f32 v78, v78
    v_mfma_f32_16x16x32_bf16 v[72:75], v[128:131], a[160:163], v[72:75]
    ds_read_b128 v[112:115], v0 offset:18432
    v_cvt_pk_bf16_f32 v208, v208, v209
    v_mfma_f32_16x16x32_bf16 v[72:75], v[132:135], a[164:167], v[72:75]
    v_cvt_pk_bf16_f32 v22, v84, v85
    v_fma_f32 v103, v103, s28, v12
    v_mfma_f32_16x16x32_bf16 v[80:83], v[124:127], a[180:183], v[80:83]
    ds_read_b128 v[120:123], v0 offset:19456
    v_cvt_pk_bf16_f32 v16, v76, v77
    v_mfma_f32_16x16x32_bf16 v[80:83], v[128:131], a[184:187], v[80:83]
    v_cvt_pk_bf16_f32 v160, v160, v161
    v_cvt_pk_bf16_f32 v29, v94, v95
    v_accvgpr_read_b32 v106, a98
    v_mfma_f32_16x16x32_bf16 v[80:83], v[132:135], a[188:191], v[80:83]
    s_add_u32 m0, s22, 37888
    v_exp_f32 v103, v103
    v_mfma_f32_16x16x32_bf16 v[88:91], v[124:127], a[204:207], v[88:91]
    buffer_load_dwordx4 v6, s[8:11], s21 offen lds
    v_cvt_pk_bf16_f32 v28, v92, v93
    v_cvt_pk_bf16_f32 v109, v110, v111
    v_cvt_pk_bf16_f32 v224, v224, v225
    v_mfma_f32_16x16x32_bf16 v[88:91], v[128:131], a[208:211], v[88:91]
    v_accvgpr_read_b32 v159, a103
    v_cvt_pk_bf16_f32 v161, v162, v163
    v_mfma_f32_16x16x32_bf16 v[88:91], v[132:135], a[212:215], v[88:91]
    s_add_u32 s21, s21, 128
    v_mul_f32 v254, v254, v49
    v_cvt_pk_bf16_f32 v17, v78, v79
    v_mfma_f32_16x16x32_bf16 v[96:99], v[124:127], a[228:231], v[96:99]
    s_add_u32 m0, s22, 38912
    v_cvt_pk_bf16_f32 v209, v210, v211
    v_fma_f32 v72, v72, s28, v9
    v_fma_f32 v73, v73, s28, v9
    v_exp_f32 v102, v102
    v_mfma_f32_16x16x32_bf16 v[96:99], v[128:131], a[232:235], v[96:99]
    buffer_load_dwordx4 v6, s[8:11], s21 offen lds
    v_mfma_f32_16x16x32_bf16 v[96:99], v[132:135], a[236:239], v[96:99]
    s_waitcnt lgkmcnt(0)
    ds_read_b128 v[128:131], v0 offset:20480
    v_mul_f32 v226, v226, v49
    v_mfma_f32_16x16x32_bf16 v[76:79], v[112:115], a[144:147], 0
    v_cvt_pk_bf16_f32 v173, v174, v175
    v_mul_f32 v249, v249, v49
    v_mfma_f32_16x16x32_bf16 v[76:79], v[116:119], a[148:151], v[76:79]
    s_add_u32 s21, s21, 12032
    ds_read_b128 v[132:135], v1 offset:20480
    v_mul_f32 v219, v219, v49
    v_mfma_f32_16x16x32_bf16 v[76:79], v[120:123], a[152:155], v[76:79]
    ds_read_b128 v[124:127], v1 offset:19456
    v_cvt_pk_bf16_f32 v34, v100, v101
    v_accvgpr_read_b32 v158, a102
    v_mfma_f32_16x16x32_bf16 v[84:87], v[112:115], a[168:171], 0
    ds_write2st64_b64 v149, v[160:161], v[208:209] offset0:0 offset1:12
    v_pk_mul_f32 v[152:153], v[152:153], v[50:51] op_sel_hi:[1,0]
    v_accvgpr_read_b32 v110, a58
    v_pk_mul_f32 v[104:105], v[104:105], v[148:149] op_sel_hi:[1,0]
    v_pk_mul_f32 v[106:107], v[106:107], v[148:149] op_sel_hi:[1,0]
    v_cvt_pk_bf16_f32 v212, v212, v213
    v_pk_mul_f32 v[168:169], v[168:169], v[48:49] op_sel_hi:[1,0]
    v_cvt_pk_bf16_f32 v152, v152, v153
    v_cvt_pk_bf16_f32 v104, v104, v105
    v_mfma_f32_16x16x32_bf16 v[84:87], v[116:119], a[172:175], v[84:87]
    v_cvt_pk_bf16_f32 v153, v154, v155
    v_cvt_pk_bf16_f32 v35, v102, v103
    v_mfma_f32_16x16x32_bf16 v[84:87], v[120:123], a[176:179], v[84:87]
    ds_write2st64_b64 v149, v[152:153], v[156:157] offset0:24 offset1:36
    v_mfma_f32_16x16x32_bf16 v[92:95], v[112:115], a[192:195], 0
    v_cvt_pk_bf16_f32 v165, v166, v167
    v_fma_f32 v98, v98, s28, v12
    v_mfma_f32_16x16x32_bf16 v[92:95], v[116:119], a[196:199], v[92:95]
    v_accvgpr_read_b32 v155, a55
    v_accvgpr_read_b32 v152, a52
    v_fma_f32 v88, v88, s28, v11
    v_mfma_f32_16x16x32_bf16 v[44:47], v[52:55], v[14:17], 0
    s_waitcnt vmcnt(6) lgkmcnt(2)
    v_accvgpr_read_b32 v111, a59
    v_accvgpr_read_b32 v154, a54
    v_accvgpr_read_b32 v157, a101
    v_fma_f32 v80, v80, s28, v10
    v_mfma_f32_16x16x32_bf16 v[92:95], v[120:123], a[200:203], v[92:95]
    s_barrier
    v_cvt_pk_bf16_f32 v105, v106, v107
    v_mfma_f32_16x16x32_bf16 v[100:103], v[112:115], a[216:219], 0
    v_fma_f32 v74, v74, s28, v9
    v_exp_f32 v98, v98
    v_cvt_pk_bf16_f32 v168, v168, v169
    v_fma_f32 v99, v99, s28, v12
    v_mfma_f32_16x16x32_bf16 v[100:103], v[116:119], a[220:223], v[100:103]
    v_mul_f32 v154, v154, v51
    v_mul_f32 v232, v232, v49
    v_cvt_pk_bf16_f32 v220, v220, v221
    v_mfma_f32_16x16x32_bf16 v[44:47], v[56:59], v[20:23], v[44:47]
    v_exp_f32 v74, v74
    v_mfma_f32_16x16x32_bf16 v[100:103], v[120:123], a[224:227], v[100:103]
    s_add_u32 m0, s22, 12288
    ds_write_b64 v149, v[104:105] offset:24576
    v_xor_b32 v149, 32, v149
    v_mul_f32 v233, v233, v49
    v_accvgpr_read_b32 v153, a53
    v_mfma_f32_16x16x32_bf16 v[76:79], v[124:127], a[156:159], v[76:79]
    ds_read_b64_tr_b16 v[112:113], v2 offset:0
    v_mul_f32 v153, v153, v51
    v_mfma_f32_16x16x32_bf16 v[76:79], v[128:131], a[160:163], v[76:79]
    v_fma_f32 v97, v97, s28, v12
    v_accvgpr_read_b32 v107, a11
    v_mfma_f32_16x16x32_bf16 v[76:79], v[132:135], a[164:167], v[76:79]
    ds_read_b64_tr_b16 v[114:115], v2 offset:6144
    v_cvt_pk_bf16_f32 v213, v214, v215
    v_mul_f32 v111, v111, v51
    v_mfma_f32_16x16x32_bf16 v[84:87], v[124:127], a[180:183], v[84:87]
    ds_read_b64_tr_b16 v[116:117], v3 offset:0
    v_mul_f32 v152, v152, v51
    v_mfma_f32_16x16x32_bf16 v[84:87], v[128:131], a[184:187], v[84:87]
    ds_write2st64_b64 v149, v[164:165], v[212:213] offset0:0 offset1:12
    v_fma_f32 v96, v96, s28, v12
    v_mfma_f32_16x16x32_bf16 v[84:87], v[132:135], a[188:191], v[84:87]
    buffer_load_dwordx4 v6, s[4:7], s20 offen lds
    ds_read_b64_tr_b16 v[118:119], v3 offset:6144
    v_mfma_f32_16x16x32_bf16 v[92:95], v[124:127], a[204:207], v[92:95]
    v_fma_f32 v91, v91, s28, v11
    v_cvt_pk_bf16_f32 v216, v216, v217
    v_mfma_f32_16x16x32_bf16 v[92:95], v[128:131], a[208:211], v[92:95]
    ds_read_b64_tr_b16 v[120:121], v4 offset:0
    v_accvgpr_read_b32 v104, a8
    v_mfma_f32_16x16x32_bf16 v[92:95], v[132:135], a[212:215], v[92:95]
    v_mul_f32 v155, v155, v51
    v_cvt_pk_bf16_f32 v152, v152, v153
    v_accvgpr_read_b32 v106, a10
    v_accvgpr_read_b32 v156, a100
    v_cvt_pk_bf16_f32 v153, v154, v155
    v_pk_mul_f32 v[106:107], v[106:107], v[50:51] op_sel_hi:[1,0]
    v_mul_f32 v229, v229, v49
    v_pk_mul_f32 v[158:159], v[158:159], v[148:149] op_sel_hi:[1,0]
    v_accvgpr_read_b32 v105, a9
    v_pk_mul_f32 v[104:105], v[104:105], v[50:51] op_sel_hi:[1,0]
    v_exp_f32 v73, v73
    v_cvt_pk_bf16_f32 v240, v240, v241
    v_mul_f32 v248, v248, v49
    v_fma_f32 v79, v79, s28, v9
    v_pk_mul_f32 v[180:181], v[180:181], v[48:49] op_sel_hi:[1,0]
    v_cvt_pk_bf16_f32 v169, v170, v171
    v_pk_mul_f32 v[176:177], v[176:177], v[48:49] op_sel_hi:[1,0]
    v_pk_mul_f32 v[194:195], v[194:195], v[48:49] op_sel_hi:[1,0]
    v_cvt_pk_bf16_f32 v221, v222, v223
    v_fma_f32 v82, v82, s28, v10
    v_mfma_f32_16x16x32_bf16 v[100:103], v[124:127], a[228:231], v[100:103]
    s_add_u32 s20, s20, 128
    ds_write2st64_b64 v149, v[108:109], v[152:153] offset0:24 offset1:36
    v_pk_mul_f32 v[156:157], v[156:157], v[148:149] op_sel_hi:[1,0]
    v_fma_f32 v92, v92, s28, v11
    v_cvt_pk_bf16_f32 v156, v156, v157
    v_pk_mul_f32 v[190:191], v[190:191], v[48:49] op_sel_hi:[1,0]
    v_pk_mul_f32 v[198:199], v[198:199], v[48:49] op_sel_hi:[1,0]
    v_fma_f32 v89, v89, s28, v11
    v_accvgpr_read_b32 v109, a57
    v_cvt_pk_bf16_f32 v157, v158, v159
    v_pk_mul_f32 v[204:205], v[204:205], v[48:49] op_sel_hi:[1,0]
    v_accvgpr_read_b32 v155, a107
    v_accvgpr_read_b32 v158, a14
    v_accvgpr_read_b32 v108, a56
    v_mfma_f32_16x16x32_bf16 v[100:103], v[128:131], a[232:235], v[100:103]
    s_add_u32 m0, s22, 13312
    ds_write_b64 v149, v[156:157] offset:24576
    v_accvgpr_read_b32 v159, a15
    v_mfma_f32_16x16x32_bf16 v[100:103], v[132:135], a[236:239], v[100:103]
    s_waitcnt lgkmcnt(2)
    ds_read_b64_tr_b16 v[122:123], v4 offset:6144
    buffer_load_dwordx4 v6, s[4:7], s20 offen lds
    v_mul_f32 v110, v110, v51
    v_mfma_f32_16x16x32_bf16 v[160:163], v[112:115], v[14:17], 0
    v_cvt_pk_bf16_f32 v217, v218, v219
    v_accvgpr_read_b32 v154, a106
    v_mul_f32 v108, v108, v51
    v_accvgpr_read_b32 v153, a105
    v_cvt_pk_bf16_f32 v104, v104, v105
    v_pk_mul_f32 v[154:155], v[154:155], v[148:149] op_sel_hi:[1,0]
    v_mul_f32 v245, v245, v49
    v_accvgpr_read_b32 v152, a104
    v_pk_mul_f32 v[192:193], v[192:193], v[48:49] op_sel_hi:[1,0]
    v_cvt_pk_bf16_f32 v105, v106, v107
    v_pk_mul_f32 v[152:153], v[152:153], v[148:149] op_sel_hi:[1,0]
    v_cvt_pk_bf16_f32 v236, v236, v237
    v_cvt_pk_bf16_f32 v188, v188, v189
    v_cvt_pk_bf16_f32 v152, v152, v153
    v_xor_b32 v149, 96, v149
    v_pk_mul_f32 v[182:183], v[182:183], v[48:49] op_sel_hi:[1,0]
    v_mul_f32 v109, v109, v51
    v_accvgpr_read_b32 v106, a62
    v_mfma_f32_16x16x32_bf16 v[208:211], v[112:115], v[20:23], 0
    ds_read_b64_tr_b16 v[124:125], v5 offset:0
    v_fma_f32 v83, v83, s28, v10
    v_mfma_f32_16x16x32_bf16 v[44:47], v[60:63], v[26:29], v[44:47]
    ds_read_b64_tr_b16 v[126:127], v5 offset:6144
    v_cvt_pk_bf16_f32 v153, v154, v155
    v_cvt_pk_bf16_f32 v248, v248, v249
    v_accvgpr_read_b32 v157, a13
    v_accvgpr_read_b32 v156, a12
    v_accvgpr_read_b32 v107, a63
    v_mfma_f32_16x16x32_bf16 a[0:3], v[112:115], v[26:29], 0
    ds_read_b64_tr_b16 v[130:131], v2 offset:7168
    v_mul_f32 v106, v106, v51
    v_cvt_pk_bf16_f32 v108, v108, v109
    v_mfma_f32_16x16x32_bf16 a[48:51], v[112:115], v[32:35], 0
    s_add_u32 s20, s20, 128
    ds_read_b64_tr_b16 v[132:133], v3 offset:1024
    v_cvt_pk_bf16_f32 v180, v180, v181
    v_mfma_f32_16x16x32_bf16 v[164:167], v[116:119], v[14:17], 0
    s_add_u32 m0, s22, 14336
    ds_write2st64_b64 v149, v[168:169], v[216:217] offset0:0 offset1:12
    v_pk_mul_f32 v[156:157], v[156:157], v[50:51] op_sel_hi:[1,0]
    v_pk_mul_f32 v[158:159], v[158:159], v[50:51] op_sel_hi:[1,0]
    v_cvt_pk_bf16_f32 v109, v110, v111
    v_cvt_pk_bf16_f32 v204, v204, v205
    v_fma_f32 v75, v75, s28, v9
    v_mfma_f32_16x16x32_bf16 v[212:215], v[116:119], v[20:23], 0
    ds_write2st64_b64 v149, v[104:105], v[108:109] offset0:24 offset1:36
    v_accvgpr_read_b32 v110, a110
    v_cvt_pk_bf16_f32 v156, v156, v157
    v_mul_f32 v107, v107, v51
    v_pk_mul_f32 v[184:185], v[184:185], v[48:49] op_sel_hi:[1,0]
    v_accvgpr_read_b32 v109, a109
    v_accvgpr_read_b32 v154, a18
    v_mfma_f32_16x16x32_bf16 a[4:7], v[116:119], v[26:29], 0
    ds_write_b64 v149, v[152:153] offset:24576
    v_fma_f32 v77, v77, s28, v9
    v_accvgpr_read_b32 v155, a19
    v_accvgpr_read_b32 v111, a111
    v_xor_b32 v149, 32, v149
    v_accvgpr_read_b32 v105, a61
    v_pk_mul_f32 v[178:179], v[178:179], v[48:49] op_sel_hi:[1,0]
    v_accvgpr_read_b32 v104, a60
    v_accvgpr_read_b32 v152, a16
    v_cvt_pk_bf16_f32 v228, v228, v229
    v_mfma_f32_16x16x32_bf16 a[52:55], v[116:119], v[32:35], 0
    s_waitcnt lgkmcnt(2)
    ds_read_b64_tr_b16 v[134:135], v3 offset:7168
    v_mul_f32 v104, v104, v51
    v_mfma_f32_16x16x32_bf16 v[168:171], v[120:123], v[14:17], 0
    buffer_load_dwordx4 v6, s[4:7], s20 offen lds
    ds_write2st64_b64 v149, v[172:173], v[220:221] offset0:0 offset1:12
    v_mul_f32 v105, v105, v51
    v_accvgpr_read_b32 v108, a108
    v_cvt_pk_bf16_f32 v176, v176, v177
    v_pk_mul_f32 v[108:109], v[108:109], v[148:149] op_sel_hi:[1,0]
    v_pk_mul_f32 v[186:187], v[186:187], v[48:49] op_sel_hi:[1,0]
    v_cvt_pk_bf16_f32 v104, v104, v105
    v_cvt_pk_bf16_f32 v232, v232, v233
    v_cvt_pk_bf16_f32 v105, v106, v107
    v_cvt_pk_bf16_f32 v189, v190, v191
    v_fma_f32 v100, v100, s28, v12
    v_cvt_pk_bf16_f32 v225, v226, v227
    v_cvt_pk_bf16_f32 v108, v108, v109
    v_cvt_pk_bf16_f32 v157, v158, v159
    v_mfma_f32_16x16x32_bf16 v[216:219], v[120:123], v[20:23], 0
    ds_write2st64_b64 v149, v[156:157], v[104:105] offset0:24 offset1:36
    v_accvgpr_read_b32 v106, a114
    v_mul_f32 v234, v234, v49
    v_accvgpr_read_b32 v153, a17
    v_mul_f32 v246, v246, v49
    v_mfma_f32_16x16x32_bf16 a[8:11], v[120:123], v[26:29], 0
    ds_read_b64_tr_b16 v[112:113], v4 offset:1024
    v_exp_f32 v91, v91
    v_accvgpr_read_b32 v158, a66
    v_mul_f32 v255, v255, v49
    v_pk_mul_f32 v[152:153], v[152:153], v[50:51] op_sel_hi:[1,0]
    v_fma_f32 v95, v95, s28, v11
    v_accvgpr_read_b32 v159, a67
    v_mul_f32 v158, v158, v51
    v_accvgpr_read_b32 v157, a65
    v_mul_f32 v157, v157, v51
    v_exp_f32 v97, v97
    v_pk_mul_f32 v[110:111], v[110:111], v[148:149] op_sel_hi:[1,0]
    v_pk_mul_f32 v[200:201], v[200:201], v[48:49] op_sel_hi:[1,0]
    v_accvgpr_read_b32 v156, a64
    v_accvgpr_read_b32 v105, a113
    v_accvgpr_read_b32 v104, a112
    v_mfma_f32_16x16x32_bf16 a[56:59], v[120:123], v[32:35], 0
    ds_read_b128 v[144:147], v8 offset:0
    v_exp_f32 v80, v80
    v_cvt_pk_bf16_f32 v109, v110, v111
    v_mfma_f32_16x16x32_bf16 v[44:47], v[64:67], v[32:35], v[44:47]
    s_add_u32 s20, s20, 12032
    ds_read_b64_tr_b16 v[116:117], v5 offset:1024
    ds_read_b64_tr_b16 v[120:121], v2 offset:2048
    v_mfma_f32_16x16x32_bf16 v[172:175], v[124:127], v[14:17], 0
    ds_read_b64_tr_b16 v[128:129], v2 offset:1024
    v_mul_f32 v159, v159, v51
    v_mfma_f32_16x16x32_bf16 v[220:223], v[124:127], v[20:23], 0
    ds_write_b64 v149, v[108:109] offset:24576
    v_fma_f32 v81, v81, s28, v10
    v_mul_f32 v156, v156, v51
    v_pk_mul_f32 v[154:155], v[154:155], v[50:51] op_sel_hi:[1,0]
    v_cvt_pk_bf16_f32 v184, v184, v185
    v_accvgpr_read_b32 v107, a115
    v_accvgpr_read_b32 v109, a21
    v_cvt_pk_bf16_f32 v177, v178, v179
    v_cvt_pk_bf16_f32 v156, v156, v157
    v_cvt_pk_bf16_f32 v152, v152, v153
    v_exp_f32 v100, v100
    v_pk_mul_f32 v[104:105], v[104:105], v[148:149] op_sel_hi:[1,0]
    v_accvgpr_read_b32 v110, a22
    v_xor_b32 v149, 96, v149
    v_cvt_pk_bf16_f32 v104, v104, v105
    v_accvgpr_read_b32 v111, a23
    v_fma_f32 v93, v93, s28, v11
    v_pk_mul_f32 v[106:107], v[106:107], v[148:149] op_sel_hi:[1,0]
    v_accvgpr_read_b32 v108, a20
    v_cvt_pk_bf16_f32 v105, v106, v107
    v_pk_mul_f32 v[108:109], v[108:109], v[50:51] op_sel_hi:[1,0]
    v_cvt_pk_bf16_f32 v157, v158, v159
    v_cvt_pk_bf16_f32 v153, v154, v155
    v_cvt_pk_bf16_f32 v229, v230, v231
    v_fma_f32 v101, v101, s28, v12
    v_mfma_f32_16x16x32_bf16 a[12:15], v[124:127], v[26:29], 0
    s_add_u32 s56, s67, 6144
    ds_write2st64_b64 v149, v[176:177], v[224:225] offset0:4 offset1:16
    v_accvgpr_read_b32 v159, a119
    v_mfma_f32_16x16x32_bf16 a[60:63], v[124:127], v[32:35], 0
    s_waitcnt lgkmcnt(2)
    ds_write2st64_b64 v149, v[152:153], v[156:157] offset0:28 offset1:40
    v_pk_mul_f32 v[110:111], v[110:111], v[50:51] op_sel_hi:[1,0]
    v_accvgpr_read_b32 v154, a70
    s_nop 0
    v_mfma_f32_16x16x32_bf16 v[176:179], v[128:131], v[14:17], 0
    ds_read_b64_tr_b16 v[114:115], v4 offset:7168
    ds_read_b64_tr_b16 v[118:119], v5 offset:7168
    v_mfma_f32_16x16x32_bf16 v[224:227], v[128:131], v[20:23], 0
    ds_write_b64 v149, v[104:105] offset:26624
    v_xor_b32 v149, 32, v149
    v_accvgpr_read_b32 v107, a27
    v_accvgpr_read_b32 v105, a25
    v_cvt_pk_bf16_f32 v108, v108, v109
    v_accvgpr_read_b32 v104, a24
    v_accvgpr_read_b32 v155, a71
    v_accvgpr_read_b32 v157, a117
    v_accvgpr_read_b32 v153, a69
    v_cvt_pk_bf16_f32 v109, v110, v111
    v_pk_mul_f32 v[104:105], v[104:105], v[50:51] op_sel_hi:[1,0]
    v_accvgpr_read_b32 v158, a118
    v_accvgpr_read_b32 v106, a26
    v_mul_f32 v153, v153, v51
    v_exp_f32 v92, v92
    v_fma_f32 v78, v78, s28, v9
    v_accvgpr_read_b32 v152, a68
    v_accvgpr_read_b32 v111, a75
    v_cvt_pk_bf16_f32 v181, v182, v183
    v_pk_mul_f32 v[106:107], v[106:107], v[50:51] op_sel_hi:[1,0]
    v_cvt_pk_bf16_f32 v104, v104, v105
    v_accvgpr_read_b32 v156, a116
    v_pk_mul_f32 v[206:207], v[206:207], v[48:49] op_sel_hi:[1,0]
    v_mul_f32 v152, v152, v51
    v_pk_mul_f32 v[156:157], v[156:157], v[148:149] op_sel_hi:[1,0]
    v_pk_mul_f32 v[158:159], v[158:159], v[148:149] op_sel_hi:[1,0]
    v_cvt_pk_bf16_f32 v205, v206, v207
    v_exp_f32 v75, v75
    v_mul_f32 v154, v154, v51
    v_cvt_pk_bf16_f32 v156, v156, v157
    v_cvt_pk_bf16_f32 v157, v158, v159
    v_cvt_pk_bf16_f32 v152, v152, v153
    v_mul_f32 v155, v155, v51
    v_mul_f32 v111, v111, v51
    v_cvt_pk_bf16_f32 v105, v106, v107
    v_cvt_pk_bf16_f32 v153, v154, v155
    v_mfma_f32_16x16x32_bf16 a[16:19], v[128:131], v[26:29], 0
    ds_write2st64_b64 v149, v[180:181], v[228:229] offset0:4 offset1:16
    v_mfma_f32_16x16x32_bf16 a[64:67], v[128:131], v[32:35], 0
    s_add_u32 s58, s33, 6144
    ds_write2st64_b64 v149, v[108:109], v[152:153] offset0:28 offset1:40
    v_exp_f32 v72, v72
    v_cvt_pk_bf16_f32 v200, v200, v201
    v_accvgpr_read_b32 v109, a73
    v_exp_f32 v99, v99
    v_mfma_f32_16x16x32_bf16 v[180:183], v[132:135], v[14:17], 0
    ds_write_b64 v149, v[156:157] offset:26624
    v_accvgpr_read_b32 v110, a74
    v_cvt_pk_bf16_f32 v185, v186, v187
    v_accvgpr_read_b32 v107, a79
    v_accvgpr_read_b32 v106, a78
    v_mul_f32 v109, v109, v51
    v_accvgpr_read_b32 v152, a120
    v_accvgpr_read_b32 v108, a72
    v_fma_f32 v86, v86, s28, v10
    v_accvgpr_read_b32 v158, a30
    v_cvt_pk_bf16_f32 v37, v98, v99
    v_accvgpr_read_b32 v153, a121
    v_mul_f32 v110, v110, v51
    v_cvt_pk_bf16_f32 v237, v238, v239
    v_mfma_f32_16x16x32_bf16 v[228:231], v[132:135], v[20:23], 0
    buffer_store_dwordx4 v[144:147], v6, s[16:19], s67 offen sc0 sc1 nt
    s_nop 0
    ds_read_b128 v[144:147], v8 offset:1024
    v_accvgpr_read_b32 v155, a123
    v_cvt_pk_bf16_f32 v233, v234, v235
    v_mul_f32 v107, v107, v51
    v_mul_f32 v108, v108, v51
    v_accvgpr_read_b32 v157, a29
    v_cvt_pk_bf16_f32 v108, v108, v109
    v_pk_mul_f32 v[152:153], v[152:153], v[148:149] op_sel_hi:[1,0]
    v_cvt_pk_bf16_f32 v109, v110, v111
    v_xor_b32 v149, 96, v149
    v_mfma_f32_16x16x32_bf16 a[20:23], v[132:135], v[26:29], 0
    ds_write2st64_b64 v149, v[184:185], v[232:233] offset0:4 offset1:16
    ds_write2st64_b64 v149, v[104:105], v[108:109] offset0:28 offset1:40
    v_accvgpr_read_b32 v104, a76
    v_accvgpr_read_b32 v110, a126
    v_accvgpr_read_b32 v156, a28
    v_accvgpr_read_b32 v111, a127
    v_accvgpr_read_b32 v105, a77
    v_mul_f32 v242, v242, v49
    v_cvt_pk_bf16_f32 v152, v152, v153
    v_mul_f32 v105, v105, v51
    v_accvgpr_read_b32 v159, a31
    v_accvgpr_read_b32 v109, a125
    v_accvgpr_read_b32 v154, a122
    v_mul_f32 v104, v104, v51
    v_cvt_pk_bf16_f32 v244, v244, v245
    v_pk_mul_f32 v[154:155], v[154:155], v[148:149] op_sel_hi:[1,0]
    v_pk_mul_f32 v[158:159], v[158:159], v[50:51] op_sel_hi:[1,0]
    v_cvt_pk_bf16_f32 v241, v242, v243
    v_cvt_pk_bf16_f32 v153, v154, v155
    v_cvt_pk_bf16_f32 v104, v104, v105
    v_cvt_pk_bf16_f32 v18, v72, v73
    v_pk_mul_f32 v[156:157], v[156:157], v[50:51] op_sel_hi:[1,0]
    v_mul_f32 v106, v106, v51
    v_cvt_pk_bf16_f32 v105, v106, v107
    v_cvt_pk_bf16_f32 v156, v156, v157
    v_mfma_f32_16x16x32_bf16 a[68:71], v[132:135], v[32:35], 0
    s_waitcnt lgkmcnt(2)
    ds_write_b64 v149, v[152:153] offset:26624
    v_mfma_f32_16x16x32_bf16 v[184:187], v[112:115], v[14:17], 0
    buffer_store_dwordx4 v[144:147], v7, s[16:19], s67 offen sc0 sc1 nt
    s_nop 0
    ds_read_b128 v[144:147], v8 offset:6144
    v_exp_f32 v82, v82
    v_accvgpr_read_b32 v108, a124
    v_cvt_pk_bf16_f32 v253, v254, v255
    v_cvt_pk_bf16_f32 v157, v158, v159
    v_pk_mul_f32 v[196:197], v[196:197], v[48:49] op_sel_hi:[1,0]
    v_xor_b32 v149, 32, v149
    v_accvgpr_read_b32 v154, a34
    v_mfma_f32_16x16x32_bf16 v[232:235], v[112:115], v[20:23], 0
    ds_write2st64_b64 v149, v[188:189], v[236:237] offset0:4 offset1:16
    v_mfma_f32_16x16x32_bf16 a[24:27], v[112:115], v[26:29], 0
    s_add_u32 m0, s38, 6144
    ds_write2st64_b64 v149, v[156:157], v[104:105] offset0:28 offset1:40
    v_accvgpr_read_b32 v153, a33
    v_fma_f32 v90, v90, s28, v11
    v_pk_mul_f32 v[108:109], v[108:109], v[148:149] op_sel_hi:[1,0]
    v_accvgpr_read_b32 v107, a131
    v_accvgpr_read_b32 v104, a128
    v_cvt_pk_bf16_f32 v192, v192, v193
    v_accvgpr_read_b32 v152, a32
    v_accvgpr_read_b32 v159, a83
    v_accvgpr_read_b32 v155, a35
    v_pk_mul_f32 v[110:111], v[110:111], v[148:149] op_sel_hi:[1,0]
    v_pk_mul_f32 v[152:153], v[152:153], v[50:51] op_sel_hi:[1,0]
    v_cvt_pk_bf16_f32 v108, v108, v109
    v_accvgpr_read_b32 v106, a130
    v_pk_mul_f32 v[154:155], v[154:155], v[50:51] op_sel_hi:[1,0]
    v_accvgpr_read_b32 v158, a82
    v_cvt_pk_bf16_f32 v152, v152, v153
    v_cvt_pk_bf16_f32 v153, v154, v155
    v_mul_f32 v247, v247, v49
    v_mfma_f32_16x16x32_bf16 a[72:75], v[112:115], v[32:35], 0
    s_waitcnt lgkmcnt(2)
    ds_read_b64_tr_b16 v[122:123], v2 offset:8192
    buffer_load_dwordx4 v6, s[12:15], s58 offen nt lds
    ds_read_b64_tr_b16 v[126:127], v3 offset:8192
    v_accvgpr_read_b32 v105, a129
    v_accvgpr_read_b32 v156, a80
    v_cvt_pk_bf16_f32 v109, v110, v111
    v_exp_f32 v81, v81
    v_accvgpr_read_b32 v157, a81
    v_cvt_pk_bf16_f32 v245, v246, v247
    v_cvt_pk_bf16_f32 v249, v250, v251
    v_accvgpr_read_b32 v111, a39
    v_mul_f32 v158, v158, v51
    v_pk_mul_f32 v[106:107], v[106:107], v[148:149] op_sel_hi:[1,0]
    v_accvgpr_read_b32 v155, a87
    v_mul_f32 v157, v157, v51
    v_mfma_f32_16x16x32_bf16 v[188:191], v[116:119], v[14:17], 0
    buffer_store_dwordx4 v[144:147], v6, s[16:19], s56 offen sc0 sc1 nt
    ds_write_b64 v149, v[108:109] offset:26624
    v_mul_f32 v159, v159, v51
    v_mfma_f32_16x16x32_bf16 v[236:239], v[116:119], v[20:23], 0
    s_add_u32 m0, s38, 7168
    ds_read_b64_tr_b16 v[128:129], v4 offset:2048
    ds_read_b64_tr_b16 v[124:125], v3 offset:2048
    v_mul_f32 v156, v156, v51
    v_accvgpr_read_b32 v154, a86
    v_cvt_pk_bf16_f32 v156, v156, v157
    v_pk_mul_f32 v[104:105], v[104:105], v[148:149] op_sel_hi:[1,0]
    v_accvgpr_read_b32 v109, a37
    v_xor_b32 v149, 96, v149
    v_cvt_pk_bf16_f32 v193, v194, v195
    v_mfma_f32_16x16x32_bf16 a[28:31], v[116:119], v[26:29], 0
    ds_read_b128 v[144:147], v8 offset:7168
    v_accvgpr_read_b32 v110, a38
    v_cvt_pk_bf16_f32 v157, v158, v159
    v_mul_f32 v154, v154, v51
    v_mfma_f32_16x16x32_bf16 a[76:79], v[116:119], v[32:35], 0
    s_waitcnt lgkmcnt(4)
    ds_write2st64_b64 v149, v[192:193], v[240:241] offset0:8 offset1:20
    v_mfma_f32_16x16x32_bf16 v[192:195], v[120:123], v[14:17], 0
    ds_write2st64_b64 v149, v[152:153], v[156:157] offset0:32 offset1:44
    v_accvgpr_read_b32 v108, a36
    v_cvt_pk_bf16_f32 v104, v104, v105
    v_cvt_pk_bf16_f32 v105, v106, v107
    v_accvgpr_read_b32 v157, a133
    v_accvgpr_read_b32 v158, a134
    v_exp_f32 v83, v83
    v_cvt_pk_bf16_f32 v19, v74, v75
    v_mfma_f32_16x16x32_bf16 v[240:243], v[120:123], v[20:23], 0
    ds_read_b64_tr_b16 v[132:133], v5 offset:2048
    ds_write_b64 v149, v[104:105] offset:0
    v_exp_f32 v77, v77
    v_accvgpr_read_b32 v106, a42
    v_accvgpr_read_b32 v153, a85
    v_accvgpr_read_b32 v104, a40
    v_accvgpr_read_b32 v156, a132
    v_exp_f32 v93, v93
    v_accvgpr_read_b32 v152, a84
    v_pk_mul_f32 v[108:109], v[108:109], v[50:51] op_sel_hi:[1,0]
    v_mul_f32 v155, v155, v51
    v_cvt_pk_bf16_f32 v196, v196, v197
    v_accvgpr_read_b32 v105, a41
    v_mfma_f32_16x16x32_bf16 a[32:35], v[120:123], v[26:29], 0
    s_waitcnt lgkmcnt(3)
    ds_read_b64_tr_b16 v[134:135], v5 offset:8192
    buffer_load_dwordx4 v7, s[12:15], s58 offen nt lds
    ds_read_b64_tr_b16 v[130:131], v4 offset:8192
    v_accvgpr_read_b32 v107, a43
    v_pk_mul_f32 v[110:111], v[110:111], v[50:51] op_sel_hi:[1,0]
    v_pk_mul_f32 v[202:203], v[202:203], v[48:49] op_sel_hi:[1,0]
    v_accvgpr_read_b32 v159, a135
    v_pk_mul_f32 v[156:157], v[156:157], v[148:149] op_sel_hi:[1,0]
    v_fma_f32 v103, v103, s28, v12
    v_pk_mul_f32 v[104:105], v[104:105], v[50:51] op_sel_hi:[1,0]
    v_xor_b32 v149, 32, v149
    v_cvt_pk_bf16_f32 v108, v108, v109
    v_cvt_pk_bf16_f32 v201, v202, v203
    v_pk_mul_f32 v[158:159], v[158:159], v[148:149] op_sel_hi:[1,0]
    v_pk_mul_f32 v[106:107], v[106:107], v[50:51] op_sel_hi:[1,0]
    v_cvt_pk_bf16_f32 v156, v156, v157
    v_cvt_pk_bf16_f32 v109, v110, v111
    v_cvt_pk_bf16_f32 v197, v198, v199
    v_cvt_pk_bf16_f32 v104, v104, v105
    v_mul_f32 v153, v153, v51
    v_mul_f32 v152, v152, v51
    v_cvt_pk_bf16_f32 v152, v152, v153
    v_cvt_pk_bf16_f32 v153, v154, v155
    v_accvgpr_read_b32 v155, a139
    v_mfma_f32_16x16x32_bf16 a[80:83], v[120:123], v[32:35], 0
    s_add_u32 s39, s39, 12288
    ds_write2st64_b64 v149, v[196:197], v[244:245] offset0:8 offset1:20
    ds_write2st64_b64 v149, v[108:109], v[152:153] offset0:32 offset1:44
    v_mfma_f32_16x16x32_bf16 v[196:199], v[124:127], v[14:17], 0
    buffer_store_dwordx4 v[144:147], v7, s[16:19], s56 offen sc0 sc1 nt
    s_waitcnt vmcnt(12) lgkmcnt(2)
    s_barrier
    ds_read_b128 v[144:147], v8 offset:2048
    v_accvgpr_read_b32 v109, a89
    v_accvgpr_read_b32 v154, a138
    v_accvgpr_read_b32 v108, a88
    v_accvgpr_read_b32 v111, a91
    v_cvt_pk_bf16_f32 v157, v158, v159
    v_cvt_pk_bf16_f32 v105, v106, v107
    v_accvgpr_read_b32 v153, a137
    v_accvgpr_read_b32 v152, a136
    v_accvgpr_read_b32 v159, a47
    v_mfma_f32_16x16x32_bf16 v[244:247], v[124:127], v[20:23], 0
    ds_write_b64 v149, v[156:157] offset:0
    v_mul_f32 v109, v109, v51
    v_accvgpr_read_b32 v158, a46
    v_pk_mul_f32 v[152:153], v[152:153], v[148:149] op_sel_hi:[1,0]
    v_pk_mul_f32 v[154:155], v[154:155], v[148:149] op_sel_hi:[1,0]
    v_mul_f32 v108, v108, v51
    v_accvgpr_read_b32 v157, a45
    v_accvgpr_read_b32 v110, a90
    v_exp_f32 v90, v90
    v_cvt_pk_bf16_f32 v108, v108, v109
    v_exp_f32 v96, v96
    v_cvt_pk_bf16_f32 v152, v152, v153
    v_mul_f32 v111, v111, v51
    v_xor_b32 v149, 96, v149
    v_mul_f32 v110, v110, v51
    v_mfma_f32_16x16x32_bf16 a[36:39], v[124:127], v[26:29], 0
    ds_write2st64_b64 v149, v[200:201], v[248:249] offset0:8 offset1:20
    v_cvt_pk_bf16_f32 v109, v110, v111
    v_mfma_f32_16x16x32_bf16 a[84:87], v[124:127], v[32:35], 0
    s_add_u32 m0, s22, 24576
    ds_read_b128 v[116:119], v1 offset:0
    ds_read_b128 v[120:123], v0 offset:1024
    buffer_load_dwordx4 v6, s[8:11], s21 offen lds
    v_mfma_f32_16x16x32_bf16 v[200:203], v[128:131], v[14:17], 0
    s_add_u32 s21, s21, 128
    ds_write2st64_b64 v149, v[104:105], v[108:109] offset0:32 offset1:44
    v_cvt_pk_bf16_f32 v153, v154, v155
    v_mfma_f32_16x16x32_bf16 v[248:251], v[128:131], v[20:23], 0
    s_add_u32 m0, s22, 25600
    ds_read_b128 v[112:115], v0 offset:0
    buffer_load_dwordx4 v6, s[8:11], s21 offen lds
    v_mfma_f32_16x16x32_bf16 a[40:43], v[128:131], v[26:29], 0
    s_add_u32 s21, s21, 128
    ds_write_b64 v149, v[152:153] offset:0
    v_xor_b32 v149, 32, v149
    v_accvgpr_read_b32 v156, a44
    v_mfma_f32_16x16x32_bf16 a[88:91], v[128:131], v[32:35], 0
    s_add_u32 m0, s22, 26624
    ds_write2st64_b64 v149, v[204:205], v[252:253] offset0:8 offset1:20
    v_mfma_f32_16x16x32_bf16 v[204:207], v[132:135], v[14:17], 0
    buffer_load_dwordx4 v6, s[8:11], s21 offen lds
    v_mfma_f32_16x16x32_bf16 v[252:255], v[132:135], v[20:23], 0
    s_add_u32 s21, s21, 12032
    s_add_u32 s56, s67, 128
    v_accvgpr_read_b32 v107, a95
    v_accvgpr_read_b32 v106, a94
    v_mfma_f32_16x16x32_bf16 a[44:47], v[132:135], v[26:29], 0
    s_waitcnt lgkmcnt(4)
    buffer_store_dwordx4 v[144:147], v6, s[16:19], s56 offen sc0 sc1 nt
    s_add_u32 s58, s33, 128
    s_add_u32 m0, s38, 2048
    v_pk_mul_f32 v[156:157], v[156:157], v[50:51] op_sel_hi:[1,0]
    v_accvgpr_read_b32 v105, a93
    v_fma_f32 v85, v85, s28, v10
    v_accvgpr_read_b32 v104, a92
    v_mfma_f32_16x16x32_bf16 a[92:95], v[132:135], v[32:35], 0
    s_waitcnt lgkmcnt(2)
    v_cvt_pk_bf16_f32 v24, v80, v81
    v_mfma_f32_16x16x32_bf16 v[72:75], v[112:115], a[144:147], 0
    buffer_load_dwordx4 v6, s[12:15], s58 offen nt lds
    ds_read_b128 v[144:147], v8 offset:3072
    v_mfma_f32_16x16x32_bf16 v[72:75], v[116:119], a[148:151], v[72:75]
    s_add_u32 m0, s38, 3072
    ds_read_b128 v[128:131], v0 offset:2048
    v_cvt_pk_bf16_f32 v31, v90, v91
    v_mfma_f32_16x16x32_bf16 v[72:75], v[120:123], a[152:155], v[72:75]
    ds_read_b128 v[124:127], v1 offset:1024
    v_cvt_pk_bf16_f32 v25, v82, v83
    v_mfma_f32_16x16x32_bf16 v[80:83], v[112:115], a[168:171], 0
    ds_read_b128 v[132:135], v1 offset:2048
    v_exp_f32 v89, v89
    v_mfma_f32_16x16x32_bf16 v[80:83], v[116:119], a[172:175], v[80:83]
    v_exp_f32 v88, v88
    v_mfma_f32_16x16x32_bf16 v[80:83], v[120:123], a[176:179], v[80:83]
    v_cvt_pk_bf16_f32 v156, v156, v157
    v_cvt_pk_bf16_f32 v30, v88, v89
    v_mfma_f32_16x16x32_bf16 v[88:91], v[112:115], a[192:195], 0
    v_mul_f32 v104, v104, v51
    v_cvt_pk_bf16_f32 v36, v96, v97
    v_mfma_f32_16x16x32_bf16 v[88:91], v[116:119], a[196:199], v[88:91]
    v_exp_f32 v95, v95
    v_fma_f32 v87, v87, s28, v10
    v_mfma_f32_16x16x32_bf16 v[88:91], v[120:123], a[200:203], v[88:91]
    v_fma_f32 v94, v94, s28, v11
    v_fma_f32 v76, v76, s28, v9
    v_fma_f32 v102, v102, s28, v12
    v_accvgpr_read_b32 v108, a140
    v_mfma_f32_16x16x32_bf16 v[96:99], v[112:115], a[216:219], 0
    s_waitcnt lgkmcnt(3)
    ds_read_b128 v[112:115], v0 offset:6144
    buffer_load_dwordx4 v7, s[12:15], s58 offen nt lds
    v_mfma_f32_16x16x32_bf16 v[96:99], v[116:119], a[220:223], v[96:99]
    buffer_store_dwordx4 v[144:147], v7, s[16:19], s56 offen sc0 sc1 nt
    s_add_u32 s57, s67, 6272
    ds_read_b128 v[144:147], v8 offset:8192
    v_exp_f32 v85, v85
    v_mfma_f32_16x16x32_bf16 v[96:99], v[120:123], a[224:227], v[96:99]
    s_waitcnt lgkmcnt(2)
    ds_read_b128 v[116:119], v1 offset:6144
    v_exp_f32 v76, v76
    v_exp_f32 v79, v79
    v_mfma_f32_16x16x32_bf16 v[72:75], v[124:127], a[156:159], v[72:75]
    v_exp_f32 v78, v78
    v_mfma_f32_16x16x32_bf16 v[72:75], v[128:131], a[160:163], v[72:75]
    v_exp_f32 v87, v87
    v_mfma_f32_16x16x32_bf16 v[72:75], v[132:135], a[164:167], v[72:75]
    s_add_u32 s59, s33, 6272
    v_mul_f32 v106, v106, v51
    v_mfma_f32_16x16x32_bf16 v[80:83], v[124:127], a[180:183], v[80:83]
    s_add_u32 m0, s38, 8192
    v_cvt_pk_bf16_f32 v17, v78, v79
    v_exp_f32 v94, v94
    v_mfma_f32_16x16x32_bf16 v[80:83], v[128:131], a[184:187], v[80:83]
    v_exp_f32 v86, v86
    v_mfma_f32_16x16x32_bf16 v[80:83], v[132:135], a[188:191], v[80:83]
    v_fma_f32 v84, v84, s28, v10
    v_cvt_pk_bf16_f32 v16, v76, v77
    v_mfma_f32_16x16x32_bf16 v[88:91], v[124:127], a[204:207], v[88:91]
    ds_read_b128 v[120:123], v0 offset:7168
    s_waitcnt lgkmcnt(2)
    buffer_load_dwordx4 v6, s[12:15], s59 offen nt lds
    v_mfma_f32_16x16x32_bf16 v[88:91], v[128:131], a[208:211], v[88:91]
    buffer_store_dwordx4 v[144:147], v6, s[16:19], s57 offen sc0 sc1 nt
    s_nop 0
    ds_read_b128 v[144:147], v8 offset:9216
    v_cvt_pk_bf16_f32 v28, v92, v93
    v_mfma_f32_16x16x32_bf16 v[88:91], v[132:135], a[212:215], v[88:91]
    v_exp_f32 v102, v102
    v_mfma_f32_16x16x32_bf16 v[96:99], v[124:127], a[228:231], v[96:99]
    v_mfma_f32_16x16x32_bf16 v[96:99], v[128:131], a[232:235], v[96:99]
    v_exp_f32 v101, v101
    v_cvt_pk_bf16_f32 v23, v86, v87
    v_mfma_f32_16x16x32_bf16 v[96:99], v[132:135], a[236:239], v[96:99]
    v_exp_f32 v84, v84
    v_mfma_f32_16x16x32_bf16 v[76:79], v[112:115], a[144:147], 0
    s_waitcnt lgkmcnt(2)
    v_accvgpr_read_b32 v109, a141
    v_mfma_f32_16x16x32_bf16 v[76:79], v[116:119], a[148:151], v[76:79]
    v_cvt_pk_bf16_f32 v22, v84, v85
    s_waitcnt lgkmcnt(1)
    v_mfma_f32_16x16x32_bf16 v[76:79], v[120:123], a[152:155], v[76:79]
    ds_read_b128 v[128:131], v0 offset:8192
    v_cvt_pk_bf16_f32 v29, v94, v95
    v_mfma_f32_16x16x32_bf16 v[84:87], v[112:115], a[168:171], 0
    s_add_u32 m0, s38, 9216
    ds_read_b128 v[132:135], v1 offset:8192
    v_accvgpr_read_b32 v111, a143
    v_mfma_f32_16x16x32_bf16 v[84:87], v[116:119], a[172:175], v[84:87]
    s_waitcnt lgkmcnt(2)
    ds_read_b128 v[124:127], v1 offset:7168
    buffer_load_dwordx4 v7, s[12:15], s59 offen nt lds
    v_mfma_f32_16x16x32_bf16 v[84:87], v[120:123], a[176:179], v[84:87]
    buffer_store_dwordx4 v[144:147], v7, s[16:19], s57 offen sc0 sc1 nt
    s_add_u32 s56, s67, 256
    ds_read_b128 v[144:147], v8 offset:4096
    v_pk_mul_f32 v[158:159], v[158:159], v[50:51] op_sel_hi:[1,0]
    v_pk_mul_f32 v[108:109], v[108:109], v[148:149] op_sel_hi:[1,0]
    v_mul_f32 v107, v107, v51
    v_cvt_pk_bf16_f32 v34, v100, v101
    v_mfma_f32_16x16x32_bf16 v[92:95], v[112:115], a[192:195], 0
    v_mul_f32 v105, v105, v51
    v_cvt_pk_bf16_f32 v157, v158, v159
    v_mfma_f32_16x16x32_bf16 v[92:95], v[116:119], a[196:199], v[92:95]
    v_accvgpr_read_b32 v110, a142
    s_add_u32 s58, s33, 256
    v_exp_f32 v103, v103
    v_mfma_f32_16x16x32_bf16 v[92:95], v[120:123], a[200:203], v[92:95]
    v_cvt_pk_bf16_f32 v104, v104, v105
    v_cvt_pk_bf16_f32 v35, v102, v103
    v_mfma_f32_16x16x32_bf16 v[100:103], v[112:115], a[216:219], 0
    v_cvt_pk_bf16_f32 v108, v108, v109
    s_add_u32 m0, s38, 4096
    v_mfma_f32_16x16x32_bf16 v[100:103], v[116:119], a[220:223], v[100:103]
    v_mfma_f32_16x16x32_bf16 v[100:103], v[120:123], a[224:227], v[100:103]
    s_waitcnt lgkmcnt(1)
    v_mfma_f32_16x16x32_bf16 v[76:79], v[124:127], a[156:159], v[76:79]
    v_cvt_pk_bf16_f32 v105, v106, v107
    v_mfma_f32_16x16x32_bf16 v[76:79], v[128:131], a[160:163], v[76:79]
    s_waitcnt lgkmcnt(0)
    buffer_load_dwordx4 v6, s[12:15], s58 offen nt lds
    v_mfma_f32_16x16x32_bf16 v[76:79], v[132:135], a[164:167], v[76:79]
    buffer_store_dwordx4 v[144:147], v6, s[16:19], s56 offen sc0 sc1 nt
    s_nop 0
    ds_read_b128 v[144:147], v8 offset:5120
    v_mfma_f32_16x16x32_bf16 v[48:51], v[52:55], v[16:19], v[44:47]
    v_mfma_f32_16x16x32_bf16 v[84:87], v[124:127], a[180:183], v[84:87]
    v_mfma_f32_16x16x32_bf16 v[84:87], v[128:131], a[184:187], v[84:87]
    v_mfma_f32_16x16x32_bf16 v[84:87], v[132:135], a[188:191], v[84:87]
    ds_write2st64_b64 v149, v[156:157], v[104:105] offset0:32 offset1:44
    v_pk_mul_f32 v[110:111], v[110:111], v[148:149] op_sel_hi:[1,0]
    s_nop 0
    v_cvt_pk_bf16_f32 v109, v110, v111
    v_mfma_f32_16x16x32_bf16 v[92:95], v[124:127], a[204:207], v[92:95]
    ds_write_b64 v149, v[108:109] offset:0
    v_mfma_f32_16x16x32_bf16 v[92:95], v[128:131], a[208:211], v[92:95]
    s_add_u32 m0, s38, 5120
    v_mfma_f32_16x16x32_bf16 v[92:95], v[132:135], a[212:215], v[92:95]
    s_waitcnt lgkmcnt(2)
    buffer_store_dwordx4 v[144:147], v7, s[16:19], s56 offen sc0 sc1 nt
    buffer_load_dwordx4 v7, s[12:15], s58 offen nt lds
    ds_read_b128 v[144:147], v8 offset:0
    v_mfma_f32_16x16x32_bf16 v[48:51], v[56:59], v[22:25], v[48:51]
    s_add_u32 s57, s67, 24832
    v_mfma_f32_16x16x32_bf16 v[100:103], v[124:127], a[228:231], v[100:103]
    s_add_u32 m0, s38, 0
    v_mfma_f32_16x16x32_bf16 v[48:51], v[60:63], v[28:31], v[48:51]
    s_waitcnt lgkmcnt(0)
    buffer_store_dwordx4 v[144:147], v6, s[16:19], s57 offen sc0 sc1 nt
    buffer_load_dwordx4 v6, s[12:15], s33 offen nt lds
    ds_read_b128 v[144:147], v8 offset:1024
    s_add_u32 m0, s38, 1024
    v_mfma_f32_16x16x32_bf16 v[48:51], v[64:67], v[34:37], v[48:51]
    s_nop 7
    v_cmp_lt_f32 vcc, s29, v48
    s_nop 4
    s_cbranch_vccnz L_rs_tr54d
L_ret_tr54d:
    v_fma_f32 v73, v73, s28, v9
    v_fma_f32 v80, v80, s28, v10
    v_fma_f32 v75, v75, s28, v9
    v_mfma_f32_16x16x32_bf16 v[100:103], v[128:131], a[232:235], v[100:103]
    v_fma_f32 v74, v74, s28, v9
    v_exp_f32 v73, v73
    v_exp_f32 v80, v80
    v_fma_f32 v72, v72, s28, v9
    v_fma_f32 v81, v81, s28, v10
    v_exp_f32 v81, v81
    v_exp_f32 v75, v75
    s_waitcnt lgkmcnt(0)
    buffer_load_dwordx4 v7, s[12:15], s33 offen nt lds
    s_waitcnt vmcnt(27)
    s_barrier
    ds_read_b64_tr_b16 v[112:113], v2 offset:18432
    ds_read_b64_tr_b16 v[114:115], v2 offset:12288
    ds_read_b64_tr_b16 v[116:117], v3 offset:18432
    ds_read_b64_tr_b16 v[118:119], v3 offset:12288
    s_add_u32 m0, s22, 0
    v_exp_f32 v74, v74
    buffer_load_dwordx4 v6, s[4:7], s20 offen lds
    s_add_u32 s20, s20, 128
    v_mfma_f32_16x16x32_bf16 v[100:103], v[132:135], a[236:239], v[100:103]
    s_add_u32 m0, s22, 1024
    buffer_store_dwordx4 v[144:147], v7, s[16:19], s57 offen sc0 sc1 nt
    ds_read_b64_tr_b16 v[120:121], v4 offset:18432
    buffer_load_dwordx4 v6, s[4:7], s20 offen lds
    v_cvt_pk_bf16_f32 v20, v80, v81
    v_add_u32 v8, 10240, v8
    v_exp_f32 v72, v72
    v_cvt_pk_bf16_f32 v15, v74, v75
    ds_read_b64_tr_b16 v[122:123], v4 offset:12288
    ds_read_b64_tr_b16 v[124:125], v5 offset:18432
    v_cvt_pk_bf16_f32 v14, v72, v73
    s_add_u32 s20, s20, 128
    s_add_u32 m0, s22, 2048
    ds_read_b64_tr_b16 v[126:127], v5 offset:12288
    buffer_load_dwordx4 v6, s[4:7], s20 offen lds
    s_add_u32 s20, s20, 12032
    s_branch L_loop4
L_tr55:
    s_waitcnt lgkmcnt(6)
    v_mfma_f32_16x16x32_bf16 v[160:163], v[112:115], v[16:19], v[160:163]
    ds_read_b64_tr_b16 v[132:133], v3 offset:19456
    v_mbcnt_lo_u32_b32 v145, -1, 0
    v_mfma_f32_16x16x32_bf16 v[208:211], v[112:115], v[22:25], v[208:211]
    ds_read_b64_tr_b16 v[130:131], v2 offset:13312
    v_fma_f32 v107, v107, s28, v13
    v_mfma_f32_16x16x32_bf16 a[0:3], v[112:115], v[28:31], a[0:3]
    ds_read_b64_tr_b16 v[128:129], v2 offset:19456
    v_mbcnt_hi_u32_b32 v145, -1, v145
    v_mfma_f32_16x16x32_bf16 a[48:51], v[112:115], v[34:37], a[48:51]
    v_and_b32 v144, 15, v145
    v_mul_u32_u24 v144, 384, v144
    v_mfma_f32_16x16x32_bf16 a[96:99], v[112:115], v[40:43], a[96:99]
    v_fma_f32 v91, v91, s28, v11
    s_waitcnt lgkmcnt(7)
    v_mfma_f32_16x16x32_bf16 v[164:167], v[116:119], v[16:19], v[164:167]
    v_fma_f32 v97, v97, s28, v12
    v_fma_f32 v98, v98, s28, v12
    v_mfma_f32_16x16x32_bf16 v[212:215], v[116:119], v[22:25], v[212:215]
    s_add_u32 s39, s39, 12288
    ds_read_b64_tr_b16 v[114:115], v4 offset:13312
    v_fma_f32 v89, v89, s28, v11
    v_mfma_f32_16x16x32_bf16 a[4:7], v[116:119], v[28:31], a[4:7]
    v_lshrrev_b32 v145, 4, v145
    v_fma_f32 v92, v92, s28, v11
    v_mfma_f32_16x16x32_bf16 a[52:55], v[116:119], v[34:37], a[52:55]
    v_fma_f32 v104, v104, s28, v13
    v_fma_f32 v99, v99, s28, v12
    v_mfma_f32_16x16x32_bf16 a[100:103], v[116:119], v[40:43], a[100:103]
    s_waitcnt lgkmcnt(4)
    v_exp_f32 v89, v89
    v_mfma_f32_16x16x32_bf16 v[168:171], v[120:123], v[16:19], v[168:171]
    ds_read_b64_tr_b16 v[116:117], v5 offset:19456
    v_fma_f32 v88, v88, s28, v11
    v_mfma_f32_16x16x32_bf16 v[216:219], v[120:123], v[22:25], v[216:219]
    s_add_u32 s48, s33, 24576
    ds_read_b64_tr_b16 v[134:135], v3 offset:13312
    v_lshl_add_u32 v144, v145, 4, v144
    v_mfma_f32_16x16x32_bf16 a[8:11], v[120:123], v[28:31], a[8:11]
    buffer_load_dword v145, v144, s[12:15], s48 offen offset:256
    v_mfma_f32_16x16x32_bf16 a[56:59], v[120:123], v[34:37], a[56:59]
    ds_read_b64_tr_b16 v[118:119], v5 offset:13312
    v_fma_f32 v111, v111, s28, v13
    v_mfma_f32_16x16x32_bf16 a[104:107], v[120:123], v[40:43], a[104:107]
    ds_read_b64_tr_b16 v[112:113], v4 offset:19456
    v_mfma_f32_16x16x32_bf16 v[172:175], v[124:127], v[16:19], v[172:175]
    v_fma_f32 v87, v87, s28, v10
    v_fma_f32 v105, v105, s28, v13
    v_mfma_f32_16x16x32_bf16 v[220:223], v[124:127], v[22:25], v[220:223]
    v_fma_f32 v77, v77, s28, v9
    v_fma_f32 v90, v90, s28, v11
    v_mfma_f32_16x16x32_bf16 a[12:15], v[124:127], v[28:31], a[12:15]
    v_exp_f32 v105, v105
    v_mfma_f32_16x16x32_bf16 a[60:63], v[124:127], v[34:37], a[60:63]
    v_fma_f32 v106, v106, s28, v13
    v_fma_f32 v110, v110, s28, v13
    v_mfma_f32_16x16x32_bf16 a[108:111], v[124:127], v[40:43], a[108:111]
    s_waitcnt lgkmcnt(4)
    v_exp_f32 v104, v104
    v_mfma_f32_16x16x32_bf16 v[176:179], v[128:131], v[16:19], v[176:179]
    ds_read_b64_tr_b16 v[120:121], v2 offset:20480
    v_fma_f32 v85, v85, s28, v10
    v_mfma_f32_16x16x32_bf16 v[224:227], v[128:131], v[22:25], v[224:227]
    ds_read_b64_tr_b16 v[124:125], v3 offset:20480
    v_fma_f32 v84, v84, s28, v10
    v_mfma_f32_16x16x32_bf16 a[16:19], v[128:131], v[28:31], a[16:19]
    v_exp_f32 v91, v91
    v_mfma_f32_16x16x32_bf16 a[64:67], v[128:131], v[34:37], a[64:67]
    v_exp_f32 v107, v107
    v_mfma_f32_16x16x32_bf16 a[112:115], v[128:131], v[40:43], a[112:115]
    s_waitcnt lgkmcnt(2)
    v_exp_f32 v98, v98
    v_mfma_f32_16x16x32_bf16 v[180:183], v[132:135], v[16:19], v[180:183]
    v_mfma_f32_16x16x32_bf16 v[228:231], v[132:135], v[22:25], v[228:231]
    ds_read_b64_tr_b16 v[122:123], v2 offset:14336
    v_fma_f32 v101, v101, s28, v12
    v_mfma_f32_16x16x32_bf16 a[20:23], v[132:135], v[28:31], a[20:23]
    ds_read_b64_tr_b16 v[130:131], v4 offset:14336
    v_fma_f32 v78, v78, s28, v9
    v_mfma_f32_16x16x32_bf16 a[68:71], v[132:135], v[34:37], a[68:71]
    ds_read_b64_tr_b16 v[126:127], v3 offset:14336
    v_fma_f32 v76, v76, s28, v9
    v_mfma_f32_16x16x32_bf16 a[116:119], v[132:135], v[40:43], a[116:119]
    ds_read_b64_tr_b16 v[134:135], v5 offset:14336
    v_fma_f32 v94, v94, s28, v11
    v_mfma_f32_16x16x32_bf16 v[184:187], v[112:115], v[16:19], v[184:187]
    ds_read_b64_tr_b16 v[132:133], v5 offset:20480
    v_fma_f32 v109, v109, s28, v13
    v_mfma_f32_16x16x32_bf16 v[232:235], v[112:115], v[22:25], v[232:235]
    ds_read_b64_tr_b16 v[128:129], v4 offset:20480
    v_mfma_f32_16x16x32_bf16 a[24:27], v[112:115], v[28:31], a[24:27]
    v_exp_f32 v87, v87
    v_mfma_f32_16x16x32_bf16 a[72:75], v[112:115], v[34:37], a[72:75]
    v_exp_f32 v84, v84
    v_mfma_f32_16x16x32_bf16 a[120:123], v[112:115], v[40:43], a[120:123]
    v_exp_f32 v88, v88
    v_mfma_f32_16x16x32_bf16 v[188:191], v[116:119], v[16:19], v[188:191]
    v_exp_f32 v109, v109
    v_mfma_f32_16x16x32_bf16 v[236:239], v[116:119], v[22:25], v[236:239]
    v_exp_f32 v90, v90
    v_mfma_f32_16x16x32_bf16 a[28:31], v[116:119], v[28:31], a[28:31]
    v_fma_f32 v108, v108, s28, v13
    v_mfma_f32_16x16x32_bf16 a[76:79], v[116:119], v[34:37], a[76:79]
    v_exp_f32 v108, v108
    v_mfma_f32_16x16x32_bf16 a[124:127], v[116:119], v[40:43], a[124:127]
    s_waitcnt lgkmcnt(2)
    v_exp_f32 v99, v99
    v_mfma_f32_16x16x32_bf16 v[192:195], v[120:123], v[16:19], v[192:195]
    v_fma_f32 v95, v95, s28, v11
    v_fma_f32 v86, v86, s28, v10
    v_mfma_f32_16x16x32_bf16 v[240:243], v[120:123], v[22:25], v[240:243]
    s_waitcnt vmcnt(11) lgkmcnt(0)
    v_exp_f32 v110, v110
    v_mfma_f32_16x16x32_bf16 a[32:35], v[120:123], v[28:31], a[32:35]
    s_add_u32 m0, s22, 36864
    v_cvt_pk_bf16_f32 v33, v98, v99
    v_cvt_pk_bf16_f32 v38, v104, v105
    v_mfma_f32_16x16x32_bf16 a[80:83], v[120:123], v[34:37], a[80:83]
    s_barrier
    v_mfma_f32_16x16x32_bf16 a[128:131], v[120:123], v[40:43], a[128:131]
    buffer_load_dwordx4 v6, s[8:11], s21 offen lds
    v_mfma_f32_16x16x32_bf16 v[196:199], v[124:127], v[16:19], v[196:199]
    ds_read_b128 v[120:123], v0 offset:13312
    v_mfma_f32_16x16x32_bf16 v[244:247], v[124:127], v[22:25], v[244:247]
    v_fma_f32 v100, v100, s28, v12
    v_mfma_f32_16x16x32_bf16 a[36:39], v[124:127], v[28:31], a[36:39]
    v_cvt_pk_bf16_f32 v27, v90, v91
    v_fma_f32 v103, v103, s28, v12
    v_mfma_f32_16x16x32_bf16 a[84:87], v[124:127], v[34:37], a[84:87]
    ds_read_b128 v[112:115], v0 offset:12288
    v_fma_f32 v79, v79, s28, v9
    v_mfma_f32_16x16x32_bf16 a[132:135], v[124:127], v[40:43], a[132:135]
    s_add_u32 s21, s21, 128
    v_fma_f32 v93, v93, s28, v11
    v_fma_f32 v96, v96, s28, v12
    v_mfma_f32_16x16x32_bf16 v[200:203], v[128:131], v[16:19], v[200:203]
    v_exp_f32 v77, v77
    v_mfma_f32_16x16x32_bf16 v[248:251], v[128:131], v[22:25], v[248:251]
    s_add_u32 m0, s22, 37888
    v_exp_f32 v92, v92
    v_mfma_f32_16x16x32_bf16 a[40:43], v[128:131], v[28:31], a[40:43]
    buffer_load_dwordx4 v6, s[8:11], s21 offen lds
    v_mfma_f32_16x16x32_bf16 a[88:91], v[128:131], v[34:37], a[88:91]
    ds_read_b128 v[116:119], v1 offset:12288
    v_mfma_f32_16x16x32_bf16 a[136:139], v[128:131], v[40:43], a[136:139]
    v_exp_f32 v96, v96
    v_mfma_f32_16x16x32_bf16 v[204:207], v[132:135], v[16:19], v[204:207]
    ds_read_b128 v[124:127], v1 offset:13312
    s_add_u32 s21, s21, 128
    v_mfma_f32_16x16x32_bf16 v[252:255], v[132:135], v[22:25], v[252:255]
    s_add_u32 m0, s22, 38912
    v_exp_f32 v76, v76
    v_mfma_f32_16x16x32_bf16 a[44:47], v[132:135], v[28:31], a[44:47]
    v_exp_f32 v97, v97
    v_mfma_f32_16x16x32_bf16 a[92:95], v[132:135], v[34:37], a[92:95]
    buffer_load_dwordx4 v6, s[8:11], s21 offen lds
    v_mfma_f32_16x16x32_bf16 a[140:143], v[132:135], v[40:43], a[140:143]
    s_waitcnt lgkmcnt(2)
    v_exp_f32 v94, v94
    v_mfma_f32_16x16x32_bf16 v[72:75], v[112:115], a[144:147], 0
    v_exp_f32 v106, v106
    v_mfma_f32_16x16x32_bf16 v[80:83], v[112:115], a[168:171], 0
    v_cvt_pk_bf16_f32 v32, v96, v97
    v_cvt_pk_bf16_f32 v26, v88, v89
    v_mfma_f32_16x16x32_bf16 v[88:91], v[112:115], a[192:195], 0
    v_exp_f32 v86, v86
    v_mfma_f32_16x16x32_bf16 v[96:99], v[112:115], a[216:219], 0
    ds_read_b128 v[128:131], v0 offset:14336
    v_cvt_pk_bf16_f32 v39, v106, v107
    v_mfma_f32_16x16x32_bf16 v[104:107], v[112:115], a[240:243], 0
    s_waitcnt lgkmcnt(2)
    v_exp_f32 v101, v101
    v_mfma_f32_16x16x32_bf16 v[72:75], v[116:119], a[148:151], v[72:75]
    v_exp_f32 v79, v79
    v_mfma_f32_16x16x32_bf16 v[80:83], v[116:119], a[172:175], v[80:83]
    v_exp_f32 v78, v78
    v_mfma_f32_16x16x32_bf16 v[88:91], v[116:119], a[196:199], v[88:91]
    v_mfma_f32_16x16x32_bf16 v[96:99], v[116:119], a[220:223], v[96:99]
    v_exp_f32 v85, v85
    v_mfma_f32_16x16x32_bf16 v[104:107], v[116:119], a[244:247], v[104:107]
    v_mfma_f32_16x16x32_bf16 v[72:75], v[120:123], a[152:155], v[72:75]
    ds_read_b128 v[132:135], v1 offset:14336
    v_mfma_f32_16x16x32_bf16 v[80:83], v[120:123], a[176:179], v[80:83]
    v_exp_f32 v111, v111
    v_mfma_f32_16x16x32_bf16 v[88:91], v[120:123], a[200:203], v[88:91]
    s_add_u32 s21, s21, 12032
    v_mfma_f32_16x16x32_bf16 v[96:99], v[120:123], a[224:227], v[96:99]
    v_cvt_pk_bf16_f32 v22, v84, v85
    v_mfma_f32_16x16x32_bf16 v[104:107], v[120:123], a[248:251], v[104:107]
    s_waitcnt lgkmcnt(1)
    v_exp_f32 v93, v93
    v_mfma_f32_16x16x32_bf16 v[72:75], v[124:127], a[156:159], v[72:75]
    ds_read_b128 v[120:123], v0 offset:18432
    v_mfma_f32_16x16x32_bf16 v[80:83], v[124:127], a[180:183], v[80:83]
    v_exp_f32 v103, v103
    v_mfma_f32_16x16x32_bf16 v[88:91], v[124:127], a[204:207], v[88:91]
    ds_read_b128 v[112:115], v0 offset:20480
    v_mfma_f32_16x16x32_bf16 v[96:99], v[124:127], a[228:231], v[96:99]
    v_cvt_pk_bf16_f32 v23, v86, v87
    v_mfma_f32_16x16x32_bf16 v[104:107], v[124:127], a[252:255], v[104:107]
    ds_read_b128 v[116:119], v1 offset:20480
    v_cvt_pk_bf16_f32 v41, v110, v111
    v_mfma_f32_16x16x32_bf16 v[72:75], v[128:131], a[160:163], v[72:75]
    v_cvt_pk_bf16_f32 v16, v76, v77
    v_cvt_pk_bf16_f32 v40, v108, v109
    v_mfma_f32_16x16x32_bf16 v[80:83], v[128:131], a[184:187], v[80:83]
    v_mfma_f32_16x16x32_bf16 v[88:91], v[128:131], a[208:211], v[88:91]
    v_exp_f32 v100, v100
    v_mfma_f32_16x16x32_bf16 v[96:99], v[128:131], a[232:235], v[96:99]
    v_exp_f32 v95, v95
    v_mfma_f32_16x16x32_bf16 v[104:107], v[128:131], v[136:139], v[104:107]
    s_waitcnt lgkmcnt(3)
    v_fma_f32 v102, v102, s28, v12
    v_mfma_f32_16x16x32_bf16 v[72:75], v[132:135], a[164:167], v[72:75]
    v_exp_f32 v102, v102
    v_mfma_f32_16x16x32_bf16 v[80:83], v[132:135], a[188:191], v[80:83]
    v_cvt_pk_bf16_f32 v28, v92, v93
    v_cvt_pk_bf16_f32 v17, v78, v79
    v_mfma_f32_16x16x32_bf16 v[88:91], v[132:135], a[212:215], v[88:91]
    ds_read_b128 v[124:127], v1 offset:18432
    v_cvt_pk_bf16_f32 v29, v94, v95
    v_mfma_f32_16x16x32_bf16 v[44:47], v[52:55], v[14:17], v[48:51]
    v_mfma_f32_16x16x32_bf16 v[96:99], v[132:135], a[236:239], v[96:99]
    ds_read_b128 v[128:131], v0 offset:19456
    v_mfma_f32_16x16x32_bf16 v[104:107], v[132:135], v[140:143], v[104:107]
    ds_read_b128 v[132:135], v1 offset:19456
    v_cvt_pk_bf16_f32 v35, v102, v103
    v_mfma_f32_16x16x32_bf16 v[44:47], v[56:59], v[20:23], v[44:47]
    v_cvt_pk_bf16_f32 v34, v100, v101
    v_mfma_f32_16x16x32_bf16 v[44:47], v[60:63], v[26:29], v[44:47]
    s_nop 0
    v_mfma_f32_16x16x32_bf16 v[44:47], v[64:67], v[32:35], v[44:47]
    v_mfma_f32_16x16x32_bf16 v[44:47], v[68:71], v[38:41], v[44:47]
    s_waitcnt lgkmcnt(3)
    v_mfma_f32_16x16x32_bf16 v[76:79], v[112:115], a[160:163], 0
    v_mfma_f32_16x16x32_bf16 v[84:87], v[112:115], a[184:187], 0
    v_mfma_f32_16x16x32_bf16 v[92:95], v[112:115], a[208:211], 0
    v_mfma_f32_16x16x32_bf16 v[100:103], v[112:115], a[232:235], 0
    v_mfma_f32_16x16x32_bf16 v[108:111], v[112:115], v[136:139], 0
    s_nop 1
    v_cmp_lt_f32 vcc, s29, v44
    v_mfma_f32_16x16x32_bf16 v[76:79], v[116:119], a[164:167], v[76:79]
    s_waitcnt vmcnt(7) lgkmcnt(0)
    v_mfma_f32_16x16x32_bf16 v[84:87], v[116:119], a[188:191], v[84:87]
    s_barrier
    v_mfma_f32_16x16x32_bf16 v[92:95], v[116:119], a[212:215], v[92:95]
    s_cbranch_vccnz L_rs_tr55a
L_ret_tr55a:
    ds_read_b64_tr_b16 v[112:113], v2 offset:0
    v_mfma_f32_16x16x32_bf16 v[100:103], v[116:119], a[236:239], v[100:103]
    v_fma_f32 v81, v81, s28, v10
    v_fma_f32 v74, v74, s28, v9
    v_mfma_f32_16x16x32_bf16 v[108:111], v[116:119], v[140:143], v[108:111]
    s_add_u32 m0, s22, 12288
    v_fma_f32 v80, v80, s28, v10
    v_fma_f32 v75, v75, s28, v9
    v_mfma_f32_16x16x32_bf16 v[76:79], v[120:123], a[144:147], v[76:79]
    v_exp_f32 v74, v74
    v_mfma_f32_16x16x32_bf16 v[84:87], v[120:123], a[168:171], v[84:87]
    buffer_load_dwordx4 v6, s[4:7], s20 offen lds
    v_mfma_f32_16x16x32_bf16 v[92:95], v[120:123], a[192:195], v[92:95]
    s_add_u32 s20, s20, 128
    v_fma_f32 v83, v83, s28, v10
    v_fma_f32 v82, v82, s28, v10
    v_mfma_f32_16x16x32_bf16 v[100:103], v[120:123], a[216:219], v[100:103]
    v_exp_f32 v83, v83
    v_mfma_f32_16x16x32_bf16 v[108:111], v[120:123], a[240:243], v[108:111]
    s_add_u32 m0, s22, 13312
    ds_read_b64_tr_b16 v[114:115], v2 offset:6144
    v_fma_f32 v72, v72, s28, v9
    v_mfma_f32_16x16x32_bf16 v[76:79], v[124:127], a[148:151], v[76:79]
    ds_read_b64_tr_b16 v[116:117], v3 offset:0
    v_exp_f32 v75, v75
    v_mfma_f32_16x16x32_bf16 v[84:87], v[124:127], a[172:175], v[84:87]
    buffer_load_dwordx4 v6, s[4:7], s20 offen lds
    v_mfma_f32_16x16x32_bf16 v[92:95], v[124:127], a[196:199], v[92:95]
    ds_read_b64_tr_b16 v[118:119], v3 offset:6144
    v_fma_f32 v73, v73, s28, v9
    v_mfma_f32_16x16x32_bf16 v[100:103], v[124:127], a[220:223], v[100:103]
    s_add_u32 s20, s20, 128
    v_exp_f32 v72, v72
    v_mfma_f32_16x16x32_bf16 v[108:111], v[124:127], a[244:247], v[108:111]
    v_exp_f32 v82, v82
    v_mfma_f32_16x16x32_bf16 v[76:79], v[128:131], a[152:155], v[76:79]
    v_exp_f32 v81, v81
    v_mfma_f32_16x16x32_bf16 v[84:87], v[128:131], a[176:179], v[84:87]
    v_exp_f32 v73, v73
    v_mfma_f32_16x16x32_bf16 v[92:95], v[128:131], a[200:203], v[92:95]
    s_add_u32 m0, s22, 14336
    ds_read_b64_tr_b16 v[120:121], v4 offset:0
    v_cvt_pk_bf16_f32 v18, v72, v73
    v_mfma_f32_16x16x32_bf16 v[100:103], v[128:131], a[224:227], v[100:103]
    ds_read_b64_tr_b16 v[122:123], v4 offset:6144
    v_cvt_pk_bf16_f32 v19, v74, v75
    v_mfma_f32_16x16x32_bf16 v[108:111], v[128:131], a[248:251], v[108:111]
    buffer_load_dwordx4 v6, s[4:7], s20 offen lds
    v_mfma_f32_16x16x32_bf16 v[76:79], v[132:135], a[156:159], v[76:79]
    v_exp_f32 v80, v80
    v_mfma_f32_16x16x32_bf16 v[84:87], v[132:135], a[180:183], v[84:87]
    s_add_u32 s20, s20, 12032
    ds_read_b64_tr_b16 v[124:125], v5 offset:0
    v_cvt_pk_bf16_f32 v24, v80, v81
    v_mfma_f32_16x16x32_bf16 v[92:95], v[132:135], a[204:207], v[92:95]
    buffer_load_dwordx4 v[136:139], v144, s[12:15], s48 offen offset:256 nt
    v_mfma_f32_16x16x32_bf16 v[100:103], v[132:135], a[228:231], v[100:103]
    ds_read_b64_tr_b16 v[126:127], v5 offset:6144
    v_cvt_pk_bf16_f32 v25, v82, v83
    v_mfma_f32_16x16x32_bf16 v[108:111], v[132:135], a[252:255], v[108:111]
    buffer_load_dwordx4 v[140:143], v144, s[12:15], s48 offen offset:320 nt
    ds_read_b64_tr_b16 v[128:129], v2 offset:1024
    v_fma_f32 v106, v106, s28, v13
    s_waitcnt lgkmcnt(7)
    v_mfma_f32_16x16x32_bf16 v[160:163], v[112:115], v[14:17], v[160:163]
    ds_read_b64_tr_b16 v[134:135], v3 offset:7168
    v_fma_f32 v99, v99, s28, v12
    v_mfma_f32_16x16x32_bf16 v[208:211], v[112:115], v[20:23], v[208:211]
    v_lshrrev_b32 v153, 11, v0
    v_fma_f32 v84, v84, s28, v10
    v_mfma_f32_16x16x32_bf16 a[0:3], v[112:115], v[26:29], a[0:3]
    v_xor_b32 v153, s65, v153
    v_and_b32 v152, 0x3ff, v0
    v_mfma_f32_16x16x32_bf16 a[48:51], v[112:115], v[32:35], a[48:51]
    v_lshl_add_u32 v152, v153, 10, v152
    v_fma_f32 v95, v95, s28, v11
    v_mfma_f32_16x16x32_bf16 a[96:99], v[112:115], v[38:41], a[96:99]
    s_waitcnt lgkmcnt(6)
    ds_read_b64_tr_b16 v[132:133], v3 offset:1024
    v_fma_f32 v96, v96, s28, v12
    v_mfma_f32_16x16x32_bf16 v[164:167], v[116:119], v[14:17], v[164:167]
    v_fma_f32 v94, v94, s28, v11
    v_add_u32 v152, s38, v152
    v_mfma_f32_16x16x32_bf16 v[212:215], v[116:119], v[20:23], v[212:215]
    ds_read_b128 a[224:227], v152 offset:20480
    v_xor_b32 v153, 64, v152
    v_mfma_f32_16x16x32_bf16 a[4:7], v[116:119], v[26:29], a[4:7]
    ds_read_b128 a[148:151], v153 offset:0
    v_fma_f32 v104, v104, s28, v13
    v_mfma_f32_16x16x32_bf16 a[52:55], v[116:119], v[32:35], a[52:55]
    ds_read_b64_tr_b16 v[130:131], v2 offset:7168
    v_fma_f32 v91, v91, s28, v11
    v_mfma_f32_16x16x32_bf16 a[100:103], v[116:119], v[38:41], a[100:103]
    s_waitcnt lgkmcnt(5)
    v_fma_f32 v88, v88, s28, v11
    v_fma_f32 v89, v89, s28, v11
    v_mfma_f32_16x16x32_bf16 v[168:171], v[120:123], v[14:17], v[168:171]
    v_exp_f32 v91, v91
    v_mfma_f32_16x16x32_bf16 v[216:219], v[120:123], v[20:23], v[216:219]
    ds_read_b64_tr_b16 v[114:115], v4 offset:7168
    v_fma_f32 v87, v87, s28, v10
    v_mfma_f32_16x16x32_bf16 a[8:11], v[120:123], v[26:29], a[8:11]
    v_exp_f32 v106, v106
    v_mfma_f32_16x16x32_bf16 a[56:59], v[120:123], v[32:35], a[56:59]
    v_exp_f32 v87, v87
    v_mfma_f32_16x16x32_bf16 a[104:107], v[120:123], v[38:41], a[104:107]
    ds_read_b128 a[216:219], v152 offset:18432
    v_fma_f32 v110, v110, s28, v13
    v_mfma_f32_16x16x32_bf16 v[172:175], v[124:127], v[14:17], v[172:175]
    ds_read_b128 a[176:179], v152 offset:8192
    v_fma_f32 v103, v103, s28, v12
    v_mfma_f32_16x16x32_bf16 v[220:223], v[124:127], v[20:23], v[220:223]
    ds_read_b64_tr_b16 v[112:113], v4 offset:1024
    v_fma_f32 v90, v90, s28, v11
    v_mfma_f32_16x16x32_bf16 a[12:15], v[124:127], v[26:29], a[12:15]
    v_exp_f32 v88, v88
    v_mfma_f32_16x16x32_bf16 a[60:63], v[124:127], v[32:35], a[60:63]
    v_exp_f32 v110, v110
    v_mfma_f32_16x16x32_bf16 a[108:111], v[124:127], v[38:41], a[108:111]
    s_waitcnt lgkmcnt(4)
    ds_read_b64_tr_b16 v[116:117], v5 offset:1024
    v_fma_f32 v111, v111, s28, v13
    v_mfma_f32_16x16x32_bf16 v[176:179], v[128:131], v[14:17], v[176:179]
    ds_read_b64_tr_b16 v[122:123], v2 offset:8192
    v_fma_f32 v79, v79, s28, v9
    v_mfma_f32_16x16x32_bf16 v[224:227], v[128:131], v[20:23], v[224:227]
    ds_read_b64_tr_b16 v[118:119], v5 offset:7168
    v_fma_f32 v109, v109, s28, v13
    v_mfma_f32_16x16x32_bf16 a[16:19], v[128:131], v[26:29], a[16:19]
    ds_read_b64_tr_b16 v[126:127], v3 offset:8192
    v_fma_f32 v105, v105, s28, v13
    v_mfma_f32_16x16x32_bf16 a[64:67], v[128:131], v[32:35], a[64:67]
    v_exp_f32 v96, v96
    v_mfma_f32_16x16x32_bf16 a[112:115], v[128:131], v[38:41], a[112:115]
    v_exp_f32 v111, v111
    v_mfma_f32_16x16x32_bf16 v[180:183], v[132:135], v[14:17], v[180:183]
    ds_read_b64_tr_b16 v[128:129], v4 offset:2048
    v_exp_f32 v89, v89
    v_mfma_f32_16x16x32_bf16 v[228:231], v[132:135], v[20:23], v[228:231]
    ds_read_b64_tr_b16 v[120:121], v2 offset:2048
    v_fma_f32 v97, v97, s28, v12
    v_mfma_f32_16x16x32_bf16 a[20:23], v[132:135], v[26:29], a[20:23]
    ds_read_b64_tr_b16 v[124:125], v3 offset:2048
    v_fma_f32 v85, v85, s28, v10
    v_mfma_f32_16x16x32_bf16 a[68:71], v[132:135], v[32:35], a[68:71]
    ds_read_b128 a[220:223], v153 offset:18432
    v_fma_f32 v98, v98, s28, v12
    v_mfma_f32_16x16x32_bf16 a[116:119], v[132:135], v[38:41], a[116:119]
    s_waitcnt lgkmcnt(7)
    ds_read_b64_tr_b16 v[134:135], v5 offset:8192
    v_exp_f32 v98, v98
    v_mfma_f32_16x16x32_bf16 v[184:187], v[112:115], v[14:17], v[184:187]
    ds_read_b64_tr_b16 v[130:131], v4 offset:8192
    s_add_u32 s39, s39, 12288
    v_mfma_f32_16x16x32_bf16 v[232:235], v[112:115], v[20:23], v[232:235]
    ds_read_b128 a[168:171], v152 offset:6144
    v_exp_f32 v84, v84
    v_mfma_f32_16x16x32_bf16 a[24:27], v[112:115], v[26:29], a[24:27]
    ds_read_b64_tr_b16 v[132:133], v5 offset:2048
    v_cvt_pk_bf16_f32 v30, v88, v89
    v_mfma_f32_16x16x32_bf16 a[72:75], v[112:115], v[32:35], a[72:75]
    v_exp_f32 v90, v90
    v_mfma_f32_16x16x32_bf16 a[120:123], v[112:115], v[38:41], a[120:123]
    s_waitcnt lgkmcnt(7)
    ds_read_b128 a[172:175], v153 offset:6144
    v_cvt_pk_bf16_f32 v31, v90, v91
    v_mfma_f32_16x16x32_bf16 v[188:191], v[116:119], v[14:17], v[188:191]
    ds_read_b128 a[144:147], v152 offset:0
    v_fma_f32 v92, v92, s28, v11
    v_mfma_f32_16x16x32_bf16 v[236:239], v[116:119], v[20:23], v[236:239]
    v_exp_f32 v97, v97
    v_mfma_f32_16x16x32_bf16 a[28:31], v[116:119], v[26:29], a[28:31]
    ds_read_b128 a[152:155], v152 offset:2048
    v_fma_f32 v86, v86, s28, v10
    v_mfma_f32_16x16x32_bf16 a[76:79], v[116:119], v[32:35], a[76:79]
    v_exp_f32 v79, v79
    v_mfma_f32_16x16x32_bf16 a[124:127], v[116:119], v[38:41], a[124:127]
    s_waitcnt lgkmcnt(6)
    v_exp_f32 v104, v104
    v_mfma_f32_16x16x32_bf16 v[192:195], v[120:123], v[14:17], v[192:195]
    ds_read_b128 a[204:207], v153 offset:14336
    v_fma_f32 v107, v107, s28, v13
    v_mfma_f32_16x16x32_bf16 v[240:243], v[120:123], v[20:23], v[240:243]
    ds_read_b128 a[196:199], v153 offset:12288
    v_fma_f32 v101, v101, s28, v12
    v_mfma_f32_16x16x32_bf16 a[32:35], v[120:123], v[26:29], a[32:35]
    s_waitcnt vmcnt(9) lgkmcnt(5)
    ds_read_b128 a[192:195], v152 offset:12288
    v_fma_f32 v76, v76, s28, v9
    v_mfma_f32_16x16x32_bf16 a[80:83], v[120:123], v[32:35], a[80:83]
    s_barrier
    v_mfma_f32_16x16x32_bf16 a[128:131], v[120:123], v[38:41], a[128:131]
    v_exp_f32 v99, v99
    v_mfma_f32_16x16x32_bf16 v[196:199], v[124:127], v[14:17], v[196:199]
    s_add_u32 s21, s21, s62
    ds_read_b128 a[240:243], v152 offset:24576
    v_fma_f32 v78, v78, s28, v9
    v_mfma_f32_16x16x32_bf16 v[244:247], v[124:127], v[20:23], v[244:247]
    s_add_u32 m0, s22, 24576
    ds_read_b128 v[120:123], v0 offset:1024
    v_cvt_pk_bf16_f32 v36, v96, v97
    v_mfma_f32_16x16x32_bf16 a[36:39], v[124:127], v[26:29], a[36:39]
    ds_read_b128 v[112:115], v0 offset:0
    v_fma_f32 v102, v102, s28, v12
    v_mfma_f32_16x16x32_bf16 a[84:87], v[124:127], v[32:35], a[84:87]
    ds_read_b128 a[244:247], v153 offset:24576
    v_cvt_pk_bf16_f32 v37, v98, v99
    v_mfma_f32_16x16x32_bf16 a[132:135], v[124:127], v[38:41], a[132:135]
    ds_read_b128 a[156:159], v153 offset:2048
    buffer_load_dwordx4 v6, s[8:11], s21 offen lds
    v_mfma_f32_16x16x32_bf16 v[200:203], v[128:131], v[14:17], v[200:203]
    s_add_u32 s21, s21, 128
    ds_read_b128 a[180:183], v153 offset:8192
    v_fma_f32 v93, v93, s28, v11
    v_mfma_f32_16x16x32_bf16 v[248:251], v[128:131], v[20:23], v[248:251]
    s_add_u32 m0, s22, 25600
    v_exp_f32 v105, v105
    v_mfma_f32_16x16x32_bf16 a[40:43], v[128:131], v[26:29], a[40:43]
    buffer_load_dwordx4 v6, s[8:11], s21 offen lds
    v_mfma_f32_16x16x32_bf16 a[88:91], v[128:131], v[32:35], a[88:91]
    ds_read_b128 v[116:119], v1 offset:0
    v_fma_f32 v100, v100, s28, v12
    v_mfma_f32_16x16x32_bf16 a[136:139], v[128:131], v[38:41], a[136:139]
    s_add_u32 s21, s21, 128
    s_add_u32 m0, s22, 26624
    ds_read_b128 a[228:231], v153 offset:20480
    v_mfma_f32_16x16x32_bf16 v[204:207], v[132:135], v[14:17], v[204:207]
    v_exp_f32 v92, v92
    v_mfma_f32_16x16x32_bf16 v[252:255], v[132:135], v[20:23], v[252:255]
    buffer_load_dwordx4 v6, s[8:11], s21 offen lds
    v_mfma_f32_16x16x32_bf16 a[44:47], v[132:135], v[26:29], a[44:47]
    v_exp_f32 v107, v107
    v_mfma_f32_16x16x32_bf16 a[92:95], v[132:135], v[32:35], a[92:95]
    v_exp_f32 v76, v76
    v_mfma_f32_16x16x32_bf16 a[140:143], v[132:135], v[38:41], a[140:143]
    s_waitcnt lgkmcnt(3)
    ds_read_b128 a[248:251], v152 offset:26624
    v_cvt_pk_bf16_f32 v42, v104, v105
    v_mfma_f32_16x16x32_bf16 v[72:75], v[112:115], a[144:147], 0
    ds_read_b128 a[200:203], v152 offset:14336
    v_cvt_pk_bf16_f32 v43, v106, v107
    v_mfma_f32_16x16x32_bf16 v[80:83], v[112:115], a[168:171], 0
    v_exp_f32 v78, v78
    v_mfma_f32_16x16x32_bf16 v[88:91], v[112:115], a[192:195], 0
    ds_read_b128 v[124:127], v1 offset:1024
    v_exp_f32 v85, v85
    v_mfma_f32_16x16x32_bf16 v[96:99], v[112:115], a[216:219], 0
    ds_read_b128 a[252:255], v153 offset:26624
    v_cvt_pk_bf16_f32 v41, v110, v111
    v_mfma_f32_16x16x32_bf16 v[104:107], v[112:115], a[240:243], 0
    s_waitcnt lgkmcnt(4)
    ds_read_b128 v[132:135], v1 offset:6144
    v_fma_f32 v77, v77, s28, v9
    v_mfma_f32_16x16x32_bf16 v[72:75], v[116:119], a[148:151], v[72:75]
    v_exp_f32 v103, v103
    v_mfma_f32_16x16x32_bf16 v[80:83], v[116:119], a[172:175], v[80:83]
    v_exp_f32 v95, v95
    v_mfma_f32_16x16x32_bf16 v[88:91], v[116:119], a[196:199], v[88:91]
    v_exp_f32 v86, v86
    v_mfma_f32_16x16x32_bf16 v[96:99], v[116:119], a[220:223], v[96:99]
    v_exp_f32 v100, v100
    v_mfma_f32_16x16x32_bf16 v[104:107], v[116:119], a[244:247], v[104:107]
    v_exp_f32 v93, v93
    v_mfma_f32_16x16x32_bf16 v[72:75], v[120:123], a[152:155], v[72:75]
    ds_read_b128 v[128:131], v0 offset:6144
    v_mfma_f32_16x16x32_bf16 v[80:83], v[120:123], a[176:179], v[80:83]
    s_waitcnt lgkmcnt(4)
    v_exp_f32 v94, v94
    v_mfma_f32_16x16x32_bf16 v[88:91], v[120:123], a[200:203], v[88:91]
    v_exp_f32 v109, v109
    v_mfma_f32_16x16x32_bf16 v[96:99], v[120:123], a[224:227], v[96:99]
    v_exp_f32 v77, v77
    v_mfma_f32_16x16x32_bf16 v[104:107], v[120:123], a[248:251], v[104:107]
    s_waitcnt lgkmcnt(1)
    v_cvt_pk_bf16_f32 v17, v78, v79
    v_fma_f32 v108, v108, s28, v13
    v_mfma_f32_16x16x32_bf16 v[72:75], v[124:127], a[156:159], v[72:75]
    v_exp_f32 v108, v108
    v_mfma_f32_16x16x32_bf16 v[80:83], v[124:127], a[180:183], v[80:83]
    v_cvt_pk_bf16_f32 v16, v76, v77
    v_cvt_pk_bf16_f32 v22, v84, v85
    v_mfma_f32_16x16x32_bf16 v[88:91], v[124:127], a[204:207], v[88:91]
    v_cvt_pk_bf16_f32 v40, v108, v109
    v_mfma_f32_16x16x32_bf16 v[96:99], v[124:127], a[228:231], v[96:99]
    v_exp_f32 v101, v101
    v_mfma_f32_16x16x32_bf16 v[48:51], v[52:55], v[16:19], v[44:47]
    ds_read_b128 v[112:115], v0 offset:7168
    v_cvt_pk_bf16_f32 v28, v92, v93
    v_mfma_f32_16x16x32_bf16 v[104:107], v[124:127], a[252:255], v[104:107]
    s_waitcnt lgkmcnt(1)
    v_cvt_pk_bf16_f32 v23, v86, v87
    v_cvt_pk_bf16_f32 v29, v94, v95
    v_mfma_f32_16x16x32_bf16 v[76:79], v[128:131], a[144:147], 0
    ds_read_b128 v[116:119], v1 offset:7168
    v_cvt_pk_bf16_f32 v34, v100, v101
    v_mfma_f32_16x16x32_bf16 v[84:87], v[128:131], a[168:171], 0
    v_exp_f32 v102, v102
    v_mfma_f32_16x16x32_bf16 v[92:95], v[128:131], a[192:195], 0
    ds_read_b128 a[232:235], v152 offset:22528
    v_cvt_pk_bf16_f32 v35, v102, v103
    v_mfma_f32_16x16x32_bf16 v[100:103], v[128:131], a[216:219], 0
    ds_read_b128 v[120:123], v0 offset:2048
    v_mfma_f32_16x16x32_bf16 v[108:111], v[128:131], a[240:243], 0
    v_mfma_f32_16x16x32_bf16 v[76:79], v[132:135], a[148:151], v[76:79]
    ds_read_b128 v[128:131], v0 offset:8192
    v_mfma_f32_16x16x32_bf16 v[84:87], v[132:135], a[172:175], v[84:87]
    ds_read_b128 a[160:163], v152 offset:4096
    v_mfma_f32_16x16x32_bf16 v[92:95], v[132:135], a[196:199], v[92:95]
    ds_read_b128 v[124:127], v1 offset:2048
    s_add_u32 s21, s21, 12032
    v_mfma_f32_16x16x32_bf16 v[100:103], v[132:135], a[220:223], v[100:103]
    ds_read_b128 a[184:187], v152 offset:10240
    v_mfma_f32_16x16x32_bf16 v[108:111], v[132:135], a[244:247], v[108:111]
    ds_read_b128 v[132:135], v1 offset:8192
    v_mfma_f32_16x16x32_bf16 v[48:51], v[56:59], v[22:25], v[48:51]
    s_waitcnt lgkmcnt(7)
    ds_read_b128 a[164:167], v153 offset:4096
    v_mfma_f32_16x16x32_bf16 v[76:79], v[112:115], a[152:155], v[76:79]
    ds_read_b128 a[208:211], v152 offset:16384
    v_mfma_f32_16x16x32_bf16 v[48:51], v[60:63], v[28:31], v[48:51]
    v_mfma_f32_16x16x32_bf16 v[48:51], v[64:67], v[34:37], v[48:51]
    v_mfma_f32_16x16x32_bf16 v[84:87], v[112:115], a[176:179], v[84:87]
    v_mfma_f32_16x16x32_bf16 v[92:95], v[112:115], a[200:203], v[92:95]
    ds_read_b128 a[236:239], v153 offset:22528
    v_mfma_f32_16x16x32_bf16 v[48:51], v[68:71], v[40:43], v[48:51]
    v_mfma_f32_16x16x32_bf16 v[100:103], v[112:115], a[224:227], v[100:103]
    ds_read_b128 a[188:191], v153 offset:10240
    s_waitcnt vmcnt(3)
    v_mfma_f32_16x16x32_bf16 v[108:111], v[112:115], a[248:251], v[108:111]
    v_mfma_f32_16x16x32_bf16 v[76:79], v[116:119], a[156:159], v[76:79]
    s_waitcnt vmcnt(8) lgkmcnt(4)
    ds_read_b128 a[212:215], v153 offset:16384
    v_mfma_f32_16x16x32_bf16 v[84:87], v[116:119], a[180:183], v[84:87]
    s_barrier
    v_mfma_f32_16x16x32_bf16 v[92:95], v[116:119], a[204:207], v[92:95]
    ds_read_b64_tr_b16 v[112:113], v2 offset:18432
    v_mfma_f32_16x16x32_bf16 v[100:103], v[116:119], a[228:231], v[100:103]
    v_mfma_f32_16x16x32_bf16 v[108:111], v[116:119], a[252:255], v[108:111]
    ds_read_b64_tr_b16 v[114:115], v2 offset:12288
    v_cmp_lt_f32 vcc, s29, v48
    v_mfma_f32_16x16x32_bf16 v[72:75], v[120:123], a[160:163], v[72:75]
    v_mfma_f32_16x16x32_bf16 v[80:83], v[120:123], a[184:187], v[80:83]
    s_waitcnt lgkmcnt(4)
    v_mfma_f32_16x16x32_bf16 v[88:91], v[120:123], a[208:211], v[88:91]
    v_mfma_f32_16x16x32_bf16 v[96:99], v[120:123], a[232:235], v[96:99]
    v_mfma_f32_16x16x32_bf16 v[104:107], v[120:123], v[136:139], v[104:107]
    s_cbranch_vccnz L_rs_tr55b
L_ret_tr55b:
    v_mfma_f32_16x16x32_bf16 v[72:75], v[124:127], a[164:167], v[72:75]
    s_waitcnt lgkmcnt(2)
    ds_read_b64_tr_b16 v[116:117], v3 offset:18432
    v_mfma_f32_16x16x32_bf16 v[80:83], v[124:127], a[188:191], v[80:83]
    v_mfma_f32_16x16x32_bf16 v[88:91], v[124:127], a[212:215], v[88:91]
    ds_read_b64_tr_b16 v[118:119], v3 offset:12288
    s_add_u32 m0, s22, 0
    v_mfma_f32_16x16x32_bf16 v[96:99], v[124:127], a[236:239], v[96:99]
    buffer_load_dwordx4 v6, s[4:7], s20 offen lds
    v_mfma_f32_16x16x32_bf16 v[104:107], v[124:127], v[140:143], v[104:107]
    v_mfma_f32_16x16x32_bf16 v[76:79], v[128:131], a[160:163], v[76:79]
    v_mfma_f32_16x16x32_bf16 v[84:87], v[128:131], a[184:187], v[84:87]
    v_mfma_f32_16x16x32_bf16 v[92:95], v[128:131], a[208:211], v[92:95]
    ds_read_b64_tr_b16 v[120:121], v4 offset:18432
    v_mfma_f32_16x16x32_bf16 v[100:103], v[128:131], a[232:235], v[100:103]
    s_add_u32 s20, s20, 128
    ds_read_b64_tr_b16 v[122:123], v4 offset:12288
    v_mfma_f32_16x16x32_bf16 v[108:111], v[128:131], v[136:139], v[108:111]
    ds_read_b64_tr_b16 v[124:125], v5 offset:18432
    s_add_u32 m0, s22, 1024
    v_mfma_f32_16x16x32_bf16 v[76:79], v[132:135], a[164:167], v[76:79]
    buffer_load_dwordx4 v6, s[4:7], s20 offen lds
    v_mfma_f32_16x16x32_bf16 v[84:87], v[132:135], a[188:191], v[84:87]
    s_add_u32 s20, s20, 128
    v_mfma_f32_16x16x32_bf16 v[92:95], v[132:135], a[212:215], v[92:95]
    ds_read_b64_tr_b16 v[126:127], v5 offset:12288
    s_add_u32 m0, s22, 2048
    v_mfma_f32_16x16x32_bf16 v[100:103], v[132:135], a[236:239], v[100:103]
    buffer_load_dwordx4 v6, s[4:7], s20 offen lds
    v_mfma_f32_16x16x32_bf16 v[108:111], v[132:135], v[140:143], v[108:111]
    s_add_u32 s20, s20, 12032
    v_max3_f32 v150, v72, v73, v74
    v_max3_f32 v150, v150, v75, v76
    v_max3_f32 v150, v150, v77, v78
    v_max_f32 v150, v150, v79
    v_mov_b32 v151, v150
    s_waitcnt lgkmcnt(6)
    v_mfma_f32_16x16x32_bf16 v[160:163], v[112:115], v[16:19], v[160:163]
    v_permlane32_swap_b32 v151, v150
    v_max_f32 v150, v150, v151
    v_mov_b32 v151, v150
    v_mfma_f32_16x16x32_bf16 v[208:211], v[112:115], v[22:25], v[208:211]
    v_rcp_f32 v49, v49
    v_mfma_f32_16x16x32_bf16 a[0:3], v[112:115], v[28:31], a[0:3]
    v_permlane16_swap_b32 v151, v150
    v_max_f32 v150, v150, v151
    v_mul_f32_e64 v9, -s28, v150
    v_max3_f32 v150, v80, v81, v82
    v_mfma_f32_16x16x32_bf16 a[48:51], v[112:115], v[34:37], a[48:51]
    s_mov_b32 s67, s34
    v_max3_f32 v150, v150, v83, v84
    v_max3_f32 v150, v150, v85, v86
    v_max_f32 v150, v150, v87
    v_mov_b32 v151, v150
    v_mfma_f32_16x16x32_bf16 a[96:99], v[112:115], v[40:43], a[96:99]
    s_waitcnt lgkmcnt(4)
    v_and_b32 v149, 0x3ff, v0
    v_permlane32_swap_b32 v151, v150
    v_accvgpr_read_b32 v156, a48
    v_mfma_f32_16x16x32_bf16 v[164:167], v[116:119], v[16:19], v[164:167]
    s_add_u32 s18, s34, 30720
    ds_read_b64_tr_b16 v[132:133], v3 offset:19456
    v_max_f32 v150, v150, v151
    v_mov_b32 v151, v150
    v_mfma_f32_16x16x32_bf16 v[212:215], v[116:119], v[22:25], v[212:215]
    ds_read_b64_tr_b16 v[134:135], v3 offset:13312
    v_permlane16_swap_b32 v151, v150
    v_max_f32 v150, v150, v151
    v_mul_f32_e64 v10, -s28, v150
    v_mov_b32 v148, v48
    v_mfma_f32_16x16x32_bf16 a[4:7], v[116:119], v[28:31], a[4:7]
    ds_read_b64_tr_b16 v[130:131], v2 offset:13312
    v_max3_f32 v150, v88, v89, v90
    v_mul_f32 v212, v212, v49
    v_lshrrev_b32 v152, 11, v0
    v_max3_f32 v150, v150, v91, v92
    v_max3_f32 v150, v150, v93, v94
    v_max_f32 v150, v150, v95
    v_mfma_f32_16x16x32_bf16 a[52:55], v[116:119], v[34:37], a[52:55]
    s_mov_b32 s34, s33
    ds_read_b64_tr_b16 v[112:113], v4 offset:19456
    v_mov_b32 v151, v150
    v_fma_f32 v77, v77, s28, v9
    v_fma_f32 v76, v76, s28, v9
    v_mfma_f32_16x16x32_bf16 a[100:103], v[116:119], v[40:43], a[100:103]
    s_waitcnt lgkmcnt(4)
    v_rcp_f32 v51, v51
    v_mfma_f32_16x16x32_bf16 v[168:171], v[120:123], v[16:19], v[168:171]
    v_permlane32_swap_b32 v151, v150
    v_fma_f32 v72, v72, s28, v9
    v_max_f32 v150, v150, v151
    v_fma_f32 v73, v73, s28, v9
    v_mul_f32 v208, v208, v49
    v_mov_b32 v151, v150
    v_mfma_f32_16x16x32_bf16 v[216:219], v[120:123], v[22:25], v[216:219]
    s_nop 0
    v_permlane16_swap_b32 v151, v150
    v_fma_f32 v87, v87, s28, v10
    v_max_f32 v150, v150, v151
    v_mfma_f32_16x16x32_bf16 a[8:11], v[120:123], v[28:31], a[8:11]
    ds_read_b64_tr_b16 v[114:115], v4 offset:13312
    v_mul_f32_e64 v11, -s28, v150
    v_mfma_f32_16x16x32_bf16 a[56:59], v[120:123], v[34:37], a[56:59]
    s_add_u32 s64, s64, s62
    ds_read_b64_tr_b16 v[128:129], v2 offset:19456
    v_xor_b32 v152, s65, v152
    v_mfma_f32_16x16x32_bf16 a[104:107], v[120:123], v[40:43], a[104:107]
    s_add_u32 s64, s64, 196608
    v_fma_f32 v91, v91, s28, v11
    v_fma_f32 v81, v81, s28, v10
    v_fma_f32 v95, v95, s28, v11
    v_max3_f32 v150, v96, v97, v98
    v_exp_f32 v72, v72
    v_mfma_f32_16x16x32_bf16 v[172:175], v[124:127], v[16:19], v[172:175]
    s_mov_b32 s39, s64
    ds_read_b64_tr_b16 v[118:119], v5 offset:13312
    v_accvgpr_read_b32 v154, a2
    v_lshl_add_u32 v149, v152, 10, v149
    v_max3_f32 v150, v150, v99, v100
    v_fma_f32 v79, v79, s28, v9
    v_fma_f32 v90, v90, s28, v11
    v_exp_f32 v77, v77
    v_mbcnt_lo_u32_b32 v152, -1, 0
    v_max3_f32 v150, v150, v101, v102
    v_mfma_f32_16x16x32_bf16 v[220:223], v[124:127], v[22:25], v[220:223]
    s_add_u32 s37, s37, 1
    v_max_f32 v150, v150, v103
    v_mov_b32 v151, v150
    v_mfma_f32_16x16x32_bf16 a[12:15], v[124:127], v[28:31], a[12:15]
    s_bitcmp1_b32 s63, s37
    v_permlane32_swap_b32 v151, v150
    v_fma_f32 v74, v74, s28, v9
    v_mfma_f32_16x16x32_bf16 a[60:63], v[124:127], v[34:37], a[60:63]
    s_cselect_b32 s62, 4294770688, 0
    ds_read_b64_tr_b16 v[120:121], v2 offset:20480
    v_mul_f32 v209, v209, v49
    v_max_f32 v150, v150, v151
    v_mov_b32 v151, v150
    v_mbcnt_hi_u32_b32 v152, -1, v152
    v_fma_f32 v88, v88, s28, v11
    v_fma_f32 v93, v93, s28, v11
    v_mfma_f32_16x16x32_bf16 a[108:111], v[124:127], v[40:43], a[108:111]
    s_waitcnt lgkmcnt(2)
    v_permlane16_swap_b32 v151, v150
    v_mfma_f32_16x16x32_bf16 v[176:179], v[128:131], v[16:19], v[176:179]
    s_cselect_b32 s42, 0, 325632
    ds_read_b64_tr_b16 v[116:117], v5 offset:19456
    v_fma_f32 v92, v92, s28, v11
    v_mfma_f32_16x16x32_bf16 v[224:227], v[128:131], v[22:25], v[224:227]
    s_add_u32 s35, s35, s42
    v_permlane32_swap_b32 v48, v148
    v_mfma_f32_16x16x32_bf16 a[16:19], v[128:131], v[28:31], a[16:19]
    v_max_f32 v150, v150, v151
    v_rcp_f32 v48, v48
    v_mfma_f32_16x16x32_bf16 a[64:67], v[128:131], v[34:37], a[64:67]
    s_lshl_b32 s42, s37, 1
    v_mul_f32_e64 v12, -s28, v150
    v_fma_f32 v82, v82, s28, v10
    v_max3_f32 v150, v104, v105, v106
    v_mfma_f32_16x16x32_bf16 a[112:115], v[128:131], v[40:43], a[112:115]
    v_fma_f32 v98, v98, s28, v12
    v_mul_f32 v220, v220, v49
    v_mfma_f32_16x16x32_bf16 v[180:183], v[132:135], v[16:19], v[180:183]
    s_lshr_b32 s42, s31, s42
    ds_read_b64_tr_b16 v[122:123], v2 offset:14336
    v_max3_f32 v150, v150, v107, v108
    v_max3_f32 v150, v150, v109, v110
    v_mfma_f32_16x16x32_bf16 v[228:231], v[132:135], v[22:25], v[228:231]
    s_and_b32 s42, s42, 3
    ds_read_b64_tr_b16 v[130:131], v4 offset:14336
    v_lshrrev_b32 v152, 1, v152
    v_mfma_f32_16x16x32_bf16 a[20:23], v[132:135], v[28:31], a[20:23]
    s_add_u32 s42, s42, s36
    ds_read_b64_tr_b16 v[124:125], v3 offset:20480
    v_mul_f32 v214, v214, v49
    v_mfma_f32_16x16x32_bf16 a[68:71], v[132:135], v[34:37], a[68:71]
    s_sub_u32 s43, s42, 3
    v_max_f32 v150, v150, v111
    v_fma_f32 v85, v85, s28, v10
    v_mfma_f32_16x16x32_bf16 a[116:119], v[132:135], v[40:43], a[116:119]
    s_cmp_ge_u32 s42, 3
    v_exp_f32 v73, v73
    v_mfma_f32_16x16x32_bf16 v[184:187], v[112:115], v[16:19], v[184:187]
    s_cselect_b32 s42, s43, s42
    v_mul_f32 v215, v215, v49
    v_and_b32 v152, 24, v152
    v_fma_f32 v84, v84, s28, v10
    v_mfma_f32_16x16x32_bf16 v[232:235], v[112:115], v[22:25], v[232:235]
    s_mul_i32 s44, s3, 5
    v_accvgpr_read_b32 v157, a49
    v_fma_f32 v80, v80, s28, v10
    v_mfma_f32_16x16x32_bf16 a[24:27], v[112:115], v[28:31], a[24:27]
    s_mov_b32 s32, 1
    v_accvgpr_read_b32 v155, a3
    v_mul_f32 v211, v211, v49
    v_fma_f32 v83, v83, s28, v10
    v_mfma_f32_16x16x32_bf16 a[72:75], v[112:115], v[34:37], a[72:75]
    s_lshl_b32 s43, s3, 2
    ds_read_b64_tr_b16 v[128:129], v4 offset:20480
    v_fma_f32 v75, v75, s28, v9
    v_mfma_f32_16x16x32_bf16 a[120:123], v[112:115], v[40:43], a[120:123]
    s_waitcnt lgkmcnt(3)
    v_fma_f32 v89, v89, s28, v11
    v_fma_f32 v86, v86, s28, v10
    v_mov_b32 v151, v150
    v_mfma_f32_16x16x32_bf16 v[188:191], v[116:119], v[16:19], v[188:191]
    s_add_u32 s45, s43, 21
    v_exp_f32 v83, v83
    v_mfma_f32_16x16x32_bf16 v[236:239], v[116:119], v[22:25], v[236:239]
    s_cmp_eq_u32 s3, 0
    v_exp_f32 v90, v90
    v_mfma_f32_16x16x32_bf16 a[28:31], v[116:119], v[28:31], a[28:31]
    s_cselect_b32 s45, 20, s45
    v_permlane32_swap_b32 v151, v150
    v_mfma_f32_16x16x32_bf16 a[76:79], v[116:119], v[34:37], a[76:79]
    s_cselect_b32 s33, 1, 0
    ds_read_b64_tr_b16 v[126:127], v3 offset:14336
    v_bfe_u32 v152, s66, v152, 8
    v_max_f32 v150, v150, v151
    v_mfma_f32_16x16x32_bf16 a[124:127], v[116:119], v[40:43], a[124:127]
    s_cmp_eq_u32 s42, 1
    v_accvgpr_read_b32 v159, a51
    v_mul_f32 v157, v157, v51
    v_add_u32 v149, s38, v149
    s_cselect_b32 s44, s45, s44
    v_mul_f32 v213, v213, v49
    v_mfma_f32_16x16x32_bf16 v[192:195], v[120:123], v[16:19], v[192:195]
    s_cselect_b32 s32, s33, s32
    ds_read_b64_tr_b16 v[134:135], v5 offset:14336
    v_exp_f32 v91, v91
    v_mfma_f32_16x16x32_bf16 v[240:243], v[120:123], v[22:25], v[240:243]
    s_add_u32 s45, s43, 37
    v_exp_f32 v80, v80
    v_mfma_f32_16x16x32_bf16 a[32:35], v[120:123], v[28:31], a[32:35]
    s_cmp_eq_u32 s42, 2
    v_exp_f32 v88, v88
    v_mul_f32 v224, v224, v49
    s_cselect_b32 s44, s45, s44
    v_exp_f32 v81, v81
    v_mfma_f32_16x16x32_bf16 a[80:83], v[120:123], v[34:37], a[80:83]
    s_cselect_b32 s32, 0, s32
    v_exp_f32 v95, v95
    v_fma_f32 v94, v94, s28, v11
    v_mfma_f32_16x16x32_bf16 a[128:131], v[120:123], v[40:43], a[128:131]
    s_mul_i32 s44, s44, 6144
    ds_read_b64_tr_b16 v[132:133], v5 offset:20480
    v_mul_f32 v216, v216, v49
    v_fma_f32 v96, v96, s28, v12
    v_mul_f32 v235, v235, v49
    s_waitcnt lgkmcnt(2)
    v_mfma_f32_16x16x32_bf16 v[196:199], v[124:127], v[16:19], v[196:199]
    s_add_u32 s33, s35, s44
    v_fma_f32 v100, v100, s28, v12
    v_exp_f32 v74, v74
    v_mfma_f32_16x16x32_bf16 v[244:247], v[124:127], v[22:25], v[244:247]
    s_mul_i32 s42, s32, 6144
    v_exp_f32 v89, v89
    s_add_u32 s42, s42, 24576
    v_cvt_pk_bf16_f32 v14, v72, v73
    v_exp_f32 v82, v82
    v_mfma_f32_16x16x32_bf16 a[36:39], v[124:127], v[28:31], a[36:39]
    s_add_u32 s42, s42, s33
    v_mov_b32 v151, v150
    v_mul_f32 v231, v231, v49
    v_mfma_f32_16x16x32_bf16 a[84:87], v[124:127], v[34:37], a[84:87]
    s_cmp_ge_u32 s37, 6
    v_exp_f32 v75, v75
    v_mfma_f32_16x16x32_bf16 a[132:135], v[124:127], v[40:43], a[132:135]
    s_cselect_b32 s14, 0, s42
    v_exp_f32 v86, v86
    v_mfma_f32_16x16x32_bf16 v[200:203], v[128:131], v[16:19], v[200:203]
    s_add_u32 s24, s67, 256
    s_add_u32 s25, s33, 256
    v_fma_f32 v102, v102, s28, v12
    v_cvt_pk_bf16_f32 v208, v208, v209
    v_mfma_f32_16x16x32_bf16 v[248:251], v[128:131], v[22:25], v[248:251]
    s_add_u32 s23, s38, 4096
    s_mov_b32 s27, 0x49249249
    v_cvt_pk_bf16_f32 v15, v74, v75
    v_mfma_f32_16x16x32_bf16 a[40:43], v[128:131], v[28:31], a[40:43]
    s_mov_b32 s30, 0
    v_permlane16_swap_b32 v151, v150
    v_mul_f32 v229, v229, v49
    v_mfma_f32_16x16x32_bf16 a[88:91], v[128:131], v[34:37], a[88:91]
    s_waitcnt vmcnt(8) lgkmcnt(0)
    v_fma_f32 v101, v101, s28, v12
    s_barrier
    ds_read_b128 v[120:123], v0 offset:13312
    v_mfma_f32_16x16x32_bf16 a[136:139], v[128:131], v[40:43], a[136:139]
    ds_read_b128 v[112:115], v0 offset:12288
    v_cvt_pk_bf16_f32 v20, v80, v81
    v_fma_f32 v78, v78, s28, v9
    v_max_f32 v150, v150, v151
    v_mul_f32 v244, v244, v49
    v_mfma_f32_16x16x32_bf16 v[204:207], v[132:135], v[16:19], v[204:207]
    ds_read_b128 v[116:119], v1 offset:12288
    v_mul_f32_e64 v13, -s28, v150
    v_fma_f32 v107, v107, s28, v13
    v_fma_f32 v99, v99, s28, v12
    v_fma_f32 v105, v105, s28, v13
    v_fma_f32 v106, v106, s28, v13
    v_pk_mul_f32 v[164:165], v[164:165], v[48:49] op_sel_hi:[1,0]
    v_fma_f32 v109, v109, s28, v13
    v_mul_f32 v230, v230, v49
    v_fma_f32 v110, v110, s28, v13
    v_exp_f32 v99, v99
    v_mul_f32 v251, v251, v49
    v_fma_f32 v97, v97, s28, v12
    v_mfma_f32_16x16x32_bf16 v[252:255], v[132:135], v[22:25], v[252:255]
    v_mul_f32 v221, v221, v49
    v_fma_f32 v103, v103, s28, v12
    v_cvt_pk_bf16_f32 v27, v90, v91
    v_mul_f32 v228, v228, v49
    v_cvt_pk_bf16_f32 v21, v82, v83
    v_mfma_f32_16x16x32_bf16 a[44:47], v[132:135], v[28:31], a[44:47]
    v_mul_f32 v156, v156, v51
    v_mul_f32 v210, v210, v49
    v_exp_f32 v85, v85
    v_mul_f32 v253, v253, v49
    v_accvgpr_read_b32 v153, a1
    v_fma_f32 v111, v111, s28, v13
    v_mfma_f32_16x16x32_bf16 a[92:95], v[132:135], v[34:37], a[92:95]
    v_exp_f32 v97, v97
    v_mfma_f32_16x16x32_bf16 a[140:143], v[132:135], v[40:43], a[140:143]
    s_waitcnt lgkmcnt(1)
    v_exp_f32 v96, v96
    v_xor_b32 v149, v149, v152
    v_mfma_f32_16x16x32_bf16 v[72:75], v[112:115], a[144:147], 0
    s_waitcnt lgkmcnt(0)
    v_mov_b32 v152, v148
    v_exp_f32 v103, v103
    v_mfma_f32_16x16x32_bf16 v[72:75], v[116:119], a[148:151], v[72:75]
    ds_read_b128 v[128:131], v0 offset:14336
    v_cvt_pk_bf16_f32 v26, v88, v89
    v_mfma_f32_16x16x32_bf16 v[72:75], v[120:123], a[152:155], v[72:75]
    ds_read_b128 v[124:127], v1 offset:13312
    v_exp_f32 v105, v105
    v_mfma_f32_16x16x32_bf16 v[80:83], v[112:115], a[168:171], 0
    v_exp_f32 v87, v87
    v_mfma_f32_16x16x32_bf16 v[80:83], v[116:119], a[172:175], v[80:83]
    v_rcp_f32 v50, v50
    v_mfma_f32_16x16x32_bf16 v[80:83], v[120:123], a[176:179], v[80:83]
    v_mul_f32 v217, v217, v49
    v_cvt_pk_bf16_f32 v32, v96, v97
    v_mul_f32 v219, v219, v49
    v_mfma_f32_16x16x32_bf16 v[88:91], v[112:115], a[192:195], 0
    v_mul_f32 v225, v225, v49
    v_exp_f32 v98, v98
    v_mfma_f32_16x16x32_bf16 v[88:91], v[116:119], a[196:199], v[88:91]
    v_cvt_pk_bf16_f32 v33, v98, v99
    v_fma_f32 v104, v104, s28, v13
    v_mul_f32 v241, v241, v49
    v_mfma_f32_16x16x32_bf16 v[88:91], v[120:123], a[200:203], v[88:91]
    v_exp_f32 v100, v100
    v_mfma_f32_16x16x32_bf16 v[96:99], v[112:115], a[216:219], 0
    ds_read_b128 v[132:135], v1 offset:14336
    v_exp_f32 v104, v104
    v_exp_f32 v106, v106
    v_exp_f32 v94, v94
    v_mul_f32 v159, v159, v51
    v_mfma_f32_16x16x32_bf16 v[96:99], v[116:119], a[220:223], v[96:99]
    v_exp_f32 v107, v107
    v_mfma_f32_16x16x32_bf16 v[96:99], v[120:123], a[224:227], v[96:99]
    v_accvgpr_read_b32 v158, a50
    v_cvt_pk_bf16_f32 v39, v106, v107
    v_exp_f32 v78, v78
    v_cvt_pk_bf16_f32 v156, v156, v157
    v_cvt_pk_bf16_f32 v228, v228, v229
    v_pk_mul_f32 v[160:161], v[160:161], v[48:49] op_sel_hi:[1,0]
    v_exp_f32 v110, v110
    v_pk_mul_f32 v[162:163], v[162:163], v[48:49] op_sel_hi:[1,0]
    v_permlane16_swap_b32 v148, v152
    v_cvt_pk_bf16_f32 v38, v104, v105
    v_mfma_f32_16x16x32_bf16 v[104:107], v[112:115], a[240:243], 0
    v_mul_f32 v238, v238, v49
    v_cvt_pk_bf16_f32 v216, v216, v217
    v_cvt_pk_bf16_f32 v220, v220, v221
    v_mfma_f32_16x16x32_bf16 v[104:107], v[116:119], a[244:247], v[104:107]
    v_mul_f32 v239, v239, v49
    v_exp_f32 v111, v111
    v_mfma_f32_16x16x32_bf16 v[104:107], v[120:123], a[248:251], v[104:107]
    s_waitcnt lgkmcnt(0)
    ds_read_b128 v[116:119], v1 offset:18432
    v_cvt_pk_bf16_f32 v212, v212, v213
    v_mfma_f32_16x16x32_bf16 v[72:75], v[124:127], a[156:159], v[72:75]
    v_mul_f32 v249, v249, v49
    v_exp_f32 v79, v79
    v_mfma_f32_16x16x32_bf16 v[72:75], v[128:131], a[160:163], v[72:75]
    s_add_u32 m0, s22, 36864
    ds_read_b128 v[112:115], v0 offset:18432
    v_fma_f32 v108, v108, s28, v13
    v_mfma_f32_16x16x32_bf16 v[72:75], v[132:135], a[164:167], v[72:75]
    buffer_load_dwordx4 v6, s[8:11], s21 offen lds
    v_mfma_f32_16x16x32_bf16 v[80:83], v[124:127], a[180:183], v[80:83]
    v_mul_f32 v218, v218, v49
    v_exp_f32 v101, v101
    v_mfma_f32_16x16x32_bf16 v[80:83], v[128:131], a[184:187], v[80:83]
    v_cvt_pk_bf16_f32 v164, v164, v165
    v_exp_f32 v84, v84
    v_mfma_f32_16x16x32_bf16 v[80:83], v[132:135], a[188:191], v[80:83]
    ds_read_b128 v[120:123], v0 offset:19456
    v_mul_f32 v245, v245, v49
    v_mul_f32 v223, v223, v49
    v_exp_f32 v109, v109
    v_mfma_f32_16x16x32_bf16 v[88:91], v[124:127], a[204:207], v[88:91]
    v_exp_f32 v108, v108
    v_mfma_f32_16x16x32_bf16 v[88:91], v[128:131], a[208:211], v[88:91]
    s_add_u32 s21, s21, 128
    v_exp_f32 v93, v93
    v_cvt_pk_bf16_f32 v160, v160, v161
    v_mfma_f32_16x16x32_bf16 v[88:91], v[132:135], a[212:215], v[88:91]
    s_add_u32 m0, s22, 37888
    v_exp_f32 v92, v92
    v_mfma_f32_16x16x32_bf16 v[96:99], v[124:127], a[228:231], v[96:99]
    v_mul_f32 v255, v255, v49
    v_mul_f32 v158, v158, v51
    v_mfma_f32_16x16x32_bf16 v[96:99], v[128:131], a[232:235], v[96:99]
    v_cvt_pk_bf16_f32 v17, v78, v79
    v_mul_f32 v246, v246, v49
    v_exp_f32 v76, v76
    v_mfma_f32_16x16x32_bf16 v[96:99], v[132:135], a[236:239], v[96:99]
    v_mul_f32 v232, v232, v49
    v_cvt_pk_bf16_f32 v161, v162, v163
    v_cvt_pk_bf16_f32 v22, v84, v85
    v_cvt_pk_bf16_f32 v16, v76, v77
    v_mfma_f32_16x16x32_bf16 v[104:107], v[124:127], a[252:255], v[104:107]
    buffer_load_dwordx4 v6, s[8:11], s21 offen lds
    v_mfma_f32_16x16x32_bf16 v[104:107], v[128:131], v[136:139], v[104:107]
    ds_read_b128 v[124:127], v1 offset:19456
    v_cvt_pk_bf16_f32 v244, v244, v245
    v_cvt_pk_bf16_f32 v209, v210, v211
    v_cvt_pk_bf16_f32 v41, v110, v111
    v_mfma_f32_16x16x32_bf16 v[104:107], v[132:135], v[140:143], v[104:107]
    s_waitcnt lgkmcnt(1)
    v_cvt_pk_bf16_f32 v28, v92, v93
    v_cvt_pk_bf16_f32 v23, v86, v87
    v_exp_f32 v102, v102
    v_mfma_f32_16x16x32_bf16 v[76:79], v[112:115], a[144:147], 0
    ds_read_b128 v[128:131], v0 offset:20480
    v_mul_f32 v234, v234, v49
    v_mfma_f32_16x16x32_bf16 v[44:47], v[52:55], v[14:17], 0
    v_cvt_pk_bf16_f32 v29, v94, v95
    v_mul_f32 v252, v252, v49
    v_fma_f32 v73, v73, s28, v9
    v_mfma_f32_16x16x32_bf16 v[76:79], v[116:119], a[148:151], v[76:79]
    s_add_u32 s21, s21, 128
    v_cvt_pk_bf16_f32 v40, v108, v109
    v_cvt_pk_bf16_f32 v229, v230, v231
    v_mfma_f32_16x16x32_bf16 v[76:79], v[120:123], a[152:155], v[76:79]
    v_fma_f32 v91, v91, s28, v11
    v_cvt_pk_bf16_f32 v35, v102, v103
    v_mfma_f32_16x16x32_bf16 v[84:87], v[112:115], a[168:171], 0
    s_add_u32 m0, s22, 38912
    ds_read_b128 v[132:135], v1 offset:20480
    v_accvgpr_read_b32 v152, a0
    v_cvt_pk_bf16_f32 v157, v158, v159
    v_mfma_f32_16x16x32_bf16 v[84:87], v[116:119], a[172:175], v[84:87]
    buffer_load_dwordx4 v6, s[8:11], s21 offen lds
    v_fma_f32 v106, v106, s28, v13
    v_mfma_f32_16x16x32_bf16 v[84:87], v[120:123], a[176:179], v[84:87]
    ds_write2st64_b64 v149, v[160:161], v[208:209] offset0:0 offset1:12
    v_accvgpr_read_b32 v158, a6
    v_pk_mul_f32 v[154:155], v[154:155], v[50:51] op_sel_hi:[1,0]
    v_pk_mul_f32 v[166:167], v[166:167], v[48:49] op_sel_hi:[1,0]
    v_pk_mul_f32 v[152:153], v[152:153], v[50:51] op_sel_hi:[1,0]
    v_fma_f32 v105, v105, s28, v13
    v_accvgpr_read_b32 v159, a7
    v_mfma_f32_16x16x32_bf16 v[92:95], v[112:115], a[192:195], 0
    v_rcp_f32 v148, v148
    v_mfma_f32_16x16x32_bf16 v[44:47], v[56:59], v[20:23], v[44:47]
    v_subrev_u32 v8, 28672, v8
    v_cvt_pk_bf16_f32 v34, v100, v101
    v_mfma_f32_16x16x32_bf16 v[92:95], v[116:119], a[196:199], v[92:95]
    v_fma_f32 v90, v90, s28, v11
    v_cvt_pk_bf16_f32 v213, v214, v215
    v_mfma_f32_16x16x32_bf16 v[92:95], v[120:123], a[200:203], v[92:95]
    s_add_u32 s21, s21, 12032
    v_cvt_pk_bf16_f32 v152, v152, v153
    v_fma_f32 v98, v98, s28, v12
    v_mfma_f32_16x16x32_bf16 v[100:103], v[112:115], a[216:219], 0
    v_exp_f32 v73, v73
    v_mfma_f32_16x16x32_bf16 v[100:103], v[116:119], a[220:223], v[100:103]
    s_waitcnt vmcnt(6) lgkmcnt(1)
    v_cvt_pk_bf16_f32 v153, v154, v155
    v_accvgpr_read_b32 v154, a98
    v_mfma_f32_16x16x32_bf16 v[100:103], v[120:123], a[224:227], v[100:103]
    s_barrier
    v_mfma_f32_16x16x32_bf16 v[108:111], v[112:115], a[240:243], 0
    s_add_u32 m0, s22, 12288
    ds_write2st64_b64 v149, v[152:153], v[156:157] offset0:24 offset1:36
    v_accvgpr_read_b32 v155, a99
    v_accvgpr_read_b32 v156, a4
    v_mul_f32 v233, v233, v49
    v_accvgpr_read_b32 v157, a5
    v_fma_f32 v82, v82, s28, v10
    v_pk_mul_f32 v[176:177], v[176:177], v[48:49] op_sel_hi:[1,0]
    v_accvgpr_read_b32 v153, a97
    v_pk_mul_f32 v[168:169], v[168:169], v[48:49] op_sel_hi:[1,0]
    v_cvt_pk_bf16_f32 v165, v166, v167
    v_accvgpr_read_b32 v152, a96
    v_pk_mul_f32 v[154:155], v[154:155], v[148:149] op_sel_hi:[1,0]
    v_cvt_pk_bf16_f32 v252, v252, v253
    v_pk_mul_f32 v[156:157], v[156:157], v[50:51] op_sel_hi:[1,0]
    v_pk_mul_f32 v[196:197], v[196:197], v[48:49] op_sel_hi:[1,0]
    v_mul_f32 v227, v227, v49
    v_pk_mul_f32 v[158:159], v[158:159], v[50:51] op_sel_hi:[1,0]
    v_fma_f32 v81, v81, s28, v10
    v_pk_mul_f32 v[152:153], v[152:153], v[148:149] op_sel_hi:[1,0]
    v_fma_f32 v74, v74, s28, v9
    v_fma_f32 v83, v83, s28, v10
    v_mfma_f32_16x16x32_bf16 v[108:111], v[116:119], a[244:247], v[108:111]
    v_cvt_pk_bf16_f32 v152, v152, v153
    v_cvt_pk_bf16_f32 v153, v154, v155
    v_mfma_f32_16x16x32_bf16 v[108:111], v[120:123], a[248:251], v[108:111]
    ds_read_b64_tr_b16 v[112:113], v2 offset:0
    v_cvt_pk_bf16_f32 v168, v168, v169
    v_mfma_f32_16x16x32_bf16 v[76:79], v[124:127], a[156:159], v[76:79]
    v_accvgpr_read_b32 v155, a55
    v_cvt_pk_bf16_f32 v156, v156, v157
    v_fma_f32 v104, v104, s28, v13
    v_mfma_f32_16x16x32_bf16 v[76:79], v[128:131], a[160:163], v[76:79]
    ds_read_b64_tr_b16 v[114:115], v2 offset:6144
    v_mul_f32 v222, v222, v49
    v_mfma_f32_16x16x32_bf16 v[76:79], v[132:135], a[164:167], v[76:79]
    ds_read_b64_tr_b16 v[116:117], v3 offset:0
    v_cvt_pk_bf16_f32 v157, v158, v159
    v_mfma_f32_16x16x32_bf16 v[44:47], v[60:63], v[26:29], v[44:47]
    v_exp_f32 v106, v106
    v_mfma_f32_16x16x32_bf16 v[84:87], v[124:127], a[180:183], v[84:87]
    ds_read_b64_tr_b16 v[118:119], v3 offset:6144
    v_mul_f32 v226, v226, v49
    v_cvt_pk_bf16_f32 v217, v218, v219
    v_mfma_f32_16x16x32_bf16 v[84:87], v[128:131], a[184:187], v[84:87]
    ds_write_b64 v149, v[152:153] offset:24576
    v_mfma_f32_16x16x32_bf16 v[84:87], v[132:135], a[188:191], v[84:87]
    buffer_load_dwordx4 v6, s[4:7], s20 offen lds
    v_accvgpr_read_b32 v154, a54
    v_mfma_f32_16x16x32_bf16 v[92:95], v[124:127], a[204:207], v[92:95]
    v_accvgpr_read_b32 v152, a52
    v_exp_f32 v82, v82
    v_mfma_f32_16x16x32_bf16 v[92:95], v[128:131], a[208:211], v[92:95]
    v_accvgpr_read_b32 v153, a53
    v_xor_b32 v149, 32, v149
    v_cvt_pk_bf16_f32 v196, v196, v197
    v_mfma_f32_16x16x32_bf16 v[92:95], v[132:135], a[212:215], v[92:95]
    v_mul_f32 v152, v152, v51
    v_exp_f32 v81, v81
    v_mfma_f32_16x16x32_bf16 v[100:103], v[124:127], a[228:231], v[100:103]
    v_mul_f32 v153, v153, v51
    v_mul_f32 v236, v236, v49
    v_fma_f32 v96, v96, s28, v12
    v_mfma_f32_16x16x32_bf16 v[100:103], v[128:131], a[232:235], v[100:103]
    s_add_u32 s20, s20, 128
    v_fma_f32 v99, v99, s28, v12
    v_cvt_pk_bf16_f32 v152, v152, v153
    v_mfma_f32_16x16x32_bf16 v[100:103], v[132:135], a[236:239], v[100:103]
    ds_write2st64_b64 v149, v[164:165], v[212:213] offset0:0 offset1:12
    v_mul_f32 v155, v155, v51
    v_mfma_f32_16x16x32_bf16 v[108:111], v[124:127], a[252:255], v[108:111]
    v_mul_f32 v154, v154, v51
    v_fma_f32 v97, v97, s28, v12
    v_mfma_f32_16x16x32_bf16 v[108:111], v[128:131], v[136:139], v[108:111]
    v_fma_f32 v92, v92, s28, v11
    v_cvt_pk_bf16_f32 v153, v154, v155
    v_mfma_f32_16x16x32_bf16 v[108:111], v[132:135], v[140:143], v[108:111]
    s_waitcnt lgkmcnt(1)
    v_accvgpr_read_b32 v158, a102
    v_mul_f32 v242, v242, v49
    v_mfma_f32_16x16x32_bf16 v[160:163], v[112:115], v[14:17], 0
    ds_read_b64_tr_b16 v[132:133], v3 offset:1024
    v_fma_f32 v79, v79, s28, v9
    v_mfma_f32_16x16x32_bf16 v[208:211], v[112:115], v[20:23], 0
    ds_read_b64_tr_b16 v[120:121], v4 offset:0
    v_accvgpr_read_b32 v159, a103
    v_mfma_f32_16x16x32_bf16 a[0:3], v[112:115], v[26:29], 0
    ds_write2st64_b64 v149, v[156:157], v[152:153] offset0:24 offset1:36
    v_mul_f32 v247, v247, v49
    v_accvgpr_read_b32 v157, a101
    v_mfma_f32_16x16x32_bf16 a[48:51], v[112:115], v[32:35], 0
    v_accvgpr_read_b32 v154, a10
    v_fma_f32 v78, v78, s28, v9
    v_mfma_f32_16x16x32_bf16 a[96:99], v[112:115], v[38:41], 0
    ds_read_b64_tr_b16 v[122:123], v4 offset:6144
    v_accvgpr_read_b32 v155, a11
    v_mfma_f32_16x16x32_bf16 v[164:167], v[116:119], v[14:17], 0
    ds_read_b64_tr_b16 v[124:125], v5 offset:0
    v_accvgpr_read_b32 v153, a9
    v_mfma_f32_16x16x32_bf16 v[44:47], v[64:67], v[32:35], v[44:47]
    ds_read_b64_tr_b16 v[130:131], v2 offset:7168
    v_accvgpr_read_b32 v156, a100
    v_exp_f32 v83, v83
    v_exp_f32 v97, v97
    v_cvt_pk_bf16_f32 v245, v246, v247
    v_pk_mul_f32 v[202:203], v[202:203], v[48:49] op_sel_hi:[1,0]
    v_cvt_pk_bf16_f32 v224, v224, v225
    v_pk_mul_f32 v[190:191], v[190:191], v[48:49] op_sel_hi:[1,0]
    v_accvgpr_read_b32 v152, a8
    v_pk_mul_f32 v[156:157], v[156:157], v[148:149] op_sel_hi:[1,0]
    v_pk_mul_f32 v[194:195], v[194:195], v[48:49] op_sel_hi:[1,0]
    v_pk_mul_f32 v[152:153], v[152:153], v[50:51] op_sel_hi:[1,0]
    v_fma_f32 v102, v102, s28, v12
    v_pk_mul_f32 v[172:173], v[172:173], v[48:49] op_sel_hi:[1,0]
    v_exp_f32 v91, v91
    v_pk_mul_f32 v[158:159], v[158:159], v[148:149] op_sel_hi:[1,0]
    v_pk_mul_f32 v[170:171], v[170:171], v[48:49] op_sel_hi:[1,0]
    v_cvt_pk_bf16_f32 v152, v152, v153
    v_cvt_pk_bf16_f32 v156, v156, v157
    v_exp_f32 v90, v90
    v_cvt_pk_bf16_f32 v169, v170, v171
    v_cvt_pk_bf16_f32 v157, v158, v159
    v_pk_mul_f32 v[154:155], v[154:155], v[50:51] op_sel_hi:[1,0]
    v_accvgpr_read_b32 v159, a59
    v_cvt_pk_bf16_f32 v172, v172, v173
    v_mfma_f32_16x16x32_bf16 v[212:215], v[116:119], v[20:23], 0
    ds_write_b64 v149, v[156:157] offset:24576
    v_fma_f32 v88, v88, s28, v11
    v_exp_f32 v78, v78
    v_accvgpr_read_b32 v158, a58
    v_pk_mul_f32 v[186:187], v[186:187], v[48:49] op_sel_hi:[1,0]
    v_accvgpr_read_b32 v156, a56
    v_fma_f32 v75, v75, s28, v9
    v_fma_f32 v80, v80, s28, v10
    v_accvgpr_read_b32 v157, a57
    v_xor_b32 v149, 96, v149
    v_mul_f32 v156, v156, v51
    v_pk_mul_f32 v[174:175], v[174:175], v[48:49] op_sel_hi:[1,0]
    v_mul_f32 v157, v157, v51
    v_pk_mul_f32 v[192:193], v[192:193], v[48:49] op_sel_hi:[1,0]
    v_pk_mul_f32 v[200:201], v[200:201], v[48:49] op_sel_hi:[1,0]
    v_cvt_pk_bf16_f32 v232, v232, v233
    v_cvt_pk_bf16_f32 v31, v90, v91
    v_mfma_f32_16x16x32_bf16 a[4:7], v[116:119], v[26:29], 0
    s_add_u32 m0, s22, 13312
    ds_write2st64_b64 v149, v[168:169], v[216:217] offset0:0 offset1:12
    v_pk_mul_f32 v[178:179], v[178:179], v[48:49] op_sel_hi:[1,0]
    v_exp_f32 v99, v99
    v_mul_f32 v243, v243, v49
    v_mul_f32 v159, v159, v51
    v_pk_mul_f32 v[198:199], v[198:199], v[48:49] op_sel_hi:[1,0]
    v_cvt_pk_bf16_f32 v153, v154, v155
    v_cvt_pk_bf16_f32 v156, v156, v157
    v_mfma_f32_16x16x32_bf16 a[52:55], v[116:119], v[32:35], 0
    ds_read_b64_tr_b16 v[112:113], v4 offset:1024
    v_mul_f32 v158, v158, v51
    v_fma_f32 v109, v109, s28, v13
    v_cvt_pk_bf16_f32 v221, v222, v223
    v_exp_f32 v98, v98
    v_fma_f32 v76, v76, s28, v9
    v_cvt_pk_bf16_f32 v157, v158, v159
    v_mfma_f32_16x16x32_bf16 a[100:103], v[116:119], v[38:41], 0
    s_waitcnt lgkmcnt(2)
    ds_write2st64_b64 v149, v[152:153], v[156:157] offset0:24 offset1:36
    v_accvgpr_read_b32 v153, a105
    v_mfma_f32_16x16x32_bf16 v[168:171], v[120:123], v[14:17], 0
    buffer_load_dwordx4 v6, s[4:7], s20 offen lds
    ds_read_b64_tr_b16 v[126:127], v5 offset:6144
    v_mul_f32 v237, v237, v49
    v_exp_f32 v80, v80
    v_accvgpr_read_b32 v154, a106
    v_cvt_pk_bf16_f32 v173, v174, v175
    v_mfma_f32_16x16x32_bf16 v[216:219], v[120:123], v[20:23], 0
    s_add_u32 s20, s20, 128
    ds_read_b64_tr_b16 v[134:135], v3 offset:7168
    v_accvgpr_read_b32 v155, a107
    v_accvgpr_read_b32 v158, a14
    v_accvgpr_read_b32 v156, a12
    v_accvgpr_read_b32 v152, a104
    v_accvgpr_read_b32 v157, a13
    v_pk_mul_f32 v[180:181], v[180:181], v[48:49] op_sel_hi:[1,0]
    v_pk_mul_f32 v[156:157], v[156:157], v[50:51] op_sel_hi:[1,0]
    v_pk_mul_f32 v[152:153], v[152:153], v[148:149] op_sel_hi:[1,0]
    v_pk_mul_f32 v[154:155], v[154:155], v[148:149] op_sel_hi:[1,0]
    v_cvt_pk_bf16_f32 v236, v236, v237
    v_cvt_pk_bf16_f32 v152, v152, v153
    v_cvt_pk_bf16_f32 v153, v154, v155
    v_mfma_f32_16x16x32_bf16 a[8:11], v[120:123], v[26:29], 0
    ds_write_b64 v149, v[152:153] offset:24576
    v_mfma_f32_16x16x32_bf16 a[56:59], v[120:123], v[32:35], 0
    ds_read_b64_tr_b16 v[128:129], v2 offset:1024
    v_accvgpr_read_b32 v155, a63
    v_accvgpr_read_b32 v152, a60
    v_accvgpr_read_b32 v159, a15
    v_mfma_f32_16x16x32_bf16 v[44:47], v[68:71], v[38:41], v[44:47]
    s_add_u32 m0, s22, 14336
    v_fma_f32 v108, v108, s28, v13
    v_cvt_pk_bf16_f32 v156, v156, v157
    v_accvgpr_read_b32 v154, a62
    v_accvgpr_read_b32 v153, a61
    v_fma_f32 v85, v85, s28, v10
    v_mul_f32 v154, v154, v51
    v_mul_f32 v153, v153, v51
    v_pk_mul_f32 v[158:159], v[158:159], v[50:51] op_sel_hi:[1,0]
    v_mul_f32 v152, v152, v51
    v_cvt_pk_bf16_f32 v176, v176, v177
    v_xor_b32 v149, 32, v149
    v_mfma_f32_16x16x32_bf16 a[104:107], v[120:123], v[38:41], 0
    s_waitcnt lgkmcnt(2)
    ds_write2st64_b64 v149, v[172:173], v[220:221] offset0:0 offset1:12
    v_mfma_f32_16x16x32_bf16 v[172:175], v[124:127], v[14:17], 0
    v_cvt_pk_bf16_f32 v233, v234, v235
    v_cvt_pk_bf16_f32 v152, v152, v153
    v_cvt_pk_bf16_f32 v25, v82, v83
    v_mul_f32 v155, v155, v51
    v_cvt_pk_bf16_f32 v157, v158, v159
    v_cvt_pk_bf16_f32 v153, v154, v155
    v_accvgpr_read_b32 v158, a110
    v_mfma_f32_16x16x32_bf16 v[220:223], v[124:127], v[20:23], 0
    ds_read_b128 v[144:147], v8 offset:0
    v_accvgpr_read_b32 v159, a111
    v_accvgpr_read_b32 v155, a19
    v_mfma_f32_16x16x32_bf16 a[12:15], v[124:127], v[26:29], 0
    ds_write2st64_b64 v149, v[156:157], v[152:153] offset0:24 offset1:36
    v_exp_f32 v88, v88
    v_accvgpr_read_b32 v157, a109
    v_accvgpr_read_b32 v156, a108
    v_pk_mul_f32 v[156:157], v[156:157], v[148:149] op_sel_hi:[1,0]
    v_accvgpr_read_b32 v154, a18
    v_cvt_pk_bf16_f32 v156, v156, v157
    v_pk_mul_f32 v[158:159], v[158:159], v[148:149] op_sel_hi:[1,0]
    v_fma_f32 v77, v77, s28, v9
    v_cvt_pk_bf16_f32 v157, v158, v159
    v_cvt_pk_bf16_f32 v225, v226, v227
    v_accvgpr_read_b32 v158, a66
    v_cvt_pk_bf16_f32 v180, v180, v181
    v_pk_mul_f32 v[188:189], v[188:189], v[48:49] op_sel_hi:[1,0]
    v_pk_mul_f32 v[184:185], v[184:185], v[48:49] op_sel_hi:[1,0]
    v_accvgpr_read_b32 v153, a17
    v_accvgpr_read_b32 v159, a67
    v_exp_f32 v75, v75
    v_accvgpr_read_b32 v152, a16
    v_mfma_f32_16x16x32_bf16 a[60:63], v[124:127], v[32:35], 0
    ds_write_b64 v149, v[156:157] offset:24576
    v_accvgpr_read_b32 v157, a65
    v_mul_f32 v157, v157, v51
    v_accvgpr_read_b32 v156, a64
    v_mul_f32 v156, v156, v51
    v_pk_mul_f32 v[152:153], v[152:153], v[50:51] op_sel_hi:[1,0]
    v_pk_mul_f32 v[182:183], v[182:183], v[48:49] op_sel_hi:[1,0]
    v_cvt_pk_bf16_f32 v188, v188, v189
    v_cvt_pk_bf16_f32 v152, v152, v153
    v_pk_mul_f32 v[154:155], v[154:155], v[50:51] op_sel_hi:[1,0]
    v_cvt_pk_bf16_f32 v156, v156, v157
    v_mul_f32 v158, v158, v51
    v_mul_f32 v159, v159, v51
    v_xor_b32 v149, 96, v149
    v_cvt_pk_bf16_f32 v177, v178, v179
    v_cvt_pk_bf16_f32 v153, v154, v155
    v_cvt_pk_bf16_f32 v157, v158, v159
    v_accvgpr_read_b32 v155, a115
    v_cvt_pk_bf16_f32 v184, v184, v185
    v_cvt_pk_bf16_f32 v185, v186, v187
    v_mfma_f32_16x16x32_bf16 a[108:111], v[124:127], v[38:41], 0
    s_waitcnt lgkmcnt(1)
    ds_write2st64_b64 v149, v[176:177], v[224:225] offset0:4 offset1:16
    v_mfma_f32_16x16x32_bf16 v[176:179], v[128:131], v[14:17], 0
    ds_write2st64_b64 v149, v[152:153], v[156:157] offset0:28 offset1:40
    v_accvgpr_read_b32 v154, a114
    v_accvgpr_read_b32 v159, a23
    v_accvgpr_read_b32 v152, a112
    v_accvgpr_read_b32 v158, a22
    v_accvgpr_read_b32 v153, a113
    v_pk_mul_f32 v[158:159], v[158:159], v[50:51] op_sel_hi:[1,0]
    v_pk_mul_f32 v[206:207], v[206:207], v[48:49] op_sel_hi:[1,0]
    v_pk_mul_f32 v[204:205], v[204:205], v[48:49] op_sel_hi:[1,0]
    v_pk_mul_f32 v[154:155], v[154:155], v[148:149] op_sel_hi:[1,0]
    v_pk_mul_f32 v[152:153], v[152:153], v[148:149] op_sel_hi:[1,0]
    v_cvt_pk_bf16_f32 v181, v182, v183
    v_cvt_pk_bf16_f32 v152, v152, v153
    v_cvt_pk_bf16_f32 v153, v154, v155
    v_mfma_f32_16x16x32_bf16 v[224:227], v[128:131], v[20:23], 0
    ds_write_b64 v149, v[152:153] offset:26624
    v_accvgpr_read_b32 v156, a20
    v_accvgpr_read_b32 v153, a69
    v_mul_f32 v153, v153, v51
    v_accvgpr_read_b32 v152, a68
    v_accvgpr_read_b32 v157, a21
    v_accvgpr_read_b32 v155, a71
    v_pk_mul_f32 v[156:157], v[156:157], v[50:51] op_sel_hi:[1,0]
    v_xor_b32 v149, 32, v149
    v_mul_f32 v155, v155, v51
    v_mul_f32 v152, v152, v51
    v_mfma_f32_16x16x32_bf16 a[16:19], v[128:131], v[26:29], 0
    ds_write2st64_b64 v149, v[180:181], v[228:229] offset0:4 offset1:16
    v_cvt_pk_bf16_f32 v152, v152, v153
    v_accvgpr_read_b32 v154, a70
    v_mul_f32 v154, v154, v51
    v_cvt_pk_bf16_f32 v156, v156, v157
    v_mfma_f32_16x16x32_bf16 a[64:67], v[128:131], v[32:35], 0
    buffer_store_dwordx4 v[144:147], v6, s[16:19], s67 offen sc0 sc1 nt
    ds_read_b64_tr_b16 v[114:115], v4 offset:7168
    ds_read_b64_tr_b16 v[116:117], v5 offset:1024
    v_exp_f32 v74, v74
    v_cvt_pk_bf16_f32 v153, v154, v155
    v_cvt_pk_bf16_f32 v157, v158, v159
    v_mfma_f32_16x16x32_bf16 a[112:115], v[128:131], v[38:41], 0
    ds_write2st64_b64 v149, v[156:157], v[152:153] offset0:28 offset1:40
    v_mfma_f32_16x16x32_bf16 v[180:183], v[132:135], v[14:17], 0
    buffer_load_dwordx4 v6, s[4:7], s20 offen lds
    ds_read_b64_tr_b16 v[118:119], v5 offset:7168
    ds_read_b64_tr_b16 v[122:123], v2 offset:8192
    v_accvgpr_read_b32 v158, a118
    v_accvgpr_read_b32 v159, a119
    v_accvgpr_read_b32 v156, a116
    v_mfma_f32_16x16x32_bf16 v[228:231], v[132:135], v[20:23], 0
    ds_read_b64_tr_b16 v[124:125], v3 offset:2048
    ds_read_b64_tr_b16 v[128:129], v4 offset:2048
    v_fma_f32 v87, v87, s28, v10
    v_fma_f32 v84, v84, s28, v10
    v_exp_f32 v96, v96
    v_accvgpr_read_b32 v155, a27
    v_mul_f32 v254, v254, v49
    v_mul_f32 v240, v240, v49
    v_mfma_f32_16x16x32_bf16 a[20:23], v[132:135], v[26:29], 0
    ds_read_b128 v[144:147], v8 offset:1024
    v_mul_f32 v248, v248, v49
    v_accvgpr_read_b32 v153, a25
    v_cvt_pk_bf16_f32 v240, v240, v241
    v_accvgpr_read_b32 v157, a117
    v_cvt_pk_bf16_f32 v189, v190, v191
    v_cvt_pk_bf16_f32 v241, v242, v243
    v_fma_f32 v107, v107, s28, v13
    v_pk_mul_f32 v[156:157], v[156:157], v[148:149] op_sel_hi:[1,0]
    v_pk_mul_f32 v[158:159], v[158:159], v[148:149] op_sel_hi:[1,0]
    v_fma_f32 v93, v93, s28, v11
    v_cvt_pk_bf16_f32 v156, v156, v157
    v_cvt_pk_bf16_f32 v157, v158, v159
    v_mfma_f32_16x16x32_bf16 a[68:71], v[132:135], v[32:35], 0
    ds_write_b64 v149, v[156:157] offset:26624
    v_fma_f32 v89, v89, s28, v11
    v_cvt_pk_bf16_f32 v204, v204, v205
    v_cvt_pk_bf16_f32 v192, v192, v193
    v_accvgpr_read_b32 v152, a24
    v_accvgpr_read_b32 v154, a26
    v_accvgpr_read_b32 v159, a75
    v_pk_mul_f32 v[154:155], v[154:155], v[50:51] op_sel_hi:[1,0]
    v_accvgpr_read_b32 v156, a72
    v_accvgpr_read_b32 v158, a74
    v_cvt_pk_bf16_f32 v248, v248, v249
    v_cvt_pk_bf16_f32 v237, v238, v239
    v_mul_f32 v156, v156, v51
    v_mul_f32 v159, v159, v51
    v_pk_mul_f32 v[152:153], v[152:153], v[50:51] op_sel_hi:[1,0]
    v_xor_b32 v149, 96, v149
    v_mul_f32 v158, v158, v51
    v_accvgpr_read_b32 v157, a73
    v_mul_f32 v157, v157, v51
    v_exp_f32 v84, v84
    v_cvt_pk_bf16_f32 v156, v156, v157
    v_cvt_pk_bf16_f32 v157, v158, v159
    v_cvt_pk_bf16_f32 v152, v152, v153
    v_cvt_pk_bf16_f32 v153, v154, v155
    v_mfma_f32_16x16x32_bf16 a[116:119], v[132:135], v[38:41], 0
    s_waitcnt lgkmcnt(1)
    ds_write2st64_b64 v149, v[184:185], v[232:233] offset0:4 offset1:16
    v_accvgpr_read_b32 v154, a122
    v_accvgpr_read_b32 v155, a123
    v_mfma_f32_16x16x32_bf16 v[184:187], v[112:115], v[14:17], 0
    ds_write2st64_b64 v149, v[152:153], v[156:157] offset0:28 offset1:40
    v_accvgpr_read_b32 v153, a121
    v_accvgpr_read_b32 v152, a120
    v_accvgpr_read_b32 v159, a31
    v_accvgpr_read_b32 v158, a30
    v_pk_mul_f32 v[152:153], v[152:153], v[148:149] op_sel_hi:[1,0]
    v_pk_mul_f32 v[154:155], v[154:155], v[148:149] op_sel_hi:[1,0]
    v_cvt_pk_bf16_f32 v152, v152, v153
    v_exp_f32 v107, v107
    v_cvt_pk_bf16_f32 v153, v154, v155
    v_mfma_f32_16x16x32_bf16 v[232:235], v[112:115], v[20:23], 0
    ds_write_b64 v149, v[152:153] offset:26624
    ds_read_b64_tr_b16 v[130:131], v4 offset:8192
    v_accvgpr_read_b32 v153, a77
    v_mfma_f32_16x16x32_bf16 a[24:27], v[112:115], v[26:29], 0
    s_add_u32 s20, s20, 12032
    ds_read_b64_tr_b16 v[126:127], v3 offset:8192
    ds_read_b64_tr_b16 v[120:121], v2 offset:2048
    v_mfma_f32_16x16x32_bf16 a[72:75], v[112:115], v[32:35], 0
    ds_read_b64_tr_b16 v[134:135], v5 offset:8192
    ds_read_b64_tr_b16 v[132:133], v5 offset:2048
    v_accvgpr_read_b32 v155, a79
    v_accvgpr_read_b32 v152, a76
    v_accvgpr_read_b32 v156, a28
    v_accvgpr_read_b32 v157, a29
    v_mul_f32 v153, v153, v51
    v_accvgpr_read_b32 v154, a78
    v_cvt_pk_bf16_f32 v193, v194, v195
    v_mul_f32 v250, v250, v49
    v_mul_f32 v155, v155, v51
    v_pk_mul_f32 v[156:157], v[156:157], v[50:51] op_sel_hi:[1,0]
    v_fma_f32 v94, v94, s28, v11
    v_mul_f32 v154, v154, v51
    v_pk_mul_f32 v[158:159], v[158:159], v[50:51] op_sel_hi:[1,0]
    v_cvt_pk_bf16_f32 v156, v156, v157
    v_xor_b32 v149, 32, v149
    v_mfma_f32_16x16x32_bf16 a[120:123], v[112:115], v[38:41], 0
    ds_write2st64_b64 v149, v[188:189], v[236:237] offset0:4 offset1:16
    v_mul_f32 v152, v152, v51
    v_cvt_pk_bf16_f32 v152, v152, v153
    v_cvt_pk_bf16_f32 v153, v154, v155
    v_cvt_pk_bf16_f32 v157, v158, v159
    v_accvgpr_read_b32 v159, a127
    v_mfma_f32_16x16x32_bf16 v[188:191], v[116:119], v[14:17], 0
    s_add_u32 s39, s39, 12288
    ds_write2st64_b64 v149, v[156:157], v[152:153] offset0:28 offset1:40
    v_accvgpr_read_b32 v156, a124
    v_accvgpr_read_b32 v157, a125
    v_accvgpr_read_b32 v152, a32
    v_mfma_f32_16x16x32_bf16 v[236:239], v[116:119], v[20:23], 0
    s_waitcnt vmcnt(7) lgkmcnt(2)
    v_fma_f32 v72, v72, s28, v9
    v_accvgpr_read_b32 v155, a35
    v_mfma_f32_16x16x32_bf16 a[28:31], v[116:119], v[26:29], 0
    buffer_store_dwordx4 v[144:147], v7, s[16:19], s67 offen sc0 sc1 nt
    s_barrier
    v_pk_mul_f32 v[156:157], v[156:157], v[148:149] op_sel_hi:[1,0]
    v_accvgpr_read_b32 v153, a33
    v_cvt_pk_bf16_f32 v249, v250, v251
    v_accvgpr_read_b32 v158, a126
    v_pk_mul_f32 v[158:159], v[158:159], v[148:149] op_sel_hi:[1,0]
    v_accvgpr_read_b32 v154, a34
    v_cvt_pk_bf16_f32 v156, v156, v157
    v_pk_mul_f32 v[152:153], v[152:153], v[50:51] op_sel_hi:[1,0]
    v_exp_f32 v72, v72
    v_cvt_pk_bf16_f32 v197, v198, v199
    v_cvt_pk_bf16_f32 v24, v80, v81
    v_cvt_pk_bf16_f32 v152, v152, v153
    v_fma_f32 v100, v100, s28, v12
    v_exp_f32 v89, v89
    v_cvt_pk_bf16_f32 v157, v158, v159
    v_fma_f32 v95, v95, s28, v11
    v_cvt_pk_bf16_f32 v205, v206, v207
    v_mfma_f32_16x16x32_bf16 a[76:79], v[116:119], v[32:35], 0
    s_add_u32 m0, s22, 24576
    ds_write_b64 v149, v[156:157] offset:26624
    v_accvgpr_read_b32 v156, a80
    v_accvgpr_read_b32 v159, a83
    v_accvgpr_read_b32 v157, a81
    v_pk_mul_f32 v[154:155], v[154:155], v[50:51] op_sel_hi:[1,0]
    v_mul_f32 v159, v159, v51
    v_xor_b32 v149, 96, v149
    v_mfma_f32_16x16x32_bf16 a[124:127], v[116:119], v[38:41], 0
    buffer_load_dwordx4 v6, s[8:11], s21 offen lds
    ds_write2st64_b64 v149, v[192:193], v[240:241] offset0:8 offset1:20
    v_mul_f32 v156, v156, v51
    v_mfma_f32_16x16x32_bf16 v[192:195], v[120:123], v[14:17], 0
    ds_read_b128 v[144:147], v8 offset:2048
    v_accvgpr_read_b32 v158, a82
    v_mul_f32 v157, v157, v51
    v_cvt_pk_bf16_f32 v153, v154, v155
    v_cvt_pk_bf16_f32 v200, v200, v201
    v_mul_f32 v158, v158, v51
    v_accvgpr_read_b32 v155, a131
    v_mfma_f32_16x16x32_bf16 v[240:243], v[120:123], v[20:23], 0
    s_add_u32 s21, s21, 128
    ds_read_b128 v[112:115], v0 offset:0
    v_cvt_pk_bf16_f32 v201, v202, v203
    v_cvt_pk_bf16_f32 v156, v156, v157
    v_cvt_pk_bf16_f32 v157, v158, v159
    v_accvgpr_read_b32 v159, a39
    v_mfma_f32_16x16x32_bf16 a[32:35], v[120:123], v[26:29], 0
    s_add_u32 m0, s22, 25600
    ds_write2st64_b64 v149, v[152:153], v[156:157] offset0:32 offset1:44
    v_accvgpr_read_b32 v156, a36
    v_accvgpr_read_b32 v152, a128
    v_accvgpr_read_b32 v157, a37
    v_accvgpr_read_b32 v153, a129
    v_accvgpr_read_b32 v154, a130
    v_pk_mul_f32 v[154:155], v[154:155], v[148:149] op_sel_hi:[1,0]
    v_accvgpr_read_b32 v158, a38
    v_pk_mul_f32 v[152:153], v[152:153], v[148:149] op_sel_hi:[1,0]
    v_pk_mul_f32 v[156:157], v[156:157], v[50:51] op_sel_hi:[1,0]
    v_cvt_pk_bf16_f32 v152, v152, v153
    v_cvt_pk_bf16_f32 v37, v98, v99
    v_cvt_pk_bf16_f32 v30, v88, v89
    v_cvt_pk_bf16_f32 v153, v154, v155
    v_mfma_f32_16x16x32_bf16 a[80:83], v[120:123], v[32:35], 0
    buffer_load_dwordx4 v6, s[8:11], s21 offen lds
    ds_write_b64 v149, v[152:153] offset:0
    v_cvt_pk_bf16_f32 v156, v156, v157
    v_exp_f32 v87, v87
    v_accvgpr_read_b32 v154, a86
    v_accvgpr_read_b32 v155, a87
    v_exp_f32 v76, v76
    v_accvgpr_read_b32 v152, a84
    v_pk_mul_f32 v[158:159], v[158:159], v[50:51] op_sel_hi:[1,0]
    v_accvgpr_read_b32 v153, a85
    v_xor_b32 v149, 32, v149
    v_mul_f32 v152, v152, v51
    v_mul_f32 v155, v155, v51
    v_mul_f32 v154, v154, v51
    v_mul_f32 v153, v153, v51
    v_cvt_pk_bf16_f32 v157, v158, v159
    v_fma_f32 v110, v110, s28, v13
    v_mfma_f32_16x16x32_bf16 a[128:131], v[120:123], v[38:41], 0
    ds_write2st64_b64 v149, v[196:197], v[244:245] offset0:8 offset1:20
    v_cvt_pk_bf16_f32 v152, v152, v153
    v_cvt_pk_bf16_f32 v153, v154, v155
    v_mfma_f32_16x16x32_bf16 v[196:199], v[124:127], v[14:17], 0
    s_add_u32 s21, s21, 128
    ds_write2st64_b64 v149, v[156:157], v[152:153] offset0:32 offset1:44
    v_accvgpr_read_b32 v154, a42
    v_accvgpr_read_b32 v159, a135
    v_accvgpr_read_b32 v157, a133
    v_exp_f32 v105, v105
    v_accvgpr_read_b32 v152, a40
    v_accvgpr_read_b32 v153, a41
    v_accvgpr_read_b32 v156, a132
    v_pk_mul_f32 v[156:157], v[156:157], v[148:149] op_sel_hi:[1,0]
    v_accvgpr_read_b32 v158, a134
    v_pk_mul_f32 v[158:159], v[158:159], v[148:149] op_sel_hi:[1,0]
    v_accvgpr_read_b32 v155, a43
    v_pk_mul_f32 v[152:153], v[152:153], v[50:51] op_sel_hi:[1,0]
    v_cvt_pk_bf16_f32 v156, v156, v157
    v_cvt_pk_bf16_f32 v157, v158, v159
    v_mfma_f32_16x16x32_bf16 v[244:247], v[124:127], v[20:23], 0
    ds_write_b64 v149, v[156:157] offset:0
    v_fma_f32 v103, v103, s28, v12
    v_accvgpr_read_b32 v159, a91
    v_accvgpr_read_b32 v157, a89
    v_accvgpr_read_b32 v156, a88
    v_accvgpr_read_b32 v158, a90
    v_exp_f32 v79, v79
    v_mfma_f32_16x16x32_bf16 a[36:39], v[124:127], v[26:29], 0
    ds_read_b128 v[116:119], v1 offset:0
    v_fma_f32 v86, v86, s28, v10
    v_cvt_pk_bf16_f32 v152, v152, v153
    v_cvt_pk_bf16_f32 v19, v74, v75
    v_mul_f32 v156, v156, v51
    v_pk_mul_f32 v[154:155], v[154:155], v[50:51] op_sel_hi:[1,0]
    v_mul_f32 v157, v157, v51
    v_xor_b32 v149, 96, v149
    v_cvt_pk_bf16_f32 v156, v156, v157
    v_mul_f32 v159, v159, v51
    v_mfma_f32_16x16x32_bf16 a[84:87], v[124:127], v[32:35], 0
    ds_write2st64_b64 v149, v[200:201], v[248:249] offset0:8 offset1:20
    v_mfma_f32_16x16x32_bf16 a[132:135], v[124:127], v[38:41], 0
    v_mul_f32 v158, v158, v51
    v_cvt_pk_bf16_f32 v157, v158, v159
    v_cvt_pk_bf16_f32 v153, v154, v155
    v_mfma_f32_16x16x32_bf16 v[200:203], v[128:131], v[14:17], 0
    ds_write2st64_b64 v149, v[152:153], v[156:157] offset0:32 offset1:44
    v_accvgpr_read_b32 v155, a139
    v_mfma_f32_16x16x32_bf16 v[248:251], v[128:131], v[20:23], 0
    ds_read_b128 v[120:123], v0 offset:1024
    v_accvgpr_read_b32 v159, a47
    v_mfma_f32_16x16x32_bf16 a[40:43], v[128:131], v[26:29], 0
    v_accvgpr_read_b32 v154, a138
    v_accvgpr_read_b32 v153, a137
    v_accvgpr_read_b32 v152, a136
    v_accvgpr_read_b32 v158, a46
    v_accvgpr_read_b32 v157, a45
    v_pk_mul_f32 v[152:153], v[152:153], v[148:149] op_sel_hi:[1,0]
    v_pk_mul_f32 v[154:155], v[154:155], v[148:149] op_sel_hi:[1,0]
    v_accvgpr_read_b32 v156, a44
    v_pk_mul_f32 v[156:157], v[156:157], v[50:51] op_sel_hi:[1,0]
    v_cvt_pk_bf16_f32 v152, v152, v153
    v_cvt_pk_bf16_f32 v153, v154, v155
    v_mfma_f32_16x16x32_bf16 a[88:91], v[128:131], v[32:35], 0
    ds_write_b64 v149, v[152:153] offset:0
    v_accvgpr_read_b32 v153, a93
    v_xor_b32 v149, 32, v149
    v_accvgpr_read_b32 v152, a92
    v_pk_mul_f32 v[158:159], v[158:159], v[50:51] op_sel_hi:[1,0]
    v_cvt_pk_bf16_f32 v253, v254, v255
    v_mul_f32 v153, v153, v51
    v_accvgpr_read_b32 v154, a94
    v_mul_f32 v152, v152, v51
    v_mfma_f32_16x16x32_bf16 a[136:139], v[128:131], v[38:41], 0
    ds_write2st64_b64 v149, v[204:205], v[252:253] offset0:8 offset1:20
    v_accvgpr_read_b32 v155, a95
    v_mfma_f32_16x16x32_bf16 v[204:207], v[132:135], v[14:17], 0
    s_add_u32 m0, s22, 26624
    v_cvt_pk_bf16_f32 v156, v156, v157
    v_cvt_pk_bf16_f32 v18, v72, v73
    v_mul_f32 v155, v155, v51
    v_cvt_pk_bf16_f32 v157, v158, v159
    v_mfma_f32_16x16x32_bf16 v[252:255], v[132:135], v[20:23], 0
    v_cvt_pk_bf16_f32 v152, v152, v153
    v_mul_f32 v154, v154, v51
    v_cvt_pk_bf16_f32 v153, v154, v155
    v_mfma_f32_16x16x32_bf16 a[44:47], v[132:135], v[26:29], 0
    ds_write2st64_b64 v149, v[156:157], v[152:153] offset0:32 offset1:44
    v_accvgpr_read_b32 v156, a140
    v_mfma_f32_16x16x32_bf16 a[92:95], v[132:135], v[32:35], 0
    v_accvgpr_read_b32 v158, a142
    v_accvgpr_read_b32 v157, a141
    v_accvgpr_read_b32 v159, a143
    v_mfma_f32_16x16x32_bf16 a[140:143], v[132:135], v[38:41], 0
    s_waitcnt lgkmcnt(2)
    v_exp_f32 v100, v100
    v_mfma_f32_16x16x32_bf16 v[72:75], v[112:115], a[144:147], 0
    v_exp_f32 v104, v104
    v_mfma_f32_16x16x32_bf16 v[72:75], v[116:119], a[148:151], v[72:75]
    v_exp_f32 v77, v77
    v_mfma_f32_16x16x32_bf16 v[72:75], v[120:123], a[152:155], v[72:75]
    ds_read_b128 v[128:131], v0 offset:2048
    v_cvt_pk_bf16_f32 v17, v78, v79
    v_mfma_f32_16x16x32_bf16 v[80:83], v[112:115], a[168:171], 0
    ds_read_b128 v[132:135], v1 offset:2048
    v_cvt_pk_bf16_f32 v16, v76, v77
    v_mfma_f32_16x16x32_bf16 v[80:83], v[116:119], a[172:175], v[80:83]
    buffer_load_dwordx4 v6, s[8:11], s21 offen lds
    v_mfma_f32_16x16x32_bf16 v[80:83], v[120:123], a[176:179], v[80:83]
    v_exp_f32 v102, v102
    v_mfma_f32_16x16x32_bf16 v[88:91], v[112:115], a[192:195], 0
    v_cvt_pk_bf16_f32 v43, v106, v107
    v_cvt_pk_bf16_f32 v42, v104, v105
    v_mfma_f32_16x16x32_bf16 v[48:51], v[52:55], v[16:19], v[44:47]
    s_add_u32 s21, s21, 12032
    ds_read_b128 v[124:127], v1 offset:1024
    v_cvt_pk_bf16_f32 v36, v96, v97
    v_mfma_f32_16x16x32_bf16 v[88:91], v[116:119], a[196:199], v[88:91]
    v_exp_f32 v94, v94
    v_mfma_f32_16x16x32_bf16 v[88:91], v[120:123], a[200:203], v[88:91]
    v_exp_f32 v103, v103
    v_mfma_f32_16x16x32_bf16 v[96:99], v[112:115], a[216:219], 0
    v_exp_f32 v85, v85
    v_mfma_f32_16x16x32_bf16 v[96:99], v[116:119], a[220:223], v[96:99]
    v_exp_f32 v86, v86
    v_mfma_f32_16x16x32_bf16 v[96:99], v[120:123], a[224:227], v[96:99]
    s_add_u32 s56, s67, 128
    v_exp_f32 v108, v108
    v_mfma_f32_16x16x32_bf16 v[104:107], v[112:115], a[240:243], 0
    buffer_store_dwordx4 v[144:147], v6, s[16:19], s56 offen sc0 sc1 nt
    ds_read_b128 v[112:115], v0 offset:6144
    v_pk_mul_f32 v[158:159], v[158:159], v[148:149] op_sel_hi:[1,0]
    v_pk_mul_f32 v[156:157], v[156:157], v[148:149] op_sel_hi:[1,0]
    v_cvt_pk_bf16_f32 v35, v102, v103
    v_cvt_pk_bf16_f32 v22, v84, v85
    v_mfma_f32_16x16x32_bf16 v[104:107], v[116:119], a[244:247], v[104:107]
    v_fma_f32 v111, v111, s28, v13
    v_cvt_pk_bf16_f32 v23, v86, v87
    v_mfma_f32_16x16x32_bf16 v[104:107], v[120:123], a[248:251], v[104:107]
    s_waitcnt lgkmcnt(1)
    v_exp_f32 v93, v93
    v_mfma_f32_16x16x32_bf16 v[72:75], v[124:127], a[156:159], v[72:75]
    s_add_u32 s58, s33, 128
    s_add_u32 m0, s38, 2048
    ds_read_b128 v[116:119], v1 offset:6144
    v_mfma_f32_16x16x32_bf16 v[72:75], v[128:131], a[160:163], v[72:75]
    buffer_load_dwordx4 v6, s[12:15], s58 offen nt lds
    v_mfma_f32_16x16x32_bf16 v[72:75], v[132:135], a[164:167], v[72:75]
    ds_read_b128 v[144:147], v8 offset:3072
    v_cvt_pk_bf16_f32 v156, v156, v157
    v_mfma_f32_16x16x32_bf16 v[80:83], v[124:127], a[180:183], v[80:83]
    v_exp_f32 v95, v95
    v_mfma_f32_16x16x32_bf16 v[80:83], v[128:131], a[184:187], v[80:83]
    v_exp_f32 v92, v92
    v_mfma_f32_16x16x32_bf16 v[80:83], v[132:135], a[188:191], v[80:83]
    v_exp_f32 v110, v110
    v_mfma_f32_16x16x32_bf16 v[88:91], v[124:127], a[204:207], v[88:91]
    s_add_u32 m0, s38, 3072
    v_cvt_pk_bf16_f32 v29, v94, v95
    v_cvt_pk_bf16_f32 v28, v92, v93
    v_mfma_f32_16x16x32_bf16 v[88:91], v[128:131], a[208:211], v[88:91]
    v_cvt_pk_bf16_f32 v157, v158, v159
    v_fma_f32 v101, v101, s28, v12
    v_mfma_f32_16x16x32_bf16 v[88:91], v[132:135], a[212:215], v[88:91]
    v_exp_f32 v101, v101
    v_mfma_f32_16x16x32_bf16 v[48:51], v[56:59], v[22:25], v[48:51]
    v_exp_f32 v111, v111
    v_mfma_f32_16x16x32_bf16 v[96:99], v[124:127], a[228:231], v[96:99]
    ds_read_b128 v[120:123], v0 offset:7168
    v_mfma_f32_16x16x32_bf16 v[96:99], v[128:131], a[232:235], v[96:99]
    v_exp_f32 v109, v109
    v_mfma_f32_16x16x32_bf16 v[96:99], v[132:135], a[236:239], v[96:99]
    s_waitcnt lgkmcnt(1)
    buffer_load_dwordx4 v7, s[12:15], s58 offen nt lds
    v_mfma_f32_16x16x32_bf16 v[104:107], v[124:127], a[252:255], v[104:107]
    buffer_store_dwordx4 v[144:147], v7, s[16:19], s56 offen sc0 sc1 nt
    ds_write_b64 v149, v[156:157] offset:0
    v_mfma_f32_16x16x32_bf16 v[104:107], v[128:131], v[136:139], v[104:107]
    ds_read_b128 v[144:147], v8 offset:0
    v_mfma_f32_16x16x32_bf16 v[48:51], v[60:63], v[28:31], v[48:51]
    v_cvt_pk_bf16_f32 v40, v108, v109
    v_mfma_f32_16x16x32_bf16 v[104:107], v[132:135], v[140:143], v[104:107]
    v_cvt_pk_bf16_f32 v41, v110, v111
    v_cvt_pk_bf16_f32 v34, v100, v101
    v_mfma_f32_16x16x32_bf16 v[76:79], v[112:115], a[144:147], 0
    s_nop 0
    v_mfma_f32_16x16x32_bf16 v[48:51], v[64:67], v[34:37], v[48:51]
    v_mfma_f32_16x16x32_bf16 v[48:51], v[68:71], v[40:43], v[48:51]
    v_mfma_f32_16x16x32_bf16 v[76:79], v[116:119], a[148:151], v[76:79]
    s_waitcnt lgkmcnt(2)
    ds_read_b128 v[128:131], v0 offset:8192
    v_mfma_f32_16x16x32_bf16 v[76:79], v[120:123], a[152:155], v[76:79]
    s_add_u32 s57, s67, 24832
    v_mfma_f32_16x16x32_bf16 v[84:87], v[112:115], a[168:171], 0
    s_add_u32 m0, s38, 0
    ds_read_b128 v[132:135], v1 offset:8192
    v_mfma_f32_16x16x32_bf16 v[84:87], v[116:119], a[172:175], v[84:87]
    v_cmp_lt_f32 vcc, s29, v48
    v_mfma_f32_16x16x32_bf16 v[84:87], v[120:123], a[176:179], v[84:87]
    s_waitcnt lgkmcnt(2)
    ds_read_b128 v[124:127], v1 offset:7168
    buffer_load_dwordx4 v6, s[12:15], s33 offen nt lds
    v_mfma_f32_16x16x32_bf16 v[92:95], v[112:115], a[192:195], 0
    s_add_u32 m0, s38, 1024
    s_cbranch_vccnz L_rs_tr55d
L_ret_tr55d:
    v_mfma_f32_16x16x32_bf16 v[92:95], v[116:119], a[196:199], v[92:95]
    buffer_store_dwordx4 v[144:147], v6, s[16:19], s57 offen sc0 sc1 nt
    s_nop 0
    ds_read_b128 v[144:147], v8 offset:1024
    v_fma_f32 v80, v80, s28, v10
    v_fma_f32 v75, v75, s28, v9
    v_mfma_f32_16x16x32_bf16 v[92:95], v[120:123], a[200:203], v[92:95]
    v_fma_f32 v83, v83, s28, v10
    v_fma_f32 v73, v73, s28, v9
    v_mfma_f32_16x16x32_bf16 v[100:103], v[112:115], a[216:219], 0
    v_exp_f32 v73, v73
    v_mfma_f32_16x16x32_bf16 v[100:103], v[116:119], a[220:223], v[100:103]
    v_exp_f32 v75, v75
    v_mfma_f32_16x16x32_bf16 v[100:103], v[120:123], a[224:227], v[100:103]
    v_fma_f32 v72, v72, s28, v9
    v_fma_f32 v74, v74, s28, v9
    v_mfma_f32_16x16x32_bf16 v[108:111], v[112:115], a[240:243], 0
    v_exp_f32 v72, v72
    v_mfma_f32_16x16x32_bf16 v[108:111], v[116:119], a[244:247], v[108:111]
    v_exp_f32 v83, v83
    v_mfma_f32_16x16x32_bf16 v[108:111], v[120:123], a[248:251], v[108:111]
    s_waitcnt lgkmcnt(1)
    v_exp_f32 v80, v80
    v_mfma_f32_16x16x32_bf16 v[76:79], v[124:127], a[156:159], v[76:79]
    v_add_u32 v8, 4096, v8
    v_fma_f32 v82, v82, s28, v10
    v_mfma_f32_16x16x32_bf16 v[76:79], v[128:131], a[160:163], v[76:79]
    v_exp_f32 v74, v74
    v_mfma_f32_16x16x32_bf16 v[76:79], v[132:135], a[164:167], v[76:79]
    s_waitcnt lgkmcnt(0)
    buffer_load_dwordx4 v7, s[12:15], s33 offen nt lds
    v_mfma_f32_16x16x32_bf16 v[84:87], v[124:127], a[180:183], v[84:87]
    s_waitcnt vmcnt(15)
    v_exp_f32 v82, v82
    v_mfma_f32_16x16x32_bf16 v[84:87], v[128:131], a[184:187], v[84:87]
    buffer_store_dwordx4 v[144:147], v7, s[16:19], s57 offen sc0 sc1 nt
    s_barrier
    ds_read_b64_tr_b16 v[112:113], v2 offset:18432
    v_fma_f32 v81, v81, s28, v10
    v_mfma_f32_16x16x32_bf16 v[84:87], v[132:135], a[188:191], v[84:87]
    s_add_u32 m0, s22, 0
    ds_read_b64_tr_b16 v[114:115], v2 offset:12288
    v_cvt_pk_bf16_f32 v21, v82, v83
    v_mfma_f32_16x16x32_bf16 v[92:95], v[124:127], a[204:207], v[92:95]
    v_exp_f32 v81, v81
    v_mfma_f32_16x16x32_bf16 v[92:95], v[128:131], a[208:211], v[92:95]
    buffer_load_dwordx4 v6, s[4:7], s20 offen lds
    v_mfma_f32_16x16x32_bf16 v[92:95], v[132:135], a[212:215], v[92:95]
    s_add_u32 s20, s20, 128
    ds_read_b64_tr_b16 v[116:117], v3 offset:18432
    v_cvt_pk_bf16_f32 v20, v80, v81
    v_mfma_f32_16x16x32_bf16 v[100:103], v[124:127], a[228:231], v[100:103]
    s_add_u32 m0, s22, 1024
    ds_read_b64_tr_b16 v[118:119], v3 offset:12288
    v_cvt_pk_bf16_f32 v14, v72, v73
    v_mfma_f32_16x16x32_bf16 v[100:103], v[128:131], a[232:235], v[100:103]
    ds_read_b64_tr_b16 v[120:121], v4 offset:18432
    buffer_load_dwordx4 v6, s[4:7], s20 offen lds
    v_mfma_f32_16x16x32_bf16 v[100:103], v[132:135], a[236:239], v[100:103]
    s_add_u32 s20, s20, 128
    s_add_u32 m0, s22, 2048
    ds_read_b64_tr_b16 v[122:123], v4 offset:12288
    v_mfma_f32_16x16x32_bf16 v[108:111], v[124:127], a[252:255], v[108:111]
    buffer_load_dwordx4 v6, s[4:7], s20 offen lds
    v_mfma_f32_16x16x32_bf16 v[108:111], v[128:131], v[136:139], v[108:111]
    ds_read_b64_tr_b16 v[124:125], v5 offset:18432
    v_cvt_pk_bf16_f32 v15, v74, v75
    v_mfma_f32_16x16x32_bf16 v[108:111], v[132:135], v[140:143], v[108:111]
    s_add_u32 s20, s20, 12032
    ds_read_b64_tr_b16 v[126:127], v5 offset:12288
    s_branch L_loop5
L_loop4:
    .p2align 6
L_loop4w0:
    s_waitcnt lgkmcnt(6)
    v_mfma_f32_16x16x32_bf16 v[160:163], v[112:115], v[16:19], v[160:163]
    ds_read_b64_tr_b16 v[130:131], v2 offset:13312
    v_fma_f32 v84, v84, s28, v10
    v_mfma_f32_16x16x32_bf16 v[208:211], v[112:115], v[22:25], v[208:211]
    v_fma_f32 v76, v76, s28, v9
    v_mfma_f32_16x16x32_bf16 a[0:3], v[112:115], v[28:31], a[0:3]
    ds_read_b64_tr_b16 v[132:133], v3 offset:19456
    v_fma_f32 v93, v93, s28, v11
    v_mfma_f32_16x16x32_bf16 a[48:51], v[112:115], v[34:37], a[48:51]
    ds_read_b64_tr_b16 v[128:129], v2 offset:19456
    s_waitcnt lgkmcnt(7)
    v_mfma_f32_16x16x32_bf16 v[164:167], v[116:119], v[16:19], v[164:167]
    ds_read_b64_tr_b16 v[112:113], v4 offset:19456
    v_fma_f32 v90, v90, s28, v11
    v_mfma_f32_16x16x32_bf16 v[212:215], v[116:119], v[22:25], v[212:215]
    v_exp_f32 v90, v90
    v_mfma_f32_16x16x32_bf16 a[4:7], v[116:119], v[28:31], a[4:7]
    ds_read_b64_tr_b16 v[134:135], v3 offset:13312
    v_fma_f32 v96, v96, s28, v12
    v_mfma_f32_16x16x32_bf16 a[52:55], v[116:119], v[34:37], a[52:55]
    s_waitcnt lgkmcnt(7)
    v_mfma_f32_16x16x32_bf16 v[168:171], v[120:123], v[16:19], v[168:171]
    ds_read_b64_tr_b16 v[114:115], v4 offset:13312
    v_fma_f32 v83, v83, s28, v10
    v_mfma_f32_16x16x32_bf16 v[216:219], v[120:123], v[22:25], v[216:219]
    ds_read_b64_tr_b16 v[116:117], v5 offset:19456
    v_fma_f32 v101, v101, s28, v12
    v_mfma_f32_16x16x32_bf16 a[8:11], v[120:123], v[28:31], a[8:11]
    ds_read_b64_tr_b16 v[118:119], v5 offset:13312
    v_fma_f32 v86, v86, s28, v10
    v_mfma_f32_16x16x32_bf16 a[56:59], v[120:123], v[34:37], a[56:59]
    s_waitcnt lgkmcnt(7)
    ds_read_b64_tr_b16 v[122:123], v2 offset:14336
    v_mfma_f32_16x16x32_bf16 v[172:175], v[124:127], v[16:19], v[172:175]
    s_add_u32 s39, s39, 12288
    v_exp_f32 v93, v93
    v_mfma_f32_16x16x32_bf16 v[220:223], v[124:127], v[22:25], v[220:223]
    v_fma_f32 v99, v99, s28, v12
    v_fma_f32 v89, v89, s28, v11
    v_mfma_f32_16x16x32_bf16 a[12:15], v[124:127], v[28:31], a[12:15]
    v_fma_f32 v103, v103, s28, v12
    v_fma_f32 v97, v97, s28, v12
    v_mfma_f32_16x16x32_bf16 a[60:63], v[124:127], v[34:37], a[60:63]
    s_waitcnt lgkmcnt(5)
    ds_read_b64_tr_b16 v[120:121], v2 offset:20480
    v_fma_f32 v91, v91, s28, v11
    v_mfma_f32_16x16x32_bf16 v[176:179], v[128:131], v[16:19], v[176:179]
    v_exp_f32 v96, v96
    v_mfma_f32_16x16x32_bf16 v[224:227], v[128:131], v[22:25], v[224:227]
    ds_read_b64_tr_b16 v[124:125], v3 offset:20480
    v_mfma_f32_16x16x32_bf16 a[16:19], v[128:131], v[28:31], a[16:19]
    ds_read_b64_tr_b16 v[126:127], v3 offset:14336
    v_fma_f32 v102, v102, s28, v12
    v_mfma_f32_16x16x32_bf16 a[64:67], v[128:131], v[34:37], a[64:67]
    s_waitcnt lgkmcnt(5)
    v_exp_f32 v91, v91
    v_mfma_f32_16x16x32_bf16 v[180:183], v[132:135], v[16:19], v[180:183]
    ds_read_b64_tr_b16 v[128:129], v4 offset:20480
    v_fma_f32 v82, v82, s28, v10
    v_mfma_f32_16x16x32_bf16 v[228:231], v[132:135], v[22:25], v[228:231]
    ds_read_b64_tr_b16 v[130:131], v4 offset:14336
    v_fma_f32 v98, v98, s28, v12
    v_mfma_f32_16x16x32_bf16 a[20:23], v[132:135], v[28:31], a[20:23]
    v_exp_f32 v84, v84
    v_mfma_f32_16x16x32_bf16 a[68:71], v[132:135], v[34:37], a[68:71]
    ds_read_b64_tr_b16 v[134:135], v5 offset:14336
    ds_read_b64_tr_b16 v[132:133], v5 offset:20480
    v_mfma_f32_16x16x32_bf16 v[184:187], v[112:115], v[16:19], v[184:187]
    v_exp_f32 v83, v83
    v_mfma_f32_16x16x32_bf16 v[232:235], v[112:115], v[22:25], v[232:235]
    v_exp_f32 v102, v102
    v_mfma_f32_16x16x32_bf16 a[24:27], v[112:115], v[28:31], a[24:27]
    v_fma_f32 v87, v87, s28, v10
    v_fma_f32 v95, v95, s28, v11
    v_mfma_f32_16x16x32_bf16 a[72:75], v[112:115], v[34:37], a[72:75]
    s_waitcnt lgkmcnt(5)
    v_exp_f32 v98, v98
    v_mfma_f32_16x16x32_bf16 v[188:191], v[116:119], v[16:19], v[188:191]
    v_exp_f32 v95, v95
    v_mfma_f32_16x16x32_bf16 v[236:239], v[116:119], v[22:25], v[236:239]
    v_exp_f32 v76, v76
    v_mfma_f32_16x16x32_bf16 a[28:31], v[116:119], v[28:31], a[28:31]
    v_exp_f32 v103, v103
    v_mfma_f32_16x16x32_bf16 a[76:79], v[116:119], v[34:37], a[76:79]
    v_exp_f32 v97, v97
    v_mfma_f32_16x16x32_bf16 v[192:195], v[120:123], v[16:19], v[192:195]
    v_exp_f32 v82, v82
    v_mfma_f32_16x16x32_bf16 v[240:243], v[120:123], v[22:25], v[240:243]
    s_waitcnt vmcnt(10) lgkmcnt(0)
    v_cvt_pk_bf16_f32 v27, v90, v91
    v_mfma_f32_16x16x32_bf16 a[32:35], v[120:123], v[28:31], a[32:35]
    s_barrier
    v_mfma_f32_16x16x32_bf16 a[80:83], v[120:123], v[34:37], a[80:83]
    s_add_u32 m0, s22, 36864
    ds_read_b128 v[112:115], v0 offset:12288
    v_fma_f32 v85, v85, s28, v10
    v_mfma_f32_16x16x32_bf16 v[196:199], v[124:127], v[16:19], v[196:199]
    ds_read_b128 v[120:123], v0 offset:13312
    v_mfma_f32_16x16x32_bf16 v[244:247], v[124:127], v[22:25], v[244:247]
    ds_read_b128 v[116:119], v1 offset:12288
    v_fma_f32 v79, v79, s28, v9
    v_mfma_f32_16x16x32_bf16 a[36:39], v[124:127], v[28:31], a[36:39]
    buffer_load_dwordx4 v6, s[8:11], s21 offen lds
    v_mfma_f32_16x16x32_bf16 a[84:87], v[124:127], v[34:37], a[84:87]
    s_add_u32 s21, s21, 128
    v_cvt_pk_bf16_f32 v21, v82, v83
    v_fma_f32 v77, v77, s28, v9
    v_mfma_f32_16x16x32_bf16 v[200:203], v[128:131], v[16:19], v[200:203]
    s_add_u32 m0, s22, 37888
    v_exp_f32 v89, v89
    v_mfma_f32_16x16x32_bf16 v[248:251], v[128:131], v[22:25], v[248:251]
    buffer_load_dwordx4 v6, s[8:11], s21 offen lds
    v_mfma_f32_16x16x32_bf16 a[40:43], v[128:131], v[28:31], a[40:43]
    v_exp_f32 v99, v99
    v_mfma_f32_16x16x32_bf16 a[88:91], v[128:131], v[34:37], a[88:91]
    v_cvt_pk_bf16_f32 v32, v96, v97
    v_cvt_pk_bf16_f32 v33, v98, v99
    v_mfma_f32_16x16x32_bf16 v[204:207], v[132:135], v[16:19], v[204:207]
    v_exp_f32 v85, v85
    v_mfma_f32_16x16x32_bf16 v[252:255], v[132:135], v[22:25], v[252:255]
    ds_read_b128 v[124:127], v1 offset:13312
    v_fma_f32 v88, v88, s28, v11
    v_mfma_f32_16x16x32_bf16 a[44:47], v[132:135], v[28:31], a[44:47]
    s_add_u32 s21, s21, 128
    ds_read_b128 v[128:131], v0 offset:14336
    v_mfma_f32_16x16x32_bf16 a[92:95], v[132:135], v[34:37], a[92:95]
    s_waitcnt lgkmcnt(2)
    v_mfma_f32_16x16x32_bf16 v[72:75], v[112:115], a[144:147], 0
    s_add_u32 m0, s22, 38912
    v_exp_f32 v88, v88
    v_mfma_f32_16x16x32_bf16 v[72:75], v[116:119], a[148:151], v[72:75]
    buffer_load_dwordx4 v6, s[8:11], s21 offen lds
    v_mfma_f32_16x16x32_bf16 v[72:75], v[120:123], a[152:155], v[72:75]
    ds_read_b128 v[132:135], v1 offset:14336
    v_mfma_f32_16x16x32_bf16 v[80:83], v[112:115], a[168:171], 0
    v_cvt_pk_bf16_f32 v26, v88, v89
    v_mfma_f32_16x16x32_bf16 v[80:83], v[116:119], a[172:175], v[80:83]
    v_exp_f32 v87, v87
    v_mfma_f32_16x16x32_bf16 v[80:83], v[120:123], a[176:179], v[80:83]
    v_fma_f32 v92, v92, s28, v11
    v_fma_f32 v94, v94, s28, v11
    v_mfma_f32_16x16x32_bf16 v[88:91], v[112:115], a[192:195], 0
    v_exp_f32 v92, v92
    v_mfma_f32_16x16x32_bf16 v[88:91], v[116:119], a[196:199], v[88:91]
    v_fma_f32 v78, v78, s28, v9
    v_mfma_f32_16x16x32_bf16 v[88:91], v[120:123], a[200:203], v[88:91]
    v_exp_f32 v78, v78
    v_mfma_f32_16x16x32_bf16 v[96:99], v[112:115], a[216:219], 0
    v_exp_f32 v101, v101
    v_mfma_f32_16x16x32_bf16 v[96:99], v[116:119], a[220:223], v[96:99]
    v_exp_f32 v77, v77
    v_mfma_f32_16x16x32_bf16 v[96:99], v[120:123], a[224:227], v[96:99]
    s_waitcnt lgkmcnt(1)
    ds_read_b128 v[112:115], v0 offset:18432
    v_mfma_f32_16x16x32_bf16 v[72:75], v[124:127], a[156:159], v[72:75]
    v_exp_f32 v94, v94
    v_mfma_f32_16x16x32_bf16 v[72:75], v[128:131], a[160:163], v[72:75]
    s_waitcnt lgkmcnt(1)
    v_cvt_pk_bf16_f32 v22, v84, v85
    v_mfma_f32_16x16x32_bf16 v[72:75], v[132:135], a[164:167], v[72:75]
    v_exp_f32 v86, v86
    v_mfma_f32_16x16x32_bf16 v[80:83], v[124:127], a[180:183], v[80:83]
    v_cvt_pk_bf16_f32 v28, v92, v93
    v_mfma_f32_16x16x32_bf16 v[80:83], v[128:131], a[184:187], v[80:83]
    ds_read_b128 v[116:119], v1 offset:18432
    v_mfma_f32_16x16x32_bf16 v[80:83], v[132:135], a[188:191], v[80:83]
    v_exp_f32 v79, v79
    v_mfma_f32_16x16x32_bf16 v[88:91], v[124:127], a[204:207], v[88:91]
    v_cvt_pk_bf16_f32 v16, v76, v77
    v_mfma_f32_16x16x32_bf16 v[88:91], v[128:131], a[208:211], v[88:91]
    ds_read_b128 v[120:123], v0 offset:19456
    v_cvt_pk_bf16_f32 v17, v78, v79
    v_mfma_f32_16x16x32_bf16 v[88:91], v[132:135], a[212:215], v[88:91]
    v_cvt_pk_bf16_f32 v23, v86, v87
    v_mfma_f32_16x16x32_bf16 v[96:99], v[124:127], a[228:231], v[96:99]
    ds_read_b128 v[124:127], v1 offset:19456
    v_cvt_pk_bf16_f32 v29, v94, v95
    v_mfma_f32_16x16x32_bf16 v[96:99], v[128:131], a[232:235], v[96:99]
    ds_read_b128 v[128:131], v0 offset:20480
    v_cvt_pk_bf16_f32 v35, v102, v103
    v_mfma_f32_16x16x32_bf16 v[96:99], v[132:135], a[236:239], v[96:99]
    s_waitcnt lgkmcnt(4)
    ds_read_b128 v[132:135], v1 offset:20480
    v_fma_f32 v100, v100, s28, v12
    v_mfma_f32_16x16x32_bf16 v[76:79], v[112:115], a[144:147], 0
    v_exp_f32 v100, v100
    v_mfma_f32_16x16x32_bf16 v[44:47], v[52:55], v[14:17], v[48:51]
    v_cvt_pk_bf16_f32 v34, v100, v101
    v_mfma_f32_16x16x32_bf16 v[44:47], v[56:59], v[20:23], v[44:47]
    v_mfma_f32_16x16x32_bf16 v[44:47], v[60:63], v[26:29], v[44:47]
    v_mfma_f32_16x16x32_bf16 v[44:47], v[64:67], v[32:35], v[44:47]
    s_waitcnt lgkmcnt(4)
    v_mfma_f32_16x16x32_bf16 v[76:79], v[116:119], a[148:151], v[76:79]
    s_add_u32 s21, s21, 12032
    s_waitcnt lgkmcnt(3)
    v_mfma_f32_16x16x32_bf16 v[76:79], v[120:123], a[152:155], v[76:79]
    v_mfma_f32_16x16x32_bf16 v[84:87], v[112:115], a[168:171], 0
    s_nop 1
    v_cmp_lt_f32 vcc, s29, v44
    v_mfma_f32_16x16x32_bf16 v[84:87], v[116:119], a[172:175], v[84:87]
    s_waitcnt vmcnt(9) lgkmcnt(0)
    v_mfma_f32_16x16x32_bf16 v[84:87], v[120:123], a[176:179], v[84:87]
    s_barrier
    v_mfma_f32_16x16x32_bf16 v[92:95], v[112:115], a[192:195], 0
    s_cbranch_vccnz L_rs_loop4w0a
L_ret_loop4w0a:
    v_fma_f32 v75, v75, s28, v9
    v_mfma_f32_16x16x32_bf16 v[92:95], v[116:119], a[196:199], v[92:95]
    s_add_u32 m0, s22, 12288
    v_fma_f32 v80, v80, s28, v10
    v_fma_f32 v81, v81, s28, v10
    v_mfma_f32_16x16x32_bf16 v[92:95], v[120:123], a[200:203], v[92:95]
    buffer_load_dwordx4 v6, s[4:7], s20 offen lds
    v_mfma_f32_16x16x32_bf16 v[100:103], v[112:115], a[216:219], 0
    s_add_u32 s20, s20, 128
    ds_read_b64_tr_b16 v[112:113], v2 offset:0
    v_fma_f32 v74, v74, s28, v9
    v_mfma_f32_16x16x32_bf16 v[100:103], v[116:119], a[220:223], v[100:103]
    v_exp_f32 v81, v81
    v_mfma_f32_16x16x32_bf16 v[100:103], v[120:123], a[224:227], v[100:103]
    s_add_u32 m0, s22, 13312
    ds_read_b64_tr_b16 v[114:115], v2 offset:6144
    v_fma_f32 v73, v73, s28, v9
    v_mfma_f32_16x16x32_bf16 v[76:79], v[124:127], a[156:159], v[76:79]
    ds_read_b64_tr_b16 v[116:117], v3 offset:0
    v_fma_f32 v72, v72, s28, v9
    v_mfma_f32_16x16x32_bf16 v[76:79], v[128:131], a[160:163], v[76:79]
    buffer_load_dwordx4 v6, s[4:7], s20 offen lds
    v_mfma_f32_16x16x32_bf16 v[76:79], v[132:135], a[164:167], v[76:79]
    v_exp_f32 v75, v75
    v_mfma_f32_16x16x32_bf16 v[84:87], v[124:127], a[180:183], v[84:87]
    v_exp_f32 v73, v73
    v_mfma_f32_16x16x32_bf16 v[84:87], v[128:131], a[184:187], v[84:87]
    s_add_u32 s20, s20, 128
    v_exp_f32 v80, v80
    v_mfma_f32_16x16x32_bf16 v[84:87], v[132:135], a[188:191], v[84:87]
    s_add_u32 m0, s22, 14336
    ds_read_b64_tr_b16 v[118:119], v3 offset:6144
    v_cvt_pk_bf16_f32 v24, v80, v81
    v_mfma_f32_16x16x32_bf16 v[92:95], v[124:127], a[204:207], v[92:95]
    v_exp_f32 v74, v74
    v_mfma_f32_16x16x32_bf16 v[92:95], v[128:131], a[208:211], v[92:95]
    buffer_load_dwordx4 v6, s[4:7], s20 offen lds
    v_mfma_f32_16x16x32_bf16 v[92:95], v[132:135], a[212:215], v[92:95]
    ds_read_b64_tr_b16 v[120:121], v4 offset:0
    v_cvt_pk_bf16_f32 v19, v74, v75
    v_mfma_f32_16x16x32_bf16 v[100:103], v[124:127], a[228:231], v[100:103]
    v_exp_f32 v72, v72
    v_mfma_f32_16x16x32_bf16 v[100:103], v[128:131], a[232:235], v[100:103]
    ds_read_b64_tr_b16 v[122:123], v4 offset:6144
    ds_read_b64_tr_b16 v[124:125], v5 offset:0
    v_mfma_f32_16x16x32_bf16 v[100:103], v[132:135], a[236:239], v[100:103]
    s_add_u32 s20, s20, 12032
    ds_read_b64_tr_b16 v[126:127], v5 offset:6144
    v_cvt_pk_bf16_f32 v18, v72, v73
    s_waitcnt lgkmcnt(6)
    v_mfma_f32_16x16x32_bf16 v[160:163], v[112:115], v[14:17], v[160:163]
    ds_read_b64_tr_b16 v[130:131], v2 offset:7168
    s_nop 1
    v_fma_f32 v101, v101, s28, v12
    v_mfma_f32_16x16x32_bf16 v[208:211], v[112:115], v[20:23], v[208:211]
    ds_read_b128 v[148:151], v8 offset:1024
    v_fma_f32 v99, v99, s28, v12
    v_mfma_f32_16x16x32_bf16 a[0:3], v[112:115], v[26:29], a[0:3]
    ds_read_b64_tr_b16 v[128:129], v2 offset:1024
    v_fma_f32 v92, v92, s28, v11
    v_mfma_f32_16x16x32_bf16 a[48:51], v[112:115], v[32:35], a[48:51]
    ds_read_b64_tr_b16 v[132:133], v3 offset:1024
    s_waitcnt lgkmcnt(8)
    v_mfma_f32_16x16x32_bf16 v[164:167], v[116:119], v[14:17], v[164:167]
    ds_read_b64_tr_b16 v[134:135], v3 offset:7168
    v_fma_f32 v82, v82, s28, v10
    v_mfma_f32_16x16x32_bf16 v[212:215], v[116:119], v[20:23], v[212:215]
    ds_read_b64_tr_b16 v[112:113], v4 offset:1024
    v_mfma_f32_16x16x32_bf16 a[4:7], v[116:119], v[26:29], a[4:7]
    v_fma_f32 v94, v94, s28, v11
    v_fma_f32 v98, v98, s28, v12
    v_mfma_f32_16x16x32_bf16 a[52:55], v[116:119], v[32:35], a[52:55]
    v_fma_f32 v96, v96, s28, v12
    s_waitcnt lgkmcnt(8)
    v_mfma_f32_16x16x32_bf16 v[168:171], v[120:123], v[14:17], v[168:171]
    ds_read_b64_tr_b16 v[118:119], v5 offset:7168
    v_fma_f32 v88, v88, s28, v11
    v_mfma_f32_16x16x32_bf16 v[216:219], v[120:123], v[20:23], v[216:219]
    v_fma_f32 v97, v97, s28, v12
    v_fma_f32 v78, v78, s28, v9
    v_mfma_f32_16x16x32_bf16 a[8:11], v[120:123], v[26:29], a[8:11]
    ds_read_b64_tr_b16 v[114:115], v4 offset:7168
    v_fma_f32 v91, v91, s28, v11
    v_mfma_f32_16x16x32_bf16 a[56:59], v[120:123], v[32:35], a[56:59]
    s_waitcnt lgkmcnt(6)
    v_exp_f32 v96, v96
    v_mfma_f32_16x16x32_bf16 v[172:175], v[124:127], v[14:17], v[172:175]
    v_exp_f32 v97, v97
    v_mfma_f32_16x16x32_bf16 v[220:223], v[124:127], v[20:23], v[220:223]
    s_add_u32 s39, s39, 12288
    ds_read_b64_tr_b16 v[116:117], v5 offset:1024
    v_fma_f32 v100, v100, s28, v12
    v_mfma_f32_16x16x32_bf16 a[12:15], v[124:127], v[26:29], a[12:15]
    ds_read_b128 v[144:147], v8 offset:0
    v_fma_f32 v90, v90, s28, v11
    v_mfma_f32_16x16x32_bf16 a[60:63], v[124:127], v[32:35], a[60:63]
    s_waitcnt lgkmcnt(4)
    ds_read_b64_tr_b16 v[122:123], v2 offset:8192
    v_mfma_f32_16x16x32_bf16 v[176:179], v[128:131], v[14:17], v[176:179]
    ds_read_b64_tr_b16 v[120:121], v2 offset:2048
    v_cvt_pk_bf16_f32 v36, v96, v97
    v_mfma_f32_16x16x32_bf16 v[224:227], v[128:131], v[20:23], v[224:227]
    v_exp_f32 v91, v91
    v_mfma_f32_16x16x32_bf16 a[16:19], v[128:131], v[26:29], a[16:19]
    ds_read_b64_tr_b16 v[124:125], v3 offset:2048
    v_fma_f32 v102, v102, s28, v12
    v_mfma_f32_16x16x32_bf16 a[64:67], v[128:131], v[32:35], a[64:67]
    v_exp_f32 v99, v99
    v_mfma_f32_16x16x32_bf16 v[180:183], v[132:135], v[14:17], v[180:183]
    ds_read_b64_tr_b16 v[130:131], v4 offset:8192
    v_fma_f32 v79, v79, s28, v9
    v_mfma_f32_16x16x32_bf16 v[228:231], v[132:135], v[20:23], v[228:231]
    v_exp_f32 v90, v90
    v_mfma_f32_16x16x32_bf16 a[20:23], v[132:135], v[26:29], a[20:23]
    ds_read_b64_tr_b16 v[128:129], v4 offset:2048
    v_mfma_f32_16x16x32_bf16 a[68:71], v[132:135], v[32:35], a[68:71]
    s_waitcnt lgkmcnt(6)
    ds_read_b64_tr_b16 v[134:135], v5 offset:8192
    v_fma_f32 v84, v84, s28, v10
    v_mfma_f32_16x16x32_bf16 v[184:187], v[112:115], v[14:17], v[184:187]
    ds_read_b64_tr_b16 v[126:127], v3 offset:8192
    v_fma_f32 v93, v93, s28, v11
    v_mfma_f32_16x16x32_bf16 v[232:235], v[112:115], v[20:23], v[232:235]
    ds_read_b64_tr_b16 v[132:133], v5 offset:2048
    v_fma_f32 v77, v77, s28, v9
    v_mfma_f32_16x16x32_bf16 a[24:27], v[112:115], v[26:29], a[24:27]
    v_fma_f32 v95, v95, s28, v11
    v_mfma_f32_16x16x32_bf16 a[72:75], v[112:115], v[32:35], a[72:75]
    v_exp_f32 v88, v88
    v_mfma_f32_16x16x32_bf16 v[188:191], v[116:119], v[14:17], v[188:191]
    v_exp_f32 v78, v78
    v_mfma_f32_16x16x32_bf16 v[236:239], v[116:119], v[20:23], v[236:239]
    v_fma_f32 v103, v103, s28, v12
    v_fma_f32 v89, v89, s28, v11
    v_mfma_f32_16x16x32_bf16 a[28:31], v[116:119], v[26:29], a[28:31]
    v_exp_f32 v100, v100
    v_mfma_f32_16x16x32_bf16 a[76:79], v[116:119], v[32:35], a[76:79]
    s_waitcnt lgkmcnt(4)
    v_exp_f32 v98, v98
    v_mfma_f32_16x16x32_bf16 v[192:195], v[120:123], v[14:17], v[192:195]
    v_exp_f32 v82, v82
    v_mfma_f32_16x16x32_bf16 v[240:243], v[120:123], v[20:23], v[240:243]
    v_fma_f32 v87, v87, s28, v10
    v_cvt_pk_bf16_f32 v31, v90, v91
    v_mfma_f32_16x16x32_bf16 a[32:35], v[120:123], v[26:29], a[32:35]
    buffer_store_dwordx4 v[144:147], v6, s[16:19], s24 offen sc0 sc1 nt
    s_waitcnt vmcnt(7) lgkmcnt(0)
    s_barrier
    v_fma_f32 v85, v85, s28, v10
    v_mfma_f32_16x16x32_bf16 a[80:83], v[120:123], v[32:35], a[80:83]
    ds_read_b128 v[120:123], v0 offset:1024
    v_mfma_f32_16x16x32_bf16 v[196:199], v[124:127], v[14:17], v[196:199]
    v_exp_f32 v79, v79
    v_mfma_f32_16x16x32_bf16 v[244:247], v[124:127], v[20:23], v[244:247]
    s_add_u32 m0, s22, 24576
    ds_read_b128 v[112:115], v0 offset:0
    v_fma_f32 v86, v86, s28, v10
    v_mfma_f32_16x16x32_bf16 a[36:39], v[124:127], v[26:29], a[36:39]
    ds_read_b128 v[116:119], v1 offset:0
    v_fma_f32 v83, v83, s28, v10
    v_mfma_f32_16x16x32_bf16 a[84:87], v[124:127], v[32:35], a[84:87]
    buffer_load_dwordx4 v6, s[8:11], s21 offen lds
    v_mfma_f32_16x16x32_bf16 v[200:203], v[128:131], v[14:17], v[200:203]
    v_exp_f32 v83, v83
    v_mfma_f32_16x16x32_bf16 v[248:251], v[128:131], v[20:23], v[248:251]
    s_add_u32 s21, s21, 128
    v_exp_f32 v89, v89
    v_mfma_f32_16x16x32_bf16 a[40:43], v[128:131], v[26:29], a[40:43]
    v_exp_f32 v102, v102
    v_mfma_f32_16x16x32_bf16 a[88:91], v[128:131], v[32:35], a[88:91]
    v_exp_f32 v77, v77
    v_mfma_f32_16x16x32_bf16 v[204:207], v[132:135], v[14:17], v[204:207]
    v_cvt_pk_bf16_f32 v30, v88, v89
    s_add_u32 m0, s22, 25600
    v_mfma_f32_16x16x32_bf16 v[252:255], v[132:135], v[20:23], v[252:255]
    buffer_load_dwordx4 v6, s[8:11], s21 offen lds
    v_mfma_f32_16x16x32_bf16 a[44:47], v[132:135], v[26:29], a[44:47]
    v_exp_f32 v101, v101
    v_mfma_f32_16x16x32_bf16 a[92:95], v[132:135], v[32:35], a[92:95]
    s_add_u32 s21, s21, 128
    ds_read_b128 v[132:135], v1 offset:2048
    s_waitcnt lgkmcnt(2)
    v_mfma_f32_16x16x32_bf16 v[72:75], v[112:115], a[144:147], 0
    s_add_u32 m0, s22, 26624
    ds_read_b128 v[124:127], v1 offset:1024
    s_waitcnt lgkmcnt(2)
    v_mfma_f32_16x16x32_bf16 v[72:75], v[116:119], a[148:151], v[72:75]
    buffer_load_dwordx4 v6, s[8:11], s21 offen lds
    v_mfma_f32_16x16x32_bf16 v[72:75], v[120:123], a[152:155], v[72:75]
    s_add_u32 s21, s21, 12032
    ds_read_b128 v[128:131], v0 offset:2048
    v_cvt_pk_bf16_f32 v25, v82, v83
    v_mfma_f32_16x16x32_bf16 v[80:83], v[112:115], a[168:171], 0
    v_exp_f32 v85, v85
    v_mfma_f32_16x16x32_bf16 v[80:83], v[116:119], a[172:175], v[80:83]
    v_mfma_f32_16x16x32_bf16 v[80:83], v[120:123], a[176:179], v[80:83]
    buffer_store_dwordx4 v[148:151], v7, s[16:19], s24 offen sc0 sc1 nt
    v_exp_f32 v86, v86
    v_cvt_pk_bf16_f32 v37, v98, v99
    v_mfma_f32_16x16x32_bf16 v[88:91], v[112:115], a[192:195], 0
    v_exp_f32 v84, v84
    v_mfma_f32_16x16x32_bf16 v[88:91], v[116:119], a[196:199], v[88:91]
    v_exp_f32 v94, v94
    v_mfma_f32_16x16x32_bf16 v[88:91], v[120:123], a[200:203], v[88:91]
    v_exp_f32 v87, v87
    v_mfma_f32_16x16x32_bf16 v[96:99], v[112:115], a[216:219], 0
    v_fma_f32 v76, v76, s28, v9
    v_mfma_f32_16x16x32_bf16 v[96:99], v[116:119], a[220:223], v[96:99]
    v_exp_f32 v103, v103
    v_mfma_f32_16x16x32_bf16 v[96:99], v[120:123], a[224:227], v[96:99]
    s_waitcnt lgkmcnt(0)
    ds_read_b128 v[112:115], v0 offset:6144
    v_cvt_pk_bf16_f32 v34, v100, v101
    v_mfma_f32_16x16x32_bf16 v[72:75], v[124:127], a[156:159], v[72:75]
    s_add_u32 m0, s23, 0
    ds_read_b128 v[116:119], v1 offset:6144
    v_mfma_f32_16x16x32_bf16 v[72:75], v[128:131], a[160:163], v[72:75]
    ds_read_b128 v[120:123], v0 offset:7168
    v_cvt_pk_bf16_f32 v22, v84, v85
    v_mfma_f32_16x16x32_bf16 v[72:75], v[132:135], a[164:167], v[72:75]
    buffer_load_dwordx4 v6, s[12:15], s25 offen nt lds
    v_mfma_f32_16x16x32_bf16 v[80:83], v[124:127], a[180:183], v[80:83]
    v_exp_f32 v76, v76
    v_mfma_f32_16x16x32_bf16 v[80:83], v[128:131], a[184:187], v[80:83]
    s_add_u32 m0, s23, 1024
    v_exp_f32 v95, v95
    v_mfma_f32_16x16x32_bf16 v[80:83], v[132:135], a[188:191], v[80:83]
    v_exp_f32 v93, v93
    v_mfma_f32_16x16x32_bf16 v[88:91], v[124:127], a[204:207], v[88:91]
    buffer_load_dwordx4 v7, s[12:15], s25 offen nt lds
    v_mfma_f32_16x16x32_bf16 v[88:91], v[128:131], a[208:211], v[88:91]
    v_exp_f32 v92, v92
    v_mfma_f32_16x16x32_bf16 v[88:91], v[132:135], a[212:215], v[88:91]
    v_cvt_pk_bf16_f32 v23, v86, v87
    v_cvt_pk_bf16_f32 v16, v76, v77
    v_mfma_f32_16x16x32_bf16 v[96:99], v[124:127], a[228:231], v[96:99]
    ds_read_b128 v[124:127], v1 offset:7168
    v_cvt_pk_bf16_f32 v17, v78, v79
    v_mfma_f32_16x16x32_bf16 v[96:99], v[128:131], a[232:235], v[96:99]
    s_bitcmp1_b32 s27, 0
    ds_read_b128 v[128:131], v0 offset:8192
    v_mfma_f32_16x16x32_bf16 v[96:99], v[132:135], a[236:239], v[96:99]
    ds_read_b128 v[132:135], v1 offset:8192
    v_cvt_pk_bf16_f32 v29, v94, v95
    v_mfma_f32_16x16x32_bf16 v[48:51], v[52:55], v[16:19], v[44:47]
    s_cselect_b32 s26, s49, 128
    v_cvt_pk_bf16_f32 v28, v92, v93
    v_cvt_pk_bf16_f32 v35, v102, v103
    v_mfma_f32_16x16x32_bf16 v[48:51], v[56:59], v[22:25], v[48:51]
    v_mfma_f32_16x16x32_bf16 v[48:51], v[60:63], v[28:31], v[48:51]
    s_lshr_b32 s27, s27, 1
    v_add_u32 v8, 2048, v8
    v_mfma_f32_16x16x32_bf16 v[48:51], v[64:67], v[34:37], v[48:51]
    s_waitcnt lgkmcnt(3)
    v_mfma_f32_16x16x32_bf16 v[76:79], v[112:115], a[144:147], 0
    s_add_u32 s24, s24, s26
    v_mfma_f32_16x16x32_bf16 v[76:79], v[116:119], a[148:151], v[76:79]
    s_add_u32 s25, s25, s26
    v_mfma_f32_16x16x32_bf16 v[76:79], v[120:123], a[152:155], v[76:79]
    v_mfma_f32_16x16x32_bf16 v[84:87], v[112:115], a[168:171], 0
    s_add_u32 s23, s23, 2048
    v_cmp_lt_f32 vcc, s29, v48
    v_mfma_f32_16x16x32_bf16 v[84:87], v[116:119], a[172:175], v[84:87]
    s_waitcnt vmcnt(10) lgkmcnt(0)
    v_mfma_f32_16x16x32_bf16 v[84:87], v[120:123], a[176:179], v[84:87]
    s_barrier
    v_mfma_f32_16x16x32_bf16 v[92:95], v[112:115], a[192:195], 0
    s_cbranch_vccnz L_rs_loop4w0b
L_ret_loop4w0b:
    v_fma_f32 v72, v72, s28, v9
    v_mfma_f32_16x16x32_bf16 v[92:95], v[116:119], a[196:199], v[92:95]
    s_cmp_eq_u32 s30, 5
    v_fma_f32 v80, v80, s28, v10
    v_fma_f32 v81, v81, s28, v10
    v_mfma_f32_16x16x32_bf16 v[92:95], v[120:123], a[200:203], v[92:95]
    s_cselect_b32 s26, s62, 0
    v_exp_f32 v72, v72
    v_mfma_f32_16x16x32_bf16 v[100:103], v[112:115], a[216:219], 0
    ds_read_b64_tr_b16 v[112:113], v2 offset:18432
    s_add_u32 s20, s20, s26
    v_mfma_f32_16x16x32_bf16 v[100:103], v[116:119], a[220:223], v[100:103]
    ds_read_b64_tr_b16 v[114:115], v2 offset:12288
    v_fma_f32 v73, v73, s28, v9
    v_mfma_f32_16x16x32_bf16 v[100:103], v[120:123], a[224:227], v[100:103]
    s_add_u32 m0, s22, 0
    ds_read_b64_tr_b16 v[116:117], v3 offset:18432
    v_fma_f32 v74, v74, s28, v9
    v_mfma_f32_16x16x32_bf16 v[76:79], v[124:127], a[156:159], v[76:79]
    buffer_load_dwordx4 v6, s[4:7], s20 offen lds
    v_mfma_f32_16x16x32_bf16 v[76:79], v[128:131], a[160:163], v[76:79]
    s_add_u32 s20, s20, 128
    ds_read_b64_tr_b16 v[118:119], v3 offset:12288
    v_fma_f32 v75, v75, s28, v9
    v_mfma_f32_16x16x32_bf16 v[76:79], v[132:135], a[164:167], v[76:79]
    s_add_u32 m0, s22, 1024
    ds_read_b64_tr_b16 v[120:121], v4 offset:18432
    v_exp_f32 v73, v73
    v_mfma_f32_16x16x32_bf16 v[84:87], v[124:127], a[180:183], v[84:87]
    v_exp_f32 v80, v80
    v_cvt_pk_bf16_f32 v14, v72, v73
    v_mfma_f32_16x16x32_bf16 v[84:87], v[128:131], a[184:187], v[84:87]
    buffer_load_dwordx4 v6, s[4:7], s20 offen lds
    v_mfma_f32_16x16x32_bf16 v[84:87], v[132:135], a[188:191], v[84:87]
    v_exp_f32 v75, v75
    v_mfma_f32_16x16x32_bf16 v[92:95], v[124:127], a[204:207], v[92:95]
    s_add_u32 s20, s20, 128
    v_exp_f32 v81, v81
    v_mfma_f32_16x16x32_bf16 v[92:95], v[128:131], a[208:211], v[92:95]
    s_add_u32 m0, s22, 2048
    v_exp_f32 v74, v74
    v_mfma_f32_16x16x32_bf16 v[92:95], v[132:135], a[212:215], v[92:95]
    buffer_load_dwordx4 v6, s[4:7], s20 offen lds
    v_mfma_f32_16x16x32_bf16 v[100:103], v[124:127], a[228:231], v[100:103]
    ds_read_b64_tr_b16 v[122:123], v4 offset:12288
    v_cvt_pk_bf16_f32 v15, v74, v75
    v_mfma_f32_16x16x32_bf16 v[100:103], v[128:131], a[232:235], v[100:103]
    s_add_u32 s20, s20, 12032
    ds_read_b64_tr_b16 v[124:125], v5 offset:18432
    s_add_u32 s30, s30, 1
    v_mfma_f32_16x16x32_bf16 v[100:103], v[132:135], a[236:239], v[100:103]
    s_cmp_lt_u32 s30, 6
    ds_read_b64_tr_b16 v[126:127], v5 offset:12288
    v_cvt_pk_bf16_f32 v20, v80, v81
    s_cbranch_scc1 L_loop4w0
    s_cmp_ge_u32 s37, 6
    s_cbranch_scc1 L_end4
    s_cmp_eq_u32 s32, 0
    s_cbranch_scc1 L_tr44
    s_branch L_tr45
L_tr45:
    v_fma_f32 v93, v93, s28, v11
    s_waitcnt lgkmcnt(6)
    v_mfma_f32_16x16x32_bf16 v[160:163], v[112:115], v[16:19], v[160:163]
    v_mbcnt_lo_u32_b32 v155, -1, 0
    v_mbcnt_hi_u32_b32 v155, -1, v155
    v_fma_f32 v103, v103, s28, v12
    v_mfma_f32_16x16x32_bf16 v[208:211], v[112:115], v[22:25], v[208:211]
    ds_read_b64_tr_b16 v[134:135], v3 offset:13312
    v_fma_f32 v91, v91, s28, v11
    v_mfma_f32_16x16x32_bf16 a[0:3], v[112:115], v[28:31], a[0:3]
    ds_read_b64_tr_b16 v[128:129], v2 offset:19456
    v_and_b32 v154, 15, v155
    v_mfma_f32_16x16x32_bf16 a[48:51], v[112:115], v[34:37], a[48:51]
    s_waitcnt lgkmcnt(6)
    ds_read_b64_tr_b16 v[132:133], v3 offset:19456
    v_fma_f32 v90, v90, s28, v11
    v_mfma_f32_16x16x32_bf16 v[164:167], v[116:119], v[16:19], v[164:167]
    s_add_u32 s39, s39, 12288
    ds_read_b64_tr_b16 v[130:131], v2 offset:13312
    v_fma_f32 v83, v83, s28, v10
    v_mfma_f32_16x16x32_bf16 v[212:215], v[116:119], v[22:25], v[212:215]
    ds_read_b64_tr_b16 v[114:115], v4 offset:13312
    v_fma_f32 v86, v86, s28, v10
    v_mfma_f32_16x16x32_bf16 a[4:7], v[116:119], v[28:31], a[4:7]
    ds_read_b64_tr_b16 v[112:113], v4 offset:19456
    v_mul_u32_u24 v154, 384, v154
    v_mfma_f32_16x16x32_bf16 a[52:55], v[116:119], v[34:37], a[52:55]
    s_waitcnt lgkmcnt(8)
    ds_read_b64_tr_b16 v[118:119], v5 offset:13312
    v_lshrrev_b32 v155, 4, v155
    v_mfma_f32_16x16x32_bf16 v[168:171], v[120:123], v[16:19], v[168:171]
    s_add_u32 s48, s33, 24576
    v_fma_f32 v96, v96, s28, v12
    v_lshl_add_u32 v154, v155, 4, v154
    v_mfma_f32_16x16x32_bf16 v[216:219], v[120:123], v[22:25], v[216:219]
    buffer_load_dwordx4 v[136:139], v154, s[12:15], s48 offen offset:256 nt
    v_mfma_f32_16x16x32_bf16 a[8:11], v[120:123], v[28:31], a[8:11]
    ds_read_b64_tr_b16 v[116:117], v5 offset:19456
    v_fma_f32 v87, v87, s28, v10
    v_mfma_f32_16x16x32_bf16 a[56:59], v[120:123], v[34:37], a[56:59]
    s_waitcnt lgkmcnt(7)
    v_exp_f32 v96, v96
    v_mfma_f32_16x16x32_bf16 v[172:175], v[124:127], v[16:19], v[172:175]
    buffer_load_dwordx4 v[140:143], v154, s[12:15], s48 offen offset:320 nt
    v_mfma_f32_16x16x32_bf16 v[220:223], v[124:127], v[22:25], v[220:223]
    v_exp_f32 v83, v83
    v_mfma_f32_16x16x32_bf16 a[12:15], v[124:127], v[28:31], a[12:15]
    v_fma_f32 v88, v88, s28, v11
    v_fma_f32 v84, v84, s28, v10
    v_mfma_f32_16x16x32_bf16 a[60:63], v[124:127], v[34:37], a[60:63]
    s_waitcnt lgkmcnt(3)
    v_exp_f32 v86, v86
    v_mfma_f32_16x16x32_bf16 v[176:179], v[128:131], v[16:19], v[176:179]
    ds_read_b64_tr_b16 v[122:123], v2 offset:14336
    v_fma_f32 v99, v99, s28, v12
    v_mfma_f32_16x16x32_bf16 v[224:227], v[128:131], v[22:25], v[224:227]
    ds_read_b64_tr_b16 v[120:121], v2 offset:20480
    v_fma_f32 v77, v77, s28, v9
    v_mfma_f32_16x16x32_bf16 a[16:19], v[128:131], v[28:31], a[16:19]
    v_exp_f32 v77, v77
    v_mfma_f32_16x16x32_bf16 a[64:67], v[128:131], v[34:37], a[64:67]
    ds_read_b64_tr_b16 v[130:131], v4 offset:14336
    v_fma_f32 v78, v78, s28, v9
    v_mfma_f32_16x16x32_bf16 v[180:183], v[132:135], v[16:19], v[180:183]
    ds_read_b64_tr_b16 v[126:127], v3 offset:14336
    v_fma_f32 v98, v98, s28, v12
    v_mfma_f32_16x16x32_bf16 v[228:231], v[132:135], v[22:25], v[228:231]
    ds_read_b64_tr_b16 v[124:125], v3 offset:20480
    v_fma_f32 v97, v97, s28, v12
    v_mfma_f32_16x16x32_bf16 a[20:23], v[132:135], v[28:31], a[20:23]
    ds_read_b64_tr_b16 v[128:129], v4 offset:20480
    v_fma_f32 v79, v79, s28, v9
    v_mfma_f32_16x16x32_bf16 a[68:71], v[132:135], v[34:37], a[68:71]
    s_waitcnt lgkmcnt(6)
    ds_read_b64_tr_b16 v[134:135], v5 offset:14336
    v_fma_f32 v95, v95, s28, v11
    v_mfma_f32_16x16x32_bf16 v[184:187], v[112:115], v[16:19], v[184:187]
    ds_read_b64_tr_b16 v[132:133], v5 offset:20480
    v_fma_f32 v82, v82, s28, v10
    v_mfma_f32_16x16x32_bf16 v[232:235], v[112:115], v[22:25], v[232:235]
    v_exp_f32 v91, v91
    v_mfma_f32_16x16x32_bf16 a[24:27], v[112:115], v[28:31], a[24:27]
    v_fma_f32 v89, v89, s28, v11
    v_fma_f32 v76, v76, s28, v9
    v_mfma_f32_16x16x32_bf16 a[72:75], v[112:115], v[34:37], a[72:75]
    v_exp_f32 v82, v82
    v_mfma_f32_16x16x32_bf16 v[188:191], v[116:119], v[16:19], v[188:191]
    v_exp_f32 v78, v78
    v_mfma_f32_16x16x32_bf16 v[236:239], v[116:119], v[22:25], v[236:239]
    ds_read_b128 v[144:147], v8 offset:2048
    v_exp_f32 v97, v97
    v_mfma_f32_16x16x32_bf16 a[28:31], v[116:119], v[28:31], a[28:31]
    v_exp_f32 v103, v103
    v_mfma_f32_16x16x32_bf16 a[76:79], v[116:119], v[34:37], a[76:79]
    s_waitcnt lgkmcnt(4)
    v_exp_f32 v99, v99
    v_mfma_f32_16x16x32_bf16 v[192:195], v[120:123], v[16:19], v[192:195]
    v_exp_f32 v90, v90
    v_mfma_f32_16x16x32_bf16 v[240:243], v[120:123], v[22:25], v[240:243]
    ds_read_b128 v[148:151], v8 offset:3072
    s_waitcnt vmcnt(12) lgkmcnt(2)
    v_mfma_f32_16x16x32_bf16 a[32:35], v[120:123], v[28:31], a[32:35]
    s_barrier
    v_mfma_f32_16x16x32_bf16 a[80:83], v[120:123], v[34:37], a[80:83]
    s_add_u32 m0, s22, 36864
    ds_read_b128 v[116:119], v1 offset:12288
    v_cvt_pk_bf16_f32 v21, v82, v83
    v_mfma_f32_16x16x32_bf16 v[196:199], v[124:127], v[16:19], v[196:199]
    ds_read_b128 v[112:115], v0 offset:12288
    v_fma_f32 v101, v101, s28, v12
    v_mfma_f32_16x16x32_bf16 v[244:247], v[124:127], v[22:25], v[244:247]
    buffer_load_dwordx4 v6, s[8:11], s21 offen lds
    v_mfma_f32_16x16x32_bf16 a[36:39], v[124:127], v[28:31], a[36:39]
    ds_read_b128 v[120:123], v0 offset:13312
    v_cvt_pk_bf16_f32 v32, v96, v97
    v_mfma_f32_16x16x32_bf16 a[84:87], v[124:127], v[34:37], a[84:87]
    v_exp_f32 v98, v98
    v_mfma_f32_16x16x32_bf16 v[200:203], v[128:131], v[16:19], v[200:203]
    s_add_u32 s21, s21, 128
    v_fma_f32 v94, v94, s28, v11
    v_fma_f32 v100, v100, s28, v12
    v_mfma_f32_16x16x32_bf16 v[248:251], v[128:131], v[22:25], v[248:251]
    s_add_u32 m0, s22, 37888
    v_exp_f32 v88, v88
    v_mfma_f32_16x16x32_bf16 a[40:43], v[128:131], v[28:31], a[40:43]
    ds_read_b128 v[124:127], v1 offset:13312
    v_cvt_pk_bf16_f32 v27, v90, v91
    v_mfma_f32_16x16x32_bf16 a[88:91], v[128:131], v[34:37], a[88:91]
    buffer_load_dwordx4 v6, s[8:11], s21 offen lds
    v_mfma_f32_16x16x32_bf16 v[204:207], v[132:135], v[16:19], v[204:207]
    s_add_u32 s21, s21, 128
    v_fma_f32 v102, v102, s28, v12
    v_mfma_f32_16x16x32_bf16 v[252:255], v[132:135], v[22:25], v[252:255]
    v_exp_f32 v89, v89
    v_mfma_f32_16x16x32_bf16 a[44:47], v[132:135], v[28:31], a[44:47]
    s_add_u32 m0, s22, 38912
    v_exp_f32 v79, v79
    v_mfma_f32_16x16x32_bf16 a[92:95], v[132:135], v[34:37], a[92:95]
    s_waitcnt lgkmcnt(2)
    v_exp_f32 v84, v84
    v_mfma_f32_16x16x32_bf16 v[72:75], v[112:115], a[144:147], 0
    buffer_load_dwordx4 v6, s[8:11], s21 offen lds
    v_mfma_f32_16x16x32_bf16 v[72:75], v[116:119], a[148:151], v[72:75]
    s_waitcnt lgkmcnt(1)
    v_exp_f32 v100, v100
    v_mfma_f32_16x16x32_bf16 v[72:75], v[120:123], a[152:155], v[72:75]
    s_add_u32 s21, s21, 12032
    v_exp_f32 v102, v102
    v_mfma_f32_16x16x32_bf16 v[80:83], v[112:115], a[168:171], 0
    v_cvt_pk_bf16_f32 v26, v88, v89
    v_fma_f32 v85, v85, s28, v10
    v_mfma_f32_16x16x32_bf16 v[80:83], v[116:119], a[172:175], v[80:83]
    s_add_u32 s56, s24, 5888
    ds_read_b128 v[128:131], v0 offset:14336
    v_cvt_pk_bf16_f32 v33, v98, v99
    v_mfma_f32_16x16x32_bf16 v[80:83], v[120:123], a[176:179], v[80:83]
    ds_read_b128 v[132:135], v1 offset:14336
    v_mfma_f32_16x16x32_bf16 v[88:91], v[112:115], a[192:195], 0
    buffer_store_dwordx4 v[144:147], v6, s[16:19], s56 offen sc0 sc1 nt
    s_add_u32 s58, s25, 5888
    s_add_u32 m0, s38, 24576
    v_cvt_pk_bf16_f32 v17, v78, v79
    v_exp_f32 v76, v76
    v_mfma_f32_16x16x32_bf16 v[88:91], v[116:119], a[196:199], v[88:91]
    v_exp_f32 v87, v87
    v_mfma_f32_16x16x32_bf16 v[88:91], v[120:123], a[200:203], v[88:91]
    buffer_load_dwordx4 v6, s[12:15], s58 offen nt lds
    v_mfma_f32_16x16x32_bf16 v[96:99], v[112:115], a[216:219], 0
    s_add_u32 m0, s38, 25600
    ds_read_b128 v[144:147], v8 offset:4096
    v_cvt_pk_bf16_f32 v16, v76, v77
    v_mfma_f32_16x16x32_bf16 v[96:99], v[116:119], a[220:223], v[96:99]
    buffer_load_dwordx4 v7, s[12:15], s58 offen nt lds
    v_mfma_f32_16x16x32_bf16 v[96:99], v[120:123], a[224:227], v[96:99]
    s_waitcnt lgkmcnt(3)
    v_exp_f32 v85, v85
    v_mfma_f32_16x16x32_bf16 v[72:75], v[124:127], a[156:159], v[72:75]
    buffer_store_dwordx4 v[148:151], v7, s[16:19], s56 offen sc0 sc1 nt
    s_add_u32 s57, s24, 6016
    ds_read_b128 v[148:151], v8 offset:5120
    v_fma_f32 v92, v92, s28, v11
    s_waitcnt lgkmcnt(2)
    v_mfma_f32_16x16x32_bf16 v[72:75], v[128:131], a[160:163], v[72:75]
    v_exp_f32 v95, v95
    v_mfma_f32_16x16x32_bf16 v[72:75], v[132:135], a[164:167], v[72:75]
    ds_read_b128 v[112:115], v0 offset:18432
    v_cvt_pk_bf16_f32 v23, v86, v87
    v_mfma_f32_16x16x32_bf16 v[80:83], v[124:127], a[180:183], v[80:83]
    s_add_u32 s59, s25, 6016
    v_exp_f32 v93, v93
    v_mfma_f32_16x16x32_bf16 v[80:83], v[128:131], a[184:187], v[80:83]
    s_add_u32 m0, s38, 26624
    v_mfma_f32_16x16x32_bf16 v[80:83], v[132:135], a[188:191], v[80:83]
    v_exp_f32 v101, v101
    v_mfma_f32_16x16x32_bf16 v[88:91], v[124:127], a[204:207], v[88:91]
    s_waitcnt lgkmcnt(2)
    ds_read_b128 v[116:119], v1 offset:18432
    buffer_load_dwordx4 v6, s[12:15], s59 offen nt lds
    v_mfma_f32_16x16x32_bf16 v[88:91], v[128:131], a[208:211], v[88:91]
    ds_read_b128 v[120:123], v0 offset:19456
    s_add_u32 m0, s38, 27648
    v_mfma_f32_16x16x32_bf16 v[88:91], v[132:135], a[212:215], v[88:91]
    buffer_store_dwordx4 v[144:147], v6, s[16:19], s57 offen sc0 sc1 nt
    v_exp_f32 v92, v92
    v_cvt_pk_bf16_f32 v22, v84, v85
    v_mfma_f32_16x16x32_bf16 v[96:99], v[124:127], a[228:231], v[96:99]
    ds_read_b128 v[124:127], v1 offset:19456
    v_cvt_pk_bf16_f32 v28, v92, v93
    v_mfma_f32_16x16x32_bf16 v[96:99], v[128:131], a[232:235], v[96:99]
    s_waitcnt lgkmcnt(4)
    ds_read_b128 v[144:147], v8 offset:0
    buffer_load_dwordx4 v7, s[12:15], s59 offen nt lds
    v_mfma_f32_16x16x32_bf16 v[96:99], v[132:135], a[236:239], v[96:99]
    buffer_store_dwordx4 v[148:151], v7, s[16:19], s57 offen sc0 sc1 nt
    s_nop 0
    ds_read_b128 v[148:151], v8 offset:1024
    v_exp_f32 v94, v94
    v_mfma_f32_16x16x32_bf16 v[44:47], v[52:55], v[14:17], v[48:51]
    ds_read_b128 v[128:131], v0 offset:20480
    v_cvt_pk_bf16_f32 v35, v102, v103
    v_mfma_f32_16x16x32_bf16 v[44:47], v[56:59], v[20:23], v[44:47]
    s_waitcnt lgkmcnt(5)
    ds_read_b128 v[132:135], v1 offset:20480
    v_cvt_pk_bf16_f32 v29, v94, v95
    v_mfma_f32_16x16x32_bf16 v[76:79], v[112:115], a[144:147], 0
    v_mfma_f32_16x16x32_bf16 v[76:79], v[116:119], a[148:151], v[76:79]
    v_cvt_pk_bf16_f32 v34, v100, v101
    v_mfma_f32_16x16x32_bf16 v[44:47], v[60:63], v[26:29], v[44:47]
    s_nop 0
    v_mfma_f32_16x16x32_bf16 v[44:47], v[64:67], v[32:35], v[44:47]
    s_add_u32 m0, s38, 22528
    s_waitcnt lgkmcnt(4)
    v_mfma_f32_16x16x32_bf16 v[76:79], v[120:123], a[152:155], v[76:79]
    s_waitcnt lgkmcnt(3)
    buffer_load_dwordx4 v6, s[12:15], s25 offen nt lds
    v_mfma_f32_16x16x32_bf16 v[84:87], v[112:115], a[168:171], 0
    s_add_u32 m0, s38, 23552
    s_nop 0
    v_cmp_lt_f32 vcc, s29, v44
    v_mfma_f32_16x16x32_bf16 v[84:87], v[116:119], a[172:175], v[84:87]
    s_waitcnt lgkmcnt(2)
    buffer_load_dwordx4 v7, s[12:15], s25 offen nt lds
    v_mfma_f32_16x16x32_bf16 v[84:87], v[120:123], a[176:179], v[84:87]
    buffer_store_dwordx4 v[144:147], v6, s[16:19], s24 offen sc0 sc1 nt
    s_waitcnt vmcnt(19) lgkmcnt(0)
    s_barrier
    v_mfma_f32_16x16x32_bf16 v[92:95], v[112:115], a[192:195], 0
    s_cbranch_vccnz L_rs_tr45a
L_ret_tr45a:
    v_fma_f32 v73, v73, s28, v9
    v_mfma_f32_16x16x32_bf16 v[92:95], v[116:119], a[196:199], v[92:95]
    v_fma_f32 v72, v72, s28, v9
    v_mfma_f32_16x16x32_bf16 v[92:95], v[120:123], a[200:203], v[92:95]
    v_exp_f32 v72, v72
    v_mfma_f32_16x16x32_bf16 v[100:103], v[112:115], a[216:219], 0
    s_add_u32 m0, s22, 12288
    ds_read_b64_tr_b16 v[112:113], v2 offset:0
    v_fma_f32 v80, v80, s28, v10
    v_mfma_f32_16x16x32_bf16 v[100:103], v[116:119], a[220:223], v[100:103]
    buffer_load_dwordx4 v6, s[4:7], s20 offen lds
    v_mfma_f32_16x16x32_bf16 v[100:103], v[120:123], a[224:227], v[100:103]
    s_add_u32 s20, s20, 128
    ds_read_b64_tr_b16 v[114:115], v2 offset:6144
    v_fma_f32 v81, v81, s28, v10
    v_mfma_f32_16x16x32_bf16 v[76:79], v[124:127], a[156:159], v[76:79]
    v_exp_f32 v80, v80
    v_mfma_f32_16x16x32_bf16 v[76:79], v[128:131], a[160:163], v[76:79]
    v_exp_f32 v73, v73
    v_mfma_f32_16x16x32_bf16 v[76:79], v[132:135], a[164:167], v[76:79]
    s_add_u32 m0, s22, 13312
    v_exp_f32 v81, v81
    v_mfma_f32_16x16x32_bf16 v[84:87], v[124:127], a[180:183], v[84:87]
    buffer_load_dwordx4 v6, s[4:7], s20 offen lds
    v_mfma_f32_16x16x32_bf16 v[84:87], v[128:131], a[184:187], v[84:87]
    ds_read_b64_tr_b16 v[116:117], v3 offset:0
    v_cvt_pk_bf16_f32 v24, v80, v81
    v_mfma_f32_16x16x32_bf16 v[84:87], v[132:135], a[188:191], v[84:87]
    s_add_u32 s20, s20, 128
    ds_read_b64_tr_b16 v[118:119], v3 offset:6144
    v_fma_f32 v75, v75, s28, v9
    v_mfma_f32_16x16x32_bf16 v[92:95], v[124:127], a[204:207], v[92:95]
    v_exp_f32 v75, v75
    v_mfma_f32_16x16x32_bf16 v[92:95], v[128:131], a[208:211], v[92:95]
    s_add_u32 m0, s22, 14336
    ds_read_b64_tr_b16 v[120:121], v4 offset:0
    v_fma_f32 v74, v74, s28, v9
    v_mfma_f32_16x16x32_bf16 v[92:95], v[132:135], a[212:215], v[92:95]
    buffer_load_dwordx4 v6, s[4:7], s20 offen lds
    v_mfma_f32_16x16x32_bf16 v[100:103], v[124:127], a[228:231], v[100:103]
    buffer_store_dwordx4 v[148:151], v7, s[16:19], s24 offen sc0 sc1 nt
    ds_read_b64_tr_b16 v[122:123], v4 offset:6144
    v_exp_f32 v74, v74
    v_mfma_f32_16x16x32_bf16 v[100:103], v[128:131], a[232:235], v[100:103]
    ds_read_b64_tr_b16 v[124:125], v5 offset:0
    v_cvt_pk_bf16_f32 v18, v72, v73
    v_mfma_f32_16x16x32_bf16 v[100:103], v[132:135], a[236:239], v[100:103]
    s_add_u32 s20, s20, 12032
    ds_read_b64_tr_b16 v[126:127], v5 offset:6144
    v_cvt_pk_bf16_f32 v19, v74, v75
    ds_read_b64_tr_b16 v[132:133], v3 offset:1024
    v_lshrrev_b32 v153, 11, v0
    s_waitcnt lgkmcnt(7)
    v_mfma_f32_16x16x32_bf16 v[160:163], v[112:115], v[14:17], v[160:163]
    v_fma_f32 v79, v79, s28, v9
    v_mfma_f32_16x16x32_bf16 v[208:211], v[112:115], v[20:23], v[208:211]
    ds_read_b64_tr_b16 v[130:131], v2 offset:7168
    v_fma_f32 v101, v101, s28, v12
    v_mfma_f32_16x16x32_bf16 a[0:3], v[112:115], v[26:29], a[0:3]
    v_fma_f32 v89, v89, s28, v11
    v_fma_f32 v95, v95, s28, v11
    v_mfma_f32_16x16x32_bf16 a[48:51], v[112:115], v[32:35], a[48:51]
    s_waitcnt lgkmcnt(6)
    v_and_b32 v152, 0x3ff, v0
    v_fma_f32 v96, v96, s28, v12
    v_mfma_f32_16x16x32_bf16 v[164:167], v[116:119], v[14:17], v[164:167]
    ds_read_b64_tr_b16 v[134:135], v3 offset:7168
    v_fma_f32 v91, v91, s28, v11
    v_mfma_f32_16x16x32_bf16 v[212:215], v[116:119], v[20:23], v[212:215]
    ds_read_b64_tr_b16 v[128:129], v2 offset:1024
    v_xor_b32 v153, s65, v153
    v_mfma_f32_16x16x32_bf16 a[4:7], v[116:119], v[26:29], a[4:7]
    ds_read_b64_tr_b16 v[112:113], v4 offset:1024
    v_lshl_add_u32 v152, v153, 10, v152
    v_mfma_f32_16x16x32_bf16 a[52:55], v[116:119], v[32:35], a[52:55]
    s_waitcnt lgkmcnt(7)
    v_fma_f32 v93, v93, s28, v11
    v_add_u32 v152, s38, v152
    v_mfma_f32_16x16x32_bf16 v[168:171], v[120:123], v[14:17], v[168:171]
    ds_read_b64_tr_b16 v[114:115], v4 offset:7168
    v_fma_f32 v82, v82, s28, v10
    v_mfma_f32_16x16x32_bf16 v[216:219], v[120:123], v[20:23], v[216:219]
    ds_read_b128 a[168:171], v152 offset:6144
    v_fma_f32 v98, v98, s28, v12
    v_mfma_f32_16x16x32_bf16 a[8:11], v[120:123], v[26:29], a[8:11]
    ds_read_b128 a[192:195], v152 offset:12288
    v_fma_f32 v99, v99, s28, v12
    v_mfma_f32_16x16x32_bf16 a[56:59], v[120:123], v[32:35], a[56:59]
    s_waitcnt lgkmcnt(6)
    ds_read_b64_tr_b16 v[122:123], v2 offset:8192
    v_xor_b32 v153, 64, v152
    v_mfma_f32_16x16x32_bf16 v[172:175], v[124:127], v[14:17], v[172:175]
    ds_read_b128 a[148:151], v153 offset:0
    v_fma_f32 v86, v86, s28, v10
    v_mfma_f32_16x16x32_bf16 v[220:223], v[124:127], v[20:23], v[220:223]
    ds_read_b64_tr_b16 v[116:117], v5 offset:1024
    v_exp_f32 v98, v98
    v_mfma_f32_16x16x32_bf16 a[12:15], v[124:127], v[26:29], a[12:15]
    v_exp_f32 v96, v96
    v_mfma_f32_16x16x32_bf16 a[60:63], v[124:127], v[32:35], a[60:63]
    s_waitcnt lgkmcnt(7)
    ds_read_b64_tr_b16 v[120:121], v2 offset:2048
    v_fma_f32 v77, v77, s28, v9
    v_mfma_f32_16x16x32_bf16 v[176:179], v[128:131], v[14:17], v[176:179]
    ds_read_b64_tr_b16 v[118:119], v5 offset:7168
    v_fma_f32 v97, v97, s28, v12
    v_mfma_f32_16x16x32_bf16 v[224:227], v[128:131], v[20:23], v[224:227]
    v_exp_f32 v99, v99
    v_mfma_f32_16x16x32_bf16 a[16:19], v[128:131], v[26:29], a[16:19]
    v_exp_f32 v97, v97
    v_mfma_f32_16x16x32_bf16 a[64:67], v[128:131], v[32:35], a[64:67]
    ds_read_b64_tr_b16 v[128:129], v4 offset:2048
    v_fma_f32 v76, v76, s28, v9
    v_mfma_f32_16x16x32_bf16 v[180:183], v[132:135], v[14:17], v[180:183]
    ds_read_b64_tr_b16 v[130:131], v4 offset:8192
    v_mfma_f32_16x16x32_bf16 v[228:231], v[132:135], v[20:23], v[228:231]
    ds_read_b64_tr_b16 v[126:127], v3 offset:8192
    v_fma_f32 v90, v90, s28, v11
    v_mfma_f32_16x16x32_bf16 a[20:23], v[132:135], v[26:29], a[20:23]
    ds_read_b64_tr_b16 v[124:125], v3 offset:2048
    v_fma_f32 v85, v85, s28, v10
    v_mfma_f32_16x16x32_bf16 a[68:71], v[132:135], v[32:35], a[68:71]
    s_waitcnt lgkmcnt(6)
    ds_read_b64_tr_b16 v[134:135], v5 offset:8192
    v_cvt_pk_bf16_f32 v36, v96, v97
    v_mfma_f32_16x16x32_bf16 v[184:187], v[112:115], v[14:17], v[184:187]
    ds_read_b64_tr_b16 v[132:133], v5 offset:2048
    v_fma_f32 v102, v102, s28, v12
    v_mfma_f32_16x16x32_bf16 v[232:235], v[112:115], v[20:23], v[232:235]
    v_exp_f32 v89, v89
    v_mfma_f32_16x16x32_bf16 a[24:27], v[112:115], v[26:29], a[24:27]
    v_exp_f32 v102, v102
    v_mfma_f32_16x16x32_bf16 a[72:75], v[112:115], v[32:35], a[72:75]
    s_waitcnt lgkmcnt(6)
    v_exp_f32 v90, v90
    v_mfma_f32_16x16x32_bf16 v[188:191], v[116:119], v[14:17], v[188:191]
    ds_read_b128 a[152:155], v152 offset:2048
    v_fma_f32 v92, v92, s28, v11
    v_exp_f32 v82, v82
    v_mfma_f32_16x16x32_bf16 v[236:239], v[116:119], v[20:23], v[236:239]
    ds_read_b128 a[196:199], v153 offset:12288
    v_fma_f32 v87, v87, s28, v10
    v_mfma_f32_16x16x32_bf16 a[28:31], v[116:119], v[26:29], a[28:31]
    ds_read_b128 a[204:207], v153 offset:14336
    v_fma_f32 v94, v94, s28, v11
    v_mfma_f32_16x16x32_bf16 a[76:79], v[116:119], v[32:35], a[76:79]
    ds_read_b128 a[176:179], v152 offset:8192
    v_fma_f32 v88, v88, s28, v11
    v_mfma_f32_16x16x32_bf16 v[192:195], v[120:123], v[14:17], v[192:195]
    s_add_u32 s39, s39, 12288
    ds_read_b128 a[156:159], v153 offset:2048
    v_exp_f32 v91, v91
    v_mfma_f32_16x16x32_bf16 v[240:243], v[120:123], v[20:23], v[240:243]
    s_waitcnt vmcnt(20) lgkmcnt(5)
    ds_read_b128 a[224:227], v152 offset:20480
    v_cvt_pk_bf16_f32 v37, v98, v99
    v_mfma_f32_16x16x32_bf16 a[32:35], v[120:123], v[26:29], a[32:35]
    s_barrier
    v_mfma_f32_16x16x32_bf16 a[80:83], v[120:123], v[32:35], a[80:83]
    s_add_u32 s21, s21, s62
    ds_read_b128 v[120:123], v0 offset:1024
    v_fma_f32 v78, v78, s28, v9
    v_mfma_f32_16x16x32_bf16 v[196:199], v[124:127], v[14:17], v[196:199]
    s_add_u32 m0, s22, 24576
    ds_read_b128 a[216:219], v152 offset:18432
    buffer_load_dwordx4 v6, s[8:11], s21 offen lds
    v_mfma_f32_16x16x32_bf16 v[244:247], v[124:127], v[20:23], v[244:247]
    s_add_u32 s21, s21, 128
    ds_read_b128 a[144:147], v152 offset:0
    v_fma_f32 v83, v83, s28, v10
    v_mfma_f32_16x16x32_bf16 a[36:39], v[124:127], v[26:29], a[36:39]
    s_add_u32 m0, s22, 25600
    ds_read_b128 v[112:115], v0 offset:0
    buffer_load_dwordx4 v6, s[8:11], s21 offen lds
    v_mfma_f32_16x16x32_bf16 a[84:87], v[124:127], v[32:35], a[84:87]
    s_add_u32 s21, s21, 128
    ds_read_b128 v[116:119], v1 offset:0
    v_exp_f32 v83, v83
    v_mfma_f32_16x16x32_bf16 v[200:203], v[128:131], v[14:17], v[200:203]
    ds_read_b128 a[180:183], v153 offset:8192
    v_cvt_pk_bf16_f32 v31, v90, v91
    v_mfma_f32_16x16x32_bf16 v[248:251], v[128:131], v[20:23], v[248:251]
    s_add_u32 m0, s22, 26624
    ds_read_b128 a[220:223], v153 offset:18432
    buffer_load_dwordx4 v6, s[8:11], s21 offen lds
    v_mfma_f32_16x16x32_bf16 a[40:43], v[128:131], v[26:29], a[40:43]
    ds_read_b128 a[200:203], v152 offset:14336
    s_add_u32 s21, s21, 12032
    v_mfma_f32_16x16x32_bf16 a[88:91], v[128:131], v[32:35], a[88:91]
    s_waitcnt vmcnt(15)
    ds_read_b128 a[240:243], v152 offset:24576
    v_fma_f32 v100, v100, s28, v12
    v_mfma_f32_16x16x32_bf16 v[204:207], v[132:135], v[14:17], v[204:207]
    s_waitcnt vmcnt(11)
    ds_read_b128 a[172:175], v153 offset:6144
    v_exp_f32 v95, v95
    v_mfma_f32_16x16x32_bf16 v[252:255], v[132:135], v[20:23], v[252:255]
    v_exp_f32 v88, v88
    v_mfma_f32_16x16x32_bf16 a[44:47], v[132:135], v[26:29], a[44:47]
    ds_read_b128 a[244:247], v153 offset:24576
    v_cvt_pk_bf16_f32 v25, v82, v83
    v_mfma_f32_16x16x32_bf16 a[92:95], v[132:135], v[32:35], a[92:95]
    s_waitcnt lgkmcnt(7)
    ds_read_b128 a[228:231], v153 offset:20480
    v_cvt_pk_bf16_f32 v30, v88, v89
    v_mfma_f32_16x16x32_bf16 v[72:75], v[112:115], a[144:147], 0
    ds_read_b128 a[252:255], v153 offset:26624
    v_exp_f32 v86, v86
    v_mfma_f32_16x16x32_bf16 v[80:83], v[112:115], a[168:171], 0
    ds_read_b128 v[124:127], v1 offset:1024
    v_exp_f32 v100, v100
    v_mfma_f32_16x16x32_bf16 v[88:91], v[112:115], a[192:195], 0
    ds_read_b128 v[132:135], v1 offset:6144
    v_exp_f32 v85, v85
    v_mfma_f32_16x16x32_bf16 v[96:99], v[112:115], a[216:219], 0
    ds_read_b128 a[248:251], v152 offset:26624
    s_waitcnt lgkmcnt(7)
    v_mfma_f32_16x16x32_bf16 v[104:107], v[112:115], a[240:243], 0
    v_fma_f32 v103, v103, s28, v12
    v_mfma_f32_16x16x32_bf16 v[72:75], v[116:119], a[148:151], v[72:75]
    s_waitcnt lgkmcnt(6)
    v_exp_f32 v87, v87
    v_mfma_f32_16x16x32_bf16 v[80:83], v[116:119], a[172:175], v[80:83]
    v_exp_f32 v79, v79
    v_mfma_f32_16x16x32_bf16 v[88:91], v[116:119], a[196:199], v[88:91]
    ds_read_b128 v[128:131], v0 offset:6144
    v_fma_f32 v84, v84, s28, v10
    v_mfma_f32_16x16x32_bf16 v[96:99], v[116:119], a[220:223], v[96:99]
    s_waitcnt lgkmcnt(5)
    v_exp_f32 v103, v103
    v_mfma_f32_16x16x32_bf16 v[104:107], v[116:119], a[244:247], v[104:107]
    v_exp_f32 v94, v94
    v_mfma_f32_16x16x32_bf16 v[72:75], v[120:123], a[152:155], v[72:75]
    v_exp_f32 v78, v78
    v_mfma_f32_16x16x32_bf16 v[80:83], v[120:123], a[176:179], v[80:83]
    v_exp_f32 v93, v93
    v_mfma_f32_16x16x32_bf16 v[88:91], v[120:123], a[200:203], v[88:91]
    v_exp_f32 v92, v92
    v_mfma_f32_16x16x32_bf16 v[96:99], v[120:123], a[224:227], v[96:99]
    s_waitcnt lgkmcnt(1)
    v_cvt_pk_bf16_f32 v17, v78, v79
    v_mfma_f32_16x16x32_bf16 v[104:107], v[120:123], a[248:251], v[104:107]
    v_exp_f32 v84, v84
    v_mfma_f32_16x16x32_bf16 v[72:75], v[124:127], a[156:159], v[72:75]
    v_exp_f32 v101, v101
    v_mfma_f32_16x16x32_bf16 v[80:83], v[124:127], a[180:183], v[80:83]
    v_exp_f32 v77, v77
    v_mfma_f32_16x16x32_bf16 v[88:91], v[124:127], a[204:207], v[88:91]
    v_exp_f32 v76, v76
    v_mfma_f32_16x16x32_bf16 v[96:99], v[124:127], a[228:231], v[96:99]
    ds_read_b128 v[112:115], v0 offset:7168
    v_cvt_pk_bf16_f32 v22, v84, v85
    v_mfma_f32_16x16x32_bf16 v[104:107], v[124:127], a[252:255], v[104:107]
    s_waitcnt lgkmcnt(1)
    v_cvt_pk_bf16_f32 v35, v102, v103
    v_cvt_pk_bf16_f32 v16, v76, v77
    v_mfma_f32_16x16x32_bf16 v[76:79], v[128:131], a[144:147], 0
    s_waitcnt vmcnt(8)
    ds_read_b128 a[232:235], v152 offset:22528
    v_cvt_pk_bf16_f32 v28, v92, v93
    v_mfma_f32_16x16x32_bf16 v[48:51], v[52:55], v[16:19], v[44:47]
    v_cvt_pk_bf16_f32 v34, v100, v101
    v_cvt_pk_bf16_f32 v23, v86, v87
    v_mfma_f32_16x16x32_bf16 v[84:87], v[128:131], a[168:171], 0
    ds_read_b128 v[116:119], v1 offset:7168
    v_cvt_pk_bf16_f32 v29, v94, v95
    v_mfma_f32_16x16x32_bf16 v[92:95], v[128:131], a[192:195], 0
    ds_read_b128 v[124:127], v1 offset:2048
    v_mfma_f32_16x16x32_bf16 v[100:103], v[128:131], a[216:219], 0
    ds_read_b128 a[208:211], v152 offset:16384
    v_mfma_f32_16x16x32_bf16 v[108:111], v[128:131], a[240:243], 0
    v_mfma_f32_16x16x32_bf16 v[76:79], v[132:135], a[148:151], v[76:79]
    ds_read_b128 v[128:131], v0 offset:8192
    v_mfma_f32_16x16x32_bf16 v[84:87], v[132:135], a[172:175], v[84:87]
    v_mfma_f32_16x16x32_bf16 v[92:95], v[132:135], a[196:199], v[92:95]
    ds_read_b128 v[120:123], v0 offset:2048
    v_mfma_f32_16x16x32_bf16 v[100:103], v[132:135], a[220:223], v[100:103]
    ds_read_b128 a[188:191], v153 offset:10240
    v_mfma_f32_16x16x32_bf16 v[108:111], v[132:135], a[244:247], v[108:111]
    s_waitcnt lgkmcnt(6)
    ds_read_b128 v[132:135], v1 offset:8192
    v_mfma_f32_16x16x32_bf16 v[76:79], v[112:115], a[152:155], v[76:79]
    ds_read_b128 a[184:187], v152 offset:10240
    v_mfma_f32_16x16x32_bf16 v[48:51], v[56:59], v[22:25], v[48:51]
    v_mfma_f32_16x16x32_bf16 v[48:51], v[60:63], v[28:31], v[48:51]
    ds_read_b128 a[160:163], v152 offset:4096
    v_mfma_f32_16x16x32_bf16 v[84:87], v[112:115], a[176:179], v[84:87]
    v_mfma_f32_16x16x32_bf16 v[92:95], v[112:115], a[200:203], v[92:95]
    ds_read_b128 a[164:167], v153 offset:4096
    v_mfma_f32_16x16x32_bf16 v[100:103], v[112:115], a[224:227], v[100:103]
    v_mfma_f32_16x16x32_bf16 v[48:51], v[64:67], v[34:37], v[48:51]
    ds_read_b128 a[212:215], v153 offset:16384
    v_mfma_f32_16x16x32_bf16 v[108:111], v[112:115], a[248:251], v[108:111]
    s_waitcnt lgkmcnt(6)
    ds_read_b128 a[236:239], v153 offset:22528
    v_mfma_f32_16x16x32_bf16 v[76:79], v[116:119], a[156:159], v[76:79]
    v_mfma_f32_16x16x32_bf16 v[84:87], v[116:119], a[180:183], v[84:87]
    s_waitcnt vmcnt(21)
    s_waitcnt vmcnt(18) lgkmcnt(5)
    v_cmp_lt_f32 vcc, s29, v48
    v_mfma_f32_16x16x32_bf16 v[92:95], v[116:119], a[204:207], v[92:95]
    s_barrier
    v_mfma_f32_16x16x32_bf16 v[100:103], v[116:119], a[228:231], v[100:103]
    ds_read_b64_tr_b16 v[112:113], v2 offset:18432
    v_mfma_f32_16x16x32_bf16 v[108:111], v[116:119], a[252:255], v[108:111]
    s_waitcnt lgkmcnt(4)
    ds_read_b64_tr_b16 v[114:115], v2 offset:12288
    v_mfma_f32_16x16x32_bf16 v[72:75], v[120:123], a[160:163], v[72:75]
    v_mfma_f32_16x16x32_bf16 v[80:83], v[120:123], a[184:187], v[80:83]
    ds_read_b64_tr_b16 v[116:117], v3 offset:18432
    v_mfma_f32_16x16x32_bf16 v[88:91], v[120:123], a[208:211], v[88:91]
    v_mfma_f32_16x16x32_bf16 v[96:99], v[120:123], a[232:235], v[96:99]
    s_cbranch_vccnz L_rs_tr45b
L_ret_tr45b:
    v_mfma_f32_16x16x32_bf16 v[104:107], v[120:123], v[136:139], v[104:107]
    s_waitcnt lgkmcnt(3)
    ds_read_b64_tr_b16 v[118:119], v3 offset:12288
    v_mfma_f32_16x16x32_bf16 v[72:75], v[124:127], a[164:167], v[72:75]
    s_add_u32 m0, s22, 0
    v_mfma_f32_16x16x32_bf16 v[80:83], v[124:127], a[188:191], v[80:83]
    v_mfma_f32_16x16x32_bf16 v[88:91], v[124:127], a[212:215], v[88:91]
    buffer_load_dwordx4 v6, s[4:7], s20 offen lds
    v_mfma_f32_16x16x32_bf16 v[96:99], v[124:127], a[236:239], v[96:99]
    s_add_u32 s20, s20, 128
    s_add_u32 m0, s22, 1024
    ds_read_b64_tr_b16 v[120:121], v4 offset:18432
    v_mfma_f32_16x16x32_bf16 v[104:107], v[124:127], v[140:143], v[104:107]
    buffer_load_dwordx4 v6, s[4:7], s20 offen lds
    v_mfma_f32_16x16x32_bf16 v[76:79], v[128:131], a[160:163], v[76:79]
    ds_read_b64_tr_b16 v[122:123], v4 offset:12288
    v_mfma_f32_16x16x32_bf16 v[84:87], v[128:131], a[184:187], v[84:87]
    s_add_u32 s20, s20, 128
    ds_read_b64_tr_b16 v[124:125], v5 offset:18432
    s_add_u32 m0, s22, 2048
    v_mfma_f32_16x16x32_bf16 v[92:95], v[128:131], a[208:211], v[92:95]
    buffer_load_dwordx4 v6, s[4:7], s20 offen lds
    v_mfma_f32_16x16x32_bf16 v[100:103], v[128:131], a[232:235], v[100:103]
    s_add_u32 s20, s20, 12032
    v_mfma_f32_16x16x32_bf16 v[108:111], v[128:131], v[136:139], v[108:111]
    v_mfma_f32_16x16x32_bf16 v[76:79], v[132:135], a[164:167], v[76:79]
    v_mfma_f32_16x16x32_bf16 v[84:87], v[132:135], a[188:191], v[84:87]
    v_mfma_f32_16x16x32_bf16 v[92:95], v[132:135], a[212:215], v[92:95]
    v_mfma_f32_16x16x32_bf16 v[100:103], v[132:135], a[236:239], v[100:103]
    ds_read_b64_tr_b16 v[126:127], v5 offset:12288
    v_mfma_f32_16x16x32_bf16 v[108:111], v[132:135], v[140:143], v[108:111]
    v_max3_f32 v150, v72, v73, v74
    s_nop 1
    v_max3_f32 v150, v150, v75, v76
    v_max3_f32 v150, v150, v77, v78
    v_max_f32 v150, v150, v79
    v_mov_b32 v151, v150
    s_waitcnt lgkmcnt(6)
    v_mfma_f32_16x16x32_bf16 v[160:163], v[112:115], v[16:19], v[160:163]
    s_mov_b32 s67, s34
    v_permlane32_swap_b32 v151, v150
    v_mov_b32 v148, v48
    v_max_f32 v150, v150, v151
    v_mov_b32 v151, v150
    v_mfma_f32_16x16x32_bf16 v[208:211], v[112:115], v[22:25], v[208:211]
    s_add_u32 s18, s34, 24576
    ds_read_b64_tr_b16 v[134:135], v3 offset:13312
    v_permlane16_swap_b32 v151, v150
    v_max_f32 v150, v150, v151
    v_mfma_f32_16x16x32_bf16 a[0:3], v[112:115], v[28:31], a[0:3]
    ds_read_b64_tr_b16 v[128:129], v2 offset:19456
    v_mul_f32_e64 v9, -s28, v150
    v_mfma_f32_16x16x32_bf16 a[48:51], v[112:115], v[34:37], a[48:51]
    s_waitcnt lgkmcnt(6)
    v_max3_f32 v150, v80, v81, v82
    v_rcp_f32 v49, v49
    v_mfma_f32_16x16x32_bf16 v[164:167], v[116:119], v[16:19], v[164:167]
    ds_read_b64_tr_b16 v[114:115], v4 offset:13312
    v_max3_f32 v150, v150, v83, v84
    v_max3_f32 v150, v150, v85, v86
    v_max_f32 v150, v150, v87
    v_mfma_f32_16x16x32_bf16 v[212:215], v[116:119], v[22:25], v[212:215]
    s_mov_b32 s34, s33
    v_mov_b32 v151, v150
    v_fma_f32 v75, v75, s28, v9
    v_accvgpr_read_b32 v157, a49
    v_permlane32_swap_b32 v151, v150
    v_max_f32 v150, v150, v151
    v_fma_f32 v72, v72, s28, v9
    v_mov_b32 v151, v150
    v_mfma_f32_16x16x32_bf16 a[4:7], v[116:119], v[28:31], a[4:7]
    s_add_u32 s64, s64, s62
    v_and_b32 v149, 0x3ff, v0
    v_fma_f32 v77, v77, s28, v9
    v_mfma_f32_16x16x32_bf16 a[52:55], v[116:119], v[34:37], a[52:55]
    s_waitcnt lgkmcnt(3)
    ds_read_b64_tr_b16 v[116:117], v5 offset:19456
    v_accvgpr_read_b32 v156, a48
    v_fma_f32 v74, v74, s28, v9
    v_mfma_f32_16x16x32_bf16 v[168:171], v[120:123], v[16:19], v[168:171]
    s_add_u32 s64, s64, 196608
    v_permlane16_swap_b32 v151, v150
    v_max_f32 v150, v150, v151
    v_mul_f32_e64 v10, -s28, v150
    v_fma_f32 v78, v78, s28, v9
    v_mfma_f32_16x16x32_bf16 v[216:219], v[120:123], v[22:25], v[216:219]
    ds_read_b64_tr_b16 v[130:131], v2 offset:13312
    v_accvgpr_read_b32 v159, a51
    v_rcp_f32 v50, v50
    v_lshrrev_b32 v152, 11, v0
    v_fma_f32 v79, v79, s28, v9
    v_accvgpr_read_b32 v154, a2
    v_max3_f32 v150, v88, v89, v90
    v_subrev_u32 v8, 22528, v8
    v_max3_f32 v150, v150, v91, v92
    v_rcp_f32 v51, v51
    v_mul_f32 v210, v210, v49
    v_max3_f32 v150, v150, v93, v94
    v_max_f32 v150, v150, v95
    v_mov_b32 v151, v150
    v_mfma_f32_16x16x32_bf16 a[8:11], v[120:123], v[28:31], a[8:11]
    s_mov_b32 s39, s64
    ds_read_b64_tr_b16 v[112:113], v4 offset:19456
    v_permlane32_swap_b32 v151, v150
    v_xor_b32 v152, s65, v152
    v_permlane32_swap_b32 v48, v148
    v_max_f32 v150, v150, v151
    v_mov_b32 v151, v150
    v_mfma_f32_16x16x32_bf16 a[56:59], v[120:123], v[34:37], a[56:59]
    s_add_u32 s37, s37, 1
    ds_read_b64_tr_b16 v[132:133], v3 offset:19456
    v_permlane16_swap_b32 v151, v150
    v_max_f32 v150, v150, v151
    v_mul_f32_e64 v11, -s28, v150
    v_mfma_f32_16x16x32_bf16 v[172:175], v[124:127], v[16:19], v[172:175]
    s_bitcmp1_b32 s63, s37
    ds_read_b64_tr_b16 v[118:119], v5 offset:13312
    v_max3_f32 v150, v96, v97, v98
    v_mfma_f32_16x16x32_bf16 v[220:223], v[124:127], v[22:25], v[220:223]
    s_cselect_b32 s62, 4294770688, 0
    v_exp_f32 v72, v72
    v_mfma_f32_16x16x32_bf16 a[12:15], v[124:127], v[28:31], a[12:15]
    s_cselect_b32 s42, 0, 325632
    v_max3_f32 v150, v150, v99, v100
    v_max3_f32 v150, v150, v101, v102
    v_fma_f32 v76, v76, s28, v9
    v_max_f32 v150, v150, v103
    v_mov_b32 v151, v150
    v_mfma_f32_16x16x32_bf16 a[60:63], v[124:127], v[34:37], a[60:63]
    s_waitcnt lgkmcnt(3)
    v_lshl_add_u32 v149, v152, 10, v149
    v_accvgpr_read_b32 v155, a3
    v_mfma_f32_16x16x32_bf16 v[176:179], v[128:131], v[16:19], v[176:179]
    s_add_u32 s35, s35, s42
    v_permlane32_swap_b32 v151, v150
    v_accvgpr_read_b32 v158, a50
    v_mbcnt_lo_u32_b32 v152, -1, 0
    v_max_f32 v150, v150, v151
    v_mfma_f32_16x16x32_bf16 v[224:227], v[128:131], v[22:25], v[224:227]
    s_lshl_b32 s42, s37, 1
    v_mov_b32 v151, v150
    v_fma_f32 v94, v94, s28, v11
    v_fma_f32 v85, v85, s28, v10
    v_exp_f32 v79, v79
    v_mfma_f32_16x16x32_bf16 a[16:19], v[128:131], v[28:31], a[16:19]
    s_lshr_b32 s42, s31, s42
    ds_read_b64_tr_b16 v[122:123], v2 offset:14336
    v_permlane16_swap_b32 v151, v150
    v_accvgpr_read_b32 v153, a1
    v_max_f32 v150, v150, v151
    v_mfma_f32_16x16x32_bf16 a[64:67], v[128:131], v[34:37], a[64:67]
    s_and_b32 s42, s42, 3
    v_exp_f32 v75, v75
    v_mul_f32_e64 v12, -s28, v150
    v_fma_f32 v73, v73, s28, v9
    v_max3_f32 v150, v104, v105, v106
    v_fma_f32 v92, v92, s28, v11
    s_waitcnt lgkmcnt(1)
    v_mfma_f32_16x16x32_bf16 v[180:183], v[132:135], v[16:19], v[180:183]
    s_add_u32 s42, s42, s36
    ds_read_b64_tr_b16 v[120:121], v2 offset:20480
    v_fma_f32 v98, v98, s28, v12
    v_max3_f32 v150, v150, v107, v108
    v_fma_f32 v89, v89, s28, v11
    v_mfma_f32_16x16x32_bf16 v[228:231], v[132:135], v[22:25], v[228:231]
    s_sub_u32 s43, s42, 3
    ds_read_b64_tr_b16 v[130:131], v4 offset:14336
    s_cmp_ge_u32 s42, 3
    v_mfma_f32_16x16x32_bf16 a[20:23], v[132:135], v[28:31], a[20:23]
    s_cselect_b32 s42, s43, s42
    ds_read_b64_tr_b16 v[124:125], v3 offset:20480
    v_max3_f32 v150, v150, v109, v110
    v_fma_f32 v88, v88, s28, v11
    v_fma_f32 v80, v80, s28, v10
    v_fma_f32 v99, v99, s28, v12
    v_mfma_f32_16x16x32_bf16 a[68:71], v[132:135], v[34:37], a[68:71]
    s_mul_i32 s44, s3, 5
    ds_read_b64_tr_b16 v[128:129], v4 offset:20480
    v_fma_f32 v82, v82, s28, v10
    s_mov_b32 s32, 1
    v_max_f32 v150, v150, v111
    v_mfma_f32_16x16x32_bf16 v[184:187], v[112:115], v[16:19], v[184:187]
    s_lshl_b32 s43, s3, 2
    ds_read_b64_tr_b16 v[126:127], v3 offset:14336
    v_fma_f32 v93, v93, s28, v11
    v_mfma_f32_16x16x32_bf16 v[232:235], v[112:115], v[22:25], v[232:235]
    s_add_u32 s45, s43, 21
    v_add_u32 v149, s38, v149
    v_fma_f32 v81, v81, s28, v10
    v_mfma_f32_16x16x32_bf16 a[24:27], v[112:115], v[28:31], a[24:27]
    s_cmp_eq_u32 s3, 0
    v_mov_b32 v151, v150
    v_mul_f32 v225, v225, v49
    v_mul_f32 v156, v156, v51
    v_mfma_f32_16x16x32_bf16 a[72:75], v[112:115], v[34:37], a[72:75]
    s_cselect_b32 s45, 20, s45
    ds_read_b64_tr_b16 v[134:135], v5 offset:14336
    s_cselect_b32 s33, 1, 0
    v_mfma_f32_16x16x32_bf16 v[188:191], v[116:119], v[16:19], v[188:191]
    s_cmp_eq_u32 s42, 1
    v_mul_f32 v212, v212, v49
    v_mul_f32 v159, v159, v51
    v_mfma_f32_16x16x32_bf16 v[236:239], v[116:119], v[22:25], v[236:239]
    s_cselect_b32 s44, s45, s44
    v_permlane32_swap_b32 v151, v150
    v_fma_f32 v96, v96, s28, v12
    v_mfma_f32_16x16x32_bf16 a[28:31], v[116:119], v[28:31], a[28:31]
    s_cselect_b32 s32, s33, s32
    ds_read_b64_tr_b16 v[132:133], v5 offset:20480
    s_add_u32 s45, s43, 37
    v_max_f32 v150, v150, v151
    v_exp_f32 v96, v96
    v_mfma_f32_16x16x32_bf16 a[76:79], v[116:119], v[34:37], a[76:79]
    s_cmp_eq_u32 s42, 2
    v_exp_f32 v76, v76
    v_rcp_f32 v48, v48
    v_fma_f32 v100, v100, s28, v12
    s_cselect_b32 s44, s45, s44
    v_exp_f32 v89, v89
    v_mul_f32 v232, v232, v49
    v_mbcnt_hi_u32_b32 v152, -1, v152
    v_fma_f32 v84, v84, s28, v10
    s_waitcnt lgkmcnt(2)
    v_mfma_f32_16x16x32_bf16 v[192:195], v[120:123], v[16:19], v[192:195]
    s_cselect_b32 s32, 0, s32
    v_fma_f32 v101, v101, s28, v12
    v_mul_f32 v211, v211, v49
    v_mul_f32 v233, v233, v49
    v_mfma_f32_16x16x32_bf16 v[240:243], v[120:123], v[22:25], v[240:243]
    s_mul_i32 s44, s44, 6144
    v_mov_b32 v151, v150
    v_fma_f32 v83, v83, s28, v10
    v_mfma_f32_16x16x32_bf16 a[32:35], v[120:123], v[28:31], a[32:35]
    s_add_u32 s33, s35, s44
    v_permlane16_swap_b32 v151, v150
    v_mul_f32 v216, v216, v49
    v_mfma_f32_16x16x32_bf16 a[80:83], v[120:123], v[34:37], a[80:83]
    s_mul_i32 s42, s32, 6144
    v_fma_f32 v91, v91, s28, v11
    v_exp_f32 v77, v77
    v_exp_f32 v73, v73
    v_mfma_f32_16x16x32_bf16 v[196:199], v[124:127], v[16:19], v[196:199]
    s_add_u32 s42, s42, 24576
    v_exp_f32 v80, v80
    v_fma_f32 v90, v90, s28, v11
    v_mul_f32 v219, v219, v49
    s_add_u32 s42, s42, s33
    v_mfma_f32_16x16x32_bf16 v[244:247], v[124:127], v[22:25], v[244:247]
    s_cmp_ge_u32 s37, 6
    v_mul_f32 v221, v221, v49
    v_max_f32 v150, v150, v151
    v_mfma_f32_16x16x32_bf16 a[36:39], v[124:127], v[28:31], a[36:39]
    s_cselect_b32 s14, 0, s42
    v_mul_f32 v158, v158, v51
    v_cvt_pk_bf16_f32 v14, v72, v73
    s_add_u32 s24, s67, 256
    v_exp_f32 v91, v91
    v_mfma_f32_16x16x32_bf16 a[84:87], v[124:127], v[34:37], a[84:87]
    s_add_u32 s25, s33, 256
    v_exp_f32 v82, v82
    v_mfma_f32_16x16x32_bf16 v[200:203], v[128:131], v[16:19], v[200:203]
    s_add_u32 s23, s38, 4096
    v_exp_f32 v74, v74
    v_mfma_f32_16x16x32_bf16 v[248:251], v[128:131], v[22:25], v[248:251]
    s_mov_b32 s27, 0x49249249
    s_mov_b32 s30, 0
    s_waitcnt vmcnt(7) lgkmcnt(0)
    v_mul_f32 v228, v228, v49
    s_barrier
    ds_read_b128 v[112:115], v0 offset:12288
    v_mul_f32_e64 v13, -s28, v150
    v_mfma_f32_16x16x32_bf16 a[40:43], v[128:131], v[28:31], a[40:43]
    ds_read_b128 v[116:119], v1 offset:12288
    v_fma_f32 v108, v108, s28, v13
    v_fma_f32 v97, v97, s28, v12
    v_mfma_f32_16x16x32_bf16 a[88:91], v[128:131], v[34:37], a[88:91]
    ds_read_b128 v[120:123], v0 offset:13312
    v_fma_f32 v104, v104, s28, v13
    v_mul_f32 v217, v217, v49
    v_mul_f32 v236, v236, v49
    v_exp_f32 v83, v83
    v_pk_mul_f32 v[160:161], v[160:161], v[48:49] op_sel_hi:[1,0]
    v_cvt_pk_bf16_f32 v21, v82, v83
    v_fma_f32 v105, v105, s28, v13
    v_fma_f32 v107, v107, s28, v13
    v_exp_f32 v107, v107
    v_lshrrev_b32 v152, 1, v152
    v_mul_f32 v220, v220, v49
    v_exp_f32 v92, v92
    v_exp_f32 v97, v97
    v_exp_f32 v90, v90
    v_mfma_f32_16x16x32_bf16 v[204:207], v[132:135], v[16:19], v[204:207]
    v_exp_f32 v104, v104
    v_cvt_pk_bf16_f32 v15, v74, v75
    v_fma_f32 v95, v95, s28, v11
    v_fma_f32 v106, v106, s28, v13
    v_fma_f32 v109, v109, s28, v13
    v_fma_f32 v87, v87, s28, v10
    v_mfma_f32_16x16x32_bf16 v[252:255], v[132:135], v[22:25], v[252:255]
    v_exp_f32 v99, v99
    v_mfma_f32_16x16x32_bf16 a[44:47], v[132:135], v[28:31], a[44:47]
    v_cvt_pk_bf16_f32 v216, v216, v217
    v_exp_f32 v81, v81
    v_mfma_f32_16x16x32_bf16 a[92:95], v[132:135], v[34:37], a[92:95]
    s_waitcnt lgkmcnt(0)
    v_exp_f32 v88, v88
    v_mfma_f32_16x16x32_bf16 v[72:75], v[112:115], a[144:147], 0
    v_mul_f32 v222, v222, v49
    v_fma_f32 v110, v110, s28, v13
    v_mfma_f32_16x16x32_bf16 v[72:75], v[116:119], a[148:151], v[72:75]
    v_mul_f32 v213, v213, v49
    v_cvt_pk_bf16_f32 v32, v96, v97
    v_mul_f32 v247, v247, v49
    v_mul_f32 v208, v208, v49
    v_mfma_f32_16x16x32_bf16 v[72:75], v[120:123], a[152:155], v[72:75]
    v_mul_f32 v209, v209, v49
    v_mul_f32 v246, v246, v49
    v_cvt_pk_bf16_f32 v220, v220, v221
    v_fma_f32 v102, v102, s28, v12
    v_exp_f32 v105, v105
    v_cvt_pk_bf16_f32 v20, v80, v81
    v_and_b32 v152, 24, v152
    v_cvt_pk_bf16_f32 v38, v104, v105
    v_cvt_pk_bf16_f32 v26, v88, v89
    v_cvt_pk_bf16_f32 v27, v90, v91
    v_mfma_f32_16x16x32_bf16 v[80:83], v[112:115], a[168:171], 0
    ds_read_b128 v[132:135], v1 offset:14336
    v_exp_f32 v108, v108
    v_mfma_f32_16x16x32_bf16 v[80:83], v[116:119], a[172:175], v[80:83]
    v_exp_f32 v98, v98
    v_exp_f32 v106, v106
    v_mfma_f32_16x16x32_bf16 v[80:83], v[120:123], a[176:179], v[80:83]
    v_exp_f32 v94, v94
    v_fma_f32 v103, v103, s28, v12
    v_mfma_f32_16x16x32_bf16 v[88:91], v[112:115], a[192:195], 0
    ds_read_b128 v[124:127], v1 offset:13312
    v_mul_f32 v157, v157, v51
    v_exp_f32 v78, v78
    v_mul_f32 v249, v249, v49
    v_mfma_f32_16x16x32_bf16 v[88:91], v[116:119], a[196:199], v[88:91]
    ds_read_b128 v[128:131], v0 offset:14336
    v_cvt_pk_bf16_f32 v212, v212, v213
    v_mfma_f32_16x16x32_bf16 v[88:91], v[120:123], a[200:203], v[88:91]
    v_cvt_pk_bf16_f32 v39, v106, v107
    v_bfe_u32 v152, s66, v152, 8
    v_cvt_pk_bf16_f32 v33, v98, v99
    v_exp_f32 v102, v102
    v_mfma_f32_16x16x32_bf16 v[96:99], v[112:115], a[216:219], 0
    s_add_u32 m0, s22, 36864
    v_xor_b32 v149, v149, v152
    v_exp_f32 v87, v87
    v_exp_f32 v84, v84
    v_mfma_f32_16x16x32_bf16 v[96:99], v[116:119], a[220:223], v[96:99]
    v_exp_f32 v100, v100
    v_exp_f32 v101, v101
    v_mfma_f32_16x16x32_bf16 v[96:99], v[120:123], a[224:227], v[96:99]
    v_mul_f32 v252, v252, v49
    v_fma_f32 v86, v86, s28, v10
    v_mul_f32 v223, v223, v49
    v_mfma_f32_16x16x32_bf16 v[104:107], v[112:115], a[240:243], 0
    v_cvt_pk_bf16_f32 v208, v208, v209
    v_mul_f32 v224, v224, v49
    v_mfma_f32_16x16x32_bf16 v[104:107], v[116:119], a[244:247], v[104:107]
    ds_read_b128 v[112:115], v0 offset:18432
    v_mul_f32 v250, v250, v49
    v_mfma_f32_16x16x32_bf16 v[104:107], v[120:123], a[248:251], v[104:107]
    s_waitcnt lgkmcnt(2)
    v_fma_f32 v111, v111, s28, v13
    v_cvt_pk_bf16_f32 v160, v160, v161
    v_mfma_f32_16x16x32_bf16 v[72:75], v[124:127], a[156:159], v[72:75]
    s_waitcnt lgkmcnt(1)
    v_exp_f32 v93, v93
    v_mfma_f32_16x16x32_bf16 v[72:75], v[128:131], a[160:163], v[72:75]
    buffer_load_dwordx4 v6, s[8:11], s21 offen lds
    v_mfma_f32_16x16x32_bf16 v[72:75], v[132:135], a[164:167], v[72:75]
    v_mul_f32 v237, v237, v49
    v_cvt_pk_bf16_f32 v209, v210, v211
    v_mfma_f32_16x16x32_bf16 v[80:83], v[124:127], a[180:183], v[80:83]
    s_add_u32 s21, s21, 128
    v_exp_f32 v95, v95
    v_mul_f32 v215, v215, v49
    v_mfma_f32_16x16x32_bf16 v[80:83], v[128:131], a[184:187], v[80:83]
    v_mul_f32 v239, v239, v49
    v_mul_f32 v248, v248, v49
    v_cvt_pk_bf16_f32 v29, v94, v95
    v_mfma_f32_16x16x32_bf16 v[80:83], v[132:135], a[188:191], v[80:83]
    v_mul_f32 v243, v243, v49
    v_mul_f32 v251, v251, v49
    v_mfma_f32_16x16x32_bf16 v[88:91], v[124:127], a[204:207], v[88:91]
    ds_read_b128 v[116:119], v1 offset:18432
    v_accvgpr_read_b32 v152, a0
    v_cvt_pk_bf16_f32 v156, v156, v157
    v_mfma_f32_16x16x32_bf16 v[88:91], v[128:131], a[208:211], v[88:91]
    v_cvt_pk_bf16_f32 v17, v78, v79
    v_exp_f32 v103, v103
    v_cvt_pk_bf16_f32 v16, v76, v77
    v_exp_f32 v86, v86
    v_mfma_f32_16x16x32_bf16 v[88:91], v[132:135], a[212:215], v[88:91]
    v_cvt_pk_bf16_f32 v34, v100, v101
    v_mul_f32 v226, v226, v49
    v_exp_f32 v111, v111
    v_exp_f32 v85, v85
    v_mfma_f32_16x16x32_bf16 v[96:99], v[124:127], a[228:231], v[96:99]
    v_cvt_pk_bf16_f32 v22, v84, v85
    v_cvt_pk_bf16_f32 v35, v102, v103
    v_mfma_f32_16x16x32_bf16 v[96:99], v[128:131], a[232:235], v[96:99]
    ds_read_b128 v[120:123], v0 offset:19456
    v_fma_f32 v74, v74, s28, v9
    v_mul_f32 v214, v214, v49
    v_mfma_f32_16x16x32_bf16 v[96:99], v[132:135], a[236:239], v[96:99]
    v_mul_f32 v227, v227, v49
    v_cvt_pk_bf16_f32 v157, v158, v159
    v_cvt_pk_bf16_f32 v23, v86, v87
    v_mfma_f32_16x16x32_bf16 v[104:107], v[124:127], a[252:255], v[104:107]
    v_exp_f32 v109, v109
    v_mfma_f32_16x16x32_bf16 v[44:47], v[52:55], v[14:17], 0
    v_cvt_pk_bf16_f32 v232, v232, v233
    v_fma_f32 v73, v73, s28, v9
    v_mfma_f32_16x16x32_bf16 v[104:107], v[128:131], v[136:139], v[104:107]
    v_mul_f32 v254, v254, v49
    v_mul_f32 v240, v240, v49
    v_cvt_pk_bf16_f32 v28, v92, v93
    v_fma_f32 v99, v99, s28, v12
    v_cvt_pk_bf16_f32 v213, v214, v215
    v_pk_mul_f32 v[152:153], v[152:153], v[50:51] op_sel_hi:[1,0]
    v_fma_f32 v89, v89, s28, v11
    v_pk_mul_f32 v[196:197], v[196:197], v[48:49] op_sel_hi:[1,0]
    v_pk_mul_f32 v[168:169], v[168:169], v[48:49] op_sel_hi:[1,0]
    v_pk_mul_f32 v[178:179], v[178:179], v[48:49] op_sel_hi:[1,0]
    v_pk_mul_f32 v[182:183], v[182:183], v[48:49] op_sel_hi:[1,0]
    v_exp_f32 v110, v110
    v_fma_f32 v83, v83, s28, v10
    v_cvt_pk_bf16_f32 v152, v152, v153
    v_pk_mul_f32 v[154:155], v[154:155], v[50:51] op_sel_hi:[1,0]
    v_pk_mul_f32 v[162:163], v[162:163], v[48:49] op_sel_hi:[1,0]
    v_pk_mul_f32 v[184:185], v[184:185], v[48:49] op_sel_hi:[1,0]
    v_cvt_pk_bf16_f32 v40, v108, v109
    v_exp_f32 v89, v89
    v_mfma_f32_16x16x32_bf16 v[104:107], v[132:135], v[140:143], v[104:107]
    s_waitcnt lgkmcnt(0)
    ds_read_b128 v[132:135], v1 offset:20480
    v_accvgpr_read_b32 v158, a54
    v_mfma_f32_16x16x32_bf16 v[76:79], v[112:115], a[144:147], 0
    s_add_u32 m0, s22, 37888
    ds_read_b128 v[124:127], v1 offset:19456
    v_cvt_pk_bf16_f32 v41, v110, v111
    v_mfma_f32_16x16x32_bf16 v[76:79], v[116:119], a[148:151], v[76:79]
    buffer_load_dwordx4 v6, s[8:11], s21 offen lds
    ds_read_b128 v[128:131], v0 offset:20480
    v_mfma_f32_16x16x32_bf16 v[76:79], v[120:123], a[152:155], v[76:79]
    v_cvt_pk_bf16_f32 v161, v162, v163
    v_mul_f32 v235, v235, v49
    v_mul_f32 v234, v234, v49
    v_mfma_f32_16x16x32_bf16 v[84:87], v[112:115], a[168:171], 0
    s_add_u32 s21, s21, 128
    v_cvt_pk_bf16_f32 v153, v154, v155
    v_mul_f32 v245, v245, v49
    v_fma_f32 v88, v88, s28, v11
    v_mfma_f32_16x16x32_bf16 v[84:87], v[116:119], a[172:175], v[84:87]
    s_add_u32 m0, s22, 38912
    v_fma_f32 v98, v98, s28, v12
    v_fma_f32 v72, v72, s28, v9
    v_mfma_f32_16x16x32_bf16 v[84:87], v[120:123], a[176:179], v[84:87]
    buffer_load_dwordx4 v6, s[8:11], s21 offen lds
    v_mfma_f32_16x16x32_bf16 v[92:95], v[112:115], a[192:195], 0
    v_mul_f32 v253, v253, v49
    v_accvgpr_read_b32 v154, a6
    v_fma_f32 v96, v96, s28, v12
    v_mfma_f32_16x16x32_bf16 v[92:95], v[116:119], a[196:199], v[92:95]
    ds_write2st64_b64 v149, v[160:161], v[208:209] offset0:0 offset1:12
    v_pk_mul_f32 v[164:165], v[164:165], v[48:49] op_sel_hi:[1,0]
    v_fma_f32 v75, v75, s28, v9
    v_cvt_pk_bf16_f32 v224, v224, v225
    v_mfma_f32_16x16x32_bf16 v[92:95], v[120:123], a[200:203], v[92:95]
    s_add_u32 s21, s21, 12032
    v_fma_f32 v82, v82, s28, v10
    v_cvt_pk_bf16_f32 v248, v248, v249
    v_mfma_f32_16x16x32_bf16 v[100:103], v[112:115], a[216:219], 0
    s_waitcnt vmcnt(6) lgkmcnt(1)
    ds_write2st64_b64 v149, v[152:153], v[156:157] offset0:24 offset1:36
    v_pk_mul_f32 v[172:173], v[172:173], v[48:49] op_sel_hi:[1,0]
    v_cvt_pk_bf16_f32 v164, v164, v165
    v_fma_f32 v107, v107, s28, v13
    v_mfma_f32_16x16x32_bf16 v[100:103], v[116:119], a[220:223], v[100:103]
    s_barrier
    v_cvt_pk_bf16_f32 v184, v184, v185
    v_accvgpr_read_b32 v156, a52
    v_mul_f32 v158, v158, v51
    v_mul_f32 v229, v229, v49
    v_pk_mul_f32 v[166:167], v[166:167], v[48:49] op_sel_hi:[1,0]
    v_accvgpr_read_b32 v153, a5
    v_accvgpr_read_b32 v157, a53
    v_mfma_f32_16x16x32_bf16 v[100:103], v[120:123], a[224:227], v[100:103]
    s_add_u32 m0, s22, 12288
    v_mul_f32 v157, v157, v51
    v_accvgpr_read_b32 v159, a55
    v_mfma_f32_16x16x32_bf16 v[108:111], v[112:115], a[240:243], 0
    ds_read_b64_tr_b16 v[112:113], v2 offset:0
    v_xor_b32 v149, 32, v149
    v_fma_f32 v80, v80, s28, v10
    v_mul_f32 v156, v156, v51
    v_exp_f32 v75, v75
    v_pk_mul_f32 v[170:171], v[170:171], v[48:49] op_sel_hi:[1,0]
    v_pk_mul_f32 v[180:181], v[180:181], v[48:49] op_sel_hi:[1,0]
    v_mul_f32 v159, v159, v51
    v_cvt_pk_bf16_f32 v168, v168, v169
    v_mfma_f32_16x16x32_bf16 v[108:111], v[116:119], a[244:247], v[108:111]
    v_cvt_pk_bf16_f32 v156, v156, v157
    v_exp_f32 v73, v73
    v_mfma_f32_16x16x32_bf16 v[108:111], v[120:123], a[248:251], v[108:111]
    v_exp_f32 v88, v88
    v_mul_f32 v244, v244, v49
    v_mfma_f32_16x16x32_bf16 v[76:79], v[124:127], a[156:159], v[76:79]
    ds_read_b64_tr_b16 v[114:115], v2 offset:6144
    buffer_load_dwordx4 v6, s[4:7], s20 offen lds
    v_mfma_f32_16x16x32_bf16 v[76:79], v[128:131], a[160:163], v[76:79]
    v_accvgpr_read_b32 v152, a4
    v_mul_f32 v231, v231, v49
    v_cvt_pk_bf16_f32 v165, v166, v167
    v_accvgpr_read_b32 v155, a7
    v_mfma_f32_16x16x32_bf16 v[76:79], v[132:135], a[164:167], v[76:79]
    v_cvt_pk_bf16_f32 v157, v158, v159
    v_accvgpr_read_b32 v158, a58
    v_fma_f32 v90, v90, s28, v11
    v_mfma_f32_16x16x32_bf16 v[84:87], v[124:127], a[180:183], v[84:87]
    s_add_u32 s20, s20, 128
    ds_read_b64_tr_b16 v[116:117], v3 offset:0
    v_cvt_pk_bf16_f32 v221, v222, v223
    v_mfma_f32_16x16x32_bf16 v[84:87], v[128:131], a[184:187], v[84:87]
    v_fma_f32 v104, v104, s28, v13
    v_cvt_pk_bf16_f32 v196, v196, v197
    v_mfma_f32_16x16x32_bf16 v[84:87], v[132:135], a[188:191], v[84:87]
    ds_read_b64_tr_b16 v[118:119], v3 offset:6144
    v_cvt_pk_bf16_f32 v169, v170, v171
    v_mfma_f32_16x16x32_bf16 v[92:95], v[124:127], a[204:207], v[92:95]
    ds_read_b64_tr_b16 v[120:121], v4 offset:0
    v_accvgpr_read_b32 v159, a59
    v_cvt_pk_bf16_f32 v180, v180, v181
    v_mfma_f32_16x16x32_bf16 v[92:95], v[128:131], a[208:211], v[92:95]
    ds_write2st64_b64 v149, v[164:165], v[212:213] offset0:0 offset1:12
    v_pk_mul_f32 v[174:175], v[174:175], v[48:49] op_sel_hi:[1,0]
    v_pk_mul_f32 v[152:153], v[152:153], v[50:51] op_sel_hi:[1,0]
    v_pk_mul_f32 v[154:155], v[154:155], v[50:51] op_sel_hi:[1,0]
    v_cvt_pk_bf16_f32 v228, v228, v229
    v_cvt_pk_bf16_f32 v152, v152, v153
    v_mul_f32 v158, v158, v51
    v_mfma_f32_16x16x32_bf16 v[92:95], v[132:135], a[212:215], v[92:95]
    v_fma_f32 v97, v97, s28, v12
    v_mul_f32 v230, v230, v49
    v_mfma_f32_16x16x32_bf16 v[100:103], v[124:127], a[228:231], v[100:103]
    v_cvt_pk_bf16_f32 v153, v154, v155
    v_cvt_pk_bf16_f32 v252, v252, v253
    v_mfma_f32_16x16x32_bf16 v[44:47], v[56:59], v[20:23], v[44:47]
    ds_write2st64_b64 v149, v[152:153], v[156:157] offset0:24 offset1:36
    v_fma_f32 v105, v105, s28, v13
    v_cvt_pk_bf16_f32 v172, v172, v173
    v_mfma_f32_16x16x32_bf16 v[100:103], v[128:131], a[232:235], v[100:103]
    ds_read_b64_tr_b16 v[122:123], v4 offset:6144
    v_mul_f32 v218, v218, v49
    v_mfma_f32_16x16x32_bf16 v[100:103], v[132:135], a[236:239], v[100:103]
    v_accvgpr_read_b32 v155, a11
    v_accvgpr_read_b32 v156, a56
    v_mfma_f32_16x16x32_bf16 v[108:111], v[124:127], a[252:255], v[108:111]
    v_accvgpr_read_b32 v157, a57
    v_mul_f32 v255, v255, v49
    v_mfma_f32_16x16x32_bf16 v[108:111], v[128:131], v[136:139], v[108:111]
    v_mul_f32 v159, v159, v51
    v_exp_f32 v74, v74
    v_mul_f32 v157, v157, v51
    v_mfma_f32_16x16x32_bf16 v[108:111], v[132:135], v[140:143], v[108:111]
    s_waitcnt lgkmcnt(2)
    ds_read_b64_tr_b16 v[130:131], v2 offset:7168
    v_mul_f32 v241, v241, v49
    v_mfma_f32_16x16x32_bf16 v[160:163], v[112:115], v[14:17], 0
    v_mul_f32 v238, v238, v49
    v_cvt_pk_bf16_f32 v244, v244, v245
    v_mfma_f32_16x16x32_bf16 v[208:211], v[112:115], v[20:23], 0
    v_cvt_pk_bf16_f32 v245, v246, v247
    v_fma_f32 v95, v95, s28, v11
    v_mfma_f32_16x16x32_bf16 a[0:3], v[112:115], v[26:29], 0
    v_mul_f32 v156, v156, v51
    v_cvt_pk_bf16_f32 v30, v88, v89
    v_mfma_f32_16x16x32_bf16 a[48:51], v[112:115], v[32:35], 0
    v_fma_f32 v102, v102, s28, v12
    v_accvgpr_read_b32 v152, a8
    v_accvgpr_read_b32 v153, a9
    v_mfma_f32_16x16x32_bf16 a[96:99], v[112:115], v[38:41], 0
    s_add_u32 m0, s22, 13312
    ds_read_b64_tr_b16 v[134:135], v3 offset:7168
    v_accvgpr_read_b32 v154, a10
    v_mfma_f32_16x16x32_bf16 v[164:167], v[116:119], v[14:17], 0
    ds_read_b64_tr_b16 v[114:115], v4 offset:7168
    v_fma_f32 v79, v79, s28, v9
    v_xor_b32 v149, 96, v149
    v_fma_f32 v85, v85, s28, v10
    v_cvt_pk_bf16_f32 v229, v230, v231
    v_fma_f32 v77, v77, s28, v9
    v_pk_mul_f32 v[152:153], v[152:153], v[50:51] op_sel_hi:[1,0]
    v_cvt_pk_bf16_f32 v156, v156, v157
    v_exp_f32 v96, v96
    v_pk_mul_f32 v[192:193], v[192:193], v[48:49] op_sel_hi:[1,0]
    v_pk_mul_f32 v[154:155], v[154:155], v[50:51] op_sel_hi:[1,0]
    v_cvt_pk_bf16_f32 v152, v152, v153
    v_cvt_pk_bf16_f32 v173, v174, v175
    v_cvt_pk_bf16_f32 v192, v192, v193
    v_cvt_pk_bf16_f32 v225, v226, v227
    v_cvt_pk_bf16_f32 v217, v218, v219
    v_exp_f32 v97, v97
    v_cvt_pk_bf16_f32 v157, v158, v159
    v_mfma_f32_16x16x32_bf16 v[212:215], v[116:119], v[20:23], 0
    buffer_load_dwordx4 v6, s[4:7], s20 offen lds
    ds_write2st64_b64 v149, v[168:169], v[216:217] offset0:0 offset1:12
    v_accvgpr_read_b32 v158, a62
    v_pk_mul_f32 v[194:195], v[194:195], v[48:49] op_sel_hi:[1,0]
    v_pk_mul_f32 v[176:177], v[176:177], v[48:49] op_sel_hi:[1,0]
    v_fma_f32 v106, v106, s28, v13
    v_cvt_pk_bf16_f32 v153, v154, v155
    v_accvgpr_read_b32 v159, a63
    v_cvt_pk_bf16_f32 v249, v250, v251
    v_pk_mul_f32 v[186:187], v[186:187], v[48:49] op_sel_hi:[1,0]
    v_cvt_pk_bf16_f32 v236, v236, v237
    v_accvgpr_read_b32 v154, a14
    v_mfma_f32_16x16x32_bf16 a[4:7], v[116:119], v[26:29], 0
    ds_write2st64_b64 v149, v[152:153], v[156:157] offset0:24 offset1:36
    v_accvgpr_read_b32 v155, a15
    v_mfma_f32_16x16x32_bf16 v[44:47], v[60:63], v[26:29], v[44:47]
    v_exp_f32 v98, v98
    v_mfma_f32_16x16x32_bf16 a[52:55], v[116:119], v[32:35], 0
    v_xor_b32 v149, 32, v149
    v_fma_f32 v81, v81, s28, v10
    v_accvgpr_read_b32 v153, a13
    v_mul_f32 v159, v159, v51
    v_accvgpr_read_b32 v156, a60
    v_cvt_pk_bf16_f32 v181, v182, v183
    v_mfma_f32_16x16x32_bf16 a[100:103], v[116:119], v[38:41], 0
    s_waitcnt lgkmcnt(2)
    ds_read_b64_tr_b16 v[132:133], v3 offset:1024
    v_accvgpr_read_b32 v152, a12
    v_mfma_f32_16x16x32_bf16 v[168:171], v[120:123], v[14:17], 0
    ds_read_b64_tr_b16 v[124:125], v5 offset:0
    v_mul_f32 v156, v156, v51
    v_mfma_f32_16x16x32_bf16 v[44:47], v[64:67], v[32:35], v[44:47]
    ds_write2st64_b64 v149, v[172:173], v[220:221] offset0:0 offset1:12
    v_exp_f32 v107, v107
    v_mul_f32 v158, v158, v51
    v_pk_mul_f32 v[152:153], v[152:153], v[50:51] op_sel_hi:[1,0]
    v_fma_f32 v84, v84, s28, v10
    v_cvt_pk_bf16_f32 v152, v152, v153
    v_accvgpr_read_b32 v157, a61
    v_exp_f32 v90, v90
    v_pk_mul_f32 v[154:155], v[154:155], v[50:51] op_sel_hi:[1,0]
    v_pk_mul_f32 v[188:189], v[188:189], v[48:49] op_sel_hi:[1,0]
    v_cvt_pk_bf16_f32 v176, v176, v177
    v_mul_f32 v157, v157, v51
    v_cvt_pk_bf16_f32 v153, v154, v155
    v_mfma_f32_16x16x32_bf16 v[216:219], v[120:123], v[20:23], 0
    ds_read_b64_tr_b16 v[126:127], v5 offset:6144
    v_cvt_pk_bf16_f32 v240, v240, v241
    v_mfma_f32_16x16x32_bf16 a[8:11], v[120:123], v[26:29], 0
    ds_read_b64_tr_b16 v[128:129], v2 offset:1024
    v_accvgpr_read_b32 v155, a19
    v_cvt_pk_bf16_f32 v156, v156, v157
    v_cvt_pk_bf16_f32 v157, v158, v159
    v_mfma_f32_16x16x32_bf16 a[56:59], v[120:123], v[32:35], 0
    ds_write2st64_b64 v149, v[152:153], v[156:157] offset0:24 offset1:36
    v_fma_f32 v101, v101, s28, v12
    v_pk_mul_f32 v[204:205], v[204:205], v[48:49] op_sel_hi:[1,0]
    v_accvgpr_read_b32 v156, a64
    v_accvgpr_read_b32 v153, a17
    v_accvgpr_read_b32 v158, a66
    v_pk_mul_f32 v[190:191], v[190:191], v[48:49] op_sel_hi:[1,0]
    v_exp_f32 v72, v72
    v_mul_f32 v156, v156, v51
    v_accvgpr_read_b32 v152, a16
    v_accvgpr_read_b32 v157, a65
    v_mul_f32 v157, v157, v51
    v_cvt_pk_bf16_f32 v156, v156, v157
    v_mul_f32 v158, v158, v51
    v_pk_mul_f32 v[152:153], v[152:153], v[50:51] op_sel_hi:[1,0]
    v_cvt_pk_bf16_f32 v177, v178, v179
    v_accvgpr_read_b32 v154, a18
    v_pk_mul_f32 v[154:155], v[154:155], v[50:51] op_sel_hi:[1,0]
    v_accvgpr_read_b32 v159, a67
    v_cvt_pk_bf16_f32 v193, v194, v195
    v_cvt_pk_bf16_f32 v152, v152, v153
    v_mul_f32 v159, v159, v51
    v_cvt_pk_bf16_f32 v237, v238, v239
    v_cvt_pk_bf16_f32 v157, v158, v159
    v_cvt_pk_bf16_f32 v153, v154, v155
    v_mfma_f32_16x16x32_bf16 a[104:107], v[120:123], v[38:41], 0
    s_add_u32 s20, s20, 128
    v_xor_b32 v149, 96, v149
    v_accvgpr_read_b32 v158, a70
    v_mfma_f32_16x16x32_bf16 v[44:47], v[68:71], v[38:41], v[44:47]
    s_waitcnt lgkmcnt(1)
    ds_read_b128 v[144:147], v8 offset:0
    v_exp_f32 v99, v99
    v_mul_f32 v158, v158, v51
    v_mfma_f32_16x16x32_bf16 v[172:175], v[124:127], v[14:17], 0
    s_add_u32 m0, s22, 14336
    ds_read_b64_tr_b16 v[116:117], v5 offset:1024
    v_mul_f32 v242, v242, v49
    v_mfma_f32_16x16x32_bf16 v[220:223], v[124:127], v[20:23], 0
    ds_write2st64_b64 v149, v[176:177], v[224:225] offset0:4 offset1:16
    v_cvt_pk_bf16_f32 v204, v204, v205
    v_fma_f32 v91, v91, s28, v11
    v_accvgpr_read_b32 v159, a71
    v_mfma_f32_16x16x32_bf16 a[12:15], v[124:127], v[26:29], 0
    ds_write2st64_b64 v149, v[152:153], v[156:157] offset0:28 offset1:40
    v_pk_mul_f32 v[206:207], v[206:207], v[48:49] op_sel_hi:[1,0]
    v_cvt_pk_bf16_f32 v19, v74, v75
    v_exp_f32 v80, v80
    v_accvgpr_read_b32 v152, a20
    v_xor_b32 v149, 32, v149
    v_accvgpr_read_b32 v157, a69
    v_mfma_f32_16x16x32_bf16 a[60:63], v[124:127], v[32:35], 0
    ds_write2st64_b64 v149, v[180:181], v[228:229] offset0:4 offset1:16
    v_mul_f32 v157, v157, v51
    v_accvgpr_read_b32 v153, a21
    v_accvgpr_read_b32 v154, a22
    v_pk_mul_f32 v[200:201], v[200:201], v[48:49] op_sel_hi:[1,0]
    v_accvgpr_read_b32 v156, a68
    v_accvgpr_read_b32 v155, a23
    v_pk_mul_f32 v[198:199], v[198:199], v[48:49] op_sel_hi:[1,0]
    v_mul_f32 v156, v156, v51
    v_cvt_pk_bf16_f32 v185, v186, v187
    v_cvt_pk_bf16_f32 v18, v72, v73
    v_cvt_pk_bf16_f32 v156, v156, v157
    v_mul_f32 v159, v159, v51
    v_mfma_f32_16x16x32_bf16 a[108:111], v[124:127], v[38:41], 0
    ds_read_b64_tr_b16 v[112:113], v4 offset:1024
    v_exp_f32 v83, v83
    v_cvt_pk_bf16_f32 v188, v188, v189
    v_cvt_pk_bf16_f32 v157, v158, v159
    v_pk_mul_f32 v[202:203], v[202:203], v[48:49] op_sel_hi:[1,0]
    v_pk_mul_f32 v[154:155], v[154:155], v[50:51] op_sel_hi:[1,0]
    v_pk_mul_f32 v[152:153], v[152:153], v[50:51] op_sel_hi:[1,0]
    v_accvgpr_read_b32 v158, a74
    v_cvt_pk_bf16_f32 v152, v152, v153
    v_cvt_pk_bf16_f32 v153, v154, v155
    v_mfma_f32_16x16x32_bf16 v[176:179], v[128:131], v[14:17], 0
    ds_write2st64_b64 v149, v[152:153], v[156:157] offset0:28 offset1:40
    v_mfma_f32_16x16x32_bf16 v[224:227], v[128:131], v[20:23], 0
    ds_read_b64_tr_b16 v[124:125], v3 offset:2048
    v_accvgpr_read_b32 v156, a72
    v_accvgpr_read_b32 v159, a75
    v_accvgpr_read_b32 v157, a73
    v_mfma_f32_16x16x32_bf16 a[16:19], v[128:131], v[26:29], 0
    ds_read_b64_tr_b16 v[122:123], v2 offset:8192
    buffer_load_dwordx4 v6, s[4:7], s20 offen lds
    v_mfma_f32_16x16x32_bf16 a[64:67], v[128:131], v[32:35], 0
    ds_read_b64_tr_b16 v[126:127], v3 offset:8192
    v_accvgpr_read_b32 v153, a25
    v_mul_f32 v157, v157, v51
    v_cvt_pk_bf16_f32 v233, v234, v235
    v_mfma_f32_16x16x32_bf16 a[112:115], v[128:131], v[38:41], 0
    ds_read_b64_tr_b16 v[120:121], v2 offset:2048
    v_mul_f32 v159, v159, v51
    v_accvgpr_read_b32 v155, a27
    v_fma_f32 v109, v109, s28, v13
    v_xor_b32 v149, 96, v149
    v_accvgpr_read_b32 v152, a24
    v_mfma_f32_16x16x32_bf16 v[180:183], v[132:135], v[14:17], 0
    s_add_u32 s20, s20, 12032
    ds_read_b64_tr_b16 v[128:129], v4 offset:2048
    v_mul_f32 v156, v156, v51
    v_mfma_f32_16x16x32_bf16 v[228:231], v[132:135], v[20:23], 0
    ds_write2st64_b64 v149, v[184:185], v[232:233] offset0:4 offset1:16
    v_mfma_f32_16x16x32_bf16 a[20:23], v[132:135], v[26:29], 0
    s_add_u32 m0, s38, 0
    ds_read_b64_tr_b16 v[118:119], v5 offset:7168
    v_cvt_pk_bf16_f32 v189, v190, v191
    v_mfma_f32_16x16x32_bf16 a[68:71], v[132:135], v[32:35], 0
    s_waitcnt lgkmcnt(6)
    ds_read_b64_tr_b16 v[130:131], v4 offset:8192
    buffer_load_dwordx4 v6, s[12:15], s33 offen nt lds
    v_mul_f32 v158, v158, v51
    v_mfma_f32_16x16x32_bf16 a[116:119], v[132:135], v[38:41], 0
    buffer_store_dwordx4 v[144:147], v6, s[16:19], s67 offen sc0 sc1 nt
    s_nop 0
    ds_read_b128 v[144:147], v8 offset:1024
    v_cvt_pk_bf16_f32 v156, v156, v157
    v_exp_f32 v79, v79
    v_pk_mul_f32 v[152:153], v[152:153], v[50:51] op_sel_hi:[1,0]
    v_cvt_pk_bf16_f32 v200, v200, v201
    v_cvt_pk_bf16_f32 v157, v158, v159
    v_accvgpr_read_b32 v154, a26
    v_pk_mul_f32 v[154:155], v[154:155], v[50:51] op_sel_hi:[1,0]
    v_cvt_pk_bf16_f32 v152, v152, v153
    v_fma_f32 v78, v78, s28, v9
    v_cvt_pk_bf16_f32 v153, v154, v155
    v_accvgpr_read_b32 v159, a79
    v_cvt_pk_bf16_f32 v241, v242, v243
    v_mfma_f32_16x16x32_bf16 v[184:187], v[112:115], v[14:17], 0
    ds_write2st64_b64 v149, v[152:153], v[156:157] offset0:28 offset1:40
    v_accvgpr_read_b32 v158, a78
    v_mfma_f32_16x16x32_bf16 v[232:235], v[112:115], v[20:23], 0
    s_add_u32 m0, s38, 1024
    ds_read_b64_tr_b16 v[134:135], v5 offset:8192
    v_accvgpr_read_b32 v152, a28
    v_accvgpr_read_b32 v156, a76
    v_accvgpr_read_b32 v154, a30
    v_accvgpr_read_b32 v157, a77
    v_mul_f32 v158, v158, v51
    v_accvgpr_read_b32 v155, a31
    v_xor_b32 v149, 32, v149
    v_mul_f32 v157, v157, v51
    v_mul_f32 v156, v156, v51
    v_accvgpr_read_b32 v153, a29
    v_mul_f32 v159, v159, v51
    v_pk_mul_f32 v[152:153], v[152:153], v[50:51] op_sel_hi:[1,0]
    v_cvt_pk_bf16_f32 v156, v156, v157
    v_pk_mul_f32 v[154:155], v[154:155], v[50:51] op_sel_hi:[1,0]
    v_cvt_pk_bf16_f32 v152, v152, v153
    v_cvt_pk_bf16_f32 v153, v154, v155
    v_mfma_f32_16x16x32_bf16 a[24:27], v[112:115], v[26:29], 0
    s_waitcnt lgkmcnt(2)
    ds_read_b64_tr_b16 v[132:133], v5 offset:2048
    buffer_load_dwordx4 v7, s[12:15], s33 offen nt lds
    v_cvt_pk_bf16_f32 v157, v158, v159
    v_exp_f32 v104, v104
    v_cvt_pk_bf16_f32 v201, v202, v203
    v_cvt_pk_bf16_f32 v36, v96, v97
    v_mfma_f32_16x16x32_bf16 a[72:75], v[112:115], v[32:35], 0
    ds_write2st64_b64 v149, v[188:189], v[236:237] offset0:4 offset1:16
    v_accvgpr_read_b32 v155, a35
    v_mfma_f32_16x16x32_bf16 a[120:123], v[112:115], v[38:41], 0
    s_add_u32 s39, s39, 12288
    ds_write2st64_b64 v149, v[152:153], v[156:157] offset0:28 offset1:40
    v_accvgpr_read_b32 v158, a82
    v_accvgpr_read_b32 v156, a80
    v_exp_f32 v105, v105
    v_xor_b32 v149, 96, v149
    v_accvgpr_read_b32 v154, a34
    v_accvgpr_read_b32 v159, a83
    v_accvgpr_read_b32 v152, a32
    v_pk_mul_f32 v[154:155], v[154:155], v[50:51] op_sel_hi:[1,0]
    v_accvgpr_read_b32 v153, a33
    v_accvgpr_read_b32 v157, a81
    v_mul_f32 v158, v158, v51
    v_pk_mul_f32 v[152:153], v[152:153], v[50:51] op_sel_hi:[1,0]
    v_mul_f32 v157, v157, v51
    v_mul_f32 v156, v156, v51
    v_cvt_pk_bf16_f32 v156, v156, v157
    v_mfma_f32_16x16x32_bf16 v[188:191], v[116:119], v[14:17], 0
    s_waitcnt vmcnt(9) lgkmcnt(2)
    v_cvt_pk_bf16_f32 v152, v152, v153
    v_mul_f32 v159, v159, v51
    v_mfma_f32_16x16x32_bf16 v[236:239], v[116:119], v[20:23], 0
    buffer_store_dwordx4 v[144:147], v7, s[16:19], s67 offen sc0 sc1 nt
    s_barrier
    ds_write2st64_b64 v149, v[192:193], v[240:241] offset0:8 offset1:20
    v_cvt_pk_bf16_f32 v153, v154, v155
    v_cvt_pk_bf16_f32 v157, v158, v159
    v_mfma_f32_16x16x32_bf16 a[28:31], v[116:119], v[26:29], 0
    ds_write2st64_b64 v149, v[152:153], v[156:157] offset0:32 offset1:44
    v_mfma_f32_16x16x32_bf16 a[76:79], v[116:119], v[32:35], 0
    ds_read_b128 v[112:115], v0 offset:0
    v_fma_f32 v76, v76, s28, v9
    v_accvgpr_read_b32 v156, a84
    v_accvgpr_read_b32 v153, a37
    v_accvgpr_read_b32 v157, a85
    v_accvgpr_read_b32 v159, a87
    v_mul_f32 v156, v156, v51
    v_accvgpr_read_b32 v158, a86
    v_mul_f32 v158, v158, v51
    v_exp_f32 v109, v109
    v_fma_f32 v100, v100, s28, v12
    v_fma_f32 v92, v92, s28, v11
    v_mul_f32 v157, v157, v51
    v_accvgpr_read_b32 v152, a36
    v_mfma_f32_16x16x32_bf16 a[124:127], v[116:119], v[38:41], 0
    ds_read_b128 v[116:119], v1 offset:0
    v_accvgpr_read_b32 v154, a38
    v_accvgpr_read_b32 v155, a39
    v_exp_f32 v91, v91
    v_pk_mul_f32 v[154:155], v[154:155], v[50:51] op_sel_hi:[1,0]
    v_pk_mul_f32 v[152:153], v[152:153], v[50:51] op_sel_hi:[1,0]
    v_cvt_pk_bf16_f32 v197, v198, v199
    v_cvt_pk_bf16_f32 v152, v152, v153
    v_cvt_pk_bf16_f32 v156, v156, v157
    v_mfma_f32_16x16x32_bf16 v[192:195], v[120:123], v[14:17], 0
    v_xor_b32 v149, 32, v149
    v_mul_f32 v159, v159, v51
    v_mfma_f32_16x16x32_bf16 v[240:243], v[120:123], v[20:23], 0
    ds_write2st64_b64 v149, v[196:197], v[244:245] offset0:8 offset1:20
    v_cvt_pk_bf16_f32 v157, v158, v159
    v_cvt_pk_bf16_f32 v253, v254, v255
    v_exp_f32 v101, v101
    v_cvt_pk_bf16_f32 v153, v154, v155
    v_cvt_pk_bf16_f32 v37, v98, v99
    v_fma_f32 v110, v110, s28, v13
    v_mfma_f32_16x16x32_bf16 a[32:35], v[120:123], v[26:29], 0
    ds_write2st64_b64 v149, v[152:153], v[156:157] offset0:32 offset1:44
    v_accvgpr_read_b32 v158, a90
    v_mfma_f32_16x16x32_bf16 a[80:83], v[120:123], v[32:35], 0
    s_add_u32 m0, s22, 24576
    v_accvgpr_read_b32 v156, a88
    v_accvgpr_read_b32 v152, a40
    v_mfma_f32_16x16x32_bf16 a[128:131], v[120:123], v[38:41], 0
    v_accvgpr_read_b32 v157, a89
    v_accvgpr_read_b32 v155, a43
    v_mfma_f32_16x16x32_bf16 v[196:199], v[124:127], v[14:17], 0
    ds_read_b128 v[120:123], v0 offset:1024
    v_mul_f32 v156, v156, v51
    v_xor_b32 v149, 96, v149
    v_mul_f32 v157, v157, v51
    v_cvt_pk_bf16_f32 v31, v90, v91
    v_accvgpr_read_b32 v153, a41
    v_mfma_f32_16x16x32_bf16 v[244:247], v[124:127], v[20:23], 0
    v_exp_f32 v81, v81
    v_mfma_f32_16x16x32_bf16 a[36:39], v[124:127], v[26:29], 0
    ds_write2st64_b64 v149, v[200:201], v[248:249] offset0:8 offset1:20
    v_pk_mul_f32 v[152:153], v[152:153], v[50:51] op_sel_hi:[1,0]
    v_accvgpr_read_b32 v159, a91
    v_accvgpr_read_b32 v154, a42
    v_pk_mul_f32 v[154:155], v[154:155], v[50:51] op_sel_hi:[1,0]
    v_cvt_pk_bf16_f32 v152, v152, v153
    v_cvt_pk_bf16_f32 v156, v156, v157
    v_mfma_f32_16x16x32_bf16 a[84:87], v[124:127], v[32:35], 0
    v_cvt_pk_bf16_f32 v153, v154, v155
    v_mul_f32 v158, v158, v51
    v_mfma_f32_16x16x32_bf16 a[132:135], v[124:127], v[38:41], 0
    v_mul_f32 v159, v159, v51
    v_cvt_pk_bf16_f32 v205, v206, v207
    v_mfma_f32_16x16x32_bf16 v[200:203], v[128:131], v[14:17], 0
    ds_read_b128 v[124:127], v1 offset:1024
    v_cvt_pk_bf16_f32 v157, v158, v159
    v_mfma_f32_16x16x32_bf16 v[248:251], v[128:131], v[20:23], 0
    ds_write2st64_b64 v149, v[152:153], v[156:157] offset0:32 offset1:44
    v_mfma_f32_16x16x32_bf16 a[40:43], v[128:131], v[26:29], 0
    v_xor_b32 v149, 32, v149
    v_accvgpr_read_b32 v152, a44
    v_mfma_f32_16x16x32_bf16 a[88:91], v[128:131], v[32:35], 0
    ds_write2st64_b64 v149, v[204:205], v[252:253] offset0:8 offset1:20
    v_accvgpr_read_b32 v153, a45
    v_mfma_f32_16x16x32_bf16 a[136:139], v[128:131], v[38:41], 0
    v_fma_f32 v93, v93, s28, v11
    v_accvgpr_read_b32 v155, a47
    v_cvt_pk_bf16_f32 v24, v80, v81
    v_accvgpr_read_b32 v156, a92
    v_accvgpr_read_b32 v157, a93
    v_pk_mul_f32 v[152:153], v[152:153], v[50:51] op_sel_hi:[1,0]
    v_accvgpr_read_b32 v154, a46
    v_fma_f32 v94, v94, s28, v11
    v_pk_mul_f32 v[154:155], v[154:155], v[50:51] op_sel_hi:[1,0]
    v_accvgpr_read_b32 v158, a94
    v_accvgpr_read_b32 v159, a95
    v_mfma_f32_16x16x32_bf16 v[204:207], v[132:135], v[14:17], 0
    v_exp_f32 v106, v106
    v_mfma_f32_16x16x32_bf16 v[252:255], v[132:135], v[20:23], 0
    v_exp_f32 v82, v82
    v_mfma_f32_16x16x32_bf16 a[44:47], v[132:135], v[26:29], 0
    v_exp_f32 v93, v93
    v_mfma_f32_16x16x32_bf16 a[92:95], v[132:135], v[32:35], 0
    v_fma_f32 v111, v111, s28, v13
    v_exp_f32 v77, v77
    v_mfma_f32_16x16x32_bf16 a[140:143], v[132:135], v[38:41], 0
    s_waitcnt lgkmcnt(1)
    v_exp_f32 v100, v100
    v_mfma_f32_16x16x32_bf16 v[72:75], v[112:115], a[144:147], 0
    v_cvt_pk_bf16_f32 v25, v82, v83
    v_cvt_pk_bf16_f32 v42, v104, v105
    v_mfma_f32_16x16x32_bf16 v[72:75], v[116:119], a[148:151], v[72:75]
    ds_read_b128 v[144:147], v8 offset:2048
    v_cvt_pk_bf16_f32 v43, v106, v107
    v_mfma_f32_16x16x32_bf16 v[72:75], v[120:123], a[152:155], v[72:75]
    ds_read_b128 v[132:135], v1 offset:2048
    v_exp_f32 v85, v85
    v_mfma_f32_16x16x32_bf16 v[80:83], v[112:115], a[168:171], 0
    v_exp_f32 v94, v94
    v_mfma_f32_16x16x32_bf16 v[80:83], v[116:119], a[172:175], v[80:83]
    buffer_load_dwordx4 v6, s[8:11], s21 offen lds
    v_mfma_f32_16x16x32_bf16 v[80:83], v[120:123], a[176:179], v[80:83]
    s_add_u32 s21, s21, 128
    ds_read_b128 v[128:131], v0 offset:2048
    v_mul_f32 v156, v156, v51
    v_mfma_f32_16x16x32_bf16 v[88:91], v[112:115], a[192:195], 0
    v_exp_f32 v84, v84
    v_mfma_f32_16x16x32_bf16 v[88:91], v[116:119], a[196:199], v[88:91]
    s_add_u32 m0, s22, 25600
    v_exp_f32 v95, v95
    v_mfma_f32_16x16x32_bf16 v[88:91], v[120:123], a[200:203], v[88:91]
    v_exp_f32 v111, v111
    v_mfma_f32_16x16x32_bf16 v[96:99], v[112:115], a[216:219], 0
    v_exp_f32 v76, v76
    v_mfma_f32_16x16x32_bf16 v[96:99], v[116:119], a[220:223], v[96:99]
    v_fma_f32 v103, v103, s28, v12
    v_fma_f32 v86, v86, s28, v10
    v_mfma_f32_16x16x32_bf16 v[96:99], v[120:123], a[224:227], v[96:99]
    v_exp_f32 v92, v92
    v_fma_f32 v108, v108, s28, v13
    v_mfma_f32_16x16x32_bf16 v[104:107], v[112:115], a[240:243], 0
    buffer_load_dwordx4 v6, s[8:11], s21 offen lds
    v_mfma_f32_16x16x32_bf16 v[104:107], v[116:119], a[244:247], v[104:107]
    s_add_u32 s21, s21, 128
    v_exp_f32 v86, v86
    v_mfma_f32_16x16x32_bf16 v[104:107], v[120:123], a[248:251], v[104:107]
    v_mul_f32 v158, v158, v51
    v_cvt_pk_bf16_f32 v16, v76, v77
    v_mfma_f32_16x16x32_bf16 v[72:75], v[124:127], a[156:159], v[72:75]
    s_waitcnt lgkmcnt(0)
    v_exp_f32 v78, v78
    v_mfma_f32_16x16x32_bf16 v[72:75], v[128:131], a[160:163], v[72:75]
    s_add_u32 m0, s22, 26624
    v_fma_f32 v87, v87, s28, v10
    v_cvt_pk_bf16_f32 v17, v78, v79
    v_mfma_f32_16x16x32_bf16 v[72:75], v[132:135], a[164:167], v[72:75]
    buffer_load_dwordx4 v6, s[8:11], s21 offen lds
    v_mfma_f32_16x16x32_bf16 v[80:83], v[124:127], a[180:183], v[80:83]
    ds_read_b128 v[112:115], v0 offset:6144
    v_mul_f32 v159, v159, v51
    v_mfma_f32_16x16x32_bf16 v[80:83], v[128:131], a[184:187], v[80:83]
    s_add_u32 s21, s21, 12032
    v_cvt_pk_bf16_f32 v22, v84, v85
    v_cvt_pk_bf16_f32 v152, v152, v153
    v_mfma_f32_16x16x32_bf16 v[80:83], v[132:135], a[188:191], v[80:83]
    s_add_u32 s56, s67, 128
    v_exp_f32 v103, v103
    v_mfma_f32_16x16x32_bf16 v[88:91], v[124:127], a[204:207], v[88:91]
    buffer_store_dwordx4 v[144:147], v6, s[16:19], s56 offen sc0 sc1 nt
    s_add_u32 s58, s33, 128
    v_cvt_pk_bf16_f32 v29, v94, v95
    v_exp_f32 v87, v87
    v_mfma_f32_16x16x32_bf16 v[88:91], v[128:131], a[208:211], v[88:91]
    s_add_u32 m0, s38, 2048
    v_exp_f32 v108, v108
    v_mfma_f32_16x16x32_bf16 v[88:91], v[132:135], a[212:215], v[88:91]
    buffer_load_dwordx4 v6, s[12:15], s58 offen nt lds
    v_mfma_f32_16x16x32_bf16 v[96:99], v[124:127], a[228:231], v[96:99]
    v_exp_f32 v110, v110
    v_mfma_f32_16x16x32_bf16 v[96:99], v[128:131], a[232:235], v[96:99]
    ds_read_b128 v[116:119], v1 offset:6144
    v_cvt_pk_bf16_f32 v23, v86, v87
    v_mfma_f32_16x16x32_bf16 v[96:99], v[132:135], a[236:239], v[96:99]
    ds_read_b128 v[144:147], v8 offset:3072
    v_mul_f32 v157, v157, v51
    v_mfma_f32_16x16x32_bf16 v[104:107], v[124:127], a[252:255], v[104:107]
    ds_read_b128 v[120:123], v0 offset:7168
    v_mfma_f32_16x16x32_bf16 v[48:51], v[52:55], v[16:19], v[44:47]
    v_exp_f32 v102, v102
    v_mfma_f32_16x16x32_bf16 v[104:107], v[128:131], v[136:139], v[104:107]
    v_cvt_pk_bf16_f32 v35, v102, v103
    v_cvt_pk_bf16_f32 v156, v156, v157
    v_mfma_f32_16x16x32_bf16 v[48:51], v[56:59], v[22:25], v[48:51]
    ds_read_b128 v[128:131], v0 offset:8192
    v_cvt_pk_bf16_f32 v28, v92, v93
    v_mfma_f32_16x16x32_bf16 v[104:107], v[132:135], v[140:143], v[104:107]
    v_cvt_pk_bf16_f32 v153, v154, v155
    v_cvt_pk_bf16_f32 v34, v100, v101
    v_mfma_f32_16x16x32_bf16 v[48:51], v[60:63], v[28:31], v[48:51]
    v_cvt_pk_bf16_f32 v40, v108, v109
    v_cvt_pk_bf16_f32 v41, v110, v111
    v_mfma_f32_16x16x32_bf16 v[48:51], v[64:67], v[34:37], v[48:51]
    s_add_u32 m0, s38, 3072
    ds_read_b128 v[124:127], v1 offset:7168
    v_mfma_f32_16x16x32_bf16 v[48:51], v[68:71], v[40:43], v[48:51]
    s_waitcnt lgkmcnt(5)
    ds_read_b128 v[132:135], v1 offset:8192
    v_cvt_pk_bf16_f32 v157, v158, v159
    v_mfma_f32_16x16x32_bf16 v[76:79], v[112:115], a[144:147], 0
    s_waitcnt lgkmcnt(5)
    ds_write2st64_b64 v149, v[152:153], v[156:157] offset0:32 offset1:44
    v_mfma_f32_16x16x32_bf16 v[76:79], v[116:119], a[148:151], v[76:79]
    s_nop 0
    v_cmp_lt_f32 vcc, s29, v48
    s_waitcnt lgkmcnt(4)
    v_mfma_f32_16x16x32_bf16 v[76:79], v[120:123], a[152:155], v[76:79]
    buffer_load_dwordx4 v7, s[12:15], s58 offen nt lds
    v_mfma_f32_16x16x32_bf16 v[84:87], v[112:115], a[168:171], 0
    s_nop 0
    s_cbranch_vccnz L_rs_tr45d
L_ret_tr45d:
    v_mfma_f32_16x16x32_bf16 v[84:87], v[116:119], a[172:175], v[84:87]
    v_fma_f32 v81, v81, s28, v10
    v_mfma_f32_16x16x32_bf16 v[84:87], v[120:123], a[176:179], v[84:87]
    v_fma_f32 v75, v75, s28, v9
    v_fma_f32 v83, v83, s28, v10
    v_mfma_f32_16x16x32_bf16 v[92:95], v[112:115], a[192:195], 0
    v_exp_f32 v83, v83
    v_mfma_f32_16x16x32_bf16 v[92:95], v[116:119], a[196:199], v[92:95]
    v_add_u32 v8, 4096, v8
    v_fma_f32 v82, v82, s28, v10
    v_mfma_f32_16x16x32_bf16 v[92:95], v[120:123], a[200:203], v[92:95]
    s_waitcnt vmcnt(13) lgkmcnt(1)
    v_fma_f32 v73, v73, s28, v9
    v_fma_f32 v72, v72, s28, v9
    v_mfma_f32_16x16x32_bf16 v[100:103], v[112:115], a[216:219], 0
    s_add_u32 m0, s22, 0
    v_exp_f32 v75, v75
    v_mfma_f32_16x16x32_bf16 v[100:103], v[116:119], a[220:223], v[100:103]
    s_barrier
    v_mfma_f32_16x16x32_bf16 v[100:103], v[120:123], a[224:227], v[100:103]
    v_exp_f32 v82, v82
    v_mfma_f32_16x16x32_bf16 v[108:111], v[112:115], a[240:243], 0
    v_exp_f32 v73, v73
    v_mfma_f32_16x16x32_bf16 v[108:111], v[116:119], a[244:247], v[108:111]
    buffer_load_dwordx4 v6, s[4:7], s20 offen lds
    v_mfma_f32_16x16x32_bf16 v[108:111], v[120:123], a[248:251], v[108:111]
    s_add_u32 s20, s20, 128
    v_exp_f32 v72, v72
    v_mfma_f32_16x16x32_bf16 v[76:79], v[124:127], a[156:159], v[76:79]
    ds_read_b64_tr_b16 v[112:113], v2 offset:18432
    s_add_u32 m0, s22, 1024
    v_mfma_f32_16x16x32_bf16 v[76:79], v[128:131], a[160:163], v[76:79]
    v_fma_f32 v80, v80, s28, v10
    v_mfma_f32_16x16x32_bf16 v[76:79], v[132:135], a[164:167], v[76:79]
    v_fma_f32 v74, v74, s28, v9
    v_mfma_f32_16x16x32_bf16 v[84:87], v[124:127], a[180:183], v[84:87]
    v_exp_f32 v80, v80
    v_mfma_f32_16x16x32_bf16 v[84:87], v[128:131], a[184:187], v[84:87]
    ds_read_b64_tr_b16 v[114:115], v2 offset:12288
    v_mfma_f32_16x16x32_bf16 v[84:87], v[132:135], a[188:191], v[84:87]
    buffer_store_dwordx4 v[144:147], v7, s[16:19], s56 offen sc0 sc1 nt
    ds_read_b64_tr_b16 v[116:117], v3 offset:18432
    v_cvt_pk_bf16_f32 v21, v82, v83
    v_mfma_f32_16x16x32_bf16 v[92:95], v[124:127], a[204:207], v[92:95]
    v_exp_f32 v74, v74
    v_mfma_f32_16x16x32_bf16 v[92:95], v[128:131], a[208:211], v[92:95]
    buffer_load_dwordx4 v6, s[4:7], s20 offen lds
    v_mfma_f32_16x16x32_bf16 v[92:95], v[132:135], a[212:215], v[92:95]
    ds_read_b64_tr_b16 v[118:119], v3 offset:12288
    v_mfma_f32_16x16x32_bf16 v[100:103], v[124:127], a[228:231], v[100:103]
    ds_read_b64_tr_b16 v[120:121], v4 offset:18432
    s_add_u32 s20, s20, 128
    v_mfma_f32_16x16x32_bf16 v[100:103], v[128:131], a[232:235], v[100:103]
    s_add_u32 m0, s22, 2048
    v_exp_f32 v81, v81
    v_mfma_f32_16x16x32_bf16 v[100:103], v[132:135], a[236:239], v[100:103]
    ds_read_b64_tr_b16 v[122:123], v4 offset:12288
    v_cvt_pk_bf16_f32 v14, v72, v73
    v_mfma_f32_16x16x32_bf16 v[108:111], v[124:127], a[252:255], v[108:111]
    ds_read_b64_tr_b16 v[124:125], v5 offset:18432
    v_cvt_pk_bf16_f32 v15, v74, v75
    v_mfma_f32_16x16x32_bf16 v[108:111], v[128:131], v[136:139], v[108:111]
    buffer_load_dwordx4 v6, s[4:7], s20 offen lds
    v_mfma_f32_16x16x32_bf16 v[108:111], v[132:135], v[140:143], v[108:111]
    s_add_u32 s20, s20, 12032
    ds_read_b64_tr_b16 v[126:127], v5 offset:12288
    v_cvt_pk_bf16_f32 v20, v80, v81
    s_branch L_loop5
L_tr44:
    s_waitcnt lgkmcnt(6)
    v_mfma_f32_16x16x32_bf16 v[160:163], v[112:115], v[16:19], v[160:163]
    v_fma_f32 v94, v94, s28, v11
    v_fma_f32 v76, v76, s28, v9
    v_mfma_f32_16x16x32_bf16 v[208:211], v[112:115], v[22:25], v[208:211]
    ds_read_b64_tr_b16 v[130:131], v2 offset:13312
    v_fma_f32 v99, v99, s28, v12
    v_mfma_f32_16x16x32_bf16 a[0:3], v[112:115], v[28:31], a[0:3]
    v_fma_f32 v91, v91, s28, v11
    v_fma_f32 v96, v96, s28, v12
    v_mfma_f32_16x16x32_bf16 a[48:51], v[112:115], v[34:37], a[48:51]
    v_fma_f32 v78, v78, s28, v9
    s_waitcnt lgkmcnt(5)
    v_mfma_f32_16x16x32_bf16 v[164:167], v[116:119], v[16:19], v[164:167]
    ds_read_b64_tr_b16 v[128:129], v2 offset:19456
    v_fma_f32 v82, v82, s28, v10
    v_mfma_f32_16x16x32_bf16 v[212:215], v[116:119], v[22:25], v[212:215]
    ds_read_b64_tr_b16 v[134:135], v3 offset:13312
    v_fma_f32 v92, v92, s28, v11
    v_mfma_f32_16x16x32_bf16 a[4:7], v[116:119], v[28:31], a[4:7]
    v_fma_f32 v90, v90, s28, v11
    v_fma_f32 v101, v101, s28, v12
    v_mfma_f32_16x16x32_bf16 a[52:55], v[116:119], v[34:37], a[52:55]
    ds_read_b64_tr_b16 v[132:133], v3 offset:19456
    s_waitcnt lgkmcnt(6)
    v_mfma_f32_16x16x32_bf16 v[168:171], v[120:123], v[16:19], v[168:171]
    ds_read_b64_tr_b16 v[114:115], v4 offset:13312
    v_mfma_f32_16x16x32_bf16 v[216:219], v[120:123], v[22:25], v[216:219]
    v_fma_f32 v95, v95, s28, v11
    v_mfma_f32_16x16x32_bf16 a[8:11], v[120:123], v[28:31], a[8:11]
    ds_read_b128 v[144:147], v8 offset:2048
    v_fma_f32 v77, v77, s28, v9
    v_mfma_f32_16x16x32_bf16 a[56:59], v[120:123], v[34:37], a[56:59]
    s_waitcnt lgkmcnt(5)
    ds_read_b64_tr_b16 v[112:113], v4 offset:19456
    v_fma_f32 v84, v84, s28, v10
    v_mfma_f32_16x16x32_bf16 v[172:175], v[124:127], v[16:19], v[172:175]
    ds_read_b64_tr_b16 v[118:119], v5 offset:13312
    v_fma_f32 v97, v97, s28, v12
    v_mfma_f32_16x16x32_bf16 v[220:223], v[124:127], v[22:25], v[220:223]
    v_exp_f32 v97, v97
    v_mfma_f32_16x16x32_bf16 a[12:15], v[124:127], v[28:31], a[12:15]
    v_exp_f32 v95, v95
    v_mfma_f32_16x16x32_bf16 a[60:63], v[124:127], v[34:37], a[60:63]
    s_waitcnt lgkmcnt(5)
    ds_read_b64_tr_b16 v[120:121], v2 offset:20480
    v_fma_f32 v87, v87, s28, v10
    v_mfma_f32_16x16x32_bf16 v[176:179], v[128:131], v[16:19], v[176:179]
    s_add_u32 s39, s39, 12288
    ds_read_b64_tr_b16 v[116:117], v5 offset:19456
    v_fma_f32 v98, v98, s28, v12
    v_mfma_f32_16x16x32_bf16 v[224:227], v[128:131], v[22:25], v[224:227]
    ds_read_b64_tr_b16 v[126:127], v3 offset:14336
    v_fma_f32 v79, v79, s28, v9
    v_mfma_f32_16x16x32_bf16 a[16:19], v[128:131], v[28:31], a[16:19]
    ds_read_b64_tr_b16 v[124:125], v3 offset:20480
    v_fma_f32 v85, v85, s28, v10
    v_mfma_f32_16x16x32_bf16 a[64:67], v[128:131], v[34:37], a[64:67]
    s_waitcnt lgkmcnt(7)
    ds_read_b64_tr_b16 v[122:123], v2 offset:14336
    v_mfma_f32_16x16x32_bf16 v[180:183], v[132:135], v[16:19], v[180:183]
    v_fma_f32 v89, v89, s28, v11
    v_mfma_f32_16x16x32_bf16 v[228:231], v[132:135], v[22:25], v[228:231]
    ds_read_b64_tr_b16 v[130:131], v4 offset:14336
    v_fma_f32 v93, v93, s28, v11
    v_mfma_f32_16x16x32_bf16 a[20:23], v[132:135], v[28:31], a[20:23]
    ds_read_b64_tr_b16 v[128:129], v4 offset:20480
    v_mfma_f32_16x16x32_bf16 a[68:71], v[132:135], v[34:37], a[68:71]
    s_waitcnt lgkmcnt(7)
    ds_read_b64_tr_b16 v[134:135], v5 offset:14336
    v_fma_f32 v102, v102, s28, v12
    v_mfma_f32_16x16x32_bf16 v[184:187], v[112:115], v[16:19], v[184:187]
    ds_read_b64_tr_b16 v[132:133], v5 offset:20480
    v_fma_f32 v103, v103, s28, v12
    v_mfma_f32_16x16x32_bf16 v[232:235], v[112:115], v[22:25], v[232:235]
    v_exp_f32 v90, v90
    v_mfma_f32_16x16x32_bf16 a[24:27], v[112:115], v[28:31], a[24:27]
    v_exp_f32 v98, v98
    v_mfma_f32_16x16x32_bf16 a[72:75], v[112:115], v[34:37], a[72:75]
    s_waitcnt lgkmcnt(6)
    v_exp_f32 v96, v96
    v_mfma_f32_16x16x32_bf16 v[188:191], v[116:119], v[16:19], v[188:191]
    v_exp_f32 v91, v91
    v_mfma_f32_16x16x32_bf16 v[236:239], v[116:119], v[22:25], v[236:239]
    v_fma_f32 v88, v88, s28, v11
    v_fma_f32 v86, v86, s28, v10
    v_mfma_f32_16x16x32_bf16 a[28:31], v[116:119], v[28:31], a[28:31]
    v_exp_f32 v99, v99
    v_mfma_f32_16x16x32_bf16 a[76:79], v[116:119], v[34:37], a[76:79]
    s_waitcnt lgkmcnt(3)
    v_exp_f32 v85, v85
    v_mfma_f32_16x16x32_bf16 v[192:195], v[120:123], v[16:19], v[192:195]
    v_exp_f32 v82, v82
    v_mfma_f32_16x16x32_bf16 v[240:243], v[120:123], v[22:25], v[240:243]
    s_waitcnt vmcnt(10) lgkmcnt(0)
    v_mfma_f32_16x16x32_bf16 a[32:35], v[120:123], v[28:31], a[32:35]
    s_barrier
    v_mfma_f32_16x16x32_bf16 a[80:83], v[120:123], v[34:37], a[80:83]
    ds_read_b128 v[116:119], v1 offset:12288
    v_mfma_f32_16x16x32_bf16 v[196:199], v[124:127], v[16:19], v[196:199]
    v_exp_f32 v87, v87
    v_mfma_f32_16x16x32_bf16 v[244:247], v[124:127], v[22:25], v[244:247]
    s_add_u32 m0, s22, 36864
    ds_read_b128 v[112:115], v0 offset:12288
    v_fma_f32 v100, v100, s28, v12
    v_mfma_f32_16x16x32_bf16 a[36:39], v[124:127], v[28:31], a[36:39]
    ds_read_b128 v[120:123], v0 offset:13312
    v_cvt_pk_bf16_f32 v32, v96, v97
    v_mfma_f32_16x16x32_bf16 a[84:87], v[124:127], v[34:37], a[84:87]
    v_exp_f32 v77, v77
    v_mfma_f32_16x16x32_bf16 v[200:203], v[128:131], v[16:19], v[200:203]
    buffer_load_dwordx4 v6, s[8:11], s21 offen lds
    v_mfma_f32_16x16x32_bf16 v[248:251], v[128:131], v[22:25], v[248:251]
    v_exp_f32 v89, v89
    v_mfma_f32_16x16x32_bf16 a[40:43], v[128:131], v[28:31], a[40:43]
    v_exp_f32 v100, v100
    v_mfma_f32_16x16x32_bf16 a[88:91], v[128:131], v[34:37], a[88:91]
    s_add_u32 s21, s21, 128
    v_fma_f32 v83, v83, s28, v10
    s_add_u32 m0, s22, 37888
    v_mfma_f32_16x16x32_bf16 v[204:207], v[132:135], v[16:19], v[204:207]
    buffer_load_dwordx4 v6, s[8:11], s21 offen lds
    v_mfma_f32_16x16x32_bf16 v[252:255], v[132:135], v[22:25], v[252:255]
    ds_read_b128 v[124:127], v1 offset:13312
    v_cvt_pk_bf16_f32 v33, v98, v99
    v_mfma_f32_16x16x32_bf16 a[44:47], v[132:135], v[28:31], a[44:47]
    s_add_u32 s21, s21, 128
    v_exp_f32 v83, v83
    v_mfma_f32_16x16x32_bf16 a[92:95], v[132:135], v[34:37], a[92:95]
    s_waitcnt lgkmcnt(2)
    v_exp_f32 v88, v88
    v_mfma_f32_16x16x32_bf16 v[72:75], v[112:115], a[144:147], 0
    s_add_u32 m0, s22, 38912
    ds_read_b128 v[128:131], v0 offset:14336
    v_cvt_pk_bf16_f32 v21, v82, v83
    v_mfma_f32_16x16x32_bf16 v[72:75], v[116:119], a[148:151], v[72:75]
    s_waitcnt lgkmcnt(2)
    ds_read_b128 v[148:151], v8 offset:3072
    v_cvt_pk_bf16_f32 v26, v88, v89
    v_mfma_f32_16x16x32_bf16 v[72:75], v[120:123], a[152:155], v[72:75]
    buffer_load_dwordx4 v6, s[8:11], s21 offen lds
    v_mfma_f32_16x16x32_bf16 v[80:83], v[112:115], a[168:171], 0
    v_cvt_pk_bf16_f32 v27, v90, v91
    s_add_u32 s21, s21, 12032
    v_mfma_f32_16x16x32_bf16 v[80:83], v[116:119], a[172:175], v[80:83]
    v_exp_f32 v76, v76
    v_mfma_f32_16x16x32_bf16 v[80:83], v[120:123], a[176:179], v[80:83]
    ds_read_b128 v[132:135], v1 offset:14336
    v_mfma_f32_16x16x32_bf16 v[88:91], v[112:115], a[192:195], 0
    v_exp_f32 v93, v93
    v_mfma_f32_16x16x32_bf16 v[88:91], v[116:119], a[196:199], v[88:91]
    v_exp_f32 v79, v79
    v_mfma_f32_16x16x32_bf16 v[88:91], v[120:123], a[200:203], v[88:91]
    s_add_u32 s56, s24, 5888
    v_exp_f32 v84, v84
    v_mfma_f32_16x16x32_bf16 v[96:99], v[112:115], a[216:219], 0
    v_exp_f32 v94, v94
    v_mfma_f32_16x16x32_bf16 v[96:99], v[116:119], a[220:223], v[96:99]
    buffer_store_dwordx4 v[144:147], v6, s[16:19], s56 offen sc0 sc1 nt
    s_nop 0
    ds_read_b128 v[144:147], v8 offset:4096
    v_exp_f32 v78, v78
    v_mfma_f32_16x16x32_bf16 v[96:99], v[120:123], a[224:227], v[96:99]
    s_waitcnt lgkmcnt(2)
    v_exp_f32 v86, v86
    v_mfma_f32_16x16x32_bf16 v[72:75], v[124:127], a[156:159], v[72:75]
    ds_read_b128 v[116:119], v1 offset:18432
    v_mfma_f32_16x16x32_bf16 v[72:75], v[128:131], a[160:163], v[72:75]
    v_cvt_pk_bf16_f32 v22, v84, v85
    s_waitcnt lgkmcnt(2)
    v_mfma_f32_16x16x32_bf16 v[72:75], v[132:135], a[164:167], v[72:75]
    buffer_store_dwordx4 v[148:151], v7, s[16:19], s56 offen sc0 sc1 nt
    s_nop 0
    ds_read_b128 v[148:151], v8 offset:5120
    v_exp_f32 v101, v101
    v_mfma_f32_16x16x32_bf16 v[80:83], v[124:127], a[180:183], v[80:83]
    s_add_u32 s57, s24, 6016
    ds_read_b128 v[112:115], v0 offset:18432
    v_cvt_pk_bf16_f32 v29, v94, v95
    v_mfma_f32_16x16x32_bf16 v[80:83], v[128:131], a[184:187], v[80:83]
    v_exp_f32 v103, v103
    v_mfma_f32_16x16x32_bf16 v[80:83], v[132:135], a[188:191], v[80:83]
    v_exp_f32 v92, v92
    v_mfma_f32_16x16x32_bf16 v[88:91], v[124:127], a[204:207], v[88:91]
    s_add_u32 m0, s38, 22528
    v_exp_f32 v102, v102
    v_mfma_f32_16x16x32_bf16 v[88:91], v[128:131], a[208:211], v[88:91]
    s_waitcnt lgkmcnt(3)
    buffer_store_dwordx4 v[144:147], v6, s[16:19], s57 offen sc0 sc1 nt
    s_nop 0
    ds_read_b128 v[144:147], v8 offset:0
    v_cvt_pk_bf16_f32 v16, v76, v77
    v_cvt_pk_bf16_f32 v23, v86, v87
    v_mfma_f32_16x16x32_bf16 v[88:91], v[132:135], a[212:215], v[88:91]
    v_cvt_pk_bf16_f32 v34, v100, v101
    v_mfma_f32_16x16x32_bf16 v[96:99], v[124:127], a[228:231], v[96:99]
    ds_read_b128 v[120:123], v0 offset:19456
    v_cvt_pk_bf16_f32 v17, v78, v79
    v_mfma_f32_16x16x32_bf16 v[96:99], v[128:131], a[232:235], v[96:99]
    ds_read_b128 v[124:127], v1 offset:19456
    v_mfma_f32_16x16x32_bf16 v[44:47], v[52:55], v[14:17], v[48:51]
    s_waitcnt lgkmcnt(4)
    buffer_store_dwordx4 v[148:151], v7, s[16:19], s57 offen sc0 sc1 nt
    s_nop 0
    ds_read_b128 v[148:151], v8 offset:1024
    v_cvt_pk_bf16_f32 v28, v92, v93
    v_cvt_pk_bf16_f32 v35, v102, v103
    v_mfma_f32_16x16x32_bf16 v[96:99], v[132:135], a[236:239], v[96:99]
    ds_read_b128 v[132:135], v1 offset:20480
    v_mfma_f32_16x16x32_bf16 v[44:47], v[56:59], v[20:23], v[44:47]
    ds_read_b128 v[128:131], v0 offset:20480
    v_mfma_f32_16x16x32_bf16 v[44:47], v[60:63], v[26:29], v[44:47]
    v_mfma_f32_16x16x32_bf16 v[44:47], v[64:67], v[32:35], v[44:47]
    s_waitcnt lgkmcnt(5)
    v_mfma_f32_16x16x32_bf16 v[76:79], v[112:115], a[144:147], 0
    buffer_load_dwordx4 v6, s[12:15], s25 offen nt lds
    v_mfma_f32_16x16x32_bf16 v[76:79], v[116:119], a[148:151], v[76:79]
    buffer_store_dwordx4 v[144:147], v6, s[16:19], s24 offen sc0 sc1 nt
    s_nop 2
    v_cmp_lt_f32 vcc, s29, v44
    s_waitcnt lgkmcnt(3)
    v_mfma_f32_16x16x32_bf16 v[76:79], v[120:123], a[152:155], v[76:79]
    s_add_u32 m0, s38, 23552
    v_mfma_f32_16x16x32_bf16 v[84:87], v[112:115], a[168:171], 0
    s_nop 0
    s_cbranch_vccnz L_rs_tr44a
L_ret_tr44a:
    v_mfma_f32_16x16x32_bf16 v[84:87], v[116:119], a[172:175], v[84:87]
    s_waitcnt lgkmcnt(2)
    buffer_load_dwordx4 v7, s[12:15], s25 offen nt lds
    v_mfma_f32_16x16x32_bf16 v[84:87], v[120:123], a[176:179], v[84:87]
    buffer_store_dwordx4 v[148:151], v7, s[16:19], s24 offen sc0 sc1 nt
    s_waitcnt vmcnt(14) lgkmcnt(0)
    s_barrier
    v_fma_f32 v75, v75, s28, v9
    v_mfma_f32_16x16x32_bf16 v[92:95], v[112:115], a[192:195], 0
    s_add_u32 m0, s22, 12288
    v_fma_f32 v80, v80, s28, v10
    v_fma_f32 v72, v72, s28, v9
    v_mfma_f32_16x16x32_bf16 v[92:95], v[116:119], a[196:199], v[92:95]
    buffer_load_dwordx4 v6, s[4:7], s20 offen lds
    v_mfma_f32_16x16x32_bf16 v[92:95], v[120:123], a[200:203], v[92:95]
    v_exp_f32 v72, v72
    v_mfma_f32_16x16x32_bf16 v[100:103], v[112:115], a[216:219], 0
    s_add_u32 s20, s20, 128
    v_exp_f32 v75, v75
    v_mfma_f32_16x16x32_bf16 v[100:103], v[116:119], a[220:223], v[100:103]
    ds_read_b64_tr_b16 v[112:113], v2 offset:0
    s_add_u32 m0, s22, 13312
    v_mfma_f32_16x16x32_bf16 v[100:103], v[120:123], a[224:227], v[100:103]
    ds_read_b64_tr_b16 v[114:115], v2 offset:6144
    v_fma_f32 v73, v73, s28, v9
    v_mfma_f32_16x16x32_bf16 v[76:79], v[124:127], a[156:159], v[76:79]
    ds_read_b64_tr_b16 v[116:117], v3 offset:0
    v_fma_f32 v74, v74, s28, v9
    v_mfma_f32_16x16x32_bf16 v[76:79], v[128:131], a[160:163], v[76:79]
    v_exp_f32 v74, v74
    v_mfma_f32_16x16x32_bf16 v[76:79], v[132:135], a[164:167], v[76:79]
    buffer_load_dwordx4 v6, s[4:7], s20 offen lds
    v_mfma_f32_16x16x32_bf16 v[84:87], v[124:127], a[180:183], v[84:87]
    ds_read_b64_tr_b16 v[118:119], v3 offset:6144
    v_mfma_f32_16x16x32_bf16 v[84:87], v[128:131], a[184:187], v[84:87]
    ds_read_b64_tr_b16 v[120:121], v4 offset:0
    v_fma_f32 v81, v81, s28, v10
    v_mfma_f32_16x16x32_bf16 v[84:87], v[132:135], a[188:191], v[84:87]
    s_add_u32 s20, s20, 128
    v_exp_f32 v81, v81
    v_mfma_f32_16x16x32_bf16 v[92:95], v[124:127], a[204:207], v[92:95]
    v_exp_f32 v80, v80
    v_mfma_f32_16x16x32_bf16 v[92:95], v[128:131], a[208:211], v[92:95]
    s_add_u32 m0, s22, 14336
    v_exp_f32 v73, v73
    v_mfma_f32_16x16x32_bf16 v[92:95], v[132:135], a[212:215], v[92:95]
    buffer_load_dwordx4 v6, s[4:7], s20 offen lds
    v_mfma_f32_16x16x32_bf16 v[100:103], v[124:127], a[228:231], v[100:103]
    ds_read_b64_tr_b16 v[122:123], v4 offset:6144
    v_cvt_pk_bf16_f32 v24, v80, v81
    v_mfma_f32_16x16x32_bf16 v[100:103], v[128:131], a[232:235], v[100:103]
    s_add_u32 s20, s20, 12032
    ds_read_b64_tr_b16 v[124:125], v5 offset:0
    v_cvt_pk_bf16_f32 v19, v74, v75
    v_mfma_f32_16x16x32_bf16 v[100:103], v[132:135], a[236:239], v[100:103]
    ds_read_b64_tr_b16 v[126:127], v5 offset:6144
    v_cvt_pk_bf16_f32 v18, v72, v73
    s_waitcnt lgkmcnt(6)
    v_mfma_f32_16x16x32_bf16 v[160:163], v[112:115], v[14:17], v[160:163]
    s_nop 3
    v_fma_f32 v101, v101, s28, v12
    v_lshrrev_b32 v153, 11, v0
    v_mfma_f32_16x16x32_bf16 v[208:211], v[112:115], v[20:23], v[208:211]
    ds_read_b64_tr_b16 v[128:129], v2 offset:1024
    v_fma_f32 v89, v89, s28, v11
    v_mfma_f32_16x16x32_bf16 a[0:3], v[112:115], v[26:29], a[0:3]
    ds_read_b64_tr_b16 v[130:131], v2 offset:7168
    v_fma_f32 v91, v91, s28, v11
    v_exp_f32 v91, v91
    v_mfma_f32_16x16x32_bf16 a[48:51], v[112:115], v[32:35], a[48:51]
    s_waitcnt lgkmcnt(6)
    v_fma_f32 v95, v95, s28, v11
    v_xor_b32 v153, s65, v153
    v_mfma_f32_16x16x32_bf16 v[164:167], v[116:119], v[14:17], v[164:167]
    ds_read_b64_tr_b16 v[112:113], v4 offset:1024
    v_fma_f32 v88, v88, s28, v11
    v_mfma_f32_16x16x32_bf16 v[212:215], v[116:119], v[20:23], v[212:215]
    ds_read_b64_tr_b16 v[132:133], v3 offset:1024
    v_fma_f32 v94, v94, s28, v11
    v_fma_f32 v90, v90, s28, v11
    v_mfma_f32_16x16x32_bf16 a[4:7], v[116:119], v[26:29], a[4:7]
    v_exp_f32 v88, v88
    v_mfma_f32_16x16x32_bf16 a[52:55], v[116:119], v[32:35], a[52:55]
    s_waitcnt lgkmcnt(6)
    ds_read_b64_tr_b16 v[134:135], v3 offset:7168
    v_and_b32 v152, 0x3ff, v0
    v_mfma_f32_16x16x32_bf16 v[168:171], v[120:123], v[14:17], v[168:171]
    v_fma_f32 v85, v85, s28, v10
    v_lshl_add_u32 v152, v153, 10, v152
    v_mfma_f32_16x16x32_bf16 v[216:219], v[120:123], v[20:23], v[216:219]
    ds_read_b64_tr_b16 v[118:119], v5 offset:7168
    v_fma_f32 v97, v97, s28, v12
    v_mfma_f32_16x16x32_bf16 a[8:11], v[120:123], v[26:29], a[8:11]
    v_exp_f32 v89, v89
    v_mfma_f32_16x16x32_bf16 a[56:59], v[120:123], v[32:35], a[56:59]
    s_waitcnt lgkmcnt(4)
    ds_read_b64_tr_b16 v[116:117], v5 offset:1024
    v_add_u32 v152, s38, v152
    v_mfma_f32_16x16x32_bf16 v[172:175], v[124:127], v[14:17], v[172:175]
    v_fma_f32 v84, v84, s28, v10
    v_xor_b32 v153, 64, v152
    v_mfma_f32_16x16x32_bf16 v[220:223], v[124:127], v[20:23], v[220:223]
    ds_read_b64_tr_b16 v[120:121], v2 offset:2048
    v_fma_f32 v99, v99, s28, v12
    v_mfma_f32_16x16x32_bf16 a[12:15], v[124:127], v[26:29], a[12:15]
    ds_read_b64_tr_b16 v[114:115], v4 offset:7168
    v_fma_f32 v102, v102, s28, v12
    v_mfma_f32_16x16x32_bf16 a[60:63], v[124:127], v[32:35], a[60:63]
    ds_read_b128 a[192:195], v152 offset:12288
    v_exp_f32 v95, v95
    v_mfma_f32_16x16x32_bf16 v[176:179], v[128:131], v[14:17], v[176:179]
    ds_read_b64_tr_b16 v[126:127], v3 offset:8192
    v_fma_f32 v79, v79, s28, v9
    v_fma_f32 v82, v82, s28, v10
    v_mfma_f32_16x16x32_bf16 v[224:227], v[128:131], v[20:23], v[224:227]
    ds_read_b64_tr_b16 v[122:123], v2 offset:8192
    v_fma_f32 v83, v83, s28, v10
    v_mfma_f32_16x16x32_bf16 a[16:19], v[128:131], v[26:29], a[16:19]
    ds_read_b64_tr_b16 v[124:125], v3 offset:2048
    v_fma_f32 v93, v93, s28, v11
    v_mfma_f32_16x16x32_bf16 a[64:67], v[128:131], v[32:35], a[64:67]
    s_waitcnt lgkmcnt(7)
    ds_read_b64_tr_b16 v[128:129], v4 offset:2048
    v_fma_f32 v77, v77, s28, v9
    v_mfma_f32_16x16x32_bf16 v[180:183], v[132:135], v[14:17], v[180:183]
    s_add_u32 s39, s39, 12288
    ds_read_b64_tr_b16 v[130:131], v4 offset:8192
    v_fma_f32 v98, v98, s28, v12
    v_mfma_f32_16x16x32_bf16 v[228:231], v[132:135], v[20:23], v[228:231]
    ds_read_b128 a[216:219], v152 offset:18432
    v_exp_f32 v99, v99
    v_mfma_f32_16x16x32_bf16 a[20:23], v[132:135], v[26:29], a[20:23]
    v_exp_f32 v82, v82
    v_mfma_f32_16x16x32_bf16 a[68:71], v[132:135], v[32:35], a[68:71]
    s_waitcnt lgkmcnt(7)
    ds_read_b64_tr_b16 v[132:133], v5 offset:2048
    v_fma_f32 v96, v96, s28, v12
    v_mfma_f32_16x16x32_bf16 v[184:187], v[112:115], v[14:17], v[184:187]
    ds_read_b64_tr_b16 v[134:135], v5 offset:8192
    v_fma_f32 v78, v78, s28, v9
    v_mfma_f32_16x16x32_bf16 v[232:235], v[112:115], v[20:23], v[232:235]
    ds_read_b128 a[148:151], v153 offset:0
    v_fma_f32 v100, v100, s28, v12
    v_mfma_f32_16x16x32_bf16 a[24:27], v[112:115], v[26:29], a[24:27]
    v_exp_f32 v96, v96
    v_mfma_f32_16x16x32_bf16 a[72:75], v[112:115], v[32:35], a[72:75]
    ds_read_b128 a[144:147], v152 offset:0
    v_exp_f32 v84, v84
    v_mfma_f32_16x16x32_bf16 v[188:191], v[116:119], v[14:17], v[188:191]
    ds_read_b128 a[184:187], v152 offset:10240
    v_fma_f32 v86, v86, s28, v10
    v_mfma_f32_16x16x32_bf16 v[236:239], v[116:119], v[20:23], v[236:239]
    ds_read_b128 a[176:179], v152 offset:8192
    v_exp_f32 v90, v90
    v_mfma_f32_16x16x32_bf16 a[28:31], v[116:119], v[26:29], a[28:31]
    ds_read_b128 a[168:171], v152 offset:6144
    v_exp_f32 v98, v98
    v_mfma_f32_16x16x32_bf16 a[76:79], v[116:119], v[32:35], a[76:79]
    s_waitcnt lgkmcnt(7)
    v_exp_f32 v83, v83
    v_mfma_f32_16x16x32_bf16 v[192:195], v[120:123], v[14:17], v[192:195]
    ds_read_b128 a[172:175], v153 offset:6144
    v_fma_f32 v92, v92, s28, v11
    v_mfma_f32_16x16x32_bf16 v[240:243], v[120:123], v[20:23], v[240:243]
    s_waitcnt vmcnt(14) lgkmcnt(6)
    v_exp_f32 v85, v85
    v_mfma_f32_16x16x32_bf16 a[32:35], v[120:123], v[26:29], a[32:35]
    s_barrier
    v_mfma_f32_16x16x32_bf16 a[80:83], v[120:123], v[32:35], a[80:83]
    ds_read_b128 v[116:119], v1 offset:0
    v_cvt_pk_bf16_f32 v25, v82, v83
    v_mfma_f32_16x16x32_bf16 v[196:199], v[124:127], v[14:17], v[196:199]
    s_add_u32 s21, s21, s62
    ds_read_b128 a[160:163], v152 offset:4096
    v_exp_f32 v86, v86
    v_mfma_f32_16x16x32_bf16 v[244:247], v[124:127], v[20:23], v[244:247]
    ds_read_b128 v[112:115], v0 offset:0
    v_exp_f32 v94, v94
    v_mfma_f32_16x16x32_bf16 a[36:39], v[124:127], v[26:29], a[36:39]
    s_add_u32 m0, s22, 24576
    ds_read_b128 a[220:223], v153 offset:18432
    buffer_load_dwordx4 v6, s[8:11], s21 offen lds
    v_mfma_f32_16x16x32_bf16 a[84:87], v[124:127], v[32:35], a[84:87]
    ds_read_b128 v[120:123], v0 offset:1024
    v_cvt_pk_bf16_f32 v30, v88, v89
    v_mfma_f32_16x16x32_bf16 v[200:203], v[128:131], v[14:17], v[200:203]
    ds_read_b128 a[196:199], v153 offset:12288
    v_fma_f32 v87, v87, s28, v10
    v_mfma_f32_16x16x32_bf16 v[248:251], v[128:131], v[20:23], v[248:251]
    ds_read_b128 a[152:155], v152 offset:2048
    v_fma_f32 v76, v76, s28, v9
    v_mfma_f32_16x16x32_bf16 a[40:43], v[128:131], v[26:29], a[40:43]
    s_add_u32 s21, s21, 128
    ds_read_b128 a[204:207], v153 offset:14336
    v_cvt_pk_bf16_f32 v31, v90, v91
    v_mfma_f32_16x16x32_bf16 a[88:91], v[128:131], v[32:35], a[88:91]
    s_add_u32 m0, s22, 25600
    ds_read_b128 v[124:127], v1 offset:1024
    buffer_load_dwordx4 v6, s[8:11], s21 offen lds
    v_mfma_f32_16x16x32_bf16 v[204:207], v[132:135], v[14:17], v[204:207]
    s_add_u32 s21, s21, 128
    v_exp_f32 v97, v97
    v_mfma_f32_16x16x32_bf16 v[252:255], v[132:135], v[20:23], v[252:255]
    ds_read_b128 a[200:203], v152 offset:14336
    v_cvt_pk_bf16_f32 v37, v98, v99
    v_mfma_f32_16x16x32_bf16 a[44:47], v[132:135], v[26:29], a[44:47]
    s_add_u32 m0, s22, 26624
    ds_read_b128 a[228:231], v153 offset:20480
    v_fma_f32 v103, v103, s28, v12
    v_mfma_f32_16x16x32_bf16 a[92:95], v[132:135], v[32:35], a[92:95]
    s_waitcnt lgkmcnt(8)
    ds_read_b128 a[180:183], v153 offset:8192
    v_cvt_pk_bf16_f32 v36, v96, v97
    v_mfma_f32_16x16x32_bf16 v[72:75], v[112:115], a[144:147], 0
    buffer_load_dwordx4 v6, s[8:11], s21 offen lds
    ds_read_b128 a[224:227], v152 offset:20480
    v_mfma_f32_16x16x32_bf16 v[80:83], v[112:115], a[168:171], 0
    ds_read_b128 a[156:159], v153 offset:2048
    v_exp_f32 v101, v101
    v_mfma_f32_16x16x32_bf16 v[88:91], v[112:115], a[192:195], 0
    ds_read_b128 v[132:135], v1 offset:6144
    v_mfma_f32_16x16x32_bf16 v[96:99], v[112:115], a[216:219], 0
    v_exp_f32 v79, v79
    v_mfma_f32_16x16x32_bf16 v[72:75], v[116:119], a[148:151], v[72:75]
    v_exp_f32 v100, v100
    v_mfma_f32_16x16x32_bf16 v[80:83], v[116:119], a[172:175], v[80:83]
    s_waitcnt lgkmcnt(6)
    ds_read_b128 v[128:131], v0 offset:6144
    v_cvt_pk_bf16_f32 v29, v94, v95
    v_mfma_f32_16x16x32_bf16 v[88:91], v[116:119], a[196:199], v[88:91]
    v_exp_f32 v87, v87
    v_mfma_f32_16x16x32_bf16 v[96:99], v[116:119], a[220:223], v[96:99]
    v_exp_f32 v76, v76
    v_mfma_f32_16x16x32_bf16 v[72:75], v[120:123], a[152:155], v[72:75]
    v_exp_f32 v77, v77
    v_mfma_f32_16x16x32_bf16 v[80:83], v[120:123], a[176:179], v[80:83]
    s_waitcnt lgkmcnt(4)
    ds_read_b128 v[112:115], v0 offset:7168
    v_cvt_pk_bf16_f32 v16, v76, v77
    v_mfma_f32_16x16x32_bf16 v[88:91], v[120:123], a[200:203], v[88:91]
    s_waitcnt lgkmcnt(4)
    v_exp_f32 v93, v93
    v_mfma_f32_16x16x32_bf16 v[96:99], v[120:123], a[224:227], v[96:99]
    s_waitcnt lgkmcnt(3)
    v_exp_f32 v92, v92
    v_mfma_f32_16x16x32_bf16 v[72:75], v[124:127], a[156:159], v[72:75]
    v_cvt_pk_bf16_f32 v34, v100, v101
    v_cvt_pk_bf16_f32 v22, v84, v85
    v_mfma_f32_16x16x32_bf16 v[80:83], v[124:127], a[180:183], v[80:83]
    v_cvt_pk_bf16_f32 v23, v86, v87
    v_cvt_pk_bf16_f32 v28, v92, v93
    v_mfma_f32_16x16x32_bf16 v[88:91], v[124:127], a[204:207], v[88:91]
    v_exp_f32 v78, v78
    v_mfma_f32_16x16x32_bf16 v[96:99], v[124:127], a[228:231], v[96:99]
    s_waitcnt lgkmcnt(1)
    ds_read_b128 v[124:127], v1 offset:2048
    v_cvt_pk_bf16_f32 v17, v78, v79
    v_mfma_f32_16x16x32_bf16 v[76:79], v[128:131], a[144:147], 0
    v_exp_f32 v103, v103
    v_mfma_f32_16x16x32_bf16 v[84:87], v[128:131], a[168:171], 0
    v_exp_f32 v102, v102
    v_mfma_f32_16x16x32_bf16 v[92:95], v[128:131], a[192:195], 0
    v_cvt_pk_bf16_f32 v35, v102, v103
    v_mfma_f32_16x16x32_bf16 v[100:103], v[128:131], a[216:219], 0
    ds_read_b128 a[208:211], v152 offset:16384
    v_mfma_f32_16x16x32_bf16 v[76:79], v[132:135], a[148:151], v[76:79]
    ds_read_b128 v[116:119], v1 offset:7168
    v_mfma_f32_16x16x32_bf16 v[84:87], v[132:135], a[172:175], v[84:87]
    ds_read_b128 v[128:131], v0 offset:8192
    v_mfma_f32_16x16x32_bf16 v[92:95], v[132:135], a[196:199], v[92:95]
    ds_read_b128 v[120:123], v0 offset:2048
    s_add_u32 s21, s21, 12032
    v_mfma_f32_16x16x32_bf16 v[100:103], v[132:135], a[220:223], v[100:103]
    ds_read_b128 v[132:135], v1 offset:8192
    v_mfma_f32_16x16x32_bf16 v[48:51], v[52:55], v[16:19], v[44:47]
    s_waitcnt lgkmcnt(6)
    v_mfma_f32_16x16x32_bf16 v[76:79], v[112:115], a[152:155], v[76:79]
    ds_read_b128 a[164:167], v153 offset:4096
    v_mfma_f32_16x16x32_bf16 v[84:87], v[112:115], a[176:179], v[84:87]
    ds_read_b128 a[188:191], v153 offset:10240
    s_waitcnt vmcnt(7)
    v_mfma_f32_16x16x32_bf16 v[92:95], v[112:115], a[200:203], v[92:95]
    v_mfma_f32_16x16x32_bf16 v[48:51], v[56:59], v[22:25], v[48:51]
    ds_read_b128 a[232:235], v152 offset:22528
    v_mfma_f32_16x16x32_bf16 v[100:103], v[112:115], a[224:227], v[100:103]
    ds_read_b128 a[212:215], v153 offset:16384
    v_mfma_f32_16x16x32_bf16 v[48:51], v[60:63], v[28:31], v[48:51]
    v_mfma_f32_16x16x32_bf16 v[48:51], v[64:67], v[34:37], v[48:51]
    s_waitcnt lgkmcnt(6)
    ds_read_b128 a[236:239], v153 offset:22528
    v_mfma_f32_16x16x32_bf16 v[76:79], v[116:119], a[156:159], v[76:79]
    s_waitcnt vmcnt(14) lgkmcnt(5)
    v_mfma_f32_16x16x32_bf16 v[84:87], v[116:119], a[180:183], v[84:87]
    s_barrier
    v_mfma_f32_16x16x32_bf16 v[92:95], v[116:119], a[204:207], v[92:95]
    ds_read_b64_tr_b16 v[112:113], v2 offset:18432
    v_mfma_f32_16x16x32_bf16 v[100:103], v[116:119], a[228:231], v[100:103]
    ds_read_b64_tr_b16 v[114:115], v2 offset:12288
    v_cmp_lt_f32 vcc, s29, v48
    v_mfma_f32_16x16x32_bf16 v[72:75], v[120:123], a[160:163], v[72:75]
    v_mfma_f32_16x16x32_bf16 v[80:83], v[120:123], a[184:187], v[80:83]
    ds_read_b64_tr_b16 v[116:117], v3 offset:18432
    v_mfma_f32_16x16x32_bf16 v[88:91], v[120:123], a[208:211], v[88:91]
    s_waitcnt lgkmcnt(5)
    ds_read_b64_tr_b16 v[118:119], v3 offset:12288
    v_mfma_f32_16x16x32_bf16 v[96:99], v[120:123], a[232:235], v[96:99]
    s_cbranch_vccnz L_rs_tr44b
L_ret_tr44b:
    ds_read_b64_tr_b16 v[120:121], v4 offset:18432
    v_mfma_f32_16x16x32_bf16 v[72:75], v[124:127], a[164:167], v[72:75]
    v_mfma_f32_16x16x32_bf16 v[80:83], v[124:127], a[188:191], v[80:83]
    s_add_u32 m0, s22, 0
    s_waitcnt lgkmcnt(5)
    v_mfma_f32_16x16x32_bf16 v[88:91], v[124:127], a[212:215], v[88:91]
    v_mfma_f32_16x16x32_bf16 v[96:99], v[124:127], a[236:239], v[96:99]
    buffer_load_dwordx4 v6, s[4:7], s20 offen lds
    v_mfma_f32_16x16x32_bf16 v[76:79], v[128:131], a[160:163], v[76:79]
    s_add_u32 s20, s20, 128
    s_add_u32 m0, s22, 1024
    v_mfma_f32_16x16x32_bf16 v[84:87], v[128:131], a[184:187], v[84:87]
    ds_read_b64_tr_b16 v[122:123], v4 offset:12288
    v_mfma_f32_16x16x32_bf16 v[92:95], v[128:131], a[208:211], v[92:95]
    ds_read_b64_tr_b16 v[124:125], v5 offset:18432
    v_mfma_f32_16x16x32_bf16 v[100:103], v[128:131], a[232:235], v[100:103]
    buffer_load_dwordx4 v6, s[4:7], s20 offen lds
    v_mfma_f32_16x16x32_bf16 v[76:79], v[132:135], a[164:167], v[76:79]
    s_add_u32 s20, s20, 128
    ds_read_b64_tr_b16 v[126:127], v5 offset:12288
    s_add_u32 m0, s22, 2048
    v_mfma_f32_16x16x32_bf16 v[84:87], v[132:135], a[188:191], v[84:87]
    v_mfma_f32_16x16x32_bf16 v[92:95], v[132:135], a[212:215], v[92:95]
    buffer_load_dwordx4 v6, s[4:7], s20 offen lds
    v_mfma_f32_16x16x32_bf16 v[100:103], v[132:135], a[236:239], v[100:103]
    s_add_u32 s20, s20, 12032
    v_max3_f32 v150, v72, v73, v74
    v_max3_f32 v150, v150, v75, v76
    v_max3_f32 v150, v150, v77, v78
    v_max_f32 v150, v150, v79
    v_mov_b32 v151, v150
    s_waitcnt lgkmcnt(6)
    v_mfma_f32_16x16x32_bf16 v[160:163], v[112:115], v[16:19], v[160:163]
    s_mov_b32 s67, s34
    ds_read_b64_tr_b16 v[132:133], v3 offset:19456
    v_permlane32_swap_b32 v151, v150
    v_max_f32 v150, v150, v151
    v_mfma_f32_16x16x32_bf16 v[208:211], v[112:115], v[22:25], v[208:211]
    s_add_u32 s18, s34, 24576
    ds_read_b64_tr_b16 v[130:131], v2 offset:13312
    v_mov_b32 v151, v150
    v_mfma_f32_16x16x32_bf16 a[0:3], v[112:115], v[28:31], a[0:3]
    s_mov_b32 s34, s33
    v_lshrrev_b32 v152, 11, v0
    v_permlane16_swap_b32 v151, v150
    v_max_f32 v150, v150, v151
    v_mfma_f32_16x16x32_bf16 a[48:51], v[112:115], v[34:37], a[48:51]
    s_waitcnt lgkmcnt(6)
    v_mul_f32_e64 v9, -s28, v150
    v_max3_f32 v150, v80, v81, v82
    v_rcp_f32 v51, v51
    v_mfma_f32_16x16x32_bf16 v[164:167], v[116:119], v[16:19], v[164:167]
    s_add_u32 s64, s64, s62
    ds_read_b64_tr_b16 v[128:129], v2 offset:19456
    v_fma_f32 v72, v72, s28, v9
    v_max3_f32 v150, v150, v83, v84
    v_mfma_f32_16x16x32_bf16 v[212:215], v[116:119], v[22:25], v[212:215]
    ds_read_b64_tr_b16 v[134:135], v3 offset:13312
    v_max3_f32 v150, v150, v85, v86
    v_max_f32 v150, v150, v87
    v_mov_b32 v151, v150
    v_accvgpr_read_b32 v156, a48
    v_mfma_f32_16x16x32_bf16 a[4:7], v[116:119], v[28:31], a[4:7]
    s_add_u32 s64, s64, 196608
    ds_read_b64_tr_b16 v[112:113], v4 offset:19456
    v_permlane32_swap_b32 v151, v150
    v_max_f32 v150, v150, v151
    v_mov_b32 v151, v150
    v_mfma_f32_16x16x32_bf16 a[52:55], v[116:119], v[34:37], a[52:55]
    s_waitcnt lgkmcnt(4)
    ds_read_b64_tr_b16 v[114:115], v4 offset:13312
    v_permlane16_swap_b32 v151, v150
    v_mfma_f32_16x16x32_bf16 v[168:171], v[120:123], v[16:19], v[168:171]
    s_mov_b32 s39, s64
    v_fma_f32 v77, v77, s28, v9
    v_accvgpr_read_b32 v157, a49
    v_max_f32 v150, v150, v151
    v_mul_f32_e64 v10, -s28, v150
    v_max3_f32 v150, v88, v89, v90
    v_mfma_f32_16x16x32_bf16 v[216:219], v[120:123], v[22:25], v[216:219]
    s_add_u32 s37, s37, 1
    v_max3_f32 v150, v150, v91, v92
    v_max3_f32 v150, v150, v93, v94
    v_fma_f32 v74, v74, s28, v9
    v_max_f32 v150, v150, v95
    v_mov_b32 v151, v150
    v_mfma_f32_16x16x32_bf16 a[8:11], v[120:123], v[28:31], a[8:11]
    s_bitcmp1_b32 s63, s37
    v_permlane32_swap_b32 v151, v150
    v_mfma_f32_16x16x32_bf16 a[56:59], v[120:123], v[34:37], a[56:59]
    s_cselect_b32 s62, 4294770688, 0
    v_rcp_f32 v49, v49
    v_max_f32 v150, v150, v151
    v_mov_b32 v148, v48
    v_mov_b32 v151, v150
    v_accvgpr_read_b32 v110, a54
    v_mfma_f32_16x16x32_bf16 v[172:175], v[124:127], v[16:19], v[172:175]
    s_cselect_b32 s42, 0, 325632
    ds_read_b64_tr_b16 v[118:119], v5 offset:13312
    v_xor_b32 v152, s65, v152
    v_permlane16_swap_b32 v151, v150
    v_mfma_f32_16x16x32_bf16 v[220:223], v[124:127], v[22:25], v[220:223]
    s_add_u32 s35, s35, s42
    ds_read_b64_tr_b16 v[116:117], v5 offset:19456
    v_fma_f32 v79, v79, s28, v9
    v_mfma_f32_16x16x32_bf16 a[12:15], v[124:127], v[28:31], a[12:15]
    s_lshl_b32 s42, s37, 1
    v_max_f32 v150, v150, v151
    v_mul_f32 v217, v217, v49
    v_mfma_f32_16x16x32_bf16 a[60:63], v[124:127], v[34:37], a[60:63]
    s_waitcnt lgkmcnt(2)
    v_mul_f32 v213, v213, v49
    v_mul_f32_e64 v11, -s28, v150
    v_max3_f32 v150, v96, v97, v98
    v_mfma_f32_16x16x32_bf16 v[176:179], v[128:131], v[16:19], v[176:179]
    s_lshr_b32 s42, s31, s42
    ds_read_b64_tr_b16 v[122:123], v2 offset:14336
    v_mul_f32 v216, v216, v49
    v_mfma_f32_16x16x32_bf16 v[224:227], v[128:131], v[22:25], v[224:227]
    s_and_b32 s42, s42, 3
    ds_read_b64_tr_b16 v[126:127], v3 offset:14336
    v_max3_f32 v150, v150, v99, v100
    v_fma_f32 v88, v88, s28, v11
    v_mfma_f32_16x16x32_bf16 a[16:19], v[128:131], v[28:31], a[16:19]
    s_add_u32 s42, s42, s36
    v_accvgpr_read_b32 v109, a53
    v_mul_f32 v157, v157, v51
    v_fma_f32 v82, v82, s28, v10
    s_sub_u32 s43, s42, 3
    v_mfma_f32_16x16x32_bf16 a[64:67], v[128:131], v[34:37], a[64:67]
    s_cmp_ge_u32 s42, 3
    ds_read_b64_tr_b16 v[120:121], v2 offset:20480
    v_max3_f32 v150, v150, v101, v102
    v_mfma_f32_16x16x32_bf16 v[180:183], v[132:135], v[16:19], v[180:183]
    s_cselect_b32 s42, s43, s42
    v_fma_f32 v78, v78, s28, v9
    v_fma_f32 v85, v85, s28, v10
    v_mfma_f32_16x16x32_bf16 v[228:231], v[132:135], v[22:25], v[228:231]
    s_mul_i32 s44, s3, 5
    v_cvt_pk_bf16_f32 v216, v216, v217
    v_max_f32 v150, v150, v103
    v_exp_f32 v88, v88
    v_mul_f32 v211, v211, v49
    v_mfma_f32_16x16x32_bf16 a[20:23], v[132:135], v[28:31], a[20:23]
    s_mov_b32 s32, 1
    v_fma_f32 v91, v91, s28, v11
    v_fma_f32 v76, v76, s28, v9
    v_exp_f32 v78, v78
    v_and_b32 v149, 0x3ff, v0
    v_mfma_f32_16x16x32_bf16 a[68:71], v[132:135], v[34:37], a[68:71]
    s_lshl_b32 s43, s3, 2
    v_mov_b32 v151, v150
    v_fma_f32 v87, v87, s28, v10
    v_fma_f32 v84, v84, s28, v10
    v_fma_f32 v95, v95, s28, v11
    v_mul_f32 v220, v220, v49
    v_mfma_f32_16x16x32_bf16 v[184:187], v[112:115], v[16:19], v[184:187]
    s_add_u32 s45, s43, 21
    s_cmp_eq_u32 s3, 0
    v_permlane32_swap_b32 v48, v148
    v_exp_f32 v82, v82
    v_mfma_f32_16x16x32_bf16 v[232:235], v[112:115], v[22:25], v[232:235]
    s_cselect_b32 s45, 20, s45
    ds_read_b64_tr_b16 v[132:133], v5 offset:20480
    v_permlane32_swap_b32 v151, v150
    v_mul_f32 v231, v231, v49
    v_mfma_f32_16x16x32_bf16 a[24:27], v[112:115], v[28:31], a[24:27]
    s_cselect_b32 s33, 1, 0
    ds_read_b64_tr_b16 v[124:125], v3 offset:20480
    v_mul_f32 v156, v156, v51
    v_max_f32 v150, v150, v151
    v_fma_f32 v83, v83, s28, v10
    v_fma_f32 v75, v75, s28, v9
    v_fma_f32 v73, v73, s28, v9
    v_mfma_f32_16x16x32_bf16 a[72:75], v[112:115], v[34:37], a[72:75]
    s_waitcnt lgkmcnt(2)
    v_mul_f32 v110, v110, v51
    v_fma_f32 v94, v94, s28, v11
    v_mfma_f32_16x16x32_bf16 v[188:191], v[116:119], v[16:19], v[188:191]
    s_cmp_eq_u32 s42, 1
    v_exp_f32 v74, v74
    v_mul_f32 v219, v219, v49
    v_mfma_f32_16x16x32_bf16 v[236:239], v[116:119], v[22:25], v[236:239]
    s_cselect_b32 s44, s45, s44
    ds_read_b64_tr_b16 v[130:131], v4 offset:14336
    v_mov_b32 v151, v150
    v_mfma_f32_16x16x32_bf16 a[28:31], v[116:119], v[28:31], a[28:31]
    s_cselect_b32 s32, s33, s32
    ds_read_b64_tr_b16 v[128:129], v4 offset:20480
    v_fma_f32 v86, v86, s28, v10
    v_accvgpr_read_b32 v111, a55
    v_fma_f32 v92, v92, s28, v11
    v_fma_f32 v90, v90, s28, v11
    v_mul_f32 v214, v214, v49
    v_lshl_add_u32 v149, v152, 10, v149
    v_mfma_f32_16x16x32_bf16 a[76:79], v[116:119], v[34:37], a[76:79]
    s_add_u32 s45, s43, 37
    ds_read_b64_tr_b16 v[134:135], v5 offset:14336
    v_exp_f32 v83, v83
    v_accvgpr_read_b32 v108, a52
    v_permlane16_swap_b32 v151, v150
    v_exp_f32 v72, v72
    v_mul_f32 v221, v221, v49
    v_fma_f32 v80, v80, s28, v10
    v_mul_f32 v228, v228, v49
    v_mfma_f32_16x16x32_bf16 v[192:195], v[120:123], v[16:19], v[192:195]
    s_cmp_eq_u32 s42, 2
    v_mul_f32 v208, v208, v49
    v_accvgpr_read_b32 v155, a3
    v_mfma_f32_16x16x32_bf16 v[240:243], v[120:123], v[22:25], v[240:243]
    s_cselect_b32 s44, s45, s44
    v_accvgpr_read_b32 v154, a2
    v_cvt_pk_bf16_f32 v21, v82, v83
    v_mfma_f32_16x16x32_bf16 a[32:35], v[120:123], v[28:31], a[32:35]
    s_cselect_b32 s32, 0, s32
    s_mul_i32 s44, s44, 6144
    v_max_f32 v150, v150, v151
    v_mul_f32 v209, v209, v49
    v_mul_f32_e64 v12, -s28, v150
    v_fma_f32 v97, v97, s28, v12
    v_fma_f32 v81, v81, s28, v10
    v_exp_f32 v79, v79
    s_add_u32 s33, s35, s44
    v_mfma_f32_16x16x32_bf16 a[80:83], v[120:123], v[34:37], a[80:83]
    s_waitcnt lgkmcnt(1)
    v_accvgpr_read_b32 v159, a51
    v_mul_f32 v239, v239, v49
    v_mfma_f32_16x16x32_bf16 v[196:199], v[124:127], v[16:19], v[196:199]
    s_mul_i32 s42, s32, 6144
    v_exp_f32 v75, v75
    v_mfma_f32_16x16x32_bf16 v[244:247], v[124:127], v[22:25], v[244:247]
    s_add_u32 s42, s42, 24576
    v_mbcnt_lo_u32_b32 v152, -1, 0
    v_mul_f32 v225, v225, v49
    v_mfma_f32_16x16x32_bf16 a[36:39], v[124:127], v[28:31], a[36:39]
    s_add_u32 s42, s42, s33
    s_cmp_ge_u32 s37, 6
    v_fma_f32 v101, v101, s28, v12
    v_mfma_f32_16x16x32_bf16 a[84:87], v[124:127], v[34:37], a[84:87]
    s_cselect_b32 s14, 0, s42
    v_exp_f32 v81, v81
    v_accvgpr_read_b32 v107, a7
    s_add_u32 s24, s67, 6400
    v_mfma_f32_16x16x32_bf16 v[200:203], v[128:131], v[16:19], v[200:203]
    s_add_u32 s25, s33, 6400
    v_fma_f32 v89, v89, s28, v11
    s_add_u32 s23, s38, 10240
    v_mfma_f32_16x16x32_bf16 v[248:251], v[128:131], v[22:25], v[248:251]
    s_mov_b32 s27, 0x49249249
    v_exp_f32 v73, v73
    v_rcp_f32 v48, v48
    v_accvgpr_read_b32 v105, a5
    v_cvt_pk_bf16_f32 v156, v156, v157
    s_mov_b32 s30, 0
    v_mul_f32 v246, v246, v49
    v_mfma_f32_16x16x32_bf16 a[40:43], v[128:131], v[28:31], a[40:43]
    s_waitcnt vmcnt(6) lgkmcnt(0)
    v_fma_f32 v99, v99, s28, v12
    v_mul_f32 v241, v241, v49
    v_mfma_f32_16x16x32_bf16 a[88:91], v[128:131], v[34:37], a[88:91]
    s_barrier
    ds_read_b128 v[112:115], v0 offset:12288
    v_fma_f32 v96, v96, s28, v12
    v_exp_f32 v97, v97
    v_exp_f32 v80, v80
    v_mul_f32 v238, v238, v49
    v_fma_f32 v100, v100, s28, v12
    v_mfma_f32_16x16x32_bf16 v[204:207], v[132:135], v[16:19], v[204:207]
    ds_read_b128 v[116:119], v1 offset:12288
    v_fma_f32 v98, v98, s28, v12
    v_exp_f32 v99, v99
    v_exp_f32 v92, v92
    v_mbcnt_hi_u32_b32 v152, -1, v152
    v_cvt_pk_bf16_f32 v20, v80, v81
    v_mfma_f32_16x16x32_bf16 v[252:255], v[132:135], v[22:25], v[252:255]
    ds_read_b128 v[120:123], v0 offset:13312
    v_exp_f32 v94, v94
    v_cvt_pk_bf16_f32 v15, v74, v75
    v_mul_f32 v109, v109, v51
    v_accvgpr_read_b32 v106, a6
    v_exp_f32 v90, v90
    v_add_u32 v149, s38, v149
    v_mfma_f32_16x16x32_bf16 a[44:47], v[132:135], v[28:31], a[44:47]
    v_exp_f32 v96, v96
    v_cvt_pk_bf16_f32 v14, v72, v73
    v_mul_f32 v222, v222, v49
    v_fma_f32 v93, v93, s28, v11
    v_exp_f32 v89, v89
    v_accvgpr_read_b32 v158, a50
    v_mul_f32 v229, v229, v49
    v_cvt_pk_bf16_f32 v26, v88, v89
    v_exp_f32 v85, v85
    v_exp_f32 v95, v95
    v_cvt_pk_bf16_f32 v32, v96, v97
    v_mfma_f32_16x16x32_bf16 a[92:95], v[132:135], v[34:37], a[92:95]
    s_waitcnt lgkmcnt(2)
    ds_read_b128 v[132:135], v1 offset:14336
    v_exp_f32 v91, v91
    v_mul_f32 v255, v255, v49
    v_mfma_f32_16x16x32_bf16 v[72:75], v[112:115], a[144:147], 0
    s_waitcnt lgkmcnt(2)
    v_mul_f32 v240, v240, v49
    v_exp_f32 v100, v100
    v_mul_f32 v232, v232, v49
    v_mfma_f32_16x16x32_bf16 v[72:75], v[116:119], a[148:151], v[72:75]
    s_waitcnt lgkmcnt(1)
    v_mul_f32 v252, v252, v49
    v_cvt_pk_bf16_f32 v208, v208, v209
    v_mfma_f32_16x16x32_bf16 v[72:75], v[120:123], a[152:155], v[72:75]
    ds_read_b128 v[128:131], v0 offset:14336
    v_mul_f32 v254, v254, v49
    v_mfma_f32_16x16x32_bf16 v[80:83], v[112:115], a[168:171], 0
    v_cvt_pk_bf16_f32 v27, v90, v91
    v_lshrrev_b32 v152, 1, v152
    v_fma_f32 v102, v102, s28, v12
    v_mfma_f32_16x16x32_bf16 v[80:83], v[116:119], a[172:175], v[80:83]
    ds_read_b128 v[124:127], v1 offset:13312
    v_exp_f32 v98, v98
    v_mul_f32 v226, v226, v49
    v_mfma_f32_16x16x32_bf16 v[80:83], v[120:123], a[176:179], v[80:83]
    v_cvt_pk_bf16_f32 v33, v98, v99
    v_mul_f32 v210, v210, v49
    v_mfma_f32_16x16x32_bf16 v[88:91], v[112:115], a[192:195], 0
    v_mul_f32 v253, v253, v49
    v_exp_f32 v101, v101
    v_mul_f32 v243, v243, v49
    v_mul_f32 v249, v249, v49
    v_accvgpr_read_b32 v153, a1
    v_mfma_f32_16x16x32_bf16 v[88:91], v[116:119], a[196:199], v[88:91]
    v_mul_f32 v212, v212, v49
    v_mul_f32 v223, v223, v49
    v_exp_f32 v76, v76
    v_exp_f32 v87, v87
    v_fma_f32 v103, v103, s28, v12
    v_mfma_f32_16x16x32_bf16 v[88:91], v[120:123], a[200:203], v[88:91]
    v_exp_f32 v84, v84
    v_mfma_f32_16x16x32_bf16 v[96:99], v[112:115], a[216:219], 0
    v_rcp_f32 v50, v50
    v_cvt_pk_bf16_f32 v34, v100, v101
    v_and_b32 v152, 24, v152
    v_cvt_pk_bf16_f32 v29, v94, v95
    v_mfma_f32_16x16x32_bf16 v[96:99], v[116:119], a[220:223], v[96:99]
    v_mul_f32 v233, v233, v49
    v_bfe_u32 v152, s66, v152, 8
    v_mul_f32 v159, v159, v51
    v_mfma_f32_16x16x32_bf16 v[96:99], v[120:123], a[224:227], v[96:99]
    s_waitcnt lgkmcnt(0)
    v_cvt_pk_bf16_f32 v212, v212, v213
    v_mul_f32 v234, v234, v49
    v_mfma_f32_16x16x32_bf16 v[72:75], v[124:127], a[156:159], v[72:75]
    ds_read_b128 v[112:115], v0 offset:18432
    v_mul_f32 v218, v218, v49
    v_mfma_f32_16x16x32_bf16 v[72:75], v[128:131], a[160:163], v[72:75]
    s_add_u32 m0, s22, 36864
    v_mul_f32 v230, v230, v49
    v_cvt_pk_bf16_f32 v220, v220, v221
    v_exp_f32 v102, v102
    v_mfma_f32_16x16x32_bf16 v[72:75], v[132:135], a[164:167], v[72:75]
    ds_read_b128 v[120:123], v0 offset:19456
    v_exp_f32 v93, v93
    v_mfma_f32_16x16x32_bf16 v[80:83], v[124:127], a[180:183], v[80:83]
    ds_read_b128 v[116:119], v1 offset:18432
    v_exp_f32 v77, v77
    v_mfma_f32_16x16x32_bf16 v[80:83], v[128:131], a[184:187], v[80:83]
    v_xor_b32 v149, v149, v152
    v_accvgpr_read_b32 v152, a0
    v_mul_f32 v227, v227, v49
    v_mfma_f32_16x16x32_bf16 v[80:83], v[132:135], a[188:191], v[80:83]
    buffer_load_dwordx4 v6, s[8:11], s21 offen lds
    v_mul_f32 v158, v158, v51
    v_exp_f32 v86, v86
    v_pk_mul_f32 v[176:177], v[176:177], v[48:49] op_sel_hi:[1,0]
    v_pk_mul_f32 v[164:165], v[164:165], v[48:49] op_sel_hi:[1,0]
    v_pk_mul_f32 v[160:161], v[160:161], v[48:49] op_sel_hi:[1,0]
    v_mul_f32 v224, v224, v49
    v_pk_mul_f32 v[192:193], v[192:193], v[48:49] op_sel_hi:[1,0]
    v_cvt_pk_bf16_f32 v17, v78, v79
    v_pk_mul_f32 v[168:169], v[168:169], v[48:49] op_sel_hi:[1,0]
    v_pk_mul_f32 v[184:185], v[184:185], v[48:49] op_sel_hi:[1,0]
    v_pk_mul_f32 v[152:153], v[152:153], v[50:51] op_sel_hi:[1,0]
    v_pk_mul_f32 v[154:155], v[154:155], v[50:51] op_sel_hi:[1,0]
    v_mul_f32 v108, v108, v51
    v_mul_f32 v215, v215, v49
    v_pk_mul_f32 v[106:107], v[106:107], v[50:51] op_sel_hi:[1,0]
    v_pk_mul_f32 v[162:163], v[162:163], v[48:49] op_sel_hi:[1,0]
    v_accvgpr_read_b32 v104, a4
    v_pk_mul_f32 v[166:167], v[166:167], v[48:49] op_sel_hi:[1,0]
    v_pk_mul_f32 v[182:183], v[182:183], v[48:49] op_sel_hi:[1,0]
    v_fma_f32 v83, v83, s28, v10
    v_pk_mul_f32 v[172:173], v[172:173], v[48:49] op_sel_hi:[1,0]
    v_pk_mul_f32 v[104:105], v[104:105], v[50:51] op_sel_hi:[1,0]
    v_mul_f32 v235, v235, v49
    v_cvt_pk_bf16_f32 v22, v84, v85
    v_mfma_f32_16x16x32_bf16 v[88:91], v[124:127], a[204:207], v[88:91]
    v_mul_f32 v245, v245, v49
    v_exp_f32 v103, v103
    v_mfma_f32_16x16x32_bf16 v[88:91], v[128:131], a[208:211], v[88:91]
    v_cvt_pk_bf16_f32 v152, v152, v153
    v_cvt_pk_bf16_f32 v160, v160, v161
    v_mfma_f32_16x16x32_bf16 v[88:91], v[132:135], a[212:215], v[88:91]
    v_cvt_pk_bf16_f32 v153, v154, v155
    v_cvt_pk_bf16_f32 v28, v92, v93
    v_cvt_pk_bf16_f32 v217, v218, v219
    v_mfma_f32_16x16x32_bf16 v[96:99], v[124:127], a[228:231], v[96:99]
    v_cvt_pk_bf16_f32 v104, v104, v105
    v_accvgpr_read_b32 v155, a11
    v_mfma_f32_16x16x32_bf16 v[96:99], v[128:131], a[232:235], v[96:99]
    s_add_u32 s21, s21, 128
    ds_read_b128 v[124:127], v1 offset:19456
    v_cvt_pk_bf16_f32 v209, v210, v211
    v_mfma_f32_16x16x32_bf16 v[96:99], v[132:135], a[236:239], v[96:99]
    s_waitcnt lgkmcnt(1)
    v_cvt_pk_bf16_f32 v161, v162, v163
    v_cvt_pk_bf16_f32 v16, v76, v77
    v_mfma_f32_16x16x32_bf16 v[76:79], v[112:115], a[144:147], 0
    s_add_u32 m0, s22, 37888
    v_cvt_pk_bf16_f32 v105, v106, v107
    v_cvt_pk_bf16_f32 v23, v86, v87
    v_mfma_f32_16x16x32_bf16 v[76:79], v[116:119], a[148:151], v[76:79]
    ds_read_b128 v[132:135], v1 offset:20480
    v_cvt_pk_bf16_f32 v108, v108, v109
    v_mfma_f32_16x16x32_bf16 v[76:79], v[120:123], a[152:155], v[76:79]
    v_accvgpr_read_b32 v106, a14
    v_mul_f32 v111, v111, v51
    v_mul_f32 v236, v236, v49
    v_mfma_f32_16x16x32_bf16 v[84:87], v[112:115], a[168:171], 0
    v_cvt_pk_bf16_f32 v157, v158, v159
    v_fma_f32 v74, v74, s28, v9
    v_cvt_pk_bf16_f32 v35, v102, v103
    v_mfma_f32_16x16x32_bf16 v[84:87], v[116:119], a[172:175], v[84:87]
    ds_read_b128 v[128:131], v0 offset:20480
    v_cvt_pk_bf16_f32 v168, v168, v169
    v_exp_f32 v74, v74
    v_cvt_pk_bf16_f32 v252, v252, v253
    v_mfma_f32_16x16x32_bf16 v[84:87], v[120:123], a[176:179], v[84:87]
    ds_write2st64_b64 v149, v[160:161], v[208:209] offset0:0 offset1:12
    v_mfma_f32_16x16x32_bf16 v[92:95], v[112:115], a[192:195], 0
    buffer_load_dwordx4 v6, s[8:11], s21 offen lds
    v_mfma_f32_16x16x32_bf16 v[92:95], v[116:119], a[196:199], v[92:95]
    s_add_u32 s21, s21, 128
    ds_write2st64_b64 v149, v[152:153], v[156:157] offset0:24 offset1:36
    v_mfma_f32_16x16x32_bf16 v[92:95], v[120:123], a[200:203], v[92:95]
    s_add_u32 m0, s22, 38912
    v_cvt_pk_bf16_f32 v109, v110, v111
    v_accvgpr_read_b32 v158, a58
    v_accvgpr_read_b32 v157, a57
    v_accvgpr_read_b32 v159, a59
    v_cvt_pk_bf16_f32 v213, v214, v215
    v_mfma_f32_16x16x32_bf16 v[100:103], v[112:115], a[216:219], 0
    buffer_load_dwordx4 v6, s[8:11], s21 offen lds
    v_mfma_f32_16x16x32_bf16 v[100:103], v[116:119], a[220:223], v[100:103]
    s_add_u32 s21, s21, 12032
    v_accvgpr_read_b32 v156, a56
    v_fma_f32 v99, v99, s28, v12
    v_mfma_f32_16x16x32_bf16 v[44:47], v[52:55], v[14:17], 0
    s_waitcnt vmcnt(6) lgkmcnt(2)
    v_mul_f32 v237, v237, v49
    v_fma_f32 v75, v75, s28, v9
    v_mfma_f32_16x16x32_bf16 v[44:47], v[56:59], v[20:23], v[44:47]
    s_barrier
    ds_read_b64_tr_b16 v[112:113], v2 offset:0
    v_mfma_f32_16x16x32_bf16 v[100:103], v[120:123], a[224:227], v[100:103]
    v_fma_f32 v98, v98, s28, v12
    v_accvgpr_read_b32 v153, a9
    v_xor_b32 v149, 32, v149
    v_mfma_f32_16x16x32_bf16 v[44:47], v[60:63], v[26:29], v[44:47]
    v_accvgpr_read_b32 v111, a63
    v_fma_f32 v80, v80, s28, v10
    v_accvgpr_read_b32 v152, a8
    v_mul_f32 v159, v159, v51
    v_cvt_pk_bf16_f32 v164, v164, v165
    v_accvgpr_read_b32 v110, a62
    v_cvt_pk_bf16_f32 v176, v176, v177
    v_mfma_f32_16x16x32_bf16 v[76:79], v[124:127], a[156:159], v[76:79]
    s_add_u32 m0, s22, 12288
    ds_read_b64_tr_b16 v[114:115], v2 offset:6144
    v_fma_f32 v82, v82, s28, v10
    v_cvt_pk_bf16_f32 v165, v166, v167
    v_mfma_f32_16x16x32_bf16 v[76:79], v[128:131], a[160:163], v[76:79]
    ds_read_b64_tr_b16 v[116:117], v3 offset:0
    v_cvt_pk_bf16_f32 v184, v184, v185
    v_cvt_pk_bf16_f32 v172, v172, v173
    v_mul_f32 v156, v156, v51
    v_mul_f32 v157, v157, v51
    v_mfma_f32_16x16x32_bf16 v[76:79], v[132:135], a[164:167], v[76:79]
    ds_read_b64_tr_b16 v[118:119], v3 offset:6144
    v_accvgpr_read_b32 v154, a10
    v_fma_f32 v81, v81, s28, v10
    v_mul_f32 v248, v248, v49
    v_fma_f32 v89, v89, s28, v11
    v_subrev_u32 v8, 22528, v8
    v_mfma_f32_16x16x32_bf16 v[84:87], v[124:127], a[180:183], v[84:87]
    ds_write2st64_b64 v149, v[164:165], v[212:213] offset0:0 offset1:12
    v_pk_mul_f32 v[152:153], v[152:153], v[50:51] op_sel_hi:[1,0]
    v_cvt_pk_bf16_f32 v156, v156, v157
    v_pk_mul_f32 v[180:181], v[180:181], v[48:49] op_sel_hi:[1,0]
    v_fma_f32 v73, v73, s28, v9
    v_accvgpr_read_b32 v107, a15
    v_mfma_f32_16x16x32_bf16 v[84:87], v[128:131], a[184:187], v[84:87]
    buffer_load_dwordx4 v6, s[4:7], s20 offen lds
    v_mfma_f32_16x16x32_bf16 v[84:87], v[132:135], a[188:191], v[84:87]
    ds_write2st64_b64 v149, v[104:105], v[108:109] offset0:24 offset1:36
    v_fma_f32 v72, v72, s28, v9
    v_mul_f32 v247, v247, v49
    v_pk_mul_f32 v[170:171], v[170:171], v[48:49] op_sel_hi:[1,0]
    v_pk_mul_f32 v[178:179], v[178:179], v[48:49] op_sel_hi:[1,0]
    v_cvt_pk_bf16_f32 v224, v224, v225
    v_pk_mul_f32 v[106:107], v[106:107], v[50:51] op_sel_hi:[1,0]
    v_pk_mul_f32 v[154:155], v[154:155], v[50:51] op_sel_hi:[1,0]
    v_cvt_pk_bf16_f32 v177, v178, v179
    v_pk_mul_f32 v[196:197], v[196:197], v[48:49] op_sel_hi:[1,0]
    v_xor_b32 v149, 96, v149
    v_mul_f32 v110, v110, v51
    v_accvgpr_read_b32 v108, a60
    v_cvt_pk_bf16_f32 v152, v152, v153
    v_exp_f32 v81, v81
    v_mfma_f32_16x16x32_bf16 v[92:95], v[124:127], a[204:207], v[92:95]
    ds_read_b64_tr_b16 v[120:121], v4 offset:0
    v_mul_f32 v111, v111, v51
    v_mfma_f32_16x16x32_bf16 v[92:95], v[128:131], a[208:211], v[92:95]
    ds_read_b64_tr_b16 v[122:123], v4 offset:6144
    v_accvgpr_read_b32 v109, a61
    v_cvt_pk_bf16_f32 v240, v240, v241
    v_cvt_pk_bf16_f32 v153, v154, v155
    v_exp_f32 v80, v80
    v_cvt_pk_bf16_f32 v236, v236, v237
    v_mfma_f32_16x16x32_bf16 v[92:95], v[132:135], a[212:215], v[92:95]
    v_mul_f32 v158, v158, v51
    v_fma_f32 v76, v76, s28, v9
    v_mul_f32 v109, v109, v51
    v_accvgpr_read_b32 v104, a12
    v_cvt_pk_bf16_f32 v169, v170, v171
    v_mul_f32 v244, v244, v49
    v_accvgpr_read_b32 v105, a13
    v_mul_f32 v242, v242, v49
    v_mfma_f32_16x16x32_bf16 v[100:103], v[124:127], a[228:231], v[100:103]
    ds_write2st64_b64 v149, v[168:169], v[216:217] offset0:0 offset1:12
    v_pk_mul_f32 v[174:175], v[174:175], v[48:49] op_sel_hi:[1,0]
    v_cvt_pk_bf16_f32 v241, v242, v243
    v_fma_f32 v88, v88, s28, v11
    v_exp_f32 v73, v73
    v_fma_f32 v87, v87, s28, v10
    v_pk_mul_f32 v[104:105], v[104:105], v[50:51] op_sel_hi:[1,0]
    v_fma_f32 v97, v97, s28, v12
    v_fma_f32 v78, v78, s28, v9
    v_exp_f32 v83, v83
    v_accvgpr_read_b32 v155, a19
    v_pk_mul_f32 v[186:187], v[186:187], v[48:49] op_sel_hi:[1,0]
    v_cvt_pk_bf16_f32 v180, v180, v181
    v_cvt_pk_bf16_f32 v157, v158, v159
    v_mul_f32 v108, v108, v51
    v_mfma_f32_16x16x32_bf16 v[100:103], v[128:131], a[232:235], v[100:103]
    s_add_u32 s20, s20, 128
    ds_read_b64_tr_b16 v[130:131], v2 offset:7168
    v_fma_f32 v96, v96, s28, v12
    v_cvt_pk_bf16_f32 v104, v104, v105
    v_mfma_f32_16x16x32_bf16 v[100:103], v[132:135], a[236:239], v[100:103]
    s_waitcnt lgkmcnt(2)
    ds_write2st64_b64 v149, v[152:153], v[156:157] offset0:24 offset1:36
    v_mfma_f32_16x16x32_bf16 v[160:163], v[112:115], v[14:17], 0
    v_accvgpr_read_b32 v156, a64
    v_cvt_pk_bf16_f32 v108, v108, v109
    v_cvt_pk_bf16_f32 v173, v174, v175
    v_fma_f32 v77, v77, s28, v9
    v_accvgpr_read_b32 v157, a65
    v_cvt_pk_bf16_f32 v192, v192, v193
    v_cvt_pk_bf16_f32 v24, v80, v81
    v_pk_mul_f32 v[200:201], v[200:201], v[48:49] op_sel_hi:[1,0]
    v_cvt_pk_bf16_f32 v244, v244, v245
    v_pk_mul_f32 v[204:205], v[204:205], v[48:49] op_sel_hi:[1,0]
    v_accvgpr_read_b32 v159, a67
    v_mul_f32 v157, v157, v51
    v_cvt_pk_bf16_f32 v109, v110, v111
    v_mul_f32 v156, v156, v51
    v_xor_b32 v149, 32, v149
    v_cvt_pk_bf16_f32 v196, v196, v197
    v_pk_mul_f32 v[190:191], v[190:191], v[48:49] op_sel_hi:[1,0]
    v_accvgpr_read_b32 v152, a16
    v_pk_mul_f32 v[188:189], v[188:189], v[48:49] op_sel_hi:[1,0]
    v_cvt_pk_bf16_f32 v221, v222, v223
    v_cvt_pk_bf16_f32 v105, v106, v107
    v_mfma_f32_16x16x32_bf16 v[208:211], v[112:115], v[20:23], 0
    s_add_u32 m0, s22, 13312
    ds_read_b64_tr_b16 v[134:135], v3 offset:7168
    v_cvt_pk_bf16_f32 v225, v226, v227
    v_cvt_pk_bf16_f32 v204, v204, v205
    v_mul_f32 v251, v251, v49
    v_accvgpr_read_b32 v154, a18
    v_mfma_f32_16x16x32_bf16 a[0:3], v[112:115], v[26:29], 0
    buffer_load_dwordx4 v6, s[4:7], s20 offen lds
    ds_read_b64_tr_b16 v[124:125], v5 offset:0
    v_mfma_f32_16x16x32_bf16 a[48:51], v[112:115], v[32:35], 0
    ds_read_b64_tr_b16 v[128:129], v2 offset:1024
    v_cvt_pk_bf16_f32 v181, v182, v183
    v_mfma_f32_16x16x32_bf16 v[164:167], v[116:119], v[14:17], 0
    ds_write2st64_b64 v149, v[172:173], v[220:221] offset0:0 offset1:12
    v_exp_f32 v76, v76
    v_exp_f32 v89, v89
    v_accvgpr_read_b32 v106, a22
    v_accvgpr_read_b32 v110, a70
    v_mfma_f32_16x16x32_bf16 v[212:215], v[116:119], v[20:23], 0
    ds_read_b64_tr_b16 v[126:127], v5 offset:6144
    v_accvgpr_read_b32 v107, a23
    v_mfma_f32_16x16x32_bf16 a[4:7], v[116:119], v[26:29], 0
    ds_read_b128 v[144:147], v8 offset:0
    v_accvgpr_read_b32 v158, a66
    v_mfma_f32_16x16x32_bf16 a[52:55], v[116:119], v[32:35], 0
    s_add_u32 s20, s20, 128
    ds_write2st64_b64 v149, v[104:105], v[108:109] offset0:24 offset1:36
    v_pk_mul_f32 v[154:155], v[154:155], v[50:51] op_sel_hi:[1,0]
    v_pk_mul_f32 v[206:207], v[206:207], v[48:49] op_sel_hi:[1,0]
    v_accvgpr_read_b32 v111, a71
    v_pk_mul_f32 v[194:195], v[194:195], v[48:49] op_sel_hi:[1,0]
    v_mul_f32 v159, v159, v51
    v_cvt_pk_bf16_f32 v200, v200, v201
    v_xor_b32 v149, 96, v149
    v_fma_f32 v84, v84, s28, v10
    v_accvgpr_read_b32 v108, a68
    v_mul_f32 v158, v158, v51
    v_mfma_f32_16x16x32_bf16 v[44:47], v[64:67], v[32:35], v[44:47]
    s_add_u32 m0, s22, 14336
    ds_read_b64_tr_b16 v[132:133], v3 offset:1024
    v_cvt_pk_bf16_f32 v185, v186, v187
    v_exp_f32 v77, v77
    v_cvt_pk_bf16_f32 v156, v156, v157
    v_mfma_f32_16x16x32_bf16 v[168:171], v[120:123], v[14:17], 0
    v_exp_f32 v88, v88
    v_exp_f32 v82, v82
    v_accvgpr_read_b32 v105, a21
    v_mfma_f32_16x16x32_bf16 v[216:219], v[120:123], v[20:23], 0
    buffer_load_dwordx4 v6, s[4:7], s20 offen lds
    ds_read_b64_tr_b16 v[112:113], v4 offset:1024
    v_accvgpr_read_b32 v109, a69
    v_accvgpr_read_b32 v153, a17
    v_mul_f32 v109, v109, v51
    v_exp_f32 v72, v72
    v_fma_f32 v102, v102, s28, v12
    v_accvgpr_read_b32 v104, a20
    v_mul_f32 v108, v108, v51
    v_cvt_pk_bf16_f32 v108, v108, v109
    v_cvt_pk_bf16_f32 v228, v228, v229
    v_pk_mul_f32 v[152:153], v[152:153], v[50:51] op_sel_hi:[1,0]
    v_mul_f32 v110, v110, v51
    v_pk_mul_f32 v[106:107], v[106:107], v[50:51] op_sel_hi:[1,0]
    v_pk_mul_f32 v[104:105], v[104:105], v[50:51] op_sel_hi:[1,0]
    v_cvt_pk_bf16_f32 v232, v232, v233
    v_cvt_pk_bf16_f32 v157, v158, v159
    v_cvt_pk_bf16_f32 v248, v248, v249
    v_cvt_pk_bf16_f32 v104, v104, v105
    v_cvt_pk_bf16_f32 v152, v152, v153
    v_mfma_f32_16x16x32_bf16 a[8:11], v[120:123], v[26:29], 0
    ds_write2st64_b64 v149, v[176:177], v[224:225] offset0:4 offset1:16
    v_exp_f32 v75, v75
    v_mfma_f32_16x16x32_bf16 a[56:59], v[120:123], v[32:35], 0
    s_waitcnt lgkmcnt(2)
    ds_read_b64_tr_b16 v[114:115], v4 offset:7168
    v_cvt_pk_bf16_f32 v153, v154, v155
    v_mfma_f32_16x16x32_bf16 v[172:175], v[124:127], v[14:17], 0
    buffer_store_dwordx4 v[144:147], v6, s[16:19], s67 offen sc0 sc1 nt
    s_add_u32 s20, s20, 12032
    ds_read_b64_tr_b16 v[120:121], v2 offset:2048
    v_accvgpr_read_b32 v155, a27
    v_pk_mul_f32 v[202:203], v[202:203], v[48:49] op_sel_hi:[1,0]
    v_accvgpr_read_b32 v159, a75
    v_mul_f32 v250, v250, v49
    v_mfma_f32_16x16x32_bf16 v[220:223], v[124:127], v[20:23], 0
    s_add_u32 m0, s38, 0
    ds_write2st64_b64 v149, v[152:153], v[156:157] offset0:28 offset1:40
    v_mul_f32 v111, v111, v51
    v_exp_f32 v98, v98
    v_cvt_pk_bf16_f32 v193, v194, v195
    v_accvgpr_read_b32 v158, a74
    v_cvt_pk_bf16_f32 v233, v234, v235
    v_accvgpr_read_b32 v153, a25
    v_xor_b32 v149, 32, v149
    v_accvgpr_read_b32 v152, a24
    v_pk_mul_f32 v[152:153], v[152:153], v[50:51] op_sel_hi:[1,0]
    v_cvt_pk_bf16_f32 v109, v110, v111
    v_fma_f32 v92, v92, s28, v11
    v_accvgpr_read_b32 v157, a73
    v_mfma_f32_16x16x32_bf16 a[12:15], v[124:127], v[26:29], 0
    ds_read_b64_tr_b16 v[116:117], v5 offset:1024
    v_cvt_pk_bf16_f32 v105, v106, v107
    v_cvt_pk_bf16_f32 v237, v238, v239
    v_accvgpr_read_b32 v154, a26
    v_cvt_pk_bf16_f32 v229, v230, v231
    v_mfma_f32_16x16x32_bf16 a[60:63], v[124:127], v[32:35], 0
    buffer_load_dwordx4 v6, s[12:15], s33 offen nt lds
    ds_read_b128 v[144:147], v8 offset:1024
    v_mul_f32 v159, v159, v51
    v_accvgpr_read_b32 v106, a30
    v_mfma_f32_16x16x32_bf16 v[176:179], v[128:131], v[14:17], 0
    ds_write2st64_b64 v149, v[180:181], v[228:229] offset0:4 offset1:16
    v_fma_f32 v95, v95, s28, v11
    v_mfma_f32_16x16x32_bf16 v[224:227], v[128:131], v[20:23], 0
    v_cvt_pk_bf16_f32 v188, v188, v189
    v_accvgpr_read_b32 v156, a72
    v_mfma_f32_16x16x32_bf16 a[16:19], v[128:131], v[26:29], 0
    ds_write2st64_b64 v149, v[104:105], v[108:109] offset0:28 offset1:40
    v_pk_mul_f32 v[154:155], v[154:155], v[50:51] op_sel_hi:[1,0]
    v_xor_b32 v149, 96, v149
    v_accvgpr_read_b32 v110, a78
    v_mul_f32 v158, v158, v51
    v_mul_f32 v156, v156, v51
    v_accvgpr_read_b32 v111, a79
    v_accvgpr_read_b32 v105, a29
    v_accvgpr_read_b32 v104, a28
    v_accvgpr_read_b32 v108, a76
    v_pk_mul_f32 v[104:105], v[104:105], v[50:51] op_sel_hi:[1,0]
    v_mul_f32 v111, v111, v51
    v_cvt_pk_bf16_f32 v104, v104, v105
    v_mfma_f32_16x16x32_bf16 a[64:67], v[128:131], v[32:35], 0
    s_add_u32 m0, s38, 1024
    ds_write2st64_b64 v149, v[184:185], v[232:233] offset0:4 offset1:16
    v_mul_f32 v157, v157, v51
    v_pk_mul_f32 v[198:199], v[198:199], v[48:49] op_sel_hi:[1,0]
    v_cvt_pk_bf16_f32 v152, v152, v153
    v_cvt_pk_bf16_f32 v156, v156, v157
    v_cvt_pk_bf16_f32 v157, v158, v159
    v_mfma_f32_16x16x32_bf16 v[180:183], v[132:135], v[14:17], 0
    s_waitcnt lgkmcnt(2)
    ds_read_b64_tr_b16 v[122:123], v2 offset:8192
    buffer_load_dwordx4 v7, s[12:15], s33 offen nt lds
    v_mfma_f32_16x16x32_bf16 v[228:231], v[132:135], v[20:23], 0
    s_add_u32 s57, s67, 6144
    ds_read_b64_tr_b16 v[118:119], v5 offset:7168
    v_mul_f32 v108, v108, v51
    v_mul_f32 v110, v110, v51
    v_fma_f32 v93, v93, s28, v11
    v_cvt_pk_bf16_f32 v153, v154, v155
    v_mfma_f32_16x16x32_bf16 a[20:23], v[132:135], v[26:29], 0
    ds_write2st64_b64 v149, v[152:153], v[156:157] offset0:28 offset1:40
    v_accvgpr_read_b32 v157, a81
    v_accvgpr_read_b32 v156, a80
    v_mfma_f32_16x16x32_bf16 a[68:71], v[132:135], v[32:35], 0
    buffer_store_dwordx4 v[144:147], v7, s[16:19], s67 offen sc0 sc1 nt
    s_nop 0
    ds_read_b128 v[144:147], v8 offset:6144
    v_accvgpr_read_b32 v158, a82
    v_accvgpr_read_b32 v153, a33
    v_cvt_pk_bf16_f32 v189, v190, v191
    v_accvgpr_read_b32 v109, a77
    v_mfma_f32_16x16x32_bf16 v[184:187], v[112:115], v[14:17], 0
    s_add_u32 s59, s33, 6144
    ds_read_b64_tr_b16 v[126:127], v3 offset:8192
    ds_read_b64_tr_b16 v[124:125], v3 offset:2048
    v_mul_f32 v109, v109, v51
    v_accvgpr_read_b32 v107, a31
    v_accvgpr_read_b32 v155, a35
    v_fma_f32 v90, v90, s28, v11
    v_xor_b32 v149, 32, v149
    v_mul_f32 v157, v157, v51
    v_cvt_pk_bf16_f32 v108, v108, v109
    v_pk_mul_f32 v[106:107], v[106:107], v[50:51] op_sel_hi:[1,0]
    v_cvt_pk_bf16_f32 v25, v82, v83
    v_cvt_pk_bf16_f32 v105, v106, v107
    v_cvt_pk_bf16_f32 v249, v250, v251
    v_accvgpr_read_b32 v154, a34
    v_accvgpr_read_b32 v106, a38
    v_cvt_pk_bf16_f32 v109, v110, v111
    v_mul_f32 v158, v158, v51
    v_cvt_pk_bf16_f32 v201, v202, v203
    v_fma_f32 v91, v91, s28, v11
    v_mfma_f32_16x16x32_bf16 v[232:235], v[112:115], v[20:23], 0
    ds_write2st64_b64 v149, v[188:189], v[236:237] offset0:4 offset1:16
    v_mfma_f32_16x16x32_bf16 a[24:27], v[112:115], v[26:29], 0
    s_add_u32 m0, s38, 6144
    ds_write2st64_b64 v149, v[104:105], v[108:109] offset0:28 offset1:40
    v_accvgpr_read_b32 v159, a83
    v_accvgpr_read_b32 v110, a86
    v_accvgpr_read_b32 v152, a32
    v_accvgpr_read_b32 v109, a85
    v_mul_f32 v109, v109, v51
    v_mul_f32 v156, v156, v51
    v_accvgpr_read_b32 v107, a39
    v_mul_f32 v159, v159, v51
    v_pk_mul_f32 v[154:155], v[154:155], v[50:51] op_sel_hi:[1,0]
    v_fma_f32 v79, v79, s28, v9
    v_accvgpr_read_b32 v111, a87
    v_accvgpr_read_b32 v104, a36
    v_pk_mul_f32 v[106:107], v[106:107], v[50:51] op_sel_hi:[1,0]
    v_cvt_pk_bf16_f32 v253, v254, v255
    v_pk_mul_f32 v[152:153], v[152:153], v[50:51] op_sel_hi:[1,0]
    v_accvgpr_read_b32 v105, a37
    v_cvt_pk_bf16_f32 v156, v156, v157
    v_pk_mul_f32 v[104:105], v[104:105], v[50:51] op_sel_hi:[1,0]
    v_fma_f32 v100, v100, s28, v12
    v_cvt_pk_bf16_f32 v205, v206, v207
    v_mfma_f32_16x16x32_bf16 a[72:75], v[112:115], v[32:35], 0
    s_waitcnt lgkmcnt(2)
    ds_read_b64_tr_b16 v[130:131], v4 offset:8192
    buffer_load_dwordx4 v6, s[12:15], s59 offen nt lds
    v_cvt_pk_bf16_f32 v157, v158, v159
    v_mfma_f32_16x16x32_bf16 v[188:191], v[116:119], v[14:17], 0
    v_xor_b32 v149, 96, v149
    v_accvgpr_read_b32 v158, a90
    v_mfma_f32_16x16x32_bf16 v[236:239], v[116:119], v[20:23], 0
    buffer_store_dwordx4 v[144:147], v6, s[16:19], s57 offen sc0 sc1 nt
    ds_write2st64_b64 v149, v[192:193], v[240:241] offset0:8 offset1:20
    v_cvt_pk_bf16_f32 v245, v246, v247
    v_accvgpr_read_b32 v108, a84
    v_cvt_pk_bf16_f32 v152, v152, v153
    v_cvt_pk_bf16_f32 v104, v104, v105
    v_mul_f32 v158, v158, v51
    v_cvt_pk_bf16_f32 v153, v154, v155
    v_cvt_pk_bf16_f32 v105, v106, v107
    v_mfma_f32_16x16x32_bf16 a[28:31], v[116:119], v[26:29], 0
    ds_read_b64_tr_b16 v[132:133], v5 offset:2048
    v_accvgpr_read_b32 v155, a43
    v_mfma_f32_16x16x32_bf16 a[76:79], v[116:119], v[32:35], 0
    ds_write2st64_b64 v149, v[152:153], v[156:157] offset0:32 offset1:44
    v_exp_f32 v99, v99
    v_mfma_f32_16x16x32_bf16 v[192:195], v[120:123], v[14:17], 0
    ds_read_b64_tr_b16 v[134:135], v5 offset:8192
    v_mul_f32 v108, v108, v51
    v_mfma_f32_16x16x32_bf16 v[240:243], v[120:123], v[20:23], 0
    ds_read_b128 v[144:147], v8 offset:7168
    v_accvgpr_read_b32 v159, a91
    v_mfma_f32_16x16x32_bf16 a[32:35], v[120:123], v[26:29], 0
    s_add_u32 m0, s38, 7168
    ds_read_b64_tr_b16 v[128:129], v4 offset:2048
    v_accvgpr_read_b32 v154, a42
    v_accvgpr_read_b32 v157, a89
    v_cvt_pk_bf16_f32 v108, v108, v109
    v_mul_f32 v110, v110, v51
    v_accvgpr_read_b32 v156, a88
    v_cvt_pk_bf16_f32 v197, v198, v199
    v_accvgpr_read_b32 v153, a41
    v_xor_b32 v149, 32, v149
    v_mul_f32 v111, v111, v51
    v_mfma_f32_16x16x32_bf16 a[80:83], v[120:123], v[32:35], 0
    ds_write2st64_b64 v149, v[196:197], v[244:245] offset0:8 offset1:20
    v_mul_f32 v156, v156, v51
    v_accvgpr_read_b32 v152, a40
    v_pk_mul_f32 v[154:155], v[154:155], v[50:51] op_sel_hi:[1,0]
    v_cvt_pk_bf16_f32 v109, v110, v111
    v_accvgpr_read_b32 v106, a46
    v_pk_mul_f32 v[152:153], v[152:153], v[50:51] op_sel_hi:[1,0]
    v_mul_f32 v159, v159, v51
    v_cvt_pk_bf16_f32 v19, v74, v75
    v_mfma_f32_16x16x32_bf16 v[196:199], v[124:127], v[14:17], 0
    ds_write2st64_b64 v149, v[104:105], v[108:109] offset0:32 offset1:44
    v_cvt_pk_bf16_f32 v152, v152, v153
    v_xor_b32 v149, 96, v149
    v_accvgpr_read_b32 v105, a45
    v_mfma_f32_16x16x32_bf16 v[244:247], v[124:127], v[20:23], 0
    s_waitcnt lgkmcnt(3)
    ds_write2st64_b64 v149, v[200:201], v[248:249] offset0:8 offset1:20
    buffer_load_dwordx4 v7, s[12:15], s59 offen nt lds
    v_accvgpr_read_b32 v110, a94
    v_mfma_f32_16x16x32_bf16 a[36:39], v[124:127], v[26:29], 0
    buffer_store_dwordx4 v[144:147], v7, s[16:19], s57 offen sc0 sc1 nt
    s_add_u32 s39, s39, 12288
    s_waitcnt vmcnt(14) lgkmcnt(2)
    ds_read_b128 v[144:147], v8 offset:2048
    v_mul_f32 v157, v157, v51
    v_cvt_pk_bf16_f32 v156, v156, v157
    v_mfma_f32_16x16x32_bf16 a[84:87], v[124:127], v[32:35], 0
    s_barrier
    ds_read_b128 v[120:123], v0 offset:1024
    v_accvgpr_read_b32 v107, a47
    v_accvgpr_read_b32 v109, a93
    v_mfma_f32_16x16x32_bf16 v[200:203], v[128:131], v[14:17], 0
    ds_read_b128 v[116:119], v1 offset:0
    v_cvt_pk_bf16_f32 v157, v158, v159
    v_mfma_f32_16x16x32_bf16 v[248:251], v[128:131], v[20:23], 0
    s_add_u32 m0, s22, 24576
    ds_read_b128 v[112:115], v0 offset:0
    v_accvgpr_read_b32 v104, a44
    v_accvgpr_read_b32 v111, a95
    v_cvt_pk_bf16_f32 v153, v154, v155
    v_mfma_f32_16x16x32_bf16 a[40:43], v[128:131], v[26:29], 0
    buffer_load_dwordx4 v6, s[8:11], s21 offen lds
    ds_write2st64_b64 v149, v[152:153], v[156:157] offset0:32 offset1:44
    v_pk_mul_f32 v[104:105], v[104:105], v[50:51] op_sel_hi:[1,0]
    v_pk_mul_f32 v[106:107], v[106:107], v[50:51] op_sel_hi:[1,0]
    v_xor_b32 v149, 32, v149
    v_accvgpr_read_b32 v108, a92
    v_cvt_pk_bf16_f32 v18, v72, v73
    v_mfma_f32_16x16x32_bf16 a[88:91], v[128:131], v[32:35], 0
    s_add_u32 s21, s21, 128
    ds_write2st64_b64 v149, v[204:205], v[252:253] offset0:8 offset1:20
    v_mfma_f32_16x16x32_bf16 v[204:207], v[132:135], v[14:17], 0
    s_add_u32 m0, s22, 25600
    ds_read_b128 v[128:131], v0 offset:2048
    v_exp_f32 v93, v93
    v_mfma_f32_16x16x32_bf16 v[252:255], v[132:135], v[20:23], 0
    ds_read_b128 v[124:127], v1 offset:1024
    buffer_load_dwordx4 v6, s[8:11], s21 offen lds
    v_mfma_f32_16x16x32_bf16 a[44:47], v[132:135], v[26:29], 0
    v_exp_f32 v97, v97
    v_mfma_f32_16x16x32_bf16 a[92:95], v[132:135], v[32:35], 0
    s_waitcnt lgkmcnt(4)
    v_exp_f32 v91, v91
    v_mfma_f32_16x16x32_bf16 v[72:75], v[112:115], a[144:147], 0
    s_add_u32 s21, s21, 128
    v_exp_f32 v90, v90
    v_mfma_f32_16x16x32_bf16 v[72:75], v[116:119], a[148:151], v[72:75]
    s_add_u32 m0, s22, 26624
    ds_read_b128 v[132:135], v1 offset:2048
    v_cvt_pk_bf16_f32 v30, v88, v89
    v_mfma_f32_16x16x32_bf16 v[72:75], v[120:123], a[152:155], v[72:75]
    buffer_load_dwordx4 v6, s[8:11], s21 offen lds
    v_mfma_f32_16x16x32_bf16 v[80:83], v[112:115], a[168:171], 0
    s_add_u32 s21, s21, 12032
    v_exp_f32 v87, v87
    v_mfma_f32_16x16x32_bf16 v[80:83], v[116:119], a[172:175], v[80:83]
    s_add_u32 s56, s67, 128
    v_exp_f32 v100, v100
    v_mfma_f32_16x16x32_bf16 v[80:83], v[120:123], a[176:179], v[80:83]
    buffer_store_dwordx4 v[144:147], v6, s[16:19], s56 offen sc0 sc1 nt
    s_add_u32 s58, s33, 128
    v_exp_f32 v96, v96
    v_cvt_pk_bf16_f32 v31, v90, v91
    v_mfma_f32_16x16x32_bf16 v[88:91], v[112:115], a[192:195], 0
    s_add_u32 m0, s38, 2048
    v_cvt_pk_bf16_f32 v36, v96, v97
    v_cvt_pk_bf16_f32 v37, v98, v99
    v_mfma_f32_16x16x32_bf16 v[88:91], v[116:119], a[196:199], v[88:91]
    buffer_load_dwordx4 v6, s[12:15], s58 offen nt lds
    ds_read_b128 v[144:147], v8 offset:3072
    v_mfma_f32_16x16x32_bf16 v[88:91], v[120:123], a[200:203], v[88:91]
    v_exp_f32 v95, v95
    v_fma_f32 v86, v86, s28, v10
    v_fma_f32 v85, v85, s28, v10
    v_mfma_f32_16x16x32_bf16 v[96:99], v[112:115], a[216:219], 0
    v_exp_f32 v86, v86
    v_mfma_f32_16x16x32_bf16 v[96:99], v[116:119], a[220:223], v[96:99]
    v_exp_f32 v84, v84
    v_mfma_f32_16x16x32_bf16 v[96:99], v[120:123], a[224:227], v[96:99]
    s_waitcnt lgkmcnt(1)
    v_exp_f32 v78, v78
    v_mfma_f32_16x16x32_bf16 v[72:75], v[124:127], a[156:159], v[72:75]
    ds_read_b128 v[112:115], v0 offset:6144
    v_fma_f32 v101, v101, s28, v12
    v_mfma_f32_16x16x32_bf16 v[72:75], v[128:131], a[160:163], v[72:75]
    s_add_u32 m0, s38, 3072
    v_fma_f32 v103, v103, s28, v12
    v_mfma_f32_16x16x32_bf16 v[72:75], v[132:135], a[164:167], v[72:75]
    v_exp_f32 v79, v79
    v_mfma_f32_16x16x32_bf16 v[80:83], v[124:127], a[180:183], v[80:83]
    ds_read_b128 v[116:119], v1 offset:6144
    v_cvt_pk_bf16_f32 v17, v78, v79
    v_mfma_f32_16x16x32_bf16 v[80:83], v[128:131], a[184:187], v[80:83]
    ds_read_b128 v[120:123], v0 offset:7168
    s_waitcnt lgkmcnt(3)
    buffer_load_dwordx4 v7, s[12:15], s58 offen nt lds
    v_mfma_f32_16x16x32_bf16 v[80:83], v[132:135], a[188:191], v[80:83]
    buffer_store_dwordx4 v[144:147], v7, s[16:19], s56 offen sc0 sc1 nt
    s_nop 0
    ds_read_b128 v[144:147], v8 offset:8192
    v_exp_f32 v85, v85
    v_mfma_f32_16x16x32_bf16 v[88:91], v[124:127], a[204:207], v[88:91]
    v_cvt_pk_bf16_f32 v22, v84, v85
    v_cvt_pk_bf16_f32 v16, v76, v77
    v_mfma_f32_16x16x32_bf16 v[88:91], v[128:131], a[208:211], v[88:91]
    s_add_u32 s57, s67, 6272
    v_mul_f32 v110, v110, v51
    v_cvt_pk_bf16_f32 v23, v86, v87
    v_mfma_f32_16x16x32_bf16 v[88:91], v[132:135], a[212:215], v[88:91]
    v_exp_f32 v92, v92
    v_mfma_f32_16x16x32_bf16 v[96:99], v[124:127], a[228:231], v[96:99]
    v_cvt_pk_bf16_f32 v28, v92, v93
    v_cvt_pk_bf16_f32 v104, v104, v105
    v_mfma_f32_16x16x32_bf16 v[96:99], v[128:131], a[232:235], v[96:99]
    v_fma_f32 v94, v94, s28, v11
    v_mfma_f32_16x16x32_bf16 v[96:99], v[132:135], a[236:239], v[96:99]
    s_waitcnt lgkmcnt(2)
    ds_read_b128 v[124:127], v1 offset:7168
    v_mfma_f32_16x16x32_bf16 v[76:79], v[112:115], a[144:147], 0
    s_add_u32 s59, s33, 6272
    v_exp_f32 v103, v103
    v_mfma_f32_16x16x32_bf16 v[76:79], v[116:119], a[148:151], v[76:79]
    s_waitcnt lgkmcnt(2)
    v_exp_f32 v101, v101
    v_mfma_f32_16x16x32_bf16 v[76:79], v[120:123], a[152:155], v[76:79]
    s_add_u32 m0, s38, 8192
    ds_read_b128 v[128:131], v0 offset:8192
    s_waitcnt lgkmcnt(2)
    buffer_load_dwordx4 v6, s[12:15], s59 offen nt lds
    v_mfma_f32_16x16x32_bf16 v[84:87], v[112:115], a[168:171], 0
    buffer_store_dwordx4 v[144:147], v6, s[16:19], s57 offen sc0 sc1 nt
    s_nop 0
    ds_read_b128 v[144:147], v8 offset:9216
    v_exp_f32 v94, v94
    v_mfma_f32_16x16x32_bf16 v[84:87], v[116:119], a[172:175], v[84:87]
    v_exp_f32 v102, v102
    v_mul_f32 v108, v108, v51
    v_mfma_f32_16x16x32_bf16 v[84:87], v[120:123], a[176:179], v[84:87]
    ds_read_b128 v[132:135], v1 offset:8192
    v_cvt_pk_bf16_f32 v29, v94, v95
    v_mfma_f32_16x16x32_bf16 v[92:95], v[112:115], a[192:195], 0
    v_cvt_pk_bf16_f32 v34, v100, v101
    v_mfma_f32_16x16x32_bf16 v[92:95], v[116:119], a[196:199], v[92:95]
    v_mfma_f32_16x16x32_bf16 v[92:95], v[120:123], a[200:203], v[92:95]
    v_cvt_pk_bf16_f32 v35, v102, v103
    v_mul_f32 v109, v109, v51
    v_mfma_f32_16x16x32_bf16 v[100:103], v[112:115], a[216:219], 0
    s_add_u32 m0, s38, 9216
    v_cvt_pk_bf16_f32 v108, v108, v109
    v_mfma_f32_16x16x32_bf16 v[100:103], v[116:119], a[220:223], v[100:103]
    v_mul_f32 v111, v111, v51
    v_mfma_f32_16x16x32_bf16 v[48:51], v[52:55], v[16:19], v[44:47]
    v_mfma_f32_16x16x32_bf16 v[100:103], v[120:123], a[224:227], v[100:103]
    s_waitcnt lgkmcnt(1)
    buffer_load_dwordx4 v7, s[12:15], s59 offen nt lds
    v_mfma_f32_16x16x32_bf16 v[76:79], v[124:127], a[156:159], v[76:79]
    buffer_store_dwordx4 v[144:147], v7, s[16:19], s57 offen sc0 sc1 nt
    s_nop 0
    ds_read_b128 v[144:147], v8 offset:4096
    v_mfma_f32_16x16x32_bf16 v[76:79], v[128:131], a[160:163], v[76:79]
    s_add_u32 s56, s67, 256
    s_waitcnt lgkmcnt(1)
    v_mfma_f32_16x16x32_bf16 v[76:79], v[132:135], a[164:167], v[76:79]
    v_mfma_f32_16x16x32_bf16 v[48:51], v[56:59], v[22:25], v[48:51]
    v_mfma_f32_16x16x32_bf16 v[84:87], v[124:127], a[180:183], v[84:87]
    v_mfma_f32_16x16x32_bf16 v[84:87], v[128:131], a[184:187], v[84:87]
    s_add_u32 s58, s33, 256
    v_cvt_pk_bf16_f32 v105, v106, v107
    v_mfma_f32_16x16x32_bf16 v[84:87], v[132:135], a[188:191], v[84:87]
    v_mfma_f32_16x16x32_bf16 v[48:51], v[60:63], v[28:31], v[48:51]
    s_add_u32 m0, s38, 4096
    v_mfma_f32_16x16x32_bf16 v[92:95], v[124:127], a[204:207], v[92:95]
    v_mfma_f32_16x16x32_bf16 v[92:95], v[128:131], a[208:211], v[92:95]
    s_waitcnt lgkmcnt(0)
    buffer_load_dwordx4 v6, s[12:15], s58 offen nt lds
    v_mfma_f32_16x16x32_bf16 v[92:95], v[132:135], a[212:215], v[92:95]
    buffer_store_dwordx4 v[144:147], v6, s[16:19], s56 offen sc0 sc1 nt
    s_nop 0
    ds_read_b128 v[144:147], v8 offset:5120
    v_cvt_pk_bf16_f32 v109, v110, v111
    v_mfma_f32_16x16x32_bf16 v[48:51], v[64:67], v[34:37], v[48:51]
    s_add_u32 m0, s38, 5120
    ds_write2st64_b64 v149, v[104:105], v[108:109] offset0:32 offset1:44
    v_mfma_f32_16x16x32_bf16 v[100:103], v[124:127], a[228:231], v[100:103]
    s_nop 4
    v_cmp_lt_f32 vcc, s29, v48
    s_nop 4
    s_cbranch_vccnz L_rs_tr44d
L_ret_tr44d:
    v_fma_f32 v72, v72, s28, v9
    v_fma_f32 v74, v74, s28, v9
    v_fma_f32 v73, v73, s28, v9
    v_fma_f32 v81, v81, s28, v10
    v_exp_f32 v74, v74
    v_exp_f32 v73, v73
    v_fma_f32 v80, v80, s28, v10
    v_fma_f32 v75, v75, s28, v9
    v_exp_f32 v75, v75
    s_waitcnt lgkmcnt(1)
    buffer_load_dwordx4 v7, s[12:15], s58 offen nt lds
    s_waitcnt vmcnt(25)
    s_barrier
    ds_read_b64_tr_b16 v[112:113], v2 offset:18432
    ds_read_b64_tr_b16 v[114:115], v2 offset:12288
    v_exp_f32 v81, v81
    v_cvt_pk_bf16_f32 v15, v74, v75
    v_exp_f32 v80, v80
    v_mfma_f32_16x16x32_bf16 v[100:103], v[128:131], a[232:235], v[100:103]
    ds_read_b64_tr_b16 v[116:117], v3 offset:18432
    s_add_u32 m0, s22, 0
    ds_read_b64_tr_b16 v[118:119], v3 offset:12288
    ds_read_b64_tr_b16 v[120:121], v4 offset:18432
    buffer_load_dwordx4 v6, s[4:7], s20 offen lds
    v_exp_f32 v72, v72
    v_mfma_f32_16x16x32_bf16 v[100:103], v[132:135], a[236:239], v[100:103]
    v_add_u32 v8, 10240, v8
    v_cvt_pk_bf16_f32 v14, v72, v73
    s_add_u32 s20, s20, 128
    buffer_store_dwordx4 v[144:147], v7, s[16:19], s56 offen sc0 sc1 nt
    s_add_u32 m0, s22, 1024
    ds_read_b64_tr_b16 v[122:123], v4 offset:12288
    buffer_load_dwordx4 v6, s[4:7], s20 offen lds
    v_cvt_pk_bf16_f32 v20, v80, v81
    s_add_u32 s20, s20, 128
    s_add_u32 m0, s22, 2048
    ds_read_b64_tr_b16 v[124:125], v5 offset:18432
    buffer_load_dwordx4 v6, s[4:7], s20 offen lds
    ds_read_b64_tr_b16 v[126:127], v5 offset:12288
    s_add_u32 s20, s20, 12032
    s_branch L_loop4
L_end5:
    s_waitcnt lgkmcnt(6)
    v_mfma_f32_16x16x32_bf16 v[160:163], v[112:115], v[16:19], v[160:163]
    v_mfma_f32_16x16x32_bf16 v[208:211], v[112:115], v[22:25], v[208:211]
    ds_read_b64_tr_b16 v[130:131], v2 offset:13312
    v_mfma_f32_16x16x32_bf16 a[0:3], v[112:115], v[28:31], a[0:3]
    ds_read_b64_tr_b16 v[132:133], v3 offset:19456
    v_fma_f32 v77, v77, s28, v9
    v_mfma_f32_16x16x32_bf16 a[48:51], v[112:115], v[34:37], a[48:51]
    ds_read_b64_tr_b16 v[134:135], v3 offset:13312
    v_fma_f32 v86, v86, s28, v10
    v_mfma_f32_16x16x32_bf16 a[96:99], v[112:115], v[40:43], a[96:99]
    v_fma_f32 v96, v96, s28, v12
    s_waitcnt lgkmcnt(7)
    v_mfma_f32_16x16x32_bf16 v[164:167], v[116:119], v[16:19], v[164:167]
    ds_read_b64_tr_b16 v[128:129], v2 offset:19456
    v_fma_f32 v89, v89, s28, v11
    v_mfma_f32_16x16x32_bf16 v[212:215], v[116:119], v[22:25], v[212:215]
    v_fma_f32 v93, v93, s28, v11
    v_mfma_f32_16x16x32_bf16 a[4:7], v[116:119], v[28:31], a[4:7]
    ds_read_b64_tr_b16 v[112:113], v4 offset:19456
    v_mfma_f32_16x16x32_bf16 a[52:55], v[116:119], v[34:37], a[52:55]
    v_fma_f32 v100, v100, s28, v12
    v_fma_f32 v99, v99, s28, v12
    v_mfma_f32_16x16x32_bf16 a[100:103], v[116:119], v[40:43], a[100:103]
    s_waitcnt lgkmcnt(5)
    v_fma_f32 v97, v97, s28, v12
    v_fma_f32 v91, v91, s28, v11
    v_mfma_f32_16x16x32_bf16 v[168:171], v[120:123], v[16:19], v[168:171]
    v_fma_f32 v103, v103, s28, v12
    v_fma_f32 v79, v79, s28, v9
    v_mfma_f32_16x16x32_bf16 v[216:219], v[120:123], v[22:25], v[216:219]
    ds_read_b64_tr_b16 v[116:117], v5 offset:19456
    v_fma_f32 v92, v92, s28, v11
    v_mfma_f32_16x16x32_bf16 a[8:11], v[120:123], v[28:31], a[8:11]
    ds_read_b64_tr_b16 v[114:115], v4 offset:13312
    v_fma_f32 v76, v76, s28, v9
    v_mfma_f32_16x16x32_bf16 a[56:59], v[120:123], v[34:37], a[56:59]
    v_mfma_f32_16x16x32_bf16 a[104:107], v[120:123], v[40:43], a[104:107]
    v_fma_f32 v98, v98, s28, v12
    v_fma_f32 v87, v87, s28, v10
    v_mfma_f32_16x16x32_bf16 v[172:175], v[124:127], v[16:19], v[172:175]
    v_exp_f32 v96, v96
    v_mfma_f32_16x16x32_bf16 v[220:223], v[124:127], v[22:25], v[220:223]
    v_exp_f32 v93, v93
    v_mfma_f32_16x16x32_bf16 a[12:15], v[124:127], v[28:31], a[12:15]
    v_fma_f32 v105, v105, s28, v13
    v_mfma_f32_16x16x32_bf16 a[60:63], v[124:127], v[34:37], a[60:63]
    ds_read_b64_tr_b16 v[120:121], v2 offset:20480
    v_fma_f32 v88, v88, s28, v11
    v_mfma_f32_16x16x32_bf16 a[108:111], v[124:127], v[40:43], a[108:111]
    s_waitcnt lgkmcnt(3)
    v_fma_f32 v90, v90, s28, v11
    v_mfma_f32_16x16x32_bf16 v[176:179], v[128:131], v[16:19], v[176:179]
    ds_read_b64_tr_b16 v[124:125], v3 offset:20480
    v_fma_f32 v78, v78, s28, v9
    v_mfma_f32_16x16x32_bf16 v[224:227], v[128:131], v[22:25], v[224:227]
    ds_read_b64_tr_b16 v[118:119], v5 offset:13312
    v_mfma_f32_16x16x32_bf16 a[16:19], v[128:131], v[28:31], a[16:19]
    v_exp_f32 v97, v97
    v_mfma_f32_16x16x32_bf16 a[64:67], v[128:131], v[34:37], a[64:67]
    v_fma_f32 v106, v106, s28, v13
    v_mfma_f32_16x16x32_bf16 a[112:115], v[128:131], v[40:43], a[112:115]
    v_fma_f32 v95, v95, s28, v11
    v_fma_f32 v85, v85, s28, v10
    v_mfma_f32_16x16x32_bf16 v[180:183], v[132:135], v[16:19], v[180:183]
    v_exp_f32 v106, v106
    v_mfma_f32_16x16x32_bf16 v[228:231], v[132:135], v[22:25], v[228:231]
    ds_read_b64_tr_b16 v[126:127], v3 offset:14336
    v_fma_f32 v94, v94, s28, v11
    v_mfma_f32_16x16x32_bf16 a[20:23], v[132:135], v[28:31], a[20:23]
    ds_read_b64_tr_b16 v[122:123], v2 offset:14336
    v_fma_f32 v110, v110, s28, v13
    v_mfma_f32_16x16x32_bf16 a[68:71], v[132:135], v[34:37], a[68:71]
    ds_read_b64_tr_b16 v[130:131], v4 offset:14336
    v_fma_f32 v109, v109, s28, v13
    v_mfma_f32_16x16x32_bf16 a[116:119], v[132:135], v[40:43], a[116:119]
    s_waitcnt lgkmcnt(5)
    ds_read_b64_tr_b16 v[132:133], v5 offset:20480
    v_mfma_f32_16x16x32_bf16 v[184:187], v[112:115], v[16:19], v[184:187]
    ds_read_b64_tr_b16 v[134:135], v5 offset:14336
    v_fma_f32 v84, v84, s28, v10
    v_mfma_f32_16x16x32_bf16 v[232:235], v[112:115], v[22:25], v[232:235]
    v_exp_f32 v87, v87
    v_mfma_f32_16x16x32_bf16 a[24:27], v[112:115], v[28:31], a[24:27]
    ds_read_b64_tr_b16 v[128:129], v4 offset:20480
    v_fma_f32 v104, v104, s28, v13
    v_mfma_f32_16x16x32_bf16 a[72:75], v[112:115], v[34:37], a[72:75]
    s_add_u32 s39, s39, 12288
    v_exp_f32 v88, v88
    v_mfma_f32_16x16x32_bf16 a[120:123], v[112:115], v[40:43], a[120:123]
    s_waitcnt lgkmcnt(6)
    v_fma_f32 v107, v107, s28, v13
    v_fma_f32 v101, v101, s28, v12
    v_mfma_f32_16x16x32_bf16 v[188:191], v[116:119], v[16:19], v[188:191]
    v_exp_f32 v90, v90
    v_mfma_f32_16x16x32_bf16 v[236:239], v[116:119], v[22:25], v[236:239]
    v_exp_f32 v100, v100
    v_mfma_f32_16x16x32_bf16 a[28:31], v[116:119], v[28:31], a[28:31]
    v_exp_f32 v92, v92
    v_mfma_f32_16x16x32_bf16 a[76:79], v[116:119], v[34:37], a[76:79]
    v_exp_f32 v94, v94
    v_mfma_f32_16x16x32_bf16 a[124:127], v[116:119], v[40:43], a[124:127]
    s_waitcnt lgkmcnt(2)
    v_exp_f32 v105, v105
    v_mfma_f32_16x16x32_bf16 v[192:195], v[120:123], v[16:19], v[192:195]
    v_exp_f32 v95, v95
    v_mfma_f32_16x16x32_bf16 v[240:243], v[120:123], v[22:25], v[240:243]
    v_mfma_f32_16x16x32_bf16 a[32:35], v[120:123], v[28:31], a[32:35]
    s_waitcnt vmcnt(10) lgkmcnt(0)
    s_add_u32 m0, s22, 36864
    v_cvt_pk_bf16_f32 v32, v96, v97
    v_mfma_f32_16x16x32_bf16 a[80:83], v[120:123], v[34:37], a[80:83]
    s_barrier
    v_mfma_f32_16x16x32_bf16 a[128:131], v[120:123], v[40:43], a[128:131]
    buffer_load_dwordx4 v6, s[8:11], s21 offen lds
    v_mfma_f32_16x16x32_bf16 v[196:199], v[124:127], v[16:19], v[196:199]
    ds_read_b128 v[112:115], v0 offset:12288
    v_fma_f32 v102, v102, s28, v12
    v_mfma_f32_16x16x32_bf16 v[244:247], v[124:127], v[22:25], v[244:247]
    v_exp_f32 v78, v78
    v_mfma_f32_16x16x32_bf16 a[36:39], v[124:127], v[28:31], a[36:39]
    v_exp_f32 v86, v86
    v_mfma_f32_16x16x32_bf16 a[84:87], v[124:127], v[34:37], a[84:87]
    ds_read_b128 v[116:119], v1 offset:12288
    v_fma_f32 v108, v108, s28, v13
    v_mfma_f32_16x16x32_bf16 a[132:135], v[124:127], v[40:43], a[132:135]
    s_add_u32 s21, s21, 128
    ds_read_b128 v[120:123], v0 offset:13312
    v_mfma_f32_16x16x32_bf16 v[200:203], v[128:131], v[16:19], v[200:203]
    v_exp_f32 v98, v98
    v_mfma_f32_16x16x32_bf16 v[248:251], v[128:131], v[22:25], v[248:251]
    s_add_u32 m0, s22, 37888
    v_exp_f32 v89, v89
    v_mfma_f32_16x16x32_bf16 a[40:43], v[128:131], v[28:31], a[40:43]
    v_exp_f32 v104, v104
    v_mfma_f32_16x16x32_bf16 a[88:91], v[128:131], v[34:37], a[88:91]
    buffer_load_dwordx4 v6, s[8:11], s21 offen lds
    v_mfma_f32_16x16x32_bf16 a[136:139], v[128:131], v[40:43], a[136:139]
    s_add_u32 s21, s21, 128
    v_exp_f32 v91, v91
    v_mfma_f32_16x16x32_bf16 v[204:207], v[132:135], v[16:19], v[204:207]
    v_exp_f32 v99, v99
    v_mfma_f32_16x16x32_bf16 v[252:255], v[132:135], v[22:25], v[252:255]
    v_cvt_pk_bf16_f32 v38, v104, v105
    s_add_u32 m0, s22, 38912
    v_mfma_f32_16x16x32_bf16 a[44:47], v[132:135], v[28:31], a[44:47]
    ds_read_b128 v[128:131], v0 offset:14336
    v_fma_f32 v111, v111, s28, v13
    v_mfma_f32_16x16x32_bf16 a[92:95], v[132:135], v[34:37], a[92:95]
    v_exp_f32 v107, v107
    v_mfma_f32_16x16x32_bf16 a[140:143], v[132:135], v[40:43], a[140:143]
    s_waitcnt lgkmcnt(1)
    v_cvt_pk_bf16_f32 v33, v98, v99
    v_cvt_pk_bf16_f32 v27, v90, v91
    v_mfma_f32_16x16x32_bf16 v[72:75], v[112:115], a[144:147], 0
    buffer_load_dwordx4 v6, s[8:11], s21 offen lds
    v_mfma_f32_16x16x32_bf16 v[72:75], v[116:119], a[148:151], v[72:75]
    ds_read_b128 v[124:127], v1 offset:13312
    v_mfma_f32_16x16x32_bf16 v[72:75], v[120:123], a[152:155], v[72:75]
    v_exp_f32 v77, v77
    v_mfma_f32_16x16x32_bf16 v[80:83], v[112:115], a[168:171], 0
    v_mfma_f32_16x16x32_bf16 v[80:83], v[116:119], a[172:175], v[80:83]
    ds_read_b128 v[132:135], v1 offset:14336
    v_cvt_pk_bf16_f32 v23, v86, v87
    v_mfma_f32_16x16x32_bf16 v[80:83], v[120:123], a[176:179], v[80:83]
    v_cvt_pk_bf16_f32 v26, v88, v89
    v_cvt_pk_bf16_f32 v39, v106, v107
    v_mfma_f32_16x16x32_bf16 v[88:91], v[112:115], a[192:195], 0
    v_exp_f32 v110, v110
    v_mfma_f32_16x16x32_bf16 v[88:91], v[116:119], a[196:199], v[88:91]
    v_exp_f32 v103, v103
    v_mfma_f32_16x16x32_bf16 v[88:91], v[120:123], a[200:203], v[88:91]
    v_exp_f32 v79, v79
    v_mfma_f32_16x16x32_bf16 v[96:99], v[112:115], a[216:219], 0
    v_exp_f32 v102, v102
    v_mfma_f32_16x16x32_bf16 v[96:99], v[116:119], a[220:223], v[96:99]
    v_exp_f32 v101, v101
    v_mfma_f32_16x16x32_bf16 v[96:99], v[120:123], a[224:227], v[96:99]
    v_exp_f32 v85, v85
    v_mfma_f32_16x16x32_bf16 v[104:107], v[112:115], a[240:243], 0
    v_exp_f32 v108, v108
    v_mfma_f32_16x16x32_bf16 v[104:107], v[116:119], a[244:247], v[104:107]
    v_exp_f32 v76, v76
    v_mfma_f32_16x16x32_bf16 v[104:107], v[120:123], a[248:251], v[104:107]
    s_waitcnt lgkmcnt(0)
    v_mfma_f32_16x16x32_bf16 v[72:75], v[124:127], a[156:159], v[72:75]
    v_exp_f32 v109, v109
    v_mfma_f32_16x16x32_bf16 v[72:75], v[128:131], a[160:163], v[72:75]
    v_cvt_pk_bf16_f32 v29, v94, v95
    v_cvt_pk_bf16_f32 v34, v100, v101
    v_mfma_f32_16x16x32_bf16 v[72:75], v[132:135], a[164:167], v[72:75]
    v_cvt_pk_bf16_f32 v16, v76, v77
    v_mfma_f32_16x16x32_bf16 v[80:83], v[124:127], a[180:183], v[80:83]
    ds_read_b128 v[120:123], v0 offset:19456
    v_mfma_f32_16x16x32_bf16 v[80:83], v[128:131], a[184:187], v[80:83]
    v_exp_f32 v84, v84
    v_mfma_f32_16x16x32_bf16 v[80:83], v[132:135], a[188:191], v[80:83]
    v_mfma_f32_16x16x32_bf16 v[88:91], v[124:127], a[204:207], v[88:91]
    ds_read_b128 v[112:115], v0 offset:18432
    v_mfma_f32_16x16x32_bf16 v[88:91], v[128:131], a[208:211], v[88:91]
    v_cvt_pk_bf16_f32 v28, v92, v93
    v_mfma_f32_16x16x32_bf16 v[88:91], v[132:135], a[212:215], v[88:91]
    v_exp_f32 v111, v111
    v_mfma_f32_16x16x32_bf16 v[96:99], v[124:127], a[228:231], v[96:99]
    v_cvt_pk_bf16_f32 v17, v78, v79
    v_mfma_f32_16x16x32_bf16 v[96:99], v[128:131], a[232:235], v[96:99]
    ds_read_b128 v[116:119], v1 offset:18432
    v_cvt_pk_bf16_f32 v35, v102, v103
    v_mfma_f32_16x16x32_bf16 v[96:99], v[132:135], a[236:239], v[96:99]
    v_cvt_pk_bf16_f32 v22, v84, v85
    v_mfma_f32_16x16x32_bf16 v[104:107], v[124:127], a[252:255], v[104:107]
    ds_read_b128 v[124:127], v1 offset:19456
    v_mfma_f32_16x16x32_bf16 v[104:107], v[128:131], v[136:139], v[104:107]
    s_add_u32 s21, s21, 12032
    ds_read_b128 v[128:131], v0 offset:20480
    v_mfma_f32_16x16x32_bf16 v[104:107], v[132:135], v[140:143], v[104:107]
    ds_read_b128 v[132:135], v1 offset:20480
    v_mfma_f32_16x16x32_bf16 v[44:47], v[52:55], v[14:17], v[48:51]
    v_mfma_f32_16x16x32_bf16 v[44:47], v[56:59], v[20:23], v[44:47]
    v_cvt_pk_bf16_f32 v41, v110, v111
    v_cvt_pk_bf16_f32 v40, v108, v109
    v_mfma_f32_16x16x32_bf16 v[44:47], v[60:63], v[26:29], v[44:47]
    v_mfma_f32_16x16x32_bf16 v[44:47], v[64:67], v[32:35], v[44:47]
    v_mfma_f32_16x16x32_bf16 v[44:47], v[68:71], v[38:41], v[44:47]
    s_waitcnt lgkmcnt(4)
    v_mfma_f32_16x16x32_bf16 v[76:79], v[112:115], a[144:147], 0
    s_waitcnt lgkmcnt(3)
    v_mfma_f32_16x16x32_bf16 v[76:79], v[116:119], a[148:151], v[76:79]
    v_mfma_f32_16x16x32_bf16 v[76:79], v[120:123], a[152:155], v[76:79]
    v_mfma_f32_16x16x32_bf16 v[84:87], v[112:115], a[168:171], 0
    v_mfma_f32_16x16x32_bf16 v[84:87], v[116:119], a[172:175], v[84:87]
    s_waitcnt vmcnt(6) lgkmcnt(0)
    v_cmp_lt_f32 vcc, s29, v44
    v_mfma_f32_16x16x32_bf16 v[84:87], v[120:123], a[176:179], v[84:87]
    v_mfma_f32_16x16x32_bf16 v[92:95], v[112:115], a[192:195], 0
    s_barrier
    v_mfma_f32_16x16x32_bf16 v[92:95], v[116:119], a[196:199], v[92:95]
    v_mfma_f32_16x16x32_bf16 v[92:95], v[120:123], a[200:203], v[92:95]
    v_mfma_f32_16x16x32_bf16 v[100:103], v[112:115], a[216:219], 0
    s_cbranch_vccnz L_rs_end5a
L_ret_end5a:
    v_fma_f32 v80, v80, s28, v10
    v_mfma_f32_16x16x32_bf16 v[100:103], v[116:119], a[220:223], v[100:103]
    v_fma_f32 v82, v82, s28, v10
    v_fma_f32 v83, v83, s28, v10
    v_mfma_f32_16x16x32_bf16 v[100:103], v[120:123], a[224:227], v[100:103]
    v_fma_f32 v81, v81, s28, v10
    v_fma_f32 v73, v73, s28, v9
    v_mfma_f32_16x16x32_bf16 v[108:111], v[112:115], a[240:243], 0
    v_exp_f32 v80, v80
    v_mfma_f32_16x16x32_bf16 v[108:111], v[116:119], a[244:247], v[108:111]
    v_exp_f32 v81, v81
    v_mfma_f32_16x16x32_bf16 v[108:111], v[120:123], a[248:251], v[108:111]
    v_exp_f32 v82, v82
    v_mfma_f32_16x16x32_bf16 v[76:79], v[124:127], a[156:159], v[76:79]
    ds_read_b64_tr_b16 v[112:113], v2 offset:0
    v_fma_f32 v74, v74, s28, v9
    v_mfma_f32_16x16x32_bf16 v[76:79], v[128:131], a[160:163], v[76:79]
    v_exp_f32 v74, v74
    v_mfma_f32_16x16x32_bf16 v[76:79], v[132:135], a[164:167], v[76:79]
    v_exp_f32 v73, v73
    v_mfma_f32_16x16x32_bf16 v[84:87], v[124:127], a[180:183], v[84:87]
    v_exp_f32 v83, v83
    v_mfma_f32_16x16x32_bf16 v[84:87], v[128:131], a[184:187], v[84:87]
    ds_read_b64_tr_b16 v[114:115], v2 offset:6144
    v_fma_f32 v75, v75, s28, v9
    v_mfma_f32_16x16x32_bf16 v[84:87], v[132:135], a[188:191], v[84:87]
    v_cvt_pk_bf16_f32 v24, v80, v81
    v_cvt_pk_bf16_f32 v25, v82, v83
    v_mfma_f32_16x16x32_bf16 v[92:95], v[124:127], a[204:207], v[92:95]
    ds_read_b64_tr_b16 v[116:117], v3 offset:0
    v_mfma_f32_16x16x32_bf16 v[92:95], v[128:131], a[208:211], v[92:95]
    ds_read_b64_tr_b16 v[118:119], v3 offset:6144
    v_fma_f32 v72, v72, s28, v9
    v_mfma_f32_16x16x32_bf16 v[92:95], v[132:135], a[212:215], v[92:95]
    v_exp_f32 v75, v75
    v_mfma_f32_16x16x32_bf16 v[100:103], v[124:127], a[228:231], v[100:103]
    ds_read_b64_tr_b16 v[120:121], v4 offset:0
    v_cvt_pk_bf16_f32 v19, v74, v75
    v_mfma_f32_16x16x32_bf16 v[100:103], v[128:131], a[232:235], v[100:103]
    v_exp_f32 v72, v72
    v_mfma_f32_16x16x32_bf16 v[100:103], v[132:135], a[236:239], v[100:103]
    ds_read_b64_tr_b16 v[122:123], v4 offset:6144
    v_cvt_pk_bf16_f32 v18, v72, v73
    v_mfma_f32_16x16x32_bf16 v[108:111], v[124:127], a[252:255], v[108:111]
    v_mfma_f32_16x16x32_bf16 v[108:111], v[128:131], v[136:139], v[108:111]
    ds_read_b64_tr_b16 v[124:125], v5 offset:0
    v_mfma_f32_16x16x32_bf16 v[108:111], v[132:135], v[140:143], v[108:111]
    ds_read_b64_tr_b16 v[126:127], v5 offset:6144
    s_waitcnt lgkmcnt(6)
    v_mfma_f32_16x16x32_bf16 v[160:163], v[112:115], v[14:17], v[160:163]
    v_fma_f32 v84, v84, s28, v10
    v_fma_f32 v104, v104, s28, v13
    v_fma_f32 v95, v95, s28, v11
    v_mfma_f32_16x16x32_bf16 v[208:211], v[112:115], v[20:23], v[208:211]
    v_fma_f32 v97, v97, s28, v12
    v_fma_f32 v110, v110, s28, v13
    v_mfma_f32_16x16x32_bf16 a[0:3], v[112:115], v[26:29], a[0:3]
    s_add_u32 s39, s39, 12288
    ds_read_b64_tr_b16 v[128:129], v2 offset:1024
    v_fma_f32 v111, v111, s28, v13
    v_mfma_f32_16x16x32_bf16 a[48:51], v[112:115], v[32:35], a[48:51]
    s_waitcnt vmcnt(0)
    v_fma_f32 v79, v79, s28, v9
    v_fma_f32 v77, v77, s28, v9
    v_fma_f32 v99, v99, s28, v12
    v_mfma_f32_16x16x32_bf16 a[96:99], v[112:115], v[38:41], a[96:99]
    s_waitcnt lgkmcnt(5)
    v_fma_f32 v107, v107, s28, v13
    v_fma_f32 v93, v93, s28, v11
    v_mfma_f32_16x16x32_bf16 v[164:167], v[116:119], v[14:17], v[164:167]
    v_fma_f32 v109, v109, s28, v13
    v_fma_f32 v100, v100, s28, v12
    v_mfma_f32_16x16x32_bf16 v[212:215], v[116:119], v[20:23], v[212:215]
    s_barrier
    v_mfma_f32_16x16x32_bf16 a[4:7], v[116:119], v[26:29], a[4:7]
    ds_read_b64_tr_b16 v[132:133], v3 offset:1024
    v_fma_f32 v102, v102, s28, v12
    v_mfma_f32_16x16x32_bf16 a[52:55], v[116:119], v[32:35], a[52:55]
    v_exp_f32 v93, v93
    v_mfma_f32_16x16x32_bf16 a[100:103], v[116:119], v[38:41], a[100:103]
    s_waitcnt lgkmcnt(2)
    ds_read_b64_tr_b16 v[130:131], v2 offset:7168
    v_fma_f32 v88, v88, s28, v11
    v_mfma_f32_16x16x32_bf16 v[168:171], v[120:123], v[14:17], v[168:171]
    v_exp_f32 v111, v111
    v_mfma_f32_16x16x32_bf16 v[216:219], v[120:123], v[20:23], v[216:219]
    ds_read_b64_tr_b16 v[134:135], v3 offset:7168
    v_exp_f32 v100, v100
    v_mfma_f32_16x16x32_bf16 a[8:11], v[120:123], v[26:29], a[8:11]
    v_exp_f32 v102, v102
    v_mfma_f32_16x16x32_bf16 a[56:59], v[120:123], v[32:35], a[56:59]
    v_fma_f32 v101, v101, s28, v12
    v_fma_f32 v86, v86, s28, v10
    v_mfma_f32_16x16x32_bf16 a[104:107], v[120:123], v[38:41], a[104:107]
    ds_read_b64_tr_b16 v[114:115], v4 offset:7168
    v_fma_f32 v91, v91, s28, v11
    v_mfma_f32_16x16x32_bf16 v[172:175], v[124:127], v[14:17], v[172:175]
    ds_read_b64_tr_b16 v[120:121], v2 offset:2048
    v_fma_f32 v87, v87, s28, v10
    v_mfma_f32_16x16x32_bf16 v[220:223], v[124:127], v[20:23], v[220:223]
    ds_read_b64_tr_b16 v[112:113], v4 offset:1024
    v_fma_f32 v105, v105, s28, v13
    v_mfma_f32_16x16x32_bf16 a[12:15], v[124:127], v[26:29], a[12:15]
    ds_read_b64_tr_b16 v[116:117], v5 offset:1024
    v_fma_f32 v92, v92, s28, v11
    v_mfma_f32_16x16x32_bf16 a[60:63], v[124:127], v[32:35], a[60:63]
    ds_read_b64_tr_b16 v[118:119], v5 offset:7168
    v_fma_f32 v98, v98, s28, v12
    v_fma_f32 v94, v94, s28, v11
    v_mfma_f32_16x16x32_bf16 a[108:111], v[124:127], v[38:41], a[108:111]
    s_waitcnt lgkmcnt(6)
    v_exp_f32 v109, v109
    v_mfma_f32_16x16x32_bf16 v[176:179], v[128:131], v[14:17], v[176:179]
    v_fma_f32 v106, v106, s28, v13
    v_fma_f32 v78, v78, s28, v9
    v_mfma_f32_16x16x32_bf16 v[224:227], v[128:131], v[20:23], v[224:227]
    v_fma_f32 v90, v90, s28, v11
    v_fma_f32 v89, v89, s28, v11
    v_mfma_f32_16x16x32_bf16 a[16:19], v[128:131], v[26:29], a[16:19]
    v_exp_f32 v95, v95
    v_mfma_f32_16x16x32_bf16 a[64:67], v[128:131], v[32:35], a[64:67]
    v_exp_f32 v99, v99
    v_mfma_f32_16x16x32_bf16 a[112:115], v[128:131], v[38:41], a[112:115]
    s_waitcnt lgkmcnt(4)
    v_exp_f32 v87, v87
    v_fma_f32 v96, v96, s28, v12
    v_mfma_f32_16x16x32_bf16 v[180:183], v[132:135], v[14:17], v[180:183]
    ds_read_b64_tr_b16 v[122:123], v2 offset:8192
    v_fma_f32 v85, v85, s28, v10
    v_mfma_f32_16x16x32_bf16 v[228:231], v[132:135], v[20:23], v[228:231]
    ds_read_b64_tr_b16 v[126:127], v3 offset:8192
    v_exp_f32 v105, v105
    v_mfma_f32_16x16x32_bf16 a[20:23], v[132:135], v[26:29], a[20:23]
    v_exp_f32 v101, v101
    v_mfma_f32_16x16x32_bf16 a[68:71], v[132:135], v[32:35], a[68:71]
    v_exp_f32 v89, v89
    v_mfma_f32_16x16x32_bf16 a[116:119], v[132:135], v[38:41], a[116:119]
    s_waitcnt lgkmcnt(2)
    v_exp_f32 v77, v77
    v_mfma_f32_16x16x32_bf16 v[184:187], v[112:115], v[14:17], v[184:187]
    v_exp_f32 v110, v110
    v_mfma_f32_16x16x32_bf16 v[232:235], v[112:115], v[20:23], v[232:235]
    v_exp_f32 v79, v79
    v_mfma_f32_16x16x32_bf16 a[24:27], v[112:115], v[26:29], a[24:27]
    v_exp_f32 v98, v98
    v_mfma_f32_16x16x32_bf16 a[72:75], v[112:115], v[32:35], a[72:75]
    v_exp_f32 v84, v84
    v_mfma_f32_16x16x32_bf16 a[120:123], v[112:115], v[38:41], a[120:123]
    ds_read_b64_tr_b16 v[124:125], v3 offset:2048
    v_fma_f32 v103, v103, s28, v12
    v_mfma_f32_16x16x32_bf16 v[188:191], v[116:119], v[14:17], v[188:191]
    ds_read_b64_tr_b16 v[128:129], v4 offset:2048
    v_fma_f32 v108, v108, s28, v13
    v_mfma_f32_16x16x32_bf16 v[236:239], v[116:119], v[20:23], v[236:239]
    ds_read_b64_tr_b16 v[112:113], v2 offset:18432
    v_exp_f32 v104, v104
    v_mfma_f32_16x16x32_bf16 a[28:31], v[116:119], v[26:29], a[28:31]
    v_exp_f32 v88, v88
    v_mfma_f32_16x16x32_bf16 a[76:79], v[116:119], v[32:35], a[76:79]
    ds_read_b64_tr_b16 v[130:131], v4 offset:8192
    v_cvt_pk_bf16_f32 v37, v98, v99
    v_mfma_f32_16x16x32_bf16 a[124:127], v[116:119], v[38:41], a[124:127]
    s_waitcnt lgkmcnt(4)
    v_exp_f32 v107, v107
    v_mfma_f32_16x16x32_bf16 v[192:195], v[120:123], v[14:17], v[192:195]
    ds_read_b64_tr_b16 v[134:135], v5 offset:8192
    v_cvt_pk_bf16_f32 v42, v104, v105
    v_mfma_f32_16x16x32_bf16 v[240:243], v[120:123], v[20:23], v[240:243]
    v_exp_f32 v90, v90
    v_mfma_f32_16x16x32_bf16 a[32:35], v[120:123], v[26:29], a[32:35]
    ds_read_b64_tr_b16 v[114:115], v2 offset:12288
    v_cvt_pk_bf16_f32 v30, v88, v89
    v_mfma_f32_16x16x32_bf16 a[80:83], v[120:123], v[32:35], a[80:83]
    v_exp_f32 v86, v86
    v_mfma_f32_16x16x32_bf16 a[128:131], v[120:123], v[38:41], a[128:131]
    s_waitcnt lgkmcnt(5)
    ds_read_b64_tr_b16 v[132:133], v5 offset:2048
    v_fma_f32 v76, v76, s28, v9
    v_mfma_f32_16x16x32_bf16 v[196:199], v[124:127], v[14:17], v[196:199]
    v_exp_f32 v106, v106
    v_mfma_f32_16x16x32_bf16 v[244:247], v[124:127], v[20:23], v[244:247]
    v_exp_f32 v96, v96
    v_mfma_f32_16x16x32_bf16 a[36:39], v[124:127], v[26:29], a[36:39]
    v_exp_f32 v92, v92
    v_cvt_pk_bf16_f32 v43, v106, v107
    v_mfma_f32_16x16x32_bf16 a[84:87], v[124:127], v[32:35], a[84:87]
    v_exp_f32 v94, v94
    v_mfma_f32_16x16x32_bf16 a[132:135], v[124:127], v[38:41], a[132:135]
    s_waitcnt lgkmcnt(3)
    v_exp_f32 v78, v78
    v_mfma_f32_16x16x32_bf16 v[200:203], v[128:131], v[14:17], v[200:203]
    ds_read_b64_tr_b16 v[116:117], v3 offset:18432
    v_exp_f32 v91, v91
    v_mfma_f32_16x16x32_bf16 v[248:251], v[128:131], v[20:23], v[248:251]
    v_exp_f32 v76, v76
    v_mfma_f32_16x16x32_bf16 a[40:43], v[128:131], v[26:29], a[40:43]
    v_exp_f32 v108, v108
    v_mfma_f32_16x16x32_bf16 a[88:91], v[128:131], v[32:35], a[88:91]
    ds_read_b64_tr_b16 v[118:119], v3 offset:12288
    v_exp_f32 v97, v97
    v_mfma_f32_16x16x32_bf16 a[136:139], v[128:131], v[38:41], a[136:139]
    s_waitcnt lgkmcnt(2)
    v_exp_f32 v103, v103
    v_mfma_f32_16x16x32_bf16 v[204:207], v[132:135], v[14:17], v[204:207]
    v_exp_f32 v85, v85
    v_mfma_f32_16x16x32_bf16 v[252:255], v[132:135], v[20:23], v[252:255]
    v_cvt_pk_bf16_f32 v16, v76, v77
    v_cvt_pk_bf16_f32 v17, v78, v79
    v_mfma_f32_16x16x32_bf16 a[44:47], v[132:135], v[26:29], a[44:47]
    v_cvt_pk_bf16_f32 v22, v84, v85
    v_cvt_pk_bf16_f32 v29, v94, v95
    v_mfma_f32_16x16x32_bf16 a[92:95], v[132:135], v[32:35], a[92:95]
    v_cvt_pk_bf16_f32 v34, v100, v101
    v_cvt_pk_bf16_f32 v23, v86, v87
    v_mfma_f32_16x16x32_bf16 v[48:51], v[52:55], v[16:19], v[44:47]
    ds_read_b64_tr_b16 v[120:121], v4 offset:18432
    v_cvt_pk_bf16_f32 v35, v102, v103
    v_mfma_f32_16x16x32_bf16 a[140:143], v[132:135], v[38:41], a[140:143]
    v_cvt_pk_bf16_f32 v31, v90, v91
    v_cvt_pk_bf16_f32 v28, v92, v93
    v_mfma_f32_16x16x32_bf16 v[48:51], v[56:59], v[22:25], v[48:51]
    ds_read_b64_tr_b16 v[122:123], v4 offset:12288
    v_cvt_pk_bf16_f32 v36, v96, v97
    v_mfma_f32_16x16x32_bf16 v[48:51], v[60:63], v[28:31], v[48:51]
    v_cvt_pk_bf16_f32 v40, v108, v109
    v_cvt_pk_bf16_f32 v41, v110, v111
    v_mfma_f32_16x16x32_bf16 v[48:51], v[64:67], v[34:37], v[48:51]
    ds_read_b64_tr_b16 v[124:125], v5 offset:18432
    v_mfma_f32_16x16x32_bf16 v[48:51], v[68:71], v[40:43], v[48:51]
    s_nop 7
    v_cmp_lt_f32 vcc, s29, v48
    s_nop 4
    s_cbranch_vccnz L_rs_end5b
L_ret_end5b:
    ds_read_b64_tr_b16 v[126:127], v5 offset:12288
    s_waitcnt lgkmcnt(6)
    v_mfma_f32_16x16x32_bf16 v[160:163], v[112:115], v[16:19], v[160:163]
    ds_read_b64_tr_b16 v[128:129], v2 offset:19456
    v_mov_b32 v148, v48
    v_mfma_f32_16x16x32_bf16 v[208:211], v[112:115], v[22:25], v[208:211]
    ds_read_b64_tr_b16 v[130:131], v2 offset:13312
    v_rcp_f32 v51, v51
    v_mfma_f32_16x16x32_bf16 a[0:3], v[112:115], v[28:31], a[0:3]
    v_permlane32_swap_b32 v48, v148
    v_subrev_u32 v8, 28672, v8
    v_mfma_f32_16x16x32_bf16 a[48:51], v[112:115], v[34:37], a[48:51]
    ds_read_b64_tr_b16 v[132:133], v3 offset:19456
    v_lshrrev_b32 v152, 11, v0
    v_mfma_f32_16x16x32_bf16 a[96:99], v[112:115], v[40:43], a[96:99]
    s_waitcnt lgkmcnt(7)
    v_xor_b32 v152, s65, v152
    v_and_b32 v149, 0x3ff, v0
    v_mfma_f32_16x16x32_bf16 v[164:167], v[116:119], v[16:19], v[164:167]
    v_rcp_f32 v49, v49
    v_mfma_f32_16x16x32_bf16 v[212:215], v[116:119], v[22:25], v[212:215]
    v_accvgpr_read_b32 v157, a49
    v_accvgpr_read_b32 v158, a50
    v_mfma_f32_16x16x32_bf16 a[4:7], v[116:119], v[28:31], a[4:7]
    s_add_u32 s84, s34, 0
    v_lshl_add_u32 v149, v152, 10, v149
    v_mul_f32 v209, v209, v49
    v_mfma_f32_16x16x32_bf16 a[52:55], v[116:119], v[34:37], a[52:55]
    v_mul_f32 v208, v208, v49
    v_mbcnt_lo_u32_b32 v152, -1, 0
    v_mfma_f32_16x16x32_bf16 a[100:103], v[116:119], v[40:43], a[100:103]
    s_waitcnt lgkmcnt(3)
    ds_read_b64_tr_b16 v[112:113], v4 offset:19456
    v_mul_f32 v214, v214, v49
    v_mfma_f32_16x16x32_bf16 v[168:171], v[120:123], v[16:19], v[168:171]
    ds_read_b64_tr_b16 v[134:135], v3 offset:13312
    v_accvgpr_read_b32 v75, a99
    v_mfma_f32_16x16x32_bf16 v[216:219], v[120:123], v[22:25], v[216:219]
    v_mbcnt_hi_u32_b32 v152, -1, v152
    v_accvgpr_read_b32 v153, a1
    v_mfma_f32_16x16x32_bf16 a[8:11], v[120:123], v[28:31], a[8:11]
    ds_read_b64_tr_b16 v[116:117], v5 offset:19456
    v_accvgpr_read_b32 v74, a98
    v_mfma_f32_16x16x32_bf16 a[56:59], v[120:123], v[34:37], a[56:59]
    v_accvgpr_read_b32 v156, a48
    v_cvt_pk_bf16_f32 v208, v208, v209
    v_mfma_f32_16x16x32_bf16 a[104:107], v[120:123], v[40:43], a[104:107]
    ds_read_b64_tr_b16 v[114:115], v4 offset:13312
    v_accvgpr_read_b32 v159, a51
    v_mfma_f32_16x16x32_bf16 v[172:175], v[124:127], v[16:19], v[172:175]
    v_add_u32 v149, s38, v149
    v_accvgpr_read_b32 v76, a4
    v_mfma_f32_16x16x32_bf16 v[220:223], v[124:127], v[22:25], v[220:223]
    v_accvgpr_read_b32 v155, a3
    v_accvgpr_read_b32 v78, a6
    v_mfma_f32_16x16x32_bf16 a[12:15], v[124:127], v[28:31], a[12:15]
    v_mul_f32 v159, v159, v51
    v_mul_f32 v156, v156, v51
    v_mfma_f32_16x16x32_bf16 a[60:63], v[124:127], v[34:37], a[60:63]
    v_rcp_f32 v50, v50
    v_mfma_f32_16x16x32_bf16 a[108:111], v[124:127], v[40:43], a[108:111]
    s_waitcnt lgkmcnt(3)
    ds_read_b64_tr_b16 v[122:123], v2 offset:14336
    v_accvgpr_read_b32 v77, a5
    v_mfma_f32_16x16x32_bf16 v[176:179], v[128:131], v[16:19], v[176:179]
    ds_read_b64_tr_b16 v[118:119], v5 offset:13312
    v_lshrrev_b32 v152, 1, v152
    v_mfma_f32_16x16x32_bf16 v[224:227], v[128:131], v[22:25], v[224:227]
    v_mul_f32 v157, v157, v51
    v_mul_f32 v158, v158, v51
    v_mfma_f32_16x16x32_bf16 a[16:19], v[128:131], v[28:31], a[16:19]
    v_rcp_f32 v48, v48
    v_mfma_f32_16x16x32_bf16 a[64:67], v[128:131], v[34:37], a[64:67]
    ds_read_b64_tr_b16 v[120:121], v2 offset:20480
    v_and_b32 v152, 24, v152
    v_cvt_pk_bf16_f32 v156, v156, v157
    v_mfma_f32_16x16x32_bf16 a[112:115], v[128:131], v[40:43], a[112:115]
    s_waitcnt lgkmcnt(3)
    v_bfe_u32 v152, s66, v152, 8
    v_mul_f32 v227, v227, v49
    v_mfma_f32_16x16x32_bf16 v[180:183], v[132:135], v[16:19], v[180:183]
    ds_read_b64_tr_b16 v[128:129], v4 offset:20480
    v_accvgpr_read_b32 v154, a2
    v_mfma_f32_16x16x32_bf16 v[228:231], v[132:135], v[22:25], v[228:231]
    ds_read_b64_tr_b16 v[124:125], v3 offset:20480
    v_xor_b32 v149, v149, v152
    v_mfma_f32_16x16x32_bf16 a[20:23], v[132:135], v[28:31], a[20:23]
    v_mul_f32 v223, v223, v49
    v_cvt_pk_bf16_f32 v157, v158, v159
    v_mov_b32 v152, v148
    v_mfma_f32_16x16x32_bf16 a[68:71], v[132:135], v[34:37], a[68:71]
    v_mul_f32 v210, v210, v49
    v_mul_f32 v211, v211, v49
    v_mfma_f32_16x16x32_bf16 a[116:119], v[132:135], v[40:43], a[116:119]
    v_mul_f32 v216, v216, v49
    v_mul_f32 v220, v220, v49
    v_mfma_f32_16x16x32_bf16 v[184:187], v[112:115], v[16:19], v[184:187]
    v_mul_f32 v224, v224, v49
    v_mul_f32 v231, v231, v49
    v_mfma_f32_16x16x32_bf16 v[232:235], v[112:115], v[22:25], v[232:235]
    s_add_u32 s85, s34, 6144
    v_permlane16_swap_b32 v148, v152
    v_mfma_f32_16x16x32_bf16 a[24:27], v[112:115], v[28:31], a[24:27]
    ds_read_b64_tr_b16 v[132:133], v5 offset:20480
    v_rcp_f32 v148, v148
    v_mfma_f32_16x16x32_bf16 a[72:75], v[112:115], v[34:37], a[72:75]
    v_accvgpr_read_b32 v72, a96
    v_mul_f32 v229, v229, v49
    v_mfma_f32_16x16x32_bf16 a[120:123], v[112:115], v[40:43], a[120:123]
    s_waitcnt lgkmcnt(3)
    v_mul_f32 v219, v219, v49
    v_mul_f32 v230, v230, v49
    v_mfma_f32_16x16x32_bf16 v[188:191], v[116:119], v[16:19], v[188:191]
    s_add_u32 s86, s34, 12288
    ds_read_b64_tr_b16 v[130:131], v4 offset:14336
    v_mul_f32 v218, v218, v49
    v_mfma_f32_16x16x32_bf16 v[236:239], v[116:119], v[22:25], v[236:239]
    v_accvgpr_read_b32 v152, a0
    v_mul_f32 v221, v221, v49
    v_mfma_f32_16x16x32_bf16 a[28:31], v[116:119], v[28:31], a[28:31]
    v_mul_f32 v212, v212, v49
    v_accvgpr_read_b32 v73, a97
    v_mfma_f32_16x16x32_bf16 a[76:79], v[116:119], v[34:37], a[76:79]
    v_accvgpr_read_b32 v159, a103
    v_mul_f32 v215, v215, v49
    v_mfma_f32_16x16x32_bf16 a[124:127], v[116:119], v[40:43], a[124:127]
    v_mul_f32 v222, v222, v49
    v_mul_f32 v236, v236, v49
    v_mul_f32 v213, v213, v49
    v_mfma_f32_16x16x32_bf16 v[192:195], v[120:123], v[16:19], v[192:195]
    ds_read_b64_tr_b16 v[126:127], v3 offset:14336
    v_mul_f32 v234, v234, v49
    v_mfma_f32_16x16x32_bf16 v[240:243], v[120:123], v[22:25], v[240:243]
    v_mul_f32 v237, v237, v49
    v_mul_f32 v233, v233, v49
    v_mfma_f32_16x16x32_bf16 a[32:35], v[120:123], v[28:31], a[32:35]
    ds_read_b64_tr_b16 v[134:135], v5 offset:14336
    v_mul_f32 v232, v232, v49
    v_cvt_pk_bf16_f32 v232, v232, v233
    v_cvt_pk_bf16_f32 v209, v210, v211
    v_mul_f32 v228, v228, v49
    v_accvgpr_read_b32 v79, a7
    v_pk_mul_f32 v[188:189], v[188:189], v[48:49] op_sel_hi:[1,0]
    v_pk_mul_f32 v[160:161], v[160:161], v[48:49] op_sel_hi:[1,0]
    v_pk_mul_f32 v[76:77], v[76:77], v[50:51] op_sel_hi:[1,0]
    v_pk_mul_f32 v[152:153], v[152:153], v[50:51] op_sel_hi:[1,0]
    v_pk_mul_f32 v[72:73], v[72:73], v[148:149] op_sel_hi:[1,0]
    v_pk_mul_f32 v[162:163], v[162:163], v[48:49] op_sel_hi:[1,0]
    v_cvt_pk_bf16_f32 v212, v212, v213
    v_pk_mul_f32 v[164:165], v[164:165], v[48:49] op_sel_hi:[1,0]
    v_mul_f32 v238, v238, v49
    v_pk_mul_f32 v[74:75], v[74:75], v[148:149] op_sel_hi:[1,0]
    v_cvt_pk_bf16_f32 v160, v160, v161
    v_pk_mul_f32 v[154:155], v[154:155], v[50:51] op_sel_hi:[1,0]
    v_cvt_pk_bf16_f32 v72, v72, v73
    v_pk_mul_f32 v[172:173], v[172:173], v[48:49] op_sel_hi:[1,0]
    v_pk_mul_f32 v[180:181], v[180:181], v[48:49] op_sel_hi:[1,0]
    v_pk_mul_f32 v[176:177], v[176:177], v[48:49] op_sel_hi:[1,0]
    v_pk_mul_f32 v[168:169], v[168:169], v[48:49] op_sel_hi:[1,0]
    v_pk_mul_f32 v[174:175], v[174:175], v[48:49] op_sel_hi:[1,0]
    v_cvt_pk_bf16_f32 v161, v162, v163
    v_pk_mul_f32 v[78:79], v[78:79], v[50:51] op_sel_hi:[1,0]
    v_cvt_pk_bf16_f32 v152, v152, v153
    v_cvt_pk_bf16_f32 v153, v154, v155
    v_cvt_pk_bf16_f32 v236, v236, v237
    v_mul_f32 v217, v217, v49
    v_pk_mul_f32 v[166:167], v[166:167], v[48:49] op_sel_hi:[1,0]
    v_pk_mul_f32 v[184:185], v[184:185], v[48:49] op_sel_hi:[1,0]
    v_accvgpr_read_b32 v154, a54
    v_mul_f32 v154, v154, v51
    v_cvt_pk_bf16_f32 v164, v164, v165
    v_cvt_pk_bf16_f32 v73, v74, v75
    v_cvt_pk_bf16_f32 v216, v216, v217
    v_mfma_f32_16x16x32_bf16 a[80:83], v[120:123], v[34:37], a[80:83]
    ds_write2st64_b64 v149, v[160:161], v[208:209] offset0:0 offset1:12
    v_mfma_f32_16x16x32_bf16 a[128:131], v[120:123], v[40:43], a[128:131]
    s_waitcnt lgkmcnt(1)
    ds_write2st64_b64 v149, v[152:153], v[156:157] offset0:24 offset1:36
    v_mfma_f32_16x16x32_bf16 v[196:199], v[124:127], v[16:19], v[196:199]
    ds_write_b64 v149, v[72:73] offset:24576
    v_accvgpr_read_b32 v74, a10
    v_accvgpr_read_b32 v153, a53
    v_cvt_pk_bf16_f32 v217, v218, v219
    v_accvgpr_read_b32 v155, a55
    v_mfma_f32_16x16x32_bf16 v[244:247], v[124:127], v[22:25], v[244:247]
    v_mul_f32 v153, v153, v51
    v_accvgpr_read_b32 v72, a8
    v_mfma_f32_16x16x32_bf16 a[36:39], v[124:127], v[28:31], a[36:39]
    v_accvgpr_read_b32 v152, a52
    v_cvt_pk_bf16_f32 v172, v172, v173
    v_mfma_f32_16x16x32_bf16 a[84:87], v[124:127], v[34:37], a[84:87]
    v_cvt_pk_bf16_f32 v165, v166, v167
    v_mul_f32 v155, v155, v51
    v_mfma_f32_16x16x32_bf16 a[132:135], v[124:127], v[40:43], a[132:135]
    v_cvt_pk_bf16_f32 v76, v76, v77
    v_accvgpr_read_b32 v75, a11
    v_cvt_pk_bf16_f32 v77, v78, v79
    v_mfma_f32_16x16x32_bf16 v[200:203], v[128:131], v[16:19], v[200:203]
    v_mul_f32 v152, v152, v51
    v_cvt_pk_bf16_f32 v213, v214, v215
    v_cvt_pk_bf16_f32 v173, v174, v175
    v_accvgpr_read_b32 v158, a102
    v_mfma_f32_16x16x32_bf16 v[248:251], v[128:131], v[22:25], v[248:251]
    v_cvt_pk_bf16_f32 v152, v152, v153
    v_accvgpr_read_b32 v156, a100
    v_mfma_f32_16x16x32_bf16 a[40:43], v[128:131], v[28:31], a[40:43]
    s_add_u32 s87, s34, 18432
    v_accvgpr_read_b32 v73, a9
    v_xor_b32 v149, 32, v149
    v_mul_f32 v241, v241, v49
    v_mul_f32 v242, v242, v49
    v_accvgpr_read_b32 v157, a101
    v_mul_f32 v226, v226, v49
    v_mfma_f32_16x16x32_bf16 a[88:91], v[128:131], v[34:37], a[88:91]
    ds_write2st64_b64 v149, v[164:165], v[212:213] offset0:0 offset1:12
    v_pk_mul_f32 v[156:157], v[156:157], v[148:149] op_sel_hi:[1,0]
    v_pk_mul_f32 v[74:75], v[74:75], v[50:51] op_sel_hi:[1,0]
    v_pk_mul_f32 v[72:73], v[72:73], v[50:51] op_sel_hi:[1,0]
    v_pk_mul_f32 v[158:159], v[158:159], v[148:149] op_sel_hi:[1,0]
    v_cvt_pk_bf16_f32 v220, v220, v221
    v_pk_mul_f32 v[196:197], v[196:197], v[48:49] op_sel_hi:[1,0]
    v_cvt_pk_bf16_f32 v168, v168, v169
    v_pk_mul_f32 v[186:187], v[186:187], v[48:49] op_sel_hi:[1,0]
    v_cvt_pk_bf16_f32 v156, v156, v157
    v_accvgpr_read_b32 v79, a59
    v_cvt_pk_bf16_f32 v157, v158, v159
    v_cvt_pk_bf16_f32 v176, v176, v177
    v_cvt_pk_bf16_f32 v153, v154, v155
    v_mul_f32 v235, v235, v49
    v_cvt_pk_bf16_f32 v188, v188, v189
    v_accvgpr_read_b32 v78, a58
    v_cvt_pk_bf16_f32 v72, v72, v73
    v_mul_f32 v78, v78, v51
    v_mfma_f32_16x16x32_bf16 a[136:139], v[128:131], v[40:43], a[136:139]
    ds_write2st64_b64 v149, v[76:77], v[152:153] offset0:24 offset1:36
    v_mul_f32 v248, v248, v49
    v_mul_f32 v251, v251, v49
    v_accvgpr_read_b32 v76, a56
    v_mul_f32 v243, v243, v49
    v_mul_f32 v76, v76, v51
    v_accvgpr_read_b32 v154, a106
    v_cvt_pk_bf16_f32 v73, v74, v75
    v_accvgpr_read_b32 v77, a57
    v_mul_f32 v225, v225, v49
    v_mul_f32 v77, v77, v51
    v_cvt_pk_bf16_f32 v221, v222, v223
    v_accvgpr_read_b32 v155, a107
    v_accvgpr_read_b32 v153, a105
    v_accvgpr_read_b32 v152, a104
    v_mfma_f32_16x16x32_bf16 v[204:207], v[132:135], v[16:19], v[204:207]
    ds_write_b64 v149, v[156:157] offset:24576
    v_cvt_pk_bf16_f32 v76, v76, v77
    v_xor_b32 v149, 96, v149
    v_mul_f32 v79, v79, v51
    v_pk_mul_f32 v[170:171], v[170:171], v[48:49] op_sel_hi:[1,0]
    v_pk_mul_f32 v[152:153], v[152:153], v[148:149] op_sel_hi:[1,0]
    v_pk_mul_f32 v[190:191], v[190:191], v[48:49] op_sel_hi:[1,0]
    v_cvt_pk_bf16_f32 v169, v170, v171
    v_pk_mul_f32 v[154:155], v[154:155], v[148:149] op_sel_hi:[1,0]
    v_cvt_pk_bf16_f32 v228, v228, v229
    v_mul_f32 v247, v247, v49
    v_pk_mul_f32 v[182:183], v[182:183], v[48:49] op_sel_hi:[1,0]
    v_accvgpr_read_b32 v157, a13
    v_cvt_pk_bf16_f32 v77, v78, v79
    v_mfma_f32_16x16x32_bf16 v[252:255], v[132:135], v[22:25], v[252:255]
    ds_write2st64_b64 v149, v[168:169], v[216:217] offset0:0 offset1:12
    v_cvt_pk_bf16_f32 v180, v180, v181
    v_mfma_f32_16x16x32_bf16 a[44:47], v[132:135], v[28:31], a[44:47]
    s_add_u32 s88, s34, 24576
    ds_write2st64_b64 v149, v[72:73], v[76:77] offset0:24 offset1:36
    v_cvt_pk_bf16_f32 v152, v152, v153
    v_cvt_pk_bf16_f32 v229, v230, v231
    v_accvgpr_read_b32 v156, a12
    v_accvgpr_read_b32 v159, a15
    v_accvgpr_read_b32 v73, a61
    v_pk_mul_f32 v[178:179], v[178:179], v[48:49] op_sel_hi:[1,0]
    v_pk_mul_f32 v[206:207], v[206:207], v[48:49] op_sel_hi:[1,0]
    v_mul_f32 v239, v239, v49
    v_cvt_pk_bf16_f32 v153, v154, v155
    v_accvgpr_read_b32 v154, a18
    v_accvgpr_read_b32 v77, a109
    v_pk_mul_f32 v[156:157], v[156:157], v[50:51] op_sel_hi:[1,0]
    v_accvgpr_read_b32 v79, a111
    v_accvgpr_read_b32 v158, a14
    v_pk_mul_f32 v[158:159], v[158:159], v[50:51] op_sel_hi:[1,0]
    v_mul_f32 v244, v244, v49
    v_cvt_pk_bf16_f32 v224, v224, v225
    v_accvgpr_read_b32 v75, a63
    v_accvgpr_read_b32 v76, a108
    v_mfma_f32_16x16x32_bf16 a[92:95], v[132:135], v[34:37], a[92:95]
    ds_write_b64 v149, v[152:153] offset:24576
    v_accvgpr_read_b32 v72, a60
    v_accvgpr_read_b32 v152, a16
    v_accvgpr_read_b32 v78, a110
    v_cvt_pk_bf16_f32 v156, v156, v157
    v_mul_f32 v253, v253, v49
    v_accvgpr_read_b32 v155, a19
    v_cvt_pk_bf16_f32 v233, v234, v235
    v_accvgpr_read_b32 v74, a62
    v_pk_mul_f32 v[76:77], v[76:77], v[148:149] op_sel_hi:[1,0]
    v_mul_f32 v73, v73, v51
    v_pk_mul_f32 v[78:79], v[78:79], v[148:149] op_sel_hi:[1,0]
    v_mul_f32 v72, v72, v51
    v_cvt_pk_bf16_f32 v157, v158, v159
    v_mul_f32 v74, v74, v51
    v_cvt_pk_bf16_f32 v196, v196, v197
    v_accvgpr_read_b32 v158, a66
    v_mul_f32 v240, v240, v49
    v_xor_b32 v149, 32, v149
    v_mul_f32 v75, v75, v51
    v_cvt_pk_bf16_f32 v72, v72, v73
    v_accvgpr_read_b32 v153, a17
    v_cvt_pk_bf16_f32 v181, v182, v183
    v_cvt_pk_bf16_f32 v73, v74, v75
    v_cvt_pk_bf16_f32 v76, v76, v77
    v_cvt_pk_bf16_f32 v77, v78, v79
    v_mfma_f32_16x16x32_bf16 a[140:143], v[132:135], v[40:43], a[140:143]
    s_add_u32 s18, s34, 30720
    ds_write2st64_b64 v149, v[172:173], v[220:221] offset0:0 offset1:12
    ds_write2st64_b64 v149, v[156:157], v[72:73] offset0:24 offset1:36
    ds_write_b64 v149, v[76:77] offset:24576
    ds_read_b128 v[144:147], v8 offset:0
    ds_read_b128 v[80:83], v8 offset:1024
    ds_read_b128 v[84:87], v8 offset:6144
    ds_read_b128 v[88:91], v8 offset:7168
    ds_read_b128 v[92:95], v8 offset:12288
    v_accvgpr_read_b32 v75, a115
    v_accvgpr_read_b32 v73, a113
    v_mul_f32 v254, v254, v49
    v_accvgpr_read_b32 v156, a64
    v_accvgpr_read_b32 v159, a67
    v_mul_f32 v246, v246, v49
    v_accvgpr_read_b32 v79, a23
    v_pk_mul_f32 v[152:153], v[152:153], v[50:51] op_sel_hi:[1,0]
    v_accvgpr_read_b32 v157, a65
    v_mul_f32 v158, v158, v51
    v_accvgpr_read_b32 v74, a114
    v_accvgpr_read_b32 v72, a112
    v_pk_mul_f32 v[72:73], v[72:73], v[148:149] op_sel_hi:[1,0]
    v_mul_f32 v156, v156, v51
    v_cvt_pk_bf16_f32 v184, v184, v185
    v_cvt_pk_bf16_f32 v225, v226, v227
    v_cvt_pk_bf16_f32 v152, v152, v153
    v_pk_mul_f32 v[192:193], v[192:193], v[48:49] op_sel_hi:[1,0]
    v_accvgpr_read_b32 v76, a20
    v_pk_mul_f32 v[74:75], v[74:75], v[148:149] op_sel_hi:[1,0]
    v_accvgpr_read_b32 v78, a22
    v_mul_f32 v157, v157, v51
    v_pk_mul_f32 v[154:155], v[154:155], v[50:51] op_sel_hi:[1,0]
    v_xor_b32 v149, 96, v149
    v_pk_mul_f32 v[194:195], v[194:195], v[48:49] op_sel_hi:[1,0]
    v_cvt_pk_bf16_f32 v153, v154, v155
    v_cvt_pk_bf16_f32 v72, v72, v73
    v_accvgpr_read_b32 v77, a21
    v_cvt_pk_bf16_f32 v73, v74, v75
    v_cvt_pk_bf16_f32 v156, v156, v157
    v_mul_f32 v159, v159, v51
    v_mul_f32 v249, v249, v49
    v_accvgpr_read_b32 v154, a70
    v_cvt_pk_bf16_f32 v177, v178, v179
    v_accvgpr_read_b32 v155, a71
    v_cvt_pk_bf16_f32 v157, v158, v159
    v_accvgpr_read_b32 v75, a27
    s_waitcnt lgkmcnt(0)
    buffer_store_dwordx4 v[144:147], v6, s[16:19], s84 offen offset:0 sc0 sc1 nt
    ds_read_b128 v[96:99], v8 offset:13312
    ds_read_b128 v[100:103], v8 offset:18432
    ds_read_b128 v[104:107], v8 offset:19456
    ds_read_b128 v[108:111], v8 offset:24576
    ds_read_b128 v[144:147], v8 offset:25600
    ds_write2st64_b64 v149, v[176:177], v[224:225] offset0:4 offset1:16
    ds_write2st64_b64 v149, v[152:153], v[156:157] offset0:28 offset1:40
    ds_write_b64 v149, v[72:73] offset:26624
    v_xor_b32 v149, 32, v149
    v_accvgpr_read_b32 v73, a25
    v_accvgpr_read_b32 v159, a119
    v_mul_f32 v154, v154, v51
    v_pk_mul_f32 v[76:77], v[76:77], v[50:51] op_sel_hi:[1,0]
    v_accvgpr_read_b32 v72, a24
    v_mul_f32 v255, v255, v49
    v_accvgpr_read_b32 v156, a116
    v_pk_mul_f32 v[72:73], v[72:73], v[50:51] op_sel_hi:[1,0]
    v_cvt_pk_bf16_f32 v76, v76, v77
    v_mul_f32 v252, v252, v49
    v_pk_mul_f32 v[78:79], v[78:79], v[50:51] op_sel_hi:[1,0]
    v_accvgpr_read_b32 v158, a118
    v_accvgpr_read_b32 v157, a117
    v_accvgpr_read_b32 v152, a68
    v_cvt_pk_bf16_f32 v77, v78, v79
    v_accvgpr_read_b32 v79, a75
    v_accvgpr_read_b32 v74, a26
    v_cvt_pk_bf16_f32 v72, v72, v73
    v_pk_mul_f32 v[158:159], v[158:159], v[148:149] op_sel_hi:[1,0]
    v_mul_f32 v250, v250, v49
    v_pk_mul_f32 v[74:75], v[74:75], v[50:51] op_sel_hi:[1,0]
    v_accvgpr_read_b32 v153, a69
    v_mul_f32 v155, v155, v51
    v_mul_f32 v152, v152, v51
    v_pk_mul_f32 v[156:157], v[156:157], v[148:149] op_sel_hi:[1,0]
    v_mul_f32 v153, v153, v51
    v_accvgpr_read_b32 v78, a74
    v_cvt_pk_bf16_f32 v152, v152, v153
    v_cvt_pk_bf16_f32 v156, v156, v157
    v_cvt_pk_bf16_f32 v153, v154, v155
    v_accvgpr_read_b32 v154, a122
    v_cvt_pk_bf16_f32 v157, v158, v159
    v_cvt_pk_bf16_f32 v237, v238, v239
    v_accvgpr_read_b32 v155, a123
    buffer_store_dwordx4 v[80:83], v7, s[16:19], s84 offen offset:0 sc0 sc1 nt
    buffer_store_dwordx4 v[84:87], v6, s[16:19], s85 offen offset:0 sc0 sc1 nt
    buffer_store_dwordx4 v[88:91], v7, s[16:19], s85 offen offset:0 sc0 sc1 nt
    buffer_store_dwordx4 v[92:95], v6, s[16:19], s86 offen offset:0 sc0 sc1 nt
    ds_write2st64_b64 v149, v[180:181], v[228:229] offset0:4 offset1:16
    ds_write2st64_b64 v149, v[76:77], v[152:153] offset0:28 offset1:40
    ds_write_b64 v149, v[156:157] offset:26624
    v_accvgpr_read_b32 v153, a121
    v_mul_f32 v79, v79, v51
    v_accvgpr_read_b32 v152, a120
    v_cvt_pk_bf16_f32 v73, v74, v75
    v_cvt_pk_bf16_f32 v185, v186, v187
    v_pk_mul_f32 v[152:153], v[152:153], v[148:149] op_sel_hi:[1,0]
    v_accvgpr_read_b32 v77, a73
    v_pk_mul_f32 v[204:205], v[204:205], v[48:49] op_sel_hi:[1,0]
    v_accvgpr_read_b32 v156, a28
    v_xor_b32 v149, 96, v149
    v_accvgpr_read_b32 v76, a72
    v_accvgpr_read_b32 v157, a29
    v_accvgpr_read_b32 v159, a31
    v_mul_f32 v78, v78, v51
    v_pk_mul_f32 v[156:157], v[156:157], v[50:51] op_sel_hi:[1,0]
    v_mul_f32 v77, v77, v51
    v_accvgpr_read_b32 v74, a78
    v_cvt_pk_bf16_f32 v192, v192, v193
    v_pk_mul_f32 v[154:155], v[154:155], v[148:149] op_sel_hi:[1,0]
    v_cvt_pk_bf16_f32 v189, v190, v191
    v_cvt_pk_bf16_f32 v152, v152, v153
    v_cvt_pk_bf16_f32 v153, v154, v155
    v_mul_f32 v245, v245, v49
    v_mul_f32 v76, v76, v51
    v_accvgpr_read_b32 v75, a79
    v_cvt_pk_bf16_f32 v244, v244, v245
    v_cvt_pk_bf16_f32 v76, v76, v77
    v_cvt_pk_bf16_f32 v77, v78, v79
    s_waitcnt lgkmcnt(2)
    buffer_store_dwordx4 v[96:99], v7, s[16:19], s86 offen offset:0 sc0 sc1 nt
    buffer_store_dwordx4 v[100:103], v6, s[16:19], s87 offen offset:0 sc0 sc1 nt
    ds_write2st64_b64 v149, v[184:185], v[232:233] offset0:4 offset1:16
    ds_write2st64_b64 v149, v[72:73], v[76:77] offset0:28 offset1:40
    ds_write_b64 v149, v[152:153] offset:26624
    v_accvgpr_read_b32 v79, a127
    v_accvgpr_read_b32 v72, a76
    v_mul_f32 v75, v75, v51
    v_cvt_pk_bf16_f32 v156, v156, v157
    v_accvgpr_read_b32 v152, a32
    v_accvgpr_read_b32 v73, a77
    v_cvt_pk_bf16_f32 v204, v204, v205
    v_accvgpr_read_b32 v158, a30
    v_accvgpr_read_b32 v76, a124
    v_accvgpr_read_b32 v78, a126
    v_accvgpr_read_b32 v155, a35
    v_pk_mul_f32 v[158:159], v[158:159], v[50:51] op_sel_hi:[1,0]
    v_accvgpr_read_b32 v153, a33
    v_cvt_pk_bf16_f32 v240, v240, v241
    v_xor_b32 v149, 32, v149
    v_pk_mul_f32 v[78:79], v[78:79], v[148:149] op_sel_hi:[1,0]
    v_pk_mul_f32 v[202:203], v[202:203], v[48:49] op_sel_hi:[1,0]
    v_mul_f32 v72, v72, v51
    v_accvgpr_read_b32 v77, a125
    v_mul_f32 v73, v73, v51
    v_accvgpr_read_b32 v154, a34
    v_pk_mul_f32 v[152:153], v[152:153], v[50:51] op_sel_hi:[1,0]
    v_cvt_pk_bf16_f32 v241, v242, v243
    v_pk_mul_f32 v[76:77], v[76:77], v[148:149] op_sel_hi:[1,0]
    v_cvt_pk_bf16_f32 v72, v72, v73
    v_mul_f32 v74, v74, v51
    v_cvt_pk_bf16_f32 v157, v158, v159
    v_cvt_pk_bf16_f32 v76, v76, v77
    v_cvt_pk_bf16_f32 v77, v78, v79
    v_accvgpr_read_b32 v159, a83
    v_cvt_pk_bf16_f32 v73, v74, v75
    buffer_store_dwordx4 v[104:107], v7, s[16:19], s87 offen offset:0 sc0 sc1 nt
    buffer_store_dwordx4 v[108:111], v6, s[16:19], s88 offen offset:0 sc0 sc1 nt
    buffer_store_dwordx4 v[144:147], v7, s[16:19], s88 offen offset:0 sc0 sc1 nt
    ds_write2st64_b64 v149, v[188:189], v[236:237] offset0:4 offset1:16
    ds_write2st64_b64 v149, v[156:157], v[72:73] offset0:28 offset1:40
    ds_write_b64 v149, v[76:77] offset:26624
    ds_read_b128 v[80:83], v8 offset:2048
    ds_read_b128 v[84:87], v8 offset:3072
    ds_read_b128 v[88:91], v8 offset:8192
    ds_read_b128 v[92:95], v8 offset:9216
    ds_read_b128 v[96:99], v8 offset:14336
    ds_read_b128 v[100:103], v8 offset:15360
    ds_read_b128 v[104:107], v8 offset:20480
    ds_read_b128 v[108:111], v8 offset:21504
    ds_read_b128 v[144:147], v8 offset:26624
    v_pk_mul_f32 v[154:155], v[154:155], v[50:51] op_sel_hi:[1,0]
    v_accvgpr_read_b32 v77, a37
    v_xor_b32 v149, 96, v149
    v_cvt_pk_bf16_f32 v193, v194, v195
    v_accvgpr_read_b32 v75, a131
    v_accvgpr_read_b32 v158, a82
    v_accvgpr_read_b32 v78, a38
    v_pk_mul_f32 v[200:201], v[200:201], v[48:49] op_sel_hi:[1,0]
    v_accvgpr_read_b32 v157, a81
    v_accvgpr_read_b32 v79, a39
    v_cvt_pk_bf16_f32 v200, v200, v201
    v_accvgpr_read_b32 v156, a80
    v_accvgpr_read_b32 v74, a130
    v_cvt_pk_bf16_f32 v152, v152, v153
    v_mul_f32 v158, v158, v51
    v_mul_f32 v156, v156, v51
    v_accvgpr_read_b32 v72, a128
    v_mul_f32 v159, v159, v51
    v_accvgpr_read_b32 v73, a129
    v_pk_mul_f32 v[198:199], v[198:199], v[48:49] op_sel_hi:[1,0]
    v_cvt_pk_bf16_f32 v153, v154, v155
    v_mul_f32 v157, v157, v51
    v_pk_mul_f32 v[72:73], v[72:73], v[148:149] op_sel_hi:[1,0]
    v_cvt_pk_bf16_f32 v248, v248, v249
    v_accvgpr_read_b32 v76, a36
    v_pk_mul_f32 v[74:75], v[74:75], v[148:149] op_sel_hi:[1,0]
    v_cvt_pk_bf16_f32 v245, v246, v247
    v_cvt_pk_bf16_f32 v156, v156, v157
    v_pk_mul_f32 v[76:77], v[76:77], v[50:51] op_sel_hi:[1,0]
    v_cvt_pk_bf16_f32 v249, v250, v251
    v_cvt_pk_bf16_f32 v157, v158, v159
    v_pk_mul_f32 v[78:79], v[78:79], v[50:51] op_sel_hi:[1,0]
    v_cvt_pk_bf16_f32 v72, v72, v73
    v_cvt_pk_bf16_f32 v252, v252, v253
    v_cvt_pk_bf16_f32 v73, v74, v75
    v_accvgpr_read_b32 v154, a86
    s_waitcnt lgkmcnt(1)
    buffer_store_dwordx4 v[80:83], v6, s[16:19], s84 offen offset:128 sc0 sc1 nt
    buffer_store_dwordx4 v[84:87], v7, s[16:19], s84 offen offset:128 sc0 sc1 nt
    buffer_store_dwordx4 v[88:91], v6, s[16:19], s85 offen offset:128 sc0 sc1 nt
    ds_read_b128 v[80:83], v8 offset:27648
    ds_write2st64_b64 v149, v[192:193], v[240:241] offset0:8 offset1:20
    ds_write2st64_b64 v149, v[152:153], v[156:157] offset0:32 offset1:44
    ds_write_b64 v149, v[72:73] offset:0
    v_accvgpr_read_b32 v75, a43
    v_cvt_pk_bf16_f32 v76, v76, v77
    v_accvgpr_read_b32 v159, a135
    v_xor_b32 v149, 32, v149
    v_accvgpr_read_b32 v158, a134
    v_accvgpr_read_b32 v156, a132
    v_accvgpr_read_b32 v153, a85
    v_accvgpr_read_b32 v155, a87
    v_mul_f32 v153, v153, v51
    v_accvgpr_read_b32 v74, a42
    v_pk_mul_f32 v[158:159], v[158:159], v[148:149] op_sel_hi:[1,0]
    v_cvt_pk_bf16_f32 v253, v254, v255
    v_mul_f32 v154, v154, v51
    v_accvgpr_read_b32 v72, a40
    v_accvgpr_read_b32 v152, a84
    v_cvt_pk_bf16_f32 v77, v78, v79
    v_accvgpr_read_b32 v157, a133
    v_pk_mul_f32 v[74:75], v[74:75], v[50:51] op_sel_hi:[1,0]
    v_mul_f32 v152, v152, v51
    v_cvt_pk_bf16_f32 v152, v152, v153
    v_pk_mul_f32 v[156:157], v[156:157], v[148:149] op_sel_hi:[1,0]
    v_accvgpr_read_b32 v79, a91
    v_cvt_pk_bf16_f32 v156, v156, v157
    v_mul_f32 v155, v155, v51
    v_cvt_pk_bf16_f32 v153, v154, v155
    v_cvt_pk_bf16_f32 v197, v198, v199
    v_cvt_pk_bf16_f32 v157, v158, v159
    v_accvgpr_read_b32 v155, a139
    ds_write2st64_b64 v149, v[196:197], v[244:245] offset0:8 offset1:20
    ds_write2st64_b64 v149, v[76:77], v[152:153] offset0:32 offset1:44
    ds_write_b64 v149, v[156:157] offset:0
    v_xor_b32 v149, 96, v149
    v_accvgpr_read_b32 v76, a88
    v_accvgpr_read_b32 v152, a136
    v_accvgpr_read_b32 v78, a90
    v_accvgpr_read_b32 v153, a137
    v_accvgpr_read_b32 v73, a41
    v_pk_mul_f32 v[152:153], v[152:153], v[148:149] op_sel_hi:[1,0]
    v_pk_mul_f32 v[72:73], v[72:73], v[50:51] op_sel_hi:[1,0]
    v_accvgpr_read_b32 v154, a138
    v_mul_f32 v79, v79, v51
    v_cvt_pk_bf16_f32 v152, v152, v153
    v_cvt_pk_bf16_f32 v201, v202, v203
    v_cvt_pk_bf16_f32 v72, v72, v73
    v_accvgpr_read_b32 v156, a44
    v_cvt_pk_bf16_f32 v73, v74, v75
    v_accvgpr_read_b32 v77, a89
    v_pk_mul_f32 v[154:155], v[154:155], v[148:149] op_sel_hi:[1,0]
    v_accvgpr_read_b32 v74, a94
    v_mul_f32 v78, v78, v51
    v_mul_f32 v77, v77, v51
    v_mul_f32 v76, v76, v51
    v_cvt_pk_bf16_f32 v76, v76, v77
    v_cvt_pk_bf16_f32 v77, v78, v79
    v_cvt_pk_bf16_f32 v153, v154, v155
    v_accvgpr_read_b32 v79, a143
    ds_write2st64_b64 v149, v[200:201], v[248:249] offset0:8 offset1:20
    ds_write2st64_b64 v149, v[72:73], v[76:77] offset0:32 offset1:44
    ds_write_b64 v149, v[152:153] offset:0
    v_xor_b32 v149, 32, v149
    v_accvgpr_read_b32 v78, a142
    v_mul_f32 v74, v74, v51
    v_accvgpr_read_b32 v157, a45
    v_accvgpr_read_b32 v72, a92
    v_accvgpr_read_b32 v77, a141
    v_accvgpr_read_b32 v75, a95
    v_pk_mul_f32 v[78:79], v[78:79], v[148:149] op_sel_hi:[1,0]
    v_cvt_pk_bf16_f32 v205, v206, v207
    v_accvgpr_read_b32 v158, a46
    v_accvgpr_read_b32 v159, a47
    v_pk_mul_f32 v[156:157], v[156:157], v[50:51] op_sel_hi:[1,0]
    v_accvgpr_read_b32 v76, a140
    v_pk_mul_f32 v[76:77], v[76:77], v[148:149] op_sel_hi:[1,0]
    v_pk_mul_f32 v[158:159], v[158:159], v[50:51] op_sel_hi:[1,0]
    v_accvgpr_read_b32 v73, a93
    v_mul_f32 v75, v75, v51
    v_cvt_pk_bf16_f32 v76, v76, v77
    v_mul_f32 v72, v72, v51
    v_mul_f32 v73, v73, v51
    v_cvt_pk_bf16_f32 v156, v156, v157
    v_cvt_pk_bf16_f32 v77, v78, v79
    v_cvt_pk_bf16_f32 v72, v72, v73
    v_cvt_pk_bf16_f32 v157, v158, v159
    v_cvt_pk_bf16_f32 v73, v74, v75
    ds_write2st64_b64 v149, v[204:205], v[252:253] offset0:8 offset1:20
    ds_write2st64_b64 v149, v[156:157], v[72:73] offset0:32 offset1:44
    ds_write_b64 v149, v[76:77] offset:0
    ds_read_b128 v[84:87], v8 offset:4096
    ds_read_b128 v[88:91], v8 offset:5120
    buffer_store_dwordx4 v[92:95], v7, s[16:19], s85 offen offset:128 sc0 sc1 nt
    buffer_store_dwordx4 v[96:99], v6, s[16:19], s86 offen offset:128 sc0 sc1 nt
    buffer_store_dwordx4 v[100:103], v7, s[16:19], s86 offen offset:128 sc0 sc1 nt
    ds_read_b128 v[92:95], v8 offset:10240
    buffer_store_dwordx4 v[104:107], v6, s[16:19], s87 offen offset:128 sc0 sc1 nt
    buffer_store_dwordx4 v[108:111], v7, s[16:19], s87 offen offset:128 sc0 sc1 nt
    ds_read_b128 v[96:99], v8 offset:11264
    ds_read_b128 v[100:103], v8 offset:16384
    ds_read_b128 v[104:107], v8 offset:17408
    ds_read_b128 v[108:111], v8 offset:22528
    s_waitcnt lgkmcnt(9)
    buffer_store_dwordx4 v[144:147], v6, s[16:19], s88 offen offset:128 sc0 sc1 nt
    buffer_store_dwordx4 v[80:83], v7, s[16:19], s88 offen offset:128 sc0 sc1 nt
    ds_read_b128 v[144:147], v8 offset:23552
    ds_read_b128 v[80:83], v8 offset:0
    s_waitcnt lgkmcnt(8)
    buffer_store_dwordx4 v[84:87], v6, s[16:19], s84 offen offset:256 sc0 sc1 nt
    s_nop 0
    ds_read_b128 v[84:87], v8 offset:1024
    s_waitcnt lgkmcnt(8)
    buffer_store_dwordx4 v[88:91], v7, s[16:19], s84 offen offset:256 sc0 sc1 nt
    s_waitcnt lgkmcnt(7)
    buffer_store_dwordx4 v[92:95], v6, s[16:19], s85 offen offset:256 sc0 sc1 nt
    s_waitcnt lgkmcnt(6)
    buffer_store_dwordx4 v[96:99], v7, s[16:19], s85 offen offset:256 sc0 sc1 nt
    s_waitcnt lgkmcnt(3)
    buffer_store_dwordx4 v[100:103], v6, s[16:19], s86 offen offset:256 sc0 sc1 nt
    buffer_store_dwordx4 v[104:107], v7, s[16:19], s86 offen offset:256 sc0 sc1 nt
    buffer_store_dwordx4 v[108:111], v6, s[16:19], s87 offen offset:256 sc0 sc1 nt
    s_waitcnt lgkmcnt(1)
    buffer_store_dwordx4 v[144:147], v7, s[16:19], s87 offen offset:256 sc0 sc1 nt
    buffer_store_dwordx4 v[80:83], v6, s[16:19], s88 offen offset:256 sc0 sc1 nt
    s_waitcnt lgkmcnt(0)
    buffer_store_dwordx4 v[84:87], v7, s[16:19], s88 offen offset:256 sc0 sc1 nt
    s_branch L_fin
L_end4:
    s_waitcnt lgkmcnt(6)
    v_mfma_f32_16x16x32_bf16 v[160:163], v[112:115], v[16:19], v[160:163]
    ds_read_b64_tr_b16 v[134:135], v3 offset:13312
    v_fma_f32 v99, v99, s28, v12
    v_mfma_f32_16x16x32_bf16 v[208:211], v[112:115], v[22:25], v[208:211]
    v_fma_f32 v102, v102, s28, v12
    v_mfma_f32_16x16x32_bf16 a[0:3], v[112:115], v[28:31], a[0:3]
    ds_read_b64_tr_b16 v[128:129], v2 offset:19456
    v_fma_f32 v90, v90, s28, v11
    v_mfma_f32_16x16x32_bf16 a[48:51], v[112:115], v[34:37], a[48:51]
    ds_read_b64_tr_b16 v[130:131], v2 offset:13312
    s_waitcnt lgkmcnt(7)
    v_mfma_f32_16x16x32_bf16 v[164:167], v[116:119], v[16:19], v[164:167]
    ds_read_b128 v[148:151], v8 offset:3072
    v_fma_f32 v88, v88, s28, v11
    v_mfma_f32_16x16x32_bf16 v[212:215], v[116:119], v[22:25], v[212:215]
    ds_read_b64_tr_b16 v[114:115], v4 offset:13312
    v_fma_f32 v85, v85, s28, v10
    v_mfma_f32_16x16x32_bf16 a[4:7], v[116:119], v[28:31], a[4:7]
    v_fma_f32 v92, v92, s28, v11
    v_fma_f32 v87, v87, s28, v10
    v_mfma_f32_16x16x32_bf16 a[52:55], v[116:119], v[34:37], a[52:55]
    ds_read_b64_tr_b16 v[132:133], v3 offset:19456
    s_waitcnt lgkmcnt(8)
    v_mfma_f32_16x16x32_bf16 v[168:171], v[120:123], v[16:19], v[168:171]
    v_exp_f32 v102, v102
    v_mfma_f32_16x16x32_bf16 v[216:219], v[120:123], v[22:25], v[216:219]
    ds_read_b128 v[144:147], v8 offset:2048
    v_fma_f32 v94, v94, s28, v11
    v_mfma_f32_16x16x32_bf16 a[8:11], v[120:123], v[28:31], a[8:11]
    ds_read_b64_tr_b16 v[112:113], v4 offset:19456
    v_fma_f32 v103, v103, s28, v12
    v_mfma_f32_16x16x32_bf16 a[56:59], v[120:123], v[34:37], a[56:59]
    s_waitcnt lgkmcnt(7)
    ds_read_b64_tr_b16 v[118:119], v5 offset:13312
    v_fma_f32 v89, v89, s28, v11
    v_mfma_f32_16x16x32_bf16 v[172:175], v[124:127], v[16:19], v[172:175]
    ds_read_b64_tr_b16 v[116:117], v5 offset:19456
    v_fma_f32 v98, v98, s28, v12
    v_mfma_f32_16x16x32_bf16 v[220:223], v[124:127], v[22:25], v[220:223]
    ds_read_b64_tr_b16 v[120:121], v2 offset:20480
    v_fma_f32 v79, v79, s28, v9
    v_mfma_f32_16x16x32_bf16 a[12:15], v[124:127], v[28:31], a[12:15]
    ds_read_b64_tr_b16 v[122:123], v2 offset:14336
    v_fma_f32 v101, v101, s28, v12
    v_mfma_f32_16x16x32_bf16 a[60:63], v[124:127], v[34:37], a[60:63]
    s_waitcnt lgkmcnt(7)
    v_exp_f32 v87, v87
    v_mfma_f32_16x16x32_bf16 v[176:179], v[128:131], v[16:19], v[176:179]
    v_exp_f32 v85, v85
    v_mfma_f32_16x16x32_bf16 v[224:227], v[128:131], v[22:25], v[224:227]
    ds_read_b64_tr_b16 v[126:127], v3 offset:14336
    v_fma_f32 v100, v100, s28, v12
    v_mfma_f32_16x16x32_bf16 a[16:19], v[128:131], v[28:31], a[16:19]
    ds_read_b64_tr_b16 v[124:125], v3 offset:20480
    v_mfma_f32_16x16x32_bf16 a[64:67], v[128:131], v[34:37], a[64:67]
    s_waitcnt lgkmcnt(7)
    ds_read_b64_tr_b16 v[130:131], v4 offset:14336
    v_fma_f32 v77, v77, s28, v9
    v_mfma_f32_16x16x32_bf16 v[180:183], v[132:135], v[16:19], v[180:183]
    v_exp_f32 v94, v94
    v_mfma_f32_16x16x32_bf16 v[228:231], v[132:135], v[22:25], v[228:231]
    ds_read_b64_tr_b16 v[128:129], v4 offset:20480
    v_fma_f32 v96, v96, s28, v12
    v_mfma_f32_16x16x32_bf16 a[20:23], v[132:135], v[28:31], a[20:23]
    v_fma_f32 v83, v83, s28, v10
    v_mfma_f32_16x16x32_bf16 a[68:71], v[132:135], v[34:37], a[68:71]
    s_waitcnt lgkmcnt(5)
    ds_read_b64_tr_b16 v[134:135], v5 offset:14336
    v_fma_f32 v78, v78, s28, v9
    v_mfma_f32_16x16x32_bf16 v[184:187], v[112:115], v[16:19], v[184:187]
    ds_read_b64_tr_b16 v[132:133], v5 offset:20480
    v_fma_f32 v97, v97, s28, v12
    v_mfma_f32_16x16x32_bf16 v[232:235], v[112:115], v[22:25], v[232:235]
    v_exp_f32 v100, v100
    v_mfma_f32_16x16x32_bf16 a[24:27], v[112:115], v[28:31], a[24:27]
    v_fma_f32 v82, v82, s28, v10
    v_fma_f32 v91, v91, s28, v11
    v_mfma_f32_16x16x32_bf16 a[72:75], v[112:115], v[34:37], a[72:75]
    v_exp_f32 v103, v103
    v_mfma_f32_16x16x32_bf16 v[188:191], v[116:119], v[16:19], v[188:191]
    v_exp_f32 v98, v98
    v_mfma_f32_16x16x32_bf16 v[236:239], v[116:119], v[22:25], v[236:239]
    v_exp_f32 v99, v99
    v_mfma_f32_16x16x32_bf16 a[28:31], v[116:119], v[28:31], a[28:31]
    v_exp_f32 v91, v91
    v_mfma_f32_16x16x32_bf16 a[76:79], v[116:119], v[34:37], a[76:79]
    s_waitcnt lgkmcnt(2)
    v_exp_f32 v89, v89
    v_mfma_f32_16x16x32_bf16 v[192:195], v[120:123], v[16:19], v[192:195]
    s_add_u32 s39, s39, 12288
    v_exp_f32 v82, v82
    v_mfma_f32_16x16x32_bf16 v[240:243], v[120:123], v[22:25], v[240:243]
    v_cvt_pk_bf16_f32 v33, v98, v99
    s_waitcnt vmcnt(10) lgkmcnt(0)
    v_mfma_f32_16x16x32_bf16 a[32:35], v[120:123], v[28:31], a[32:35]
    s_barrier
    v_mfma_f32_16x16x32_bf16 a[80:83], v[120:123], v[34:37], a[80:83]
    ds_read_b128 v[112:115], v0 offset:12288
    v_fma_f32 v86, v86, s28, v10
    v_mfma_f32_16x16x32_bf16 v[196:199], v[124:127], v[16:19], v[196:199]
    ds_read_b128 v[116:119], v1 offset:12288
    v_fma_f32 v95, v95, s28, v11
    v_mfma_f32_16x16x32_bf16 v[244:247], v[124:127], v[22:25], v[244:247]
    s_add_u32 m0, s22, 36864
    v_exp_f32 v97, v97
    v_mfma_f32_16x16x32_bf16 a[36:39], v[124:127], v[28:31], a[36:39]
    buffer_load_dwordx4 v6, s[8:11], s21 offen lds
    v_mfma_f32_16x16x32_bf16 a[84:87], v[124:127], v[34:37], a[84:87]
    s_add_u32 s21, s21, 128
    s_add_u32 m0, s22, 37888
    ds_read_b128 v[120:123], v0 offset:13312
    v_mfma_f32_16x16x32_bf16 v[200:203], v[128:131], v[16:19], v[200:203]
    v_exp_f32 v96, v96
    v_mfma_f32_16x16x32_bf16 v[248:251], v[128:131], v[22:25], v[248:251]
    buffer_load_dwordx4 v6, s[8:11], s21 offen lds
    v_mfma_f32_16x16x32_bf16 a[40:43], v[128:131], v[28:31], a[40:43]
    v_exp_f32 v95, v95
    v_mfma_f32_16x16x32_bf16 a[88:91], v[128:131], v[34:37], a[88:91]
    v_exp_f32 v88, v88
    v_mfma_f32_16x16x32_bf16 v[204:207], v[132:135], v[16:19], v[204:207]
    v_exp_f32 v83, v83
    v_mfma_f32_16x16x32_bf16 v[252:255], v[132:135], v[22:25], v[252:255]
    v_exp_f32 v90, v90
    v_mfma_f32_16x16x32_bf16 a[44:47], v[132:135], v[28:31], a[44:47]
    ds_read_b128 v[124:127], v1 offset:13312
    v_cvt_pk_bf16_f32 v21, v82, v83
    v_mfma_f32_16x16x32_bf16 a[92:95], v[132:135], v[34:37], a[92:95]
    s_waitcnt lgkmcnt(2)
    ds_read_b128 v[128:131], v0 offset:14336
    v_fma_f32 v84, v84, s28, v10
    v_mfma_f32_16x16x32_bf16 v[72:75], v[112:115], a[144:147], 0
    s_add_u32 s21, s21, 128
    v_fma_f32 v93, v93, s28, v11
    s_add_u32 m0, s22, 38912
    v_mfma_f32_16x16x32_bf16 v[72:75], v[116:119], a[148:151], v[72:75]
    s_waitcnt lgkmcnt(2)
    v_cvt_pk_bf16_f32 v27, v90, v91
    v_cvt_pk_bf16_f32 v26, v88, v89
    v_mfma_f32_16x16x32_bf16 v[72:75], v[120:123], a[152:155], v[72:75]
    buffer_load_dwordx4 v6, s[8:11], s21 offen lds
    v_mfma_f32_16x16x32_bf16 v[80:83], v[112:115], a[168:171], 0
    v_exp_f32 v93, v93
    v_mfma_f32_16x16x32_bf16 v[80:83], v[116:119], a[172:175], v[80:83]
    v_exp_f32 v92, v92
    v_mfma_f32_16x16x32_bf16 v[80:83], v[120:123], a[176:179], v[80:83]
    ds_read_b128 v[132:135], v1 offset:14336
    v_fma_f32 v76, v76, s28, v9
    v_mfma_f32_16x16x32_bf16 v[88:91], v[112:115], a[192:195], 0
    v_cvt_pk_bf16_f32 v32, v96, v97
    v_mfma_f32_16x16x32_bf16 v[88:91], v[116:119], a[196:199], v[88:91]
    s_add_u32 s21, s21, 12032
    v_exp_f32 v101, v101
    v_mfma_f32_16x16x32_bf16 v[88:91], v[120:123], a[200:203], v[88:91]
    s_add_u32 s56, s24, 5888
    v_mfma_f32_16x16x32_bf16 v[96:99], v[112:115], a[216:219], 0
    buffer_store_dwordx4 v[144:147], v6, s[16:19], s56 offen sc0 sc1 nt
    v_exp_f32 v77, v77
    v_mfma_f32_16x16x32_bf16 v[96:99], v[116:119], a[220:223], v[96:99]
    v_exp_f32 v76, v76
    v_mfma_f32_16x16x32_bf16 v[96:99], v[120:123], a[224:227], v[96:99]
    s_waitcnt lgkmcnt(1)
    v_exp_f32 v86, v86
    v_mfma_f32_16x16x32_bf16 v[72:75], v[124:127], a[156:159], v[72:75]
    ds_read_b128 v[144:147], v8 offset:4096
    v_mfma_f32_16x16x32_bf16 v[72:75], v[128:131], a[160:163], v[72:75]
    buffer_store_dwordx4 v[148:151], v7, s[16:19], s56 offen sc0 sc1 nt
    ds_read_b128 v[112:115], v0 offset:18432
    v_cvt_pk_bf16_f32 v23, v86, v87
    s_waitcnt lgkmcnt(2)
    v_mfma_f32_16x16x32_bf16 v[72:75], v[132:135], a[164:167], v[72:75]
    v_exp_f32 v79, v79
    v_mfma_f32_16x16x32_bf16 v[80:83], v[124:127], a[180:183], v[80:83]
    v_cvt_pk_bf16_f32 v16, v76, v77
    v_mfma_f32_16x16x32_bf16 v[80:83], v[128:131], a[184:187], v[80:83]
    v_exp_f32 v78, v78
    v_mfma_f32_16x16x32_bf16 v[80:83], v[132:135], a[188:191], v[80:83]
    ds_read_b128 v[148:151], v8 offset:5120
    v_mfma_f32_16x16x32_bf16 v[88:91], v[124:127], a[204:207], v[88:91]
    v_cvt_pk_bf16_f32 v28, v92, v93
    v_mfma_f32_16x16x32_bf16 v[88:91], v[128:131], a[208:211], v[88:91]
    v_exp_f32 v84, v84
    v_mfma_f32_16x16x32_bf16 v[88:91], v[132:135], a[212:215], v[88:91]
    ds_read_b128 v[116:119], v1 offset:18432
    v_cvt_pk_bf16_f32 v29, v94, v95
    v_mfma_f32_16x16x32_bf16 v[96:99], v[124:127], a[228:231], v[96:99]
    ds_read_b128 v[120:123], v0 offset:19456
    v_mfma_f32_16x16x32_bf16 v[96:99], v[128:131], a[232:235], v[96:99]
    v_cvt_pk_bf16_f32 v17, v78, v79
    s_add_u32 s57, s24, 6016
    v_mfma_f32_16x16x32_bf16 v[96:99], v[132:135], a[236:239], v[96:99]
    ds_read_b128 v[132:135], v1 offset:20480
    v_cvt_pk_bf16_f32 v22, v84, v85
    v_mfma_f32_16x16x32_bf16 v[44:47], v[52:55], v[14:17], v[48:51]
    ds_read_b128 v[128:131], v0 offset:20480
    v_mfma_f32_16x16x32_bf16 v[44:47], v[56:59], v[20:23], v[44:47]
    ds_read_b128 v[124:127], v1 offset:19456
    v_cvt_pk_bf16_f32 v35, v102, v103
    v_mfma_f32_16x16x32_bf16 v[44:47], v[60:63], v[26:29], v[44:47]
    s_waitcnt lgkmcnt(6)
    v_cvt_pk_bf16_f32 v34, v100, v101
    v_mfma_f32_16x16x32_bf16 v[76:79], v[112:115], a[144:147], 0
    buffer_store_dwordx4 v[144:147], v6, s[16:19], s57 offen sc0 sc1 nt
    s_nop 0
    ds_read_b128 v[144:147], v8 offset:0
    v_mfma_f32_16x16x32_bf16 v[44:47], v[64:67], v[32:35], v[44:47]
    s_waitcnt lgkmcnt(5)
    v_mfma_f32_16x16x32_bf16 v[76:79], v[116:119], a[148:151], v[76:79]
    buffer_store_dwordx4 v[148:151], v7, s[16:19], s57 offen sc0 sc1 nt
    s_waitcnt lgkmcnt(4)
    v_mfma_f32_16x16x32_bf16 v[76:79], v[120:123], a[152:155], v[76:79]
    ds_read_b128 v[148:151], v8 offset:1024
    v_mfma_f32_16x16x32_bf16 v[84:87], v[112:115], a[168:171], 0
    s_nop 0
    v_cmp_lt_f32 vcc, s29, v44
    v_mfma_f32_16x16x32_bf16 v[84:87], v[116:119], a[172:175], v[84:87]
    s_waitcnt vmcnt(10) lgkmcnt(2)
    v_mfma_f32_16x16x32_bf16 v[84:87], v[120:123], a[176:179], v[84:87]
    s_barrier
    v_mfma_f32_16x16x32_bf16 v[92:95], v[112:115], a[192:195], 0
    s_cbranch_vccnz L_rs_end4a
L_ret_end4a:
    v_mfma_f32_16x16x32_bf16 v[92:95], v[116:119], a[196:199], v[92:95]
    v_fma_f32 v81, v81, s28, v10
    v_mfma_f32_16x16x32_bf16 v[92:95], v[120:123], a[200:203], v[92:95]
    v_exp_f32 v81, v81
    v_mfma_f32_16x16x32_bf16 v[100:103], v[112:115], a[216:219], 0
    ds_read_b64_tr_b16 v[112:113], v2 offset:0
    v_mfma_f32_16x16x32_bf16 v[100:103], v[116:119], a[220:223], v[100:103]
    ds_read_b64_tr_b16 v[114:115], v2 offset:6144
    v_mfma_f32_16x16x32_bf16 v[100:103], v[120:123], a[224:227], v[100:103]
    v_fma_f32 v72, v72, s28, v9
    v_fma_f32 v80, v80, s28, v10
    v_mfma_f32_16x16x32_bf16 v[76:79], v[124:127], a[156:159], v[76:79]
    s_waitcnt lgkmcnt(2)
    buffer_store_dwordx4 v[144:147], v6, s[16:19], s24 offen sc0 sc1 nt
    v_exp_f32 v80, v80
    v_mfma_f32_16x16x32_bf16 v[76:79], v[128:131], a[160:163], v[76:79]
    ds_read_b64_tr_b16 v[116:117], v3 offset:0
    v_fma_f32 v73, v73, s28, v9
    v_mfma_f32_16x16x32_bf16 v[76:79], v[132:135], a[164:167], v[76:79]
    v_exp_f32 v72, v72
    v_mfma_f32_16x16x32_bf16 v[84:87], v[124:127], a[180:183], v[84:87]
    ds_read_b64_tr_b16 v[118:119], v3 offset:6144
    v_mfma_f32_16x16x32_bf16 v[84:87], v[128:131], a[184:187], v[84:87]
    buffer_store_dwordx4 v[148:151], v7, s[16:19], s24 offen sc0 sc1 nt
    v_exp_f32 v73, v73
    v_mfma_f32_16x16x32_bf16 v[84:87], v[132:135], a[188:191], v[84:87]
    v_cvt_pk_bf16_f32 v18, v72, v73
    v_fma_f32 v75, v75, s28, v9
    v_mfma_f32_16x16x32_bf16 v[92:95], v[124:127], a[204:207], v[92:95]
    ds_read_b64_tr_b16 v[120:121], v4 offset:0
    v_fma_f32 v74, v74, s28, v9
    v_mfma_f32_16x16x32_bf16 v[92:95], v[128:131], a[208:211], v[92:95]
    ds_read_b64_tr_b16 v[122:123], v4 offset:6144
    v_mfma_f32_16x16x32_bf16 v[92:95], v[132:135], a[212:215], v[92:95]
    v_exp_f32 v74, v74
    v_mfma_f32_16x16x32_bf16 v[100:103], v[124:127], a[228:231], v[100:103]
    v_exp_f32 v75, v75
    v_mfma_f32_16x16x32_bf16 v[100:103], v[128:131], a[232:235], v[100:103]
    ds_read_b64_tr_b16 v[124:125], v5 offset:0
    v_cvt_pk_bf16_f32 v24, v80, v81
    v_mfma_f32_16x16x32_bf16 v[100:103], v[132:135], a[236:239], v[100:103]
    ds_read_b64_tr_b16 v[126:127], v5 offset:6144
    v_cvt_pk_bf16_f32 v19, v74, v75
    v_fma_f32 v89, v89, s28, v11
    s_waitcnt lgkmcnt(6)
    v_mfma_f32_16x16x32_bf16 v[160:163], v[112:115], v[14:17], v[160:163]
    s_add_u32 s39, s39, 12288
    ds_read_b64_tr_b16 v[128:129], v2 offset:1024
    v_fma_f32 v92, v92, s28, v11
    v_mfma_f32_16x16x32_bf16 v[208:211], v[112:115], v[20:23], v[208:211]
    s_waitcnt vmcnt(6)
    ds_read_b64_tr_b16 v[134:135], v3 offset:7168
    v_fma_f32 v88, v88, s28, v11
    v_mfma_f32_16x16x32_bf16 a[0:3], v[112:115], v[26:29], a[0:3]
    s_barrier
    ds_read_b64_tr_b16 v[132:133], v3 offset:1024
    v_fma_f32 v94, v94, s28, v11
    v_fma_f32 v85, v85, s28, v10
    v_fma_f32 v90, v90, s28, v11
    v_mfma_f32_16x16x32_bf16 a[48:51], v[112:115], v[32:35], a[48:51]
    s_waitcnt lgkmcnt(7)
    ds_read_b64_tr_b16 v[130:131], v2 offset:7168
    v_fma_f32 v98, v98, s28, v12
    v_mfma_f32_16x16x32_bf16 v[164:167], v[116:119], v[14:17], v[164:167]
    v_fma_f32 v96, v96, s28, v12
    v_fma_f32 v87, v87, s28, v10
    v_mfma_f32_16x16x32_bf16 v[212:215], v[116:119], v[20:23], v[212:215]
    ds_read_b64_tr_b16 v[112:113], v4 offset:1024
    v_fma_f32 v86, v86, s28, v10
    v_mfma_f32_16x16x32_bf16 a[4:7], v[116:119], v[26:29], a[4:7]
    v_fma_f32 v95, v95, s28, v11
    v_fma_f32 v91, v91, s28, v11
    v_mfma_f32_16x16x32_bf16 a[52:55], v[116:119], v[32:35], a[52:55]
    s_waitcnt lgkmcnt(7)
    ds_read_b64_tr_b16 v[114:115], v4 offset:7168
    v_fma_f32 v79, v79, s28, v9
    v_mfma_f32_16x16x32_bf16 v[168:171], v[120:123], v[14:17], v[168:171]
    v_fma_f32 v78, v78, s28, v9
    v_fma_f32 v82, v82, s28, v10
    v_mfma_f32_16x16x32_bf16 v[216:219], v[120:123], v[20:23], v[216:219]
    v_exp_f32 v94, v94
    v_mfma_f32_16x16x32_bf16 a[8:11], v[120:123], v[26:29], a[8:11]
    v_exp_f32 v88, v88
    v_mfma_f32_16x16x32_bf16 a[56:59], v[120:123], v[32:35], a[56:59]
    s_waitcnt lgkmcnt(4)
    v_exp_f32 v85, v85
    v_mfma_f32_16x16x32_bf16 v[172:175], v[124:127], v[14:17], v[172:175]
    ds_read_b64_tr_b16 v[116:117], v5 offset:1024
    v_fma_f32 v83, v83, s28, v10
    v_fma_f32 v93, v93, s28, v11
    v_fma_f32 v76, v76, s28, v9
    v_mfma_f32_16x16x32_bf16 v[220:223], v[124:127], v[20:23], v[220:223]
    v_exp_f32 v92, v92
    v_mfma_f32_16x16x32_bf16 a[12:15], v[124:127], v[26:29], a[12:15]
    ds_read_b64_tr_b16 v[118:119], v5 offset:7168
    v_exp_f32 v89, v89
    v_mfma_f32_16x16x32_bf16 a[60:63], v[124:127], v[32:35], a[60:63]
    s_waitcnt lgkmcnt(3)
    ds_read_b64_tr_b16 v[120:121], v2 offset:2048
    v_fma_f32 v84, v84, s28, v10
    v_mfma_f32_16x16x32_bf16 v[176:179], v[128:131], v[14:17], v[176:179]
    ds_read_b64_tr_b16 v[122:123], v2 offset:8192
    v_fma_f32 v99, v99, s28, v12
    v_mfma_f32_16x16x32_bf16 v[224:227], v[128:131], v[20:23], v[224:227]
    v_exp_f32 v90, v90
    v_mfma_f32_16x16x32_bf16 a[16:19], v[128:131], v[26:29], a[16:19]
    ds_read_b64_tr_b16 v[124:125], v3 offset:2048
    v_fma_f32 v77, v77, s28, v9
    v_mfma_f32_16x16x32_bf16 a[64:67], v[128:131], v[32:35], a[64:67]
    v_fma_f32 v101, v101, s28, v12
    v_fma_f32 v102, v102, s28, v12
    v_mfma_f32_16x16x32_bf16 v[180:183], v[132:135], v[14:17], v[180:183]
    ds_read_b64_tr_b16 v[126:127], v3 offset:8192
    v_fma_f32 v103, v103, s28, v12
    v_mfma_f32_16x16x32_bf16 v[228:231], v[132:135], v[20:23], v[228:231]
    v_exp_f32 v91, v91
    v_mfma_f32_16x16x32_bf16 a[20:23], v[132:135], v[26:29], a[20:23]
    v_exp_f32 v82, v82
    v_mfma_f32_16x16x32_bf16 a[68:71], v[132:135], v[32:35], a[68:71]
    s_waitcnt lgkmcnt(5)
    v_exp_f32 v103, v103
    v_mfma_f32_16x16x32_bf16 v[184:187], v[112:115], v[14:17], v[184:187]
    v_exp_f32 v95, v95
    v_mfma_f32_16x16x32_bf16 v[232:235], v[112:115], v[20:23], v[232:235]
    v_exp_f32 v83, v83
    v_mfma_f32_16x16x32_bf16 a[24:27], v[112:115], v[26:29], a[24:27]
    v_exp_f32 v99, v99
    v_mfma_f32_16x16x32_bf16 a[72:75], v[112:115], v[32:35], a[72:75]
    s_waitcnt lgkmcnt(2)
    ds_read_b64_tr_b16 v[128:129], v4 offset:2048
    v_exp_f32 v86, v86
    v_mfma_f32_16x16x32_bf16 v[188:191], v[116:119], v[14:17], v[188:191]
    v_exp_f32 v79, v79
    v_mfma_f32_16x16x32_bf16 v[236:239], v[116:119], v[20:23], v[236:239]
    ds_read_b64_tr_b16 v[130:131], v4 offset:8192
    v_fma_f32 v100, v100, s28, v12
    v_mfma_f32_16x16x32_bf16 a[28:31], v[116:119], v[26:29], a[28:31]
    ds_read_b64_tr_b16 v[112:113], v2 offset:18432
    v_exp_f32 v76, v76
    v_mfma_f32_16x16x32_bf16 a[76:79], v[116:119], v[32:35], a[76:79]
    v_exp_f32 v93, v93
    v_mfma_f32_16x16x32_bf16 v[192:195], v[120:123], v[14:17], v[192:195]
    v_exp_f32 v98, v98
    v_mfma_f32_16x16x32_bf16 v[240:243], v[120:123], v[20:23], v[240:243]
    ds_read_b64_tr_b16 v[132:133], v5 offset:2048
    v_exp_f32 v78, v78
    v_mfma_f32_16x16x32_bf16 a[32:35], v[120:123], v[26:29], a[32:35]
    ds_read_b64_tr_b16 v[134:135], v5 offset:8192
    v_exp_f32 v77, v77
    v_mfma_f32_16x16x32_bf16 a[80:83], v[120:123], v[32:35], a[80:83]
    s_waitcnt lgkmcnt(5)
    ds_read_b64_tr_b16 v[114:115], v2 offset:12288
    v_exp_f32 v96, v96
    v_mfma_f32_16x16x32_bf16 v[196:199], v[124:127], v[14:17], v[196:199]
    v_exp_f32 v102, v102
    v_mfma_f32_16x16x32_bf16 v[244:247], v[124:127], v[20:23], v[244:247]
    v_exp_f32 v87, v87
    v_mfma_f32_16x16x32_bf16 a[36:39], v[124:127], v[26:29], a[36:39]
    v_fma_f32 v97, v97, s28, v12
    v_cvt_pk_bf16_f32 v30, v88, v89
    v_mfma_f32_16x16x32_bf16 a[84:87], v[124:127], v[32:35], a[84:87]
    s_waitcnt lgkmcnt(3)
    v_exp_f32 v97, v97
    v_mfma_f32_16x16x32_bf16 v[200:203], v[128:131], v[14:17], v[200:203]
    v_exp_f32 v101, v101
    v_mfma_f32_16x16x32_bf16 v[248:251], v[128:131], v[20:23], v[248:251]
    ds_read_b64_tr_b16 v[116:117], v3 offset:18432
    v_exp_f32 v100, v100
    v_mfma_f32_16x16x32_bf16 a[40:43], v[128:131], v[26:29], a[40:43]
    ds_read_b64_tr_b16 v[118:119], v3 offset:12288
    v_cvt_pk_bf16_f32 v25, v82, v83
    v_mfma_f32_16x16x32_bf16 a[88:91], v[128:131], v[32:35], a[88:91]
    s_waitcnt lgkmcnt(3)
    v_exp_f32 v84, v84
    v_mfma_f32_16x16x32_bf16 v[204:207], v[132:135], v[14:17], v[204:207]
    ds_read_b64_tr_b16 v[120:121], v4 offset:18432
    v_cvt_pk_bf16_f32 v17, v78, v79
    v_mfma_f32_16x16x32_bf16 v[252:255], v[132:135], v[20:23], v[252:255]
    v_cvt_pk_bf16_f32 v23, v86, v87
    v_cvt_pk_bf16_f32 v16, v76, v77
    v_mfma_f32_16x16x32_bf16 a[44:47], v[132:135], v[26:29], a[44:47]
    ds_read_b64_tr_b16 v[122:123], v4 offset:12288
    v_cvt_pk_bf16_f32 v22, v84, v85
    v_mfma_f32_16x16x32_bf16 a[92:95], v[132:135], v[32:35], a[92:95]
    v_cvt_pk_bf16_f32 v36, v96, v97
    v_cvt_pk_bf16_f32 v28, v92, v93
    v_cvt_pk_bf16_f32 v29, v94, v95
    v_mfma_f32_16x16x32_bf16 v[48:51], v[52:55], v[16:19], v[44:47]
    ds_read_b64_tr_b16 v[124:125], v5 offset:18432
    v_cvt_pk_bf16_f32 v35, v102, v103
    v_mfma_f32_16x16x32_bf16 v[48:51], v[56:59], v[22:25], v[48:51]
    v_cvt_pk_bf16_f32 v31, v90, v91
    v_cvt_pk_bf16_f32 v34, v100, v101
    v_cvt_pk_bf16_f32 v37, v98, v99
    v_mfma_f32_16x16x32_bf16 v[48:51], v[60:63], v[28:31], v[48:51]
    ds_read_b64_tr_b16 v[126:127], v5 offset:12288
    v_mfma_f32_16x16x32_bf16 v[48:51], v[64:67], v[34:37], v[48:51]
    s_nop 7
    v_cmp_lt_f32 vcc, s29, v48
    s_nop 4
    s_cbranch_vccnz L_rs_end4b
L_ret_end4b:
    v_and_b32 v149, 0x3ff, v0
    v_lshrrev_b32 v152, 11, v0
    s_waitcnt lgkmcnt(6)
    v_mfma_f32_16x16x32_bf16 v[160:163], v[112:115], v[16:19], v[160:163]
    v_xor_b32 v152, s65, v152
    v_rcp_f32 v51, v51
    v_mfma_f32_16x16x32_bf16 v[208:211], v[112:115], v[22:25], v[208:211]
    v_lshl_add_u32 v149, v152, 10, v149
    v_mbcnt_lo_u32_b32 v152, -1, 0
    v_mfma_f32_16x16x32_bf16 a[0:3], v[112:115], v[28:31], a[0:3]
    ds_read_b64_tr_b16 v[130:131], v2 offset:13312
    v_mbcnt_hi_u32_b32 v152, -1, v152
    v_mfma_f32_16x16x32_bf16 a[48:51], v[112:115], v[34:37], a[48:51]
    s_waitcnt lgkmcnt(5)
    v_rcp_f32 v49, v49
    v_mfma_f32_16x16x32_bf16 v[164:167], v[116:119], v[16:19], v[164:167]
    ds_read_b64_tr_b16 v[128:129], v2 offset:19456
    v_lshrrev_b32 v152, 1, v152
    v_mov_b32 v148, v48
    v_mfma_f32_16x16x32_bf16 v[212:215], v[116:119], v[22:25], v[212:215]
    s_nop 0
    v_accvgpr_read_b32 v158, a50
    v_mul_f32 v209, v209, v49
    v_mfma_f32_16x16x32_bf16 a[4:7], v[116:119], v[28:31], a[4:7]
    ds_read_b64_tr_b16 v[134:135], v3 offset:13312
    v_permlane32_swap_b32 v48, v148
    v_mul_f32 v211, v211, v49
    v_mfma_f32_16x16x32_bf16 a[52:55], v[116:119], v[34:37], a[52:55]
    s_waitcnt lgkmcnt(4)
    v_accvgpr_read_b32 v153, a1
    v_rcp_f32 v50, v50
    v_mfma_f32_16x16x32_bf16 v[168:171], v[120:123], v[16:19], v[168:171]
    ds_read_b64_tr_b16 v[114:115], v4 offset:13312
    v_accvgpr_read_b32 v157, a49
    v_mfma_f32_16x16x32_bf16 v[216:219], v[120:123], v[22:25], v[216:219]
    v_and_b32 v152, 24, v152
    v_accvgpr_read_b32 v77, a53
    v_accvgpr_read_b32 v79, a55
    v_accvgpr_read_b32 v76, a52
    v_add_u32 v149, s38, v149
    v_mfma_f32_16x16x32_bf16 a[8:11], v[120:123], v[28:31], a[8:11]
    v_bfe_u32 v152, s66, v152, 8
    v_xor_b32 v149, v149, v152
    v_mfma_f32_16x16x32_bf16 a[56:59], v[120:123], v[34:37], a[56:59]
    s_waitcnt lgkmcnt(3)
    v_mul_f32 v77, v77, v51
    v_accvgpr_read_b32 v156, a48
    v_mfma_f32_16x16x32_bf16 v[172:175], v[124:127], v[16:19], v[172:175]
    ds_read_b64_tr_b16 v[132:133], v3 offset:19456
    v_accvgpr_read_b32 v152, a0
    v_mul_f32 v208, v208, v49
    v_mul_f32 v214, v214, v49
    v_mul_f32 v156, v156, v51
    v_mul_f32 v217, v217, v49
    v_mfma_f32_16x16x32_bf16 v[220:223], v[124:127], v[22:25], v[220:223]
    v_accvgpr_read_b32 v78, a54
    v_accvgpr_read_b32 v73, a5
    v_mfma_f32_16x16x32_bf16 a[12:15], v[124:127], v[28:31], a[12:15]
    v_mul_f32 v78, v78, v51
    v_mul_f32 v219, v219, v49
    v_mfma_f32_16x16x32_bf16 a[60:63], v[124:127], v[34:37], a[60:63]
    s_waitcnt lgkmcnt(2)
    v_mul_f32 v213, v213, v49
    v_accvgpr_read_b32 v74, a6
    v_mfma_f32_16x16x32_bf16 v[176:179], v[128:131], v[16:19], v[176:179]
    ds_read_b64_tr_b16 v[112:113], v4 offset:19456
    v_accvgpr_read_b32 v154, a2
    v_mul_f32 v222, v222, v49
    v_rcp_f32 v48, v48
    v_cvt_pk_bf16_f32 v208, v208, v209
    v_mul_f32 v212, v212, v49
    v_pk_mul_f32 v[164:165], v[164:165], v[48:49] op_sel_hi:[1,0]
    v_pk_mul_f32 v[152:153], v[152:153], v[50:51] op_sel_hi:[1,0]
    v_mul_f32 v223, v223, v49
    v_mul_f32 v216, v216, v49
    v_mfma_f32_16x16x32_bf16 v[224:227], v[128:131], v[22:25], v[224:227]
    ds_read_b64_tr_b16 v[126:127], v3 offset:14336
    v_accvgpr_read_b32 v72, a4
    v_mfma_f32_16x16x32_bf16 a[16:19], v[128:131], v[28:31], a[16:19]
    ds_read_b64_tr_b16 v[120:121], v2 offset:20480
    v_mul_f32 v79, v79, v51
    v_mfma_f32_16x16x32_bf16 a[64:67], v[128:131], v[34:37], a[64:67]
    s_waitcnt lgkmcnt(3)
    ds_read_b64_tr_b16 v[118:119], v5 offset:13312
    v_mul_f32 v218, v218, v49
    v_mfma_f32_16x16x32_bf16 v[180:183], v[132:135], v[16:19], v[180:183]
    v_mul_f32 v210, v210, v49
    v_cvt_pk_bf16_f32 v216, v216, v217
    v_cvt_pk_bf16_f32 v212, v212, v213
    v_mfma_f32_16x16x32_bf16 v[228:231], v[132:135], v[22:25], v[228:231]
    ds_read_b64_tr_b16 v[116:117], v5 offset:19456
    v_mul_f32 v157, v157, v51
    v_mul_f32 v158, v158, v51
    v_mul_f32 v220, v220, v49
    v_mfma_f32_16x16x32_bf16 a[20:23], v[132:135], v[28:31], a[20:23]
    ds_read_b64_tr_b16 v[122:123], v2 offset:14336
    v_mul_f32 v226, v226, v49
    v_mul_f32 v76, v76, v51
    v_accvgpr_read_b32 v155, a3
    v_cvt_pk_bf16_f32 v76, v76, v77
    v_cvt_pk_bf16_f32 v156, v156, v157
    v_pk_mul_f32 v[154:155], v[154:155], v[50:51] op_sel_hi:[1,0]
    v_pk_mul_f32 v[178:179], v[178:179], v[48:49] op_sel_hi:[1,0]
    v_cvt_pk_bf16_f32 v77, v78, v79
    v_pk_mul_f32 v[160:161], v[160:161], v[48:49] op_sel_hi:[1,0]
    v_pk_mul_f32 v[168:169], v[168:169], v[48:49] op_sel_hi:[1,0]
    v_accvgpr_read_b32 v75, a7
    v_pk_mul_f32 v[74:75], v[74:75], v[50:51] op_sel_hi:[1,0]
    v_pk_mul_f32 v[72:73], v[72:73], v[50:51] op_sel_hi:[1,0]
    v_pk_mul_f32 v[162:163], v[162:163], v[48:49] op_sel_hi:[1,0]
    v_mul_f32 v224, v224, v49
    v_pk_mul_f32 v[176:177], v[176:177], v[48:49] op_sel_hi:[1,0]
    v_accvgpr_read_b32 v159, a51
    v_cvt_pk_bf16_f32 v152, v152, v153
    v_subrev_u32 v8, 22528, v8
    v_mfma_f32_16x16x32_bf16 a[68:71], v[132:135], v[34:37], a[68:71]
    s_waitcnt lgkmcnt(3)
    v_accvgpr_read_b32 v79, a63
    v_mul_f32 v225, v225, v49
    v_cvt_pk_bf16_f32 v72, v72, v73
    v_mfma_f32_16x16x32_bf16 v[184:187], v[112:115], v[16:19], v[184:187]
    ds_read_b64_tr_b16 v[134:135], v5 offset:14336
    v_cvt_pk_bf16_f32 v224, v224, v225
    v_cvt_pk_bf16_f32 v160, v160, v161
    v_cvt_pk_bf16_f32 v209, v210, v211
    v_mul_f32 v159, v159, v51
    v_mfma_f32_16x16x32_bf16 v[232:235], v[112:115], v[22:25], v[232:235]
    s_add_u32 s84, s34, 0
    ds_read_b64_tr_b16 v[124:125], v3 offset:20480
    v_mul_f32 v215, v215, v49
    v_mfma_f32_16x16x32_bf16 a[24:27], v[112:115], v[28:31], a[24:27]
    v_cvt_pk_bf16_f32 v157, v158, v159
    v_cvt_pk_bf16_f32 v176, v176, v177
    v_accvgpr_read_b32 v159, a59
    v_mfma_f32_16x16x32_bf16 a[72:75], v[112:115], v[34:37], a[72:75]
    s_waitcnt lgkmcnt(2)
    v_accvgpr_read_b32 v158, a58
    v_mul_f32 v159, v159, v51
    v_mfma_f32_16x16x32_bf16 v[188:191], v[116:119], v[16:19], v[188:191]
    v_mul_f32 v221, v221, v49
    v_cvt_pk_bf16_f32 v168, v168, v169
    v_mfma_f32_16x16x32_bf16 v[236:239], v[116:119], v[22:25], v[236:239]
    ds_read_b64_tr_b16 v[132:133], v5 offset:20480
    v_mul_f32 v158, v158, v51
    v_mfma_f32_16x16x32_bf16 a[28:31], v[116:119], v[28:31], a[28:31]
    v_cvt_pk_bf16_f32 v220, v220, v221
    v_mul_f32 v230, v230, v49
    v_mul_f32 v234, v234, v49
    v_mfma_f32_16x16x32_bf16 a[76:79], v[116:119], v[34:37], a[76:79]
    ds_read_b64_tr_b16 v[130:131], v4 offset:14336
    v_cvt_pk_bf16_f32 v153, v154, v155
    v_mfma_f32_16x16x32_bf16 v[192:195], v[120:123], v[16:19], v[192:195]
    v_cvt_pk_bf16_f32 v177, v178, v179
    v_cvt_pk_bf16_f32 v161, v162, v163
    v_mfma_f32_16x16x32_bf16 v[240:243], v[120:123], v[22:25], v[240:243]
    ds_read_b64_tr_b16 v[128:129], v4 offset:20480
    v_cvt_pk_bf16_f32 v164, v164, v165
    v_cvt_pk_bf16_f32 v73, v74, v75
    v_mfma_f32_16x16x32_bf16 a[32:35], v[120:123], v[28:31], a[32:35]
    s_add_u32 s85, s34, 6144
    ds_write2st64_b64 v149, v[160:161], v[208:209] offset0:0 offset1:12
    v_pk_mul_f32 v[166:167], v[166:167], v[48:49] op_sel_hi:[1,0]
    v_pk_mul_f32 v[184:185], v[184:185], v[48:49] op_sel_hi:[1,0]
    v_pk_mul_f32 v[180:181], v[180:181], v[48:49] op_sel_hi:[1,0]
    v_pk_mul_f32 v[170:171], v[170:171], v[48:49] op_sel_hi:[1,0]
    v_accvgpr_read_b32 v78, a62
    v_mul_f32 v229, v229, v49
    v_mfma_f32_16x16x32_bf16 a[80:83], v[120:123], v[34:37], a[80:83]
    s_waitcnt lgkmcnt(4)
    ds_write2st64_b64 v149, v[152:153], v[156:157] offset0:24 offset1:36
    v_mul_f32 v236, v236, v49
    v_mul_f32 v228, v228, v49
    v_mfma_f32_16x16x32_bf16 v[196:199], v[124:127], v[16:19], v[196:199]
    v_cvt_pk_bf16_f32 v184, v184, v185
    v_accvgpr_read_b32 v156, a56
    v_accvgpr_read_b32 v153, a9
    v_cvt_pk_bf16_f32 v165, v166, v167
    v_mul_f32 v235, v235, v49
    v_accvgpr_read_b32 v157, a57
    v_mul_f32 v157, v157, v51
    v_mul_f32 v156, v156, v51
    v_mul_f32 v239, v239, v49
    v_accvgpr_read_b32 v74, a14
    v_cvt_pk_bf16_f32 v213, v214, v215
    v_mfma_f32_16x16x32_bf16 v[244:247], v[124:127], v[22:25], v[244:247]
    v_mul_f32 v79, v79, v51
    v_accvgpr_read_b32 v155, a11
    v_mfma_f32_16x16x32_bf16 a[36:39], v[124:127], v[28:31], a[36:39]
    v_accvgpr_read_b32 v152, a8
    v_xor_b32 v149, 32, v149
    v_mul_f32 v227, v227, v49
    v_mfma_f32_16x16x32_bf16 a[84:87], v[124:127], v[34:37], a[84:87]
    s_waitcnt lgkmcnt(1)
    v_mul_f32 v241, v241, v49
    v_mul_f32 v247, v247, v49
    v_mfma_f32_16x16x32_bf16 v[200:203], v[128:131], v[16:19], v[200:203]
    s_add_u32 s86, s34, 12288
    ds_write2st64_b64 v149, v[164:165], v[212:213] offset0:0 offset1:12
    v_mul_f32 v243, v243, v49
    v_mul_f32 v246, v246, v49
    v_mfma_f32_16x16x32_bf16 v[248:251], v[128:131], v[22:25], v[248:251]
    ds_write2st64_b64 v149, v[72:73], v[76:77] offset0:24 offset1:36
    v_pk_mul_f32 v[152:153], v[152:153], v[50:51] op_sel_hi:[1,0]
    v_pk_mul_f32 v[174:175], v[174:175], v[48:49] op_sel_hi:[1,0]
    v_accvgpr_read_b32 v76, a60
    v_accvgpr_read_b32 v72, a12
    v_mfma_f32_16x16x32_bf16 a[40:43], v[128:131], v[28:31], a[40:43]
    v_xor_b32 v149, 96, v149
    v_cvt_pk_bf16_f32 v152, v152, v153
    v_mfma_f32_16x16x32_bf16 a[88:91], v[128:131], v[34:37], a[88:91]
    s_add_u32 s87, s34, 18432
    v_mul_f32 v249, v249, v49
    v_cvt_pk_bf16_f32 v180, v180, v181
    v_cvt_pk_bf16_f32 v217, v218, v219
    v_mul_f32 v78, v78, v51
    v_cvt_pk_bf16_f32 v225, v226, v227
    v_accvgpr_read_b32 v77, a61
    v_cvt_pk_bf16_f32 v156, v156, v157
    v_accvgpr_read_b32 v154, a10
    v_mul_f32 v76, v76, v51
    v_pk_mul_f32 v[182:183], v[182:183], v[48:49] op_sel_hi:[1,0]
    v_cvt_pk_bf16_f32 v169, v170, v171
    v_pk_mul_f32 v[154:155], v[154:155], v[50:51] op_sel_hi:[1,0]
    v_mul_f32 v231, v231, v49
    v_accvgpr_read_b32 v73, a13
    v_pk_mul_f32 v[194:195], v[194:195], v[48:49] op_sel_hi:[1,0]
    v_mul_f32 v237, v237, v49
    v_pk_mul_f32 v[172:173], v[172:173], v[48:49] op_sel_hi:[1,0]
    v_mul_f32 v238, v238, v49
    v_cvt_pk_bf16_f32 v157, v158, v159
    v_mul_f32 v233, v233, v49
    v_cvt_pk_bf16_f32 v153, v154, v155
    v_cvt_pk_bf16_f32 v236, v236, v237
    v_cvt_pk_bf16_f32 v228, v228, v229
    v_mfma_f32_16x16x32_bf16 v[204:207], v[132:135], v[16:19], v[204:207]
    ds_write2st64_b64 v149, v[168:169], v[216:217] offset0:0 offset1:12
    v_accvgpr_read_b32 v75, a15
    v_mfma_f32_16x16x32_bf16 v[252:255], v[132:135], v[22:25], v[252:255]
    ds_write2st64_b64 v149, v[152:153], v[156:157] offset0:24 offset1:36
    v_pk_mul_f32 v[74:75], v[74:75], v[50:51] op_sel_hi:[1,0]
    v_pk_mul_f32 v[198:199], v[198:199], v[48:49] op_sel_hi:[1,0]
    v_mul_f32 v77, v77, v51
    v_accvgpr_read_b32 v152, a16
    v_pk_mul_f32 v[72:73], v[72:73], v[50:51] op_sel_hi:[1,0]
    v_cvt_pk_bf16_f32 v221, v222, v223
    v_cvt_pk_bf16_f32 v172, v172, v173
    v_accvgpr_read_b32 v156, a64
    v_cvt_pk_bf16_f32 v72, v72, v73
    v_accvgpr_read_b32 v158, a66
    v_accvgpr_read_b32 v157, a65
    v_xor_b32 v149, 32, v149
    v_mul_f32 v252, v252, v49
    v_mul_f32 v255, v255, v49
    v_cvt_pk_bf16_f32 v73, v74, v75
    v_pk_mul_f32 v[188:189], v[188:189], v[48:49] op_sel_hi:[1,0]
    v_accvgpr_read_b32 v155, a19
    v_mul_f32 v240, v240, v49
    v_accvgpr_read_b32 v154, a18
    v_mul_f32 v158, v158, v51
    v_cvt_pk_bf16_f32 v173, v174, v175
    v_accvgpr_read_b32 v74, a22
    v_cvt_pk_bf16_f32 v76, v76, v77
    v_cvt_pk_bf16_f32 v77, v78, v79
    v_mfma_f32_16x16x32_bf16 a[44:47], v[132:135], v[28:31], a[44:47]
    ds_write2st64_b64 v149, v[172:173], v[220:221] offset0:0 offset1:12
    ds_write2st64_b64 v149, v[72:73], v[76:77] offset0:24 offset1:36
    ds_read_b128 v[144:147], v8 offset:0
    ds_read_b128 v[80:83], v8 offset:1024
    ds_read_b128 v[84:87], v8 offset:6144
    v_accvgpr_read_b32 v79, a71
    v_mul_f32 v157, v157, v51
    v_accvgpr_read_b32 v153, a17
    v_accvgpr_read_b32 v77, a69
    v_mul_f32 v232, v232, v49
    v_accvgpr_read_b32 v73, a21
    v_pk_mul_f32 v[152:153], v[152:153], v[50:51] op_sel_hi:[1,0]
    v_mul_f32 v156, v156, v51
    v_cvt_pk_bf16_f32 v156, v156, v157
    v_accvgpr_read_b32 v72, a20
    v_accvgpr_read_b32 v78, a70
    v_accvgpr_read_b32 v75, a23
    v_accvgpr_read_b32 v159, a67
    v_mul_f32 v78, v78, v51
    v_mul_f32 v253, v253, v49
    v_pk_mul_f32 v[72:73], v[72:73], v[50:51] op_sel_hi:[1,0]
    v_cvt_pk_bf16_f32 v188, v188, v189
    v_mul_f32 v79, v79, v51
    v_xor_b32 v149, 96, v149
    v_mul_f32 v242, v242, v49
    v_mul_f32 v159, v159, v51
    v_cvt_pk_bf16_f32 v72, v72, v73
    v_mul_f32 v77, v77, v51
    v_mul_f32 v248, v248, v49
    v_pk_mul_f32 v[186:187], v[186:187], v[48:49] op_sel_hi:[1,0]
    v_cvt_pk_bf16_f32 v157, v158, v159
    v_mul_f32 v244, v244, v49
    v_pk_mul_f32 v[192:193], v[192:193], v[48:49] op_sel_hi:[1,0]
    v_pk_mul_f32 v[200:201], v[200:201], v[48:49] op_sel_hi:[1,0]
    v_cvt_pk_bf16_f32 v185, v186, v187
    v_cvt_pk_bf16_f32 v240, v240, v241
    v_accvgpr_read_b32 v76, a68
    v_cvt_pk_bf16_f32 v181, v182, v183
    v_pk_mul_f32 v[154:155], v[154:155], v[50:51] op_sel_hi:[1,0]
    v_cvt_pk_bf16_f32 v152, v152, v153
    v_cvt_pk_bf16_f32 v153, v154, v155
    v_mfma_f32_16x16x32_bf16 a[92:95], v[132:135], v[34:37], a[92:95]
    s_add_u32 s18, s34, 24576
    ds_read_b128 v[88:91], v8 offset:7168
    ds_read_b128 v[92:95], v8 offset:12288
    ds_read_b128 v[96:99], v8 offset:13312
    ds_read_b128 v[100:103], v8 offset:18432
    ds_read_b128 v[104:107], v8 offset:19456
    ds_write2st64_b64 v149, v[176:177], v[224:225] offset0:4 offset1:16
    ds_write2st64_b64 v149, v[152:153], v[156:157] offset0:28 offset1:40
    v_pk_mul_f32 v[190:191], v[190:191], v[48:49] op_sel_hi:[1,0]
    v_pk_mul_f32 v[206:207], v[206:207], v[48:49] op_sel_hi:[1,0]
    v_cvt_pk_bf16_f32 v232, v232, v233
    v_mul_f32 v76, v76, v51
    v_pk_mul_f32 v[196:197], v[196:197], v[48:49] op_sel_hi:[1,0]
    v_accvgpr_read_b32 v153, a25
    v_accvgpr_read_b32 v159, a75
    v_cvt_pk_bf16_f32 v192, v192, v193
    v_cvt_pk_bf16_f32 v241, v242, v243
    v_accvgpr_read_b32 v156, a72
    v_cvt_pk_bf16_f32 v76, v76, v77
    v_pk_mul_f32 v[74:75], v[74:75], v[50:51] op_sel_hi:[1,0]
    v_cvt_pk_bf16_f32 v233, v234, v235
    v_accvgpr_read_b32 v152, a24
    v_accvgpr_read_b32 v158, a74
    v_cvt_pk_bf16_f32 v196, v196, v197
    v_pk_mul_f32 v[152:153], v[152:153], v[50:51] op_sel_hi:[1,0]
    v_cvt_pk_bf16_f32 v77, v78, v79
    v_cvt_pk_bf16_f32 v152, v152, v153
    v_accvgpr_read_b32 v79, a79
    v_cvt_pk_bf16_f32 v73, v74, v75
    v_mul_f32 v158, v158, v51
    v_accvgpr_read_b32 v157, a73
    v_mul_f32 v245, v245, v49
    v_cvt_pk_bf16_f32 v229, v230, v231
    v_mul_f32 v159, v159, v51
    v_mul_f32 v156, v156, v51
    v_accvgpr_read_b32 v74, a30
    v_accvgpr_read_b32 v154, a26
    v_xor_b32 v149, 32, v149
    v_accvgpr_read_b32 v155, a27
    v_pk_mul_f32 v[204:205], v[204:205], v[48:49] op_sel_hi:[1,0]
    s_waitcnt lgkmcnt(1)
    buffer_store_dwordx4 v[144:147], v6, s[16:19], s84 offen offset:0 sc0 sc1 nt
    buffer_store_dwordx4 v[80:83], v7, s[16:19], s84 offen offset:0 sc0 sc1 nt
    buffer_store_dwordx4 v[84:87], v6, s[16:19], s85 offen offset:0 sc0 sc1 nt
    buffer_store_dwordx4 v[88:91], v7, s[16:19], s85 offen offset:0 sc0 sc1 nt
    buffer_store_dwordx4 v[92:95], v6, s[16:19], s86 offen offset:0 sc0 sc1 nt
    buffer_store_dwordx4 v[96:99], v7, s[16:19], s86 offen offset:0 sc0 sc1 nt
    ds_write2st64_b64 v149, v[180:181], v[228:229] offset0:4 offset1:16
    ds_write2st64_b64 v149, v[72:73], v[76:77] offset0:28 offset1:40
    v_pk_mul_f32 v[154:155], v[154:155], v[50:51] op_sel_hi:[1,0]
    v_cvt_pk_bf16_f32 v193, v194, v195
    v_accvgpr_read_b32 v75, a31
    v_mul_f32 v79, v79, v51
    v_mul_f32 v157, v157, v51
    v_accvgpr_read_b32 v77, a77
    v_accvgpr_read_b32 v78, a78
    v_cvt_pk_bf16_f32 v237, v238, v239
    v_cvt_pk_bf16_f32 v156, v156, v157
    v_mul_f32 v78, v78, v51
    v_cvt_pk_bf16_f32 v157, v158, v159
    v_cvt_pk_bf16_f32 v204, v204, v205
    v_accvgpr_read_b32 v73, a29
    v_cvt_pk_bf16_f32 v205, v206, v207
    v_cvt_pk_bf16_f32 v189, v190, v191
    v_cvt_pk_bf16_f32 v153, v154, v155
    v_mul_f32 v254, v254, v49
    v_xor_b32 v149, 96, v149
    ds_write2st64_b64 v149, v[184:185], v[232:233] offset0:4 offset1:16
    ds_write2st64_b64 v149, v[152:153], v[156:157] offset0:28 offset1:40
    v_accvgpr_read_b32 v76, a76
    v_accvgpr_read_b32 v72, a28
    v_accvgpr_read_b32 v154, a34
    v_accvgpr_read_b32 v155, a35
    v_mul_f32 v77, v77, v51
    v_pk_mul_f32 v[72:73], v[72:73], v[50:51] op_sel_hi:[1,0]
    v_mul_f32 v251, v251, v49
    v_mul_f32 v76, v76, v51
    v_cvt_pk_bf16_f32 v76, v76, v77
    v_cvt_pk_bf16_f32 v244, v244, v245
    v_accvgpr_read_b32 v152, a32
    v_cvt_pk_bf16_f32 v200, v200, v201
    v_cvt_pk_bf16_f32 v72, v72, v73
    v_accvgpr_read_b32 v153, a33
    v_pk_mul_f32 v[152:153], v[152:153], v[50:51] op_sel_hi:[1,0]
    v_pk_mul_f32 v[74:75], v[74:75], v[50:51] op_sel_hi:[1,0]
    v_cvt_pk_bf16_f32 v77, v78, v79
    v_cvt_pk_bf16_f32 v73, v74, v75
    v_xor_b32 v149, 32, v149
    ds_write2st64_b64 v149, v[188:189], v[236:237] offset0:4 offset1:16
    ds_write2st64_b64 v149, v[72:73], v[76:77] offset0:28 offset1:40
    ds_read_b128 v[108:111], v8 offset:2048
    ds_read_b128 v[144:147], v8 offset:3072
    ds_read_b128 v[80:83], v8 offset:8192
    ds_read_b128 v[84:87], v8 offset:9216
    ds_read_b128 v[88:91], v8 offset:14336
    ds_read_b128 v[92:95], v8 offset:15360
    v_cvt_pk_bf16_f32 v248, v248, v249
    v_cvt_pk_bf16_f32 v245, v246, v247
    v_accvgpr_read_b32 v77, a85
    v_accvgpr_read_b32 v78, a86
    v_accvgpr_read_b32 v76, a84
    v_accvgpr_read_b32 v72, a36
    v_cvt_pk_bf16_f32 v152, v152, v153
    v_accvgpr_read_b32 v158, a82
    v_accvgpr_read_b32 v156, a80
    v_pk_mul_f32 v[154:155], v[154:155], v[50:51] op_sel_hi:[1,0]
    v_accvgpr_read_b32 v73, a37
    v_accvgpr_read_b32 v157, a81
    v_pk_mul_f32 v[72:73], v[72:73], v[50:51] op_sel_hi:[1,0]
    v_mul_f32 v76, v76, v51
    v_mul_f32 v158, v158, v51
    v_pk_mul_f32 v[202:203], v[202:203], v[48:49] op_sel_hi:[1,0]
    v_mul_f32 v156, v156, v51
    v_accvgpr_read_b32 v74, a38
    v_mul_f32 v250, v250, v49
    v_mul_f32 v157, v157, v51
    v_accvgpr_read_b32 v159, a83
    v_mul_f32 v159, v159, v51
    v_accvgpr_read_b32 v75, a39
    v_xor_b32 v149, 96, v149
    v_accvgpr_read_b32 v79, a87
    v_cvt_pk_bf16_f32 v252, v252, v253
    v_cvt_pk_bf16_f32 v156, v156, v157
    v_cvt_pk_bf16_f32 v157, v158, v159
    v_cvt_pk_bf16_f32 v153, v154, v155
    buffer_store_dwordx4 v[100:103], v6, s[16:19], s87 offen offset:0 sc0 sc1 nt
    buffer_store_dwordx4 v[104:107], v7, s[16:19], s87 offen offset:0 sc0 sc1 nt
    ds_read_b128 v[96:99], v8 offset:20480
    ds_read_b128 v[100:103], v8 offset:21504
    ds_write2st64_b64 v149, v[192:193], v[240:241] offset0:8 offset1:20
    ds_write2st64_b64 v149, v[152:153], v[156:157] offset0:32 offset1:44
    v_mul_f32 v77, v77, v51
    v_accvgpr_read_b32 v159, a91
    v_cvt_pk_bf16_f32 v197, v198, v199
    v_cvt_pk_bf16_f32 v201, v202, v203
    v_accvgpr_read_b32 v155, a43
    v_pk_mul_f32 v[74:75], v[74:75], v[50:51] op_sel_hi:[1,0]
    v_cvt_pk_bf16_f32 v76, v76, v77
    v_accvgpr_read_b32 v157, a89
    v_cvt_pk_bf16_f32 v253, v254, v255
    v_mul_f32 v79, v79, v51
    v_cvt_pk_bf16_f32 v72, v72, v73
    v_xor_b32 v149, 32, v149
    v_accvgpr_read_b32 v153, a41
    v_accvgpr_read_b32 v154, a42
    v_mul_f32 v78, v78, v51
    v_cvt_pk_bf16_f32 v73, v74, v75
    v_accvgpr_read_b32 v152, a40
    v_mul_f32 v159, v159, v51
    v_pk_mul_f32 v[154:155], v[154:155], v[50:51] op_sel_hi:[1,0]
    v_cvt_pk_bf16_f32 v77, v78, v79
    v_mul_f32 v157, v157, v51
    v_accvgpr_read_b32 v156, a88
    v_mul_f32 v156, v156, v51
    v_accvgpr_read_b32 v75, a47
    v_cvt_pk_bf16_f32 v249, v250, v251
    v_pk_mul_f32 v[152:153], v[152:153], v[50:51] op_sel_hi:[1,0]
    v_accvgpr_read_b32 v158, a90
    s_waitcnt lgkmcnt(2)
    buffer_store_dwordx4 v[108:111], v6, s[16:19], s84 offen offset:128 sc0 sc1 nt
    buffer_store_dwordx4 v[144:147], v7, s[16:19], s84 offen offset:128 sc0 sc1 nt
    buffer_store_dwordx4 v[80:83], v6, s[16:19], s85 offen offset:128 sc0 sc1 nt
    ds_write2st64_b64 v149, v[196:197], v[244:245] offset0:8 offset1:20
    ds_write2st64_b64 v149, v[72:73], v[76:77] offset0:32 offset1:44
    v_xor_b32 v149, 96, v149
    v_accvgpr_read_b32 v73, a45
    v_accvgpr_read_b32 v74, a46
    v_accvgpr_read_b32 v78, a94
    v_cvt_pk_bf16_f32 v156, v156, v157
    v_cvt_pk_bf16_f32 v152, v152, v153
    v_mul_f32 v78, v78, v51
    v_accvgpr_read_b32 v72, a44
    v_accvgpr_read_b32 v79, a95
    v_mul_f32 v158, v158, v51
    v_accvgpr_read_b32 v76, a92
    v_accvgpr_read_b32 v77, a93
    v_mul_f32 v76, v76, v51
    v_pk_mul_f32 v[72:73], v[72:73], v[50:51] op_sel_hi:[1,0]
    v_cvt_pk_bf16_f32 v157, v158, v159
    v_cvt_pk_bf16_f32 v153, v154, v155
    v_mul_f32 v77, v77, v51
    v_mul_f32 v79, v79, v51
    v_pk_mul_f32 v[74:75], v[74:75], v[50:51] op_sel_hi:[1,0]
    ds_write2st64_b64 v149, v[200:201], v[248:249] offset0:8 offset1:20
    ds_write2st64_b64 v149, v[152:153], v[156:157] offset0:32 offset1:44
    v_cvt_pk_bf16_f32 v72, v72, v73
    v_cvt_pk_bf16_f32 v76, v76, v77
    v_cvt_pk_bf16_f32 v73, v74, v75
    v_cvt_pk_bf16_f32 v77, v78, v79
    v_xor_b32 v149, 32, v149
    ds_write2st64_b64 v149, v[204:205], v[252:253] offset0:8 offset1:20
    ds_write2st64_b64 v149, v[72:73], v[76:77] offset0:32 offset1:44
    ds_read_b128 v[104:107], v8 offset:4096
    ds_read_b128 v[108:111], v8 offset:5120
    ds_read_b128 v[144:147], v8 offset:10240
    ds_read_b128 v[80:83], v8 offset:11264
    buffer_store_dwordx4 v[84:87], v7, s[16:19], s85 offen offset:128 sc0 sc1 nt
    buffer_store_dwordx4 v[88:91], v6, s[16:19], s86 offen offset:128 sc0 sc1 nt
    ds_read_b128 v[84:87], v8 offset:16384
    ds_read_b128 v[88:91], v8 offset:17408
    buffer_store_dwordx4 v[92:95], v7, s[16:19], s86 offen offset:128 sc0 sc1 nt
    s_nop 0
    ds_read_b128 v[92:95], v8 offset:22528
    buffer_store_dwordx4 v[96:99], v6, s[16:19], s87 offen offset:128 sc0 sc1 nt
    s_nop 0
    ds_read_b128 v[96:99], v8 offset:23552
    buffer_store_dwordx4 v[100:103], v7, s[16:19], s87 offen offset:128 sc0 sc1 nt
    s_waitcnt lgkmcnt(7)
    buffer_store_dwordx4 v[104:107], v6, s[16:19], s84 offen offset:256 sc0 sc1 nt
    s_waitcnt lgkmcnt(4)
    buffer_store_dwordx4 v[108:111], v7, s[16:19], s84 offen offset:256 sc0 sc1 nt
    buffer_store_dwordx4 v[144:147], v6, s[16:19], s85 offen offset:256 sc0 sc1 nt
    buffer_store_dwordx4 v[80:83], v7, s[16:19], s85 offen offset:256 sc0 sc1 nt
    s_waitcnt lgkmcnt(2)
    buffer_store_dwordx4 v[84:87], v6, s[16:19], s86 offen offset:256 sc0 sc1 nt
    buffer_store_dwordx4 v[88:91], v7, s[16:19], s86 offen offset:256 sc0 sc1 nt
    s_waitcnt lgkmcnt(1)
    buffer_store_dwordx4 v[92:95], v6, s[16:19], s87 offen offset:256 sc0 sc1 nt
    s_waitcnt lgkmcnt(0)
    buffer_store_dwordx4 v[96:99], v7, s[16:19], s87 offen offset:256 sc0 sc1 nt
    s_branch L_fin
L_fin:
    s_waitcnt vmcnt(0)
L_end:
    s_endpgm
L_codeend:
L_rare5_0:
    s_nop 15
    v_mbcnt_lo_u32_b32 v31, -1, 0
    v_mbcnt_hi_u32_b32 v31, -1, v31
    v_and_b32 v30, 15, v31
    v_mul_u32_u24 v30, 384, v30
    v_lshrrev_b32 v31, 4, v31
    v_lshl_add_u32 v30, v31, 4, v30
    s_add_u32 s69, s39, 0
    buffer_load_dwordx4 v[44:47], v30, s[4:7], s69 offen offset:0
    s_waitcnt vmcnt(0)
    v_mfma_f32_16x16x32_bf16 v[152:155], v[44:47], a[144:147], 0
    s_nop 7
    buffer_load_dwordx4 v[44:47], v30, s[4:7], s69 offen offset:64
    s_waitcnt vmcnt(0)
    v_mfma_f32_16x16x32_bf16 v[152:155], v[44:47], a[148:151], v[152:155]
    s_nop 7
    buffer_load_dwordx4 v[44:47], v30, s[4:7], s69 offen offset:128
    s_waitcnt vmcnt(0)
    v_mfma_f32_16x16x32_bf16 v[152:155], v[44:47], a[152:155], v[152:155]
    s_nop 7
    buffer_load_dwordx4 v[44:47], v30, s[4:7], s69 offen offset:192
    s_waitcnt vmcnt(0)
    v_mfma_f32_16x16x32_bf16 v[152:155], v[44:47], a[156:159], v[152:155]
    s_nop 7
    buffer_load_dwordx4 v[44:47], v30, s[4:7], s69 offen offset:256
    s_waitcnt vmcnt(0)
    v_mfma_f32_16x16x32_bf16 v[152:155], v[44:47], a[160:163], v[152:155]
    s_nop 7
    buffer_load_dwordx4 v[44:47], v30, s[4:7], s69 offen offset:320
    s_waitcnt vmcnt(0)
    v_mfma_f32_16x16x32_bf16 v[152:155], v[44:47], a[164:167], v[152:155]
    s_nop 7
    s_add_u32 s69, s39, 6144
    buffer_load_dwordx4 v[44:47], v30, s[4:7], s69 offen offset:0
    s_waitcnt vmcnt(0)
    v_mfma_f32_16x16x32_bf16 v[156:159], v[44:47], a[144:147], 0
    s_nop 7
    buffer_load_dwordx4 v[44:47], v30, s[4:7], s69 offen offset:64
    s_waitcnt vmcnt(0)
    v_mfma_f32_16x16x32_bf16 v[156:159], v[44:47], a[148:151], v[156:159]
    s_nop 7
    buffer_load_dwordx4 v[44:47], v30, s[4:7], s69 offen offset:128
    s_waitcnt vmcnt(0)
    v_mfma_f32_16x16x32_bf16 v[156:159], v[44:47], a[152:155], v[156:159]
    s_nop 7
    buffer_load_dwordx4 v[44:47], v30, s[4:7], s69 offen offset:192
    s_waitcnt vmcnt(0)
    v_mfma_f32_16x16x32_bf16 v[156:159], v[44:47], a[156:159], v[156:159]
    s_nop 7
    buffer_load_dwordx4 v[44:47], v30, s[4:7], s69 offen offset:256
    s_waitcnt vmcnt(0)
    v_mfma_f32_16x16x32_bf16 v[156:159], v[44:47], a[160:163], v[156:159]
    s_nop 7
    buffer_load_dwordx4 v[44:47], v30, s[4:7], s69 offen offset:320
    s_waitcnt vmcnt(0)
    v_mfma_f32_16x16x32_bf16 v[156:159], v[44:47], a[164:167], v[156:159]
    s_nop 7
    s_nop 15
    v_max3_f32 v18, v152, v153, v154
    v_max3_f32 v18, v18, v155, v156
    v_max3_f32 v18, v18, v157, v158
    v_max_f32 v18, v18, v159
    v_mov_b32 v19, v18
    s_nop 1
    v_permlane32_swap_b32 v19, v18
    v_max_f32 v18, v18, v19
    v_mov_b32 v19, v18
    s_nop 1
    v_permlane16_swap_b32 v19, v18
    v_max_f32 v18, v18, v19
    v_fma_f32 v18, v18, s28, v9
    v_max_f32 v24, 0, v18
    v_sub_f32 v9, v9, v24
    v_sub_f32 v25, 0, v24
    v_exp_f32 v25, v25
    s_nop 0
    v_mul_f32 v19, v48, v25
    v_cndmask_b32_e64 v48, v19, v48, s[60:61]
    v_cndmask_b32_e64 v48, v48, 0, s[46:47]
    v_mul_f32 v160, v160, v25
    v_mul_f32 v161, v161, v25
    v_mul_f32 v162, v162, v25
    v_mul_f32 v163, v163, v25
    v_mul_f32 v164, v164, v25
    v_mul_f32 v165, v165, v25
    v_mul_f32 v166, v166, v25
    v_mul_f32 v167, v167, v25
    v_mul_f32 v168, v168, v25
    v_mul_f32 v169, v169, v25
    v_mul_f32 v170, v170, v25
    v_mul_f32 v171, v171, v25
    v_mul_f32 v172, v172, v25
    v_mul_f32 v173, v173, v25
    v_mul_f32 v174, v174, v25
    v_mul_f32 v175, v175, v25
    v_mul_f32 v176, v176, v25
    v_mul_f32 v177, v177, v25
    v_mul_f32 v178, v178, v25
    v_mul_f32 v179, v179, v25
    v_mul_f32 v180, v180, v25
    v_mul_f32 v181, v181, v25
    v_mul_f32 v182, v182, v25
    v_mul_f32 v183, v183, v25
    v_mul_f32 v184, v184, v25
    v_mul_f32 v185, v185, v25
    v_mul_f32 v186, v186, v25
    v_mul_f32 v187, v187, v25
    v_mul_f32 v188, v188, v25
    v_mul_f32 v189, v189, v25
    v_mul_f32 v190, v190, v25
    v_mul_f32 v191, v191, v25
    v_mul_f32 v192, v192, v25
    v_mul_f32 v193, v193, v25
    v_mul_f32 v194, v194, v25
    v_mul_f32 v195, v195, v25
    v_mul_f32 v196, v196, v25
    v_mul_f32 v197, v197, v25
    v_mul_f32 v198, v198, v25
    v_mul_f32 v199, v199, v25
    v_mul_f32 v200, v200, v25
    v_mul_f32 v201, v201, v25
    v_mul_f32 v202, v202, v25
    v_mul_f32 v203, v203, v25
    v_mul_f32 v204, v204, v25
    v_mul_f32 v205, v205, v25
    v_mul_f32 v206, v206, v25
    v_mul_f32 v207, v207, v25
    v_fma_f32 v152, v152, s28, v9
    v_fma_f32 v153, v153, s28, v9
    v_exp_f32 v152, v152
    v_exp_f32 v153, v153
    s_nop 0
    v_cvt_pk_bf16_f32 v14, v152, v153
    v_fma_f32 v154, v154, s28, v9
    v_fma_f32 v155, v155, s28, v9
    v_exp_f32 v154, v154
    v_exp_f32 v155, v155
    s_nop 0
    v_cvt_pk_bf16_f32 v15, v154, v155
    v_fma_f32 v156, v156, s28, v9
    v_fma_f32 v157, v157, s28, v9
    v_exp_f32 v156, v156
    v_exp_f32 v157, v157
    s_nop 0
    v_cvt_pk_bf16_f32 v16, v156, v157
    v_fma_f32 v158, v158, s28, v9
    v_fma_f32 v159, v159, s28, v9
    v_exp_f32 v158, v158
    v_exp_f32 v159, v159
    s_nop 0
    v_cvt_pk_bf16_f32 v17, v158, v159
    s_add_u32 s69, s39, 0
    buffer_load_dwordx4 v[44:47], v30, s[4:7], s69 offen offset:0
    s_waitcnt vmcnt(0)
    v_mfma_f32_16x16x32_bf16 v[152:155], v[44:47], a[168:171], 0
    s_nop 7
    buffer_load_dwordx4 v[44:47], v30, s[4:7], s69 offen offset:64
    s_waitcnt vmcnt(0)
    v_mfma_f32_16x16x32_bf16 v[152:155], v[44:47], a[172:175], v[152:155]
    s_nop 7
    buffer_load_dwordx4 v[44:47], v30, s[4:7], s69 offen offset:128
    s_waitcnt vmcnt(0)
    v_mfma_f32_16x16x32_bf16 v[152:155], v[44:47], a[176:179], v[152:155]
    s_nop 7
    buffer_load_dwordx4 v[44:47], v30, s[4:7], s69 offen offset:192
    s_waitcnt vmcnt(0)
    v_mfma_f32_16x16x32_bf16 v[152:155], v[44:47], a[180:183], v[152:155]
    s_nop 7
    buffer_load_dwordx4 v[44:47], v30, s[4:7], s69 offen offset:256
    s_waitcnt vmcnt(0)
    v_mfma_f32_16x16x32_bf16 v[152:155], v[44:47], a[184:187], v[152:155]
    s_nop 7
    buffer_load_dwordx4 v[44:47], v30, s[4:7], s69 offen offset:320
    s_waitcnt vmcnt(0)
    v_mfma_f32_16x16x32_bf16 v[152:155], v[44:47], a[188:191], v[152:155]
    s_nop 7
    s_add_u32 s69, s39, 6144
    buffer_load_dwordx4 v[44:47], v30, s[4:7], s69 offen offset:0
    s_waitcnt vmcnt(0)
    v_mfma_f32_16x16x32_bf16 v[156:159], v[44:47], a[168:171], 0
    s_nop 7
    buffer_load_dwordx4 v[44:47], v30, s[4:7], s69 offen offset:64
    s_waitcnt vmcnt(0)
    v_mfma_f32_16x16x32_bf16 v[156:159], v[44:47], a[172:175], v[156:159]
    s_nop 7
    buffer_load_dwordx4 v[44:47], v30, s[4:7], s69 offen offset:128
    s_waitcnt vmcnt(0)
    v_mfma_f32_16x16x32_bf16 v[156:159], v[44:47], a[176:179], v[156:159]
    s_nop 7
    buffer_load_dwordx4 v[44:47], v30, s[4:7], s69 offen offset:192
    s_waitcnt vmcnt(0)
    v_mfma_f32_16x16x32_bf16 v[156:159], v[44:47], a[180:183], v[156:159]
    s_nop 7
    buffer_load_dwordx4 v[44:47], v30, s[4:7], s69 offen offset:256
    s_waitcnt vmcnt(0)
    v_mfma_f32_16x16x32_bf16 v[156:159], v[44:47], a[184:187], v[156:159]
    s_nop 7
    buffer_load_dwordx4 v[44:47], v30, s[4:7], s69 offen offset:320
    s_waitcnt vmcnt(0)
    v_mfma_f32_16x16x32_bf16 v[156:159], v[44:47], a[188:191], v[156:159]
    s_nop 7
    s_nop 15
    v_max3_f32 v18, v152, v153, v154
    v_max3_f32 v18, v18, v155, v156
    v_max3_f32 v18, v18, v157, v158
    v_max_f32 v18, v18, v159
    v_mov_b32 v19, v18
    s_nop 1
    v_permlane32_swap_b32 v19, v18
    v_max_f32 v18, v18, v19
    v_mov_b32 v19, v18
    s_nop 1
    v_permlane16_swap_b32 v19, v18
    v_max_f32 v18, v18, v19
    v_fma_f32 v18, v18, s28, v10
    v_max_f32 v24, 0, v18
    v_sub_f32 v10, v10, v24
    v_sub_f32 v25, 0, v24
    v_exp_f32 v25, v25
    s_nop 0
    v_mul_f32 v49, v49, v25
    v_mul_f32 v208, v208, v25
    v_mul_f32 v209, v209, v25
    v_mul_f32 v210, v210, v25
    v_mul_f32 v211, v211, v25
    v_mul_f32 v212, v212, v25
    v_mul_f32 v213, v213, v25
    v_mul_f32 v214, v214, v25
    v_mul_f32 v215, v215, v25
    v_mul_f32 v216, v216, v25
    v_mul_f32 v217, v217, v25
    v_mul_f32 v218, v218, v25
    v_mul_f32 v219, v219, v25
    v_mul_f32 v220, v220, v25
    v_mul_f32 v221, v221, v25
    v_mul_f32 v222, v222, v25
    v_mul_f32 v223, v223, v25
    v_mul_f32 v224, v224, v25
    v_mul_f32 v225, v225, v25
    v_mul_f32 v226, v226, v25
    v_mul_f32 v227, v227, v25
    v_mul_f32 v228, v228, v25
    v_mul_f32 v229, v229, v25
    v_mul_f32 v230, v230, v25
    v_mul_f32 v231, v231, v25
    v_mul_f32 v232, v232, v25
    v_mul_f32 v233, v233, v25
    v_mul_f32 v234, v234, v25
    v_mul_f32 v235, v235, v25
    v_mul_f32 v236, v236, v25
    v_mul_f32 v237, v237, v25
    v_mul_f32 v238, v238, v25
    v_mul_f32 v239, v239, v25
    v_mul_f32 v240, v240, v25
    v_mul_f32 v241, v241, v25
    v_mul_f32 v242, v242, v25
    v_mul_f32 v243, v243, v25
    v_mul_f32 v244, v244, v25
    v_mul_f32 v245, v245, v25
    v_mul_f32 v246, v246, v25
    v_mul_f32 v247, v247, v25
    v_mul_f32 v248, v248, v25
    v_mul_f32 v249, v249, v25
    v_mul_f32 v250, v250, v25
    v_mul_f32 v251, v251, v25
    v_mul_f32 v252, v252, v25
    v_mul_f32 v253, v253, v25
    v_mul_f32 v254, v254, v25
    v_mul_f32 v255, v255, v25
    v_fma_f32 v152, v152, s28, v10
    v_fma_f32 v153, v153, s28, v10
    v_exp_f32 v152, v152
    v_exp_f32 v153, v153
    s_nop 0
    v_cvt_pk_bf16_f32 v20, v152, v153
    v_fma_f32 v154, v154, s28, v10
    v_fma_f32 v155, v155, s28, v10
    v_exp_f32 v154, v154
    v_exp_f32 v155, v155
    s_nop 0
    v_cvt_pk_bf16_f32 v21, v154, v155
    v_fma_f32 v156, v156, s28, v10
    v_fma_f32 v157, v157, s28, v10
    v_exp_f32 v156, v156
    v_exp_f32 v157, v157
    s_nop 0
    v_cvt_pk_bf16_f32 v22, v156, v157
    v_fma_f32 v158, v158, s28, v10
    v_fma_f32 v159, v159, s28, v10
    v_exp_f32 v158, v158
    v_exp_f32 v159, v159
    s_nop 0
    v_cvt_pk_bf16_f32 v23, v158, v159
    s_add_u32 s69, s39, 0
    buffer_load_dwordx4 v[44:47], v30, s[4:7], s69 offen offset:0
    s_waitcnt vmcnt(0)
    v_mfma_f32_16x16x32_bf16 v[152:155], v[44:47], a[192:195], 0
    s_nop 7
    buffer_load_dwordx4 v[44:47], v30, s[4:7], s69 offen offset:64
    s_waitcnt vmcnt(0)
    v_mfma_f32_16x16x32_bf16 v[152:155], v[44:47], a[196:199], v[152:155]
    s_nop 7
    buffer_load_dwordx4 v[44:47], v30, s[4:7], s69 offen offset:128
    s_waitcnt vmcnt(0)
    v_mfma_f32_16x16x32_bf16 v[152:155], v[44:47], a[200:203], v[152:155]
    s_nop 7
    buffer_load_dwordx4 v[44:47], v30, s[4:7], s69 offen offset:192
    s_waitcnt vmcnt(0)
    v_mfma_f32_16x16x32_bf16 v[152:155], v[44:47], a[204:207], v[152:155]
    s_nop 7
    buffer_load_dwordx4 v[44:47], v30, s[4:7], s69 offen offset:256
    s_waitcnt vmcnt(0)
    v_mfma_f32_16x16x32_bf16 v[152:155], v[44:47], a[208:211], v[152:155]
    s_nop 7
    buffer_load_dwordx4 v[44:47], v30, s[4:7], s69 offen offset:320
    s_waitcnt vmcnt(0)
    v_mfma_f32_16x16x32_bf16 v[152:155], v[44:47], a[212:215], v[152:155]
    s_nop 7
    s_add_u32 s69, s39, 6144
    buffer_load_dwordx4 v[44:47], v30, s[4:7], s69 offen offset:0
    s_waitcnt vmcnt(0)
    v_mfma_f32_16x16x32_bf16 v[156:159], v[44:47], a[192:195], 0
    s_nop 7
    buffer_load_dwordx4 v[44:47], v30, s[4:7], s69 offen offset:64
    s_waitcnt vmcnt(0)
    v_mfma_f32_16x16x32_bf16 v[156:159], v[44:47], a[196:199], v[156:159]
    s_nop 7
    buffer_load_dwordx4 v[44:47], v30, s[4:7], s69 offen offset:128
    s_waitcnt vmcnt(0)
    v_mfma_f32_16x16x32_bf16 v[156:159], v[44:47], a[200:203], v[156:159]
    s_nop 7
    buffer_load_dwordx4 v[44:47], v30, s[4:7], s69 offen offset:192
    s_waitcnt vmcnt(0)
    v_mfma_f32_16x16x32_bf16 v[156:159], v[44:47], a[204:207], v[156:159]
    s_nop 7
    buffer_load_dwordx4 v[44:47], v30, s[4:7], s69 offen offset:256
    s_waitcnt vmcnt(0)
    v_mfma_f32_16x16x32_bf16 v[156:159], v[44:47], a[208:211], v[156:159]
    s_nop 7
    buffer_load_dwordx4 v[44:47], v30, s[4:7], s69 offen offset:320
    s_waitcnt vmcnt(0)
    v_mfma_f32_16x16x32_bf16 v[156:159], v[44:47], a[212:215], v[156:159]
    s_nop 7
    s_nop 15
    v_max3_f32 v18, v152, v153, v154
    v_max3_f32 v18, v18, v155, v156
    v_max3_f32 v18, v18, v157, v158
    v_max_f32 v18, v18, v159
    v_mov_b32 v19, v18
    s_nop 1
    v_permlane32_swap_b32 v19, v18
    v_max_f32 v18, v18, v19
    v_mov_b32 v19, v18
    s_nop 1
    v_permlane16_swap_b32 v19, v18
    v_max_f32 v18, v18, v19
    v_fma_f32 v18, v18, s28, v11
    v_max_f32 v24, 0, v18
    v_sub_f32 v11, v11, v24
    v_sub_f32 v25, 0, v24
    v_exp_f32 v25, v25
    s_nop 0
    v_mul_f32 v50, v50, v25
    v_accvgpr_read_b32 v19, a0
    v_mul_f32 v19, v19, v25
    v_accvgpr_write_b32 a0, v19
    v_accvgpr_read_b32 v19, a1
    v_mul_f32 v19, v19, v25
    v_accvgpr_write_b32 a1, v19
    v_accvgpr_read_b32 v19, a2
    v_mul_f32 v19, v19, v25
    v_accvgpr_write_b32 a2, v19
    v_accvgpr_read_b32 v19, a3
    v_mul_f32 v19, v19, v25
    v_accvgpr_write_b32 a3, v19
    v_accvgpr_read_b32 v19, a4
    v_mul_f32 v19, v19, v25
    v_accvgpr_write_b32 a4, v19
    v_accvgpr_read_b32 v19, a5
    v_mul_f32 v19, v19, v25
    v_accvgpr_write_b32 a5, v19
    v_accvgpr_read_b32 v19, a6
    v_mul_f32 v19, v19, v25
    v_accvgpr_write_b32 a6, v19
    v_accvgpr_read_b32 v19, a7
    v_mul_f32 v19, v19, v25
    v_accvgpr_write_b32 a7, v19
    v_accvgpr_read_b32 v19, a8
    v_mul_f32 v19, v19, v25
    v_accvgpr_write_b32 a8, v19
    v_accvgpr_read_b32 v19, a9
    v_mul_f32 v19, v19, v25
    v_accvgpr_write_b32 a9, v19
    v_accvgpr_read_b32 v19, a10
    v_mul_f32 v19, v19, v25
    v_accvgpr_write_b32 a10, v19
    v_accvgpr_read_b32 v19, a11
    v_mul_f32 v19, v19, v25
    v_accvgpr_write_b32 a11, v19
    v_accvgpr_read_b32 v19, a12
    v_mul_f32 v19, v19, v25
    v_accvgpr_write_b32 a12, v19
    v_accvgpr_read_b32 v19, a13
    v_mul_f32 v19, v19, v25
    v_accvgpr_write_b32 a13, v19
    v_accvgpr_read_b32 v19, a14
    v_mul_f32 v19, v19, v25
    v_accvgpr_write_b32 a14, v19
    v_accvgpr_read_b32 v19, a15
    v_mul_f32 v19, v19, v25
    v_accvgpr_write_b32 a15, v19
    v_accvgpr_read_b32 v19, a16
    v_mul_f32 v19, v19, v25
    v_accvgpr_write_b32 a16, v19
    v_accvgpr_read_b32 v19, a17
    v_mul_f32 v19, v19, v25
    v_accvgpr_write_b32 a17, v19
    v_accvgpr_read_b32 v19, a18
    v_mul_f32 v19, v19, v25
    v_accvgpr_write_b32 a18, v19
    v_accvgpr_read_b32 v19, a19
    v_mul_f32 v19, v19, v25
    v_accvgpr_write_b32 a19, v19
    v_accvgpr_read_b32 v19, a20
    v_mul_f32 v19, v19, v25
    v_accvgpr_write_b32 a20, v19
    v_accvgpr_read_b32 v19, a21
    v_mul_f32 v19, v19, v25
    v_accvgpr_write_b32 a21, v19
    v_accvgpr_read_b32 v19, a22
    v_mul_f32 v19, v19, v25
    v_accvgpr_write_b32 a22, v19
    v_accvgpr_read_b32 v19, a23
    v_mul_f32 v19, v19, v25
    v_accvgpr_write_b32 a23, v19
    v_accvgpr_read_b32 v19, a24
    v_mul_f32 v19, v19, v25
    v_accvgpr_write_b32 a24, v19
    v_accvgpr_read_b32 v19, a25
    v_mul_f32 v19, v19, v25
    v_accvgpr_write_b32 a25, v19
    v_accvgpr_read_b32 v19, a26
    v_mul_f32 v19, v19, v25
    v_accvgpr_write_b32 a26, v19
    v_accvgpr_read_b32 v19, a27
    v_mul_f32 v19, v19, v25
    v_accvgpr_write_b32 a27, v19
    v_accvgpr_read_b32 v19, a28
    v_mul_f32 v19, v19, v25
    v_accvgpr_write_b32 a28, v19
    v_accvgpr_read_b32 v19, a29
    v_mul_f32 v19, v19, v25
    v_accvgpr_write_b32 a29, v19
    v_accvgpr_read_b32 v19, a30
    v_mul_f32 v19, v19, v25
    v_accvgpr_write_b32 a30, v19
    v_accvgpr_read_b32 v19, a31
    v_mul_f32 v19, v19, v25
    v_accvgpr_write_b32 a31, v19
    v_accvgpr_read_b32 v19, a32
    v_mul_f32 v19, v19, v25
    v_accvgpr_write_b32 a32, v19
    v_accvgpr_read_b32 v19, a33
    v_mul_f32 v19, v19, v25
    v_accvgpr_write_b32 a33, v19
    v_accvgpr_read_b32 v19, a34
    v_mul_f32 v19, v19, v25
    v_accvgpr_write_b32 a34, v19
    v_accvgpr_read_b32 v19, a35
    v_mul_f32 v19, v19, v25
    v_accvgpr_write_b32 a35, v19
    v_accvgpr_read_b32 v19, a36
    v_mul_f32 v19, v19, v25
    v_accvgpr_write_b32 a36, v19
    v_accvgpr_read_b32 v19, a37
    v_mul_f32 v19, v19, v25
    v_accvgpr_write_b32 a37, v19
    v_accvgpr_read_b32 v19, a38
    v_mul_f32 v19, v19, v25
    v_accvgpr_write_b32 a38, v19
    v_accvgpr_read_b32 v19, a39
    v_mul_f32 v19, v19, v25
    v_accvgpr_write_b32 a39, v19
    v_accvgpr_read_b32 v19, a40
    v_mul_f32 v19, v19, v25
    v_accvgpr_write_b32 a40, v19
    v_accvgpr_read_b32 v19, a41
    v_mul_f32 v19, v19, v25
    v_accvgpr_write_b32 a41, v19
    v_accvgpr_read_b32 v19, a42
    v_mul_f32 v19, v19, v25
    v_accvgpr_write_b32 a42, v19
    v_accvgpr_read_b32 v19, a43
    v_mul_f32 v19, v19, v25
    v_accvgpr_write_b32 a43, v19
    v_accvgpr_read_b32 v19, a44
    v_mul_f32 v19, v19, v25
    v_accvgpr_write_b32 a44, v19
    v_accvgpr_read_b32 v19, a45
    v_mul_f32 v19, v19, v25
    v_accvgpr_write_b32 a45, v19
    v_accvgpr_read_b32 v19, a46
    v_mul_f32 v19, v19, v25
    v_accvgpr_write_b32 a46, v19
    v_accvgpr_read_b32 v19, a47
    v_mul_f32 v19, v19, v25
    v_accvgpr_write_b32 a47, v19
    v_fma_f32 v152, v152, s28, v11
    v_fma_f32 v153, v153, s28, v11
    v_exp_f32 v152, v152
    v_exp_f32 v153, v153
    s_nop 0
    v_cvt_pk_bf16_f32 v26, v152, v153
    v_fma_f32 v154, v154, s28, v11
    v_fma_f32 v155, v155, s28, v11
    v_exp_f32 v154, v154
    v_exp_f32 v155, v155
    s_nop 0
    v_cvt_pk_bf16_f32 v27, v154, v155
    v_fma_f32 v156, v156, s28, v11
    v_fma_f32 v157, v157, s28, v11
    v_exp_f32 v156, v156
    v_exp_f32 v157, v157
    s_nop 0
    v_cvt_pk_bf16_f32 v28, v156, v157
    v_fma_f32 v158, v158, s28, v11
    v_fma_f32 v159, v159, s28, v11
    v_exp_f32 v158, v158
    v_exp_f32 v159, v159
    s_nop 0
    v_cvt_pk_bf16_f32 v29, v158, v159
    s_add_u32 s69, s39, 0
    buffer_load_dwordx4 v[44:47], v30, s[4:7], s69 offen offset:0
    s_waitcnt vmcnt(0)
    v_mfma_f32_16x16x32_bf16 v[152:155], v[44:47], a[216:219], 0
    s_nop 7
    buffer_load_dwordx4 v[44:47], v30, s[4:7], s69 offen offset:64
    s_waitcnt vmcnt(0)
    v_mfma_f32_16x16x32_bf16 v[152:155], v[44:47], a[220:223], v[152:155]
    s_nop 7
    buffer_load_dwordx4 v[44:47], v30, s[4:7], s69 offen offset:128
    s_waitcnt vmcnt(0)
    v_mfma_f32_16x16x32_bf16 v[152:155], v[44:47], a[224:227], v[152:155]
    s_nop 7
    buffer_load_dwordx4 v[44:47], v30, s[4:7], s69 offen offset:192
    s_waitcnt vmcnt(0)
    v_mfma_f32_16x16x32_bf16 v[152:155], v[44:47], a[228:231], v[152:155]
    s_nop 7
    buffer_load_dwordx4 v[44:47], v30, s[4:7], s69 offen offset:256
    s_waitcnt vmcnt(0)
    v_mfma_f32_16x16x32_bf16 v[152:155], v[44:47], a[232:235], v[152:155]
    s_nop 7
    buffer_load_dwordx4 v[44:47], v30, s[4:7], s69 offen offset:320
    s_waitcnt vmcnt(0)
    v_mfma_f32_16x16x32_bf16 v[152:155], v[44:47], a[236:239], v[152:155]
    s_nop 7
    s_add_u32 s69, s39, 6144
    buffer_load_dwordx4 v[44:47], v30, s[4:7], s69 offen offset:0
    s_waitcnt vmcnt(0)
    v_mfma_f32_16x16x32_bf16 v[156:159], v[44:47], a[216:219], 0
    s_nop 7
    buffer_load_dwordx4 v[44:47], v30, s[4:7], s69 offen offset:64
    s_waitcnt vmcnt(0)
    v_mfma_f32_16x16x32_bf16 v[156:159], v[44:47], a[220:223], v[156:159]
    s_nop 7
    buffer_load_dwordx4 v[44:47], v30, s[4:7], s69 offen offset:128
    s_waitcnt vmcnt(0)
    v_mfma_f32_16x16x32_bf16 v[156:159], v[44:47], a[224:227], v[156:159]
    s_nop 7
    buffer_load_dwordx4 v[44:47], v30, s[4:7], s69 offen offset:192
    s_waitcnt vmcnt(0)
    v_mfma_f32_16x16x32_bf16 v[156:159], v[44:47], a[228:231], v[156:159]
    s_nop 7
    buffer_load_dwordx4 v[44:47], v30, s[4:7], s69 offen offset:256
    s_waitcnt vmcnt(0)
    v_mfma_f32_16x16x32_bf16 v[156:159], v[44:47], a[232:235], v[156:159]
    s_nop 7
    buffer_load_dwordx4 v[44:47], v30, s[4:7], s69 offen offset:320
    s_waitcnt vmcnt(0)
    v_mfma_f32_16x16x32_bf16 v[156:159], v[44:47], a[236:239], v[156:159]
    s_nop 7
    s_nop 15
    v_max3_f32 v18, v152, v153, v154
    v_max3_f32 v18, v18, v155, v156
    v_max3_f32 v18, v18, v157, v158
    v_max_f32 v18, v18, v159
    v_mov_b32 v19, v18
    s_nop 1
    v_permlane32_swap_b32 v19, v18
    v_max_f32 v18, v18, v19
    v_mov_b32 v19, v18
    s_nop 1
    v_permlane16_swap_b32 v19, v18
    v_max_f32 v18, v18, v19
    v_fma_f32 v18, v18, s28, v12
    v_max_f32 v24, 0, v18
    v_sub_f32 v12, v12, v24
    v_sub_f32 v25, 0, v24
    v_exp_f32 v25, v25
    s_nop 0
    v_mul_f32 v51, v51, v25
    v_accvgpr_read_b32 v19, a48
    v_mul_f32 v19, v19, v25
    v_accvgpr_write_b32 a48, v19
    v_accvgpr_read_b32 v19, a49
    v_mul_f32 v19, v19, v25
    v_accvgpr_write_b32 a49, v19
    v_accvgpr_read_b32 v19, a50
    v_mul_f32 v19, v19, v25
    v_accvgpr_write_b32 a50, v19
    v_accvgpr_read_b32 v19, a51
    v_mul_f32 v19, v19, v25
    v_accvgpr_write_b32 a51, v19
    v_accvgpr_read_b32 v19, a52
    v_mul_f32 v19, v19, v25
    v_accvgpr_write_b32 a52, v19
    v_accvgpr_read_b32 v19, a53
    v_mul_f32 v19, v19, v25
    v_accvgpr_write_b32 a53, v19
    v_accvgpr_read_b32 v19, a54
    v_mul_f32 v19, v19, v25
    v_accvgpr_write_b32 a54, v19
    v_accvgpr_read_b32 v19, a55
    v_mul_f32 v19, v19, v25
    v_accvgpr_write_b32 a55, v19
    v_accvgpr_read_b32 v19, a56
    v_mul_f32 v19, v19, v25
    v_accvgpr_write_b32 a56, v19
    v_accvgpr_read_b32 v19, a57
    v_mul_f32 v19, v19, v25
    v_accvgpr_write_b32 a57, v19
    v_accvgpr_read_b32 v19, a58
    v_mul_f32 v19, v19, v25
    v_accvgpr_write_b32 a58, v19
    v_accvgpr_read_b32 v19, a59
    v_mul_f32 v19, v19, v25
    v_accvgpr_write_b32 a59, v19
    v_accvgpr_read_b32 v19, a60
    v_mul_f32 v19, v19, v25
    v_accvgpr_write_b32 a60, v19
    v_accvgpr_read_b32 v19, a61
    v_mul_f32 v19, v19, v25
    v_accvgpr_write_b32 a61, v19
    v_accvgpr_read_b32 v19, a62
    v_mul_f32 v19, v19, v25
    v_accvgpr_write_b32 a62, v19
    v_accvgpr_read_b32 v19, a63
    v_mul_f32 v19, v19, v25
    v_accvgpr_write_b32 a63, v19
    v_accvgpr_read_b32 v19, a64
    v_mul_f32 v19, v19, v25
    v_accvgpr_write_b32 a64, v19
    v_accvgpr_read_b32 v19, a65
    v_mul_f32 v19, v19, v25
    v_accvgpr_write_b32 a65, v19
    v_accvgpr_read_b32 v19, a66
    v_mul_f32 v19, v19, v25
    v_accvgpr_write_b32 a66, v19
    v_accvgpr_read_b32 v19, a67
    v_mul_f32 v19, v19, v25
    v_accvgpr_write_b32 a67, v19
    v_accvgpr_read_b32 v19, a68
    v_mul_f32 v19, v19, v25
    v_accvgpr_write_b32 a68, v19
    v_accvgpr_read_b32 v19, a69
    v_mul_f32 v19, v19, v25
    v_accvgpr_write_b32 a69, v19
    v_accvgpr_read_b32 v19, a70
    v_mul_f32 v19, v19, v25
    v_accvgpr_write_b32 a70, v19
    v_accvgpr_read_b32 v19, a71
    v_mul_f32 v19, v19, v25
    v_accvgpr_write_b32 a71, v19
    v_accvgpr_read_b32 v19, a72
    v_mul_f32 v19, v19, v25
    v_accvgpr_write_b32 a72, v19
    v_accvgpr_read_b32 v19, a73
    v_mul_f32 v19, v19, v25
    v_accvgpr_write_b32 a73, v19
    v_accvgpr_read_b32 v19, a74
    v_mul_f32 v19, v19, v25
    v_accvgpr_write_b32 a74, v19
    v_accvgpr_read_b32 v19, a75
    v_mul_f32 v19, v19, v25
    v_accvgpr_write_b32 a75, v19
    v_accvgpr_read_b32 v19, a76
    v_mul_f32 v19, v19, v25
    v_accvgpr_write_b32 a76, v19
    v_accvgpr_read_b32 v19, a77
    v_mul_f32 v19, v19, v25
    v_accvgpr_write_b32 a77, v19
    v_accvgpr_read_b32 v19, a78
    v_mul_f32 v19, v19, v25
    v_accvgpr_write_b32 a78, v19
    v_accvgpr_read_b32 v19, a79
    v_mul_f32 v19, v19, v25
    v_accvgpr_write_b32 a79, v19
    v_accvgpr_read_b32 v19, a80
    v_mul_f32 v19, v19, v25
    v_accvgpr_write_b32 a80, v19
    v_accvgpr_read_b32 v19, a81
    v_mul_f32 v19, v19, v25
    v_accvgpr_write_b32 a81, v19
    v_accvgpr_read_b32 v19, a82
    v_mul_f32 v19, v19, v25
    v_accvgpr_write_b32 a82, v19
    v_accvgpr_read_b32 v19, a83
    v_mul_f32 v19, v19, v25
    v_accvgpr_write_b32 a83, v19
    v_accvgpr_read_b32 v19, a84
    v_mul_f32 v19, v19, v25
    v_accvgpr_write_b32 a84, v19
    v_accvgpr_read_b32 v19, a85
    v_mul_f32 v19, v19, v25
    v_accvgpr_write_b32 a85, v19
    v_accvgpr_read_b32 v19, a86
    v_mul_f32 v19, v19, v25
    v_accvgpr_write_b32 a86, v19
    v_accvgpr_read_b32 v19, a87
    v_mul_f32 v19, v19, v25
    v_accvgpr_write_b32 a87, v19
    v_accvgpr_read_b32 v19, a88
    v_mul_f32 v19, v19, v25
    v_accvgpr_write_b32 a88, v19
    v_accvgpr_read_b32 v19, a89
    v_mul_f32 v19, v19, v25
    v_accvgpr_write_b32 a89, v19
    v_accvgpr_read_b32 v19, a90
    v_mul_f32 v19, v19, v25
    v_accvgpr_write_b32 a90, v19
    v_accvgpr_read_b32 v19, a91
    v_mul_f32 v19, v19, v25
    v_accvgpr_write_b32 a91, v19
    v_accvgpr_read_b32 v19, a92
    v_mul_f32 v19, v19, v25
    v_accvgpr_write_b32 a92, v19
    v_accvgpr_read_b32 v19, a93
    v_mul_f32 v19, v19, v25
    v_accvgpr_write_b32 a93, v19
    v_accvgpr_read_b32 v19, a94
    v_mul_f32 v19, v19, v25
    v_accvgpr_write_b32 a94, v19
    v_accvgpr_read_b32 v19, a95
    v_mul_f32 v19, v19, v25
    v_accvgpr_write_b32 a95, v19
    v_fma_f32 v152, v152, s28, v12
    v_fma_f32 v153, v153, s28, v12
    v_exp_f32 v152, v152
    v_exp_f32 v153, v153
    s_nop 0
    v_cvt_pk_bf16_f32 v32, v152, v153
    v_fma_f32 v154, v154, s28, v12
    v_fma_f32 v155, v155, s28, v12
    v_exp_f32 v154, v154
    v_exp_f32 v155, v155
    s_nop 0
    v_cvt_pk_bf16_f32 v33, v154, v155
    v_fma_f32 v156, v156, s28, v12
    v_fma_f32 v157, v157, s28, v12
    v_exp_f32 v156, v156
    v_exp_f32 v157, v157
    s_nop 0
    v_cvt_pk_bf16_f32 v34, v156, v157
    v_fma_f32 v158, v158, s28, v12
    v_fma_f32 v159, v159, s28, v12
    v_exp_f32 v158, v158
    v_exp_f32 v159, v159
    s_nop 0
    v_cvt_pk_bf16_f32 v35, v158, v159
    s_add_u32 s69, s39, 0
    buffer_load_dwordx4 v[44:47], v30, s[4:7], s69 offen offset:0
    s_waitcnt vmcnt(0)
    v_mfma_f32_16x16x32_bf16 v[152:155], v[44:47], a[240:243], 0
    s_nop 7
    buffer_load_dwordx4 v[44:47], v30, s[4:7], s69 offen offset:64
    s_waitcnt vmcnt(0)
    v_mfma_f32_16x16x32_bf16 v[152:155], v[44:47], a[244:247], v[152:155]
    s_nop 7
    buffer_load_dwordx4 v[44:47], v30, s[4:7], s69 offen offset:128
    s_waitcnt vmcnt(0)
    v_mfma_f32_16x16x32_bf16 v[152:155], v[44:47], a[248:251], v[152:155]
    s_nop 7
    buffer_load_dwordx4 v[44:47], v30, s[4:7], s69 offen offset:192
    s_waitcnt vmcnt(0)
    v_mfma_f32_16x16x32_bf16 v[152:155], v[44:47], a[252:255], v[152:155]
    s_nop 7
    buffer_load_dwordx4 v[44:47], v30, s[4:7], s69 offen offset:256
    s_waitcnt vmcnt(0)
    v_mfma_f32_16x16x32_bf16 v[152:155], v[44:47], v[136:139], v[152:155]
    s_nop 7
    buffer_load_dwordx4 v[44:47], v30, s[4:7], s69 offen offset:320
    s_waitcnt vmcnt(0)
    v_mfma_f32_16x16x32_bf16 v[152:155], v[44:47], v[140:143], v[152:155]
    s_nop 7
    s_add_u32 s69, s39, 6144
    buffer_load_dwordx4 v[44:47], v30, s[4:7], s69 offen offset:0
    s_waitcnt vmcnt(0)
    v_mfma_f32_16x16x32_bf16 v[156:159], v[44:47], a[240:243], 0
    s_nop 7
    buffer_load_dwordx4 v[44:47], v30, s[4:7], s69 offen offset:64
    s_waitcnt vmcnt(0)
    v_mfma_f32_16x16x32_bf16 v[156:159], v[44:47], a[244:247], v[156:159]
    s_nop 7
    buffer_load_dwordx4 v[44:47], v30, s[4:7], s69 offen offset:128
    s_waitcnt vmcnt(0)
    v_mfma_f32_16x16x32_bf16 v[156:159], v[44:47], a[248:251], v[156:159]
    s_nop 7
    buffer_load_dwordx4 v[44:47], v30, s[4:7], s69 offen offset:192
    s_waitcnt vmcnt(0)
    v_mfma_f32_16x16x32_bf16 v[156:159], v[44:47], a[252:255], v[156:159]
    s_nop 7
    buffer_load_dwordx4 v[44:47], v30, s[4:7], s69 offen offset:256
    s_waitcnt vmcnt(0)
    v_mfma_f32_16x16x32_bf16 v[156:159], v[44:47], v[136:139], v[156:159]
    s_nop 7
    buffer_load_dwordx4 v[44:47], v30, s[4:7], s69 offen offset:320
    s_waitcnt vmcnt(0)
    v_mfma_f32_16x16x32_bf16 v[156:159], v[44:47], v[140:143], v[156:159]
    s_nop 7
    s_nop 15
    v_max3_f32 v18, v152, v153, v154
    v_max3_f32 v18, v18, v155, v156
    v_max3_f32 v18, v18, v157, v158
    v_max_f32 v18, v18, v159
    v_mov_b32 v19, v18
    s_nop 1
    v_permlane32_swap_b32 v19, v18
    v_max_f32 v18, v18, v19
    v_mov_b32 v19, v18
    s_nop 1
    v_permlane16_swap_b32 v19, v18
    v_max_f32 v18, v18, v19
    v_fma_f32 v18, v18, s28, v13
    v_max_f32 v24, 0, v18
    v_sub_f32 v13, v13, v24
    v_sub_f32 v25, 0, v24
    v_exp_f32 v25, v25
    s_nop 0
    v_mul_f32 v19, v48, v25
    v_cndmask_b32_e64 v48, v48, v19, s[60:61]
    v_accvgpr_read_b32 v19, a96
    v_mul_f32 v19, v19, v25
    v_accvgpr_write_b32 a96, v19
    v_accvgpr_read_b32 v19, a97
    v_mul_f32 v19, v19, v25
    v_accvgpr_write_b32 a97, v19
    v_accvgpr_read_b32 v19, a98
    v_mul_f32 v19, v19, v25
    v_accvgpr_write_b32 a98, v19
    v_accvgpr_read_b32 v19, a99
    v_mul_f32 v19, v19, v25
    v_accvgpr_write_b32 a99, v19
    v_accvgpr_read_b32 v19, a100
    v_mul_f32 v19, v19, v25
    v_accvgpr_write_b32 a100, v19
    v_accvgpr_read_b32 v19, a101
    v_mul_f32 v19, v19, v25
    v_accvgpr_write_b32 a101, v19
    v_accvgpr_read_b32 v19, a102
    v_mul_f32 v19, v19, v25
    v_accvgpr_write_b32 a102, v19
    v_accvgpr_read_b32 v19, a103
    v_mul_f32 v19, v19, v25
    v_accvgpr_write_b32 a103, v19
    v_accvgpr_read_b32 v19, a104
    v_mul_f32 v19, v19, v25
    v_accvgpr_write_b32 a104, v19
    v_accvgpr_read_b32 v19, a105
    v_mul_f32 v19, v19, v25
    v_accvgpr_write_b32 a105, v19
    v_accvgpr_read_b32 v19, a106
    v_mul_f32 v19, v19, v25
    v_accvgpr_write_b32 a106, v19
    v_accvgpr_read_b32 v19, a107
    v_mul_f32 v19, v19, v25
    v_accvgpr_write_b32 a107, v19
    v_accvgpr_read_b32 v19, a108
    v_mul_f32 v19, v19, v25
    v_accvgpr_write_b32 a108, v19
    v_accvgpr_read_b32 v19, a109
    v_mul_f32 v19, v19, v25
    v_accvgpr_write_b32 a109, v19
    v_accvgpr_read_b32 v19, a110
    v_mul_f32 v19, v19, v25
    v_accvgpr_write_b32 a110, v19
    v_accvgpr_read_b32 v19, a111
    v_mul_f32 v19, v19, v25
    v_accvgpr_write_b32 a111, v19
    v_accvgpr_read_b32 v19, a112
    v_mul_f32 v19, v19, v25
    v_accvgpr_write_b32 a112, v19
    v_accvgpr_read_b32 v19, a113
    v_mul_f32 v19, v19, v25
    v_accvgpr_write_b32 a113, v19
    v_accvgpr_read_b32 v19, a114
    v_mul_f32 v19, v19, v25
    v_accvgpr_write_b32 a114, v19
    v_accvgpr_read_b32 v19, a115
    v_mul_f32 v19, v19, v25
    v_accvgpr_write_b32 a115, v19
    v_accvgpr_read_b32 v19, a116
    v_mul_f32 v19, v19, v25
    v_accvgpr_write_b32 a116, v19
    v_accvgpr_read_b32 v19, a117
    v_mul_f32 v19, v19, v25
    v_accvgpr_write_b32 a117, v19
    v_accvgpr_read_b32 v19, a118
    v_mul_f32 v19, v19, v25
    v_accvgpr_write_b32 a118, v19
    v_accvgpr_read_b32 v19, a119
    v_mul_f32 v19, v19, v25
    v_accvgpr_write_b32 a119, v19
    v_accvgpr_read_b32 v19, a120
    v_mul_f32 v19, v19, v25
    v_accvgpr_write_b32 a120, v19
    v_accvgpr_read_b32 v19, a121
    v_mul_f32 v19, v19, v25
    v_accvgpr_write_b32 a121, v19
    v_accvgpr_read_b32 v19, a122
    v_mul_f32 v19, v19, v25
    v_accvgpr_write_b32 a122, v19
    v_accvgpr_read_b32 v19, a123
    v_mul_f32 v19, v19, v25
    v_accvgpr_write_b32 a123, v19
    v_accvgpr_read_b32 v19, a124
    v_mul_f32 v19, v19, v25
    v_accvgpr_write_b32 a124, v19
    v_accvgpr_read_b32 v19, a125
    v_mul_f32 v19, v19, v25
    v_accvgpr_write_b32 a125, v19
    v_accvgpr_read_b32 v19, a126
    v_mul_f32 v19, v19, v25
    v_accvgpr_write_b32 a126, v19
    v_accvgpr_read_b32 v19, a127
    v_mul_f32 v19, v19, v25
    v_accvgpr_write_b32 a127, v19
    v_accvgpr_read_b32 v19, a128
    v_mul_f32 v19, v19, v25
    v_accvgpr_write_b32 a128, v19
    v_accvgpr_read_b32 v19, a129
    v_mul_f32 v19, v19, v25
    v_accvgpr_write_b32 a129, v19
    v_accvgpr_read_b32 v19, a130
    v_mul_f32 v19, v19, v25
    v_accvgpr_write_b32 a130, v19
    v_accvgpr_read_b32 v19, a131
    v_mul_f32 v19, v19, v25
    v_accvgpr_write_b32 a131, v19
    v_accvgpr_read_b32 v19, a132
    v_mul_f32 v19, v19, v25
    v_accvgpr_write_b32 a132, v19
    v_accvgpr_read_b32 v19, a133
    v_mul_f32 v19, v19, v25
    v_accvgpr_write_b32 a133, v19
    v_accvgpr_read_b32 v19, a134
    v_mul_f32 v19, v19, v25
    v_accvgpr_write_b32 a134, v19
    v_accvgpr_read_b32 v19, a135
    v_mul_f32 v19, v19, v25
    v_accvgpr_write_b32 a135, v19
    v_accvgpr_read_b32 v19, a136
    v_mul_f32 v19, v19, v25
    v_accvgpr_write_b32 a136, v19
    v_accvgpr_read_b32 v19, a137
    v_mul_f32 v19, v19, v25
    v_accvgpr_write_b32 a137, v19
    v_accvgpr_read_b32 v19, a138
    v_mul_f32 v19, v19, v25
    v_accvgpr_write_b32 a138, v19
    v_accvgpr_read_b32 v19, a139
    v_mul_f32 v19, v19, v25
    v_accvgpr_write_b32 a139, v19
    v_accvgpr_read_b32 v19, a140
    v_mul_f32 v19, v19, v25
    v_accvgpr_write_b32 a140, v19
    v_accvgpr_read_b32 v19, a141
    v_mul_f32 v19, v19, v25
    v_accvgpr_write_b32 a141, v19
    v_accvgpr_read_b32 v19, a142
    v_mul_f32 v19, v19, v25
    v_accvgpr_write_b32 a142, v19
    v_accvgpr_read_b32 v19, a143
    v_mul_f32 v19, v19, v25
    v_accvgpr_write_b32 a143, v19
    v_fma_f32 v152, v152, s28, v13
    v_fma_f32 v153, v153, s28, v13
    v_exp_f32 v152, v152
    v_exp_f32 v153, v153
    s_nop 0
    v_cvt_pk_bf16_f32 v38, v152, v153
    v_fma_f32 v154, v154, s28, v13
    v_fma_f32 v155, v155, s28, v13
    v_exp_f32 v154, v154
    v_exp_f32 v155, v155
    s_nop 0
    v_cvt_pk_bf16_f32 v39, v154, v155
    v_fma_f32 v156, v156, s28, v13
    v_fma_f32 v157, v157, s28, v13
    v_exp_f32 v156, v156
    v_exp_f32 v157, v157
    s_nop 0
    v_cvt_pk_bf16_f32 v40, v156, v157
    v_fma_f32 v158, v158, s28, v13
    v_fma_f32 v159, v159, s28, v13
    v_exp_f32 v158, v158
    v_exp_f32 v159, v159
    s_nop 0
    v_cvt_pk_bf16_f32 v41, v158, v159
    v_mfma_f32_16x16x32_bf16 v[44:47], v[52:55], v[14:17], v[48:51]
    v_mfma_f32_16x16x32_bf16 v[44:47], v[56:59], v[20:23], v[44:47]
    v_mfma_f32_16x16x32_bf16 v[44:47], v[60:63], v[26:29], v[44:47]
    v_mfma_f32_16x16x32_bf16 v[44:47], v[64:67], v[32:35], v[44:47]
    v_mfma_f32_16x16x32_bf16 v[44:47], v[68:71], v[38:41], v[44:47]
    s_nop 15
    s_setpc_b64 s[40:41]
L_rare5_1:
    s_nop 15
    v_mbcnt_lo_u32_b32 v27, -1, 0
    v_mbcnt_hi_u32_b32 v27, -1, v27
    v_and_b32 v26, 15, v27
    v_mul_u32_u24 v26, 384, v26
    v_lshrrev_b32 v27, 4, v27
    v_lshl_add_u32 v26, v27, 4, v26
    s_add_u32 s69, s39, 0
    buffer_load_dwordx4 v[48:51], v26, s[4:7], s69 offen offset:0
    s_waitcnt vmcnt(0)
    v_mfma_f32_16x16x32_bf16 v[152:155], v[48:51], a[144:147], 0
    s_nop 7
    buffer_load_dwordx4 v[48:51], v26, s[4:7], s69 offen offset:64
    s_waitcnt vmcnt(0)
    v_mfma_f32_16x16x32_bf16 v[152:155], v[48:51], a[148:151], v[152:155]
    s_nop 7
    buffer_load_dwordx4 v[48:51], v26, s[4:7], s69 offen offset:128
    s_waitcnt vmcnt(0)
    v_mfma_f32_16x16x32_bf16 v[152:155], v[48:51], a[152:155], v[152:155]
    s_nop 7
    buffer_load_dwordx4 v[48:51], v26, s[4:7], s69 offen offset:192
    s_waitcnt vmcnt(0)
    v_mfma_f32_16x16x32_bf16 v[152:155], v[48:51], a[156:159], v[152:155]
    s_nop 7
    buffer_load_dwordx4 v[48:51], v26, s[4:7], s69 offen offset:256
    s_waitcnt vmcnt(0)
    v_mfma_f32_16x16x32_bf16 v[152:155], v[48:51], a[160:163], v[152:155]
    s_nop 7
    buffer_load_dwordx4 v[48:51], v26, s[4:7], s69 offen offset:320
    s_waitcnt vmcnt(0)
    v_mfma_f32_16x16x32_bf16 v[152:155], v[48:51], a[164:167], v[152:155]
    s_nop 7
    s_add_u32 s69, s39, 6144
    buffer_load_dwordx4 v[48:51], v26, s[4:7], s69 offen offset:0
    s_waitcnt vmcnt(0)
    v_mfma_f32_16x16x32_bf16 v[156:159], v[48:51], a[144:147], 0
    s_nop 7
    buffer_load_dwordx4 v[48:51], v26, s[4:7], s69 offen offset:64
    s_waitcnt vmcnt(0)
    v_mfma_f32_16x16x32_bf16 v[156:159], v[48:51], a[148:151], v[156:159]
    s_nop 7
    buffer_load_dwordx4 v[48:51], v26, s[4:7], s69 offen offset:128
    s_waitcnt vmcnt(0)
    v_mfma_f32_16x16x32_bf16 v[156:159], v[48:51], a[152:155], v[156:159]
    s_nop 7
    buffer_load_dwordx4 v[48:51], v26, s[4:7], s69 offen offset:192
    s_waitcnt vmcnt(0)
    v_mfma_f32_16x16x32_bf16 v[156:159], v[48:51], a[156:159], v[156:159]
    s_nop 7
    buffer_load_dwordx4 v[48:51], v26, s[4:7], s69 offen offset:256
    s_waitcnt vmcnt(0)
    v_mfma_f32_16x16x32_bf16 v[156:159], v[48:51], a[160:163], v[156:159]
    s_nop 7
    buffer_load_dwordx4 v[48:51], v26, s[4:7], s69 offen offset:320
    s_waitcnt vmcnt(0)
    v_mfma_f32_16x16x32_bf16 v[156:159], v[48:51], a[164:167], v[156:159]
    s_nop 7
    s_nop 15
    v_max3_f32 v14, v152, v153, v154
    v_max3_f32 v14, v14, v155, v156
    v_max3_f32 v14, v14, v157, v158
    v_max_f32 v14, v14, v159
    v_mov_b32 v15, v14
    s_nop 1
    v_permlane32_swap_b32 v15, v14
    v_max_f32 v14, v14, v15
    v_mov_b32 v15, v14
    s_nop 1
    v_permlane16_swap_b32 v15, v14
    v_max_f32 v14, v14, v15
    v_fma_f32 v14, v14, s28, v9
    v_max_f32 v20, 0, v14
    v_sub_f32 v9, v9, v20
    v_sub_f32 v21, 0, v20
    v_exp_f32 v21, v21
    s_nop 0
    v_mul_f32 v15, v44, v21
    v_cndmask_b32_e64 v44, v15, v44, s[60:61]
    v_cndmask_b32_e64 v44, v44, 0, s[46:47]
    v_mul_f32 v160, v160, v21
    v_mul_f32 v161, v161, v21
    v_mul_f32 v162, v162, v21
    v_mul_f32 v163, v163, v21
    v_mul_f32 v164, v164, v21
    v_mul_f32 v165, v165, v21
    v_mul_f32 v166, v166, v21
    v_mul_f32 v167, v167, v21
    v_mul_f32 v168, v168, v21
    v_mul_f32 v169, v169, v21
    v_mul_f32 v170, v170, v21
    v_mul_f32 v171, v171, v21
    v_mul_f32 v172, v172, v21
    v_mul_f32 v173, v173, v21
    v_mul_f32 v174, v174, v21
    v_mul_f32 v175, v175, v21
    v_mul_f32 v176, v176, v21
    v_mul_f32 v177, v177, v21
    v_mul_f32 v178, v178, v21
    v_mul_f32 v179, v179, v21
    v_mul_f32 v180, v180, v21
    v_mul_f32 v181, v181, v21
    v_mul_f32 v182, v182, v21
    v_mul_f32 v183, v183, v21
    v_mul_f32 v184, v184, v21
    v_mul_f32 v185, v185, v21
    v_mul_f32 v186, v186, v21
    v_mul_f32 v187, v187, v21
    v_mul_f32 v188, v188, v21
    v_mul_f32 v189, v189, v21
    v_mul_f32 v190, v190, v21
    v_mul_f32 v191, v191, v21
    v_mul_f32 v192, v192, v21
    v_mul_f32 v193, v193, v21
    v_mul_f32 v194, v194, v21
    v_mul_f32 v195, v195, v21
    v_mul_f32 v196, v196, v21
    v_mul_f32 v197, v197, v21
    v_mul_f32 v198, v198, v21
    v_mul_f32 v199, v199, v21
    v_mul_f32 v200, v200, v21
    v_mul_f32 v201, v201, v21
    v_mul_f32 v202, v202, v21
    v_mul_f32 v203, v203, v21
    v_mul_f32 v204, v204, v21
    v_mul_f32 v205, v205, v21
    v_mul_f32 v206, v206, v21
    v_mul_f32 v207, v207, v21
    v_fma_f32 v152, v152, s28, v9
    v_fma_f32 v153, v153, s28, v9
    v_exp_f32 v152, v152
    v_exp_f32 v153, v153
    s_nop 0
    v_cvt_pk_bf16_f32 v18, v152, v153
    v_fma_f32 v154, v154, s28, v9
    v_fma_f32 v155, v155, s28, v9
    v_exp_f32 v154, v154
    v_exp_f32 v155, v155
    s_nop 0
    v_cvt_pk_bf16_f32 v19, v154, v155
    v_fma_f32 v156, v156, s28, v9
    v_fma_f32 v157, v157, s28, v9
    v_exp_f32 v156, v156
    v_exp_f32 v157, v157
    s_nop 0
    v_cvt_pk_bf16_f32 v16, v156, v157
    v_fma_f32 v158, v158, s28, v9
    v_fma_f32 v159, v159, s28, v9
    v_exp_f32 v158, v158
    v_exp_f32 v159, v159
    s_nop 0
    v_cvt_pk_bf16_f32 v17, v158, v159
    s_add_u32 s69, s39, 0
    buffer_load_dwordx4 v[48:51], v26, s[4:7], s69 offen offset:0
    s_waitcnt vmcnt(0)
    v_mfma_f32_16x16x32_bf16 v[152:155], v[48:51], a[168:171], 0
    s_nop 7
    buffer_load_dwordx4 v[48:51], v26, s[4:7], s69 offen offset:64
    s_waitcnt vmcnt(0)
    v_mfma_f32_16x16x32_bf16 v[152:155], v[48:51], a[172:175], v[152:155]
    s_nop 7
    buffer_load_dwordx4 v[48:51], v26, s[4:7], s69 offen offset:128
    s_waitcnt vmcnt(0)
    v_mfma_f32_16x16x32_bf16 v[152:155], v[48:51], a[176:179], v[152:155]
    s_nop 7
    buffer_load_dwordx4 v[48:51], v26, s[4:7], s69 offen offset:192
    s_waitcnt vmcnt(0)
    v_mfma_f32_16x16x32_bf16 v[152:155], v[48:51], a[180:183], v[152:155]
    s_nop 7
    buffer_load_dwordx4 v[48:51], v26, s[4:7], s69 offen offset:256
    s_waitcnt vmcnt(0)
    v_mfma_f32_16x16x32_bf16 v[152:155], v[48:51], a[184:187], v[152:155]
    s_nop 7
    buffer_load_dwordx4 v[48:51], v26, s[4:7], s69 offen offset:320
    s_waitcnt vmcnt(0)
    v_mfma_f32_16x16x32_bf16 v[152:155], v[48:51], a[188:191], v[152:155]
    s_nop 7
    s_add_u32 s69, s39, 6144
    buffer_load_dwordx4 v[48:51], v26, s[4:7], s69 offen offset:0
    s_waitcnt vmcnt(0)
    v_mfma_f32_16x16x32_bf16 v[156:159], v[48:51], a[168:171], 0
    s_nop 7
    buffer_load_dwordx4 v[48:51], v26, s[4:7], s69 offen offset:64
    s_waitcnt vmcnt(0)
    v_mfma_f32_16x16x32_bf16 v[156:159], v[48:51], a[172:175], v[156:159]
    s_nop 7
    buffer_load_dwordx4 v[48:51], v26, s[4:7], s69 offen offset:128
    s_waitcnt vmcnt(0)
    v_mfma_f32_16x16x32_bf16 v[156:159], v[48:51], a[176:179], v[156:159]
    s_nop 7
    buffer_load_dwordx4 v[48:51], v26, s[4:7], s69 offen offset:192
    s_waitcnt vmcnt(0)
    v_mfma_f32_16x16x32_bf16 v[156:159], v[48:51], a[180:183], v[156:159]
    s_nop 7
    buffer_load_dwordx4 v[48:51], v26, s[4:7], s69 offen offset:256
    s_waitcnt vmcnt(0)
    v_mfma_f32_16x16x32_bf16 v[156:159], v[48:51], a[184:187], v[156:159]
    s_nop 7
    buffer_load_dwordx4 v[48:51], v26, s[4:7], s69 offen offset:320
    s_waitcnt vmcnt(0)
    v_mfma_f32_16x16x32_bf16 v[156:159], v[48:51], a[188:191], v[156:159]
    s_nop 7
    s_nop 15
    v_max3_f32 v14, v152, v153, v154
    v_max3_f32 v14, v14, v155, v156
    v_max3_f32 v14, v14, v157, v158
    v_max_f32 v14, v14, v159
    v_mov_b32 v15, v14
    s_nop 1
    v_permlane32_swap_b32 v15, v14
    v_max_f32 v14, v14, v15
    v_mov_b32 v15, v14
    s_nop 1
    v_permlane16_swap_b32 v15, v14
    v_max_f32 v14, v14, v15
    v_fma_f32 v14, v14, s28, v10
    v_max_f32 v20, 0, v14
    v_sub_f32 v10, v10, v20
    v_sub_f32 v21, 0, v20
    v_exp_f32 v21, v21
    s_nop 0
    v_mul_f32 v45, v45, v21
    v_mul_f32 v208, v208, v21
    v_mul_f32 v209, v209, v21
    v_mul_f32 v210, v210, v21
    v_mul_f32 v211, v211, v21
    v_mul_f32 v212, v212, v21
    v_mul_f32 v213, v213, v21
    v_mul_f32 v214, v214, v21
    v_mul_f32 v215, v215, v21
    v_mul_f32 v216, v216, v21
    v_mul_f32 v217, v217, v21
    v_mul_f32 v218, v218, v21
    v_mul_f32 v219, v219, v21
    v_mul_f32 v220, v220, v21
    v_mul_f32 v221, v221, v21
    v_mul_f32 v222, v222, v21
    v_mul_f32 v223, v223, v21
    v_mul_f32 v224, v224, v21
    v_mul_f32 v225, v225, v21
    v_mul_f32 v226, v226, v21
    v_mul_f32 v227, v227, v21
    v_mul_f32 v228, v228, v21
    v_mul_f32 v229, v229, v21
    v_mul_f32 v230, v230, v21
    v_mul_f32 v231, v231, v21
    v_mul_f32 v232, v232, v21
    v_mul_f32 v233, v233, v21
    v_mul_f32 v234, v234, v21
    v_mul_f32 v235, v235, v21
    v_mul_f32 v236, v236, v21
    v_mul_f32 v237, v237, v21
    v_mul_f32 v238, v238, v21
    v_mul_f32 v239, v239, v21
    v_mul_f32 v240, v240, v21
    v_mul_f32 v241, v241, v21
    v_mul_f32 v242, v242, v21
    v_mul_f32 v243, v243, v21
    v_mul_f32 v244, v244, v21
    v_mul_f32 v245, v245, v21
    v_mul_f32 v246, v246, v21
    v_mul_f32 v247, v247, v21
    v_mul_f32 v248, v248, v21
    v_mul_f32 v249, v249, v21
    v_mul_f32 v250, v250, v21
    v_mul_f32 v251, v251, v21
    v_mul_f32 v252, v252, v21
    v_mul_f32 v253, v253, v21
    v_mul_f32 v254, v254, v21
    v_mul_f32 v255, v255, v21
    v_fma_f32 v152, v152, s28, v10
    v_fma_f32 v153, v153, s28, v10
    v_exp_f32 v152, v152
    v_exp_f32 v153, v153
    s_nop 0
    v_cvt_pk_bf16_f32 v24, v152, v153
    v_fma_f32 v154, v154, s28, v10
    v_fma_f32 v155, v155, s28, v10
    v_exp_f32 v154, v154
    v_exp_f32 v155, v155
    s_nop 0
    v_cvt_pk_bf16_f32 v25, v154, v155
    v_fma_f32 v156, v156, s28, v10
    v_fma_f32 v157, v157, s28, v10
    v_exp_f32 v156, v156
    v_exp_f32 v157, v157
    s_nop 0
    v_cvt_pk_bf16_f32 v22, v156, v157
    v_fma_f32 v158, v158, s28, v10
    v_fma_f32 v159, v159, s28, v10
    v_exp_f32 v158, v158
    v_exp_f32 v159, v159
    s_nop 0
    v_cvt_pk_bf16_f32 v23, v158, v159
    s_add_u32 s69, s39, 0
    buffer_load_dwordx4 v[48:51], v26, s[4:7], s69 offen offset:0
    s_waitcnt vmcnt(0)
    v_mfma_f32_16x16x32_bf16 v[152:155], v[48:51], a[192:195], 0
    s_nop 7
    buffer_load_dwordx4 v[48:51], v26, s[4:7], s69 offen offset:64
    s_waitcnt vmcnt(0)
    v_mfma_f32_16x16x32_bf16 v[152:155], v[48:51], a[196:199], v[152:155]
    s_nop 7
    buffer_load_dwordx4 v[48:51], v26, s[4:7], s69 offen offset:128
    s_waitcnt vmcnt(0)
    v_mfma_f32_16x16x32_bf16 v[152:155], v[48:51], a[200:203], v[152:155]
    s_nop 7
    buffer_load_dwordx4 v[48:51], v26, s[4:7], s69 offen offset:192
    s_waitcnt vmcnt(0)
    v_mfma_f32_16x16x32_bf16 v[152:155], v[48:51], a[204:207], v[152:155]
    s_nop 7
    buffer_load_dwordx4 v[48:51], v26, s[4:7], s69 offen offset:256
    s_waitcnt vmcnt(0)
    v_mfma_f32_16x16x32_bf16 v[152:155], v[48:51], a[208:211], v[152:155]
    s_nop 7
    buffer_load_dwordx4 v[48:51], v26, s[4:7], s69 offen offset:320
    s_waitcnt vmcnt(0)
    v_mfma_f32_16x16x32_bf16 v[152:155], v[48:51], a[212:215], v[152:155]
    s_nop 7
    s_add_u32 s69, s39, 6144
    buffer_load_dwordx4 v[48:51], v26, s[4:7], s69 offen offset:0
    s_waitcnt vmcnt(0)
    v_mfma_f32_16x16x32_bf16 v[156:159], v[48:51], a[192:195], 0
    s_nop 7
    buffer_load_dwordx4 v[48:51], v26, s[4:7], s69 offen offset:64
    s_waitcnt vmcnt(0)
    v_mfma_f32_16x16x32_bf16 v[156:159], v[48:51], a[196:199], v[156:159]
    s_nop 7
    buffer_load_dwordx4 v[48:51], v26, s[4:7], s69 offen offset:128
    s_waitcnt vmcnt(0)
    v_mfma_f32_16x16x32_bf16 v[156:159], v[48:51], a[200:203], v[156:159]
    s_nop 7
    buffer_load_dwordx4 v[48:51], v26, s[4:7], s69 offen offset:192
    s_waitcnt vmcnt(0)
    v_mfma_f32_16x16x32_bf16 v[156:159], v[48:51], a[204:207], v[156:159]
    s_nop 7
    buffer_load_dwordx4 v[48:51], v26, s[4:7], s69 offen offset:256
    s_waitcnt vmcnt(0)
    v_mfma_f32_16x16x32_bf16 v[156:159], v[48:51], a[208:211], v[156:159]
    s_nop 7
    buffer_load_dwordx4 v[48:51], v26, s[4:7], s69 offen offset:320
    s_waitcnt vmcnt(0)
    v_mfma_f32_16x16x32_bf16 v[156:159], v[48:51], a[212:215], v[156:159]
    s_nop 7
    s_nop 15
    v_max3_f32 v14, v152, v153, v154
    v_max3_f32 v14, v14, v155, v156
    v_max3_f32 v14, v14, v157, v158
    v_max_f32 v14, v14, v159
    v_mov_b32 v15, v14
    s_nop 1
    v_permlane32_swap_b32 v15, v14
    v_max_f32 v14, v14, v15
    v_mov_b32 v15, v14
    s_nop 1
    v_permlane16_swap_b32 v15, v14
    v_max_f32 v14, v14, v15
    v_fma_f32 v14, v14, s28, v11
    v_max_f32 v20, 0, v14
    v_sub_f32 v11, v11, v20
    v_sub_f32 v21, 0, v20
    v_exp_f32 v21, v21
    s_nop 0
    v_mul_f32 v46, v46, v21
    v_accvgpr_read_b32 v15, a0
    v_mul_f32 v15, v15, v21
    v_accvgpr_write_b32 a0, v15
    v_accvgpr_read_b32 v15, a1
    v_mul_f32 v15, v15, v21
    v_accvgpr_write_b32 a1, v15
    v_accvgpr_read_b32 v15, a2
    v_mul_f32 v15, v15, v21
    v_accvgpr_write_b32 a2, v15
    v_accvgpr_read_b32 v15, a3
    v_mul_f32 v15, v15, v21
    v_accvgpr_write_b32 a3, v15
    v_accvgpr_read_b32 v15, a4
    v_mul_f32 v15, v15, v21
    v_accvgpr_write_b32 a4, v15
    v_accvgpr_read_b32 v15, a5
    v_mul_f32 v15, v15, v21
    v_accvgpr_write_b32 a5, v15
    v_accvgpr_read_b32 v15, a6
    v_mul_f32 v15, v15, v21
    v_accvgpr_write_b32 a6, v15
    v_accvgpr_read_b32 v15, a7
    v_mul_f32 v15, v15, v21
    v_accvgpr_write_b32 a7, v15
    v_accvgpr_read_b32 v15, a8
    v_mul_f32 v15, v15, v21
    v_accvgpr_write_b32 a8, v15
    v_accvgpr_read_b32 v15, a9
    v_mul_f32 v15, v15, v21
    v_accvgpr_write_b32 a9, v15
    v_accvgpr_read_b32 v15, a10
    v_mul_f32 v15, v15, v21
    v_accvgpr_write_b32 a10, v15
    v_accvgpr_read_b32 v15, a11
    v_mul_f32 v15, v15, v21
    v_accvgpr_write_b32 a11, v15
    v_accvgpr_read_b32 v15, a12
    v_mul_f32 v15, v15, v21
    v_accvgpr_write_b32 a12, v15
    v_accvgpr_read_b32 v15, a13
    v_mul_f32 v15, v15, v21
    v_accvgpr_write_b32 a13, v15
    v_accvgpr_read_b32 v15, a14
    v_mul_f32 v15, v15, v21
    v_accvgpr_write_b32 a14, v15
    v_accvgpr_read_b32 v15, a15
    v_mul_f32 v15, v15, v21
    v_accvgpr_write_b32 a15, v15
    v_accvgpr_read_b32 v15, a16
    v_mul_f32 v15, v15, v21
    v_accvgpr_write_b32 a16, v15
    v_accvgpr_read_b32 v15, a17
    v_mul_f32 v15, v15, v21
    v_accvgpr_write_b32 a17, v15
    v_accvgpr_read_b32 v15, a18
    v_mul_f32 v15, v15, v21
    v_accvgpr_write_b32 a18, v15
    v_accvgpr_read_b32 v15, a19
    v_mul_f32 v15, v15, v21
    v_accvgpr_write_b32 a19, v15
    v_accvgpr_read_b32 v15, a20
    v_mul_f32 v15, v15, v21
    v_accvgpr_write_b32 a20, v15
    v_accvgpr_read_b32 v15, a21
    v_mul_f32 v15, v15, v21
    v_accvgpr_write_b32 a21, v15
    v_accvgpr_read_b32 v15, a22
    v_mul_f32 v15, v15, v21
    v_accvgpr_write_b32 a22, v15
    v_accvgpr_read_b32 v15, a23
    v_mul_f32 v15, v15, v21
    v_accvgpr_write_b32 a23, v15
    v_accvgpr_read_b32 v15, a24
    v_mul_f32 v15, v15, v21
    v_accvgpr_write_b32 a24, v15
    v_accvgpr_read_b32 v15, a25
    v_mul_f32 v15, v15, v21
    v_accvgpr_write_b32 a25, v15
    v_accvgpr_read_b32 v15, a26
    v_mul_f32 v15, v15, v21
    v_accvgpr_write_b32 a26, v15
    v_accvgpr_read_b32 v15, a27
    v_mul_f32 v15, v15, v21
    v_accvgpr_write_b32 a27, v15
    v_accvgpr_read_b32 v15, a28
    v_mul_f32 v15, v15, v21
    v_accvgpr_write_b32 a28, v15
    v_accvgpr_read_b32 v15, a29
    v_mul_f32 v15, v15, v21
    v_accvgpr_write_b32 a29, v15
    v_accvgpr_read_b32 v15, a30
    v_mul_f32 v15, v15, v21
    v_accvgpr_write_b32 a30, v15
    v_accvgpr_read_b32 v15, a31
    v_mul_f32 v15, v15, v21
    v_accvgpr_write_b32 a31, v15
    v_accvgpr_read_b32 v15, a32
    v_mul_f32 v15, v15, v21
    v_accvgpr_write_b32 a32, v15
    v_accvgpr_read_b32 v15, a33
    v_mul_f32 v15, v15, v21
    v_accvgpr_write_b32 a33, v15
    v_accvgpr_read_b32 v15, a34
    v_mul_f32 v15, v15, v21
    v_accvgpr_write_b32 a34, v15
    v_accvgpr_read_b32 v15, a35
    v_mul_f32 v15, v15, v21
    v_accvgpr_write_b32 a35, v15
    v_accvgpr_read_b32 v15, a36
    v_mul_f32 v15, v15, v21
    v_accvgpr_write_b32 a36, v15
    v_accvgpr_read_b32 v15, a37
    v_mul_f32 v15, v15, v21
    v_accvgpr_write_b32 a37, v15
    v_accvgpr_read_b32 v15, a38
    v_mul_f32 v15, v15, v21
    v_accvgpr_write_b32 a38, v15
    v_accvgpr_read_b32 v15, a39
    v_mul_f32 v15, v15, v21
    v_accvgpr_write_b32 a39, v15
    v_accvgpr_read_b32 v15, a40
    v_mul_f32 v15, v15, v21
    v_accvgpr_write_b32 a40, v15
    v_accvgpr_read_b32 v15, a41
    v_mul_f32 v15, v15, v21
    v_accvgpr_write_b32 a41, v15
    v_accvgpr_read_b32 v15, a42
    v_mul_f32 v15, v15, v21
    v_accvgpr_write_b32 a42, v15
    v_accvgpr_read_b32 v15, a43
    v_mul_f32 v15, v15, v21
    v_accvgpr_write_b32 a43, v15
    v_accvgpr_read_b32 v15, a44
    v_mul_f32 v15, v15, v21
    v_accvgpr_write_b32 a44, v15
    v_accvgpr_read_b32 v15, a45
    v_mul_f32 v15, v15, v21
    v_accvgpr_write_b32 a45, v15
    v_accvgpr_read_b32 v15, a46
    v_mul_f32 v15, v15, v21
    v_accvgpr_write_b32 a46, v15
    v_accvgpr_read_b32 v15, a47
    v_mul_f32 v15, v15, v21
    v_accvgpr_write_b32 a47, v15
    v_fma_f32 v152, v152, s28, v11
    v_fma_f32 v153, v153, s28, v11
    v_exp_f32 v152, v152
    v_exp_f32 v153, v153
    s_nop 0
    v_cvt_pk_bf16_f32 v30, v152, v153
    v_fma_f32 v154, v154, s28, v11
    v_fma_f32 v155, v155, s28, v11
    v_exp_f32 v154, v154
    v_exp_f32 v155, v155
    s_nop 0
    v_cvt_pk_bf16_f32 v31, v154, v155
    v_fma_f32 v156, v156, s28, v11
    v_fma_f32 v157, v157, s28, v11
    v_exp_f32 v156, v156
    v_exp_f32 v157, v157
    s_nop 0
    v_cvt_pk_bf16_f32 v28, v156, v157
    v_fma_f32 v158, v158, s28, v11
    v_fma_f32 v159, v159, s28, v11
    v_exp_f32 v158, v158
    v_exp_f32 v159, v159
    s_nop 0
    v_cvt_pk_bf16_f32 v29, v158, v159
    s_add_u32 s69, s39, 0
    buffer_load_dwordx4 v[48:51], v26, s[4:7], s69 offen offset:0
    s_waitcnt vmcnt(0)
    v_mfma_f32_16x16x32_bf16 v[152:155], v[48:51], a[216:219], 0
    s_nop 7
    buffer_load_dwordx4 v[48:51], v26, s[4:7], s69 offen offset:64
    s_waitcnt vmcnt(0)
    v_mfma_f32_16x16x32_bf16 v[152:155], v[48:51], a[220:223], v[152:155]
    s_nop 7
    buffer_load_dwordx4 v[48:51], v26, s[4:7], s69 offen offset:128
    s_waitcnt vmcnt(0)
    v_mfma_f32_16x16x32_bf16 v[152:155], v[48:51], a[224:227], v[152:155]
    s_nop 7
    buffer_load_dwordx4 v[48:51], v26, s[4:7], s69 offen offset:192
    s_waitcnt vmcnt(0)
    v_mfma_f32_16x16x32_bf16 v[152:155], v[48:51], a[228:231], v[152:155]
    s_nop 7
    buffer_load_dwordx4 v[48:51], v26, s[4:7], s69 offen offset:256
    s_waitcnt vmcnt(0)
    v_mfma_f32_16x16x32_bf16 v[152:155], v[48:51], a[232:235], v[152:155]
    s_nop 7
    buffer_load_dwordx4 v[48:51], v26, s[4:7], s69 offen offset:320
    s_waitcnt vmcnt(0)
    v_mfma_f32_16x16x32_bf16 v[152:155], v[48:51], a[236:239], v[152:155]
    s_nop 7
    s_add_u32 s69, s39, 6144
    buffer_load_dwordx4 v[48:51], v26, s[4:7], s69 offen offset:0
    s_waitcnt vmcnt(0)
    v_mfma_f32_16x16x32_bf16 v[156:159], v[48:51], a[216:219], 0
    s_nop 7
    buffer_load_dwordx4 v[48:51], v26, s[4:7], s69 offen offset:64
    s_waitcnt vmcnt(0)
    v_mfma_f32_16x16x32_bf16 v[156:159], v[48:51], a[220:223], v[156:159]
    s_nop 7
    buffer_load_dwordx4 v[48:51], v26, s[4:7], s69 offen offset:128
    s_waitcnt vmcnt(0)
    v_mfma_f32_16x16x32_bf16 v[156:159], v[48:51], a[224:227], v[156:159]
    s_nop 7
    buffer_load_dwordx4 v[48:51], v26, s[4:7], s69 offen offset:192
    s_waitcnt vmcnt(0)
    v_mfma_f32_16x16x32_bf16 v[156:159], v[48:51], a[228:231], v[156:159]
    s_nop 7
    buffer_load_dwordx4 v[48:51], v26, s[4:7], s69 offen offset:256
    s_waitcnt vmcnt(0)
    v_mfma_f32_16x16x32_bf16 v[156:159], v[48:51], a[232:235], v[156:159]
    s_nop 7
    buffer_load_dwordx4 v[48:51], v26, s[4:7], s69 offen offset:320
    s_waitcnt vmcnt(0)
    v_mfma_f32_16x16x32_bf16 v[156:159], v[48:51], a[236:239], v[156:159]
    s_nop 7
    s_nop 15
    v_max3_f32 v14, v152, v153, v154
    v_max3_f32 v14, v14, v155, v156
    v_max3_f32 v14, v14, v157, v158
    v_max_f32 v14, v14, v159
    v_mov_b32 v15, v14
    s_nop 1
    v_permlane32_swap_b32 v15, v14
    v_max_f32 v14, v14, v15
    v_mov_b32 v15, v14
    s_nop 1
    v_permlane16_swap_b32 v15, v14
    v_max_f32 v14, v14, v15
    v_fma_f32 v14, v14, s28, v12
    v_max_f32 v20, 0, v14
    v_sub_f32 v12, v12, v20
    v_sub_f32 v21, 0, v20
    v_exp_f32 v21, v21
    s_nop 0
    v_mul_f32 v47, v47, v21
    v_accvgpr_read_b32 v15, a48
    v_mul_f32 v15, v15, v21
    v_accvgpr_write_b32 a48, v15
    v_accvgpr_read_b32 v15, a49
    v_mul_f32 v15, v15, v21
    v_accvgpr_write_b32 a49, v15
    v_accvgpr_read_b32 v15, a50
    v_mul_f32 v15, v15, v21
    v_accvgpr_write_b32 a50, v15
    v_accvgpr_read_b32 v15, a51
    v_mul_f32 v15, v15, v21
    v_accvgpr_write_b32 a51, v15
    v_accvgpr_read_b32 v15, a52
    v_mul_f32 v15, v15, v21
    v_accvgpr_write_b32 a52, v15
    v_accvgpr_read_b32 v15, a53
    v_mul_f32 v15, v15, v21
    v_accvgpr_write_b32 a53, v15
    v_accvgpr_read_b32 v15, a54
    v_mul_f32 v15, v15, v21
    v_accvgpr_write_b32 a54, v15
    v_accvgpr_read_b32 v15, a55
    v_mul_f32 v15, v15, v21
    v_accvgpr_write_b32 a55, v15
    v_accvgpr_read_b32 v15, a56
    v_mul_f32 v15, v15, v21
    v_accvgpr_write_b32 a56, v15
    v_accvgpr_read_b32 v15, a57
    v_mul_f32 v15, v15, v21
    v_accvgpr_write_b32 a57, v15
    v_accvgpr_read_b32 v15, a58
    v_mul_f32 v15, v15, v21
    v_accvgpr_write_b32 a58, v15
    v_accvgpr_read_b32 v15, a59
    v_mul_f32 v15, v15, v21
    v_accvgpr_write_b32 a59, v15
    v_accvgpr_read_b32 v15, a60
    v_mul_f32 v15, v15, v21
    v_accvgpr_write_b32 a60, v15
    v_accvgpr_read_b32 v15, a61
    v_mul_f32 v15, v15, v21
    v_accvgpr_write_b32 a61, v15
    v_accvgpr_read_b32 v15, a62
    v_mul_f32 v15, v15, v21
    v_accvgpr_write_b32 a62, v15
    v_accvgpr_read_b32 v15, a63
    v_mul_f32 v15, v15, v21
    v_accvgpr_write_b32 a63, v15
    v_accvgpr_read_b32 v15, a64
    v_mul_f32 v15, v15, v21
    v_accvgpr_write_b32 a64, v15
    v_accvgpr_read_b32 v15, a65
    v_mul_f32 v15, v15, v21
    v_accvgpr_write_b32 a65, v15
    v_accvgpr_read_b32 v15, a66
    v_mul_f32 v15, v15, v21
    v_accvgpr_write_b32 a66, v15
    v_accvgpr_read_b32 v15, a67
    v_mul_f32 v15, v15, v21
    v_accvgpr_write_b32 a67, v15
    v_accvgpr_read_b32 v15, a68
    v_mul_f32 v15, v15, v21
    v_accvgpr_write_b32 a68, v15
    v_accvgpr_read_b32 v15, a69
    v_mul_f32 v15, v15, v21
    v_accvgpr_write_b32 a69, v15
    v_accvgpr_read_b32 v15, a70
    v_mul_f32 v15, v15, v21
    v_accvgpr_write_b32 a70, v15
    v_accvgpr_read_b32 v15, a71
    v_mul_f32 v15, v15, v21
    v_accvgpr_write_b32 a71, v15
    v_accvgpr_read_b32 v15, a72
    v_mul_f32 v15, v15, v21
    v_accvgpr_write_b32 a72, v15
    v_accvgpr_read_b32 v15, a73
    v_mul_f32 v15, v15, v21
    v_accvgpr_write_b32 a73, v15
    v_accvgpr_read_b32 v15, a74
    v_mul_f32 v15, v15, v21
    v_accvgpr_write_b32 a74, v15
    v_accvgpr_read_b32 v15, a75
    v_mul_f32 v15, v15, v21
    v_accvgpr_write_b32 a75, v15
    v_accvgpr_read_b32 v15, a76
    v_mul_f32 v15, v15, v21
    v_accvgpr_write_b32 a76, v15
    v_accvgpr_read_b32 v15, a77
    v_mul_f32 v15, v15, v21
    v_accvgpr_write_b32 a77, v15
    v_accvgpr_read_b32 v15, a78
    v_mul_f32 v15, v15, v21
    v_accvgpr_write_b32 a78, v15
    v_accvgpr_read_b32 v15, a79
    v_mul_f32 v15, v15, v21
    v_accvgpr_write_b32 a79, v15
    v_accvgpr_read_b32 v15, a80
    v_mul_f32 v15, v15, v21
    v_accvgpr_write_b32 a80, v15
    v_accvgpr_read_b32 v15, a81
    v_mul_f32 v15, v15, v21
    v_accvgpr_write_b32 a81, v15
    v_accvgpr_read_b32 v15, a82
    v_mul_f32 v15, v15, v21
    v_accvgpr_write_b32 a82, v15
    v_accvgpr_read_b32 v15, a83
    v_mul_f32 v15, v15, v21
    v_accvgpr_write_b32 a83, v15
    v_accvgpr_read_b32 v15, a84
    v_mul_f32 v15, v15, v21
    v_accvgpr_write_b32 a84, v15
    v_accvgpr_read_b32 v15, a85
    v_mul_f32 v15, v15, v21
    v_accvgpr_write_b32 a85, v15
    v_accvgpr_read_b32 v15, a86
    v_mul_f32 v15, v15, v21
    v_accvgpr_write_b32 a86, v15
    v_accvgpr_read_b32 v15, a87
    v_mul_f32 v15, v15, v21
    v_accvgpr_write_b32 a87, v15
    v_accvgpr_read_b32 v15, a88
    v_mul_f32 v15, v15, v21
    v_accvgpr_write_b32 a88, v15
    v_accvgpr_read_b32 v15, a89
    v_mul_f32 v15, v15, v21
    v_accvgpr_write_b32 a89, v15
    v_accvgpr_read_b32 v15, a90
    v_mul_f32 v15, v15, v21
    v_accvgpr_write_b32 a90, v15
    v_accvgpr_read_b32 v15, a91
    v_mul_f32 v15, v15, v21
    v_accvgpr_write_b32 a91, v15
    v_accvgpr_read_b32 v15, a92
    v_mul_f32 v15, v15, v21
    v_accvgpr_write_b32 a92, v15
    v_accvgpr_read_b32 v15, a93
    v_mul_f32 v15, v15, v21
    v_accvgpr_write_b32 a93, v15
    v_accvgpr_read_b32 v15, a94
    v_mul_f32 v15, v15, v21
    v_accvgpr_write_b32 a94, v15
    v_accvgpr_read_b32 v15, a95
    v_mul_f32 v15, v15, v21
    v_accvgpr_write_b32 a95, v15
    v_fma_f32 v152, v152, s28, v12
    v_fma_f32 v153, v153, s28, v12
    v_exp_f32 v152, v152
    v_exp_f32 v153, v153
    s_nop 0
    v_cvt_pk_bf16_f32 v36, v152, v153
    v_fma_f32 v154, v154, s28, v12
    v_fma_f32 v155, v155, s28, v12
    v_exp_f32 v154, v154
    v_exp_f32 v155, v155
    s_nop 0
    v_cvt_pk_bf16_f32 v37, v154, v155
    v_fma_f32 v156, v156, s28, v12
    v_fma_f32 v157, v157, s28, v12
    v_exp_f32 v156, v156
    v_exp_f32 v157, v157
    s_nop 0
    v_cvt_pk_bf16_f32 v34, v156, v157
    v_fma_f32 v158, v158, s28, v12
    v_fma_f32 v159, v159, s28, v12
    v_exp_f32 v158, v158
    v_exp_f32 v159, v159
    s_nop 0
    v_cvt_pk_bf16_f32 v35, v158, v159
    s_add_u32 s69, s39, 0
    buffer_load_dwordx4 v[48:51], v26, s[4:7], s69 offen offset:0
    s_waitcnt vmcnt(0)
    v_mfma_f32_16x16x32_bf16 v[152:155], v[48:51], a[240:243], 0
    s_nop 7
    buffer_load_dwordx4 v[48:51], v26, s[4:7], s69 offen offset:64
    s_waitcnt vmcnt(0)
    v_mfma_f32_16x16x32_bf16 v[152:155], v[48:51], a[244:247], v[152:155]
    s_nop 7
    buffer_load_dwordx4 v[48:51], v26, s[4:7], s69 offen offset:128
    s_waitcnt vmcnt(0)
    v_mfma_f32_16x16x32_bf16 v[152:155], v[48:51], a[248:251], v[152:155]
    s_nop 7
    buffer_load_dwordx4 v[48:51], v26, s[4:7], s69 offen offset:192
    s_waitcnt vmcnt(0)
    v_mfma_f32_16x16x32_bf16 v[152:155], v[48:51], a[252:255], v[152:155]
    s_nop 7
    buffer_load_dwordx4 v[48:51], v26, s[4:7], s69 offen offset:256
    s_waitcnt vmcnt(0)
    v_mfma_f32_16x16x32_bf16 v[152:155], v[48:51], v[136:139], v[152:155]
    s_nop 7
    buffer_load_dwordx4 v[48:51], v26, s[4:7], s69 offen offset:320
    s_waitcnt vmcnt(0)
    v_mfma_f32_16x16x32_bf16 v[152:155], v[48:51], v[140:143], v[152:155]
    s_nop 7
    s_add_u32 s69, s39, 6144
    buffer_load_dwordx4 v[48:51], v26, s[4:7], s69 offen offset:0
    s_waitcnt vmcnt(0)
    v_mfma_f32_16x16x32_bf16 v[156:159], v[48:51], a[240:243], 0
    s_nop 7
    buffer_load_dwordx4 v[48:51], v26, s[4:7], s69 offen offset:64
    s_waitcnt vmcnt(0)
    v_mfma_f32_16x16x32_bf16 v[156:159], v[48:51], a[244:247], v[156:159]
    s_nop 7
    buffer_load_dwordx4 v[48:51], v26, s[4:7], s69 offen offset:128
    s_waitcnt vmcnt(0)
    v_mfma_f32_16x16x32_bf16 v[156:159], v[48:51], a[248:251], v[156:159]
    s_nop 7
    buffer_load_dwordx4 v[48:51], v26, s[4:7], s69 offen offset:192
    s_waitcnt vmcnt(0)
    v_mfma_f32_16x16x32_bf16 v[156:159], v[48:51], a[252:255], v[156:159]
    s_nop 7
    buffer_load_dwordx4 v[48:51], v26, s[4:7], s69 offen offset:256
    s_waitcnt vmcnt(0)
    v_mfma_f32_16x16x32_bf16 v[156:159], v[48:51], v[136:139], v[156:159]
    s_nop 7
    buffer_load_dwordx4 v[48:51], v26, s[4:7], s69 offen offset:320
    s_waitcnt vmcnt(0)
    v_mfma_f32_16x16x32_bf16 v[156:159], v[48:51], v[140:143], v[156:159]
    s_nop 7
    s_nop 15
    v_max3_f32 v14, v152, v153, v154
    v_max3_f32 v14, v14, v155, v156
    v_max3_f32 v14, v14, v157, v158
    v_max_f32 v14, v14, v159
    v_mov_b32 v15, v14
    s_nop 1
    v_permlane32_swap_b32 v15, v14
    v_max_f32 v14, v14, v15
    v_mov_b32 v15, v14
    s_nop 1
    v_permlane16_swap_b32 v15, v14
    v_max_f32 v14, v14, v15
    v_fma_f32 v14, v14, s28, v13
    v_max_f32 v20, 0, v14
    v_sub_f32 v13, v13, v20
    v_sub_f32 v21, 0, v20
    v_exp_f32 v21, v21
    s_nop 0
    v_mul_f32 v15, v44, v21
    v_cndmask_b32_e64 v44, v44, v15, s[60:61]
    v_accvgpr_read_b32 v15, a96
    v_mul_f32 v15, v15, v21
    v_accvgpr_write_b32 a96, v15
    v_accvgpr_read_b32 v15, a97
    v_mul_f32 v15, v15, v21
    v_accvgpr_write_b32 a97, v15
    v_accvgpr_read_b32 v15, a98
    v_mul_f32 v15, v15, v21
    v_accvgpr_write_b32 a98, v15
    v_accvgpr_read_b32 v15, a99
    v_mul_f32 v15, v15, v21
    v_accvgpr_write_b32 a99, v15
    v_accvgpr_read_b32 v15, a100
    v_mul_f32 v15, v15, v21
    v_accvgpr_write_b32 a100, v15
    v_accvgpr_read_b32 v15, a101
    v_mul_f32 v15, v15, v21
    v_accvgpr_write_b32 a101, v15
    v_accvgpr_read_b32 v15, a102
    v_mul_f32 v15, v15, v21
    v_accvgpr_write_b32 a102, v15
    v_accvgpr_read_b32 v15, a103
    v_mul_f32 v15, v15, v21
    v_accvgpr_write_b32 a103, v15
    v_accvgpr_read_b32 v15, a104
    v_mul_f32 v15, v15, v21
    v_accvgpr_write_b32 a104, v15
    v_accvgpr_read_b32 v15, a105
    v_mul_f32 v15, v15, v21
    v_accvgpr_write_b32 a105, v15
    v_accvgpr_read_b32 v15, a106
    v_mul_f32 v15, v15, v21
    v_accvgpr_write_b32 a106, v15
    v_accvgpr_read_b32 v15, a107
    v_mul_f32 v15, v15, v21
    v_accvgpr_write_b32 a107, v15
    v_accvgpr_read_b32 v15, a108
    v_mul_f32 v15, v15, v21
    v_accvgpr_write_b32 a108, v15
    v_accvgpr_read_b32 v15, a109
    v_mul_f32 v15, v15, v21
    v_accvgpr_write_b32 a109, v15
    v_accvgpr_read_b32 v15, a110
    v_mul_f32 v15, v15, v21
    v_accvgpr_write_b32 a110, v15
    v_accvgpr_read_b32 v15, a111
    v_mul_f32 v15, v15, v21
    v_accvgpr_write_b32 a111, v15
    v_accvgpr_read_b32 v15, a112
    v_mul_f32 v15, v15, v21
    v_accvgpr_write_b32 a112, v15
    v_accvgpr_read_b32 v15, a113
    v_mul_f32 v15, v15, v21
    v_accvgpr_write_b32 a113, v15
    v_accvgpr_read_b32 v15, a114
    v_mul_f32 v15, v15, v21
    v_accvgpr_write_b32 a114, v15
    v_accvgpr_read_b32 v15, a115
    v_mul_f32 v15, v15, v21
    v_accvgpr_write_b32 a115, v15
    v_accvgpr_read_b32 v15, a116
    v_mul_f32 v15, v15, v21
    v_accvgpr_write_b32 a116, v15
    v_accvgpr_read_b32 v15, a117
    v_mul_f32 v15, v15, v21
    v_accvgpr_write_b32 a117, v15
    v_accvgpr_read_b32 v15, a118
    v_mul_f32 v15, v15, v21
    v_accvgpr_write_b32 a118, v15
    v_accvgpr_read_b32 v15, a119
    v_mul_f32 v15, v15, v21
    v_accvgpr_write_b32 a119, v15
    v_accvgpr_read_b32 v15, a120
    v_mul_f32 v15, v15, v21
    v_accvgpr_write_b32 a120, v15
    v_accvgpr_read_b32 v15, a121
    v_mul_f32 v15, v15, v21
    v_accvgpr_write_b32 a121, v15
    v_accvgpr_read_b32 v15, a122
    v_mul_f32 v15, v15, v21
    v_accvgpr_write_b32 a122, v15
    v_accvgpr_read_b32 v15, a123
    v_mul_f32 v15, v15, v21
    v_accvgpr_write_b32 a123, v15
    v_accvgpr_read_b32 v15, a124
    v_mul_f32 v15, v15, v21
    v_accvgpr_write_b32 a124, v15
    v_accvgpr_read_b32 v15, a125
    v_mul_f32 v15, v15, v21
    v_accvgpr_write_b32 a125, v15
    v_accvgpr_read_b32 v15, a126
    v_mul_f32 v15, v15, v21
    v_accvgpr_write_b32 a126, v15
    v_accvgpr_read_b32 v15, a127
    v_mul_f32 v15, v15, v21
    v_accvgpr_write_b32 a127, v15
    v_accvgpr_read_b32 v15, a128
    v_mul_f32 v15, v15, v21
    v_accvgpr_write_b32 a128, v15
    v_accvgpr_read_b32 v15, a129
    v_mul_f32 v15, v15, v21
    v_accvgpr_write_b32 a129, v15
    v_accvgpr_read_b32 v15, a130
    v_mul_f32 v15, v15, v21
    v_accvgpr_write_b32 a130, v15
    v_accvgpr_read_b32 v15, a131
    v_mul_f32 v15, v15, v21
    v_accvgpr_write_b32 a131, v15
    v_accvgpr_read_b32 v15, a132
    v_mul_f32 v15, v15, v21
    v_accvgpr_write_b32 a132, v15
    v_accvgpr_read_b32 v15, a133
    v_mul_f32 v15, v15, v21
    v_accvgpr_write_b32 a133, v15
    v_accvgpr_read_b32 v15, a134
    v_mul_f32 v15, v15, v21
    v_accvgpr_write_b32 a134, v15
    v_accvgpr_read_b32 v15, a135
    v_mul_f32 v15, v15, v21
    v_accvgpr_write_b32 a135, v15
    v_accvgpr_read_b32 v15, a136
    v_mul_f32 v15, v15, v21
    v_accvgpr_write_b32 a136, v15
    v_accvgpr_read_b32 v15, a137
    v_mul_f32 v15, v15, v21
    v_accvgpr_write_b32 a137, v15
    v_accvgpr_read_b32 v15, a138
    v_mul_f32 v15, v15, v21
    v_accvgpr_write_b32 a138, v15
    v_accvgpr_read_b32 v15, a139
    v_mul_f32 v15, v15, v21
    v_accvgpr_write_b32 a139, v15
    v_accvgpr_read_b32 v15, a140
    v_mul_f32 v15, v15, v21
    v_accvgpr_write_b32 a140, v15
    v_accvgpr_read_b32 v15, a141
    v_mul_f32 v15, v15, v21
    v_accvgpr_write_b32 a141, v15
    v_accvgpr_read_b32 v15, a142
    v_mul_f32 v15, v15, v21
    v_accvgpr_write_b32 a142, v15
    v_accvgpr_read_b32 v15, a143
    v_mul_f32 v15, v15, v21
    v_accvgpr_write_b32 a143, v15
    v_fma_f32 v152, v152, s28, v13
    v_fma_f32 v153, v153, s28, v13
    v_exp_f32 v152, v152
    v_exp_f32 v153, v153
    s_nop 0
    v_cvt_pk_bf16_f32 v42, v152, v153
    v_fma_f32 v154, v154, s28, v13
    v_fma_f32 v155, v155, s28, v13
    v_exp_f32 v154, v154
    v_exp_f32 v155, v155
    s_nop 0
    v_cvt_pk_bf16_f32 v43, v154, v155
    v_fma_f32 v156, v156, s28, v13
    v_fma_f32 v157, v157, s28, v13
    v_exp_f32 v156, v156
    v_exp_f32 v157, v157
    s_nop 0
    v_cvt_pk_bf16_f32 v40, v156, v157
    v_fma_f32 v158, v158, s28, v13
    v_fma_f32 v159, v159, s28, v13
    v_exp_f32 v158, v158
    v_exp_f32 v159, v159
    s_nop 0
    v_cvt_pk_bf16_f32 v41, v158, v159
    v_mfma_f32_16x16x32_bf16 v[48:51], v[52:55], v[16:19], v[44:47]
    v_mfma_f32_16x16x32_bf16 v[48:51], v[56:59], v[22:25], v[48:51]
    v_mfma_f32_16x16x32_bf16 v[48:51], v[60:63], v[28:31], v[48:51]
    v_mfma_f32_16x16x32_bf16 v[48:51], v[64:67], v[34:37], v[48:51]
    v_mfma_f32_16x16x32_bf16 v[48:51], v[68:71], v[40:43], v[48:51]
    s_nop 15
    s_setpc_b64 s[40:41]
L_rare4_0:
    s_nop 15
    v_mbcnt_lo_u32_b32 v31, -1, 0
    v_mbcnt_hi_u32_b32 v31, -1, v31
    v_and_b32 v30, 15, v31
    v_mul_u32_u24 v30, 384, v30
    v_lshrrev_b32 v31, 4, v31
    v_lshl_add_u32 v30, v31, 4, v30
    s_add_u32 s69, s39, 0
    buffer_load_dwordx4 v[44:47], v30, s[4:7], s69 offen offset:0
    s_waitcnt vmcnt(0)
    v_mfma_f32_16x16x32_bf16 v[152:155], v[44:47], a[144:147], 0
    s_nop 7
    buffer_load_dwordx4 v[44:47], v30, s[4:7], s69 offen offset:64
    s_waitcnt vmcnt(0)
    v_mfma_f32_16x16x32_bf16 v[152:155], v[44:47], a[148:151], v[152:155]
    s_nop 7
    buffer_load_dwordx4 v[44:47], v30, s[4:7], s69 offen offset:128
    s_waitcnt vmcnt(0)
    v_mfma_f32_16x16x32_bf16 v[152:155], v[44:47], a[152:155], v[152:155]
    s_nop 7
    buffer_load_dwordx4 v[44:47], v30, s[4:7], s69 offen offset:192
    s_waitcnt vmcnt(0)
    v_mfma_f32_16x16x32_bf16 v[152:155], v[44:47], a[156:159], v[152:155]
    s_nop 7
    buffer_load_dwordx4 v[44:47], v30, s[4:7], s69 offen offset:256
    s_waitcnt vmcnt(0)
    v_mfma_f32_16x16x32_bf16 v[152:155], v[44:47], a[160:163], v[152:155]
    s_nop 7
    buffer_load_dwordx4 v[44:47], v30, s[4:7], s69 offen offset:320
    s_waitcnt vmcnt(0)
    v_mfma_f32_16x16x32_bf16 v[152:155], v[44:47], a[164:167], v[152:155]
    s_nop 7
    s_add_u32 s69, s39, 6144
    buffer_load_dwordx4 v[44:47], v30, s[4:7], s69 offen offset:0
    s_waitcnt vmcnt(0)
    v_mfma_f32_16x16x32_bf16 v[156:159], v[44:47], a[144:147], 0
    s_nop 7
    buffer_load_dwordx4 v[44:47], v30, s[4:7], s69 offen offset:64
    s_waitcnt vmcnt(0)
    v_mfma_f32_16x16x32_bf16 v[156:159], v[44:47], a[148:151], v[156:159]
    s_nop 7
    buffer_load_dwordx4 v[44:47], v30, s[4:7], s69 offen offset:128
    s_waitcnt vmcnt(0)
    v_mfma_f32_16x16x32_bf16 v[156:159], v[44:47], a[152:155], v[156:159]
    s_nop 7
    buffer_load_dwordx4 v[44:47], v30, s[4:7], s69 offen offset:192
    s_waitcnt vmcnt(0)
    v_mfma_f32_16x16x32_bf16 v[156:159], v[44:47], a[156:159], v[156:159]
    s_nop 7
    buffer_load_dwordx4 v[44:47], v30, s[4:7], s69 offen offset:256
    s_waitcnt vmcnt(0)
    v_mfma_f32_16x16x32_bf16 v[156:159], v[44:47], a[160:163], v[156:159]
    s_nop 7
    buffer_load_dwordx4 v[44:47], v30, s[4:7], s69 offen offset:320
    s_waitcnt vmcnt(0)
    v_mfma_f32_16x16x32_bf16 v[156:159], v[44:47], a[164:167], v[156:159]
    s_nop 7
    s_nop 15
    v_max3_f32 v18, v152, v153, v154
    v_max3_f32 v18, v18, v155, v156
    v_max3_f32 v18, v18, v157, v158
    v_max_f32 v18, v18, v159
    v_mov_b32 v19, v18
    s_nop 1
    v_permlane32_swap_b32 v19, v18
    v_max_f32 v18, v18, v19
    v_mov_b32 v19, v18
    s_nop 1
    v_permlane16_swap_b32 v19, v18
    v_max_f32 v18, v18, v19
    v_fma_f32 v18, v18, s28, v9
    v_max_f32 v24, 0, v18
    v_sub_f32 v9, v9, v24
    v_sub_f32 v25, 0, v24
    v_exp_f32 v25, v25
    s_nop 0
    v_mul_f32 v19, v48, v25
    v_cndmask_b32_e64 v48, v19, v48, s[60:61]
    v_cndmask_b32_e64 v48, v48, 0, s[46:47]
    v_mul_f32 v160, v160, v25
    v_mul_f32 v161, v161, v25
    v_mul_f32 v162, v162, v25
    v_mul_f32 v163, v163, v25
    v_mul_f32 v164, v164, v25
    v_mul_f32 v165, v165, v25
    v_mul_f32 v166, v166, v25
    v_mul_f32 v167, v167, v25
    v_mul_f32 v168, v168, v25
    v_mul_f32 v169, v169, v25
    v_mul_f32 v170, v170, v25
    v_mul_f32 v171, v171, v25
    v_mul_f32 v172, v172, v25
    v_mul_f32 v173, v173, v25
    v_mul_f32 v174, v174, v25
    v_mul_f32 v175, v175, v25
    v_mul_f32 v176, v176, v25
    v_mul_f32 v177, v177, v25
    v_mul_f32 v178, v178, v25
    v_mul_f32 v179, v179, v25
    v_mul_f32 v180, v180, v25
    v_mul_f32 v181, v181, v25
    v_mul_f32 v182, v182, v25
    v_mul_f32 v183, v183, v25
    v_mul_f32 v184, v184, v25
    v_mul_f32 v185, v185, v25
    v_mul_f32 v186, v186, v25
    v_mul_f32 v187, v187, v25
    v_mul_f32 v188, v188, v25
    v_mul_f32 v189, v189, v25
    v_mul_f32 v190, v190, v25
    v_mul_f32 v191, v191, v25
    v_mul_f32 v192, v192, v25
    v_mul_f32 v193, v193, v25
    v_mul_f32 v194, v194, v25
    v_mul_f32 v195, v195, v25
    v_mul_f32 v196, v196, v25
    v_mul_f32 v197, v197, v25
    v_mul_f32 v198, v198, v25
    v_mul_f32 v199, v199, v25
    v_mul_f32 v200, v200, v25
    v_mul_f32 v201, v201, v25
    v_mul_f32 v202, v202, v25
    v_mul_f32 v203, v203, v25
    v_mul_f32 v204, v204, v25
    v_mul_f32 v205, v205, v25
    v_mul_f32 v206, v206, v25
    v_mul_f32 v207, v207, v25
    v_fma_f32 v152, v152, s28, v9
    v_fma_f32 v153, v153, s28, v9
    v_exp_f32 v152, v152
    v_exp_f32 v153, v153
    s_nop 0
    v_cvt_pk_bf16_f32 v14, v152, v153
    v_fma_f32 v154, v154, s28, v9
    v_fma_f32 v155, v155, s28, v9
    v_exp_f32 v154, v154
    v_exp_f32 v155, v155
    s_nop 0
    v_cvt_pk_bf16_f32 v15, v154, v155
    v_fma_f32 v156, v156, s28, v9
    v_fma_f32 v157, v157, s28, v9
    v_exp_f32 v156, v156
    v_exp_f32 v157, v157
    s_nop 0
    v_cvt_pk_bf16_f32 v16, v156, v157
    v_fma_f32 v158, v158, s28, v9
    v_fma_f32 v159, v159, s28, v9
    v_exp_f32 v158, v158
    v_exp_f32 v159, v159
    s_nop 0
    v_cvt_pk_bf16_f32 v17, v158, v159
    s_add_u32 s69, s39, 0
    buffer_load_dwordx4 v[44:47], v30, s[4:7], s69 offen offset:0
    s_waitcnt vmcnt(0)
    v_mfma_f32_16x16x32_bf16 v[152:155], v[44:47], a[168:171], 0
    s_nop 7
    buffer_load_dwordx4 v[44:47], v30, s[4:7], s69 offen offset:64
    s_waitcnt vmcnt(0)
    v_mfma_f32_16x16x32_bf16 v[152:155], v[44:47], a[172:175], v[152:155]
    s_nop 7
    buffer_load_dwordx4 v[44:47], v30, s[4:7], s69 offen offset:128
    s_waitcnt vmcnt(0)
    v_mfma_f32_16x16x32_bf16 v[152:155], v[44:47], a[176:179], v[152:155]
    s_nop 7
    buffer_load_dwordx4 v[44:47], v30, s[4:7], s69 offen offset:192
    s_waitcnt vmcnt(0)
    v_mfma_f32_16x16x32_bf16 v[152:155], v[44:47], a[180:183], v[152:155]
    s_nop 7
    buffer_load_dwordx4 v[44:47], v30, s[4:7], s69 offen offset:256
    s_waitcnt vmcnt(0)
    v_mfma_f32_16x16x32_bf16 v[152:155], v[44:47], a[184:187], v[152:155]
    s_nop 7
    buffer_load_dwordx4 v[44:47], v30, s[4:7], s69 offen offset:320
    s_waitcnt vmcnt(0)
    v_mfma_f32_16x16x32_bf16 v[152:155], v[44:47], a[188:191], v[152:155]
    s_nop 7
    s_add_u32 s69, s39, 6144
    buffer_load_dwordx4 v[44:47], v30, s[4:7], s69 offen offset:0
    s_waitcnt vmcnt(0)
    v_mfma_f32_16x16x32_bf16 v[156:159], v[44:47], a[168:171], 0
    s_nop 7
    buffer_load_dwordx4 v[44:47], v30, s[4:7], s69 offen offset:64
    s_waitcnt vmcnt(0)
    v_mfma_f32_16x16x32_bf16 v[156:159], v[44:47], a[172:175], v[156:159]
    s_nop 7
    buffer_load_dwordx4 v[44:47], v30, s[4:7], s69 offen offset:128
    s_waitcnt vmcnt(0)
    v_mfma_f32_16x16x32_bf16 v[156:159], v[44:47], a[176:179], v[156:159]
    s_nop 7
    buffer_load_dwordx4 v[44:47], v30, s[4:7], s69 offen offset:192
    s_waitcnt vmcnt(0)
    v_mfma_f32_16x16x32_bf16 v[156:159], v[44:47], a[180:183], v[156:159]
    s_nop 7
    buffer_load_dwordx4 v[44:47], v30, s[4:7], s69 offen offset:256
    s_waitcnt vmcnt(0)
    v_mfma_f32_16x16x32_bf16 v[156:159], v[44:47], a[184:187], v[156:159]
    s_nop 7
    buffer_load_dwordx4 v[44:47], v30, s[4:7], s69 offen offset:320
    s_waitcnt vmcnt(0)
    v_mfma_f32_16x16x32_bf16 v[156:159], v[44:47], a[188:191], v[156:159]
    s_nop 7
    s_nop 15
    v_max3_f32 v18, v152, v153, v154
    v_max3_f32 v18, v18, v155, v156
    v_max3_f32 v18, v18, v157, v158
    v_max_f32 v18, v18, v159
    v_mov_b32 v19, v18
    s_nop 1
    v_permlane32_swap_b32 v19, v18
    v_max_f32 v18, v18, v19
    v_mov_b32 v19, v18
    s_nop 1
    v_permlane16_swap_b32 v19, v18
    v_max_f32 v18, v18, v19
    v_fma_f32 v18, v18, s28, v10
    v_max_f32 v24, 0, v18
    v_sub_f32 v10, v10, v24
    v_sub_f32 v25, 0, v24
    v_exp_f32 v25, v25
    s_nop 0
    v_mul_f32 v49, v49, v25
    v_mul_f32 v208, v208, v25
    v_mul_f32 v209, v209, v25
    v_mul_f32 v210, v210, v25
    v_mul_f32 v211, v211, v25
    v_mul_f32 v212, v212, v25
    v_mul_f32 v213, v213, v25
    v_mul_f32 v214, v214, v25
    v_mul_f32 v215, v215, v25
    v_mul_f32 v216, v216, v25
    v_mul_f32 v217, v217, v25
    v_mul_f32 v218, v218, v25
    v_mul_f32 v219, v219, v25
    v_mul_f32 v220, v220, v25
    v_mul_f32 v221, v221, v25
    v_mul_f32 v222, v222, v25
    v_mul_f32 v223, v223, v25
    v_mul_f32 v224, v224, v25
    v_mul_f32 v225, v225, v25
    v_mul_f32 v226, v226, v25
    v_mul_f32 v227, v227, v25
    v_mul_f32 v228, v228, v25
    v_mul_f32 v229, v229, v25
    v_mul_f32 v230, v230, v25
    v_mul_f32 v231, v231, v25
    v_mul_f32 v232, v232, v25
    v_mul_f32 v233, v233, v25
    v_mul_f32 v234, v234, v25
    v_mul_f32 v235, v235, v25
    v_mul_f32 v236, v236, v25
    v_mul_f32 v237, v237, v25
    v_mul_f32 v238, v238, v25
    v_mul_f32 v239, v239, v25
    v_mul_f32 v240, v240, v25
    v_mul_f32 v241, v241, v25
    v_mul_f32 v242, v242, v25
    v_mul_f32 v243, v243, v25
    v_mul_f32 v244, v244, v25
    v_mul_f32 v245, v245, v25
    v_mul_f32 v246, v246, v25
    v_mul_f32 v247, v247, v25
    v_mul_f32 v248, v248, v25
    v_mul_f32 v249, v249, v25
    v_mul_f32 v250, v250, v25
    v_mul_f32 v251, v251, v25
    v_mul_f32 v252, v252, v25
    v_mul_f32 v253, v253, v25
    v_mul_f32 v254, v254, v25
    v_mul_f32 v255, v255, v25
    v_fma_f32 v152, v152, s28, v10
    v_fma_f32 v153, v153, s28, v10
    v_exp_f32 v152, v152
    v_exp_f32 v153, v153
    s_nop 0
    v_cvt_pk_bf16_f32 v20, v152, v153
    v_fma_f32 v154, v154, s28, v10
    v_fma_f32 v155, v155, s28, v10
    v_exp_f32 v154, v154
    v_exp_f32 v155, v155
    s_nop 0
    v_cvt_pk_bf16_f32 v21, v154, v155
    v_fma_f32 v156, v156, s28, v10
    v_fma_f32 v157, v157, s28, v10
    v_exp_f32 v156, v156
    v_exp_f32 v157, v157
    s_nop 0
    v_cvt_pk_bf16_f32 v22, v156, v157
    v_fma_f32 v158, v158, s28, v10
    v_fma_f32 v159, v159, s28, v10
    v_exp_f32 v158, v158
    v_exp_f32 v159, v159
    s_nop 0
    v_cvt_pk_bf16_f32 v23, v158, v159
    s_add_u32 s69, s39, 0
    buffer_load_dwordx4 v[44:47], v30, s[4:7], s69 offen offset:0
    s_waitcnt vmcnt(0)
    v_mfma_f32_16x16x32_bf16 v[152:155], v[44:47], a[192:195], 0
    s_nop 7
    buffer_load_dwordx4 v[44:47], v30, s[4:7], s69 offen offset:64
    s_waitcnt vmcnt(0)
    v_mfma_f32_16x16x32_bf16 v[152:155], v[44:47], a[196:199], v[152:155]
    s_nop 7
    buffer_load_dwordx4 v[44:47], v30, s[4:7], s69 offen offset:128
    s_waitcnt vmcnt(0)
    v_mfma_f32_16x16x32_bf16 v[152:155], v[44:47], a[200:203], v[152:155]
    s_nop 7
    buffer_load_dwordx4 v[44:47], v30, s[4:7], s69 offen offset:192
    s_waitcnt vmcnt(0)
    v_mfma_f32_16x16x32_bf16 v[152:155], v[44:47], a[204:207], v[152:155]
    s_nop 7
    buffer_load_dwordx4 v[44:47], v30, s[4:7], s69 offen offset:256
    s_waitcnt vmcnt(0)
    v_mfma_f32_16x16x32_bf16 v[152:155], v[44:47], a[208:211], v[152:155]
    s_nop 7
    buffer_load_dwordx4 v[44:47], v30, s[4:7], s69 offen offset:320
    s_waitcnt vmcnt(0)
    v_mfma_f32_16x16x32_bf16 v[152:155], v[44:47], a[212:215], v[152:155]
    s_nop 7
    s_add_u32 s69, s39, 6144
    buffer_load_dwordx4 v[44:47], v30, s[4:7], s69 offen offset:0
    s_waitcnt vmcnt(0)
    v_mfma_f32_16x16x32_bf16 v[156:159], v[44:47], a[192:195], 0
    s_nop 7
    buffer_load_dwordx4 v[44:47], v30, s[4:7], s69 offen offset:64
    s_waitcnt vmcnt(0)
    v_mfma_f32_16x16x32_bf16 v[156:159], v[44:47], a[196:199], v[156:159]
    s_nop 7
    buffer_load_dwordx4 v[44:47], v30, s[4:7], s69 offen offset:128
    s_waitcnt vmcnt(0)
    v_mfma_f32_16x16x32_bf16 v[156:159], v[44:47], a[200:203], v[156:159]
    s_nop 7
    buffer_load_dwordx4 v[44:47], v30, s[4:7], s69 offen offset:192
    s_waitcnt vmcnt(0)
    v_mfma_f32_16x16x32_bf16 v[156:159], v[44:47], a[204:207], v[156:159]
    s_nop 7
    buffer_load_dwordx4 v[44:47], v30, s[4:7], s69 offen offset:256
    s_waitcnt vmcnt(0)
    v_mfma_f32_16x16x32_bf16 v[156:159], v[44:47], a[208:211], v[156:159]
    s_nop 7
    buffer_load_dwordx4 v[44:47], v30, s[4:7], s69 offen offset:320
    s_waitcnt vmcnt(0)
    v_mfma_f32_16x16x32_bf16 v[156:159], v[44:47], a[212:215], v[156:159]
    s_nop 7
    s_nop 15
    v_max3_f32 v18, v152, v153, v154
    v_max3_f32 v18, v18, v155, v156
    v_max3_f32 v18, v18, v157, v158
    v_max_f32 v18, v18, v159
    v_mov_b32 v19, v18
    s_nop 1
    v_permlane32_swap_b32 v19, v18
    v_max_f32 v18, v18, v19
    v_mov_b32 v19, v18
    s_nop 1
    v_permlane16_swap_b32 v19, v18
    v_max_f32 v18, v18, v19
    v_fma_f32 v18, v18, s28, v11
    v_max_f32 v24, 0, v18
    v_sub_f32 v11, v11, v24
    v_sub_f32 v25, 0, v24
    v_exp_f32 v25, v25
    s_nop 0
    v_mul_f32 v50, v50, v25
    v_accvgpr_read_b32 v19, a0
    v_mul_f32 v19, v19, v25
    v_accvgpr_write_b32 a0, v19
    v_accvgpr_read_b32 v19, a1
    v_mul_f32 v19, v19, v25
    v_accvgpr_write_b32 a1, v19
    v_accvgpr_read_b32 v19, a2
    v_mul_f32 v19, v19, v25
    v_accvgpr_write_b32 a2, v19
    v_accvgpr_read_b32 v19, a3
    v_mul_f32 v19, v19, v25
    v_accvgpr_write_b32 a3, v19
    v_accvgpr_read_b32 v19, a4
    v_mul_f32 v19, v19, v25
    v_accvgpr_write_b32 a4, v19
    v_accvgpr_read_b32 v19, a5
    v_mul_f32 v19, v19, v25
    v_accvgpr_write_b32 a5, v19
    v_accvgpr_read_b32 v19, a6
    v_mul_f32 v19, v19, v25
    v_accvgpr_write_b32 a6, v19
    v_accvgpr_read_b32 v19, a7
    v_mul_f32 v19, v19, v25
    v_accvgpr_write_b32 a7, v19
    v_accvgpr_read_b32 v19, a8
    v_mul_f32 v19, v19, v25
    v_accvgpr_write_b32 a8, v19
    v_accvgpr_read_b32 v19, a9
    v_mul_f32 v19, v19, v25
    v_accvgpr_write_b32 a9, v19
    v_accvgpr_read_b32 v19, a10
    v_mul_f32 v19, v19, v25
    v_accvgpr_write_b32 a10, v19
    v_accvgpr_read_b32 v19, a11
    v_mul_f32 v19, v19, v25
    v_accvgpr_write_b32 a11, v19
    v_accvgpr_read_b32 v19, a12
    v_mul_f32 v19, v19, v25
    v_accvgpr_write_b32 a12, v19
    v_accvgpr_read_b32 v19, a13
    v_mul_f32 v19, v19, v25
    v_accvgpr_write_b32 a13, v19
    v_accvgpr_read_b32 v19, a14
    v_mul_f32 v19, v19, v25
    v_accvgpr_write_b32 a14, v19
    v_accvgpr_read_b32 v19, a15
    v_mul_f32 v19, v19, v25
    v_accvgpr_write_b32 a15, v19
    v_accvgpr_read_b32 v19, a16
    v_mul_f32 v19, v19, v25
    v_accvgpr_write_b32 a16, v19
    v_accvgpr_read_b32 v19, a17
    v_mul_f32 v19, v19, v25
    v_accvgpr_write_b32 a17, v19
    v_accvgpr_read_b32 v19, a18
    v_mul_f32 v19, v19, v25
    v_accvgpr_write_b32 a18, v19
    v_accvgpr_read_b32 v19, a19
    v_mul_f32 v19, v19, v25
    v_accvgpr_write_b32 a19, v19
    v_accvgpr_read_b32 v19, a20
    v_mul_f32 v19, v19, v25
    v_accvgpr_write_b32 a20, v19
    v_accvgpr_read_b32 v19, a21
    v_mul_f32 v19, v19, v25
    v_accvgpr_write_b32 a21, v19
    v_accvgpr_read_b32 v19, a22
    v_mul_f32 v19, v19, v25
    v_accvgpr_write_b32 a22, v19
    v_accvgpr_read_b32 v19, a23
    v_mul_f32 v19, v19, v25
    v_accvgpr_write_b32 a23, v19
    v_accvgpr_read_b32 v19, a24
    v_mul_f32 v19, v19, v25
    v_accvgpr_write_b32 a24, v19
    v_accvgpr_read_b32 v19, a25
    v_mul_f32 v19, v19, v25
    v_accvgpr_write_b32 a25, v19
    v_accvgpr_read_b32 v19, a26
    v_mul_f32 v19, v19, v25
    v_accvgpr_write_b32 a26, v19
    v_accvgpr_read_b32 v19, a27
    v_mul_f32 v19, v19, v25
    v_accvgpr_write_b32 a27, v19
    v_accvgpr_read_b32 v19, a28
    v_mul_f32 v19, v19, v25
    v_accvgpr_write_b32 a28, v19
    v_accvgpr_read_b32 v19, a29
    v_mul_f32 v19, v19, v25
    v_accvgpr_write_b32 a29, v19
    v_accvgpr_read_b32 v19, a30
    v_mul_f32 v19, v19, v25
    v_accvgpr_write_b32 a30, v19
    v_accvgpr_read_b32 v19, a31
    v_mul_f32 v19, v19, v25
    v_accvgpr_write_b32 a31, v19
    v_accvgpr_read_b32 v19, a32
    v_mul_f32 v19, v19, v25
    v_accvgpr_write_b32 a32, v19
    v_accvgpr_read_b32 v19, a33
    v_mul_f32 v19, v19, v25
    v_accvgpr_write_b32 a33, v19
    v_accvgpr_read_b32 v19, a34
    v_mul_f32 v19, v19, v25
    v_accvgpr_write_b32 a34, v19
    v_accvgpr_read_b32 v19, a35
    v_mul_f32 v19, v19, v25
    v_accvgpr_write_b32 a35, v19
    v_accvgpr_read_b32 v19, a36
    v_mul_f32 v19, v19, v25
    v_accvgpr_write_b32 a36, v19
    v_accvgpr_read_b32 v19, a37
    v_mul_f32 v19, v19, v25
    v_accvgpr_write_b32 a37, v19
    v_accvgpr_read_b32 v19, a38
    v_mul_f32 v19, v19, v25
    v_accvgpr_write_b32 a38, v19
    v_accvgpr_read_b32 v19, a39
    v_mul_f32 v19, v19, v25
    v_accvgpr_write_b32 a39, v19
    v_accvgpr_read_b32 v19, a40
    v_mul_f32 v19, v19, v25
    v_accvgpr_write_b32 a40, v19
    v_accvgpr_read_b32 v19, a41
    v_mul_f32 v19, v19, v25
    v_accvgpr_write_b32 a41, v19
    v_accvgpr_read_b32 v19, a42
    v_mul_f32 v19, v19, v25
    v_accvgpr_write_b32 a42, v19
    v_accvgpr_read_b32 v19, a43
    v_mul_f32 v19, v19, v25
    v_accvgpr_write_b32 a43, v19
    v_accvgpr_read_b32 v19, a44
    v_mul_f32 v19, v19, v25
    v_accvgpr_write_b32 a44, v19
    v_accvgpr_read_b32 v19, a45
    v_mul_f32 v19, v19, v25
    v_accvgpr_write_b32 a45, v19
    v_accvgpr_read_b32 v19, a46
    v_mul_f32 v19, v19, v25
    v_accvgpr_write_b32 a46, v19
    v_accvgpr_read_b32 v19, a47
    v_mul_f32 v19, v19, v25
    v_accvgpr_write_b32 a47, v19
    v_fma_f32 v152, v152, s28, v11
    v_fma_f32 v153, v153, s28, v11
    v_exp_f32 v152, v152
    v_exp_f32 v153, v153
    s_nop 0
    v_cvt_pk_bf16_f32 v26, v152, v153
    v_fma_f32 v154, v154, s28, v11
    v_fma_f32 v155, v155, s28, v11
    v_exp_f32 v154, v154
    v_exp_f32 v155, v155
    s_nop 0
    v_cvt_pk_bf16_f32 v27, v154, v155
    v_fma_f32 v156, v156, s28, v11
    v_fma_f32 v157, v157, s28, v11
    v_exp_f32 v156, v156
    v_exp_f32 v157, v157
    s_nop 0
    v_cvt_pk_bf16_f32 v28, v156, v157
    v_fma_f32 v158, v158, s28, v11
    v_fma_f32 v159, v159, s28, v11
    v_exp_f32 v158, v158
    v_exp_f32 v159, v159
    s_nop 0
    v_cvt_pk_bf16_f32 v29, v158, v159
    s_add_u32 s69, s39, 0
    buffer_load_dwordx4 v[44:47], v30, s[4:7], s69 offen offset:0
    s_waitcnt vmcnt(0)
    v_mfma_f32_16x16x32_bf16 v[152:155], v[44:47], a[216:219], 0
    s_nop 7
    buffer_load_dwordx4 v[44:47], v30, s[4:7], s69 offen offset:64
    s_waitcnt vmcnt(0)
    v_mfma_f32_16x16x32_bf16 v[152:155], v[44:47], a[220:223], v[152:155]
    s_nop 7
    buffer_load_dwordx4 v[44:47], v30, s[4:7], s69 offen offset:128
    s_waitcnt vmcnt(0)
    v_mfma_f32_16x16x32_bf16 v[152:155], v[44:47], a[224:227], v[152:155]
    s_nop 7
    buffer_load_dwordx4 v[44:47], v30, s[4:7], s69 offen offset:192
    s_waitcnt vmcnt(0)
    v_mfma_f32_16x16x32_bf16 v[152:155], v[44:47], a[228:231], v[152:155]
    s_nop 7
    buffer_load_dwordx4 v[44:47], v30, s[4:7], s69 offen offset:256
    s_waitcnt vmcnt(0)
    v_mfma_f32_16x16x32_bf16 v[152:155], v[44:47], a[232:235], v[152:155]
    s_nop 7
    buffer_load_dwordx4 v[44:47], v30, s[4:7], s69 offen offset:320
    s_waitcnt vmcnt(0)
    v_mfma_f32_16x16x32_bf16 v[152:155], v[44:47], a[236:239], v[152:155]
    s_nop 7
    s_add_u32 s69, s39, 6144
    buffer_load_dwordx4 v[44:47], v30, s[4:7], s69 offen offset:0
    s_waitcnt vmcnt(0)
    v_mfma_f32_16x16x32_bf16 v[156:159], v[44:47], a[216:219], 0
    s_nop 7
    buffer_load_dwordx4 v[44:47], v30, s[4:7], s69 offen offset:64
    s_waitcnt vmcnt(0)
    v_mfma_f32_16x16x32_bf16 v[156:159], v[44:47], a[220:223], v[156:159]
    s_nop 7
    buffer_load_dwordx4 v[44:47], v30, s[4:7], s69 offen offset:128
    s_waitcnt vmcnt(0)
    v_mfma_f32_16x16x32_bf16 v[156:159], v[44:47], a[224:227], v[156:159]
    s_nop 7
    buffer_load_dwordx4 v[44:47], v30, s[4:7], s69 offen offset:192
    s_waitcnt vmcnt(0)
    v_mfma_f32_16x16x32_bf16 v[156:159], v[44:47], a[228:231], v[156:159]
    s_nop 7
    buffer_load_dwordx4 v[44:47], v30, s[4:7], s69 offen offset:256
    s_waitcnt vmcnt(0)
    v_mfma_f32_16x16x32_bf16 v[156:159], v[44:47], a[232:235], v[156:159]
    s_nop 7
    buffer_load_dwordx4 v[44:47], v30, s[4:7], s69 offen offset:320
    s_waitcnt vmcnt(0)
    v_mfma_f32_16x16x32_bf16 v[156:159], v[44:47], a[236:239], v[156:159]
    s_nop 7
    s_nop 15
    v_max3_f32 v18, v152, v153, v154
    v_max3_f32 v18, v18, v155, v156
    v_max3_f32 v18, v18, v157, v158
    v_max_f32 v18, v18, v159
    v_mov_b32 v19, v18
    s_nop 1
    v_permlane32_swap_b32 v19, v18
    v_max_f32 v18, v18, v19
    v_mov_b32 v19, v18
    s_nop 1
    v_permlane16_swap_b32 v19, v18
    v_max_f32 v18, v18, v19
    v_fma_f32 v18, v18, s28, v12
    v_max_f32 v24, 0, v18
    v_sub_f32 v12, v12, v24
    v_sub_f32 v25, 0, v24
    v_exp_f32 v25, v25
    s_nop 0
    v_mul_f32 v51, v51, v25
    v_accvgpr_read_b32 v19, a48
    v_mul_f32 v19, v19, v25
    v_accvgpr_write_b32 a48, v19
    v_accvgpr_read_b32 v19, a49
    v_mul_f32 v19, v19, v25
    v_accvgpr_write_b32 a49, v19
    v_accvgpr_read_b32 v19, a50
    v_mul_f32 v19, v19, v25
    v_accvgpr_write_b32 a50, v19
    v_accvgpr_read_b32 v19, a51
    v_mul_f32 v19, v19, v25
    v_accvgpr_write_b32 a51, v19
    v_accvgpr_read_b32 v19, a52
    v_mul_f32 v19, v19, v25
    v_accvgpr_write_b32 a52, v19
    v_accvgpr_read_b32 v19, a53
    v_mul_f32 v19, v19, v25
    v_accvgpr_write_b32 a53, v19
    v_accvgpr_read_b32 v19, a54
    v_mul_f32 v19, v19, v25
    v_accvgpr_write_b32 a54, v19
    v_accvgpr_read_b32 v19, a55
    v_mul_f32 v19, v19, v25
    v_accvgpr_write_b32 a55, v19
    v_accvgpr_read_b32 v19, a56
    v_mul_f32 v19, v19, v25
    v_accvgpr_write_b32 a56, v19
    v_accvgpr_read_b32 v19, a57
    v_mul_f32 v19, v19, v25
    v_accvgpr_write_b32 a57, v19
    v_accvgpr_read_b32 v19, a58
    v_mul_f32 v19, v19, v25
    v_accvgpr_write_b32 a58, v19
    v_accvgpr_read_b32 v19, a59
    v_mul_f32 v19, v19, v25
    v_accvgpr_write_b32 a59, v19
    v_accvgpr_read_b32 v19, a60
    v_mul_f32 v19, v19, v25
    v_accvgpr_write_b32 a60, v19
    v_accvgpr_read_b32 v19, a61
    v_mul_f32 v19, v19, v25
    v_accvgpr_write_b32 a61, v19
    v_accvgpr_read_b32 v19, a62
    v_mul_f32 v19, v19, v25
    v_accvgpr_write_b32 a62, v19
    v_accvgpr_read_b32 v19, a63
    v_mul_f32 v19, v19, v25
    v_accvgpr_write_b32 a63, v19
    v_accvgpr_read_b32 v19, a64
    v_mul_f32 v19, v19, v25
    v_accvgpr_write_b32 a64, v19
    v_accvgpr_read_b32 v19, a65
    v_mul_f32 v19, v19, v25
    v_accvgpr_write_b32 a65, v19
    v_accvgpr_read_b32 v19, a66
    v_mul_f32 v19, v19, v25
    v_accvgpr_write_b32 a66, v19
    v_accvgpr_read_b32 v19, a67
    v_mul_f32 v19, v19, v25
    v_accvgpr_write_b32 a67, v19
    v_accvgpr_read_b32 v19, a68
    v_mul_f32 v19, v19, v25
    v_accvgpr_write_b32 a68, v19
    v_accvgpr_read_b32 v19, a69
    v_mul_f32 v19, v19, v25
    v_accvgpr_write_b32 a69, v19
    v_accvgpr_read_b32 v19, a70
    v_mul_f32 v19, v19, v25
    v_accvgpr_write_b32 a70, v19
    v_accvgpr_read_b32 v19, a71
    v_mul_f32 v19, v19, v25
    v_accvgpr_write_b32 a71, v19
    v_accvgpr_read_b32 v19, a72
    v_mul_f32 v19, v19, v25
    v_accvgpr_write_b32 a72, v19
    v_accvgpr_read_b32 v19, a73
    v_mul_f32 v19, v19, v25
    v_accvgpr_write_b32 a73, v19
    v_accvgpr_read_b32 v19, a74
    v_mul_f32 v19, v19, v25
    v_accvgpr_write_b32 a74, v19
    v_accvgpr_read_b32 v19, a75
    v_mul_f32 v19, v19, v25
    v_accvgpr_write_b32 a75, v19
    v_accvgpr_read_b32 v19, a76
    v_mul_f32 v19, v19, v25
    v_accvgpr_write_b32 a76, v19
    v_accvgpr_read_b32 v19, a77
    v_mul_f32 v19, v19, v25
    v_accvgpr_write_b32 a77, v19
    v_accvgpr_read_b32 v19, a78
    v_mul_f32 v19, v19, v25
    v_accvgpr_write_b32 a78, v19
    v_accvgpr_read_b32 v19, a79
    v_mul_f32 v19, v19, v25
    v_accvgpr_write_b32 a79, v19
    v_accvgpr_read_b32 v19, a80
    v_mul_f32 v19, v19, v25
    v_accvgpr_write_b32 a80, v19
    v_accvgpr_read_b32 v19, a81
    v_mul_f32 v19, v19, v25
    v_accvgpr_write_b32 a81, v19
    v_accvgpr_read_b32 v19, a82
    v_mul_f32 v19, v19, v25
    v_accvgpr_write_b32 a82, v19
    v_accvgpr_read_b32 v19, a83
    v_mul_f32 v19, v19, v25
    v_accvgpr_write_b32 a83, v19
    v_accvgpr_read_b32 v19, a84
    v_mul_f32 v19, v19, v25
    v_accvgpr_write_b32 a84, v19
    v_accvgpr_read_b32 v19, a85
    v_mul_f32 v19, v19, v25
    v_accvgpr_write_b32 a85, v19
    v_accvgpr_read_b32 v19, a86
    v_mul_f32 v19, v19, v25
    v_accvgpr_write_b32 a86, v19
    v_accvgpr_read_b32 v19, a87
    v_mul_f32 v19, v19, v25
    v_accvgpr_write_b32 a87, v19
    v_accvgpr_read_b32 v19, a88
    v_mul_f32 v19, v19, v25
    v_accvgpr_write_b32 a88, v19
    v_accvgpr_read_b32 v19, a89
    v_mul_f32 v19, v19, v25
    v_accvgpr_write_b32 a89, v19
    v_accvgpr_read_b32 v19, a90
    v_mul_f32 v19, v19, v25
    v_accvgpr_write_b32 a90, v19
    v_accvgpr_read_b32 v19, a91
    v_mul_f32 v19, v19, v25
    v_accvgpr_write_b32 a91, v19
    v_accvgpr_read_b32 v19, a92
    v_mul_f32 v19, v19, v25
    v_accvgpr_write_b32 a92, v19
    v_accvgpr_read_b32 v19, a93
    v_mul_f32 v19, v19, v25
    v_accvgpr_write_b32 a93, v19
    v_accvgpr_read_b32 v19, a94
    v_mul_f32 v19, v19, v25
    v_accvgpr_write_b32 a94, v19
    v_accvgpr_read_b32 v19, a95
    v_mul_f32 v19, v19, v25
    v_accvgpr_write_b32 a95, v19
    v_fma_f32 v152, v152, s28, v12
    v_fma_f32 v153, v153, s28, v12
    v_exp_f32 v152, v152
    v_exp_f32 v153, v153
    s_nop 0
    v_cvt_pk_bf16_f32 v32, v152, v153
    v_fma_f32 v154, v154, s28, v12
    v_fma_f32 v155, v155, s28, v12
    v_exp_f32 v154, v154
    v_exp_f32 v155, v155
    s_nop 0
    v_cvt_pk_bf16_f32 v33, v154, v155
    v_fma_f32 v156, v156, s28, v12
    v_fma_f32 v157, v157, s28, v12
    v_exp_f32 v156, v156
    v_exp_f32 v157, v157
    s_nop 0
    v_cvt_pk_bf16_f32 v34, v156, v157
    v_fma_f32 v158, v158, s28, v12
    v_fma_f32 v159, v159, s28, v12
    v_exp_f32 v158, v158
    v_exp_f32 v159, v159
    s_nop 0
    v_cvt_pk_bf16_f32 v35, v158, v159
    v_mfma_f32_16x16x32_bf16 v[44:47], v[52:55], v[14:17], v[48:51]
    v_mfma_f32_16x16x32_bf16 v[44:47], v[56:59], v[20:23], v[44:47]
    v_mfma_f32_16x16x32_bf16 v[44:47], v[60:63], v[26:29], v[44:47]
    v_mfma_f32_16x16x32_bf16 v[44:47], v[64:67], v[32:35], v[44:47]
    s_nop 15
    s_setpc_b64 s[40:41]
L_rare4_1:
    s_nop 15
    v_mbcnt_lo_u32_b32 v27, -1, 0
    v_mbcnt_hi_u32_b32 v27, -1, v27
    v_and_b32 v26, 15, v27
    v_mul_u32_u24 v26, 384, v26
    v_lshrrev_b32 v27, 4, v27
    v_lshl_add_u32 v26, v27, 4, v26
    s_add_u32 s69, s39, 0
    buffer_load_dwordx4 v[48:51], v26, s[4:7], s69 offen offset:0
    s_waitcnt vmcnt(0)
    v_mfma_f32_16x16x32_bf16 v[152:155], v[48:51], a[144:147], 0
    s_nop 7
    buffer_load_dwordx4 v[48:51], v26, s[4:7], s69 offen offset:64
    s_waitcnt vmcnt(0)
    v_mfma_f32_16x16x32_bf16 v[152:155], v[48:51], a[148:151], v[152:155]
    s_nop 7
    buffer_load_dwordx4 v[48:51], v26, s[4:7], s69 offen offset:128
    s_waitcnt vmcnt(0)
    v_mfma_f32_16x16x32_bf16 v[152:155], v[48:51], a[152:155], v[152:155]
    s_nop 7
    buffer_load_dwordx4 v[48:51], v26, s[4:7], s69 offen offset:192
    s_waitcnt vmcnt(0)
    v_mfma_f32_16x16x32_bf16 v[152:155], v[48:51], a[156:159], v[152:155]
    s_nop 7
    buffer_load_dwordx4 v[48:51], v26, s[4:7], s69 offen offset:256
    s_waitcnt vmcnt(0)
    v_mfma_f32_16x16x32_bf16 v[152:155], v[48:51], a[160:163], v[152:155]
    s_nop 7
    buffer_load_dwordx4 v[48:51], v26, s[4:7], s69 offen offset:320
    s_waitcnt vmcnt(0)
    v_mfma_f32_16x16x32_bf16 v[152:155], v[48:51], a[164:167], v[152:155]
    s_nop 7
    s_add_u32 s69, s39, 6144
    buffer_load_dwordx4 v[48:51], v26, s[4:7], s69 offen offset:0
    s_waitcnt vmcnt(0)
    v_mfma_f32_16x16x32_bf16 v[156:159], v[48:51], a[144:147], 0
    s_nop 7
    buffer_load_dwordx4 v[48:51], v26, s[4:7], s69 offen offset:64
    s_waitcnt vmcnt(0)
    v_mfma_f32_16x16x32_bf16 v[156:159], v[48:51], a[148:151], v[156:159]
    s_nop 7
    buffer_load_dwordx4 v[48:51], v26, s[4:7], s69 offen offset:128
    s_waitcnt vmcnt(0)
    v_mfma_f32_16x16x32_bf16 v[156:159], v[48:51], a[152:155], v[156:159]
    s_nop 7
    buffer_load_dwordx4 v[48:51], v26, s[4:7], s69 offen offset:192
    s_waitcnt vmcnt(0)
    v_mfma_f32_16x16x32_bf16 v[156:159], v[48:51], a[156:159], v[156:159]
    s_nop 7
    buffer_load_dwordx4 v[48:51], v26, s[4:7], s69 offen offset:256
    s_waitcnt vmcnt(0)
    v_mfma_f32_16x16x32_bf16 v[156:159], v[48:51], a[160:163], v[156:159]
    s_nop 7
    buffer_load_dwordx4 v[48:51], v26, s[4:7], s69 offen offset:320
    s_waitcnt vmcnt(0)
    v_mfma_f32_16x16x32_bf16 v[156:159], v[48:51], a[164:167], v[156:159]
    s_nop 7
    s_nop 15
    v_max3_f32 v14, v152, v153, v154
    v_max3_f32 v14, v14, v155, v156
    v_max3_f32 v14, v14, v157, v158
    v_max_f32 v14, v14, v159
    v_mov_b32 v15, v14
    s_nop 1
    v_permlane32_swap_b32 v15, v14
    v_max_f32 v14, v14, v15
    v_mov_b32 v15, v14
    s_nop 1
    v_permlane16_swap_b32 v15, v14
    v_max_f32 v14, v14, v15
    v_fma_f32 v14, v14, s28, v9
    v_max_f32 v20, 0, v14
    v_sub_f32 v9, v9, v20
    v_sub_f32 v21, 0, v20
    v_exp_f32 v21, v21
    s_nop 0
    v_mul_f32 v15, v44, v21
    v_cndmask_b32_e64 v44, v15, v44, s[60:61]
    v_cndmask_b32_e64 v44, v44, 0, s[46:47]
    v_mul_f32 v160, v160, v21
    v_mul_f32 v161, v161, v21
    v_mul_f32 v162, v162, v21
    v_mul_f32 v163, v163, v21
    v_mul_f32 v164, v164, v21
    v_mul_f32 v165, v165, v21
    v_mul_f32 v166, v166, v21
    v_mul_f32 v167, v167, v21
    v_mul_f32 v168, v168, v21
    v_mul_f32 v169, v169, v21
    v_mul_f32 v170, v170, v21
    v_mul_f32 v171, v171, v21
    v_mul_f32 v172, v172, v21
    v_mul_f32 v173, v173, v21
    v_mul_f32 v174, v174, v21
    v_mul_f32 v175, v175, v21
    v_mul_f32 v176, v176, v21
    v_mul_f32 v177, v177, v21
    v_mul_f32 v178, v178, v21
    v_mul_f32 v179, v179, v21
    v_mul_f32 v180, v180, v21
    v_mul_f32 v181, v181, v21
    v_mul_f32 v182, v182, v21
    v_mul_f32 v183, v183, v21
    v_mul_f32 v184, v184, v21
    v_mul_f32 v185, v185, v21
    v_mul_f32 v186, v186, v21
    v_mul_f32 v187, v187, v21
    v_mul_f32 v188, v188, v21
    v_mul_f32 v189, v189, v21
    v_mul_f32 v190, v190, v21
    v_mul_f32 v191, v191, v21
    v_mul_f32 v192, v192, v21
    v_mul_f32 v193, v193, v21
    v_mul_f32 v194, v194, v21
    v_mul_f32 v195, v195, v21
    v_mul_f32 v196, v196, v21
    v_mul_f32 v197, v197, v21
    v_mul_f32 v198, v198, v21
    v_mul_f32 v199, v199, v21
    v_mul_f32 v200, v200, v21
    v_mul_f32 v201, v201, v21
    v_mul_f32 v202, v202, v21
    v_mul_f32 v203, v203, v21
    v_mul_f32 v204, v204, v21
    v_mul_f32 v205, v205, v21
    v_mul_f32 v206, v206, v21
    v_mul_f32 v207, v207, v21
    v_fma_f32 v152, v152, s28, v9
    v_fma_f32 v153, v153, s28, v9
    v_exp_f32 v152, v152
    v_exp_f32 v153, v153
    s_nop 0
    v_cvt_pk_bf16_f32 v18, v152, v153
    v_fma_f32 v154, v154, s28, v9
    v_fma_f32 v155, v155, s28, v9
    v_exp_f32 v154, v154
    v_exp_f32 v155, v155
    s_nop 0
    v_cvt_pk_bf16_f32 v19, v154, v155
    v_fma_f32 v156, v156, s28, v9
    v_fma_f32 v157, v157, s28, v9
    v_exp_f32 v156, v156
    v_exp_f32 v157, v157
    s_nop 0
    v_cvt_pk_bf16_f32 v16, v156, v157
    v_fma_f32 v158, v158, s28, v9
    v_fma_f32 v159, v159, s28, v9
    v_exp_f32 v158, v158
    v_exp_f32 v159, v159
    s_nop 0
    v_cvt_pk_bf16_f32 v17, v158, v159
    s_add_u32 s69, s39, 0
    buffer_load_dwordx4 v[48:51], v26, s[4:7], s69 offen offset:0
    s_waitcnt vmcnt(0)
    v_mfma_f32_16x16x32_bf16 v[152:155], v[48:51], a[168:171], 0
    s_nop 7
    buffer_load_dwordx4 v[48:51], v26, s[4:7], s69 offen offset:64
    s_waitcnt vmcnt(0)
    v_mfma_f32_16x16x32_bf16 v[152:155], v[48:51], a[172:175], v[152:155]
    s_nop 7
    buffer_load_dwordx4 v[48:51], v26, s[4:7], s69 offen offset:128
    s_waitcnt vmcnt(0)
    v_mfma_f32_16x16x32_bf16 v[152:155], v[48:51], a[176:179], v[152:155]
    s_nop 7
    buffer_load_dwordx4 v[48:51], v26, s[4:7], s69 offen offset:192
    s_waitcnt vmcnt(0)
    v_mfma_f32_16x16x32_bf16 v[152:155], v[48:51], a[180:183], v[152:155]
    s_nop 7
    buffer_load_dwordx4 v[48:51], v26, s[4:7], s69 offen offset:256
    s_waitcnt vmcnt(0)
    v_mfma_f32_16x16x32_bf16 v[152:155], v[48:51], a[184:187], v[152:155]
    s_nop 7
    buffer_load_dwordx4 v[48:51], v26, s[4:7], s69 offen offset:320
    s_waitcnt vmcnt(0)
    v_mfma_f32_16x16x32_bf16 v[152:155], v[48:51], a[188:191], v[152:155]
    s_nop 7
    s_add_u32 s69, s39, 6144
    buffer_load_dwordx4 v[48:51], v26, s[4:7], s69 offen offset:0
    s_waitcnt vmcnt(0)
    v_mfma_f32_16x16x32_bf16 v[156:159], v[48:51], a[168:171], 0
    s_nop 7
    buffer_load_dwordx4 v[48:51], v26, s[4:7], s69 offen offset:64
    s_waitcnt vmcnt(0)
    v_mfma_f32_16x16x32_bf16 v[156:159], v[48:51], a[172:175], v[156:159]
    s_nop 7
    buffer_load_dwordx4 v[48:51], v26, s[4:7], s69 offen offset:128
    s_waitcnt vmcnt(0)
    v_mfma_f32_16x16x32_bf16 v[156:159], v[48:51], a[176:179], v[156:159]
    s_nop 7
    buffer_load_dwordx4 v[48:51], v26, s[4:7], s69 offen offset:192
    s_waitcnt vmcnt(0)
    v_mfma_f32_16x16x32_bf16 v[156:159], v[48:51], a[180:183], v[156:159]
    s_nop 7
    buffer_load_dwordx4 v[48:51], v26, s[4:7], s69 offen offset:256
    s_waitcnt vmcnt(0)
    v_mfma_f32_16x16x32_bf16 v[156:159], v[48:51], a[184:187], v[156:159]
    s_nop 7
    buffer_load_dwordx4 v[48:51], v26, s[4:7], s69 offen offset:320
    s_waitcnt vmcnt(0)
    v_mfma_f32_16x16x32_bf16 v[156:159], v[48:51], a[188:191], v[156:159]
    s_nop 7
    s_nop 15
    v_max3_f32 v14, v152, v153, v154
    v_max3_f32 v14, v14, v155, v156
    v_max3_f32 v14, v14, v157, v158
    v_max_f32 v14, v14, v159
    v_mov_b32 v15, v14
    s_nop 1
    v_permlane32_swap_b32 v15, v14
    v_max_f32 v14, v14, v15
    v_mov_b32 v15, v14
    s_nop 1
    v_permlane16_swap_b32 v15, v14
    v_max_f32 v14, v14, v15
    v_fma_f32 v14, v14, s28, v10
    v_max_f32 v20, 0, v14
    v_sub_f32 v10, v10, v20
    v_sub_f32 v21, 0, v20
    v_exp_f32 v21, v21
    s_nop 0
    v_mul_f32 v45, v45, v21
    v_mul_f32 v208, v208, v21
    v_mul_f32 v209, v209, v21
    v_mul_f32 v210, v210, v21
    v_mul_f32 v211, v211, v21
    v_mul_f32 v212, v212, v21
    v_mul_f32 v213, v213, v21
    v_mul_f32 v214, v214, v21
    v_mul_f32 v215, v215, v21
    v_mul_f32 v216, v216, v21
    v_mul_f32 v217, v217, v21
    v_mul_f32 v218, v218, v21
    v_mul_f32 v219, v219, v21
    v_mul_f32 v220, v220, v21
    v_mul_f32 v221, v221, v21
    v_mul_f32 v222, v222, v21
    v_mul_f32 v223, v223, v21
    v_mul_f32 v224, v224, v21
    v_mul_f32 v225, v225, v21
    v_mul_f32 v226, v226, v21
    v_mul_f32 v227, v227, v21
    v_mul_f32 v228, v228, v21
    v_mul_f32 v229, v229, v21
    v_mul_f32 v230, v230, v21
    v_mul_f32 v231, v231, v21
    v_mul_f32 v232, v232, v21
    v_mul_f32 v233, v233, v21
    v_mul_f32 v234, v234, v21
    v_mul_f32 v235, v235, v21
    v_mul_f32 v236, v236, v21
    v_mul_f32 v237, v237, v21
    v_mul_f32 v238, v238, v21
    v_mul_f32 v239, v239, v21
    v_mul_f32 v240, v240, v21
    v_mul_f32 v241, v241, v21
    v_mul_f32 v242, v242, v21
    v_mul_f32 v243, v243, v21
    v_mul_f32 v244, v244, v21
    v_mul_f32 v245, v245, v21
    v_mul_f32 v246, v246, v21
    v_mul_f32 v247, v247, v21
    v_mul_f32 v248, v248, v21
    v_mul_f32 v249, v249, v21
    v_mul_f32 v250, v250, v21
    v_mul_f32 v251, v251, v21
    v_mul_f32 v252, v252, v21
    v_mul_f32 v253, v253, v21
    v_mul_f32 v254, v254, v21
    v_mul_f32 v255, v255, v21
    v_fma_f32 v152, v152, s28, v10
    v_fma_f32 v153, v153, s28, v10
    v_exp_f32 v152, v152
    v_exp_f32 v153, v153
    s_nop 0
    v_cvt_pk_bf16_f32 v24, v152, v153
    v_fma_f32 v154, v154, s28, v10
    v_fma_f32 v155, v155, s28, v10
    v_exp_f32 v154, v154
    v_exp_f32 v155, v155
    s_nop 0
    v_cvt_pk_bf16_f32 v25, v154, v155
    v_fma_f32 v156, v156, s28, v10
    v_fma_f32 v157, v157, s28, v10
    v_exp_f32 v156, v156
    v_exp_f32 v157, v157
    s_nop 0
    v_cvt_pk_bf16_f32 v22, v156, v157
    v_fma_f32 v158, v158, s28, v10
    v_fma_f32 v159, v159, s28, v10
    v_exp_f32 v158, v158
    v_exp_f32 v159, v159
    s_nop 0
    v_cvt_pk_bf16_f32 v23, v158, v159
    s_add_u32 s69, s39, 0
    buffer_load_dwordx4 v[48:51], v26, s[4:7], s69 offen offset:0
    s_waitcnt vmcnt(0)
    v_mfma_f32_16x16x32_bf16 v[152:155], v[48:51], a[192:195], 0
    s_nop 7
    buffer_load_dwordx4 v[48:51], v26, s[4:7], s69 offen offset:64
    s_waitcnt vmcnt(0)
    v_mfma_f32_16x16x32_bf16 v[152:155], v[48:51], a[196:199], v[152:155]
    s_nop 7
    buffer_load_dwordx4 v[48:51], v26, s[4:7], s69 offen offset:128
    s_waitcnt vmcnt(0)
    v_mfma_f32_16x16x32_bf16 v[152:155], v[48:51], a[200:203], v[152:155]
    s_nop 7
    buffer_load_dwordx4 v[48:51], v26, s[4:7], s69 offen offset:192
    s_waitcnt vmcnt(0)
    v_mfma_f32_16x16x32_bf16 v[152:155], v[48:51], a[204:207], v[152:155]
    s_nop 7
    buffer_load_dwordx4 v[48:51], v26, s[4:7], s69 offen offset:256
    s_waitcnt vmcnt(0)
    v_mfma_f32_16x16x32_bf16 v[152:155], v[48:51], a[208:211], v[152:155]
    s_nop 7
    buffer_load_dwordx4 v[48:51], v26, s[4:7], s69 offen offset:320
    s_waitcnt vmcnt(0)
    v_mfma_f32_16x16x32_bf16 v[152:155], v[48:51], a[212:215], v[152:155]
    s_nop 7
    s_add_u32 s69, s39, 6144
    buffer_load_dwordx4 v[48:51], v26, s[4:7], s69 offen offset:0
    s_waitcnt vmcnt(0)
    v_mfma_f32_16x16x32_bf16 v[156:159], v[48:51], a[192:195], 0
    s_nop 7
    buffer_load_dwordx4 v[48:51], v26, s[4:7], s69 offen offset:64
    s_waitcnt vmcnt(0)
    v_mfma_f32_16x16x32_bf16 v[156:159], v[48:51], a[196:199], v[156:159]
    s_nop 7
    buffer_load_dwordx4 v[48:51], v26, s[4:7], s69 offen offset:128
    s_waitcnt vmcnt(0)
    v_mfma_f32_16x16x32_bf16 v[156:159], v[48:51], a[200:203], v[156:159]
    s_nop 7
    buffer_load_dwordx4 v[48:51], v26, s[4:7], s69 offen offset:192
    s_waitcnt vmcnt(0)
    v_mfma_f32_16x16x32_bf16 v[156:159], v[48:51], a[204:207], v[156:159]
    s_nop 7
    buffer_load_dwordx4 v[48:51], v26, s[4:7], s69 offen offset:256
    s_waitcnt vmcnt(0)
    v_mfma_f32_16x16x32_bf16 v[156:159], v[48:51], a[208:211], v[156:159]
    s_nop 7
    buffer_load_dwordx4 v[48:51], v26, s[4:7], s69 offen offset:320
    s_waitcnt vmcnt(0)
    v_mfma_f32_16x16x32_bf16 v[156:159], v[48:51], a[212:215], v[156:159]
    s_nop 7
    s_nop 15
    v_max3_f32 v14, v152, v153, v154
    v_max3_f32 v14, v14, v155, v156
    v_max3_f32 v14, v14, v157, v158
    v_max_f32 v14, v14, v159
    v_mov_b32 v15, v14
    s_nop 1
    v_permlane32_swap_b32 v15, v14
    v_max_f32 v14, v14, v15
    v_mov_b32 v15, v14
    s_nop 1
    v_permlane16_swap_b32 v15, v14
    v_max_f32 v14, v14, v15
    v_fma_f32 v14, v14, s28, v11
    v_max_f32 v20, 0, v14
    v_sub_f32 v11, v11, v20
    v_sub_f32 v21, 0, v20
    v_exp_f32 v21, v21
    s_nop 0
    v_mul_f32 v46, v46, v21
    v_accvgpr_read_b32 v15, a0
    v_mul_f32 v15, v15, v21
    v_accvgpr_write_b32 a0, v15
    v_accvgpr_read_b32 v15, a1
    v_mul_f32 v15, v15, v21
    v_accvgpr_write_b32 a1, v15
    v_accvgpr_read_b32 v15, a2
    v_mul_f32 v15, v15, v21
    v_accvgpr_write_b32 a2, v15
    v_accvgpr_read_b32 v15, a3
    v_mul_f32 v15, v15, v21
    v_accvgpr_write_b32 a3, v15
    v_accvgpr_read_b32 v15, a4
    v_mul_f32 v15, v15, v21
    v_accvgpr_write_b32 a4, v15
    v_accvgpr_read_b32 v15, a5
    v_mul_f32 v15, v15, v21
    v_accvgpr_write_b32 a5, v15
    v_accvgpr_read_b32 v15, a6
    v_mul_f32 v15, v15, v21
    v_accvgpr_write_b32 a6, v15
    v_accvgpr_read_b32 v15, a7
    v_mul_f32 v15, v15, v21
    v_accvgpr_write_b32 a7, v15
    v_accvgpr_read_b32 v15, a8
    v_mul_f32 v15, v15, v21
    v_accvgpr_write_b32 a8, v15
    v_accvgpr_read_b32 v15, a9
    v_mul_f32 v15, v15, v21
    v_accvgpr_write_b32 a9, v15
    v_accvgpr_read_b32 v15, a10
    v_mul_f32 v15, v15, v21
    v_accvgpr_write_b32 a10, v15
    v_accvgpr_read_b32 v15, a11
    v_mul_f32 v15, v15, v21
    v_accvgpr_write_b32 a11, v15
    v_accvgpr_read_b32 v15, a12
    v_mul_f32 v15, v15, v21
    v_accvgpr_write_b32 a12, v15
    v_accvgpr_read_b32 v15, a13
    v_mul_f32 v15, v15, v21
    v_accvgpr_write_b32 a13, v15
    v_accvgpr_read_b32 v15, a14
    v_mul_f32 v15, v15, v21
    v_accvgpr_write_b32 a14, v15
    v_accvgpr_read_b32 v15, a15
    v_mul_f32 v15, v15, v21
    v_accvgpr_write_b32 a15, v15
    v_accvgpr_read_b32 v15, a16
    v_mul_f32 v15, v15, v21
    v_accvgpr_write_b32 a16, v15
    v_accvgpr_read_b32 v15, a17
    v_mul_f32 v15, v15, v21
    v_accvgpr_write_b32 a17, v15
    v_accvgpr_read_b32 v15, a18
    v_mul_f32 v15, v15, v21
    v_accvgpr_write_b32 a18, v15
    v_accvgpr_read_b32 v15, a19
    v_mul_f32 v15, v15, v21
    v_accvgpr_write_b32 a19, v15
    v_accvgpr_read_b32 v15, a20
    v_mul_f32 v15, v15, v21
    v_accvgpr_write_b32 a20, v15
    v_accvgpr_read_b32 v15, a21
    v_mul_f32 v15, v15, v21
    v_accvgpr_write_b32 a21, v15
    v_accvgpr_read_b32 v15, a22
    v_mul_f32 v15, v15, v21
    v_accvgpr_write_b32 a22, v15
    v_accvgpr_read_b32 v15, a23
    v_mul_f32 v15, v15, v21
    v_accvgpr_write_b32 a23, v15
    v_accvgpr_read_b32 v15, a24
    v_mul_f32 v15, v15, v21
    v_accvgpr_write_b32 a24, v15
    v_accvgpr_read_b32 v15, a25
    v_mul_f32 v15, v15, v21
    v_accvgpr_write_b32 a25, v15
    v_accvgpr_read_b32 v15, a26
    v_mul_f32 v15, v15, v21
    v_accvgpr_write_b32 a26, v15
    v_accvgpr_read_b32 v15, a27
    v_mul_f32 v15, v15, v21
    v_accvgpr_write_b32 a27, v15
    v_accvgpr_read_b32 v15, a28
    v_mul_f32 v15, v15, v21
    v_accvgpr_write_b32 a28, v15
    v_accvgpr_read_b32 v15, a29
    v_mul_f32 v15, v15, v21
    v_accvgpr_write_b32 a29, v15
    v_accvgpr_read_b32 v15, a30
    v_mul_f32 v15, v15, v21
    v_accvgpr_write_b32 a30, v15
    v_accvgpr_read_b32 v15, a31
    v_mul_f32 v15, v15, v21
    v_accvgpr_write_b32 a31, v15
    v_accvgpr_read_b32 v15, a32
    v_mul_f32 v15, v15, v21
    v_accvgpr_write_b32 a32, v15
    v_accvgpr_read_b32 v15, a33
    v_mul_f32 v15, v15, v21
    v_accvgpr_write_b32 a33, v15
    v_accvgpr_read_b32 v15, a34
    v_mul_f32 v15, v15, v21
    v_accvgpr_write_b32 a34, v15
    v_accvgpr_read_b32 v15, a35
    v_mul_f32 v15, v15, v21
    v_accvgpr_write_b32 a35, v15
    v_accvgpr_read_b32 v15, a36
    v_mul_f32 v15, v15, v21
    v_accvgpr_write_b32 a36, v15
    v_accvgpr_read_b32 v15, a37
    v_mul_f32 v15, v15, v21
    v_accvgpr_write_b32 a37, v15
    v_accvgpr_read_b32 v15, a38
    v_mul_f32 v15, v15, v21
    v_accvgpr_write_b32 a38, v15
    v_accvgpr_read_b32 v15, a39
    v_mul_f32 v15, v15, v21
    v_accvgpr_write_b32 a39, v15
    v_accvgpr_read_b32 v15, a40
    v_mul_f32 v15, v15, v21
    v_accvgpr_write_b32 a40, v15
    v_accvgpr_read_b32 v15, a41
    v_mul_f32 v15, v15, v21
    v_accvgpr_write_b32 a41, v15
    v_accvgpr_read_b32 v15, a42
    v_mul_f32 v15, v15, v21
    v_accvgpr_write_b32 a42, v15
    v_accvgpr_read_b32 v15, a43
    v_mul_f32 v15, v15, v21
    v_accvgpr_write_b32 a43, v15
    v_accvgpr_read_b32 v15, a44
    v_mul_f32 v15, v15, v21
    v_accvgpr_write_b32 a44, v15
    v_accvgpr_read_b32 v15, a45
    v_mul_f32 v15, v15, v21
    v_accvgpr_write_b32 a45, v15
    v_accvgpr_read_b32 v15, a46
    v_mul_f32 v15, v15, v21
    v_accvgpr_write_b32 a46, v15
    v_accvgpr_read_b32 v15, a47
    v_mul_f32 v15, v15, v21
    v_accvgpr_write_b32 a47, v15
    v_fma_f32 v152, v152, s28, v11
    v_fma_f32 v153, v153, s28, v11
    v_exp_f32 v152, v152
    v_exp_f32 v153, v153
    s_nop 0
    v_cvt_pk_bf16_f32 v30, v152, v153
    v_fma_f32 v154, v154, s28, v11
    v_fma_f32 v155, v155, s28, v11
    v_exp_f32 v154, v154
    v_exp_f32 v155, v155
    s_nop 0
    v_cvt_pk_bf16_f32 v31, v154, v155
    v_fma_f32 v156, v156, s28, v11
    v_fma_f32 v157, v157, s28, v11
    v_exp_f32 v156, v156
    v_exp_f32 v157, v157
    s_nop 0
    v_cvt_pk_bf16_f32 v28, v156, v157
    v_fma_f32 v158, v158, s28, v11
    v_fma_f32 v159, v159, s28, v11
    v_exp_f32 v158, v158
    v_exp_f32 v159, v159
    s_nop 0
    v_cvt_pk_bf16_f32 v29, v158, v159
    s_add_u32 s69, s39, 0
    buffer_load_dwordx4 v[48:51], v26, s[4:7], s69 offen offset:0
    s_waitcnt vmcnt(0)
    v_mfma_f32_16x16x32_bf16 v[152:155], v[48:51], a[216:219], 0
    s_nop 7
    buffer_load_dwordx4 v[48:51], v26, s[4:7], s69 offen offset:64
    s_waitcnt vmcnt(0)
    v_mfma_f32_16x16x32_bf16 v[152:155], v[48:51], a[220:223], v[152:155]
    s_nop 7
    buffer_load_dwordx4 v[48:51], v26, s[4:7], s69 offen offset:128
    s_waitcnt vmcnt(0)
    v_mfma_f32_16x16x32_bf16 v[152:155], v[48:51], a[224:227], v[152:155]
    s_nop 7
    buffer_load_dwordx4 v[48:51], v26, s[4:7], s69 offen offset:192
    s_waitcnt vmcnt(0)
    v_mfma_f32_16x16x32_bf16 v[152:155], v[48:51], a[228:231], v[152:155]
    s_nop 7
    buffer_load_dwordx4 v[48:51], v26, s[4:7], s69 offen offset:256
    s_waitcnt vmcnt(0)
    v_mfma_f32_16x16x32_bf16 v[152:155], v[48:51], a[232:235], v[152:155]
    s_nop 7
    buffer_load_dwordx4 v[48:51], v26, s[4:7], s69 offen offset:320
    s_waitcnt vmcnt(0)
    v_mfma_f32_16x16x32_bf16 v[152:155], v[48:51], a[236:239], v[152:155]
    s_nop 7
    s_add_u32 s69, s39, 6144
    buffer_load_dwordx4 v[48:51], v26, s[4:7], s69 offen offset:0
    s_waitcnt vmcnt(0)
    v_mfma_f32_16x16x32_bf16 v[156:159], v[48:51], a[216:219], 0
    s_nop 7
    buffer_load_dwordx4 v[48:51], v26, s[4:7], s69 offen offset:64
    s_waitcnt vmcnt(0)
    v_mfma_f32_16x16x32_bf16 v[156:159], v[48:51], a[220:223], v[156:159]
    s_nop 7
    buffer_load_dwordx4 v[48:51], v26, s[4:7], s69 offen offset:128
    s_waitcnt vmcnt(0)
    v_mfma_f32_16x16x32_bf16 v[156:159], v[48:51], a[224:227], v[156:159]
    s_nop 7
    buffer_load_dwordx4 v[48:51], v26, s[4:7], s69 offen offset:192
    s_waitcnt vmcnt(0)
    v_mfma_f32_16x16x32_bf16 v[156:159], v[48:51], a[228:231], v[156:159]
    s_nop 7
    buffer_load_dwordx4 v[48:51], v26, s[4:7], s69 offen offset:256
    s_waitcnt vmcnt(0)
    v_mfma_f32_16x16x32_bf16 v[156:159], v[48:51], a[232:235], v[156:159]
    s_nop 7
    buffer_load_dwordx4 v[48:51], v26, s[4:7], s69 offen offset:320
    s_waitcnt vmcnt(0)
    v_mfma_f32_16x16x32_bf16 v[156:159], v[48:51], a[236:239], v[156:159]
    s_nop 7
    s_nop 15
    v_max3_f32 v14, v152, v153, v154
    v_max3_f32 v14, v14, v155, v156
    v_max3_f32 v14, v14, v157, v158
    v_max_f32 v14, v14, v159
    v_mov_b32 v15, v14
    s_nop 1
    v_permlane32_swap_b32 v15, v14
    v_max_f32 v14, v14, v15
    v_mov_b32 v15, v14
    s_nop 1
    v_permlane16_swap_b32 v15, v14
    v_max_f32 v14, v14, v15
    v_fma_f32 v14, v14, s28, v12
    v_max_f32 v20, 0, v14
    v_sub_f32 v12, v12, v20
    v_sub_f32 v21, 0, v20
    v_exp_f32 v21, v21
    s_nop 0
    v_mul_f32 v47, v47, v21
    v_accvgpr_read_b32 v15, a48
    v_mul_f32 v15, v15, v21
    v_accvgpr_write_b32 a48, v15
    v_accvgpr_read_b32 v15, a49
    v_mul_f32 v15, v15, v21
    v_accvgpr_write_b32 a49, v15
    v_accvgpr_read_b32 v15, a50
    v_mul_f32 v15, v15, v21
    v_accvgpr_write_b32 a50, v15
    v_accvgpr_read_b32 v15, a51
    v_mul_f32 v15, v15, v21
    v_accvgpr_write_b32 a51, v15
    v_accvgpr_read_b32 v15, a52
    v_mul_f32 v15, v15, v21
    v_accvgpr_write_b32 a52, v15
    v_accvgpr_read_b32 v15, a53
    v_mul_f32 v15, v15, v21
    v_accvgpr_write_b32 a53, v15
    v_accvgpr_read_b32 v15, a54
    v_mul_f32 v15, v15, v21
    v_accvgpr_write_b32 a54, v15
    v_accvgpr_read_b32 v15, a55
    v_mul_f32 v15, v15, v21
    v_accvgpr_write_b32 a55, v15
    v_accvgpr_read_b32 v15, a56
    v_mul_f32 v15, v15, v21
    v_accvgpr_write_b32 a56, v15
    v_accvgpr_read_b32 v15, a57
    v_mul_f32 v15, v15, v21
    v_accvgpr_write_b32 a57, v15
    v_accvgpr_read_b32 v15, a58
    v_mul_f32 v15, v15, v21
    v_accvgpr_write_b32 a58, v15
    v_accvgpr_read_b32 v15, a59
    v_mul_f32 v15, v15, v21
    v_accvgpr_write_b32 a59, v15
    v_accvgpr_read_b32 v15, a60
    v_mul_f32 v15, v15, v21
    v_accvgpr_write_b32 a60, v15
    v_accvgpr_read_b32 v15, a61
    v_mul_f32 v15, v15, v21
    v_accvgpr_write_b32 a61, v15
    v_accvgpr_read_b32 v15, a62
    v_mul_f32 v15, v15, v21
    v_accvgpr_write_b32 a62, v15
    v_accvgpr_read_b32 v15, a63
    v_mul_f32 v15, v15, v21
    v_accvgpr_write_b32 a63, v15
    v_accvgpr_read_b32 v15, a64
    v_mul_f32 v15, v15, v21
    v_accvgpr_write_b32 a64, v15
    v_accvgpr_read_b32 v15, a65
    v_mul_f32 v15, v15, v21
    v_accvgpr_write_b32 a65, v15
    v_accvgpr_read_b32 v15, a66
    v_mul_f32 v15, v15, v21
    v_accvgpr_write_b32 a66, v15
    v_accvgpr_read_b32 v15, a67
    v_mul_f32 v15, v15, v21
    v_accvgpr_write_b32 a67, v15
    v_accvgpr_read_b32 v15, a68
    v_mul_f32 v15, v15, v21
    v_accvgpr_write_b32 a68, v15
    v_accvgpr_read_b32 v15, a69
    v_mul_f32 v15, v15, v21
    v_accvgpr_write_b32 a69, v15
    v_accvgpr_read_b32 v15, a70
    v_mul_f32 v15, v15, v21
    v_accvgpr_write_b32 a70, v15
    v_accvgpr_read_b32 v15, a71
    v_mul_f32 v15, v15, v21
    v_accvgpr_write_b32 a71, v15
    v_accvgpr_read_b32 v15, a72
    v_mul_f32 v15, v15, v21
    v_accvgpr_write_b32 a72, v15
    v_accvgpr_read_b32 v15, a73
    v_mul_f32 v15, v15, v21
    v_accvgpr_write_b32 a73, v15
    v_accvgpr_read_b32 v15, a74
    v_mul_f32 v15, v15, v21
    v_accvgpr_write_b32 a74, v15
    v_accvgpr_read_b32 v15, a75
    v_mul_f32 v15, v15, v21
    v_accvgpr_write_b32 a75, v15
    v_accvgpr_read_b32 v15, a76
    v_mul_f32 v15, v15, v21
    v_accvgpr_write_b32 a76, v15
    v_accvgpr_read_b32 v15, a77
    v_mul_f32 v15, v15, v21
    v_accvgpr_write_b32 a77, v15
    v_accvgpr_read_b32 v15, a78
    v_mul_f32 v15, v15, v21
    v_accvgpr_write_b32 a78, v15
    v_accvgpr_read_b32 v15, a79
    v_mul_f32 v15, v15, v21
    v_accvgpr_write_b32 a79, v15
    v_accvgpr_read_b32 v15, a80
    v_mul_f32 v15, v15, v21
    v_accvgpr_write_b32 a80, v15
    v_accvgpr_read_b32 v15, a81
    v_mul_f32 v15, v15, v21
    v_accvgpr_write_b32 a81, v15
    v_accvgpr_read_b32 v15, a82
    v_mul_f32 v15, v15, v21
    v_accvgpr_write_b32 a82, v15
    v_accvgpr_read_b32 v15, a83
    v_mul_f32 v15, v15, v21
    v_accvgpr_write_b32 a83, v15
    v_accvgpr_read_b32 v15, a84
    v_mul_f32 v15, v15, v21
    v_accvgpr_write_b32 a84, v15
    v_accvgpr_read_b32 v15, a85
    v_mul_f32 v15, v15, v21
    v_accvgpr_write_b32 a85, v15
    v_accvgpr_read_b32 v15, a86
    v_mul_f32 v15, v15, v21
    v_accvgpr_write_b32 a86, v15
    v_accvgpr_read_b32 v15, a87
    v_mul_f32 v15, v15, v21
    v_accvgpr_write_b32 a87, v15
    v_accvgpr_read_b32 v15, a88
    v_mul_f32 v15, v15, v21
    v_accvgpr_write_b32 a88, v15
    v_accvgpr_read_b32 v15, a89
    v_mul_f32 v15, v15, v21
    v_accvgpr_write_b32 a89, v15
    v_accvgpr_read_b32 v15, a90
    v_mul_f32 v15, v15, v21
    v_accvgpr_write_b32 a90, v15
    v_accvgpr_read_b32 v15, a91
    v_mul_f32 v15, v15, v21
    v_accvgpr_write_b32 a91, v15
    v_accvgpr_read_b32 v15, a92
    v_mul_f32 v15, v15, v21
    v_accvgpr_write_b32 a92, v15
    v_accvgpr_read_b32 v15, a93
    v_mul_f32 v15, v15, v21
    v_accvgpr_write_b32 a93, v15
    v_accvgpr_read_b32 v15, a94
    v_mul_f32 v15, v15, v21
    v_accvgpr_write_b32 a94, v15
    v_accvgpr_read_b32 v15, a95
    v_mul_f32 v15, v15, v21
    v_accvgpr_write_b32 a95, v15
    v_fma_f32 v152, v152, s28, v12
    v_fma_f32 v153, v153, s28, v12
    v_exp_f32 v152, v152
    v_exp_f32 v153, v153
    s_nop 0
    v_cvt_pk_bf16_f32 v36, v152, v153
    v_fma_f32 v154, v154, s28, v12
    v_fma_f32 v155, v155, s28, v12
    v_exp_f32 v154, v154
    v_exp_f32 v155, v155
    s_nop 0
    v_cvt_pk_bf16_f32 v37, v154, v155
    v_fma_f32 v156, v156, s28, v12
    v_fma_f32 v157, v157, s28, v12
    v_exp_f32 v156, v156
    v_exp_f32 v157, v157
    s_nop 0
    v_cvt_pk_bf16_f32 v34, v156, v157
    v_fma_f32 v158, v158, s28, v12
    v_fma_f32 v159, v159, s28, v12
    v_exp_f32 v158, v158
    v_exp_f32 v159, v159
    s_nop 0
    v_cvt_pk_bf16_f32 v35, v158, v159
    v_mfma_f32_16x16x32_bf16 v[48:51], v[52:55], v[16:19], v[44:47]
    v_mfma_f32_16x16x32_bf16 v[48:51], v[56:59], v[22:25], v[48:51]
    v_mfma_f32_16x16x32_bf16 v[48:51], v[60:63], v[28:31], v[48:51]
    v_mfma_f32_16x16x32_bf16 v[48:51], v[64:67], v[34:37], v[48:51]
    s_nop 15
    s_setpc_b64 s[40:41]
L_rs_start5b:
    s_call_b64 s[40:41], L_rare5_1
    s_branch L_ret_start5b
L_rs_loop5w0a:
    s_call_b64 s[40:41], L_rare5_0
    s_branch L_ret_loop5w0a
L_rs_loop5w0b:
    s_call_b64 s[40:41], L_rare5_1
    s_branch L_ret_loop5w0b
L_rs_end5a:
    s_call_b64 s[40:41], L_rare5_0
    s_branch L_ret_end5a
L_rs_end5b:
    s_call_b64 s[40:41], L_rare5_1
    s_branch L_ret_end5b
L_rs_start4b:
    s_call_b64 s[40:41], L_rare4_1
    s_branch L_ret_start4b
L_rs_loop4w0a:
    s_call_b64 s[40:41], L_rare4_0
    s_branch L_ret_loop4w0a
L_rs_loop4w0b:
    s_call_b64 s[40:41], L_rare4_1
    s_branch L_ret_loop4w0b
L_rs_end4a:
    s_call_b64 s[40:41], L_rare4_0
    s_branch L_ret_end4a
L_rs_end4b:
    s_call_b64 s[40:41], L_rare4_1
    s_branch L_ret_end4b
L_rs_tr54a:
    s_call_b64 s[40:41], L_rare5_0
    s_branch L_ret_tr54a
L_rs_tr54b:
    s_nop 15
    s_waitcnt vmcnt(0) lgkmcnt(0)
    s_mov_b32 s68, s14
    s_mov_b32 s14, 166723584
    v_mbcnt_lo_u32_b32 v153, -1, 0
    v_mbcnt_hi_u32_b32 v153, -1, v153
    v_and_b32 v152, 15, v153
    v_mul_u32_u24 v152, 384, v152
    v_lshrrev_b32 v153, 4, v153
    v_lshl_add_u32 v152, v153, 4, v152
    s_add_u32 s69, s34, 0
    buffer_load_dwordx4 a[144:147], v152, s[12:15], s69 offen offset:0
    buffer_load_dwordx4 a[148:151], v152, s[12:15], s69 offen offset:64
    buffer_load_dwordx4 a[152:155], v152, s[12:15], s69 offen offset:128
    buffer_load_dwordx4 a[156:159], v152, s[12:15], s69 offen offset:192
    buffer_load_dwordx4 a[160:163], v152, s[12:15], s69 offen offset:256
    buffer_load_dwordx4 a[164:167], v152, s[12:15], s69 offen offset:320
    s_add_u32 s69, s34, 6144
    buffer_load_dwordx4 a[168:171], v152, s[12:15], s69 offen offset:0
    buffer_load_dwordx4 a[172:175], v152, s[12:15], s69 offen offset:64
    buffer_load_dwordx4 a[176:179], v152, s[12:15], s69 offen offset:128
    buffer_load_dwordx4 a[180:183], v152, s[12:15], s69 offen offset:192
    buffer_load_dwordx4 a[184:187], v152, s[12:15], s69 offen offset:256
    buffer_load_dwordx4 a[188:191], v152, s[12:15], s69 offen offset:320
    s_add_u32 s69, s34, 12288
    buffer_load_dwordx4 a[192:195], v152, s[12:15], s69 offen offset:0
    buffer_load_dwordx4 a[196:199], v152, s[12:15], s69 offen offset:64
    buffer_load_dwordx4 a[200:203], v152, s[12:15], s69 offen offset:128
    buffer_load_dwordx4 a[204:207], v152, s[12:15], s69 offen offset:192
    buffer_load_dwordx4 a[208:211], v152, s[12:15], s69 offen offset:256
    buffer_load_dwordx4 a[212:215], v152, s[12:15], s69 offen offset:320
    s_add_u32 s69, s34, 18432
    buffer_load_dwordx4 a[216:219], v152, s[12:15], s69 offen offset:0
    buffer_load_dwordx4 a[220:223], v152, s[12:15], s69 offen offset:64
    buffer_load_dwordx4 a[224:227], v152, s[12:15], s69 offen offset:128
    buffer_load_dwordx4 a[228:231], v152, s[12:15], s69 offen offset:192
    buffer_load_dwordx4 a[232:235], v152, s[12:15], s69 offen offset:256
    buffer_load_dwordx4 a[236:239], v152, s[12:15], s69 offen offset:320
    s_add_u32 s69, s34, 24576
    buffer_load_dwordx4 a[240:243], v152, s[12:15], s69 offen offset:0
    buffer_load_dwordx4 a[244:247], v152, s[12:15], s69 offen offset:64
    buffer_load_dwordx4 a[248:251], v152, s[12:15], s69 offen offset:128
    buffer_load_dwordx4 a[252:255], v152, s[12:15], s69 offen offset:192
    buffer_load_dwordx4 v[136:139], v152, s[12:15], s69 offen offset:256
    buffer_load_dwordx4 v[140:143], v152, s[12:15], s69 offen offset:320
    s_waitcnt vmcnt(0)
    s_call_b64 s[40:41], L_rare5_1
    v_mbcnt_lo_u32_b32 v153, -1, 0
    v_mbcnt_hi_u32_b32 v153, -1, v153
    v_and_b32 v152, 15, v153
    v_mul_u32_u24 v152, 384, v152
    v_lshrrev_b32 v153, 4, v153
    v_lshl_add_u32 v152, v153, 4, v152
    s_add_u32 s69, s33, 0
    buffer_load_dwordx4 a[144:147], v152, s[12:15], s69 offen offset:0
    buffer_load_dwordx4 a[148:151], v152, s[12:15], s69 offen offset:64
    buffer_load_dwordx4 a[152:155], v152, s[12:15], s69 offen offset:128
    buffer_load_dwordx4 a[156:159], v152, s[12:15], s69 offen offset:192
    buffer_load_dwordx4 a[160:163], v152, s[12:15], s69 offen offset:256
    buffer_load_dwordx4 a[164:167], v152, s[12:15], s69 offen offset:320
    s_add_u32 s69, s33, 6144
    buffer_load_dwordx4 a[168:171], v152, s[12:15], s69 offen offset:0
    buffer_load_dwordx4 a[172:175], v152, s[12:15], s69 offen offset:64
    buffer_load_dwordx4 a[176:179], v152, s[12:15], s69 offen offset:128
    buffer_load_dwordx4 a[180:183], v152, s[12:15], s69 offen offset:192
    buffer_load_dwordx4 a[184:187], v152, s[12:15], s69 offen offset:256
    buffer_load_dwordx4 a[188:191], v152, s[12:15], s69 offen offset:320
    s_add_u32 s69, s33, 12288
    buffer_load_dwordx4 a[192:195], v152, s[12:15], s69 offen offset:0
    buffer_load_dwordx4 a[196:199], v152, s[12:15], s69 offen offset:64
    buffer_load_dwordx4 a[200:203], v152, s[12:15], s69 offen offset:128
    buffer_load_dwordx4 a[204:207], v152, s[12:15], s69 offen offset:192
    buffer_load_dwordx4 a[208:211], v152, s[12:15], s69 offen offset:256
    buffer_load_dwordx4 a[212:215], v152, s[12:15], s69 offen offset:320
    s_add_u32 s69, s33, 18432
    buffer_load_dwordx4 a[216:219], v152, s[12:15], s69 offen offset:0
    buffer_load_dwordx4 a[220:223], v152, s[12:15], s69 offen offset:64
    buffer_load_dwordx4 a[224:227], v152, s[12:15], s69 offen offset:128
    buffer_load_dwordx4 a[228:231], v152, s[12:15], s69 offen offset:192
    buffer_load_dwordx4 a[232:235], v152, s[12:15], s69 offen offset:256
    buffer_load_dwordx4 a[236:239], v152, s[12:15], s69 offen offset:320
    s_waitcnt vmcnt(0)
    s_mov_b32 s14, s68
    s_branch L_ret_tr54b
L_rs_tr54d:
    s_call_b64 s[40:41], L_rare4_1
    s_branch L_ret_tr54d
L_rs_tr45a:
    s_call_b64 s[40:41], L_rare4_0
    s_branch L_ret_tr45a
L_rs_tr45b:
    s_nop 15
    s_waitcnt vmcnt(0) lgkmcnt(0)
    s_mov_b32 s68, s14
    s_mov_b32 s14, 166723584
    v_mbcnt_lo_u32_b32 v153, -1, 0
    v_mbcnt_hi_u32_b32 v153, -1, v153
    v_and_b32 v152, 15, v153
    v_mul_u32_u24 v152, 384, v152
    v_lshrrev_b32 v153, 4, v153
    v_lshl_add_u32 v152, v153, 4, v152
    s_add_u32 s69, s34, 0
    buffer_load_dwordx4 a[144:147], v152, s[12:15], s69 offen offset:0
    buffer_load_dwordx4 a[148:151], v152, s[12:15], s69 offen offset:64
    buffer_load_dwordx4 a[152:155], v152, s[12:15], s69 offen offset:128
    buffer_load_dwordx4 a[156:159], v152, s[12:15], s69 offen offset:192
    buffer_load_dwordx4 a[160:163], v152, s[12:15], s69 offen offset:256
    buffer_load_dwordx4 a[164:167], v152, s[12:15], s69 offen offset:320
    s_add_u32 s69, s34, 6144
    buffer_load_dwordx4 a[168:171], v152, s[12:15], s69 offen offset:0
    buffer_load_dwordx4 a[172:175], v152, s[12:15], s69 offen offset:64
    buffer_load_dwordx4 a[176:179], v152, s[12:15], s69 offen offset:128
    buffer_load_dwordx4 a[180:183], v152, s[12:15], s69 offen offset:192
    buffer_load_dwordx4 a[184:187], v152, s[12:15], s69 offen offset:256
    buffer_load_dwordx4 a[188:191], v152, s[12:15], s69 offen offset:320
    s_add_u32 s69, s34, 12288
    buffer_load_dwordx4 a[192:195], v152, s[12:15], s69 offen offset:0
    buffer_load_dwordx4 a[196:199], v152, s[12:15], s69 offen offset:64
    buffer_load_dwordx4 a[200:203], v152, s[12:15], s69 offen offset:128
    buffer_load_dwordx4 a[204:207], v152, s[12:15], s69 offen offset:192
    buffer_load_dwordx4 a[208:211], v152, s[12:15], s69 offen offset:256
    buffer_load_dwordx4 a[212:215], v152, s[12:15], s69 offen offset:320
    s_add_u32 s69, s34, 18432
    buffer_load_dwordx4 a[216:219], v152, s[12:15], s69 offen offset:0
    buffer_load_dwordx4 a[220:223], v152, s[12:15], s69 offen offset:64
    buffer_load_dwordx4 a[224:227], v152, s[12:15], s69 offen offset:128
    buffer_load_dwordx4 a[228:231], v152, s[12:15], s69 offen offset:192
    buffer_load_dwordx4 a[232:235], v152, s[12:15], s69 offen offset:256
    buffer_load_dwordx4 a[236:239], v152, s[12:15], s69 offen offset:320
    s_waitcnt vmcnt(0)
    s_call_b64 s[40:41], L_rare4_1
    v_mbcnt_lo_u32_b32 v153, -1, 0
    v_mbcnt_hi_u32_b32 v153, -1, v153
    v_and_b32 v152, 15, v153
    v_mul_u32_u24 v152, 384, v152
    v_lshrrev_b32 v153, 4, v153
    v_lshl_add_u32 v152, v153, 4, v152
    s_add_u32 s69, s33, 0
    buffer_load_dwordx4 a[144:147], v152, s[12:15], s69 offen offset:0
    buffer_load_dwordx4 a[148:151], v152, s[12:15], s69 offen offset:64
    buffer_load_dwordx4 a[152:155], v152, s[12:15], s69 offen offset:128
    buffer_load_dwordx4 a[156:159], v152, s[12:15], s69 offen offset:192
    buffer_load_dwordx4 a[160:163], v152, s[12:15], s69 offen offset:256
    buffer_load_dwordx4 a[164:167], v152, s[12:15], s69 offen offset:320
    s_add_u32 s69, s33, 6144
    buffer_load_dwordx4 a[168:171], v152, s[12:15], s69 offen offset:0
    buffer_load_dwordx4 a[172:175], v152, s[12:15], s69 offen offset:64
    buffer_load_dwordx4 a[176:179], v152, s[12:15], s69 offen offset:128
    buffer_load_dwordx4 a[180:183], v152, s[12:15], s69 offen offset:192
    buffer_load_dwordx4 a[184:187], v152, s[12:15], s69 offen offset:256
    buffer_load_dwordx4 a[188:191], v152, s[12:15], s69 offen offset:320
    s_add_u32 s69, s33, 12288
    buffer_load_dwordx4 a[192:195], v152, s[12:15], s69 offen offset:0
    buffer_load_dwordx4 a[196:199], v152, s[12:15], s69 offen offset:64
    buffer_load_dwordx4 a[200:203], v152, s[12:15], s69 offen offset:128
    buffer_load_dwordx4 a[204:207], v152, s[12:15], s69 offen offset:192
    buffer_load_dwordx4 a[208:211], v152, s[12:15], s69 offen offset:256
    buffer_load_dwordx4 a[212:215], v152, s[12:15], s69 offen offset:320
    s_add_u32 s69, s33, 18432
    buffer_load_dwordx4 a[216:219], v152, s[12:15], s69 offen offset:0
    buffer_load_dwordx4 a[220:223], v152, s[12:15], s69 offen offset:64
    buffer_load_dwordx4 a[224:227], v152, s[12:15], s69 offen offset:128
    buffer_load_dwordx4 a[228:231], v152, s[12:15], s69 offen offset:192
    buffer_load_dwordx4 a[232:235], v152, s[12:15], s69 offen offset:256
    buffer_load_dwordx4 a[236:239], v152, s[12:15], s69 offen offset:320
    s_add_u32 s69, s33, 24576
    buffer_load_dwordx4 a[240:243], v152, s[12:15], s69 offen offset:0
    buffer_load_dwordx4 a[244:247], v152, s[12:15], s69 offen offset:64
    buffer_load_dwordx4 a[248:251], v152, s[12:15], s69 offen offset:128
    buffer_load_dwordx4 a[252:255], v152, s[12:15], s69 offen offset:192
    buffer_load_dwordx4 v[136:139], v152, s[12:15], s69 offen offset:256
    buffer_load_dwordx4 v[140:143], v152, s[12:15], s69 offen offset:320
    s_waitcnt vmcnt(0)
    s_mov_b32 s14, s68
    s_branch L_ret_tr45b
L_rs_tr45d:
    s_call_b64 s[40:41], L_rare5_1
    s_branch L_ret_tr45d
L_rs_tr44a:
    s_call_b64 s[40:41], L_rare4_0
    s_branch L_ret_tr44a
L_rs_tr44b:
    s_nop 15
    s_waitcnt vmcnt(0) lgkmcnt(0)
    s_mov_b32 s68, s14
    s_mov_b32 s14, 166723584
    v_mbcnt_lo_u32_b32 v153, -1, 0
    v_mbcnt_hi_u32_b32 v153, -1, v153
    v_and_b32 v152, 15, v153
    v_mul_u32_u24 v152, 384, v152
    v_lshrrev_b32 v153, 4, v153
    v_lshl_add_u32 v152, v153, 4, v152
    s_add_u32 s69, s34, 0
    buffer_load_dwordx4 a[144:147], v152, s[12:15], s69 offen offset:0
    buffer_load_dwordx4 a[148:151], v152, s[12:15], s69 offen offset:64
    buffer_load_dwordx4 a[152:155], v152, s[12:15], s69 offen offset:128
    buffer_load_dwordx4 a[156:159], v152, s[12:15], s69 offen offset:192
    buffer_load_dwordx4 a[160:163], v152, s[12:15], s69 offen offset:256
    buffer_load_dwordx4 a[164:167], v152, s[12:15], s69 offen offset:320
    s_add_u32 s69, s34, 6144
    buffer_load_dwordx4 a[168:171], v152, s[12:15], s69 offen offset:0
    buffer_load_dwordx4 a[172:175], v152, s[12:15], s69 offen offset:64
    buffer_load_dwordx4 a[176:179], v152, s[12:15], s69 offen offset:128
    buffer_load_dwordx4 a[180:183], v152, s[12:15], s69 offen offset:192
    buffer_load_dwordx4 a[184:187], v152, s[12:15], s69 offen offset:256
    buffer_load_dwordx4 a[188:191], v152, s[12:15], s69 offen offset:320
    s_add_u32 s69, s34, 12288
    buffer_load_dwordx4 a[192:195], v152, s[12:15], s69 offen offset:0
    buffer_load_dwordx4 a[196:199], v152, s[12:15], s69 offen offset:64
    buffer_load_dwordx4 a[200:203], v152, s[12:15], s69 offen offset:128
    buffer_load_dwordx4 a[204:207], v152, s[12:15], s69 offen offset:192
    buffer_load_dwordx4 a[208:211], v152, s[12:15], s69 offen offset:256
    buffer_load_dwordx4 a[212:215], v152, s[12:15], s69 offen offset:320
    s_add_u32 s69, s34, 18432
    buffer_load_dwordx4 a[216:219], v152, s[12:15], s69 offen offset:0
    buffer_load_dwordx4 a[220:223], v152, s[12:15], s69 offen offset:64
    buffer_load_dwordx4 a[224:227], v152, s[12:15], s69 offen offset:128
    buffer_load_dwordx4 a[228:231], v152, s[12:15], s69 offen offset:192
    buffer_load_dwordx4 a[232:235], v152, s[12:15], s69 offen offset:256
    buffer_load_dwordx4 a[236:239], v152, s[12:15], s69 offen offset:320
    s_waitcnt vmcnt(0)
    s_call_b64 s[40:41], L_rare4_1
    v_mbcnt_lo_u32_b32 v153, -1, 0
    v_mbcnt_hi_u32_b32 v153, -1, v153
    v_and_b32 v152, 15, v153
    v_mul_u32_u24 v152, 384, v152
    v_lshrrev_b32 v153, 4, v153
    v_lshl_add_u32 v152, v153, 4, v152
    s_add_u32 s69, s33, 0
    buffer_load_dwordx4 a[144:147], v152, s[12:15], s69 offen offset:0
    buffer_load_dwordx4 a[148:151], v152, s[12:15], s69 offen offset:64
    buffer_load_dwordx4 a[152:155], v152, s[12:15], s69 offen offset:128
    buffer_load_dwordx4 a[156:159], v152, s[12:15], s69 offen offset:192
    buffer_load_dwordx4 a[160:163], v152, s[12:15], s69 offen offset:256
    buffer_load_dwordx4 a[164:167], v152, s[12:15], s69 offen offset:320
    s_add_u32 s69, s33, 6144
    buffer_load_dwordx4 a[168:171], v152, s[12:15], s69 offen offset:0
    buffer_load_dwordx4 a[172:175], v152, s[12:15], s69 offen offset:64
    buffer_load_dwordx4 a[176:179], v152, s[12:15], s69 offen offset:128
    buffer_load_dwordx4 a[180:183], v152, s[12:15], s69 offen offset:192
    buffer_load_dwordx4 a[184:187], v152, s[12:15], s69 offen offset:256
    buffer_load_dwordx4 a[188:191], v152, s[12:15], s69 offen offset:320
    s_add_u32 s69, s33, 12288
    buffer_load_dwordx4 a[192:195], v152, s[12:15], s69 offen offset:0
    buffer_load_dwordx4 a[196:199], v152, s[12:15], s69 offen offset:64
    buffer_load_dwordx4 a[200:203], v152, s[12:15], s69 offen offset:128
    buffer_load_dwordx4 a[204:207], v152, s[12:15], s69 offen offset:192
    buffer_load_dwordx4 a[208:211], v152, s[12:15], s69 offen offset:256
    buffer_load_dwordx4 a[212:215], v152, s[12:15], s69 offen offset:320
    s_add_u32 s69, s33, 18432
    buffer_load_dwordx4 a[216:219], v152, s[12:15], s69 offen offset:0
    buffer_load_dwordx4 a[220:223], v152, s[12:15], s69 offen offset:64
    buffer_load_dwordx4 a[224:227], v152, s[12:15], s69 offen offset:128
    buffer_load_dwordx4 a[228:231], v152, s[12:15], s69 offen offset:192
    buffer_load_dwordx4 a[232:235], v152, s[12:15], s69 offen offset:256
    buffer_load_dwordx4 a[236:239], v152, s[12:15], s69 offen offset:320
    s_waitcnt vmcnt(0)
    s_mov_b32 s14, s68
    s_branch L_ret_tr44b
L_rs_tr44d:
    s_call_b64 s[40:41], L_rare4_1
    s_branch L_ret_tr44d
L_rs_tr55a:
    s_call_b64 s[40:41], L_rare5_0
    s_branch L_ret_tr55a
L_rs_tr55b:
    s_nop 15
    s_waitcnt vmcnt(0) lgkmcnt(0)
    s_mov_b32 s68, s14
    s_mov_b32 s14, 166723584
    v_mbcnt_lo_u32_b32 v153, -1, 0
    v_mbcnt_hi_u32_b32 v153, -1, v153
    v_and_b32 v152, 15, v153
    v_mul_u32_u24 v152, 384, v152
    v_lshrrev_b32 v153, 4, v153
    v_lshl_add_u32 v152, v153, 4, v152
    s_add_u32 s69, s34, 0
    buffer_load_dwordx4 a[144:147], v152, s[12:15], s69 offen offset:0
    buffer_load_dwordx4 a[148:151], v152, s[12:15], s69 offen offset:64
    buffer_load_dwordx4 a[152:155], v152, s[12:15], s69 offen offset:128
    buffer_load_dwordx4 a[156:159], v152, s[12:15], s69 offen offset:192
    buffer_load_dwordx4 a[160:163], v152, s[12:15], s69 offen offset:256
    buffer_load_dwordx4 a[164:167], v152, s[12:15], s69 offen offset:320
    s_add_u32 s69, s34, 6144
    buffer_load_dwordx4 a[168:171], v152, s[12:15], s69 offen offset:0
    buffer_load_dwordx4 a[172:175], v152, s[12:15], s69 offen offset:64
    buffer_load_dwordx4 a[176:179], v152, s[12:15], s69 offen offset:128
    buffer_load_dwordx4 a[180:183], v152, s[12:15], s69 offen offset:192
    buffer_load_dwordx4 a[184:187], v152, s[12:15], s69 offen offset:256
    buffer_load_dwordx4 a[188:191], v152, s[12:15], s69 offen offset:320
    s_add_u32 s69, s34, 12288
    buffer_load_dwordx4 a[192:195], v152, s[12:15], s69 offen offset:0
    buffer_load_dwordx4 a[196:199], v152, s[12:15], s69 offen offset:64
    buffer_load_dwordx4 a[200:203], v152, s[12:15], s69 offen offset:128
    buffer_load_dwordx4 a[204:207], v152, s[12:15], s69 offen offset:192
    buffer_load_dwordx4 a[208:211], v152, s[12:15], s69 offen offset:256
    buffer_load_dwordx4 a[212:215], v152, s[12:15], s69 offen offset:320
    s_add_u32 s69, s34, 18432
    buffer_load_dwordx4 a[216:219], v152, s[12:15], s69 offen offset:0
    buffer_load_dwordx4 a[220:223], v152, s[12:15], s69 offen offset:64
    buffer_load_dwordx4 a[224:227], v152, s[12:15], s69 offen offset:128
    buffer_load_dwordx4 a[228:231], v152, s[12:15], s69 offen offset:192
    buffer_load_dwordx4 a[232:235], v152, s[12:15], s69 offen offset:256
    buffer_load_dwordx4 a[236:239], v152, s[12:15], s69 offen offset:320
    s_add_u32 s69, s34, 24576
    buffer_load_dwordx4 a[240:243], v152, s[12:15], s69 offen offset:0
    buffer_load_dwordx4 a[244:247], v152, s[12:15], s69 offen offset:64
    buffer_load_dwordx4 a[248:251], v152, s[12:15], s69 offen offset:128
    buffer_load_dwordx4 a[252:255], v152, s[12:15], s69 offen offset:192
    buffer_load_dwordx4 v[136:139], v152, s[12:15], s69 offen offset:256
    buffer_load_dwordx4 v[140:143], v152, s[12:15], s69 offen offset:320
    s_waitcnt vmcnt(0)
    s_call_b64 s[40:41], L_rare5_1
    v_mbcnt_lo_u32_b32 v153, -1, 0
    v_mbcnt_hi_u32_b32 v153, -1, v153
    v_and_b32 v152, 15, v153
    v_mul_u32_u24 v152, 384, v152
    v_lshrrev_b32 v153, 4, v153
    v_lshl_add_u32 v152, v153, 4, v152
    s_add_u32 s69, s33, 0
    buffer_load_dwordx4 a[144:147], v152, s[12:15], s69 offen offset:0
    buffer_load_dwordx4 a[148:151], v152, s[12:15], s69 offen offset:64
    buffer_load_dwordx4 a[152:155], v152, s[12:15], s69 offen offset:128
    buffer_load_dwordx4 a[156:159], v152, s[12:15], s69 offen offset:192
    buffer_load_dwordx4 a[160:163], v152, s[12:15], s69 offen offset:256
    buffer_load_dwordx4 a[164:167], v152, s[12:15], s69 offen offset:320
    s_add_u32 s69, s33, 6144
    buffer_load_dwordx4 a[168:171], v152, s[12:15], s69 offen offset:0
    buffer_load_dwordx4 a[172:175], v152, s[12:15], s69 offen offset:64
    buffer_load_dwordx4 a[176:179], v152, s[12:15], s69 offen offset:128
    buffer_load_dwordx4 a[180:183], v152, s[12:15], s69 offen offset:192
    buffer_load_dwordx4 a[184:187], v152, s[12:15], s69 offen offset:256
    buffer_load_dwordx4 a[188:191], v152, s[12:15], s69 offen offset:320
    s_add_u32 s69, s33, 12288
    buffer_load_dwordx4 a[192:195], v152, s[12:15], s69 offen offset:0
    buffer_load_dwordx4 a[196:199], v152, s[12:15], s69 offen offset:64
    buffer_load_dwordx4 a[200:203], v152, s[12:15], s69 offen offset:128
    buffer_load_dwordx4 a[204:207], v152, s[12:15], s69 offen offset:192
    buffer_load_dwordx4 a[208:211], v152, s[12:15], s69 offen offset:256
    buffer_load_dwordx4 a[212:215], v152, s[12:15], s69 offen offset:320
    s_add_u32 s69, s33, 18432
    buffer_load_dwordx4 a[216:219], v152, s[12:15], s69 offen offset:0
    buffer_load_dwordx4 a[220:223], v152, s[12:15], s69 offen offset:64
    buffer_load_dwordx4 a[224:227], v152, s[12:15], s69 offen offset:128
    buffer_load_dwordx4 a[228:231], v152, s[12:15], s69 offen offset:192
    buffer_load_dwordx4 a[232:235], v152, s[12:15], s69 offen offset:256
    buffer_load_dwordx4 a[236:239], v152, s[12:15], s69 offen offset:320
    s_add_u32 s69, s33, 24576
    buffer_load_dwordx4 a[240:243], v152, s[12:15], s69 offen offset:0
    buffer_load_dwordx4 a[244:247], v152, s[12:15], s69 offen offset:64
    buffer_load_dwordx4 a[248:251], v152, s[12:15], s69 offen offset:128
    buffer_load_dwordx4 a[252:255], v152, s[12:15], s69 offen offset:192
    buffer_load_dwordx4 v[136:139], v152, s[12:15], s69 offen offset:256
    buffer_load_dwordx4 v[140:143], v152, s[12:15], s69 offen offset:320
    s_waitcnt vmcnt(0)
    s_mov_b32 s14, s68
    s_branch L_ret_tr55b
L_rs_tr55d:
    s_call_b64 s[40:41], L_rare5_1
    s_branch L_ret_tr55d
.section .rodata,"a"
.p2align 6
.amdhsa_kernel standalone__gqa_softmax__near_ridge_kernel
  .amdhsa_next_free_vgpr 512
  .amdhsa_next_free_sgpr 102
  .amdhsa_accum_offset 256
  .amdhsa_group_segment_fixed_size 0
  .amdhsa_kernarg_size 48
  .amdhsa_user_sgpr_count 2
  .amdhsa_user_sgpr_kernarg_segment_ptr 1
  .amdhsa_system_sgpr_workgroup_id_x 1
.end_amdhsa_kernel
```

```asm
; @launch grid=(256,1,1) block=(256,1,1) lds=163840
.amdgcn_target "amdgcn-amd-amdhsa--gfx950"
.text
.globl standalone__gqa_softmax__near_ridge_kernel
.p2align 8
.type standalone__gqa_softmax__near_ridge_kernel,@function
standalone__gqa_softmax__near_ridge_kernel:
    s_cmp_ge_u32 s2, 256
    s_cbranch_scc1 L_end
    s_load_dwordx4 s[84:87], s[0:1], 0
    s_load_dwordx4 s[88:91], s[0:1], 16
    v_lshrrev_b32 v110, 6, v0
    v_and_b32 v111, 63, v0
    s_getpc_b64 s[60:61]
L_pc:
    s_lshr_b32 s62, s2, 3
    v_lshl_add_u32 v53, s62, 2, v110
    v_min_u32 v52, ((L_codeend-L_pc+16383)/16384)-1, v111
    v_mul_u32_u24 v53, ((L_codeend-L_pc+16383)/16384), v53
    v_add_lshl_u32 v52, v52, v53, 7
    v_min_u32 v52, L_codeend-L_pc-4, v52
    global_load_dword v53, v52, s[60:61]
    v_readfirstlane_b32 s3, v110
    v_lshrrev_b32 v96, 3, v111
    v_mul_u32_u24 v7, 384, v96
    v_lshrrev_b32 v97, 1, v96
    v_lshlrev_b32 v97, 1, v97
    v_and_b32 v98, 7, v111
    v_xor_b32 v97, v97, v98
    v_lshl_add_u32 v7, v97, 4, v7
    s_and_b32 s65, s3, 1
    s_mul_i32 s42, s65, 80
    s_mul_i32 s43, s65, 3072
    v_xor_b32 v6, s42, v7
    v_xor_b32 v7, 80, v6
    v_add_u32 v6, s43, v6
    s_sub_u32 s43, 3072, s43
    v_add_u32 v7, s43, v7
    s_mov_b32 s28, 0x3dd53b95
    s_mov_b32 s29, 0x4e800000
    s_mov_b32 s49, 5888
    s_mov_b32 s46, 0
    s_mov_b32 s47, 0xffff0000
    s_and_b32 s42, s2, 7
    s_lshr_b32 s43, s2, 3
    s_mul_i32 s44, s43, 43
    s_lshr_b32 s44, s44, 7
    s_mov_b32 s39, s44
    s_mul_i32 s45, s44, 3
    s_sub_u32 s36, s43, s45
    s_lshl_b32 s42, s42, 6
    s_lshl_b32 s45, s45, 1
    s_add_u32 s42, s42, s45
    s_mul_i32 s64, s42, 196608
    s_mul_i32 s35, s42, 325632
    s_lshr_b32 s42, s44, 1
    s_mov_b32 s31, 0x6900924
    s_cmp_eq_u32 s42, 1
    s_cselect_b32 s31, 0x14a0489, s31
    s_cmp_eq_u32 s42, 2
    s_cselect_b32 s31, 0x8250258, s31
    s_cmp_eq_u32 s42, 3
    s_cselect_b32 s31, 0x8940912, s31
    s_cmp_eq_u32 s42, 4
    s_cselect_b32 s31, 0x1a10606, s31
    s_and_b32 s42, s44, 1
    s_lshl_b32 s42, s42, 4
    s_lshr_b32 s31, s31, s42
    s_and_b32 s31, s31, 0xffff
    s_cmp_eq_u32 s43, 30
    s_cselect_b32 s31, 0x120648, s31
    s_cmp_eq_u32 s43, 31
    s_cselect_b32 s31, 0x240219, s31
    s_lshr_b32 s63, s31, 16
    s_cmp_ge_u32 s43, 30
    s_cselect_b32 s36, 0, s36
    s_cselect_b32 s42, 4, 6
    s_mul_i32 s42, s42, 196608
    s_add_u32 s6, s64, s42
    s_mov_b32 s10, s6
    s_mul_i32 s22, s3, 3072
    s_mul_i32 s38, s3, 28672
    s_add_u32 s38, s38, 49152
    s_and_b32 s42, s3, 2
    s_mul_i32 s42, s42, 3072
    s_add_u32 s20, s64, s42
    s_mov_b32 s21, s20
    s_mov_b32 s14, 166723584
    s_mov_b32 s18, 0
    s_mov_b32 s67, 0
    s_mov_b32 s37, 0
    s_mov_b32 s60, 0
    s_mov_b32 s61, 0xffff
    s_lshl_b32 s42, s37, 1
    s_lshr_b32 s42, s31, s42
    s_and_b32 s42, s42, 3
    s_add_u32 s42, s42, s36
    s_sub_u32 s43, s42, 3
    s_cmp_ge_u32 s42, 3
    s_cselect_b32 s42, s43, s42
    s_mul_i32 s44, s3, 5
    s_mov_b32 s32, 1
    s_lshl_b32 s43, s3, 2
    s_add_u32 s45, s43, 21
    s_cmp_eq_u32 s3, 0
    s_cselect_b32 s45, 20, s45
    s_cselect_b32 s34, 1, 0
    s_cmp_eq_u32 s42, 1
    s_cselect_b32 s44, s45, s44
    s_cselect_b32 s32, s34, s32
    s_add_u32 s45, s43, 37
    s_cmp_eq_u32 s42, 2
    s_cselect_b32 s44, s45, s44
    s_cselect_b32 s32, 0, s32
    s_mul_i32 s44, s44, 6144
    s_add_u32 s34, s35, s44
    s_waitcnt lgkmcnt(0)
    s_mov_b32 s12, s84
    s_and_b32 s13, s85, 0xffff
    s_mov_b32 s15, 0x20000
    s_mov_b32 s4, s86
    s_and_b32 s5, s87, 0xffff
    s_mov_b32 s7, 0x20000
    s_mov_b32 s8, s88
    s_and_b32 s9, s89, 0xffff
    s_mov_b32 s11, 0x20000
    s_mov_b32 s16, s90
    s_and_b32 s17, s91, 0xffff
    s_mov_b32 s19, 0x20000
    s_cmp_eq_u32 s32, 0
    s_cbranch_scc1 L_start4
L_start5:
    s_add_u32 m0, s22, 0
    s_nop 0
    buffer_load_dwordx4 v6, s[4:7], s20 offen lds
    s_add_u32 s20, s20, 128
    s_add_u32 m0, s22, 1024
    s_nop 0
    buffer_load_dwordx4 v6, s[4:7], s20 offen lds
    s_add_u32 s20, s20, 128
    s_add_u32 m0, s22, 2048
    s_nop 0
    buffer_load_dwordx4 v6, s[4:7], s20 offen lds
    s_add_u32 s20, s20, 12032
    s_add_u32 m0, s22, 12288
    s_nop 0
    buffer_load_dwordx4 v6, s[4:7], s20 offen lds
    s_add_u32 s20, s20, 128
    s_add_u32 m0, s22, 13312
    s_nop 0
    buffer_load_dwordx4 v6, s[4:7], s20 offen lds
    s_add_u32 s20, s20, 128
    s_add_u32 m0, s22, 14336
    s_nop 0
    buffer_load_dwordx4 v6, s[4:7], s20 offen lds
    s_add_u32 s20, s20, 12032
    s_add_u32 s48, s34, 0
    s_add_u32 m0, s38, 0
    s_nop 0
    buffer_load_dwordx4 v6, s[12:15], s48 offen nt lds
    s_add_u32 m0, s38, 1024
    s_nop 0
    buffer_load_dwordx4 v7, s[12:15], s48 offen nt lds
    s_add_u32 s48, s34, 128
    s_add_u32 m0, s38, 2048
    s_nop 0
    buffer_load_dwordx4 v6, s[12:15], s48 offen nt lds
    s_add_u32 m0, s38, 3072
    s_nop 0
    buffer_load_dwordx4 v7, s[12:15], s48 offen nt lds
    s_add_u32 s48, s34, 256
    s_add_u32 m0, s38, 4096
    s_nop 0
    buffer_load_dwordx4 v6, s[12:15], s48 offen nt lds
    s_add_u32 m0, s38, 5120
    s_nop 0
    buffer_load_dwordx4 v7, s[12:15], s48 offen nt lds
    s_add_u32 s48, s34, 6144
    s_add_u32 m0, s38, 6144
    s_nop 0
    buffer_load_dwordx4 v6, s[12:15], s48 offen nt lds
    s_add_u32 m0, s38, 7168
    s_nop 0
    buffer_load_dwordx4 v7, s[12:15], s48 offen nt lds
    s_add_u32 s48, s34, 6272
    s_add_u32 m0, s38, 8192
    s_nop 0
    buffer_load_dwordx4 v6, s[12:15], s48 offen nt lds
    s_add_u32 m0, s38, 9216
    s_nop 0
    buffer_load_dwordx4 v7, s[12:15], s48 offen nt lds
    s_add_u32 s48, s34, 6400
    s_add_u32 m0, s38, 10240
    s_nop 0
    buffer_load_dwordx4 v6, s[12:15], s48 offen nt lds
    s_add_u32 m0, s38, 11264
    s_nop 0
    buffer_load_dwordx4 v7, s[12:15], s48 offen nt lds
    s_add_u32 s48, s34, 12288
    s_add_u32 m0, s38, 12288
    s_nop 0
    buffer_load_dwordx4 v6, s[12:15], s48 offen nt lds
    s_add_u32 m0, s38, 13312
    s_nop 0
    buffer_load_dwordx4 v7, s[12:15], s48 offen nt lds
    s_add_u32 s48, s34, 12416
    s_add_u32 m0, s38, 14336
    s_nop 0
    buffer_load_dwordx4 v6, s[12:15], s48 offen nt lds
    s_add_u32 m0, s38, 15360
    s_nop 0
    buffer_load_dwordx4 v7, s[12:15], s48 offen nt lds
    s_add_u32 s48, s34, 12544
    s_add_u32 m0, s38, 16384
    s_nop 0
    buffer_load_dwordx4 v6, s[12:15], s48 offen nt lds
    s_add_u32 m0, s38, 17408
    s_nop 0
    buffer_load_dwordx4 v7, s[12:15], s48 offen nt lds
    v_and_b32 v96, 15, v111
    v_lshrrev_b32 v97, 4, v111
    v_lshrrev_b32 v98, 3, v96
    v_and_b32 v99, 7, v96
    v_lshlrev_b32 v0, 7, v99
    v_bfe_u32 v99, v96, 1, 2
    v_lshlrev_b32 v99, 1, v99
    v_mul_u32_u24 v100, 5, v98
    v_xor_b32 v99, v99, v100
    v_xor_b32 v99, v99, v97
    v_lshl_add_u32 v0, v99, 4, v0
    v_mul_u32_u24 v100, 3072, v98
    v_add_u32 v0, v100, v0
    v_xor_b32 v1, 64, v0
    v_lshrrev_b32 v98, 1, v97
    v_mul_u32_u24 v2, 3072, v98
    v_and_b32 v99, 1, v97
    v_bfe_u32 v100, v111, 2, 2
    v_lshl_add_u32 v96, v99, 2, v100
    v_lshl_add_u32 v2, v96, 7, v2
    v_lshrrev_b32 v96, 1, v96
    v_lshlrev_b32 v96, 1, v96
    v_mul_u32_u24 v98, 5, v98
    v_xor_b32 v96, v96, v98
    v_bfe_u32 v99, v111, 1, 1
    v_xor_b32 v96, v96, v99
    v_lshl_add_u32 v2, v96, 4, v2
    v_and_b32 v99, 1, v111
    v_lshl_add_u32 v2, v99, 3, v2
    v_add_u32 v2, 24576, v2
    v_xor_b32 v3, 32, v2
    v_xor_b32 v4, 64, v2
    v_xor_b32 v5, 96, v2
    v_lshl_add_u32 v8, v111, 4, s38
    v_lshrrev_b32 v96, 3, v111
    v_bfe_u32 v97, v111, 0, 3
    v_and_b32 v98, 3, v96
    v_lshlrev_b32 v98, 1, v98
    v_xor_b32 v97, v97, v98
    v_xor_b32 v97, s65, v97
    v_mul_u32_u24 v102, 384, v96
    v_lshl_add_u32 v102, v97, 4, v102
    v_xor_b32 v103, 16, v102
    s_mul_i32 s42, s65, 3072
    v_add_u32 v102, s42, v102
    s_sub_u32 s42, 3072, s42
    v_add_u32 v103, s42, v103
    v_and_b32 v96, 15, v111
    s_mov_b32 s42, 0x1011
    v_bfe_i32 v97, s42, v96, 1
    v_and_b32 v97, 0x3f803f80, v97
    v_accvgpr_write_b32 a236, v97
    v_accvgpr_write_b32 a237, v97
    v_accvgpr_write_b32 a238, v97
    v_accvgpr_write_b32 a239, v97
    s_mov_b32 s42, 0x3222
    v_bfe_i32 v97, s42, v96, 1
    v_and_b32 v97, 0x3f803f80, v97
    v_accvgpr_write_b32 a240, v97
    v_accvgpr_write_b32 a241, v97
    v_accvgpr_write_b32 a242, v97
    v_accvgpr_write_b32 a243, v97
    s_mov_b32 s42, 0x5444
    v_bfe_i32 v97, s42, v96, 1
    v_and_b32 v97, 0x3f803f80, v97
    v_accvgpr_write_b32 a244, v97
    v_accvgpr_write_b32 a245, v97
    v_accvgpr_write_b32 a246, v97
    v_accvgpr_write_b32 a247, v97
    s_mov_b32 s42, 0x9888
    v_bfe_i32 v97, s42, v96, 1
    v_and_b32 v97, 0x3f803f80, v97
    v_accvgpr_write_b32 a248, v97
    v_accvgpr_write_b32 a249, v97
    v_accvgpr_write_b32 a250, v97
    v_accvgpr_write_b32 a251, v97
    s_mov_b32 s42, 0x1100
    v_bfe_i32 v97, s42, v96, 1
    v_and_b32 v97, 0x3f803f80, v97
    v_accvgpr_write_b32 a252, v97
    v_accvgpr_write_b32 a253, v97
    v_accvgpr_write_b32 a254, v97
    v_accvgpr_write_b32 a255, v97
    s_waitcnt vmcnt(18)
    s_barrier
    s_waitcnt vmcnt(12)
    s_add_u32 s48, s34, 18432
    s_add_u32 m0, s38, 18432
    ds_read_b128 a[228:231], v0 offset:2048
    buffer_load_dwordx4 v6, s[12:15], s48 offen nt lds
    s_add_u32 m0, s38, 19456
    ds_read_b128 a[212:215], v0 offset:0
    ds_read_b128 a[216:219], v1 offset:0
    buffer_load_dwordx4 v7, s[12:15], s48 offen nt lds
    v_and_b32 v104, 0x3ff, v0
    s_add_u32 s48, s34, 18560
    s_add_u32 m0, s38, 20480
    s_nop 0
    buffer_load_dwordx4 v6, s[12:15], s48 offen nt lds
    ds_read_b128 a[224:227], v1 offset:1024
    v_lshrrev_b32 v105, 11, v0
    v_mbcnt_lo_u32_b32 v107, -1, 0
    v_xor_b32 v105, s65, v105
    s_add_u32 m0, s38, 21504
    v_mbcnt_hi_u32_b32 v107, -1, v107
    buffer_load_dwordx4 v7, s[12:15], s48 offen nt lds
    v_lshl_add_u32 v104, v105, 10, v104
    v_add_u32 v104, s38, v104
    s_add_u32 s48, s34, 18688
    ds_read_b128 a[112:115], v104 offset:4096
    s_add_u32 m0, s38, 22528
    s_nop 0
    buffer_load_dwordx4 v6, s[12:15], s48 offen nt lds
    v_xor_b32 v105, 64, v104
    v_and_b32 v106, 15, v107
    ds_read_b128 a[100:103], v105 offset:0
    ds_read_b128 a[104:107], v104 offset:2048
    s_add_u32 m0, s38, 23552
    s_nop 0
    buffer_load_dwordx4 v7, s[12:15], s48 offen nt lds
    ds_read_b128 a[96:99], v104 offset:0
    s_waitcnt lgkmcnt(0)
    v_mfma_f32_16x16x32_bf16 v[52:55], a[212:215], a[96:99], 0
    ds_read_b128 a[220:223], v0 offset:1024
    v_mul_u32_u24 v106, 384, v106
    ds_read_b128 a[212:215], v0 offset:6144
    v_mfma_f32_16x16x32_bf16 v[52:55], a[216:219], a[100:103], v[52:55]
    ds_read_b128 a[108:111], v105 offset:2048
    s_waitcnt lgkmcnt(2)
    v_mfma_f32_16x16x32_bf16 v[52:55], a[220:223], a[104:107], v[52:55]
    ds_read_b128 a[116:119], v105 offset:4096
    s_waitcnt lgkmcnt(1)
    v_mfma_f32_16x16x32_bf16 v[52:55], a[224:227], a[108:111], v[52:55]
    ds_read_b128 a[232:235], v1 offset:2048
    v_lshrrev_b32 v107, 4, v107
    v_mfma_f32_16x16x32_bf16 v[52:55], a[228:231], a[112:115], v[52:55]
    ds_read_b128 a[216:219], v1 offset:6144
    s_waitcnt lgkmcnt(1)
    v_mfma_f32_16x16x32_bf16 v[52:55], a[232:235], a[116:119], v[52:55]
    ds_read_b128 a[228:231], v0 offset:8192
    v_mfma_f32_16x16x32_bf16 v[56:59], a[212:215], a[96:99], 0
    s_waitcnt lgkmcnt(1)
    ds_read_b128 a[220:223], v0 offset:7168
    ds_read_b128 a[232:235], v1 offset:8192
    v_mfma_f32_16x16x32_bf16 v[56:59], a[216:219], a[100:103], v[56:59]
    ds_read_b128 a[224:227], v1 offset:7168
    s_waitcnt lgkmcnt(2)
    v_mfma_f32_16x16x32_bf16 v[56:59], a[220:223], a[104:107], v[56:59]
    ds_read_b128 a[212:215], v0 offset:12288
    s_waitcnt lgkmcnt(1)
    v_mfma_f32_16x16x32_bf16 v[56:59], a[224:227], a[108:111], v[56:59]
    ds_read_b128 a[220:223], v0 offset:13312
    v_mfma_f32_16x16x32_bf16 v[56:59], a[228:231], a[112:115], v[56:59]
    ds_read_b128 a[228:231], v0 offset:14336
    v_mfma_f32_16x16x32_bf16 v[56:59], a[232:235], a[116:119], v[56:59]
    v_max3_f32 v96, v52, v53, v54
    s_nop 6
    v_max3_f32 v96, v96, v55, v56
    v_max3_f32 v96, v96, v57, v58
    v_max_f32 v96, v96, v59
    v_mov_b32 v97, v96
    s_nop 1
    v_permlane32_swap_b32 v97, v96
    v_max_f32 v96, v96, v97
    v_mov_b32 v97, v96
    ds_read_b128 a[232:235], v1 offset:14336
    s_nop 0
    v_permlane16_swap_b32 v97, v96
    v_max_f32 v96, v96, v97
    v_mul_f32_e64 v9, -s28, v96
    v_fma_f32 v54, v54, s28, v9
    v_fma_f32 v58, v58, s28, v9
    v_fma_f32 v52, v52, s28, v9
    v_exp_f32 v58, v58
    v_fma_f32 v59, v59, s28, v9
    v_fma_f32 v55, v55, s28, v9
    v_exp_f32 v52, v52
    v_fma_f32 v53, v53, s28, v9
    ds_read_b128 a[216:219], v1 offset:12288
    v_exp_f32 v59, v59
    v_lshl_add_u32 v106, v107, 4, v106
    v_exp_f32 v54, v54
    v_exp_f32 v55, v55
    v_fma_f32 v56, v56, s28, v9
    v_cvt_pk_bf16_f32 v17, v58, v59
    v_exp_f32 v53, v53
    ds_read_b128 a[224:227], v1 offset:13312
    v_cvt_pk_bf16_f32 v14, v52, v53
    v_cvt_pk_bf16_f32 v15, v54, v55
    s_waitcnt vmcnt(12)
    s_add_u32 s48, s34, 24576
    s_add_u32 m0, s38, 24576
    s_nop 0
    buffer_load_dwordx4 v6, s[12:15], s48 offen nt lds
    s_add_u32 m0, s38, 25600
    s_waitcnt lgkmcnt(0)
    v_mfma_f32_16x16x32_bf16 v[52:55], a[212:215], a[96:99], 0
    buffer_load_dwordx4 v7, s[12:15], s48 offen nt lds
    ds_read_b128 a[140:143], v105 offset:10240
    v_mfma_f32_16x16x32_bf16 v[52:55], a[216:219], a[100:103], v[52:55]
    s_add_u32 s48, s34, 24704
    s_add_u32 m0, s38, 26624
    ds_read_b128 a[216:219], v1 offset:18432
    v_fma_f32 v57, v57, s28, v9
    buffer_load_dwordx4 v6, s[12:15], s48 offen nt lds
    v_mfma_f32_16x16x32_bf16 v[52:55], a[220:223], a[104:107], v[52:55]
    s_add_u32 m0, s38, 27648
    ds_read_b128 a[120:123], v104 offset:6144
    buffer_load_dwordx4 v7, s[12:15], s48 offen nt lds
    v_exp_f32 v57, v57
    v_mfma_f32_16x16x32_bf16 v[52:55], a[224:227], a[108:111], v[52:55]
    s_add_u32 s48, s34, 24576
    ds_read_b128 a[124:127], v105 offset:6144
    ds_read_b128 a[212:215], v0 offset:18432
    v_exp_f32 v56, v56
    v_mfma_f32_16x16x32_bf16 v[52:55], a[228:231], a[112:115], v[52:55]
    ds_read_b128 a[132:135], v105 offset:8192
    buffer_load_dwordx4 a[208:211], v106, s[12:15], s48 offen offset:256 nt
    v_mfma_f32_16x16x32_bf16 v[52:55], a[232:235], a[116:119], v[52:55]
    v_cvt_pk_bf16_f32 v16, v56, v57
    ds_read_b128 a[232:235], v1 offset:20480
    ds_read_b128 a[224:227], v1 offset:19456
    buffer_load_dwordx4 v[92:95], v106, s[12:15], s48 offen offset:320 nt
    s_waitcnt lgkmcnt(3)
    v_mfma_f32_16x16x32_bf16 v[56:59], a[212:215], a[96:99], 0
    ds_read_b128 a[220:223], v0 offset:19456
    v_mfma_f32_16x16x32_bf16 v[56:59], a[216:219], a[100:103], v[56:59]
    ds_read_b128 a[228:231], v0 offset:20480
    ds_read_b128 a[136:139], v104 offset:10240
    s_waitcnt lgkmcnt(2)
    v_mfma_f32_16x16x32_bf16 v[56:59], a[220:223], a[104:107], v[56:59]
    ds_read_b128 a[212:215], v0 offset:0
    v_mfma_f32_16x16x32_bf16 v[56:59], a[224:227], a[108:111], v[56:59]
    s_waitcnt lgkmcnt(1)
    ds_read_b128 a[216:219], v1 offset:0
    v_mfma_f32_16x16x32_bf16 v[56:59], a[228:231], a[112:115], v[56:59]
    ds_read_b128 a[220:223], v0 offset:1024
    v_mfma_f32_16x16x32_bf16 v[56:59], a[232:235], a[116:119], v[56:59]
    ds_read_b128 a[228:231], v0 offset:2048
    s_waitcnt lgkmcnt(3)
    v_mfma_f32_16x16x32_bf16 v[60:63], a[212:215], a[120:123], 0
    ds_read_b128 a[128:131], v104 offset:8192
    s_waitcnt lgkmcnt(3)
    v_mfma_f32_16x16x32_bf16 v[60:63], a[216:219], a[124:127], v[60:63]
    ds_read_b128 a[224:227], v1 offset:1024
    s_waitcnt lgkmcnt(1)
    v_mfma_f32_16x16x32_bf16 v[60:63], a[220:223], a[128:131], v[60:63]
    ds_read_b128 a[212:215], v0 offset:6144
    s_waitcnt lgkmcnt(1)
    v_mfma_f32_16x16x32_bf16 v[60:63], a[224:227], a[132:135], v[60:63]
    ds_read_b128 a[232:235], v1 offset:2048
    v_mfma_f32_16x16x32_bf16 v[60:63], a[228:231], a[136:139], v[60:63]
    ds_read_b128 a[216:219], v1 offset:6144
    s_waitcnt lgkmcnt(1)
    v_mfma_f32_16x16x32_bf16 v[60:63], a[232:235], a[140:143], v[60:63]
    ds_read_b128 a[228:231], v0 offset:8192
    v_mfma_f32_16x16x32_bf16 v[64:67], a[212:215], a[120:123], 0
    s_waitcnt lgkmcnt(1)
    ds_read_b128 a[220:223], v0 offset:7168
    v_mfma_f32_16x16x32_bf16 v[64:67], a[216:219], a[124:127], v[64:67]
    ds_read_b128 a[224:227], v1 offset:7168
    s_waitcnt lgkmcnt(1)
    v_mfma_f32_16x16x32_bf16 v[64:67], a[220:223], a[128:131], v[64:67]
    v_max3_f32 v98, v60, v61, v62
    ds_read_b128 a[232:235], v1 offset:8192
    s_waitcnt lgkmcnt(1)
    v_mfma_f32_16x16x32_bf16 v[64:67], a[224:227], a[132:135], v[64:67]
    v_fma_f32 v55, v55, s28, v9
    ds_read_b128 a[216:219], v1 offset:12288
    v_mfma_f32_16x16x32_bf16 v[64:67], a[228:231], a[136:139], v[64:67]
    ds_read_b128 a[212:215], v0 offset:12288
    s_waitcnt lgkmcnt(2)
    v_mfma_f32_16x16x32_bf16 v[64:67], a[232:235], a[140:143], v[64:67]
    v_exp_f32 v55, v55
    s_nop 6
    v_max3_f32 v98, v98, v63, v64
    v_max3_f32 v98, v98, v65, v66
    v_max_f32 v98, v98, v67
    v_fma_f32 v54, v54, s28, v9
    s_waitcnt vmcnt(12)
    s_add_u32 m0, s22, 24576
    s_nop 0
    buffer_load_dwordx4 v6, s[8:11], s21 offen lds
    s_add_u32 s21, s21, 128
    s_add_u32 m0, s22, 25600
    v_mov_b32 v99, v98
    buffer_load_dwordx4 v6, s[8:11], s21 offen lds
    s_nop 0
    v_permlane32_swap_b32 v99, v98
    s_add_u32 s21, s21, 128
    v_max_f32 v98, v98, v99
    s_add_u32 m0, s22, 26624
    s_nop 0
    buffer_load_dwordx4 v6, s[8:11], s21 offen lds
    v_mov_b32 v99, v98
    s_nop 1
    v_permlane16_swap_b32 v99, v98
    v_max_f32 v98, v98, v99
    ds_read_b128 a[220:223], v0 offset:13312
    v_mul_f32_e64 v10, -s28, v98
    v_fma_f32 v61, v61, s28, v10
    v_fma_f32 v63, v63, s28, v10
    v_fma_f32 v60, v60, s28, v10
    v_fma_f32 v62, v62, s28, v10
    ds_read_b128 a[144:147], v104 offset:12288
    v_fma_f32 v66, v66, s28, v10
    v_exp_f32 v61, v61
    v_exp_f32 v60, v60
    v_fma_f32 v67, v67, s28, v10
    v_exp_f32 v66, v66
    v_cvt_pk_bf16_f32 v20, v60, v61
    v_exp_f32 v62, v62
    v_exp_f32 v63, v63
    v_exp_f32 v67, v67
    ds_read_b128 a[152:155], v104 offset:14336
    ds_read_b128 a[232:235], v1 offset:14336
    v_cvt_pk_bf16_f32 v21, v62, v63
    s_waitcnt lgkmcnt(4)
    v_mfma_f32_16x16x32_bf16 v[60:63], a[212:215], a[120:123], 0
    ds_read_b128 a[228:231], v0 offset:14336
    v_mfma_f32_16x16x32_bf16 v[60:63], a[216:219], a[124:127], v[60:63]
    ds_read_b128 a[224:227], v1 offset:13312
    v_fma_f32 v64, v64, s28, v10
    s_waitcnt lgkmcnt(5)
    v_mfma_f32_16x16x32_bf16 v[60:63], a[220:223], a[128:131], v[60:63]
    ds_read_b128 a[216:219], v1 offset:18432
    s_waitcnt lgkmcnt(1)
    v_mfma_f32_16x16x32_bf16 v[60:63], a[224:227], a[132:135], v[60:63]
    ds_read_b128 a[220:223], v0 offset:19456
    v_mfma_f32_16x16x32_bf16 v[60:63], a[228:231], a[136:139], v[60:63]
    v_exp_f32 v64, v64
    ds_read_b128 a[212:215], v0 offset:18432
    v_fma_f32 v65, v65, s28, v10
    s_add_u32 s21, s21, 12032
    v_cvt_pk_bf16_f32 v23, v66, v67
    v_exp_f32 v65, v65
    v_mfma_f32_16x16x32_bf16 v[60:63], a[232:235], a[140:143], v[60:63]
    v_cvt_pk_bf16_f32 v22, v64, v65
    ds_read_b128 a[224:227], v1 offset:19456
    s_waitcnt lgkmcnt(1)
    v_mfma_f32_16x16x32_bf16 v[64:67], a[212:215], a[120:123], 0
    ds_read_b128 a[232:235], v1 offset:20480
    ds_read_b128 a[160:163], v104 offset:16384
    ds_read_b128 a[228:231], v0 offset:20480
    v_fma_f32 v52, v52, s28, v9
    v_mfma_f32_16x16x32_bf16 v[64:67], a[216:219], a[124:127], v[64:67]
    ds_read_b128 a[148:151], v105 offset:12288
    v_mfma_f32_16x16x32_bf16 v[64:67], a[220:223], a[128:131], v[64:67]
    s_waitcnt lgkmcnt(4)
    ds_read_b128 a[212:215], v0 offset:0
    v_mfma_f32_16x16x32_bf16 v[64:67], a[224:227], a[132:135], v[64:67]
    ds_read_b128 a[216:219], v1 offset:0
    ds_read_b128 a[220:223], v0 offset:1024
    ds_read_b128 a[156:159], v105 offset:14336
    s_waitcnt lgkmcnt(5)
    v_mfma_f32_16x16x32_bf16 v[64:67], a[228:231], a[136:139], v[64:67]
    ds_read_b128 a[224:227], v1 offset:1024
    v_mfma_f32_16x16x32_bf16 v[64:67], a[232:235], a[140:143], v[64:67]
    ds_read_b128 a[228:231], v0 offset:2048
    s_waitcnt lgkmcnt(5)
    v_mfma_f32_16x16x32_bf16 v[68:71], a[212:215], a[144:147], 0
    ds_read_b128 a[164:167], v105 offset:16384
    v_fma_f32 v61, v61, s28, v10
    s_waitcnt lgkmcnt(4)
    v_mfma_f32_16x16x32_bf16 v[68:71], a[216:219], a[148:151], v[68:71]
    ds_read_b128 a[212:215], v0 offset:6144
    v_mfma_f32_16x16x32_bf16 v[68:71], a[220:223], a[152:155], v[68:71]
    v_exp_f32 v54, v54
    ds_read_b128 a[216:219], v1 offset:6144
    s_waitcnt lgkmcnt(4)
    v_mfma_f32_16x16x32_bf16 v[68:71], a[224:227], a[156:159], v[68:71]
    ds_read_b128 a[224:227], v1 offset:7168
    v_fma_f32 v63, v63, s28, v10
    s_waitcnt lgkmcnt(4)
    v_mfma_f32_16x16x32_bf16 v[68:71], a[228:231], a[160:163], v[68:71]
    ds_read_b128 a[232:235], v1 offset:2048
    s_waitcnt lgkmcnt(0)
    v_mfma_f32_16x16x32_bf16 v[68:71], a[232:235], a[164:167], v[68:71]
    ds_read_b128 a[232:235], v1 offset:8192
    v_fma_f32 v53, v53, s28, v9
    v_mfma_f32_16x16x32_bf16 v[72:75], a[212:215], a[144:147], 0
    ds_read_b128 a[228:231], v0 offset:8192
    v_mfma_f32_16x16x32_bf16 v[72:75], a[216:219], a[148:151], v[72:75]
    ds_read_b128 a[220:223], v0 offset:7168
    s_waitcnt lgkmcnt(0)
    v_mfma_f32_16x16x32_bf16 v[72:75], a[220:223], a[152:155], v[72:75]
    ds_read_b128 a[220:223], v0 offset:13312
    v_mfma_f32_16x16x32_bf16 v[72:75], a[224:227], a[156:159], v[72:75]
    ds_read_b128 a[216:219], v1 offset:12288
    v_mfma_f32_16x16x32_bf16 v[72:75], a[228:231], a[160:163], v[72:75]
    s_waitcnt vmcnt(9)
    s_add_u32 m0, s22, 36864
    ds_read_b128 a[224:227], v1 offset:13312
    buffer_load_dwordx4 v6, s[8:11], s21 offen lds
    v_mfma_f32_16x16x32_bf16 v[72:75], a[232:235], a[164:167], v[72:75]
    s_add_u32 s21, s21, 128
    s_add_u32 m0, s22, 37888
    ds_read_b128 a[228:231], v0 offset:14336
    ds_read_b128 a[212:215], v0 offset:12288
    buffer_load_dwordx4 v6, s[8:11], s21 offen lds
    s_add_u32 s21, s21, 128
    v_max3_f32 v96, v68, v69, v70
    s_add_u32 m0, s22, 38912
    v_max3_f32 v96, v96, v71, v72
    v_max3_f32 v96, v96, v73, v74
    v_max_f32 v96, v96, v75
    v_mov_b32 v97, v96
    v_mfma_f32_16x16x32_bf16 v[44:47], a[236:239], v[14:17], 0
    buffer_load_dwordx4 v6, s[8:11], s21 offen lds
    v_permlane32_swap_b32 v97, v96
    v_max_f32 v96, v96, v97
    v_mov_b32 v97, v96
    s_nop 1
    v_permlane16_swap_b32 v97, v96
    v_max_f32 v96, v96, v97
    v_mul_f32_e64 v11, -s28, v96
    v_exp_f32 v61, v61
    v_fma_f32 v71, v71, s28, v11
    v_fma_f32 v70, v70, s28, v11
    v_exp_f32 v70, v70
    v_exp_f32 v52, v52
    v_fma_f32 v75, v75, s28, v11
    v_exp_f32 v71, v71
    v_fma_f32 v68, v68, s28, v11
    v_fma_f32 v69, v69, s28, v11
    v_exp_f32 v68, v68
    v_exp_f32 v69, v69
    v_fma_f32 v72, v72, s28, v11
    s_add_u32 s21, s21, 12032
    v_cvt_pk_bf16_f32 v27, v70, v71
    ds_read_b128 a[172:175], v105 offset:18432
    ds_read_b128 a[176:179], v104 offset:20480
    v_cvt_pk_bf16_f32 v26, v68, v69
    v_exp_f32 v72, v72
    s_waitcnt lgkmcnt(2)
    v_mfma_f32_16x16x32_bf16 v[68:71], a[212:215], a[144:147], 0
    ds_read_b128 a[212:215], v0 offset:18432
    v_fma_f32 v74, v74, s28, v11
    v_mfma_f32_16x16x32_bf16 v[68:71], a[216:219], a[148:151], v[68:71]
    v_fma_f32 v73, v73, s28, v11
    ds_read_b128 a[168:171], v104 offset:18432
    ds_read_b128 a[232:235], v1 offset:14336
    v_exp_f32 v73, v73
    v_mfma_f32_16x16x32_bf16 v[68:71], a[220:223], a[152:155], v[68:71]
    ds_read_b128 a[216:219], v1 offset:18432
    v_mfma_f32_16x16x32_bf16 v[68:71], a[224:227], a[156:159], v[68:71]
    v_cvt_pk_bf16_f32 v28, v72, v73
    ds_read_b128 a[220:223], v0 offset:19456
    v_exp_f32 v74, v74
    v_exp_f32 v75, v75
    v_exp_f32 v53, v53
    ds_read_b128 a[224:227], v1 offset:19456
    v_mfma_f32_16x16x32_bf16 v[68:71], a[228:231], a[160:163], v[68:71]
    v_cvt_pk_bf16_f32 v29, v74, v75
    ds_read_b128 a[180:183], v105 offset:20480
    s_waitcnt lgkmcnt(4)
    v_mfma_f32_16x16x32_bf16 v[68:71], a[232:235], a[164:167], v[68:71]
    ds_read_b128 a[228:231], v0 offset:20480
    v_mfma_f32_16x16x32_bf16 v[72:75], a[212:215], a[144:147], 0
    s_waitcnt lgkmcnt(4)
    ds_read_b128 a[184:187], v104 offset:22528
    v_mfma_f32_16x16x32_bf16 v[72:75], a[216:219], a[148:151], v[72:75]
    ds_read_b128 a[232:235], v1 offset:20480
    s_waitcnt lgkmcnt(5)
    v_mfma_f32_16x16x32_bf16 v[72:75], a[220:223], a[152:155], v[72:75]
    ds_read_b128 a[212:215], v0 offset:0
    ds_read_b128 a[220:223], v0 offset:1024
    s_waitcnt lgkmcnt(6)
    v_mfma_f32_16x16x32_bf16 v[72:75], a[224:227], a[156:159], v[72:75]
    ds_read_b128 a[216:219], v1 offset:0
    v_mfma_f32_16x16x32_bf16 v[44:47], a[240:243], v[20:23], v[44:47]
    ds_read_b128 a[188:191], v105 offset:22528
    s_waitcnt lgkmcnt(6)
    v_mfma_f32_16x16x32_bf16 v[72:75], a[228:231], a[160:163], v[72:75]
    ds_read_b128 a[224:227], v1 offset:1024
    s_waitcnt lgkmcnt(5)
    v_mfma_f32_16x16x32_bf16 v[72:75], a[232:235], a[164:167], v[72:75]
    ds_read_b128 a[232:235], v1 offset:2048
    s_waitcnt lgkmcnt(5)
    v_mfma_f32_16x16x32_bf16 v[76:79], a[212:215], a[168:171], 0
    ds_read_b128 a[228:231], v0 offset:2048
    s_waitcnt lgkmcnt(4)
    v_mfma_f32_16x16x32_bf16 v[76:79], a[216:219], a[172:175], v[76:79]
    ds_read_b128 a[212:215], v0 offset:6144
    v_mfma_f32_16x16x32_bf16 v[76:79], a[220:223], a[176:179], v[76:79]
    v_fma_f32 v62, v62, s28, v10
    v_cvt_pk_bf16_f32 v18, v52, v53
    ds_read_b128 a[220:223], v0 offset:7168
    s_waitcnt lgkmcnt(4)
    v_mfma_f32_16x16x32_bf16 v[76:79], a[224:227], a[180:183], v[76:79]
    ds_read_b128 a[216:219], v1 offset:6144
    s_waitcnt lgkmcnt(3)
    v_mfma_f32_16x16x32_bf16 v[76:79], a[228:231], a[184:187], v[76:79]
    ds_read_b128 a[228:231], v0 offset:8192
    v_mfma_f32_16x16x32_bf16 v[76:79], a[232:235], a[188:191], v[76:79]
    ds_read_b128 a[224:227], v1 offset:7168
    s_waitcnt lgkmcnt(4)
    v_mfma_f32_16x16x32_bf16 v[80:83], a[212:215], a[168:171], 0
    ds_read_b128 a[232:235], v1 offset:8192
    s_nop 3
    v_max3_f32 v98, v76, v77, v78
    s_waitcnt lgkmcnt(3)
    v_mfma_f32_16x16x32_bf16 v[80:83], a[216:219], a[172:175], v[80:83]
    ds_read_b128 a[216:219], v1 offset:12288
    v_mfma_f32_16x16x32_bf16 v[80:83], a[220:223], a[176:179], v[80:83]
    ds_read_b128 a[212:215], v0 offset:12288
    s_waitcnt lgkmcnt(3)
    v_mfma_f32_16x16x32_bf16 v[80:83], a[224:227], a[180:183], v[80:83]
    ds_read_b128 a[224:227], v1 offset:13312
    v_fma_f32 v60, v60, s28, v10
    v_mfma_f32_16x16x32_bf16 v[80:83], a[228:231], a[184:187], v[80:83]
    s_waitcnt lgkmcnt(3)
    ds_read_b128 a[220:223], v0 offset:13312
    v_mfma_f32_16x16x32_bf16 v[80:83], a[232:235], a[188:191], v[80:83]
    s_nop 7
    v_max3_f32 v98, v98, v79, v80
    v_max3_f32 v98, v98, v81, v82
    v_max_f32 v98, v98, v83
    v_mov_b32 v99, v98
    s_nop 1
    v_permlane32_swap_b32 v99, v98
    v_max_f32 v98, v98, v99
    v_mov_b32 v99, v98
    s_nop 1
    v_permlane16_swap_b32 v99, v98
    ds_read_b128 a[232:235], v1 offset:14336
    v_max_f32 v98, v98, v99
    v_mfma_f32_16x16x32_bf16 v[44:47], a[244:247], v[26:29], v[44:47]
    ds_read_b128 a[228:231], v0 offset:14336
    v_mul_f32_e64 v12, -s28, v98
    v_fma_f32 v77, v77, s28, v12
    v_fma_f32 v81, v81, s28, v12
    v_fma_f32 v83, v83, s28, v12
    v_fma_f32 v78, v78, s28, v12
    v_fma_f32 v76, v76, s28, v12
    v_exp_f32 v78, v78
    v_exp_f32 v63, v63
    v_fma_f32 v80, v80, s28, v12
    v_exp_f32 v77, v77
    v_fma_f32 v79, v79, s28, v12
    v_exp_f32 v76, v76
    v_exp_f32 v81, v81
    v_exp_f32 v79, v79
    s_nop 0
    v_cvt_pk_bf16_f32 v33, v78, v79
    v_exp_f32 v83, v83
    v_fma_f32 v82, v82, s28, v12
    v_exp_f32 v80, v80
    v_cvt_pk_bf16_f32 v32, v76, v77
    s_waitcnt lgkmcnt(2)
    v_mfma_f32_16x16x32_bf16 v[76:79], a[212:215], a[168:171], 0
    ds_read_b128 a[212:215], v0 offset:18432
    v_mfma_f32_16x16x32_bf16 v[76:79], a[216:219], a[172:175], v[76:79]
    ds_read_b128 a[216:219], v1 offset:18432
    v_exp_f32 v82, v82
    v_mfma_f32_16x16x32_bf16 v[76:79], a[220:223], a[176:179], v[76:79]
    ds_read_b128 a[220:223], v0 offset:19456
    v_cvt_pk_bf16_f32 v34, v80, v81
    v_mfma_f32_16x16x32_bf16 v[76:79], a[224:227], a[180:183], v[76:79]
    s_waitcnt lgkmcnt(3)
    ds_read_b128 a[224:227], v1 offset:19456
    v_mfma_f32_16x16x32_bf16 v[76:79], a[228:231], a[184:187], v[76:79]
    ds_read_b128 a[228:231], v0 offset:20480
    v_cvt_pk_bf16_f32 v35, v82, v83
    v_cvt_pk_bf16_f32 v19, v54, v55
    v_mfma_f32_16x16x32_bf16 v[76:79], a[232:235], a[188:191], v[76:79]
    ds_read_b128 a[232:235], v1 offset:20480
    s_waitcnt lgkmcnt(5)
    v_mfma_f32_16x16x32_bf16 v[80:83], a[212:215], a[168:171], 0
    ds_read_b128 a[212:215], v0 offset:0
    v_exp_f32 v62, v62
    s_waitcnt lgkmcnt(5)
    v_mfma_f32_16x16x32_bf16 v[80:83], a[216:219], a[172:175], v[80:83]
    ds_read_b128 a[216:219], v1 offset:0
    s_waitcnt lgkmcnt(5)
    v_mfma_f32_16x16x32_bf16 v[80:83], a[220:223], a[176:179], v[80:83]
    ds_read_b128 a[220:223], v0 offset:1024
    s_waitcnt lgkmcnt(5)
    v_mfma_f32_16x16x32_bf16 v[80:83], a[224:227], a[180:183], v[80:83]
    v_exp_f32 v60, v60
    s_waitcnt vmcnt(6)
    ds_read_b128 a[192:195], v104 offset:24576
    ds_read_b128 a[196:199], v105 offset:24576
    v_mfma_f32_16x16x32_bf16 v[44:47], a[248:251], v[32:35], v[44:47]
    s_waitcnt lgkmcnt(5)
    ds_read_b128 a[224:227], v1 offset:1024
    v_mfma_f32_16x16x32_bf16 v[80:83], a[228:231], a[184:187], v[80:83]
    ds_read_b128 a[200:203], v104 offset:26624
    ds_read_b128 a[228:231], v0 offset:2048
    v_mfma_f32_16x16x32_bf16 v[80:83], a[232:235], a[188:191], v[80:83]
    ds_read_b128 a[204:207], v105 offset:26624
    ds_read_b128 a[232:235], v1 offset:2048
    s_waitcnt lgkmcnt(6)
    v_mfma_f32_16x16x32_bf16 v[84:87], a[212:215], a[192:195], 0
    s_waitcnt lgkmcnt(5)
    ds_read_b128 a[212:215], v0 offset:6144
    v_mfma_f32_16x16x32_bf16 v[84:87], a[216:219], a[196:199], v[84:87]
    ds_read_b128 a[216:219], v1 offset:6144
    s_waitcnt lgkmcnt(5)
    v_mfma_f32_16x16x32_bf16 v[84:87], a[220:223], a[200:203], v[84:87]
    ds_read_b128 a[220:223], v0 offset:7168
    s_waitcnt lgkmcnt(4)
    v_mfma_f32_16x16x32_bf16 v[84:87], a[224:227], a[204:207], v[84:87]
    ds_read_b128 a[224:227], v1 offset:7168
    v_mfma_f32_16x16x32_bf16 v[84:87], a[228:231], a[208:211], v[84:87]
    s_waitcnt lgkmcnt(4)
    ds_read_b128 a[228:231], v0 offset:8192
    v_mfma_f32_16x16x32_bf16 v[84:87], a[232:235], v[92:95], v[84:87]
    ds_read_b128 a[232:235], v1 offset:8192
    s_waitcnt lgkmcnt(5)
    v_mfma_f32_16x16x32_bf16 v[88:91], a[212:215], a[192:195], 0
    s_nop 4
    v_max3_f32 v96, v84, v85, v86
    s_waitcnt lgkmcnt(3)
    v_mfma_f32_16x16x32_bf16 v[88:91], a[216:219], a[196:199], v[88:91]
    v_cvt_pk_bf16_f32 v25, v62, v63
    v_mfma_f32_16x16x32_bf16 v[88:91], a[220:223], a[200:203], v[88:91]
    s_waitcnt vmcnt(63) lgkmcnt(0)
    s_barrier
    ds_read_b128 a[212:215], v0 offset:12288
    v_mfma_f32_16x16x32_bf16 v[88:91], a[224:227], a[204:207], v[88:91]
    s_add_u32 m0, s22, 0
    ds_read_b128 a[224:227], v1 offset:13312
    buffer_load_dwordx4 v6, s[4:7], s20 offen lds
    s_add_u32 s20, s20, 128
    v_mfma_f32_16x16x32_bf16 v[88:91], a[228:231], a[208:211], v[88:91]
    s_add_u32 m0, s22, 1024
    ds_read_b128 a[216:219], v1 offset:12288
    buffer_load_dwordx4 v6, s[4:7], s20 offen lds
    v_mfma_f32_16x16x32_bf16 v[88:91], a[232:235], v[92:95], v[88:91]
    s_add_u32 s20, s20, 128
    s_add_u32 m0, s22, 2048
    ds_read_b128 a[228:231], v0 offset:14336
    buffer_load_dwordx4 v6, s[4:7], s20 offen lds
    ds_read_b128 a[220:223], v0 offset:13312
    s_add_u32 s20, s20, 12032
    ds_read_b128 a[232:235], v1 offset:14336
    s_mov_b32 s39, s64
    v_max3_f32 v96, v96, v87, v88
    v_max3_f32 v96, v96, v89, v90
    v_max_f32 v96, v96, v91
    v_mov_b32 v97, v96
    s_add_u32 s37, s37, 1
    s_bitcmp1_b32 s63, s37
    v_permlane32_swap_b32 v97, v96
    s_cselect_b32 s62, 4294770688, 0
    v_max_f32 v96, v96, v97
    v_mov_b32 v97, v96
    s_cselect_b32 s42, 0, 325632
    s_add_u32 s35, s35, s42
    v_permlane16_swap_b32 v97, v96
    s_lshl_b32 s42, s37, 1
    v_max_f32 v96, v96, v97
    v_mul_f32_e64 v13, -s28, v96
    v_fma_f32 v87, v87, s28, v13
    v_fma_f32 v85, v85, s28, v13
    v_exp_f32 v85, v85
    v_fma_f32 v86, v86, s28, v13
    v_fma_f32 v84, v84, s28, v13
    v_exp_f32 v86, v86
    v_exp_f32 v84, v84
    v_exp_f32 v87, v87
    v_cvt_pk_bf16_f32 v38, v84, v85
    v_cvt_pk_bf16_f32 v39, v86, v87
    s_waitcnt lgkmcnt(2)
    v_mfma_f32_16x16x32_bf16 v[84:87], a[212:215], a[192:195], 0
    s_lshr_b32 s42, s31, s42
    ds_read_b128 a[212:215], v0 offset:18432
    s_and_b32 s42, s42, 3
    v_mfma_f32_16x16x32_bf16 v[84:87], a[216:219], a[196:199], v[84:87]
    s_add_u32 s42, s42, s36
    ds_read_b128 a[216:219], v1 offset:18432
    s_waitcnt lgkmcnt(2)
    v_mfma_f32_16x16x32_bf16 v[84:87], a[220:223], a[200:203], v[84:87]
    s_sub_u32 s43, s42, 3
    s_cmp_ge_u32 s42, 3
    ds_read_b128 a[220:223], v0 offset:19456
    v_mfma_f32_16x16x32_bf16 v[84:87], a[224:227], a[204:207], v[84:87]
    s_cselect_b32 s42, s43, s42
    ds_read_b128 a[224:227], v1 offset:19456
    s_mul_i32 s44, s3, 5
    v_mfma_f32_16x16x32_bf16 v[84:87], a[228:231], a[208:211], v[84:87]
    s_mov_b32 s32, 1
    ds_read_b128 a[228:231], v0 offset:20480
    v_fma_f32 v90, v90, s28, v13
    v_mfma_f32_16x16x32_bf16 v[84:87], a[232:235], v[92:95], v[84:87]
    s_lshl_b32 s43, s3, 2
    ds_read_b128 a[232:235], v1 offset:20480
    v_exp_f32 v90, v90
    s_add_u32 s45, s43, 21
    v_fma_f32 v91, v91, s28, v13
    v_fma_f32 v88, v88, s28, v13
    v_fma_f32 v89, v89, s28, v13
    v_exp_f32 v88, v88
    s_cmp_eq_u32 s3, 0
    s_cselect_b32 s45, 20, s45
    s_cselect_b32 s33, 1, 0
    v_exp_f32 v91, v91
    s_cmp_eq_u32 s42, 1
    s_cselect_b32 s44, s45, s44
    s_cselect_b32 s32, s33, s32
    v_exp_f32 v89, v89
    s_add_u32 s45, s43, 37
    s_cmp_eq_u32 s42, 2
    v_cvt_pk_bf16_f32 v40, v88, v89
    v_cvt_pk_bf16_f32 v41, v90, v91
    s_cselect_b32 s44, s45, s44
    s_cselect_b32 s32, 0, s32
    s_mul_i32 s44, s44, 6144
    s_add_u32 s33, s35, s44
    s_mul_i32 s42, s32, 6144
    s_add_u32 s42, s42, 24576
    s_add_u32 s42, s42, s33
    s_cmp_ge_u32 s37, 6
    s_cselect_b32 s14, 0, s42
    s_add_u32 s24, s67, 256
    s_add_u32 s25, s33, 256
    s_add_u32 s23, s38, 4096
    s_mov_b32 s27, 0x49249249
    s_mov_b32 s30, 0
    s_waitcnt vmcnt(6) lgkmcnt(0)
    v_mfma_f32_16x16x32_bf16 v[88:91], a[212:215], a[192:195], 0
    s_barrier
    ds_read_b64_tr_b16 a[212:213], v2 offset:0
    ds_read_b64_tr_b16 a[214:215], v2 offset:6144
    s_add_u32 m0, s22, 12288
    v_mfma_f32_16x16x32_bf16 v[88:91], a[216:219], a[196:199], v[88:91]
    buffer_load_dwordx4 v6, s[4:7], s20 offen lds
    ds_read_b64_tr_b16 a[216:217], v3 offset:0
    v_mfma_f32_16x16x32_bf16 v[88:91], a[220:223], a[200:203], v[88:91]
    ds_read_b64_tr_b16 a[218:219], v3 offset:6144
    v_mfma_f32_16x16x32_bf16 v[88:91], a[224:227], a[204:207], v[88:91]
    v_cvt_pk_bf16_f32 v24, v60, v61
    s_add_u32 s20, s20, 128
    ds_read_b64_tr_b16 a[220:221], v4 offset:0
    s_add_u32 m0, s22, 13312
    s_nop 0
    buffer_load_dwordx4 v6, s[4:7], s20 offen lds
    v_mfma_f32_16x16x32_bf16 v[88:91], a[228:231], a[208:211], v[88:91]
    s_add_u32 s20, s20, 128
    ds_read_b64_tr_b16 a[222:223], v4 offset:6144
    s_add_u32 m0, s22, 14336
    v_mfma_f32_16x16x32_bf16 v[44:47], a[252:255], v[38:41], v[44:47]
    buffer_load_dwordx4 v6, s[4:7], s20 offen lds
    ds_read_b64_tr_b16 a[224:225], v5 offset:0
    ds_read_b64_tr_b16 a[226:227], v5 offset:6144
    s_add_u32 s20, s20, 12032
    v_mfma_f32_16x16x32_bf16 v[88:91], a[232:235], v[92:95], v[88:91]
    s_waitcnt lgkmcnt(6)
    v_mfma_f32_16x16x32_bf16 v[112:115], a[212:215], v[14:17], 0
    ds_read_b64_tr_b16 a[234:235], v3 offset:7168
    v_fma_f32 v84, v84, s28, v13
    v_mfma_f32_16x16x32_bf16 v[160:163], a[212:215], v[20:23], 0
    v_fma_f32 v81, v81, s28, v12
    v_mfma_f32_16x16x32_bf16 v[208:211], a[212:215], v[26:29], 0
    v_fma_f32 v75, v75, s28, v11
    v_fma_f32 v76, v76, s28, v12
    v_mfma_f32_16x16x32_bf16 a[0:3], a[212:215], v[32:35], 0
    ds_read_b64_tr_b16 a[232:233], v3 offset:1024
    v_fma_f32 v80, v80, s28, v12
    v_mfma_f32_16x16x32_bf16 a[48:51], a[212:215], v[38:41], 0
    ds_read_b64_tr_b16 a[228:229], v2 offset:1024
    s_waitcnt lgkmcnt(7)
    v_mfma_f32_16x16x32_bf16 v[116:119], a[216:219], v[14:17], 0
    v_fma_f32 v70, v70, s28, v11
    v_mfma_f32_16x16x32_bf16 v[164:167], a[216:219], v[20:23], 0
    ds_read_b64_tr_b16 a[230:231], v2 offset:7168
    v_fma_f32 v87, v87, s28, v13
    v_mfma_f32_16x16x32_bf16 v[212:215], a[216:219], v[26:29], 0
    ds_read_b64_tr_b16 a[212:213], v4 offset:1024
    v_fma_f32 v68, v68, s28, v11
    v_mfma_f32_16x16x32_bf16 a[4:7], a[216:219], v[32:35], 0
    v_fma_f32 v71, v71, s28, v11
    v_fma_f32 v59, v59, s28, v9
    v_mfma_f32_16x16x32_bf16 a[52:55], a[216:219], v[38:41], 0
    s_waitcnt lgkmcnt(5)
    v_fma_f32 v74, v74, s28, v11
    v_fma_f32 v79, v79, s28, v12
    v_mfma_f32_16x16x32_bf16 v[120:123], a[220:223], v[14:17], 0
    s_add_u32 s39, s39, 12288
    v_fma_f32 v77, v77, s28, v12
    v_fma_f32 v58, v58, s28, v9
    v_mfma_f32_16x16x32_bf16 v[168:171], a[220:223], v[20:23], 0
    v_exp_f32 v68, v68
    v_mfma_f32_16x16x32_bf16 v[216:219], a[220:223], v[26:29], 0
    v_exp_f32 v59, v59
    v_mfma_f32_16x16x32_bf16 a[8:11], a[220:223], v[32:35], 0
    v_exp_f32 v87, v87
    v_mfma_f32_16x16x32_bf16 a[56:59], a[220:223], v[38:41], 0
    v_fma_f32 v65, v65, s28, v10
    v_mfma_f32_16x16x32_bf16 v[124:127], a[224:227], v[14:17], 0
    ds_read_b64_tr_b16 a[218:219], v5 offset:7168
    v_fma_f32 v78, v78, s28, v12
    v_mfma_f32_16x16x32_bf16 v[172:175], a[224:227], v[20:23], 0
    v_exp_f32 v71, v71
    v_mfma_f32_16x16x32_bf16 v[220:223], a[224:227], v[26:29], 0
    ds_read_b64_tr_b16 a[216:217], v5 offset:1024
    v_mfma_f32_16x16x32_bf16 a[12:15], a[224:227], v[32:35], 0
    ds_read_b64_tr_b16 a[220:221], v2 offset:2048
    v_fma_f32 v90, v90, s28, v13
    v_mfma_f32_16x16x32_bf16 a[60:63], a[224:227], v[38:41], 0
    s_waitcnt lgkmcnt(3)
    ds_read_b64_tr_b16 a[214:215], v4 offset:7168
    v_add_u32 v8, 4096, v8
    v_mfma_f32_16x16x32_bf16 v[128:131], a[228:231], v[14:17], 0
    v_exp_f32 v79, v79
    v_mfma_f32_16x16x32_bf16 v[176:179], a[228:231], v[20:23], 0
    v_exp_f32 v74, v74
    v_mfma_f32_16x16x32_bf16 v[224:227], a[228:231], v[26:29], 0
    ds_read_b64_tr_b16 a[222:223], v2 offset:8192
    v_fma_f32 v82, v82, s28, v12
    v_mfma_f32_16x16x32_bf16 a[16:19], a[228:231], v[32:35], 0
    v_fma_f32 v83, v83, s28, v12
    v_fma_f32 v69, v69, s28, v11
    v_mfma_f32_16x16x32_bf16 a[64:67], a[228:231], v[38:41], 0
    ds_read_b64_tr_b16 a[226:227], v3 offset:8192
    v_mfma_f32_16x16x32_bf16 v[132:135], a[232:235], v[14:17], 0
    v_exp_f32 v76, v76
    v_mfma_f32_16x16x32_bf16 v[180:183], a[232:235], v[20:23], 0
    v_exp_f32 v69, v69
    v_mfma_f32_16x16x32_bf16 v[228:231], a[232:235], v[26:29], 0
    ds_read_b64_tr_b16 a[230:231], v4 offset:8192
    v_fma_f32 v67, v67, s28, v10
    v_mfma_f32_16x16x32_bf16 a[20:23], a[232:235], v[32:35], 0
    ds_read_b64_tr_b16 a[224:225], v3 offset:2048
    v_fma_f32 v73, v73, s28, v11
    v_mfma_f32_16x16x32_bf16 a[68:71], a[232:235], v[38:41], 0
    s_waitcnt lgkmcnt(4)
    ds_read_b64_tr_b16 a[232:233], v5 offset:2048
    v_fma_f32 v86, v86, s28, v13
    v_mfma_f32_16x16x32_bf16 v[136:139], a[212:215], v[14:17], 0
    ds_read_b64_tr_b16 a[228:229], v4 offset:2048
    v_fma_f32 v66, v66, s28, v10
    v_mfma_f32_16x16x32_bf16 v[184:187], a[212:215], v[20:23], 0
    v_exp_f32 v70, v70
    v_mfma_f32_16x16x32_bf16 v[232:235], a[212:215], v[26:29], 0
    ds_read_b64_tr_b16 a[234:235], v5 offset:8192
    v_cvt_pk_bf16_f32 v31, v70, v71
    v_mfma_f32_16x16x32_bf16 a[24:27], a[212:215], v[32:35], 0
    v_exp_f32 v58, v58
    v_mfma_f32_16x16x32_bf16 a[72:75], a[212:215], v[38:41], 0
    v_fma_f32 v64, v64, s28, v10
    v_cvt_pk_bf16_f32 v30, v68, v69
    v_mfma_f32_16x16x32_bf16 v[140:143], a[216:219], v[14:17], 0
    v_fma_f32 v56, v56, s28, v9
    v_mfma_f32_16x16x32_bf16 v[188:191], a[216:219], v[20:23], 0
    v_exp_f32 v64, v64
    v_mfma_f32_16x16x32_bf16 v[236:239], a[216:219], v[26:29], 0
    v_fma_f32 v85, v85, s28, v13
    v_mfma_f32_16x16x32_bf16 a[28:31], a[216:219], v[32:35], 0
    v_exp_f32 v82, v82
    v_mfma_f32_16x16x32_bf16 a[76:79], a[216:219], v[38:41], 0
    s_waitcnt lgkmcnt(2)
    v_exp_f32 v75, v75
    v_mfma_f32_16x16x32_bf16 v[144:147], a[220:223], v[14:17], 0
    v_fma_f32 v88, v88, s28, v13
    v_fma_f32 v57, v57, s28, v9
    v_mfma_f32_16x16x32_bf16 v[192:195], a[220:223], v[20:23], 0
    v_exp_f32 v78, v78
    v_mfma_f32_16x16x32_bf16 v[240:243], a[220:223], v[26:29], 0
    s_waitcnt vmcnt(3) lgkmcnt(0)
    v_exp_f32 v86, v86
    v_mfma_f32_16x16x32_bf16 a[32:35], a[220:223], v[32:35], 0
    s_barrier
    v_mfma_f32_16x16x32_bf16 a[80:83], a[220:223], v[38:41], 0
    v_exp_f32 v65, v65
    v_mfma_f32_16x16x32_bf16 v[148:151], a[224:227], v[14:17], 0
    s_add_u32 m0, s22, 24576
    ds_read_b128 a[220:223], v0 offset:1024
    v_mfma_f32_16x16x32_bf16 v[196:199], a[224:227], v[20:23], 0
    buffer_load_dwordx4 v6, s[8:11], s21 offen lds
    v_mfma_f32_16x16x32_bf16 v[244:247], a[224:227], v[26:29], 0
    s_add_u32 s21, s21, 128
    v_exp_f32 v85, v85
    v_mfma_f32_16x16x32_bf16 a[36:39], a[224:227], v[32:35], 0
    v_exp_f32 v84, v84
    v_mfma_f32_16x16x32_bf16 a[84:87], a[224:227], v[38:41], 0
    s_add_u32 m0, s22, 25600
    ds_read_b128 a[212:215], v0 offset:0
    v_mfma_f32_16x16x32_bf16 v[152:155], a[228:231], v[14:17], 0
    ds_read_b128 a[216:219], v1 offset:0
    v_mfma_f32_16x16x32_bf16 v[200:203], a[228:231], v[20:23], 0
    buffer_load_dwordx4 v6, s[8:11], s21 offen lds
    v_mfma_f32_16x16x32_bf16 v[248:251], a[228:231], v[26:29], 0
    v_exp_f32 v56, v56
    v_mfma_f32_16x16x32_bf16 a[40:43], a[228:231], v[32:35], 0
    s_add_u32 s21, s21, 128
    s_add_u32 m0, s22, 26624
    ds_read_b128 a[224:227], v1 offset:1024
    v_mfma_f32_16x16x32_bf16 a[88:91], a[228:231], v[38:41], 0
    buffer_load_dwordx4 v6, s[8:11], s21 offen lds
    v_mfma_f32_16x16x32_bf16 v[156:159], a[232:235], v[14:17], 0
    v_exp_f32 v67, v67
    v_mfma_f32_16x16x32_bf16 v[204:207], a[232:235], v[20:23], 0
    s_add_u32 s21, s21, 12032
    v_fma_f32 v91, v91, s28, v13
    v_fma_f32 v72, v72, s28, v11
    v_mfma_f32_16x16x32_bf16 v[252:255], a[232:235], v[26:29], 0
    v_exp_f32 v77, v77
    v_mfma_f32_16x16x32_bf16 a[44:47], a[232:235], v[32:35], 0
    v_exp_f32 v72, v72
    v_mfma_f32_16x16x32_bf16 a[92:95], a[232:235], v[38:41], 0
    s_waitcnt lgkmcnt(2)
    v_cvt_pk_bf16_f32 v37, v78, v79
    v_cvt_pk_bf16_f32 v17, v58, v59
    v_mfma_f32_16x16x32_bf16 v[52:55], a[212:215], a[96:99], 0
    s_add_u32 m0, s38, 0
    s_waitcnt lgkmcnt(1)
    v_mfma_f32_16x16x32_bf16 v[52:55], a[216:219], a[100:103], v[52:55]
    v_exp_f32 v88, v88
    v_mfma_f32_16x16x32_bf16 v[52:55], a[220:223], a[104:107], v[52:55]
    ds_read_b128 a[228:231], v0 offset:2048
    v_mfma_f32_16x16x32_bf16 v[60:63], a[212:215], a[120:123], 0
    ds_read_b128 a[232:235], v1 offset:2048
    v_mfma_f32_16x16x32_bf16 v[60:63], a[216:219], a[124:127], v[60:63]
    v_exp_f32 v73, v73
    v_mfma_f32_16x16x32_bf16 v[60:63], a[220:223], a[128:131], v[60:63]
    v_cvt_pk_bf16_f32 v42, v84, v85
    v_cvt_pk_bf16_f32 v36, v76, v77
    v_mfma_f32_16x16x32_bf16 v[68:71], a[212:215], a[144:147], 0
    v_exp_f32 v91, v91
    v_mfma_f32_16x16x32_bf16 v[68:71], a[216:219], a[148:151], v[68:71]
    v_exp_f32 v66, v66
    v_mfma_f32_16x16x32_bf16 v[68:71], a[220:223], a[152:155], v[68:71]
    v_fma_f32 v89, v89, s28, v13
    v_mfma_f32_16x16x32_bf16 v[76:79], a[212:215], a[168:171], 0
    v_cvt_pk_bf16_f32 v43, v86, v87
    v_cvt_pk_bf16_f32 v28, v72, v73
    v_mfma_f32_16x16x32_bf16 v[76:79], a[216:219], a[172:175], v[76:79]
    buffer_load_dwordx4 v6, s[12:15], s33 offen nt lds
    v_mfma_f32_16x16x32_bf16 v[76:79], a[220:223], a[176:179], v[76:79]
    v_exp_f32 v81, v81
    v_mfma_f32_16x16x32_bf16 v[84:87], a[212:215], a[192:195], 0
    s_add_u32 m0, s38, 1024
    v_exp_f32 v83, v83
    v_mfma_f32_16x16x32_bf16 v[84:87], a[216:219], a[196:199], v[84:87]
    v_mfma_f32_16x16x32_bf16 v[84:87], a[220:223], a[200:203], v[84:87]
    s_waitcnt lgkmcnt(0)
    ds_read_b128 a[220:223], v0 offset:7168
    v_cvt_pk_bf16_f32 v29, v74, v75
    v_mfma_f32_16x16x32_bf16 v[52:55], a[224:227], a[108:111], v[52:55]
    ds_read_b128 a[212:215], v0 offset:6144
    v_mfma_f32_16x16x32_bf16 v[52:55], a[228:231], a[112:115], v[52:55]
    v_cvt_pk_bf16_f32 v22, v64, v65
    v_mfma_f32_16x16x32_bf16 v[52:55], a[232:235], a[116:119], v[52:55]
    v_exp_f32 v89, v89
    v_mfma_f32_16x16x32_bf16 v[60:63], a[224:227], a[132:135], v[60:63]
    v_exp_f32 v80, v80
    v_mfma_f32_16x16x32_bf16 v[60:63], a[228:231], a[136:139], v[60:63]
    v_mfma_f32_16x16x32_bf16 v[60:63], a[232:235], a[140:143], v[60:63]
    v_exp_f32 v57, v57
    v_mfma_f32_16x16x32_bf16 v[68:71], a[224:227], a[156:159], v[68:71]
    buffer_load_dwordx4 v7, s[12:15], s33 offen nt lds
    v_mfma_f32_16x16x32_bf16 v[68:71], a[228:231], a[160:163], v[68:71]
    v_exp_f32 v90, v90
    v_mfma_f32_16x16x32_bf16 v[68:71], a[232:235], a[164:167], v[68:71]
    ds_read_b128 a[216:219], v1 offset:6144
    v_mfma_f32_16x16x32_bf16 v[76:79], a[224:227], a[180:183], v[76:79]
    v_cvt_pk_bf16_f32 v35, v82, v83
    v_mfma_f32_16x16x32_bf16 v[76:79], a[228:231], a[184:187], v[76:79]
    v_cvt_pk_bf16_f32 v40, v88, v89
    v_mfma_f32_16x16x32_bf16 v[76:79], a[232:235], a[188:191], v[76:79]
    v_mfma_f32_16x16x32_bf16 v[84:87], a[224:227], a[204:207], v[84:87]
    v_cvt_pk_bf16_f32 v16, v56, v57
    v_mfma_f32_16x16x32_bf16 v[84:87], a[228:231], a[208:211], v[84:87]
    ds_read_b128 a[224:227], v1 offset:7168
    v_cvt_pk_bf16_f32 v34, v80, v81
    v_mfma_f32_16x16x32_bf16 v[84:87], a[232:235], v[92:95], v[84:87]
    ds_read_b128 a[232:235], v1 offset:8192
    v_cvt_pk_bf16_f32 v23, v66, v67
    v_mfma_f32_16x16x32_bf16 v[48:51], a[236:239], v[16:19], v[44:47]
    ds_read_b128 a[228:231], v0 offset:8192
    v_cvt_pk_bf16_f32 v41, v90, v91
    v_mfma_f32_16x16x32_bf16 v[48:51], a[240:243], v[22:25], v[48:51]
    v_mfma_f32_16x16x32_bf16 v[48:51], a[244:247], v[28:31], v[48:51]
    v_mfma_f32_16x16x32_bf16 v[48:51], a[248:251], v[34:37], v[48:51]
    s_add_u32 s59, s33, 128
    v_mfma_f32_16x16x32_bf16 v[48:51], a[252:255], v[40:43], v[48:51]
    s_add_u32 m0, s38, 2048
    s_waitcnt lgkmcnt(3)
    v_mfma_f32_16x16x32_bf16 v[56:59], a[212:215], a[96:99], 0
    buffer_load_dwordx4 v6, s[12:15], s59 offen nt lds
    v_mfma_f32_16x16x32_bf16 v[56:59], a[216:219], a[100:103], v[56:59]
    s_add_u32 m0, s38, 3072
    v_mfma_f32_16x16x32_bf16 v[56:59], a[220:223], a[104:107], v[56:59]
    s_nop 0
    v_cmp_lt_f32 vcc, s29, v48
    v_mfma_f32_16x16x32_bf16 v[64:67], a[212:215], a[120:123], 0
    buffer_load_dwordx4 v7, s[12:15], s59 offen nt lds
    v_mfma_f32_16x16x32_bf16 v[64:67], a[216:219], a[124:127], v[64:67]
    v_mfma_f32_16x16x32_bf16 v[64:67], a[220:223], a[128:131], v[64:67]
    s_waitcnt vmcnt(13) lgkmcnt(0)
    s_cbranch_vccnz L_rs_start5b
L_ret_start5b:
    v_mfma_f32_16x16x32_bf16 v[72:75], a[212:215], a[144:147], 0
    s_barrier
    v_mfma_f32_16x16x32_bf16 v[72:75], a[216:219], a[148:151], v[72:75]
    s_add_u32 m0, s22, 0
    v_fma_f32 v52, v52, s28, v9
    v_fma_f32 v63, v63, s28, v10
    v_mfma_f32_16x16x32_bf16 v[72:75], a[220:223], a[152:155], v[72:75]
    buffer_load_dwordx4 v6, s[4:7], s20 offen lds
    v_mfma_f32_16x16x32_bf16 v[80:83], a[212:215], a[168:171], 0
    v_exp_f32 v52, v52
    v_mfma_f32_16x16x32_bf16 v[80:83], a[216:219], a[172:175], v[80:83]
    s_add_u32 s20, s20, 128
    v_fma_f32 v55, v55, s28, v9
    v_fma_f32 v53, v53, s28, v9
    v_mfma_f32_16x16x32_bf16 v[80:83], a[220:223], a[176:179], v[80:83]
    s_add_u32 m0, s22, 1024
    v_exp_f32 v53, v53
    v_mfma_f32_16x16x32_bf16 v[88:91], a[212:215], a[192:195], 0
    buffer_load_dwordx4 v6, s[4:7], s20 offen lds
    v_mfma_f32_16x16x32_bf16 v[88:91], a[216:219], a[196:199], v[88:91]
    ds_read_b64_tr_b16 a[212:213], v2 offset:18432
    s_add_u32 s20, s20, 128
    v_mfma_f32_16x16x32_bf16 v[88:91], a[220:223], a[200:203], v[88:91]
    v_exp_f32 v63, v63
    v_mfma_f32_16x16x32_bf16 v[56:59], a[224:227], a[108:111], v[56:59]
    ds_read_b64_tr_b16 a[214:215], v2 offset:12288
    v_fma_f32 v54, v54, s28, v9
    v_mfma_f32_16x16x32_bf16 v[56:59], a[228:231], a[112:115], v[56:59]
    s_add_u32 m0, s22, 2048
    v_exp_f32 v55, v55
    v_mfma_f32_16x16x32_bf16 v[56:59], a[232:235], a[116:119], v[56:59]
    buffer_load_dwordx4 v6, s[4:7], s20 offen lds
    v_mfma_f32_16x16x32_bf16 v[64:67], a[224:227], a[132:135], v[64:67]
    ds_read_b64_tr_b16 a[216:217], v3 offset:18432
    v_fma_f32 v60, v60, s28, v10
    v_mfma_f32_16x16x32_bf16 v[64:67], a[228:231], a[136:139], v[64:67]
    s_add_u32 s20, s20, 12032
    ds_read_b64_tr_b16 a[218:219], v3 offset:12288
    v_fma_f32 v62, v62, s28, v10
    v_mfma_f32_16x16x32_bf16 v[64:67], a[232:235], a[140:143], v[64:67]
    ds_read_b64_tr_b16 a[220:221], v4 offset:18432
    v_mfma_f32_16x16x32_bf16 v[72:75], a[224:227], a[156:159], v[72:75]
    ds_read_b64_tr_b16 a[222:223], v4 offset:12288
    v_mfma_f32_16x16x32_bf16 v[72:75], a[228:231], a[160:163], v[72:75]
    v_cvt_pk_bf16_f32 v14, v52, v53
    v_fma_f32 v61, v61, s28, v10
    v_mfma_f32_16x16x32_bf16 v[72:75], a[232:235], a[164:167], v[72:75]
    v_exp_f32 v54, v54
    v_mfma_f32_16x16x32_bf16 v[80:83], a[224:227], a[180:183], v[80:83]
    v_exp_f32 v62, v62
    v_mfma_f32_16x16x32_bf16 v[80:83], a[228:231], a[184:187], v[80:83]
    v_exp_f32 v60, v60
    v_mfma_f32_16x16x32_bf16 v[80:83], a[232:235], a[188:191], v[80:83]
    v_exp_f32 v61, v61
    v_mfma_f32_16x16x32_bf16 v[88:91], a[224:227], a[204:207], v[88:91]
    ds_read_b64_tr_b16 a[224:225], v5 offset:18432
    v_mfma_f32_16x16x32_bf16 v[88:91], a[228:231], a[208:211], v[88:91]
    ds_read_b64_tr_b16 a[226:227], v5 offset:12288
    v_cvt_pk_bf16_f32 v15, v54, v55
    v_mfma_f32_16x16x32_bf16 v[88:91], a[232:235], v[92:95], v[88:91]
    v_cvt_pk_bf16_f32 v20, v60, v61
    v_cvt_pk_bf16_f32 v21, v62, v63
    s_branch L_loop5
L_start4:
    s_add_u32 m0, s22, 0
    s_nop 0
    buffer_load_dwordx4 v6, s[4:7], s20 offen lds
    s_add_u32 s20, s20, 128
    s_add_u32 m0, s22, 1024
    s_nop 0
    buffer_load_dwordx4 v6, s[4:7], s20 offen lds
    s_add_u32 s20, s20, 128
    s_add_u32 m0, s22, 2048
    s_nop 0
    buffer_load_dwordx4 v6, s[4:7], s20 offen lds
    s_add_u32 s20, s20, 12032
    s_add_u32 m0, s22, 12288
    s_nop 0
    buffer_load_dwordx4 v6, s[4:7], s20 offen lds
    s_add_u32 s20, s20, 128
    s_add_u32 m0, s22, 13312
    s_nop 0
    buffer_load_dwordx4 v6, s[4:7], s20 offen lds
    s_add_u32 s20, s20, 128
    s_add_u32 m0, s22, 14336
    s_nop 0
    buffer_load_dwordx4 v6, s[4:7], s20 offen lds
    s_add_u32 s20, s20, 12032
    s_add_u32 s48, s34, 0
    s_add_u32 m0, s38, 0
    s_nop 0
    buffer_load_dwordx4 v6, s[12:15], s48 offen nt lds
    s_add_u32 m0, s38, 1024
    s_nop 0
    buffer_load_dwordx4 v7, s[12:15], s48 offen nt lds
    s_add_u32 s48, s34, 128
    s_add_u32 m0, s38, 2048
    s_nop 0
    buffer_load_dwordx4 v6, s[12:15], s48 offen nt lds
    s_add_u32 m0, s38, 3072
    s_nop 0
    buffer_load_dwordx4 v7, s[12:15], s48 offen nt lds
    s_add_u32 s48, s34, 256
    s_add_u32 m0, s38, 4096
    s_nop 0
    buffer_load_dwordx4 v6, s[12:15], s48 offen nt lds
    s_add_u32 m0, s38, 5120
    s_nop 0
    buffer_load_dwordx4 v7, s[12:15], s48 offen nt lds
    s_add_u32 s48, s34, 6144
    s_add_u32 m0, s38, 6144
    s_nop 0
    buffer_load_dwordx4 v6, s[12:15], s48 offen nt lds
    s_add_u32 m0, s38, 7168
    s_nop 0
    buffer_load_dwordx4 v7, s[12:15], s48 offen nt lds
    s_add_u32 s48, s34, 6272
    s_add_u32 m0, s38, 8192
    s_nop 0
    buffer_load_dwordx4 v6, s[12:15], s48 offen nt lds
    s_add_u32 m0, s38, 9216
    s_nop 0
    buffer_load_dwordx4 v7, s[12:15], s48 offen nt lds
    s_add_u32 s48, s34, 6400
    s_add_u32 m0, s38, 10240
    s_nop 0
    buffer_load_dwordx4 v6, s[12:15], s48 offen nt lds
    s_add_u32 m0, s38, 11264
    s_nop 0
    buffer_load_dwordx4 v7, s[12:15], s48 offen nt lds
    s_add_u32 s48, s34, 12288
    s_add_u32 m0, s38, 12288
    s_nop 0
    buffer_load_dwordx4 v6, s[12:15], s48 offen nt lds
    s_add_u32 m0, s38, 13312
    s_nop 0
    buffer_load_dwordx4 v7, s[12:15], s48 offen nt lds
    s_add_u32 s48, s34, 12416
    s_add_u32 m0, s38, 14336
    s_nop 0
    buffer_load_dwordx4 v6, s[12:15], s48 offen nt lds
    s_add_u32 m0, s38, 15360
    s_nop 0
    buffer_load_dwordx4 v7, s[12:15], s48 offen nt lds
    s_add_u32 s48, s34, 12544
    s_add_u32 m0, s38, 16384
    s_nop 0
    buffer_load_dwordx4 v6, s[12:15], s48 offen nt lds
    s_add_u32 m0, s38, 17408
    s_nop 0
    buffer_load_dwordx4 v7, s[12:15], s48 offen nt lds
    v_and_b32 v96, 15, v111
    v_lshrrev_b32 v97, 4, v111
    v_lshrrev_b32 v98, 3, v96
    v_and_b32 v99, 7, v96
    v_lshlrev_b32 v0, 7, v99
    v_bfe_u32 v99, v96, 1, 2
    v_lshlrev_b32 v99, 1, v99
    v_mul_u32_u24 v100, 5, v98
    v_xor_b32 v99, v99, v100
    v_xor_b32 v99, v99, v97
    v_lshl_add_u32 v0, v99, 4, v0
    v_mul_u32_u24 v100, 3072, v98
    v_add_u32 v0, v100, v0
    v_xor_b32 v1, 64, v0
    v_lshrrev_b32 v98, 1, v97
    v_mul_u32_u24 v2, 3072, v98
    v_and_b32 v99, 1, v97
    v_bfe_u32 v100, v111, 2, 2
    v_lshl_add_u32 v96, v99, 2, v100
    v_lshl_add_u32 v2, v96, 7, v2
    v_lshrrev_b32 v96, 1, v96
    v_lshlrev_b32 v96, 1, v96
    v_mul_u32_u24 v98, 5, v98
    v_xor_b32 v96, v96, v98
    v_bfe_u32 v99, v111, 1, 1
    v_xor_b32 v96, v96, v99
    v_lshl_add_u32 v2, v96, 4, v2
    v_and_b32 v99, 1, v111
    v_lshl_add_u32 v2, v99, 3, v2
    v_add_u32 v2, 24576, v2
    v_xor_b32 v3, 32, v2
    v_xor_b32 v4, 64, v2
    v_xor_b32 v5, 96, v2
    v_lshl_add_u32 v8, v111, 4, s38
    v_lshrrev_b32 v96, 3, v111
    v_bfe_u32 v97, v111, 0, 3
    v_and_b32 v98, 3, v96
    v_lshlrev_b32 v98, 1, v98
    v_xor_b32 v97, v97, v98
    v_xor_b32 v97, s65, v97
    v_mul_u32_u24 v102, 384, v96
    v_lshl_add_u32 v102, v97, 4, v102
    v_xor_b32 v103, 16, v102
    s_mul_i32 s42, s65, 3072
    v_add_u32 v102, s42, v102
    s_sub_u32 s42, 3072, s42
    v_add_u32 v103, s42, v103
    v_and_b32 v96, 15, v111
    s_mov_b32 s42, 0x1011
    v_bfe_i32 v97, s42, v96, 1
    v_and_b32 v97, 0x3f803f80, v97
    v_accvgpr_write_b32 a236, v97
    v_accvgpr_write_b32 a237, v97
    v_accvgpr_write_b32 a238, v97
    v_accvgpr_write_b32 a239, v97
    s_mov_b32 s42, 0x3222
    v_bfe_i32 v97, s42, v96, 1
    v_and_b32 v97, 0x3f803f80, v97
    v_accvgpr_write_b32 a240, v97
    v_accvgpr_write_b32 a241, v97
    v_accvgpr_write_b32 a242, v97
    v_accvgpr_write_b32 a243, v97
    s_mov_b32 s42, 0x5444
    v_bfe_i32 v97, s42, v96, 1
    v_and_b32 v97, 0x3f803f80, v97
    v_accvgpr_write_b32 a244, v97
    v_accvgpr_write_b32 a245, v97
    v_accvgpr_write_b32 a246, v97
    v_accvgpr_write_b32 a247, v97
    s_mov_b32 s42, 0x9888
    v_bfe_i32 v97, s42, v96, 1
    v_and_b32 v97, 0x3f803f80, v97
    v_accvgpr_write_b32 a248, v97
    v_accvgpr_write_b32 a249, v97
    v_accvgpr_write_b32 a250, v97
    v_accvgpr_write_b32 a251, v97
    s_mov_b32 s42, 0x1100
    v_bfe_i32 v97, s42, v96, 1
    v_and_b32 v97, 0x3f803f80, v97
    v_accvgpr_write_b32 a252, v97
    v_accvgpr_write_b32 a253, v97
    v_accvgpr_write_b32 a254, v97
    v_accvgpr_write_b32 a255, v97
    s_waitcnt vmcnt(18)
    s_barrier
    s_waitcnt vmcnt(12)
    s_add_u32 s48, s34, 18432
    s_add_u32 m0, s38, 18432
    s_nop 0
    buffer_load_dwordx4 v6, s[12:15], s48 offen nt lds
    s_add_u32 m0, s38, 19456
    s_nop 0
    buffer_load_dwordx4 v7, s[12:15], s48 offen nt lds
    v_lshrrev_b32 v105, 11, v0
    s_add_u32 s48, s34, 18560
    v_xor_b32 v105, s65, v105
    s_add_u32 m0, s38, 20480
    s_nop 0
    buffer_load_dwordx4 v6, s[12:15], s48 offen nt lds
    s_add_u32 m0, s38, 21504
    s_nop 0
    buffer_load_dwordx4 v7, s[12:15], s48 offen nt lds
    v_and_b32 v104, 0x3ff, v0
    ds_read_b128 a[232:235], v1 offset:2048
    ds_read_b128 a[212:215], v0 offset:0
    v_lshl_add_u32 v104, v105, 10, v104
    v_add_u32 v104, s38, v104
    s_add_u32 s48, s34, 18688
    s_add_u32 m0, s38, 22528
    v_xor_b32 v105, 64, v104
    buffer_load_dwordx4 v6, s[12:15], s48 offen nt lds
    ds_read_b128 a[220:223], v0 offset:1024
    s_add_u32 m0, s38, 23552
    ds_read_b128 a[96:99], v104 offset:0
    ds_read_b128 a[100:103], v105 offset:0
    buffer_load_dwordx4 v7, s[12:15], s48 offen nt lds
    ds_read_b128 a[108:111], v105 offset:2048
    ds_read_b128 a[112:115], v104 offset:4096
    ds_read_b128 a[224:227], v1 offset:1024
    ds_read_b128 a[216:219], v1 offset:0
    s_waitcnt lgkmcnt(5)
    v_mfma_f32_16x16x32_bf16 v[52:55], a[212:215], a[96:99], 0
    ds_read_b128 a[228:231], v0 offset:2048
    s_waitcnt lgkmcnt(1)
    v_mfma_f32_16x16x32_bf16 v[52:55], a[216:219], a[100:103], v[52:55]
    ds_read_b128 a[104:107], v104 offset:2048
    s_waitcnt lgkmcnt(0)
    v_mfma_f32_16x16x32_bf16 v[52:55], a[220:223], a[104:107], v[52:55]
    ds_read_b128 a[116:119], v105 offset:4096
    v_mfma_f32_16x16x32_bf16 v[52:55], a[224:227], a[108:111], v[52:55]
    ds_read_b128 a[220:223], v0 offset:7168
    v_mfma_f32_16x16x32_bf16 v[52:55], a[228:231], a[112:115], v[52:55]
    ds_read_b128 a[212:215], v0 offset:6144
    s_waitcnt lgkmcnt(2)
    v_mfma_f32_16x16x32_bf16 v[52:55], a[232:235], a[116:119], v[52:55]
    ds_read_b128 a[232:235], v1 offset:8192
    s_waitcnt lgkmcnt(1)
    v_mfma_f32_16x16x32_bf16 v[56:59], a[212:215], a[96:99], 0
    s_nop 4
    v_max3_f32 v96, v52, v53, v54
    ds_read_b128 a[216:219], v1 offset:6144
    s_waitcnt lgkmcnt(0)
    v_mfma_f32_16x16x32_bf16 v[56:59], a[216:219], a[100:103], v[56:59]
    ds_read_b128 a[224:227], v1 offset:7168
    v_mfma_f32_16x16x32_bf16 v[56:59], a[220:223], a[104:107], v[56:59]
    ds_read_b128 a[216:219], v1 offset:12288
    s_waitcnt lgkmcnt(1)
    v_mfma_f32_16x16x32_bf16 v[56:59], a[224:227], a[108:111], v[56:59]
    ds_read_b128 a[228:231], v0 offset:8192
    s_waitcnt lgkmcnt(0)
    v_mfma_f32_16x16x32_bf16 v[56:59], a[228:231], a[112:115], v[56:59]
    ds_read_b128 a[220:223], v0 offset:13312
    v_mfma_f32_16x16x32_bf16 v[56:59], a[232:235], a[116:119], v[56:59]
    s_nop 7
    v_max3_f32 v96, v96, v55, v56
    v_max3_f32 v96, v96, v57, v58
    v_max_f32 v96, v96, v59
    s_waitcnt vmcnt(12)
    s_add_u32 m0, s22, 24576
    ds_read_b128 a[232:235], v1 offset:14336
    buffer_load_dwordx4 v6, s[8:11], s21 offen lds
    s_add_u32 s21, s21, 128
    v_mov_b32 v97, v96
    s_add_u32 m0, s22, 25600
    s_nop 0
    buffer_load_dwordx4 v6, s[8:11], s21 offen lds
    s_add_u32 s21, s21, 128
    v_permlane32_swap_b32 v97, v96
    v_max_f32 v96, v96, v97
    s_add_u32 m0, s22, 26624
    v_mov_b32 v97, v96
    buffer_load_dwordx4 v6, s[8:11], s21 offen lds
    ds_read_b128 a[120:123], v104 offset:6144
    v_permlane16_swap_b32 v97, v96
    v_max_f32 v96, v96, v97
    v_mul_f32_e64 v9, -s28, v96
    v_fma_f32 v53, v53, s28, v9
    ds_read_b128 a[224:227], v1 offset:13312
    v_fma_f32 v54, v54, s28, v9
    v_fma_f32 v55, v55, s28, v9
    v_fma_f32 v57, v57, s28, v9
    v_fma_f32 v52, v52, s28, v9
    ds_read_b128 a[212:215], v0 offset:12288
    v_exp_f32 v55, v55
    v_exp_f32 v52, v52
    ds_read_b128 a[228:231], v0 offset:14336
    v_exp_f32 v53, v53
    v_exp_f32 v54, v54
    v_exp_f32 v57, v57
    v_cvt_pk_bf16_f32 v15, v54, v55
    v_fma_f32 v58, v58, s28, v9
    v_cvt_pk_bf16_f32 v14, v52, v53
    s_waitcnt lgkmcnt(1)
    v_mfma_f32_16x16x32_bf16 v[52:55], a[212:215], a[96:99], 0
    v_fma_f32 v59, v59, s28, v9
    ds_read_b128 a[124:127], v105 offset:6144
    v_mfma_f32_16x16x32_bf16 v[52:55], a[216:219], a[100:103], v[52:55]
    ds_read_b128 a[216:219], v1 offset:18432
    v_mfma_f32_16x16x32_bf16 v[52:55], a[220:223], a[104:107], v[52:55]
    ds_read_b128 a[212:215], v0 offset:18432
    v_fma_f32 v56, v56, s28, v9
    v_exp_f32 v56, v56
    v_mfma_f32_16x16x32_bf16 v[52:55], a[224:227], a[108:111], v[52:55]
    s_waitcnt lgkmcnt(3)
    v_exp_f32 v58, v58
    ds_read_b128 a[132:135], v105 offset:8192
    v_mfma_f32_16x16x32_bf16 v[52:55], a[228:231], a[112:115], v[52:55]
    ds_read_b128 a[224:227], v1 offset:19456
    v_cvt_pk_bf16_f32 v16, v56, v57
    v_exp_f32 v59, v59
    v_mfma_f32_16x16x32_bf16 v[52:55], a[232:235], a[116:119], v[52:55]
    ds_read_b128 a[220:223], v0 offset:19456
    v_cvt_pk_bf16_f32 v17, v58, v59
    s_waitcnt lgkmcnt(3)
    v_mfma_f32_16x16x32_bf16 v[56:59], a[212:215], a[96:99], 0
    ds_read_b128 a[212:215], v0 offset:0
    ds_read_b128 a[228:231], v0 offset:20480
    v_mfma_f32_16x16x32_bf16 v[56:59], a[216:219], a[100:103], v[56:59]
    ds_read_b128 a[136:139], v104 offset:10240
    s_waitcnt lgkmcnt(3)
    v_mfma_f32_16x16x32_bf16 v[56:59], a[220:223], a[104:107], v[56:59]
    ds_read_b128 a[128:131], v104 offset:8192
    ds_read_b128 a[220:223], v0 offset:1024
    v_mfma_f32_16x16x32_bf16 v[56:59], a[224:227], a[108:111], v[56:59]
    v_fma_f32 v52, v52, s28, v9
    ds_read_b128 a[232:235], v1 offset:20480
    s_waitcnt lgkmcnt(4)
    v_mfma_f32_16x16x32_bf16 v[56:59], a[228:231], a[112:115], v[56:59]
    ds_read_b128 a[216:219], v1 offset:0
    s_waitcnt lgkmcnt(1)
    v_mfma_f32_16x16x32_bf16 v[56:59], a[232:235], a[116:119], v[56:59]
    v_fma_f32 v55, v55, s28, v9
    s_add_u32 s21, s21, 12032
    ds_read_b128 a[140:143], v105 offset:10240
    v_mfma_f32_16x16x32_bf16 v[60:63], a[212:215], a[120:123], 0
    ds_read_b128 a[224:227], v1 offset:1024
    s_waitcnt lgkmcnt(2)
    v_mfma_f32_16x16x32_bf16 v[60:63], a[216:219], a[124:127], v[60:63]
    ds_read_b128 a[228:231], v0 offset:2048
    v_mfma_f32_16x16x32_bf16 v[60:63], a[220:223], a[128:131], v[60:63]
    ds_read_b128 a[232:235], v1 offset:2048
    s_waitcnt lgkmcnt(2)
    v_mfma_f32_16x16x32_bf16 v[60:63], a[224:227], a[132:135], v[60:63]
    ds_read_b128 a[220:223], v0 offset:7168
    s_waitcnt lgkmcnt(2)
    v_mfma_f32_16x16x32_bf16 v[60:63], a[228:231], a[136:139], v[60:63]
    ds_read_b128 a[216:219], v1 offset:6144
    s_waitcnt lgkmcnt(2)
    v_mfma_f32_16x16x32_bf16 v[60:63], a[232:235], a[140:143], v[60:63]
    ds_read_b128 a[212:215], v0 offset:6144
    v_exp_f32 v55, v55
    s_waitcnt lgkmcnt(0)
    v_mfma_f32_16x16x32_bf16 v[64:67], a[212:215], a[120:123], 0
    ds_read_b128 a[232:235], v1 offset:8192
    ds_read_b128 a[228:231], v0 offset:8192
    v_mfma_f32_16x16x32_bf16 v[64:67], a[216:219], a[124:127], v[64:67]
    ds_read_b128 a[224:227], v1 offset:7168
    v_mfma_f32_16x16x32_bf16 v[64:67], a[220:223], a[128:131], v[64:67]
    ds_read_b128 a[220:223], v0 offset:13312
    s_waitcnt lgkmcnt(1)
    v_mfma_f32_16x16x32_bf16 v[64:67], a[224:227], a[132:135], v[64:67]
    ds_read_b128 a[216:219], v1 offset:12288
    s_waitcnt vmcnt(9)
    s_add_u32 m0, s22, 36864
    ds_read_b128 a[212:215], v0 offset:12288
    buffer_load_dwordx4 v6, s[8:11], s21 offen lds
    v_max3_f32 v98, v60, v61, v62
    s_add_u32 s21, s21, 128
    v_mfma_f32_16x16x32_bf16 v[64:67], a[228:231], a[136:139], v[64:67]
    s_add_u32 m0, s22, 37888
    s_nop 0
    buffer_load_dwordx4 v6, s[8:11], s21 offen lds
    s_add_u32 s21, s21, 128
    ds_read_b128 a[148:151], v105 offset:12288
    ds_read_b128 a[164:167], v105 offset:16384
    v_mfma_f32_16x16x32_bf16 v[64:67], a[232:235], a[140:143], v[64:67]
    s_add_u32 m0, s22, 38912
    s_nop 0
    buffer_load_dwordx4 v6, s[8:11], s21 offen lds
    ds_read_b128 a[224:227], v1 offset:13312
    v_fma_f32 v53, v53, s28, v9
    s_nop 2
    v_max3_f32 v98, v98, v63, v64
    ds_read_b128 a[228:231], v0 offset:14336
    v_max3_f32 v98, v98, v65, v66
    v_max_f32 v98, v98, v67
    v_mov_b32 v99, v98
    s_nop 1
    v_permlane32_swap_b32 v99, v98
    v_max_f32 v98, v98, v99
    v_mov_b32 v99, v98
    s_nop 1
    v_permlane16_swap_b32 v99, v98
    v_max_f32 v98, v98, v99
    v_mul_f32_e64 v10, -s28, v98
    v_fma_f32 v60, v60, s28, v10
    v_exp_f32 v60, v60
    v_fma_f32 v62, v62, s28, v10
    v_mfma_f32_16x16x32_bf16 v[44:47], a[236:239], v[14:17], 0
    v_fma_f32 v61, v61, s28, v10
    v_exp_f32 v62, v62
    v_exp_f32 v61, v61
    s_nop 0
    v_cvt_pk_bf16_f32 v20, v60, v61
    v_fma_f32 v66, v66, s28, v10
    v_fma_f32 v63, v63, s28, v10
    v_fma_f32 v64, v64, s28, v10
    v_exp_f32 v63, v63
    v_exp_f32 v66, v66
    ds_read_b128 a[232:235], v1 offset:14336
    v_cvt_pk_bf16_f32 v21, v62, v63
    v_fma_f32 v67, v67, s28, v10
    s_waitcnt lgkmcnt(1)
    v_mfma_f32_16x16x32_bf16 v[60:63], a[212:215], a[120:123], 0
    v_fma_f32 v65, v65, s28, v10
    ds_read_b128 a[152:155], v104 offset:14336
    v_exp_f32 v67, v67
    ds_read_b128 a[212:215], v0 offset:18432
    v_mfma_f32_16x16x32_bf16 v[60:63], a[216:219], a[124:127], v[60:63]
    ds_read_b128 a[216:219], v1 offset:18432
    v_mfma_f32_16x16x32_bf16 v[60:63], a[220:223], a[128:131], v[60:63]
    ds_read_b128 a[220:223], v0 offset:19456
    v_fma_f32 v54, v54, s28, v9
    ds_read_b128 a[156:159], v105 offset:14336
    v_exp_f32 v64, v64
    v_exp_f32 v65, v65
    v_mfma_f32_16x16x32_bf16 v[60:63], a[224:227], a[132:135], v[60:63]
    ds_read_b128 a[160:163], v104 offset:16384
    v_mfma_f32_16x16x32_bf16 v[60:63], a[228:231], a[136:139], v[60:63]
    v_cvt_pk_bf16_f32 v22, v64, v65
    ds_read_b128 a[224:227], v1 offset:19456
    s_waitcnt lgkmcnt(7)
    v_mfma_f32_16x16x32_bf16 v[60:63], a[232:235], a[140:143], v[60:63]
    v_cvt_pk_bf16_f32 v23, v66, v67
    ds_read_b128 a[228:231], v0 offset:20480
    s_waitcnt lgkmcnt(6)
    v_mfma_f32_16x16x32_bf16 v[64:67], a[212:215], a[120:123], 0
    ds_read_b128 a[144:147], v104 offset:12288
    s_waitcnt lgkmcnt(6)
    v_mfma_f32_16x16x32_bf16 v[64:67], a[216:219], a[124:127], v[64:67]
    ds_read_b128 a[212:215], v0 offset:0
    ds_read_b128 a[232:235], v1 offset:20480
    s_waitcnt lgkmcnt(7)
    v_mfma_f32_16x16x32_bf16 v[64:67], a[220:223], a[128:131], v[64:67]
    ds_read_b128 a[216:219], v1 offset:0
    v_exp_f32 v52, v52
    s_waitcnt lgkmcnt(5)
    v_mfma_f32_16x16x32_bf16 v[64:67], a[224:227], a[132:135], v[64:67]
    ds_read_b128 a[220:223], v0 offset:1024
    s_waitcnt lgkmcnt(5)
    v_mfma_f32_16x16x32_bf16 v[64:67], a[228:231], a[136:139], v[64:67]
    ds_read_b128 a[224:227], v1 offset:1024
    s_waitcnt lgkmcnt(3)
    v_mfma_f32_16x16x32_bf16 v[64:67], a[232:235], a[140:143], v[64:67]
    ds_read_b128 a[228:231], v0 offset:2048
    v_mfma_f32_16x16x32_bf16 v[68:71], a[212:215], a[144:147], 0
    s_waitcnt lgkmcnt(3)
    ds_read_b128 a[232:235], v1 offset:2048
    v_mfma_f32_16x16x32_bf16 v[68:71], a[216:219], a[148:151], v[68:71]
    ds_read_b128 a[212:215], v0 offset:6144
    s_waitcnt lgkmcnt(4)
    v_mfma_f32_16x16x32_bf16 v[68:71], a[220:223], a[152:155], v[68:71]
    v_exp_f32 v54, v54
    s_add_u32 s21, s21, 12032
    ds_read_b128 a[216:219], v1 offset:6144
    s_waitcnt lgkmcnt(4)
    v_mfma_f32_16x16x32_bf16 v[68:71], a[224:227], a[156:159], v[68:71]
    ds_read_b128 a[224:227], v1 offset:7168
    v_fma_f32 v61, v61, s28, v10
    s_waitcnt lgkmcnt(4)
    v_mfma_f32_16x16x32_bf16 v[68:71], a[228:231], a[160:163], v[68:71]
    ds_read_b128 a[220:223], v0 offset:7168
    s_waitcnt lgkmcnt(4)
    v_mfma_f32_16x16x32_bf16 v[68:71], a[232:235], a[164:167], v[68:71]
    ds_read_b128 a[228:231], v0 offset:8192
    s_waitcnt lgkmcnt(4)
    v_mfma_f32_16x16x32_bf16 v[72:75], a[212:215], a[144:147], 0
    ds_read_b128 a[232:235], v1 offset:8192
    s_waitcnt lgkmcnt(4)
    v_mfma_f32_16x16x32_bf16 v[72:75], a[216:219], a[148:151], v[72:75]
    ds_read_b128 a[216:219], v1 offset:12288
    s_nop 0
    v_max3_f32 v96, v68, v69, v70
    s_waitcnt lgkmcnt(3)
    v_mfma_f32_16x16x32_bf16 v[72:75], a[220:223], a[152:155], v[72:75]
    ds_read_b128 a[220:223], v0 offset:13312
    v_mfma_f32_16x16x32_bf16 v[72:75], a[224:227], a[156:159], v[72:75]
    s_waitcnt lgkmcnt(3)
    ds_read_b128 a[212:215], v0 offset:12288
    v_mfma_f32_16x16x32_bf16 v[72:75], a[228:231], a[160:163], v[72:75]
    s_waitcnt lgkmcnt(3)
    ds_read_b128 a[228:231], v0 offset:14336
    v_mfma_f32_16x16x32_bf16 v[72:75], a[232:235], a[164:167], v[72:75]
    s_nop 7
    v_max3_f32 v96, v96, v71, v72
    ds_read_b128 a[224:227], v1 offset:13312
    v_max3_f32 v96, v96, v73, v74
    v_max_f32 v96, v96, v75
    v_mov_b32 v97, v96
    s_nop 1
    v_permlane32_swap_b32 v97, v96
    v_max_f32 v96, v96, v97
    v_mov_b32 v97, v96
    s_nop 1
    v_permlane16_swap_b32 v97, v96
    v_max_f32 v96, v96, v97
    v_mfma_f32_16x16x32_bf16 v[44:47], a[240:243], v[20:23], v[44:47]
    ds_read_b128 a[232:235], v1 offset:14336
    v_mul_f32_e64 v11, -s28, v96
    v_fma_f32 v69, v69, s28, v11
    v_fma_f32 v73, v73, s28, v11
    v_fma_f32 v74, v74, s28, v11
    v_fma_f32 v70, v70, s28, v11
    v_fma_f32 v68, v68, s28, v11
    v_exp_f32 v70, v70
    v_fma_f32 v71, v71, s28, v11
    v_exp_f32 v69, v69
    v_exp_f32 v53, v53
    v_exp_f32 v68, v68
    v_exp_f32 v71, v71
    v_cvt_pk_bf16_f32 v26, v68, v69
    v_cvt_pk_bf16_f32 v27, v70, v71
    v_exp_f32 v74, v74
    v_exp_f32 v73, v73
    s_waitcnt lgkmcnt(1)
    v_mfma_f32_16x16x32_bf16 v[68:71], a[212:215], a[144:147], 0
    v_fma_f32 v75, v75, s28, v11
    v_fma_f32 v72, v72, s28, v11
    ds_read_b128 a[212:215], v0 offset:18432
    v_mfma_f32_16x16x32_bf16 v[68:71], a[216:219], a[148:151], v[68:71]
    v_cvt_pk_bf16_f32 v19, v54, v55
    ds_read_b128 a[216:219], v1 offset:18432
    v_mfma_f32_16x16x32_bf16 v[68:71], a[220:223], a[152:155], v[68:71]
    ds_read_b128 a[220:223], v0 offset:19456
    v_mfma_f32_16x16x32_bf16 v[68:71], a[224:227], a[156:159], v[68:71]
    ds_read_b128 a[224:227], v1 offset:19456
    v_exp_f32 v75, v75
    v_exp_f32 v61, v61
    v_exp_f32 v72, v72
    s_nop 0
    v_cvt_pk_bf16_f32 v28, v72, v73
    v_fma_f32 v60, v60, s28, v10
    v_mfma_f32_16x16x32_bf16 v[68:71], a[228:231], a[160:163], v[68:71]
    s_waitcnt lgkmcnt(4)
    ds_read_b128 a[228:231], v0 offset:20480
    v_cvt_pk_bf16_f32 v29, v74, v75
    v_mfma_f32_16x16x32_bf16 v[68:71], a[232:235], a[164:167], v[68:71]
    ds_read_b128 a[232:235], v1 offset:20480
    s_waitcnt lgkmcnt(5)
    v_mfma_f32_16x16x32_bf16 v[72:75], a[212:215], a[144:147], 0
    ds_read_b128 a[212:215], v0 offset:0
    s_waitcnt lgkmcnt(5)
    v_mfma_f32_16x16x32_bf16 v[72:75], a[216:219], a[148:151], v[72:75]
    ds_read_b128 a[216:219], v1 offset:0
    v_exp_f32 v60, v60
    s_waitcnt lgkmcnt(5)
    v_mfma_f32_16x16x32_bf16 v[72:75], a[220:223], a[152:155], v[72:75]
    s_waitcnt vmcnt(6)
    ds_read_b128 a[168:171], v104 offset:18432
    ds_read_b128 a[172:175], v105 offset:18432
    s_waitcnt lgkmcnt(6)
    v_mfma_f32_16x16x32_bf16 v[72:75], a[224:227], a[156:159], v[72:75]
    ds_read_b128 a[220:223], v0 offset:1024
    ds_read_b128 a[224:227], v1 offset:1024
    ds_read_b128 a[176:179], v104 offset:20480
    s_waitcnt lgkmcnt(8)
    v_mfma_f32_16x16x32_bf16 v[72:75], a[228:231], a[160:163], v[72:75]
    s_waitcnt lgkmcnt(7)
    ds_read_b128 a[180:183], v105 offset:20480
    v_mfma_f32_16x16x32_bf16 v[72:75], a[232:235], a[164:167], v[72:75]
    ds_read_b128 a[228:231], v0 offset:2048
    ds_read_b128 a[184:187], v104 offset:22528
    v_mfma_f32_16x16x32_bf16 v[44:47], a[244:247], v[26:29], v[44:47]
    ds_read_b128 a[232:235], v1 offset:2048
    ds_read_b128 a[188:191], v105 offset:22528
    s_waitcnt lgkmcnt(9)
    v_mfma_f32_16x16x32_bf16 v[76:79], a[212:215], a[168:171], 0
    s_waitcnt lgkmcnt(8)
    ds_read_b128 a[212:215], v0 offset:6144
    v_mfma_f32_16x16x32_bf16 v[76:79], a[216:219], a[172:175], v[76:79]
    ds_read_b128 a[216:219], v1 offset:6144
    s_waitcnt lgkmcnt(7)
    v_mfma_f32_16x16x32_bf16 v[76:79], a[220:223], a[176:179], v[76:79]
    ds_read_b128 a[220:223], v0 offset:7168
    s_waitcnt lgkmcnt(7)
    v_mfma_f32_16x16x32_bf16 v[76:79], a[224:227], a[180:183], v[76:79]
    ds_read_b128 a[224:227], v1 offset:7168
    s_waitcnt lgkmcnt(6)
    v_mfma_f32_16x16x32_bf16 v[76:79], a[228:231], a[184:187], v[76:79]
    ds_read_b128 a[228:231], v0 offset:8192
    s_waitcnt lgkmcnt(5)
    v_mfma_f32_16x16x32_bf16 v[76:79], a[232:235], a[188:191], v[76:79]
    ds_read_b128 a[232:235], v1 offset:8192
    s_waitcnt lgkmcnt(5)
    v_mfma_f32_16x16x32_bf16 v[80:83], a[212:215], a[168:171], 0
    s_waitcnt lgkmcnt(4)
    v_mfma_f32_16x16x32_bf16 v[80:83], a[216:219], a[172:175], v[80:83]
    s_nop 2
    v_max3_f32 v98, v76, v77, v78
    s_waitcnt lgkmcnt(3)
    v_mfma_f32_16x16x32_bf16 v[80:83], a[220:223], a[176:179], v[80:83]
    s_waitcnt vmcnt(63) lgkmcnt(0)
    s_barrier
    ds_read_b128 a[212:215], v0 offset:12288
    v_mfma_f32_16x16x32_bf16 v[80:83], a[224:227], a[180:183], v[80:83]
    s_add_u32 m0, s22, 0
    ds_read_b128 a[220:223], v0 offset:13312
    buffer_load_dwordx4 v6, s[4:7], s20 offen lds
    s_add_u32 s20, s20, 128
    v_mfma_f32_16x16x32_bf16 v[80:83], a[228:231], a[184:187], v[80:83]
    s_add_u32 m0, s22, 1024
    ds_read_b128 a[216:219], v1 offset:12288
    buffer_load_dwordx4 v6, s[4:7], s20 offen lds
    v_mfma_f32_16x16x32_bf16 v[80:83], a[232:235], a[188:191], v[80:83]
    s_add_u32 s20, s20, 128
    s_add_u32 m0, s22, 2048
    ds_read_b128 a[228:231], v0 offset:14336
    ds_read_b128 a[224:227], v1 offset:13312
    buffer_load_dwordx4 v6, s[4:7], s20 offen lds
    s_add_u32 s20, s20, 12032
    s_mov_b32 s39, s64
    s_add_u32 s37, s37, 1
    v_max3_f32 v98, v98, v79, v80
    v_max3_f32 v98, v98, v81, v82
    v_max_f32 v98, v98, v83
    v_mov_b32 v99, v98
    s_bitcmp1_b32 s63, s37
    s_cselect_b32 s62, 4294770688, 0
    v_permlane32_swap_b32 v99, v98
    v_max_f32 v98, v98, v99
    v_mov_b32 v99, v98
    s_cselect_b32 s42, 0, 325632
    s_add_u32 s35, s35, s42
    ds_read_b128 a[232:235], v1 offset:14336
    v_permlane16_swap_b32 v99, v98
    v_max_f32 v98, v98, v99
    v_mul_f32_e64 v12, -s28, v98
    s_lshl_b32 s42, s37, 1
    v_fma_f32 v77, v77, s28, v12
    v_fma_f32 v76, v76, s28, v12
    v_fma_f32 v79, v79, s28, v12
    v_fma_f32 v78, v78, s28, v12
    v_exp_f32 v79, v79
    v_exp_f32 v76, v76
    v_exp_f32 v77, v77
    v_exp_f32 v78, v78
    v_cvt_pk_bf16_f32 v32, v76, v77
    v_cvt_pk_bf16_f32 v33, v78, v79
    s_waitcnt lgkmcnt(1)
    v_mfma_f32_16x16x32_bf16 v[76:79], a[212:215], a[168:171], 0
    s_lshr_b32 s42, s31, s42
    s_and_b32 s42, s42, 3
    ds_read_b128 a[212:215], v0 offset:18432
    v_mfma_f32_16x16x32_bf16 v[76:79], a[216:219], a[172:175], v[76:79]
    s_add_u32 s42, s42, s36
    ds_read_b128 a[216:219], v1 offset:18432
    s_sub_u32 s43, s42, 3
    v_mfma_f32_16x16x32_bf16 v[76:79], a[220:223], a[176:179], v[76:79]
    s_cmp_ge_u32 s42, 3
    ds_read_b128 a[220:223], v0 offset:19456
    v_fma_f32 v83, v83, s28, v12
    v_mfma_f32_16x16x32_bf16 v[76:79], a[224:227], a[180:183], v[76:79]
    s_cselect_b32 s42, s43, s42
    ds_read_b128 a[224:227], v1 offset:19456
    s_mul_i32 s44, s3, 5
    v_mfma_f32_16x16x32_bf16 v[76:79], a[228:231], a[184:187], v[76:79]
    s_mov_b32 s32, 1
    ds_read_b128 a[228:231], v0 offset:20480
    s_waitcnt lgkmcnt(5)
    v_mfma_f32_16x16x32_bf16 v[76:79], a[232:235], a[188:191], v[76:79]
    s_lshl_b32 s43, s3, 2
    ds_read_b128 a[232:235], v1 offset:20480
    s_add_u32 s45, s43, 21
    s_cmp_eq_u32 s3, 0
    v_fma_f32 v80, v80, s28, v12
    s_cselect_b32 s45, 20, s45
    s_cselect_b32 s33, 1, 0
    s_cmp_eq_u32 s42, 1
    s_cselect_b32 s44, s45, s44
    s_cselect_b32 s32, s33, s32
    s_add_u32 s45, s43, 37
    s_cmp_eq_u32 s42, 2
    v_exp_f32 v83, v83
    s_cselect_b32 s44, s45, s44
    s_cselect_b32 s32, 0, s32
    s_mul_i32 s44, s44, 6144
    v_exp_f32 v80, v80
    s_add_u32 s33, s35, s44
    s_mul_i32 s42, s32, 6144
    v_fma_f32 v81, v81, s28, v12
    v_fma_f32 v82, v82, s28, v12
    s_add_u32 s42, s42, 24576
    s_add_u32 s42, s42, s33
    s_cmp_ge_u32 s37, 6
    v_exp_f32 v81, v81
    s_cselect_b32 s14, 0, s42
    s_add_u32 s24, s67, 6400
    s_add_u32 s25, s33, 6400
    v_exp_f32 v82, v82
    s_add_u32 s23, s38, 10240
    s_mov_b32 s27, 0x49249249
    v_cvt_pk_bf16_f32 v34, v80, v81
    v_cvt_pk_bf16_f32 v35, v82, v83
    s_mov_b32 s30, 0
    s_waitcnt vmcnt(6) lgkmcnt(0)
    v_mfma_f32_16x16x32_bf16 v[80:83], a[212:215], a[168:171], 0
    s_barrier
    ds_read_b64_tr_b16 a[212:213], v2 offset:0
    ds_read_b64_tr_b16 a[214:215], v2 offset:6144
    s_add_u32 m0, s22, 12288
    v_mfma_f32_16x16x32_bf16 v[80:83], a[216:219], a[172:175], v[80:83]
    ds_read_b64_tr_b16 a[216:217], v3 offset:0
    buffer_load_dwordx4 v6, s[4:7], s20 offen lds
    s_add_u32 s20, s20, 128
    v_mfma_f32_16x16x32_bf16 v[80:83], a[220:223], a[176:179], v[80:83]
    ds_read_b64_tr_b16 a[218:219], v3 offset:6144
    s_add_u32 m0, s22, 13312
    v_mfma_f32_16x16x32_bf16 v[80:83], a[224:227], a[180:183], v[80:83]
    buffer_load_dwordx4 v6, s[4:7], s20 offen lds
    v_cvt_pk_bf16_f32 v18, v52, v53
    s_add_u32 s20, s20, 128
    ds_read_b64_tr_b16 a[220:221], v4 offset:0
    v_mfma_f32_16x16x32_bf16 v[80:83], a[228:231], a[184:187], v[80:83]
    ds_read_b64_tr_b16 a[222:223], v4 offset:6144
    v_cvt_pk_bf16_f32 v24, v60, v61
    v_mfma_f32_16x16x32_bf16 v[44:47], a[248:251], v[32:35], v[44:47]
    ds_read_b64_tr_b16 a[224:225], v5 offset:0
    s_add_u32 m0, s22, 14336
    s_nop 0
    buffer_load_dwordx4 v6, s[4:7], s20 offen lds
    ds_read_b64_tr_b16 a[226:227], v5 offset:6144
    v_mfma_f32_16x16x32_bf16 v[80:83], a[232:235], a[188:191], v[80:83]
    s_add_u32 s20, s20, 12032
    s_waitcnt lgkmcnt(6)
    v_mfma_f32_16x16x32_bf16 v[112:115], a[212:215], v[14:17], 0
    ds_read_b64_tr_b16 a[230:231], v2 offset:7168
    v_fma_f32 v56, v56, s28, v9
    v_mfma_f32_16x16x32_bf16 v[160:163], a[212:215], v[20:23], 0
    ds_read_b64_tr_b16 a[234:235], v3 offset:7168
    v_fma_f32 v67, v67, s28, v10
    v_mfma_f32_16x16x32_bf16 v[208:211], a[212:215], v[26:29], 0
    v_fma_f32 v65, v65, s28, v10
    v_fma_f32 v63, v63, s28, v10
    v_mfma_f32_16x16x32_bf16 a[0:3], a[212:215], v[32:35], 0
    ds_read_b64_tr_b16 a[212:213], v4 offset:1024
    s_waitcnt lgkmcnt(7)
    v_mfma_f32_16x16x32_bf16 v[116:119], a[216:219], v[14:17], 0
    ds_read_b64_tr_b16 a[228:229], v2 offset:1024
    v_fma_f32 v78, v78, s28, v12
    v_mfma_f32_16x16x32_bf16 v[164:167], a[216:219], v[20:23], 0
    ds_read_b64_tr_b16 a[232:233], v3 offset:1024
    v_fma_f32 v82, v82, s28, v12
    v_mfma_f32_16x16x32_bf16 v[212:215], a[216:219], v[26:29], 0
    v_fma_f32 v69, v69, s28, v11
    v_fma_f32 v79, v79, s28, v12
    v_mfma_f32_16x16x32_bf16 a[4:7], a[216:219], v[32:35], 0
    ds_read_b64_tr_b16 a[218:219], v5 offset:7168
    s_waitcnt lgkmcnt(8)
    v_mfma_f32_16x16x32_bf16 v[120:123], a[220:223], v[14:17], 0
    ds_read_b64_tr_b16 a[216:217], v5 offset:1024
    v_fma_f32 v81, v81, s28, v12
    v_mfma_f32_16x16x32_bf16 v[168:171], a[220:223], v[20:23], 0
    v_fma_f32 v68, v68, s28, v11
    v_fma_f32 v76, v76, s28, v12
    v_mfma_f32_16x16x32_bf16 v[216:219], a[220:223], v[26:29], 0
    v_fma_f32 v75, v75, s28, v11
    v_fma_f32 v71, v71, s28, v11
    v_mfma_f32_16x16x32_bf16 a[8:11], a[220:223], v[32:35], 0
    s_waitcnt lgkmcnt(5)
    ds_read_b64_tr_b16 a[222:223], v2 offset:8192
    v_fma_f32 v77, v77, s28, v12
    v_mfma_f32_16x16x32_bf16 v[124:127], a[224:227], v[14:17], 0
    v_fma_f32 v64, v64, s28, v10
    v_fma_f32 v59, v59, s28, v9
    v_mfma_f32_16x16x32_bf16 v[172:175], a[224:227], v[20:23], 0
    ds_read_b64_tr_b16 a[214:215], v4 offset:7168
    v_fma_f32 v74, v74, s28, v11
    v_mfma_f32_16x16x32_bf16 v[220:223], a[224:227], v[26:29], 0
    s_add_u32 s39, s39, 12288
    v_exp_f32 v76, v76
    v_mfma_f32_16x16x32_bf16 a[12:15], a[224:227], v[32:35], 0
    s_waitcnt lgkmcnt(4)
    v_exp_f32 v64, v64
    v_mfma_f32_16x16x32_bf16 v[128:131], a[228:231], v[14:17], 0
    ds_read_b64_tr_b16 a[224:225], v3 offset:2048
    v_mfma_f32_16x16x32_bf16 v[176:179], a[228:231], v[20:23], 0
    v_exp_f32 v78, v78
    v_mfma_f32_16x16x32_bf16 v[224:227], a[228:231], v[26:29], 0
    v_exp_f32 v56, v56
    v_mfma_f32_16x16x32_bf16 a[16:19], a[228:231], v[32:35], 0
    ds_read_b64_tr_b16 a[226:227], v3 offset:8192
    v_fma_f32 v83, v83, s28, v12
    v_mfma_f32_16x16x32_bf16 v[132:135], a[232:235], v[14:17], 0
    ds_read_b64_tr_b16 a[228:229], v4 offset:2048
    v_fma_f32 v73, v73, s28, v11
    v_mfma_f32_16x16x32_bf16 v[180:183], a[232:235], v[20:23], 0
    ds_read_b64_tr_b16 a[220:221], v2 offset:2048
    v_fma_f32 v70, v70, s28, v11
    v_mfma_f32_16x16x32_bf16 v[228:231], a[232:235], v[26:29], 0
    ds_read_b64_tr_b16 a[230:231], v4 offset:8192
    v_fma_f32 v62, v62, s28, v10
    v_mfma_f32_16x16x32_bf16 a[20:23], a[232:235], v[32:35], 0
    s_waitcnt lgkmcnt(5)
    ds_read_b64_tr_b16 a[234:235], v5 offset:8192
    v_fma_f32 v58, v58, s28, v9
    v_mfma_f32_16x16x32_bf16 v[136:139], a[212:215], v[14:17], 0
    ds_read_b64_tr_b16 a[232:233], v5 offset:2048
    v_fma_f32 v66, v66, s28, v10
    v_mfma_f32_16x16x32_bf16 v[184:187], a[212:215], v[20:23], 0
    v_exp_f32 v63, v63
    v_mfma_f32_16x16x32_bf16 v[232:235], a[212:215], v[26:29], 0
    v_exp_f32 v71, v71
    v_mfma_f32_16x16x32_bf16 a[24:27], a[212:215], v[32:35], 0
    v_exp_f32 v65, v65
    v_mfma_f32_16x16x32_bf16 v[140:143], a[216:219], v[14:17], 0
    v_exp_f32 v68, v68
    v_mfma_f32_16x16x32_bf16 v[188:191], a[216:219], v[20:23], 0
    v_exp_f32 v70, v70
    v_mfma_f32_16x16x32_bf16 v[236:239], a[216:219], v[26:29], 0
    v_exp_f32 v81, v81
    v_mfma_f32_16x16x32_bf16 a[28:31], a[216:219], v[32:35], 0
    s_waitcnt lgkmcnt(3)
    v_exp_f32 v58, v58
    v_mfma_f32_16x16x32_bf16 v[144:147], a[220:223], v[14:17], 0
    v_exp_f32 v79, v79
    v_mfma_f32_16x16x32_bf16 v[192:195], a[220:223], v[20:23], 0
    v_exp_f32 v77, v77
    s_waitcnt vmcnt(3) lgkmcnt(0)
    v_mfma_f32_16x16x32_bf16 v[240:243], a[220:223], v[26:29], 0
    s_barrier
    v_mfma_f32_16x16x32_bf16 a[32:35], a[220:223], v[32:35], 0
    s_add_u32 m0, s22, 24576
    ds_read_b128 a[212:215], v0 offset:0
    v_fma_f32 v72, v72, s28, v11
    v_mfma_f32_16x16x32_bf16 v[148:151], a[224:227], v[14:17], 0
    v_exp_f32 v62, v62
    v_mfma_f32_16x16x32_bf16 v[196:199], a[224:227], v[20:23], 0
    buffer_load_dwordx4 v6, s[8:11], s21 offen lds
    v_mfma_f32_16x16x32_bf16 v[244:247], a[224:227], v[26:29], 0
    s_add_u32 s21, s21, 128
    ds_read_b128 a[216:219], v1 offset:0
    v_cvt_pk_bf16_f32 v31, v70, v71
    v_mfma_f32_16x16x32_bf16 a[36:39], a[224:227], v[32:35], 0
    ds_read_b128 a[220:223], v0 offset:1024
    s_add_u32 m0, s22, 25600
    v_mfma_f32_16x16x32_bf16 v[152:155], a[228:231], v[14:17], 0
    buffer_load_dwordx4 v6, s[8:11], s21 offen lds
    v_mfma_f32_16x16x32_bf16 v[200:203], a[228:231], v[20:23], 0
    s_add_u32 s21, s21, 128
    v_exp_f32 v69, v69
    v_mfma_f32_16x16x32_bf16 v[248:251], a[228:231], v[26:29], 0
    v_exp_f32 v73, v73
    v_mfma_f32_16x16x32_bf16 a[40:43], a[228:231], v[32:35], 0
    ds_read_b128 a[228:231], v0 offset:2048
    s_add_u32 m0, s22, 26624
    v_mfma_f32_16x16x32_bf16 v[156:159], a[232:235], v[14:17], 0
    v_fma_f32 v57, v57, s28, v9
    v_cvt_pk_bf16_f32 v37, v78, v79
    v_mfma_f32_16x16x32_bf16 v[204:207], a[232:235], v[20:23], 0
    buffer_load_dwordx4 v6, s[8:11], s21 offen lds
    v_mfma_f32_16x16x32_bf16 v[252:255], a[232:235], v[26:29], 0
    v_exp_f32 v67, v67
    v_mfma_f32_16x16x32_bf16 a[44:47], a[232:235], v[32:35], 0
    s_waitcnt lgkmcnt(3)
    v_cvt_pk_bf16_f32 v36, v76, v77
    s_add_u32 s21, s21, 12032
    v_mfma_f32_16x16x32_bf16 v[52:55], a[212:215], a[96:99], 0
    s_waitcnt lgkmcnt(2)
    ds_read_b128 a[224:227], v1 offset:1024
    v_cvt_pk_bf16_f32 v25, v62, v63
    v_mfma_f32_16x16x32_bf16 v[52:55], a[216:219], a[100:103], v[52:55]
    s_waitcnt lgkmcnt(2)
    ds_read_b128 a[232:235], v1 offset:2048
    v_cvt_pk_bf16_f32 v22, v64, v65
    v_mfma_f32_16x16x32_bf16 v[52:55], a[220:223], a[104:107], v[52:55]
    v_cvt_pk_bf16_f32 v30, v68, v69
    s_add_u32 m0, s38, 0
    v_mfma_f32_16x16x32_bf16 v[60:63], a[212:215], a[120:123], 0
    buffer_load_dwordx4 v6, s[12:15], s33 offen nt lds
    v_mfma_f32_16x16x32_bf16 v[60:63], a[216:219], a[124:127], v[60:63]
    s_add_u32 m0, s38, 1024
    v_exp_f32 v74, v74
    v_mfma_f32_16x16x32_bf16 v[60:63], a[220:223], a[128:131], v[60:63]
    buffer_load_dwordx4 v7, s[12:15], s33 offen nt lds
    v_mfma_f32_16x16x32_bf16 v[68:71], a[212:215], a[144:147], 0
    s_add_u32 s59, s33, 6144
    v_exp_f32 v59, v59
    v_mfma_f32_16x16x32_bf16 v[68:71], a[216:219], a[148:151], v[68:71]
    v_exp_f32 v57, v57
    v_mfma_f32_16x16x32_bf16 v[68:71], a[220:223], a[152:155], v[68:71]
    v_exp_f32 v83, v83
    v_mfma_f32_16x16x32_bf16 v[76:79], a[212:215], a[168:171], 0
    s_add_u32 m0, s38, 6144
    ds_read_b128 a[212:215], v0 offset:6144
    v_mfma_f32_16x16x32_bf16 v[76:79], a[216:219], a[172:175], v[76:79]
    v_exp_f32 v72, v72
    v_mfma_f32_16x16x32_bf16 v[76:79], a[220:223], a[176:179], v[76:79]
    s_waitcnt lgkmcnt(1)
    v_fma_f32 v80, v80, s28, v12
    v_mfma_f32_16x16x32_bf16 v[52:55], a[224:227], a[108:111], v[52:55]
    buffer_load_dwordx4 v6, s[12:15], s59 offen nt lds
    v_mfma_f32_16x16x32_bf16 v[52:55], a[228:231], a[112:115], v[52:55]
    s_add_u32 m0, s38, 7168
    v_exp_f32 v66, v66
    v_mfma_f32_16x16x32_bf16 v[52:55], a[232:235], a[116:119], v[52:55]
    ds_read_b128 a[216:219], v1 offset:6144
    v_cvt_pk_bf16_f32 v28, v72, v73
    v_mfma_f32_16x16x32_bf16 v[60:63], a[224:227], a[132:135], v[60:63]
    buffer_load_dwordx4 v7, s[12:15], s59 offen nt lds
    v_mfma_f32_16x16x32_bf16 v[60:63], a[228:231], a[136:139], v[60:63]
    s_add_u32 s58, s33, 128
    ds_read_b128 a[220:223], v0 offset:7168
    s_add_u32 m0, s38, 2048
    v_mfma_f32_16x16x32_bf16 v[60:63], a[232:235], a[140:143], v[60:63]
    v_cvt_pk_bf16_f32 v16, v56, v57
    v_cvt_pk_bf16_f32 v17, v58, v59
    v_mfma_f32_16x16x32_bf16 v[68:71], a[224:227], a[156:159], v[68:71]
    buffer_load_dwordx4 v6, s[12:15], s58 offen nt lds
    v_mfma_f32_16x16x32_bf16 v[68:71], a[228:231], a[160:163], v[68:71]
    s_add_u32 m0, s38, 3072
    v_exp_f32 v75, v75
    v_mfma_f32_16x16x32_bf16 v[68:71], a[232:235], a[164:167], v[68:71]
    buffer_load_dwordx4 v7, s[12:15], s58 offen nt lds
    v_mfma_f32_16x16x32_bf16 v[76:79], a[224:227], a[180:183], v[76:79]
    ds_read_b128 a[224:227], v1 offset:7168
    v_cvt_pk_bf16_f32 v29, v74, v75
    v_mfma_f32_16x16x32_bf16 v[76:79], a[228:231], a[184:187], v[76:79]
    s_add_u32 s59, s33, 6272
    ds_read_b128 a[228:231], v0 offset:8192
    v_cvt_pk_bf16_f32 v23, v66, v67
    v_mfma_f32_16x16x32_bf16 v[76:79], a[232:235], a[188:191], v[76:79]
    s_waitcnt lgkmcnt(4)
    ds_read_b128 a[232:235], v1 offset:8192
    s_add_u32 m0, s38, 8192
    v_mfma_f32_16x16x32_bf16 v[56:59], a[212:215], a[96:99], 0
    buffer_load_dwordx4 v6, s[12:15], s59 offen nt lds
    v_mfma_f32_16x16x32_bf16 v[48:51], a[236:239], v[16:19], v[44:47]
    v_exp_f32 v82, v82
    v_mfma_f32_16x16x32_bf16 v[48:51], a[240:243], v[22:25], v[48:51]
    s_add_u32 m0, s38, 9216
    v_exp_f32 v80, v80
    v_mfma_f32_16x16x32_bf16 v[48:51], a[244:247], v[28:31], v[48:51]
    s_waitcnt lgkmcnt(3)
    v_cvt_pk_bf16_f32 v35, v82, v83
    v_cvt_pk_bf16_f32 v34, v80, v81
    v_mfma_f32_16x16x32_bf16 v[56:59], a[216:219], a[100:103], v[56:59]
    buffer_load_dwordx4 v7, s[12:15], s59 offen nt lds
    v_mfma_f32_16x16x32_bf16 v[48:51], a[248:251], v[34:37], v[48:51]
    s_add_u32 s58, s33, 256
    v_add_u32 v8, 10240, v8
    s_add_u32 m0, s38, 4096
    v_mfma_f32_16x16x32_bf16 v[56:59], a[220:223], a[104:107], v[56:59]
    buffer_load_dwordx4 v6, s[12:15], s58 offen nt lds
    v_mfma_f32_16x16x32_bf16 v[64:67], a[212:215], a[120:123], 0
    s_add_u32 m0, s38, 5120
    s_nop 0
    v_cmp_lt_f32 vcc, s29, v48
    v_mfma_f32_16x16x32_bf16 v[64:67], a[216:219], a[124:127], v[64:67]
    buffer_load_dwordx4 v7, s[12:15], s58 offen nt lds
    s_waitcnt vmcnt(19) lgkmcnt(0)
    v_mfma_f32_16x16x32_bf16 v[64:67], a[220:223], a[128:131], v[64:67]
    s_barrier
    v_mfma_f32_16x16x32_bf16 v[72:75], a[212:215], a[144:147], 0
    s_cbranch_vccnz L_rs_start4b
L_ret_start4b:
    s_add_u32 m0, s22, 0
    v_mfma_f32_16x16x32_bf16 v[72:75], a[216:219], a[148:151], v[72:75]
    buffer_load_dwordx4 v6, s[4:7], s20 offen lds
    v_mfma_f32_16x16x32_bf16 v[72:75], a[220:223], a[152:155], v[72:75]
    s_add_u32 s20, s20, 128
    v_fma_f32 v61, v61, s28, v10
    v_fma_f32 v53, v53, s28, v9
    v_mfma_f32_16x16x32_bf16 v[80:83], a[212:215], a[168:171], 0
    s_add_u32 m0, s22, 1024
    ds_read_b64_tr_b16 a[212:213], v2 offset:18432
    v_fma_f32 v55, v55, s28, v9
    v_mfma_f32_16x16x32_bf16 v[80:83], a[216:219], a[172:175], v[80:83]
    buffer_load_dwordx4 v6, s[4:7], s20 offen lds
    v_mfma_f32_16x16x32_bf16 v[80:83], a[220:223], a[176:179], v[80:83]
    ds_read_b64_tr_b16 a[214:215], v2 offset:12288
    v_fma_f32 v60, v60, s28, v10
    v_mfma_f32_16x16x32_bf16 v[56:59], a[224:227], a[108:111], v[56:59]
    v_exp_f32 v61, v61
    v_mfma_f32_16x16x32_bf16 v[56:59], a[228:231], a[112:115], v[56:59]
    s_add_u32 s20, s20, 128
    v_exp_f32 v53, v53
    v_mfma_f32_16x16x32_bf16 v[56:59], a[232:235], a[116:119], v[56:59]
    v_exp_f32 v60, v60
    v_mfma_f32_16x16x32_bf16 v[64:67], a[224:227], a[132:135], v[64:67]
    s_add_u32 m0, s22, 2048
    ds_read_b64_tr_b16 a[216:217], v3 offset:18432
    v_cvt_pk_bf16_f32 v20, v60, v61
    v_mfma_f32_16x16x32_bf16 v[64:67], a[228:231], a[136:139], v[64:67]
    buffer_load_dwordx4 v6, s[4:7], s20 offen lds
    v_mfma_f32_16x16x32_bf16 v[64:67], a[232:235], a[140:143], v[64:67]
    ds_read_b64_tr_b16 a[218:219], v3 offset:12288
    v_exp_f32 v55, v55
    v_mfma_f32_16x16x32_bf16 v[72:75], a[224:227], a[156:159], v[72:75]
    ds_read_b64_tr_b16 a[220:221], v4 offset:18432
    v_fma_f32 v54, v54, s28, v9
    v_mfma_f32_16x16x32_bf16 v[72:75], a[228:231], a[160:163], v[72:75]
    v_exp_f32 v54, v54
    v_mfma_f32_16x16x32_bf16 v[72:75], a[232:235], a[164:167], v[72:75]
    ds_read_b64_tr_b16 a[222:223], v4 offset:12288
    v_fma_f32 v52, v52, s28, v9
    v_mfma_f32_16x16x32_bf16 v[80:83], a[224:227], a[180:183], v[80:83]
    s_add_u32 s20, s20, 12032
    v_exp_f32 v52, v52
    v_mfma_f32_16x16x32_bf16 v[80:83], a[228:231], a[184:187], v[80:83]
    ds_read_b64_tr_b16 a[224:225], v5 offset:18432
    v_cvt_pk_bf16_f32 v14, v52, v53
    v_mfma_f32_16x16x32_bf16 v[80:83], a[232:235], a[188:191], v[80:83]
    ds_read_b64_tr_b16 a[226:227], v5 offset:12288
    v_cvt_pk_bf16_f32 v15, v54, v55
    s_branch L_loop4
L_loop5:
    .p2align 6
L_loop5w0:
    s_waitcnt lgkmcnt(6)
    v_mfma_f32_16x16x32_bf16 v[112:115], a[212:215], v[16:19], v[112:115]
    v_fma_f32 v73, v73, s28, v11
    v_fma_f32 v66, v66, s28, v10
    v_mfma_f32_16x16x32_bf16 v[160:163], a[212:215], v[22:25], v[160:163]
    ds_read_b64_tr_b16 a[234:235], v3 offset:13312
    v_fma_f32 v90, v90, s28, v13
    v_mfma_f32_16x16x32_bf16 v[208:211], a[212:215], v[28:31], v[208:211]
    v_fma_f32 v64, v64, s28, v10
    v_fma_f32 v56, v56, s28, v9
    v_mfma_f32_16x16x32_bf16 a[0:3], a[212:215], v[34:37], a[0:3]
    ds_read_b64_tr_b16 a[232:233], v3 offset:19456
    v_fma_f32 v75, v75, s28, v11
    v_mfma_f32_16x16x32_bf16 a[48:51], a[212:215], v[40:43], a[48:51]
    v_fma_f32 v82, v82, s28, v12
    s_waitcnt lgkmcnt(6)
    v_mfma_f32_16x16x32_bf16 v[116:119], a[216:219], v[16:19], v[116:119]
    ds_read_b64_tr_b16 a[230:231], v2 offset:13312
    v_fma_f32 v79, v79, s28, v12
    v_mfma_f32_16x16x32_bf16 v[164:167], a[216:219], v[22:25], v[164:167]
    v_fma_f32 v89, v89, s28, v13
    v_fma_f32 v71, v71, s28, v11
    v_mfma_f32_16x16x32_bf16 v[212:215], a[216:219], v[28:31], v[212:215]
    ds_read_b64_tr_b16 a[228:229], v2 offset:19456
    v_fma_f32 v74, v74, s28, v11
    v_mfma_f32_16x16x32_bf16 a[4:7], a[216:219], v[34:37], a[4:7]
    v_exp_f32 v64, v64
    v_mfma_f32_16x16x32_bf16 a[52:55], a[216:219], v[40:43], a[52:55]
    s_waitcnt lgkmcnt(4)
    v_fma_f32 v80, v80, s28, v12
    v_mfma_f32_16x16x32_bf16 v[120:123], a[220:223], v[16:19], v[120:123]
    ds_read_b64_tr_b16 a[214:215], v4 offset:13312
    v_fma_f32 v81, v81, s28, v12
    v_mfma_f32_16x16x32_bf16 v[168:171], a[220:223], v[22:25], v[168:171]
    v_fma_f32 v85, v85, s28, v13
    v_mfma_f32_16x16x32_bf16 v[216:219], a[220:223], v[28:31], v[216:219]
    v_fma_f32 v59, v59, s28, v9
    v_fma_f32 v84, v84, s28, v13
    v_mfma_f32_16x16x32_bf16 a[8:11], a[220:223], v[34:37], a[8:11]
    ds_read_b64_tr_b16 a[212:213], v4 offset:19456
    v_fma_f32 v78, v78, s28, v12
    v_mfma_f32_16x16x32_bf16 a[56:59], a[220:223], v[40:43], a[56:59]
    v_fma_f32 v72, v72, s28, v11
    v_mfma_f32_16x16x32_bf16 v[124:127], a[224:227], v[16:19], v[124:127]
    v_fma_f32 v57, v57, s28, v9
    v_fma_f32 v77, v77, s28, v12
    v_mfma_f32_16x16x32_bf16 v[172:175], a[224:227], v[22:25], v[172:175]
    ds_read_b64_tr_b16 a[216:217], v5 offset:19456
    v_fma_f32 v70, v70, s28, v11
    v_mfma_f32_16x16x32_bf16 v[220:223], a[224:227], v[28:31], v[220:223]
    v_exp_f32 v56, v56
    v_mfma_f32_16x16x32_bf16 a[12:15], a[224:227], v[34:37], a[12:15]
    v_exp_f32 v77, v77
    v_mfma_f32_16x16x32_bf16 a[60:63], a[224:227], v[40:43], a[60:63]
    s_add_u32 s39, s39, 12288
    ds_read_b64_tr_b16 a[218:219], v5 offset:13312
    s_waitcnt lgkmcnt(4)
    v_mfma_f32_16x16x32_bf16 v[128:131], a[228:231], v[16:19], v[128:131]
    v_exp_f32 v71, v71
    v_mfma_f32_16x16x32_bf16 v[176:179], a[228:231], v[22:25], v[176:179]
    ds_read_b64_tr_b16 a[220:221], v2 offset:20480
    v_fma_f32 v69, v69, s28, v11
    v_mfma_f32_16x16x32_bf16 v[224:227], a[228:231], v[28:31], v[224:227]
    ds_read_b64_tr_b16 a[226:227], v3 offset:14336
    v_mfma_f32_16x16x32_bf16 a[16:19], a[228:231], v[34:37], a[16:19]
    v_exp_f32 v85, v85
    v_mfma_f32_16x16x32_bf16 a[64:67], a[228:231], v[40:43], a[64:67]
    ds_read_b64_tr_b16 a[228:229], v4 offset:20480
    v_mfma_f32_16x16x32_bf16 v[132:135], a[232:235], v[16:19], v[132:135]
    ds_read_b64_tr_b16 a[230:231], v4 offset:14336
    v_fma_f32 v76, v76, s28, v12
    v_mfma_f32_16x16x32_bf16 v[180:183], a[232:235], v[22:25], v[180:183]
    ds_read_b64_tr_b16 a[224:225], v3 offset:20480
    v_fma_f32 v67, v67, s28, v10
    v_mfma_f32_16x16x32_bf16 v[228:231], a[232:235], v[28:31], v[228:231]
    v_exp_f32 v59, v59
    v_mfma_f32_16x16x32_bf16 a[20:23], a[232:235], v[34:37], a[20:23]
    ds_read_b64_tr_b16 a[222:223], v2 offset:14336
    v_mfma_f32_16x16x32_bf16 a[68:71], a[232:235], v[40:43], a[68:71]
    s_waitcnt lgkmcnt(6)
    ds_read_b64_tr_b16 a[234:235], v5 offset:14336
    v_fma_f32 v86, v86, s28, v13
    v_mfma_f32_16x16x32_bf16 v[136:139], a[212:215], v[16:19], v[136:139]
    v_exp_f32 v57, v57
    v_mfma_f32_16x16x32_bf16 v[184:187], a[212:215], v[22:25], v[184:187]
    ds_read_b64_tr_b16 a[232:233], v5 offset:20480
    v_mfma_f32_16x16x32_bf16 v[232:235], a[212:215], v[28:31], v[232:235]
    v_exp_f32 v82, v82
    v_mfma_f32_16x16x32_bf16 a[24:27], a[212:215], v[34:37], a[24:27]
    v_fma_f32 v87, v87, s28, v13
    v_fma_f32 v88, v88, s28, v13
    v_mfma_f32_16x16x32_bf16 a[72:75], a[212:215], v[40:43], a[72:75]
    v_exp_f32 v73, v73
    v_mfma_f32_16x16x32_bf16 v[140:143], a[216:219], v[16:19], v[140:143]
    v_exp_f32 v84, v84
    v_mfma_f32_16x16x32_bf16 v[188:191], a[216:219], v[22:25], v[188:191]
    v_mfma_f32_16x16x32_bf16 v[236:239], a[216:219], v[28:31], v[236:239]
    v_fma_f32 v58, v58, s28, v9
    v_fma_f32 v91, v91, s28, v13
    v_mfma_f32_16x16x32_bf16 a[28:31], a[216:219], v[34:37], a[28:31]
    v_exp_f32 v70, v70
    v_mfma_f32_16x16x32_bf16 a[76:79], a[216:219], v[40:43], a[76:79]
    s_waitcnt lgkmcnt(1)
    v_cvt_pk_bf16_f32 v38, v84, v85
    v_fma_f32 v68, v68, s28, v11
    v_mfma_f32_16x16x32_bf16 v[144:147], a[220:223], v[16:19], v[144:147]
    v_exp_f32 v76, v76
    v_mfma_f32_16x16x32_bf16 v[192:195], a[220:223], v[22:25], v[192:195]
    v_cvt_pk_bf16_f32 v27, v70, v71
    v_fma_f32 v65, v65, s28, v10
    v_mfma_f32_16x16x32_bf16 v[240:243], a[220:223], v[28:31], v[240:243]
    s_waitcnt vmcnt(10) lgkmcnt(0)
    v_exp_f32 v72, v72
    v_mfma_f32_16x16x32_bf16 a[32:35], a[220:223], v[34:37], a[32:35]
    s_barrier
    v_mfma_f32_16x16x32_bf16 a[80:83], a[220:223], v[40:43], a[80:83]
    s_add_u32 m0, s22, 36864
    ds_read_b128 v[96:99], v8 offset:0
    v_mfma_f32_16x16x32_bf16 v[148:151], a[224:227], v[16:19], v[148:151]
    buffer_load_dwordx4 v6, s[8:11], s21 offen lds
    v_mfma_f32_16x16x32_bf16 v[196:199], a[224:227], v[22:25], v[196:199]
    v_cvt_pk_bf16_f32 v32, v76, v77
    v_mfma_f32_16x16x32_bf16 v[244:247], a[224:227], v[28:31], v[244:247]
    ds_read_b128 a[212:215], v0 offset:12288
    v_mfma_f32_16x16x32_bf16 a[36:39], a[224:227], v[34:37], a[36:39]
    s_add_u32 s21, s21, 128
    v_exp_f32 v79, v79
    v_mfma_f32_16x16x32_bf16 a[84:87], a[224:227], v[40:43], a[84:87]
    s_add_u32 m0, s22, 37888
    ds_read_b128 a[216:219], v1 offset:12288
    v_mfma_f32_16x16x32_bf16 v[152:155], a[228:231], v[16:19], v[152:155]
    buffer_load_dwordx4 v6, s[8:11], s21 offen lds
    v_mfma_f32_16x16x32_bf16 v[200:203], a[228:231], v[22:25], v[200:203]
    s_add_u32 s21, s21, 128
    s_add_u32 m0, s22, 38912
    ds_read_b128 a[220:223], v0 offset:13312
    v_mfma_f32_16x16x32_bf16 v[248:251], a[228:231], v[28:31], v[248:251]
    v_exp_f32 v58, v58
    v_mfma_f32_16x16x32_bf16 a[40:43], a[228:231], v[34:37], a[40:43]
    buffer_load_dwordx4 v6, s[8:11], s21 offen lds
    v_mfma_f32_16x16x32_bf16 a[88:91], a[228:231], v[40:43], a[88:91]
    v_exp_f32 v86, v86
    v_mfma_f32_16x16x32_bf16 v[156:159], a[232:235], v[16:19], v[156:159]
    ds_read_b128 a[224:227], v1 offset:13312
    v_fma_f32 v83, v83, s28, v12
    v_mfma_f32_16x16x32_bf16 v[204:207], a[232:235], v[22:25], v[204:207]
    v_exp_f32 v87, v87
    v_mfma_f32_16x16x32_bf16 v[252:255], a[232:235], v[28:31], v[252:255]
    v_exp_f32 v78, v78
    v_mfma_f32_16x16x32_bf16 a[44:47], a[232:235], v[34:37], a[44:47]
    v_exp_f32 v65, v65
    v_mfma_f32_16x16x32_bf16 a[92:95], a[232:235], v[40:43], a[92:95]
    s_waitcnt lgkmcnt(2)
    v_exp_f32 v69, v69
    v_mfma_f32_16x16x32_bf16 v[52:55], a[212:215], a[96:99], 0
    v_exp_f32 v68, v68
    v_mfma_f32_16x16x32_bf16 v[52:55], a[216:219], a[100:103], v[52:55]
    s_waitcnt lgkmcnt(1)
    ds_read_b128 a[232:235], v1 offset:14336
    v_cvt_pk_bf16_f32 v39, v86, v87
    v_mfma_f32_16x16x32_bf16 v[52:55], a[220:223], a[104:107], v[52:55]
    v_cvt_pk_bf16_f32 v33, v78, v79
    v_cvt_pk_bf16_f32 v28, v72, v73
    v_mfma_f32_16x16x32_bf16 v[60:63], a[212:215], a[120:123], 0
    v_exp_f32 v83, v83
    v_mfma_f32_16x16x32_bf16 v[60:63], a[216:219], a[124:127], v[60:63]
    buffer_store_dwordx4 v[96:99], v102, s[16:19], s24 offen offset:0 nt
    v_cvt_pk_bf16_f32 v22, v64, v65
    v_mfma_f32_16x16x32_bf16 v[60:63], a[220:223], a[128:131], v[60:63]
    ds_read_b128 a[228:231], v0 offset:14336
    v_cvt_pk_bf16_f32 v26, v68, v69
    v_mfma_f32_16x16x32_bf16 v[68:71], a[212:215], a[144:147], 0
    v_exp_f32 v66, v66
    v_mfma_f32_16x16x32_bf16 v[68:71], a[216:219], a[148:151], v[68:71]
    s_add_u32 s21, s21, 12032
    v_exp_f32 v67, v67
    v_mfma_f32_16x16x32_bf16 v[68:71], a[220:223], a[152:155], v[68:71]
    s_add_u32 m0, s23, 0
    v_exp_f32 v75, v75
    v_mfma_f32_16x16x32_bf16 v[76:79], a[212:215], a[168:171], 0
    buffer_load_dwordx4 v6, s[12:15], s25 offen nt lds
    v_mfma_f32_16x16x32_bf16 v[76:79], a[216:219], a[172:175], v[76:79]
    v_cvt_pk_bf16_f32 v35, v82, v83
    v_cvt_pk_bf16_f32 v17, v58, v59
    v_mfma_f32_16x16x32_bf16 v[76:79], a[220:223], a[176:179], v[76:79]
    v_cvt_pk_bf16_f32 v16, v56, v57
    v_mfma_f32_16x16x32_bf16 v[84:87], a[212:215], a[192:195], 0
    ds_read_b128 v[96:99], v8 offset:1024
    v_mfma_f32_16x16x32_bf16 v[84:87], a[216:219], a[196:199], v[84:87]
    v_exp_f32 v74, v74
    v_mfma_f32_16x16x32_bf16 v[84:87], a[220:223], a[200:203], v[84:87]
    s_waitcnt lgkmcnt(2)
    v_exp_f32 v88, v88
    v_mfma_f32_16x16x32_bf16 v[52:55], a[224:227], a[108:111], v[52:55]
    s_waitcnt lgkmcnt(1)
    v_exp_f32 v80, v80
    v_mfma_f32_16x16x32_bf16 v[52:55], a[228:231], a[112:115], v[52:55]
    v_exp_f32 v81, v81
    v_mfma_f32_16x16x32_bf16 v[52:55], a[232:235], a[116:119], v[52:55]
    v_exp_f32 v90, v90
    v_mfma_f32_16x16x32_bf16 v[60:63], a[224:227], a[132:135], v[60:63]
    ds_read_b128 a[216:219], v1 offset:18432
    v_cvt_pk_bf16_f32 v29, v74, v75
    v_mfma_f32_16x16x32_bf16 v[60:63], a[228:231], a[136:139], v[60:63]
    v_exp_f32 v91, v91
    v_mfma_f32_16x16x32_bf16 v[60:63], a[232:235], a[140:143], v[60:63]
    v_mfma_f32_16x16x32_bf16 v[68:71], a[224:227], a[156:159], v[68:71]
    v_mfma_f32_16x16x32_bf16 v[68:71], a[228:231], a[160:163], v[68:71]
    ds_read_b128 a[212:215], v0 offset:18432
    v_mfma_f32_16x16x32_bf16 v[68:71], a[232:235], a[164:167], v[68:71]
    v_exp_f32 v89, v89
    v_mfma_f32_16x16x32_bf16 v[76:79], a[224:227], a[180:183], v[76:79]
    s_add_u32 m0, s23, 1024
    v_mfma_f32_16x16x32_bf16 v[76:79], a[228:231], a[184:187], v[76:79]
    v_mfma_f32_16x16x32_bf16 v[76:79], a[232:235], a[188:191], v[76:79]
    ds_read_b128 a[220:223], v0 offset:19456
    v_mfma_f32_16x16x32_bf16 v[84:87], a[224:227], a[204:207], v[84:87]
    v_mfma_f32_16x16x32_bf16 v[84:87], a[228:231], a[208:211], v[84:87]
    ds_read_b128 a[224:227], v1 offset:19456
    v_cvt_pk_bf16_f32 v40, v88, v89
    v_mfma_f32_16x16x32_bf16 v[44:47], a[236:239], v[14:17], v[48:51]
    v_cvt_pk_bf16_f32 v23, v66, v67
    v_cvt_pk_bf16_f32 v34, v80, v81
    v_mfma_f32_16x16x32_bf16 v[84:87], a[232:235], v[92:95], v[84:87]
    ds_read_b128 a[228:231], v0 offset:20480
    v_mfma_f32_16x16x32_bf16 v[44:47], a[240:243], v[20:23], v[44:47]
    ds_read_b128 a[232:235], v1 offset:20480
    v_cvt_pk_bf16_f32 v41, v90, v91
    v_mfma_f32_16x16x32_bf16 v[44:47], a[244:247], v[26:29], v[44:47]
    v_mfma_f32_16x16x32_bf16 v[44:47], a[248:251], v[32:35], v[44:47]
    s_waitcnt lgkmcnt(4)
    v_mfma_f32_16x16x32_bf16 v[56:59], a[212:215], a[96:99], 0
    buffer_load_dwordx4 v7, s[12:15], s25 offen nt lds
    v_mfma_f32_16x16x32_bf16 v[44:47], a[252:255], v[38:41], v[44:47]
    s_bitcmp1_b32 s27, 0
    s_cselect_b32 s26, s49, 128
    s_lshr_b32 s27, s27, 1
    v_mfma_f32_16x16x32_bf16 v[56:59], a[216:219], a[100:103], v[56:59]
    buffer_store_dwordx4 v[96:99], v103, s[16:19], s24 offen offset:0 nt
    s_nop 2
    v_cmp_lt_f32 vcc, s29, v44
    s_waitcnt lgkmcnt(2)
    v_mfma_f32_16x16x32_bf16 v[56:59], a[220:223], a[104:107], v[56:59]
    s_add_u32 s24, s24, s26
    s_add_u32 s25, s25, s26
    v_mfma_f32_16x16x32_bf16 v[64:67], a[212:215], a[120:123], 0
    s_cbranch_vccnz L_rs_loop5w0a
L_ret_loop5w0a:
    v_fma_f32 v52, v52, s28, v9
    v_mfma_f32_16x16x32_bf16 v[64:67], a[216:219], a[124:127], v[64:67]
    v_fma_f32 v54, v54, s28, v9
    v_fma_f32 v55, v55, s28, v9
    v_mfma_f32_16x16x32_bf16 v[64:67], a[220:223], a[128:131], v[64:67]
    s_waitcnt vmcnt(14) lgkmcnt(0)
    s_add_u32 m0, s22, 12288
    v_fma_f32 v61, v61, s28, v10
    v_mfma_f32_16x16x32_bf16 v[72:75], a[212:215], a[144:147], 0
    s_barrier
    v_mfma_f32_16x16x32_bf16 v[72:75], a[216:219], a[148:151], v[72:75]
    buffer_load_dwordx4 v6, s[4:7], s20 offen lds
    v_mfma_f32_16x16x32_bf16 v[72:75], a[220:223], a[152:155], v[72:75]
    v_exp_f32 v52, v52
    v_mfma_f32_16x16x32_bf16 v[80:83], a[212:215], a[168:171], 0
    s_add_u32 s20, s20, 128
    s_add_u32 m0, s22, 13312
    v_fma_f32 v53, v53, s28, v9
    v_mfma_f32_16x16x32_bf16 v[80:83], a[216:219], a[172:175], v[80:83]
    v_exp_f32 v61, v61
    v_mfma_f32_16x16x32_bf16 v[80:83], a[220:223], a[176:179], v[80:83]
    buffer_load_dwordx4 v6, s[4:7], s20 offen lds
    v_mfma_f32_16x16x32_bf16 v[88:91], a[212:215], a[192:195], 0
    s_add_u32 s20, s20, 128
    v_mfma_f32_16x16x32_bf16 v[88:91], a[216:219], a[196:199], v[88:91]
    s_add_u32 m0, s22, 14336
    ds_read_b64_tr_b16 a[212:213], v2 offset:0
    v_fma_f32 v60, v60, s28, v10
    v_mfma_f32_16x16x32_bf16 v[88:91], a[220:223], a[200:203], v[88:91]
    buffer_load_dwordx4 v6, s[4:7], s20 offen lds
    v_mfma_f32_16x16x32_bf16 v[56:59], a[224:227], a[108:111], v[56:59]
    v_exp_f32 v60, v60
    v_mfma_f32_16x16x32_bf16 v[56:59], a[228:231], a[112:115], v[56:59]
    ds_read_b64_tr_b16 a[214:215], v2 offset:6144
    v_fma_f32 v62, v62, s28, v10
    v_mfma_f32_16x16x32_bf16 v[56:59], a[232:235], a[116:119], v[56:59]
    v_exp_f32 v54, v54
    v_mfma_f32_16x16x32_bf16 v[64:67], a[224:227], a[132:135], v[64:67]
    v_fma_f32 v63, v63, s28, v10
    v_mfma_f32_16x16x32_bf16 v[64:67], a[228:231], a[136:139], v[64:67]
    v_exp_f32 v55, v55
    v_mfma_f32_16x16x32_bf16 v[64:67], a[232:235], a[140:143], v[64:67]
    ds_read_b64_tr_b16 a[216:217], v3 offset:0
    v_cvt_pk_bf16_f32 v19, v54, v55
    v_mfma_f32_16x16x32_bf16 v[72:75], a[224:227], a[156:159], v[72:75]
    v_exp_f32 v62, v62
    v_mfma_f32_16x16x32_bf16 v[72:75], a[228:231], a[160:163], v[72:75]
    ds_read_b64_tr_b16 a[218:219], v3 offset:6144
    v_mfma_f32_16x16x32_bf16 v[72:75], a[232:235], a[164:167], v[72:75]
    v_cvt_pk_bf16_f32 v24, v60, v61
    v_mfma_f32_16x16x32_bf16 v[80:83], a[224:227], a[180:183], v[80:83]
    v_exp_f32 v63, v63
    v_mfma_f32_16x16x32_bf16 v[80:83], a[228:231], a[184:187], v[80:83]
    v_exp_f32 v53, v53
    v_mfma_f32_16x16x32_bf16 v[80:83], a[232:235], a[188:191], v[80:83]
    ds_read_b64_tr_b16 a[220:221], v4 offset:0
    s_add_u32 s20, s20, 12032
    v_mfma_f32_16x16x32_bf16 v[88:91], a[224:227], a[204:207], v[88:91]
    ds_read_b64_tr_b16 a[222:223], v4 offset:6144
    v_cvt_pk_bf16_f32 v25, v62, v63
    v_mfma_f32_16x16x32_bf16 v[88:91], a[228:231], a[208:211], v[88:91]
    ds_read_b64_tr_b16 a[224:225], v5 offset:0
    v_mfma_f32_16x16x32_bf16 v[88:91], a[232:235], v[92:95], v[88:91]
    ds_read_b64_tr_b16 a[226:227], v5 offset:6144
    v_cvt_pk_bf16_f32 v18, v52, v53
    s_waitcnt lgkmcnt(6)
    v_mfma_f32_16x16x32_bf16 v[112:115], a[212:215], v[14:17], v[112:115]
    ds_read_b64_tr_b16 a[228:229], v2 offset:1024
    v_fma_f32 v85, v85, s28, v13
    v_mfma_f32_16x16x32_bf16 v[160:163], a[212:215], v[20:23], v[160:163]
    v_mfma_f32_16x16x32_bf16 v[208:211], a[212:215], v[26:29], v[208:211]
    v_exp_f32 v85, v85
    v_mfma_f32_16x16x32_bf16 a[0:3], a[212:215], v[32:35], a[0:3]
    v_fma_f32 v76, v76, s28, v12
    v_fma_f32 v83, v83, s28, v12
    v_mfma_f32_16x16x32_bf16 a[48:51], a[212:215], v[38:41], a[48:51]
    ds_read_b64_tr_b16 a[232:233], v3 offset:1024
    s_waitcnt lgkmcnt(6)
    v_mfma_f32_16x16x32_bf16 v[116:119], a[216:219], v[14:17], v[116:119]
    ds_read_b64_tr_b16 a[230:231], v2 offset:7168
    v_fma_f32 v81, v81, s28, v12
    v_mfma_f32_16x16x32_bf16 v[164:167], a[216:219], v[20:23], v[164:167]
    v_fma_f32 v79, v79, s28, v12
    v_fma_f32 v78, v78, s28, v12
    v_mfma_f32_16x16x32_bf16 v[212:215], a[216:219], v[26:29], v[212:215]
    v_fma_f32 v84, v84, s28, v13
    v_fma_f32 v70, v70, s28, v11
    v_mfma_f32_16x16x32_bf16 a[4:7], a[216:219], v[32:35], a[4:7]
    ds_read_b128 v[96:99], v8 offset:2048
    v_fma_f32 v58, v58, s28, v9
    v_mfma_f32_16x16x32_bf16 a[52:55], a[216:219], v[38:41], a[52:55]
    s_waitcnt lgkmcnt(4)
    ds_read_b64_tr_b16 a[216:217], v5 offset:1024
    v_fma_f32 v59, v59, s28, v9
    v_mfma_f32_16x16x32_bf16 v[120:123], a[220:223], v[14:17], v[120:123]
    v_fma_f32 v80, v80, s28, v12
    v_fma_f32 v91, v91, s28, v13
    v_mfma_f32_16x16x32_bf16 v[168:171], a[220:223], v[20:23], v[168:171]
    v_exp_f32 v59, v59
    v_mfma_f32_16x16x32_bf16 v[216:219], a[220:223], v[26:29], v[216:219]
    v_mfma_f32_16x16x32_bf16 a[8:11], a[220:223], v[32:35], a[8:11]
    v_fma_f32 v87, v87, s28, v13
    v_mfma_f32_16x16x32_bf16 a[56:59], a[220:223], v[38:41], a[56:59]
    s_add_u32 s39, s39, 12288
    ds_read_b64_tr_b16 a[234:235], v3 offset:7168
    v_mfma_f32_16x16x32_bf16 v[124:127], a[224:227], v[14:17], v[124:127]
    ds_read_b64_tr_b16 a[218:219], v5 offset:7168
    v_fma_f32 v56, v56, s28, v9
    v_mfma_f32_16x16x32_bf16 v[172:175], a[224:227], v[20:23], v[172:175]
    v_exp_f32 v70, v70
    v_mfma_f32_16x16x32_bf16 v[220:223], a[224:227], v[26:29], v[220:223]
    v_exp_f32 v84, v84
    v_mfma_f32_16x16x32_bf16 a[12:15], a[224:227], v[32:35], a[12:15]
    ds_read_b64_tr_b16 a[212:213], v4 offset:1024
    v_fma_f32 v68, v68, s28, v11
    v_mfma_f32_16x16x32_bf16 a[60:63], a[224:227], v[38:41], a[60:63]
    s_waitcnt lgkmcnt(3)
    ds_read_b64_tr_b16 a[214:215], v4 offset:7168
    v_fma_f32 v77, v77, s28, v12
    v_mfma_f32_16x16x32_bf16 v[128:131], a[228:231], v[14:17], v[128:131]
    v_fma_f32 v66, v66, s28, v10
    v_fma_f32 v86, v86, s28, v13
    v_mfma_f32_16x16x32_bf16 v[176:179], a[228:231], v[20:23], v[176:179]
    v_exp_f32 v87, v87
    v_mfma_f32_16x16x32_bf16 v[224:227], a[228:231], v[26:29], v[224:227]
    ds_read_b64_tr_b16 a[220:221], v2 offset:2048
    v_fma_f32 v71, v71, s28, v11
    v_mfma_f32_16x16x32_bf16 a[16:19], a[228:231], v[32:35], a[16:19]
    ds_read_b64_tr_b16 a[224:225], v3 offset:2048
    v_fma_f32 v73, v73, s28, v11
    v_mfma_f32_16x16x32_bf16 a[64:67], a[228:231], v[38:41], a[64:67]
    s_waitcnt lgkmcnt(5)
    ds_read_b64_tr_b16 a[222:223], v2 offset:8192
    v_fma_f32 v74, v74, s28, v11
    v_mfma_f32_16x16x32_bf16 v[132:135], a[232:235], v[14:17], v[132:135]
    v_exp_f32 v74, v74
    v_mfma_f32_16x16x32_bf16 v[180:183], a[232:235], v[20:23], v[180:183]
    ds_read_b64_tr_b16 a[230:231], v4 offset:8192
    v_cvt_pk_bf16_f32 v42, v84, v85
    v_mfma_f32_16x16x32_bf16 v[228:231], a[232:235], v[26:29], v[228:231]
    v_fma_f32 v65, v65, s28, v10
    v_fma_f32 v88, v88, s28, v13
    v_mfma_f32_16x16x32_bf16 a[20:23], a[232:235], v[32:35], a[20:23]
    ds_read_b64_tr_b16 a[228:229], v4 offset:2048
    v_fma_f32 v69, v69, s28, v11
    v_mfma_f32_16x16x32_bf16 a[68:71], a[232:235], v[38:41], a[68:71]
    s_waitcnt lgkmcnt(5)
    ds_read_b64_tr_b16 a[232:233], v5 offset:2048
    v_mfma_f32_16x16x32_bf16 v[136:139], a[212:215], v[14:17], v[136:139]
    ds_read_b64_tr_b16 a[226:227], v3 offset:8192
    v_fma_f32 v64, v64, s28, v10
    v_mfma_f32_16x16x32_bf16 v[184:187], a[212:215], v[20:23], v[184:187]
    v_exp_f32 v68, v68
    v_mfma_f32_16x16x32_bf16 v[232:235], a[212:215], v[26:29], v[232:235]
    ds_read_b64_tr_b16 a[234:235], v5 offset:8192
    v_mfma_f32_16x16x32_bf16 a[24:27], a[212:215], v[32:35], a[24:27]
    v_exp_f32 v76, v76
    v_mfma_f32_16x16x32_bf16 a[72:75], a[212:215], v[38:41], a[72:75]
    v_exp_f32 v77, v77
    v_mfma_f32_16x16x32_bf16 v[140:143], a[216:219], v[14:17], v[140:143]
    v_fma_f32 v67, v67, s28, v10
    v_mfma_f32_16x16x32_bf16 v[188:191], a[216:219], v[20:23], v[188:191]
    v_mfma_f32_16x16x32_bf16 v[236:239], a[216:219], v[26:29], v[236:239]
    v_exp_f32 v86, v86
    v_mfma_f32_16x16x32_bf16 a[28:31], a[216:219], v[32:35], a[28:31]
    v_exp_f32 v79, v79
    v_mfma_f32_16x16x32_bf16 a[76:79], a[216:219], v[38:41], a[76:79]
    s_waitcnt lgkmcnt(2)
    v_exp_f32 v80, v80
    v_mfma_f32_16x16x32_bf16 v[144:147], a[220:223], v[14:17], v[144:147]
    v_fma_f32 v57, v57, s28, v9
    v_mfma_f32_16x16x32_bf16 v[192:195], a[220:223], v[20:23], v[192:195]
    v_exp_f32 v73, v73
    v_mfma_f32_16x16x32_bf16 v[240:243], a[220:223], v[26:29], v[240:243]
    s_waitcnt vmcnt(10) lgkmcnt(0)
    v_exp_f32 v58, v58
    v_mfma_f32_16x16x32_bf16 a[32:35], a[220:223], v[32:35], a[32:35]
    s_barrier
    v_mfma_f32_16x16x32_bf16 a[80:83], a[220:223], v[38:41], a[80:83]
    s_add_u32 m0, s22, 24576
    ds_read_b128 a[216:219], v1 offset:0
    v_fma_f32 v90, v90, s28, v13
    v_mfma_f32_16x16x32_bf16 v[148:151], a[224:227], v[14:17], v[148:151]
    buffer_load_dwordx4 v6, s[8:11], s21 offen lds
    v_mfma_f32_16x16x32_bf16 v[196:199], a[224:227], v[20:23], v[196:199]
    v_exp_f32 v78, v78
    v_mfma_f32_16x16x32_bf16 v[244:247], a[224:227], v[26:29], v[244:247]
    ds_read_b128 a[212:215], v0 offset:0
    s_add_u32 s21, s21, 128
    v_mfma_f32_16x16x32_bf16 a[36:39], a[224:227], v[32:35], a[36:39]
    s_add_u32 m0, s22, 25600
    v_fma_f32 v82, v82, s28, v12
    v_fma_f32 v72, v72, s28, v11
    v_mfma_f32_16x16x32_bf16 a[84:87], a[224:227], v[38:41], a[84:87]
    ds_read_b128 a[220:223], v0 offset:1024
    v_cvt_pk_bf16_f32 v37, v78, v79
    v_mfma_f32_16x16x32_bf16 v[152:155], a[228:231], v[14:17], v[152:155]
    buffer_load_dwordx4 v6, s[8:11], s21 offen lds
    v_mfma_f32_16x16x32_bf16 v[200:203], a[228:231], v[20:23], v[200:203]
    v_exp_f32 v64, v64
    v_mfma_f32_16x16x32_bf16 v[248:251], a[228:231], v[26:29], v[248:251]
    s_add_u32 s21, s21, 128
    v_exp_f32 v69, v69
    v_mfma_f32_16x16x32_bf16 a[40:43], a[228:231], v[32:35], a[40:43]
    s_add_u32 m0, s22, 26624
    v_fma_f32 v75, v75, s28, v11
    v_mfma_f32_16x16x32_bf16 a[88:91], a[228:231], v[38:41], a[88:91]
    buffer_load_dwordx4 v6, s[8:11], s21 offen lds
    v_mfma_f32_16x16x32_bf16 v[156:159], a[232:235], v[14:17], v[156:159]
    v_exp_f32 v71, v71
    v_mfma_f32_16x16x32_bf16 v[204:207], a[232:235], v[20:23], v[204:207]
    s_add_u32 s21, s21, 12032
    v_exp_f32 v75, v75
    v_mfma_f32_16x16x32_bf16 v[252:255], a[232:235], v[26:29], v[252:255]
    ds_read_b128 a[228:231], v0 offset:2048
    v_cvt_pk_bf16_f32 v30, v68, v69
    v_mfma_f32_16x16x32_bf16 a[44:47], a[232:235], v[32:35], a[44:47]
    s_add_u32 m0, s23, 2048
    v_exp_f32 v67, v67
    v_mfma_f32_16x16x32_bf16 a[92:95], a[232:235], v[38:41], a[92:95]
    s_waitcnt lgkmcnt(1)
    v_exp_f32 v91, v91
    v_mfma_f32_16x16x32_bf16 v[52:55], a[212:215], a[96:99], 0
    v_exp_f32 v66, v66
    v_mfma_f32_16x16x32_bf16 v[52:55], a[216:219], a[100:103], v[52:55]
    ds_read_b128 a[224:227], v1 offset:1024
    v_cvt_pk_bf16_f32 v43, v86, v87
    v_mfma_f32_16x16x32_bf16 v[52:55], a[220:223], a[104:107], v[52:55]
    v_exp_f32 v56, v56
    v_mfma_f32_16x16x32_bf16 v[60:63], a[212:215], a[120:123], 0
    v_mfma_f32_16x16x32_bf16 v[60:63], a[216:219], a[124:127], v[60:63]
    v_exp_f32 v81, v81
    v_mfma_f32_16x16x32_bf16 v[60:63], a[220:223], a[128:131], v[60:63]
    v_cvt_pk_bf16_f32 v36, v76, v77
    v_cvt_pk_bf16_f32 v31, v70, v71
    v_mfma_f32_16x16x32_bf16 v[68:71], a[212:215], a[144:147], 0
    ds_read_b128 a[232:235], v1 offset:2048
    v_mfma_f32_16x16x32_bf16 v[68:71], a[216:219], a[148:151], v[68:71]
    v_exp_f32 v72, v72
    v_mfma_f32_16x16x32_bf16 v[68:71], a[220:223], a[152:155], v[68:71]
    v_fma_f32 v89, v89, s28, v13
    v_mfma_f32_16x16x32_bf16 v[76:79], a[212:215], a[168:171], 0
    buffer_store_dwordx4 v[96:99], v102, s[16:19], s24 offen offset:0 nt
    v_exp_f32 v89, v89
    v_mfma_f32_16x16x32_bf16 v[76:79], a[216:219], a[172:175], v[76:79]
    v_exp_f32 v57, v57
    v_mfma_f32_16x16x32_bf16 v[76:79], a[220:223], a[176:179], v[76:79]
    v_exp_f32 v65, v65
    v_mfma_f32_16x16x32_bf16 v[84:87], a[212:215], a[192:195], 0
    v_exp_f32 v83, v83
    v_mfma_f32_16x16x32_bf16 v[84:87], a[216:219], a[196:199], v[84:87]
    ds_read_b128 a[212:215], v0 offset:6144
    v_cvt_pk_bf16_f32 v16, v56, v57
    v_mfma_f32_16x16x32_bf16 v[84:87], a[220:223], a[200:203], v[84:87]
    s_waitcnt lgkmcnt(2)
    v_cvt_pk_bf16_f32 v22, v64, v65
    v_mfma_f32_16x16x32_bf16 v[52:55], a[224:227], a[108:111], v[52:55]
    v_cvt_pk_bf16_f32 v23, v66, v67
    v_mfma_f32_16x16x32_bf16 v[52:55], a[228:231], a[112:115], v[52:55]
    s_waitcnt lgkmcnt(1)
    v_mfma_f32_16x16x32_bf16 v[52:55], a[232:235], a[116:119], v[52:55]
    buffer_load_dwordx4 v6, s[12:15], s25 offen nt lds
    v_mfma_f32_16x16x32_bf16 v[60:63], a[224:227], a[132:135], v[60:63]
    ds_read_b128 v[96:99], v8 offset:3072
    v_cvt_pk_bf16_f32 v29, v74, v75
    v_mfma_f32_16x16x32_bf16 v[60:63], a[228:231], a[136:139], v[60:63]
    v_exp_f32 v82, v82
    v_mfma_f32_16x16x32_bf16 v[60:63], a[232:235], a[140:143], v[60:63]
    v_cvt_pk_bf16_f32 v28, v72, v73
    v_cvt_pk_bf16_f32 v17, v58, v59
    v_mfma_f32_16x16x32_bf16 v[68:71], a[224:227], a[156:159], v[68:71]
    v_exp_f32 v88, v88
    v_mfma_f32_16x16x32_bf16 v[68:71], a[228:231], a[160:163], v[68:71]
    v_exp_f32 v90, v90
    v_mfma_f32_16x16x32_bf16 v[68:71], a[232:235], a[164:167], v[68:71]
    ds_read_b128 a[216:219], v1 offset:6144
    v_mfma_f32_16x16x32_bf16 v[76:79], a[224:227], a[180:183], v[76:79]
    v_mfma_f32_16x16x32_bf16 v[76:79], a[228:231], a[184:187], v[76:79]
    v_cvt_pk_bf16_f32 v40, v88, v89
    v_mfma_f32_16x16x32_bf16 v[76:79], a[232:235], a[188:191], v[76:79]
    v_cvt_pk_bf16_f32 v34, v80, v81
    v_cvt_pk_bf16_f32 v41, v90, v91
    v_mfma_f32_16x16x32_bf16 v[48:51], a[236:239], v[16:19], v[44:47]
    v_mfma_f32_16x16x32_bf16 v[84:87], a[224:227], a[204:207], v[84:87]
    ds_read_b128 a[220:223], v0 offset:7168
    s_add_u32 m0, s23, 3072
    v_mfma_f32_16x16x32_bf16 v[84:87], a[228:231], a[208:211], v[84:87]
    ds_read_b128 a[228:231], v0 offset:8192
    v_mfma_f32_16x16x32_bf16 v[48:51], a[240:243], v[22:25], v[48:51]
    ds_read_b128 a[224:227], v1 offset:7168
    v_mfma_f32_16x16x32_bf16 v[84:87], a[232:235], v[92:95], v[84:87]
    ds_read_b128 a[232:235], v1 offset:8192
    v_mfma_f32_16x16x32_bf16 v[48:51], a[244:247], v[28:31], v[48:51]
    s_waitcnt lgkmcnt(5)
    v_add_u32 v8, 4096, v8
    v_cvt_pk_bf16_f32 v35, v82, v83
    v_mfma_f32_16x16x32_bf16 v[56:59], a[212:215], a[96:99], 0
    buffer_load_dwordx4 v7, s[12:15], s25 offen nt lds
    v_mfma_f32_16x16x32_bf16 v[48:51], a[248:251], v[34:37], v[48:51]
    s_bitcmp1_b32 s27, 0
    v_mfma_f32_16x16x32_bf16 v[48:51], a[252:255], v[40:43], v[48:51]
    s_cselect_b32 s26, s49, 128
    s_lshr_b32 s27, s27, 1
    s_waitcnt lgkmcnt(4)
    v_mfma_f32_16x16x32_bf16 v[56:59], a[216:219], a[100:103], v[56:59]
    buffer_store_dwordx4 v[96:99], v103, s[16:19], s24 offen offset:0 nt
    s_add_u32 s24, s24, s26
    s_nop 1
    v_cmp_lt_f32 vcc, s29, v48
    s_waitcnt lgkmcnt(3)
    v_mfma_f32_16x16x32_bf16 v[56:59], a[220:223], a[104:107], v[56:59]
    s_add_u32 s25, s25, s26
    s_add_u32 s23, s23, 4096
    v_mfma_f32_16x16x32_bf16 v[64:67], a[212:215], a[120:123], 0
    s_cbranch_vccnz L_rs_loop5w0b
L_ret_loop5w0b:
    v_fma_f32 v55, v55, s28, v9
    v_mfma_f32_16x16x32_bf16 v[64:67], a[216:219], a[124:127], v[64:67]
    v_fma_f32 v61, v61, s28, v10
    v_mfma_f32_16x16x32_bf16 v[64:67], a[220:223], a[128:131], v[64:67]
    s_waitcnt vmcnt(14) lgkmcnt(0)
    v_fma_f32 v60, v60, s28, v10
    s_cmp_eq_u32 s30, 5
    v_mfma_f32_16x16x32_bf16 v[72:75], a[212:215], a[144:147], 0
    s_barrier
    v_mfma_f32_16x16x32_bf16 v[72:75], a[216:219], a[148:151], v[72:75]
    s_cselect_b32 s26, s62, 0
    v_fma_f32 v54, v54, s28, v9
    v_fma_f32 v52, v52, s28, v9
    v_mfma_f32_16x16x32_bf16 v[72:75], a[220:223], a[152:155], v[72:75]
    s_add_u32 s20, s20, s26
    s_add_u32 m0, s22, 0
    v_fma_f32 v53, v53, s28, v9
    v_mfma_f32_16x16x32_bf16 v[80:83], a[212:215], a[168:171], 0
    buffer_load_dwordx4 v6, s[4:7], s20 offen lds
    v_mfma_f32_16x16x32_bf16 v[80:83], a[216:219], a[172:175], v[80:83]
    s_add_u32 s20, s20, 128
    s_add_u32 m0, s22, 1024
    v_fma_f32 v62, v62, s28, v10
    v_mfma_f32_16x16x32_bf16 v[80:83], a[220:223], a[176:179], v[80:83]
    buffer_load_dwordx4 v6, s[4:7], s20 offen lds
    v_mfma_f32_16x16x32_bf16 v[88:91], a[212:215], a[192:195], 0
    s_add_u32 s20, s20, 128
    ds_read_b64_tr_b16 a[212:213], v2 offset:18432
    v_mfma_f32_16x16x32_bf16 v[88:91], a[216:219], a[196:199], v[88:91]
    v_exp_f32 v60, v60
    v_mfma_f32_16x16x32_bf16 v[88:91], a[220:223], a[200:203], v[88:91]
    s_add_u32 m0, s22, 2048
    v_exp_f32 v54, v54
    v_mfma_f32_16x16x32_bf16 v[56:59], a[224:227], a[108:111], v[56:59]
    buffer_load_dwordx4 v6, s[4:7], s20 offen lds
    v_mfma_f32_16x16x32_bf16 v[56:59], a[228:231], a[112:115], v[56:59]
    ds_read_b64_tr_b16 a[214:215], v2 offset:12288
    s_add_u32 s20, s20, 12032
    v_mfma_f32_16x16x32_bf16 v[56:59], a[232:235], a[116:119], v[56:59]
    s_add_u32 s30, s30, 1
    v_exp_f32 v62, v62
    v_mfma_f32_16x16x32_bf16 v[64:67], a[224:227], a[132:135], v[64:67]
    v_exp_f32 v55, v55
    v_mfma_f32_16x16x32_bf16 v[64:67], a[228:231], a[136:139], v[64:67]
    v_exp_f32 v52, v52
    v_mfma_f32_16x16x32_bf16 v[64:67], a[232:235], a[140:143], v[64:67]
    s_cmp_lt_u32 s30, 6
    v_exp_f32 v61, v61
    v_mfma_f32_16x16x32_bf16 v[72:75], a[224:227], a[156:159], v[72:75]
    v_exp_f32 v53, v53
    v_mfma_f32_16x16x32_bf16 v[72:75], a[228:231], a[160:163], v[72:75]
    ds_read_b64_tr_b16 a[216:217], v3 offset:18432
    v_fma_f32 v63, v63, s28, v10
    v_mfma_f32_16x16x32_bf16 v[72:75], a[232:235], a[164:167], v[72:75]
    v_exp_f32 v63, v63
    v_mfma_f32_16x16x32_bf16 v[80:83], a[224:227], a[180:183], v[80:83]
    ds_read_b64_tr_b16 a[218:219], v3 offset:12288
    v_mfma_f32_16x16x32_bf16 v[80:83], a[228:231], a[184:187], v[80:83]
    ds_read_b64_tr_b16 a[220:221], v4 offset:18432
    v_cvt_pk_bf16_f32 v14, v52, v53
    v_mfma_f32_16x16x32_bf16 v[80:83], a[232:235], a[188:191], v[80:83]
    ds_read_b64_tr_b16 a[222:223], v4 offset:12288
    v_cvt_pk_bf16_f32 v15, v54, v55
    v_mfma_f32_16x16x32_bf16 v[88:91], a[224:227], a[204:207], v[88:91]
    ds_read_b64_tr_b16 a[224:225], v5 offset:18432
    v_cvt_pk_bf16_f32 v20, v60, v61
    v_mfma_f32_16x16x32_bf16 v[88:91], a[228:231], a[208:211], v[88:91]
    ds_read_b64_tr_b16 a[226:227], v5 offset:12288
    v_cvt_pk_bf16_f32 v21, v62, v63
    v_mfma_f32_16x16x32_bf16 v[88:91], a[232:235], v[92:95], v[88:91]
    s_cbranch_scc1 L_loop5w0
    s_cmp_ge_u32 s37, 6
    s_cbranch_scc1 L_end5
    s_cmp_eq_u32 s32, 0
    s_cbranch_scc1 L_tr54
    s_branch L_tr55
L_tr54:
    s_waitcnt lgkmcnt(6)
    v_mfma_f32_16x16x32_bf16 v[112:115], a[212:215], v[16:19], v[112:115]
    ds_read_b64_tr_b16 a[228:229], v2 offset:19456
    v_mfma_f32_16x16x32_bf16 v[160:163], a[212:215], v[22:25], v[160:163]
    v_fma_f32 v86, v86, s28, v13
    v_fma_f32 v84, v84, s28, v13
    v_mfma_f32_16x16x32_bf16 v[208:211], a[212:215], v[28:31], v[208:211]
    v_fma_f32 v70, v70, s28, v11
    v_fma_f32 v87, v87, s28, v13
    v_mfma_f32_16x16x32_bf16 a[0:3], a[212:215], v[34:37], a[0:3]
    ds_read_b64_tr_b16 a[230:231], v2 offset:13312
    v_fma_f32 v74, v74, s28, v11
    v_mfma_f32_16x16x32_bf16 a[48:51], a[212:215], v[40:43], a[48:51]
    s_waitcnt lgkmcnt(6)
    v_mfma_f32_16x16x32_bf16 v[116:119], a[216:219], v[16:19], v[116:119]
    ds_read_b64_tr_b16 a[234:235], v3 offset:13312
    v_mfma_f32_16x16x32_bf16 v[164:167], a[216:219], v[22:25], v[164:167]
    v_exp_f32 v87, v87
    v_mfma_f32_16x16x32_bf16 v[212:215], a[216:219], v[28:31], v[212:215]
    v_exp_f32 v70, v70
    v_mfma_f32_16x16x32_bf16 a[4:7], a[216:219], v[34:37], a[4:7]
    ds_read_b64_tr_b16 a[212:213], v4 offset:19456
    v_fma_f32 v77, v77, s28, v12
    v_mfma_f32_16x16x32_bf16 a[52:55], a[216:219], v[40:43], a[52:55]
    s_waitcnt lgkmcnt(4)
    ds_read_b64_tr_b16 a[232:233], v3 offset:19456
    v_fma_f32 v89, v89, s28, v13
    v_mfma_f32_16x16x32_bf16 v[120:123], a[220:223], v[16:19], v[120:123]
    v_fma_f32 v72, v72, s28, v11
    v_mfma_f32_16x16x32_bf16 v[168:171], a[220:223], v[22:25], v[168:171]
    v_mfma_f32_16x16x32_bf16 v[216:219], a[220:223], v[28:31], v[216:219]
    v_mfma_f32_16x16x32_bf16 a[8:11], a[220:223], v[34:37], a[8:11]
    ds_read_b64_tr_b16 a[214:215], v4 offset:13312
    v_fma_f32 v88, v88, s28, v13
    v_mfma_f32_16x16x32_bf16 a[56:59], a[220:223], v[40:43], a[56:59]
    v_fma_f32 v75, v75, s28, v11
    v_fma_f32 v85, v85, s28, v13
    v_mfma_f32_16x16x32_bf16 v[124:127], a[224:227], v[16:19], v[124:127]
    v_mfma_f32_16x16x32_bf16 v[172:175], a[224:227], v[22:25], v[172:175]
    ds_read_b64_tr_b16 a[222:223], v2 offset:14336
    v_fma_f32 v76, v76, s28, v12
    v_mfma_f32_16x16x32_bf16 v[220:223], a[224:227], v[28:31], v[220:223]
    v_exp_f32 v88, v88
    v_mfma_f32_16x16x32_bf16 a[12:15], a[224:227], v[34:37], a[12:15]
    ds_read_b64_tr_b16 a[218:219], v5 offset:13312
    v_fma_f32 v69, v69, s28, v11
    v_mfma_f32_16x16x32_bf16 a[60:63], a[224:227], v[40:43], a[60:63]
    s_waitcnt lgkmcnt(3)
    ds_read_b64_tr_b16 a[226:227], v3 offset:14336
    v_mfma_f32_16x16x32_bf16 v[128:131], a[228:231], v[16:19], v[128:131]
    v_fma_f32 v82, v82, s28, v12
    v_mfma_f32_16x16x32_bf16 v[176:179], a[228:231], v[22:25], v[176:179]
    v_exp_f32 v75, v75
    v_mfma_f32_16x16x32_bf16 v[224:227], a[228:231], v[28:31], v[224:227]
    v_fma_f32 v79, v79, s28, v12
    v_mfma_f32_16x16x32_bf16 a[16:19], a[228:231], v[34:37], a[16:19]
    ds_read_b64_tr_b16 a[224:225], v3 offset:20480
    v_fma_f32 v78, v78, s28, v12
    v_mfma_f32_16x16x32_bf16 a[64:67], a[228:231], v[40:43], a[64:67]
    ds_read_b64_tr_b16 a[216:217], v5 offset:19456
    v_mfma_f32_16x16x32_bf16 v[132:135], a[232:235], v[16:19], v[132:135]
    ds_read_b64_tr_b16 a[228:229], v4 offset:20480
    v_fma_f32 v59, v59, s28, v9
    v_mfma_f32_16x16x32_bf16 v[180:183], a[232:235], v[22:25], v[180:183]
    v_exp_f32 v59, v59
    v_mfma_f32_16x16x32_bf16 v[228:231], a[232:235], v[28:31], v[228:231]
    ds_read_b64_tr_b16 a[220:221], v2 offset:20480
    v_fma_f32 v68, v68, s28, v11
    v_mfma_f32_16x16x32_bf16 a[20:23], a[232:235], v[34:37], a[20:23]
    ds_read_b64_tr_b16 a[230:231], v4 offset:14336
    s_add_u32 s39, s39, 12288
    v_mfma_f32_16x16x32_bf16 a[68:71], a[232:235], v[40:43], a[68:71]
    s_waitcnt lgkmcnt(5)
    ds_read_b64_tr_b16 a[234:235], v5 offset:14336
    v_mfma_f32_16x16x32_bf16 v[136:139], a[212:215], v[16:19], v[136:139]
    v_exp_f32 v76, v76
    v_mfma_f32_16x16x32_bf16 v[184:187], a[212:215], v[22:25], v[184:187]
    ds_read_b64_tr_b16 a[232:233], v5 offset:20480
    v_fma_f32 v83, v83, s28, v12
    v_mfma_f32_16x16x32_bf16 v[232:235], a[212:215], v[28:31], v[232:235]
    v_fma_f32 v66, v66, s28, v10
    v_fma_f32 v73, v73, s28, v11
    v_mfma_f32_16x16x32_bf16 a[24:27], a[212:215], v[34:37], a[24:27]
    v_fma_f32 v64, v64, s28, v10
    v_fma_f32 v90, v90, s28, v13
    v_mfma_f32_16x16x32_bf16 a[72:75], a[212:215], v[40:43], a[72:75]
    s_waitcnt lgkmcnt(5)
    v_fma_f32 v67, v67, s28, v10
    v_fma_f32 v56, v56, s28, v9
    v_mfma_f32_16x16x32_bf16 v[140:143], a[216:219], v[16:19], v[140:143]
    v_exp_f32 v69, v69
    v_mfma_f32_16x16x32_bf16 v[188:191], a[216:219], v[22:25], v[188:191]
    v_exp_f32 v68, v68
    v_mfma_f32_16x16x32_bf16 v[236:239], a[216:219], v[28:31], v[236:239]
    v_exp_f32 v84, v84
    v_mfma_f32_16x16x32_bf16 a[28:31], a[216:219], v[34:37], a[28:31]
    v_fma_f32 v91, v91, s28, v13
    v_fma_f32 v65, v65, s28, v10
    v_mfma_f32_16x16x32_bf16 a[76:79], a[216:219], v[40:43], a[76:79]
    s_waitcnt lgkmcnt(1)
    v_fma_f32 v71, v71, s28, v11
    v_fma_f32 v81, v81, s28, v12
    v_mfma_f32_16x16x32_bf16 v[144:147], a[220:223], v[16:19], v[144:147]
    v_exp_f32 v85, v85
    v_mfma_f32_16x16x32_bf16 v[192:195], a[220:223], v[22:25], v[192:195]
    v_exp_f32 v86, v86
    v_mfma_f32_16x16x32_bf16 v[240:243], a[220:223], v[28:31], v[240:243]
    s_waitcnt vmcnt(10) lgkmcnt(0)
    v_fma_f32 v80, v80, s28, v12
    s_add_u32 m0, s22, 36864
    v_mfma_f32_16x16x32_bf16 a[32:35], a[220:223], v[34:37], a[32:35]
    s_barrier
    v_mfma_f32_16x16x32_bf16 a[80:83], a[220:223], v[40:43], a[80:83]
    buffer_load_dwordx4 v6, s[8:11], s21 offen lds
    v_mfma_f32_16x16x32_bf16 v[148:151], a[224:227], v[16:19], v[148:151]
    s_add_u32 s21, s21, 128
    ds_read_b128 a[212:215], v0 offset:12288
    v_fma_f32 v58, v58, s28, v9
    v_mfma_f32_16x16x32_bf16 v[196:199], a[224:227], v[22:25], v[196:199]
    v_exp_f32 v89, v89
    v_mfma_f32_16x16x32_bf16 v[244:247], a[224:227], v[28:31], v[244:247]
    s_add_u32 m0, s22, 37888
    ds_read_b128 a[220:223], v0 offset:13312
    v_mfma_f32_16x16x32_bf16 a[36:39], a[224:227], v[34:37], a[36:39]
    buffer_load_dwordx4 v6, s[8:11], s21 offen lds
    v_mfma_f32_16x16x32_bf16 a[84:87], a[224:227], v[40:43], a[84:87]
    ds_read_b128 a[216:219], v1 offset:12288
    v_mfma_f32_16x16x32_bf16 v[152:155], a[228:231], v[16:19], v[152:155]
    v_exp_f32 v73, v73
    v_mfma_f32_16x16x32_bf16 v[200:203], a[228:231], v[22:25], v[200:203]
    s_add_u32 s21, s21, 128
    v_fma_f32 v57, v57, s28, v9
    v_cvt_pk_bf16_f32 v26, v68, v69
    v_mfma_f32_16x16x32_bf16 v[248:251], a[228:231], v[28:31], v[248:251]
    s_add_u32 m0, s22, 38912
    v_exp_f32 v56, v56
    v_mfma_f32_16x16x32_bf16 a[40:43], a[228:231], v[34:37], a[40:43]
    buffer_load_dwordx4 v6, s[8:11], s21 offen lds
    v_mfma_f32_16x16x32_bf16 a[88:91], a[228:231], v[40:43], a[88:91]
    v_exp_f32 v82, v82
    v_mfma_f32_16x16x32_bf16 v[156:159], a[232:235], v[16:19], v[156:159]
    v_exp_f32 v78, v78
    v_mfma_f32_16x16x32_bf16 v[204:207], a[232:235], v[22:25], v[204:207]
    v_exp_f32 v77, v77
    v_mfma_f32_16x16x32_bf16 v[252:255], a[232:235], v[28:31], v[252:255]
    s_add_u32 s21, s21, 12032
    v_exp_f32 v79, v79
    v_mfma_f32_16x16x32_bf16 a[44:47], a[232:235], v[34:37], a[44:47]
    v_cvt_pk_bf16_f32 v39, v86, v87
    v_mfma_f32_16x16x32_bf16 a[92:95], a[232:235], v[40:43], a[92:95]
    s_waitcnt lgkmcnt(0)
    v_exp_f32 v67, v67
    v_mfma_f32_16x16x32_bf16 v[52:55], a[212:215], a[96:99], 0
    v_cvt_pk_bf16_f32 v33, v78, v79
    v_mfma_f32_16x16x32_bf16 v[52:55], a[216:219], a[100:103], v[52:55]
    v_exp_f32 v71, v71
    v_mfma_f32_16x16x32_bf16 v[52:55], a[220:223], a[104:107], v[52:55]
    v_exp_f32 v66, v66
    v_mfma_f32_16x16x32_bf16 v[60:63], a[212:215], a[120:123], 0
    ds_read_b128 a[224:227], v1 offset:13312
    v_mfma_f32_16x16x32_bf16 v[60:63], a[216:219], a[124:127], v[60:63]
    ds_read_b128 a[228:231], v0 offset:14336
    v_cvt_pk_bf16_f32 v27, v70, v71
    v_mfma_f32_16x16x32_bf16 v[60:63], a[220:223], a[128:131], v[60:63]
    ds_read_b128 a[232:235], v1 offset:14336
    v_mfma_f32_16x16x32_bf16 v[68:71], a[212:215], a[144:147], 0
    v_exp_f32 v72, v72
    v_mfma_f32_16x16x32_bf16 v[68:71], a[216:219], a[148:151], v[68:71]
    v_exp_f32 v91, v91
    v_mfma_f32_16x16x32_bf16 v[68:71], a[220:223], a[152:155], v[68:71]
    v_cvt_pk_bf16_f32 v32, v76, v77
    v_cvt_pk_bf16_f32 v38, v84, v85
    v_mfma_f32_16x16x32_bf16 v[76:79], a[212:215], a[168:171], 0
    v_exp_f32 v83, v83
    v_mfma_f32_16x16x32_bf16 v[76:79], a[216:219], a[172:175], v[76:79]
    v_exp_f32 v74, v74
    v_mfma_f32_16x16x32_bf16 v[76:79], a[220:223], a[176:179], v[76:79]
    v_exp_f32 v57, v57
    v_mfma_f32_16x16x32_bf16 v[84:87], a[212:215], a[192:195], 0
    v_exp_f32 v80, v80
    v_mfma_f32_16x16x32_bf16 v[84:87], a[216:219], a[196:199], v[84:87]
    v_exp_f32 v65, v65
    v_mfma_f32_16x16x32_bf16 v[84:87], a[220:223], a[200:203], v[84:87]
    s_waitcnt lgkmcnt(1)
    v_exp_f32 v58, v58
    v_mfma_f32_16x16x32_bf16 v[52:55], a[224:227], a[108:111], v[52:55]
    ds_read_b128 a[216:219], v1 offset:18432
    v_mfma_f32_16x16x32_bf16 v[52:55], a[228:231], a[112:115], v[52:55]
    s_waitcnt lgkmcnt(1)
    v_cvt_pk_bf16_f32 v40, v88, v89
    v_cvt_pk_bf16_f32 v23, v66, v67
    v_mfma_f32_16x16x32_bf16 v[52:55], a[232:235], a[116:119], v[52:55]
    v_cvt_pk_bf16_f32 v17, v58, v59
    v_cvt_pk_bf16_f32 v16, v56, v57
    v_mfma_f32_16x16x32_bf16 v[60:63], a[224:227], a[132:135], v[60:63]
    v_cvt_pk_bf16_f32 v28, v72, v73
    v_mfma_f32_16x16x32_bf16 v[60:63], a[228:231], a[136:139], v[60:63]
    v_mfma_f32_16x16x32_bf16 v[60:63], a[232:235], a[140:143], v[60:63]
    ds_read_b128 a[212:215], v0 offset:18432
    v_mfma_f32_16x16x32_bf16 v[68:71], a[224:227], a[156:159], v[68:71]
    v_exp_f32 v64, v64
    v_mfma_f32_16x16x32_bf16 v[68:71], a[228:231], a[160:163], v[68:71]
    v_exp_f32 v81, v81
    v_mfma_f32_16x16x32_bf16 v[68:71], a[232:235], a[164:167], v[68:71]
    v_mfma_f32_16x16x32_bf16 v[76:79], a[224:227], a[180:183], v[76:79]
    v_exp_f32 v90, v90
    v_mfma_f32_16x16x32_bf16 v[76:79], a[228:231], a[184:187], v[76:79]
    ds_read_b128 a[220:223], v0 offset:19456
    v_mfma_f32_16x16x32_bf16 v[76:79], a[232:235], a[188:191], v[76:79]
    v_cvt_pk_bf16_f32 v34, v80, v81
    v_mfma_f32_16x16x32_bf16 v[84:87], a[224:227], a[204:207], v[84:87]
    v_cvt_pk_bf16_f32 v22, v64, v65
    v_cvt_pk_bf16_f32 v29, v74, v75
    v_mfma_f32_16x16x32_bf16 v[84:87], a[228:231], a[208:211], v[84:87]
    ds_read_b128 a[228:231], v0 offset:20480
    v_mfma_f32_16x16x32_bf16 v[84:87], a[232:235], v[92:95], v[84:87]
    ds_read_b128 a[224:227], v1 offset:19456
    v_cvt_pk_bf16_f32 v35, v82, v83
    v_mfma_f32_16x16x32_bf16 v[44:47], a[236:239], v[14:17], v[48:51]
    ds_read_b128 a[232:235], v1 offset:20480
    v_mfma_f32_16x16x32_bf16 v[44:47], a[240:243], v[20:23], v[44:47]
    v_mfma_f32_16x16x32_bf16 v[44:47], a[244:247], v[26:29], v[44:47]
    v_cvt_pk_bf16_f32 v41, v90, v91
    v_mfma_f32_16x16x32_bf16 v[44:47], a[248:251], v[32:35], v[44:47]
    s_nop 0
    v_mfma_f32_16x16x32_bf16 v[44:47], a[252:255], v[38:41], v[44:47]
    s_waitcnt lgkmcnt(4)
    v_mfma_f32_16x16x32_bf16 v[56:59], a[212:215], a[96:99], 0
    v_mfma_f32_16x16x32_bf16 v[56:59], a[216:219], a[100:103], v[56:59]
    s_waitcnt lgkmcnt(3)
    v_mfma_f32_16x16x32_bf16 v[56:59], a[220:223], a[104:107], v[56:59]
    v_mfma_f32_16x16x32_bf16 v[64:67], a[212:215], a[120:123], 0
    v_mfma_f32_16x16x32_bf16 v[64:67], a[216:219], a[124:127], v[64:67]
    s_nop 0
    v_cmp_lt_f32 vcc, s29, v44
    v_mfma_f32_16x16x32_bf16 v[64:67], a[220:223], a[128:131], v[64:67]
    s_waitcnt vmcnt(7) lgkmcnt(0)
    v_mfma_f32_16x16x32_bf16 v[72:75], a[212:215], a[144:147], 0
    s_barrier
    v_mfma_f32_16x16x32_bf16 v[72:75], a[216:219], a[148:151], v[72:75]
    s_cbranch_vccnz L_rs_tr54a
L_ret_tr54a:
    v_fma_f32 v61, v61, s28, v10
    v_mfma_f32_16x16x32_bf16 v[72:75], a[220:223], a[152:155], v[72:75]
    s_add_u32 m0, s22, 12288
    v_fma_f32 v55, v55, s28, v9
    v_fma_f32 v60, v60, s28, v10
    v_mfma_f32_16x16x32_bf16 v[80:83], a[212:215], a[168:171], 0
    v_exp_f32 v61, v61
    v_mfma_f32_16x16x32_bf16 v[80:83], a[216:219], a[172:175], v[80:83]
    buffer_load_dwordx4 v6, s[4:7], s20 offen lds
    v_mfma_f32_16x16x32_bf16 v[80:83], a[220:223], a[176:179], v[80:83]
    v_fma_f32 v54, v54, s28, v9
    s_add_u32 s20, s20, 128
    v_mfma_f32_16x16x32_bf16 v[88:91], a[212:215], a[192:195], 0
    s_add_u32 m0, s22, 13312
    ds_read_b64_tr_b16 a[212:213], v2 offset:0
    v_fma_f32 v52, v52, s28, v9
    v_mfma_f32_16x16x32_bf16 v[88:91], a[216:219], a[196:199], v[88:91]
    buffer_load_dwordx4 v6, s[4:7], s20 offen lds
    v_mfma_f32_16x16x32_bf16 v[88:91], a[220:223], a[200:203], v[88:91]
    v_exp_f32 v55, v55
    v_mfma_f32_16x16x32_bf16 v[56:59], a[224:227], a[108:111], v[56:59]
    s_add_u32 s20, s20, 128
    ds_read_b64_tr_b16 a[214:215], v2 offset:6144
    v_mfma_f32_16x16x32_bf16 v[56:59], a[228:231], a[112:115], v[56:59]
    s_add_u32 m0, s22, 14336
    v_exp_f32 v54, v54
    v_mfma_f32_16x16x32_bf16 v[56:59], a[232:235], a[116:119], v[56:59]
    buffer_load_dwordx4 v6, s[4:7], s20 offen lds
    v_mfma_f32_16x16x32_bf16 v[64:67], a[224:227], a[132:135], v[64:67]
    ds_read_b64_tr_b16 a[216:217], v3 offset:0
    v_fma_f32 v53, v53, s28, v9
    v_mfma_f32_16x16x32_bf16 v[64:67], a[228:231], a[136:139], v[64:67]
    v_fma_f32 v63, v63, s28, v10
    v_fma_f32 v62, v62, s28, v10
    v_mfma_f32_16x16x32_bf16 v[64:67], a[232:235], a[140:143], v[64:67]
    ds_read_b64_tr_b16 a[218:219], v3 offset:6144
    v_cvt_pk_bf16_f32 v19, v54, v55
    v_mfma_f32_16x16x32_bf16 v[72:75], a[224:227], a[156:159], v[72:75]
    v_exp_f32 v63, v63
    v_mfma_f32_16x16x32_bf16 v[72:75], a[228:231], a[160:163], v[72:75]
    s_add_u32 s20, s20, 12032
    v_exp_f32 v60, v60
    v_mfma_f32_16x16x32_bf16 v[72:75], a[232:235], a[164:167], v[72:75]
    ds_read_b64_tr_b16 a[220:221], v4 offset:0
    v_cvt_pk_bf16_f32 v24, v60, v61
    v_mfma_f32_16x16x32_bf16 v[80:83], a[224:227], a[180:183], v[80:83]
    v_exp_f32 v62, v62
    v_mfma_f32_16x16x32_bf16 v[80:83], a[228:231], a[184:187], v[80:83]
    v_exp_f32 v53, v53
    v_mfma_f32_16x16x32_bf16 v[80:83], a[232:235], a[188:191], v[80:83]
    v_exp_f32 v52, v52
    v_mfma_f32_16x16x32_bf16 v[88:91], a[224:227], a[204:207], v[88:91]
    ds_read_b64_tr_b16 a[222:223], v4 offset:6144
    v_cvt_pk_bf16_f32 v25, v62, v63
    v_mfma_f32_16x16x32_bf16 v[88:91], a[228:231], a[208:211], v[88:91]
    ds_read_b64_tr_b16 a[224:225], v5 offset:0
    v_cvt_pk_bf16_f32 v18, v52, v53
    v_mfma_f32_16x16x32_bf16 v[88:91], a[232:235], v[92:95], v[88:91]
    ds_read_b64_tr_b16 a[226:227], v5 offset:6144
    s_waitcnt lgkmcnt(6)
    v_mfma_f32_16x16x32_bf16 v[112:115], a[212:215], v[14:17], v[112:115]
    ds_read_b64_tr_b16 a[232:233], v3 offset:1024
    s_nop 3
    v_fma_f32 v88, v88, s28, v13
    v_mfma_f32_16x16x32_bf16 v[160:163], a[212:215], v[20:23], v[160:163]
    ds_read_b64_tr_b16 a[230:231], v2 offset:7168
    v_fma_f32 v77, v77, s28, v12
    v_mfma_f32_16x16x32_bf16 v[208:211], a[212:215], v[26:29], v[208:211]
    ds_read_b64_tr_b16 a[234:235], v3 offset:7168
    v_fma_f32 v68, v68, s28, v11
    v_mfma_f32_16x16x32_bf16 a[0:3], a[212:215], v[32:35], a[0:3]
    ds_read_b64_tr_b16 a[228:229], v2 offset:1024
    v_fma_f32 v74, v74, s28, v11
    v_lshrrev_b32 v105, 11, v0
    v_fma_f32 v69, v69, s28, v11
    v_mfma_f32_16x16x32_bf16 a[48:51], a[212:215], v[38:41], a[48:51]
    s_waitcnt lgkmcnt(8)
    v_fma_f32 v71, v71, s28, v11
    v_xor_b32 v105, s65, v105
    v_mfma_f32_16x16x32_bf16 v[116:119], a[216:219], v[14:17], v[116:119]
    v_and_b32 v104, 0x3ff, v0
    v_lshl_add_u32 v104, v105, 10, v104
    v_mfma_f32_16x16x32_bf16 v[164:167], a[216:219], v[20:23], v[164:167]
    v_exp_f32 v88, v88
    v_mfma_f32_16x16x32_bf16 v[212:215], a[216:219], v[26:29], v[212:215]
    v_fma_f32 v79, v79, s28, v12
    v_add_u32 v104, s38, v104
    v_mfma_f32_16x16x32_bf16 a[4:7], a[216:219], v[32:35], a[4:7]
    v_exp_f32 v69, v69
    v_mfma_f32_16x16x32_bf16 a[52:55], a[216:219], v[38:41], a[52:55]
    s_waitcnt lgkmcnt(4)
    ds_read_b128 a[96:99], v104 offset:0
    v_fma_f32 v67, v67, s28, v10
    v_mfma_f32_16x16x32_bf16 v[120:123], a[220:223], v[14:17], v[120:123]
    ds_read_b128 a[136:139], v104 offset:10240
    v_fma_f32 v83, v83, s28, v12
    v_mfma_f32_16x16x32_bf16 v[168:171], a[220:223], v[20:23], v[168:171]
    ds_read_b64_tr_b16 a[218:219], v5 offset:7168
    v_fma_f32 v57, v57, s28, v9
    v_mfma_f32_16x16x32_bf16 v[216:219], a[220:223], v[26:29], v[216:219]
    ds_read_b64_tr_b16 a[214:215], v4 offset:7168
    v_fma_f32 v64, v64, s28, v10
    v_mfma_f32_16x16x32_bf16 a[8:11], a[220:223], v[32:35], a[8:11]
    ds_read_b64_tr_b16 a[216:217], v5 offset:1024
    v_xor_b32 v105, 64, v104
    v_mfma_f32_16x16x32_bf16 a[56:59], a[220:223], v[38:41], a[56:59]
    v_exp_f32 v71, v71
    v_mfma_f32_16x16x32_bf16 v[124:127], a[224:227], v[14:17], v[124:127]
    v_fma_f32 v84, v84, s28, v13
    v_fma_f32 v76, v76, s28, v12
    v_mfma_f32_16x16x32_bf16 v[172:175], a[224:227], v[20:23], v[172:175]
    ds_read_b128 a[132:135], v105 offset:8192
    v_fma_f32 v80, v80, s28, v12
    v_mfma_f32_16x16x32_bf16 v[220:223], a[224:227], v[26:29], v[220:223]
    ds_read_b64_tr_b16 a[220:221], v2 offset:2048
    v_fma_f32 v56, v56, s28, v9
    v_mfma_f32_16x16x32_bf16 a[12:15], a[224:227], v[32:35], a[12:15]
    ds_read_b64_tr_b16 a[212:213], v4 offset:1024
    v_fma_f32 v65, v65, s28, v10
    v_mfma_f32_16x16x32_bf16 a[60:63], a[224:227], v[38:41], a[60:63]
    s_waitcnt lgkmcnt(7)
    ds_read_b128 a[152:155], v104 offset:14336
    v_fma_f32 v72, v72, s28, v11
    v_mfma_f32_16x16x32_bf16 v[128:131], a[228:231], v[14:17], v[128:131]
    v_exp_f32 v65, v65
    v_mfma_f32_16x16x32_bf16 v[176:179], a[228:231], v[20:23], v[176:179]
    v_exp_f32 v76, v76
    v_mfma_f32_16x16x32_bf16 v[224:227], a[228:231], v[26:29], v[224:227]
    v_exp_f32 v68, v68
    v_mfma_f32_16x16x32_bf16 a[16:19], a[228:231], v[32:35], a[16:19]
    ds_read_b128 a[168:171], v104 offset:18432
    v_fma_f32 v85, v85, s28, v13
    v_mfma_f32_16x16x32_bf16 a[64:67], a[228:231], v[38:41], a[64:67]
    ds_read_b64_tr_b16 a[230:231], v4 offset:8192
    v_mfma_f32_16x16x32_bf16 v[132:135], a[232:235], v[14:17], v[132:135]
    ds_read_b128 a[128:131], v104 offset:8192
    v_mfma_f32_16x16x32_bf16 v[180:183], a[232:235], v[20:23], v[180:183]
    v_exp_f32 v77, v77
    v_mfma_f32_16x16x32_bf16 v[228:231], a[232:235], v[26:29], v[228:231]
    s_add_u32 s39, s39, 12288
    ds_read_b64_tr_b16 a[222:223], v2 offset:8192
    v_fma_f32 v70, v70, s28, v11
    v_mfma_f32_16x16x32_bf16 a[20:23], a[232:235], v[32:35], a[20:23]
    ds_read_b64_tr_b16 a[228:229], v4 offset:2048
    v_cvt_pk_bf16_f32 v36, v76, v77
    v_mfma_f32_16x16x32_bf16 a[68:71], a[232:235], v[38:41], a[68:71]
    s_waitcnt lgkmcnt(5)
    ds_read_b64_tr_b16 a[224:225], v3 offset:2048
    v_cvt_pk_bf16_f32 v30, v68, v69
    v_mfma_f32_16x16x32_bf16 v[136:139], a[212:215], v[14:17], v[136:139]
    ds_read_b64_tr_b16 a[234:235], v5 offset:8192
    v_exp_f32 v72, v72
    v_mfma_f32_16x16x32_bf16 v[184:187], a[212:215], v[20:23], v[184:187]
    ds_read_b64_tr_b16 a[232:233], v5 offset:2048
    ds_read_b64_tr_b16 a[226:227], v3 offset:8192
    v_mfma_f32_16x16x32_bf16 v[232:235], a[212:215], v[26:29], v[232:235]
    ds_read_b128 a[124:127], v105 offset:6144
    v_fma_f32 v86, v86, s28, v13
    v_mfma_f32_16x16x32_bf16 a[24:27], a[212:215], v[32:35], a[24:27]
    ds_read_b128 a[148:151], v105 offset:12288
    v_fma_f32 v78, v78, s28, v12
    v_mfma_f32_16x16x32_bf16 a[72:75], a[212:215], v[38:41], a[72:75]
    v_exp_f32 v74, v74
    v_mfma_f32_16x16x32_bf16 v[140:143], a[216:219], v[14:17], v[140:143]
    v_exp_f32 v84, v84
    v_mfma_f32_16x16x32_bf16 v[188:191], a[216:219], v[20:23], v[188:191]
    v_exp_f32 v56, v56
    v_mfma_f32_16x16x32_bf16 v[236:239], a[216:219], v[26:29], v[236:239]
    ds_read_b128 a[120:123], v104 offset:6144
    v_mfma_f32_16x16x32_bf16 a[28:31], a[216:219], v[32:35], a[28:31]
    ds_read_b128 a[144:147], v104 offset:12288
    v_exp_f32 v78, v78
    v_mfma_f32_16x16x32_bf16 a[76:79], a[216:219], v[38:41], a[76:79]
    s_waitcnt lgkmcnt(7)
    v_exp_f32 v70, v70
    v_mfma_f32_16x16x32_bf16 v[144:147], a[220:223], v[14:17], v[144:147]
    ds_read_b128 a[156:159], v105 offset:14336
    v_fma_f32 v81, v81, s28, v12
    v_mfma_f32_16x16x32_bf16 v[192:195], a[220:223], v[20:23], v[192:195]
    s_waitcnt vmcnt(6) lgkmcnt(5)
    v_exp_f32 v79, v79
    v_mfma_f32_16x16x32_bf16 v[240:243], a[220:223], v[26:29], v[240:243]
    s_add_u32 s21, s21, s62
    ds_read_b128 a[108:111], v105 offset:2048
    s_add_u32 m0, s22, 24576
    v_mfma_f32_16x16x32_bf16 a[32:35], a[220:223], v[32:35], a[32:35]
    s_barrier
    v_mfma_f32_16x16x32_bf16 a[80:83], a[220:223], v[38:41], a[80:83]
    ds_read_b128 a[104:107], v104 offset:2048
    v_fma_f32 v75, v75, s28, v11
    v_mfma_f32_16x16x32_bf16 v[148:151], a[224:227], v[14:17], v[148:151]
    ds_read_b128 a[100:103], v105 offset:0
    buffer_load_dwordx4 v6, s[8:11], s21 offen lds
    v_mfma_f32_16x16x32_bf16 v[196:199], a[224:227], v[20:23], v[196:199]
    s_add_u32 s21, s21, 128
    s_add_u32 m0, s22, 25600
    ds_read_b128 a[216:219], v1 offset:0
    v_mfma_f32_16x16x32_bf16 v[244:247], a[224:227], v[26:29], v[244:247]
    buffer_load_dwordx4 v6, s[8:11], s21 offen lds
    v_mfma_f32_16x16x32_bf16 a[36:39], a[224:227], v[32:35], a[36:39]
    ds_read_b128 a[212:215], v0 offset:0
    v_fma_f32 v87, v87, s28, v13
    v_mfma_f32_16x16x32_bf16 a[84:87], a[224:227], v[38:41], a[84:87]
    ds_read_b128 a[220:223], v0 offset:1024
    v_mfma_f32_16x16x32_bf16 v[152:155], a[228:231], v[14:17], v[152:155]
    s_add_u32 s21, s21, 128
    v_exp_f32 v64, v64
    v_mfma_f32_16x16x32_bf16 v[200:203], a[228:231], v[20:23], v[200:203]
    s_add_u32 m0, s22, 26624
    ds_read_b128 a[164:167], v105 offset:16384
    v_mfma_f32_16x16x32_bf16 v[248:251], a[228:231], v[26:29], v[248:251]
    buffer_load_dwordx4 v6, s[8:11], s21 offen lds
    v_mfma_f32_16x16x32_bf16 a[40:43], a[228:231], v[32:35], a[40:43]
    ds_read_b128 a[112:115], v104 offset:4096
    v_fma_f32 v82, v82, s28, v12
    v_mfma_f32_16x16x32_bf16 a[88:91], a[228:231], v[38:41], a[88:91]
    ds_read_b128 a[160:163], v104 offset:16384
    v_fma_f32 v90, v90, s28, v13
    v_mfma_f32_16x16x32_bf16 v[156:159], a[232:235], v[14:17], v[156:159]
    ds_read_b128 a[176:179], v104 offset:20480
    v_fma_f32 v58, v58, s28, v9
    v_mfma_f32_16x16x32_bf16 v[204:207], a[232:235], v[20:23], v[204:207]
    v_exp_f32 v83, v83
    v_mfma_f32_16x16x32_bf16 v[252:255], a[232:235], v[26:29], v[252:255]
    ds_read_b128 a[172:175], v105 offset:18432
    v_cvt_pk_bf16_f32 v37, v78, v79
    v_mfma_f32_16x16x32_bf16 a[44:47], a[232:235], v[32:35], a[44:47]
    ds_read_b128 a[180:183], v105 offset:20480
    v_fma_f32 v59, v59, s28, v9
    v_mfma_f32_16x16x32_bf16 a[92:95], a[232:235], v[38:41], a[92:95]
    s_waitcnt lgkmcnt(6)
    ds_read_b128 a[224:227], v1 offset:1024
    v_cvt_pk_bf16_f32 v22, v64, v65
    v_mfma_f32_16x16x32_bf16 v[52:55], a[212:215], a[96:99], 0
    ds_read_b128 a[228:231], v0 offset:2048
    v_mfma_f32_16x16x32_bf16 v[52:55], a[216:219], a[100:103], v[52:55]
    ds_read_b128 a[232:235], v1 offset:2048
    v_fma_f32 v91, v91, s28, v13
    v_mfma_f32_16x16x32_bf16 v[52:55], a[220:223], a[104:107], v[52:55]
    s_add_u32 s21, s21, 12032
    ds_read_b128 a[116:119], v105 offset:4096
    v_cvt_pk_bf16_f32 v31, v70, v71
    v_mfma_f32_16x16x32_bf16 v[60:63], a[212:215], a[120:123], 0
    ds_read_b128 a[140:143], v105 offset:10240
    v_fma_f32 v73, v73, s28, v11
    v_mfma_f32_16x16x32_bf16 v[60:63], a[216:219], a[124:127], v[60:63]
    v_exp_f32 v81, v81
    v_mfma_f32_16x16x32_bf16 v[60:63], a[220:223], a[128:131], v[60:63]
    v_exp_f32 v73, v73
    v_mfma_f32_16x16x32_bf16 v[68:71], a[212:215], a[144:147], 0
    ds_read_b128 a[184:187], v104 offset:22528
    v_mfma_f32_16x16x32_bf16 v[68:71], a[216:219], a[148:151], v[68:71]
    v_exp_f32 v85, v85
    v_mfma_f32_16x16x32_bf16 v[68:71], a[220:223], a[152:155], v[68:71]
    ds_read_b128 a[188:191], v105 offset:22528
    v_fma_f32 v66, v66, s28, v10
    v_mfma_f32_16x16x32_bf16 v[76:79], a[212:215], a[168:171], 0
    s_waitcnt lgkmcnt(6)
    ds_read_b128 a[212:215], v0 offset:6144
    v_fma_f32 v89, v89, s28, v13
    v_mfma_f32_16x16x32_bf16 v[76:79], a[216:219], a[172:175], v[76:79]
    v_exp_f32 v57, v57
    v_mfma_f32_16x16x32_bf16 v[76:79], a[220:223], a[176:179], v[76:79]
    ds_read_b128 a[220:223], v0 offset:7168
    v_mfma_f32_16x16x32_bf16 v[52:55], a[224:227], a[108:111], v[52:55]
    s_waitcnt lgkmcnt(5)
    v_exp_f32 v82, v82
    v_mfma_f32_16x16x32_bf16 v[52:55], a[228:231], a[112:115], v[52:55]
    v_exp_f32 v58, v58
    v_mfma_f32_16x16x32_bf16 v[52:55], a[232:235], a[116:119], v[52:55]
    ds_read_b128 a[216:219], v1 offset:6144
    v_mfma_f32_16x16x32_bf16 v[60:63], a[224:227], a[132:135], v[60:63]
    v_exp_f32 v67, v67
    v_mfma_f32_16x16x32_bf16 v[60:63], a[228:231], a[136:139], v[60:63]
    s_waitcnt lgkmcnt(4)
    v_mfma_f32_16x16x32_bf16 v[60:63], a[232:235], a[140:143], v[60:63]
    v_exp_f32 v66, v66
    v_mfma_f32_16x16x32_bf16 v[68:71], a[224:227], a[156:159], v[68:71]
    v_exp_f32 v59, v59
    v_mfma_f32_16x16x32_bf16 v[68:71], a[228:231], a[160:163], v[68:71]
    v_cvt_pk_bf16_f32 v16, v56, v57
    v_mfma_f32_16x16x32_bf16 v[68:71], a[232:235], a[164:167], v[68:71]
    v_exp_f32 v75, v75
    v_mfma_f32_16x16x32_bf16 v[76:79], a[224:227], a[180:183], v[76:79]
    ds_read_b128 a[224:227], v1 offset:7168
    v_cvt_pk_bf16_f32 v28, v72, v73
    v_mfma_f32_16x16x32_bf16 v[76:79], a[228:231], a[184:187], v[76:79]
    s_waitcnt lgkmcnt(2)
    ds_read_b128 a[228:231], v0 offset:8192
    v_cvt_pk_bf16_f32 v17, v58, v59
    v_mfma_f32_16x16x32_bf16 v[76:79], a[232:235], a[188:191], v[76:79]
    ds_read_b128 a[232:235], v1 offset:8192
    v_cvt_pk_bf16_f32 v42, v84, v85
    v_mfma_f32_16x16x32_bf16 v[48:51], a[236:239], v[16:19], v[44:47]
    v_exp_f32 v87, v87
    v_mfma_f32_16x16x32_bf16 v[56:59], a[212:215], a[96:99], 0
    s_waitcnt lgkmcnt(3)
    v_exp_f32 v86, v86
    v_mfma_f32_16x16x32_bf16 v[56:59], a[216:219], a[100:103], v[56:59]
    v_exp_f32 v90, v90
    v_mfma_f32_16x16x32_bf16 v[56:59], a[220:223], a[104:107], v[56:59]
    v_cvt_pk_bf16_f32 v23, v66, v67
    v_cvt_pk_bf16_f32 v29, v74, v75
    v_mfma_f32_16x16x32_bf16 v[64:67], a[212:215], a[120:123], 0
    v_exp_f32 v89, v89
    v_mfma_f32_16x16x32_bf16 v[48:51], a[240:243], v[22:25], v[48:51]
    v_exp_f32 v80, v80
    v_mfma_f32_16x16x32_bf16 v[64:67], a[216:219], a[124:127], v[64:67]
    v_exp_f32 v91, v91
    v_mfma_f32_16x16x32_bf16 v[64:67], a[220:223], a[128:131], v[64:67]
    v_cvt_pk_bf16_f32 v35, v82, v83
    v_cvt_pk_bf16_f32 v40, v88, v89
    v_mfma_f32_16x16x32_bf16 v[72:75], a[212:215], a[144:147], 0
    v_cvt_pk_bf16_f32 v34, v80, v81
    s_waitcnt vmcnt(6) lgkmcnt(0)
    v_mfma_f32_16x16x32_bf16 v[72:75], a[216:219], a[148:151], v[72:75]
    s_barrier
    v_mfma_f32_16x16x32_bf16 v[48:51], a[244:247], v[28:31], v[48:51]
    v_cvt_pk_bf16_f32 v41, v90, v91
    v_cvt_pk_bf16_f32 v43, v86, v87
    v_mfma_f32_16x16x32_bf16 v[48:51], a[248:251], v[34:37], v[48:51]
    s_nop 0
    v_mfma_f32_16x16x32_bf16 v[48:51], a[252:255], v[40:43], v[48:51]
    v_mfma_f32_16x16x32_bf16 v[72:75], a[220:223], a[152:155], v[72:75]
    v_mfma_f32_16x16x32_bf16 v[80:83], a[212:215], a[168:171], 0
    ds_read_b64_tr_b16 a[212:213], v2 offset:18432
    v_mfma_f32_16x16x32_bf16 v[80:83], a[216:219], a[172:175], v[80:83]
    ds_read_b64_tr_b16 a[214:215], v2 offset:12288
    v_mfma_f32_16x16x32_bf16 v[80:83], a[220:223], a[176:179], v[80:83]
    s_nop 1
    v_cmp_lt_f32 vcc, s29, v48
    v_mfma_f32_16x16x32_bf16 v[56:59], a[224:227], a[108:111], v[56:59]
    ds_read_b64_tr_b16 a[216:217], v3 offset:18432
    v_mfma_f32_16x16x32_bf16 v[56:59], a[228:231], a[112:115], v[56:59]
    ds_read_b64_tr_b16 a[218:219], v3 offset:12288
    v_mfma_f32_16x16x32_bf16 v[56:59], a[232:235], a[116:119], v[56:59]
    s_cbranch_vccnz L_rs_tr54b
L_ret_tr54b:
    s_add_u32 m0, s22, 0
    v_mfma_f32_16x16x32_bf16 v[64:67], a[224:227], a[132:135], v[64:67]
    buffer_load_dwordx4 v6, s[4:7], s20 offen lds
    v_mfma_f32_16x16x32_bf16 v[64:67], a[228:231], a[136:139], v[64:67]
    s_add_u32 s20, s20, 128
    ds_read_b64_tr_b16 a[220:221], v4 offset:18432
    s_add_u32 m0, s22, 1024
    v_mfma_f32_16x16x32_bf16 v[64:67], a[232:235], a[140:143], v[64:67]
    buffer_load_dwordx4 v6, s[4:7], s20 offen lds
    v_mfma_f32_16x16x32_bf16 v[72:75], a[224:227], a[156:159], v[72:75]
    s_add_u32 s20, s20, 128
    ds_read_b64_tr_b16 a[222:223], v4 offset:12288
    s_add_u32 m0, s22, 2048
    v_mfma_f32_16x16x32_bf16 v[72:75], a[228:231], a[160:163], v[72:75]
    buffer_load_dwordx4 v6, s[4:7], s20 offen lds
    v_mfma_f32_16x16x32_bf16 v[72:75], a[232:235], a[164:167], v[72:75]
    v_mfma_f32_16x16x32_bf16 v[80:83], a[224:227], a[180:183], v[80:83]
    s_add_u32 s20, s20, 12032
    ds_read_b64_tr_b16 a[224:225], v5 offset:18432
    v_mfma_f32_16x16x32_bf16 v[80:83], a[228:231], a[184:187], v[80:83]
    v_mfma_f32_16x16x32_bf16 v[80:83], a[232:235], a[188:191], v[80:83]
    ds_read_b64_tr_b16 a[226:227], v5 offset:12288
    v_max3_f32 v96, v52, v53, v54
    v_max3_f32 v96, v96, v55, v56
    v_max3_f32 v96, v96, v57, v58
    s_waitcnt lgkmcnt(6)
    v_mfma_f32_16x16x32_bf16 v[112:115], a[212:215], v[16:19], v[112:115]
    s_mov_b32 s67, s34
    v_max_f32 v96, v96, v59
    v_mov_b32 v97, v96
    v_mfma_f32_16x16x32_bf16 v[160:163], a[212:215], v[22:25], v[160:163]
    s_add_u32 s18, s34, 30720
    v_mov_b32 v100, v48
    v_permlane32_swap_b32 v97, v96
    v_max_f32 v96, v96, v97
    v_mov_b32 v97, v96
    v_mfma_f32_16x16x32_bf16 v[208:211], a[212:215], v[28:31], v[208:211]
    s_mov_b32 s34, s33
    ds_read_b64_tr_b16 a[228:229], v2 offset:19456
    v_permlane16_swap_b32 v97, v96
    v_max_f32 v96, v96, v97
    v_mul_f32_e64 v9, -s28, v96
    v_max3_f32 v96, v60, v61, v62
    v_max3_f32 v96, v96, v63, v64
    v_max3_f32 v96, v96, v65, v66
    v_max_f32 v96, v96, v67
    v_mov_b32 v97, v96
    v_mbcnt_lo_u32_b32 v104, -1, 0
    v_fma_f32 v52, v52, s28, v9
    v_permlane32_swap_b32 v97, v96
    v_max_f32 v96, v96, v97
    v_mov_b32 v97, v96
    v_mbcnt_hi_u32_b32 v104, -1, v104
    v_mfma_f32_16x16x32_bf16 a[0:3], a[212:215], v[34:37], a[0:3]
    ds_read_b64_tr_b16 a[234:235], v3 offset:13312
    v_rcp_f32 v49, v49
    v_permlane16_swap_b32 v97, v96
    v_mfma_f32_16x16x32_bf16 a[48:51], a[212:215], v[40:43], a[48:51]
    s_waitcnt lgkmcnt(2)
    v_max_f32 v96, v96, v97
    v_mul_f32_e64 v10, -s28, v96
    v_max3_f32 v96, v68, v69, v70
    v_mfma_f32_16x16x32_bf16 v[116:119], a[216:219], v[16:19], v[116:119]
    s_add_u32 s64, s64, s62
    ds_read_b64_tr_b16 a[230:231], v2 offset:13312
    v_max3_f32 v96, v96, v71, v72
    v_max3_f32 v96, v96, v73, v74
    v_mfma_f32_16x16x32_bf16 v[164:167], a[216:219], v[22:25], v[164:167]
    s_add_u32 s64, s64, 196608
    v_max_f32 v96, v96, v75
    v_mov_b32 v97, v96
    v_fma_f32 v62, v62, s28, v10
    v_mfma_f32_16x16x32_bf16 v[212:215], a[216:219], v[28:31], v[212:215]
    s_mov_b32 s39, s64
    v_accvgpr_read_b32 v111, a51
    v_permlane32_swap_b32 v97, v96
    v_fma_f32 v65, v65, s28, v10
    v_mfma_f32_16x16x32_bf16 a[4:7], a[216:219], v[34:37], a[4:7]
    ds_read_b64_tr_b16 a[232:233], v3 offset:19456
    v_fma_f32 v57, v57, s28, v9
    v_mfma_f32_16x16x32_bf16 a[52:55], a[216:219], v[40:43], a[52:55]
    s_add_u32 s37, s37, 1
    ds_read_b64_tr_b16 a[212:213], v4 offset:19456
    v_fma_f32 v63, v63, s28, v10
    v_fma_f32 v59, v59, s28, v9
    v_max_f32 v96, v96, v97
    v_mul_f32 v163, v163, v49
    v_mov_b32 v97, v96
    v_mfma_f32_16x16x32_bf16 v[120:123], a[220:223], v[16:19], v[120:123]
    s_bitcmp1_b32 s63, s37
    v_fma_f32 v56, v56, s28, v9
    v_permlane16_swap_b32 v97, v96
    v_mfma_f32_16x16x32_bf16 v[168:171], a[220:223], v[22:25], v[168:171]
    s_cselect_b32 s62, 4294770688, 0
    ds_read_b64_tr_b16 a[214:215], v4 offset:13312
    v_max_f32 v96, v96, v97
    v_mfma_f32_16x16x32_bf16 v[216:219], a[220:223], v[28:31], v[216:219]
    s_cselect_b32 s42, 0, 325632
    ds_read_b64_tr_b16 a[218:219], v5 offset:13312
    v_mul_f32_e64 v11, -s28, v96
    v_subrev_u32 v8, 28672, v8
    v_mfma_f32_16x16x32_bf16 a[8:11], a[220:223], v[34:37], a[8:11]
    s_add_u32 s35, s35, s42
    v_lshrrev_b32 v106, 5, v104
    v_fma_f32 v71, v71, s28, v11
    v_max3_f32 v96, v76, v77, v78
    v_mfma_f32_16x16x32_bf16 a[56:59], a[220:223], v[40:43], a[56:59]
    s_lshl_b32 s42, s37, 1
    v_bfe_u32 v105, v104, 3, 1
    v_fma_f32 v55, v55, s28, v9
    v_exp_f32 v57, v57
    v_fma_f32 v54, v54, s28, v9
    v_mfma_f32_16x16x32_bf16 v[124:127], a[224:227], v[16:19], v[124:127]
    s_lshr_b32 s42, s31, s42
    v_xor_b32 v106, v106, v105
    v_fma_f32 v69, v69, s28, v11
    v_mfma_f32_16x16x32_bf16 v[172:175], a[224:227], v[22:25], v[172:175]
    s_and_b32 s42, s42, 3
    v_and_b32 v107, 3, v104
    v_mul_f32 v168, v168, v49
    v_mfma_f32_16x16x32_bf16 v[220:223], a[224:227], v[28:31], v[220:223]
    s_add_u32 s42, s42, s36
    v_mul_f32 v162, v162, v49
    v_max3_f32 v96, v96, v79, v80
    v_exp_f32 v54, v54
    v_mfma_f32_16x16x32_bf16 a[12:15], a[224:227], v[34:37], a[12:15]
    s_sub_u32 s43, s42, 3
    ds_read_b64_tr_b16 a[216:217], v5 offset:19456
    v_fma_f32 v68, v68, s28, v11
    v_max3_f32 v96, v96, v81, v82
    v_mfma_f32_16x16x32_bf16 a[60:63], a[224:227], v[40:43], a[60:63]
    s_waitcnt lgkmcnt(2)
    v_mul_f32 v160, v160, v49
    v_max_f32 v96, v96, v83
    v_xor_b32 v105, s65, v105
    v_mfma_f32_16x16x32_bf16 v[128:131], a[228:231], v[16:19], v[128:131]
    s_cmp_ge_u32 s42, 3
    ds_read_b64_tr_b16 a[220:221], v2 offset:20480
    v_fma_f32 v60, v60, s28, v10
    v_mfma_f32_16x16x32_bf16 v[176:179], a[228:231], v[22:25], v[176:179]
    s_cselect_b32 s42, s43, s42
    ds_read_b64_tr_b16 a[222:223], v2 offset:14336
    v_mov_b32 v97, v96
    v_mfma_f32_16x16x32_bf16 v[224:227], a[228:231], v[28:31], v[224:227]
    s_mul_i32 s44, s3, 5
    ds_read_b64_tr_b16 a[226:227], v3 offset:14336
    v_mul_f32 v170, v170, v49
    v_mfma_f32_16x16x32_bf16 a[16:19], a[228:231], v[34:37], a[16:19]
    s_mov_b32 s32, 1
    v_permlane32_swap_b32 v97, v96
    v_mfma_f32_16x16x32_bf16 a[64:67], a[228:231], v[40:43], a[64:67]
    s_lshl_b32 s43, s3, 2
    v_accvgpr_read_b32 v108, a48
    v_lshl_or_b32 v106, v107, 1, v106
    v_mfma_f32_16x16x32_bf16 v[132:135], a[232:235], v[16:19], v[132:135]
    s_add_u32 s45, s43, 21
    ds_read_b64_tr_b16 a[224:225], v3 offset:20480
    v_max_f32 v96, v96, v97
    v_mov_b32 v97, v96
    v_mfma_f32_16x16x32_bf16 v[180:183], a[232:235], v[22:25], v[180:183]
    s_cmp_eq_u32 s3, 0
    v_mul_f32 v165, v165, v49
    v_fma_f32 v70, v70, s28, v11
    v_mfma_f32_16x16x32_bf16 v[228:231], a[232:235], v[28:31], v[228:231]
    s_cselect_b32 s45, 20, s45
    v_fma_f32 v66, v66, s28, v10
    v_mul_f32 v161, v161, v49
    v_mfma_f32_16x16x32_bf16 a[20:23], a[232:235], v[34:37], a[20:23]
    s_cselect_b32 s33, 1, 0
    v_permlane32_swap_b32 v48, v100
    v_mfma_f32_16x16x32_bf16 a[68:71], a[232:235], v[40:43], a[68:71]
    s_cmp_eq_u32 s42, 1
    v_fma_f32 v74, v74, s28, v11
    v_mul_f32 v176, v176, v49
    v_mfma_f32_16x16x32_bf16 v[136:139], a[212:215], v[16:19], v[136:139]
    s_cselect_b32 s44, s45, s44
    v_fma_f32 v58, v58, s28, v9
    v_permlane16_swap_b32 v97, v96
    v_mfma_f32_16x16x32_bf16 v[184:187], a[212:215], v[22:25], v[184:187]
    s_cselect_b32 s32, s33, s32
    v_max_f32 v96, v96, v97
    v_and_b32 v107, 7, v104
    v_lshl_add_u32 v101, v105, 10, s38
    v_mfma_f32_16x16x32_bf16 v[232:235], a[212:215], v[28:31], v[232:235]
    s_add_u32 s45, s43, 37
    ds_read_b64_tr_b16 a[228:229], v4 offset:20480
    v_mul_f32_e64 v12, -s28, v96
    v_accvgpr_read_b32 v110, a50
    v_mfma_f32_16x16x32_bf16 a[24:27], a[212:215], v[34:37], a[24:27]
    s_cmp_eq_u32 s42, 2
    ds_read_b64_tr_b16 a[234:235], v5 offset:14336
    v_exp_f32 v66, v66
    v_cvt_pk_bf16_f32 v160, v160, v161
    v_mfma_f32_16x16x32_bf16 a[72:75], a[212:215], v[40:43], a[72:75]
    s_waitcnt lgkmcnt(2)
    ds_read_b64_tr_b16 a[230:231], v4 offset:14336
    v_fma_f32 v61, v61, s28, v10
    v_mfma_f32_16x16x32_bf16 v[140:143], a[216:219], v[16:19], v[140:143]
    s_cselect_b32 s44, s45, s44
    v_fma_f32 v76, v76, s28, v12
    v_fma_f32 v53, v53, s28, v9
    v_mfma_f32_16x16x32_bf16 v[188:191], a[216:219], v[22:25], v[188:191]
    s_cselect_b32 s32, 0, s32
    ds_read_b64_tr_b16 a[232:233], v5 offset:20480
    v_mul_f32 v164, v164, v49
    v_mfma_f32_16x16x32_bf16 v[236:239], a[216:219], v[28:31], v[236:239]
    s_mul_i32 s44, s44, 6144
    v_exp_f32 v60, v60
    v_mfma_f32_16x16x32_bf16 a[28:31], a[216:219], v[34:37], a[28:31]
    s_add_u32 s33, s35, s44
    v_fma_f32 v81, v81, s28, v12
    v_lshl_add_u32 v101, v106, 4, v101
    v_mfma_f32_16x16x32_bf16 a[76:79], a[216:219], v[40:43], a[76:79]
    s_mul_i32 s42, s32, 6144
    v_exp_f32 v71, v71
    v_mfma_f32_16x16x32_bf16 v[144:147], a[220:223], v[16:19], v[144:147]
    s_add_u32 s42, s42, 24576
    v_exp_f32 v56, v56
    v_exp_f32 v69, v69
    v_mfma_f32_16x16x32_bf16 v[192:195], a[220:223], v[22:25], v[192:195]
    s_add_u32 s42, s42, s33
    v_exp_f32 v55, v55
    v_mfma_f32_16x16x32_bf16 v[240:243], a[220:223], v[28:31], v[240:243]
    s_cmp_ge_u32 s37, 6
    v_fma_f32 v78, v78, s28, v12
    v_exp_f32 v63, v63
    v_mfma_f32_16x16x32_bf16 a[32:35], a[220:223], v[34:37], a[32:35]
    s_cselect_b32 s14, 0, s42
    v_fma_f32 v77, v77, s28, v12
    v_fma_f32 v80, v80, s28, v12
    v_fma_f32 v64, v64, s28, v10
    v_mfma_f32_16x16x32_bf16 a[80:83], a[220:223], v[40:43], a[80:83]
    s_add_u32 s24, s67, 6400
    v_cvt_pk_bf16_f32 v15, v54, v55
    v_accvgpr_read_b32 v109, a49
    v_mfma_f32_16x16x32_bf16 v[148:151], a[224:227], v[16:19], v[148:151]
    s_add_u32 s25, s33, 6400
    v_exp_f32 v59, v59
    v_mfma_f32_16x16x32_bf16 v[196:199], a[224:227], v[22:25], v[196:199]
    s_add_u32 s23, s38, 10240
    v_exp_f32 v68, v68
    v_lshl_add_u32 v101, v107, 7, v101
    v_mfma_f32_16x16x32_bf16 v[244:247], a[224:227], v[28:31], v[244:247]
    s_mov_b32 s27, 0x49249249
    v_mul_f32 v186, v186, v49
    v_bfe_u32 v107, v104, 4, 1
    v_mfma_f32_16x16x32_bf16 a[36:39], a[224:227], v[34:37], a[36:39]
    s_mov_b32 s30, 0
    v_mul_f32 v167, v167, v49
    v_rcp_f32 v51, v51
    v_exp_f32 v53, v53
    v_mfma_f32_16x16x32_bf16 a[84:87], a[224:227], v[40:43], a[84:87]
    s_waitcnt vmcnt(6) lgkmcnt(0)
    v_exp_f32 v62, v62
    v_mfma_f32_16x16x32_bf16 v[152:155], a[228:231], v[16:19], v[152:155]
    s_barrier
    ds_read_b128 a[212:215], v0 offset:12288
    v_mul_f32 v197, v197, v49
    v_accvgpr_read_b32 v105, a1
    v_mul_f32 v188, v188, v49
    v_mfma_f32_16x16x32_bf16 v[200:203], a[228:231], v[22:25], v[200:203]
    ds_read_b128 a[220:223], v0 offset:13312
    v_lshl_add_u32 v101, v107, 3, v101
    v_mfma_f32_16x16x32_bf16 v[248:251], a[228:231], v[28:31], v[248:251]
    v_exp_f32 v64, v64
    v_exp_f32 v77, v77
    v_mfma_f32_16x16x32_bf16 a[40:43], a[228:231], v[34:37], a[40:43]
    ds_read_b128 a[216:219], v1 offset:12288
    v_exp_f32 v76, v76
    v_fma_f32 v67, v67, s28, v10
    v_mfma_f32_16x16x32_bf16 a[88:91], a[228:231], v[40:43], a[88:91]
    v_exp_f32 v58, v58
    v_mfma_f32_16x16x32_bf16 v[156:159], a[232:235], v[16:19], v[156:159]
    v_exp_f32 v52, v52
    v_fma_f32 v72, v72, s28, v11
    v_cvt_pk_bf16_f32 v26, v68, v69
    v_exp_f32 v78, v78
    v_mfma_f32_16x16x32_bf16 v[204:207], a[232:235], v[22:25], v[204:207]
    v_cvt_pk_bf16_f32 v14, v52, v53
    v_exp_f32 v65, v65
    v_exp_f32 v80, v80
    v_exp_f32 v61, v61
    v_mfma_f32_16x16x32_bf16 v[252:255], a[232:235], v[28:31], v[252:255]
    v_mul_f32 v177, v177, v49
    v_cvt_pk_bf16_f32 v21, v62, v63
    v_fma_f32 v79, v79, s28, v12
    v_mul_f32 v189, v189, v49
    v_mfma_f32_16x16x32_bf16 a[44:47], a[232:235], v[34:37], a[44:47]
    s_add_u32 m0, s22, 36864
    ds_read_b128 a[224:227], v1 offset:13312
    v_fma_f32 v82, v82, s28, v12
    v_mfma_f32_16x16x32_bf16 a[92:95], a[232:235], v[40:43], a[92:95]
    s_waitcnt lgkmcnt(2)
    v_exp_f32 v79, v79
    v_mfma_f32_16x16x32_bf16 v[52:55], a[212:215], a[96:99], 0
    s_waitcnt lgkmcnt(1)
    v_cvt_pk_bf16_f32 v20, v60, v61
    v_exp_f32 v70, v70
    v_mfma_f32_16x16x32_bf16 v[52:55], a[216:219], a[100:103], v[52:55]
    v_cvt_pk_bf16_f32 v33, v78, v79
    v_mul_f32 v185, v185, v49
    v_mul_f32 v183, v183, v49
    v_mfma_f32_16x16x32_bf16 v[52:55], a[220:223], a[104:107], v[52:55]
    v_cvt_pk_bf16_f32 v22, v64, v65
    v_mov_b32 v104, v100
    v_mfma_f32_16x16x32_bf16 v[60:63], a[212:215], a[120:123], 0
    ds_read_b128 a[228:231], v0 offset:14336
    v_fma_f32 v73, v73, s28, v11
    v_mul_f32 v173, v173, v49
    v_cvt_pk_bf16_f32 v32, v76, v77
    v_mfma_f32_16x16x32_bf16 v[60:63], a[216:219], a[124:127], v[60:63]
    ds_read_b128 a[232:235], v1 offset:14336
    v_mul_f32 v105, v105, v51
    v_cvt_pk_bf16_f32 v27, v70, v71
    v_mfma_f32_16x16x32_bf16 v[60:63], a[220:223], a[128:131], v[60:63]
    v_mul_f32 v178, v178, v49
    v_fma_f32 v83, v83, s28, v12
    v_mfma_f32_16x16x32_bf16 v[68:71], a[212:215], a[144:147], 0
    v_mul_f32 v198, v198, v49
    v_fma_f32 v75, v75, s28, v11
    v_mfma_f32_16x16x32_bf16 v[68:71], a[216:219], a[148:151], v[68:71]
    buffer_load_dwordx4 v6, s[8:11], s21 offen lds
    v_mfma_f32_16x16x32_bf16 v[68:71], a[220:223], a[152:155], v[68:71]
    v_exp_f32 v82, v82
    v_mfma_f32_16x16x32_bf16 v[76:79], a[212:215], a[168:171], 0
    s_add_u32 s21, s21, 128
    v_exp_f32 v73, v73
    v_rcp_f32 v48, v48
    v_mfma_f32_16x16x32_bf16 v[76:79], a[216:219], a[172:175], v[76:79]
    v_exp_f32 v74, v74
    v_mfma_f32_16x16x32_bf16 v[76:79], a[220:223], a[176:179], v[76:79]
    s_waitcnt lgkmcnt(2)
    ds_read_b128 a[212:215], v0 offset:18432
    v_mul_f32 v166, v166, v49
    v_mfma_f32_16x16x32_bf16 v[52:55], a[224:227], a[108:111], v[52:55]
    s_waitcnt lgkmcnt(2)
    v_exp_f32 v75, v75
    v_mul_f32 v184, v184, v49
    v_mfma_f32_16x16x32_bf16 v[52:55], a[228:231], a[112:115], v[52:55]
    s_waitcnt lgkmcnt(1)
    ds_read_b128 a[220:223], v0 offset:19456
    v_mul_f32 v180, v180, v49
    v_mfma_f32_16x16x32_bf16 v[52:55], a[232:235], a[116:119], v[52:55]
    s_add_u32 m0, s22, 37888
    v_permlane16_swap_b32 v100, v104
    v_mfma_f32_16x16x32_bf16 v[60:63], a[224:227], a[132:135], v[60:63]
    v_mul_f32 v195, v195, v49
    v_mul_f32 v205, v205, v49
    v_mfma_f32_16x16x32_bf16 v[60:63], a[228:231], a[136:139], v[60:63]
    v_rcp_f32 v50, v50
    v_mfma_f32_16x16x32_bf16 v[60:63], a[232:235], a[140:143], v[60:63]
    buffer_load_dwordx4 v6, s[8:11], s21 offen lds
    v_accvgpr_read_b32 v106, a2
    v_mfma_f32_16x16x32_bf16 v[68:71], a[224:227], a[156:159], v[68:71]
    v_exp_f32 v67, v67
    v_exp_f32 v72, v72
    v_mfma_f32_16x16x32_bf16 v[68:71], a[228:231], a[160:163], v[68:71]
    v_accvgpr_read_b32 v107, a3
    v_mul_f32 v207, v207, v49
    v_mul_f32 v200, v200, v49
    v_mfma_f32_16x16x32_bf16 v[68:71], a[232:235], a[164:167], v[68:71]
    s_add_u32 s21, s21, 128
    v_cvt_pk_bf16_f32 v17, v58, v59
    v_mul_f32 v202, v202, v49
    v_mfma_f32_16x16x32_bf16 v[76:79], a[224:227], a[180:183], v[76:79]
    s_add_u32 m0, s22, 38912
    ds_read_b128 a[216:219], v1 offset:18432
    v_cvt_pk_bf16_f32 v16, v56, v57
    v_mfma_f32_16x16x32_bf16 v[76:79], a[228:231], a[184:187], v[76:79]
    buffer_load_dwordx4 v6, s[8:11], s21 offen lds
    v_mul_f32 v107, v107, v51
    v_mul_f32 v187, v187, v49
    v_mul_f32 v169, v169, v49
    v_pk_mul_f32 v[218:219], v[218:219], v[50:51] op_sel_hi:[1,0]
    v_mul_f32 v181, v181, v49
    v_accvgpr_read_b32 v104, a0
    v_pk_mul_f32 v[120:121], v[120:121], v[48:49] op_sel_hi:[1,0]
    v_mul_f32 v174, v174, v49
    v_pk_mul_f32 v[216:217], v[216:217], v[50:51] op_sel_hi:[1,0]
    v_pk_mul_f32 v[114:115], v[114:115], v[48:49] op_sel_hi:[1,0]
    v_pk_mul_f32 v[208:209], v[208:209], v[50:51] op_sel_hi:[1,0]
    v_pk_mul_f32 v[112:113], v[112:113], v[48:49] op_sel_hi:[1,0]
    v_pk_mul_f32 v[210:211], v[210:211], v[50:51] op_sel_hi:[1,0]
    v_pk_mul_f32 v[128:129], v[128:129], v[48:49] op_sel_hi:[1,0]
    v_fma_f32 v63, v63, s28, v10
    v_pk_mul_f32 v[116:117], v[116:117], v[48:49] op_sel_hi:[1,0]
    v_pk_mul_f32 v[118:119], v[118:119], v[48:49] op_sel_hi:[1,0]
    v_pk_mul_f32 v[146:147], v[146:147], v[48:49] op_sel_hi:[1,0]
    v_pk_mul_f32 v[214:215], v[214:215], v[50:51] op_sel_hi:[1,0]
    v_pk_mul_f32 v[212:213], v[212:213], v[50:51] op_sel_hi:[1,0]
    v_pk_mul_f32 v[220:221], v[220:221], v[50:51] op_sel_hi:[1,0]
    v_cvt_pk_bf16_f32 v164, v164, v165
    v_cvt_pk_bf16_f32 v23, v66, v67
    v_cvt_pk_bf16_f32 v29, v74, v75
    v_pk_mul_f32 v[122:123], v[122:123], v[48:49] op_sel_hi:[1,0]
    v_cvt_pk_bf16_f32 v161, v162, v163
    v_fma_f32 v68, v68, s28, v11
    v_pk_mul_f32 v[132:133], v[132:133], v[48:49] op_sel_hi:[1,0]
    v_cvt_pk_bf16_f32 v208, v208, v209
    v_pk_mul_f32 v[126:127], v[126:127], v[48:49] op_sel_hi:[1,0]
    v_fma_f32 v71, v71, s28, v11
    v_pk_mul_f32 v[224:225], v[224:225], v[50:51] op_sel_hi:[1,0]
    v_mul_f32 v104, v104, v51
    v_cvt_pk_bf16_f32 v28, v72, v73
    v_cvt_pk_bf16_f32 v104, v104, v105
    v_mfma_f32_16x16x32_bf16 v[76:79], a[232:235], a[188:191], v[76:79]
    v_exp_f32 v71, v71
    v_mfma_f32_16x16x32_bf16 v[44:47], a[236:239], v[14:17], 0
    s_waitcnt lgkmcnt(0)
    ds_read_b128 a[224:227], v1 offset:19456
    v_exp_f32 v83, v83
    v_fma_f32 v70, v70, s28, v11
    v_mfma_f32_16x16x32_bf16 v[56:59], a[212:215], a[96:99], 0
    v_cvt_pk_bf16_f32 v120, v120, v121
    v_cvt_pk_bf16_f32 v112, v112, v113
    v_mfma_f32_16x16x32_bf16 v[56:59], a[216:219], a[100:103], v[56:59]
    v_exp_f32 v81, v81
    v_mfma_f32_16x16x32_bf16 v[56:59], a[220:223], a[104:107], v[56:59]
    v_cvt_pk_bf16_f32 v209, v210, v211
    v_cvt_pk_bf16_f32 v35, v82, v83
    v_mfma_f32_16x16x32_bf16 v[64:67], a[212:215], a[120:123], 0
    ds_read_b128 a[228:231], v0 offset:20480
    v_mul_f32 v172, v172, v49
    v_mfma_f32_16x16x32_bf16 v[64:67], a[216:219], a[124:127], v[64:67]
    ds_read_b128 a[232:235], v1 offset:20480
    v_cvt_pk_bf16_f32 v113, v114, v115
    v_mfma_f32_16x16x32_bf16 v[64:67], a[220:223], a[128:131], v[64:67]
    v_rcp_f32 v100, v100
    v_mfma_f32_16x16x32_bf16 v[72:75], a[212:215], a[144:147], 0
    s_add_u32 s21, s21, 12032
    v_mul_f32 v190, v190, v49
    v_cvt_pk_bf16_f32 v176, v176, v177
    v_mfma_f32_16x16x32_bf16 v[72:75], a[216:219], a[148:151], v[72:75]
    v_cvt_pk_bf16_f32 v34, v80, v81
    v_mul_f32 v179, v179, v49
    v_mul_f32 v196, v196, v49
    v_mfma_f32_16x16x32_bf16 v[72:75], a[220:223], a[152:155], v[72:75]
    v_mul_f32 v106, v106, v51
    v_cvt_pk_bf16_f32 v121, v122, v123
    v_cvt_pk_bf16_f32 v105, v106, v107
    v_mfma_f32_16x16x32_bf16 v[80:83], a[212:215], a[168:171], 0
    ds_write2st64_b64 v101, v[112:113], v[160:161] offset0:0 offset1:12
    v_accvgpr_read_b32 v107, a7
    v_mfma_f32_16x16x32_bf16 v[80:83], a[216:219], a[172:175], v[80:83]
    ds_write2st64_b64 v101, v[208:209], v[104:105] offset0:24 offset1:36
    v_pk_mul_f32 v[108:109], v[108:109], v[100:101] op_sel_hi:[1,0]
    v_pk_mul_f32 v[110:111], v[110:111], v[100:101] op_sel_hi:[1,0]
    v_cvt_pk_bf16_f32 v116, v116, v117
    v_mul_f32 v192, v192, v49
    v_mfma_f32_16x16x32_bf16 v[80:83], a[220:223], a[176:179], v[80:83]
    s_waitcnt vmcnt(6) lgkmcnt(2)
    v_fma_f32 v55, v55, s28, v9
    v_cvt_pk_bf16_f32 v165, v166, v167
    v_mfma_f32_16x16x32_bf16 v[56:59], a[224:227], a[108:111], v[56:59]
    s_barrier
    v_cvt_pk_bf16_f32 v108, v108, v109
    v_cvt_pk_bf16_f32 v109, v110, v111
    v_accvgpr_read_b32 v105, a5
    v_fma_f32 v79, v79, s28, v12
    v_cvt_pk_bf16_f32 v117, v118, v119
    v_accvgpr_read_b32 v106, a6
    v_cvt_pk_bf16_f32 v180, v180, v181
    v_mfma_f32_16x16x32_bf16 v[56:59], a[228:231], a[112:115], v[56:59]
    v_fma_f32 v52, v52, s28, v9
    v_mul_f32 v194, v194, v49
    v_mfma_f32_16x16x32_bf16 v[56:59], a[232:235], a[116:119], v[56:59]
    ds_read_b64_tr_b16 a[212:213], v2 offset:0
    v_accvgpr_read_b32 v111, a55
    v_mfma_f32_16x16x32_bf16 v[64:67], a[224:227], a[132:135], v[64:67]
    ds_read_b64_tr_b16 a[214:215], v2 offset:6144
    v_exp_f32 v55, v55
    v_cvt_pk_bf16_f32 v177, v178, v179
    v_mfma_f32_16x16x32_bf16 v[64:67], a[228:231], a[136:139], v[64:67]
    ds_write_b64 v101, v[108:109] offset:24576
    v_fma_f32 v76, v76, s28, v12
    v_mul_f32 v204, v204, v49
    v_cvt_pk_bf16_f32 v184, v184, v185
    v_accvgpr_read_b32 v109, a53
    v_mfma_f32_16x16x32_bf16 v[64:67], a[232:235], a[140:143], v[64:67]
    v_mul_f32 v171, v171, v49
    v_fma_f32 v69, v69, s28, v11
    v_accvgpr_read_b32 v104, a4
    v_accvgpr_read_b32 v110, a54
    v_mul_f32 v106, v106, v51
    v_pk_mul_f32 v[244:245], v[244:245], v[50:51] op_sel_hi:[1,0]
    v_fma_f32 v78, v78, s28, v12
    v_fma_f32 v57, v57, s28, v9
    v_mfma_f32_16x16x32_bf16 v[72:75], a[224:227], a[156:159], v[72:75]
    ds_read_b64_tr_b16 a[216:217], v3 offset:0
    v_xor_b32 v101, 32, v101
    v_mul_f32 v105, v105, v51
    v_accvgpr_read_b32 v108, a52
    v_cvt_pk_bf16_f32 v216, v216, v217
    v_mfma_f32_16x16x32_bf16 v[72:75], a[228:231], a[160:163], v[72:75]
    ds_write2st64_b64 v101, v[116:117], v[164:165] offset0:0 offset1:12
    v_pk_mul_f32 v[138:139], v[138:139], v[48:49] op_sel_hi:[1,0]
    v_pk_mul_f32 v[108:109], v[108:109], v[100:101] op_sel_hi:[1,0]
    v_fma_f32 v61, v61, s28, v10
    v_cvt_pk_bf16_f32 v132, v132, v133
    v_pk_mul_f32 v[246:247], v[246:247], v[50:51] op_sel_hi:[1,0]
    v_pk_mul_f32 v[124:125], v[124:125], v[48:49] op_sel_hi:[1,0]
    v_cvt_pk_bf16_f32 v168, v168, v169
    v_cvt_pk_bf16_f32 v212, v212, v213
    v_cvt_pk_bf16_f32 v188, v188, v189
    v_mul_f32 v104, v104, v51
    v_pk_mul_f32 v[236:237], v[236:237], v[50:51] op_sel_hi:[1,0]
    v_cvt_pk_bf16_f32 v104, v104, v105
    v_cvt_pk_bf16_f32 v108, v108, v109
    v_pk_mul_f32 v[110:111], v[110:111], v[100:101] op_sel_hi:[1,0]
    v_mul_f32 v107, v107, v51
    v_mul_f32 v175, v175, v49
    v_mfma_f32_16x16x32_bf16 v[72:75], a[232:235], a[164:167], v[72:75]
    s_add_u32 m0, s22, 12288
    v_cvt_pk_bf16_f32 v105, v106, v107
    v_cvt_pk_bf16_f32 v213, v214, v215
    v_mfma_f32_16x16x32_bf16 v[80:83], a[224:227], a[180:183], v[80:83]
    ds_read_b64_tr_b16 a[218:219], v3 offset:6144
    v_cvt_pk_bf16_f32 v109, v110, v111
    v_fma_f32 v77, v77, s28, v12
    v_cvt_pk_bf16_f32 v172, v172, v173
    v_mfma_f32_16x16x32_bf16 v[80:83], a[228:231], a[184:187], v[80:83]
    ds_write2st64_b64 v101, v[212:213], v[104:105] offset0:24 offset1:36
    v_mul_f32 v203, v203, v49
    v_mfma_f32_16x16x32_bf16 v[80:83], a[232:235], a[188:191], v[80:83]
    s_waitcnt lgkmcnt(2)
    ds_read_b64_tr_b16 a[220:221], v4 offset:0
    v_exp_f32 v78, v78
    v_mfma_f32_16x16x32_bf16 v[112:115], a[212:215], v[14:17], 0
    ds_write_b64 v101, v[108:109] offset:24576
    v_mfma_f32_16x16x32_bf16 v[160:163], a[212:215], v[20:23], 0
    ds_read_b64_tr_b16 a[222:223], v4 offset:6144
    v_mul_f32 v201, v201, v49
    v_cvt_pk_bf16_f32 v169, v170, v171
    v_mfma_f32_16x16x32_bf16 v[44:47], a[240:243], v[20:23], v[44:47]
    ds_read_b64_tr_b16 a[230:231], v2 offset:7168
    v_xor_b32 v101, 96, v101
    v_accvgpr_read_b32 v107, a11
    v_cvt_pk_bf16_f32 v220, v220, v221
    v_mul_f32 v191, v191, v49
    v_cvt_pk_bf16_f32 v217, v218, v219
    v_accvgpr_read_b32 v110, a58
    v_accvgpr_read_b32 v109, a57
    v_pk_mul_f32 v[240:241], v[240:241], v[50:51] op_sel_hi:[1,0]
    v_accvgpr_read_b32 v111, a59
    v_pk_mul_f32 v[250:251], v[250:251], v[50:51] op_sel_hi:[1,0]
    v_accvgpr_read_b32 v104, a8
    v_pk_mul_f32 v[252:253], v[252:253], v[50:51] op_sel_hi:[1,0]
    v_cvt_pk_bf16_f32 v124, v124, v125
    v_accvgpr_read_b32 v106, a10
    v_accvgpr_read_b32 v105, a9
    v_cvt_pk_bf16_f32 v128, v128, v129
    v_pk_mul_f32 v[232:233], v[232:233], v[50:51] op_sel_hi:[1,0]
    v_fma_f32 v75, v75, s28, v11
    v_mul_f32 v193, v193, v49
    v_exp_f32 v52, v52
    v_mul_f32 v106, v106, v51
    v_mfma_f32_16x16x32_bf16 v[208:211], a[212:215], v[26:29], 0
    ds_read_b64_tr_b16 a[232:233], v3 offset:1024
    v_accvgpr_read_b32 v108, a56
    v_mfma_f32_16x16x32_bf16 a[0:3], a[212:215], v[32:35], 0
    s_waitcnt lgkmcnt(3)
    ds_read_b64_tr_b16 a[224:225], v5 offset:0
    buffer_load_dwordx4 v6, s[4:7], s20 offen lds
    v_mfma_f32_16x16x32_bf16 v[116:119], a[216:219], v[14:17], 0
    s_add_u32 s20, s20, 128
    ds_read_b64_tr_b16 a[214:215], v4 offset:7168
    v_fma_f32 v54, v54, s28, v9
    v_mul_f32 v104, v104, v51
    v_fma_f32 v83, v83, s28, v12
    v_mul_f32 v107, v107, v51
    v_mfma_f32_16x16x32_bf16 v[164:167], a[216:219], v[20:23], 0
    ds_read_b64_tr_b16 a[212:213], v4 offset:1024
    v_mul_f32 v105, v105, v51
    v_mfma_f32_16x16x32_bf16 v[44:47], a[244:247], v[26:29], v[44:47]
    s_add_u32 m0, s22, 13312
    ds_read_b64_tr_b16 a[226:227], v5 offset:6144
    v_cvt_pk_bf16_f32 v104, v104, v105
    v_mfma_f32_16x16x32_bf16 v[44:47], a[248:251], v[32:35], v[44:47]
    ds_write2st64_b64 v101, v[120:121], v[168:169] offset0:0 offset1:12
    v_cvt_pk_bf16_f32 v244, v244, v245
    v_fma_f32 v66, v66, s28, v10
    v_exp_f32 v76, v76
    v_cvt_pk_bf16_f32 v105, v106, v107
    v_pk_mul_f32 v[222:223], v[222:223], v[50:51] op_sel_hi:[1,0]
    v_cvt_pk_bf16_f32 v252, v252, v253
    v_cvt_pk_bf16_f32 v196, v196, v197
    v_mul_f32 v199, v199, v49
    v_accvgpr_read_b32 v107, a15
    v_mfma_f32_16x16x32_bf16 v[212:215], a[216:219], v[26:29], 0
    ds_write2st64_b64 v101, v[216:217], v[104:105] offset0:24 offset1:36
    v_fma_f32 v56, v56, s28, v9
    v_accvgpr_read_b32 v105, a13
    v_cvt_pk_bf16_f32 v125, v126, v127
    v_pk_mul_f32 v[238:239], v[238:239], v[50:51] op_sel_hi:[1,0]
    v_pk_mul_f32 v[148:149], v[148:149], v[48:49] op_sel_hi:[1,0]
    v_pk_mul_f32 v[152:153], v[152:153], v[48:49] op_sel_hi:[1,0]
    v_pk_mul_f32 v[108:109], v[108:109], v[100:101] op_sel_hi:[1,0]
    v_pk_mul_f32 v[110:111], v[110:111], v[100:101] op_sel_hi:[1,0]
    v_cvt_pk_bf16_f32 v221, v222, v223
    v_pk_mul_f32 v[226:227], v[226:227], v[50:51] op_sel_hi:[1,0]
    v_accvgpr_read_b32 v104, a12
    v_exp_f32 v70, v70
    v_exp_f32 v54, v54
    v_pk_mul_f32 v[158:159], v[158:159], v[48:49] op_sel_hi:[1,0]
    v_pk_mul_f32 v[254:255], v[254:255], v[50:51] op_sel_hi:[1,0]
    v_pk_mul_f32 v[242:243], v[242:243], v[50:51] op_sel_hi:[1,0]
    v_cvt_pk_bf16_f32 v197, v198, v199
    v_cvt_pk_bf16_f32 v108, v108, v109
    v_mfma_f32_16x16x32_bf16 a[4:7], a[216:219], v[32:35], 0
    s_waitcnt lgkmcnt(1)
    ds_read_b64_tr_b16 a[228:229], v2 offset:1024
    v_cvt_pk_bf16_f32 v148, v148, v149
    v_cvt_pk_bf16_f32 v109, v110, v111
    v_mfma_f32_16x16x32_bf16 v[120:123], a[220:223], v[14:17], 0
    buffer_load_dwordx4 v6, s[4:7], s20 offen lds
    ds_write_b64 v101, v[108:109] offset:24576
    v_mul_f32 v104, v104, v51
    v_fma_f32 v60, v60, s28, v10
    v_pk_mul_f32 v[228:229], v[228:229], v[50:51] op_sel_hi:[1,0]
    v_mul_f32 v107, v107, v51
    v_accvgpr_read_b32 v106, a14
    v_accvgpr_read_b32 v111, a63
    v_cvt_pk_bf16_f32 v236, v236, v237
    v_fma_f32 v82, v82, s28, v12
    v_cvt_pk_bf16_f32 v224, v224, v225
    v_pk_mul_f32 v[142:143], v[142:143], v[48:49] op_sel_hi:[1,0]
    v_pk_mul_f32 v[130:131], v[130:131], v[48:49] op_sel_hi:[1,0]
    v_pk_mul_f32 v[248:249], v[248:249], v[50:51] op_sel_hi:[1,0]
    v_accvgpr_read_b32 v110, a62
    v_pk_mul_f32 v[136:137], v[136:137], v[48:49] op_sel_hi:[1,0]
    v_cvt_pk_bf16_f32 v185, v186, v187
    v_pk_mul_f32 v[234:235], v[234:235], v[50:51] op_sel_hi:[1,0]
    v_mul_f32 v105, v105, v51
    v_xor_b32 v101, 32, v101
    v_pk_mul_f32 v[110:111], v[110:111], v[100:101] op_sel_hi:[1,0]
    v_cvt_pk_bf16_f32 v173, v174, v175
    v_mul_f32 v106, v106, v51
    v_fma_f32 v73, v73, s28, v11
    v_mfma_f32_16x16x32_bf16 v[168:171], a[220:223], v[20:23], 0
    ds_write2st64_b64 v101, v[124:125], v[172:173] offset0:0 offset1:12
    v_cvt_pk_bf16_f32 v104, v104, v105
    v_mfma_f32_16x16x32_bf16 v[216:219], a[220:223], v[26:29], 0
    ds_read_b128 v[84:87], v8 offset:1024
    v_fma_f32 v74, v74, s28, v11
    v_exp_f32 v74, v74
    v_accvgpr_read_b32 v109, a61
    v_accvgpr_read_b32 v108, a60
    v_mul_f32 v206, v206, v49
    v_cvt_pk_bf16_f32 v240, v240, v241
    v_cvt_pk_bf16_f32 v105, v106, v107
    v_pk_mul_f32 v[140:141], v[140:141], v[48:49] op_sel_hi:[1,0]
    v_cvt_pk_bf16_f32 v189, v190, v191
    v_pk_mul_f32 v[108:109], v[108:109], v[100:101] op_sel_hi:[1,0]
    v_pk_mul_f32 v[154:155], v[154:155], v[48:49] op_sel_hi:[1,0]
    v_cvt_pk_bf16_f32 v129, v130, v131
    v_cvt_pk_bf16_f32 v108, v108, v109
    v_cvt_pk_bf16_f32 v232, v232, v233
    v_mfma_f32_16x16x32_bf16 a[8:11], a[220:223], v[32:35], 0
    ds_read_b128 v[96:99], v8 offset:0
    v_cvt_pk_bf16_f32 v109, v110, v111
    v_mfma_f32_16x16x32_bf16 v[124:127], a[224:227], v[14:17], 0
    ds_write2st64_b64 v101, v[220:221], v[104:105] offset0:24 offset1:36
    ds_read_b64_tr_b16 a[234:235], v3 offset:7168
    v_mfma_f32_16x16x32_bf16 v[172:175], a[224:227], v[20:23], 0
    ds_write_b64 v101, v[108:109] offset:24576
    v_accvgpr_read_b32 v104, a16
    v_accvgpr_read_b32 v107, a19
    v_accvgpr_read_b32 v110, a66
    v_mul_f32 v182, v182, v49
    v_pk_mul_f32 v[134:135], v[134:135], v[48:49] op_sel_hi:[1,0]
    v_exp_f32 v60, v60
    v_pk_mul_f32 v[144:145], v[144:145], v[48:49] op_sel_hi:[1,0]
    v_cvt_pk_bf16_f32 v233, v234, v235
    v_accvgpr_read_b32 v106, a18
    v_accvgpr_read_b32 v111, a67
    v_accvgpr_read_b32 v105, a17
    v_accvgpr_read_b32 v108, a64
    v_exp_f32 v79, v79
    v_accvgpr_read_b32 v109, a65
    v_mul_f32 v104, v104, v51
    v_cvt_pk_bf16_f32 v31, v70, v71
    v_cvt_pk_bf16_f32 v37, v78, v79
    v_cvt_pk_bf16_f32 v253, v254, v255
    v_mul_f32 v105, v105, v51
    v_cvt_pk_bf16_f32 v204, v204, v205
    v_pk_mul_f32 v[108:109], v[108:109], v[100:101] op_sel_hi:[1,0]
    v_cvt_pk_bf16_f32 v205, v206, v207
    v_cvt_pk_bf16_f32 v104, v104, v105
    v_pk_mul_f32 v[110:111], v[110:111], v[100:101] op_sel_hi:[1,0]
    v_xor_b32 v101, 96, v101
    v_mul_f32 v106, v106, v51
    v_exp_f32 v77, v77
    v_cvt_pk_bf16_f32 v108, v108, v109
    v_fma_f32 v53, v53, s28, v9
    v_pk_mul_f32 v[230:231], v[230:231], v[50:51] op_sel_hi:[1,0]
    v_cvt_pk_bf16_f32 v133, v134, v135
    v_cvt_pk_bf16_f32 v200, v200, v201
    v_mul_f32 v107, v107, v51
    v_cvt_pk_bf16_f32 v225, v226, v227
    v_cvt_pk_bf16_f32 v109, v110, v111
    v_mfma_f32_16x16x32_bf16 v[220:223], a[224:227], v[26:29], 0
    s_add_u32 s20, s20, 128
    ds_write2st64_b64 v101, v[128:129], v[176:177] offset0:4 offset1:16
    v_cvt_pk_bf16_f32 v140, v140, v141
    v_accvgpr_read_b32 v110, a70
    v_cvt_pk_bf16_f32 v105, v106, v107
    v_cvt_pk_bf16_f32 v228, v228, v229
    v_accvgpr_read_b32 v111, a71
    v_mfma_f32_16x16x32_bf16 a[12:15], a[224:227], v[32:35], 0
    s_waitcnt lgkmcnt(1)
    ds_write2st64_b64 v101, v[224:225], v[104:105] offset0:28 offset1:40
    v_accvgpr_read_b32 v104, a20
    v_accvgpr_read_b32 v107, a23
    v_mfma_f32_16x16x32_bf16 v[128:131], a[228:231], v[14:17], 0
    s_add_u32 m0, s22, 14336
    ds_write_b64 v101, v[108:109] offset:26624
    v_accvgpr_read_b32 v108, a68
    v_accvgpr_read_b32 v105, a21
    v_mul_f32 v104, v104, v51
    v_accvgpr_read_b32 v109, a69
    v_xor_b32 v101, 32, v101
    v_accvgpr_read_b32 v106, a22
    v_pk_mul_f32 v[108:109], v[108:109], v[100:101] op_sel_hi:[1,0]
    v_mul_f32 v105, v105, v51
    v_cvt_pk_bf16_f32 v136, v136, v137
    v_fma_f32 v64, v64, s28, v10
    v_cvt_pk_bf16_f32 v181, v182, v183
    v_mul_f32 v106, v106, v51
    v_cvt_pk_bf16_f32 v104, v104, v105
    v_pk_mul_f32 v[110:111], v[110:111], v[100:101] op_sel_hi:[1,0]
    v_cvt_pk_bf16_f32 v229, v230, v231
    v_fma_f32 v59, v59, s28, v9
    v_cvt_pk_bf16_f32 v241, v242, v243
    v_mfma_f32_16x16x32_bf16 v[176:179], a[228:231], v[20:23], 0
    ds_write2st64_b64 v101, v[132:133], v[180:181] offset0:4 offset1:16
    v_mul_f32 v107, v107, v51
    v_cvt_pk_bf16_f32 v105, v106, v107
    v_mfma_f32_16x16x32_bf16 v[224:227], a[228:231], v[26:29], 0
    buffer_store_dwordx4 v[96:99], v102, s[16:19], s67 offen offset:0 nt
    ds_write2st64_b64 v101, v[228:229], v[104:105] offset0:28 offset1:40
    v_accvgpr_read_b32 v105, a25
    v_accvgpr_read_b32 v107, a27
    v_cvt_pk_bf16_f32 v108, v108, v109
    v_cvt_pk_bf16_f32 v109, v110, v111
    v_cvt_pk_bf16_f32 v237, v238, v239
    v_mfma_f32_16x16x32_bf16 a[16:19], a[228:231], v[32:35], 0
    ds_read_b64_tr_b16 a[218:219], v5 offset:7168
    ds_write_b64 v101, v[108:109] offset:26624
    v_cvt_pk_bf16_f32 v144, v144, v145
    v_cvt_pk_bf16_f32 v145, v146, v147
    v_accvgpr_read_b32 v108, a72
    v_mul_f32 v105, v105, v51
    v_cvt_pk_bf16_f32 v137, v138, v139
    v_accvgpr_read_b32 v111, a75
    v_accvgpr_read_b32 v106, a26
    v_accvgpr_read_b32 v104, a24
    v_xor_b32 v101, 96, v101
    v_mul_f32 v104, v104, v51
    v_exp_f32 v53, v53
    v_mul_f32 v106, v106, v51
    v_cvt_pk_bf16_f32 v104, v104, v105
    v_accvgpr_read_b32 v109, a73
    v_accvgpr_read_b32 v110, a74
    v_pk_mul_f32 v[110:111], v[110:111], v[100:101] op_sel_hi:[1,0]
    v_mul_f32 v107, v107, v51
    v_pk_mul_f32 v[108:109], v[108:109], v[100:101] op_sel_hi:[1,0]
    v_cvt_pk_bf16_f32 v105, v106, v107
    v_cvt_pk_bf16_f32 v141, v142, v143
    v_mfma_f32_16x16x32_bf16 v[132:135], a[232:235], v[14:17], 0
    ds_write2st64_b64 v101, v[136:137], v[184:185] offset0:4 offset1:16
    ds_read_b64_tr_b16 a[216:217], v5 offset:1024
    buffer_load_dwordx4 v6, s[4:7], s20 offen lds
    ds_read_b128 v[96:99], v8 offset:7168
    ds_write2st64_b64 v101, v[232:233], v[104:105] offset0:28 offset1:40
    v_cvt_pk_bf16_f32 v108, v108, v109
    v_cvt_pk_bf16_f32 v109, v110, v111
    v_accvgpr_read_b32 v105, a29
    v_exp_f32 v69, v69
    v_mfma_f32_16x16x32_bf16 v[180:183], a[232:235], v[20:23], 0
    ds_write_b64 v101, v[108:109] offset:26624
    v_accvgpr_read_b32 v104, a28
    v_accvgpr_read_b32 v110, a78
    v_accvgpr_read_b32 v108, a76
    v_accvgpr_read_b32 v107, a31
    v_accvgpr_read_b32 v106, a30
    v_xor_b32 v101, 32, v101
    v_cvt_pk_bf16_f32 v192, v192, v193
    v_cvt_pk_bf16_f32 v248, v248, v249
    v_mfma_f32_16x16x32_bf16 v[228:231], a[232:235], v[26:29], 0
    s_add_u32 s20, s20, 12032
    ds_read_b128 v[88:91], v8 offset:6144
    v_mul_f32 v104, v104, v51
    v_mfma_f32_16x16x32_bf16 a[20:23], a[232:235], v[32:35], 0
    ds_read_b64_tr_b16 a[228:229], v4 offset:2048
    ds_read_b64_tr_b16 a[224:225], v3 offset:2048
    ds_read_b64_tr_b16 a[230:231], v4 offset:8192
    v_accvgpr_read_b32 v109, a77
    v_mul_f32 v107, v107, v51
    v_pk_mul_f32 v[108:109], v[108:109], v[100:101] op_sel_hi:[1,0]
    v_mul_f32 v105, v105, v51
    v_pk_mul_f32 v[150:151], v[150:151], v[48:49] op_sel_hi:[1,0]
    v_accvgpr_read_b32 v111, a79
    v_mul_f32 v106, v106, v51
    v_fma_f32 v62, v62, s28, v10
    v_cvt_pk_bf16_f32 v152, v152, v153
    v_fma_f32 v58, v58, s28, v9
    v_cvt_pk_bf16_f32 v104, v104, v105
    v_cvt_pk_bf16_f32 v108, v108, v109
    v_pk_mul_f32 v[110:111], v[110:111], v[100:101] op_sel_hi:[1,0]
    v_exp_f32 v68, v68
    v_fma_f32 v67, v67, s28, v10
    v_cvt_pk_bf16_f32 v245, v246, v247
    v_cvt_pk_bf16_f32 v105, v106, v107
    v_accvgpr_read_b32 v107, a35
    v_cvt_pk_bf16_f32 v109, v110, v111
    v_mfma_f32_16x16x32_bf16 v[136:139], a[212:215], v[14:17], 0
    s_add_u32 s56, s67, 6144
    ds_write2st64_b64 v101, v[140:141], v[188:189] offset0:4 offset1:16
    v_mfma_f32_16x16x32_bf16 v[184:187], a[212:215], v[20:23], 0
    buffer_store_dwordx4 v[84:87], v103, s[16:19], s67 offen offset:0 nt
    s_add_u32 s58, s33, 6144
    s_add_u32 m0, s38, 6144
    ds_read_b64_tr_b16 a[222:223], v2 offset:8192
    ds_write2st64_b64 v101, v[236:237], v[104:105] offset0:28 offset1:40
    v_mul_f32 v107, v107, v51
    v_mfma_f32_16x16x32_bf16 v[232:235], a[212:215], v[26:29], 0
    ds_write_b64 v101, v[108:109] offset:26624
    v_mfma_f32_16x16x32_bf16 a[24:27], a[212:215], v[32:35], 0
    s_waitcnt lgkmcnt(4)
    ds_read_b64_tr_b16 a[220:221], v2 offset:2048
    buffer_load_dwordx4 v6, s[12:15], s58 offen nt lds
    ds_read_b64_tr_b16 a[232:233], v5 offset:2048
    v_accvgpr_read_b32 v108, a80
    v_exp_f32 v75, v75
    v_accvgpr_read_b32 v109, a81
    v_xor_b32 v101, 96, v101
    v_mfma_f32_16x16x32_bf16 v[140:143], a[216:219], v[14:17], 0
    s_add_u32 m0, s38, 7168
    ds_read_b64_tr_b16 a[234:235], v5 offset:8192
    ds_read_b64_tr_b16 a[226:227], v3 offset:8192
    v_accvgpr_read_b32 v104, a32
    v_exp_f32 v56, v56
    v_mul_f32 v104, v104, v51
    v_accvgpr_read_b32 v106, a34
    v_accvgpr_read_b32 v110, a82
    v_cvt_pk_bf16_f32 v193, v194, v195
    v_accvgpr_read_b32 v111, a83
    v_mfma_f32_16x16x32_bf16 v[188:191], a[216:219], v[20:23], 0
    buffer_load_dwordx4 v7, s[12:15], s58 offen nt lds
    ds_write2st64_b64 v101, v[144:145], v[192:193] offset0:8 offset1:20
    v_accvgpr_read_b32 v105, a33
    v_mul_f32 v106, v106, v51
    v_mul_f32 v105, v105, v51
    v_pk_mul_f32 v[108:109], v[108:109], v[100:101] op_sel_hi:[1,0]
    v_pk_mul_f32 v[110:111], v[110:111], v[100:101] op_sel_hi:[1,0]
    v_exp_f32 v62, v62
    v_cvt_pk_bf16_f32 v104, v104, v105
    v_cvt_pk_bf16_f32 v108, v108, v109
    v_cvt_pk_bf16_f32 v105, v106, v107
    v_cvt_pk_bf16_f32 v109, v110, v111
    v_cvt_pk_bf16_f32 v18, v52, v53
    v_cvt_pk_bf16_f32 v249, v250, v251
    v_accvgpr_read_b32 v111, a87
    v_mfma_f32_16x16x32_bf16 v[236:239], a[216:219], v[26:29], 0
    buffer_store_dwordx4 v[88:91], v102, s[16:19], s56 offen offset:0 nt
    s_add_u32 s39, s39, 12288
    ds_write2st64_b64 v101, v[240:241], v[104:105] offset0:32 offset1:44
    v_mfma_f32_16x16x32_bf16 a[28:31], a[216:219], v[32:35], 0
    s_waitcnt vmcnt(11) lgkmcnt(2)
    ds_write_b64 v101, v[108:109] offset:0
    v_cvt_pk_bf16_f32 v201, v202, v203
    v_mfma_f32_16x16x32_bf16 v[144:147], a[220:223], v[14:17], 0
    buffer_store_dwordx4 v[96:99], v103, s[16:19], s56 offen offset:0 nt
    s_barrier
    ds_read_b128 v[84:87], v8 offset:2048
    v_cvt_pk_bf16_f32 v19, v54, v55
    v_accvgpr_read_b32 v105, a37
    v_accvgpr_read_b32 v107, a39
    v_accvgpr_read_b32 v104, a36
    v_pk_mul_f32 v[156:157], v[156:157], v[48:49] op_sel_hi:[1,0]
    v_exp_f32 v82, v82
    v_mul_f32 v104, v104, v51
    v_exp_f32 v61, v61
    v_accvgpr_read_b32 v108, a84
    v_cvt_pk_bf16_f32 v30, v68, v69
    v_cvt_pk_bf16_f32 v149, v150, v151
    v_accvgpr_read_b32 v110, a86
    v_accvgpr_read_b32 v109, a85
    v_pk_mul_f32 v[108:109], v[108:109], v[100:101] op_sel_hi:[1,0]
    v_mul_f32 v105, v105, v51
    v_xor_b32 v101, 32, v101
    v_mul_f32 v107, v107, v51
    v_cvt_pk_bf16_f32 v104, v104, v105
    v_pk_mul_f32 v[110:111], v[110:111], v[100:101] op_sel_hi:[1,0]
    v_cvt_pk_bf16_f32 v153, v154, v155
    v_accvgpr_read_b32 v106, a38
    v_cvt_pk_bf16_f32 v156, v156, v157
    v_mul_f32 v106, v106, v51
    v_mfma_f32_16x16x32_bf16 v[192:195], a[220:223], v[20:23], 0
    ds_write2st64_b64 v101, v[148:149], v[196:197] offset0:8 offset1:20
    v_cvt_pk_bf16_f32 v105, v106, v107
    v_exp_f32 v63, v63
    v_cvt_pk_bf16_f32 v108, v108, v109
    v_cvt_pk_bf16_f32 v109, v110, v111
    v_accvgpr_read_b32 v107, a43
    v_accvgpr_read_b32 v106, a42
    v_cvt_pk_bf16_f32 v24, v60, v61
    v_mul_f32 v107, v107, v51
    v_mfma_f32_16x16x32_bf16 v[240:243], a[220:223], v[26:29], 0
    s_add_u32 m0, s22, 24576
    ds_write2st64_b64 v101, v[244:245], v[104:105] offset0:32 offset1:44
    v_accvgpr_read_b32 v105, a41
    v_mfma_f32_16x16x32_bf16 a[32:35], a[220:223], v[32:35], 0
    ds_write_b64 v101, v[108:109] offset:0
    v_accvgpr_read_b32 v104, a40
    v_fma_f32 v81, v81, s28, v12
    v_fma_f32 v65, v65, s28, v10
    v_mul_f32 v105, v105, v51
    v_mul_f32 v104, v104, v51
    v_cvt_pk_bf16_f32 v104, v104, v105
    v_fma_f32 v80, v80, s28, v12
    v_accvgpr_read_b32 v111, a91
    v_mul_f32 v106, v106, v51
    v_accvgpr_read_b32 v109, a89
    v_mfma_f32_16x16x32_bf16 v[148:151], a[224:227], v[14:17], 0
    buffer_load_dwordx4 v6, s[8:11], s21 offen lds
    ds_read_b128 a[220:223], v0 offset:1024
    v_xor_b32 v101, 96, v101
    v_cvt_pk_bf16_f32 v105, v106, v107
    v_accvgpr_read_b32 v107, a47
    v_mfma_f32_16x16x32_bf16 v[196:199], a[224:227], v[20:23], 0
    s_add_u32 s21, s21, 128
    ds_read_b128 a[216:219], v1 offset:0
    v_cvt_pk_bf16_f32 v157, v158, v159
    v_accvgpr_read_b32 v108, a88
    v_mfma_f32_16x16x32_bf16 v[244:247], a[224:227], v[26:29], 0
    ds_write2st64_b64 v101, v[152:153], v[200:201] offset0:8 offset1:20
    v_accvgpr_read_b32 v110, a90
    v_mfma_f32_16x16x32_bf16 a[36:39], a[224:227], v[32:35], 0
    s_add_u32 m0, s22, 25600
    ds_read_b128 v[88:91], v8 offset:3072
    buffer_load_dwordx4 v6, s[8:11], s21 offen lds
    v_mfma_f32_16x16x32_bf16 v[152:155], a[228:231], v[14:17], 0
    ds_write2st64_b64 v101, v[248:249], v[104:105] offset0:32 offset1:44
    v_pk_mul_f32 v[108:109], v[108:109], v[100:101] op_sel_hi:[1,0]
    v_mul_f32 v107, v107, v51
    v_pk_mul_f32 v[110:111], v[110:111], v[100:101] op_sel_hi:[1,0]
    v_cvt_pk_bf16_f32 v25, v62, v63
    v_exp_f32 v58, v58
    v_mfma_f32_16x16x32_bf16 v[200:203], a[228:231], v[20:23], 0
    ds_read_b128 a[212:215], v0 offset:0
    v_accvgpr_read_b32 v105, a45
    v_accvgpr_read_b32 v106, a46
    v_mul_f32 v105, v105, v51
    v_cvt_pk_bf16_f32 v108, v108, v109
    v_accvgpr_read_b32 v104, a44
    v_mul_f32 v104, v104, v51
    v_cvt_pk_bf16_f32 v109, v110, v111
    v_mfma_f32_16x16x32_bf16 v[248:251], a[228:231], v[26:29], 0
    s_add_u32 s21, s21, 128
    ds_write_b64 v101, v[108:109] offset:0
    v_xor_b32 v101, 32, v101
    v_mfma_f32_16x16x32_bf16 a[40:43], a[228:231], v[32:35], 0
    ds_write2st64_b64 v101, v[156:157], v[204:205] offset0:8 offset1:20
    v_mul_f32 v106, v106, v51
    v_mfma_f32_16x16x32_bf16 v[156:159], a[232:235], v[14:17], 0
    v_cvt_pk_bf16_f32 v104, v104, v105
    v_cvt_pk_bf16_f32 v105, v106, v107
    v_mfma_f32_16x16x32_bf16 v[204:207], a[232:235], v[20:23], 0
    s_add_u32 m0, s22, 26624
    ds_write2st64_b64 v101, v[252:253], v[104:105] offset0:32 offset1:44
    v_mfma_f32_16x16x32_bf16 v[252:255], a[232:235], v[26:29], 0
    buffer_load_dwordx4 v6, s[8:11], s21 offen lds
    v_mfma_f32_16x16x32_bf16 a[44:47], a[232:235], v[32:35], 0
    s_waitcnt lgkmcnt(3)
    ds_read_b128 a[224:227], v1 offset:1024
    v_accvgpr_read_b32 v109, a93
    v_mfma_f32_16x16x32_bf16 v[52:55], a[212:215], a[96:99], 0
    s_add_u32 s21, s21, 12032
    v_accvgpr_read_b32 v110, a94
    v_exp_f32 v83, v83
    v_mfma_f32_16x16x32_bf16 v[52:55], a[216:219], a[100:103], v[52:55]
    v_exp_f32 v59, v59
    v_mfma_f32_16x16x32_bf16 v[52:55], a[220:223], a[104:107], v[52:55]
    s_add_u32 s56, s67, 128
    ds_read_b128 a[228:231], v0 offset:2048
    v_exp_f32 v65, v65
    v_mfma_f32_16x16x32_bf16 v[60:63], a[212:215], a[120:123], 0
    s_add_u32 s58, s33, 128
    v_exp_f32 v57, v57
    v_mfma_f32_16x16x32_bf16 v[60:63], a[216:219], a[124:127], v[60:63]
    s_add_u32 m0, s38, 2048
    ds_read_b128 v[96:99], v8 offset:8192
    v_accvgpr_read_b32 v111, a95
    v_mfma_f32_16x16x32_bf16 v[60:63], a[220:223], a[128:131], v[60:63]
    v_cvt_pk_bf16_f32 v36, v76, v77
    v_cvt_pk_bf16_f32 v17, v58, v59
    v_mfma_f32_16x16x32_bf16 v[68:71], a[212:215], a[144:147], 0
    ds_read_b128 a[232:235], v1 offset:2048
    v_exp_f32 v67, v67
    v_mfma_f32_16x16x32_bf16 v[68:71], a[216:219], a[148:151], v[68:71]
    buffer_load_dwordx4 v6, s[12:15], s58 offen nt lds
    v_mfma_f32_16x16x32_bf16 v[68:71], a[220:223], a[152:155], v[68:71]
    buffer_store_dwordx4 v[84:87], v102, s[16:19], s56 offen offset:0 nt
    v_fma_f32 v72, v72, s28, v11
    v_exp_f32 v72, v72
    v_mfma_f32_16x16x32_bf16 v[76:79], a[212:215], a[168:171], 0
    s_add_u32 m0, s38, 3072
    ds_read_b128 v[84:87], v8 offset:9216
    v_accvgpr_read_b32 v108, a92
    v_mfma_f32_16x16x32_bf16 v[76:79], a[216:219], a[172:175], v[76:79]
    buffer_load_dwordx4 v7, s[12:15], s58 offen nt lds
    v_mfma_f32_16x16x32_bf16 v[76:79], a[220:223], a[176:179], v[76:79]
    s_waitcnt lgkmcnt(3)
    v_exp_f32 v80, v80
    v_mfma_f32_16x16x32_bf16 v[52:55], a[224:227], a[108:111], v[52:55]
    buffer_store_dwordx4 v[88:91], v103, s[16:19], s56 offen offset:0 nt
    s_add_u32 s57, s67, 6272
    s_add_u32 s59, s33, 6272
    ds_read_b128 v[88:91], v8 offset:4096
    v_pk_mul_f32 v[110:111], v[110:111], v[100:101] op_sel_hi:[1,0]
    v_pk_mul_f32 v[108:109], v[108:109], v[100:101] op_sel_hi:[1,0]
    s_add_u32 m0, s38, 8192
    v_cvt_pk_bf16_f32 v16, v56, v57
    v_mfma_f32_16x16x32_bf16 v[52:55], a[228:231], a[112:115], v[52:55]
    s_waitcnt lgkmcnt(2)
    ds_read_b128 a[220:223], v0 offset:7168
    v_cvt_pk_bf16_f32 v35, v82, v83
    v_mfma_f32_16x16x32_bf16 v[52:55], a[232:235], a[116:119], v[52:55]
    ds_read_b128 a[212:215], v0 offset:6144
    buffer_load_dwordx4 v6, s[12:15], s59 offen nt lds
    v_mfma_f32_16x16x32_bf16 v[60:63], a[224:227], a[132:135], v[60:63]
    v_exp_f32 v66, v66
    v_mfma_f32_16x16x32_bf16 v[48:51], a[236:239], v[16:19], v[44:47]
    s_add_u32 m0, s38, 9216
    v_cvt_pk_bf16_f32 v23, v66, v67
    v_exp_f32 v64, v64
    v_mfma_f32_16x16x32_bf16 v[60:63], a[228:231], a[136:139], v[60:63]
    buffer_store_dwordx4 v[96:99], v102, s[16:19], s57 offen offset:0 nt
    v_exp_f32 v73, v73
    v_cvt_pk_bf16_f32 v22, v64, v65
    v_mfma_f32_16x16x32_bf16 v[60:63], a[232:235], a[140:143], v[60:63]
    ds_read_b128 v[96:99], v8 offset:5120
    v_cvt_pk_bf16_f32 v108, v108, v109
    v_cvt_pk_bf16_f32 v109, v110, v111
    v_mfma_f32_16x16x32_bf16 v[68:71], a[224:227], a[156:159], v[68:71]
    s_waitcnt lgkmcnt(3)
    ds_read_b128 a[216:219], v1 offset:6144
    buffer_load_dwordx4 v7, s[12:15], s59 offen nt lds
    v_mfma_f32_16x16x32_bf16 v[68:71], a[228:231], a[160:163], v[68:71]
    buffer_store_dwordx4 v[84:87], v103, s[16:19], s57 offen offset:0 nt
    s_add_u32 s56, s67, 256
    ds_write_b64 v101, v[108:109] offset:0
    v_mfma_f32_16x16x32_bf16 v[68:71], a[232:235], a[164:167], v[68:71]
    s_add_u32 s58, s33, 256
    s_add_u32 m0, s38, 4096
    ds_read_b128 v[84:87], v8 offset:0
    v_mfma_f32_16x16x32_bf16 v[76:79], a[224:227], a[180:183], v[76:79]
    ds_read_b128 a[224:227], v1 offset:7168
    v_cvt_pk_bf16_f32 v29, v74, v75
    v_mfma_f32_16x16x32_bf16 v[76:79], a[228:231], a[184:187], v[76:79]
    buffer_load_dwordx4 v6, s[12:15], s58 offen nt lds
    v_mfma_f32_16x16x32_bf16 v[48:51], a[240:243], v[22:25], v[48:51]
    buffer_store_dwordx4 v[88:91], v102, s[16:19], s56 offen offset:0 nt
    v_exp_f32 v81, v81
    v_cvt_pk_bf16_f32 v28, v72, v73
    v_mfma_f32_16x16x32_bf16 v[76:79], a[232:235], a[188:191], v[76:79]
    v_cvt_pk_bf16_f32 v34, v80, v81
    v_mfma_f32_16x16x32_bf16 v[48:51], a[244:247], v[28:31], v[48:51]
    ds_read_b128 v[88:91], v8 offset:1024
    s_add_u32 m0, s38, 5120
    v_mfma_f32_16x16x32_bf16 v[48:51], a[248:251], v[34:37], v[48:51]
    s_waitcnt lgkmcnt(4)
    ds_read_b128 a[228:231], v0 offset:8192
    v_mfma_f32_16x16x32_bf16 v[56:59], a[212:215], a[96:99], 0
    ds_read_b128 a[232:235], v1 offset:8192
    v_add_u32 v8, 10240, v8
    v_mfma_f32_16x16x32_bf16 v[56:59], a[216:219], a[100:103], v[56:59]
    buffer_load_dwordx4 v7, s[12:15], s58 offen nt lds
    v_mfma_f32_16x16x32_bf16 v[56:59], a[220:223], a[104:107], v[56:59]
    s_add_u32 s57, s67, 24832
    s_add_u32 m0, s38, 0
    v_cmp_lt_f32 vcc, s29, v48
    v_mfma_f32_16x16x32_bf16 v[64:67], a[212:215], a[120:123], 0
    s_waitcnt lgkmcnt(3)
    buffer_load_dwordx4 v6, s[12:15], s33 offen nt lds
    v_mfma_f32_16x16x32_bf16 v[64:67], a[216:219], a[124:127], v[64:67]
    s_add_u32 m0, s38, 1024
    s_cbranch_vccnz L_rs_tr54d
L_ret_tr54d:
    v_mfma_f32_16x16x32_bf16 v[64:67], a[220:223], a[128:131], v[64:67]
    buffer_store_dwordx4 v[96:99], v103, s[16:19], s56 offen offset:0 nt
    v_fma_f32 v54, v54, s28, v9
    v_fma_f32 v55, v55, s28, v9
    v_fma_f32 v52, v52, s28, v9
    v_mfma_f32_16x16x32_bf16 v[72:75], a[212:215], a[144:147], 0
    v_exp_f32 v54, v54
    v_mfma_f32_16x16x32_bf16 v[72:75], a[216:219], a[148:151], v[72:75]
    v_fma_f32 v61, v61, s28, v10
    v_fma_f32 v60, v60, s28, v10
    v_mfma_f32_16x16x32_bf16 v[72:75], a[220:223], a[152:155], v[72:75]
    v_exp_f32 v60, v60
    v_mfma_f32_16x16x32_bf16 v[80:83], a[212:215], a[168:171], 0
    s_waitcnt lgkmcnt(0)
    buffer_load_dwordx4 v7, s[12:15], s33 offen nt lds
    v_mfma_f32_16x16x32_bf16 v[80:83], a[216:219], a[172:175], v[80:83]
    s_waitcnt vmcnt(26)
    v_exp_f32 v52, v52
    v_mfma_f32_16x16x32_bf16 v[80:83], a[220:223], a[176:179], v[80:83]
    v_exp_f32 v61, v61
    v_mfma_f32_16x16x32_bf16 v[56:59], a[224:227], a[108:111], v[56:59]
    buffer_store_dwordx4 v[84:87], v102, s[16:19], s57 offen offset:0 nt
    s_barrier
    v_exp_f32 v55, v55
    v_mfma_f32_16x16x32_bf16 v[56:59], a[228:231], a[112:115], v[56:59]
    s_add_u32 m0, s22, 0
    ds_read_b64_tr_b16 a[212:213], v2 offset:18432
    v_fma_f32 v53, v53, s28, v9
    v_mfma_f32_16x16x32_bf16 v[56:59], a[232:235], a[116:119], v[56:59]
    ds_read_b64_tr_b16 a[214:215], v2 offset:12288
    v_cvt_pk_bf16_f32 v20, v60, v61
    v_mfma_f32_16x16x32_bf16 v[64:67], a[224:227], a[132:135], v[64:67]
    buffer_load_dwordx4 v6, s[4:7], s20 offen lds
    v_mfma_f32_16x16x32_bf16 v[64:67], a[228:231], a[136:139], v[64:67]
    ds_read_b64_tr_b16 a[216:217], v3 offset:18432
    v_mfma_f32_16x16x32_bf16 v[64:67], a[232:235], a[140:143], v[64:67]
    buffer_store_dwordx4 v[88:91], v103, s[16:19], s57 offen offset:0 nt
    s_add_u32 s20, s20, 128
    ds_read_b64_tr_b16 a[218:219], v3 offset:12288
    v_exp_f32 v53, v53
    v_mfma_f32_16x16x32_bf16 v[72:75], a[224:227], a[156:159], v[72:75]
    s_add_u32 m0, s22, 1024
    ds_read_b64_tr_b16 a[220:221], v4 offset:18432
    v_mfma_f32_16x16x32_bf16 v[72:75], a[228:231], a[160:163], v[72:75]
    ds_read_b64_tr_b16 a[222:223], v4 offset:12288
    v_cvt_pk_bf16_f32 v15, v54, v55
    v_mfma_f32_16x16x32_bf16 v[72:75], a[232:235], a[164:167], v[72:75]
    buffer_load_dwordx4 v6, s[4:7], s20 offen lds
    v_mfma_f32_16x16x32_bf16 v[80:83], a[224:227], a[180:183], v[80:83]
    s_add_u32 s20, s20, 128
    ds_read_b64_tr_b16 a[224:225], v5 offset:18432
    s_add_u32 m0, s22, 2048
    v_mfma_f32_16x16x32_bf16 v[80:83], a[228:231], a[184:187], v[80:83]
    buffer_load_dwordx4 v6, s[4:7], s20 offen lds
    v_mfma_f32_16x16x32_bf16 v[80:83], a[232:235], a[188:191], v[80:83]
    s_add_u32 s20, s20, 12032
    ds_read_b64_tr_b16 a[226:227], v5 offset:12288
    v_cvt_pk_bf16_f32 v14, v52, v53
    s_branch L_loop4
L_tr55:
    s_waitcnt lgkmcnt(6)
    v_mfma_f32_16x16x32_bf16 v[112:115], a[212:215], v[16:19], v[112:115]
    ds_read_b64_tr_b16 a[234:235], v3 offset:13312
    v_mbcnt_lo_u32_b32 v97, -1, 0
    v_mfma_f32_16x16x32_bf16 v[160:163], a[212:215], v[22:25], v[160:163]
    v_fma_f32 v64, v64, s28, v10
    v_fma_f32 v77, v77, s28, v12
    v_mfma_f32_16x16x32_bf16 v[208:211], a[212:215], v[28:31], v[208:211]
    ds_read_b64_tr_b16 a[232:233], v3 offset:19456
    v_fma_f32 v59, v59, s28, v9
    v_mfma_f32_16x16x32_bf16 a[0:3], a[212:215], v[34:37], a[0:3]
    s_add_u32 s39, s39, 12288
    v_fma_f32 v86, v86, s28, v13
    s_add_u32 s48, s33, 24576
    v_mfma_f32_16x16x32_bf16 a[48:51], a[212:215], v[40:43], a[48:51]
    ds_read_b64_tr_b16 a[230:231], v2 offset:13312
    s_waitcnt lgkmcnt(7)
    v_mfma_f32_16x16x32_bf16 v[116:119], a[216:219], v[16:19], v[116:119]
    ds_read_b64_tr_b16 a[214:215], v4 offset:13312
    v_mfma_f32_16x16x32_bf16 v[164:167], a[216:219], v[22:25], v[164:167]
    v_mbcnt_hi_u32_b32 v97, -1, v97
    v_and_b32 v96, 15, v97
    v_mfma_f32_16x16x32_bf16 v[212:215], a[216:219], v[28:31], v[212:215]
    v_fma_f32 v58, v58, s28, v9
    v_mul_u32_u24 v96, 384, v96
    v_mfma_f32_16x16x32_bf16 a[4:7], a[216:219], v[34:37], a[4:7]
    v_exp_f32 v77, v77
    v_mfma_f32_16x16x32_bf16 a[52:55], a[216:219], v[40:43], a[52:55]
    s_waitcnt lgkmcnt(4)
    ds_read_b64_tr_b16 a[228:229], v2 offset:19456
    v_lshrrev_b32 v97, 4, v97
    v_mfma_f32_16x16x32_bf16 v[120:123], a[220:223], v[16:19], v[120:123]
    v_fma_f32 v84, v84, s28, v13
    v_lshl_add_u32 v96, v97, 4, v96
    v_mfma_f32_16x16x32_bf16 v[168:171], a[220:223], v[22:25], v[168:171]
    buffer_load_dword v97, v96, s[12:15], s48 offen offset:256
    v_mfma_f32_16x16x32_bf16 v[216:219], a[220:223], v[28:31], v[216:219]
    ds_read_b64_tr_b16 a[218:219], v5 offset:13312
    v_fma_f32 v72, v72, s28, v11
    v_mfma_f32_16x16x32_bf16 a[8:11], a[220:223], v[34:37], a[8:11]
    v_fma_f32 v57, v57, s28, v9
    v_fma_f32 v78, v78, s28, v12
    v_mfma_f32_16x16x32_bf16 a[56:59], a[220:223], v[40:43], a[56:59]
    ds_read_b64_tr_b16 a[212:213], v4 offset:19456
    v_fma_f32 v67, v67, s28, v10
    v_mfma_f32_16x16x32_bf16 v[124:127], a[224:227], v[16:19], v[124:127]
    ds_read_b64_tr_b16 a[222:223], v2 offset:14336
    v_mfma_f32_16x16x32_bf16 v[172:175], a[224:227], v[22:25], v[172:175]
    v_exp_f32 v57, v57
    v_mfma_f32_16x16x32_bf16 v[220:223], a[224:227], v[28:31], v[220:223]
    v_fma_f32 v91, v91, s28, v13
    v_fma_f32 v85, v85, s28, v13
    v_mfma_f32_16x16x32_bf16 a[12:15], a[224:227], v[34:37], a[12:15]
    v_fma_f32 v56, v56, s28, v9
    v_mfma_f32_16x16x32_bf16 a[60:63], a[224:227], v[40:43], a[60:63]
    s_waitcnt lgkmcnt(3)
    ds_read_b64_tr_b16 a[216:217], v5 offset:19456
    v_fma_f32 v75, v75, s28, v11
    v_mfma_f32_16x16x32_bf16 v[128:131], a[228:231], v[16:19], v[128:131]
    v_fma_f32 v79, v79, s28, v12
    v_fma_f32 v69, v69, s28, v11
    v_mfma_f32_16x16x32_bf16 v[176:179], a[228:231], v[22:25], v[176:179]
    ds_read_b64_tr_b16 a[224:225], v3 offset:20480
    v_mfma_f32_16x16x32_bf16 v[224:227], a[228:231], v[28:31], v[224:227]
    ds_read_b64_tr_b16 a[220:221], v2 offset:20480
    v_fma_f32 v87, v87, s28, v13
    v_mfma_f32_16x16x32_bf16 a[16:19], a[228:231], v[34:37], a[16:19]
    v_fma_f32 v76, v76, s28, v12
    v_fma_f32 v70, v70, s28, v11
    v_mfma_f32_16x16x32_bf16 a[64:67], a[228:231], v[40:43], a[64:67]
    v_exp_f32 v86, v86
    v_mfma_f32_16x16x32_bf16 v[132:135], a[232:235], v[16:19], v[132:135]
    v_exp_f32 v85, v85
    v_mfma_f32_16x16x32_bf16 v[180:183], a[232:235], v[22:25], v[180:183]
    ds_read_b64_tr_b16 a[228:229], v4 offset:20480
    v_fma_f32 v88, v88, s28, v13
    v_mfma_f32_16x16x32_bf16 v[228:231], a[232:235], v[28:31], v[228:231]
    ds_read_b64_tr_b16 a[230:231], v4 offset:14336
    v_fma_f32 v65, v65, s28, v10
    v_mfma_f32_16x16x32_bf16 a[20:23], a[232:235], v[34:37], a[20:23]
    ds_read_b64_tr_b16 a[226:227], v3 offset:14336
    v_fma_f32 v73, v73, s28, v11
    v_mfma_f32_16x16x32_bf16 a[68:71], a[232:235], v[40:43], a[68:71]
    s_waitcnt lgkmcnt(5)
    ds_read_b64_tr_b16 a[234:235], v5 offset:14336
    v_mfma_f32_16x16x32_bf16 v[136:139], a[212:215], v[16:19], v[136:139]
    v_exp_f32 v69, v69
    v_mfma_f32_16x16x32_bf16 v[184:187], a[212:215], v[22:25], v[184:187]
    ds_read_b64_tr_b16 a[232:233], v5 offset:20480
    v_fma_f32 v71, v71, s28, v11
    v_mfma_f32_16x16x32_bf16 v[232:235], a[212:215], v[28:31], v[232:235]
    v_exp_f32 v71, v71
    v_mfma_f32_16x16x32_bf16 a[24:27], a[212:215], v[34:37], a[24:27]
    v_exp_f32 v91, v91
    v_mfma_f32_16x16x32_bf16 a[72:75], a[212:215], v[40:43], a[72:75]
    v_fma_f32 v82, v82, s28, v12
    v_fma_f32 v66, v66, s28, v10
    v_mfma_f32_16x16x32_bf16 v[140:143], a[216:219], v[16:19], v[140:143]
    v_fma_f32 v74, v74, s28, v11
    v_fma_f32 v68, v68, s28, v11
    v_mfma_f32_16x16x32_bf16 v[188:191], a[216:219], v[22:25], v[188:191]
    v_exp_f32 v78, v78
    v_mfma_f32_16x16x32_bf16 v[236:239], a[216:219], v[28:31], v[236:239]
    v_exp_f32 v76, v76
    v_mfma_f32_16x16x32_bf16 a[28:31], a[216:219], v[34:37], a[28:31]
    v_exp_f32 v87, v87
    v_mfma_f32_16x16x32_bf16 a[76:79], a[216:219], v[40:43], a[76:79]
    s_waitcnt lgkmcnt(1)
    v_exp_f32 v68, v68
    v_mfma_f32_16x16x32_bf16 v[144:147], a[220:223], v[16:19], v[144:147]
    v_fma_f32 v89, v89, s28, v13
    v_fma_f32 v90, v90, s28, v13
    v_mfma_f32_16x16x32_bf16 v[192:195], a[220:223], v[22:25], v[192:195]
    s_waitcnt vmcnt(11) lgkmcnt(0)
    v_exp_f32 v74, v74
    v_mfma_f32_16x16x32_bf16 v[240:243], a[220:223], v[28:31], v[240:243]
    s_add_u32 m0, s22, 36864
    v_exp_f32 v70, v70
    v_mfma_f32_16x16x32_bf16 a[32:35], a[220:223], v[34:37], a[32:35]
    s_barrier
    v_mfma_f32_16x16x32_bf16 a[80:83], a[220:223], v[40:43], a[80:83]
    v_fma_f32 v83, v83, s28, v12
    v_fma_f32 v81, v81, s28, v12
    v_mfma_f32_16x16x32_bf16 v[148:151], a[224:227], v[16:19], v[148:151]
    buffer_load_dwordx4 v6, s[8:11], s21 offen lds
    v_mfma_f32_16x16x32_bf16 v[196:199], a[224:227], v[22:25], v[196:199]
    v_exp_f32 v84, v84
    v_mfma_f32_16x16x32_bf16 v[244:247], a[224:227], v[28:31], v[244:247]
    s_add_u32 s21, s21, 128
    v_exp_f32 v79, v79
    v_mfma_f32_16x16x32_bf16 a[36:39], a[224:227], v[34:37], a[36:39]
    ds_read_b128 a[212:215], v0 offset:12288
    v_mfma_f32_16x16x32_bf16 a[84:87], a[224:227], v[40:43], a[84:87]
    s_add_u32 m0, s22, 37888
    v_cvt_pk_bf16_f32 v26, v68, v69
    v_mfma_f32_16x16x32_bf16 v[152:155], a[228:231], v[16:19], v[152:155]
    buffer_load_dwordx4 v6, s[8:11], s21 offen lds
    v_mfma_f32_16x16x32_bf16 v[200:203], a[228:231], v[22:25], v[200:203]
    s_add_u32 s21, s21, 128
    s_add_u32 m0, s22, 38912
    ds_read_b128 a[216:219], v1 offset:12288
    v_mfma_f32_16x16x32_bf16 v[248:251], a[228:231], v[28:31], v[248:251]
    buffer_load_dwordx4 v6, s[8:11], s21 offen lds
    v_mfma_f32_16x16x32_bf16 a[40:43], a[228:231], v[34:37], a[40:43]
    v_exp_f32 v56, v56
    v_mfma_f32_16x16x32_bf16 a[88:91], a[228:231], v[40:43], a[88:91]
    v_exp_f32 v58, v58
    v_mfma_f32_16x16x32_bf16 v[156:159], a[232:235], v[16:19], v[156:159]
    v_cvt_pk_bf16_f32 v16, v56, v57
    v_mfma_f32_16x16x32_bf16 v[204:207], a[232:235], v[22:25], v[204:207]
    ds_read_b128 a[220:223], v0 offset:13312
    v_mfma_f32_16x16x32_bf16 v[252:255], a[232:235], v[28:31], v[252:255]
    v_exp_f32 v64, v64
    v_mfma_f32_16x16x32_bf16 a[44:47], a[232:235], v[34:37], a[44:47]
    v_exp_f32 v82, v82
    v_mfma_f32_16x16x32_bf16 a[92:95], a[232:235], v[40:43], a[92:95]
    s_waitcnt lgkmcnt(2)
    ds_read_b128 a[228:231], v0 offset:14336
    v_cvt_pk_bf16_f32 v33, v78, v79
    v_mfma_f32_16x16x32_bf16 v[52:55], a[212:215], a[96:99], 0
    v_cvt_pk_bf16_f32 v27, v70, v71
    v_fma_f32 v80, v80, s28, v12
    v_mfma_f32_16x16x32_bf16 v[60:63], a[212:215], a[120:123], 0
    v_cvt_pk_bf16_f32 v39, v86, v87
    v_cvt_pk_bf16_f32 v32, v76, v77
    v_mfma_f32_16x16x32_bf16 v[68:71], a[212:215], a[144:147], 0
    ds_read_b128 a[224:227], v1 offset:13312
    v_cvt_pk_bf16_f32 v38, v84, v85
    v_mfma_f32_16x16x32_bf16 v[76:79], a[212:215], a[168:171], 0
    v_exp_f32 v81, v81
    v_mfma_f32_16x16x32_bf16 v[84:87], a[212:215], a[192:195], 0
    s_waitcnt lgkmcnt(3)
    v_exp_f32 v83, v83
    v_mfma_f32_16x16x32_bf16 v[52:55], a[216:219], a[100:103], v[52:55]
    v_exp_f32 v65, v65
    v_mfma_f32_16x16x32_bf16 v[60:63], a[216:219], a[124:127], v[60:63]
    v_exp_f32 v75, v75
    v_mfma_f32_16x16x32_bf16 v[68:71], a[216:219], a[148:151], v[68:71]
    v_exp_f32 v88, v88
    v_mfma_f32_16x16x32_bf16 v[76:79], a[216:219], a[172:175], v[76:79]
    ds_read_b128 a[232:235], v1 offset:14336
    v_mfma_f32_16x16x32_bf16 v[84:87], a[216:219], a[196:199], v[84:87]
    s_waitcnt lgkmcnt(2)
    v_mfma_f32_16x16x32_bf16 v[52:55], a[220:223], a[104:107], v[52:55]
    v_exp_f32 v59, v59
    v_mfma_f32_16x16x32_bf16 v[60:63], a[220:223], a[128:131], v[60:63]
    s_add_u32 s21, s21, 12032
    v_exp_f32 v90, v90
    v_mfma_f32_16x16x32_bf16 v[68:71], a[220:223], a[152:155], v[68:71]
    v_cvt_pk_bf16_f32 v17, v58, v59
    v_mfma_f32_16x16x32_bf16 v[76:79], a[220:223], a[176:179], v[76:79]
    v_exp_f32 v66, v66
    v_mfma_f32_16x16x32_bf16 v[84:87], a[220:223], a[200:203], v[84:87]
    s_waitcnt lgkmcnt(1)
    v_exp_f32 v72, v72
    v_mfma_f32_16x16x32_bf16 v[52:55], a[224:227], a[108:111], v[52:55]
    v_mfma_f32_16x16x32_bf16 v[60:63], a[224:227], a[132:135], v[60:63]
    v_exp_f32 v73, v73
    v_mfma_f32_16x16x32_bf16 v[68:71], a[224:227], a[156:159], v[68:71]
    v_mfma_f32_16x16x32_bf16 v[76:79], a[224:227], a[180:183], v[76:79]
    v_exp_f32 v67, v67
    v_mfma_f32_16x16x32_bf16 v[84:87], a[224:227], a[204:207], v[84:87]
    v_exp_f32 v80, v80
    v_mfma_f32_16x16x32_bf16 v[44:47], a[236:239], v[14:17], v[48:51]
    ds_read_b128 a[220:223], v0 offset:18432
    v_cvt_pk_bf16_f32 v34, v80, v81
    v_mfma_f32_16x16x32_bf16 v[52:55], a[228:231], a[112:115], v[52:55]
    v_cvt_pk_bf16_f32 v23, v66, v67
    v_cvt_pk_bf16_f32 v22, v64, v65
    v_mfma_f32_16x16x32_bf16 v[60:63], a[228:231], a[136:139], v[60:63]
    ds_read_b128 a[216:219], v1 offset:20480
    v_mfma_f32_16x16x32_bf16 v[68:71], a[228:231], a[160:163], v[68:71]
    ds_read_b128 a[212:215], v0 offset:20480
    v_cvt_pk_bf16_f32 v29, v74, v75
    v_mfma_f32_16x16x32_bf16 v[76:79], a[228:231], a[184:187], v[76:79]
    v_cvt_pk_bf16_f32 v35, v82, v83
    v_mfma_f32_16x16x32_bf16 v[84:87], a[228:231], a[208:211], v[84:87]
    s_waitcnt lgkmcnt(3)
    v_cvt_pk_bf16_f32 v28, v72, v73
    v_mfma_f32_16x16x32_bf16 v[52:55], a[232:235], a[116:119], v[52:55]
    ds_read_b128 a[224:227], v1 offset:18432
    v_cvt_pk_bf16_f32 v41, v90, v91
    v_mfma_f32_16x16x32_bf16 v[60:63], a[232:235], a[140:143], v[60:63]
    v_mfma_f32_16x16x32_bf16 v[68:71], a[232:235], a[164:167], v[68:71]
    ds_read_b128 a[228:231], v0 offset:19456
    v_mfma_f32_16x16x32_bf16 v[76:79], a[232:235], a[188:191], v[76:79]
    v_mfma_f32_16x16x32_bf16 v[84:87], a[232:235], v[92:95], v[84:87]
    ds_read_b128 a[232:235], v1 offset:19456
    v_mfma_f32_16x16x32_bf16 v[44:47], a[240:243], v[20:23], v[44:47]
    v_exp_f32 v89, v89
    v_mfma_f32_16x16x32_bf16 v[44:47], a[244:247], v[26:29], v[44:47]
    v_cvt_pk_bf16_f32 v40, v88, v89
    v_mfma_f32_16x16x32_bf16 v[44:47], a[248:251], v[32:35], v[44:47]
    s_nop 0
    v_mfma_f32_16x16x32_bf16 v[44:47], a[252:255], v[38:41], v[44:47]
    s_waitcnt lgkmcnt(3)
    v_mfma_f32_16x16x32_bf16 v[56:59], a[212:215], a[112:115], 0
    v_mfma_f32_16x16x32_bf16 v[64:67], a[212:215], a[136:139], 0
    v_mfma_f32_16x16x32_bf16 v[72:75], a[212:215], a[160:163], 0
    v_mfma_f32_16x16x32_bf16 v[80:83], a[212:215], a[184:187], 0
    v_mfma_f32_16x16x32_bf16 v[88:91], a[212:215], a[208:211], 0
    s_nop 1
    v_cmp_lt_f32 vcc, s29, v44
    v_mfma_f32_16x16x32_bf16 v[56:59], a[216:219], a[116:119], v[56:59]
    s_waitcnt vmcnt(8) lgkmcnt(0)
    v_mfma_f32_16x16x32_bf16 v[64:67], a[216:219], a[140:143], v[64:67]
    s_barrier
    v_mfma_f32_16x16x32_bf16 v[72:75], a[216:219], a[164:167], v[72:75]
    s_cbranch_vccnz L_rs_tr55a
L_ret_tr55a:
    v_fma_f32 v60, v60, s28, v10
    v_mfma_f32_16x16x32_bf16 v[80:83], a[216:219], a[188:191], v[80:83]
    s_add_u32 m0, s22, 12288
    v_fma_f32 v63, v63, s28, v10
    v_fma_f32 v53, v53, s28, v9
    v_mfma_f32_16x16x32_bf16 v[88:91], a[216:219], v[92:95], v[88:91]
    buffer_load_dwordx4 v6, s[4:7], s20 offen lds
    v_mfma_f32_16x16x32_bf16 v[56:59], a[220:223], a[96:99], v[56:59]
    v_fma_f32 v62, v62, s28, v10
    v_fma_f32 v52, v52, s28, v9
    v_mfma_f32_16x16x32_bf16 v[64:67], a[220:223], a[120:123], v[64:67]
    s_add_u32 s20, s20, 128
    v_exp_f32 v53, v53
    v_mfma_f32_16x16x32_bf16 v[72:75], a[220:223], a[144:147], v[72:75]
    s_add_u32 m0, s22, 13312
    ds_read_b64_tr_b16 a[212:213], v2 offset:0
    v_fma_f32 v55, v55, s28, v9
    v_mfma_f32_16x16x32_bf16 v[80:83], a[220:223], a[168:171], v[80:83]
    ds_read_b64_tr_b16 a[214:215], v2 offset:6144
    v_fma_f32 v54, v54, s28, v9
    v_mfma_f32_16x16x32_bf16 v[88:91], a[220:223], a[192:195], v[88:91]
    buffer_load_dwordx4 v6, s[4:7], s20 offen lds
    v_mfma_f32_16x16x32_bf16 v[56:59], a[224:227], a[100:103], v[56:59]
    s_add_u32 s20, s20, 128
    v_exp_f32 v52, v52
    v_mfma_f32_16x16x32_bf16 v[64:67], a[224:227], a[124:127], v[64:67]
    s_add_u32 m0, s22, 14336
    v_exp_f32 v63, v63
    v_mfma_f32_16x16x32_bf16 v[72:75], a[224:227], a[148:151], v[72:75]
    buffer_load_dwordx4 v6, s[4:7], s20 offen lds
    v_mfma_f32_16x16x32_bf16 v[80:83], a[224:227], a[172:175], v[80:83]
    v_exp_f32 v55, v55
    v_mfma_f32_16x16x32_bf16 v[88:91], a[224:227], a[196:199], v[88:91]
    v_exp_f32 v60, v60
    v_mfma_f32_16x16x32_bf16 v[56:59], a[228:231], a[104:107], v[56:59]
    v_exp_f32 v54, v54
    v_mfma_f32_16x16x32_bf16 v[64:67], a[228:231], a[128:131], v[64:67]
    s_add_u32 s20, s20, 12032
    v_exp_f32 v62, v62
    v_mfma_f32_16x16x32_bf16 v[72:75], a[228:231], a[152:155], v[72:75]
    buffer_load_dwordx4 a[208:211], v96, s[12:15], s48 offen offset:256 nt
    v_mfma_f32_16x16x32_bf16 v[80:83], a[228:231], a[176:179], v[80:83]
    ds_read_b64_tr_b16 a[216:217], v3 offset:0
    v_cvt_pk_bf16_f32 v25, v62, v63
    v_mfma_f32_16x16x32_bf16 v[88:91], a[228:231], a[200:203], v[88:91]
    ds_read_b64_tr_b16 a[218:219], v3 offset:6144
    v_fma_f32 v61, v61, s28, v10
    v_mfma_f32_16x16x32_bf16 v[56:59], a[232:235], a[108:111], v[56:59]
    ds_read_b64_tr_b16 a[220:221], v4 offset:0
    v_cvt_pk_bf16_f32 v19, v54, v55
    v_mfma_f32_16x16x32_bf16 v[64:67], a[232:235], a[132:135], v[64:67]
    ds_read_b64_tr_b16 a[222:223], v4 offset:6144
    v_exp_f32 v61, v61
    v_mfma_f32_16x16x32_bf16 v[72:75], a[232:235], a[156:159], v[72:75]
    ds_read_b64_tr_b16 a[224:225], v5 offset:0
    v_cvt_pk_bf16_f32 v24, v60, v61
    v_mfma_f32_16x16x32_bf16 v[80:83], a[232:235], a[180:183], v[80:83]
    ds_read_b64_tr_b16 a[226:227], v5 offset:6144
    v_cvt_pk_bf16_f32 v18, v52, v53
    v_mfma_f32_16x16x32_bf16 v[88:91], a[232:235], a[204:207], v[88:91]
    buffer_load_dwordx4 v[92:95], v96, s[12:15], s48 offen offset:320 nt
    ds_read_b64_tr_b16 a[228:229], v2 offset:1024
    s_waitcnt lgkmcnt(7)
    v_mfma_f32_16x16x32_bf16 v[112:115], a[212:215], v[14:17], v[112:115]
    ds_read_b64_tr_b16 a[234:235], v3 offset:7168
    v_fma_f32 v68, v68, s28, v11
    v_mfma_f32_16x16x32_bf16 v[160:163], a[212:215], v[20:23], v[160:163]
    ds_read_b64_tr_b16 a[230:231], v2 offset:7168
    v_lshrrev_b32 v105, 11, v0
    v_mfma_f32_16x16x32_bf16 v[208:211], a[212:215], v[26:29], v[208:211]
    v_fma_f32 v67, v67, s28, v10
    v_and_b32 v104, 0x3ff, v0
    v_mfma_f32_16x16x32_bf16 a[0:3], a[212:215], v[32:35], a[0:3]
    v_exp_f32 v67, v67
    v_mfma_f32_16x16x32_bf16 a[48:51], a[212:215], v[38:41], a[48:51]
    v_fma_f32 v88, v88, s28, v13
    s_waitcnt lgkmcnt(7)
    v_mfma_f32_16x16x32_bf16 v[116:119], a[216:219], v[14:17], v[116:119]
    v_fma_f32 v77, v77, s28, v12
    v_fma_f32 v69, v69, s28, v11
    v_mfma_f32_16x16x32_bf16 v[164:167], a[216:219], v[20:23], v[164:167]
    v_fma_f32 v56, v56, s28, v9
    v_fma_f32 v79, v79, s28, v12
    v_mfma_f32_16x16x32_bf16 v[212:215], a[216:219], v[26:29], v[212:215]
    v_fma_f32 v58, v58, s28, v9
    v_fma_f32 v85, v85, s28, v13
    v_mfma_f32_16x16x32_bf16 a[4:7], a[216:219], v[32:35], a[4:7]
    v_xor_b32 v105, s65, v105
    v_lshl_add_u32 v104, v105, 10, v104
    v_mfma_f32_16x16x32_bf16 a[52:55], a[216:219], v[38:41], a[52:55]
    s_waitcnt lgkmcnt(2)
    ds_read_b64_tr_b16 a[212:213], v4 offset:1024
    v_add_u32 v104, s38, v104
    v_mfma_f32_16x16x32_bf16 v[120:123], a[220:223], v[14:17], v[120:123]
    ds_read_b128 a[144:147], v104 offset:12288
    v_fma_f32 v76, v76, s28, v12
    v_mfma_f32_16x16x32_bf16 v[168:171], a[220:223], v[20:23], v[168:171]
    ds_read_b64_tr_b16 a[232:233], v3 offset:1024
    v_xor_b32 v105, 64, v104
    v_mfma_f32_16x16x32_bf16 v[216:219], a[220:223], v[26:29], v[216:219]
    ds_read_b128 a[128:131], v104 offset:8192
    v_fma_f32 v86, v86, s28, v13
    v_mfma_f32_16x16x32_bf16 a[8:11], a[220:223], v[32:35], a[8:11]
    ds_read_b64_tr_b16 a[214:215], v4 offset:7168
    v_fma_f32 v82, v82, s28, v12
    v_mfma_f32_16x16x32_bf16 a[56:59], a[220:223], v[38:41], a[56:59]
    ds_read_b128 a[96:99], v104 offset:0
    v_fma_f32 v84, v84, s28, v13
    v_mfma_f32_16x16x32_bf16 v[124:127], a[224:227], v[14:17], v[124:127]
    ds_read_b64_tr_b16 a[218:219], v5 offset:7168
    v_fma_f32 v80, v80, s28, v12
    v_mfma_f32_16x16x32_bf16 v[172:175], a[224:227], v[20:23], v[172:175]
    ds_read_b64_tr_b16 a[222:223], v2 offset:8192
    v_fma_f32 v70, v70, s28, v11
    v_mfma_f32_16x16x32_bf16 v[220:223], a[224:227], v[26:29], v[220:223]
    ds_read_b128 a[192:195], v104 offset:24576
    v_fma_f32 v75, v75, s28, v11
    v_mfma_f32_16x16x32_bf16 a[12:15], a[224:227], v[32:35], a[12:15]
    ds_read_b64_tr_b16 a[216:217], v5 offset:1024
    v_fma_f32 v74, v74, s28, v11
    v_mfma_f32_16x16x32_bf16 a[60:63], a[224:227], v[38:41], a[60:63]
    s_waitcnt lgkmcnt(9)
    v_exp_f32 v77, v77
    v_mfma_f32_16x16x32_bf16 v[128:131], a[228:231], v[14:17], v[128:131]
    v_exp_f32 v86, v86
    v_mfma_f32_16x16x32_bf16 v[176:179], a[228:231], v[20:23], v[176:179]
    ds_read_b64_tr_b16 a[220:221], v2 offset:2048
    v_fma_f32 v64, v64, s28, v10
    v_mfma_f32_16x16x32_bf16 v[224:227], a[228:231], v[26:29], v[224:227]
    ds_read_b128 a[100:103], v105 offset:0
    v_fma_f32 v87, v87, s28, v13
    v_mfma_f32_16x16x32_bf16 a[16:19], a[228:231], v[32:35], a[16:19]
    s_add_u32 s39, s39, 12288
    ds_read_b64_tr_b16 a[226:227], v3 offset:8192
    v_fma_f32 v65, v65, s28, v10
    v_mfma_f32_16x16x32_bf16 a[64:67], a[228:231], v[38:41], a[64:67]
    s_waitcnt lgkmcnt(7)
    v_exp_f32 v56, v56
    v_mfma_f32_16x16x32_bf16 v[132:135], a[232:235], v[14:17], v[132:135]
    ds_read_b64_tr_b16 a[224:225], v3 offset:2048
    v_exp_f32 v70, v70
    v_mfma_f32_16x16x32_bf16 v[180:183], a[232:235], v[20:23], v[180:183]
    v_exp_f32 v82, v82
    v_mfma_f32_16x16x32_bf16 v[228:231], a[232:235], v[26:29], v[228:231]
    ds_read_b64_tr_b16 a[228:229], v4 offset:2048
    v_exp_f32 v74, v74
    v_mfma_f32_16x16x32_bf16 a[20:23], a[232:235], v[32:35], a[20:23]
    v_exp_f32 v58, v58
    v_mfma_f32_16x16x32_bf16 a[68:71], a[232:235], v[38:41], a[68:71]
    ds_read_b64_tr_b16 a[230:231], v4 offset:8192
    v_fma_f32 v78, v78, s28, v12
    v_mfma_f32_16x16x32_bf16 v[136:139], a[212:215], v[14:17], v[136:139]
    ds_read_b64_tr_b16 a[234:235], v5 offset:8192
    v_fma_f32 v89, v89, s28, v13
    v_mfma_f32_16x16x32_bf16 v[184:187], a[212:215], v[20:23], v[184:187]
    ds_read_b64_tr_b16 a[232:233], v5 offset:2048
    v_fma_f32 v71, v71, s28, v11
    v_mfma_f32_16x16x32_bf16 v[232:235], a[212:215], v[26:29], v[232:235]
    ds_read_b128 a[204:207], v105 offset:26624
    v_fma_f32 v83, v83, s28, v12
    v_mfma_f32_16x16x32_bf16 a[24:27], a[212:215], v[32:35], a[24:27]
    v_exp_f32 v65, v65
    v_mfma_f32_16x16x32_bf16 a[72:75], a[212:215], v[38:41], a[72:75]
    s_waitcnt lgkmcnt(6)
    v_exp_f32 v75, v75
    v_mfma_f32_16x16x32_bf16 v[140:143], a[216:219], v[14:17], v[140:143]
    v_exp_f32 v69, v69
    v_mfma_f32_16x16x32_bf16 v[188:191], a[216:219], v[20:23], v[188:191]
    v_exp_f32 v83, v83
    v_mfma_f32_16x16x32_bf16 v[236:239], a[216:219], v[26:29], v[236:239]
    v_exp_f32 v79, v79
    v_mfma_f32_16x16x32_bf16 a[28:31], a[216:219], v[32:35], a[28:31]
    v_exp_f32 v76, v76
    v_mfma_f32_16x16x32_bf16 a[76:79], a[216:219], v[38:41], a[76:79]
    ds_read_b128 a[172:175], v105 offset:18432
    v_fma_f32 v57, v57, s28, v9
    v_mfma_f32_16x16x32_bf16 v[144:147], a[220:223], v[14:17], v[144:147]
    v_exp_f32 v78, v78
    v_mfma_f32_16x16x32_bf16 v[192:195], a[220:223], v[20:23], v[192:195]
    s_waitcnt vmcnt(9) lgkmcnt(2)
    ds_read_b128 a[120:123], v104 offset:6144
    v_exp_f32 v87, v87
    v_mfma_f32_16x16x32_bf16 v[240:243], a[220:223], v[26:29], v[240:243]
    s_add_u32 s21, s21, s62
    v_exp_f32 v68, v68
    v_mfma_f32_16x16x32_bf16 a[32:35], a[220:223], v[32:35], a[32:35]
    s_barrier
    v_mfma_f32_16x16x32_bf16 a[80:83], a[220:223], v[38:41], a[80:83]
    s_add_u32 m0, s22, 24576
    ds_read_b128 a[124:127], v105 offset:6144
    v_fma_f32 v72, v72, s28, v11
    v_mfma_f32_16x16x32_bf16 v[148:151], a[224:227], v[14:17], v[148:151]
    buffer_load_dwordx4 v6, s[8:11], s21 offen lds
    v_mfma_f32_16x16x32_bf16 v[196:199], a[224:227], v[20:23], v[196:199]
    ds_read_b128 a[168:171], v104 offset:18432
    v_exp_f32 v64, v64
    v_mfma_f32_16x16x32_bf16 v[244:247], a[224:227], v[26:29], v[244:247]
    s_add_u32 s21, s21, 128
    ds_read_b128 a[196:199], v105 offset:24576
    v_fma_f32 v59, v59, s28, v9
    v_mfma_f32_16x16x32_bf16 a[36:39], a[224:227], v[32:35], a[36:39]
    s_add_u32 m0, s22, 25600
    ds_read_b128 a[220:223], v0 offset:1024
    v_fma_f32 v90, v90, s28, v13
    v_mfma_f32_16x16x32_bf16 a[84:87], a[224:227], v[38:41], a[84:87]
    ds_read_b128 a[212:215], v0 offset:0
    buffer_load_dwordx4 v6, s[8:11], s21 offen lds
    v_mfma_f32_16x16x32_bf16 v[152:155], a[228:231], v[14:17], v[152:155]
    ds_read_b128 a[200:203], v104 offset:26624
    v_cvt_pk_bf16_f32 v36, v76, v77
    v_mfma_f32_16x16x32_bf16 v[200:203], a[228:231], v[20:23], v[200:203]
    s_add_u32 s21, s21, 128
    ds_read_b128 a[216:219], v1 offset:0
    v_fma_f32 v91, v91, s28, v13
    v_mfma_f32_16x16x32_bf16 v[248:251], a[228:231], v[26:29], v[248:251]
    s_add_u32 m0, s22, 26624
    ds_read_b128 a[104:107], v104 offset:2048
    v_cvt_pk_bf16_f32 v37, v78, v79
    v_mfma_f32_16x16x32_bf16 a[40:43], a[228:231], v[32:35], a[40:43]
    buffer_load_dwordx4 v6, s[8:11], s21 offen lds
    ds_read_b128 a[224:227], v1 offset:1024
    v_mfma_f32_16x16x32_bf16 a[88:91], a[228:231], v[38:41], a[88:91]
    ds_read_b128 a[148:151], v105 offset:12288
    v_fma_f32 v73, v73, s28, v11
    v_mfma_f32_16x16x32_bf16 v[156:159], a[232:235], v[14:17], v[156:159]
    v_exp_f32 v71, v71
    v_mfma_f32_16x16x32_bf16 v[204:207], a[232:235], v[20:23], v[204:207]
    v_fma_f32 v81, v81, s28, v12
    v_cvt_pk_bf16_f32 v43, v86, v87
    v_mfma_f32_16x16x32_bf16 v[252:255], a[232:235], v[26:29], v[252:255]
    ds_read_b128 a[152:155], v104 offset:14336
    v_cvt_pk_bf16_f32 v31, v70, v71
    v_mfma_f32_16x16x32_bf16 a[44:47], a[232:235], v[32:35], a[44:47]
    v_exp_f32 v89, v89
    v_mfma_f32_16x16x32_bf16 a[92:95], a[232:235], v[38:41], a[92:95]
    s_waitcnt lgkmcnt(6)
    v_exp_f32 v85, v85
    v_mfma_f32_16x16x32_bf16 v[52:55], a[212:215], a[96:99], 0
    ds_read_b128 a[176:179], v104 offset:20480
    v_cvt_pk_bf16_f32 v30, v68, v69
    v_mfma_f32_16x16x32_bf16 v[60:63], a[212:215], a[120:123], 0
    ds_read_b128 a[108:111], v105 offset:2048
    v_cvt_pk_bf16_f32 v35, v82, v83
    v_mfma_f32_16x16x32_bf16 v[68:71], a[212:215], a[144:147], 0
    v_exp_f32 v84, v84
    v_mfma_f32_16x16x32_bf16 v[76:79], a[212:215], a[168:171], 0
    ds_read_b128 a[132:135], v105 offset:8192
    v_cvt_pk_bf16_f32 v42, v84, v85
    v_mfma_f32_16x16x32_bf16 v[84:87], a[212:215], a[192:195], 0
    s_waitcnt lgkmcnt(4)
    ds_read_b128 a[156:159], v105 offset:14336
    v_mfma_f32_16x16x32_bf16 v[52:55], a[216:219], a[100:103], v[52:55]
    v_exp_f32 v57, v57
    v_mfma_f32_16x16x32_bf16 v[60:63], a[216:219], a[124:127], v[60:63]
    v_exp_f32 v88, v88
    v_mfma_f32_16x16x32_bf16 v[68:71], a[216:219], a[148:151], v[68:71]
    v_exp_f32 v59, v59
    v_mfma_f32_16x16x32_bf16 v[76:79], a[216:219], a[172:175], v[76:79]
    ds_read_b128 a[180:183], v105 offset:20480
    v_cvt_pk_bf16_f32 v16, v56, v57
    v_mfma_f32_16x16x32_bf16 v[84:87], a[216:219], a[196:199], v[84:87]
    ds_read_b128 a[228:231], v0 offset:6144
    v_fma_f32 v66, v66, s28, v10
    v_mfma_f32_16x16x32_bf16 v[52:55], a[220:223], a[104:107], v[52:55]
    v_exp_f32 v81, v81
    v_mfma_f32_16x16x32_bf16 v[60:63], a[220:223], a[128:131], v[60:63]
    s_waitcnt lgkmcnt(4)
    v_exp_f32 v66, v66
    v_mfma_f32_16x16x32_bf16 v[68:71], a[220:223], a[152:155], v[68:71]
    v_cvt_pk_bf16_f32 v17, v58, v59
    v_mfma_f32_16x16x32_bf16 v[76:79], a[220:223], a[176:179], v[76:79]
    v_exp_f32 v80, v80
    v_mfma_f32_16x16x32_bf16 v[84:87], a[220:223], a[200:203], v[84:87]
    v_exp_f32 v73, v73
    v_mfma_f32_16x16x32_bf16 v[52:55], a[224:227], a[108:111], v[52:55]
    s_waitcnt lgkmcnt(2)
    v_exp_f32 v91, v91
    v_mfma_f32_16x16x32_bf16 v[60:63], a[224:227], a[132:135], v[60:63]
    ds_read_b128 a[232:235], v1 offset:6144
    v_cvt_pk_bf16_f32 v23, v66, v67
    v_mfma_f32_16x16x32_bf16 v[68:71], a[224:227], a[156:159], v[68:71]
    ds_read_b128 a[140:143], v105 offset:10240
    v_mfma_f32_16x16x32_bf16 v[48:51], a[236:239], v[16:19], v[44:47]
    s_waitcnt lgkmcnt(3)
    v_cvt_pk_bf16_f32 v34, v80, v81
    v_cvt_pk_bf16_f32 v22, v64, v65
    v_mfma_f32_16x16x32_bf16 v[76:79], a[224:227], a[180:183], v[76:79]
    v_exp_f32 v72, v72
    v_mfma_f32_16x16x32_bf16 v[84:87], a[224:227], a[204:207], v[84:87]
    s_waitcnt lgkmcnt(2)
    ds_read_b128 a[220:223], v0 offset:2048
    v_cvt_pk_bf16_f32 v29, v74, v75
    v_mfma_f32_16x16x32_bf16 v[56:59], a[228:231], a[96:99], 0
    ds_read_b128 a[112:115], v104 offset:4096
    v_cvt_pk_bf16_f32 v28, v72, v73
    v_mfma_f32_16x16x32_bf16 v[48:51], a[240:243], v[22:25], v[48:51]
    v_exp_f32 v90, v90
    v_mfma_f32_16x16x32_bf16 v[64:67], a[228:231], a[120:123], 0
    s_add_u32 s21, s21, 12032
    ds_read_b128 a[164:167], v105 offset:16384
    v_cvt_pk_bf16_f32 v41, v90, v91
    v_mfma_f32_16x16x32_bf16 v[72:75], a[228:231], a[144:147], 0
    ds_read_b128 a[212:215], v0 offset:7168
    v_cvt_pk_bf16_f32 v40, v88, v89
    v_mfma_f32_16x16x32_bf16 v[80:83], a[228:231], a[168:171], 0
    ds_read_b128 a[216:219], v1 offset:7168
    v_mfma_f32_16x16x32_bf16 v[88:91], a[228:231], a[192:195], 0
    s_waitcnt lgkmcnt(6)
    ds_read_b128 a[116:119], v105 offset:4096
    v_mfma_f32_16x16x32_bf16 v[56:59], a[232:235], a[100:103], v[56:59]
    v_mfma_f32_16x16x32_bf16 v[64:67], a[232:235], a[124:127], v[64:67]
    ds_read_b128 a[224:227], v1 offset:2048
    v_mfma_f32_16x16x32_bf16 v[72:75], a[232:235], a[148:151], v[72:75]
    v_mfma_f32_16x16x32_bf16 v[80:83], a[232:235], a[172:175], v[80:83]
    ds_read_b128 a[228:231], v0 offset:8192
    v_mfma_f32_16x16x32_bf16 v[88:91], a[232:235], a[196:199], v[88:91]
    ds_read_b128 a[232:235], v1 offset:8192
    v_mfma_f32_16x16x32_bf16 v[48:51], a[244:247], v[28:31], v[48:51]
    v_mfma_f32_16x16x32_bf16 v[48:51], a[248:251], v[34:37], v[48:51]
    ds_read_b128 a[184:187], v104 offset:22528
    v_mfma_f32_16x16x32_bf16 v[48:51], a[252:255], v[40:43], v[48:51]
    s_waitcnt lgkmcnt(6)
    ds_read_b128 a[188:191], v105 offset:22528
    v_mfma_f32_16x16x32_bf16 v[56:59], a[212:215], a[104:107], v[56:59]
    ds_read_b128 a[160:163], v104 offset:16384
    v_mfma_f32_16x16x32_bf16 v[64:67], a[212:215], a[128:131], v[64:67]
    ds_read_b128 a[136:139], v104 offset:10240
    v_mfma_f32_16x16x32_bf16 v[72:75], a[212:215], a[152:155], v[72:75]
    v_mfma_f32_16x16x32_bf16 v[80:83], a[212:215], a[176:179], v[80:83]
    s_waitcnt vmcnt(3)
    v_mfma_f32_16x16x32_bf16 v[88:91], a[212:215], a[200:203], v[88:91]
    s_waitcnt lgkmcnt(6)
    v_cmp_lt_f32 vcc, s29, v48
    v_mfma_f32_16x16x32_bf16 v[56:59], a[216:219], a[108:111], v[56:59]
    s_waitcnt vmcnt(8) lgkmcnt(4)
    v_mfma_f32_16x16x32_bf16 v[64:67], a[216:219], a[132:135], v[64:67]
    s_barrier
    v_mfma_f32_16x16x32_bf16 v[72:75], a[216:219], a[156:159], v[72:75]
    s_cbranch_vccnz L_rs_tr55b
L_ret_tr55b:
    s_add_u32 m0, s22, 0
    v_mfma_f32_16x16x32_bf16 v[80:83], a[216:219], a[180:183], v[80:83]
    buffer_load_dwordx4 v6, s[4:7], s20 offen lds
    v_mfma_f32_16x16x32_bf16 v[88:91], a[216:219], a[204:207], v[88:91]
    ds_read_b64_tr_b16 a[212:213], v2 offset:18432
    v_mfma_f32_16x16x32_bf16 v[52:55], a[220:223], a[112:115], v[52:55]
    s_add_u32 s20, s20, 128
    s_waitcnt lgkmcnt(1)
    v_mfma_f32_16x16x32_bf16 v[60:63], a[220:223], a[136:139], v[60:63]
    s_add_u32 m0, s22, 1024
    v_mfma_f32_16x16x32_bf16 v[68:71], a[220:223], a[160:163], v[68:71]
    buffer_load_dwordx4 v6, s[4:7], s20 offen lds
    v_mfma_f32_16x16x32_bf16 v[76:79], a[220:223], a[184:187], v[76:79]
    ds_read_b64_tr_b16 a[214:215], v2 offset:12288
    v_mfma_f32_16x16x32_bf16 v[84:87], a[220:223], a[208:211], v[84:87]
    s_add_u32 s20, s20, 128
    v_mfma_f32_16x16x32_bf16 v[52:55], a[224:227], a[116:119], v[52:55]
    s_add_u32 m0, s22, 2048
    ds_read_b64_tr_b16 a[216:217], v3 offset:18432
    v_mfma_f32_16x16x32_bf16 v[60:63], a[224:227], a[140:143], v[60:63]
    buffer_load_dwordx4 v6, s[4:7], s20 offen lds
    v_mfma_f32_16x16x32_bf16 v[68:71], a[224:227], a[164:167], v[68:71]
    v_mfma_f32_16x16x32_bf16 v[76:79], a[224:227], a[188:191], v[76:79]
    v_mfma_f32_16x16x32_bf16 v[84:87], a[224:227], v[92:95], v[84:87]
    ds_read_b64_tr_b16 a[218:219], v3 offset:12288
    v_mfma_f32_16x16x32_bf16 v[56:59], a[228:231], a[112:115], v[56:59]
    ds_read_b64_tr_b16 a[220:221], v4 offset:18432
    v_mfma_f32_16x16x32_bf16 v[64:67], a[228:231], a[136:139], v[64:67]
    v_mfma_f32_16x16x32_bf16 v[72:75], a[228:231], a[160:163], v[72:75]
    v_mfma_f32_16x16x32_bf16 v[80:83], a[228:231], a[184:187], v[80:83]
    v_mfma_f32_16x16x32_bf16 v[88:91], a[228:231], a[208:211], v[88:91]
    v_mfma_f32_16x16x32_bf16 v[56:59], a[232:235], a[116:119], v[56:59]
    ds_read_b64_tr_b16 a[222:223], v4 offset:12288
    v_mfma_f32_16x16x32_bf16 v[64:67], a[232:235], a[140:143], v[64:67]
    ds_read_b64_tr_b16 a[224:225], v5 offset:18432
    v_mfma_f32_16x16x32_bf16 v[72:75], a[232:235], a[164:167], v[72:75]
    s_add_u32 s20, s20, 12032
    ds_read_b64_tr_b16 a[226:227], v5 offset:12288
    v_mfma_f32_16x16x32_bf16 v[80:83], a[232:235], a[188:191], v[80:83]
    v_mfma_f32_16x16x32_bf16 v[88:91], a[232:235], v[92:95], v[88:91]
    v_max3_f32 v96, v52, v53, v54
    v_max3_f32 v96, v96, v55, v56
    s_waitcnt lgkmcnt(6)
    v_mfma_f32_16x16x32_bf16 v[112:115], a[212:215], v[16:19], v[112:115]
    s_mov_b32 s67, s34
    v_max3_f32 v96, v96, v57, v58
    v_max_f32 v96, v96, v59
    v_rcp_f32 v49, v49
    v_mbcnt_lo_u32_b32 v104, -1, 0
    v_mov_b32 v97, v96
    v_mbcnt_hi_u32_b32 v104, -1, v104
    v_mfma_f32_16x16x32_bf16 v[160:163], a[212:215], v[22:25], v[160:163]
    v_permlane32_swap_b32 v97, v96
    v_mfma_f32_16x16x32_bf16 v[208:211], a[212:215], v[28:31], v[208:211]
    s_add_u32 s18, s34, 30720
    v_max_f32 v96, v96, v97
    v_mov_b32 v97, v96
    v_lshrrev_b32 v106, 5, v104
    v_mfma_f32_16x16x32_bf16 a[0:3], a[212:215], v[34:37], a[0:3]
    s_mov_b32 s34, s33
    v_permlane16_swap_b32 v97, v96
    v_max_f32 v96, v96, v97
    v_mfma_f32_16x16x32_bf16 a[48:51], a[212:215], v[40:43], a[48:51]
    s_waitcnt lgkmcnt(4)
    ds_read_b64_tr_b16 a[232:233], v3 offset:19456
    v_mul_f32_e64 v9, -s28, v96
    v_mfma_f32_16x16x32_bf16 v[116:119], a[216:219], v[16:19], v[116:119]
    s_add_u32 s64, s64, s62
    v_max3_f32 v96, v60, v61, v62
    v_max3_f32 v96, v96, v63, v64
    v_max3_f32 v96, v96, v65, v66
    v_fma_f32 v56, v56, s28, v9
    v_max_f32 v96, v96, v67
    v_mov_b32 v97, v96
    v_mov_b32 v100, v48
    v_fma_f32 v53, v53, s28, v9
    v_mfma_f32_16x16x32_bf16 v[164:167], a[216:219], v[22:25], v[164:167]
    ds_read_b64_tr_b16 a[212:213], v4 offset:19456
    v_permlane32_swap_b32 v97, v96
    v_max_f32 v96, v96, v97
    v_mul_f32 v162, v162, v49
    v_mfma_f32_16x16x32_bf16 v[212:215], a[216:219], v[28:31], v[212:215]
    ds_read_b64_tr_b16 a[234:235], v3 offset:13312
    v_fma_f32 v55, v55, s28, v9
    v_mov_b32 v97, v96
    v_fma_f32 v58, v58, s28, v9
    v_fma_f32 v52, v52, s28, v9
    v_permlane16_swap_b32 v97, v96
    v_max_f32 v96, v96, v97
    v_mfma_f32_16x16x32_bf16 a[4:7], a[216:219], v[34:37], a[4:7]
    s_add_u32 s64, s64, 196608
    ds_read_b64_tr_b16 a[214:215], v4 offset:13312
    v_mul_f32_e64 v10, -s28, v96
    v_fma_f32 v57, v57, s28, v9
    v_mfma_f32_16x16x32_bf16 a[52:55], a[216:219], v[40:43], a[52:55]
    s_waitcnt lgkmcnt(4)
    v_max3_f32 v96, v68, v69, v70
    v_max3_f32 v96, v96, v71, v72
    v_max3_f32 v96, v96, v73, v74
    v_mfma_f32_16x16x32_bf16 v[120:123], a[220:223], v[16:19], v[120:123]
    s_mov_b32 s39, s64
    ds_read_b64_tr_b16 a[228:229], v2 offset:19456
    v_max_f32 v96, v96, v75
    v_mov_b32 v97, v96
    v_bfe_u32 v105, v104, 3, 1
    v_and_b32 v107, 3, v104
    v_permlane32_swap_b32 v97, v96
    v_max_f32 v96, v96, v97
    v_mfma_f32_16x16x32_bf16 v[168:171], a[220:223], v[22:25], v[168:171]
    s_add_u32 s37, s37, 1
    ds_read_b64_tr_b16 a[230:231], v2 offset:13312
    v_mov_b32 v97, v96
    v_mul_f32 v164, v164, v49
    v_xor_b32 v106, v106, v105
    v_xor_b32 v105, s65, v105
    v_mfma_f32_16x16x32_bf16 v[216:219], a[220:223], v[28:31], v[216:219]
    s_bitcmp1_b32 s63, s37
    v_rcp_f32 v50, v50
    v_mfma_f32_16x16x32_bf16 a[8:11], a[220:223], v[34:37], a[8:11]
    s_cselect_b32 s62, 4294770688, 0
    v_permlane16_swap_b32 v97, v96
    v_max_f32 v96, v96, v97
    v_mfma_f32_16x16x32_bf16 a[56:59], a[220:223], v[40:43], a[56:59]
    v_fma_f32 v54, v54, s28, v9
    v_exp_f32 v53, v53
    v_mul_f32_e64 v11, -s28, v96
    v_fma_f32 v60, v60, s28, v10
    v_permlane32_swap_b32 v48, v100
    v_exp_f32 v55, v55
    v_max3_f32 v96, v76, v77, v78
    v_mfma_f32_16x16x32_bf16 v[124:127], a[224:227], v[16:19], v[124:127]
    s_cselect_b32 s42, 0, 325632
    ds_read_b64_tr_b16 a[216:217], v5 offset:19456
    v_max3_f32 v96, v96, v79, v80
    v_fma_f32 v70, v70, s28, v11
    v_max3_f32 v96, v96, v81, v82
    v_mfma_f32_16x16x32_bf16 v[172:175], a[224:227], v[22:25], v[172:175]
    s_add_u32 s35, s35, s42
    v_fma_f32 v62, v62, s28, v10
    v_fma_f32 v69, v69, s28, v11
    v_mul_f32 v169, v169, v49
    v_mul_f32 v168, v168, v49
    v_max_f32 v96, v96, v83
    v_mov_b32 v97, v96
    v_mfma_f32_16x16x32_bf16 v[220:223], a[224:227], v[28:31], v[220:223]
    s_lshl_b32 s42, s37, 1
    v_permlane32_swap_b32 v97, v96
    v_max_f32 v96, v96, v97
    v_mov_b32 v97, v96
    v_fma_f32 v71, v71, s28, v11
    v_fma_f32 v67, v67, s28, v10
    v_lshl_or_b32 v106, v107, 1, v106
    v_permlane16_swap_b32 v97, v96
    v_mfma_f32_16x16x32_bf16 a[12:15], a[224:227], v[34:37], a[12:15]
    s_lshr_b32 s42, s31, s42
    v_fma_f32 v75, v75, s28, v11
    v_max_f32 v96, v96, v97
    v_mfma_f32_16x16x32_bf16 a[60:63], a[224:227], v[40:43], a[60:63]
    s_waitcnt lgkmcnt(1)
    v_exp_f32 v71, v71
    v_mfma_f32_16x16x32_bf16 v[128:131], a[228:231], v[16:19], v[128:131]
    s_and_b32 s42, s42, 3
    v_mul_f32_e64 v12, -s28, v96
    v_max3_f32 v96, v84, v85, v86
    v_max3_f32 v96, v96, v87, v88
    v_mul_f32 v161, v161, v49
    v_mfma_f32_16x16x32_bf16 v[176:179], a[228:231], v[22:25], v[176:179]
    s_add_u32 s42, s42, s36
    ds_read_b64_tr_b16 a[218:219], v5 offset:13312
    v_fma_f32 v74, v74, s28, v11
    v_max3_f32 v96, v96, v89, v90
    v_mfma_f32_16x16x32_bf16 v[224:227], a[228:231], v[28:31], v[224:227]
    s_sub_u32 s43, s42, 3
    v_exp_f32 v75, v75
    v_mul_f32 v163, v163, v49
    v_mfma_f32_16x16x32_bf16 a[16:19], a[228:231], v[34:37], a[16:19]
    s_cmp_ge_u32 s42, 3
    v_exp_f32 v54, v54
    v_mfma_f32_16x16x32_bf16 a[64:67], a[228:231], v[40:43], a[64:67]
    s_cselect_b32 s42, s43, s42
    v_max_f32 v96, v96, v91
    v_fma_f32 v77, v77, s28, v12
    v_mfma_f32_16x16x32_bf16 v[132:135], a[232:235], v[16:19], v[132:135]
    s_mul_i32 s44, s3, 5
    ds_read_b64_tr_b16 a[222:223], v2 offset:14336
    v_fma_f32 v65, v65, s28, v10
    v_mfma_f32_16x16x32_bf16 v[180:183], a[232:235], v[22:25], v[180:183]
    s_mov_b32 s32, 1
    ds_read_b64_tr_b16 a[220:221], v2 offset:20480
    v_fma_f32 v83, v83, s28, v12
    v_mfma_f32_16x16x32_bf16 v[228:231], a[232:235], v[28:31], v[228:231]
    s_lshl_b32 s43, s3, 2
    v_fma_f32 v79, v79, s28, v12
    v_fma_f32 v73, v73, s28, v11
    v_mul_f32 v175, v175, v49
    v_exp_f32 v60, v60
    v_lshl_add_u32 v101, v105, 10, s38
    v_mfma_f32_16x16x32_bf16 a[20:23], a[232:235], v[34:37], a[20:23]
    s_add_u32 s45, s43, 21
    v_fma_f32 v78, v78, s28, v12
    v_mul_f32 v181, v181, v49
    v_exp_f32 v56, v56
    v_mfma_f32_16x16x32_bf16 a[68:71], a[232:235], v[40:43], a[68:71]
    s_cmp_eq_u32 s3, 0
    v_mov_b32 v97, v96
    s_cselect_b32 s45, 20, s45
    v_fma_f32 v76, v76, s28, v12
    v_mfma_f32_16x16x32_bf16 v[136:139], a[212:215], v[16:19], v[136:139]
    s_cselect_b32 s33, 1, 0
    ds_read_b64_tr_b16 a[226:227], v3 offset:14336
    v_fma_f32 v61, v61, s28, v10
    v_mfma_f32_16x16x32_bf16 v[184:187], a[212:215], v[22:25], v[184:187]
    s_cmp_eq_u32 s42, 1
    ds_read_b64_tr_b16 a[228:229], v4 offset:20480
    v_fma_f32 v72, v72, s28, v11
    v_mfma_f32_16x16x32_bf16 v[232:235], a[212:215], v[28:31], v[232:235]
    s_cselect_b32 s44, s45, s44
    ds_read_b64_tr_b16 a[224:225], v3 offset:20480
    v_fma_f32 v64, v64, s28, v10
    v_mfma_f32_16x16x32_bf16 a[24:27], a[212:215], v[34:37], a[24:27]
    s_cselect_b32 s32, s33, s32
    ds_read_b64_tr_b16 a[230:231], v4 offset:14336
    v_fma_f32 v82, v82, s28, v12
    v_mfma_f32_16x16x32_bf16 a[72:75], a[212:215], v[40:43], a[72:75]
    s_waitcnt lgkmcnt(4)
    ds_read_b64_tr_b16 a[234:235], v5 offset:14336
    v_exp_f32 v61, v61
    v_mfma_f32_16x16x32_bf16 v[140:143], a[216:219], v[16:19], v[140:143]
    s_add_u32 s45, s43, 37
    v_exp_f32 v73, v73
    v_mfma_f32_16x16x32_bf16 v[188:191], a[216:219], v[22:25], v[188:191]
    s_cmp_eq_u32 s42, 2
    v_permlane32_swap_b32 v97, v96
    v_mfma_f32_16x16x32_bf16 v[236:239], a[216:219], v[28:31], v[236:239]
    s_cselect_b32 s44, s45, s44
    v_exp_f32 v69, v69
    v_mfma_f32_16x16x32_bf16 a[28:31], a[216:219], v[34:37], a[28:31]
    s_cselect_b32 s32, 0, s32
    v_exp_f32 v67, v67
    v_mfma_f32_16x16x32_bf16 a[76:79], a[216:219], v[40:43], a[76:79]
    s_mul_i32 s44, s44, 6144
    v_fma_f32 v81, v81, s28, v12
    v_and_b32 v107, 7, v104
    s_add_u32 s33, s35, s44
    s_mul_i32 s42, s32, 6144
    v_fma_f32 v63, v63, s28, v10
    v_fma_f32 v68, v68, s28, v11
    v_exp_f32 v79, v79
    v_mfma_f32_16x16x32_bf16 v[144:147], a[220:223], v[16:19], v[144:147]
    s_add_u32 s42, s42, 24576
    v_exp_f32 v83, v83
    v_fma_f32 v80, v80, s28, v12
    v_mfma_f32_16x16x32_bf16 v[192:195], a[220:223], v[22:25], v[192:195]
    s_add_u32 s42, s42, s33
    ds_read_b64_tr_b16 a[232:233], v5 offset:20480
    v_max_f32 v96, v96, v97
    v_exp_f32 v68, v68
    v_mfma_f32_16x16x32_bf16 v[240:243], a[220:223], v[28:31], v[240:243]
    s_cmp_ge_u32 s37, 6
    v_exp_f32 v78, v78
    v_lshl_add_u32 v101, v106, 4, v101
    v_mov_b32 v97, v96
    v_mfma_f32_16x16x32_bf16 a[32:35], a[220:223], v[34:37], a[32:35]
    s_cselect_b32 s14, 0, s42
    v_exp_f32 v52, v52
    v_mfma_f32_16x16x32_bf16 a[80:83], a[220:223], v[40:43], a[80:83]
    s_waitcnt lgkmcnt(1)
    v_permlane16_swap_b32 v97, v96
    v_mfma_f32_16x16x32_bf16 v[148:151], a[224:227], v[16:19], v[148:151]
    s_add_u32 s24, s67, 256
    v_cvt_pk_bf16_f32 v20, v60, v61
    v_accvgpr_read_b32 v106, a2
    v_mfma_f32_16x16x32_bf16 v[196:199], a[224:227], v[22:25], v[196:199]
    s_add_u32 s25, s33, 256
    v_exp_f32 v77, v77
    v_mfma_f32_16x16x32_bf16 v[244:247], a[224:227], v[28:31], v[244:247]
    s_add_u32 s23, s38, 4096
    v_exp_f32 v70, v70
    v_mfma_f32_16x16x32_bf16 a[36:39], a[224:227], v[34:37], a[36:39]
    s_mov_b32 s27, 0x49249249
    v_exp_f32 v63, v63
    v_mfma_f32_16x16x32_bf16 a[84:87], a[224:227], v[40:43], a[84:87]
    s_mov_b32 s30, 0
    v_exp_f32 v72, v72
    v_mfma_f32_16x16x32_bf16 v[152:155], a[228:231], v[16:19], v[152:155]
    s_waitcnt vmcnt(8) lgkmcnt(0)
    v_exp_f32 v62, v62
    v_mfma_f32_16x16x32_bf16 v[200:203], a[228:231], v[22:25], v[200:203]
    s_barrier
    ds_read_b128 a[216:219], v1 offset:12288
    v_mfma_f32_16x16x32_bf16 v[248:251], a[228:231], v[28:31], v[248:251]
    ds_read_b128 a[212:215], v0 offset:12288
    v_lshl_add_u32 v101, v107, 7, v101
    v_max_f32 v96, v96, v97
    v_mul_f32_e64 v13, -s28, v96
    v_mfma_f32_16x16x32_bf16 a[40:43], a[228:231], v[34:37], a[40:43]
    v_rcp_f32 v48, v48
    v_fma_f32 v85, v85, s28, v13
    v_exp_f32 v57, v57
    v_mfma_f32_16x16x32_bf16 a[88:91], a[228:231], v[40:43], a[88:91]
    ds_read_b128 a[220:223], v0 offset:13312
    v_cvt_pk_bf16_f32 v21, v62, v63
    v_bfe_u32 v107, v104, 4, 1
    v_mov_b32 v104, v100
    v_mfma_f32_16x16x32_bf16 v[156:159], a[232:235], v[16:19], v[156:159]
    v_rcp_f32 v51, v51
    v_mfma_f32_16x16x32_bf16 v[204:207], a[232:235], v[22:25], v[204:207]
    v_mul_f32 v174, v174, v49
    v_fma_f32 v66, v66, s28, v10
    v_cvt_pk_bf16_f32 v33, v78, v79
    v_accvgpr_read_b32 v105, a1
    v_fma_f32 v87, v87, s28, v13
    v_exp_f32 v76, v76
    v_mfma_f32_16x16x32_bf16 v[252:255], a[232:235], v[28:31], v[252:255]
    ds_read_b128 a[224:227], v1 offset:13312
    v_mul_f32 v186, v186, v49
    v_mul_f32 v165, v165, v49
    v_cvt_pk_bf16_f32 v15, v54, v55
    v_mul_f32 v180, v180, v49
    v_pk_mul_f32 v[210:211], v[210:211], v[50:51] op_sel_hi:[1,0]
    v_cvt_pk_bf16_f32 v14, v52, v53
    v_exp_f32 v82, v82
    v_mfma_f32_16x16x32_bf16 a[44:47], a[232:235], v[34:37], a[44:47]
    v_cvt_pk_bf16_f32 v27, v70, v71
    v_permlane16_swap_b32 v100, v104
    v_mul_f32 v202, v202, v49
    v_mfma_f32_16x16x32_bf16 a[92:95], a[232:235], v[40:43], a[92:95]
    s_waitcnt lgkmcnt(2)
    v_exp_f32 v87, v87
    v_fma_f32 v59, v59, s28, v9
    v_fma_f32 v86, v86, s28, v13
    v_mfma_f32_16x16x32_bf16 v[52:55], a[212:215], a[96:99], 0
    v_exp_f32 v86, v86
    v_mfma_f32_16x16x32_bf16 v[52:55], a[216:219], a[100:103], v[52:55]
    s_waitcnt lgkmcnt(1)
    v_exp_f32 v81, v81
    v_mfma_f32_16x16x32_bf16 v[52:55], a[220:223], a[104:107], v[52:55]
    s_add_u32 m0, s22, 36864
    v_accvgpr_read_b32 v109, a49
    v_mul_f32 v195, v195, v49
    v_mfma_f32_16x16x32_bf16 v[60:63], a[212:215], a[120:123], 0
    v_mul_f32 v177, v177, v49
    v_mul_f32 v189, v189, v49
    v_mfma_f32_16x16x32_bf16 v[60:63], a[216:219], a[124:127], v[60:63]
    ds_read_b128 a[228:231], v0 offset:14336
    v_cvt_pk_bf16_f32 v26, v68, v69
    v_mul_f32 v160, v160, v49
    v_mfma_f32_16x16x32_bf16 v[60:63], a[220:223], a[128:131], v[60:63]
    v_mul_f32 v172, v172, v49
    v_exp_f32 v85, v85
    v_mfma_f32_16x16x32_bf16 v[68:71], a[212:215], a[144:147], 0
    v_fma_f32 v90, v90, s28, v13
    v_cvt_pk_bf16_f32 v39, v86, v87
    v_mul_f32 v105, v105, v51
    v_mul_f32 v203, v203, v49
    v_cvt_pk_bf16_f32 v32, v76, v77
    v_mfma_f32_16x16x32_bf16 v[68:71], a[216:219], a[148:151], v[68:71]
    ds_read_b128 a[232:235], v1 offset:14336
    v_mul_f32 v176, v176, v49
    v_fma_f32 v84, v84, s28, v13
    v_mfma_f32_16x16x32_bf16 v[68:71], a[220:223], a[152:155], v[68:71]
    v_exp_f32 v64, v64
    v_mfma_f32_16x16x32_bf16 v[76:79], a[212:215], a[168:171], 0
    v_accvgpr_read_b32 v108, a48
    v_mul_f32 v204, v204, v49
    v_mfma_f32_16x16x32_bf16 v[76:79], a[216:219], a[172:175], v[76:79]
    v_exp_f32 v84, v84
    v_lshl_add_u32 v101, v107, 3, v101
    v_mul_f32 v206, v206, v49
    v_mfma_f32_16x16x32_bf16 v[76:79], a[220:223], a[176:179], v[76:79]
    v_mul_f32 v166, v166, v49
    v_cvt_pk_bf16_f32 v38, v84, v85
    v_mfma_f32_16x16x32_bf16 v[84:87], a[212:215], a[192:195], 0
    buffer_load_dwordx4 v6, s[8:11], s21 offen lds
    v_exp_f32 v58, v58
    v_mfma_f32_16x16x32_bf16 v[84:87], a[216:219], a[196:199], v[84:87]
    v_exp_f32 v90, v90
    v_mfma_f32_16x16x32_bf16 v[84:87], a[220:223], a[200:203], v[84:87]
    s_waitcnt lgkmcnt(1)
    v_mul_f32 v170, v170, v49
    v_exp_f32 v65, v65
    v_mfma_f32_16x16x32_bf16 v[52:55], a[224:227], a[108:111], v[52:55]
    v_exp_f32 v80, v80
    v_mfma_f32_16x16x32_bf16 v[52:55], a[228:231], a[112:115], v[52:55]
    s_waitcnt lgkmcnt(0)
    v_cvt_pk_bf16_f32 v16, v56, v57
    v_accvgpr_read_b32 v107, a3
    v_mfma_f32_16x16x32_bf16 v[52:55], a[232:235], a[116:119], v[52:55]
    v_exp_f32 v59, v59
    v_mfma_f32_16x16x32_bf16 v[60:63], a[224:227], a[132:135], v[60:63]
    v_mul_f32 v185, v185, v49
    v_mul_f32 v198, v198, v49
    v_mfma_f32_16x16x32_bf16 v[60:63], a[228:231], a[136:139], v[60:63]
    s_add_u32 s21, s21, 128
    v_mul_f32 v106, v106, v51
    v_fma_f32 v89, v89, s28, v13
    v_mfma_f32_16x16x32_bf16 v[60:63], a[232:235], a[140:143], v[60:63]
    v_exp_f32 v66, v66
    v_mfma_f32_16x16x32_bf16 v[68:71], a[224:227], a[156:159], v[68:71]
    s_add_u32 m0, s22, 37888
    ds_read_b128 a[216:219], v1 offset:18432
    v_accvgpr_read_b32 v104, a0
    v_mfma_f32_16x16x32_bf16 v[68:71], a[228:231], a[160:163], v[68:71]
    buffer_load_dwordx4 v6, s[8:11], s21 offen lds
    v_mfma_f32_16x16x32_bf16 v[68:71], a[232:235], a[164:167], v[68:71]
    v_fma_f32 v88, v88, s28, v13
    v_mul_f32 v167, v167, v49
    v_fma_f32 v91, v91, s28, v13
    v_mfma_f32_16x16x32_bf16 v[76:79], a[224:227], a[180:183], v[76:79]
    v_mul_f32 v188, v188, v49
    v_exp_f32 v91, v91
    v_mfma_f32_16x16x32_bf16 v[76:79], a[228:231], a[184:187], v[76:79]
    v_accvgpr_read_b32 v111, a51
    v_exp_f32 v88, v88
    v_mfma_f32_16x16x32_bf16 v[76:79], a[232:235], a[188:191], v[76:79]
    ds_read_b128 a[220:223], v0 offset:19456
    v_mul_f32 v107, v107, v51
    v_cvt_pk_bf16_f32 v23, v66, v67
    v_mul_f32 v104, v104, v51
    v_mfma_f32_16x16x32_bf16 v[84:87], a[224:227], a[204:207], v[84:87]
    s_add_u32 s21, s21, 128
    ds_read_b128 a[212:215], v0 offset:18432
    v_fma_f32 v60, v60, s28, v10
    v_mul_f32 v184, v184, v49
    v_mfma_f32_16x16x32_bf16 v[84:87], a[228:231], a[208:211], v[84:87]
    v_cvt_pk_bf16_f32 v22, v64, v65
    v_cvt_pk_bf16_f32 v17, v58, v59
    v_cvt_pk_bf16_f32 v28, v72, v73
    v_mul_f32 v190, v190, v49
    v_cvt_pk_bf16_f32 v180, v180, v181
    v_mfma_f32_16x16x32_bf16 v[44:47], a[236:239], v[14:17], 0
    v_exp_f32 v89, v89
    v_exp_f32 v74, v74
    v_rcp_f32 v100, v100
    v_fma_f32 v68, v68, s28, v11
    v_fma_f32 v79, v79, s28, v12
    v_pk_mul_f32 v[208:209], v[208:209], v[50:51] op_sel_hi:[1,0]
    v_pk_mul_f32 v[218:219], v[218:219], v[50:51] op_sel_hi:[1,0]
    v_pk_mul_f32 v[112:113], v[112:113], v[48:49] op_sel_hi:[1,0]
    v_pk_mul_f32 v[236:237], v[236:237], v[50:51] op_sel_hi:[1,0]
    v_pk_mul_f32 v[122:123], v[122:123], v[48:49] op_sel_hi:[1,0]
    v_pk_mul_f32 v[246:247], v[246:247], v[50:51] op_sel_hi:[1,0]
    v_pk_mul_f32 v[108:109], v[108:109], v[100:101] op_sel_hi:[1,0]
    v_pk_mul_f32 v[120:121], v[120:121], v[48:49] op_sel_hi:[1,0]
    v_mul_f32 v200, v200, v49
    v_cvt_pk_bf16_f32 v41, v90, v91
    v_mul_f32 v173, v173, v49
    v_pk_mul_f32 v[224:225], v[224:225], v[50:51] op_sel_hi:[1,0]
    v_pk_mul_f32 v[136:137], v[136:137], v[48:49] op_sel_hi:[1,0]
    v_cvt_pk_bf16_f32 v168, v168, v169
    v_cvt_pk_bf16_f32 v40, v88, v89
    v_cvt_pk_bf16_f32 v108, v108, v109
    v_pk_mul_f32 v[116:117], v[116:117], v[48:49] op_sel_hi:[1,0]
    v_pk_mul_f32 v[228:229], v[228:229], v[50:51] op_sel_hi:[1,0]
    v_accvgpr_read_b32 v110, a50
    v_cvt_pk_bf16_f32 v34, v80, v81
    v_cvt_pk_bf16_f32 v160, v160, v161
    v_pk_mul_f32 v[144:145], v[144:145], v[48:49] op_sel_hi:[1,0]
    v_pk_mul_f32 v[114:115], v[114:115], v[48:49] op_sel_hi:[1,0]
    v_pk_mul_f32 v[110:111], v[110:111], v[100:101] op_sel_hi:[1,0]
    v_pk_mul_f32 v[216:217], v[216:217], v[50:51] op_sel_hi:[1,0]
    v_cvt_pk_bf16_f32 v104, v104, v105
    v_mul_f32 v179, v179, v49
    v_mul_f32 v178, v178, v49
    v_mfma_f32_16x16x32_bf16 v[84:87], a[232:235], v[92:95], v[84:87]
    s_waitcnt lgkmcnt(0)
    ds_read_b128 a[228:231], v0 offset:20480
    v_fma_f32 v54, v54, s28, v9
    v_cvt_pk_bf16_f32 v228, v228, v229
    v_mfma_f32_16x16x32_bf16 v[56:59], a[212:215], a[96:99], 0
    ds_read_b128 a[224:227], v1 offset:19456
    v_cvt_pk_bf16_f32 v35, v82, v83
    v_mfma_f32_16x16x32_bf16 v[56:59], a[216:219], a[100:103], v[56:59]
    ds_read_b128 a[232:235], v1 offset:20480
    v_cvt_pk_bf16_f32 v184, v184, v185
    v_mfma_f32_16x16x32_bf16 v[56:59], a[220:223], a[104:107], v[56:59]
    s_add_u32 m0, s22, 38912
    v_cvt_pk_bf16_f32 v208, v208, v209
    v_cvt_pk_bf16_f32 v144, v144, v145
    v_cvt_pk_bf16_f32 v172, v172, v173
    v_mfma_f32_16x16x32_bf16 v[64:67], a[212:215], a[120:123], 0
    v_mul_f32 v205, v205, v49
    v_exp_f32 v68, v68
    v_fma_f32 v69, v69, s28, v11
    v_mfma_f32_16x16x32_bf16 v[64:67], a[216:219], a[124:127], v[64:67]
    v_fma_f32 v63, v63, s28, v10
    v_cvt_pk_bf16_f32 v105, v106, v107
    v_mfma_f32_16x16x32_bf16 v[64:67], a[220:223], a[128:131], v[64:67]
    v_cvt_pk_bf16_f32 v29, v74, v75
    v_cvt_pk_bf16_f32 v112, v112, v113
    v_mfma_f32_16x16x32_bf16 v[72:75], a[212:215], a[144:147], 0
    v_mul_f32 v171, v171, v49
    v_cvt_pk_bf16_f32 v209, v210, v211
    v_accvgpr_read_b32 v107, a7
    v_mul_f32 v196, v196, v49
    v_mfma_f32_16x16x32_bf16 v[72:75], a[216:219], a[148:151], v[72:75]
    buffer_load_dwordx4 v6, s[8:11], s21 offen lds
    v_mfma_f32_16x16x32_bf16 v[72:75], a[220:223], a[152:155], v[72:75]
    v_mul_f32 v183, v183, v49
    v_exp_f32 v79, v79
    v_mfma_f32_16x16x32_bf16 v[80:83], a[212:215], a[168:171], 0
    s_add_u32 s21, s21, 12032
    v_fma_f32 v71, v71, s28, v11
    v_cvt_pk_bf16_f32 v113, v114, v115
    v_mfma_f32_16x16x32_bf16 v[80:83], a[216:219], a[172:175], v[80:83]
    s_waitcnt vmcnt(6) lgkmcnt(0)
    v_cvt_pk_bf16_f32 v161, v162, v163
    v_fma_f32 v70, v70, s28, v11
    v_mfma_f32_16x16x32_bf16 v[80:83], a[220:223], a[176:179], v[80:83]
    s_barrier
    v_mfma_f32_16x16x32_bf16 v[88:91], a[212:215], a[192:195], 0
    v_fma_f32 v61, v61, s28, v10
    v_cvt_pk_bf16_f32 v224, v224, v225
    v_cvt_pk_bf16_f32 v173, v174, v175
    v_cvt_pk_bf16_f32 v120, v120, v121
    v_mfma_f32_16x16x32_bf16 v[88:91], a[216:219], a[196:199], v[88:91]
    ds_write2st64_b64 v101, v[112:113], v[160:161] offset0:0 offset1:12
    v_mfma_f32_16x16x32_bf16 v[44:47], a[240:243], v[20:23], v[44:47]
    s_add_u32 m0, s22, 12288
    ds_read_b64_tr_b16 a[212:213], v2 offset:0
    v_cvt_pk_bf16_f32 v121, v122, v123
    v_mfma_f32_16x16x32_bf16 v[88:91], a[220:223], a[200:203], v[88:91]
    ds_read_b64_tr_b16 a[214:215], v2 offset:6144
    v_mul_f32 v194, v194, v49
    v_mfma_f32_16x16x32_bf16 v[56:59], a[224:227], a[108:111], v[56:59]
    ds_write2st64_b64 v101, v[208:209], v[104:105] offset0:24 offset1:36
    v_pk_mul_f32 v[212:213], v[212:213], v[50:51] op_sel_hi:[1,0]
    v_accvgpr_read_b32 v105, a5
    v_cvt_pk_bf16_f32 v164, v164, v165
    v_mfma_f32_16x16x32_bf16 v[56:59], a[228:231], a[112:115], v[56:59]
    ds_read_b64_tr_b16 a[216:217], v3 offset:0
    v_accvgpr_read_b32 v104, a4
    v_mul_f32 v105, v105, v51
    v_mfma_f32_16x16x32_bf16 v[44:47], a[244:247], v[26:29], v[44:47]
    v_mul_f32 v107, v107, v51
    v_mul_f32 v104, v104, v51
    v_cvt_pk_bf16_f32 v109, v110, v111
    v_cvt_pk_bf16_f32 v104, v104, v105
    v_accvgpr_read_b32 v106, a6
    v_mul_f32 v106, v106, v51
    v_pk_mul_f32 v[126:127], v[126:127], v[48:49] op_sel_hi:[1,0]
    v_fma_f32 v52, v52, s28, v9
    v_fma_f32 v86, v86, s28, v13
    v_mul_f32 v201, v201, v49
    v_pk_mul_f32 v[242:243], v[242:243], v[50:51] op_sel_hi:[1,0]
    v_fma_f32 v55, v55, s28, v9
    v_exp_f32 v52, v52
    v_pk_mul_f32 v[222:223], v[222:223], v[50:51] op_sel_hi:[1,0]
    v_pk_mul_f32 v[134:135], v[134:135], v[48:49] op_sel_hi:[1,0]
    v_pk_mul_f32 v[140:141], v[140:141], v[48:49] op_sel_hi:[1,0]
    v_pk_mul_f32 v[138:139], v[138:139], v[48:49] op_sel_hi:[1,0]
    v_cvt_pk_bf16_f32 v169, v170, v171
    v_pk_mul_f32 v[132:133], v[132:133], v[48:49] op_sel_hi:[1,0]
    v_pk_mul_f32 v[214:215], v[214:215], v[50:51] op_sel_hi:[1,0]
    v_mul_f32 v191, v191, v49
    v_accvgpr_read_b32 v110, a54
    v_mfma_f32_16x16x32_bf16 v[56:59], a[232:235], a[116:119], v[56:59]
    buffer_load_dwordx4 v6, s[4:7], s20 offen lds
    v_mfma_f32_16x16x32_bf16 v[64:67], a[224:227], a[132:135], v[64:67]
    v_mul_f32 v197, v197, v49
    v_accvgpr_read_b32 v111, a55
    v_fma_f32 v76, v76, s28, v12
    v_cvt_pk_bf16_f32 v212, v212, v213
    v_mfma_f32_16x16x32_bf16 v[64:67], a[228:231], a[136:139], v[64:67]
    ds_write_b64 v101, v[108:109] offset:24576
    v_accvgpr_read_b32 v109, a53
    v_cvt_pk_bf16_f32 v188, v188, v189
    v_pk_mul_f32 v[128:129], v[128:129], v[48:49] op_sel_hi:[1,0]
    v_cvt_pk_bf16_f32 v165, v166, v167
    v_cvt_pk_bf16_f32 v105, v106, v107
    v_pk_mul_f32 v[220:221], v[220:221], v[50:51] op_sel_hi:[1,0]
    v_accvgpr_read_b32 v108, a52
    v_pk_mul_f32 v[158:159], v[158:159], v[48:49] op_sel_hi:[1,0]
    v_xor_b32 v101, 32, v101
    v_pk_mul_f32 v[142:143], v[142:143], v[48:49] op_sel_hi:[1,0]
    v_pk_mul_f32 v[108:109], v[108:109], v[100:101] op_sel_hi:[1,0]
    v_pk_mul_f32 v[118:119], v[118:119], v[48:49] op_sel_hi:[1,0]
    v_cvt_pk_bf16_f32 v116, v116, v117
    v_cvt_pk_bf16_f32 v213, v214, v215
    v_pk_mul_f32 v[110:111], v[110:111], v[100:101] op_sel_hi:[1,0]
    v_cvt_pk_bf16_f32 v108, v108, v109
    v_mul_f32 v182, v182, v49
    v_pk_mul_f32 v[232:233], v[232:233], v[50:51] op_sel_hi:[1,0]
    v_fma_f32 v77, v77, s28, v12
    v_accvgpr_read_b32 v106, a10
    v_mul_f32 v207, v207, v49
    v_mfma_f32_16x16x32_bf16 v[64:67], a[232:235], a[140:143], v[64:67]
    ds_read_b64_tr_b16 a[218:219], v3 offset:6144
    v_cvt_pk_bf16_f32 v109, v110, v111
    v_mfma_f32_16x16x32_bf16 v[72:75], a[224:227], a[156:159], v[72:75]
    v_fma_f32 v53, v53, s28, v9
    v_accvgpr_read_b32 v107, a11
    v_cvt_pk_bf16_f32 v117, v118, v119
    v_mfma_f32_16x16x32_bf16 v[72:75], a[228:231], a[160:163], v[72:75]
    s_add_u32 s20, s20, 128
    ds_write2st64_b64 v101, v[116:117], v[164:165] offset0:0 offset1:12
    v_mfma_f32_16x16x32_bf16 v[72:75], a[232:235], a[164:167], v[72:75]
    ds_read_b64_tr_b16 a[220:221], v4 offset:0
    v_mul_f32 v106, v106, v51
    v_mfma_f32_16x16x32_bf16 v[80:83], a[224:227], a[180:183], v[80:83]
    ds_write2st64_b64 v101, v[212:213], v[104:105] offset0:24 offset1:36
    v_mfma_f32_16x16x32_bf16 v[80:83], a[228:231], a[184:187], v[80:83]
    ds_write_b64 v101, v[108:109] offset:24576
    v_cvt_pk_bf16_f32 v176, v176, v177
    v_fma_f32 v65, v65, s28, v10
    v_exp_f32 v60, v60
    v_mfma_f32_16x16x32_bf16 v[80:83], a[232:235], a[188:191], v[80:83]
    s_add_u32 m0, s22, 13312
    ds_read_b64_tr_b16 a[222:223], v4 offset:6144
    v_fma_f32 v56, v56, s28, v9
    v_cvt_pk_bf16_f32 v216, v216, v217
    v_mul_f32 v187, v187, v49
    v_mfma_f32_16x16x32_bf16 v[88:91], a[224:227], a[204:207], v[88:91]
    v_accvgpr_read_b32 v104, a8
    v_accvgpr_read_b32 v111, a59
    v_accvgpr_read_b32 v108, a56
    v_mul_f32 v104, v104, v51
    v_xor_b32 v101, 96, v101
    v_accvgpr_read_b32 v105, a9
    v_accvgpr_read_b32 v109, a57
    v_mfma_f32_16x16x32_bf16 v[88:91], a[228:231], a[208:211], v[88:91]
    ds_read_b64_tr_b16 a[228:229], v2 offset:1024
    v_cvt_pk_bf16_f32 v181, v182, v183
    v_fma_f32 v57, v57, s28, v9
    v_subrev_u32 v8, 28672, v8
    v_mfma_f32_16x16x32_bf16 v[88:91], a[232:235], v[92:95], v[88:91]
    s_waitcnt lgkmcnt(4)
    ds_read_b64_tr_b16 a[224:225], v5 offset:0
    v_exp_f32 v86, v86
    v_mfma_f32_16x16x32_bf16 v[112:115], a[212:215], v[14:17], 0
    buffer_load_dwordx4 v6, s[4:7], s20 offen lds
    v_cvt_pk_bf16_f32 v217, v218, v219
    v_cvt_pk_bf16_f32 v220, v220, v221
    v_exp_f32 v77, v77
    v_pk_mul_f32 v[148:149], v[148:149], v[48:49] op_sel_hi:[1,0]
    v_cvt_pk_bf16_f32 v204, v204, v205
    v_accvgpr_read_b32 v110, a58
    v_exp_f32 v63, v63
    v_pk_mul_f32 v[108:109], v[108:109], v[100:101] op_sel_hi:[1,0]
    v_pk_mul_f32 v[240:241], v[240:241], v[50:51] op_sel_hi:[1,0]
    v_exp_f32 v76, v76
    v_cvt_pk_bf16_f32 v136, v136, v137
    v_cvt_pk_bf16_f32 v200, v200, v201
    v_exp_f32 v61, v61
    v_fma_f32 v64, v64, s28, v10
    v_pk_mul_f32 v[124:125], v[124:125], v[48:49] op_sel_hi:[1,0]
    v_mul_f32 v107, v107, v51
    v_pk_mul_f32 v[230:231], v[230:231], v[50:51] op_sel_hi:[1,0]
    v_mul_f32 v192, v192, v49
    v_pk_mul_f32 v[110:111], v[110:111], v[100:101] op_sel_hi:[1,0]
    v_fma_f32 v82, v82, s28, v12
    v_fma_f32 v62, v62, s28, v10
    v_mul_f32 v105, v105, v51
    v_cvt_pk_bf16_f32 v108, v108, v109
    v_cvt_pk_bf16_f32 v124, v124, v125
    v_pk_mul_f32 v[152:153], v[152:153], v[48:49] op_sel_hi:[1,0]
    v_cvt_pk_bf16_f32 v236, v236, v237
    v_cvt_pk_bf16_f32 v196, v196, v197
    v_cvt_pk_bf16_f32 v104, v104, v105
    v_mfma_f32_16x16x32_bf16 v[160:163], a[212:215], v[20:23], 0
    v_cvt_pk_bf16_f32 v232, v232, v233
    v_exp_f32 v82, v82
    v_mfma_f32_16x16x32_bf16 v[208:211], a[212:215], v[26:29], 0
    ds_write2st64_b64 v101, v[120:121], v[168:169] offset0:0 offset1:12
    v_cvt_pk_bf16_f32 v105, v106, v107
    v_mfma_f32_16x16x32_bf16 a[0:3], a[212:215], v[32:35], 0
    ds_read_b64_tr_b16 a[226:227], v5 offset:6144
    v_cvt_pk_bf16_f32 v189, v190, v191
    v_fma_f32 v90, v90, s28, v13
    v_mfma_f32_16x16x32_bf16 a[48:51], a[212:215], v[38:41], 0
    ds_write2st64_b64 v101, v[216:217], v[104:105] offset0:24 offset1:36
    v_pk_mul_f32 v[130:131], v[130:131], v[48:49] op_sel_hi:[1,0]
    v_fma_f32 v58, v58, s28, v9
    v_accvgpr_read_b32 v104, a12
    v_accvgpr_read_b32 v106, a14
    v_mfma_f32_16x16x32_bf16 v[116:119], a[216:219], v[14:17], 0
    ds_read_b64_tr_b16 a[234:235], v3 offset:7168
    v_cvt_pk_bf16_f32 v109, v110, v111
    v_accvgpr_read_b32 v105, a13
    v_mfma_f32_16x16x32_bf16 v[164:167], a[216:219], v[20:23], 0
    ds_write_b64 v101, v[108:109] offset:24576
    v_exp_f32 v53, v53
    v_exp_f32 v57, v57
    v_fma_f32 v84, v84, s28, v13
    v_mfma_f32_16x16x32_bf16 v[212:215], a[216:219], v[26:29], 0
    s_add_u32 s20, s20, 128
    v_accvgpr_read_b32 v111, a63
    v_cvt_pk_bf16_f32 v185, v186, v187
    v_mfma_f32_16x16x32_bf16 a[4:7], a[216:219], v[32:35], 0
    s_add_u32 m0, s22, 14336
    v_cvt_pk_bf16_f32 v148, v148, v149
    v_mul_f32 v105, v105, v51
    v_accvgpr_read_b32 v108, a60
    v_cvt_pk_bf16_f32 v132, v132, v133
    v_mul_f32 v199, v199, v49
    v_cvt_pk_bf16_f32 v140, v140, v141
    v_pk_mul_f32 v[226:227], v[226:227], v[50:51] op_sel_hi:[1,0]
    v_cvt_pk_bf16_f32 v221, v222, v223
    v_accvgpr_read_b32 v109, a61
    v_mfma_f32_16x16x32_bf16 a[52:55], a[216:219], v[38:41], 0
    s_waitcnt lgkmcnt(2)
    ds_read_b64_tr_b16 a[230:231], v2 offset:7168
    v_cvt_pk_bf16_f32 v128, v128, v129
    v_mfma_f32_16x16x32_bf16 v[120:123], a[220:223], v[14:17], 0
    ds_read_b64_tr_b16 a[232:233], v3 offset:1024
    buffer_load_dwordx4 v6, s[4:7], s20 offen lds
    v_fma_f32 v89, v89, s28, v13
    v_fma_f32 v88, v88, s28, v13
    v_mul_f32 v104, v104, v51
    v_cvt_pk_bf16_f32 v137, v138, v139
    v_pk_mul_f32 v[238:239], v[238:239], v[50:51] op_sel_hi:[1,0]
    v_accvgpr_read_b32 v107, a15
    v_mul_f32 v106, v106, v51
    v_accvgpr_read_b32 v110, a62
    v_pk_mul_f32 v[108:109], v[108:109], v[100:101] op_sel_hi:[1,0]
    v_pk_mul_f32 v[110:111], v[110:111], v[100:101] op_sel_hi:[1,0]
    v_pk_mul_f32 v[250:251], v[250:251], v[50:51] op_sel_hi:[1,0]
    v_fma_f32 v59, v59, s28, v9
    v_xor_b32 v101, 32, v101
    v_cvt_pk_bf16_f32 v125, v126, v127
    v_pk_mul_f32 v[252:253], v[252:253], v[50:51] op_sel_hi:[1,0]
    v_cvt_pk_bf16_f32 v177, v178, v179
    v_cvt_pk_bf16_f32 v108, v108, v109
    v_cvt_pk_bf16_f32 v104, v104, v105
    v_exp_f32 v70, v70
    v_fma_f32 v78, v78, s28, v12
    v_mfma_f32_16x16x32_bf16 v[168:171], a[220:223], v[20:23], 0
    ds_read_b64_tr_b16 a[212:213], v4 offset:1024
    v_mul_f32 v107, v107, v51
    v_cvt_pk_bf16_f32 v133, v134, v135
    v_cvt_pk_bf16_f32 v105, v106, v107
    v_accvgpr_read_b32 v107, a19
    v_cvt_pk_bf16_f32 v109, v110, v111
    v_mul_f32 v193, v193, v49
    v_mfma_f32_16x16x32_bf16 v[216:219], a[220:223], v[26:29], 0
    ds_write2st64_b64 v101, v[124:125], v[172:173] offset0:0 offset1:12
    v_mfma_f32_16x16x32_bf16 a[8:11], a[220:223], v[32:35], 0
    ds_write2st64_b64 v101, v[220:221], v[104:105] offset0:24 offset1:36
    v_accvgpr_read_b32 v105, a17
    v_mul_f32 v107, v107, v51
    v_accvgpr_read_b32 v104, a16
    v_mul_f32 v104, v104, v51
    v_fma_f32 v91, v91, s28, v13
    v_mfma_f32_16x16x32_bf16 a[56:59], a[220:223], v[38:41], 0
    ds_read_b64_tr_b16 a[222:223], v2 offset:8192
    v_mul_f32 v105, v105, v51
    v_fma_f32 v72, v72, s28, v11
    v_mfma_f32_16x16x32_bf16 v[124:127], a[224:227], v[14:17], 0
    ds_write_b64 v101, v[108:109] offset:24576
    v_mfma_f32_16x16x32_bf16 v[44:47], a[248:251], v[32:35], v[44:47]
    v_cvt_pk_bf16_f32 v240, v240, v241
    v_cvt_pk_bf16_f32 v141, v142, v143
    v_accvgpr_read_b32 v106, a18
    v_accvgpr_read_b32 v111, a67
    v_cvt_pk_bf16_f32 v225, v226, v227
    v_accvgpr_read_b32 v109, a65
    v_cvt_pk_bf16_f32 v36, v76, v77
    v_mfma_f32_16x16x32_bf16 v[172:175], a[224:227], v[20:23], 0
    ds_read_b64_tr_b16 a[216:217], v5 offset:1024
    v_fma_f32 v75, v75, s28, v11
    v_accvgpr_read_b32 v110, a66
    v_cvt_pk_bf16_f32 v241, v242, v243
    v_accvgpr_read_b32 v108, a64
    v_pk_mul_f32 v[234:235], v[234:235], v[50:51] op_sel_hi:[1,0]
    v_fma_f32 v85, v85, s28, v13
    v_pk_mul_f32 v[108:109], v[108:109], v[100:101] op_sel_hi:[1,0]
    v_cvt_pk_bf16_f32 v104, v104, v105
    v_xor_b32 v101, 96, v101
    v_pk_mul_f32 v[248:249], v[248:249], v[50:51] op_sel_hi:[1,0]
    v_pk_mul_f32 v[110:111], v[110:111], v[100:101] op_sel_hi:[1,0]
    v_mul_f32 v106, v106, v51
    v_cvt_pk_bf16_f32 v105, v106, v107
    v_cvt_pk_bf16_f32 v108, v108, v109
    v_cvt_pk_bf16_f32 v129, v130, v131
    v_cvt_pk_bf16_f32 v192, v192, v193
    v_mfma_f32_16x16x32_bf16 v[220:223], a[224:227], v[26:29], 0
    ds_read_b128 v[96:99], v8 offset:0
    v_cvt_pk_bf16_f32 v109, v110, v111
    v_mfma_f32_16x16x32_bf16 a[12:15], a[224:227], v[32:35], 0
    ds_write2st64_b64 v101, v[128:129], v[176:177] offset0:4 offset1:16
    v_cvt_pk_bf16_f32 v229, v230, v231
    v_accvgpr_read_b32 v107, a23
    v_mfma_f32_16x16x32_bf16 v[44:47], a[252:255], v[38:41], v[44:47]
    ds_write2st64_b64 v101, v[224:225], v[104:105] offset0:28 offset1:40
    v_accvgpr_read_b32 v106, a22
    v_mfma_f32_16x16x32_bf16 a[60:63], a[224:227], v[38:41], 0
    s_waitcnt lgkmcnt(3)
    ds_write_b64 v101, v[108:109] offset:26624
    v_accvgpr_read_b32 v104, a20
    v_accvgpr_read_b32 v109, a69
    v_mfma_f32_16x16x32_bf16 v[128:131], a[228:231], v[14:17], 0
    ds_read_b64_tr_b16 a[214:215], v4 offset:7168
    v_exp_f32 v62, v62
    v_accvgpr_read_b32 v105, a21
    v_exp_f32 v56, v56
    v_accvgpr_read_b32 v108, a68
    v_mfma_f32_16x16x32_bf16 v[176:179], a[228:231], v[20:23], 0
    ds_read_b64_tr_b16 a[224:225], v3 offset:2048
    v_cvt_pk_bf16_f32 v252, v252, v253
    v_xor_b32 v101, 32, v101
    v_exp_f32 v85, v85
    v_mul_f32 v105, v105, v51
    v_pk_mul_f32 v[108:109], v[108:109], v[100:101] op_sel_hi:[1,0]
    v_mul_f32 v104, v104, v51
    v_accvgpr_read_b32 v111, a71
    v_cvt_pk_bf16_f32 v104, v104, v105
    v_mfma_f32_16x16x32_bf16 v[224:227], a[228:231], v[26:29], 0
    ds_read_b64_tr_b16 a[218:219], v5 offset:7168
    v_fma_f32 v74, v74, s28, v11
    v_accvgpr_read_b32 v110, a70
    v_mul_f32 v107, v107, v51
    v_cvt_pk_bf16_f32 v108, v108, v109
    v_pk_mul_f32 v[110:111], v[110:111], v[100:101] op_sel_hi:[1,0]
    v_cvt_pk_bf16_f32 v233, v234, v235
    v_cvt_pk_bf16_f32 v109, v110, v111
    v_mul_f32 v106, v106, v51
    v_cvt_pk_bf16_f32 v105, v106, v107
    v_mfma_f32_16x16x32_bf16 a[16:19], a[228:231], v[32:35], 0
    ds_write2st64_b64 v101, v[132:133], v[180:181] offset0:4 offset1:16
    v_mfma_f32_16x16x32_bf16 a[64:67], a[228:231], v[38:41], 0
    ds_write2st64_b64 v101, v[228:229], v[104:105] offset0:28 offset1:40
    v_accvgpr_read_b32 v107, a27
    v_pk_mul_f32 v[146:147], v[146:147], v[48:49] op_sel_hi:[1,0]
    v_accvgpr_read_b32 v106, a26
    v_accvgpr_read_b32 v104, a24
    v_mfma_f32_16x16x32_bf16 v[132:135], a[232:235], v[14:17], 0
    ds_write_b64 v101, v[108:109] offset:26624
    v_exp_f32 v69, v69
    v_mul_f32 v104, v104, v51
    v_mfma_f32_16x16x32_bf16 v[180:183], a[232:235], v[20:23], 0
    ds_read_b64_tr_b16 a[220:221], v2 offset:2048
    v_accvgpr_read_b32 v109, a73
    v_accvgpr_read_b32 v111, a75
    v_accvgpr_read_b32 v105, a25
    v_accvgpr_read_b32 v108, a72
    v_exp_f32 v84, v84
    v_xor_b32 v101, 96, v101
    v_pk_mul_f32 v[108:109], v[108:109], v[100:101] op_sel_hi:[1,0]
    v_mul_f32 v107, v107, v51
    v_pk_mul_f32 v[150:151], v[150:151], v[48:49] op_sel_hi:[1,0]
    v_accvgpr_read_b32 v110, a74
    v_cvt_pk_bf16_f32 v108, v108, v109
    v_mfma_f32_16x16x32_bf16 v[228:231], a[232:235], v[26:29], 0
    ds_write2st64_b64 v101, v[136:137], v[184:185] offset0:4 offset1:16
    v_cvt_pk_bf16_f32 v149, v150, v151
    v_mul_f32 v105, v105, v51
    v_cvt_pk_bf16_f32 v42, v84, v85
    v_mul_f32 v106, v106, v51
    v_cvt_pk_bf16_f32 v30, v68, v69
    v_pk_mul_f32 v[110:111], v[110:111], v[100:101] op_sel_hi:[1,0]
    v_cvt_pk_bf16_f32 v104, v104, v105
    v_cvt_pk_bf16_f32 v105, v106, v107
    v_accvgpr_read_b32 v106, a30
    v_mfma_f32_16x16x32_bf16 a[20:23], a[232:235], v[32:35], 0
    ds_read_b64_tr_b16 a[228:229], v4 offset:2048
    v_cvt_pk_bf16_f32 v201, v202, v203
    v_cvt_pk_bf16_f32 v152, v152, v153
    v_cvt_pk_bf16_f32 v109, v110, v111
    v_mfma_f32_16x16x32_bf16 a[68:71], a[232:235], v[38:41], 0
    s_waitcnt lgkmcnt(3)
    ds_write2st64_b64 v101, v[232:233], v[104:105] offset0:28 offset1:40
    v_mfma_f32_16x16x32_bf16 v[136:139], a[212:215], v[14:17], 0
    ds_write_b64 v101, v[108:109] offset:26624
    v_accvgpr_read_b32 v108, a76
    v_xor_b32 v101, 32, v101
    v_fma_f32 v83, v83, s28, v12
    v_fma_f32 v73, v73, s28, v11
    v_accvgpr_read_b32 v111, a79
    v_accvgpr_read_b32 v110, a78
    v_accvgpr_read_b32 v109, a77
    v_accvgpr_read_b32 v104, a28
    v_accvgpr_read_b32 v105, a29
    v_mul_f32 v106, v106, v51
    v_mfma_f32_16x16x32_bf16 v[184:187], a[212:215], v[20:23], 0
    buffer_store_dwordx4 v[96:99], v102, s[16:19], s67 offen offset:0 nt
    ds_read_b64_tr_b16 a[232:233], v5 offset:2048
    v_exp_f32 v55, v55
    v_pk_mul_f32 v[108:109], v[108:109], v[100:101] op_sel_hi:[1,0]
    v_mul_f32 v105, v105, v51
    v_mul_f32 v104, v104, v51
    v_pk_mul_f32 v[110:111], v[110:111], v[100:101] op_sel_hi:[1,0]
    v_fma_f32 v66, v66, s28, v10
    v_exp_f32 v75, v75
    v_accvgpr_read_b32 v107, a31
    v_mfma_f32_16x16x32_bf16 v[232:235], a[212:215], v[26:29], 0
    ds_write2st64_b64 v101, v[140:141], v[188:189] offset0:4 offset1:16
    v_cvt_pk_bf16_f32 v104, v104, v105
    v_pk_mul_f32 v[244:245], v[244:245], v[50:51] op_sel_hi:[1,0]
    v_mul_f32 v107, v107, v51
    v_cvt_pk_bf16_f32 v193, v194, v195
    v_mfma_f32_16x16x32_bf16 a[24:27], a[212:215], v[32:35], 0
    ds_read_b64_tr_b16 a[234:235], v5 offset:8192
    v_cvt_pk_bf16_f32 v237, v238, v239
    v_mfma_f32_16x16x32_bf16 a[72:75], a[212:215], v[38:41], 0
    ds_read_b128 v[96:99], v8 offset:1024
    v_cvt_pk_bf16_f32 v145, v146, v147
    v_cvt_pk_bf16_f32 v105, v106, v107
    v_cvt_pk_bf16_f32 v108, v108, v109
    v_mfma_f32_16x16x32_bf16 v[140:143], a[216:219], v[14:17], 0
    ds_write2st64_b64 v101, v[236:237], v[104:105] offset0:28 offset1:40
    v_exp_f32 v71, v71
    v_accvgpr_read_b32 v106, a34
    v_cvt_pk_bf16_f32 v109, v110, v111
    v_accvgpr_read_b32 v104, a32
    v_mfma_f32_16x16x32_bf16 v[188:191], a[216:219], v[20:23], 0
    ds_read_b64_tr_b16 a[226:227], v3 offset:8192
    ds_read_b64_tr_b16 a[230:231], v4 offset:8192
    v_cvt_pk_bf16_f32 v248, v248, v249
    v_accvgpr_read_b32 v110, a82
    v_accvgpr_read_b32 v105, a33
    v_exp_f32 v78, v78
    v_mfma_f32_16x16x32_bf16 v[236:239], a[216:219], v[26:29], 0
    s_add_u32 s20, s20, 12032
    ds_write_b64 v101, v[108:109] offset:26624
    v_xor_b32 v101, 96, v101
    v_accvgpr_read_b32 v107, a35
    v_accvgpr_read_b32 v109, a81
    v_mul_f32 v106, v106, v51
    v_accvgpr_read_b32 v108, a80
    v_accvgpr_read_b32 v111, a83
    v_mfma_f32_16x16x32_bf16 a[28:31], a[216:219], v[32:35], 0
    s_add_u32 s39, s39, 12288
    ds_write2st64_b64 v101, v[144:145], v[192:193] offset0:8 offset1:20
    v_cvt_pk_bf16_f32 v37, v78, v79
    v_mul_f32 v105, v105, v51
    v_pk_mul_f32 v[108:109], v[108:109], v[100:101] op_sel_hi:[1,0]
    v_mul_f32 v104, v104, v51
    v_cvt_pk_bf16_f32 v108, v108, v109
    v_cvt_pk_bf16_f32 v104, v104, v105
    v_cvt_pk_bf16_f32 v197, v198, v199
    v_pk_mul_f32 v[110:111], v[110:111], v[100:101] op_sel_hi:[1,0]
    v_mul_f32 v107, v107, v51
    v_cvt_pk_bf16_f32 v244, v244, v245
    v_pk_mul_f32 v[156:157], v[156:157], v[48:49] op_sel_hi:[1,0]
    v_cvt_pk_bf16_f32 v105, v106, v107
    v_cvt_pk_bf16_f32 v109, v110, v111
    v_mfma_f32_16x16x32_bf16 a[76:79], a[216:219], v[38:41], 0
    s_waitcnt vmcnt(7) lgkmcnt(2)
    ds_write2st64_b64 v101, v[240:241], v[104:105] offset0:32 offset1:44
    v_mfma_f32_16x16x32_bf16 v[144:147], a[220:223], v[14:17], 0
    buffer_store_dwordx4 v[96:99], v103, s[16:19], s67 offen offset:0 nt
    s_barrier
    ds_write_b64 v101, v[108:109] offset:0
    v_accvgpr_read_b32 v110, a86
    v_fma_f32 v87, v87, s28, v13
    v_mfma_f32_16x16x32_bf16 v[192:195], a[220:223], v[20:23], 0
    ds_read_b128 a[212:215], v0 offset:0
    v_xor_b32 v101, 32, v101
    v_accvgpr_read_b32 v109, a85
    v_accvgpr_read_b32 v111, a87
    v_accvgpr_read_b32 v107, a39
    v_pk_mul_f32 v[110:111], v[110:111], v[100:101] op_sel_hi:[1,0]
    v_cvt_pk_bf16_f32 v249, v250, v251
    v_accvgpr_read_b32 v104, a36
    v_accvgpr_read_b32 v106, a38
    v_accvgpr_read_b32 v108, a84
    v_cvt_pk_bf16_f32 v245, v246, v247
    v_accvgpr_read_b32 v105, a37
    v_mul_f32 v104, v104, v51
    v_pk_mul_f32 v[254:255], v[254:255], v[50:51] op_sel_hi:[1,0]
    v_pk_mul_f32 v[154:155], v[154:155], v[48:49] op_sel_hi:[1,0]
    v_mul_f32 v106, v106, v51
    v_pk_mul_f32 v[108:109], v[108:109], v[100:101] op_sel_hi:[1,0]
    v_mul_f32 v107, v107, v51
    v_mul_f32 v105, v105, v51
    v_cvt_pk_bf16_f32 v18, v52, v53
    v_cvt_pk_bf16_f32 v108, v108, v109
    v_cvt_pk_bf16_f32 v104, v104, v105
    v_cvt_pk_bf16_f32 v25, v62, v63
    v_cvt_pk_bf16_f32 v109, v110, v111
    v_fma_f32 v67, v67, s28, v10
    v_mfma_f32_16x16x32_bf16 v[240:243], a[220:223], v[26:29], 0
    ds_read_b128 a[216:219], v1 offset:0
    v_accvgpr_read_b32 v111, a91
    v_mfma_f32_16x16x32_bf16 a[32:35], a[220:223], v[32:35], 0
    ds_write2st64_b64 v101, v[148:149], v[196:197] offset0:8 offset1:20
    v_cvt_pk_bf16_f32 v105, v106, v107
    v_mfma_f32_16x16x32_bf16 a[80:83], a[220:223], v[38:41], 0
    ds_write2st64_b64 v101, v[244:245], v[104:105] offset0:32 offset1:44
    v_accvgpr_read_b32 v104, a40
    v_mul_f32 v104, v104, v51
    v_accvgpr_read_b32 v110, a90
    v_accvgpr_read_b32 v106, a42
    v_accvgpr_read_b32 v107, a43
    v_mfma_f32_16x16x32_bf16 v[148:151], a[224:227], v[14:17], 0
    s_add_u32 m0, s22, 24576
    ds_write_b64 v101, v[108:109] offset:0
    v_accvgpr_read_b32 v108, a88
    v_cvt_pk_bf16_f32 v205, v206, v207
    v_accvgpr_read_b32 v109, a89
    v_cvt_pk_bf16_f32 v156, v156, v157
    v_cvt_pk_bf16_f32 v157, v158, v159
    v_cvt_pk_bf16_f32 v153, v154, v155
    v_accvgpr_read_b32 v105, a41
    v_xor_b32 v101, 96, v101
    v_mul_f32 v106, v106, v51
    v_pk_mul_f32 v[110:111], v[110:111], v[100:101] op_sel_hi:[1,0]
    v_mul_f32 v107, v107, v51
    v_cvt_pk_bf16_f32 v24, v60, v61
    v_pk_mul_f32 v[108:109], v[108:109], v[100:101] op_sel_hi:[1,0]
    v_mul_f32 v105, v105, v51
    v_cvt_pk_bf16_f32 v108, v108, v109
    v_mfma_f32_16x16x32_bf16 v[196:199], a[224:227], v[20:23], 0
    ds_write2st64_b64 v101, v[152:153], v[200:201] offset0:8 offset1:20
    v_cvt_pk_bf16_f32 v104, v104, v105
    v_cvt_pk_bf16_f32 v105, v106, v107
    v_accvgpr_read_b32 v106, a46
    v_mfma_f32_16x16x32_bf16 v[244:247], a[224:227], v[26:29], 0
    ds_read_b128 v[96:99], v8 offset:2048
    v_mul_f32 v106, v106, v51
    v_cvt_pk_bf16_f32 v253, v254, v255
    v_cvt_pk_bf16_f32 v109, v110, v111
    v_mfma_f32_16x16x32_bf16 a[36:39], a[224:227], v[32:35], 0
    buffer_load_dwordx4 v6, s[8:11], s21 offen lds
    ds_write2st64_b64 v101, v[248:249], v[104:105] offset0:32 offset1:44
    v_accvgpr_read_b32 v105, a45
    v_accvgpr_read_b32 v107, a47
    v_mfma_f32_16x16x32_bf16 a[84:87], a[224:227], v[38:41], 0
    s_add_u32 s21, s21, 128
    ds_write_b64 v101, v[108:109] offset:0
    v_accvgpr_read_b32 v104, a44
    v_mfma_f32_16x16x32_bf16 v[152:155], a[228:231], v[14:17], 0
    v_mul_f32 v105, v105, v51
    v_accvgpr_read_b32 v109, a93
    v_mfma_f32_16x16x32_bf16 v[200:203], a[228:231], v[20:23], 0
    v_xor_b32 v101, 32, v101
    v_mul_f32 v104, v104, v51
    v_mfma_f32_16x16x32_bf16 v[248:251], a[228:231], v[26:29], 0
    ds_read_b128 a[220:223], v0 offset:1024
    v_accvgpr_read_b32 v110, a94
    v_mul_f32 v107, v107, v51
    v_cvt_pk_bf16_f32 v104, v104, v105
    v_mfma_f32_16x16x32_bf16 a[40:43], a[228:231], v[32:35], 0
    ds_write2st64_b64 v101, v[156:157], v[204:205] offset0:8 offset1:20
    v_mfma_f32_16x16x32_bf16 a[88:91], a[228:231], v[38:41], 0
    s_add_u32 m0, s22, 25600
    v_cvt_pk_bf16_f32 v105, v106, v107
    v_accvgpr_read_b32 v108, a92
    v_mfma_f32_16x16x32_bf16 v[156:159], a[232:235], v[14:17], 0
    buffer_load_dwordx4 v6, s[8:11], s21 offen lds
    v_mfma_f32_16x16x32_bf16 v[204:207], a[232:235], v[20:23], 0
    ds_write2st64_b64 v101, v[252:253], v[104:105] offset0:32 offset1:44
    v_mfma_f32_16x16x32_bf16 v[252:255], a[232:235], v[26:29], 0
    s_add_u32 s21, s21, 128
    v_exp_f32 v54, v54
    v_mfma_f32_16x16x32_bf16 a[44:47], a[232:235], v[32:35], 0
    s_add_u32 m0, s22, 26624
    v_cvt_pk_bf16_f32 v19, v54, v55
    v_accvgpr_read_b32 v111, a95
    v_mfma_f32_16x16x32_bf16 a[92:95], a[232:235], v[38:41], 0
    s_waitcnt lgkmcnt(3)
    ds_read_b128 a[232:235], v1 offset:2048
    v_exp_f32 v89, v89
    v_mfma_f32_16x16x32_bf16 v[52:55], a[212:215], a[96:99], 0
    buffer_load_dwordx4 v6, s[8:11], s21 offen lds
    v_mfma_f32_16x16x32_bf16 v[52:55], a[216:219], a[100:103], v[52:55]
    s_waitcnt lgkmcnt(2)
    v_exp_f32 v59, v59
    v_mfma_f32_16x16x32_bf16 v[52:55], a[220:223], a[104:107], v[52:55]
    s_add_u32 s21, s21, 12032
    v_exp_f32 v58, v58
    v_mfma_f32_16x16x32_bf16 v[60:63], a[212:215], a[120:123], 0
    v_exp_f32 v87, v87
    v_mfma_f32_16x16x32_bf16 v[60:63], a[216:219], a[124:127], v[60:63]
    ds_read_b128 a[224:227], v1 offset:1024
    v_cvt_pk_bf16_f32 v31, v70, v71
    v_mfma_f32_16x16x32_bf16 v[60:63], a[220:223], a[128:131], v[60:63]
    s_add_u32 s56, s67, 128
    v_exp_f32 v72, v72
    v_mfma_f32_16x16x32_bf16 v[68:71], a[212:215], a[144:147], 0
    ds_read_b128 a[228:231], v0 offset:2048
    v_cvt_pk_bf16_f32 v16, v56, v57
    v_mfma_f32_16x16x32_bf16 v[68:71], a[216:219], a[148:151], v[68:71]
    s_add_u32 s58, s33, 128
    v_cvt_pk_bf16_f32 v17, v58, v59
    v_cvt_pk_bf16_f32 v43, v86, v87
    v_mfma_f32_16x16x32_bf16 v[68:71], a[220:223], a[152:155], v[68:71]
    v_exp_f32 v74, v74
    v_mfma_f32_16x16x32_bf16 v[76:79], a[212:215], a[168:171], 0
    s_add_u32 m0, s38, 2048
    v_exp_f32 v66, v66
    v_mfma_f32_16x16x32_bf16 v[76:79], a[216:219], a[172:175], v[76:79]
    buffer_load_dwordx4 v6, s[12:15], s58 offen nt lds
    v_mfma_f32_16x16x32_bf16 v[48:51], a[236:239], v[16:19], v[44:47]
    v_exp_f32 v65, v65
    v_mfma_f32_16x16x32_bf16 v[76:79], a[220:223], a[176:179], v[76:79]
    buffer_store_dwordx4 v[96:99], v102, s[16:19], s56 offen offset:0 nt
    s_nop 0
    ds_read_b128 v[96:99], v8 offset:3072
    v_pk_mul_f32 v[108:109], v[108:109], v[100:101] op_sel_hi:[1,0]
    v_pk_mul_f32 v[110:111], v[110:111], v[100:101] op_sel_hi:[1,0]
    v_cvt_pk_bf16_f32 v29, v74, v75
    v_fma_f32 v81, v81, s28, v12
    v_mfma_f32_16x16x32_bf16 v[84:87], a[212:215], a[192:195], 0
    v_exp_f32 v73, v73
    v_mfma_f32_16x16x32_bf16 v[84:87], a[216:219], a[196:199], v[84:87]
    v_exp_f32 v83, v83
    v_mfma_f32_16x16x32_bf16 v[84:87], a[220:223], a[200:203], v[84:87]
    s_waitcnt lgkmcnt(1)
    v_exp_f32 v67, v67
    v_mfma_f32_16x16x32_bf16 v[52:55], a[224:227], a[108:111], v[52:55]
    v_exp_f32 v91, v91
    v_mfma_f32_16x16x32_bf16 v[52:55], a[228:231], a[112:115], v[52:55]
    v_cvt_pk_bf16_f32 v28, v72, v73
    v_cvt_pk_bf16_f32 v23, v66, v67
    v_mfma_f32_16x16x32_bf16 v[52:55], a[232:235], a[116:119], v[52:55]
    s_add_u32 m0, s38, 3072
    v_exp_f32 v90, v90
    v_mfma_f32_16x16x32_bf16 v[60:63], a[224:227], a[132:135], v[60:63]
    ds_read_b128 a[212:215], v0 offset:6144
    v_cvt_pk_bf16_f32 v108, v108, v109
    v_mfma_f32_16x16x32_bf16 v[60:63], a[228:231], a[136:139], v[60:63]
    v_cvt_pk_bf16_f32 v109, v110, v111
    v_fma_f32 v80, v80, s28, v12
    v_mfma_f32_16x16x32_bf16 v[60:63], a[232:235], a[140:143], v[60:63]
    s_waitcnt lgkmcnt(1)
    ds_read_b128 a[216:219], v1 offset:6144
    buffer_load_dwordx4 v7, s[12:15], s58 offen nt lds
    v_mfma_f32_16x16x32_bf16 v[68:71], a[224:227], a[156:159], v[68:71]
    buffer_store_dwordx4 v[96:99], v103, s[16:19], s56 offen offset:0 nt
    ds_write_b64 v101, v[108:109] offset:0
    v_mfma_f32_16x16x32_bf16 v[68:71], a[228:231], a[160:163], v[68:71]
    ds_read_b128 v[96:99], v8 offset:0
    v_mfma_f32_16x16x32_bf16 v[68:71], a[232:235], a[164:167], v[68:71]
    v_exp_f32 v64, v64
    v_mfma_f32_16x16x32_bf16 v[76:79], a[224:227], a[180:183], v[76:79]
    ds_read_b128 a[220:223], v0 offset:7168
    v_cvt_pk_bf16_f32 v22, v64, v65
    v_mfma_f32_16x16x32_bf16 v[76:79], a[228:231], a[184:187], v[76:79]
    v_exp_f32 v80, v80
    v_mfma_f32_16x16x32_bf16 v[48:51], a[240:243], v[22:25], v[48:51]
    v_exp_f32 v81, v81
    v_mfma_f32_16x16x32_bf16 v[76:79], a[232:235], a[188:191], v[76:79]
    v_cvt_pk_bf16_f32 v34, v80, v81
    v_mfma_f32_16x16x32_bf16 v[48:51], a[244:247], v[28:31], v[48:51]
    s_add_u32 s57, s67, 24832
    v_mfma_f32_16x16x32_bf16 v[84:87], a[224:227], a[204:207], v[84:87]
    v_exp_f32 v88, v88
    v_mfma_f32_16x16x32_bf16 v[84:87], a[228:231], a[208:211], v[84:87]
    v_cvt_pk_bf16_f32 v35, v82, v83
    v_cvt_pk_bf16_f32 v41, v90, v91
    v_mfma_f32_16x16x32_bf16 v[84:87], a[232:235], v[92:95], v[84:87]
    v_cvt_pk_bf16_f32 v40, v88, v89
    s_add_u32 m0, s38, 0
    v_mfma_f32_16x16x32_bf16 v[48:51], a[248:251], v[34:37], v[48:51]
    ds_read_b128 a[228:231], v0 offset:8192
    v_mfma_f32_16x16x32_bf16 v[48:51], a[252:255], v[40:43], v[48:51]
    s_waitcnt lgkmcnt(2)
    ds_read_b128 a[224:227], v1 offset:7168
    v_mfma_f32_16x16x32_bf16 v[56:59], a[212:215], a[96:99], 0
    buffer_load_dwordx4 v6, s[12:15], s33 offen nt lds
    v_mfma_f32_16x16x32_bf16 v[56:59], a[216:219], a[100:103], v[56:59]
    buffer_store_dwordx4 v[96:99], v102, s[16:19], s57 offen offset:0 nt
    s_nop 1
    v_cmp_lt_f32 vcc, s29, v48
    s_add_u32 m0, s38, 1024
    s_waitcnt lgkmcnt(2)
    v_mfma_f32_16x16x32_bf16 v[56:59], a[220:223], a[104:107], v[56:59]
    ds_read_b128 v[96:99], v8 offset:1024
    v_add_u32 v8, 4096, v8
    v_mfma_f32_16x16x32_bf16 v[64:67], a[212:215], a[120:123], 0
    s_cbranch_vccnz L_rs_tr55d
L_ret_tr55d:
    v_fma_f32 v60, v60, s28, v10
    v_mfma_f32_16x16x32_bf16 v[64:67], a[216:219], a[124:127], v[64:67]
    ds_read_b128 a[232:235], v1 offset:8192
    v_mfma_f32_16x16x32_bf16 v[64:67], a[220:223], a[128:131], v[64:67]
    v_exp_f32 v60, v60
    v_mfma_f32_16x16x32_bf16 v[72:75], a[212:215], a[144:147], 0
    v_fma_f32 v54, v54, s28, v9
    v_fma_f32 v52, v52, s28, v9
    v_mfma_f32_16x16x32_bf16 v[72:75], a[216:219], a[148:151], v[72:75]
    v_fma_f32 v61, v61, s28, v10
    v_mfma_f32_16x16x32_bf16 v[72:75], a[220:223], a[152:155], v[72:75]
    v_exp_f32 v54, v54
    v_mfma_f32_16x16x32_bf16 v[80:83], a[212:215], a[168:171], 0
    v_exp_f32 v52, v52
    v_mfma_f32_16x16x32_bf16 v[80:83], a[216:219], a[172:175], v[80:83]
    v_fma_f32 v63, v63, s28, v10
    v_fma_f32 v55, v55, s28, v9
    v_mfma_f32_16x16x32_bf16 v[80:83], a[220:223], a[176:179], v[80:83]
    v_exp_f32 v63, v63
    v_mfma_f32_16x16x32_bf16 v[88:91], a[212:215], a[192:195], 0
    s_waitcnt lgkmcnt(1)
    buffer_load_dwordx4 v7, s[12:15], s33 offen nt lds
    v_mfma_f32_16x16x32_bf16 v[88:91], a[216:219], a[196:199], v[88:91]
    buffer_store_dwordx4 v[96:99], v103, s[16:19], s57 offen offset:0 nt
    s_waitcnt vmcnt(16) lgkmcnt(0)
    s_barrier
    v_fma_f32 v62, v62, s28, v10
    v_mfma_f32_16x16x32_bf16 v[88:91], a[220:223], a[200:203], v[88:91]
    ds_read_b64_tr_b16 a[212:213], v2 offset:18432
    s_add_u32 m0, s22, 0
    v_mfma_f32_16x16x32_bf16 v[56:59], a[224:227], a[108:111], v[56:59]
    ds_read_b64_tr_b16 a[214:215], v2 offset:12288
    v_mfma_f32_16x16x32_bf16 v[56:59], a[228:231], a[112:115], v[56:59]
    v_exp_f32 v61, v61
    v_mfma_f32_16x16x32_bf16 v[56:59], a[232:235], a[116:119], v[56:59]
    v_fma_f32 v53, v53, s28, v9
    v_mfma_f32_16x16x32_bf16 v[64:67], a[224:227], a[132:135], v[64:67]
    buffer_load_dwordx4 v6, s[4:7], s20 offen lds
    v_mfma_f32_16x16x32_bf16 v[64:67], a[228:231], a[136:139], v[64:67]
    s_add_u32 s20, s20, 128
    s_add_u32 m0, s22, 1024
    ds_read_b64_tr_b16 a[216:217], v3 offset:18432
    v_mfma_f32_16x16x32_bf16 v[64:67], a[232:235], a[140:143], v[64:67]
    v_exp_f32 v62, v62
    v_mfma_f32_16x16x32_bf16 v[72:75], a[224:227], a[156:159], v[72:75]
    ds_read_b64_tr_b16 a[218:219], v3 offset:12288
    v_mfma_f32_16x16x32_bf16 v[72:75], a[228:231], a[160:163], v[72:75]
    v_exp_f32 v53, v53
    v_mfma_f32_16x16x32_bf16 v[72:75], a[232:235], a[164:167], v[72:75]
    buffer_load_dwordx4 v6, s[4:7], s20 offen lds
    v_mfma_f32_16x16x32_bf16 v[80:83], a[224:227], a[180:183], v[80:83]
    s_add_u32 s20, s20, 128
    ds_read_b64_tr_b16 a[220:221], v4 offset:18432
    v_cvt_pk_bf16_f32 v20, v60, v61
    v_mfma_f32_16x16x32_bf16 v[80:83], a[228:231], a[184:187], v[80:83]
    ds_read_b64_tr_b16 a[222:223], v4 offset:12288
    v_cvt_pk_bf16_f32 v21, v62, v63
    v_mfma_f32_16x16x32_bf16 v[80:83], a[232:235], a[188:191], v[80:83]
    v_exp_f32 v55, v55
    v_mfma_f32_16x16x32_bf16 v[88:91], a[224:227], a[204:207], v[88:91]
    s_add_u32 m0, s22, 2048
    ds_read_b64_tr_b16 a[224:225], v5 offset:18432
    v_cvt_pk_bf16_f32 v15, v54, v55
    v_mfma_f32_16x16x32_bf16 v[88:91], a[228:231], a[208:211], v[88:91]
    buffer_load_dwordx4 v6, s[4:7], s20 offen lds
    v_mfma_f32_16x16x32_bf16 v[88:91], a[232:235], v[92:95], v[88:91]
    s_add_u32 s20, s20, 12032
    ds_read_b64_tr_b16 a[226:227], v5 offset:12288
    v_cvt_pk_bf16_f32 v14, v52, v53
    s_branch L_loop5
L_loop4:
    .p2align 6
L_loop4w0:
    s_waitcnt lgkmcnt(6)
    v_mfma_f32_16x16x32_bf16 v[112:115], a[212:215], v[16:19], v[112:115]
    ds_read_b64_tr_b16 a[234:235], v3 offset:13312
    v_fma_f32 v77, v77, s28, v12
    v_mfma_f32_16x16x32_bf16 v[160:163], a[212:215], v[22:25], v[160:163]
    v_fma_f32 v68, v68, s28, v11
    v_mfma_f32_16x16x32_bf16 v[208:211], a[212:215], v[28:31], v[208:211]
    v_fma_f32 v63, v63, s28, v10
    v_mfma_f32_16x16x32_bf16 a[0:3], a[212:215], v[34:37], a[0:3]
    ds_read_b64_tr_b16 a[230:231], v2 offset:13312
    s_waitcnt lgkmcnt(6)
    v_mfma_f32_16x16x32_bf16 v[116:119], a[216:219], v[16:19], v[116:119]
    ds_read_b64_tr_b16 a[228:229], v2 offset:19456
    v_fma_f32 v64, v64, s28, v10
    v_mfma_f32_16x16x32_bf16 v[164:167], a[216:219], v[22:25], v[164:167]
    v_exp_f32 v68, v68
    v_mfma_f32_16x16x32_bf16 v[212:215], a[216:219], v[28:31], v[212:215]
    v_fma_f32 v76, v76, s28, v12
    v_fma_f32 v56, v56, s28, v9
    v_mfma_f32_16x16x32_bf16 a[4:7], a[216:219], v[34:37], a[4:7]
    ds_read_b64_tr_b16 a[218:219], v5 offset:13312
    s_waitcnt lgkmcnt(6)
    v_mfma_f32_16x16x32_bf16 v[120:123], a[220:223], v[16:19], v[120:123]
    ds_read_b64_tr_b16 a[212:213], v4 offset:19456
    v_fma_f32 v70, v70, s28, v11
    v_mfma_f32_16x16x32_bf16 v[168:171], a[220:223], v[22:25], v[168:171]
    ds_read_b64_tr_b16 a[232:233], v3 offset:19456
    v_mfma_f32_16x16x32_bf16 v[216:219], a[220:223], v[28:31], v[216:219]
    ds_read_b64_tr_b16 a[216:217], v5 offset:19456
    v_fma_f32 v83, v83, s28, v12
    v_mfma_f32_16x16x32_bf16 a[8:11], a[220:223], v[34:37], a[8:11]
    s_waitcnt lgkmcnt(6)
    ds_read_b64_tr_b16 a[220:221], v2 offset:20480
    v_fma_f32 v59, v59, s28, v9
    v_mfma_f32_16x16x32_bf16 v[124:127], a[224:227], v[16:19], v[124:127]
    v_fma_f32 v69, v69, s28, v11
    v_fma_f32 v62, v62, s28, v10
    v_mfma_f32_16x16x32_bf16 v[172:175], a[224:227], v[22:25], v[172:175]
    s_add_u32 s39, s39, 12288
    ds_read_b64_tr_b16 a[214:215], v4 offset:13312
    v_fma_f32 v67, v67, s28, v10
    v_mfma_f32_16x16x32_bf16 v[220:223], a[224:227], v[28:31], v[220:223]
    v_fma_f32 v57, v57, s28, v9
    v_fma_f32 v73, v73, s28, v11
    v_mfma_f32_16x16x32_bf16 a[12:15], a[224:227], v[34:37], a[12:15]
    s_waitcnt lgkmcnt(6)
    v_exp_f32 v63, v63
    v_mfma_f32_16x16x32_bf16 v[128:131], a[228:231], v[16:19], v[128:131]
    v_exp_f32 v59, v59
    v_mfma_f32_16x16x32_bf16 v[176:179], a[228:231], v[22:25], v[176:179]
    ds_read_b64_tr_b16 a[226:227], v3 offset:14336
    v_fma_f32 v78, v78, s28, v12
    v_mfma_f32_16x16x32_bf16 v[224:227], a[228:231], v[28:31], v[224:227]
    ds_read_b64_tr_b16 a[222:223], v2 offset:14336
    v_fma_f32 v72, v72, s28, v11
    v_mfma_f32_16x16x32_bf16 a[16:19], a[228:231], v[34:37], a[16:19]
    s_waitcnt lgkmcnt(5)
    ds_read_b64_tr_b16 a[230:231], v4 offset:14336
    v_mfma_f32_16x16x32_bf16 v[132:135], a[232:235], v[16:19], v[132:135]
    ds_read_b64_tr_b16 a[224:225], v3 offset:20480
    v_fma_f32 v71, v71, s28, v11
    v_mfma_f32_16x16x32_bf16 v[180:183], a[232:235], v[22:25], v[180:183]
    ds_read_b64_tr_b16 a[228:229], v4 offset:20480
    v_fma_f32 v81, v81, s28, v12
    v_mfma_f32_16x16x32_bf16 v[228:231], a[232:235], v[28:31], v[228:231]
    v_exp_f32 v69, v69
    v_mfma_f32_16x16x32_bf16 a[20:23], a[232:235], v[34:37], a[20:23]
    s_waitcnt lgkmcnt(5)
    ds_read_b64_tr_b16 a[234:235], v5 offset:14336
    v_mfma_f32_16x16x32_bf16 v[136:139], a[212:215], v[16:19], v[136:139]
    ds_read_b64_tr_b16 a[232:233], v5 offset:20480
    v_fma_f32 v66, v66, s28, v10
    v_mfma_f32_16x16x32_bf16 v[184:187], a[212:215], v[22:25], v[184:187]
    v_exp_f32 v83, v83
    v_mfma_f32_16x16x32_bf16 v[232:235], a[212:215], v[28:31], v[232:235]
    v_exp_f32 v67, v67
    v_mfma_f32_16x16x32_bf16 a[24:27], a[212:215], v[34:37], a[24:27]
    v_exp_f32 v77, v77
    v_mfma_f32_16x16x32_bf16 v[140:143], a[216:219], v[16:19], v[140:143]
    v_fma_f32 v74, v74, s28, v11
    v_fma_f32 v79, v79, s28, v12
    v_mfma_f32_16x16x32_bf16 v[188:191], a[216:219], v[22:25], v[188:191]
    v_exp_f32 v62, v62
    v_mfma_f32_16x16x32_bf16 v[236:239], a[216:219], v[28:31], v[236:239]
    v_exp_f32 v71, v71
    v_mfma_f32_16x16x32_bf16 a[28:31], a[216:219], v[34:37], a[28:31]
    s_waitcnt lgkmcnt(2)
    v_exp_f32 v76, v76
    v_mfma_f32_16x16x32_bf16 v[144:147], a[220:223], v[16:19], v[144:147]
    v_exp_f32 v78, v78
    v_mfma_f32_16x16x32_bf16 v[192:195], a[220:223], v[22:25], v[192:195]
    v_fma_f32 v80, v80, s28, v12
    s_waitcnt vmcnt(10) lgkmcnt(0)
    v_mfma_f32_16x16x32_bf16 v[240:243], a[220:223], v[28:31], v[240:243]
    s_barrier
    v_mfma_f32_16x16x32_bf16 a[32:35], a[220:223], v[34:37], a[32:35]
    s_add_u32 m0, s22, 36864
    ds_read_b128 a[212:215], v0 offset:12288
    v_mfma_f32_16x16x32_bf16 v[148:151], a[224:227], v[16:19], v[148:151]
    ds_read_b128 a[216:219], v1 offset:12288
    v_mfma_f32_16x16x32_bf16 v[196:199], a[224:227], v[22:25], v[196:199]
    buffer_load_dwordx4 v6, s[8:11], s21 offen lds
    v_mfma_f32_16x16x32_bf16 v[244:247], a[224:227], v[28:31], v[244:247]
    s_add_u32 s21, s21, 128
    s_add_u32 m0, s22, 37888
    ds_read_b128 a[220:223], v0 offset:13312
    v_mfma_f32_16x16x32_bf16 a[36:39], a[224:227], v[34:37], a[36:39]
    buffer_load_dwordx4 v6, s[8:11], s21 offen lds
    v_mfma_f32_16x16x32_bf16 v[152:155], a[228:231], v[16:19], v[152:155]
    v_exp_f32 v79, v79
    v_mfma_f32_16x16x32_bf16 v[200:203], a[228:231], v[22:25], v[200:203]
    s_add_u32 s21, s21, 128
    v_fma_f32 v58, v58, s28, v9
    v_mfma_f32_16x16x32_bf16 v[248:251], a[228:231], v[28:31], v[248:251]
    v_exp_f32 v70, v70
    v_mfma_f32_16x16x32_bf16 a[40:43], a[228:231], v[34:37], a[40:43]
    s_add_u32 m0, s22, 38912
    v_fma_f32 v82, v82, s28, v12
    v_cvt_pk_bf16_f32 v26, v68, v69
    v_mfma_f32_16x16x32_bf16 v[156:159], a[232:235], v[16:19], v[156:159]
    buffer_load_dwordx4 v6, s[8:11], s21 offen lds
    v_mfma_f32_16x16x32_bf16 v[204:207], a[232:235], v[22:25], v[204:207]
    v_cvt_pk_bf16_f32 v27, v70, v71
    v_fma_f32 v75, v75, s28, v11
    v_mfma_f32_16x16x32_bf16 v[252:255], a[232:235], v[28:31], v[252:255]
    v_exp_f32 v64, v64
    v_mfma_f32_16x16x32_bf16 a[44:47], a[232:235], v[34:37], a[44:47]
    s_waitcnt lgkmcnt(1)
    v_exp_f32 v57, v57
    v_mfma_f32_16x16x32_bf16 v[52:55], a[212:215], a[96:99], 0
    ds_read_b128 a[224:227], v1 offset:13312
    v_cvt_pk_bf16_f32 v33, v78, v79
    v_mfma_f32_16x16x32_bf16 v[52:55], a[216:219], a[100:103], v[52:55]
    s_waitcnt lgkmcnt(1)
    ds_read_b128 a[232:235], v1 offset:14336
    v_cvt_pk_bf16_f32 v21, v62, v63
    v_mfma_f32_16x16x32_bf16 v[52:55], a[220:223], a[104:107], v[52:55]
    ds_read_b128 a[228:231], v0 offset:14336
    v_fma_f32 v65, v65, s28, v10
    v_mfma_f32_16x16x32_bf16 v[60:63], a[212:215], a[120:123], 0
    v_exp_f32 v65, v65
    v_mfma_f32_16x16x32_bf16 v[60:63], a[216:219], a[124:127], v[60:63]
    v_exp_f32 v80, v80
    v_mfma_f32_16x16x32_bf16 v[60:63], a[220:223], a[128:131], v[60:63]
    v_exp_f32 v74, v74
    v_mfma_f32_16x16x32_bf16 v[68:71], a[212:215], a[144:147], 0
    v_exp_f32 v56, v56
    v_mfma_f32_16x16x32_bf16 v[68:71], a[216:219], a[148:151], v[68:71]
    v_cvt_pk_bf16_f32 v32, v76, v77
    v_mfma_f32_16x16x32_bf16 v[68:71], a[220:223], a[152:155], v[68:71]
    v_exp_f32 v66, v66
    v_mfma_f32_16x16x32_bf16 v[76:79], a[212:215], a[168:171], 0
    v_mfma_f32_16x16x32_bf16 v[76:79], a[216:219], a[172:175], v[76:79]
    ds_read_b128 a[216:219], v1 offset:18432
    v_mfma_f32_16x16x32_bf16 v[76:79], a[220:223], a[176:179], v[76:79]
    s_waitcnt lgkmcnt(2)
    v_exp_f32 v81, v81
    v_mfma_f32_16x16x32_bf16 v[52:55], a[224:227], a[108:111], v[52:55]
    s_waitcnt lgkmcnt(1)
    v_exp_f32 v58, v58
    v_mfma_f32_16x16x32_bf16 v[52:55], a[228:231], a[112:115], v[52:55]
    ds_read_b128 a[220:223], v0 offset:19456
    v_cvt_pk_bf16_f32 v23, v66, v67
    v_mfma_f32_16x16x32_bf16 v[52:55], a[232:235], a[116:119], v[52:55]
    v_exp_f32 v82, v82
    v_mfma_f32_16x16x32_bf16 v[60:63], a[224:227], a[132:135], v[60:63]
    v_exp_f32 v72, v72
    v_mfma_f32_16x16x32_bf16 v[60:63], a[228:231], a[136:139], v[60:63]
    v_exp_f32 v75, v75
    v_mfma_f32_16x16x32_bf16 v[60:63], a[232:235], a[140:143], v[60:63]
    v_exp_f32 v73, v73
    v_mfma_f32_16x16x32_bf16 v[68:71], a[224:227], a[156:159], v[68:71]
    ds_read_b128 a[212:215], v0 offset:18432
    v_cvt_pk_bf16_f32 v22, v64, v65
    v_mfma_f32_16x16x32_bf16 v[68:71], a[228:231], a[160:163], v[68:71]
    v_cvt_pk_bf16_f32 v28, v72, v73
    v_cvt_pk_bf16_f32 v17, v58, v59
    v_mfma_f32_16x16x32_bf16 v[68:71], a[232:235], a[164:167], v[68:71]
    v_cvt_pk_bf16_f32 v16, v56, v57
    v_cvt_pk_bf16_f32 v29, v74, v75
    v_mfma_f32_16x16x32_bf16 v[76:79], a[224:227], a[180:183], v[76:79]
    ds_read_b128 a[224:227], v1 offset:19456
    v_cvt_pk_bf16_f32 v34, v80, v81
    v_mfma_f32_16x16x32_bf16 v[76:79], a[228:231], a[184:187], v[76:79]
    ds_read_b128 a[228:231], v0 offset:20480
    v_mfma_f32_16x16x32_bf16 v[76:79], a[232:235], a[188:191], v[76:79]
    ds_read_b128 a[232:235], v1 offset:20480
    v_mfma_f32_16x16x32_bf16 v[44:47], a[236:239], v[14:17], v[48:51]
    v_cvt_pk_bf16_f32 v35, v82, v83
    v_mfma_f32_16x16x32_bf16 v[44:47], a[240:243], v[20:23], v[44:47]
    v_mfma_f32_16x16x32_bf16 v[44:47], a[244:247], v[26:29], v[44:47]
    v_mfma_f32_16x16x32_bf16 v[44:47], a[248:251], v[32:35], v[44:47]
    s_waitcnt lgkmcnt(3)
    v_mfma_f32_16x16x32_bf16 v[56:59], a[212:215], a[96:99], 0
    v_mfma_f32_16x16x32_bf16 v[56:59], a[216:219], a[100:103], v[56:59]
    s_add_u32 s21, s21, 12032
    v_mfma_f32_16x16x32_bf16 v[56:59], a[220:223], a[104:107], v[56:59]
    v_mfma_f32_16x16x32_bf16 v[64:67], a[212:215], a[120:123], 0
    s_nop 1
    v_cmp_lt_f32 vcc, s29, v44
    v_mfma_f32_16x16x32_bf16 v[64:67], a[216:219], a[124:127], v[64:67]
    s_waitcnt vmcnt(9) lgkmcnt(0)
    v_mfma_f32_16x16x32_bf16 v[64:67], a[220:223], a[128:131], v[64:67]
    s_barrier
    v_mfma_f32_16x16x32_bf16 v[72:75], a[212:215], a[144:147], 0
    s_cbranch_vccnz L_rs_loop4w0a
L_ret_loop4w0a:
    s_add_u32 m0, s22, 12288
    v_mfma_f32_16x16x32_bf16 v[72:75], a[216:219], a[148:151], v[72:75]
    v_fma_f32 v61, v61, s28, v10
    v_fma_f32 v54, v54, s28, v9
    v_mfma_f32_16x16x32_bf16 v[72:75], a[220:223], a[152:155], v[72:75]
    buffer_load_dwordx4 v6, s[4:7], s20 offen lds
    v_mfma_f32_16x16x32_bf16 v[80:83], a[212:215], a[168:171], 0
    ds_read_b64_tr_b16 a[212:213], v2 offset:0
    v_fma_f32 v55, v55, s28, v9
    v_mfma_f32_16x16x32_bf16 v[80:83], a[216:219], a[172:175], v[80:83]
    s_add_u32 s20, s20, 128
    v_exp_f32 v55, v55
    v_mfma_f32_16x16x32_bf16 v[80:83], a[220:223], a[176:179], v[80:83]
    s_add_u32 m0, s22, 13312
    ds_read_b64_tr_b16 a[214:215], v2 offset:6144
    v_fma_f32 v53, v53, s28, v9
    v_mfma_f32_16x16x32_bf16 v[56:59], a[224:227], a[108:111], v[56:59]
    buffer_load_dwordx4 v6, s[4:7], s20 offen lds
    v_mfma_f32_16x16x32_bf16 v[56:59], a[228:231], a[112:115], v[56:59]
    s_add_u32 s20, s20, 128
    ds_read_b64_tr_b16 a[216:217], v3 offset:0
    v_fma_f32 v60, v60, s28, v10
    v_mfma_f32_16x16x32_bf16 v[56:59], a[232:235], a[116:119], v[56:59]
    v_exp_f32 v61, v61
    v_mfma_f32_16x16x32_bf16 v[64:67], a[224:227], a[132:135], v[64:67]
    s_add_u32 m0, s22, 14336
    ds_read_b64_tr_b16 a[218:219], v3 offset:6144
    v_fma_f32 v52, v52, s28, v9
    v_mfma_f32_16x16x32_bf16 v[64:67], a[228:231], a[136:139], v[64:67]
    buffer_load_dwordx4 v6, s[4:7], s20 offen lds
    v_mfma_f32_16x16x32_bf16 v[64:67], a[232:235], a[140:143], v[64:67]
    v_exp_f32 v54, v54
    v_mfma_f32_16x16x32_bf16 v[72:75], a[224:227], a[156:159], v[72:75]
    v_exp_f32 v60, v60
    v_mfma_f32_16x16x32_bf16 v[72:75], a[228:231], a[160:163], v[72:75]
    ds_read_b64_tr_b16 a[220:221], v4 offset:0
    v_exp_f32 v52, v52
    v_mfma_f32_16x16x32_bf16 v[72:75], a[232:235], a[164:167], v[72:75]
    s_add_u32 s20, s20, 12032
    ds_read_b64_tr_b16 a[222:223], v4 offset:6144
    v_cvt_pk_bf16_f32 v24, v60, v61
    v_mfma_f32_16x16x32_bf16 v[80:83], a[224:227], a[180:183], v[80:83]
    v_exp_f32 v53, v53
    v_mfma_f32_16x16x32_bf16 v[80:83], a[228:231], a[184:187], v[80:83]
    ds_read_b64_tr_b16 a[224:225], v5 offset:0
    v_cvt_pk_bf16_f32 v19, v54, v55
    v_mfma_f32_16x16x32_bf16 v[80:83], a[232:235], a[188:191], v[80:83]
    ds_read_b64_tr_b16 a[226:227], v5 offset:6144
    v_cvt_pk_bf16_f32 v18, v52, v53
    s_waitcnt lgkmcnt(6)
    v_mfma_f32_16x16x32_bf16 v[112:115], a[212:215], v[14:17], v[112:115]
    ds_read_b64_tr_b16 a[230:231], v2 offset:7168
    v_fma_f32 v65, v65, s28, v10
    v_mfma_f32_16x16x32_bf16 v[160:163], a[212:215], v[20:23], v[160:163]
    ds_read_b64_tr_b16 a[228:229], v2 offset:1024
    v_fma_f32 v63, v63, s28, v10
    v_mfma_f32_16x16x32_bf16 v[208:211], a[212:215], v[26:29], v[208:211]
    v_fma_f32 v62, v62, s28, v10
    v_fma_f32 v58, v58, s28, v9
    v_mfma_f32_16x16x32_bf16 a[0:3], a[212:215], v[32:35], a[0:3]
    v_fma_f32 v74, v74, s28, v11
    s_waitcnt lgkmcnt(6)
    v_mfma_f32_16x16x32_bf16 v[116:119], a[216:219], v[14:17], v[116:119]
    v_fma_f32 v70, v70, s28, v11
    v_fma_f32 v77, v77, s28, v12
    v_mfma_f32_16x16x32_bf16 v[164:167], a[216:219], v[20:23], v[164:167]
    ds_read_b64_tr_b16 a[212:213], v4 offset:1024
    v_mfma_f32_16x16x32_bf16 v[212:215], a[216:219], v[26:29], v[212:215]
    v_exp_f32 v70, v70
    v_mfma_f32_16x16x32_bf16 a[4:7], a[216:219], v[32:35], a[4:7]
    ds_read_b64_tr_b16 a[234:235], v3 offset:7168
    s_waitcnt lgkmcnt(6)
    v_mfma_f32_16x16x32_bf16 v[120:123], a[220:223], v[14:17], v[120:123]
    v_exp_f32 v63, v63
    v_mfma_f32_16x16x32_bf16 v[168:171], a[220:223], v[20:23], v[168:171]
    ds_read_b64_tr_b16 a[232:233], v3 offset:1024
    v_mfma_f32_16x16x32_bf16 v[216:219], a[220:223], v[26:29], v[216:219]
    s_add_u32 s39, s39, 12288
    ds_read_b64_tr_b16 a[216:217], v5 offset:1024
    v_fma_f32 v75, v75, s28, v11
    v_mfma_f32_16x16x32_bf16 a[8:11], a[220:223], v[32:35], a[8:11]
    s_waitcnt lgkmcnt(4)
    ds_read_b64_tr_b16 a[218:219], v5 offset:7168
    v_fma_f32 v83, v83, s28, v12
    v_mfma_f32_16x16x32_bf16 v[124:127], a[224:227], v[14:17], v[124:127]
    v_exp_f32 v62, v62
    v_mfma_f32_16x16x32_bf16 v[172:175], a[224:227], v[20:23], v[172:175]
    ds_read_b64_tr_b16 a[214:215], v4 offset:7168
    v_fma_f32 v59, v59, s28, v9
    v_mfma_f32_16x16x32_bf16 v[220:223], a[224:227], v[26:29], v[220:223]
    ds_read_b64_tr_b16 a[222:223], v2 offset:8192
    v_fma_f32 v68, v68, s28, v11
    v_mfma_f32_16x16x32_bf16 a[12:15], a[224:227], v[32:35], a[12:15]
    v_fma_f32 v64, v64, s28, v10
    v_fma_f32 v66, v66, s28, v10
    v_mfma_f32_16x16x32_bf16 v[128:131], a[228:231], v[14:17], v[128:131]
    ds_read_b128 v[84:87], v8 offset:0
    v_fma_f32 v80, v80, s28, v12
    v_mfma_f32_16x16x32_bf16 v[176:179], a[228:231], v[20:23], v[176:179]
    ds_read_b64_tr_b16 a[220:221], v2 offset:2048
    v_fma_f32 v67, v67, s28, v10
    v_mfma_f32_16x16x32_bf16 v[224:227], a[228:231], v[26:29], v[224:227]
    ds_read_b64_tr_b16 a[224:225], v3 offset:2048
    v_fma_f32 v69, v69, s28, v11
    v_mfma_f32_16x16x32_bf16 a[16:19], a[228:231], v[32:35], a[16:19]
    s_waitcnt lgkmcnt(7)
    v_exp_f32 v58, v58
    v_mfma_f32_16x16x32_bf16 v[132:135], a[232:235], v[14:17], v[132:135]
    ds_read_b64_tr_b16 a[228:229], v4 offset:2048
    v_fma_f32 v79, v79, s28, v12
    v_mfma_f32_16x16x32_bf16 v[180:183], a[232:235], v[20:23], v[180:183]
    v_exp_f32 v68, v68
    v_mfma_f32_16x16x32_bf16 v[228:231], a[232:235], v[26:29], v[228:231]
    ds_read_b64_tr_b16 a[230:231], v4 offset:8192
    v_fma_f32 v57, v57, s28, v9
    v_mfma_f32_16x16x32_bf16 a[20:23], a[232:235], v[32:35], a[20:23]
    s_waitcnt lgkmcnt(6)
    ds_read_b64_tr_b16 a[234:235], v5 offset:8192
    v_fma_f32 v71, v71, s28, v11
    v_mfma_f32_16x16x32_bf16 v[136:139], a[212:215], v[14:17], v[136:139]
    ds_read_b64_tr_b16 a[226:227], v3 offset:8192
    v_cvt_pk_bf16_f32 v25, v62, v63
    v_mfma_f32_16x16x32_bf16 v[184:187], a[212:215], v[20:23], v[184:187]
    ds_read_b64_tr_b16 a[232:233], v5 offset:2048
    v_mfma_f32_16x16x32_bf16 v[232:235], a[212:215], v[26:29], v[232:235]
    v_exp_f32 v74, v74
    v_mfma_f32_16x16x32_bf16 a[24:27], a[212:215], v[32:35], a[24:27]
    v_exp_f32 v79, v79
    v_mfma_f32_16x16x32_bf16 v[140:143], a[216:219], v[14:17], v[140:143]
    v_exp_f32 v83, v83
    v_mfma_f32_16x16x32_bf16 v[188:191], a[216:219], v[20:23], v[188:191]
    v_exp_f32 v77, v77
    v_mfma_f32_16x16x32_bf16 v[236:239], a[216:219], v[26:29], v[236:239]
    v_exp_f32 v67, v67
    v_mfma_f32_16x16x32_bf16 a[28:31], a[216:219], v[32:35], a[28:31]
    s_waitcnt lgkmcnt(4)
    v_exp_f32 v69, v69
    v_mfma_f32_16x16x32_bf16 v[144:147], a[220:223], v[14:17], v[144:147]
    v_fma_f32 v56, v56, s28, v9
    v_mfma_f32_16x16x32_bf16 v[192:195], a[220:223], v[20:23], v[192:195]
    v_fma_f32 v76, v76, s28, v12
    v_fma_f32 v81, v81, s28, v12
    v_mfma_f32_16x16x32_bf16 v[240:243], a[220:223], v[26:29], v[240:243]
    buffer_store_dwordx4 v[84:87], v102, s[16:19], s24 offen offset:0 nt
    s_waitcnt vmcnt(7) lgkmcnt(0)
    s_barrier
    ds_read_b128 v[88:91], v8 offset:1024
    v_mfma_f32_16x16x32_bf16 a[32:35], a[220:223], v[32:35], a[32:35]
    ds_read_b128 a[216:219], v1 offset:0
    v_fma_f32 v82, v82, s28, v12
    v_mfma_f32_16x16x32_bf16 v[148:151], a[224:227], v[14:17], v[148:151]
    s_add_u32 m0, s22, 24576
    ds_read_b128 a[220:223], v0 offset:1024
    v_mfma_f32_16x16x32_bf16 v[196:199], a[224:227], v[20:23], v[196:199]
    ds_read_b128 a[212:215], v0 offset:0
    v_mfma_f32_16x16x32_bf16 v[244:247], a[224:227], v[26:29], v[244:247]
    buffer_load_dwordx4 v6, s[8:11], s21 offen lds
    v_mfma_f32_16x16x32_bf16 a[36:39], a[224:227], v[32:35], a[36:39]
    s_add_u32 s21, s21, 128
    v_exp_f32 v65, v65
    v_mfma_f32_16x16x32_bf16 v[152:155], a[228:231], v[14:17], v[152:155]
    s_add_u32 m0, s22, 25600
    v_exp_f32 v75, v75
    v_mfma_f32_16x16x32_bf16 v[200:203], a[228:231], v[20:23], v[200:203]
    buffer_load_dwordx4 v6, s[8:11], s21 offen lds
    v_mfma_f32_16x16x32_bf16 v[248:251], a[228:231], v[26:29], v[248:251]
    s_add_u32 s21, s21, 128
    v_exp_f32 v76, v76
    v_mfma_f32_16x16x32_bf16 a[40:43], a[228:231], v[32:35], a[40:43]
    v_exp_f32 v64, v64
    v_mfma_f32_16x16x32_bf16 v[156:159], a[232:235], v[14:17], v[156:159]
    s_add_u32 m0, s22, 26624
    v_exp_f32 v71, v71
    v_mfma_f32_16x16x32_bf16 v[204:207], a[232:235], v[20:23], v[204:207]
    buffer_load_dwordx4 v6, s[8:11], s21 offen lds
    v_mfma_f32_16x16x32_bf16 v[252:255], a[232:235], v[26:29], v[252:255]
    v_exp_f32 v56, v56
    v_mfma_f32_16x16x32_bf16 a[44:47], a[232:235], v[32:35], a[44:47]
    s_waitcnt lgkmcnt(0)
    ds_read_b128 a[228:231], v0 offset:2048
    v_cvt_pk_bf16_f32 v22, v64, v65
    v_mfma_f32_16x16x32_bf16 v[52:55], a[212:215], a[96:99], 0
    ds_read_b128 a[224:227], v1 offset:1024
    v_cvt_pk_bf16_f32 v29, v74, v75
    v_mfma_f32_16x16x32_bf16 v[52:55], a[216:219], a[100:103], v[52:55]
    s_add_u32 s21, s21, 12032
    v_exp_f32 v66, v66
    v_mfma_f32_16x16x32_bf16 v[52:55], a[220:223], a[104:107], v[52:55]
    ds_read_b128 a[232:235], v1 offset:2048
    v_fma_f32 v78, v78, s28, v12
    v_mfma_f32_16x16x32_bf16 v[60:63], a[212:215], a[120:123], 0
    v_cvt_pk_bf16_f32 v30, v68, v69
    v_cvt_pk_bf16_f32 v31, v70, v71
    v_mfma_f32_16x16x32_bf16 v[60:63], a[216:219], a[124:127], v[60:63]
    v_exp_f32 v81, v81
    v_mfma_f32_16x16x32_bf16 v[60:63], a[220:223], a[128:131], v[60:63]
    v_exp_f32 v78, v78
    v_mfma_f32_16x16x32_bf16 v[68:71], a[212:215], a[144:147], 0
    v_cvt_pk_bf16_f32 v36, v76, v77
    v_fma_f32 v73, v73, s28, v11
    v_mfma_f32_16x16x32_bf16 v[68:71], a[216:219], a[148:151], v[68:71]
    s_add_u32 m0, s23, 0
    v_cvt_pk_bf16_f32 v37, v78, v79
    v_mfma_f32_16x16x32_bf16 v[68:71], a[220:223], a[152:155], v[68:71]
    v_exp_f32 v57, v57
    v_mfma_f32_16x16x32_bf16 v[76:79], a[212:215], a[168:171], 0
    buffer_load_dwordx4 v6, s[12:15], s25 offen nt lds
    v_mfma_f32_16x16x32_bf16 v[76:79], a[216:219], a[172:175], v[76:79]
    v_add_u32 v8, 2048, v8
    v_cvt_pk_bf16_f32 v23, v66, v67
    v_mfma_f32_16x16x32_bf16 v[76:79], a[220:223], a[176:179], v[76:79]
    s_waitcnt lgkmcnt(1)
    ds_read_b128 a[220:223], v0 offset:7168
    v_fma_f32 v72, v72, s28, v11
    v_mfma_f32_16x16x32_bf16 v[52:55], a[224:227], a[108:111], v[52:55]
    ds_read_b128 a[216:219], v1 offset:6144
    s_add_u32 m0, s23, 1024
    v_mfma_f32_16x16x32_bf16 v[52:55], a[228:231], a[112:115], v[52:55]
    s_waitcnt lgkmcnt(2)
    v_exp_f32 v59, v59
    v_mfma_f32_16x16x32_bf16 v[52:55], a[232:235], a[116:119], v[52:55]
    v_exp_f32 v73, v73
    v_mfma_f32_16x16x32_bf16 v[60:63], a[224:227], a[132:135], v[60:63]
    ds_read_b128 a[212:215], v0 offset:6144
    v_cvt_pk_bf16_f32 v17, v58, v59
    v_mfma_f32_16x16x32_bf16 v[60:63], a[228:231], a[136:139], v[60:63]
    buffer_load_dwordx4 v7, s[12:15], s25 offen nt lds
    v_mfma_f32_16x16x32_bf16 v[60:63], a[232:235], a[140:143], v[60:63]
    v_exp_f32 v82, v82
    v_mfma_f32_16x16x32_bf16 v[68:71], a[224:227], a[156:159], v[68:71]
    s_bitcmp1_b32 s27, 0
    v_cvt_pk_bf16_f32 v16, v56, v57
    v_mfma_f32_16x16x32_bf16 v[68:71], a[228:231], a[160:163], v[68:71]
    v_exp_f32 v72, v72
    v_mfma_f32_16x16x32_bf16 v[68:71], a[232:235], a[164:167], v[68:71]
    v_cvt_pk_bf16_f32 v28, v72, v73
    v_mfma_f32_16x16x32_bf16 v[76:79], a[224:227], a[180:183], v[76:79]
    v_exp_f32 v80, v80
    v_mfma_f32_16x16x32_bf16 v[76:79], a[228:231], a[184:187], v[76:79]
    ds_read_b128 a[224:227], v1 offset:7168
    s_cselect_b32 s26, s49, 128
    v_mfma_f32_16x16x32_bf16 v[76:79], a[232:235], a[188:191], v[76:79]
    ds_read_b128 a[228:231], v0 offset:8192
    v_cvt_pk_bf16_f32 v34, v80, v81
    v_mfma_f32_16x16x32_bf16 v[48:51], a[236:239], v[16:19], v[44:47]
    ds_read_b128 a[232:235], v1 offset:8192
    v_mfma_f32_16x16x32_bf16 v[48:51], a[240:243], v[22:25], v[48:51]
    v_cvt_pk_bf16_f32 v35, v82, v83
    v_mfma_f32_16x16x32_bf16 v[48:51], a[244:247], v[28:31], v[48:51]
    s_nop 0
    v_mfma_f32_16x16x32_bf16 v[48:51], a[248:251], v[34:37], v[48:51]
    s_lshr_b32 s27, s27, 1
    s_waitcnt lgkmcnt(3)
    v_mfma_f32_16x16x32_bf16 v[56:59], a[212:215], a[96:99], 0
    buffer_store_dwordx4 v[88:91], v103, s[16:19], s24 offen offset:0 nt
    s_nop 3
    v_cmp_lt_f32 vcc, s29, v48
    v_mfma_f32_16x16x32_bf16 v[56:59], a[216:219], a[100:103], v[56:59]
    s_add_u32 s24, s24, s26
    s_add_u32 s25, s25, s26
    s_add_u32 s23, s23, 2048
    v_mfma_f32_16x16x32_bf16 v[56:59], a[220:223], a[104:107], v[56:59]
    s_cbranch_vccnz L_rs_loop4w0b
L_ret_loop4w0b:
    v_fma_f32 v53, v53, s28, v9
    v_mfma_f32_16x16x32_bf16 v[64:67], a[212:215], a[120:123], 0
    v_fma_f32 v55, v55, s28, v9
    v_fma_f32 v60, v60, s28, v10
    v_mfma_f32_16x16x32_bf16 v[64:67], a[216:219], a[124:127], v[64:67]
    v_fma_f32 v54, v54, s28, v9
    s_waitcnt vmcnt(10) lgkmcnt(0)
    v_mfma_f32_16x16x32_bf16 v[64:67], a[220:223], a[128:131], v[64:67]
    s_barrier
    v_mfma_f32_16x16x32_bf16 v[72:75], a[212:215], a[144:147], 0
    s_cmp_eq_u32 s30, 5
    v_exp_f32 v53, v53
    v_mfma_f32_16x16x32_bf16 v[72:75], a[216:219], a[148:151], v[72:75]
    s_cselect_b32 s26, s62, 0
    s_add_u32 s20, s20, s26
    s_add_u32 m0, s22, 0
    v_mfma_f32_16x16x32_bf16 v[72:75], a[220:223], a[152:155], v[72:75]
    buffer_load_dwordx4 v6, s[4:7], s20 offen lds
    v_mfma_f32_16x16x32_bf16 v[80:83], a[212:215], a[168:171], 0
    s_add_u32 s20, s20, 128
    v_exp_f32 v60, v60
    v_mfma_f32_16x16x32_bf16 v[80:83], a[216:219], a[172:175], v[80:83]
    s_add_u32 m0, s22, 1024
    v_exp_f32 v55, v55
    v_mfma_f32_16x16x32_bf16 v[80:83], a[220:223], a[176:179], v[80:83]
    buffer_load_dwordx4 v6, s[4:7], s20 offen lds
    v_mfma_f32_16x16x32_bf16 v[56:59], a[224:227], a[108:111], v[56:59]
    s_add_u32 s20, s20, 128
    ds_read_b64_tr_b16 a[212:213], v2 offset:18432
    s_add_u32 m0, s22, 2048
    v_mfma_f32_16x16x32_bf16 v[56:59], a[228:231], a[112:115], v[56:59]
    v_exp_f32 v54, v54
    v_mfma_f32_16x16x32_bf16 v[56:59], a[232:235], a[116:119], v[56:59]
    buffer_load_dwordx4 v6, s[4:7], s20 offen lds
    ds_read_b64_tr_b16 a[214:215], v2 offset:12288
    v_mfma_f32_16x16x32_bf16 v[64:67], a[224:227], a[132:135], v[64:67]
    ds_read_b64_tr_b16 a[216:217], v3 offset:18432
    v_fma_f32 v52, v52, s28, v9
    v_mfma_f32_16x16x32_bf16 v[64:67], a[228:231], a[136:139], v[64:67]
    v_exp_f32 v52, v52
    v_mfma_f32_16x16x32_bf16 v[64:67], a[232:235], a[140:143], v[64:67]
    s_add_u32 s20, s20, 12032
    ds_read_b64_tr_b16 a[218:219], v3 offset:12288
    v_fma_f32 v61, v61, s28, v10
    v_mfma_f32_16x16x32_bf16 v[72:75], a[224:227], a[156:159], v[72:75]
    s_add_u32 s30, s30, 1
    v_exp_f32 v61, v61
    v_mfma_f32_16x16x32_bf16 v[72:75], a[228:231], a[160:163], v[72:75]
    ds_read_b64_tr_b16 a[220:221], v4 offset:18432
    v_cvt_pk_bf16_f32 v20, v60, v61
    v_mfma_f32_16x16x32_bf16 v[72:75], a[232:235], a[164:167], v[72:75]
    ds_read_b64_tr_b16 a[222:223], v4 offset:12288
    v_cvt_pk_bf16_f32 v15, v54, v55
    v_mfma_f32_16x16x32_bf16 v[80:83], a[224:227], a[180:183], v[80:83]
    ds_read_b64_tr_b16 a[224:225], v5 offset:18432
    v_cvt_pk_bf16_f32 v14, v52, v53
    v_mfma_f32_16x16x32_bf16 v[80:83], a[228:231], a[184:187], v[80:83]
    s_cmp_lt_u32 s30, 6
    ds_read_b64_tr_b16 a[226:227], v5 offset:12288
    v_mfma_f32_16x16x32_bf16 v[80:83], a[232:235], a[188:191], v[80:83]
    s_cbranch_scc1 L_loop4w0
    s_cmp_ge_u32 s37, 6
    s_cbranch_scc1 L_end4
    s_cmp_eq_u32 s32, 0
    s_cbranch_scc1 L_tr44
    s_branch L_tr45
L_tr45:
    v_mbcnt_lo_u32_b32 v107, -1, 0
    s_waitcnt lgkmcnt(6)
    v_mfma_f32_16x16x32_bf16 v[112:115], a[212:215], v[16:19], v[112:115]
    v_mbcnt_hi_u32_b32 v107, -1, v107
    v_fma_f32 v74, v74, s28, v11
    v_fma_f32 v80, v80, s28, v12
    v_mfma_f32_16x16x32_bf16 v[160:163], a[212:215], v[22:25], v[160:163]
    v_fma_f32 v65, v65, s28, v10
    v_and_b32 v106, 15, v107
    v_mfma_f32_16x16x32_bf16 v[208:211], a[212:215], v[28:31], v[208:211]
    s_add_u32 s39, s39, 12288
    ds_read_b128 v[88:91], v8 offset:4096
    v_mul_u32_u24 v106, 384, v106
    v_mfma_f32_16x16x32_bf16 a[0:3], a[212:215], v[34:37], a[0:3]
    s_waitcnt lgkmcnt(5)
    ds_read_b64_tr_b16 a[230:231], v2 offset:13312
    v_lshrrev_b32 v107, 4, v107
    v_mfma_f32_16x16x32_bf16 v[116:119], a[216:219], v[16:19], v[116:119]
    ds_read_b64_tr_b16 a[228:229], v2 offset:19456
    v_fma_f32 v68, v68, s28, v11
    v_mfma_f32_16x16x32_bf16 v[164:167], a[216:219], v[22:25], v[164:167]
    v_fma_f32 v67, v67, s28, v10
    v_fma_f32 v70, v70, s28, v11
    v_mfma_f32_16x16x32_bf16 v[212:215], a[216:219], v[28:31], v[212:215]
    s_add_u32 s48, s33, 24576
    ds_read_b64_tr_b16 a[232:233], v3 offset:19456
    v_fma_f32 v58, v58, s28, v9
    v_mfma_f32_16x16x32_bf16 a[4:7], a[216:219], v[34:37], a[4:7]
    s_waitcnt lgkmcnt(6)
    v_lshl_add_u32 v106, v107, 4, v106
    v_fma_f32 v73, v73, s28, v11
    v_mfma_f32_16x16x32_bf16 v[120:123], a[220:223], v[16:19], v[120:123]
    ds_read_b64_tr_b16 a[234:235], v3 offset:13312
    v_fma_f32 v72, v72, s28, v11
    v_mfma_f32_16x16x32_bf16 v[168:171], a[220:223], v[22:25], v[168:171]
    buffer_load_dwordx4 a[208:211], v106, s[12:15], s48 offen offset:256 nt
    v_mfma_f32_16x16x32_bf16 v[216:219], a[220:223], v[28:31], v[216:219]
    ds_read_b64_tr_b16 a[212:213], v4 offset:19456
    buffer_load_dwordx4 v[92:95], v106, s[12:15], s48 offen offset:320 nt
    v_mfma_f32_16x16x32_bf16 a[8:11], a[220:223], v[34:37], a[8:11]
    s_waitcnt lgkmcnt(6)
    ds_read_b64_tr_b16 a[214:215], v4 offset:13312
    v_fma_f32 v82, v82, s28, v12
    v_mfma_f32_16x16x32_bf16 v[124:127], a[224:227], v[16:19], v[124:127]
    v_fma_f32 v66, v66, s28, v10
    v_fma_f32 v59, v59, s28, v9
    v_mfma_f32_16x16x32_bf16 v[172:175], a[224:227], v[22:25], v[172:175]
    ds_read_b64_tr_b16 a[218:219], v5 offset:13312
    v_fma_f32 v56, v56, s28, v9
    v_mfma_f32_16x16x32_bf16 v[220:223], a[224:227], v[28:31], v[220:223]
    ds_read_b64_tr_b16 a[216:217], v5 offset:19456
    v_fma_f32 v76, v76, s28, v12
    v_mfma_f32_16x16x32_bf16 a[12:15], a[224:227], v[34:37], a[12:15]
    s_waitcnt lgkmcnt(6)
    v_fma_f32 v81, v81, s28, v12
    v_fma_f32 v63, v63, s28, v10
    v_mfma_f32_16x16x32_bf16 v[128:131], a[228:231], v[16:19], v[128:131]
    ds_read_b64_tr_b16 a[226:227], v3 offset:14336
    v_fma_f32 v64, v64, s28, v10
    v_mfma_f32_16x16x32_bf16 v[176:179], a[228:231], v[22:25], v[176:179]
    ds_read_b64_tr_b16 a[220:221], v2 offset:20480
    v_fma_f32 v83, v83, s28, v12
    v_mfma_f32_16x16x32_bf16 v[224:227], a[228:231], v[28:31], v[224:227]
    ds_read_b64_tr_b16 a[222:223], v2 offset:14336
    v_fma_f32 v78, v78, s28, v12
    v_mfma_f32_16x16x32_bf16 a[16:19], a[228:231], v[34:37], a[16:19]
    s_waitcnt lgkmcnt(7)
    v_exp_f32 v78, v78
    v_mfma_f32_16x16x32_bf16 v[132:135], a[232:235], v[16:19], v[132:135]
    ds_read_b64_tr_b16 a[230:231], v4 offset:14336
    v_fma_f32 v62, v62, s28, v10
    v_mfma_f32_16x16x32_bf16 v[180:183], a[232:235], v[22:25], v[180:183]
    ds_read_b64_tr_b16 a[224:225], v3 offset:20480
    v_fma_f32 v75, v75, s28, v11
    v_mfma_f32_16x16x32_bf16 v[228:231], a[232:235], v[28:31], v[228:231]
    ds_read_b64_tr_b16 a[228:229], v4 offset:20480
    v_fma_f32 v71, v71, s28, v11
    v_mfma_f32_16x16x32_bf16 a[20:23], a[232:235], v[34:37], a[20:23]
    s_waitcnt lgkmcnt(7)
    ds_read_b64_tr_b16 a[234:235], v5 offset:14336
    ds_read_b64_tr_b16 a[232:233], v5 offset:20480
    v_mfma_f32_16x16x32_bf16 v[136:139], a[212:215], v[16:19], v[136:139]
    v_exp_f32 v70, v70
    v_mfma_f32_16x16x32_bf16 v[184:187], a[212:215], v[22:25], v[184:187]
    v_exp_f32 v81, v81
    v_mfma_f32_16x16x32_bf16 v[232:235], a[212:215], v[28:31], v[232:235]
    ds_read_b128 v[96:99], v8 offset:2048
    v_fma_f32 v57, v57, s28, v9
    v_mfma_f32_16x16x32_bf16 a[24:27], a[212:215], v[34:37], a[24:27]
    s_waitcnt lgkmcnt(7)
    v_exp_f32 v62, v62
    v_mfma_f32_16x16x32_bf16 v[140:143], a[216:219], v[16:19], v[140:143]
    v_exp_f32 v76, v76
    v_mfma_f32_16x16x32_bf16 v[188:191], a[216:219], v[22:25], v[188:191]
    v_exp_f32 v73, v73
    v_mfma_f32_16x16x32_bf16 v[236:239], a[216:219], v[28:31], v[236:239]
    ds_read_b128 v[84:87], v8 offset:3072
    v_fma_f32 v69, v69, s28, v11
    v_mfma_f32_16x16x32_bf16 a[28:31], a[216:219], v[34:37], a[28:31]
    s_waitcnt lgkmcnt(5)
    v_exp_f32 v69, v69
    v_mfma_f32_16x16x32_bf16 v[144:147], a[220:223], v[16:19], v[144:147]
    v_exp_f32 v59, v59
    v_mfma_f32_16x16x32_bf16 v[192:195], a[220:223], v[22:25], v[192:195]
    s_waitcnt vmcnt(12) lgkmcnt(2)
    v_exp_f32 v63, v63
    v_mfma_f32_16x16x32_bf16 v[240:243], a[220:223], v[28:31], v[240:243]
    s_barrier
    v_mfma_f32_16x16x32_bf16 a[32:35], a[220:223], v[34:37], a[32:35]
    s_add_u32 m0, s22, 36864
    ds_read_b128 a[212:215], v0 offset:12288
    v_cvt_pk_bf16_f32 v21, v62, v63
    v_mfma_f32_16x16x32_bf16 v[148:151], a[224:227], v[16:19], v[148:151]
    ds_read_b128 a[220:223], v0 offset:13312
    v_fma_f32 v77, v77, s28, v12
    v_mfma_f32_16x16x32_bf16 v[196:199], a[224:227], v[22:25], v[196:199]
    buffer_load_dwordx4 v6, s[8:11], s21 offen lds
    ds_read_b128 a[216:219], v1 offset:12288
    v_mfma_f32_16x16x32_bf16 v[244:247], a[224:227], v[28:31], v[244:247]
    s_add_u32 s21, s21, 128
    v_exp_f32 v68, v68
    v_mfma_f32_16x16x32_bf16 a[36:39], a[224:227], v[34:37], a[36:39]
    s_add_u32 m0, s22, 37888
    v_exp_f32 v71, v71
    v_mfma_f32_16x16x32_bf16 v[152:155], a[228:231], v[16:19], v[152:155]
    buffer_load_dwordx4 v6, s[8:11], s21 offen lds
    v_mfma_f32_16x16x32_bf16 v[200:203], a[228:231], v[22:25], v[200:203]
    s_add_u32 s21, s21, 128
    v_cvt_pk_bf16_f32 v26, v68, v69
    v_fma_f32 v79, v79, s28, v12
    v_mfma_f32_16x16x32_bf16 v[248:251], a[228:231], v[28:31], v[248:251]
    s_add_u32 m0, s22, 38912
    v_exp_f32 v64, v64
    v_mfma_f32_16x16x32_bf16 a[40:43], a[228:231], v[34:37], a[40:43]
    buffer_load_dwordx4 v6, s[8:11], s21 offen lds
    v_mfma_f32_16x16x32_bf16 v[156:159], a[232:235], v[16:19], v[156:159]
    s_add_u32 s21, s21, 12032
    v_exp_f32 v83, v83
    v_mfma_f32_16x16x32_bf16 v[204:207], a[232:235], v[22:25], v[204:207]
    s_add_u32 s56, s24, 5888
    ds_read_b128 a[228:231], v0 offset:14336
    v_cvt_pk_bf16_f32 v27, v70, v71
    v_mfma_f32_16x16x32_bf16 v[252:255], a[232:235], v[28:31], v[252:255]
    s_add_u32 s58, s25, 5888
    v_exp_f32 v79, v79
    v_mfma_f32_16x16x32_bf16 a[44:47], a[232:235], v[34:37], a[44:47]
    s_waitcnt lgkmcnt(1)
    v_exp_f32 v77, v77
    v_mfma_f32_16x16x32_bf16 v[52:55], a[212:215], a[96:99], 0
    v_exp_f32 v74, v74
    v_mfma_f32_16x16x32_bf16 v[52:55], a[216:219], a[100:103], v[52:55]
    ds_read_b128 a[224:227], v1 offset:13312
    v_cvt_pk_bf16_f32 v33, v78, v79
    v_mfma_f32_16x16x32_bf16 v[52:55], a[220:223], a[104:107], v[52:55]
    buffer_store_dwordx4 v[96:99], v102, s[16:19], s56 offen offset:0 nt
    ds_read_b128 a[232:235], v1 offset:14336
    v_exp_f32 v82, v82
    v_mfma_f32_16x16x32_bf16 v[60:63], a[212:215], a[120:123], 0
    v_exp_f32 v58, v58
    v_mfma_f32_16x16x32_bf16 v[60:63], a[216:219], a[124:127], v[60:63]
    buffer_store_dwordx4 v[84:87], v103, s[16:19], s56 offen offset:0 nt
    v_exp_f32 v80, v80
    v_cvt_pk_bf16_f32 v32, v76, v77
    v_mfma_f32_16x16x32_bf16 v[60:63], a[220:223], a[128:131], v[60:63]
    s_add_u32 m0, s38, 24576
    v_exp_f32 v66, v66
    v_mfma_f32_16x16x32_bf16 v[68:71], a[212:215], a[144:147], 0
    buffer_load_dwordx4 v6, s[12:15], s58 offen nt lds
    v_mfma_f32_16x16x32_bf16 v[68:71], a[216:219], a[148:151], v[68:71]
    v_exp_f32 v65, v65
    v_mfma_f32_16x16x32_bf16 v[68:71], a[220:223], a[152:155], v[68:71]
    ds_read_b128 v[96:99], v8 offset:5120
    v_cvt_pk_bf16_f32 v35, v82, v83
    v_mfma_f32_16x16x32_bf16 v[76:79], a[212:215], a[168:171], 0
    s_add_u32 m0, s38, 25600
    v_exp_f32 v75, v75
    v_mfma_f32_16x16x32_bf16 v[76:79], a[216:219], a[172:175], v[76:79]
    buffer_load_dwordx4 v7, s[12:15], s58 offen nt lds
    v_mfma_f32_16x16x32_bf16 v[76:79], a[220:223], a[176:179], v[76:79]
    s_waitcnt lgkmcnt(1)
    v_exp_f32 v56, v56
    v_mfma_f32_16x16x32_bf16 v[52:55], a[224:227], a[108:111], v[52:55]
    v_exp_f32 v57, v57
    v_mfma_f32_16x16x32_bf16 v[52:55], a[228:231], a[112:115], v[52:55]
    s_add_u32 s57, s24, 6016
    v_exp_f32 v72, v72
    v_mfma_f32_16x16x32_bf16 v[52:55], a[232:235], a[116:119], v[52:55]
    v_cvt_pk_bf16_f32 v16, v56, v57
    v_mfma_f32_16x16x32_bf16 v[60:63], a[224:227], a[132:135], v[60:63]
    ds_read_b128 v[84:87], v8 offset:0
    v_cvt_pk_bf16_f32 v17, v58, v59
    v_mfma_f32_16x16x32_bf16 v[60:63], a[228:231], a[136:139], v[60:63]
    buffer_store_dwordx4 v[88:91], v102, s[16:19], s57 offen offset:0 nt
    s_add_u32 s59, s25, 6016
    ds_read_b128 a[212:215], v0 offset:18432
    v_cvt_pk_bf16_f32 v28, v72, v73
    s_add_u32 m0, s38, 26624
    v_mfma_f32_16x16x32_bf16 v[44:47], a[236:239], v[14:17], v[48:51]
    ds_read_b128 a[216:219], v1 offset:18432
    v_cvt_pk_bf16_f32 v22, v64, v65
    v_mfma_f32_16x16x32_bf16 v[60:63], a[232:235], a[140:143], v[60:63]
    buffer_load_dwordx4 v6, s[12:15], s59 offen nt lds
    v_mfma_f32_16x16x32_bf16 v[68:71], a[224:227], a[156:159], v[68:71]
    v_exp_f32 v67, v67
    v_mfma_f32_16x16x32_bf16 v[68:71], a[228:231], a[160:163], v[68:71]
    ds_read_b128 v[88:91], v8 offset:1024
    v_mfma_f32_16x16x32_bf16 v[68:71], a[232:235], a[164:167], v[68:71]
    s_add_u32 m0, s38, 27648
    ds_read_b128 a[220:223], v0 offset:19456
    v_cvt_pk_bf16_f32 v29, v74, v75
    v_mfma_f32_16x16x32_bf16 v[76:79], a[224:227], a[180:183], v[76:79]
    ds_read_b128 a[224:227], v1 offset:19456
    v_cvt_pk_bf16_f32 v23, v66, v67
    v_mfma_f32_16x16x32_bf16 v[76:79], a[228:231], a[184:187], v[76:79]
    ds_read_b128 a[228:231], v0 offset:20480
    v_cvt_pk_bf16_f32 v34, v80, v81
    v_mfma_f32_16x16x32_bf16 v[76:79], a[232:235], a[188:191], v[76:79]
    s_waitcnt lgkmcnt(6)
    ds_read_b128 a[232:235], v1 offset:20480
    buffer_load_dwordx4 v7, s[12:15], s59 offen nt lds
    v_mfma_f32_16x16x32_bf16 v[44:47], a[240:243], v[20:23], v[44:47]
    s_add_u32 m0, s38, 22528
    v_mfma_f32_16x16x32_bf16 v[44:47], a[244:247], v[26:29], v[44:47]
    buffer_load_dwordx4 v6, s[12:15], s25 offen nt lds
    v_mfma_f32_16x16x32_bf16 v[44:47], a[248:251], v[32:35], v[44:47]
    s_add_u32 m0, s38, 23552
    s_waitcnt lgkmcnt(5)
    v_mfma_f32_16x16x32_bf16 v[56:59], a[212:215], a[96:99], 0
    buffer_store_dwordx4 v[96:99], v103, s[16:19], s57 offen offset:0 nt
    s_nop 3
    v_cmp_lt_f32 vcc, s29, v44
    v_mfma_f32_16x16x32_bf16 v[56:59], a[216:219], a[100:103], v[56:59]
    s_waitcnt lgkmcnt(3)
    v_mfma_f32_16x16x32_bf16 v[56:59], a[220:223], a[104:107], v[56:59]
    buffer_load_dwordx4 v7, s[12:15], s25 offen nt lds
    v_mfma_f32_16x16x32_bf16 v[64:67], a[212:215], a[120:123], 0
    s_cbranch_vccnz L_rs_tr45a
L_ret_tr45a:
    v_fma_f32 v55, v55, s28, v9
    v_mfma_f32_16x16x32_bf16 v[64:67], a[216:219], a[124:127], v[64:67]
    s_waitcnt vmcnt(19) lgkmcnt(0)
    s_add_u32 m0, s22, 12288
    v_mfma_f32_16x16x32_bf16 v[64:67], a[220:223], a[128:131], v[64:67]
    s_barrier
    v_mfma_f32_16x16x32_bf16 v[72:75], a[212:215], a[144:147], 0
    buffer_load_dwordx4 v6, s[4:7], s20 offen lds
    v_mfma_f32_16x16x32_bf16 v[72:75], a[216:219], a[148:151], v[72:75]
    s_add_u32 s20, s20, 128
    v_fma_f32 v61, v61, s28, v10
    s_add_u32 m0, s22, 13312
    v_mfma_f32_16x16x32_bf16 v[72:75], a[220:223], a[152:155], v[72:75]
    buffer_load_dwordx4 v6, s[4:7], s20 offen lds
    v_mfma_f32_16x16x32_bf16 v[80:83], a[212:215], a[168:171], 0
    s_add_u32 s20, s20, 128
    s_add_u32 m0, s22, 14336
    v_fma_f32 v54, v54, s28, v9
    v_mfma_f32_16x16x32_bf16 v[80:83], a[216:219], a[172:175], v[80:83]
    buffer_load_dwordx4 v6, s[4:7], s20 offen lds
    v_mfma_f32_16x16x32_bf16 v[80:83], a[220:223], a[176:179], v[80:83]
    ds_read_b64_tr_b16 a[212:213], v2 offset:0
    v_fma_f32 v60, v60, s28, v10
    v_mfma_f32_16x16x32_bf16 v[56:59], a[224:227], a[108:111], v[56:59]
    ds_read_b64_tr_b16 a[214:215], v2 offset:6144
    v_fma_f32 v52, v52, s28, v9
    v_mfma_f32_16x16x32_bf16 v[56:59], a[228:231], a[112:115], v[56:59]
    v_exp_f32 v55, v55
    v_mfma_f32_16x16x32_bf16 v[56:59], a[232:235], a[116:119], v[56:59]
    v_exp_f32 v60, v60
    v_mfma_f32_16x16x32_bf16 v[64:67], a[224:227], a[132:135], v[64:67]
    ds_read_b64_tr_b16 a[216:217], v3 offset:0
    s_add_u32 s20, s20, 12032
    v_mfma_f32_16x16x32_bf16 v[64:67], a[228:231], a[136:139], v[64:67]
    v_exp_f32 v52, v52
    v_mfma_f32_16x16x32_bf16 v[64:67], a[232:235], a[140:143], v[64:67]
    v_exp_f32 v61, v61
    v_mfma_f32_16x16x32_bf16 v[72:75], a[224:227], a[156:159], v[72:75]
    ds_read_b64_tr_b16 a[218:219], v3 offset:6144
    v_fma_f32 v53, v53, s28, v9
    v_mfma_f32_16x16x32_bf16 v[72:75], a[228:231], a[160:163], v[72:75]
    buffer_store_dwordx4 v[84:87], v102, s[16:19], s24 offen offset:0 nt
    ds_read_b64_tr_b16 a[220:221], v4 offset:0
    v_exp_f32 v54, v54
    v_mfma_f32_16x16x32_bf16 v[72:75], a[232:235], a[164:167], v[72:75]
    ds_read_b64_tr_b16 a[222:223], v4 offset:6144
    v_cvt_pk_bf16_f32 v19, v54, v55
    v_mfma_f32_16x16x32_bf16 v[80:83], a[224:227], a[180:183], v[80:83]
    ds_read_b64_tr_b16 a[224:225], v5 offset:0
    v_cvt_pk_bf16_f32 v24, v60, v61
    v_mfma_f32_16x16x32_bf16 v[80:83], a[228:231], a[184:187], v[80:83]
    v_exp_f32 v53, v53
    v_mfma_f32_16x16x32_bf16 v[80:83], a[232:235], a[188:191], v[80:83]
    buffer_store_dwordx4 v[88:91], v103, s[16:19], s24 offen offset:0 nt
    ds_read_b64_tr_b16 a[226:227], v5 offset:6144
    v_cvt_pk_bf16_f32 v18, v52, v53
    s_waitcnt lgkmcnt(6)
    v_mfma_f32_16x16x32_bf16 v[112:115], a[212:215], v[14:17], v[112:115]
    ds_read_b64_tr_b16 a[234:235], v3 offset:7168
    v_lshrrev_b32 v105, 11, v0
    v_fma_f32 v64, v64, s28, v10
    v_mfma_f32_16x16x32_bf16 v[160:163], a[212:215], v[20:23], v[160:163]
    v_and_b32 v104, 0x3ff, v0
    v_fma_f32 v69, v69, s28, v11
    v_mfma_f32_16x16x32_bf16 v[208:211], a[212:215], v[26:29], v[208:211]
    v_xor_b32 v105, s65, v105
    v_fma_f32 v78, v78, s28, v12
    v_fma_f32 v68, v68, s28, v11
    v_mfma_f32_16x16x32_bf16 a[0:3], a[212:215], v[32:35], a[0:3]
    s_waitcnt lgkmcnt(5)
    v_fma_f32 v70, v70, s28, v11
    v_lshl_add_u32 v104, v105, 10, v104
    v_mfma_f32_16x16x32_bf16 v[116:119], a[216:219], v[14:17], v[116:119]
    ds_read_b64_tr_b16 a[230:231], v2 offset:7168
    v_fma_f32 v79, v79, s28, v12
    v_mfma_f32_16x16x32_bf16 v[164:167], a[216:219], v[20:23], v[164:167]
    ds_read_b64_tr_b16 a[228:229], v2 offset:1024
    v_add_u32 v104, s38, v104
    v_mfma_f32_16x16x32_bf16 v[212:215], a[216:219], v[26:29], v[212:215]
    ds_read_b64_tr_b16 a[232:233], v3 offset:1024
    v_fma_f32 v56, v56, s28, v9
    v_mfma_f32_16x16x32_bf16 a[4:7], a[216:219], v[32:35], a[4:7]
    s_waitcnt lgkmcnt(6)
    ds_read_b64_tr_b16 a[214:215], v4 offset:7168
    v_fma_f32 v58, v58, s28, v9
    v_mfma_f32_16x16x32_bf16 v[120:123], a[220:223], v[14:17], v[120:123]
    ds_read_b64_tr_b16 a[212:213], v4 offset:1024
    v_fma_f32 v59, v59, s28, v9
    v_mfma_f32_16x16x32_bf16 v[168:171], a[220:223], v[20:23], v[168:171]
    ds_read_b64_tr_b16 a[216:217], v5 offset:1024
    v_xor_b32 v105, 64, v104
    v_mfma_f32_16x16x32_bf16 v[216:219], a[220:223], v[26:29], v[216:219]
    ds_read_b128 a[104:107], v104 offset:2048
    v_fma_f32 v81, v81, s28, v12
    v_mfma_f32_16x16x32_bf16 a[8:11], a[220:223], v[32:35], a[8:11]
    s_waitcnt lgkmcnt(7)
    ds_read_b64_tr_b16 a[222:223], v2 offset:8192
    v_fma_f32 v65, v65, s28, v10
    v_mfma_f32_16x16x32_bf16 v[124:127], a[224:227], v[14:17], v[124:127]
    v_exp_f32 v79, v79
    v_mfma_f32_16x16x32_bf16 v[172:175], a[224:227], v[20:23], v[172:175]
    v_exp_f32 v58, v58
    v_mfma_f32_16x16x32_bf16 v[220:223], a[224:227], v[26:29], v[220:223]
    ds_read_b128 a[96:99], v104 offset:0
    v_fma_f32 v71, v71, s28, v11
    v_mfma_f32_16x16x32_bf16 a[12:15], a[224:227], v[32:35], a[12:15]
    s_waitcnt lgkmcnt(7)
    ds_read_b128 a[108:111], v105 offset:2048
    v_exp_f32 v64, v64
    v_mfma_f32_16x16x32_bf16 v[128:131], a[228:231], v[14:17], v[128:131]
    ds_read_b64_tr_b16 a[218:219], v5 offset:7168
    v_fma_f32 v57, v57, s28, v9
    v_mfma_f32_16x16x32_bf16 v[176:179], a[228:231], v[20:23], v[176:179]
    ds_read_b128 a[172:175], v105 offset:18432
    v_fma_f32 v83, v83, s28, v12
    v_mfma_f32_16x16x32_bf16 v[224:227], a[228:231], v[26:29], v[224:227]
    ds_read_b64_tr_b16 a[224:225], v3 offset:2048
    v_fma_f32 v75, v75, s28, v11
    v_mfma_f32_16x16x32_bf16 a[16:19], a[228:231], v[32:35], a[16:19]
    s_waitcnt lgkmcnt(7)
    ds_read_b64_tr_b16 a[220:221], v2 offset:2048
    v_fma_f32 v73, v73, s28, v11
    v_mfma_f32_16x16x32_bf16 v[132:135], a[232:235], v[14:17], v[132:135]
    s_add_u32 s39, s39, 12288
    ds_read_b64_tr_b16 a[228:229], v4 offset:2048
    v_fma_f32 v63, v63, s28, v10
    v_mfma_f32_16x16x32_bf16 v[180:183], a[232:235], v[20:23], v[180:183]
    ds_read_b64_tr_b16 a[230:231], v4 offset:8192
    v_fma_f32 v77, v77, s28, v12
    v_mfma_f32_16x16x32_bf16 v[228:231], a[232:235], v[26:29], v[228:231]
    ds_read_b64_tr_b16 a[226:227], v3 offset:8192
    v_fma_f32 v76, v76, s28, v12
    v_mfma_f32_16x16x32_bf16 a[20:23], a[232:235], v[32:35], a[20:23]
    ds_read_b64_tr_b16 a[234:235], v5 offset:8192
    v_fma_f32 v62, v62, s28, v10
    v_mfma_f32_16x16x32_bf16 v[136:139], a[212:215], v[14:17], v[136:139]
    ds_read_b64_tr_b16 a[232:233], v5 offset:2048
    v_fma_f32 v74, v74, s28, v11
    v_mfma_f32_16x16x32_bf16 v[184:187], a[212:215], v[20:23], v[184:187]
    ds_read_b128 a[124:127], v105 offset:6144
    v_exp_f32 v78, v78
    v_mfma_f32_16x16x32_bf16 v[232:235], a[212:215], v[26:29], v[232:235]
    ds_read_b128 a[168:171], v104 offset:18432
    v_exp_f32 v75, v75
    v_mfma_f32_16x16x32_bf16 a[24:27], a[212:215], v[32:35], a[24:27]
    s_waitcnt lgkmcnt(9)
    ds_read_b128 a[156:159], v105 offset:14336
    v_fma_f32 v80, v80, s28, v12
    v_mfma_f32_16x16x32_bf16 v[140:143], a[216:219], v[14:17], v[140:143]
    v_exp_f32 v56, v56
    v_mfma_f32_16x16x32_bf16 v[188:191], a[216:219], v[20:23], v[188:191]
    ds_read_b128 a[148:151], v105 offset:12288
    v_exp_f32 v57, v57
    v_mfma_f32_16x16x32_bf16 v[236:239], a[216:219], v[26:29], v[236:239]
    v_exp_f32 v76, v76
    v_mfma_f32_16x16x32_bf16 a[28:31], a[216:219], v[32:35], a[28:31]
    s_waitcnt lgkmcnt(6)
    ds_read_b128 a[144:147], v104 offset:12288
    v_exp_f32 v62, v62
    v_mfma_f32_16x16x32_bf16 v[144:147], a[220:223], v[14:17], v[144:147]
    ds_read_b128 a[180:183], v105 offset:20480
    s_waitcnt vmcnt(20) lgkmcnt(6)
    v_mfma_f32_16x16x32_bf16 v[192:195], a[220:223], v[20:23], v[192:195]
    s_add_u32 s21, s21, s62
    v_exp_f32 v68, v68
    v_mfma_f32_16x16x32_bf16 v[240:243], a[220:223], v[26:29], v[240:243]
    s_barrier
    v_mfma_f32_16x16x32_bf16 a[32:35], a[220:223], v[32:35], a[32:35]
    s_add_u32 m0, s22, 24576
    ds_read_b128 a[216:219], v1 offset:0
    buffer_load_dwordx4 v6, s[8:11], s21 offen lds
    v_mfma_f32_16x16x32_bf16 v[148:151], a[224:227], v[14:17], v[148:151]
    s_add_u32 s21, s21, 128
    v_exp_f32 v69, v69
    v_mfma_f32_16x16x32_bf16 v[196:199], a[224:227], v[20:23], v[196:199]
    s_add_u32 m0, s22, 25600
    ds_read_b128 a[212:215], v0 offset:0
    buffer_load_dwordx4 v6, s[8:11], s21 offen lds
    v_mfma_f32_16x16x32_bf16 v[244:247], a[224:227], v[26:29], v[244:247]
    s_add_u32 s21, s21, 128
    v_exp_f32 v71, v71
    v_mfma_f32_16x16x32_bf16 a[36:39], a[224:227], v[32:35], a[36:39]
    s_add_u32 m0, s22, 26624
    ds_read_b128 a[120:123], v104 offset:6144
    buffer_load_dwordx4 v6, s[8:11], s21 offen lds
    v_mfma_f32_16x16x32_bf16 v[152:155], a[228:231], v[14:17], v[152:155]
    s_add_u32 s21, s21, 12032
    ds_read_b128 a[220:223], v0 offset:1024
    v_fma_f32 v82, v82, s28, v12
    v_mfma_f32_16x16x32_bf16 v[200:203], a[228:231], v[20:23], v[200:203]
    s_waitcnt vmcnt(14)
    ds_read_b128 a[192:195], v104 offset:24576
    v_exp_f32 v70, v70
    v_mfma_f32_16x16x32_bf16 v[248:251], a[228:231], v[26:29], v[248:251]
    ds_read_b128 a[100:103], v105 offset:0
    v_cvt_pk_bf16_f32 v30, v68, v69
    v_mfma_f32_16x16x32_bf16 a[40:43], a[228:231], v[32:35], a[40:43]
    ds_read_b128 a[128:131], v104 offset:8192
    v_cvt_pk_bf16_f32 v31, v70, v71
    v_mfma_f32_16x16x32_bf16 v[156:159], a[232:235], v[14:17], v[156:159]
    v_exp_f32 v77, v77
    v_mfma_f32_16x16x32_bf16 v[204:207], a[232:235], v[20:23], v[204:207]
    ds_read_b128 a[152:155], v104 offset:14336
    v_exp_f32 v63, v63
    v_mfma_f32_16x16x32_bf16 v[252:255], a[232:235], v[26:29], v[252:255]
    s_waitcnt vmcnt(11)
    ds_read_b128 a[196:199], v105 offset:24576
    v_cvt_pk_bf16_f32 v25, v62, v63
    v_mfma_f32_16x16x32_bf16 a[44:47], a[232:235], v[32:35], a[44:47]
    s_waitcnt lgkmcnt(7)
    v_exp_f32 v59, v59
    v_mfma_f32_16x16x32_bf16 v[52:55], a[212:215], a[96:99], 0
    s_waitcnt lgkmcnt(6)
    ds_read_b128 a[132:135], v105 offset:8192
    v_cvt_pk_bf16_f32 v17, v58, v59
    v_mfma_f32_16x16x32_bf16 v[60:63], a[212:215], a[120:123], 0
    ds_read_b128 a[200:203], v104 offset:26624
    v_cvt_pk_bf16_f32 v37, v78, v79
    v_mfma_f32_16x16x32_bf16 v[68:71], a[212:215], a[144:147], 0
    v_cvt_pk_bf16_f32 v36, v76, v77
    v_fma_f32 v72, v72, s28, v11
    v_mfma_f32_16x16x32_bf16 v[76:79], a[212:215], a[168:171], 0
    s_waitcnt lgkmcnt(6)
    ds_read_b128 a[176:179], v104 offset:20480
    v_fma_f32 v66, v66, s28, v10
    v_mfma_f32_16x16x32_bf16 v[84:87], a[212:215], a[192:195], 0
    s_waitcnt lgkmcnt(6)
    ds_read_b128 a[224:227], v1 offset:1024
    v_mfma_f32_16x16x32_bf16 v[52:55], a[216:219], a[100:103], v[52:55]
    v_exp_f32 v74, v74
    v_mfma_f32_16x16x32_bf16 v[60:63], a[216:219], a[124:127], v[60:63]
    v_exp_f32 v83, v83
    v_mfma_f32_16x16x32_bf16 v[68:71], a[216:219], a[148:151], v[68:71]
    ds_read_b128 a[228:231], v0 offset:6144
    v_cvt_pk_bf16_f32 v16, v56, v57
    v_mfma_f32_16x16x32_bf16 v[76:79], a[216:219], a[172:175], v[76:79]
    ds_read_b128 a[204:207], v105 offset:26624
    v_fma_f32 v67, v67, s28, v10
    v_mfma_f32_16x16x32_bf16 v[48:51], a[236:239], v[16:19], v[44:47]
    s_waitcnt lgkmcnt(6)
    v_exp_f32 v80, v80
    v_mfma_f32_16x16x32_bf16 v[84:87], a[216:219], a[196:199], v[84:87]
    ds_read_b128 a[232:235], v1 offset:6144
    v_cvt_pk_bf16_f32 v29, v74, v75
    v_mfma_f32_16x16x32_bf16 v[52:55], a[220:223], a[104:107], v[52:55]
    v_exp_f32 v66, v66
    v_mfma_f32_16x16x32_bf16 v[60:63], a[220:223], a[128:131], v[60:63]
    v_exp_f32 v82, v82
    v_mfma_f32_16x16x32_bf16 v[68:71], a[220:223], a[152:155], v[68:71]
    s_waitcnt lgkmcnt(4)
    v_exp_f32 v65, v65
    v_mfma_f32_16x16x32_bf16 v[76:79], a[220:223], a[176:179], v[76:79]
    v_exp_f32 v67, v67
    v_mfma_f32_16x16x32_bf16 v[84:87], a[220:223], a[200:203], v[84:87]
    s_waitcnt lgkmcnt(3)
    v_exp_f32 v73, v73
    v_mfma_f32_16x16x32_bf16 v[52:55], a[224:227], a[108:111], v[52:55]
    v_exp_f32 v72, v72
    v_mfma_f32_16x16x32_bf16 v[60:63], a[224:227], a[132:135], v[60:63]
    ds_read_b128 a[112:115], v104 offset:4096
    v_cvt_pk_bf16_f32 v35, v82, v83
    v_mfma_f32_16x16x32_bf16 v[68:71], a[224:227], a[156:159], v[68:71]
    ds_read_b128 a[220:223], v0 offset:2048
    v_cvt_pk_bf16_f32 v28, v72, v73
    v_mfma_f32_16x16x32_bf16 v[76:79], a[224:227], a[180:183], v[76:79]
    s_waitcnt lgkmcnt(3)
    v_cvt_pk_bf16_f32 v22, v64, v65
    v_cvt_pk_bf16_f32 v23, v66, v67
    v_mfma_f32_16x16x32_bf16 v[84:87], a[224:227], a[204:207], v[84:87]
    v_exp_f32 v81, v81
    v_mfma_f32_16x16x32_bf16 v[56:59], a[228:231], a[96:99], 0
    ds_read_b128 a[212:215], v0 offset:7168
    v_cvt_pk_bf16_f32 v34, v80, v81
    v_mfma_f32_16x16x32_bf16 v[64:67], a[228:231], a[120:123], 0
    s_waitcnt vmcnt(8)
    ds_read_b128 a[140:143], v105 offset:10240
    v_mfma_f32_16x16x32_bf16 v[72:75], a[228:231], a[144:147], 0
    v_mfma_f32_16x16x32_bf16 v[80:83], a[228:231], a[168:171], 0
    ds_read_b128 a[224:227], v1 offset:2048
    v_mfma_f32_16x16x32_bf16 v[88:91], a[228:231], a[192:195], 0
    s_waitcnt lgkmcnt(5)
    v_mfma_f32_16x16x32_bf16 v[56:59], a[232:235], a[100:103], v[56:59]
    ds_read_b128 a[228:231], v0 offset:8192
    v_mfma_f32_16x16x32_bf16 v[64:67], a[232:235], a[124:127], v[64:67]
    v_mfma_f32_16x16x32_bf16 v[72:75], a[232:235], a[148:151], v[72:75]
    ds_read_b128 a[216:219], v1 offset:7168
    v_mfma_f32_16x16x32_bf16 v[80:83], a[232:235], a[172:175], v[80:83]
    ds_read_b128 a[136:139], v104 offset:10240
    v_mfma_f32_16x16x32_bf16 v[88:91], a[232:235], a[196:199], v[88:91]
    ds_read_b128 a[232:235], v1 offset:8192
    v_mfma_f32_16x16x32_bf16 v[48:51], a[240:243], v[22:25], v[48:51]
    ds_read_b128 a[116:119], v105 offset:4096
    v_mfma_f32_16x16x32_bf16 v[48:51], a[244:247], v[28:31], v[48:51]
    v_mfma_f32_16x16x32_bf16 v[48:51], a[248:251], v[34:37], v[48:51]
    s_waitcnt lgkmcnt(6)
    ds_read_b128 a[184:187], v104 offset:22528
    v_mfma_f32_16x16x32_bf16 v[56:59], a[212:215], a[104:107], v[56:59]
    ds_read_b128 a[160:163], v104 offset:16384
    v_mfma_f32_16x16x32_bf16 v[64:67], a[212:215], a[128:131], v[64:67]
    ds_read_b128 a[188:191], v105 offset:22528
    v_mfma_f32_16x16x32_bf16 v[72:75], a[212:215], a[152:155], v[72:75]
    ds_read_b128 a[164:167], v105 offset:16384
    v_cmp_lt_f32 vcc, s29, v48
    v_mfma_f32_16x16x32_bf16 v[80:83], a[212:215], a[176:179], v[80:83]
    v_mfma_f32_16x16x32_bf16 v[88:91], a[212:215], a[200:203], v[88:91]
    s_waitcnt lgkmcnt(7)
    v_mfma_f32_16x16x32_bf16 v[56:59], a[216:219], a[108:111], v[56:59]
    s_nop 0
    s_cbranch_vccnz L_rs_tr45b
L_ret_tr45b:
    v_mfma_f32_16x16x32_bf16 v[64:67], a[216:219], a[132:135], v[64:67]
    s_waitcnt vmcnt(21)
    s_waitcnt vmcnt(18) lgkmcnt(5)
    s_add_u32 m0, s22, 0
    v_mfma_f32_16x16x32_bf16 v[72:75], a[216:219], a[156:159], v[72:75]
    s_barrier
    v_mfma_f32_16x16x32_bf16 v[80:83], a[216:219], a[180:183], v[80:83]
    buffer_load_dwordx4 v6, s[4:7], s20 offen lds
    v_mfma_f32_16x16x32_bf16 v[88:91], a[216:219], a[204:207], v[88:91]
    s_add_u32 s20, s20, 128
    v_mfma_f32_16x16x32_bf16 v[52:55], a[220:223], a[112:115], v[52:55]
    s_add_u32 m0, s22, 1024
    v_mfma_f32_16x16x32_bf16 v[60:63], a[220:223], a[136:139], v[60:63]
    s_waitcnt lgkmcnt(1)
    ds_read_b64_tr_b16 a[212:213], v2 offset:18432
    v_mfma_f32_16x16x32_bf16 v[68:71], a[220:223], a[160:163], v[68:71]
    buffer_load_dwordx4 v6, s[4:7], s20 offen lds
    v_mfma_f32_16x16x32_bf16 v[76:79], a[220:223], a[184:187], v[76:79]
    v_mfma_f32_16x16x32_bf16 v[84:87], a[220:223], a[208:211], v[84:87]
    s_add_u32 s20, s20, 128
    s_add_u32 m0, s22, 2048
    v_mfma_f32_16x16x32_bf16 v[52:55], a[224:227], a[116:119], v[52:55]
    buffer_load_dwordx4 v6, s[4:7], s20 offen lds
    v_mfma_f32_16x16x32_bf16 v[60:63], a[224:227], a[140:143], v[60:63]
    s_waitcnt lgkmcnt(1)
    v_mfma_f32_16x16x32_bf16 v[68:71], a[224:227], a[164:167], v[68:71]
    ds_read_b64_tr_b16 a[214:215], v2 offset:12288
    v_mfma_f32_16x16x32_bf16 v[76:79], a[224:227], a[188:191], v[76:79]
    v_mfma_f32_16x16x32_bf16 v[84:87], a[224:227], v[92:95], v[84:87]
    ds_read_b64_tr_b16 a[216:217], v3 offset:18432
    v_mfma_f32_16x16x32_bf16 v[56:59], a[228:231], a[112:115], v[56:59]
    ds_read_b64_tr_b16 a[218:219], v3 offset:12288
    v_mfma_f32_16x16x32_bf16 v[64:67], a[228:231], a[136:139], v[64:67]
    v_mfma_f32_16x16x32_bf16 v[72:75], a[228:231], a[160:163], v[72:75]
    s_add_u32 s20, s20, 12032
    v_mfma_f32_16x16x32_bf16 v[80:83], a[228:231], a[184:187], v[80:83]
    ds_read_b64_tr_b16 a[220:221], v4 offset:18432
    v_mfma_f32_16x16x32_bf16 v[88:91], a[228:231], a[208:211], v[88:91]
    v_mfma_f32_16x16x32_bf16 v[56:59], a[232:235], a[116:119], v[56:59]
    v_mfma_f32_16x16x32_bf16 v[64:67], a[232:235], a[140:143], v[64:67]
    ds_read_b64_tr_b16 a[222:223], v4 offset:12288
    v_mfma_f32_16x16x32_bf16 v[72:75], a[232:235], a[164:167], v[72:75]
    v_mfma_f32_16x16x32_bf16 v[80:83], a[232:235], a[188:191], v[80:83]
    ds_read_b64_tr_b16 a[224:225], v5 offset:18432
    v_mfma_f32_16x16x32_bf16 v[88:91], a[232:235], v[92:95], v[88:91]
    ds_read_b64_tr_b16 a[226:227], v5 offset:12288
    v_max3_f32 v96, v52, v53, v54
    v_max3_f32 v96, v96, v55, v56
    s_waitcnt lgkmcnt(6)
    v_mfma_f32_16x16x32_bf16 v[112:115], a[212:215], v[16:19], v[112:115]
    s_mov_b32 s67, s34
    v_max3_f32 v96, v96, v57, v58
    v_max_f32 v96, v96, v59
    v_mov_b32 v97, v96
    v_mbcnt_lo_u32_b32 v104, -1, 0
    v_mfma_f32_16x16x32_bf16 v[160:163], a[212:215], v[22:25], v[160:163]
    s_add_u32 s18, s34, 24576
    ds_read_b64_tr_b16 a[230:231], v2 offset:13312
    v_permlane32_swap_b32 v97, v96
    v_max_f32 v96, v96, v97
    v_mov_b32 v97, v96
    v_mfma_f32_16x16x32_bf16 v[208:211], a[212:215], v[28:31], v[208:211]
    s_mov_b32 s34, s33
    ds_read_b64_tr_b16 a[228:229], v2 offset:19456
    v_permlane16_swap_b32 v97, v96
    v_max_f32 v96, v96, v97
    v_mul_f32_e64 v9, -s28, v96
    v_max3_f32 v96, v60, v61, v62
    v_mfma_f32_16x16x32_bf16 a[0:3], a[212:215], v[34:37], a[0:3]
    s_waitcnt lgkmcnt(6)
    v_max3_f32 v96, v96, v63, v64
    v_max3_f32 v96, v96, v65, v66
    v_mfma_f32_16x16x32_bf16 v[116:119], a[216:219], v[16:19], v[116:119]
    v_max_f32 v96, v96, v67
    v_mov_b32 v97, v96
    v_mfma_f32_16x16x32_bf16 v[164:167], a[216:219], v[22:25], v[164:167]
    ds_read_b64_tr_b16 a[214:215], v4 offset:13312
    v_permlane32_swap_b32 v97, v96
    v_max_f32 v96, v96, v97
    v_mov_b32 v97, v96
    v_mfma_f32_16x16x32_bf16 v[212:215], a[216:219], v[28:31], v[212:215]
    s_add_u32 s64, s64, s62
    v_mbcnt_hi_u32_b32 v104, -1, v104
    v_permlane16_swap_b32 v97, v96
    v_mfma_f32_16x16x32_bf16 a[4:7], a[216:219], v[34:37], a[4:7]
    s_waitcnt lgkmcnt(3)
    ds_read_b64_tr_b16 a[232:233], v3 offset:19456
    v_max_f32 v96, v96, v97
    v_mul_f32_e64 v10, -s28, v96
    v_mfma_f32_16x16x32_bf16 v[120:123], a[220:223], v[16:19], v[120:123]
    s_add_u32 s64, s64, 196608
    v_fma_f32 v66, v66, s28, v10
    v_max3_f32 v96, v68, v69, v70
    v_max3_f32 v96, v96, v71, v72
    v_fma_f32 v57, v57, s28, v9
    v_rcp_f32 v50, v50
    v_max3_f32 v96, v96, v73, v74
    v_mfma_f32_16x16x32_bf16 v[168:171], a[220:223], v[22:25], v[168:171]
    s_mov_b32 s39, s64
    ds_read_b64_tr_b16 a[234:235], v3 offset:13312
    v_max_f32 v96, v96, v75
    v_mov_b32 v97, v96
    v_accvgpr_read_b32 v111, a7
    v_mfma_f32_16x16x32_bf16 v[216:219], a[220:223], v[28:31], v[216:219]
    s_add_u32 s37, s37, 1
    ds_read_b64_tr_b16 a[218:219], v5 offset:13312
    v_mov_b32 v100, v48
    v_mfma_f32_16x16x32_bf16 a[8:11], a[220:223], v[34:37], a[8:11]
    ds_read_b64_tr_b16 a[216:217], v5 offset:19456
    v_permlane32_swap_b32 v97, v96
    v_max_f32 v96, v96, v97
    v_mfma_f32_16x16x32_bf16 v[124:127], a[224:227], v[16:19], v[124:127]
    s_bitcmp1_b32 s63, s37
    ds_read_b64_tr_b16 a[212:213], v4 offset:19456
    v_mov_b32 v97, v96
    v_mfma_f32_16x16x32_bf16 v[172:175], a[224:227], v[22:25], v[172:175]
    s_cselect_b32 s62, 4294770688, 0
    v_rcp_f32 v49, v49
    v_permlane16_swap_b32 v97, v96
    v_lshrrev_b32 v106, 5, v104
    v_mul_f32 v161, v161, v49
    v_max_f32 v96, v96, v97
    v_mul_f32_e64 v11, -s28, v96
    v_fma_f32 v63, v63, s28, v10
    v_and_b32 v107, 3, v104
    v_mfma_f32_16x16x32_bf16 v[220:223], a[224:227], v[28:31], v[220:223]
    s_cselect_b32 s42, 0, 325632
    v_permlane32_swap_b32 v48, v100
    v_mul_f32 v160, v160, v49
    v_fma_f32 v55, v55, s28, v9
    v_fma_f32 v61, v61, s28, v10
    v_fma_f32 v71, v71, s28, v11
    v_max3_f32 v96, v76, v77, v78
    v_mfma_f32_16x16x32_bf16 a[12:15], a[224:227], v[34:37], a[12:15]
    s_waitcnt lgkmcnt(3)
    v_mul_f32 v167, v167, v49
    v_fma_f32 v56, v56, s28, v9
    v_max3_f32 v96, v96, v79, v80
    v_mfma_f32_16x16x32_bf16 v[128:131], a[228:231], v[16:19], v[128:131]
    s_add_u32 s35, s35, s42
    ds_read_b64_tr_b16 a[220:221], v2 offset:20480
    v_fma_f32 v60, v60, s28, v10
    v_max3_f32 v96, v96, v81, v82
    v_mfma_f32_16x16x32_bf16 v[176:179], a[228:231], v[22:25], v[176:179]
    s_lshl_b32 s42, s37, 1
    ds_read_b64_tr_b16 a[224:225], v3 offset:20480
    v_exp_f32 v55, v55
    v_max_f32 v96, v96, v83
    v_mov_b32 v97, v96
    v_fma_f32 v52, v52, s28, v9
    v_fma_f32 v75, v75, s28, v11
    v_mfma_f32_16x16x32_bf16 v[224:227], a[228:231], v[28:31], v[224:227]
    s_lshr_b32 s42, s31, s42
    v_exp_f32 v61, v61
    v_permlane32_swap_b32 v97, v96
    v_bfe_u32 v105, v104, 3, 1
    v_mfma_f32_16x16x32_bf16 a[16:19], a[228:231], v[34:37], a[16:19]
    s_and_b32 s42, s42, 3
    ds_read_b64_tr_b16 a[226:227], v3 offset:14336
    v_fma_f32 v53, v53, s28, v9
    v_fma_f32 v70, v70, s28, v11
    v_max_f32 v96, v96, v97
    v_fma_f32 v74, v74, s28, v11
    v_mfma_f32_16x16x32_bf16 v[132:135], a[232:235], v[16:19], v[132:135]
    s_add_u32 s42, s42, s36
    ds_read_b64_tr_b16 a[222:223], v2 offset:14336
    v_mov_b32 v97, v96
    v_xor_b32 v106, v106, v105
    v_mfma_f32_16x16x32_bf16 v[180:183], a[232:235], v[22:25], v[180:183]
    s_sub_u32 s43, s42, 3
    v_permlane16_swap_b32 v97, v96
    v_mfma_f32_16x16x32_bf16 v[228:231], a[232:235], v[28:31], v[228:231]
    s_cmp_ge_u32 s42, 3
    ds_read_b64_tr_b16 a[228:229], v4 offset:20480
    s_cselect_b32 s42, s43, s42
    v_max_f32 v96, v96, v97
    v_mfma_f32_16x16x32_bf16 a[20:23], a[232:235], v[34:37], a[20:23]
    s_waitcnt lgkmcnt(4)
    v_exp_f32 v53, v53
    v_mul_f32 v163, v163, v49
    v_mfma_f32_16x16x32_bf16 v[136:139], a[212:215], v[16:19], v[136:139]
    s_mul_i32 s44, s3, 5
    v_mul_f32_e64 v12, -s28, v96
    v_cvt_pk_bf16_f32 v160, v160, v161
    v_fma_f32 v59, v59, s28, v9
    v_mfma_f32_16x16x32_bf16 v[184:187], a[212:215], v[22:25], v[184:187]
    s_mov_b32 s32, 1
    ds_read_b64_tr_b16 a[230:231], v4 offset:14336
    v_fma_f32 v80, v80, s28, v12
    v_mul_f32 v176, v176, v49
    v_exp_f32 v60, v60
    v_max3_f32 v96, v84, v85, v86
    v_mfma_f32_16x16x32_bf16 v[232:235], a[212:215], v[28:31], v[232:235]
    s_lshl_b32 s43, s3, 2
    v_exp_f32 v52, v52
    v_mfma_f32_16x16x32_bf16 a[24:27], a[212:215], v[34:37], a[24:27]
    s_add_u32 s45, s43, 21
    v_fma_f32 v67, v67, s28, v10
    v_lshl_or_b32 v106, v107, 1, v106
    v_max3_f32 v96, v96, v87, v88
    v_fma_f32 v68, v68, s28, v11
    v_max3_f32 v96, v96, v89, v90
    v_max_f32 v96, v96, v91
    v_accvgpr_read_b32 v110, a6
    v_pk_mul_f32 v[208:209], v[208:209], v[50:51] op_sel_hi:[1,0]
    v_fma_f32 v82, v82, s28, v12
    v_mov_b32 v97, v96
    v_mfma_f32_16x16x32_bf16 v[140:143], a[216:219], v[16:19], v[140:143]
    s_cmp_eq_u32 s3, 0
    v_exp_f32 v71, v71
    v_exp_f32 v57, v57
    v_mfma_f32_16x16x32_bf16 v[188:191], a[216:219], v[22:25], v[188:191]
    s_cselect_b32 s45, 20, s45
    s_cselect_b32 s33, 1, 0
    ds_read_b64_tr_b16 a[232:233], v5 offset:20480
    v_permlane32_swap_b32 v97, v96
    v_xor_b32 v105, s65, v105
    v_fma_f32 v78, v78, s28, v12
    v_mul_f32 v175, v175, v49
    v_mul_f32 v162, v162, v49
    v_mfma_f32_16x16x32_bf16 v[236:239], a[216:219], v[28:31], v[236:239]
    s_cmp_eq_u32 s42, 1
    v_mul_f32 v177, v177, v49
    v_exp_f32 v75, v75
    v_fma_f32 v69, v69, s28, v11
    v_mfma_f32_16x16x32_bf16 a[28:31], a[216:219], v[34:37], a[28:31]
    s_cselect_b32 s44, s45, s44
    v_cvt_pk_bf16_f32 v161, v162, v163
    v_mul_f32 v178, v178, v49
    s_waitcnt lgkmcnt(1)
    v_mfma_f32_16x16x32_bf16 v[144:147], a[220:223], v[16:19], v[144:147]
    s_cselect_b32 s32, s33, s32
    s_add_u32 s45, s43, 37
    s_cmp_eq_u32 s42, 2
    v_rcp_f32 v48, v48
    v_mfma_f32_16x16x32_bf16 v[192:195], a[220:223], v[22:25], v[192:195]
    s_cselect_b32 s44, s45, s44
    v_mul_f32 v165, v165, v49
    v_max_f32 v96, v96, v97
    v_mfma_f32_16x16x32_bf16 v[240:243], a[220:223], v[28:31], v[240:243]
    s_cselect_b32 s32, 0, s32
    v_accvgpr_read_b32 v109, a5
    v_mov_b32 v97, v96
    v_mfma_f32_16x16x32_bf16 a[32:35], a[220:223], v[34:37], a[32:35]
    s_mul_i32 s44, s44, 6144
    v_lshl_add_u32 v101, v105, 10, s38
    v_fma_f32 v62, v62, s28, v10
    v_mfma_f32_16x16x32_bf16 v[148:151], a[224:227], v[16:19], v[148:151]
    s_add_u32 s33, s35, s44
    s_mul_i32 s42, s32, 6144
    v_fma_f32 v76, v76, s28, v12
    v_mfma_f32_16x16x32_bf16 v[196:199], a[224:227], v[22:25], v[196:199]
    s_add_u32 s42, s42, 24576
    v_exp_f32 v78, v78
    s_add_u32 s42, s42, s33
    v_mfma_f32_16x16x32_bf16 v[244:247], a[224:227], v[28:31], v[244:247]
    s_cmp_ge_u32 s37, 6
    ds_read_b64_tr_b16 a[234:235], v5 offset:14336
    v_fma_f32 v72, v72, s28, v11
    v_permlane16_swap_b32 v97, v96
    v_fma_f32 v54, v54, s28, v9
    v_exp_f32 v63, v63
    v_mfma_f32_16x16x32_bf16 a[36:39], a[224:227], v[34:37], a[36:39]
    s_cselect_b32 s14, 0, s42
    v_cvt_pk_bf16_f32 v20, v60, v61
    v_rcp_f32 v51, v51
    v_exp_f32 v69, v69
    v_mul_f32 v182, v182, v49
    v_pk_mul_f32 v[112:113], v[112:113], v[48:49] op_sel_hi:[1,0]
    v_fma_f32 v81, v81, s28, v12
    v_max_f32 v96, v96, v97
    v_exp_f32 v70, v70
    s_add_u32 s24, s67, 256
    v_mul_f32 v183, v183, v49
    v_exp_f32 v67, v67
    s_add_u32 s25, s33, 256
    v_exp_f32 v62, v62
    v_mfma_f32_16x16x32_bf16 v[152:155], a[228:231], v[16:19], v[152:155]
    s_add_u32 s23, s38, 4096
    v_mul_f32_e64 v13, -s28, v96
    v_fma_f32 v58, v58, s28, v9
    v_mul_f32 v172, v172, v49
    s_mov_b32 s27, 0x49249249
    v_mfma_f32_16x16x32_bf16 v[200:203], a[228:231], v[22:25], v[200:203]
    s_mov_b32 s30, 0
    v_fma_f32 v83, v83, s28, v12
    v_mul_f32 v174, v174, v49
    v_mfma_f32_16x16x32_bf16 v[248:251], a[228:231], v[28:31], v[248:251]
    s_waitcnt vmcnt(8) lgkmcnt(0)
    v_exp_f32 v68, v68
    s_barrier
    ds_read_b128 a[220:223], v0 offset:13312
    v_pk_mul_f32 v[126:127], v[126:127], v[48:49] op_sel_hi:[1,0]
    v_fma_f32 v73, v73, s28, v11
    v_pk_mul_f32 v[212:213], v[212:213], v[50:51] op_sel_hi:[1,0]
    v_exp_f32 v54, v54
    v_mul_f32 v188, v188, v49
    v_cvt_pk_bf16_f32 v21, v62, v63
    v_mfma_f32_16x16x32_bf16 a[40:43], a[228:231], v[34:37], a[40:43]
    s_add_u32 m0, s22, 36864
    ds_read_b128 a[212:215], v0 offset:12288
    v_fma_f32 v85, v85, s28, v13
    v_cvt_pk_bf16_f32 v15, v54, v55
    v_cvt_pk_bf16_f32 v14, v52, v53
    v_mul_f32 v166, v166, v49
    v_mul_f32 v184, v184, v49
    v_mfma_f32_16x16x32_bf16 v[156:159], a[232:235], v[16:19], v[156:159]
    ds_read_b128 a[216:219], v1 offset:12288
    v_mul_f32 v191, v191, v49
    v_mul_f32 v187, v187, v49
    v_fma_f32 v86, v86, s28, v13
    v_mfma_f32_16x16x32_bf16 v[204:207], a[232:235], v[22:25], v[204:207]
    v_fma_f32 v84, v84, s28, v13
    v_cvt_pk_bf16_f32 v26, v68, v69
    v_fma_f32 v90, v90, s28, v13
    v_fma_f32 v77, v77, s28, v12
    v_exp_f32 v82, v82
    v_pk_mul_f32 v[236:237], v[236:237], v[50:51] op_sel_hi:[1,0]
    v_fma_f32 v87, v87, s28, v13
    v_exp_f32 v77, v77
    v_exp_f32 v76, v76
    v_mul_f32 v111, v111, v51
    v_lshl_add_u32 v101, v106, 4, v101
    v_fma_f32 v79, v79, s28, v12
    v_cvt_pk_bf16_f32 v32, v76, v77
    v_mfma_f32_16x16x32_bf16 v[252:255], a[232:235], v[28:31], v[252:255]
    ds_read_b128 a[228:231], v0 offset:14336
    v_fma_f32 v89, v89, s28, v13
    v_exp_f32 v79, v79
    v_mul_f32 v110, v110, v51
    v_exp_f32 v80, v80
    v_fma_f32 v65, v65, s28, v10
    v_mfma_f32_16x16x32_bf16 a[44:47], a[232:235], v[34:37], a[44:47]
    s_waitcnt lgkmcnt(2)
    v_exp_f32 v74, v74
    v_mul_f32 v164, v164, v49
    v_exp_f32 v66, v66
    v_mfma_f32_16x16x32_bf16 v[52:55], a[212:215], a[96:99], 0
    s_waitcnt lgkmcnt(1)
    v_exp_f32 v83, v83
    v_mfma_f32_16x16x32_bf16 v[52:55], a[216:219], a[100:103], v[52:55]
    v_and_b32 v107, 7, v104
    v_mul_f32 v109, v109, v51
    v_fma_f32 v64, v64, s28, v10
    v_mfma_f32_16x16x32_bf16 v[52:55], a[220:223], a[104:107], v[52:55]
    v_mul_f32 v206, v206, v49
    v_cvt_pk_bf16_f32 v27, v70, v71
    v_lshl_add_u32 v101, v107, 7, v101
    v_mfma_f32_16x16x32_bf16 v[60:63], a[212:215], a[120:123], 0
    v_exp_f32 v58, v58
    v_exp_f32 v85, v85
    v_mfma_f32_16x16x32_bf16 v[60:63], a[216:219], a[124:127], v[60:63]
    v_exp_f32 v87, v87
    v_mfma_f32_16x16x32_bf16 v[60:63], a[220:223], a[128:131], v[60:63]
    v_exp_f32 v90, v90
    v_mfma_f32_16x16x32_bf16 v[68:71], a[212:215], a[144:147], 0
    ds_read_b128 a[224:227], v1 offset:13312
    v_accvgpr_read_b32 v105, a1
    v_mfma_f32_16x16x32_bf16 v[68:71], a[216:219], a[148:151], v[68:71]
    ds_read_b128 a[232:235], v1 offset:14336
    v_cvt_pk_bf16_f32 v164, v164, v165
    v_exp_f32 v84, v84
    v_mfma_f32_16x16x32_bf16 v[68:71], a[220:223], a[152:155], v[68:71]
    v_accvgpr_read_b32 v108, a4
    v_cvt_pk_bf16_f32 v33, v78, v79
    v_bfe_u32 v107, v104, 4, 1
    v_exp_f32 v86, v86
    v_mfma_f32_16x16x32_bf16 v[76:79], a[212:215], a[168:171], 0
    buffer_load_dwordx4 v6, s[8:11], s21 offen lds
    v_cvt_pk_bf16_f32 v112, v112, v113
    v_mfma_f32_16x16x32_bf16 v[76:79], a[216:219], a[172:175], v[76:79]
    v_cvt_pk_bf16_f32 v39, v86, v87
    v_mul_f32 v108, v108, v51
    v_mfma_f32_16x16x32_bf16 v[76:79], a[220:223], a[176:179], v[76:79]
    v_exp_f32 v72, v72
    v_mul_f32 v171, v171, v49
    v_cvt_pk_bf16_f32 v108, v108, v109
    v_mul_f32 v201, v201, v49
    v_cvt_pk_bf16_f32 v38, v84, v85
    v_mfma_f32_16x16x32_bf16 v[84:87], a[212:215], a[192:195], 0
    s_add_u32 s21, s21, 128
    v_accvgpr_read_b32 v106, a2
    v_mul_f32 v200, v200, v49
    v_mul_f32 v105, v105, v51
    v_mul_f32 v170, v170, v49
    v_mfma_f32_16x16x32_bf16 v[84:87], a[216:219], a[196:199], v[84:87]
    v_accvgpr_read_b32 v104, a0
    v_exp_f32 v59, v59
    v_mfma_f32_16x16x32_bf16 v[84:87], a[220:223], a[200:203], v[84:87]
    s_waitcnt lgkmcnt(0)
    v_exp_f32 v65, v65
    v_mfma_f32_16x16x32_bf16 v[52:55], a[224:227], a[108:111], v[52:55]
    v_mul_f32 v194, v194, v49
    v_cvt_pk_bf16_f32 v236, v236, v237
    v_mfma_f32_16x16x32_bf16 v[52:55], a[228:231], a[112:115], v[52:55]
    v_mul_f32 v186, v186, v49
    v_mul_f32 v173, v173, v49
    v_mfma_f32_16x16x32_bf16 v[52:55], a[232:235], a[116:119], v[52:55]
    v_fma_f32 v88, v88, s28, v13
    v_cvt_pk_bf16_f32 v212, v212, v213
    v_mfma_f32_16x16x32_bf16 v[60:63], a[224:227], a[132:135], v[60:63]
    v_exp_f32 v73, v73
    v_mfma_f32_16x16x32_bf16 v[60:63], a[228:231], a[136:139], v[60:63]
    ds_read_b128 a[212:215], v0 offset:18432
    v_mul_f32 v181, v181, v49
    v_mfma_f32_16x16x32_bf16 v[60:63], a[232:235], a[140:143], v[60:63]
    ds_read_b128 a[220:223], v0 offset:19456
    v_cvt_pk_bf16_f32 v17, v58, v59
    v_mfma_f32_16x16x32_bf16 v[68:71], a[224:227], a[156:159], v[68:71]
    v_mul_f32 v198, v198, v49
    v_lshl_add_u32 v101, v107, 3, v101
    v_cvt_pk_bf16_f32 v29, v74, v75
    v_mfma_f32_16x16x32_bf16 v[68:71], a[228:231], a[160:163], v[68:71]
    v_exp_f32 v81, v81
    v_fma_f32 v91, v91, s28, v13
    v_mfma_f32_16x16x32_bf16 v[68:71], a[232:235], a[164:167], v[68:71]
    ds_read_b128 a[216:219], v1 offset:18432
    v_mul_f32 v189, v189, v49
    v_mfma_f32_16x16x32_bf16 v[76:79], a[224:227], a[180:183], v[76:79]
    v_cvt_pk_bf16_f32 v208, v208, v209
    v_cvt_pk_bf16_f32 v23, v66, v67
    v_mfma_f32_16x16x32_bf16 v[76:79], a[228:231], a[184:187], v[76:79]
    v_cvt_pk_bf16_f32 v34, v80, v81
    v_fma_f32 v55, v55, s28, v9
    v_exp_f32 v89, v89
    v_mfma_f32_16x16x32_bf16 v[76:79], a[232:235], a[188:191], v[76:79]
    v_exp_f32 v56, v56
    v_mfma_f32_16x16x32_bf16 v[84:87], a[224:227], a[204:207], v[84:87]
    s_add_u32 m0, s22, 37888
    v_exp_f32 v64, v64
    v_mfma_f32_16x16x32_bf16 v[84:87], a[228:231], a[208:211], v[84:87]
    buffer_load_dwordx4 v6, s[8:11], s21 offen lds
    v_mfma_f32_16x16x32_bf16 v[84:87], a[232:235], v[92:95], v[84:87]
    s_nop 0
    v_fma_f32 v78, v78, s28, v12
    v_mul_f32 v180, v180, v49
    v_exp_f32 v88, v88
    v_fma_f32 v63, v63, s28, v10
    v_pk_mul_f32 v[228:229], v[228:229], v[50:51] op_sel_hi:[1,0]
    v_pk_mul_f32 v[214:215], v[214:215], v[50:51] op_sel_hi:[1,0]
    v_pk_mul_f32 v[210:211], v[210:211], v[50:51] op_sel_hi:[1,0]
    v_cvt_pk_bf16_f32 v109, v110, v111
    v_mul_f32 v204, v204, v49
    v_pk_mul_f32 v[220:221], v[220:221], v[50:51] op_sel_hi:[1,0]
    v_pk_mul_f32 v[128:129], v[128:129], v[48:49] op_sel_hi:[1,0]
    v_exp_f32 v91, v91
    v_cvt_pk_bf16_f32 v16, v56, v57
    v_pk_mul_f32 v[144:145], v[144:145], v[48:49] op_sel_hi:[1,0]
    v_pk_mul_f32 v[116:117], v[116:117], v[48:49] op_sel_hi:[1,0]
    v_pk_mul_f32 v[238:239], v[238:239], v[50:51] op_sel_hi:[1,0]
    v_pk_mul_f32 v[132:133], v[132:133], v[48:49] op_sel_hi:[1,0]
    v_cvt_pk_bf16_f32 v188, v188, v189
    v_pk_mul_f32 v[130:131], v[130:131], v[48:49] op_sel_hi:[1,0]
    v_pk_mul_f32 v[134:135], v[134:135], v[48:49] op_sel_hi:[1,0]
    v_pk_mul_f32 v[114:115], v[114:115], v[48:49] op_sel_hi:[1,0]
    v_cvt_pk_bf16_f32 v172, v172, v173
    v_pk_mul_f32 v[218:219], v[218:219], v[50:51] op_sel_hi:[1,0]
    v_pk_mul_f32 v[120:121], v[120:121], v[48:49] op_sel_hi:[1,0]
    v_cvt_pk_bf16_f32 v209, v210, v211
    s_waitcnt lgkmcnt(0)
    v_mfma_f32_16x16x32_bf16 v[56:59], a[212:215], a[96:99], 0
    v_fma_f32 v60, v60, s28, v10
    v_cvt_pk_bf16_f32 v165, v166, v167
    v_mfma_f32_16x16x32_bf16 v[56:59], a[216:219], a[100:103], v[56:59]
    v_cvt_pk_bf16_f32 v28, v72, v73
    v_cvt_pk_bf16_f32 v22, v64, v65
    v_fma_f32 v68, v68, s28, v11
    v_cvt_pk_bf16_f32 v113, v114, v115
    v_mul_f32 v193, v193, v49
    v_pk_mul_f32 v[152:153], v[152:153], v[48:49] op_sel_hi:[1,0]
    v_fma_f32 v54, v54, s28, v9
    v_mul_f32 v192, v192, v49
    v_mfma_f32_16x16x32_bf16 v[56:59], a[220:223], a[104:107], v[56:59]
    s_add_u32 s21, s21, 128
    v_mul_f32 v185, v185, v49
    v_cvt_pk_bf16_f32 v41, v90, v91
    v_mul_f32 v190, v190, v49
    v_mfma_f32_16x16x32_bf16 v[64:67], a[212:215], a[120:123], 0
    s_add_u32 m0, s22, 38912
    ds_read_b128 a[228:231], v0 offset:20480
    v_mul_f32 v104, v104, v51
    v_mfma_f32_16x16x32_bf16 v[64:67], a[216:219], a[124:127], v[64:67]
    ds_read_b128 a[224:227], v1 offset:19456
    v_fma_f32 v61, v61, s28, v10
    v_mfma_f32_16x16x32_bf16 v[64:67], a[220:223], a[128:131], v[64:67]
    v_accvgpr_read_b32 v107, a3
    v_fma_f32 v71, v71, s28, v11
    v_fma_f32 v76, v76, s28, v12
    v_mfma_f32_16x16x32_bf16 v[72:75], a[212:215], a[144:147], 0
    buffer_load_dwordx4 v6, s[8:11], s21 offen lds
    ds_read_b128 a[232:235], v1 offset:20480
    v_mfma_f32_16x16x32_bf16 v[72:75], a[216:219], a[148:151], v[72:75]
    v_cvt_pk_bf16_f32 v40, v88, v89
    v_cvt_pk_bf16_f32 v180, v180, v181
    v_cvt_pk_bf16_f32 v132, v132, v133
    v_cvt_pk_bf16_f32 v116, v116, v117
    v_cvt_pk_bf16_f32 v128, v128, v129
    v_fma_f32 v62, v62, s28, v10
    v_cvt_pk_bf16_f32 v104, v104, v105
    v_mfma_f32_16x16x32_bf16 v[72:75], a[220:223], a[152:155], v[72:75]
    v_cvt_pk_bf16_f32 v35, v82, v83
    v_accvgpr_read_b32 v111, a15
    v_mfma_f32_16x16x32_bf16 v[80:83], a[212:215], a[168:171], 0
    ds_write2st64_b64 v101, v[112:113], v[160:161] offset0:0 offset1:12
    v_fma_f32 v77, v77, s28, v12
    v_pk_mul_f32 v[216:217], v[216:217], v[50:51] op_sel_hi:[1,0]
    v_mul_f32 v106, v106, v51
    v_fma_f32 v52, v52, s28, v9
    v_pk_mul_f32 v[240:241], v[240:241], v[50:51] op_sel_hi:[1,0]
    v_mul_f32 v107, v107, v51
    v_pk_mul_f32 v[226:227], v[226:227], v[50:51] op_sel_hi:[1,0]
    v_cvt_pk_bf16_f32 v105, v106, v107
    v_pk_mul_f32 v[154:155], v[154:155], v[48:49] op_sel_hi:[1,0]
    v_pk_mul_f32 v[118:119], v[118:119], v[48:49] op_sel_hi:[1,0]
    v_mul_f32 v168, v168, v49
    v_cvt_pk_bf16_f32 v184, v184, v185
    v_mfma_f32_16x16x32_bf16 v[80:83], a[216:219], a[172:175], v[80:83]
    s_add_u32 s21, s21, 12032
    v_exp_f32 v60, v60
    v_mfma_f32_16x16x32_bf16 v[80:83], a[220:223], a[176:179], v[80:83]
    s_waitcnt vmcnt(6) lgkmcnt(1)
    v_accvgpr_read_b32 v107, a11
    v_cvt_pk_bf16_f32 v213, v214, v215
    v_mfma_f32_16x16x32_bf16 v[88:91], a[212:215], a[192:195], 0
    s_barrier
    v_mfma_f32_16x16x32_bf16 v[88:91], a[216:219], a[196:199], v[88:91]
    v_mul_f32 v205, v205, v49
    v_mul_f32 v202, v202, v49
    v_mfma_f32_16x16x32_bf16 v[88:91], a[220:223], a[200:203], v[88:91]
    v_accvgpr_read_b32 v110, a14
    v_mul_f32 v197, v197, v49
    v_mfma_f32_16x16x32_bf16 v[56:59], a[224:227], a[108:111], v[56:59]
    ds_read_b64_tr_b16 a[212:213], v2 offset:0
    v_mul_f32 v195, v195, v49
    v_exp_f32 v54, v54
    v_mfma_f32_16x16x32_bf16 v[56:59], a[228:231], a[112:115], v[56:59]
    s_add_u32 m0, s22, 12288
    v_exp_f32 v63, v63
    v_cvt_pk_bf16_f32 v176, v176, v177
    v_mfma_f32_16x16x32_bf16 v[56:59], a[232:235], a[116:119], v[56:59]
    ds_read_b64_tr_b16 a[214:215], v2 offset:6144
    v_cvt_pk_bf16_f32 v192, v192, v193
    v_mfma_f32_16x16x32_bf16 v[64:67], a[224:227], a[132:135], v[64:67]
    v_fma_f32 v79, v79, s28, v12
    v_mul_f32 v110, v110, v51
    v_mfma_f32_16x16x32_bf16 v[64:67], a[228:231], a[136:139], v[64:67]
    ds_write2st64_b64 v101, v[208:209], v[104:105] offset0:24 offset1:36
    v_fma_f32 v84, v84, s28, v13
    v_pk_mul_f32 v[224:225], v[224:225], v[50:51] op_sel_hi:[1,0]
    v_pk_mul_f32 v[156:157], v[156:157], v[48:49] op_sel_hi:[1,0]
    v_fma_f32 v53, v53, s28, v9
    v_pk_mul_f32 v[232:233], v[232:233], v[50:51] op_sel_hi:[1,0]
    v_cvt_pk_bf16_f32 v120, v120, v121
    v_cvt_pk_bf16_f32 v117, v118, v119
    v_exp_f32 v84, v84
    v_xor_b32 v101, 32, v101
    v_pk_mul_f32 v[138:139], v[138:139], v[48:49] op_sel_hi:[1,0]
    v_mul_f32 v169, v169, v49
    v_pk_mul_f32 v[122:123], v[122:123], v[48:49] op_sel_hi:[1,0]
    v_accvgpr_read_b32 v104, a8
    v_fma_f32 v87, v87, s28, v13
    v_mfma_f32_16x16x32_bf16 v[64:67], a[232:235], a[140:143], v[64:67]
    v_cvt_pk_bf16_f32 v152, v152, v153
    v_cvt_pk_bf16_f32 v216, v216, v217
    v_accvgpr_read_b32 v106, a10
    v_cvt_pk_bf16_f32 v217, v218, v219
    v_cvt_pk_bf16_f32 v181, v182, v183
    v_mul_f32 v111, v111, v51
    v_mfma_f32_16x16x32_bf16 v[72:75], a[224:227], a[156:159], v[72:75]
    ds_read_b64_tr_b16 a[216:217], v3 offset:0
    v_cvt_pk_bf16_f32 v168, v168, v169
    v_mul_f32 v107, v107, v51
    v_cvt_pk_bf16_f32 v173, v174, v175
    v_mfma_f32_16x16x32_bf16 v[72:75], a[228:231], a[160:163], v[72:75]
    v_fma_f32 v58, v58, s28, v9
    v_mul_f32 v104, v104, v51
    v_exp_f32 v68, v68
    v_mfma_f32_16x16x32_bf16 v[72:75], a[232:235], a[164:167], v[72:75]
    v_exp_f32 v62, v62
    v_mfma_f32_16x16x32_bf16 v[80:83], a[224:227], a[180:183], v[80:83]
    ds_write2st64_b64 v101, v[116:117], v[164:165] offset0:0 offset1:12
    v_mfma_f32_16x16x32_bf16 v[80:83], a[228:231], a[184:187], v[80:83]
    ds_read_b64_tr_b16 a[218:219], v3 offset:6144
    v_fma_f32 v66, v66, s28, v10
    v_exp_f32 v87, v87
    v_cvt_pk_bf16_f32 v240, v240, v241
    v_mfma_f32_16x16x32_bf16 v[80:83], a[232:235], a[188:191], v[80:83]
    v_cvt_pk_bf16_f32 v220, v220, v221
    v_accvgpr_read_b32 v105, a9
    v_mfma_f32_16x16x32_bf16 v[88:91], a[224:227], a[204:207], v[88:91]
    buffer_load_dwordx4 v6, s[4:7], s20 offen lds
    v_cvt_pk_bf16_f32 v169, v170, v171
    v_mfma_f32_16x16x32_bf16 v[88:91], a[228:231], a[208:211], v[88:91]
    ds_write2st64_b64 v101, v[212:213], v[108:109] offset0:24 offset1:36
    v_pk_mul_f32 v[222:223], v[222:223], v[50:51] op_sel_hi:[1,0]
    v_pk_mul_f32 v[248:249], v[248:249], v[50:51] op_sel_hi:[1,0]
    v_pk_mul_f32 v[246:247], v[246:247], v[50:51] op_sel_hi:[1,0]
    v_pk_mul_f32 v[230:231], v[230:231], v[50:51] op_sel_hi:[1,0]
    v_pk_mul_f32 v[124:125], v[124:125], v[48:49] op_sel_hi:[1,0]
    v_pk_mul_f32 v[244:245], v[244:245], v[50:51] op_sel_hi:[1,0]
    v_cvt_pk_bf16_f32 v124, v124, v125
    v_pk_mul_f32 v[142:143], v[142:143], v[48:49] op_sel_hi:[1,0]
    v_exp_f32 v76, v76
    v_accvgpr_read_b32 v108, a12
    v_cvt_pk_bf16_f32 v204, v204, v205
    v_pk_mul_f32 v[150:151], v[150:151], v[48:49] op_sel_hi:[1,0]
    v_pk_mul_f32 v[140:141], v[140:141], v[48:49] op_sel_hi:[1,0]
    v_mul_f32 v105, v105, v51
    v_pk_mul_f32 v[136:137], v[136:137], v[48:49] op_sel_hi:[1,0]
    v_exp_f32 v55, v55
    v_accvgpr_read_b32 v109, a13
    v_cvt_pk_bf16_f32 v121, v122, v123
    v_cvt_pk_bf16_f32 v104, v104, v105
    v_fma_f32 v75, v75, s28, v11
    v_cvt_pk_bf16_f32 v232, v232, v233
    v_mul_f32 v106, v106, v51
    v_mfma_f32_16x16x32_bf16 v[88:91], a[232:235], v[92:95], v[88:91]
    v_fma_f32 v85, v85, s28, v13
    v_fma_f32 v67, v67, s28, v10
    v_cvt_pk_bf16_f32 v193, v194, v195
    v_mfma_f32_16x16x32_bf16 v[44:47], a[236:239], v[14:17], 0
    s_waitcnt lgkmcnt(1)
    v_cvt_pk_bf16_f32 v105, v106, v107
    v_cvt_pk_bf16_f32 v125, v126, v127
    v_subrev_u32 v8, 22528, v8
    v_mfma_f32_16x16x32_bf16 v[112:115], a[212:215], v[14:17], 0
    ds_read_b64_tr_b16 a[228:229], v2 offset:1024
    v_cvt_pk_bf16_f32 v228, v228, v229
    v_mul_f32 v108, v108, v51
    v_exp_f32 v52, v52
    v_mul_f32 v109, v109, v51
    v_mfma_f32_16x16x32_bf16 v[160:163], a[212:215], v[20:23], 0
    v_fma_f32 v73, v73, s28, v11
    v_cvt_pk_bf16_f32 v224, v224, v225
    v_mul_f32 v179, v179, v49
    v_cvt_pk_bf16_f32 v108, v108, v109
    v_cvt_pk_bf16_f32 v248, v248, v249
    v_fma_f32 v69, v69, s28, v11
    v_fma_f32 v64, v64, s28, v10
    v_accvgpr_read_b32 v106, a18
    v_mul_f32 v196, v196, v49
    v_mfma_f32_16x16x32_bf16 v[208:211], a[212:215], v[26:29], 0
    v_fma_f32 v70, v70, s28, v11
    v_cvt_pk_bf16_f32 v221, v222, v223
    v_accvgpr_read_b32 v107, a19
    v_mfma_f32_16x16x32_bf16 a[0:3], a[212:215], v[32:35], 0
    ds_read_b64_tr_b16 a[220:221], v4 offset:0
    v_cvt_pk_bf16_f32 v109, v110, v111
    v_xor_b32 v101, 96, v101
    v_mfma_f32_16x16x32_bf16 v[44:47], a[240:243], v[20:23], v[44:47]
    ds_read_b64_tr_b16 a[234:235], v3 offset:7168
    v_exp_f32 v53, v53
    v_exp_f32 v77, v77
    v_mfma_f32_16x16x32_bf16 a[48:51], a[212:215], v[38:41], 0
    ds_write2st64_b64 v101, v[120:121], v[168:169] offset0:0 offset1:12
    v_fma_f32 v65, v65, s28, v10
    v_mfma_f32_16x16x32_bf16 v[116:119], a[216:219], v[14:17], 0
    ds_read_b64_tr_b16 a[222:223], v4 offset:6144
    v_cvt_pk_bf16_f32 v177, v178, v179
    v_exp_f32 v69, v69
    v_accvgpr_read_b32 v111, a23
    v_mfma_f32_16x16x32_bf16 v[164:167], a[216:219], v[20:23], 0
    s_add_u32 s20, s20, 128
    ds_write2st64_b64 v101, v[216:217], v[104:105] offset0:24 offset1:36
    v_fma_f32 v72, v72, s28, v11
    v_xor_b32 v101, 32, v101
    v_mfma_f32_16x16x32_bf16 v[212:215], a[216:219], v[26:29], 0
    ds_write2st64_b64 v101, v[124:125], v[172:173] offset0:0 offset1:12
    v_cvt_pk_bf16_f32 v225, v226, v227
    v_pk_mul_f32 v[234:235], v[234:235], v[50:51] op_sel_hi:[1,0]
    v_pk_mul_f32 v[148:149], v[148:149], v[48:49] op_sel_hi:[1,0]
    v_mul_f32 v106, v106, v51
    v_exp_f32 v64, v64
    v_cvt_pk_bf16_f32 v185, v186, v187
    v_exp_f32 v85, v85
    v_mfma_f32_16x16x32_bf16 a[4:7], a[216:219], v[32:35], 0
    ds_read_b64_tr_b16 a[224:225], v5 offset:0
    v_accvgpr_read_b32 v105, a17
    v_mfma_f32_16x16x32_bf16 v[44:47], a[244:247], v[26:29], v[44:47]
    ds_read_b64_tr_b16 a[230:231], v2 offset:7168
    v_mul_f32 v107, v107, v51
    v_mfma_f32_16x16x32_bf16 a[52:55], a[216:219], v[38:41], 0
    s_waitcnt lgkmcnt(4)
    ds_read_b128 v[96:99], v8 offset:0
    v_cvt_pk_bf16_f32 v200, v200, v201
    v_accvgpr_read_b32 v104, a16
    v_mfma_f32_16x16x32_bf16 v[120:123], a[220:223], v[14:17], 0
    s_add_u32 m0, s22, 13312
    ds_read_b64_tr_b16 a[226:227], v5 offset:6144
    v_cvt_pk_bf16_f32 v129, v130, v131
    v_mul_f32 v111, v111, v51
    v_mfma_f32_16x16x32_bf16 v[168:171], a[220:223], v[20:23], 0
    buffer_load_dwordx4 v6, s[4:7], s20 offen lds
    ds_read_b64_tr_b16 a[232:233], v3 offset:1024
    v_accvgpr_read_b32 v110, a22
    v_exp_f32 v75, v75
    v_mfma_f32_16x16x32_bf16 v[44:47], a[248:251], v[32:35], v[44:47]
    ds_read_b64_tr_b16 a[212:213], v4 offset:1024
    v_mul_f32 v105, v105, v51
    v_mfma_f32_16x16x32_bf16 v[216:219], a[220:223], v[26:29], 0
    ds_read_b64_tr_b16 a[218:219], v5 offset:7168
    v_cvt_pk_bf16_f32 v148, v148, v149
    v_cvt_pk_bf16_f32 v133, v134, v135
    v_mul_f32 v110, v110, v51
    v_mfma_f32_16x16x32_bf16 a[8:11], a[220:223], v[32:35], 0
    s_add_u32 s20, s20, 128
    ds_write2st64_b64 v101, v[220:221], v[108:109] offset0:24 offset1:36
    v_fma_f32 v86, v86, s28, v13
    v_mfma_f32_16x16x32_bf16 v[44:47], a[252:255], v[38:41], v[44:47]
    s_add_u32 m0, s22, 14336
    ds_read_b64_tr_b16 a[216:217], v5 offset:1024
    v_mul_f32 v207, v207, v49
    v_exp_f32 v86, v86
    v_cvt_pk_bf16_f32 v189, v190, v191
    v_pk_mul_f32 v[158:159], v[158:159], v[48:49] op_sel_hi:[1,0]
    v_cvt_pk_bf16_f32 v233, v234, v235
    v_xor_b32 v101, 96, v101
    v_cvt_pk_bf16_f32 v229, v230, v231
    v_accvgpr_read_b32 v109, a21
    v_mul_f32 v104, v104, v51
    v_cvt_pk_bf16_f32 v104, v104, v105
    v_cvt_pk_bf16_f32 v105, v106, v107
    v_cvt_pk_bf16_f32 v136, v136, v137
    v_mfma_f32_16x16x32_bf16 a[56:59], a[220:223], v[38:41], 0
    s_waitcnt lgkmcnt(4)
    ds_write2st64_b64 v101, v[128:129], v[176:177] offset0:4 offset1:16
    v_cvt_pk_bf16_f32 v144, v144, v145
    v_accvgpr_read_b32 v108, a20
    v_mfma_f32_16x16x32_bf16 v[124:127], a[224:227], v[14:17], 0
    buffer_load_dwordx4 v6, s[4:7], s20 offen lds
    v_mfma_f32_16x16x32_bf16 v[172:175], a[224:227], v[20:23], 0
    ds_write2st64_b64 v101, v[224:225], v[104:105] offset0:28 offset1:40
    v_cvt_pk_bf16_f32 v140, v140, v141
    v_fma_f32 v56, v56, s28, v9
    v_mfma_f32_16x16x32_bf16 v[220:223], a[224:227], v[26:29], 0
    buffer_store_dwordx4 v[96:99], v102, s[16:19], s67 offen offset:0 nt
    v_cvt_pk_bf16_f32 v196, v196, v197
    v_accvgpr_read_b32 v104, a24
    v_xor_b32 v101, 32, v101
    v_accvgpr_read_b32 v107, a27
    v_mul_f32 v109, v109, v51
    v_fma_f32 v88, v88, s28, v13
    v_exp_f32 v61, v61
    v_pk_mul_f32 v[252:253], v[252:253], v[50:51] op_sel_hi:[1,0]
    v_mul_f32 v108, v108, v51
    v_mul_f32 v107, v107, v51
    v_fma_f32 v57, v57, s28, v9
    v_pk_mul_f32 v[242:243], v[242:243], v[50:51] op_sel_hi:[1,0]
    v_cvt_pk_bf16_f32 v153, v154, v155
    v_mul_f32 v199, v199, v49
    v_mfma_f32_16x16x32_bf16 a[12:15], a[224:227], v[32:35], 0
    s_add_u32 s20, s20, 12032
    v_accvgpr_read_b32 v106, a26
    v_cvt_pk_bf16_f32 v244, v244, v245
    v_cvt_pk_bf16_f32 v108, v108, v109
    v_mfma_f32_16x16x32_bf16 a[60:63], a[224:227], v[38:41], 0
    s_add_u32 m0, s38, 0
    ds_read_b64_tr_b16 a[214:215], v4 offset:7168
    v_mul_f32 v104, v104, v51
    v_mfma_f32_16x16x32_bf16 v[128:131], a[228:231], v[14:17], 0
    ds_read_b64_tr_b16 a[220:221], v2 offset:2048
    v_cvt_pk_bf16_f32 v109, v110, v111
    v_mfma_f32_16x16x32_bf16 v[176:179], a[228:231], v[20:23], 0
    ds_read_b64_tr_b16 a[226:227], v3 offset:8192
    buffer_load_dwordx4 v6, s[12:15], s33 offen nt lds
    v_accvgpr_read_b32 v110, a30
    v_accvgpr_read_b32 v105, a25
    v_pk_mul_f32 v[146:147], v[146:147], v[48:49] op_sel_hi:[1,0]
    v_pk_mul_f32 v[254:255], v[254:255], v[50:51] op_sel_hi:[1,0]
    v_accvgpr_read_b32 v111, a31
    v_cvt_pk_bf16_f32 v252, v252, v253
    v_mfma_f32_16x16x32_bf16 v[224:227], a[228:231], v[26:29], 0
    ds_write2st64_b64 v101, v[132:133], v[180:181] offset0:4 offset1:16
    v_cvt_pk_bf16_f32 v141, v142, v143
    v_mfma_f32_16x16x32_bf16 a[16:19], a[228:231], v[32:35], 0
    ds_write2st64_b64 v101, v[228:229], v[108:109] offset0:28 offset1:40
    v_mfma_f32_16x16x32_bf16 a[64:67], a[228:231], v[38:41], 0
    ds_read_b128 v[96:99], v8 offset:1024
    v_cvt_pk_bf16_f32 v36, v76, v77
    v_cvt_pk_bf16_f32 v241, v242, v243
    v_mul_f32 v111, v111, v51
    v_cvt_pk_bf16_f32 v137, v138, v139
    v_mul_f32 v105, v105, v51
    v_xor_b32 v101, 96, v101
    v_mul_f32 v203, v203, v49
    v_mul_f32 v106, v106, v51
    v_cvt_pk_bf16_f32 v104, v104, v105
    v_accvgpr_read_b32 v108, a28
    v_cvt_pk_bf16_f32 v105, v106, v107
    v_mfma_f32_16x16x32_bf16 v[132:135], a[232:235], v[14:17], 0
    ds_write2st64_b64 v101, v[136:137], v[184:185] offset0:4 offset1:16
    v_accvgpr_read_b32 v109, a29
    v_mul_f32 v108, v108, v51
    v_cvt_pk_bf16_f32 v237, v238, v239
    v_mfma_f32_16x16x32_bf16 v[180:183], a[232:235], v[20:23], 0
    ds_write2st64_b64 v101, v[232:233], v[104:105] offset0:28 offset1:40
    v_accvgpr_read_b32 v104, a32
    v_mfma_f32_16x16x32_bf16 v[228:231], a[232:235], v[26:29], 0
    ds_read_b64_tr_b16 a[230:231], v4 offset:8192
    v_accvgpr_read_b32 v106, a34
    v_mul_f32 v110, v110, v51
    v_mfma_f32_16x16x32_bf16 a[20:23], a[232:235], v[32:35], 0
    ds_read_b64_tr_b16 a[228:229], v4 offset:2048
    v_mul_f32 v104, v104, v51
    v_mfma_f32_16x16x32_bf16 a[68:71], a[232:235], v[38:41], 0
    s_waitcnt lgkmcnt(4)
    ds_read_b64_tr_b16 a[224:225], v3 offset:2048
    v_mul_f32 v106, v106, v51
    v_mfma_f32_16x16x32_bf16 v[136:139], a[212:215], v[14:17], 0
    v_mul_f32 v109, v109, v51
    v_xor_b32 v101, 32, v101
    v_cvt_pk_bf16_f32 v108, v108, v109
    v_cvt_pk_bf16_f32 v201, v202, v203
    v_cvt_pk_bf16_f32 v253, v254, v255
    v_cvt_pk_bf16_f32 v109, v110, v111
    v_cvt_pk_bf16_f32 v205, v206, v207
    v_mfma_f32_16x16x32_bf16 v[184:187], a[212:215], v[20:23], 0
    v_accvgpr_read_b32 v105, a33
    v_cvt_pk_bf16_f32 v156, v156, v157
    v_mfma_f32_16x16x32_bf16 v[232:235], a[212:215], v[26:29], 0
    ds_read_b64_tr_b16 a[222:223], v2 offset:8192
    v_fma_f32 v91, v91, s28, v13
    v_accvgpr_read_b32 v107, a35
    v_mfma_f32_16x16x32_bf16 a[24:27], a[212:215], v[32:35], 0
    s_add_u32 m0, s38, 1024
    ds_write2st64_b64 v101, v[140:141], v[188:189] offset0:4 offset1:16
    v_cvt_pk_bf16_f32 v30, v68, v69
    v_mfma_f32_16x16x32_bf16 a[72:75], a[212:215], v[38:41], 0
    ds_write2st64_b64 v101, v[236:237], v[108:109] offset0:28 offset1:40
    v_accvgpr_read_b32 v110, a38
    v_cvt_pk_bf16_f32 v197, v198, v199
    v_cvt_pk_bf16_f32 v145, v146, v147
    v_accvgpr_read_b32 v108, a36
    v_mfma_f32_16x16x32_bf16 v[140:143], a[216:219], v[14:17], 0
    buffer_load_dwordx4 v7, s[12:15], s33 offen nt lds
    ds_read_b64_tr_b16 a[232:233], v5 offset:2048
    v_mfma_f32_16x16x32_bf16 v[188:191], a[216:219], v[20:23], 0
    ds_read_b64_tr_b16 a[234:235], v5 offset:8192
    v_cvt_pk_bf16_f32 v24, v60, v61
    v_mul_f32 v107, v107, v51
    v_mfma_f32_16x16x32_bf16 v[236:239], a[216:219], v[26:29], 0
    s_add_u32 s39, s39, 12288
    v_exp_f32 v56, v56
    v_exp_f32 v70, v70
    v_mul_f32 v105, v105, v51
    v_pk_mul_f32 v[250:251], v[250:251], v[50:51] op_sel_hi:[1,0]
    v_cvt_pk_bf16_f32 v104, v104, v105
    v_cvt_pk_bf16_f32 v105, v106, v107
    v_xor_b32 v101, 96, v101
    v_accvgpr_read_b32 v107, a43
    v_accvgpr_read_b32 v109, a37
    v_accvgpr_read_b32 v106, a42
    v_mfma_f32_16x16x32_bf16 a[28:31], a[216:219], v[32:35], 0
    ds_write2st64_b64 v101, v[144:145], v[192:193] offset0:8 offset1:20
    v_mul_f32 v109, v109, v51
    v_cvt_pk_bf16_f32 v249, v250, v251
    v_mfma_f32_16x16x32_bf16 a[76:79], a[216:219], v[38:41], 0
    s_waitcnt lgkmcnt(3)
    v_mul_f32 v108, v108, v51
    v_cvt_pk_bf16_f32 v245, v246, v247
    v_mfma_f32_16x16x32_bf16 v[144:147], a[220:223], v[14:17], 0
    ds_write2st64_b64 v101, v[240:241], v[104:105] offset0:32 offset1:44
    v_accvgpr_read_b32 v111, a39
    v_cvt_pk_bf16_f32 v108, v108, v109
    v_mul_f32 v111, v111, v51
    v_mfma_f32_16x16x32_bf16 v[192:195], a[220:223], v[20:23], 0
    v_mul_f32 v110, v110, v51
    v_cvt_pk_bf16_f32 v109, v110, v111
    v_mul_f32 v106, v106, v51
    v_mfma_f32_16x16x32_bf16 v[240:243], a[220:223], v[26:29], 0
    v_xor_b32 v101, 32, v101
    v_accvgpr_read_b32 v105, a41
    v_cvt_pk_bf16_f32 v149, v150, v151
    v_mfma_f32_16x16x32_bf16 a[32:35], a[220:223], v[32:35], 0
    s_waitcnt vmcnt(9) lgkmcnt(2)
    ds_write2st64_b64 v101, v[148:149], v[196:197] offset0:8 offset1:20
    v_mfma_f32_16x16x32_bf16 a[80:83], a[220:223], v[38:41], 0
    buffer_store_dwordx4 v[96:99], v103, s[16:19], s67 offen offset:0 nt
    s_barrier
    ds_write2st64_b64 v101, v[244:245], v[108:109] offset0:32 offset1:44
    v_accvgpr_read_b32 v104, a40
    v_cvt_pk_bf16_f32 v43, v86, v87
    v_cvt_pk_bf16_f32 v157, v158, v159
    v_mul_f32 v107, v107, v51
    v_mul_f32 v104, v104, v51
    v_mfma_f32_16x16x32_bf16 v[148:151], a[224:227], v[14:17], 0
    v_xor_b32 v101, 96, v101
    v_accvgpr_read_b32 v111, a47
    v_accvgpr_read_b32 v110, a46
    v_mfma_f32_16x16x32_bf16 v[196:199], a[224:227], v[20:23], 0
    ds_write2st64_b64 v101, v[152:153], v[200:201] offset0:8 offset1:20
    v_mfma_f32_16x16x32_bf16 v[244:247], a[224:227], v[26:29], 0
    s_add_u32 m0, s22, 24576
    ds_read_b128 a[212:215], v0 offset:0
    v_fma_f32 v80, v80, s28, v12
    v_exp_f32 v67, v67
    v_cvt_pk_bf16_f32 v25, v62, v63
    v_mul_f32 v111, v111, v51
    v_mul_f32 v105, v105, v51
    v_cvt_pk_bf16_f32 v104, v104, v105
    v_mfma_f32_16x16x32_bf16 a[36:39], a[224:227], v[32:35], 0
    v_accvgpr_read_b32 v109, a45
    v_accvgpr_read_b32 v108, a44
    v_exp_f32 v71, v71
    v_mfma_f32_16x16x32_bf16 a[84:87], a[224:227], v[38:41], 0
    ds_read_b128 a[220:223], v0 offset:1024
    v_mul_f32 v110, v110, v51
    v_mfma_f32_16x16x32_bf16 v[152:155], a[228:231], v[14:17], 0
    v_cvt_pk_bf16_f32 v105, v106, v107
    v_mul_f32 v108, v108, v51
    v_mfma_f32_16x16x32_bf16 v[200:203], a[228:231], v[20:23], 0
    ds_write2st64_b64 v101, v[248:249], v[104:105] offset0:32 offset1:44
    v_mfma_f32_16x16x32_bf16 v[248:251], a[228:231], v[26:29], 0
    ds_read_b128 a[216:219], v1 offset:0
    v_mul_f32 v109, v109, v51
    v_mfma_f32_16x16x32_bf16 a[40:43], a[228:231], v[32:35], 0
    v_xor_b32 v101, 32, v101
    v_fma_f32 v81, v81, s28, v12
    v_mfma_f32_16x16x32_bf16 a[88:91], a[228:231], v[38:41], 0
    ds_write2st64_b64 v101, v[156:157], v[204:205] offset0:8 offset1:20
    v_cvt_pk_bf16_f32 v108, v108, v109
    v_cvt_pk_bf16_f32 v109, v110, v111
    v_mfma_f32_16x16x32_bf16 v[156:159], a[232:235], v[14:17], 0
    ds_write2st64_b64 v101, v[252:253], v[108:109] offset0:32 offset1:44
    v_mfma_f32_16x16x32_bf16 v[204:207], a[232:235], v[20:23], 0
    v_cvt_pk_bf16_f32 v19, v54, v55
    v_cvt_pk_bf16_f32 v18, v52, v53
    v_mfma_f32_16x16x32_bf16 v[252:255], a[232:235], v[26:29], 0
    v_exp_f32 v73, v73
    v_mfma_f32_16x16x32_bf16 a[44:47], a[232:235], v[32:35], 0
    buffer_load_dwordx4 v6, s[8:11], s21 offen lds
    v_mfma_f32_16x16x32_bf16 a[92:95], a[232:235], v[38:41], 0
    s_waitcnt lgkmcnt(3)
    v_exp_f32 v78, v78
    v_mfma_f32_16x16x32_bf16 v[52:55], a[212:215], a[96:99], 0
    s_waitcnt lgkmcnt(2)
    ds_read_b128 a[228:231], v0 offset:2048
    v_exp_f32 v79, v79
    v_mfma_f32_16x16x32_bf16 v[52:55], a[216:219], a[100:103], v[52:55]
    ds_read_b128 a[224:227], v1 offset:1024
    v_fma_f32 v74, v74, s28, v11
    v_mfma_f32_16x16x32_bf16 v[52:55], a[220:223], a[104:107], v[52:55]
    ds_read_b128 v[96:99], v8 offset:2048
    v_cvt_pk_bf16_f32 v42, v84, v85
    v_mfma_f32_16x16x32_bf16 v[60:63], a[212:215], a[120:123], 0
    v_exp_f32 v65, v65
    v_mfma_f32_16x16x32_bf16 v[60:63], a[216:219], a[124:127], v[60:63]
    v_cvt_pk_bf16_f32 v37, v78, v79
    v_exp_f32 v72, v72
    v_mfma_f32_16x16x32_bf16 v[60:63], a[220:223], a[128:131], v[60:63]
    v_fma_f32 v59, v59, s28, v9
    v_cvt_pk_bf16_f32 v31, v70, v71
    v_mfma_f32_16x16x32_bf16 v[68:71], a[212:215], a[144:147], 0
    ds_read_b128 a[232:235], v1 offset:2048
    v_fma_f32 v90, v90, s28, v13
    v_mfma_f32_16x16x32_bf16 v[68:71], a[216:219], a[148:151], v[68:71]
    v_exp_f32 v58, v58
    v_mfma_f32_16x16x32_bf16 v[68:71], a[220:223], a[152:155], v[68:71]
    v_exp_f32 v57, v57
    v_mfma_f32_16x16x32_bf16 v[76:79], a[212:215], a[168:171], 0
    v_exp_f32 v59, v59
    v_mfma_f32_16x16x32_bf16 v[76:79], a[216:219], a[172:175], v[76:79]
    v_cvt_pk_bf16_f32 v16, v56, v57
    v_cvt_pk_bf16_f32 v28, v72, v73
    v_mfma_f32_16x16x32_bf16 v[76:79], a[220:223], a[176:179], v[76:79]
    s_add_u32 s21, s21, 128
    v_exp_f32 v74, v74
    v_mfma_f32_16x16x32_bf16 v[84:87], a[212:215], a[192:195], 0
    s_add_u32 m0, s22, 25600
    v_fma_f32 v83, v83, s28, v12
    v_cvt_pk_bf16_f32 v17, v58, v59
    v_mfma_f32_16x16x32_bf16 v[84:87], a[216:219], a[196:199], v[84:87]
    v_exp_f32 v66, v66
    v_mfma_f32_16x16x32_bf16 v[84:87], a[220:223], a[200:203], v[84:87]
    s_waitcnt lgkmcnt(1)
    v_exp_f32 v80, v80
    v_mfma_f32_16x16x32_bf16 v[52:55], a[224:227], a[108:111], v[52:55]
    ds_read_b128 a[216:219], v1 offset:6144
    v_cvt_pk_bf16_f32 v22, v64, v65
    v_mfma_f32_16x16x32_bf16 v[52:55], a[228:231], a[112:115], v[52:55]
    s_waitcnt lgkmcnt(1)
    v_exp_f32 v81, v81
    v_mfma_f32_16x16x32_bf16 v[52:55], a[232:235], a[116:119], v[52:55]
    buffer_load_dwordx4 v6, s[8:11], s21 offen lds
    v_mfma_f32_16x16x32_bf16 v[48:51], a[236:239], v[16:19], v[44:47]
    v_cvt_pk_bf16_f32 v23, v66, v67
    v_fma_f32 v89, v89, s28, v13
    v_mfma_f32_16x16x32_bf16 v[60:63], a[224:227], a[132:135], v[60:63]
    v_exp_f32 v88, v88
    v_mfma_f32_16x16x32_bf16 v[48:51], a[240:243], v[22:25], v[48:51]
    s_add_u32 s21, s21, 128
    ds_read_b128 a[220:223], v0 offset:7168
    v_fma_f32 v82, v82, s28, v12
    v_mfma_f32_16x16x32_bf16 v[60:63], a[228:231], a[136:139], v[60:63]
    s_add_u32 m0, s22, 26624
    v_exp_f32 v83, v83
    v_mfma_f32_16x16x32_bf16 v[60:63], a[232:235], a[140:143], v[60:63]
    v_cvt_pk_bf16_f32 v34, v80, v81
    v_cvt_pk_bf16_f32 v29, v74, v75
    v_mfma_f32_16x16x32_bf16 v[68:71], a[224:227], a[156:159], v[68:71]
    v_exp_f32 v82, v82
    v_mfma_f32_16x16x32_bf16 v[68:71], a[228:231], a[160:163], v[68:71]
    buffer_load_dwordx4 v6, s[8:11], s21 offen lds
    v_mfma_f32_16x16x32_bf16 v[68:71], a[232:235], a[164:167], v[68:71]
    s_add_u32 s21, s21, 12032
    v_exp_f32 v91, v91
    v_mfma_f32_16x16x32_bf16 v[76:79], a[224:227], a[180:183], v[76:79]
    ds_read_b128 a[212:215], v0 offset:6144
    v_cvt_pk_bf16_f32 v35, v82, v83
    v_mfma_f32_16x16x32_bf16 v[48:51], a[244:247], v[28:31], v[48:51]
    s_add_u32 s56, s67, 128
    v_exp_f32 v89, v89
    v_mfma_f32_16x16x32_bf16 v[48:51], a[248:251], v[34:37], v[48:51]
    buffer_store_dwordx4 v[96:99], v102, s[16:19], s56 offen offset:0 nt
    s_add_u32 s58, s33, 128
    v_exp_f32 v90, v90
    v_mfma_f32_16x16x32_bf16 v[76:79], a[228:231], a[184:187], v[76:79]
    v_cvt_pk_bf16_f32 v40, v88, v89
    v_mfma_f32_16x16x32_bf16 v[76:79], a[232:235], a[188:191], v[76:79]
    v_cvt_pk_bf16_f32 v41, v90, v91
    s_add_u32 m0, s38, 2048
    v_mfma_f32_16x16x32_bf16 v[84:87], a[224:227], a[204:207], v[84:87]
    buffer_load_dwordx4 v6, s[12:15], s58 offen nt lds
    v_mfma_f32_16x16x32_bf16 v[48:51], a[252:255], v[40:43], v[48:51]
    ds_read_b128 v[96:99], v8 offset:3072
    v_mfma_f32_16x16x32_bf16 v[84:87], a[228:231], a[208:211], v[84:87]
    ds_read_b128 a[228:231], v0 offset:8192
    v_mfma_f32_16x16x32_bf16 v[84:87], a[232:235], v[92:95], v[84:87]
    ds_read_b128 a[224:227], v1 offset:7168
    s_waitcnt lgkmcnt(3)
    v_mfma_f32_16x16x32_bf16 v[56:59], a[212:215], a[96:99], 0
    s_nop 0
    v_cmp_lt_f32 vcc, s29, v48
    v_mfma_f32_16x16x32_bf16 v[56:59], a[216:219], a[100:103], v[56:59]
    s_add_u32 m0, s38, 3072
    ds_read_b128 a[232:235], v1 offset:8192
    v_mfma_f32_16x16x32_bf16 v[56:59], a[220:223], a[104:107], v[56:59]
    s_nop 0
    s_cbranch_vccnz L_rs_tr45d
L_ret_tr45d:
    v_mfma_f32_16x16x32_bf16 v[64:67], a[212:215], a[120:123], 0
    v_mfma_f32_16x16x32_bf16 v[64:67], a[216:219], a[124:127], v[64:67]
    v_fma_f32 v55, v55, s28, v9
    v_fma_f32 v52, v52, s28, v9
    v_mfma_f32_16x16x32_bf16 v[64:67], a[220:223], a[128:131], v[64:67]
    v_fma_f32 v53, v53, s28, v9
    v_fma_f32 v63, v63, s28, v10
    v_mfma_f32_16x16x32_bf16 v[72:75], a[212:215], a[144:147], 0
    v_exp_f32 v52, v52
    v_mfma_f32_16x16x32_bf16 v[72:75], a[216:219], a[148:151], v[72:75]
    s_waitcnt lgkmcnt(3)
    buffer_load_dwordx4 v7, s[12:15], s58 offen nt lds
    v_mfma_f32_16x16x32_bf16 v[72:75], a[220:223], a[152:155], v[72:75]
    v_fma_f32 v62, v62, s28, v10
    v_fma_f32 v54, v54, s28, v9
    v_mfma_f32_16x16x32_bf16 v[80:83], a[212:215], a[168:171], 0
    v_exp_f32 v54, v54
    v_mfma_f32_16x16x32_bf16 v[80:83], a[216:219], a[172:175], v[80:83]
    buffer_store_dwordx4 v[96:99], v103, s[16:19], s56 offen offset:0 nt
    s_waitcnt vmcnt(14) lgkmcnt(0)
    s_barrier
    v_mfma_f32_16x16x32_bf16 v[80:83], a[220:223], a[176:179], v[80:83]
    v_exp_f32 v53, v53
    v_mfma_f32_16x16x32_bf16 v[88:91], a[212:215], a[192:195], 0
    s_add_u32 m0, s22, 0
    v_exp_f32 v63, v63
    v_mfma_f32_16x16x32_bf16 v[88:91], a[216:219], a[196:199], v[88:91]
    v_exp_f32 v55, v55
    v_mfma_f32_16x16x32_bf16 v[88:91], a[220:223], a[200:203], v[88:91]
    buffer_load_dwordx4 v6, s[4:7], s20 offen lds
    v_mfma_f32_16x16x32_bf16 v[56:59], a[224:227], a[108:111], v[56:59]
    ds_read_b64_tr_b16 a[212:213], v2 offset:18432
    v_add_u32 v8, 4096, v8
    v_mfma_f32_16x16x32_bf16 v[56:59], a[228:231], a[112:115], v[56:59]
    s_add_u32 s20, s20, 128
    s_add_u32 m0, s22, 1024
    v_fma_f32 v61, v61, s28, v10
    v_mfma_f32_16x16x32_bf16 v[56:59], a[232:235], a[116:119], v[56:59]
    buffer_load_dwordx4 v6, s[4:7], s20 offen lds
    v_mfma_f32_16x16x32_bf16 v[64:67], a[224:227], a[132:135], v[64:67]
    ds_read_b64_tr_b16 a[214:215], v2 offset:12288
    v_fma_f32 v60, v60, s28, v10
    v_mfma_f32_16x16x32_bf16 v[64:67], a[228:231], a[136:139], v[64:67]
    v_exp_f32 v60, v60
    v_mfma_f32_16x16x32_bf16 v[64:67], a[232:235], a[140:143], v[64:67]
    ds_read_b64_tr_b16 a[216:217], v3 offset:18432
    s_add_u32 s20, s20, 128
    v_mfma_f32_16x16x32_bf16 v[72:75], a[224:227], a[156:159], v[72:75]
    v_exp_f32 v62, v62
    v_mfma_f32_16x16x32_bf16 v[72:75], a[228:231], a[160:163], v[72:75]
    v_cvt_pk_bf16_f32 v14, v52, v53
    v_mfma_f32_16x16x32_bf16 v[72:75], a[232:235], a[164:167], v[72:75]
    v_exp_f32 v61, v61
    v_mfma_f32_16x16x32_bf16 v[80:83], a[224:227], a[180:183], v[80:83]
    ds_read_b64_tr_b16 a[218:219], v3 offset:12288
    s_add_u32 m0, s22, 2048
    v_mfma_f32_16x16x32_bf16 v[80:83], a[228:231], a[184:187], v[80:83]
    buffer_load_dwordx4 v6, s[4:7], s20 offen lds
    v_mfma_f32_16x16x32_bf16 v[80:83], a[232:235], a[188:191], v[80:83]
    ds_read_b64_tr_b16 a[220:221], v4 offset:18432
    v_cvt_pk_bf16_f32 v21, v62, v63
    v_mfma_f32_16x16x32_bf16 v[88:91], a[224:227], a[204:207], v[88:91]
    ds_read_b64_tr_b16 a[222:223], v4 offset:12288
    v_mfma_f32_16x16x32_bf16 v[88:91], a[228:231], a[208:211], v[88:91]
    s_add_u32 s20, s20, 12032
    ds_read_b64_tr_b16 a[224:225], v5 offset:18432
    v_cvt_pk_bf16_f32 v20, v60, v61
    v_mfma_f32_16x16x32_bf16 v[88:91], a[232:235], v[92:95], v[88:91]
    ds_read_b64_tr_b16 a[226:227], v5 offset:12288
    v_cvt_pk_bf16_f32 v15, v54, v55
    s_branch L_loop5
L_tr44:
    s_waitcnt lgkmcnt(6)
    v_mfma_f32_16x16x32_bf16 v[112:115], a[212:215], v[16:19], v[112:115]
    v_fma_f32 v59, v59, s28, v9
    v_fma_f32 v58, v58, s28, v9
    v_mfma_f32_16x16x32_bf16 v[160:163], a[212:215], v[22:25], v[160:163]
    ds_read_b64_tr_b16 a[234:235], v3 offset:13312
    v_fma_f32 v73, v73, s28, v11
    v_mfma_f32_16x16x32_bf16 v[208:211], a[212:215], v[28:31], v[208:211]
    ds_read_b64_tr_b16 a[228:229], v2 offset:19456
    v_fma_f32 v64, v64, s28, v10
    v_mfma_f32_16x16x32_bf16 a[0:3], a[212:215], v[34:37], a[0:3]
    ds_read_b64_tr_b16 a[230:231], v2 offset:13312
    s_waitcnt lgkmcnt(7)
    v_mfma_f32_16x16x32_bf16 v[116:119], a[216:219], v[16:19], v[116:119]
    ds_read_b64_tr_b16 a[214:215], v4 offset:13312
    v_fma_f32 v81, v81, s28, v12
    v_mfma_f32_16x16x32_bf16 v[164:167], a[216:219], v[22:25], v[164:167]
    v_fma_f32 v70, v70, s28, v11
    v_mfma_f32_16x16x32_bf16 v[212:215], a[216:219], v[28:31], v[212:215]
    ds_read_b64_tr_b16 a[212:213], v4 offset:19456
    v_fma_f32 v71, v71, s28, v11
    v_mfma_f32_16x16x32_bf16 a[4:7], a[216:219], v[34:37], a[4:7]
    ds_read_b128 v[96:99], v8 offset:4096
    s_waitcnt lgkmcnt(8)
    v_mfma_f32_16x16x32_bf16 v[120:123], a[220:223], v[16:19], v[120:123]
    v_fma_f32 v79, v79, s28, v12
    v_fma_f32 v66, v66, s28, v10
    v_mfma_f32_16x16x32_bf16 v[168:171], a[220:223], v[22:25], v[168:171]
    ds_read_b64_tr_b16 a[232:233], v3 offset:19456
    v_fma_f32 v74, v74, s28, v11
    v_mfma_f32_16x16x32_bf16 v[216:219], a[220:223], v[28:31], v[216:219]
    v_fma_f32 v77, v77, s28, v12
    v_fma_f32 v68, v68, s28, v11
    v_mfma_f32_16x16x32_bf16 a[8:11], a[220:223], v[34:37], a[8:11]
    s_waitcnt lgkmcnt(6)
    ds_read_b64_tr_b16 a[220:221], v2 offset:20480
    v_fma_f32 v76, v76, s28, v12
    v_mfma_f32_16x16x32_bf16 v[124:127], a[224:227], v[16:19], v[124:127]
    ds_read_b64_tr_b16 a[218:219], v5 offset:13312
    v_fma_f32 v78, v78, s28, v12
    v_mfma_f32_16x16x32_bf16 v[172:175], a[224:227], v[22:25], v[172:175]
    s_add_u32 s39, s39, 12288
    ds_read_b64_tr_b16 a[216:217], v5 offset:19456
    v_fma_f32 v72, v72, s28, v11
    v_mfma_f32_16x16x32_bf16 v[220:223], a[224:227], v[28:31], v[220:223]
    ds_read_b128 v[84:87], v8 offset:2048
    v_fma_f32 v67, v67, s28, v10
    v_mfma_f32_16x16x32_bf16 a[12:15], a[224:227], v[34:37], a[12:15]
    s_waitcnt lgkmcnt(7)
    ds_read_b64_tr_b16 a[222:223], v2 offset:14336
    v_fma_f32 v57, v57, s28, v9
    v_mfma_f32_16x16x32_bf16 v[128:131], a[228:231], v[16:19], v[128:131]
    v_exp_f32 v74, v74
    v_mfma_f32_16x16x32_bf16 v[176:179], a[228:231], v[22:25], v[176:179]
    ds_read_b64_tr_b16 a[226:227], v3 offset:14336
    v_fma_f32 v69, v69, s28, v11
    v_mfma_f32_16x16x32_bf16 v[224:227], a[228:231], v[28:31], v[224:227]
    v_exp_f32 v67, v67
    v_mfma_f32_16x16x32_bf16 a[16:19], a[228:231], v[34:37], a[16:19]
    s_waitcnt lgkmcnt(6)
    ds_read_b64_tr_b16 a[230:231], v4 offset:14336
    v_fma_f32 v65, v65, s28, v10
    v_mfma_f32_16x16x32_bf16 v[132:135], a[232:235], v[16:19], v[132:135]
    v_exp_f32 v79, v79
    v_mfma_f32_16x16x32_bf16 v[180:183], a[232:235], v[22:25], v[180:183]
    ds_read_b64_tr_b16 a[224:225], v3 offset:20480
    v_mfma_f32_16x16x32_bf16 v[228:231], a[232:235], v[28:31], v[228:231]
    ds_read_b64_tr_b16 a[228:229], v4 offset:20480
    v_fma_f32 v82, v82, s28, v12
    v_mfma_f32_16x16x32_bf16 a[20:23], a[232:235], v[34:37], a[20:23]
    ds_read_b64_tr_b16 a[232:233], v5 offset:20480
    v_fma_f32 v75, v75, s28, v11
    v_mfma_f32_16x16x32_bf16 v[136:139], a[212:215], v[16:19], v[136:139]
    ds_read_b64_tr_b16 a[234:235], v5 offset:14336
    v_fma_f32 v62, v62, s28, v10
    v_mfma_f32_16x16x32_bf16 v[184:187], a[212:215], v[22:25], v[184:187]
    v_exp_f32 v62, v62
    v_mfma_f32_16x16x32_bf16 v[232:235], a[212:215], v[28:31], v[232:235]
    v_exp_f32 v71, v71
    v_mfma_f32_16x16x32_bf16 a[24:27], a[212:215], v[34:37], a[24:27]
    s_waitcnt lgkmcnt(5)
    v_fma_f32 v80, v80, s28, v12
    v_fma_f32 v63, v63, s28, v10
    v_mfma_f32_16x16x32_bf16 v[140:143], a[216:219], v[16:19], v[140:143]
    v_exp_f32 v64, v64
    v_mfma_f32_16x16x32_bf16 v[188:191], a[216:219], v[22:25], v[188:191]
    v_exp_f32 v78, v78
    v_mfma_f32_16x16x32_bf16 v[236:239], a[216:219], v[28:31], v[236:239]
    v_exp_f32 v68, v68
    v_mfma_f32_16x16x32_bf16 a[28:31], a[216:219], v[34:37], a[28:31]
    v_exp_f32 v66, v66
    v_mfma_f32_16x16x32_bf16 v[144:147], a[220:223], v[16:19], v[144:147]
    v_exp_f32 v63, v63
    v_mfma_f32_16x16x32_bf16 v[192:195], a[220:223], v[22:25], v[192:195]
    s_waitcnt vmcnt(10) lgkmcnt(0)
    v_mfma_f32_16x16x32_bf16 v[240:243], a[220:223], v[28:31], v[240:243]
    s_barrier
    v_mfma_f32_16x16x32_bf16 a[32:35], a[220:223], v[34:37], a[32:35]
    v_exp_f32 v57, v57
    v_mfma_f32_16x16x32_bf16 v[148:151], a[224:227], v[16:19], v[148:151]
    ds_read_b128 a[212:215], v0 offset:12288
    s_add_u32 m0, s22, 36864
    v_mfma_f32_16x16x32_bf16 v[196:199], a[224:227], v[22:25], v[196:199]
    buffer_load_dwordx4 v6, s[8:11], s21 offen lds
    v_mfma_f32_16x16x32_bf16 v[244:247], a[224:227], v[28:31], v[244:247]
    ds_read_b128 a[216:219], v1 offset:12288
    v_mfma_f32_16x16x32_bf16 a[36:39], a[224:227], v[34:37], a[36:39]
    s_add_u32 s21, s21, 128
    ds_read_b128 a[220:223], v0 offset:13312
    v_cvt_pk_bf16_f32 v21, v62, v63
    v_mfma_f32_16x16x32_bf16 v[152:155], a[228:231], v[16:19], v[152:155]
    s_add_u32 m0, s22, 37888
    v_fma_f32 v56, v56, s28, v9
    v_mfma_f32_16x16x32_bf16 v[200:203], a[228:231], v[22:25], v[200:203]
    v_exp_f32 v70, v70
    v_mfma_f32_16x16x32_bf16 v[248:251], a[228:231], v[28:31], v[248:251]
    buffer_load_dwordx4 v6, s[8:11], s21 offen lds
    v_mfma_f32_16x16x32_bf16 a[40:43], a[228:231], v[34:37], a[40:43]
    v_exp_f32 v73, v73
    v_mfma_f32_16x16x32_bf16 v[156:159], a[232:235], v[16:19], v[156:159]
    s_add_u32 s21, s21, 128
    s_add_u32 m0, s22, 38912
    ds_read_b128 a[224:227], v1 offset:13312
    v_mfma_f32_16x16x32_bf16 v[204:207], a[232:235], v[22:25], v[204:207]
    buffer_load_dwordx4 v6, s[8:11], s21 offen lds
    v_mfma_f32_16x16x32_bf16 v[252:255], a[232:235], v[28:31], v[252:255]
    s_add_u32 s21, s21, 12032
    v_exp_f32 v69, v69
    v_mfma_f32_16x16x32_bf16 a[44:47], a[232:235], v[34:37], a[44:47]
    s_waitcnt lgkmcnt(3)
    ds_read_b128 v[88:91], v8 offset:3072
    v_cvt_pk_bf16_f32 v33, v78, v79
    v_mfma_f32_16x16x32_bf16 v[52:55], a[212:215], a[96:99], 0
    s_waitcnt lgkmcnt(3)
    ds_read_b128 a[232:235], v1 offset:14336
    v_mfma_f32_16x16x32_bf16 v[52:55], a[216:219], a[100:103], v[52:55]
    s_waitcnt lgkmcnt(3)
    v_exp_f32 v77, v77
    v_mfma_f32_16x16x32_bf16 v[52:55], a[220:223], a[104:107], v[52:55]
    s_add_u32 s56, s24, 5888
    ds_read_b128 a[228:231], v0 offset:14336
    v_cvt_pk_bf16_f32 v27, v70, v71
    v_mfma_f32_16x16x32_bf16 v[60:63], a[212:215], a[120:123], 0
    v_exp_f32 v72, v72
    v_mfma_f32_16x16x32_bf16 v[60:63], a[216:219], a[124:127], v[60:63]
    buffer_store_dwordx4 v[84:87], v102, s[16:19], s56 offen offset:0 nt
    v_exp_f32 v76, v76
    v_cvt_pk_bf16_f32 v26, v68, v69
    v_mfma_f32_16x16x32_bf16 v[60:63], a[220:223], a[128:131], v[60:63]
    v_exp_f32 v75, v75
    v_mfma_f32_16x16x32_bf16 v[68:71], a[212:215], a[144:147], 0
    s_add_u32 s57, s24, 6016
    ds_read_b128 v[84:87], v8 offset:5120
    v_fma_f32 v83, v83, s28, v12
    v_mfma_f32_16x16x32_bf16 v[68:71], a[216:219], a[148:151], v[68:71]
    v_cvt_pk_bf16_f32 v29, v74, v75
    v_cvt_pk_bf16_f32 v32, v76, v77
    v_mfma_f32_16x16x32_bf16 v[68:71], a[220:223], a[152:155], v[68:71]
    v_exp_f32 v58, v58
    v_mfma_f32_16x16x32_bf16 v[76:79], a[212:215], a[168:171], 0
    v_exp_f32 v81, v81
    v_mfma_f32_16x16x32_bf16 v[76:79], a[216:219], a[172:175], v[76:79]
    v_exp_f32 v56, v56
    v_mfma_f32_16x16x32_bf16 v[76:79], a[220:223], a[176:179], v[76:79]
    s_waitcnt lgkmcnt(1)
    v_exp_f32 v82, v82
    v_mfma_f32_16x16x32_bf16 v[52:55], a[224:227], a[108:111], v[52:55]
    buffer_store_dwordx4 v[88:91], v103, s[16:19], s56 offen offset:0 nt
    s_nop 0
    ds_read_b128 v[88:91], v8 offset:0
    v_exp_f32 v59, v59
    v_mfma_f32_16x16x32_bf16 v[52:55], a[228:231], a[112:115], v[52:55]
    v_exp_f32 v80, v80
    v_mfma_f32_16x16x32_bf16 v[52:55], a[232:235], a[116:119], v[52:55]
    v_cvt_pk_bf16_f32 v34, v80, v81
    v_mfma_f32_16x16x32_bf16 v[60:63], a[224:227], a[132:135], v[60:63]
    ds_read_b128 a[212:215], v0 offset:18432
    v_mfma_f32_16x16x32_bf16 v[60:63], a[228:231], a[136:139], v[60:63]
    ds_read_b128 a[216:219], v1 offset:18432
    v_cvt_pk_bf16_f32 v17, v58, v59
    v_mfma_f32_16x16x32_bf16 v[60:63], a[232:235], a[140:143], v[60:63]
    buffer_store_dwordx4 v[96:99], v102, s[16:19], s57 offen offset:0 nt
    v_cvt_pk_bf16_f32 v23, v66, v67
    v_cvt_pk_bf16_f32 v16, v56, v57
    v_mfma_f32_16x16x32_bf16 v[68:71], a[224:227], a[156:159], v[68:71]
    ds_read_b128 a[220:223], v0 offset:19456
    v_cvt_pk_bf16_f32 v28, v72, v73
    v_mfma_f32_16x16x32_bf16 v[68:71], a[228:231], a[160:163], v[68:71]
    v_exp_f32 v65, v65
    v_mfma_f32_16x16x32_bf16 v[68:71], a[232:235], a[164:167], v[68:71]
    ds_read_b128 v[96:99], v8 offset:1024
    s_add_u32 m0, s38, 22528
    v_mfma_f32_16x16x32_bf16 v[76:79], a[224:227], a[180:183], v[76:79]
    v_exp_f32 v83, v83
    v_mfma_f32_16x16x32_bf16 v[76:79], a[228:231], a[184:187], v[76:79]
    ds_read_b128 a[224:227], v1 offset:19456
    v_cvt_pk_bf16_f32 v22, v64, v65
    v_mfma_f32_16x16x32_bf16 v[76:79], a[232:235], a[188:191], v[76:79]
    ds_read_b128 a[228:231], v0 offset:20480
    v_cvt_pk_bf16_f32 v35, v82, v83
    v_mfma_f32_16x16x32_bf16 v[44:47], a[236:239], v[14:17], v[48:51]
    ds_read_b128 a[232:235], v1 offset:20480
    v_mfma_f32_16x16x32_bf16 v[44:47], a[240:243], v[20:23], v[44:47]
    v_mfma_f32_16x16x32_bf16 v[44:47], a[244:247], v[26:29], v[44:47]
    v_mfma_f32_16x16x32_bf16 v[44:47], a[248:251], v[32:35], v[44:47]
    s_waitcnt lgkmcnt(5)
    v_mfma_f32_16x16x32_bf16 v[56:59], a[212:215], a[96:99], 0
    buffer_load_dwordx4 v6, s[12:15], s25 offen nt lds
    v_mfma_f32_16x16x32_bf16 v[56:59], a[216:219], a[100:103], v[56:59]
    s_add_u32 m0, s38, 23552
    s_waitcnt lgkmcnt(4)
    v_mfma_f32_16x16x32_bf16 v[56:59], a[220:223], a[104:107], v[56:59]
    s_nop 0
    v_cmp_lt_f32 vcc, s29, v44
    v_mfma_f32_16x16x32_bf16 v[64:67], a[212:215], a[120:123], 0
    s_waitcnt lgkmcnt(3)
    buffer_load_dwordx4 v7, s[12:15], s25 offen nt lds
    v_mfma_f32_16x16x32_bf16 v[64:67], a[216:219], a[124:127], v[64:67]
    buffer_store_dwordx4 v[84:87], v103, s[16:19], s57 offen offset:0 nt
    s_cbranch_vccnz L_rs_tr44a
L_ret_tr44a:
    v_fma_f32 v54, v54, s28, v9
    s_waitcnt vmcnt(13) lgkmcnt(0)
    s_add_u32 m0, s22, 12288
    v_mfma_f32_16x16x32_bf16 v[64:67], a[220:223], a[128:131], v[64:67]
    s_barrier
    v_mfma_f32_16x16x32_bf16 v[72:75], a[212:215], a[144:147], 0
    buffer_load_dwordx4 v6, s[4:7], s20 offen lds
    v_mfma_f32_16x16x32_bf16 v[72:75], a[216:219], a[148:151], v[72:75]
    s_add_u32 s20, s20, 128
    v_fma_f32 v55, v55, s28, v9
    s_add_u32 m0, s22, 13312
    v_mfma_f32_16x16x32_bf16 v[72:75], a[220:223], a[152:155], v[72:75]
    buffer_load_dwordx4 v6, s[4:7], s20 offen lds
    v_mfma_f32_16x16x32_bf16 v[80:83], a[212:215], a[168:171], 0
    ds_read_b64_tr_b16 a[212:213], v2 offset:0
    v_fma_f32 v61, v61, s28, v10
    v_mfma_f32_16x16x32_bf16 v[80:83], a[216:219], a[172:175], v[80:83]
    s_add_u32 s20, s20, 128
    ds_read_b64_tr_b16 a[214:215], v2 offset:6144
    s_add_u32 m0, s22, 14336
    v_mfma_f32_16x16x32_bf16 v[80:83], a[220:223], a[176:179], v[80:83]
    buffer_load_dwordx4 v6, s[4:7], s20 offen lds
    v_mfma_f32_16x16x32_bf16 v[56:59], a[224:227], a[108:111], v[56:59]
    v_exp_f32 v55, v55
    v_mfma_f32_16x16x32_bf16 v[56:59], a[228:231], a[112:115], v[56:59]
    v_exp_f32 v54, v54
    v_mfma_f32_16x16x32_bf16 v[56:59], a[232:235], a[116:119], v[56:59]
    ds_read_b64_tr_b16 a[216:217], v3 offset:0
    v_fma_f32 v60, v60, s28, v10
    v_mfma_f32_16x16x32_bf16 v[64:67], a[224:227], a[132:135], v[64:67]
    ds_read_b64_tr_b16 a[218:219], v3 offset:6144
    v_mfma_f32_16x16x32_bf16 v[64:67], a[228:231], a[136:139], v[64:67]
    v_exp_f32 v60, v60
    v_mfma_f32_16x16x32_bf16 v[64:67], a[232:235], a[140:143], v[64:67]
    ds_read_b64_tr_b16 a[220:221], v4 offset:0
    v_cvt_pk_bf16_f32 v19, v54, v55
    v_mfma_f32_16x16x32_bf16 v[72:75], a[224:227], a[156:159], v[72:75]
    ds_read_b64_tr_b16 a[222:223], v4 offset:6144
    v_fma_f32 v53, v53, s28, v9
    v_mfma_f32_16x16x32_bf16 v[72:75], a[228:231], a[160:163], v[72:75]
    v_exp_f32 v53, v53
    v_mfma_f32_16x16x32_bf16 v[72:75], a[232:235], a[164:167], v[72:75]
    buffer_store_dwordx4 v[88:91], v102, s[16:19], s24 offen offset:0 nt
    s_add_u32 s20, s20, 12032
    v_fma_f32 v52, v52, s28, v9
    v_exp_f32 v61, v61
    v_mfma_f32_16x16x32_bf16 v[80:83], a[224:227], a[180:183], v[80:83]
    ds_read_b64_tr_b16 a[224:225], v5 offset:0
    v_cvt_pk_bf16_f32 v24, v60, v61
    v_mfma_f32_16x16x32_bf16 v[80:83], a[228:231], a[184:187], v[80:83]
    v_exp_f32 v52, v52
    v_mfma_f32_16x16x32_bf16 v[80:83], a[232:235], a[188:191], v[80:83]
    buffer_store_dwordx4 v[96:99], v103, s[16:19], s24 offen offset:0 nt
    ds_read_b64_tr_b16 a[226:227], v5 offset:6144
    v_cvt_pk_bf16_f32 v18, v52, v53
    s_waitcnt lgkmcnt(6)
    v_mfma_f32_16x16x32_bf16 v[112:115], a[212:215], v[14:17], v[112:115]
    ds_read_b64_tr_b16 a[234:235], v3 offset:7168
    v_fma_f32 v79, v79, s28, v12
    v_mfma_f32_16x16x32_bf16 v[160:163], a[212:215], v[20:23], v[160:163]
    ds_read_b64_tr_b16 a[228:229], v2 offset:1024
    v_fma_f32 v62, v62, s28, v10
    v_mfma_f32_16x16x32_bf16 v[208:211], a[212:215], v[26:29], v[208:211]
    ds_read_b64_tr_b16 a[230:231], v2 offset:7168
    v_lshrrev_b32 v105, 11, v0
    v_xor_b32 v105, s65, v105
    v_and_b32 v104, 0x3ff, v0
    v_mfma_f32_16x16x32_bf16 a[0:3], a[212:215], v[32:35], a[0:3]
    s_waitcnt lgkmcnt(7)
    v_fma_f32 v82, v82, s28, v12
    v_fma_f32 v63, v63, s28, v10
    v_mfma_f32_16x16x32_bf16 v[116:119], a[216:219], v[14:17], v[116:119]
    ds_read_b64_tr_b16 a[232:233], v3 offset:1024
    v_lshl_add_u32 v104, v105, 10, v104
    v_mfma_f32_16x16x32_bf16 v[164:167], a[216:219], v[20:23], v[164:167]
    ds_read_b64_tr_b16 a[212:213], v4 offset:1024
    v_fma_f32 v67, v67, s28, v10
    v_mfma_f32_16x16x32_bf16 v[212:215], a[216:219], v[26:29], v[212:215]
    v_fma_f32 v70, v70, s28, v11
    v_add_u32 v104, s38, v104
    v_mfma_f32_16x16x32_bf16 a[4:7], a[216:219], v[32:35], a[4:7]
    s_waitcnt lgkmcnt(7)
    ds_read_b128 a[96:99], v104 offset:0
    v_fma_f32 v68, v68, s28, v11
    v_mfma_f32_16x16x32_bf16 v[120:123], a[220:223], v[14:17], v[120:123]
    ds_read_b64_tr_b16 a[214:215], v4 offset:7168
    v_fma_f32 v65, v65, s28, v10
    v_mfma_f32_16x16x32_bf16 v[168:171], a[220:223], v[20:23], v[168:171]
    ds_read_b128 a[128:131], v104 offset:8192
    v_fma_f32 v56, v56, s28, v9
    v_mfma_f32_16x16x32_bf16 v[216:219], a[220:223], v[26:29], v[216:219]
    v_exp_f32 v70, v70
    v_mfma_f32_16x16x32_bf16 a[8:11], a[220:223], v[32:35], a[8:11]
    s_waitcnt lgkmcnt(6)
    ds_read_b64_tr_b16 a[216:217], v5 offset:1024
    v_xor_b32 v105, 64, v104
    v_mfma_f32_16x16x32_bf16 v[124:127], a[224:227], v[14:17], v[124:127]
    ds_read_b64_tr_b16 a[218:219], v5 offset:7168
    v_fma_f32 v76, v76, s28, v12
    v_mfma_f32_16x16x32_bf16 v[172:175], a[224:227], v[20:23], v[172:175]
    v_exp_f32 v79, v79
    v_mfma_f32_16x16x32_bf16 v[220:223], a[224:227], v[26:29], v[220:223]
    ds_read_b128 a[144:147], v104 offset:12288
    v_fma_f32 v66, v66, s28, v10
    v_mfma_f32_16x16x32_bf16 a[12:15], a[224:227], v[32:35], a[12:15]
    s_waitcnt lgkmcnt(6)
    v_exp_f32 v63, v63
    v_mfma_f32_16x16x32_bf16 v[128:131], a[228:231], v[14:17], v[128:131]
    ds_read_b64_tr_b16 a[226:227], v3 offset:8192
    v_exp_f32 v68, v68
    v_mfma_f32_16x16x32_bf16 v[176:179], a[228:231], v[20:23], v[176:179]
    ds_read_b64_tr_b16 a[224:225], v3 offset:2048
    v_fma_f32 v58, v58, s28, v9
    v_mfma_f32_16x16x32_bf16 v[224:227], a[228:231], v[26:29], v[224:227]
    ds_read_b64_tr_b16 a[222:223], v2 offset:8192
    v_fma_f32 v69, v69, s28, v11
    v_mfma_f32_16x16x32_bf16 a[16:19], a[228:231], v[32:35], a[16:19]
    ds_read_b64_tr_b16 a[228:229], v4 offset:2048
    v_fma_f32 v57, v57, s28, v9
    v_mfma_f32_16x16x32_bf16 v[132:135], a[232:235], v[14:17], v[132:135]
    ds_read_b64_tr_b16 a[230:231], v4 offset:8192
    ds_read_b64_tr_b16 a[220:221], v2 offset:2048
    v_mfma_f32_16x16x32_bf16 v[180:183], a[232:235], v[20:23], v[180:183]
    ds_read_b128 a[120:123], v104 offset:6144
    v_fma_f32 v75, v75, s28, v11
    v_mfma_f32_16x16x32_bf16 v[228:231], a[232:235], v[26:29], v[228:231]
    s_add_u32 s39, s39, 12288
    v_exp_f32 v65, v65
    v_mfma_f32_16x16x32_bf16 a[20:23], a[232:235], v[32:35], a[20:23]
    s_waitcnt lgkmcnt(8)
    ds_read_b64_tr_b16 a[232:233], v5 offset:2048
    v_fma_f32 v77, v77, s28, v12
    v_mfma_f32_16x16x32_bf16 v[136:139], a[212:215], v[14:17], v[136:139]
    ds_read_b64_tr_b16 a[234:235], v5 offset:8192
    v_exp_f32 v57, v57
    v_mfma_f32_16x16x32_bf16 v[184:187], a[212:215], v[20:23], v[184:187]
    ds_read_b128 a[172:175], v105 offset:18432
    v_fma_f32 v64, v64, s28, v10
    v_mfma_f32_16x16x32_bf16 v[232:235], a[212:215], v[26:29], v[232:235]
    ds_read_b128 a[104:107], v104 offset:2048
    v_exp_f32 v76, v76
    v_mfma_f32_16x16x32_bf16 a[24:27], a[212:215], v[32:35], a[24:27]
    ds_read_b128 a[124:127], v105 offset:6144
    v_fma_f32 v71, v71, s28, v11
    v_mfma_f32_16x16x32_bf16 v[140:143], a[216:219], v[14:17], v[140:143]
    v_fma_f32 v73, v73, s28, v11
    v_fma_f32 v78, v78, s28, v12
    v_mfma_f32_16x16x32_bf16 v[188:191], a[216:219], v[20:23], v[188:191]
    v_exp_f32 v77, v77
    v_mfma_f32_16x16x32_bf16 v[236:239], a[216:219], v[26:29], v[236:239]
    ds_read_b128 a[152:155], v104 offset:14336
    v_exp_f32 v78, v78
    v_mfma_f32_16x16x32_bf16 a[28:31], a[216:219], v[32:35], a[28:31]
    s_waitcnt lgkmcnt(6)
    ds_read_b128 a[100:103], v105 offset:0
    v_exp_f32 v62, v62
    v_mfma_f32_16x16x32_bf16 v[144:147], a[220:223], v[14:17], v[144:147]
    v_exp_f32 v82, v82
    v_mfma_f32_16x16x32_bf16 v[192:195], a[220:223], v[20:23], v[192:195]
    s_waitcnt vmcnt(14) lgkmcnt(5)
    ds_read_b128 a[132:135], v105 offset:8192
    v_fma_f32 v59, v59, s28, v9
    v_mfma_f32_16x16x32_bf16 v[240:243], a[220:223], v[26:29], v[240:243]
    s_barrier
    v_mfma_f32_16x16x32_bf16 a[32:35], a[220:223], v[32:35], a[32:35]
    s_add_u32 s21, s21, s62
    ds_read_b128 a[216:219], v1 offset:0
    v_cvt_pk_bf16_f32 v25, v62, v63
    v_mfma_f32_16x16x32_bf16 v[148:151], a[224:227], v[14:17], v[148:151]
    s_add_u32 m0, s22, 24576
    ds_read_b128 a[212:215], v0 offset:0
    v_fma_f32 v81, v81, s28, v12
    v_mfma_f32_16x16x32_bf16 v[196:199], a[224:227], v[20:23], v[196:199]
    buffer_load_dwordx4 v6, s[8:11], s21 offen lds
    v_mfma_f32_16x16x32_bf16 v[244:247], a[224:227], v[26:29], v[244:247]
    s_add_u32 s21, s21, 128
    ds_read_b128 a[108:111], v105 offset:2048
    v_fma_f32 v83, v83, s28, v12
    v_mfma_f32_16x16x32_bf16 a[36:39], a[224:227], v[32:35], a[36:39]
    s_add_u32 m0, s22, 25600
    ds_read_b128 a[136:139], v104 offset:10240
    buffer_load_dwordx4 v6, s[8:11], s21 offen lds
    v_mfma_f32_16x16x32_bf16 v[152:155], a[228:231], v[14:17], v[152:155]
    s_add_u32 s21, s21, 128
    ds_read_b128 a[168:171], v104 offset:18432
    v_cvt_pk_bf16_f32 v37, v78, v79
    v_mfma_f32_16x16x32_bf16 v[200:203], a[228:231], v[20:23], v[200:203]
    s_add_u32 m0, s22, 26624
    v_exp_f32 v59, v59
    v_mfma_f32_16x16x32_bf16 v[248:251], a[228:231], v[26:29], v[248:251]
    buffer_load_dwordx4 v6, s[8:11], s21 offen lds
    ds_read_b128 a[148:151], v105 offset:12288
    v_mfma_f32_16x16x32_bf16 a[40:43], a[228:231], v[32:35], a[40:43]
    ds_read_b128 a[220:223], v0 offset:1024
    v_exp_f32 v69, v69
    v_mfma_f32_16x16x32_bf16 v[156:159], a[232:235], v[14:17], v[156:159]
    ds_read_b128 a[176:179], v104 offset:20480
    v_cvt_pk_bf16_f32 v36, v76, v77
    v_mfma_f32_16x16x32_bf16 v[204:207], a[232:235], v[20:23], v[204:207]
    v_cvt_pk_bf16_f32 v30, v68, v69
    v_fma_f32 v72, v72, s28, v11
    v_mfma_f32_16x16x32_bf16 v[252:255], a[232:235], v[26:29], v[252:255]
    v_exp_f32 v72, v72
    v_mfma_f32_16x16x32_bf16 a[44:47], a[232:235], v[32:35], a[44:47]
    s_waitcnt lgkmcnt(5)
    ds_read_b128 a[156:159], v105 offset:14336
    v_exp_f32 v71, v71
    v_mfma_f32_16x16x32_bf16 v[52:55], a[212:215], a[96:99], 0
    ds_read_b128 a[224:227], v1 offset:1024
    v_fma_f32 v80, v80, s28, v12
    v_mfma_f32_16x16x32_bf16 v[60:63], a[212:215], a[120:123], 0
    ds_read_b128 a[228:231], v0 offset:6144
    v_cvt_pk_bf16_f32 v31, v70, v71
    v_mfma_f32_16x16x32_bf16 v[68:71], a[212:215], a[144:147], 0
    s_waitcnt lgkmcnt(6)
    v_exp_f32 v66, v66
    v_mfma_f32_16x16x32_bf16 v[76:79], a[212:215], a[168:171], 0
    v_exp_f32 v75, v75
    v_mfma_f32_16x16x32_bf16 v[52:55], a[216:219], a[100:103], v[52:55]
    ds_read_b128 a[180:183], v105 offset:20480
    v_exp_f32 v64, v64
    v_exp_f32 v56, v56
    v_mfma_f32_16x16x32_bf16 v[60:63], a[216:219], a[124:127], v[60:63]
    s_waitcnt lgkmcnt(4)
    v_exp_f32 v73, v73
    v_mfma_f32_16x16x32_bf16 v[68:71], a[216:219], a[148:151], v[68:71]
    v_exp_f32 v58, v58
    v_mfma_f32_16x16x32_bf16 v[76:79], a[216:219], a[172:175], v[76:79]
    v_exp_f32 v67, v67
    v_mfma_f32_16x16x32_bf16 v[52:55], a[220:223], a[104:107], v[52:55]
    s_add_u32 s21, s21, 12032
    ds_read_b128 a[232:235], v1 offset:6144
    v_cvt_pk_bf16_f32 v22, v64, v65
    v_mfma_f32_16x16x32_bf16 v[60:63], a[220:223], a[128:131], v[60:63]
    ds_read_b128 a[140:143], v105 offset:10240
    v_fma_f32 v74, v74, s28, v11
    v_mfma_f32_16x16x32_bf16 v[68:71], a[220:223], a[152:155], v[68:71]
    v_exp_f32 v83, v83
    v_mfma_f32_16x16x32_bf16 v[76:79], a[220:223], a[176:179], v[76:79]
    s_waitcnt lgkmcnt(3)
    v_exp_f32 v81, v81
    v_mfma_f32_16x16x32_bf16 v[52:55], a[224:227], a[108:111], v[52:55]
    ds_read_b128 a[212:215], v0 offset:7168
    v_cvt_pk_bf16_f32 v17, v58, v59
    v_mfma_f32_16x16x32_bf16 v[60:63], a[224:227], a[132:135], v[60:63]
    ds_read_b128 a[160:163], v104 offset:16384
    v_cvt_pk_bf16_f32 v23, v66, v67
    v_mfma_f32_16x16x32_bf16 v[68:71], a[224:227], a[156:159], v[68:71]
    s_waitcnt lgkmcnt(4)
    v_exp_f32 v80, v80
    v_mfma_f32_16x16x32_bf16 v[76:79], a[224:227], a[180:183], v[76:79]
    ds_read_b128 a[112:115], v104 offset:4096
    v_cvt_pk_bf16_f32 v16, v56, v57
    v_mfma_f32_16x16x32_bf16 v[56:59], a[228:231], a[96:99], 0
    v_exp_f32 v74, v74
    v_mfma_f32_16x16x32_bf16 v[64:67], a[228:231], a[120:123], 0
    v_cvt_pk_bf16_f32 v29, v74, v75
    v_cvt_pk_bf16_f32 v28, v72, v73
    v_mfma_f32_16x16x32_bf16 v[72:75], a[228:231], a[144:147], 0
    v_cvt_pk_bf16_f32 v35, v82, v83
    v_cvt_pk_bf16_f32 v34, v80, v81
    v_mfma_f32_16x16x32_bf16 v[80:83], a[228:231], a[168:171], 0
    s_waitcnt lgkmcnt(3)
    ds_read_b128 a[228:231], v0 offset:8192
    s_waitcnt vmcnt(9)
    v_mfma_f32_16x16x32_bf16 v[56:59], a[232:235], a[100:103], v[56:59]
    ds_read_b128 a[220:223], v0 offset:2048
    v_mfma_f32_16x16x32_bf16 v[64:67], a[232:235], a[124:127], v[64:67]
    ds_read_b128 a[216:219], v1 offset:7168
    v_mfma_f32_16x16x32_bf16 v[72:75], a[232:235], a[148:151], v[72:75]
    ds_read_b128 a[224:227], v1 offset:2048
    v_mfma_f32_16x16x32_bf16 v[80:83], a[232:235], a[172:175], v[80:83]
    ds_read_b128 a[232:235], v1 offset:8192
    v_mfma_f32_16x16x32_bf16 v[48:51], a[236:239], v[16:19], v[44:47]
    ds_read_b128 a[184:187], v104 offset:22528
    v_mfma_f32_16x16x32_bf16 v[48:51], a[240:243], v[22:25], v[48:51]
    v_mfma_f32_16x16x32_bf16 v[48:51], a[244:247], v[28:31], v[48:51]
    v_mfma_f32_16x16x32_bf16 v[48:51], a[248:251], v[34:37], v[48:51]
    s_waitcnt lgkmcnt(6)
    ds_read_b128 a[164:167], v105 offset:16384
    v_mfma_f32_16x16x32_bf16 v[56:59], a[212:215], a[104:107], v[56:59]
    ds_read_b128 a[116:119], v105 offset:4096
    v_mfma_f32_16x16x32_bf16 v[64:67], a[212:215], a[128:131], v[64:67]
    v_mfma_f32_16x16x32_bf16 v[72:75], a[212:215], a[152:155], v[72:75]
    ds_read_b128 a[188:191], v105 offset:22528
    v_mfma_f32_16x16x32_bf16 v[80:83], a[212:215], a[176:179], v[80:83]
    s_waitcnt lgkmcnt(6)
    v_cmp_lt_f32 vcc, s29, v48
    v_mfma_f32_16x16x32_bf16 v[56:59], a[216:219], a[108:111], v[56:59]
    s_waitcnt vmcnt(14) lgkmcnt(4)
    v_mfma_f32_16x16x32_bf16 v[64:67], a[216:219], a[132:135], v[64:67]
    s_barrier
    v_mfma_f32_16x16x32_bf16 v[72:75], a[216:219], a[156:159], v[72:75]
    s_cbranch_vccnz L_rs_tr44b
L_ret_tr44b:
    s_add_u32 m0, s22, 0
    v_mfma_f32_16x16x32_bf16 v[80:83], a[216:219], a[180:183], v[80:83]
    buffer_load_dwordx4 v6, s[4:7], s20 offen lds
    v_mfma_f32_16x16x32_bf16 v[52:55], a[220:223], a[112:115], v[52:55]
    s_add_u32 s20, s20, 128
    s_add_u32 m0, s22, 1024
    v_mfma_f32_16x16x32_bf16 v[60:63], a[220:223], a[136:139], v[60:63]
    buffer_load_dwordx4 v6, s[4:7], s20 offen lds
    v_mfma_f32_16x16x32_bf16 v[68:71], a[220:223], a[160:163], v[68:71]
    s_waitcnt lgkmcnt(1)
    ds_read_b64_tr_b16 a[212:213], v2 offset:18432
    v_mfma_f32_16x16x32_bf16 v[76:79], a[220:223], a[184:187], v[76:79]
    s_add_u32 s20, s20, 128
    s_add_u32 m0, s22, 2048
    v_mfma_f32_16x16x32_bf16 v[52:55], a[224:227], a[116:119], v[52:55]
    buffer_load_dwordx4 v6, s[4:7], s20 offen lds
    v_mfma_f32_16x16x32_bf16 v[60:63], a[224:227], a[140:143], v[60:63]
    ds_read_b64_tr_b16 a[214:215], v2 offset:12288
    v_mfma_f32_16x16x32_bf16 v[68:71], a[224:227], a[164:167], v[68:71]
    s_waitcnt lgkmcnt(2)
    ds_read_b64_tr_b16 a[216:217], v3 offset:18432
    v_mfma_f32_16x16x32_bf16 v[76:79], a[224:227], a[188:191], v[76:79]
    ds_read_b64_tr_b16 a[218:219], v3 offset:12288
    v_mfma_f32_16x16x32_bf16 v[56:59], a[228:231], a[112:115], v[56:59]
    ds_read_b64_tr_b16 a[220:221], v4 offset:18432
    v_mfma_f32_16x16x32_bf16 v[64:67], a[228:231], a[136:139], v[64:67]
    ds_read_b64_tr_b16 a[222:223], v4 offset:12288
    v_mfma_f32_16x16x32_bf16 v[72:75], a[228:231], a[160:163], v[72:75]
    s_add_u32 s20, s20, 12032
    ds_read_b64_tr_b16 a[224:225], v5 offset:18432
    v_mfma_f32_16x16x32_bf16 v[80:83], a[228:231], a[184:187], v[80:83]
    v_mfma_f32_16x16x32_bf16 v[56:59], a[232:235], a[116:119], v[56:59]
    ds_read_b64_tr_b16 a[226:227], v5 offset:12288
    v_mfma_f32_16x16x32_bf16 v[64:67], a[232:235], a[140:143], v[64:67]
    v_mfma_f32_16x16x32_bf16 v[72:75], a[232:235], a[164:167], v[72:75]
    v_mfma_f32_16x16x32_bf16 v[80:83], a[232:235], a[188:191], v[80:83]
    v_max3_f32 v96, v52, v53, v54
    s_nop 2
    v_max3_f32 v96, v96, v55, v56
    v_max3_f32 v96, v96, v57, v58
    s_waitcnt lgkmcnt(6)
    v_mfma_f32_16x16x32_bf16 v[112:115], a[212:215], v[16:19], v[112:115]
    s_mov_b32 s67, s34
    v_max_f32 v96, v96, v59
    v_mov_b32 v97, v96
    v_mfma_f32_16x16x32_bf16 v[160:163], a[212:215], v[22:25], v[160:163]
    s_add_u32 s18, s34, 24576
    ds_read_b64_tr_b16 a[228:229], v2 offset:19456
    v_permlane32_swap_b32 v97, v96
    v_mfma_f32_16x16x32_bf16 v[208:211], a[212:215], v[28:31], v[208:211]
    ds_read_b64_tr_b16 a[234:235], v3 offset:13312
    v_max_f32 v96, v96, v97
    v_mov_b32 v97, v96
    v_mfma_f32_16x16x32_bf16 a[0:3], a[212:215], v[34:37], a[0:3]
    s_waitcnt lgkmcnt(6)
    v_mov_b32 v100, v48
    v_permlane16_swap_b32 v97, v96
    v_max_f32 v96, v96, v97
    v_mfma_f32_16x16x32_bf16 v[116:119], a[216:219], v[16:19], v[116:119]
    s_mov_b32 s34, s33
    ds_read_b64_tr_b16 a[232:233], v3 offset:19456
    v_mul_f32_e64 v9, -s28, v96
    v_max3_f32 v96, v60, v61, v62
    v_fma_f32 v54, v54, s28, v9
    v_mfma_f32_16x16x32_bf16 v[164:167], a[216:219], v[22:25], v[164:167]
    s_add_u32 s64, s64, s62
    ds_read_b64_tr_b16 a[230:231], v2 offset:13312
    v_max3_f32 v96, v96, v63, v64
    v_max3_f32 v96, v96, v65, v66
    v_max_f32 v96, v96, v67
    v_mov_b32 v97, v96
    v_mfma_f32_16x16x32_bf16 v[212:215], a[216:219], v[28:31], v[212:215]
    s_add_u32 s64, s64, 196608
    v_permlane32_swap_b32 v97, v96
    v_max_f32 v96, v96, v97
    v_mfma_f32_16x16x32_bf16 a[4:7], a[216:219], v[34:37], a[4:7]
    s_waitcnt lgkmcnt(4)
    v_rcp_f32 v49, v49
    v_mov_b32 v97, v96
    v_mfma_f32_16x16x32_bf16 v[120:123], a[220:223], v[16:19], v[120:123]
    s_nop 0
    v_permlane16_swap_b32 v97, v96
    v_mfma_f32_16x16x32_bf16 v[168:171], a[220:223], v[22:25], v[168:171]
    s_mov_b32 s39, s64
    v_rcp_f32 v50, v50
    v_mfma_f32_16x16x32_bf16 v[216:219], a[220:223], v[28:31], v[216:219]
    ds_read_b64_tr_b16 a[216:217], v5 offset:19456
    v_accvgpr_read_b32 v109, a5
    v_max_f32 v96, v96, v97
    v_mul_f32_e64 v10, -s28, v96
    v_mfma_f32_16x16x32_bf16 a[8:11], a[220:223], v[34:37], a[8:11]
    s_add_u32 s37, s37, 1
    ds_read_b64_tr_b16 a[212:213], v4 offset:19456
    v_max3_f32 v96, v68, v69, v70
    v_mfma_f32_16x16x32_bf16 v[124:127], a[224:227], v[16:19], v[124:127]
    s_bitcmp1_b32 s63, s37
    ds_read_b64_tr_b16 a[218:219], v5 offset:13312
    v_permlane32_swap_b32 v48, v100
    v_mfma_f32_16x16x32_bf16 v[172:175], a[224:227], v[22:25], v[172:175]
    s_cselect_b32 s62, 4294770688, 0
    ds_read_b64_tr_b16 a[214:215], v4 offset:13312
    v_max3_f32 v96, v96, v71, v72
    v_mfma_f32_16x16x32_bf16 v[220:223], a[224:227], v[28:31], v[220:223]
    s_cselect_b32 s42, 0, 325632
    v_fma_f32 v61, v61, s28, v10
    v_max3_f32 v96, v96, v73, v74
    v_mfma_f32_16x16x32_bf16 a[12:15], a[224:227], v[34:37], a[12:15]
    s_waitcnt lgkmcnt(4)
    ds_read_b64_tr_b16 a[220:221], v2 offset:20480
    v_fma_f32 v53, v53, s28, v9
    v_max_f32 v96, v96, v75
    v_mfma_f32_16x16x32_bf16 v[128:131], a[228:231], v[16:19], v[128:131]
    s_add_u32 s35, s35, s42
    v_mov_b32 v97, v96
    v_fma_f32 v63, v63, s28, v10
    v_mfma_f32_16x16x32_bf16 v[176:179], a[228:231], v[22:25], v[176:179]
    s_lshl_b32 s42, s37, 1
    v_mul_f32 v165, v165, v49
    v_permlane32_swap_b32 v97, v96
    v_mfma_f32_16x16x32_bf16 v[224:227], a[228:231], v[28:31], v[224:227]
    s_lshr_b32 s42, s31, s42
    v_max_f32 v96, v96, v97
    v_mov_b32 v97, v96
    v_mfma_f32_16x16x32_bf16 a[16:19], a[228:231], v[34:37], a[16:19]
    s_and_b32 s42, s42, 3
    v_mbcnt_lo_u32_b32 v104, -1, 0
    v_exp_f32 v53, v53
    v_mfma_f32_16x16x32_bf16 v[132:135], a[232:235], v[16:19], v[132:135]
    s_add_u32 s42, s42, s36
    ds_read_b64_tr_b16 a[226:227], v3 offset:14336
    v_rcp_f32 v51, v51
    v_mfma_f32_16x16x32_bf16 v[180:183], a[232:235], v[22:25], v[180:183]
    s_sub_u32 s43, s42, 3
    ds_read_b64_tr_b16 a[224:225], v3 offset:20480
    v_mbcnt_hi_u32_b32 v104, -1, v104
    v_mfma_f32_16x16x32_bf16 v[228:231], a[232:235], v[28:31], v[228:231]
    s_cmp_ge_u32 s42, 3
    ds_read_b64_tr_b16 a[228:229], v4 offset:20480
    v_fma_f32 v60, v60, s28, v10
    v_mfma_f32_16x16x32_bf16 a[20:23], a[232:235], v[34:37], a[20:23]
    s_waitcnt lgkmcnt(4)
    v_mul_f32 v161, v161, v49
    v_lshrrev_b32 v106, 5, v104
    v_mfma_f32_16x16x32_bf16 v[136:139], a[212:215], v[16:19], v[136:139]
    s_cselect_b32 s42, s43, s42
    v_fma_f32 v64, v64, s28, v10
    v_permlane16_swap_b32 v97, v96
    v_mfma_f32_16x16x32_bf16 v[184:187], a[212:215], v[22:25], v[184:187]
    s_mul_i32 s44, s3, 5
    ds_read_b64_tr_b16 a[230:231], v4 offset:14336
    v_mul_f32 v163, v163, v49
    v_max_f32 v96, v96, v97
    v_mul_f32_e64 v11, -s28, v96
    v_mfma_f32_16x16x32_bf16 v[232:235], a[212:215], v[28:31], v[232:235]
    s_mov_b32 s32, 1
    ds_read_b64_tr_b16 a[222:223], v2 offset:14336
    v_fma_f32 v62, v62, s28, v10
    v_max3_f32 v96, v76, v77, v78
    s_lshl_b32 s43, s3, 2
    v_bfe_u32 v105, v104, 3, 1
    v_max3_f32 v96, v96, v79, v80
    s_add_u32 s45, s43, 21
    v_max3_f32 v96, v96, v81, v82
    v_mul_f32 v168, v168, v49
    v_fma_f32 v75, v75, s28, v11
    v_max_f32 v96, v96, v83
    v_mfma_f32_16x16x32_bf16 a[24:27], a[212:215], v[34:37], a[24:27]
    s_cmp_eq_u32 s3, 0
    v_fma_f32 v52, v52, s28, v9
    v_rcp_f32 v48, v48
    v_mfma_f32_16x16x32_bf16 v[140:143], a[216:219], v[16:19], v[140:143]
    s_cselect_b32 s45, 20, s45
    ds_read_b64_tr_b16 a[234:235], v5 offset:14336
    v_fma_f32 v57, v57, s28, v9
    v_mov_b32 v97, v96
    v_and_b32 v107, 3, v104
    v_fma_f32 v69, v69, s28, v11
    v_permlane32_swap_b32 v97, v96
    v_pk_mul_f32 v[116:117], v[116:117], v[48:49] op_sel_hi:[1,0]
    v_max_f32 v96, v96, v97
    v_xor_b32 v106, v106, v105
    v_pk_mul_f32 v[118:119], v[118:119], v[48:49] op_sel_hi:[1,0]
    v_pk_mul_f32 v[208:209], v[208:209], v[50:51] op_sel_hi:[1,0]
    s_cselect_b32 s33, 1, 0
    s_cmp_eq_u32 s42, 1
    v_exp_f32 v69, v69
    v_fma_f32 v70, v70, s28, v11
    v_mov_b32 v97, v96
    v_mfma_f32_16x16x32_bf16 v[188:191], a[216:219], v[22:25], v[188:191]
    s_cselect_b32 s44, s45, s44
    v_permlane16_swap_b32 v97, v96
    v_mfma_f32_16x16x32_bf16 v[236:239], a[216:219], v[28:31], v[236:239]
    s_cselect_b32 s32, s33, s32
    v_max_f32 v96, v96, v97
    v_exp_f32 v54, v54
    v_mfma_f32_16x16x32_bf16 a[28:31], a[216:219], v[34:37], a[28:31]
    s_waitcnt lgkmcnt(1)
    ds_read_b64_tr_b16 a[232:233], v5 offset:20480
    s_add_u32 s45, s43, 37
    v_fma_f32 v73, v73, s28, v11
    v_mfma_f32_16x16x32_bf16 v[144:147], a[220:223], v[16:19], v[144:147]
    s_cmp_eq_u32 s42, 2
    v_exp_f32 v70, v70
    v_mul_f32 v184, v184, v49
    v_mul_f32 v178, v178, v49
    v_exp_f32 v52, v52
    v_mul_f32 v169, v169, v49
    v_pk_mul_f32 v[112:113], v[112:113], v[48:49] op_sel_hi:[1,0]
    v_mul_f32 v179, v179, v49
    v_fma_f32 v71, v71, s28, v11
    v_mfma_f32_16x16x32_bf16 v[192:195], a[220:223], v[22:25], v[192:195]
    s_cselect_b32 s44, s45, s44
    v_accvgpr_read_b32 v111, a7
    v_mul_f32 v162, v162, v49
    v_mul_f32 v185, v185, v49
    v_mfma_f32_16x16x32_bf16 v[240:243], a[220:223], v[28:31], v[240:243]
    s_cselect_b32 s32, 0, s32
    v_accvgpr_read_b32 v108, a4
    v_exp_f32 v62, v62
    v_mfma_f32_16x16x32_bf16 a[32:35], a[220:223], v[34:37], a[32:35]
    s_mul_i32 s44, s44, 6144
    s_add_u32 s33, s35, s44
    v_mul_f32_e64 v12, -s28, v96
    v_fma_f32 v78, v78, s28, v12
    v_mfma_f32_16x16x32_bf16 v[148:151], a[224:227], v[16:19], v[148:151]
    s_mul_i32 s42, s32, 6144
    v_fma_f32 v76, v76, s28, v12
    v_xor_b32 v105, s65, v105
    v_mfma_f32_16x16x32_bf16 v[196:199], a[224:227], v[22:25], v[196:199]
    s_add_u32 s42, s42, 24576
    v_fma_f32 v56, v56, s28, v9
    v_lshl_or_b32 v106, v107, 1, v106
    v_exp_f32 v61, v61
    v_mfma_f32_16x16x32_bf16 v[244:247], a[224:227], v[28:31], v[244:247]
    s_add_u32 s42, s42, s33
    v_fma_f32 v65, v65, s28, v10
    v_mul_f32 v170, v170, v49
    s_cmp_ge_u32 s37, 6
    v_mfma_f32_16x16x32_bf16 a[36:39], a[224:227], v[34:37], a[36:39]
    s_cselect_b32 s14, 0, s42
    v_exp_f32 v71, v71
    v_mfma_f32_16x16x32_bf16 v[152:155], a[228:231], v[16:19], v[152:155]
    s_add_u32 s24, s67, 6400
    v_fma_f32 v68, v68, s28, v11
    v_lshl_add_u32 v101, v105, 10, s38
    v_mul_f32 v164, v164, v49
    v_cvt_pk_bf16_f32 v116, v116, v117
    s_add_u32 s25, s33, 6400
    v_exp_f32 v75, v75
    v_mfma_f32_16x16x32_bf16 v[200:203], a[228:231], v[22:25], v[200:203]
    s_add_u32 s23, s38, 10240
    v_fma_f32 v66, v66, s28, v10
    v_fma_f32 v59, v59, s28, v9
    v_mul_f32 v160, v160, v49
    v_mul_f32 v180, v180, v49
    v_mfma_f32_16x16x32_bf16 v[248:251], a[228:231], v[28:31], v[248:251]
    s_mov_b32 s27, 0x49249249
    v_fma_f32 v55, v55, s28, v9
    v_exp_f32 v55, v55
    v_mul_f32 v191, v191, v49
    v_fma_f32 v79, v79, s28, v12
    v_pk_mul_f32 v[214:215], v[214:215], v[50:51] op_sel_hi:[1,0]
    v_cvt_pk_bf16_f32 v15, v54, v55
    v_exp_f32 v60, v60
    s_mov_b32 s30, 0
    v_exp_f32 v63, v63
    v_mfma_f32_16x16x32_bf16 a[40:43], a[228:231], v[34:37], a[40:43]
    s_waitcnt vmcnt(8) lgkmcnt(0)
    v_accvgpr_read_b32 v110, a6
    v_cvt_pk_bf16_f32 v21, v62, v63
    v_fma_f32 v80, v80, s28, v12
    v_mfma_f32_16x16x32_bf16 v[156:159], a[232:235], v[16:19], v[156:159]
    s_barrier
    ds_read_b128 a[212:215], v0 offset:12288
    v_fma_f32 v72, v72, s28, v11
    v_lshl_add_u32 v101, v106, 4, v101
    v_mfma_f32_16x16x32_bf16 v[204:207], a[232:235], v[22:25], v[204:207]
    ds_read_b128 a[216:219], v1 offset:12288
    v_fma_f32 v83, v83, s28, v12
    v_exp_f32 v68, v68
    v_mfma_f32_16x16x32_bf16 v[252:255], a[232:235], v[28:31], v[252:255]
    ds_read_b128 a[220:223], v0 offset:13312
    v_mul_f32 v111, v111, v51
    v_and_b32 v107, 7, v104
    v_exp_f32 v79, v79
    v_pk_mul_f32 v[114:115], v[114:115], v[48:49] op_sel_hi:[1,0]
    v_exp_f32 v78, v78
    v_pk_mul_f32 v[120:121], v[120:121], v[48:49] op_sel_hi:[1,0]
    v_fma_f32 v58, v58, s28, v9
    v_mul_f32 v172, v172, v49
    v_exp_f32 v66, v66
    v_mul_f32 v183, v183, v49
    v_accvgpr_read_b32 v106, a2
    v_mul_f32 v109, v109, v51
    v_pk_mul_f32 v[218:219], v[218:219], v[50:51] op_sel_hi:[1,0]
    v_fma_f32 v77, v77, s28, v12
    v_mul_f32 v188, v188, v49
    v_mul_f32 v176, v176, v49
    v_mul_f32 v175, v175, v49
    v_cvt_pk_bf16_f32 v27, v70, v71
    v_exp_f32 v77, v77
    v_exp_f32 v65, v65
    v_cvt_pk_bf16_f32 v14, v52, v53
    v_mfma_f32_16x16x32_bf16 a[44:47], a[232:235], v[34:37], a[44:47]
    s_waitcnt lgkmcnt(2)
    ds_read_b128 a[224:227], v1 offset:13312
    v_cvt_pk_bf16_f32 v26, v68, v69
    v_cvt_pk_bf16_f32 v120, v120, v121
    v_mfma_f32_16x16x32_bf16 v[52:55], a[212:215], a[96:99], 0
    s_waitcnt lgkmcnt(2)
    v_fma_f32 v82, v82, s28, v12
    v_exp_f32 v76, v76
    v_fma_f32 v67, v67, s28, v10
    v_mfma_f32_16x16x32_bf16 v[52:55], a[216:219], a[100:103], v[52:55]
    s_waitcnt lgkmcnt(1)
    ds_read_b128 a[232:235], v1 offset:14336
    v_mul_f32 v192, v192, v49
    v_mfma_f32_16x16x32_bf16 v[52:55], a[220:223], a[104:107], v[52:55]
    v_mul_f32 v110, v110, v51
    v_cvt_pk_bf16_f32 v20, v60, v61
    v_exp_f32 v59, v59
    v_mul_f32 v187, v187, v49
    v_exp_f32 v72, v72
    v_mfma_f32_16x16x32_bf16 v[60:63], a[212:215], a[120:123], 0
    ds_read_b128 a[228:231], v0 offset:14336
    v_cvt_pk_bf16_f32 v33, v78, v79
    v_exp_f32 v80, v80
    v_fma_f32 v81, v81, s28, v12
    v_mfma_f32_16x16x32_bf16 v[60:63], a[216:219], a[124:127], v[60:63]
    v_exp_f32 v64, v64
    v_mfma_f32_16x16x32_bf16 v[60:63], a[220:223], a[128:131], v[60:63]
    v_cvt_pk_bf16_f32 v112, v112, v113
    v_cvt_pk_bf16_f32 v168, v168, v169
    v_mfma_f32_16x16x32_bf16 v[68:71], a[212:215], a[144:147], 0
    v_exp_f32 v83, v83
    v_mfma_f32_16x16x32_bf16 v[68:71], a[216:219], a[148:151], v[68:71]
    v_exp_f32 v67, v67
    v_mfma_f32_16x16x32_bf16 v[68:71], a[220:223], a[152:155], v[68:71]
    v_cvt_pk_bf16_f32 v32, v76, v77
    v_fma_f32 v74, v74, s28, v11
    v_exp_f32 v56, v56
    v_mul_f32 v186, v186, v49
    v_mfma_f32_16x16x32_bf16 v[76:79], a[212:215], a[168:171], 0
    v_mul_f32 v106, v106, v51
    v_cvt_pk_bf16_f32 v113, v114, v115
    v_mul_f32 v193, v193, v49
    v_mfma_f32_16x16x32_bf16 v[76:79], a[216:219], a[172:175], v[76:79]
    v_exp_f32 v74, v74
    v_mfma_f32_16x16x32_bf16 v[76:79], a[220:223], a[176:179], v[76:79]
    s_waitcnt lgkmcnt(0)
    v_cvt_pk_bf16_f32 v160, v160, v161
    v_exp_f32 v57, v57
    v_mfma_f32_16x16x32_bf16 v[52:55], a[224:227], a[108:111], v[52:55]
    s_add_u32 m0, s22, 36864
    ds_read_b128 a[212:215], v0 offset:18432
    v_cvt_pk_bf16_f32 v184, v184, v185
    v_mfma_f32_16x16x32_bf16 v[52:55], a[228:231], a[112:115], v[52:55]
    ds_read_b128 a[216:219], v1 offset:18432
    v_accvgpr_read_b32 v105, a1
    v_mul_f32 v108, v108, v51
    v_mfma_f32_16x16x32_bf16 v[52:55], a[232:235], a[116:119], v[52:55]
    buffer_load_dwordx4 v6, s[8:11], s21 offen lds
    v_mfma_f32_16x16x32_bf16 v[60:63], a[224:227], a[132:135], v[60:63]
    v_cvt_pk_bf16_f32 v108, v108, v109
    v_exp_f32 v58, v58
    v_mfma_f32_16x16x32_bf16 v[60:63], a[228:231], a[136:139], v[60:63]
    v_lshl_add_u32 v101, v107, 7, v101
    v_mul_f32 v197, v197, v49
    v_mfma_f32_16x16x32_bf16 v[60:63], a[232:235], a[140:143], v[60:63]
    v_mul_f32 v173, v173, v49
    v_bfe_u32 v107, v104, 4, 1
    v_mul_f32 v199, v199, v49
    v_lshl_add_u32 v101, v107, 3, v101
    v_mfma_f32_16x16x32_bf16 v[68:71], a[224:227], a[156:159], v[68:71]
    s_add_u32 s21, s21, 128
    v_cvt_pk_bf16_f32 v109, v110, v111
    v_mul_f32 v105, v105, v51
    v_mfma_f32_16x16x32_bf16 v[68:71], a[228:231], a[160:163], v[68:71]
    ds_read_b128 a[220:223], v0 offset:19456
    v_cvt_pk_bf16_f32 v17, v58, v59
    v_mul_f32 v204, v204, v49
    v_mfma_f32_16x16x32_bf16 v[68:71], a[232:235], a[164:167], v[68:71]
    v_exp_f32 v73, v73
    v_mul_f32 v207, v207, v49
    v_exp_f32 v82, v82
    v_mul_f32 v182, v182, v49
    v_mul_f32 v196, v196, v49
    v_fma_f32 v55, v55, s28, v9
    v_mfma_f32_16x16x32_bf16 v[76:79], a[224:227], a[180:183], v[76:79]
    v_cvt_pk_bf16_f32 v192, v192, v193
    v_accvgpr_read_b32 v110, a14
    v_cvt_pk_bf16_f32 v16, v56, v57
    v_mfma_f32_16x16x32_bf16 v[76:79], a[228:231], a[184:187], v[76:79]
    v_accvgpr_read_b32 v107, a3
    v_exp_f32 v81, v81
    v_mfma_f32_16x16x32_bf16 v[76:79], a[232:235], a[188:191], v[76:79]
    s_waitcnt lgkmcnt(1)
    v_mul_f32 v198, v198, v49
    v_cvt_pk_bf16_f32 v34, v80, v81
    v_cvt_pk_bf16_f32 v22, v64, v65
    v_mfma_f32_16x16x32_bf16 v[56:59], a[212:215], a[96:99], 0
    v_mul_f32 v171, v171, v49
    v_cvt_pk_bf16_f32 v23, v66, v67
    v_mfma_f32_16x16x32_bf16 v[56:59], a[216:219], a[100:103], v[56:59]
    v_cvt_pk_bf16_f32 v35, v82, v83
    v_fma_f32 v61, v61, s28, v10
    v_cvt_pk_bf16_f32 v28, v72, v73
    v_mul_f32 v190, v190, v49
    v_mul_f32 v195, v195, v49
    v_accvgpr_read_b32 v104, a0
    v_pk_mul_f32 v[212:213], v[212:213], v[50:51] op_sel_hi:[1,0]
    v_pk_mul_f32 v[216:217], v[216:217], v[50:51] op_sel_hi:[1,0]
    v_pk_mul_f32 v[242:243], v[242:243], v[50:51] op_sel_hi:[1,0]
    v_pk_mul_f32 v[238:239], v[238:239], v[50:51] op_sel_hi:[1,0]
    v_cvt_pk_bf16_f32 v208, v208, v209
    v_fma_f32 v54, v54, s28, v9
    v_mfma_f32_16x16x32_bf16 v[44:47], a[236:239], v[14:17], 0
    s_waitcnt lgkmcnt(0)
    ds_read_b128 a[224:227], v1 offset:19456
    v_mul_f32 v177, v177, v49
    v_mfma_f32_16x16x32_bf16 v[56:59], a[220:223], a[104:107], v[56:59]
    ds_read_b128 a[232:235], v1 offset:20480
    v_cvt_pk_bf16_f32 v29, v74, v75
    v_cvt_pk_bf16_f32 v117, v118, v119
    v_mfma_f32_16x16x32_bf16 v[64:67], a[212:215], a[120:123], 0
    s_add_u32 m0, s22, 37888
    ds_read_b128 a[228:231], v0 offset:20480
    buffer_load_dwordx4 v6, s[8:11], s21 offen lds
    v_mul_f32 v205, v205, v49
    v_subrev_u32 v8, 22528, v8
    v_fma_f32 v62, v62, s28, v10
    v_pk_mul_f32 v[126:127], v[126:127], v[48:49] op_sel_hi:[1,0]
    v_mul_f32 v104, v104, v51
    v_pk_mul_f32 v[140:141], v[140:141], v[48:49] op_sel_hi:[1,0]
    v_pk_mul_f32 v[228:229], v[228:229], v[50:51] op_sel_hi:[1,0]
    v_pk_mul_f32 v[230:231], v[230:231], v[50:51] op_sel_hi:[1,0]
    v_mul_f32 v203, v203, v49
    v_mul_f32 v107, v107, v51
    v_pk_mul_f32 v[210:211], v[210:211], v[50:51] op_sel_hi:[1,0]
    v_pk_mul_f32 v[224:225], v[224:225], v[50:51] op_sel_hi:[1,0]
    v_mul_f32 v206, v206, v49
    v_pk_mul_f32 v[128:129], v[128:129], v[48:49] op_sel_hi:[1,0]
    v_pk_mul_f32 v[144:145], v[144:145], v[48:49] op_sel_hi:[1,0]
    v_pk_mul_f32 v[244:245], v[244:245], v[50:51] op_sel_hi:[1,0]
    v_fma_f32 v53, v53, s28, v9
    v_fma_f32 v76, v76, s28, v12
    v_mfma_f32_16x16x32_bf16 v[64:67], a[216:219], a[124:127], v[64:67]
    s_add_u32 s21, s21, 128
    v_cvt_pk_bf16_f32 v104, v104, v105
    v_fma_f32 v77, v77, s28, v12
    v_cvt_pk_bf16_f32 v161, v162, v163
    v_mfma_f32_16x16x32_bf16 v[64:67], a[220:223], a[128:131], v[64:67]
    v_mul_f32 v200, v200, v49
    v_cvt_pk_bf16_f32 v185, v186, v187
    v_mfma_f32_16x16x32_bf16 v[72:75], a[212:215], a[144:147], 0
    s_add_u32 m0, s22, 38912
    v_cvt_pk_bf16_f32 v105, v106, v107
    v_mul_f32 v202, v202, v49
    v_mfma_f32_16x16x32_bf16 v[72:75], a[216:219], a[148:151], v[72:75]
    buffer_load_dwordx4 v6, s[8:11], s21 offen lds
    v_mfma_f32_16x16x32_bf16 v[72:75], a[220:223], a[152:155], v[72:75]
    s_add_u32 s21, s21, 12032
    v_exp_f32 v62, v62
    v_cvt_pk_bf16_f32 v209, v210, v211
    v_cvt_pk_bf16_f32 v212, v212, v213
    v_mfma_f32_16x16x32_bf16 v[80:83], a[212:215], a[168:171], 0
    v_cvt_pk_bf16_f32 v164, v164, v165
    v_accvgpr_read_b32 v107, a11
    v_mfma_f32_16x16x32_bf16 v[80:83], a[216:219], a[172:175], v[80:83]
    ds_write2st64_b64 v101, v[112:113], v[160:161] offset0:0 offset1:12
    v_mfma_f32_16x16x32_bf16 v[80:83], a[220:223], a[176:179], v[80:83]
    s_waitcnt lgkmcnt(1)
    ds_write2st64_b64 v101, v[208:209], v[104:105] offset0:24 offset1:36
    v_mfma_f32_16x16x32_bf16 v[56:59], a[224:227], a[108:111], v[56:59]
    s_waitcnt vmcnt(6)
    v_cvt_pk_bf16_f32 v216, v216, v217
    v_accvgpr_read_b32 v106, a10
    v_cvt_pk_bf16_f32 v224, v224, v225
    v_mfma_f32_16x16x32_bf16 v[44:47], a[240:243], v[20:23], v[44:47]
    s_barrier
    v_fma_f32 v69, v69, s28, v11
    v_mul_f32 v167, v167, v49
    v_mfma_f32_16x16x32_bf16 v[56:59], a[228:231], a[112:115], v[56:59]
    ds_read_b64_tr_b16 a[212:213], v2 offset:0
    v_accvgpr_read_b32 v105, a9
    v_mfma_f32_16x16x32_bf16 v[56:59], a[232:235], a[116:119], v[56:59]
    ds_read_b64_tr_b16 a[214:215], v2 offset:6144
    v_cvt_pk_bf16_f32 v228, v228, v229
    v_exp_f32 v61, v61
    v_mul_f32 v166, v166, v49
    v_fma_f32 v71, v71, s28, v11
    v_mfma_f32_16x16x32_bf16 v[64:67], a[224:227], a[132:135], v[64:67]
    v_fma_f32 v78, v78, s28, v12
    v_mul_f32 v106, v106, v51
    v_mfma_f32_16x16x32_bf16 v[64:67], a[228:231], a[136:139], v[64:67]
    ds_read_b64_tr_b16 a[216:217], v3 offset:0
    v_cvt_pk_bf16_f32 v172, v172, v173
    v_cvt_pk_bf16_f32 v196, v196, v197
    v_mul_f32 v107, v107, v51
    v_exp_f32 v54, v54
    v_accvgpr_read_b32 v104, a8
    v_pk_mul_f32 v[246:247], v[246:247], v[50:51] op_sel_hi:[1,0]
    v_mul_f32 v105, v105, v51
    v_fma_f32 v70, v70, s28, v11
    v_mfma_f32_16x16x32_bf16 v[64:67], a[232:235], a[140:143], v[64:67]
    s_add_u32 m0, s22, 12288
    v_mul_f32 v201, v201, v49
    v_mul_f32 v181, v181, v49
    v_fma_f32 v68, v68, s28, v11
    v_mfma_f32_16x16x32_bf16 v[72:75], a[224:227], a[156:159], v[72:75]
    ds_read_b64_tr_b16 a[218:219], v3 offset:6144
    v_exp_f32 v68, v68
    v_mfma_f32_16x16x32_bf16 v[72:75], a[228:231], a[160:163], v[72:75]
    v_mul_f32 v174, v174, v49
    v_mul_f32 v104, v104, v51
    v_mfma_f32_16x16x32_bf16 v[72:75], a[232:235], a[164:167], v[72:75]
    buffer_load_dwordx4 v6, s[4:7], s20 offen lds
    v_mfma_f32_16x16x32_bf16 v[80:83], a[224:227], a[180:183], v[80:83]
    v_cvt_pk_bf16_f32 v165, v166, v167
    v_cvt_pk_bf16_f32 v244, v244, v245
    v_fma_f32 v79, v79, s28, v12
    v_cvt_pk_bf16_f32 v217, v218, v219
    v_fma_f32 v67, v67, s28, v10
    v_cvt_pk_bf16_f32 v144, v144, v145
    v_pk_mul_f32 v[252:253], v[252:253], v[50:51] op_sel_hi:[1,0]
    v_xor_b32 v101, 32, v101
    v_pk_mul_f32 v[236:237], v[236:237], v[50:51] op_sel_hi:[1,0]
    v_pk_mul_f32 v[130:131], v[130:131], v[48:49] op_sel_hi:[1,0]
    v_mul_f32 v110, v110, v51
    v_cvt_pk_bf16_f32 v176, v176, v177
    v_cvt_pk_bf16_f32 v213, v214, v215
    v_exp_f32 v53, v53
    v_mfma_f32_16x16x32_bf16 v[80:83], a[228:231], a[184:187], v[80:83]
    ds_write2st64_b64 v101, v[116:117], v[164:165] offset0:0 offset1:12
    v_cvt_pk_bf16_f32 v252, v252, v253
    v_fma_f32 v60, v60, s28, v10
    v_cvt_pk_bf16_f32 v104, v104, v105
    v_pk_mul_f32 v[156:157], v[156:157], v[48:49] op_sel_hi:[1,0]
    v_pk_mul_f32 v[234:235], v[234:235], v[50:51] op_sel_hi:[1,0]
    v_pk_mul_f32 v[136:137], v[136:137], v[48:49] op_sel_hi:[1,0]
    v_cvt_pk_bf16_f32 v105, v106, v107
    v_accvgpr_read_b32 v111, a15
    v_pk_mul_f32 v[222:223], v[222:223], v[50:51] op_sel_hi:[1,0]
    v_exp_f32 v69, v69
    v_accvgpr_read_b32 v106, a18
    v_pk_mul_f32 v[124:125], v[124:125], v[48:49] op_sel_hi:[1,0]
    v_pk_mul_f32 v[152:153], v[152:153], v[48:49] op_sel_hi:[1,0]
    v_cvt_pk_bf16_f32 v197, v198, v199
    v_pk_mul_f32 v[240:241], v[240:241], v[50:51] op_sel_hi:[1,0]
    v_mul_f32 v189, v189, v49
    v_cvt_pk_bf16_f32 v173, v174, v175
    v_cvt_pk_bf16_f32 v30, v68, v69
    v_pk_mul_f32 v[146:147], v[146:147], v[48:49] op_sel_hi:[1,0]
    v_cvt_pk_bf16_f32 v169, v170, v171
    v_mul_f32 v106, v106, v51
    v_pk_mul_f32 v[250:251], v[250:251], v[50:51] op_sel_hi:[1,0]
    v_pk_mul_f32 v[122:123], v[122:123], v[48:49] op_sel_hi:[1,0]
    v_fma_f32 v75, v75, s28, v11
    v_cvt_pk_bf16_f32 v124, v124, v125
    v_cvt_pk_bf16_f32 v152, v152, v153
    v_mfma_f32_16x16x32_bf16 v[80:83], a[232:235], a[188:191], v[80:83]
    s_waitcnt lgkmcnt(1)
    ds_write2st64_b64 v101, v[212:213], v[108:109] offset0:24 offset1:36
    v_xor_b32 v101, 96, v101
    v_mfma_f32_16x16x32_bf16 v[112:115], a[212:215], v[14:17], 0
    s_add_u32 s20, s20, 128
    ds_read_b64_tr_b16 a[220:221], v4 offset:0
    v_cvt_pk_bf16_f32 v125, v126, v127
    v_accvgpr_read_b32 v108, a12
    v_mul_f32 v194, v194, v49
    v_mul_f32 v111, v111, v51
    v_cvt_pk_bf16_f32 v156, v156, v157
    v_cvt_pk_bf16_f32 v121, v122, v123
    v_mfma_f32_16x16x32_bf16 v[160:163], a[212:215], v[20:23], 0
    s_add_u32 m0, s22, 13312
    ds_write2st64_b64 v101, v[120:121], v[168:169] offset0:0 offset1:12
    v_pk_mul_f32 v[232:233], v[232:233], v[50:51] op_sel_hi:[1,0]
    v_cvt_pk_bf16_f32 v245, v246, v247
    v_pk_mul_f32 v[220:221], v[220:221], v[50:51] op_sel_hi:[1,0]
    v_pk_mul_f32 v[154:155], v[154:155], v[48:49] op_sel_hi:[1,0]
    v_mul_f32 v108, v108, v51
    v_accvgpr_read_b32 v109, a13
    v_mfma_f32_16x16x32_bf16 v[208:211], a[212:215], v[26:29], 0
    ds_read_b64_tr_b16 a[232:233], v3 offset:1024
    v_cvt_pk_bf16_f32 v145, v146, v147
    v_mfma_f32_16x16x32_bf16 a[0:3], a[212:215], v[32:35], 0
    ds_read_b64_tr_b16 a[222:223], v4 offset:6144
    v_cvt_pk_bf16_f32 v204, v204, v205
    v_mfma_f32_16x16x32_bf16 v[116:119], a[216:219], v[14:17], 0
    ds_write2st64_b64 v101, v[216:217], v[104:105] offset0:24 offset1:36
    v_xor_b32 v101, 32, v101
    v_mfma_f32_16x16x32_bf16 v[164:167], a[216:219], v[20:23], 0
    ds_read_b64_tr_b16 a[234:235], v3 offset:7168
    buffer_load_dwordx4 v6, s[4:7], s20 offen lds
    v_cvt_pk_bf16_f32 v180, v180, v181
    v_fma_f32 v81, v81, s28, v12
    v_pk_mul_f32 v[150:151], v[150:151], v[48:49] op_sel_hi:[1,0]
    v_exp_f32 v77, v77
    v_mul_f32 v109, v109, v51
    v_exp_f32 v81, v81
    v_cvt_pk_bf16_f32 v188, v188, v189
    v_fma_f32 v63, v63, s28, v10
    v_cvt_pk_bf16_f32 v220, v220, v221
    v_cvt_pk_bf16_f32 v205, v206, v207
    v_mfma_f32_16x16x32_bf16 v[212:215], a[216:219], v[26:29], 0
    ds_read_b64_tr_b16 a[228:229], v2 offset:1024
    ds_read_b64_tr_b16 a[224:225], v5 offset:0
    v_cvt_pk_bf16_f32 v177, v178, v179
    v_accvgpr_read_b32 v107, a19
    v_mfma_f32_16x16x32_bf16 a[4:7], a[216:219], v[32:35], 0
    s_add_u32 s20, s20, 128
    ds_read_b64_tr_b16 a[230:231], v2 offset:7168
    v_cvt_pk_bf16_f32 v136, v136, v137
    v_accvgpr_read_b32 v104, a16
    v_accvgpr_read_b32 v105, a17
    v_mul_f32 v105, v105, v51
    v_mul_f32 v104, v104, v51
    v_cvt_pk_bf16_f32 v108, v108, v109
    v_mfma_f32_16x16x32_bf16 v[44:47], a[244:247], v[26:29], v[44:47]
    s_waitcnt lgkmcnt(4)
    ds_write2st64_b64 v101, v[124:125], v[172:173] offset0:0 offset1:12
    v_pk_mul_f32 v[226:227], v[226:227], v[50:51] op_sel_hi:[1,0]
    v_mul_f32 v107, v107, v51
    s_nop 0
    v_mfma_f32_16x16x32_bf16 v[120:123], a[220:223], v[14:17], 0
    ds_read_b64_tr_b16 a[226:227], v5 offset:6144
    v_fma_f32 v52, v52, s28, v9
    v_mfma_f32_16x16x32_bf16 v[168:171], a[220:223], v[20:23], 0
    ds_read_b128 v[88:91], v8 offset:1024
    v_cvt_pk_bf16_f32 v128, v128, v129
    v_cvt_pk_bf16_f32 v240, v240, v241
    v_cvt_pk_bf16_f32 v221, v222, v223
    v_fma_f32 v66, v66, s28, v10
    v_pk_mul_f32 v[138:139], v[138:139], v[48:49] op_sel_hi:[1,0]
    v_cvt_pk_bf16_f32 v229, v230, v231
    v_pk_mul_f32 v[134:135], v[134:135], v[48:49] op_sel_hi:[1,0]
    v_pk_mul_f32 v[158:159], v[158:159], v[48:49] op_sel_hi:[1,0]
    v_cvt_pk_bf16_f32 v129, v130, v131
    v_exp_f32 v71, v71
    v_cvt_pk_bf16_f32 v109, v110, v111
    v_mfma_f32_16x16x32_bf16 v[216:219], a[220:223], v[26:29], 0
    ds_write2st64_b64 v101, v[220:221], v[108:109] offset0:24 offset1:36
    v_cvt_pk_bf16_f32 v232, v232, v233
    v_exp_f32 v60, v60
    v_cvt_pk_bf16_f32 v200, v200, v201
    v_accvgpr_read_b32 v110, a22
    v_cvt_pk_bf16_f32 v104, v104, v105
    v_accvgpr_read_b32 v111, a23
    v_cvt_pk_bf16_f32 v236, v236, v237
    v_cvt_pk_bf16_f32 v105, v106, v107
    v_pk_mul_f32 v[132:133], v[132:133], v[48:49] op_sel_hi:[1,0]
    v_fma_f32 v74, v74, s28, v11
    v_cvt_pk_bf16_f32 v132, v132, v133
    v_accvgpr_read_b32 v108, a20
    v_cvt_pk_bf16_f32 v237, v238, v239
    v_mfma_f32_16x16x32_bf16 a[8:11], a[220:223], v[32:35], 0
    s_waitcnt lgkmcnt(2)
    ds_read_b128 v[96:99], v8 offset:6144
    v_accvgpr_read_b32 v109, a21
    v_cvt_pk_bf16_f32 v181, v182, v183
    v_mfma_f32_16x16x32_bf16 v[124:127], a[224:227], v[14:17], 0
    ds_read_b128 v[84:87], v8 offset:0
    v_cvt_pk_bf16_f32 v153, v154, v155
    v_fma_f32 v59, v59, s28, v9
    v_fma_f32 v72, v72, s28, v11
    v_exp_f32 v76, v76
    v_mul_f32 v108, v108, v51
    v_exp_f32 v70, v70
    v_mul_f32 v109, v109, v51
    v_cvt_pk_bf16_f32 v225, v226, v227
    v_mfma_f32_16x16x32_bf16 v[172:175], a[224:227], v[20:23], 0
    ds_read_b64_tr_b16 a[218:219], v5 offset:7168
    v_cvt_pk_bf16_f32 v157, v158, v159
    v_xor_b32 v101, 96, v101
    v_accvgpr_read_b32 v107, a27
    v_mfma_f32_16x16x32_bf16 v[220:223], a[224:227], v[26:29], 0
    ds_write2st64_b64 v101, v[128:129], v[176:177] offset0:4 offset1:16
    v_mfma_f32_16x16x32_bf16 v[44:47], a[248:251], v[32:35], v[44:47]
    s_add_u32 m0, s22, 14336
    ds_read_b64_tr_b16 a[214:215], v4 offset:7168
    v_cvt_pk_bf16_f32 v201, v202, v203
    v_mul_f32 v110, v110, v51
    v_mfma_f32_16x16x32_bf16 a[12:15], a[224:227], v[32:35], 0
    buffer_load_dwordx4 v6, s[4:7], s20 offen lds
    ds_read_b64_tr_b16 a[224:225], v3 offset:2048
    ds_read_b64_tr_b16 a[212:213], v4 offset:1024
    v_cvt_pk_bf16_f32 v137, v138, v139
    v_exp_f32 v79, v79
    v_accvgpr_read_b32 v106, a26
    v_mfma_f32_16x16x32_bf16 v[128:131], a[228:231], v[14:17], 0
    s_add_u32 s20, s20, 12032
    ds_write2st64_b64 v101, v[224:225], v[104:105] offset0:28 offset1:40
    v_cvt_pk_bf16_f32 v108, v108, v109
    v_pk_mul_f32 v[142:143], v[142:143], v[48:49] op_sel_hi:[1,0]
    v_xor_b32 v101, 32, v101
    v_mul_f32 v111, v111, v51
    v_cvt_pk_bf16_f32 v241, v242, v243
    v_cvt_pk_bf16_f32 v133, v134, v135
    v_fma_f32 v83, v83, s28, v12
    v_mfma_f32_16x16x32_bf16 v[176:179], a[228:231], v[20:23], 0
    s_add_u32 m0, s38, 0
    ds_write2st64_b64 v101, v[132:133], v[180:181] offset0:4 offset1:16
    v_accvgpr_read_b32 v105, a25
    v_mul_f32 v106, v106, v51
    v_mfma_f32_16x16x32_bf16 v[224:227], a[228:231], v[26:29], 0
    s_waitcnt lgkmcnt(5)
    ds_read_b64_tr_b16 a[220:221], v2 offset:2048
    buffer_load_dwordx4 v6, s[12:15], s33 offen nt lds
    v_cvt_pk_bf16_f32 v189, v190, v191
    v_mul_f32 v107, v107, v51
    v_mfma_f32_16x16x32_bf16 a[16:19], a[228:231], v[32:35], 0
    s_add_u32 m0, s38, 1024
    ds_read_b64_tr_b16 a[226:227], v3 offset:8192
    buffer_load_dwordx4 v7, s[12:15], s33 offen nt lds
    v_cvt_pk_bf16_f32 v109, v110, v111
    v_cvt_pk_bf16_f32 v193, v194, v195
    v_mfma_f32_16x16x32_bf16 v[132:135], a[232:235], v[14:17], 0
    s_add_u32 s57, s67, 6144
    ds_write2st64_b64 v101, v[228:229], v[108:109] offset0:28 offset1:40
    v_accvgpr_read_b32 v109, a29
    v_pk_mul_f32 v[248:249], v[248:249], v[50:51] op_sel_hi:[1,0]
    v_accvgpr_read_b32 v111, a31
    v_accvgpr_read_b32 v104, a24
    v_mul_f32 v105, v105, v51
    v_pk_mul_f32 v[254:255], v[254:255], v[50:51] op_sel_hi:[1,0]
    v_pk_mul_f32 v[148:149], v[148:149], v[48:49] op_sel_hi:[1,0]
    v_mul_f32 v111, v111, v51
    v_exp_f32 v55, v55
    v_mul_f32 v104, v104, v51
    v_mfma_f32_16x16x32_bf16 v[180:183], a[232:235], v[20:23], 0
    ds_read_b64_tr_b16 a[222:223], v2 offset:8192
    v_mul_f32 v109, v109, v51
    v_cvt_pk_bf16_f32 v233, v234, v235
    v_fma_f32 v58, v58, s28, v9
    v_cvt_pk_bf16_f32 v104, v104, v105
    v_cvt_pk_bf16_f32 v140, v140, v141
    v_accvgpr_read_b32 v110, a30
    v_exp_f32 v78, v78
    v_xor_b32 v101, 96, v101
    v_mfma_f32_16x16x32_bf16 v[228:231], a[232:235], v[26:29], 0
    s_add_u32 s59, s33, 6144
    ds_write2st64_b64 v101, v[136:137], v[184:185] offset0:4 offset1:16
    v_mfma_f32_16x16x32_bf16 a[20:23], a[232:235], v[32:35], 0
    s_waitcnt lgkmcnt(3)
    ds_read_b64_tr_b16 a[216:217], v5 offset:1024
    v_cvt_pk_bf16_f32 v105, v106, v107
    v_mfma_f32_16x16x32_bf16 v[136:139], a[212:215], v[14:17], 0
    buffer_store_dwordx4 v[84:87], v102, s[16:19], s67 offen offset:0 nt
    s_add_u32 m0, s38, 6144
    ds_write2st64_b64 v101, v[232:233], v[104:105] offset0:28 offset1:40
    v_accvgpr_read_b32 v108, a28
    v_accvgpr_read_b32 v104, a32
    v_xor_b32 v101, 32, v101
    v_cvt_pk_bf16_f32 v31, v70, v71
    v_mul_f32 v108, v108, v51
    v_accvgpr_read_b32 v105, a33
    v_mfma_f32_16x16x32_bf16 v[184:187], a[212:215], v[20:23], 0
    ds_read_b128 v[84:87], v8 offset:7168
    v_cvt_pk_bf16_f32 v24, v60, v61
    v_mul_f32 v105, v105, v51
    v_cvt_pk_bf16_f32 v141, v142, v143
    v_mfma_f32_16x16x32_bf16 v[232:235], a[212:215], v[26:29], 0
    buffer_load_dwordx4 v6, s[12:15], s59 offen nt lds
    ds_write2st64_b64 v101, v[140:141], v[188:189] offset0:4 offset1:16
    v_cvt_pk_bf16_f32 v108, v108, v109
    v_mul_f32 v110, v110, v51
    v_accvgpr_read_b32 v106, a34
    v_accvgpr_read_b32 v107, a35
    v_cvt_pk_bf16_f32 v109, v110, v111
    v_mul_f32 v104, v104, v51
    v_mul_f32 v106, v106, v51
    v_mfma_f32_16x16x32_bf16 a[24:27], a[212:215], v[32:35], 0
    s_waitcnt lgkmcnt(3)
    ds_write2st64_b64 v101, v[236:237], v[108:109] offset0:28 offset1:40
    v_mul_f32 v107, v107, v51
    v_accvgpr_read_b32 v111, a39
    v_mfma_f32_16x16x32_bf16 v[140:143], a[216:219], v[14:17], 0
    s_add_u32 m0, s38, 7168
    ds_read_b64_tr_b16 a[230:231], v4 offset:8192
    v_accvgpr_read_b32 v108, a36
    v_mfma_f32_16x16x32_bf16 v[188:191], a[216:219], v[20:23], 0
    ds_read_b64_tr_b16 a[232:233], v5 offset:2048
    v_cvt_pk_bf16_f32 v148, v148, v149
    v_cvt_pk_bf16_f32 v104, v104, v105
    v_mfma_f32_16x16x32_bf16 v[236:239], a[216:219], v[26:29], 0
    s_waitcnt lgkmcnt(4)
    ds_read_b64_tr_b16 a[228:229], v4 offset:2048
    ds_read_b64_tr_b16 a[234:235], v5 offset:8192
    buffer_load_dwordx4 v7, s[12:15], s59 offen nt lds
    v_xor_b32 v101, 96, v101
    v_cvt_pk_bf16_f32 v105, v106, v107
    v_exp_f32 v58, v58
    v_cvt_pk_bf16_f32 v149, v150, v151
    v_mfma_f32_16x16x32_bf16 a[28:31], a[216:219], v[32:35], 0
    ds_write2st64_b64 v101, v[144:145], v[192:193] offset0:8 offset1:20
    v_mul_f32 v111, v111, v51
    v_accvgpr_read_b32 v109, a37
    v_mfma_f32_16x16x32_bf16 v[144:147], a[220:223], v[14:17], 0
    s_add_u32 s39, s39, 12288
    ds_write2st64_b64 v101, v[240:241], v[104:105] offset0:32 offset1:44
    v_mul_f32 v108, v108, v51
    v_accvgpr_read_b32 v110, a38
    v_mul_f32 v109, v109, v51
    v_accvgpr_read_b32 v106, a42
    v_cvt_pk_bf16_f32 v253, v254, v255
    v_cvt_pk_bf16_f32 v19, v54, v55
    v_accvgpr_read_b32 v107, a43
    v_cvt_pk_bf16_f32 v248, v248, v249
    v_mul_f32 v110, v110, v51
    v_cvt_pk_bf16_f32 v108, v108, v109
    v_accvgpr_read_b32 v104, a40
    v_cvt_pk_bf16_f32 v37, v78, v79
    v_xor_b32 v101, 32, v101
    v_mfma_f32_16x16x32_bf16 v[192:195], a[220:223], v[20:23], 0
    s_waitcnt vmcnt(11) lgkmcnt(2)
    v_mul_f32 v106, v106, v51
    v_cvt_pk_bf16_f32 v109, v110, v111
    v_mfma_f32_16x16x32_bf16 v[240:243], a[220:223], v[26:29], 0
    buffer_store_dwordx4 v[88:91], v103, s[16:19], s67 offen offset:0 nt
    s_barrier
    ds_write2st64_b64 v101, v[148:149], v[196:197] offset0:8 offset1:20
    v_mfma_f32_16x16x32_bf16 a[32:35], a[220:223], v[32:35], 0
    s_add_u32 m0, s22, 24576
    ds_write2st64_b64 v101, v[244:245], v[108:109] offset0:32 offset1:44
    v_cvt_pk_bf16_f32 v36, v76, v77
    v_accvgpr_read_b32 v109, a45
    v_fma_f32 v64, v64, s28, v10
    v_cvt_pk_bf16_f32 v249, v250, v251
    v_accvgpr_read_b32 v111, a47
    v_xor_b32 v101, 96, v101
    v_mul_f32 v107, v107, v51
    v_accvgpr_read_b32 v105, a41
    v_exp_f32 v52, v52
    v_mfma_f32_16x16x32_bf16 v[148:151], a[224:227], v[14:17], 0
    ds_read_b128 a[216:219], v1 offset:0
    v_mul_f32 v111, v111, v51
    v_accvgpr_read_b32 v110, a46
    v_mfma_f32_16x16x32_bf16 v[196:199], a[224:227], v[20:23], 0
    buffer_load_dwordx4 v6, s[8:11], s21 offen lds
    ds_write2st64_b64 v101, v[152:153], v[200:201] offset0:8 offset1:20
    v_accvgpr_read_b32 v108, a44
    v_mul_f32 v105, v105, v51
    v_mul_f32 v108, v108, v51
    v_mul_f32 v110, v110, v51
    v_mul_f32 v109, v109, v51
    v_mfma_f32_16x16x32_bf16 v[244:247], a[224:227], v[26:29], 0
    buffer_store_dwordx4 v[96:99], v102, s[16:19], s57 offen offset:0 nt
    v_fma_f32 v56, v56, s28, v9
    v_mul_f32 v104, v104, v51
    v_cvt_pk_bf16_f32 v104, v104, v105
    v_cvt_pk_bf16_f32 v18, v52, v53
    v_mfma_f32_16x16x32_bf16 a[36:39], a[224:227], v[32:35], 0
    s_add_u32 s21, s21, 128
    ds_read_b128 a[212:215], v0 offset:0
    v_cvt_pk_bf16_f32 v105, v106, v107
    v_cvt_pk_bf16_f32 v108, v108, v109
    v_mfma_f32_16x16x32_bf16 v[152:155], a[228:231], v[14:17], 0
    buffer_store_dwordx4 v[84:87], v103, s[16:19], s57 offen offset:0 nt
    ds_write2st64_b64 v101, v[248:249], v[104:105] offset0:32 offset1:44
    v_mfma_f32_16x16x32_bf16 v[200:203], a[228:231], v[20:23], 0
    ds_read_b128 a[220:223], v0 offset:1024
    v_xor_b32 v101, 32, v101
    v_mfma_f32_16x16x32_bf16 v[248:251], a[228:231], v[26:29], 0
    ds_write2st64_b64 v101, v[156:157], v[204:205] offset0:8 offset1:20
    v_mfma_f32_16x16x32_bf16 a[40:43], a[228:231], v[32:35], 0
    s_add_u32 m0, s22, 25600
    ds_read_b128 v[88:91], v8 offset:2048
    v_cvt_pk_bf16_f32 v109, v110, v111
    v_mfma_f32_16x16x32_bf16 v[156:159], a[232:235], v[14:17], 0
    ds_write2st64_b64 v101, v[252:253], v[108:109] offset0:32 offset1:44
    v_fma_f32 v57, v57, s28, v9
    v_mfma_f32_16x16x32_bf16 v[204:207], a[232:235], v[20:23], 0
    buffer_load_dwordx4 v6, s[8:11], s21 offen lds
    v_mfma_f32_16x16x32_bf16 v[252:255], a[232:235], v[26:29], 0
    ds_read_b128 a[228:231], v0 offset:2048
    v_exp_f32 v63, v63
    v_mfma_f32_16x16x32_bf16 a[44:47], a[232:235], v[32:35], 0
    s_waitcnt lgkmcnt(5)
    v_exp_f32 v67, v67
    v_mfma_f32_16x16x32_bf16 v[52:55], a[212:215], a[96:99], 0
    s_add_u32 s21, s21, 128
    v_exp_f32 v59, v59
    v_mfma_f32_16x16x32_bf16 v[52:55], a[216:219], a[100:103], v[52:55]
    s_waitcnt lgkmcnt(4)
    ds_read_b128 a[224:227], v1 offset:1024
    v_cvt_pk_bf16_f32 v25, v62, v63
    v_mfma_f32_16x16x32_bf16 v[52:55], a[220:223], a[104:107], v[52:55]
    s_add_u32 m0, s22, 26624
    ds_read_b128 a[232:235], v1 offset:2048
    buffer_load_dwordx4 v6, s[8:11], s21 offen lds
    v_mfma_f32_16x16x32_bf16 v[60:63], a[212:215], a[120:123], 0
    ds_read_b128 v[96:99], v8 offset:3072
    v_fma_f32 v65, v65, s28, v10
    v_mfma_f32_16x16x32_bf16 v[60:63], a[216:219], a[124:127], v[60:63]
    ds_read_b128 v[84:87], v8 offset:8192
    v_fma_f32 v73, v73, s28, v11
    v_mfma_f32_16x16x32_bf16 v[60:63], a[220:223], a[128:131], v[60:63]
    v_exp_f32 v56, v56
    v_mfma_f32_16x16x32_bf16 v[68:71], a[212:215], a[144:147], 0
    s_add_u32 s21, s21, 12032
    v_exp_f32 v57, v57
    v_mfma_f32_16x16x32_bf16 v[68:71], a[216:219], a[148:151], v[68:71]
    s_add_u32 s56, s67, 128
    v_exp_f32 v64, v64
    v_mfma_f32_16x16x32_bf16 v[68:71], a[220:223], a[152:155], v[68:71]
    s_add_u32 s58, s33, 128
    v_cvt_pk_bf16_f32 v16, v56, v57
    v_cvt_pk_bf16_f32 v17, v58, v59
    v_mfma_f32_16x16x32_bf16 v[76:79], a[212:215], a[168:171], 0
    v_exp_f32 v83, v83
    v_mfma_f32_16x16x32_bf16 v[48:51], a[236:239], v[16:19], v[44:47]
    s_add_u32 m0, s38, 2048
    ds_read_b128 a[212:215], v0 offset:6144
    v_exp_f32 v66, v66
    v_mfma_f32_16x16x32_bf16 v[76:79], a[216:219], a[172:175], v[76:79]
    ds_read_b128 a[216:219], v1 offset:6144
    v_fma_f32 v82, v82, s28, v12
    v_mfma_f32_16x16x32_bf16 v[76:79], a[220:223], a[176:179], v[76:79]
    s_waitcnt lgkmcnt(4)
    v_exp_f32 v74, v74
    v_mfma_f32_16x16x32_bf16 v[52:55], a[224:227], a[108:111], v[52:55]
    buffer_load_dwordx4 v6, s[12:15], s58 offen nt lds
    v_mfma_f32_16x16x32_bf16 v[52:55], a[228:231], a[112:115], v[52:55]
    buffer_store_dwordx4 v[88:91], v102, s[16:19], s56 offen offset:0 nt
    ds_read_b128 a[220:223], v0 offset:7168
    v_exp_f32 v65, v65
    v_mfma_f32_16x16x32_bf16 v[52:55], a[232:235], a[116:119], v[52:55]
    s_add_u32 m0, s38, 3072
    v_fma_f32 v80, v80, s28, v12
    v_cvt_pk_bf16_f32 v22, v64, v65
    v_mfma_f32_16x16x32_bf16 v[60:63], a[224:227], a[132:135], v[60:63]
    s_waitcnt lgkmcnt(3)
    ds_read_b128 v[88:91], v8 offset:9216
    buffer_load_dwordx4 v7, s[12:15], s58 offen nt lds
    v_mfma_f32_16x16x32_bf16 v[60:63], a[228:231], a[136:139], v[60:63]
    buffer_store_dwordx4 v[96:99], v103, s[16:19], s56 offen offset:0 nt
    s_nop 0
    ds_read_b128 v[96:99], v8 offset:4096
    v_exp_f32 v72, v72
    v_mfma_f32_16x16x32_bf16 v[60:63], a[232:235], a[140:143], v[60:63]
    s_add_u32 s57, s67, 6272
    v_exp_f32 v80, v80
    v_mfma_f32_16x16x32_bf16 v[68:71], a[224:227], a[156:159], v[68:71]
    v_exp_f32 v82, v82
    v_mfma_f32_16x16x32_bf16 v[68:71], a[228:231], a[160:163], v[68:71]
    buffer_store_dwordx4 v[84:87], v102, s[16:19], s57 offen offset:0 nt
    s_add_u32 s59, s33, 6272
    v_cvt_pk_bf16_f32 v23, v66, v67
    v_exp_f32 v75, v75
    v_mfma_f32_16x16x32_bf16 v[68:71], a[232:235], a[164:167], v[68:71]
    v_exp_f32 v73, v73
    v_mfma_f32_16x16x32_bf16 v[48:51], a[240:243], v[22:25], v[48:51]
    s_add_u32 m0, s38, 8192
    v_cvt_pk_bf16_f32 v34, v80, v81
    v_cvt_pk_bf16_f32 v29, v74, v75
    v_mfma_f32_16x16x32_bf16 v[76:79], a[224:227], a[180:183], v[76:79]
    v_cvt_pk_bf16_f32 v28, v72, v73
    v_mfma_f32_16x16x32_bf16 v[76:79], a[228:231], a[184:187], v[76:79]
    buffer_load_dwordx4 v6, s[12:15], s59 offen nt lds
    v_mfma_f32_16x16x32_bf16 v[48:51], a[244:247], v[28:31], v[48:51]
    s_add_u32 m0, s38, 9216
    ds_read_b128 v[84:87], v8 offset:5120
    v_cvt_pk_bf16_f32 v35, v82, v83
    v_mfma_f32_16x16x32_bf16 v[76:79], a[232:235], a[188:191], v[76:79]
    s_waitcnt lgkmcnt(1)
    ds_read_b128 a[224:227], v1 offset:7168
    buffer_load_dwordx4 v7, s[12:15], s59 offen nt lds
    v_mfma_f32_16x16x32_bf16 v[48:51], a[248:251], v[34:37], v[48:51]
    s_add_u32 s56, s67, 256
    ds_read_b128 a[228:231], v0 offset:8192
    v_add_u32 v8, 10240, v8
    v_mfma_f32_16x16x32_bf16 v[56:59], a[212:215], a[96:99], 0
    s_add_u32 s58, s33, 256
    s_add_u32 m0, s38, 4096
    ds_read_b128 a[232:235], v1 offset:8192
    v_mfma_f32_16x16x32_bf16 v[56:59], a[216:219], a[100:103], v[56:59]
    buffer_load_dwordx4 v6, s[12:15], s58 offen nt lds
    v_mfma_f32_16x16x32_bf16 v[56:59], a[220:223], a[104:107], v[56:59]
    v_cmp_lt_f32 vcc, s29, v48
    s_add_u32 m0, s38, 5120
    v_mfma_f32_16x16x32_bf16 v[64:67], a[212:215], a[120:123], 0
    buffer_store_dwordx4 v[88:91], v103, s[16:19], s57 offen offset:0 nt
    s_nop 1
    s_cbranch_vccnz L_rs_tr44d
L_ret_tr44d:
    v_fma_f32 v55, v55, s28, v9
    v_mfma_f32_16x16x32_bf16 v[64:67], a[216:219], a[124:127], v[64:67]
    v_fma_f32 v53, v53, s28, v9
    v_mfma_f32_16x16x32_bf16 v[64:67], a[220:223], a[128:131], v[64:67]
    v_fma_f32 v54, v54, s28, v9
    v_fma_f32 v52, v52, s28, v9
    v_mfma_f32_16x16x32_bf16 v[72:75], a[212:215], a[144:147], 0
    s_waitcnt lgkmcnt(3)
    buffer_load_dwordx4 v7, s[12:15], s58 offen nt lds
    v_mfma_f32_16x16x32_bf16 v[72:75], a[216:219], a[148:151], v[72:75]
    v_exp_f32 v52, v52
    v_mfma_f32_16x16x32_bf16 v[72:75], a[220:223], a[152:155], v[72:75]
    v_exp_f32 v55, v55
    v_mfma_f32_16x16x32_bf16 v[80:83], a[212:215], a[168:171], 0
    s_waitcnt vmcnt(24) lgkmcnt(0)
    v_exp_f32 v54, v54
    v_mfma_f32_16x16x32_bf16 v[80:83], a[216:219], a[172:175], v[80:83]
    buffer_store_dwordx4 v[96:99], v102, s[16:19], s56 offen offset:0 nt
    s_barrier
    ds_read_b64_tr_b16 a[212:213], v2 offset:18432
    v_fma_f32 v61, v61, s28, v10
    v_mfma_f32_16x16x32_bf16 v[80:83], a[220:223], a[176:179], v[80:83]
    ds_read_b64_tr_b16 a[214:215], v2 offset:12288
    s_add_u32 m0, s22, 0
    v_mfma_f32_16x16x32_bf16 v[56:59], a[224:227], a[108:111], v[56:59]
    buffer_load_dwordx4 v6, s[4:7], s20 offen lds
    v_mfma_f32_16x16x32_bf16 v[56:59], a[228:231], a[112:115], v[56:59]
    buffer_store_dwordx4 v[84:87], v103, s[16:19], s56 offen offset:0 nt
    s_add_u32 s20, s20, 128
    v_fma_f32 v60, v60, s28, v10
    v_exp_f32 v53, v53
    v_mfma_f32_16x16x32_bf16 v[56:59], a[232:235], a[116:119], v[56:59]
    v_exp_f32 v60, v60
    v_mfma_f32_16x16x32_bf16 v[64:67], a[224:227], a[132:135], v[64:67]
    s_add_u32 m0, s22, 1024
    ds_read_b64_tr_b16 a[216:217], v3 offset:18432
    v_cvt_pk_bf16_f32 v15, v54, v55
    v_mfma_f32_16x16x32_bf16 v[64:67], a[228:231], a[136:139], v[64:67]
    ds_read_b64_tr_b16 a[218:219], v3 offset:12288
    v_mfma_f32_16x16x32_bf16 v[64:67], a[232:235], a[140:143], v[64:67]
    buffer_load_dwordx4 v6, s[4:7], s20 offen lds
    v_mfma_f32_16x16x32_bf16 v[72:75], a[224:227], a[156:159], v[72:75]
    v_exp_f32 v61, v61
    v_mfma_f32_16x16x32_bf16 v[72:75], a[228:231], a[160:163], v[72:75]
    s_add_u32 s20, s20, 128
    ds_read_b64_tr_b16 a[220:221], v4 offset:18432
    v_mfma_f32_16x16x32_bf16 v[72:75], a[232:235], a[164:167], v[72:75]
    s_add_u32 m0, s22, 2048
    ds_read_b64_tr_b16 a[222:223], v4 offset:12288
    v_cvt_pk_bf16_f32 v14, v52, v53
    v_mfma_f32_16x16x32_bf16 v[80:83], a[224:227], a[180:183], v[80:83]
    buffer_load_dwordx4 v6, s[4:7], s20 offen lds
    v_mfma_f32_16x16x32_bf16 v[80:83], a[228:231], a[184:187], v[80:83]
    ds_read_b64_tr_b16 a[224:225], v5 offset:18432
    s_add_u32 s20, s20, 12032
    v_mfma_f32_16x16x32_bf16 v[80:83], a[232:235], a[188:191], v[80:83]
    ds_read_b64_tr_b16 a[226:227], v5 offset:12288
    v_cvt_pk_bf16_f32 v20, v60, v61
    s_branch L_loop4
L_end5:
    s_waitcnt lgkmcnt(6)
    v_mfma_f32_16x16x32_bf16 v[112:115], a[212:215], v[16:19], v[112:115]
    v_fma_f32 v71, v71, s28, v11
    v_fma_f32 v65, v65, s28, v10
    v_mfma_f32_16x16x32_bf16 v[160:163], a[212:215], v[22:25], v[160:163]
    v_fma_f32 v68, v68, s28, v11
    v_fma_f32 v57, v57, s28, v9
    v_mfma_f32_16x16x32_bf16 v[208:211], a[212:215], v[28:31], v[208:211]
    v_fma_f32 v89, v89, s28, v13
    v_mfma_f32_16x16x32_bf16 a[0:3], a[212:215], v[34:37], a[0:3]
    ds_read_b64_tr_b16 a[230:231], v2 offset:13312
    v_fma_f32 v70, v70, s28, v11
    v_mfma_f32_16x16x32_bf16 a[48:51], a[212:215], v[40:43], a[48:51]
    v_fma_f32 v58, v58, s28, v9
    s_waitcnt lgkmcnt(5)
    v_mfma_f32_16x16x32_bf16 v[116:119], a[216:219], v[16:19], v[116:119]
    ds_read_b64_tr_b16 a[228:229], v2 offset:19456
    v_fma_f32 v56, v56, s28, v9
    v_mfma_f32_16x16x32_bf16 v[164:167], a[216:219], v[22:25], v[164:167]
    v_exp_f32 v71, v71
    v_mfma_f32_16x16x32_bf16 v[212:215], a[216:219], v[28:31], v[212:215]
    v_fma_f32 v76, v76, s28, v12
    v_fma_f32 v85, v85, s28, v13
    v_mfma_f32_16x16x32_bf16 a[4:7], a[216:219], v[34:37], a[4:7]
    v_mfma_f32_16x16x32_bf16 a[52:55], a[216:219], v[40:43], a[52:55]
    s_waitcnt lgkmcnt(2)
    v_fma_f32 v87, v87, s28, v13
    v_fma_f32 v90, v90, s28, v13
    v_mfma_f32_16x16x32_bf16 v[120:123], a[220:223], v[16:19], v[120:123]
    v_exp_f32 v70, v70
    v_mfma_f32_16x16x32_bf16 v[168:171], a[220:223], v[22:25], v[168:171]
    ds_read_b64_tr_b16 a[234:235], v3 offset:13312
    v_mfma_f32_16x16x32_bf16 v[216:219], a[220:223], v[28:31], v[216:219]
    v_exp_f32 v87, v87
    v_mfma_f32_16x16x32_bf16 a[8:11], a[220:223], v[34:37], a[8:11]
    ds_read_b64_tr_b16 a[218:219], v5 offset:13312
    v_fma_f32 v74, v74, s28, v11
    v_mfma_f32_16x16x32_bf16 a[56:59], a[220:223], v[40:43], a[56:59]
    ds_read_b64_tr_b16 a[232:233], v3 offset:19456
    v_mfma_f32_16x16x32_bf16 v[124:127], a[224:227], v[16:19], v[124:127]
    ds_read_b64_tr_b16 a[220:221], v2 offset:20480
    v_fma_f32 v79, v79, s28, v12
    v_mfma_f32_16x16x32_bf16 v[172:175], a[224:227], v[22:25], v[172:175]
    ds_read_b64_tr_b16 a[216:217], v5 offset:19456
    v_fma_f32 v73, v73, s28, v11
    v_mfma_f32_16x16x32_bf16 v[220:223], a[224:227], v[28:31], v[220:223]
    v_exp_f32 v57, v57
    v_mfma_f32_16x16x32_bf16 a[12:15], a[224:227], v[34:37], a[12:15]
    ds_read_b64_tr_b16 a[212:213], v4 offset:19456
    v_fma_f32 v84, v84, s28, v13
    v_mfma_f32_16x16x32_bf16 a[60:63], a[224:227], v[40:43], a[60:63]
    s_waitcnt lgkmcnt(6)
    ds_read_b64_tr_b16 a[214:215], v4 offset:13312
    v_fma_f32 v82, v82, s28, v12
    v_mfma_f32_16x16x32_bf16 v[128:131], a[228:231], v[16:19], v[128:131]
    v_exp_f32 v68, v68
    v_mfma_f32_16x16x32_bf16 v[176:179], a[228:231], v[22:25], v[176:179]
    v_fma_f32 v64, v64, s28, v10
    v_fma_f32 v88, v88, s28, v13
    v_mfma_f32_16x16x32_bf16 v[224:227], a[228:231], v[28:31], v[224:227]
    v_fma_f32 v78, v78, s28, v12
    v_mfma_f32_16x16x32_bf16 a[16:19], a[228:231], v[34:37], a[16:19]
    ds_read_b64_tr_b16 a[222:223], v2 offset:14336
    v_mfma_f32_16x16x32_bf16 a[64:67], a[228:231], v[40:43], a[64:67]
    s_waitcnt lgkmcnt(5)
    v_exp_f32 v56, v56
    v_mfma_f32_16x16x32_bf16 v[132:135], a[232:235], v[16:19], v[132:135]
    v_exp_f32 v85, v85
    v_mfma_f32_16x16x32_bf16 v[180:183], a[232:235], v[22:25], v[180:183]
    v_exp_f32 v76, v76
    v_mfma_f32_16x16x32_bf16 v[228:231], a[232:235], v[28:31], v[228:231]
    ds_read_b64_tr_b16 a[230:231], v4 offset:14336
    v_fma_f32 v86, v86, s28, v13
    v_mfma_f32_16x16x32_bf16 a[20:23], a[232:235], v[34:37], a[20:23]
    ds_read_b64_tr_b16 a[226:227], v3 offset:14336
    v_mfma_f32_16x16x32_bf16 a[68:71], a[232:235], v[40:43], a[68:71]
    s_waitcnt lgkmcnt(3)
    ds_read_b64_tr_b16 a[234:235], v5 offset:14336
    v_mfma_f32_16x16x32_bf16 v[136:139], a[212:215], v[16:19], v[136:139]
    ds_read_b64_tr_b16 a[232:233], v5 offset:20480
    v_fma_f32 v80, v80, s28, v12
    v_mfma_f32_16x16x32_bf16 v[184:187], a[212:215], v[22:25], v[184:187]
    ds_read_b64_tr_b16 a[224:225], v3 offset:20480
    v_mfma_f32_16x16x32_bf16 v[232:235], a[212:215], v[28:31], v[232:235]
    ds_read_b64_tr_b16 a[228:229], v4 offset:20480
    v_mfma_f32_16x16x32_bf16 a[24:27], a[212:215], v[34:37], a[24:27]
    v_exp_f32 v78, v78
    v_mfma_f32_16x16x32_bf16 a[72:75], a[212:215], v[40:43], a[72:75]
    s_add_u32 s39, s39, 12288
    v_fma_f32 v77, v77, s28, v12
    v_mfma_f32_16x16x32_bf16 v[140:143], a[216:219], v[16:19], v[140:143]
    v_fma_f32 v75, v75, s28, v11
    v_mfma_f32_16x16x32_bf16 v[188:191], a[216:219], v[22:25], v[188:191]
    v_exp_f32 v84, v84
    v_mfma_f32_16x16x32_bf16 v[236:239], a[216:219], v[28:31], v[236:239]
    v_exp_f32 v75, v75
    v_mfma_f32_16x16x32_bf16 a[28:31], a[216:219], v[34:37], a[28:31]
    v_exp_f32 v64, v64
    v_mfma_f32_16x16x32_bf16 a[76:79], a[216:219], v[40:43], a[76:79]
    s_waitcnt lgkmcnt(3)
    v_mfma_f32_16x16x32_bf16 v[144:147], a[220:223], v[16:19], v[144:147]
    v_fma_f32 v72, v72, s28, v11
    v_fma_f32 v69, v69, s28, v11
    v_mfma_f32_16x16x32_bf16 v[192:195], a[220:223], v[22:25], v[192:195]
    v_exp_f32 v86, v86
    v_mfma_f32_16x16x32_bf16 v[240:243], a[220:223], v[28:31], v[240:243]
    s_waitcnt vmcnt(10) lgkmcnt(0)
    v_mfma_f32_16x16x32_bf16 a[32:35], a[220:223], v[34:37], a[32:35]
    s_barrier
    v_mfma_f32_16x16x32_bf16 a[80:83], a[220:223], v[40:43], a[80:83]
    ds_read_b128 a[216:219], v1 offset:12288
    v_mfma_f32_16x16x32_bf16 v[148:151], a[224:227], v[16:19], v[148:151]
    s_add_u32 m0, s22, 36864
    ds_read_b128 a[220:223], v0 offset:13312
    v_cvt_pk_bf16_f32 v38, v84, v85
    v_mfma_f32_16x16x32_bf16 v[196:199], a[224:227], v[22:25], v[196:199]
    v_exp_f32 v69, v69
    v_mfma_f32_16x16x32_bf16 v[244:247], a[224:227], v[28:31], v[244:247]
    buffer_load_dwordx4 v6, s[8:11], s21 offen lds
    v_mfma_f32_16x16x32_bf16 a[36:39], a[224:227], v[34:37], a[36:39]
    s_add_u32 s21, s21, 128
    ds_read_b128 a[212:215], v0 offset:12288
    v_cvt_pk_bf16_f32 v27, v70, v71
    v_mfma_f32_16x16x32_bf16 a[84:87], a[224:227], v[40:43], a[84:87]
    s_add_u32 m0, s22, 37888
    v_exp_f32 v77, v77
    v_mfma_f32_16x16x32_bf16 v[152:155], a[228:231], v[16:19], v[152:155]
    v_exp_f32 v58, v58
    v_mfma_f32_16x16x32_bf16 v[200:203], a[228:231], v[22:25], v[200:203]
    buffer_load_dwordx4 v6, s[8:11], s21 offen lds
    v_mfma_f32_16x16x32_bf16 v[248:251], a[228:231], v[28:31], v[248:251]
    v_fma_f32 v83, v83, s28, v12
    v_mfma_f32_16x16x32_bf16 a[40:43], a[228:231], v[34:37], a[40:43]
    s_add_u32 s21, s21, 128
    ds_read_b128 a[224:227], v1 offset:13312
    s_add_u32 m0, s22, 38912
    v_mfma_f32_16x16x32_bf16 a[88:91], a[228:231], v[40:43], a[88:91]
    buffer_load_dwordx4 v6, s[8:11], s21 offen lds
    v_mfma_f32_16x16x32_bf16 v[156:159], a[232:235], v[16:19], v[156:159]
    v_exp_f32 v88, v88
    v_mfma_f32_16x16x32_bf16 v[204:207], a[232:235], v[22:25], v[204:207]
    v_fma_f32 v81, v81, s28, v12
    v_mfma_f32_16x16x32_bf16 v[252:255], a[232:235], v[28:31], v[252:255]
    v_exp_f32 v80, v80
    v_mfma_f32_16x16x32_bf16 a[44:47], a[232:235], v[34:37], a[44:47]
    v_exp_f32 v65, v65
    v_mfma_f32_16x16x32_bf16 a[92:95], a[232:235], v[40:43], a[92:95]
    s_waitcnt lgkmcnt(1)
    v_exp_f32 v72, v72
    v_mfma_f32_16x16x32_bf16 v[52:55], a[212:215], a[96:99], 0
    v_exp_f32 v73, v73
    v_mfma_f32_16x16x32_bf16 v[52:55], a[216:219], a[100:103], v[52:55]
    v_exp_f32 v89, v89
    v_mfma_f32_16x16x32_bf16 v[52:55], a[220:223], a[104:107], v[52:55]
    v_exp_f32 v81, v81
    v_mfma_f32_16x16x32_bf16 v[60:63], a[212:215], a[120:123], 0
    v_exp_f32 v79, v79
    v_mfma_f32_16x16x32_bf16 v[60:63], a[216:219], a[124:127], v[60:63]
    s_add_u32 s21, s21, 12032
    ds_read_b128 a[228:231], v0 offset:14336
    v_cvt_pk_bf16_f32 v39, v86, v87
    v_mfma_f32_16x16x32_bf16 v[60:63], a[220:223], a[128:131], v[60:63]
    v_cvt_pk_bf16_f32 v33, v78, v79
    v_cvt_pk_bf16_f32 v26, v68, v69
    v_mfma_f32_16x16x32_bf16 v[68:71], a[212:215], a[144:147], 0
    ds_read_b128 a[232:235], v1 offset:14336
    v_fma_f32 v66, v66, s28, v10
    v_mfma_f32_16x16x32_bf16 v[68:71], a[216:219], a[148:151], v[68:71]
    v_cvt_pk_bf16_f32 v40, v88, v89
    v_mfma_f32_16x16x32_bf16 v[68:71], a[220:223], a[152:155], v[68:71]
    v_cvt_pk_bf16_f32 v32, v76, v77
    v_mfma_f32_16x16x32_bf16 v[76:79], a[212:215], a[168:171], 0
    v_mfma_f32_16x16x32_bf16 v[76:79], a[216:219], a[172:175], v[76:79]
    v_exp_f32 v74, v74
    v_mfma_f32_16x16x32_bf16 v[76:79], a[220:223], a[176:179], v[76:79]
    v_cvt_pk_bf16_f32 v16, v56, v57
    v_cvt_pk_bf16_f32 v34, v80, v81
    v_mfma_f32_16x16x32_bf16 v[84:87], a[212:215], a[192:195], 0
    v_fma_f32 v59, v59, s28, v9
    v_mfma_f32_16x16x32_bf16 v[84:87], a[216:219], a[196:199], v[84:87]
    v_exp_f32 v82, v82
    v_mfma_f32_16x16x32_bf16 v[84:87], a[220:223], a[200:203], v[84:87]
    s_waitcnt lgkmcnt(1)
    v_mfma_f32_16x16x32_bf16 v[52:55], a[224:227], a[108:111], v[52:55]
    v_exp_f32 v90, v90
    v_mfma_f32_16x16x32_bf16 v[52:55], a[228:231], a[112:115], v[52:55]
    s_waitcnt lgkmcnt(0)
    v_exp_f32 v83, v83
    v_mfma_f32_16x16x32_bf16 v[52:55], a[232:235], a[116:119], v[52:55]
    ds_read_b128 a[212:215], v0 offset:18432
    v_fma_f32 v91, v91, s28, v13
    v_mfma_f32_16x16x32_bf16 v[60:63], a[224:227], a[132:135], v[60:63]
    v_exp_f32 v66, v66
    v_mfma_f32_16x16x32_bf16 v[60:63], a[228:231], a[136:139], v[60:63]
    v_cvt_pk_bf16_f32 v35, v82, v83
    v_mfma_f32_16x16x32_bf16 v[60:63], a[232:235], a[140:143], v[60:63]
    v_cvt_pk_bf16_f32 v29, v74, v75
    v_fma_f32 v67, v67, s28, v10
    v_mfma_f32_16x16x32_bf16 v[68:71], a[224:227], a[156:159], v[68:71]
    v_exp_f32 v59, v59
    v_mfma_f32_16x16x32_bf16 v[68:71], a[228:231], a[160:163], v[68:71]
    v_cvt_pk_bf16_f32 v22, v64, v65
    v_mfma_f32_16x16x32_bf16 v[68:71], a[232:235], a[164:167], v[68:71]
    v_exp_f32 v67, v67
    v_mfma_f32_16x16x32_bf16 v[76:79], a[224:227], a[180:183], v[76:79]
    v_mfma_f32_16x16x32_bf16 v[76:79], a[228:231], a[184:187], v[76:79]
    ds_read_b128 a[216:219], v1 offset:18432
    v_cvt_pk_bf16_f32 v17, v58, v59
    v_mfma_f32_16x16x32_bf16 v[76:79], a[232:235], a[188:191], v[76:79]
    ds_read_b128 a[220:223], v0 offset:19456
    v_mfma_f32_16x16x32_bf16 v[84:87], a[224:227], a[204:207], v[84:87]
    v_cvt_pk_bf16_f32 v23, v66, v67
    v_mfma_f32_16x16x32_bf16 v[84:87], a[228:231], a[208:211], v[84:87]
    ds_read_b128 a[228:231], v0 offset:20480
    v_cvt_pk_bf16_f32 v28, v72, v73
    v_mfma_f32_16x16x32_bf16 v[84:87], a[232:235], v[92:95], v[84:87]
    s_waitcnt lgkmcnt(3)
    ds_read_b128 a[232:235], v1 offset:20480
    v_mfma_f32_16x16x32_bf16 v[56:59], a[212:215], a[96:99], 0
    ds_read_b128 a[224:227], v1 offset:19456
    v_mfma_f32_16x16x32_bf16 v[44:47], a[236:239], v[14:17], v[48:51]
    v_exp_f32 v91, v91
    v_mfma_f32_16x16x32_bf16 v[44:47], a[240:243], v[20:23], v[44:47]
    v_mfma_f32_16x16x32_bf16 v[44:47], a[244:247], v[26:29], v[44:47]
    v_cvt_pk_bf16_f32 v41, v90, v91
    v_mfma_f32_16x16x32_bf16 v[44:47], a[248:251], v[32:35], v[44:47]
    s_nop 0
    v_mfma_f32_16x16x32_bf16 v[44:47], a[252:255], v[38:41], v[44:47]
    s_waitcnt lgkmcnt(4)
    v_mfma_f32_16x16x32_bf16 v[56:59], a[216:219], a[100:103], v[56:59]
    s_waitcnt lgkmcnt(3)
    v_mfma_f32_16x16x32_bf16 v[56:59], a[220:223], a[104:107], v[56:59]
    v_mfma_f32_16x16x32_bf16 v[64:67], a[212:215], a[120:123], 0
    v_mfma_f32_16x16x32_bf16 v[64:67], a[216:219], a[124:127], v[64:67]
    s_nop 1
    v_cmp_lt_f32 vcc, s29, v44
    v_mfma_f32_16x16x32_bf16 v[64:67], a[220:223], a[128:131], v[64:67]
    s_waitcnt vmcnt(7) lgkmcnt(0)
    v_mfma_f32_16x16x32_bf16 v[72:75], a[212:215], a[144:147], 0
    s_barrier
    v_mfma_f32_16x16x32_bf16 v[72:75], a[216:219], a[148:151], v[72:75]
    s_cbranch_vccnz L_rs_end5a
L_ret_end5a:
    v_fma_f32 v53, v53, s28, v9
    v_mfma_f32_16x16x32_bf16 v[72:75], a[220:223], a[152:155], v[72:75]
    v_fma_f32 v52, v52, s28, v9
    v_fma_f32 v60, v60, s28, v10
    v_mfma_f32_16x16x32_bf16 v[80:83], a[212:215], a[168:171], 0
    v_fma_f32 v54, v54, s28, v9
    v_fma_f32 v63, v63, s28, v10
    v_mfma_f32_16x16x32_bf16 v[80:83], a[216:219], a[172:175], v[80:83]
    v_exp_f32 v60, v60
    v_mfma_f32_16x16x32_bf16 v[80:83], a[220:223], a[176:179], v[80:83]
    v_exp_f32 v53, v53
    v_mfma_f32_16x16x32_bf16 v[88:91], a[212:215], a[192:195], 0
    ds_read_b64_tr_b16 a[212:213], v2 offset:0
    v_mfma_f32_16x16x32_bf16 v[88:91], a[216:219], a[196:199], v[88:91]
    v_fma_f32 v62, v62, s28, v10
    v_fma_f32 v55, v55, s28, v9
    v_mfma_f32_16x16x32_bf16 v[88:91], a[220:223], a[200:203], v[88:91]
    v_exp_f32 v62, v62
    v_mfma_f32_16x16x32_bf16 v[56:59], a[224:227], a[108:111], v[56:59]
    v_exp_f32 v63, v63
    v_mfma_f32_16x16x32_bf16 v[56:59], a[228:231], a[112:115], v[56:59]
    v_exp_f32 v55, v55
    v_mfma_f32_16x16x32_bf16 v[56:59], a[232:235], a[116:119], v[56:59]
    ds_read_b64_tr_b16 a[214:215], v2 offset:6144
    v_mfma_f32_16x16x32_bf16 v[64:67], a[224:227], a[132:135], v[64:67]
    ds_read_b64_tr_b16 a[216:217], v3 offset:0
    v_mfma_f32_16x16x32_bf16 v[64:67], a[228:231], a[136:139], v[64:67]
    v_exp_f32 v54, v54
    v_mfma_f32_16x16x32_bf16 v[64:67], a[232:235], a[140:143], v[64:67]
    v_mfma_f32_16x16x32_bf16 v[72:75], a[224:227], a[156:159], v[72:75]
    ds_read_b64_tr_b16 a[218:219], v3 offset:6144
    v_cvt_pk_bf16_f32 v25, v62, v63
    v_mfma_f32_16x16x32_bf16 v[72:75], a[228:231], a[160:163], v[72:75]
    v_fma_f32 v61, v61, s28, v10
    v_mfma_f32_16x16x32_bf16 v[72:75], a[232:235], a[164:167], v[72:75]
    v_exp_f32 v61, v61
    v_mfma_f32_16x16x32_bf16 v[80:83], a[224:227], a[180:183], v[80:83]
    v_exp_f32 v52, v52
    v_mfma_f32_16x16x32_bf16 v[80:83], a[228:231], a[184:187], v[80:83]
    ds_read_b64_tr_b16 a[220:221], v4 offset:0
    v_mfma_f32_16x16x32_bf16 v[80:83], a[232:235], a[188:191], v[80:83]
    ds_read_b64_tr_b16 a[222:223], v4 offset:6144
    v_mfma_f32_16x16x32_bf16 v[88:91], a[224:227], a[204:207], v[88:91]
    ds_read_b64_tr_b16 a[224:225], v5 offset:0
    v_mfma_f32_16x16x32_bf16 v[88:91], a[228:231], a[208:211], v[88:91]
    v_cvt_pk_bf16_f32 v18, v52, v53
    v_cvt_pk_bf16_f32 v24, v60, v61
    v_mfma_f32_16x16x32_bf16 v[88:91], a[232:235], v[92:95], v[88:91]
    ds_read_b64_tr_b16 a[226:227], v5 offset:6144
    v_cvt_pk_bf16_f32 v19, v54, v55
    s_waitcnt lgkmcnt(6)
    v_mfma_f32_16x16x32_bf16 v[112:115], a[212:215], v[14:17], v[112:115]
    v_fma_f32 v64, v64, s28, v10
    v_fma_f32 v84, v84, s28, v13
    v_fma_f32 v75, v75, s28, v11
    v_mfma_f32_16x16x32_bf16 v[160:163], a[212:215], v[20:23], v[160:163]
    v_fma_f32 v77, v77, s28, v12
    v_fma_f32 v90, v90, s28, v13
    v_mfma_f32_16x16x32_bf16 v[208:211], a[212:215], v[26:29], v[208:211]
    s_add_u32 s39, s39, 12288
    ds_read_b64_tr_b16 a[228:229], v2 offset:1024
    v_fma_f32 v91, v91, s28, v13
    v_mfma_f32_16x16x32_bf16 a[0:3], a[212:215], v[32:35], a[0:3]
    s_waitcnt vmcnt(0)
    v_fma_f32 v59, v59, s28, v9
    v_fma_f32 v57, v57, s28, v9
    v_fma_f32 v79, v79, s28, v12
    v_mfma_f32_16x16x32_bf16 a[48:51], a[212:215], v[38:41], a[48:51]
    s_waitcnt lgkmcnt(5)
    v_fma_f32 v87, v87, s28, v13
    v_fma_f32 v73, v73, s28, v11
    v_mfma_f32_16x16x32_bf16 v[116:119], a[216:219], v[14:17], v[116:119]
    v_fma_f32 v89, v89, s28, v13
    v_fma_f32 v80, v80, s28, v12
    v_mfma_f32_16x16x32_bf16 v[164:167], a[216:219], v[20:23], v[164:167]
    s_barrier
    v_mfma_f32_16x16x32_bf16 v[212:215], a[216:219], v[26:29], v[212:215]
    ds_read_b64_tr_b16 a[232:233], v3 offset:1024
    v_fma_f32 v82, v82, s28, v12
    v_mfma_f32_16x16x32_bf16 a[4:7], a[216:219], v[32:35], a[4:7]
    v_exp_f32 v73, v73
    v_mfma_f32_16x16x32_bf16 a[52:55], a[216:219], v[38:41], a[52:55]
    s_waitcnt lgkmcnt(2)
    ds_read_b64_tr_b16 a[230:231], v2 offset:7168
    v_fma_f32 v68, v68, s28, v11
    v_mfma_f32_16x16x32_bf16 v[120:123], a[220:223], v[14:17], v[120:123]
    v_exp_f32 v91, v91
    v_mfma_f32_16x16x32_bf16 v[168:171], a[220:223], v[20:23], v[168:171]
    ds_read_b64_tr_b16 a[234:235], v3 offset:7168
    v_exp_f32 v80, v80
    v_mfma_f32_16x16x32_bf16 v[216:219], a[220:223], v[26:29], v[216:219]
    v_exp_f32 v82, v82
    v_mfma_f32_16x16x32_bf16 a[8:11], a[220:223], v[32:35], a[8:11]
    v_fma_f32 v81, v81, s28, v12
    v_fma_f32 v66, v66, s28, v10
    v_mfma_f32_16x16x32_bf16 a[56:59], a[220:223], v[38:41], a[56:59]
    ds_read_b64_tr_b16 a[214:215], v4 offset:7168
    v_fma_f32 v71, v71, s28, v11
    v_mfma_f32_16x16x32_bf16 v[124:127], a[224:227], v[14:17], v[124:127]
    ds_read_b64_tr_b16 a[220:221], v2 offset:2048
    v_fma_f32 v67, v67, s28, v10
    v_mfma_f32_16x16x32_bf16 v[172:175], a[224:227], v[20:23], v[172:175]
    ds_read_b64_tr_b16 a[212:213], v4 offset:1024
    v_fma_f32 v85, v85, s28, v13
    v_mfma_f32_16x16x32_bf16 v[220:223], a[224:227], v[26:29], v[220:223]
    ds_read_b64_tr_b16 a[216:217], v5 offset:1024
    v_fma_f32 v72, v72, s28, v11
    v_mfma_f32_16x16x32_bf16 a[12:15], a[224:227], v[32:35], a[12:15]
    ds_read_b64_tr_b16 a[218:219], v5 offset:7168
    v_fma_f32 v78, v78, s28, v12
    v_fma_f32 v74, v74, s28, v11
    v_mfma_f32_16x16x32_bf16 a[60:63], a[224:227], v[38:41], a[60:63]
    s_waitcnt lgkmcnt(6)
    v_exp_f32 v89, v89
    v_mfma_f32_16x16x32_bf16 v[128:131], a[228:231], v[14:17], v[128:131]
    v_fma_f32 v86, v86, s28, v13
    v_fma_f32 v58, v58, s28, v9
    v_mfma_f32_16x16x32_bf16 v[176:179], a[228:231], v[20:23], v[176:179]
    v_fma_f32 v70, v70, s28, v11
    v_fma_f32 v69, v69, s28, v11
    v_mfma_f32_16x16x32_bf16 v[224:227], a[228:231], v[26:29], v[224:227]
    v_exp_f32 v75, v75
    v_mfma_f32_16x16x32_bf16 a[16:19], a[228:231], v[32:35], a[16:19]
    v_exp_f32 v79, v79
    v_mfma_f32_16x16x32_bf16 a[64:67], a[228:231], v[38:41], a[64:67]
    s_waitcnt lgkmcnt(4)
    v_exp_f32 v67, v67
    v_fma_f32 v76, v76, s28, v12
    v_mfma_f32_16x16x32_bf16 v[132:135], a[232:235], v[14:17], v[132:135]
    ds_read_b64_tr_b16 a[222:223], v2 offset:8192
    v_fma_f32 v65, v65, s28, v10
    v_mfma_f32_16x16x32_bf16 v[180:183], a[232:235], v[20:23], v[180:183]
    ds_read_b64_tr_b16 a[226:227], v3 offset:8192
    v_exp_f32 v85, v85
    v_mfma_f32_16x16x32_bf16 v[228:231], a[232:235], v[26:29], v[228:231]
    v_exp_f32 v81, v81
    v_mfma_f32_16x16x32_bf16 a[20:23], a[232:235], v[32:35], a[20:23]
    v_exp_f32 v69, v69
    v_mfma_f32_16x16x32_bf16 a[68:71], a[232:235], v[38:41], a[68:71]
    s_waitcnt lgkmcnt(2)
    v_exp_f32 v57, v57
    v_mfma_f32_16x16x32_bf16 v[136:139], a[212:215], v[14:17], v[136:139]
    v_exp_f32 v90, v90
    v_mfma_f32_16x16x32_bf16 v[184:187], a[212:215], v[20:23], v[184:187]
    v_exp_f32 v59, v59
    v_mfma_f32_16x16x32_bf16 v[232:235], a[212:215], v[26:29], v[232:235]
    v_exp_f32 v78, v78
    v_mfma_f32_16x16x32_bf16 a[24:27], a[212:215], v[32:35], a[24:27]
    v_exp_f32 v64, v64
    v_mfma_f32_16x16x32_bf16 a[72:75], a[212:215], v[38:41], a[72:75]
    ds_read_b64_tr_b16 a[224:225], v3 offset:2048
    v_fma_f32 v83, v83, s28, v12
    v_mfma_f32_16x16x32_bf16 v[140:143], a[216:219], v[14:17], v[140:143]
    ds_read_b64_tr_b16 a[228:229], v4 offset:2048
    v_fma_f32 v88, v88, s28, v13
    v_mfma_f32_16x16x32_bf16 v[188:191], a[216:219], v[20:23], v[188:191]
    ds_read_b64_tr_b16 a[212:213], v2 offset:18432
    v_exp_f32 v84, v84
    v_mfma_f32_16x16x32_bf16 v[236:239], a[216:219], v[26:29], v[236:239]
    v_exp_f32 v68, v68
    v_mfma_f32_16x16x32_bf16 a[28:31], a[216:219], v[32:35], a[28:31]
    ds_read_b64_tr_b16 a[230:231], v4 offset:8192
    v_cvt_pk_bf16_f32 v37, v78, v79
    v_mfma_f32_16x16x32_bf16 a[76:79], a[216:219], v[38:41], a[76:79]
    s_waitcnt lgkmcnt(4)
    v_exp_f32 v87, v87
    v_mfma_f32_16x16x32_bf16 v[144:147], a[220:223], v[14:17], v[144:147]
    ds_read_b64_tr_b16 a[234:235], v5 offset:8192
    v_cvt_pk_bf16_f32 v42, v84, v85
    v_mfma_f32_16x16x32_bf16 v[192:195], a[220:223], v[20:23], v[192:195]
    v_exp_f32 v70, v70
    v_mfma_f32_16x16x32_bf16 v[240:243], a[220:223], v[26:29], v[240:243]
    ds_read_b64_tr_b16 a[214:215], v2 offset:12288
    v_cvt_pk_bf16_f32 v30, v68, v69
    v_mfma_f32_16x16x32_bf16 a[32:35], a[220:223], v[32:35], a[32:35]
    v_exp_f32 v66, v66
    v_mfma_f32_16x16x32_bf16 a[80:83], a[220:223], v[38:41], a[80:83]
    s_waitcnt lgkmcnt(5)
    ds_read_b64_tr_b16 a[232:233], v5 offset:2048
    v_fma_f32 v56, v56, s28, v9
    v_mfma_f32_16x16x32_bf16 v[148:151], a[224:227], v[14:17], v[148:151]
    v_exp_f32 v86, v86
    v_mfma_f32_16x16x32_bf16 v[196:199], a[224:227], v[20:23], v[196:199]
    v_exp_f32 v76, v76
    v_mfma_f32_16x16x32_bf16 v[244:247], a[224:227], v[26:29], v[244:247]
    v_exp_f32 v72, v72
    v_cvt_pk_bf16_f32 v43, v86, v87
    v_mfma_f32_16x16x32_bf16 a[36:39], a[224:227], v[32:35], a[36:39]
    v_exp_f32 v74, v74
    v_mfma_f32_16x16x32_bf16 a[84:87], a[224:227], v[38:41], a[84:87]
    s_waitcnt lgkmcnt(3)
    v_exp_f32 v58, v58
    v_mfma_f32_16x16x32_bf16 v[152:155], a[228:231], v[14:17], v[152:155]
    ds_read_b64_tr_b16 a[216:217], v3 offset:18432
    v_exp_f32 v71, v71
    v_mfma_f32_16x16x32_bf16 v[200:203], a[228:231], v[20:23], v[200:203]
    v_exp_f32 v56, v56
    v_mfma_f32_16x16x32_bf16 v[248:251], a[228:231], v[26:29], v[248:251]
    v_exp_f32 v88, v88
    v_mfma_f32_16x16x32_bf16 a[40:43], a[228:231], v[32:35], a[40:43]
    ds_read_b64_tr_b16 a[218:219], v3 offset:12288
    v_exp_f32 v77, v77
    v_mfma_f32_16x16x32_bf16 a[88:91], a[228:231], v[38:41], a[88:91]
    s_waitcnt lgkmcnt(2)
    v_exp_f32 v83, v83
    v_mfma_f32_16x16x32_bf16 v[156:159], a[232:235], v[14:17], v[156:159]
    v_exp_f32 v65, v65
    v_mfma_f32_16x16x32_bf16 v[204:207], a[232:235], v[20:23], v[204:207]
    v_cvt_pk_bf16_f32 v16, v56, v57
    v_cvt_pk_bf16_f32 v17, v58, v59
    v_mfma_f32_16x16x32_bf16 v[252:255], a[232:235], v[26:29], v[252:255]
    v_cvt_pk_bf16_f32 v22, v64, v65
    v_cvt_pk_bf16_f32 v29, v74, v75
    v_mfma_f32_16x16x32_bf16 a[44:47], a[232:235], v[32:35], a[44:47]
    v_cvt_pk_bf16_f32 v34, v80, v81
    v_cvt_pk_bf16_f32 v23, v66, v67
    v_mfma_f32_16x16x32_bf16 v[48:51], a[236:239], v[16:19], v[44:47]
    ds_read_b64_tr_b16 a[220:221], v4 offset:18432
    v_cvt_pk_bf16_f32 v35, v82, v83
    v_mfma_f32_16x16x32_bf16 a[92:95], a[232:235], v[38:41], a[92:95]
    v_cvt_pk_bf16_f32 v31, v70, v71
    v_cvt_pk_bf16_f32 v28, v72, v73
    v_mfma_f32_16x16x32_bf16 v[48:51], a[240:243], v[22:25], v[48:51]
    ds_read_b64_tr_b16 a[222:223], v4 offset:12288
    v_cvt_pk_bf16_f32 v36, v76, v77
    v_mfma_f32_16x16x32_bf16 v[48:51], a[244:247], v[28:31], v[48:51]
    v_cvt_pk_bf16_f32 v40, v88, v89
    v_cvt_pk_bf16_f32 v41, v90, v91
    v_mfma_f32_16x16x32_bf16 v[48:51], a[248:251], v[34:37], v[48:51]
    ds_read_b64_tr_b16 a[224:225], v5 offset:18432
    v_mfma_f32_16x16x32_bf16 v[48:51], a[252:255], v[40:43], v[48:51]
    s_nop 7
    v_cmp_lt_f32 vcc, s29, v48
    s_nop 4
    s_cbranch_vccnz L_rs_end5b
L_ret_end5b:
    ds_read_b64_tr_b16 a[226:227], v5 offset:12288
    s_waitcnt lgkmcnt(6)
    v_mfma_f32_16x16x32_bf16 v[112:115], a[212:215], v[16:19], v[112:115]
    v_mbcnt_lo_u32_b32 v104, -1, 0
    v_mfma_f32_16x16x32_bf16 v[160:163], a[212:215], v[22:25], v[160:163]
    ds_read_b64_tr_b16 a[232:233], v3 offset:19456
    v_subrev_u32 v8, 28672, v8
    v_mfma_f32_16x16x32_bf16 v[208:211], a[212:215], v[28:31], v[208:211]
    ds_read_b64_tr_b16 a[230:231], v2 offset:13312
    v_mov_b32 v100, v48
    v_mfma_f32_16x16x32_bf16 a[0:3], a[212:215], v[34:37], a[0:3]
    v_rcp_f32 v49, v49
    v_mfma_f32_16x16x32_bf16 a[48:51], a[212:215], v[40:43], a[48:51]
    ds_read_b64_tr_b16 a[212:213], v4 offset:19456
    s_waitcnt lgkmcnt(7)
    v_mfma_f32_16x16x32_bf16 v[116:119], a[216:219], v[16:19], v[116:119]
    v_rcp_f32 v50, v50
    v_mfma_f32_16x16x32_bf16 v[164:167], a[216:219], v[22:25], v[164:167]
    v_rcp_f32 v51, v51
    v_mfma_f32_16x16x32_bf16 v[212:215], a[216:219], v[28:31], v[212:215]
    ds_read_b64_tr_b16 a[228:229], v2 offset:19456
    v_mul_f32 v163, v163, v49
    v_mfma_f32_16x16x32_bf16 a[4:7], a[216:219], v[34:37], a[4:7]
    ds_read_b64_tr_b16 a[214:215], v4 offset:13312
    v_mul_f32 v161, v161, v49
    v_mfma_f32_16x16x32_bf16 a[52:55], a[216:219], v[40:43], a[52:55]
    s_waitcnt lgkmcnt(5)
    v_mbcnt_hi_u32_b32 v104, -1, v104
    v_mfma_f32_16x16x32_bf16 v[120:123], a[220:223], v[16:19], v[120:123]
    ds_read_b64_tr_b16 a[234:235], v3 offset:13312
    v_mul_f32 v166, v166, v49
    v_mfma_f32_16x16x32_bf16 v[168:171], a[220:223], v[22:25], v[168:171]
    ds_read_b64_tr_b16 a[218:219], v5 offset:13312
    v_accvgpr_read_b32 v109, a5
    v_mfma_f32_16x16x32_bf16 v[216:219], a[220:223], v[28:31], v[216:219]
    v_mul_f32 v160, v160, v49
    v_and_b32 v107, 3, v104
    v_mfma_f32_16x16x32_bf16 a[8:11], a[220:223], v[34:37], a[8:11]
    v_permlane32_swap_b32 v48, v100
    v_mfma_f32_16x16x32_bf16 a[56:59], a[220:223], v[40:43], a[56:59]
    ds_read_b64_tr_b16 a[216:217], v5 offset:19456
    v_mul_f32 v168, v168, v49
    v_mfma_f32_16x16x32_bf16 v[124:127], a[224:227], v[16:19], v[124:127]
    v_mul_f32 v162, v162, v49
    v_lshrrev_b32 v106, 5, v104
    v_mfma_f32_16x16x32_bf16 v[172:175], a[224:227], v[22:25], v[172:175]
    ds_read_b64_tr_b16 a[222:223], v2 offset:14336
    v_mul_f32 v169, v169, v49
    v_mfma_f32_16x16x32_bf16 v[220:223], a[224:227], v[28:31], v[220:223]
    v_bfe_u32 v105, v104, 3, 1
    v_xor_b32 v106, v106, v105
    v_mfma_f32_16x16x32_bf16 a[12:15], a[224:227], v[34:37], a[12:15]
    s_nop 1
    v_mul_f32 v172, v172, v49
    v_mfma_f32_16x16x32_bf16 a[60:63], a[224:227], v[40:43], a[60:63]
    s_waitcnt lgkmcnt(4)
    v_mul_f32 v175, v175, v49
    v_lshl_or_b32 v106, v107, 1, v106
    v_mfma_f32_16x16x32_bf16 v[128:131], a[228:231], v[16:19], v[128:131]
    v_mul_f32 v164, v164, v49
    v_mul_f32 v173, v173, v49
    v_mfma_f32_16x16x32_bf16 v[176:179], a[228:231], v[22:25], v[176:179]
    v_accvgpr_read_b32 v55, a11
    v_mul_f32 v165, v165, v49
    v_mfma_f32_16x16x32_bf16 v[224:227], a[228:231], v[28:31], v[224:227]
    v_and_b32 v107, 7, v104
    v_xor_b32 v105, s65, v105
    v_mfma_f32_16x16x32_bf16 a[16:19], a[228:231], v[34:37], a[16:19]
    v_cvt_pk_bf16_f32 v172, v172, v173
    v_mul_f32 v167, v167, v49
    v_mfma_f32_16x16x32_bf16 a[64:67], a[228:231], v[40:43], a[64:67]
    s_add_u32 s84, s34, 0
    v_lshl_add_u32 v101, v105, 10, s38
    s_waitcnt lgkmcnt(1)
    v_mfma_f32_16x16x32_bf16 v[132:135], a[232:235], v[16:19], v[132:135]
    ds_read_b64_tr_b16 a[230:231], v4 offset:14336
    v_accvgpr_read_b32 v108, a4
    v_mfma_f32_16x16x32_bf16 v[180:183], a[232:235], v[22:25], v[180:183]
    s_add_u32 s85, s34, 6144
    ds_read_b64_tr_b16 a[228:229], v4 offset:20480
    v_lshl_add_u32 v101, v106, 4, v101
    v_mfma_f32_16x16x32_bf16 v[228:231], a[232:235], v[28:31], v[228:231]
    v_rcp_f32 v48, v48
    v_mfma_f32_16x16x32_bf16 a[20:23], a[232:235], v[34:37], a[20:23]
    ds_read_b64_tr_b16 a[226:227], v3 offset:14336
    v_accvgpr_read_b32 v56, a12
    v_mfma_f32_16x16x32_bf16 a[68:71], a[232:235], v[40:43], a[68:71]
    ds_read_b64_tr_b16 a[232:233], v5 offset:20480
    v_mul_f32 v170, v170, v49
    v_mfma_f32_16x16x32_bf16 v[136:139], a[212:215], v[16:19], v[136:139]
    ds_read_b64_tr_b16 a[224:225], v3 offset:20480
    v_lshl_add_u32 v101, v107, 7, v101
    v_mfma_f32_16x16x32_bf16 v[184:187], a[212:215], v[22:25], v[184:187]
    ds_read_b64_tr_b16 a[220:221], v2 offset:20480
    v_cvt_pk_bf16_f32 v160, v160, v161
    v_accvgpr_read_b32 v106, a2
    v_bfe_u32 v107, v104, 4, 1
    v_cvt_pk_bf16_f32 v164, v164, v165
    v_pk_mul_f32 v[120:121], v[120:121], v[48:49] op_sel_hi:[1,0]
    v_pk_mul_f32 v[116:117], v[116:117], v[48:49] op_sel_hi:[1,0]
    v_pk_mul_f32 v[122:123], v[122:123], v[48:49] op_sel_hi:[1,0]
    v_pk_mul_f32 v[112:113], v[112:113], v[48:49] op_sel_hi:[1,0]
    v_pk_mul_f32 v[126:127], v[126:127], v[48:49] op_sel_hi:[1,0]
    v_pk_mul_f32 v[118:119], v[118:119], v[48:49] op_sel_hi:[1,0]
    v_pk_mul_f32 v[214:215], v[214:215], v[50:51] op_sel_hi:[1,0]
    v_pk_mul_f32 v[124:125], v[124:125], v[48:49] op_sel_hi:[1,0]
    v_pk_mul_f32 v[114:115], v[114:115], v[48:49] op_sel_hi:[1,0]
    v_pk_mul_f32 v[212:213], v[212:213], v[50:51] op_sel_hi:[1,0]
    v_accvgpr_read_b32 v59, a15
    v_mul_f32 v174, v174, v49
    v_mfma_f32_16x16x32_bf16 v[232:235], a[212:215], v[28:31], v[232:235]
    v_cvt_pk_bf16_f32 v120, v120, v121
    v_cvt_pk_bf16_f32 v168, v168, v169
    v_mfma_f32_16x16x32_bf16 a[24:27], a[212:215], v[34:37], a[24:27]
    v_cvt_pk_bf16_f32 v161, v162, v163
    v_cvt_pk_bf16_f32 v116, v116, v117
    v_mfma_f32_16x16x32_bf16 a[72:75], a[212:215], v[40:43], a[72:75]
    v_cvt_pk_bf16_f32 v124, v124, v125
    v_mul_f32 v171, v171, v49
    v_mfma_f32_16x16x32_bf16 v[140:143], a[216:219], v[16:19], v[140:143]
    s_add_u32 s86, s34, 12288
    v_mul_f32 v109, v109, v51
    v_mul_f32 v56, v56, v51
    v_mfma_f32_16x16x32_bf16 v[188:191], a[216:219], v[22:25], v[188:191]
    v_cvt_pk_bf16_f32 v165, v166, v167
    v_cvt_pk_bf16_f32 v112, v112, v113
    v_mfma_f32_16x16x32_bf16 v[236:239], a[216:219], v[28:31], v[236:239]
    v_mul_f32 v108, v108, v51
    v_lshl_add_u32 v101, v107, 3, v101
    v_mfma_f32_16x16x32_bf16 a[28:31], a[216:219], v[34:37], a[28:31]
    v_cvt_pk_bf16_f32 v113, v114, v115
    v_mov_b32 v104, v100
    v_mfma_f32_16x16x32_bf16 a[76:79], a[216:219], v[40:43], a[76:79]
    s_waitcnt lgkmcnt(0)
    v_cvt_pk_bf16_f32 v125, v126, v127
    v_xor_b32 v93, 64, v101
    v_mfma_f32_16x16x32_bf16 v[144:147], a[220:223], v[16:19], v[144:147]
    v_mul_f32 v181, v181, v49
    v_cvt_pk_bf16_f32 v117, v118, v119
    v_mfma_f32_16x16x32_bf16 v[192:195], a[220:223], v[22:25], v[192:195]
    v_xor_b32 v92, 32, v101
    v_mfma_f32_16x16x32_bf16 v[240:243], a[220:223], v[28:31], v[240:243]
    v_cvt_pk_bf16_f32 v173, v174, v175
    v_mfma_f32_16x16x32_bf16 a[32:35], a[220:223], v[34:37], a[32:35]
    v_accvgpr_read_b32 v54, a10
    v_xor_b32 v94, 96, v101
    v_mfma_f32_16x16x32_bf16 a[80:83], a[220:223], v[40:43], a[80:83]
    ds_read_b64_tr_b16 a[234:235], v5 offset:14336
    v_cvt_pk_bf16_f32 v169, v170, v171
    v_mfma_f32_16x16x32_bf16 v[148:151], a[224:227], v[16:19], v[148:151]
    v_accvgpr_read_b32 v52, a8
    v_accvgpr_read_b32 v57, a13
    v_mfma_f32_16x16x32_bf16 v[196:199], a[224:227], v[22:25], v[196:199]
    v_mul_f32 v55, v55, v51
    v_cvt_pk_bf16_f32 v121, v122, v123
    v_mfma_f32_16x16x32_bf16 v[244:247], a[224:227], v[28:31], v[244:247]
    v_accvgpr_read_b32 v53, a9
    v_accvgpr_read_b32 v111, a7
    v_mfma_f32_16x16x32_bf16 a[36:39], a[224:227], v[34:37], a[36:39]
    s_add_u32 s87, s34, 18432
    ds_write2st64_b64 v101, v[112:113], v[160:161] offset0:0 offset1:12
    v_mfma_f32_16x16x32_bf16 a[84:87], a[224:227], v[40:43], a[84:87]
    ds_write2st64_b64 v92, v[116:117], v[164:165] offset0:0 offset1:12
    v_mfma_f32_16x16x32_bf16 v[152:155], a[228:231], v[16:19], v[152:155]
    ds_write2st64_b64 v93, v[120:121], v[168:169] offset0:0 offset1:12
    v_mfma_f32_16x16x32_bf16 v[200:203], a[228:231], v[22:25], v[200:203]
    ds_write2st64_b64 v94, v[124:125], v[172:173] offset0:0 offset1:12
    v_mfma_f32_16x16x32_bf16 v[248:251], a[228:231], v[28:31], v[248:251]
    ds_read_b128 v[76:79], v8 offset:0
    v_mul_f32 v53, v53, v51
    v_permlane16_swap_b32 v100, v104
    v_pk_mul_f32 v[128:129], v[128:129], v[48:49] op_sel_hi:[1,0]
    v_mul_f32 v193, v193, v49
    v_mul_f32 v57, v57, v51
    v_pk_mul_f32 v[218:219], v[218:219], v[50:51] op_sel_hi:[1,0]
    v_accvgpr_read_b32 v105, a1
    v_mul_f32 v59, v59, v51
    v_pk_mul_f32 v[210:211], v[210:211], v[50:51] op_sel_hi:[1,0]
    v_pk_mul_f32 v[216:217], v[216:217], v[50:51] op_sel_hi:[1,0]
    v_mul_f32 v179, v179, v49
    s_add_u32 s88, s34, 24576
    v_mul_f32 v106, v106, v51
    v_accvgpr_read_b32 v110, a6
    v_cvt_pk_bf16_f32 v212, v212, v213
    v_mul_f32 v190, v190, v49
    v_mfma_f32_16x16x32_bf16 a[40:43], a[228:231], v[34:37], a[40:43]
    ds_read_b128 v[80:83], v8 offset:1024
    v_mul_f32 v110, v110, v51
    v_mul_f32 v52, v52, v51
    v_mfma_f32_16x16x32_bf16 a[88:91], a[228:231], v[40:43], a[88:91]
    s_add_u32 s18, s34, 30720
    v_accvgpr_read_b32 v58, a14
    s_waitcnt lgkmcnt(3)
    v_mfma_f32_16x16x32_bf16 v[156:159], a[232:235], v[16:19], v[156:159]
    v_mul_f32 v186, v186, v49
    ds_read_b128 v[84:87], v8 offset:6144
    v_cvt_pk_bf16_f32 v108, v108, v109
    v_cvt_pk_bf16_f32 v52, v52, v53
    v_cvt_pk_bf16_f32 v216, v216, v217
    s_waitcnt lgkmcnt(2)
    buffer_store_dwordx4 v[76:79], v102, s[16:19], s84 offen offset:0 nt
    v_pk_mul_f32 v[208:209], v[208:209], v[50:51] op_sel_hi:[1,0]
    v_mul_f32 v105, v105, v51
    v_mul_f32 v54, v54, v51
    v_mul_f32 v111, v111, v51
    v_cvt_pk_bf16_f32 v56, v56, v57
    v_pk_mul_f32 v[134:135], v[134:135], v[48:49] op_sel_hi:[1,0]
    v_accvgpr_read_b32 v107, a3
    v_pk_mul_f32 v[132:133], v[132:133], v[48:49] op_sel_hi:[1,0]
    v_mul_f32 v200, v200, v49
    v_mul_f32 v177, v177, v49
    v_pk_mul_f32 v[140:141], v[140:141], v[48:49] op_sel_hi:[1,0]
    v_pk_mul_f32 v[220:221], v[220:221], v[50:51] op_sel_hi:[1,0]
    v_accvgpr_read_b32 v104, a0
    v_mul_f32 v104, v104, v51
    v_mfma_f32_16x16x32_bf16 v[204:207], a[232:235], v[22:25], v[204:207]
    v_cvt_pk_bf16_f32 v104, v104, v105
    v_mul_f32 v107, v107, v51
    ds_read_b128 v[88:91], v8 offset:7168
    v_pk_mul_f32 v[138:139], v[138:139], v[48:49] op_sel_hi:[1,0]
    v_cvt_pk_bf16_f32 v208, v208, v209
    v_pk_mul_f32 v[236:237], v[236:237], v[50:51] op_sel_hi:[1,0]
    v_cvt_pk_bf16_f32 v132, v132, v133
    v_cvt_pk_bf16_f32 v209, v210, v211
    v_cvt_pk_bf16_f32 v105, v106, v107
    v_cvt_pk_bf16_f32 v220, v220, v221
    v_mfma_f32_16x16x32_bf16 v[252:255], a[232:235], v[28:31], v[252:255]
    s_waitcnt lgkmcnt(1)
    buffer_store_dwordx4 v[80:83], v103, s[16:19], s84 offen offset:0 nt
    v_pk_mul_f32 v[228:229], v[228:229], v[50:51] op_sel_hi:[1,0]
    ds_write2st64_b64 v101, v[208:209], v[104:105] offset0:24 offset1:36
    v_mul_f32 v58, v58, v51
    v_pk_mul_f32 v[222:223], v[222:223], v[50:51] op_sel_hi:[1,0]
    v_cvt_pk_bf16_f32 v53, v54, v55
    s_nop 0
    v_mfma_f32_16x16x32_bf16 a[44:47], a[232:235], v[34:37], a[44:47]
    v_mul_f32 v185, v185, v49
    v_cvt_pk_bf16_f32 v57, v58, v59
    v_cvt_pk_bf16_f32 v213, v214, v215
    v_mul_f32 v182, v182, v49
    v_cvt_pk_bf16_f32 v109, v110, v111
    v_pk_mul_f32 v[148:149], v[148:149], v[48:49] op_sel_hi:[1,0]
    v_cvt_pk_bf16_f32 v221, v222, v223
    v_mul_f32 v184, v184, v49
    v_cvt_pk_bf16_f32 v128, v128, v129
    v_accvgpr_read_b32 v107, a51
    v_cvt_pk_bf16_f32 v140, v140, v141
    v_cvt_pk_bf16_f32 v217, v218, v219
    buffer_store_dwordx4 v[84:87], v102, s[16:19], s85 offen offset:0 nt
    ds_write2st64_b64 v92, v[212:213], v[108:109] offset0:24 offset1:36
    v_accvgpr_read_b32 v109, a53
    ds_write2st64_b64 v93, v[216:217], v[52:53] offset0:24 offset1:36
    v_accvgpr_read_b32 v52, a56
    v_mfma_f32_16x16x32_bf16 a[92:95], a[232:235], v[40:43], a[92:95]
    ds_write2st64_b64 v94, v[220:221], v[56:57] offset0:24 offset1:36
    ds_read_b128 v[60:63], v8 offset:12288
    v_accvgpr_read_b32 v105, a49
    ds_read_b128 v[64:67], v8 offset:13312
    s_waitcnt lgkmcnt(5)
    buffer_store_dwordx4 v[88:91], v103, s[16:19], s85 offen offset:0 nt
    v_mul_f32 v189, v189, v49
    v_accvgpr_read_b32 v111, a55
    v_pk_mul_f32 v[246:247], v[246:247], v[50:51] op_sel_hi:[1,0]
    v_rcp_f32 v100, v100
    v_mul_f32 v176, v176, v49
    v_accvgpr_read_b32 v53, a57
    v_mul_f32 v180, v180, v49
    v_mul_f32 v204, v204, v49
    v_accvgpr_read_b32 v108, a52
    v_pk_mul_f32 v[146:147], v[146:147], v[48:49] op_sel_hi:[1,0]
    v_cvt_pk_bf16_f32 v236, v236, v237
    v_accvgpr_read_b32 v54, a58
    v_pk_mul_f32 v[52:53], v[52:53], v[100:101] op_sel_hi:[1,0]
    v_pk_mul_f32 v[156:157], v[156:157], v[48:49] op_sel_hi:[1,0]
    v_mul_f32 v203, v203, v49
    v_accvgpr_read_b32 v58, a62
    v_pk_mul_f32 v[232:233], v[232:233], v[50:51] op_sel_hi:[1,0]
    v_pk_mul_f32 v[144:145], v[144:145], v[48:49] op_sel_hi:[1,0]
    v_accvgpr_read_b32 v104, a48
    v_cvt_pk_bf16_f32 v52, v52, v53
    v_pk_mul_f32 v[104:105], v[104:105], v[100:101] op_sel_hi:[1,0]
    v_accvgpr_read_b32 v59, a63
    v_mul_f32 v178, v178, v49
    v_accvgpr_read_b32 v110, a54
    v_accvgpr_read_b32 v55, a59
    v_accvgpr_read_b32 v106, a50
    v_pk_mul_f32 v[108:109], v[108:109], v[100:101] op_sel_hi:[1,0]
    s_waitcnt lgkmcnt(0)
    buffer_store_dwordx4 v[60:63], v102, s[16:19], s86 offen offset:0 nt
    ds_read_b128 v[68:71], v8 offset:18432
    v_cvt_pk_bf16_f32 v144, v144, v145
    v_pk_mul_f32 v[130:131], v[130:131], v[48:49] op_sel_hi:[1,0]
    v_accvgpr_read_b32 v56, a60
    v_cvt_pk_bf16_f32 v104, v104, v105
    v_accvgpr_read_b32 v57, a61
    v_mul_f32 v207, v207, v49
    v_cvt_pk_bf16_f32 v108, v108, v109
    v_pk_mul_f32 v[226:227], v[226:227], v[50:51] op_sel_hi:[1,0]
    v_pk_mul_f32 v[106:107], v[106:107], v[100:101] op_sel_hi:[1,0]
    v_cvt_pk_bf16_f32 v176, v176, v177
    ds_read_b128 v[72:75], v8 offset:19456
    v_pk_mul_f32 v[136:137], v[136:137], v[48:49] op_sel_hi:[1,0]
    v_pk_mul_f32 v[110:111], v[110:111], v[100:101] op_sel_hi:[1,0]
    s_nop 0
    v_cvt_pk_bf16_f32 v109, v110, v111
    v_mul_f32 v194, v194, v49
    v_accvgpr_read_b32 v110, a22
    v_mul_f32 v187, v187, v49
    v_cvt_pk_bf16_f32 v228, v228, v229
    v_pk_mul_f32 v[54:55], v[54:55], v[100:101] op_sel_hi:[1,0]
    v_pk_mul_f32 v[58:59], v[58:59], v[100:101] op_sel_hi:[1,0]
    v_cvt_pk_bf16_f32 v105, v106, v107
    ds_write_b64 v101, v[104:105] offset:24576
    buffer_store_dwordx4 v[64:67], v103, s[16:19], s86 offen offset:0 nt
    v_pk_mul_f32 v[142:143], v[142:143], v[48:49] op_sel_hi:[1,0]
    v_accvgpr_read_b32 v107, a19
    v_cvt_pk_bf16_f32 v180, v180, v181
    v_cvt_pk_bf16_f32 v133, v134, v135
    v_pk_mul_f32 v[56:57], v[56:57], v[100:101] op_sel_hi:[1,0]
    ds_write_b64 v92, v[108:109] offset:24576
    v_pk_mul_f32 v[224:225], v[224:225], v[50:51] op_sel_hi:[1,0]
    v_accvgpr_read_b32 v106, a18
    v_cvt_pk_bf16_f32 v56, v56, v57
    v_cvt_pk_bf16_f32 v57, v58, v59
    v_cvt_pk_bf16_f32 v53, v54, v55
    v_pk_mul_f32 v[152:153], v[152:153], v[48:49] op_sel_hi:[1,0]
    v_pk_mul_f32 v[230:231], v[230:231], v[50:51] op_sel_hi:[1,0]
    v_cvt_pk_bf16_f32 v136, v136, v137
    v_accvgpr_read_b32 v104, a16
    v_accvgpr_read_b32 v59, a31
    v_pk_mul_f32 v[234:235], v[234:235], v[50:51] op_sel_hi:[1,0]
    v_accvgpr_read_b32 v111, a23
    v_mul_f32 v183, v183, v49
    v_mul_f32 v191, v191, v49
    ds_write_b64 v93, v[52:53] offset:24576
    s_waitcnt lgkmcnt(3)
    buffer_store_dwordx4 v[68:71], v102, s[16:19], s87 offen offset:0 nt
    v_cvt_pk_bf16_f32 v229, v230, v231
    v_cvt_pk_bf16_f32 v177, v178, v179
    v_mul_f32 v188, v188, v49
    v_cvt_pk_bf16_f32 v137, v138, v139
    v_accvgpr_read_b32 v109, a21
    v_mul_f32 v109, v109, v51
    ds_write_b64 v94, v[56:57] offset:24576
    v_cvt_pk_bf16_f32 v224, v224, v225
    v_cvt_pk_bf16_f32 v232, v232, v233
    v_cvt_pk_bf16_f32 v129, v130, v131
    v_accvgpr_read_b32 v108, a20
    ds_read_b128 v[76:79], v8 offset:24576
    v_cvt_pk_bf16_f32 v233, v234, v235
    v_pk_mul_f32 v[238:239], v[238:239], v[50:51] op_sel_hi:[1,0]
    v_cvt_pk_bf16_f32 v181, v182, v183
    buffer_store_dwordx4 v[72:75], v103, s[16:19], s87 offen offset:0 nt
    v_pk_mul_f32 v[150:151], v[150:151], v[48:49] op_sel_hi:[1,0]
    v_pk_mul_f32 v[248:249], v[248:249], v[50:51] op_sel_hi:[1,0]
    v_accvgpr_read_b32 v52, a24
    v_accvgpr_read_b32 v54, a26
    v_pk_mul_f32 v[250:251], v[250:251], v[50:51] op_sel_hi:[1,0]
    v_cvt_pk_bf16_f32 v188, v188, v189
    v_cvt_pk_bf16_f32 v156, v156, v157
    ds_read_b128 v[80:83], v8 offset:25600
    v_mul_f32 v111, v111, v51
    v_accvgpr_read_b32 v56, a28
    v_cvt_pk_bf16_f32 v189, v190, v191
    v_cvt_pk_bf16_f32 v184, v184, v185
    v_mul_f32 v107, v107, v51
    v_pk_mul_f32 v[242:243], v[242:243], v[50:51] op_sel_hi:[1,0]
    ds_write2st64_b64 v101, v[128:129], v[176:177] offset0:4 offset1:16
    ds_write2st64_b64 v92, v[132:133], v[180:181] offset0:4 offset1:16
    v_accvgpr_read_b32 v57, a29
    s_waitcnt lgkmcnt(3)
    buffer_store_dwordx4 v[76:79], v102, s[16:19], s88 offen offset:0 nt
    v_cvt_pk_bf16_f32 v141, v142, v143
    v_cvt_pk_bf16_f32 v185, v186, v187
    ds_write2st64_b64 v93, v[136:137], v[184:185] offset0:4 offset1:16
    v_mul_f32 v54, v54, v51
    v_accvgpr_read_b32 v105, a17
    ds_write2st64_b64 v94, v[140:141], v[188:189] offset0:4 offset1:16
    v_mul_f32 v110, v110, v51
    v_mul_f32 v52, v52, v51
    ds_read_b128 v[84:87], v8 offset:2048
    ds_read_b128 v[88:91], v8 offset:3072
    s_waitcnt lgkmcnt(5)
    buffer_store_dwordx4 v[80:83], v103, s[16:19], s88 offen offset:0 nt
    v_mul_f32 v105, v105, v51
    v_pk_mul_f32 v[158:159], v[158:159], v[48:49] op_sel_hi:[1,0]
    v_pk_mul_f32 v[244:245], v[244:245], v[50:51] op_sel_hi:[1,0]
    v_pk_mul_f32 v[254:255], v[254:255], v[50:51] op_sel_hi:[1,0]
    v_accvgpr_read_b32 v58, a30
    v_accvgpr_read_b32 v55, a27
    v_mul_f32 v199, v199, v49
    v_mul_f32 v104, v104, v51
    v_accvgpr_read_b32 v53, a25
    v_cvt_pk_bf16_f32 v225, v226, v227
    v_cvt_pk_bf16_f32 v237, v238, v239
    v_mul_f32 v202, v202, v49
    v_mul_f32 v56, v56, v51
    ds_read_b128 v[60:63], v8 offset:8192
    v_mul_f32 v59, v59, v51
    v_mul_f32 v205, v205, v49
    v_mul_f32 v55, v55, v51
    ds_read_b128 v[64:67], v8 offset:9216
    v_cvt_pk_bf16_f32 v104, v104, v105
    v_mul_f32 v192, v192, v49
    v_mul_f32 v197, v197, v49
    v_mul_f32 v198, v198, v49
    v_mul_f32 v53, v53, v51
    v_mul_f32 v106, v106, v51
    v_mul_f32 v57, v57, v51
    s_waitcnt lgkmcnt(2)
    buffer_store_dwordx4 v[84:87], v102, s[16:19], s84 offen offset:128 nt
    v_cvt_pk_bf16_f32 v105, v106, v107
    v_mul_f32 v58, v58, v51
    v_mul_f32 v201, v201, v49
    v_mul_f32 v108, v108, v51
    v_cvt_pk_bf16_f32 v56, v56, v57
    v_cvt_pk_bf16_f32 v148, v148, v149
    ds_write2st64_b64 v101, v[224:225], v[104:105] offset0:28 offset1:40
    v_accvgpr_read_b32 v104, a64
    v_pk_mul_f32 v[252:253], v[252:253], v[50:51] op_sel_hi:[1,0]
    v_cvt_pk_bf16_f32 v108, v108, v109
    v_cvt_pk_bf16_f32 v109, v110, v111
    v_cvt_pk_bf16_f32 v52, v52, v53
    v_cvt_pk_bf16_f32 v152, v152, v153
    v_cvt_pk_bf16_f32 v53, v54, v55
    buffer_store_dwordx4 v[88:91], v103, s[16:19], s84 offen offset:128 nt
    v_accvgpr_read_b32 v105, a65
    v_mul_f32 v206, v206, v49
    ds_write2st64_b64 v92, v[228:229], v[108:109] offset0:28 offset1:40
    v_accvgpr_read_b32 v106, a66
    v_cvt_pk_bf16_f32 v57, v58, v59
    v_accvgpr_read_b32 v55, a75
    ds_write2st64_b64 v93, v[232:233], v[52:53] offset0:28 offset1:40
    v_accvgpr_read_b32 v54, a74
    s_waitcnt lgkmcnt(2)
    buffer_store_dwordx4 v[60:63], v102, s[16:19], s85 offen offset:128 nt
    v_accvgpr_read_b32 v52, a72
    v_accvgpr_read_b32 v58, a78
    v_pk_mul_f32 v[104:105], v[104:105], v[100:101] op_sel_hi:[1,0]
    v_accvgpr_read_b32 v107, a67
    ds_write2st64_b64 v94, v[236:237], v[56:57] offset0:28 offset1:40
    v_accvgpr_read_b32 v111, a71
    v_cvt_pk_bf16_f32 v104, v104, v105
    v_accvgpr_read_b32 v110, a70
    v_cvt_pk_bf16_f32 v252, v252, v253
    v_accvgpr_read_b32 v109, a69
    ds_read_b128 v[68:71], v8 offset:14336
    v_pk_mul_f32 v[106:107], v[106:107], v[100:101] op_sel_hi:[1,0]
    buffer_store_dwordx4 v[64:67], v103, s[16:19], s85 offen offset:128 nt
    v_cvt_pk_bf16_f32 v105, v106, v107
    v_cvt_pk_bf16_f32 v192, v192, v193
    v_cvt_pk_bf16_f32 v244, v244, v245
    v_mul_f32 v196, v196, v49
    v_pk_mul_f32 v[54:55], v[54:55], v[100:101] op_sel_hi:[1,0]
    v_accvgpr_read_b32 v56, a76
    v_cvt_pk_bf16_f32 v196, v196, v197
    v_pk_mul_f32 v[154:155], v[154:155], v[48:49] op_sel_hi:[1,0]
    v_accvgpr_read_b32 v108, a68
    ds_read_b128 v[72:75], v8 offset:15360
    v_accvgpr_read_b32 v57, a77
    v_accvgpr_read_b32 v107, a35
    v_accvgpr_read_b32 v59, a79
    v_accvgpr_read_b32 v53, a73
    v_pk_mul_f32 v[108:109], v[108:109], v[100:101] op_sel_hi:[1,0]
    ds_read_b128 v[76:79], v8 offset:20480
    v_cvt_pk_bf16_f32 v200, v200, v201
    v_cvt_pk_bf16_f32 v204, v204, v205
    v_cvt_pk_bf16_f32 v108, v108, v109
    v_cvt_pk_bf16_f32 v245, v246, v247
    v_pk_mul_f32 v[56:57], v[56:57], v[100:101] op_sel_hi:[1,0]
    v_cvt_pk_bf16_f32 v153, v154, v155
    s_waitcnt lgkmcnt(2)
    buffer_store_dwordx4 v[68:71], v102, s[16:19], s86 offen offset:128 nt
    v_pk_mul_f32 v[110:111], v[110:111], v[100:101] op_sel_hi:[1,0]
    v_pk_mul_f32 v[52:53], v[52:53], v[100:101] op_sel_hi:[1,0]
    v_cvt_pk_bf16_f32 v157, v158, v159
    v_cvt_pk_bf16_f32 v56, v56, v57
    v_pk_mul_f32 v[240:241], v[240:241], v[50:51] op_sel_hi:[1,0]
    v_pk_mul_f32 v[58:59], v[58:59], v[100:101] op_sel_hi:[1,0]
    s_waitcnt lgkmcnt(1)
    buffer_store_dwordx4 v[72:75], v103, s[16:19], s86 offen offset:128 nt
    ds_read_b128 v[80:83], v8 offset:21504
    ds_write_b64 v101, v[104:105] offset:26624
    v_cvt_pk_bf16_f32 v109, v110, v111
    ds_write_b64 v92, v[108:109] offset:26624
    v_cvt_pk_bf16_f32 v57, v58, v59
    v_cvt_pk_bf16_f32 v52, v52, v53
    v_cvt_pk_bf16_f32 v240, v240, v241
    v_cvt_pk_bf16_f32 v53, v54, v55
    v_accvgpr_read_b32 v108, a36
    v_accvgpr_read_b32 v111, a39
    v_cvt_pk_bf16_f32 v248, v248, v249
    v_accvgpr_read_b32 v54, a42
    v_cvt_pk_bf16_f32 v145, v146, v147
    ds_write_b64 v93, v[52:53] offset:26624
    v_cvt_pk_bf16_f32 v149, v150, v151
    v_accvgpr_read_b32 v109, a37
    v_mul_f32 v111, v111, v51
    s_waitcnt lgkmcnt(4)
    buffer_store_dwordx4 v[76:79], v102, s[16:19], s87 offen offset:128 nt
    v_mul_f32 v54, v54, v51
    v_mul_f32 v109, v109, v51
    v_accvgpr_read_b32 v104, a32
    v_mul_f32 v104, v104, v51
    ds_write_b64 v94, v[56:57] offset:26624
    v_accvgpr_read_b32 v58, a46
    v_accvgpr_read_b32 v56, a44
    v_cvt_pk_bf16_f32 v241, v242, v243
    v_accvgpr_read_b32 v55, a43
    v_accvgpr_read_b32 v53, a41
    v_accvgpr_read_b32 v110, a38
    v_mul_f32 v195, v195, v49
    v_mul_f32 v108, v108, v51
    v_accvgpr_read_b32 v105, a33
    v_cvt_pk_bf16_f32 v205, v206, v207
    v_accvgpr_read_b32 v59, a47
    v_mul_f32 v105, v105, v51
    v_cvt_pk_bf16_f32 v201, v202, v203
    v_mul_f32 v56, v56, v51
    ds_read_b128 v[84:87], v8 offset:26624
    v_mul_f32 v59, v59, v51
    v_mul_f32 v107, v107, v51
    s_waitcnt lgkmcnt(2)
    buffer_store_dwordx4 v[80:83], v103, s[16:19], s87 offen offset:128 nt
    v_cvt_pk_bf16_f32 v197, v198, v199
    v_mul_f32 v53, v53, v51
    ds_read_b128 v[88:91], v8 offset:27648
    v_cvt_pk_bf16_f32 v108, v108, v109
    v_mul_f32 v110, v110, v51
    v_accvgpr_read_b32 v106, a34
    v_accvgpr_read_b32 v52, a40
    v_cvt_pk_bf16_f32 v193, v194, v195
    v_mul_f32 v58, v58, v51
    ds_write2st64_b64 v101, v[144:145], v[192:193] offset0:8 offset1:20
    ds_write2st64_b64 v92, v[148:149], v[196:197] offset0:8 offset1:20
    v_accvgpr_read_b32 v57, a45
    v_mul_f32 v106, v106, v51
    v_cvt_pk_bf16_f32 v249, v250, v251
    v_cvt_pk_bf16_f32 v104, v104, v105
    v_mul_f32 v52, v52, v51
    v_mul_f32 v57, v57, v51
    s_waitcnt lgkmcnt(3)
    buffer_store_dwordx4 v[84:87], v102, s[16:19], s88 offen offset:128 nt
    ds_write2st64_b64 v93, v[152:153], v[200:201] offset0:8 offset1:20
    ds_write2st64_b64 v94, v[156:157], v[204:205] offset0:8 offset1:20
    v_cvt_pk_bf16_f32 v56, v56, v57
    ds_read_b128 v[60:63], v8 offset:4096
    ds_read_b128 v[64:67], v8 offset:5120
    s_waitcnt lgkmcnt(6)
    buffer_store_dwordx4 v[88:91], v103, s[16:19], s88 offen offset:128 nt
    v_cvt_pk_bf16_f32 v109, v110, v111
    v_cvt_pk_bf16_f32 v57, v58, v59
    ds_read_b128 v[68:71], v8 offset:10240
    ds_read_b128 v[72:75], v8 offset:11264
    v_cvt_pk_bf16_f32 v52, v52, v53
    s_waitcnt lgkmcnt(3)
    buffer_store_dwordx4 v[60:63], v102, s[16:19], s84 offen offset:256 nt
    v_cvt_pk_bf16_f32 v105, v106, v107
    v_mul_f32 v55, v55, v51
    v_cvt_pk_bf16_f32 v53, v54, v55
    v_accvgpr_read_b32 v59, a95
    ds_write2st64_b64 v101, v[240:241], v[104:105] offset0:32 offset1:44
    ds_write2st64_b64 v92, v[244:245], v[108:109] offset0:32 offset1:44
    v_cvt_pk_bf16_f32 v253, v254, v255
    v_accvgpr_read_b32 v106, a82
    ds_write2st64_b64 v93, v[248:249], v[52:53] offset0:32 offset1:44
    s_waitcnt lgkmcnt(3)
    buffer_store_dwordx4 v[64:67], v103, s[16:19], s84 offen offset:256 nt
    v_accvgpr_read_b32 v110, a86
    v_accvgpr_read_b32 v107, a83
    v_accvgpr_read_b32 v55, a91
    ds_write2st64_b64 v94, v[252:253], v[56:57] offset0:32 offset1:44
    v_pk_mul_f32 v[106:107], v[106:107], v[100:101] op_sel_hi:[1,0]
    v_accvgpr_read_b32 v53, a89
    ds_read_b128 v[76:79], v8 offset:16384
    v_accvgpr_read_b32 v58, a94
    v_accvgpr_read_b32 v109, a85
    v_accvgpr_read_b32 v104, a80
    buffer_store_dwordx4 v[68:71], v102, s[16:19], s85 offen offset:256 nt
    v_accvgpr_read_b32 v105, a81
    v_accvgpr_read_b32 v111, a87
    ds_read_b128 v[80:83], v8 offset:17408
    buffer_store_dwordx4 v[72:75], v103, s[16:19], s85 offen offset:256 nt
    v_accvgpr_read_b32 v108, a84
    v_accvgpr_read_b32 v56, a92
    v_accvgpr_read_b32 v52, a88
    v_accvgpr_read_b32 v54, a90
    v_accvgpr_read_b32 v57, a93
    v_pk_mul_f32 v[110:111], v[110:111], v[100:101] op_sel_hi:[1,0]
    ds_read_b128 v[84:87], v8 offset:22528
    ds_read_b128 v[88:91], v8 offset:23552
    v_pk_mul_f32 v[52:53], v[52:53], v[100:101] op_sel_hi:[1,0]
    v_pk_mul_f32 v[104:105], v[104:105], v[100:101] op_sel_hi:[1,0]
    v_pk_mul_f32 v[54:55], v[54:55], v[100:101] op_sel_hi:[1,0]
    v_cvt_pk_bf16_f32 v52, v52, v53
    v_pk_mul_f32 v[108:109], v[108:109], v[100:101] op_sel_hi:[1,0]
    s_nop 0
    v_cvt_pk_bf16_f32 v108, v108, v109
    v_cvt_pk_bf16_f32 v104, v104, v105
    v_cvt_pk_bf16_f32 v105, v106, v107
    v_pk_mul_f32 v[56:57], v[56:57], v[100:101] op_sel_hi:[1,0]
    s_waitcnt lgkmcnt(2)
    buffer_store_dwordx4 v[76:79], v102, s[16:19], s86 offen offset:256 nt
    v_cvt_pk_bf16_f32 v56, v56, v57
    v_pk_mul_f32 v[58:59], v[58:59], v[100:101] op_sel_hi:[1,0]
    v_cvt_pk_bf16_f32 v109, v110, v111
    buffer_store_dwordx4 v[80:83], v103, s[16:19], s86 offen offset:256 nt
    s_waitcnt lgkmcnt(0)
    buffer_store_dwordx4 v[84:87], v102, s[16:19], s87 offen offset:256 nt
    v_cvt_pk_bf16_f32 v53, v54, v55
    ds_write_b64 v101, v[104:105] offset:0
    ds_write_b64 v92, v[108:109] offset:0
    ds_write_b64 v93, v[52:53] offset:0
    v_cvt_pk_bf16_f32 v57, v58, v59
    ds_write_b64 v94, v[56:57] offset:0
    ds_read_b128 v[60:63], v8 offset:0
    buffer_store_dwordx4 v[88:91], v103, s[16:19], s87 offen offset:256 nt
    ds_read_b128 v[64:67], v8 offset:1024
    s_waitcnt lgkmcnt(1)
    buffer_store_dwordx4 v[60:63], v102, s[16:19], s88 offen offset:256 nt
    s_waitcnt lgkmcnt(0)
    buffer_store_dwordx4 v[64:67], v103, s[16:19], s88 offen offset:256 nt
    s_branch L_fin
L_end4:
    s_waitcnt lgkmcnt(6)
    v_mfma_f32_16x16x32_bf16 v[112:115], a[212:215], v[16:19], v[112:115]
    v_fma_f32 v70, v70, s28, v11
    v_fma_f32 v73, v73, s28, v11
    v_mfma_f32_16x16x32_bf16 v[160:163], a[212:215], v[22:25], v[160:163]
    v_fma_f32 v62, v62, s28, v10
    v_fma_f32 v83, v83, s28, v12
    v_mfma_f32_16x16x32_bf16 v[208:211], a[212:215], v[28:31], v[208:211]
    ds_read_b64_tr_b16 a[228:229], v2 offset:19456
    v_fma_f32 v69, v69, s28, v11
    v_mfma_f32_16x16x32_bf16 a[0:3], a[212:215], v[34:37], a[0:3]
    ds_read_b64_tr_b16 a[230:231], v2 offset:13312
    s_waitcnt lgkmcnt(6)
    v_mfma_f32_16x16x32_bf16 v[116:119], a[216:219], v[16:19], v[116:119]
    v_exp_f32 v62, v62
    v_mfma_f32_16x16x32_bf16 v[164:167], a[216:219], v[22:25], v[164:167]
    ds_read_b64_tr_b16 a[234:235], v3 offset:13312
    v_fma_f32 v63, v63, s28, v10
    v_mfma_f32_16x16x32_bf16 v[212:215], a[216:219], v[28:31], v[212:215]
    ds_read_b64_tr_b16 a[214:215], v4 offset:13312
    v_fma_f32 v78, v78, s28, v12
    v_mfma_f32_16x16x32_bf16 a[4:7], a[216:219], v[34:37], a[4:7]
    ds_read_b64_tr_b16 a[218:219], v5 offset:13312
    s_waitcnt lgkmcnt(7)
    v_mfma_f32_16x16x32_bf16 v[120:123], a[220:223], v[16:19], v[120:123]
    ds_read_b64_tr_b16 a[232:233], v3 offset:19456
    v_fma_f32 v74, v74, s28, v11
    v_mfma_f32_16x16x32_bf16 v[168:171], a[220:223], v[22:25], v[168:171]
    v_fma_f32 v76, v76, s28, v12
    v_fma_f32 v77, v77, s28, v12
    v_mfma_f32_16x16x32_bf16 v[216:219], a[220:223], v[28:31], v[216:219]
    ds_read_b64_tr_b16 a[216:217], v5 offset:19456
    v_fma_f32 v59, v59, s28, v9
    v_mfma_f32_16x16x32_bf16 a[8:11], a[220:223], v[34:37], a[8:11]
    s_waitcnt lgkmcnt(7)
    ds_read_b128 v[88:91], v8 offset:4096
    v_fma_f32 v72, v72, s28, v11
    v_mfma_f32_16x16x32_bf16 v[124:127], a[224:227], v[16:19], v[124:127]
    ds_read_b64_tr_b16 a[212:213], v4 offset:19456
    v_fma_f32 v66, v66, s28, v10
    v_mfma_f32_16x16x32_bf16 v[172:175], a[224:227], v[22:25], v[172:175]
    ds_read_b64_tr_b16 a[220:221], v2 offset:20480
    v_fma_f32 v68, v68, s28, v11
    v_mfma_f32_16x16x32_bf16 v[220:223], a[224:227], v[28:31], v[220:223]
    ds_read_b64_tr_b16 a[222:223], v2 offset:14336
    v_mfma_f32_16x16x32_bf16 a[12:15], a[224:227], v[34:37], a[12:15]
    s_waitcnt lgkmcnt(8)
    v_exp_f32 v70, v70
    v_mfma_f32_16x16x32_bf16 v[128:131], a[228:231], v[16:19], v[128:131]
    v_fma_f32 v67, v67, s28, v10
    v_fma_f32 v64, v64, s28, v10
    v_mfma_f32_16x16x32_bf16 v[176:179], a[228:231], v[22:25], v[176:179]
    ds_read_b64_tr_b16 a[226:227], v3 offset:14336
    v_fma_f32 v82, v82, s28, v12
    v_mfma_f32_16x16x32_bf16 v[224:227], a[228:231], v[28:31], v[224:227]
    v_exp_f32 v63, v63
    v_mfma_f32_16x16x32_bf16 a[16:19], a[228:231], v[34:37], a[16:19]
    s_waitcnt lgkmcnt(6)
    ds_read_b128 v[96:99], v8 offset:2048
    v_fma_f32 v71, v71, s28, v11
    v_mfma_f32_16x16x32_bf16 v[132:135], a[232:235], v[16:19], v[132:135]
    ds_read_b64_tr_b16 a[224:225], v3 offset:20480
    v_mfma_f32_16x16x32_bf16 v[180:183], a[232:235], v[22:25], v[180:183]
    ds_read_b64_tr_b16 a[230:231], v4 offset:14336
    v_cvt_pk_bf16_f32 v21, v62, v63
    v_mfma_f32_16x16x32_bf16 v[228:231], a[232:235], v[28:31], v[228:231]
    ds_read_b64_tr_b16 a[228:229], v4 offset:20480
    v_fma_f32 v79, v79, s28, v12
    v_mfma_f32_16x16x32_bf16 a[20:23], a[232:235], v[34:37], a[20:23]
    s_waitcnt lgkmcnt(6)
    ds_read_b64_tr_b16 a[234:235], v5 offset:14336
    v_mfma_f32_16x16x32_bf16 v[136:139], a[212:215], v[16:19], v[136:139]
    ds_read_b64_tr_b16 a[232:233], v5 offset:20480
    v_fma_f32 v80, v80, s28, v12
    v_mfma_f32_16x16x32_bf16 v[184:187], a[212:215], v[22:25], v[184:187]
    v_fma_f32 v58, v58, s28, v9
    v_fma_f32 v57, v57, s28, v9
    v_mfma_f32_16x16x32_bf16 v[232:235], a[212:215], v[28:31], v[232:235]
    v_exp_f32 v78, v78
    v_mfma_f32_16x16x32_bf16 a[24:27], a[212:215], v[34:37], a[24:27]
    v_exp_f32 v79, v79
    v_mfma_f32_16x16x32_bf16 v[140:143], a[216:219], v[16:19], v[140:143]
    v_fma_f32 v75, v75, s28, v11
    s_add_u32 s39, s39, 12288
    v_mfma_f32_16x16x32_bf16 v[188:191], a[216:219], v[22:25], v[188:191]
    v_exp_f32 v77, v77
    v_mfma_f32_16x16x32_bf16 v[236:239], a[216:219], v[28:31], v[236:239]
    v_exp_f32 v71, v71
    v_mfma_f32_16x16x32_bf16 a[28:31], a[216:219], v[34:37], a[28:31]
    s_waitcnt lgkmcnt(3)
    v_exp_f32 v64, v64
    v_mfma_f32_16x16x32_bf16 v[144:147], a[220:223], v[16:19], v[144:147]
    v_exp_f32 v69, v69
    v_mfma_f32_16x16x32_bf16 v[192:195], a[220:223], v[22:25], v[192:195]
    v_fma_f32 v56, v56, s28, v9
    s_waitcnt vmcnt(10) lgkmcnt(0)
    v_mfma_f32_16x16x32_bf16 v[240:243], a[220:223], v[28:31], v[240:243]
    s_barrier
    v_mfma_f32_16x16x32_bf16 a[32:35], a[220:223], v[34:37], a[32:35]
    ds_read_b128 a[212:215], v0 offset:12288
    v_mfma_f32_16x16x32_bf16 v[148:151], a[224:227], v[16:19], v[148:151]
    s_add_u32 m0, s22, 36864
    ds_read_b128 a[220:223], v0 offset:13312
    v_mfma_f32_16x16x32_bf16 v[196:199], a[224:227], v[22:25], v[196:199]
    v_exp_f32 v68, v68
    v_mfma_f32_16x16x32_bf16 v[244:247], a[224:227], v[28:31], v[244:247]
    ds_read_b128 a[216:219], v1 offset:12288
    v_fma_f32 v81, v81, s28, v12
    v_mfma_f32_16x16x32_bf16 a[36:39], a[224:227], v[34:37], a[36:39]
    buffer_load_dwordx4 v6, s[8:11], s21 offen lds
    v_mfma_f32_16x16x32_bf16 v[152:155], a[228:231], v[16:19], v[152:155]
    s_add_u32 s21, s21, 128
    v_exp_f32 v76, v76
    v_mfma_f32_16x16x32_bf16 v[200:203], a[228:231], v[22:25], v[200:203]
    s_add_u32 m0, s22, 37888
    v_exp_f32 v81, v81
    v_mfma_f32_16x16x32_bf16 v[248:251], a[228:231], v[28:31], v[248:251]
    buffer_load_dwordx4 v6, s[8:11], s21 offen lds
    v_mfma_f32_16x16x32_bf16 a[40:43], a[228:231], v[34:37], a[40:43]
    s_add_u32 s21, s21, 128
    ds_read_b128 a[228:231], v0 offset:14336
    v_cvt_pk_bf16_f32 v32, v76, v77
    v_mfma_f32_16x16x32_bf16 v[156:159], a[232:235], v[16:19], v[156:159]
    s_add_u32 m0, s22, 38912
    v_exp_f32 v59, v59
    v_mfma_f32_16x16x32_bf16 v[204:207], a[232:235], v[22:25], v[204:207]
    buffer_load_dwordx4 v6, s[8:11], s21 offen lds
    v_mfma_f32_16x16x32_bf16 v[252:255], a[232:235], v[28:31], v[252:255]
    s_add_u32 s21, s21, 12032
    v_exp_f32 v73, v73
    v_mfma_f32_16x16x32_bf16 a[44:47], a[232:235], v[34:37], a[44:47]
    s_waitcnt lgkmcnt(2)
    ds_read_b128 v[84:87], v8 offset:3072
    v_fma_f32 v65, v65, s28, v10
    v_mfma_f32_16x16x32_bf16 v[52:55], a[212:215], a[96:99], 0
    s_waitcnt lgkmcnt(2)
    v_exp_f32 v74, v74
    v_mfma_f32_16x16x32_bf16 v[52:55], a[216:219], a[100:103], v[52:55]
    v_cvt_pk_bf16_f32 v26, v68, v69
    s_add_u32 s56, s24, 5888
    v_mfma_f32_16x16x32_bf16 v[52:55], a[220:223], a[104:107], v[52:55]
    ds_read_b128 a[232:235], v1 offset:14336
    v_cvt_pk_bf16_f32 v33, v78, v79
    v_mfma_f32_16x16x32_bf16 v[60:63], a[212:215], a[120:123], 0
    ds_read_b128 a[224:227], v1 offset:13312
    v_cvt_pk_bf16_f32 v27, v70, v71
    v_mfma_f32_16x16x32_bf16 v[60:63], a[216:219], a[124:127], v[60:63]
    v_exp_f32 v83, v83
    v_mfma_f32_16x16x32_bf16 v[60:63], a[220:223], a[128:131], v[60:63]
    v_exp_f32 v75, v75
    v_mfma_f32_16x16x32_bf16 v[68:71], a[212:215], a[144:147], 0
    v_mfma_f32_16x16x32_bf16 v[68:71], a[216:219], a[148:151], v[68:71]
    v_exp_f32 v72, v72
    v_mfma_f32_16x16x32_bf16 v[68:71], a[220:223], a[152:155], v[68:71]
    v_exp_f32 v82, v82
    v_mfma_f32_16x16x32_bf16 v[76:79], a[212:215], a[168:171], 0
    v_exp_f32 v57, v57
    v_mfma_f32_16x16x32_bf16 v[76:79], a[216:219], a[172:175], v[76:79]
    v_exp_f32 v80, v80
    v_mfma_f32_16x16x32_bf16 v[76:79], a[220:223], a[176:179], v[76:79]
    buffer_store_dwordx4 v[96:99], v102, s[16:19], s56 offen offset:0 nt
    v_exp_f32 v65, v65
    s_waitcnt lgkmcnt(0)
    v_mfma_f32_16x16x32_bf16 v[52:55], a[224:227], a[108:111], v[52:55]
    v_exp_f32 v67, v67
    v_mfma_f32_16x16x32_bf16 v[52:55], a[228:231], a[112:115], v[52:55]
    v_exp_f32 v56, v56
    v_mfma_f32_16x16x32_bf16 v[52:55], a[232:235], a[116:119], v[52:55]
    ds_read_b128 a[212:215], v0 offset:18432
    v_mfma_f32_16x16x32_bf16 v[60:63], a[224:227], a[132:135], v[60:63]
    v_cvt_pk_bf16_f32 v16, v56, v57
    v_cvt_pk_bf16_f32 v22, v64, v65
    v_mfma_f32_16x16x32_bf16 v[60:63], a[228:231], a[136:139], v[60:63]
    ds_read_b128 a[216:219], v1 offset:18432
    v_cvt_pk_bf16_f32 v29, v74, v75
    v_mfma_f32_16x16x32_bf16 v[60:63], a[232:235], a[140:143], v[60:63]
    v_exp_f32 v58, v58
    v_mfma_f32_16x16x32_bf16 v[68:71], a[224:227], a[156:159], v[68:71]
    v_exp_f32 v66, v66
    v_mfma_f32_16x16x32_bf16 v[68:71], a[228:231], a[160:163], v[68:71]
    ds_read_b128 a[220:223], v0 offset:19456
    v_cvt_pk_bf16_f32 v23, v66, v67
    v_mfma_f32_16x16x32_bf16 v[68:71], a[232:235], a[164:167], v[68:71]
    ds_read_b128 v[96:99], v8 offset:5120
    v_mfma_f32_16x16x32_bf16 v[76:79], a[224:227], a[180:183], v[76:79]
    v_cvt_pk_bf16_f32 v34, v80, v81
    v_cvt_pk_bf16_f32 v17, v58, v59
    v_mfma_f32_16x16x32_bf16 v[76:79], a[228:231], a[184:187], v[76:79]
    ds_read_b128 a[228:231], v0 offset:20480
    v_mfma_f32_16x16x32_bf16 v[44:47], a[236:239], v[14:17], v[48:51]
    ds_read_b128 a[224:227], v1 offset:19456
    v_mfma_f32_16x16x32_bf16 v[76:79], a[232:235], a[188:191], v[76:79]
    ds_read_b128 a[232:235], v1 offset:20480
    v_cvt_pk_bf16_f32 v28, v72, v73
    v_mfma_f32_16x16x32_bf16 v[44:47], a[240:243], v[20:23], v[44:47]
    v_cvt_pk_bf16_f32 v35, v82, v83
    v_mfma_f32_16x16x32_bf16 v[44:47], a[244:247], v[26:29], v[44:47]
    buffer_store_dwordx4 v[84:87], v103, s[16:19], s56 offen offset:0 nt
    s_waitcnt lgkmcnt(5)
    v_mfma_f32_16x16x32_bf16 v[56:59], a[212:215], a[96:99], 0
    v_mfma_f32_16x16x32_bf16 v[56:59], a[216:219], a[100:103], v[56:59]
    s_waitcnt lgkmcnt(4)
    v_mfma_f32_16x16x32_bf16 v[56:59], a[220:223], a[104:107], v[56:59]
    v_mfma_f32_16x16x32_bf16 v[44:47], a[248:251], v[32:35], v[44:47]
    s_add_u32 s57, s24, 6016
    ds_read_b128 v[84:87], v8 offset:0
    v_mfma_f32_16x16x32_bf16 v[64:67], a[212:215], a[120:123], 0
    buffer_store_dwordx4 v[88:91], v102, s[16:19], s57 offen offset:0 nt
    s_nop 3
    v_cmp_lt_f32 vcc, s29, v44
    v_mfma_f32_16x16x32_bf16 v[64:67], a[216:219], a[124:127], v[64:67]
    s_waitcnt vmcnt(10) lgkmcnt(1)
    v_mfma_f32_16x16x32_bf16 v[64:67], a[220:223], a[128:131], v[64:67]
    s_barrier
    v_mfma_f32_16x16x32_bf16 v[72:75], a[212:215], a[144:147], 0
    s_cbranch_vccnz L_rs_end4a
L_ret_end4a:
    v_mfma_f32_16x16x32_bf16 v[72:75], a[216:219], a[148:151], v[72:75]
    v_mfma_f32_16x16x32_bf16 v[72:75], a[220:223], a[152:155], v[72:75]
    ds_read_b128 v[88:91], v8 offset:1024
    v_fma_f32 v53, v53, s28, v9
    v_mfma_f32_16x16x32_bf16 v[80:83], a[212:215], a[168:171], 0
    ds_read_b64_tr_b16 a[212:213], v2 offset:0
    v_fma_f32 v60, v60, s28, v10
    v_mfma_f32_16x16x32_bf16 v[80:83], a[216:219], a[172:175], v[80:83]
    ds_read_b64_tr_b16 a[214:215], v2 offset:6144
    v_mfma_f32_16x16x32_bf16 v[80:83], a[220:223], a[176:179], v[80:83]
    v_fma_f32 v52, v52, s28, v9
    v_mfma_f32_16x16x32_bf16 v[56:59], a[224:227], a[108:111], v[56:59]
    ds_read_b64_tr_b16 a[216:217], v3 offset:0
    v_fma_f32 v54, v54, s28, v9
    v_mfma_f32_16x16x32_bf16 v[56:59], a[228:231], a[112:115], v[56:59]
    ds_read_b64_tr_b16 a[218:219], v3 offset:6144
    v_fma_f32 v61, v61, s28, v10
    v_mfma_f32_16x16x32_bf16 v[56:59], a[232:235], a[116:119], v[56:59]
    v_exp_f32 v52, v52
    v_mfma_f32_16x16x32_bf16 v[64:67], a[224:227], a[132:135], v[64:67]
    v_exp_f32 v53, v53
    v_mfma_f32_16x16x32_bf16 v[64:67], a[228:231], a[136:139], v[64:67]
    buffer_store_dwordx4 v[96:99], v103, s[16:19], s57 offen offset:0 nt
    ds_read_b64_tr_b16 a[220:221], v4 offset:0
    v_exp_f32 v61, v61
    v_mfma_f32_16x16x32_bf16 v[64:67], a[232:235], a[140:143], v[64:67]
    v_mfma_f32_16x16x32_bf16 v[72:75], a[224:227], a[156:159], v[72:75]
    s_waitcnt lgkmcnt(4)
    buffer_store_dwordx4 v[84:87], v102, s[16:19], s24 offen offset:0 nt
    v_fma_f32 v55, v55, s28, v9
    v_exp_f32 v55, v55
    v_mfma_f32_16x16x32_bf16 v[72:75], a[228:231], a[160:163], v[72:75]
    v_exp_f32 v60, v60
    v_mfma_f32_16x16x32_bf16 v[72:75], a[232:235], a[164:167], v[72:75]
    buffer_store_dwordx4 v[88:91], v103, s[16:19], s24 offen offset:0 nt
    v_cvt_pk_bf16_f32 v18, v52, v53
    v_exp_f32 v54, v54
    v_mfma_f32_16x16x32_bf16 v[80:83], a[224:227], a[180:183], v[80:83]
    ds_read_b64_tr_b16 a[222:223], v4 offset:6144
    v_cvt_pk_bf16_f32 v24, v60, v61
    v_mfma_f32_16x16x32_bf16 v[80:83], a[228:231], a[184:187], v[80:83]
    ds_read_b64_tr_b16 a[224:225], v5 offset:0
    v_cvt_pk_bf16_f32 v19, v54, v55
    v_mfma_f32_16x16x32_bf16 v[80:83], a[232:235], a[188:191], v[80:83]
    ds_read_b64_tr_b16 a[226:227], v5 offset:6144
    v_fma_f32 v69, v69, s28, v11
    s_waitcnt lgkmcnt(6)
    v_mfma_f32_16x16x32_bf16 v[112:115], a[212:215], v[14:17], v[112:115]
    s_add_u32 s39, s39, 12288
    ds_read_b64_tr_b16 a[228:229], v2 offset:1024
    v_fma_f32 v72, v72, s28, v11
    v_mfma_f32_16x16x32_bf16 v[160:163], a[212:215], v[20:23], v[160:163]
    s_waitcnt vmcnt(6)
    ds_read_b64_tr_b16 a[234:235], v3 offset:7168
    v_fma_f32 v68, v68, s28, v11
    v_mfma_f32_16x16x32_bf16 v[208:211], a[212:215], v[26:29], v[208:211]
    s_barrier
    ds_read_b64_tr_b16 a[232:233], v3 offset:1024
    v_fma_f32 v74, v74, s28, v11
    v_fma_f32 v65, v65, s28, v10
    v_fma_f32 v70, v70, s28, v11
    v_mfma_f32_16x16x32_bf16 a[0:3], a[212:215], v[32:35], a[0:3]
    s_waitcnt lgkmcnt(7)
    ds_read_b64_tr_b16 a[230:231], v2 offset:7168
    v_fma_f32 v78, v78, s28, v12
    v_mfma_f32_16x16x32_bf16 v[116:119], a[216:219], v[14:17], v[116:119]
    v_fma_f32 v76, v76, s28, v12
    v_fma_f32 v67, v67, s28, v10
    v_mfma_f32_16x16x32_bf16 v[164:167], a[216:219], v[20:23], v[164:167]
    ds_read_b64_tr_b16 a[212:213], v4 offset:1024
    v_fma_f32 v66, v66, s28, v10
    v_mfma_f32_16x16x32_bf16 v[212:215], a[216:219], v[26:29], v[212:215]
    v_fma_f32 v75, v75, s28, v11
    v_fma_f32 v71, v71, s28, v11
    v_mfma_f32_16x16x32_bf16 a[4:7], a[216:219], v[32:35], a[4:7]
    s_waitcnt lgkmcnt(7)
    ds_read_b64_tr_b16 a[214:215], v4 offset:7168
    v_fma_f32 v59, v59, s28, v9
    v_mfma_f32_16x16x32_bf16 v[120:123], a[220:223], v[14:17], v[120:123]
    v_fma_f32 v58, v58, s28, v9
    v_fma_f32 v62, v62, s28, v10
    v_mfma_f32_16x16x32_bf16 v[168:171], a[220:223], v[20:23], v[168:171]
    v_exp_f32 v74, v74
    v_mfma_f32_16x16x32_bf16 v[216:219], a[220:223], v[26:29], v[216:219]
    v_exp_f32 v68, v68
    v_mfma_f32_16x16x32_bf16 a[8:11], a[220:223], v[32:35], a[8:11]
    s_waitcnt lgkmcnt(4)
    v_exp_f32 v65, v65
    v_mfma_f32_16x16x32_bf16 v[124:127], a[224:227], v[14:17], v[124:127]
    ds_read_b64_tr_b16 a[216:217], v5 offset:1024
    v_fma_f32 v63, v63, s28, v10
    v_fma_f32 v73, v73, s28, v11
    v_fma_f32 v56, v56, s28, v9
    v_mfma_f32_16x16x32_bf16 v[172:175], a[224:227], v[20:23], v[172:175]
    v_exp_f32 v72, v72
    v_mfma_f32_16x16x32_bf16 v[220:223], a[224:227], v[26:29], v[220:223]
    ds_read_b64_tr_b16 a[218:219], v5 offset:7168
    v_exp_f32 v69, v69
    v_mfma_f32_16x16x32_bf16 a[12:15], a[224:227], v[32:35], a[12:15]
    s_waitcnt lgkmcnt(3)
    ds_read_b64_tr_b16 a[220:221], v2 offset:2048
    v_fma_f32 v64, v64, s28, v10
    v_mfma_f32_16x16x32_bf16 v[128:131], a[228:231], v[14:17], v[128:131]
    ds_read_b64_tr_b16 a[222:223], v2 offset:8192
    v_fma_f32 v79, v79, s28, v12
    v_mfma_f32_16x16x32_bf16 v[176:179], a[228:231], v[20:23], v[176:179]
    v_exp_f32 v70, v70
    v_mfma_f32_16x16x32_bf16 v[224:227], a[228:231], v[26:29], v[224:227]
    ds_read_b64_tr_b16 a[224:225], v3 offset:2048
    v_fma_f32 v57, v57, s28, v9
    v_mfma_f32_16x16x32_bf16 a[16:19], a[228:231], v[32:35], a[16:19]
    v_fma_f32 v81, v81, s28, v12
    v_fma_f32 v82, v82, s28, v12
    v_mfma_f32_16x16x32_bf16 v[132:135], a[232:235], v[14:17], v[132:135]
    ds_read_b64_tr_b16 a[226:227], v3 offset:8192
    v_fma_f32 v83, v83, s28, v12
    v_mfma_f32_16x16x32_bf16 v[180:183], a[232:235], v[20:23], v[180:183]
    v_exp_f32 v71, v71
    v_mfma_f32_16x16x32_bf16 v[228:231], a[232:235], v[26:29], v[228:231]
    v_exp_f32 v62, v62
    v_mfma_f32_16x16x32_bf16 a[20:23], a[232:235], v[32:35], a[20:23]
    s_waitcnt lgkmcnt(5)
    v_exp_f32 v83, v83
    v_mfma_f32_16x16x32_bf16 v[136:139], a[212:215], v[14:17], v[136:139]
    v_exp_f32 v75, v75
    v_mfma_f32_16x16x32_bf16 v[184:187], a[212:215], v[20:23], v[184:187]
    v_exp_f32 v63, v63
    v_mfma_f32_16x16x32_bf16 v[232:235], a[212:215], v[26:29], v[232:235]
    v_exp_f32 v79, v79
    v_mfma_f32_16x16x32_bf16 a[24:27], a[212:215], v[32:35], a[24:27]
    s_waitcnt lgkmcnt(2)
    ds_read_b64_tr_b16 a[228:229], v4 offset:2048
    v_exp_f32 v66, v66
    v_mfma_f32_16x16x32_bf16 v[140:143], a[216:219], v[14:17], v[140:143]
    v_exp_f32 v59, v59
    v_mfma_f32_16x16x32_bf16 v[188:191], a[216:219], v[20:23], v[188:191]
    ds_read_b64_tr_b16 a[230:231], v4 offset:8192
    v_fma_f32 v80, v80, s28, v12
    v_mfma_f32_16x16x32_bf16 v[236:239], a[216:219], v[26:29], v[236:239]
    ds_read_b64_tr_b16 a[212:213], v2 offset:18432
    v_exp_f32 v56, v56
    v_mfma_f32_16x16x32_bf16 a[28:31], a[216:219], v[32:35], a[28:31]
    v_exp_f32 v73, v73
    v_mfma_f32_16x16x32_bf16 v[144:147], a[220:223], v[14:17], v[144:147]
    v_exp_f32 v78, v78
    v_mfma_f32_16x16x32_bf16 v[192:195], a[220:223], v[20:23], v[192:195]
    ds_read_b64_tr_b16 a[232:233], v5 offset:2048
    v_exp_f32 v58, v58
    v_mfma_f32_16x16x32_bf16 v[240:243], a[220:223], v[26:29], v[240:243]
    ds_read_b64_tr_b16 a[234:235], v5 offset:8192
    v_exp_f32 v57, v57
    v_mfma_f32_16x16x32_bf16 a[32:35], a[220:223], v[32:35], a[32:35]
    s_waitcnt lgkmcnt(5)
    ds_read_b64_tr_b16 a[214:215], v2 offset:12288
    v_exp_f32 v76, v76
    v_mfma_f32_16x16x32_bf16 v[148:151], a[224:227], v[14:17], v[148:151]
    v_exp_f32 v82, v82
    v_mfma_f32_16x16x32_bf16 v[196:199], a[224:227], v[20:23], v[196:199]
    v_exp_f32 v67, v67
    v_mfma_f32_16x16x32_bf16 v[244:247], a[224:227], v[26:29], v[244:247]
    v_fma_f32 v77, v77, s28, v12
    v_cvt_pk_bf16_f32 v30, v68, v69
    v_mfma_f32_16x16x32_bf16 a[36:39], a[224:227], v[32:35], a[36:39]
    s_waitcnt lgkmcnt(3)
    v_exp_f32 v77, v77
    v_mfma_f32_16x16x32_bf16 v[152:155], a[228:231], v[14:17], v[152:155]
    v_exp_f32 v81, v81
    v_mfma_f32_16x16x32_bf16 v[200:203], a[228:231], v[20:23], v[200:203]
    ds_read_b64_tr_b16 a[216:217], v3 offset:18432
    v_exp_f32 v80, v80
    v_mfma_f32_16x16x32_bf16 v[248:251], a[228:231], v[26:29], v[248:251]
    ds_read_b64_tr_b16 a[218:219], v3 offset:12288
    v_cvt_pk_bf16_f32 v25, v62, v63
    v_mfma_f32_16x16x32_bf16 a[40:43], a[228:231], v[32:35], a[40:43]
    s_waitcnt lgkmcnt(3)
    v_exp_f32 v64, v64
    v_mfma_f32_16x16x32_bf16 v[156:159], a[232:235], v[14:17], v[156:159]
    ds_read_b64_tr_b16 a[220:221], v4 offset:18432
    v_cvt_pk_bf16_f32 v17, v58, v59
    v_mfma_f32_16x16x32_bf16 v[204:207], a[232:235], v[20:23], v[204:207]
    v_cvt_pk_bf16_f32 v23, v66, v67
    v_cvt_pk_bf16_f32 v16, v56, v57
    v_mfma_f32_16x16x32_bf16 v[252:255], a[232:235], v[26:29], v[252:255]
    ds_read_b64_tr_b16 a[222:223], v4 offset:12288
    v_cvt_pk_bf16_f32 v22, v64, v65
    v_mfma_f32_16x16x32_bf16 a[44:47], a[232:235], v[32:35], a[44:47]
    v_cvt_pk_bf16_f32 v36, v76, v77
    v_cvt_pk_bf16_f32 v28, v72, v73
    v_cvt_pk_bf16_f32 v29, v74, v75
    v_mfma_f32_16x16x32_bf16 v[48:51], a[236:239], v[16:19], v[44:47]
    ds_read_b64_tr_b16 a[224:225], v5 offset:18432
    v_cvt_pk_bf16_f32 v35, v82, v83
    v_mfma_f32_16x16x32_bf16 v[48:51], a[240:243], v[22:25], v[48:51]
    v_cvt_pk_bf16_f32 v31, v70, v71
    v_cvt_pk_bf16_f32 v34, v80, v81
    v_cvt_pk_bf16_f32 v37, v78, v79
    v_mfma_f32_16x16x32_bf16 v[48:51], a[244:247], v[28:31], v[48:51]
    ds_read_b64_tr_b16 a[226:227], v5 offset:12288
    v_mfma_f32_16x16x32_bf16 v[48:51], a[248:251], v[34:37], v[48:51]
    s_nop 7
    v_cmp_lt_f32 vcc, s29, v48
    s_nop 4
    s_cbranch_vccnz L_rs_end4b
L_ret_end4b:
    s_waitcnt lgkmcnt(6)
    v_mfma_f32_16x16x32_bf16 v[112:115], a[212:215], v[16:19], v[112:115]
    ds_read_b64_tr_b16 a[230:231], v2 offset:13312
    v_mbcnt_lo_u32_b32 v104, -1, 0
    v_mbcnt_hi_u32_b32 v104, -1, v104
    v_mfma_f32_16x16x32_bf16 v[160:163], a[212:215], v[22:25], v[160:163]
    v_bfe_u32 v105, v104, 3, 1
    v_lshrrev_b32 v106, 5, v104
    v_xor_b32 v106, v106, v105
    v_mfma_f32_16x16x32_bf16 v[208:211], a[212:215], v[28:31], v[208:211]
    ds_read_b64_tr_b16 a[234:235], v3 offset:13312
    v_mov_b32 v100, v48
    v_mfma_f32_16x16x32_bf16 a[0:3], a[212:215], v[34:37], a[0:3]
    s_waitcnt lgkmcnt(6)
    ds_read_b64_tr_b16 a[228:229], v2 offset:19456
    v_xor_b32 v105, s65, v105
    v_mfma_f32_16x16x32_bf16 v[116:119], a[216:219], v[16:19], v[116:119]
    v_rcp_f32 v51, v51
    v_mfma_f32_16x16x32_bf16 v[164:167], a[216:219], v[22:25], v[164:167]
    ds_read_b64_tr_b16 a[232:233], v3 offset:19456
    v_and_b32 v107, 3, v104
    v_mfma_f32_16x16x32_bf16 v[212:215], a[216:219], v[28:31], v[212:215]
    v_rcp_f32 v49, v49
    v_mfma_f32_16x16x32_bf16 a[4:7], a[216:219], v[34:37], a[4:7]
    s_waitcnt lgkmcnt(6)
    v_lshl_or_b32 v106, v107, 1, v106
    v_lshl_add_u32 v101, v105, 10, s38
    v_mfma_f32_16x16x32_bf16 v[120:123], a[220:223], v[16:19], v[120:123]
    ds_read_b64_tr_b16 a[218:219], v5 offset:13312
    v_mul_f32 v166, v166, v49
    v_mfma_f32_16x16x32_bf16 v[168:171], a[220:223], v[22:25], v[168:171]
    v_lshl_add_u32 v101, v106, 4, v101
    v_subrev_u32 v8, 22528, v8
    v_mfma_f32_16x16x32_bf16 v[216:219], a[220:223], v[28:31], v[216:219]
    s_add_u32 s84, s34, 0
    v_and_b32 v107, 7, v104
    v_mul_f32 v165, v165, v49
    v_mfma_f32_16x16x32_bf16 a[8:11], a[220:223], v[34:37], a[8:11]
    s_waitcnt lgkmcnt(4)
    ds_read_b64_tr_b16 a[212:213], v4 offset:19456
    v_mul_f32 v161, v161, v49
    v_mfma_f32_16x16x32_bf16 v[124:127], a[224:227], v[16:19], v[124:127]
    ds_read_b64_tr_b16 a[214:215], v4 offset:13312
    v_accvgpr_read_b32 v109, a5
    v_mfma_f32_16x16x32_bf16 v[172:175], a[224:227], v[22:25], v[172:175]
    ds_read_b64_tr_b16 a[222:223], v2 offset:14336
    v_mul_f32 v160, v160, v49
    v_mfma_f32_16x16x32_bf16 v[220:223], a[224:227], v[28:31], v[220:223]
    v_lshl_add_u32 v101, v107, 7, v101
    v_mul_f32 v169, v169, v49
    v_mfma_f32_16x16x32_bf16 a[12:15], a[224:227], v[34:37], a[12:15]
    s_waitcnt lgkmcnt(4)
    v_rcp_f32 v50, v50
    v_mfma_f32_16x16x32_bf16 v[128:131], a[228:231], v[16:19], v[128:131]
    ds_read_b64_tr_b16 a[220:221], v2 offset:20480
    v_bfe_u32 v107, v104, 4, 1
    v_mfma_f32_16x16x32_bf16 v[176:179], a[228:231], v[22:25], v[176:179]
    ds_read_b64_tr_b16 a[216:217], v5 offset:19456
    v_accvgpr_read_b32 v105, a1
    v_mfma_f32_16x16x32_bf16 v[224:227], a[228:231], v[28:31], v[224:227]
    v_mul_f32 v168, v168, v49
    v_accvgpr_read_b32 v54, a10
    v_mfma_f32_16x16x32_bf16 a[16:19], a[228:231], v[34:37], a[16:19]
    v_cvt_pk_bf16_f32 v160, v160, v161
    v_lshl_add_u32 v101, v107, 3, v101
    v_mfma_f32_16x16x32_bf16 v[132:135], a[232:235], v[16:19], v[132:135]
    v_permlane32_swap_b32 v48, v100
    v_mfma_f32_16x16x32_bf16 v[180:183], a[232:235], v[22:25], v[180:183]
    v_mul_f32 v174, v174, v49
    v_mul_f32 v176, v176, v49
    v_mfma_f32_16x16x32_bf16 v[228:231], a[232:235], v[28:31], v[228:231]
    v_mul_f32 v167, v167, v49
    v_mul_f32 v170, v170, v49
    v_mfma_f32_16x16x32_bf16 a[20:23], a[232:235], v[34:37], a[20:23]
    s_waitcnt lgkmcnt(2)
    v_rcp_f32 v48, v48
    v_mfma_f32_16x16x32_bf16 v[136:139], a[212:215], v[16:19], v[136:139]
    ds_read_b64_tr_b16 a[224:225], v3 offset:20480
    v_cvt_pk_bf16_f32 v168, v168, v169
    v_mfma_f32_16x16x32_bf16 v[184:187], a[212:215], v[22:25], v[184:187]
    ds_read_b64_tr_b16 a[226:227], v3 offset:14336
    v_xor_b32 v93, 64, v101
    v_mfma_f32_16x16x32_bf16 v[232:235], a[212:215], v[28:31], v[232:235]
    v_mul_f32 v164, v164, v49
    v_xor_b32 v92, 32, v101
    v_mfma_f32_16x16x32_bf16 a[24:27], a[212:215], v[34:37], a[24:27]
    s_waitcnt lgkmcnt(2)
    v_mul_f32 v178, v178, v49
    v_mul_f32 v163, v163, v49
    v_mfma_f32_16x16x32_bf16 v[140:143], a[216:219], v[16:19], v[140:143]
    v_mul_f32 v162, v162, v49
    v_mul_f32 v173, v173, v49
    v_mfma_f32_16x16x32_bf16 v[188:191], a[216:219], v[22:25], v[188:191]
    ds_read_b64_tr_b16 a[228:229], v4 offset:20480
    v_mul_f32 v172, v172, v49
    v_mfma_f32_16x16x32_bf16 v[236:239], a[216:219], v[28:31], v[236:239]
    s_add_u32 s85, s34, 6144
    ds_read_b64_tr_b16 a[232:233], v5 offset:20480
    v_xor_b32 v94, 96, v101
    v_mfma_f32_16x16x32_bf16 a[28:31], a[216:219], v[34:37], a[28:31]
    v_cvt_pk_bf16_f32 v172, v172, v173
    v_mul_f32 v175, v175, v49
    v_mfma_f32_16x16x32_bf16 v[144:147], a[220:223], v[16:19], v[144:147]
    ds_read_b64_tr_b16 a[230:231], v4 offset:14336
    v_cvt_pk_bf16_f32 v164, v164, v165
    v_mfma_f32_16x16x32_bf16 v[192:195], a[220:223], v[22:25], v[192:195]
    v_cvt_pk_bf16_f32 v165, v166, v167
    v_mul_f32 v171, v171, v49
    v_mfma_f32_16x16x32_bf16 v[240:243], a[220:223], v[28:31], v[240:243]
    s_add_u32 s86, s34, 12288
    ds_read_b64_tr_b16 a[234:235], v5 offset:14336
    v_mul_f32 v105, v105, v51
    v_cvt_pk_bf16_f32 v169, v170, v171
    v_cvt_pk_bf16_f32 v161, v162, v163
    v_mul_f32 v109, v109, v51
    v_pk_mul_f32 v[112:113], v[112:113], v[48:49] op_sel_hi:[1,0]
    v_pk_mul_f32 v[116:117], v[116:117], v[48:49] op_sel_hi:[1,0]
    v_pk_mul_f32 v[122:123], v[122:123], v[48:49] op_sel_hi:[1,0]
    v_pk_mul_f32 v[118:119], v[118:119], v[48:49] op_sel_hi:[1,0]
    v_pk_mul_f32 v[124:125], v[124:125], v[48:49] op_sel_hi:[1,0]
    v_pk_mul_f32 v[114:115], v[114:115], v[48:49] op_sel_hi:[1,0]
    v_pk_mul_f32 v[126:127], v[126:127], v[48:49] op_sel_hi:[1,0]
    v_pk_mul_f32 v[120:121], v[120:121], v[48:49] op_sel_hi:[1,0]
    v_accvgpr_read_b32 v104, a0
    v_cvt_pk_bf16_f32 v112, v112, v113
    v_mfma_f32_16x16x32_bf16 a[32:35], a[220:223], v[34:37], a[32:35]
    s_waitcnt lgkmcnt(4)
    v_cvt_pk_bf16_f32 v124, v124, v125
    v_cvt_pk_bf16_f32 v173, v174, v175
    v_mfma_f32_16x16x32_bf16 v[148:151], a[224:227], v[16:19], v[148:151]
    v_cvt_pk_bf16_f32 v125, v126, v127
    v_cvt_pk_bf16_f32 v113, v114, v115
    v_mfma_f32_16x16x32_bf16 v[196:199], a[224:227], v[22:25], v[196:199]
    v_cvt_pk_bf16_f32 v116, v116, v117
    v_cvt_pk_bf16_f32 v120, v120, v121
    v_mfma_f32_16x16x32_bf16 v[244:247], a[224:227], v[28:31], v[244:247]
    ds_write2st64_b64 v101, v[112:113], v[160:161] offset0:0 offset1:12
    v_mfma_f32_16x16x32_bf16 a[36:39], a[224:227], v[34:37], a[36:39]
    s_waitcnt lgkmcnt(2)
    v_cvt_pk_bf16_f32 v117, v118, v119
    v_cvt_pk_bf16_f32 v121, v122, v123
    v_mfma_f32_16x16x32_bf16 v[152:155], a[228:231], v[16:19], v[152:155]
    ds_write2st64_b64 v92, v[116:117], v[164:165] offset0:0 offset1:12
    v_mfma_f32_16x16x32_bf16 v[200:203], a[228:231], v[22:25], v[200:203]
    ds_write2st64_b64 v93, v[120:121], v[168:169] offset0:0 offset1:12
    v_mfma_f32_16x16x32_bf16 v[248:251], a[228:231], v[28:31], v[248:251]
    ds_write2st64_b64 v94, v[124:125], v[172:173] offset0:0 offset1:12
    v_mfma_f32_16x16x32_bf16 a[40:43], a[228:231], v[34:37], a[40:43]
    ds_read_b128 v[68:71], v8 offset:0
    v_accvgpr_read_b32 v108, a4
    v_accvgpr_read_b32 v55, a11
    s_add_u32 s87, s34, 18432
    s_waitcnt lgkmcnt(5)
    v_mfma_f32_16x16x32_bf16 v[156:159], a[232:235], v[16:19], v[156:159]
    s_add_u32 s18, s34, 24576
    v_accvgpr_read_b32 v57, a13
    ds_read_b128 v[72:75], v8 offset:1024
    v_pk_mul_f32 v[208:209], v[208:209], v[50:51] op_sel_hi:[1,0]
    v_mul_f32 v177, v177, v49
    v_pk_mul_f32 v[130:131], v[130:131], v[48:49] op_sel_hi:[1,0]
    v_mul_f32 v108, v108, v51
    v_pk_mul_f32 v[142:143], v[142:143], v[48:49] op_sel_hi:[1,0]
    v_pk_mul_f32 v[220:221], v[220:221], v[50:51] op_sel_hi:[1,0]
    v_accvgpr_read_b32 v53, a9
    v_accvgpr_read_b32 v106, a2
    v_accvgpr_read_b32 v52, a8
    v_pk_mul_f32 v[216:217], v[216:217], v[50:51] op_sel_hi:[1,0]
    v_pk_mul_f32 v[212:213], v[212:213], v[50:51] op_sel_hi:[1,0]
    v_mul_f32 v54, v54, v51
    v_mul_f32 v57, v57, v51
    v_accvgpr_read_b32 v107, a3
    v_mfma_f32_16x16x32_bf16 v[204:207], a[232:235], v[22:25], v[204:207]
    v_cvt_pk_bf16_f32 v108, v108, v109
    v_cvt_pk_bf16_f32 v216, v216, v217
    v_mul_f32 v185, v185, v49
    v_accvgpr_read_b32 v110, a6
    v_mul_f32 v180, v180, v49
    v_cvt_pk_bf16_f32 v212, v212, v213
    v_mul_f32 v186, v186, v49
    v_accvgpr_read_b32 v56, a12
    v_mul_f32 v56, v56, v51
    s_waitcnt lgkmcnt(1)
    buffer_store_dwordx4 v[68:71], v102, s[16:19], s84 offen offset:0 nt
    v_mul_f32 v55, v55, v51
    v_mul_f32 v104, v104, v51
    v_pk_mul_f32 v[156:157], v[156:157], v[48:49] op_sel_hi:[1,0]
    v_pk_mul_f32 v[146:147], v[146:147], v[48:49] op_sel_hi:[1,0]
    v_accvgpr_read_b32 v111, a7
    v_mul_f32 v107, v107, v51
    v_pk_mul_f32 v[246:247], v[246:247], v[50:51] op_sel_hi:[1,0]
    v_cvt_pk_bf16_f32 v104, v104, v105
    ds_read_b128 v[76:79], v8 offset:6144
    v_mfma_f32_16x16x32_bf16 v[252:255], a[232:235], v[28:31], v[252:255]
    v_accvgpr_read_b32 v59, a15
    v_mul_f32 v111, v111, v51
    v_mul_f32 v192, v192, v49
    ds_read_b128 v[80:83], v8 offset:7168
    v_pk_mul_f32 v[144:145], v[144:145], v[48:49] op_sel_hi:[1,0]
    v_pk_mul_f32 v[218:219], v[218:219], v[50:51] op_sel_hi:[1,0]
    v_mul_f32 v189, v189, v49
    v_pk_mul_f32 v[210:211], v[210:211], v[50:51] op_sel_hi:[1,0]
    v_mul_f32 v52, v52, v51
    v_mul_f32 v53, v53, v51
    v_mul_f32 v106, v106, v51
    v_mfma_f32_16x16x32_bf16 a[44:47], a[232:235], v[34:37], a[44:47]
    s_waitcnt lgkmcnt(2)
    v_accvgpr_read_b32 v58, a14
    buffer_store_dwordx4 v[72:75], v103, s[16:19], s84 offen offset:0 nt
    v_cvt_pk_bf16_f32 v208, v208, v209
    v_cvt_pk_bf16_f32 v105, v106, v107
    v_mul_f32 v58, v58, v51
    v_cvt_pk_bf16_f32 v217, v218, v219
    v_cvt_pk_bf16_f32 v209, v210, v211
    v_cvt_pk_bf16_f32 v52, v52, v53
    ds_write2st64_b64 v101, v[208:209], v[104:105] offset0:24 offset1:36
    v_pk_mul_f32 v[222:223], v[222:223], v[50:51] op_sel_hi:[1,0]
    v_accvgpr_read_b32 v107, a19
    v_cvt_pk_bf16_f32 v220, v220, v221
    v_mul_f32 v184, v184, v49
    v_pk_mul_f32 v[214:215], v[214:215], v[50:51] op_sel_hi:[1,0]
    v_cvt_pk_bf16_f32 v56, v56, v57
    v_mul_f32 v110, v110, v51
    v_cvt_pk_bf16_f32 v53, v54, v55
    v_pk_mul_f32 v[134:135], v[134:135], v[48:49] op_sel_hi:[1,0]
    v_cvt_pk_bf16_f32 v221, v222, v223
    v_pk_mul_f32 v[236:237], v[236:237], v[50:51] op_sel_hi:[1,0]
    v_cvt_pk_bf16_f32 v213, v214, v215
    v_mul_f32 v183, v183, v49
    v_mul_f32 v201, v201, v49
    v_accvgpr_read_b32 v55, a27
    v_cvt_pk_bf16_f32 v109, v110, v111
    s_waitcnt lgkmcnt(1)
    buffer_store_dwordx4 v[76:79], v102, s[16:19], s85 offen offset:0 nt
    v_mul_f32 v59, v59, v51
    v_cvt_pk_bf16_f32 v57, v58, v59
    v_pk_mul_f32 v[228:229], v[228:229], v[50:51] op_sel_hi:[1,0]
    v_pk_mul_f32 v[136:137], v[136:137], v[48:49] op_sel_hi:[1,0]
    v_mul_f32 v197, v197, v49
    v_mul_f32 v181, v181, v49
    ds_write2st64_b64 v92, v[212:213], v[108:109] offset0:24 offset1:36
    ds_write2st64_b64 v93, v[216:217], v[52:53] offset0:24 offset1:36
    ds_write2st64_b64 v94, v[220:221], v[56:57] offset0:24 offset1:36
    v_pk_mul_f32 v[132:133], v[132:133], v[48:49] op_sel_hi:[1,0]
    ds_read_b128 v[84:87], v8 offset:12288
    v_accvgpr_read_b32 v58, a30
    v_accvgpr_read_b32 v54, a26
    buffer_store_dwordx4 v[80:83], v103, s[16:19], s85 offen offset:0 nt
    v_pk_mul_f32 v[138:139], v[138:139], v[48:49] op_sel_hi:[1,0]
    v_accvgpr_read_b32 v52, a24
    ds_read_b128 v[88:91], v8 offset:13312
    v_mul_f32 v193, v193, v49
    v_accvgpr_read_b32 v109, a21
    v_accvgpr_read_b32 v110, a22
    v_pk_mul_f32 v[232:233], v[232:233], v[50:51] op_sel_hi:[1,0]
    v_pk_mul_f32 v[244:245], v[244:245], v[50:51] op_sel_hi:[1,0]
    ds_read_b128 v[60:63], v8 offset:18432
    v_mul_f32 v179, v179, v49
    v_mul_f32 v109, v109, v51
    v_cvt_pk_bf16_f32 v132, v132, v133
    v_pk_mul_f32 v[140:141], v[140:141], v[48:49] op_sel_hi:[1,0]
    v_mul_f32 v58, v58, v51
    v_accvgpr_read_b32 v57, a29
    v_mul_f32 v199, v199, v49
    v_cvt_pk_bf16_f32 v133, v134, v135
    v_pk_mul_f32 v[234:235], v[234:235], v[50:51] op_sel_hi:[1,0]
    v_mul_f32 v187, v187, v49
    v_cvt_pk_bf16_f32 v180, v180, v181
    v_accvgpr_read_b32 v105, a17
    v_cvt_pk_bf16_f32 v144, v144, v145
    v_mul_f32 v105, v105, v51
    s_waitcnt lgkmcnt(2)
    buffer_store_dwordx4 v[84:87], v102, s[16:19], s86 offen offset:0 nt
    ds_read_b128 v[64:67], v8 offset:19456
    v_accvgpr_read_b32 v53, a25
    v_cvt_pk_bf16_f32 v184, v184, v185
    v_accvgpr_read_b32 v104, a16
    v_cvt_pk_bf16_f32 v176, v176, v177
    v_cvt_pk_bf16_f32 v228, v228, v229
    v_accvgpr_read_b32 v59, a31
    v_mul_f32 v190, v190, v49
    v_mul_f32 v57, v57, v51
    v_accvgpr_read_b32 v108, a20
    v_cvt_pk_bf16_f32 v136, v136, v137
    v_pk_mul_f32 v[248:249], v[248:249], v[50:51] op_sel_hi:[1,0]
    v_mul_f32 v203, v203, v49
    v_accvgpr_read_b32 v111, a23
    v_pk_mul_f32 v[128:129], v[128:129], v[48:49] op_sel_hi:[1,0]
    v_mul_f32 v108, v108, v51
    v_mul_f32 v191, v191, v49
    v_pk_mul_f32 v[152:153], v[152:153], v[48:49] op_sel_hi:[1,0]
    v_mul_f32 v188, v188, v49
    v_mul_f32 v104, v104, v51
    v_mul_f32 v52, v52, v51
    v_mul_f32 v182, v182, v49
    v_pk_mul_f32 v[226:227], v[226:227], v[50:51] op_sel_hi:[1,0]
    v_cvt_pk_bf16_f32 v244, v244, v245
    v_cvt_pk_bf16_f32 v177, v178, v179
    v_mul_f32 v107, v107, v51
    v_cvt_pk_bf16_f32 v181, v182, v183
    v_cvt_pk_bf16_f32 v128, v128, v129
    v_mul_f32 v110, v110, v51
    s_waitcnt lgkmcnt(1)
    buffer_store_dwordx4 v[88:91], v103, s[16:19], s86 offen offset:0 nt
    v_pk_mul_f32 v[230:231], v[230:231], v[50:51] op_sel_hi:[1,0]
    v_cvt_pk_bf16_f32 v129, v130, v131
    v_pk_mul_f32 v[154:155], v[154:155], v[48:49] op_sel_hi:[1,0]
    v_cvt_pk_bf16_f32 v104, v104, v105
    v_mul_f32 v55, v55, v51
    v_cvt_pk_bf16_f32 v140, v140, v141
    v_accvgpr_read_b32 v56, a28
    v_mul_f32 v202, v202, v49
    v_accvgpr_read_b32 v106, a18
    v_mul_f32 v56, v56, v51
    v_cvt_pk_bf16_f32 v185, v186, v187
    v_cvt_pk_bf16_f32 v137, v138, v139
    v_cvt_pk_bf16_f32 v188, v188, v189
    v_cvt_pk_bf16_f32 v236, v236, v237
    v_cvt_pk_bf16_f32 v245, v246, v247
    v_pk_mul_f32 v[240:241], v[240:241], v[50:51] op_sel_hi:[1,0]
    v_mul_f32 v54, v54, v51
    v_mul_f32 v106, v106, v51
    ds_write2st64_b64 v101, v[128:129], v[176:177] offset0:4 offset1:16
    v_cvt_pk_bf16_f32 v248, v248, v249
    v_cvt_pk_bf16_f32 v189, v190, v191
    v_cvt_pk_bf16_f32 v105, v106, v107
    v_mul_f32 v206, v206, v49
    buffer_store_dwordx4 v[60:63], v102, s[16:19], s87 offen offset:0 nt
    v_cvt_pk_bf16_f32 v229, v230, v231
    v_cvt_pk_bf16_f32 v141, v142, v143
    v_pk_mul_f32 v[238:239], v[238:239], v[50:51] op_sel_hi:[1,0]
    ds_write2st64_b64 v92, v[132:133], v[180:181] offset0:4 offset1:16
    ds_write2st64_b64 v93, v[136:137], v[184:185] offset0:4 offset1:16
    ds_write2st64_b64 v94, v[140:141], v[188:189] offset0:4 offset1:16
    ds_read_b128 v[68:71], v8 offset:2048
    v_pk_mul_f32 v[224:225], v[224:225], v[50:51] op_sel_hi:[1,0]
    v_mul_f32 v196, v196, v49
    v_cvt_pk_bf16_f32 v152, v152, v153
    v_cvt_pk_bf16_f32 v224, v224, v225
    s_waitcnt lgkmcnt(4)
    buffer_store_dwordx4 v[64:67], v103, s[16:19], s87 offen offset:0 nt
    v_mul_f32 v204, v204, v49
    v_mul_f32 v53, v53, v51
    v_cvt_pk_bf16_f32 v52, v52, v53
    v_mul_f32 v200, v200, v49
    v_mul_f32 v111, v111, v51
    v_cvt_pk_bf16_f32 v156, v156, v157
    v_cvt_pk_bf16_f32 v196, v196, v197
    v_pk_mul_f32 v[158:159], v[158:159], v[48:49] op_sel_hi:[1,0]
    v_mul_f32 v59, v59, v51
    v_mul_f32 v205, v205, v49
    v_cvt_pk_bf16_f32 v225, v226, v227
    v_cvt_pk_bf16_f32 v157, v158, v159
    v_cvt_pk_bf16_f32 v56, v56, v57
    v_cvt_pk_bf16_f32 v108, v108, v109
    v_cvt_pk_bf16_f32 v204, v204, v205
    v_mul_f32 v194, v194, v49
    ds_read_b128 v[72:75], v8 offset:3072
    s_waitcnt lgkmcnt(1)
    buffer_store_dwordx4 v[68:71], v102, s[16:19], s84 offen offset:128 nt
    v_cvt_pk_bf16_f32 v240, v240, v241
    v_mul_f32 v207, v207, v49
    v_cvt_pk_bf16_f32 v232, v232, v233
    v_cvt_pk_bf16_f32 v57, v58, v59
    v_pk_mul_f32 v[254:255], v[254:255], v[50:51] op_sel_hi:[1,0]
    v_pk_mul_f32 v[242:243], v[242:243], v[50:51] op_sel_hi:[1,0]
    ds_read_b128 v[76:79], v8 offset:8192
    v_cvt_pk_bf16_f32 v241, v242, v243
    v_pk_mul_f32 v[150:151], v[150:151], v[48:49] op_sel_hi:[1,0]
    ds_read_b128 v[80:83], v8 offset:9216
    v_cvt_pk_bf16_f32 v237, v238, v239
    v_cvt_pk_bf16_f32 v192, v192, v193
    v_mul_f32 v198, v198, v49
    v_accvgpr_read_b32 v107, a35
    s_waitcnt lgkmcnt(2)
    buffer_store_dwordx4 v[72:75], v103, s[16:19], s84 offen offset:128 nt
    v_cvt_pk_bf16_f32 v53, v54, v55
    v_cvt_pk_bf16_f32 v200, v200, v201
    v_mul_f32 v195, v195, v49
    ds_write2st64_b64 v101, v[224:225], v[104:105] offset0:28 offset1:40
    v_accvgpr_read_b32 v55, a43
    v_cvt_pk_bf16_f32 v109, v110, v111
    ds_write2st64_b64 v92, v[228:229], v[108:109] offset0:28 offset1:40
    v_cvt_pk_bf16_f32 v233, v234, v235
    ds_write2st64_b64 v93, v[232:233], v[52:53] offset0:28 offset1:40
    v_accvgpr_read_b32 v54, a42
    v_pk_mul_f32 v[148:149], v[148:149], v[48:49] op_sel_hi:[1,0]
    s_waitcnt lgkmcnt(3)
    buffer_store_dwordx4 v[76:79], v102, s[16:19], s85 offen offset:128 nt
    ds_write2st64_b64 v94, v[236:237], v[56:57] offset0:28 offset1:40
    ds_read_b128 v[84:87], v8 offset:14336
    v_accvgpr_read_b32 v58, a46
    v_accvgpr_read_b32 v105, a33
    v_mul_f32 v58, v58, v51
    v_accvgpr_read_b32 v108, a36
    v_mul_f32 v54, v54, v51
    v_accvgpr_read_b32 v111, a39
    v_pk_mul_f32 v[252:253], v[252:253], v[50:51] op_sel_hi:[1,0]
    v_cvt_pk_bf16_f32 v205, v206, v207
    v_accvgpr_read_b32 v56, a44
    v_cvt_pk_bf16_f32 v148, v148, v149
    buffer_store_dwordx4 v[80:83], v103, s[16:19], s85 offen offset:128 nt
    v_accvgpr_read_b32 v59, a47
    v_accvgpr_read_b32 v106, a34
    v_accvgpr_read_b32 v52, a40
    ds_read_b128 v[88:91], v8 offset:15360
    s_waitcnt lgkmcnt(1)
    buffer_store_dwordx4 v[84:87], v102, s[16:19], s86 offen offset:128 nt
    v_accvgpr_read_b32 v57, a45
    v_cvt_pk_bf16_f32 v145, v146, v147
    ds_read_b128 v[60:63], v8 offset:20480
    v_cvt_pk_bf16_f32 v149, v150, v151
    v_cvt_pk_bf16_f32 v252, v252, v253
    v_cvt_pk_bf16_f32 v201, v202, v203
    ds_read_b128 v[64:67], v8 offset:21504
    v_cvt_pk_bf16_f32 v193, v194, v195
    s_waitcnt lgkmcnt(2)
    buffer_store_dwordx4 v[88:91], v103, s[16:19], s86 offen offset:128 nt
    v_mul_f32 v52, v52, v51
    ds_write2st64_b64 v101, v[144:145], v[192:193] offset0:8 offset1:20
    v_accvgpr_read_b32 v109, a37
    v_accvgpr_read_b32 v110, a38
    v_mul_f32 v108, v108, v51
    v_mul_f32 v111, v111, v51
    v_mul_f32 v57, v57, v51
    v_accvgpr_read_b32 v53, a41
    v_cvt_pk_bf16_f32 v197, v198, v199
    v_cvt_pk_bf16_f32 v153, v154, v155
    v_mul_f32 v105, v105, v51
    v_mul_f32 v107, v107, v51
    v_accvgpr_read_b32 v104, a32
    v_mul_f32 v104, v104, v51
    v_cvt_pk_bf16_f32 v253, v254, v255
    ds_write2st64_b64 v92, v[148:149], v[196:197] offset0:8 offset1:20
    s_waitcnt lgkmcnt(2)
    buffer_store_dwordx4 v[60:63], v102, s[16:19], s87 offen offset:128 nt
    v_mul_f32 v59, v59, v51
    v_mul_f32 v56, v56, v51
    v_cvt_pk_bf16_f32 v104, v104, v105
    v_mul_f32 v53, v53, v51
    ds_write2st64_b64 v93, v[152:153], v[200:201] offset0:8 offset1:20
    ds_write2st64_b64 v94, v[156:157], v[204:205] offset0:8 offset1:20
    v_cvt_pk_bf16_f32 v56, v56, v57
    v_pk_mul_f32 v[250:251], v[250:251], v[50:51] op_sel_hi:[1,0]
    ds_read_b128 v[68:71], v8 offset:4096
    v_mul_f32 v106, v106, v51
    v_cvt_pk_bf16_f32 v57, v58, v59
    v_mul_f32 v55, v55, v51
    buffer_store_dwordx4 v[64:67], v103, s[16:19], s87 offen offset:128 nt
    ds_read_b128 v[72:75], v8 offset:5120
    s_waitcnt lgkmcnt(1)
    buffer_store_dwordx4 v[68:71], v102, s[16:19], s84 offen offset:256 nt
    ds_read_b128 v[76:79], v8 offset:10240
    v_cvt_pk_bf16_f32 v52, v52, v53
    ds_read_b128 v[80:83], v8 offset:11264
    v_cvt_pk_bf16_f32 v249, v250, v251
    v_mul_f32 v109, v109, v51
    s_waitcnt lgkmcnt(2)
    buffer_store_dwordx4 v[72:75], v103, s[16:19], s84 offen offset:256 nt
    v_mul_f32 v110, v110, v51
    v_cvt_pk_bf16_f32 v108, v108, v109
    v_cvt_pk_bf16_f32 v53, v54, v55
    v_cvt_pk_bf16_f32 v105, v106, v107
    s_waitcnt lgkmcnt(1)
    buffer_store_dwordx4 v[76:79], v102, s[16:19], s85 offen offset:256 nt
    ds_write2st64_b64 v101, v[240:241], v[104:105] offset0:32 offset1:44
    v_cvt_pk_bf16_f32 v109, v110, v111
    ds_write2st64_b64 v92, v[244:245], v[108:109] offset0:32 offset1:44
    ds_write2st64_b64 v93, v[248:249], v[52:53] offset0:32 offset1:44
    ds_write2st64_b64 v94, v[252:253], v[56:57] offset0:32 offset1:44
    ds_read_b128 v[84:87], v8 offset:16384
    ds_read_b128 v[88:91], v8 offset:17408
    s_waitcnt lgkmcnt(6)
    buffer_store_dwordx4 v[80:83], v103, s[16:19], s85 offen offset:256 nt
    s_waitcnt lgkmcnt(1)
    buffer_store_dwordx4 v[84:87], v102, s[16:19], s86 offen offset:256 nt
    ds_read_b128 v[60:63], v8 offset:22528
    ds_read_b128 v[64:67], v8 offset:23552
    s_waitcnt lgkmcnt(2)
    buffer_store_dwordx4 v[88:91], v103, s[16:19], s86 offen offset:256 nt
    s_waitcnt lgkmcnt(1)
    buffer_store_dwordx4 v[60:63], v102, s[16:19], s87 offen offset:256 nt
    s_waitcnt lgkmcnt(0)
    buffer_store_dwordx4 v[64:67], v103, s[16:19], s87 offen offset:256 nt
    s_branch L_fin
L_fin:
    s_waitcnt vmcnt(0)
L_end:
    s_endpgm
L_codeend:
L_rare5_0:
    s_nop 15
    v_mbcnt_lo_u32_b32 v31, -1, 0
    v_mbcnt_hi_u32_b32 v31, -1, v31
    v_and_b32 v30, 15, v31
    v_mul_u32_u24 v30, 384, v30
    v_lshrrev_b32 v31, 4, v31
    v_lshl_add_u32 v30, v31, 4, v30
    s_add_u32 s69, s39, 0
    buffer_load_dwordx4 v[44:47], v30, s[4:7], s69 offen offset:0
    s_waitcnt vmcnt(0)
    v_mfma_f32_16x16x32_bf16 v[104:107], v[44:47], a[96:99], 0
    s_nop 7
    buffer_load_dwordx4 v[44:47], v30, s[4:7], s69 offen offset:64
    s_waitcnt vmcnt(0)
    v_mfma_f32_16x16x32_bf16 v[104:107], v[44:47], a[100:103], v[104:107]
    s_nop 7
    buffer_load_dwordx4 v[44:47], v30, s[4:7], s69 offen offset:128
    s_waitcnt vmcnt(0)
    v_mfma_f32_16x16x32_bf16 v[104:107], v[44:47], a[104:107], v[104:107]
    s_nop 7
    buffer_load_dwordx4 v[44:47], v30, s[4:7], s69 offen offset:192
    s_waitcnt vmcnt(0)
    v_mfma_f32_16x16x32_bf16 v[104:107], v[44:47], a[108:111], v[104:107]
    s_nop 7
    buffer_load_dwordx4 v[44:47], v30, s[4:7], s69 offen offset:256
    s_waitcnt vmcnt(0)
    v_mfma_f32_16x16x32_bf16 v[104:107], v[44:47], a[112:115], v[104:107]
    s_nop 7
    buffer_load_dwordx4 v[44:47], v30, s[4:7], s69 offen offset:320
    s_waitcnt vmcnt(0)
    v_mfma_f32_16x16x32_bf16 v[104:107], v[44:47], a[116:119], v[104:107]
    s_nop 7
    s_add_u32 s69, s39, 6144
    buffer_load_dwordx4 v[44:47], v30, s[4:7], s69 offen offset:0
    s_waitcnt vmcnt(0)
    v_mfma_f32_16x16x32_bf16 v[108:111], v[44:47], a[96:99], 0
    s_nop 7
    buffer_load_dwordx4 v[44:47], v30, s[4:7], s69 offen offset:64
    s_waitcnt vmcnt(0)
    v_mfma_f32_16x16x32_bf16 v[108:111], v[44:47], a[100:103], v[108:111]
    s_nop 7
    buffer_load_dwordx4 v[44:47], v30, s[4:7], s69 offen offset:128
    s_waitcnt vmcnt(0)
    v_mfma_f32_16x16x32_bf16 v[108:111], v[44:47], a[104:107], v[108:111]
    s_nop 7
    buffer_load_dwordx4 v[44:47], v30, s[4:7], s69 offen offset:192
    s_waitcnt vmcnt(0)
    v_mfma_f32_16x16x32_bf16 v[108:111], v[44:47], a[108:111], v[108:111]
    s_nop 7
    buffer_load_dwordx4 v[44:47], v30, s[4:7], s69 offen offset:256
    s_waitcnt vmcnt(0)
    v_mfma_f32_16x16x32_bf16 v[108:111], v[44:47], a[112:115], v[108:111]
    s_nop 7
    buffer_load_dwordx4 v[44:47], v30, s[4:7], s69 offen offset:320
    s_waitcnt vmcnt(0)
    v_mfma_f32_16x16x32_bf16 v[108:111], v[44:47], a[116:119], v[108:111]
    s_nop 7
    s_nop 15
    v_max3_f32 v18, v104, v105, v106
    v_max3_f32 v18, v18, v107, v108
    v_max3_f32 v18, v18, v109, v110
    v_max_f32 v18, v18, v111
    v_mov_b32 v19, v18
    s_nop 1
    v_permlane32_swap_b32 v19, v18
    v_max_f32 v18, v18, v19
    v_mov_b32 v19, v18
    s_nop 1
    v_permlane16_swap_b32 v19, v18
    v_max_f32 v18, v18, v19
    v_fma_f32 v18, v18, s28, v9
    v_max_f32 v24, 0, v18
    v_sub_f32 v9, v9, v24
    v_sub_f32 v25, 0, v24
    v_exp_f32 v25, v25
    s_nop 0
    v_mul_f32 v19, v48, v25
    v_cndmask_b32_e64 v48, v19, v48, s[60:61]
    v_cndmask_b32_e64 v48, v48, 0, s[46:47]
    v_mul_f32 v112, v112, v25
    v_mul_f32 v113, v113, v25
    v_mul_f32 v114, v114, v25
    v_mul_f32 v115, v115, v25
    v_mul_f32 v116, v116, v25
    v_mul_f32 v117, v117, v25
    v_mul_f32 v118, v118, v25
    v_mul_f32 v119, v119, v25
    v_mul_f32 v120, v120, v25
    v_mul_f32 v121, v121, v25
    v_mul_f32 v122, v122, v25
    v_mul_f32 v123, v123, v25
    v_mul_f32 v124, v124, v25
    v_mul_f32 v125, v125, v25
    v_mul_f32 v126, v126, v25
    v_mul_f32 v127, v127, v25
    v_mul_f32 v128, v128, v25
    v_mul_f32 v129, v129, v25
    v_mul_f32 v130, v130, v25
    v_mul_f32 v131, v131, v25
    v_mul_f32 v132, v132, v25
    v_mul_f32 v133, v133, v25
    v_mul_f32 v134, v134, v25
    v_mul_f32 v135, v135, v25
    v_mul_f32 v136, v136, v25
    v_mul_f32 v137, v137, v25
    v_mul_f32 v138, v138, v25
    v_mul_f32 v139, v139, v25
    v_mul_f32 v140, v140, v25
    v_mul_f32 v141, v141, v25
    v_mul_f32 v142, v142, v25
    v_mul_f32 v143, v143, v25
    v_mul_f32 v144, v144, v25
    v_mul_f32 v145, v145, v25
    v_mul_f32 v146, v146, v25
    v_mul_f32 v147, v147, v25
    v_mul_f32 v148, v148, v25
    v_mul_f32 v149, v149, v25
    v_mul_f32 v150, v150, v25
    v_mul_f32 v151, v151, v25
    v_mul_f32 v152, v152, v25
    v_mul_f32 v153, v153, v25
    v_mul_f32 v154, v154, v25
    v_mul_f32 v155, v155, v25
    v_mul_f32 v156, v156, v25
    v_mul_f32 v157, v157, v25
    v_mul_f32 v158, v158, v25
    v_mul_f32 v159, v159, v25
    v_fma_f32 v104, v104, s28, v9
    v_fma_f32 v105, v105, s28, v9
    v_exp_f32 v104, v104
    v_exp_f32 v105, v105
    s_nop 0
    v_cvt_pk_bf16_f32 v14, v104, v105
    v_fma_f32 v106, v106, s28, v9
    v_fma_f32 v107, v107, s28, v9
    v_exp_f32 v106, v106
    v_exp_f32 v107, v107
    s_nop 0
    v_cvt_pk_bf16_f32 v15, v106, v107
    v_fma_f32 v108, v108, s28, v9
    v_fma_f32 v109, v109, s28, v9
    v_exp_f32 v108, v108
    v_exp_f32 v109, v109
    s_nop 0
    v_cvt_pk_bf16_f32 v16, v108, v109
    v_fma_f32 v110, v110, s28, v9
    v_fma_f32 v111, v111, s28, v9
    v_exp_f32 v110, v110
    v_exp_f32 v111, v111
    s_nop 0
    v_cvt_pk_bf16_f32 v17, v110, v111
    s_add_u32 s69, s39, 0
    buffer_load_dwordx4 v[44:47], v30, s[4:7], s69 offen offset:0
    s_waitcnt vmcnt(0)
    v_mfma_f32_16x16x32_bf16 v[104:107], v[44:47], a[120:123], 0
    s_nop 7
    buffer_load_dwordx4 v[44:47], v30, s[4:7], s69 offen offset:64
    s_waitcnt vmcnt(0)
    v_mfma_f32_16x16x32_bf16 v[104:107], v[44:47], a[124:127], v[104:107]
    s_nop 7
    buffer_load_dwordx4 v[44:47], v30, s[4:7], s69 offen offset:128
    s_waitcnt vmcnt(0)
    v_mfma_f32_16x16x32_bf16 v[104:107], v[44:47], a[128:131], v[104:107]
    s_nop 7
    buffer_load_dwordx4 v[44:47], v30, s[4:7], s69 offen offset:192
    s_waitcnt vmcnt(0)
    v_mfma_f32_16x16x32_bf16 v[104:107], v[44:47], a[132:135], v[104:107]
    s_nop 7
    buffer_load_dwordx4 v[44:47], v30, s[4:7], s69 offen offset:256
    s_waitcnt vmcnt(0)
    v_mfma_f32_16x16x32_bf16 v[104:107], v[44:47], a[136:139], v[104:107]
    s_nop 7
    buffer_load_dwordx4 v[44:47], v30, s[4:7], s69 offen offset:320
    s_waitcnt vmcnt(0)
    v_mfma_f32_16x16x32_bf16 v[104:107], v[44:47], a[140:143], v[104:107]
    s_nop 7
    s_add_u32 s69, s39, 6144
    buffer_load_dwordx4 v[44:47], v30, s[4:7], s69 offen offset:0
    s_waitcnt vmcnt(0)
    v_mfma_f32_16x16x32_bf16 v[108:111], v[44:47], a[120:123], 0
    s_nop 7
    buffer_load_dwordx4 v[44:47], v30, s[4:7], s69 offen offset:64
    s_waitcnt vmcnt(0)
    v_mfma_f32_16x16x32_bf16 v[108:111], v[44:47], a[124:127], v[108:111]
    s_nop 7
    buffer_load_dwordx4 v[44:47], v30, s[4:7], s69 offen offset:128
    s_waitcnt vmcnt(0)
    v_mfma_f32_16x16x32_bf16 v[108:111], v[44:47], a[128:131], v[108:111]
    s_nop 7
    buffer_load_dwordx4 v[44:47], v30, s[4:7], s69 offen offset:192
    s_waitcnt vmcnt(0)
    v_mfma_f32_16x16x32_bf16 v[108:111], v[44:47], a[132:135], v[108:111]
    s_nop 7
    buffer_load_dwordx4 v[44:47], v30, s[4:7], s69 offen offset:256
    s_waitcnt vmcnt(0)
    v_mfma_f32_16x16x32_bf16 v[108:111], v[44:47], a[136:139], v[108:111]
    s_nop 7
    buffer_load_dwordx4 v[44:47], v30, s[4:7], s69 offen offset:320
    s_waitcnt vmcnt(0)
    v_mfma_f32_16x16x32_bf16 v[108:111], v[44:47], a[140:143], v[108:111]
    s_nop 7
    s_nop 15
    v_max3_f32 v18, v104, v105, v106
    v_max3_f32 v18, v18, v107, v108
    v_max3_f32 v18, v18, v109, v110
    v_max_f32 v18, v18, v111
    v_mov_b32 v19, v18
    s_nop 1
    v_permlane32_swap_b32 v19, v18
    v_max_f32 v18, v18, v19
    v_mov_b32 v19, v18
    s_nop 1
    v_permlane16_swap_b32 v19, v18
    v_max_f32 v18, v18, v19
    v_fma_f32 v18, v18, s28, v10
    v_max_f32 v24, 0, v18
    v_sub_f32 v10, v10, v24
    v_sub_f32 v25, 0, v24
    v_exp_f32 v25, v25
    s_nop 0
    v_mul_f32 v49, v49, v25
    v_mul_f32 v160, v160, v25
    v_mul_f32 v161, v161, v25
    v_mul_f32 v162, v162, v25
    v_mul_f32 v163, v163, v25
    v_mul_f32 v164, v164, v25
    v_mul_f32 v165, v165, v25
    v_mul_f32 v166, v166, v25
    v_mul_f32 v167, v167, v25
    v_mul_f32 v168, v168, v25
    v_mul_f32 v169, v169, v25
    v_mul_f32 v170, v170, v25
    v_mul_f32 v171, v171, v25
    v_mul_f32 v172, v172, v25
    v_mul_f32 v173, v173, v25
    v_mul_f32 v174, v174, v25
    v_mul_f32 v175, v175, v25
    v_mul_f32 v176, v176, v25
    v_mul_f32 v177, v177, v25
    v_mul_f32 v178, v178, v25
    v_mul_f32 v179, v179, v25
    v_mul_f32 v180, v180, v25
    v_mul_f32 v181, v181, v25
    v_mul_f32 v182, v182, v25
    v_mul_f32 v183, v183, v25
    v_mul_f32 v184, v184, v25
    v_mul_f32 v185, v185, v25
    v_mul_f32 v186, v186, v25
    v_mul_f32 v187, v187, v25
    v_mul_f32 v188, v188, v25
    v_mul_f32 v189, v189, v25
    v_mul_f32 v190, v190, v25
    v_mul_f32 v191, v191, v25
    v_mul_f32 v192, v192, v25
    v_mul_f32 v193, v193, v25
    v_mul_f32 v194, v194, v25
    v_mul_f32 v195, v195, v25
    v_mul_f32 v196, v196, v25
    v_mul_f32 v197, v197, v25
    v_mul_f32 v198, v198, v25
    v_mul_f32 v199, v199, v25
    v_mul_f32 v200, v200, v25
    v_mul_f32 v201, v201, v25
    v_mul_f32 v202, v202, v25
    v_mul_f32 v203, v203, v25
    v_mul_f32 v204, v204, v25
    v_mul_f32 v205, v205, v25
    v_mul_f32 v206, v206, v25
    v_mul_f32 v207, v207, v25
    v_fma_f32 v104, v104, s28, v10
    v_fma_f32 v105, v105, s28, v10
    v_exp_f32 v104, v104
    v_exp_f32 v105, v105
    s_nop 0
    v_cvt_pk_bf16_f32 v20, v104, v105
    v_fma_f32 v106, v106, s28, v10
    v_fma_f32 v107, v107, s28, v10
    v_exp_f32 v106, v106
    v_exp_f32 v107, v107
    s_nop 0
    v_cvt_pk_bf16_f32 v21, v106, v107
    v_fma_f32 v108, v108, s28, v10
    v_fma_f32 v109, v109, s28, v10
    v_exp_f32 v108, v108
    v_exp_f32 v109, v109
    s_nop 0
    v_cvt_pk_bf16_f32 v22, v108, v109
    v_fma_f32 v110, v110, s28, v10
    v_fma_f32 v111, v111, s28, v10
    v_exp_f32 v110, v110
    v_exp_f32 v111, v111
    s_nop 0
    v_cvt_pk_bf16_f32 v23, v110, v111
    s_add_u32 s69, s39, 0
    buffer_load_dwordx4 v[44:47], v30, s[4:7], s69 offen offset:0
    s_waitcnt vmcnt(0)
    v_mfma_f32_16x16x32_bf16 v[104:107], v[44:47], a[144:147], 0
    s_nop 7
    buffer_load_dwordx4 v[44:47], v30, s[4:7], s69 offen offset:64
    s_waitcnt vmcnt(0)
    v_mfma_f32_16x16x32_bf16 v[104:107], v[44:47], a[148:151], v[104:107]
    s_nop 7
    buffer_load_dwordx4 v[44:47], v30, s[4:7], s69 offen offset:128
    s_waitcnt vmcnt(0)
    v_mfma_f32_16x16x32_bf16 v[104:107], v[44:47], a[152:155], v[104:107]
    s_nop 7
    buffer_load_dwordx4 v[44:47], v30, s[4:7], s69 offen offset:192
    s_waitcnt vmcnt(0)
    v_mfma_f32_16x16x32_bf16 v[104:107], v[44:47], a[156:159], v[104:107]
    s_nop 7
    buffer_load_dwordx4 v[44:47], v30, s[4:7], s69 offen offset:256
    s_waitcnt vmcnt(0)
    v_mfma_f32_16x16x32_bf16 v[104:107], v[44:47], a[160:163], v[104:107]
    s_nop 7
    buffer_load_dwordx4 v[44:47], v30, s[4:7], s69 offen offset:320
    s_waitcnt vmcnt(0)
    v_mfma_f32_16x16x32_bf16 v[104:107], v[44:47], a[164:167], v[104:107]
    s_nop 7
    s_add_u32 s69, s39, 6144
    buffer_load_dwordx4 v[44:47], v30, s[4:7], s69 offen offset:0
    s_waitcnt vmcnt(0)
    v_mfma_f32_16x16x32_bf16 v[108:111], v[44:47], a[144:147], 0
    s_nop 7
    buffer_load_dwordx4 v[44:47], v30, s[4:7], s69 offen offset:64
    s_waitcnt vmcnt(0)
    v_mfma_f32_16x16x32_bf16 v[108:111], v[44:47], a[148:151], v[108:111]
    s_nop 7
    buffer_load_dwordx4 v[44:47], v30, s[4:7], s69 offen offset:128
    s_waitcnt vmcnt(0)
    v_mfma_f32_16x16x32_bf16 v[108:111], v[44:47], a[152:155], v[108:111]
    s_nop 7
    buffer_load_dwordx4 v[44:47], v30, s[4:7], s69 offen offset:192
    s_waitcnt vmcnt(0)
    v_mfma_f32_16x16x32_bf16 v[108:111], v[44:47], a[156:159], v[108:111]
    s_nop 7
    buffer_load_dwordx4 v[44:47], v30, s[4:7], s69 offen offset:256
    s_waitcnt vmcnt(0)
    v_mfma_f32_16x16x32_bf16 v[108:111], v[44:47], a[160:163], v[108:111]
    s_nop 7
    buffer_load_dwordx4 v[44:47], v30, s[4:7], s69 offen offset:320
    s_waitcnt vmcnt(0)
    v_mfma_f32_16x16x32_bf16 v[108:111], v[44:47], a[164:167], v[108:111]
    s_nop 7
    s_nop 15
    v_max3_f32 v18, v104, v105, v106
    v_max3_f32 v18, v18, v107, v108
    v_max3_f32 v18, v18, v109, v110
    v_max_f32 v18, v18, v111
    v_mov_b32 v19, v18
    s_nop 1
    v_permlane32_swap_b32 v19, v18
    v_max_f32 v18, v18, v19
    v_mov_b32 v19, v18
    s_nop 1
    v_permlane16_swap_b32 v19, v18
    v_max_f32 v18, v18, v19
    v_fma_f32 v18, v18, s28, v11
    v_max_f32 v24, 0, v18
    v_sub_f32 v11, v11, v24
    v_sub_f32 v25, 0, v24
    v_exp_f32 v25, v25
    s_nop 0
    v_mul_f32 v50, v50, v25
    v_mul_f32 v208, v208, v25
    v_mul_f32 v209, v209, v25
    v_mul_f32 v210, v210, v25
    v_mul_f32 v211, v211, v25
    v_mul_f32 v212, v212, v25
    v_mul_f32 v213, v213, v25
    v_mul_f32 v214, v214, v25
    v_mul_f32 v215, v215, v25
    v_mul_f32 v216, v216, v25
    v_mul_f32 v217, v217, v25
    v_mul_f32 v218, v218, v25
    v_mul_f32 v219, v219, v25
    v_mul_f32 v220, v220, v25
    v_mul_f32 v221, v221, v25
    v_mul_f32 v222, v222, v25
    v_mul_f32 v223, v223, v25
    v_mul_f32 v224, v224, v25
    v_mul_f32 v225, v225, v25
    v_mul_f32 v226, v226, v25
    v_mul_f32 v227, v227, v25
    v_mul_f32 v228, v228, v25
    v_mul_f32 v229, v229, v25
    v_mul_f32 v230, v230, v25
    v_mul_f32 v231, v231, v25
    v_mul_f32 v232, v232, v25
    v_mul_f32 v233, v233, v25
    v_mul_f32 v234, v234, v25
    v_mul_f32 v235, v235, v25
    v_mul_f32 v236, v236, v25
    v_mul_f32 v237, v237, v25
    v_mul_f32 v238, v238, v25
    v_mul_f32 v239, v239, v25
    v_mul_f32 v240, v240, v25
    v_mul_f32 v241, v241, v25
    v_mul_f32 v242, v242, v25
    v_mul_f32 v243, v243, v25
    v_mul_f32 v244, v244, v25
    v_mul_f32 v245, v245, v25
    v_mul_f32 v246, v246, v25
    v_mul_f32 v247, v247, v25
    v_mul_f32 v248, v248, v25
    v_mul_f32 v249, v249, v25
    v_mul_f32 v250, v250, v25
    v_mul_f32 v251, v251, v25
    v_mul_f32 v252, v252, v25
    v_mul_f32 v253, v253, v25
    v_mul_f32 v254, v254, v25
    v_mul_f32 v255, v255, v25
    v_fma_f32 v104, v104, s28, v11
    v_fma_f32 v105, v105, s28, v11
    v_exp_f32 v104, v104
    v_exp_f32 v105, v105
    s_nop 0
    v_cvt_pk_bf16_f32 v26, v104, v105
    v_fma_f32 v106, v106, s28, v11
    v_fma_f32 v107, v107, s28, v11
    v_exp_f32 v106, v106
    v_exp_f32 v107, v107
    s_nop 0
    v_cvt_pk_bf16_f32 v27, v106, v107
    v_fma_f32 v108, v108, s28, v11
    v_fma_f32 v109, v109, s28, v11
    v_exp_f32 v108, v108
    v_exp_f32 v109, v109
    s_nop 0
    v_cvt_pk_bf16_f32 v28, v108, v109
    v_fma_f32 v110, v110, s28, v11
    v_fma_f32 v111, v111, s28, v11
    v_exp_f32 v110, v110
    v_exp_f32 v111, v111
    s_nop 0
    v_cvt_pk_bf16_f32 v29, v110, v111
    s_add_u32 s69, s39, 0
    buffer_load_dwordx4 v[44:47], v30, s[4:7], s69 offen offset:0
    s_waitcnt vmcnt(0)
    v_mfma_f32_16x16x32_bf16 v[104:107], v[44:47], a[168:171], 0
    s_nop 7
    buffer_load_dwordx4 v[44:47], v30, s[4:7], s69 offen offset:64
    s_waitcnt vmcnt(0)
    v_mfma_f32_16x16x32_bf16 v[104:107], v[44:47], a[172:175], v[104:107]
    s_nop 7
    buffer_load_dwordx4 v[44:47], v30, s[4:7], s69 offen offset:128
    s_waitcnt vmcnt(0)
    v_mfma_f32_16x16x32_bf16 v[104:107], v[44:47], a[176:179], v[104:107]
    s_nop 7
    buffer_load_dwordx4 v[44:47], v30, s[4:7], s69 offen offset:192
    s_waitcnt vmcnt(0)
    v_mfma_f32_16x16x32_bf16 v[104:107], v[44:47], a[180:183], v[104:107]
    s_nop 7
    buffer_load_dwordx4 v[44:47], v30, s[4:7], s69 offen offset:256
    s_waitcnt vmcnt(0)
    v_mfma_f32_16x16x32_bf16 v[104:107], v[44:47], a[184:187], v[104:107]
    s_nop 7
    buffer_load_dwordx4 v[44:47], v30, s[4:7], s69 offen offset:320
    s_waitcnt vmcnt(0)
    v_mfma_f32_16x16x32_bf16 v[104:107], v[44:47], a[188:191], v[104:107]
    s_nop 7
    s_add_u32 s69, s39, 6144
    buffer_load_dwordx4 v[44:47], v30, s[4:7], s69 offen offset:0
    s_waitcnt vmcnt(0)
    v_mfma_f32_16x16x32_bf16 v[108:111], v[44:47], a[168:171], 0
    s_nop 7
    buffer_load_dwordx4 v[44:47], v30, s[4:7], s69 offen offset:64
    s_waitcnt vmcnt(0)
    v_mfma_f32_16x16x32_bf16 v[108:111], v[44:47], a[172:175], v[108:111]
    s_nop 7
    buffer_load_dwordx4 v[44:47], v30, s[4:7], s69 offen offset:128
    s_waitcnt vmcnt(0)
    v_mfma_f32_16x16x32_bf16 v[108:111], v[44:47], a[176:179], v[108:111]
    s_nop 7
    buffer_load_dwordx4 v[44:47], v30, s[4:7], s69 offen offset:192
    s_waitcnt vmcnt(0)
    v_mfma_f32_16x16x32_bf16 v[108:111], v[44:47], a[180:183], v[108:111]
    s_nop 7
    buffer_load_dwordx4 v[44:47], v30, s[4:7], s69 offen offset:256
    s_waitcnt vmcnt(0)
    v_mfma_f32_16x16x32_bf16 v[108:111], v[44:47], a[184:187], v[108:111]
    s_nop 7
    buffer_load_dwordx4 v[44:47], v30, s[4:7], s69 offen offset:320
    s_waitcnt vmcnt(0)
    v_mfma_f32_16x16x32_bf16 v[108:111], v[44:47], a[188:191], v[108:111]
    s_nop 7
    s_nop 15
    v_max3_f32 v18, v104, v105, v106
    v_max3_f32 v18, v18, v107, v108
    v_max3_f32 v18, v18, v109, v110
    v_max_f32 v18, v18, v111
    v_mov_b32 v19, v18
    s_nop 1
    v_permlane32_swap_b32 v19, v18
    v_max_f32 v18, v18, v19
    v_mov_b32 v19, v18
    s_nop 1
    v_permlane16_swap_b32 v19, v18
    v_max_f32 v18, v18, v19
    v_fma_f32 v18, v18, s28, v12
    v_max_f32 v24, 0, v18
    v_sub_f32 v12, v12, v24
    v_sub_f32 v25, 0, v24
    v_exp_f32 v25, v25
    s_nop 0
    v_mul_f32 v51, v51, v25
    v_accvgpr_read_b32 v19, a0
    v_mul_f32 v19, v19, v25
    v_accvgpr_write_b32 a0, v19
    v_accvgpr_read_b32 v19, a1
    v_mul_f32 v19, v19, v25
    v_accvgpr_write_b32 a1, v19
    v_accvgpr_read_b32 v19, a2
    v_mul_f32 v19, v19, v25
    v_accvgpr_write_b32 a2, v19
    v_accvgpr_read_b32 v19, a3
    v_mul_f32 v19, v19, v25
    v_accvgpr_write_b32 a3, v19
    v_accvgpr_read_b32 v19, a4
    v_mul_f32 v19, v19, v25
    v_accvgpr_write_b32 a4, v19
    v_accvgpr_read_b32 v19, a5
    v_mul_f32 v19, v19, v25
    v_accvgpr_write_b32 a5, v19
    v_accvgpr_read_b32 v19, a6
    v_mul_f32 v19, v19, v25
    v_accvgpr_write_b32 a6, v19
    v_accvgpr_read_b32 v19, a7
    v_mul_f32 v19, v19, v25
    v_accvgpr_write_b32 a7, v19
    v_accvgpr_read_b32 v19, a8
    v_mul_f32 v19, v19, v25
    v_accvgpr_write_b32 a8, v19
    v_accvgpr_read_b32 v19, a9
    v_mul_f32 v19, v19, v25
    v_accvgpr_write_b32 a9, v19
    v_accvgpr_read_b32 v19, a10
    v_mul_f32 v19, v19, v25
    v_accvgpr_write_b32 a10, v19
    v_accvgpr_read_b32 v19, a11
    v_mul_f32 v19, v19, v25
    v_accvgpr_write_b32 a11, v19
    v_accvgpr_read_b32 v19, a12
    v_mul_f32 v19, v19, v25
    v_accvgpr_write_b32 a12, v19
    v_accvgpr_read_b32 v19, a13
    v_mul_f32 v19, v19, v25
    v_accvgpr_write_b32 a13, v19
    v_accvgpr_read_b32 v19, a14
    v_mul_f32 v19, v19, v25
    v_accvgpr_write_b32 a14, v19
    v_accvgpr_read_b32 v19, a15
    v_mul_f32 v19, v19, v25
    v_accvgpr_write_b32 a15, v19
    v_accvgpr_read_b32 v19, a16
    v_mul_f32 v19, v19, v25
    v_accvgpr_write_b32 a16, v19
    v_accvgpr_read_b32 v19, a17
    v_mul_f32 v19, v19, v25
    v_accvgpr_write_b32 a17, v19
    v_accvgpr_read_b32 v19, a18
    v_mul_f32 v19, v19, v25
    v_accvgpr_write_b32 a18, v19
    v_accvgpr_read_b32 v19, a19
    v_mul_f32 v19, v19, v25
    v_accvgpr_write_b32 a19, v19
    v_accvgpr_read_b32 v19, a20
    v_mul_f32 v19, v19, v25
    v_accvgpr_write_b32 a20, v19
    v_accvgpr_read_b32 v19, a21
    v_mul_f32 v19, v19, v25
    v_accvgpr_write_b32 a21, v19
    v_accvgpr_read_b32 v19, a22
    v_mul_f32 v19, v19, v25
    v_accvgpr_write_b32 a22, v19
    v_accvgpr_read_b32 v19, a23
    v_mul_f32 v19, v19, v25
    v_accvgpr_write_b32 a23, v19
    v_accvgpr_read_b32 v19, a24
    v_mul_f32 v19, v19, v25
    v_accvgpr_write_b32 a24, v19
    v_accvgpr_read_b32 v19, a25
    v_mul_f32 v19, v19, v25
    v_accvgpr_write_b32 a25, v19
    v_accvgpr_read_b32 v19, a26
    v_mul_f32 v19, v19, v25
    v_accvgpr_write_b32 a26, v19
    v_accvgpr_read_b32 v19, a27
    v_mul_f32 v19, v19, v25
    v_accvgpr_write_b32 a27, v19
    v_accvgpr_read_b32 v19, a28
    v_mul_f32 v19, v19, v25
    v_accvgpr_write_b32 a28, v19
    v_accvgpr_read_b32 v19, a29
    v_mul_f32 v19, v19, v25
    v_accvgpr_write_b32 a29, v19
    v_accvgpr_read_b32 v19, a30
    v_mul_f32 v19, v19, v25
    v_accvgpr_write_b32 a30, v19
    v_accvgpr_read_b32 v19, a31
    v_mul_f32 v19, v19, v25
    v_accvgpr_write_b32 a31, v19
    v_accvgpr_read_b32 v19, a32
    v_mul_f32 v19, v19, v25
    v_accvgpr_write_b32 a32, v19
    v_accvgpr_read_b32 v19, a33
    v_mul_f32 v19, v19, v25
    v_accvgpr_write_b32 a33, v19
    v_accvgpr_read_b32 v19, a34
    v_mul_f32 v19, v19, v25
    v_accvgpr_write_b32 a34, v19
    v_accvgpr_read_b32 v19, a35
    v_mul_f32 v19, v19, v25
    v_accvgpr_write_b32 a35, v19
    v_accvgpr_read_b32 v19, a36
    v_mul_f32 v19, v19, v25
    v_accvgpr_write_b32 a36, v19
    v_accvgpr_read_b32 v19, a37
    v_mul_f32 v19, v19, v25
    v_accvgpr_write_b32 a37, v19
    v_accvgpr_read_b32 v19, a38
    v_mul_f32 v19, v19, v25
    v_accvgpr_write_b32 a38, v19
    v_accvgpr_read_b32 v19, a39
    v_mul_f32 v19, v19, v25
    v_accvgpr_write_b32 a39, v19
    v_accvgpr_read_b32 v19, a40
    v_mul_f32 v19, v19, v25
    v_accvgpr_write_b32 a40, v19
    v_accvgpr_read_b32 v19, a41
    v_mul_f32 v19, v19, v25
    v_accvgpr_write_b32 a41, v19
    v_accvgpr_read_b32 v19, a42
    v_mul_f32 v19, v19, v25
    v_accvgpr_write_b32 a42, v19
    v_accvgpr_read_b32 v19, a43
    v_mul_f32 v19, v19, v25
    v_accvgpr_write_b32 a43, v19
    v_accvgpr_read_b32 v19, a44
    v_mul_f32 v19, v19, v25
    v_accvgpr_write_b32 a44, v19
    v_accvgpr_read_b32 v19, a45
    v_mul_f32 v19, v19, v25
    v_accvgpr_write_b32 a45, v19
    v_accvgpr_read_b32 v19, a46
    v_mul_f32 v19, v19, v25
    v_accvgpr_write_b32 a46, v19
    v_accvgpr_read_b32 v19, a47
    v_mul_f32 v19, v19, v25
    v_accvgpr_write_b32 a47, v19
    v_fma_f32 v104, v104, s28, v12
    v_fma_f32 v105, v105, s28, v12
    v_exp_f32 v104, v104
    v_exp_f32 v105, v105
    s_nop 0
    v_cvt_pk_bf16_f32 v32, v104, v105
    v_fma_f32 v106, v106, s28, v12
    v_fma_f32 v107, v107, s28, v12
    v_exp_f32 v106, v106
    v_exp_f32 v107, v107
    s_nop 0
    v_cvt_pk_bf16_f32 v33, v106, v107
    v_fma_f32 v108, v108, s28, v12
    v_fma_f32 v109, v109, s28, v12
    v_exp_f32 v108, v108
    v_exp_f32 v109, v109
    s_nop 0
    v_cvt_pk_bf16_f32 v34, v108, v109
    v_fma_f32 v110, v110, s28, v12
    v_fma_f32 v111, v111, s28, v12
    v_exp_f32 v110, v110
    v_exp_f32 v111, v111
    s_nop 0
    v_cvt_pk_bf16_f32 v35, v110, v111
    s_add_u32 s69, s39, 0
    buffer_load_dwordx4 v[44:47], v30, s[4:7], s69 offen offset:0
    s_waitcnt vmcnt(0)
    v_mfma_f32_16x16x32_bf16 v[104:107], v[44:47], a[192:195], 0
    s_nop 7
    buffer_load_dwordx4 v[44:47], v30, s[4:7], s69 offen offset:64
    s_waitcnt vmcnt(0)
    v_mfma_f32_16x16x32_bf16 v[104:107], v[44:47], a[196:199], v[104:107]
    s_nop 7
    buffer_load_dwordx4 v[44:47], v30, s[4:7], s69 offen offset:128
    s_waitcnt vmcnt(0)
    v_mfma_f32_16x16x32_bf16 v[104:107], v[44:47], a[200:203], v[104:107]
    s_nop 7
    buffer_load_dwordx4 v[44:47], v30, s[4:7], s69 offen offset:192
    s_waitcnt vmcnt(0)
    v_mfma_f32_16x16x32_bf16 v[104:107], v[44:47], a[204:207], v[104:107]
    s_nop 7
    buffer_load_dwordx4 v[44:47], v30, s[4:7], s69 offen offset:256
    s_waitcnt vmcnt(0)
    v_mfma_f32_16x16x32_bf16 v[104:107], v[44:47], a[208:211], v[104:107]
    s_nop 7
    buffer_load_dwordx4 v[44:47], v30, s[4:7], s69 offen offset:320
    s_waitcnt vmcnt(0)
    v_mfma_f32_16x16x32_bf16 v[104:107], v[44:47], v[92:95], v[104:107]
    s_nop 7
    s_add_u32 s69, s39, 6144
    buffer_load_dwordx4 v[44:47], v30, s[4:7], s69 offen offset:0
    s_waitcnt vmcnt(0)
    v_mfma_f32_16x16x32_bf16 v[108:111], v[44:47], a[192:195], 0
    s_nop 7
    buffer_load_dwordx4 v[44:47], v30, s[4:7], s69 offen offset:64
    s_waitcnt vmcnt(0)
    v_mfma_f32_16x16x32_bf16 v[108:111], v[44:47], a[196:199], v[108:111]
    s_nop 7
    buffer_load_dwordx4 v[44:47], v30, s[4:7], s69 offen offset:128
    s_waitcnt vmcnt(0)
    v_mfma_f32_16x16x32_bf16 v[108:111], v[44:47], a[200:203], v[108:111]
    s_nop 7
    buffer_load_dwordx4 v[44:47], v30, s[4:7], s69 offen offset:192
    s_waitcnt vmcnt(0)
    v_mfma_f32_16x16x32_bf16 v[108:111], v[44:47], a[204:207], v[108:111]
    s_nop 7
    buffer_load_dwordx4 v[44:47], v30, s[4:7], s69 offen offset:256
    s_waitcnt vmcnt(0)
    v_mfma_f32_16x16x32_bf16 v[108:111], v[44:47], a[208:211], v[108:111]
    s_nop 7
    buffer_load_dwordx4 v[44:47], v30, s[4:7], s69 offen offset:320
    s_waitcnt vmcnt(0)
    v_mfma_f32_16x16x32_bf16 v[108:111], v[44:47], v[92:95], v[108:111]
    s_nop 7
    s_nop 15
    v_max3_f32 v18, v104, v105, v106
    v_max3_f32 v18, v18, v107, v108
    v_max3_f32 v18, v18, v109, v110
    v_max_f32 v18, v18, v111
    v_mov_b32 v19, v18
    s_nop 1
    v_permlane32_swap_b32 v19, v18
    v_max_f32 v18, v18, v19
    v_mov_b32 v19, v18
    s_nop 1
    v_permlane16_swap_b32 v19, v18
    v_max_f32 v18, v18, v19
    v_fma_f32 v18, v18, s28, v13
    v_max_f32 v24, 0, v18
    v_sub_f32 v13, v13, v24
    v_sub_f32 v25, 0, v24
    v_exp_f32 v25, v25
    s_nop 0
    v_mul_f32 v19, v48, v25
    v_cndmask_b32_e64 v48, v48, v19, s[60:61]
    v_accvgpr_read_b32 v19, a48
    v_mul_f32 v19, v19, v25
    v_accvgpr_write_b32 a48, v19
    v_accvgpr_read_b32 v19, a49
    v_mul_f32 v19, v19, v25
    v_accvgpr_write_b32 a49, v19
    v_accvgpr_read_b32 v19, a50
    v_mul_f32 v19, v19, v25
    v_accvgpr_write_b32 a50, v19
    v_accvgpr_read_b32 v19, a51
    v_mul_f32 v19, v19, v25
    v_accvgpr_write_b32 a51, v19
    v_accvgpr_read_b32 v19, a52
    v_mul_f32 v19, v19, v25
    v_accvgpr_write_b32 a52, v19
    v_accvgpr_read_b32 v19, a53
    v_mul_f32 v19, v19, v25
    v_accvgpr_write_b32 a53, v19
    v_accvgpr_read_b32 v19, a54
    v_mul_f32 v19, v19, v25
    v_accvgpr_write_b32 a54, v19
    v_accvgpr_read_b32 v19, a55
    v_mul_f32 v19, v19, v25
    v_accvgpr_write_b32 a55, v19
    v_accvgpr_read_b32 v19, a56
    v_mul_f32 v19, v19, v25
    v_accvgpr_write_b32 a56, v19
    v_accvgpr_read_b32 v19, a57
    v_mul_f32 v19, v19, v25
    v_accvgpr_write_b32 a57, v19
    v_accvgpr_read_b32 v19, a58
    v_mul_f32 v19, v19, v25
    v_accvgpr_write_b32 a58, v19
    v_accvgpr_read_b32 v19, a59
    v_mul_f32 v19, v19, v25
    v_accvgpr_write_b32 a59, v19
    v_accvgpr_read_b32 v19, a60
    v_mul_f32 v19, v19, v25
    v_accvgpr_write_b32 a60, v19
    v_accvgpr_read_b32 v19, a61
    v_mul_f32 v19, v19, v25
    v_accvgpr_write_b32 a61, v19
    v_accvgpr_read_b32 v19, a62
    v_mul_f32 v19, v19, v25
    v_accvgpr_write_b32 a62, v19
    v_accvgpr_read_b32 v19, a63
    v_mul_f32 v19, v19, v25
    v_accvgpr_write_b32 a63, v19
    v_accvgpr_read_b32 v19, a64
    v_mul_f32 v19, v19, v25
    v_accvgpr_write_b32 a64, v19
    v_accvgpr_read_b32 v19, a65
    v_mul_f32 v19, v19, v25
    v_accvgpr_write_b32 a65, v19
    v_accvgpr_read_b32 v19, a66
    v_mul_f32 v19, v19, v25
    v_accvgpr_write_b32 a66, v19
    v_accvgpr_read_b32 v19, a67
    v_mul_f32 v19, v19, v25
    v_accvgpr_write_b32 a67, v19
    v_accvgpr_read_b32 v19, a68
    v_mul_f32 v19, v19, v25
    v_accvgpr_write_b32 a68, v19
    v_accvgpr_read_b32 v19, a69
    v_mul_f32 v19, v19, v25
    v_accvgpr_write_b32 a69, v19
    v_accvgpr_read_b32 v19, a70
    v_mul_f32 v19, v19, v25
    v_accvgpr_write_b32 a70, v19
    v_accvgpr_read_b32 v19, a71
    v_mul_f32 v19, v19, v25
    v_accvgpr_write_b32 a71, v19
    v_accvgpr_read_b32 v19, a72
    v_mul_f32 v19, v19, v25
    v_accvgpr_write_b32 a72, v19
    v_accvgpr_read_b32 v19, a73
    v_mul_f32 v19, v19, v25
    v_accvgpr_write_b32 a73, v19
    v_accvgpr_read_b32 v19, a74
    v_mul_f32 v19, v19, v25
    v_accvgpr_write_b32 a74, v19
    v_accvgpr_read_b32 v19, a75
    v_mul_f32 v19, v19, v25
    v_accvgpr_write_b32 a75, v19
    v_accvgpr_read_b32 v19, a76
    v_mul_f32 v19, v19, v25
    v_accvgpr_write_b32 a76, v19
    v_accvgpr_read_b32 v19, a77
    v_mul_f32 v19, v19, v25
    v_accvgpr_write_b32 a77, v19
    v_accvgpr_read_b32 v19, a78
    v_mul_f32 v19, v19, v25
    v_accvgpr_write_b32 a78, v19
    v_accvgpr_read_b32 v19, a79
    v_mul_f32 v19, v19, v25
    v_accvgpr_write_b32 a79, v19
    v_accvgpr_read_b32 v19, a80
    v_mul_f32 v19, v19, v25
    v_accvgpr_write_b32 a80, v19
    v_accvgpr_read_b32 v19, a81
    v_mul_f32 v19, v19, v25
    v_accvgpr_write_b32 a81, v19
    v_accvgpr_read_b32 v19, a82
    v_mul_f32 v19, v19, v25
    v_accvgpr_write_b32 a82, v19
    v_accvgpr_read_b32 v19, a83
    v_mul_f32 v19, v19, v25
    v_accvgpr_write_b32 a83, v19
    v_accvgpr_read_b32 v19, a84
    v_mul_f32 v19, v19, v25
    v_accvgpr_write_b32 a84, v19
    v_accvgpr_read_b32 v19, a85
    v_mul_f32 v19, v19, v25
    v_accvgpr_write_b32 a85, v19
    v_accvgpr_read_b32 v19, a86
    v_mul_f32 v19, v19, v25
    v_accvgpr_write_b32 a86, v19
    v_accvgpr_read_b32 v19, a87
    v_mul_f32 v19, v19, v25
    v_accvgpr_write_b32 a87, v19
    v_accvgpr_read_b32 v19, a88
    v_mul_f32 v19, v19, v25
    v_accvgpr_write_b32 a88, v19
    v_accvgpr_read_b32 v19, a89
    v_mul_f32 v19, v19, v25
    v_accvgpr_write_b32 a89, v19
    v_accvgpr_read_b32 v19, a90
    v_mul_f32 v19, v19, v25
    v_accvgpr_write_b32 a90, v19
    v_accvgpr_read_b32 v19, a91
    v_mul_f32 v19, v19, v25
    v_accvgpr_write_b32 a91, v19
    v_accvgpr_read_b32 v19, a92
    v_mul_f32 v19, v19, v25
    v_accvgpr_write_b32 a92, v19
    v_accvgpr_read_b32 v19, a93
    v_mul_f32 v19, v19, v25
    v_accvgpr_write_b32 a93, v19
    v_accvgpr_read_b32 v19, a94
    v_mul_f32 v19, v19, v25
    v_accvgpr_write_b32 a94, v19
    v_accvgpr_read_b32 v19, a95
    v_mul_f32 v19, v19, v25
    v_accvgpr_write_b32 a95, v19
    v_fma_f32 v104, v104, s28, v13
    v_fma_f32 v105, v105, s28, v13
    v_exp_f32 v104, v104
    v_exp_f32 v105, v105
    s_nop 0
    v_cvt_pk_bf16_f32 v38, v104, v105
    v_fma_f32 v106, v106, s28, v13
    v_fma_f32 v107, v107, s28, v13
    v_exp_f32 v106, v106
    v_exp_f32 v107, v107
    s_nop 0
    v_cvt_pk_bf16_f32 v39, v106, v107
    v_fma_f32 v108, v108, s28, v13
    v_fma_f32 v109, v109, s28, v13
    v_exp_f32 v108, v108
    v_exp_f32 v109, v109
    s_nop 0
    v_cvt_pk_bf16_f32 v40, v108, v109
    v_fma_f32 v110, v110, s28, v13
    v_fma_f32 v111, v111, s28, v13
    v_exp_f32 v110, v110
    v_exp_f32 v111, v111
    s_nop 0
    v_cvt_pk_bf16_f32 v41, v110, v111
    v_mfma_f32_16x16x32_bf16 v[44:47], a[236:239], v[14:17], v[48:51]
    v_mfma_f32_16x16x32_bf16 v[44:47], a[240:243], v[20:23], v[44:47]
    v_mfma_f32_16x16x32_bf16 v[44:47], a[244:247], v[26:29], v[44:47]
    v_mfma_f32_16x16x32_bf16 v[44:47], a[248:251], v[32:35], v[44:47]
    v_mfma_f32_16x16x32_bf16 v[44:47], a[252:255], v[38:41], v[44:47]
    s_nop 15
    s_setpc_b64 s[40:41]
L_rare5_1:
    s_nop 15
    v_mbcnt_lo_u32_b32 v27, -1, 0
    v_mbcnt_hi_u32_b32 v27, -1, v27
    v_and_b32 v26, 15, v27
    v_mul_u32_u24 v26, 384, v26
    v_lshrrev_b32 v27, 4, v27
    v_lshl_add_u32 v26, v27, 4, v26
    s_add_u32 s69, s39, 0
    buffer_load_dwordx4 v[48:51], v26, s[4:7], s69 offen offset:0
    s_waitcnt vmcnt(0)
    v_mfma_f32_16x16x32_bf16 v[104:107], v[48:51], a[96:99], 0
    s_nop 7
    buffer_load_dwordx4 v[48:51], v26, s[4:7], s69 offen offset:64
    s_waitcnt vmcnt(0)
    v_mfma_f32_16x16x32_bf16 v[104:107], v[48:51], a[100:103], v[104:107]
    s_nop 7
    buffer_load_dwordx4 v[48:51], v26, s[4:7], s69 offen offset:128
    s_waitcnt vmcnt(0)
    v_mfma_f32_16x16x32_bf16 v[104:107], v[48:51], a[104:107], v[104:107]
    s_nop 7
    buffer_load_dwordx4 v[48:51], v26, s[4:7], s69 offen offset:192
    s_waitcnt vmcnt(0)
    v_mfma_f32_16x16x32_bf16 v[104:107], v[48:51], a[108:111], v[104:107]
    s_nop 7
    buffer_load_dwordx4 v[48:51], v26, s[4:7], s69 offen offset:256
    s_waitcnt vmcnt(0)
    v_mfma_f32_16x16x32_bf16 v[104:107], v[48:51], a[112:115], v[104:107]
    s_nop 7
    buffer_load_dwordx4 v[48:51], v26, s[4:7], s69 offen offset:320
    s_waitcnt vmcnt(0)
    v_mfma_f32_16x16x32_bf16 v[104:107], v[48:51], a[116:119], v[104:107]
    s_nop 7
    s_add_u32 s69, s39, 6144
    buffer_load_dwordx4 v[48:51], v26, s[4:7], s69 offen offset:0
    s_waitcnt vmcnt(0)
    v_mfma_f32_16x16x32_bf16 v[108:111], v[48:51], a[96:99], 0
    s_nop 7
    buffer_load_dwordx4 v[48:51], v26, s[4:7], s69 offen offset:64
    s_waitcnt vmcnt(0)
    v_mfma_f32_16x16x32_bf16 v[108:111], v[48:51], a[100:103], v[108:111]
    s_nop 7
    buffer_load_dwordx4 v[48:51], v26, s[4:7], s69 offen offset:128
    s_waitcnt vmcnt(0)
    v_mfma_f32_16x16x32_bf16 v[108:111], v[48:51], a[104:107], v[108:111]
    s_nop 7
    buffer_load_dwordx4 v[48:51], v26, s[4:7], s69 offen offset:192
    s_waitcnt vmcnt(0)
    v_mfma_f32_16x16x32_bf16 v[108:111], v[48:51], a[108:111], v[108:111]
    s_nop 7
    buffer_load_dwordx4 v[48:51], v26, s[4:7], s69 offen offset:256
    s_waitcnt vmcnt(0)
    v_mfma_f32_16x16x32_bf16 v[108:111], v[48:51], a[112:115], v[108:111]
    s_nop 7
    buffer_load_dwordx4 v[48:51], v26, s[4:7], s69 offen offset:320
    s_waitcnt vmcnt(0)
    v_mfma_f32_16x16x32_bf16 v[108:111], v[48:51], a[116:119], v[108:111]
    s_nop 7
    s_nop 15
    v_max3_f32 v14, v104, v105, v106
    v_max3_f32 v14, v14, v107, v108
    v_max3_f32 v14, v14, v109, v110
    v_max_f32 v14, v14, v111
    v_mov_b32 v15, v14
    s_nop 1
    v_permlane32_swap_b32 v15, v14
    v_max_f32 v14, v14, v15
    v_mov_b32 v15, v14
    s_nop 1
    v_permlane16_swap_b32 v15, v14
    v_max_f32 v14, v14, v15
    v_fma_f32 v14, v14, s28, v9
    v_max_f32 v20, 0, v14
    v_sub_f32 v9, v9, v20
    v_sub_f32 v21, 0, v20
    v_exp_f32 v21, v21
    s_nop 0
    v_mul_f32 v15, v44, v21
    v_cndmask_b32_e64 v44, v15, v44, s[60:61]
    v_cndmask_b32_e64 v44, v44, 0, s[46:47]
    v_mul_f32 v112, v112, v21
    v_mul_f32 v113, v113, v21
    v_mul_f32 v114, v114, v21
    v_mul_f32 v115, v115, v21
    v_mul_f32 v116, v116, v21
    v_mul_f32 v117, v117, v21
    v_mul_f32 v118, v118, v21
    v_mul_f32 v119, v119, v21
    v_mul_f32 v120, v120, v21
    v_mul_f32 v121, v121, v21
    v_mul_f32 v122, v122, v21
    v_mul_f32 v123, v123, v21
    v_mul_f32 v124, v124, v21
    v_mul_f32 v125, v125, v21
    v_mul_f32 v126, v126, v21
    v_mul_f32 v127, v127, v21
    v_mul_f32 v128, v128, v21
    v_mul_f32 v129, v129, v21
    v_mul_f32 v130, v130, v21
    v_mul_f32 v131, v131, v21
    v_mul_f32 v132, v132, v21
    v_mul_f32 v133, v133, v21
    v_mul_f32 v134, v134, v21
    v_mul_f32 v135, v135, v21
    v_mul_f32 v136, v136, v21
    v_mul_f32 v137, v137, v21
    v_mul_f32 v138, v138, v21
    v_mul_f32 v139, v139, v21
    v_mul_f32 v140, v140, v21
    v_mul_f32 v141, v141, v21
    v_mul_f32 v142, v142, v21
    v_mul_f32 v143, v143, v21
    v_mul_f32 v144, v144, v21
    v_mul_f32 v145, v145, v21
    v_mul_f32 v146, v146, v21
    v_mul_f32 v147, v147, v21
    v_mul_f32 v148, v148, v21
    v_mul_f32 v149, v149, v21
    v_mul_f32 v150, v150, v21
    v_mul_f32 v151, v151, v21
    v_mul_f32 v152, v152, v21
    v_mul_f32 v153, v153, v21
    v_mul_f32 v154, v154, v21
    v_mul_f32 v155, v155, v21
    v_mul_f32 v156, v156, v21
    v_mul_f32 v157, v157, v21
    v_mul_f32 v158, v158, v21
    v_mul_f32 v159, v159, v21
    v_fma_f32 v104, v104, s28, v9
    v_fma_f32 v105, v105, s28, v9
    v_exp_f32 v104, v104
    v_exp_f32 v105, v105
    s_nop 0
    v_cvt_pk_bf16_f32 v18, v104, v105
    v_fma_f32 v106, v106, s28, v9
    v_fma_f32 v107, v107, s28, v9
    v_exp_f32 v106, v106
    v_exp_f32 v107, v107
    s_nop 0
    v_cvt_pk_bf16_f32 v19, v106, v107
    v_fma_f32 v108, v108, s28, v9
    v_fma_f32 v109, v109, s28, v9
    v_exp_f32 v108, v108
    v_exp_f32 v109, v109
    s_nop 0
    v_cvt_pk_bf16_f32 v16, v108, v109
    v_fma_f32 v110, v110, s28, v9
    v_fma_f32 v111, v111, s28, v9
    v_exp_f32 v110, v110
    v_exp_f32 v111, v111
    s_nop 0
    v_cvt_pk_bf16_f32 v17, v110, v111
    s_add_u32 s69, s39, 0
    buffer_load_dwordx4 v[48:51], v26, s[4:7], s69 offen offset:0
    s_waitcnt vmcnt(0)
    v_mfma_f32_16x16x32_bf16 v[104:107], v[48:51], a[120:123], 0
    s_nop 7
    buffer_load_dwordx4 v[48:51], v26, s[4:7], s69 offen offset:64
    s_waitcnt vmcnt(0)
    v_mfma_f32_16x16x32_bf16 v[104:107], v[48:51], a[124:127], v[104:107]
    s_nop 7
    buffer_load_dwordx4 v[48:51], v26, s[4:7], s69 offen offset:128
    s_waitcnt vmcnt(0)
    v_mfma_f32_16x16x32_bf16 v[104:107], v[48:51], a[128:131], v[104:107]
    s_nop 7
    buffer_load_dwordx4 v[48:51], v26, s[4:7], s69 offen offset:192
    s_waitcnt vmcnt(0)
    v_mfma_f32_16x16x32_bf16 v[104:107], v[48:51], a[132:135], v[104:107]
    s_nop 7
    buffer_load_dwordx4 v[48:51], v26, s[4:7], s69 offen offset:256
    s_waitcnt vmcnt(0)
    v_mfma_f32_16x16x32_bf16 v[104:107], v[48:51], a[136:139], v[104:107]
    s_nop 7
    buffer_load_dwordx4 v[48:51], v26, s[4:7], s69 offen offset:320
    s_waitcnt vmcnt(0)
    v_mfma_f32_16x16x32_bf16 v[104:107], v[48:51], a[140:143], v[104:107]
    s_nop 7
    s_add_u32 s69, s39, 6144
    buffer_load_dwordx4 v[48:51], v26, s[4:7], s69 offen offset:0
    s_waitcnt vmcnt(0)
    v_mfma_f32_16x16x32_bf16 v[108:111], v[48:51], a[120:123], 0
    s_nop 7
    buffer_load_dwordx4 v[48:51], v26, s[4:7], s69 offen offset:64
    s_waitcnt vmcnt(0)
    v_mfma_f32_16x16x32_bf16 v[108:111], v[48:51], a[124:127], v[108:111]
    s_nop 7
    buffer_load_dwordx4 v[48:51], v26, s[4:7], s69 offen offset:128
    s_waitcnt vmcnt(0)
    v_mfma_f32_16x16x32_bf16 v[108:111], v[48:51], a[128:131], v[108:111]
    s_nop 7
    buffer_load_dwordx4 v[48:51], v26, s[4:7], s69 offen offset:192
    s_waitcnt vmcnt(0)
    v_mfma_f32_16x16x32_bf16 v[108:111], v[48:51], a[132:135], v[108:111]
    s_nop 7
    buffer_load_dwordx4 v[48:51], v26, s[4:7], s69 offen offset:256
    s_waitcnt vmcnt(0)
    v_mfma_f32_16x16x32_bf16 v[108:111], v[48:51], a[136:139], v[108:111]
    s_nop 7
    buffer_load_dwordx4 v[48:51], v26, s[4:7], s69 offen offset:320
    s_waitcnt vmcnt(0)
    v_mfma_f32_16x16x32_bf16 v[108:111], v[48:51], a[140:143], v[108:111]
    s_nop 7
    s_nop 15
    v_max3_f32 v14, v104, v105, v106
    v_max3_f32 v14, v14, v107, v108
    v_max3_f32 v14, v14, v109, v110
    v_max_f32 v14, v14, v111
    v_mov_b32 v15, v14
    s_nop 1
    v_permlane32_swap_b32 v15, v14
    v_max_f32 v14, v14, v15
    v_mov_b32 v15, v14
    s_nop 1
    v_permlane16_swap_b32 v15, v14
    v_max_f32 v14, v14, v15
    v_fma_f32 v14, v14, s28, v10
    v_max_f32 v20, 0, v14
    v_sub_f32 v10, v10, v20
    v_sub_f32 v21, 0, v20
    v_exp_f32 v21, v21
    s_nop 0
    v_mul_f32 v45, v45, v21
    v_mul_f32 v160, v160, v21
    v_mul_f32 v161, v161, v21
    v_mul_f32 v162, v162, v21
    v_mul_f32 v163, v163, v21
    v_mul_f32 v164, v164, v21
    v_mul_f32 v165, v165, v21
    v_mul_f32 v166, v166, v21
    v_mul_f32 v167, v167, v21
    v_mul_f32 v168, v168, v21
    v_mul_f32 v169, v169, v21
    v_mul_f32 v170, v170, v21
    v_mul_f32 v171, v171, v21
    v_mul_f32 v172, v172, v21
    v_mul_f32 v173, v173, v21
    v_mul_f32 v174, v174, v21
    v_mul_f32 v175, v175, v21
    v_mul_f32 v176, v176, v21
    v_mul_f32 v177, v177, v21
    v_mul_f32 v178, v178, v21
    v_mul_f32 v179, v179, v21
    v_mul_f32 v180, v180, v21
    v_mul_f32 v181, v181, v21
    v_mul_f32 v182, v182, v21
    v_mul_f32 v183, v183, v21
    v_mul_f32 v184, v184, v21
    v_mul_f32 v185, v185, v21
    v_mul_f32 v186, v186, v21
    v_mul_f32 v187, v187, v21
    v_mul_f32 v188, v188, v21
    v_mul_f32 v189, v189, v21
    v_mul_f32 v190, v190, v21
    v_mul_f32 v191, v191, v21
    v_mul_f32 v192, v192, v21
    v_mul_f32 v193, v193, v21
    v_mul_f32 v194, v194, v21
    v_mul_f32 v195, v195, v21
    v_mul_f32 v196, v196, v21
    v_mul_f32 v197, v197, v21
    v_mul_f32 v198, v198, v21
    v_mul_f32 v199, v199, v21
    v_mul_f32 v200, v200, v21
    v_mul_f32 v201, v201, v21
    v_mul_f32 v202, v202, v21
    v_mul_f32 v203, v203, v21
    v_mul_f32 v204, v204, v21
    v_mul_f32 v205, v205, v21
    v_mul_f32 v206, v206, v21
    v_mul_f32 v207, v207, v21
    v_fma_f32 v104, v104, s28, v10
    v_fma_f32 v105, v105, s28, v10
    v_exp_f32 v104, v104
    v_exp_f32 v105, v105
    s_nop 0
    v_cvt_pk_bf16_f32 v24, v104, v105
    v_fma_f32 v106, v106, s28, v10
    v_fma_f32 v107, v107, s28, v10
    v_exp_f32 v106, v106
    v_exp_f32 v107, v107
    s_nop 0
    v_cvt_pk_bf16_f32 v25, v106, v107
    v_fma_f32 v108, v108, s28, v10
    v_fma_f32 v109, v109, s28, v10
    v_exp_f32 v108, v108
    v_exp_f32 v109, v109
    s_nop 0
    v_cvt_pk_bf16_f32 v22, v108, v109
    v_fma_f32 v110, v110, s28, v10
    v_fma_f32 v111, v111, s28, v10
    v_exp_f32 v110, v110
    v_exp_f32 v111, v111
    s_nop 0
    v_cvt_pk_bf16_f32 v23, v110, v111
    s_add_u32 s69, s39, 0
    buffer_load_dwordx4 v[48:51], v26, s[4:7], s69 offen offset:0
    s_waitcnt vmcnt(0)
    v_mfma_f32_16x16x32_bf16 v[104:107], v[48:51], a[144:147], 0
    s_nop 7
    buffer_load_dwordx4 v[48:51], v26, s[4:7], s69 offen offset:64
    s_waitcnt vmcnt(0)
    v_mfma_f32_16x16x32_bf16 v[104:107], v[48:51], a[148:151], v[104:107]
    s_nop 7
    buffer_load_dwordx4 v[48:51], v26, s[4:7], s69 offen offset:128
    s_waitcnt vmcnt(0)
    v_mfma_f32_16x16x32_bf16 v[104:107], v[48:51], a[152:155], v[104:107]
    s_nop 7
    buffer_load_dwordx4 v[48:51], v26, s[4:7], s69 offen offset:192
    s_waitcnt vmcnt(0)
    v_mfma_f32_16x16x32_bf16 v[104:107], v[48:51], a[156:159], v[104:107]
    s_nop 7
    buffer_load_dwordx4 v[48:51], v26, s[4:7], s69 offen offset:256
    s_waitcnt vmcnt(0)
    v_mfma_f32_16x16x32_bf16 v[104:107], v[48:51], a[160:163], v[104:107]
    s_nop 7
    buffer_load_dwordx4 v[48:51], v26, s[4:7], s69 offen offset:320
    s_waitcnt vmcnt(0)
    v_mfma_f32_16x16x32_bf16 v[104:107], v[48:51], a[164:167], v[104:107]
    s_nop 7
    s_add_u32 s69, s39, 6144
    buffer_load_dwordx4 v[48:51], v26, s[4:7], s69 offen offset:0
    s_waitcnt vmcnt(0)
    v_mfma_f32_16x16x32_bf16 v[108:111], v[48:51], a[144:147], 0
    s_nop 7
    buffer_load_dwordx4 v[48:51], v26, s[4:7], s69 offen offset:64
    s_waitcnt vmcnt(0)
    v_mfma_f32_16x16x32_bf16 v[108:111], v[48:51], a[148:151], v[108:111]
    s_nop 7
    buffer_load_dwordx4 v[48:51], v26, s[4:7], s69 offen offset:128
    s_waitcnt vmcnt(0)
    v_mfma_f32_16x16x32_bf16 v[108:111], v[48:51], a[152:155], v[108:111]
    s_nop 7
    buffer_load_dwordx4 v[48:51], v26, s[4:7], s69 offen offset:192
    s_waitcnt vmcnt(0)
    v_mfma_f32_16x16x32_bf16 v[108:111], v[48:51], a[156:159], v[108:111]
    s_nop 7
    buffer_load_dwordx4 v[48:51], v26, s[4:7], s69 offen offset:256
    s_waitcnt vmcnt(0)
    v_mfma_f32_16x16x32_bf16 v[108:111], v[48:51], a[160:163], v[108:111]
    s_nop 7
    buffer_load_dwordx4 v[48:51], v26, s[4:7], s69 offen offset:320
    s_waitcnt vmcnt(0)
    v_mfma_f32_16x16x32_bf16 v[108:111], v[48:51], a[164:167], v[108:111]
    s_nop 7
    s_nop 15
    v_max3_f32 v14, v104, v105, v106
    v_max3_f32 v14, v14, v107, v108
    v_max3_f32 v14, v14, v109, v110
    v_max_f32 v14, v14, v111
    v_mov_b32 v15, v14
    s_nop 1
    v_permlane32_swap_b32 v15, v14
    v_max_f32 v14, v14, v15
    v_mov_b32 v15, v14
    s_nop 1
    v_permlane16_swap_b32 v15, v14
    v_max_f32 v14, v14, v15
    v_fma_f32 v14, v14, s28, v11
    v_max_f32 v20, 0, v14
    v_sub_f32 v11, v11, v20
    v_sub_f32 v21, 0, v20
    v_exp_f32 v21, v21
    s_nop 0
    v_mul_f32 v46, v46, v21
    v_mul_f32 v208, v208, v21
    v_mul_f32 v209, v209, v21
    v_mul_f32 v210, v210, v21
    v_mul_f32 v211, v211, v21
    v_mul_f32 v212, v212, v21
    v_mul_f32 v213, v213, v21
    v_mul_f32 v214, v214, v21
    v_mul_f32 v215, v215, v21
    v_mul_f32 v216, v216, v21
    v_mul_f32 v217, v217, v21
    v_mul_f32 v218, v218, v21
    v_mul_f32 v219, v219, v21
    v_mul_f32 v220, v220, v21
    v_mul_f32 v221, v221, v21
    v_mul_f32 v222, v222, v21
    v_mul_f32 v223, v223, v21
    v_mul_f32 v224, v224, v21
    v_mul_f32 v225, v225, v21
    v_mul_f32 v226, v226, v21
    v_mul_f32 v227, v227, v21
    v_mul_f32 v228, v228, v21
    v_mul_f32 v229, v229, v21
    v_mul_f32 v230, v230, v21
    v_mul_f32 v231, v231, v21
    v_mul_f32 v232, v232, v21
    v_mul_f32 v233, v233, v21
    v_mul_f32 v234, v234, v21
    v_mul_f32 v235, v235, v21
    v_mul_f32 v236, v236, v21
    v_mul_f32 v237, v237, v21
    v_mul_f32 v238, v238, v21
    v_mul_f32 v239, v239, v21
    v_mul_f32 v240, v240, v21
    v_mul_f32 v241, v241, v21
    v_mul_f32 v242, v242, v21
    v_mul_f32 v243, v243, v21
    v_mul_f32 v244, v244, v21
    v_mul_f32 v245, v245, v21
    v_mul_f32 v246, v246, v21
    v_mul_f32 v247, v247, v21
    v_mul_f32 v248, v248, v21
    v_mul_f32 v249, v249, v21
    v_mul_f32 v250, v250, v21
    v_mul_f32 v251, v251, v21
    v_mul_f32 v252, v252, v21
    v_mul_f32 v253, v253, v21
    v_mul_f32 v254, v254, v21
    v_mul_f32 v255, v255, v21
    v_fma_f32 v104, v104, s28, v11
    v_fma_f32 v105, v105, s28, v11
    v_exp_f32 v104, v104
    v_exp_f32 v105, v105
    s_nop 0
    v_cvt_pk_bf16_f32 v30, v104, v105
    v_fma_f32 v106, v106, s28, v11
    v_fma_f32 v107, v107, s28, v11
    v_exp_f32 v106, v106
    v_exp_f32 v107, v107
    s_nop 0
    v_cvt_pk_bf16_f32 v31, v106, v107
    v_fma_f32 v108, v108, s28, v11
    v_fma_f32 v109, v109, s28, v11
    v_exp_f32 v108, v108
    v_exp_f32 v109, v109
    s_nop 0
    v_cvt_pk_bf16_f32 v28, v108, v109
    v_fma_f32 v110, v110, s28, v11
    v_fma_f32 v111, v111, s28, v11
    v_exp_f32 v110, v110
    v_exp_f32 v111, v111
    s_nop 0
    v_cvt_pk_bf16_f32 v29, v110, v111
    s_add_u32 s69, s39, 0
    buffer_load_dwordx4 v[48:51], v26, s[4:7], s69 offen offset:0
    s_waitcnt vmcnt(0)
    v_mfma_f32_16x16x32_bf16 v[104:107], v[48:51], a[168:171], 0
    s_nop 7
    buffer_load_dwordx4 v[48:51], v26, s[4:7], s69 offen offset:64
    s_waitcnt vmcnt(0)
    v_mfma_f32_16x16x32_bf16 v[104:107], v[48:51], a[172:175], v[104:107]
    s_nop 7
    buffer_load_dwordx4 v[48:51], v26, s[4:7], s69 offen offset:128
    s_waitcnt vmcnt(0)
    v_mfma_f32_16x16x32_bf16 v[104:107], v[48:51], a[176:179], v[104:107]
    s_nop 7
    buffer_load_dwordx4 v[48:51], v26, s[4:7], s69 offen offset:192
    s_waitcnt vmcnt(0)
    v_mfma_f32_16x16x32_bf16 v[104:107], v[48:51], a[180:183], v[104:107]
    s_nop 7
    buffer_load_dwordx4 v[48:51], v26, s[4:7], s69 offen offset:256
    s_waitcnt vmcnt(0)
    v_mfma_f32_16x16x32_bf16 v[104:107], v[48:51], a[184:187], v[104:107]
    s_nop 7
    buffer_load_dwordx4 v[48:51], v26, s[4:7], s69 offen offset:320
    s_waitcnt vmcnt(0)
    v_mfma_f32_16x16x32_bf16 v[104:107], v[48:51], a[188:191], v[104:107]
    s_nop 7
    s_add_u32 s69, s39, 6144
    buffer_load_dwordx4 v[48:51], v26, s[4:7], s69 offen offset:0
    s_waitcnt vmcnt(0)
    v_mfma_f32_16x16x32_bf16 v[108:111], v[48:51], a[168:171], 0
    s_nop 7
    buffer_load_dwordx4 v[48:51], v26, s[4:7], s69 offen offset:64
    s_waitcnt vmcnt(0)
    v_mfma_f32_16x16x32_bf16 v[108:111], v[48:51], a[172:175], v[108:111]
    s_nop 7
    buffer_load_dwordx4 v[48:51], v26, s[4:7], s69 offen offset:128
    s_waitcnt vmcnt(0)
    v_mfma_f32_16x16x32_bf16 v[108:111], v[48:51], a[176:179], v[108:111]
    s_nop 7
    buffer_load_dwordx4 v[48:51], v26, s[4:7], s69 offen offset:192
    s_waitcnt vmcnt(0)
    v_mfma_f32_16x16x32_bf16 v[108:111], v[48:51], a[180:183], v[108:111]
    s_nop 7
    buffer_load_dwordx4 v[48:51], v26, s[4:7], s69 offen offset:256
    s_waitcnt vmcnt(0)
    v_mfma_f32_16x16x32_bf16 v[108:111], v[48:51], a[184:187], v[108:111]
    s_nop 7
    buffer_load_dwordx4 v[48:51], v26, s[4:7], s69 offen offset:320
    s_waitcnt vmcnt(0)
    v_mfma_f32_16x16x32_bf16 v[108:111], v[48:51], a[188:191], v[108:111]
    s_nop 7
    s_nop 15
    v_max3_f32 v14, v104, v105, v106
    v_max3_f32 v14, v14, v107, v108
    v_max3_f32 v14, v14, v109, v110
    v_max_f32 v14, v14, v111
    v_mov_b32 v15, v14
    s_nop 1
    v_permlane32_swap_b32 v15, v14
    v_max_f32 v14, v14, v15
    v_mov_b32 v15, v14
    s_nop 1
    v_permlane16_swap_b32 v15, v14
    v_max_f32 v14, v14, v15
    v_fma_f32 v14, v14, s28, v12
    v_max_f32 v20, 0, v14
    v_sub_f32 v12, v12, v20
    v_sub_f32 v21, 0, v20
    v_exp_f32 v21, v21
    s_nop 0
    v_mul_f32 v47, v47, v21
    v_accvgpr_read_b32 v15, a0
    v_mul_f32 v15, v15, v21
    v_accvgpr_write_b32 a0, v15
    v_accvgpr_read_b32 v15, a1
    v_mul_f32 v15, v15, v21
    v_accvgpr_write_b32 a1, v15
    v_accvgpr_read_b32 v15, a2
    v_mul_f32 v15, v15, v21
    v_accvgpr_write_b32 a2, v15
    v_accvgpr_read_b32 v15, a3
    v_mul_f32 v15, v15, v21
    v_accvgpr_write_b32 a3, v15
    v_accvgpr_read_b32 v15, a4
    v_mul_f32 v15, v15, v21
    v_accvgpr_write_b32 a4, v15
    v_accvgpr_read_b32 v15, a5
    v_mul_f32 v15, v15, v21
    v_accvgpr_write_b32 a5, v15
    v_accvgpr_read_b32 v15, a6
    v_mul_f32 v15, v15, v21
    v_accvgpr_write_b32 a6, v15
    v_accvgpr_read_b32 v15, a7
    v_mul_f32 v15, v15, v21
    v_accvgpr_write_b32 a7, v15
    v_accvgpr_read_b32 v15, a8
    v_mul_f32 v15, v15, v21
    v_accvgpr_write_b32 a8, v15
    v_accvgpr_read_b32 v15, a9
    v_mul_f32 v15, v15, v21
    v_accvgpr_write_b32 a9, v15
    v_accvgpr_read_b32 v15, a10
    v_mul_f32 v15, v15, v21
    v_accvgpr_write_b32 a10, v15
    v_accvgpr_read_b32 v15, a11
    v_mul_f32 v15, v15, v21
    v_accvgpr_write_b32 a11, v15
    v_accvgpr_read_b32 v15, a12
    v_mul_f32 v15, v15, v21
    v_accvgpr_write_b32 a12, v15
    v_accvgpr_read_b32 v15, a13
    v_mul_f32 v15, v15, v21
    v_accvgpr_write_b32 a13, v15
    v_accvgpr_read_b32 v15, a14
    v_mul_f32 v15, v15, v21
    v_accvgpr_write_b32 a14, v15
    v_accvgpr_read_b32 v15, a15
    v_mul_f32 v15, v15, v21
    v_accvgpr_write_b32 a15, v15
    v_accvgpr_read_b32 v15, a16
    v_mul_f32 v15, v15, v21
    v_accvgpr_write_b32 a16, v15
    v_accvgpr_read_b32 v15, a17
    v_mul_f32 v15, v15, v21
    v_accvgpr_write_b32 a17, v15
    v_accvgpr_read_b32 v15, a18
    v_mul_f32 v15, v15, v21
    v_accvgpr_write_b32 a18, v15
    v_accvgpr_read_b32 v15, a19
    v_mul_f32 v15, v15, v21
    v_accvgpr_write_b32 a19, v15
    v_accvgpr_read_b32 v15, a20
    v_mul_f32 v15, v15, v21
    v_accvgpr_write_b32 a20, v15
    v_accvgpr_read_b32 v15, a21
    v_mul_f32 v15, v15, v21
    v_accvgpr_write_b32 a21, v15
    v_accvgpr_read_b32 v15, a22
    v_mul_f32 v15, v15, v21
    v_accvgpr_write_b32 a22, v15
    v_accvgpr_read_b32 v15, a23
    v_mul_f32 v15, v15, v21
    v_accvgpr_write_b32 a23, v15
    v_accvgpr_read_b32 v15, a24
    v_mul_f32 v15, v15, v21
    v_accvgpr_write_b32 a24, v15
    v_accvgpr_read_b32 v15, a25
    v_mul_f32 v15, v15, v21
    v_accvgpr_write_b32 a25, v15
    v_accvgpr_read_b32 v15, a26
    v_mul_f32 v15, v15, v21
    v_accvgpr_write_b32 a26, v15
    v_accvgpr_read_b32 v15, a27
    v_mul_f32 v15, v15, v21
    v_accvgpr_write_b32 a27, v15
    v_accvgpr_read_b32 v15, a28
    v_mul_f32 v15, v15, v21
    v_accvgpr_write_b32 a28, v15
    v_accvgpr_read_b32 v15, a29
    v_mul_f32 v15, v15, v21
    v_accvgpr_write_b32 a29, v15
    v_accvgpr_read_b32 v15, a30
    v_mul_f32 v15, v15, v21
    v_accvgpr_write_b32 a30, v15
    v_accvgpr_read_b32 v15, a31
    v_mul_f32 v15, v15, v21
    v_accvgpr_write_b32 a31, v15
    v_accvgpr_read_b32 v15, a32
    v_mul_f32 v15, v15, v21
    v_accvgpr_write_b32 a32, v15
    v_accvgpr_read_b32 v15, a33
    v_mul_f32 v15, v15, v21
    v_accvgpr_write_b32 a33, v15
    v_accvgpr_read_b32 v15, a34
    v_mul_f32 v15, v15, v21
    v_accvgpr_write_b32 a34, v15
    v_accvgpr_read_b32 v15, a35
    v_mul_f32 v15, v15, v21
    v_accvgpr_write_b32 a35, v15
    v_accvgpr_read_b32 v15, a36
    v_mul_f32 v15, v15, v21
    v_accvgpr_write_b32 a36, v15
    v_accvgpr_read_b32 v15, a37
    v_mul_f32 v15, v15, v21
    v_accvgpr_write_b32 a37, v15
    v_accvgpr_read_b32 v15, a38
    v_mul_f32 v15, v15, v21
    v_accvgpr_write_b32 a38, v15
    v_accvgpr_read_b32 v15, a39
    v_mul_f32 v15, v15, v21
    v_accvgpr_write_b32 a39, v15
    v_accvgpr_read_b32 v15, a40
    v_mul_f32 v15, v15, v21
    v_accvgpr_write_b32 a40, v15
    v_accvgpr_read_b32 v15, a41
    v_mul_f32 v15, v15, v21
    v_accvgpr_write_b32 a41, v15
    v_accvgpr_read_b32 v15, a42
    v_mul_f32 v15, v15, v21
    v_accvgpr_write_b32 a42, v15
    v_accvgpr_read_b32 v15, a43
    v_mul_f32 v15, v15, v21
    v_accvgpr_write_b32 a43, v15
    v_accvgpr_read_b32 v15, a44
    v_mul_f32 v15, v15, v21
    v_accvgpr_write_b32 a44, v15
    v_accvgpr_read_b32 v15, a45
    v_mul_f32 v15, v15, v21
    v_accvgpr_write_b32 a45, v15
    v_accvgpr_read_b32 v15, a46
    v_mul_f32 v15, v15, v21
    v_accvgpr_write_b32 a46, v15
    v_accvgpr_read_b32 v15, a47
    v_mul_f32 v15, v15, v21
    v_accvgpr_write_b32 a47, v15
    v_fma_f32 v104, v104, s28, v12
    v_fma_f32 v105, v105, s28, v12
    v_exp_f32 v104, v104
    v_exp_f32 v105, v105
    s_nop 0
    v_cvt_pk_bf16_f32 v36, v104, v105
    v_fma_f32 v106, v106, s28, v12
    v_fma_f32 v107, v107, s28, v12
    v_exp_f32 v106, v106
    v_exp_f32 v107, v107
    s_nop 0
    v_cvt_pk_bf16_f32 v37, v106, v107
    v_fma_f32 v108, v108, s28, v12
    v_fma_f32 v109, v109, s28, v12
    v_exp_f32 v108, v108
    v_exp_f32 v109, v109
    s_nop 0
    v_cvt_pk_bf16_f32 v34, v108, v109
    v_fma_f32 v110, v110, s28, v12
    v_fma_f32 v111, v111, s28, v12
    v_exp_f32 v110, v110
    v_exp_f32 v111, v111
    s_nop 0
    v_cvt_pk_bf16_f32 v35, v110, v111
    s_add_u32 s69, s39, 0
    buffer_load_dwordx4 v[48:51], v26, s[4:7], s69 offen offset:0
    s_waitcnt vmcnt(0)
    v_mfma_f32_16x16x32_bf16 v[104:107], v[48:51], a[192:195], 0
    s_nop 7
    buffer_load_dwordx4 v[48:51], v26, s[4:7], s69 offen offset:64
    s_waitcnt vmcnt(0)
    v_mfma_f32_16x16x32_bf16 v[104:107], v[48:51], a[196:199], v[104:107]
    s_nop 7
    buffer_load_dwordx4 v[48:51], v26, s[4:7], s69 offen offset:128
    s_waitcnt vmcnt(0)
    v_mfma_f32_16x16x32_bf16 v[104:107], v[48:51], a[200:203], v[104:107]
    s_nop 7
    buffer_load_dwordx4 v[48:51], v26, s[4:7], s69 offen offset:192
    s_waitcnt vmcnt(0)
    v_mfma_f32_16x16x32_bf16 v[104:107], v[48:51], a[204:207], v[104:107]
    s_nop 7
    buffer_load_dwordx4 v[48:51], v26, s[4:7], s69 offen offset:256
    s_waitcnt vmcnt(0)
    v_mfma_f32_16x16x32_bf16 v[104:107], v[48:51], a[208:211], v[104:107]
    s_nop 7
    buffer_load_dwordx4 v[48:51], v26, s[4:7], s69 offen offset:320
    s_waitcnt vmcnt(0)
    v_mfma_f32_16x16x32_bf16 v[104:107], v[48:51], v[92:95], v[104:107]
    s_nop 7
    s_add_u32 s69, s39, 6144
    buffer_load_dwordx4 v[48:51], v26, s[4:7], s69 offen offset:0
    s_waitcnt vmcnt(0)
    v_mfma_f32_16x16x32_bf16 v[108:111], v[48:51], a[192:195], 0
    s_nop 7
    buffer_load_dwordx4 v[48:51], v26, s[4:7], s69 offen offset:64
    s_waitcnt vmcnt(0)
    v_mfma_f32_16x16x32_bf16 v[108:111], v[48:51], a[196:199], v[108:111]
    s_nop 7
    buffer_load_dwordx4 v[48:51], v26, s[4:7], s69 offen offset:128
    s_waitcnt vmcnt(0)
    v_mfma_f32_16x16x32_bf16 v[108:111], v[48:51], a[200:203], v[108:111]
    s_nop 7
    buffer_load_dwordx4 v[48:51], v26, s[4:7], s69 offen offset:192
    s_waitcnt vmcnt(0)
    v_mfma_f32_16x16x32_bf16 v[108:111], v[48:51], a[204:207], v[108:111]
    s_nop 7
    buffer_load_dwordx4 v[48:51], v26, s[4:7], s69 offen offset:256
    s_waitcnt vmcnt(0)
    v_mfma_f32_16x16x32_bf16 v[108:111], v[48:51], a[208:211], v[108:111]
    s_nop 7
    buffer_load_dwordx4 v[48:51], v26, s[4:7], s69 offen offset:320
    s_waitcnt vmcnt(0)
    v_mfma_f32_16x16x32_bf16 v[108:111], v[48:51], v[92:95], v[108:111]
    s_nop 7
    s_nop 15
    v_max3_f32 v14, v104, v105, v106
    v_max3_f32 v14, v14, v107, v108
    v_max3_f32 v14, v14, v109, v110
    v_max_f32 v14, v14, v111
    v_mov_b32 v15, v14
    s_nop 1
    v_permlane32_swap_b32 v15, v14
    v_max_f32 v14, v14, v15
    v_mov_b32 v15, v14
    s_nop 1
    v_permlane16_swap_b32 v15, v14
    v_max_f32 v14, v14, v15
    v_fma_f32 v14, v14, s28, v13
    v_max_f32 v20, 0, v14
    v_sub_f32 v13, v13, v20
    v_sub_f32 v21, 0, v20
    v_exp_f32 v21, v21
    s_nop 0
    v_mul_f32 v15, v44, v21
    v_cndmask_b32_e64 v44, v44, v15, s[60:61]
    v_accvgpr_read_b32 v15, a48
    v_mul_f32 v15, v15, v21
    v_accvgpr_write_b32 a48, v15
    v_accvgpr_read_b32 v15, a49
    v_mul_f32 v15, v15, v21
    v_accvgpr_write_b32 a49, v15
    v_accvgpr_read_b32 v15, a50
    v_mul_f32 v15, v15, v21
    v_accvgpr_write_b32 a50, v15
    v_accvgpr_read_b32 v15, a51
    v_mul_f32 v15, v15, v21
    v_accvgpr_write_b32 a51, v15
    v_accvgpr_read_b32 v15, a52
    v_mul_f32 v15, v15, v21
    v_accvgpr_write_b32 a52, v15
    v_accvgpr_read_b32 v15, a53
    v_mul_f32 v15, v15, v21
    v_accvgpr_write_b32 a53, v15
    v_accvgpr_read_b32 v15, a54
    v_mul_f32 v15, v15, v21
    v_accvgpr_write_b32 a54, v15
    v_accvgpr_read_b32 v15, a55
    v_mul_f32 v15, v15, v21
    v_accvgpr_write_b32 a55, v15
    v_accvgpr_read_b32 v15, a56
    v_mul_f32 v15, v15, v21
    v_accvgpr_write_b32 a56, v15
    v_accvgpr_read_b32 v15, a57
    v_mul_f32 v15, v15, v21
    v_accvgpr_write_b32 a57, v15
    v_accvgpr_read_b32 v15, a58
    v_mul_f32 v15, v15, v21
    v_accvgpr_write_b32 a58, v15
    v_accvgpr_read_b32 v15, a59
    v_mul_f32 v15, v15, v21
    v_accvgpr_write_b32 a59, v15
    v_accvgpr_read_b32 v15, a60
    v_mul_f32 v15, v15, v21
    v_accvgpr_write_b32 a60, v15
    v_accvgpr_read_b32 v15, a61
    v_mul_f32 v15, v15, v21
    v_accvgpr_write_b32 a61, v15
    v_accvgpr_read_b32 v15, a62
    v_mul_f32 v15, v15, v21
    v_accvgpr_write_b32 a62, v15
    v_accvgpr_read_b32 v15, a63
    v_mul_f32 v15, v15, v21
    v_accvgpr_write_b32 a63, v15
    v_accvgpr_read_b32 v15, a64
    v_mul_f32 v15, v15, v21
    v_accvgpr_write_b32 a64, v15
    v_accvgpr_read_b32 v15, a65
    v_mul_f32 v15, v15, v21
    v_accvgpr_write_b32 a65, v15
    v_accvgpr_read_b32 v15, a66
    v_mul_f32 v15, v15, v21
    v_accvgpr_write_b32 a66, v15
    v_accvgpr_read_b32 v15, a67
    v_mul_f32 v15, v15, v21
    v_accvgpr_write_b32 a67, v15
    v_accvgpr_read_b32 v15, a68
    v_mul_f32 v15, v15, v21
    v_accvgpr_write_b32 a68, v15
    v_accvgpr_read_b32 v15, a69
    v_mul_f32 v15, v15, v21
    v_accvgpr_write_b32 a69, v15
    v_accvgpr_read_b32 v15, a70
    v_mul_f32 v15, v15, v21
    v_accvgpr_write_b32 a70, v15
    v_accvgpr_read_b32 v15, a71
    v_mul_f32 v15, v15, v21
    v_accvgpr_write_b32 a71, v15
    v_accvgpr_read_b32 v15, a72
    v_mul_f32 v15, v15, v21
    v_accvgpr_write_b32 a72, v15
    v_accvgpr_read_b32 v15, a73
    v_mul_f32 v15, v15, v21
    v_accvgpr_write_b32 a73, v15
    v_accvgpr_read_b32 v15, a74
    v_mul_f32 v15, v15, v21
    v_accvgpr_write_b32 a74, v15
    v_accvgpr_read_b32 v15, a75
    v_mul_f32 v15, v15, v21
    v_accvgpr_write_b32 a75, v15
    v_accvgpr_read_b32 v15, a76
    v_mul_f32 v15, v15, v21
    v_accvgpr_write_b32 a76, v15
    v_accvgpr_read_b32 v15, a77
    v_mul_f32 v15, v15, v21
    v_accvgpr_write_b32 a77, v15
    v_accvgpr_read_b32 v15, a78
    v_mul_f32 v15, v15, v21
    v_accvgpr_write_b32 a78, v15
    v_accvgpr_read_b32 v15, a79
    v_mul_f32 v15, v15, v21
    v_accvgpr_write_b32 a79, v15
    v_accvgpr_read_b32 v15, a80
    v_mul_f32 v15, v15, v21
    v_accvgpr_write_b32 a80, v15
    v_accvgpr_read_b32 v15, a81
    v_mul_f32 v15, v15, v21
    v_accvgpr_write_b32 a81, v15
    v_accvgpr_read_b32 v15, a82
    v_mul_f32 v15, v15, v21
    v_accvgpr_write_b32 a82, v15
    v_accvgpr_read_b32 v15, a83
    v_mul_f32 v15, v15, v21
    v_accvgpr_write_b32 a83, v15
    v_accvgpr_read_b32 v15, a84
    v_mul_f32 v15, v15, v21
    v_accvgpr_write_b32 a84, v15
    v_accvgpr_read_b32 v15, a85
    v_mul_f32 v15, v15, v21
    v_accvgpr_write_b32 a85, v15
    v_accvgpr_read_b32 v15, a86
    v_mul_f32 v15, v15, v21
    v_accvgpr_write_b32 a86, v15
    v_accvgpr_read_b32 v15, a87
    v_mul_f32 v15, v15, v21
    v_accvgpr_write_b32 a87, v15
    v_accvgpr_read_b32 v15, a88
    v_mul_f32 v15, v15, v21
    v_accvgpr_write_b32 a88, v15
    v_accvgpr_read_b32 v15, a89
    v_mul_f32 v15, v15, v21
    v_accvgpr_write_b32 a89, v15
    v_accvgpr_read_b32 v15, a90
    v_mul_f32 v15, v15, v21
    v_accvgpr_write_b32 a90, v15
    v_accvgpr_read_b32 v15, a91
    v_mul_f32 v15, v15, v21
    v_accvgpr_write_b32 a91, v15
    v_accvgpr_read_b32 v15, a92
    v_mul_f32 v15, v15, v21
    v_accvgpr_write_b32 a92, v15
    v_accvgpr_read_b32 v15, a93
    v_mul_f32 v15, v15, v21
    v_accvgpr_write_b32 a93, v15
    v_accvgpr_read_b32 v15, a94
    v_mul_f32 v15, v15, v21
    v_accvgpr_write_b32 a94, v15
    v_accvgpr_read_b32 v15, a95
    v_mul_f32 v15, v15, v21
    v_accvgpr_write_b32 a95, v15
    v_fma_f32 v104, v104, s28, v13
    v_fma_f32 v105, v105, s28, v13
    v_exp_f32 v104, v104
    v_exp_f32 v105, v105
    s_nop 0
    v_cvt_pk_bf16_f32 v42, v104, v105
    v_fma_f32 v106, v106, s28, v13
    v_fma_f32 v107, v107, s28, v13
    v_exp_f32 v106, v106
    v_exp_f32 v107, v107
    s_nop 0
    v_cvt_pk_bf16_f32 v43, v106, v107
    v_fma_f32 v108, v108, s28, v13
    v_fma_f32 v109, v109, s28, v13
    v_exp_f32 v108, v108
    v_exp_f32 v109, v109
    s_nop 0
    v_cvt_pk_bf16_f32 v40, v108, v109
    v_fma_f32 v110, v110, s28, v13
    v_fma_f32 v111, v111, s28, v13
    v_exp_f32 v110, v110
    v_exp_f32 v111, v111
    s_nop 0
    v_cvt_pk_bf16_f32 v41, v110, v111
    v_mfma_f32_16x16x32_bf16 v[48:51], a[236:239], v[16:19], v[44:47]
    v_mfma_f32_16x16x32_bf16 v[48:51], a[240:243], v[22:25], v[48:51]
    v_mfma_f32_16x16x32_bf16 v[48:51], a[244:247], v[28:31], v[48:51]
    v_mfma_f32_16x16x32_bf16 v[48:51], a[248:251], v[34:37], v[48:51]
    v_mfma_f32_16x16x32_bf16 v[48:51], a[252:255], v[40:43], v[48:51]
    s_nop 15
    s_setpc_b64 s[40:41]
L_rare4_0:
    s_nop 15
    v_mbcnt_lo_u32_b32 v31, -1, 0
    v_mbcnt_hi_u32_b32 v31, -1, v31
    v_and_b32 v30, 15, v31
    v_mul_u32_u24 v30, 384, v30
    v_lshrrev_b32 v31, 4, v31
    v_lshl_add_u32 v30, v31, 4, v30
    s_add_u32 s69, s39, 0
    buffer_load_dwordx4 v[44:47], v30, s[4:7], s69 offen offset:0
    s_waitcnt vmcnt(0)
    v_mfma_f32_16x16x32_bf16 v[104:107], v[44:47], a[96:99], 0
    s_nop 7
    buffer_load_dwordx4 v[44:47], v30, s[4:7], s69 offen offset:64
    s_waitcnt vmcnt(0)
    v_mfma_f32_16x16x32_bf16 v[104:107], v[44:47], a[100:103], v[104:107]
    s_nop 7
    buffer_load_dwordx4 v[44:47], v30, s[4:7], s69 offen offset:128
    s_waitcnt vmcnt(0)
    v_mfma_f32_16x16x32_bf16 v[104:107], v[44:47], a[104:107], v[104:107]
    s_nop 7
    buffer_load_dwordx4 v[44:47], v30, s[4:7], s69 offen offset:192
    s_waitcnt vmcnt(0)
    v_mfma_f32_16x16x32_bf16 v[104:107], v[44:47], a[108:111], v[104:107]
    s_nop 7
    buffer_load_dwordx4 v[44:47], v30, s[4:7], s69 offen offset:256
    s_waitcnt vmcnt(0)
    v_mfma_f32_16x16x32_bf16 v[104:107], v[44:47], a[112:115], v[104:107]
    s_nop 7
    buffer_load_dwordx4 v[44:47], v30, s[4:7], s69 offen offset:320
    s_waitcnt vmcnt(0)
    v_mfma_f32_16x16x32_bf16 v[104:107], v[44:47], a[116:119], v[104:107]
    s_nop 7
    s_add_u32 s69, s39, 6144
    buffer_load_dwordx4 v[44:47], v30, s[4:7], s69 offen offset:0
    s_waitcnt vmcnt(0)
    v_mfma_f32_16x16x32_bf16 v[108:111], v[44:47], a[96:99], 0
    s_nop 7
    buffer_load_dwordx4 v[44:47], v30, s[4:7], s69 offen offset:64
    s_waitcnt vmcnt(0)
    v_mfma_f32_16x16x32_bf16 v[108:111], v[44:47], a[100:103], v[108:111]
    s_nop 7
    buffer_load_dwordx4 v[44:47], v30, s[4:7], s69 offen offset:128
    s_waitcnt vmcnt(0)
    v_mfma_f32_16x16x32_bf16 v[108:111], v[44:47], a[104:107], v[108:111]
    s_nop 7
    buffer_load_dwordx4 v[44:47], v30, s[4:7], s69 offen offset:192
    s_waitcnt vmcnt(0)
    v_mfma_f32_16x16x32_bf16 v[108:111], v[44:47], a[108:111], v[108:111]
    s_nop 7
    buffer_load_dwordx4 v[44:47], v30, s[4:7], s69 offen offset:256
    s_waitcnt vmcnt(0)
    v_mfma_f32_16x16x32_bf16 v[108:111], v[44:47], a[112:115], v[108:111]
    s_nop 7
    buffer_load_dwordx4 v[44:47], v30, s[4:7], s69 offen offset:320
    s_waitcnt vmcnt(0)
    v_mfma_f32_16x16x32_bf16 v[108:111], v[44:47], a[116:119], v[108:111]
    s_nop 7
    s_nop 15
    v_max3_f32 v18, v104, v105, v106
    v_max3_f32 v18, v18, v107, v108
    v_max3_f32 v18, v18, v109, v110
    v_max_f32 v18, v18, v111
    v_mov_b32 v19, v18
    s_nop 1
    v_permlane32_swap_b32 v19, v18
    v_max_f32 v18, v18, v19
    v_mov_b32 v19, v18
    s_nop 1
    v_permlane16_swap_b32 v19, v18
    v_max_f32 v18, v18, v19
    v_fma_f32 v18, v18, s28, v9
    v_max_f32 v24, 0, v18
    v_sub_f32 v9, v9, v24
    v_sub_f32 v25, 0, v24
    v_exp_f32 v25, v25
    s_nop 0
    v_mul_f32 v19, v48, v25
    v_cndmask_b32_e64 v48, v19, v48, s[60:61]
    v_cndmask_b32_e64 v48, v48, 0, s[46:47]
    v_mul_f32 v112, v112, v25
    v_mul_f32 v113, v113, v25
    v_mul_f32 v114, v114, v25
    v_mul_f32 v115, v115, v25
    v_mul_f32 v116, v116, v25
    v_mul_f32 v117, v117, v25
    v_mul_f32 v118, v118, v25
    v_mul_f32 v119, v119, v25
    v_mul_f32 v120, v120, v25
    v_mul_f32 v121, v121, v25
    v_mul_f32 v122, v122, v25
    v_mul_f32 v123, v123, v25
    v_mul_f32 v124, v124, v25
    v_mul_f32 v125, v125, v25
    v_mul_f32 v126, v126, v25
    v_mul_f32 v127, v127, v25
    v_mul_f32 v128, v128, v25
    v_mul_f32 v129, v129, v25
    v_mul_f32 v130, v130, v25
    v_mul_f32 v131, v131, v25
    v_mul_f32 v132, v132, v25
    v_mul_f32 v133, v133, v25
    v_mul_f32 v134, v134, v25
    v_mul_f32 v135, v135, v25
    v_mul_f32 v136, v136, v25
    v_mul_f32 v137, v137, v25
    v_mul_f32 v138, v138, v25
    v_mul_f32 v139, v139, v25
    v_mul_f32 v140, v140, v25
    v_mul_f32 v141, v141, v25
    v_mul_f32 v142, v142, v25
    v_mul_f32 v143, v143, v25
    v_mul_f32 v144, v144, v25
    v_mul_f32 v145, v145, v25
    v_mul_f32 v146, v146, v25
    v_mul_f32 v147, v147, v25
    v_mul_f32 v148, v148, v25
    v_mul_f32 v149, v149, v25
    v_mul_f32 v150, v150, v25
    v_mul_f32 v151, v151, v25
    v_mul_f32 v152, v152, v25
    v_mul_f32 v153, v153, v25
    v_mul_f32 v154, v154, v25
    v_mul_f32 v155, v155, v25
    v_mul_f32 v156, v156, v25
    v_mul_f32 v157, v157, v25
    v_mul_f32 v158, v158, v25
    v_mul_f32 v159, v159, v25
    v_fma_f32 v104, v104, s28, v9
    v_fma_f32 v105, v105, s28, v9
    v_exp_f32 v104, v104
    v_exp_f32 v105, v105
    s_nop 0
    v_cvt_pk_bf16_f32 v14, v104, v105
    v_fma_f32 v106, v106, s28, v9
    v_fma_f32 v107, v107, s28, v9
    v_exp_f32 v106, v106
    v_exp_f32 v107, v107
    s_nop 0
    v_cvt_pk_bf16_f32 v15, v106, v107
    v_fma_f32 v108, v108, s28, v9
    v_fma_f32 v109, v109, s28, v9
    v_exp_f32 v108, v108
    v_exp_f32 v109, v109
    s_nop 0
    v_cvt_pk_bf16_f32 v16, v108, v109
    v_fma_f32 v110, v110, s28, v9
    v_fma_f32 v111, v111, s28, v9
    v_exp_f32 v110, v110
    v_exp_f32 v111, v111
    s_nop 0
    v_cvt_pk_bf16_f32 v17, v110, v111
    s_add_u32 s69, s39, 0
    buffer_load_dwordx4 v[44:47], v30, s[4:7], s69 offen offset:0
    s_waitcnt vmcnt(0)
    v_mfma_f32_16x16x32_bf16 v[104:107], v[44:47], a[120:123], 0
    s_nop 7
    buffer_load_dwordx4 v[44:47], v30, s[4:7], s69 offen offset:64
    s_waitcnt vmcnt(0)
    v_mfma_f32_16x16x32_bf16 v[104:107], v[44:47], a[124:127], v[104:107]
    s_nop 7
    buffer_load_dwordx4 v[44:47], v30, s[4:7], s69 offen offset:128
    s_waitcnt vmcnt(0)
    v_mfma_f32_16x16x32_bf16 v[104:107], v[44:47], a[128:131], v[104:107]
    s_nop 7
    buffer_load_dwordx4 v[44:47], v30, s[4:7], s69 offen offset:192
    s_waitcnt vmcnt(0)
    v_mfma_f32_16x16x32_bf16 v[104:107], v[44:47], a[132:135], v[104:107]
    s_nop 7
    buffer_load_dwordx4 v[44:47], v30, s[4:7], s69 offen offset:256
    s_waitcnt vmcnt(0)
    v_mfma_f32_16x16x32_bf16 v[104:107], v[44:47], a[136:139], v[104:107]
    s_nop 7
    buffer_load_dwordx4 v[44:47], v30, s[4:7], s69 offen offset:320
    s_waitcnt vmcnt(0)
    v_mfma_f32_16x16x32_bf16 v[104:107], v[44:47], a[140:143], v[104:107]
    s_nop 7
    s_add_u32 s69, s39, 6144
    buffer_load_dwordx4 v[44:47], v30, s[4:7], s69 offen offset:0
    s_waitcnt vmcnt(0)
    v_mfma_f32_16x16x32_bf16 v[108:111], v[44:47], a[120:123], 0
    s_nop 7
    buffer_load_dwordx4 v[44:47], v30, s[4:7], s69 offen offset:64
    s_waitcnt vmcnt(0)
    v_mfma_f32_16x16x32_bf16 v[108:111], v[44:47], a[124:127], v[108:111]
    s_nop 7
    buffer_load_dwordx4 v[44:47], v30, s[4:7], s69 offen offset:128
    s_waitcnt vmcnt(0)
    v_mfma_f32_16x16x32_bf16 v[108:111], v[44:47], a[128:131], v[108:111]
    s_nop 7
    buffer_load_dwordx4 v[44:47], v30, s[4:7], s69 offen offset:192
    s_waitcnt vmcnt(0)
    v_mfma_f32_16x16x32_bf16 v[108:111], v[44:47], a[132:135], v[108:111]
    s_nop 7
    buffer_load_dwordx4 v[44:47], v30, s[4:7], s69 offen offset:256
    s_waitcnt vmcnt(0)
    v_mfma_f32_16x16x32_bf16 v[108:111], v[44:47], a[136:139], v[108:111]
    s_nop 7
    buffer_load_dwordx4 v[44:47], v30, s[4:7], s69 offen offset:320
    s_waitcnt vmcnt(0)
    v_mfma_f32_16x16x32_bf16 v[108:111], v[44:47], a[140:143], v[108:111]
    s_nop 7
    s_nop 15
    v_max3_f32 v18, v104, v105, v106
    v_max3_f32 v18, v18, v107, v108
    v_max3_f32 v18, v18, v109, v110
    v_max_f32 v18, v18, v111
    v_mov_b32 v19, v18
    s_nop 1
    v_permlane32_swap_b32 v19, v18
    v_max_f32 v18, v18, v19
    v_mov_b32 v19, v18
    s_nop 1
    v_permlane16_swap_b32 v19, v18
    v_max_f32 v18, v18, v19
    v_fma_f32 v18, v18, s28, v10
    v_max_f32 v24, 0, v18
    v_sub_f32 v10, v10, v24
    v_sub_f32 v25, 0, v24
    v_exp_f32 v25, v25
    s_nop 0
    v_mul_f32 v49, v49, v25
    v_mul_f32 v160, v160, v25
    v_mul_f32 v161, v161, v25
    v_mul_f32 v162, v162, v25
    v_mul_f32 v163, v163, v25
    v_mul_f32 v164, v164, v25
    v_mul_f32 v165, v165, v25
    v_mul_f32 v166, v166, v25
    v_mul_f32 v167, v167, v25
    v_mul_f32 v168, v168, v25
    v_mul_f32 v169, v169, v25
    v_mul_f32 v170, v170, v25
    v_mul_f32 v171, v171, v25
    v_mul_f32 v172, v172, v25
    v_mul_f32 v173, v173, v25
    v_mul_f32 v174, v174, v25
    v_mul_f32 v175, v175, v25
    v_mul_f32 v176, v176, v25
    v_mul_f32 v177, v177, v25
    v_mul_f32 v178, v178, v25
    v_mul_f32 v179, v179, v25
    v_mul_f32 v180, v180, v25
    v_mul_f32 v181, v181, v25
    v_mul_f32 v182, v182, v25
    v_mul_f32 v183, v183, v25
    v_mul_f32 v184, v184, v25
    v_mul_f32 v185, v185, v25
    v_mul_f32 v186, v186, v25
    v_mul_f32 v187, v187, v25
    v_mul_f32 v188, v188, v25
    v_mul_f32 v189, v189, v25
    v_mul_f32 v190, v190, v25
    v_mul_f32 v191, v191, v25
    v_mul_f32 v192, v192, v25
    v_mul_f32 v193, v193, v25
    v_mul_f32 v194, v194, v25
    v_mul_f32 v195, v195, v25
    v_mul_f32 v196, v196, v25
    v_mul_f32 v197, v197, v25
    v_mul_f32 v198, v198, v25
    v_mul_f32 v199, v199, v25
    v_mul_f32 v200, v200, v25
    v_mul_f32 v201, v201, v25
    v_mul_f32 v202, v202, v25
    v_mul_f32 v203, v203, v25
    v_mul_f32 v204, v204, v25
    v_mul_f32 v205, v205, v25
    v_mul_f32 v206, v206, v25
    v_mul_f32 v207, v207, v25
    v_fma_f32 v104, v104, s28, v10
    v_fma_f32 v105, v105, s28, v10
    v_exp_f32 v104, v104
    v_exp_f32 v105, v105
    s_nop 0
    v_cvt_pk_bf16_f32 v20, v104, v105
    v_fma_f32 v106, v106, s28, v10
    v_fma_f32 v107, v107, s28, v10
    v_exp_f32 v106, v106
    v_exp_f32 v107, v107
    s_nop 0
    v_cvt_pk_bf16_f32 v21, v106, v107
    v_fma_f32 v108, v108, s28, v10
    v_fma_f32 v109, v109, s28, v10
    v_exp_f32 v108, v108
    v_exp_f32 v109, v109
    s_nop 0
    v_cvt_pk_bf16_f32 v22, v108, v109
    v_fma_f32 v110, v110, s28, v10
    v_fma_f32 v111, v111, s28, v10
    v_exp_f32 v110, v110
    v_exp_f32 v111, v111
    s_nop 0
    v_cvt_pk_bf16_f32 v23, v110, v111
    s_add_u32 s69, s39, 0
    buffer_load_dwordx4 v[44:47], v30, s[4:7], s69 offen offset:0
    s_waitcnt vmcnt(0)
    v_mfma_f32_16x16x32_bf16 v[104:107], v[44:47], a[144:147], 0
    s_nop 7
    buffer_load_dwordx4 v[44:47], v30, s[4:7], s69 offen offset:64
    s_waitcnt vmcnt(0)
    v_mfma_f32_16x16x32_bf16 v[104:107], v[44:47], a[148:151], v[104:107]
    s_nop 7
    buffer_load_dwordx4 v[44:47], v30, s[4:7], s69 offen offset:128
    s_waitcnt vmcnt(0)
    v_mfma_f32_16x16x32_bf16 v[104:107], v[44:47], a[152:155], v[104:107]
    s_nop 7
    buffer_load_dwordx4 v[44:47], v30, s[4:7], s69 offen offset:192
    s_waitcnt vmcnt(0)
    v_mfma_f32_16x16x32_bf16 v[104:107], v[44:47], a[156:159], v[104:107]
    s_nop 7
    buffer_load_dwordx4 v[44:47], v30, s[4:7], s69 offen offset:256
    s_waitcnt vmcnt(0)
    v_mfma_f32_16x16x32_bf16 v[104:107], v[44:47], a[160:163], v[104:107]
    s_nop 7
    buffer_load_dwordx4 v[44:47], v30, s[4:7], s69 offen offset:320
    s_waitcnt vmcnt(0)
    v_mfma_f32_16x16x32_bf16 v[104:107], v[44:47], a[164:167], v[104:107]
    s_nop 7
    s_add_u32 s69, s39, 6144
    buffer_load_dwordx4 v[44:47], v30, s[4:7], s69 offen offset:0
    s_waitcnt vmcnt(0)
    v_mfma_f32_16x16x32_bf16 v[108:111], v[44:47], a[144:147], 0
    s_nop 7
    buffer_load_dwordx4 v[44:47], v30, s[4:7], s69 offen offset:64
    s_waitcnt vmcnt(0)
    v_mfma_f32_16x16x32_bf16 v[108:111], v[44:47], a[148:151], v[108:111]
    s_nop 7
    buffer_load_dwordx4 v[44:47], v30, s[4:7], s69 offen offset:128
    s_waitcnt vmcnt(0)
    v_mfma_f32_16x16x32_bf16 v[108:111], v[44:47], a[152:155], v[108:111]
    s_nop 7
    buffer_load_dwordx4 v[44:47], v30, s[4:7], s69 offen offset:192
    s_waitcnt vmcnt(0)
    v_mfma_f32_16x16x32_bf16 v[108:111], v[44:47], a[156:159], v[108:111]
    s_nop 7
    buffer_load_dwordx4 v[44:47], v30, s[4:7], s69 offen offset:256
    s_waitcnt vmcnt(0)
    v_mfma_f32_16x16x32_bf16 v[108:111], v[44:47], a[160:163], v[108:111]
    s_nop 7
    buffer_load_dwordx4 v[44:47], v30, s[4:7], s69 offen offset:320
    s_waitcnt vmcnt(0)
    v_mfma_f32_16x16x32_bf16 v[108:111], v[44:47], a[164:167], v[108:111]
    s_nop 7
    s_nop 15
    v_max3_f32 v18, v104, v105, v106
    v_max3_f32 v18, v18, v107, v108
    v_max3_f32 v18, v18, v109, v110
    v_max_f32 v18, v18, v111
    v_mov_b32 v19, v18
    s_nop 1
    v_permlane32_swap_b32 v19, v18
    v_max_f32 v18, v18, v19
    v_mov_b32 v19, v18
    s_nop 1
    v_permlane16_swap_b32 v19, v18
    v_max_f32 v18, v18, v19
    v_fma_f32 v18, v18, s28, v11
    v_max_f32 v24, 0, v18
    v_sub_f32 v11, v11, v24
    v_sub_f32 v25, 0, v24
    v_exp_f32 v25, v25
    s_nop 0
    v_mul_f32 v50, v50, v25
    v_mul_f32 v208, v208, v25
    v_mul_f32 v209, v209, v25
    v_mul_f32 v210, v210, v25
    v_mul_f32 v211, v211, v25
    v_mul_f32 v212, v212, v25
    v_mul_f32 v213, v213, v25
    v_mul_f32 v214, v214, v25
    v_mul_f32 v215, v215, v25
    v_mul_f32 v216, v216, v25
    v_mul_f32 v217, v217, v25
    v_mul_f32 v218, v218, v25
    v_mul_f32 v219, v219, v25
    v_mul_f32 v220, v220, v25
    v_mul_f32 v221, v221, v25
    v_mul_f32 v222, v222, v25
    v_mul_f32 v223, v223, v25
    v_mul_f32 v224, v224, v25
    v_mul_f32 v225, v225, v25
    v_mul_f32 v226, v226, v25
    v_mul_f32 v227, v227, v25
    v_mul_f32 v228, v228, v25
    v_mul_f32 v229, v229, v25
    v_mul_f32 v230, v230, v25
    v_mul_f32 v231, v231, v25
    v_mul_f32 v232, v232, v25
    v_mul_f32 v233, v233, v25
    v_mul_f32 v234, v234, v25
    v_mul_f32 v235, v235, v25
    v_mul_f32 v236, v236, v25
    v_mul_f32 v237, v237, v25
    v_mul_f32 v238, v238, v25
    v_mul_f32 v239, v239, v25
    v_mul_f32 v240, v240, v25
    v_mul_f32 v241, v241, v25
    v_mul_f32 v242, v242, v25
    v_mul_f32 v243, v243, v25
    v_mul_f32 v244, v244, v25
    v_mul_f32 v245, v245, v25
    v_mul_f32 v246, v246, v25
    v_mul_f32 v247, v247, v25
    v_mul_f32 v248, v248, v25
    v_mul_f32 v249, v249, v25
    v_mul_f32 v250, v250, v25
    v_mul_f32 v251, v251, v25
    v_mul_f32 v252, v252, v25
    v_mul_f32 v253, v253, v25
    v_mul_f32 v254, v254, v25
    v_mul_f32 v255, v255, v25
    v_fma_f32 v104, v104, s28, v11
    v_fma_f32 v105, v105, s28, v11
    v_exp_f32 v104, v104
    v_exp_f32 v105, v105
    s_nop 0
    v_cvt_pk_bf16_f32 v26, v104, v105
    v_fma_f32 v106, v106, s28, v11
    v_fma_f32 v107, v107, s28, v11
    v_exp_f32 v106, v106
    v_exp_f32 v107, v107
    s_nop 0
    v_cvt_pk_bf16_f32 v27, v106, v107
    v_fma_f32 v108, v108, s28, v11
    v_fma_f32 v109, v109, s28, v11
    v_exp_f32 v108, v108
    v_exp_f32 v109, v109
    s_nop 0
    v_cvt_pk_bf16_f32 v28, v108, v109
    v_fma_f32 v110, v110, s28, v11
    v_fma_f32 v111, v111, s28, v11
    v_exp_f32 v110, v110
    v_exp_f32 v111, v111
    s_nop 0
    v_cvt_pk_bf16_f32 v29, v110, v111
    s_add_u32 s69, s39, 0
    buffer_load_dwordx4 v[44:47], v30, s[4:7], s69 offen offset:0
    s_waitcnt vmcnt(0)
    v_mfma_f32_16x16x32_bf16 v[104:107], v[44:47], a[168:171], 0
    s_nop 7
    buffer_load_dwordx4 v[44:47], v30, s[4:7], s69 offen offset:64
    s_waitcnt vmcnt(0)
    v_mfma_f32_16x16x32_bf16 v[104:107], v[44:47], a[172:175], v[104:107]
    s_nop 7
    buffer_load_dwordx4 v[44:47], v30, s[4:7], s69 offen offset:128
    s_waitcnt vmcnt(0)
    v_mfma_f32_16x16x32_bf16 v[104:107], v[44:47], a[176:179], v[104:107]
    s_nop 7
    buffer_load_dwordx4 v[44:47], v30, s[4:7], s69 offen offset:192
    s_waitcnt vmcnt(0)
    v_mfma_f32_16x16x32_bf16 v[104:107], v[44:47], a[180:183], v[104:107]
    s_nop 7
    buffer_load_dwordx4 v[44:47], v30, s[4:7], s69 offen offset:256
    s_waitcnt vmcnt(0)
    v_mfma_f32_16x16x32_bf16 v[104:107], v[44:47], a[184:187], v[104:107]
    s_nop 7
    buffer_load_dwordx4 v[44:47], v30, s[4:7], s69 offen offset:320
    s_waitcnt vmcnt(0)
    v_mfma_f32_16x16x32_bf16 v[104:107], v[44:47], a[188:191], v[104:107]
    s_nop 7
    s_add_u32 s69, s39, 6144
    buffer_load_dwordx4 v[44:47], v30, s[4:7], s69 offen offset:0
    s_waitcnt vmcnt(0)
    v_mfma_f32_16x16x32_bf16 v[108:111], v[44:47], a[168:171], 0
    s_nop 7
    buffer_load_dwordx4 v[44:47], v30, s[4:7], s69 offen offset:64
    s_waitcnt vmcnt(0)
    v_mfma_f32_16x16x32_bf16 v[108:111], v[44:47], a[172:175], v[108:111]
    s_nop 7
    buffer_load_dwordx4 v[44:47], v30, s[4:7], s69 offen offset:128
    s_waitcnt vmcnt(0)
    v_mfma_f32_16x16x32_bf16 v[108:111], v[44:47], a[176:179], v[108:111]
    s_nop 7
    buffer_load_dwordx4 v[44:47], v30, s[4:7], s69 offen offset:192
    s_waitcnt vmcnt(0)
    v_mfma_f32_16x16x32_bf16 v[108:111], v[44:47], a[180:183], v[108:111]
    s_nop 7
    buffer_load_dwordx4 v[44:47], v30, s[4:7], s69 offen offset:256
    s_waitcnt vmcnt(0)
    v_mfma_f32_16x16x32_bf16 v[108:111], v[44:47], a[184:187], v[108:111]
    s_nop 7
    buffer_load_dwordx4 v[44:47], v30, s[4:7], s69 offen offset:320
    s_waitcnt vmcnt(0)
    v_mfma_f32_16x16x32_bf16 v[108:111], v[44:47], a[188:191], v[108:111]
    s_nop 7
    s_nop 15
    v_max3_f32 v18, v104, v105, v106
    v_max3_f32 v18, v18, v107, v108
    v_max3_f32 v18, v18, v109, v110
    v_max_f32 v18, v18, v111
    v_mov_b32 v19, v18
    s_nop 1
    v_permlane32_swap_b32 v19, v18
    v_max_f32 v18, v18, v19
    v_mov_b32 v19, v18
    s_nop 1
    v_permlane16_swap_b32 v19, v18
    v_max_f32 v18, v18, v19
    v_fma_f32 v18, v18, s28, v12
    v_max_f32 v24, 0, v18
    v_sub_f32 v12, v12, v24
    v_sub_f32 v25, 0, v24
    v_exp_f32 v25, v25
    s_nop 0
    v_mul_f32 v51, v51, v25
    v_accvgpr_read_b32 v19, a0
    v_mul_f32 v19, v19, v25
    v_accvgpr_write_b32 a0, v19
    v_accvgpr_read_b32 v19, a1
    v_mul_f32 v19, v19, v25
    v_accvgpr_write_b32 a1, v19
    v_accvgpr_read_b32 v19, a2
    v_mul_f32 v19, v19, v25
    v_accvgpr_write_b32 a2, v19
    v_accvgpr_read_b32 v19, a3
    v_mul_f32 v19, v19, v25
    v_accvgpr_write_b32 a3, v19
    v_accvgpr_read_b32 v19, a4
    v_mul_f32 v19, v19, v25
    v_accvgpr_write_b32 a4, v19
    v_accvgpr_read_b32 v19, a5
    v_mul_f32 v19, v19, v25
    v_accvgpr_write_b32 a5, v19
    v_accvgpr_read_b32 v19, a6
    v_mul_f32 v19, v19, v25
    v_accvgpr_write_b32 a6, v19
    v_accvgpr_read_b32 v19, a7
    v_mul_f32 v19, v19, v25
    v_accvgpr_write_b32 a7, v19
    v_accvgpr_read_b32 v19, a8
    v_mul_f32 v19, v19, v25
    v_accvgpr_write_b32 a8, v19
    v_accvgpr_read_b32 v19, a9
    v_mul_f32 v19, v19, v25
    v_accvgpr_write_b32 a9, v19
    v_accvgpr_read_b32 v19, a10
    v_mul_f32 v19, v19, v25
    v_accvgpr_write_b32 a10, v19
    v_accvgpr_read_b32 v19, a11
    v_mul_f32 v19, v19, v25
    v_accvgpr_write_b32 a11, v19
    v_accvgpr_read_b32 v19, a12
    v_mul_f32 v19, v19, v25
    v_accvgpr_write_b32 a12, v19
    v_accvgpr_read_b32 v19, a13
    v_mul_f32 v19, v19, v25
    v_accvgpr_write_b32 a13, v19
    v_accvgpr_read_b32 v19, a14
    v_mul_f32 v19, v19, v25
    v_accvgpr_write_b32 a14, v19
    v_accvgpr_read_b32 v19, a15
    v_mul_f32 v19, v19, v25
    v_accvgpr_write_b32 a15, v19
    v_accvgpr_read_b32 v19, a16
    v_mul_f32 v19, v19, v25
    v_accvgpr_write_b32 a16, v19
    v_accvgpr_read_b32 v19, a17
    v_mul_f32 v19, v19, v25
    v_accvgpr_write_b32 a17, v19
    v_accvgpr_read_b32 v19, a18
    v_mul_f32 v19, v19, v25
    v_accvgpr_write_b32 a18, v19
    v_accvgpr_read_b32 v19, a19
    v_mul_f32 v19, v19, v25
    v_accvgpr_write_b32 a19, v19
    v_accvgpr_read_b32 v19, a20
    v_mul_f32 v19, v19, v25
    v_accvgpr_write_b32 a20, v19
    v_accvgpr_read_b32 v19, a21
    v_mul_f32 v19, v19, v25
    v_accvgpr_write_b32 a21, v19
    v_accvgpr_read_b32 v19, a22
    v_mul_f32 v19, v19, v25
    v_accvgpr_write_b32 a22, v19
    v_accvgpr_read_b32 v19, a23
    v_mul_f32 v19, v19, v25
    v_accvgpr_write_b32 a23, v19
    v_accvgpr_read_b32 v19, a24
    v_mul_f32 v19, v19, v25
    v_accvgpr_write_b32 a24, v19
    v_accvgpr_read_b32 v19, a25
    v_mul_f32 v19, v19, v25
    v_accvgpr_write_b32 a25, v19
    v_accvgpr_read_b32 v19, a26
    v_mul_f32 v19, v19, v25
    v_accvgpr_write_b32 a26, v19
    v_accvgpr_read_b32 v19, a27
    v_mul_f32 v19, v19, v25
    v_accvgpr_write_b32 a27, v19
    v_accvgpr_read_b32 v19, a28
    v_mul_f32 v19, v19, v25
    v_accvgpr_write_b32 a28, v19
    v_accvgpr_read_b32 v19, a29
    v_mul_f32 v19, v19, v25
    v_accvgpr_write_b32 a29, v19
    v_accvgpr_read_b32 v19, a30
    v_mul_f32 v19, v19, v25
    v_accvgpr_write_b32 a30, v19
    v_accvgpr_read_b32 v19, a31
    v_mul_f32 v19, v19, v25
    v_accvgpr_write_b32 a31, v19
    v_accvgpr_read_b32 v19, a32
    v_mul_f32 v19, v19, v25
    v_accvgpr_write_b32 a32, v19
    v_accvgpr_read_b32 v19, a33
    v_mul_f32 v19, v19, v25
    v_accvgpr_write_b32 a33, v19
    v_accvgpr_read_b32 v19, a34
    v_mul_f32 v19, v19, v25
    v_accvgpr_write_b32 a34, v19
    v_accvgpr_read_b32 v19, a35
    v_mul_f32 v19, v19, v25
    v_accvgpr_write_b32 a35, v19
    v_accvgpr_read_b32 v19, a36
    v_mul_f32 v19, v19, v25
    v_accvgpr_write_b32 a36, v19
    v_accvgpr_read_b32 v19, a37
    v_mul_f32 v19, v19, v25
    v_accvgpr_write_b32 a37, v19
    v_accvgpr_read_b32 v19, a38
    v_mul_f32 v19, v19, v25
    v_accvgpr_write_b32 a38, v19
    v_accvgpr_read_b32 v19, a39
    v_mul_f32 v19, v19, v25
    v_accvgpr_write_b32 a39, v19
    v_accvgpr_read_b32 v19, a40
    v_mul_f32 v19, v19, v25
    v_accvgpr_write_b32 a40, v19
    v_accvgpr_read_b32 v19, a41
    v_mul_f32 v19, v19, v25
    v_accvgpr_write_b32 a41, v19
    v_accvgpr_read_b32 v19, a42
    v_mul_f32 v19, v19, v25
    v_accvgpr_write_b32 a42, v19
    v_accvgpr_read_b32 v19, a43
    v_mul_f32 v19, v19, v25
    v_accvgpr_write_b32 a43, v19
    v_accvgpr_read_b32 v19, a44
    v_mul_f32 v19, v19, v25
    v_accvgpr_write_b32 a44, v19
    v_accvgpr_read_b32 v19, a45
    v_mul_f32 v19, v19, v25
    v_accvgpr_write_b32 a45, v19
    v_accvgpr_read_b32 v19, a46
    v_mul_f32 v19, v19, v25
    v_accvgpr_write_b32 a46, v19
    v_accvgpr_read_b32 v19, a47
    v_mul_f32 v19, v19, v25
    v_accvgpr_write_b32 a47, v19
    v_fma_f32 v104, v104, s28, v12
    v_fma_f32 v105, v105, s28, v12
    v_exp_f32 v104, v104
    v_exp_f32 v105, v105
    s_nop 0
    v_cvt_pk_bf16_f32 v32, v104, v105
    v_fma_f32 v106, v106, s28, v12
    v_fma_f32 v107, v107, s28, v12
    v_exp_f32 v106, v106
    v_exp_f32 v107, v107
    s_nop 0
    v_cvt_pk_bf16_f32 v33, v106, v107
    v_fma_f32 v108, v108, s28, v12
    v_fma_f32 v109, v109, s28, v12
    v_exp_f32 v108, v108
    v_exp_f32 v109, v109
    s_nop 0
    v_cvt_pk_bf16_f32 v34, v108, v109
    v_fma_f32 v110, v110, s28, v12
    v_fma_f32 v111, v111, s28, v12
    v_exp_f32 v110, v110
    v_exp_f32 v111, v111
    s_nop 0
    v_cvt_pk_bf16_f32 v35, v110, v111
    v_mfma_f32_16x16x32_bf16 v[44:47], a[236:239], v[14:17], v[48:51]
    v_mfma_f32_16x16x32_bf16 v[44:47], a[240:243], v[20:23], v[44:47]
    v_mfma_f32_16x16x32_bf16 v[44:47], a[244:247], v[26:29], v[44:47]
    v_mfma_f32_16x16x32_bf16 v[44:47], a[248:251], v[32:35], v[44:47]
    s_nop 15
    s_setpc_b64 s[40:41]
L_rare4_1:
    s_nop 15
    v_mbcnt_lo_u32_b32 v27, -1, 0
    v_mbcnt_hi_u32_b32 v27, -1, v27
    v_and_b32 v26, 15, v27
    v_mul_u32_u24 v26, 384, v26
    v_lshrrev_b32 v27, 4, v27
    v_lshl_add_u32 v26, v27, 4, v26
    s_add_u32 s69, s39, 0
    buffer_load_dwordx4 v[48:51], v26, s[4:7], s69 offen offset:0
    s_waitcnt vmcnt(0)
    v_mfma_f32_16x16x32_bf16 v[104:107], v[48:51], a[96:99], 0
    s_nop 7
    buffer_load_dwordx4 v[48:51], v26, s[4:7], s69 offen offset:64
    s_waitcnt vmcnt(0)
    v_mfma_f32_16x16x32_bf16 v[104:107], v[48:51], a[100:103], v[104:107]
    s_nop 7
    buffer_load_dwordx4 v[48:51], v26, s[4:7], s69 offen offset:128
    s_waitcnt vmcnt(0)
    v_mfma_f32_16x16x32_bf16 v[104:107], v[48:51], a[104:107], v[104:107]
    s_nop 7
    buffer_load_dwordx4 v[48:51], v26, s[4:7], s69 offen offset:192
    s_waitcnt vmcnt(0)
    v_mfma_f32_16x16x32_bf16 v[104:107], v[48:51], a[108:111], v[104:107]
    s_nop 7
    buffer_load_dwordx4 v[48:51], v26, s[4:7], s69 offen offset:256
    s_waitcnt vmcnt(0)
    v_mfma_f32_16x16x32_bf16 v[104:107], v[48:51], a[112:115], v[104:107]
    s_nop 7
    buffer_load_dwordx4 v[48:51], v26, s[4:7], s69 offen offset:320
    s_waitcnt vmcnt(0)
    v_mfma_f32_16x16x32_bf16 v[104:107], v[48:51], a[116:119], v[104:107]
    s_nop 7
    s_add_u32 s69, s39, 6144
    buffer_load_dwordx4 v[48:51], v26, s[4:7], s69 offen offset:0
    s_waitcnt vmcnt(0)
    v_mfma_f32_16x16x32_bf16 v[108:111], v[48:51], a[96:99], 0
    s_nop 7
    buffer_load_dwordx4 v[48:51], v26, s[4:7], s69 offen offset:64
    s_waitcnt vmcnt(0)
    v_mfma_f32_16x16x32_bf16 v[108:111], v[48:51], a[100:103], v[108:111]
    s_nop 7
    buffer_load_dwordx4 v[48:51], v26, s[4:7], s69 offen offset:128
    s_waitcnt vmcnt(0)
    v_mfma_f32_16x16x32_bf16 v[108:111], v[48:51], a[104:107], v[108:111]
    s_nop 7
    buffer_load_dwordx4 v[48:51], v26, s[4:7], s69 offen offset:192
    s_waitcnt vmcnt(0)
    v_mfma_f32_16x16x32_bf16 v[108:111], v[48:51], a[108:111], v[108:111]
    s_nop 7
    buffer_load_dwordx4 v[48:51], v26, s[4:7], s69 offen offset:256
    s_waitcnt vmcnt(0)
    v_mfma_f32_16x16x32_bf16 v[108:111], v[48:51], a[112:115], v[108:111]
    s_nop 7
    buffer_load_dwordx4 v[48:51], v26, s[4:7], s69 offen offset:320
    s_waitcnt vmcnt(0)
    v_mfma_f32_16x16x32_bf16 v[108:111], v[48:51], a[116:119], v[108:111]
    s_nop 7
    s_nop 15
    v_max3_f32 v14, v104, v105, v106
    v_max3_f32 v14, v14, v107, v108
    v_max3_f32 v14, v14, v109, v110
    v_max_f32 v14, v14, v111
    v_mov_b32 v15, v14
    s_nop 1
    v_permlane32_swap_b32 v15, v14
    v_max_f32 v14, v14, v15
    v_mov_b32 v15, v14
    s_nop 1
    v_permlane16_swap_b32 v15, v14
    v_max_f32 v14, v14, v15
    v_fma_f32 v14, v14, s28, v9
    v_max_f32 v20, 0, v14
    v_sub_f32 v9, v9, v20
    v_sub_f32 v21, 0, v20
    v_exp_f32 v21, v21
    s_nop 0
    v_mul_f32 v15, v44, v21
    v_cndmask_b32_e64 v44, v15, v44, s[60:61]
    v_cndmask_b32_e64 v44, v44, 0, s[46:47]
    v_mul_f32 v112, v112, v21
    v_mul_f32 v113, v113, v21
    v_mul_f32 v114, v114, v21
    v_mul_f32 v115, v115, v21
    v_mul_f32 v116, v116, v21
    v_mul_f32 v117, v117, v21
    v_mul_f32 v118, v118, v21
    v_mul_f32 v119, v119, v21
    v_mul_f32 v120, v120, v21
    v_mul_f32 v121, v121, v21
    v_mul_f32 v122, v122, v21
    v_mul_f32 v123, v123, v21
    v_mul_f32 v124, v124, v21
    v_mul_f32 v125, v125, v21
    v_mul_f32 v126, v126, v21
    v_mul_f32 v127, v127, v21
    v_mul_f32 v128, v128, v21
    v_mul_f32 v129, v129, v21
    v_mul_f32 v130, v130, v21
    v_mul_f32 v131, v131, v21
    v_mul_f32 v132, v132, v21
    v_mul_f32 v133, v133, v21
    v_mul_f32 v134, v134, v21
    v_mul_f32 v135, v135, v21
    v_mul_f32 v136, v136, v21
    v_mul_f32 v137, v137, v21
    v_mul_f32 v138, v138, v21
    v_mul_f32 v139, v139, v21
    v_mul_f32 v140, v140, v21
    v_mul_f32 v141, v141, v21
    v_mul_f32 v142, v142, v21
    v_mul_f32 v143, v143, v21
    v_mul_f32 v144, v144, v21
    v_mul_f32 v145, v145, v21
    v_mul_f32 v146, v146, v21
    v_mul_f32 v147, v147, v21
    v_mul_f32 v148, v148, v21
    v_mul_f32 v149, v149, v21
    v_mul_f32 v150, v150, v21
    v_mul_f32 v151, v151, v21
    v_mul_f32 v152, v152, v21
    v_mul_f32 v153, v153, v21
    v_mul_f32 v154, v154, v21
    v_mul_f32 v155, v155, v21
    v_mul_f32 v156, v156, v21
    v_mul_f32 v157, v157, v21
    v_mul_f32 v158, v158, v21
    v_mul_f32 v159, v159, v21
    v_fma_f32 v104, v104, s28, v9
    v_fma_f32 v105, v105, s28, v9
    v_exp_f32 v104, v104
    v_exp_f32 v105, v105
    s_nop 0
    v_cvt_pk_bf16_f32 v18, v104, v105
    v_fma_f32 v106, v106, s28, v9
    v_fma_f32 v107, v107, s28, v9
    v_exp_f32 v106, v106
    v_exp_f32 v107, v107
    s_nop 0
    v_cvt_pk_bf16_f32 v19, v106, v107
    v_fma_f32 v108, v108, s28, v9
    v_fma_f32 v109, v109, s28, v9
    v_exp_f32 v108, v108
    v_exp_f32 v109, v109
    s_nop 0
    v_cvt_pk_bf16_f32 v16, v108, v109
    v_fma_f32 v110, v110, s28, v9
    v_fma_f32 v111, v111, s28, v9
    v_exp_f32 v110, v110
    v_exp_f32 v111, v111
    s_nop 0
    v_cvt_pk_bf16_f32 v17, v110, v111
    s_add_u32 s69, s39, 0
    buffer_load_dwordx4 v[48:51], v26, s[4:7], s69 offen offset:0
    s_waitcnt vmcnt(0)
    v_mfma_f32_16x16x32_bf16 v[104:107], v[48:51], a[120:123], 0
    s_nop 7
    buffer_load_dwordx4 v[48:51], v26, s[4:7], s69 offen offset:64
    s_waitcnt vmcnt(0)
    v_mfma_f32_16x16x32_bf16 v[104:107], v[48:51], a[124:127], v[104:107]
    s_nop 7
    buffer_load_dwordx4 v[48:51], v26, s[4:7], s69 offen offset:128
    s_waitcnt vmcnt(0)
    v_mfma_f32_16x16x32_bf16 v[104:107], v[48:51], a[128:131], v[104:107]
    s_nop 7
    buffer_load_dwordx4 v[48:51], v26, s[4:7], s69 offen offset:192
    s_waitcnt vmcnt(0)
    v_mfma_f32_16x16x32_bf16 v[104:107], v[48:51], a[132:135], v[104:107]
    s_nop 7
    buffer_load_dwordx4 v[48:51], v26, s[4:7], s69 offen offset:256
    s_waitcnt vmcnt(0)
    v_mfma_f32_16x16x32_bf16 v[104:107], v[48:51], a[136:139], v[104:107]
    s_nop 7
    buffer_load_dwordx4 v[48:51], v26, s[4:7], s69 offen offset:320
    s_waitcnt vmcnt(0)
    v_mfma_f32_16x16x32_bf16 v[104:107], v[48:51], a[140:143], v[104:107]
    s_nop 7
    s_add_u32 s69, s39, 6144
    buffer_load_dwordx4 v[48:51], v26, s[4:7], s69 offen offset:0
    s_waitcnt vmcnt(0)
    v_mfma_f32_16x16x32_bf16 v[108:111], v[48:51], a[120:123], 0
    s_nop 7
    buffer_load_dwordx4 v[48:51], v26, s[4:7], s69 offen offset:64
    s_waitcnt vmcnt(0)
    v_mfma_f32_16x16x32_bf16 v[108:111], v[48:51], a[124:127], v[108:111]
    s_nop 7
    buffer_load_dwordx4 v[48:51], v26, s[4:7], s69 offen offset:128
    s_waitcnt vmcnt(0)
    v_mfma_f32_16x16x32_bf16 v[108:111], v[48:51], a[128:131], v[108:111]
    s_nop 7
    buffer_load_dwordx4 v[48:51], v26, s[4:7], s69 offen offset:192
    s_waitcnt vmcnt(0)
    v_mfma_f32_16x16x32_bf16 v[108:111], v[48:51], a[132:135], v[108:111]
    s_nop 7
    buffer_load_dwordx4 v[48:51], v26, s[4:7], s69 offen offset:256
    s_waitcnt vmcnt(0)
    v_mfma_f32_16x16x32_bf16 v[108:111], v[48:51], a[136:139], v[108:111]
    s_nop 7
    buffer_load_dwordx4 v[48:51], v26, s[4:7], s69 offen offset:320
    s_waitcnt vmcnt(0)
    v_mfma_f32_16x16x32_bf16 v[108:111], v[48:51], a[140:143], v[108:111]
    s_nop 7
    s_nop 15
    v_max3_f32 v14, v104, v105, v106
    v_max3_f32 v14, v14, v107, v108
    v_max3_f32 v14, v14, v109, v110
    v_max_f32 v14, v14, v111
    v_mov_b32 v15, v14
    s_nop 1
    v_permlane32_swap_b32 v15, v14
    v_max_f32 v14, v14, v15
    v_mov_b32 v15, v14
    s_nop 1
    v_permlane16_swap_b32 v15, v14
    v_max_f32 v14, v14, v15
    v_fma_f32 v14, v14, s28, v10
    v_max_f32 v20, 0, v14
    v_sub_f32 v10, v10, v20
    v_sub_f32 v21, 0, v20
    v_exp_f32 v21, v21
    s_nop 0
    v_mul_f32 v45, v45, v21
    v_mul_f32 v160, v160, v21
    v_mul_f32 v161, v161, v21
    v_mul_f32 v162, v162, v21
    v_mul_f32 v163, v163, v21
    v_mul_f32 v164, v164, v21
    v_mul_f32 v165, v165, v21
    v_mul_f32 v166, v166, v21
    v_mul_f32 v167, v167, v21
    v_mul_f32 v168, v168, v21
    v_mul_f32 v169, v169, v21
    v_mul_f32 v170, v170, v21
    v_mul_f32 v171, v171, v21
    v_mul_f32 v172, v172, v21
    v_mul_f32 v173, v173, v21
    v_mul_f32 v174, v174, v21
    v_mul_f32 v175, v175, v21
    v_mul_f32 v176, v176, v21
    v_mul_f32 v177, v177, v21
    v_mul_f32 v178, v178, v21
    v_mul_f32 v179, v179, v21
    v_mul_f32 v180, v180, v21
    v_mul_f32 v181, v181, v21
    v_mul_f32 v182, v182, v21
    v_mul_f32 v183, v183, v21
    v_mul_f32 v184, v184, v21
    v_mul_f32 v185, v185, v21
    v_mul_f32 v186, v186, v21
    v_mul_f32 v187, v187, v21
    v_mul_f32 v188, v188, v21
    v_mul_f32 v189, v189, v21
    v_mul_f32 v190, v190, v21
    v_mul_f32 v191, v191, v21
    v_mul_f32 v192, v192, v21
    v_mul_f32 v193, v193, v21
    v_mul_f32 v194, v194, v21
    v_mul_f32 v195, v195, v21
    v_mul_f32 v196, v196, v21
    v_mul_f32 v197, v197, v21
    v_mul_f32 v198, v198, v21
    v_mul_f32 v199, v199, v21
    v_mul_f32 v200, v200, v21
    v_mul_f32 v201, v201, v21
    v_mul_f32 v202, v202, v21
    v_mul_f32 v203, v203, v21
    v_mul_f32 v204, v204, v21
    v_mul_f32 v205, v205, v21
    v_mul_f32 v206, v206, v21
    v_mul_f32 v207, v207, v21
    v_fma_f32 v104, v104, s28, v10
    v_fma_f32 v105, v105, s28, v10
    v_exp_f32 v104, v104
    v_exp_f32 v105, v105
    s_nop 0
    v_cvt_pk_bf16_f32 v24, v104, v105
    v_fma_f32 v106, v106, s28, v10
    v_fma_f32 v107, v107, s28, v10
    v_exp_f32 v106, v106
    v_exp_f32 v107, v107
    s_nop 0
    v_cvt_pk_bf16_f32 v25, v106, v107
    v_fma_f32 v108, v108, s28, v10
    v_fma_f32 v109, v109, s28, v10
    v_exp_f32 v108, v108
    v_exp_f32 v109, v109
    s_nop 0
    v_cvt_pk_bf16_f32 v22, v108, v109
    v_fma_f32 v110, v110, s28, v10
    v_fma_f32 v111, v111, s28, v10
    v_exp_f32 v110, v110
    v_exp_f32 v111, v111
    s_nop 0
    v_cvt_pk_bf16_f32 v23, v110, v111
    s_add_u32 s69, s39, 0
    buffer_load_dwordx4 v[48:51], v26, s[4:7], s69 offen offset:0
    s_waitcnt vmcnt(0)
    v_mfma_f32_16x16x32_bf16 v[104:107], v[48:51], a[144:147], 0
    s_nop 7
    buffer_load_dwordx4 v[48:51], v26, s[4:7], s69 offen offset:64
    s_waitcnt vmcnt(0)
    v_mfma_f32_16x16x32_bf16 v[104:107], v[48:51], a[148:151], v[104:107]
    s_nop 7
    buffer_load_dwordx4 v[48:51], v26, s[4:7], s69 offen offset:128
    s_waitcnt vmcnt(0)
    v_mfma_f32_16x16x32_bf16 v[104:107], v[48:51], a[152:155], v[104:107]
    s_nop 7
    buffer_load_dwordx4 v[48:51], v26, s[4:7], s69 offen offset:192
    s_waitcnt vmcnt(0)
    v_mfma_f32_16x16x32_bf16 v[104:107], v[48:51], a[156:159], v[104:107]
    s_nop 7
    buffer_load_dwordx4 v[48:51], v26, s[4:7], s69 offen offset:256
    s_waitcnt vmcnt(0)
    v_mfma_f32_16x16x32_bf16 v[104:107], v[48:51], a[160:163], v[104:107]
    s_nop 7
    buffer_load_dwordx4 v[48:51], v26, s[4:7], s69 offen offset:320
    s_waitcnt vmcnt(0)
    v_mfma_f32_16x16x32_bf16 v[104:107], v[48:51], a[164:167], v[104:107]
    s_nop 7
    s_add_u32 s69, s39, 6144
    buffer_load_dwordx4 v[48:51], v26, s[4:7], s69 offen offset:0
    s_waitcnt vmcnt(0)
    v_mfma_f32_16x16x32_bf16 v[108:111], v[48:51], a[144:147], 0
    s_nop 7
    buffer_load_dwordx4 v[48:51], v26, s[4:7], s69 offen offset:64
    s_waitcnt vmcnt(0)
    v_mfma_f32_16x16x32_bf16 v[108:111], v[48:51], a[148:151], v[108:111]
    s_nop 7
    buffer_load_dwordx4 v[48:51], v26, s[4:7], s69 offen offset:128
    s_waitcnt vmcnt(0)
    v_mfma_f32_16x16x32_bf16 v[108:111], v[48:51], a[152:155], v[108:111]
    s_nop 7
    buffer_load_dwordx4 v[48:51], v26, s[4:7], s69 offen offset:192
    s_waitcnt vmcnt(0)
    v_mfma_f32_16x16x32_bf16 v[108:111], v[48:51], a[156:159], v[108:111]
    s_nop 7
    buffer_load_dwordx4 v[48:51], v26, s[4:7], s69 offen offset:256
    s_waitcnt vmcnt(0)
    v_mfma_f32_16x16x32_bf16 v[108:111], v[48:51], a[160:163], v[108:111]
    s_nop 7
    buffer_load_dwordx4 v[48:51], v26, s[4:7], s69 offen offset:320
    s_waitcnt vmcnt(0)
    v_mfma_f32_16x16x32_bf16 v[108:111], v[48:51], a[164:167], v[108:111]
    s_nop 7
    s_nop 15
    v_max3_f32 v14, v104, v105, v106
    v_max3_f32 v14, v14, v107, v108
    v_max3_f32 v14, v14, v109, v110
    v_max_f32 v14, v14, v111
    v_mov_b32 v15, v14
    s_nop 1
    v_permlane32_swap_b32 v15, v14
    v_max_f32 v14, v14, v15
    v_mov_b32 v15, v14
    s_nop 1
    v_permlane16_swap_b32 v15, v14
    v_max_f32 v14, v14, v15
    v_fma_f32 v14, v14, s28, v11
    v_max_f32 v20, 0, v14
    v_sub_f32 v11, v11, v20
    v_sub_f32 v21, 0, v20
    v_exp_f32 v21, v21
    s_nop 0
    v_mul_f32 v46, v46, v21
    v_mul_f32 v208, v208, v21
    v_mul_f32 v209, v209, v21
    v_mul_f32 v210, v210, v21
    v_mul_f32 v211, v211, v21
    v_mul_f32 v212, v212, v21
    v_mul_f32 v213, v213, v21
    v_mul_f32 v214, v214, v21
    v_mul_f32 v215, v215, v21
    v_mul_f32 v216, v216, v21
    v_mul_f32 v217, v217, v21
    v_mul_f32 v218, v218, v21
    v_mul_f32 v219, v219, v21
    v_mul_f32 v220, v220, v21
    v_mul_f32 v221, v221, v21
    v_mul_f32 v222, v222, v21
    v_mul_f32 v223, v223, v21
    v_mul_f32 v224, v224, v21
    v_mul_f32 v225, v225, v21
    v_mul_f32 v226, v226, v21
    v_mul_f32 v227, v227, v21
    v_mul_f32 v228, v228, v21
    v_mul_f32 v229, v229, v21
    v_mul_f32 v230, v230, v21
    v_mul_f32 v231, v231, v21
    v_mul_f32 v232, v232, v21
    v_mul_f32 v233, v233, v21
    v_mul_f32 v234, v234, v21
    v_mul_f32 v235, v235, v21
    v_mul_f32 v236, v236, v21
    v_mul_f32 v237, v237, v21
    v_mul_f32 v238, v238, v21
    v_mul_f32 v239, v239, v21
    v_mul_f32 v240, v240, v21
    v_mul_f32 v241, v241, v21
    v_mul_f32 v242, v242, v21
    v_mul_f32 v243, v243, v21
    v_mul_f32 v244, v244, v21
    v_mul_f32 v245, v245, v21
    v_mul_f32 v246, v246, v21
    v_mul_f32 v247, v247, v21
    v_mul_f32 v248, v248, v21
    v_mul_f32 v249, v249, v21
    v_mul_f32 v250, v250, v21
    v_mul_f32 v251, v251, v21
    v_mul_f32 v252, v252, v21
    v_mul_f32 v253, v253, v21
    v_mul_f32 v254, v254, v21
    v_mul_f32 v255, v255, v21
    v_fma_f32 v104, v104, s28, v11
    v_fma_f32 v105, v105, s28, v11
    v_exp_f32 v104, v104
    v_exp_f32 v105, v105
    s_nop 0
    v_cvt_pk_bf16_f32 v30, v104, v105
    v_fma_f32 v106, v106, s28, v11
    v_fma_f32 v107, v107, s28, v11
    v_exp_f32 v106, v106
    v_exp_f32 v107, v107
    s_nop 0
    v_cvt_pk_bf16_f32 v31, v106, v107
    v_fma_f32 v108, v108, s28, v11
    v_fma_f32 v109, v109, s28, v11
    v_exp_f32 v108, v108
    v_exp_f32 v109, v109
    s_nop 0
    v_cvt_pk_bf16_f32 v28, v108, v109
    v_fma_f32 v110, v110, s28, v11
    v_fma_f32 v111, v111, s28, v11
    v_exp_f32 v110, v110
    v_exp_f32 v111, v111
    s_nop 0
    v_cvt_pk_bf16_f32 v29, v110, v111
    s_add_u32 s69, s39, 0
    buffer_load_dwordx4 v[48:51], v26, s[4:7], s69 offen offset:0
    s_waitcnt vmcnt(0)
    v_mfma_f32_16x16x32_bf16 v[104:107], v[48:51], a[168:171], 0
    s_nop 7
    buffer_load_dwordx4 v[48:51], v26, s[4:7], s69 offen offset:64
    s_waitcnt vmcnt(0)
    v_mfma_f32_16x16x32_bf16 v[104:107], v[48:51], a[172:175], v[104:107]
    s_nop 7
    buffer_load_dwordx4 v[48:51], v26, s[4:7], s69 offen offset:128
    s_waitcnt vmcnt(0)
    v_mfma_f32_16x16x32_bf16 v[104:107], v[48:51], a[176:179], v[104:107]
    s_nop 7
    buffer_load_dwordx4 v[48:51], v26, s[4:7], s69 offen offset:192
    s_waitcnt vmcnt(0)
    v_mfma_f32_16x16x32_bf16 v[104:107], v[48:51], a[180:183], v[104:107]
    s_nop 7
    buffer_load_dwordx4 v[48:51], v26, s[4:7], s69 offen offset:256
    s_waitcnt vmcnt(0)
    v_mfma_f32_16x16x32_bf16 v[104:107], v[48:51], a[184:187], v[104:107]
    s_nop 7
    buffer_load_dwordx4 v[48:51], v26, s[4:7], s69 offen offset:320
    s_waitcnt vmcnt(0)
    v_mfma_f32_16x16x32_bf16 v[104:107], v[48:51], a[188:191], v[104:107]
    s_nop 7
    s_add_u32 s69, s39, 6144
    buffer_load_dwordx4 v[48:51], v26, s[4:7], s69 offen offset:0
    s_waitcnt vmcnt(0)
    v_mfma_f32_16x16x32_bf16 v[108:111], v[48:51], a[168:171], 0
    s_nop 7
    buffer_load_dwordx4 v[48:51], v26, s[4:7], s69 offen offset:64
    s_waitcnt vmcnt(0)
    v_mfma_f32_16x16x32_bf16 v[108:111], v[48:51], a[172:175], v[108:111]
    s_nop 7
    buffer_load_dwordx4 v[48:51], v26, s[4:7], s69 offen offset:128
    s_waitcnt vmcnt(0)
    v_mfma_f32_16x16x32_bf16 v[108:111], v[48:51], a[176:179], v[108:111]
    s_nop 7
    buffer_load_dwordx4 v[48:51], v26, s[4:7], s69 offen offset:192
    s_waitcnt vmcnt(0)
    v_mfma_f32_16x16x32_bf16 v[108:111], v[48:51], a[180:183], v[108:111]
    s_nop 7
    buffer_load_dwordx4 v[48:51], v26, s[4:7], s69 offen offset:256
    s_waitcnt vmcnt(0)
    v_mfma_f32_16x16x32_bf16 v[108:111], v[48:51], a[184:187], v[108:111]
    s_nop 7
    buffer_load_dwordx4 v[48:51], v26, s[4:7], s69 offen offset:320
    s_waitcnt vmcnt(0)
    v_mfma_f32_16x16x32_bf16 v[108:111], v[48:51], a[188:191], v[108:111]
    s_nop 7
    s_nop 15
    v_max3_f32 v14, v104, v105, v106
    v_max3_f32 v14, v14, v107, v108
    v_max3_f32 v14, v14, v109, v110
    v_max_f32 v14, v14, v111
    v_mov_b32 v15, v14
    s_nop 1
    v_permlane32_swap_b32 v15, v14
    v_max_f32 v14, v14, v15
    v_mov_b32 v15, v14
    s_nop 1
    v_permlane16_swap_b32 v15, v14
    v_max_f32 v14, v14, v15
    v_fma_f32 v14, v14, s28, v12
    v_max_f32 v20, 0, v14
    v_sub_f32 v12, v12, v20
    v_sub_f32 v21, 0, v20
    v_exp_f32 v21, v21
    s_nop 0
    v_mul_f32 v47, v47, v21
    v_accvgpr_read_b32 v15, a0
    v_mul_f32 v15, v15, v21
    v_accvgpr_write_b32 a0, v15
    v_accvgpr_read_b32 v15, a1
    v_mul_f32 v15, v15, v21
    v_accvgpr_write_b32 a1, v15
    v_accvgpr_read_b32 v15, a2
    v_mul_f32 v15, v15, v21
    v_accvgpr_write_b32 a2, v15
    v_accvgpr_read_b32 v15, a3
    v_mul_f32 v15, v15, v21
    v_accvgpr_write_b32 a3, v15
    v_accvgpr_read_b32 v15, a4
    v_mul_f32 v15, v15, v21
    v_accvgpr_write_b32 a4, v15
    v_accvgpr_read_b32 v15, a5
    v_mul_f32 v15, v15, v21
    v_accvgpr_write_b32 a5, v15
    v_accvgpr_read_b32 v15, a6
    v_mul_f32 v15, v15, v21
    v_accvgpr_write_b32 a6, v15
    v_accvgpr_read_b32 v15, a7
    v_mul_f32 v15, v15, v21
    v_accvgpr_write_b32 a7, v15
    v_accvgpr_read_b32 v15, a8
    v_mul_f32 v15, v15, v21
    v_accvgpr_write_b32 a8, v15
    v_accvgpr_read_b32 v15, a9
    v_mul_f32 v15, v15, v21
    v_accvgpr_write_b32 a9, v15
    v_accvgpr_read_b32 v15, a10
    v_mul_f32 v15, v15, v21
    v_accvgpr_write_b32 a10, v15
    v_accvgpr_read_b32 v15, a11
    v_mul_f32 v15, v15, v21
    v_accvgpr_write_b32 a11, v15
    v_accvgpr_read_b32 v15, a12
    v_mul_f32 v15, v15, v21
    v_accvgpr_write_b32 a12, v15
    v_accvgpr_read_b32 v15, a13
    v_mul_f32 v15, v15, v21
    v_accvgpr_write_b32 a13, v15
    v_accvgpr_read_b32 v15, a14
    v_mul_f32 v15, v15, v21
    v_accvgpr_write_b32 a14, v15
    v_accvgpr_read_b32 v15, a15
    v_mul_f32 v15, v15, v21
    v_accvgpr_write_b32 a15, v15
    v_accvgpr_read_b32 v15, a16
    v_mul_f32 v15, v15, v21
    v_accvgpr_write_b32 a16, v15
    v_accvgpr_read_b32 v15, a17
    v_mul_f32 v15, v15, v21
    v_accvgpr_write_b32 a17, v15
    v_accvgpr_read_b32 v15, a18
    v_mul_f32 v15, v15, v21
    v_accvgpr_write_b32 a18, v15
    v_accvgpr_read_b32 v15, a19
    v_mul_f32 v15, v15, v21
    v_accvgpr_write_b32 a19, v15
    v_accvgpr_read_b32 v15, a20
    v_mul_f32 v15, v15, v21
    v_accvgpr_write_b32 a20, v15
    v_accvgpr_read_b32 v15, a21
    v_mul_f32 v15, v15, v21
    v_accvgpr_write_b32 a21, v15
    v_accvgpr_read_b32 v15, a22
    v_mul_f32 v15, v15, v21
    v_accvgpr_write_b32 a22, v15
    v_accvgpr_read_b32 v15, a23
    v_mul_f32 v15, v15, v21
    v_accvgpr_write_b32 a23, v15
    v_accvgpr_read_b32 v15, a24
    v_mul_f32 v15, v15, v21
    v_accvgpr_write_b32 a24, v15
    v_accvgpr_read_b32 v15, a25
    v_mul_f32 v15, v15, v21
    v_accvgpr_write_b32 a25, v15
    v_accvgpr_read_b32 v15, a26
    v_mul_f32 v15, v15, v21
    v_accvgpr_write_b32 a26, v15
    v_accvgpr_read_b32 v15, a27
    v_mul_f32 v15, v15, v21
    v_accvgpr_write_b32 a27, v15
    v_accvgpr_read_b32 v15, a28
    v_mul_f32 v15, v15, v21
    v_accvgpr_write_b32 a28, v15
    v_accvgpr_read_b32 v15, a29
    v_mul_f32 v15, v15, v21
    v_accvgpr_write_b32 a29, v15
    v_accvgpr_read_b32 v15, a30
    v_mul_f32 v15, v15, v21
    v_accvgpr_write_b32 a30, v15
    v_accvgpr_read_b32 v15, a31
    v_mul_f32 v15, v15, v21
    v_accvgpr_write_b32 a31, v15
    v_accvgpr_read_b32 v15, a32
    v_mul_f32 v15, v15, v21
    v_accvgpr_write_b32 a32, v15
    v_accvgpr_read_b32 v15, a33
    v_mul_f32 v15, v15, v21
    v_accvgpr_write_b32 a33, v15
    v_accvgpr_read_b32 v15, a34
    v_mul_f32 v15, v15, v21
    v_accvgpr_write_b32 a34, v15
    v_accvgpr_read_b32 v15, a35
    v_mul_f32 v15, v15, v21
    v_accvgpr_write_b32 a35, v15
    v_accvgpr_read_b32 v15, a36
    v_mul_f32 v15, v15, v21
    v_accvgpr_write_b32 a36, v15
    v_accvgpr_read_b32 v15, a37
    v_mul_f32 v15, v15, v21
    v_accvgpr_write_b32 a37, v15
    v_accvgpr_read_b32 v15, a38
    v_mul_f32 v15, v15, v21
    v_accvgpr_write_b32 a38, v15
    v_accvgpr_read_b32 v15, a39
    v_mul_f32 v15, v15, v21
    v_accvgpr_write_b32 a39, v15
    v_accvgpr_read_b32 v15, a40
    v_mul_f32 v15, v15, v21
    v_accvgpr_write_b32 a40, v15
    v_accvgpr_read_b32 v15, a41
    v_mul_f32 v15, v15, v21
    v_accvgpr_write_b32 a41, v15
    v_accvgpr_read_b32 v15, a42
    v_mul_f32 v15, v15, v21
    v_accvgpr_write_b32 a42, v15
    v_accvgpr_read_b32 v15, a43
    v_mul_f32 v15, v15, v21
    v_accvgpr_write_b32 a43, v15
    v_accvgpr_read_b32 v15, a44
    v_mul_f32 v15, v15, v21
    v_accvgpr_write_b32 a44, v15
    v_accvgpr_read_b32 v15, a45
    v_mul_f32 v15, v15, v21
    v_accvgpr_write_b32 a45, v15
    v_accvgpr_read_b32 v15, a46
    v_mul_f32 v15, v15, v21
    v_accvgpr_write_b32 a46, v15
    v_accvgpr_read_b32 v15, a47
    v_mul_f32 v15, v15, v21
    v_accvgpr_write_b32 a47, v15
    v_fma_f32 v104, v104, s28, v12
    v_fma_f32 v105, v105, s28, v12
    v_exp_f32 v104, v104
    v_exp_f32 v105, v105
    s_nop 0
    v_cvt_pk_bf16_f32 v36, v104, v105
    v_fma_f32 v106, v106, s28, v12
    v_fma_f32 v107, v107, s28, v12
    v_exp_f32 v106, v106
    v_exp_f32 v107, v107
    s_nop 0
    v_cvt_pk_bf16_f32 v37, v106, v107
    v_fma_f32 v108, v108, s28, v12
    v_fma_f32 v109, v109, s28, v12
    v_exp_f32 v108, v108
    v_exp_f32 v109, v109
    s_nop 0
    v_cvt_pk_bf16_f32 v34, v108, v109
    v_fma_f32 v110, v110, s28, v12
    v_fma_f32 v111, v111, s28, v12
    v_exp_f32 v110, v110
    v_exp_f32 v111, v111
    s_nop 0
    v_cvt_pk_bf16_f32 v35, v110, v111
    v_mfma_f32_16x16x32_bf16 v[48:51], a[236:239], v[16:19], v[44:47]
    v_mfma_f32_16x16x32_bf16 v[48:51], a[240:243], v[22:25], v[48:51]
    v_mfma_f32_16x16x32_bf16 v[48:51], a[244:247], v[28:31], v[48:51]
    v_mfma_f32_16x16x32_bf16 v[48:51], a[248:251], v[34:37], v[48:51]
    s_nop 15
    s_setpc_b64 s[40:41]
L_rs_start5b:
    s_call_b64 s[40:41], L_rare5_1
    s_branch L_ret_start5b
L_rs_loop5w0a:
    s_call_b64 s[40:41], L_rare5_0
    s_branch L_ret_loop5w0a
L_rs_loop5w0b:
    s_call_b64 s[40:41], L_rare5_1
    s_branch L_ret_loop5w0b
L_rs_end5a:
    s_call_b64 s[40:41], L_rare5_0
    s_branch L_ret_end5a
L_rs_end5b:
    s_call_b64 s[40:41], L_rare5_1
    s_branch L_ret_end5b
L_rs_start4b:
    s_call_b64 s[40:41], L_rare4_1
    s_branch L_ret_start4b
L_rs_loop4w0a:
    s_call_b64 s[40:41], L_rare4_0
    s_branch L_ret_loop4w0a
L_rs_loop4w0b:
    s_call_b64 s[40:41], L_rare4_1
    s_branch L_ret_loop4w0b
L_rs_end4a:
    s_call_b64 s[40:41], L_rare4_0
    s_branch L_ret_end4a
L_rs_end4b:
    s_call_b64 s[40:41], L_rare4_1
    s_branch L_ret_end4b
L_rs_tr54a:
    s_call_b64 s[40:41], L_rare5_0
    s_branch L_ret_tr54a
L_rs_tr54b:
    s_nop 15
    s_waitcnt vmcnt(0) lgkmcnt(0)
    s_mov_b32 s68, s14
    s_mov_b32 s14, 166723584
    v_mbcnt_lo_u32_b32 v105, -1, 0
    v_mbcnt_hi_u32_b32 v105, -1, v105
    v_and_b32 v104, 15, v105
    v_mul_u32_u24 v104, 384, v104
    v_lshrrev_b32 v105, 4, v105
    v_lshl_add_u32 v104, v105, 4, v104
    s_add_u32 s69, s34, 0
    buffer_load_dwordx4 a[96:99], v104, s[12:15], s69 offen offset:0
    buffer_load_dwordx4 a[100:103], v104, s[12:15], s69 offen offset:64
    buffer_load_dwordx4 a[104:107], v104, s[12:15], s69 offen offset:128
    buffer_load_dwordx4 a[108:111], v104, s[12:15], s69 offen offset:192
    buffer_load_dwordx4 a[112:115], v104, s[12:15], s69 offen offset:256
    buffer_load_dwordx4 a[116:119], v104, s[12:15], s69 offen offset:320
    s_add_u32 s69, s34, 6144
    buffer_load_dwordx4 a[120:123], v104, s[12:15], s69 offen offset:0
    buffer_load_dwordx4 a[124:127], v104, s[12:15], s69 offen offset:64
    buffer_load_dwordx4 a[128:131], v104, s[12:15], s69 offen offset:128
    buffer_load_dwordx4 a[132:135], v104, s[12:15], s69 offen offset:192
    buffer_load_dwordx4 a[136:139], v104, s[12:15], s69 offen offset:256
    buffer_load_dwordx4 a[140:143], v104, s[12:15], s69 offen offset:320
    s_add_u32 s69, s34, 12288
    buffer_load_dwordx4 a[144:147], v104, s[12:15], s69 offen offset:0
    buffer_load_dwordx4 a[148:151], v104, s[12:15], s69 offen offset:64
    buffer_load_dwordx4 a[152:155], v104, s[12:15], s69 offen offset:128
    buffer_load_dwordx4 a[156:159], v104, s[12:15], s69 offen offset:192
    buffer_load_dwordx4 a[160:163], v104, s[12:15], s69 offen offset:256
    buffer_load_dwordx4 a[164:167], v104, s[12:15], s69 offen offset:320
    s_add_u32 s69, s34, 18432
    buffer_load_dwordx4 a[168:171], v104, s[12:15], s69 offen offset:0
    buffer_load_dwordx4 a[172:175], v104, s[12:15], s69 offen offset:64
    buffer_load_dwordx4 a[176:179], v104, s[12:15], s69 offen offset:128
    buffer_load_dwordx4 a[180:183], v104, s[12:15], s69 offen offset:192
    buffer_load_dwordx4 a[184:187], v104, s[12:15], s69 offen offset:256
    buffer_load_dwordx4 a[188:191], v104, s[12:15], s69 offen offset:320
    s_add_u32 s69, s34, 24576
    buffer_load_dwordx4 a[192:195], v104, s[12:15], s69 offen offset:0
    buffer_load_dwordx4 a[196:199], v104, s[12:15], s69 offen offset:64
    buffer_load_dwordx4 a[200:203], v104, s[12:15], s69 offen offset:128
    buffer_load_dwordx4 a[204:207], v104, s[12:15], s69 offen offset:192
    buffer_load_dwordx4 a[208:211], v104, s[12:15], s69 offen offset:256
    buffer_load_dwordx4 v[92:95], v104, s[12:15], s69 offen offset:320
    s_waitcnt vmcnt(0)
    s_call_b64 s[40:41], L_rare5_1
    v_mbcnt_lo_u32_b32 v105, -1, 0
    v_mbcnt_hi_u32_b32 v105, -1, v105
    v_and_b32 v104, 15, v105
    v_mul_u32_u24 v104, 384, v104
    v_lshrrev_b32 v105, 4, v105
    v_lshl_add_u32 v104, v105, 4, v104
    s_add_u32 s69, s33, 0
    buffer_load_dwordx4 a[96:99], v104, s[12:15], s69 offen offset:0
    buffer_load_dwordx4 a[100:103], v104, s[12:15], s69 offen offset:64
    buffer_load_dwordx4 a[104:107], v104, s[12:15], s69 offen offset:128
    buffer_load_dwordx4 a[108:111], v104, s[12:15], s69 offen offset:192
    buffer_load_dwordx4 a[112:115], v104, s[12:15], s69 offen offset:256
    buffer_load_dwordx4 a[116:119], v104, s[12:15], s69 offen offset:320
    s_add_u32 s69, s33, 6144
    buffer_load_dwordx4 a[120:123], v104, s[12:15], s69 offen offset:0
    buffer_load_dwordx4 a[124:127], v104, s[12:15], s69 offen offset:64
    buffer_load_dwordx4 a[128:131], v104, s[12:15], s69 offen offset:128
    buffer_load_dwordx4 a[132:135], v104, s[12:15], s69 offen offset:192
    buffer_load_dwordx4 a[136:139], v104, s[12:15], s69 offen offset:256
    buffer_load_dwordx4 a[140:143], v104, s[12:15], s69 offen offset:320
    s_add_u32 s69, s33, 12288
    buffer_load_dwordx4 a[144:147], v104, s[12:15], s69 offen offset:0
    buffer_load_dwordx4 a[148:151], v104, s[12:15], s69 offen offset:64
    buffer_load_dwordx4 a[152:155], v104, s[12:15], s69 offen offset:128
    buffer_load_dwordx4 a[156:159], v104, s[12:15], s69 offen offset:192
    buffer_load_dwordx4 a[160:163], v104, s[12:15], s69 offen offset:256
    buffer_load_dwordx4 a[164:167], v104, s[12:15], s69 offen offset:320
    s_add_u32 s69, s33, 18432
    buffer_load_dwordx4 a[168:171], v104, s[12:15], s69 offen offset:0
    buffer_load_dwordx4 a[172:175], v104, s[12:15], s69 offen offset:64
    buffer_load_dwordx4 a[176:179], v104, s[12:15], s69 offen offset:128
    buffer_load_dwordx4 a[180:183], v104, s[12:15], s69 offen offset:192
    buffer_load_dwordx4 a[184:187], v104, s[12:15], s69 offen offset:256
    buffer_load_dwordx4 a[188:191], v104, s[12:15], s69 offen offset:320
    s_waitcnt vmcnt(0)
    s_mov_b32 s14, s68
    s_branch L_ret_tr54b
L_rs_tr54d:
    s_call_b64 s[40:41], L_rare4_1
    s_branch L_ret_tr54d
L_rs_tr45a:
    s_call_b64 s[40:41], L_rare4_0
    s_branch L_ret_tr45a
L_rs_tr45b:
    s_nop 15
    s_waitcnt vmcnt(0) lgkmcnt(0)
    s_mov_b32 s68, s14
    s_mov_b32 s14, 166723584
    v_mbcnt_lo_u32_b32 v105, -1, 0
    v_mbcnt_hi_u32_b32 v105, -1, v105
    v_and_b32 v104, 15, v105
    v_mul_u32_u24 v104, 384, v104
    v_lshrrev_b32 v105, 4, v105
    v_lshl_add_u32 v104, v105, 4, v104
    s_add_u32 s69, s34, 0
    buffer_load_dwordx4 a[96:99], v104, s[12:15], s69 offen offset:0
    buffer_load_dwordx4 a[100:103], v104, s[12:15], s69 offen offset:64
    buffer_load_dwordx4 a[104:107], v104, s[12:15], s69 offen offset:128
    buffer_load_dwordx4 a[108:111], v104, s[12:15], s69 offen offset:192
    buffer_load_dwordx4 a[112:115], v104, s[12:15], s69 offen offset:256
    buffer_load_dwordx4 a[116:119], v104, s[12:15], s69 offen offset:320
    s_add_u32 s69, s34, 6144
    buffer_load_dwordx4 a[120:123], v104, s[12:15], s69 offen offset:0
    buffer_load_dwordx4 a[124:127], v104, s[12:15], s69 offen offset:64
    buffer_load_dwordx4 a[128:131], v104, s[12:15], s69 offen offset:128
    buffer_load_dwordx4 a[132:135], v104, s[12:15], s69 offen offset:192
    buffer_load_dwordx4 a[136:139], v104, s[12:15], s69 offen offset:256
    buffer_load_dwordx4 a[140:143], v104, s[12:15], s69 offen offset:320
    s_add_u32 s69, s34, 12288
    buffer_load_dwordx4 a[144:147], v104, s[12:15], s69 offen offset:0
    buffer_load_dwordx4 a[148:151], v104, s[12:15], s69 offen offset:64
    buffer_load_dwordx4 a[152:155], v104, s[12:15], s69 offen offset:128
    buffer_load_dwordx4 a[156:159], v104, s[12:15], s69 offen offset:192
    buffer_load_dwordx4 a[160:163], v104, s[12:15], s69 offen offset:256
    buffer_load_dwordx4 a[164:167], v104, s[12:15], s69 offen offset:320
    s_add_u32 s69, s34, 18432
    buffer_load_dwordx4 a[168:171], v104, s[12:15], s69 offen offset:0
    buffer_load_dwordx4 a[172:175], v104, s[12:15], s69 offen offset:64
    buffer_load_dwordx4 a[176:179], v104, s[12:15], s69 offen offset:128
    buffer_load_dwordx4 a[180:183], v104, s[12:15], s69 offen offset:192
    buffer_load_dwordx4 a[184:187], v104, s[12:15], s69 offen offset:256
    buffer_load_dwordx4 a[188:191], v104, s[12:15], s69 offen offset:320
    s_waitcnt vmcnt(0)
    s_call_b64 s[40:41], L_rare4_1
    v_mbcnt_lo_u32_b32 v105, -1, 0
    v_mbcnt_hi_u32_b32 v105, -1, v105
    v_and_b32 v104, 15, v105
    v_mul_u32_u24 v104, 384, v104
    v_lshrrev_b32 v105, 4, v105
    v_lshl_add_u32 v104, v105, 4, v104
    s_add_u32 s69, s33, 0
    buffer_load_dwordx4 a[96:99], v104, s[12:15], s69 offen offset:0
    buffer_load_dwordx4 a[100:103], v104, s[12:15], s69 offen offset:64
    buffer_load_dwordx4 a[104:107], v104, s[12:15], s69 offen offset:128
    buffer_load_dwordx4 a[108:111], v104, s[12:15], s69 offen offset:192
    buffer_load_dwordx4 a[112:115], v104, s[12:15], s69 offen offset:256
    buffer_load_dwordx4 a[116:119], v104, s[12:15], s69 offen offset:320
    s_add_u32 s69, s33, 6144
    buffer_load_dwordx4 a[120:123], v104, s[12:15], s69 offen offset:0
    buffer_load_dwordx4 a[124:127], v104, s[12:15], s69 offen offset:64
    buffer_load_dwordx4 a[128:131], v104, s[12:15], s69 offen offset:128
    buffer_load_dwordx4 a[132:135], v104, s[12:15], s69 offen offset:192
    buffer_load_dwordx4 a[136:139], v104, s[12:15], s69 offen offset:256
    buffer_load_dwordx4 a[140:143], v104, s[12:15], s69 offen offset:320
    s_add_u32 s69, s33, 12288
    buffer_load_dwordx4 a[144:147], v104, s[12:15], s69 offen offset:0
    buffer_load_dwordx4 a[148:151], v104, s[12:15], s69 offen offset:64
    buffer_load_dwordx4 a[152:155], v104, s[12:15], s69 offen offset:128
    buffer_load_dwordx4 a[156:159], v104, s[12:15], s69 offen offset:192
    buffer_load_dwordx4 a[160:163], v104, s[12:15], s69 offen offset:256
    buffer_load_dwordx4 a[164:167], v104, s[12:15], s69 offen offset:320
    s_add_u32 s69, s33, 18432
    buffer_load_dwordx4 a[168:171], v104, s[12:15], s69 offen offset:0
    buffer_load_dwordx4 a[172:175], v104, s[12:15], s69 offen offset:64
    buffer_load_dwordx4 a[176:179], v104, s[12:15], s69 offen offset:128
    buffer_load_dwordx4 a[180:183], v104, s[12:15], s69 offen offset:192
    buffer_load_dwordx4 a[184:187], v104, s[12:15], s69 offen offset:256
    buffer_load_dwordx4 a[188:191], v104, s[12:15], s69 offen offset:320
    s_add_u32 s69, s33, 24576
    buffer_load_dwordx4 a[192:195], v104, s[12:15], s69 offen offset:0
    buffer_load_dwordx4 a[196:199], v104, s[12:15], s69 offen offset:64
    buffer_load_dwordx4 a[200:203], v104, s[12:15], s69 offen offset:128
    buffer_load_dwordx4 a[204:207], v104, s[12:15], s69 offen offset:192
    buffer_load_dwordx4 a[208:211], v104, s[12:15], s69 offen offset:256
    buffer_load_dwordx4 v[92:95], v104, s[12:15], s69 offen offset:320
    s_waitcnt vmcnt(0)
    s_mov_b32 s14, s68
    s_branch L_ret_tr45b
L_rs_tr45d:
    s_call_b64 s[40:41], L_rare5_1
    s_branch L_ret_tr45d
L_rs_tr44a:
    s_call_b64 s[40:41], L_rare4_0
    s_branch L_ret_tr44a
L_rs_tr44b:
    s_nop 15
    s_waitcnt vmcnt(0) lgkmcnt(0)
    s_mov_b32 s68, s14
    s_mov_b32 s14, 166723584
    v_mbcnt_lo_u32_b32 v105, -1, 0
    v_mbcnt_hi_u32_b32 v105, -1, v105
    v_and_b32 v104, 15, v105
    v_mul_u32_u24 v104, 384, v104
    v_lshrrev_b32 v105, 4, v105
    v_lshl_add_u32 v104, v105, 4, v104
    s_add_u32 s69, s34, 0
    buffer_load_dwordx4 a[96:99], v104, s[12:15], s69 offen offset:0
    buffer_load_dwordx4 a[100:103], v104, s[12:15], s69 offen offset:64
    buffer_load_dwordx4 a[104:107], v104, s[12:15], s69 offen offset:128
    buffer_load_dwordx4 a[108:111], v104, s[12:15], s69 offen offset:192
    buffer_load_dwordx4 a[112:115], v104, s[12:15], s69 offen offset:256
    buffer_load_dwordx4 a[116:119], v104, s[12:15], s69 offen offset:320
    s_add_u32 s69, s34, 6144
    buffer_load_dwordx4 a[120:123], v104, s[12:15], s69 offen offset:0
    buffer_load_dwordx4 a[124:127], v104, s[12:15], s69 offen offset:64
    buffer_load_dwordx4 a[128:131], v104, s[12:15], s69 offen offset:128
    buffer_load_dwordx4 a[132:135], v104, s[12:15], s69 offen offset:192
    buffer_load_dwordx4 a[136:139], v104, s[12:15], s69 offen offset:256
    buffer_load_dwordx4 a[140:143], v104, s[12:15], s69 offen offset:320
    s_add_u32 s69, s34, 12288
    buffer_load_dwordx4 a[144:147], v104, s[12:15], s69 offen offset:0
    buffer_load_dwordx4 a[148:151], v104, s[12:15], s69 offen offset:64
    buffer_load_dwordx4 a[152:155], v104, s[12:15], s69 offen offset:128
    buffer_load_dwordx4 a[156:159], v104, s[12:15], s69 offen offset:192
    buffer_load_dwordx4 a[160:163], v104, s[12:15], s69 offen offset:256
    buffer_load_dwordx4 a[164:167], v104, s[12:15], s69 offen offset:320
    s_add_u32 s69, s34, 18432
    buffer_load_dwordx4 a[168:171], v104, s[12:15], s69 offen offset:0
    buffer_load_dwordx4 a[172:175], v104, s[12:15], s69 offen offset:64
    buffer_load_dwordx4 a[176:179], v104, s[12:15], s69 offen offset:128
    buffer_load_dwordx4 a[180:183], v104, s[12:15], s69 offen offset:192
    buffer_load_dwordx4 a[184:187], v104, s[12:15], s69 offen offset:256
    buffer_load_dwordx4 a[188:191], v104, s[12:15], s69 offen offset:320
    s_waitcnt vmcnt(0)
    s_call_b64 s[40:41], L_rare4_1
    v_mbcnt_lo_u32_b32 v105, -1, 0
    v_mbcnt_hi_u32_b32 v105, -1, v105
    v_and_b32 v104, 15, v105
    v_mul_u32_u24 v104, 384, v104
    v_lshrrev_b32 v105, 4, v105
    v_lshl_add_u32 v104, v105, 4, v104
    s_add_u32 s69, s33, 0
    buffer_load_dwordx4 a[96:99], v104, s[12:15], s69 offen offset:0
    buffer_load_dwordx4 a[100:103], v104, s[12:15], s69 offen offset:64
    buffer_load_dwordx4 a[104:107], v104, s[12:15], s69 offen offset:128
    buffer_load_dwordx4 a[108:111], v104, s[12:15], s69 offen offset:192
    buffer_load_dwordx4 a[112:115], v104, s[12:15], s69 offen offset:256
    buffer_load_dwordx4 a[116:119], v104, s[12:15], s69 offen offset:320
    s_add_u32 s69, s33, 6144
    buffer_load_dwordx4 a[120:123], v104, s[12:15], s69 offen offset:0
    buffer_load_dwordx4 a[124:127], v104, s[12:15], s69 offen offset:64
    buffer_load_dwordx4 a[128:131], v104, s[12:15], s69 offen offset:128
    buffer_load_dwordx4 a[132:135], v104, s[12:15], s69 offen offset:192
    buffer_load_dwordx4 a[136:139], v104, s[12:15], s69 offen offset:256
    buffer_load_dwordx4 a[140:143], v104, s[12:15], s69 offen offset:320
    s_add_u32 s69, s33, 12288
    buffer_load_dwordx4 a[144:147], v104, s[12:15], s69 offen offset:0
    buffer_load_dwordx4 a[148:151], v104, s[12:15], s69 offen offset:64
    buffer_load_dwordx4 a[152:155], v104, s[12:15], s69 offen offset:128
    buffer_load_dwordx4 a[156:159], v104, s[12:15], s69 offen offset:192
    buffer_load_dwordx4 a[160:163], v104, s[12:15], s69 offen offset:256
    buffer_load_dwordx4 a[164:167], v104, s[12:15], s69 offen offset:320
    s_add_u32 s69, s33, 18432
    buffer_load_dwordx4 a[168:171], v104, s[12:15], s69 offen offset:0
    buffer_load_dwordx4 a[172:175], v104, s[12:15], s69 offen offset:64
    buffer_load_dwordx4 a[176:179], v104, s[12:15], s69 offen offset:128
    buffer_load_dwordx4 a[180:183], v104, s[12:15], s69 offen offset:192
    buffer_load_dwordx4 a[184:187], v104, s[12:15], s69 offen offset:256
    buffer_load_dwordx4 a[188:191], v104, s[12:15], s69 offen offset:320
    s_waitcnt vmcnt(0)
    s_mov_b32 s14, s68
    s_branch L_ret_tr44b
L_rs_tr44d:
    s_call_b64 s[40:41], L_rare4_1
    s_branch L_ret_tr44d
L_rs_tr55a:
    s_call_b64 s[40:41], L_rare5_0
    s_branch L_ret_tr55a
L_rs_tr55b:
    s_nop 15
    s_waitcnt vmcnt(0) lgkmcnt(0)
    s_mov_b32 s68, s14
    s_mov_b32 s14, 166723584
    v_mbcnt_lo_u32_b32 v105, -1, 0
    v_mbcnt_hi_u32_b32 v105, -1, v105
    v_and_b32 v104, 15, v105
    v_mul_u32_u24 v104, 384, v104
    v_lshrrev_b32 v105, 4, v105
    v_lshl_add_u32 v104, v105, 4, v104
    s_add_u32 s69, s34, 0
    buffer_load_dwordx4 a[96:99], v104, s[12:15], s69 offen offset:0
    buffer_load_dwordx4 a[100:103], v104, s[12:15], s69 offen offset:64
    buffer_load_dwordx4 a[104:107], v104, s[12:15], s69 offen offset:128
    buffer_load_dwordx4 a[108:111], v104, s[12:15], s69 offen offset:192
    buffer_load_dwordx4 a[112:115], v104, s[12:15], s69 offen offset:256
    buffer_load_dwordx4 a[116:119], v104, s[12:15], s69 offen offset:320
    s_add_u32 s69, s34, 6144
    buffer_load_dwordx4 a[120:123], v104, s[12:15], s69 offen offset:0
    buffer_load_dwordx4 a[124:127], v104, s[12:15], s69 offen offset:64
    buffer_load_dwordx4 a[128:131], v104, s[12:15], s69 offen offset:128
    buffer_load_dwordx4 a[132:135], v104, s[12:15], s69 offen offset:192
    buffer_load_dwordx4 a[136:139], v104, s[12:15], s69 offen offset:256
    buffer_load_dwordx4 a[140:143], v104, s[12:15], s69 offen offset:320
    s_add_u32 s69, s34, 12288
    buffer_load_dwordx4 a[144:147], v104, s[12:15], s69 offen offset:0
    buffer_load_dwordx4 a[148:151], v104, s[12:15], s69 offen offset:64
    buffer_load_dwordx4 a[152:155], v104, s[12:15], s69 offen offset:128
    buffer_load_dwordx4 a[156:159], v104, s[12:15], s69 offen offset:192
    buffer_load_dwordx4 a[160:163], v104, s[12:15], s69 offen offset:256
    buffer_load_dwordx4 a[164:167], v104, s[12:15], s69 offen offset:320
    s_add_u32 s69, s34, 18432
    buffer_load_dwordx4 a[168:171], v104, s[12:15], s69 offen offset:0
    buffer_load_dwordx4 a[172:175], v104, s[12:15], s69 offen offset:64
    buffer_load_dwordx4 a[176:179], v104, s[12:15], s69 offen offset:128
    buffer_load_dwordx4 a[180:183], v104, s[12:15], s69 offen offset:192
    buffer_load_dwordx4 a[184:187], v104, s[12:15], s69 offen offset:256
    buffer_load_dwordx4 a[188:191], v104, s[12:15], s69 offen offset:320
    s_add_u32 s69, s34, 24576
    buffer_load_dwordx4 a[192:195], v104, s[12:15], s69 offen offset:0
    buffer_load_dwordx4 a[196:199], v104, s[12:15], s69 offen offset:64
    buffer_load_dwordx4 a[200:203], v104, s[12:15], s69 offen offset:128
    buffer_load_dwordx4 a[204:207], v104, s[12:15], s69 offen offset:192
    buffer_load_dwordx4 a[208:211], v104, s[12:15], s69 offen offset:256
    buffer_load_dwordx4 v[92:95], v104, s[12:15], s69 offen offset:320
    s_waitcnt vmcnt(0)
    s_call_b64 s[40:41], L_rare5_1
    v_mbcnt_lo_u32_b32 v105, -1, 0
    v_mbcnt_hi_u32_b32 v105, -1, v105
    v_and_b32 v104, 15, v105
    v_mul_u32_u24 v104, 384, v104
    v_lshrrev_b32 v105, 4, v105
    v_lshl_add_u32 v104, v105, 4, v104
    s_add_u32 s69, s33, 0
    buffer_load_dwordx4 a[96:99], v104, s[12:15], s69 offen offset:0
    buffer_load_dwordx4 a[100:103], v104, s[12:15], s69 offen offset:64
    buffer_load_dwordx4 a[104:107], v104, s[12:15], s69 offen offset:128
    buffer_load_dwordx4 a[108:111], v104, s[12:15], s69 offen offset:192
    buffer_load_dwordx4 a[112:115], v104, s[12:15], s69 offen offset:256
    buffer_load_dwordx4 a[116:119], v104, s[12:15], s69 offen offset:320
    s_add_u32 s69, s33, 6144
    buffer_load_dwordx4 a[120:123], v104, s[12:15], s69 offen offset:0
    buffer_load_dwordx4 a[124:127], v104, s[12:15], s69 offen offset:64
    buffer_load_dwordx4 a[128:131], v104, s[12:15], s69 offen offset:128
    buffer_load_dwordx4 a[132:135], v104, s[12:15], s69 offen offset:192
    buffer_load_dwordx4 a[136:139], v104, s[12:15], s69 offen offset:256
    buffer_load_dwordx4 a[140:143], v104, s[12:15], s69 offen offset:320
    s_add_u32 s69, s33, 12288
    buffer_load_dwordx4 a[144:147], v104, s[12:15], s69 offen offset:0
    buffer_load_dwordx4 a[148:151], v104, s[12:15], s69 offen offset:64
    buffer_load_dwordx4 a[152:155], v104, s[12:15], s69 offen offset:128
    buffer_load_dwordx4 a[156:159], v104, s[12:15], s69 offen offset:192
    buffer_load_dwordx4 a[160:163], v104, s[12:15], s69 offen offset:256
    buffer_load_dwordx4 a[164:167], v104, s[12:15], s69 offen offset:320
    s_add_u32 s69, s33, 18432
    buffer_load_dwordx4 a[168:171], v104, s[12:15], s69 offen offset:0
    buffer_load_dwordx4 a[172:175], v104, s[12:15], s69 offen offset:64
    buffer_load_dwordx4 a[176:179], v104, s[12:15], s69 offen offset:128
    buffer_load_dwordx4 a[180:183], v104, s[12:15], s69 offen offset:192
    buffer_load_dwordx4 a[184:187], v104, s[12:15], s69 offen offset:256
    buffer_load_dwordx4 a[188:191], v104, s[12:15], s69 offen offset:320
    s_add_u32 s69, s33, 24576
    buffer_load_dwordx4 a[192:195], v104, s[12:15], s69 offen offset:0
    buffer_load_dwordx4 a[196:199], v104, s[12:15], s69 offen offset:64
    buffer_load_dwordx4 a[200:203], v104, s[12:15], s69 offen offset:128
    buffer_load_dwordx4 a[204:207], v104, s[12:15], s69 offen offset:192
    buffer_load_dwordx4 a[208:211], v104, s[12:15], s69 offen offset:256
    buffer_load_dwordx4 v[92:95], v104, s[12:15], s69 offen offset:320
    s_waitcnt vmcnt(0)
    s_mov_b32 s14, s68
    s_branch L_ret_tr55b
L_rs_tr55d:
    s_call_b64 s[40:41], L_rare5_1
    s_branch L_ret_tr55d
.section .rodata,"a"
.p2align 6
.amdhsa_kernel standalone__gqa_softmax__near_ridge_kernel
  .amdhsa_next_free_vgpr 512
  .amdhsa_next_free_sgpr 102
  .amdhsa_accum_offset 256
  .amdhsa_group_segment_fixed_size 0
  .amdhsa_kernarg_size 48
  .amdhsa_user_sgpr_count 2
  .amdhsa_user_sgpr_kernarg_segment_ptr 1
  .amdhsa_system_sgpr_workgroup_id_x 1
.end_amdhsa_kernel
```

```asm
; @launch grid=(256,1,1) block=(256,1,1) lds=163840
.amdgcn_target "amdgcn-amd-amdhsa--gfx950"
.text
.globl standalone__gqa_softmax__near_ridge_kernel
.p2align 8
.type standalone__gqa_softmax__near_ridge_kernel,@function
standalone__gqa_softmax__near_ridge_kernel:
    s_cmp_ge_u32 s2, 256
    s_cbranch_scc1 L_end
    s_load_dwordx4 s[84:87], s[0:1], 0
    s_load_dwordx4 s[88:91], s[0:1], 16
    v_lshrrev_b32 v110, 6, v0
    v_and_b32 v111, 63, v0
    s_getpc_b64 s[60:61]
L_pc:
    s_lshr_b32 s62, s2, 3
    v_lshl_add_u32 v53, s62, 2, v110
    v_min_u32 v52, ((L_codeend-L_pc+16383)/16384)-1, v111
    v_mul_u32_u24 v53, ((L_codeend-L_pc+16383)/16384), v53
    v_add_lshl_u32 v52, v52, v53, 7
    v_min_u32 v52, L_codeend-L_pc-4, v52
    global_load_dword v53, v52, s[60:61]
    v_readfirstlane_b32 s3, v110
    v_lshrrev_b32 v96, 3, v111
    v_mul_u32_u24 v7, 384, v96
    v_lshrrev_b32 v97, 1, v96
    v_lshlrev_b32 v97, 1, v97
    v_and_b32 v98, 7, v111
    v_xor_b32 v97, v97, v98
    v_lshl_add_u32 v7, v97, 4, v7
    s_and_b32 s65, s3, 1
    s_mul_i32 s42, s65, 80
    s_mul_i32 s43, s65, 3072
    v_xor_b32 v6, s42, v7
    v_xor_b32 v7, 80, v6
    v_add_u32 v6, s43, v6
    s_sub_u32 s43, 3072, s43
    v_add_u32 v7, s43, v7
    s_mov_b32 s28, 0x3dd53b95
    s_mov_b32 s29, 0x4e800000
    s_mov_b32 s49, 5888
    s_mov_b32 s46, 0
    s_mov_b32 s47, 0xffff0000
    s_and_b32 s42, s2, 7
    s_lshr_b32 s43, s2, 3
    s_mul_i32 s44, s43, 43
    s_lshr_b32 s44, s44, 7
    s_mov_b32 s39, s44
    s_mul_i32 s45, s44, 3
    s_sub_u32 s36, s43, s45
    s_lshl_b32 s42, s42, 6
    s_lshl_b32 s45, s45, 1
    s_add_u32 s42, s42, s45
    s_mul_i32 s64, s42, 196608
    s_mul_i32 s35, s42, 325632
    s_lshr_b32 s42, s44, 1
    s_mov_b32 s31, 0x6900924
    s_cmp_eq_u32 s42, 1
    s_cselect_b32 s31, 0x14a0489, s31
    s_cmp_eq_u32 s42, 2
    s_cselect_b32 s31, 0x8250258, s31
    s_cmp_eq_u32 s42, 3
    s_cselect_b32 s31, 0x8940912, s31
    s_cmp_eq_u32 s42, 4
    s_cselect_b32 s31, 0x1a10606, s31
    s_and_b32 s42, s44, 1
    s_lshl_b32 s42, s42, 4
    s_lshr_b32 s31, s31, s42
    s_and_b32 s31, s31, 0xffff
    s_cmp_eq_u32 s43, 30
    s_cselect_b32 s31, 0x120648, s31
    s_cmp_eq_u32 s43, 31
    s_cselect_b32 s31, 0x240219, s31
    s_lshr_b32 s63, s31, 16
    s_cmp_ge_u32 s43, 30
    s_cselect_b32 s36, 0, s36
    s_cselect_b32 s42, 4, 6
    s_mul_i32 s42, s42, 196608
    s_add_u32 s6, s64, s42
    s_mov_b32 s10, s6
    s_mul_i32 s22, s3, 3072
    s_mul_i32 s38, s3, 28672
    s_add_u32 s38, s38, 49152
    s_and_b32 s42, s3, 2
    s_mul_i32 s42, s42, 3072
    s_add_u32 s20, s64, s42
    s_mov_b32 s21, s20
    s_mov_b32 s14, 166723584
    s_mov_b32 s18, 0
    s_mov_b32 s67, 0
    s_mov_b32 s37, 0
    s_mov_b32 s60, 0
    s_mov_b32 s61, 0xffff
    s_lshl_b32 s42, s37, 1
    s_lshr_b32 s42, s31, s42
    s_and_b32 s42, s42, 3
    s_add_u32 s42, s42, s36
    s_sub_u32 s43, s42, 3
    s_cmp_ge_u32 s42, 3
    s_cselect_b32 s42, s43, s42
    s_mul_i32 s44, s3, 5
    s_mov_b32 s32, 1
    s_lshl_b32 s43, s3, 2
    s_add_u32 s45, s43, 21
    s_cmp_eq_u32 s3, 0
    s_cselect_b32 s45, 20, s45
    s_cselect_b32 s34, 1, 0
    s_cmp_eq_u32 s42, 1
    s_cselect_b32 s44, s45, s44
    s_cselect_b32 s32, s34, s32
    s_add_u32 s45, s43, 37
    s_cmp_eq_u32 s42, 2
    s_cselect_b32 s44, s45, s44
    s_cselect_b32 s32, 0, s32
    s_mul_i32 s44, s44, 6144
    s_add_u32 s34, s35, s44
    s_waitcnt lgkmcnt(0)
    s_mov_b32 s12, s84
    s_and_b32 s13, s85, 0xffff
    s_mov_b32 s15, 0x20000
    s_mov_b32 s4, s86
    s_and_b32 s5, s87, 0xffff
    s_mov_b32 s7, 0x20000
    s_mov_b32 s8, s88
    s_and_b32 s9, s89, 0xffff
    s_mov_b32 s11, 0x20000
    s_mov_b32 s16, s90
    s_and_b32 s17, s91, 0xffff
    s_mov_b32 s19, 0x20000
    s_cmp_eq_u32 s32, 0
    s_cbranch_scc1 L_start4
L_start5:
    s_add_u32 m0, s22, 0
    s_nop 0
    buffer_load_dwordx4 v6, s[4:7], s20 offen lds
    s_add_u32 s20, s20, 128
    s_add_u32 m0, s22, 1024
    s_nop 0
    buffer_load_dwordx4 v6, s[4:7], s20 offen lds
    s_add_u32 s20, s20, 128
    s_add_u32 m0, s22, 2048
    s_nop 0
    buffer_load_dwordx4 v6, s[4:7], s20 offen lds
    s_add_u32 s20, s20, 12032
    s_add_u32 m0, s22, 12288
    s_nop 0
    buffer_load_dwordx4 v6, s[4:7], s20 offen lds
    s_add_u32 s20, s20, 128
    s_add_u32 m0, s22, 13312
    s_nop 0
    buffer_load_dwordx4 v6, s[4:7], s20 offen lds
    s_add_u32 s20, s20, 128
    s_add_u32 m0, s22, 14336
    s_nop 0
    buffer_load_dwordx4 v6, s[4:7], s20 offen lds
    s_add_u32 s20, s20, 12032
    s_add_u32 s48, s34, 0
    s_add_u32 m0, s38, 0
    s_nop 0
    buffer_load_dwordx4 v6, s[12:15], s48 offen nt lds
    s_add_u32 m0, s38, 1024
    s_nop 0
    buffer_load_dwordx4 v7, s[12:15], s48 offen nt lds
    s_add_u32 s48, s34, 128
    s_add_u32 m0, s38, 2048
    s_nop 0
    buffer_load_dwordx4 v6, s[12:15], s48 offen nt lds
    s_add_u32 m0, s38, 3072
    s_nop 0
    buffer_load_dwordx4 v7, s[12:15], s48 offen nt lds
    s_add_u32 s48, s34, 256
    s_add_u32 m0, s38, 4096
    s_nop 0
    buffer_load_dwordx4 v6, s[12:15], s48 offen nt lds
    s_add_u32 m0, s38, 5120
    s_nop 0
    buffer_load_dwordx4 v7, s[12:15], s48 offen nt lds
    s_add_u32 s48, s34, 6144
    s_add_u32 m0, s38, 6144
    s_nop 0
    buffer_load_dwordx4 v6, s[12:15], s48 offen nt lds
    s_add_u32 m0, s38, 7168
    s_nop 0
    buffer_load_dwordx4 v7, s[12:15], s48 offen nt lds
    s_add_u32 s48, s34, 6272
    s_add_u32 m0, s38, 8192
    s_nop 0
    buffer_load_dwordx4 v6, s[12:15], s48 offen nt lds
    s_add_u32 m0, s38, 9216
    s_nop 0
    buffer_load_dwordx4 v7, s[12:15], s48 offen nt lds
    s_add_u32 s48, s34, 6400
    s_add_u32 m0, s38, 10240
    s_nop 0
    buffer_load_dwordx4 v6, s[12:15], s48 offen nt lds
    s_add_u32 m0, s38, 11264
    s_nop 0
    buffer_load_dwordx4 v7, s[12:15], s48 offen nt lds
    s_add_u32 s48, s34, 12288
    s_add_u32 m0, s38, 12288
    s_nop 0
    buffer_load_dwordx4 v6, s[12:15], s48 offen nt lds
    s_add_u32 m0, s38, 13312
    s_nop 0
    buffer_load_dwordx4 v7, s[12:15], s48 offen nt lds
    s_add_u32 s48, s34, 12416
    s_add_u32 m0, s38, 14336
    s_nop 0
    buffer_load_dwordx4 v6, s[12:15], s48 offen nt lds
    s_add_u32 m0, s38, 15360
    s_nop 0
    buffer_load_dwordx4 v7, s[12:15], s48 offen nt lds
    s_add_u32 s48, s34, 12544
    s_add_u32 m0, s38, 16384
    s_nop 0
    buffer_load_dwordx4 v6, s[12:15], s48 offen nt lds
    s_add_u32 m0, s38, 17408
    s_nop 0
    buffer_load_dwordx4 v7, s[12:15], s48 offen nt lds
    v_and_b32 v96, 15, v111
    v_lshrrev_b32 v97, 4, v111
    v_lshrrev_b32 v98, 3, v96
    v_and_b32 v99, 7, v96
    v_lshlrev_b32 v0, 7, v99
    v_bfe_u32 v99, v96, 1, 2
    v_lshlrev_b32 v99, 1, v99
    v_mul_u32_u24 v100, 5, v98
    v_xor_b32 v99, v99, v100
    v_xor_b32 v99, v99, v97
    v_lshl_add_u32 v0, v99, 4, v0
    v_mul_u32_u24 v100, 3072, v98
    v_add_u32 v0, v100, v0
    v_xor_b32 v1, 64, v0
    v_lshrrev_b32 v98, 1, v97
    v_mul_u32_u24 v2, 3072, v98
    v_and_b32 v99, 1, v97
    v_bfe_u32 v100, v111, 2, 2
    v_lshl_add_u32 v96, v99, 2, v100
    v_lshl_add_u32 v2, v96, 7, v2
    v_lshrrev_b32 v96, 1, v96
    v_lshlrev_b32 v96, 1, v96
    v_mul_u32_u24 v98, 5, v98
    v_xor_b32 v96, v96, v98
    v_bfe_u32 v99, v111, 1, 1
    v_xor_b32 v96, v96, v99
    v_lshl_add_u32 v2, v96, 4, v2
    v_and_b32 v99, 1, v111
    v_lshl_add_u32 v2, v99, 3, v2
    v_add_u32 v2, 24576, v2
    v_xor_b32 v3, 32, v2
    v_xor_b32 v4, 64, v2
    v_xor_b32 v5, 96, v2
    v_lshl_add_u32 v8, v111, 4, s38
    v_lshrrev_b32 v96, 3, v111
    v_bfe_u32 v97, v111, 0, 3
    v_and_b32 v98, 3, v96
    v_lshlrev_b32 v98, 1, v98
    v_xor_b32 v97, v97, v98
    v_xor_b32 v97, s65, v97
    v_mul_u32_u24 v102, 384, v96
    v_lshl_add_u32 v102, v97, 4, v102
    v_xor_b32 v103, 16, v102
    s_mul_i32 s42, s65, 3072
    v_add_u32 v102, s42, v102
    s_sub_u32 s42, 3072, s42
    v_add_u32 v103, s42, v103
    v_and_b32 v96, 15, v111
    s_mov_b32 s42, 0x1011
    v_bfe_i32 v97, s42, v96, 1
    v_and_b32 v97, 0x3f803f80, v97
    v_accvgpr_write_b32 a236, v97
    v_accvgpr_write_b32 a237, v97
    v_accvgpr_write_b32 a238, v97
    v_accvgpr_write_b32 a239, v97
    s_mov_b32 s42, 0x3222
    v_bfe_i32 v97, s42, v96, 1
    v_and_b32 v97, 0x3f803f80, v97
    v_accvgpr_write_b32 a240, v97
    v_accvgpr_write_b32 a241, v97
    v_accvgpr_write_b32 a242, v97
    v_accvgpr_write_b32 a243, v97
    s_mov_b32 s42, 0x5444
    v_bfe_i32 v97, s42, v96, 1
    v_and_b32 v97, 0x3f803f80, v97
    v_accvgpr_write_b32 a244, v97
    v_accvgpr_write_b32 a245, v97
    v_accvgpr_write_b32 a246, v97
    v_accvgpr_write_b32 a247, v97
    s_mov_b32 s42, 0x9888
    v_bfe_i32 v97, s42, v96, 1
    v_and_b32 v97, 0x3f803f80, v97
    v_accvgpr_write_b32 a248, v97
    v_accvgpr_write_b32 a249, v97
    v_accvgpr_write_b32 a250, v97
    v_accvgpr_write_b32 a251, v97
    s_mov_b32 s42, 0x1100
    v_bfe_i32 v97, s42, v96, 1
    v_and_b32 v97, 0x3f803f80, v97
    v_accvgpr_write_b32 a252, v97
    v_accvgpr_write_b32 a253, v97
    v_accvgpr_write_b32 a254, v97
    v_accvgpr_write_b32 a255, v97
    s_waitcnt vmcnt(18)
    s_barrier
    s_waitcnt vmcnt(12)
    s_add_u32 s48, s34, 18432
    s_add_u32 m0, s38, 18432
    s_nop 0
    buffer_load_dwordx4 v6, s[12:15], s48 offen nt lds
    s_add_u32 m0, s38, 19456
    s_nop 0
    buffer_load_dwordx4 v7, s[12:15], s48 offen nt lds
    ds_read_b128 a[216:219], v1 offset:0
    s_add_u32 s48, s34, 18560
    s_add_u32 m0, s38, 20480
    v_mbcnt_lo_u32_b32 v107, -1, 0
    v_and_b32 v104, 0x3ff, v0
    v_mbcnt_hi_u32_b32 v107, -1, v107
    buffer_load_dwordx4 v6, s[12:15], s48 offen nt lds
    s_add_u32 m0, s38, 21504
    ds_read_b128 a[212:215], v0 offset:0
    v_lshrrev_b32 v105, 11, v0
    buffer_load_dwordx4 v7, s[12:15], s48 offen nt lds
    s_add_u32 s48, s34, 18688
    v_and_b32 v106, 15, v107
    s_add_u32 m0, s38, 22528
    s_nop 0
    buffer_load_dwordx4 v6, s[12:15], s48 offen nt lds
    v_xor_b32 v105, s65, v105
    v_lshl_add_u32 v104, v105, 10, v104
    v_add_u32 v104, s38, v104
    s_add_u32 m0, s38, 23552
    s_nop 0
    buffer_load_dwordx4 v7, s[12:15], s48 offen nt lds
    v_xor_b32 v105, 64, v104
    ds_read_b128 a[96:99], v104 offset:0
    ds_read_b128 a[116:119], v105 offset:4096
    ds_read_b128 a[100:103], v105 offset:0
    ds_read_b128 a[220:223], v0 offset:1024
    ds_read_b128 a[112:115], v104 offset:4096
    ds_read_b128 a[104:107], v104 offset:2048
    ds_read_b128 a[108:111], v105 offset:2048
    s_waitcnt lgkmcnt(6)
    v_mfma_f32_16x16x32_bf16 v[52:55], a[212:215], a[96:99], 0
    s_waitcnt lgkmcnt(4)
    ds_read_b128 a[228:231], v0 offset:2048
    v_mfma_f32_16x16x32_bf16 v[52:55], a[216:219], a[100:103], v[52:55]
    s_waitcnt lgkmcnt(1)
    ds_read_b128 a[224:227], v1 offset:1024
    v_mfma_f32_16x16x32_bf16 v[52:55], a[220:223], a[104:107], v[52:55]
    ds_read_b128 a[232:235], v1 offset:2048
    ds_read_b128 a[220:223], v0 offset:7168
    s_waitcnt lgkmcnt(2)
    v_mfma_f32_16x16x32_bf16 v[52:55], a[224:227], a[108:111], v[52:55]
    ds_read_b128 a[212:215], v0 offset:6144
    v_mfma_f32_16x16x32_bf16 v[52:55], a[228:231], a[112:115], v[52:55]
    s_waitcnt lgkmcnt(1)
    ds_read_b128 a[224:227], v1 offset:7168
    v_mfma_f32_16x16x32_bf16 v[52:55], a[232:235], a[116:119], v[52:55]
    ds_read_b128 a[232:235], v1 offset:8192
    s_waitcnt lgkmcnt(2)
    v_mfma_f32_16x16x32_bf16 v[56:59], a[212:215], a[96:99], 0
    ds_read_b128 a[216:219], v1 offset:6144
    s_waitcnt lgkmcnt(0)
    v_mfma_f32_16x16x32_bf16 v[56:59], a[216:219], a[100:103], v[56:59]
    ds_read_b128 a[212:215], v0 offset:12288
    s_nop 0
    v_max3_f32 v96, v52, v53, v54
    v_mfma_f32_16x16x32_bf16 v[56:59], a[220:223], a[104:107], v[56:59]
    ds_read_b128 a[228:231], v0 offset:8192
    v_mfma_f32_16x16x32_bf16 v[56:59], a[224:227], a[108:111], v[56:59]
    ds_read_b128 a[220:223], v0 offset:13312
    s_waitcnt lgkmcnt(1)
    v_mfma_f32_16x16x32_bf16 v[56:59], a[228:231], a[112:115], v[56:59]
    ds_read_b128 a[216:219], v1 offset:12288
    v_mfma_f32_16x16x32_bf16 v[56:59], a[232:235], a[116:119], v[56:59]
    s_nop 7
    v_max3_f32 v96, v96, v55, v56
    v_max3_f32 v96, v96, v57, v58
    v_max_f32 v96, v96, v59
    v_mov_b32 v97, v96
    s_nop 1
    v_permlane32_swap_b32 v97, v96
    v_max_f32 v96, v96, v97
    v_mov_b32 v97, v96
    s_nop 1
    v_permlane16_swap_b32 v97, v96
    v_max_f32 v96, v96, v97
    v_mul_f32_e64 v9, -s28, v96
    ds_read_b128 a[228:231], v0 offset:14336
    v_fma_f32 v52, v52, s28, v9
    v_mul_u32_u24 v106, 384, v106
    v_lshrrev_b32 v107, 4, v107
    v_fma_f32 v58, v58, s28, v9
    v_fma_f32 v54, v54, s28, v9
    v_fma_f32 v59, v59, s28, v9
    v_fma_f32 v55, v55, s28, v9
    v_exp_f32 v54, v54
    v_fma_f32 v53, v53, s28, v9
    ds_read_b128 a[224:227], v1 offset:13312
    v_fma_f32 v57, v57, s28, v9
    v_fma_f32 v56, v56, s28, v9
    v_exp_f32 v57, v57
    v_exp_f32 v58, v58
    v_lshl_add_u32 v106, v107, 4, v106
    v_exp_f32 v55, v55
    s_nop 0
    v_cvt_pk_bf16_f32 v15, v54, v55
    v_exp_f32 v53, v53
    v_exp_f32 v52, v52
    s_nop 0
    v_cvt_pk_bf16_f32 v14, v52, v53
    v_exp_f32 v56, v56
    s_waitcnt vmcnt(12)
    s_add_u32 s48, s34, 24576
    s_add_u32 m0, s38, 24576
    s_nop 0
    buffer_load_dwordx4 v6, s[12:15], s48 offen nt lds
    s_add_u32 m0, s38, 25600
    v_mfma_f32_16x16x32_bf16 v[52:55], a[212:215], a[96:99], 0
    buffer_load_dwordx4 v7, s[12:15], s48 offen nt lds
    s_add_u32 s48, s34, 24704
    v_exp_f32 v59, v59
    s_add_u32 m0, s38, 26624
    ds_read_b128 a[212:215], v0 offset:18432
    s_waitcnt lgkmcnt(1)
    v_mfma_f32_16x16x32_bf16 v[52:55], a[216:219], a[100:103], v[52:55]
    buffer_load_dwordx4 v6, s[12:15], s48 offen nt lds
    ds_read_b128 a[216:219], v1 offset:18432
    v_mfma_f32_16x16x32_bf16 v[52:55], a[220:223], a[104:107], v[52:55]
    ds_read_b128 a[136:139], v104 offset:10240
    s_add_u32 m0, s38, 27648
    s_nop 0
    buffer_load_dwordx4 v7, s[12:15], s48 offen nt lds
    v_cvt_pk_bf16_f32 v17, v58, v59
    v_mfma_f32_16x16x32_bf16 v[52:55], a[224:227], a[108:111], v[52:55]
    s_add_u32 s48, s34, 24576
    v_cvt_pk_bf16_f32 v16, v56, v57
    buffer_load_dwordx4 a[208:211], v106, s[12:15], s48 offen offset:256 nt
    ds_read_b128 a[232:235], v1 offset:14336
    ds_read_b128 a[120:123], v104 offset:6144
    v_mfma_f32_16x16x32_bf16 v[52:55], a[228:231], a[112:115], v[52:55]
    ds_read_b128 a[132:135], v105 offset:8192
    buffer_load_dwordx4 v[92:95], v106, s[12:15], s48 offen offset:320 nt
    s_waitcnt lgkmcnt(2)
    v_mfma_f32_16x16x32_bf16 v[52:55], a[232:235], a[116:119], v[52:55]
    ds_read_b128 a[228:231], v0 offset:20480
    ds_read_b128 a[220:223], v0 offset:19456
    ds_read_b128 a[140:143], v105 offset:10240
    v_mfma_f32_16x16x32_bf16 v[56:59], a[212:215], a[96:99], 0
    ds_read_b128 a[224:227], v1 offset:19456
    ds_read_b128 a[128:131], v104 offset:8192
    v_mfma_f32_16x16x32_bf16 v[56:59], a[216:219], a[100:103], v[56:59]
    ds_read_b128 a[212:215], v0 offset:0
    s_waitcnt lgkmcnt(4)
    v_mfma_f32_16x16x32_bf16 v[56:59], a[220:223], a[104:107], v[56:59]
    ds_read_b128 a[124:127], v105 offset:6144
    s_waitcnt lgkmcnt(3)
    v_mfma_f32_16x16x32_bf16 v[56:59], a[224:227], a[108:111], v[56:59]
    ds_read_b128 a[232:235], v1 offset:20480
    v_mfma_f32_16x16x32_bf16 v[56:59], a[228:231], a[112:115], v[56:59]
    ds_read_b128 a[216:219], v1 offset:0
    s_waitcnt lgkmcnt(1)
    v_mfma_f32_16x16x32_bf16 v[56:59], a[232:235], a[116:119], v[56:59]
    ds_read_b128 a[224:227], v1 offset:1024
    v_mfma_f32_16x16x32_bf16 v[60:63], a[212:215], a[120:123], 0
    s_waitcnt lgkmcnt(1)
    ds_read_b128 a[220:223], v0 offset:1024
    v_mfma_f32_16x16x32_bf16 v[60:63], a[216:219], a[124:127], v[60:63]
    ds_read_b128 a[228:231], v0 offset:2048
    s_waitcnt lgkmcnt(1)
    v_mfma_f32_16x16x32_bf16 v[60:63], a[220:223], a[128:131], v[60:63]
    ds_read_b128 a[232:235], v1 offset:2048
    ds_read_b128 a[212:215], v0 offset:6144
    v_mfma_f32_16x16x32_bf16 v[60:63], a[224:227], a[132:135], v[60:63]
    s_waitcnt lgkmcnt(2)
    ds_read_b128 a[224:227], v1 offset:7168
    v_mfma_f32_16x16x32_bf16 v[60:63], a[228:231], a[136:139], v[60:63]
    ds_read_b128 a[220:223], v0 offset:7168
    s_waitcnt lgkmcnt(3)
    v_mfma_f32_16x16x32_bf16 v[60:63], a[232:235], a[140:143], v[60:63]
    s_waitcnt lgkmcnt(2)
    ds_read_b128 a[216:219], v1 offset:6144
    v_mfma_f32_16x16x32_bf16 v[64:67], a[212:215], a[120:123], 0
    ds_read_b128 a[232:235], v1 offset:8192
    s_nop 3
    v_max3_f32 v98, v60, v61, v62
    s_waitcnt lgkmcnt(1)
    v_mfma_f32_16x16x32_bf16 v[64:67], a[216:219], a[124:127], v[64:67]
    ds_read_b128 a[228:231], v0 offset:8192
    v_mfma_f32_16x16x32_bf16 v[64:67], a[220:223], a[128:131], v[64:67]
    ds_read_b128 a[212:215], v0 offset:12288
    v_fma_f32 v52, v52, s28, v9
    v_mfma_f32_16x16x32_bf16 v[64:67], a[224:227], a[132:135], v[64:67]
    ds_read_b128 a[220:223], v0 offset:13312
    s_waitcnt lgkmcnt(2)
    v_mfma_f32_16x16x32_bf16 v[64:67], a[228:231], a[136:139], v[64:67]
    ds_read_b128 a[216:219], v1 offset:12288
    v_mfma_f32_16x16x32_bf16 v[64:67], a[232:235], a[140:143], v[64:67]
    ds_read_b128 a[224:227], v1 offset:13312
    s_nop 6
    v_max3_f32 v98, v98, v63, v64
    ds_read_b128 a[228:231], v0 offset:14336
    v_max3_f32 v98, v98, v65, v66
    v_max_f32 v98, v98, v67
    v_mov_b32 v99, v98
    s_nop 1
    v_permlane32_swap_b32 v99, v98
    v_max_f32 v98, v98, v99
    v_mov_b32 v99, v98
    s_nop 1
    v_permlane16_swap_b32 v99, v98
    v_max_f32 v98, v98, v99
    s_waitcnt vmcnt(12)
    s_add_u32 m0, s22, 24576
    s_nop 0
    buffer_load_dwordx4 v6, s[8:11], s21 offen lds
    s_add_u32 s21, s21, 128
    s_add_u32 m0, s22, 25600
    v_mfma_f32_16x16x32_bf16 v[44:47], a[236:239], v[14:17], 0
    buffer_load_dwordx4 v6, s[8:11], s21 offen lds
    v_mul_f32_e64 v10, -s28, v98
    s_add_u32 s21, s21, 128
    v_fma_f32 v65, v65, s28, v10
    ds_read_b128 a[144:147], v104 offset:12288
    s_add_u32 m0, s22, 26624
    s_nop 0
    buffer_load_dwordx4 v6, s[8:11], s21 offen lds
    v_exp_f32 v65, v65
    ds_read_b128 a[152:155], v104 offset:14336
    v_fma_f32 v60, v60, s28, v10
    v_fma_f32 v62, v62, s28, v10
    v_exp_f32 v60, v60
    v_fma_f32 v67, v67, s28, v10
    v_fma_f32 v53, v53, s28, v9
    v_fma_f32 v63, v63, s28, v10
    v_fma_f32 v66, v66, s28, v10
    v_exp_f32 v67, v67
    v_fma_f32 v61, v61, s28, v10
    v_exp_f32 v61, v61
    v_exp_f32 v62, v62
    v_exp_f32 v66, v66
    v_exp_f32 v63, v63
    v_cvt_pk_bf16_f32 v20, v60, v61
    v_cvt_pk_bf16_f32 v21, v62, v63
    v_fma_f32 v64, v64, s28, v10
    s_waitcnt lgkmcnt(2)
    v_mfma_f32_16x16x32_bf16 v[60:63], a[212:215], a[120:123], 0
    ds_read_b128 a[232:235], v1 offset:14336
    v_mfma_f32_16x16x32_bf16 v[60:63], a[216:219], a[124:127], v[60:63]
    ds_read_b128 a[148:151], v105 offset:12288
    v_mfma_f32_16x16x32_bf16 v[60:63], a[220:223], a[128:131], v[60:63]
    v_cvt_pk_bf16_f32 v23, v66, v67
    ds_read_b128 a[220:223], v0 offset:19456
    v_mfma_f32_16x16x32_bf16 v[60:63], a[224:227], a[132:135], v[60:63]
    ds_read_b128 a[216:219], v1 offset:18432
    v_mfma_f32_16x16x32_bf16 v[60:63], a[228:231], a[136:139], v[60:63]
    v_exp_f32 v64, v64
    ds_read_b128 a[224:227], v1 offset:19456
    ds_read_b128 a[212:215], v0 offset:18432
    v_cvt_pk_bf16_f32 v22, v64, v65
    s_waitcnt lgkmcnt(5)
    v_mfma_f32_16x16x32_bf16 v[60:63], a[232:235], a[140:143], v[60:63]
    ds_read_b128 a[156:159], v105 offset:14336
    s_waitcnt lgkmcnt(1)
    v_mfma_f32_16x16x32_bf16 v[64:67], a[212:215], a[120:123], 0
    ds_read_b128 a[228:231], v0 offset:20480
    v_mfma_f32_16x16x32_bf16 v[64:67], a[216:219], a[124:127], v[64:67]
    s_nop 2
    v_fma_f32 v60, v60, s28, v10
    ds_read_b128 a[232:235], v1 offset:20480
    v_mfma_f32_16x16x32_bf16 v[64:67], a[220:223], a[128:131], v[64:67]
    ds_read_b128 a[216:219], v1 offset:0
    v_mfma_f32_16x16x32_bf16 v[64:67], a[224:227], a[132:135], v[64:67]
    s_add_u32 s21, s21, 12032
    ds_read_b128 a[212:215], v0 offset:0
    s_waitcnt lgkmcnt(3)
    v_mfma_f32_16x16x32_bf16 v[64:67], a[228:231], a[136:139], v[64:67]
    ds_read_b128 a[224:227], v1 offset:1024
    s_waitcnt lgkmcnt(3)
    v_mfma_f32_16x16x32_bf16 v[64:67], a[232:235], a[140:143], v[64:67]
    ds_read_b128 a[160:163], v104 offset:16384
    s_waitcnt lgkmcnt(2)
    v_mfma_f32_16x16x32_bf16 v[68:71], a[212:215], a[144:147], 0
    ds_read_b128 a[220:223], v0 offset:1024
    v_mfma_f32_16x16x32_bf16 v[68:71], a[216:219], a[148:151], v[68:71]
    ds_read_b128 a[228:231], v0 offset:2048
    s_waitcnt lgkmcnt(1)
    v_mfma_f32_16x16x32_bf16 v[68:71], a[220:223], a[152:155], v[68:71]
    ds_read_b128 a[164:167], v105 offset:16384
    v_mfma_f32_16x16x32_bf16 v[68:71], a[224:227], a[156:159], v[68:71]
    s_waitcnt lgkmcnt(1)
    ds_read_b128 a[232:235], v1 offset:2048
    ds_read_b128 a[212:215], v0 offset:6144
    v_mfma_f32_16x16x32_bf16 v[68:71], a[228:231], a[160:163], v[68:71]
    ds_read_b128 a[220:223], v0 offset:7168
    ds_read_b128 a[216:219], v1 offset:6144
    s_waitcnt lgkmcnt(3)
    v_mfma_f32_16x16x32_bf16 v[68:71], a[232:235], a[164:167], v[68:71]
    s_waitcnt lgkmcnt(2)
    ds_read_b128 a[232:235], v1 offset:8192
    v_mfma_f32_16x16x32_bf16 v[72:75], a[212:215], a[144:147], 0
    s_waitcnt lgkmcnt(1)
    ds_read_b128 a[224:227], v1 offset:7168
    v_mfma_f32_16x16x32_bf16 v[72:75], a[216:219], a[148:151], v[72:75]
    ds_read_b128 a[228:231], v0 offset:8192
    v_exp_f32 v53, v53
    v_mfma_f32_16x16x32_bf16 v[72:75], a[220:223], a[152:155], v[72:75]
    ds_read_b128 a[216:219], v1 offset:12288
    s_waitcnt lgkmcnt(2)
    v_mfma_f32_16x16x32_bf16 v[72:75], a[224:227], a[156:159], v[72:75]
    ds_read_b128 a[220:223], v0 offset:13312
    v_max3_f32 v96, v68, v69, v70
    s_waitcnt lgkmcnt(2)
    v_mfma_f32_16x16x32_bf16 v[72:75], a[228:231], a[160:163], v[72:75]
    ds_read_b128 a[212:215], v0 offset:12288
    v_mfma_f32_16x16x32_bf16 v[72:75], a[232:235], a[164:167], v[72:75]
    s_nop 7
    v_max3_f32 v96, v96, v71, v72
    v_max3_f32 v96, v96, v73, v74
    v_max_f32 v96, v96, v75
    v_mov_b32 v97, v96
    s_nop 1
    v_permlane32_swap_b32 v97, v96
    v_max_f32 v96, v96, v97
    v_mov_b32 v97, v96
    s_nop 1
    v_permlane16_swap_b32 v97, v96
    v_max_f32 v96, v96, v97
    ds_read_b128 a[224:227], v1 offset:13312
    v_mul_f32_e64 v11, -s28, v96
    v_fma_f32 v71, v71, s28, v11
    v_fma_f32 v74, v74, s28, v11
    v_fma_f32 v70, v70, s28, v11
    v_fma_f32 v73, v73, s28, v11
    v_fma_f32 v72, v72, s28, v11
    v_exp_f32 v74, v74
    v_fma_f32 v75, v75, s28, v11
    v_fma_f32 v69, v69, s28, v11
    v_fma_f32 v68, v68, s28, v11
    v_exp_f32 v72, v72
    v_exp_f32 v69, v69
    v_exp_f32 v68, v68
    v_exp_f32 v71, v71
    v_exp_f32 v70, v70
    s_nop 0
    v_cvt_pk_bf16_f32 v27, v70, v71
    v_cvt_pk_bf16_f32 v26, v68, v69
    v_exp_f32 v73, v73
    s_waitcnt vmcnt(9)
    s_add_u32 m0, s22, 36864
    s_nop 0
    buffer_load_dwordx4 v6, s[8:11], s21 offen lds
    s_add_u32 s21, s21, 128
    s_add_u32 m0, s22, 37888
    s_waitcnt lgkmcnt(0)
    v_mfma_f32_16x16x32_bf16 v[68:71], a[212:215], a[144:147], 0
    buffer_load_dwordx4 v6, s[8:11], s21 offen lds
    ds_read_b128 a[232:235], v1 offset:14336
    s_add_u32 s21, s21, 128
    v_mfma_f32_16x16x32_bf16 v[68:71], a[216:219], a[148:151], v[68:71]
    s_add_u32 m0, s22, 38912
    ds_read_b128 a[228:231], v0 offset:14336
    ds_read_b128 a[212:215], v0 offset:18432
    buffer_load_dwordx4 v6, s[8:11], s21 offen lds
    v_mfma_f32_16x16x32_bf16 v[44:47], a[240:243], v[20:23], v[44:47]
    ds_read_b128 a[168:171], v104 offset:18432
    v_mfma_f32_16x16x32_bf16 v[68:71], a[220:223], a[152:155], v[68:71]
    v_fma_f32 v63, v63, s28, v10
    v_exp_f32 v75, v75
    ds_read_b128 a[220:223], v0 offset:19456
    v_fma_f32 v55, v55, s28, v9
    v_exp_f32 v52, v52
    ds_read_b128 a[216:219], v1 offset:18432
    v_mfma_f32_16x16x32_bf16 v[68:71], a[224:227], a[156:159], v[68:71]
    ds_read_b128 a[224:227], v1 offset:19456
    s_waitcnt lgkmcnt(5)
    v_mfma_f32_16x16x32_bf16 v[68:71], a[228:231], a[160:163], v[68:71]
    v_cvt_pk_bf16_f32 v29, v74, v75
    ds_read_b128 a[184:187], v104 offset:22528
    v_cvt_pk_bf16_f32 v28, v72, v73
    v_mfma_f32_16x16x32_bf16 v[68:71], a[232:235], a[164:167], v[68:71]
    s_waitcnt lgkmcnt(4)
    v_exp_f32 v55, v55
    ds_read_b128 a[176:179], v104 offset:20480
    v_mfma_f32_16x16x32_bf16 v[72:75], a[212:215], a[144:147], 0
    ds_read_b128 a[228:231], v0 offset:20480
    s_waitcnt lgkmcnt(4)
    v_mfma_f32_16x16x32_bf16 v[72:75], a[216:219], a[148:151], v[72:75]
    v_fma_f32 v61, v61, s28, v10
    ds_read_b128 a[232:235], v1 offset:20480
    v_mfma_f32_16x16x32_bf16 v[72:75], a[220:223], a[152:155], v[72:75]
    ds_read_b128 a[212:215], v0 offset:0
    ds_read_b128 a[216:219], v1 offset:0
    ds_read_b128 a[172:175], v105 offset:18432
    v_exp_f32 v63, v63
    ds_read_b128 a[220:223], v0 offset:1024
    s_waitcnt lgkmcnt(8)
    v_mfma_f32_16x16x32_bf16 v[72:75], a[224:227], a[156:159], v[72:75]
    ds_read_b128 a[224:227], v1 offset:1024
    ds_read_b128 a[180:183], v105 offset:20480
    s_waitcnt lgkmcnt(7)
    v_mfma_f32_16x16x32_bf16 v[72:75], a[228:231], a[160:163], v[72:75]
    v_exp_f32 v61, v61
    ds_read_b128 a[188:191], v105 offset:22528
    s_waitcnt lgkmcnt(7)
    v_mfma_f32_16x16x32_bf16 v[72:75], a[232:235], a[164:167], v[72:75]
    ds_read_b128 a[232:235], v1 offset:2048
    s_waitcnt lgkmcnt(6)
    v_mfma_f32_16x16x32_bf16 v[76:79], a[212:215], a[168:171], 0
    s_waitcnt lgkmcnt(5)
    ds_read_b128 a[228:231], v0 offset:2048
    v_mfma_f32_16x16x32_bf16 v[76:79], a[216:219], a[172:175], v[76:79]
    s_waitcnt lgkmcnt(5)
    ds_read_b128 a[212:215], v0 offset:6144
    v_mfma_f32_16x16x32_bf16 v[76:79], a[220:223], a[176:179], v[76:79]
    ds_read_b128 a[216:219], v1 offset:6144
    s_waitcnt lgkmcnt(5)
    v_mfma_f32_16x16x32_bf16 v[76:79], a[224:227], a[180:183], v[76:79]
    ds_read_b128 a[220:223], v0 offset:7168
    s_waitcnt lgkmcnt(3)
    v_mfma_f32_16x16x32_bf16 v[76:79], a[228:231], a[184:187], v[76:79]
    ds_read_b128 a[224:227], v1 offset:7168
    v_mfma_f32_16x16x32_bf16 v[76:79], a[232:235], a[188:191], v[76:79]
    s_waitcnt lgkmcnt(3)
    ds_read_b128 a[232:235], v1 offset:8192
    v_mfma_f32_16x16x32_bf16 v[80:83], a[212:215], a[168:171], 0
    s_waitcnt lgkmcnt(3)
    ds_read_b128 a[212:215], v0 offset:12288
    v_mfma_f32_16x16x32_bf16 v[80:83], a[216:219], a[172:175], v[80:83]
    s_waitcnt lgkmcnt(3)
    ds_read_b128 a[216:219], v1 offset:12288
    v_mfma_f32_16x16x32_bf16 v[80:83], a[220:223], a[176:179], v[80:83]
    v_max3_f32 v98, v76, v77, v78
    ds_read_b128 a[228:231], v0 offset:8192
    s_add_u32 s21, s21, 12032
    s_waitcnt lgkmcnt(4)
    v_mfma_f32_16x16x32_bf16 v[80:83], a[224:227], a[180:183], v[80:83]
    ds_read_b128 a[220:223], v0 offset:13312
    s_waitcnt lgkmcnt(1)
    v_mfma_f32_16x16x32_bf16 v[80:83], a[228:231], a[184:187], v[80:83]
    ds_read_b128 a[224:227], v1 offset:13312
    v_fma_f32 v54, v54, s28, v9
    v_mfma_f32_16x16x32_bf16 v[80:83], a[232:235], a[188:191], v[80:83]
    s_nop 7
    v_max3_f32 v98, v98, v79, v80
    v_max3_f32 v98, v98, v81, v82
    v_max_f32 v98, v98, v83
    v_mov_b32 v99, v98
    s_nop 1
    v_permlane32_swap_b32 v99, v98
    v_max_f32 v98, v98, v99
    v_mov_b32 v99, v98
    s_nop 1
    v_permlane16_swap_b32 v99, v98
    ds_read_b128 a[232:235], v1 offset:14336
    v_max_f32 v98, v98, v99
    v_mul_f32_e64 v12, -s28, v98
    v_fma_f32 v76, v76, s28, v12
    v_fma_f32 v79, v79, s28, v12
    v_fma_f32 v83, v83, s28, v12
    v_fma_f32 v77, v77, s28, v12
    v_fma_f32 v62, v62, s28, v10
    v_fma_f32 v78, v78, s28, v12
    v_exp_f32 v76, v76
    v_exp_f32 v79, v79
    v_exp_f32 v78, v78
    v_fma_f32 v82, v82, s28, v12
    v_exp_f32 v60, v60
    v_exp_f32 v77, v77
    s_nop 0
    v_cvt_pk_bf16_f32 v32, v76, v77
    v_cvt_pk_bf16_f32 v33, v78, v79
    v_mfma_f32_16x16x32_bf16 v[76:79], a[212:215], a[168:171], 0
    ds_read_b128 a[228:231], v0 offset:14336
    v_exp_f32 v83, v83
    v_mfma_f32_16x16x32_bf16 v[76:79], a[216:219], a[172:175], v[76:79]
    s_waitcnt lgkmcnt(2)
    ds_read_b128 a[216:219], v1 offset:18432
    v_exp_f32 v62, v62
    v_mfma_f32_16x16x32_bf16 v[76:79], a[220:223], a[176:179], v[76:79]
    v_fma_f32 v81, v81, s28, v12
    ds_read_b128 a[212:215], v0 offset:18432
    v_exp_f32 v82, v82
    v_exp_f32 v81, v81
    v_mfma_f32_16x16x32_bf16 v[76:79], a[224:227], a[180:183], v[76:79]
    ds_read_b128 a[224:227], v1 offset:19456
    s_waitcnt lgkmcnt(3)
    v_mfma_f32_16x16x32_bf16 v[76:79], a[228:231], a[184:187], v[76:79]
    v_fma_f32 v80, v80, s28, v12
    ds_read_b128 a[220:223], v0 offset:19456
    v_mfma_f32_16x16x32_bf16 v[76:79], a[232:235], a[188:191], v[76:79]
    v_cvt_pk_bf16_f32 v35, v82, v83
    v_exp_f32 v80, v80
    s_nop 0
    v_cvt_pk_bf16_f32 v34, v80, v81
    ds_read_b128 a[228:231], v0 offset:20480
    s_waitcnt lgkmcnt(3)
    v_mfma_f32_16x16x32_bf16 v[80:83], a[212:215], a[168:171], 0
    ds_read_b128 a[232:235], v1 offset:20480
    v_mfma_f32_16x16x32_bf16 v[80:83], a[216:219], a[172:175], v[80:83]
    ds_read_b128 a[216:219], v1 offset:0
    s_waitcnt lgkmcnt(3)
    v_mfma_f32_16x16x32_bf16 v[80:83], a[220:223], a[176:179], v[80:83]
    ds_read_b128 a[220:223], v0 offset:1024
    v_mfma_f32_16x16x32_bf16 v[44:47], a[244:247], v[26:29], v[44:47]
    v_cvt_pk_bf16_f32 v18, v52, v53
    ds_read_b128 a[212:215], v0 offset:0
    v_mfma_f32_16x16x32_bf16 v[80:83], a[224:227], a[180:183], v[80:83]
    s_waitcnt vmcnt(6)
    ds_read_b128 a[192:195], v104 offset:24576
    ds_read_b128 a[200:203], v104 offset:26624
    ds_read_b128 a[224:227], v1 offset:1024
    ds_read_b128 a[196:199], v105 offset:24576
    s_waitcnt lgkmcnt(6)
    v_mfma_f32_16x16x32_bf16 v[80:83], a[228:231], a[184:187], v[80:83]
    ds_read_b128 a[204:207], v105 offset:26624
    v_mfma_f32_16x16x32_bf16 v[80:83], a[232:235], a[188:191], v[80:83]
    ds_read_b128 a[232:235], v1 offset:2048
    v_mfma_f32_16x16x32_bf16 v[44:47], a[248:251], v[32:35], v[44:47]
    ds_read_b128 a[228:231], v0 offset:2048
    v_exp_f32 v54, v54
    s_waitcnt lgkmcnt(6)
    v_mfma_f32_16x16x32_bf16 v[84:87], a[212:215], a[192:195], 0
    ds_read_b128 a[212:215], v0 offset:6144
    s_waitcnt lgkmcnt(4)
    v_mfma_f32_16x16x32_bf16 v[84:87], a[216:219], a[196:199], v[84:87]
    ds_read_b128 a[216:219], v1 offset:6144
    v_mfma_f32_16x16x32_bf16 v[84:87], a[220:223], a[200:203], v[84:87]
    s_waitcnt lgkmcnt(4)
    ds_read_b128 a[220:223], v0 offset:7168
    v_mfma_f32_16x16x32_bf16 v[84:87], a[224:227], a[204:207], v[84:87]
    ds_read_b128 a[224:227], v1 offset:7168
    s_waitcnt lgkmcnt(4)
    v_mfma_f32_16x16x32_bf16 v[84:87], a[228:231], a[208:211], v[84:87]
    ds_read_b128 a[228:231], v0 offset:8192
    v_mfma_f32_16x16x32_bf16 v[84:87], a[232:235], v[92:95], v[84:87]
    ds_read_b128 a[232:235], v1 offset:8192
    s_waitcnt lgkmcnt(5)
    v_mfma_f32_16x16x32_bf16 v[88:91], a[212:215], a[192:195], 0
    s_waitcnt lgkmcnt(4)
    v_mfma_f32_16x16x32_bf16 v[88:91], a[216:219], a[196:199], v[88:91]
    s_waitcnt lgkmcnt(3)
    v_mfma_f32_16x16x32_bf16 v[88:91], a[220:223], a[200:203], v[88:91]
    s_nop 0
    v_max3_f32 v96, v84, v85, v86
    s_waitcnt vmcnt(63) lgkmcnt(0)
    s_barrier
    ds_read_b128 a[216:219], v1 offset:12288
    v_mfma_f32_16x16x32_bf16 v[88:91], a[224:227], a[204:207], v[88:91]
    s_add_u32 m0, s22, 0
    ds_read_b128 a[224:227], v1 offset:13312
    buffer_load_dwordx4 v6, s[4:7], s20 offen lds
    s_add_u32 s20, s20, 128
    v_mfma_f32_16x16x32_bf16 v[88:91], a[228:231], a[208:211], v[88:91]
    s_add_u32 m0, s22, 1024
    ds_read_b128 a[212:215], v0 offset:12288
    buffer_load_dwordx4 v6, s[4:7], s20 offen lds
    v_mfma_f32_16x16x32_bf16 v[88:91], a[232:235], v[92:95], v[88:91]
    s_add_u32 s20, s20, 128
    s_add_u32 m0, s22, 2048
    ds_read_b128 a[220:223], v0 offset:13312
    buffer_load_dwordx4 v6, s[4:7], s20 offen lds
    s_add_u32 s20, s20, 12032
    ds_read_b128 a[232:235], v1 offset:14336
    s_mov_b32 s39, s64
    ds_read_b128 a[228:231], v0 offset:14336
    v_max3_f32 v96, v96, v87, v88
    v_max3_f32 v96, v96, v89, v90
    v_max_f32 v96, v96, v91
    v_mov_b32 v97, v96
    s_add_u32 s37, s37, 1
    s_bitcmp1_b32 s63, s37
    v_permlane32_swap_b32 v97, v96
    v_max_f32 v96, v96, v97
    v_mov_b32 v97, v96
    s_cselect_b32 s62, 4294770688, 0
    s_cselect_b32 s42, 0, 325632
    v_permlane16_swap_b32 v97, v96
    v_max_f32 v96, v96, v97
    v_mul_f32_e64 v13, -s28, v96
    v_fma_f32 v87, v87, s28, v13
    v_fma_f32 v86, v86, s28, v13
    v_fma_f32 v84, v84, s28, v13
    v_fma_f32 v85, v85, s28, v13
    v_exp_f32 v85, v85
    v_exp_f32 v84, v84
    v_exp_f32 v87, v87
    s_add_u32 s35, s35, s42
    v_exp_f32 v86, v86
    v_cvt_pk_bf16_f32 v38, v84, v85
    v_cvt_pk_bf16_f32 v39, v86, v87
    s_waitcnt lgkmcnt(2)
    v_mfma_f32_16x16x32_bf16 v[84:87], a[212:215], a[192:195], 0
    s_lshl_b32 s42, s37, 1
    ds_read_b128 a[212:215], v0 offset:18432
    v_fma_f32 v88, v88, s28, v13
    v_mfma_f32_16x16x32_bf16 v[84:87], a[216:219], a[196:199], v[84:87]
    s_lshr_b32 s42, s31, s42
    ds_read_b128 a[216:219], v1 offset:18432
    v_fma_f32 v89, v89, s28, v13
    v_mfma_f32_16x16x32_bf16 v[84:87], a[220:223], a[200:203], v[84:87]
    s_and_b32 s42, s42, 3
    ds_read_b128 a[220:223], v0 offset:19456
    v_fma_f32 v90, v90, s28, v13
    v_mfma_f32_16x16x32_bf16 v[84:87], a[224:227], a[204:207], v[84:87]
    s_waitcnt lgkmcnt(3)
    ds_read_b128 a[224:227], v1 offset:19456
    s_add_u32 s42, s42, s36
    v_mfma_f32_16x16x32_bf16 v[84:87], a[228:231], a[208:211], v[84:87]
    s_sub_u32 s43, s42, 3
    ds_read_b128 a[228:231], v0 offset:20480
    v_fma_f32 v91, v91, s28, v13
    v_mfma_f32_16x16x32_bf16 v[84:87], a[232:235], v[92:95], v[84:87]
    s_cmp_ge_u32 s42, 3
    ds_read_b128 a[232:235], v1 offset:20480
    s_cselect_b32 s42, s43, s42
    s_mul_i32 s44, s3, 5
    s_mov_b32 s32, 1
    v_exp_f32 v89, v89
    s_lshl_b32 s43, s3, 2
    s_add_u32 s45, s43, 21
    s_cmp_eq_u32 s3, 0
    s_cselect_b32 s45, 20, s45
    s_cselect_b32 s33, 1, 0
    s_cmp_eq_u32 s42, 1
    s_cselect_b32 s44, s45, s44
    s_cselect_b32 s32, s33, s32
    s_add_u32 s45, s43, 37
    s_cmp_eq_u32 s42, 2
    s_cselect_b32 s44, s45, s44
    v_exp_f32 v88, v88
    s_cselect_b32 s32, 0, s32
    v_exp_f32 v90, v90
    s_mul_i32 s44, s44, 6144
    s_add_u32 s33, s35, s44
    s_mul_i32 s42, s32, 6144
    v_exp_f32 v91, v91
    s_add_u32 s42, s42, 24576
    s_add_u32 s42, s42, s33
    s_cmp_ge_u32 s37, 6
    s_cselect_b32 s14, 0, s42
    s_add_u32 s24, s67, 256
    v_cvt_pk_bf16_f32 v41, v90, v91
    v_cvt_pk_bf16_f32 v40, v88, v89
    s_add_u32 s25, s33, 256
    s_add_u32 s23, s38, 4096
    s_mov_b32 s27, 0x49249249
    s_mov_b32 s30, 0
    s_waitcnt vmcnt(6) lgkmcnt(0)
    v_mfma_f32_16x16x32_bf16 v[88:91], a[212:215], a[192:195], 0
    s_barrier
    ds_read_b64_tr_b16 a[212:213], v2 offset:0
    ds_read_b64_tr_b16 a[214:215], v2 offset:6144
    v_mfma_f32_16x16x32_bf16 v[88:91], a[216:219], a[196:199], v[88:91]
    s_add_u32 m0, s22, 12288
    ds_read_b64_tr_b16 a[216:217], v3 offset:0
    ds_read_b64_tr_b16 a[218:219], v3 offset:6144
    buffer_load_dwordx4 v6, s[4:7], s20 offen lds
    v_mfma_f32_16x16x32_bf16 v[88:91], a[220:223], a[200:203], v[88:91]
    v_cvt_pk_bf16_f32 v25, v62, v63
    ds_read_b64_tr_b16 a[220:221], v4 offset:0
    v_mfma_f32_16x16x32_bf16 v[88:91], a[224:227], a[204:207], v[88:91]
    ds_read_b64_tr_b16 a[222:223], v4 offset:6144
    s_add_u32 s20, s20, 128
    s_add_u32 m0, s22, 13312
    s_nop 0
    buffer_load_dwordx4 v6, s[4:7], s20 offen lds
    v_mfma_f32_16x16x32_bf16 v[88:91], a[228:231], a[208:211], v[88:91]
    ds_read_b64_tr_b16 a[224:225], v5 offset:0
    v_cvt_pk_bf16_f32 v24, v60, v61
    s_add_u32 s20, s20, 128
    v_mfma_f32_16x16x32_bf16 v[44:47], a[252:255], v[38:41], v[44:47]
    ds_read_b64_tr_b16 a[226:227], v5 offset:6144
    v_cvt_pk_bf16_f32 v19, v54, v55
    s_add_u32 m0, s22, 14336
    s_nop 0
    buffer_load_dwordx4 v6, s[4:7], s20 offen lds
    s_add_u32 s20, s20, 12032
    v_mfma_f32_16x16x32_bf16 v[88:91], a[232:235], v[92:95], v[88:91]
    s_waitcnt lgkmcnt(4)
    v_mfma_f32_16x16x32_bf16 v[112:115], a[212:215], v[14:17], 0
    ds_read_b64_tr_b16 a[234:235], v3 offset:7168
    v_add_u32 v8, 4096, v8
    v_mfma_f32_16x16x32_bf16 v[116:119], a[216:219], v[14:17], 0
    v_fma_f32 v82, v82, s28, v12
    v_fma_f32 v59, v59, s28, v9
    v_mfma_f32_16x16x32_bf16 v[164:167], a[216:219], v[20:23], 0
    v_fma_f32 v57, v57, s28, v9
    v_mfma_f32_16x16x32_bf16 v[160:163], a[212:215], v[20:23], 0
    v_fma_f32 v75, v75, s28, v11
    v_fma_f32 v91, v91, s28, v13
    v_mfma_f32_16x16x32_bf16 v[208:211], a[212:215], v[26:29], 0
    ds_read_b64_tr_b16 a[230:231], v2 offset:7168
    v_fma_f32 v84, v84, s28, v13
    v_mfma_f32_16x16x32_bf16 v[212:215], a[216:219], v[26:29], 0
    ds_read_b64_tr_b16 a[228:229], v2 offset:1024
    v_mfma_f32_16x16x32_bf16 a[4:7], a[216:219], v[32:35], 0
    v_mfma_f32_16x16x32_bf16 a[0:3], a[212:215], v[32:35], 0
    v_fma_f32 v70, v70, s28, v11
    v_mfma_f32_16x16x32_bf16 a[48:51], a[212:215], v[38:41], 0
    ds_read_b64_tr_b16 a[232:233], v3 offset:1024
    v_fma_f32 v71, v71, s28, v11
    v_mfma_f32_16x16x32_bf16 a[52:55], a[216:219], v[38:41], 0
    s_waitcnt lgkmcnt(4)
    ds_read_b64_tr_b16 a[214:215], v4 offset:7168
    v_fma_f32 v79, v79, s28, v12
    v_mfma_f32_16x16x32_bf16 a[56:59], a[220:223], v[38:41], 0
    v_fma_f32 v69, v69, s28, v11
    v_mfma_f32_16x16x32_bf16 a[60:63], a[224:227], v[38:41], 0
    ds_read_b64_tr_b16 a[216:217], v5 offset:1024
    v_fma_f32 v81, v81, s28, v12
    v_mfma_f32_16x16x32_bf16 a[12:15], a[224:227], v[32:35], 0
    v_exp_f32 v69, v69
    v_mfma_f32_16x16x32_bf16 a[8:11], a[220:223], v[32:35], 0
    v_fma_f32 v76, v76, s28, v12
    v_fma_f32 v87, v87, s28, v13
    v_mfma_f32_16x16x32_bf16 v[216:219], a[220:223], v[26:29], 0
    ds_read_b64_tr_b16 a[212:213], v4 offset:1024
    v_fma_f32 v56, v56, s28, v9
    v_mfma_f32_16x16x32_bf16 v[220:223], a[224:227], v[26:29], 0
    v_exp_f32 v79, v79
    v_mfma_f32_16x16x32_bf16 v[172:175], a[224:227], v[20:23], 0
    ds_read_b64_tr_b16 a[218:219], v5 offset:7168
    v_fma_f32 v58, v58, s28, v9
    v_mfma_f32_16x16x32_bf16 v[168:171], a[220:223], v[20:23], 0
    v_exp_f32 v87, v87
    v_mfma_f32_16x16x32_bf16 v[120:123], a[220:223], v[14:17], 0
    v_fma_f32 v64, v64, s28, v10
    v_fma_f32 v67, v67, s28, v10
    v_mfma_f32_16x16x32_bf16 v[124:127], a[224:227], v[14:17], 0
    s_waitcnt lgkmcnt(3)
    v_fma_f32 v83, v83, s28, v12
    v_fma_f32 v86, v86, s28, v13
    v_mfma_f32_16x16x32_bf16 v[128:131], a[228:231], v[14:17], 0
    s_add_u32 s39, s39, 12288
    v_exp_f32 v70, v70
    v_mfma_f32_16x16x32_bf16 v[132:135], a[232:235], v[14:17], 0
    ds_read_b64_tr_b16 a[220:221], v2 offset:2048
    v_mfma_f32_16x16x32_bf16 v[180:183], a[232:235], v[20:23], 0
    ds_read_b64_tr_b16 a[224:225], v3 offset:2048
    v_fma_f32 v65, v65, s28, v10
    v_mfma_f32_16x16x32_bf16 v[176:179], a[228:231], v[20:23], 0
    ds_read_b64_tr_b16 a[226:227], v3 offset:8192
    v_fma_f32 v77, v77, s28, v12
    v_mfma_f32_16x16x32_bf16 v[224:227], a[228:231], v[26:29], 0
    v_fma_f32 v90, v90, s28, v13
    v_fma_f32 v89, v89, s28, v13
    v_mfma_f32_16x16x32_bf16 v[228:231], a[232:235], v[26:29], 0
    v_exp_f32 v71, v71
    v_mfma_f32_16x16x32_bf16 a[20:23], a[232:235], v[32:35], 0
    v_exp_f32 v76, v76
    v_mfma_f32_16x16x32_bf16 a[16:19], a[228:231], v[32:35], 0
    ds_read_b64_tr_b16 a[222:223], v2 offset:8192
    v_fma_f32 v74, v74, s28, v11
    v_mfma_f32_16x16x32_bf16 a[64:67], a[228:231], v[38:41], 0
    ds_read_b64_tr_b16 a[228:229], v4 offset:2048
    v_fma_f32 v68, v68, s28, v11
    v_mfma_f32_16x16x32_bf16 a[68:71], a[232:235], v[38:41], 0
    s_waitcnt lgkmcnt(5)
    v_exp_f32 v58, v58
    v_mfma_f32_16x16x32_bf16 a[72:75], a[212:215], v[38:41], 0
    v_exp_f32 v57, v57
    v_mfma_f32_16x16x32_bf16 a[76:79], a[216:219], v[38:41], 0
    v_exp_f32 v91, v91
    v_mfma_f32_16x16x32_bf16 a[28:31], a[216:219], v[32:35], 0
    ds_read_b64_tr_b16 a[234:235], v5 offset:8192
    v_cvt_pk_bf16_f32 v31, v70, v71
    v_mfma_f32_16x16x32_bf16 a[24:27], a[212:215], v[32:35], 0
    ds_read_b64_tr_b16 a[230:231], v4 offset:8192
    v_mfma_f32_16x16x32_bf16 v[232:235], a[212:215], v[26:29], 0
    ds_read_b64_tr_b16 a[232:233], v5 offset:2048
    v_mfma_f32_16x16x32_bf16 v[236:239], a[216:219], v[26:29], 0
    v_exp_f32 v74, v74
    v_mfma_f32_16x16x32_bf16 v[188:191], a[216:219], v[20:23], 0
    v_exp_f32 v64, v64
    v_mfma_f32_16x16x32_bf16 v[184:187], a[212:215], v[20:23], 0
    v_exp_f32 v68, v68
    v_mfma_f32_16x16x32_bf16 v[136:139], a[212:215], v[14:17], 0
    v_fma_f32 v73, v73, s28, v11
    v_mfma_f32_16x16x32_bf16 v[140:143], a[216:219], v[14:17], 0
    s_waitcnt lgkmcnt(3)
    v_exp_f32 v77, v77
    v_mfma_f32_16x16x32_bf16 v[144:147], a[220:223], v[14:17], 0
    v_fma_f32 v85, v85, s28, v13
    v_fma_f32 v78, v78, s28, v12
    v_mfma_f32_16x16x32_bf16 v[148:151], a[224:227], v[14:17], 0
    v_exp_f32 v84, v84
    v_mfma_f32_16x16x32_bf16 v[196:199], a[224:227], v[20:23], 0
    v_exp_f32 v59, v59
    v_mfma_f32_16x16x32_bf16 v[192:195], a[220:223], v[20:23], 0
    v_exp_f32 v86, v86
    v_mfma_f32_16x16x32_bf16 v[240:243], a[220:223], v[26:29], 0
    s_waitcnt vmcnt(3) lgkmcnt(0)
    v_exp_f32 v90, v90
    v_mfma_f32_16x16x32_bf16 v[244:247], a[224:227], v[26:29], 0
    v_exp_f32 v85, v85
    v_mfma_f32_16x16x32_bf16 a[36:39], a[224:227], v[32:35], 0
    s_add_u32 m0, s22, 24576
    v_exp_f32 v78, v78
    v_mfma_f32_16x16x32_bf16 a[32:35], a[220:223], v[32:35], 0
    s_barrier
    v_mfma_f32_16x16x32_bf16 a[80:83], a[220:223], v[38:41], 0
    buffer_load_dwordx4 v6, s[8:11], s21 offen lds
    v_mfma_f32_16x16x32_bf16 a[84:87], a[224:227], v[38:41], 0
    ds_read_b128 a[212:215], v0 offset:0
    v_cvt_pk_bf16_f32 v30, v68, v69
    v_mfma_f32_16x16x32_bf16 a[88:91], a[228:231], v[38:41], 0
    s_add_u32 s21, s21, 128
    ds_read_b128 a[216:219], v1 offset:0
    v_mfma_f32_16x16x32_bf16 a[92:95], a[232:235], v[38:41], 0
    ds_read_b128 a[220:223], v0 offset:1024
    v_cvt_pk_bf16_f32 v37, v78, v79
    v_mfma_f32_16x16x32_bf16 a[44:47], a[232:235], v[32:35], 0
    v_exp_f32 v56, v56
    v_mfma_f32_16x16x32_bf16 a[40:43], a[228:231], v[32:35], 0
    s_add_u32 m0, s22, 25600
    v_mfma_f32_16x16x32_bf16 v[248:251], a[228:231], v[26:29], 0
    buffer_load_dwordx4 v6, s[8:11], s21 offen lds
    v_mfma_f32_16x16x32_bf16 v[252:255], a[232:235], v[26:29], 0
    s_add_u32 s21, s21, 128
    v_cvt_pk_bf16_f32 v43, v86, v87
    v_mfma_f32_16x16x32_bf16 v[204:207], a[232:235], v[20:23], 0
    v_mfma_f32_16x16x32_bf16 v[200:203], a[228:231], v[20:23], 0
    s_add_u32 m0, s22, 26624
    v_mfma_f32_16x16x32_bf16 v[152:155], a[228:231], v[14:17], 0
    buffer_load_dwordx4 v6, s[8:11], s21 offen lds
    v_mfma_f32_16x16x32_bf16 v[156:159], a[232:235], v[14:17], 0
    s_waitcnt lgkmcnt(2)
    v_cvt_pk_bf16_f32 v16, v56, v57
    v_fma_f32 v88, v88, s28, v13
    v_mfma_f32_16x16x32_bf16 v[52:55], a[212:215], a[96:99], 0
    s_waitcnt lgkmcnt(1)
    ds_read_b128 a[232:235], v1 offset:2048
    v_fma_f32 v80, v80, s28, v12
    v_mfma_f32_16x16x32_bf16 v[52:55], a[216:219], a[100:103], v[52:55]
    s_waitcnt lgkmcnt(1)
    v_cvt_pk_bf16_f32 v42, v84, v85
    v_fma_f32 v72, v72, s28, v11
    v_mfma_f32_16x16x32_bf16 v[52:55], a[220:223], a[104:107], v[52:55]
    v_cvt_pk_bf16_f32 v41, v90, v91
    v_mfma_f32_16x16x32_bf16 v[60:63], a[220:223], a[128:131], 0
    ds_read_b128 a[228:231], v0 offset:2048
    v_mfma_f32_16x16x32_bf16 v[60:63], a[216:219], a[124:127], v[60:63]
    ds_read_b128 a[224:227], v1 offset:1024
    v_cvt_pk_bf16_f32 v36, v76, v77
    v_mfma_f32_16x16x32_bf16 v[60:63], a[212:215], a[120:123], v[60:63]
    v_exp_f32 v73, v73
    v_mfma_f32_16x16x32_bf16 v[68:71], a[212:215], a[144:147], 0
    v_exp_f32 v81, v81
    v_mfma_f32_16x16x32_bf16 v[68:71], a[216:219], a[148:151], v[68:71]
    v_exp_f32 v82, v82
    v_mfma_f32_16x16x32_bf16 v[68:71], a[220:223], a[152:155], v[68:71]
    v_exp_f32 v88, v88
    v_mfma_f32_16x16x32_bf16 v[76:79], a[220:223], a[176:179], 0
    v_exp_f32 v65, v65
    v_mfma_f32_16x16x32_bf16 v[76:79], a[216:219], a[172:175], v[76:79]
    v_exp_f32 v67, v67
    v_mfma_f32_16x16x32_bf16 v[76:79], a[212:215], a[168:171], v[76:79]
    v_exp_f32 v89, v89
    v_mfma_f32_16x16x32_bf16 v[84:87], a[212:215], a[192:195], 0
    v_exp_f32 v83, v83
    v_mfma_f32_16x16x32_bf16 v[84:87], a[216:219], a[196:199], v[84:87]
    v_exp_f32 v80, v80
    v_mfma_f32_16x16x32_bf16 v[84:87], a[220:223], a[200:203], v[84:87]
    s_waitcnt lgkmcnt(0)
    ds_read_b128 a[212:215], v0 offset:6144
    v_mfma_f32_16x16x32_bf16 v[84:87], a[224:227], a[204:207], v[84:87]
    s_add_u32 s21, s21, 12032
    v_fma_f32 v66, v66, s28, v10
    v_cvt_pk_bf16_f32 v22, v64, v65
    v_mfma_f32_16x16x32_bf16 v[84:87], a[228:231], a[208:211], v[84:87]
    s_add_u32 m0, s38, 0
    v_exp_f32 v66, v66
    v_mfma_f32_16x16x32_bf16 v[84:87], a[232:235], v[92:95], v[84:87]
    v_mfma_f32_16x16x32_bf16 v[76:79], a[232:235], a[188:191], v[76:79]
    v_exp_f32 v75, v75
    v_mfma_f32_16x16x32_bf16 v[76:79], a[228:231], a[184:187], v[76:79]
    buffer_load_dwordx4 v6, s[12:15], s33 offen nt lds
    v_mfma_f32_16x16x32_bf16 v[76:79], a[224:227], a[180:183], v[76:79]
    v_exp_f32 v72, v72
    v_mfma_f32_16x16x32_bf16 v[68:71], a[224:227], a[156:159], v[68:71]
    v_cvt_pk_bf16_f32 v40, v88, v89
    v_mfma_f32_16x16x32_bf16 v[68:71], a[228:231], a[160:163], v[68:71]
    ds_read_b128 a[220:223], v0 offset:7168
    v_mfma_f32_16x16x32_bf16 v[68:71], a[232:235], a[164:167], v[68:71]
    ds_read_b128 a[216:219], v1 offset:6144
    s_add_u32 m0, s38, 1024
    v_mfma_f32_16x16x32_bf16 v[60:63], a[232:235], a[140:143], v[60:63]
    v_cvt_pk_bf16_f32 v29, v74, v75
    v_cvt_pk_bf16_f32 v35, v82, v83
    v_mfma_f32_16x16x32_bf16 v[60:63], a[228:231], a[136:139], v[60:63]
    buffer_load_dwordx4 v7, s[12:15], s33 offen nt lds
    v_mfma_f32_16x16x32_bf16 v[60:63], a[224:227], a[132:135], v[60:63]
    v_mfma_f32_16x16x32_bf16 v[52:55], a[224:227], a[108:111], v[52:55]
    ds_read_b128 a[224:227], v1 offset:7168
    v_mfma_f32_16x16x32_bf16 v[52:55], a[228:231], a[112:115], v[52:55]
    v_cvt_pk_bf16_f32 v17, v58, v59
    v_cvt_pk_bf16_f32 v23, v66, v67
    v_mfma_f32_16x16x32_bf16 v[52:55], a[232:235], a[116:119], v[52:55]
    ds_read_b128 a[228:231], v0 offset:8192
    v_cvt_pk_bf16_f32 v34, v80, v81
    v_mfma_f32_16x16x32_bf16 v[48:51], a[236:239], v[16:19], v[44:47]
    ds_read_b128 a[232:235], v1 offset:8192
    v_cvt_pk_bf16_f32 v28, v72, v73
    v_mfma_f32_16x16x32_bf16 v[48:51], a[240:243], v[22:25], v[48:51]
    s_nop 0
    v_mfma_f32_16x16x32_bf16 v[48:51], a[244:247], v[28:31], v[48:51]
    v_mfma_f32_16x16x32_bf16 v[48:51], a[248:251], v[34:37], v[48:51]
    v_mfma_f32_16x16x32_bf16 v[48:51], a[252:255], v[40:43], v[48:51]
    s_add_u32 s59, s33, 128
    s_add_u32 m0, s38, 2048
    s_waitcnt lgkmcnt(3)
    v_mfma_f32_16x16x32_bf16 v[56:59], a[212:215], a[96:99], 0
    buffer_load_dwordx4 v6, s[12:15], s59 offen nt lds
    v_mfma_f32_16x16x32_bf16 v[56:59], a[216:219], a[100:103], v[56:59]
    s_add_u32 m0, s38, 3072
    s_nop 0
    v_cmp_lt_f32 vcc, s29, v48
    v_mfma_f32_16x16x32_bf16 v[56:59], a[220:223], a[104:107], v[56:59]
    v_mfma_f32_16x16x32_bf16 v[64:67], a[220:223], a[128:131], 0
    buffer_load_dwordx4 v7, s[12:15], s59 offen nt lds
    v_mfma_f32_16x16x32_bf16 v[64:67], a[216:219], a[124:127], v[64:67]
    s_nop 0
    s_cbranch_vccnz L_rs_start5b
L_ret_start5b:
    v_mfma_f32_16x16x32_bf16 v[64:67], a[212:215], a[120:123], v[64:67]
    s_waitcnt vmcnt(13) lgkmcnt(0)
    v_fma_f32 v63, v63, s28, v10
    v_fma_f32 v62, v62, s28, v10
    v_mfma_f32_16x16x32_bf16 v[72:75], a[212:215], a[144:147], 0
    s_barrier
    v_mfma_f32_16x16x32_bf16 v[72:75], a[216:219], a[148:151], v[72:75]
    v_fma_f32 v60, v60, s28, v10
    v_mfma_f32_16x16x32_bf16 v[72:75], a[220:223], a[152:155], v[72:75]
    v_exp_f32 v62, v62
    v_mfma_f32_16x16x32_bf16 v[80:83], a[220:223], a[176:179], 0
    s_add_u32 m0, s22, 0
    v_fma_f32 v53, v53, s28, v9
    v_fma_f32 v61, v61, s28, v10
    v_mfma_f32_16x16x32_bf16 v[80:83], a[216:219], a[172:175], v[80:83]
    buffer_load_dwordx4 v6, s[4:7], s20 offen lds
    v_mfma_f32_16x16x32_bf16 v[80:83], a[212:215], a[168:171], v[80:83]
    v_fma_f32 v55, v55, s28, v9
    s_add_u32 s20, s20, 128
    v_mfma_f32_16x16x32_bf16 v[88:91], a[212:215], a[192:195], 0
    ds_read_b64_tr_b16 a[212:213], v2 offset:18432
    s_add_u32 m0, s22, 1024
    v_mfma_f32_16x16x32_bf16 v[88:91], a[216:219], a[196:199], v[88:91]
    buffer_load_dwordx4 v6, s[4:7], s20 offen lds
    v_mfma_f32_16x16x32_bf16 v[88:91], a[220:223], a[200:203], v[88:91]
    ds_read_b64_tr_b16 a[214:215], v2 offset:12288
    s_add_u32 s20, s20, 128
    v_mfma_f32_16x16x32_bf16 v[88:91], a[224:227], a[204:207], v[88:91]
    s_add_u32 m0, s22, 2048
    v_exp_f32 v63, v63
    v_mfma_f32_16x16x32_bf16 v[88:91], a[228:231], a[208:211], v[88:91]
    ds_read_b64_tr_b16 a[216:217], v3 offset:18432
    v_fma_f32 v52, v52, s28, v9
    v_mfma_f32_16x16x32_bf16 v[88:91], a[232:235], v[92:95], v[88:91]
    buffer_load_dwordx4 v6, s[4:7], s20 offen lds
    v_mfma_f32_16x16x32_bf16 v[80:83], a[232:235], a[188:191], v[80:83]
    ds_read_b64_tr_b16 a[218:219], v3 offset:12288
    v_fma_f32 v54, v54, s28, v9
    v_mfma_f32_16x16x32_bf16 v[80:83], a[228:231], a[184:187], v[80:83]
    v_exp_f32 v54, v54
    v_mfma_f32_16x16x32_bf16 v[80:83], a[224:227], a[180:183], v[80:83]
    v_exp_f32 v60, v60
    v_mfma_f32_16x16x32_bf16 v[72:75], a[224:227], a[156:159], v[72:75]
    v_exp_f32 v61, v61
    v_mfma_f32_16x16x32_bf16 v[72:75], a[228:231], a[160:163], v[72:75]
    ds_read_b64_tr_b16 a[220:221], v4 offset:18432
    v_mfma_f32_16x16x32_bf16 v[72:75], a[232:235], a[164:167], v[72:75]
    ds_read_b64_tr_b16 a[222:223], v4 offset:12288
    v_mfma_f32_16x16x32_bf16 v[64:67], a[232:235], a[140:143], v[64:67]
    v_exp_f32 v52, v52
    v_mfma_f32_16x16x32_bf16 v[64:67], a[228:231], a[136:139], v[64:67]
    v_exp_f32 v53, v53
    v_mfma_f32_16x16x32_bf16 v[64:67], a[224:227], a[132:135], v[64:67]
    v_exp_f32 v55, v55
    v_mfma_f32_16x16x32_bf16 v[56:59], a[224:227], a[108:111], v[56:59]
    v_cvt_pk_bf16_f32 v15, v54, v55
    v_cvt_pk_bf16_f32 v20, v60, v61
    v_mfma_f32_16x16x32_bf16 v[56:59], a[228:231], a[112:115], v[56:59]
    ds_read_b64_tr_b16 a[224:225], v5 offset:18432
    v_cvt_pk_bf16_f32 v14, v52, v53
    v_mfma_f32_16x16x32_bf16 v[56:59], a[232:235], a[116:119], v[56:59]
    s_add_u32 s20, s20, 12032
    ds_read_b64_tr_b16 a[226:227], v5 offset:12288
    v_cvt_pk_bf16_f32 v21, v62, v63
    s_branch L_loop5
L_start4:
    s_add_u32 m0, s22, 0
    s_nop 0
    buffer_load_dwordx4 v6, s[4:7], s20 offen lds
    s_add_u32 s20, s20, 128
    s_add_u32 m0, s22, 1024
    s_nop 0
    buffer_load_dwordx4 v6, s[4:7], s20 offen lds
    s_add_u32 s20, s20, 128
    s_add_u32 m0, s22, 2048
    s_nop 0
    buffer_load_dwordx4 v6, s[4:7], s20 offen lds
    s_add_u32 s20, s20, 12032
    s_add_u32 m0, s22, 12288
    s_nop 0
    buffer_load_dwordx4 v6, s[4:7], s20 offen lds
    s_add_u32 s20, s20, 128
    s_add_u32 m0, s22, 13312
    s_nop 0
    buffer_load_dwordx4 v6, s[4:7], s20 offen lds
    s_add_u32 s20, s20, 128
    s_add_u32 m0, s22, 14336
    s_nop 0
    buffer_load_dwordx4 v6, s[4:7], s20 offen lds
    s_add_u32 s20, s20, 12032
    s_add_u32 s48, s34, 0
    s_add_u32 m0, s38, 0
    s_nop 0
    buffer_load_dwordx4 v6, s[12:15], s48 offen nt lds
    s_add_u32 m0, s38, 1024
    s_nop 0
    buffer_load_dwordx4 v7, s[12:15], s48 offen nt lds
    s_add_u32 s48, s34, 128
    s_add_u32 m0, s38, 2048
    s_nop 0
    buffer_load_dwordx4 v6, s[12:15], s48 offen nt lds
    s_add_u32 m0, s38, 3072
    s_nop 0
    buffer_load_dwordx4 v7, s[12:15], s48 offen nt lds
    s_add_u32 s48, s34, 256
    s_add_u32 m0, s38, 4096
    s_nop 0
    buffer_load_dwordx4 v6, s[12:15], s48 offen nt lds
    s_add_u32 m0, s38, 5120
    s_nop 0
    buffer_load_dwordx4 v7, s[12:15], s48 offen nt lds
    s_add_u32 s48, s34, 6144
    s_add_u32 m0, s38, 6144
    s_nop 0
    buffer_load_dwordx4 v6, s[12:15], s48 offen nt lds
    s_add_u32 m0, s38, 7168
    s_nop 0
    buffer_load_dwordx4 v7, s[12:15], s48 offen nt lds
    s_add_u32 s48, s34, 6272
    s_add_u32 m0, s38, 8192
    s_nop 0
    buffer_load_dwordx4 v6, s[12:15], s48 offen nt lds
    s_add_u32 m0, s38, 9216
    s_nop 0
    buffer_load_dwordx4 v7, s[12:15], s48 offen nt lds
    s_add_u32 s48, s34, 6400
    s_add_u32 m0, s38, 10240
    s_nop 0
    buffer_load_dwordx4 v6, s[12:15], s48 offen nt lds
    s_add_u32 m0, s38, 11264
    s_nop 0
    buffer_load_dwordx4 v7, s[12:15], s48 offen nt lds
    s_add_u32 s48, s34, 12288
    s_add_u32 m0, s38, 12288
    s_nop 0
    buffer_load_dwordx4 v6, s[12:15], s48 offen nt lds
    s_add_u32 m0, s38, 13312
    s_nop 0
    buffer_load_dwordx4 v7, s[12:15], s48 offen nt lds
    s_add_u32 s48, s34, 12416
    s_add_u32 m0, s38, 14336
    s_nop 0
    buffer_load_dwordx4 v6, s[12:15], s48 offen nt lds
    s_add_u32 m0, s38, 15360
    s_nop 0
    buffer_load_dwordx4 v7, s[12:15], s48 offen nt lds
    s_add_u32 s48, s34, 12544
    s_add_u32 m0, s38, 16384
    s_nop 0
    buffer_load_dwordx4 v6, s[12:15], s48 offen nt lds
    s_add_u32 m0, s38, 17408
    s_nop 0
    buffer_load_dwordx4 v7, s[12:15], s48 offen nt lds
    v_and_b32 v96, 15, v111
    v_lshrrev_b32 v97, 4, v111
    v_lshrrev_b32 v98, 3, v96
    v_and_b32 v99, 7, v96
    v_lshlrev_b32 v0, 7, v99
    v_bfe_u32 v99, v96, 1, 2
    v_lshlrev_b32 v99, 1, v99
    v_mul_u32_u24 v100, 5, v98
    v_xor_b32 v99, v99, v100
    v_xor_b32 v99, v99, v97
    v_lshl_add_u32 v0, v99, 4, v0
    v_mul_u32_u24 v100, 3072, v98
    v_add_u32 v0, v100, v0
    v_xor_b32 v1, 64, v0
    v_lshrrev_b32 v98, 1, v97
    v_mul_u32_u24 v2, 3072, v98
    v_and_b32 v99, 1, v97
    v_bfe_u32 v100, v111, 2, 2
    v_lshl_add_u32 v96, v99, 2, v100
    v_lshl_add_u32 v2, v96, 7, v2
    v_lshrrev_b32 v96, 1, v96
    v_lshlrev_b32 v96, 1, v96
    v_mul_u32_u24 v98, 5, v98
    v_xor_b32 v96, v96, v98
    v_bfe_u32 v99, v111, 1, 1
    v_xor_b32 v96, v96, v99
    v_lshl_add_u32 v2, v96, 4, v2
    v_and_b32 v99, 1, v111
    v_lshl_add_u32 v2, v99, 3, v2
    v_add_u32 v2, 24576, v2
    v_xor_b32 v3, 32, v2
    v_xor_b32 v4, 64, v2
    v_xor_b32 v5, 96, v2
    v_lshl_add_u32 v8, v111, 4, s38
    v_lshrrev_b32 v96, 3, v111
    v_bfe_u32 v97, v111, 0, 3
    v_and_b32 v98, 3, v96
    v_lshlrev_b32 v98, 1, v98
    v_xor_b32 v97, v97, v98
    v_xor_b32 v97, s65, v97
    v_mul_u32_u24 v102, 384, v96
    v_lshl_add_u32 v102, v97, 4, v102
    v_xor_b32 v103, 16, v102
    s_mul_i32 s42, s65, 3072
    v_add_u32 v102, s42, v102
    s_sub_u32 s42, 3072, s42
    v_add_u32 v103, s42, v103
    v_and_b32 v96, 15, v111
    s_mov_b32 s42, 0x1011
    v_bfe_i32 v97, s42, v96, 1
    v_and_b32 v97, 0x3f803f80, v97
    v_accvgpr_write_b32 a236, v97
    v_accvgpr_write_b32 a237, v97
    v_accvgpr_write_b32 a238, v97
    v_accvgpr_write_b32 a239, v97
    s_mov_b32 s42, 0x3222
    v_bfe_i32 v97, s42, v96, 1
    v_and_b32 v97, 0x3f803f80, v97
    v_accvgpr_write_b32 a240, v97
    v_accvgpr_write_b32 a241, v97
    v_accvgpr_write_b32 a242, v97
    v_accvgpr_write_b32 a243, v97
    s_mov_b32 s42, 0x5444
    v_bfe_i32 v97, s42, v96, 1
    v_and_b32 v97, 0x3f803f80, v97
    v_accvgpr_write_b32 a244, v97
    v_accvgpr_write_b32 a245, v97
    v_accvgpr_write_b32 a246, v97
    v_accvgpr_write_b32 a247, v97
    s_mov_b32 s42, 0x9888
    v_bfe_i32 v97, s42, v96, 1
    v_and_b32 v97, 0x3f803f80, v97
    v_accvgpr_write_b32 a248, v97
    v_accvgpr_write_b32 a249, v97
    v_accvgpr_write_b32 a250, v97
    v_accvgpr_write_b32 a251, v97
    s_mov_b32 s42, 0x1100
    v_bfe_i32 v97, s42, v96, 1
    v_and_b32 v97, 0x3f803f80, v97
    v_accvgpr_write_b32 a252, v97
    v_accvgpr_write_b32 a253, v97
    v_accvgpr_write_b32 a254, v97
    v_accvgpr_write_b32 a255, v97
    s_waitcnt vmcnt(18)
    s_barrier
    s_waitcnt vmcnt(12)
    s_add_u32 s48, s34, 18432
    s_add_u32 m0, s38, 18432
    s_nop 0
    buffer_load_dwordx4 v6, s[12:15], s48 offen nt lds
    s_add_u32 m0, s38, 19456
    ds_read_b128 a[216:219], v1 offset:0
    buffer_load_dwordx4 v7, s[12:15], s48 offen nt lds
    ds_read_b128 a[228:231], v0 offset:2048
    v_lshrrev_b32 v105, 11, v0
    v_xor_b32 v105, s65, v105
    v_and_b32 v104, 0x3ff, v0
    v_lshl_add_u32 v104, v105, 10, v104
    s_add_u32 s48, s34, 18560
    s_add_u32 m0, s38, 20480
    v_add_u32 v104, s38, v104
    buffer_load_dwordx4 v6, s[12:15], s48 offen nt lds
    ds_read_b128 a[112:115], v104 offset:4096
    s_add_u32 m0, s38, 21504
    s_nop 0
    buffer_load_dwordx4 v7, s[12:15], s48 offen nt lds
    ds_read_b128 a[104:107], v104 offset:2048
    ds_read_b128 a[96:99], v104 offset:0
    ds_read_b128 a[220:223], v0 offset:1024
    s_add_u32 s48, s34, 18688
    ds_read_b128 a[212:215], v0 offset:0
    s_add_u32 m0, s38, 22528
    v_xor_b32 v105, 64, v104
    ds_read_b128 a[100:103], v105 offset:0
    buffer_load_dwordx4 v6, s[12:15], s48 offen nt lds
    ds_read_b128 a[108:111], v105 offset:2048
    s_add_u32 m0, s38, 23552
    ds_read_b128 a[116:119], v105 offset:4096
    buffer_load_dwordx4 v7, s[12:15], s48 offen nt lds
    s_waitcnt lgkmcnt(3)
    v_mfma_f32_16x16x32_bf16 v[52:55], a[212:215], a[96:99], 0
    ds_read_b128 a[232:235], v1 offset:2048
    s_waitcnt lgkmcnt(3)
    v_mfma_f32_16x16x32_bf16 v[52:55], a[216:219], a[100:103], v[52:55]
    ds_read_b128 a[224:227], v1 offset:1024
    v_mfma_f32_16x16x32_bf16 v[52:55], a[220:223], a[104:107], v[52:55]
    ds_read_b128 a[212:215], v0 offset:6144
    s_waitcnt lgkmcnt(1)
    v_mfma_f32_16x16x32_bf16 v[52:55], a[224:227], a[108:111], v[52:55]
    ds_read_b128 a[216:219], v1 offset:6144
    v_mfma_f32_16x16x32_bf16 v[52:55], a[228:231], a[112:115], v[52:55]
    ds_read_b128 a[220:223], v0 offset:7168
    v_mfma_f32_16x16x32_bf16 v[52:55], a[232:235], a[116:119], v[52:55]
    s_waitcnt lgkmcnt(2)
    ds_read_b128 a[224:227], v1 offset:7168
    v_mfma_f32_16x16x32_bf16 v[56:59], a[212:215], a[96:99], 0
    ds_read_b128 a[228:231], v0 offset:8192
    s_waitcnt lgkmcnt(3)
    v_mfma_f32_16x16x32_bf16 v[56:59], a[216:219], a[100:103], v[56:59]
    ds_read_b128 a[232:235], v1 offset:8192
    s_waitcnt lgkmcnt(3)
    v_mfma_f32_16x16x32_bf16 v[56:59], a[220:223], a[104:107], v[56:59]
    v_max3_f32 v96, v52, v53, v54
    ds_read_b128 a[216:219], v1 offset:12288
    s_waitcnt lgkmcnt(3)
    v_mfma_f32_16x16x32_bf16 v[56:59], a[224:227], a[108:111], v[56:59]
    s_waitcnt vmcnt(12)
    s_add_u32 m0, s22, 24576
    ds_read_b128 a[212:215], v0 offset:12288
    buffer_load_dwordx4 v6, s[8:11], s21 offen lds
    s_add_u32 s21, s21, 128
    s_waitcnt lgkmcnt(1)
    v_mfma_f32_16x16x32_bf16 v[56:59], a[228:231], a[112:115], v[56:59]
    s_add_u32 m0, s22, 25600
    ds_read_b128 a[220:223], v0 offset:13312
    buffer_load_dwordx4 v6, s[8:11], s21 offen lds
    s_add_u32 s21, s21, 128
    v_mfma_f32_16x16x32_bf16 v[56:59], a[232:235], a[116:119], v[56:59]
    s_add_u32 m0, s22, 26624
    s_nop 0
    buffer_load_dwordx4 v6, s[8:11], s21 offen lds
    s_nop 4
    v_max3_f32 v96, v96, v55, v56
    v_max3_f32 v96, v96, v57, v58
    v_max_f32 v96, v96, v59
    v_mov_b32 v97, v96
    ds_read_b128 a[232:235], v1 offset:14336
    s_nop 0
    v_permlane32_swap_b32 v97, v96
    v_max_f32 v96, v96, v97
    v_mov_b32 v97, v96
    ds_read_b128 a[228:231], v0 offset:14336
    ds_read_b128 a[224:227], v1 offset:13312
    v_permlane16_swap_b32 v97, v96
    v_max_f32 v96, v96, v97
    v_mul_f32_e64 v9, -s28, v96
    v_fma_f32 v53, v53, s28, v9
    v_fma_f32 v55, v55, s28, v9
    v_fma_f32 v58, v58, s28, v9
    v_exp_f32 v55, v55
    v_fma_f32 v52, v52, s28, v9
    v_fma_f32 v54, v54, s28, v9
    v_exp_f32 v53, v53
    v_exp_f32 v52, v52
    v_fma_f32 v57, v57, s28, v9
    v_cvt_pk_bf16_f32 v14, v52, v53
    v_fma_f32 v56, v56, s28, v9
    v_exp_f32 v56, v56
    v_exp_f32 v54, v54
    s_nop 0
    v_cvt_pk_bf16_f32 v15, v54, v55
    s_waitcnt lgkmcnt(3)
    v_mfma_f32_16x16x32_bf16 v[52:55], a[212:215], a[96:99], 0
    ds_read_b128 a[212:215], v0 offset:18432
    v_fma_f32 v59, v59, s28, v9
    ds_read_b128 a[132:135], v105 offset:8192
    v_exp_f32 v59, v59
    v_mfma_f32_16x16x32_bf16 v[52:55], a[216:219], a[100:103], v[52:55]
    ds_read_b128 a[136:139], v104 offset:10240
    v_mfma_f32_16x16x32_bf16 v[52:55], a[220:223], a[104:107], v[52:55]
    s_waitcnt lgkmcnt(3)
    ds_read_b128 a[124:127], v105 offset:6144
    v_exp_f32 v57, v57
    v_mfma_f32_16x16x32_bf16 v[52:55], a[224:227], a[108:111], v[52:55]
    v_exp_f32 v58, v58
    ds_read_b128 a[216:219], v1 offset:18432
    v_mfma_f32_16x16x32_bf16 v[52:55], a[228:231], a[112:115], v[52:55]
    ds_read_b128 a[220:223], v0 offset:19456
    v_mfma_f32_16x16x32_bf16 v[52:55], a[232:235], a[116:119], v[52:55]
    v_cvt_pk_bf16_f32 v17, v58, v59
    ds_read_b128 a[224:227], v1 offset:19456
    v_cvt_pk_bf16_f32 v16, v56, v57
    s_waitcnt lgkmcnt(6)
    v_mfma_f32_16x16x32_bf16 v[56:59], a[212:215], a[96:99], 0
    ds_read_b128 a[212:215], v0 offset:0
    s_waitcnt lgkmcnt(3)
    v_mfma_f32_16x16x32_bf16 v[56:59], a[216:219], a[100:103], v[56:59]
    ds_read_b128 a[120:123], v104 offset:6144
    ds_read_b128 a[216:219], v1 offset:0
    s_waitcnt lgkmcnt(4)
    v_mfma_f32_16x16x32_bf16 v[56:59], a[220:223], a[104:107], v[56:59]
    ds_read_b128 a[228:231], v0 offset:20480
    s_waitcnt lgkmcnt(4)
    v_mfma_f32_16x16x32_bf16 v[56:59], a[224:227], a[108:111], v[56:59]
    ds_read_b128 a[232:235], v1 offset:20480
    s_waitcnt lgkmcnt(1)
    v_mfma_f32_16x16x32_bf16 v[56:59], a[228:231], a[112:115], v[56:59]
    ds_read_b128 a[128:131], v104 offset:8192
    s_waitcnt lgkmcnt(1)
    v_mfma_f32_16x16x32_bf16 v[56:59], a[232:235], a[116:119], v[56:59]
    ds_read_b128 a[220:223], v0 offset:1024
    ds_read_b128 a[228:231], v0 offset:2048
    v_mfma_f32_16x16x32_bf16 v[60:63], a[212:215], a[120:123], 0
    ds_read_b128 a[224:227], v1 offset:1024
    ds_read_b128 a[232:235], v1 offset:2048
    v_mfma_f32_16x16x32_bf16 v[60:63], a[216:219], a[124:127], v[60:63]
    ds_read_b128 a[140:143], v105 offset:10240
    s_waitcnt lgkmcnt(4)
    v_mfma_f32_16x16x32_bf16 v[60:63], a[220:223], a[128:131], v[60:63]
    ds_read_b128 a[212:215], v0 offset:6144
    s_waitcnt lgkmcnt(3)
    v_mfma_f32_16x16x32_bf16 v[60:63], a[224:227], a[132:135], v[60:63]
    ds_read_b128 a[224:227], v1 offset:7168
    v_fma_f32 v55, v55, s28, v9
    v_mfma_f32_16x16x32_bf16 v[60:63], a[228:231], a[136:139], v[60:63]
    s_waitcnt lgkmcnt(2)
    v_fma_f32 v53, v53, s28, v9
    ds_read_b128 a[220:223], v0 offset:7168
    v_mfma_f32_16x16x32_bf16 v[60:63], a[232:235], a[140:143], v[60:63]
    ds_read_b128 a[216:219], v1 offset:6144
    s_waitcnt lgkmcnt(3)
    v_mfma_f32_16x16x32_bf16 v[64:67], a[212:215], a[120:123], 0
    ds_read_b128 a[228:231], v0 offset:8192
    s_waitcnt lgkmcnt(1)
    v_mfma_f32_16x16x32_bf16 v[64:67], a[216:219], a[124:127], v[64:67]
    ds_read_b128 a[232:235], v1 offset:8192
    v_mfma_f32_16x16x32_bf16 v[64:67], a[220:223], a[128:131], v[64:67]
    ds_read_b128 a[212:215], v0 offset:12288
    v_mfma_f32_16x16x32_bf16 v[64:67], a[224:227], a[132:135], v[64:67]
    ds_read_b128 a[216:219], v1 offset:12288
    s_waitcnt lgkmcnt(3)
    v_mfma_f32_16x16x32_bf16 v[64:67], a[228:231], a[136:139], v[64:67]
    ds_read_b128 a[228:231], v0 offset:14336
    v_max3_f32 v98, v60, v61, v62
    s_waitcnt lgkmcnt(3)
    v_mfma_f32_16x16x32_bf16 v[64:67], a[232:235], a[140:143], v[64:67]
    s_nop 7
    v_max3_f32 v98, v98, v63, v64
    v_max3_f32 v98, v98, v65, v66
    v_max_f32 v98, v98, v67
    v_mov_b32 v99, v98
    s_nop 1
    v_permlane32_swap_b32 v99, v98
    v_max_f32 v98, v98, v99
    v_mov_b32 v99, v98
    s_nop 1
    v_permlane16_swap_b32 v99, v98
    v_max_f32 v98, v98, v99
    v_mul_f32_e64 v10, -s28, v98
    ds_read_b128 a[220:223], v0 offset:13312
    v_fma_f32 v66, v66, s28, v10
    v_fma_f32 v67, v67, s28, v10
    v_fma_f32 v62, v62, s28, v10
    v_exp_f32 v62, v62
    v_exp_f32 v66, v66
    v_fma_f32 v60, v60, s28, v10
    v_fma_f32 v63, v63, s28, v10
    s_add_u32 s21, s21, 12032
    ds_read_b128 a[232:235], v1 offset:14336
    v_fma_f32 v61, v61, s28, v10
    v_exp_f32 v60, v60
    v_exp_f32 v61, v61
    v_fma_f32 v54, v54, s28, v9
    v_cvt_pk_bf16_f32 v20, v60, v61
    v_exp_f32 v63, v63
    v_fma_f32 v65, v65, s28, v10
    v_cvt_pk_bf16_f32 v21, v62, v63
    ds_read_b128 a[224:227], v1 offset:13312
    s_waitcnt vmcnt(9)
    s_add_u32 m0, s22, 36864
    s_nop 0
    buffer_load_dwordx4 v6, s[8:11], s21 offen lds
    s_add_u32 s21, s21, 128
    s_add_u32 m0, s22, 37888
    v_mfma_f32_16x16x32_bf16 v[44:47], a[236:239], v[14:17], 0
    buffer_load_dwordx4 v6, s[8:11], s21 offen lds
    v_fma_f32 v64, v64, s28, v10
    s_add_u32 s21, s21, 128
    ds_read_b128 a[144:147], v104 offset:12288
    ds_read_b128 a[156:159], v105 offset:14336
    s_add_u32 m0, s22, 38912
    s_waitcnt lgkmcnt(3)
    v_mfma_f32_16x16x32_bf16 v[60:63], a[212:215], a[120:123], 0
    buffer_load_dwordx4 v6, s[8:11], s21 offen lds
    ds_read_b128 a[152:155], v104 offset:14336
    v_exp_f32 v65, v65
    v_exp_f32 v67, v67
    v_mfma_f32_16x16x32_bf16 v[60:63], a[216:219], a[124:127], v[60:63]
    v_exp_f32 v64, v64
    ds_read_b128 a[148:151], v105 offset:12288
    v_mfma_f32_16x16x32_bf16 v[60:63], a[220:223], a[128:131], v[60:63]
    s_waitcnt lgkmcnt(4)
    ds_read_b128 a[212:215], v0 offset:18432
    v_mfma_f32_16x16x32_bf16 v[60:63], a[224:227], a[132:135], v[60:63]
    ds_read_b128 a[216:219], v1 offset:18432
    ds_read_b128 a[220:223], v0 offset:19456
    v_cvt_pk_bf16_f32 v22, v64, v65
    v_cvt_pk_bf16_f32 v23, v66, v67
    v_mfma_f32_16x16x32_bf16 v[60:63], a[228:231], a[136:139], v[60:63]
    ds_read_b128 a[224:227], v1 offset:19456
    v_mfma_f32_16x16x32_bf16 v[60:63], a[232:235], a[140:143], v[60:63]
    ds_read_b128 a[228:231], v0 offset:20480
    s_waitcnt lgkmcnt(4)
    v_mfma_f32_16x16x32_bf16 v[64:67], a[212:215], a[120:123], 0
    ds_read_b128 a[232:235], v1 offset:20480
    s_waitcnt lgkmcnt(4)
    v_mfma_f32_16x16x32_bf16 v[64:67], a[216:219], a[124:127], v[64:67]
    s_waitcnt lgkmcnt(3)
    ds_read_b128 a[164:167], v105 offset:16384
    v_mfma_f32_16x16x32_bf16 v[64:67], a[220:223], a[128:131], v[64:67]
    s_waitcnt lgkmcnt(3)
    ds_read_b128 a[216:219], v1 offset:0
    v_mfma_f32_16x16x32_bf16 v[64:67], a[224:227], a[132:135], v[64:67]
    s_waitcnt lgkmcnt(3)
    ds_read_b128 a[212:215], v0 offset:0
    v_mfma_f32_16x16x32_bf16 v[64:67], a[228:231], a[136:139], v[64:67]
    ds_read_b128 a[220:223], v0 offset:1024
    s_waitcnt lgkmcnt(4)
    v_mfma_f32_16x16x32_bf16 v[64:67], a[232:235], a[140:143], v[64:67]
    ds_read_b128 a[224:227], v1 offset:1024
    s_waitcnt lgkmcnt(2)
    v_mfma_f32_16x16x32_bf16 v[68:71], a[212:215], a[144:147], 0
    v_fma_f32 v61, v61, s28, v10
    v_fma_f32 v52, v52, s28, v9
    ds_read_b128 a[160:163], v104 offset:16384
    ds_read_b128 a[212:215], v0 offset:6144
    v_mfma_f32_16x16x32_bf16 v[68:71], a[216:219], a[148:151], v[68:71]
    s_waitcnt lgkmcnt(3)
    ds_read_b128 a[228:231], v0 offset:2048
    v_mfma_f32_16x16x32_bf16 v[68:71], a[220:223], a[152:155], v[68:71]
    ds_read_b128 a[232:235], v1 offset:2048
    s_waitcnt lgkmcnt(4)
    v_mfma_f32_16x16x32_bf16 v[68:71], a[224:227], a[156:159], v[68:71]
    ds_read_b128 a[216:219], v1 offset:6144
    s_waitcnt lgkmcnt(2)
    v_mfma_f32_16x16x32_bf16 v[68:71], a[228:231], a[160:163], v[68:71]
    ds_read_b128 a[220:223], v0 offset:7168
    s_waitcnt lgkmcnt(2)
    v_mfma_f32_16x16x32_bf16 v[68:71], a[232:235], a[164:167], v[68:71]
    v_fma_f32 v60, v60, s28, v10
    ds_read_b128 a[224:227], v1 offset:7168
    s_nop 5
    v_max3_f32 v96, v68, v69, v70
    v_mfma_f32_16x16x32_bf16 v[72:75], a[212:215], a[144:147], 0
    ds_read_b128 a[228:231], v0 offset:8192
    s_waitcnt lgkmcnt(3)
    v_mfma_f32_16x16x32_bf16 v[72:75], a[216:219], a[148:151], v[72:75]
    ds_read_b128 a[232:235], v1 offset:8192
    s_waitcnt lgkmcnt(3)
    v_mfma_f32_16x16x32_bf16 v[72:75], a[220:223], a[152:155], v[72:75]
    ds_read_b128 a[220:223], v0 offset:13312
    v_exp_f32 v52, v52
    s_waitcnt lgkmcnt(3)
    v_mfma_f32_16x16x32_bf16 v[72:75], a[224:227], a[156:159], v[72:75]
    ds_read_b128 a[216:219], v1 offset:12288
    s_waitcnt lgkmcnt(3)
    v_mfma_f32_16x16x32_bf16 v[72:75], a[228:231], a[160:163], v[72:75]
    ds_read_b128 a[224:227], v1 offset:13312
    s_waitcnt lgkmcnt(3)
    v_mfma_f32_16x16x32_bf16 v[72:75], a[232:235], a[164:167], v[72:75]
    s_nop 7
    v_max3_f32 v96, v96, v71, v72
    ds_read_b128 a[212:215], v0 offset:12288
    v_max3_f32 v96, v96, v73, v74
    v_max_f32 v96, v96, v75
    v_mov_b32 v97, v96
    s_nop 1
    v_permlane32_swap_b32 v97, v96
    v_max_f32 v96, v96, v97
    v_mov_b32 v97, v96
    s_nop 1
    v_permlane16_swap_b32 v97, v96
    v_max_f32 v96, v96, v97
    ds_read_b128 a[228:231], v0 offset:14336
    v_exp_f32 v60, v60
    v_mul_f32_e64 v11, -s28, v96
    v_fma_f32 v69, v69, s28, v11
    v_exp_f32 v69, v69
    v_fma_f32 v71, v71, s28, v11
    v_fma_f32 v73, v73, s28, v11
    v_fma_f32 v70, v70, s28, v11
    v_fma_f32 v72, v72, s28, v11
    s_add_u32 s21, s21, 12032
    v_fma_f32 v68, v68, s28, v11
    v_exp_f32 v68, v68
    v_fma_f32 v74, v74, s28, v11
    v_exp_f32 v70, v70
    v_exp_f32 v73, v73
    v_cvt_pk_bf16_f32 v26, v68, v69
    v_fma_f32 v75, v75, s28, v11
    v_exp_f32 v74, v74
    v_exp_f32 v72, v72
    v_exp_f32 v71, v71
    s_nop 0
    v_cvt_pk_bf16_f32 v27, v70, v71
    s_waitcnt lgkmcnt(1)
    v_mfma_f32_16x16x32_bf16 v[68:71], a[212:215], a[144:147], 0
    ds_read_b128 a[232:235], v1 offset:14336
    v_mfma_f32_16x16x32_bf16 v[68:71], a[216:219], a[148:151], v[68:71]
    ds_read_b128 a[212:215], v0 offset:18432
    v_mfma_f32_16x16x32_bf16 v[68:71], a[220:223], a[152:155], v[68:71]
    ds_read_b128 a[216:219], v1 offset:18432
    v_cvt_pk_bf16_f32 v28, v72, v73
    v_exp_f32 v61, v61
    v_mfma_f32_16x16x32_bf16 v[68:71], a[224:227], a[156:159], v[68:71]
    s_waitcnt lgkmcnt(3)
    v_exp_f32 v75, v75
    ds_read_b128 a[224:227], v1 offset:19456
    v_mfma_f32_16x16x32_bf16 v[68:71], a[228:231], a[160:163], v[68:71]
    ds_read_b128 a[220:223], v0 offset:19456
    v_exp_f32 v54, v54
    v_cvt_pk_bf16_f32 v29, v74, v75
    s_waitcnt lgkmcnt(4)
    v_mfma_f32_16x16x32_bf16 v[68:71], a[232:235], a[164:167], v[68:71]
    ds_read_b128 a[232:235], v1 offset:20480
    s_waitcnt lgkmcnt(4)
    v_mfma_f32_16x16x32_bf16 v[72:75], a[212:215], a[144:147], 0
    ds_read_b128 a[228:231], v0 offset:20480
    s_waitcnt lgkmcnt(4)
    v_mfma_f32_16x16x32_bf16 v[72:75], a[216:219], a[148:151], v[72:75]
    ds_read_b128 a[216:219], v1 offset:0
    s_waitcnt lgkmcnt(3)
    v_mfma_f32_16x16x32_bf16 v[72:75], a[220:223], a[152:155], v[72:75]
    v_exp_f32 v53, v53
    ds_read_b128 a[212:215], v0 offset:0
    s_waitcnt vmcnt(6)
    ds_read_b128 a[168:171], v104 offset:18432
    ds_read_b128 a[176:179], v104 offset:20480
    v_mfma_f32_16x16x32_bf16 v[72:75], a[224:227], a[156:159], v[72:75]
    ds_read_b128 a[172:175], v105 offset:18432
    ds_read_b128 a[220:223], v0 offset:1024
    s_waitcnt lgkmcnt(6)
    v_mfma_f32_16x16x32_bf16 v[72:75], a[228:231], a[160:163], v[72:75]
    ds_read_b128 a[228:231], v0 offset:2048
    ds_read_b128 a[180:183], v105 offset:20480
    ds_read_b128 a[224:227], v1 offset:1024
    v_mfma_f32_16x16x32_bf16 v[72:75], a[232:235], a[164:167], v[72:75]
    ds_read_b128 a[184:187], v104 offset:22528
    v_mfma_f32_16x16x32_bf16 v[44:47], a[240:243], v[20:23], v[44:47]
    ds_read_b128 a[232:235], v1 offset:2048
    ds_read_b128 a[188:191], v105 offset:22528
    s_waitcnt lgkmcnt(9)
    v_mfma_f32_16x16x32_bf16 v[76:79], a[212:215], a[168:171], 0
    ds_read_b128 a[212:215], v0 offset:6144
    s_waitcnt lgkmcnt(8)
    v_mfma_f32_16x16x32_bf16 v[76:79], a[216:219], a[172:175], v[76:79]
    s_waitcnt lgkmcnt(7)
    ds_read_b128 a[216:219], v1 offset:6144
    v_mfma_f32_16x16x32_bf16 v[76:79], a[220:223], a[176:179], v[76:79]
    ds_read_b128 a[220:223], v0 offset:7168
    s_waitcnt lgkmcnt(6)
    v_mfma_f32_16x16x32_bf16 v[76:79], a[224:227], a[180:183], v[76:79]
    s_waitcnt lgkmcnt(5)
    ds_read_b128 a[224:227], v1 offset:7168
    v_mfma_f32_16x16x32_bf16 v[76:79], a[228:231], a[184:187], v[76:79]
    ds_read_b128 a[228:231], v0 offset:8192
    s_waitcnt lgkmcnt(5)
    v_mfma_f32_16x16x32_bf16 v[76:79], a[232:235], a[188:191], v[76:79]
    ds_read_b128 a[232:235], v1 offset:8192
    s_waitcnt lgkmcnt(5)
    v_mfma_f32_16x16x32_bf16 v[80:83], a[212:215], a[168:171], 0
    s_waitcnt lgkmcnt(4)
    v_mfma_f32_16x16x32_bf16 v[80:83], a[216:219], a[172:175], v[80:83]
    s_nop 2
    v_max3_f32 v98, v76, v77, v78
    s_waitcnt lgkmcnt(3)
    v_mfma_f32_16x16x32_bf16 v[80:83], a[220:223], a[176:179], v[80:83]
    s_waitcnt vmcnt(63) lgkmcnt(0)
    ds_read_b128 a[212:215], v0 offset:12288
    v_mfma_f32_16x16x32_bf16 v[80:83], a[224:227], a[180:183], v[80:83]
    s_barrier
    ds_read_b128 a[216:219], v1 offset:12288
    v_mfma_f32_16x16x32_bf16 v[80:83], a[228:231], a[184:187], v[80:83]
    s_add_u32 m0, s22, 0
    ds_read_b128 a[224:227], v1 offset:13312
    buffer_load_dwordx4 v6, s[4:7], s20 offen lds
    s_add_u32 s20, s20, 128
    v_mfma_f32_16x16x32_bf16 v[80:83], a[232:235], a[188:191], v[80:83]
    s_add_u32 m0, s22, 1024
    ds_read_b128 a[220:223], v0 offset:13312
    buffer_load_dwordx4 v6, s[4:7], s20 offen lds
    v_mfma_f32_16x16x32_bf16 v[44:47], a[244:247], v[26:29], v[44:47]
    s_add_u32 s20, s20, 128
    s_add_u32 m0, s22, 2048
    ds_read_b128 a[228:231], v0 offset:14336
    ds_read_b128 a[232:235], v1 offset:14336
    buffer_load_dwordx4 v6, s[4:7], s20 offen lds
    v_max3_f32 v98, v98, v79, v80
    s_add_u32 s20, s20, 12032
    s_mov_b32 s39, s64
    v_max3_f32 v98, v98, v81, v82
    v_max_f32 v98, v98, v83
    v_mov_b32 v99, v98
    s_add_u32 s37, s37, 1
    s_bitcmp1_b32 s63, s37
    v_permlane32_swap_b32 v99, v98
    v_max_f32 v98, v98, v99
    v_mov_b32 v99, v98
    s_cselect_b32 s62, 4294770688, 0
    s_cselect_b32 s42, 0, 325632
    v_permlane16_swap_b32 v99, v98
    v_max_f32 v98, v98, v99
    v_mul_f32_e64 v12, -s28, v98
    v_fma_f32 v77, v77, s28, v12
    v_fma_f32 v79, v79, s28, v12
    v_exp_f32 v77, v77
    v_fma_f32 v78, v78, s28, v12
    v_fma_f32 v82, v82, s28, v12
    s_add_u32 s35, s35, s42
    s_lshl_b32 s42, s37, 1
    v_fma_f32 v76, v76, s28, v12
    v_exp_f32 v78, v78
    v_exp_f32 v76, v76
    v_exp_f32 v79, v79
    v_cvt_pk_bf16_f32 v32, v76, v77
    v_cvt_pk_bf16_f32 v33, v78, v79
    s_waitcnt lgkmcnt(0)
    v_mfma_f32_16x16x32_bf16 v[76:79], a[212:215], a[168:171], 0
    s_lshr_b32 s42, s31, s42
    ds_read_b128 a[212:215], v0 offset:18432
    s_and_b32 s42, s42, 3
    v_mfma_f32_16x16x32_bf16 v[76:79], a[216:219], a[172:175], v[76:79]
    s_add_u32 s42, s42, s36
    ds_read_b128 a[216:219], v1 offset:18432
    s_sub_u32 s43, s42, 3
    v_mfma_f32_16x16x32_bf16 v[76:79], a[220:223], a[176:179], v[76:79]
    s_cmp_ge_u32 s42, 3
    ds_read_b128 a[220:223], v0 offset:19456
    s_cselect_b32 s42, s43, s42
    v_mfma_f32_16x16x32_bf16 v[76:79], a[224:227], a[180:183], v[76:79]
    s_mul_i32 s44, s3, 5
    ds_read_b128 a[224:227], v1 offset:19456
    s_mov_b32 s32, 1
    v_mfma_f32_16x16x32_bf16 v[76:79], a[228:231], a[184:187], v[76:79]
    s_lshl_b32 s43, s3, 2
    s_add_u32 s45, s43, 21
    ds_read_b128 a[228:231], v0 offset:20480
    v_mfma_f32_16x16x32_bf16 v[76:79], a[232:235], a[188:191], v[76:79]
    s_cmp_eq_u32 s3, 0
    ds_read_b128 a[232:235], v1 offset:20480
    v_fma_f32 v83, v83, s28, v12
    s_cselect_b32 s45, 20, s45
    v_fma_f32 v80, v80, s28, v12
    s_cselect_b32 s33, 1, 0
    s_cmp_eq_u32 s42, 1
    s_cselect_b32 s44, s45, s44
    s_cselect_b32 s32, s33, s32
    v_fma_f32 v81, v81, s28, v12
    s_add_u32 s45, s43, 37
    v_exp_f32 v83, v83
    v_exp_f32 v82, v82
    s_cmp_eq_u32 s42, 2
    v_exp_f32 v81, v81
    v_exp_f32 v80, v80
    s_cselect_b32 s44, s45, s44
    s_cselect_b32 s32, 0, s32
    v_cvt_pk_bf16_f32 v35, v82, v83
    s_mul_i32 s44, s44, 6144
    v_cvt_pk_bf16_f32 v34, v80, v81
    s_add_u32 s33, s35, s44
    s_mul_i32 s42, s32, 6144
    s_add_u32 s42, s42, 24576
    s_add_u32 s42, s42, s33
    s_cmp_ge_u32 s37, 6
    s_cselect_b32 s14, 0, s42
    s_add_u32 s24, s67, 6400
    s_add_u32 s25, s33, 6400
    s_add_u32 s23, s38, 10240
    s_waitcnt lgkmcnt(2)
    v_mfma_f32_16x16x32_bf16 v[80:83], a[212:215], a[168:171], 0
    s_mov_b32 s27, 0x49249249
    s_mov_b32 s30, 0
    s_waitcnt vmcnt(6) lgkmcnt(0)
    s_barrier
    ds_read_b64_tr_b16 a[212:213], v2 offset:0
    ds_read_b64_tr_b16 a[214:215], v2 offset:6144
    v_mfma_f32_16x16x32_bf16 v[80:83], a[216:219], a[172:175], v[80:83]
    ds_read_b64_tr_b16 a[216:217], v3 offset:0
    ds_read_b64_tr_b16 a[218:219], v3 offset:6144
    s_add_u32 m0, s22, 12288
    v_mfma_f32_16x16x32_bf16 v[80:83], a[220:223], a[176:179], v[80:83]
    buffer_load_dwordx4 v6, s[4:7], s20 offen lds
    s_add_u32 s20, s20, 128
    s_add_u32 m0, s22, 13312
    ds_read_b64_tr_b16 a[220:221], v4 offset:0
    v_exp_f32 v55, v55
    v_mfma_f32_16x16x32_bf16 v[80:83], a[224:227], a[180:183], v[80:83]
    ds_read_b64_tr_b16 a[222:223], v4 offset:6144
    v_cvt_pk_bf16_f32 v24, v60, v61
    buffer_load_dwordx4 v6, s[4:7], s20 offen lds
    v_mfma_f32_16x16x32_bf16 v[44:47], a[248:251], v[32:35], v[44:47]
    s_add_u32 s20, s20, 128
    ds_read_b64_tr_b16 a[224:225], v5 offset:0
    v_cvt_pk_bf16_f32 v18, v52, v53
    v_mfma_f32_16x16x32_bf16 v[80:83], a[228:231], a[184:187], v[80:83]
    ds_read_b64_tr_b16 a[226:227], v5 offset:6144
    s_add_u32 m0, s22, 14336
    s_nop 0
    buffer_load_dwordx4 v6, s[4:7], s20 offen lds
    s_add_u32 s20, s20, 12032
    v_cvt_pk_bf16_f32 v19, v54, v55
    v_mfma_f32_16x16x32_bf16 v[80:83], a[232:235], a[188:191], v[80:83]
    s_waitcnt lgkmcnt(4)
    v_mfma_f32_16x16x32_bf16 v[112:115], a[212:215], v[14:17], 0
    ds_read_b64_tr_b16 a[234:235], v3 offset:7168
    v_fma_f32 v74, v74, s28, v11
    v_mfma_f32_16x16x32_bf16 v[116:119], a[216:219], v[14:17], 0
    ds_read_b64_tr_b16 a[232:233], v3 offset:1024
    v_fma_f32 v69, v69, s28, v11
    v_mfma_f32_16x16x32_bf16 v[164:167], a[216:219], v[20:23], 0
    v_fma_f32 v80, v80, s28, v12
    v_fma_f32 v81, v81, s28, v12
    v_mfma_f32_16x16x32_bf16 v[160:163], a[212:215], v[20:23], 0
    ds_read_b64_tr_b16 a[230:231], v2 offset:7168
    v_fma_f32 v73, v73, s28, v11
    v_mfma_f32_16x16x32_bf16 v[208:211], a[212:215], v[26:29], 0
    v_exp_f32 v69, v69
    v_mfma_f32_16x16x32_bf16 v[212:215], a[216:219], v[26:29], 0
    ds_read_b64_tr_b16 a[228:229], v2 offset:1024
    v_fma_f32 v75, v75, s28, v11
    v_mfma_f32_16x16x32_bf16 a[4:7], a[216:219], v[32:35], 0
    v_fma_f32 v72, v72, s28, v11
    v_fma_f32 v82, v82, s28, v12
    v_mfma_f32_16x16x32_bf16 a[0:3], a[212:215], v[32:35], 0
    ds_read_b64_tr_b16 a[216:217], v5 offset:1024
    s_waitcnt lgkmcnt(5)
    v_mfma_f32_16x16x32_bf16 a[8:11], a[220:223], v[32:35], 0
    v_exp_f32 v81, v81
    v_mfma_f32_16x16x32_bf16 a[12:15], a[224:227], v[32:35], 0
    v_exp_f32 v73, v73
    v_mfma_f32_16x16x32_bf16 v[220:223], a[224:227], v[26:29], 0
    ds_read_b64_tr_b16 a[214:215], v4 offset:7168
    v_fma_f32 v57, v57, s28, v9
    v_mfma_f32_16x16x32_bf16 v[216:219], a[220:223], v[26:29], 0
    v_fma_f32 v83, v83, s28, v12
    v_fma_f32 v56, v56, s28, v9
    v_mfma_f32_16x16x32_bf16 v[168:171], a[220:223], v[20:23], 0
    ds_read_b64_tr_b16 a[212:213], v4 offset:1024
    v_fma_f32 v71, v71, s28, v11
    v_mfma_f32_16x16x32_bf16 v[172:175], a[224:227], v[20:23], 0
    v_exp_f32 v74, v74
    v_mfma_f32_16x16x32_bf16 v[124:127], a[224:227], v[14:17], 0
    ds_read_b64_tr_b16 a[218:219], v5 offset:7168
    v_fma_f32 v59, v59, s28, v9
    v_mfma_f32_16x16x32_bf16 v[120:123], a[220:223], v[14:17], 0
    s_waitcnt lgkmcnt(4)
    ds_read_b64_tr_b16 a[224:225], v3 offset:2048
    v_fma_f32 v78, v78, s28, v12
    v_mfma_f32_16x16x32_bf16 v[128:131], a[228:231], v[14:17], 0
    v_fma_f32 v77, v77, s28, v12
    v_fma_f32 v58, v58, s28, v9
    v_mfma_f32_16x16x32_bf16 v[132:135], a[232:235], v[14:17], 0
    ds_read_b64_tr_b16 a[222:223], v2 offset:8192
    v_fma_f32 v68, v68, s28, v11
    v_mfma_f32_16x16x32_bf16 v[180:183], a[232:235], v[20:23], 0
    v_exp_f32 v57, v57
    v_mfma_f32_16x16x32_bf16 v[176:179], a[228:231], v[20:23], 0
    v_exp_f32 v78, v78
    v_mfma_f32_16x16x32_bf16 v[224:227], a[228:231], v[26:29], 0
    v_exp_f32 v68, v68
    v_mfma_f32_16x16x32_bf16 v[228:231], a[232:235], v[26:29], 0
    ds_read_b64_tr_b16 a[220:221], v2 offset:2048
    v_fma_f32 v63, v63, s28, v10
    v_mfma_f32_16x16x32_bf16 a[20:23], a[232:235], v[32:35], 0
    ds_read_b64_tr_b16 a[226:227], v3 offset:8192
    v_add_u32 v8, 10240, v8
    v_mfma_f32_16x16x32_bf16 a[16:19], a[228:231], v[32:35], 0
    s_waitcnt lgkmcnt(5)
    ds_read_b64_tr_b16 a[230:231], v4 offset:8192
    v_cvt_pk_bf16_f32 v30, v68, v69
    v_mfma_f32_16x16x32_bf16 a[24:27], a[212:215], v[32:35], 0
    s_waitcnt lgkmcnt(5)
    ds_read_b64_tr_b16 a[234:235], v5 offset:8192
    v_fma_f32 v62, v62, s28, v10
    v_mfma_f32_16x16x32_bf16 a[28:31], a[216:219], v[32:35], 0
    ds_read_b64_tr_b16 a[232:233], v5 offset:2048
    v_fma_f32 v67, v67, s28, v10
    v_mfma_f32_16x16x32_bf16 v[236:239], a[216:219], v[26:29], 0
    s_add_u32 s39, s39, 12288
    ds_read_b64_tr_b16 a[228:229], v4 offset:2048
    v_fma_f32 v70, v70, s28, v11
    v_mfma_f32_16x16x32_bf16 v[232:235], a[212:215], v[26:29], 0
    v_exp_f32 v80, v80
    v_mfma_f32_16x16x32_bf16 v[184:187], a[212:215], v[20:23], 0
    v_exp_f32 v70, v70
    v_mfma_f32_16x16x32_bf16 v[188:191], a[216:219], v[20:23], 0
    v_fma_f32 v79, v79, s28, v12
    v_fma_f32 v64, v64, s28, v10
    v_mfma_f32_16x16x32_bf16 v[140:143], a[216:219], v[14:17], 0
    v_exp_f32 v77, v77
    v_mfma_f32_16x16x32_bf16 v[136:139], a[212:215], v[14:17], 0
    s_waitcnt lgkmcnt(5)
    v_exp_f32 v71, v71
    v_mfma_f32_16x16x32_bf16 v[144:147], a[220:223], v[14:17], 0
    s_waitcnt lgkmcnt(4)
    v_exp_f32 v82, v82
    v_mfma_f32_16x16x32_bf16 v[148:151], a[224:227], v[14:17], 0
    v_exp_f32 v56, v56
    v_mfma_f32_16x16x32_bf16 v[196:199], a[224:227], v[20:23], 0
    v_exp_f32 v67, v67
    v_mfma_f32_16x16x32_bf16 v[192:195], a[220:223], v[20:23], 0
    v_fma_f32 v66, v66, s28, v10
    v_cvt_pk_bf16_f32 v31, v70, v71
    v_mfma_f32_16x16x32_bf16 v[240:243], a[220:223], v[26:29], 0
    s_waitcnt vmcnt(3) lgkmcnt(0)
    v_exp_f32 v62, v62
    v_mfma_f32_16x16x32_bf16 v[244:247], a[224:227], v[26:29], 0
    s_barrier
    ds_read_b128 a[212:215], v0 offset:0
    v_mfma_f32_16x16x32_bf16 a[36:39], a[224:227], v[32:35], 0
    s_add_u32 m0, s22, 24576
    ds_read_b128 a[216:219], v1 offset:0
    v_fma_f32 v76, v76, s28, v12
    v_mfma_f32_16x16x32_bf16 a[32:35], a[220:223], v[32:35], 0
    ds_read_b128 a[220:223], v0 offset:1024
    v_fma_f32 v65, v65, s28, v10
    v_mfma_f32_16x16x32_bf16 a[40:43], a[228:231], v[32:35], 0
    buffer_load_dwordx4 v6, s[8:11], s21 offen lds
    v_mfma_f32_16x16x32_bf16 a[44:47], a[232:235], v[32:35], 0
    v_exp_f32 v66, v66
    v_mfma_f32_16x16x32_bf16 v[252:255], a[232:235], v[26:29], 0
    s_add_u32 s21, s21, 128
    v_exp_f32 v64, v64
    v_mfma_f32_16x16x32_bf16 v[248:251], a[228:231], v[26:29], 0
    s_add_u32 m0, s22, 25600
    v_exp_f32 v58, v58
    v_mfma_f32_16x16x32_bf16 v[200:203], a[228:231], v[20:23], 0
    buffer_load_dwordx4 v6, s[8:11], s21 offen lds
    v_mfma_f32_16x16x32_bf16 v[204:207], a[232:235], v[20:23], 0
    s_add_u32 s21, s21, 128
    s_add_u32 m0, s22, 26624
    ds_read_b128 a[224:227], v1 offset:1024
    v_mfma_f32_16x16x32_bf16 v[156:159], a[232:235], v[14:17], 0
    buffer_load_dwordx4 v6, s[8:11], s21 offen lds
    v_mfma_f32_16x16x32_bf16 v[152:155], a[228:231], v[14:17], 0
    s_waitcnt lgkmcnt(3)
    v_exp_f32 v63, v63
    v_mfma_f32_16x16x32_bf16 v[52:55], a[212:215], a[96:99], 0
    s_waitcnt lgkmcnt(2)
    v_exp_f32 v75, v75
    v_mfma_f32_16x16x32_bf16 v[52:55], a[216:219], a[100:103], v[52:55]
    s_waitcnt lgkmcnt(1)
    ds_read_b128 a[228:231], v0 offset:2048
    v_cvt_pk_bf16_f32 v34, v80, v81
    v_mfma_f32_16x16x32_bf16 v[52:55], a[220:223], a[104:107], v[52:55]
    s_add_u32 s21, s21, 12032
    ds_read_b128 a[232:235], v1 offset:2048
    v_cvt_pk_bf16_f32 v25, v62, v63
    v_mfma_f32_16x16x32_bf16 v[60:63], a[220:223], a[128:131], 0
    v_exp_f32 v76, v76
    v_mfma_f32_16x16x32_bf16 v[60:63], a[216:219], a[124:127], v[60:63]
    v_exp_f32 v79, v79
    v_mfma_f32_16x16x32_bf16 v[60:63], a[212:215], a[120:123], v[60:63]
    s_add_u32 m0, s38, 0
    v_cvt_pk_bf16_f32 v36, v76, v77
    v_cvt_pk_bf16_f32 v37, v78, v79
    v_mfma_f32_16x16x32_bf16 v[68:71], a[212:215], a[144:147], 0
    buffer_load_dwordx4 v6, s[12:15], s33 offen nt lds
    v_mfma_f32_16x16x32_bf16 v[68:71], a[216:219], a[148:151], v[68:71]
    s_add_u32 m0, s38, 1024
    v_exp_f32 v83, v83
    v_mfma_f32_16x16x32_bf16 v[68:71], a[220:223], a[152:155], v[68:71]
    buffer_load_dwordx4 v7, s[12:15], s33 offen nt lds
    v_mfma_f32_16x16x32_bf16 v[76:79], a[220:223], a[176:179], 0
    v_exp_f32 v59, v59
    v_mfma_f32_16x16x32_bf16 v[76:79], a[216:219], a[172:175], v[76:79]
    s_add_u32 s59, s33, 6144
    v_exp_f32 v72, v72
    v_mfma_f32_16x16x32_bf16 v[76:79], a[212:215], a[168:171], v[76:79]
    s_waitcnt lgkmcnt(1)
    ds_read_b128 a[212:215], v0 offset:6144
    s_add_u32 m0, s38, 6144
    v_mfma_f32_16x16x32_bf16 v[76:79], a[224:227], a[180:183], v[76:79]
    v_exp_f32 v65, v65
    v_mfma_f32_16x16x32_bf16 v[76:79], a[228:231], a[184:187], v[76:79]
    s_waitcnt lgkmcnt(1)
    ds_read_b128 a[216:219], v1 offset:6144
    v_cvt_pk_bf16_f32 v17, v58, v59
    v_mfma_f32_16x16x32_bf16 v[76:79], a[232:235], a[188:191], v[76:79]
    buffer_load_dwordx4 v6, s[12:15], s59 offen nt lds
    v_mfma_f32_16x16x32_bf16 v[68:71], a[232:235], a[164:167], v[68:71]
    ds_read_b128 a[220:223], v0 offset:7168
    s_add_u32 m0, s38, 7168
    v_mfma_f32_16x16x32_bf16 v[68:71], a[228:231], a[160:163], v[68:71]
    buffer_load_dwordx4 v7, s[12:15], s59 offen nt lds
    v_mfma_f32_16x16x32_bf16 v[68:71], a[224:227], a[156:159], v[68:71]
    s_add_u32 s58, s33, 128
    s_add_u32 m0, s38, 2048
    v_cvt_pk_bf16_f32 v16, v56, v57
    v_mfma_f32_16x16x32_bf16 v[60:63], a[224:227], a[132:135], v[60:63]
    buffer_load_dwordx4 v6, s[12:15], s58 offen nt lds
    v_mfma_f32_16x16x32_bf16 v[60:63], a[228:231], a[136:139], v[60:63]
    s_add_u32 m0, s38, 3072
    v_cvt_pk_bf16_f32 v29, v74, v75
    v_cvt_pk_bf16_f32 v22, v64, v65
    v_mfma_f32_16x16x32_bf16 v[60:63], a[232:235], a[140:143], v[60:63]
    buffer_load_dwordx4 v7, s[12:15], s58 offen nt lds
    v_mfma_f32_16x16x32_bf16 v[52:55], a[232:235], a[116:119], v[52:55]
    ds_read_b128 a[232:235], v1 offset:8192
    v_cvt_pk_bf16_f32 v28, v72, v73
    v_mfma_f32_16x16x32_bf16 v[52:55], a[228:231], a[112:115], v[52:55]
    s_add_u32 s59, s33, 6272
    ds_read_b128 a[228:231], v0 offset:8192
    s_add_u32 m0, s38, 8192
    v_mfma_f32_16x16x32_bf16 v[52:55], a[224:227], a[108:111], v[52:55]
    s_waitcnt lgkmcnt(3)
    ds_read_b128 a[224:227], v1 offset:7168
    v_mfma_f32_16x16x32_bf16 v[56:59], a[212:215], a[96:99], 0
    v_cvt_pk_bf16_f32 v35, v82, v83
    v_cvt_pk_bf16_f32 v23, v66, v67
    v_mfma_f32_16x16x32_bf16 v[48:51], a[236:239], v[16:19], v[44:47]
    s_nop 0
    v_mfma_f32_16x16x32_bf16 v[48:51], a[240:243], v[22:25], v[48:51]
    buffer_load_dwordx4 v6, s[12:15], s59 offen nt lds
    v_mfma_f32_16x16x32_bf16 v[56:59], a[216:219], a[100:103], v[56:59]
    s_add_u32 m0, s38, 9216
    v_mfma_f32_16x16x32_bf16 v[48:51], a[244:247], v[28:31], v[48:51]
    buffer_load_dwordx4 v7, s[12:15], s59 offen nt lds
    v_mfma_f32_16x16x32_bf16 v[48:51], a[248:251], v[34:37], v[48:51]
    s_add_u32 s58, s33, 256
    s_add_u32 m0, s38, 4096
    s_waitcnt lgkmcnt(3)
    v_mfma_f32_16x16x32_bf16 v[56:59], a[220:223], a[104:107], v[56:59]
    buffer_load_dwordx4 v6, s[12:15], s58 offen nt lds
    s_add_u32 m0, s38, 5120
    v_mfma_f32_16x16x32_bf16 v[64:67], a[220:223], a[128:131], 0
    buffer_load_dwordx4 v7, s[12:15], s58 offen nt lds
    v_mfma_f32_16x16x32_bf16 v[64:67], a[216:219], a[124:127], v[64:67]
    v_cmp_lt_f32 vcc, s29, v48
    s_waitcnt vmcnt(19) lgkmcnt(0)
    v_mfma_f32_16x16x32_bf16 v[64:67], a[212:215], a[120:123], v[64:67]
    s_barrier
    v_mfma_f32_16x16x32_bf16 v[72:75], a[212:215], a[144:147], 0
    s_nop 0
    s_cbranch_vccnz L_rs_start4b
L_ret_start4b:
    v_mfma_f32_16x16x32_bf16 v[72:75], a[216:219], a[148:151], v[72:75]
    s_add_u32 m0, s22, 0
    v_fma_f32 v55, v55, s28, v9
    v_mfma_f32_16x16x32_bf16 v[72:75], a[220:223], a[152:155], v[72:75]
    buffer_load_dwordx4 v6, s[4:7], s20 offen lds
    v_mfma_f32_16x16x32_bf16 v[80:83], a[220:223], a[176:179], 0
    s_add_u32 s20, s20, 128
    v_fma_f32 v53, v53, s28, v9
    s_add_u32 m0, s22, 1024
    v_mfma_f32_16x16x32_bf16 v[80:83], a[216:219], a[172:175], v[80:83]
    buffer_load_dwordx4 v6, s[4:7], s20 offen lds
    v_mfma_f32_16x16x32_bf16 v[80:83], a[212:215], a[168:171], v[80:83]
    ds_read_b64_tr_b16 a[212:213], v2 offset:18432
    v_mfma_f32_16x16x32_bf16 v[80:83], a[224:227], a[180:183], v[80:83]
    ds_read_b64_tr_b16 a[214:215], v2 offset:12288
    v_fma_f32 v54, v54, s28, v9
    v_mfma_f32_16x16x32_bf16 v[80:83], a[228:231], a[184:187], v[80:83]
    s_add_u32 s20, s20, 128
    ds_read_b64_tr_b16 a[216:217], v3 offset:18432
    v_fma_f32 v52, v52, s28, v9
    v_mfma_f32_16x16x32_bf16 v[80:83], a[232:235], a[188:191], v[80:83]
    s_add_u32 m0, s22, 2048
    ds_read_b64_tr_b16 a[218:219], v3 offset:12288
    v_fma_f32 v60, v60, s28, v10
    v_mfma_f32_16x16x32_bf16 v[72:75], a[232:235], a[164:167], v[72:75]
    buffer_load_dwordx4 v6, s[4:7], s20 offen lds
    v_mfma_f32_16x16x32_bf16 v[72:75], a[228:231], a[160:163], v[72:75]
    v_exp_f32 v54, v54
    v_mfma_f32_16x16x32_bf16 v[72:75], a[224:227], a[156:159], v[72:75]
    v_exp_f32 v53, v53
    v_mfma_f32_16x16x32_bf16 v[64:67], a[224:227], a[132:135], v[64:67]
    ds_read_b64_tr_b16 a[220:221], v4 offset:18432
    v_fma_f32 v61, v61, s28, v10
    v_mfma_f32_16x16x32_bf16 v[64:67], a[228:231], a[136:139], v[64:67]
    v_exp_f32 v61, v61
    v_mfma_f32_16x16x32_bf16 v[64:67], a[232:235], a[140:143], v[64:67]
    v_exp_f32 v60, v60
    v_mfma_f32_16x16x32_bf16 v[56:59], a[232:235], a[116:119], v[56:59]
    s_add_u32 s20, s20, 12032
    v_exp_f32 v55, v55
    v_mfma_f32_16x16x32_bf16 v[56:59], a[228:231], a[112:115], v[56:59]
    ds_read_b64_tr_b16 a[222:223], v4 offset:12288
    v_cvt_pk_bf16_f32 v15, v54, v55
    v_mfma_f32_16x16x32_bf16 v[56:59], a[224:227], a[108:111], v[56:59]
    ds_read_b64_tr_b16 a[224:225], v5 offset:18432
    ds_read_b64_tr_b16 a[226:227], v5 offset:12288
    v_exp_f32 v52, v52
    v_cvt_pk_bf16_f32 v20, v60, v61
    v_cvt_pk_bf16_f32 v14, v52, v53
    s_branch L_loop4
L_loop5:
    .p2align 6
L_loop5w0:
    s_waitcnt lgkmcnt(4)
    v_mfma_f32_16x16x32_bf16 v[112:115], a[212:215], v[16:19], v[112:115]
    v_fma_f32 v68, v68, s28, v11
    v_mfma_f32_16x16x32_bf16 v[116:119], a[216:219], v[16:19], v[116:119]
    v_fma_f32 v80, v80, s28, v12
    v_fma_f32 v69, v69, s28, v11
    v_mfma_f32_16x16x32_bf16 v[164:167], a[216:219], v[22:25], v[164:167]
    ds_read_b64_tr_b16 a[230:231], v2 offset:13312
    v_mfma_f32_16x16x32_bf16 v[160:163], a[212:215], v[22:25], v[160:163]
    v_fma_f32 v71, v71, s28, v11
    v_fma_f32 v88, v88, s28, v13
    v_mfma_f32_16x16x32_bf16 v[208:211], a[212:215], v[28:31], v[208:211]
    v_exp_f32 v71, v71
    v_mfma_f32_16x16x32_bf16 v[212:215], a[216:219], v[28:31], v[212:215]
    v_fma_f32 v56, v56, s28, v9
    v_mfma_f32_16x16x32_bf16 a[4:7], a[216:219], v[34:37], a[4:7]
    ds_read_b64_tr_b16 a[232:233], v3 offset:19456
    v_fma_f32 v76, v76, s28, v12
    v_mfma_f32_16x16x32_bf16 a[0:3], a[212:215], v[34:37], a[0:3]
    v_fma_f32 v67, v67, s28, v10
    v_fma_f32 v72, v72, s28, v11
    v_mfma_f32_16x16x32_bf16 a[48:51], a[212:215], v[40:43], a[48:51]
    ds_read_b64_tr_b16 a[234:235], v3 offset:13312
    v_fma_f32 v89, v89, s28, v13
    v_mfma_f32_16x16x32_bf16 a[52:55], a[216:219], v[40:43], a[52:55]
    s_waitcnt lgkmcnt(3)
    ds_read_b64_tr_b16 a[228:229], v2 offset:19456
    v_fma_f32 v78, v78, s28, v12
    v_mfma_f32_16x16x32_bf16 a[56:59], a[220:223], v[40:43], a[56:59]
    v_fma_f32 v84, v84, s28, v13
    v_fma_f32 v90, v90, s28, v13
    v_mfma_f32_16x16x32_bf16 a[60:63], a[224:227], v[40:43], a[60:63]
    v_exp_f32 v80, v80
    v_mfma_f32_16x16x32_bf16 a[12:15], a[224:227], v[34:37], a[12:15]
    v_fma_f32 v70, v70, s28, v11
    v_fma_f32 v86, v86, s28, v13
    v_mfma_f32_16x16x32_bf16 a[8:11], a[220:223], v[34:37], a[8:11]
    ds_read_b64_tr_b16 a[212:213], v4 offset:19456
    v_mfma_f32_16x16x32_bf16 v[216:219], a[220:223], v[28:31], v[216:219]
    v_fma_f32 v82, v82, s28, v12
    v_mfma_f32_16x16x32_bf16 v[220:223], a[224:227], v[28:31], v[220:223]
    ds_read_b64_tr_b16 a[214:215], v4 offset:13312
    v_mfma_f32_16x16x32_bf16 v[172:175], a[224:227], v[22:25], v[172:175]
    v_fma_f32 v87, v87, s28, v13
    v_fma_f32 v77, v77, s28, v12
    v_mfma_f32_16x16x32_bf16 v[168:171], a[220:223], v[22:25], v[168:171]
    s_add_u32 s39, s39, 12288
    ds_read_b64_tr_b16 a[218:219], v5 offset:13312
    v_fma_f32 v79, v79, s28, v12
    v_mfma_f32_16x16x32_bf16 v[120:123], a[220:223], v[16:19], v[120:123]
    ds_read_b64_tr_b16 a[216:217], v5 offset:19456
    v_fma_f32 v73, v73, s28, v11
    v_mfma_f32_16x16x32_bf16 v[124:127], a[224:227], v[16:19], v[124:127]
    s_waitcnt lgkmcnt(4)
    ds_read_b64_tr_b16 a[222:223], v2 offset:14336
    v_fma_f32 v57, v57, s28, v9
    v_mfma_f32_16x16x32_bf16 v[128:131], a[228:231], v[16:19], v[128:131]
    v_exp_f32 v56, v56
    v_mfma_f32_16x16x32_bf16 v[132:135], a[232:235], v[16:19], v[132:135]
    v_exp_f32 v88, v88
    v_mfma_f32_16x16x32_bf16 v[180:183], a[232:235], v[22:25], v[180:183]
    v_exp_f32 v78, v78
    v_mfma_f32_16x16x32_bf16 v[176:179], a[228:231], v[22:25], v[176:179]
    ds_read_b128 v[96:99], v8 offset:0
    v_fma_f32 v66, v66, s28, v10
    v_mfma_f32_16x16x32_bf16 v[224:227], a[228:231], v[28:31], v[224:227]
    ds_read_b64_tr_b16 a[224:225], v3 offset:20480
    v_mfma_f32_16x16x32_bf16 v[228:231], a[232:235], v[28:31], v[228:231]
    ds_read_b64_tr_b16 a[220:221], v2 offset:20480
    v_mfma_f32_16x16x32_bf16 a[20:23], a[232:235], v[34:37], a[20:23]
    ds_read_b64_tr_b16 a[226:227], v3 offset:14336
    v_mfma_f32_16x16x32_bf16 a[16:19], a[228:231], v[34:37], a[16:19]
    v_exp_f32 v76, v76
    v_mfma_f32_16x16x32_bf16 a[64:67], a[228:231], v[40:43], a[64:67]
    ds_read_b64_tr_b16 a[228:229], v4 offset:20480
    v_mfma_f32_16x16x32_bf16 a[68:71], a[232:235], v[40:43], a[68:71]
    s_waitcnt lgkmcnt(5)
    v_exp_f32 v69, v69
    v_mfma_f32_16x16x32_bf16 a[72:75], a[212:215], v[40:43], a[72:75]
    v_exp_f32 v79, v79
    v_mfma_f32_16x16x32_bf16 a[76:79], a[216:219], v[40:43], a[76:79]
    v_exp_f32 v68, v68
    v_mfma_f32_16x16x32_bf16 a[28:31], a[216:219], v[34:37], a[28:31]
    ds_read_b64_tr_b16 a[232:233], v5 offset:20480
    v_mfma_f32_16x16x32_bf16 a[24:27], a[212:215], v[34:37], a[24:27]
    ds_read_b64_tr_b16 a[234:235], v5 offset:14336
    v_fma_f32 v85, v85, s28, v13
    v_mfma_f32_16x16x32_bf16 v[232:235], a[212:215], v[28:31], v[232:235]
    v_mfma_f32_16x16x32_bf16 v[236:239], a[216:219], v[28:31], v[236:239]
    ds_read_b64_tr_b16 a[230:231], v4 offset:14336
    v_fma_f32 v58, v58, s28, v9
    v_mfma_f32_16x16x32_bf16 v[188:191], a[216:219], v[22:25], v[188:191]
    v_exp_f32 v85, v85
    v_mfma_f32_16x16x32_bf16 v[184:187], a[212:215], v[22:25], v[184:187]
    v_mfma_f32_16x16x32_bf16 v[136:139], a[212:215], v[16:19], v[136:139]
    v_exp_f32 v73, v73
    v_mfma_f32_16x16x32_bf16 v[140:143], a[216:219], v[16:19], v[140:143]
    s_waitcnt lgkmcnt(3)
    v_fma_f32 v59, v59, s28, v9
    v_mfma_f32_16x16x32_bf16 v[144:147], a[220:223], v[16:19], v[144:147]
    v_exp_f32 v77, v77
    v_mfma_f32_16x16x32_bf16 v[148:151], a[224:227], v[16:19], v[148:151]
    v_exp_f32 v70, v70
    v_mfma_f32_16x16x32_bf16 v[196:199], a[224:227], v[22:25], v[196:199]
    v_fma_f32 v91, v91, s28, v13
    v_mfma_f32_16x16x32_bf16 v[192:195], a[220:223], v[22:25], v[192:195]
    v_fma_f32 v83, v83, s28, v12
    v_fma_f32 v74, v74, s28, v11
    v_mfma_f32_16x16x32_bf16 v[240:243], a[220:223], v[28:31], v[240:243]
    v_cvt_pk_bf16_f32 v32, v76, v77
    v_cvt_pk_bf16_f32 v27, v70, v71
    v_mfma_f32_16x16x32_bf16 v[244:247], a[224:227], v[28:31], v[244:247]
    s_waitcnt vmcnt(10) lgkmcnt(0)
    v_exp_f32 v91, v91
    v_mfma_f32_16x16x32_bf16 a[36:39], a[224:227], v[34:37], a[36:39]
    v_exp_f32 v87, v87
    v_mfma_f32_16x16x32_bf16 a[32:35], a[220:223], v[34:37], a[32:35]
    s_barrier
    v_mfma_f32_16x16x32_bf16 a[80:83], a[220:223], v[40:43], a[80:83]
    s_add_u32 m0, s22, 36864
    ds_read_b128 a[212:215], v0 offset:12288
    v_cvt_pk_bf16_f32 v26, v68, v69
    v_mfma_f32_16x16x32_bf16 a[84:87], a[224:227], v[40:43], a[84:87]
    ds_read_b128 a[216:219], v1 offset:12288
    v_fma_f32 v75, v75, s28, v11
    v_mfma_f32_16x16x32_bf16 a[88:91], a[228:231], v[40:43], a[88:91]
    ds_read_b128 a[220:223], v0 offset:13312
    v_mfma_f32_16x16x32_bf16 a[92:95], a[232:235], v[40:43], a[92:95]
    buffer_load_dwordx4 v6, s[8:11], s21 offen lds
    v_mfma_f32_16x16x32_bf16 a[44:47], a[232:235], v[34:37], a[44:47]
    s_add_u32 s21, s21, 128
    v_fma_f32 v65, v65, s28, v10
    v_cvt_pk_bf16_f32 v33, v78, v79
    v_mfma_f32_16x16x32_bf16 a[40:43], a[228:231], v[34:37], a[40:43]
    s_add_u32 m0, s22, 37888
    v_exp_f32 v67, v67
    v_mfma_f32_16x16x32_bf16 v[248:251], a[228:231], v[28:31], v[248:251]
    v_exp_f32 v74, v74
    v_mfma_f32_16x16x32_bf16 v[252:255], a[232:235], v[28:31], v[252:255]
    buffer_load_dwordx4 v6, s[8:11], s21 offen lds
    v_mfma_f32_16x16x32_bf16 v[204:207], a[232:235], v[22:25], v[204:207]
    v_exp_f32 v86, v86
    v_mfma_f32_16x16x32_bf16 v[200:203], a[228:231], v[22:25], v[200:203]
    s_add_u32 s21, s21, 128
    s_add_u32 m0, s22, 38912
    v_fma_f32 v64, v64, s28, v10
    v_mfma_f32_16x16x32_bf16 v[152:155], a[228:231], v[16:19], v[152:155]
    buffer_load_dwordx4 v6, s[8:11], s21 offen lds
    v_mfma_f32_16x16x32_bf16 v[156:159], a[232:235], v[16:19], v[156:159]
    s_waitcnt lgkmcnt(1)
    v_exp_f32 v84, v84
    v_mfma_f32_16x16x32_bf16 v[52:55], a[212:215], a[96:99], 0
    v_mfma_f32_16x16x32_bf16 v[52:55], a[216:219], a[100:103], v[52:55]
    s_waitcnt lgkmcnt(0)
    v_exp_f32 v57, v57
    v_mfma_f32_16x16x32_bf16 v[52:55], a[220:223], a[104:107], v[52:55]
    ds_read_b128 a[232:235], v1 offset:14336
    v_cvt_pk_bf16_f32 v38, v84, v85
    v_mfma_f32_16x16x32_bf16 v[60:63], a[220:223], a[128:131], 0
    ds_read_b128 a[224:227], v1 offset:13312
    v_fma_f32 v81, v81, s28, v12
    v_mfma_f32_16x16x32_bf16 v[60:63], a[216:219], a[124:127], v[60:63]
    v_exp_f32 v75, v75
    v_mfma_f32_16x16x32_bf16 v[60:63], a[212:215], a[120:123], v[60:63]
    ds_read_b128 a[228:231], v0 offset:14336
    v_mfma_f32_16x16x32_bf16 v[68:71], a[212:215], a[144:147], 0
    s_add_u32 s21, s21, 12032
    v_exp_f32 v58, v58
    v_mfma_f32_16x16x32_bf16 v[68:71], a[216:219], a[148:151], v[68:71]
    v_exp_f32 v90, v90
    v_mfma_f32_16x16x32_bf16 v[68:71], a[220:223], a[152:155], v[68:71]
    buffer_store_dwordx4 v[96:99], v102, s[16:19], s24 offen offset:0 nt
    v_cvt_pk_bf16_f32 v39, v86, v87
    v_exp_f32 v59, v59
    v_mfma_f32_16x16x32_bf16 v[76:79], a[220:223], a[176:179], 0
    v_mfma_f32_16x16x32_bf16 v[76:79], a[216:219], a[172:175], v[76:79]
    s_add_u32 m0, s23, 0
    v_exp_f32 v72, v72
    v_mfma_f32_16x16x32_bf16 v[76:79], a[212:215], a[168:171], v[76:79]
    v_exp_f32 v64, v64
    v_mfma_f32_16x16x32_bf16 v[84:87], a[212:215], a[192:195], 0
    v_exp_f32 v89, v89
    v_mfma_f32_16x16x32_bf16 v[84:87], a[216:219], a[196:199], v[84:87]
    v_exp_f32 v81, v81
    v_mfma_f32_16x16x32_bf16 v[84:87], a[220:223], a[200:203], v[84:87]
    s_waitcnt lgkmcnt(0)
    ds_read_b128 a[212:215], v0 offset:18432
    v_mfma_f32_16x16x32_bf16 v[84:87], a[224:227], a[204:207], v[84:87]
    v_exp_f32 v65, v65
    v_mfma_f32_16x16x32_bf16 v[84:87], a[228:231], a[208:211], v[84:87]
    buffer_load_dwordx4 v6, s[12:15], s25 offen nt lds
    v_mfma_f32_16x16x32_bf16 v[84:87], a[232:235], v[92:95], v[84:87]
    ds_read_b128 v[96:99], v8 offset:1024
    v_cvt_pk_bf16_f32 v16, v56, v57
    v_mfma_f32_16x16x32_bf16 v[76:79], a[232:235], a[188:191], v[76:79]
    v_exp_f32 v66, v66
    v_mfma_f32_16x16x32_bf16 v[76:79], a[228:231], a[184:187], v[76:79]
    v_cvt_pk_bf16_f32 v41, v90, v91
    v_cvt_pk_bf16_f32 v29, v74, v75
    v_mfma_f32_16x16x32_bf16 v[76:79], a[224:227], a[180:183], v[76:79]
    v_cvt_pk_bf16_f32 v34, v80, v81
    v_cvt_pk_bf16_f32 v17, v58, v59
    v_mfma_f32_16x16x32_bf16 v[68:71], a[224:227], a[156:159], v[68:71]
    ds_read_b128 a[220:223], v0 offset:19456
    v_mfma_f32_16x16x32_bf16 v[68:71], a[228:231], a[160:163], v[68:71]
    v_cvt_pk_bf16_f32 v22, v64, v65
    v_mfma_f32_16x16x32_bf16 v[68:71], a[232:235], a[164:167], v[68:71]
    v_cvt_pk_bf16_f32 v40, v88, v89
    v_mfma_f32_16x16x32_bf16 v[44:47], a[236:239], v[14:17], v[48:51]
    ds_read_b128 a[216:219], v1 offset:18432
    v_cvt_pk_bf16_f32 v28, v72, v73
    v_mfma_f32_16x16x32_bf16 v[60:63], a[232:235], a[140:143], v[60:63]
    v_exp_f32 v83, v83
    v_mfma_f32_16x16x32_bf16 v[60:63], a[228:231], a[136:139], v[60:63]
    v_exp_f32 v82, v82
    v_mfma_f32_16x16x32_bf16 v[60:63], a[224:227], a[132:135], v[60:63]
    v_cvt_pk_bf16_f32 v23, v66, v67
    v_mfma_f32_16x16x32_bf16 v[52:55], a[224:227], a[108:111], v[52:55]
    v_mfma_f32_16x16x32_bf16 v[52:55], a[228:231], a[112:115], v[52:55]
    v_cvt_pk_bf16_f32 v35, v82, v83
    v_mfma_f32_16x16x32_bf16 v[52:55], a[232:235], a[116:119], v[52:55]
    s_add_u32 m0, s23, 1024
    ds_read_b128 a[232:235], v1 offset:20480
    v_mfma_f32_16x16x32_bf16 v[44:47], a[240:243], v[20:23], v[44:47]
    ds_read_b128 a[228:231], v0 offset:20480
    v_mfma_f32_16x16x32_bf16 v[44:47], a[244:247], v[26:29], v[44:47]
    s_waitcnt lgkmcnt(3)
    ds_read_b128 a[224:227], v1 offset:19456
    v_mfma_f32_16x16x32_bf16 v[56:59], a[212:215], a[96:99], 0
    v_mfma_f32_16x16x32_bf16 v[44:47], a[248:251], v[32:35], v[44:47]
    buffer_load_dwordx4 v7, s[12:15], s25 offen nt lds
    v_mfma_f32_16x16x32_bf16 v[44:47], a[252:255], v[38:41], v[44:47]
    s_bitcmp1_b32 s27, 0
    s_cselect_b32 s26, s49, 128
    s_waitcnt lgkmcnt(3)
    v_mfma_f32_16x16x32_bf16 v[56:59], a[216:219], a[100:103], v[56:59]
    v_mfma_f32_16x16x32_bf16 v[56:59], a[220:223], a[104:107], v[56:59]
    s_lshr_b32 s27, s27, 1
    v_mfma_f32_16x16x32_bf16 v[64:67], a[220:223], a[128:131], 0
    s_nop 0
    v_cmp_lt_f32 vcc, s29, v44
    v_mfma_f32_16x16x32_bf16 v[64:67], a[216:219], a[124:127], v[64:67]
    buffer_store_dwordx4 v[96:99], v103, s[16:19], s24 offen offset:0 nt
    s_add_u32 s24, s24, s26
    s_add_u32 s25, s25, s26
    s_nop 0
    s_cbranch_vccnz L_rs_loop5w0a
L_ret_loop5w0a:
    v_mfma_f32_16x16x32_bf16 v[64:67], a[212:215], a[120:123], v[64:67]
    v_fma_f32 v61, v61, s28, v10
    s_waitcnt vmcnt(14) lgkmcnt(0)
    v_mfma_f32_16x16x32_bf16 v[72:75], a[212:215], a[144:147], 0
    s_barrier
    v_mfma_f32_16x16x32_bf16 v[72:75], a[216:219], a[148:151], v[72:75]
    s_add_u32 m0, s22, 12288
    v_fma_f32 v52, v52, s28, v9
    v_fma_f32 v63, v63, s28, v10
    v_mfma_f32_16x16x32_bf16 v[72:75], a[220:223], a[152:155], v[72:75]
    buffer_load_dwordx4 v6, s[4:7], s20 offen lds
    v_mfma_f32_16x16x32_bf16 v[80:83], a[220:223], a[176:179], 0
    s_add_u32 s20, s20, 128
    v_fma_f32 v62, v62, s28, v10
    v_fma_f32 v60, v60, s28, v10
    v_mfma_f32_16x16x32_bf16 v[80:83], a[216:219], a[172:175], v[80:83]
    s_add_u32 m0, s22, 13312
    v_exp_f32 v60, v60
    v_mfma_f32_16x16x32_bf16 v[80:83], a[212:215], a[168:171], v[80:83]
    buffer_load_dwordx4 v6, s[4:7], s20 offen lds
    v_mfma_f32_16x16x32_bf16 v[88:91], a[212:215], a[192:195], 0
    s_add_u32 s20, s20, 128
    ds_read_b64_tr_b16 a[212:213], v2 offset:0
    v_fma_f32 v55, v55, s28, v9
    v_mfma_f32_16x16x32_bf16 v[88:91], a[216:219], a[196:199], v[88:91]
    s_add_u32 m0, s22, 14336
    v_exp_f32 v52, v52
    v_mfma_f32_16x16x32_bf16 v[88:91], a[220:223], a[200:203], v[88:91]
    ds_read_b64_tr_b16 a[214:215], v2 offset:6144
    v_mfma_f32_16x16x32_bf16 v[88:91], a[224:227], a[204:207], v[88:91]
    buffer_load_dwordx4 v6, s[4:7], s20 offen lds
    v_mfma_f32_16x16x32_bf16 v[88:91], a[228:231], a[208:211], v[88:91]
    v_exp_f32 v62, v62
    v_mfma_f32_16x16x32_bf16 v[88:91], a[232:235], v[92:95], v[88:91]
    v_exp_f32 v55, v55
    v_mfma_f32_16x16x32_bf16 v[80:83], a[232:235], a[188:191], v[80:83]
    v_exp_f32 v61, v61
    v_mfma_f32_16x16x32_bf16 v[80:83], a[228:231], a[184:187], v[80:83]
    ds_read_b64_tr_b16 a[216:217], v3 offset:0
    v_fma_f32 v53, v53, s28, v9
    v_mfma_f32_16x16x32_bf16 v[80:83], a[224:227], a[180:183], v[80:83]
    s_add_u32 s20, s20, 12032
    ds_read_b64_tr_b16 a[218:219], v3 offset:6144
    v_fma_f32 v54, v54, s28, v9
    v_mfma_f32_16x16x32_bf16 v[72:75], a[224:227], a[156:159], v[72:75]
    v_exp_f32 v54, v54
    v_mfma_f32_16x16x32_bf16 v[72:75], a[228:231], a[160:163], v[72:75]
    ds_read_b64_tr_b16 a[220:221], v4 offset:0
    v_mfma_f32_16x16x32_bf16 v[72:75], a[232:235], a[164:167], v[72:75]
    v_exp_f32 v53, v53
    v_mfma_f32_16x16x32_bf16 v[64:67], a[232:235], a[140:143], v[64:67]
    v_exp_f32 v63, v63
    v_mfma_f32_16x16x32_bf16 v[64:67], a[228:231], a[136:139], v[64:67]
    v_cvt_pk_bf16_f32 v24, v60, v61
    v_mfma_f32_16x16x32_bf16 v[64:67], a[224:227], a[132:135], v[64:67]
    v_cvt_pk_bf16_f32 v19, v54, v55
    v_mfma_f32_16x16x32_bf16 v[56:59], a[224:227], a[108:111], v[56:59]
    ds_read_b64_tr_b16 a[222:223], v4 offset:6144
    v_cvt_pk_bf16_f32 v25, v62, v63
    v_mfma_f32_16x16x32_bf16 v[56:59], a[228:231], a[112:115], v[56:59]
    ds_read_b64_tr_b16 a[224:225], v5 offset:0
    v_cvt_pk_bf16_f32 v18, v52, v53
    v_mfma_f32_16x16x32_bf16 v[56:59], a[232:235], a[116:119], v[56:59]
    ds_read_b64_tr_b16 a[226:227], v5 offset:6144
    s_waitcnt lgkmcnt(4)
    v_mfma_f32_16x16x32_bf16 v[112:115], a[212:215], v[14:17], v[112:115]
    v_fma_f32 v80, v80, s28, v12
    v_mfma_f32_16x16x32_bf16 v[116:119], a[216:219], v[14:17], v[116:119]
    v_fma_f32 v71, v71, s28, v11
    v_fma_f32 v79, v79, s28, v12
    v_mfma_f32_16x16x32_bf16 v[164:167], a[216:219], v[20:23], v[164:167]
    ds_read_b64_tr_b16 a[228:229], v2 offset:1024
    v_mfma_f32_16x16x32_bf16 v[160:163], a[212:215], v[20:23], v[160:163]
    s_add_u32 s39, s39, 12288
    ds_read_b64_tr_b16 a[230:231], v2 offset:7168
    v_mfma_f32_16x16x32_bf16 v[208:211], a[212:215], v[26:29], v[208:211]
    ds_read_b64_tr_b16 a[232:233], v3 offset:1024
    v_mfma_f32_16x16x32_bf16 v[212:215], a[216:219], v[26:29], v[212:215]
    v_fma_f32 v76, v76, s28, v12
    v_fma_f32 v81, v81, s28, v12
    v_mfma_f32_16x16x32_bf16 a[4:7], a[216:219], v[32:35], a[4:7]
    ds_read_b64_tr_b16 a[234:235], v3 offset:7168
    v_fma_f32 v56, v56, s28, v9
    v_mfma_f32_16x16x32_bf16 a[0:3], a[212:215], v[32:35], a[0:3]
    v_exp_f32 v79, v79
    v_mfma_f32_16x16x32_bf16 a[48:51], a[212:215], v[38:41], a[48:51]
    v_fma_f32 v70, v70, s28, v11
    v_fma_f32 v86, v86, s28, v13
    v_mfma_f32_16x16x32_bf16 a[52:55], a[216:219], v[38:41], a[52:55]
    s_waitcnt lgkmcnt(4)
    v_exp_f32 v70, v70
    v_mfma_f32_16x16x32_bf16 a[56:59], a[220:223], v[38:41], a[56:59]
    v_fma_f32 v84, v84, s28, v13
    v_fma_f32 v83, v83, s28, v12
    v_mfma_f32_16x16x32_bf16 a[60:63], a[224:227], v[38:41], a[60:63]
    ds_read_b64_tr_b16 a[218:219], v5 offset:7168
    v_fma_f32 v57, v57, s28, v9
    v_mfma_f32_16x16x32_bf16 a[12:15], a[224:227], v[32:35], a[12:15]
    v_exp_f32 v84, v84
    v_mfma_f32_16x16x32_bf16 a[8:11], a[220:223], v[32:35], a[8:11]
    v_fma_f32 v68, v68, s28, v11
    v_fma_f32 v66, v66, s28, v10
    v_mfma_f32_16x16x32_bf16 v[216:219], a[220:223], v[26:29], v[216:219]
    v_exp_f32 v71, v71
    v_mfma_f32_16x16x32_bf16 v[220:223], a[224:227], v[26:29], v[220:223]
    ds_read_b64_tr_b16 a[212:213], v4 offset:1024
    v_fma_f32 v89, v89, s28, v13
    v_mfma_f32_16x16x32_bf16 v[172:175], a[224:227], v[20:23], v[172:175]
    v_fma_f32 v90, v90, s28, v13
    v_mfma_f32_16x16x32_bf16 v[168:171], a[220:223], v[20:23], v[168:171]
    ds_read_b64_tr_b16 a[216:217], v5 offset:1024
    v_fma_f32 v78, v78, s28, v12
    v_mfma_f32_16x16x32_bf16 v[120:123], a[220:223], v[14:17], v[120:123]
    ds_read_b64_tr_b16 a[214:215], v4 offset:7168
    v_fma_f32 v82, v82, s28, v12
    v_mfma_f32_16x16x32_bf16 v[124:127], a[224:227], v[14:17], v[124:127]
    s_waitcnt lgkmcnt(4)
    v_exp_f32 v68, v68
    v_mfma_f32_16x16x32_bf16 v[128:131], a[228:231], v[14:17], v[128:131]
    v_exp_f32 v83, v83
    v_mfma_f32_16x16x32_bf16 v[132:135], a[232:235], v[14:17], v[132:135]
    ds_read_b64_tr_b16 a[222:223], v2 offset:8192
    v_fma_f32 v73, v73, s28, v11
    v_mfma_f32_16x16x32_bf16 v[180:183], a[232:235], v[20:23], v[180:183]
    v_exp_f32 v86, v86
    v_mfma_f32_16x16x32_bf16 v[176:179], a[228:231], v[20:23], v[176:179]
    ds_read_b64_tr_b16 a[224:225], v3 offset:2048
    v_mfma_f32_16x16x32_bf16 v[224:227], a[228:231], v[26:29], v[224:227]
    ds_read_b64_tr_b16 a[220:221], v2 offset:2048
    v_fma_f32 v85, v85, s28, v13
    v_mfma_f32_16x16x32_bf16 v[228:231], a[232:235], v[26:29], v[228:231]
    v_exp_f32 v81, v81
    v_mfma_f32_16x16x32_bf16 a[20:23], a[232:235], v[32:35], a[20:23]
    ds_read_b64_tr_b16 a[226:227], v3 offset:8192
    v_fma_f32 v67, v67, s28, v10
    v_mfma_f32_16x16x32_bf16 a[16:19], a[228:231], v[32:35], a[16:19]
    v_fma_f32 v59, v59, s28, v9
    v_mfma_f32_16x16x32_bf16 a[64:67], a[228:231], v[38:41], a[64:67]
    v_fma_f32 v64, v64, s28, v10
    v_fma_f32 v74, v74, s28, v11
    v_mfma_f32_16x16x32_bf16 a[68:71], a[232:235], v[38:41], a[68:71]
    s_waitcnt lgkmcnt(4)
    ds_read_b64_tr_b16 a[232:233], v5 offset:2048
    v_mfma_f32_16x16x32_bf16 a[72:75], a[212:215], v[38:41], a[72:75]
    ds_read_b64_tr_b16 a[228:229], v4 offset:2048
    v_mfma_f32_16x16x32_bf16 a[76:79], a[216:219], v[38:41], a[76:79]
    ds_read_b64_tr_b16 a[230:231], v4 offset:8192
    v_fma_f32 v69, v69, s28, v11
    v_mfma_f32_16x16x32_bf16 a[28:31], a[216:219], v[32:35], a[28:31]
    ds_read_b64_tr_b16 a[234:235], v5 offset:8192
    v_mfma_f32_16x16x32_bf16 a[24:27], a[212:215], v[32:35], a[24:27]
    v_exp_f32 v76, v76
    v_mfma_f32_16x16x32_bf16 v[232:235], a[212:215], v[26:29], v[232:235]
    v_exp_f32 v90, v90
    v_mfma_f32_16x16x32_bf16 v[236:239], a[216:219], v[26:29], v[236:239]
    v_exp_f32 v82, v82
    v_mfma_f32_16x16x32_bf16 v[188:191], a[216:219], v[20:23], v[188:191]
    v_fma_f32 v91, v91, s28, v13
    v_mfma_f32_16x16x32_bf16 v[184:187], a[212:215], v[20:23], v[184:187]
    v_fma_f32 v77, v77, s28, v12
    v_fma_f32 v87, v87, s28, v13
    v_mfma_f32_16x16x32_bf16 v[136:139], a[212:215], v[14:17], v[136:139]
    v_exp_f32 v67, v67
    v_mfma_f32_16x16x32_bf16 v[140:143], a[216:219], v[14:17], v[140:143]
    s_waitcnt lgkmcnt(3)
    v_exp_f32 v78, v78
    v_mfma_f32_16x16x32_bf16 v[144:147], a[220:223], v[14:17], v[144:147]
    v_exp_f32 v77, v77
    v_mfma_f32_16x16x32_bf16 v[148:151], a[224:227], v[14:17], v[148:151]
    v_exp_f32 v80, v80
    v_mfma_f32_16x16x32_bf16 v[196:199], a[224:227], v[20:23], v[196:199]
    v_exp_f32 v87, v87
    v_mfma_f32_16x16x32_bf16 v[192:195], a[220:223], v[20:23], v[192:195]
    s_waitcnt vmcnt(10) lgkmcnt(0)
    v_fma_f32 v65, v65, s28, v10
    v_fma_f32 v58, v58, s28, v9
    v_mfma_f32_16x16x32_bf16 v[240:243], a[220:223], v[26:29], v[240:243]
    v_exp_f32 v64, v64
    v_mfma_f32_16x16x32_bf16 v[244:247], a[224:227], v[26:29], v[244:247]
    s_add_u32 m0, s22, 24576
    ds_read_b128 v[96:99], v8 offset:2048
    v_mfma_f32_16x16x32_bf16 a[36:39], a[224:227], v[32:35], a[36:39]
    v_cvt_pk_bf16_f32 v37, v78, v79
    v_fma_f32 v75, v75, s28, v11
    v_mfma_f32_16x16x32_bf16 a[32:35], a[220:223], v[32:35], a[32:35]
    s_barrier
    v_mfma_f32_16x16x32_bf16 a[80:83], a[220:223], v[38:41], a[80:83]
    buffer_load_dwordx4 v6, s[8:11], s21 offen lds
    v_mfma_f32_16x16x32_bf16 a[84:87], a[224:227], v[38:41], a[84:87]
    s_add_u32 s21, s21, 128
    ds_read_b128 a[212:215], v0 offset:0
    v_mfma_f32_16x16x32_bf16 a[88:91], a[228:231], v[38:41], a[88:91]
    ds_read_b128 a[216:219], v1 offset:0
    v_mfma_f32_16x16x32_bf16 a[92:95], a[232:235], v[38:41], a[92:95]
    ds_read_b128 a[220:223], v0 offset:1024
    v_mfma_f32_16x16x32_bf16 a[44:47], a[232:235], v[32:35], a[44:47]
    s_add_u32 m0, s22, 25600
    ds_read_b128 a[224:227], v1 offset:1024
    v_mfma_f32_16x16x32_bf16 a[40:43], a[228:231], v[32:35], a[40:43]
    buffer_load_dwordx4 v6, s[8:11], s21 offen lds
    v_mfma_f32_16x16x32_bf16 v[248:251], a[228:231], v[26:29], v[248:251]
    v_exp_f32 v73, v73
    v_mfma_f32_16x16x32_bf16 v[252:255], a[232:235], v[26:29], v[252:255]
    s_add_u32 s21, s21, 128
    v_exp_f32 v69, v69
    v_mfma_f32_16x16x32_bf16 v[204:207], a[232:235], v[20:23], v[204:207]
    v_cvt_pk_bf16_f32 v34, v80, v81
    v_cvt_pk_bf16_f32 v31, v70, v71
    v_mfma_f32_16x16x32_bf16 v[200:203], a[228:231], v[20:23], v[200:203]
    s_add_u32 m0, s22, 26624
    v_exp_f32 v58, v58
    v_mfma_f32_16x16x32_bf16 v[152:155], a[228:231], v[14:17], v[152:155]
    buffer_load_dwordx4 v6, s[8:11], s21 offen lds
    v_mfma_f32_16x16x32_bf16 v[156:159], a[232:235], v[14:17], v[156:159]
    s_waitcnt lgkmcnt(3)
    ds_read_b128 a[228:231], v0 offset:2048
    v_fma_f32 v88, v88, s28, v13
    v_mfma_f32_16x16x32_bf16 v[52:55], a[212:215], a[96:99], 0
    s_waitcnt lgkmcnt(3)
    ds_read_b128 a[232:235], v1 offset:2048
    v_mfma_f32_16x16x32_bf16 v[52:55], a[216:219], a[100:103], v[52:55]
    s_waitcnt lgkmcnt(3)
    v_mfma_f32_16x16x32_bf16 v[52:55], a[220:223], a[104:107], v[52:55]
    s_add_u32 s21, s21, 12032
    v_cvt_pk_bf16_f32 v30, v68, v69
    v_cvt_pk_bf16_f32 v36, v76, v77
    v_mfma_f32_16x16x32_bf16 v[60:63], a[220:223], a[128:131], 0
    v_exp_f32 v56, v56
    v_mfma_f32_16x16x32_bf16 v[60:63], a[216:219], a[124:127], v[60:63]
    v_exp_f32 v91, v91
    v_mfma_f32_16x16x32_bf16 v[60:63], a[212:215], a[120:123], v[60:63]
    v_fma_f32 v72, v72, s28, v11
    v_mfma_f32_16x16x32_bf16 v[68:71], a[212:215], a[144:147], 0
    v_exp_f32 v85, v85
    v_mfma_f32_16x16x32_bf16 v[68:71], a[216:219], a[148:151], v[68:71]
    v_exp_f32 v59, v59
    v_mfma_f32_16x16x32_bf16 v[68:71], a[220:223], a[152:155], v[68:71]
    buffer_store_dwordx4 v[96:99], v102, s[16:19], s24 offen offset:0 nt
    s_add_u32 m0, s23, 2048
    v_exp_f32 v57, v57
    v_cvt_pk_bf16_f32 v42, v84, v85
    v_mfma_f32_16x16x32_bf16 v[76:79], a[220:223], a[176:179], 0
    v_cvt_pk_bf16_f32 v17, v58, v59
    v_cvt_pk_bf16_f32 v43, v86, v87
    v_mfma_f32_16x16x32_bf16 v[76:79], a[216:219], a[172:175], v[76:79]
    v_exp_f32 v74, v74
    v_mfma_f32_16x16x32_bf16 v[76:79], a[212:215], a[168:171], v[76:79]
    v_exp_f32 v66, v66
    v_mfma_f32_16x16x32_bf16 v[84:87], a[212:215], a[192:195], 0
    v_mfma_f32_16x16x32_bf16 v[84:87], a[216:219], a[196:199], v[84:87]
    v_exp_f32 v65, v65
    v_mfma_f32_16x16x32_bf16 v[84:87], a[220:223], a[200:203], v[84:87]
    s_waitcnt lgkmcnt(0)
    v_exp_f32 v72, v72
    v_mfma_f32_16x16x32_bf16 v[84:87], a[224:227], a[204:207], v[84:87]
    ds_read_b128 a[220:223], v0 offset:7168
    v_cvt_pk_bf16_f32 v41, v90, v91
    v_mfma_f32_16x16x32_bf16 v[84:87], a[228:231], a[208:211], v[84:87]
    v_exp_f32 v75, v75
    v_mfma_f32_16x16x32_bf16 v[84:87], a[232:235], v[92:95], v[84:87]
    v_mfma_f32_16x16x32_bf16 v[76:79], a[232:235], a[188:191], v[76:79]
    buffer_load_dwordx4 v6, s[12:15], s25 offen nt lds
    v_mfma_f32_16x16x32_bf16 v[76:79], a[228:231], a[184:187], v[76:79]
    v_exp_f32 v89, v89
    v_mfma_f32_16x16x32_bf16 v[76:79], a[224:227], a[180:183], v[76:79]
    v_cvt_pk_bf16_f32 v23, v66, v67
    v_mfma_f32_16x16x32_bf16 v[68:71], a[224:227], a[156:159], v[68:71]
    v_exp_f32 v88, v88
    v_mfma_f32_16x16x32_bf16 v[68:71], a[228:231], a[160:163], v[68:71]
    ds_read_b128 v[96:99], v8 offset:3072
    v_mfma_f32_16x16x32_bf16 v[68:71], a[232:235], a[164:167], v[68:71]
    v_cvt_pk_bf16_f32 v40, v88, v89
    v_cvt_pk_bf16_f32 v16, v56, v57
    v_mfma_f32_16x16x32_bf16 v[60:63], a[232:235], a[140:143], v[60:63]
    ds_read_b128 a[216:219], v1 offset:6144
    v_mfma_f32_16x16x32_bf16 v[60:63], a[228:231], a[136:139], v[60:63]
    ds_read_b128 a[212:215], v0 offset:6144
    v_cvt_pk_bf16_f32 v35, v82, v83
    v_mfma_f32_16x16x32_bf16 v[60:63], a[224:227], a[132:135], v[60:63]
    v_mfma_f32_16x16x32_bf16 v[48:51], a[236:239], v[16:19], v[44:47]
    v_cvt_pk_bf16_f32 v22, v64, v65
    v_cvt_pk_bf16_f32 v29, v74, v75
    v_mfma_f32_16x16x32_bf16 v[52:55], a[224:227], a[108:111], v[52:55]
    v_cvt_pk_bf16_f32 v28, v72, v73
    v_mfma_f32_16x16x32_bf16 v[52:55], a[228:231], a[112:115], v[52:55]
    s_add_u32 m0, s23, 3072
    ds_read_b128 a[224:227], v1 offset:7168
    v_mfma_f32_16x16x32_bf16 v[48:51], a[240:243], v[22:25], v[48:51]
    ds_read_b128 a[228:231], v0 offset:8192
    v_mfma_f32_16x16x32_bf16 v[52:55], a[232:235], a[116:119], v[52:55]
    ds_read_b128 a[232:235], v1 offset:8192
    v_mfma_f32_16x16x32_bf16 v[48:51], a[244:247], v[28:31], v[48:51]
    s_waitcnt lgkmcnt(5)
    buffer_load_dwordx4 v7, s[12:15], s25 offen nt lds
    v_mfma_f32_16x16x32_bf16 v[48:51], a[248:251], v[34:37], v[48:51]
    s_bitcmp1_b32 s27, 0
    v_add_u32 v8, 4096, v8
    v_mfma_f32_16x16x32_bf16 v[48:51], a[252:255], v[40:43], v[48:51]
    s_cselect_b32 s26, s49, 128
    s_lshr_b32 s27, s27, 1
    s_waitcnt lgkmcnt(3)
    v_mfma_f32_16x16x32_bf16 v[56:59], a[212:215], a[96:99], 0
    buffer_store_dwordx4 v[96:99], v103, s[16:19], s24 offen offset:0 nt
    s_nop 2
    v_cmp_lt_f32 vcc, s29, v48
    s_add_u32 s24, s24, s26
    v_mfma_f32_16x16x32_bf16 v[56:59], a[216:219], a[100:103], v[56:59]
    s_add_u32 s25, s25, s26
    s_add_u32 s23, s23, 4096
    v_mfma_f32_16x16x32_bf16 v[56:59], a[220:223], a[104:107], v[56:59]
    s_cbranch_vccnz L_rs_loop5w0b
L_ret_loop5w0b:
    v_fma_f32 v54, v54, s28, v9
    v_mfma_f32_16x16x32_bf16 v[64:67], a[220:223], a[128:131], 0
    v_fma_f32 v53, v53, s28, v9
    v_mfma_f32_16x16x32_bf16 v[64:67], a[216:219], a[124:127], v[64:67]
    v_fma_f32 v55, v55, s28, v9
    v_mfma_f32_16x16x32_bf16 v[64:67], a[212:215], a[120:123], v[64:67]
    s_waitcnt vmcnt(14) lgkmcnt(0)
    s_cmp_eq_u32 s30, 5
    s_cselect_b32 s26, s62, 0
    v_mfma_f32_16x16x32_bf16 v[72:75], a[212:215], a[144:147], 0
    s_barrier
    v_mfma_f32_16x16x32_bf16 v[72:75], a[216:219], a[148:151], v[72:75]
    s_add_u32 s20, s20, s26
    s_add_u32 m0, s22, 0
    v_fma_f32 v62, v62, s28, v10
    v_mfma_f32_16x16x32_bf16 v[72:75], a[220:223], a[152:155], v[72:75]
    buffer_load_dwordx4 v6, s[4:7], s20 offen lds
    v_mfma_f32_16x16x32_bf16 v[80:83], a[220:223], a[176:179], 0
    s_add_u32 s20, s20, 128
    v_exp_f32 v62, v62
    v_mfma_f32_16x16x32_bf16 v[80:83], a[216:219], a[172:175], v[80:83]
    s_add_u32 m0, s22, 1024
    v_exp_f32 v54, v54
    v_mfma_f32_16x16x32_bf16 v[80:83], a[212:215], a[168:171], v[80:83]
    buffer_load_dwordx4 v6, s[4:7], s20 offen lds
    v_mfma_f32_16x16x32_bf16 v[88:91], a[212:215], a[192:195], 0
    ds_read_b64_tr_b16 a[212:213], v2 offset:18432
    v_fma_f32 v52, v52, s28, v9
    v_mfma_f32_16x16x32_bf16 v[88:91], a[216:219], a[196:199], v[88:91]
    s_add_u32 s20, s20, 128
    ds_read_b64_tr_b16 a[214:215], v2 offset:12288
    s_add_u32 m0, s22, 2048
    v_mfma_f32_16x16x32_bf16 v[88:91], a[220:223], a[200:203], v[88:91]
    buffer_load_dwordx4 v6, s[4:7], s20 offen lds
    v_mfma_f32_16x16x32_bf16 v[88:91], a[224:227], a[204:207], v[88:91]
    v_exp_f32 v53, v53
    v_mfma_f32_16x16x32_bf16 v[88:91], a[228:231], a[208:211], v[88:91]
    ds_read_b64_tr_b16 a[216:217], v3 offset:18432
    v_fma_f32 v61, v61, s28, v10
    v_mfma_f32_16x16x32_bf16 v[88:91], a[232:235], v[92:95], v[88:91]
    v_exp_f32 v55, v55
    v_mfma_f32_16x16x32_bf16 v[80:83], a[232:235], a[188:191], v[80:83]
    ds_read_b64_tr_b16 a[218:219], v3 offset:12288
    v_fma_f32 v60, v60, s28, v10
    v_mfma_f32_16x16x32_bf16 v[80:83], a[228:231], a[184:187], v[80:83]
    v_exp_f32 v52, v52
    v_mfma_f32_16x16x32_bf16 v[80:83], a[224:227], a[180:183], v[80:83]
    s_add_u32 s20, s20, 12032
    v_fma_f32 v63, v63, s28, v10
    v_mfma_f32_16x16x32_bf16 v[72:75], a[224:227], a[156:159], v[72:75]
    s_add_u32 s30, s30, 1
    v_exp_f32 v60, v60
    v_mfma_f32_16x16x32_bf16 v[72:75], a[228:231], a[160:163], v[72:75]
    ds_read_b64_tr_b16 a[220:221], v4 offset:18432
    v_cvt_pk_bf16_f32 v14, v52, v53
    v_mfma_f32_16x16x32_bf16 v[72:75], a[232:235], a[164:167], v[72:75]
    v_exp_f32 v61, v61
    v_mfma_f32_16x16x32_bf16 v[64:67], a[232:235], a[140:143], v[64:67]
    v_exp_f32 v63, v63
    v_mfma_f32_16x16x32_bf16 v[64:67], a[228:231], a[136:139], v[64:67]
    ds_read_b64_tr_b16 a[222:223], v4 offset:12288
    v_cvt_pk_bf16_f32 v15, v54, v55
    v_mfma_f32_16x16x32_bf16 v[64:67], a[224:227], a[132:135], v[64:67]
    v_cvt_pk_bf16_f32 v21, v62, v63
    v_mfma_f32_16x16x32_bf16 v[56:59], a[224:227], a[108:111], v[56:59]
    ds_read_b64_tr_b16 a[224:225], v5 offset:18432
    v_cvt_pk_bf16_f32 v20, v60, v61
    v_mfma_f32_16x16x32_bf16 v[56:59], a[228:231], a[112:115], v[56:59]
    s_cmp_lt_u32 s30, 6
    ds_read_b64_tr_b16 a[226:227], v5 offset:12288
    v_mfma_f32_16x16x32_bf16 v[56:59], a[232:235], a[116:119], v[56:59]
    s_cbranch_scc1 L_loop5w0
    s_cmp_ge_u32 s37, 6
    s_cbranch_scc1 L_end5
    s_cmp_eq_u32 s32, 0
    s_cbranch_scc1 L_tr54
    s_branch L_tr55
L_tr54:
    s_waitcnt lgkmcnt(4)
    v_mfma_f32_16x16x32_bf16 v[112:115], a[212:215], v[16:19], v[112:115]
    ds_read_b64_tr_b16 a[232:233], v3 offset:19456
    v_fma_f32 v56, v56, s28, v9
    v_mfma_f32_16x16x32_bf16 v[116:119], a[216:219], v[16:19], v[116:119]
    v_fma_f32 v77, v77, s28, v12
    v_mfma_f32_16x16x32_bf16 v[164:167], a[216:219], v[22:25], v[164:167]
    ds_read_b64_tr_b16 a[230:231], v2 offset:13312
    v_fma_f32 v59, v59, s28, v9
    v_mfma_f32_16x16x32_bf16 v[160:163], a[212:215], v[22:25], v[160:163]
    ds_read_b64_tr_b16 a[228:229], v2 offset:19456
    v_fma_f32 v75, v75, s28, v11
    v_mfma_f32_16x16x32_bf16 v[208:211], a[212:215], v[28:31], v[208:211]
    v_exp_f32 v59, v59
    v_mfma_f32_16x16x32_bf16 v[212:215], a[216:219], v[28:31], v[212:215]
    v_fma_f32 v73, v73, s28, v11
    v_fma_f32 v85, v85, s28, v13
    v_mfma_f32_16x16x32_bf16 a[4:7], a[216:219], v[34:37], a[4:7]
    v_fma_f32 v57, v57, s28, v9
    v_fma_f32 v68, v68, s28, v11
    v_mfma_f32_16x16x32_bf16 a[0:3], a[212:215], v[34:37], a[0:3]
    v_exp_f32 v85, v85
    v_mfma_f32_16x16x32_bf16 a[48:51], a[212:215], v[40:43], a[48:51]
    v_fma_f32 v66, v66, s28, v10
    v_fma_f32 v65, v65, s28, v10
    v_mfma_f32_16x16x32_bf16 a[52:55], a[216:219], v[40:43], a[52:55]
    s_waitcnt lgkmcnt(3)
    ds_read_b64_tr_b16 a[212:213], v4 offset:19456
    v_fma_f32 v87, v87, s28, v13
    v_mfma_f32_16x16x32_bf16 a[56:59], a[220:223], v[40:43], a[56:59]
    ds_read_b64_tr_b16 a[234:235], v3 offset:13312
    v_mfma_f32_16x16x32_bf16 a[60:63], a[224:227], v[40:43], a[60:63]
    ds_read_b64_tr_b16 a[218:219], v5 offset:13312
    v_mfma_f32_16x16x32_bf16 a[12:15], a[224:227], v[34:37], a[12:15]
    v_exp_f32 v77, v77
    v_mfma_f32_16x16x32_bf16 a[8:11], a[220:223], v[34:37], a[8:11]
    ds_read_b64_tr_b16 a[216:217], v5 offset:19456
    v_fma_f32 v88, v88, s28, v13
    v_mfma_f32_16x16x32_bf16 v[216:219], a[220:223], v[28:31], v[216:219]
    v_exp_f32 v56, v56
    v_mfma_f32_16x16x32_bf16 v[220:223], a[224:227], v[28:31], v[220:223]
    ds_read_b64_tr_b16 a[214:215], v4 offset:13312
    v_fma_f32 v72, v72, s28, v11
    v_mfma_f32_16x16x32_bf16 v[172:175], a[224:227], v[22:25], v[172:175]
    v_exp_f32 v75, v75
    v_mfma_f32_16x16x32_bf16 v[168:171], a[220:223], v[22:25], v[168:171]
    v_exp_f32 v87, v87
    v_mfma_f32_16x16x32_bf16 v[120:123], a[220:223], v[16:19], v[120:123]
    v_exp_f32 v88, v88
    v_mfma_f32_16x16x32_bf16 v[124:127], a[224:227], v[16:19], v[124:127]
    s_waitcnt lgkmcnt(4)
    v_fma_f32 v86, v86, s28, v13
    v_fma_f32 v58, v58, s28, v9
    v_mfma_f32_16x16x32_bf16 v[128:131], a[228:231], v[16:19], v[128:131]
    s_waitcnt lgkmcnt(3)
    v_fma_f32 v74, v74, s28, v11
    v_mfma_f32_16x16x32_bf16 v[132:135], a[232:235], v[16:19], v[132:135]
    v_fma_f32 v91, v91, s28, v13
    v_fma_f32 v69, v69, s28, v11
    v_mfma_f32_16x16x32_bf16 v[180:183], a[232:235], v[22:25], v[180:183]
    ds_read_b64_tr_b16 a[226:227], v3 offset:14336
    v_fma_f32 v64, v64, s28, v10
    v_mfma_f32_16x16x32_bf16 v[176:179], a[228:231], v[22:25], v[176:179]
    v_exp_f32 v86, v86
    v_mfma_f32_16x16x32_bf16 v[224:227], a[228:231], v[28:31], v[224:227]
    v_fma_f32 v78, v78, s28, v12
    v_fma_f32 v84, v84, s28, v13
    v_mfma_f32_16x16x32_bf16 v[228:231], a[232:235], v[28:31], v[228:231]
    v_mfma_f32_16x16x32_bf16 a[20:23], a[232:235], v[34:37], a[20:23]
    ds_read_b64_tr_b16 a[220:221], v2 offset:20480
    v_fma_f32 v79, v79, s28, v12
    v_mfma_f32_16x16x32_bf16 a[16:19], a[228:231], v[34:37], a[16:19]
    ds_read_b64_tr_b16 a[222:223], v2 offset:14336
    v_fma_f32 v82, v82, s28, v12
    v_mfma_f32_16x16x32_bf16 a[64:67], a[228:231], v[40:43], a[64:67]
    ds_read_b64_tr_b16 a[224:225], v3 offset:20480
    v_mfma_f32_16x16x32_bf16 a[68:71], a[232:235], v[40:43], a[68:71]
    s_waitcnt lgkmcnt(4)
    ds_read_b64_tr_b16 a[234:235], v5 offset:14336
    v_fma_f32 v89, v89, s28, v13
    v_mfma_f32_16x16x32_bf16 a[72:75], a[212:215], v[40:43], a[72:75]
    ds_read_b64_tr_b16 a[228:229], v4 offset:20480
    v_mfma_f32_16x16x32_bf16 a[76:79], a[216:219], v[40:43], a[76:79]
    v_exp_f32 v68, v68
    v_mfma_f32_16x16x32_bf16 a[28:31], a[216:219], v[34:37], a[28:31]
    v_exp_f32 v89, v89
    v_mfma_f32_16x16x32_bf16 a[24:27], a[212:215], v[34:37], a[24:27]
    v_fma_f32 v67, v67, s28, v10
    v_fma_f32 v83, v83, s28, v12
    v_mfma_f32_16x16x32_bf16 v[232:235], a[212:215], v[28:31], v[232:235]
    ds_read_b64_tr_b16 a[232:233], v5 offset:20480
    v_fma_f32 v76, v76, s28, v12
    v_mfma_f32_16x16x32_bf16 v[236:239], a[216:219], v[28:31], v[236:239]
    ds_read_b64_tr_b16 a[230:231], v4 offset:14336
    v_mfma_f32_16x16x32_bf16 v[188:191], a[216:219], v[22:25], v[188:191]
    v_exp_f32 v66, v66
    v_mfma_f32_16x16x32_bf16 v[184:187], a[212:215], v[22:25], v[184:187]
    s_add_u32 s39, s39, 12288
    v_exp_f32 v78, v78
    v_mfma_f32_16x16x32_bf16 v[136:139], a[212:215], v[16:19], v[136:139]
    v_exp_f32 v58, v58
    v_mfma_f32_16x16x32_bf16 v[140:143], a[216:219], v[16:19], v[140:143]
    s_waitcnt lgkmcnt(3)
    v_exp_f32 v64, v64
    v_mfma_f32_16x16x32_bf16 v[144:147], a[220:223], v[16:19], v[144:147]
    v_exp_f32 v76, v76
    v_mfma_f32_16x16x32_bf16 v[148:151], a[224:227], v[16:19], v[148:151]
    v_exp_f32 v73, v73
    v_mfma_f32_16x16x32_bf16 v[196:199], a[224:227], v[22:25], v[196:199]
    v_fma_f32 v70, v70, s28, v11
    v_fma_f32 v80, v80, s28, v12
    v_mfma_f32_16x16x32_bf16 v[192:195], a[220:223], v[22:25], v[192:195]
    v_fma_f32 v71, v71, s28, v11
    v_mfma_f32_16x16x32_bf16 v[240:243], a[220:223], v[28:31], v[240:243]
    v_cvt_pk_bf16_f32 v39, v86, v87
    v_mfma_f32_16x16x32_bf16 v[244:247], a[224:227], v[28:31], v[244:247]
    s_waitcnt vmcnt(10) lgkmcnt(0)
    v_exp_f32 v70, v70
    v_mfma_f32_16x16x32_bf16 a[36:39], a[224:227], v[34:37], a[36:39]
    s_add_u32 m0, s22, 36864
    v_exp_f32 v79, v79
    v_mfma_f32_16x16x32_bf16 a[32:35], a[220:223], v[34:37], a[32:35]
    s_barrier
    v_mfma_f32_16x16x32_bf16 a[80:83], a[220:223], v[40:43], a[80:83]
    ds_read_b128 a[212:215], v0 offset:12288
    v_fma_f32 v81, v81, s28, v12
    v_mfma_f32_16x16x32_bf16 a[84:87], a[224:227], v[40:43], a[84:87]
    v_exp_f32 v71, v71
    v_mfma_f32_16x16x32_bf16 a[88:91], a[228:231], v[40:43], a[88:91]
    ds_read_b128 a[216:219], v1 offset:12288
    v_cvt_pk_bf16_f32 v33, v78, v79
    v_mfma_f32_16x16x32_bf16 a[92:95], a[232:235], v[40:43], a[92:95]
    ds_read_b128 a[220:223], v0 offset:13312
    v_mfma_f32_16x16x32_bf16 a[44:47], a[232:235], v[34:37], a[44:47]
    buffer_load_dwordx4 v6, s[8:11], s21 offen lds
    v_mfma_f32_16x16x32_bf16 a[40:43], a[228:231], v[34:37], a[40:43]
    s_add_u32 s21, s21, 128
    v_cvt_pk_bf16_f32 v27, v70, v71
    s_add_u32 m0, s22, 37888
    v_mfma_f32_16x16x32_bf16 v[248:251], a[228:231], v[28:31], v[248:251]
    buffer_load_dwordx4 v6, s[8:11], s21 offen lds
    v_mfma_f32_16x16x32_bf16 v[252:255], a[232:235], v[28:31], v[252:255]
    v_exp_f32 v82, v82
    v_mfma_f32_16x16x32_bf16 v[204:207], a[232:235], v[22:25], v[204:207]
    s_add_u32 s21, s21, 128
    v_fma_f32 v90, v90, s28, v13
    s_add_u32 m0, s22, 38912
    v_mfma_f32_16x16x32_bf16 v[200:203], a[228:231], v[22:25], v[200:203]
    ds_read_b128 a[224:227], v1 offset:13312
    v_mfma_f32_16x16x32_bf16 v[152:155], a[228:231], v[16:19], v[152:155]
    buffer_load_dwordx4 v6, s[8:11], s21 offen lds
    v_mfma_f32_16x16x32_bf16 v[156:159], a[232:235], v[16:19], v[156:159]
    s_waitcnt lgkmcnt(3)
    ds_read_b128 a[228:231], v0 offset:14336
    v_cvt_pk_bf16_f32 v17, v58, v59
    v_mfma_f32_16x16x32_bf16 v[52:55], a[212:215], a[96:99], 0
    s_waitcnt lgkmcnt(3)
    v_exp_f32 v84, v84
    v_mfma_f32_16x16x32_bf16 v[52:55], a[216:219], a[100:103], v[52:55]
    s_waitcnt lgkmcnt(2)
    v_exp_f32 v74, v74
    v_mfma_f32_16x16x32_bf16 v[52:55], a[220:223], a[104:107], v[52:55]
    v_exp_f32 v83, v83
    v_mfma_f32_16x16x32_bf16 v[60:63], a[220:223], a[128:131], 0
    v_exp_f32 v69, v69
    v_mfma_f32_16x16x32_bf16 v[60:63], a[216:219], a[124:127], v[60:63]
    ds_read_b128 a[232:235], v1 offset:14336
    v_mfma_f32_16x16x32_bf16 v[60:63], a[212:215], a[120:123], v[60:63]
    v_cvt_pk_bf16_f32 v38, v84, v85
    v_cvt_pk_bf16_f32 v26, v68, v69
    v_mfma_f32_16x16x32_bf16 v[68:71], a[212:215], a[144:147], 0
    v_cvt_pk_bf16_f32 v32, v76, v77
    v_mfma_f32_16x16x32_bf16 v[68:71], a[216:219], a[148:151], v[68:71]
    v_mfma_f32_16x16x32_bf16 v[68:71], a[220:223], a[152:155], v[68:71]
    v_mfma_f32_16x16x32_bf16 v[76:79], a[220:223], a[176:179], 0
    v_exp_f32 v57, v57
    v_mfma_f32_16x16x32_bf16 v[76:79], a[216:219], a[172:175], v[76:79]
    v_exp_f32 v81, v81
    v_mfma_f32_16x16x32_bf16 v[76:79], a[212:215], a[168:171], v[76:79]
    v_mfma_f32_16x16x32_bf16 v[84:87], a[212:215], a[192:195], 0
    v_exp_f32 v65, v65
    v_mfma_f32_16x16x32_bf16 v[84:87], a[216:219], a[196:199], v[84:87]
    v_exp_f32 v80, v80
    v_mfma_f32_16x16x32_bf16 v[84:87], a[220:223], a[200:203], v[84:87]
    s_waitcnt lgkmcnt(0)
    v_mfma_f32_16x16x32_bf16 v[84:87], a[224:227], a[204:207], v[84:87]
    v_cvt_pk_bf16_f32 v35, v82, v83
    v_mfma_f32_16x16x32_bf16 v[84:87], a[228:231], a[208:211], v[84:87]
    v_exp_f32 v90, v90
    v_mfma_f32_16x16x32_bf16 v[84:87], a[232:235], v[92:95], v[84:87]
    v_exp_f32 v72, v72
    v_mfma_f32_16x16x32_bf16 v[76:79], a[232:235], a[188:191], v[76:79]
    ds_read_b128 a[220:223], v0 offset:19456
    v_cvt_pk_bf16_f32 v40, v88, v89
    v_mfma_f32_16x16x32_bf16 v[76:79], a[228:231], a[184:187], v[76:79]
    v_exp_f32 v91, v91
    v_mfma_f32_16x16x32_bf16 v[76:79], a[224:227], a[180:183], v[76:79]
    ds_read_b128 a[212:215], v0 offset:18432
    v_cvt_pk_bf16_f32 v34, v80, v81
    v_mfma_f32_16x16x32_bf16 v[68:71], a[224:227], a[156:159], v[68:71]
    v_cvt_pk_bf16_f32 v22, v64, v65
    v_cvt_pk_bf16_f32 v16, v56, v57
    v_mfma_f32_16x16x32_bf16 v[68:71], a[228:231], a[160:163], v[68:71]
    v_mfma_f32_16x16x32_bf16 v[68:71], a[232:235], a[164:167], v[68:71]
    v_exp_f32 v67, v67
    v_mfma_f32_16x16x32_bf16 v[60:63], a[232:235], a[140:143], v[60:63]
    ds_read_b128 a[216:219], v1 offset:18432
    v_mfma_f32_16x16x32_bf16 v[60:63], a[228:231], a[136:139], v[60:63]
    v_mfma_f32_16x16x32_bf16 v[60:63], a[224:227], a[132:135], v[60:63]
    v_cvt_pk_bf16_f32 v23, v66, v67
    v_mfma_f32_16x16x32_bf16 v[52:55], a[224:227], a[108:111], v[52:55]
    v_mfma_f32_16x16x32_bf16 v[52:55], a[228:231], a[112:115], v[52:55]
    ds_read_b128 a[228:231], v0 offset:20480
    v_cvt_pk_bf16_f32 v28, v72, v73
    v_mfma_f32_16x16x32_bf16 v[44:47], a[236:239], v[14:17], v[48:51]
    ds_read_b128 a[224:227], v1 offset:19456
    v_mfma_f32_16x16x32_bf16 v[52:55], a[232:235], a[116:119], v[52:55]
    s_waitcnt lgkmcnt(3)
    ds_read_b128 a[232:235], v1 offset:20480
    v_cvt_pk_bf16_f32 v29, v74, v75
    v_mfma_f32_16x16x32_bf16 v[56:59], a[212:215], a[96:99], 0
    v_mfma_f32_16x16x32_bf16 v[44:47], a[240:243], v[20:23], v[44:47]
    v_cvt_pk_bf16_f32 v41, v90, v91
    v_mfma_f32_16x16x32_bf16 v[44:47], a[244:247], v[26:29], v[44:47]
    v_mfma_f32_16x16x32_bf16 v[44:47], a[248:251], v[32:35], v[44:47]
    v_mfma_f32_16x16x32_bf16 v[44:47], a[252:255], v[38:41], v[44:47]
    s_add_u32 s21, s21, 12032
    s_waitcnt lgkmcnt(3)
    v_mfma_f32_16x16x32_bf16 v[56:59], a[216:219], a[100:103], v[56:59]
    v_mfma_f32_16x16x32_bf16 v[56:59], a[220:223], a[104:107], v[56:59]
    v_mfma_f32_16x16x32_bf16 v[64:67], a[220:223], a[128:131], 0
    v_mfma_f32_16x16x32_bf16 v[64:67], a[216:219], a[124:127], v[64:67]
    s_nop 1
    v_cmp_lt_f32 vcc, s29, v44
    v_mfma_f32_16x16x32_bf16 v[64:67], a[212:215], a[120:123], v[64:67]
    s_waitcnt vmcnt(7) lgkmcnt(0)
    v_mfma_f32_16x16x32_bf16 v[72:75], a[212:215], a[144:147], 0
    s_barrier
    v_mfma_f32_16x16x32_bf16 v[72:75], a[216:219], a[148:151], v[72:75]
    s_cbranch_vccnz L_rs_tr54a
L_ret_tr54a:
    v_fma_f32 v55, v55, s28, v9
    v_mfma_f32_16x16x32_bf16 v[72:75], a[220:223], a[152:155], v[72:75]
    v_fma_f32 v54, v54, s28, v9
    v_fma_f32 v63, v63, s28, v10
    v_mfma_f32_16x16x32_bf16 v[80:83], a[220:223], a[176:179], 0
    s_add_u32 m0, s22, 12288
    v_exp_f32 v55, v55
    v_mfma_f32_16x16x32_bf16 v[80:83], a[216:219], a[172:175], v[80:83]
    v_exp_f32 v54, v54
    v_mfma_f32_16x16x32_bf16 v[80:83], a[212:215], a[168:171], v[80:83]
    buffer_load_dwordx4 v6, s[4:7], s20 offen lds
    v_mfma_f32_16x16x32_bf16 v[88:91], a[212:215], a[192:195], 0
    s_add_u32 s20, s20, 128
    v_fma_f32 v53, v53, s28, v9
    s_add_u32 m0, s22, 13312
    v_mfma_f32_16x16x32_bf16 v[88:91], a[216:219], a[196:199], v[88:91]
    buffer_load_dwordx4 v6, s[4:7], s20 offen lds
    v_mfma_f32_16x16x32_bf16 v[88:91], a[220:223], a[200:203], v[88:91]
    s_add_u32 s20, s20, 128
    ds_read_b64_tr_b16 a[212:213], v2 offset:0
    v_mfma_f32_16x16x32_bf16 v[88:91], a[224:227], a[204:207], v[88:91]
    s_add_u32 m0, s22, 14336
    ds_read_b64_tr_b16 a[214:215], v2 offset:6144
    v_fma_f32 v61, v61, s28, v10
    v_mfma_f32_16x16x32_bf16 v[88:91], a[228:231], a[208:211], v[88:91]
    buffer_load_dwordx4 v6, s[4:7], s20 offen lds
    v_mfma_f32_16x16x32_bf16 v[88:91], a[232:235], v[92:95], v[88:91]
    ds_read_b64_tr_b16 a[216:217], v3 offset:0
    v_fma_f32 v60, v60, s28, v10
    v_mfma_f32_16x16x32_bf16 v[80:83], a[232:235], a[188:191], v[80:83]
    v_exp_f32 v63, v63
    v_mfma_f32_16x16x32_bf16 v[80:83], a[228:231], a[184:187], v[80:83]
    ds_read_b64_tr_b16 a[218:219], v3 offset:6144
    v_fma_f32 v52, v52, s28, v9
    v_mfma_f32_16x16x32_bf16 v[80:83], a[224:227], a[180:183], v[80:83]
    v_exp_f32 v52, v52
    v_mfma_f32_16x16x32_bf16 v[72:75], a[224:227], a[156:159], v[72:75]
    v_exp_f32 v60, v60
    v_mfma_f32_16x16x32_bf16 v[72:75], a[228:231], a[160:163], v[72:75]
    v_exp_f32 v53, v53
    v_mfma_f32_16x16x32_bf16 v[72:75], a[232:235], a[164:167], v[72:75]
    v_cvt_pk_bf16_f32 v19, v54, v55
    v_fma_f32 v62, v62, s28, v10
    v_mfma_f32_16x16x32_bf16 v[64:67], a[232:235], a[140:143], v[64:67]
    s_add_u32 s20, s20, 12032
    v_exp_f32 v62, v62
    v_mfma_f32_16x16x32_bf16 v[64:67], a[228:231], a[136:139], v[64:67]
    v_exp_f32 v61, v61
    v_mfma_f32_16x16x32_bf16 v[64:67], a[224:227], a[132:135], v[64:67]
    ds_read_b64_tr_b16 a[220:221], v4 offset:0
    v_cvt_pk_bf16_f32 v25, v62, v63
    v_mfma_f32_16x16x32_bf16 v[56:59], a[224:227], a[108:111], v[56:59]
    ds_read_b64_tr_b16 a[222:223], v4 offset:6144
    v_cvt_pk_bf16_f32 v24, v60, v61
    v_mfma_f32_16x16x32_bf16 v[56:59], a[228:231], a[112:115], v[56:59]
    ds_read_b64_tr_b16 a[224:225], v5 offset:0
    v_cvt_pk_bf16_f32 v18, v52, v53
    v_mfma_f32_16x16x32_bf16 v[56:59], a[232:235], a[116:119], v[56:59]
    ds_read_b64_tr_b16 a[226:227], v5 offset:6144
    s_waitcnt lgkmcnt(4)
    v_mfma_f32_16x16x32_bf16 v[112:115], a[212:215], v[14:17], v[112:115]
    v_fma_f32 v91, v91, s28, v13
    v_fma_f32 v64, v64, s28, v10
    v_mfma_f32_16x16x32_bf16 v[116:119], a[216:219], v[14:17], v[116:119]
    ds_read_b64_tr_b16 a[228:229], v2 offset:1024
    v_fma_f32 v75, v75, s28, v11
    v_mfma_f32_16x16x32_bf16 v[164:167], a[216:219], v[20:23], v[164:167]
    v_fma_f32 v78, v78, s28, v12
    v_fma_f32 v77, v77, s28, v12
    v_mfma_f32_16x16x32_bf16 v[160:163], a[212:215], v[20:23], v[160:163]
    ds_read_b64_tr_b16 a[232:233], v3 offset:1024
    v_lshrrev_b32 v105, 11, v0
    v_mfma_f32_16x16x32_bf16 v[208:211], a[212:215], v[26:29], v[208:211]
    v_and_b32 v104, 0x3ff, v0
    v_fma_f32 v73, v73, s28, v11
    v_mfma_f32_16x16x32_bf16 v[212:215], a[216:219], v[26:29], v[212:215]
    ds_read_b64_tr_b16 a[230:231], v2 offset:7168
    v_fma_f32 v81, v81, s28, v12
    v_mfma_f32_16x16x32_bf16 a[4:7], a[216:219], v[32:35], a[4:7]
    v_xor_b32 v105, s65, v105
    v_lshl_add_u32 v104, v105, 10, v104
    v_mfma_f32_16x16x32_bf16 a[0:3], a[212:215], v[32:35], a[0:3]
    ds_read_b64_tr_b16 a[234:235], v3 offset:7168
    v_add_u32 v104, s38, v104
    v_mfma_f32_16x16x32_bf16 a[48:51], a[212:215], v[38:41], a[48:51]
    v_exp_f32 v73, v73
    v_mfma_f32_16x16x32_bf16 a[52:55], a[216:219], v[38:41], a[52:55]
    s_waitcnt lgkmcnt(4)
    ds_read_b64_tr_b16 a[212:213], v4 offset:1024
    v_fma_f32 v76, v76, s28, v12
    v_mfma_f32_16x16x32_bf16 a[56:59], a[220:223], v[38:41], a[56:59]
    ds_read_b64_tr_b16 a[218:219], v5 offset:7168
    v_xor_b32 v105, 64, v104
    v_mfma_f32_16x16x32_bf16 a[60:63], a[224:227], v[38:41], a[60:63]
    ds_read_b64_tr_b16 a[216:217], v5 offset:1024
    v_fma_f32 v90, v90, s28, v13
    v_mfma_f32_16x16x32_bf16 a[12:15], a[224:227], v[32:35], a[12:15]
    ds_read_b128 a[152:155], v104 offset:14336
    v_fma_f32 v79, v79, s28, v12
    v_mfma_f32_16x16x32_bf16 a[8:11], a[220:223], v[32:35], a[8:11]
    ds_read_b128 a[140:143], v105 offset:10240
    v_fma_f32 v68, v68, s28, v11
    v_mfma_f32_16x16x32_bf16 v[216:219], a[220:223], v[26:29], v[216:219]
    ds_read_b64_tr_b16 a[214:215], v4 offset:7168
    v_fma_f32 v85, v85, s28, v13
    v_mfma_f32_16x16x32_bf16 v[220:223], a[224:227], v[26:29], v[220:223]
    v_exp_f32 v78, v78
    v_mfma_f32_16x16x32_bf16 v[172:175], a[224:227], v[20:23], v[172:175]
    ds_read_b128 a[180:183], v105 offset:20480
    v_fma_f32 v84, v84, s28, v13
    v_mfma_f32_16x16x32_bf16 v[168:171], a[220:223], v[20:23], v[168:171]
    v_exp_f32 v79, v79
    v_mfma_f32_16x16x32_bf16 v[120:123], a[220:223], v[14:17], v[120:123]
    ds_read_b64_tr_b16 a[222:223], v2 offset:8192
    v_fma_f32 v72, v72, s28, v11
    v_mfma_f32_16x16x32_bf16 v[124:127], a[224:227], v[14:17], v[124:127]
    s_waitcnt lgkmcnt(7)
    v_exp_f32 v77, v77
    v_mfma_f32_16x16x32_bf16 v[128:131], a[228:231], v[14:17], v[128:131]
    ds_read_b128 a[160:163], v104 offset:16384
    v_fma_f32 v69, v69, s28, v11
    v_mfma_f32_16x16x32_bf16 v[132:135], a[232:235], v[14:17], v[132:135]
    ds_read_b64_tr_b16 a[224:225], v3 offset:2048
    v_fma_f32 v89, v89, s28, v13
    v_mfma_f32_16x16x32_bf16 v[180:183], a[232:235], v[20:23], v[180:183]
    v_exp_f32 v68, v68
    v_mfma_f32_16x16x32_bf16 v[176:179], a[228:231], v[20:23], v[176:179]
    ds_read_b128 a[116:119], v105 offset:4096
    v_fma_f32 v59, v59, s28, v9
    v_mfma_f32_16x16x32_bf16 v[224:227], a[228:231], v[26:29], v[224:227]
    ds_read_b64_tr_b16 a[226:227], v3 offset:8192
    v_exp_f32 v64, v64
    v_mfma_f32_16x16x32_bf16 v[228:231], a[232:235], v[26:29], v[228:231]
    ds_read_b128 a[144:147], v104 offset:12288
    v_fma_f32 v66, v66, s28, v10
    v_mfma_f32_16x16x32_bf16 a[20:23], a[232:235], v[32:35], a[20:23]
    ds_read_b64_tr_b16 a[220:221], v2 offset:2048
    v_cvt_pk_bf16_f32 v37, v78, v79
    v_mfma_f32_16x16x32_bf16 a[16:19], a[228:231], v[32:35], a[16:19]
    ds_read_b128 a[128:131], v104 offset:8192
    v_fma_f32 v70, v70, s28, v11
    v_mfma_f32_16x16x32_bf16 a[64:67], a[228:231], v[38:41], a[64:67]
    ds_read_b64_tr_b16 a[230:231], v4 offset:8192
    v_fma_f32 v56, v56, s28, v9
    v_mfma_f32_16x16x32_bf16 a[68:71], a[232:235], v[38:41], a[68:71]
    s_waitcnt lgkmcnt(8)
    ds_read_b64_tr_b16 a[228:229], v4 offset:2048
    v_mfma_f32_16x16x32_bf16 a[72:75], a[212:215], v[38:41], a[72:75]
    ds_read_b128 a[176:179], v104 offset:20480
    v_fma_f32 v57, v57, s28, v9
    v_mfma_f32_16x16x32_bf16 a[76:79], a[216:219], v[38:41], a[76:79]
    ds_read_b64_tr_b16 a[232:233], v5 offset:2048
    v_fma_f32 v67, v67, s28, v10
    v_mfma_f32_16x16x32_bf16 a[28:31], a[216:219], v[32:35], a[28:31]
    v_exp_f32 v69, v69
    v_mfma_f32_16x16x32_bf16 a[24:27], a[212:215], v[32:35], a[24:27]
    v_exp_f32 v76, v76
    v_mfma_f32_16x16x32_bf16 v[232:235], a[212:215], v[26:29], v[232:235]
    ds_read_b64_tr_b16 a[234:235], v5 offset:8192
    v_fma_f32 v83, v83, s28, v12
    v_mfma_f32_16x16x32_bf16 v[236:239], a[216:219], v[26:29], v[236:239]
    v_exp_f32 v70, v70
    v_mfma_f32_16x16x32_bf16 v[188:191], a[216:219], v[20:23], v[188:191]
    ds_read_b128 a[156:159], v105 offset:14336
    v_fma_f32 v71, v71, s28, v11
    v_mfma_f32_16x16x32_bf16 v[184:187], a[212:215], v[20:23], v[184:187]
    v_exp_f32 v81, v81
    v_mfma_f32_16x16x32_bf16 v[136:139], a[212:215], v[14:17], v[136:139]
    ds_read_b128 a[136:139], v104 offset:10240
    s_add_u32 s39, s39, 12288
    v_mfma_f32_16x16x32_bf16 v[140:143], a[216:219], v[14:17], v[140:143]
    s_waitcnt lgkmcnt(5)
    v_exp_f32 v72, v72
    v_mfma_f32_16x16x32_bf16 v[144:147], a[220:223], v[14:17], v[144:147]
    ds_read_b128 a[104:107], v104 offset:2048
    v_fma_f32 v88, v88, s28, v13
    v_mfma_f32_16x16x32_bf16 v[148:151], a[224:227], v[14:17], v[148:151]
    ds_read_b128 a[100:103], v105 offset:0
    v_fma_f32 v82, v82, s28, v12
    v_mfma_f32_16x16x32_bf16 v[196:199], a[224:227], v[20:23], v[196:199]
    ds_read_b128 a[96:99], v104 offset:0
    v_fma_f32 v80, v80, s28, v12
    v_mfma_f32_16x16x32_bf16 v[192:195], a[220:223], v[20:23], v[192:195]
    v_exp_f32 v71, v71
    v_mfma_f32_16x16x32_bf16 v[240:243], a[220:223], v[26:29], v[240:243]
    ds_read_b128 a[168:171], v104 offset:18432
    s_waitcnt vmcnt(6) lgkmcnt(6)
    v_mfma_f32_16x16x32_bf16 v[244:247], a[224:227], v[26:29], v[244:247]
    v_exp_f32 v56, v56
    v_mfma_f32_16x16x32_bf16 a[36:39], a[224:227], v[32:35], a[36:39]
    ds_read_b128 a[184:187], v104 offset:22528
    v_exp_f32 v83, v83
    v_mfma_f32_16x16x32_bf16 a[32:35], a[220:223], v[32:35], a[32:35]
    s_barrier
    ds_read_b128 a[148:151], v105 offset:12288
    v_mfma_f32_16x16x32_bf16 a[80:83], a[220:223], v[38:41], a[80:83]
    s_add_u32 s21, s21, s62
    ds_read_b128 a[212:215], v0 offset:0
    v_cvt_pk_bf16_f32 v30, v68, v69
    v_mfma_f32_16x16x32_bf16 a[84:87], a[224:227], v[38:41], a[84:87]
    ds_read_b128 a[108:111], v105 offset:2048
    v_fma_f32 v74, v74, s28, v11
    v_mfma_f32_16x16x32_bf16 a[88:91], a[228:231], v[38:41], a[88:91]
    ds_read_b128 a[216:219], v1 offset:0
    v_fma_f32 v65, v65, s28, v10
    v_mfma_f32_16x16x32_bf16 a[92:95], a[232:235], v[38:41], a[92:95]
    s_add_u32 m0, s22, 24576
    ds_read_b128 a[220:223], v0 offset:1024
    buffer_load_dwordx4 v6, s[8:11], s21 offen lds
    v_cvt_pk_bf16_f32 v36, v76, v77
    v_mfma_f32_16x16x32_bf16 a[44:47], a[232:235], v[32:35], a[44:47]
    s_add_u32 s21, s21, 128
    ds_read_b128 a[124:127], v105 offset:6144
    v_exp_f32 v82, v82
    v_mfma_f32_16x16x32_bf16 a[40:43], a[228:231], v[32:35], a[40:43]
    s_add_u32 m0, s22, 25600
    ds_read_b128 a[120:123], v104 offset:6144
    v_fma_f32 v58, v58, s28, v9
    v_mfma_f32_16x16x32_bf16 v[248:251], a[228:231], v[26:29], v[248:251]
    buffer_load_dwordx4 v6, s[8:11], s21 offen lds
    v_mfma_f32_16x16x32_bf16 v[252:255], a[232:235], v[26:29], v[252:255]
    s_add_u32 s21, s21, 128
    ds_read_b128 a[172:175], v105 offset:18432
    v_cvt_pk_bf16_f32 v31, v70, v71
    v_mfma_f32_16x16x32_bf16 v[204:207], a[232:235], v[20:23], v[204:207]
    s_add_u32 m0, s22, 26624
    ds_read_b128 a[164:167], v105 offset:16384
    v_fma_f32 v86, v86, s28, v13
    v_mfma_f32_16x16x32_bf16 v[200:203], a[228:231], v[20:23], v[200:203]
    buffer_load_dwordx4 v6, s[8:11], s21 offen lds
    v_mfma_f32_16x16x32_bf16 v[152:155], a[228:231], v[14:17], v[152:155]
    ds_read_b128 a[224:227], v1 offset:1024
    v_mfma_f32_16x16x32_bf16 v[156:159], a[232:235], v[14:17], v[156:159]
    s_waitcnt lgkmcnt(6)
    v_exp_f32 v75, v75
    v_mfma_f32_16x16x32_bf16 v[52:55], a[212:215], a[96:99], 0
    ds_read_b128 a[228:231], v0 offset:2048
    v_cvt_pk_bf16_f32 v35, v82, v83
    v_mfma_f32_16x16x32_bf16 v[52:55], a[216:219], a[100:103], v[52:55]
    s_waitcnt lgkmcnt(6)
    ds_read_b128 a[232:235], v1 offset:2048
    v_exp_f32 v57, v57
    v_mfma_f32_16x16x32_bf16 v[52:55], a[220:223], a[104:107], v[52:55]
    ds_read_b128 a[112:115], v104 offset:4096
    v_cvt_pk_bf16_f32 v16, v56, v57
    v_mfma_f32_16x16x32_bf16 v[60:63], a[220:223], a[128:131], 0
    s_waitcnt lgkmcnt(6)
    ds_read_b128 a[188:191], v105 offset:22528
    v_cvt_pk_bf16_f32 v28, v72, v73
    v_mfma_f32_16x16x32_bf16 v[60:63], a[216:219], a[124:127], v[60:63]
    v_exp_f32 v65, v65
    v_mfma_f32_16x16x32_bf16 v[60:63], a[212:215], a[120:123], v[60:63]
    v_exp_f32 v89, v89
    v_mfma_f32_16x16x32_bf16 v[68:71], a[212:215], a[144:147], 0
    v_exp_f32 v86, v86
    v_mfma_f32_16x16x32_bf16 v[68:71], a[216:219], a[148:151], v[68:71]
    ds_read_b128 a[132:135], v105 offset:8192
    v_cvt_pk_bf16_f32 v22, v64, v65
    v_mfma_f32_16x16x32_bf16 v[68:71], a[220:223], a[152:155], v[68:71]
    v_exp_f32 v84, v84
    v_mfma_f32_16x16x32_bf16 v[76:79], a[220:223], a[176:179], 0
    s_waitcnt lgkmcnt(5)
    v_exp_f32 v90, v90
    v_mfma_f32_16x16x32_bf16 v[76:79], a[216:219], a[172:175], v[76:79]
    v_exp_f32 v58, v58
    v_mfma_f32_16x16x32_bf16 v[76:79], a[212:215], a[168:171], v[76:79]
    v_exp_f32 v74, v74
    v_mfma_f32_16x16x32_bf16 v[76:79], a[224:227], a[180:183], v[76:79]
    s_waitcnt lgkmcnt(2)
    v_exp_f32 v88, v88
    v_mfma_f32_16x16x32_bf16 v[76:79], a[228:231], a[184:187], v[76:79]
    s_waitcnt lgkmcnt(1)
    v_exp_f32 v85, v85
    v_mfma_f32_16x16x32_bf16 v[76:79], a[232:235], a[188:191], v[76:79]
    v_exp_f32 v59, v59
    v_mfma_f32_16x16x32_bf16 v[68:71], a[232:235], a[164:167], v[68:71]
    v_exp_f32 v67, v67
    v_mfma_f32_16x16x32_bf16 v[68:71], a[228:231], a[160:163], v[68:71]
    v_exp_f32 v66, v66
    v_mfma_f32_16x16x32_bf16 v[68:71], a[224:227], a[156:159], v[68:71]
    s_waitcnt lgkmcnt(0)
    ds_read_b128 a[212:215], v0 offset:6144
    v_fma_f32 v87, v87, s28, v13
    v_mfma_f32_16x16x32_bf16 v[60:63], a[224:227], a[132:135], v[60:63]
    ds_read_b128 a[220:223], v0 offset:7168
    v_cvt_pk_bf16_f32 v23, v66, v67
    v_mfma_f32_16x16x32_bf16 v[60:63], a[228:231], a[136:139], v[60:63]
    v_exp_f32 v91, v91
    v_mfma_f32_16x16x32_bf16 v[60:63], a[232:235], a[140:143], v[60:63]
    ds_read_b128 a[216:219], v1 offset:6144
    v_cvt_pk_bf16_f32 v17, v58, v59
    v_mfma_f32_16x16x32_bf16 v[52:55], a[232:235], a[116:119], v[52:55]
    ds_read_b128 a[232:235], v1 offset:8192
    v_cvt_pk_bf16_f32 v29, v74, v75
    v_mfma_f32_16x16x32_bf16 v[52:55], a[228:231], a[112:115], v[52:55]
    ds_read_b128 a[228:231], v0 offset:8192
    v_cvt_pk_bf16_f32 v40, v88, v89
    v_mfma_f32_16x16x32_bf16 v[52:55], a[224:227], a[108:111], v[52:55]
    ds_read_b128 a[224:227], v1 offset:7168
    v_exp_f32 v80, v80
    v_mfma_f32_16x16x32_bf16 v[48:51], a[236:239], v[16:19], v[44:47]
    v_exp_f32 v87, v87
    v_mfma_f32_16x16x32_bf16 v[48:51], a[240:243], v[22:25], v[48:51]
    v_cvt_pk_bf16_f32 v34, v80, v81
    v_cvt_pk_bf16_f32 v43, v86, v87
    v_mfma_f32_16x16x32_bf16 v[48:51], a[244:247], v[28:31], v[48:51]
    v_cvt_pk_bf16_f32 v42, v84, v85
    v_cvt_pk_bf16_f32 v41, v90, v91
    v_mfma_f32_16x16x32_bf16 v[48:51], a[248:251], v[34:37], v[48:51]
    s_nop 0
    v_mfma_f32_16x16x32_bf16 v[48:51], a[252:255], v[40:43], v[48:51]
    s_waitcnt lgkmcnt(4)
    v_mfma_f32_16x16x32_bf16 v[56:59], a[212:215], a[96:99], 0
    s_add_u32 s21, s21, 12032
    s_waitcnt lgkmcnt(3)
    v_mfma_f32_16x16x32_bf16 v[56:59], a[216:219], a[100:103], v[56:59]
    v_mfma_f32_16x16x32_bf16 v[56:59], a[220:223], a[104:107], v[56:59]
    s_nop 1
    v_cmp_lt_f32 vcc, s29, v48
    v_mfma_f32_16x16x32_bf16 v[64:67], a[220:223], a[128:131], 0
    s_waitcnt vmcnt(6) lgkmcnt(0)
    v_mfma_f32_16x16x32_bf16 v[64:67], a[216:219], a[124:127], v[64:67]
    s_barrier
    v_mfma_f32_16x16x32_bf16 v[64:67], a[212:215], a[120:123], v[64:67]
    s_cbranch_vccnz L_rs_tr54b
L_ret_tr54b:
    s_add_u32 m0, s22, 0
    v_mfma_f32_16x16x32_bf16 v[72:75], a[212:215], a[144:147], 0
    buffer_load_dwordx4 v6, s[4:7], s20 offen lds
    v_mfma_f32_16x16x32_bf16 v[72:75], a[216:219], a[148:151], v[72:75]
    v_mfma_f32_16x16x32_bf16 v[72:75], a[220:223], a[152:155], v[72:75]
    s_add_u32 s20, s20, 128
    v_mfma_f32_16x16x32_bf16 v[80:83], a[220:223], a[176:179], 0
    s_add_u32 m0, s22, 1024
    v_mfma_f32_16x16x32_bf16 v[80:83], a[216:219], a[172:175], v[80:83]
    buffer_load_dwordx4 v6, s[4:7], s20 offen lds
    v_mfma_f32_16x16x32_bf16 v[80:83], a[212:215], a[168:171], v[80:83]
    ds_read_b64_tr_b16 a[212:213], v2 offset:18432
    v_mfma_f32_16x16x32_bf16 v[80:83], a[224:227], a[180:183], v[80:83]
    ds_read_b64_tr_b16 a[214:215], v2 offset:12288
    s_add_u32 s20, s20, 128
    v_mfma_f32_16x16x32_bf16 v[80:83], a[228:231], a[184:187], v[80:83]
    ds_read_b64_tr_b16 a[216:217], v3 offset:18432
    s_add_u32 m0, s22, 2048
    v_mfma_f32_16x16x32_bf16 v[80:83], a[232:235], a[188:191], v[80:83]
    ds_read_b64_tr_b16 a[218:219], v3 offset:12288
    v_mfma_f32_16x16x32_bf16 v[72:75], a[232:235], a[164:167], v[72:75]
    buffer_load_dwordx4 v6, s[4:7], s20 offen lds
    v_mfma_f32_16x16x32_bf16 v[72:75], a[228:231], a[160:163], v[72:75]
    v_mfma_f32_16x16x32_bf16 v[72:75], a[224:227], a[156:159], v[72:75]
    v_mfma_f32_16x16x32_bf16 v[64:67], a[224:227], a[132:135], v[64:67]
    v_mfma_f32_16x16x32_bf16 v[64:67], a[228:231], a[136:139], v[64:67]
    ds_read_b64_tr_b16 a[220:221], v4 offset:18432
    v_mfma_f32_16x16x32_bf16 v[64:67], a[232:235], a[140:143], v[64:67]
    ds_read_b64_tr_b16 a[222:223], v4 offset:12288
    s_add_u32 s20, s20, 12032
    v_mfma_f32_16x16x32_bf16 v[56:59], a[232:235], a[116:119], v[56:59]
    v_mfma_f32_16x16x32_bf16 v[56:59], a[228:231], a[112:115], v[56:59]
    v_mfma_f32_16x16x32_bf16 v[56:59], a[224:227], a[108:111], v[56:59]
    ds_read_b64_tr_b16 a[224:225], v5 offset:18432
    ds_read_b64_tr_b16 a[226:227], v5 offset:12288
    v_max3_f32 v96, v52, v53, v54
    v_mbcnt_lo_u32_b32 v104, -1, 0
    s_nop 3
    v_max3_f32 v96, v96, v55, v56
    s_waitcnt lgkmcnt(4)
    v_mfma_f32_16x16x32_bf16 v[112:115], a[212:215], v[16:19], v[112:115]
    v_max3_f32 v96, v96, v57, v58
    v_max_f32 v96, v96, v59
    v_mov_b32 v97, v96
    v_mfma_f32_16x16x32_bf16 v[116:119], a[216:219], v[16:19], v[116:119]
    s_mov_b32 s67, s34
    ds_read_b64_tr_b16 a[230:231], v2 offset:13312
    v_permlane32_swap_b32 v97, v96
    v_mfma_f32_16x16x32_bf16 v[164:167], a[216:219], v[22:25], v[164:167]
    s_add_u32 s18, s34, 30720
    v_max_f32 v96, v96, v97
    v_mov_b32 v97, v96
    v_mfma_f32_16x16x32_bf16 v[160:163], a[212:215], v[22:25], v[160:163]
    s_mov_b32 s34, s33
    ds_read_b64_tr_b16 a[228:229], v2 offset:19456
    v_permlane16_swap_b32 v97, v96
    v_max_f32 v96, v96, v97
    v_mul_f32_e64 v9, -s28, v96
    v_max3_f32 v96, v60, v61, v62
    v_max3_f32 v96, v96, v63, v64
    v_mfma_f32_16x16x32_bf16 v[208:211], a[212:215], v[28:31], v[208:211]
    ds_read_b64_tr_b16 a[232:233], v3 offset:19456
    v_max3_f32 v96, v96, v65, v66
    v_max_f32 v96, v96, v67
    v_mov_b32 v97, v96
    v_mfma_f32_16x16x32_bf16 v[212:215], a[216:219], v[28:31], v[212:215]
    s_nop 0
    v_permlane32_swap_b32 v97, v96
    v_mfma_f32_16x16x32_bf16 a[4:7], a[216:219], v[34:37], a[4:7]
    v_max_f32 v96, v96, v97
    v_mov_b32 v97, v96
    v_mfma_f32_16x16x32_bf16 a[0:3], a[212:215], v[34:37], a[0:3]
    v_fma_f32 v57, v57, s28, v9
    v_permlane16_swap_b32 v97, v96
    v_mfma_f32_16x16x32_bf16 a[48:51], a[212:215], v[40:43], a[48:51]
    s_add_u32 s64, s64, s62
    ds_read_b64_tr_b16 a[214:215], v4 offset:13312
    v_fma_f32 v55, v55, s28, v9
    v_mov_b32 v100, v48
    v_max_f32 v96, v96, v97
    v_mfma_f32_16x16x32_bf16 a[52:55], a[216:219], v[40:43], a[52:55]
    s_waitcnt lgkmcnt(3)
    v_mbcnt_hi_u32_b32 v104, -1, v104
    v_mul_f32_e64 v10, -s28, v96
    v_mfma_f32_16x16x32_bf16 a[56:59], a[220:223], v[40:43], a[56:59]
    ds_read_b64_tr_b16 a[234:235], v3 offset:13312
    v_max3_f32 v96, v68, v69, v70
    v_max3_f32 v96, v96, v71, v72
    v_mfma_f32_16x16x32_bf16 a[60:63], a[224:227], v[40:43], a[60:63]
    s_add_u32 s64, s64, 196608
    v_max3_f32 v96, v96, v73, v74
    v_bfe_u32 v105, v104, 3, 1
    v_mfma_f32_16x16x32_bf16 a[12:15], a[224:227], v[34:37], a[12:15]
    s_mov_b32 s39, s64
    v_max_f32 v96, v96, v75
    v_mov_b32 v97, v96
    v_mfma_f32_16x16x32_bf16 a[8:11], a[220:223], v[34:37], a[8:11]
    s_add_u32 s37, s37, 1
    ds_read_b64_tr_b16 a[212:213], v4 offset:19456
    v_fma_f32 v61, v61, s28, v10
    v_mfma_f32_16x16x32_bf16 v[216:219], a[220:223], v[28:31], v[216:219]
    s_bitcmp1_b32 s63, s37
    ds_read_b64_tr_b16 a[218:219], v5 offset:13312
    v_permlane32_swap_b32 v97, v96
    v_max_f32 v96, v96, v97
    v_mov_b32 v97, v96
    v_mfma_f32_16x16x32_bf16 v[220:223], a[224:227], v[28:31], v[220:223]
    s_cselect_b32 s62, 4294770688, 0
    v_rcp_f32 v49, v49
    v_lshrrev_b32 v106, 5, v104
    v_permlane16_swap_b32 v97, v96
    v_fma_f32 v52, v52, s28, v9
    v_mfma_f32_16x16x32_bf16 v[172:175], a[224:227], v[22:25], v[172:175]
    s_cselect_b32 s42, 0, 325632
    v_fma_f32 v64, v64, s28, v10
    v_and_b32 v107, 3, v104
    v_max_f32 v96, v96, v97
    v_mul_f32 v165, v165, v49
    v_mul_f32_e64 v11, -s28, v96
    v_mfma_f32_16x16x32_bf16 v[168:171], a[220:223], v[22:25], v[168:171]
    ds_read_b64_tr_b16 a[216:217], v5 offset:19456
    v_accvgpr_read_b32 v108, a48
    v_max3_f32 v96, v76, v77, v78
    v_mfma_f32_16x16x32_bf16 v[120:123], a[220:223], v[16:19], v[120:123]
    s_add_u32 s35, s35, s42
    v_fma_f32 v73, v73, s28, v11
    v_mul_f32 v160, v160, v49
    v_mfma_f32_16x16x32_bf16 v[124:127], a[224:227], v[16:19], v[124:127]
    s_waitcnt lgkmcnt(3)
    ds_read_b64_tr_b16 a[220:221], v2 offset:20480
    v_fma_f32 v62, v62, s28, v10
    v_mfma_f32_16x16x32_bf16 v[128:131], a[228:231], v[16:19], v[128:131]
    s_lshl_b32 s42, s37, 1
    v_mul_f32 v162, v162, v49
    v_max3_f32 v96, v96, v79, v80
    v_mfma_f32_16x16x32_bf16 v[132:135], a[232:235], v[16:19], v[132:135]
    s_lshr_b32 s42, s31, s42
    v_max3_f32 v96, v96, v81, v82
    v_xor_b32 v106, v106, v105
    v_mfma_f32_16x16x32_bf16 v[180:183], a[232:235], v[22:25], v[180:183]
    s_and_b32 s42, s42, 3
    ds_read_b64_tr_b16 a[224:225], v3 offset:20480
    v_accvgpr_read_b32 v110, a50
    v_mfma_f32_16x16x32_bf16 v[176:179], a[228:231], v[22:25], v[176:179]
    ds_read_b64_tr_b16 a[222:223], v2 offset:14336
    v_exp_f32 v57, v57
    v_xor_b32 v105, s65, v105
    v_mfma_f32_16x16x32_bf16 v[224:227], a[228:231], v[28:31], v[224:227]
    s_add_u32 s42, s42, s36
    v_max_f32 v96, v96, v83
    v_lshl_or_b32 v106, v107, 1, v106
    v_mov_b32 v97, v96
    v_permlane32_swap_b32 v48, v100
    v_mfma_f32_16x16x32_bf16 v[228:231], a[232:235], v[28:31], v[228:231]
    s_sub_u32 s43, s42, 3
    v_fma_f32 v53, v53, s28, v9
    v_permlane32_swap_b32 v97, v96
    v_mfma_f32_16x16x32_bf16 a[20:23], a[232:235], v[34:37], a[20:23]
    s_cmp_ge_u32 s42, 3
    v_max_f32 v96, v96, v97
    v_exp_f32 v61, v61
    v_fma_f32 v58, v58, s28, v9
    v_lshl_add_u32 v101, v105, 10, s38
    v_mfma_f32_16x16x32_bf16 a[16:19], a[228:231], v[34:37], a[16:19]
    s_cselect_b32 s42, s43, s42
    v_fma_f32 v70, v70, s28, v11
    v_mul_f32 v170, v170, v49
    v_mul_f32 v166, v166, v49
    v_mfma_f32_16x16x32_bf16 a[64:67], a[228:231], v[40:43], a[64:67]
    s_mul_i32 s44, s3, 5
    v_mov_b32 v97, v96
    v_mul_f32 v168, v168, v49
    v_and_b32 v107, 7, v104
    v_fma_f32 v68, v68, s28, v11
    v_mfma_f32_16x16x32_bf16 a[68:71], a[232:235], v[40:43], a[68:71]
    s_waitcnt lgkmcnt(1)
    v_rcp_f32 v51, v51
    v_permlane16_swap_b32 v97, v96
    v_mfma_f32_16x16x32_bf16 a[72:75], a[212:215], v[40:43], a[72:75]
    s_mov_b32 s32, 1
    v_exp_f32 v55, v55
    v_mfma_f32_16x16x32_bf16 a[76:79], a[216:219], v[40:43], a[76:79]
    s_lshl_b32 s43, s3, 2
    ds_read_b64_tr_b16 a[226:227], v3 offset:14336
    v_lshl_add_u32 v101, v106, 4, v101
    v_lshl_add_u32 v101, v107, 7, v101
    v_mfma_f32_16x16x32_bf16 a[28:31], a[216:219], v[34:37], a[28:31]
    s_add_u32 s45, s43, 21
    v_exp_f32 v64, v64
    v_exp_f32 v62, v62
    v_max_f32 v96, v96, v97
    v_mfma_f32_16x16x32_bf16 a[24:27], a[212:215], v[34:37], a[24:27]
    s_cmp_eq_u32 s3, 0
    v_mul_f32 v176, v176, v49
    v_fma_f32 v74, v74, s28, v11
    v_fma_f32 v65, v65, s28, v10
    v_mfma_f32_16x16x32_bf16 v[232:235], a[212:215], v[28:31], v[232:235]
    s_cselect_b32 s45, 20, s45
    v_exp_f32 v58, v58
    v_fma_f32 v71, v71, s28, v11
    v_mfma_f32_16x16x32_bf16 v[236:239], a[216:219], v[28:31], v[236:239]
    s_cselect_b32 s33, 1, 0
    ds_read_b64_tr_b16 a[228:229], v4 offset:20480
    v_fma_f32 v60, v60, s28, v10
    v_mfma_f32_16x16x32_bf16 v[188:191], a[216:219], v[22:25], v[188:191]
    s_cmp_eq_u32 s42, 1
    s_cselect_b32 s44, s45, s44
    v_exp_f32 v52, v52
    v_exp_f32 v70, v70
    v_mfma_f32_16x16x32_bf16 v[184:187], a[212:215], v[22:25], v[184:187]
    s_cselect_b32 s32, s33, s32
    v_exp_f32 v60, v60
    v_mul_f32_e64 v12, -s28, v96
    v_fma_f32 v54, v54, s28, v9
    v_mfma_f32_16x16x32_bf16 v[136:139], a[212:215], v[16:19], v[136:139]
    s_add_u32 s45, s43, 37
    ds_read_b64_tr_b16 a[230:231], v4 offset:14336
    v_fma_f32 v83, v83, s28, v12
    v_mfma_f32_16x16x32_bf16 v[140:143], a[216:219], v[16:19], v[140:143]
    s_waitcnt lgkmcnt(2)
    ds_read_b64_tr_b16 a[232:233], v5 offset:20480
    v_exp_f32 v53, v53
    v_mfma_f32_16x16x32_bf16 v[144:147], a[220:223], v[16:19], v[144:147]
    s_cmp_eq_u32 s42, 2
    v_rcp_f32 v50, v50
    v_mfma_f32_16x16x32_bf16 v[148:151], a[224:227], v[16:19], v[148:151]
    s_cselect_b32 s44, s45, s44
    ds_read_b64_tr_b16 a[234:235], v5 offset:14336
    s_cselect_b32 s32, 0, s32
    v_mul_f32 v187, v187, v49
    v_mfma_f32_16x16x32_bf16 v[196:199], a[224:227], v[22:25], v[196:199]
    s_mul_i32 s44, s44, 6144
    v_exp_f32 v54, v54
    s_add_u32 s33, s35, s44
    v_mfma_f32_16x16x32_bf16 v[192:195], a[220:223], v[22:25], v[192:195]
    s_mul_i32 s42, s32, 6144
    v_fma_f32 v75, v75, s28, v11
    v_mul_f32 v163, v163, v49
    v_mfma_f32_16x16x32_bf16 v[240:243], a[220:223], v[28:31], v[240:243]
    s_add_u32 s42, s42, 24576
    v_fma_f32 v78, v78, s28, v12
    v_exp_f32 v71, v71
    v_mfma_f32_16x16x32_bf16 v[244:247], a[224:227], v[28:31], v[244:247]
    s_add_u32 s42, s42, s33
    s_cmp_ge_u32 s37, 6
    v_cvt_pk_bf16_f32 v14, v52, v53
    v_mfma_f32_16x16x32_bf16 a[36:39], a[224:227], v[34:37], a[36:39]
    s_cselect_b32 s14, 0, s42
    v_fma_f32 v63, v63, s28, v10
    v_mul_f32 v179, v179, v49
    v_mfma_f32_16x16x32_bf16 a[32:35], a[220:223], v[34:37], a[32:35]
    s_add_u32 s24, s67, 6400
    v_fma_f32 v81, v81, s28, v12
    s_add_u32 s25, s33, 6400
    v_mfma_f32_16x16x32_bf16 a[80:83], a[220:223], v[40:43], a[80:83]
    s_add_u32 s23, s38, 10240
    v_rcp_f32 v48, v48
    s_mov_b32 s27, 0x49249249
    v_mul_f32 v190, v190, v49
    v_mfma_f32_16x16x32_bf16 a[84:87], a[224:227], v[40:43], a[84:87]
    s_mov_b32 s30, 0
    v_fma_f32 v77, v77, s28, v12
    v_mul_f32 v191, v191, v49
    s_waitcnt vmcnt(6) lgkmcnt(0)
    v_cvt_pk_bf16_f32 v15, v54, v55
    v_fma_f32 v56, v56, s28, v9
    v_cvt_pk_bf16_f32 v27, v70, v71
    v_mfma_f32_16x16x32_bf16 a[88:91], a[228:231], v[40:43], a[88:91]
    s_barrier
    v_mfma_f32_16x16x32_bf16 a[92:95], a[232:235], v[40:43], a[92:95]
    s_add_u32 m0, s22, 36864
    v_mul_f32 v198, v198, v49
    v_bfe_u32 v107, v104, 4, 1
    v_mfma_f32_16x16x32_bf16 a[44:47], a[232:235], v[34:37], a[44:47]
    ds_read_b128 a[220:223], v0 offset:13312
    v_mul_f32 v161, v161, v49
    v_mfma_f32_16x16x32_bf16 a[40:43], a[228:231], v[34:37], a[40:43]
    ds_read_b128 a[212:215], v0 offset:12288
    v_lshl_add_u32 v101, v107, 3, v101
    v_mfma_f32_16x16x32_bf16 v[248:251], a[228:231], v[28:31], v[248:251]
    ds_read_b128 a[216:219], v1 offset:12288
    v_fma_f32 v79, v79, s28, v12
    v_accvgpr_read_b32 v106, a2
    v_mov_b32 v104, v100
    v_mul_f32 v169, v169, v49
    v_accvgpr_read_b32 v105, a1
    v_accvgpr_read_b32 v111, a51
    v_fma_f32 v76, v76, s28, v12
    v_fma_f32 v69, v69, s28, v11
    v_mfma_f32_16x16x32_bf16 v[252:255], a[232:235], v[28:31], v[252:255]
    v_exp_f32 v63, v63
    v_exp_f32 v68, v68
    v_mfma_f32_16x16x32_bf16 v[204:207], a[232:235], v[22:25], v[204:207]
    ds_read_b128 a[224:227], v1 offset:13312
    v_mul_f32 v180, v180, v49
    v_mul_f32 v174, v174, v49
    v_cvt_pk_bf16_f32 v21, v62, v63
    v_exp_f32 v69, v69
    v_exp_f32 v65, v65
    v_pk_mul_f32 v[228:229], v[228:229], v[50:51] op_sel_hi:[1,0]
    v_pk_mul_f32 v[112:113], v[112:113], v[48:49] op_sel_hi:[1,0]
    v_exp_f32 v56, v56
    v_mul_f32 v192, v192, v49
    v_mfma_f32_16x16x32_bf16 v[200:203], a[228:231], v[22:25], v[200:203]
    v_cvt_pk_bf16_f32 v26, v68, v69
    v_exp_f32 v78, v78
    v_mul_f32 v175, v175, v49
    v_mfma_f32_16x16x32_bf16 v[152:155], a[228:231], v[16:19], v[152:155]
    v_cvt_pk_bf16_f32 v20, v60, v61
    v_accvgpr_read_b32 v107, a3
    v_accvgpr_read_b32 v109, a49
    v_mul_f32 v171, v171, v49
    v_mfma_f32_16x16x32_bf16 v[156:159], a[232:235], v[16:19], v[156:159]
    s_waitcnt lgkmcnt(1)
    v_fma_f32 v72, v72, s28, v11
    v_permlane16_swap_b32 v100, v104
    v_mfma_f32_16x16x32_bf16 v[52:55], a[212:215], a[96:99], 0
    ds_read_b128 a[228:231], v0 offset:14336
    v_cvt_pk_bf16_f32 v16, v56, v57
    v_mul_f32 v164, v164, v49
    v_mfma_f32_16x16x32_bf16 v[52:55], a[216:219], a[100:103], v[52:55]
    buffer_load_dwordx4 v6, s[8:11], s21 offen lds
    v_mfma_f32_16x16x32_bf16 v[52:55], a[220:223], a[104:107], v[52:55]
    s_add_u32 s21, s21, 128
    v_exp_f32 v75, v75
    v_fma_f32 v82, v82, s28, v12
    v_mfma_f32_16x16x32_bf16 v[60:63], a[220:223], a[128:131], 0
    v_mul_f32 v177, v177, v49
    v_exp_f32 v77, v77
    v_exp_f32 v79, v79
    v_mfma_f32_16x16x32_bf16 v[60:63], a[216:219], a[124:127], v[60:63]
    ds_read_b128 a[232:235], v1 offset:14336
    v_mul_f32 v197, v197, v49
    v_mfma_f32_16x16x32_bf16 v[60:63], a[212:215], a[120:123], v[60:63]
    v_exp_f32 v76, v76
    v_mfma_f32_16x16x32_bf16 v[68:71], a[212:215], a[144:147], 0
    v_exp_f32 v73, v73
    v_mfma_f32_16x16x32_bf16 v[68:71], a[216:219], a[148:151], v[68:71]
    s_add_u32 m0, s22, 37888
    v_rcp_f32 v100, v100
    v_fma_f32 v66, v66, s28, v10
    v_mfma_f32_16x16x32_bf16 v[68:71], a[220:223], a[152:155], v[68:71]
    v_exp_f32 v83, v83
    v_mul_f32 v167, v167, v49
    v_exp_f32 v74, v74
    v_cvt_pk_bf16_f32 v32, v76, v77
    v_cvt_pk_bf16_f32 v33, v78, v79
    v_cvt_pk_bf16_f32 v160, v160, v161
    v_mul_f32 v105, v105, v51
    v_pk_mul_f32 v[108:109], v[108:109], v[100:101] op_sel_hi:[1,0]
    v_mul_f32 v173, v173, v49
    v_pk_mul_f32 v[216:217], v[216:217], v[50:51] op_sel_hi:[1,0]
    v_cvt_pk_bf16_f32 v164, v164, v165
    v_accvgpr_read_b32 v104, a0
    v_mfma_f32_16x16x32_bf16 v[76:79], a[220:223], a[176:179], 0
    v_mul_f32 v107, v107, v51
    v_mul_f32 v184, v184, v49
    v_fma_f32 v59, v59, s28, v9
    v_mfma_f32_16x16x32_bf16 v[76:79], a[216:219], a[172:175], v[76:79]
    v_fma_f32 v67, v67, s28, v10
    v_mul_f32 v189, v189, v49
    v_mfma_f32_16x16x32_bf16 v[76:79], a[212:215], a[168:171], v[76:79]
    s_waitcnt lgkmcnt(0)
    ds_read_b128 a[220:223], v0 offset:19456
    v_mul_f32 v178, v178, v49
    v_mfma_f32_16x16x32_bf16 v[76:79], a[224:227], a[180:183], v[76:79]
    buffer_load_dwordx4 v6, s[8:11], s21 offen lds
    v_mfma_f32_16x16x32_bf16 v[76:79], a[228:231], a[184:187], v[76:79]
    v_exp_f32 v72, v72
    v_mfma_f32_16x16x32_bf16 v[76:79], a[232:235], a[188:191], v[76:79]
    ds_read_b128 a[212:215], v0 offset:18432
    v_exp_f32 v82, v82
    v_mfma_f32_16x16x32_bf16 v[68:71], a[232:235], a[164:167], v[68:71]
    v_exp_f32 v66, v66
    v_mfma_f32_16x16x32_bf16 v[68:71], a[228:231], a[160:163], v[68:71]
    s_add_u32 s21, s21, 128
    v_mul_f32 v204, v204, v49
    v_exp_f32 v81, v81
    v_mfma_f32_16x16x32_bf16 v[68:71], a[224:227], a[156:159], v[68:71]
    v_mul_f32 v104, v104, v51
    v_cvt_pk_bf16_f32 v161, v162, v163
    v_mfma_f32_16x16x32_bf16 v[60:63], a[224:227], a[132:135], v[60:63]
    ds_read_b128 a[216:219], v1 offset:18432
    v_fma_f32 v80, v80, s28, v12
    v_mfma_f32_16x16x32_bf16 v[60:63], a[228:231], a[136:139], v[60:63]
    s_add_u32 m0, s22, 38912
    v_exp_f32 v80, v80
    v_mfma_f32_16x16x32_bf16 v[60:63], a[232:235], a[140:143], v[60:63]
    v_exp_f32 v59, v59
    v_mfma_f32_16x16x32_bf16 v[52:55], a[232:235], a[116:119], v[52:55]
    ds_read_b128 a[232:235], v1 offset:20480
    v_cvt_pk_bf16_f32 v29, v74, v75
    v_mfma_f32_16x16x32_bf16 v[52:55], a[228:231], a[112:115], v[52:55]
    buffer_load_dwordx4 v6, s[8:11], s21 offen lds
    v_exp_f32 v67, v67
    v_mul_f32 v183, v183, v49
    v_cvt_pk_bf16_f32 v17, v58, v59
    v_cvt_pk_bf16_f32 v108, v108, v109
    v_pk_mul_f32 v[208:209], v[208:209], v[50:51] op_sel_hi:[1,0]
    v_mul_f32 v199, v199, v49
    v_cvt_pk_bf16_f32 v104, v104, v105
    v_pk_mul_f32 v[114:115], v[114:115], v[48:49] op_sel_hi:[1,0]
    v_pk_mul_f32 v[224:225], v[224:225], v[50:51] op_sel_hi:[1,0]
    v_mul_f32 v172, v172, v49
    v_cvt_pk_bf16_f32 v112, v112, v113
    v_pk_mul_f32 v[220:221], v[220:221], v[50:51] op_sel_hi:[1,0]
    v_mul_f32 v195, v195, v49
    v_pk_mul_f32 v[122:123], v[122:123], v[48:49] op_sel_hi:[1,0]
    v_cvt_pk_bf16_f32 v172, v172, v173
    v_pk_mul_f32 v[130:131], v[130:131], v[48:49] op_sel_hi:[1,0]
    v_cvt_pk_bf16_f32 v228, v228, v229
    v_pk_mul_f32 v[110:111], v[110:111], v[100:101] op_sel_hi:[1,0]
    v_pk_mul_f32 v[218:219], v[218:219], v[50:51] op_sel_hi:[1,0]
    v_pk_mul_f32 v[128:129], v[128:129], v[48:49] op_sel_hi:[1,0]
    v_pk_mul_f32 v[116:117], v[116:117], v[48:49] op_sel_hi:[1,0]
    v_mul_f32 v106, v106, v51
    v_cvt_pk_bf16_f32 v105, v106, v107
    v_pk_mul_f32 v[210:211], v[210:211], v[50:51] op_sel_hi:[1,0]
    v_pk_mul_f32 v[124:125], v[124:125], v[48:49] op_sel_hi:[1,0]
    v_cvt_pk_bf16_f32 v28, v72, v73
    v_mul_f32 v206, v206, v49
    v_cvt_pk_bf16_f32 v113, v114, v115
    v_pk_mul_f32 v[212:213], v[212:213], v[50:51] op_sel_hi:[1,0]
    v_pk_mul_f32 v[214:215], v[214:215], v[50:51] op_sel_hi:[1,0]
    v_pk_mul_f32 v[226:227], v[226:227], v[50:51] op_sel_hi:[1,0]
    v_cvt_pk_bf16_f32 v22, v64, v65
    v_pk_mul_f32 v[140:141], v[140:141], v[48:49] op_sel_hi:[1,0]
    v_cvt_pk_bf16_f32 v208, v208, v209
    v_pk_mul_f32 v[120:121], v[120:121], v[48:49] op_sel_hi:[1,0]
    v_pk_mul_f32 v[118:119], v[118:119], v[48:49] op_sel_hi:[1,0]
    v_accvgpr_read_b32 v107, a7
    v_mul_f32 v181, v181, v49
    v_mfma_f32_16x16x32_bf16 v[52:55], a[224:227], a[108:111], v[52:55]
    s_waitcnt lgkmcnt(0)
    ds_read_b128 a[224:227], v1 offset:19456
    v_mul_f32 v203, v203, v49
    v_cvt_pk_bf16_f32 v124, v124, v125
    v_mfma_f32_16x16x32_bf16 v[56:59], a[212:215], a[96:99], 0
    v_cvt_pk_bf16_f32 v23, v66, v67
    v_cvt_pk_bf16_f32 v209, v210, v211
    v_fma_f32 v63, v63, s28, v10
    v_mfma_f32_16x16x32_bf16 v[56:59], a[216:219], a[100:103], v[56:59]
    ds_write2st64_b64 v101, v[112:113], v[160:161] offset0:0 offset1:12
    v_mfma_f32_16x16x32_bf16 v[56:59], a[220:223], a[104:107], v[56:59]
    ds_read_b128 a[228:231], v0 offset:20480
    v_cvt_pk_bf16_f32 v109, v110, v111
    v_cvt_pk_bf16_f32 v165, v166, v167
    v_mfma_f32_16x16x32_bf16 v[64:67], a[220:223], a[128:131], 0
    v_fma_f32 v71, v71, s28, v11
    v_mul_f32 v188, v188, v49
    v_mul_f32 v185, v185, v49
    v_fma_f32 v68, v68, s28, v11
    v_mfma_f32_16x16x32_bf16 v[64:67], a[216:219], a[124:127], v[64:67]
    ds_write2st64_b64 v101, v[208:209], v[104:105] offset0:24 offset1:36
    v_mfma_f32_16x16x32_bf16 v[64:67], a[212:215], a[120:123], v[64:67]
    ds_write_b64 v101, v[108:109] offset:24576
    v_cvt_pk_bf16_f32 v120, v120, v121
    v_fma_f32 v69, v69, s28, v11
    v_mfma_f32_16x16x32_bf16 v[72:75], a[212:215], a[144:147], 0
    v_accvgpr_read_b32 v111, a55
    v_accvgpr_read_b32 v104, a4
    v_mfma_f32_16x16x32_bf16 v[72:75], a[216:219], a[148:151], v[72:75]
    v_cvt_pk_bf16_f32 v116, v116, v117
    v_xor_b32 v101, 32, v101
    v_cvt_pk_bf16_f32 v34, v80, v81
    v_accvgpr_read_b32 v105, a5
    v_mfma_f32_16x16x32_bf16 v[72:75], a[220:223], a[152:155], v[72:75]
    s_add_u32 s21, s21, 12032
    v_cvt_pk_bf16_f32 v216, v216, v217
    v_cvt_pk_bf16_f32 v35, v82, v83
    v_mfma_f32_16x16x32_bf16 v[80:83], a[220:223], a[176:179], 0
    s_waitcnt vmcnt(6) lgkmcnt(2)
    v_cvt_pk_bf16_f32 v117, v118, v119
    v_mul_f32 v104, v104, v51
    v_fma_f32 v55, v55, s28, v9
    v_mfma_f32_16x16x32_bf16 v[80:83], a[216:219], a[172:175], v[80:83]
    s_barrier
    v_fma_f32 v78, v78, s28, v12
    v_mul_f32 v207, v207, v49
    v_exp_f32 v69, v69
    v_mfma_f32_16x16x32_bf16 v[80:83], a[212:215], a[168:171], v[80:83]
    v_accvgpr_read_b32 v106, a6
    v_cvt_pk_bf16_f32 v212, v212, v213
    v_accvgpr_read_b32 v110, a54
    v_mul_f32 v186, v186, v49
    v_subrev_u32 v8, 28672, v8
    v_mul_f32 v106, v106, v51
    v_mfma_f32_16x16x32_bf16 v[80:83], a[224:227], a[180:183], v[80:83]
    ds_read_b64_tr_b16 a[212:213], v2 offset:0
    v_mul_f32 v105, v105, v51
    v_mfma_f32_16x16x32_bf16 v[80:83], a[228:231], a[184:187], v[80:83]
    v_cvt_pk_bf16_f32 v180, v180, v181
    v_accvgpr_read_b32 v109, a53
    v_cvt_pk_bf16_f32 v213, v214, v215
    v_cvt_pk_bf16_f32 v128, v128, v129
    v_mfma_f32_16x16x32_bf16 v[80:83], a[232:235], a[188:191], v[80:83]
    v_cvt_pk_bf16_f32 v184, v184, v185
    v_cvt_pk_bf16_f32 v104, v104, v105
    v_accvgpr_read_b32 v108, a52
    v_mul_f32 v107, v107, v51
    v_mfma_f32_16x16x32_bf16 v[72:75], a[232:235], a[164:167], v[72:75]
    ds_read_b64_tr_b16 a[214:215], v2 offset:6144
    v_mul_f32 v205, v205, v49
    v_mfma_f32_16x16x32_bf16 v[44:47], a[236:239], v[14:17], 0
    ds_read_b64_tr_b16 a[216:217], v3 offset:0
    v_mul_f32 v194, v194, v49
    v_fma_f32 v81, v81, s28, v12
    v_mfma_f32_16x16x32_bf16 v[72:75], a[228:231], a[160:163], v[72:75]
    v_fma_f32 v62, v62, s28, v10
    v_cvt_pk_bf16_f32 v121, v122, v123
    v_mfma_f32_16x16x32_bf16 v[72:75], a[224:227], a[156:159], v[72:75]
    ds_read_b64_tr_b16 a[218:219], v3 offset:6144
    v_mul_f32 v201, v201, v49
    v_mfma_f32_16x16x32_bf16 v[64:67], a[224:227], a[132:135], v[64:67]
    ds_write2st64_b64 v101, v[116:117], v[164:165] offset0:0 offset1:12
    v_pk_mul_f32 v[108:109], v[108:109], v[100:101] op_sel_hi:[1,0]
    v_fma_f32 v77, v77, s28, v12
    v_cvt_pk_bf16_f32 v108, v108, v109
    v_pk_mul_f32 v[110:111], v[110:111], v[100:101] op_sel_hi:[1,0]
    v_cvt_pk_bf16_f32 v204, v204, v205
    v_cvt_pk_bf16_f32 v173, v174, v175
    v_mfma_f32_16x16x32_bf16 v[64:67], a[228:231], a[136:139], v[64:67]
    s_add_u32 m0, s22, 12288
    ds_read_b64_tr_b16 a[220:221], v4 offset:0
    v_cvt_pk_bf16_f32 v105, v106, v107
    v_mfma_f32_16x16x32_bf16 v[64:67], a[232:235], a[140:143], v[64:67]
    ds_read_b64_tr_b16 a[222:223], v4 offset:6144
    buffer_load_dwordx4 v6, s[4:7], s20 offen lds
    v_mfma_f32_16x16x32_bf16 v[56:59], a[232:235], a[116:119], v[56:59]
    s_add_u32 s20, s20, 128
    ds_write2st64_b64 v101, v[212:213], v[104:105] offset0:24 offset1:36
    v_pk_mul_f32 v[144:145], v[144:145], v[48:49] op_sel_hi:[1,0]
    v_pk_mul_f32 v[126:127], v[126:127], v[48:49] op_sel_hi:[1,0]
    v_pk_mul_f32 v[232:233], v[232:233], v[50:51] op_sel_hi:[1,0]
    v_cvt_pk_bf16_f32 v188, v188, v189
    v_pk_mul_f32 v[146:147], v[146:147], v[48:49] op_sel_hi:[1,0]
    v_pk_mul_f32 v[156:157], v[156:157], v[48:49] op_sel_hi:[1,0]
    v_exp_f32 v68, v68
    v_accvgpr_read_b32 v104, a8
    v_exp_f32 v63, v63
    v_accvgpr_read_b32 v107, a11
    v_pk_mul_f32 v[138:139], v[138:139], v[48:49] op_sel_hi:[1,0]
    v_cvt_pk_bf16_f32 v109, v110, v111
    v_cvt_pk_bf16_f32 v220, v220, v221
    v_fma_f32 v79, v79, s28, v12
    v_cvt_pk_bf16_f32 v156, v156, v157
    v_mfma_f32_16x16x32_bf16 v[56:59], a[228:231], a[112:115], v[56:59]
    s_add_u32 m0, s22, 13312
    v_accvgpr_read_b32 v105, a9
    v_accvgpr_read_b32 v106, a10
    v_accvgpr_read_b32 v110, a58
    v_cvt_pk_bf16_f32 v168, v168, v169
    v_mul_f32 v104, v104, v51
    v_mul_f32 v107, v107, v51
    v_pk_mul_f32 v[230:231], v[230:231], v[50:51] op_sel_hi:[1,0]
    v_accvgpr_read_b32 v111, a59
    v_cvt_pk_bf16_f32 v229, v230, v231
    v_mfma_f32_16x16x32_bf16 v[56:59], a[224:227], a[108:111], v[56:59]
    s_waitcnt lgkmcnt(1)
    ds_read_b64_tr_b16 a[224:225], v5 offset:0
    v_mul_f32 v182, v182, v49
    v_mfma_f32_16x16x32_bf16 v[112:115], a[212:215], v[14:17], 0
    ds_write_b64 v101, v[108:109] offset:24576
    v_cvt_pk_bf16_f32 v217, v218, v219
    v_cvt_pk_bf16_f32 v189, v190, v191
    v_cvt_pk_bf16_f32 v125, v126, v127
    v_mfma_f32_16x16x32_bf16 v[116:119], a[216:219], v[14:17], 0
    buffer_load_dwordx4 v6, s[4:7], s20 offen lds
    ds_read_b64_tr_b16 a[232:233], v3 offset:1024
    v_xor_b32 v101, 96, v101
    v_mul_f32 v106, v106, v51
    v_fma_f32 v66, v66, s28, v10
    v_fma_f32 v72, v72, s28, v11
    v_pk_mul_f32 v[148:149], v[148:149], v[48:49] op_sel_hi:[1,0]
    v_pk_mul_f32 v[236:237], v[236:237], v[50:51] op_sel_hi:[1,0]
    v_cvt_pk_bf16_f32 v224, v224, v225
    v_pk_mul_f32 v[110:111], v[110:111], v[100:101] op_sel_hi:[1,0]
    v_fma_f32 v58, v58, s28, v9
    v_cvt_pk_bf16_f32 v169, v170, v171
    v_fma_f32 v52, v52, s28, v9
    v_mul_f32 v105, v105, v51
    v_fma_f32 v61, v61, s28, v10
    v_exp_f32 v55, v55
    v_mfma_f32_16x16x32_bf16 v[164:167], a[216:219], v[20:23], 0
    ds_read_b64_tr_b16 a[230:231], v2 offset:7168
    v_fma_f32 v75, v75, s28, v11
    v_mfma_f32_16x16x32_bf16 v[44:47], a[240:243], v[20:23], v[44:47]
    ds_read_b64_tr_b16 a[234:235], v3 offset:7168
    v_cvt_pk_bf16_f32 v140, v140, v141
    v_exp_f32 v52, v52
    v_mfma_f32_16x16x32_bf16 v[44:47], a[244:247], v[26:29], v[44:47]
    s_add_u32 s20, s20, 128
    ds_read_b64_tr_b16 a[228:229], v2 offset:1024
    v_accvgpr_read_b32 v108, a56
    v_fma_f32 v60, v60, s28, v10
    v_accvgpr_read_b32 v109, a57
    v_cvt_pk_bf16_f32 v104, v104, v105
    v_cvt_pk_bf16_f32 v181, v182, v183
    v_cvt_pk_bf16_f32 v105, v106, v107
    v_mul_f32 v196, v196, v49
    v_pk_mul_f32 v[222:223], v[222:223], v[50:51] op_sel_hi:[1,0]
    v_pk_mul_f32 v[248:249], v[248:249], v[50:51] op_sel_hi:[1,0]
    v_pk_mul_f32 v[108:109], v[108:109], v[100:101] op_sel_hi:[1,0]
    v_accvgpr_read_b32 v106, a14
    v_pk_mul_f32 v[132:133], v[132:133], v[48:49] op_sel_hi:[1,0]
    v_pk_mul_f32 v[246:247], v[246:247], v[50:51] op_sel_hi:[1,0]
    v_pk_mul_f32 v[154:155], v[154:155], v[48:49] op_sel_hi:[1,0]
    v_pk_mul_f32 v[136:137], v[136:137], v[48:49] op_sel_hi:[1,0]
    v_cvt_pk_bf16_f32 v108, v108, v109
    v_cvt_pk_bf16_f32 v109, v110, v111
    v_cvt_pk_bf16_f32 v144, v144, v145
    v_mfma_f32_16x16x32_bf16 v[160:163], a[212:215], v[20:23], 0
    s_add_u32 m0, s22, 14336
    ds_read_b64_tr_b16 a[226:227], v5 offset:6144
    v_cvt_pk_bf16_f32 v132, v132, v133
    v_mfma_f32_16x16x32_bf16 v[208:211], a[212:215], v[26:29], 0
    buffer_load_dwordx4 v6, s[4:7], s20 offen lds
    ds_write2st64_b64 v101, v[120:121], v[168:169] offset0:0 offset1:12
    v_fma_f32 v83, v83, s28, v12
    v_mfma_f32_16x16x32_bf16 v[212:215], a[216:219], v[26:29], 0
    s_add_u32 s20, s20, 12032
    ds_write2st64_b64 v101, v[216:217], v[104:105] offset0:24 offset1:36
    v_mul_f32 v106, v106, v51
    v_cvt_pk_bf16_f32 v129, v130, v131
    v_fma_f32 v54, v54, s28, v9
    v_mfma_f32_16x16x32_bf16 a[4:7], a[216:219], v[32:35], 0
    s_add_u32 s56, s67, 6144
    ds_write_b64 v101, v[108:109] offset:24576
    v_accvgpr_read_b32 v111, a63
    v_cvt_pk_bf16_f32 v225, v226, v227
    v_accvgpr_read_b32 v110, a62
    v_cvt_pk_bf16_f32 v221, v222, v223
    v_accvgpr_read_b32 v107, a15
    v_pk_mul_f32 v[134:135], v[134:135], v[48:49] op_sel_hi:[1,0]
    v_mul_f32 v202, v202, v49
    v_pk_mul_f32 v[110:111], v[110:111], v[100:101] op_sel_hi:[1,0]
    v_mul_f32 v107, v107, v51
    v_accvgpr_read_b32 v105, a13
    v_mul_f32 v105, v105, v51
    v_accvgpr_read_b32 v109, a61
    v_cvt_pk_bf16_f32 v176, v176, v177
    v_accvgpr_read_b32 v108, a60
    v_pk_mul_f32 v[108:109], v[108:109], v[100:101] op_sel_hi:[1,0]
    v_pk_mul_f32 v[152:153], v[152:153], v[48:49] op_sel_hi:[1,0]
    v_xor_b32 v101, 32, v101
    v_exp_f32 v71, v71
    v_fma_f32 v53, v53, s28, v9
    v_cvt_pk_bf16_f32 v177, v178, v179
    v_mul_f32 v200, v200, v49
    v_exp_f32 v79, v79
    v_accvgpr_read_b32 v104, a12
    v_cvt_pk_bf16_f32 v108, v108, v109
    v_mul_f32 v104, v104, v51
    v_cvt_pk_bf16_f32 v136, v136, v137
    v_fma_f32 v59, v59, s28, v9
    v_cvt_pk_bf16_f32 v104, v104, v105
    v_cvt_pk_bf16_f32 v105, v106, v107
    v_fma_f32 v64, v64, s28, v10
    v_cvt_pk_bf16_f32 v137, v138, v139
    v_cvt_pk_bf16_f32 v109, v110, v111
    v_mfma_f32_16x16x32_bf16 a[0:3], a[212:215], v[32:35], 0
    s_add_u32 s58, s33, 6144
    ds_write2st64_b64 v101, v[124:125], v[172:173] offset0:0 offset1:12
    v_mfma_f32_16x16x32_bf16 a[8:11], a[220:223], v[32:35], 0
    s_waitcnt lgkmcnt(1)
    ds_write2st64_b64 v101, v[220:221], v[104:105] offset0:24 offset1:36
    v_mfma_f32_16x16x32_bf16 a[12:15], a[224:227], v[32:35], 0
    ds_write_b64 v101, v[108:109] offset:24576
    v_accvgpr_read_b32 v111, a67
    v_accvgpr_read_b32 v109, a65
    v_accvgpr_read_b32 v110, a66
    v_pk_mul_f32 v[110:111], v[110:111], v[100:101] op_sel_hi:[1,0]
    v_pk_mul_f32 v[238:239], v[238:239], v[50:51] op_sel_hi:[1,0]
    v_accvgpr_read_b32 v108, a64
    v_pk_mul_f32 v[244:245], v[244:245], v[50:51] op_sel_hi:[1,0]
    v_accvgpr_read_b32 v105, a17
    v_cvt_pk_bf16_f32 v205, v206, v207
    v_accvgpr_read_b32 v104, a16
    v_cvt_pk_bf16_f32 v196, v196, v197
    v_fma_f32 v74, v74, s28, v11
    v_pk_mul_f32 v[250:251], v[250:251], v[50:51] op_sel_hi:[1,0]
    v_pk_mul_f32 v[240:241], v[240:241], v[50:51] op_sel_hi:[1,0]
    v_accvgpr_read_b32 v106, a18
    v_cvt_pk_bf16_f32 v232, v232, v233
    v_pk_mul_f32 v[108:109], v[108:109], v[100:101] op_sel_hi:[1,0]
    v_mul_f32 v105, v105, v51
    v_xor_b32 v101, 96, v101
    v_mul_f32 v104, v104, v51
    v_pk_mul_f32 v[234:235], v[234:235], v[50:51] op_sel_hi:[1,0]
    v_cvt_pk_bf16_f32 v185, v186, v187
    v_cvt_pk_bf16_f32 v108, v108, v109
    v_fma_f32 v80, v80, s28, v12
    v_mfma_f32_16x16x32_bf16 v[44:47], a[248:251], v[32:35], v[44:47]
    ds_write2st64_b64 v101, v[128:129], v[176:177] offset0:4 offset1:16
    v_mfma_f32_16x16x32_bf16 v[220:223], a[224:227], v[26:29], 0
    ds_read_b128 v[96:99], v8 offset:0
    v_accvgpr_read_b32 v107, a19
    v_mul_f32 v107, v107, v51
    v_cvt_pk_bf16_f32 v104, v104, v105
    v_mul_f32 v106, v106, v51
    v_cvt_pk_bf16_f32 v148, v148, v149
    v_cvt_pk_bf16_f32 v105, v106, v107
    v_cvt_pk_bf16_f32 v109, v110, v111
    v_fma_f32 v76, v76, s28, v12
    v_exp_f32 v77, v77
    v_cvt_pk_bf16_f32 v133, v134, v135
    v_mfma_f32_16x16x32_bf16 v[216:219], a[220:223], v[26:29], 0
    ds_read_b64_tr_b16 a[216:217], v5 offset:1024
    ds_write2st64_b64 v101, v[224:225], v[104:105] offset0:28 offset1:40
    v_accvgpr_read_b32 v111, a71
    v_accvgpr_read_b32 v107, a23
    v_mfma_f32_16x16x32_bf16 v[168:171], a[220:223], v[20:23], 0
    ds_read_b128 v[88:91], v8 offset:6144
    ds_read_b64_tr_b16 a[214:215], v4 offset:7168
    v_accvgpr_read_b32 v106, a22
    v_cvt_pk_bf16_f32 v240, v240, v241
    v_mfma_f32_16x16x32_bf16 v[172:175], a[224:227], v[20:23], 0
    ds_read_b128 v[84:87], v8 offset:1024
    v_accvgpr_read_b32 v104, a20
    v_mfma_f32_16x16x32_bf16 v[124:127], a[224:227], v[14:17], 0
    ds_write_b64 v101, v[108:109] offset:26624
    v_accvgpr_read_b32 v105, a21
    v_mul_f32 v104, v104, v51
    v_cvt_pk_bf16_f32 v145, v146, v147
    v_cvt_pk_bf16_f32 v152, v152, v153
    v_accvgpr_read_b32 v108, a68
    v_mul_f32 v106, v106, v51
    v_mul_f32 v105, v105, v51
    v_accvgpr_read_b32 v109, a69
    v_mul_f32 v193, v193, v49
    v_xor_b32 v101, 32, v101
    v_cvt_pk_bf16_f32 v104, v104, v105
    v_fma_f32 v70, v70, s28, v11
    v_cvt_pk_bf16_f32 v244, v244, v245
    v_cvt_pk_bf16_f32 v153, v154, v155
    v_pk_mul_f32 v[108:109], v[108:109], v[100:101] op_sel_hi:[1,0]
    v_accvgpr_read_b32 v110, a70
    v_pk_mul_f32 v[110:111], v[110:111], v[100:101] op_sel_hi:[1,0]
    v_mul_f32 v107, v107, v51
    v_exp_f32 v53, v53
    v_mfma_f32_16x16x32_bf16 v[120:123], a[220:223], v[14:17], 0
    ds_write2st64_b64 v101, v[132:133], v[180:181] offset0:4 offset1:16
    v_cvt_pk_bf16_f32 v105, v106, v107
    v_mfma_f32_16x16x32_bf16 v[128:131], a[228:231], v[14:17], 0
    s_add_u32 m0, s38, 6144
    ds_write2st64_b64 v101, v[228:229], v[104:105] offset0:28 offset1:40
    ds_read_b64_tr_b16 a[218:219], v5 offset:7168
    v_cvt_pk_bf16_f32 v233, v234, v235
    v_exp_f32 v81, v81
    v_pk_mul_f32 v[150:151], v[150:151], v[48:49] op_sel_hi:[1,0]
    v_accvgpr_read_b32 v105, a25
    v_accvgpr_read_b32 v107, a27
    v_cvt_pk_bf16_f32 v108, v108, v109
    v_cvt_pk_bf16_f32 v109, v110, v111
    v_cvt_pk_bf16_f32 v236, v236, v237
    v_mfma_f32_16x16x32_bf16 v[132:135], a[232:235], v[14:17], 0
    ds_write_b64 v101, v[108:109] offset:26624
    v_accvgpr_read_b32 v104, a24
    v_accvgpr_read_b32 v109, a73
    v_accvgpr_read_b32 v108, a72
    v_mul_f32 v104, v104, v51
    v_fma_f32 v65, v65, s28, v10
    v_exp_f32 v76, v76
    v_accvgpr_read_b32 v106, a26
    v_pk_mul_f32 v[142:143], v[142:143], v[48:49] op_sel_hi:[1,0]
    v_pk_mul_f32 v[108:109], v[108:109], v[100:101] op_sel_hi:[1,0]
    v_accvgpr_read_b32 v110, a74
    v_accvgpr_read_b32 v111, a75
    v_cvt_pk_bf16_f32 v18, v52, v53
    v_cvt_pk_bf16_f32 v108, v108, v109
    v_mul_f32 v105, v105, v51
    v_exp_f32 v62, v62
    v_mfma_f32_16x16x32_bf16 v[180:183], a[232:235], v[20:23], 0
    s_waitcnt lgkmcnt(2)
    ds_read_b64_tr_b16 a[212:213], v4 offset:1024
    ds_read_b64_tr_b16 a[222:223], v2 offset:8192
    buffer_load_dwordx4 v6, s[12:15], s58 offen nt lds
    v_cvt_pk_bf16_f32 v141, v142, v143
    v_cvt_pk_bf16_f32 v104, v104, v105
    v_mul_f32 v107, v107, v51
    v_exp_f32 v61, v61
    v_pk_mul_f32 v[158:159], v[158:159], v[48:49] op_sel_hi:[1,0]
    v_pk_mul_f32 v[110:111], v[110:111], v[100:101] op_sel_hi:[1,0]
    v_xor_b32 v101, 96, v101
    v_mul_f32 v106, v106, v51
    v_mfma_f32_16x16x32_bf16 v[176:179], a[228:231], v[20:23], 0
    ds_write2st64_b64 v101, v[136:137], v[184:185] offset0:4 offset1:16
    v_mfma_f32_16x16x32_bf16 v[224:227], a[228:231], v[26:29], 0
    buffer_store_dwordx4 v[96:99], v102, s[16:19], s67 offen offset:0 nt
    s_nop 0
    ds_read_b128 v[96:99], v8 offset:7168
    ds_read_b64_tr_b16 a[226:227], v3 offset:8192
    v_pk_mul_f32 v[252:253], v[252:253], v[50:51] op_sel_hi:[1,0]
    v_cvt_pk_bf16_f32 v105, v106, v107
    v_accvgpr_read_b32 v106, a30
    v_cvt_pk_bf16_f32 v109, v110, v111
    v_mfma_f32_16x16x32_bf16 v[228:231], a[232:235], v[26:29], 0
    s_add_u32 m0, s38, 7168
    ds_write2st64_b64 v101, v[232:233], v[104:105] offset0:28 offset1:40
    v_mfma_f32_16x16x32_bf16 a[20:23], a[232:235], v[32:35], 0
    ds_write_b64 v101, v[108:109] offset:26624
    v_accvgpr_read_b32 v107, a31
    v_accvgpr_read_b32 v104, a28
    v_mul_f32 v104, v104, v51
    v_pk_mul_f32 v[242:243], v[242:243], v[50:51] op_sel_hi:[1,0]
    v_accvgpr_read_b32 v105, a29
    v_mul_f32 v106, v106, v51
    v_xor_b32 v101, 32, v101
    v_cvt_pk_bf16_f32 v237, v238, v239
    v_accvgpr_read_b32 v110, a78
    v_pk_mul_f32 v[254:255], v[254:255], v[50:51] op_sel_hi:[1,0]
    v_mul_f32 v105, v105, v51
    v_accvgpr_read_b32 v108, a76
    v_accvgpr_read_b32 v109, a77
    v_fma_f32 v56, v56, s28, v9
    v_mul_f32 v107, v107, v51
    v_accvgpr_read_b32 v111, a79
    v_cvt_pk_bf16_f32 v104, v104, v105
    v_cvt_pk_bf16_f32 v105, v106, v107
    v_cvt_pk_bf16_f32 v192, v192, v193
    v_cvt_pk_bf16_f32 v193, v194, v195
    v_pk_mul_f32 v[108:109], v[108:109], v[100:101] op_sel_hi:[1,0]
    v_pk_mul_f32 v[110:111], v[110:111], v[100:101] op_sel_hi:[1,0]
    v_cvt_pk_bf16_f32 v108, v108, v109
    v_accvgpr_read_b32 v107, a35
    v_mfma_f32_16x16x32_bf16 a[16:19], a[228:231], v[32:35], 0
    s_waitcnt lgkmcnt(2)
    ds_write2st64_b64 v101, v[140:141], v[188:189] offset0:4 offset1:16
    v_mfma_f32_16x16x32_bf16 a[24:27], a[212:215], v[32:35], 0
    buffer_load_dwordx4 v7, s[12:15], s58 offen nt lds
    ds_read_b64_tr_b16 a[234:235], v5 offset:8192
    ds_read_b64_tr_b16 a[230:231], v4 offset:8192
    v_mfma_f32_16x16x32_bf16 a[28:31], a[216:219], v[32:35], 0
    buffer_store_dwordx4 v[84:87], v103, s[16:19], s67 offen offset:0 nt
    ds_write2st64_b64 v101, v[236:237], v[104:105] offset0:28 offset1:40
    ds_read_b64_tr_b16 a[232:233], v5 offset:2048
    ds_read_b64_tr_b16 a[220:221], v2 offset:2048
    v_accvgpr_read_b32 v106, a34
    v_exp_f32 v70, v70
    v_mul_f32 v107, v107, v51
    v_mfma_f32_16x16x32_bf16 v[236:239], a[216:219], v[26:29], 0
    ds_read_b64_tr_b16 a[224:225], v3 offset:2048
    ds_read_b64_tr_b16 a[228:229], v4 offset:2048
    v_accvgpr_read_b32 v104, a32
    v_cvt_pk_bf16_f32 v109, v110, v111
    v_mfma_f32_16x16x32_bf16 v[232:235], a[212:215], v[26:29], 0
    s_add_u32 s39, s39, 12288
    ds_write_b64 v101, v[108:109] offset:26624
    v_accvgpr_read_b32 v108, a80
    v_accvgpr_read_b32 v105, a33
    v_mul_f32 v105, v105, v51
    v_mul_f32 v104, v104, v51
    v_cvt_pk_bf16_f32 v197, v198, v199
    v_cvt_pk_bf16_f32 v104, v104, v105
    v_accvgpr_read_b32 v110, a82
    v_exp_f32 v54, v54
    v_accvgpr_read_b32 v111, a83
    v_accvgpr_read_b32 v109, a81
    v_cvt_pk_bf16_f32 v200, v200, v201
    v_exp_f32 v78, v78
    v_mul_f32 v106, v106, v51
    v_cvt_pk_bf16_f32 v241, v242, v243
    v_pk_mul_f32 v[108:109], v[108:109], v[100:101] op_sel_hi:[1,0]
    v_xor_b32 v101, 96, v101
    v_cvt_pk_bf16_f32 v149, v150, v151
    v_cvt_pk_bf16_f32 v201, v202, v203
    v_cvt_pk_bf16_f32 v108, v108, v109
    v_pk_mul_f32 v[110:111], v[110:111], v[100:101] op_sel_hi:[1,0]
    v_cvt_pk_bf16_f32 v105, v106, v107
    v_cvt_pk_bf16_f32 v157, v158, v159
    v_cvt_pk_bf16_f32 v109, v110, v111
    v_mfma_f32_16x16x32_bf16 v[184:187], a[212:215], v[20:23], 0
    ds_write2st64_b64 v101, v[144:145], v[192:193] offset0:8 offset1:20
    v_accvgpr_read_b32 v110, a86
    v_mfma_f32_16x16x32_bf16 v[188:191], a[216:219], v[20:23], 0
    s_waitcnt vmcnt(10) lgkmcnt(2)
    ds_write2st64_b64 v101, v[240:241], v[104:105] offset0:32 offset1:44
    v_cvt_pk_bf16_f32 v248, v248, v249
    v_cvt_pk_bf16_f32 v36, v76, v77
    v_accvgpr_read_b32 v107, a39
    v_accvgpr_read_b32 v104, a36
    v_cvt_pk_bf16_f32 v245, v246, v247
    v_accvgpr_read_b32 v105, a37
    v_mul_f32 v104, v104, v51
    v_mfma_f32_16x16x32_bf16 v[140:143], a[216:219], v[14:17], 0
    buffer_store_dwordx4 v[88:91], v102, s[16:19], s56 offen offset:0 nt
    s_barrier
    ds_write_b64 v101, v[108:109] offset:0
    v_cvt_pk_bf16_f32 v25, v62, v63
    v_accvgpr_read_b32 v111, a87
    v_xor_b32 v101, 32, v101
    v_accvgpr_read_b32 v109, a85
    v_mul_f32 v107, v107, v51
    v_cvt_pk_bf16_f32 v249, v250, v251
    v_fma_f32 v82, v82, s28, v12
    v_pk_mul_f32 v[110:111], v[110:111], v[100:101] op_sel_hi:[1,0]
    v_accvgpr_read_b32 v108, a84
    v_pk_mul_f32 v[108:109], v[108:109], v[100:101] op_sel_hi:[1,0]
    v_exp_f32 v74, v74
    v_mul_f32 v105, v105, v51
    v_cvt_pk_bf16_f32 v104, v104, v105
    v_mfma_f32_16x16x32_bf16 v[136:139], a[212:215], v[14:17], 0
    s_add_u32 m0, s22, 24576
    ds_write2st64_b64 v101, v[148:149], v[196:197] offset0:8 offset1:20
    v_accvgpr_read_b32 v106, a38
    v_cvt_pk_bf16_f32 v252, v252, v253
    v_mul_f32 v106, v106, v51
    v_cvt_pk_bf16_f32 v105, v106, v107
    v_mfma_f32_16x16x32_bf16 v[144:147], a[220:223], v[14:17], 0
    buffer_load_dwordx4 v6, s[8:11], s21 offen lds
    ds_read_b128 a[212:215], v0 offset:0
    v_cvt_pk_bf16_f32 v108, v108, v109
    v_accvgpr_read_b32 v107, a43
    v_fma_f32 v67, v67, s28, v10
    v_cvt_pk_bf16_f32 v109, v110, v111
    v_mfma_f32_16x16x32_bf16 v[148:151], a[224:227], v[14:17], 0
    s_add_u32 s21, s21, 128
    ds_write2st64_b64 v101, v[244:245], v[104:105] offset0:32 offset1:44
    v_accvgpr_read_b32 v104, a40
    v_mfma_f32_16x16x32_bf16 v[196:199], a[224:227], v[20:23], 0
    s_add_u32 m0, s22, 25600
    ds_write_b64 v101, v[108:109] offset:0
    v_accvgpr_read_b32 v105, a41
    v_accvgpr_read_b32 v106, a42
    v_mul_f32 v106, v106, v51
    v_accvgpr_read_b32 v108, a88
    v_accvgpr_read_b32 v109, a89
    v_mul_f32 v104, v104, v51
    v_mul_f32 v107, v107, v51
    v_mul_f32 v105, v105, v51
    v_cvt_pk_bf16_f32 v104, v104, v105
    v_cvt_pk_bf16_f32 v105, v106, v107
    v_xor_b32 v101, 96, v101
    v_accvgpr_read_b32 v111, a91
    v_mfma_f32_16x16x32_bf16 v[192:195], a[220:223], v[20:23], 0
    ds_write2st64_b64 v101, v[152:153], v[200:201] offset0:8 offset1:20
    v_mfma_f32_16x16x32_bf16 v[240:243], a[220:223], v[26:29], 0
    buffer_load_dwordx4 v6, s[8:11], s21 offen lds
    ds_write2st64_b64 v101, v[248:249], v[104:105] offset0:32 offset1:44
    v_accvgpr_read_b32 v104, a44
    v_cvt_pk_bf16_f32 v19, v54, v55
    v_pk_mul_f32 v[108:109], v[108:109], v[100:101] op_sel_hi:[1,0]
    v_accvgpr_read_b32 v110, a90
    v_cvt_pk_bf16_f32 v108, v108, v109
    v_accvgpr_read_b32 v106, a46
    v_pk_mul_f32 v[110:111], v[110:111], v[100:101] op_sel_hi:[1,0]
    v_accvgpr_read_b32 v107, a47
    v_accvgpr_read_b32 v105, a45
    v_mfma_f32_16x16x32_bf16 v[244:247], a[224:227], v[26:29], 0
    ds_read_b128 v[84:87], v8 offset:2048
    v_mul_f32 v105, v105, v51
    v_cvt_pk_bf16_f32 v253, v254, v255
    v_cvt_pk_bf16_f32 v109, v110, v111
    v_mul_f32 v107, v107, v51
    v_mul_f32 v104, v104, v51
    v_mfma_f32_16x16x32_bf16 a[36:39], a[224:227], v[32:35], 0
    ds_write_b64 v101, v[108:109] offset:0
    v_xor_b32 v101, 32, v101
    v_mul_f32 v106, v106, v51
    v_mfma_f32_16x16x32_bf16 a[32:35], a[220:223], v[32:35], 0
    ds_write2st64_b64 v101, v[156:157], v[204:205] offset0:8 offset1:20
    v_cvt_pk_bf16_f32 v104, v104, v105
    v_mfma_f32_16x16x32_bf16 a[40:43], a[228:231], v[32:35], 0
    s_add_u32 s21, s21, 128
    ds_read_b128 a[216:219], v1 offset:0
    v_cvt_pk_bf16_f32 v105, v106, v107
    v_mfma_f32_16x16x32_bf16 a[44:47], a[232:235], v[32:35], 0
    s_add_u32 m0, s22, 26624
    ds_write2st64_b64 v101, v[252:253], v[104:105] offset0:32 offset1:44
    v_mfma_f32_16x16x32_bf16 v[252:255], a[232:235], v[26:29], 0
    ds_read_b128 a[220:223], v0 offset:1024
    buffer_load_dwordx4 v6, s[8:11], s21 offen lds
    v_mfma_f32_16x16x32_bf16 v[248:251], a[228:231], v[26:29], 0
    buffer_store_dwordx4 v[96:99], v103, s[16:19], s56 offen offset:0 nt
    s_add_u32 s21, s21, 12032
    ds_read_b128 v[88:91], v8 offset:3072
    v_fma_f32 v73, v73, s28, v11
    v_exp_f32 v60, v60
    v_mfma_f32_16x16x32_bf16 v[200:203], a[228:231], v[20:23], 0
    v_accvgpr_read_b32 v110, a94
    v_cvt_pk_bf16_f32 v37, v78, v79
    v_cvt_pk_bf16_f32 v31, v70, v71
    v_mfma_f32_16x16x32_bf16 v[204:207], a[232:235], v[20:23], 0
    s_add_u32 s56, s67, 128
    ds_read_b128 v[96:99], v8 offset:8192
    v_cvt_pk_bf16_f32 v30, v68, v69
    v_mfma_f32_16x16x32_bf16 v[156:159], a[232:235], v[14:17], 0
    s_add_u32 s58, s33, 128
    v_cvt_pk_bf16_f32 v24, v60, v61
    v_exp_f32 v59, v59
    v_mfma_f32_16x16x32_bf16 v[152:155], a[228:231], v[14:17], 0
    s_waitcnt lgkmcnt(4)
    v_exp_f32 v64, v64
    v_mfma_f32_16x16x32_bf16 v[52:55], a[212:215], a[96:99], 0
    s_add_u32 m0, s38, 2048
    v_exp_f32 v58, v58
    v_mfma_f32_16x16x32_bf16 v[52:55], a[216:219], a[100:103], v[52:55]
    ds_read_b128 a[228:231], v0 offset:2048
    s_waitcnt lgkmcnt(3)
    v_mfma_f32_16x16x32_bf16 v[52:55], a[220:223], a[104:107], v[52:55]
    ds_read_b128 a[224:227], v1 offset:1024
    buffer_load_dwordx4 v6, s[12:15], s58 offen nt lds
    v_mfma_f32_16x16x32_bf16 v[60:63], a[220:223], a[128:131], 0
    buffer_store_dwordx4 v[84:87], v102, s[16:19], s56 offen offset:0 nt
    s_add_u32 m0, s38, 3072
    v_exp_f32 v82, v82
    v_accvgpr_read_b32 v108, a92
    v_mfma_f32_16x16x32_bf16 v[60:63], a[216:219], a[124:127], v[60:63]
    ds_read_b128 v[84:87], v8 offset:9216
    v_fma_f32 v57, v57, s28, v9
    v_mfma_f32_16x16x32_bf16 v[60:63], a[212:215], a[120:123], v[60:63]
    s_waitcnt lgkmcnt(3)
    ds_read_b128 a[232:235], v1 offset:2048
    buffer_load_dwordx4 v7, s[12:15], s58 offen nt lds
    v_mfma_f32_16x16x32_bf16 v[68:71], a[212:215], a[144:147], 0
    v_exp_f32 v73, v73
    v_mfma_f32_16x16x32_bf16 v[68:71], a[216:219], a[148:151], v[68:71]
    v_exp_f32 v56, v56
    v_mfma_f32_16x16x32_bf16 v[68:71], a[220:223], a[152:155], v[68:71]
    v_exp_f32 v83, v83
    v_mfma_f32_16x16x32_bf16 v[76:79], a[220:223], a[176:179], 0
    v_exp_f32 v65, v65
    v_mfma_f32_16x16x32_bf16 v[76:79], a[216:219], a[172:175], v[76:79]
    buffer_store_dwordx4 v[88:91], v103, s[16:19], s56 offen offset:0 nt
    s_add_u32 s57, s67, 6272
    v_exp_f32 v67, v67
    v_exp_f32 v66, v66
    v_mfma_f32_16x16x32_bf16 v[76:79], a[212:215], a[168:171], v[76:79]
    s_waitcnt lgkmcnt(2)
    v_exp_f32 v80, v80
    v_mfma_f32_16x16x32_bf16 v[76:79], a[224:227], a[180:183], v[76:79]
    s_add_u32 s59, s33, 6272
    v_exp_f32 v75, v75
    v_mfma_f32_16x16x32_bf16 v[76:79], a[228:231], a[184:187], v[76:79]
    s_waitcnt lgkmcnt(0)
    ds_read_b128 v[88:91], v8 offset:4096
    v_accvgpr_read_b32 v111, a95
    v_mfma_f32_16x16x32_bf16 v[76:79], a[232:235], a[188:191], v[76:79]
    v_exp_f32 v72, v72
    v_mfma_f32_16x16x32_bf16 v[68:71], a[232:235], a[164:167], v[68:71]
    s_add_u32 m0, s38, 8192
    ds_read_b128 a[212:215], v0 offset:6144
    buffer_load_dwordx4 v6, s[12:15], s59 offen nt lds
    v_accvgpr_read_b32 v109, a93
    v_mfma_f32_16x16x32_bf16 v[68:71], a[228:231], a[160:163], v[68:71]
    s_add_u32 m0, s38, 9216
    v_exp_f32 v57, v57
    v_mfma_f32_16x16x32_bf16 v[68:71], a[224:227], a[156:159], v[68:71]
    buffer_load_dwordx4 v7, s[12:15], s59 offen nt lds
    ds_read_b128 a[216:219], v1 offset:6144
    v_mfma_f32_16x16x32_bf16 v[60:63], a[224:227], a[132:135], v[60:63]
    buffer_store_dwordx4 v[96:99], v102, s[16:19], s57 offen offset:0 nt
    s_add_u32 s56, s67, 256
    ds_read_b128 a[220:223], v0 offset:7168
    v_pk_mul_f32 v[108:109], v[108:109], v[100:101] op_sel_hi:[1,0]
    v_pk_mul_f32 v[110:111], v[110:111], v[100:101] op_sel_hi:[1,0]
    v_cvt_pk_bf16_f32 v16, v56, v57
    v_cvt_pk_bf16_f32 v108, v108, v109
    v_mfma_f32_16x16x32_bf16 v[60:63], a[228:231], a[136:139], v[60:63]
    ds_read_b128 v[96:99], v8 offset:5120
    v_cvt_pk_bf16_f32 v109, v110, v111
    v_mfma_f32_16x16x32_bf16 v[60:63], a[232:235], a[140:143], v[60:63]
    buffer_store_dwordx4 v[84:87], v103, s[16:19], s57 offen offset:0 nt
    ds_write_b64 v101, v[108:109] offset:0
    v_mfma_f32_16x16x32_bf16 v[52:55], a[232:235], a[116:119], v[52:55]
    s_add_u32 s58, s33, 256
    ds_read_b128 v[84:87], v8 offset:0
    s_add_u32 m0, s38, 4096
    v_mfma_f32_16x16x32_bf16 v[52:55], a[228:231], a[112:115], v[52:55]
    v_cvt_pk_bf16_f32 v29, v74, v75
    v_cvt_pk_bf16_f32 v17, v58, v59
    v_mfma_f32_16x16x32_bf16 v[52:55], a[224:227], a[108:111], v[52:55]
    v_cvt_pk_bf16_f32 v28, v72, v73
    v_cvt_pk_bf16_f32 v23, v66, v67
    v_mfma_f32_16x16x32_bf16 v[48:51], a[236:239], v[16:19], v[44:47]
    s_waitcnt lgkmcnt(4)
    v_cvt_pk_bf16_f32 v22, v64, v65
    v_cvt_pk_bf16_f32 v35, v82, v83
    v_mfma_f32_16x16x32_bf16 v[56:59], a[212:215], a[96:99], 0
    buffer_load_dwordx4 v6, s[12:15], s58 offen nt lds
    v_mfma_f32_16x16x32_bf16 v[48:51], a[240:243], v[22:25], v[48:51]
    buffer_store_dwordx4 v[88:91], v102, s[16:19], s56 offen offset:0 nt
    s_nop 0
    ds_read_b128 v[88:91], v8 offset:1024
    v_cvt_pk_bf16_f32 v34, v80, v81
    v_mfma_f32_16x16x32_bf16 v[48:51], a[244:247], v[28:31], v[48:51]
    s_nop 0
    v_mfma_f32_16x16x32_bf16 v[48:51], a[248:251], v[34:37], v[48:51]
    ds_read_b128 a[228:231], v0 offset:8192
    v_mfma_f32_16x16x32_bf16 v[56:59], a[216:219], a[100:103], v[56:59]
    s_add_u32 m0, s38, 5120
    ds_read_b128 a[224:227], v1 offset:7168
    s_waitcnt lgkmcnt(3)
    v_mfma_f32_16x16x32_bf16 v[56:59], a[220:223], a[104:107], v[56:59]
    buffer_load_dwordx4 v7, s[12:15], s58 offen nt lds
    v_mfma_f32_16x16x32_bf16 v[64:67], a[220:223], a[128:131], 0
    s_add_u32 s57, s67, 24832
    v_cmp_lt_f32 vcc, s29, v48
    v_mfma_f32_16x16x32_bf16 v[64:67], a[216:219], a[124:127], v[64:67]
    s_add_u32 m0, s38, 0
    ds_read_b128 a[232:235], v1 offset:8192
    v_add_u32 v8, 10240, v8
    v_mfma_f32_16x16x32_bf16 v[64:67], a[212:215], a[120:123], v[64:67]
    buffer_load_dwordx4 v6, s[12:15], s33 offen nt lds
    v_mfma_f32_16x16x32_bf16 v[72:75], a[212:215], a[144:147], 0
    s_add_u32 m0, s38, 1024
    s_cbranch_vccnz L_rs_tr54d
L_ret_tr54d:
    v_mfma_f32_16x16x32_bf16 v[72:75], a[216:219], a[148:151], v[72:75]
    v_fma_f32 v54, v54, s28, v9
    v_fma_f32 v55, v55, s28, v9
    v_mfma_f32_16x16x32_bf16 v[72:75], a[220:223], a[152:155], v[72:75]
    v_fma_f32 v60, v60, s28, v10
    v_fma_f32 v61, v61, s28, v10
    v_mfma_f32_16x16x32_bf16 v[80:83], a[220:223], a[176:179], 0
    v_exp_f32 v61, v61
    v_mfma_f32_16x16x32_bf16 v[80:83], a[216:219], a[172:175], v[80:83]
    buffer_store_dwordx4 v[96:99], v103, s[16:19], s56 offen offset:0 nt
    v_fma_f32 v52, v52, s28, v9
    v_exp_f32 v55, v55
    v_mfma_f32_16x16x32_bf16 v[80:83], a[212:215], a[168:171], v[80:83]
    s_waitcnt lgkmcnt(1)
    v_exp_f32 v60, v60
    v_mfma_f32_16x16x32_bf16 v[80:83], a[224:227], a[180:183], v[80:83]
    buffer_load_dwordx4 v7, s[12:15], s33 offen nt lds
    v_mfma_f32_16x16x32_bf16 v[80:83], a[228:231], a[184:187], v[80:83]
    v_cvt_pk_bf16_f32 v20, v60, v61
    s_waitcnt vmcnt(26) lgkmcnt(0)
    v_mfma_f32_16x16x32_bf16 v[80:83], a[232:235], a[188:191], v[80:83]
    buffer_store_dwordx4 v[84:87], v102, s[16:19], s57 offen offset:0 nt
    s_barrier
    ds_read_b64_tr_b16 a[212:213], v2 offset:18432
    ds_read_b64_tr_b16 a[214:215], v2 offset:12288
    v_mfma_f32_16x16x32_bf16 v[72:75], a[232:235], a[164:167], v[72:75]
    ds_read_b64_tr_b16 a[216:217], v3 offset:18432
    v_mfma_f32_16x16x32_bf16 v[72:75], a[228:231], a[160:163], v[72:75]
    s_add_u32 m0, s22, 0
    ds_read_b64_tr_b16 a[218:219], v3 offset:12288
    v_fma_f32 v53, v53, s28, v9
    v_mfma_f32_16x16x32_bf16 v[72:75], a[224:227], a[156:159], v[72:75]
    buffer_load_dwordx4 v6, s[4:7], s20 offen lds
    v_mfma_f32_16x16x32_bf16 v[64:67], a[224:227], a[132:135], v[64:67]
    buffer_store_dwordx4 v[88:91], v103, s[16:19], s57 offen offset:0 nt
    s_add_u32 s20, s20, 128
    s_add_u32 m0, s22, 1024
    ds_read_b64_tr_b16 a[220:221], v4 offset:18432
    v_exp_f32 v52, v52
    v_mfma_f32_16x16x32_bf16 v[64:67], a[228:231], a[136:139], v[64:67]
    v_exp_f32 v54, v54
    v_mfma_f32_16x16x32_bf16 v[64:67], a[232:235], a[140:143], v[64:67]
    v_exp_f32 v53, v53
    v_mfma_f32_16x16x32_bf16 v[56:59], a[232:235], a[116:119], v[56:59]
    buffer_load_dwordx4 v6, s[4:7], s20 offen lds
    v_mfma_f32_16x16x32_bf16 v[56:59], a[228:231], a[112:115], v[56:59]
    s_add_u32 s20, s20, 128
    ds_read_b64_tr_b16 a[222:223], v4 offset:12288
    v_cvt_pk_bf16_f32 v15, v54, v55
    v_mfma_f32_16x16x32_bf16 v[56:59], a[224:227], a[108:111], v[56:59]
    s_add_u32 m0, s22, 2048
    ds_read_b64_tr_b16 a[224:225], v5 offset:18432
    ds_read_b64_tr_b16 a[226:227], v5 offset:12288
    buffer_load_dwordx4 v6, s[4:7], s20 offen lds
    s_add_u32 s20, s20, 12032
    v_cvt_pk_bf16_f32 v14, v52, v53
    s_branch L_loop4
L_tr55:
    s_waitcnt lgkmcnt(4)
    v_mfma_f32_16x16x32_bf16 v[112:115], a[212:215], v[16:19], v[112:115]
    ds_read_b64_tr_b16 a[232:233], v3 offset:19456
    v_mbcnt_lo_u32_b32 v97, -1, 0
    v_mfma_f32_16x16x32_bf16 v[116:119], a[216:219], v[16:19], v[116:119]
    s_add_u32 s39, s39, 12288
    ds_read_b64_tr_b16 a[228:229], v2 offset:19456
    v_fma_f32 v57, v57, s28, v9
    v_mfma_f32_16x16x32_bf16 v[164:167], a[216:219], v[22:25], v[164:167]
    v_fma_f32 v70, v70, s28, v11
    v_mfma_f32_16x16x32_bf16 v[160:163], a[212:215], v[22:25], v[160:163]
    v_fma_f32 v69, v69, s28, v11
    v_fma_f32 v77, v77, s28, v12
    v_mfma_f32_16x16x32_bf16 v[208:211], a[212:215], v[28:31], v[208:211]
    s_add_u32 s48, s33, 24576
    ds_read_b64_tr_b16 a[230:231], v2 offset:13312
    v_mbcnt_hi_u32_b32 v97, -1, v97
    v_mfma_f32_16x16x32_bf16 v[212:215], a[216:219], v[28:31], v[212:215]
    ds_read_b64_tr_b16 a[234:235], v3 offset:13312
    v_fma_f32 v82, v82, s28, v12
    v_mfma_f32_16x16x32_bf16 a[4:7], a[216:219], v[34:37], a[4:7]
    v_and_b32 v96, 15, v97
    v_lshrrev_b32 v97, 4, v97
    v_mfma_f32_16x16x32_bf16 a[0:3], a[212:215], v[34:37], a[0:3]
    v_mul_u32_u24 v96, 384, v96
    v_fma_f32 v79, v79, s28, v12
    v_mfma_f32_16x16x32_bf16 a[48:51], a[212:215], v[40:43], a[48:51]
    ds_read_b64_tr_b16 a[214:215], v4 offset:13312
    v_fma_f32 v59, v59, s28, v9
    v_mfma_f32_16x16x32_bf16 a[52:55], a[216:219], v[40:43], a[52:55]
    s_waitcnt lgkmcnt(5)
    v_fma_f32 v68, v68, s28, v11
    v_mfma_f32_16x16x32_bf16 a[56:59], a[220:223], v[40:43], a[56:59]
    v_lshl_add_u32 v96, v97, 4, v96
    v_fma_f32 v58, v58, s28, v9
    v_mfma_f32_16x16x32_bf16 a[60:63], a[224:227], v[40:43], a[60:63]
    buffer_load_dword v97, v96, s[12:15], s48 offen offset:256
    v_mfma_f32_16x16x32_bf16 a[12:15], a[224:227], v[34:37], a[12:15]
    ds_read_b64_tr_b16 a[218:219], v5 offset:13312
    v_fma_f32 v85, v85, s28, v13
    v_mfma_f32_16x16x32_bf16 a[8:11], a[220:223], v[34:37], a[8:11]
    ds_read_b64_tr_b16 a[212:213], v4 offset:19456
    v_fma_f32 v83, v83, s28, v12
    v_mfma_f32_16x16x32_bf16 v[216:219], a[220:223], v[28:31], v[216:219]
    v_fma_f32 v90, v90, s28, v13
    v_fma_f32 v56, v56, s28, v9
    v_mfma_f32_16x16x32_bf16 v[220:223], a[224:227], v[28:31], v[220:223]
    ds_read_b64_tr_b16 a[216:217], v5 offset:19456
    v_fma_f32 v78, v78, s28, v12
    v_mfma_f32_16x16x32_bf16 v[172:175], a[224:227], v[22:25], v[172:175]
    v_fma_f32 v73, v73, s28, v11
    v_fma_f32 v71, v71, s28, v11
    v_mfma_f32_16x16x32_bf16 v[168:171], a[220:223], v[22:25], v[168:171]
    v_exp_f32 v69, v69
    v_mfma_f32_16x16x32_bf16 v[120:123], a[220:223], v[16:19], v[120:123]
    v_fma_f32 v75, v75, s28, v11
    v_mfma_f32_16x16x32_bf16 v[124:127], a[224:227], v[16:19], v[124:127]
    s_waitcnt lgkmcnt(3)
    v_exp_f32 v57, v57
    v_mfma_f32_16x16x32_bf16 v[128:131], a[228:231], v[16:19], v[128:131]
    v_exp_f32 v78, v78
    v_mfma_f32_16x16x32_bf16 v[132:135], a[232:235], v[16:19], v[132:135]
    v_exp_f32 v79, v79
    v_mfma_f32_16x16x32_bf16 v[180:183], a[232:235], v[22:25], v[180:183]
    v_fma_f32 v72, v72, s28, v11
    v_fma_f32 v74, v74, s28, v11
    v_mfma_f32_16x16x32_bf16 v[176:179], a[228:231], v[22:25], v[176:179]
    ds_read_b64_tr_b16 a[220:221], v2 offset:20480
    v_fma_f32 v89, v89, s28, v13
    v_mfma_f32_16x16x32_bf16 v[224:227], a[228:231], v[28:31], v[224:227]
    ds_read_b64_tr_b16 a[222:223], v2 offset:14336
    v_mfma_f32_16x16x32_bf16 v[228:231], a[232:235], v[28:31], v[228:231]
    v_exp_f32 v85, v85
    v_mfma_f32_16x16x32_bf16 a[20:23], a[232:235], v[34:37], a[20:23]
    v_exp_f32 v77, v77
    v_mfma_f32_16x16x32_bf16 a[16:19], a[228:231], v[34:37], a[16:19]
    ds_read_b64_tr_b16 a[224:225], v3 offset:20480
    v_fma_f32 v87, v87, s28, v13
    v_mfma_f32_16x16x32_bf16 a[64:67], a[228:231], v[40:43], a[64:67]
    ds_read_b64_tr_b16 a[226:227], v3 offset:14336
    v_fma_f32 v86, v86, s28, v13
    v_mfma_f32_16x16x32_bf16 a[68:71], a[232:235], v[40:43], a[68:71]
    s_waitcnt lgkmcnt(4)
    ds_read_b64_tr_b16 a[230:231], v4 offset:14336
    v_mfma_f32_16x16x32_bf16 a[72:75], a[212:215], v[40:43], a[72:75]
    v_fma_f32 v81, v81, s28, v12
    v_fma_f32 v65, v65, s28, v10
    v_mfma_f32_16x16x32_bf16 a[76:79], a[216:219], v[40:43], a[76:79]
    ds_read_b64_tr_b16 a[232:233], v5 offset:20480
    v_mfma_f32_16x16x32_bf16 a[28:31], a[216:219], v[34:37], a[28:31]
    v_exp_f32 v87, v87
    v_mfma_f32_16x16x32_bf16 a[24:27], a[212:215], v[34:37], a[24:27]
    v_exp_f32 v71, v71
    v_mfma_f32_16x16x32_bf16 v[232:235], a[212:215], v[28:31], v[232:235]
    ds_read_b64_tr_b16 a[228:229], v4 offset:20480
    v_mfma_f32_16x16x32_bf16 v[236:239], a[216:219], v[28:31], v[236:239]
    v_mfma_f32_16x16x32_bf16 v[188:191], a[216:219], v[22:25], v[188:191]
    ds_read_b64_tr_b16 a[234:235], v5 offset:14336
    v_mfma_f32_16x16x32_bf16 v[184:187], a[212:215], v[22:25], v[184:187]
    v_fma_f32 v84, v84, s28, v13
    v_fma_f32 v88, v88, s28, v13
    v_mfma_f32_16x16x32_bf16 v[136:139], a[212:215], v[16:19], v[136:139]
    v_exp_f32 v56, v56
    v_mfma_f32_16x16x32_bf16 v[140:143], a[216:219], v[16:19], v[140:143]
    s_waitcnt lgkmcnt(3)
    v_fma_f32 v76, v76, s28, v12
    v_mfma_f32_16x16x32_bf16 v[144:147], a[220:223], v[16:19], v[144:147]
    v_exp_f32 v70, v70
    v_mfma_f32_16x16x32_bf16 v[148:151], a[224:227], v[16:19], v[148:151]
    v_exp_f32 v75, v75
    v_mfma_f32_16x16x32_bf16 v[196:199], a[224:227], v[22:25], v[196:199]
    v_fma_f32 v80, v80, s28, v12
    v_cvt_pk_bf16_f32 v33, v78, v79
    v_mfma_f32_16x16x32_bf16 v[192:195], a[220:223], v[22:25], v[192:195]
    v_exp_f32 v65, v65
    v_mfma_f32_16x16x32_bf16 v[240:243], a[220:223], v[28:31], v[240:243]
    v_exp_f32 v68, v68
    v_mfma_f32_16x16x32_bf16 v[244:247], a[224:227], v[28:31], v[244:247]
    v_exp_f32 v86, v86
    v_mfma_f32_16x16x32_bf16 a[36:39], a[224:227], v[34:37], a[36:39]
    s_waitcnt vmcnt(11) lgkmcnt(0)
    v_exp_f32 v90, v90
    v_mfma_f32_16x16x32_bf16 a[32:35], a[220:223], v[34:37], a[32:35]
    s_barrier
    v_mfma_f32_16x16x32_bf16 a[80:83], a[220:223], v[40:43], a[80:83]
    ds_read_b128 a[216:219], v1 offset:12288
    v_mfma_f32_16x16x32_bf16 a[84:87], a[224:227], v[40:43], a[84:87]
    ds_read_b128 a[212:215], v0 offset:12288
    s_add_u32 m0, s22, 36864
    v_mfma_f32_16x16x32_bf16 a[88:91], a[228:231], v[40:43], a[88:91]
    v_exp_f32 v84, v84
    v_mfma_f32_16x16x32_bf16 a[92:95], a[232:235], v[40:43], a[92:95]
    buffer_load_dwordx4 v6, s[8:11], s21 offen lds
    v_mfma_f32_16x16x32_bf16 a[44:47], a[232:235], v[34:37], a[44:47]
    s_add_u32 s21, s21, 128
    s_add_u32 m0, s22, 37888
    v_cvt_pk_bf16_f32 v27, v70, v71
    v_mfma_f32_16x16x32_bf16 a[40:43], a[228:231], v[34:37], a[40:43]
    buffer_load_dwordx4 v6, s[8:11], s21 offen lds
    v_mfma_f32_16x16x32_bf16 v[248:251], a[228:231], v[28:31], v[248:251]
    v_exp_f32 v76, v76
    v_mfma_f32_16x16x32_bf16 v[252:255], a[232:235], v[28:31], v[252:255]
    ds_read_b128 a[220:223], v0 offset:13312
    v_cvt_pk_bf16_f32 v26, v68, v69
    v_mfma_f32_16x16x32_bf16 v[204:207], a[232:235], v[22:25], v[204:207]
    s_add_u32 s21, s21, 128
    v_fma_f32 v91, v91, s28, v13
    s_add_u32 m0, s22, 38912
    v_mfma_f32_16x16x32_bf16 v[200:203], a[228:231], v[22:25], v[200:203]
    buffer_load_dwordx4 v6, s[8:11], s21 offen lds
    v_mfma_f32_16x16x32_bf16 v[152:155], a[228:231], v[16:19], v[152:155]
    ds_read_b128 a[228:231], v0 offset:14336
    v_fma_f32 v64, v64, s28, v10
    v_mfma_f32_16x16x32_bf16 v[156:159], a[232:235], v[16:19], v[156:159]
    s_waitcnt lgkmcnt(2)
    v_cvt_pk_bf16_f32 v38, v84, v85
    v_cvt_pk_bf16_f32 v39, v86, v87
    v_mfma_f32_16x16x32_bf16 v[52:55], a[212:215], a[96:99], 0
    v_exp_f32 v80, v80
    v_mfma_f32_16x16x32_bf16 v[60:63], a[212:215], a[120:123], 0
    ds_read_b128 a[224:227], v1 offset:13312
    v_cvt_pk_bf16_f32 v32, v76, v77
    v_mfma_f32_16x16x32_bf16 v[68:71], a[212:215], a[144:147], 0
    v_exp_f32 v72, v72
    v_mfma_f32_16x16x32_bf16 v[76:79], a[212:215], a[168:171], 0
    v_exp_f32 v82, v82
    v_mfma_f32_16x16x32_bf16 v[84:87], a[212:215], a[192:195], 0
    v_mfma_f32_16x16x32_bf16 v[52:55], a[216:219], a[100:103], v[52:55]
    v_exp_f32 v91, v91
    v_mfma_f32_16x16x32_bf16 v[60:63], a[216:219], a[124:127], v[60:63]
    ds_read_b128 a[232:235], v1 offset:14336
    v_fma_f32 v67, v67, s28, v10
    v_mfma_f32_16x16x32_bf16 v[68:71], a[216:219], a[148:151], v[68:71]
    v_exp_f32 v64, v64
    v_mfma_f32_16x16x32_bf16 v[76:79], a[216:219], a[172:175], v[76:79]
    v_exp_f32 v73, v73
    v_mfma_f32_16x16x32_bf16 v[84:87], a[216:219], a[196:199], v[84:87]
    s_waitcnt lgkmcnt(2)
    v_exp_f32 v67, v67
    v_mfma_f32_16x16x32_bf16 v[52:55], a[220:223], a[104:107], v[52:55]
    ds_read_b128 a[216:219], v1 offset:20480
    v_mfma_f32_16x16x32_bf16 v[60:63], a[220:223], a[128:131], v[60:63]
    v_exp_f32 v88, v88
    v_mfma_f32_16x16x32_bf16 v[68:71], a[220:223], a[152:155], v[68:71]
    v_exp_f32 v74, v74
    v_mfma_f32_16x16x32_bf16 v[76:79], a[220:223], a[176:179], v[76:79]
    v_exp_f32 v58, v58
    v_mfma_f32_16x16x32_bf16 v[84:87], a[220:223], a[200:203], v[84:87]
    s_waitcnt lgkmcnt(2)
    v_exp_f32 v59, v59
    v_mfma_f32_16x16x32_bf16 v[52:55], a[224:227], a[108:111], v[52:55]
    v_exp_f32 v83, v83
    v_mfma_f32_16x16x32_bf16 v[60:63], a[224:227], a[132:135], v[60:63]
    ds_read_b128 a[212:215], v0 offset:20480
    v_mfma_f32_16x16x32_bf16 v[68:71], a[224:227], a[156:159], v[68:71]
    v_exp_f32 v81, v81
    v_mfma_f32_16x16x32_bf16 v[76:79], a[224:227], a[180:183], v[76:79]
    v_exp_f32 v89, v89
    v_mfma_f32_16x16x32_bf16 v[84:87], a[224:227], a[204:207], v[84:87]
    v_cvt_pk_bf16_f32 v22, v64, v65
    v_mfma_f32_16x16x32_bf16 v[52:55], a[228:231], a[112:115], v[52:55]
    v_fma_f32 v66, v66, s28, v10
    v_cvt_pk_bf16_f32 v40, v88, v89
    v_mfma_f32_16x16x32_bf16 v[60:63], a[228:231], a[136:139], v[60:63]
    v_mfma_f32_16x16x32_bf16 v[68:71], a[228:231], a[160:163], v[68:71]
    s_add_u32 s21, s21, 12032
    ds_read_b128 a[220:223], v0 offset:18432
    v_cvt_pk_bf16_f32 v29, v74, v75
    v_mfma_f32_16x16x32_bf16 v[76:79], a[228:231], a[184:187], v[76:79]
    v_cvt_pk_bf16_f32 v17, v58, v59
    v_cvt_pk_bf16_f32 v16, v56, v57
    v_mfma_f32_16x16x32_bf16 v[84:87], a[228:231], a[208:211], v[84:87]
    s_waitcnt lgkmcnt(2)
    v_exp_f32 v66, v66
    v_mfma_f32_16x16x32_bf16 v[52:55], a[232:235], a[116:119], v[52:55]
    ds_read_b128 a[228:231], v0 offset:19456
    v_mfma_f32_16x16x32_bf16 v[60:63], a[232:235], a[140:143], v[60:63]
    ds_read_b128 a[224:227], v1 offset:18432
    v_mfma_f32_16x16x32_bf16 v[44:47], a[236:239], v[14:17], v[48:51]
    v_cvt_pk_bf16_f32 v35, v82, v83
    v_mfma_f32_16x16x32_bf16 v[68:71], a[232:235], a[164:167], v[68:71]
    v_cvt_pk_bf16_f32 v28, v72, v73
    v_mfma_f32_16x16x32_bf16 v[76:79], a[232:235], a[188:191], v[76:79]
    v_cvt_pk_bf16_f32 v23, v66, v67
    v_cvt_pk_bf16_f32 v41, v90, v91
    v_mfma_f32_16x16x32_bf16 v[84:87], a[232:235], v[92:95], v[84:87]
    ds_read_b128 a[232:235], v1 offset:19456
    v_cvt_pk_bf16_f32 v34, v80, v81
    v_mfma_f32_16x16x32_bf16 v[44:47], a[240:243], v[20:23], v[44:47]
    v_mfma_f32_16x16x32_bf16 v[44:47], a[244:247], v[26:29], v[44:47]
    v_mfma_f32_16x16x32_bf16 v[44:47], a[248:251], v[32:35], v[44:47]
    v_mfma_f32_16x16x32_bf16 v[44:47], a[252:255], v[38:41], v[44:47]
    s_waitcnt lgkmcnt(3)
    v_mfma_f32_16x16x32_bf16 v[56:59], a[212:215], a[112:115], 0
    v_mfma_f32_16x16x32_bf16 v[64:67], a[212:215], a[136:139], 0
    v_mfma_f32_16x16x32_bf16 v[72:75], a[212:215], a[160:163], 0
    v_mfma_f32_16x16x32_bf16 v[80:83], a[212:215], a[184:187], 0
    v_mfma_f32_16x16x32_bf16 v[88:91], a[212:215], a[208:211], 0
    s_nop 1
    v_cmp_lt_f32 vcc, s29, v44
    v_mfma_f32_16x16x32_bf16 v[56:59], a[216:219], a[116:119], v[56:59]
    s_waitcnt vmcnt(8) lgkmcnt(0)
    v_mfma_f32_16x16x32_bf16 v[64:67], a[216:219], a[140:143], v[64:67]
    s_barrier
    v_mfma_f32_16x16x32_bf16 v[72:75], a[216:219], a[164:167], v[72:75]
    s_cbranch_vccnz L_rs_tr55a
L_ret_tr55a:
    v_fma_f32 v60, v60, s28, v10
    v_mfma_f32_16x16x32_bf16 v[80:83], a[216:219], a[188:191], v[80:83]
    ds_read_b64_tr_b16 a[212:213], v2 offset:0
    v_fma_f32 v54, v54, s28, v9
    v_mfma_f32_16x16x32_bf16 v[88:91], a[216:219], v[92:95], v[88:91]
    s_add_u32 m0, s22, 12288
    v_fma_f32 v52, v52, s28, v9
    v_fma_f32 v61, v61, s28, v10
    v_mfma_f32_16x16x32_bf16 v[56:59], a[220:223], a[96:99], v[56:59]
    buffer_load_dwordx4 v6, s[4:7], s20 offen lds
    v_mfma_f32_16x16x32_bf16 v[64:67], a[220:223], a[120:123], v[64:67]
    v_fma_f32 v55, v55, s28, v9
    v_fma_f32 v63, v63, s28, v10
    v_mfma_f32_16x16x32_bf16 v[72:75], a[220:223], a[144:147], v[72:75]
    s_add_u32 s20, s20, 128
    v_exp_f32 v52, v52
    v_mfma_f32_16x16x32_bf16 v[80:83], a[220:223], a[168:171], v[80:83]
    s_add_u32 m0, s22, 13312
    v_exp_f32 v55, v55
    v_mfma_f32_16x16x32_bf16 v[88:91], a[220:223], a[192:195], v[88:91]
    buffer_load_dwordx4 v6, s[4:7], s20 offen lds
    v_mfma_f32_16x16x32_bf16 v[56:59], a[224:227], a[100:103], v[56:59]
    s_add_u32 s20, s20, 128
    v_exp_f32 v54, v54
    v_mfma_f32_16x16x32_bf16 v[64:67], a[224:227], a[124:127], v[64:67]
    s_add_u32 m0, s22, 14336
    ds_read_b64_tr_b16 a[214:215], v2 offset:6144
    v_fma_f32 v62, v62, s28, v10
    v_mfma_f32_16x16x32_bf16 v[72:75], a[224:227], a[148:151], v[72:75]
    buffer_load_dwordx4 v6, s[4:7], s20 offen lds
    v_mfma_f32_16x16x32_bf16 v[80:83], a[224:227], a[172:175], v[80:83]
    v_exp_f32 v63, v63
    v_mfma_f32_16x16x32_bf16 v[88:91], a[224:227], a[196:199], v[88:91]
    ds_read_b64_tr_b16 a[216:217], v3 offset:0
    v_fma_f32 v53, v53, s28, v9
    v_mfma_f32_16x16x32_bf16 v[56:59], a[228:231], a[104:107], v[56:59]
    ds_read_b64_tr_b16 a[218:219], v3 offset:6144
    v_cvt_pk_bf16_f32 v19, v54, v55
    v_mfma_f32_16x16x32_bf16 v[64:67], a[228:231], a[128:131], v[64:67]
    v_exp_f32 v62, v62
    v_mfma_f32_16x16x32_bf16 v[72:75], a[228:231], a[152:155], v[72:75]
    ds_read_b64_tr_b16 a[220:221], v4 offset:0
    v_exp_f32 v61, v61
    v_mfma_f32_16x16x32_bf16 v[80:83], a[228:231], a[176:179], v[80:83]
    ds_read_b64_tr_b16 a[222:223], v4 offset:6144
    v_cvt_pk_bf16_f32 v25, v62, v63
    v_mfma_f32_16x16x32_bf16 v[88:91], a[228:231], a[200:203], v[88:91]
    v_exp_f32 v60, v60
    v_mfma_f32_16x16x32_bf16 v[56:59], a[232:235], a[108:111], v[56:59]
    s_add_u32 s20, s20, 12032
    v_exp_f32 v53, v53
    v_mfma_f32_16x16x32_bf16 v[64:67], a[232:235], a[132:135], v[64:67]
    ds_read_b64_tr_b16 a[224:225], v5 offset:0
    v_cvt_pk_bf16_f32 v18, v52, v53
    v_mfma_f32_16x16x32_bf16 v[72:75], a[232:235], a[156:159], v[72:75]
    buffer_load_dwordx4 a[208:211], v96, s[12:15], s48 offen offset:256 nt
    v_mfma_f32_16x16x32_bf16 v[80:83], a[232:235], a[180:183], v[80:83]
    ds_read_b64_tr_b16 a[226:227], v5 offset:6144
    v_cvt_pk_bf16_f32 v24, v60, v61
    v_mfma_f32_16x16x32_bf16 v[88:91], a[232:235], a[204:207], v[88:91]
    buffer_load_dwordx4 v[92:95], v96, s[12:15], s48 offen offset:320 nt
    s_waitcnt lgkmcnt(4)
    v_mfma_f32_16x16x32_bf16 v[112:115], a[212:215], v[14:17], v[112:115]
    ds_read_b64_tr_b16 a[234:235], v3 offset:7168
    v_fma_f32 v66, v66, s28, v10
    v_mfma_f32_16x16x32_bf16 v[116:119], a[216:219], v[14:17], v[116:119]
    ds_read_b64_tr_b16 a[228:229], v2 offset:1024
    v_fma_f32 v68, v68, s28, v11
    v_mfma_f32_16x16x32_bf16 v[164:167], a[216:219], v[20:23], v[164:167]
    v_fma_f32 v73, v73, s28, v11
    v_fma_f32 v67, v67, s28, v10
    v_mfma_f32_16x16x32_bf16 v[160:163], a[212:215], v[20:23], v[160:163]
    v_lshrrev_b32 v105, 11, v0
    v_xor_b32 v105, s65, v105
    v_mfma_f32_16x16x32_bf16 v[208:211], a[212:215], v[26:29], v[208:211]
    v_fma_f32 v56, v56, s28, v9
    v_fma_f32 v88, v88, s28, v13
    v_mfma_f32_16x16x32_bf16 v[212:215], a[216:219], v[26:29], v[212:215]
    v_fma_f32 v79, v79, s28, v12
    v_fma_f32 v78, v78, s28, v12
    v_mfma_f32_16x16x32_bf16 a[4:7], a[216:219], v[32:35], a[4:7]
    ds_read_b64_tr_b16 a[232:233], v3 offset:1024
    v_fma_f32 v76, v76, s28, v12
    v_mfma_f32_16x16x32_bf16 a[0:3], a[212:215], v[32:35], a[0:3]
    ds_read_b64_tr_b16 a[230:231], v2 offset:7168
    v_fma_f32 v81, v81, s28, v12
    v_mfma_f32_16x16x32_bf16 a[48:51], a[212:215], v[38:41], a[48:51]
    ds_read_b64_tr_b16 a[212:213], v4 offset:1024
    v_and_b32 v104, 0x3ff, v0
    v_mfma_f32_16x16x32_bf16 a[52:55], a[216:219], v[38:41], a[52:55]
    s_waitcnt lgkmcnt(5)
    v_exp_f32 v67, v67
    v_mfma_f32_16x16x32_bf16 a[56:59], a[220:223], v[38:41], a[56:59]
    v_exp_f32 v66, v66
    v_mfma_f32_16x16x32_bf16 a[60:63], a[224:227], v[38:41], a[60:63]
    v_lshl_add_u32 v104, v105, 10, v104
    v_fma_f32 v83, v83, s28, v12
    v_mfma_f32_16x16x32_bf16 a[12:15], a[224:227], v[32:35], a[12:15]
    ds_read_b64_tr_b16 a[218:219], v5 offset:7168
    v_fma_f32 v90, v90, s28, v13
    v_mfma_f32_16x16x32_bf16 a[8:11], a[220:223], v[32:35], a[8:11]
    v_fma_f32 v84, v84, s28, v13
    v_exp_f32 v76, v76
    v_mfma_f32_16x16x32_bf16 v[216:219], a[220:223], v[26:29], v[216:219]
    ds_read_b64_tr_b16 a[214:215], v4 offset:7168
    v_fma_f32 v58, v58, s28, v9
    v_mfma_f32_16x16x32_bf16 v[220:223], a[224:227], v[26:29], v[220:223]
    ds_read_b64_tr_b16 a[216:217], v5 offset:1024
    v_add_u32 v104, s38, v104
    v_mfma_f32_16x16x32_bf16 v[172:175], a[224:227], v[20:23], v[172:175]
    ds_read_b128 a[200:203], v104 offset:26624
    v_xor_b32 v105, 64, v104
    v_mfma_f32_16x16x32_bf16 v[168:171], a[220:223], v[20:23], v[168:171]
    ds_read_b128 a[144:147], v104 offset:12288
    v_fma_f32 v75, v75, s28, v11
    v_mfma_f32_16x16x32_bf16 v[120:123], a[220:223], v[14:17], v[120:123]
    v_exp_f32 v58, v58
    v_mfma_f32_16x16x32_bf16 v[124:127], a[224:227], v[14:17], v[124:127]
    s_waitcnt lgkmcnt(5)
    ds_read_b128 a[128:131], v104 offset:8192
    v_fma_f32 v69, v69, s28, v11
    v_mfma_f32_16x16x32_bf16 v[128:131], a[228:231], v[14:17], v[128:131]
    v_exp_f32 v68, v68
    v_mfma_f32_16x16x32_bf16 v[132:135], a[232:235], v[14:17], v[132:135]
    ds_read_b128 a[124:127], v105 offset:6144
    v_fma_f32 v91, v91, s28, v13
    v_mfma_f32_16x16x32_bf16 v[180:183], a[232:235], v[20:23], v[180:183]
    ds_read_b128 a[172:175], v105 offset:18432
    v_fma_f32 v87, v87, s28, v13
    v_mfma_f32_16x16x32_bf16 v[176:179], a[228:231], v[20:23], v[176:179]
    v_exp_f32 v69, v69
    v_mfma_f32_16x16x32_bf16 v[224:227], a[228:231], v[26:29], v[224:227]
    ds_read_b64_tr_b16 a[222:223], v2 offset:8192
    v_exp_f32 v73, v73
    v_mfma_f32_16x16x32_bf16 v[228:231], a[232:235], v[26:29], v[228:231]
    ds_read_b64_tr_b16 a[224:225], v3 offset:2048
    v_fma_f32 v74, v74, s28, v11
    v_mfma_f32_16x16x32_bf16 a[20:23], a[232:235], v[32:35], a[20:23]
    ds_read_b128 a[96:99], v104 offset:0
    v_fma_f32 v85, v85, s28, v13
    v_mfma_f32_16x16x32_bf16 a[16:19], a[228:231], v[32:35], a[16:19]
    ds_read_b64_tr_b16 a[220:221], v2 offset:2048
    v_fma_f32 v64, v64, s28, v10
    v_fma_f32 v82, v82, s28, v12
    v_mfma_f32_16x16x32_bf16 a[64:67], a[228:231], v[38:41], a[64:67]
    ds_read_b64_tr_b16 a[226:227], v3 offset:8192
    v_fma_f32 v77, v77, s28, v12
    v_mfma_f32_16x16x32_bf16 a[68:71], a[232:235], v[38:41], a[68:71]
    s_waitcnt lgkmcnt(7)
    v_exp_f32 v84, v84
    v_mfma_f32_16x16x32_bf16 a[72:75], a[212:215], v[38:41], a[72:75]
    ds_read_b64_tr_b16 a[232:233], v5 offset:2048
    v_fma_f32 v86, v86, s28, v13
    v_mfma_f32_16x16x32_bf16 a[76:79], a[216:219], v[38:41], a[76:79]
    ds_read_b64_tr_b16 a[230:231], v4 offset:8192
    v_fma_f32 v70, v70, s28, v11
    v_mfma_f32_16x16x32_bf16 a[28:31], a[216:219], v[32:35], a[28:31]
    ds_read_b64_tr_b16 a[234:235], v5 offset:8192
    v_cvt_pk_bf16_f32 v30, v68, v69
    v_mfma_f32_16x16x32_bf16 a[24:27], a[212:215], v[32:35], a[24:27]
    ds_read_b64_tr_b16 a[228:229], v4 offset:2048
    v_fma_f32 v71, v71, s28, v11
    v_mfma_f32_16x16x32_bf16 v[232:235], a[212:215], v[26:29], v[232:235]
    v_exp_f32 v86, v86
    v_mfma_f32_16x16x32_bf16 v[236:239], a[216:219], v[26:29], v[236:239]
    v_exp_f32 v70, v70
    v_mfma_f32_16x16x32_bf16 v[188:191], a[216:219], v[20:23], v[188:191]
    ds_read_b128 a[156:159], v105 offset:14336
    v_fma_f32 v57, v57, s28, v9
    v_mfma_f32_16x16x32_bf16 v[184:187], a[212:215], v[20:23], v[184:187]
    s_add_u32 s39, s39, 12288
    v_exp_f32 v78, v78
    v_mfma_f32_16x16x32_bf16 v[136:139], a[212:215], v[14:17], v[136:139]
    v_exp_f32 v83, v83
    v_mfma_f32_16x16x32_bf16 v[140:143], a[216:219], v[14:17], v[140:143]
    s_waitcnt lgkmcnt(5)
    v_exp_f32 v71, v71
    v_mfma_f32_16x16x32_bf16 v[144:147], a[220:223], v[14:17], v[144:147]
    ds_read_b128 a[104:107], v104 offset:2048
    v_fma_f32 v89, v89, s28, v13
    v_mfma_f32_16x16x32_bf16 v[148:151], a[224:227], v[14:17], v[148:151]
    ds_read_b128 a[168:171], v104 offset:18432
    v_fma_f32 v65, v65, s28, v10
    v_mfma_f32_16x16x32_bf16 v[196:199], a[224:227], v[20:23], v[196:199]
    ds_read_b128 a[148:151], v105 offset:12288
    v_cvt_pk_bf16_f32 v31, v70, v71
    v_mfma_f32_16x16x32_bf16 v[192:195], a[220:223], v[20:23], v[192:195]
    s_waitcnt vmcnt(9) lgkmcnt(4)
    v_exp_f32 v77, v77
    v_mfma_f32_16x16x32_bf16 v[240:243], a[220:223], v[26:29], v[240:243]
    ds_read_b128 a[120:123], v104 offset:6144
    v_cvt_pk_bf16_f32 v36, v76, v77
    v_mfma_f32_16x16x32_bf16 v[244:247], a[224:227], v[26:29], v[244:247]
    s_add_u32 s21, s21, s62
    v_exp_f32 v65, v65
    v_mfma_f32_16x16x32_bf16 a[36:39], a[224:227], v[32:35], a[36:39]
    s_add_u32 m0, s22, 24576
    v_exp_f32 v79, v79
    v_mfma_f32_16x16x32_bf16 a[32:35], a[220:223], v[32:35], a[32:35]
    s_barrier
    ds_read_b128 a[216:219], v1 offset:0
    v_mfma_f32_16x16x32_bf16 a[80:83], a[220:223], v[38:41], a[80:83]
    buffer_load_dwordx4 v6, s[8:11], s21 offen lds
    v_mfma_f32_16x16x32_bf16 a[84:87], a[224:227], v[38:41], a[84:87]
    s_add_u32 s21, s21, 128
    ds_read_b128 a[212:215], v0 offset:0
    v_fma_f32 v59, v59, s28, v9
    v_mfma_f32_16x16x32_bf16 a[88:91], a[228:231], v[38:41], a[88:91]
    ds_read_b128 a[100:103], v105 offset:0
    v_fma_f32 v72, v72, s28, v11
    v_mfma_f32_16x16x32_bf16 a[92:95], a[232:235], v[38:41], a[92:95]
    s_add_u32 m0, s22, 25600
    ds_read_b128 a[192:195], v104 offset:24576
    buffer_load_dwordx4 v6, s[8:11], s21 offen lds
    v_mfma_f32_16x16x32_bf16 a[44:47], a[232:235], v[32:35], a[44:47]
    s_add_u32 s21, s21, 128
    v_exp_f32 v72, v72
    v_mfma_f32_16x16x32_bf16 a[40:43], a[228:231], v[32:35], a[40:43]
    ds_read_b128 a[224:227], v1 offset:1024
    v_exp_f32 v64, v64
    v_mfma_f32_16x16x32_bf16 v[248:251], a[228:231], v[26:29], v[248:251]
    s_add_u32 m0, s22, 26624
    v_exp_f32 v85, v85
    v_mfma_f32_16x16x32_bf16 v[252:255], a[232:235], v[26:29], v[252:255]
    v_exp_f32 v87, v87
    v_mfma_f32_16x16x32_bf16 v[204:207], a[232:235], v[20:23], v[204:207]
    buffer_load_dwordx4 v6, s[8:11], s21 offen lds
    v_mfma_f32_16x16x32_bf16 v[200:203], a[228:231], v[20:23], v[200:203]
    ds_read_b128 a[196:199], v105 offset:24576
    v_exp_f32 v82, v82
    v_mfma_f32_16x16x32_bf16 v[152:155], a[228:231], v[14:17], v[152:155]
    ds_read_b128 a[220:223], v0 offset:1024
    v_cvt_pk_bf16_f32 v43, v86, v87
    v_mfma_f32_16x16x32_bf16 v[156:159], a[232:235], v[14:17], v[156:159]
    s_waitcnt lgkmcnt(4)
    ds_read_b128 a[132:135], v105 offset:8192
    v_cvt_pk_bf16_f32 v28, v72, v73
    v_mfma_f32_16x16x32_bf16 v[52:55], a[212:215], a[96:99], 0
    ds_read_b128 a[152:155], v104 offset:14336
    v_cvt_pk_bf16_f32 v22, v64, v65
    v_mfma_f32_16x16x32_bf16 v[60:63], a[212:215], a[120:123], 0
    ds_read_b128 a[176:179], v104 offset:20480
    v_cvt_pk_bf16_f32 v37, v78, v79
    v_mfma_f32_16x16x32_bf16 v[68:71], a[212:215], a[144:147], 0
    v_exp_f32 v59, v59
    v_mfma_f32_16x16x32_bf16 v[76:79], a[212:215], a[168:171], 0
    s_waitcnt lgkmcnt(5)
    ds_read_b128 a[180:183], v105 offset:20480
    v_cvt_pk_bf16_f32 v42, v84, v85
    v_mfma_f32_16x16x32_bf16 v[84:87], a[212:215], a[192:195], 0
    ds_read_b128 a[108:111], v105 offset:2048
    v_cvt_pk_bf16_f32 v35, v82, v83
    v_mfma_f32_16x16x32_bf16 v[52:55], a[216:219], a[100:103], v[52:55]
    ds_read_b128 a[204:207], v105 offset:26624
    v_mfma_f32_16x16x32_bf16 v[60:63], a[216:219], a[124:127], v[60:63]
    ds_read_b128 a[228:231], v0 offset:6144
    v_cvt_pk_bf16_f32 v23, v66, v67
    v_mfma_f32_16x16x32_bf16 v[68:71], a[216:219], a[148:151], v[68:71]
    v_exp_f32 v88, v88
    v_mfma_f32_16x16x32_bf16 v[76:79], a[216:219], a[172:175], v[76:79]
    s_waitcnt lgkmcnt(7)
    v_exp_f32 v75, v75
    v_mfma_f32_16x16x32_bf16 v[84:87], a[216:219], a[196:199], v[84:87]
    v_exp_f32 v81, v81
    v_mfma_f32_16x16x32_bf16 v[52:55], a[220:223], a[104:107], v[52:55]
    v_exp_f32 v89, v89
    v_mfma_f32_16x16x32_bf16 v[60:63], a[220:223], a[128:131], v[60:63]
    s_waitcnt lgkmcnt(4)
    v_exp_f32 v74, v74
    v_mfma_f32_16x16x32_bf16 v[68:71], a[220:223], a[152:155], v[68:71]
    ds_read_b128 a[212:215], v0 offset:7168
    v_mfma_f32_16x16x32_bf16 v[76:79], a[220:223], a[176:179], v[76:79]
    s_add_u32 s21, s21, 12032
    v_exp_f32 v57, v57
    v_mfma_f32_16x16x32_bf16 v[84:87], a[220:223], a[200:203], v[84:87]
    s_waitcnt lgkmcnt(3)
    v_exp_f32 v90, v90
    v_mfma_f32_16x16x32_bf16 v[52:55], a[224:227], a[108:111], v[52:55]
    ds_read_b128 a[232:235], v1 offset:6144
    v_fma_f32 v80, v80, s28, v12
    v_mfma_f32_16x16x32_bf16 v[60:63], a[224:227], a[132:135], v[60:63]
    v_exp_f32 v56, v56
    v_mfma_f32_16x16x32_bf16 v[68:71], a[224:227], a[156:159], v[68:71]
    v_cvt_pk_bf16_f32 v17, v58, v59
    v_mfma_f32_16x16x32_bf16 v[76:79], a[224:227], a[180:183], v[76:79]
    s_waitcnt lgkmcnt(2)
    v_cvt_pk_bf16_f32 v16, v56, v57
    v_cvt_pk_bf16_f32 v40, v88, v89
    v_mfma_f32_16x16x32_bf16 v[84:87], a[224:227], a[204:207], v[84:87]
    v_exp_f32 v80, v80
    v_mfma_f32_16x16x32_bf16 v[56:59], a[228:231], a[96:99], 0
    ds_read_b128 a[216:219], v1 offset:7168
    v_mfma_f32_16x16x32_bf16 v[48:51], a[236:239], v[16:19], v[44:47]
    v_cvt_pk_bf16_f32 v29, v74, v75
    v_cvt_pk_bf16_f32 v34, v80, v81
    v_mfma_f32_16x16x32_bf16 v[64:67], a[228:231], a[120:123], 0
    v_exp_f32 v91, v91
    v_mfma_f32_16x16x32_bf16 v[72:75], a[228:231], a[144:147], 0
    v_mfma_f32_16x16x32_bf16 v[80:83], a[228:231], a[168:171], 0
    ds_read_b128 a[160:163], v104 offset:16384
    v_cvt_pk_bf16_f32 v41, v90, v91
    v_mfma_f32_16x16x32_bf16 v[88:91], a[228:231], a[192:195], 0
    s_waitcnt lgkmcnt(2)
    ds_read_b128 a[228:231], v0 offset:8192
    v_mfma_f32_16x16x32_bf16 v[56:59], a[232:235], a[100:103], v[56:59]
    ds_read_b128 a[220:223], v0 offset:2048
    v_mfma_f32_16x16x32_bf16 v[64:67], a[232:235], a[124:127], v[64:67]
    ds_read_b128 a[224:227], v1 offset:2048
    v_mfma_f32_16x16x32_bf16 v[72:75], a[232:235], a[148:151], v[72:75]
    ds_read_b128 a[136:139], v104 offset:10240
    v_mfma_f32_16x16x32_bf16 v[80:83], a[232:235], a[172:175], v[80:83]
    ds_read_b128 a[140:143], v105 offset:10240
    v_mfma_f32_16x16x32_bf16 v[88:91], a[232:235], a[196:199], v[88:91]
    ds_read_b128 a[232:235], v1 offset:8192
    v_mfma_f32_16x16x32_bf16 v[48:51], a[240:243], v[22:25], v[48:51]
    v_mfma_f32_16x16x32_bf16 v[48:51], a[244:247], v[28:31], v[48:51]
    ds_read_b128 a[112:115], v104 offset:4096
    v_mfma_f32_16x16x32_bf16 v[48:51], a[248:251], v[34:37], v[48:51]
    ds_read_b128 a[184:187], v104 offset:22528
    v_mfma_f32_16x16x32_bf16 v[48:51], a[252:255], v[40:43], v[48:51]
    ds_read_b128 a[188:191], v105 offset:22528
    v_mfma_f32_16x16x32_bf16 v[56:59], a[212:215], a[104:107], v[56:59]
    ds_read_b128 a[164:167], v105 offset:16384
    v_mfma_f32_16x16x32_bf16 v[64:67], a[212:215], a[128:131], v[64:67]
    ds_read_b128 a[116:119], v105 offset:4096
    v_mfma_f32_16x16x32_bf16 v[72:75], a[212:215], a[152:155], v[72:75]
    s_nop 1
    v_cmp_lt_f32 vcc, s29, v48
    v_mfma_f32_16x16x32_bf16 v[80:83], a[212:215], a[176:179], v[80:83]
    v_mfma_f32_16x16x32_bf16 v[88:91], a[212:215], a[200:203], v[88:91]
    s_waitcnt lgkmcnt(6)
    v_mfma_f32_16x16x32_bf16 v[56:59], a[216:219], a[108:111], v[56:59]
    s_waitcnt vmcnt(3)
    s_waitcnt vmcnt(8) lgkmcnt(5)
    v_mfma_f32_16x16x32_bf16 v[64:67], a[216:219], a[132:135], v[64:67]
    s_barrier
    v_mfma_f32_16x16x32_bf16 v[72:75], a[216:219], a[156:159], v[72:75]
    s_cbranch_vccnz L_rs_tr55b
L_ret_tr55b:
    s_add_u32 m0, s22, 0
    v_mfma_f32_16x16x32_bf16 v[80:83], a[216:219], a[180:183], v[80:83]
    buffer_load_dwordx4 v6, s[4:7], s20 offen lds
    v_mfma_f32_16x16x32_bf16 v[88:91], a[216:219], a[204:207], v[88:91]
    s_add_u32 s20, s20, 128
    ds_read_b64_tr_b16 a[212:213], v2 offset:18432
    s_waitcnt lgkmcnt(3)
    v_mfma_f32_16x16x32_bf16 v[52:55], a[220:223], a[112:115], v[52:55]
    ds_read_b64_tr_b16 a[214:215], v2 offset:12288
    s_add_u32 m0, s22, 1024
    v_mfma_f32_16x16x32_bf16 v[60:63], a[220:223], a[136:139], v[60:63]
    buffer_load_dwordx4 v6, s[4:7], s20 offen lds
    v_mfma_f32_16x16x32_bf16 v[68:71], a[220:223], a[160:163], v[68:71]
    v_mfma_f32_16x16x32_bf16 v[76:79], a[220:223], a[184:187], v[76:79]
    s_add_u32 s20, s20, 128
    s_add_u32 m0, s22, 2048
    v_mfma_f32_16x16x32_bf16 v[84:87], a[220:223], a[208:211], v[84:87]
    s_waitcnt lgkmcnt(2)
    v_mfma_f32_16x16x32_bf16 v[52:55], a[224:227], a[116:119], v[52:55]
    buffer_load_dwordx4 v6, s[4:7], s20 offen lds
    v_mfma_f32_16x16x32_bf16 v[60:63], a[224:227], a[140:143], v[60:63]
    v_mfma_f32_16x16x32_bf16 v[68:71], a[224:227], a[164:167], v[68:71]
    v_mfma_f32_16x16x32_bf16 v[76:79], a[224:227], a[188:191], v[76:79]
    ds_read_b64_tr_b16 a[216:217], v3 offset:18432
    v_mfma_f32_16x16x32_bf16 v[84:87], a[224:227], v[92:95], v[84:87]
    ds_read_b64_tr_b16 a[218:219], v3 offset:12288
    v_mfma_f32_16x16x32_bf16 v[56:59], a[228:231], a[112:115], v[56:59]
    v_mfma_f32_16x16x32_bf16 v[64:67], a[228:231], a[136:139], v[64:67]
    v_mfma_f32_16x16x32_bf16 v[72:75], a[228:231], a[160:163], v[72:75]
    v_mfma_f32_16x16x32_bf16 v[80:83], a[228:231], a[184:187], v[80:83]
    v_mfma_f32_16x16x32_bf16 v[88:91], a[228:231], a[208:211], v[88:91]
    s_add_u32 s20, s20, 12032
    ds_read_b64_tr_b16 a[220:221], v4 offset:18432
    v_mfma_f32_16x16x32_bf16 v[56:59], a[232:235], a[116:119], v[56:59]
    ds_read_b64_tr_b16 a[222:223], v4 offset:12288
    v_mfma_f32_16x16x32_bf16 v[64:67], a[232:235], a[140:143], v[64:67]
    ds_read_b64_tr_b16 a[224:225], v5 offset:18432
    v_mfma_f32_16x16x32_bf16 v[72:75], a[232:235], a[164:167], v[72:75]
    ds_read_b64_tr_b16 a[226:227], v5 offset:12288
    v_mfma_f32_16x16x32_bf16 v[80:83], a[232:235], a[188:191], v[80:83]
    v_mfma_f32_16x16x32_bf16 v[88:91], a[232:235], v[92:95], v[88:91]
    v_mbcnt_lo_u32_b32 v104, -1, 0
    s_waitcnt lgkmcnt(4)
    v_mfma_f32_16x16x32_bf16 v[112:115], a[212:215], v[16:19], v[112:115]
    v_max3_f32 v96, v52, v53, v54
    v_max3_f32 v96, v96, v55, v56
    v_max3_f32 v96, v96, v57, v58
    v_max_f32 v96, v96, v59
    v_mov_b32 v97, v96
    v_mfma_f32_16x16x32_bf16 v[116:119], a[216:219], v[16:19], v[116:119]
    s_mov_b32 s67, s34
    v_mbcnt_hi_u32_b32 v104, -1, v104
    v_permlane32_swap_b32 v97, v96
    v_max_f32 v96, v96, v97
    v_mov_b32 v97, v96
    v_mfma_f32_16x16x32_bf16 v[164:167], a[216:219], v[22:25], v[164:167]
    s_nop 0
    v_permlane16_swap_b32 v97, v96
    v_rcp_f32 v50, v50
    v_max_f32 v96, v96, v97
    v_mul_f32_e64 v9, -s28, v96
    v_lshrrev_b32 v106, 5, v104
    v_mfma_f32_16x16x32_bf16 v[160:163], a[212:215], v[22:25], v[160:163]
    s_add_u32 s18, s34, 30720
    ds_read_b64_tr_b16 a[232:233], v3 offset:19456
    v_max3_f32 v96, v60, v61, v62
    v_max3_f32 v96, v96, v63, v64
    v_max3_f32 v96, v96, v65, v66
    v_bfe_u32 v105, v104, 3, 1
    v_mfma_f32_16x16x32_bf16 v[208:211], a[212:215], v[28:31], v[208:211]
    s_mov_b32 s34, s33
    v_max_f32 v96, v96, v67
    v_mov_b32 v97, v96
    v_mfma_f32_16x16x32_bf16 v[212:215], a[216:219], v[28:31], v[212:215]
    s_add_u32 s64, s64, s62
    v_rcp_f32 v49, v49
    v_mov_b32 v100, v48
    v_mfma_f32_16x16x32_bf16 a[4:7], a[216:219], v[34:37], a[4:7]
    ds_read_b64_tr_b16 a[228:229], v2 offset:19456
    v_permlane32_swap_b32 v97, v96
    v_mfma_f32_16x16x32_bf16 a[0:3], a[212:215], v[34:37], a[0:3]
    s_add_u32 s64, s64, 196608
    v_max_f32 v96, v96, v97
    v_mov_b32 v97, v96
    v_mfma_f32_16x16x32_bf16 a[48:51], a[212:215], v[40:43], a[48:51]
    s_mov_b32 s39, s64
    v_permlane16_swap_b32 v97, v96
    v_max_f32 v96, v96, v97
    v_mfma_f32_16x16x32_bf16 a[52:55], a[216:219], v[40:43], a[52:55]
    s_waitcnt lgkmcnt(2)
    ds_read_b64_tr_b16 a[230:231], v2 offset:13312
    v_mul_f32_e64 v10, -s28, v96
    v_max3_f32 v96, v68, v69, v70
    v_mfma_f32_16x16x32_bf16 a[56:59], a[220:223], v[40:43], a[56:59]
    v_max3_f32 v96, v96, v71, v72
    v_max3_f32 v96, v96, v73, v74
    v_max_f32 v96, v96, v75
    v_mov_b32 v97, v96
    v_mfma_f32_16x16x32_bf16 a[60:63], a[224:227], v[40:43], a[60:63]
    s_add_u32 s37, s37, 1
    ds_read_b64_tr_b16 a[234:235], v3 offset:13312
    v_permlane32_swap_b32 v97, v96
    v_mfma_f32_16x16x32_bf16 a[12:15], a[224:227], v[34:37], a[12:15]
    s_bitcmp1_b32 s63, s37
    ds_read_b64_tr_b16 a[218:219], v5 offset:13312
    v_max_f32 v96, v96, v97
    v_mov_b32 v97, v96
    v_mfma_f32_16x16x32_bf16 a[8:11], a[220:223], v[34:37], a[8:11]
    s_nop 0
    v_permlane16_swap_b32 v97, v96
    v_mfma_f32_16x16x32_bf16 v[216:219], a[220:223], v[28:31], v[216:219]
    s_cselect_b32 s62, 4294770688, 0
    v_max_f32 v96, v96, v97
    v_mul_f32_e64 v11, -s28, v96
    v_fma_f32 v66, v66, s28, v10
    v_max3_f32 v96, v76, v77, v78
    v_max3_f32 v96, v96, v79, v80
    v_max3_f32 v96, v96, v81, v82
    v_xor_b32 v106, v106, v105
    v_max_f32 v96, v96, v83
    v_mfma_f32_16x16x32_bf16 v[220:223], a[224:227], v[28:31], v[220:223]
    s_cselect_b32 s42, 0, 325632
    v_and_b32 v107, 3, v104
    v_mov_b32 v97, v96
    v_mfma_f32_16x16x32_bf16 v[172:175], a[224:227], v[22:25], v[172:175]
    s_add_u32 s35, s35, s42
    ds_read_b64_tr_b16 a[212:213], v4 offset:19456
    v_fma_f32 v62, v62, s28, v10
    v_permlane32_swap_b32 v97, v96
    v_lshl_or_b32 v106, v107, 1, v106
    v_permlane32_swap_b32 v48, v100
    v_mfma_f32_16x16x32_bf16 v[168:171], a[220:223], v[22:25], v[168:171]
    s_lshl_b32 s42, s37, 1
    v_max_f32 v96, v96, v97
    v_mul_f32 v167, v167, v49
    v_fma_f32 v61, v61, s28, v10
    v_mfma_f32_16x16x32_bf16 v[120:123], a[220:223], v[16:19], v[120:123]
    s_lshr_b32 s42, s31, s42
    ds_read_b64_tr_b16 a[214:215], v4 offset:13312
    v_exp_f32 v62, v62
    v_mov_b32 v97, v96
    v_mfma_f32_16x16x32_bf16 v[124:127], a[224:227], v[16:19], v[124:127]
    s_and_b32 s42, s42, 3
    ds_read_b64_tr_b16 a[216:217], v5 offset:19456
    v_fma_f32 v55, v55, s28, v9
    s_waitcnt lgkmcnt(3)
    v_mfma_f32_16x16x32_bf16 v[128:131], a[228:231], v[16:19], v[128:131]
    s_add_u32 s42, s42, s36
    v_permlane16_swap_b32 v97, v96
    v_mfma_f32_16x16x32_bf16 v[132:135], a[232:235], v[16:19], v[132:135]
    s_sub_u32 s43, s42, 3
    ds_read_b64_tr_b16 a[220:221], v2 offset:20480
    v_fma_f32 v70, v70, s28, v11
    v_fma_f32 v63, v63, s28, v10
    v_max_f32 v96, v96, v97
    v_fma_f32 v72, v72, s28, v11
    v_xor_b32 v105, s65, v105
    v_mul_f32_e64 v12, -s28, v96
    v_max3_f32 v96, v84, v85, v86
    v_mfma_f32_16x16x32_bf16 v[180:183], a[232:235], v[22:25], v[180:183]
    s_cmp_ge_u32 s42, 3
    v_mul_f32 v171, v171, v49
    v_fma_f32 v68, v68, s28, v11
    v_fma_f32 v57, v57, s28, v9
    v_fma_f32 v59, v59, s28, v9
    v_fma_f32 v82, v82, s28, v12
    v_mfma_f32_16x16x32_bf16 v[176:179], a[228:231], v[22:25], v[176:179]
    s_cselect_b32 s42, s43, s42
    v_lshl_add_u32 v101, v105, 10, s38
    v_max3_f32 v96, v96, v87, v88
    v_mfma_f32_16x16x32_bf16 v[224:227], a[228:231], v[28:31], v[224:227]
    s_mul_i32 s44, s3, 5
    ds_read_b64_tr_b16 a[224:225], v3 offset:20480
    v_max3_f32 v96, v96, v89, v90
    v_mfma_f32_16x16x32_bf16 v[228:231], a[232:235], v[28:31], v[228:231]
    s_mov_b32 s32, 1
    v_fma_f32 v78, v78, s28, v12
    v_fma_f32 v81, v81, s28, v12
    v_mfma_f32_16x16x32_bf16 a[20:23], a[232:235], v[34:37], a[20:23]
    s_lshl_b32 s43, s3, 2
    ds_read_b64_tr_b16 a[222:223], v2 offset:14336
    v_rcp_f32 v48, v48
    v_mfma_f32_16x16x32_bf16 a[16:19], a[228:231], v[34:37], a[16:19]
    s_add_u32 s45, s43, 21
    v_accvgpr_read_b32 v108, a48
    v_fma_f32 v54, v54, s28, v9
    v_mfma_f32_16x16x32_bf16 a[64:67], a[228:231], v[40:43], a[64:67]
    s_cmp_eq_u32 s3, 0
    ds_read_b64_tr_b16 a[230:231], v4 offset:14336
    v_mul_f32 v161, v161, v49
    v_mfma_f32_16x16x32_bf16 a[68:71], a[232:235], v[40:43], a[68:71]
    s_waitcnt lgkmcnt(3)
    ds_read_b64_tr_b16 a[226:227], v3 offset:14336
    v_and_b32 v107, 7, v104
    v_mfma_f32_16x16x32_bf16 a[72:75], a[212:215], v[40:43], a[72:75]
    s_cselect_b32 s45, 20, s45
    v_max_f32 v96, v96, v91
    v_fma_f32 v53, v53, s28, v9
    v_mfma_f32_16x16x32_bf16 a[76:79], a[216:219], v[40:43], a[76:79]
    s_cselect_b32 s33, 1, 0
    ds_read_b64_tr_b16 a[228:229], v4 offset:20480
    v_fma_f32 v69, v69, s28, v11
    v_mfma_f32_16x16x32_bf16 a[28:31], a[216:219], v[34:37], a[28:31]
    s_cmp_eq_u32 s42, 1
    v_mul_f32 v169, v169, v49
    s_cselect_b32 s44, s45, s44
    v_mfma_f32_16x16x32_bf16 a[24:27], a[212:215], v[34:37], a[24:27]
    s_cselect_b32 s32, s33, s32
    v_fma_f32 v75, v75, s28, v11
    v_exp_f32 v61, v61
    v_mfma_f32_16x16x32_bf16 v[232:235], a[212:215], v[28:31], v[232:235]
    s_add_u32 s45, s43, 37
    v_mov_b32 v97, v96
    v_mul_f32 v164, v164, v49
    v_mfma_f32_16x16x32_bf16 v[236:239], a[216:219], v[28:31], v[236:239]
    s_cmp_eq_u32 s42, 2
    v_fma_f32 v71, v71, s28, v11
    v_permlane32_swap_b32 v97, v96
    v_mfma_f32_16x16x32_bf16 v[188:191], a[216:219], v[22:25], v[188:191]
    s_cselect_b32 s44, s45, s44
    ds_read_b64_tr_b16 a[234:235], v5 offset:14336
    v_fma_f32 v65, v65, s28, v10
    v_mfma_f32_16x16x32_bf16 v[184:187], a[212:215], v[22:25], v[184:187]
    s_cselect_b32 s32, 0, s32
    v_mul_f32 v172, v172, v49
    v_max_f32 v96, v96, v97
    v_exp_f32 v72, v72
    v_fma_f32 v80, v80, s28, v12
    v_exp_f32 v63, v63
    v_pk_mul_f32 v[212:213], v[212:213], v[50:51] op_sel_hi:[1,0]
    s_mul_i32 s44, s44, 6144
    v_mul_f32 v185, v185, v49
    v_mfma_f32_16x16x32_bf16 v[136:139], a[212:215], v[16:19], v[136:139]
    s_add_u32 s33, s35, s44
    ds_read_b64_tr_b16 a[232:233], v5 offset:20480
    v_lshl_add_u32 v101, v106, 4, v101
    v_mfma_f32_16x16x32_bf16 v[140:143], a[216:219], v[16:19], v[140:143]
    s_waitcnt lgkmcnt(2)
    v_exp_f32 v54, v54
    v_mul_f32 v176, v176, v49
    v_mfma_f32_16x16x32_bf16 v[144:147], a[220:223], v[16:19], v[144:147]
    s_mul_i32 s42, s32, 6144
    v_fma_f32 v76, v76, s28, v12
    v_mul_f32 v178, v178, v49
    v_exp_f32 v68, v68
    v_cvt_pk_bf16_f32 v21, v62, v63
    v_mfma_f32_16x16x32_bf16 v[148:151], a[224:227], v[16:19], v[148:151]
    s_add_u32 s42, s42, 24576
    v_exp_f32 v78, v78
    v_lshl_add_u32 v101, v107, 7, v101
    v_fma_f32 v60, v60, s28, v10
    v_mov_b32 v97, v96
    v_mfma_f32_16x16x32_bf16 v[196:199], a[224:227], v[22:25], v[196:199]
    s_add_u32 s42, s42, s33
    v_exp_f32 v53, v53
    v_mfma_f32_16x16x32_bf16 v[192:195], a[220:223], v[22:25], v[192:195]
    s_cmp_ge_u32 s37, 6
    v_permlane16_swap_b32 v97, v96
    v_fma_f32 v77, v77, s28, v12
    v_accvgpr_read_b32 v105, a1
    v_mfma_f32_16x16x32_bf16 v[240:243], a[220:223], v[28:31], v[240:243]
    s_cselect_b32 s14, 0, s42
    v_mul_f32 v160, v160, v49
    v_fma_f32 v52, v52, s28, v9
    v_mfma_f32_16x16x32_bf16 v[244:247], a[224:227], v[28:31], v[244:247]
    s_add_u32 s24, s67, 256
    v_mul_f32 v183, v183, v49
    v_exp_f32 v69, v69
    v_mfma_f32_16x16x32_bf16 a[36:39], a[224:227], v[34:37], a[36:39]
    s_add_u32 s25, s33, 256
    v_exp_f32 v52, v52
    v_fma_f32 v74, v74, s28, v11
    v_mfma_f32_16x16x32_bf16 a[32:35], a[220:223], v[34:37], a[32:35]
    s_add_u32 s23, s38, 4096
    v_exp_f32 v70, v70
    v_mfma_f32_16x16x32_bf16 a[80:83], a[220:223], v[40:43], a[80:83]
    s_mov_b32 s27, 0x49249249
    v_exp_f32 v71, v71
    v_mfma_f32_16x16x32_bf16 a[84:87], a[224:227], v[40:43], a[84:87]
    s_mov_b32 s30, 0
    v_max_f32 v96, v96, v97
    v_fma_f32 v79, v79, s28, v12
    v_mfma_f32_16x16x32_bf16 a[88:91], a[228:231], v[40:43], a[88:91]
    s_waitcnt vmcnt(8) lgkmcnt(0)
    v_exp_f32 v60, v60
    v_mul_f32_e64 v13, -s28, v96
    v_fma_f32 v86, v86, s28, v13
    v_mfma_f32_16x16x32_bf16 a[92:95], a[232:235], v[40:43], a[92:95]
    s_barrier
    ds_read_b128 a[216:219], v1 offset:12288
    v_mfma_f32_16x16x32_bf16 a[44:47], a[232:235], v[34:37], a[44:47]
    ds_read_b128 a[220:223], v0 offset:13312
    v_mul_f32 v197, v197, v49
    v_mul_f32 v186, v186, v49
    v_mfma_f32_16x16x32_bf16 a[40:43], a[228:231], v[34:37], a[40:43]
    v_mul_f32 v173, v173, v49
    v_exp_f32 v66, v66
    v_fma_f32 v91, v91, s28, v13
    v_bfe_u32 v107, v104, 4, 1
    v_fma_f32 v64, v64, s28, v10
    v_mfma_f32_16x16x32_bf16 v[248:251], a[228:231], v[28:31], v[248:251]
    ds_read_b128 a[212:215], v0 offset:12288
    v_exp_f32 v55, v55
    v_fma_f32 v58, v58, s28, v9
    v_exp_f32 v91, v91
    v_fma_f32 v85, v85, s28, v13
    v_pk_mul_f32 v[116:117], v[116:117], v[48:49] op_sel_hi:[1,0]
    v_exp_f32 v79, v79
    v_pk_mul_f32 v[112:113], v[112:113], v[48:49] op_sel_hi:[1,0]
    v_exp_f32 v86, v86
    v_fma_f32 v67, v67, s28, v10
    v_lshl_add_u32 v101, v107, 3, v101
    v_fma_f32 v87, v87, s28, v13
    v_mfma_f32_16x16x32_bf16 v[252:255], a[232:235], v[28:31], v[252:255]
    v_mul_f32 v190, v190, v49
    v_exp_f32 v80, v80
    v_cvt_pk_bf16_f32 v14, v52, v53
    v_rcp_f32 v51, v51
    v_mfma_f32_16x16x32_bf16 v[204:207], a[232:235], v[22:25], v[204:207]
    v_cvt_pk_bf16_f32 v15, v54, v55
    v_cvt_pk_bf16_f32 v26, v68, v69
    v_mul_f32 v165, v165, v49
    v_mfma_f32_16x16x32_bf16 v[200:203], a[228:231], v[22:25], v[200:203]
    v_exp_f32 v76, v76
    v_exp_f32 v67, v67
    v_mul_f32 v194, v194, v49
    v_mfma_f32_16x16x32_bf16 v[152:155], a[228:231], v[16:19], v[152:155]
    v_exp_f32 v77, v77
    v_cvt_pk_bf16_f32 v20, v60, v61
    v_mul_f32 v184, v184, v49
    v_mfma_f32_16x16x32_bf16 v[156:159], a[232:235], v[16:19], v[156:159]
    s_waitcnt lgkmcnt(0)
    v_fma_f32 v83, v83, s28, v12
    v_exp_f32 v65, v65
    v_mul_f32 v199, v199, v49
    v_mfma_f32_16x16x32_bf16 v[52:55], a[212:215], a[96:99], 0
    v_accvgpr_read_b32 v107, a3
    v_fma_f32 v88, v88, s28, v13
    v_mfma_f32_16x16x32_bf16 v[52:55], a[216:219], a[100:103], v[52:55]
    ds_read_b128 a[232:235], v1 offset:14336
    v_fma_f32 v56, v56, s28, v9
    v_cvt_pk_bf16_f32 v27, v70, v71
    v_cvt_pk_bf16_f32 v184, v184, v185
    v_mfma_f32_16x16x32_bf16 v[52:55], a[220:223], a[104:107], v[52:55]
    v_exp_f32 v74, v74
    v_mfma_f32_16x16x32_bf16 v[60:63], a[220:223], a[128:131], 0
    ds_read_b128 a[224:227], v1 offset:13312
    v_fma_f32 v90, v90, s28, v13
    v_mov_b32 v104, v100
    v_cvt_pk_bf16_f32 v33, v78, v79
    v_mfma_f32_16x16x32_bf16 v[60:63], a[216:219], a[124:127], v[60:63]
    s_add_u32 m0, s22, 36864
    ds_read_b128 a[228:231], v0 offset:14336
    v_exp_f32 v57, v57
    v_exp_f32 v75, v75
    v_mfma_f32_16x16x32_bf16 v[60:63], a[212:215], a[120:123], v[60:63]
    v_fma_f32 v84, v84, s28, v13
    v_exp_f32 v84, v84
    v_cvt_pk_bf16_f32 v32, v76, v77
    v_mul_f32 v182, v182, v49
    v_mfma_f32_16x16x32_bf16 v[68:71], a[212:215], a[144:147], 0
    v_exp_f32 v87, v87
    v_fma_f32 v73, v73, s28, v11
    v_mfma_f32_16x16x32_bf16 v[68:71], a[216:219], a[148:151], v[68:71]
    v_mul_f32 v163, v163, v49
    v_exp_f32 v85, v85
    v_cvt_pk_bf16_f32 v160, v160, v161
    v_mfma_f32_16x16x32_bf16 v[68:71], a[220:223], a[152:155], v[68:71]
    v_cvt_pk_bf16_f32 v39, v86, v87
    v_cvt_pk_bf16_f32 v38, v84, v85
    v_mfma_f32_16x16x32_bf16 v[76:79], a[220:223], a[176:179], 0
    buffer_load_dwordx4 v6, s[8:11], s21 offen lds
    v_permlane16_swap_b32 v100, v104
    v_mfma_f32_16x16x32_bf16 v[76:79], a[216:219], a[172:175], v[76:79]
    v_mul_f32 v201, v201, v49
    v_exp_f32 v81, v81
    v_mfma_f32_16x16x32_bf16 v[76:79], a[212:215], a[168:171], v[76:79]
    s_add_u32 s21, s21, 128
    v_mul_f32 v168, v168, v49
    v_cvt_pk_bf16_f32 v168, v168, v169
    v_mfma_f32_16x16x32_bf16 v[84:87], a[212:215], a[192:195], 0
    v_rcp_f32 v100, v100
    v_exp_f32 v90, v90
    v_mfma_f32_16x16x32_bf16 v[84:87], a[216:219], a[196:199], v[84:87]
    ds_read_b128 a[212:215], v0 offset:18432
    v_mul_f32 v198, v198, v49
    v_cvt_pk_bf16_f32 v34, v80, v81
    v_accvgpr_read_b32 v111, a51
    v_accvgpr_read_b32 v109, a49
    v_mfma_f32_16x16x32_bf16 v[84:87], a[220:223], a[200:203], v[84:87]
    s_waitcnt lgkmcnt(1)
    v_exp_f32 v59, v59
    v_exp_f32 v64, v64
    v_mfma_f32_16x16x32_bf16 v[84:87], a[224:227], a[204:207], v[84:87]
    v_mul_f32 v187, v187, v49
    v_accvgpr_read_b32 v104, a0
    v_mfma_f32_16x16x32_bf16 v[84:87], a[228:231], a[208:211], v[84:87]
    v_mul_f32 v107, v107, v51
    v_cvt_pk_bf16_f32 v112, v112, v113
    v_mfma_f32_16x16x32_bf16 v[84:87], a[232:235], v[92:95], v[84:87]
    v_exp_f32 v82, v82
    v_mfma_f32_16x16x32_bf16 v[76:79], a[232:235], a[188:191], v[76:79]
    s_add_u32 m0, s22, 37888
    v_mul_f32 v179, v179, v49
    v_mul_f32 v188, v188, v49
    v_mfma_f32_16x16x32_bf16 v[76:79], a[228:231], a[184:187], v[76:79]
    v_cvt_pk_bf16_f32 v23, v66, v67
    v_exp_f32 v83, v83
    v_mfma_f32_16x16x32_bf16 v[76:79], a[224:227], a[180:183], v[76:79]
    v_exp_f32 v56, v56
    v_mfma_f32_16x16x32_bf16 v[68:71], a[224:227], a[156:159], v[68:71]
    v_fma_f32 v89, v89, s28, v13
    v_mul_f32 v177, v177, v49
    v_mfma_f32_16x16x32_bf16 v[68:71], a[228:231], a[160:163], v[68:71]
    ds_read_b128 a[220:223], v0 offset:19456
    v_cvt_pk_bf16_f32 v35, v82, v83
    v_mul_f32 v193, v193, v49
    v_mfma_f32_16x16x32_bf16 v[68:71], a[232:235], a[164:167], v[68:71]
    v_cvt_pk_bf16_f32 v41, v90, v91
    v_fma_f32 v79, v79, s28, v12
    v_mfma_f32_16x16x32_bf16 v[60:63], a[232:235], a[140:143], v[60:63]
    ds_read_b128 a[216:219], v1 offset:18432
    buffer_load_dwordx4 v6, s[8:11], s21 offen lds
    v_mfma_f32_16x16x32_bf16 v[60:63], a[228:231], a[136:139], v[60:63]
    v_fma_f32 v78, v78, s28, v12
    v_accvgpr_read_b32 v110, a50
    v_exp_f32 v73, v73
    v_mfma_f32_16x16x32_bf16 v[60:63], a[224:227], a[132:135], v[60:63]
    v_exp_f32 v58, v58
    v_mfma_f32_16x16x32_bf16 v[52:55], a[224:227], a[108:111], v[52:55]
    v_mul_f32 v170, v170, v49
    v_exp_f32 v88, v88
    v_mul_f32 v162, v162, v49
    v_mfma_f32_16x16x32_bf16 v[52:55], a[228:231], a[112:115], v[52:55]
    ds_read_b128 a[228:231], v0 offset:20480
    v_cvt_pk_bf16_f32 v22, v64, v65
    v_exp_f32 v78, v78
    v_cvt_pk_bf16_f32 v172, v172, v173
    v_pk_mul_f32 v[208:209], v[208:209], v[50:51] op_sel_hi:[1,0]
    v_pk_mul_f32 v[118:119], v[118:119], v[48:49] op_sel_hi:[1,0]
    v_pk_mul_f32 v[120:121], v[120:121], v[48:49] op_sel_hi:[1,0]
    v_cvt_pk_bf16_f32 v116, v116, v117
    v_mul_f32 v104, v104, v51
    v_cvt_pk_bf16_f32 v161, v162, v163
    v_exp_f32 v89, v89
    v_pk_mul_f32 v[236:237], v[236:237], v[50:51] op_sel_hi:[1,0]
    v_cvt_pk_bf16_f32 v212, v212, v213
    v_accvgpr_read_b32 v106, a2
    v_pk_mul_f32 v[210:211], v[210:211], v[50:51] op_sel_hi:[1,0]
    v_pk_mul_f32 v[124:125], v[124:125], v[48:49] op_sel_hi:[1,0]
    v_pk_mul_f32 v[218:219], v[218:219], v[50:51] op_sel_hi:[1,0]
    v_cvt_pk_bf16_f32 v16, v56, v57
    v_pk_mul_f32 v[220:221], v[220:221], v[50:51] op_sel_hi:[1,0]
    v_pk_mul_f32 v[110:111], v[110:111], v[100:101] op_sel_hi:[1,0]
    v_pk_mul_f32 v[250:251], v[250:251], v[50:51] op_sel_hi:[1,0]
    v_pk_mul_f32 v[232:233], v[232:233], v[50:51] op_sel_hi:[1,0]
    v_fma_f32 v70, v70, s28, v11
    v_cvt_pk_bf16_f32 v17, v58, v59
    v_fma_f32 v60, v60, s28, v10
    v_cvt_pk_bf16_f32 v176, v176, v177
    v_pk_mul_f32 v[140:141], v[140:141], v[48:49] op_sel_hi:[1,0]
    v_pk_mul_f32 v[230:231], v[230:231], v[50:51] op_sel_hi:[1,0]
    v_mul_f32 v203, v203, v49
    v_pk_mul_f32 v[114:115], v[114:115], v[48:49] op_sel_hi:[1,0]
    v_mul_f32 v106, v106, v51
    v_fma_f32 v63, v63, s28, v10
    v_pk_mul_f32 v[214:215], v[214:215], v[50:51] op_sel_hi:[1,0]
    v_pk_mul_f32 v[108:109], v[108:109], v[100:101] op_sel_hi:[1,0]
    v_mul_f32 v105, v105, v51
    v_cvt_pk_bf16_f32 v108, v108, v109
    v_cvt_pk_bf16_f32 v28, v72, v73
    v_cvt_pk_bf16_f32 v124, v124, v125
    v_mul_f32 v166, v166, v49
    v_mul_f32 v195, v195, v49
    v_mfma_f32_16x16x32_bf16 v[44:47], a[236:239], v[14:17], 0
    v_fma_f32 v84, v84, s28, v13
    v_cvt_pk_bf16_f32 v40, v88, v89
    v_mfma_f32_16x16x32_bf16 v[52:55], a[232:235], a[116:119], v[52:55]
    s_waitcnt lgkmcnt(0)
    v_cvt_pk_bf16_f32 v208, v208, v209
    v_mul_f32 v205, v205, v49
    v_mfma_f32_16x16x32_bf16 v[56:59], a[212:215], a[96:99], 0
    ds_read_b128 a[224:227], v1 offset:19456
    v_cvt_pk_bf16_f32 v29, v74, v75
    v_cvt_pk_bf16_f32 v232, v232, v233
    v_cvt_pk_bf16_f32 v164, v164, v165
    v_cvt_pk_bf16_f32 v236, v236, v237
    v_pk_mul_f32 v[216:217], v[216:217], v[50:51] op_sel_hi:[1,0]
    v_pk_mul_f32 v[248:249], v[248:249], v[50:51] op_sel_hi:[1,0]
    v_pk_mul_f32 v[132:133], v[132:133], v[48:49] op_sel_hi:[1,0]
    v_pk_mul_f32 v[228:229], v[228:229], v[50:51] op_sel_hi:[1,0]
    v_cvt_pk_bf16_f32 v213, v214, v215
    v_fma_f32 v61, v61, s28, v10
    v_mfma_f32_16x16x32_bf16 v[56:59], a[216:219], a[100:103], v[56:59]
    ds_read_b128 a[232:235], v1 offset:20480
    v_fma_f32 v77, v77, s28, v12
    v_mfma_f32_16x16x32_bf16 v[56:59], a[220:223], a[104:107], v[56:59]
    v_cvt_pk_bf16_f32 v109, v110, v111
    v_accvgpr_read_b32 v110, a54
    v_mfma_f32_16x16x32_bf16 v[64:67], a[220:223], a[128:131], 0
    s_add_u32 s21, s21, 128
    v_exp_f32 v77, v77
    v_mfma_f32_16x16x32_bf16 v[64:67], a[216:219], a[124:127], v[64:67]
    v_cvt_pk_bf16_f32 v113, v114, v115
    v_fma_f32 v71, v71, s28, v11
    v_cvt_pk_bf16_f32 v104, v104, v105
    v_subrev_u32 v8, 28672, v8
    v_mfma_f32_16x16x32_bf16 v[64:67], a[212:215], a[120:123], v[64:67]
    s_add_u32 m0, s22, 38912
    v_exp_f32 v61, v61
    v_mfma_f32_16x16x32_bf16 v[72:75], a[212:215], a[144:147], 0
    v_exp_f32 v84, v84
    v_cvt_pk_bf16_f32 v209, v210, v211
    v_fma_f32 v69, v69, s28, v11
    v_mfma_f32_16x16x32_bf16 v[72:75], a[216:219], a[148:151], v[72:75]
    ds_write2st64_b64 v101, v[112:113], v[160:161] offset0:0 offset1:12
    v_mfma_f32_16x16x32_bf16 v[72:75], a[220:223], a[152:155], v[72:75]
    buffer_load_dwordx4 v6, s[8:11], s21 offen lds
    v_mfma_f32_16x16x32_bf16 v[80:83], a[220:223], a[176:179], 0
    s_add_u32 s21, s21, 12032
    v_cvt_pk_bf16_f32 v105, v106, v107
    v_fma_f32 v76, v76, s28, v12
    v_mfma_f32_16x16x32_bf16 v[80:83], a[216:219], a[172:175], v[80:83]
    s_waitcnt vmcnt(6) lgkmcnt(1)
    v_cvt_pk_bf16_f32 v177, v178, v179
    v_cvt_pk_bf16_f32 v117, v118, v119
    v_mfma_f32_16x16x32_bf16 v[80:83], a[212:215], a[168:171], v[80:83]
    s_barrier
    v_mul_f32 v202, v202, v49
    v_exp_f32 v63, v63
    v_mfma_f32_16x16x32_bf16 v[88:91], a[212:215], a[192:195], 0
    ds_read_b64_tr_b16 a[212:213], v2 offset:0
    v_fma_f32 v68, v68, s28, v11
    v_mfma_f32_16x16x32_bf16 v[88:91], a[216:219], a[196:199], v[88:91]
    v_mul_f32 v189, v189, v49
    v_cvt_pk_bf16_f32 v216, v216, v217
    v_mfma_f32_16x16x32_bf16 v[88:91], a[220:223], a[200:203], v[88:91]
    s_add_u32 m0, s22, 12288
    ds_write2st64_b64 v101, v[208:209], v[104:105] offset0:24 offset1:36
    v_fma_f32 v52, v52, s28, v9
    v_mfma_f32_16x16x32_bf16 v[44:47], a[240:243], v[20:23], v[44:47]
    ds_write_b64 v101, v[108:109] offset:24576
    v_fma_f32 v53, v53, s28, v9
    v_accvgpr_read_b32 v107, a7
    v_pk_mul_f32 v[144:145], v[144:145], v[48:49] op_sel_hi:[1,0]
    v_pk_mul_f32 v[136:137], v[136:137], v[48:49] op_sel_hi:[1,0]
    v_pk_mul_f32 v[244:245], v[244:245], v[50:51] op_sel_hi:[1,0]
    v_cvt_pk_bf16_f32 v169, v170, v171
    v_xor_b32 v101, 32, v101
    v_accvgpr_read_b32 v105, a5
    v_mfma_f32_16x16x32_bf16 v[88:91], a[224:227], a[204:207], v[88:91]
    v_cvt_pk_bf16_f32 v185, v186, v187
    v_accvgpr_read_b32 v104, a4
    v_cvt_pk_bf16_f32 v120, v120, v121
    v_mfma_f32_16x16x32_bf16 v[88:91], a[228:231], a[208:211], v[88:91]
    v_exp_f32 v79, v79
    v_mul_f32 v105, v105, v51
    v_mfma_f32_16x16x32_bf16 v[88:91], a[232:235], v[92:95], v[88:91]
    ds_read_b64_tr_b16 a[214:215], v2 offset:6144
    v_mul_f32 v104, v104, v51
    v_accvgpr_read_b32 v109, a53
    v_mfma_f32_16x16x32_bf16 v[80:83], a[232:235], a[188:191], v[80:83]
    v_mul_f32 v192, v192, v49
    v_mul_f32 v174, v174, v49
    v_mfma_f32_16x16x32_bf16 v[80:83], a[228:231], a[184:187], v[80:83]
    v_accvgpr_read_b32 v106, a6
    v_mul_f32 v106, v106, v51
    v_mfma_f32_16x16x32_bf16 v[80:83], a[224:227], a[180:183], v[80:83]
    v_cvt_pk_bf16_f32 v140, v140, v141
    v_fma_f32 v90, v90, s28, v13
    v_mfma_f32_16x16x32_bf16 v[72:75], a[224:227], a[156:159], v[72:75]
    ds_read_b64_tr_b16 a[216:217], v3 offset:0
    v_cvt_pk_bf16_f32 v165, v166, v167
    v_accvgpr_read_b32 v108, a52
    v_mfma_f32_16x16x32_bf16 v[72:75], a[228:231], a[160:163], v[72:75]
    ds_read_b64_tr_b16 a[218:219], v3 offset:6144
    v_fma_f32 v62, v62, s28, v10
    v_mfma_f32_16x16x32_bf16 v[72:75], a[232:235], a[164:167], v[72:75]
    ds_read_b64_tr_b16 a[220:221], v4 offset:0
    buffer_load_dwordx4 v6, s[4:7], s20 offen lds
    v_mfma_f32_16x16x32_bf16 v[64:67], a[232:235], a[140:143], v[64:67]
    ds_write2st64_b64 v101, v[116:117], v[164:165] offset0:0 offset1:12
    v_pk_mul_f32 v[240:241], v[240:241], v[50:51] op_sel_hi:[1,0]
    v_mul_f32 v200, v200, v49
    v_pk_mul_f32 v[126:127], v[126:127], v[48:49] op_sel_hi:[1,0]
    v_pk_mul_f32 v[122:123], v[122:123], v[48:49] op_sel_hi:[1,0]
    v_pk_mul_f32 v[154:155], v[154:155], v[48:49] op_sel_hi:[1,0]
    v_pk_mul_f32 v[152:153], v[152:153], v[48:49] op_sel_hi:[1,0]
    v_cvt_pk_bf16_f32 v104, v104, v105
    v_pk_mul_f32 v[128:129], v[128:129], v[48:49] op_sel_hi:[1,0]
    v_pk_mul_f32 v[108:109], v[108:109], v[100:101] op_sel_hi:[1,0]
    v_accvgpr_read_b32 v111, a55
    v_mul_f32 v107, v107, v51
    v_cvt_pk_bf16_f32 v105, v106, v107
    v_fma_f32 v55, v55, s28, v9
    v_fma_f32 v80, v80, s28, v12
    v_pk_mul_f32 v[224:225], v[224:225], v[50:51] op_sel_hi:[1,0]
    v_pk_mul_f32 v[110:111], v[110:111], v[100:101] op_sel_hi:[1,0]
    v_exp_f32 v68, v68
    v_cvt_pk_bf16_f32 v217, v218, v219
    v_mfma_f32_16x16x32_bf16 v[64:67], a[228:231], a[136:139], v[64:67]
    ds_read_b64_tr_b16 a[222:223], v4 offset:6144
    v_cvt_pk_bf16_f32 v108, v108, v109
    v_mfma_f32_16x16x32_bf16 v[64:67], a[224:227], a[132:135], v[64:67]
    s_add_u32 s20, s20, 128
    ds_write2st64_b64 v101, v[212:213], v[104:105] offset0:24 offset1:36
    v_cvt_pk_bf16_f32 v121, v122, v123
    v_fma_f32 v75, v75, s28, v11
    v_mfma_f32_16x16x32_bf16 v[56:59], a[224:227], a[108:111], v[56:59]
    v_exp_f32 v71, v71
    v_cvt_pk_bf16_f32 v109, v110, v111
    v_exp_f32 v60, v60
    v_pk_mul_f32 v[222:223], v[222:223], v[50:51] op_sel_hi:[1,0]
    v_cvt_pk_bf16_f32 v220, v220, v221
    v_exp_f32 v62, v62
    v_pk_mul_f32 v[138:139], v[138:139], v[48:49] op_sel_hi:[1,0]
    v_accvgpr_read_b32 v110, a58
    v_cvt_pk_bf16_f32 v192, v192, v193
    v_mfma_f32_16x16x32_bf16 v[44:47], a[244:247], v[26:29], v[44:47]
    ds_read_b64_tr_b16 a[224:225], v5 offset:0
    v_accvgpr_read_b32 v105, a9
    v_accvgpr_read_b32 v107, a11
    v_mfma_f32_16x16x32_bf16 v[56:59], a[228:231], a[112:115], v[56:59]
    s_add_u32 m0, s22, 13312
    ds_read_b64_tr_b16 a[226:227], v5 offset:6144
    buffer_load_dwordx4 v6, s[4:7], s20 offen lds
    v_accvgpr_read_b32 v104, a8
    v_cvt_pk_bf16_f32 v248, v248, v249
    v_mfma_f32_16x16x32_bf16 v[56:59], a[232:235], a[116:119], v[56:59]
    s_waitcnt lgkmcnt(3)
    v_cvt_pk_bf16_f32 v221, v222, v223
    v_mul_f32 v175, v175, v49
    v_mfma_f32_16x16x32_bf16 v[112:115], a[212:215], v[14:17], 0
    ds_write_b64 v101, v[108:109] offset:24576
    v_mul_f32 v104, v104, v51
    v_cvt_pk_bf16_f32 v188, v188, v189
    v_mfma_f32_16x16x32_bf16 v[116:119], a[216:219], v[14:17], 0
    ds_read_b64_tr_b16 a[228:229], v2 offset:1024
    v_accvgpr_read_b32 v106, a10
    v_accvgpr_read_b32 v109, a57
    v_mfma_f32_16x16x32_bf16 v[164:167], a[216:219], v[20:23], 0
    v_mul_f32 v105, v105, v51
    v_fma_f32 v88, v88, s28, v13
    v_mfma_f32_16x16x32_bf16 v[44:47], a[248:251], v[32:35], v[44:47]
    ds_read_b64_tr_b16 a[230:231], v2 offset:7168
    v_cvt_pk_bf16_f32 v128, v128, v129
    v_mfma_f32_16x16x32_bf16 v[160:163], a[212:215], v[20:23], 0
    v_fma_f32 v64, v64, s28, v10
    v_accvgpr_read_b32 v108, a56
    v_accvgpr_read_b32 v111, a59
    v_cvt_pk_bf16_f32 v104, v104, v105
    v_mul_f32 v191, v191, v49
    v_pk_mul_f32 v[238:239], v[238:239], v[50:51] op_sel_hi:[1,0]
    v_pk_mul_f32 v[242:243], v[242:243], v[50:51] op_sel_hi:[1,0]
    v_pk_mul_f32 v[108:109], v[108:109], v[100:101] op_sel_hi:[1,0]
    v_mul_f32 v106, v106, v51
    v_xor_b32 v101, 96, v101
    v_pk_mul_f32 v[148:149], v[148:149], v[48:49] op_sel_hi:[1,0]
    v_mul_f32 v107, v107, v51
    v_cvt_pk_bf16_f32 v108, v108, v109
    v_pk_mul_f32 v[110:111], v[110:111], v[100:101] op_sel_hi:[1,0]
    v_cvt_pk_bf16_f32 v105, v106, v107
    v_accvgpr_read_b32 v107, a15
    v_accvgpr_read_b32 v106, a14
    v_mfma_f32_16x16x32_bf16 v[208:211], a[212:215], v[26:29], 0
    v_exp_f32 v53, v53
    v_cvt_pk_bf16_f32 v109, v110, v111
    v_mfma_f32_16x16x32_bf16 v[212:215], a[216:219], v[26:29], 0
    ds_write2st64_b64 v101, v[120:121], v[168:169] offset0:0 offset1:12
    v_mfma_f32_16x16x32_bf16 a[4:7], a[216:219], v[32:35], 0
    ds_write2st64_b64 v101, v[216:217], v[104:105] offset0:24 offset1:36
    v_mfma_f32_16x16x32_bf16 a[0:3], a[212:215], v[32:35], 0
    ds_write_b64 v101, v[108:109] offset:24576
    v_mul_f32 v107, v107, v51
    v_accvgpr_read_b32 v105, a13
    v_pk_mul_f32 v[134:135], v[134:135], v[48:49] op_sel_hi:[1,0]
    v_cvt_pk_bf16_f32 v240, v240, v241
    v_mul_f32 v181, v181, v49
    v_cvt_pk_bf16_f32 v125, v126, v127
    v_mul_f32 v180, v180, v49
    v_pk_mul_f32 v[130:131], v[130:131], v[48:49] op_sel_hi:[1,0]
    v_mul_f32 v106, v106, v51
    v_accvgpr_read_b32 v111, a63
    v_mul_f32 v204, v204, v49
    v_fma_f32 v87, v87, s28, v13
    v_cvt_pk_bf16_f32 v180, v180, v181
    v_mfma_f32_16x16x32_bf16 a[48:51], a[212:215], v[38:41], 0
    ds_read_b64_tr_b16 a[234:235], v3 offset:7168
    v_cvt_pk_bf16_f32 v173, v174, v175
    v_accvgpr_read_b32 v110, a62
    v_cvt_pk_bf16_f32 v237, v238, v239
    v_fma_f32 v59, v59, s28, v9
    v_accvgpr_read_b32 v104, a12
    v_xor_b32 v101, 32, v101
    v_cvt_pk_bf16_f32 v228, v228, v229
    v_exp_f32 v64, v64
    v_mul_f32 v104, v104, v51
    v_cvt_pk_bf16_f32 v136, v136, v137
    v_cvt_pk_bf16_f32 v224, v224, v225
    v_pk_mul_f32 v[110:111], v[110:111], v[100:101] op_sel_hi:[1,0]
    v_pk_mul_f32 v[226:227], v[226:227], v[50:51] op_sel_hi:[1,0]
    v_pk_mul_f32 v[234:235], v[234:235], v[50:51] op_sel_hi:[1,0]
    v_pk_mul_f32 v[146:147], v[146:147], v[48:49] op_sel_hi:[1,0]
    v_mul_f32 v105, v105, v51
    v_exp_f32 v52, v52
    v_accvgpr_read_b32 v108, a60
    v_mfma_f32_16x16x32_bf16 a[52:55], a[216:219], v[38:41], 0
    s_add_u32 s20, s20, 128
    ds_read_b64_tr_b16 a[216:217], v5 offset:1024
    v_cvt_pk_bf16_f32 v204, v204, v205
    v_accvgpr_read_b32 v109, a61
    v_exp_f32 v69, v69
    v_cvt_pk_bf16_f32 v129, v130, v131
    v_pk_mul_f32 v[108:109], v[108:109], v[100:101] op_sel_hi:[1,0]
    v_exp_f32 v87, v87
    v_cvt_pk_bf16_f32 v108, v108, v109
    v_mfma_f32_16x16x32_bf16 a[56:59], a[220:223], v[38:41], 0
    s_waitcnt lgkmcnt(2)
    ds_read_b64_tr_b16 a[232:233], v3 offset:1024
    v_fma_f32 v82, v82, s28, v12
    v_fma_f32 v56, v56, s28, v9
    v_mfma_f32_16x16x32_bf16 a[60:63], a[224:227], v[38:41], 0
    ds_read_b64_tr_b16 a[218:219], v5 offset:7168
    v_cvt_pk_bf16_f32 v137, v138, v139
    v_cvt_pk_bf16_f32 v104, v104, v105
    v_mfma_f32_16x16x32_bf16 a[12:15], a[224:227], v[32:35], 0
    ds_write2st64_b64 v101, v[124:125], v[172:173] offset0:0 offset1:12
    v_cvt_pk_bf16_f32 v105, v106, v107
    v_mfma_f32_16x16x32_bf16 a[8:11], a[220:223], v[32:35], 0
    ds_write2st64_b64 v101, v[220:221], v[104:105] offset0:24 offset1:36
    v_accvgpr_read_b32 v106, a18
    v_cvt_pk_bf16_f32 v109, v110, v111
    v_mul_f32 v106, v106, v51
    v_accvgpr_read_b32 v107, a19
    v_accvgpr_read_b32 v105, a17
    v_mul_f32 v105, v105, v51
    v_mfma_f32_16x16x32_bf16 v[216:219], a[220:223], v[26:29], 0
    ds_write_b64 v101, v[108:109] offset:24576
    v_mul_f32 v206, v206, v49
    v_xor_b32 v101, 96, v101
    v_accvgpr_read_b32 v104, a16
    v_cvt_pk_bf16_f32 v233, v234, v235
    v_accvgpr_read_b32 v109, a65
    v_mul_f32 v196, v196, v49
    v_fma_f32 v73, v73, s28, v11
    v_mul_f32 v104, v104, v51
    v_cvt_pk_bf16_f32 v148, v148, v149
    v_accvgpr_read_b32 v111, a67
    v_fma_f32 v54, v54, s28, v9
    v_cvt_pk_bf16_f32 v132, v132, v133
    v_cvt_pk_bf16_f32 v104, v104, v105
    v_accvgpr_read_b32 v110, a66
    v_mul_f32 v107, v107, v51
    v_accvgpr_read_b32 v108, a64
    v_cvt_pk_bf16_f32 v105, v106, v107
    v_mfma_f32_16x16x32_bf16 v[220:223], a[224:227], v[26:29], 0
    ds_read_b128 v[96:99], v8 offset:0
    v_cvt_pk_bf16_f32 v225, v226, v227
    v_mfma_f32_16x16x32_bf16 v[172:175], a[224:227], v[20:23], 0
    ds_write2st64_b64 v101, v[128:129], v[176:177] offset0:4 offset1:16
    v_pk_mul_f32 v[156:157], v[156:157], v[48:49] op_sel_hi:[1,0]
    v_cvt_pk_bf16_f32 v244, v244, v245
    v_mul_f32 v207, v207, v49
    v_pk_mul_f32 v[108:109], v[108:109], v[100:101] op_sel_hi:[1,0]
    v_accvgpr_read_b32 v107, a23
    v_accvgpr_read_b32 v106, a22
    v_mfma_f32_16x16x32_bf16 v[168:171], a[220:223], v[20:23], 0
    ds_write2st64_b64 v101, v[224:225], v[104:105] offset0:28 offset1:40
    v_mul_f32 v107, v107, v51
    v_cvt_pk_bf16_f32 v108, v108, v109
    v_pk_mul_f32 v[110:111], v[110:111], v[100:101] op_sel_hi:[1,0]
    v_pk_mul_f32 v[246:247], v[246:247], v[50:51] op_sel_hi:[1,0]
    v_accvgpr_read_b32 v105, a21
    v_fma_f32 v81, v81, s28, v12
    v_cvt_pk_bf16_f32 v109, v110, v111
    v_accvgpr_read_b32 v104, a20
    v_accvgpr_read_b32 v111, a71
    v_cvt_pk_bf16_f32 v144, v144, v145
    v_mul_f32 v105, v105, v51
    v_mfma_f32_16x16x32_bf16 v[120:123], a[220:223], v[14:17], 0
    s_add_u32 m0, s22, 14336
    ds_write_b64 v101, v[108:109] offset:26624
    v_mul_f32 v104, v104, v51
    v_mul_f32 v106, v106, v51
    v_accvgpr_read_b32 v108, a68
    v_cvt_pk_bf16_f32 v133, v134, v135
    v_accvgpr_read_b32 v109, a69
    v_mfma_f32_16x16x32_bf16 v[124:127], a[224:227], v[14:17], 0
    ds_read_b64_tr_b16 a[224:225], v3 offset:2048
    v_cvt_pk_bf16_f32 v229, v230, v231
    v_cvt_pk_bf16_f32 v104, v104, v105
    v_cvt_pk_bf16_f32 v105, v106, v107
    v_xor_b32 v101, 32, v101
    v_exp_f32 v54, v54
    v_pk_mul_f32 v[142:143], v[142:143], v[48:49] op_sel_hi:[1,0]
    v_accvgpr_read_b32 v110, a70
    v_pk_mul_f32 v[108:109], v[108:109], v[100:101] op_sel_hi:[1,0]
    v_pk_mul_f32 v[110:111], v[110:111], v[100:101] op_sel_hi:[1,0]
    v_cvt_pk_bf16_f32 v108, v108, v109
    v_cvt_pk_bf16_f32 v181, v182, v183
    v_cvt_pk_bf16_f32 v193, v194, v195
    v_mfma_f32_16x16x32_bf16 v[128:131], a[228:231], v[14:17], 0
    s_waitcnt lgkmcnt(2)
    ds_write2st64_b64 v101, v[132:133], v[180:181] offset0:4 offset1:16
    v_mfma_f32_16x16x32_bf16 v[132:135], a[232:235], v[14:17], 0
    ds_write2st64_b64 v101, v[228:229], v[104:105] offset0:28 offset1:40
    v_accvgpr_read_b32 v107, a27
    v_cvt_pk_bf16_f32 v109, v110, v111
    v_accvgpr_read_b32 v106, a26
    v_accvgpr_read_b32 v104, a24
    v_accvgpr_read_b32 v105, a25
    v_mul_f32 v106, v106, v51
    v_mfma_f32_16x16x32_bf16 v[180:183], a[232:235], v[20:23], 0
    buffer_load_dwordx4 v6, s[4:7], s20 offen lds
    ds_write_b64 v101, v[108:109] offset:26624
    v_fma_f32 v67, v67, s28, v10
    v_xor_b32 v101, 96, v101
    v_accvgpr_read_b32 v111, a75
    v_accvgpr_read_b32 v109, a73
    v_accvgpr_read_b32 v110, a74
    v_accvgpr_read_b32 v108, a72
    v_mul_f32 v104, v104, v51
    v_fma_f32 v58, v58, s28, v9
    v_cvt_pk_bf16_f32 v18, v52, v53
    v_pk_mul_f32 v[158:159], v[158:159], v[48:49] op_sel_hi:[1,0]
    v_mul_f32 v105, v105, v51
    v_pk_mul_f32 v[108:109], v[108:109], v[100:101] op_sel_hi:[1,0]
    v_fma_f32 v85, v85, s28, v13
    v_pk_mul_f32 v[110:111], v[110:111], v[100:101] op_sel_hi:[1,0]
    v_cvt_pk_bf16_f32 v104, v104, v105
    v_cvt_pk_bf16_f32 v108, v108, v109
    v_fma_f32 v86, v86, s28, v13
    v_mfma_f32_16x16x32_bf16 v[176:179], a[228:231], v[20:23], 0
    s_add_u32 s20, s20, 12032
    ds_read_b64_tr_b16 a[212:213], v4 offset:1024
    ds_read_b64_tr_b16 a[214:215], v4 offset:7168
    v_mul_f32 v107, v107, v51
    v_cvt_pk_bf16_f32 v105, v106, v107
    v_mfma_f32_16x16x32_bf16 v[224:227], a[228:231], v[26:29], 0
    ds_write2st64_b64 v101, v[136:137], v[184:185] offset0:4 offset1:16
    v_accvgpr_read_b32 v106, a30
    v_cvt_pk_bf16_f32 v109, v110, v111
    v_mfma_f32_16x16x32_bf16 v[228:231], a[232:235], v[26:29], 0
    ds_write2st64_b64 v101, v[232:233], v[104:105] offset0:28 offset1:40
    v_mul_f32 v106, v106, v51
    v_fma_f32 v89, v89, s28, v13
    v_accvgpr_read_b32 v107, a31
    v_mfma_f32_16x16x32_bf16 v[44:47], a[252:255], v[38:41], v[44:47]
    ds_read_b64_tr_b16 a[222:223], v2 offset:8192
    v_cvt_pk_bf16_f32 v152, v152, v153
    v_accvgpr_read_b32 v104, a28
    v_accvgpr_read_b32 v105, a29
    v_mfma_f32_16x16x32_bf16 a[20:23], a[232:235], v[32:35], 0
    ds_write_b64 v101, v[108:109] offset:26624
    v_mfma_f32_16x16x32_bf16 a[16:19], a[228:231], v[32:35], 0
    ds_read_b64_tr_b16 a[226:227], v3 offset:8192
    v_accvgpr_read_b32 v109, a77
    v_cvt_pk_bf16_f32 v189, v190, v191
    v_mul_f32 v105, v105, v51
    v_mfma_f32_16x16x32_bf16 a[64:67], a[228:231], v[38:41], 0
    ds_read_b64_tr_b16 a[228:229], v4 offset:2048
    v_mul_f32 v107, v107, v51
    v_mfma_f32_16x16x32_bf16 a[68:71], a[232:235], v[38:41], 0
    s_waitcnt lgkmcnt(5)
    ds_read_b64_tr_b16 a[220:221], v2 offset:2048
    ds_read_b64_tr_b16 a[234:235], v5 offset:8192
    v_accvgpr_read_b32 v108, a76
    v_mfma_f32_16x16x32_bf16 a[72:75], a[212:215], v[38:41], 0
    ds_read_b64_tr_b16 a[232:233], v5 offset:2048
    ds_read_b64_tr_b16 a[230:231], v4 offset:8192
    v_fma_f32 v57, v57, s28, v9
    v_accvgpr_read_b32 v111, a79
    v_accvgpr_read_b32 v110, a78
    v_xor_b32 v101, 32, v101
    v_exp_f32 v58, v58
    v_mul_f32 v104, v104, v51
    v_pk_mul_f32 v[108:109], v[108:109], v[100:101] op_sel_hi:[1,0]
    v_cvt_pk_bf16_f32 v249, v250, v251
    v_cvt_pk_bf16_f32 v104, v104, v105
    v_cvt_pk_bf16_f32 v141, v142, v143
    v_cvt_pk_bf16_f32 v108, v108, v109
    v_cvt_pk_bf16_f32 v105, v106, v107
    v_mfma_f32_16x16x32_bf16 a[76:79], a[216:219], v[38:41], 0
    s_add_u32 s39, s39, 12288
    ds_write2st64_b64 v101, v[140:141], v[188:189] offset0:4 offset1:16
    v_mfma_f32_16x16x32_bf16 a[28:31], a[216:219], v[32:35], 0
    ds_write2st64_b64 v101, v[236:237], v[104:105] offset0:28 offset1:40
    v_cvt_pk_bf16_f32 v196, v196, v197
    v_exp_f32 v55, v55
    v_cvt_pk_bf16_f32 v25, v62, v63
    v_pk_mul_f32 v[110:111], v[110:111], v[100:101] op_sel_hi:[1,0]
    v_cvt_pk_bf16_f32 v145, v146, v147
    v_accvgpr_read_b32 v104, a32
    v_mul_f32 v104, v104, v51
    v_cvt_pk_bf16_f32 v109, v110, v111
    v_mfma_f32_16x16x32_bf16 a[24:27], a[212:215], v[32:35], 0
    s_waitcnt vmcnt(6) lgkmcnt(2)
    ds_write_b64 v101, v[108:109] offset:26624
    v_mfma_f32_16x16x32_bf16 v[232:235], a[212:215], v[26:29], 0
    buffer_store_dwordx4 v[96:99], v102, s[16:19], s67 offen offset:0 nt
    s_barrier
    ds_read_b128 v[96:99], v8 offset:1024
    v_accvgpr_read_b32 v110, a82
    v_cvt_pk_bf16_f32 v197, v198, v199
    v_accvgpr_read_b32 v109, a81
    v_accvgpr_read_b32 v106, a34
    v_accvgpr_read_b32 v111, a83
    v_pk_mul_f32 v[110:111], v[110:111], v[100:101] op_sel_hi:[1,0]
    v_exp_f32 v86, v86
    v_accvgpr_read_b32 v108, a80
    v_pk_mul_f32 v[108:109], v[108:109], v[100:101] op_sel_hi:[1,0]
    v_xor_b32 v101, 96, v101
    v_accvgpr_read_b32 v105, a33
    v_mfma_f32_16x16x32_bf16 v[236:239], a[216:219], v[26:29], 0
    v_mul_f32 v105, v105, v51
    v_cvt_pk_bf16_f32 v37, v78, v79
    v_cvt_pk_bf16_f32 v24, v60, v61
    v_accvgpr_read_b32 v107, a35
    v_cvt_pk_bf16_f32 v104, v104, v105
    v_cvt_pk_bf16_f32 v19, v54, v55
    v_mul_f32 v107, v107, v51
    v_mul_f32 v106, v106, v51
    v_cvt_pk_bf16_f32 v105, v106, v107
    v_accvgpr_read_b32 v107, a39
    v_cvt_pk_bf16_f32 v108, v108, v109
    v_cvt_pk_bf16_f32 v109, v110, v111
    v_mfma_f32_16x16x32_bf16 v[188:191], a[216:219], v[20:23], 0
    ds_write2st64_b64 v101, v[144:145], v[192:193] offset0:8 offset1:20
    v_cvt_pk_bf16_f32 v241, v242, v243
    v_cvt_pk_bf16_f32 v200, v200, v201
    v_cvt_pk_bf16_f32 v43, v86, v87
    v_cvt_pk_bf16_f32 v153, v154, v155
    v_cvt_pk_bf16_f32 v201, v202, v203
    v_mfma_f32_16x16x32_bf16 v[184:187], a[212:215], v[20:23], 0
    s_add_u32 m0, s22, 24576
    ds_write2st64_b64 v101, v[240:241], v[104:105] offset0:32 offset1:44
    v_mfma_f32_16x16x32_bf16 v[136:139], a[212:215], v[14:17], 0
    buffer_load_dwordx4 v6, s[8:11], s21 offen lds
    ds_write_b64 v101, v[108:109] offset:0
    v_accvgpr_read_b32 v106, a38
    v_accvgpr_read_b32 v104, a36
    v_accvgpr_read_b32 v111, a87
    v_pk_mul_f32 v[150:151], v[150:151], v[48:49] op_sel_hi:[1,0]
    v_accvgpr_read_b32 v109, a85
    v_accvgpr_read_b32 v108, a84
    v_mul_f32 v107, v107, v51
    v_mul_f32 v106, v106, v51
    v_accvgpr_read_b32 v105, a37
    v_cvt_pk_bf16_f32 v156, v156, v157
    v_mul_f32 v104, v104, v51
    v_mfma_f32_16x16x32_bf16 v[140:143], a[216:219], v[14:17], 0
    s_waitcnt lgkmcnt(3)
    buffer_store_dwordx4 v[96:99], v103, s[16:19], s67 offen offset:0 nt
    s_add_u32 s21, s21, 128
    v_mul_f32 v105, v105, v51
    v_cvt_pk_bf16_f32 v245, v246, v247
    v_accvgpr_read_b32 v110, a86
    v_cvt_pk_bf16_f32 v104, v104, v105
    v_pk_mul_f32 v[254:255], v[254:255], v[50:51] op_sel_hi:[1,0]
    v_pk_mul_f32 v[108:109], v[108:109], v[100:101] op_sel_hi:[1,0]
    v_cvt_pk_bf16_f32 v149, v150, v151
    v_pk_mul_f32 v[110:111], v[110:111], v[100:101] op_sel_hi:[1,0]
    v_cvt_pk_bf16_f32 v105, v106, v107
    v_cvt_pk_bf16_f32 v205, v206, v207
    v_pk_mul_f32 v[252:253], v[252:253], v[50:51] op_sel_hi:[1,0]
    v_xor_b32 v101, 32, v101
    v_accvgpr_read_b32 v107, a43
    v_mfma_f32_16x16x32_bf16 v[144:147], a[220:223], v[14:17], 0
    s_add_u32 m0, s22, 25600
    ds_write2st64_b64 v101, v[148:149], v[196:197] offset0:8 offset1:20
    v_cvt_pk_bf16_f32 v252, v252, v253
    v_cvt_pk_bf16_f32 v108, v108, v109
    v_mfma_f32_16x16x32_bf16 v[148:151], a[224:227], v[14:17], 0
    buffer_load_dwordx4 v6, s[8:11], s21 offen lds
    ds_write2st64_b64 v101, v[244:245], v[104:105] offset0:32 offset1:44
    v_cvt_pk_bf16_f32 v109, v110, v111
    v_mfma_f32_16x16x32_bf16 v[196:199], a[224:227], v[20:23], 0
    ds_read_b128 a[212:215], v0 offset:0
    v_accvgpr_read_b32 v104, a40
    v_mfma_f32_16x16x32_bf16 v[192:195], a[220:223], v[20:23], 0
    ds_write_b64 v101, v[108:109] offset:0
    v_accvgpr_read_b32 v105, a41
    v_accvgpr_read_b32 v106, a42
    v_mfma_f32_16x16x32_bf16 v[240:243], a[220:223], v[26:29], 0
    s_add_u32 s21, s21, 128
    ds_read_b128 v[96:99], v8 offset:2048
    v_mul_f32 v106, v106, v51
    v_mfma_f32_16x16x32_bf16 v[244:247], a[224:227], v[26:29], 0
    v_mul_f32 v105, v105, v51
    v_accvgpr_read_b32 v108, a88
    v_accvgpr_read_b32 v109, a89
    v_accvgpr_read_b32 v110, a90
    v_xor_b32 v101, 96, v101
    v_mul_f32 v107, v107, v51
    v_mul_f32 v104, v104, v51
    v_accvgpr_read_b32 v111, a91
    v_pk_mul_f32 v[108:109], v[108:109], v[100:101] op_sel_hi:[1,0]
    v_cvt_pk_bf16_f32 v104, v104, v105
    v_cvt_pk_bf16_f32 v108, v108, v109
    v_mfma_f32_16x16x32_bf16 a[36:39], a[224:227], v[32:35], 0
    ds_write2st64_b64 v101, v[152:153], v[200:201] offset0:8 offset1:20
    v_pk_mul_f32 v[110:111], v[110:111], v[100:101] op_sel_hi:[1,0]
    v_cvt_pk_bf16_f32 v105, v106, v107
    v_accvgpr_read_b32 v106, a46
    v_mfma_f32_16x16x32_bf16 a[32:35], a[220:223], v[32:35], 0
    ds_write2st64_b64 v101, v[248:249], v[104:105] offset0:32 offset1:44
    v_accvgpr_read_b32 v104, a44
    v_accvgpr_read_b32 v107, a47
    v_mfma_f32_16x16x32_bf16 a[80:83], a[220:223], v[38:41], 0
    s_add_u32 m0, s22, 26624
    v_accvgpr_read_b32 v105, a45
    v_mul_f32 v105, v105, v51
    v_cvt_pk_bf16_f32 v109, v110, v111
    v_fma_f32 v66, v66, s28, v10
    v_mul_f32 v104, v104, v51
    v_accvgpr_read_b32 v111, a95
    v_exp_f32 v56, v56
    v_mfma_f32_16x16x32_bf16 a[84:87], a[224:227], v[38:41], 0
    buffer_load_dwordx4 v6, s[8:11], s21 offen lds
    ds_write_b64 v101, v[108:109] offset:0
    v_cvt_pk_bf16_f32 v104, v104, v105
    v_accvgpr_read_b32 v110, a94
    v_accvgpr_read_b32 v109, a93
    v_accvgpr_read_b32 v108, a92
    v_mfma_f32_16x16x32_bf16 a[88:91], a[228:231], v[38:41], 0
    v_mul_f32 v107, v107, v51
    v_mul_f32 v106, v106, v51
    v_cvt_pk_bf16_f32 v105, v106, v107
    v_exp_f32 v57, v57
    v_mfma_f32_16x16x32_bf16 a[92:95], a[232:235], v[38:41], 0
    s_add_u32 s21, s21, 12032
    ds_read_b128 a[216:219], v1 offset:0
    v_cvt_pk_bf16_f32 v157, v158, v159
    v_mfma_f32_16x16x32_bf16 a[44:47], a[232:235], v[32:35], 0
    s_add_u32 s56, s67, 128
    ds_read_b128 a[220:223], v0 offset:1024
    v_cvt_pk_bf16_f32 v253, v254, v255
    v_xor_b32 v101, 32, v101
    v_mfma_f32_16x16x32_bf16 a[40:43], a[228:231], v[32:35], 0
    s_add_u32 s58, s33, 128
    ds_write2st64_b64 v101, v[156:157], v[204:205] offset0:8 offset1:20
    v_mfma_f32_16x16x32_bf16 v[248:251], a[228:231], v[26:29], 0
    ds_write2st64_b64 v101, v[252:253], v[104:105] offset0:32 offset1:44
    v_mfma_f32_16x16x32_bf16 v[252:255], a[232:235], v[26:29], 0
    s_add_u32 m0, s38, 2048
    v_exp_f32 v76, v76
    v_mfma_f32_16x16x32_bf16 v[204:207], a[232:235], v[20:23], 0
    v_cvt_pk_bf16_f32 v36, v76, v77
    v_fma_f32 v74, v74, s28, v11
    v_mfma_f32_16x16x32_bf16 v[200:203], a[228:231], v[20:23], 0
    v_exp_f32 v70, v70
    v_mfma_f32_16x16x32_bf16 v[152:155], a[228:231], v[14:17], 0
    s_waitcnt lgkmcnt(4)
    ds_read_b128 a[224:227], v1 offset:1024
    buffer_load_dwordx4 v6, s[12:15], s58 offen nt lds
    v_mfma_f32_16x16x32_bf16 v[156:159], a[232:235], v[14:17], 0
    buffer_store_dwordx4 v[96:99], v102, s[16:19], s56 offen offset:0 nt
    v_fma_f32 v65, v65, s28, v10
    v_pk_mul_f32 v[110:111], v[110:111], v[100:101] op_sel_hi:[1,0]
    v_pk_mul_f32 v[108:109], v[108:109], v[100:101] op_sel_hi:[1,0]
    v_fma_f32 v72, v72, s28, v11
    v_exp_f32 v85, v85
    v_mfma_f32_16x16x32_bf16 v[52:55], a[212:215], a[96:99], 0
    s_waitcnt lgkmcnt(2)
    ds_read_b128 v[96:99], v8 offset:3072
    v_cvt_pk_bf16_f32 v108, v108, v109
    v_mfma_f32_16x16x32_bf16 v[52:55], a[216:219], a[100:103], v[52:55]
    v_exp_f32 v65, v65
    v_mfma_f32_16x16x32_bf16 v[52:55], a[220:223], a[104:107], v[52:55]
    ds_read_b128 a[228:231], v0 offset:2048
    v_exp_f32 v72, v72
    v_mfma_f32_16x16x32_bf16 v[60:63], a[220:223], a[128:131], 0
    v_cvt_pk_bf16_f32 v30, v68, v69
    v_fma_f32 v83, v83, s28, v12
    v_mfma_f32_16x16x32_bf16 v[60:63], a[216:219], a[124:127], v[60:63]
    ds_read_b128 a[232:235], v1 offset:2048
    v_exp_f32 v74, v74
    v_mfma_f32_16x16x32_bf16 v[60:63], a[212:215], a[120:123], v[60:63]
    v_cvt_pk_bf16_f32 v31, v70, v71
    v_exp_f32 v82, v82
    v_mfma_f32_16x16x32_bf16 v[68:71], a[212:215], a[144:147], 0
    s_add_u32 m0, s38, 3072
    v_exp_f32 v66, v66
    v_mfma_f32_16x16x32_bf16 v[68:71], a[216:219], a[148:151], v[68:71]
    v_exp_f32 v59, v59
    v_mfma_f32_16x16x32_bf16 v[68:71], a[220:223], a[152:155], v[68:71]
    v_cvt_pk_bf16_f32 v109, v110, v111
    v_cvt_pk_bf16_f32 v42, v84, v85
    v_mfma_f32_16x16x32_bf16 v[76:79], a[220:223], a[176:179], 0
    v_exp_f32 v90, v90
    v_mfma_f32_16x16x32_bf16 v[76:79], a[216:219], a[172:175], v[76:79]
    v_fma_f32 v91, v91, s28, v13
    v_cvt_pk_bf16_f32 v17, v58, v59
    v_mfma_f32_16x16x32_bf16 v[76:79], a[212:215], a[168:171], v[76:79]
    v_exp_f32 v75, v75
    v_mfma_f32_16x16x32_bf16 v[84:87], a[212:215], a[192:195], 0
    v_exp_f32 v91, v91
    v_mfma_f32_16x16x32_bf16 v[84:87], a[216:219], a[196:199], v[84:87]
    v_exp_f32 v67, v67
    v_mfma_f32_16x16x32_bf16 v[84:87], a[220:223], a[200:203], v[84:87]
    s_waitcnt lgkmcnt(0)
    v_cvt_pk_bf16_f32 v29, v74, v75
    v_cvt_pk_bf16_f32 v16, v56, v57
    v_mfma_f32_16x16x32_bf16 v[84:87], a[224:227], a[204:207], v[84:87]
    buffer_load_dwordx4 v7, s[12:15], s58 offen nt lds
    v_mfma_f32_16x16x32_bf16 v[48:51], a[236:239], v[16:19], v[44:47]
    v_exp_f32 v81, v81
    v_mfma_f32_16x16x32_bf16 v[84:87], a[228:231], a[208:211], v[84:87]
    buffer_store_dwordx4 v[96:99], v103, s[16:19], s56 offen offset:0 nt
    ds_write_b64 v101, v[108:109] offset:0
    v_mfma_f32_16x16x32_bf16 v[84:87], a[232:235], v[92:95], v[84:87]
    v_exp_f32 v73, v73
    v_mfma_f32_16x16x32_bf16 v[76:79], a[232:235], a[188:191], v[76:79]
    ds_read_b128 v[96:99], v8 offset:0
    v_cvt_pk_bf16_f32 v22, v64, v65
    v_mfma_f32_16x16x32_bf16 v[76:79], a[228:231], a[184:187], v[76:79]
    v_exp_f32 v80, v80
    v_mfma_f32_16x16x32_bf16 v[76:79], a[224:227], a[180:183], v[76:79]
    v_cvt_pk_bf16_f32 v28, v72, v73
    v_cvt_pk_bf16_f32 v23, v66, v67
    v_mfma_f32_16x16x32_bf16 v[68:71], a[224:227], a[156:159], v[68:71]
    v_exp_f32 v88, v88
    v_mfma_f32_16x16x32_bf16 v[68:71], a[228:231], a[160:163], v[68:71]
    s_add_u32 s57, s67, 24832
    v_exp_f32 v89, v89
    v_mfma_f32_16x16x32_bf16 v[48:51], a[240:243], v[22:25], v[48:51]
    s_add_u32 m0, s38, 0
    v_exp_f32 v83, v83
    v_mfma_f32_16x16x32_bf16 v[48:51], a[244:247], v[28:31], v[48:51]
    ds_read_b128 a[212:215], v0 offset:6144
    v_cvt_pk_bf16_f32 v34, v80, v81
    v_mfma_f32_16x16x32_bf16 v[68:71], a[232:235], a[164:167], v[68:71]
    ds_read_b128 a[216:219], v1 offset:6144
    v_cvt_pk_bf16_f32 v40, v88, v89
    v_mfma_f32_16x16x32_bf16 v[60:63], a[232:235], a[140:143], v[60:63]
    v_cvt_pk_bf16_f32 v35, v82, v83
    v_cvt_pk_bf16_f32 v41, v90, v91
    v_mfma_f32_16x16x32_bf16 v[60:63], a[228:231], a[136:139], v[60:63]
    ds_read_b128 a[220:223], v0 offset:7168
    v_mfma_f32_16x16x32_bf16 v[48:51], a[248:251], v[34:37], v[48:51]
    v_mfma_f32_16x16x32_bf16 v[60:63], a[224:227], a[132:135], v[60:63]
    s_waitcnt lgkmcnt(3)
    buffer_load_dwordx4 v6, s[12:15], s33 offen nt lds
    v_mfma_f32_16x16x32_bf16 v[48:51], a[252:255], v[40:43], v[48:51]
    buffer_store_dwordx4 v[96:99], v102, s[16:19], s57 offen offset:0 nt
    s_nop 0
    ds_read_b128 v[96:99], v8 offset:1024
    v_mfma_f32_16x16x32_bf16 v[52:55], a[224:227], a[108:111], v[52:55]
    ds_read_b128 a[224:227], v1 offset:7168
    s_add_u32 m0, s38, 1024
    v_mfma_f32_16x16x32_bf16 v[52:55], a[228:231], a[112:115], v[52:55]
    s_nop 0
    v_cmp_lt_f32 vcc, s29, v48
    v_mfma_f32_16x16x32_bf16 v[52:55], a[232:235], a[116:119], v[52:55]
    s_waitcnt lgkmcnt(4)
    ds_read_b128 a[228:231], v0 offset:8192
    v_mfma_f32_16x16x32_bf16 v[56:59], a[212:215], a[96:99], 0
    s_waitcnt lgkmcnt(4)
    ds_read_b128 a[232:235], v1 offset:8192
    v_mfma_f32_16x16x32_bf16 v[56:59], a[216:219], a[100:103], v[56:59]
    s_waitcnt lgkmcnt(4)
    v_mfma_f32_16x16x32_bf16 v[56:59], a[220:223], a[104:107], v[56:59]
    s_cbranch_vccnz L_rs_tr55d
L_ret_tr55d:
    v_mfma_f32_16x16x32_bf16 v[64:67], a[220:223], a[128:131], 0
    v_fma_f32 v52, v52, s28, v9
    v_fma_f32 v54, v54, s28, v9
    v_mfma_f32_16x16x32_bf16 v[64:67], a[216:219], a[124:127], v[64:67]
    v_fma_f32 v60, v60, s28, v10
    v_fma_f32 v63, v63, s28, v10
    v_mfma_f32_16x16x32_bf16 v[64:67], a[212:215], a[120:123], v[64:67]
    v_exp_f32 v63, v63
    v_mfma_f32_16x16x32_bf16 v[72:75], a[212:215], a[144:147], 0
    s_waitcnt lgkmcnt(3)
    buffer_load_dwordx4 v7, s[12:15], s33 offen nt lds
    v_mfma_f32_16x16x32_bf16 v[72:75], a[216:219], a[148:151], v[72:75]
    v_exp_f32 v52, v52
    v_mfma_f32_16x16x32_bf16 v[72:75], a[220:223], a[152:155], v[72:75]
    buffer_store_dwordx4 v[96:99], v103, s[16:19], s57 offen offset:0 nt
    v_fma_f32 v62, v62, s28, v10
    s_waitcnt vmcnt(16) lgkmcnt(0)
    v_fma_f32 v61, v61, s28, v10
    v_mfma_f32_16x16x32_bf16 v[80:83], a[220:223], a[176:179], 0
    s_barrier
    v_mfma_f32_16x16x32_bf16 v[80:83], a[216:219], a[172:175], v[80:83]
    v_exp_f32 v62, v62
    v_mfma_f32_16x16x32_bf16 v[80:83], a[212:215], a[168:171], v[80:83]
    s_add_u32 m0, s22, 0
    v_exp_f32 v61, v61
    v_mfma_f32_16x16x32_bf16 v[88:91], a[212:215], a[192:195], 0
    v_fma_f32 v53, v53, s28, v9
    v_mfma_f32_16x16x32_bf16 v[88:91], a[216:219], a[196:199], v[88:91]
    ds_read_b64_tr_b16 a[212:213], v2 offset:18432
    v_mfma_f32_16x16x32_bf16 v[88:91], a[220:223], a[200:203], v[88:91]
    buffer_load_dwordx4 v6, s[4:7], s20 offen lds
    v_mfma_f32_16x16x32_bf16 v[88:91], a[224:227], a[204:207], v[88:91]
    s_add_u32 s20, s20, 128
    ds_read_b64_tr_b16 a[214:215], v2 offset:12288
    v_fma_f32 v55, v55, s28, v9
    v_mfma_f32_16x16x32_bf16 v[88:91], a[228:231], a[208:211], v[88:91]
    s_add_u32 m0, s22, 1024
    v_exp_f32 v54, v54
    v_mfma_f32_16x16x32_bf16 v[88:91], a[232:235], v[92:95], v[88:91]
    ds_read_b64_tr_b16 a[216:217], v3 offset:18432
    v_cvt_pk_bf16_f32 v21, v62, v63
    v_mfma_f32_16x16x32_bf16 v[80:83], a[232:235], a[188:191], v[80:83]
    ds_read_b64_tr_b16 a[218:219], v3 offset:12288
    v_mfma_f32_16x16x32_bf16 v[80:83], a[228:231], a[184:187], v[80:83]
    buffer_load_dwordx4 v6, s[4:7], s20 offen lds
    v_mfma_f32_16x16x32_bf16 v[80:83], a[224:227], a[180:183], v[80:83]
    s_add_u32 s20, s20, 128
    v_exp_f32 v55, v55
    v_mfma_f32_16x16x32_bf16 v[72:75], a[224:227], a[156:159], v[72:75]
    ds_read_b64_tr_b16 a[220:221], v4 offset:18432
    v_mfma_f32_16x16x32_bf16 v[72:75], a[228:231], a[160:163], v[72:75]
    v_exp_f32 v60, v60
    v_mfma_f32_16x16x32_bf16 v[72:75], a[232:235], a[164:167], v[72:75]
    v_exp_f32 v53, v53
    v_mfma_f32_16x16x32_bf16 v[64:67], a[232:235], a[140:143], v[64:67]
    v_mfma_f32_16x16x32_bf16 v[64:67], a[228:231], a[136:139], v[64:67]
    s_add_u32 m0, s22, 2048
    v_cvt_pk_bf16_f32 v20, v60, v61
    v_cvt_pk_bf16_f32 v15, v54, v55
    v_mfma_f32_16x16x32_bf16 v[64:67], a[224:227], a[132:135], v[64:67]
    buffer_load_dwordx4 v6, s[4:7], s20 offen lds
    v_mfma_f32_16x16x32_bf16 v[56:59], a[224:227], a[108:111], v[56:59]
    ds_read_b64_tr_b16 a[222:223], v4 offset:12288
    v_add_u32 v8, 4096, v8
    v_mfma_f32_16x16x32_bf16 v[56:59], a[228:231], a[112:115], v[56:59]
    ds_read_b64_tr_b16 a[224:225], v5 offset:18432
    v_cvt_pk_bf16_f32 v14, v52, v53
    v_mfma_f32_16x16x32_bf16 v[56:59], a[232:235], a[116:119], v[56:59]
    s_add_u32 s20, s20, 12032
    ds_read_b64_tr_b16 a[226:227], v5 offset:12288
    s_branch L_loop5
L_loop4:
    .p2align 6
L_loop4w0:
    s_waitcnt lgkmcnt(4)
    v_mfma_f32_16x16x32_bf16 v[112:115], a[212:215], v[16:19], v[112:115]
    ds_read_b64_tr_b16 a[230:231], v2 offset:13312
    v_mfma_f32_16x16x32_bf16 v[116:119], a[216:219], v[16:19], v[116:119]
    ds_read_b64_tr_b16 a[234:235], v3 offset:13312
    v_fma_f32 v72, v72, s28, v11
    v_mfma_f32_16x16x32_bf16 v[164:167], a[216:219], v[22:25], v[164:167]
    ds_read_b64_tr_b16 a[232:233], v3 offset:19456
    v_fma_f32 v66, v66, s28, v10
    v_mfma_f32_16x16x32_bf16 v[160:163], a[212:215], v[22:25], v[160:163]
    ds_read_b64_tr_b16 a[228:229], v2 offset:19456
    v_fma_f32 v58, v58, s28, v9
    v_mfma_f32_16x16x32_bf16 v[208:211], a[212:215], v[28:31], v[208:211]
    v_mfma_f32_16x16x32_bf16 v[212:215], a[216:219], v[28:31], v[212:215]
    v_fma_f32 v68, v68, s28, v11
    v_mfma_f32_16x16x32_bf16 a[4:7], a[216:219], v[34:37], a[4:7]
    ds_read_b64_tr_b16 a[216:217], v5 offset:19456
    v_fma_f32 v62, v62, s28, v10
    v_mfma_f32_16x16x32_bf16 a[0:3], a[212:215], v[34:37], a[0:3]
    v_fma_f32 v73, v73, s28, v11
    s_waitcnt lgkmcnt(5)
    v_mfma_f32_16x16x32_bf16 a[8:11], a[220:223], v[34:37], a[8:11]
    ds_read_b64_tr_b16 a[214:215], v4 offset:13312
    v_fma_f32 v81, v81, s28, v12
    v_mfma_f32_16x16x32_bf16 a[12:15], a[224:227], v[34:37], a[12:15]
    v_fma_f32 v64, v64, s28, v10
    v_fma_f32 v71, v71, s28, v11
    v_mfma_f32_16x16x32_bf16 v[220:223], a[224:227], v[28:31], v[220:223]
    ds_read_b64_tr_b16 a[218:219], v5 offset:13312
    v_mfma_f32_16x16x32_bf16 v[216:219], a[220:223], v[28:31], v[216:219]
    v_exp_f32 v62, v62
    v_mfma_f32_16x16x32_bf16 v[168:171], a[220:223], v[22:25], v[168:171]
    v_fma_f32 v77, v77, s28, v12
    v_fma_f32 v78, v78, s28, v12
    v_mfma_f32_16x16x32_bf16 v[172:175], a[224:227], v[22:25], v[172:175]
    ds_read_b64_tr_b16 a[212:213], v4 offset:19456
    v_fma_f32 v76, v76, s28, v12
    v_mfma_f32_16x16x32_bf16 v[124:127], a[224:227], v[16:19], v[124:127]
    v_exp_f32 v77, v77
    v_mfma_f32_16x16x32_bf16 v[120:123], a[220:223], v[16:19], v[120:123]
    s_waitcnt lgkmcnt(4)
    ds_read_b64_tr_b16 a[226:227], v3 offset:14336
    v_fma_f32 v75, v75, s28, v11
    v_mfma_f32_16x16x32_bf16 v[128:131], a[228:231], v[16:19], v[128:131]
    ds_read_b64_tr_b16 a[222:223], v2 offset:14336
    v_fma_f32 v70, v70, s28, v11
    v_mfma_f32_16x16x32_bf16 v[132:135], a[232:235], v[16:19], v[132:135]
    ds_read_b64_tr_b16 a[220:221], v2 offset:20480
    v_fma_f32 v79, v79, s28, v12
    v_mfma_f32_16x16x32_bf16 v[180:183], a[232:235], v[22:25], v[180:183]
    v_exp_f32 v58, v58
    v_mfma_f32_16x16x32_bf16 v[176:179], a[228:231], v[22:25], v[176:179]
    v_exp_f32 v78, v78
    v_mfma_f32_16x16x32_bf16 v[224:227], a[228:231], v[28:31], v[224:227]
    s_add_u32 s39, s39, 12288
    ds_read_b64_tr_b16 a[224:225], v3 offset:20480
    v_fma_f32 v83, v83, s28, v12
    v_mfma_f32_16x16x32_bf16 v[228:231], a[232:235], v[28:31], v[228:231]
    v_fma_f32 v56, v56, s28, v9
    v_fma_f32 v82, v82, s28, v12
    v_mfma_f32_16x16x32_bf16 a[20:23], a[232:235], v[34:37], a[20:23]
    ds_read_b64_tr_b16 a[232:233], v5 offset:20480
    v_fma_f32 v65, v65, s28, v10
    v_mfma_f32_16x16x32_bf16 a[16:19], a[228:231], v[34:37], a[16:19]
    s_waitcnt lgkmcnt(5)
    ds_read_b64_tr_b16 a[234:235], v5 offset:14336
    v_mfma_f32_16x16x32_bf16 a[24:27], a[212:215], v[34:37], a[24:27]
    ds_read_b64_tr_b16 a[230:231], v4 offset:14336
    v_fma_f32 v67, v67, s28, v10
    v_mfma_f32_16x16x32_bf16 a[28:31], a[216:219], v[34:37], a[28:31]
    v_exp_f32 v75, v75
    v_mfma_f32_16x16x32_bf16 v[236:239], a[216:219], v[28:31], v[236:239]
    ds_read_b64_tr_b16 a[228:229], v4 offset:20480
    v_fma_f32 v57, v57, s28, v9
    v_mfma_f32_16x16x32_bf16 v[232:235], a[212:215], v[28:31], v[232:235]
    v_fma_f32 v59, v59, s28, v9
    v_fma_f32 v69, v69, s28, v11
    v_mfma_f32_16x16x32_bf16 v[184:187], a[212:215], v[22:25], v[184:187]
    v_mfma_f32_16x16x32_bf16 v[188:191], a[216:219], v[22:25], v[188:191]
    v_exp_f32 v71, v71
    v_mfma_f32_16x16x32_bf16 v[140:143], a[216:219], v[16:19], v[140:143]
    v_fma_f32 v63, v63, s28, v10
    v_mfma_f32_16x16x32_bf16 v[136:139], a[212:215], v[16:19], v[136:139]
    s_waitcnt lgkmcnt(4)
    v_exp_f32 v64, v64
    v_mfma_f32_16x16x32_bf16 v[144:147], a[220:223], v[16:19], v[144:147]
    v_exp_f32 v69, v69
    v_mfma_f32_16x16x32_bf16 v[148:151], a[224:227], v[16:19], v[148:151]
    v_exp_f32 v76, v76
    v_mfma_f32_16x16x32_bf16 v[196:199], a[224:227], v[22:25], v[196:199]
    v_exp_f32 v68, v68
    v_mfma_f32_16x16x32_bf16 v[192:195], a[220:223], v[22:25], v[192:195]
    v_exp_f32 v79, v79
    v_mfma_f32_16x16x32_bf16 v[240:243], a[220:223], v[28:31], v[240:243]
    s_waitcnt vmcnt(10) lgkmcnt(0)
    v_exp_f32 v72, v72
    v_mfma_f32_16x16x32_bf16 v[244:247], a[224:227], v[28:31], v[244:247]
    s_barrier
    ds_read_b128 a[216:219], v1 offset:12288
    v_mfma_f32_16x16x32_bf16 a[36:39], a[224:227], v[34:37], a[36:39]
    ds_read_b128 a[212:215], v0 offset:12288
    v_fma_f32 v74, v74, s28, v11
    v_mfma_f32_16x16x32_bf16 a[32:35], a[220:223], v[34:37], a[32:35]
    s_add_u32 m0, s22, 36864
    ds_read_b128 a[220:223], v0 offset:13312
    v_mfma_f32_16x16x32_bf16 a[40:43], a[228:231], v[34:37], a[40:43]
    buffer_load_dwordx4 v6, s[8:11], s21 offen lds
    v_mfma_f32_16x16x32_bf16 a[44:47], a[232:235], v[34:37], a[44:47]
    s_add_u32 s21, s21, 128
    v_exp_f32 v65, v65
    v_mfma_f32_16x16x32_bf16 v[252:255], a[232:235], v[28:31], v[252:255]
    v_cvt_pk_bf16_f32 v33, v78, v79
    s_add_u32 m0, s22, 37888
    v_mfma_f32_16x16x32_bf16 v[248:251], a[228:231], v[28:31], v[248:251]
    buffer_load_dwordx4 v6, s[8:11], s21 offen lds
    v_mfma_f32_16x16x32_bf16 v[200:203], a[228:231], v[22:25], v[200:203]
    v_exp_f32 v63, v63
    v_mfma_f32_16x16x32_bf16 v[204:207], a[232:235], v[22:25], v[204:207]
    s_add_u32 s21, s21, 128
    v_exp_f32 v70, v70
    v_mfma_f32_16x16x32_bf16 v[156:159], a[232:235], v[16:19], v[156:159]
    ds_read_b128 a[224:227], v1 offset:13312
    v_cvt_pk_bf16_f32 v21, v62, v63
    v_mfma_f32_16x16x32_bf16 v[152:155], a[228:231], v[16:19], v[152:155]
    s_add_u32 m0, s22, 38912
    ds_read_b128 a[228:231], v0 offset:14336
    s_waitcnt lgkmcnt(3)
    v_mfma_f32_16x16x32_bf16 v[52:55], a[212:215], a[96:99], 0
    buffer_load_dwordx4 v6, s[8:11], s21 offen lds
    v_mfma_f32_16x16x32_bf16 v[52:55], a[216:219], a[100:103], v[52:55]
    s_waitcnt lgkmcnt(2)
    v_cvt_pk_bf16_f32 v27, v70, v71
    v_cvt_pk_bf16_f32 v32, v76, v77
    v_mfma_f32_16x16x32_bf16 v[52:55], a[220:223], a[104:107], v[52:55]
    ds_read_b128 a[232:235], v1 offset:14336
    v_fma_f32 v80, v80, s28, v12
    v_mfma_f32_16x16x32_bf16 v[60:63], a[220:223], a[128:131], 0
    v_exp_f32 v66, v66
    v_mfma_f32_16x16x32_bf16 v[60:63], a[216:219], a[124:127], v[60:63]
    v_cvt_pk_bf16_f32 v26, v68, v69
    v_mfma_f32_16x16x32_bf16 v[60:63], a[212:215], a[120:123], v[60:63]
    v_exp_f32 v81, v81
    v_mfma_f32_16x16x32_bf16 v[68:71], a[212:215], a[144:147], 0
    v_exp_f32 v59, v59
    v_mfma_f32_16x16x32_bf16 v[68:71], a[216:219], a[148:151], v[68:71]
    v_exp_f32 v73, v73
    v_mfma_f32_16x16x32_bf16 v[68:71], a[220:223], a[152:155], v[68:71]
    v_exp_f32 v80, v80
    v_mfma_f32_16x16x32_bf16 v[76:79], a[220:223], a[176:179], 0
    v_exp_f32 v67, v67
    v_mfma_f32_16x16x32_bf16 v[76:79], a[216:219], a[172:175], v[76:79]
    v_exp_f32 v83, v83
    v_mfma_f32_16x16x32_bf16 v[76:79], a[212:215], a[168:171], v[76:79]
    s_waitcnt lgkmcnt(1)
    v_exp_f32 v82, v82
    v_mfma_f32_16x16x32_bf16 v[76:79], a[224:227], a[180:183], v[76:79]
    ds_read_b128 a[212:215], v0 offset:18432
    v_cvt_pk_bf16_f32 v34, v80, v81
    v_mfma_f32_16x16x32_bf16 v[76:79], a[228:231], a[184:187], v[76:79]
    s_waitcnt lgkmcnt(1)
    v_cvt_pk_bf16_f32 v28, v72, v73
    v_mfma_f32_16x16x32_bf16 v[76:79], a[232:235], a[188:191], v[76:79]
    v_exp_f32 v56, v56
    v_mfma_f32_16x16x32_bf16 v[68:71], a[232:235], a[164:167], v[68:71]
    v_exp_f32 v74, v74
    v_mfma_f32_16x16x32_bf16 v[68:71], a[228:231], a[160:163], v[68:71]
    ds_read_b128 a[216:219], v1 offset:18432
    v_cvt_pk_bf16_f32 v23, v66, v67
    v_mfma_f32_16x16x32_bf16 v[68:71], a[224:227], a[156:159], v[68:71]
    v_mfma_f32_16x16x32_bf16 v[60:63], a[224:227], a[132:135], v[60:63]
    v_cvt_pk_bf16_f32 v22, v64, v65
    v_mfma_f32_16x16x32_bf16 v[60:63], a[228:231], a[136:139], v[60:63]
    ds_read_b128 a[220:223], v0 offset:19456
    v_cvt_pk_bf16_f32 v17, v58, v59
    v_mfma_f32_16x16x32_bf16 v[60:63], a[232:235], a[140:143], v[60:63]
    v_exp_f32 v57, v57
    v_mfma_f32_16x16x32_bf16 v[52:55], a[232:235], a[116:119], v[52:55]
    ds_read_b128 a[232:235], v1 offset:20480
    v_cvt_pk_bf16_f32 v16, v56, v57
    v_mfma_f32_16x16x32_bf16 v[52:55], a[228:231], a[112:115], v[52:55]
    ds_read_b128 a[228:231], v0 offset:20480
    v_mfma_f32_16x16x32_bf16 v[52:55], a[224:227], a[108:111], v[52:55]
    s_waitcnt lgkmcnt(4)
    ds_read_b128 a[224:227], v1 offset:19456
    v_cvt_pk_bf16_f32 v35, v82, v83
    v_mfma_f32_16x16x32_bf16 v[56:59], a[212:215], a[96:99], 0
    v_cvt_pk_bf16_f32 v29, v74, v75
    v_mfma_f32_16x16x32_bf16 v[44:47], a[236:239], v[14:17], v[48:51]
    v_mfma_f32_16x16x32_bf16 v[44:47], a[240:243], v[20:23], v[44:47]
    v_mfma_f32_16x16x32_bf16 v[44:47], a[244:247], v[26:29], v[44:47]
    v_mfma_f32_16x16x32_bf16 v[44:47], a[248:251], v[32:35], v[44:47]
    s_waitcnt lgkmcnt(4)
    v_mfma_f32_16x16x32_bf16 v[56:59], a[216:219], a[100:103], v[56:59]
    s_add_u32 s21, s21, 12032
    s_waitcnt lgkmcnt(3)
    v_mfma_f32_16x16x32_bf16 v[56:59], a[220:223], a[104:107], v[56:59]
    v_mfma_f32_16x16x32_bf16 v[64:67], a[220:223], a[128:131], 0
    v_mfma_f32_16x16x32_bf16 v[64:67], a[216:219], a[124:127], v[64:67]
    s_nop 0
    v_cmp_lt_f32 vcc, s29, v44
    s_waitcnt vmcnt(10) lgkmcnt(0)
    v_mfma_f32_16x16x32_bf16 v[64:67], a[212:215], a[120:123], v[64:67]
    s_barrier
    v_mfma_f32_16x16x32_bf16 v[72:75], a[212:215], a[144:147], 0
    s_nop 0
    s_cbranch_vccnz L_rs_loop4w0a
L_ret_loop4w0a:
    v_mfma_f32_16x16x32_bf16 v[72:75], a[216:219], a[148:151], v[72:75]
    s_add_u32 m0, s22, 12288
    v_fma_f32 v52, v52, s28, v9
    v_fma_f32 v55, v55, s28, v9
    v_mfma_f32_16x16x32_bf16 v[72:75], a[220:223], a[152:155], v[72:75]
    v_fma_f32 v61, v61, s28, v10
    v_fma_f32 v53, v53, s28, v9
    v_mfma_f32_16x16x32_bf16 v[80:83], a[220:223], a[176:179], 0
    buffer_load_dwordx4 v6, s[4:7], s20 offen lds
    v_mfma_f32_16x16x32_bf16 v[80:83], a[216:219], a[172:175], v[80:83]
    v_exp_f32 v52, v52
    v_mfma_f32_16x16x32_bf16 v[80:83], a[212:215], a[168:171], v[80:83]
    s_add_u32 s20, s20, 128
    ds_read_b64_tr_b16 a[212:213], v2 offset:0
    s_add_u32 m0, s22, 13312
    v_mfma_f32_16x16x32_bf16 v[80:83], a[224:227], a[180:183], v[80:83]
    buffer_load_dwordx4 v6, s[4:7], s20 offen lds
    v_mfma_f32_16x16x32_bf16 v[80:83], a[228:231], a[184:187], v[80:83]
    ds_read_b64_tr_b16 a[214:215], v2 offset:6144
    v_fma_f32 v54, v54, s28, v9
    v_mfma_f32_16x16x32_bf16 v[80:83], a[232:235], a[188:191], v[80:83]
    s_add_u32 s20, s20, 128
    ds_read_b64_tr_b16 a[216:217], v3 offset:0
    v_fma_f32 v60, v60, s28, v10
    v_mfma_f32_16x16x32_bf16 v[72:75], a[232:235], a[164:167], v[72:75]
    ds_read_b64_tr_b16 a[218:219], v3 offset:6144
    v_mfma_f32_16x16x32_bf16 v[72:75], a[228:231], a[160:163], v[72:75]
    s_add_u32 m0, s22, 14336
    v_exp_f32 v55, v55
    v_mfma_f32_16x16x32_bf16 v[72:75], a[224:227], a[156:159], v[72:75]
    buffer_load_dwordx4 v6, s[4:7], s20 offen lds
    v_mfma_f32_16x16x32_bf16 v[64:67], a[224:227], a[132:135], v[64:67]
    v_exp_f32 v61, v61
    v_mfma_f32_16x16x32_bf16 v[64:67], a[228:231], a[136:139], v[64:67]
    ds_read_b64_tr_b16 a[220:221], v4 offset:0
    v_mfma_f32_16x16x32_bf16 v[64:67], a[232:235], a[140:143], v[64:67]
    v_exp_f32 v60, v60
    v_mfma_f32_16x16x32_bf16 v[56:59], a[232:235], a[116:119], v[56:59]
    s_add_u32 s20, s20, 12032
    v_exp_f32 v53, v53
    v_mfma_f32_16x16x32_bf16 v[56:59], a[228:231], a[112:115], v[56:59]
    ds_read_b64_tr_b16 a[222:223], v4 offset:6144
    v_mfma_f32_16x16x32_bf16 v[56:59], a[224:227], a[108:111], v[56:59]
    ds_read_b64_tr_b16 a[224:225], v5 offset:0
    ds_read_b64_tr_b16 a[226:227], v5 offset:6144
    v_exp_f32 v54, v54
    v_cvt_pk_bf16_f32 v18, v52, v53
    v_cvt_pk_bf16_f32 v24, v60, v61
    v_cvt_pk_bf16_f32 v19, v54, v55
    s_waitcnt lgkmcnt(4)
    v_mfma_f32_16x16x32_bf16 v[112:115], a[212:215], v[14:17], v[112:115]
    ds_read_b64_tr_b16 a[234:235], v3 offset:7168
    v_fma_f32 v83, v83, s28, v12
    v_mfma_f32_16x16x32_bf16 v[116:119], a[216:219], v[14:17], v[116:119]
    ds_read_b64_tr_b16 a[232:233], v3 offset:1024
    v_fma_f32 v78, v78, s28, v12
    v_mfma_f32_16x16x32_bf16 v[164:167], a[216:219], v[20:23], v[164:167]
    ds_read_b64_tr_b16 a[228:229], v2 offset:1024
    v_fma_f32 v58, v58, s28, v9
    v_mfma_f32_16x16x32_bf16 v[160:163], a[212:215], v[20:23], v[160:163]
    v_fma_f32 v59, v59, s28, v9
    v_fma_f32 v57, v57, s28, v9
    v_mfma_f32_16x16x32_bf16 v[208:211], a[212:215], v[26:29], v[208:211]
    s_add_u32 s39, s39, 12288
    ds_read_b64_tr_b16 a[230:231], v2 offset:7168
    v_fma_f32 v75, v75, s28, v11
    v_mfma_f32_16x16x32_bf16 v[212:215], a[216:219], v[26:29], v[212:215]
    v_fma_f32 v68, v68, s28, v11
    v_mfma_f32_16x16x32_bf16 a[4:7], a[216:219], v[32:35], a[4:7]
    v_mfma_f32_16x16x32_bf16 a[0:3], a[212:215], v[32:35], a[0:3]
    ds_read_b64_tr_b16 a[218:219], v5 offset:7168
    s_waitcnt lgkmcnt(5)
    v_mfma_f32_16x16x32_bf16 a[8:11], a[220:223], v[32:35], a[8:11]
    ds_read_b64_tr_b16 a[216:217], v5 offset:1024
    v_fma_f32 v76, v76, s28, v12
    v_mfma_f32_16x16x32_bf16 a[12:15], a[224:227], v[32:35], a[12:15]
    v_fma_f32 v62, v62, s28, v10
    v_fma_f32 v77, v77, s28, v12
    v_mfma_f32_16x16x32_bf16 v[220:223], a[224:227], v[26:29], v[220:223]
    v_fma_f32 v72, v72, s28, v11
    v_fma_f32 v70, v70, s28, v11
    v_mfma_f32_16x16x32_bf16 v[216:219], a[220:223], v[26:29], v[216:219]
    ds_read_b64_tr_b16 a[212:213], v4 offset:1024
    v_mfma_f32_16x16x32_bf16 v[168:171], a[220:223], v[20:23], v[168:171]
    ds_read_b64_tr_b16 a[214:215], v4 offset:7168
    v_fma_f32 v65, v65, s28, v10
    v_mfma_f32_16x16x32_bf16 v[172:175], a[224:227], v[20:23], v[172:175]
    v_exp_f32 v75, v75
    v_mfma_f32_16x16x32_bf16 v[124:127], a[224:227], v[14:17], v[124:127]
    v_exp_f32 v83, v83
    v_mfma_f32_16x16x32_bf16 v[120:123], a[220:223], v[14:17], v[120:123]
    s_waitcnt lgkmcnt(4)
    v_exp_f32 v58, v58
    v_mfma_f32_16x16x32_bf16 v[128:131], a[228:231], v[14:17], v[128:131]
    ds_read_b64_tr_b16 a[224:225], v3 offset:2048
    v_fma_f32 v63, v63, s28, v10
    v_mfma_f32_16x16x32_bf16 v[132:135], a[232:235], v[14:17], v[132:135]
    ds_read_b64_tr_b16 a[222:223], v2 offset:8192
    v_fma_f32 v74, v74, s28, v11
    v_mfma_f32_16x16x32_bf16 v[180:183], a[232:235], v[20:23], v[180:183]
    ds_read_b64_tr_b16 a[220:221], v2 offset:2048
    v_fma_f32 v79, v79, s28, v12
    v_mfma_f32_16x16x32_bf16 v[176:179], a[228:231], v[20:23], v[176:179]
    v_exp_f32 v70, v70
    v_mfma_f32_16x16x32_bf16 v[224:227], a[228:231], v[26:29], v[224:227]
    ds_read_b64_tr_b16 a[226:227], v3 offset:8192
    v_mfma_f32_16x16x32_bf16 v[228:231], a[232:235], v[26:29], v[228:231]
    v_exp_f32 v77, v77
    v_mfma_f32_16x16x32_bf16 a[20:23], a[232:235], v[32:35], a[20:23]
    ds_read_b64_tr_b16 a[234:235], v5 offset:8192
    v_fma_f32 v64, v64, s28, v10
    v_mfma_f32_16x16x32_bf16 a[16:19], a[228:231], v[32:35], a[16:19]
    s_waitcnt lgkmcnt(5)
    ds_read_b64_tr_b16 a[228:229], v4 offset:2048
    v_mfma_f32_16x16x32_bf16 a[24:27], a[212:215], v[32:35], a[24:27]
    ds_read_b64_tr_b16 a[230:231], v4 offset:8192
    v_fma_f32 v71, v71, s28, v11
    v_mfma_f32_16x16x32_bf16 a[28:31], a[216:219], v[32:35], a[28:31]
    ds_read_b64_tr_b16 a[232:233], v5 offset:2048
    v_mfma_f32_16x16x32_bf16 v[236:239], a[216:219], v[26:29], v[236:239]
    v_exp_f32 v79, v79
    v_mfma_f32_16x16x32_bf16 v[232:235], a[212:215], v[26:29], v[232:235]
    v_exp_f32 v62, v62
    v_mfma_f32_16x16x32_bf16 v[184:187], a[212:215], v[20:23], v[184:187]
    v_exp_f32 v63, v63
    v_mfma_f32_16x16x32_bf16 v[188:191], a[216:219], v[20:23], v[188:191]
    v_exp_f32 v76, v76
    v_mfma_f32_16x16x32_bf16 v[140:143], a[216:219], v[14:17], v[140:143]
    v_exp_f32 v59, v59
    v_mfma_f32_16x16x32_bf16 v[136:139], a[212:215], v[14:17], v[136:139]
    s_waitcnt lgkmcnt(4)
    v_exp_f32 v78, v78
    v_mfma_f32_16x16x32_bf16 v[144:147], a[220:223], v[14:17], v[144:147]
    v_exp_f32 v64, v64
    v_mfma_f32_16x16x32_bf16 v[148:151], a[224:227], v[14:17], v[148:151]
    v_fma_f32 v69, v69, s28, v11
    v_mfma_f32_16x16x32_bf16 v[196:199], a[224:227], v[20:23], v[196:199]
    v_exp_f32 v71, v71
    v_mfma_f32_16x16x32_bf16 v[192:195], a[220:223], v[20:23], v[192:195]
    s_waitcnt vmcnt(6) lgkmcnt(0)
    v_fma_f32 v82, v82, s28, v12
    v_cvt_pk_bf16_f32 v36, v76, v77
    v_mfma_f32_16x16x32_bf16 v[240:243], a[220:223], v[26:29], v[240:243]
    s_add_u32 m0, s22, 24576
    v_exp_f32 v68, v68
    v_mfma_f32_16x16x32_bf16 v[244:247], a[224:227], v[26:29], v[244:247]
    s_barrier
    ds_read_b128 a[212:215], v0 offset:0
    v_mfma_f32_16x16x32_bf16 a[36:39], a[224:227], v[32:35], a[36:39]
    ds_read_b128 a[216:219], v1 offset:0
    v_fma_f32 v67, v67, s28, v10
    v_mfma_f32_16x16x32_bf16 a[32:35], a[220:223], v[32:35], a[32:35]
    ds_read_b128 a[220:223], v0 offset:1024
    v_fma_f32 v73, v73, s28, v11
    v_mfma_f32_16x16x32_bf16 a[40:43], a[228:231], v[32:35], a[40:43]
    v_fma_f32 v66, v66, s28, v10
    v_fma_f32 v56, v56, s28, v9
    v_mfma_f32_16x16x32_bf16 a[44:47], a[232:235], v[32:35], a[44:47]
    buffer_load_dwordx4 v6, s[8:11], s21 offen lds
    v_mfma_f32_16x16x32_bf16 v[252:255], a[232:235], v[26:29], v[252:255]
    s_add_u32 s21, s21, 128
    ds_read_b128 a[224:227], v1 offset:1024
    v_cvt_pk_bf16_f32 v25, v62, v63
    v_mfma_f32_16x16x32_bf16 v[248:251], a[228:231], v[26:29], v[248:251]
    s_add_u32 m0, s22, 25600
    v_exp_f32 v69, v69
    v_mfma_f32_16x16x32_bf16 v[200:203], a[228:231], v[20:23], v[200:203]
    ds_read_b128 v[88:91], v8 offset:1024
    v_fma_f32 v80, v80, s28, v12
    v_mfma_f32_16x16x32_bf16 v[204:207], a[232:235], v[20:23], v[204:207]
    buffer_load_dwordx4 v6, s[8:11], s21 offen lds
    v_mfma_f32_16x16x32_bf16 v[156:159], a[232:235], v[14:17], v[156:159]
    ds_read_b128 a[232:235], v1 offset:2048
    v_cvt_pk_bf16_f32 v30, v68, v69
    v_mfma_f32_16x16x32_bf16 v[152:155], a[228:231], v[14:17], v[152:155]
    s_waitcnt lgkmcnt(5)
    ds_read_b128 v[84:87], v8 offset:0
    s_add_u32 s21, s21, 128
    v_mfma_f32_16x16x32_bf16 v[52:55], a[212:215], a[96:99], 0
    s_waitcnt lgkmcnt(5)
    v_exp_f32 v65, v65
    v_mfma_f32_16x16x32_bf16 v[52:55], a[216:219], a[100:103], v[52:55]
    s_waitcnt lgkmcnt(4)
    v_cvt_pk_bf16_f32 v31, v70, v71
    v_cvt_pk_bf16_f32 v37, v78, v79
    v_mfma_f32_16x16x32_bf16 v[52:55], a[220:223], a[104:107], v[52:55]
    ds_read_b128 a[228:231], v0 offset:2048
    s_add_u32 m0, s22, 26624
    v_mfma_f32_16x16x32_bf16 v[60:63], a[220:223], a[128:131], 0
    buffer_load_dwordx4 v6, s[8:11], s21 offen lds
    v_mfma_f32_16x16x32_bf16 v[60:63], a[216:219], a[124:127], v[60:63]
    v_exp_f32 v57, v57
    v_mfma_f32_16x16x32_bf16 v[60:63], a[212:215], a[120:123], v[60:63]
    v_exp_f32 v82, v82
    v_mfma_f32_16x16x32_bf16 v[68:71], a[212:215], a[144:147], 0
    v_exp_f32 v72, v72
    v_mfma_f32_16x16x32_bf16 v[68:71], a[216:219], a[148:151], v[68:71]
    v_fma_f32 v81, v81, s28, v12
    v_cvt_pk_bf16_f32 v35, v82, v83
    v_mfma_f32_16x16x32_bf16 v[68:71], a[220:223], a[152:155], v[68:71]
    v_exp_f32 v74, v74
    v_mfma_f32_16x16x32_bf16 v[76:79], a[220:223], a[176:179], 0
    s_add_u32 s21, s21, 12032
    v_exp_f32 v73, v73
    v_mfma_f32_16x16x32_bf16 v[76:79], a[216:219], a[172:175], v[76:79]
    v_exp_f32 v66, v66
    v_mfma_f32_16x16x32_bf16 v[76:79], a[212:215], a[168:171], v[76:79]
    s_waitcnt lgkmcnt(1)
    v_exp_f32 v81, v81
    v_mfma_f32_16x16x32_bf16 v[76:79], a[224:227], a[180:183], v[76:79]
    s_waitcnt lgkmcnt(0)
    v_cvt_pk_bf16_f32 v17, v58, v59
    v_cvt_pk_bf16_f32 v28, v72, v73
    v_mfma_f32_16x16x32_bf16 v[76:79], a[228:231], a[184:187], v[76:79]
    s_add_u32 m0, s23, 0
    v_exp_f32 v56, v56
    v_mfma_f32_16x16x32_bf16 v[76:79], a[232:235], a[188:191], v[76:79]
    ds_read_b128 a[220:223], v0 offset:7168
    v_mfma_f32_16x16x32_bf16 v[68:71], a[232:235], a[164:167], v[68:71]
    v_add_u32 v8, 2048, v8
    v_mfma_f32_16x16x32_bf16 v[68:71], a[228:231], a[160:163], v[68:71]
    v_cvt_pk_bf16_f32 v29, v74, v75
    v_cvt_pk_bf16_f32 v16, v56, v57
    v_mfma_f32_16x16x32_bf16 v[68:71], a[224:227], a[156:159], v[68:71]
    ds_read_b128 a[216:219], v1 offset:6144
    v_mfma_f32_16x16x32_bf16 v[60:63], a[224:227], a[132:135], v[60:63]
    v_exp_f32 v80, v80
    v_mfma_f32_16x16x32_bf16 v[60:63], a[228:231], a[136:139], v[60:63]
    ds_read_b128 a[212:215], v0 offset:6144
    v_cvt_pk_bf16_f32 v22, v64, v65
    v_mfma_f32_16x16x32_bf16 v[60:63], a[232:235], a[140:143], v[60:63]
    buffer_load_dwordx4 v6, s[12:15], s25 offen nt lds
    v_mfma_f32_16x16x32_bf16 v[52:55], a[232:235], a[116:119], v[52:55]
    v_exp_f32 v67, v67
    v_mfma_f32_16x16x32_bf16 v[52:55], a[228:231], a[112:115], v[52:55]
    ds_read_b128 a[232:235], v1 offset:8192
    v_mfma_f32_16x16x32_bf16 v[52:55], a[224:227], a[108:111], v[52:55]
    buffer_store_dwordx4 v[84:87], v102, s[16:19], s24 offen offset:0 nt
    ds_read_b128 a[224:227], v1 offset:7168
    v_cvt_pk_bf16_f32 v23, v66, v67
    v_cvt_pk_bf16_f32 v34, v80, v81
    v_mfma_f32_16x16x32_bf16 v[48:51], a[236:239], v[16:19], v[44:47]
    ds_read_b128 a[228:231], v0 offset:8192
    s_add_u32 m0, s23, 1024
    v_mfma_f32_16x16x32_bf16 v[48:51], a[240:243], v[22:25], v[48:51]
    v_mfma_f32_16x16x32_bf16 v[48:51], a[244:247], v[28:31], v[48:51]
    buffer_load_dwordx4 v7, s[12:15], s25 offen nt lds
    v_mfma_f32_16x16x32_bf16 v[48:51], a[248:251], v[34:37], v[48:51]
    s_bitcmp1_b32 s27, 0
    s_cselect_b32 s26, s49, 128
    s_waitcnt lgkmcnt(3)
    v_mfma_f32_16x16x32_bf16 v[56:59], a[212:215], a[96:99], 0
    buffer_store_dwordx4 v[88:91], v103, s[16:19], s24 offen offset:0 nt
    s_lshr_b32 s27, s27, 1
    s_nop 1
    v_cmp_lt_f32 vcc, s29, v48
    v_mfma_f32_16x16x32_bf16 v[56:59], a[216:219], a[100:103], v[56:59]
    s_add_u32 s24, s24, s26
    s_add_u32 s25, s25, s26
    v_mfma_f32_16x16x32_bf16 v[56:59], a[220:223], a[104:107], v[56:59]
    s_add_u32 s23, s23, 2048
    v_mfma_f32_16x16x32_bf16 v[64:67], a[220:223], a[128:131], 0
    s_cbranch_vccnz L_rs_loop4w0b
L_ret_loop4w0b:
    v_fma_f32 v61, v61, s28, v10
    v_mfma_f32_16x16x32_bf16 v[64:67], a[216:219], a[124:127], v[64:67]
    v_fma_f32 v55, v55, s28, v9
    s_waitcnt vmcnt(10) lgkmcnt(0)
    v_mfma_f32_16x16x32_bf16 v[64:67], a[212:215], a[120:123], v[64:67]
    s_barrier
    v_mfma_f32_16x16x32_bf16 v[72:75], a[212:215], a[144:147], 0
    s_cmp_eq_u32 s30, 5
    s_cselect_b32 s26, s62, 0
    s_add_u32 s20, s20, s26
    v_mfma_f32_16x16x32_bf16 v[72:75], a[216:219], a[148:151], v[72:75]
    s_add_u32 m0, s22, 0
    v_exp_f32 v61, v61
    v_mfma_f32_16x16x32_bf16 v[72:75], a[220:223], a[152:155], v[72:75]
    buffer_load_dwordx4 v6, s[4:7], s20 offen lds
    v_mfma_f32_16x16x32_bf16 v[80:83], a[220:223], a[176:179], 0
    s_add_u32 s20, s20, 128
    v_fma_f32 v54, v54, s28, v9
    v_fma_f32 v60, v60, s28, v10
    v_mfma_f32_16x16x32_bf16 v[80:83], a[216:219], a[172:175], v[80:83]
    s_add_u32 m0, s22, 1024
    v_exp_f32 v54, v54
    v_mfma_f32_16x16x32_bf16 v[80:83], a[212:215], a[168:171], v[80:83]
    buffer_load_dwordx4 v6, s[4:7], s20 offen lds
    v_mfma_f32_16x16x32_bf16 v[80:83], a[224:227], a[180:183], v[80:83]
    s_add_u32 s20, s20, 128
    ds_read_b64_tr_b16 a[212:213], v2 offset:18432
    s_add_u32 m0, s22, 2048
    v_mfma_f32_16x16x32_bf16 v[80:83], a[228:231], a[184:187], v[80:83]
    buffer_load_dwordx4 v6, s[4:7], s20 offen lds
    v_mfma_f32_16x16x32_bf16 v[80:83], a[232:235], a[188:191], v[80:83]
    ds_read_b64_tr_b16 a[214:215], v2 offset:12288
    v_fma_f32 v53, v53, s28, v9
    v_mfma_f32_16x16x32_bf16 v[72:75], a[232:235], a[164:167], v[72:75]
    ds_read_b64_tr_b16 a[216:217], v3 offset:18432
    v_fma_f32 v52, v52, s28, v9
    v_mfma_f32_16x16x32_bf16 v[72:75], a[228:231], a[160:163], v[72:75]
    ds_read_b64_tr_b16 a[218:219], v3 offset:12288
    v_exp_f32 v52, v52
    v_mfma_f32_16x16x32_bf16 v[72:75], a[224:227], a[156:159], v[72:75]
    v_exp_f32 v55, v55
    v_mfma_f32_16x16x32_bf16 v[64:67], a[224:227], a[132:135], v[64:67]
    s_add_u32 s20, s20, 12032
    v_exp_f32 v60, v60
    v_mfma_f32_16x16x32_bf16 v[64:67], a[228:231], a[136:139], v[64:67]
    v_exp_f32 v53, v53
    v_mfma_f32_16x16x32_bf16 v[64:67], a[232:235], a[140:143], v[64:67]
    ds_read_b64_tr_b16 a[220:221], v4 offset:18432
    v_cvt_pk_bf16_f32 v14, v52, v53
    v_mfma_f32_16x16x32_bf16 v[56:59], a[232:235], a[116:119], v[56:59]
    ds_read_b64_tr_b16 a[222:223], v4 offset:12288
    s_add_u32 s30, s30, 1
    v_mfma_f32_16x16x32_bf16 v[56:59], a[228:231], a[112:115], v[56:59]
    s_cmp_lt_u32 s30, 6
    v_cvt_pk_bf16_f32 v20, v60, v61
    v_cvt_pk_bf16_f32 v15, v54, v55
    v_mfma_f32_16x16x32_bf16 v[56:59], a[224:227], a[108:111], v[56:59]
    ds_read_b64_tr_b16 a[224:225], v5 offset:18432
    ds_read_b64_tr_b16 a[226:227], v5 offset:12288
    s_cbranch_scc1 L_loop4w0
    s_cmp_ge_u32 s37, 6
    s_cbranch_scc1 L_end4
    s_cmp_eq_u32 s32, 0
    s_cbranch_scc1 L_tr44
    s_branch L_tr45
L_tr45:
    s_waitcnt lgkmcnt(4)
    v_mfma_f32_16x16x32_bf16 v[112:115], a[212:215], v[16:19], v[112:115]
    ds_read_b64_tr_b16 a[230:231], v2 offset:13312
    v_mbcnt_lo_u32_b32 v107, -1, 0
    v_mfma_f32_16x16x32_bf16 v[116:119], a[216:219], v[16:19], v[116:119]
    ds_read_b64_tr_b16 a[228:229], v2 offset:19456
    v_fma_f32 v82, v82, s28, v12
    v_mfma_f32_16x16x32_bf16 v[164:167], a[216:219], v[22:25], v[164:167]
    v_fma_f32 v62, v62, s28, v10
    v_fma_f32 v59, v59, s28, v9
    v_mfma_f32_16x16x32_bf16 v[160:163], a[212:215], v[22:25], v[160:163]
    ds_read_b64_tr_b16 a[232:233], v3 offset:19456
    v_mbcnt_hi_u32_b32 v107, -1, v107
    v_fma_f32 v74, v74, s28, v11
    v_mfma_f32_16x16x32_bf16 v[208:211], a[212:215], v[28:31], v[208:211]
    ds_read_b64_tr_b16 a[234:235], v3 offset:13312
    v_exp_f32 v59, v59
    v_mfma_f32_16x16x32_bf16 v[212:215], a[216:219], v[28:31], v[212:215]
    v_fma_f32 v57, v57, s28, v9
    v_fma_f32 v72, v72, s28, v11
    v_mfma_f32_16x16x32_bf16 a[4:7], a[216:219], v[34:37], a[4:7]
    s_add_u32 s39, s39, 12288
    ds_read_b64_tr_b16 a[218:219], v5 offset:13312
    v_and_b32 v106, 15, v107
    v_mfma_f32_16x16x32_bf16 a[0:3], a[212:215], v[34:37], a[0:3]
    s_waitcnt lgkmcnt(5)
    v_mul_u32_u24 v106, 384, v106
    v_fma_f32 v63, v63, s28, v10
    v_mfma_f32_16x16x32_bf16 a[8:11], a[220:223], v[34:37], a[8:11]
    ds_read_b64_tr_b16 a[212:213], v4 offset:19456
    v_fma_f32 v67, v67, s28, v10
    v_mfma_f32_16x16x32_bf16 a[12:15], a[224:227], v[34:37], a[12:15]
    s_add_u32 s48, s33, 24576
    v_fma_f32 v76, v76, s28, v12
    v_lshrrev_b32 v107, 4, v107
    v_mfma_f32_16x16x32_bf16 v[220:223], a[224:227], v[28:31], v[220:223]
    ds_read_b64_tr_b16 a[216:217], v5 offset:19456
    v_lshl_add_u32 v106, v107, 4, v106
    v_mfma_f32_16x16x32_bf16 v[216:219], a[220:223], v[28:31], v[216:219]
    buffer_load_dwordx4 a[208:211], v106, s[12:15], s48 offen offset:256 nt
    v_mfma_f32_16x16x32_bf16 v[168:171], a[220:223], v[22:25], v[168:171]
    ds_read_b64_tr_b16 a[214:215], v4 offset:13312
    v_fma_f32 v71, v71, s28, v11
    v_mfma_f32_16x16x32_bf16 v[172:175], a[224:227], v[22:25], v[172:175]
    buffer_load_dwordx4 v[92:95], v106, s[12:15], s48 offen offset:320 nt
    v_mfma_f32_16x16x32_bf16 v[124:127], a[224:227], v[16:19], v[124:127]
    v_exp_f32 v62, v62
    v_mfma_f32_16x16x32_bf16 v[120:123], a[220:223], v[16:19], v[120:123]
    s_waitcnt lgkmcnt(4)
    v_exp_f32 v63, v63
    v_mfma_f32_16x16x32_bf16 v[128:131], a[228:231], v[16:19], v[128:131]
    ds_read_b64_tr_b16 a[222:223], v2 offset:14336
    v_fma_f32 v79, v79, s28, v12
    v_mfma_f32_16x16x32_bf16 v[132:135], a[232:235], v[16:19], v[132:135]
    ds_read_b64_tr_b16 a[220:221], v2 offset:20480
    v_fma_f32 v68, v68, s28, v11
    v_mfma_f32_16x16x32_bf16 v[180:183], a[232:235], v[22:25], v[180:183]
    ds_read_b64_tr_b16 a[224:225], v3 offset:20480
    v_fma_f32 v56, v56, s28, v9
    v_mfma_f32_16x16x32_bf16 v[176:179], a[228:231], v[22:25], v[176:179]
    v_fma_f32 v58, v58, s28, v9
    v_fma_f32 v73, v73, s28, v11
    v_mfma_f32_16x16x32_bf16 v[224:227], a[228:231], v[28:31], v[224:227]
    ds_read_b64_tr_b16 a[226:227], v3 offset:14336
    v_fma_f32 v77, v77, s28, v12
    v_mfma_f32_16x16x32_bf16 v[228:231], a[232:235], v[28:31], v[228:231]
    v_fma_f32 v81, v81, s28, v12
    v_fma_f32 v69, v69, s28, v11
    v_mfma_f32_16x16x32_bf16 a[20:23], a[232:235], v[34:37], a[20:23]
    ds_read_b64_tr_b16 a[232:233], v5 offset:20480
    v_fma_f32 v80, v80, s28, v12
    v_mfma_f32_16x16x32_bf16 a[16:19], a[228:231], v[34:37], a[16:19]
    s_waitcnt lgkmcnt(5)
    ds_read_b64_tr_b16 a[234:235], v5 offset:14336
    v_fma_f32 v70, v70, s28, v11
    v_mfma_f32_16x16x32_bf16 a[24:27], a[212:215], v[34:37], a[24:27]
    ds_read_b64_tr_b16 a[230:231], v4 offset:14336
    v_fma_f32 v78, v78, s28, v12
    v_mfma_f32_16x16x32_bf16 a[28:31], a[216:219], v[34:37], a[28:31]
    ds_read_b64_tr_b16 a[228:229], v4 offset:20480
    v_fma_f32 v65, v65, s28, v10
    v_mfma_f32_16x16x32_bf16 v[236:239], a[216:219], v[28:31], v[236:239]
    v_exp_f32 v71, v71
    v_mfma_f32_16x16x32_bf16 v[232:235], a[212:215], v[28:31], v[232:235]
    v_exp_f32 v74, v74
    v_mfma_f32_16x16x32_bf16 v[184:187], a[212:215], v[22:25], v[184:187]
    v_exp_f32 v82, v82
    v_mfma_f32_16x16x32_bf16 v[188:191], a[216:219], v[22:25], v[188:191]
    v_exp_f32 v72, v72
    v_mfma_f32_16x16x32_bf16 v[140:143], a[216:219], v[16:19], v[140:143]
    v_exp_f32 v69, v69
    v_mfma_f32_16x16x32_bf16 v[136:139], a[212:215], v[16:19], v[136:139]
    s_waitcnt lgkmcnt(4)
    v_exp_f32 v77, v77
    v_mfma_f32_16x16x32_bf16 v[144:147], a[220:223], v[16:19], v[144:147]
    v_exp_f32 v70, v70
    v_mfma_f32_16x16x32_bf16 v[148:151], a[224:227], v[16:19], v[148:151]
    v_exp_f32 v76, v76
    v_mfma_f32_16x16x32_bf16 v[196:199], a[224:227], v[22:25], v[196:199]
    ds_read_b128 v[96:99], v8 offset:2048
    v_cvt_pk_bf16_f32 v32, v76, v77
    v_mfma_f32_16x16x32_bf16 v[192:195], a[220:223], v[22:25], v[192:195]
    ds_read_b128 v[84:87], v8 offset:3072
    v_cvt_pk_bf16_f32 v27, v70, v71
    v_mfma_f32_16x16x32_bf16 v[240:243], a[220:223], v[28:31], v[240:243]
    s_waitcnt vmcnt(12) lgkmcnt(2)
    v_exp_f32 v68, v68
    v_mfma_f32_16x16x32_bf16 v[244:247], a[224:227], v[28:31], v[244:247]
    s_barrier
    v_mfma_f32_16x16x32_bf16 a[36:39], a[224:227], v[34:37], a[36:39]
    s_add_u32 m0, s22, 36864
    ds_read_b128 a[212:215], v0 offset:12288
    v_cvt_pk_bf16_f32 v21, v62, v63
    v_mfma_f32_16x16x32_bf16 a[32:35], a[220:223], v[34:37], a[32:35]
    ds_read_b128 a[216:219], v1 offset:12288
    v_mfma_f32_16x16x32_bf16 a[40:43], a[228:231], v[34:37], a[40:43]
    ds_read_b128 a[220:223], v0 offset:13312
    buffer_load_dwordx4 v6, s[8:11], s21 offen lds
    v_mfma_f32_16x16x32_bf16 a[44:47], a[232:235], v[34:37], a[44:47]
    v_exp_f32 v56, v56
    v_mfma_f32_16x16x32_bf16 v[252:255], a[232:235], v[28:31], v[252:255]
    s_add_u32 s21, s21, 128
    v_fma_f32 v83, v83, s28, v12
    v_fma_f32 v64, v64, s28, v10
    v_mfma_f32_16x16x32_bf16 v[248:251], a[228:231], v[28:31], v[248:251]
    ds_read_b128 a[224:227], v1 offset:13312
    s_add_u32 m0, s22, 37888
    v_mfma_f32_16x16x32_bf16 v[200:203], a[228:231], v[22:25], v[200:203]
    buffer_load_dwordx4 v6, s[8:11], s21 offen lds
    ds_read_b128 v[88:91], v8 offset:4096
    v_mfma_f32_16x16x32_bf16 v[204:207], a[232:235], v[22:25], v[204:207]
    s_add_u32 s21, s21, 128
    v_exp_f32 v79, v79
    v_mfma_f32_16x16x32_bf16 v[156:159], a[232:235], v[16:19], v[156:159]
    s_add_u32 m0, s22, 38912
    ds_read_b128 a[232:235], v1 offset:14336
    buffer_load_dwordx4 v6, s[8:11], s21 offen lds
    v_mfma_f32_16x16x32_bf16 v[152:155], a[228:231], v[16:19], v[152:155]
    s_waitcnt lgkmcnt(5)
    v_exp_f32 v67, v67
    v_mfma_f32_16x16x32_bf16 v[52:55], a[212:215], a[96:99], 0
    s_waitcnt lgkmcnt(4)
    ds_read_b128 a[228:231], v0 offset:14336
    v_cvt_pk_bf16_f32 v26, v68, v69
    v_mfma_f32_16x16x32_bf16 v[52:55], a[216:219], a[100:103], v[52:55]
    s_waitcnt lgkmcnt(4)
    v_exp_f32 v83, v83
    v_mfma_f32_16x16x32_bf16 v[52:55], a[220:223], a[104:107], v[52:55]
    s_add_u32 s21, s21, 12032
    v_exp_f32 v58, v58
    v_mfma_f32_16x16x32_bf16 v[60:63], a[220:223], a[128:131], 0
    s_add_u32 s56, s24, 5888
    v_exp_f32 v81, v81
    v_mfma_f32_16x16x32_bf16 v[60:63], a[216:219], a[124:127], v[60:63]
    buffer_store_dwordx4 v[96:99], v102, s[16:19], s56 offen offset:0 nt
    v_exp_f32 v80, v80
    v_fma_f32 v75, v75, s28, v11
    v_mfma_f32_16x16x32_bf16 v[60:63], a[212:215], a[120:123], v[60:63]
    v_exp_f32 v78, v78
    v_mfma_f32_16x16x32_bf16 v[68:71], a[212:215], a[144:147], 0
    s_add_u32 s58, s25, 5888
    v_cvt_pk_bf16_f32 v33, v78, v79
    v_fma_f32 v66, v66, s28, v10
    v_mfma_f32_16x16x32_bf16 v[68:71], a[216:219], a[148:151], v[68:71]
    s_add_u32 m0, s38, 24576
    v_exp_f32 v57, v57
    v_mfma_f32_16x16x32_bf16 v[68:71], a[220:223], a[152:155], v[68:71]
    buffer_load_dwordx4 v6, s[12:15], s58 offen nt lds
    v_mfma_f32_16x16x32_bf16 v[76:79], a[220:223], a[176:179], 0
    v_exp_f32 v75, v75
    v_mfma_f32_16x16x32_bf16 v[76:79], a[216:219], a[172:175], v[76:79]
    v_exp_f32 v64, v64
    v_mfma_f32_16x16x32_bf16 v[76:79], a[212:215], a[168:171], v[76:79]
    s_waitcnt lgkmcnt(0)
    v_exp_f32 v66, v66
    v_mfma_f32_16x16x32_bf16 v[76:79], a[224:227], a[180:183], v[76:79]
    s_add_u32 m0, s38, 25600
    ds_read_b128 a[220:223], v0 offset:19456
    v_cvt_pk_bf16_f32 v23, v66, v67
    v_mfma_f32_16x16x32_bf16 v[76:79], a[228:231], a[184:187], v[76:79]
    buffer_store_dwordx4 v[84:87], v103, s[16:19], s56 offen offset:0 nt
    ds_read_b128 a[212:215], v0 offset:18432
    v_exp_f32 v65, v65
    v_mfma_f32_16x16x32_bf16 v[76:79], a[232:235], a[188:191], v[76:79]
    ds_read_b128 v[96:99], v8 offset:5120
    v_mfma_f32_16x16x32_bf16 v[68:71], a[232:235], a[164:167], v[68:71]
    buffer_load_dwordx4 v7, s[12:15], s58 offen nt lds
    v_mfma_f32_16x16x32_bf16 v[68:71], a[228:231], a[160:163], v[68:71]
    s_add_u32 s57, s24, 6016
    v_cvt_pk_bf16_f32 v34, v80, v81
    v_cvt_pk_bf16_f32 v17, v58, v59
    v_mfma_f32_16x16x32_bf16 v[68:71], a[224:227], a[156:159], v[68:71]
    ds_read_b128 v[84:87], v8 offset:0
    s_add_u32 s59, s25, 6016
    v_mfma_f32_16x16x32_bf16 v[60:63], a[224:227], a[132:135], v[60:63]
    buffer_store_dwordx4 v[88:91], v102, s[16:19], s57 offen offset:0 nt
    ds_read_b128 a[216:219], v1 offset:18432
    v_exp_f32 v73, v73
    v_mfma_f32_16x16x32_bf16 v[60:63], a[228:231], a[136:139], v[60:63]
    s_add_u32 m0, s38, 26624
    v_cvt_pk_bf16_f32 v16, v56, v57
    v_cvt_pk_bf16_f32 v35, v82, v83
    v_mfma_f32_16x16x32_bf16 v[60:63], a[232:235], a[140:143], v[60:63]
    buffer_load_dwordx4 v6, s[12:15], s59 offen nt lds
    v_mfma_f32_16x16x32_bf16 v[52:55], a[232:235], a[116:119], v[52:55]
    ds_read_b128 v[88:91], v8 offset:1024
    v_cvt_pk_bf16_f32 v28, v72, v73
    v_mfma_f32_16x16x32_bf16 v[52:55], a[228:231], a[112:115], v[52:55]
    ds_read_b128 a[232:235], v1 offset:20480
    v_cvt_pk_bf16_f32 v22, v64, v65
    v_mfma_f32_16x16x32_bf16 v[52:55], a[224:227], a[108:111], v[52:55]
    ds_read_b128 a[228:231], v0 offset:20480
    v_cvt_pk_bf16_f32 v29, v74, v75
    v_mfma_f32_16x16x32_bf16 v[44:47], a[236:239], v[14:17], v[48:51]
    s_add_u32 m0, s38, 27648
    ds_read_b128 a[224:227], v1 offset:19456
    v_mfma_f32_16x16x32_bf16 v[44:47], a[240:243], v[20:23], v[44:47]
    v_mfma_f32_16x16x32_bf16 v[44:47], a[244:247], v[26:29], v[44:47]
    v_mfma_f32_16x16x32_bf16 v[44:47], a[248:251], v[32:35], v[44:47]
    s_waitcnt lgkmcnt(5)
    buffer_load_dwordx4 v7, s[12:15], s59 offen nt lds
    v_mfma_f32_16x16x32_bf16 v[56:59], a[212:215], a[96:99], 0
    s_add_u32 m0, s38, 22528
    s_waitcnt lgkmcnt(4)
    v_mfma_f32_16x16x32_bf16 v[56:59], a[216:219], a[100:103], v[56:59]
    buffer_load_dwordx4 v6, s[12:15], s25 offen nt lds
    v_mfma_f32_16x16x32_bf16 v[56:59], a[220:223], a[104:107], v[56:59]
    v_cmp_lt_f32 vcc, s29, v44
    s_add_u32 m0, s38, 23552
    v_mfma_f32_16x16x32_bf16 v[64:67], a[220:223], a[128:131], 0
    s_waitcnt lgkmcnt(3)
    buffer_load_dwordx4 v7, s[12:15], s25 offen nt lds
    v_mfma_f32_16x16x32_bf16 v[64:67], a[216:219], a[124:127], v[64:67]
    buffer_store_dwordx4 v[96:99], v103, s[16:19], s57 offen offset:0 nt
    s_cbranch_vccnz L_rs_tr45a
L_ret_tr45a:
    s_waitcnt vmcnt(19) lgkmcnt(0)
    v_fma_f32 v61, v61, s28, v10
    s_add_u32 m0, s22, 12288
    v_mfma_f32_16x16x32_bf16 v[64:67], a[212:215], a[120:123], v[64:67]
    s_barrier
    v_mfma_f32_16x16x32_bf16 v[72:75], a[212:215], a[144:147], 0
    buffer_load_dwordx4 v6, s[4:7], s20 offen lds
    v_mfma_f32_16x16x32_bf16 v[72:75], a[216:219], a[148:151], v[72:75]
    s_add_u32 s20, s20, 128
    v_fma_f32 v54, v54, s28, v9
    s_add_u32 m0, s22, 13312
    v_mfma_f32_16x16x32_bf16 v[72:75], a[220:223], a[152:155], v[72:75]
    buffer_load_dwordx4 v6, s[4:7], s20 offen lds
    v_mfma_f32_16x16x32_bf16 v[80:83], a[220:223], a[176:179], 0
    s_add_u32 s20, s20, 128
    v_fma_f32 v52, v52, s28, v9
    s_add_u32 m0, s22, 14336
    v_mfma_f32_16x16x32_bf16 v[80:83], a[216:219], a[172:175], v[80:83]
    buffer_load_dwordx4 v6, s[4:7], s20 offen lds
    v_mfma_f32_16x16x32_bf16 v[80:83], a[212:215], a[168:171], v[80:83]
    v_exp_f32 v54, v54
    v_mfma_f32_16x16x32_bf16 v[80:83], a[224:227], a[180:183], v[80:83]
    ds_read_b64_tr_b16 a[212:213], v2 offset:0
    v_fma_f32 v55, v55, s28, v9
    v_mfma_f32_16x16x32_bf16 v[80:83], a[228:231], a[184:187], v[80:83]
    v_exp_f32 v61, v61
    v_mfma_f32_16x16x32_bf16 v[80:83], a[232:235], a[188:191], v[80:83]
    v_exp_f32 v55, v55
    v_mfma_f32_16x16x32_bf16 v[72:75], a[232:235], a[164:167], v[72:75]
    ds_read_b64_tr_b16 a[214:215], v2 offset:6144
    v_mfma_f32_16x16x32_bf16 v[72:75], a[228:231], a[160:163], v[72:75]
    ds_read_b64_tr_b16 a[216:217], v3 offset:0
    v_mfma_f32_16x16x32_bf16 v[72:75], a[224:227], a[156:159], v[72:75]
    ds_read_b64_tr_b16 a[218:219], v3 offset:6144
    v_fma_f32 v53, v53, s28, v9
    v_mfma_f32_16x16x32_bf16 v[64:67], a[224:227], a[132:135], v[64:67]
    ds_read_b64_tr_b16 a[220:221], v4 offset:0
    v_fma_f32 v60, v60, s28, v10
    v_mfma_f32_16x16x32_bf16 v[64:67], a[228:231], a[136:139], v[64:67]
    v_exp_f32 v53, v53
    v_mfma_f32_16x16x32_bf16 v[64:67], a[232:235], a[140:143], v[64:67]
    buffer_store_dwordx4 v[84:87], v102, s[16:19], s24 offen offset:0 nt
    s_add_u32 s20, s20, 12032
    v_exp_f32 v60, v60
    v_mfma_f32_16x16x32_bf16 v[56:59], a[232:235], a[116:119], v[56:59]
    ds_read_b64_tr_b16 a[222:223], v4 offset:6144
    v_mfma_f32_16x16x32_bf16 v[56:59], a[228:231], a[112:115], v[56:59]
    v_exp_f32 v52, v52
    v_mfma_f32_16x16x32_bf16 v[56:59], a[224:227], a[108:111], v[56:59]
    ds_read_b64_tr_b16 a[224:225], v5 offset:0
    ds_read_b64_tr_b16 a[226:227], v5 offset:6144
    buffer_store_dwordx4 v[88:91], v103, s[16:19], s24 offen offset:0 nt
    v_cvt_pk_bf16_f32 v24, v60, v61
    v_cvt_pk_bf16_f32 v19, v54, v55
    v_cvt_pk_bf16_f32 v18, v52, v53
    ds_read_b64_tr_b16 a[234:235], v3 offset:7168
    s_waitcnt lgkmcnt(5)
    v_mfma_f32_16x16x32_bf16 v[112:115], a[212:215], v[14:17], v[112:115]
    ds_read_b64_tr_b16 a[230:231], v2 offset:7168
    v_fma_f32 v78, v78, s28, v12
    v_mfma_f32_16x16x32_bf16 v[116:119], a[216:219], v[14:17], v[116:119]
    ds_read_b64_tr_b16 a[228:229], v2 offset:1024
    v_and_b32 v104, 0x3ff, v0
    v_mfma_f32_16x16x32_bf16 v[164:167], a[216:219], v[20:23], v[164:167]
    v_lshrrev_b32 v105, 11, v0
    v_fma_f32 v64, v64, s28, v10
    v_mfma_f32_16x16x32_bf16 v[160:163], a[212:215], v[20:23], v[160:163]
    v_xor_b32 v105, s65, v105
    v_exp_f32 v78, v78
    v_mfma_f32_16x16x32_bf16 v[208:211], a[212:215], v[26:29], v[208:211]
    ds_read_b64_tr_b16 a[232:233], v3 offset:1024
    v_fma_f32 v77, v77, s28, v12
    v_mfma_f32_16x16x32_bf16 v[212:215], a[216:219], v[26:29], v[212:215]
    v_exp_f32 v77, v77
    v_mfma_f32_16x16x32_bf16 a[4:7], a[216:219], v[32:35], a[4:7]
    ds_read_b64_tr_b16 a[216:217], v5 offset:1024
    v_lshl_add_u32 v104, v105, 10, v104
    v_mfma_f32_16x16x32_bf16 a[0:3], a[212:215], v[32:35], a[0:3]
    s_waitcnt lgkmcnt(5)
    ds_read_b64_tr_b16 a[214:215], v4 offset:7168
    v_fma_f32 v68, v68, s28, v11
    v_mfma_f32_16x16x32_bf16 a[8:11], a[220:223], v[32:35], a[8:11]
    v_exp_f32 v68, v68
    v_mfma_f32_16x16x32_bf16 a[12:15], a[224:227], v[32:35], a[12:15]
    v_add_u32 v104, s38, v104
    v_xor_b32 v105, 64, v104
    v_mfma_f32_16x16x32_bf16 v[220:223], a[224:227], v[26:29], v[220:223]
    ds_read_b128 a[168:171], v104 offset:18432
    v_fma_f32 v71, v71, s28, v11
    v_mfma_f32_16x16x32_bf16 v[216:219], a[220:223], v[26:29], v[216:219]
    ds_read_b64_tr_b16 a[218:219], v5 offset:7168
    v_fma_f32 v76, v76, s28, v12
    v_mfma_f32_16x16x32_bf16 v[168:171], a[220:223], v[20:23], v[168:171]
    ds_read_b64_tr_b16 a[212:213], v4 offset:1024
    v_fma_f32 v63, v63, s28, v10
    v_mfma_f32_16x16x32_bf16 v[172:175], a[224:227], v[20:23], v[172:175]
    ds_read_b128 a[120:123], v104 offset:6144
    v_fma_f32 v67, v67, s28, v10
    v_mfma_f32_16x16x32_bf16 v[124:127], a[224:227], v[14:17], v[124:127]
    ds_read_b128 a[156:159], v105 offset:14336
    v_fma_f32 v57, v57, s28, v9
    v_mfma_f32_16x16x32_bf16 v[120:123], a[220:223], v[14:17], v[120:123]
    s_waitcnt lgkmcnt(7)
    ds_read_b128 a[104:107], v104 offset:2048
    v_fma_f32 v70, v70, s28, v11
    v_mfma_f32_16x16x32_bf16 v[128:131], a[228:231], v[14:17], v[128:131]
    v_exp_f32 v76, v76
    v_mfma_f32_16x16x32_bf16 v[132:135], a[232:235], v[14:17], v[132:135]
    ds_read_b64_tr_b16 a[226:227], v3 offset:8192
    v_fma_f32 v80, v80, s28, v12
    v_mfma_f32_16x16x32_bf16 v[180:183], a[232:235], v[20:23], v[180:183]
    ds_read_b64_tr_b16 a[222:223], v2 offset:8192
    v_fma_f32 v59, v59, s28, v9
    v_mfma_f32_16x16x32_bf16 v[176:179], a[228:231], v[20:23], v[176:179]
    ds_read_b128 a[96:99], v104 offset:0
    v_fma_f32 v74, v74, s28, v11
    v_mfma_f32_16x16x32_bf16 v[224:227], a[228:231], v[26:29], v[224:227]
    ds_read_b128 a[148:151], v105 offset:12288
    v_fma_f32 v72, v72, s28, v11
    v_mfma_f32_16x16x32_bf16 v[228:231], a[232:235], v[26:29], v[228:231]
    ds_read_b64_tr_b16 a[220:221], v2 offset:2048
    v_exp_f32 v70, v70
    v_mfma_f32_16x16x32_bf16 a[20:23], a[232:235], v[32:35], a[20:23]
    ds_read_b64_tr_b16 a[232:233], v5 offset:2048
    ds_read_b64_tr_b16 a[224:225], v3 offset:2048
    v_mfma_f32_16x16x32_bf16 a[16:19], a[228:231], v[32:35], a[16:19]
    s_waitcnt lgkmcnt(9)
    ds_read_b64_tr_b16 a[230:231], v4 offset:8192
    v_fma_f32 v62, v62, s28, v10
    v_mfma_f32_16x16x32_bf16 a[24:27], a[212:215], v[32:35], a[24:27]
    ds_read_b128 a[124:127], v105 offset:6144
    v_fma_f32 v75, v75, s28, v11
    v_mfma_f32_16x16x32_bf16 a[28:31], a[216:219], v[32:35], a[28:31]
    ds_read_b64_tr_b16 a[228:229], v4 offset:2048
    v_fma_f32 v82, v82, s28, v12
    v_mfma_f32_16x16x32_bf16 v[236:239], a[216:219], v[26:29], v[236:239]
    ds_read_b64_tr_b16 a[234:235], v5 offset:8192
    v_fma_f32 v79, v79, s28, v12
    v_mfma_f32_16x16x32_bf16 v[232:235], a[212:215], v[26:29], v[232:235]
    v_exp_f32 v59, v59
    v_mfma_f32_16x16x32_bf16 v[184:187], a[212:215], v[20:23], v[184:187]
    ds_read_b128 a[128:131], v104 offset:8192
    v_fma_f32 v69, v69, s28, v11
    v_mfma_f32_16x16x32_bf16 v[188:191], a[216:219], v[20:23], v[188:191]
    ds_read_b128 a[108:111], v105 offset:2048
    v_exp_f32 v82, v82
    v_mfma_f32_16x16x32_bf16 v[140:143], a[216:219], v[14:17], v[140:143]
    s_add_u32 s39, s39, 12288
    v_exp_f32 v79, v79
    v_mfma_f32_16x16x32_bf16 v[136:139], a[212:215], v[14:17], v[136:139]
    s_waitcnt lgkmcnt(8)
    v_exp_f32 v63, v63
    v_mfma_f32_16x16x32_bf16 v[144:147], a[220:223], v[14:17], v[144:147]
    s_waitcnt lgkmcnt(6)
    ds_read_b128 a[144:147], v104 offset:12288
    v_fma_f32 v58, v58, s28, v9
    v_mfma_f32_16x16x32_bf16 v[148:151], a[224:227], v[14:17], v[148:151]
    v_exp_f32 v62, v62
    v_mfma_f32_16x16x32_bf16 v[196:199], a[224:227], v[20:23], v[196:199]
    ds_read_b128 a[160:163], v104 offset:16384
    v_cvt_pk_bf16_f32 v25, v62, v63
    v_mfma_f32_16x16x32_bf16 v[192:195], a[220:223], v[20:23], v[192:195]
    ds_read_b128 a[152:155], v104 offset:14336
    s_waitcnt vmcnt(20) lgkmcnt(5)
    v_mfma_f32_16x16x32_bf16 v[240:243], a[220:223], v[26:29], v[240:243]
    s_add_u32 s21, s21, s62
    v_exp_f32 v69, v69
    v_mfma_f32_16x16x32_bf16 v[244:247], a[224:227], v[26:29], v[244:247]
    s_barrier
    v_mfma_f32_16x16x32_bf16 a[36:39], a[224:227], v[32:35], a[36:39]
    s_add_u32 m0, s22, 24576
    ds_read_b128 a[172:175], v105 offset:18432
    buffer_load_dwordx4 v6, s[8:11], s21 offen lds
    v_mfma_f32_16x16x32_bf16 a[32:35], a[220:223], v[32:35], a[32:35]
    s_add_u32 s21, s21, 128
    ds_read_b128 a[212:215], v0 offset:0
    s_add_u32 m0, s22, 25600
    v_mfma_f32_16x16x32_bf16 a[40:43], a[228:231], v[32:35], a[40:43]
    buffer_load_dwordx4 v6, s[8:11], s21 offen lds
    v_mfma_f32_16x16x32_bf16 a[44:47], a[232:235], v[32:35], a[44:47]
    s_add_u32 s21, s21, 128
    ds_read_b128 a[224:227], v1 offset:1024
    v_fma_f32 v66, v66, s28, v10
    v_mfma_f32_16x16x32_bf16 v[252:255], a[232:235], v[26:29], v[252:255]
    s_add_u32 m0, s22, 26624
    ds_read_b128 a[216:219], v1 offset:0
    buffer_load_dwordx4 v6, s[8:11], s21 offen lds
    v_mfma_f32_16x16x32_bf16 v[248:251], a[228:231], v[26:29], v[248:251]
    s_add_u32 s21, s21, 12032
    ds_read_b128 a[100:103], v105 offset:0
    v_fma_f32 v73, v73, s28, v11
    v_mfma_f32_16x16x32_bf16 v[200:203], a[228:231], v[20:23], v[200:203]
    s_waitcnt vmcnt(14)
    ds_read_b128 a[192:195], v104 offset:24576
    v_fma_f32 v56, v56, s28, v9
    v_fma_f32 v83, v83, s28, v12
    v_mfma_f32_16x16x32_bf16 v[204:207], a[232:235], v[20:23], v[204:207]
    v_exp_f32 v71, v71
    v_fma_f32 v81, v81, s28, v12
    v_fma_f32 v65, v65, s28, v10
    v_mfma_f32_16x16x32_bf16 v[156:159], a[232:235], v[14:17], v[156:159]
    ds_read_b128 a[220:223], v0 offset:1024
    v_cvt_pk_bf16_f32 v36, v76, v77
    v_exp_f32 v57, v57
    v_cvt_pk_bf16_f32 v37, v78, v79
    v_mfma_f32_16x16x32_bf16 v[152:155], a[228:231], v[14:17], v[152:155]
    s_waitcnt lgkmcnt(5)
    ds_read_b128 a[196:199], v105 offset:24576
    v_exp_f32 v56, v56
    v_mfma_f32_16x16x32_bf16 v[52:55], a[212:215], a[96:99], 0
    ds_read_b128 a[180:183], v105 offset:20480
    v_cvt_pk_bf16_f32 v31, v70, v71
    v_mfma_f32_16x16x32_bf16 v[60:63], a[212:215], a[120:123], 0
    ds_read_b128 a[176:179], v104 offset:20480
    v_cvt_pk_bf16_f32 v30, v68, v69
    v_mfma_f32_16x16x32_bf16 v[68:71], a[212:215], a[144:147], 0
    s_waitcnt vmcnt(11)
    ds_read_b128 a[132:135], v105 offset:8192
    v_exp_f32 v64, v64
    v_mfma_f32_16x16x32_bf16 v[76:79], a[212:215], a[168:171], 0
    ds_read_b128 a[200:203], v104 offset:26624
    s_waitcnt lgkmcnt(6)
    v_mfma_f32_16x16x32_bf16 v[84:87], a[212:215], a[192:195], 0
    v_exp_f32 v75, v75
    v_mfma_f32_16x16x32_bf16 v[52:55], a[216:219], a[100:103], v[52:55]
    v_exp_f32 v81, v81
    v_mfma_f32_16x16x32_bf16 v[60:63], a[216:219], a[124:127], v[60:63]
    v_exp_f32 v74, v74
    v_mfma_f32_16x16x32_bf16 v[68:71], a[216:219], a[148:151], v[68:71]
    ds_read_b128 a[204:207], v105 offset:26624
    v_mfma_f32_16x16x32_bf16 v[76:79], a[216:219], a[172:175], v[76:79]
    s_waitcnt lgkmcnt(5)
    v_exp_f32 v58, v58
    v_mfma_f32_16x16x32_bf16 v[84:87], a[216:219], a[196:199], v[84:87]
    v_exp_f32 v73, v73
    v_mfma_f32_16x16x32_bf16 v[52:55], a[220:223], a[104:107], v[52:55]
    ds_read_b128 a[228:231], v0 offset:6144
    v_cvt_pk_bf16_f32 v17, v58, v59
    v_mfma_f32_16x16x32_bf16 v[60:63], a[220:223], a[128:131], v[60:63]
    v_exp_f32 v80, v80
    v_mfma_f32_16x16x32_bf16 v[68:71], a[220:223], a[152:155], v[68:71]
    s_waitcnt lgkmcnt(3)
    v_exp_f32 v65, v65
    v_mfma_f32_16x16x32_bf16 v[76:79], a[220:223], a[176:179], v[76:79]
    s_waitcnt lgkmcnt(2)
    ds_read_b128 a[232:235], v1 offset:6144
    v_cvt_pk_bf16_f32 v16, v56, v57
    v_mfma_f32_16x16x32_bf16 v[84:87], a[220:223], a[200:203], v[84:87]
    ds_read_b128 a[116:119], v105 offset:4096
    v_mfma_f32_16x16x32_bf16 v[52:55], a[224:227], a[108:111], v[52:55]
    v_exp_f32 v72, v72
    v_mfma_f32_16x16x32_bf16 v[48:51], a[236:239], v[16:19], v[44:47]
    v_exp_f32 v67, v67
    v_mfma_f32_16x16x32_bf16 v[60:63], a[224:227], a[132:135], v[60:63]
    v_exp_f32 v66, v66
    v_mfma_f32_16x16x32_bf16 v[68:71], a[224:227], a[156:159], v[68:71]
    v_exp_f32 v83, v83
    v_mfma_f32_16x16x32_bf16 v[76:79], a[224:227], a[180:183], v[76:79]
    s_waitcnt lgkmcnt(3)
    v_cvt_pk_bf16_f32 v22, v64, v65
    v_cvt_pk_bf16_f32 v29, v74, v75
    v_mfma_f32_16x16x32_bf16 v[84:87], a[224:227], a[204:207], v[84:87]
    s_waitcnt lgkmcnt(2)
    ds_read_b128 a[212:215], v0 offset:7168
    v_mfma_f32_16x16x32_bf16 v[56:59], a[228:231], a[96:99], 0
    v_cvt_pk_bf16_f32 v28, v72, v73
    v_cvt_pk_bf16_f32 v23, v66, v67
    v_mfma_f32_16x16x32_bf16 v[64:67], a[228:231], a[120:123], 0
    v_cvt_pk_bf16_f32 v35, v82, v83
    v_cvt_pk_bf16_f32 v34, v80, v81
    v_mfma_f32_16x16x32_bf16 v[72:75], a[228:231], a[144:147], 0
    ds_read_b128 a[140:143], v105 offset:10240
    v_mfma_f32_16x16x32_bf16 v[80:83], a[228:231], a[168:171], 0
    ds_read_b128 a[220:223], v0 offset:2048
    v_mfma_f32_16x16x32_bf16 v[88:91], a[228:231], a[192:195], 0
    s_waitcnt lgkmcnt(3)
    ds_read_b128 a[216:219], v1 offset:7168
    v_mfma_f32_16x16x32_bf16 v[56:59], a[232:235], a[100:103], v[56:59]
    ds_read_b128 a[228:231], v0 offset:8192
    v_mfma_f32_16x16x32_bf16 v[64:67], a[232:235], a[124:127], v[64:67]
    ds_read_b128 a[224:227], v1 offset:2048
    s_waitcnt vmcnt(9)
    v_mfma_f32_16x16x32_bf16 v[72:75], a[232:235], a[148:151], v[72:75]
    ds_read_b128 a[112:115], v104 offset:4096
    v_mfma_f32_16x16x32_bf16 v[80:83], a[232:235], a[172:175], v[80:83]
    v_mfma_f32_16x16x32_bf16 v[88:91], a[232:235], a[196:199], v[88:91]
    ds_read_b128 a[232:235], v1 offset:8192
    v_mfma_f32_16x16x32_bf16 v[48:51], a[240:243], v[22:25], v[48:51]
    ds_read_b128 a[164:167], v105 offset:16384
    v_mfma_f32_16x16x32_bf16 v[48:51], a[244:247], v[28:31], v[48:51]
    ds_read_b128 a[184:187], v104 offset:22528
    v_mfma_f32_16x16x32_bf16 v[48:51], a[248:251], v[34:37], v[48:51]
    s_waitcnt lgkmcnt(8)
    v_mfma_f32_16x16x32_bf16 v[56:59], a[212:215], a[104:107], v[56:59]
    ds_read_b128 a[136:139], v104 offset:10240
    v_mfma_f32_16x16x32_bf16 v[64:67], a[212:215], a[128:131], v[64:67]
    ds_read_b128 a[188:191], v105 offset:22528
    v_mfma_f32_16x16x32_bf16 v[72:75], a[212:215], a[152:155], v[72:75]
    v_mfma_f32_16x16x32_bf16 v[80:83], a[212:215], a[176:179], v[80:83]
    s_nop 0
    v_cmp_lt_f32 vcc, s29, v48
    v_mfma_f32_16x16x32_bf16 v[88:91], a[212:215], a[200:203], v[88:91]
    s_waitcnt vmcnt(21)
    s_waitcnt lgkmcnt(5)
    v_mfma_f32_16x16x32_bf16 v[56:59], a[216:219], a[108:111], v[56:59]
    s_nop 0
    s_cbranch_vccnz L_rs_tr45b
L_ret_tr45b:
    v_mfma_f32_16x16x32_bf16 v[64:67], a[216:219], a[132:135], v[64:67]
    s_waitcnt vmcnt(18) lgkmcnt(4)
    s_add_u32 m0, s22, 0
    v_mfma_f32_16x16x32_bf16 v[72:75], a[216:219], a[156:159], v[72:75]
    s_barrier
    v_mfma_f32_16x16x32_bf16 v[80:83], a[216:219], a[180:183], v[80:83]
    buffer_load_dwordx4 v6, s[4:7], s20 offen lds
    v_mfma_f32_16x16x32_bf16 v[88:91], a[216:219], a[204:207], v[88:91]
    s_add_u32 s20, s20, 128
    ds_read_b64_tr_b16 a[212:213], v2 offset:18432
    s_add_u32 m0, s22, 1024
    v_mfma_f32_16x16x32_bf16 v[52:55], a[220:223], a[112:115], v[52:55]
    s_waitcnt lgkmcnt(2)
    v_mfma_f32_16x16x32_bf16 v[60:63], a[220:223], a[136:139], v[60:63]
    buffer_load_dwordx4 v6, s[4:7], s20 offen lds
    v_mfma_f32_16x16x32_bf16 v[68:71], a[220:223], a[160:163], v[68:71]
    v_mfma_f32_16x16x32_bf16 v[76:79], a[220:223], a[184:187], v[76:79]
    s_add_u32 s20, s20, 128
    ds_read_b64_tr_b16 a[214:215], v2 offset:12288
    s_add_u32 m0, s22, 2048
    v_mfma_f32_16x16x32_bf16 v[84:87], a[220:223], a[208:211], v[84:87]
    buffer_load_dwordx4 v6, s[4:7], s20 offen lds
    v_mfma_f32_16x16x32_bf16 v[52:55], a[224:227], a[116:119], v[52:55]
    v_mfma_f32_16x16x32_bf16 v[60:63], a[224:227], a[140:143], v[60:63]
    v_mfma_f32_16x16x32_bf16 v[68:71], a[224:227], a[164:167], v[68:71]
    s_add_u32 s20, s20, 12032
    s_waitcnt lgkmcnt(2)
    v_mfma_f32_16x16x32_bf16 v[76:79], a[224:227], a[188:191], v[76:79]
    ds_read_b64_tr_b16 a[216:217], v3 offset:18432
    v_mfma_f32_16x16x32_bf16 v[84:87], a[224:227], v[92:95], v[84:87]
    ds_read_b64_tr_b16 a[218:219], v3 offset:12288
    v_mfma_f32_16x16x32_bf16 v[56:59], a[228:231], a[112:115], v[56:59]
    ds_read_b64_tr_b16 a[220:221], v4 offset:18432
    v_mfma_f32_16x16x32_bf16 v[64:67], a[228:231], a[136:139], v[64:67]
    ds_read_b64_tr_b16 a[222:223], v4 offset:12288
    v_mfma_f32_16x16x32_bf16 v[72:75], a[228:231], a[160:163], v[72:75]
    v_mfma_f32_16x16x32_bf16 v[80:83], a[228:231], a[184:187], v[80:83]
    ds_read_b64_tr_b16 a[224:225], v5 offset:18432
    v_mfma_f32_16x16x32_bf16 v[88:91], a[228:231], a[208:211], v[88:91]
    v_mfma_f32_16x16x32_bf16 v[56:59], a[232:235], a[116:119], v[56:59]
    v_mfma_f32_16x16x32_bf16 v[64:67], a[232:235], a[140:143], v[64:67]
    v_mfma_f32_16x16x32_bf16 v[72:75], a[232:235], a[164:167], v[72:75]
    v_mfma_f32_16x16x32_bf16 v[80:83], a[232:235], a[188:191], v[80:83]
    ds_read_b64_tr_b16 a[226:227], v5 offset:12288
    v_mfma_f32_16x16x32_bf16 v[88:91], a[232:235], v[92:95], v[88:91]
    v_max3_f32 v96, v52, v53, v54
    s_nop 1
    v_max3_f32 v96, v96, v55, v56
    v_max3_f32 v96, v96, v57, v58
    v_max_f32 v96, v96, v59
    v_mbcnt_lo_u32_b32 v104, -1, 0
    v_mov_b32 v97, v96
    s_waitcnt lgkmcnt(4)
    v_mfma_f32_16x16x32_bf16 v[112:115], a[212:215], v[16:19], v[112:115]
    v_permlane32_swap_b32 v97, v96
    v_max_f32 v96, v96, v97
    v_mov_b32 v97, v96
    v_mfma_f32_16x16x32_bf16 v[116:119], a[216:219], v[16:19], v[116:119]
    s_mov_b32 s67, s34
    v_permlane16_swap_b32 v97, v96
    v_max_f32 v96, v96, v97
    v_mfma_f32_16x16x32_bf16 v[164:167], a[216:219], v[22:25], v[164:167]
    s_add_u32 s18, s34, 24576
    ds_read_b64_tr_b16 a[234:235], v3 offset:13312
    v_mul_f32_e64 v9, -s28, v96
    v_max3_f32 v96, v60, v61, v62
    v_max3_f32 v96, v96, v63, v64
    v_fma_f32 v58, v58, s28, v9
    v_max3_f32 v96, v96, v65, v66
    v_mfma_f32_16x16x32_bf16 v[160:163], a[212:215], v[22:25], v[160:163]
    s_mov_b32 s34, s33
    ds_read_b64_tr_b16 a[230:231], v2 offset:13312
    v_max_f32 v96, v96, v67
    v_mov_b32 v97, v96
    v_mfma_f32_16x16x32_bf16 v[208:211], a[212:215], v[28:31], v[208:211]
    s_add_u32 s64, s64, s62
    ds_read_b64_tr_b16 a[232:233], v3 offset:19456
    v_fma_f32 v56, v56, s28, v9
    v_mfma_f32_16x16x32_bf16 v[212:215], a[216:219], v[28:31], v[212:215]
    s_add_u32 s64, s64, 196608
    v_permlane32_swap_b32 v97, v96
    v_mbcnt_hi_u32_b32 v104, -1, v104
    v_rcp_f32 v49, v49
    v_fma_f32 v55, v55, s28, v9
    v_bfe_u32 v105, v104, 3, 1
    v_max_f32 v96, v96, v97
    v_mov_b32 v97, v96
    v_mfma_f32_16x16x32_bf16 a[4:7], a[216:219], v[34:37], a[4:7]
    s_mov_b32 s39, s64
    v_permlane16_swap_b32 v97, v96
    v_fma_f32 v53, v53, s28, v9
    v_fma_f32 v59, v59, s28, v9
    v_fma_f32 v52, v52, s28, v9
    v_max_f32 v96, v96, v97
    v_mfma_f32_16x16x32_bf16 a[0:3], a[212:215], v[34:37], a[0:3]
    s_waitcnt lgkmcnt(3)
    ds_read_b64_tr_b16 a[228:229], v2 offset:19456
    v_mul_f32_e64 v10, -s28, v96
    v_mfma_f32_16x16x32_bf16 a[8:11], a[220:223], v[34:37], a[8:11]
    s_add_u32 s37, s37, 1
    v_max3_f32 v96, v68, v69, v70
    v_max3_f32 v96, v96, v71, v72
    v_mfma_f32_16x16x32_bf16 a[12:15], a[224:227], v[34:37], a[12:15]
    s_bitcmp1_b32 s63, s37
    v_fma_f32 v62, v62, s28, v10
    v_max3_f32 v96, v96, v73, v74
    v_mfma_f32_16x16x32_bf16 v[220:223], a[224:227], v[28:31], v[220:223]
    s_cselect_b32 s62, 4294770688, 0
    ds_read_b64_tr_b16 a[216:217], v5 offset:19456
    v_fma_f32 v54, v54, s28, v9
    v_max_f32 v96, v96, v75
    v_mov_b32 v97, v96
    v_mul_f32 v166, v166, v49
    v_mul_f32 v165, v165, v49
    v_mfma_f32_16x16x32_bf16 v[216:219], a[220:223], v[28:31], v[216:219]
    s_cselect_b32 s42, 0, 325632
    v_permlane32_swap_b32 v97, v96
    v_fma_f32 v60, v60, s28, v10
    v_max_f32 v96, v96, v97
    v_mfma_f32_16x16x32_bf16 v[168:171], a[220:223], v[22:25], v[168:171]
    s_add_u32 s35, s35, s42
    v_and_b32 v107, 3, v104
    v_mov_b32 v97, v96
    v_mfma_f32_16x16x32_bf16 v[172:175], a[224:227], v[22:25], v[172:175]
    s_lshl_b32 s42, s37, 1
    ds_read_b64_tr_b16 a[218:219], v5 offset:13312
    v_permlane16_swap_b32 v97, v96
    v_mfma_f32_16x16x32_bf16 v[124:127], a[224:227], v[16:19], v[124:127]
    s_lshr_b32 s42, s31, s42
    ds_read_b64_tr_b16 a[212:213], v4 offset:19456
    v_max_f32 v96, v96, v97
    s_and_b32 s42, s42, 3
    v_mul_f32_e64 v11, -s28, v96
    v_max3_f32 v96, v76, v77, v78
    v_max3_f32 v96, v96, v79, v80
    v_lshrrev_b32 v106, 5, v104
    v_mfma_f32_16x16x32_bf16 v[120:123], a[220:223], v[16:19], v[120:123]
    s_waitcnt lgkmcnt(3)
    ds_read_b64_tr_b16 a[214:215], v4 offset:13312
    v_max3_f32 v96, v96, v81, v82
    v_mfma_f32_16x16x32_bf16 v[128:131], a[228:231], v[16:19], v[128:131]
    s_add_u32 s42, s42, s36
    v_xor_b32 v106, v106, v105
    v_fma_f32 v71, v71, s28, v11
    v_max_f32 v96, v96, v83
    v_mul_f32 v162, v162, v49
    v_mov_b32 v100, v48
    v_mfma_f32_16x16x32_bf16 v[132:135], a[232:235], v[16:19], v[132:135]
    s_sub_u32 s43, s42, 3
    v_mov_b32 v97, v96
    v_lshl_or_b32 v106, v107, 1, v106
    v_rcp_f32 v51, v51
    v_permlane32_swap_b32 v97, v96
    v_max_f32 v96, v96, v97
    v_mfma_f32_16x16x32_bf16 v[180:183], a[232:235], v[22:25], v[180:183]
    s_cmp_ge_u32 s42, 3
    ds_read_b64_tr_b16 a[226:227], v3 offset:14336
    v_fma_f32 v69, v69, s28, v11
    v_mfma_f32_16x16x32_bf16 v[176:179], a[228:231], v[22:25], v[176:179]
    s_cselect_b32 s42, s43, s42
    ds_read_b64_tr_b16 a[224:225], v3 offset:20480
    v_accvgpr_read_b32 v110, a6
    v_mfma_f32_16x16x32_bf16 v[224:227], a[228:231], v[28:31], v[224:227]
    s_mul_i32 s44, s3, 5
    v_permlane32_swap_b32 v48, v100
    v_accvgpr_read_b32 v108, a4
    v_mfma_f32_16x16x32_bf16 v[228:231], a[232:235], v[28:31], v[228:231]
    s_mov_b32 s32, 1
    s_lshl_b32 s43, s3, 2
    v_mov_b32 v97, v96
    v_mfma_f32_16x16x32_bf16 a[20:23], a[232:235], v[34:37], a[20:23]
    s_add_u32 s45, s43, 21
    v_permlane16_swap_b32 v97, v96
    v_mfma_f32_16x16x32_bf16 a[16:19], a[228:231], v[34:37], a[16:19]
    s_waitcnt lgkmcnt(2)
    ds_read_b64_tr_b16 a[220:221], v2 offset:20480
    v_max_f32 v96, v96, v97
    v_mfma_f32_16x16x32_bf16 a[24:27], a[212:215], v[34:37], a[24:27]
    s_cmp_eq_u32 s3, 0
    ds_read_b64_tr_b16 a[222:223], v2 offset:14336
    v_mul_f32_e64 v12, -s28, v96
    v_fma_f32 v57, v57, s28, v9
    v_mfma_f32_16x16x32_bf16 a[28:31], a[216:219], v[34:37], a[28:31]
    s_cselect_b32 s45, 20, s45
    v_fma_f32 v79, v79, s28, v12
    v_mul_f32 v169, v169, v49
    v_exp_f32 v60, v60
    v_exp_f32 v56, v56
    v_mfma_f32_16x16x32_bf16 v[236:239], a[216:219], v[28:31], v[236:239]
    s_cselect_b32 s33, 1, 0
    v_mul_f32 v182, v182, v49
    v_fma_f32 v63, v63, s28, v10
    v_max3_f32 v96, v84, v85, v86
    v_max3_f32 v96, v96, v87, v88
    v_mul_f32 v108, v108, v51
    v_mfma_f32_16x16x32_bf16 v[232:235], a[212:215], v[28:31], v[232:235]
    s_cmp_eq_u32 s42, 1
    ds_read_b64_tr_b16 a[234:235], v5 offset:14336
    v_max3_f32 v96, v96, v89, v90
    v_mfma_f32_16x16x32_bf16 v[184:187], a[212:215], v[22:25], v[184:187]
    s_cselect_b32 s44, s45, s44
    ds_read_b64_tr_b16 a[230:231], v4 offset:14336
    v_rcp_f32 v48, v48
    v_mul_f32 v110, v110, v51
    s_cselect_b32 s32, s33, s32
    v_fma_f32 v66, v66, s28, v10
    v_xor_b32 v105, s65, v105
    v_max_f32 v96, v96, v91
    v_mov_b32 v97, v96
    v_mul_f32 v161, v161, v49
    v_and_b32 v107, 7, v104
    v_mul_f32 v184, v184, v49
    v_mfma_f32_16x16x32_bf16 v[188:191], a[216:219], v[22:25], v[188:191]
    s_add_u32 s45, s43, 37
    s_cmp_eq_u32 s42, 2
    v_fma_f32 v70, v70, s28, v11
    v_permlane32_swap_b32 v97, v96
    v_mfma_f32_16x16x32_bf16 v[140:143], a[216:219], v[16:19], v[140:143]
    s_cselect_b32 s44, s45, s44
    ds_read_b64_tr_b16 a[232:233], v5 offset:20480
    v_lshl_add_u32 v101, v105, 10, s38
    v_mfma_f32_16x16x32_bf16 v[136:139], a[212:215], v[16:19], v[136:139]
    s_waitcnt lgkmcnt(3)
    v_fma_f32 v76, v76, s28, v12
    v_max_f32 v96, v96, v97
    v_exp_f32 v53, v53
    v_mfma_f32_16x16x32_bf16 v[144:147], a[220:223], v[16:19], v[144:147]
    s_cselect_b32 s32, 0, s32
    s_mul_i32 s44, s44, 6144
    v_fma_f32 v78, v78, s28, v12
    v_exp_f32 v76, v76
    v_mfma_f32_16x16x32_bf16 v[148:151], a[224:227], v[16:19], v[148:151]
    s_add_u32 s33, s35, s44
    ds_read_b64_tr_b16 a[228:229], v4 offset:20480
    v_fma_f32 v68, v68, s28, v11
    v_lshl_add_u32 v101, v106, 4, v101
    v_mfma_f32_16x16x32_bf16 v[196:199], a[224:227], v[22:25], v[196:199]
    s_mul_i32 s42, s32, 6144
    v_mov_b32 v97, v96
    s_add_u32 s42, s42, 24576
    v_fma_f32 v77, v77, s28, v12
    v_mfma_f32_16x16x32_bf16 v[192:195], a[220:223], v[22:25], v[192:195]
    s_add_u32 s42, s42, s33
    v_fma_f32 v67, v67, s28, v10
    v_lshl_add_u32 v101, v107, 7, v101
    v_mul_f32 v171, v171, v49
    v_exp_f32 v52, v52
    v_mfma_f32_16x16x32_bf16 v[240:243], a[220:223], v[28:31], v[240:243]
    s_cmp_ge_u32 s37, 6
    v_permlane16_swap_b32 v97, v96
    v_mul_f32 v176, v176, v49
    v_max_f32 v96, v96, v97
    v_exp_f32 v71, v71
    v_mfma_f32_16x16x32_bf16 v[244:247], a[224:227], v[28:31], v[244:247]
    s_cselect_b32 s14, 0, s42
    v_mul_f32_e64 v13, -s28, v96
    v_accvgpr_read_b32 v109, a5
    v_mfma_f32_16x16x32_bf16 a[36:39], a[224:227], v[34:37], a[36:39]
    s_add_u32 s24, s67, 256
    v_mul_f32 v168, v168, v49
    s_add_u32 s25, s33, 256
    v_exp_f32 v79, v79
    v_exp_f32 v70, v70
    v_fma_f32 v64, v64, s28, v10
    v_fma_f32 v81, v81, s28, v12
    v_mfma_f32_16x16x32_bf16 a[32:35], a[220:223], v[34:37], a[32:35]
    s_waitcnt lgkmcnt(0)
    v_exp_f32 v54, v54
    v_exp_f32 v69, v69
    v_fma_f32 v85, v85, s28, v13
    v_mfma_f32_16x16x32_bf16 a[40:43], a[228:231], v[34:37], a[40:43]
    s_add_u32 s23, s38, 4096
    v_cvt_pk_bf16_f32 v14, v52, v53
    v_mul_f32 v181, v181, v49
    v_mfma_f32_16x16x32_bf16 a[44:47], a[232:235], v[34:37], a[44:47]
    s_mov_b32 s27, 0x49249249
    s_mov_b32 s30, 0
    v_bfe_u32 v107, v104, 4, 1
    v_mfma_f32_16x16x32_bf16 v[252:255], a[232:235], v[28:31], v[252:255]
    s_waitcnt vmcnt(8)
    s_barrier
    ds_read_b128 a[220:223], v0 offset:13312
    v_cvt_pk_bf16_f32 v27, v70, v71
    v_exp_f32 v78, v78
    v_mfma_f32_16x16x32_bf16 v[248:251], a[228:231], v[28:31], v[248:251]
    ds_read_b128 a[212:215], v0 offset:12288
    v_fma_f32 v82, v82, s28, v12
    v_fma_f32 v91, v91, s28, v13
    v_exp_f32 v77, v77
    v_mfma_f32_16x16x32_bf16 v[200:203], a[228:231], v[22:25], v[200:203]
    ds_read_b128 a[216:219], v1 offset:12288
    v_fma_f32 v61, v61, s28, v10
    v_mul_f32 v180, v180, v49
    v_mul_f32 v163, v163, v49
    v_cvt_pk_bf16_f32 v32, v76, v77
    v_fma_f32 v74, v74, s28, v11
    v_rcp_f32 v50, v50
    v_fma_f32 v89, v89, s28, v13
    v_mul_f32 v164, v164, v49
    v_mul_f32 v160, v160, v49
    v_fma_f32 v80, v80, s28, v12
    v_exp_f32 v55, v55
    v_mul_f32 v179, v179, v49
    v_exp_f32 v63, v63
    v_mul_f32 v189, v189, v49
    v_fma_f32 v86, v86, s28, v13
    v_lshl_add_u32 v101, v107, 3, v101
    v_mfma_f32_16x16x32_bf16 v[204:207], a[232:235], v[22:25], v[204:207]
    s_add_u32 m0, s22, 36864
    v_exp_f32 v62, v62
    v_cvt_pk_bf16_f32 v15, v54, v55
    v_exp_f32 v67, v67
    v_exp_f32 v68, v68
    v_cvt_pk_bf16_f32 v21, v62, v63
    v_mfma_f32_16x16x32_bf16 v[156:159], a[232:235], v[16:19], v[156:159]
    v_mul_f32 v197, v197, v49
    v_mul_f32 v177, v177, v49
    v_fma_f32 v87, v87, s28, v13
    v_exp_f32 v61, v61
    v_mfma_f32_16x16x32_bf16 v[152:155], a[228:231], v[16:19], v[152:155]
    s_waitcnt lgkmcnt(0)
    v_cvt_pk_bf16_f32 v33, v78, v79
    v_exp_f32 v58, v58
    v_mfma_f32_16x16x32_bf16 v[52:55], a[212:215], a[96:99], 0
    ds_read_b128 a[228:231], v0 offset:14336
    v_mul_f32 v204, v204, v49
    v_mul_f32 v202, v202, v49
    v_fma_f32 v73, v73, s28, v11
    v_cvt_pk_bf16_f32 v20, v60, v61
    v_fma_f32 v84, v84, s28, v13
    v_fma_f32 v88, v88, s28, v13
    v_exp_f32 v85, v85
    v_fma_f32 v90, v90, s28, v13
    v_mfma_f32_16x16x32_bf16 v[52:55], a[216:219], a[100:103], v[52:55]
    v_exp_f32 v84, v84
    v_mul_f32 v205, v205, v49
    v_mfma_f32_16x16x32_bf16 v[52:55], a[220:223], a[104:107], v[52:55]
    v_exp_f32 v87, v87
    v_mfma_f32_16x16x32_bf16 v[60:63], a[220:223], a[128:131], 0
    v_accvgpr_read_b32 v105, a1
    v_fma_f32 v72, v72, s28, v11
    v_fma_f32 v75, v75, s28, v11
    v_mul_f32 v190, v190, v49
    v_exp_f32 v90, v90
    v_mfma_f32_16x16x32_bf16 v[60:63], a[216:219], a[124:127], v[60:63]
    ds_read_b128 a[224:227], v1 offset:13312
    v_exp_f32 v89, v89
    v_mfma_f32_16x16x32_bf16 v[60:63], a[212:215], a[120:123], v[60:63]
    v_exp_f32 v86, v86
    v_cvt_pk_bf16_f32 v26, v68, v69
    v_mfma_f32_16x16x32_bf16 v[68:71], a[212:215], a[144:147], 0
    buffer_load_dwordx4 v6, s[8:11], s21 offen lds
    ds_read_b128 a[232:235], v1 offset:14336
    v_mfma_f32_16x16x32_bf16 v[68:71], a[216:219], a[148:151], v[68:71]
    v_cvt_pk_bf16_f32 v160, v160, v161
    v_mul_f32 v185, v185, v49
    v_mfma_f32_16x16x32_bf16 v[68:71], a[220:223], a[152:155], v[68:71]
    v_cvt_pk_bf16_f32 v38, v84, v85
    v_exp_f32 v57, v57
    v_mfma_f32_16x16x32_bf16 v[76:79], a[220:223], a[176:179], 0
    v_exp_f32 v59, v59
    v_fma_f32 v65, v65, s28, v10
    v_cvt_pk_bf16_f32 v39, v86, v87
    v_mfma_f32_16x16x32_bf16 v[76:79], a[216:219], a[172:175], v[76:79]
    s_add_u32 s21, s21, 128
    v_exp_f32 v64, v64
    v_mfma_f32_16x16x32_bf16 v[76:79], a[212:215], a[168:171], v[76:79]
    v_mul_f32 v206, v206, v49
    v_accvgpr_read_b32 v107, a3
    v_mfma_f32_16x16x32_bf16 v[84:87], a[212:215], a[192:195], 0
    v_cvt_pk_bf16_f32 v168, v168, v169
    v_exp_f32 v81, v81
    v_mfma_f32_16x16x32_bf16 v[84:87], a[216:219], a[196:199], v[84:87]
    v_accvgpr_read_b32 v104, a0
    v_exp_f32 v72, v72
    v_mul_f32 v173, v173, v49
    v_mfma_f32_16x16x32_bf16 v[84:87], a[220:223], a[200:203], v[84:87]
    s_waitcnt lgkmcnt(1)
    v_exp_f32 v82, v82
    v_mfma_f32_16x16x32_bf16 v[84:87], a[224:227], a[204:207], v[84:87]
    v_exp_f32 v80, v80
    v_accvgpr_read_b32 v106, a2
    v_mfma_f32_16x16x32_bf16 v[84:87], a[228:231], a[208:211], v[84:87]
    s_waitcnt lgkmcnt(0)
    v_cvt_pk_bf16_f32 v204, v204, v205
    v_cvt_pk_bf16_f32 v17, v58, v59
    v_mul_f32 v192, v192, v49
    v_mfma_f32_16x16x32_bf16 v[84:87], a[232:235], v[92:95], v[84:87]
    s_add_u32 m0, s22, 37888
    ds_read_b128 a[216:219], v1 offset:18432
    v_exp_f32 v66, v66
    v_exp_f32 v65, v65
    v_pk_mul_f32 v[116:117], v[116:117], v[48:49] op_sel_hi:[1,0]
    v_pk_mul_f32 v[208:209], v[208:209], v[50:51] op_sel_hi:[1,0]
    v_pk_mul_f32 v[220:221], v[220:221], v[50:51] op_sel_hi:[1,0]
    v_pk_mul_f32 v[210:211], v[210:211], v[50:51] op_sel_hi:[1,0]
    v_mul_f32 v170, v170, v49
    v_pk_mul_f32 v[124:125], v[124:125], v[48:49] op_sel_hi:[1,0]
    v_pk_mul_f32 v[136:137], v[136:137], v[48:49] op_sel_hi:[1,0]
    v_pk_mul_f32 v[234:235], v[234:235], v[50:51] op_sel_hi:[1,0]
    v_pk_mul_f32 v[222:223], v[222:223], v[50:51] op_sel_hi:[1,0]
    v_pk_mul_f32 v[212:213], v[212:213], v[50:51] op_sel_hi:[1,0]
    v_accvgpr_read_b32 v111, a7
    v_mul_f32 v193, v193, v49
    v_mfma_f32_16x16x32_bf16 v[76:79], a[232:235], a[188:191], v[76:79]
    v_exp_f32 v75, v75
    v_mfma_f32_16x16x32_bf16 v[76:79], a[228:231], a[184:187], v[76:79]
    v_mul_f32 v196, v196, v49
    v_cvt_pk_bf16_f32 v23, v66, v67
    v_mfma_f32_16x16x32_bf16 v[76:79], a[224:227], a[180:183], v[76:79]
    ds_read_b128 a[212:215], v0 offset:18432
    v_fma_f32 v83, v83, s28, v12
    v_subrev_u32 v8, 22528, v8
    v_mfma_f32_16x16x32_bf16 v[68:71], a[224:227], a[156:159], v[68:71]
    buffer_load_dwordx4 v6, s[8:11], s21 offen lds
    v_mfma_f32_16x16x32_bf16 v[68:71], a[228:231], a[160:163], v[68:71]
    v_exp_f32 v88, v88
    v_mfma_f32_16x16x32_bf16 v[68:71], a[232:235], a[164:167], v[68:71]
    ds_read_b128 a[220:223], v0 offset:19456
    v_cvt_pk_bf16_f32 v16, v56, v57
    v_mfma_f32_16x16x32_bf16 v[60:63], a[232:235], a[140:143], v[60:63]
    v_cvt_pk_bf16_f32 v176, v176, v177
    v_cvt_pk_bf16_f32 v208, v208, v209
    v_mfma_f32_16x16x32_bf16 v[60:63], a[228:231], a[136:139], v[60:63]
    s_add_u32 s21, s21, 128
    v_exp_f32 v73, v73
    v_mfma_f32_16x16x32_bf16 v[60:63], a[224:227], a[132:135], v[60:63]
    s_add_u32 m0, s22, 38912
    v_mul_f32 v195, v195, v49
    v_fma_f32 v84, v84, s28, v13
    v_mfma_f32_16x16x32_bf16 v[52:55], a[224:227], a[108:111], v[52:55]
    buffer_load_dwordx4 v6, s[8:11], s21 offen lds
    v_exp_f32 v74, v74
    v_cvt_pk_bf16_f32 v28, v72, v73
    v_mul_f32 v104, v104, v51
    v_pk_mul_f32 v[112:113], v[112:113], v[48:49] op_sel_hi:[1,0]
    v_pk_mul_f32 v[224:225], v[224:225], v[50:51] op_sel_hi:[1,0]
    v_fma_f32 v71, v71, s28, v11
    v_cvt_pk_bf16_f32 v116, v116, v117
    v_mul_f32 v109, v109, v51
    v_pk_mul_f32 v[216:217], v[216:217], v[50:51] op_sel_hi:[1,0]
    v_fma_f32 v60, v60, s28, v10
    v_mul_f32 v107, v107, v51
    v_mfma_f32_16x16x32_bf16 v[52:55], a[228:231], a[112:115], v[52:55]
    v_mul_f32 v105, v105, v51
    v_fma_f32 v68, v68, s28, v11
    v_mul_f32 v186, v186, v49
    v_mfma_f32_16x16x32_bf16 v[52:55], a[232:235], a[116:119], v[52:55]
    s_waitcnt lgkmcnt(1)
    ds_read_b128 a[228:231], v0 offset:20480
    v_mul_f32 v167, v167, v49
    v_mfma_f32_16x16x32_bf16 v[56:59], a[212:215], a[96:99], 0
    v_mul_f32 v172, v172, v49
    v_mul_f32 v198, v198, v49
    v_mfma_f32_16x16x32_bf16 v[56:59], a[216:219], a[100:103], v[56:59]
    s_waitcnt lgkmcnt(1)
    ds_read_b128 a[224:227], v1 offset:19456
    v_cvt_pk_bf16_f32 v209, v210, v211
    v_fma_f32 v70, v70, s28, v11
    v_mfma_f32_16x16x32_bf16 v[56:59], a[220:223], a[104:107], v[56:59]
    v_mul_f32 v188, v188, v49
    v_cvt_pk_bf16_f32 v22, v64, v65
    v_mfma_f32_16x16x32_bf16 v[64:67], a[220:223], a[128:131], 0
    ds_read_b128 a[232:235], v1 offset:20480
    v_cvt_pk_bf16_f32 v29, v74, v75
    v_mfma_f32_16x16x32_bf16 v[64:67], a[216:219], a[124:127], v[64:67]
    v_cvt_pk_bf16_f32 v34, v80, v81
    v_cvt_pk_bf16_f32 v104, v104, v105
    v_mfma_f32_16x16x32_bf16 v[64:67], a[212:215], a[120:123], v[64:67]
    s_add_u32 s21, s21, 12032
    v_exp_f32 v83, v83
    v_mfma_f32_16x16x32_bf16 v[72:75], a[212:215], a[144:147], 0
    v_cvt_pk_bf16_f32 v169, v170, v171
    v_cvt_pk_bf16_f32 v161, v162, v163
    v_mfma_f32_16x16x32_bf16 v[72:75], a[216:219], a[148:151], v[72:75]
    v_mul_f32 v111, v111, v51
    v_cvt_pk_bf16_f32 v112, v112, v113
    v_cvt_pk_bf16_f32 v220, v220, v221
    v_exp_f32 v91, v91
    v_mul_f32 v207, v207, v49
    v_fma_f32 v53, v53, s28, v9
    v_pk_mul_f32 v[126:127], v[126:127], v[48:49] op_sel_hi:[1,0]
    v_pk_mul_f32 v[226:227], v[226:227], v[50:51] op_sel_hi:[1,0]
    v_cvt_pk_bf16_f32 v35, v82, v83
    v_pk_mul_f32 v[120:121], v[120:121], v[48:49] op_sel_hi:[1,0]
    v_fma_f32 v86, v86, s28, v13
    v_pk_mul_f32 v[214:215], v[214:215], v[50:51] op_sel_hi:[1,0]
    v_mul_f32 v106, v106, v51
    v_cvt_pk_bf16_f32 v41, v90, v91
    v_cvt_pk_bf16_f32 v108, v108, v109
    v_cvt_pk_bf16_f32 v188, v188, v189
    v_pk_mul_f32 v[122:123], v[122:123], v[48:49] op_sel_hi:[1,0]
    v_pk_mul_f32 v[228:229], v[228:229], v[50:51] op_sel_hi:[1,0]
    v_pk_mul_f32 v[118:119], v[118:119], v[48:49] op_sel_hi:[1,0]
    v_pk_mul_f32 v[114:115], v[114:115], v[48:49] op_sel_hi:[1,0]
    v_cvt_pk_bf16_f32 v205, v206, v207
    v_cvt_pk_bf16_f32 v40, v88, v89
    v_pk_mul_f32 v[138:139], v[138:139], v[48:49] op_sel_hi:[1,0]
    v_pk_mul_f32 v[218:219], v[218:219], v[50:51] op_sel_hi:[1,0]
    v_pk_mul_f32 v[132:133], v[132:133], v[48:49] op_sel_hi:[1,0]
    v_cvt_pk_bf16_f32 v109, v110, v111
    v_fma_f32 v61, v61, s28, v10
    v_mfma_f32_16x16x32_bf16 v[72:75], a[220:223], a[152:155], v[72:75]
    s_waitcnt vmcnt(6) lgkmcnt(0)
    v_cvt_pk_bf16_f32 v180, v180, v181
    v_fma_f32 v54, v54, s28, v9
    v_mfma_f32_16x16x32_bf16 v[80:83], a[220:223], a[176:179], 0
    s_barrier
    v_mfma_f32_16x16x32_bf16 v[80:83], a[216:219], a[172:175], v[80:83]
    v_cvt_pk_bf16_f32 v172, v172, v173
    v_cvt_pk_bf16_f32 v124, v124, v125
    v_fma_f32 v77, v77, s28, v12
    v_accvgpr_read_b32 v110, a14
    v_cvt_pk_bf16_f32 v212, v212, v213
    v_mfma_f32_16x16x32_bf16 v[80:83], a[212:215], a[168:171], v[80:83]
    v_cvt_pk_bf16_f32 v105, v106, v107
    v_cvt_pk_bf16_f32 v164, v164, v165
    v_mfma_f32_16x16x32_bf16 v[88:91], a[212:215], a[192:195], 0
    v_fma_f32 v79, v79, s28, v12
    v_cvt_pk_bf16_f32 v113, v114, v115
    v_cvt_pk_bf16_f32 v165, v166, v167
    v_mfma_f32_16x16x32_bf16 v[88:91], a[216:219], a[196:199], v[88:91]
    ds_read_b64_tr_b16 a[212:213], v2 offset:0
    v_mul_f32 v183, v183, v49
    v_mfma_f32_16x16x32_bf16 v[88:91], a[220:223], a[200:203], v[88:91]
    v_exp_f32 v71, v71
    v_cvt_pk_bf16_f32 v117, v118, v119
    v_mfma_f32_16x16x32_bf16 v[88:91], a[224:227], a[204:207], v[88:91]
    ds_write2st64_b64 v101, v[112:113], v[160:161] offset0:0 offset1:12
    v_cvt_pk_bf16_f32 v125, v126, v127
    v_mfma_f32_16x16x32_bf16 v[88:91], a[228:231], a[208:211], v[88:91]
    v_fma_f32 v62, v62, s28, v10
    v_accvgpr_read_b32 v106, a10
    v_mfma_f32_16x16x32_bf16 v[88:91], a[232:235], v[92:95], v[88:91]
    ds_read_b64_tr_b16 a[214:215], v2 offset:6144
    v_mul_f32 v191, v191, v49
    v_mfma_f32_16x16x32_bf16 v[80:83], a[232:235], a[188:191], v[80:83]
    v_exp_f32 v60, v60
    v_mfma_f32_16x16x32_bf16 v[80:83], a[228:231], a[184:187], v[80:83]
    s_add_u32 m0, s22, 12288
    ds_read_b64_tr_b16 a[216:217], v3 offset:0
    v_cvt_pk_bf16_f32 v213, v214, v215
    v_mfma_f32_16x16x32_bf16 v[80:83], a[224:227], a[180:183], v[80:83]
    ds_write2st64_b64 v101, v[208:209], v[104:105] offset0:24 offset1:36
    v_mfma_f32_16x16x32_bf16 v[72:75], a[224:227], a[156:159], v[72:75]
    buffer_load_dwordx4 v6, s[4:7], s20 offen lds
    v_fma_f32 v69, v69, s28, v11
    v_cvt_pk_bf16_f32 v224, v224, v225
    v_mul_f32 v201, v201, v49
    v_mfma_f32_16x16x32_bf16 v[72:75], a[228:231], a[160:163], v[72:75]
    v_cvt_pk_bf16_f32 v228, v228, v229
    v_cvt_pk_bf16_f32 v225, v226, v227
    v_mfma_f32_16x16x32_bf16 v[72:75], a[232:235], a[164:167], v[72:75]
    ds_read_b64_tr_b16 a[218:219], v3 offset:6144
    v_mul_f32 v200, v200, v49
    v_mfma_f32_16x16x32_bf16 v[64:67], a[232:235], a[140:143], v[64:67]
    s_add_u32 s20, s20, 128
    ds_read_b64_tr_b16 a[220:221], v4 offset:0
    v_exp_f32 v77, v77
    v_cvt_pk_bf16_f32 v120, v120, v121
    v_mfma_f32_16x16x32_bf16 v[64:67], a[228:231], a[136:139], v[64:67]
    s_add_u32 m0, s22, 13312
    v_exp_f32 v53, v53
    v_mul_f32 v178, v178, v49
    v_accvgpr_read_b32 v107, a11
    v_mfma_f32_16x16x32_bf16 v[64:67], a[224:227], a[132:135], v[64:67]
    v_accvgpr_read_b32 v111, a15
    v_accvgpr_read_b32 v104, a8
    v_mfma_f32_16x16x32_bf16 v[56:59], a[224:227], a[108:111], v[56:59]
    v_mul_f32 v106, v106, v51
    v_xor_b32 v101, 32, v101
    v_mul_f32 v175, v175, v49
    v_cvt_pk_bf16_f32 v132, v132, v133
    v_mfma_f32_16x16x32_bf16 v[44:47], a[236:239], v[14:17], 0
    ds_read_b64_tr_b16 a[222:223], v4 offset:6144
    buffer_load_dwordx4 v6, s[4:7], s20 offen lds
    v_cvt_pk_bf16_f32 v221, v222, v223
    v_mfma_f32_16x16x32_bf16 v[56:59], a[228:231], a[112:115], v[56:59]
    s_add_u32 s20, s20, 128
    v_exp_f32 v61, v61
    v_fma_f32 v73, v73, s28, v11
    v_mfma_f32_16x16x32_bf16 v[56:59], a[232:235], a[116:119], v[56:59]
    v_fma_f32 v74, v74, s28, v11
    v_accvgpr_read_b32 v105, a9
    v_mfma_f32_16x16x32_bf16 v[44:47], a[240:243], v[20:23], v[44:47]
    s_waitcnt lgkmcnt(2)
    ds_write2st64_b64 v101, v[116:117], v[164:165] offset0:0 offset1:12
    v_mfma_f32_16x16x32_bf16 v[112:115], a[212:215], v[14:17], 0
    v_mul_f32 v107, v107, v51
    v_mul_f32 v104, v104, v51
    v_mfma_f32_16x16x32_bf16 v[116:119], a[216:219], v[14:17], 0
    ds_write2st64_b64 v101, v[212:213], v[108:109] offset0:24 offset1:36
    v_pk_mul_f32 v[144:145], v[144:145], v[48:49] op_sel_hi:[1,0]
    v_pk_mul_f32 v[244:245], v[244:245], v[50:51] op_sel_hi:[1,0]
    v_pk_mul_f32 v[240:241], v[240:241], v[50:51] op_sel_hi:[1,0]
    v_mul_f32 v174, v174, v49
    v_pk_mul_f32 v[148:149], v[148:149], v[48:49] op_sel_hi:[1,0]
    v_cvt_pk_bf16_f32 v121, v122, v123
    v_mul_f32 v111, v111, v51
    v_xor_b32 v101, 96, v101
    v_pk_mul_f32 v[130:131], v[130:131], v[48:49] op_sel_hi:[1,0]
    v_cvt_pk_bf16_f32 v173, v174, v175
    v_fma_f32 v76, v76, s28, v12
    v_mfma_f32_16x16x32_bf16 v[164:167], a[216:219], v[20:23], 0
    ds_write2st64_b64 v101, v[120:121], v[168:169] offset0:0 offset1:12
    v_pk_mul_f32 v[140:141], v[140:141], v[48:49] op_sel_hi:[1,0]
    v_cvt_pk_bf16_f32 v216, v216, v217
    v_mul_f32 v105, v105, v51
    v_fma_f32 v58, v58, s28, v9
    v_pk_mul_f32 v[232:233], v[232:233], v[50:51] op_sel_hi:[1,0]
    v_pk_mul_f32 v[128:129], v[128:129], v[48:49] op_sel_hi:[1,0]
    v_pk_mul_f32 v[236:237], v[236:237], v[50:51] op_sel_hi:[1,0]
    v_accvgpr_read_b32 v109, a13
    v_pk_mul_f32 v[142:143], v[142:143], v[48:49] op_sel_hi:[1,0]
    v_accvgpr_read_b32 v108, a12
    v_fma_f32 v88, v88, s28, v13
    v_cvt_pk_bf16_f32 v104, v104, v105
    v_mul_f32 v109, v109, v51
    v_pk_mul_f32 v[238:239], v[238:239], v[50:51] op_sel_hi:[1,0]
    v_pk_mul_f32 v[152:153], v[152:153], v[48:49] op_sel_hi:[1,0]
    v_mul_f32 v110, v110, v51
    v_fma_f32 v78, v78, s28, v12
    v_mul_f32 v203, v203, v49
    v_cvt_pk_bf16_f32 v200, v200, v201
    v_fma_f32 v90, v90, s28, v13
    v_mul_f32 v187, v187, v49
    v_pk_mul_f32 v[250:251], v[250:251], v[50:51] op_sel_hi:[1,0]
    v_mul_f32 v108, v108, v51
    v_pk_mul_f32 v[242:243], v[242:243], v[50:51] op_sel_hi:[1,0]
    v_pk_mul_f32 v[254:255], v[254:255], v[50:51] op_sel_hi:[1,0]
    v_cvt_pk_bf16_f32 v196, v196, v197
    v_pk_mul_f32 v[246:247], v[246:247], v[50:51] op_sel_hi:[1,0]
    v_cvt_pk_bf16_f32 v244, v244, v245
    v_exp_f32 v84, v84
    v_mfma_f32_16x16x32_bf16 v[44:47], a[244:247], v[26:29], v[44:47]
    s_add_u32 m0, s22, 14336
    ds_read_b64_tr_b16 a[224:225], v5 offset:0
    v_cvt_pk_bf16_f32 v217, v218, v219
    v_mfma_f32_16x16x32_bf16 v[44:47], a[248:251], v[32:35], v[44:47]
    ds_read_b64_tr_b16 a[232:233], v3 offset:1024
    v_cvt_pk_bf16_f32 v105, v106, v107
    v_fma_f32 v55, v55, s28, v9
    v_cvt_pk_bf16_f32 v189, v190, v191
    v_mfma_f32_16x16x32_bf16 v[160:163], a[212:215], v[20:23], 0
    ds_write2st64_b64 v101, v[216:217], v[104:105] offset0:24 offset1:36
    v_cvt_pk_bf16_f32 v136, v136, v137
    v_cvt_pk_bf16_f32 v181, v182, v183
    v_xor_b32 v101, 32, v101
    v_cvt_pk_bf16_f32 v108, v108, v109
    v_cvt_pk_bf16_f32 v109, v110, v111
    v_mfma_f32_16x16x32_bf16 v[208:211], a[212:215], v[26:29], 0
    buffer_load_dwordx4 v6, s[4:7], s20 offen lds
    ds_write2st64_b64 v101, v[124:125], v[172:173] offset0:0 offset1:12
    v_cvt_pk_bf16_f32 v236, v236, v237
    v_pk_mul_f32 v[156:157], v[156:157], v[48:49] op_sel_hi:[1,0]
    v_pk_mul_f32 v[134:135], v[134:135], v[48:49] op_sel_hi:[1,0]
    v_accvgpr_read_b32 v111, a23
    v_accvgpr_read_b32 v110, a22
    v_accvgpr_read_b32 v107, a19
    v_mfma_f32_16x16x32_bf16 v[212:215], a[216:219], v[26:29], 0
    ds_read_b128 v[96:99], v8 offset:0
    v_cvt_pk_bf16_f32 v137, v138, v139
    v_mfma_f32_16x16x32_bf16 a[4:7], a[216:219], v[32:35], 0
    ds_read_b64_tr_b16 a[228:229], v2 offset:1024
    v_cvt_pk_bf16_f32 v128, v128, v129
    v_mfma_f32_16x16x32_bf16 a[0:3], a[212:215], v[32:35], 0
    ds_write2st64_b64 v101, v[220:221], v[108:109] offset0:24 offset1:36
    v_accvgpr_read_b32 v109, a21
    v_mfma_f32_16x16x32_bf16 a[48:51], a[212:215], v[38:41], 0
    ds_read_b64_tr_b16 a[226:227], v5 offset:6144
    v_accvgpr_read_b32 v106, a18
    v_fma_f32 v63, v63, s28, v10
    v_cvt_pk_bf16_f32 v148, v148, v149
    v_fma_f32 v52, v52, s28, v9
    v_mul_f32 v109, v109, v51
    v_fma_f32 v83, v83, s28, v12
    v_accvgpr_read_b32 v105, a17
    v_accvgpr_read_b32 v104, a16
    v_cvt_pk_bf16_f32 v129, v130, v131
    v_mul_f32 v104, v104, v51
    v_cvt_pk_bf16_f32 v144, v144, v145
    v_pk_mul_f32 v[252:253], v[252:253], v[50:51] op_sel_hi:[1,0]
    v_mul_f32 v105, v105, v51
    v_mul_f32 v107, v107, v51
    v_exp_f32 v52, v52
    v_pk_mul_f32 v[230:231], v[230:231], v[50:51] op_sel_hi:[1,0]
    v_accvgpr_read_b32 v108, a20
    v_cvt_pk_bf16_f32 v240, v240, v241
    v_cvt_pk_bf16_f32 v140, v140, v141
    v_exp_f32 v55, v55
    v_pk_mul_f32 v[158:159], v[158:159], v[48:49] op_sel_hi:[1,0]
    v_mul_f32 v199, v199, v49
    v_mul_f32 v108, v108, v51
    v_cvt_pk_bf16_f32 v184, v184, v185
    v_pk_mul_f32 v[154:155], v[154:155], v[48:49] op_sel_hi:[1,0]
    v_fma_f32 v85, v85, s28, v13
    v_cvt_pk_bf16_f32 v104, v104, v105
    v_mfma_f32_16x16x32_bf16 a[52:55], a[216:219], v[38:41], 0
    s_add_u32 s20, s20, 12032
    ds_read_b64_tr_b16 a[216:217], v5 offset:1024
    v_mul_f32 v111, v111, v51
    v_cvt_pk_bf16_f32 v108, v108, v109
    v_mul_f32 v106, v106, v51
    v_fma_f32 v87, v87, s28, v13
    v_cvt_pk_bf16_f32 v237, v238, v239
    v_mfma_f32_16x16x32_bf16 v[44:47], a[252:255], v[38:41], v[44:47]
    s_waitcnt lgkmcnt(1)
    ds_read_b64_tr_b16 a[230:231], v2 offset:7168
    v_mul_f32 v110, v110, v51
    v_mfma_f32_16x16x32_bf16 a[56:59], a[220:223], v[38:41], 0
    ds_read_b64_tr_b16 a[218:219], v5 offset:7168
    v_cvt_pk_bf16_f32 v241, v242, v243
    v_exp_f32 v70, v70
    v_mfma_f32_16x16x32_bf16 a[60:63], a[224:227], v[38:41], 0
    ds_read_b64_tr_b16 a[234:235], v3 offset:7168
    v_cvt_pk_bf16_f32 v192, v192, v193
    v_exp_f32 v79, v79
    v_cvt_pk_bf16_f32 v133, v134, v135
    v_cvt_pk_bf16_f32 v177, v178, v179
    v_cvt_pk_bf16_f32 v105, v106, v107
    v_cvt_pk_bf16_f32 v201, v202, v203
    v_cvt_pk_bf16_f32 v229, v230, v231
    v_exp_f32 v68, v68
    v_xor_b32 v101, 96, v101
    v_mfma_f32_16x16x32_bf16 a[12:15], a[224:227], v[32:35], 0
    s_add_u32 m0, s38, 0
    ds_write2st64_b64 v101, v[128:129], v[176:177] offset0:4 offset1:16
    v_mfma_f32_16x16x32_bf16 a[8:11], a[220:223], v[32:35], 0
    ds_write2st64_b64 v101, v[224:225], v[104:105] offset0:28 offset1:40
    v_mfma_f32_16x16x32_bf16 v[216:219], a[220:223], v[26:29], 0
    buffer_load_dwordx4 v6, s[12:15], s33 offen nt lds
    v_cvt_pk_bf16_f32 v185, v186, v187
    v_mfma_f32_16x16x32_bf16 v[220:223], a[224:227], v[26:29], 0
    v_exp_f32 v69, v69
    v_mfma_f32_16x16x32_bf16 v[172:175], a[224:227], v[20:23], 0
    buffer_store_dwordx4 v[96:99], v102, s[16:19], s67 offen offset:0 nt
    ds_read_b64_tr_b16 a[212:213], v4 offset:1024
    v_accvgpr_read_b32 v107, a27
    v_fma_f32 v59, v59, s28, v9
    v_accvgpr_read_b32 v106, a26
    v_accvgpr_read_b32 v104, a24
    v_xor_b32 v101, 32, v101
    v_pk_mul_f32 v[150:151], v[150:151], v[48:49] op_sel_hi:[1,0]
    v_exp_f32 v78, v78
    v_mul_f32 v107, v107, v51
    v_mfma_f32_16x16x32_bf16 v[168:171], a[220:223], v[20:23], 0
    ds_read_b128 v[96:99], v8 offset:1024
    v_cvt_pk_bf16_f32 v141, v142, v143
    v_accvgpr_read_b32 v105, a25
    v_cvt_pk_bf16_f32 v109, v110, v111
    v_fma_f32 v66, v66, s28, v10
    v_mfma_f32_16x16x32_bf16 v[120:123], a[220:223], v[14:17], 0
    ds_write2st64_b64 v101, v[132:133], v[180:181] offset0:4 offset1:16
    v_mul_f32 v104, v104, v51
    v_cvt_pk_bf16_f32 v149, v150, v151
    v_mul_f32 v105, v105, v51
    v_accvgpr_read_b32 v111, a31
    v_mul_f32 v106, v106, v51
    v_accvgpr_read_b32 v110, a30
    v_mfma_f32_16x16x32_bf16 v[124:127], a[224:227], v[14:17], 0
    s_waitcnt lgkmcnt(3)
    ds_read_b64_tr_b16 a[220:221], v2 offset:2048
    v_cvt_pk_bf16_f32 v232, v232, v233
    v_mfma_f32_16x16x32_bf16 v[128:131], a[228:231], v[14:17], 0
    ds_read_b64_tr_b16 a[222:223], v2 offset:8192
    v_mul_f32 v194, v194, v49
    v_mfma_f32_16x16x32_bf16 v[132:135], a[232:235], v[14:17], 0
    ds_write2st64_b64 v101, v[228:229], v[108:109] offset0:28 offset1:40
    v_pk_mul_f32 v[146:147], v[146:147], v[48:49] op_sel_hi:[1,0]
    v_pk_mul_f32 v[248:249], v[248:249], v[50:51] op_sel_hi:[1,0]
    v_cvt_pk_bf16_f32 v156, v156, v157
    v_accvgpr_read_b32 v109, a29
    v_xor_b32 v101, 96, v101
    v_mfma_f32_16x16x32_bf16 v[180:183], a[232:235], v[20:23], 0
    ds_read_b64_tr_b16 a[226:227], v3 offset:8192
    v_mul_f32 v110, v110, v51
    v_cvt_pk_bf16_f32 v233, v234, v235
    v_cvt_pk_bf16_f32 v152, v152, v153
    v_fma_f32 v64, v64, s28, v10
    v_mul_f32 v109, v109, v51
    v_mfma_f32_16x16x32_bf16 v[176:179], a[228:231], v[20:23], 0
    ds_read_b64_tr_b16 a[214:215], v4 offset:7168
    v_cvt_pk_bf16_f32 v197, v198, v199
    v_cvt_pk_bf16_f32 v30, v68, v69
    v_accvgpr_read_b32 v108, a28
    v_cvt_pk_bf16_f32 v104, v104, v105
    v_mfma_f32_16x16x32_bf16 v[224:227], a[228:231], v[26:29], 0
    ds_write2st64_b64 v101, v[136:137], v[184:185] offset0:4 offset1:16
    v_mfma_f32_16x16x32_bf16 v[228:231], a[232:235], v[26:29], 0
    v_cvt_pk_bf16_f32 v248, v248, v249
    v_cvt_pk_bf16_f32 v105, v106, v107
    v_mul_f32 v108, v108, v51
    v_exp_f32 v73, v73
    v_mul_f32 v111, v111, v51
    v_cvt_pk_bf16_f32 v108, v108, v109
    v_mfma_f32_16x16x32_bf16 a[20:23], a[232:235], v[32:35], 0
    ds_write2st64_b64 v101, v[232:233], v[104:105] offset0:28 offset1:40
    v_accvgpr_read_b32 v106, a34
    v_cvt_pk_bf16_f32 v145, v146, v147
    v_xor_b32 v101, 32, v101
    v_mfma_f32_16x16x32_bf16 a[16:19], a[228:231], v[32:35], 0
    v_cvt_pk_bf16_f32 v153, v154, v155
    v_accvgpr_read_b32 v107, a35
    v_cvt_pk_bf16_f32 v252, v252, v253
    v_cvt_pk_bf16_f32 v109, v110, v111
    v_accvgpr_read_b32 v110, a38
    v_fma_f32 v56, v56, s28, v9
    v_mfma_f32_16x16x32_bf16 a[64:67], a[228:231], v[38:41], 0
    ds_write2st64_b64 v101, v[140:141], v[188:189] offset0:4 offset1:16
    v_mfma_f32_16x16x32_bf16 a[68:71], a[232:235], v[38:41], 0
    s_waitcnt lgkmcnt(2)
    ds_read_b64_tr_b16 a[228:229], v4 offset:2048
    v_accvgpr_read_b32 v105, a33
    v_mfma_f32_16x16x32_bf16 a[72:75], a[212:215], v[38:41], 0
    ds_read_b64_tr_b16 a[230:231], v4 offset:8192
    v_accvgpr_read_b32 v104, a32
    v_cvt_pk_bf16_f32 v157, v158, v159
    v_accvgpr_read_b32 v111, a39
    v_mfma_f32_16x16x32_bf16 a[76:79], a[216:219], v[38:41], 0
    s_add_u32 m0, s38, 1024
    ds_write2st64_b64 v101, v[236:237], v[108:109] offset0:28 offset1:40
    v_mfma_f32_16x16x32_bf16 a[28:31], a[216:219], v[32:35], 0
    buffer_load_dwordx4 v7, s[12:15], s33 offen nt lds
    ds_read_b64_tr_b16 a[232:233], v5 offset:2048
    v_mul_f32 v110, v110, v51
    v_accvgpr_read_b32 v109, a37
    v_cvt_pk_bf16_f32 v31, v70, v71
    v_accvgpr_read_b32 v108, a36
    v_mfma_f32_16x16x32_bf16 a[24:27], a[212:215], v[32:35], 0
    ds_read_b64_tr_b16 a[234:235], v5 offset:8192
    v_mul_f32 v104, v104, v51
    v_mul_f32 v109, v109, v51
    v_mul_f32 v108, v108, v51
    v_mul_f32 v107, v107, v51
    v_mfma_f32_16x16x32_bf16 v[232:235], a[212:215], v[26:29], 0
    ds_read_b64_tr_b16 a[224:225], v3 offset:2048
    v_mul_f32 v106, v106, v51
    v_mfma_f32_16x16x32_bf16 v[236:239], a[216:219], v[26:29], 0
    s_add_u32 s39, s39, 12288
    v_mul_f32 v105, v105, v51
    v_cvt_pk_bf16_f32 v193, v194, v195
    v_mul_f32 v111, v111, v51
    v_cvt_pk_bf16_f32 v245, v246, v247
    v_cvt_pk_bf16_f32 v108, v108, v109
    v_cvt_pk_bf16_f32 v253, v254, v255
    v_mfma_f32_16x16x32_bf16 v[188:191], a[216:219], v[20:23], 0
    v_xor_b32 v101, 96, v101
    v_cvt_pk_bf16_f32 v104, v104, v105
    v_mfma_f32_16x16x32_bf16 v[184:187], a[212:215], v[20:23], 0
    ds_write2st64_b64 v101, v[144:145], v[192:193] offset0:8 offset1:20
    v_cvt_pk_bf16_f32 v105, v106, v107
    v_fma_f32 v57, v57, s28, v9
    v_mfma_f32_16x16x32_bf16 v[136:139], a[212:215], v[14:17], 0
    ds_write2st64_b64 v101, v[240:241], v[104:105] offset0:32 offset1:44
    v_mfma_f32_16x16x32_bf16 v[140:143], a[216:219], v[14:17], 0
    v_xor_b32 v101, 32, v101
    v_cvt_pk_bf16_f32 v109, v110, v111
    v_accvgpr_read_b32 v107, a43
    v_exp_f32 v76, v76
    v_mfma_f32_16x16x32_bf16 v[144:147], a[220:223], v[14:17], 0
    s_waitcnt vmcnt(9) lgkmcnt(2)
    buffer_store_dwordx4 v[96:99], v103, s[16:19], s67 offen offset:0 nt
    s_barrier
    ds_write2st64_b64 v101, v[148:149], v[196:197] offset0:8 offset1:20
    v_accvgpr_read_b32 v105, a41
    v_accvgpr_read_b32 v110, a46
    v_fma_f32 v80, v80, s28, v12
    v_cvt_pk_bf16_f32 v24, v60, v61
    v_mfma_f32_16x16x32_bf16 v[148:151], a[224:227], v[14:17], 0
    v_mul_f32 v107, v107, v51
    v_cvt_pk_bf16_f32 v249, v250, v251
    v_mfma_f32_16x16x32_bf16 v[196:199], a[224:227], v[20:23], 0
    ds_write2st64_b64 v101, v[244:245], v[108:109] offset0:32 offset1:44
    v_mfma_f32_16x16x32_bf16 v[192:195], a[220:223], v[20:23], 0
    v_accvgpr_read_b32 v108, a44
    v_exp_f32 v87, v87
    v_accvgpr_read_b32 v104, a40
    v_mfma_f32_16x16x32_bf16 v[240:243], a[220:223], v[26:29], 0
    s_add_u32 m0, s22, 24576
    v_accvgpr_read_b32 v111, a47
    v_fma_f32 v91, v91, s28, v13
    v_exp_f32 v85, v85
    v_fma_f32 v82, v82, s28, v12
    v_mul_f32 v104, v104, v51
    v_accvgpr_read_b32 v106, a42
    v_mul_f32 v105, v105, v51
    v_exp_f32 v54, v54
    v_mfma_f32_16x16x32_bf16 v[244:247], a[224:227], v[26:29], 0
    buffer_load_dwordx4 v6, s[8:11], s21 offen lds
    v_mfma_f32_16x16x32_bf16 a[36:39], a[224:227], v[32:35], 0
    ds_read_b128 a[212:215], v0 offset:0
    v_mul_f32 v111, v111, v51
    v_mul_f32 v106, v106, v51
    v_cvt_pk_bf16_f32 v37, v78, v79
    v_mul_f32 v108, v108, v51
    v_mfma_f32_16x16x32_bf16 a[32:35], a[220:223], v[32:35], 0
    ds_read_b128 a[216:219], v1 offset:0
    v_accvgpr_read_b32 v109, a45
    v_cvt_pk_bf16_f32 v19, v54, v55
    v_mfma_f32_16x16x32_bf16 a[80:83], a[220:223], v[38:41], 0
    ds_read_b128 v[96:99], v8 offset:2048
    v_mul_f32 v110, v110, v51
    v_mfma_f32_16x16x32_bf16 a[84:87], a[224:227], v[38:41], 0
    v_cvt_pk_bf16_f32 v104, v104, v105
    v_cvt_pk_bf16_f32 v105, v106, v107
    v_xor_b32 v101, 96, v101
    v_mul_f32 v109, v109, v51
    v_mfma_f32_16x16x32_bf16 a[88:91], a[228:231], v[38:41], 0
    ds_write2st64_b64 v101, v[152:153], v[200:201] offset0:8 offset1:20
    v_cvt_pk_bf16_f32 v108, v108, v109
    v_mfma_f32_16x16x32_bf16 a[92:95], a[232:235], v[38:41], 0
    ds_write2st64_b64 v101, v[248:249], v[104:105] offset0:32 offset1:44
    v_xor_b32 v101, 32, v101
    v_exp_f32 v62, v62
    v_mfma_f32_16x16x32_bf16 a[44:47], a[232:235], v[32:35], 0
    s_add_u32 s21, s21, 128
    ds_read_b128 a[220:223], v0 offset:1024
    v_cvt_pk_bf16_f32 v109, v110, v111
    v_mfma_f32_16x16x32_bf16 a[40:43], a[228:231], v[32:35], 0
    ds_write2st64_b64 v101, v[156:157], v[204:205] offset0:8 offset1:20
    v_mfma_f32_16x16x32_bf16 v[248:251], a[228:231], v[26:29], 0
    ds_write2st64_b64 v101, v[252:253], v[108:109] offset0:32 offset1:44
    v_mfma_f32_16x16x32_bf16 v[252:255], a[232:235], v[26:29], 0
    v_exp_f32 v58, v58
    v_mfma_f32_16x16x32_bf16 v[204:207], a[232:235], v[20:23], 0
    s_add_u32 m0, s22, 25600
    v_exp_f32 v59, v59
    v_exp_f32 v63, v63
    v_mfma_f32_16x16x32_bf16 v[200:203], a[228:231], v[20:23], 0
    v_exp_f32 v86, v86
    v_cvt_pk_bf16_f32 v36, v76, v77
    v_mfma_f32_16x16x32_bf16 v[152:155], a[228:231], v[14:17], 0
    ds_read_b128 a[224:227], v1 offset:1024
    v_cvt_pk_bf16_f32 v25, v62, v63
    v_mfma_f32_16x16x32_bf16 v[156:159], a[232:235], v[14:17], 0
    s_waitcnt lgkmcnt(4)
    v_cvt_pk_bf16_f32 v18, v52, v53
    v_fma_f32 v81, v81, s28, v12
    v_mfma_f32_16x16x32_bf16 v[52:55], a[212:215], a[96:99], 0
    buffer_load_dwordx4 v6, s[8:11], s21 offen lds
    v_mfma_f32_16x16x32_bf16 v[52:55], a[216:219], a[100:103], v[52:55]
    s_waitcnt lgkmcnt(2)
    ds_read_b128 a[228:231], v0 offset:2048
    v_cvt_pk_bf16_f32 v42, v84, v85
    v_mfma_f32_16x16x32_bf16 v[52:55], a[220:223], a[104:107], v[52:55]
    s_add_u32 s21, s21, 128
    v_exp_f32 v91, v91
    v_mfma_f32_16x16x32_bf16 v[60:63], a[220:223], a[128:131], 0
    v_exp_f32 v66, v66
    v_mfma_f32_16x16x32_bf16 v[60:63], a[216:219], a[124:127], v[60:63]
    ds_read_b128 a[232:235], v1 offset:2048
    v_exp_f32 v57, v57
    v_mfma_f32_16x16x32_bf16 v[60:63], a[212:215], a[120:123], v[60:63]
    s_add_u32 m0, s22, 26624
    v_fma_f32 v72, v72, s28, v11
    v_exp_f32 v88, v88
    v_mfma_f32_16x16x32_bf16 v[68:71], a[212:215], a[144:147], 0
    buffer_load_dwordx4 v6, s[8:11], s21 offen lds
    v_mfma_f32_16x16x32_bf16 v[68:71], a[216:219], a[148:151], v[68:71]
    s_add_u32 s21, s21, 12032
    v_exp_f32 v64, v64
    v_mfma_f32_16x16x32_bf16 v[68:71], a[220:223], a[152:155], v[68:71]
    v_exp_f32 v80, v80
    v_mfma_f32_16x16x32_bf16 v[76:79], a[220:223], a[176:179], 0
    v_cvt_pk_bf16_f32 v17, v58, v59
    v_cvt_pk_bf16_f32 v43, v86, v87
    v_mfma_f32_16x16x32_bf16 v[76:79], a[216:219], a[172:175], v[76:79]
    s_add_u32 s56, s67, 128
    v_exp_f32 v56, v56
    v_mfma_f32_16x16x32_bf16 v[76:79], a[212:215], a[168:171], v[76:79]
    v_exp_f32 v81, v81
    v_mfma_f32_16x16x32_bf16 v[84:87], a[212:215], a[192:195], 0
    v_fma_f32 v89, v89, s28, v13
    v_fma_f32 v75, v75, s28, v11
    v_mfma_f32_16x16x32_bf16 v[84:87], a[216:219], a[196:199], v[84:87]
    buffer_store_dwordx4 v[96:99], v102, s[16:19], s56 offen offset:0 nt
    v_exp_f32 v83, v83
    v_cvt_pk_bf16_f32 v16, v56, v57
    v_mfma_f32_16x16x32_bf16 v[84:87], a[220:223], a[200:203], v[84:87]
    s_waitcnt lgkmcnt(0)
    ds_read_b128 a[212:215], v0 offset:6144
    v_fma_f32 v67, v67, s28, v10
    v_mfma_f32_16x16x32_bf16 v[84:87], a[224:227], a[204:207], v[84:87]
    v_exp_f32 v72, v72
    v_mfma_f32_16x16x32_bf16 v[84:87], a[228:231], a[208:211], v[84:87]
    v_fma_f32 v65, v65, s28, v10
    v_cvt_pk_bf16_f32 v28, v72, v73
    v_mfma_f32_16x16x32_bf16 v[84:87], a[232:235], v[92:95], v[84:87]
    v_exp_f32 v90, v90
    v_mfma_f32_16x16x32_bf16 v[76:79], a[232:235], a[188:191], v[76:79]
    s_add_u32 s58, s33, 128
    v_exp_f32 v67, v67
    v_mfma_f32_16x16x32_bf16 v[76:79], a[228:231], a[184:187], v[76:79]
    s_add_u32 m0, s38, 2048
    v_exp_f32 v89, v89
    v_mfma_f32_16x16x32_bf16 v[48:51], a[236:239], v[16:19], v[44:47]
    buffer_load_dwordx4 v6, s[12:15], s58 offen nt lds
    v_mfma_f32_16x16x32_bf16 v[76:79], a[224:227], a[180:183], v[76:79]
    v_exp_f32 v65, v65
    v_mfma_f32_16x16x32_bf16 v[68:71], a[224:227], a[156:159], v[68:71]
    v_exp_f32 v75, v75
    v_mfma_f32_16x16x32_bf16 v[68:71], a[228:231], a[160:163], v[68:71]
    ds_read_b128 v[96:99], v8 offset:3072
    v_mfma_f32_16x16x32_bf16 v[68:71], a[232:235], a[164:167], v[68:71]
    v_exp_f32 v74, v74
    v_mfma_f32_16x16x32_bf16 v[60:63], a[232:235], a[140:143], v[60:63]
    ds_read_b128 a[216:219], v1 offset:6144
    v_cvt_pk_bf16_f32 v22, v64, v65
    v_mfma_f32_16x16x32_bf16 v[60:63], a[228:231], a[136:139], v[60:63]
    ds_read_b128 a[220:223], v0 offset:7168
    v_cvt_pk_bf16_f32 v23, v66, v67
    v_mfma_f32_16x16x32_bf16 v[60:63], a[224:227], a[132:135], v[60:63]
    v_cvt_pk_bf16_f32 v40, v88, v89
    v_cvt_pk_bf16_f32 v34, v80, v81
    v_mfma_f32_16x16x32_bf16 v[52:55], a[224:227], a[108:111], v[52:55]
    v_exp_f32 v82, v82
    v_mfma_f32_16x16x32_bf16 v[52:55], a[228:231], a[112:115], v[52:55]
    v_cvt_pk_bf16_f32 v35, v82, v83
    v_cvt_pk_bf16_f32 v29, v74, v75
    v_mfma_f32_16x16x32_bf16 v[48:51], a[240:243], v[22:25], v[48:51]
    ds_read_b128 a[228:231], v0 offset:8192
    s_add_u32 m0, s38, 3072
    v_mfma_f32_16x16x32_bf16 v[48:51], a[244:247], v[28:31], v[48:51]
    v_cvt_pk_bf16_f32 v41, v90, v91
    v_mfma_f32_16x16x32_bf16 v[48:51], a[248:251], v[34:37], v[48:51]
    ds_read_b128 a[224:227], v1 offset:7168
    v_mfma_f32_16x16x32_bf16 v[48:51], a[252:255], v[40:43], v[48:51]
    v_mfma_f32_16x16x32_bf16 v[52:55], a[232:235], a[116:119], v[52:55]
    s_waitcnt lgkmcnt(4)
    ds_read_b128 a[232:235], v1 offset:8192
    v_mfma_f32_16x16x32_bf16 v[56:59], a[212:215], a[96:99], 0
    s_waitcnt lgkmcnt(4)
    v_add_u32 v8, 4096, v8
    v_mfma_f32_16x16x32_bf16 v[56:59], a[216:219], a[100:103], v[56:59]
    s_nop 0
    v_cmp_lt_f32 vcc, s29, v48
    s_waitcnt lgkmcnt(3)
    v_mfma_f32_16x16x32_bf16 v[56:59], a[220:223], a[104:107], v[56:59]
    buffer_load_dwordx4 v7, s[12:15], s58 offen nt lds
    v_mfma_f32_16x16x32_bf16 v[64:67], a[220:223], a[128:131], 0
    v_mfma_f32_16x16x32_bf16 v[64:67], a[216:219], a[124:127], v[64:67]
    s_cbranch_vccnz L_rs_tr45d
L_ret_tr45d:
    v_mfma_f32_16x16x32_bf16 v[64:67], a[212:215], a[120:123], v[64:67]
    v_fma_f32 v52, v52, s28, v9
    v_fma_f32 v53, v53, s28, v9
    v_mfma_f32_16x16x32_bf16 v[72:75], a[212:215], a[144:147], 0
    v_fma_f32 v63, v63, s28, v10
    v_mfma_f32_16x16x32_bf16 v[72:75], a[216:219], a[148:151], v[72:75]
    v_fma_f32 v61, v61, s28, v10
    v_fma_f32 v54, v54, s28, v9
    v_mfma_f32_16x16x32_bf16 v[72:75], a[220:223], a[152:155], v[72:75]
    buffer_store_dwordx4 v[96:99], v103, s[16:19], s56 offen offset:0 nt
    s_waitcnt vmcnt(14) lgkmcnt(0)
    s_barrier
    v_fma_f32 v55, v55, s28, v9
    v_mfma_f32_16x16x32_bf16 v[80:83], a[220:223], a[176:179], 0
    v_fma_f32 v60, v60, s28, v10
    v_mfma_f32_16x16x32_bf16 v[80:83], a[216:219], a[172:175], v[80:83]
    v_exp_f32 v53, v53
    v_mfma_f32_16x16x32_bf16 v[80:83], a[212:215], a[168:171], v[80:83]
    v_exp_f32 v60, v60
    v_mfma_f32_16x16x32_bf16 v[88:91], a[212:215], a[192:195], 0
    v_exp_f32 v52, v52
    v_mfma_f32_16x16x32_bf16 v[88:91], a[216:219], a[196:199], v[88:91]
    v_exp_f32 v61, v61
    v_mfma_f32_16x16x32_bf16 v[88:91], a[220:223], a[200:203], v[88:91]
    s_add_u32 m0, s22, 0
    v_exp_f32 v63, v63
    v_mfma_f32_16x16x32_bf16 v[88:91], a[224:227], a[204:207], v[88:91]
    ds_read_b64_tr_b16 a[212:213], v2 offset:18432
    v_mfma_f32_16x16x32_bf16 v[88:91], a[228:231], a[208:211], v[88:91]
    ds_read_b64_tr_b16 a[214:215], v2 offset:12288
    v_fma_f32 v62, v62, s28, v10
    v_mfma_f32_16x16x32_bf16 v[88:91], a[232:235], v[92:95], v[88:91]
    buffer_load_dwordx4 v6, s[4:7], s20 offen lds
    v_mfma_f32_16x16x32_bf16 v[80:83], a[232:235], a[188:191], v[80:83]
    s_add_u32 s20, s20, 128
    ds_read_b64_tr_b16 a[216:217], v3 offset:18432
    v_cvt_pk_bf16_f32 v14, v52, v53
    v_mfma_f32_16x16x32_bf16 v[80:83], a[228:231], a[184:187], v[80:83]
    v_exp_f32 v55, v55
    v_mfma_f32_16x16x32_bf16 v[80:83], a[224:227], a[180:183], v[80:83]
    ds_read_b64_tr_b16 a[218:219], v3 offset:12288
    v_mfma_f32_16x16x32_bf16 v[72:75], a[224:227], a[156:159], v[72:75]
    ds_read_b64_tr_b16 a[220:221], v4 offset:18432
    s_add_u32 m0, s22, 1024
    v_mfma_f32_16x16x32_bf16 v[72:75], a[228:231], a[160:163], v[72:75]
    buffer_load_dwordx4 v6, s[4:7], s20 offen lds
    v_mfma_f32_16x16x32_bf16 v[72:75], a[232:235], a[164:167], v[72:75]
    v_cvt_pk_bf16_f32 v20, v60, v61
    v_mfma_f32_16x16x32_bf16 v[64:67], a[232:235], a[140:143], v[64:67]
    v_exp_f32 v62, v62
    v_mfma_f32_16x16x32_bf16 v[64:67], a[228:231], a[136:139], v[64:67]
    s_add_u32 s20, s20, 128
    s_add_u32 m0, s22, 2048
    ds_read_b64_tr_b16 a[222:223], v4 offset:12288
    v_mfma_f32_16x16x32_bf16 v[64:67], a[224:227], a[132:135], v[64:67]
    buffer_load_dwordx4 v6, s[4:7], s20 offen lds
    v_mfma_f32_16x16x32_bf16 v[56:59], a[224:227], a[108:111], v[56:59]
    ds_read_b64_tr_b16 a[224:225], v5 offset:18432
    v_cvt_pk_bf16_f32 v21, v62, v63
    v_mfma_f32_16x16x32_bf16 v[56:59], a[228:231], a[112:115], v[56:59]
    v_exp_f32 v54, v54
    v_mfma_f32_16x16x32_bf16 v[56:59], a[232:235], a[116:119], v[56:59]
    s_add_u32 s20, s20, 12032
    ds_read_b64_tr_b16 a[226:227], v5 offset:12288
    v_cvt_pk_bf16_f32 v15, v54, v55
    s_branch L_loop5
L_tr44:
    s_waitcnt lgkmcnt(4)
    v_mfma_f32_16x16x32_bf16 v[112:115], a[212:215], v[16:19], v[112:115]
    ds_read_b64_tr_b16 a[230:231], v2 offset:13312
    v_fma_f32 v80, v80, s28, v12
    v_mfma_f32_16x16x32_bf16 v[116:119], a[216:219], v[16:19], v[116:119]
    ds_read_b64_tr_b16 a[232:233], v3 offset:19456
    v_fma_f32 v72, v72, s28, v11
    v_mfma_f32_16x16x32_bf16 v[164:167], a[216:219], v[22:25], v[164:167]
    ds_read_b64_tr_b16 a[228:229], v2 offset:19456
    v_fma_f32 v65, v65, s28, v10
    v_mfma_f32_16x16x32_bf16 v[160:163], a[212:215], v[22:25], v[160:163]
    ds_read_b64_tr_b16 a[234:235], v3 offset:13312
    v_fma_f32 v70, v70, s28, v11
    v_mfma_f32_16x16x32_bf16 v[208:211], a[212:215], v[28:31], v[208:211]
    ds_read_b128 v[96:99], v8 offset:4096
    v_fma_f32 v75, v75, s28, v11
    v_mfma_f32_16x16x32_bf16 v[212:215], a[216:219], v[28:31], v[212:215]
    ds_read_b128 v[88:91], v8 offset:3072
    v_fma_f32 v71, v71, s28, v11
    v_mfma_f32_16x16x32_bf16 a[4:7], a[216:219], v[34:37], a[4:7]
    v_exp_f32 v70, v70
    v_mfma_f32_16x16x32_bf16 a[0:3], a[212:215], v[34:37], a[0:3]
    v_fma_f32 v64, v64, s28, v10
    s_waitcnt lgkmcnt(6)
    v_mfma_f32_16x16x32_bf16 a[8:11], a[220:223], v[34:37], a[8:11]
    ds_read_b64_tr_b16 a[212:213], v4 offset:19456
    v_fma_f32 v78, v78, s28, v12
    v_mfma_f32_16x16x32_bf16 a[12:15], a[224:227], v[34:37], a[12:15]
    ds_read_b64_tr_b16 a[218:219], v5 offset:13312
    v_fma_f32 v77, v77, s28, v12
    v_mfma_f32_16x16x32_bf16 v[220:223], a[224:227], v[28:31], v[220:223]
    v_exp_f32 v71, v71
    v_mfma_f32_16x16x32_bf16 v[216:219], a[220:223], v[28:31], v[216:219]
    ds_read_b64_tr_b16 a[214:215], v4 offset:13312
    v_fma_f32 v83, v83, s28, v12
    v_mfma_f32_16x16x32_bf16 v[168:171], a[220:223], v[22:25], v[168:171]
    v_fma_f32 v62, v62, s28, v10
    v_fma_f32 v67, v67, s28, v10
    v_mfma_f32_16x16x32_bf16 v[172:175], a[224:227], v[22:25], v[172:175]
    ds_read_b64_tr_b16 a[216:217], v5 offset:19456
    v_fma_f32 v63, v63, s28, v10
    v_mfma_f32_16x16x32_bf16 v[124:127], a[224:227], v[16:19], v[124:127]
    v_fma_f32 v74, v74, s28, v11
    v_fma_f32 v69, v69, s28, v11
    v_mfma_f32_16x16x32_bf16 v[120:123], a[220:223], v[16:19], v[120:123]
    s_waitcnt lgkmcnt(4)
    v_fma_f32 v56, v56, s28, v9
    v_fma_f32 v76, v76, s28, v12
    v_mfma_f32_16x16x32_bf16 v[128:131], a[228:231], v[16:19], v[128:131]
    ds_read_b64_tr_b16 a[224:225], v3 offset:20480
    s_add_u32 s39, s39, 12288
    v_mfma_f32_16x16x32_bf16 v[132:135], a[232:235], v[16:19], v[132:135]
    ds_read_b64_tr_b16 a[220:221], v2 offset:20480
    v_fma_f32 v68, v68, s28, v11
    v_mfma_f32_16x16x32_bf16 v[180:183], a[232:235], v[22:25], v[180:183]
    v_exp_f32 v56, v56
    v_mfma_f32_16x16x32_bf16 v[176:179], a[228:231], v[22:25], v[176:179]
    ds_read_b64_tr_b16 a[226:227], v3 offset:14336
    v_mfma_f32_16x16x32_bf16 v[224:227], a[228:231], v[28:31], v[224:227]
    v_fma_f32 v59, v59, s28, v9
    v_cvt_pk_bf16_f32 v27, v70, v71
    v_mfma_f32_16x16x32_bf16 v[228:231], a[232:235], v[28:31], v[228:231]
    ds_read_b64_tr_b16 a[222:223], v2 offset:14336
    v_mfma_f32_16x16x32_bf16 a[20:23], a[232:235], v[34:37], a[20:23]
    v_exp_f32 v77, v77
    v_mfma_f32_16x16x32_bf16 a[16:19], a[228:231], v[34:37], a[16:19]
    s_waitcnt lgkmcnt(4)
    ds_read_b64_tr_b16 a[230:231], v4 offset:14336
    v_mfma_f32_16x16x32_bf16 a[24:27], a[212:215], v[34:37], a[24:27]
    ds_read_b64_tr_b16 a[228:229], v4 offset:20480
    v_fma_f32 v66, v66, s28, v10
    v_mfma_f32_16x16x32_bf16 a[28:31], a[216:219], v[34:37], a[28:31]
    ds_read_b64_tr_b16 a[234:235], v5 offset:14336
    v_fma_f32 v82, v82, s28, v12
    v_mfma_f32_16x16x32_bf16 v[236:239], a[216:219], v[28:31], v[236:239]
    ds_read_b64_tr_b16 a[232:233], v5 offset:20480
    v_mfma_f32_16x16x32_bf16 v[232:235], a[212:215], v[28:31], v[232:235]
    v_exp_f32 v72, v72
    v_mfma_f32_16x16x32_bf16 v[184:187], a[212:215], v[22:25], v[184:187]
    v_exp_f32 v69, v69
    v_mfma_f32_16x16x32_bf16 v[188:191], a[216:219], v[22:25], v[188:191]
    ds_read_b128 v[84:87], v8 offset:2048
    v_mfma_f32_16x16x32_bf16 v[140:143], a[216:219], v[16:19], v[140:143]
    v_fma_f32 v79, v79, s28, v12
    v_fma_f32 v73, v73, s28, v11
    v_mfma_f32_16x16x32_bf16 v[136:139], a[212:215], v[16:19], v[136:139]
    s_waitcnt lgkmcnt(5)
    v_exp_f32 v62, v62
    v_mfma_f32_16x16x32_bf16 v[144:147], a[220:223], v[16:19], v[144:147]
    v_exp_f32 v68, v68
    v_mfma_f32_16x16x32_bf16 v[148:151], a[224:227], v[16:19], v[148:151]
    v_exp_f32 v79, v79
    v_mfma_f32_16x16x32_bf16 v[196:199], a[224:227], v[22:25], v[196:199]
    v_exp_f32 v73, v73
    v_mfma_f32_16x16x32_bf16 v[192:195], a[220:223], v[22:25], v[192:195]
    v_exp_f32 v80, v80
    v_mfma_f32_16x16x32_bf16 v[240:243], a[220:223], v[28:31], v[240:243]
    s_waitcnt vmcnt(10) lgkmcnt(1)
    v_exp_f32 v63, v63
    v_mfma_f32_16x16x32_bf16 v[244:247], a[224:227], v[28:31], v[244:247]
    s_barrier
    ds_read_b128 a[212:215], v0 offset:12288
    v_mfma_f32_16x16x32_bf16 a[36:39], a[224:227], v[34:37], a[36:39]
    s_add_u32 m0, s22, 36864
    ds_read_b128 a[216:219], v1 offset:12288
    v_cvt_pk_bf16_f32 v21, v62, v63
    v_mfma_f32_16x16x32_bf16 a[32:35], a[220:223], v[34:37], a[32:35]
    ds_read_b128 a[220:223], v0 offset:13312
    v_fma_f32 v58, v58, s28, v9
    v_mfma_f32_16x16x32_bf16 a[40:43], a[228:231], v[34:37], a[40:43]
    buffer_load_dwordx4 v6, s[8:11], s21 offen lds
    v_mfma_f32_16x16x32_bf16 a[44:47], a[232:235], v[34:37], a[44:47]
    s_add_u32 s21, s21, 128
    s_add_u32 m0, s22, 37888
    v_mfma_f32_16x16x32_bf16 v[252:255], a[232:235], v[28:31], v[252:255]
    ds_read_b128 a[224:227], v1 offset:13312
    v_fma_f32 v57, v57, s28, v9
    v_mfma_f32_16x16x32_bf16 v[248:251], a[228:231], v[28:31], v[248:251]
    buffer_load_dwordx4 v6, s[8:11], s21 offen lds
    v_mfma_f32_16x16x32_bf16 v[200:203], a[228:231], v[22:25], v[200:203]
    v_exp_f32 v74, v74
    v_mfma_f32_16x16x32_bf16 v[204:207], a[232:235], v[22:25], v[204:207]
    s_add_u32 s21, s21, 128
    v_exp_f32 v67, v67
    v_mfma_f32_16x16x32_bf16 v[156:159], a[232:235], v[16:19], v[156:159]
    s_add_u32 m0, s22, 38912
    v_exp_f32 v76, v76
    v_mfma_f32_16x16x32_bf16 v[152:155], a[228:231], v[16:19], v[152:155]
    s_waitcnt lgkmcnt(3)
    ds_read_b128 a[232:235], v1 offset:14336
    v_fma_f32 v81, v81, s28, v12
    v_mfma_f32_16x16x32_bf16 v[52:55], a[212:215], a[96:99], 0
    s_waitcnt lgkmcnt(3)
    v_mfma_f32_16x16x32_bf16 v[52:55], a[216:219], a[100:103], v[52:55]
    s_waitcnt lgkmcnt(2)
    v_exp_f32 v75, v75
    v_mfma_f32_16x16x32_bf16 v[52:55], a[220:223], a[104:107], v[52:55]
    buffer_load_dwordx4 v6, s[8:11], s21 offen lds
    v_mfma_f32_16x16x32_bf16 v[60:63], a[220:223], a[128:131], 0
    ds_read_b128 a[228:231], v0 offset:14336
    v_cvt_pk_bf16_f32 v26, v68, v69
    v_mfma_f32_16x16x32_bf16 v[60:63], a[216:219], a[124:127], v[60:63]
    s_add_u32 s21, s21, 12032
    v_exp_f32 v66, v66
    v_mfma_f32_16x16x32_bf16 v[60:63], a[212:215], a[120:123], v[60:63]
    v_exp_f32 v78, v78
    v_mfma_f32_16x16x32_bf16 v[68:71], a[212:215], a[144:147], 0
    v_cvt_pk_bf16_f32 v32, v76, v77
    v_cvt_pk_bf16_f32 v33, v78, v79
    v_mfma_f32_16x16x32_bf16 v[68:71], a[216:219], a[148:151], v[68:71]
    v_exp_f32 v58, v58
    v_mfma_f32_16x16x32_bf16 v[68:71], a[220:223], a[152:155], v[68:71]
    s_add_u32 s56, s24, 5888
    v_exp_f32 v81, v81
    v_mfma_f32_16x16x32_bf16 v[76:79], a[220:223], a[176:179], 0
    buffer_store_dwordx4 v[84:87], v102, s[16:19], s56 offen offset:0 nt
    v_exp_f32 v64, v64
    v_mfma_f32_16x16x32_bf16 v[76:79], a[216:219], a[172:175], v[76:79]
    v_mfma_f32_16x16x32_bf16 v[76:79], a[212:215], a[168:171], v[76:79]
    s_waitcnt lgkmcnt(1)
    v_exp_f32 v59, v59
    v_mfma_f32_16x16x32_bf16 v[76:79], a[224:227], a[180:183], v[76:79]
    s_waitcnt lgkmcnt(0)
    v_exp_f32 v57, v57
    v_mfma_f32_16x16x32_bf16 v[76:79], a[228:231], a[184:187], v[76:79]
    s_add_u32 s57, s24, 6016
    v_exp_f32 v65, v65
    v_mfma_f32_16x16x32_bf16 v[76:79], a[232:235], a[188:191], v[76:79]
    buffer_store_dwordx4 v[88:91], v103, s[16:19], s56 offen offset:0 nt
    ds_read_b128 a[216:219], v1 offset:18432
    v_cvt_pk_bf16_f32 v23, v66, v67
    v_cvt_pk_bf16_f32 v29, v74, v75
    v_mfma_f32_16x16x32_bf16 v[68:71], a[232:235], a[164:167], v[68:71]
    ds_read_b128 a[212:215], v0 offset:18432
    v_mfma_f32_16x16x32_bf16 v[68:71], a[228:231], a[160:163], v[68:71]
    buffer_store_dwordx4 v[96:99], v102, s[16:19], s57 offen offset:0 nt
    ds_read_b128 v[84:87], v8 offset:5120
    v_exp_f32 v82, v82
    v_mfma_f32_16x16x32_bf16 v[68:71], a[224:227], a[156:159], v[68:71]
    ds_read_b128 v[88:91], v8 offset:0
    v_mfma_f32_16x16x32_bf16 v[60:63], a[224:227], a[132:135], v[60:63]
    ds_read_b128 v[96:99], v8 offset:1024
    v_mfma_f32_16x16x32_bf16 v[60:63], a[228:231], a[136:139], v[60:63]
    s_add_u32 m0, s38, 22528
    ds_read_b128 a[220:223], v0 offset:19456
    v_cvt_pk_bf16_f32 v22, v64, v65
    v_mfma_f32_16x16x32_bf16 v[60:63], a[232:235], a[140:143], v[60:63]
    v_cvt_pk_bf16_f32 v16, v56, v57
    v_cvt_pk_bf16_f32 v17, v58, v59
    v_mfma_f32_16x16x32_bf16 v[52:55], a[232:235], a[116:119], v[52:55]
    ds_read_b128 a[232:235], v1 offset:20480
    v_cvt_pk_bf16_f32 v34, v80, v81
    v_mfma_f32_16x16x32_bf16 v[52:55], a[228:231], a[112:115], v[52:55]
    ds_read_b128 a[228:231], v0 offset:20480
    v_cvt_pk_bf16_f32 v28, v72, v73
    v_mfma_f32_16x16x32_bf16 v[52:55], a[224:227], a[108:111], v[52:55]
    ds_read_b128 a[224:227], v1 offset:19456
    v_mfma_f32_16x16x32_bf16 v[44:47], a[236:239], v[14:17], v[48:51]
    v_exp_f32 v83, v83
    v_mfma_f32_16x16x32_bf16 v[44:47], a[240:243], v[20:23], v[44:47]
    v_cvt_pk_bf16_f32 v35, v82, v83
    v_mfma_f32_16x16x32_bf16 v[44:47], a[244:247], v[26:29], v[44:47]
    s_nop 0
    v_mfma_f32_16x16x32_bf16 v[44:47], a[248:251], v[32:35], v[44:47]
    s_waitcnt lgkmcnt(5)
    v_mfma_f32_16x16x32_bf16 v[56:59], a[212:215], a[96:99], 0
    buffer_load_dwordx4 v6, s[12:15], s25 offen nt lds
    v_mfma_f32_16x16x32_bf16 v[56:59], a[216:219], a[100:103], v[56:59]
    s_add_u32 m0, s38, 23552
    s_waitcnt lgkmcnt(3)
    v_mfma_f32_16x16x32_bf16 v[56:59], a[220:223], a[104:107], v[56:59]
    s_nop 0
    v_cmp_lt_f32 vcc, s29, v44
    v_mfma_f32_16x16x32_bf16 v[64:67], a[220:223], a[128:131], 0
    buffer_load_dwordx4 v7, s[12:15], s25 offen nt lds
    v_mfma_f32_16x16x32_bf16 v[64:67], a[216:219], a[124:127], v[64:67]
    buffer_store_dwordx4 v[84:87], v103, s[16:19], s57 offen offset:0 nt
    s_waitcnt vmcnt(13) lgkmcnt(0)
    s_cbranch_vccnz L_rs_tr44a
L_ret_tr44a:
    s_add_u32 m0, s22, 12288
    v_mfma_f32_16x16x32_bf16 v[64:67], a[212:215], a[120:123], v[64:67]
    s_barrier
    v_mfma_f32_16x16x32_bf16 v[72:75], a[212:215], a[144:147], 0
    buffer_load_dwordx4 v6, s[4:7], s20 offen lds
    v_mfma_f32_16x16x32_bf16 v[72:75], a[216:219], a[148:151], v[72:75]
    s_add_u32 s20, s20, 128
    s_add_u32 m0, s22, 13312
    v_mfma_f32_16x16x32_bf16 v[72:75], a[220:223], a[152:155], v[72:75]
    buffer_load_dwordx4 v6, s[4:7], s20 offen lds
    v_mfma_f32_16x16x32_bf16 v[80:83], a[220:223], a[176:179], 0
    s_add_u32 s20, s20, 128
    s_add_u32 m0, s22, 14336
    v_fma_f32 v53, v53, s28, v9
    v_mfma_f32_16x16x32_bf16 v[80:83], a[216:219], a[172:175], v[80:83]
    buffer_load_dwordx4 v6, s[4:7], s20 offen lds
    v_mfma_f32_16x16x32_bf16 v[80:83], a[212:215], a[168:171], v[80:83]
    ds_read_b64_tr_b16 a[212:213], v2 offset:0
    v_fma_f32 v61, v61, s28, v10
    v_mfma_f32_16x16x32_bf16 v[80:83], a[224:227], a[180:183], v[80:83]
    ds_read_b64_tr_b16 a[214:215], v2 offset:6144
    v_mfma_f32_16x16x32_bf16 v[80:83], a[228:231], a[184:187], v[80:83]
    v_fma_f32 v55, v55, s28, v9
    v_fma_f32 v52, v52, s28, v9
    v_mfma_f32_16x16x32_bf16 v[80:83], a[232:235], a[188:191], v[80:83]
    buffer_store_dwordx4 v[88:91], v102, s[16:19], s24 offen offset:0 nt
    ds_read_b64_tr_b16 a[216:217], v3 offset:0
    v_exp_f32 v55, v55
    v_mfma_f32_16x16x32_bf16 v[72:75], a[232:235], a[164:167], v[72:75]
    ds_read_b64_tr_b16 a[218:219], v3 offset:6144
    v_fma_f32 v54, v54, s28, v9
    v_mfma_f32_16x16x32_bf16 v[72:75], a[228:231], a[160:163], v[72:75]
    v_exp_f32 v53, v53
    v_mfma_f32_16x16x32_bf16 v[72:75], a[224:227], a[156:159], v[72:75]
    s_add_u32 s20, s20, 12032
    v_exp_f32 v52, v52
    v_mfma_f32_16x16x32_bf16 v[64:67], a[224:227], a[132:135], v[64:67]
    ds_read_b64_tr_b16 a[220:221], v4 offset:0
    v_fma_f32 v60, v60, s28, v10
    v_mfma_f32_16x16x32_bf16 v[64:67], a[228:231], a[136:139], v[64:67]
    v_exp_f32 v54, v54
    v_mfma_f32_16x16x32_bf16 v[64:67], a[232:235], a[140:143], v[64:67]
    ds_read_b64_tr_b16 a[222:223], v4 offset:6144
    v_cvt_pk_bf16_f32 v18, v52, v53
    v_mfma_f32_16x16x32_bf16 v[56:59], a[232:235], a[116:119], v[56:59]
    v_exp_f32 v61, v61
    v_mfma_f32_16x16x32_bf16 v[56:59], a[228:231], a[112:115], v[56:59]
    v_exp_f32 v60, v60
    v_mfma_f32_16x16x32_bf16 v[56:59], a[224:227], a[108:111], v[56:59]
    ds_read_b64_tr_b16 a[224:225], v5 offset:0
    ds_read_b64_tr_b16 a[226:227], v5 offset:6144
    buffer_store_dwordx4 v[96:99], v103, s[16:19], s24 offen offset:0 nt
    v_cvt_pk_bf16_f32 v24, v60, v61
    v_cvt_pk_bf16_f32 v19, v54, v55
    s_waitcnt lgkmcnt(4)
    v_mfma_f32_16x16x32_bf16 v[112:115], a[212:215], v[14:17], v[112:115]
    v_fma_f32 v77, v77, s28, v12
    v_and_b32 v104, 0x3ff, v0
    v_fma_f32 v69, v69, s28, v11
    v_mfma_f32_16x16x32_bf16 v[116:119], a[216:219], v[14:17], v[116:119]
    ds_read_b64_tr_b16 a[230:231], v2 offset:7168
    v_fma_f32 v70, v70, s28, v11
    v_mfma_f32_16x16x32_bf16 v[164:167], a[216:219], v[20:23], v[164:167]
    ds_read_b64_tr_b16 a[234:235], v3 offset:7168
    v_fma_f32 v71, v71, s28, v11
    v_mfma_f32_16x16x32_bf16 v[160:163], a[212:215], v[20:23], v[160:163]
    v_exp_f32 v71, v71
    v_mfma_f32_16x16x32_bf16 v[208:211], a[212:215], v[26:29], v[208:211]
    ds_read_b64_tr_b16 a[228:229], v2 offset:1024
    v_exp_f32 v70, v70
    v_mfma_f32_16x16x32_bf16 v[212:215], a[216:219], v[26:29], v[212:215]
    v_lshrrev_b32 v105, 11, v0
    v_xor_b32 v105, s65, v105
    v_mfma_f32_16x16x32_bf16 a[4:7], a[216:219], v[32:35], a[4:7]
    ds_read_b64_tr_b16 a[232:233], v3 offset:1024
    v_fma_f32 v76, v76, s28, v12
    v_mfma_f32_16x16x32_bf16 a[0:3], a[212:215], v[32:35], a[0:3]
    s_waitcnt lgkmcnt(4)
    ds_read_b64_tr_b16 a[214:215], v4 offset:7168
    v_fma_f32 v83, v83, s28, v12
    v_mfma_f32_16x16x32_bf16 a[8:11], a[220:223], v[32:35], a[8:11]
    v_exp_f32 v69, v69
    v_mfma_f32_16x16x32_bf16 a[12:15], a[224:227], v[32:35], a[12:15]
    ds_read_b64_tr_b16 a[212:213], v4 offset:1024
    v_fma_f32 v57, v57, s28, v9
    v_mfma_f32_16x16x32_bf16 v[220:223], a[224:227], v[26:29], v[220:223]
    v_lshl_add_u32 v104, v105, 10, v104
    v_add_u32 v104, s38, v104
    v_mfma_f32_16x16x32_bf16 v[216:219], a[220:223], v[26:29], v[216:219]
    v_xor_b32 v105, 64, v104
    v_fma_f32 v58, v58, s28, v9
    v_mfma_f32_16x16x32_bf16 v[168:171], a[220:223], v[20:23], v[168:171]
    ds_read_b64_tr_b16 a[218:219], v5 offset:7168
    v_fma_f32 v62, v62, s28, v10
    v_mfma_f32_16x16x32_bf16 v[172:175], a[224:227], v[20:23], v[172:175]
    ds_read_b64_tr_b16 a[216:217], v5 offset:1024
    v_fma_f32 v78, v78, s28, v12
    v_mfma_f32_16x16x32_bf16 v[124:127], a[224:227], v[14:17], v[124:127]
    ds_read_b128 a[172:175], v105 offset:18432
    v_fma_f32 v65, v65, s28, v10
    v_mfma_f32_16x16x32_bf16 v[120:123], a[220:223], v[14:17], v[120:123]
    s_waitcnt lgkmcnt(6)
    ds_read_b64_tr_b16 a[220:221], v2 offset:2048
    v_exp_f32 v78, v78
    v_mfma_f32_16x16x32_bf16 v[128:131], a[228:231], v[14:17], v[128:131]
    s_waitcnt lgkmcnt(6)
    ds_read_b64_tr_b16 a[226:227], v3 offset:8192
    v_fma_f32 v79, v79, s28, v12
    v_mfma_f32_16x16x32_bf16 v[132:135], a[232:235], v[14:17], v[132:135]
    ds_read_b64_tr_b16 a[224:225], v3 offset:2048
    v_fma_f32 v68, v68, s28, v11
    v_mfma_f32_16x16x32_bf16 v[180:183], a[232:235], v[20:23], v[180:183]
    ds_read_b64_tr_b16 a[222:223], v2 offset:8192
    v_fma_f32 v72, v72, s28, v11
    v_mfma_f32_16x16x32_bf16 v[176:179], a[228:231], v[20:23], v[176:179]
    ds_read_b128 a[176:179], v104 offset:20480
    v_fma_f32 v59, v59, s28, v9
    v_mfma_f32_16x16x32_bf16 v[224:227], a[228:231], v[26:29], v[224:227]
    ds_read_b128 a[96:99], v104 offset:0
    v_fma_f32 v63, v63, s28, v10
    v_mfma_f32_16x16x32_bf16 v[228:231], a[232:235], v[26:29], v[228:231]
    v_exp_f32 v68, v68
    v_mfma_f32_16x16x32_bf16 a[20:23], a[232:235], v[32:35], a[20:23]
    ds_read_b64_tr_b16 a[232:233], v5 offset:2048
    v_fma_f32 v64, v64, s28, v10
    v_mfma_f32_16x16x32_bf16 a[16:19], a[228:231], v[32:35], a[16:19]
    s_waitcnt lgkmcnt(8)
    ds_read_b64_tr_b16 a[228:229], v4 offset:2048
    v_exp_f32 v62, v62
    v_mfma_f32_16x16x32_bf16 a[24:27], a[212:215], v[32:35], a[24:27]
    ds_read_b64_tr_b16 a[234:235], v5 offset:8192
    v_fma_f32 v66, v66, s28, v10
    v_mfma_f32_16x16x32_bf16 a[28:31], a[216:219], v[32:35], a[28:31]
    ds_read_b128 a[168:171], v104 offset:18432
    v_cvt_pk_bf16_f32 v30, v68, v69
    v_mfma_f32_16x16x32_bf16 v[236:239], a[216:219], v[26:29], v[236:239]
    ds_read_b64_tr_b16 a[230:231], v4 offset:8192
    v_exp_f32 v63, v63
    v_mfma_f32_16x16x32_bf16 v[232:235], a[212:215], v[26:29], v[232:235]
    ds_read_b128 a[104:107], v104 offset:2048
    v_fma_f32 v73, v73, s28, v11
    v_mfma_f32_16x16x32_bf16 v[184:187], a[212:215], v[20:23], v[184:187]
    s_add_u32 s39, s39, 12288
    v_exp_f32 v77, v77
    v_mfma_f32_16x16x32_bf16 v[188:191], a[216:219], v[20:23], v[188:191]
    ds_read_b128 a[108:111], v105 offset:2048
    v_fma_f32 v75, v75, s28, v11
    v_mfma_f32_16x16x32_bf16 v[140:143], a[216:219], v[14:17], v[140:143]
    ds_read_b128 a[124:127], v105 offset:6144
    v_cvt_pk_bf16_f32 v25, v62, v63
    v_mfma_f32_16x16x32_bf16 v[136:139], a[212:215], v[14:17], v[136:139]
    s_waitcnt lgkmcnt(8)
    ds_read_b128 a[120:123], v104 offset:6144
    v_exp_f32 v83, v83
    v_mfma_f32_16x16x32_bf16 v[144:147], a[220:223], v[14:17], v[144:147]
    v_exp_f32 v75, v75
    v_mfma_f32_16x16x32_bf16 v[148:151], a[224:227], v[14:17], v[148:151]
    v_exp_f32 v79, v79
    v_mfma_f32_16x16x32_bf16 v[196:199], a[224:227], v[20:23], v[196:199]
    ds_read_b128 a[144:147], v104 offset:12288
    v_fma_f32 v56, v56, s28, v9
    v_mfma_f32_16x16x32_bf16 v[192:195], a[220:223], v[20:23], v[192:195]
    ds_read_b128 a[132:135], v105 offset:8192
    v_cvt_pk_bf16_f32 v37, v78, v79
    v_mfma_f32_16x16x32_bf16 v[240:243], a[220:223], v[26:29], v[240:243]
    s_waitcnt vmcnt(14) lgkmcnt(6)
    ds_read_b128 a[128:131], v104 offset:8192
    v_fma_f32 v67, v67, s28, v10
    v_mfma_f32_16x16x32_bf16 v[244:247], a[224:227], v[26:29], v[244:247]
    s_barrier
    v_mfma_f32_16x16x32_bf16 a[36:39], a[224:227], v[32:35], a[36:39]
    s_add_u32 s21, s21, s62
    ds_read_b128 a[212:215], v0 offset:0
    v_exp_f32 v76, v76
    v_mfma_f32_16x16x32_bf16 a[32:35], a[220:223], v[32:35], a[32:35]
    s_add_u32 m0, s22, 24576
    ds_read_b128 a[220:223], v0 offset:1024
    v_cvt_pk_bf16_f32 v31, v70, v71
    v_mfma_f32_16x16x32_bf16 a[40:43], a[228:231], v[32:35], a[40:43]
    buffer_load_dwordx4 v6, s[8:11], s21 offen lds
    ds_read_b128 a[100:103], v105 offset:0
    v_mfma_f32_16x16x32_bf16 a[44:47], a[232:235], v[32:35], a[44:47]
    s_add_u32 s21, s21, 128
    ds_read_b128 a[216:219], v1 offset:0
    v_fma_f32 v82, v82, s28, v12
    v_mfma_f32_16x16x32_bf16 v[252:255], a[232:235], v[26:29], v[252:255]
    s_add_u32 m0, s22, 25600
    ds_read_b128 a[148:151], v105 offset:12288
    buffer_load_dwordx4 v6, s[8:11], s21 offen lds
    v_mfma_f32_16x16x32_bf16 v[248:251], a[228:231], v[26:29], v[248:251]
    ds_read_b128 a[156:159], v105 offset:14336
    v_exp_f32 v56, v56
    v_mfma_f32_16x16x32_bf16 v[200:203], a[228:231], v[20:23], v[200:203]
    s_add_u32 s21, s21, 128
    ds_read_b128 a[224:227], v1 offset:1024
    v_cvt_pk_bf16_f32 v36, v76, v77
    v_mfma_f32_16x16x32_bf16 v[204:207], a[232:235], v[20:23], v[204:207]
    s_add_u32 m0, s22, 26624
    ds_read_b128 a[152:155], v104 offset:14336
    v_fma_f32 v81, v81, s28, v12
    v_mfma_f32_16x16x32_bf16 v[156:159], a[232:235], v[14:17], v[156:159]
    buffer_load_dwordx4 v6, s[8:11], s21 offen lds
    v_mfma_f32_16x16x32_bf16 v[152:155], a[228:231], v[14:17], v[152:155]
    s_waitcnt lgkmcnt(7)
    v_exp_f32 v57, v57
    v_mfma_f32_16x16x32_bf16 v[52:55], a[212:215], a[96:99], 0
    v_exp_f32 v66, v66
    v_mfma_f32_16x16x32_bf16 v[60:63], a[212:215], a[120:123], 0
    ds_read_b128 a[228:231], v0 offset:6144
    v_exp_f32 v72, v72
    v_mfma_f32_16x16x32_bf16 v[68:71], a[212:215], a[144:147], 0
    v_exp_f32 v73, v73
    v_mfma_f32_16x16x32_bf16 v[76:79], a[212:215], a[168:171], 0
    s_waitcnt lgkmcnt(4)
    v_exp_f32 v65, v65
    v_mfma_f32_16x16x32_bf16 v[52:55], a[216:219], a[100:103], v[52:55]
    ds_read_b128 a[180:183], v105 offset:20480
    v_fma_f32 v74, v74, s28, v11
    v_mfma_f32_16x16x32_bf16 v[60:63], a[216:219], a[124:127], v[60:63]
    v_exp_f32 v64, v64
    v_mfma_f32_16x16x32_bf16 v[68:71], a[216:219], a[148:151], v[68:71]
    v_exp_f32 v58, v58
    v_mfma_f32_16x16x32_bf16 v[76:79], a[216:219], a[172:175], v[76:79]
    s_add_u32 s21, s21, 12032
    v_exp_f32 v81, v81
    v_mfma_f32_16x16x32_bf16 v[52:55], a[220:223], a[104:107], v[52:55]
    v_exp_f32 v67, v67
    v_mfma_f32_16x16x32_bf16 v[60:63], a[220:223], a[128:131], v[60:63]
    s_waitcnt lgkmcnt(2)
    v_exp_f32 v59, v59
    v_mfma_f32_16x16x32_bf16 v[68:71], a[220:223], a[152:155], v[68:71]
    ds_read_b128 a[232:235], v1 offset:6144
    v_fma_f32 v80, v80, s28, v12
    v_mfma_f32_16x16x32_bf16 v[76:79], a[220:223], a[176:179], v[76:79]
    v_exp_f32 v82, v82
    v_mfma_f32_16x16x32_bf16 v[52:55], a[224:227], a[108:111], v[52:55]
    ds_read_b128 a[212:215], v0 offset:7168
    v_cvt_pk_bf16_f32 v17, v58, v59
    v_mfma_f32_16x16x32_bf16 v[60:63], a[224:227], a[132:135], v[60:63]
    v_cvt_pk_bf16_f32 v28, v72, v73
    v_cvt_pk_bf16_f32 v35, v82, v83
    v_cvt_pk_bf16_f32 v16, v56, v57
    v_mfma_f32_16x16x32_bf16 v[68:71], a[224:227], a[156:159], v[68:71]
    s_waitcnt lgkmcnt(2)
    v_exp_f32 v74, v74
    v_mfma_f32_16x16x32_bf16 v[76:79], a[224:227], a[180:183], v[76:79]
    v_cvt_pk_bf16_f32 v29, v74, v75
    v_cvt_pk_bf16_f32 v22, v64, v65
    v_mfma_f32_16x16x32_bf16 v[56:59], a[228:231], a[96:99], 0
    ds_read_b128 a[220:223], v0 offset:2048
    v_cvt_pk_bf16_f32 v23, v66, v67
    v_mfma_f32_16x16x32_bf16 v[64:67], a[228:231], a[120:123], 0
    v_exp_f32 v80, v80
    v_mfma_f32_16x16x32_bf16 v[72:75], a[228:231], a[144:147], 0
    ds_read_b128 a[160:163], v104 offset:16384
    v_cvt_pk_bf16_f32 v34, v80, v81
    v_mfma_f32_16x16x32_bf16 v[80:83], a[228:231], a[168:171], 0
    s_waitcnt vmcnt(9)
    ds_read_b128 a[224:227], v1 offset:2048
    s_waitcnt lgkmcnt(4)
    v_mfma_f32_16x16x32_bf16 v[56:59], a[232:235], a[100:103], v[56:59]
    ds_read_b128 a[216:219], v1 offset:7168
    v_mfma_f32_16x16x32_bf16 v[64:67], a[232:235], a[124:127], v[64:67]
    ds_read_b128 a[188:191], v105 offset:22528
    v_mfma_f32_16x16x32_bf16 v[72:75], a[232:235], a[148:151], v[72:75]
    ds_read_b128 a[228:231], v0 offset:8192
    v_mfma_f32_16x16x32_bf16 v[80:83], a[232:235], a[172:175], v[80:83]
    ds_read_b128 a[232:235], v1 offset:8192
    v_mfma_f32_16x16x32_bf16 v[48:51], a[236:239], v[16:19], v[44:47]
    ds_read_b128 a[112:115], v104 offset:4096
    v_mfma_f32_16x16x32_bf16 v[48:51], a[240:243], v[22:25], v[48:51]
    ds_read_b128 a[136:139], v104 offset:10240
    v_mfma_f32_16x16x32_bf16 v[48:51], a[244:247], v[28:31], v[48:51]
    ds_read_b128 a[164:167], v105 offset:16384
    v_mfma_f32_16x16x32_bf16 v[48:51], a[248:251], v[34:37], v[48:51]
    s_waitcnt lgkmcnt(9)
    ds_read_b128 a[140:143], v105 offset:10240
    v_mfma_f32_16x16x32_bf16 v[56:59], a[212:215], a[104:107], v[56:59]
    ds_read_b128 a[116:119], v105 offset:4096
    v_mfma_f32_16x16x32_bf16 v[64:67], a[212:215], a[128:131], v[64:67]
    ds_read_b128 a[184:187], v104 offset:22528
    v_mfma_f32_16x16x32_bf16 v[72:75], a[212:215], a[152:155], v[72:75]
    v_mfma_f32_16x16x32_bf16 v[80:83], a[212:215], a[176:179], v[80:83]
    s_waitcnt lgkmcnt(8)
    v_cmp_lt_f32 vcc, s29, v48
    v_mfma_f32_16x16x32_bf16 v[56:59], a[216:219], a[108:111], v[56:59]
    s_waitcnt vmcnt(14) lgkmcnt(6)
    v_mfma_f32_16x16x32_bf16 v[64:67], a[216:219], a[132:135], v[64:67]
    s_barrier
    v_mfma_f32_16x16x32_bf16 v[72:75], a[216:219], a[156:159], v[72:75]
    s_cbranch_vccnz L_rs_tr44b
L_ret_tr44b:
    ds_read_b64_tr_b16 a[212:213], v2 offset:18432
    v_mfma_f32_16x16x32_bf16 v[80:83], a[216:219], a[180:183], v[80:83]
    s_waitcnt lgkmcnt(5)
    ds_read_b64_tr_b16 a[214:215], v2 offset:12288
    s_add_u32 m0, s22, 0
    v_mfma_f32_16x16x32_bf16 v[52:55], a[220:223], a[112:115], v[52:55]
    buffer_load_dwordx4 v6, s[4:7], s20 offen lds
    v_mfma_f32_16x16x32_bf16 v[60:63], a[220:223], a[136:139], v[60:63]
    s_add_u32 s20, s20, 128
    ds_read_b64_tr_b16 a[216:217], v3 offset:18432
    s_add_u32 m0, s22, 1024
    v_mfma_f32_16x16x32_bf16 v[68:71], a[220:223], a[160:163], v[68:71]
    s_waitcnt lgkmcnt(3)
    v_mfma_f32_16x16x32_bf16 v[76:79], a[220:223], a[184:187], v[76:79]
    buffer_load_dwordx4 v6, s[4:7], s20 offen lds
    v_mfma_f32_16x16x32_bf16 v[52:55], a[224:227], a[116:119], v[52:55]
    s_add_u32 s20, s20, 128
    s_add_u32 m0, s22, 2048
    ds_read_b64_tr_b16 a[218:219], v3 offset:12288
    v_mfma_f32_16x16x32_bf16 v[60:63], a[224:227], a[140:143], v[60:63]
    buffer_load_dwordx4 v6, s[4:7], s20 offen lds
    v_mfma_f32_16x16x32_bf16 v[68:71], a[224:227], a[164:167], v[68:71]
    ds_read_b64_tr_b16 a[220:221], v4 offset:18432
    v_mfma_f32_16x16x32_bf16 v[76:79], a[224:227], a[188:191], v[76:79]
    v_mfma_f32_16x16x32_bf16 v[56:59], a[228:231], a[112:115], v[56:59]
    s_add_u32 s20, s20, 12032
    v_mfma_f32_16x16x32_bf16 v[64:67], a[228:231], a[136:139], v[64:67]
    v_mfma_f32_16x16x32_bf16 v[72:75], a[228:231], a[160:163], v[72:75]
    ds_read_b64_tr_b16 a[222:223], v4 offset:12288
    v_mfma_f32_16x16x32_bf16 v[80:83], a[228:231], a[184:187], v[80:83]
    v_mfma_f32_16x16x32_bf16 v[56:59], a[232:235], a[116:119], v[56:59]
    ds_read_b64_tr_b16 a[224:225], v5 offset:18432
    v_mfma_f32_16x16x32_bf16 v[64:67], a[232:235], a[140:143], v[64:67]
    ds_read_b64_tr_b16 a[226:227], v5 offset:12288
    v_mfma_f32_16x16x32_bf16 v[72:75], a[232:235], a[164:167], v[72:75]
    v_mfma_f32_16x16x32_bf16 v[80:83], a[232:235], a[188:191], v[80:83]
    v_max3_f32 v96, v52, v53, v54
    s_nop 1
    v_max3_f32 v96, v96, v55, v56
    v_max3_f32 v96, v96, v57, v58
    v_max_f32 v96, v96, v59
    v_mov_b32 v97, v96
    s_waitcnt lgkmcnt(4)
    v_mfma_f32_16x16x32_bf16 v[112:115], a[212:215], v[16:19], v[112:115]
    s_mov_b32 s67, s34
    v_permlane32_swap_b32 v97, v96
    v_mfma_f32_16x16x32_bf16 v[116:119], a[216:219], v[16:19], v[116:119]
    s_add_u32 s18, s34, 24576
    ds_read_b64_tr_b16 a[230:231], v2 offset:13312
    v_max_f32 v96, v96, v97
    v_mov_b32 v97, v96
    v_mfma_f32_16x16x32_bf16 v[164:167], a[216:219], v[22:25], v[164:167]
    s_mov_b32 s34, s33
    v_mbcnt_lo_u32_b32 v104, -1, 0
    v_permlane16_swap_b32 v97, v96
    v_max_f32 v96, v96, v97
    v_mul_f32_e64 v9, -s28, v96
    v_max3_f32 v96, v60, v61, v62
    v_mfma_f32_16x16x32_bf16 v[160:163], a[212:215], v[22:25], v[160:163]
    s_add_u32 s64, s64, s62
    ds_read_b64_tr_b16 a[228:229], v2 offset:19456
    v_fma_f32 v58, v58, s28, v9
    v_max3_f32 v96, v96, v63, v64
    v_mbcnt_hi_u32_b32 v104, -1, v104
    v_mfma_f32_16x16x32_bf16 v[208:211], a[212:215], v[28:31], v[208:211]
    s_add_u32 s64, s64, 196608
    ds_read_b64_tr_b16 a[234:235], v3 offset:13312
    v_max3_f32 v96, v96, v65, v66
    v_max_f32 v96, v96, v67
    v_mov_b32 v97, v96
    v_mfma_f32_16x16x32_bf16 v[212:215], a[216:219], v[28:31], v[212:215]
    s_mov_b32 s39, s64
    v_permlane32_swap_b32 v97, v96
    v_mfma_f32_16x16x32_bf16 a[4:7], a[216:219], v[34:37], a[4:7]
    s_add_u32 s37, s37, 1
    v_mov_b32 v100, v48
    v_max_f32 v96, v96, v97
    v_bfe_u32 v105, v104, 3, 1
    v_mfma_f32_16x16x32_bf16 a[0:3], a[212:215], v[34:37], a[0:3]
    s_waitcnt lgkmcnt(3)
    ds_read_b64_tr_b16 a[218:219], v5 offset:13312
    v_mov_b32 v97, v96
    v_mfma_f32_16x16x32_bf16 a[8:11], a[220:223], v[34:37], a[8:11]
    s_bitcmp1_b32 s63, s37
    ds_read_b64_tr_b16 a[232:233], v3 offset:19456
    v_rcp_f32 v49, v49
    v_mfma_f32_16x16x32_bf16 a[12:15], a[224:227], v[34:37], a[12:15]
    s_cselect_b32 s62, 4294770688, 0
    v_rcp_f32 v51, v51
    v_permlane16_swap_b32 v97, v96
    v_max_f32 v96, v96, v97
    v_mfma_f32_16x16x32_bf16 v[220:223], a[224:227], v[28:31], v[220:223]
    s_cselect_b32 s42, 0, 325632
    v_permlane32_swap_b32 v48, v100
    v_accvgpr_read_b32 v110, a6
    v_fma_f32 v54, v54, s28, v9
    v_fma_f32 v55, v55, s28, v9
    v_fma_f32 v53, v53, s28, v9
    v_mfma_f32_16x16x32_bf16 v[216:219], a[220:223], v[28:31], v[216:219]
    s_add_u32 s35, s35, s42
    v_accvgpr_read_b32 v109, a5
    v_lshrrev_b32 v106, 5, v104
    v_fma_f32 v59, v59, s28, v9
    v_mfma_f32_16x16x32_bf16 v[168:171], a[220:223], v[22:25], v[168:171]
    ds_read_b64_tr_b16 a[214:215], v4 offset:13312
    v_exp_f32 v55, v55
    v_mul_f32 v161, v161, v49
    v_mul_f32_e64 v10, -s28, v96
    v_mul_f32 v163, v163, v49
    v_max3_f32 v96, v68, v69, v70
    v_mfma_f32_16x16x32_bf16 v[172:175], a[224:227], v[22:25], v[172:175]
    s_lshl_b32 s42, s37, 1
    ds_read_b64_tr_b16 a[212:213], v4 offset:19456
    v_fma_f32 v65, v65, s28, v10
    v_mfma_f32_16x16x32_bf16 v[124:127], a[224:227], v[16:19], v[124:127]
    s_lshr_b32 s42, s31, s42
    v_max3_f32 v96, v96, v71, v72
    v_max3_f32 v96, v96, v73, v74
    v_max_f32 v96, v96, v75
    v_mov_b32 v97, v96
    v_mfma_f32_16x16x32_bf16 v[120:123], a[220:223], v[16:19], v[120:123]
    s_waitcnt lgkmcnt(2)
    ds_read_b64_tr_b16 a[216:217], v5 offset:19456
    v_permlane32_swap_b32 v97, v96
    v_mfma_f32_16x16x32_bf16 v[128:131], a[228:231], v[16:19], v[128:131]
    s_and_b32 s42, s42, 3
    ds_read_b64_tr_b16 a[220:221], v2 offset:20480
    v_max_f32 v96, v96, v97
    v_and_b32 v107, 3, v104
    v_mfma_f32_16x16x32_bf16 v[132:135], a[232:235], v[16:19], v[132:135]
    s_add_u32 s42, s42, s36
    v_exp_f32 v65, v65
    v_mfma_f32_16x16x32_bf16 v[180:183], a[232:235], v[22:25], v[180:183]
    s_sub_u32 s43, s42, 3
    ds_read_b64_tr_b16 a[224:225], v3 offset:20480
    v_accvgpr_read_b32 v108, a4
    v_mul_f32 v167, v167, v49
    v_exp_f32 v53, v53
    v_fma_f32 v64, v64, s28, v10
    v_mov_b32 v97, v96
    v_mfma_f32_16x16x32_bf16 v[176:179], a[228:231], v[22:25], v[176:179]
    s_cmp_ge_u32 s42, 3
    v_permlane16_swap_b32 v97, v96
    v_rcp_f32 v50, v50
    v_max_f32 v96, v96, v97
    v_fma_f32 v52, v52, s28, v9
    v_mfma_f32_16x16x32_bf16 v[224:227], a[228:231], v[28:31], v[224:227]
    s_cselect_b32 s42, s43, s42
    v_fma_f32 v56, v56, s28, v9
    v_mul_f32 v160, v160, v49
    v_mul_f32_e64 v11, -s28, v96
    v_rcp_f32 v48, v48
    v_max3_f32 v96, v76, v77, v78
    v_mfma_f32_16x16x32_bf16 v[228:231], a[232:235], v[28:31], v[228:231]
    s_mul_i32 s44, s3, 5
    ds_read_b64_tr_b16 a[226:227], v3 offset:14336
    v_max3_f32 v96, v96, v79, v80
    v_mfma_f32_16x16x32_bf16 a[20:23], a[232:235], v[34:37], a[20:23]
    s_mov_b32 s32, 1
    ds_read_b64_tr_b16 a[222:223], v2 offset:14336
    v_max3_f32 v96, v96, v81, v82
    v_mfma_f32_16x16x32_bf16 a[16:19], a[228:231], v[34:37], a[16:19]
    s_waitcnt lgkmcnt(3)
    ds_read_b64_tr_b16 a[230:231], v4 offset:14336
    v_max_f32 v96, v96, v83
    v_mfma_f32_16x16x32_bf16 a[24:27], a[212:215], v[34:37], a[24:27]
    s_lshl_b32 s43, s3, 2
    v_exp_f32 v58, v58
    v_mov_b32 v97, v96
    v_xor_b32 v106, v106, v105
    v_mfma_f32_16x16x32_bf16 a[28:31], a[216:219], v[34:37], a[28:31]
    s_add_u32 s45, s43, 21
    ds_read_b64_tr_b16 a[232:233], v5 offset:20480
    v_fma_f32 v71, v71, s28, v11
    v_fma_f32 v70, v70, s28, v11
    v_fma_f32 v63, v63, s28, v10
    v_mul_f32 v165, v165, v49
    v_fma_f32 v57, v57, s28, v9
    v_fma_f32 v75, v75, s28, v11
    v_mul_f32 v164, v164, v49
    v_mfma_f32_16x16x32_bf16 v[236:239], a[216:219], v[28:31], v[236:239]
    s_cmp_eq_u32 s3, 0
    ds_read_b64_tr_b16 a[234:235], v5 offset:14336
    v_mul_f32 v108, v108, v51
    v_mfma_f32_16x16x32_bf16 v[232:235], a[212:215], v[28:31], v[232:235]
    s_cselect_b32 s45, 20, s45
    v_permlane32_swap_b32 v97, v96
    v_mfma_f32_16x16x32_bf16 v[184:187], a[212:215], v[22:25], v[184:187]
    s_cselect_b32 s33, 1, 0
    v_exp_f32 v54, v54
    v_mfma_f32_16x16x32_bf16 v[188:191], a[216:219], v[22:25], v[188:191]
    s_cmp_eq_u32 s42, 1
    v_fma_f32 v62, v62, s28, v10
    v_accvgpr_read_b32 v111, a7
    s_cselect_b32 s44, s45, s44
    v_mfma_f32_16x16x32_bf16 v[140:143], a[216:219], v[16:19], v[140:143]
    s_cselect_b32 s32, s33, s32
    v_max_f32 v96, v96, v97
    s_add_u32 s45, s43, 37
    v_mfma_f32_16x16x32_bf16 v[136:139], a[212:215], v[16:19], v[136:139]
    s_waitcnt lgkmcnt(2)
    ds_read_b64_tr_b16 a[228:229], v4 offset:20480
    v_xor_b32 v105, s65, v105
    v_mfma_f32_16x16x32_bf16 v[144:147], a[220:223], v[16:19], v[144:147]
    s_cmp_eq_u32 s42, 2
    v_mul_f32 v177, v177, v49
    s_cselect_b32 s44, s45, s44
    v_cvt_pk_bf16_f32 v15, v54, v55
    v_mfma_f32_16x16x32_bf16 v[148:151], a[224:227], v[16:19], v[148:151]
    s_cselect_b32 s32, 0, s32
    v_mov_b32 v97, v96
    s_mul_i32 s44, s44, 6144
    v_mfma_f32_16x16x32_bf16 v[196:199], a[224:227], v[22:25], v[196:199]
    s_add_u32 s33, s35, s44
    v_fma_f32 v60, v60, s28, v10
    v_permlane16_swap_b32 v97, v96
    v_mfma_f32_16x16x32_bf16 v[192:195], a[220:223], v[22:25], v[192:195]
    s_mul_i32 s42, s32, 6144
    v_exp_f32 v56, v56
    v_mul_f32 v173, v173, v49
    v_mul_f32 v109, v109, v51
    v_mfma_f32_16x16x32_bf16 v[240:243], a[220:223], v[28:31], v[240:243]
    s_add_u32 s42, s42, 24576
    s_add_u32 s42, s42, s33
    s_cmp_ge_u32 s37, 6
    v_lshl_or_b32 v106, v107, 1, v106
    s_cselect_b32 s14, 0, s42
    v_mfma_f32_16x16x32_bf16 v[244:247], a[224:227], v[28:31], v[244:247]
    s_add_u32 s24, s67, 6400
    s_add_u32 s25, s33, 6400
    v_mul_f32 v176, v176, v49
    v_mfma_f32_16x16x32_bf16 a[36:39], a[224:227], v[34:37], a[36:39]
    s_add_u32 s23, s38, 10240
    v_exp_f32 v52, v52
    v_mfma_f32_16x16x32_bf16 a[32:35], a[220:223], v[34:37], a[32:35]
    s_mov_b32 s27, 0x49249249
    s_mov_b32 s30, 0
    s_waitcnt vmcnt(8) lgkmcnt(0)
    v_mfma_f32_16x16x32_bf16 a[40:43], a[228:231], v[34:37], a[40:43]
    s_barrier
    v_max_f32 v96, v96, v97
    v_and_b32 v107, 7, v104
    v_lshl_add_u32 v101, v105, 10, s38
    v_pk_mul_f32 v[212:213], v[212:213], v[50:51] op_sel_hi:[1,0]
    v_pk_mul_f32 v[208:209], v[208:209], v[50:51] op_sel_hi:[1,0]
    v_fma_f32 v68, v68, s28, v11
    v_fma_f32 v67, v67, s28, v10
    v_fma_f32 v66, v66, s28, v10
    v_pk_mul_f32 v[210:211], v[210:211], v[50:51] op_sel_hi:[1,0]
    v_exp_f32 v71, v71
    v_mul_f32 v186, v186, v49
    v_exp_f32 v66, v66
    v_lshl_add_u32 v101, v106, 4, v101
    v_mul_f32 v195, v195, v49
    v_lshl_add_u32 v101, v107, 7, v101
    v_pk_mul_f32 v[112:113], v[112:113], v[48:49] op_sel_hi:[1,0]
    v_cvt_pk_bf16_f32 v208, v208, v209
    v_pk_mul_f32 v[114:115], v[114:115], v[48:49] op_sel_hi:[1,0]
    v_fma_f32 v61, v61, s28, v10
    v_bfe_u32 v107, v104, 4, 1
    v_mfma_f32_16x16x32_bf16 a[44:47], a[232:235], v[34:37], a[44:47]
    ds_read_b128 a[212:215], v0 offset:12288
    v_exp_f32 v68, v68
    v_mfma_f32_16x16x32_bf16 v[252:255], a[232:235], v[28:31], v[252:255]
    ds_read_b128 a[224:227], v1 offset:13312
    v_exp_f32 v70, v70
    v_mul_f32 v168, v168, v49
    v_mul_f32 v174, v174, v49
    v_exp_f32 v63, v63
    v_mul_f32 v194, v194, v49
    v_mfma_f32_16x16x32_bf16 v[248:251], a[228:231], v[28:31], v[248:251]
    ds_read_b128 a[216:219], v1 offset:12288
    v_exp_f32 v61, v61
    v_mul_f32 v180, v180, v49
    v_cvt_pk_bf16_f32 v209, v210, v211
    v_mul_f32 v110, v110, v51
    v_mfma_f32_16x16x32_bf16 v[200:203], a[228:231], v[22:25], v[200:203]
    v_fma_f32 v74, v74, s28, v11
    v_exp_f32 v62, v62
    v_mul_f32_e64 v12, -s28, v96
    v_fma_f32 v76, v76, s28, v12
    v_cvt_pk_bf16_f32 v21, v62, v63
    v_mfma_f32_16x16x32_bf16 v[204:207], a[232:235], v[22:25], v[204:207]
    ds_read_b128 a[220:223], v0 offset:13312
    v_fma_f32 v69, v69, s28, v11
    v_accvgpr_read_b32 v106, a2
    v_exp_f32 v69, v69
    v_pk_mul_f32 v[120:121], v[120:121], v[48:49] op_sel_hi:[1,0]
    v_mul_f32 v181, v181, v49
    v_exp_f32 v60, v60
    v_pk_mul_f32 v[116:117], v[116:117], v[48:49] op_sel_hi:[1,0]
    v_pk_mul_f32 v[220:221], v[220:221], v[50:51] op_sel_hi:[1,0]
    v_mul_f32 v203, v203, v49
    v_fma_f32 v78, v78, s28, v12
    v_mul_f32 v169, v169, v49
    v_exp_f32 v59, v59
    v_fma_f32 v79, v79, s28, v12
    v_cvt_pk_bf16_f32 v14, v52, v53
    v_exp_f32 v64, v64
    v_mfma_f32_16x16x32_bf16 v[156:159], a[232:235], v[16:19], v[156:159]
    v_cvt_pk_bf16_f32 v108, v108, v109
    v_exp_f32 v76, v76
    v_exp_f32 v79, v79
    v_mfma_f32_16x16x32_bf16 v[152:155], a[228:231], v[16:19], v[152:155]
    s_waitcnt lgkmcnt(1)
    ds_read_b128 a[232:235], v1 offset:14336
    v_mul_f32 v111, v111, v51
    v_mfma_f32_16x16x32_bf16 v[52:55], a[212:215], a[96:99], 0
    v_cvt_pk_bf16_f32 v22, v64, v65
    v_cvt_pk_bf16_f32 v20, v60, v61
    v_exp_f32 v57, v57
    v_accvgpr_read_b32 v105, a1
    v_cvt_pk_bf16_f32 v180, v180, v181
    v_mfma_f32_16x16x32_bf16 v[52:55], a[216:219], a[100:103], v[52:55]
    s_waitcnt lgkmcnt(1)
    v_exp_f32 v67, v67
    v_mfma_f32_16x16x32_bf16 v[52:55], a[220:223], a[104:107], v[52:55]
    v_cvt_pk_bf16_f32 v27, v70, v71
    v_fma_f32 v77, v77, s28, v12
    v_mfma_f32_16x16x32_bf16 v[60:63], a[220:223], a[128:131], 0
    v_exp_f32 v75, v75
    v_mfma_f32_16x16x32_bf16 v[60:63], a[216:219], a[124:127], v[60:63]
    ds_read_b128 a[228:231], v0 offset:14336
    v_cvt_pk_bf16_f32 v17, v58, v59
    v_cvt_pk_bf16_f32 v26, v68, v69
    v_exp_f32 v77, v77
    v_mfma_f32_16x16x32_bf16 v[60:63], a[212:215], a[120:123], v[60:63]
    s_add_u32 m0, s22, 36864
    v_cvt_pk_bf16_f32 v32, v76, v77
    v_cvt_pk_bf16_f32 v109, v110, v111
    v_exp_f32 v78, v78
    v_mfma_f32_16x16x32_bf16 v[68:71], a[212:215], a[144:147], 0
    buffer_load_dwordx4 v6, s[8:11], s21 offen lds
    v_accvgpr_read_b32 v110, a14
    v_mul_f32 v205, v205, v49
    v_mfma_f32_16x16x32_bf16 v[68:71], a[216:219], a[148:151], v[68:71]
    v_exp_f32 v74, v74
    v_mfma_f32_16x16x32_bf16 v[68:71], a[220:223], a[152:155], v[68:71]
    v_cvt_pk_bf16_f32 v33, v78, v79
    v_accvgpr_read_b32 v104, a0
    v_mul_f32 v105, v105, v51
    v_cvt_pk_bf16_f32 v112, v112, v113
    v_mul_f32 v175, v175, v49
    v_mfma_f32_16x16x32_bf16 v[76:79], a[220:223], a[176:179], 0
    v_lshl_add_u32 v101, v107, 3, v101
    v_mul_f32 v200, v200, v49
    v_mfma_f32_16x16x32_bf16 v[76:79], a[216:219], a[172:175], v[76:79]
    v_mul_f32 v193, v193, v49
    v_mul_f32 v104, v104, v51
    v_fma_f32 v73, v73, s28, v11
    v_mfma_f32_16x16x32_bf16 v[76:79], a[212:215], a[168:171], v[76:79]
    ds_read_b128 a[216:219], v1 offset:18432
    v_mul_f32 v171, v171, v49
    v_mul_f32 v172, v172, v49
    v_mfma_f32_16x16x32_bf16 v[76:79], a[224:227], a[180:183], v[76:79]
    s_waitcnt lgkmcnt(1)
    v_mul_f32 v106, v106, v51
    v_cvt_pk_bf16_f32 v120, v120, v121
    v_cvt_pk_bf16_f32 v212, v212, v213
    v_mfma_f32_16x16x32_bf16 v[76:79], a[228:231], a[184:187], v[76:79]
    v_accvgpr_read_b32 v107, a3
    v_cvt_pk_bf16_f32 v164, v164, v165
    v_mfma_f32_16x16x32_bf16 v[76:79], a[232:235], a[188:191], v[76:79]
    ds_read_b128 a[212:215], v0 offset:18432
    v_cvt_pk_bf16_f32 v104, v104, v105
    v_mul_f32 v178, v178, v49
    v_mul_f32 v202, v202, v49
    v_mfma_f32_16x16x32_bf16 v[68:71], a[232:235], a[164:167], v[68:71]
    v_mul_f32 v184, v184, v49
    v_mul_f32 v190, v190, v49
    v_mfma_f32_16x16x32_bf16 v[68:71], a[228:231], a[160:163], v[68:71]
    v_fma_f32 v72, v72, s28, v11
    v_mul_f32 v162, v162, v49
    v_mul_f32 v201, v201, v49
    v_mfma_f32_16x16x32_bf16 v[68:71], a[224:227], a[156:159], v[68:71]
    ds_read_b128 a[220:223], v0 offset:19456
    v_fma_f32 v81, v81, s28, v12
    v_fma_f32 v80, v80, s28, v12
    v_mfma_f32_16x16x32_bf16 v[60:63], a[224:227], a[132:135], v[60:63]
    s_add_u32 s21, s21, 128
    v_mul_f32 v110, v110, v51
    v_exp_f32 v72, v72
    v_mul_f32 v179, v179, v49
    v_mfma_f32_16x16x32_bf16 v[60:63], a[228:231], a[136:139], v[60:63]
    v_fma_f32 v83, v83, s28, v12
    v_fma_f32 v82, v82, s28, v12
    v_mfma_f32_16x16x32_bf16 v[60:63], a[232:235], a[140:143], v[60:63]
    v_mul_f32 v185, v185, v49
    v_cvt_pk_bf16_f32 v220, v220, v221
    v_cvt_pk_bf16_f32 v23, v66, v67
    v_mfma_f32_16x16x32_bf16 v[52:55], a[232:235], a[116:119], v[52:55]
    v_subrev_u32 v8, 22528, v8
    v_exp_f32 v73, v73
    v_exp_f32 v83, v83
    v_mfma_f32_16x16x32_bf16 v[52:55], a[228:231], a[112:115], v[52:55]
    v_fma_f32 v62, v62, s28, v10
    v_cvt_pk_bf16_f32 v16, v56, v57
    v_cvt_pk_bf16_f32 v160, v160, v161
    v_mul_f32 v192, v192, v49
    v_exp_f32 v80, v80
    v_mfma_f32_16x16x32_bf16 v[52:55], a[224:227], a[108:111], v[52:55]
    s_waitcnt lgkmcnt(1)
    v_cvt_pk_bf16_f32 v28, v72, v73
    v_accvgpr_read_b32 v111, a15
    v_fma_f32 v71, v71, s28, v11
    v_mfma_f32_16x16x32_bf16 v[56:59], a[212:215], a[96:99], 0
    v_exp_f32 v81, v81
    v_cvt_pk_bf16_f32 v116, v116, v117
    v_cvt_pk_bf16_f32 v172, v172, v173
    v_mfma_f32_16x16x32_bf16 v[56:59], a[216:219], a[100:103], v[56:59]
    s_waitcnt lgkmcnt(0)
    ds_read_b128 a[224:227], v1 offset:19456
    v_mul_f32 v197, v197, v49
    v_mfma_f32_16x16x32_bf16 v[56:59], a[220:223], a[104:107], v[56:59]
    s_add_u32 m0, s22, 37888
    ds_read_b128 a[232:235], v1 offset:20480
    buffer_load_dwordx4 v6, s[8:11], s21 offen lds
    v_mul_f32 v189, v189, v49
    v_mul_f32 v191, v191, v49
    v_mfma_f32_16x16x32_bf16 v[64:67], a[220:223], a[128:131], 0
    ds_read_b128 a[228:231], v0 offset:20480
    v_exp_f32 v82, v82
    v_mfma_f32_16x16x32_bf16 v[64:67], a[216:219], a[124:127], v[64:67]
    v_cvt_pk_bf16_f32 v29, v74, v75
    v_fma_f32 v78, v78, s28, v12
    v_mul_f32 v207, v207, v49
    v_mfma_f32_16x16x32_bf16 v[64:67], a[212:215], a[120:123], v[64:67]
    v_fma_f32 v68, v68, s28, v11
    v_mul_f32 v187, v187, v49
    v_cvt_pk_bf16_f32 v113, v114, v115
    v_mul_f32 v199, v199, v49
    v_mfma_f32_16x16x32_bf16 v[72:75], a[212:215], a[144:147], 0
    v_mul_f32 v107, v107, v51
    v_cvt_pk_bf16_f32 v35, v82, v83
    v_mfma_f32_16x16x32_bf16 v[72:75], a[216:219], a[148:151], v[72:75]
    s_add_u32 s21, s21, 128
    v_cvt_pk_bf16_f32 v105, v106, v107
    v_exp_f32 v71, v71
    v_mfma_f32_16x16x32_bf16 v[72:75], a[220:223], a[152:155], v[72:75]
    s_add_u32 m0, s22, 38912
    v_mul_f32 v204, v204, v49
    v_mul_f32 v166, v166, v49
    v_cvt_pk_bf16_f32 v34, v80, v81
    v_mfma_f32_16x16x32_bf16 v[80:83], a[220:223], a[176:179], 0
    buffer_load_dwordx4 v6, s[8:11], s21 offen lds
    v_mfma_f32_16x16x32_bf16 v[80:83], a[216:219], a[172:175], v[80:83]
    s_add_u32 s21, s21, 12032
    v_fma_f32 v54, v54, s28, v9
    v_mul_f32 v206, v206, v49
    v_accvgpr_read_b32 v107, a11
    v_mfma_f32_16x16x32_bf16 v[80:83], a[212:215], a[168:171], v[80:83]
    s_waitcnt vmcnt(6) lgkmcnt(0)
    v_cvt_pk_bf16_f32 v161, v162, v163
    v_mul_f32 v107, v107, v51
    v_mfma_f32_16x16x32_bf16 v[80:83], a[224:227], a[180:183], v[80:83]
    v_mul_f32 v182, v182, v49
    v_fma_f32 v63, v63, s28, v10
    v_mfma_f32_16x16x32_bf16 v[80:83], a[228:231], a[184:187], v[80:83]
    s_barrier
    ds_read_b64_tr_b16 a[212:213], v2 offset:0
    v_mfma_f32_16x16x32_bf16 v[80:83], a[232:235], a[188:191], v[80:83]
    ds_read_b64_tr_b16 a[214:215], v2 offset:6144
    v_exp_f32 v68, v68
    v_mfma_f32_16x16x32_bf16 v[72:75], a[232:235], a[164:167], v[72:75]
    ds_write2st64_b64 v101, v[112:113], v[160:161] offset0:0 offset1:12
    v_mfma_f32_16x16x32_bf16 v[72:75], a[228:231], a[160:163], v[72:75]
    ds_read_b64_tr_b16 a[216:217], v3 offset:0
    v_exp_f32 v63, v63
    v_mfma_f32_16x16x32_bf16 v[44:47], a[236:239], v[14:17], 0
    s_add_u32 m0, s22, 12288
    ds_write2st64_b64 v101, v[208:209], v[104:105] offset0:24 offset1:36
    v_pk_mul_f32 v[130:131], v[130:131], v[48:49] op_sel_hi:[1,0]
    v_pk_mul_f32 v[132:133], v[132:133], v[48:49] op_sel_hi:[1,0]
    v_cvt_pk_bf16_f32 v176, v176, v177
    v_pk_mul_f32 v[128:129], v[128:129], v[48:49] op_sel_hi:[1,0]
    v_mul_f32 v183, v183, v49
    v_pk_mul_f32 v[118:119], v[118:119], v[48:49] op_sel_hi:[1,0]
    v_fma_f32 v55, v55, s28, v9
    v_pk_mul_f32 v[214:215], v[214:215], v[50:51] op_sel_hi:[1,0]
    v_cvt_pk_bf16_f32 v117, v118, v119
    v_cvt_pk_bf16_f32 v192, v192, v193
    v_cvt_pk_bf16_f32 v213, v214, v215
    v_pk_mul_f32 v[152:153], v[152:153], v[48:49] op_sel_hi:[1,0]
    v_pk_mul_f32 v[224:225], v[224:225], v[50:51] op_sel_hi:[1,0]
    v_pk_mul_f32 v[230:231], v[230:231], v[50:51] op_sel_hi:[1,0]
    v_pk_mul_f32 v[144:145], v[144:145], v[48:49] op_sel_hi:[1,0]
    v_pk_mul_f32 v[126:127], v[126:127], v[48:49] op_sel_hi:[1,0]
    v_accvgpr_read_b32 v104, a8
    v_pk_mul_f32 v[226:227], v[226:227], v[50:51] op_sel_hi:[1,0]
    v_fma_f32 v76, v76, s28, v12
    v_mul_f32 v111, v111, v51
    v_pk_mul_f32 v[154:155], v[154:155], v[48:49] op_sel_hi:[1,0]
    v_pk_mul_f32 v[228:229], v[228:229], v[50:51] op_sel_hi:[1,0]
    v_pk_mul_f32 v[158:159], v[158:159], v[48:49] op_sel_hi:[1,0]
    v_pk_mul_f32 v[240:241], v[240:241], v[50:51] op_sel_hi:[1,0]
    v_pk_mul_f32 v[252:253], v[252:253], v[50:51] op_sel_hi:[1,0]
    v_pk_mul_f32 v[136:137], v[136:137], v[48:49] op_sel_hi:[1,0]
    v_pk_mul_f32 v[122:123], v[122:123], v[48:49] op_sel_hi:[1,0]
    v_pk_mul_f32 v[218:219], v[218:219], v[50:51] op_sel_hi:[1,0]
    v_pk_mul_f32 v[236:237], v[236:237], v[50:51] op_sel_hi:[1,0]
    v_accvgpr_read_b32 v105, a9
    v_cvt_pk_bf16_f32 v165, v166, v167
    v_cvt_pk_bf16_f32 v132, v132, v133
    v_mfma_f32_16x16x32_bf16 v[72:75], a[224:227], a[156:159], v[72:75]
    ds_read_b64_tr_b16 a[218:219], v3 offset:6144
    v_cvt_pk_bf16_f32 v168, v168, v169
    v_xor_b32 v101, 32, v101
    v_mfma_f32_16x16x32_bf16 v[64:67], a[224:227], a[132:135], v[64:67]
    buffer_load_dwordx4 v6, s[4:7], s20 offen lds
    v_fma_f32 v60, v60, s28, v10
    v_mfma_f32_16x16x32_bf16 v[64:67], a[228:231], a[136:139], v[64:67]
    ds_write2st64_b64 v101, v[116:117], v[164:165] offset0:0 offset1:12
    v_fma_f32 v69, v69, s28, v11
    v_mfma_f32_16x16x32_bf16 v[64:67], a[232:235], a[140:143], v[64:67]
    ds_write2st64_b64 v101, v[212:213], v[108:109] offset0:24 offset1:36
    v_cvt_pk_bf16_f32 v240, v240, v241
    v_cvt_pk_bf16_f32 v128, v128, v129
    v_fma_f32 v79, v79, s28, v12
    v_mfma_f32_16x16x32_bf16 v[56:59], a[232:235], a[116:119], v[56:59]
    ds_read_b64_tr_b16 a[220:221], v4 offset:0
    v_accvgpr_read_b32 v109, a13
    v_mul_f32 v170, v170, v49
    v_mul_f32 v196, v196, v49
    v_mfma_f32_16x16x32_bf16 v[56:59], a[228:231], a[112:115], v[56:59]
    v_exp_f32 v54, v54
    v_mfma_f32_16x16x32_bf16 v[44:47], a[240:243], v[20:23], v[44:47]
    ds_read_b64_tr_b16 a[228:229], v2 offset:1024
    v_mul_f32 v105, v105, v51
    v_accvgpr_read_b32 v108, a12
    v_mul_f32 v104, v104, v51
    v_cvt_pk_bf16_f32 v181, v182, v183
    v_pk_mul_f32 v[216:217], v[216:217], v[50:51] op_sel_hi:[1,0]
    v_mul_f32 v108, v108, v51
    v_pk_mul_f32 v[244:245], v[244:245], v[50:51] op_sel_hi:[1,0]
    v_cvt_pk_bf16_f32 v224, v224, v225
    v_mul_f32 v109, v109, v51
    v_cvt_pk_bf16_f32 v136, v136, v137
    v_fma_f32 v66, v66, s28, v10
    v_fma_f32 v75, v75, s28, v11
    v_pk_mul_f32 v[150:151], v[150:151], v[48:49] op_sel_hi:[1,0]
    v_accvgpr_read_b32 v106, a10
    v_mul_f32 v106, v106, v51
    v_mfma_f32_16x16x32_bf16 v[56:59], a[224:227], a[108:111], v[56:59]
    s_waitcnt lgkmcnt(3)
    v_xor_b32 v101, 96, v101
    v_cvt_pk_bf16_f32 v252, v252, v253
    v_mfma_f32_16x16x32_bf16 v[112:115], a[212:215], v[14:17], 0
    s_add_u32 s20, s20, 128
    ds_read_b64_tr_b16 a[222:223], v4 offset:6144
    v_fma_f32 v61, v61, s28, v10
    v_cvt_pk_bf16_f32 v177, v178, v179
    v_exp_f32 v62, v62
    v_pk_mul_f32 v[222:223], v[222:223], v[50:51] op_sel_hi:[1,0]
    v_pk_mul_f32 v[138:139], v[138:139], v[48:49] op_sel_hi:[1,0]
    v_pk_mul_f32 v[242:243], v[242:243], v[50:51] op_sel_hi:[1,0]
    v_pk_mul_f32 v[142:143], v[142:143], v[48:49] op_sel_hi:[1,0]
    v_pk_mul_f32 v[238:239], v[238:239], v[50:51] op_sel_hi:[1,0]
    v_exp_f32 v76, v76
    v_cvt_pk_bf16_f32 v104, v104, v105
    v_pk_mul_f32 v[124:125], v[124:125], v[48:49] op_sel_hi:[1,0]
    v_pk_mul_f32 v[148:149], v[148:149], v[48:49] op_sel_hi:[1,0]
    v_pk_mul_f32 v[134:135], v[134:135], v[48:49] op_sel_hi:[1,0]
    v_cvt_pk_bf16_f32 v124, v124, v125
    v_cvt_pk_bf16_f32 v148, v148, v149
    v_exp_f32 v55, v55
    v_cvt_pk_bf16_f32 v184, v184, v185
    v_mfma_f32_16x16x32_bf16 v[116:119], a[216:219], v[14:17], 0
    s_add_u32 m0, s22, 13312
    ds_read_b64_tr_b16 a[224:225], v5 offset:0
    v_fma_f32 v74, v74, s28, v11
    v_cvt_pk_bf16_f32 v221, v222, v223
    v_cvt_pk_bf16_f32 v185, v186, v187
    v_cvt_pk_bf16_f32 v129, v130, v131
    v_pk_mul_f32 v[156:157], v[156:157], v[48:49] op_sel_hi:[1,0]
    v_cvt_pk_bf16_f32 v228, v228, v229
    v_cvt_pk_bf16_f32 v105, v106, v107
    v_cvt_pk_bf16_f32 v229, v230, v231
    v_cvt_pk_bf16_f32 v225, v226, v227
    v_fma_f32 v56, v56, s28, v9
    v_cvt_pk_bf16_f32 v241, v242, v243
    v_cvt_pk_bf16_f32 v121, v122, v123
    v_mul_f32 v188, v188, v49
    v_mfma_f32_16x16x32_bf16 v[164:167], a[216:219], v[20:23], 0
    buffer_load_dwordx4 v6, s[4:7], s20 offen lds
    ds_read_b64_tr_b16 a[226:227], v5 offset:6144
    v_cvt_pk_bf16_f32 v216, v216, v217
    v_cvt_pk_bf16_f32 v217, v218, v219
    v_cvt_pk_bf16_f32 v125, v126, v127
    v_fma_f32 v83, v83, s28, v12
    v_cvt_pk_bf16_f32 v108, v108, v109
    v_pk_mul_f32 v[140:141], v[140:141], v[48:49] op_sel_hi:[1,0]
    v_fma_f32 v64, v64, s28, v10
    v_cvt_pk_bf16_f32 v188, v188, v189
    v_cvt_pk_bf16_f32 v169, v170, v171
    v_mfma_f32_16x16x32_bf16 v[160:163], a[212:215], v[20:23], 0
    ds_read_b64_tr_b16 a[234:235], v3 offset:7168
    v_cvt_pk_bf16_f32 v196, v196, v197
    v_mfma_f32_16x16x32_bf16 v[208:211], a[212:215], v[26:29], 0
    s_add_u32 s20, s20, 128
    ds_write2st64_b64 v101, v[120:121], v[168:169] offset0:0 offset1:12
    v_fma_f32 v65, v65, s28, v10
    v_exp_f32 v75, v75
    v_accvgpr_read_b32 v107, a19
    v_mfma_f32_16x16x32_bf16 v[212:215], a[216:219], v[26:29], 0
    ds_read_b64_tr_b16 a[230:231], v2 offset:7168
    v_cvt_pk_bf16_f32 v173, v174, v175
    v_mfma_f32_16x16x32_bf16 a[4:7], a[216:219], v[32:35], 0
    ds_write2st64_b64 v101, v[216:217], v[104:105] offset0:24 offset1:36
    v_pk_mul_f32 v[232:233], v[232:233], v[50:51] op_sel_hi:[1,0]
    v_cvt_pk_bf16_f32 v236, v236, v237
    v_fma_f32 v52, v52, s28, v9
    v_cvt_pk_bf16_f32 v144, v144, v145
    v_fma_f32 v58, v58, s28, v9
    v_accvgpr_read_b32 v104, a16
    v_cvt_pk_bf16_f32 v109, v110, v111
    v_pk_mul_f32 v[248:249], v[248:249], v[50:51] op_sel_hi:[1,0]
    v_accvgpr_read_b32 v111, a23
    v_accvgpr_read_b32 v110, a22
    v_fma_f32 v53, v53, s28, v9
    v_accvgpr_read_b32 v106, a18
    v_cvt_pk_bf16_f32 v204, v204, v205
    v_pk_mul_f32 v[146:147], v[146:147], v[48:49] op_sel_hi:[1,0]
    v_cvt_pk_bf16_f32 v232, v232, v233
    v_xor_b32 v101, 32, v101
    v_cvt_pk_bf16_f32 v19, v54, v55
    v_mul_f32 v107, v107, v51
    v_mfma_f32_16x16x32_bf16 a[0:3], a[212:215], v[32:35], 0
    s_waitcnt lgkmcnt(2)
    ds_write2st64_b64 v101, v[124:125], v[172:173] offset0:0 offset1:12
    v_mfma_f32_16x16x32_bf16 a[8:11], a[220:223], v[32:35], 0
    ds_read_b128 v[84:87], v8 offset:0
    v_fma_f32 v82, v82, s28, v12
    v_mfma_f32_16x16x32_bf16 a[12:15], a[224:227], v[32:35], 0
    s_add_u32 m0, s22, 14336
    ds_write2st64_b64 v101, v[220:221], v[108:109] offset0:24 offset1:36
    v_accvgpr_read_b32 v109, a21
    v_mfma_f32_16x16x32_bf16 v[44:47], a[244:247], v[26:29], v[44:47]
    ds_read_b64_tr_b16 a[232:233], v3 offset:1024
    v_mul_f32 v104, v104, v51
    v_mfma_f32_16x16x32_bf16 v[220:223], a[224:227], v[26:29], 0
    ds_read_b64_tr_b16 a[216:217], v5 offset:1024
    buffer_load_dwordx4 v6, s[4:7], s20 offen lds
    v_mul_f32 v109, v109, v51
    v_accvgpr_read_b32 v105, a17
    v_pk_mul_f32 v[250:251], v[250:251], v[50:51] op_sel_hi:[1,0]
    v_cvt_pk_bf16_f32 v248, v248, v249
    v_mul_f32 v110, v110, v51
    v_mfma_f32_16x16x32_bf16 v[216:219], a[220:223], v[26:29], 0
    ds_read_b128 v[96:99], v8 offset:6144
    v_cvt_pk_bf16_f32 v189, v190, v191
    v_mfma_f32_16x16x32_bf16 v[168:171], a[220:223], v[20:23], 0
    ds_read_b128 v[88:91], v8 offset:1024
    v_accvgpr_read_b32 v108, a20
    v_cvt_pk_bf16_f32 v156, v156, v157
    v_cvt_pk_bf16_f32 v25, v62, v63
    v_xor_b32 v101, 96, v101
    v_cvt_pk_bf16_f32 v140, v140, v141
    v_cvt_pk_bf16_f32 v133, v134, v135
    v_pk_mul_f32 v[254:255], v[254:255], v[50:51] op_sel_hi:[1,0]
    v_mul_f32 v111, v111, v51
    v_pk_mul_f32 v[234:235], v[234:235], v[50:51] op_sel_hi:[1,0]
    v_mul_f32 v108, v108, v51
    v_mul_f32 v105, v105, v51
    v_fma_f32 v70, v70, s28, v11
    v_mfma_f32_16x16x32_bf16 v[172:175], a[224:227], v[20:23], 0
    s_add_u32 s20, s20, 12032
    ds_write2st64_b64 v101, v[128:129], v[176:177] offset0:4 offset1:16
    v_cvt_pk_bf16_f32 v104, v104, v105
    v_mul_f32 v198, v198, v49
    v_exp_f32 v66, v66
    v_fma_f32 v77, v77, s28, v12
    v_mul_f32 v106, v106, v51
    v_cvt_pk_bf16_f32 v105, v106, v107
    v_cvt_pk_bf16_f32 v108, v108, v109
    v_cvt_pk_bf16_f32 v109, v110, v111
    v_cvt_pk_bf16_f32 v141, v142, v143
    v_cvt_pk_bf16_f32 v193, v194, v195
    v_cvt_pk_bf16_f32 v200, v200, v201
    v_mfma_f32_16x16x32_bf16 v[124:127], a[224:227], v[14:17], 0
    s_add_u32 m0, s38, 0
    ds_write2st64_b64 v101, v[224:225], v[104:105] offset0:28 offset1:40
    v_accvgpr_read_b32 v106, a26
    v_accvgpr_read_b32 v111, a31
    v_cvt_pk_bf16_f32 v253, v254, v255
    v_fma_f32 v57, v57, s28, v9
    v_accvgpr_read_b32 v110, a30
    v_xor_b32 v101, 32, v101
    v_cvt_pk_bf16_f32 v152, v152, v153
    v_accvgpr_read_b32 v105, a25
    v_mfma_f32_16x16x32_bf16 v[120:123], a[220:223], v[14:17], 0
    s_waitcnt lgkmcnt(2)
    ds_read_b64_tr_b16 a[212:213], v4 offset:1024
    buffer_load_dwordx4 v6, s[12:15], s33 offen nt lds
    v_cvt_pk_bf16_f32 v205, v206, v207
    v_accvgpr_read_b32 v104, a24
    v_mfma_f32_16x16x32_bf16 v[128:131], a[228:231], v[14:17], 0
    s_add_u32 m0, s38, 1024
    ds_write2st64_b64 v101, v[132:133], v[180:181] offset0:4 offset1:16
    v_mul_f32 v106, v106, v51
    v_fma_f32 v80, v80, s28, v12
    v_mfma_f32_16x16x32_bf16 v[132:135], a[232:235], v[14:17], 0
    buffer_store_dwordx4 v[84:87], v102, s[16:19], s67 offen offset:0 nt
    ds_read_b64_tr_b16 a[224:225], v3 offset:2048
    v_accvgpr_read_b32 v107, a27
    v_mul_f32 v104, v104, v51
    v_mfma_f32_16x16x32_bf16 v[180:183], a[232:235], v[20:23], 0
    ds_write2st64_b64 v101, v[228:229], v[108:109] offset0:28 offset1:40
    v_cvt_pk_bf16_f32 v197, v198, v199
    v_mul_f32 v107, v107, v51
    v_accvgpr_read_b32 v108, a28
    v_accvgpr_read_b32 v109, a29
    v_cvt_pk_bf16_f32 v233, v234, v235
    v_mfma_f32_16x16x32_bf16 v[176:179], a[228:231], v[20:23], 0
    ds_read_b64_tr_b16 a[214:215], v4 offset:7168
    ds_read_b64_tr_b16 a[218:219], v5 offset:7168
    v_mul_f32 v105, v105, v51
    v_exp_f32 v69, v69
    v_cvt_pk_bf16_f32 v104, v104, v105
    v_xor_b32 v101, 96, v101
    v_fma_f32 v81, v81, s28, v12
    v_cvt_pk_bf16_f32 v105, v106, v107
    v_mul_f32 v110, v110, v51
    v_accvgpr_read_b32 v107, a35
    v_mul_f32 v109, v109, v51
    v_mfma_f32_16x16x32_bf16 v[224:227], a[228:231], v[26:29], 0
    ds_read_b64_tr_b16 a[226:227], v3 offset:8192
    ds_read_b64_tr_b16 a[220:221], v2 offset:2048
    buffer_load_dwordx4 v7, s[12:15], s33 offen nt lds
    v_cvt_pk_bf16_f32 v137, v138, v139
    v_accvgpr_read_b32 v106, a34
    v_mul_f32 v108, v108, v51
    v_cvt_pk_bf16_f32 v237, v238, v239
    v_cvt_pk_bf16_f32 v201, v202, v203
    v_fma_f32 v72, v72, s28, v11
    v_mfma_f32_16x16x32_bf16 v[228:231], a[232:235], v[26:29], 0
    ds_write2st64_b64 v101, v[136:137], v[184:185] offset0:4 offset1:16
    v_mfma_f32_16x16x32_bf16 a[20:23], a[232:235], v[32:35], 0
    buffer_store_dwordx4 v[88:91], v103, s[16:19], s67 offen offset:0 nt
    s_add_u32 s57, s67, 6144
    ds_write2st64_b64 v101, v[232:233], v[104:105] offset0:28 offset1:40
    v_accvgpr_read_b32 v105, a33
    v_cvt_pk_bf16_f32 v145, v146, v147
    v_pk_mul_f32 v[246:247], v[246:247], v[50:51] op_sel_hi:[1,0]
    v_mul_f32 v111, v111, v51
    v_cvt_pk_bf16_f32 v108, v108, v109
    v_xor_b32 v101, 32, v101
    v_exp_f32 v52, v52
    v_mfma_f32_16x16x32_bf16 a[16:19], a[228:231], v[32:35], 0
    s_waitcnt lgkmcnt(4)
    ds_read_b64_tr_b16 a[222:223], v2 offset:8192
    v_cvt_pk_bf16_f32 v109, v110, v111
    v_mfma_f32_16x16x32_bf16 a[24:27], a[212:215], v[32:35], 0
    ds_write2st64_b64 v101, v[140:141], v[188:189] offset0:4 offset1:16
    v_mfma_f32_16x16x32_bf16 a[28:31], a[216:219], v[32:35], 0
    ds_write2st64_b64 v101, v[236:237], v[108:109] offset0:28 offset1:40
    v_accvgpr_read_b32 v104, a32
    v_mfma_f32_16x16x32_bf16 v[236:239], a[216:219], v[26:29], 0
    s_add_u32 s59, s33, 6144
    ds_read_b64_tr_b16 a[234:235], v5 offset:8192
    v_cvt_pk_bf16_f32 v244, v244, v245
    v_mul_f32 v106, v106, v51
    v_accvgpr_read_b32 v111, a39
    v_accvgpr_read_b32 v108, a36
    v_mul_f32 v105, v105, v51
    v_mul_f32 v107, v107, v51
    v_xor_b32 v101, 96, v101
    v_cvt_pk_bf16_f32 v249, v250, v251
    v_mfma_f32_16x16x32_bf16 v[232:235], a[212:215], v[26:29], 0
    s_add_u32 m0, s38, 6144
    ds_read_b128 v[84:87], v8 offset:7168
    v_mul_f32 v104, v104, v51
    v_cvt_pk_bf16_f32 v104, v104, v105
    v_mul_f32 v108, v108, v51
    v_cvt_pk_bf16_f32 v105, v106, v107
    v_accvgpr_read_b32 v106, a42
    v_cvt_pk_bf16_f32 v153, v154, v155
    v_cvt_pk_bf16_f32 v245, v246, v247
    v_mul_f32 v111, v111, v51
    v_mfma_f32_16x16x32_bf16 v[184:187], a[212:215], v[20:23], 0
    ds_read_b64_tr_b16 a[228:229], v4 offset:2048
    ds_read_b64_tr_b16 a[230:231], v4 offset:8192
    v_accvgpr_read_b32 v109, a37
    v_mfma_f32_16x16x32_bf16 v[188:191], a[216:219], v[20:23], 0
    buffer_load_dwordx4 v6, s[12:15], s59 offen nt lds
    ds_read_b64_tr_b16 a[232:233], v5 offset:2048
    v_accvgpr_read_b32 v110, a38
    v_mul_f32 v109, v109, v51
    v_accvgpr_read_b32 v107, a43
    v_mul_f32 v107, v107, v51
    v_mul_f32 v110, v110, v51
    v_cvt_pk_bf16_f32 v149, v150, v151
    v_mfma_f32_16x16x32_bf16 v[140:143], a[216:219], v[14:17], 0
    buffer_store_dwordx4 v[96:99], v102, s[16:19], s57 offen offset:0 nt
    s_add_u32 m0, s38, 7168
    ds_write2st64_b64 v101, v[144:145], v[192:193] offset0:8 offset1:20
    v_cvt_pk_bf16_f32 v108, v108, v109
    v_mfma_f32_16x16x32_bf16 v[136:139], a[212:215], v[14:17], 0
    ds_write2st64_b64 v101, v[240:241], v[104:105] offset0:32 offset1:44
    v_xor_b32 v101, 32, v101
    v_fma_f32 v73, v73, s28, v11
    v_accvgpr_read_b32 v104, a40
    v_cvt_pk_bf16_f32 v109, v110, v111
    v_mfma_f32_16x16x32_bf16 v[44:47], a[248:251], v[32:35], v[44:47]
    s_waitcnt lgkmcnt(4)
    ds_read_b128 v[88:91], v8 offset:2048
    buffer_load_dwordx4 v7, s[12:15], s59 offen nt lds
    v_mfma_f32_16x16x32_bf16 v[144:147], a[220:223], v[14:17], 0
    s_add_u32 s39, s39, 12288
    ds_write2st64_b64 v101, v[148:149], v[196:197] offset0:8 offset1:20
    v_mfma_f32_16x16x32_bf16 v[148:151], a[224:227], v[14:17], 0
    s_waitcnt vmcnt(13) lgkmcnt(4)
    ds_write2st64_b64 v101, v[244:245], v[108:109] offset0:32 offset1:44
    v_mul_f32 v106, v106, v51
    v_mfma_f32_16x16x32_bf16 v[196:199], a[224:227], v[20:23], 0
    buffer_store_dwordx4 v[84:87], v103, s[16:19], s57 offen offset:0 nt
    s_barrier
    v_xor_b32 v101, 96, v101
    v_accvgpr_read_b32 v105, a41
    v_accvgpr_read_b32 v110, a46
    v_mul_f32 v104, v104, v51
    v_mfma_f32_16x16x32_bf16 v[192:195], a[220:223], v[20:23], 0
    ds_read_b128 a[212:215], v0 offset:0
    v_cvt_pk_bf16_f32 v30, v68, v69
    v_accvgpr_read_b32 v109, a45
    v_exp_f32 v78, v78
    v_accvgpr_read_b32 v108, a44
    v_accvgpr_read_b32 v111, a47
    v_cvt_pk_bf16_f32 v157, v158, v159
    v_mul_f32 v105, v105, v51
    v_mul_f32 v110, v110, v51
    v_mul_f32 v111, v111, v51
    v_cvt_pk_bf16_f32 v104, v104, v105
    v_mfma_f32_16x16x32_bf16 v[240:243], a[220:223], v[26:29], 0
    ds_write2st64_b64 v101, v[152:153], v[200:201] offset0:8 offset1:20
    v_mfma_f32_16x16x32_bf16 v[244:247], a[224:227], v[26:29], 0
    ds_read_b128 a[216:219], v1 offset:0
    v_mul_f32 v108, v108, v51
    v_cvt_pk_bf16_f32 v105, v106, v107
    v_mul_f32 v109, v109, v51
    v_mfma_f32_16x16x32_bf16 a[36:39], a[224:227], v[32:35], 0
    ds_write2st64_b64 v101, v[248:249], v[104:105] offset0:32 offset1:44
    v_mfma_f32_16x16x32_bf16 a[32:35], a[220:223], v[32:35], 0
    s_add_u32 m0, s22, 24576
    ds_read_b128 a[220:223], v0 offset:1024
    v_xor_b32 v101, 32, v101
    v_cvt_pk_bf16_f32 v108, v108, v109
    v_mfma_f32_16x16x32_bf16 a[40:43], a[228:231], v[32:35], 0
    ds_write2st64_b64 v101, v[156:157], v[204:205] offset0:8 offset1:20
    v_cvt_pk_bf16_f32 v109, v110, v111
    v_mfma_f32_16x16x32_bf16 a[44:47], a[232:235], v[32:35], 0
    ds_write2st64_b64 v101, v[252:253], v[108:109] offset0:32 offset1:44
    v_exp_f32 v53, v53
    v_mfma_f32_16x16x32_bf16 v[252:255], a[232:235], v[26:29], 0
    v_exp_f32 v64, v64
    v_mfma_f32_16x16x32_bf16 v[248:251], a[228:231], v[26:29], 0
    v_exp_f32 v79, v79
    v_exp_f32 v70, v70
    v_mfma_f32_16x16x32_bf16 v[200:203], a[228:231], v[20:23], 0
    buffer_load_dwordx4 v6, s[8:11], s21 offen lds
    v_mfma_f32_16x16x32_bf16 v[204:207], a[232:235], v[20:23], 0
    s_add_u32 s21, s21, 128
    ds_read_b128 a[224:227], v1 offset:1024
    v_cvt_pk_bf16_f32 v18, v52, v53
    v_cvt_pk_bf16_f32 v31, v70, v71
    v_mfma_f32_16x16x32_bf16 v[156:159], a[232:235], v[14:17], 0
    s_add_u32 m0, s22, 25600
    v_exp_f32 v60, v60
    v_exp_f32 v77, v77
    v_mfma_f32_16x16x32_bf16 v[152:155], a[228:231], v[14:17], 0
    s_waitcnt lgkmcnt(2)
    v_exp_f32 v61, v61
    v_mfma_f32_16x16x32_bf16 v[52:55], a[212:215], a[96:99], 0
    ds_read_b128 a[232:235], v1 offset:2048
    buffer_load_dwordx4 v6, s[8:11], s21 offen lds
    v_mfma_f32_16x16x32_bf16 v[52:55], a[216:219], a[100:103], v[52:55]
    ds_read_b128 a[228:231], v0 offset:2048
    v_fma_f32 v67, v67, s28, v10
    v_mfma_f32_16x16x32_bf16 v[52:55], a[220:223], a[104:107], v[52:55]
    ds_read_b128 v[96:99], v8 offset:3072
    v_cvt_pk_bf16_f32 v24, v60, v61
    v_mfma_f32_16x16x32_bf16 v[60:63], a[220:223], a[128:131], 0
    ds_read_b128 v[84:87], v8 offset:8192
    v_fma_f32 v59, v59, s28, v9
    v_mfma_f32_16x16x32_bf16 v[60:63], a[216:219], a[124:127], v[60:63]
    s_add_u32 s21, s21, 128
    v_exp_f32 v73, v73
    v_mfma_f32_16x16x32_bf16 v[60:63], a[212:215], a[120:123], v[60:63]
    s_add_u32 m0, s22, 26624
    v_exp_f32 v56, v56
    v_mfma_f32_16x16x32_bf16 v[68:71], a[212:215], a[144:147], 0
    buffer_load_dwordx4 v6, s[8:11], s21 offen lds
    v_mfma_f32_16x16x32_bf16 v[68:71], a[216:219], a[148:151], v[68:71]
    v_cvt_pk_bf16_f32 v37, v78, v79
    v_cvt_pk_bf16_f32 v36, v76, v77
    v_mfma_f32_16x16x32_bf16 v[68:71], a[220:223], a[152:155], v[68:71]
    s_add_u32 s21, s21, 12032
    v_exp_f32 v65, v65
    v_mfma_f32_16x16x32_bf16 v[76:79], a[220:223], a[176:179], 0
    v_exp_f32 v57, v57
    v_mfma_f32_16x16x32_bf16 v[76:79], a[216:219], a[172:175], v[76:79]
    s_add_u32 s56, s67, 128
    v_exp_f32 v59, v59
    v_mfma_f32_16x16x32_bf16 v[76:79], a[212:215], a[168:171], v[76:79]
    buffer_store_dwordx4 v[88:91], v102, s[16:19], s56 offen offset:0 nt
    s_add_u32 s58, s33, 128
    s_add_u32 m0, s38, 2048
    v_exp_f32 v83, v83
    s_waitcnt lgkmcnt(0)
    v_mfma_f32_16x16x32_bf16 v[76:79], a[224:227], a[180:183], v[76:79]
    v_exp_f32 v67, v67
    v_mfma_f32_16x16x32_bf16 v[76:79], a[228:231], a[184:187], v[76:79]
    buffer_load_dwordx4 v6, s[12:15], s58 offen nt lds
    v_mfma_f32_16x16x32_bf16 v[76:79], a[232:235], a[188:191], v[76:79]
    ds_read_b128 a[216:219], v1 offset:6144
    v_cvt_pk_bf16_f32 v23, v66, v67
    v_mfma_f32_16x16x32_bf16 v[68:71], a[232:235], a[164:167], v[68:71]
    ds_read_b128 a[212:215], v0 offset:6144
    v_exp_f32 v72, v72
    v_mfma_f32_16x16x32_bf16 v[68:71], a[228:231], a[160:163], v[68:71]
    s_add_u32 m0, s38, 3072
    ds_read_b128 a[220:223], v0 offset:7168
    buffer_load_dwordx4 v7, s[12:15], s58 offen nt lds
    v_mfma_f32_16x16x32_bf16 v[68:71], a[224:227], a[156:159], v[68:71]
    buffer_store_dwordx4 v[96:99], v103, s[16:19], s56 offen offset:0 nt
    s_nop 0
    ds_read_b128 v[96:99], v8 offset:4096
    v_cvt_pk_bf16_f32 v28, v72, v73
    v_exp_f32 v81, v81
    v_mfma_f32_16x16x32_bf16 v[60:63], a[224:227], a[132:135], v[60:63]
    s_add_u32 s57, s67, 6272
    ds_read_b128 v[88:91], v8 offset:9216
    v_cvt_pk_bf16_f32 v22, v64, v65
    v_mfma_f32_16x16x32_bf16 v[60:63], a[228:231], a[136:139], v[60:63]
    v_exp_f32 v80, v80
    v_mfma_f32_16x16x32_bf16 v[60:63], a[232:235], a[140:143], v[60:63]
    s_add_u32 s59, s33, 6272
    v_exp_f32 v58, v58
    v_mfma_f32_16x16x32_bf16 v[52:55], a[232:235], a[116:119], v[52:55]
    v_cvt_pk_bf16_f32 v17, v58, v59
    v_cvt_pk_bf16_f32 v16, v56, v57
    v_mfma_f32_16x16x32_bf16 v[52:55], a[228:231], a[112:115], v[52:55]
    v_exp_f32 v74, v74
    v_mfma_f32_16x16x32_bf16 v[52:55], a[224:227], a[108:111], v[52:55]
    s_add_u32 m0, s38, 8192
    ds_read_b128 a[224:227], v1 offset:7168
    v_cvt_pk_bf16_f32 v34, v80, v81
    v_mfma_f32_16x16x32_bf16 v[48:51], a[236:239], v[16:19], v[44:47]
    buffer_store_dwordx4 v[84:87], v102, s[16:19], s57 offen offset:0 nt
    v_cvt_pk_bf16_f32 v29, v74, v75
    v_exp_f32 v82, v82
    v_mfma_f32_16x16x32_bf16 v[48:51], a[240:243], v[22:25], v[48:51]
    ds_read_b128 a[232:235], v1 offset:8192
    v_cvt_pk_bf16_f32 v35, v82, v83
    v_mfma_f32_16x16x32_bf16 v[48:51], a[244:247], v[28:31], v[48:51]
    buffer_load_dwordx4 v6, s[12:15], s59 offen nt lds
    v_mfma_f32_16x16x32_bf16 v[48:51], a[248:251], v[34:37], v[48:51]
    s_add_u32 m0, s38, 9216
    ds_read_b128 v[84:87], v8 offset:5120
    s_waitcnt lgkmcnt(3)
    v_mfma_f32_16x16x32_bf16 v[56:59], a[212:215], a[96:99], 0
    buffer_load_dwordx4 v7, s[12:15], s59 offen nt lds
    v_mfma_f32_16x16x32_bf16 v[56:59], a[216:219], a[100:103], v[56:59]
    ds_read_b128 a[228:231], v0 offset:8192
    v_mfma_f32_16x16x32_bf16 v[56:59], a[220:223], a[104:107], v[56:59]
    s_add_u32 s56, s67, 256
    v_cmp_lt_f32 vcc, s29, v48
    v_mfma_f32_16x16x32_bf16 v[64:67], a[220:223], a[128:131], 0
    s_add_u32 s58, s33, 256
    s_add_u32 m0, s38, 4096
    v_mfma_f32_16x16x32_bf16 v[64:67], a[216:219], a[124:127], v[64:67]
    buffer_load_dwordx4 v6, s[12:15], s58 offen nt lds
    v_mfma_f32_16x16x32_bf16 v[64:67], a[212:215], a[120:123], v[64:67]
    buffer_store_dwordx4 v[88:91], v103, s[16:19], s57 offen offset:0 nt
    s_add_u32 m0, s38, 5120
    s_cbranch_vccnz L_rs_tr44d
L_ret_tr44d:
    v_fma_f32 v54, v54, s28, v9
    v_add_u32 v8, 10240, v8
    v_mfma_f32_16x16x32_bf16 v[72:75], a[212:215], a[144:147], 0
    v_fma_f32 v61, v61, s28, v10
    v_fma_f32 v52, v52, s28, v9
    v_mfma_f32_16x16x32_bf16 v[72:75], a[216:219], a[148:151], v[72:75]
    v_exp_f32 v61, v61
    v_mfma_f32_16x16x32_bf16 v[72:75], a[220:223], a[152:155], v[72:75]
    s_waitcnt lgkmcnt(1)
    buffer_load_dwordx4 v7, s[12:15], s58 offen nt lds
    v_mfma_f32_16x16x32_bf16 v[80:83], a[220:223], a[176:179], 0
    buffer_store_dwordx4 v[96:99], v102, s[16:19], s56 offen offset:0 nt
    v_exp_f32 v54, v54
    s_waitcnt vmcnt(25) lgkmcnt(0)
    v_mfma_f32_16x16x32_bf16 v[80:83], a[216:219], a[172:175], v[80:83]
    s_barrier
    v_mfma_f32_16x16x32_bf16 v[80:83], a[212:215], a[168:171], v[80:83]
    v_fma_f32 v60, v60, s28, v10
    v_fma_f32 v53, v53, s28, v9
    v_mfma_f32_16x16x32_bf16 v[80:83], a[224:227], a[180:183], v[80:83]
    s_add_u32 m0, s22, 0
    ds_read_b64_tr_b16 a[212:213], v2 offset:18432
    buffer_load_dwordx4 v6, s[4:7], s20 offen lds
    v_mfma_f32_16x16x32_bf16 v[80:83], a[228:231], a[184:187], v[80:83]
    ds_read_b64_tr_b16 a[214:215], v2 offset:12288
    v_fma_f32 v55, v55, s28, v9
    v_mfma_f32_16x16x32_bf16 v[80:83], a[232:235], a[188:191], v[80:83]
    s_add_u32 s20, s20, 128
    ds_read_b64_tr_b16 a[216:217], v3 offset:18432
    v_mfma_f32_16x16x32_bf16 v[72:75], a[232:235], a[164:167], v[72:75]
    s_add_u32 m0, s22, 1024
    v_exp_f32 v60, v60
    v_mfma_f32_16x16x32_bf16 v[72:75], a[228:231], a[160:163], v[72:75]
    ds_read_b64_tr_b16 a[218:219], v3 offset:12288
    v_mfma_f32_16x16x32_bf16 v[72:75], a[224:227], a[156:159], v[72:75]
    ds_read_b64_tr_b16 a[220:221], v4 offset:18432
    v_mfma_f32_16x16x32_bf16 v[64:67], a[224:227], a[132:135], v[64:67]
    buffer_load_dwordx4 v6, s[4:7], s20 offen lds
    v_mfma_f32_16x16x32_bf16 v[64:67], a[228:231], a[136:139], v[64:67]
    ds_read_b64_tr_b16 a[222:223], v4 offset:12288
    v_cvt_pk_bf16_f32 v20, v60, v61
    v_mfma_f32_16x16x32_bf16 v[64:67], a[232:235], a[140:143], v[64:67]
    s_add_u32 s20, s20, 128
    v_exp_f32 v55, v55
    v_mfma_f32_16x16x32_bf16 v[56:59], a[232:235], a[116:119], v[56:59]
    buffer_store_dwordx4 v[84:87], v103, s[16:19], s56 offen offset:0 nt
    s_add_u32 m0, s22, 2048
    v_exp_f32 v53, v53
    v_cvt_pk_bf16_f32 v15, v54, v55
    v_mfma_f32_16x16x32_bf16 v[56:59], a[228:231], a[112:115], v[56:59]
    v_exp_f32 v52, v52
    v_mfma_f32_16x16x32_bf16 v[56:59], a[224:227], a[108:111], v[56:59]
    ds_read_b64_tr_b16 a[224:225], v5 offset:18432
    ds_read_b64_tr_b16 a[226:227], v5 offset:12288
    buffer_load_dwordx4 v6, s[4:7], s20 offen lds
    v_cvt_pk_bf16_f32 v14, v52, v53
    s_add_u32 s20, s20, 12032
    s_branch L_loop4
L_end5:
    s_waitcnt lgkmcnt(4)
    v_mfma_f32_16x16x32_bf16 v[112:115], a[212:215], v[16:19], v[112:115]
    v_mfma_f32_16x16x32_bf16 v[116:119], a[216:219], v[16:19], v[116:119]
    v_fma_f32 v85, v85, s28, v13
    v_fma_f32 v83, v83, s28, v12
    v_mfma_f32_16x16x32_bf16 v[164:167], a[216:219], v[22:25], v[164:167]
    v_fma_f32 v78, v78, s28, v12
    v_fma_f32 v68, v68, s28, v11
    v_mfma_f32_16x16x32_bf16 v[160:163], a[212:215], v[22:25], v[160:163]
    ds_read_b64_tr_b16 a[230:231], v2 offset:13312
    v_fma_f32 v84, v84, s28, v13
    v_mfma_f32_16x16x32_bf16 v[208:211], a[212:215], v[28:31], v[208:211]
    ds_read_b64_tr_b16 a[232:233], v3 offset:19456
    v_fma_f32 v79, v79, s28, v12
    v_mfma_f32_16x16x32_bf16 v[212:215], a[216:219], v[28:31], v[212:215]
    ds_read_b64_tr_b16 a[234:235], v3 offset:13312
    v_mfma_f32_16x16x32_bf16 a[4:7], a[216:219], v[34:37], a[4:7]
    v_fma_f32 v69, v69, s28, v11
    v_fma_f32 v81, v81, s28, v12
    v_mfma_f32_16x16x32_bf16 a[0:3], a[212:215], v[34:37], a[0:3]
    ds_read_b64_tr_b16 a[228:229], v2 offset:19456
    v_mfma_f32_16x16x32_bf16 a[48:51], a[212:215], v[40:43], a[48:51]
    v_fma_f32 v71, v71, s28, v11
    v_mfma_f32_16x16x32_bf16 a[52:55], a[216:219], v[40:43], a[52:55]
    s_waitcnt lgkmcnt(4)
    ds_read_b64_tr_b16 a[214:215], v4 offset:13312
    v_fma_f32 v59, v59, s28, v9
    v_mfma_f32_16x16x32_bf16 a[56:59], a[220:223], v[40:43], a[56:59]
    v_fma_f32 v76, v76, s28, v12
    v_fma_f32 v87, v87, s28, v13
    v_mfma_f32_16x16x32_bf16 a[60:63], a[224:227], v[40:43], a[60:63]
    ds_read_b64_tr_b16 a[216:217], v5 offset:19456
    v_mfma_f32_16x16x32_bf16 a[12:15], a[224:227], v[34:37], a[12:15]
    v_exp_f32 v83, v83
    v_mfma_f32_16x16x32_bf16 a[8:11], a[220:223], v[34:37], a[8:11]
    ds_read_b64_tr_b16 a[212:213], v4 offset:19456
    v_mfma_f32_16x16x32_bf16 v[216:219], a[220:223], v[28:31], v[216:219]
    v_fma_f32 v74, v74, s28, v11
    v_fma_f32 v89, v89, s28, v13
    v_mfma_f32_16x16x32_bf16 v[220:223], a[224:227], v[28:31], v[220:223]
    v_fma_f32 v82, v82, s28, v12
    v_mfma_f32_16x16x32_bf16 v[172:175], a[224:227], v[22:25], v[172:175]
    v_fma_f32 v90, v90, s28, v13
    v_mfma_f32_16x16x32_bf16 v[168:171], a[220:223], v[22:25], v[168:171]
    ds_read_b64_tr_b16 a[218:219], v5 offset:13312
    v_fma_f32 v57, v57, s28, v9
    v_mfma_f32_16x16x32_bf16 v[120:123], a[220:223], v[16:19], v[120:123]
    v_exp_f32 v69, v69
    v_mfma_f32_16x16x32_bf16 v[124:127], a[224:227], v[16:19], v[124:127]
    s_waitcnt lgkmcnt(3)
    v_exp_f32 v85, v85
    v_mfma_f32_16x16x32_bf16 v[128:131], a[228:231], v[16:19], v[128:131]
    ds_read_b64_tr_b16 a[220:221], v2 offset:20480
    v_fma_f32 v75, v75, s28, v11
    v_mfma_f32_16x16x32_bf16 v[132:135], a[232:235], v[16:19], v[132:135]
    ds_read_b64_tr_b16 a[222:223], v2 offset:14336
    v_mfma_f32_16x16x32_bf16 v[180:183], a[232:235], v[22:25], v[180:183]
    v_exp_f32 v84, v84
    v_mfma_f32_16x16x32_bf16 v[176:179], a[228:231], v[22:25], v[176:179]
    s_add_u32 s39, s39, 12288
    v_fma_f32 v56, v56, s28, v9
    v_fma_f32 v73, v73, s28, v11
    v_mfma_f32_16x16x32_bf16 v[224:227], a[228:231], v[28:31], v[224:227]
    v_exp_f32 v87, v87
    v_mfma_f32_16x16x32_bf16 v[228:231], a[232:235], v[28:31], v[228:231]
    v_fma_f32 v77, v77, s28, v12
    v_mfma_f32_16x16x32_bf16 a[20:23], a[232:235], v[34:37], a[20:23]
    ds_read_b64_tr_b16 a[226:227], v3 offset:14336
    v_fma_f32 v86, v86, s28, v13
    v_mfma_f32_16x16x32_bf16 a[16:19], a[228:231], v[34:37], a[16:19]
    v_exp_f32 v68, v68
    v_mfma_f32_16x16x32_bf16 a[64:67], a[228:231], v[40:43], a[64:67]
    v_fma_f32 v91, v91, s28, v13
    v_fma_f32 v70, v70, s28, v11
    v_mfma_f32_16x16x32_bf16 a[68:71], a[232:235], v[40:43], a[68:71]
    s_waitcnt lgkmcnt(3)
    ds_read_b64_tr_b16 a[228:229], v4 offset:20480
    v_fma_f32 v80, v80, s28, v12
    v_mfma_f32_16x16x32_bf16 a[72:75], a[212:215], v[40:43], a[72:75]
    ds_read_b64_tr_b16 a[224:225], v3 offset:20480
    v_fma_f32 v88, v88, s28, v13
    v_mfma_f32_16x16x32_bf16 a[76:79], a[216:219], v[40:43], a[76:79]
    v_exp_f32 v76, v76
    v_mfma_f32_16x16x32_bf16 a[28:31], a[216:219], v[34:37], a[28:31]
    ds_read_b64_tr_b16 a[232:233], v5 offset:20480
    v_mfma_f32_16x16x32_bf16 a[24:27], a[212:215], v[34:37], a[24:27]
    ds_read_b64_tr_b16 a[234:235], v5 offset:14336
    v_cvt_pk_bf16_f32 v38, v84, v85
    v_mfma_f32_16x16x32_bf16 v[232:235], a[212:215], v[28:31], v[232:235]
    ds_read_b64_tr_b16 a[230:231], v4 offset:14336
    v_mfma_f32_16x16x32_bf16 v[236:239], a[216:219], v[28:31], v[236:239]
    v_exp_f32 v77, v77
    v_mfma_f32_16x16x32_bf16 v[188:191], a[216:219], v[22:25], v[188:191]
    v_exp_f32 v57, v57
    v_mfma_f32_16x16x32_bf16 v[184:187], a[212:215], v[22:25], v[184:187]
    v_exp_f32 v78, v78
    v_mfma_f32_16x16x32_bf16 v[136:139], a[212:215], v[16:19], v[136:139]
    v_fma_f32 v72, v72, s28, v11
    v_cvt_pk_bf16_f32 v26, v68, v69
    v_mfma_f32_16x16x32_bf16 v[140:143], a[216:219], v[16:19], v[140:143]
    s_waitcnt lgkmcnt(4)
    v_mfma_f32_16x16x32_bf16 v[144:147], a[220:223], v[16:19], v[144:147]
    s_waitcnt lgkmcnt(3)
    v_exp_f32 v79, v79
    v_mfma_f32_16x16x32_bf16 v[148:151], a[224:227], v[16:19], v[148:151]
    v_exp_f32 v70, v70
    v_mfma_f32_16x16x32_bf16 v[196:199], a[224:227], v[22:25], v[196:199]
    v_exp_f32 v71, v71
    v_mfma_f32_16x16x32_bf16 v[192:195], a[220:223], v[22:25], v[192:195]
    v_exp_f32 v59, v59
    v_mfma_f32_16x16x32_bf16 v[240:243], a[220:223], v[28:31], v[240:243]
    v_exp_f32 v75, v75
    v_mfma_f32_16x16x32_bf16 v[244:247], a[224:227], v[28:31], v[244:247]
    s_waitcnt vmcnt(10) lgkmcnt(0)
    v_exp_f32 v89, v89
    v_mfma_f32_16x16x32_bf16 a[36:39], a[224:227], v[34:37], a[36:39]
    v_fma_f32 v67, v67, s28, v10
    v_mfma_f32_16x16x32_bf16 a[32:35], a[220:223], v[34:37], a[32:35]
    s_barrier
    v_mfma_f32_16x16x32_bf16 a[80:83], a[220:223], v[40:43], a[80:83]
    ds_read_b128 a[212:215], v0 offset:12288
    v_cvt_pk_bf16_f32 v32, v76, v77
    v_mfma_f32_16x16x32_bf16 a[84:87], a[224:227], v[40:43], a[84:87]
    ds_read_b128 a[220:223], v0 offset:13312
    s_add_u32 m0, s22, 36864
    v_mfma_f32_16x16x32_bf16 a[88:91], a[228:231], v[40:43], a[88:91]
    ds_read_b128 a[216:219], v1 offset:12288
    v_cvt_pk_bf16_f32 v27, v70, v71
    v_mfma_f32_16x16x32_bf16 a[92:95], a[232:235], v[40:43], a[92:95]
    v_exp_f32 v72, v72
    v_mfma_f32_16x16x32_bf16 a[44:47], a[232:235], v[34:37], a[44:47]
    buffer_load_dwordx4 v6, s[8:11], s21 offen lds
    v_mfma_f32_16x16x32_bf16 a[40:43], a[228:231], v[34:37], a[40:43]
    s_add_u32 s21, s21, 128
    s_add_u32 m0, s22, 37888
    v_fma_f32 v58, v58, s28, v9
    v_mfma_f32_16x16x32_bf16 v[248:251], a[228:231], v[28:31], v[248:251]
    buffer_load_dwordx4 v6, s[8:11], s21 offen lds
    v_mfma_f32_16x16x32_bf16 v[252:255], a[232:235], v[28:31], v[252:255]
    ds_read_b128 a[224:227], v1 offset:13312
    v_fma_f32 v64, v64, s28, v10
    v_mfma_f32_16x16x32_bf16 v[204:207], a[232:235], v[22:25], v[204:207]
    v_exp_f32 v64, v64
    v_mfma_f32_16x16x32_bf16 v[200:203], a[228:231], v[22:25], v[200:203]
    s_add_u32 s21, s21, 128
    s_add_u32 m0, s22, 38912
    v_mfma_f32_16x16x32_bf16 v[152:155], a[228:231], v[16:19], v[152:155]
    buffer_load_dwordx4 v6, s[8:11], s21 offen lds
    v_mfma_f32_16x16x32_bf16 v[156:159], a[232:235], v[16:19], v[156:159]
    s_waitcnt lgkmcnt(2)
    ds_read_b128 a[228:231], v0 offset:14336
    v_mfma_f32_16x16x32_bf16 v[52:55], a[212:215], a[96:99], 0
    s_waitcnt lgkmcnt(2)
    v_cvt_pk_bf16_f32 v33, v78, v79
    v_mfma_f32_16x16x32_bf16 v[52:55], a[216:219], a[100:103], v[52:55]
    v_exp_f32 v86, v86
    v_mfma_f32_16x16x32_bf16 v[52:55], a[220:223], a[104:107], v[52:55]
    v_exp_f32 v73, v73
    v_mfma_f32_16x16x32_bf16 v[60:63], a[220:223], a[128:131], 0
    v_exp_f32 v88, v88
    v_mfma_f32_16x16x32_bf16 v[60:63], a[216:219], a[124:127], v[60:63]
    v_exp_f32 v56, v56
    v_mfma_f32_16x16x32_bf16 v[60:63], a[212:215], a[120:123], v[60:63]
    v_exp_f32 v81, v81
    v_mfma_f32_16x16x32_bf16 v[68:71], a[212:215], a[144:147], 0
    ds_read_b128 a[232:235], v1 offset:14336
    v_cvt_pk_bf16_f32 v16, v56, v57
    v_mfma_f32_16x16x32_bf16 v[68:71], a[216:219], a[148:151], v[68:71]
    v_fma_f32 v65, v65, s28, v10
    v_fma_f32 v66, v66, s28, v10
    v_mfma_f32_16x16x32_bf16 v[68:71], a[220:223], a[152:155], v[68:71]
    v_exp_f32 v82, v82
    v_mfma_f32_16x16x32_bf16 v[76:79], a[220:223], a[176:179], 0
    v_cvt_pk_bf16_f32 v39, v86, v87
    v_cvt_pk_bf16_f32 v35, v82, v83
    v_mfma_f32_16x16x32_bf16 v[76:79], a[216:219], a[172:175], v[76:79]
    v_exp_f32 v58, v58
    v_mfma_f32_16x16x32_bf16 v[76:79], a[212:215], a[168:171], v[76:79]
    v_exp_f32 v66, v66
    v_mfma_f32_16x16x32_bf16 v[84:87], a[212:215], a[192:195], 0
    v_exp_f32 v65, v65
    v_mfma_f32_16x16x32_bf16 v[84:87], a[216:219], a[196:199], v[84:87]
    v_mfma_f32_16x16x32_bf16 v[84:87], a[220:223], a[200:203], v[84:87]
    s_waitcnt lgkmcnt(1)
    v_exp_f32 v74, v74
    v_mfma_f32_16x16x32_bf16 v[84:87], a[224:227], a[204:207], v[84:87]
    v_exp_f32 v80, v80
    v_mfma_f32_16x16x32_bf16 v[84:87], a[228:231], a[208:211], v[84:87]
    s_waitcnt lgkmcnt(0)
    ds_read_b128 a[212:215], v0 offset:18432
    v_mfma_f32_16x16x32_bf16 v[84:87], a[232:235], v[92:95], v[84:87]
    v_exp_f32 v67, v67
    v_mfma_f32_16x16x32_bf16 v[76:79], a[232:235], a[188:191], v[76:79]
    v_exp_f32 v90, v90
    v_mfma_f32_16x16x32_bf16 v[76:79], a[228:231], a[184:187], v[76:79]
    v_cvt_pk_bf16_f32 v22, v64, v65
    v_cvt_pk_bf16_f32 v17, v58, v59
    v_mfma_f32_16x16x32_bf16 v[76:79], a[224:227], a[180:183], v[76:79]
    ds_read_b128 a[216:219], v1 offset:18432
    v_mfma_f32_16x16x32_bf16 v[68:71], a[224:227], a[156:159], v[68:71]
    v_cvt_pk_bf16_f32 v23, v66, v67
    v_cvt_pk_bf16_f32 v29, v74, v75
    v_mfma_f32_16x16x32_bf16 v[68:71], a[228:231], a[160:163], v[68:71]
    ds_read_b128 a[220:223], v0 offset:19456
    v_cvt_pk_bf16_f32 v40, v88, v89
    v_mfma_f32_16x16x32_bf16 v[68:71], a[232:235], a[164:167], v[68:71]
    v_cvt_pk_bf16_f32 v28, v72, v73
    v_mfma_f32_16x16x32_bf16 v[60:63], a[232:235], a[140:143], v[60:63]
    v_mfma_f32_16x16x32_bf16 v[60:63], a[228:231], a[136:139], v[60:63]
    v_exp_f32 v91, v91
    v_mfma_f32_16x16x32_bf16 v[60:63], a[224:227], a[132:135], v[60:63]
    v_mfma_f32_16x16x32_bf16 v[52:55], a[224:227], a[108:111], v[52:55]
    v_cvt_pk_bf16_f32 v34, v80, v81
    v_mfma_f32_16x16x32_bf16 v[52:55], a[228:231], a[112:115], v[52:55]
    ds_read_b128 a[224:227], v1 offset:19456
    v_mfma_f32_16x16x32_bf16 v[52:55], a[232:235], a[116:119], v[52:55]
    ds_read_b128 a[228:231], v0 offset:20480
    v_mfma_f32_16x16x32_bf16 v[44:47], a[236:239], v[14:17], v[48:51]
    ds_read_b128 a[232:235], v1 offset:20480
    v_mfma_f32_16x16x32_bf16 v[44:47], a[240:243], v[20:23], v[44:47]
    s_add_u32 s21, s21, 12032
    v_mfma_f32_16x16x32_bf16 v[44:47], a[244:247], v[26:29], v[44:47]
    v_cvt_pk_bf16_f32 v41, v90, v91
    v_mfma_f32_16x16x32_bf16 v[44:47], a[248:251], v[32:35], v[44:47]
    s_nop 0
    v_mfma_f32_16x16x32_bf16 v[44:47], a[252:255], v[38:41], v[44:47]
    s_waitcnt lgkmcnt(3)
    v_mfma_f32_16x16x32_bf16 v[56:59], a[212:215], a[96:99], 0
    v_mfma_f32_16x16x32_bf16 v[56:59], a[216:219], a[100:103], v[56:59]
    v_mfma_f32_16x16x32_bf16 v[56:59], a[220:223], a[104:107], v[56:59]
    v_mfma_f32_16x16x32_bf16 v[64:67], a[220:223], a[128:131], 0
    v_mfma_f32_16x16x32_bf16 v[64:67], a[216:219], a[124:127], v[64:67]
    v_mfma_f32_16x16x32_bf16 v[64:67], a[212:215], a[120:123], v[64:67]
    s_nop 0
    v_cmp_lt_f32 vcc, s29, v44
    s_waitcnt vmcnt(7) lgkmcnt(0)
    v_mfma_f32_16x16x32_bf16 v[72:75], a[212:215], a[144:147], 0
    s_barrier
    v_mfma_f32_16x16x32_bf16 v[72:75], a[216:219], a[148:151], v[72:75]
    s_nop 0
    s_cbranch_vccnz L_rs_end5a
L_ret_end5a:
    v_mfma_f32_16x16x32_bf16 v[72:75], a[220:223], a[152:155], v[72:75]
    v_fma_f32 v55, v55, s28, v9
    v_mfma_f32_16x16x32_bf16 v[80:83], a[220:223], a[176:179], 0
    v_fma_f32 v52, v52, s28, v9
    v_fma_f32 v60, v60, s28, v10
    v_mfma_f32_16x16x32_bf16 v[80:83], a[216:219], a[172:175], v[80:83]
    v_fma_f32 v63, v63, s28, v10
    v_mfma_f32_16x16x32_bf16 v[80:83], a[212:215], a[168:171], v[80:83]
    v_fma_f32 v61, v61, s28, v10
    v_fma_f32 v53, v53, s28, v9
    v_mfma_f32_16x16x32_bf16 v[88:91], a[212:215], a[192:195], 0
    v_exp_f32 v52, v52
    v_mfma_f32_16x16x32_bf16 v[88:91], a[216:219], a[196:199], v[88:91]
    v_exp_f32 v55, v55
    v_mfma_f32_16x16x32_bf16 v[88:91], a[220:223], a[200:203], v[88:91]
    v_fma_f32 v54, v54, s28, v9
    v_mfma_f32_16x16x32_bf16 v[88:91], a[224:227], a[204:207], v[88:91]
    ds_read_b64_tr_b16 a[212:213], v2 offset:0
    v_mfma_f32_16x16x32_bf16 v[88:91], a[228:231], a[208:211], v[88:91]
    v_exp_f32 v54, v54
    v_mfma_f32_16x16x32_bf16 v[88:91], a[232:235], v[92:95], v[88:91]
    v_exp_f32 v53, v53
    v_mfma_f32_16x16x32_bf16 v[80:83], a[232:235], a[188:191], v[80:83]
    ds_read_b64_tr_b16 a[214:215], v2 offset:6144
    v_fma_f32 v62, v62, s28, v10
    v_mfma_f32_16x16x32_bf16 v[80:83], a[228:231], a[184:187], v[80:83]
    ds_read_b64_tr_b16 a[216:217], v3 offset:0
    v_cvt_pk_bf16_f32 v18, v52, v53
    v_mfma_f32_16x16x32_bf16 v[80:83], a[224:227], a[180:183], v[80:83]
    ds_read_b64_tr_b16 a[218:219], v3 offset:6144
    v_cvt_pk_bf16_f32 v19, v54, v55
    v_mfma_f32_16x16x32_bf16 v[72:75], a[224:227], a[156:159], v[72:75]
    v_exp_f32 v61, v61
    v_mfma_f32_16x16x32_bf16 v[72:75], a[228:231], a[160:163], v[72:75]
    v_exp_f32 v60, v60
    v_mfma_f32_16x16x32_bf16 v[72:75], a[232:235], a[164:167], v[72:75]
    v_exp_f32 v62, v62
    v_mfma_f32_16x16x32_bf16 v[64:67], a[232:235], a[140:143], v[64:67]
    ds_read_b64_tr_b16 a[220:221], v4 offset:0
    v_mfma_f32_16x16x32_bf16 v[64:67], a[228:231], a[136:139], v[64:67]
    ds_read_b64_tr_b16 a[222:223], v4 offset:6144
    v_cvt_pk_bf16_f32 v24, v60, v61
    v_mfma_f32_16x16x32_bf16 v[64:67], a[224:227], a[132:135], v[64:67]
    v_mfma_f32_16x16x32_bf16 v[56:59], a[224:227], a[108:111], v[56:59]
    v_exp_f32 v63, v63
    v_mfma_f32_16x16x32_bf16 v[56:59], a[228:231], a[112:115], v[56:59]
    ds_read_b64_tr_b16 a[224:225], v5 offset:0
    v_mfma_f32_16x16x32_bf16 v[56:59], a[232:235], a[116:119], v[56:59]
    ds_read_b64_tr_b16 a[226:227], v5 offset:6144
    v_cvt_pk_bf16_f32 v25, v62, v63
    s_waitcnt lgkmcnt(4)
    v_mfma_f32_16x16x32_bf16 v[112:115], a[212:215], v[14:17], v[112:115]
    s_nop 3
    v_fma_f32 v59, v59, s28, v9
    v_fma_f32 v84, v84, s28, v13
    v_mfma_f32_16x16x32_bf16 v[116:119], a[216:219], v[14:17], v[116:119]
    v_fma_f32 v91, v91, s28, v13
    v_fma_f32 v90, v90, s28, v13
    v_mfma_f32_16x16x32_bf16 v[164:167], a[216:219], v[20:23], v[164:167]
    s_add_u32 s39, s39, 12288
    v_fma_f32 v82, v82, s28, v12
    v_fma_f32 v70, v70, s28, v11
    v_mfma_f32_16x16x32_bf16 v[160:163], a[212:215], v[20:23], v[160:163]
    s_waitcnt vmcnt(0)
    v_fma_f32 v79, v79, s28, v12
    v_fma_f32 v83, v83, s28, v12
    v_mfma_f32_16x16x32_bf16 v[208:211], a[212:215], v[26:29], v[208:211]
    s_barrier
    v_mfma_f32_16x16x32_bf16 v[212:215], a[216:219], v[26:29], v[212:215]
    v_exp_f32 v79, v79
    v_mfma_f32_16x16x32_bf16 a[4:7], a[216:219], v[32:35], a[4:7]
    v_exp_f32 v82, v82
    v_mfma_f32_16x16x32_bf16 a[0:3], a[212:215], v[32:35], a[0:3]
    ds_read_b64_tr_b16 a[232:233], v3 offset:1024
    v_fma_f32 v78, v78, s28, v12
    v_mfma_f32_16x16x32_bf16 a[48:51], a[212:215], v[38:41], a[48:51]
    ds_read_b64_tr_b16 a[228:229], v2 offset:1024
    v_fma_f32 v75, v75, s28, v11
    v_mfma_f32_16x16x32_bf16 a[52:55], a[216:219], v[38:41], a[52:55]
    s_waitcnt lgkmcnt(2)
    ds_read_b64_tr_b16 a[230:231], v2 offset:7168
    v_fma_f32 v74, v74, s28, v11
    v_mfma_f32_16x16x32_bf16 a[56:59], a[220:223], v[38:41], a[56:59]
    ds_read_b64_tr_b16 a[234:235], v3 offset:7168
    v_fma_f32 v85, v85, s28, v13
    v_fma_f32 v72, v72, s28, v11
    v_mfma_f32_16x16x32_bf16 a[60:63], a[224:227], v[38:41], a[60:63]
    ds_read_b64_tr_b16 a[214:215], v4 offset:7168
    v_exp_f32 v78, v78
    v_mfma_f32_16x16x32_bf16 a[12:15], a[224:227], v[32:35], a[12:15]
    v_fma_f32 v73, v73, s28, v11
    v_fma_f32 v58, v58, s28, v9
    v_mfma_f32_16x16x32_bf16 a[8:11], a[220:223], v[32:35], a[8:11]
    v_fma_f32 v81, v81, s28, v12
    v_fma_f32 v56, v56, s28, v9
    v_mfma_f32_16x16x32_bf16 v[216:219], a[220:223], v[26:29], v[216:219]
    ds_read_b64_tr_b16 a[216:217], v5 offset:1024
    v_fma_f32 v88, v88, s28, v13
    v_mfma_f32_16x16x32_bf16 v[220:223], a[224:227], v[26:29], v[220:223]
    ds_read_b64_tr_b16 a[212:213], v4 offset:1024
    v_fma_f32 v68, v68, s28, v11
    v_mfma_f32_16x16x32_bf16 v[172:175], a[224:227], v[20:23], v[172:175]
    v_fma_f32 v65, v65, s28, v10
    v_fma_f32 v71, v71, s28, v11
    v_mfma_f32_16x16x32_bf16 v[168:171], a[220:223], v[20:23], v[168:171]
    v_exp_f32 v83, v83
    v_mfma_f32_16x16x32_bf16 v[120:123], a[220:223], v[14:17], v[120:123]
    ds_read_b64_tr_b16 a[220:221], v2 offset:2048
    v_fma_f32 v64, v64, s28, v10
    v_mfma_f32_16x16x32_bf16 v[124:127], a[224:227], v[14:17], v[124:127]
    s_waitcnt lgkmcnt(5)
    ds_read_b64_tr_b16 a[218:219], v5 offset:7168
    v_fma_f32 v69, v69, s28, v11
    v_mfma_f32_16x16x32_bf16 v[128:131], a[228:231], v[14:17], v[128:131]
    s_waitcnt lgkmcnt(5)
    ds_read_b64_tr_b16 a[222:223], v2 offset:8192
    v_fma_f32 v86, v86, s28, v13
    v_mfma_f32_16x16x32_bf16 v[132:135], a[232:235], v[14:17], v[132:135]
    v_exp_f32 v81, v81
    v_mfma_f32_16x16x32_bf16 v[180:183], a[232:235], v[20:23], v[180:183]
    v_exp_f32 v59, v59
    v_mfma_f32_16x16x32_bf16 v[176:179], a[228:231], v[20:23], v[176:179]
    v_exp_f32 v65, v65
    v_mfma_f32_16x16x32_bf16 v[224:227], a[228:231], v[26:29], v[224:227]
    ds_read_b64_tr_b16 a[224:225], v3 offset:2048
    v_fma_f32 v80, v80, s28, v12
    v_mfma_f32_16x16x32_bf16 v[228:231], a[232:235], v[26:29], v[228:231]
    v_exp_f32 v64, v64
    v_mfma_f32_16x16x32_bf16 a[20:23], a[232:235], v[32:35], a[20:23]
    v_fma_f32 v66, v66, s28, v10
    v_exp_f32 v91, v91
    v_mfma_f32_16x16x32_bf16 a[16:19], a[228:231], v[32:35], a[16:19]
    v_exp_f32 v68, v68
    v_mfma_f32_16x16x32_bf16 a[64:67], a[228:231], v[38:41], a[64:67]
    ds_read_b64_tr_b16 a[226:227], v3 offset:8192
    v_fma_f32 v67, v67, s28, v10
    v_mfma_f32_16x16x32_bf16 a[68:71], a[232:235], v[38:41], a[68:71]
    s_waitcnt lgkmcnt(3)
    ds_read_b64_tr_b16 a[232:233], v5 offset:2048
    v_fma_f32 v89, v89, s28, v13
    v_mfma_f32_16x16x32_bf16 a[72:75], a[212:215], v[38:41], a[72:75]
    v_exp_f32 v84, v84
    v_mfma_f32_16x16x32_bf16 a[76:79], a[216:219], v[38:41], a[76:79]
    v_exp_f32 v89, v89
    v_mfma_f32_16x16x32_bf16 a[28:31], a[216:219], v[32:35], a[28:31]
    ds_read_b64_tr_b16 a[234:235], v5 offset:8192
    v_fma_f32 v77, v77, s28, v12
    v_mfma_f32_16x16x32_bf16 a[24:27], a[212:215], v[32:35], a[24:27]
    v_exp_f32 v73, v73
    v_mfma_f32_16x16x32_bf16 v[232:235], a[212:215], v[26:29], v[232:235]
    v_fma_f32 v57, v57, s28, v9
    v_exp_f32 v88, v88
    v_mfma_f32_16x16x32_bf16 v[236:239], a[216:219], v[26:29], v[236:239]
    v_exp_f32 v66, v66
    v_mfma_f32_16x16x32_bf16 v[188:191], a[216:219], v[20:23], v[188:191]
    v_exp_f32 v85, v85
    v_mfma_f32_16x16x32_bf16 v[184:187], a[212:215], v[20:23], v[184:187]
    ds_read_b64_tr_b16 a[230:231], v4 offset:8192
    v_fma_f32 v76, v76, s28, v12
    v_mfma_f32_16x16x32_bf16 v[136:139], a[212:215], v[14:17], v[136:139]
    ds_read_b64_tr_b16 a[228:229], v4 offset:2048
    v_cvt_pk_bf16_f32 v42, v84, v85
    v_mfma_f32_16x16x32_bf16 v[140:143], a[216:219], v[14:17], v[140:143]
    s_waitcnt lgkmcnt(3)
    v_exp_f32 v74, v74
    v_mfma_f32_16x16x32_bf16 v[144:147], a[220:223], v[14:17], v[144:147]
    v_exp_f32 v77, v77
    v_mfma_f32_16x16x32_bf16 v[148:151], a[224:227], v[14:17], v[148:151]
    v_exp_f32 v71, v71
    v_mfma_f32_16x16x32_bf16 v[196:199], a[224:227], v[20:23], v[196:199]
    v_exp_f32 v80, v80
    v_mfma_f32_16x16x32_bf16 v[192:195], a[220:223], v[20:23], v[192:195]
    v_exp_f32 v90, v90
    v_mfma_f32_16x16x32_bf16 v[240:243], a[220:223], v[26:29], v[240:243]
    ds_read_b64_tr_b16 a[212:213], v2 offset:18432
    v_fma_f32 v87, v87, s28, v13
    v_mfma_f32_16x16x32_bf16 v[244:247], a[224:227], v[26:29], v[244:247]
    v_exp_f32 v72, v72
    v_mfma_f32_16x16x32_bf16 a[36:39], a[224:227], v[32:35], a[36:39]
    v_exp_f32 v56, v56
    v_mfma_f32_16x16x32_bf16 a[32:35], a[220:223], v[32:35], a[32:35]
    v_exp_f32 v76, v76
    v_mfma_f32_16x16x32_bf16 a[80:83], a[220:223], v[38:41], a[80:83]
    v_exp_f32 v87, v87
    v_cvt_pk_bf16_f32 v37, v78, v79
    v_mfma_f32_16x16x32_bf16 a[84:87], a[224:227], v[38:41], a[84:87]
    s_waitcnt lgkmcnt(1)
    ds_read_b64_tr_b16 a[214:215], v2 offset:12288
    v_exp_f32 v70, v70
    v_mfma_f32_16x16x32_bf16 a[88:91], a[228:231], v[38:41], a[88:91]
    v_exp_f32 v86, v86
    v_mfma_f32_16x16x32_bf16 a[92:95], a[232:235], v[38:41], a[92:95]
    v_exp_f32 v75, v75
    v_mfma_f32_16x16x32_bf16 a[44:47], a[232:235], v[32:35], a[44:47]
    v_exp_f32 v69, v69
    v_mfma_f32_16x16x32_bf16 a[40:43], a[228:231], v[32:35], a[40:43]
    v_exp_f32 v57, v57
    v_cvt_pk_bf16_f32 v35, v82, v83
    v_mfma_f32_16x16x32_bf16 v[248:251], a[228:231], v[26:29], v[248:251]
    ds_read_b64_tr_b16 a[216:217], v3 offset:18432
    v_exp_f32 v58, v58
    v_mfma_f32_16x16x32_bf16 v[252:255], a[232:235], v[26:29], v[252:255]
    ds_read_b64_tr_b16 a[218:219], v3 offset:12288
    v_cvt_pk_bf16_f32 v34, v80, v81
    v_mfma_f32_16x16x32_bf16 v[204:207], a[232:235], v[20:23], v[204:207]
    v_exp_f32 v67, v67
    v_mfma_f32_16x16x32_bf16 v[200:203], a[228:231], v[20:23], v[200:203]
    v_cvt_pk_bf16_f32 v31, v70, v71
    v_cvt_pk_bf16_f32 v30, v68, v69
    v_mfma_f32_16x16x32_bf16 v[152:155], a[228:231], v[14:17], v[152:155]
    v_cvt_pk_bf16_f32 v28, v72, v73
    v_cvt_pk_bf16_f32 v23, v66, v67
    v_mfma_f32_16x16x32_bf16 v[156:159], a[232:235], v[14:17], v[156:159]
    ds_read_b64_tr_b16 a[220:221], v4 offset:18432
    v_cvt_pk_bf16_f32 v16, v56, v57
    v_cvt_pk_bf16_f32 v17, v58, v59
    v_cvt_pk_bf16_f32 v43, v86, v87
    v_cvt_pk_bf16_f32 v22, v64, v65
    v_mfma_f32_16x16x32_bf16 v[48:51], a[236:239], v[16:19], v[44:47]
    v_cvt_pk_bf16_f32 v36, v76, v77
    v_cvt_pk_bf16_f32 v29, v74, v75
    v_mfma_f32_16x16x32_bf16 v[48:51], a[240:243], v[22:25], v[48:51]
    ds_read_b64_tr_b16 a[222:223], v4 offset:12288
    v_cvt_pk_bf16_f32 v41, v90, v91
    v_mfma_f32_16x16x32_bf16 v[48:51], a[244:247], v[28:31], v[48:51]
    ds_read_b64_tr_b16 a[224:225], v5 offset:18432
    v_cvt_pk_bf16_f32 v40, v88, v89
    v_mfma_f32_16x16x32_bf16 v[48:51], a[248:251], v[34:37], v[48:51]
    ds_read_b64_tr_b16 a[226:227], v5 offset:12288
    v_mfma_f32_16x16x32_bf16 v[48:51], a[252:255], v[40:43], v[48:51]
    s_nop 7
    v_cmp_lt_f32 vcc, s29, v48
    s_nop 4
    s_cbranch_vccnz L_rs_end5b
L_ret_end5b:
    s_waitcnt lgkmcnt(4)
    v_mfma_f32_16x16x32_bf16 v[112:115], a[212:215], v[16:19], v[112:115]
    v_mfma_f32_16x16x32_bf16 v[116:119], a[216:219], v[16:19], v[116:119]
    s_add_u32 s84, s34, 0
    v_mbcnt_lo_u32_b32 v104, -1, 0
    v_mbcnt_hi_u32_b32 v104, -1, v104
    v_mfma_f32_16x16x32_bf16 v[164:167], a[216:219], v[22:25], v[164:167]
    ds_read_b64_tr_b16 a[232:233], v3 offset:19456
    v_lshrrev_b32 v106, 5, v104
    v_mfma_f32_16x16x32_bf16 v[160:163], a[212:215], v[22:25], v[160:163]
    ds_read_b64_tr_b16 a[234:235], v3 offset:13312
    v_bfe_u32 v105, v104, 3, 1
    v_mfma_f32_16x16x32_bf16 v[208:211], a[212:215], v[28:31], v[208:211]
    v_rcp_f32 v50, v50
    v_mfma_f32_16x16x32_bf16 v[212:215], a[216:219], v[28:31], v[212:215]
    v_rcp_f32 v49, v49
    v_mfma_f32_16x16x32_bf16 a[4:7], a[216:219], v[34:37], a[4:7]
    v_rcp_f32 v51, v51
    v_mfma_f32_16x16x32_bf16 a[0:3], a[212:215], v[34:37], a[0:3]
    ds_read_b64_tr_b16 a[228:229], v2 offset:19456
    v_mul_f32 v162, v162, v49
    v_mfma_f32_16x16x32_bf16 a[48:51], a[212:215], v[40:43], a[48:51]
    ds_read_b64_tr_b16 a[230:231], v2 offset:13312
    v_xor_b32 v106, v106, v105
    v_mfma_f32_16x16x32_bf16 a[52:55], a[216:219], v[40:43], a[52:55]
    s_waitcnt lgkmcnt(4)
    ds_read_b64_tr_b16 a[214:215], v4 offset:13312
    v_xor_b32 v105, s65, v105
    v_mfma_f32_16x16x32_bf16 a[56:59], a[220:223], v[40:43], a[56:59]
    v_mul_f32 v167, v167, v49
    v_and_b32 v107, 3, v104
    v_mfma_f32_16x16x32_bf16 a[60:63], a[224:227], v[40:43], a[60:63]
    ds_read_b64_tr_b16 a[216:217], v5 offset:19456
    v_mfma_f32_16x16x32_bf16 a[12:15], a[224:227], v[34:37], a[12:15]
    s_add_u32 s85, s34, 6144
    v_mul_f32 v160, v160, v49
    v_mul_f32 v161, v161, v49
    v_mfma_f32_16x16x32_bf16 a[8:11], a[220:223], v[34:37], a[8:11]
    ds_read_b64_tr_b16 a[218:219], v5 offset:13312
    v_mul_f32 v166, v166, v49
    v_mfma_f32_16x16x32_bf16 v[216:219], a[220:223], v[28:31], v[216:219]
    v_accvgpr_read_b32 v108, a4
    v_mov_b32 v100, v48
    v_mfma_f32_16x16x32_bf16 v[220:223], a[224:227], v[28:31], v[220:223]
    v_lshl_add_u32 v101, v105, 10, s38
    v_mul_f32 v165, v165, v49
    v_mfma_f32_16x16x32_bf16 v[172:175], a[224:227], v[22:25], v[172:175]
    v_accvgpr_read_b32 v53, a9
    v_lshl_or_b32 v106, v107, 1, v106
    v_mfma_f32_16x16x32_bf16 v[168:171], a[220:223], v[22:25], v[168:171]
    v_mfma_f32_16x16x32_bf16 v[120:123], a[220:223], v[16:19], v[120:123]
    v_lshl_add_u32 v101, v106, 4, v101
    v_accvgpr_read_b32 v56, a12
    v_mfma_f32_16x16x32_bf16 v[124:127], a[224:227], v[16:19], v[124:127]
    s_waitcnt lgkmcnt(2)
    ds_read_b64_tr_b16 a[220:221], v2 offset:20480
    v_mul_f32 v174, v174, v49
    v_mfma_f32_16x16x32_bf16 v[128:131], a[228:231], v[16:19], v[128:131]
    ds_read_b64_tr_b16 a[212:213], v4 offset:19456
    v_mul_f32 v108, v108, v51
    v_mfma_f32_16x16x32_bf16 v[132:135], a[232:235], v[16:19], v[132:135]
    v_permlane32_swap_b32 v48, v100
    v_mfma_f32_16x16x32_bf16 v[180:183], a[232:235], v[22:25], v[180:183]
    s_add_u32 s86, s34, 12288
    v_mul_f32 v172, v172, v49
    v_and_b32 v107, 7, v104
    v_mfma_f32_16x16x32_bf16 v[176:179], a[228:231], v[22:25], v[176:179]
    v_subrev_u32 v8, 28672, v8
    v_mul_f32 v169, v169, v49
    v_mfma_f32_16x16x32_bf16 v[224:227], a[228:231], v[28:31], v[224:227]
    ds_read_b64_tr_b16 a[222:223], v2 offset:14336
    v_mul_f32 v173, v173, v49
    v_mfma_f32_16x16x32_bf16 v[228:231], a[232:235], v[28:31], v[228:231]
    ds_read_b64_tr_b16 a[226:227], v3 offset:14336
    v_accvgpr_read_b32 v58, a14
    v_mfma_f32_16x16x32_bf16 a[20:23], a[232:235], v[34:37], a[20:23]
    s_add_u32 s87, s34, 18432
    v_mul_f32 v56, v56, v51
    v_mul_f32 v168, v168, v49
    v_mfma_f32_16x16x32_bf16 a[16:19], a[228:231], v[34:37], a[16:19]
    ds_read_b64_tr_b16 a[224:225], v3 offset:20480
    v_accvgpr_read_b32 v57, a13
    v_mfma_f32_16x16x32_bf16 a[64:67], a[228:231], v[40:43], a[64:67]
    s_add_u32 s88, s34, 24576
    v_rcp_f32 v48, v48
    v_cvt_pk_bf16_f32 v168, v168, v169
    v_mul_f32 v164, v164, v49
    v_cvt_pk_bf16_f32 v160, v160, v161
    v_pk_mul_f32 v[208:209], v[208:209], v[50:51] op_sel_hi:[1,0]
    v_pk_mul_f32 v[118:119], v[118:119], v[48:49] op_sel_hi:[1,0]
    v_pk_mul_f32 v[124:125], v[124:125], v[48:49] op_sel_hi:[1,0]
    v_pk_mul_f32 v[218:219], v[218:219], v[50:51] op_sel_hi:[1,0]
    v_pk_mul_f32 v[120:121], v[120:121], v[48:49] op_sel_hi:[1,0]
    v_pk_mul_f32 v[222:223], v[222:223], v[50:51] op_sel_hi:[1,0]
    v_pk_mul_f32 v[114:115], v[114:115], v[48:49] op_sel_hi:[1,0]
    v_pk_mul_f32 v[116:117], v[116:117], v[48:49] op_sel_hi:[1,0]
    v_pk_mul_f32 v[112:113], v[112:113], v[48:49] op_sel_hi:[1,0]
    v_pk_mul_f32 v[126:127], v[126:127], v[48:49] op_sel_hi:[1,0]
    v_pk_mul_f32 v[122:123], v[122:123], v[48:49] op_sel_hi:[1,0]
    v_lshl_add_u32 v101, v107, 7, v101
    v_bfe_u32 v107, v104, 4, 1
    v_mfma_f32_16x16x32_bf16 a[68:71], a[232:235], v[40:43], a[68:71]
    s_waitcnt lgkmcnt(3)
    ds_read_b64_tr_b16 a[228:229], v4 offset:20480
    v_lshl_add_u32 v101, v107, 3, v101
    v_mfma_f32_16x16x32_bf16 a[72:75], a[212:215], v[40:43], a[72:75]
    ds_read_b64_tr_b16 a[234:235], v5 offset:14336
    v_accvgpr_read_b32 v54, a10
    v_mfma_f32_16x16x32_bf16 a[76:79], a[216:219], v[40:43], a[76:79]
    ds_read_b64_tr_b16 a[232:233], v5 offset:20480
    v_mul_f32 v170, v170, v49
    v_mfma_f32_16x16x32_bf16 a[28:31], a[216:219], v[34:37], a[28:31]
    v_mul_f32 v163, v163, v49
    v_mov_b32 v104, v100
    v_mfma_f32_16x16x32_bf16 a[24:27], a[212:215], v[34:37], a[24:27]
    v_cvt_pk_bf16_f32 v116, v116, v117
    v_accvgpr_read_b32 v106, a2
    v_mfma_f32_16x16x32_bf16 v[232:235], a[212:215], v[28:31], v[232:235]
    v_cvt_pk_bf16_f32 v124, v124, v125
    v_cvt_pk_bf16_f32 v172, v172, v173
    v_mfma_f32_16x16x32_bf16 v[236:239], a[216:219], v[28:31], v[236:239]
    v_cvt_pk_bf16_f32 v120, v120, v121
    v_accvgpr_read_b32 v55, a11
    v_mfma_f32_16x16x32_bf16 v[188:191], a[216:219], v[22:25], v[188:191]
    v_cvt_pk_bf16_f32 v121, v122, v123
    v_cvt_pk_bf16_f32 v112, v112, v113
    v_mfma_f32_16x16x32_bf16 v[184:187], a[212:215], v[22:25], v[184:187]
    v_mul_f32 v175, v175, v49
    v_cvt_pk_bf16_f32 v164, v164, v165
    v_mfma_f32_16x16x32_bf16 v[136:139], a[212:215], v[16:19], v[136:139]
    s_add_u32 s18, s34, 30720
    v_accvgpr_read_b32 v105, a1
    v_xor_b32 v94, 96, v101
    v_mfma_f32_16x16x32_bf16 v[140:143], a[216:219], v[16:19], v[140:143]
    s_waitcnt lgkmcnt(2)
    ds_read_b64_tr_b16 a[230:231], v4 offset:14336
    v_xor_b32 v92, 32, v101
    v_mfma_f32_16x16x32_bf16 v[144:147], a[220:223], v[16:19], v[144:147]
    v_cvt_pk_bf16_f32 v165, v166, v167
    v_cvt_pk_bf16_f32 v161, v162, v163
    v_mfma_f32_16x16x32_bf16 v[148:151], a[224:227], v[16:19], v[148:151]
    v_cvt_pk_bf16_f32 v125, v126, v127
    v_mul_f32 v171, v171, v49
    v_mfma_f32_16x16x32_bf16 v[196:199], a[224:227], v[22:25], v[196:199]
    v_xor_b32 v93, 64, v101
    v_cvt_pk_bf16_f32 v113, v114, v115
    v_mfma_f32_16x16x32_bf16 v[192:195], a[220:223], v[22:25], v[192:195]
    v_cvt_pk_bf16_f32 v173, v174, v175
    v_cvt_pk_bf16_f32 v117, v118, v119
    v_mfma_f32_16x16x32_bf16 v[240:243], a[220:223], v[28:31], v[240:243]
    ds_write2st64_b64 v101, v[112:113], v[160:161] offset0:0 offset1:12
    v_mfma_f32_16x16x32_bf16 v[244:247], a[224:227], v[28:31], v[244:247]
    v_cvt_pk_bf16_f32 v169, v170, v171
    v_accvgpr_read_b32 v109, a5
    v_mfma_f32_16x16x32_bf16 a[36:39], a[224:227], v[34:37], a[36:39]
    v_mul_f32 v190, v190, v49
    v_accvgpr_read_b32 v107, a3
    v_mfma_f32_16x16x32_bf16 a[32:35], a[220:223], v[34:37], a[32:35]
    ds_write2st64_b64 v92, v[116:117], v[164:165] offset0:0 offset1:12
    v_mfma_f32_16x16x32_bf16 a[80:83], a[220:223], v[40:43], a[80:83]
    ds_write2st64_b64 v93, v[120:121], v[168:169] offset0:0 offset1:12
    v_mfma_f32_16x16x32_bf16 a[84:87], a[224:227], v[40:43], a[84:87]
    s_waitcnt lgkmcnt(3)
    ds_write2st64_b64 v94, v[124:125], v[172:173] offset0:0 offset1:12
    v_mfma_f32_16x16x32_bf16 a[88:91], a[228:231], v[40:43], a[88:91]
    ds_read_b128 v[76:79], v8 offset:0
    v_mul_f32 v54, v54, v51
    v_mfma_f32_16x16x32_bf16 a[92:95], a[232:235], v[40:43], a[92:95]
    ds_read_b128 v[80:83], v8 offset:1024
    v_accvgpr_read_b32 v52, a8
    v_permlane16_swap_b32 v100, v104
    v_accvgpr_read_b32 v111, a7
    v_mul_f32 v107, v107, v51
    v_pk_mul_f32 v[216:217], v[216:217], v[50:51] op_sel_hi:[1,0]
    v_pk_mul_f32 v[212:213], v[212:213], v[50:51] op_sel_hi:[1,0]
    v_mul_f32 v106, v106, v51
    v_mul_f32 v191, v191, v49
    v_pk_mul_f32 v[140:141], v[140:141], v[48:49] op_sel_hi:[1,0]
    v_mul_f32 v53, v53, v51
    v_mul_f32 v55, v55, v51
    v_mul_f32 v105, v105, v51
    v_mfma_f32_16x16x32_bf16 a[44:47], a[232:235], v[34:37], a[44:47]
    v_mul_f32 v187, v187, v49
    v_mul_f32 v186, v186, v49
    v_mfma_f32_16x16x32_bf16 a[40:43], a[228:231], v[34:37], a[40:43]
    v_accvgpr_read_b32 v59, a15
    v_cvt_pk_bf16_f32 v208, v208, v209
    v_cvt_pk_bf16_f32 v212, v212, v213
    v_accvgpr_read_b32 v104, a0
    v_mfma_f32_16x16x32_bf16 v[248:251], a[228:231], v[28:31], v[248:251]
    ds_read_b128 v[84:87], v8 offset:6144
    v_accvgpr_read_b32 v110, a6
    v_mul_f32 v109, v109, v51
    v_mfma_f32_16x16x32_bf16 v[252:255], a[232:235], v[28:31], v[252:255]
    v_mul_f32 v182, v182, v49
    v_mul_f32 v58, v58, v51
    s_waitcnt lgkmcnt(2)
    buffer_store_dwordx4 v[76:79], v102, s[16:19], s84 offen offset:0 nt
    v_mul_f32 v104, v104, v51
    v_mul_f32 v110, v110, v51
    v_pk_mul_f32 v[136:137], v[136:137], v[48:49] op_sel_hi:[1,0]
    v_cvt_pk_bf16_f32 v104, v104, v105
    v_cvt_pk_bf16_f32 v216, v216, v217
    v_pk_mul_f32 v[252:253], v[252:253], v[50:51] op_sel_hi:[1,0]
    v_mul_f32 v52, v52, v51
    v_pk_mul_f32 v[210:211], v[210:211], v[50:51] op_sel_hi:[1,0]
    v_cvt_pk_bf16_f32 v105, v106, v107
    v_pk_mul_f32 v[148:149], v[148:149], v[48:49] op_sel_hi:[1,0]
    v_pk_mul_f32 v[214:215], v[214:215], v[50:51] op_sel_hi:[1,0]
    v_mul_f32 v184, v184, v49
    v_cvt_pk_bf16_f32 v209, v210, v211
    v_pk_mul_f32 v[220:221], v[220:221], v[50:51] op_sel_hi:[1,0]
    v_cvt_pk_bf16_f32 v108, v108, v109
    v_rcp_f32 v100, v100
    v_cvt_pk_bf16_f32 v52, v52, v53
    v_mul_f32 v57, v57, v51
    v_mul_f32 v111, v111, v51
    v_mfma_f32_16x16x32_bf16 v[204:207], a[232:235], v[22:25], v[204:207]
    ds_read_b128 v[88:91], v8 offset:7168
    v_cvt_pk_bf16_f32 v56, v56, v57
    v_accvgpr_read_b32 v107, a51
    v_mul_f32 v178, v178, v49
    v_cvt_pk_bf16_f32 v140, v140, v141
    v_cvt_pk_bf16_f32 v213, v214, v215
    v_mfma_f32_16x16x32_bf16 v[200:203], a[228:231], v[22:25], v[200:203]
    s_waitcnt lgkmcnt(1)
    buffer_store_dwordx4 v[80:83], v103, s[16:19], s84 offen offset:0 nt
    ds_write2st64_b64 v101, v[208:209], v[104:105] offset0:24 offset1:36
    v_cvt_pk_bf16_f32 v109, v110, v111
    v_accvgpr_read_b32 v110, a54
    v_mfma_f32_16x16x32_bf16 v[152:155], a[228:231], v[16:19], v[152:155]
    ds_write2st64_b64 v92, v[212:213], v[108:109] offset0:24 offset1:36
    v_mul_f32 v59, v59, v51
    v_mul_f32 v192, v192, v49
    v_pk_mul_f32 v[142:143], v[142:143], v[48:49] op_sel_hi:[1,0]
    v_pk_mul_f32 v[128:129], v[128:129], v[48:49] op_sel_hi:[1,0]
    v_cvt_pk_bf16_f32 v53, v54, v55
    v_mul_f32 v201, v201, v49
    v_accvgpr_read_b32 v104, a48
    v_pk_mul_f32 v[134:135], v[134:135], v[48:49] op_sel_hi:[1,0]
    v_accvgpr_read_b32 v105, a49
    v_cvt_pk_bf16_f32 v220, v220, v221
    v_accvgpr_read_b32 v111, a55
    v_mul_f32 v183, v183, v49
    v_cvt_pk_bf16_f32 v217, v218, v219
    v_mfma_f32_16x16x32_bf16 v[156:159], a[232:235], v[16:19], v[156:159]
    buffer_store_dwordx4 v[84:87], v102, s[16:19], s85 offen offset:0 nt
    v_mul_f32 v177, v177, v49
    v_pk_mul_f32 v[104:105], v[104:105], v[100:101] op_sel_hi:[1,0]
    v_mul_f32 v204, v204, v49
    v_pk_mul_f32 v[130:131], v[130:131], v[48:49] op_sel_hi:[1,0]
    v_pk_mul_f32 v[226:227], v[226:227], v[50:51] op_sel_hi:[1,0]
    v_cvt_pk_bf16_f32 v221, v222, v223
    v_mul_f32 v189, v189, v49
    ds_write2st64_b64 v93, v[216:217], v[52:53] offset0:24 offset1:36
    v_cvt_pk_bf16_f32 v57, v58, v59
    v_accvgpr_read_b32 v108, a52
    v_accvgpr_read_b32 v109, a53
    ds_write2st64_b64 v94, v[220:221], v[56:57] offset0:24 offset1:36
    ds_read_b128 v[60:63], v8 offset:12288
    v_accvgpr_read_b32 v55, a59
    v_mul_f32 v185, v185, v49
    s_waitcnt lgkmcnt(3)
    buffer_store_dwordx4 v[88:91], v103, s[16:19], s85 offen offset:0 nt
    v_accvgpr_read_b32 v54, a58
    v_accvgpr_read_b32 v56, a60
    v_mul_f32 v188, v188, v49
    v_pk_mul_f32 v[236:237], v[236:237], v[50:51] op_sel_hi:[1,0]
    v_pk_mul_f32 v[144:145], v[144:145], v[48:49] op_sel_hi:[1,0]
    v_accvgpr_read_b32 v57, a61
    v_mul_f32 v180, v180, v49
    v_pk_mul_f32 v[232:233], v[232:233], v[50:51] op_sel_hi:[1,0]
    v_cvt_pk_bf16_f32 v184, v184, v185
    v_accvgpr_read_b32 v106, a50
    v_pk_mul_f32 v[108:109], v[108:109], v[100:101] op_sel_hi:[1,0]
    v_cvt_pk_bf16_f32 v185, v186, v187
    v_pk_mul_f32 v[106:107], v[106:107], v[100:101] op_sel_hi:[1,0]
    ds_read_b128 v[64:67], v8 offset:13312
    v_cvt_pk_bf16_f32 v144, v144, v145
    v_accvgpr_read_b32 v52, a56
    v_pk_mul_f32 v[138:139], v[138:139], v[48:49] op_sel_hi:[1,0]
    s_waitcnt lgkmcnt(1)
    buffer_store_dwordx4 v[60:63], v102, s[16:19], s86 offen offset:0 nt
    v_accvgpr_read_b32 v53, a57
    v_cvt_pk_bf16_f32 v104, v104, v105
    v_pk_mul_f32 v[52:53], v[52:53], v[100:101] op_sel_hi:[1,0]
    v_pk_mul_f32 v[228:229], v[228:229], v[50:51] op_sel_hi:[1,0]
    v_pk_mul_f32 v[244:245], v[244:245], v[50:51] op_sel_hi:[1,0]
    v_pk_mul_f32 v[110:111], v[110:111], v[100:101] op_sel_hi:[1,0]
    v_pk_mul_f32 v[156:157], v[156:157], v[48:49] op_sel_hi:[1,0]
    ds_read_b128 v[68:71], v8 offset:18432
    ds_read_b128 v[72:75], v8 offset:19456
    v_cvt_pk_bf16_f32 v105, v106, v107
    v_pk_mul_f32 v[56:57], v[56:57], v[100:101] op_sel_hi:[1,0]
    v_pk_mul_f32 v[54:55], v[54:55], v[100:101] op_sel_hi:[1,0]
    v_cvt_pk_bf16_f32 v52, v52, v53
    v_mul_f32 v176, v176, v49
    v_accvgpr_read_b32 v59, a63
    v_cvt_pk_bf16_f32 v148, v148, v149
    v_pk_mul_f32 v[224:225], v[224:225], v[50:51] op_sel_hi:[1,0]
    v_accvgpr_read_b32 v58, a62
    v_pk_mul_f32 v[58:59], v[58:59], v[100:101] op_sel_hi:[1,0]
    ds_write_b64 v101, v[104:105] offset:24576
    v_pk_mul_f32 v[246:247], v[246:247], v[50:51] op_sel_hi:[1,0]
    s_waitcnt lgkmcnt(3)
    buffer_store_dwordx4 v[64:67], v103, s[16:19], s86 offen offset:0 nt
    v_cvt_pk_bf16_f32 v108, v108, v109
    v_cvt_pk_bf16_f32 v228, v228, v229
    v_cvt_pk_bf16_f32 v232, v232, v233
    v_pk_mul_f32 v[132:133], v[132:133], v[48:49] op_sel_hi:[1,0]
    v_cvt_pk_bf16_f32 v56, v56, v57
    v_cvt_pk_bf16_f32 v53, v54, v55
    v_mul_f32 v181, v181, v49
    v_cvt_pk_bf16_f32 v224, v224, v225
    v_accvgpr_read_b32 v107, a19
    v_cvt_pk_bf16_f32 v180, v180, v181
    v_cvt_pk_bf16_f32 v109, v110, v111
    v_cvt_pk_bf16_f32 v128, v128, v129
    v_cvt_pk_bf16_f32 v132, v132, v133
    v_cvt_pk_bf16_f32 v57, v58, v59
    v_pk_mul_f32 v[230:231], v[230:231], v[50:51] op_sel_hi:[1,0]
    ds_write_b64 v92, v[108:109] offset:24576
    v_accvgpr_read_b32 v59, a31
    v_mul_f32 v59, v59, v51
    v_accvgpr_read_b32 v54, a26
    v_mul_f32 v207, v207, v49
    v_cvt_pk_bf16_f32 v141, v142, v143
    v_mul_f32 v179, v179, v49
    v_cvt_pk_bf16_f32 v176, v176, v177
    s_waitcnt lgkmcnt(1)
    buffer_store_dwordx4 v[68:71], v102, s[16:19], s87 offen offset:0 nt
    ds_write_b64 v93, v[52:53] offset:24576
    ds_write_b64 v94, v[56:57] offset:24576
    v_accvgpr_read_b32 v58, a30
    v_accvgpr_read_b32 v57, a29
    v_accvgpr_read_b32 v55, a27
    ds_read_b128 v[76:79], v8 offset:24576
    v_pk_mul_f32 v[238:239], v[238:239], v[50:51] op_sel_hi:[1,0]
    v_accvgpr_read_b32 v110, a22
    v_accvgpr_read_b32 v56, a28
    v_cvt_pk_bf16_f32 v129, v130, v131
    v_accvgpr_read_b32 v111, a23
    v_mul_f32 v196, v196, v49
    v_mul_f32 v57, v57, v51
    v_mul_f32 v56, v56, v51
    v_cvt_pk_bf16_f32 v177, v178, v179
    v_cvt_pk_bf16_f32 v133, v134, v135
    v_accvgpr_read_b32 v108, a20
    v_accvgpr_read_b32 v106, a18
    v_cvt_pk_bf16_f32 v136, v136, v137
    v_mul_f32 v107, v107, v51
    v_mul_f32 v108, v108, v51
    v_accvgpr_read_b32 v109, a21
    v_cvt_pk_bf16_f32 v236, v236, v237
    buffer_store_dwordx4 v[72:75], v103, s[16:19], s87 offen offset:0 nt
    v_mul_f32 v55, v55, v51
    v_mul_f32 v205, v205, v49
    v_accvgpr_read_b32 v104, a16
    v_mul_f32 v104, v104, v51
    ds_read_b128 v[80:83], v8 offset:25600
    v_cvt_pk_bf16_f32 v188, v188, v189
    v_pk_mul_f32 v[248:249], v[248:249], v[50:51] op_sel_hi:[1,0]
    v_cvt_pk_bf16_f32 v56, v56, v57
    v_mul_f32 v54, v54, v51
    v_pk_mul_f32 v[234:235], v[234:235], v[50:51] op_sel_hi:[1,0]
    v_accvgpr_read_b32 v52, a24
    v_cvt_pk_bf16_f32 v181, v182, v183
    v_mul_f32 v198, v198, v49
    ds_write2st64_b64 v101, v[128:129], v[176:177] offset0:4 offset1:16
    v_cvt_pk_bf16_f32 v237, v238, v239
    v_mul_f32 v110, v110, v51
    v_mul_f32 v111, v111, v51
    v_mul_f32 v109, v109, v51
    v_accvgpr_read_b32 v105, a17
    v_cvt_pk_bf16_f32 v225, v226, v227
    s_waitcnt lgkmcnt(2)
    buffer_store_dwordx4 v[76:79], v102, s[16:19], s88 offen offset:0 nt
    v_pk_mul_f32 v[250:251], v[250:251], v[50:51] op_sel_hi:[1,0]
    v_cvt_pk_bf16_f32 v137, v138, v139
    v_cvt_pk_bf16_f32 v189, v190, v191
    v_accvgpr_read_b32 v53, a25
    v_cvt_pk_bf16_f32 v244, v244, v245
    v_mul_f32 v200, v200, v49
    ds_write2st64_b64 v92, v[132:133], v[180:181] offset0:4 offset1:16
    ds_write2st64_b64 v93, v[136:137], v[184:185] offset0:4 offset1:16
    ds_write2st64_b64 v94, v[140:141], v[188:189] offset0:4 offset1:16
    ds_read_b128 v[84:87], v8 offset:2048
    v_mul_f32 v197, v197, v49
    v_cvt_pk_bf16_f32 v108, v108, v109
    v_mul_f32 v52, v52, v51
    s_waitcnt lgkmcnt(4)
    buffer_store_dwordx4 v[80:83], v103, s[16:19], s88 offen offset:0 nt
    v_cvt_pk_bf16_f32 v229, v230, v231
    v_mul_f32 v105, v105, v51
    v_pk_mul_f32 v[154:155], v[154:155], v[48:49] op_sel_hi:[1,0]
    v_mul_f32 v53, v53, v51
    v_cvt_pk_bf16_f32 v233, v234, v235
    v_mul_f32 v106, v106, v51
    v_cvt_pk_bf16_f32 v52, v52, v53
    ds_read_b128 v[88:91], v8 offset:3072
    v_mul_f32 v199, v199, v49
    v_cvt_pk_bf16_f32 v104, v104, v105
    ds_read_b128 v[60:63], v8 offset:8192
    v_cvt_pk_bf16_f32 v105, v106, v107
    v_mul_f32 v206, v206, v49
    v_accvgpr_read_b32 v107, a67
    v_cvt_pk_bf16_f32 v109, v110, v111
    s_waitcnt lgkmcnt(2)
    buffer_store_dwordx4 v[84:87], v102, s[16:19], s84 offen offset:128 nt
    v_accvgpr_read_b32 v106, a66
    ds_read_b128 v[64:67], v8 offset:9216
    v_mul_f32 v202, v202, v49
    v_cvt_pk_bf16_f32 v53, v54, v55
    ds_write2st64_b64 v101, v[224:225], v[104:105] offset0:28 offset1:40
    v_accvgpr_read_b32 v105, a65
    ds_write2st64_b64 v92, v[228:229], v[108:109] offset0:28 offset1:40
    v_mul_f32 v58, v58, v51
    v_cvt_pk_bf16_f32 v252, v252, v253
    s_waitcnt lgkmcnt(3)
    buffer_store_dwordx4 v[88:91], v103, s[16:19], s84 offen offset:128 nt
    v_accvgpr_read_b32 v110, a70
    v_cvt_pk_bf16_f32 v57, v58, v59
    v_accvgpr_read_b32 v54, a74
    v_accvgpr_read_b32 v109, a69
    v_accvgpr_read_b32 v55, a75
    ds_write2st64_b64 v93, v[232:233], v[52:53] offset0:28 offset1:40
    v_mul_f32 v193, v193, v49
    v_accvgpr_read_b32 v108, a68
    v_accvgpr_read_b32 v58, a78
    v_cvt_pk_bf16_f32 v200, v200, v201
    ds_write2st64_b64 v94, v[236:237], v[56:57] offset0:28 offset1:40
    v_accvgpr_read_b32 v56, a76
    v_pk_mul_f32 v[152:153], v[152:153], v[48:49] op_sel_hi:[1,0]
    v_pk_mul_f32 v[146:147], v[146:147], v[48:49] op_sel_hi:[1,0]
    v_pk_mul_f32 v[108:109], v[108:109], v[100:101] op_sel_hi:[1,0]
    v_mul_f32 v195, v195, v49
    v_accvgpr_read_b32 v52, a72
    buffer_store_dwordx4 v[60:63], v102, s[16:19], s85 offen offset:128 nt
    ds_read_b128 v[68:71], v8 offset:14336
    v_pk_mul_f32 v[254:255], v[254:255], v[50:51] op_sel_hi:[1,0]
    ds_read_b128 v[72:75], v8 offset:15360
    v_cvt_pk_bf16_f32 v204, v204, v205
    v_accvgpr_read_b32 v111, a71
    v_pk_mul_f32 v[158:159], v[158:159], v[48:49] op_sel_hi:[1,0]
    v_accvgpr_read_b32 v104, a64
    v_cvt_pk_bf16_f32 v145, v146, v147
    v_accvgpr_read_b32 v59, a79
    v_cvt_pk_bf16_f32 v248, v248, v249
    ds_read_b128 v[76:79], v8 offset:20480
    v_pk_mul_f32 v[104:105], v[104:105], v[100:101] op_sel_hi:[1,0]
    v_cvt_pk_bf16_f32 v156, v156, v157
    v_accvgpr_read_b32 v57, a77
    v_cvt_pk_bf16_f32 v245, v246, v247
    v_pk_mul_f32 v[58:59], v[58:59], v[100:101] op_sel_hi:[1,0]
    v_accvgpr_read_b32 v53, a73
    v_cvt_pk_bf16_f32 v196, v196, v197
    v_cvt_pk_bf16_f32 v108, v108, v109
    s_waitcnt lgkmcnt(3)
    buffer_store_dwordx4 v[64:67], v103, s[16:19], s85 offen offset:128 nt
    v_pk_mul_f32 v[52:53], v[52:53], v[100:101] op_sel_hi:[1,0]
    v_pk_mul_f32 v[242:243], v[242:243], v[50:51] op_sel_hi:[1,0]
    v_pk_mul_f32 v[240:241], v[240:241], v[50:51] op_sel_hi:[1,0]
    v_pk_mul_f32 v[110:111], v[110:111], v[100:101] op_sel_hi:[1,0]
    v_cvt_pk_bf16_f32 v157, v158, v159
    v_pk_mul_f32 v[106:107], v[106:107], v[100:101] op_sel_hi:[1,0]
    v_cvt_pk_bf16_f32 v197, v198, v199
    v_cvt_pk_bf16_f32 v240, v240, v241
    v_mul_f32 v203, v203, v49
    v_pk_mul_f32 v[54:55], v[54:55], v[100:101] op_sel_hi:[1,0]
    v_cvt_pk_bf16_f32 v152, v152, v153
    v_cvt_pk_bf16_f32 v52, v52, v53
    v_cvt_pk_bf16_f32 v104, v104, v105
    v_pk_mul_f32 v[56:57], v[56:57], v[100:101] op_sel_hi:[1,0]
    ds_read_b128 v[80:83], v8 offset:21504
    v_cvt_pk_bf16_f32 v192, v192, v193
    v_cvt_pk_bf16_f32 v53, v54, v55
    v_cvt_pk_bf16_f32 v56, v56, v57
    v_cvt_pk_bf16_f32 v249, v250, v251
    v_cvt_pk_bf16_f32 v105, v106, v107
    v_cvt_pk_bf16_f32 v109, v110, v111
    v_cvt_pk_bf16_f32 v57, v58, v59
    v_accvgpr_read_b32 v55, a43
    v_pk_mul_f32 v[150:151], v[150:151], v[48:49] op_sel_hi:[1,0]
    v_cvt_pk_bf16_f32 v253, v254, v255
    s_waitcnt lgkmcnt(1)
    buffer_store_dwordx4 v[68:71], v102, s[16:19], s86 offen offset:128 nt
    ds_write_b64 v101, v[104:105] offset:26624
    v_accvgpr_read_b32 v54, a42
    v_mul_f32 v194, v194, v49
    ds_write_b64 v92, v[108:109] offset:26624
    ds_write_b64 v93, v[52:53] offset:26624
    v_cvt_pk_bf16_f32 v201, v202, v203
    buffer_store_dwordx4 v[72:75], v103, s[16:19], s86 offen offset:128 nt
    v_cvt_pk_bf16_f32 v193, v194, v195
    v_accvgpr_read_b32 v104, a32
    v_accvgpr_read_b32 v105, a33
    v_accvgpr_read_b32 v108, a36
    ds_write_b64 v94, v[56:57] offset:26624
    v_accvgpr_read_b32 v107, a35
    v_mul_f32 v54, v54, v51
    v_mul_f32 v104, v104, v51
    v_cvt_pk_bf16_f32 v205, v206, v207
    v_cvt_pk_bf16_f32 v153, v154, v155
    v_accvgpr_read_b32 v106, a34
    v_cvt_pk_bf16_f32 v241, v242, v243
    ds_read_b128 v[84:87], v8 offset:26624
    v_cvt_pk_bf16_f32 v149, v150, v151
    v_mul_f32 v55, v55, v51
    v_accvgpr_read_b32 v109, a37
    ds_read_b128 v[88:91], v8 offset:27648
    v_accvgpr_read_b32 v111, a39
    v_mul_f32 v105, v105, v51
    v_mul_f32 v107, v107, v51
    buffer_store_dwordx4 v[76:79], v102, s[16:19], s87 offen offset:128 nt
    v_accvgpr_read_b32 v52, a40
    ds_write2st64_b64 v101, v[144:145], v[192:193] offset0:8 offset1:20
    ds_write2st64_b64 v92, v[148:149], v[196:197] offset0:8 offset1:20
    ds_write2st64_b64 v93, v[152:153], v[200:201] offset0:8 offset1:20
    ds_write2st64_b64 v94, v[156:157], v[204:205] offset0:8 offset1:20
    v_mul_f32 v111, v111, v51
    ds_read_b128 v[60:63], v8 offset:4096
    v_cvt_pk_bf16_f32 v104, v104, v105
    v_mul_f32 v106, v106, v51
    s_waitcnt lgkmcnt(5)
    buffer_store_dwordx4 v[80:83], v103, s[16:19], s87 offen offset:128 nt
    v_mul_f32 v108, v108, v51
    ds_read_b128 v[64:67], v8 offset:5120
    ds_read_b128 v[68:71], v8 offset:10240
    ds_read_b128 v[72:75], v8 offset:11264
    v_cvt_pk_bf16_f32 v105, v106, v107
    v_accvgpr_read_b32 v57, a45
    v_accvgpr_read_b32 v58, a46
    v_accvgpr_read_b32 v56, a44
    v_mul_f32 v109, v109, v51
    ds_write2st64_b64 v101, v[240:241], v[104:105] offset0:32 offset1:44
    v_mul_f32 v57, v57, v51
    v_mul_f32 v56, v56, v51
    v_accvgpr_read_b32 v107, a83
    v_accvgpr_read_b32 v106, a82
    v_accvgpr_read_b32 v105, a81
    v_accvgpr_read_b32 v104, a80
    v_pk_mul_f32 v[106:107], v[106:107], v[100:101] op_sel_hi:[1,0]
    v_cvt_pk_bf16_f32 v108, v108, v109
    v_accvgpr_read_b32 v59, a47
    v_mul_f32 v58, v58, v51
    v_cvt_pk_bf16_f32 v56, v56, v57
    buffer_store_dwordx4 v[84:87], v102, s[16:19], s88 offen offset:128 nt
    buffer_store_dwordx4 v[88:91], v103, s[16:19], s88 offen offset:128 nt
    v_accvgpr_read_b32 v53, a41
    v_accvgpr_read_b32 v110, a38
    v_pk_mul_f32 v[104:105], v[104:105], v[100:101] op_sel_hi:[1,0]
    s_waitcnt lgkmcnt(0)
    buffer_store_dwordx4 v[60:63], v102, s[16:19], s84 offen offset:256 nt
    v_mul_f32 v52, v52, v51
    v_cvt_pk_bf16_f32 v104, v104, v105
    v_mul_f32 v53, v53, v51
    v_mul_f32 v110, v110, v51
    v_mul_f32 v59, v59, v51
    v_cvt_pk_bf16_f32 v109, v110, v111
    v_cvt_pk_bf16_f32 v52, v52, v53
    v_cvt_pk_bf16_f32 v53, v54, v55
    ds_write2st64_b64 v92, v[244:245], v[108:109] offset0:32 offset1:44
    v_cvt_pk_bf16_f32 v105, v106, v107
    v_cvt_pk_bf16_f32 v57, v58, v59
    ds_write2st64_b64 v93, v[248:249], v[52:53] offset0:32 offset1:44
    v_accvgpr_read_b32 v109, a85
    v_accvgpr_read_b32 v52, a88
    buffer_store_dwordx4 v[64:67], v103, s[16:19], s84 offen offset:256 nt
    v_accvgpr_read_b32 v55, a91
    v_accvgpr_read_b32 v58, a94
    ds_write2st64_b64 v94, v[252:253], v[56:57] offset0:32 offset1:44
    v_accvgpr_read_b32 v53, a89
    ds_read_b128 v[76:79], v8 offset:16384
    v_pk_mul_f32 v[52:53], v[52:53], v[100:101] op_sel_hi:[1,0]
    v_accvgpr_read_b32 v111, a87
    ds_read_b128 v[80:83], v8 offset:17408
    v_accvgpr_read_b32 v108, a84
    v_accvgpr_read_b32 v110, a86
    buffer_store_dwordx4 v[68:71], v102, s[16:19], s85 offen offset:256 nt
    ds_read_b128 v[84:87], v8 offset:22528
    v_accvgpr_read_b32 v54, a90
    v_pk_mul_f32 v[108:109], v[108:109], v[100:101] op_sel_hi:[1,0]
    v_pk_mul_f32 v[110:111], v[110:111], v[100:101] op_sel_hi:[1,0]
    v_cvt_pk_bf16_f32 v52, v52, v53
    v_pk_mul_f32 v[54:55], v[54:55], v[100:101] op_sel_hi:[1,0]
    v_accvgpr_read_b32 v59, a95
    v_accvgpr_read_b32 v57, a93
    v_pk_mul_f32 v[58:59], v[58:59], v[100:101] op_sel_hi:[1,0]
    buffer_store_dwordx4 v[72:75], v103, s[16:19], s85 offen offset:256 nt
    ds_read_b128 v[88:91], v8 offset:23552
    v_accvgpr_read_b32 v56, a92
    v_cvt_pk_bf16_f32 v53, v54, v55
    ds_write_b64 v101, v[104:105] offset:0
    v_cvt_pk_bf16_f32 v108, v108, v109
    v_pk_mul_f32 v[56:57], v[56:57], v[100:101] op_sel_hi:[1,0]
    s_nop 0
    v_cvt_pk_bf16_f32 v56, v56, v57
    v_cvt_pk_bf16_f32 v109, v110, v111
    ds_write_b64 v92, v[108:109] offset:0
    s_waitcnt lgkmcnt(3)
    buffer_store_dwordx4 v[76:79], v102, s[16:19], s86 offen offset:256 nt
    ds_write_b64 v93, v[52:53] offset:0
    buffer_store_dwordx4 v[80:83], v103, s[16:19], s86 offen offset:256 nt
    v_cvt_pk_bf16_f32 v57, v58, v59
    ds_write_b64 v94, v[56:57] offset:0
    buffer_store_dwordx4 v[84:87], v102, s[16:19], s87 offen offset:256 nt
    ds_read_b128 v[60:63], v8 offset:0
    ds_read_b128 v[64:67], v8 offset:1024
    s_waitcnt lgkmcnt(3)
    buffer_store_dwordx4 v[88:91], v103, s[16:19], s87 offen offset:256 nt
    s_waitcnt lgkmcnt(1)
    buffer_store_dwordx4 v[60:63], v102, s[16:19], s88 offen offset:256 nt
    s_waitcnt lgkmcnt(0)
    buffer_store_dwordx4 v[64:67], v103, s[16:19], s88 offen offset:256 nt
    s_branch L_fin
L_end4:
    s_waitcnt lgkmcnt(4)
    v_mfma_f32_16x16x32_bf16 v[112:115], a[212:215], v[16:19], v[112:115]
    v_fma_f32 v56, v56, s28, v9
    v_mfma_f32_16x16x32_bf16 v[116:119], a[216:219], v[16:19], v[116:119]
    ds_read_b64_tr_b16 a[234:235], v3 offset:13312
    v_fma_f32 v79, v79, s28, v12
    v_mfma_f32_16x16x32_bf16 v[164:167], a[216:219], v[22:25], v[164:167]
    ds_read_b64_tr_b16 a[228:229], v2 offset:19456
    v_fma_f32 v63, v63, s28, v10
    v_mfma_f32_16x16x32_bf16 v[160:163], a[212:215], v[22:25], v[160:163]
    ds_read_b64_tr_b16 a[230:231], v2 offset:13312
    v_mfma_f32_16x16x32_bf16 v[208:211], a[212:215], v[28:31], v[208:211]
    ds_read_b64_tr_b16 a[232:233], v3 offset:19456
    v_fma_f32 v69, v69, s28, v11
    v_mfma_f32_16x16x32_bf16 v[212:215], a[216:219], v[28:31], v[212:215]
    v_fma_f32 v75, v75, s28, v11
    v_mfma_f32_16x16x32_bf16 a[4:7], a[216:219], v[34:37], a[4:7]
    v_exp_f32 v69, v69
    v_mfma_f32_16x16x32_bf16 a[0:3], a[212:215], v[34:37], a[0:3]
    v_fma_f32 v71, v71, s28, v11
    s_waitcnt lgkmcnt(4)
    v_mfma_f32_16x16x32_bf16 a[8:11], a[220:223], v[34:37], a[8:11]
    v_exp_f32 v71, v71
    v_mfma_f32_16x16x32_bf16 a[12:15], a[224:227], v[34:37], a[12:15]
    ds_read_b64_tr_b16 a[216:217], v5 offset:19456
    v_fma_f32 v62, v62, s28, v10
    v_mfma_f32_16x16x32_bf16 v[220:223], a[224:227], v[28:31], v[220:223]
    v_exp_f32 v79, v79
    v_mfma_f32_16x16x32_bf16 v[216:219], a[220:223], v[28:31], v[216:219]
    ds_read_b64_tr_b16 a[214:215], v4 offset:13312
    v_mfma_f32_16x16x32_bf16 v[168:171], a[220:223], v[22:25], v[168:171]
    ds_read_b64_tr_b16 a[212:213], v4 offset:19456
    v_fma_f32 v74, v74, s28, v11
    v_mfma_f32_16x16x32_bf16 v[172:175], a[224:227], v[22:25], v[172:175]
    ds_read_b64_tr_b16 a[218:219], v5 offset:13312
    v_fma_f32 v77, v77, s28, v12
    v_mfma_f32_16x16x32_bf16 v[124:127], a[224:227], v[16:19], v[124:127]
    v_fma_f32 v57, v57, s28, v9
    v_fma_f32 v81, v81, s28, v12
    v_mfma_f32_16x16x32_bf16 v[120:123], a[220:223], v[16:19], v[120:123]
    s_waitcnt lgkmcnt(4)
    v_fma_f32 v70, v70, s28, v11
    v_fma_f32 v58, v58, s28, v9
    v_mfma_f32_16x16x32_bf16 v[128:131], a[228:231], v[16:19], v[128:131]
    v_exp_f32 v62, v62
    v_mfma_f32_16x16x32_bf16 v[132:135], a[232:235], v[16:19], v[132:135]
    ds_read_b64_tr_b16 a[220:221], v2 offset:20480
    v_mfma_f32_16x16x32_bf16 v[180:183], a[232:235], v[22:25], v[180:183]
    ds_read_b64_tr_b16 a[222:223], v2 offset:14336
    v_fma_f32 v67, v67, s28, v10
    v_mfma_f32_16x16x32_bf16 v[176:179], a[228:231], v[22:25], v[176:179]
    v_exp_f32 v70, v70
    v_mfma_f32_16x16x32_bf16 v[224:227], a[228:231], v[28:31], v[224:227]
    ds_read_b64_tr_b16 a[224:225], v3 offset:20480
    v_fma_f32 v78, v78, s28, v12
    v_mfma_f32_16x16x32_bf16 v[228:231], a[232:235], v[28:31], v[228:231]
    v_cvt_pk_bf16_f32 v27, v70, v71
    v_mfma_f32_16x16x32_bf16 a[20:23], a[232:235], v[34:37], a[20:23]
    ds_read_b64_tr_b16 a[226:227], v3 offset:14336
    v_fma_f32 v72, v72, s28, v11
    v_mfma_f32_16x16x32_bf16 a[16:19], a[228:231], v[34:37], a[16:19]
    s_waitcnt lgkmcnt(4)
    ds_read_b64_tr_b16 a[232:233], v5 offset:20480
    s_add_u32 s39, s39, 12288
    v_mfma_f32_16x16x32_bf16 a[24:27], a[212:215], v[34:37], a[24:27]
    ds_read_b64_tr_b16 a[234:235], v5 offset:14336
    v_fma_f32 v68, v68, s28, v11
    v_mfma_f32_16x16x32_bf16 a[28:31], a[216:219], v[34:37], a[28:31]
    ds_read_b64_tr_b16 a[230:231], v4 offset:14336
    v_fma_f32 v76, v76, s28, v12
    v_mfma_f32_16x16x32_bf16 v[236:239], a[216:219], v[28:31], v[236:239]
    ds_read_b64_tr_b16 a[228:229], v4 offset:20480
    v_fma_f32 v73, v73, s28, v11
    v_mfma_f32_16x16x32_bf16 v[232:235], a[212:215], v[28:31], v[232:235]
    v_exp_f32 v56, v56
    v_mfma_f32_16x16x32_bf16 v[184:187], a[212:215], v[22:25], v[184:187]
    v_exp_f32 v57, v57
    v_mfma_f32_16x16x32_bf16 v[188:191], a[216:219], v[22:25], v[188:191]
    v_exp_f32 v75, v75
    v_mfma_f32_16x16x32_bf16 v[140:143], a[216:219], v[16:19], v[140:143]
    v_exp_f32 v63, v63
    v_mfma_f32_16x16x32_bf16 v[136:139], a[212:215], v[16:19], v[136:139]
    s_waitcnt lgkmcnt(5)
    v_exp_f32 v78, v78
    v_mfma_f32_16x16x32_bf16 v[144:147], a[220:223], v[16:19], v[144:147]
    s_waitcnt lgkmcnt(4)
    v_exp_f32 v68, v68
    v_mfma_f32_16x16x32_bf16 v[148:151], a[224:227], v[16:19], v[148:151]
    ds_read_b128 v[96:99], v8 offset:2048
    v_fma_f32 v82, v82, s28, v12
    v_mfma_f32_16x16x32_bf16 v[196:199], a[224:227], v[22:25], v[196:199]
    v_exp_f32 v77, v77
    v_mfma_f32_16x16x32_bf16 v[192:195], a[220:223], v[22:25], v[192:195]
    v_exp_f32 v74, v74
    v_mfma_f32_16x16x32_bf16 v[240:243], a[220:223], v[28:31], v[240:243]
    s_waitcnt vmcnt(10) lgkmcnt(1)
    v_exp_f32 v76, v76
    v_mfma_f32_16x16x32_bf16 v[244:247], a[224:227], v[28:31], v[244:247]
    s_barrier
    v_mfma_f32_16x16x32_bf16 a[36:39], a[224:227], v[34:37], a[36:39]
    ds_read_b128 a[212:215], v0 offset:12288
    v_cvt_pk_bf16_f32 v21, v62, v63
    v_mfma_f32_16x16x32_bf16 a[32:35], a[220:223], v[34:37], a[32:35]
    s_add_u32 m0, s22, 36864
    ds_read_b128 a[216:219], v1 offset:12288
    v_fma_f32 v66, v66, s28, v10
    v_mfma_f32_16x16x32_bf16 a[40:43], a[228:231], v[34:37], a[40:43]
    ds_read_b128 a[220:223], v0 offset:13312
    v_fma_f32 v65, v65, s28, v10
    v_mfma_f32_16x16x32_bf16 a[44:47], a[232:235], v[34:37], a[44:47]
    buffer_load_dwordx4 v6, s[8:11], s21 offen lds
    v_mfma_f32_16x16x32_bf16 v[252:255], a[232:235], v[28:31], v[252:255]
    s_add_u32 s21, s21, 128
    v_exp_f32 v58, v58
    v_mfma_f32_16x16x32_bf16 v[248:251], a[228:231], v[28:31], v[248:251]
    ds_read_b128 a[224:227], v1 offset:13312
    s_add_u32 m0, s22, 37888
    v_mfma_f32_16x16x32_bf16 v[200:203], a[228:231], v[22:25], v[200:203]
    buffer_load_dwordx4 v6, s[8:11], s21 offen lds
    v_mfma_f32_16x16x32_bf16 v[204:207], a[232:235], v[22:25], v[204:207]
    s_add_u32 s21, s21, 128
    v_fma_f32 v83, v83, s28, v12
    s_add_u32 m0, s22, 38912
    v_mfma_f32_16x16x32_bf16 v[156:159], a[232:235], v[16:19], v[156:159]
    buffer_load_dwordx4 v6, s[8:11], s21 offen lds
    v_mfma_f32_16x16x32_bf16 v[152:155], a[228:231], v[16:19], v[152:155]
    ds_read_b128 a[228:231], v0 offset:14336
    s_waitcnt lgkmcnt(4)
    v_mfma_f32_16x16x32_bf16 v[52:55], a[212:215], a[96:99], 0
    ds_read_b128 a[232:235], v1 offset:14336
    s_waitcnt lgkmcnt(4)
    v_mfma_f32_16x16x32_bf16 v[52:55], a[216:219], a[100:103], v[52:55]
    v_cvt_pk_bf16_f32 v32, v76, v77
    s_waitcnt lgkmcnt(3)
    v_mfma_f32_16x16x32_bf16 v[52:55], a[220:223], a[104:107], v[52:55]
    v_exp_f32 v67, v67
    v_mfma_f32_16x16x32_bf16 v[60:63], a[220:223], a[128:131], 0
    ds_read_b128 v[84:87], v8 offset:3072
    v_cvt_pk_bf16_f32 v33, v78, v79
    v_mfma_f32_16x16x32_bf16 v[60:63], a[216:219], a[124:127], v[60:63]
    v_cvt_pk_bf16_f32 v26, v68, v69
    v_cvt_pk_bf16_f32 v16, v56, v57
    v_mfma_f32_16x16x32_bf16 v[60:63], a[212:215], a[120:123], v[60:63]
    v_fma_f32 v59, v59, s28, v9
    v_mfma_f32_16x16x32_bf16 v[68:71], a[212:215], a[144:147], 0
    v_exp_f32 v73, v73
    v_mfma_f32_16x16x32_bf16 v[68:71], a[216:219], a[148:151], v[68:71]
    s_add_u32 s21, s21, 12032
    v_exp_f32 v82, v82
    v_mfma_f32_16x16x32_bf16 v[68:71], a[220:223], a[152:155], v[68:71]
    v_exp_f32 v66, v66
    v_mfma_f32_16x16x32_bf16 v[76:79], a[220:223], a[176:179], 0
    ds_read_b128 a[220:223], v0 offset:19456
    v_cvt_pk_bf16_f32 v29, v74, v75
    v_mfma_f32_16x16x32_bf16 v[76:79], a[216:219], a[172:175], v[76:79]
    v_fma_f32 v64, v64, s28, v10
    v_fma_f32 v80, v80, s28, v12
    v_mfma_f32_16x16x32_bf16 v[76:79], a[212:215], a[168:171], v[76:79]
    s_waitcnt lgkmcnt(2)
    v_exp_f32 v64, v64
    v_mfma_f32_16x16x32_bf16 v[76:79], a[224:227], a[180:183], v[76:79]
    v_exp_f32 v72, v72
    v_mfma_f32_16x16x32_bf16 v[76:79], a[228:231], a[184:187], v[76:79]
    v_exp_f32 v59, v59
    v_mfma_f32_16x16x32_bf16 v[76:79], a[232:235], a[188:191], v[76:79]
    v_exp_f32 v80, v80
    v_mfma_f32_16x16x32_bf16 v[68:71], a[232:235], a[164:167], v[68:71]
    s_add_u32 s56, s24, 5888
    v_exp_f32 v81, v81
    v_mfma_f32_16x16x32_bf16 v[68:71], a[228:231], a[160:163], v[68:71]
    ds_read_b128 a[212:215], v0 offset:18432
    v_mfma_f32_16x16x32_bf16 v[68:71], a[224:227], a[156:159], v[68:71]
    ds_read_b128 a[216:219], v1 offset:18432
    v_cvt_pk_bf16_f32 v17, v58, v59
    v_mfma_f32_16x16x32_bf16 v[60:63], a[224:227], a[132:135], v[60:63]
    ds_read_b128 v[88:91], v8 offset:4096
    v_cvt_pk_bf16_f32 v28, v72, v73
    v_mfma_f32_16x16x32_bf16 v[60:63], a[228:231], a[136:139], v[60:63]
    v_exp_f32 v83, v83
    v_mfma_f32_16x16x32_bf16 v[60:63], a[232:235], a[140:143], v[60:63]
    buffer_store_dwordx4 v[96:99], v102, s[16:19], s56 offen offset:0 nt
    v_exp_f32 v65, v65
    v_mfma_f32_16x16x32_bf16 v[52:55], a[232:235], a[116:119], v[52:55]
    ds_read_b128 a[232:235], v1 offset:20480
    v_cvt_pk_bf16_f32 v22, v64, v65
    v_mfma_f32_16x16x32_bf16 v[52:55], a[228:231], a[112:115], v[52:55]
    ds_read_b128 a[228:231], v0 offset:20480
    v_cvt_pk_bf16_f32 v23, v66, v67
    v_mfma_f32_16x16x32_bf16 v[52:55], a[224:227], a[108:111], v[52:55]
    ds_read_b128 a[224:227], v1 offset:19456
    v_mfma_f32_16x16x32_bf16 v[44:47], a[236:239], v[14:17], v[48:51]
    s_waitcnt lgkmcnt(5)
    v_mfma_f32_16x16x32_bf16 v[56:59], a[212:215], a[96:99], 0
    ds_read_b128 v[96:99], v8 offset:5120
    v_cvt_pk_bf16_f32 v35, v82, v83
    v_mfma_f32_16x16x32_bf16 v[44:47], a[240:243], v[20:23], v[44:47]
    v_cvt_pk_bf16_f32 v34, v80, v81
    v_mfma_f32_16x16x32_bf16 v[44:47], a[244:247], v[26:29], v[44:47]
    s_waitcnt lgkmcnt(4)
    v_mfma_f32_16x16x32_bf16 v[56:59], a[216:219], a[100:103], v[56:59]
    buffer_store_dwordx4 v[84:87], v103, s[16:19], s56 offen offset:0 nt
    v_mfma_f32_16x16x32_bf16 v[44:47], a[248:251], v[32:35], v[44:47]
    s_add_u32 s57, s24, 6016
    ds_read_b128 v[84:87], v8 offset:0
    v_mfma_f32_16x16x32_bf16 v[56:59], a[220:223], a[104:107], v[56:59]
    v_mfma_f32_16x16x32_bf16 v[64:67], a[220:223], a[128:131], 0
    buffer_store_dwordx4 v[88:91], v102, s[16:19], s57 offen offset:0 nt
    s_waitcnt vmcnt(10) lgkmcnt(2)
    s_nop 1
    v_cmp_lt_f32 vcc, s29, v44
    v_mfma_f32_16x16x32_bf16 v[64:67], a[216:219], a[124:127], v[64:67]
    ds_read_b128 v[88:91], v8 offset:1024
    v_mfma_f32_16x16x32_bf16 v[64:67], a[212:215], a[120:123], v[64:67]
    s_barrier
    v_mfma_f32_16x16x32_bf16 v[72:75], a[212:215], a[144:147], 0
    s_cbranch_vccnz L_rs_end4a
L_ret_end4a:
    v_fma_f32 v52, v52, s28, v9
    v_mfma_f32_16x16x32_bf16 v[72:75], a[216:219], a[148:151], v[72:75]
    v_fma_f32 v55, v55, s28, v9
    v_fma_f32 v53, v53, s28, v9
    v_mfma_f32_16x16x32_bf16 v[72:75], a[220:223], a[152:155], v[72:75]
    v_exp_f32 v52, v52
    v_mfma_f32_16x16x32_bf16 v[80:83], a[220:223], a[176:179], 0
    v_mfma_f32_16x16x32_bf16 v[80:83], a[216:219], a[172:175], v[80:83]
    v_fma_f32 v54, v54, s28, v9
    v_mfma_f32_16x16x32_bf16 v[80:83], a[212:215], a[168:171], v[80:83]
    v_mfma_f32_16x16x32_bf16 v[80:83], a[224:227], a[180:183], v[80:83]
    ds_read_b64_tr_b16 a[212:213], v2 offset:0
    v_fma_f32 v60, v60, s28, v10
    v_mfma_f32_16x16x32_bf16 v[80:83], a[228:231], a[184:187], v[80:83]
    ds_read_b64_tr_b16 a[214:215], v2 offset:6144
    v_mfma_f32_16x16x32_bf16 v[80:83], a[232:235], a[188:191], v[80:83]
    ds_read_b64_tr_b16 a[216:217], v3 offset:0
    v_mfma_f32_16x16x32_bf16 v[72:75], a[232:235], a[164:167], v[72:75]
    ds_read_b64_tr_b16 a[218:219], v3 offset:6144
    v_fma_f32 v61, v61, s28, v10
    v_mfma_f32_16x16x32_bf16 v[72:75], a[228:231], a[160:163], v[72:75]
    ds_read_b64_tr_b16 a[220:221], v4 offset:0
    v_mfma_f32_16x16x32_bf16 v[72:75], a[224:227], a[156:159], v[72:75]
    s_waitcnt lgkmcnt(5)
    buffer_store_dwordx4 v[96:99], v103, s[16:19], s57 offen offset:0 nt
    ds_read_b64_tr_b16 a[222:223], v4 offset:6144
    v_exp_f32 v53, v53
    v_mfma_f32_16x16x32_bf16 v[64:67], a[224:227], a[132:135], v[64:67]
    v_exp_f32 v54, v54
    v_mfma_f32_16x16x32_bf16 v[64:67], a[228:231], a[136:139], v[64:67]
    buffer_store_dwordx4 v[84:87], v102, s[16:19], s24 offen offset:0 nt
    v_exp_f32 v61, v61
    v_mfma_f32_16x16x32_bf16 v[64:67], a[232:235], a[140:143], v[64:67]
    v_exp_f32 v55, v55
    v_mfma_f32_16x16x32_bf16 v[56:59], a[232:235], a[116:119], v[56:59]
    v_exp_f32 v60, v60
    v_mfma_f32_16x16x32_bf16 v[56:59], a[228:231], a[112:115], v[56:59]
    v_cvt_pk_bf16_f32 v19, v54, v55
    v_mfma_f32_16x16x32_bf16 v[56:59], a[224:227], a[108:111], v[56:59]
    ds_read_b64_tr_b16 a[224:225], v5 offset:0
    ds_read_b64_tr_b16 a[226:227], v5 offset:6144
    buffer_store_dwordx4 v[88:91], v103, s[16:19], s24 offen offset:0 nt
    v_cvt_pk_bf16_f32 v18, v52, v53
    v_cvt_pk_bf16_f32 v24, v60, v61
    s_waitcnt lgkmcnt(4)
    v_mfma_f32_16x16x32_bf16 v[112:115], a[212:215], v[14:17], v[112:115]
    ds_read_b64_tr_b16 a[228:229], v2 offset:1024
    v_fma_f32 v56, v56, s28, v9
    v_mfma_f32_16x16x32_bf16 v[116:119], a[216:219], v[14:17], v[116:119]
    s_add_u32 s39, s39, 12288
    ds_read_b64_tr_b16 a[232:233], v3 offset:1024
    v_fma_f32 v74, v74, s28, v11
    v_mfma_f32_16x16x32_bf16 v[164:167], a[216:219], v[20:23], v[164:167]
    s_waitcnt vmcnt(6)
    ds_read_b64_tr_b16 a[234:235], v3 offset:7168
    v_fma_f32 v82, v82, s28, v12
    v_mfma_f32_16x16x32_bf16 v[160:163], a[212:215], v[20:23], v[160:163]
    s_barrier
    v_fma_f32 v77, v77, s28, v12
    v_fma_f32 v75, v75, s28, v11
    v_mfma_f32_16x16x32_bf16 v[208:211], a[212:215], v[26:29], v[208:211]
    v_fma_f32 v67, v67, s28, v10
    v_fma_f32 v64, v64, s28, v10
    v_mfma_f32_16x16x32_bf16 v[212:215], a[216:219], v[26:29], v[212:215]
    ds_read_b64_tr_b16 a[230:231], v2 offset:7168
    v_fma_f32 v63, v63, s28, v10
    v_fma_f32 v65, v65, s28, v10
    v_mfma_f32_16x16x32_bf16 a[4:7], a[216:219], v[32:35], a[4:7]
    ds_read_b64_tr_b16 a[216:217], v5 offset:1024
    v_fma_f32 v78, v78, s28, v12
    v_mfma_f32_16x16x32_bf16 a[0:3], a[212:215], v[32:35], a[0:3]
    s_waitcnt lgkmcnt(5)
    ds_read_b64_tr_b16 a[214:215], v4 offset:7168
    v_fma_f32 v79, v79, s28, v12
    v_mfma_f32_16x16x32_bf16 a[8:11], a[220:223], v[32:35], a[8:11]
    ds_read_b64_tr_b16 a[218:219], v5 offset:7168
    v_fma_f32 v69, v69, s28, v11
    v_mfma_f32_16x16x32_bf16 a[12:15], a[224:227], v[32:35], a[12:15]
    v_exp_f32 v77, v77
    v_fma_f32 v83, v83, s28, v12
    v_mfma_f32_16x16x32_bf16 v[220:223], a[224:227], v[26:29], v[220:223]
    v_exp_f32 v63, v63
    v_fma_f32 v70, v70, s28, v11
    v_mfma_f32_16x16x32_bf16 v[216:219], a[220:223], v[26:29], v[216:219]
    v_fma_f32 v66, v66, s28, v10
    v_fma_f32 v81, v81, s28, v12
    v_fma_f32 v57, v57, s28, v9
    v_mfma_f32_16x16x32_bf16 v[168:171], a[220:223], v[20:23], v[168:171]
    v_exp_f32 v64, v64
    v_mfma_f32_16x16x32_bf16 v[172:175], a[224:227], v[20:23], v[172:175]
    ds_read_b64_tr_b16 a[212:213], v4 offset:1024
    v_fma_f32 v68, v68, s28, v11
    v_mfma_f32_16x16x32_bf16 v[124:127], a[224:227], v[14:17], v[124:127]
    v_exp_f32 v74, v74
    v_mfma_f32_16x16x32_bf16 v[120:123], a[220:223], v[14:17], v[120:123]
    s_waitcnt lgkmcnt(3)
    ds_read_b64_tr_b16 a[222:223], v2 offset:8192
    v_fma_f32 v58, v58, s28, v9
    v_mfma_f32_16x16x32_bf16 v[128:131], a[228:231], v[14:17], v[128:131]
    v_exp_f32 v69, v69
    v_mfma_f32_16x16x32_bf16 v[132:135], a[232:235], v[14:17], v[132:135]
    ds_read_b64_tr_b16 a[224:225], v3 offset:2048
    v_fma_f32 v62, v62, s28, v10
    v_mfma_f32_16x16x32_bf16 v[180:183], a[232:235], v[20:23], v[180:183]
    v_exp_f32 v75, v75
    v_mfma_f32_16x16x32_bf16 v[176:179], a[228:231], v[20:23], v[176:179]
    v_exp_f32 v68, v68
    v_mfma_f32_16x16x32_bf16 v[224:227], a[228:231], v[26:29], v[224:227]
    ds_read_b64_tr_b16 a[220:221], v2 offset:2048
    v_exp_f32 v79, v79
    v_mfma_f32_16x16x32_bf16 v[228:231], a[232:235], v[26:29], v[228:231]
    v_exp_f32 v57, v57
    v_mfma_f32_16x16x32_bf16 a[20:23], a[232:235], v[32:35], a[20:23]
    ds_read_b64_tr_b16 a[226:227], v3 offset:8192
    v_fma_f32 v59, v59, s28, v9
    v_mfma_f32_16x16x32_bf16 a[16:19], a[228:231], v[32:35], a[16:19]
    s_waitcnt lgkmcnt(4)
    v_exp_f32 v81, v81
    v_mfma_f32_16x16x32_bf16 a[24:27], a[212:215], v[32:35], a[24:27]
    v_exp_f32 v78, v78
    v_mfma_f32_16x16x32_bf16 a[28:31], a[216:219], v[32:35], a[28:31]
    ds_read_b64_tr_b16 a[228:229], v4 offset:2048
    v_fma_f32 v80, v80, s28, v12
    v_fma_f32 v71, v71, s28, v11
    v_mfma_f32_16x16x32_bf16 v[236:239], a[216:219], v[26:29], v[236:239]
    ds_read_b64_tr_b16 a[230:231], v4 offset:8192
    v_fma_f32 v73, v73, s28, v11
    v_mfma_f32_16x16x32_bf16 v[232:235], a[212:215], v[26:29], v[232:235]
    ds_read_b64_tr_b16 a[234:235], v5 offset:8192
    v_fma_f32 v72, v72, s28, v11
    v_mfma_f32_16x16x32_bf16 v[184:187], a[212:215], v[20:23], v[184:187]
    v_exp_f32 v82, v82
    v_mfma_f32_16x16x32_bf16 v[188:191], a[216:219], v[20:23], v[188:191]
    v_exp_f32 v80, v80
    v_mfma_f32_16x16x32_bf16 v[140:143], a[216:219], v[14:17], v[140:143]
    ds_read_b64_tr_b16 a[232:233], v5 offset:2048
    v_cvt_pk_bf16_f32 v37, v78, v79
    v_mfma_f32_16x16x32_bf16 v[136:139], a[212:215], v[14:17], v[136:139]
    s_waitcnt lgkmcnt(5)
    v_exp_f32 v56, v56
    v_mfma_f32_16x16x32_bf16 v[144:147], a[220:223], v[14:17], v[144:147]
    s_waitcnt lgkmcnt(4)
    v_exp_f32 v66, v66
    v_mfma_f32_16x16x32_bf16 v[148:151], a[224:227], v[14:17], v[148:151]
    v_exp_f32 v70, v70
    v_mfma_f32_16x16x32_bf16 v[196:199], a[224:227], v[20:23], v[196:199]
    v_exp_f32 v62, v62
    v_mfma_f32_16x16x32_bf16 v[192:195], a[220:223], v[20:23], v[192:195]
    v_fma_f32 v76, v76, s28, v12
    v_exp_f32 v59, v59
    v_mfma_f32_16x16x32_bf16 v[240:243], a[220:223], v[26:29], v[240:243]
    v_exp_f32 v65, v65
    v_mfma_f32_16x16x32_bf16 v[244:247], a[224:227], v[26:29], v[244:247]
    v_exp_f32 v71, v71
    v_mfma_f32_16x16x32_bf16 a[36:39], a[224:227], v[32:35], a[36:39]
    v_exp_f32 v83, v83
    v_mfma_f32_16x16x32_bf16 a[32:35], a[220:223], v[32:35], a[32:35]
    s_waitcnt lgkmcnt(1)
    ds_read_b64_tr_b16 a[212:213], v2 offset:18432
    v_cvt_pk_bf16_f32 v30, v68, v69
    v_mfma_f32_16x16x32_bf16 a[40:43], a[228:231], v[32:35], a[40:43]
    s_waitcnt lgkmcnt(1)
    ds_read_b64_tr_b16 a[214:215], v2 offset:12288
    v_exp_f32 v73, v73
    v_mfma_f32_16x16x32_bf16 a[44:47], a[232:235], v[32:35], a[44:47]
    ds_read_b64_tr_b16 a[216:217], v3 offset:18432
    v_cvt_pk_bf16_f32 v31, v70, v71
    v_mfma_f32_16x16x32_bf16 v[252:255], a[232:235], v[26:29], v[252:255]
    v_exp_f32 v76, v76
    v_mfma_f32_16x16x32_bf16 v[248:251], a[228:231], v[26:29], v[248:251]
    v_exp_f32 v58, v58
    v_mfma_f32_16x16x32_bf16 v[200:203], a[228:231], v[20:23], v[200:203]
    v_cvt_pk_bf16_f32 v34, v80, v81
    v_exp_f32 v67, v67
    v_mfma_f32_16x16x32_bf16 v[204:207], a[232:235], v[20:23], v[204:207]
    ds_read_b64_tr_b16 a[218:219], v3 offset:12288
    v_cvt_pk_bf16_f32 v22, v64, v65
    v_mfma_f32_16x16x32_bf16 v[156:159], a[232:235], v[14:17], v[156:159]
    ds_read_b64_tr_b16 a[220:221], v4 offset:18432
    v_exp_f32 v72, v72
    v_mfma_f32_16x16x32_bf16 v[152:155], a[228:231], v[14:17], v[152:155]
    ds_read_b64_tr_b16 a[222:223], v4 offset:12288
    v_cvt_pk_bf16_f32 v17, v58, v59
    v_cvt_pk_bf16_f32 v25, v62, v63
    v_cvt_pk_bf16_f32 v16, v56, v57
    v_cvt_pk_bf16_f32 v35, v82, v83
    v_cvt_pk_bf16_f32 v23, v66, v67
    v_mfma_f32_16x16x32_bf16 v[48:51], a[236:239], v[16:19], v[44:47]
    v_cvt_pk_bf16_f32 v29, v74, v75
    v_cvt_pk_bf16_f32 v28, v72, v73
    v_mfma_f32_16x16x32_bf16 v[48:51], a[240:243], v[22:25], v[48:51]
    ds_read_b64_tr_b16 a[224:225], v5 offset:18432
    v_cvt_pk_bf16_f32 v36, v76, v77
    v_mfma_f32_16x16x32_bf16 v[48:51], a[244:247], v[28:31], v[48:51]
    ds_read_b64_tr_b16 a[226:227], v5 offset:12288
    v_mfma_f32_16x16x32_bf16 v[48:51], a[248:251], v[34:37], v[48:51]
    s_nop 7
    v_cmp_lt_f32 vcc, s29, v48
    s_nop 4
    s_cbranch_vccnz L_rs_end4b
L_ret_end4b:
    s_waitcnt lgkmcnt(4)
    v_mfma_f32_16x16x32_bf16 v[112:115], a[212:215], v[16:19], v[112:115]
    v_mbcnt_lo_u32_b32 v104, -1, 0
    v_mbcnt_hi_u32_b32 v104, -1, v104
    v_mfma_f32_16x16x32_bf16 v[116:119], a[216:219], v[16:19], v[116:119]
    ds_read_b64_tr_b16 a[228:229], v2 offset:19456
    v_and_b32 v107, 3, v104
    v_mfma_f32_16x16x32_bf16 v[164:167], a[216:219], v[22:25], v[164:167]
    ds_read_b64_tr_b16 a[234:235], v3 offset:13312
    v_mov_b32 v100, v48
    v_mfma_f32_16x16x32_bf16 v[160:163], a[212:215], v[22:25], v[160:163]
    v_lshrrev_b32 v106, 5, v104
    v_bfe_u32 v105, v104, 3, 1
    v_mfma_f32_16x16x32_bf16 v[208:211], a[212:215], v[28:31], v[208:211]
    ds_read_b64_tr_b16 a[232:233], v3 offset:19456
    v_rcp_f32 v51, v51
    v_mfma_f32_16x16x32_bf16 v[212:215], a[216:219], v[28:31], v[212:215]
    ds_read_b64_tr_b16 a[230:231], v2 offset:13312
    v_rcp_f32 v49, v49
    v_mfma_f32_16x16x32_bf16 a[4:7], a[216:219], v[34:37], a[4:7]
    v_xor_b32 v106, v106, v105
    v_subrev_u32 v8, 22528, v8
    v_mfma_f32_16x16x32_bf16 a[0:3], a[212:215], v[34:37], a[0:3]
    s_waitcnt lgkmcnt(4)
    ds_read_b64_tr_b16 a[214:215], v4 offset:13312
    v_mul_f32 v160, v160, v49
    v_mfma_f32_16x16x32_bf16 a[8:11], a[220:223], v[34:37], a[8:11]
    s_add_u32 s84, s34, 0
    v_rcp_f32 v50, v50
    v_mfma_f32_16x16x32_bf16 a[12:15], a[224:227], v[34:37], a[12:15]
    v_mul_f32 v163, v163, v49
    v_mul_f32 v161, v161, v49
    v_mfma_f32_16x16x32_bf16 v[220:223], a[224:227], v[28:31], v[220:223]
    v_permlane32_swap_b32 v48, v100
    v_mfma_f32_16x16x32_bf16 v[216:219], a[220:223], v[28:31], v[216:219]
    ds_read_b64_tr_b16 a[218:219], v5 offset:13312
    v_mul_f32 v167, v167, v49
    v_mfma_f32_16x16x32_bf16 v[168:171], a[220:223], v[22:25], v[168:171]
    v_xor_b32 v105, s65, v105
    v_lshl_add_u32 v101, v105, 10, s38
    v_mfma_f32_16x16x32_bf16 v[172:175], a[224:227], v[22:25], v[172:175]
    ds_read_b64_tr_b16 a[212:213], v4 offset:19456
    v_mul_f32 v164, v164, v49
    v_mfma_f32_16x16x32_bf16 v[124:127], a[224:227], v[16:19], v[124:127]
    ds_read_b64_tr_b16 a[216:217], v5 offset:19456
    v_lshl_or_b32 v106, v107, 1, v106
    v_mfma_f32_16x16x32_bf16 v[120:123], a[220:223], v[16:19], v[120:123]
    s_waitcnt lgkmcnt(4)
    ds_read_b64_tr_b16 a[226:227], v3 offset:14336
    v_and_b32 v107, 7, v104
    v_mfma_f32_16x16x32_bf16 v[128:131], a[228:231], v[16:19], v[128:131]
    ds_read_b64_tr_b16 a[222:223], v2 offset:14336
    v_mul_f32 v170, v170, v49
    v_mfma_f32_16x16x32_bf16 v[132:135], a[232:235], v[16:19], v[132:135]
    v_mul_f32 v172, v172, v49
    v_lshl_add_u32 v101, v106, 4, v101
    v_mfma_f32_16x16x32_bf16 v[180:183], a[232:235], v[22:25], v[180:183]
    v_mul_f32 v173, v173, v49
    v_lshl_add_u32 v101, v107, 7, v101
    v_mfma_f32_16x16x32_bf16 v[176:179], a[228:231], v[22:25], v[176:179]
    v_rcp_f32 v48, v48
    v_mfma_f32_16x16x32_bf16 v[224:227], a[228:231], v[28:31], v[224:227]
    v_mul_f32 v162, v162, v49
    v_mul_f32 v169, v169, v49
    v_mfma_f32_16x16x32_bf16 v[228:231], a[232:235], v[28:31], v[228:231]
    v_mul_f32 v174, v174, v49
    v_bfe_u32 v107, v104, 4, 1
    v_mfma_f32_16x16x32_bf16 a[20:23], a[232:235], v[34:37], a[20:23]
    s_add_u32 s85, s34, 6144
    ds_read_b64_tr_b16 a[220:221], v2 offset:20480
    v_accvgpr_read_b32 v110, a6
    v_mfma_f32_16x16x32_bf16 a[16:19], a[228:231], v[34:37], a[16:19]
    s_waitcnt lgkmcnt(4)
    ds_read_b64_tr_b16 a[224:225], v3 offset:20480
    v_mul_f32 v168, v168, v49
    v_mfma_f32_16x16x32_bf16 a[24:27], a[212:215], v[34:37], a[24:27]
    s_waitcnt lgkmcnt(4)
    v_lshl_add_u32 v101, v107, 3, v101
    v_cvt_pk_bf16_f32 v160, v160, v161
    v_mfma_f32_16x16x32_bf16 a[28:31], a[216:219], v[34:37], a[28:31]
    ds_read_b64_tr_b16 a[230:231], v4 offset:14336
    v_cvt_pk_bf16_f32 v168, v168, v169
    v_xor_b32 v93, 64, v101
    v_mul_f32 v166, v166, v49
    v_mul_f32 v165, v165, v49
    v_pk_mul_f32 v[124:125], v[124:125], v[48:49] op_sel_hi:[1,0]
    v_pk_mul_f32 v[208:209], v[208:209], v[50:51] op_sel_hi:[1,0]
    v_pk_mul_f32 v[116:117], v[116:117], v[48:49] op_sel_hi:[1,0]
    v_pk_mul_f32 v[118:119], v[118:119], v[48:49] op_sel_hi:[1,0]
    v_pk_mul_f32 v[114:115], v[114:115], v[48:49] op_sel_hi:[1,0]
    v_pk_mul_f32 v[230:231], v[230:231], v[50:51] op_sel_hi:[1,0]
    v_pk_mul_f32 v[126:127], v[126:127], v[48:49] op_sel_hi:[1,0]
    v_pk_mul_f32 v[120:121], v[120:121], v[48:49] op_sel_hi:[1,0]
    v_pk_mul_f32 v[216:217], v[216:217], v[50:51] op_sel_hi:[1,0]
    v_pk_mul_f32 v[112:113], v[112:113], v[48:49] op_sel_hi:[1,0]
    v_pk_mul_f32 v[212:213], v[212:213], v[50:51] op_sel_hi:[1,0]
    v_pk_mul_f32 v[122:123], v[122:123], v[48:49] op_sel_hi:[1,0]
    v_pk_mul_f32 v[220:221], v[220:221], v[50:51] op_sel_hi:[1,0]
    v_pk_mul_f32 v[214:215], v[214:215], v[50:51] op_sel_hi:[1,0]
    v_cvt_pk_bf16_f32 v116, v116, v117
    v_pk_mul_f32 v[222:223], v[222:223], v[50:51] op_sel_hi:[1,0]
    v_cvt_pk_bf16_f32 v161, v162, v163
    v_mul_f32 v171, v171, v49
    v_mfma_f32_16x16x32_bf16 v[236:239], a[216:219], v[28:31], v[236:239]
    v_cvt_pk_bf16_f32 v112, v112, v113
    v_cvt_pk_bf16_f32 v120, v120, v121
    v_mfma_f32_16x16x32_bf16 v[232:235], a[212:215], v[28:31], v[232:235]
    v_cvt_pk_bf16_f32 v124, v124, v125
    v_xor_b32 v94, 96, v101
    v_mfma_f32_16x16x32_bf16 v[184:187], a[212:215], v[22:25], v[184:187]
    s_add_u32 s86, s34, 12288
    ds_read_b64_tr_b16 a[228:229], v4 offset:20480
    v_cvt_pk_bf16_f32 v164, v164, v165
    v_mfma_f32_16x16x32_bf16 v[188:191], a[216:219], v[22:25], v[188:191]
    s_add_u32 s87, s34, 18432
    v_cvt_pk_bf16_f32 v121, v122, v123
    v_cvt_pk_bf16_f32 v113, v114, v115
    v_mfma_f32_16x16x32_bf16 v[140:143], a[216:219], v[16:19], v[140:143]
    ds_read_b64_tr_b16 a[232:233], v5 offset:20480
    v_cvt_pk_bf16_f32 v125, v126, v127
    v_mfma_f32_16x16x32_bf16 v[136:139], a[212:215], v[16:19], v[136:139]
    s_waitcnt lgkmcnt(2)
    v_cvt_pk_bf16_f32 v172, v172, v173
    v_cvt_pk_bf16_f32 v165, v166, v167
    v_mfma_f32_16x16x32_bf16 v[144:147], a[220:223], v[16:19], v[144:147]
    ds_read_b64_tr_b16 a[234:235], v5 offset:14336
    v_cvt_pk_bf16_f32 v169, v170, v171
    v_mfma_f32_16x16x32_bf16 v[148:151], a[224:227], v[16:19], v[148:151]
    v_mul_f32 v175, v175, v49
    v_cvt_pk_bf16_f32 v117, v118, v119
    v_mfma_f32_16x16x32_bf16 v[196:199], a[224:227], v[22:25], v[196:199]
    ds_write2st64_b64 v101, v[112:113], v[160:161] offset0:0 offset1:12
    v_mfma_f32_16x16x32_bf16 v[192:195], a[220:223], v[22:25], v[192:195]
    v_xor_b32 v92, 32, v101
    v_cvt_pk_bf16_f32 v173, v174, v175
    v_mfma_f32_16x16x32_bf16 v[240:243], a[220:223], v[28:31], v[240:243]
    s_add_u32 s18, s34, 24576
    ds_write2st64_b64 v92, v[116:117], v[164:165] offset0:0 offset1:12
    v_mfma_f32_16x16x32_bf16 v[244:247], a[224:227], v[28:31], v[244:247]
    ds_write2st64_b64 v93, v[120:121], v[168:169] offset0:0 offset1:12
    v_mfma_f32_16x16x32_bf16 a[36:39], a[224:227], v[34:37], a[36:39]
    ds_write2st64_b64 v94, v[124:125], v[172:173] offset0:0 offset1:12
    v_mfma_f32_16x16x32_bf16 a[32:35], a[220:223], v[34:37], a[32:35]
    ds_read_b128 v[68:71], v8 offset:0
    v_accvgpr_read_b32 v108, a4
    v_accvgpr_read_b32 v52, a8
    v_accvgpr_read_b32 v59, a15
    v_accvgpr_read_b32 v106, a2
    v_accvgpr_read_b32 v54, a10
    v_pk_mul_f32 v[140:141], v[140:141], v[48:49] op_sel_hi:[1,0]
    v_accvgpr_read_b32 v105, a1
    v_accvgpr_read_b32 v53, a9
    v_mul_f32 v105, v105, v51
    v_accvgpr_read_b32 v104, a0
    v_pk_mul_f32 v[210:211], v[210:211], v[50:51] op_sel_hi:[1,0]
    v_mul_f32 v106, v106, v51
    v_mul_f32 v54, v54, v51
    s_waitcnt lgkmcnt(4)
    v_mfma_f32_16x16x32_bf16 a[40:43], a[228:231], v[34:37], a[40:43]
    ds_read_b128 v[72:75], v8 offset:1024
    v_accvgpr_read_b32 v57, a13
    v_mul_f32 v184, v184, v49
    v_cvt_pk_bf16_f32 v220, v220, v221
    v_mfma_f32_16x16x32_bf16 a[44:47], a[232:235], v[34:37], a[44:47]
    ds_read_b128 v[76:79], v8 offset:6144
    v_mul_f32 v108, v108, v51
    v_mfma_f32_16x16x32_bf16 v[252:255], a[232:235], v[28:31], v[252:255]
    v_cvt_pk_bf16_f32 v221, v222, v223
    v_accvgpr_read_b32 v109, a5
    v_cvt_pk_bf16_f32 v212, v212, v213
    v_mfma_f32_16x16x32_bf16 v[248:251], a[228:231], v[28:31], v[248:251]
    v_mul_f32 v52, v52, v51
    v_mul_f32 v104, v104, v51
    v_mul_f32 v53, v53, v51
    v_cvt_pk_bf16_f32 v213, v214, v215
    v_mfma_f32_16x16x32_bf16 v[200:203], a[228:231], v[22:25], v[200:203]
    s_waitcnt lgkmcnt(2)
    buffer_store_dwordx4 v[68:71], v102, s[16:19], s84 offen offset:0 nt
    v_accvgpr_read_b32 v107, a3
    ds_read_b128 v[80:83], v8 offset:7168
    v_mul_f32 v57, v57, v51
    v_cvt_pk_bf16_f32 v208, v208, v209
    v_mul_f32 v107, v107, v51
    v_pk_mul_f32 v[128:129], v[128:129], v[48:49] op_sel_hi:[1,0]
    v_cvt_pk_bf16_f32 v104, v104, v105
    v_pk_mul_f32 v[218:219], v[218:219], v[50:51] op_sel_hi:[1,0]
    v_pk_mul_f32 v[146:147], v[146:147], v[48:49] op_sel_hi:[1,0]
    v_cvt_pk_bf16_f32 v105, v106, v107
    v_cvt_pk_bf16_f32 v52, v52, v53
    v_accvgpr_read_b32 v111, a7
    v_accvgpr_read_b32 v55, a11
    v_cvt_pk_bf16_f32 v209, v210, v211
    v_mul_f32 v178, v178, v49
    v_mul_f32 v109, v109, v51
    v_mul_f32 v111, v111, v51
    v_mfma_f32_16x16x32_bf16 v[204:207], a[232:235], v[22:25], v[204:207]
    ds_write2st64_b64 v101, v[208:209], v[104:105] offset0:24 offset1:36
    v_mfma_f32_16x16x32_bf16 v[156:159], a[232:235], v[16:19], v[156:159]
    s_waitcnt lgkmcnt(2)
    v_accvgpr_read_b32 v56, a12
    buffer_store_dwordx4 v[72:75], v103, s[16:19], s84 offen offset:0 nt
    v_mul_f32 v186, v186, v49
    v_mul_f32 v59, v59, v51
    v_accvgpr_read_b32 v58, a14
    v_mul_f32 v110, v110, v51
    v_accvgpr_read_b32 v107, a19
    v_mul_f32 v58, v58, v51
    v_pk_mul_f32 v[236:237], v[236:237], v[50:51] op_sel_hi:[1,0]
    v_pk_mul_f32 v[134:135], v[134:135], v[48:49] op_sel_hi:[1,0]
    v_cvt_pk_bf16_f32 v108, v108, v109
    v_mul_f32 v56, v56, v51
    v_pk_mul_f32 v[228:229], v[228:229], v[50:51] op_sel_hi:[1,0]
    v_cvt_pk_bf16_f32 v216, v216, v217
    v_cvt_pk_bf16_f32 v56, v56, v57
    v_mul_f32 v192, v192, v49
    v_mul_f32 v176, v176, v49
    v_pk_mul_f32 v[150:151], v[150:151], v[48:49] op_sel_hi:[1,0]
    v_mul_f32 v107, v107, v51
    v_mul_f32 v185, v185, v49
    v_cvt_pk_bf16_f32 v109, v110, v111
    v_mul_f32 v55, v55, v51
    v_mul_f32 v188, v188, v49
    v_mul_f32 v183, v183, v49
    ds_write2st64_b64 v92, v[212:213], v[108:109] offset0:24 offset1:36
    buffer_store_dwordx4 v[76:79], v102, s[16:19], s85 offen offset:0 nt
    v_cvt_pk_bf16_f32 v217, v218, v219
    v_cvt_pk_bf16_f32 v53, v54, v55
    v_cvt_pk_bf16_f32 v57, v58, v59
    v_pk_mul_f32 v[144:145], v[144:145], v[48:49] op_sel_hi:[1,0]
    v_pk_mul_f32 v[138:139], v[138:139], v[48:49] op_sel_hi:[1,0]
    v_mul_f32 v177, v177, v49
    ds_write2st64_b64 v93, v[216:217], v[52:53] offset0:24 offset1:36
    v_pk_mul_f32 v[132:133], v[132:133], v[48:49] op_sel_hi:[1,0]
    v_accvgpr_read_b32 v55, a27
    v_pk_mul_f32 v[242:243], v[242:243], v[50:51] op_sel_hi:[1,0]
    ds_write2st64_b64 v94, v[220:221], v[56:57] offset0:24 offset1:36
    ds_read_b128 v[84:87], v8 offset:12288
    ds_read_b128 v[88:91], v8 offset:13312
    ds_read_b128 v[60:63], v8 offset:18432
    v_mul_f32 v196, v196, v49
    v_cvt_pk_bf16_f32 v128, v128, v129
    v_pk_mul_f32 v[226:227], v[226:227], v[50:51] op_sel_hi:[1,0]
    s_waitcnt lgkmcnt(5)
    buffer_store_dwordx4 v[80:83], v103, s[16:19], s85 offen offset:0 nt
    v_pk_mul_f32 v[136:137], v[136:137], v[48:49] op_sel_hi:[1,0]
    v_mul_f32 v204, v204, v49
    ds_read_b128 v[64:67], v8 offset:19456
    v_pk_mul_f32 v[248:249], v[248:249], v[50:51] op_sel_hi:[1,0]
    v_pk_mul_f32 v[250:251], v[250:251], v[50:51] op_sel_hi:[1,0]
    v_cvt_pk_bf16_f32 v176, v176, v177
    v_accvgpr_read_b32 v52, a24
    v_accvgpr_read_b32 v57, a29
    v_pk_mul_f32 v[240:241], v[240:241], v[50:51] op_sel_hi:[1,0]
    v_cvt_pk_bf16_f32 v144, v144, v145
    v_cvt_pk_bf16_f32 v136, v136, v137
    v_pk_mul_f32 v[130:131], v[130:131], v[48:49] op_sel_hi:[1,0]
    v_mul_f32 v194, v194, v49
    v_cvt_pk_bf16_f32 v184, v184, v185
    v_mul_f32 v181, v181, v49
    v_mul_f32 v180, v180, v49
    v_pk_mul_f32 v[158:159], v[158:159], v[48:49] op_sel_hi:[1,0]
    v_cvt_pk_bf16_f32 v129, v130, v131
    v_pk_mul_f32 v[224:225], v[224:225], v[50:51] op_sel_hi:[1,0]
    v_mul_f32 v189, v189, v49
    v_pk_mul_f32 v[232:233], v[232:233], v[50:51] op_sel_hi:[1,0]
    v_mul_f32 v179, v179, v49
    v_cvt_pk_bf16_f32 v228, v228, v229
    v_accvgpr_read_b32 v56, a28
    v_accvgpr_read_b32 v104, a16
    v_mul_f32 v205, v205, v49
    v_mfma_f32_16x16x32_bf16 v[152:155], a[228:231], v[16:19], v[152:155]
    s_waitcnt lgkmcnt(1)
    buffer_store_dwordx4 v[84:87], v102, s[16:19], s86 offen offset:0 nt
    v_mul_f32 v182, v182, v49
    v_mul_f32 v190, v190, v49
    v_mul_f32 v187, v187, v49
    v_cvt_pk_bf16_f32 v188, v188, v189
    v_cvt_pk_bf16_f32 v132, v132, v133
    v_mul_f32 v56, v56, v51
    v_accvgpr_read_b32 v108, a20
    v_mul_f32 v195, v195, v49
    v_pk_mul_f32 v[154:155], v[154:155], v[48:49] op_sel_hi:[1,0]
    v_mul_f32 v55, v55, v51
    v_cvt_pk_bf16_f32 v185, v186, v187
    v_mul_f32 v191, v191, v49
    v_pk_mul_f32 v[142:143], v[142:143], v[48:49] op_sel_hi:[1,0]
    v_mul_f32 v201, v201, v49
    v_cvt_pk_bf16_f32 v180, v180, v181
    v_cvt_pk_bf16_f32 v248, v248, v249
    v_accvgpr_read_b32 v110, a22
    v_cvt_pk_bf16_f32 v189, v190, v191
    v_mul_f32 v108, v108, v51
    v_accvgpr_read_b32 v109, a21
    v_cvt_pk_bf16_f32 v140, v140, v141
    v_cvt_pk_bf16_f32 v236, v236, v237
    v_mul_f32 v200, v200, v49
    v_mul_f32 v109, v109, v51
    v_pk_mul_f32 v[148:149], v[148:149], v[48:49] op_sel_hi:[1,0]
    v_mul_f32 v198, v198, v49
    v_mul_f32 v52, v52, v51
    v_accvgpr_read_b32 v105, a17
    v_mul_f32 v110, v110, v51
    buffer_store_dwordx4 v[88:91], v103, s[16:19], s86 offen offset:0 nt
    v_accvgpr_read_b32 v106, a18
    v_cvt_pk_bf16_f32 v108, v108, v109
    v_cvt_pk_bf16_f32 v181, v182, v183
    v_cvt_pk_bf16_f32 v133, v134, v135
    v_mul_f32 v199, v199, v49
    v_cvt_pk_bf16_f32 v177, v178, v179
    v_accvgpr_read_b32 v58, a30
    v_cvt_pk_bf16_f32 v229, v230, v231
    v_accvgpr_read_b32 v53, a25
    v_cvt_pk_bf16_f32 v137, v138, v139
    v_cvt_pk_bf16_f32 v224, v224, v225
    v_accvgpr_read_b32 v111, a23
    v_mul_f32 v111, v111, v51
    v_cvt_pk_bf16_f32 v200, v200, v201
    v_mul_f32 v104, v104, v51
    v_mul_f32 v203, v203, v49
    v_cvt_pk_bf16_f32 v232, v232, v233
    v_cvt_pk_bf16_f32 v109, v110, v111
    v_pk_mul_f32 v[152:153], v[152:153], v[48:49] op_sel_hi:[1,0]
    ds_write2st64_b64 v101, v[128:129], v[176:177] offset0:4 offset1:16
    v_mul_f32 v197, v197, v49
    buffer_store_dwordx4 v[60:63], v102, s[16:19], s87 offen offset:0 nt
    ds_write2st64_b64 v92, v[132:133], v[180:181] offset0:4 offset1:16
    v_mul_f32 v53, v53, v51
    v_cvt_pk_bf16_f32 v141, v142, v143
    v_pk_mul_f32 v[156:157], v[156:157], v[48:49] op_sel_hi:[1,0]
    v_pk_mul_f32 v[252:253], v[252:253], v[50:51] op_sel_hi:[1,0]
    ds_write2st64_b64 v93, v[136:137], v[184:185] offset0:4 offset1:16
    v_accvgpr_read_b32 v54, a26
    v_mul_f32 v105, v105, v51
    ds_write2st64_b64 v94, v[140:141], v[188:189] offset0:4 offset1:16
    ds_read_b128 v[68:71], v8 offset:2048
    v_mul_f32 v57, v57, v51
    v_mul_f32 v58, v58, v51
    s_waitcnt lgkmcnt(4)
    buffer_store_dwordx4 v[64:67], v103, s[16:19], s87 offen offset:0 nt
    v_mul_f32 v54, v54, v51
    v_cvt_pk_bf16_f32 v196, v196, v197
    v_pk_mul_f32 v[238:239], v[238:239], v[50:51] op_sel_hi:[1,0]
    s_nop 0
    v_cvt_pk_bf16_f32 v237, v238, v239
    v_mul_f32 v106, v106, v51
    v_cvt_pk_bf16_f32 v56, v56, v57
    ds_read_b128 v[72:75], v8 offset:3072
    v_mul_f32 v206, v206, v49
    v_pk_mul_f32 v[246:247], v[246:247], v[50:51] op_sel_hi:[1,0]
    v_cvt_pk_bf16_f32 v104, v104, v105
    v_cvt_pk_bf16_f32 v145, v146, v147
    v_mul_f32 v193, v193, v49
    v_cvt_pk_bf16_f32 v105, v106, v107
    ds_read_b128 v[76:79], v8 offset:8192
    v_pk_mul_f32 v[234:235], v[234:235], v[50:51] op_sel_hi:[1,0]
    v_mul_f32 v202, v202, v49
    v_cvt_pk_bf16_f32 v204, v204, v205
    v_cvt_pk_bf16_f32 v240, v240, v241
    ds_read_b128 v[80:83], v8 offset:9216
    v_accvgpr_read_b32 v107, a35
    v_cvt_pk_bf16_f32 v225, v226, v227
    s_waitcnt lgkmcnt(3)
    buffer_store_dwordx4 v[68:71], v102, s[16:19], s84 offen offset:128 nt
    ds_write2st64_b64 v101, v[224:225], v[104:105] offset0:28 offset1:40
    v_accvgpr_read_b32 v59, a31
    v_pk_mul_f32 v[244:245], v[244:245], v[50:51] op_sel_hi:[1,0]
    v_mul_f32 v59, v59, v51
    v_cvt_pk_bf16_f32 v252, v252, v253
    v_cvt_pk_bf16_f32 v197, v198, v199
    v_mul_f32 v107, v107, v51
    v_cvt_pk_bf16_f32 v192, v192, v193
    v_cvt_pk_bf16_f32 v52, v52, v53
    v_cvt_pk_bf16_f32 v53, v54, v55
    v_accvgpr_read_b32 v104, a32
    v_mul_f32 v207, v207, v49
    v_cvt_pk_bf16_f32 v205, v206, v207
    ds_write2st64_b64 v92, v[228:229], v[108:109] offset0:28 offset1:40
    s_waitcnt lgkmcnt(3)
    buffer_store_dwordx4 v[72:75], v103, s[16:19], s84 offen offset:128 nt
    v_cvt_pk_bf16_f32 v57, v58, v59
    v_cvt_pk_bf16_f32 v233, v234, v235
    v_accvgpr_read_b32 v58, a46
    ds_write2st64_b64 v93, v[232:233], v[52:53] offset0:28 offset1:40
    v_accvgpr_read_b32 v108, a36
    ds_write2st64_b64 v94, v[236:237], v[56:57] offset0:28 offset1:40
    v_accvgpr_read_b32 v56, a44
    v_mul_f32 v108, v108, v51
    v_accvgpr_read_b32 v59, a47
    v_accvgpr_read_b32 v53, a41
    ds_read_b128 v[84:87], v8 offset:14336
    v_accvgpr_read_b32 v105, a33
    buffer_store_dwordx4 v[76:79], v102, s[16:19], s85 offen offset:128 nt
    v_pk_mul_f32 v[254:255], v[254:255], v[50:51] op_sel_hi:[1,0]
    v_accvgpr_read_b32 v109, a37
    v_mul_f32 v109, v109, v51
    v_cvt_pk_bf16_f32 v148, v148, v149
    v_cvt_pk_bf16_f32 v108, v108, v109
    v_cvt_pk_bf16_f32 v193, v194, v195
    v_mul_f32 v58, v58, v51
    v_cvt_pk_bf16_f32 v152, v152, v153
    v_mul_f32 v59, v59, v51
    v_cvt_pk_bf16_f32 v149, v150, v151
    v_cvt_pk_bf16_f32 v201, v202, v203
    v_mul_f32 v53, v53, v51
    v_cvt_pk_bf16_f32 v244, v244, v245
    v_accvgpr_read_b32 v106, a34
    ds_read_b128 v[88:91], v8 offset:15360
    ds_read_b128 v[60:63], v8 offset:20480
    v_accvgpr_read_b32 v55, a43
    v_accvgpr_read_b32 v52, a40
    v_accvgpr_read_b32 v54, a42
    v_cvt_pk_bf16_f32 v156, v156, v157
    ds_read_b128 v[64:67], v8 offset:21504
    v_cvt_pk_bf16_f32 v157, v158, v159
    s_waitcnt lgkmcnt(4)
    buffer_store_dwordx4 v[80:83], v103, s[16:19], s85 offen offset:128 nt
    ds_write2st64_b64 v101, v[144:145], v[192:193] offset0:8 offset1:20
    v_cvt_pk_bf16_f32 v253, v254, v255
    s_waitcnt lgkmcnt(4)
    buffer_store_dwordx4 v[84:87], v102, s[16:19], s86 offen offset:128 nt
    ds_write2st64_b64 v92, v[148:149], v[196:197] offset0:8 offset1:20
    v_mul_f32 v55, v55, v51
    s_waitcnt lgkmcnt(1)
    buffer_store_dwordx4 v[88:91], v103, s[16:19], s86 offen offset:128 nt
    v_accvgpr_read_b32 v57, a45
    v_accvgpr_read_b32 v111, a39
    v_mul_f32 v52, v52, v51
    v_mul_f32 v106, v106, v51
    v_cvt_pk_bf16_f32 v52, v52, v53
    v_cvt_pk_bf16_f32 v241, v242, v243
    v_accvgpr_read_b32 v110, a38
    v_mul_f32 v57, v57, v51
    v_cvt_pk_bf16_f32 v153, v154, v155
    v_mul_f32 v105, v105, v51
    v_mul_f32 v56, v56, v51
    buffer_store_dwordx4 v[60:63], v102, s[16:19], s87 offen offset:128 nt
    v_mul_f32 v111, v111, v51
    v_mul_f32 v54, v54, v51
    v_mul_f32 v110, v110, v51
    ds_write2st64_b64 v93, v[152:153], v[200:201] offset0:8 offset1:20
    ds_write2st64_b64 v94, v[156:157], v[204:205] offset0:8 offset1:20
    ds_read_b128 v[68:71], v8 offset:4096
    v_cvt_pk_bf16_f32 v56, v56, v57
    buffer_store_dwordx4 v[64:67], v103, s[16:19], s87 offen offset:128 nt
    v_mul_f32 v104, v104, v51
    v_cvt_pk_bf16_f32 v245, v246, v247
    v_cvt_pk_bf16_f32 v104, v104, v105
    v_cvt_pk_bf16_f32 v53, v54, v55
    v_cvt_pk_bf16_f32 v105, v106, v107
    ds_read_b128 v[72:75], v8 offset:5120
    ds_read_b128 v[76:79], v8 offset:10240
    v_cvt_pk_bf16_f32 v57, v58, v59
    v_cvt_pk_bf16_f32 v109, v110, v111
    s_waitcnt lgkmcnt(2)
    buffer_store_dwordx4 v[68:71], v102, s[16:19], s84 offen offset:256 nt
    v_cvt_pk_bf16_f32 v249, v250, v251
    ds_read_b128 v[80:83], v8 offset:11264
    ds_write2st64_b64 v101, v[240:241], v[104:105] offset0:32 offset1:44
    ds_write2st64_b64 v92, v[244:245], v[108:109] offset0:32 offset1:44
    s_waitcnt lgkmcnt(3)
    buffer_store_dwordx4 v[72:75], v103, s[16:19], s84 offen offset:256 nt
    ds_write2st64_b64 v93, v[248:249], v[52:53] offset0:32 offset1:44
    ds_write2st64_b64 v94, v[252:253], v[56:57] offset0:32 offset1:44
    ds_read_b128 v[84:87], v8 offset:16384
    buffer_store_dwordx4 v[76:79], v102, s[16:19], s85 offen offset:256 nt
    ds_read_b128 v[88:91], v8 offset:17408
    s_waitcnt lgkmcnt(4)
    buffer_store_dwordx4 v[80:83], v103, s[16:19], s85 offen offset:256 nt
    ds_read_b128 v[60:63], v8 offset:22528
    s_waitcnt lgkmcnt(2)
    buffer_store_dwordx4 v[84:87], v102, s[16:19], s86 offen offset:256 nt
    ds_read_b128 v[64:67], v8 offset:23552
    s_waitcnt lgkmcnt(2)
    buffer_store_dwordx4 v[88:91], v103, s[16:19], s86 offen offset:256 nt
    s_waitcnt lgkmcnt(1)
    buffer_store_dwordx4 v[60:63], v102, s[16:19], s87 offen offset:256 nt
    s_waitcnt lgkmcnt(0)
    buffer_store_dwordx4 v[64:67], v103, s[16:19], s87 offen offset:256 nt
    s_branch L_fin
L_fin:
    s_waitcnt vmcnt(0)
L_end:
    s_endpgm
L_codeend:
L_rare5_0:
    s_nop 15
    v_mbcnt_lo_u32_b32 v31, -1, 0
    v_mbcnt_hi_u32_b32 v31, -1, v31
    v_and_b32 v30, 15, v31
    v_mul_u32_u24 v30, 384, v30
    v_lshrrev_b32 v31, 4, v31
    v_lshl_add_u32 v30, v31, 4, v30
    s_add_u32 s69, s39, 0
    buffer_load_dwordx4 v[44:47], v30, s[4:7], s69 offen offset:0
    s_waitcnt vmcnt(0)
    v_mfma_f32_16x16x32_bf16 v[104:107], v[44:47], a[96:99], 0
    s_nop 7
    buffer_load_dwordx4 v[44:47], v30, s[4:7], s69 offen offset:64
    s_waitcnt vmcnt(0)
    v_mfma_f32_16x16x32_bf16 v[104:107], v[44:47], a[100:103], v[104:107]
    s_nop 7
    buffer_load_dwordx4 v[44:47], v30, s[4:7], s69 offen offset:128
    s_waitcnt vmcnt(0)
    v_mfma_f32_16x16x32_bf16 v[104:107], v[44:47], a[104:107], v[104:107]
    s_nop 7
    buffer_load_dwordx4 v[44:47], v30, s[4:7], s69 offen offset:192
    s_waitcnt vmcnt(0)
    v_mfma_f32_16x16x32_bf16 v[104:107], v[44:47], a[108:111], v[104:107]
    s_nop 7
    buffer_load_dwordx4 v[44:47], v30, s[4:7], s69 offen offset:256
    s_waitcnt vmcnt(0)
    v_mfma_f32_16x16x32_bf16 v[104:107], v[44:47], a[112:115], v[104:107]
    s_nop 7
    buffer_load_dwordx4 v[44:47], v30, s[4:7], s69 offen offset:320
    s_waitcnt vmcnt(0)
    v_mfma_f32_16x16x32_bf16 v[104:107], v[44:47], a[116:119], v[104:107]
    s_nop 7
    s_add_u32 s69, s39, 6144
    buffer_load_dwordx4 v[44:47], v30, s[4:7], s69 offen offset:0
    s_waitcnt vmcnt(0)
    v_mfma_f32_16x16x32_bf16 v[108:111], v[44:47], a[96:99], 0
    s_nop 7
    buffer_load_dwordx4 v[44:47], v30, s[4:7], s69 offen offset:64
    s_waitcnt vmcnt(0)
    v_mfma_f32_16x16x32_bf16 v[108:111], v[44:47], a[100:103], v[108:111]
    s_nop 7
    buffer_load_dwordx4 v[44:47], v30, s[4:7], s69 offen offset:128
    s_waitcnt vmcnt(0)
    v_mfma_f32_16x16x32_bf16 v[108:111], v[44:47], a[104:107], v[108:111]
    s_nop 7
    buffer_load_dwordx4 v[44:47], v30, s[4:7], s69 offen offset:192
    s_waitcnt vmcnt(0)
    v_mfma_f32_16x16x32_bf16 v[108:111], v[44:47], a[108:111], v[108:111]
    s_nop 7
    buffer_load_dwordx4 v[44:47], v30, s[4:7], s69 offen offset:256
    s_waitcnt vmcnt(0)
    v_mfma_f32_16x16x32_bf16 v[108:111], v[44:47], a[112:115], v[108:111]
    s_nop 7
    buffer_load_dwordx4 v[44:47], v30, s[4:7], s69 offen offset:320
    s_waitcnt vmcnt(0)
    v_mfma_f32_16x16x32_bf16 v[108:111], v[44:47], a[116:119], v[108:111]
    s_nop 7
    s_nop 15
    v_max3_f32 v18, v104, v105, v106
    v_max3_f32 v18, v18, v107, v108
    v_max3_f32 v18, v18, v109, v110
    v_max_f32 v18, v18, v111
    v_mov_b32 v19, v18
    s_nop 1
    v_permlane32_swap_b32 v19, v18
    v_max_f32 v18, v18, v19
    v_mov_b32 v19, v18
    s_nop 1
    v_permlane16_swap_b32 v19, v18
    v_max_f32 v18, v18, v19
    v_fma_f32 v18, v18, s28, v9
    v_max_f32 v24, 0, v18
    v_sub_f32 v9, v9, v24
    v_sub_f32 v25, 0, v24
    v_exp_f32 v25, v25
    s_nop 0
    v_mul_f32 v19, v48, v25
    v_cndmask_b32_e64 v48, v19, v48, s[60:61]
    v_cndmask_b32_e64 v48, v48, 0, s[46:47]
    v_mul_f32 v112, v112, v25
    v_mul_f32 v113, v113, v25
    v_mul_f32 v114, v114, v25
    v_mul_f32 v115, v115, v25
    v_mul_f32 v116, v116, v25
    v_mul_f32 v117, v117, v25
    v_mul_f32 v118, v118, v25
    v_mul_f32 v119, v119, v25
    v_mul_f32 v120, v120, v25
    v_mul_f32 v121, v121, v25
    v_mul_f32 v122, v122, v25
    v_mul_f32 v123, v123, v25
    v_mul_f32 v124, v124, v25
    v_mul_f32 v125, v125, v25
    v_mul_f32 v126, v126, v25
    v_mul_f32 v127, v127, v25
    v_mul_f32 v128, v128, v25
    v_mul_f32 v129, v129, v25
    v_mul_f32 v130, v130, v25
    v_mul_f32 v131, v131, v25
    v_mul_f32 v132, v132, v25
    v_mul_f32 v133, v133, v25
    v_mul_f32 v134, v134, v25
    v_mul_f32 v135, v135, v25
    v_mul_f32 v136, v136, v25
    v_mul_f32 v137, v137, v25
    v_mul_f32 v138, v138, v25
    v_mul_f32 v139, v139, v25
    v_mul_f32 v140, v140, v25
    v_mul_f32 v141, v141, v25
    v_mul_f32 v142, v142, v25
    v_mul_f32 v143, v143, v25
    v_mul_f32 v144, v144, v25
    v_mul_f32 v145, v145, v25
    v_mul_f32 v146, v146, v25
    v_mul_f32 v147, v147, v25
    v_mul_f32 v148, v148, v25
    v_mul_f32 v149, v149, v25
    v_mul_f32 v150, v150, v25
    v_mul_f32 v151, v151, v25
    v_mul_f32 v152, v152, v25
    v_mul_f32 v153, v153, v25
    v_mul_f32 v154, v154, v25
    v_mul_f32 v155, v155, v25
    v_mul_f32 v156, v156, v25
    v_mul_f32 v157, v157, v25
    v_mul_f32 v158, v158, v25
    v_mul_f32 v159, v159, v25
    v_fma_f32 v104, v104, s28, v9
    v_fma_f32 v105, v105, s28, v9
    v_exp_f32 v104, v104
    v_exp_f32 v105, v105
    s_nop 0
    v_cvt_pk_bf16_f32 v14, v104, v105
    v_fma_f32 v106, v106, s28, v9
    v_fma_f32 v107, v107, s28, v9
    v_exp_f32 v106, v106
    v_exp_f32 v107, v107
    s_nop 0
    v_cvt_pk_bf16_f32 v15, v106, v107
    v_fma_f32 v108, v108, s28, v9
    v_fma_f32 v109, v109, s28, v9
    v_exp_f32 v108, v108
    v_exp_f32 v109, v109
    s_nop 0
    v_cvt_pk_bf16_f32 v16, v108, v109
    v_fma_f32 v110, v110, s28, v9
    v_fma_f32 v111, v111, s28, v9
    v_exp_f32 v110, v110
    v_exp_f32 v111, v111
    s_nop 0
    v_cvt_pk_bf16_f32 v17, v110, v111
    s_add_u32 s69, s39, 0
    buffer_load_dwordx4 v[44:47], v30, s[4:7], s69 offen offset:0
    s_waitcnt vmcnt(0)
    v_mfma_f32_16x16x32_bf16 v[104:107], v[44:47], a[120:123], 0
    s_nop 7
    buffer_load_dwordx4 v[44:47], v30, s[4:7], s69 offen offset:64
    s_waitcnt vmcnt(0)
    v_mfma_f32_16x16x32_bf16 v[104:107], v[44:47], a[124:127], v[104:107]
    s_nop 7
    buffer_load_dwordx4 v[44:47], v30, s[4:7], s69 offen offset:128
    s_waitcnt vmcnt(0)
    v_mfma_f32_16x16x32_bf16 v[104:107], v[44:47], a[128:131], v[104:107]
    s_nop 7
    buffer_load_dwordx4 v[44:47], v30, s[4:7], s69 offen offset:192
    s_waitcnt vmcnt(0)
    v_mfma_f32_16x16x32_bf16 v[104:107], v[44:47], a[132:135], v[104:107]
    s_nop 7
    buffer_load_dwordx4 v[44:47], v30, s[4:7], s69 offen offset:256
    s_waitcnt vmcnt(0)
    v_mfma_f32_16x16x32_bf16 v[104:107], v[44:47], a[136:139], v[104:107]
    s_nop 7
    buffer_load_dwordx4 v[44:47], v30, s[4:7], s69 offen offset:320
    s_waitcnt vmcnt(0)
    v_mfma_f32_16x16x32_bf16 v[104:107], v[44:47], a[140:143], v[104:107]
    s_nop 7
    s_add_u32 s69, s39, 6144
    buffer_load_dwordx4 v[44:47], v30, s[4:7], s69 offen offset:0
    s_waitcnt vmcnt(0)
    v_mfma_f32_16x16x32_bf16 v[108:111], v[44:47], a[120:123], 0
    s_nop 7
    buffer_load_dwordx4 v[44:47], v30, s[4:7], s69 offen offset:64
    s_waitcnt vmcnt(0)
    v_mfma_f32_16x16x32_bf16 v[108:111], v[44:47], a[124:127], v[108:111]
    s_nop 7
    buffer_load_dwordx4 v[44:47], v30, s[4:7], s69 offen offset:128
    s_waitcnt vmcnt(0)
    v_mfma_f32_16x16x32_bf16 v[108:111], v[44:47], a[128:131], v[108:111]
    s_nop 7
    buffer_load_dwordx4 v[44:47], v30, s[4:7], s69 offen offset:192
    s_waitcnt vmcnt(0)
    v_mfma_f32_16x16x32_bf16 v[108:111], v[44:47], a[132:135], v[108:111]
    s_nop 7
    buffer_load_dwordx4 v[44:47], v30, s[4:7], s69 offen offset:256
    s_waitcnt vmcnt(0)
    v_mfma_f32_16x16x32_bf16 v[108:111], v[44:47], a[136:139], v[108:111]
    s_nop 7
    buffer_load_dwordx4 v[44:47], v30, s[4:7], s69 offen offset:320
    s_waitcnt vmcnt(0)
    v_mfma_f32_16x16x32_bf16 v[108:111], v[44:47], a[140:143], v[108:111]
    s_nop 7
    s_nop 15
    v_max3_f32 v18, v104, v105, v106
    v_max3_f32 v18, v18, v107, v108
    v_max3_f32 v18, v18, v109, v110
    v_max_f32 v18, v18, v111
    v_mov_b32 v19, v18
    s_nop 1
    v_permlane32_swap_b32 v19, v18
    v_max_f32 v18, v18, v19
    v_mov_b32 v19, v18
    s_nop 1
    v_permlane16_swap_b32 v19, v18
    v_max_f32 v18, v18, v19
    v_fma_f32 v18, v18, s28, v10
    v_max_f32 v24, 0, v18
    v_sub_f32 v10, v10, v24
    v_sub_f32 v25, 0, v24
    v_exp_f32 v25, v25
    s_nop 0
    v_mul_f32 v49, v49, v25
    v_mul_f32 v160, v160, v25
    v_mul_f32 v161, v161, v25
    v_mul_f32 v162, v162, v25
    v_mul_f32 v163, v163, v25
    v_mul_f32 v164, v164, v25
    v_mul_f32 v165, v165, v25
    v_mul_f32 v166, v166, v25
    v_mul_f32 v167, v167, v25
    v_mul_f32 v168, v168, v25
    v_mul_f32 v169, v169, v25
    v_mul_f32 v170, v170, v25
    v_mul_f32 v171, v171, v25
    v_mul_f32 v172, v172, v25
    v_mul_f32 v173, v173, v25
    v_mul_f32 v174, v174, v25
    v_mul_f32 v175, v175, v25
    v_mul_f32 v176, v176, v25
    v_mul_f32 v177, v177, v25
    v_mul_f32 v178, v178, v25
    v_mul_f32 v179, v179, v25
    v_mul_f32 v180, v180, v25
    v_mul_f32 v181, v181, v25
    v_mul_f32 v182, v182, v25
    v_mul_f32 v183, v183, v25
    v_mul_f32 v184, v184, v25
    v_mul_f32 v185, v185, v25
    v_mul_f32 v186, v186, v25
    v_mul_f32 v187, v187, v25
    v_mul_f32 v188, v188, v25
    v_mul_f32 v189, v189, v25
    v_mul_f32 v190, v190, v25
    v_mul_f32 v191, v191, v25
    v_mul_f32 v192, v192, v25
    v_mul_f32 v193, v193, v25
    v_mul_f32 v194, v194, v25
    v_mul_f32 v195, v195, v25
    v_mul_f32 v196, v196, v25
    v_mul_f32 v197, v197, v25
    v_mul_f32 v198, v198, v25
    v_mul_f32 v199, v199, v25
    v_mul_f32 v200, v200, v25
    v_mul_f32 v201, v201, v25
    v_mul_f32 v202, v202, v25
    v_mul_f32 v203, v203, v25
    v_mul_f32 v204, v204, v25
    v_mul_f32 v205, v205, v25
    v_mul_f32 v206, v206, v25
    v_mul_f32 v207, v207, v25
    v_fma_f32 v104, v104, s28, v10
    v_fma_f32 v105, v105, s28, v10
    v_exp_f32 v104, v104
    v_exp_f32 v105, v105
    s_nop 0
    v_cvt_pk_bf16_f32 v20, v104, v105
    v_fma_f32 v106, v106, s28, v10
    v_fma_f32 v107, v107, s28, v10
    v_exp_f32 v106, v106
    v_exp_f32 v107, v107
    s_nop 0
    v_cvt_pk_bf16_f32 v21, v106, v107
    v_fma_f32 v108, v108, s28, v10
    v_fma_f32 v109, v109, s28, v10
    v_exp_f32 v108, v108
    v_exp_f32 v109, v109
    s_nop 0
    v_cvt_pk_bf16_f32 v22, v108, v109
    v_fma_f32 v110, v110, s28, v10
    v_fma_f32 v111, v111, s28, v10
    v_exp_f32 v110, v110
    v_exp_f32 v111, v111
    s_nop 0
    v_cvt_pk_bf16_f32 v23, v110, v111
    s_add_u32 s69, s39, 0
    buffer_load_dwordx4 v[44:47], v30, s[4:7], s69 offen offset:0
    s_waitcnt vmcnt(0)
    v_mfma_f32_16x16x32_bf16 v[104:107], v[44:47], a[144:147], 0
    s_nop 7
    buffer_load_dwordx4 v[44:47], v30, s[4:7], s69 offen offset:64
    s_waitcnt vmcnt(0)
    v_mfma_f32_16x16x32_bf16 v[104:107], v[44:47], a[148:151], v[104:107]
    s_nop 7
    buffer_load_dwordx4 v[44:47], v30, s[4:7], s69 offen offset:128
    s_waitcnt vmcnt(0)
    v_mfma_f32_16x16x32_bf16 v[104:107], v[44:47], a[152:155], v[104:107]
    s_nop 7
    buffer_load_dwordx4 v[44:47], v30, s[4:7], s69 offen offset:192
    s_waitcnt vmcnt(0)
    v_mfma_f32_16x16x32_bf16 v[104:107], v[44:47], a[156:159], v[104:107]
    s_nop 7
    buffer_load_dwordx4 v[44:47], v30, s[4:7], s69 offen offset:256
    s_waitcnt vmcnt(0)
    v_mfma_f32_16x16x32_bf16 v[104:107], v[44:47], a[160:163], v[104:107]
    s_nop 7
    buffer_load_dwordx4 v[44:47], v30, s[4:7], s69 offen offset:320
    s_waitcnt vmcnt(0)
    v_mfma_f32_16x16x32_bf16 v[104:107], v[44:47], a[164:167], v[104:107]
    s_nop 7
    s_add_u32 s69, s39, 6144
    buffer_load_dwordx4 v[44:47], v30, s[4:7], s69 offen offset:0
    s_waitcnt vmcnt(0)
    v_mfma_f32_16x16x32_bf16 v[108:111], v[44:47], a[144:147], 0
    s_nop 7
    buffer_load_dwordx4 v[44:47], v30, s[4:7], s69 offen offset:64
    s_waitcnt vmcnt(0)
    v_mfma_f32_16x16x32_bf16 v[108:111], v[44:47], a[148:151], v[108:111]
    s_nop 7
    buffer_load_dwordx4 v[44:47], v30, s[4:7], s69 offen offset:128
    s_waitcnt vmcnt(0)
    v_mfma_f32_16x16x32_bf16 v[108:111], v[44:47], a[152:155], v[108:111]
    s_nop 7
    buffer_load_dwordx4 v[44:47], v30, s[4:7], s69 offen offset:192
    s_waitcnt vmcnt(0)
    v_mfma_f32_16x16x32_bf16 v[108:111], v[44:47], a[156:159], v[108:111]
    s_nop 7
    buffer_load_dwordx4 v[44:47], v30, s[4:7], s69 offen offset:256
    s_waitcnt vmcnt(0)
    v_mfma_f32_16x16x32_bf16 v[108:111], v[44:47], a[160:163], v[108:111]
    s_nop 7
    buffer_load_dwordx4 v[44:47], v30, s[4:7], s69 offen offset:320
    s_waitcnt vmcnt(0)
    v_mfma_f32_16x16x32_bf16 v[108:111], v[44:47], a[164:167], v[108:111]
    s_nop 7
    s_nop 15
    v_max3_f32 v18, v104, v105, v106
    v_max3_f32 v18, v18, v107, v108
    v_max3_f32 v18, v18, v109, v110
    v_max_f32 v18, v18, v111
    v_mov_b32 v19, v18
    s_nop 1
    v_permlane32_swap_b32 v19, v18
    v_max_f32 v18, v18, v19
    v_mov_b32 v19, v18
    s_nop 1
    v_permlane16_swap_b32 v19, v18
    v_max_f32 v18, v18, v19
    v_fma_f32 v18, v18, s28, v11
    v_max_f32 v24, 0, v18
    v_sub_f32 v11, v11, v24
    v_sub_f32 v25, 0, v24
    v_exp_f32 v25, v25
    s_nop 0
    v_mul_f32 v50, v50, v25
    v_mul_f32 v208, v208, v25
    v_mul_f32 v209, v209, v25
    v_mul_f32 v210, v210, v25
    v_mul_f32 v211, v211, v25
    v_mul_f32 v212, v212, v25
    v_mul_f32 v213, v213, v25
    v_mul_f32 v214, v214, v25
    v_mul_f32 v215, v215, v25
    v_mul_f32 v216, v216, v25
    v_mul_f32 v217, v217, v25
    v_mul_f32 v218, v218, v25
    v_mul_f32 v219, v219, v25
    v_mul_f32 v220, v220, v25
    v_mul_f32 v221, v221, v25
    v_mul_f32 v222, v222, v25
    v_mul_f32 v223, v223, v25
    v_mul_f32 v224, v224, v25
    v_mul_f32 v225, v225, v25
    v_mul_f32 v226, v226, v25
    v_mul_f32 v227, v227, v25
    v_mul_f32 v228, v228, v25
    v_mul_f32 v229, v229, v25
    v_mul_f32 v230, v230, v25
    v_mul_f32 v231, v231, v25
    v_mul_f32 v232, v232, v25
    v_mul_f32 v233, v233, v25
    v_mul_f32 v234, v234, v25
    v_mul_f32 v235, v235, v25
    v_mul_f32 v236, v236, v25
    v_mul_f32 v237, v237, v25
    v_mul_f32 v238, v238, v25
    v_mul_f32 v239, v239, v25
    v_mul_f32 v240, v240, v25
    v_mul_f32 v241, v241, v25
    v_mul_f32 v242, v242, v25
    v_mul_f32 v243, v243, v25
    v_mul_f32 v244, v244, v25
    v_mul_f32 v245, v245, v25
    v_mul_f32 v246, v246, v25
    v_mul_f32 v247, v247, v25
    v_mul_f32 v248, v248, v25
    v_mul_f32 v249, v249, v25
    v_mul_f32 v250, v250, v25
    v_mul_f32 v251, v251, v25
    v_mul_f32 v252, v252, v25
    v_mul_f32 v253, v253, v25
    v_mul_f32 v254, v254, v25
    v_mul_f32 v255, v255, v25
    v_fma_f32 v104, v104, s28, v11
    v_fma_f32 v105, v105, s28, v11
    v_exp_f32 v104, v104
    v_exp_f32 v105, v105
    s_nop 0
    v_cvt_pk_bf16_f32 v26, v104, v105
    v_fma_f32 v106, v106, s28, v11
    v_fma_f32 v107, v107, s28, v11
    v_exp_f32 v106, v106
    v_exp_f32 v107, v107
    s_nop 0
    v_cvt_pk_bf16_f32 v27, v106, v107
    v_fma_f32 v108, v108, s28, v11
    v_fma_f32 v109, v109, s28, v11
    v_exp_f32 v108, v108
    v_exp_f32 v109, v109
    s_nop 0
    v_cvt_pk_bf16_f32 v28, v108, v109
    v_fma_f32 v110, v110, s28, v11
    v_fma_f32 v111, v111, s28, v11
    v_exp_f32 v110, v110
    v_exp_f32 v111, v111
    s_nop 0
    v_cvt_pk_bf16_f32 v29, v110, v111
    s_add_u32 s69, s39, 0
    buffer_load_dwordx4 v[44:47], v30, s[4:7], s69 offen offset:0
    s_waitcnt vmcnt(0)
    v_mfma_f32_16x16x32_bf16 v[104:107], v[44:47], a[168:171], 0
    s_nop 7
    buffer_load_dwordx4 v[44:47], v30, s[4:7], s69 offen offset:64
    s_waitcnt vmcnt(0)
    v_mfma_f32_16x16x32_bf16 v[104:107], v[44:47], a[172:175], v[104:107]
    s_nop 7
    buffer_load_dwordx4 v[44:47], v30, s[4:7], s69 offen offset:128
    s_waitcnt vmcnt(0)
    v_mfma_f32_16x16x32_bf16 v[104:107], v[44:47], a[176:179], v[104:107]
    s_nop 7
    buffer_load_dwordx4 v[44:47], v30, s[4:7], s69 offen offset:192
    s_waitcnt vmcnt(0)
    v_mfma_f32_16x16x32_bf16 v[104:107], v[44:47], a[180:183], v[104:107]
    s_nop 7
    buffer_load_dwordx4 v[44:47], v30, s[4:7], s69 offen offset:256
    s_waitcnt vmcnt(0)
    v_mfma_f32_16x16x32_bf16 v[104:107], v[44:47], a[184:187], v[104:107]
    s_nop 7
    buffer_load_dwordx4 v[44:47], v30, s[4:7], s69 offen offset:320
    s_waitcnt vmcnt(0)
    v_mfma_f32_16x16x32_bf16 v[104:107], v[44:47], a[188:191], v[104:107]
    s_nop 7
    s_add_u32 s69, s39, 6144
    buffer_load_dwordx4 v[44:47], v30, s[4:7], s69 offen offset:0
    s_waitcnt vmcnt(0)
    v_mfma_f32_16x16x32_bf16 v[108:111], v[44:47], a[168:171], 0
    s_nop 7
    buffer_load_dwordx4 v[44:47], v30, s[4:7], s69 offen offset:64
    s_waitcnt vmcnt(0)
    v_mfma_f32_16x16x32_bf16 v[108:111], v[44:47], a[172:175], v[108:111]
    s_nop 7
    buffer_load_dwordx4 v[44:47], v30, s[4:7], s69 offen offset:128
    s_waitcnt vmcnt(0)
    v_mfma_f32_16x16x32_bf16 v[108:111], v[44:47], a[176:179], v[108:111]
    s_nop 7
    buffer_load_dwordx4 v[44:47], v30, s[4:7], s69 offen offset:192
    s_waitcnt vmcnt(0)
    v_mfma_f32_16x16x32_bf16 v[108:111], v[44:47], a[180:183], v[108:111]
    s_nop 7
    buffer_load_dwordx4 v[44:47], v30, s[4:7], s69 offen offset:256
    s_waitcnt vmcnt(0)
    v_mfma_f32_16x16x32_bf16 v[108:111], v[44:47], a[184:187], v[108:111]
    s_nop 7
    buffer_load_dwordx4 v[44:47], v30, s[4:7], s69 offen offset:320
    s_waitcnt vmcnt(0)
    v_mfma_f32_16x16x32_bf16 v[108:111], v[44:47], a[188:191], v[108:111]
    s_nop 7
    s_nop 15
    v_max3_f32 v18, v104, v105, v106
    v_max3_f32 v18, v18, v107, v108
    v_max3_f32 v18, v18, v109, v110
    v_max_f32 v18, v18, v111
    v_mov_b32 v19, v18
    s_nop 1
    v_permlane32_swap_b32 v19, v18
    v_max_f32 v18, v18, v19
    v_mov_b32 v19, v18
    s_nop 1
    v_permlane16_swap_b32 v19, v18
    v_max_f32 v18, v18, v19
    v_fma_f32 v18, v18, s28, v12
    v_max_f32 v24, 0, v18
    v_sub_f32 v12, v12, v24
    v_sub_f32 v25, 0, v24
    v_exp_f32 v25, v25
    s_nop 0
    v_mul_f32 v51, v51, v25
    v_accvgpr_read_b32 v19, a0
    v_mul_f32 v19, v19, v25
    v_accvgpr_write_b32 a0, v19
    v_accvgpr_read_b32 v19, a1
    v_mul_f32 v19, v19, v25
    v_accvgpr_write_b32 a1, v19
    v_accvgpr_read_b32 v19, a2
    v_mul_f32 v19, v19, v25
    v_accvgpr_write_b32 a2, v19
    v_accvgpr_read_b32 v19, a3
    v_mul_f32 v19, v19, v25
    v_accvgpr_write_b32 a3, v19
    v_accvgpr_read_b32 v19, a4
    v_mul_f32 v19, v19, v25
    v_accvgpr_write_b32 a4, v19
    v_accvgpr_read_b32 v19, a5
    v_mul_f32 v19, v19, v25
    v_accvgpr_write_b32 a5, v19
    v_accvgpr_read_b32 v19, a6
    v_mul_f32 v19, v19, v25
    v_accvgpr_write_b32 a6, v19
    v_accvgpr_read_b32 v19, a7
    v_mul_f32 v19, v19, v25
    v_accvgpr_write_b32 a7, v19
    v_accvgpr_read_b32 v19, a8
    v_mul_f32 v19, v19, v25
    v_accvgpr_write_b32 a8, v19
    v_accvgpr_read_b32 v19, a9
    v_mul_f32 v19, v19, v25
    v_accvgpr_write_b32 a9, v19
    v_accvgpr_read_b32 v19, a10
    v_mul_f32 v19, v19, v25
    v_accvgpr_write_b32 a10, v19
    v_accvgpr_read_b32 v19, a11
    v_mul_f32 v19, v19, v25
    v_accvgpr_write_b32 a11, v19
    v_accvgpr_read_b32 v19, a12
    v_mul_f32 v19, v19, v25
    v_accvgpr_write_b32 a12, v19
    v_accvgpr_read_b32 v19, a13
    v_mul_f32 v19, v19, v25
    v_accvgpr_write_b32 a13, v19
    v_accvgpr_read_b32 v19, a14
    v_mul_f32 v19, v19, v25
    v_accvgpr_write_b32 a14, v19
    v_accvgpr_read_b32 v19, a15
    v_mul_f32 v19, v19, v25
    v_accvgpr_write_b32 a15, v19
    v_accvgpr_read_b32 v19, a16
    v_mul_f32 v19, v19, v25
    v_accvgpr_write_b32 a16, v19
    v_accvgpr_read_b32 v19, a17
    v_mul_f32 v19, v19, v25
    v_accvgpr_write_b32 a17, v19
    v_accvgpr_read_b32 v19, a18
    v_mul_f32 v19, v19, v25
    v_accvgpr_write_b32 a18, v19
    v_accvgpr_read_b32 v19, a19
    v_mul_f32 v19, v19, v25
    v_accvgpr_write_b32 a19, v19
    v_accvgpr_read_b32 v19, a20
    v_mul_f32 v19, v19, v25
    v_accvgpr_write_b32 a20, v19
    v_accvgpr_read_b32 v19, a21
    v_mul_f32 v19, v19, v25
    v_accvgpr_write_b32 a21, v19
    v_accvgpr_read_b32 v19, a22
    v_mul_f32 v19, v19, v25
    v_accvgpr_write_b32 a22, v19
    v_accvgpr_read_b32 v19, a23
    v_mul_f32 v19, v19, v25
    v_accvgpr_write_b32 a23, v19
    v_accvgpr_read_b32 v19, a24
    v_mul_f32 v19, v19, v25
    v_accvgpr_write_b32 a24, v19
    v_accvgpr_read_b32 v19, a25
    v_mul_f32 v19, v19, v25
    v_accvgpr_write_b32 a25, v19
    v_accvgpr_read_b32 v19, a26
    v_mul_f32 v19, v19, v25
    v_accvgpr_write_b32 a26, v19
    v_accvgpr_read_b32 v19, a27
    v_mul_f32 v19, v19, v25
    v_accvgpr_write_b32 a27, v19
    v_accvgpr_read_b32 v19, a28
    v_mul_f32 v19, v19, v25
    v_accvgpr_write_b32 a28, v19
    v_accvgpr_read_b32 v19, a29
    v_mul_f32 v19, v19, v25
    v_accvgpr_write_b32 a29, v19
    v_accvgpr_read_b32 v19, a30
    v_mul_f32 v19, v19, v25
    v_accvgpr_write_b32 a30, v19
    v_accvgpr_read_b32 v19, a31
    v_mul_f32 v19, v19, v25
    v_accvgpr_write_b32 a31, v19
    v_accvgpr_read_b32 v19, a32
    v_mul_f32 v19, v19, v25
    v_accvgpr_write_b32 a32, v19
    v_accvgpr_read_b32 v19, a33
    v_mul_f32 v19, v19, v25
    v_accvgpr_write_b32 a33, v19
    v_accvgpr_read_b32 v19, a34
    v_mul_f32 v19, v19, v25
    v_accvgpr_write_b32 a34, v19
    v_accvgpr_read_b32 v19, a35
    v_mul_f32 v19, v19, v25
    v_accvgpr_write_b32 a35, v19
    v_accvgpr_read_b32 v19, a36
    v_mul_f32 v19, v19, v25
    v_accvgpr_write_b32 a36, v19
    v_accvgpr_read_b32 v19, a37
    v_mul_f32 v19, v19, v25
    v_accvgpr_write_b32 a37, v19
    v_accvgpr_read_b32 v19, a38
    v_mul_f32 v19, v19, v25
    v_accvgpr_write_b32 a38, v19
    v_accvgpr_read_b32 v19, a39
    v_mul_f32 v19, v19, v25
    v_accvgpr_write_b32 a39, v19
    v_accvgpr_read_b32 v19, a40
    v_mul_f32 v19, v19, v25
    v_accvgpr_write_b32 a40, v19
    v_accvgpr_read_b32 v19, a41
    v_mul_f32 v19, v19, v25
    v_accvgpr_write_b32 a41, v19
    v_accvgpr_read_b32 v19, a42
    v_mul_f32 v19, v19, v25
    v_accvgpr_write_b32 a42, v19
    v_accvgpr_read_b32 v19, a43
    v_mul_f32 v19, v19, v25
    v_accvgpr_write_b32 a43, v19
    v_accvgpr_read_b32 v19, a44
    v_mul_f32 v19, v19, v25
    v_accvgpr_write_b32 a44, v19
    v_accvgpr_read_b32 v19, a45
    v_mul_f32 v19, v19, v25
    v_accvgpr_write_b32 a45, v19
    v_accvgpr_read_b32 v19, a46
    v_mul_f32 v19, v19, v25
    v_accvgpr_write_b32 a46, v19
    v_accvgpr_read_b32 v19, a47
    v_mul_f32 v19, v19, v25
    v_accvgpr_write_b32 a47, v19
    v_fma_f32 v104, v104, s28, v12
    v_fma_f32 v105, v105, s28, v12
    v_exp_f32 v104, v104
    v_exp_f32 v105, v105
    s_nop 0
    v_cvt_pk_bf16_f32 v32, v104, v105
    v_fma_f32 v106, v106, s28, v12
    v_fma_f32 v107, v107, s28, v12
    v_exp_f32 v106, v106
    v_exp_f32 v107, v107
    s_nop 0
    v_cvt_pk_bf16_f32 v33, v106, v107
    v_fma_f32 v108, v108, s28, v12
    v_fma_f32 v109, v109, s28, v12
    v_exp_f32 v108, v108
    v_exp_f32 v109, v109
    s_nop 0
    v_cvt_pk_bf16_f32 v34, v108, v109
    v_fma_f32 v110, v110, s28, v12
    v_fma_f32 v111, v111, s28, v12
    v_exp_f32 v110, v110
    v_exp_f32 v111, v111
    s_nop 0
    v_cvt_pk_bf16_f32 v35, v110, v111
    s_add_u32 s69, s39, 0
    buffer_load_dwordx4 v[44:47], v30, s[4:7], s69 offen offset:0
    s_waitcnt vmcnt(0)
    v_mfma_f32_16x16x32_bf16 v[104:107], v[44:47], a[192:195], 0
    s_nop 7
    buffer_load_dwordx4 v[44:47], v30, s[4:7], s69 offen offset:64
    s_waitcnt vmcnt(0)
    v_mfma_f32_16x16x32_bf16 v[104:107], v[44:47], a[196:199], v[104:107]
    s_nop 7
    buffer_load_dwordx4 v[44:47], v30, s[4:7], s69 offen offset:128
    s_waitcnt vmcnt(0)
    v_mfma_f32_16x16x32_bf16 v[104:107], v[44:47], a[200:203], v[104:107]
    s_nop 7
    buffer_load_dwordx4 v[44:47], v30, s[4:7], s69 offen offset:192
    s_waitcnt vmcnt(0)
    v_mfma_f32_16x16x32_bf16 v[104:107], v[44:47], a[204:207], v[104:107]
    s_nop 7
    buffer_load_dwordx4 v[44:47], v30, s[4:7], s69 offen offset:256
    s_waitcnt vmcnt(0)
    v_mfma_f32_16x16x32_bf16 v[104:107], v[44:47], a[208:211], v[104:107]
    s_nop 7
    buffer_load_dwordx4 v[44:47], v30, s[4:7], s69 offen offset:320
    s_waitcnt vmcnt(0)
    v_mfma_f32_16x16x32_bf16 v[104:107], v[44:47], v[92:95], v[104:107]
    s_nop 7
    s_add_u32 s69, s39, 6144
    buffer_load_dwordx4 v[44:47], v30, s[4:7], s69 offen offset:0
    s_waitcnt vmcnt(0)
    v_mfma_f32_16x16x32_bf16 v[108:111], v[44:47], a[192:195], 0
    s_nop 7
    buffer_load_dwordx4 v[44:47], v30, s[4:7], s69 offen offset:64
    s_waitcnt vmcnt(0)
    v_mfma_f32_16x16x32_bf16 v[108:111], v[44:47], a[196:199], v[108:111]
    s_nop 7
    buffer_load_dwordx4 v[44:47], v30, s[4:7], s69 offen offset:128
    s_waitcnt vmcnt(0)
    v_mfma_f32_16x16x32_bf16 v[108:111], v[44:47], a[200:203], v[108:111]
    s_nop 7
    buffer_load_dwordx4 v[44:47], v30, s[4:7], s69 offen offset:192
    s_waitcnt vmcnt(0)
    v_mfma_f32_16x16x32_bf16 v[108:111], v[44:47], a[204:207], v[108:111]
    s_nop 7
    buffer_load_dwordx4 v[44:47], v30, s[4:7], s69 offen offset:256
    s_waitcnt vmcnt(0)
    v_mfma_f32_16x16x32_bf16 v[108:111], v[44:47], a[208:211], v[108:111]
    s_nop 7
    buffer_load_dwordx4 v[44:47], v30, s[4:7], s69 offen offset:320
    s_waitcnt vmcnt(0)
    v_mfma_f32_16x16x32_bf16 v[108:111], v[44:47], v[92:95], v[108:111]
    s_nop 7
    s_nop 15
    v_max3_f32 v18, v104, v105, v106
    v_max3_f32 v18, v18, v107, v108
    v_max3_f32 v18, v18, v109, v110
    v_max_f32 v18, v18, v111
    v_mov_b32 v19, v18
    s_nop 1
    v_permlane32_swap_b32 v19, v18
    v_max_f32 v18, v18, v19
    v_mov_b32 v19, v18
    s_nop 1
    v_permlane16_swap_b32 v19, v18
    v_max_f32 v18, v18, v19
    v_fma_f32 v18, v18, s28, v13
    v_max_f32 v24, 0, v18
    v_sub_f32 v13, v13, v24
    v_sub_f32 v25, 0, v24
    v_exp_f32 v25, v25
    s_nop 0
    v_mul_f32 v19, v48, v25
    v_cndmask_b32_e64 v48, v48, v19, s[60:61]
    v_accvgpr_read_b32 v19, a48
    v_mul_f32 v19, v19, v25
    v_accvgpr_write_b32 a48, v19
    v_accvgpr_read_b32 v19, a49
    v_mul_f32 v19, v19, v25
    v_accvgpr_write_b32 a49, v19
    v_accvgpr_read_b32 v19, a50
    v_mul_f32 v19, v19, v25
    v_accvgpr_write_b32 a50, v19
    v_accvgpr_read_b32 v19, a51
    v_mul_f32 v19, v19, v25
    v_accvgpr_write_b32 a51, v19
    v_accvgpr_read_b32 v19, a52
    v_mul_f32 v19, v19, v25
    v_accvgpr_write_b32 a52, v19
    v_accvgpr_read_b32 v19, a53
    v_mul_f32 v19, v19, v25
    v_accvgpr_write_b32 a53, v19
    v_accvgpr_read_b32 v19, a54
    v_mul_f32 v19, v19, v25
    v_accvgpr_write_b32 a54, v19
    v_accvgpr_read_b32 v19, a55
    v_mul_f32 v19, v19, v25
    v_accvgpr_write_b32 a55, v19
    v_accvgpr_read_b32 v19, a56
    v_mul_f32 v19, v19, v25
    v_accvgpr_write_b32 a56, v19
    v_accvgpr_read_b32 v19, a57
    v_mul_f32 v19, v19, v25
    v_accvgpr_write_b32 a57, v19
    v_accvgpr_read_b32 v19, a58
    v_mul_f32 v19, v19, v25
    v_accvgpr_write_b32 a58, v19
    v_accvgpr_read_b32 v19, a59
    v_mul_f32 v19, v19, v25
    v_accvgpr_write_b32 a59, v19
    v_accvgpr_read_b32 v19, a60
    v_mul_f32 v19, v19, v25
    v_accvgpr_write_b32 a60, v19
    v_accvgpr_read_b32 v19, a61
    v_mul_f32 v19, v19, v25
    v_accvgpr_write_b32 a61, v19
    v_accvgpr_read_b32 v19, a62
    v_mul_f32 v19, v19, v25
    v_accvgpr_write_b32 a62, v19
    v_accvgpr_read_b32 v19, a63
    v_mul_f32 v19, v19, v25
    v_accvgpr_write_b32 a63, v19
    v_accvgpr_read_b32 v19, a64
    v_mul_f32 v19, v19, v25
    v_accvgpr_write_b32 a64, v19
    v_accvgpr_read_b32 v19, a65
    v_mul_f32 v19, v19, v25
    v_accvgpr_write_b32 a65, v19
    v_accvgpr_read_b32 v19, a66
    v_mul_f32 v19, v19, v25
    v_accvgpr_write_b32 a66, v19
    v_accvgpr_read_b32 v19, a67
    v_mul_f32 v19, v19, v25
    v_accvgpr_write_b32 a67, v19
    v_accvgpr_read_b32 v19, a68
    v_mul_f32 v19, v19, v25
    v_accvgpr_write_b32 a68, v19
    v_accvgpr_read_b32 v19, a69
    v_mul_f32 v19, v19, v25
    v_accvgpr_write_b32 a69, v19
    v_accvgpr_read_b32 v19, a70
    v_mul_f32 v19, v19, v25
    v_accvgpr_write_b32 a70, v19
    v_accvgpr_read_b32 v19, a71
    v_mul_f32 v19, v19, v25
    v_accvgpr_write_b32 a71, v19
    v_accvgpr_read_b32 v19, a72
    v_mul_f32 v19, v19, v25
    v_accvgpr_write_b32 a72, v19
    v_accvgpr_read_b32 v19, a73
    v_mul_f32 v19, v19, v25
    v_accvgpr_write_b32 a73, v19
    v_accvgpr_read_b32 v19, a74
    v_mul_f32 v19, v19, v25
    v_accvgpr_write_b32 a74, v19
    v_accvgpr_read_b32 v19, a75
    v_mul_f32 v19, v19, v25
    v_accvgpr_write_b32 a75, v19
    v_accvgpr_read_b32 v19, a76
    v_mul_f32 v19, v19, v25
    v_accvgpr_write_b32 a76, v19
    v_accvgpr_read_b32 v19, a77
    v_mul_f32 v19, v19, v25
    v_accvgpr_write_b32 a77, v19
    v_accvgpr_read_b32 v19, a78
    v_mul_f32 v19, v19, v25
    v_accvgpr_write_b32 a78, v19
    v_accvgpr_read_b32 v19, a79
    v_mul_f32 v19, v19, v25
    v_accvgpr_write_b32 a79, v19
    v_accvgpr_read_b32 v19, a80
    v_mul_f32 v19, v19, v25
    v_accvgpr_write_b32 a80, v19
    v_accvgpr_read_b32 v19, a81
    v_mul_f32 v19, v19, v25
    v_accvgpr_write_b32 a81, v19
    v_accvgpr_read_b32 v19, a82
    v_mul_f32 v19, v19, v25
    v_accvgpr_write_b32 a82, v19
    v_accvgpr_read_b32 v19, a83
    v_mul_f32 v19, v19, v25
    v_accvgpr_write_b32 a83, v19
    v_accvgpr_read_b32 v19, a84
    v_mul_f32 v19, v19, v25
    v_accvgpr_write_b32 a84, v19
    v_accvgpr_read_b32 v19, a85
    v_mul_f32 v19, v19, v25
    v_accvgpr_write_b32 a85, v19
    v_accvgpr_read_b32 v19, a86
    v_mul_f32 v19, v19, v25
    v_accvgpr_write_b32 a86, v19
    v_accvgpr_read_b32 v19, a87
    v_mul_f32 v19, v19, v25
    v_accvgpr_write_b32 a87, v19
    v_accvgpr_read_b32 v19, a88
    v_mul_f32 v19, v19, v25
    v_accvgpr_write_b32 a88, v19
    v_accvgpr_read_b32 v19, a89
    v_mul_f32 v19, v19, v25
    v_accvgpr_write_b32 a89, v19
    v_accvgpr_read_b32 v19, a90
    v_mul_f32 v19, v19, v25
    v_accvgpr_write_b32 a90, v19
    v_accvgpr_read_b32 v19, a91
    v_mul_f32 v19, v19, v25
    v_accvgpr_write_b32 a91, v19
    v_accvgpr_read_b32 v19, a92
    v_mul_f32 v19, v19, v25
    v_accvgpr_write_b32 a92, v19
    v_accvgpr_read_b32 v19, a93
    v_mul_f32 v19, v19, v25
    v_accvgpr_write_b32 a93, v19
    v_accvgpr_read_b32 v19, a94
    v_mul_f32 v19, v19, v25
    v_accvgpr_write_b32 a94, v19
    v_accvgpr_read_b32 v19, a95
    v_mul_f32 v19, v19, v25
    v_accvgpr_write_b32 a95, v19
    v_fma_f32 v104, v104, s28, v13
    v_fma_f32 v105, v105, s28, v13
    v_exp_f32 v104, v104
    v_exp_f32 v105, v105
    s_nop 0
    v_cvt_pk_bf16_f32 v38, v104, v105
    v_fma_f32 v106, v106, s28, v13
    v_fma_f32 v107, v107, s28, v13
    v_exp_f32 v106, v106
    v_exp_f32 v107, v107
    s_nop 0
    v_cvt_pk_bf16_f32 v39, v106, v107
    v_fma_f32 v108, v108, s28, v13
    v_fma_f32 v109, v109, s28, v13
    v_exp_f32 v108, v108
    v_exp_f32 v109, v109
    s_nop 0
    v_cvt_pk_bf16_f32 v40, v108, v109
    v_fma_f32 v110, v110, s28, v13
    v_fma_f32 v111, v111, s28, v13
    v_exp_f32 v110, v110
    v_exp_f32 v111, v111
    s_nop 0
    v_cvt_pk_bf16_f32 v41, v110, v111
    v_mfma_f32_16x16x32_bf16 v[44:47], a[236:239], v[14:17], v[48:51]
    v_mfma_f32_16x16x32_bf16 v[44:47], a[240:243], v[20:23], v[44:47]
    v_mfma_f32_16x16x32_bf16 v[44:47], a[244:247], v[26:29], v[44:47]
    v_mfma_f32_16x16x32_bf16 v[44:47], a[248:251], v[32:35], v[44:47]
    v_mfma_f32_16x16x32_bf16 v[44:47], a[252:255], v[38:41], v[44:47]
    s_nop 15
    s_setpc_b64 s[40:41]
L_rare5_1:
    s_nop 15
    v_mbcnt_lo_u32_b32 v27, -1, 0
    v_mbcnt_hi_u32_b32 v27, -1, v27
    v_and_b32 v26, 15, v27
    v_mul_u32_u24 v26, 384, v26
    v_lshrrev_b32 v27, 4, v27
    v_lshl_add_u32 v26, v27, 4, v26
    s_add_u32 s69, s39, 0
    buffer_load_dwordx4 v[48:51], v26, s[4:7], s69 offen offset:0
    s_waitcnt vmcnt(0)
    v_mfma_f32_16x16x32_bf16 v[104:107], v[48:51], a[96:99], 0
    s_nop 7
    buffer_load_dwordx4 v[48:51], v26, s[4:7], s69 offen offset:64
    s_waitcnt vmcnt(0)
    v_mfma_f32_16x16x32_bf16 v[104:107], v[48:51], a[100:103], v[104:107]
    s_nop 7
    buffer_load_dwordx4 v[48:51], v26, s[4:7], s69 offen offset:128
    s_waitcnt vmcnt(0)
    v_mfma_f32_16x16x32_bf16 v[104:107], v[48:51], a[104:107], v[104:107]
    s_nop 7
    buffer_load_dwordx4 v[48:51], v26, s[4:7], s69 offen offset:192
    s_waitcnt vmcnt(0)
    v_mfma_f32_16x16x32_bf16 v[104:107], v[48:51], a[108:111], v[104:107]
    s_nop 7
    buffer_load_dwordx4 v[48:51], v26, s[4:7], s69 offen offset:256
    s_waitcnt vmcnt(0)
    v_mfma_f32_16x16x32_bf16 v[104:107], v[48:51], a[112:115], v[104:107]
    s_nop 7
    buffer_load_dwordx4 v[48:51], v26, s[4:7], s69 offen offset:320
    s_waitcnt vmcnt(0)
    v_mfma_f32_16x16x32_bf16 v[104:107], v[48:51], a[116:119], v[104:107]
    s_nop 7
    s_add_u32 s69, s39, 6144
    buffer_load_dwordx4 v[48:51], v26, s[4:7], s69 offen offset:0
    s_waitcnt vmcnt(0)
    v_mfma_f32_16x16x32_bf16 v[108:111], v[48:51], a[96:99], 0
    s_nop 7
    buffer_load_dwordx4 v[48:51], v26, s[4:7], s69 offen offset:64
    s_waitcnt vmcnt(0)
    v_mfma_f32_16x16x32_bf16 v[108:111], v[48:51], a[100:103], v[108:111]
    s_nop 7
    buffer_load_dwordx4 v[48:51], v26, s[4:7], s69 offen offset:128
    s_waitcnt vmcnt(0)
    v_mfma_f32_16x16x32_bf16 v[108:111], v[48:51], a[104:107], v[108:111]
    s_nop 7
    buffer_load_dwordx4 v[48:51], v26, s[4:7], s69 offen offset:192
    s_waitcnt vmcnt(0)
    v_mfma_f32_16x16x32_bf16 v[108:111], v[48:51], a[108:111], v[108:111]
    s_nop 7
    buffer_load_dwordx4 v[48:51], v26, s[4:7], s69 offen offset:256
    s_waitcnt vmcnt(0)
    v_mfma_f32_16x16x32_bf16 v[108:111], v[48:51], a[112:115], v[108:111]
    s_nop 7
    buffer_load_dwordx4 v[48:51], v26, s[4:7], s69 offen offset:320
    s_waitcnt vmcnt(0)
    v_mfma_f32_16x16x32_bf16 v[108:111], v[48:51], a[116:119], v[108:111]
    s_nop 7
    s_nop 15
    v_max3_f32 v14, v104, v105, v106
    v_max3_f32 v14, v14, v107, v108
    v_max3_f32 v14, v14, v109, v110
    v_max_f32 v14, v14, v111
    v_mov_b32 v15, v14
    s_nop 1
    v_permlane32_swap_b32 v15, v14
    v_max_f32 v14, v14, v15
    v_mov_b32 v15, v14
    s_nop 1
    v_permlane16_swap_b32 v15, v14
    v_max_f32 v14, v14, v15
    v_fma_f32 v14, v14, s28, v9
    v_max_f32 v20, 0, v14
    v_sub_f32 v9, v9, v20
    v_sub_f32 v21, 0, v20
    v_exp_f32 v21, v21
    s_nop 0
    v_mul_f32 v15, v44, v21
    v_cndmask_b32_e64 v44, v15, v44, s[60:61]
    v_cndmask_b32_e64 v44, v44, 0, s[46:47]
    v_mul_f32 v112, v112, v21
    v_mul_f32 v113, v113, v21
    v_mul_f32 v114, v114, v21
    v_mul_f32 v115, v115, v21
    v_mul_f32 v116, v116, v21
    v_mul_f32 v117, v117, v21
    v_mul_f32 v118, v118, v21
    v_mul_f32 v119, v119, v21
    v_mul_f32 v120, v120, v21
    v_mul_f32 v121, v121, v21
    v_mul_f32 v122, v122, v21
    v_mul_f32 v123, v123, v21
    v_mul_f32 v124, v124, v21
    v_mul_f32 v125, v125, v21
    v_mul_f32 v126, v126, v21
    v_mul_f32 v127, v127, v21
    v_mul_f32 v128, v128, v21
    v_mul_f32 v129, v129, v21
    v_mul_f32 v130, v130, v21
    v_mul_f32 v131, v131, v21
    v_mul_f32 v132, v132, v21
    v_mul_f32 v133, v133, v21
    v_mul_f32 v134, v134, v21
    v_mul_f32 v135, v135, v21
    v_mul_f32 v136, v136, v21
    v_mul_f32 v137, v137, v21
    v_mul_f32 v138, v138, v21
    v_mul_f32 v139, v139, v21
    v_mul_f32 v140, v140, v21
    v_mul_f32 v141, v141, v21
    v_mul_f32 v142, v142, v21
    v_mul_f32 v143, v143, v21
    v_mul_f32 v144, v144, v21
    v_mul_f32 v145, v145, v21
    v_mul_f32 v146, v146, v21
    v_mul_f32 v147, v147, v21
    v_mul_f32 v148, v148, v21
    v_mul_f32 v149, v149, v21
    v_mul_f32 v150, v150, v21
    v_mul_f32 v151, v151, v21
    v_mul_f32 v152, v152, v21
    v_mul_f32 v153, v153, v21
    v_mul_f32 v154, v154, v21
    v_mul_f32 v155, v155, v21
    v_mul_f32 v156, v156, v21
    v_mul_f32 v157, v157, v21
    v_mul_f32 v158, v158, v21
    v_mul_f32 v159, v159, v21
    v_fma_f32 v104, v104, s28, v9
    v_fma_f32 v105, v105, s28, v9
    v_exp_f32 v104, v104
    v_exp_f32 v105, v105
    s_nop 0
    v_cvt_pk_bf16_f32 v18, v104, v105
    v_fma_f32 v106, v106, s28, v9
    v_fma_f32 v107, v107, s28, v9
    v_exp_f32 v106, v106
    v_exp_f32 v107, v107
    s_nop 0
    v_cvt_pk_bf16_f32 v19, v106, v107
    v_fma_f32 v108, v108, s28, v9
    v_fma_f32 v109, v109, s28, v9
    v_exp_f32 v108, v108
    v_exp_f32 v109, v109
    s_nop 0
    v_cvt_pk_bf16_f32 v16, v108, v109
    v_fma_f32 v110, v110, s28, v9
    v_fma_f32 v111, v111, s28, v9
    v_exp_f32 v110, v110
    v_exp_f32 v111, v111
    s_nop 0
    v_cvt_pk_bf16_f32 v17, v110, v111
    s_add_u32 s69, s39, 0
    buffer_load_dwordx4 v[48:51], v26, s[4:7], s69 offen offset:0
    s_waitcnt vmcnt(0)
    v_mfma_f32_16x16x32_bf16 v[104:107], v[48:51], a[120:123], 0
    s_nop 7
    buffer_load_dwordx4 v[48:51], v26, s[4:7], s69 offen offset:64
    s_waitcnt vmcnt(0)
    v_mfma_f32_16x16x32_bf16 v[104:107], v[48:51], a[124:127], v[104:107]
    s_nop 7
    buffer_load_dwordx4 v[48:51], v26, s[4:7], s69 offen offset:128
    s_waitcnt vmcnt(0)
    v_mfma_f32_16x16x32_bf16 v[104:107], v[48:51], a[128:131], v[104:107]
    s_nop 7
    buffer_load_dwordx4 v[48:51], v26, s[4:7], s69 offen offset:192
    s_waitcnt vmcnt(0)
    v_mfma_f32_16x16x32_bf16 v[104:107], v[48:51], a[132:135], v[104:107]
    s_nop 7
    buffer_load_dwordx4 v[48:51], v26, s[4:7], s69 offen offset:256
    s_waitcnt vmcnt(0)
    v_mfma_f32_16x16x32_bf16 v[104:107], v[48:51], a[136:139], v[104:107]
    s_nop 7
    buffer_load_dwordx4 v[48:51], v26, s[4:7], s69 offen offset:320
    s_waitcnt vmcnt(0)
    v_mfma_f32_16x16x32_bf16 v[104:107], v[48:51], a[140:143], v[104:107]
    s_nop 7
    s_add_u32 s69, s39, 6144
    buffer_load_dwordx4 v[48:51], v26, s[4:7], s69 offen offset:0
    s_waitcnt vmcnt(0)
    v_mfma_f32_16x16x32_bf16 v[108:111], v[48:51], a[120:123], 0
    s_nop 7
    buffer_load_dwordx4 v[48:51], v26, s[4:7], s69 offen offset:64
    s_waitcnt vmcnt(0)
    v_mfma_f32_16x16x32_bf16 v[108:111], v[48:51], a[124:127], v[108:111]
    s_nop 7
    buffer_load_dwordx4 v[48:51], v26, s[4:7], s69 offen offset:128
    s_waitcnt vmcnt(0)
    v_mfma_f32_16x16x32_bf16 v[108:111], v[48:51], a[128:131], v[108:111]
    s_nop 7
    buffer_load_dwordx4 v[48:51], v26, s[4:7], s69 offen offset:192
    s_waitcnt vmcnt(0)
    v_mfma_f32_16x16x32_bf16 v[108:111], v[48:51], a[132:135], v[108:111]
    s_nop 7
    buffer_load_dwordx4 v[48:51], v26, s[4:7], s69 offen offset:256
    s_waitcnt vmcnt(0)
    v_mfma_f32_16x16x32_bf16 v[108:111], v[48:51], a[136:139], v[108:111]
    s_nop 7
    buffer_load_dwordx4 v[48:51], v26, s[4:7], s69 offen offset:320
    s_waitcnt vmcnt(0)
    v_mfma_f32_16x16x32_bf16 v[108:111], v[48:51], a[140:143], v[108:111]
    s_nop 7
    s_nop 15
    v_max3_f32 v14, v104, v105, v106
    v_max3_f32 v14, v14, v107, v108
    v_max3_f32 v14, v14, v109, v110
    v_max_f32 v14, v14, v111
    v_mov_b32 v15, v14
    s_nop 1
    v_permlane32_swap_b32 v15, v14
    v_max_f32 v14, v14, v15
    v_mov_b32 v15, v14
    s_nop 1
    v_permlane16_swap_b32 v15, v14
    v_max_f32 v14, v14, v15
    v_fma_f32 v14, v14, s28, v10
    v_max_f32 v20, 0, v14
    v_sub_f32 v10, v10, v20
    v_sub_f32 v21, 0, v20
    v_exp_f32 v21, v21
    s_nop 0
    v_mul_f32 v45, v45, v21
    v_mul_f32 v160, v160, v21
    v_mul_f32 v161, v161, v21
    v_mul_f32 v162, v162, v21
    v_mul_f32 v163, v163, v21
    v_mul_f32 v164, v164, v21
    v_mul_f32 v165, v165, v21
    v_mul_f32 v166, v166, v21
    v_mul_f32 v167, v167, v21
    v_mul_f32 v168, v168, v21
    v_mul_f32 v169, v169, v21
    v_mul_f32 v170, v170, v21
    v_mul_f32 v171, v171, v21
    v_mul_f32 v172, v172, v21
    v_mul_f32 v173, v173, v21
    v_mul_f32 v174, v174, v21
    v_mul_f32 v175, v175, v21
    v_mul_f32 v176, v176, v21
    v_mul_f32 v177, v177, v21
    v_mul_f32 v178, v178, v21
    v_mul_f32 v179, v179, v21
    v_mul_f32 v180, v180, v21
    v_mul_f32 v181, v181, v21
    v_mul_f32 v182, v182, v21
    v_mul_f32 v183, v183, v21
    v_mul_f32 v184, v184, v21
    v_mul_f32 v185, v185, v21
    v_mul_f32 v186, v186, v21
    v_mul_f32 v187, v187, v21
    v_mul_f32 v188, v188, v21
    v_mul_f32 v189, v189, v21
    v_mul_f32 v190, v190, v21
    v_mul_f32 v191, v191, v21
    v_mul_f32 v192, v192, v21
    v_mul_f32 v193, v193, v21
    v_mul_f32 v194, v194, v21
    v_mul_f32 v195, v195, v21
    v_mul_f32 v196, v196, v21
    v_mul_f32 v197, v197, v21
    v_mul_f32 v198, v198, v21
    v_mul_f32 v199, v199, v21
    v_mul_f32 v200, v200, v21
    v_mul_f32 v201, v201, v21
    v_mul_f32 v202, v202, v21
    v_mul_f32 v203, v203, v21
    v_mul_f32 v204, v204, v21
    v_mul_f32 v205, v205, v21
    v_mul_f32 v206, v206, v21
    v_mul_f32 v207, v207, v21
    v_fma_f32 v104, v104, s28, v10
    v_fma_f32 v105, v105, s28, v10
    v_exp_f32 v104, v104
    v_exp_f32 v105, v105
    s_nop 0
    v_cvt_pk_bf16_f32 v24, v104, v105
    v_fma_f32 v106, v106, s28, v10
    v_fma_f32 v107, v107, s28, v10
    v_exp_f32 v106, v106
    v_exp_f32 v107, v107
    s_nop 0
    v_cvt_pk_bf16_f32 v25, v106, v107
    v_fma_f32 v108, v108, s28, v10
    v_fma_f32 v109, v109, s28, v10
    v_exp_f32 v108, v108
    v_exp_f32 v109, v109
    s_nop 0
    v_cvt_pk_bf16_f32 v22, v108, v109
    v_fma_f32 v110, v110, s28, v10
    v_fma_f32 v111, v111, s28, v10
    v_exp_f32 v110, v110
    v_exp_f32 v111, v111
    s_nop 0
    v_cvt_pk_bf16_f32 v23, v110, v111
    s_add_u32 s69, s39, 0
    buffer_load_dwordx4 v[48:51], v26, s[4:7], s69 offen offset:0
    s_waitcnt vmcnt(0)
    v_mfma_f32_16x16x32_bf16 v[104:107], v[48:51], a[144:147], 0
    s_nop 7
    buffer_load_dwordx4 v[48:51], v26, s[4:7], s69 offen offset:64
    s_waitcnt vmcnt(0)
    v_mfma_f32_16x16x32_bf16 v[104:107], v[48:51], a[148:151], v[104:107]
    s_nop 7
    buffer_load_dwordx4 v[48:51], v26, s[4:7], s69 offen offset:128
    s_waitcnt vmcnt(0)
    v_mfma_f32_16x16x32_bf16 v[104:107], v[48:51], a[152:155], v[104:107]
    s_nop 7
    buffer_load_dwordx4 v[48:51], v26, s[4:7], s69 offen offset:192
    s_waitcnt vmcnt(0)
    v_mfma_f32_16x16x32_bf16 v[104:107], v[48:51], a[156:159], v[104:107]
    s_nop 7
    buffer_load_dwordx4 v[48:51], v26, s[4:7], s69 offen offset:256
    s_waitcnt vmcnt(0)
    v_mfma_f32_16x16x32_bf16 v[104:107], v[48:51], a[160:163], v[104:107]
    s_nop 7
    buffer_load_dwordx4 v[48:51], v26, s[4:7], s69 offen offset:320
    s_waitcnt vmcnt(0)
    v_mfma_f32_16x16x32_bf16 v[104:107], v[48:51], a[164:167], v[104:107]
    s_nop 7
    s_add_u32 s69, s39, 6144
    buffer_load_dwordx4 v[48:51], v26, s[4:7], s69 offen offset:0
    s_waitcnt vmcnt(0)
    v_mfma_f32_16x16x32_bf16 v[108:111], v[48:51], a[144:147], 0
    s_nop 7
    buffer_load_dwordx4 v[48:51], v26, s[4:7], s69 offen offset:64
    s_waitcnt vmcnt(0)
    v_mfma_f32_16x16x32_bf16 v[108:111], v[48:51], a[148:151], v[108:111]
    s_nop 7
    buffer_load_dwordx4 v[48:51], v26, s[4:7], s69 offen offset:128
    s_waitcnt vmcnt(0)
    v_mfma_f32_16x16x32_bf16 v[108:111], v[48:51], a[152:155], v[108:111]
    s_nop 7
    buffer_load_dwordx4 v[48:51], v26, s[4:7], s69 offen offset:192
    s_waitcnt vmcnt(0)
    v_mfma_f32_16x16x32_bf16 v[108:111], v[48:51], a[156:159], v[108:111]
    s_nop 7
    buffer_load_dwordx4 v[48:51], v26, s[4:7], s69 offen offset:256
    s_waitcnt vmcnt(0)
    v_mfma_f32_16x16x32_bf16 v[108:111], v[48:51], a[160:163], v[108:111]
    s_nop 7
    buffer_load_dwordx4 v[48:51], v26, s[4:7], s69 offen offset:320
    s_waitcnt vmcnt(0)
    v_mfma_f32_16x16x32_bf16 v[108:111], v[48:51], a[164:167], v[108:111]
    s_nop 7
    s_nop 15
    v_max3_f32 v14, v104, v105, v106
    v_max3_f32 v14, v14, v107, v108
    v_max3_f32 v14, v14, v109, v110
    v_max_f32 v14, v14, v111
    v_mov_b32 v15, v14
    s_nop 1
    v_permlane32_swap_b32 v15, v14
    v_max_f32 v14, v14, v15
    v_mov_b32 v15, v14
    s_nop 1
    v_permlane16_swap_b32 v15, v14
    v_max_f32 v14, v14, v15
    v_fma_f32 v14, v14, s28, v11
    v_max_f32 v20, 0, v14
    v_sub_f32 v11, v11, v20
    v_sub_f32 v21, 0, v20
    v_exp_f32 v21, v21
    s_nop 0
    v_mul_f32 v46, v46, v21
    v_mul_f32 v208, v208, v21
    v_mul_f32 v209, v209, v21
    v_mul_f32 v210, v210, v21
    v_mul_f32 v211, v211, v21
    v_mul_f32 v212, v212, v21
    v_mul_f32 v213, v213, v21
    v_mul_f32 v214, v214, v21
    v_mul_f32 v215, v215, v21
    v_mul_f32 v216, v216, v21
    v_mul_f32 v217, v217, v21
    v_mul_f32 v218, v218, v21
    v_mul_f32 v219, v219, v21
    v_mul_f32 v220, v220, v21
    v_mul_f32 v221, v221, v21
    v_mul_f32 v222, v222, v21
    v_mul_f32 v223, v223, v21
    v_mul_f32 v224, v224, v21
    v_mul_f32 v225, v225, v21
    v_mul_f32 v226, v226, v21
    v_mul_f32 v227, v227, v21
    v_mul_f32 v228, v228, v21
    v_mul_f32 v229, v229, v21
    v_mul_f32 v230, v230, v21
    v_mul_f32 v231, v231, v21
    v_mul_f32 v232, v232, v21
    v_mul_f32 v233, v233, v21
    v_mul_f32 v234, v234, v21
    v_mul_f32 v235, v235, v21
    v_mul_f32 v236, v236, v21
    v_mul_f32 v237, v237, v21
    v_mul_f32 v238, v238, v21
    v_mul_f32 v239, v239, v21
    v_mul_f32 v240, v240, v21
    v_mul_f32 v241, v241, v21
    v_mul_f32 v242, v242, v21
    v_mul_f32 v243, v243, v21
    v_mul_f32 v244, v244, v21
    v_mul_f32 v245, v245, v21
    v_mul_f32 v246, v246, v21
    v_mul_f32 v247, v247, v21
    v_mul_f32 v248, v248, v21
    v_mul_f32 v249, v249, v21
    v_mul_f32 v250, v250, v21
    v_mul_f32 v251, v251, v21
    v_mul_f32 v252, v252, v21
    v_mul_f32 v253, v253, v21
    v_mul_f32 v254, v254, v21
    v_mul_f32 v255, v255, v21
    v_fma_f32 v104, v104, s28, v11
    v_fma_f32 v105, v105, s28, v11
    v_exp_f32 v104, v104
    v_exp_f32 v105, v105
    s_nop 0
    v_cvt_pk_bf16_f32 v30, v104, v105
    v_fma_f32 v106, v106, s28, v11
    v_fma_f32 v107, v107, s28, v11
    v_exp_f32 v106, v106
    v_exp_f32 v107, v107
    s_nop 0
    v_cvt_pk_bf16_f32 v31, v106, v107
    v_fma_f32 v108, v108, s28, v11
    v_fma_f32 v109, v109, s28, v11
    v_exp_f32 v108, v108
    v_exp_f32 v109, v109
    s_nop 0
    v_cvt_pk_bf16_f32 v28, v108, v109
    v_fma_f32 v110, v110, s28, v11
    v_fma_f32 v111, v111, s28, v11
    v_exp_f32 v110, v110
    v_exp_f32 v111, v111
    s_nop 0
    v_cvt_pk_bf16_f32 v29, v110, v111
    s_add_u32 s69, s39, 0
    buffer_load_dwordx4 v[48:51], v26, s[4:7], s69 offen offset:0
    s_waitcnt vmcnt(0)
    v_mfma_f32_16x16x32_bf16 v[104:107], v[48:51], a[168:171], 0
    s_nop 7
    buffer_load_dwordx4 v[48:51], v26, s[4:7], s69 offen offset:64
    s_waitcnt vmcnt(0)
    v_mfma_f32_16x16x32_bf16 v[104:107], v[48:51], a[172:175], v[104:107]
    s_nop 7
    buffer_load_dwordx4 v[48:51], v26, s[4:7], s69 offen offset:128
    s_waitcnt vmcnt(0)
    v_mfma_f32_16x16x32_bf16 v[104:107], v[48:51], a[176:179], v[104:107]
    s_nop 7
    buffer_load_dwordx4 v[48:51], v26, s[4:7], s69 offen offset:192
    s_waitcnt vmcnt(0)
    v_mfma_f32_16x16x32_bf16 v[104:107], v[48:51], a[180:183], v[104:107]
    s_nop 7
    buffer_load_dwordx4 v[48:51], v26, s[4:7], s69 offen offset:256
    s_waitcnt vmcnt(0)
    v_mfma_f32_16x16x32_bf16 v[104:107], v[48:51], a[184:187], v[104:107]
    s_nop 7
    buffer_load_dwordx4 v[48:51], v26, s[4:7], s69 offen offset:320
    s_waitcnt vmcnt(0)
    v_mfma_f32_16x16x32_bf16 v[104:107], v[48:51], a[188:191], v[104:107]
    s_nop 7
    s_add_u32 s69, s39, 6144
    buffer_load_dwordx4 v[48:51], v26, s[4:7], s69 offen offset:0
    s_waitcnt vmcnt(0)
    v_mfma_f32_16x16x32_bf16 v[108:111], v[48:51], a[168:171], 0
    s_nop 7
    buffer_load_dwordx4 v[48:51], v26, s[4:7], s69 offen offset:64
    s_waitcnt vmcnt(0)
    v_mfma_f32_16x16x32_bf16 v[108:111], v[48:51], a[172:175], v[108:111]
    s_nop 7
    buffer_load_dwordx4 v[48:51], v26, s[4:7], s69 offen offset:128
    s_waitcnt vmcnt(0)
    v_mfma_f32_16x16x32_bf16 v[108:111], v[48:51], a[176:179], v[108:111]
    s_nop 7
    buffer_load_dwordx4 v[48:51], v26, s[4:7], s69 offen offset:192
    s_waitcnt vmcnt(0)
    v_mfma_f32_16x16x32_bf16 v[108:111], v[48:51], a[180:183], v[108:111]
    s_nop 7
    buffer_load_dwordx4 v[48:51], v26, s[4:7], s69 offen offset:256
    s_waitcnt vmcnt(0)
    v_mfma_f32_16x16x32_bf16 v[108:111], v[48:51], a[184:187], v[108:111]
    s_nop 7
    buffer_load_dwordx4 v[48:51], v26, s[4:7], s69 offen offset:320
    s_waitcnt vmcnt(0)
    v_mfma_f32_16x16x32_bf16 v[108:111], v[48:51], a[188:191], v[108:111]
    s_nop 7
    s_nop 15
    v_max3_f32 v14, v104, v105, v106
    v_max3_f32 v14, v14, v107, v108
    v_max3_f32 v14, v14, v109, v110
    v_max_f32 v14, v14, v111
    v_mov_b32 v15, v14
    s_nop 1
    v_permlane32_swap_b32 v15, v14
    v_max_f32 v14, v14, v15
    v_mov_b32 v15, v14
    s_nop 1
    v_permlane16_swap_b32 v15, v14
    v_max_f32 v14, v14, v15
    v_fma_f32 v14, v14, s28, v12
    v_max_f32 v20, 0, v14
    v_sub_f32 v12, v12, v20
    v_sub_f32 v21, 0, v20
    v_exp_f32 v21, v21
    s_nop 0
    v_mul_f32 v47, v47, v21
    v_accvgpr_read_b32 v15, a0
    v_mul_f32 v15, v15, v21
    v_accvgpr_write_b32 a0, v15
    v_accvgpr_read_b32 v15, a1
    v_mul_f32 v15, v15, v21
    v_accvgpr_write_b32 a1, v15
    v_accvgpr_read_b32 v15, a2
    v_mul_f32 v15, v15, v21
    v_accvgpr_write_b32 a2, v15
    v_accvgpr_read_b32 v15, a3
    v_mul_f32 v15, v15, v21
    v_accvgpr_write_b32 a3, v15
    v_accvgpr_read_b32 v15, a4
    v_mul_f32 v15, v15, v21
    v_accvgpr_write_b32 a4, v15
    v_accvgpr_read_b32 v15, a5
    v_mul_f32 v15, v15, v21
    v_accvgpr_write_b32 a5, v15
    v_accvgpr_read_b32 v15, a6
    v_mul_f32 v15, v15, v21
    v_accvgpr_write_b32 a6, v15
    v_accvgpr_read_b32 v15, a7
    v_mul_f32 v15, v15, v21
    v_accvgpr_write_b32 a7, v15
    v_accvgpr_read_b32 v15, a8
    v_mul_f32 v15, v15, v21
    v_accvgpr_write_b32 a8, v15
    v_accvgpr_read_b32 v15, a9
    v_mul_f32 v15, v15, v21
    v_accvgpr_write_b32 a9, v15
    v_accvgpr_read_b32 v15, a10
    v_mul_f32 v15, v15, v21
    v_accvgpr_write_b32 a10, v15
    v_accvgpr_read_b32 v15, a11
    v_mul_f32 v15, v15, v21
    v_accvgpr_write_b32 a11, v15
    v_accvgpr_read_b32 v15, a12
    v_mul_f32 v15, v15, v21
    v_accvgpr_write_b32 a12, v15
    v_accvgpr_read_b32 v15, a13
    v_mul_f32 v15, v15, v21
    v_accvgpr_write_b32 a13, v15
    v_accvgpr_read_b32 v15, a14
    v_mul_f32 v15, v15, v21
    v_accvgpr_write_b32 a14, v15
    v_accvgpr_read_b32 v15, a15
    v_mul_f32 v15, v15, v21
    v_accvgpr_write_b32 a15, v15
    v_accvgpr_read_b32 v15, a16
    v_mul_f32 v15, v15, v21
    v_accvgpr_write_b32 a16, v15
    v_accvgpr_read_b32 v15, a17
    v_mul_f32 v15, v15, v21
    v_accvgpr_write_b32 a17, v15
    v_accvgpr_read_b32 v15, a18
    v_mul_f32 v15, v15, v21
    v_accvgpr_write_b32 a18, v15
    v_accvgpr_read_b32 v15, a19
    v_mul_f32 v15, v15, v21
    v_accvgpr_write_b32 a19, v15
    v_accvgpr_read_b32 v15, a20
    v_mul_f32 v15, v15, v21
    v_accvgpr_write_b32 a20, v15
    v_accvgpr_read_b32 v15, a21
    v_mul_f32 v15, v15, v21
    v_accvgpr_write_b32 a21, v15
    v_accvgpr_read_b32 v15, a22
    v_mul_f32 v15, v15, v21
    v_accvgpr_write_b32 a22, v15
    v_accvgpr_read_b32 v15, a23
    v_mul_f32 v15, v15, v21
    v_accvgpr_write_b32 a23, v15
    v_accvgpr_read_b32 v15, a24
    v_mul_f32 v15, v15, v21
    v_accvgpr_write_b32 a24, v15
    v_accvgpr_read_b32 v15, a25
    v_mul_f32 v15, v15, v21
    v_accvgpr_write_b32 a25, v15
    v_accvgpr_read_b32 v15, a26
    v_mul_f32 v15, v15, v21
    v_accvgpr_write_b32 a26, v15
    v_accvgpr_read_b32 v15, a27
    v_mul_f32 v15, v15, v21
    v_accvgpr_write_b32 a27, v15
    v_accvgpr_read_b32 v15, a28
    v_mul_f32 v15, v15, v21
    v_accvgpr_write_b32 a28, v15
    v_accvgpr_read_b32 v15, a29
    v_mul_f32 v15, v15, v21
    v_accvgpr_write_b32 a29, v15
    v_accvgpr_read_b32 v15, a30
    v_mul_f32 v15, v15, v21
    v_accvgpr_write_b32 a30, v15
    v_accvgpr_read_b32 v15, a31
    v_mul_f32 v15, v15, v21
    v_accvgpr_write_b32 a31, v15
    v_accvgpr_read_b32 v15, a32
    v_mul_f32 v15, v15, v21
    v_accvgpr_write_b32 a32, v15
    v_accvgpr_read_b32 v15, a33
    v_mul_f32 v15, v15, v21
    v_accvgpr_write_b32 a33, v15
    v_accvgpr_read_b32 v15, a34
    v_mul_f32 v15, v15, v21
    v_accvgpr_write_b32 a34, v15
    v_accvgpr_read_b32 v15, a35
    v_mul_f32 v15, v15, v21
    v_accvgpr_write_b32 a35, v15
    v_accvgpr_read_b32 v15, a36
    v_mul_f32 v15, v15, v21
    v_accvgpr_write_b32 a36, v15
    v_accvgpr_read_b32 v15, a37
    v_mul_f32 v15, v15, v21
    v_accvgpr_write_b32 a37, v15
    v_accvgpr_read_b32 v15, a38
    v_mul_f32 v15, v15, v21
    v_accvgpr_write_b32 a38, v15
    v_accvgpr_read_b32 v15, a39
    v_mul_f32 v15, v15, v21
    v_accvgpr_write_b32 a39, v15
    v_accvgpr_read_b32 v15, a40
    v_mul_f32 v15, v15, v21
    v_accvgpr_write_b32 a40, v15
    v_accvgpr_read_b32 v15, a41
    v_mul_f32 v15, v15, v21
    v_accvgpr_write_b32 a41, v15
    v_accvgpr_read_b32 v15, a42
    v_mul_f32 v15, v15, v21
    v_accvgpr_write_b32 a42, v15
    v_accvgpr_read_b32 v15, a43
    v_mul_f32 v15, v15, v21
    v_accvgpr_write_b32 a43, v15
    v_accvgpr_read_b32 v15, a44
    v_mul_f32 v15, v15, v21
    v_accvgpr_write_b32 a44, v15
    v_accvgpr_read_b32 v15, a45
    v_mul_f32 v15, v15, v21
    v_accvgpr_write_b32 a45, v15
    v_accvgpr_read_b32 v15, a46
    v_mul_f32 v15, v15, v21
    v_accvgpr_write_b32 a46, v15
    v_accvgpr_read_b32 v15, a47
    v_mul_f32 v15, v15, v21
    v_accvgpr_write_b32 a47, v15
    v_fma_f32 v104, v104, s28, v12
    v_fma_f32 v105, v105, s28, v12
    v_exp_f32 v104, v104
    v_exp_f32 v105, v105
    s_nop 0
    v_cvt_pk_bf16_f32 v36, v104, v105
    v_fma_f32 v106, v106, s28, v12
    v_fma_f32 v107, v107, s28, v12
    v_exp_f32 v106, v106
    v_exp_f32 v107, v107
    s_nop 0
    v_cvt_pk_bf16_f32 v37, v106, v107
    v_fma_f32 v108, v108, s28, v12
    v_fma_f32 v109, v109, s28, v12
    v_exp_f32 v108, v108
    v_exp_f32 v109, v109
    s_nop 0
    v_cvt_pk_bf16_f32 v34, v108, v109
    v_fma_f32 v110, v110, s28, v12
    v_fma_f32 v111, v111, s28, v12
    v_exp_f32 v110, v110
    v_exp_f32 v111, v111
    s_nop 0
    v_cvt_pk_bf16_f32 v35, v110, v111
    s_add_u32 s69, s39, 0
    buffer_load_dwordx4 v[48:51], v26, s[4:7], s69 offen offset:0
    s_waitcnt vmcnt(0)
    v_mfma_f32_16x16x32_bf16 v[104:107], v[48:51], a[192:195], 0
    s_nop 7
    buffer_load_dwordx4 v[48:51], v26, s[4:7], s69 offen offset:64
    s_waitcnt vmcnt(0)
    v_mfma_f32_16x16x32_bf16 v[104:107], v[48:51], a[196:199], v[104:107]
    s_nop 7
    buffer_load_dwordx4 v[48:51], v26, s[4:7], s69 offen offset:128
    s_waitcnt vmcnt(0)
    v_mfma_f32_16x16x32_bf16 v[104:107], v[48:51], a[200:203], v[104:107]
    s_nop 7
    buffer_load_dwordx4 v[48:51], v26, s[4:7], s69 offen offset:192
    s_waitcnt vmcnt(0)
    v_mfma_f32_16x16x32_bf16 v[104:107], v[48:51], a[204:207], v[104:107]
    s_nop 7
    buffer_load_dwordx4 v[48:51], v26, s[4:7], s69 offen offset:256
    s_waitcnt vmcnt(0)
    v_mfma_f32_16x16x32_bf16 v[104:107], v[48:51], a[208:211], v[104:107]
    s_nop 7
    buffer_load_dwordx4 v[48:51], v26, s[4:7], s69 offen offset:320
    s_waitcnt vmcnt(0)
    v_mfma_f32_16x16x32_bf16 v[104:107], v[48:51], v[92:95], v[104:107]
    s_nop 7
    s_add_u32 s69, s39, 6144
    buffer_load_dwordx4 v[48:51], v26, s[4:7], s69 offen offset:0
    s_waitcnt vmcnt(0)
    v_mfma_f32_16x16x32_bf16 v[108:111], v[48:51], a[192:195], 0
    s_nop 7
    buffer_load_dwordx4 v[48:51], v26, s[4:7], s69 offen offset:64
    s_waitcnt vmcnt(0)
    v_mfma_f32_16x16x32_bf16 v[108:111], v[48:51], a[196:199], v[108:111]
    s_nop 7
    buffer_load_dwordx4 v[48:51], v26, s[4:7], s69 offen offset:128
    s_waitcnt vmcnt(0)
    v_mfma_f32_16x16x32_bf16 v[108:111], v[48:51], a[200:203], v[108:111]
    s_nop 7
    buffer_load_dwordx4 v[48:51], v26, s[4:7], s69 offen offset:192
    s_waitcnt vmcnt(0)
    v_mfma_f32_16x16x32_bf16 v[108:111], v[48:51], a[204:207], v[108:111]
    s_nop 7
    buffer_load_dwordx4 v[48:51], v26, s[4:7], s69 offen offset:256
    s_waitcnt vmcnt(0)
    v_mfma_f32_16x16x32_bf16 v[108:111], v[48:51], a[208:211], v[108:111]
    s_nop 7
    buffer_load_dwordx4 v[48:51], v26, s[4:7], s69 offen offset:320
    s_waitcnt vmcnt(0)
    v_mfma_f32_16x16x32_bf16 v[108:111], v[48:51], v[92:95], v[108:111]
    s_nop 7
    s_nop 15
    v_max3_f32 v14, v104, v105, v106
    v_max3_f32 v14, v14, v107, v108
    v_max3_f32 v14, v14, v109, v110
    v_max_f32 v14, v14, v111
    v_mov_b32 v15, v14
    s_nop 1
    v_permlane32_swap_b32 v15, v14
    v_max_f32 v14, v14, v15
    v_mov_b32 v15, v14
    s_nop 1
    v_permlane16_swap_b32 v15, v14
    v_max_f32 v14, v14, v15
    v_fma_f32 v14, v14, s28, v13
    v_max_f32 v20, 0, v14
    v_sub_f32 v13, v13, v20
    v_sub_f32 v21, 0, v20
    v_exp_f32 v21, v21
    s_nop 0
    v_mul_f32 v15, v44, v21
    v_cndmask_b32_e64 v44, v44, v15, s[60:61]
    v_accvgpr_read_b32 v15, a48
    v_mul_f32 v15, v15, v21
    v_accvgpr_write_b32 a48, v15
    v_accvgpr_read_b32 v15, a49
    v_mul_f32 v15, v15, v21
    v_accvgpr_write_b32 a49, v15
    v_accvgpr_read_b32 v15, a50
    v_mul_f32 v15, v15, v21
    v_accvgpr_write_b32 a50, v15
    v_accvgpr_read_b32 v15, a51
    v_mul_f32 v15, v15, v21
    v_accvgpr_write_b32 a51, v15
    v_accvgpr_read_b32 v15, a52
    v_mul_f32 v15, v15, v21
    v_accvgpr_write_b32 a52, v15
    v_accvgpr_read_b32 v15, a53
    v_mul_f32 v15, v15, v21
    v_accvgpr_write_b32 a53, v15
    v_accvgpr_read_b32 v15, a54
    v_mul_f32 v15, v15, v21
    v_accvgpr_write_b32 a54, v15
    v_accvgpr_read_b32 v15, a55
    v_mul_f32 v15, v15, v21
    v_accvgpr_write_b32 a55, v15
    v_accvgpr_read_b32 v15, a56
    v_mul_f32 v15, v15, v21
    v_accvgpr_write_b32 a56, v15
    v_accvgpr_read_b32 v15, a57
    v_mul_f32 v15, v15, v21
    v_accvgpr_write_b32 a57, v15
    v_accvgpr_read_b32 v15, a58
    v_mul_f32 v15, v15, v21
    v_accvgpr_write_b32 a58, v15
    v_accvgpr_read_b32 v15, a59
    v_mul_f32 v15, v15, v21
    v_accvgpr_write_b32 a59, v15
    v_accvgpr_read_b32 v15, a60
    v_mul_f32 v15, v15, v21
    v_accvgpr_write_b32 a60, v15
    v_accvgpr_read_b32 v15, a61
    v_mul_f32 v15, v15, v21
    v_accvgpr_write_b32 a61, v15
    v_accvgpr_read_b32 v15, a62
    v_mul_f32 v15, v15, v21
    v_accvgpr_write_b32 a62, v15
    v_accvgpr_read_b32 v15, a63
    v_mul_f32 v15, v15, v21
    v_accvgpr_write_b32 a63, v15
    v_accvgpr_read_b32 v15, a64
    v_mul_f32 v15, v15, v21
    v_accvgpr_write_b32 a64, v15
    v_accvgpr_read_b32 v15, a65
    v_mul_f32 v15, v15, v21
    v_accvgpr_write_b32 a65, v15
    v_accvgpr_read_b32 v15, a66
    v_mul_f32 v15, v15, v21
    v_accvgpr_write_b32 a66, v15
    v_accvgpr_read_b32 v15, a67
    v_mul_f32 v15, v15, v21
    v_accvgpr_write_b32 a67, v15
    v_accvgpr_read_b32 v15, a68
    v_mul_f32 v15, v15, v21
    v_accvgpr_write_b32 a68, v15
    v_accvgpr_read_b32 v15, a69
    v_mul_f32 v15, v15, v21
    v_accvgpr_write_b32 a69, v15
    v_accvgpr_read_b32 v15, a70
    v_mul_f32 v15, v15, v21
    v_accvgpr_write_b32 a70, v15
    v_accvgpr_read_b32 v15, a71
    v_mul_f32 v15, v15, v21
    v_accvgpr_write_b32 a71, v15
    v_accvgpr_read_b32 v15, a72
    v_mul_f32 v15, v15, v21
    v_accvgpr_write_b32 a72, v15
    v_accvgpr_read_b32 v15, a73
    v_mul_f32 v15, v15, v21
    v_accvgpr_write_b32 a73, v15
    v_accvgpr_read_b32 v15, a74
    v_mul_f32 v15, v15, v21
    v_accvgpr_write_b32 a74, v15
    v_accvgpr_read_b32 v15, a75
    v_mul_f32 v15, v15, v21
    v_accvgpr_write_b32 a75, v15
    v_accvgpr_read_b32 v15, a76
    v_mul_f32 v15, v15, v21
    v_accvgpr_write_b32 a76, v15
    v_accvgpr_read_b32 v15, a77
    v_mul_f32 v15, v15, v21
    v_accvgpr_write_b32 a77, v15
    v_accvgpr_read_b32 v15, a78
    v_mul_f32 v15, v15, v21
    v_accvgpr_write_b32 a78, v15
    v_accvgpr_read_b32 v15, a79
    v_mul_f32 v15, v15, v21
    v_accvgpr_write_b32 a79, v15
    v_accvgpr_read_b32 v15, a80
    v_mul_f32 v15, v15, v21
    v_accvgpr_write_b32 a80, v15
    v_accvgpr_read_b32 v15, a81
    v_mul_f32 v15, v15, v21
    v_accvgpr_write_b32 a81, v15
    v_accvgpr_read_b32 v15, a82
    v_mul_f32 v15, v15, v21
    v_accvgpr_write_b32 a82, v15
    v_accvgpr_read_b32 v15, a83
    v_mul_f32 v15, v15, v21
    v_accvgpr_write_b32 a83, v15
    v_accvgpr_read_b32 v15, a84
    v_mul_f32 v15, v15, v21
    v_accvgpr_write_b32 a84, v15
    v_accvgpr_read_b32 v15, a85
    v_mul_f32 v15, v15, v21
    v_accvgpr_write_b32 a85, v15
    v_accvgpr_read_b32 v15, a86
    v_mul_f32 v15, v15, v21
    v_accvgpr_write_b32 a86, v15
    v_accvgpr_read_b32 v15, a87
    v_mul_f32 v15, v15, v21
    v_accvgpr_write_b32 a87, v15
    v_accvgpr_read_b32 v15, a88
    v_mul_f32 v15, v15, v21
    v_accvgpr_write_b32 a88, v15
    v_accvgpr_read_b32 v15, a89
    v_mul_f32 v15, v15, v21
    v_accvgpr_write_b32 a89, v15
    v_accvgpr_read_b32 v15, a90
    v_mul_f32 v15, v15, v21
    v_accvgpr_write_b32 a90, v15
    v_accvgpr_read_b32 v15, a91
    v_mul_f32 v15, v15, v21
    v_accvgpr_write_b32 a91, v15
    v_accvgpr_read_b32 v15, a92
    v_mul_f32 v15, v15, v21
    v_accvgpr_write_b32 a92, v15
    v_accvgpr_read_b32 v15, a93
    v_mul_f32 v15, v15, v21
    v_accvgpr_write_b32 a93, v15
    v_accvgpr_read_b32 v15, a94
    v_mul_f32 v15, v15, v21
    v_accvgpr_write_b32 a94, v15
    v_accvgpr_read_b32 v15, a95
    v_mul_f32 v15, v15, v21
    v_accvgpr_write_b32 a95, v15
    v_fma_f32 v104, v104, s28, v13
    v_fma_f32 v105, v105, s28, v13
    v_exp_f32 v104, v104
    v_exp_f32 v105, v105
    s_nop 0
    v_cvt_pk_bf16_f32 v42, v104, v105
    v_fma_f32 v106, v106, s28, v13
    v_fma_f32 v107, v107, s28, v13
    v_exp_f32 v106, v106
    v_exp_f32 v107, v107
    s_nop 0
    v_cvt_pk_bf16_f32 v43, v106, v107
    v_fma_f32 v108, v108, s28, v13
    v_fma_f32 v109, v109, s28, v13
    v_exp_f32 v108, v108
    v_exp_f32 v109, v109
    s_nop 0
    v_cvt_pk_bf16_f32 v40, v108, v109
    v_fma_f32 v110, v110, s28, v13
    v_fma_f32 v111, v111, s28, v13
    v_exp_f32 v110, v110
    v_exp_f32 v111, v111
    s_nop 0
    v_cvt_pk_bf16_f32 v41, v110, v111
    v_mfma_f32_16x16x32_bf16 v[48:51], a[236:239], v[16:19], v[44:47]
    v_mfma_f32_16x16x32_bf16 v[48:51], a[240:243], v[22:25], v[48:51]
    v_mfma_f32_16x16x32_bf16 v[48:51], a[244:247], v[28:31], v[48:51]
    v_mfma_f32_16x16x32_bf16 v[48:51], a[248:251], v[34:37], v[48:51]
    v_mfma_f32_16x16x32_bf16 v[48:51], a[252:255], v[40:43], v[48:51]
    s_nop 15
    s_setpc_b64 s[40:41]
L_rare4_0:
    s_nop 15
    v_mbcnt_lo_u32_b32 v31, -1, 0
    v_mbcnt_hi_u32_b32 v31, -1, v31
    v_and_b32 v30, 15, v31
    v_mul_u32_u24 v30, 384, v30
    v_lshrrev_b32 v31, 4, v31
    v_lshl_add_u32 v30, v31, 4, v30
    s_add_u32 s69, s39, 0
    buffer_load_dwordx4 v[44:47], v30, s[4:7], s69 offen offset:0
    s_waitcnt vmcnt(0)
    v_mfma_f32_16x16x32_bf16 v[104:107], v[44:47], a[96:99], 0
    s_nop 7
    buffer_load_dwordx4 v[44:47], v30, s[4:7], s69 offen offset:64
    s_waitcnt vmcnt(0)
    v_mfma_f32_16x16x32_bf16 v[104:107], v[44:47], a[100:103], v[104:107]
    s_nop 7
    buffer_load_dwordx4 v[44:47], v30, s[4:7], s69 offen offset:128
    s_waitcnt vmcnt(0)
    v_mfma_f32_16x16x32_bf16 v[104:107], v[44:47], a[104:107], v[104:107]
    s_nop 7
    buffer_load_dwordx4 v[44:47], v30, s[4:7], s69 offen offset:192
    s_waitcnt vmcnt(0)
    v_mfma_f32_16x16x32_bf16 v[104:107], v[44:47], a[108:111], v[104:107]
    s_nop 7
    buffer_load_dwordx4 v[44:47], v30, s[4:7], s69 offen offset:256
    s_waitcnt vmcnt(0)
    v_mfma_f32_16x16x32_bf16 v[104:107], v[44:47], a[112:115], v[104:107]
    s_nop 7
    buffer_load_dwordx4 v[44:47], v30, s[4:7], s69 offen offset:320
    s_waitcnt vmcnt(0)
    v_mfma_f32_16x16x32_bf16 v[104:107], v[44:47], a[116:119], v[104:107]
    s_nop 7
    s_add_u32 s69, s39, 6144
    buffer_load_dwordx4 v[44:47], v30, s[4:7], s69 offen offset:0
    s_waitcnt vmcnt(0)
    v_mfma_f32_16x16x32_bf16 v[108:111], v[44:47], a[96:99], 0
    s_nop 7
    buffer_load_dwordx4 v[44:47], v30, s[4:7], s69 offen offset:64
    s_waitcnt vmcnt(0)
    v_mfma_f32_16x16x32_bf16 v[108:111], v[44:47], a[100:103], v[108:111]
    s_nop 7
    buffer_load_dwordx4 v[44:47], v30, s[4:7], s69 offen offset:128
    s_waitcnt vmcnt(0)
    v_mfma_f32_16x16x32_bf16 v[108:111], v[44:47], a[104:107], v[108:111]
    s_nop 7
    buffer_load_dwordx4 v[44:47], v30, s[4:7], s69 offen offset:192
    s_waitcnt vmcnt(0)
    v_mfma_f32_16x16x32_bf16 v[108:111], v[44:47], a[108:111], v[108:111]
    s_nop 7
    buffer_load_dwordx4 v[44:47], v30, s[4:7], s69 offen offset:256
    s_waitcnt vmcnt(0)
    v_mfma_f32_16x16x32_bf16 v[108:111], v[44:47], a[112:115], v[108:111]
    s_nop 7
    buffer_load_dwordx4 v[44:47], v30, s[4:7], s69 offen offset:320
    s_waitcnt vmcnt(0)
    v_mfma_f32_16x16x32_bf16 v[108:111], v[44:47], a[116:119], v[108:111]
    s_nop 7
    s_nop 15
    v_max3_f32 v18, v104, v105, v106
    v_max3_f32 v18, v18, v107, v108
    v_max3_f32 v18, v18, v109, v110
    v_max_f32 v18, v18, v111
    v_mov_b32 v19, v18
    s_nop 1
    v_permlane32_swap_b32 v19, v18
    v_max_f32 v18, v18, v19
    v_mov_b32 v19, v18
    s_nop 1
    v_permlane16_swap_b32 v19, v18
    v_max_f32 v18, v18, v19
    v_fma_f32 v18, v18, s28, v9
    v_max_f32 v24, 0, v18
    v_sub_f32 v9, v9, v24
    v_sub_f32 v25, 0, v24
    v_exp_f32 v25, v25
    s_nop 0
    v_mul_f32 v19, v48, v25
    v_cndmask_b32_e64 v48, v19, v48, s[60:61]
    v_cndmask_b32_e64 v48, v48, 0, s[46:47]
    v_mul_f32 v112, v112, v25
    v_mul_f32 v113, v113, v25
    v_mul_f32 v114, v114, v25
    v_mul_f32 v115, v115, v25
    v_mul_f32 v116, v116, v25
    v_mul_f32 v117, v117, v25
    v_mul_f32 v118, v118, v25
    v_mul_f32 v119, v119, v25
    v_mul_f32 v120, v120, v25
    v_mul_f32 v121, v121, v25
    v_mul_f32 v122, v122, v25
    v_mul_f32 v123, v123, v25
    v_mul_f32 v124, v124, v25
    v_mul_f32 v125, v125, v25
    v_mul_f32 v126, v126, v25
    v_mul_f32 v127, v127, v25
    v_mul_f32 v128, v128, v25
    v_mul_f32 v129, v129, v25
    v_mul_f32 v130, v130, v25
    v_mul_f32 v131, v131, v25
    v_mul_f32 v132, v132, v25
    v_mul_f32 v133, v133, v25
    v_mul_f32 v134, v134, v25
    v_mul_f32 v135, v135, v25
    v_mul_f32 v136, v136, v25
    v_mul_f32 v137, v137, v25
    v_mul_f32 v138, v138, v25
    v_mul_f32 v139, v139, v25
    v_mul_f32 v140, v140, v25
    v_mul_f32 v141, v141, v25
    v_mul_f32 v142, v142, v25
    v_mul_f32 v143, v143, v25
    v_mul_f32 v144, v144, v25
    v_mul_f32 v145, v145, v25
    v_mul_f32 v146, v146, v25
    v_mul_f32 v147, v147, v25
    v_mul_f32 v148, v148, v25
    v_mul_f32 v149, v149, v25
    v_mul_f32 v150, v150, v25
    v_mul_f32 v151, v151, v25
    v_mul_f32 v152, v152, v25
    v_mul_f32 v153, v153, v25
    v_mul_f32 v154, v154, v25
    v_mul_f32 v155, v155, v25
    v_mul_f32 v156, v156, v25
    v_mul_f32 v157, v157, v25
    v_mul_f32 v158, v158, v25
    v_mul_f32 v159, v159, v25
    v_fma_f32 v104, v104, s28, v9
    v_fma_f32 v105, v105, s28, v9
    v_exp_f32 v104, v104
    v_exp_f32 v105, v105
    s_nop 0
    v_cvt_pk_bf16_f32 v14, v104, v105
    v_fma_f32 v106, v106, s28, v9
    v_fma_f32 v107, v107, s28, v9
    v_exp_f32 v106, v106
    v_exp_f32 v107, v107
    s_nop 0
    v_cvt_pk_bf16_f32 v15, v106, v107
    v_fma_f32 v108, v108, s28, v9
    v_fma_f32 v109, v109, s28, v9
    v_exp_f32 v108, v108
    v_exp_f32 v109, v109
    s_nop 0
    v_cvt_pk_bf16_f32 v16, v108, v109
    v_fma_f32 v110, v110, s28, v9
    v_fma_f32 v111, v111, s28, v9
    v_exp_f32 v110, v110
    v_exp_f32 v111, v111
    s_nop 0
    v_cvt_pk_bf16_f32 v17, v110, v111
    s_add_u32 s69, s39, 0
    buffer_load_dwordx4 v[44:47], v30, s[4:7], s69 offen offset:0
    s_waitcnt vmcnt(0)
    v_mfma_f32_16x16x32_bf16 v[104:107], v[44:47], a[120:123], 0
    s_nop 7
    buffer_load_dwordx4 v[44:47], v30, s[4:7], s69 offen offset:64
    s_waitcnt vmcnt(0)
    v_mfma_f32_16x16x32_bf16 v[104:107], v[44:47], a[124:127], v[104:107]
    s_nop 7
    buffer_load_dwordx4 v[44:47], v30, s[4:7], s69 offen offset:128
    s_waitcnt vmcnt(0)
    v_mfma_f32_16x16x32_bf16 v[104:107], v[44:47], a[128:131], v[104:107]
    s_nop 7
    buffer_load_dwordx4 v[44:47], v30, s[4:7], s69 offen offset:192
    s_waitcnt vmcnt(0)
    v_mfma_f32_16x16x32_bf16 v[104:107], v[44:47], a[132:135], v[104:107]
    s_nop 7
    buffer_load_dwordx4 v[44:47], v30, s[4:7], s69 offen offset:256
    s_waitcnt vmcnt(0)
    v_mfma_f32_16x16x32_bf16 v[104:107], v[44:47], a[136:139], v[104:107]
    s_nop 7
    buffer_load_dwordx4 v[44:47], v30, s[4:7], s69 offen offset:320
    s_waitcnt vmcnt(0)
    v_mfma_f32_16x16x32_bf16 v[104:107], v[44:47], a[140:143], v[104:107]
    s_nop 7
    s_add_u32 s69, s39, 6144
    buffer_load_dwordx4 v[44:47], v30, s[4:7], s69 offen offset:0
    s_waitcnt vmcnt(0)
    v_mfma_f32_16x16x32_bf16 v[108:111], v[44:47], a[120:123], 0
    s_nop 7
    buffer_load_dwordx4 v[44:47], v30, s[4:7], s69 offen offset:64
    s_waitcnt vmcnt(0)
    v_mfma_f32_16x16x32_bf16 v[108:111], v[44:47], a[124:127], v[108:111]
    s_nop 7
    buffer_load_dwordx4 v[44:47], v30, s[4:7], s69 offen offset:128
    s_waitcnt vmcnt(0)
    v_mfma_f32_16x16x32_bf16 v[108:111], v[44:47], a[128:131], v[108:111]
    s_nop 7
    buffer_load_dwordx4 v[44:47], v30, s[4:7], s69 offen offset:192
    s_waitcnt vmcnt(0)
    v_mfma_f32_16x16x32_bf16 v[108:111], v[44:47], a[132:135], v[108:111]
    s_nop 7
    buffer_load_dwordx4 v[44:47], v30, s[4:7], s69 offen offset:256
    s_waitcnt vmcnt(0)
    v_mfma_f32_16x16x32_bf16 v[108:111], v[44:47], a[136:139], v[108:111]
    s_nop 7
    buffer_load_dwordx4 v[44:47], v30, s[4:7], s69 offen offset:320
    s_waitcnt vmcnt(0)
    v_mfma_f32_16x16x32_bf16 v[108:111], v[44:47], a[140:143], v[108:111]
    s_nop 7
    s_nop 15
    v_max3_f32 v18, v104, v105, v106
    v_max3_f32 v18, v18, v107, v108
    v_max3_f32 v18, v18, v109, v110
    v_max_f32 v18, v18, v111
    v_mov_b32 v19, v18
    s_nop 1
    v_permlane32_swap_b32 v19, v18
    v_max_f32 v18, v18, v19
    v_mov_b32 v19, v18
    s_nop 1
    v_permlane16_swap_b32 v19, v18
    v_max_f32 v18, v18, v19
    v_fma_f32 v18, v18, s28, v10
    v_max_f32 v24, 0, v18
    v_sub_f32 v10, v10, v24
    v_sub_f32 v25, 0, v24
    v_exp_f32 v25, v25
    s_nop 0
    v_mul_f32 v49, v49, v25
    v_mul_f32 v160, v160, v25
    v_mul_f32 v161, v161, v25
    v_mul_f32 v162, v162, v25
    v_mul_f32 v163, v163, v25
    v_mul_f32 v164, v164, v25
    v_mul_f32 v165, v165, v25
    v_mul_f32 v166, v166, v25
    v_mul_f32 v167, v167, v25
    v_mul_f32 v168, v168, v25
    v_mul_f32 v169, v169, v25
    v_mul_f32 v170, v170, v25
    v_mul_f32 v171, v171, v25
    v_mul_f32 v172, v172, v25
    v_mul_f32 v173, v173, v25
    v_mul_f32 v174, v174, v25
    v_mul_f32 v175, v175, v25
    v_mul_f32 v176, v176, v25
    v_mul_f32 v177, v177, v25
    v_mul_f32 v178, v178, v25
    v_mul_f32 v179, v179, v25
    v_mul_f32 v180, v180, v25
    v_mul_f32 v181, v181, v25
    v_mul_f32 v182, v182, v25
    v_mul_f32 v183, v183, v25
    v_mul_f32 v184, v184, v25
    v_mul_f32 v185, v185, v25
    v_mul_f32 v186, v186, v25
    v_mul_f32 v187, v187, v25
    v_mul_f32 v188, v188, v25
    v_mul_f32 v189, v189, v25
    v_mul_f32 v190, v190, v25
    v_mul_f32 v191, v191, v25
    v_mul_f32 v192, v192, v25
    v_mul_f32 v193, v193, v25
    v_mul_f32 v194, v194, v25
    v_mul_f32 v195, v195, v25
    v_mul_f32 v196, v196, v25
    v_mul_f32 v197, v197, v25
    v_mul_f32 v198, v198, v25
    v_mul_f32 v199, v199, v25
    v_mul_f32 v200, v200, v25
    v_mul_f32 v201, v201, v25
    v_mul_f32 v202, v202, v25
    v_mul_f32 v203, v203, v25
    v_mul_f32 v204, v204, v25
    v_mul_f32 v205, v205, v25
    v_mul_f32 v206, v206, v25
    v_mul_f32 v207, v207, v25
    v_fma_f32 v104, v104, s28, v10
    v_fma_f32 v105, v105, s28, v10
    v_exp_f32 v104, v104
    v_exp_f32 v105, v105
    s_nop 0
    v_cvt_pk_bf16_f32 v20, v104, v105
    v_fma_f32 v106, v106, s28, v10
    v_fma_f32 v107, v107, s28, v10
    v_exp_f32 v106, v106
    v_exp_f32 v107, v107
    s_nop 0
    v_cvt_pk_bf16_f32 v21, v106, v107
    v_fma_f32 v108, v108, s28, v10
    v_fma_f32 v109, v109, s28, v10
    v_exp_f32 v108, v108
    v_exp_f32 v109, v109
    s_nop 0
    v_cvt_pk_bf16_f32 v22, v108, v109
    v_fma_f32 v110, v110, s28, v10
    v_fma_f32 v111, v111, s28, v10
    v_exp_f32 v110, v110
    v_exp_f32 v111, v111
    s_nop 0
    v_cvt_pk_bf16_f32 v23, v110, v111
    s_add_u32 s69, s39, 0
    buffer_load_dwordx4 v[44:47], v30, s[4:7], s69 offen offset:0
    s_waitcnt vmcnt(0)
    v_mfma_f32_16x16x32_bf16 v[104:107], v[44:47], a[144:147], 0
    s_nop 7
    buffer_load_dwordx4 v[44:47], v30, s[4:7], s69 offen offset:64
    s_waitcnt vmcnt(0)
    v_mfma_f32_16x16x32_bf16 v[104:107], v[44:47], a[148:151], v[104:107]
    s_nop 7
    buffer_load_dwordx4 v[44:47], v30, s[4:7], s69 offen offset:128
    s_waitcnt vmcnt(0)
    v_mfma_f32_16x16x32_bf16 v[104:107], v[44:47], a[152:155], v[104:107]
    s_nop 7
    buffer_load_dwordx4 v[44:47], v30, s[4:7], s69 offen offset:192
    s_waitcnt vmcnt(0)
    v_mfma_f32_16x16x32_bf16 v[104:107], v[44:47], a[156:159], v[104:107]
    s_nop 7
    buffer_load_dwordx4 v[44:47], v30, s[4:7], s69 offen offset:256
    s_waitcnt vmcnt(0)
    v_mfma_f32_16x16x32_bf16 v[104:107], v[44:47], a[160:163], v[104:107]
    s_nop 7
    buffer_load_dwordx4 v[44:47], v30, s[4:7], s69 offen offset:320
    s_waitcnt vmcnt(0)
    v_mfma_f32_16x16x32_bf16 v[104:107], v[44:47], a[164:167], v[104:107]
    s_nop 7
    s_add_u32 s69, s39, 6144
    buffer_load_dwordx4 v[44:47], v30, s[4:7], s69 offen offset:0
    s_waitcnt vmcnt(0)
    v_mfma_f32_16x16x32_bf16 v[108:111], v[44:47], a[144:147], 0
    s_nop 7
    buffer_load_dwordx4 v[44:47], v30, s[4:7], s69 offen offset:64
    s_waitcnt vmcnt(0)
    v_mfma_f32_16x16x32_bf16 v[108:111], v[44:47], a[148:151], v[108:111]
    s_nop 7
    buffer_load_dwordx4 v[44:47], v30, s[4:7], s69 offen offset:128
    s_waitcnt vmcnt(0)
    v_mfma_f32_16x16x32_bf16 v[108:111], v[44:47], a[152:155], v[108:111]
    s_nop 7
    buffer_load_dwordx4 v[44:47], v30, s[4:7], s69 offen offset:192
    s_waitcnt vmcnt(0)
    v_mfma_f32_16x16x32_bf16 v[108:111], v[44:47], a[156:159], v[108:111]
    s_nop 7
    buffer_load_dwordx4 v[44:47], v30, s[4:7], s69 offen offset:256
    s_waitcnt vmcnt(0)
    v_mfma_f32_16x16x32_bf16 v[108:111], v[44:47], a[160:163], v[108:111]
    s_nop 7
    buffer_load_dwordx4 v[44:47], v30, s[4:7], s69 offen offset:320
    s_waitcnt vmcnt(0)
    v_mfma_f32_16x16x32_bf16 v[108:111], v[44:47], a[164:167], v[108:111]
    s_nop 7
    s_nop 15
    v_max3_f32 v18, v104, v105, v106
    v_max3_f32 v18, v18, v107, v108
    v_max3_f32 v18, v18, v109, v110
    v_max_f32 v18, v18, v111
    v_mov_b32 v19, v18
    s_nop 1
    v_permlane32_swap_b32 v19, v18
    v_max_f32 v18, v18, v19
    v_mov_b32 v19, v18
    s_nop 1
    v_permlane16_swap_b32 v19, v18
    v_max_f32 v18, v18, v19
    v_fma_f32 v18, v18, s28, v11
    v_max_f32 v24, 0, v18
    v_sub_f32 v11, v11, v24
    v_sub_f32 v25, 0, v24
    v_exp_f32 v25, v25
    s_nop 0
    v_mul_f32 v50, v50, v25
    v_mul_f32 v208, v208, v25
    v_mul_f32 v209, v209, v25
    v_mul_f32 v210, v210, v25
    v_mul_f32 v211, v211, v25
    v_mul_f32 v212, v212, v25
    v_mul_f32 v213, v213, v25
    v_mul_f32 v214, v214, v25
    v_mul_f32 v215, v215, v25
    v_mul_f32 v216, v216, v25
    v_mul_f32 v217, v217, v25
    v_mul_f32 v218, v218, v25
    v_mul_f32 v219, v219, v25
    v_mul_f32 v220, v220, v25
    v_mul_f32 v221, v221, v25
    v_mul_f32 v222, v222, v25
    v_mul_f32 v223, v223, v25
    v_mul_f32 v224, v224, v25
    v_mul_f32 v225, v225, v25
    v_mul_f32 v226, v226, v25
    v_mul_f32 v227, v227, v25
    v_mul_f32 v228, v228, v25
    v_mul_f32 v229, v229, v25
    v_mul_f32 v230, v230, v25
    v_mul_f32 v231, v231, v25
    v_mul_f32 v232, v232, v25
    v_mul_f32 v233, v233, v25
    v_mul_f32 v234, v234, v25
    v_mul_f32 v235, v235, v25
    v_mul_f32 v236, v236, v25
    v_mul_f32 v237, v237, v25
    v_mul_f32 v238, v238, v25
    v_mul_f32 v239, v239, v25
    v_mul_f32 v240, v240, v25
    v_mul_f32 v241, v241, v25
    v_mul_f32 v242, v242, v25
    v_mul_f32 v243, v243, v25
    v_mul_f32 v244, v244, v25
    v_mul_f32 v245, v245, v25
    v_mul_f32 v246, v246, v25
    v_mul_f32 v247, v247, v25
    v_mul_f32 v248, v248, v25
    v_mul_f32 v249, v249, v25
    v_mul_f32 v250, v250, v25
    v_mul_f32 v251, v251, v25
    v_mul_f32 v252, v252, v25
    v_mul_f32 v253, v253, v25
    v_mul_f32 v254, v254, v25
    v_mul_f32 v255, v255, v25
    v_fma_f32 v104, v104, s28, v11
    v_fma_f32 v105, v105, s28, v11
    v_exp_f32 v104, v104
    v_exp_f32 v105, v105
    s_nop 0
    v_cvt_pk_bf16_f32 v26, v104, v105
    v_fma_f32 v106, v106, s28, v11
    v_fma_f32 v107, v107, s28, v11
    v_exp_f32 v106, v106
    v_exp_f32 v107, v107
    s_nop 0
    v_cvt_pk_bf16_f32 v27, v106, v107
    v_fma_f32 v108, v108, s28, v11
    v_fma_f32 v109, v109, s28, v11
    v_exp_f32 v108, v108
    v_exp_f32 v109, v109
    s_nop 0
    v_cvt_pk_bf16_f32 v28, v108, v109
    v_fma_f32 v110, v110, s28, v11
    v_fma_f32 v111, v111, s28, v11
    v_exp_f32 v110, v110
    v_exp_f32 v111, v111
    s_nop 0
    v_cvt_pk_bf16_f32 v29, v110, v111
    s_add_u32 s69, s39, 0
    buffer_load_dwordx4 v[44:47], v30, s[4:7], s69 offen offset:0
    s_waitcnt vmcnt(0)
    v_mfma_f32_16x16x32_bf16 v[104:107], v[44:47], a[168:171], 0
    s_nop 7
    buffer_load_dwordx4 v[44:47], v30, s[4:7], s69 offen offset:64
    s_waitcnt vmcnt(0)
    v_mfma_f32_16x16x32_bf16 v[104:107], v[44:47], a[172:175], v[104:107]
    s_nop 7
    buffer_load_dwordx4 v[44:47], v30, s[4:7], s69 offen offset:128
    s_waitcnt vmcnt(0)
    v_mfma_f32_16x16x32_bf16 v[104:107], v[44:47], a[176:179], v[104:107]
    s_nop 7
    buffer_load_dwordx4 v[44:47], v30, s[4:7], s69 offen offset:192
    s_waitcnt vmcnt(0)
    v_mfma_f32_16x16x32_bf16 v[104:107], v[44:47], a[180:183], v[104:107]
    s_nop 7
    buffer_load_dwordx4 v[44:47], v30, s[4:7], s69 offen offset:256
    s_waitcnt vmcnt(0)
    v_mfma_f32_16x16x32_bf16 v[104:107], v[44:47], a[184:187], v[104:107]
    s_nop 7
    buffer_load_dwordx4 v[44:47], v30, s[4:7], s69 offen offset:320
    s_waitcnt vmcnt(0)
    v_mfma_f32_16x16x32_bf16 v[104:107], v[44:47], a[188:191], v[104:107]
    s_nop 7
    s_add_u32 s69, s39, 6144
    buffer_load_dwordx4 v[44:47], v30, s[4:7], s69 offen offset:0
    s_waitcnt vmcnt(0)
    v_mfma_f32_16x16x32_bf16 v[108:111], v[44:47], a[168:171], 0
    s_nop 7
    buffer_load_dwordx4 v[44:47], v30, s[4:7], s69 offen offset:64
    s_waitcnt vmcnt(0)
    v_mfma_f32_16x16x32_bf16 v[108:111], v[44:47], a[172:175], v[108:111]
    s_nop 7
    buffer_load_dwordx4 v[44:47], v30, s[4:7], s69 offen offset:128
    s_waitcnt vmcnt(0)
    v_mfma_f32_16x16x32_bf16 v[108:111], v[44:47], a[176:179], v[108:111]
    s_nop 7
    buffer_load_dwordx4 v[44:47], v30, s[4:7], s69 offen offset:192
    s_waitcnt vmcnt(0)
    v_mfma_f32_16x16x32_bf16 v[108:111], v[44:47], a[180:183], v[108:111]
    s_nop 7
    buffer_load_dwordx4 v[44:47], v30, s[4:7], s69 offen offset:256
    s_waitcnt vmcnt(0)
    v_mfma_f32_16x16x32_bf16 v[108:111], v[44:47], a[184:187], v[108:111]
    s_nop 7
    buffer_load_dwordx4 v[44:47], v30, s[4:7], s69 offen offset:320
    s_waitcnt vmcnt(0)
    v_mfma_f32_16x16x32_bf16 v[108:111], v[44:47], a[188:191], v[108:111]
    s_nop 7
    s_nop 15
    v_max3_f32 v18, v104, v105, v106
    v_max3_f32 v18, v18, v107, v108
    v_max3_f32 v18, v18, v109, v110
    v_max_f32 v18, v18, v111
    v_mov_b32 v19, v18
    s_nop 1
    v_permlane32_swap_b32 v19, v18
    v_max_f32 v18, v18, v19
    v_mov_b32 v19, v18
    s_nop 1
    v_permlane16_swap_b32 v19, v18
    v_max_f32 v18, v18, v19
    v_fma_f32 v18, v18, s28, v12
    v_max_f32 v24, 0, v18
    v_sub_f32 v12, v12, v24
    v_sub_f32 v25, 0, v24
    v_exp_f32 v25, v25
    s_nop 0
    v_mul_f32 v51, v51, v25
    v_accvgpr_read_b32 v19, a0
    v_mul_f32 v19, v19, v25
    v_accvgpr_write_b32 a0, v19
    v_accvgpr_read_b32 v19, a1
    v_mul_f32 v19, v19, v25
    v_accvgpr_write_b32 a1, v19
    v_accvgpr_read_b32 v19, a2
    v_mul_f32 v19, v19, v25
    v_accvgpr_write_b32 a2, v19
    v_accvgpr_read_b32 v19, a3
    v_mul_f32 v19, v19, v25
    v_accvgpr_write_b32 a3, v19
    v_accvgpr_read_b32 v19, a4
    v_mul_f32 v19, v19, v25
    v_accvgpr_write_b32 a4, v19
    v_accvgpr_read_b32 v19, a5
    v_mul_f32 v19, v19, v25
    v_accvgpr_write_b32 a5, v19
    v_accvgpr_read_b32 v19, a6
    v_mul_f32 v19, v19, v25
    v_accvgpr_write_b32 a6, v19
    v_accvgpr_read_b32 v19, a7
    v_mul_f32 v19, v19, v25
    v_accvgpr_write_b32 a7, v19
    v_accvgpr_read_b32 v19, a8
    v_mul_f32 v19, v19, v25
    v_accvgpr_write_b32 a8, v19
    v_accvgpr_read_b32 v19, a9
    v_mul_f32 v19, v19, v25
    v_accvgpr_write_b32 a9, v19
    v_accvgpr_read_b32 v19, a10
    v_mul_f32 v19, v19, v25
    v_accvgpr_write_b32 a10, v19
    v_accvgpr_read_b32 v19, a11
    v_mul_f32 v19, v19, v25
    v_accvgpr_write_b32 a11, v19
    v_accvgpr_read_b32 v19, a12
    v_mul_f32 v19, v19, v25
    v_accvgpr_write_b32 a12, v19
    v_accvgpr_read_b32 v19, a13
    v_mul_f32 v19, v19, v25
    v_accvgpr_write_b32 a13, v19
    v_accvgpr_read_b32 v19, a14
    v_mul_f32 v19, v19, v25
    v_accvgpr_write_b32 a14, v19
    v_accvgpr_read_b32 v19, a15
    v_mul_f32 v19, v19, v25
    v_accvgpr_write_b32 a15, v19
    v_accvgpr_read_b32 v19, a16
    v_mul_f32 v19, v19, v25
    v_accvgpr_write_b32 a16, v19
    v_accvgpr_read_b32 v19, a17
    v_mul_f32 v19, v19, v25
    v_accvgpr_write_b32 a17, v19
    v_accvgpr_read_b32 v19, a18
    v_mul_f32 v19, v19, v25
    v_accvgpr_write_b32 a18, v19
    v_accvgpr_read_b32 v19, a19
    v_mul_f32 v19, v19, v25
    v_accvgpr_write_b32 a19, v19
    v_accvgpr_read_b32 v19, a20
    v_mul_f32 v19, v19, v25
    v_accvgpr_write_b32 a20, v19
    v_accvgpr_read_b32 v19, a21
    v_mul_f32 v19, v19, v25
    v_accvgpr_write_b32 a21, v19
    v_accvgpr_read_b32 v19, a22
    v_mul_f32 v19, v19, v25
    v_accvgpr_write_b32 a22, v19
    v_accvgpr_read_b32 v19, a23
    v_mul_f32 v19, v19, v25
    v_accvgpr_write_b32 a23, v19
    v_accvgpr_read_b32 v19, a24
    v_mul_f32 v19, v19, v25
    v_accvgpr_write_b32 a24, v19
    v_accvgpr_read_b32 v19, a25
    v_mul_f32 v19, v19, v25
    v_accvgpr_write_b32 a25, v19
    v_accvgpr_read_b32 v19, a26
    v_mul_f32 v19, v19, v25
    v_accvgpr_write_b32 a26, v19
    v_accvgpr_read_b32 v19, a27
    v_mul_f32 v19, v19, v25
    v_accvgpr_write_b32 a27, v19
    v_accvgpr_read_b32 v19, a28
    v_mul_f32 v19, v19, v25
    v_accvgpr_write_b32 a28, v19
    v_accvgpr_read_b32 v19, a29
    v_mul_f32 v19, v19, v25
    v_accvgpr_write_b32 a29, v19
    v_accvgpr_read_b32 v19, a30
    v_mul_f32 v19, v19, v25
    v_accvgpr_write_b32 a30, v19
    v_accvgpr_read_b32 v19, a31
    v_mul_f32 v19, v19, v25
    v_accvgpr_write_b32 a31, v19
    v_accvgpr_read_b32 v19, a32
    v_mul_f32 v19, v19, v25
    v_accvgpr_write_b32 a32, v19
    v_accvgpr_read_b32 v19, a33
    v_mul_f32 v19, v19, v25
    v_accvgpr_write_b32 a33, v19
    v_accvgpr_read_b32 v19, a34
    v_mul_f32 v19, v19, v25
    v_accvgpr_write_b32 a34, v19
    v_accvgpr_read_b32 v19, a35
    v_mul_f32 v19, v19, v25
    v_accvgpr_write_b32 a35, v19
    v_accvgpr_read_b32 v19, a36
    v_mul_f32 v19, v19, v25
    v_accvgpr_write_b32 a36, v19
    v_accvgpr_read_b32 v19, a37
    v_mul_f32 v19, v19, v25
    v_accvgpr_write_b32 a37, v19
    v_accvgpr_read_b32 v19, a38
    v_mul_f32 v19, v19, v25
    v_accvgpr_write_b32 a38, v19
    v_accvgpr_read_b32 v19, a39
    v_mul_f32 v19, v19, v25
    v_accvgpr_write_b32 a39, v19
    v_accvgpr_read_b32 v19, a40
    v_mul_f32 v19, v19, v25
    v_accvgpr_write_b32 a40, v19
    v_accvgpr_read_b32 v19, a41
    v_mul_f32 v19, v19, v25
    v_accvgpr_write_b32 a41, v19
    v_accvgpr_read_b32 v19, a42
    v_mul_f32 v19, v19, v25
    v_accvgpr_write_b32 a42, v19
    v_accvgpr_read_b32 v19, a43
    v_mul_f32 v19, v19, v25
    v_accvgpr_write_b32 a43, v19
    v_accvgpr_read_b32 v19, a44
    v_mul_f32 v19, v19, v25
    v_accvgpr_write_b32 a44, v19
    v_accvgpr_read_b32 v19, a45
    v_mul_f32 v19, v19, v25
    v_accvgpr_write_b32 a45, v19
    v_accvgpr_read_b32 v19, a46
    v_mul_f32 v19, v19, v25
    v_accvgpr_write_b32 a46, v19
    v_accvgpr_read_b32 v19, a47
    v_mul_f32 v19, v19, v25
    v_accvgpr_write_b32 a47, v19
    v_fma_f32 v104, v104, s28, v12
    v_fma_f32 v105, v105, s28, v12
    v_exp_f32 v104, v104
    v_exp_f32 v105, v105
    s_nop 0
    v_cvt_pk_bf16_f32 v32, v104, v105
    v_fma_f32 v106, v106, s28, v12
    v_fma_f32 v107, v107, s28, v12
    v_exp_f32 v106, v106
    v_exp_f32 v107, v107
    s_nop 0
    v_cvt_pk_bf16_f32 v33, v106, v107
    v_fma_f32 v108, v108, s28, v12
    v_fma_f32 v109, v109, s28, v12
    v_exp_f32 v108, v108
    v_exp_f32 v109, v109
    s_nop 0
    v_cvt_pk_bf16_f32 v34, v108, v109
    v_fma_f32 v110, v110, s28, v12
    v_fma_f32 v111, v111, s28, v12
    v_exp_f32 v110, v110
    v_exp_f32 v111, v111
    s_nop 0
    v_cvt_pk_bf16_f32 v35, v110, v111
    v_mfma_f32_16x16x32_bf16 v[44:47], a[236:239], v[14:17], v[48:51]
    v_mfma_f32_16x16x32_bf16 v[44:47], a[240:243], v[20:23], v[44:47]
    v_mfma_f32_16x16x32_bf16 v[44:47], a[244:247], v[26:29], v[44:47]
    v_mfma_f32_16x16x32_bf16 v[44:47], a[248:251], v[32:35], v[44:47]
    s_nop 15
    s_setpc_b64 s[40:41]
L_rare4_1:
    s_nop 15
    v_mbcnt_lo_u32_b32 v27, -1, 0
    v_mbcnt_hi_u32_b32 v27, -1, v27
    v_and_b32 v26, 15, v27
    v_mul_u32_u24 v26, 384, v26
    v_lshrrev_b32 v27, 4, v27
    v_lshl_add_u32 v26, v27, 4, v26
    s_add_u32 s69, s39, 0
    buffer_load_dwordx4 v[48:51], v26, s[4:7], s69 offen offset:0
    s_waitcnt vmcnt(0)
    v_mfma_f32_16x16x32_bf16 v[104:107], v[48:51], a[96:99], 0
    s_nop 7
    buffer_load_dwordx4 v[48:51], v26, s[4:7], s69 offen offset:64
    s_waitcnt vmcnt(0)
    v_mfma_f32_16x16x32_bf16 v[104:107], v[48:51], a[100:103], v[104:107]
    s_nop 7
    buffer_load_dwordx4 v[48:51], v26, s[4:7], s69 offen offset:128
    s_waitcnt vmcnt(0)
    v_mfma_f32_16x16x32_bf16 v[104:107], v[48:51], a[104:107], v[104:107]
    s_nop 7
    buffer_load_dwordx4 v[48:51], v26, s[4:7], s69 offen offset:192
    s_waitcnt vmcnt(0)
    v_mfma_f32_16x16x32_bf16 v[104:107], v[48:51], a[108:111], v[104:107]
    s_nop 7
    buffer_load_dwordx4 v[48:51], v26, s[4:7], s69 offen offset:256
    s_waitcnt vmcnt(0)
    v_mfma_f32_16x16x32_bf16 v[104:107], v[48:51], a[112:115], v[104:107]
    s_nop 7
    buffer_load_dwordx4 v[48:51], v26, s[4:7], s69 offen offset:320
    s_waitcnt vmcnt(0)
    v_mfma_f32_16x16x32_bf16 v[104:107], v[48:51], a[116:119], v[104:107]
    s_nop 7
    s_add_u32 s69, s39, 6144
    buffer_load_dwordx4 v[48:51], v26, s[4:7], s69 offen offset:0
    s_waitcnt vmcnt(0)
    v_mfma_f32_16x16x32_bf16 v[108:111], v[48:51], a[96:99], 0
    s_nop 7
    buffer_load_dwordx4 v[48:51], v26, s[4:7], s69 offen offset:64
    s_waitcnt vmcnt(0)
    v_mfma_f32_16x16x32_bf16 v[108:111], v[48:51], a[100:103], v[108:111]
    s_nop 7
    buffer_load_dwordx4 v[48:51], v26, s[4:7], s69 offen offset:128
    s_waitcnt vmcnt(0)
    v_mfma_f32_16x16x32_bf16 v[108:111], v[48:51], a[104:107], v[108:111]
    s_nop 7
    buffer_load_dwordx4 v[48:51], v26, s[4:7], s69 offen offset:192
    s_waitcnt vmcnt(0)
    v_mfma_f32_16x16x32_bf16 v[108:111], v[48:51], a[108:111], v[108:111]
    s_nop 7
    buffer_load_dwordx4 v[48:51], v26, s[4:7], s69 offen offset:256
    s_waitcnt vmcnt(0)
    v_mfma_f32_16x16x32_bf16 v[108:111], v[48:51], a[112:115], v[108:111]
    s_nop 7
    buffer_load_dwordx4 v[48:51], v26, s[4:7], s69 offen offset:320
    s_waitcnt vmcnt(0)
    v_mfma_f32_16x16x32_bf16 v[108:111], v[48:51], a[116:119], v[108:111]
    s_nop 7
    s_nop 15
    v_max3_f32 v14, v104, v105, v106
    v_max3_f32 v14, v14, v107, v108
    v_max3_f32 v14, v14, v109, v110
    v_max_f32 v14, v14, v111
    v_mov_b32 v15, v14
    s_nop 1
    v_permlane32_swap_b32 v15, v14
    v_max_f32 v14, v14, v15
    v_mov_b32 v15, v14
    s_nop 1
    v_permlane16_swap_b32 v15, v14
    v_max_f32 v14, v14, v15
    v_fma_f32 v14, v14, s28, v9
    v_max_f32 v20, 0, v14
    v_sub_f32 v9, v9, v20
    v_sub_f32 v21, 0, v20
    v_exp_f32 v21, v21
    s_nop 0
    v_mul_f32 v15, v44, v21
    v_cndmask_b32_e64 v44, v15, v44, s[60:61]
    v_cndmask_b32_e64 v44, v44, 0, s[46:47]
    v_mul_f32 v112, v112, v21
    v_mul_f32 v113, v113, v21
    v_mul_f32 v114, v114, v21
    v_mul_f32 v115, v115, v21
    v_mul_f32 v116, v116, v21
    v_mul_f32 v117, v117, v21
    v_mul_f32 v118, v118, v21
    v_mul_f32 v119, v119, v21
    v_mul_f32 v120, v120, v21
    v_mul_f32 v121, v121, v21
    v_mul_f32 v122, v122, v21
    v_mul_f32 v123, v123, v21
    v_mul_f32 v124, v124, v21
    v_mul_f32 v125, v125, v21
    v_mul_f32 v126, v126, v21
    v_mul_f32 v127, v127, v21
    v_mul_f32 v128, v128, v21
    v_mul_f32 v129, v129, v21
    v_mul_f32 v130, v130, v21
    v_mul_f32 v131, v131, v21
    v_mul_f32 v132, v132, v21
    v_mul_f32 v133, v133, v21
    v_mul_f32 v134, v134, v21
    v_mul_f32 v135, v135, v21
    v_mul_f32 v136, v136, v21
    v_mul_f32 v137, v137, v21
    v_mul_f32 v138, v138, v21
    v_mul_f32 v139, v139, v21
    v_mul_f32 v140, v140, v21
    v_mul_f32 v141, v141, v21
    v_mul_f32 v142, v142, v21
    v_mul_f32 v143, v143, v21
    v_mul_f32 v144, v144, v21
    v_mul_f32 v145, v145, v21
    v_mul_f32 v146, v146, v21
    v_mul_f32 v147, v147, v21
    v_mul_f32 v148, v148, v21
    v_mul_f32 v149, v149, v21
    v_mul_f32 v150, v150, v21
    v_mul_f32 v151, v151, v21
    v_mul_f32 v152, v152, v21
    v_mul_f32 v153, v153, v21
    v_mul_f32 v154, v154, v21
    v_mul_f32 v155, v155, v21
    v_mul_f32 v156, v156, v21
    v_mul_f32 v157, v157, v21
    v_mul_f32 v158, v158, v21
    v_mul_f32 v159, v159, v21
    v_fma_f32 v104, v104, s28, v9
    v_fma_f32 v105, v105, s28, v9
    v_exp_f32 v104, v104
    v_exp_f32 v105, v105
    s_nop 0
    v_cvt_pk_bf16_f32 v18, v104, v105
    v_fma_f32 v106, v106, s28, v9
    v_fma_f32 v107, v107, s28, v9
    v_exp_f32 v106, v106
    v_exp_f32 v107, v107
    s_nop 0
    v_cvt_pk_bf16_f32 v19, v106, v107
    v_fma_f32 v108, v108, s28, v9
    v_fma_f32 v109, v109, s28, v9
    v_exp_f32 v108, v108
    v_exp_f32 v109, v109
    s_nop 0
    v_cvt_pk_bf16_f32 v16, v108, v109
    v_fma_f32 v110, v110, s28, v9
    v_fma_f32 v111, v111, s28, v9
    v_exp_f32 v110, v110
    v_exp_f32 v111, v111
    s_nop 0
    v_cvt_pk_bf16_f32 v17, v110, v111
    s_add_u32 s69, s39, 0
    buffer_load_dwordx4 v[48:51], v26, s[4:7], s69 offen offset:0
    s_waitcnt vmcnt(0)
    v_mfma_f32_16x16x32_bf16 v[104:107], v[48:51], a[120:123], 0
    s_nop 7
    buffer_load_dwordx4 v[48:51], v26, s[4:7], s69 offen offset:64
    s_waitcnt vmcnt(0)
    v_mfma_f32_16x16x32_bf16 v[104:107], v[48:51], a[124:127], v[104:107]
    s_nop 7
    buffer_load_dwordx4 v[48:51], v26, s[4:7], s69 offen offset:128
    s_waitcnt vmcnt(0)
    v_mfma_f32_16x16x32_bf16 v[104:107], v[48:51], a[128:131], v[104:107]
    s_nop 7
    buffer_load_dwordx4 v[48:51], v26, s[4:7], s69 offen offset:192
    s_waitcnt vmcnt(0)
    v_mfma_f32_16x16x32_bf16 v[104:107], v[48:51], a[132:135], v[104:107]
    s_nop 7
    buffer_load_dwordx4 v[48:51], v26, s[4:7], s69 offen offset:256
    s_waitcnt vmcnt(0)
    v_mfma_f32_16x16x32_bf16 v[104:107], v[48:51], a[136:139], v[104:107]
    s_nop 7
    buffer_load_dwordx4 v[48:51], v26, s[4:7], s69 offen offset:320
    s_waitcnt vmcnt(0)
    v_mfma_f32_16x16x32_bf16 v[104:107], v[48:51], a[140:143], v[104:107]
    s_nop 7
    s_add_u32 s69, s39, 6144
    buffer_load_dwordx4 v[48:51], v26, s[4:7], s69 offen offset:0
    s_waitcnt vmcnt(0)
    v_mfma_f32_16x16x32_bf16 v[108:111], v[48:51], a[120:123], 0
    s_nop 7
    buffer_load_dwordx4 v[48:51], v26, s[4:7], s69 offen offset:64
    s_waitcnt vmcnt(0)
    v_mfma_f32_16x16x32_bf16 v[108:111], v[48:51], a[124:127], v[108:111]
    s_nop 7
    buffer_load_dwordx4 v[48:51], v26, s[4:7], s69 offen offset:128
    s_waitcnt vmcnt(0)
    v_mfma_f32_16x16x32_bf16 v[108:111], v[48:51], a[128:131], v[108:111]
    s_nop 7
    buffer_load_dwordx4 v[48:51], v26, s[4:7], s69 offen offset:192
    s_waitcnt vmcnt(0)
    v_mfma_f32_16x16x32_bf16 v[108:111], v[48:51], a[132:135], v[108:111]
    s_nop 7
    buffer_load_dwordx4 v[48:51], v26, s[4:7], s69 offen offset:256
    s_waitcnt vmcnt(0)
    v_mfma_f32_16x16x32_bf16 v[108:111], v[48:51], a[136:139], v[108:111]
    s_nop 7
    buffer_load_dwordx4 v[48:51], v26, s[4:7], s69 offen offset:320
    s_waitcnt vmcnt(0)
    v_mfma_f32_16x16x32_bf16 v[108:111], v[48:51], a[140:143], v[108:111]
    s_nop 7
    s_nop 15
    v_max3_f32 v14, v104, v105, v106
    v_max3_f32 v14, v14, v107, v108
    v_max3_f32 v14, v14, v109, v110
    v_max_f32 v14, v14, v111
    v_mov_b32 v15, v14
    s_nop 1
    v_permlane32_swap_b32 v15, v14
    v_max_f32 v14, v14, v15
    v_mov_b32 v15, v14
    s_nop 1
    v_permlane16_swap_b32 v15, v14
    v_max_f32 v14, v14, v15
    v_fma_f32 v14, v14, s28, v10
    v_max_f32 v20, 0, v14
    v_sub_f32 v10, v10, v20
    v_sub_f32 v21, 0, v20
    v_exp_f32 v21, v21
    s_nop 0
    v_mul_f32 v45, v45, v21
    v_mul_f32 v160, v160, v21
    v_mul_f32 v161, v161, v21
    v_mul_f32 v162, v162, v21
    v_mul_f32 v163, v163, v21
    v_mul_f32 v164, v164, v21
    v_mul_f32 v165, v165, v21
    v_mul_f32 v166, v166, v21
    v_mul_f32 v167, v167, v21
    v_mul_f32 v168, v168, v21
    v_mul_f32 v169, v169, v21
    v_mul_f32 v170, v170, v21
    v_mul_f32 v171, v171, v21
    v_mul_f32 v172, v172, v21
    v_mul_f32 v173, v173, v21
    v_mul_f32 v174, v174, v21
    v_mul_f32 v175, v175, v21
    v_mul_f32 v176, v176, v21
    v_mul_f32 v177, v177, v21
    v_mul_f32 v178, v178, v21
    v_mul_f32 v179, v179, v21
    v_mul_f32 v180, v180, v21
    v_mul_f32 v181, v181, v21
    v_mul_f32 v182, v182, v21
    v_mul_f32 v183, v183, v21
    v_mul_f32 v184, v184, v21
    v_mul_f32 v185, v185, v21
    v_mul_f32 v186, v186, v21
    v_mul_f32 v187, v187, v21
    v_mul_f32 v188, v188, v21
    v_mul_f32 v189, v189, v21
    v_mul_f32 v190, v190, v21
    v_mul_f32 v191, v191, v21
    v_mul_f32 v192, v192, v21
    v_mul_f32 v193, v193, v21
    v_mul_f32 v194, v194, v21
    v_mul_f32 v195, v195, v21
    v_mul_f32 v196, v196, v21
    v_mul_f32 v197, v197, v21
    v_mul_f32 v198, v198, v21
    v_mul_f32 v199, v199, v21
    v_mul_f32 v200, v200, v21
    v_mul_f32 v201, v201, v21
    v_mul_f32 v202, v202, v21
    v_mul_f32 v203, v203, v21
    v_mul_f32 v204, v204, v21
    v_mul_f32 v205, v205, v21
    v_mul_f32 v206, v206, v21
    v_mul_f32 v207, v207, v21
    v_fma_f32 v104, v104, s28, v10
    v_fma_f32 v105, v105, s28, v10
    v_exp_f32 v104, v104
    v_exp_f32 v105, v105
    s_nop 0
    v_cvt_pk_bf16_f32 v24, v104, v105
    v_fma_f32 v106, v106, s28, v10
    v_fma_f32 v107, v107, s28, v10
    v_exp_f32 v106, v106
    v_exp_f32 v107, v107
    s_nop 0
    v_cvt_pk_bf16_f32 v25, v106, v107
    v_fma_f32 v108, v108, s28, v10
    v_fma_f32 v109, v109, s28, v10
    v_exp_f32 v108, v108
    v_exp_f32 v109, v109
    s_nop 0
    v_cvt_pk_bf16_f32 v22, v108, v109
    v_fma_f32 v110, v110, s28, v10
    v_fma_f32 v111, v111, s28, v10
    v_exp_f32 v110, v110
    v_exp_f32 v111, v111
    s_nop 0
    v_cvt_pk_bf16_f32 v23, v110, v111
    s_add_u32 s69, s39, 0
    buffer_load_dwordx4 v[48:51], v26, s[4:7], s69 offen offset:0
    s_waitcnt vmcnt(0)
    v_mfma_f32_16x16x32_bf16 v[104:107], v[48:51], a[144:147], 0
    s_nop 7
    buffer_load_dwordx4 v[48:51], v26, s[4:7], s69 offen offset:64
    s_waitcnt vmcnt(0)
    v_mfma_f32_16x16x32_bf16 v[104:107], v[48:51], a[148:151], v[104:107]
    s_nop 7
    buffer_load_dwordx4 v[48:51], v26, s[4:7], s69 offen offset:128
    s_waitcnt vmcnt(0)
    v_mfma_f32_16x16x32_bf16 v[104:107], v[48:51], a[152:155], v[104:107]
    s_nop 7
    buffer_load_dwordx4 v[48:51], v26, s[4:7], s69 offen offset:192
    s_waitcnt vmcnt(0)
    v_mfma_f32_16x16x32_bf16 v[104:107], v[48:51], a[156:159], v[104:107]
    s_nop 7
    buffer_load_dwordx4 v[48:51], v26, s[4:7], s69 offen offset:256
    s_waitcnt vmcnt(0)
    v_mfma_f32_16x16x32_bf16 v[104:107], v[48:51], a[160:163], v[104:107]
    s_nop 7
    buffer_load_dwordx4 v[48:51], v26, s[4:7], s69 offen offset:320
    s_waitcnt vmcnt(0)
    v_mfma_f32_16x16x32_bf16 v[104:107], v[48:51], a[164:167], v[104:107]
    s_nop 7
    s_add_u32 s69, s39, 6144
    buffer_load_dwordx4 v[48:51], v26, s[4:7], s69 offen offset:0
    s_waitcnt vmcnt(0)
    v_mfma_f32_16x16x32_bf16 v[108:111], v[48:51], a[144:147], 0
    s_nop 7
    buffer_load_dwordx4 v[48:51], v26, s[4:7], s69 offen offset:64
    s_waitcnt vmcnt(0)
    v_mfma_f32_16x16x32_bf16 v[108:111], v[48:51], a[148:151], v[108:111]
    s_nop 7
    buffer_load_dwordx4 v[48:51], v26, s[4:7], s69 offen offset:128
    s_waitcnt vmcnt(0)
    v_mfma_f32_16x16x32_bf16 v[108:111], v[48:51], a[152:155], v[108:111]
    s_nop 7
    buffer_load_dwordx4 v[48:51], v26, s[4:7], s69 offen offset:192
    s_waitcnt vmcnt(0)
    v_mfma_f32_16x16x32_bf16 v[108:111], v[48:51], a[156:159], v[108:111]
    s_nop 7
    buffer_load_dwordx4 v[48:51], v26, s[4:7], s69 offen offset:256
    s_waitcnt vmcnt(0)
    v_mfma_f32_16x16x32_bf16 v[108:111], v[48:51], a[160:163], v[108:111]
    s_nop 7
    buffer_load_dwordx4 v[48:51], v26, s[4:7], s69 offen offset:320
    s_waitcnt vmcnt(0)
    v_mfma_f32_16x16x32_bf16 v[108:111], v[48:51], a[164:167], v[108:111]
    s_nop 7
    s_nop 15
    v_max3_f32 v14, v104, v105, v106
    v_max3_f32 v14, v14, v107, v108
    v_max3_f32 v14, v14, v109, v110
    v_max_f32 v14, v14, v111
    v_mov_b32 v15, v14
    s_nop 1
    v_permlane32_swap_b32 v15, v14
    v_max_f32 v14, v14, v15
    v_mov_b32 v15, v14
    s_nop 1
    v_permlane16_swap_b32 v15, v14
    v_max_f32 v14, v14, v15
    v_fma_f32 v14, v14, s28, v11
    v_max_f32 v20, 0, v14
    v_sub_f32 v11, v11, v20
    v_sub_f32 v21, 0, v20
    v_exp_f32 v21, v21
    s_nop 0
    v_mul_f32 v46, v46, v21
    v_mul_f32 v208, v208, v21
    v_mul_f32 v209, v209, v21
    v_mul_f32 v210, v210, v21
    v_mul_f32 v211, v211, v21
    v_mul_f32 v212, v212, v21
    v_mul_f32 v213, v213, v21
    v_mul_f32 v214, v214, v21
    v_mul_f32 v215, v215, v21
    v_mul_f32 v216, v216, v21
    v_mul_f32 v217, v217, v21
    v_mul_f32 v218, v218, v21
    v_mul_f32 v219, v219, v21
    v_mul_f32 v220, v220, v21
    v_mul_f32 v221, v221, v21
    v_mul_f32 v222, v222, v21
    v_mul_f32 v223, v223, v21
    v_mul_f32 v224, v224, v21
    v_mul_f32 v225, v225, v21
    v_mul_f32 v226, v226, v21
    v_mul_f32 v227, v227, v21
    v_mul_f32 v228, v228, v21
    v_mul_f32 v229, v229, v21
    v_mul_f32 v230, v230, v21
    v_mul_f32 v231, v231, v21
    v_mul_f32 v232, v232, v21
    v_mul_f32 v233, v233, v21
    v_mul_f32 v234, v234, v21
    v_mul_f32 v235, v235, v21
    v_mul_f32 v236, v236, v21
    v_mul_f32 v237, v237, v21
    v_mul_f32 v238, v238, v21
    v_mul_f32 v239, v239, v21
    v_mul_f32 v240, v240, v21
    v_mul_f32 v241, v241, v21
    v_mul_f32 v242, v242, v21
    v_mul_f32 v243, v243, v21
    v_mul_f32 v244, v244, v21
    v_mul_f32 v245, v245, v21
    v_mul_f32 v246, v246, v21
    v_mul_f32 v247, v247, v21
    v_mul_f32 v248, v248, v21
    v_mul_f32 v249, v249, v21
    v_mul_f32 v250, v250, v21
    v_mul_f32 v251, v251, v21
    v_mul_f32 v252, v252, v21
    v_mul_f32 v253, v253, v21
    v_mul_f32 v254, v254, v21
    v_mul_f32 v255, v255, v21
    v_fma_f32 v104, v104, s28, v11
    v_fma_f32 v105, v105, s28, v11
    v_exp_f32 v104, v104
    v_exp_f32 v105, v105
    s_nop 0
    v_cvt_pk_bf16_f32 v30, v104, v105
    v_fma_f32 v106, v106, s28, v11
    v_fma_f32 v107, v107, s28, v11
    v_exp_f32 v106, v106
    v_exp_f32 v107, v107
    s_nop 0
    v_cvt_pk_bf16_f32 v31, v106, v107
    v_fma_f32 v108, v108, s28, v11
    v_fma_f32 v109, v109, s28, v11
    v_exp_f32 v108, v108
    v_exp_f32 v109, v109
    s_nop 0
    v_cvt_pk_bf16_f32 v28, v108, v109
    v_fma_f32 v110, v110, s28, v11
    v_fma_f32 v111, v111, s28, v11
    v_exp_f32 v110, v110
    v_exp_f32 v111, v111
    s_nop 0
    v_cvt_pk_bf16_f32 v29, v110, v111
    s_add_u32 s69, s39, 0
    buffer_load_dwordx4 v[48:51], v26, s[4:7], s69 offen offset:0
    s_waitcnt vmcnt(0)
    v_mfma_f32_16x16x32_bf16 v[104:107], v[48:51], a[168:171], 0
    s_nop 7
    buffer_load_dwordx4 v[48:51], v26, s[4:7], s69 offen offset:64
    s_waitcnt vmcnt(0)
    v_mfma_f32_16x16x32_bf16 v[104:107], v[48:51], a[172:175], v[104:107]
    s_nop 7
    buffer_load_dwordx4 v[48:51], v26, s[4:7], s69 offen offset:128
    s_waitcnt vmcnt(0)
    v_mfma_f32_16x16x32_bf16 v[104:107], v[48:51], a[176:179], v[104:107]
    s_nop 7
    buffer_load_dwordx4 v[48:51], v26, s[4:7], s69 offen offset:192
    s_waitcnt vmcnt(0)
    v_mfma_f32_16x16x32_bf16 v[104:107], v[48:51], a[180:183], v[104:107]
    s_nop 7
    buffer_load_dwordx4 v[48:51], v26, s[4:7], s69 offen offset:256
    s_waitcnt vmcnt(0)
    v_mfma_f32_16x16x32_bf16 v[104:107], v[48:51], a[184:187], v[104:107]
    s_nop 7
    buffer_load_dwordx4 v[48:51], v26, s[4:7], s69 offen offset:320
    s_waitcnt vmcnt(0)
    v_mfma_f32_16x16x32_bf16 v[104:107], v[48:51], a[188:191], v[104:107]
    s_nop 7
    s_add_u32 s69, s39, 6144
    buffer_load_dwordx4 v[48:51], v26, s[4:7], s69 offen offset:0
    s_waitcnt vmcnt(0)
    v_mfma_f32_16x16x32_bf16 v[108:111], v[48:51], a[168:171], 0
    s_nop 7
    buffer_load_dwordx4 v[48:51], v26, s[4:7], s69 offen offset:64
    s_waitcnt vmcnt(0)
    v_mfma_f32_16x16x32_bf16 v[108:111], v[48:51], a[172:175], v[108:111]
    s_nop 7
    buffer_load_dwordx4 v[48:51], v26, s[4:7], s69 offen offset:128
    s_waitcnt vmcnt(0)
    v_mfma_f32_16x16x32_bf16 v[108:111], v[48:51], a[176:179], v[108:111]
    s_nop 7
    buffer_load_dwordx4 v[48:51], v26, s[4:7], s69 offen offset:192
    s_waitcnt vmcnt(0)
    v_mfma_f32_16x16x32_bf16 v[108:111], v[48:51], a[180:183], v[108:111]
    s_nop 7
    buffer_load_dwordx4 v[48:51], v26, s[4:7], s69 offen offset:256
    s_waitcnt vmcnt(0)
    v_mfma_f32_16x16x32_bf16 v[108:111], v[48:51], a[184:187], v[108:111]
    s_nop 7
    buffer_load_dwordx4 v[48:51], v26, s[4:7], s69 offen offset:320
    s_waitcnt vmcnt(0)
    v_mfma_f32_16x16x32_bf16 v[108:111], v[48:51], a[188:191], v[108:111]
    s_nop 7
    s_nop 15
    v_max3_f32 v14, v104, v105, v106
    v_max3_f32 v14, v14, v107, v108
    v_max3_f32 v14, v14, v109, v110
    v_max_f32 v14, v14, v111
    v_mov_b32 v15, v14
    s_nop 1
    v_permlane32_swap_b32 v15, v14
    v_max_f32 v14, v14, v15
    v_mov_b32 v15, v14
    s_nop 1
    v_permlane16_swap_b32 v15, v14
    v_max_f32 v14, v14, v15
    v_fma_f32 v14, v14, s28, v12
    v_max_f32 v20, 0, v14
    v_sub_f32 v12, v12, v20
    v_sub_f32 v21, 0, v20
    v_exp_f32 v21, v21
    s_nop 0
    v_mul_f32 v47, v47, v21
    v_accvgpr_read_b32 v15, a0
    v_mul_f32 v15, v15, v21
    v_accvgpr_write_b32 a0, v15
    v_accvgpr_read_b32 v15, a1
    v_mul_f32 v15, v15, v21
    v_accvgpr_write_b32 a1, v15
    v_accvgpr_read_b32 v15, a2
    v_mul_f32 v15, v15, v21
    v_accvgpr_write_b32 a2, v15
    v_accvgpr_read_b32 v15, a3
    v_mul_f32 v15, v15, v21
    v_accvgpr_write_b32 a3, v15
    v_accvgpr_read_b32 v15, a4
    v_mul_f32 v15, v15, v21
    v_accvgpr_write_b32 a4, v15
    v_accvgpr_read_b32 v15, a5
    v_mul_f32 v15, v15, v21
    v_accvgpr_write_b32 a5, v15
    v_accvgpr_read_b32 v15, a6
    v_mul_f32 v15, v15, v21
    v_accvgpr_write_b32 a6, v15
    v_accvgpr_read_b32 v15, a7
    v_mul_f32 v15, v15, v21
    v_accvgpr_write_b32 a7, v15
    v_accvgpr_read_b32 v15, a8
    v_mul_f32 v15, v15, v21
    v_accvgpr_write_b32 a8, v15
    v_accvgpr_read_b32 v15, a9
    v_mul_f32 v15, v15, v21
    v_accvgpr_write_b32 a9, v15
    v_accvgpr_read_b32 v15, a10
    v_mul_f32 v15, v15, v21
    v_accvgpr_write_b32 a10, v15
    v_accvgpr_read_b32 v15, a11
    v_mul_f32 v15, v15, v21
    v_accvgpr_write_b32 a11, v15
    v_accvgpr_read_b32 v15, a12
    v_mul_f32 v15, v15, v21
    v_accvgpr_write_b32 a12, v15
    v_accvgpr_read_b32 v15, a13
    v_mul_f32 v15, v15, v21
    v_accvgpr_write_b32 a13, v15
    v_accvgpr_read_b32 v15, a14
    v_mul_f32 v15, v15, v21
    v_accvgpr_write_b32 a14, v15
    v_accvgpr_read_b32 v15, a15
    v_mul_f32 v15, v15, v21
    v_accvgpr_write_b32 a15, v15
    v_accvgpr_read_b32 v15, a16
    v_mul_f32 v15, v15, v21
    v_accvgpr_write_b32 a16, v15
    v_accvgpr_read_b32 v15, a17
    v_mul_f32 v15, v15, v21
    v_accvgpr_write_b32 a17, v15
    v_accvgpr_read_b32 v15, a18
    v_mul_f32 v15, v15, v21
    v_accvgpr_write_b32 a18, v15
    v_accvgpr_read_b32 v15, a19
    v_mul_f32 v15, v15, v21
    v_accvgpr_write_b32 a19, v15
    v_accvgpr_read_b32 v15, a20
    v_mul_f32 v15, v15, v21
    v_accvgpr_write_b32 a20, v15
    v_accvgpr_read_b32 v15, a21
    v_mul_f32 v15, v15, v21
    v_accvgpr_write_b32 a21, v15
    v_accvgpr_read_b32 v15, a22
    v_mul_f32 v15, v15, v21
    v_accvgpr_write_b32 a22, v15
    v_accvgpr_read_b32 v15, a23
    v_mul_f32 v15, v15, v21
    v_accvgpr_write_b32 a23, v15
    v_accvgpr_read_b32 v15, a24
    v_mul_f32 v15, v15, v21
    v_accvgpr_write_b32 a24, v15
    v_accvgpr_read_b32 v15, a25
    v_mul_f32 v15, v15, v21
    v_accvgpr_write_b32 a25, v15
    v_accvgpr_read_b32 v15, a26
    v_mul_f32 v15, v15, v21
    v_accvgpr_write_b32 a26, v15
    v_accvgpr_read_b32 v15, a27
    v_mul_f32 v15, v15, v21
    v_accvgpr_write_b32 a27, v15
    v_accvgpr_read_b32 v15, a28
    v_mul_f32 v15, v15, v21
    v_accvgpr_write_b32 a28, v15
    v_accvgpr_read_b32 v15, a29
    v_mul_f32 v15, v15, v21
    v_accvgpr_write_b32 a29, v15
    v_accvgpr_read_b32 v15, a30
    v_mul_f32 v15, v15, v21
    v_accvgpr_write_b32 a30, v15
    v_accvgpr_read_b32 v15, a31
    v_mul_f32 v15, v15, v21
    v_accvgpr_write_b32 a31, v15
    v_accvgpr_read_b32 v15, a32
    v_mul_f32 v15, v15, v21
    v_accvgpr_write_b32 a32, v15
    v_accvgpr_read_b32 v15, a33
    v_mul_f32 v15, v15, v21
    v_accvgpr_write_b32 a33, v15
    v_accvgpr_read_b32 v15, a34
    v_mul_f32 v15, v15, v21
    v_accvgpr_write_b32 a34, v15
    v_accvgpr_read_b32 v15, a35
    v_mul_f32 v15, v15, v21
    v_accvgpr_write_b32 a35, v15
    v_accvgpr_read_b32 v15, a36
    v_mul_f32 v15, v15, v21
    v_accvgpr_write_b32 a36, v15
    v_accvgpr_read_b32 v15, a37
    v_mul_f32 v15, v15, v21
    v_accvgpr_write_b32 a37, v15
    v_accvgpr_read_b32 v15, a38
    v_mul_f32 v15, v15, v21
    v_accvgpr_write_b32 a38, v15
    v_accvgpr_read_b32 v15, a39
    v_mul_f32 v15, v15, v21
    v_accvgpr_write_b32 a39, v15
    v_accvgpr_read_b32 v15, a40
    v_mul_f32 v15, v15, v21
    v_accvgpr_write_b32 a40, v15
    v_accvgpr_read_b32 v15, a41
    v_mul_f32 v15, v15, v21
    v_accvgpr_write_b32 a41, v15
    v_accvgpr_read_b32 v15, a42
    v_mul_f32 v15, v15, v21
    v_accvgpr_write_b32 a42, v15
    v_accvgpr_read_b32 v15, a43
    v_mul_f32 v15, v15, v21
    v_accvgpr_write_b32 a43, v15
    v_accvgpr_read_b32 v15, a44
    v_mul_f32 v15, v15, v21
    v_accvgpr_write_b32 a44, v15
    v_accvgpr_read_b32 v15, a45
    v_mul_f32 v15, v15, v21
    v_accvgpr_write_b32 a45, v15
    v_accvgpr_read_b32 v15, a46
    v_mul_f32 v15, v15, v21
    v_accvgpr_write_b32 a46, v15
    v_accvgpr_read_b32 v15, a47
    v_mul_f32 v15, v15, v21
    v_accvgpr_write_b32 a47, v15
    v_fma_f32 v104, v104, s28, v12
    v_fma_f32 v105, v105, s28, v12
    v_exp_f32 v104, v104
    v_exp_f32 v105, v105
    s_nop 0
    v_cvt_pk_bf16_f32 v36, v104, v105
    v_fma_f32 v106, v106, s28, v12
    v_fma_f32 v107, v107, s28, v12
    v_exp_f32 v106, v106
    v_exp_f32 v107, v107
    s_nop 0
    v_cvt_pk_bf16_f32 v37, v106, v107
    v_fma_f32 v108, v108, s28, v12
    v_fma_f32 v109, v109, s28, v12
    v_exp_f32 v108, v108
    v_exp_f32 v109, v109
    s_nop 0
    v_cvt_pk_bf16_f32 v34, v108, v109
    v_fma_f32 v110, v110, s28, v12
    v_fma_f32 v111, v111, s28, v12
    v_exp_f32 v110, v110
    v_exp_f32 v111, v111
    s_nop 0
    v_cvt_pk_bf16_f32 v35, v110, v111
    v_mfma_f32_16x16x32_bf16 v[48:51], a[236:239], v[16:19], v[44:47]
    v_mfma_f32_16x16x32_bf16 v[48:51], a[240:243], v[22:25], v[48:51]
    v_mfma_f32_16x16x32_bf16 v[48:51], a[244:247], v[28:31], v[48:51]
    v_mfma_f32_16x16x32_bf16 v[48:51], a[248:251], v[34:37], v[48:51]
    s_nop 15
    s_setpc_b64 s[40:41]
L_rs_start5b:
    s_call_b64 s[40:41], L_rare5_1
    s_branch L_ret_start5b
L_rs_loop5w0a:
    s_call_b64 s[40:41], L_rare5_0
    s_branch L_ret_loop5w0a
L_rs_loop5w0b:
    s_call_b64 s[40:41], L_rare5_1
    s_branch L_ret_loop5w0b
L_rs_end5a:
    s_call_b64 s[40:41], L_rare5_0
    s_branch L_ret_end5a
L_rs_end5b:
    s_call_b64 s[40:41], L_rare5_1
    s_branch L_ret_end5b
L_rs_start4b:
    s_call_b64 s[40:41], L_rare4_1
    s_branch L_ret_start4b
L_rs_loop4w0a:
    s_call_b64 s[40:41], L_rare4_0
    s_branch L_ret_loop4w0a
L_rs_loop4w0b:
    s_call_b64 s[40:41], L_rare4_1
    s_branch L_ret_loop4w0b
L_rs_end4a:
    s_call_b64 s[40:41], L_rare4_0
    s_branch L_ret_end4a
L_rs_end4b:
    s_call_b64 s[40:41], L_rare4_1
    s_branch L_ret_end4b
L_rs_tr54a:
    s_call_b64 s[40:41], L_rare5_0
    s_branch L_ret_tr54a
L_rs_tr54b:
    s_nop 15
    s_waitcnt vmcnt(0) lgkmcnt(0)
    s_mov_b32 s68, s14
    s_mov_b32 s14, 166723584
    v_mbcnt_lo_u32_b32 v105, -1, 0
    v_mbcnt_hi_u32_b32 v105, -1, v105
    v_and_b32 v104, 15, v105
    v_mul_u32_u24 v104, 384, v104
    v_lshrrev_b32 v105, 4, v105
    v_lshl_add_u32 v104, v105, 4, v104
    s_add_u32 s69, s34, 0
    buffer_load_dwordx4 a[96:99], v104, s[12:15], s69 offen offset:0
    buffer_load_dwordx4 a[100:103], v104, s[12:15], s69 offen offset:64
    buffer_load_dwordx4 a[104:107], v104, s[12:15], s69 offen offset:128
    buffer_load_dwordx4 a[108:111], v104, s[12:15], s69 offen offset:192
    buffer_load_dwordx4 a[112:115], v104, s[12:15], s69 offen offset:256
    buffer_load_dwordx4 a[116:119], v104, s[12:15], s69 offen offset:320
    s_add_u32 s69, s34, 6144
    buffer_load_dwordx4 a[120:123], v104, s[12:15], s69 offen offset:0
    buffer_load_dwordx4 a[124:127], v104, s[12:15], s69 offen offset:64
    buffer_load_dwordx4 a[128:131], v104, s[12:15], s69 offen offset:128
    buffer_load_dwordx4 a[132:135], v104, s[12:15], s69 offen offset:192
    buffer_load_dwordx4 a[136:139], v104, s[12:15], s69 offen offset:256
    buffer_load_dwordx4 a[140:143], v104, s[12:15], s69 offen offset:320
    s_add_u32 s69, s34, 12288
    buffer_load_dwordx4 a[144:147], v104, s[12:15], s69 offen offset:0
    buffer_load_dwordx4 a[148:151], v104, s[12:15], s69 offen offset:64
    buffer_load_dwordx4 a[152:155], v104, s[12:15], s69 offen offset:128
    buffer_load_dwordx4 a[156:159], v104, s[12:15], s69 offen offset:192
    buffer_load_dwordx4 a[160:163], v104, s[12:15], s69 offen offset:256
    buffer_load_dwordx4 a[164:167], v104, s[12:15], s69 offen offset:320
    s_add_u32 s69, s34, 18432
    buffer_load_dwordx4 a[168:171], v104, s[12:15], s69 offen offset:0
    buffer_load_dwordx4 a[172:175], v104, s[12:15], s69 offen offset:64
    buffer_load_dwordx4 a[176:179], v104, s[12:15], s69 offen offset:128
    buffer_load_dwordx4 a[180:183], v104, s[12:15], s69 offen offset:192
    buffer_load_dwordx4 a[184:187], v104, s[12:15], s69 offen offset:256
    buffer_load_dwordx4 a[188:191], v104, s[12:15], s69 offen offset:320
    s_add_u32 s69, s34, 24576
    buffer_load_dwordx4 a[192:195], v104, s[12:15], s69 offen offset:0
    buffer_load_dwordx4 a[196:199], v104, s[12:15], s69 offen offset:64
    buffer_load_dwordx4 a[200:203], v104, s[12:15], s69 offen offset:128
    buffer_load_dwordx4 a[204:207], v104, s[12:15], s69 offen offset:192
    buffer_load_dwordx4 a[208:211], v104, s[12:15], s69 offen offset:256
    buffer_load_dwordx4 v[92:95], v104, s[12:15], s69 offen offset:320
    s_waitcnt vmcnt(0)
    s_call_b64 s[40:41], L_rare5_1
    v_mbcnt_lo_u32_b32 v105, -1, 0
    v_mbcnt_hi_u32_b32 v105, -1, v105
    v_and_b32 v104, 15, v105
    v_mul_u32_u24 v104, 384, v104
    v_lshrrev_b32 v105, 4, v105
    v_lshl_add_u32 v104, v105, 4, v104
    s_add_u32 s69, s33, 0
    buffer_load_dwordx4 a[96:99], v104, s[12:15], s69 offen offset:0
    buffer_load_dwordx4 a[100:103], v104, s[12:15], s69 offen offset:64
    buffer_load_dwordx4 a[104:107], v104, s[12:15], s69 offen offset:128
    buffer_load_dwordx4 a[108:111], v104, s[12:15], s69 offen offset:192
    buffer_load_dwordx4 a[112:115], v104, s[12:15], s69 offen offset:256
    buffer_load_dwordx4 a[116:119], v104, s[12:15], s69 offen offset:320
    s_add_u32 s69, s33, 6144
    buffer_load_dwordx4 a[120:123], v104, s[12:15], s69 offen offset:0
    buffer_load_dwordx4 a[124:127], v104, s[12:15], s69 offen offset:64
    buffer_load_dwordx4 a[128:131], v104, s[12:15], s69 offen offset:128
    buffer_load_dwordx4 a[132:135], v104, s[12:15], s69 offen offset:192
    buffer_load_dwordx4 a[136:139], v104, s[12:15], s69 offen offset:256
    buffer_load_dwordx4 a[140:143], v104, s[12:15], s69 offen offset:320
    s_add_u32 s69, s33, 12288
    buffer_load_dwordx4 a[144:147], v104, s[12:15], s69 offen offset:0
    buffer_load_dwordx4 a[148:151], v104, s[12:15], s69 offen offset:64
    buffer_load_dwordx4 a[152:155], v104, s[12:15], s69 offen offset:128
    buffer_load_dwordx4 a[156:159], v104, s[12:15], s69 offen offset:192
    buffer_load_dwordx4 a[160:163], v104, s[12:15], s69 offen offset:256
    buffer_load_dwordx4 a[164:167], v104, s[12:15], s69 offen offset:320
    s_add_u32 s69, s33, 18432
    buffer_load_dwordx4 a[168:171], v104, s[12:15], s69 offen offset:0
    buffer_load_dwordx4 a[172:175], v104, s[12:15], s69 offen offset:64
    buffer_load_dwordx4 a[176:179], v104, s[12:15], s69 offen offset:128
    buffer_load_dwordx4 a[180:183], v104, s[12:15], s69 offen offset:192
    buffer_load_dwordx4 a[184:187], v104, s[12:15], s69 offen offset:256
    buffer_load_dwordx4 a[188:191], v104, s[12:15], s69 offen offset:320
    s_waitcnt vmcnt(0)
    s_mov_b32 s14, s68
    s_branch L_ret_tr54b
L_rs_tr54d:
    s_call_b64 s[40:41], L_rare4_1
    s_branch L_ret_tr54d
L_rs_tr45a:
    s_call_b64 s[40:41], L_rare4_0
    s_branch L_ret_tr45a
L_rs_tr45b:
    s_nop 15
    s_waitcnt vmcnt(0) lgkmcnt(0)
    s_mov_b32 s68, s14
    s_mov_b32 s14, 166723584
    v_mbcnt_lo_u32_b32 v105, -1, 0
    v_mbcnt_hi_u32_b32 v105, -1, v105
    v_and_b32 v104, 15, v105
    v_mul_u32_u24 v104, 384, v104
    v_lshrrev_b32 v105, 4, v105
    v_lshl_add_u32 v104, v105, 4, v104
    s_add_u32 s69, s34, 0
    buffer_load_dwordx4 a[96:99], v104, s[12:15], s69 offen offset:0
    buffer_load_dwordx4 a[100:103], v104, s[12:15], s69 offen offset:64
    buffer_load_dwordx4 a[104:107], v104, s[12:15], s69 offen offset:128
    buffer_load_dwordx4 a[108:111], v104, s[12:15], s69 offen offset:192
    buffer_load_dwordx4 a[112:115], v104, s[12:15], s69 offen offset:256
    buffer_load_dwordx4 a[116:119], v104, s[12:15], s69 offen offset:320
    s_add_u32 s69, s34, 6144
    buffer_load_dwordx4 a[120:123], v104, s[12:15], s69 offen offset:0
    buffer_load_dwordx4 a[124:127], v104, s[12:15], s69 offen offset:64
    buffer_load_dwordx4 a[128:131], v104, s[12:15], s69 offen offset:128
    buffer_load_dwordx4 a[132:135], v104, s[12:15], s69 offen offset:192
    buffer_load_dwordx4 a[136:139], v104, s[12:15], s69 offen offset:256
    buffer_load_dwordx4 a[140:143], v104, s[12:15], s69 offen offset:320
    s_add_u32 s69, s34, 12288
    buffer_load_dwordx4 a[144:147], v104, s[12:15], s69 offen offset:0
    buffer_load_dwordx4 a[148:151], v104, s[12:15], s69 offen offset:64
    buffer_load_dwordx4 a[152:155], v104, s[12:15], s69 offen offset:128
    buffer_load_dwordx4 a[156:159], v104, s[12:15], s69 offen offset:192
    buffer_load_dwordx4 a[160:163], v104, s[12:15], s69 offen offset:256
    buffer_load_dwordx4 a[164:167], v104, s[12:15], s69 offen offset:320
    s_add_u32 s69, s34, 18432
    buffer_load_dwordx4 a[168:171], v104, s[12:15], s69 offen offset:0
    buffer_load_dwordx4 a[172:175], v104, s[12:15], s69 offen offset:64
    buffer_load_dwordx4 a[176:179], v104, s[12:15], s69 offen offset:128
    buffer_load_dwordx4 a[180:183], v104, s[12:15], s69 offen offset:192
    buffer_load_dwordx4 a[184:187], v104, s[12:15], s69 offen offset:256
    buffer_load_dwordx4 a[188:191], v104, s[12:15], s69 offen offset:320
    s_waitcnt vmcnt(0)
    s_call_b64 s[40:41], L_rare4_1
    v_mbcnt_lo_u32_b32 v105, -1, 0
    v_mbcnt_hi_u32_b32 v105, -1, v105
    v_and_b32 v104, 15, v105
    v_mul_u32_u24 v104, 384, v104
    v_lshrrev_b32 v105, 4, v105
    v_lshl_add_u32 v104, v105, 4, v104
    s_add_u32 s69, s33, 0
    buffer_load_dwordx4 a[96:99], v104, s[12:15], s69 offen offset:0
    buffer_load_dwordx4 a[100:103], v104, s[12:15], s69 offen offset:64
    buffer_load_dwordx4 a[104:107], v104, s[12:15], s69 offen offset:128
    buffer_load_dwordx4 a[108:111], v104, s[12:15], s69 offen offset:192
    buffer_load_dwordx4 a[112:115], v104, s[12:15], s69 offen offset:256
    buffer_load_dwordx4 a[116:119], v104, s[12:15], s69 offen offset:320
    s_add_u32 s69, s33, 6144
    buffer_load_dwordx4 a[120:123], v104, s[12:15], s69 offen offset:0
    buffer_load_dwordx4 a[124:127], v104, s[12:15], s69 offen offset:64
    buffer_load_dwordx4 a[128:131], v104, s[12:15], s69 offen offset:128
    buffer_load_dwordx4 a[132:135], v104, s[12:15], s69 offen offset:192
    buffer_load_dwordx4 a[136:139], v104, s[12:15], s69 offen offset:256
    buffer_load_dwordx4 a[140:143], v104, s[12:15], s69 offen offset:320
    s_add_u32 s69, s33, 12288
    buffer_load_dwordx4 a[144:147], v104, s[12:15], s69 offen offset:0
    buffer_load_dwordx4 a[148:151], v104, s[12:15], s69 offen offset:64
    buffer_load_dwordx4 a[152:155], v104, s[12:15], s69 offen offset:128
    buffer_load_dwordx4 a[156:159], v104, s[12:15], s69 offen offset:192
    buffer_load_dwordx4 a[160:163], v104, s[12:15], s69 offen offset:256
    buffer_load_dwordx4 a[164:167], v104, s[12:15], s69 offen offset:320
    s_add_u32 s69, s33, 18432
    buffer_load_dwordx4 a[168:171], v104, s[12:15], s69 offen offset:0
    buffer_load_dwordx4 a[172:175], v104, s[12:15], s69 offen offset:64
    buffer_load_dwordx4 a[176:179], v104, s[12:15], s69 offen offset:128
    buffer_load_dwordx4 a[180:183], v104, s[12:15], s69 offen offset:192
    buffer_load_dwordx4 a[184:187], v104, s[12:15], s69 offen offset:256
    buffer_load_dwordx4 a[188:191], v104, s[12:15], s69 offen offset:320
    s_add_u32 s69, s33, 24576
    buffer_load_dwordx4 a[192:195], v104, s[12:15], s69 offen offset:0
    buffer_load_dwordx4 a[196:199], v104, s[12:15], s69 offen offset:64
    buffer_load_dwordx4 a[200:203], v104, s[12:15], s69 offen offset:128
    buffer_load_dwordx4 a[204:207], v104, s[12:15], s69 offen offset:192
    buffer_load_dwordx4 a[208:211], v104, s[12:15], s69 offen offset:256
    buffer_load_dwordx4 v[92:95], v104, s[12:15], s69 offen offset:320
    s_waitcnt vmcnt(0)
    s_mov_b32 s14, s68
    s_branch L_ret_tr45b
L_rs_tr45d:
    s_call_b64 s[40:41], L_rare5_1
    s_branch L_ret_tr45d
L_rs_tr44a:
    s_call_b64 s[40:41], L_rare4_0
    s_branch L_ret_tr44a
L_rs_tr44b:
    s_nop 15
    s_waitcnt vmcnt(0) lgkmcnt(0)
    s_mov_b32 s68, s14
    s_mov_b32 s14, 166723584
    v_mbcnt_lo_u32_b32 v105, -1, 0
    v_mbcnt_hi_u32_b32 v105, -1, v105
    v_and_b32 v104, 15, v105
    v_mul_u32_u24 v104, 384, v104
    v_lshrrev_b32 v105, 4, v105
    v_lshl_add_u32 v104, v105, 4, v104
    s_add_u32 s69, s34, 0
    buffer_load_dwordx4 a[96:99], v104, s[12:15], s69 offen offset:0
    buffer_load_dwordx4 a[100:103], v104, s[12:15], s69 offen offset:64
    buffer_load_dwordx4 a[104:107], v104, s[12:15], s69 offen offset:128
    buffer_load_dwordx4 a[108:111], v104, s[12:15], s69 offen offset:192
    buffer_load_dwordx4 a[112:115], v104, s[12:15], s69 offen offset:256
    buffer_load_dwordx4 a[116:119], v104, s[12:15], s69 offen offset:320
    s_add_u32 s69, s34, 6144
    buffer_load_dwordx4 a[120:123], v104, s[12:15], s69 offen offset:0
    buffer_load_dwordx4 a[124:127], v104, s[12:15], s69 offen offset:64
    buffer_load_dwordx4 a[128:131], v104, s[12:15], s69 offen offset:128
    buffer_load_dwordx4 a[132:135], v104, s[12:15], s69 offen offset:192
    buffer_load_dwordx4 a[136:139], v104, s[12:15], s69 offen offset:256
    buffer_load_dwordx4 a[140:143], v104, s[12:15], s69 offen offset:320
    s_add_u32 s69, s34, 12288
    buffer_load_dwordx4 a[144:147], v104, s[12:15], s69 offen offset:0
    buffer_load_dwordx4 a[148:151], v104, s[12:15], s69 offen offset:64
    buffer_load_dwordx4 a[152:155], v104, s[12:15], s69 offen offset:128
    buffer_load_dwordx4 a[156:159], v104, s[12:15], s69 offen offset:192
    buffer_load_dwordx4 a[160:163], v104, s[12:15], s69 offen offset:256
    buffer_load_dwordx4 a[164:167], v104, s[12:15], s69 offen offset:320
    s_add_u32 s69, s34, 18432
    buffer_load_dwordx4 a[168:171], v104, s[12:15], s69 offen offset:0
    buffer_load_dwordx4 a[172:175], v104, s[12:15], s69 offen offset:64
    buffer_load_dwordx4 a[176:179], v104, s[12:15], s69 offen offset:128
    buffer_load_dwordx4 a[180:183], v104, s[12:15], s69 offen offset:192
    buffer_load_dwordx4 a[184:187], v104, s[12:15], s69 offen offset:256
    buffer_load_dwordx4 a[188:191], v104, s[12:15], s69 offen offset:320
    s_waitcnt vmcnt(0)
    s_call_b64 s[40:41], L_rare4_1
    v_mbcnt_lo_u32_b32 v105, -1, 0
    v_mbcnt_hi_u32_b32 v105, -1, v105
    v_and_b32 v104, 15, v105
    v_mul_u32_u24 v104, 384, v104
    v_lshrrev_b32 v105, 4, v105
    v_lshl_add_u32 v104, v105, 4, v104
    s_add_u32 s69, s33, 0
    buffer_load_dwordx4 a[96:99], v104, s[12:15], s69 offen offset:0
    buffer_load_dwordx4 a[100:103], v104, s[12:15], s69 offen offset:64
    buffer_load_dwordx4 a[104:107], v104, s[12:15], s69 offen offset:128
    buffer_load_dwordx4 a[108:111], v104, s[12:15], s69 offen offset:192
    buffer_load_dwordx4 a[112:115], v104, s[12:15], s69 offen offset:256
    buffer_load_dwordx4 a[116:119], v104, s[12:15], s69 offen offset:320
    s_add_u32 s69, s33, 6144
    buffer_load_dwordx4 a[120:123], v104, s[12:15], s69 offen offset:0
    buffer_load_dwordx4 a[124:127], v104, s[12:15], s69 offen offset:64
    buffer_load_dwordx4 a[128:131], v104, s[12:15], s69 offen offset:128
    buffer_load_dwordx4 a[132:135], v104, s[12:15], s69 offen offset:192
    buffer_load_dwordx4 a[136:139], v104, s[12:15], s69 offen offset:256
    buffer_load_dwordx4 a[140:143], v104, s[12:15], s69 offen offset:320
    s_add_u32 s69, s33, 12288
    buffer_load_dwordx4 a[144:147], v104, s[12:15], s69 offen offset:0
    buffer_load_dwordx4 a[148:151], v104, s[12:15], s69 offen offset:64
    buffer_load_dwordx4 a[152:155], v104, s[12:15], s69 offen offset:128
    buffer_load_dwordx4 a[156:159], v104, s[12:15], s69 offen offset:192
    buffer_load_dwordx4 a[160:163], v104, s[12:15], s69 offen offset:256
    buffer_load_dwordx4 a[164:167], v104, s[12:15], s69 offen offset:320
    s_add_u32 s69, s33, 18432
    buffer_load_dwordx4 a[168:171], v104, s[12:15], s69 offen offset:0
    buffer_load_dwordx4 a[172:175], v104, s[12:15], s69 offen offset:64
    buffer_load_dwordx4 a[176:179], v104, s[12:15], s69 offen offset:128
    buffer_load_dwordx4 a[180:183], v104, s[12:15], s69 offen offset:192
    buffer_load_dwordx4 a[184:187], v104, s[12:15], s69 offen offset:256
    buffer_load_dwordx4 a[188:191], v104, s[12:15], s69 offen offset:320
    s_waitcnt vmcnt(0)
    s_mov_b32 s14, s68
    s_branch L_ret_tr44b
L_rs_tr44d:
    s_call_b64 s[40:41], L_rare4_1
    s_branch L_ret_tr44d
L_rs_tr55a:
    s_call_b64 s[40:41], L_rare5_0
    s_branch L_ret_tr55a
L_rs_tr55b:
    s_nop 15
    s_waitcnt vmcnt(0) lgkmcnt(0)
    s_mov_b32 s68, s14
    s_mov_b32 s14, 166723584
    v_mbcnt_lo_u32_b32 v105, -1, 0
    v_mbcnt_hi_u32_b32 v105, -1, v105
    v_and_b32 v104, 15, v105
    v_mul_u32_u24 v104, 384, v104
    v_lshrrev_b32 v105, 4, v105
    v_lshl_add_u32 v104, v105, 4, v104
    s_add_u32 s69, s34, 0
    buffer_load_dwordx4 a[96:99], v104, s[12:15], s69 offen offset:0
    buffer_load_dwordx4 a[100:103], v104, s[12:15], s69 offen offset:64
    buffer_load_dwordx4 a[104:107], v104, s[12:15], s69 offen offset:128
    buffer_load_dwordx4 a[108:111], v104, s[12:15], s69 offen offset:192
    buffer_load_dwordx4 a[112:115], v104, s[12:15], s69 offen offset:256
    buffer_load_dwordx4 a[116:119], v104, s[12:15], s69 offen offset:320
    s_add_u32 s69, s34, 6144
    buffer_load_dwordx4 a[120:123], v104, s[12:15], s69 offen offset:0
    buffer_load_dwordx4 a[124:127], v104, s[12:15], s69 offen offset:64
    buffer_load_dwordx4 a[128:131], v104, s[12:15], s69 offen offset:128
    buffer_load_dwordx4 a[132:135], v104, s[12:15], s69 offen offset:192
    buffer_load_dwordx4 a[136:139], v104, s[12:15], s69 offen offset:256
    buffer_load_dwordx4 a[140:143], v104, s[12:15], s69 offen offset:320
    s_add_u32 s69, s34, 12288
    buffer_load_dwordx4 a[144:147], v104, s[12:15], s69 offen offset:0
    buffer_load_dwordx4 a[148:151], v104, s[12:15], s69 offen offset:64
    buffer_load_dwordx4 a[152:155], v104, s[12:15], s69 offen offset:128
    buffer_load_dwordx4 a[156:159], v104, s[12:15], s69 offen offset:192
    buffer_load_dwordx4 a[160:163], v104, s[12:15], s69 offen offset:256
    buffer_load_dwordx4 a[164:167], v104, s[12:15], s69 offen offset:320
    s_add_u32 s69, s34, 18432
    buffer_load_dwordx4 a[168:171], v104, s[12:15], s69 offen offset:0
    buffer_load_dwordx4 a[172:175], v104, s[12:15], s69 offen offset:64
    buffer_load_dwordx4 a[176:179], v104, s[12:15], s69 offen offset:128
    buffer_load_dwordx4 a[180:183], v104, s[12:15], s69 offen offset:192
    buffer_load_dwordx4 a[184:187], v104, s[12:15], s69 offen offset:256
    buffer_load_dwordx4 a[188:191], v104, s[12:15], s69 offen offset:320
    s_add_u32 s69, s34, 24576
    buffer_load_dwordx4 a[192:195], v104, s[12:15], s69 offen offset:0
    buffer_load_dwordx4 a[196:199], v104, s[12:15], s69 offen offset:64
    buffer_load_dwordx4 a[200:203], v104, s[12:15], s69 offen offset:128
    buffer_load_dwordx4 a[204:207], v104, s[12:15], s69 offen offset:192
    buffer_load_dwordx4 a[208:211], v104, s[12:15], s69 offen offset:256
    buffer_load_dwordx4 v[92:95], v104, s[12:15], s69 offen offset:320
    s_waitcnt vmcnt(0)
    s_call_b64 s[40:41], L_rare5_1
    v_mbcnt_lo_u32_b32 v105, -1, 0
    v_mbcnt_hi_u32_b32 v105, -1, v105
    v_and_b32 v104, 15, v105
    v_mul_u32_u24 v104, 384, v104
    v_lshrrev_b32 v105, 4, v105
    v_lshl_add_u32 v104, v105, 4, v104
    s_add_u32 s69, s33, 0
    buffer_load_dwordx4 a[96:99], v104, s[12:15], s69 offen offset:0
    buffer_load_dwordx4 a[100:103], v104, s[12:15], s69 offen offset:64
    buffer_load_dwordx4 a[104:107], v104, s[12:15], s69 offen offset:128
    buffer_load_dwordx4 a[108:111], v104, s[12:15], s69 offen offset:192
    buffer_load_dwordx4 a[112:115], v104, s[12:15], s69 offen offset:256
    buffer_load_dwordx4 a[116:119], v104, s[12:15], s69 offen offset:320
    s_add_u32 s69, s33, 6144
    buffer_load_dwordx4 a[120:123], v104, s[12:15], s69 offen offset:0
    buffer_load_dwordx4 a[124:127], v104, s[12:15], s69 offen offset:64
    buffer_load_dwordx4 a[128:131], v104, s[12:15], s69 offen offset:128
    buffer_load_dwordx4 a[132:135], v104, s[12:15], s69 offen offset:192
    buffer_load_dwordx4 a[136:139], v104, s[12:15], s69 offen offset:256
    buffer_load_dwordx4 a[140:143], v104, s[12:15], s69 offen offset:320
    s_add_u32 s69, s33, 12288
    buffer_load_dwordx4 a[144:147], v104, s[12:15], s69 offen offset:0
    buffer_load_dwordx4 a[148:151], v104, s[12:15], s69 offen offset:64
    buffer_load_dwordx4 a[152:155], v104, s[12:15], s69 offen offset:128
    buffer_load_dwordx4 a[156:159], v104, s[12:15], s69 offen offset:192
    buffer_load_dwordx4 a[160:163], v104, s[12:15], s69 offen offset:256
    buffer_load_dwordx4 a[164:167], v104, s[12:15], s69 offen offset:320
    s_add_u32 s69, s33, 18432
    buffer_load_dwordx4 a[168:171], v104, s[12:15], s69 offen offset:0
    buffer_load_dwordx4 a[172:175], v104, s[12:15], s69 offen offset:64
    buffer_load_dwordx4 a[176:179], v104, s[12:15], s69 offen offset:128
    buffer_load_dwordx4 a[180:183], v104, s[12:15], s69 offen offset:192
    buffer_load_dwordx4 a[184:187], v104, s[12:15], s69 offen offset:256
    buffer_load_dwordx4 a[188:191], v104, s[12:15], s69 offen offset:320
    s_add_u32 s69, s33, 24576
    buffer_load_dwordx4 a[192:195], v104, s[12:15], s69 offen offset:0
    buffer_load_dwordx4 a[196:199], v104, s[12:15], s69 offen offset:64
    buffer_load_dwordx4 a[200:203], v104, s[12:15], s69 offen offset:128
    buffer_load_dwordx4 a[204:207], v104, s[12:15], s69 offen offset:192
    buffer_load_dwordx4 a[208:211], v104, s[12:15], s69 offen offset:256
    buffer_load_dwordx4 v[92:95], v104, s[12:15], s69 offen offset:320
    s_waitcnt vmcnt(0)
    s_mov_b32 s14, s68
    s_branch L_ret_tr55b
L_rs_tr55d:
    s_call_b64 s[40:41], L_rare5_1
    s_branch L_ret_tr55d
.section .rodata,"a"
.p2align 6
.amdhsa_kernel standalone__gqa_softmax__near_ridge_kernel
  .amdhsa_next_free_vgpr 512
  .amdhsa_next_free_sgpr 102
  .amdhsa_accum_offset 256
  .amdhsa_group_segment_fixed_size 0
  .amdhsa_kernarg_size 48
  .amdhsa_user_sgpr_count 2
  .amdhsa_user_sgpr_kernarg_segment_ptr 1
  .amdhsa_system_sgpr_workgroup_id_x 1
.end_amdhsa_kernel
```

```asm
; @launch grid=(256,1,1) block=(256,1,1) lds=163840
.amdgcn_target "amdgcn-amd-amdhsa--gfx950"
.text
.globl standalone__gqa_softmax__near_ridge_kernel
.p2align 8
.type standalone__gqa_softmax__near_ridge_kernel,@function
standalone__gqa_softmax__near_ridge_kernel:
    s_cmp_ge_u32 s2, 256
    s_cbranch_scc1 L_end
    s_load_dwordx4 s[84:87], s[0:1], 0
    s_load_dwordx4 s[88:91], s[0:1], 16
    v_lshrrev_b32 v110, 6, v0
    v_and_b32 v111, 63, v0
    s_getpc_b64 s[60:61]
L_pc:
    s_lshr_b32 s62, s2, 3
    v_lshl_add_u32 v53, s62, 2, v110
    v_min_u32 v52, ((L_codeend-L_pc+16383)/16384)-1, v111
    v_mul_u32_u24 v53, ((L_codeend-L_pc+16383)/16384), v53
    v_add_lshl_u32 v52, v52, v53, 7
    v_min_u32 v52, L_codeend-L_pc-4, v52
    global_load_dword v53, v52, s[60:61]
    v_readfirstlane_b32 s3, v110
    v_lshrrev_b32 v96, 3, v111
    v_mul_u32_u24 v7, 384, v96
    v_lshrrev_b32 v97, 1, v96
    v_lshlrev_b32 v97, 1, v97
    v_and_b32 v98, 7, v111
    v_xor_b32 v97, v97, v98
    v_lshl_add_u32 v7, v97, 4, v7
    s_and_b32 s65, s3, 1
    s_mul_i32 s42, s65, 80
    s_mul_i32 s43, s65, 3072
    v_xor_b32 v6, s42, v7
    v_xor_b32 v7, 80, v6
    v_add_u32 v6, s43, v6
    s_sub_u32 s43, 3072, s43
    v_add_u32 v7, s43, v7
    s_mov_b32 s28, 0x3dd53b95
    s_mov_b32 s29, 0x4e800000
    s_mov_b32 s49, 5888
    s_mov_b32 s46, 0
    s_mov_b32 s47, 0xffff0000
    s_and_b32 s42, s2, 7
    s_lshr_b32 s43, s2, 3
    s_mul_i32 s44, s43, 43
    s_lshr_b32 s44, s44, 7
    s_mov_b32 s39, s44
    s_mul_i32 s45, s44, 3
    s_sub_u32 s36, s43, s45
    s_lshl_b32 s42, s42, 6
    s_lshl_b32 s45, s45, 1
    s_add_u32 s42, s42, s45
    s_mul_i32 s64, s42, 196608
    s_mul_i32 s35, s42, 325632
    s_lshr_b32 s42, s44, 1
    s_mov_b32 s31, 0x6900924
    s_cmp_eq_u32 s42, 1
    s_cselect_b32 s31, 0x14a0489, s31
    s_cmp_eq_u32 s42, 2
    s_cselect_b32 s31, 0x8250258, s31
    s_cmp_eq_u32 s42, 3
    s_cselect_b32 s31, 0x8940912, s31
    s_cmp_eq_u32 s42, 4
    s_cselect_b32 s31, 0x1a10606, s31
    s_and_b32 s42, s44, 1
    s_lshl_b32 s42, s42, 4
    s_lshr_b32 s31, s31, s42
    s_and_b32 s31, s31, 0xffff
    s_cmp_eq_u32 s43, 30
    s_cselect_b32 s31, 0x120648, s31
    s_cmp_eq_u32 s43, 31
    s_cselect_b32 s31, 0x240219, s31
    s_lshr_b32 s63, s31, 16
    s_cmp_ge_u32 s43, 30
    s_cselect_b32 s36, 0, s36
    s_cselect_b32 s42, 4, 6
    s_mul_i32 s42, s42, 196608
    s_add_u32 s6, s64, s42
    s_mov_b32 s10, s6
    s_mul_i32 s22, s3, 3072
    s_mul_i32 s38, s3, 28672
    s_add_u32 s38, s38, 49152
    s_and_b32 s42, s3, 2
    s_mul_i32 s42, s42, 3072
    s_add_u32 s20, s64, s42
    s_mov_b32 s21, s20
    s_mov_b32 s14, 166723584
    s_mov_b32 s18, 0
    s_mov_b32 s67, 0
    s_mov_b32 s37, 0
    s_mov_b32 s60, 0
    s_mov_b32 s61, 0xffff
    s_lshl_b32 s42, s37, 1
    s_lshr_b32 s42, s31, s42
    s_and_b32 s42, s42, 3
    s_add_u32 s42, s42, s36
    s_sub_u32 s43, s42, 3
    s_cmp_ge_u32 s42, 3
    s_cselect_b32 s42, s43, s42
    s_mul_i32 s44, s3, 5
    s_mov_b32 s32, 1
    s_lshl_b32 s43, s3, 2
    s_add_u32 s45, s43, 21
    s_cmp_eq_u32 s3, 0
    s_cselect_b32 s45, 20, s45
    s_cselect_b32 s34, 1, 0
    s_cmp_eq_u32 s42, 1
    s_cselect_b32 s44, s45, s44
    s_cselect_b32 s32, s34, s32
    s_add_u32 s45, s43, 37
    s_cmp_eq_u32 s42, 2
    s_cselect_b32 s44, s45, s44
    s_cselect_b32 s32, 0, s32
    s_mul_i32 s44, s44, 6144
    s_add_u32 s34, s35, s44
    s_waitcnt lgkmcnt(0)
    s_mov_b32 s12, s84
    s_and_b32 s13, s85, 0xffff
    s_mov_b32 s15, 0x20000
    s_mov_b32 s4, s86
    s_and_b32 s5, s87, 0xffff
    s_mov_b32 s7, 0x20000
    s_mov_b32 s8, s88
    s_and_b32 s9, s89, 0xffff
    s_mov_b32 s11, 0x20000
    s_mov_b32 s16, s90
    s_and_b32 s17, s91, 0xffff
    s_mov_b32 s19, 0x20000
    s_cmp_eq_u32 s32, 0
    s_cbranch_scc1 L_start4
L_start5:
    s_add_u32 m0, s22, 0
    s_nop 0
    buffer_load_dwordx4 v6, s[4:7], s20 offen lds
    s_add_u32 s20, s20, 128
    s_add_u32 m0, s22, 1024
    s_nop 0
    buffer_load_dwordx4 v6, s[4:7], s20 offen lds
    s_add_u32 s20, s20, 128
    s_add_u32 m0, s22, 2048
    s_nop 0
    buffer_load_dwordx4 v6, s[4:7], s20 offen lds
    s_add_u32 s20, s20, 12032
    s_add_u32 m0, s22, 12288
    s_nop 0
    buffer_load_dwordx4 v6, s[4:7], s20 offen lds
    s_add_u32 s20, s20, 128
    s_add_u32 m0, s22, 13312
    s_nop 0
    buffer_load_dwordx4 v6, s[4:7], s20 offen lds
    s_add_u32 s20, s20, 128
    s_add_u32 m0, s22, 14336
    s_nop 0
    buffer_load_dwordx4 v6, s[4:7], s20 offen lds
    s_add_u32 s20, s20, 12032
    s_add_u32 s48, s34, 0
    s_add_u32 m0, s38, 0
    s_nop 0
    buffer_load_dwordx4 v6, s[12:15], s48 offen nt lds
    s_add_u32 m0, s38, 1024
    s_nop 0
    buffer_load_dwordx4 v7, s[12:15], s48 offen nt lds
    s_add_u32 s48, s34, 128
    s_add_u32 m0, s38, 2048
    s_nop 0
    buffer_load_dwordx4 v6, s[12:15], s48 offen nt lds
    s_add_u32 m0, s38, 3072
    s_nop 0
    buffer_load_dwordx4 v7, s[12:15], s48 offen nt lds
    s_add_u32 s48, s34, 256
    s_add_u32 m0, s38, 4096
    s_nop 0
    buffer_load_dwordx4 v6, s[12:15], s48 offen nt lds
    s_add_u32 m0, s38, 5120
    s_nop 0
    buffer_load_dwordx4 v7, s[12:15], s48 offen nt lds
    s_add_u32 s48, s34, 6144
    s_add_u32 m0, s38, 6144
    s_nop 0
    buffer_load_dwordx4 v6, s[12:15], s48 offen nt lds
    s_add_u32 m0, s38, 7168
    s_nop 0
    buffer_load_dwordx4 v7, s[12:15], s48 offen nt lds
    s_add_u32 s48, s34, 6272
    s_add_u32 m0, s38, 8192
    s_nop 0
    buffer_load_dwordx4 v6, s[12:15], s48 offen nt lds
    s_add_u32 m0, s38, 9216
    s_nop 0
    buffer_load_dwordx4 v7, s[12:15], s48 offen nt lds
    s_add_u32 s48, s34, 6400
    s_add_u32 m0, s38, 10240
    s_nop 0
    buffer_load_dwordx4 v6, s[12:15], s48 offen nt lds
    s_add_u32 m0, s38, 11264
    s_nop 0
    buffer_load_dwordx4 v7, s[12:15], s48 offen nt lds
    s_add_u32 s48, s34, 12288
    s_add_u32 m0, s38, 12288
    s_nop 0
    buffer_load_dwordx4 v6, s[12:15], s48 offen nt lds
    s_add_u32 m0, s38, 13312
    s_nop 0
    buffer_load_dwordx4 v7, s[12:15], s48 offen nt lds
    s_add_u32 s48, s34, 12416
    s_add_u32 m0, s38, 14336
    s_nop 0
    buffer_load_dwordx4 v6, s[12:15], s48 offen nt lds
    s_add_u32 m0, s38, 15360
    s_nop 0
    buffer_load_dwordx4 v7, s[12:15], s48 offen nt lds
    s_add_u32 s48, s34, 12544
    s_add_u32 m0, s38, 16384
    s_nop 0
    buffer_load_dwordx4 v6, s[12:15], s48 offen nt lds
    s_add_u32 m0, s38, 17408
    s_nop 0
    buffer_load_dwordx4 v7, s[12:15], s48 offen nt lds
    v_and_b32 v96, 15, v111
    v_lshrrev_b32 v97, 4, v111
    v_lshrrev_b32 v98, 3, v96
    v_and_b32 v99, 7, v96
    v_lshlrev_b32 v0, 7, v99
    v_bfe_u32 v99, v96, 1, 2
    v_lshlrev_b32 v99, 1, v99
    v_mul_u32_u24 v100, 5, v98
    v_xor_b32 v99, v99, v100
    v_xor_b32 v99, v99, v97
    v_lshl_add_u32 v0, v99, 4, v0
    v_mul_u32_u24 v100, 3072, v98
    v_add_u32 v0, v100, v0
    v_xor_b32 v1, 64, v0
    v_lshrrev_b32 v98, 1, v97
    v_mul_u32_u24 v2, 3072, v98
    v_and_b32 v99, 1, v97
    v_bfe_u32 v100, v111, 2, 2
    v_lshl_add_u32 v96, v99, 2, v100
    v_lshl_add_u32 v2, v96, 7, v2
    v_lshrrev_b32 v96, 1, v96
    v_lshlrev_b32 v96, 1, v96
    v_mul_u32_u24 v98, 5, v98
    v_xor_b32 v96, v96, v98
    v_bfe_u32 v99, v111, 1, 1
    v_xor_b32 v96, v96, v99
    v_lshl_add_u32 v2, v96, 4, v2
    v_and_b32 v99, 1, v111
    v_lshl_add_u32 v2, v99, 3, v2
    v_add_u32 v2, 24576, v2
    v_xor_b32 v3, 32, v2
    v_xor_b32 v4, 64, v2
    v_xor_b32 v5, 96, v2
    v_lshl_add_u32 v8, v111, 4, s38
    v_lshrrev_b32 v96, 3, v111
    v_bfe_u32 v97, v111, 0, 3
    v_and_b32 v98, 3, v96
    v_lshlrev_b32 v98, 1, v98
    v_xor_b32 v97, v97, v98
    v_xor_b32 v97, s65, v97
    v_mul_u32_u24 v102, 384, v96
    v_lshl_add_u32 v102, v97, 4, v102
    v_xor_b32 v103, 16, v102
    s_mul_i32 s42, s65, 3072
    v_add_u32 v102, s42, v102
    s_sub_u32 s42, 3072, s42
    v_add_u32 v103, s42, v103
    v_and_b32 v96, 15, v111
    s_mov_b32 s42, 0x1011
    v_bfe_i32 v97, s42, v96, 1
    v_and_b32 v97, 0x3f803f80, v97
    v_accvgpr_write_b32 a236, v97
    v_accvgpr_write_b32 a237, v97
    v_accvgpr_write_b32 a238, v97
    v_accvgpr_write_b32 a239, v97
    s_mov_b32 s42, 0x3222
    v_bfe_i32 v97, s42, v96, 1
    v_and_b32 v97, 0x3f803f80, v97
    v_accvgpr_write_b32 a240, v97
    v_accvgpr_write_b32 a241, v97
    v_accvgpr_write_b32 a242, v97
    v_accvgpr_write_b32 a243, v97
    s_mov_b32 s42, 0x5444
    v_bfe_i32 v97, s42, v96, 1
    v_and_b32 v97, 0x3f803f80, v97
    v_accvgpr_write_b32 a244, v97
    v_accvgpr_write_b32 a245, v97
    v_accvgpr_write_b32 a246, v97
    v_accvgpr_write_b32 a247, v97
    s_mov_b32 s42, 0x9888
    v_bfe_i32 v97, s42, v96, 1
    v_and_b32 v97, 0x3f803f80, v97
    v_accvgpr_write_b32 a248, v97
    v_accvgpr_write_b32 a249, v97
    v_accvgpr_write_b32 a250, v97
    v_accvgpr_write_b32 a251, v97
    s_mov_b32 s42, 0x1100
    v_bfe_i32 v97, s42, v96, 1
    v_and_b32 v97, 0x3f803f80, v97
    v_accvgpr_write_b32 a252, v97
    v_accvgpr_write_b32 a253, v97
    v_accvgpr_write_b32 a254, v97
    v_accvgpr_write_b32 a255, v97
    s_waitcnt vmcnt(18)
    s_barrier
    s_waitcnt vmcnt(12)
    s_add_u32 s48, s34, 18432
    s_add_u32 m0, s38, 18432
    s_nop 0
    buffer_load_dwordx4 v6, s[12:15], s48 offen nt lds
    s_add_u32 m0, s38, 19456
    s_nop 0
    buffer_load_dwordx4 v7, s[12:15], s48 offen nt lds
    ds_read_b128 a[216:219], v1 offset:0
    s_add_u32 s48, s34, 18560
    s_add_u32 m0, s38, 20480
    v_mbcnt_lo_u32_b32 v107, -1, 0
    v_and_b32 v104, 0x3ff, v0
    v_mbcnt_hi_u32_b32 v107, -1, v107
    buffer_load_dwordx4 v6, s[12:15], s48 offen nt lds
    s_add_u32 m0, s38, 21504
    ds_read_b128 a[212:215], v0 offset:0
    v_lshrrev_b32 v105, 11, v0
    buffer_load_dwordx4 v7, s[12:15], s48 offen nt lds
    s_add_u32 s48, s34, 18688
    v_and_b32 v106, 15, v107
    s_add_u32 m0, s38, 22528
    s_nop 0
    buffer_load_dwordx4 v6, s[12:15], s48 offen nt lds
    v_xor_b32 v105, s65, v105
    v_lshl_add_u32 v104, v105, 10, v104
    v_add_u32 v104, s38, v104
    s_add_u32 m0, s38, 23552
    s_nop 0
    buffer_load_dwordx4 v7, s[12:15], s48 offen nt lds
    v_xor_b32 v105, 64, v104
    ds_read_b128 a[96:99], v104 offset:0
    ds_read_b128 a[116:119], v105 offset:4096
    ds_read_b128 a[100:103], v105 offset:0
    ds_read_b128 a[220:223], v0 offset:1024
    ds_read_b128 a[112:115], v104 offset:4096
    ds_read_b128 a[104:107], v104 offset:2048
    ds_read_b128 a[108:111], v105 offset:2048
    s_waitcnt lgkmcnt(6)
    v_mfma_f32_16x16x32_bf16 v[52:55], a[212:215], a[96:99], 0
    s_waitcnt lgkmcnt(4)
    ds_read_b128 a[228:231], v0 offset:2048
    v_mfma_f32_16x16x32_bf16 v[52:55], a[216:219], a[100:103], v[52:55]
    s_waitcnt lgkmcnt(1)
    ds_read_b128 a[224:227], v1 offset:1024
    v_mfma_f32_16x16x32_bf16 v[52:55], a[220:223], a[104:107], v[52:55]
    ds_read_b128 a[232:235], v1 offset:2048
    ds_read_b128 a[220:223], v0 offset:7168
    s_waitcnt lgkmcnt(2)
    v_mfma_f32_16x16x32_bf16 v[52:55], a[224:227], a[108:111], v[52:55]
    ds_read_b128 a[212:215], v0 offset:6144
    v_mfma_f32_16x16x32_bf16 v[52:55], a[228:231], a[112:115], v[52:55]
    s_waitcnt lgkmcnt(1)
    ds_read_b128 a[224:227], v1 offset:7168
    v_mfma_f32_16x16x32_bf16 v[52:55], a[232:235], a[116:119], v[52:55]
    ds_read_b128 a[232:235], v1 offset:8192
    s_waitcnt lgkmcnt(2)
    v_mfma_f32_16x16x32_bf16 v[56:59], a[212:215], a[96:99], 0
    ds_read_b128 a[216:219], v1 offset:6144
    s_waitcnt lgkmcnt(0)
    v_mfma_f32_16x16x32_bf16 v[56:59], a[216:219], a[100:103], v[56:59]
    ds_read_b128 a[212:215], v0 offset:12288
    s_nop 0
    v_max3_f32 v96, v52, v53, v54
    v_mfma_f32_16x16x32_bf16 v[56:59], a[220:223], a[104:107], v[56:59]
    ds_read_b128 a[228:231], v0 offset:8192
    v_mfma_f32_16x16x32_bf16 v[56:59], a[224:227], a[108:111], v[56:59]
    ds_read_b128 a[220:223], v0 offset:13312
    s_waitcnt lgkmcnt(1)
    v_mfma_f32_16x16x32_bf16 v[56:59], a[228:231], a[112:115], v[56:59]
    ds_read_b128 a[216:219], v1 offset:12288
    v_mfma_f32_16x16x32_bf16 v[56:59], a[232:235], a[116:119], v[56:59]
    s_nop 7
    v_max3_f32 v96, v96, v55, v56
    v_max3_f32 v96, v96, v57, v58
    v_max_f32 v96, v96, v59
    v_mov_b32 v97, v96
    s_nop 1
    v_permlane32_swap_b32 v97, v96
    v_max_f32 v96, v96, v97
    v_mov_b32 v97, v96
    s_nop 1
    v_permlane16_swap_b32 v97, v96
    v_max_f32 v96, v96, v97
    v_mul_f32_e64 v9, -s28, v96
    ds_read_b128 a[228:231], v0 offset:14336
    v_fma_f32 v52, v52, s28, v9
    v_mul_u32_u24 v106, 384, v106
    v_lshrrev_b32 v107, 4, v107
    v_fma_f32 v58, v58, s28, v9
    v_fma_f32 v54, v54, s28, v9
    v_fma_f32 v59, v59, s28, v9
    v_fma_f32 v55, v55, s28, v9
    v_exp_f32 v54, v54
    v_fma_f32 v53, v53, s28, v9
    ds_read_b128 a[224:227], v1 offset:13312
    v_fma_f32 v57, v57, s28, v9
    v_fma_f32 v56, v56, s28, v9
    v_exp_f32 v57, v57
    v_exp_f32 v58, v58
    v_lshl_add_u32 v106, v107, 4, v106
    v_exp_f32 v55, v55
    s_nop 0
    v_cvt_pk_bf16_f32 v15, v54, v55
    v_exp_f32 v53, v53
    v_exp_f32 v52, v52
    s_nop 0
    v_cvt_pk_bf16_f32 v14, v52, v53
    v_exp_f32 v56, v56
    s_waitcnt vmcnt(12)
    s_add_u32 s48, s34, 24576
    s_add_u32 m0, s38, 24576
    s_nop 0
    buffer_load_dwordx4 v6, s[12:15], s48 offen nt lds
    s_add_u32 m0, s38, 25600
    v_mfma_f32_16x16x32_bf16 v[52:55], a[212:215], a[96:99], 0
    buffer_load_dwordx4 v7, s[12:15], s48 offen nt lds
    s_add_u32 s48, s34, 24704
    v_exp_f32 v59, v59
    s_add_u32 m0, s38, 26624
    ds_read_b128 a[212:215], v0 offset:18432
    s_waitcnt lgkmcnt(1)
    v_mfma_f32_16x16x32_bf16 v[52:55], a[216:219], a[100:103], v[52:55]
    buffer_load_dwordx4 v6, s[12:15], s48 offen nt lds
    ds_read_b128 a[216:219], v1 offset:18432
    v_mfma_f32_16x16x32_bf16 v[52:55], a[220:223], a[104:107], v[52:55]
    ds_read_b128 a[136:139], v104 offset:10240
    s_add_u32 m0, s38, 27648
    s_nop 0
    buffer_load_dwordx4 v7, s[12:15], s48 offen nt lds
    v_cvt_pk_bf16_f32 v17, v58, v59
    v_mfma_f32_16x16x32_bf16 v[52:55], a[224:227], a[108:111], v[52:55]
    s_add_u32 s48, s34, 24576
    v_cvt_pk_bf16_f32 v16, v56, v57
    buffer_load_dwordx4 a[208:211], v106, s[12:15], s48 offen offset:256 nt
    ds_read_b128 a[232:235], v1 offset:14336
    ds_read_b128 a[120:123], v104 offset:6144
    v_mfma_f32_16x16x32_bf16 v[52:55], a[228:231], a[112:115], v[52:55]
    ds_read_b128 a[132:135], v105 offset:8192
    buffer_load_dwordx4 v[92:95], v106, s[12:15], s48 offen offset:320 nt
    s_waitcnt lgkmcnt(2)
    v_mfma_f32_16x16x32_bf16 v[52:55], a[232:235], a[116:119], v[52:55]
    ds_read_b128 a[228:231], v0 offset:20480
    ds_read_b128 a[220:223], v0 offset:19456
    ds_read_b128 a[140:143], v105 offset:10240
    v_mfma_f32_16x16x32_bf16 v[56:59], a[212:215], a[96:99], 0
    ds_read_b128 a[224:227], v1 offset:19456
    ds_read_b128 a[128:131], v104 offset:8192
    v_mfma_f32_16x16x32_bf16 v[56:59], a[216:219], a[100:103], v[56:59]
    ds_read_b128 a[212:215], v0 offset:0
    s_waitcnt lgkmcnt(4)
    v_mfma_f32_16x16x32_bf16 v[56:59], a[220:223], a[104:107], v[56:59]
    ds_read_b128 a[124:127], v105 offset:6144
    s_waitcnt lgkmcnt(3)
    v_mfma_f32_16x16x32_bf16 v[56:59], a[224:227], a[108:111], v[56:59]
    ds_read_b128 a[232:235], v1 offset:20480
    v_mfma_f32_16x16x32_bf16 v[56:59], a[228:231], a[112:115], v[56:59]
    ds_read_b128 a[216:219], v1 offset:0
    s_waitcnt lgkmcnt(1)
    v_mfma_f32_16x16x32_bf16 v[56:59], a[232:235], a[116:119], v[56:59]
    ds_read_b128 a[224:227], v1 offset:1024
    v_mfma_f32_16x16x32_bf16 v[60:63], a[212:215], a[120:123], 0
    s_waitcnt lgkmcnt(1)
    ds_read_b128 a[220:223], v0 offset:1024
    v_mfma_f32_16x16x32_bf16 v[60:63], a[216:219], a[124:127], v[60:63]
    ds_read_b128 a[228:231], v0 offset:2048
    s_waitcnt lgkmcnt(1)
    v_mfma_f32_16x16x32_bf16 v[60:63], a[220:223], a[128:131], v[60:63]
    ds_read_b128 a[232:235], v1 offset:2048
    ds_read_b128 a[212:215], v0 offset:6144
    v_mfma_f32_16x16x32_bf16 v[60:63], a[224:227], a[132:135], v[60:63]
    s_waitcnt lgkmcnt(2)
    ds_read_b128 a[224:227], v1 offset:7168
    v_mfma_f32_16x16x32_bf16 v[60:63], a[228:231], a[136:139], v[60:63]
    ds_read_b128 a[220:223], v0 offset:7168
    s_waitcnt lgkmcnt(3)
    v_mfma_f32_16x16x32_bf16 v[60:63], a[232:235], a[140:143], v[60:63]
    s_waitcnt lgkmcnt(2)
    ds_read_b128 a[216:219], v1 offset:6144
    v_mfma_f32_16x16x32_bf16 v[64:67], a[212:215], a[120:123], 0
    ds_read_b128 a[232:235], v1 offset:8192
    s_nop 3
    v_max3_f32 v98, v60, v61, v62
    s_waitcnt lgkmcnt(1)
    v_mfma_f32_16x16x32_bf16 v[64:67], a[216:219], a[124:127], v[64:67]
    ds_read_b128 a[228:231], v0 offset:8192
    v_mfma_f32_16x16x32_bf16 v[64:67], a[220:223], a[128:131], v[64:67]
    ds_read_b128 a[212:215], v0 offset:12288
    v_fma_f32 v52, v52, s28, v9
    v_mfma_f32_16x16x32_bf16 v[64:67], a[224:227], a[132:135], v[64:67]
    ds_read_b128 a[220:223], v0 offset:13312
    s_waitcnt lgkmcnt(2)
    v_mfma_f32_16x16x32_bf16 v[64:67], a[228:231], a[136:139], v[64:67]
    ds_read_b128 a[216:219], v1 offset:12288
    v_mfma_f32_16x16x32_bf16 v[64:67], a[232:235], a[140:143], v[64:67]
    ds_read_b128 a[224:227], v1 offset:13312
    s_nop 6
    v_max3_f32 v98, v98, v63, v64
    ds_read_b128 a[228:231], v0 offset:14336
    v_max3_f32 v98, v98, v65, v66
    v_max_f32 v98, v98, v67
    v_mov_b32 v99, v98
    s_nop 1
    v_permlane32_swap_b32 v99, v98
    v_max_f32 v98, v98, v99
    v_mov_b32 v99, v98
    s_nop 1
    v_permlane16_swap_b32 v99, v98
    v_max_f32 v98, v98, v99
    s_waitcnt vmcnt(12)
    s_add_u32 m0, s22, 24576
    s_nop 0
    buffer_load_dwordx4 v6, s[8:11], s21 offen lds
    s_add_u32 s21, s21, 128
    s_add_u32 m0, s22, 25600
    v_mfma_f32_16x16x32_bf16 v[44:47], a[236:239], v[14:17], 0
    buffer_load_dwordx4 v6, s[8:11], s21 offen lds
    v_mul_f32_e64 v10, -s28, v98
    s_add_u32 s21, s21, 128
    v_fma_f32 v65, v65, s28, v10
    ds_read_b128 a[144:147], v104 offset:12288
    s_add_u32 m0, s22, 26624
    s_nop 0
    buffer_load_dwordx4 v6, s[8:11], s21 offen lds
    v_exp_f32 v65, v65
    ds_read_b128 a[152:155], v104 offset:14336
    v_fma_f32 v60, v60, s28, v10
    v_fma_f32 v62, v62, s28, v10
    v_exp_f32 v60, v60
    v_fma_f32 v67, v67, s28, v10
    v_fma_f32 v53, v53, s28, v9
    v_fma_f32 v63, v63, s28, v10
    v_fma_f32 v66, v66, s28, v10
    v_exp_f32 v67, v67
    v_fma_f32 v61, v61, s28, v10
    v_exp_f32 v61, v61
    v_exp_f32 v62, v62
    v_exp_f32 v66, v66
    v_exp_f32 v63, v63
    v_cvt_pk_bf16_f32 v20, v60, v61
    v_cvt_pk_bf16_f32 v21, v62, v63
    v_fma_f32 v64, v64, s28, v10
    s_waitcnt lgkmcnt(2)
    v_mfma_f32_16x16x32_bf16 v[60:63], a[212:215], a[120:123], 0
    ds_read_b128 a[232:235], v1 offset:14336
    v_mfma_f32_16x16x32_bf16 v[60:63], a[216:219], a[124:127], v[60:63]
    ds_read_b128 a[148:151], v105 offset:12288
    v_mfma_f32_16x16x32_bf16 v[60:63], a[220:223], a[128:131], v[60:63]
    v_cvt_pk_bf16_f32 v23, v66, v67
    ds_read_b128 a[220:223], v0 offset:19456
    v_mfma_f32_16x16x32_bf16 v[60:63], a[224:227], a[132:135], v[60:63]
    ds_read_b128 a[216:219], v1 offset:18432
    v_mfma_f32_16x16x32_bf16 v[60:63], a[228:231], a[136:139], v[60:63]
    v_exp_f32 v64, v64
    ds_read_b128 a[224:227], v1 offset:19456
    ds_read_b128 a[212:215], v0 offset:18432
    v_cvt_pk_bf16_f32 v22, v64, v65
    s_waitcnt lgkmcnt(5)
    v_mfma_f32_16x16x32_bf16 v[60:63], a[232:235], a[140:143], v[60:63]
    ds_read_b128 a[156:159], v105 offset:14336
    s_waitcnt lgkmcnt(1)
    v_mfma_f32_16x16x32_bf16 v[64:67], a[212:215], a[120:123], 0
    ds_read_b128 a[228:231], v0 offset:20480
    v_mfma_f32_16x16x32_bf16 v[64:67], a[216:219], a[124:127], v[64:67]
    s_nop 2
    v_fma_f32 v60, v60, s28, v10
    ds_read_b128 a[232:235], v1 offset:20480
    v_mfma_f32_16x16x32_bf16 v[64:67], a[220:223], a[128:131], v[64:67]
    ds_read_b128 a[216:219], v1 offset:0
    v_mfma_f32_16x16x32_bf16 v[64:67], a[224:227], a[132:135], v[64:67]
    s_add_u32 s21, s21, 12032
    ds_read_b128 a[212:215], v0 offset:0
    s_waitcnt lgkmcnt(3)
    v_mfma_f32_16x16x32_bf16 v[64:67], a[228:231], a[136:139], v[64:67]
    ds_read_b128 a[224:227], v1 offset:1024
    s_waitcnt lgkmcnt(3)
    v_mfma_f32_16x16x32_bf16 v[64:67], a[232:235], a[140:143], v[64:67]
    ds_read_b128 a[160:163], v104 offset:16384
    s_waitcnt lgkmcnt(2)
    v_mfma_f32_16x16x32_bf16 v[68:71], a[212:215], a[144:147], 0
    ds_read_b128 a[220:223], v0 offset:1024
    v_mfma_f32_16x16x32_bf16 v[68:71], a[216:219], a[148:151], v[68:71]
    ds_read_b128 a[228:231], v0 offset:2048
    s_waitcnt lgkmcnt(1)
    v_mfma_f32_16x16x32_bf16 v[68:71], a[220:223], a[152:155], v[68:71]
    ds_read_b128 a[164:167], v105 offset:16384
    v_mfma_f32_16x16x32_bf16 v[68:71], a[224:227], a[156:159], v[68:71]
    s_waitcnt lgkmcnt(1)
    ds_read_b128 a[232:235], v1 offset:2048
    ds_read_b128 a[212:215], v0 offset:6144
    v_mfma_f32_16x16x32_bf16 v[68:71], a[228:231], a[160:163], v[68:71]
    ds_read_b128 a[220:223], v0 offset:7168
    ds_read_b128 a[216:219], v1 offset:6144
    s_waitcnt lgkmcnt(3)
    v_mfma_f32_16x16x32_bf16 v[68:71], a[232:235], a[164:167], v[68:71]
    s_waitcnt lgkmcnt(2)
    ds_read_b128 a[232:235], v1 offset:8192
    v_mfma_f32_16x16x32_bf16 v[72:75], a[212:215], a[144:147], 0
    s_waitcnt lgkmcnt(1)
    ds_read_b128 a[224:227], v1 offset:7168
    v_mfma_f32_16x16x32_bf16 v[72:75], a[216:219], a[148:151], v[72:75]
    ds_read_b128 a[228:231], v0 offset:8192
    v_exp_f32 v53, v53
    v_mfma_f32_16x16x32_bf16 v[72:75], a[220:223], a[152:155], v[72:75]
    ds_read_b128 a[216:219], v1 offset:12288
    s_waitcnt lgkmcnt(2)
    v_mfma_f32_16x16x32_bf16 v[72:75], a[224:227], a[156:159], v[72:75]
    ds_read_b128 a[220:223], v0 offset:13312
    v_max3_f32 v96, v68, v69, v70
    s_waitcnt lgkmcnt(2)
    v_mfma_f32_16x16x32_bf16 v[72:75], a[228:231], a[160:163], v[72:75]
    ds_read_b128 a[212:215], v0 offset:12288
    v_mfma_f32_16x16x32_bf16 v[72:75], a[232:235], a[164:167], v[72:75]
    s_nop 7
    v_max3_f32 v96, v96, v71, v72
    v_max3_f32 v96, v96, v73, v74
    v_max_f32 v96, v96, v75
    v_mov_b32 v97, v96
    s_nop 1
    v_permlane32_swap_b32 v97, v96
    v_max_f32 v96, v96, v97
    v_mov_b32 v97, v96
    s_nop 1
    v_permlane16_swap_b32 v97, v96
    v_max_f32 v96, v96, v97
    ds_read_b128 a[224:227], v1 offset:13312
    v_mul_f32_e64 v11, -s28, v96
    v_fma_f32 v71, v71, s28, v11
    v_fma_f32 v74, v74, s28, v11
    v_fma_f32 v70, v70, s28, v11
    v_fma_f32 v73, v73, s28, v11
    v_fma_f32 v72, v72, s28, v11
    v_exp_f32 v74, v74
    v_fma_f32 v75, v75, s28, v11
    v_fma_f32 v69, v69, s28, v11
    v_fma_f32 v68, v68, s28, v11
    v_exp_f32 v72, v72
    v_exp_f32 v69, v69
    v_exp_f32 v68, v68
    v_exp_f32 v71, v71
    v_exp_f32 v70, v70
    s_nop 0
    v_cvt_pk_bf16_f32 v27, v70, v71
    v_cvt_pk_bf16_f32 v26, v68, v69
    v_exp_f32 v73, v73
    s_waitcnt vmcnt(9)
    s_add_u32 m0, s22, 36864
    s_nop 0
    buffer_load_dwordx4 v6, s[8:11], s21 offen lds
    s_add_u32 s21, s21, 128
    s_add_u32 m0, s22, 37888
    s_waitcnt lgkmcnt(0)
    v_mfma_f32_16x16x32_bf16 v[68:71], a[212:215], a[144:147], 0
    buffer_load_dwordx4 v6, s[8:11], s21 offen lds
    ds_read_b128 a[232:235], v1 offset:14336
    s_add_u32 s21, s21, 128
    v_mfma_f32_16x16x32_bf16 v[68:71], a[216:219], a[148:151], v[68:71]
    s_add_u32 m0, s22, 38912
    ds_read_b128 a[228:231], v0 offset:14336
    ds_read_b128 a[212:215], v0 offset:18432
    buffer_load_dwordx4 v6, s[8:11], s21 offen lds
    v_mfma_f32_16x16x32_bf16 v[44:47], a[240:243], v[20:23], v[44:47]
    ds_read_b128 a[168:171], v104 offset:18432
    v_mfma_f32_16x16x32_bf16 v[68:71], a[220:223], a[152:155], v[68:71]
    v_fma_f32 v63, v63, s28, v10
    v_exp_f32 v75, v75
    ds_read_b128 a[220:223], v0 offset:19456
    v_fma_f32 v55, v55, s28, v9
    v_exp_f32 v52, v52
    ds_read_b128 a[216:219], v1 offset:18432
    v_mfma_f32_16x16x32_bf16 v[68:71], a[224:227], a[156:159], v[68:71]
    ds_read_b128 a[224:227], v1 offset:19456
    s_waitcnt lgkmcnt(5)
    v_mfma_f32_16x16x32_bf16 v[68:71], a[228:231], a[160:163], v[68:71]
    v_cvt_pk_bf16_f32 v29, v74, v75
    ds_read_b128 a[184:187], v104 offset:22528
    v_cvt_pk_bf16_f32 v28, v72, v73
    v_mfma_f32_16x16x32_bf16 v[68:71], a[232:235], a[164:167], v[68:71]
    s_waitcnt lgkmcnt(4)
    v_exp_f32 v55, v55
    ds_read_b128 a[176:179], v104 offset:20480
    v_mfma_f32_16x16x32_bf16 v[72:75], a[212:215], a[144:147], 0
    ds_read_b128 a[228:231], v0 offset:20480
    s_waitcnt lgkmcnt(4)
    v_mfma_f32_16x16x32_bf16 v[72:75], a[216:219], a[148:151], v[72:75]
    v_fma_f32 v61, v61, s28, v10
    ds_read_b128 a[232:235], v1 offset:20480
    v_mfma_f32_16x16x32_bf16 v[72:75], a[220:223], a[152:155], v[72:75]
    ds_read_b128 a[212:215], v0 offset:0
    ds_read_b128 a[216:219], v1 offset:0
    ds_read_b128 a[172:175], v105 offset:18432
    v_exp_f32 v63, v63
    ds_read_b128 a[220:223], v0 offset:1024
    s_waitcnt lgkmcnt(8)
    v_mfma_f32_16x16x32_bf16 v[72:75], a[224:227], a[156:159], v[72:75]
    ds_read_b128 a[224:227], v1 offset:1024
    ds_read_b128 a[180:183], v105 offset:20480
    s_waitcnt lgkmcnt(7)
    v_mfma_f32_16x16x32_bf16 v[72:75], a[228:231], a[160:163], v[72:75]
    v_exp_f32 v61, v61
    ds_read_b128 a[188:191], v105 offset:22528
    s_waitcnt lgkmcnt(7)
    v_mfma_f32_16x16x32_bf16 v[72:75], a[232:235], a[164:167], v[72:75]
    ds_read_b128 a[232:235], v1 offset:2048
    s_waitcnt lgkmcnt(6)
    v_mfma_f32_16x16x32_bf16 v[76:79], a[212:215], a[168:171], 0
    s_waitcnt lgkmcnt(5)
    ds_read_b128 a[228:231], v0 offset:2048
    v_mfma_f32_16x16x32_bf16 v[76:79], a[216:219], a[172:175], v[76:79]
    s_waitcnt lgkmcnt(5)
    ds_read_b128 a[212:215], v0 offset:6144
    v_mfma_f32_16x16x32_bf16 v[76:79], a[220:223], a[176:179], v[76:79]
    ds_read_b128 a[216:219], v1 offset:6144
    s_waitcnt lgkmcnt(5)
    v_mfma_f32_16x16x32_bf16 v[76:79], a[224:227], a[180:183], v[76:79]
    ds_read_b128 a[220:223], v0 offset:7168
    s_waitcnt lgkmcnt(3)
    v_mfma_f32_16x16x32_bf16 v[76:79], a[228:231], a[184:187], v[76:79]
    ds_read_b128 a[224:227], v1 offset:7168
    v_mfma_f32_16x16x32_bf16 v[76:79], a[232:235], a[188:191], v[76:79]
    s_waitcnt lgkmcnt(3)
    ds_read_b128 a[232:235], v1 offset:8192
    v_mfma_f32_16x16x32_bf16 v[80:83], a[212:215], a[168:171], 0
    s_waitcnt lgkmcnt(3)
    ds_read_b128 a[212:215], v0 offset:12288
    v_mfma_f32_16x16x32_bf16 v[80:83], a[216:219], a[172:175], v[80:83]
    s_waitcnt lgkmcnt(3)
    ds_read_b128 a[216:219], v1 offset:12288
    v_mfma_f32_16x16x32_bf16 v[80:83], a[220:223], a[176:179], v[80:83]
    v_max3_f32 v98, v76, v77, v78
    ds_read_b128 a[228:231], v0 offset:8192
    s_add_u32 s21, s21, 12032
    s_waitcnt lgkmcnt(4)
    v_mfma_f32_16x16x32_bf16 v[80:83], a[224:227], a[180:183], v[80:83]
    ds_read_b128 a[220:223], v0 offset:13312
    s_waitcnt lgkmcnt(1)
    v_mfma_f32_16x16x32_bf16 v[80:83], a[228:231], a[184:187], v[80:83]
    ds_read_b128 a[224:227], v1 offset:13312
    v_fma_f32 v54, v54, s28, v9
    v_mfma_f32_16x16x32_bf16 v[80:83], a[232:235], a[188:191], v[80:83]
    s_nop 7
    v_max3_f32 v98, v98, v79, v80
    v_max3_f32 v98, v98, v81, v82
    v_max_f32 v98, v98, v83
    v_mov_b32 v99, v98
    s_nop 1
    v_permlane32_swap_b32 v99, v98
    v_max_f32 v98, v98, v99
    v_mov_b32 v99, v98
    s_nop 1
    v_permlane16_swap_b32 v99, v98
    ds_read_b128 a[232:235], v1 offset:14336
    v_max_f32 v98, v98, v99
    v_mul_f32_e64 v12, -s28, v98
    v_fma_f32 v76, v76, s28, v12
    v_fma_f32 v79, v79, s28, v12
    v_fma_f32 v83, v83, s28, v12
    v_fma_f32 v77, v77, s28, v12
    v_fma_f32 v62, v62, s28, v10
    v_fma_f32 v78, v78, s28, v12
    v_exp_f32 v76, v76
    v_exp_f32 v79, v79
    v_exp_f32 v78, v78
    v_fma_f32 v82, v82, s28, v12
    v_exp_f32 v60, v60
    v_exp_f32 v77, v77
    s_nop 0
    v_cvt_pk_bf16_f32 v32, v76, v77
    v_cvt_pk_bf16_f32 v33, v78, v79
    v_mfma_f32_16x16x32_bf16 v[76:79], a[212:215], a[168:171], 0
    ds_read_b128 a[228:231], v0 offset:14336
    v_exp_f32 v83, v83
    v_mfma_f32_16x16x32_bf16 v[76:79], a[216:219], a[172:175], v[76:79]
    s_waitcnt lgkmcnt(2)
    ds_read_b128 a[216:219], v1 offset:18432
    v_exp_f32 v62, v62
    v_mfma_f32_16x16x32_bf16 v[76:79], a[220:223], a[176:179], v[76:79]
    v_fma_f32 v81, v81, s28, v12
    ds_read_b128 a[212:215], v0 offset:18432
    v_exp_f32 v82, v82
    v_exp_f32 v81, v81
    v_mfma_f32_16x16x32_bf16 v[76:79], a[224:227], a[180:183], v[76:79]
    ds_read_b128 a[224:227], v1 offset:19456
    s_waitcnt lgkmcnt(3)
    v_mfma_f32_16x16x32_bf16 v[76:79], a[228:231], a[184:187], v[76:79]
    v_fma_f32 v80, v80, s28, v12
    ds_read_b128 a[220:223], v0 offset:19456
    v_mfma_f32_16x16x32_bf16 v[76:79], a[232:235], a[188:191], v[76:79]
    v_cvt_pk_bf16_f32 v35, v82, v83
    v_exp_f32 v80, v80
    s_nop 0
    v_cvt_pk_bf16_f32 v34, v80, v81
    ds_read_b128 a[228:231], v0 offset:20480
    s_waitcnt lgkmcnt(3)
    v_mfma_f32_16x16x32_bf16 v[80:83], a[212:215], a[168:171], 0
    ds_read_b128 a[232:235], v1 offset:20480
    v_mfma_f32_16x16x32_bf16 v[80:83], a[216:219], a[172:175], v[80:83]
    ds_read_b128 a[216:219], v1 offset:0
    s_waitcnt lgkmcnt(3)
    v_mfma_f32_16x16x32_bf16 v[80:83], a[220:223], a[176:179], v[80:83]
    ds_read_b128 a[220:223], v0 offset:1024
    v_mfma_f32_16x16x32_bf16 v[44:47], a[244:247], v[26:29], v[44:47]
    v_cvt_pk_bf16_f32 v18, v52, v53
    ds_read_b128 a[212:215], v0 offset:0
    v_mfma_f32_16x16x32_bf16 v[80:83], a[224:227], a[180:183], v[80:83]
    s_waitcnt vmcnt(6)
    ds_read_b128 a[192:195], v104 offset:24576
    ds_read_b128 a[200:203], v104 offset:26624
    ds_read_b128 a[224:227], v1 offset:1024
    ds_read_b128 a[196:199], v105 offset:24576
    s_waitcnt lgkmcnt(6)
    v_mfma_f32_16x16x32_bf16 v[80:83], a[228:231], a[184:187], v[80:83]
    ds_read_b128 a[204:207], v105 offset:26624
    v_mfma_f32_16x16x32_bf16 v[80:83], a[232:235], a[188:191], v[80:83]
    ds_read_b128 a[232:235], v1 offset:2048
    v_mfma_f32_16x16x32_bf16 v[44:47], a[248:251], v[32:35], v[44:47]
    ds_read_b128 a[228:231], v0 offset:2048
    v_exp_f32 v54, v54
    s_waitcnt lgkmcnt(6)
    v_mfma_f32_16x16x32_bf16 v[84:87], a[212:215], a[192:195], 0
    ds_read_b128 a[212:215], v0 offset:6144
    s_waitcnt lgkmcnt(4)
    v_mfma_f32_16x16x32_bf16 v[84:87], a[216:219], a[196:199], v[84:87]
    ds_read_b128 a[216:219], v1 offset:6144
    v_mfma_f32_16x16x32_bf16 v[84:87], a[220:223], a[200:203], v[84:87]
    s_waitcnt lgkmcnt(4)
    ds_read_b128 a[220:223], v0 offset:7168
    v_mfma_f32_16x16x32_bf16 v[84:87], a[224:227], a[204:207], v[84:87]
    ds_read_b128 a[224:227], v1 offset:7168
    s_waitcnt lgkmcnt(4)
    v_mfma_f32_16x16x32_bf16 v[84:87], a[228:231], a[208:211], v[84:87]
    ds_read_b128 a[228:231], v0 offset:8192
    v_mfma_f32_16x16x32_bf16 v[84:87], a[232:235], v[92:95], v[84:87]
    ds_read_b128 a[232:235], v1 offset:8192
    s_waitcnt lgkmcnt(5)
    v_mfma_f32_16x16x32_bf16 v[88:91], a[212:215], a[192:195], 0
    s_waitcnt lgkmcnt(4)
    v_mfma_f32_16x16x32_bf16 v[88:91], a[216:219], a[196:199], v[88:91]
    s_waitcnt lgkmcnt(3)
    v_mfma_f32_16x16x32_bf16 v[88:91], a[220:223], a[200:203], v[88:91]
    s_nop 0
    v_max3_f32 v96, v84, v85, v86
    s_waitcnt vmcnt(63) lgkmcnt(0)
    s_barrier
    ds_read_b128 a[216:219], v1 offset:12288
    v_mfma_f32_16x16x32_bf16 v[88:91], a[224:227], a[204:207], v[88:91]
    s_add_u32 m0, s22, 0
    ds_read_b128 a[224:227], v1 offset:13312
    buffer_load_dwordx4 v6, s[4:7], s20 offen lds
    s_add_u32 s20, s20, 128
    v_mfma_f32_16x16x32_bf16 v[88:91], a[228:231], a[208:211], v[88:91]
    s_add_u32 m0, s22, 1024
    ds_read_b128 a[212:215], v0 offset:12288
    buffer_load_dwordx4 v6, s[4:7], s20 offen lds
    v_mfma_f32_16x16x32_bf16 v[88:91], a[232:235], v[92:95], v[88:91]
    s_add_u32 s20, s20, 128
    s_add_u32 m0, s22, 2048
    ds_read_b128 a[220:223], v0 offset:13312
    buffer_load_dwordx4 v6, s[4:7], s20 offen lds
    s_add_u32 s20, s20, 12032
    ds_read_b128 a[232:235], v1 offset:14336
    s_mov_b32 s39, s64
    ds_read_b128 a[228:231], v0 offset:14336
    v_max3_f32 v96, v96, v87, v88
    v_max3_f32 v96, v96, v89, v90
    v_max_f32 v96, v96, v91
    v_mov_b32 v97, v96
    s_add_u32 s37, s37, 1
    s_bitcmp1_b32 s63, s37
    v_permlane32_swap_b32 v97, v96
    v_max_f32 v96, v96, v97
    v_mov_b32 v97, v96
    s_cselect_b32 s62, 4294770688, 0
    s_cselect_b32 s42, 0, 325632
    v_permlane16_swap_b32 v97, v96
    v_max_f32 v96, v96, v97
    v_mul_f32_e64 v13, -s28, v96
    v_fma_f32 v87, v87, s28, v13
    v_fma_f32 v86, v86, s28, v13
    v_fma_f32 v84, v84, s28, v13
    v_fma_f32 v85, v85, s28, v13
    v_exp_f32 v85, v85
    v_exp_f32 v84, v84
    v_exp_f32 v87, v87
    s_add_u32 s35, s35, s42
    v_exp_f32 v86, v86
    v_cvt_pk_bf16_f32 v38, v84, v85
    v_cvt_pk_bf16_f32 v39, v86, v87
    s_waitcnt lgkmcnt(2)
    v_mfma_f32_16x16x32_bf16 v[84:87], a[212:215], a[192:195], 0
    s_lshl_b32 s42, s37, 1
    ds_read_b128 a[212:215], v0 offset:18432
    v_fma_f32 v88, v88, s28, v13
    v_mfma_f32_16x16x32_bf16 v[84:87], a[216:219], a[196:199], v[84:87]
    s_lshr_b32 s42, s31, s42
    ds_read_b128 a[216:219], v1 offset:18432
    v_fma_f32 v89, v89, s28, v13
    v_mfma_f32_16x16x32_bf16 v[84:87], a[220:223], a[200:203], v[84:87]
    s_and_b32 s42, s42, 3
    ds_read_b128 a[220:223], v0 offset:19456
    v_fma_f32 v90, v90, s28, v13
    v_mfma_f32_16x16x32_bf16 v[84:87], a[224:227], a[204:207], v[84:87]
    s_waitcnt lgkmcnt(3)
    ds_read_b128 a[224:227], v1 offset:19456
    s_add_u32 s42, s42, s36
    v_mfma_f32_16x16x32_bf16 v[84:87], a[228:231], a[208:211], v[84:87]
    s_sub_u32 s43, s42, 3
    ds_read_b128 a[228:231], v0 offset:20480
    v_fma_f32 v91, v91, s28, v13
    v_mfma_f32_16x16x32_bf16 v[84:87], a[232:235], v[92:95], v[84:87]
    s_cmp_ge_u32 s42, 3
    ds_read_b128 a[232:235], v1 offset:20480
    s_cselect_b32 s42, s43, s42
    s_mul_i32 s44, s3, 5
    s_mov_b32 s32, 1
    v_exp_f32 v89, v89
    s_lshl_b32 s43, s3, 2
    s_add_u32 s45, s43, 21
    s_cmp_eq_u32 s3, 0
    s_cselect_b32 s45, 20, s45
    s_cselect_b32 s33, 1, 0
    s_cmp_eq_u32 s42, 1
    s_cselect_b32 s44, s45, s44
    s_cselect_b32 s32, s33, s32
    s_add_u32 s45, s43, 37
    s_cmp_eq_u32 s42, 2
    s_cselect_b32 s44, s45, s44
    v_exp_f32 v88, v88
    s_cselect_b32 s32, 0, s32
    v_exp_f32 v90, v90
    s_mul_i32 s44, s44, 6144
    s_add_u32 s33, s35, s44
    s_mul_i32 s42, s32, 6144
    v_exp_f32 v91, v91
    s_add_u32 s42, s42, 24576
    s_add_u32 s42, s42, s33
    s_cmp_ge_u32 s37, 6
    s_cselect_b32 s14, 0, s42
    s_add_u32 s24, s67, 256
    v_cvt_pk_bf16_f32 v41, v90, v91
    v_cvt_pk_bf16_f32 v40, v88, v89
    s_add_u32 s25, s33, 256
    s_add_u32 s23, s38, 4096
    s_mov_b32 s27, 0x49249249
    s_mov_b32 s30, 0
    s_waitcnt vmcnt(6) lgkmcnt(0)
    v_mfma_f32_16x16x32_bf16 v[88:91], a[212:215], a[192:195], 0
    s_barrier
    ds_read_b64_tr_b16 a[212:213], v2 offset:0
    ds_read_b64_tr_b16 a[214:215], v2 offset:6144
    v_mfma_f32_16x16x32_bf16 v[88:91], a[216:219], a[196:199], v[88:91]
    s_add_u32 m0, s22, 12288
    ds_read_b64_tr_b16 a[216:217], v3 offset:0
    ds_read_b64_tr_b16 a[218:219], v3 offset:6144
    buffer_load_dwordx4 v6, s[4:7], s20 offen lds
    v_mfma_f32_16x16x32_bf16 v[88:91], a[220:223], a[200:203], v[88:91]
    v_cvt_pk_bf16_f32 v25, v62, v63
    ds_read_b64_tr_b16 a[220:221], v4 offset:0
    v_mfma_f32_16x16x32_bf16 v[88:91], a[224:227], a[204:207], v[88:91]
    ds_read_b64_tr_b16 a[222:223], v4 offset:6144
    s_add_u32 s20, s20, 128
    s_add_u32 m0, s22, 13312
    s_nop 0
    buffer_load_dwordx4 v6, s[4:7], s20 offen lds
    v_mfma_f32_16x16x32_bf16 v[88:91], a[228:231], a[208:211], v[88:91]
    ds_read_b64_tr_b16 a[224:225], v5 offset:0
    v_cvt_pk_bf16_f32 v24, v60, v61
    s_add_u32 s20, s20, 128
    v_mfma_f32_16x16x32_bf16 v[44:47], a[252:255], v[38:41], v[44:47]
    ds_read_b64_tr_b16 a[226:227], v5 offset:6144
    v_cvt_pk_bf16_f32 v19, v54, v55
    s_add_u32 m0, s22, 14336
    s_nop 0
    buffer_load_dwordx4 v6, s[4:7], s20 offen lds
    s_add_u32 s20, s20, 12032
    v_mfma_f32_16x16x32_bf16 v[88:91], a[232:235], v[92:95], v[88:91]
    s_waitcnt lgkmcnt(4)
    v_mfma_f32_16x16x32_bf16 v[112:115], a[212:215], v[14:17], 0
    ds_read_b64_tr_b16 a[234:235], v3 offset:7168
    v_add_u32 v8, 4096, v8
    v_mfma_f32_16x16x32_bf16 v[116:119], a[216:219], v[14:17], 0
    v_fma_f32 v82, v82, s28, v12
    v_fma_f32 v59, v59, s28, v9
    v_mfma_f32_16x16x32_bf16 v[164:167], a[216:219], v[20:23], 0
    v_fma_f32 v57, v57, s28, v9
    v_mfma_f32_16x16x32_bf16 v[160:163], a[212:215], v[20:23], 0
    v_fma_f32 v75, v75, s28, v11
    v_fma_f32 v91, v91, s28, v13
    v_mfma_f32_16x16x32_bf16 v[208:211], a[212:215], v[26:29], 0
    ds_read_b64_tr_b16 a[230:231], v2 offset:7168
    v_fma_f32 v84, v84, s28, v13
    v_mfma_f32_16x16x32_bf16 v[212:215], a[216:219], v[26:29], 0
    ds_read_b64_tr_b16 a[228:229], v2 offset:1024
    v_mfma_f32_16x16x32_bf16 a[4:7], a[216:219], v[32:35], 0
    v_mfma_f32_16x16x32_bf16 a[0:3], a[212:215], v[32:35], 0
    v_fma_f32 v70, v70, s28, v11
    v_mfma_f32_16x16x32_bf16 a[48:51], a[212:215], v[38:41], 0
    ds_read_b64_tr_b16 a[232:233], v3 offset:1024
    v_fma_f32 v71, v71, s28, v11
    v_mfma_f32_16x16x32_bf16 a[52:55], a[216:219], v[38:41], 0
    s_waitcnt lgkmcnt(4)
    ds_read_b64_tr_b16 a[214:215], v4 offset:7168
    v_fma_f32 v79, v79, s28, v12
    v_mfma_f32_16x16x32_bf16 a[56:59], a[220:223], v[38:41], 0
    v_fma_f32 v69, v69, s28, v11
    v_mfma_f32_16x16x32_bf16 a[60:63], a[224:227], v[38:41], 0
    ds_read_b64_tr_b16 a[216:217], v5 offset:1024
    v_fma_f32 v81, v81, s28, v12
    v_mfma_f32_16x16x32_bf16 a[12:15], a[224:227], v[32:35], 0
    v_exp_f32 v69, v69
    v_mfma_f32_16x16x32_bf16 a[8:11], a[220:223], v[32:35], 0
    v_fma_f32 v76, v76, s28, v12
    v_fma_f32 v87, v87, s28, v13
    v_mfma_f32_16x16x32_bf16 v[216:219], a[220:223], v[26:29], 0
    ds_read_b64_tr_b16 a[212:213], v4 offset:1024
    v_fma_f32 v56, v56, s28, v9
    v_mfma_f32_16x16x32_bf16 v[220:223], a[224:227], v[26:29], 0
    v_exp_f32 v79, v79
    v_mfma_f32_16x16x32_bf16 v[172:175], a[224:227], v[20:23], 0
    ds_read_b64_tr_b16 a[218:219], v5 offset:7168
    v_fma_f32 v58, v58, s28, v9
    v_mfma_f32_16x16x32_bf16 v[168:171], a[220:223], v[20:23], 0
    v_exp_f32 v87, v87
    v_mfma_f32_16x16x32_bf16 v[120:123], a[220:223], v[14:17], 0
    v_fma_f32 v64, v64, s28, v10
    v_fma_f32 v67, v67, s28, v10
    v_mfma_f32_16x16x32_bf16 v[124:127], a[224:227], v[14:17], 0
    s_waitcnt lgkmcnt(3)
    v_fma_f32 v83, v83, s28, v12
    v_fma_f32 v86, v86, s28, v13
    v_mfma_f32_16x16x32_bf16 v[128:131], a[228:231], v[14:17], 0
    s_add_u32 s39, s39, 12288
    v_exp_f32 v70, v70
    v_mfma_f32_16x16x32_bf16 v[132:135], a[232:235], v[14:17], 0
    ds_read_b64_tr_b16 a[220:221], v2 offset:2048
    v_mfma_f32_16x16x32_bf16 v[180:183], a[232:235], v[20:23], 0
    ds_read_b64_tr_b16 a[224:225], v3 offset:2048
    v_fma_f32 v65, v65, s28, v10
    v_mfma_f32_16x16x32_bf16 v[176:179], a[228:231], v[20:23], 0
    ds_read_b64_tr_b16 a[226:227], v3 offset:8192
    v_fma_f32 v77, v77, s28, v12
    v_mfma_f32_16x16x32_bf16 v[224:227], a[228:231], v[26:29], 0
    v_fma_f32 v90, v90, s28, v13
    v_fma_f32 v89, v89, s28, v13
    v_mfma_f32_16x16x32_bf16 v[228:231], a[232:235], v[26:29], 0
    v_exp_f32 v71, v71
    v_mfma_f32_16x16x32_bf16 a[20:23], a[232:235], v[32:35], 0
    v_exp_f32 v76, v76
    v_mfma_f32_16x16x32_bf16 a[16:19], a[228:231], v[32:35], 0
    ds_read_b64_tr_b16 a[222:223], v2 offset:8192
    v_fma_f32 v74, v74, s28, v11
    v_mfma_f32_16x16x32_bf16 a[64:67], a[228:231], v[38:41], 0
    ds_read_b64_tr_b16 a[228:229], v4 offset:2048
    v_fma_f32 v68, v68, s28, v11
    v_mfma_f32_16x16x32_bf16 a[68:71], a[232:235], v[38:41], 0
    s_waitcnt lgkmcnt(5)
    v_exp_f32 v58, v58
    v_mfma_f32_16x16x32_bf16 a[72:75], a[212:215], v[38:41], 0
    v_exp_f32 v57, v57
    v_mfma_f32_16x16x32_bf16 a[76:79], a[216:219], v[38:41], 0
    v_exp_f32 v91, v91
    v_mfma_f32_16x16x32_bf16 a[28:31], a[216:219], v[32:35], 0
    ds_read_b64_tr_b16 a[234:235], v5 offset:8192
    v_cvt_pk_bf16_f32 v31, v70, v71
    v_mfma_f32_16x16x32_bf16 a[24:27], a[212:215], v[32:35], 0
    ds_read_b64_tr_b16 a[230:231], v4 offset:8192
    v_mfma_f32_16x16x32_bf16 v[232:235], a[212:215], v[26:29], 0
    ds_read_b64_tr_b16 a[232:233], v5 offset:2048
    v_mfma_f32_16x16x32_bf16 v[236:239], a[216:219], v[26:29], 0
    v_exp_f32 v74, v74
    v_mfma_f32_16x16x32_bf16 v[188:191], a[216:219], v[20:23], 0
    v_exp_f32 v64, v64
    v_mfma_f32_16x16x32_bf16 v[184:187], a[212:215], v[20:23], 0
    v_exp_f32 v68, v68
    v_mfma_f32_16x16x32_bf16 v[136:139], a[212:215], v[14:17], 0
    v_fma_f32 v73, v73, s28, v11
    v_mfma_f32_16x16x32_bf16 v[140:143], a[216:219], v[14:17], 0
    s_waitcnt lgkmcnt(3)
    v_exp_f32 v77, v77
    v_mfma_f32_16x16x32_bf16 v[144:147], a[220:223], v[14:17], 0
    v_fma_f32 v85, v85, s28, v13
    v_fma_f32 v78, v78, s28, v12
    v_mfma_f32_16x16x32_bf16 v[148:151], a[224:227], v[14:17], 0
    v_exp_f32 v84, v84
    v_mfma_f32_16x16x32_bf16 v[196:199], a[224:227], v[20:23], 0
    v_exp_f32 v59, v59
    v_mfma_f32_16x16x32_bf16 v[192:195], a[220:223], v[20:23], 0
    v_exp_f32 v86, v86
    v_mfma_f32_16x16x32_bf16 v[240:243], a[220:223], v[26:29], 0
    s_waitcnt vmcnt(3) lgkmcnt(0)
    v_exp_f32 v90, v90
    v_mfma_f32_16x16x32_bf16 v[244:247], a[224:227], v[26:29], 0
    v_exp_f32 v85, v85
    v_mfma_f32_16x16x32_bf16 a[36:39], a[224:227], v[32:35], 0
    s_add_u32 m0, s22, 24576
    v_exp_f32 v78, v78
    v_mfma_f32_16x16x32_bf16 a[32:35], a[220:223], v[32:35], 0
    s_barrier
    v_mfma_f32_16x16x32_bf16 a[80:83], a[220:223], v[38:41], 0
    buffer_load_dwordx4 v6, s[8:11], s21 offen lds
    v_mfma_f32_16x16x32_bf16 a[84:87], a[224:227], v[38:41], 0
    ds_read_b128 a[212:215], v0 offset:0
    v_cvt_pk_bf16_f32 v30, v68, v69
    v_mfma_f32_16x16x32_bf16 a[88:91], a[228:231], v[38:41], 0
    s_add_u32 s21, s21, 128
    ds_read_b128 a[216:219], v1 offset:0
    v_mfma_f32_16x16x32_bf16 a[92:95], a[232:235], v[38:41], 0
    ds_read_b128 a[220:223], v0 offset:1024
    v_cvt_pk_bf16_f32 v37, v78, v79
    v_mfma_f32_16x16x32_bf16 a[44:47], a[232:235], v[32:35], 0
    v_exp_f32 v56, v56
    v_mfma_f32_16x16x32_bf16 a[40:43], a[228:231], v[32:35], 0
    s_add_u32 m0, s22, 25600
    v_mfma_f32_16x16x32_bf16 v[248:251], a[228:231], v[26:29], 0
    buffer_load_dwordx4 v6, s[8:11], s21 offen lds
    v_mfma_f32_16x16x32_bf16 v[252:255], a[232:235], v[26:29], 0
    s_add_u32 s21, s21, 128
    v_cvt_pk_bf16_f32 v43, v86, v87
    v_mfma_f32_16x16x32_bf16 v[204:207], a[232:235], v[20:23], 0
    v_mfma_f32_16x16x32_bf16 v[200:203], a[228:231], v[20:23], 0
    s_add_u32 m0, s22, 26624
    v_mfma_f32_16x16x32_bf16 v[152:155], a[228:231], v[14:17], 0
    buffer_load_dwordx4 v6, s[8:11], s21 offen lds
    v_mfma_f32_16x16x32_bf16 v[156:159], a[232:235], v[14:17], 0
    s_waitcnt lgkmcnt(2)
    v_cvt_pk_bf16_f32 v16, v56, v57
    v_fma_f32 v88, v88, s28, v13
    v_mfma_f32_16x16x32_bf16 v[52:55], a[212:215], a[96:99], 0
    s_waitcnt lgkmcnt(1)
    ds_read_b128 a[232:235], v1 offset:2048
    v_fma_f32 v80, v80, s28, v12
    v_mfma_f32_16x16x32_bf16 v[52:55], a[216:219], a[100:103], v[52:55]
    s_waitcnt lgkmcnt(1)
    v_cvt_pk_bf16_f32 v42, v84, v85
    v_fma_f32 v72, v72, s28, v11
    v_mfma_f32_16x16x32_bf16 v[52:55], a[220:223], a[104:107], v[52:55]
    v_cvt_pk_bf16_f32 v41, v90, v91
    v_mfma_f32_16x16x32_bf16 v[60:63], a[220:223], a[128:131], 0
    ds_read_b128 a[228:231], v0 offset:2048
    v_mfma_f32_16x16x32_bf16 v[60:63], a[216:219], a[124:127], v[60:63]
    ds_read_b128 a[224:227], v1 offset:1024
    v_cvt_pk_bf16_f32 v36, v76, v77
    v_mfma_f32_16x16x32_bf16 v[60:63], a[212:215], a[120:123], v[60:63]
    v_exp_f32 v73, v73
    v_mfma_f32_16x16x32_bf16 v[68:71], a[212:215], a[144:147], 0
    v_exp_f32 v81, v81
    v_mfma_f32_16x16x32_bf16 v[68:71], a[216:219], a[148:151], v[68:71]
    v_exp_f32 v82, v82
    v_mfma_f32_16x16x32_bf16 v[68:71], a[220:223], a[152:155], v[68:71]
    v_exp_f32 v88, v88
    v_mfma_f32_16x16x32_bf16 v[76:79], a[220:223], a[176:179], 0
    v_exp_f32 v65, v65
    v_mfma_f32_16x16x32_bf16 v[76:79], a[216:219], a[172:175], v[76:79]
    v_exp_f32 v67, v67
    v_mfma_f32_16x16x32_bf16 v[76:79], a[212:215], a[168:171], v[76:79]
    v_exp_f32 v89, v89
    v_mfma_f32_16x16x32_bf16 v[84:87], a[212:215], a[192:195], 0
    v_exp_f32 v83, v83
    v_mfma_f32_16x16x32_bf16 v[84:87], a[216:219], a[196:199], v[84:87]
    v_exp_f32 v80, v80
    v_mfma_f32_16x16x32_bf16 v[84:87], a[220:223], a[200:203], v[84:87]
    s_waitcnt lgkmcnt(0)
    ds_read_b128 a[212:215], v0 offset:6144
    v_mfma_f32_16x16x32_bf16 v[84:87], a[224:227], a[204:207], v[84:87]
    s_add_u32 s21, s21, 12032
    v_fma_f32 v66, v66, s28, v10
    v_cvt_pk_bf16_f32 v22, v64, v65
    v_mfma_f32_16x16x32_bf16 v[84:87], a[228:231], a[208:211], v[84:87]
    s_add_u32 m0, s38, 0
    v_exp_f32 v66, v66
    v_mfma_f32_16x16x32_bf16 v[84:87], a[232:235], v[92:95], v[84:87]
    v_mfma_f32_16x16x32_bf16 v[76:79], a[232:235], a[188:191], v[76:79]
    v_exp_f32 v75, v75
    v_mfma_f32_16x16x32_bf16 v[76:79], a[228:231], a[184:187], v[76:79]
    buffer_load_dwordx4 v6, s[12:15], s33 offen nt lds
    v_mfma_f32_16x16x32_bf16 v[76:79], a[224:227], a[180:183], v[76:79]
    v_exp_f32 v72, v72
    v_mfma_f32_16x16x32_bf16 v[68:71], a[224:227], a[156:159], v[68:71]
    v_cvt_pk_bf16_f32 v40, v88, v89
    v_mfma_f32_16x16x32_bf16 v[68:71], a[228:231], a[160:163], v[68:71]
    ds_read_b128 a[220:223], v0 offset:7168
    v_mfma_f32_16x16x32_bf16 v[68:71], a[232:235], a[164:167], v[68:71]
    ds_read_b128 a[216:219], v1 offset:6144
    s_add_u32 m0, s38, 1024
    v_mfma_f32_16x16x32_bf16 v[60:63], a[232:235], a[140:143], v[60:63]
    v_cvt_pk_bf16_f32 v29, v74, v75
    v_cvt_pk_bf16_f32 v35, v82, v83
    v_mfma_f32_16x16x32_bf16 v[60:63], a[228:231], a[136:139], v[60:63]
    buffer_load_dwordx4 v7, s[12:15], s33 offen nt lds
    v_mfma_f32_16x16x32_bf16 v[60:63], a[224:227], a[132:135], v[60:63]
    v_mfma_f32_16x16x32_bf16 v[52:55], a[224:227], a[108:111], v[52:55]
    ds_read_b128 a[224:227], v1 offset:7168
    v_mfma_f32_16x16x32_bf16 v[52:55], a[228:231], a[112:115], v[52:55]
    v_cvt_pk_bf16_f32 v17, v58, v59
    v_cvt_pk_bf16_f32 v23, v66, v67
    v_mfma_f32_16x16x32_bf16 v[52:55], a[232:235], a[116:119], v[52:55]
    ds_read_b128 a[228:231], v0 offset:8192
    v_cvt_pk_bf16_f32 v34, v80, v81
    v_mfma_f32_16x16x32_bf16 v[48:51], a[236:239], v[16:19], v[44:47]
    ds_read_b128 a[232:235], v1 offset:8192
    v_cvt_pk_bf16_f32 v28, v72, v73
    v_mfma_f32_16x16x32_bf16 v[48:51], a[240:243], v[22:25], v[48:51]
    s_nop 0
    v_mfma_f32_16x16x32_bf16 v[48:51], a[244:247], v[28:31], v[48:51]
    v_mfma_f32_16x16x32_bf16 v[48:51], a[248:251], v[34:37], v[48:51]
    v_mfma_f32_16x16x32_bf16 v[48:51], a[252:255], v[40:43], v[48:51]
    s_add_u32 s59, s33, 128
    s_add_u32 m0, s38, 2048
    s_waitcnt lgkmcnt(3)
    v_mfma_f32_16x16x32_bf16 v[56:59], a[212:215], a[96:99], 0
    buffer_load_dwordx4 v6, s[12:15], s59 offen nt lds
    v_mfma_f32_16x16x32_bf16 v[56:59], a[216:219], a[100:103], v[56:59]
    s_add_u32 m0, s38, 3072
    s_nop 0
    v_cmp_lt_f32 vcc, s29, v48
    v_mfma_f32_16x16x32_bf16 v[56:59], a[220:223], a[104:107], v[56:59]
    v_mfma_f32_16x16x32_bf16 v[64:67], a[220:223], a[128:131], 0
    buffer_load_dwordx4 v7, s[12:15], s59 offen nt lds
    v_mfma_f32_16x16x32_bf16 v[64:67], a[216:219], a[124:127], v[64:67]
    s_nop 0
    s_cbranch_vccnz L_rs_start5b
L_ret_start5b:
    v_mfma_f32_16x16x32_bf16 v[64:67], a[212:215], a[120:123], v[64:67]
    s_waitcnt vmcnt(13) lgkmcnt(0)
    v_fma_f32 v63, v63, s28, v10
    v_fma_f32 v62, v62, s28, v10
    v_mfma_f32_16x16x32_bf16 v[72:75], a[212:215], a[144:147], 0
    s_barrier
    v_mfma_f32_16x16x32_bf16 v[72:75], a[216:219], a[148:151], v[72:75]
    v_fma_f32 v60, v60, s28, v10
    v_mfma_f32_16x16x32_bf16 v[72:75], a[220:223], a[152:155], v[72:75]
    v_exp_f32 v62, v62
    v_mfma_f32_16x16x32_bf16 v[80:83], a[220:223], a[176:179], 0
    s_add_u32 m0, s22, 0
    v_fma_f32 v53, v53, s28, v9
    v_fma_f32 v61, v61, s28, v10
    v_mfma_f32_16x16x32_bf16 v[80:83], a[216:219], a[172:175], v[80:83]
    buffer_load_dwordx4 v6, s[4:7], s20 offen lds
    v_mfma_f32_16x16x32_bf16 v[80:83], a[212:215], a[168:171], v[80:83]
    v_fma_f32 v55, v55, s28, v9
    s_add_u32 s20, s20, 128
    v_mfma_f32_16x16x32_bf16 v[88:91], a[212:215], a[192:195], 0
    ds_read_b64_tr_b16 a[212:213], v2 offset:18432
    s_add_u32 m0, s22, 1024
    v_mfma_f32_16x16x32_bf16 v[88:91], a[216:219], a[196:199], v[88:91]
    buffer_load_dwordx4 v6, s[4:7], s20 offen lds
    v_mfma_f32_16x16x32_bf16 v[88:91], a[220:223], a[200:203], v[88:91]
    ds_read_b64_tr_b16 a[214:215], v2 offset:12288
    s_add_u32 s20, s20, 128
    v_mfma_f32_16x16x32_bf16 v[88:91], a[224:227], a[204:207], v[88:91]
    s_add_u32 m0, s22, 2048
    v_exp_f32 v63, v63
    v_mfma_f32_16x16x32_bf16 v[88:91], a[228:231], a[208:211], v[88:91]
    ds_read_b64_tr_b16 a[216:217], v3 offset:18432
    v_fma_f32 v52, v52, s28, v9
    v_mfma_f32_16x16x32_bf16 v[88:91], a[232:235], v[92:95], v[88:91]
    buffer_load_dwordx4 v6, s[4:7], s20 offen lds
    v_mfma_f32_16x16x32_bf16 v[80:83], a[232:235], a[188:191], v[80:83]
    ds_read_b64_tr_b16 a[218:219], v3 offset:12288
    v_fma_f32 v54, v54, s28, v9
    v_mfma_f32_16x16x32_bf16 v[80:83], a[228:231], a[184:187], v[80:83]
    v_exp_f32 v54, v54
    v_mfma_f32_16x16x32_bf16 v[80:83], a[224:227], a[180:183], v[80:83]
    v_exp_f32 v60, v60
    v_mfma_f32_16x16x32_bf16 v[72:75], a[224:227], a[156:159], v[72:75]
    v_exp_f32 v61, v61
    v_mfma_f32_16x16x32_bf16 v[72:75], a[228:231], a[160:163], v[72:75]
    ds_read_b64_tr_b16 a[220:221], v4 offset:18432
    v_mfma_f32_16x16x32_bf16 v[72:75], a[232:235], a[164:167], v[72:75]
    ds_read_b64_tr_b16 a[222:223], v4 offset:12288
    v_mfma_f32_16x16x32_bf16 v[64:67], a[232:235], a[140:143], v[64:67]
    v_exp_f32 v52, v52
    v_mfma_f32_16x16x32_bf16 v[64:67], a[228:231], a[136:139], v[64:67]
    v_exp_f32 v53, v53
    v_mfma_f32_16x16x32_bf16 v[64:67], a[224:227], a[132:135], v[64:67]
    v_exp_f32 v55, v55
    v_mfma_f32_16x16x32_bf16 v[56:59], a[224:227], a[108:111], v[56:59]
    v_cvt_pk_bf16_f32 v15, v54, v55
    v_cvt_pk_bf16_f32 v20, v60, v61
    v_mfma_f32_16x16x32_bf16 v[56:59], a[228:231], a[112:115], v[56:59]
    ds_read_b64_tr_b16 a[224:225], v5 offset:18432
    v_cvt_pk_bf16_f32 v14, v52, v53
    v_mfma_f32_16x16x32_bf16 v[56:59], a[232:235], a[116:119], v[56:59]
    s_add_u32 s20, s20, 12032
    ds_read_b64_tr_b16 a[226:227], v5 offset:12288
    v_cvt_pk_bf16_f32 v21, v62, v63
    s_branch L_loop5
L_start4:
    s_add_u32 m0, s22, 0
    s_nop 0
    buffer_load_dwordx4 v6, s[4:7], s20 offen lds
    s_add_u32 s20, s20, 128
    s_add_u32 m0, s22, 1024
    s_nop 0
    buffer_load_dwordx4 v6, s[4:7], s20 offen lds
    s_add_u32 s20, s20, 128
    s_add_u32 m0, s22, 2048
    s_nop 0
    buffer_load_dwordx4 v6, s[4:7], s20 offen lds
    s_add_u32 s20, s20, 12032
    s_add_u32 m0, s22, 12288
    s_nop 0
    buffer_load_dwordx4 v6, s[4:7], s20 offen lds
    s_add_u32 s20, s20, 128
    s_add_u32 m0, s22, 13312
    s_nop 0
    buffer_load_dwordx4 v6, s[4:7], s20 offen lds
    s_add_u32 s20, s20, 128
    s_add_u32 m0, s22, 14336
    s_nop 0
    buffer_load_dwordx4 v6, s[4:7], s20 offen lds
    s_add_u32 s20, s20, 12032
    s_add_u32 s48, s34, 0
    s_add_u32 m0, s38, 0
    s_nop 0
    buffer_load_dwordx4 v6, s[12:15], s48 offen nt lds
    s_add_u32 m0, s38, 1024
    s_nop 0
    buffer_load_dwordx4 v7, s[12:15], s48 offen nt lds
    s_add_u32 s48, s34, 128
    s_add_u32 m0, s38, 2048
    s_nop 0
    buffer_load_dwordx4 v6, s[12:15], s48 offen nt lds
    s_add_u32 m0, s38, 3072
    s_nop 0
    buffer_load_dwordx4 v7, s[12:15], s48 offen nt lds
    s_add_u32 s48, s34, 256
    s_add_u32 m0, s38, 4096
    s_nop 0
    buffer_load_dwordx4 v6, s[12:15], s48 offen nt lds
    s_add_u32 m0, s38, 5120
    s_nop 0
    buffer_load_dwordx4 v7, s[12:15], s48 offen nt lds
    s_add_u32 s48, s34, 6144
    s_add_u32 m0, s38, 6144
    s_nop 0
    buffer_load_dwordx4 v6, s[12:15], s48 offen nt lds
    s_add_u32 m0, s38, 7168
    s_nop 0
    buffer_load_dwordx4 v7, s[12:15], s48 offen nt lds
    s_add_u32 s48, s34, 6272
    s_add_u32 m0, s38, 8192
    s_nop 0
    buffer_load_dwordx4 v6, s[12:15], s48 offen nt lds
    s_add_u32 m0, s38, 9216
    s_nop 0
    buffer_load_dwordx4 v7, s[12:15], s48 offen nt lds
    s_add_u32 s48, s34, 6400
    s_add_u32 m0, s38, 10240
    s_nop 0
    buffer_load_dwordx4 v6, s[12:15], s48 offen nt lds
    s_add_u32 m0, s38, 11264
    s_nop 0
    buffer_load_dwordx4 v7, s[12:15], s48 offen nt lds
    s_add_u32 s48, s34, 12288
    s_add_u32 m0, s38, 12288
    s_nop 0
    buffer_load_dwordx4 v6, s[12:15], s48 offen nt lds
    s_add_u32 m0, s38, 13312
    s_nop 0
    buffer_load_dwordx4 v7, s[12:15], s48 offen nt lds
    s_add_u32 s48, s34, 12416
    s_add_u32 m0, s38, 14336
    s_nop 0
    buffer_load_dwordx4 v6, s[12:15], s48 offen nt lds
    s_add_u32 m0, s38, 15360
    s_nop 0
    buffer_load_dwordx4 v7, s[12:15], s48 offen nt lds
    s_add_u32 s48, s34, 12544
    s_add_u32 m0, s38, 16384
    s_nop 0
    buffer_load_dwordx4 v6, s[12:15], s48 offen nt lds
    s_add_u32 m0, s38, 17408
    s_nop 0
    buffer_load_dwordx4 v7, s[12:15], s48 offen nt lds
    v_and_b32 v96, 15, v111
    v_lshrrev_b32 v97, 4, v111
    v_lshrrev_b32 v98, 3, v96
    v_and_b32 v99, 7, v96
    v_lshlrev_b32 v0, 7, v99
    v_bfe_u32 v99, v96, 1, 2
    v_lshlrev_b32 v99, 1, v99
    v_mul_u32_u24 v100, 5, v98
    v_xor_b32 v99, v99, v100
    v_xor_b32 v99, v99, v97
    v_lshl_add_u32 v0, v99, 4, v0
    v_mul_u32_u24 v100, 3072, v98
    v_add_u32 v0, v100, v0
    v_xor_b32 v1, 64, v0
    v_lshrrev_b32 v98, 1, v97
    v_mul_u32_u24 v2, 3072, v98
    v_and_b32 v99, 1, v97
    v_bfe_u32 v100, v111, 2, 2
    v_lshl_add_u32 v96, v99, 2, v100
    v_lshl_add_u32 v2, v96, 7, v2
    v_lshrrev_b32 v96, 1, v96
    v_lshlrev_b32 v96, 1, v96
    v_mul_u32_u24 v98, 5, v98
    v_xor_b32 v96, v96, v98
    v_bfe_u32 v99, v111, 1, 1
    v_xor_b32 v96, v96, v99
    v_lshl_add_u32 v2, v96, 4, v2
    v_and_b32 v99, 1, v111
    v_lshl_add_u32 v2, v99, 3, v2
    v_add_u32 v2, 24576, v2
    v_xor_b32 v3, 32, v2
    v_xor_b32 v4, 64, v2
    v_xor_b32 v5, 96, v2
    v_lshl_add_u32 v8, v111, 4, s38
    v_lshrrev_b32 v96, 3, v111
    v_bfe_u32 v97, v111, 0, 3
    v_and_b32 v98, 3, v96
    v_lshlrev_b32 v98, 1, v98
    v_xor_b32 v97, v97, v98
    v_xor_b32 v97, s65, v97
    v_mul_u32_u24 v102, 384, v96
    v_lshl_add_u32 v102, v97, 4, v102
    v_xor_b32 v103, 16, v102
    s_mul_i32 s42, s65, 3072
    v_add_u32 v102, s42, v102
    s_sub_u32 s42, 3072, s42
    v_add_u32 v103, s42, v103
    v_and_b32 v96, 15, v111
    s_mov_b32 s42, 0x1011
    v_bfe_i32 v97, s42, v96, 1
    v_and_b32 v97, 0x3f803f80, v97
    v_accvgpr_write_b32 a236, v97
    v_accvgpr_write_b32 a237, v97
    v_accvgpr_write_b32 a238, v97
    v_accvgpr_write_b32 a239, v97
    s_mov_b32 s42, 0x3222
    v_bfe_i32 v97, s42, v96, 1
    v_and_b32 v97, 0x3f803f80, v97
    v_accvgpr_write_b32 a240, v97
    v_accvgpr_write_b32 a241, v97
    v_accvgpr_write_b32 a242, v97
    v_accvgpr_write_b32 a243, v97
    s_mov_b32 s42, 0x5444
    v_bfe_i32 v97, s42, v96, 1
    v_and_b32 v97, 0x3f803f80, v97
    v_accvgpr_write_b32 a244, v97
    v_accvgpr_write_b32 a245, v97
    v_accvgpr_write_b32 a246, v97
    v_accvgpr_write_b32 a247, v97
    s_mov_b32 s42, 0x9888
    v_bfe_i32 v97, s42, v96, 1
    v_and_b32 v97, 0x3f803f80, v97
    v_accvgpr_write_b32 a248, v97
    v_accvgpr_write_b32 a249, v97
    v_accvgpr_write_b32 a250, v97
    v_accvgpr_write_b32 a251, v97
    s_mov_b32 s42, 0x1100
    v_bfe_i32 v97, s42, v96, 1
    v_and_b32 v97, 0x3f803f80, v97
    v_accvgpr_write_b32 a252, v97
    v_accvgpr_write_b32 a253, v97
    v_accvgpr_write_b32 a254, v97
    v_accvgpr_write_b32 a255, v97
    s_waitcnt vmcnt(18)
    s_barrier
    s_waitcnt vmcnt(12)
    s_add_u32 s48, s34, 18432
    s_add_u32 m0, s38, 18432
    s_nop 0
    buffer_load_dwordx4 v6, s[12:15], s48 offen nt lds
    s_add_u32 m0, s38, 19456
    s_nop 0
    buffer_load_dwordx4 v7, s[12:15], s48 offen nt lds
    v_lshrrev_b32 v105, 11, v0
    s_add_u32 s48, s34, 18560
    v_xor_b32 v105, s65, v105
    s_add_u32 m0, s38, 20480
    s_nop 0
    buffer_load_dwordx4 v6, s[12:15], s48 offen nt lds
    s_add_u32 m0, s38, 21504
    s_nop 0
    buffer_load_dwordx4 v7, s[12:15], s48 offen nt lds
    v_and_b32 v104, 0x3ff, v0
    ds_read_b128 a[232:235], v1 offset:2048
    ds_read_b128 a[212:215], v0 offset:0
    v_lshl_add_u32 v104, v105, 10, v104
    v_add_u32 v104, s38, v104
    s_add_u32 s48, s34, 18688
    s_add_u32 m0, s38, 22528
    v_xor_b32 v105, 64, v104
    buffer_load_dwordx4 v6, s[12:15], s48 offen nt lds
    ds_read_b128 a[220:223], v0 offset:1024
    s_add_u32 m0, s38, 23552
    ds_read_b128 a[96:99], v104 offset:0
    ds_read_b128 a[100:103], v105 offset:0
    buffer_load_dwordx4 v7, s[12:15], s48 offen nt lds
    ds_read_b128 a[108:111], v105 offset:2048
    ds_read_b128 a[112:115], v104 offset:4096
    ds_read_b128 a[224:227], v1 offset:1024
    ds_read_b128 a[216:219], v1 offset:0
    s_waitcnt lgkmcnt(5)
    v_mfma_f32_16x16x32_bf16 v[52:55], a[212:215], a[96:99], 0
    ds_read_b128 a[228:231], v0 offset:2048
    s_waitcnt lgkmcnt(1)
    v_mfma_f32_16x16x32_bf16 v[52:55], a[216:219], a[100:103], v[52:55]
    ds_read_b128 a[104:107], v104 offset:2048
    s_waitcnt lgkmcnt(0)
    v_mfma_f32_16x16x32_bf16 v[52:55], a[220:223], a[104:107], v[52:55]
    ds_read_b128 a[116:119], v105 offset:4096
    v_mfma_f32_16x16x32_bf16 v[52:55], a[224:227], a[108:111], v[52:55]
    ds_read_b128 a[220:223], v0 offset:7168
    v_mfma_f32_16x16x32_bf16 v[52:55], a[228:231], a[112:115], v[52:55]
    ds_read_b128 a[212:215], v0 offset:6144
    s_waitcnt lgkmcnt(2)
    v_mfma_f32_16x16x32_bf16 v[52:55], a[232:235], a[116:119], v[52:55]
    ds_read_b128 a[232:235], v1 offset:8192
    s_waitcnt lgkmcnt(1)
    v_mfma_f32_16x16x32_bf16 v[56:59], a[212:215], a[96:99], 0
    s_nop 4
    v_max3_f32 v96, v52, v53, v54
    ds_read_b128 a[216:219], v1 offset:6144
    s_waitcnt lgkmcnt(0)
    v_mfma_f32_16x16x32_bf16 v[56:59], a[216:219], a[100:103], v[56:59]
    ds_read_b128 a[224:227], v1 offset:7168
    v_mfma_f32_16x16x32_bf16 v[56:59], a[220:223], a[104:107], v[56:59]
    ds_read_b128 a[216:219], v1 offset:12288
    s_waitcnt lgkmcnt(1)
    v_mfma_f32_16x16x32_bf16 v[56:59], a[224:227], a[108:111], v[56:59]
    ds_read_b128 a[228:231], v0 offset:8192
    s_waitcnt lgkmcnt(0)
    v_mfma_f32_16x16x32_bf16 v[56:59], a[228:231], a[112:115], v[56:59]
    ds_read_b128 a[220:223], v0 offset:13312
    v_mfma_f32_16x16x32_bf16 v[56:59], a[232:235], a[116:119], v[56:59]
    s_nop 7
    v_max3_f32 v96, v96, v55, v56
    v_max3_f32 v96, v96, v57, v58
    v_max_f32 v96, v96, v59
    s_waitcnt vmcnt(12)
    s_add_u32 m0, s22, 24576
    ds_read_b128 a[232:235], v1 offset:14336
    buffer_load_dwordx4 v6, s[8:11], s21 offen lds
    s_add_u32 s21, s21, 128
    v_mov_b32 v97, v96
    s_add_u32 m0, s22, 25600
    s_nop 0
    buffer_load_dwordx4 v6, s[8:11], s21 offen lds
    s_add_u32 s21, s21, 128
    v_permlane32_swap_b32 v97, v96
    v_max_f32 v96, v96, v97
    s_add_u32 m0, s22, 26624
    v_mov_b32 v97, v96
    buffer_load_dwordx4 v6, s[8:11], s21 offen lds
    ds_read_b128 a[120:123], v104 offset:6144
    v_permlane16_swap_b32 v97, v96
    v_max_f32 v96, v96, v97
    v_mul_f32_e64 v9, -s28, v96
    v_fma_f32 v53, v53, s28, v9
    ds_read_b128 a[224:227], v1 offset:13312
    v_fma_f32 v54, v54, s28, v9
    v_fma_f32 v55, v55, s28, v9
    v_fma_f32 v57, v57, s28, v9
    v_fma_f32 v52, v52, s28, v9
    ds_read_b128 a[212:215], v0 offset:12288
    v_exp_f32 v55, v55
    v_exp_f32 v52, v52
    ds_read_b128 a[228:231], v0 offset:14336
    v_exp_f32 v53, v53
    v_exp_f32 v54, v54
    v_exp_f32 v57, v57
    v_cvt_pk_bf16_f32 v15, v54, v55
    v_fma_f32 v58, v58, s28, v9
    v_cvt_pk_bf16_f32 v14, v52, v53
    s_waitcnt lgkmcnt(1)
    v_mfma_f32_16x16x32_bf16 v[52:55], a[212:215], a[96:99], 0
    v_fma_f32 v59, v59, s28, v9
    ds_read_b128 a[124:127], v105 offset:6144
    v_mfma_f32_16x16x32_bf16 v[52:55], a[216:219], a[100:103], v[52:55]
    ds_read_b128 a[216:219], v1 offset:18432
    v_mfma_f32_16x16x32_bf16 v[52:55], a[220:223], a[104:107], v[52:55]
    ds_read_b128 a[212:215], v0 offset:18432
    v_fma_f32 v56, v56, s28, v9
    v_exp_f32 v56, v56
    v_mfma_f32_16x16x32_bf16 v[52:55], a[224:227], a[108:111], v[52:55]
    s_waitcnt lgkmcnt(3)
    v_exp_f32 v58, v58
    ds_read_b128 a[132:135], v105 offset:8192
    v_mfma_f32_16x16x32_bf16 v[52:55], a[228:231], a[112:115], v[52:55]
    ds_read_b128 a[224:227], v1 offset:19456
    v_cvt_pk_bf16_f32 v16, v56, v57
    v_exp_f32 v59, v59
    v_mfma_f32_16x16x32_bf16 v[52:55], a[232:235], a[116:119], v[52:55]
    ds_read_b128 a[220:223], v0 offset:19456
    v_cvt_pk_bf16_f32 v17, v58, v59
    s_waitcnt lgkmcnt(3)
    v_mfma_f32_16x16x32_bf16 v[56:59], a[212:215], a[96:99], 0
    ds_read_b128 a[212:215], v0 offset:0
    ds_read_b128 a[228:231], v0 offset:20480
    v_mfma_f32_16x16x32_bf16 v[56:59], a[216:219], a[100:103], v[56:59]
    ds_read_b128 a[136:139], v104 offset:10240
    s_waitcnt lgkmcnt(3)
    v_mfma_f32_16x16x32_bf16 v[56:59], a[220:223], a[104:107], v[56:59]
    ds_read_b128 a[128:131], v104 offset:8192
    ds_read_b128 a[220:223], v0 offset:1024
    v_mfma_f32_16x16x32_bf16 v[56:59], a[224:227], a[108:111], v[56:59]
    v_fma_f32 v52, v52, s28, v9
    ds_read_b128 a[232:235], v1 offset:20480
    s_waitcnt lgkmcnt(4)
    v_mfma_f32_16x16x32_bf16 v[56:59], a[228:231], a[112:115], v[56:59]
    ds_read_b128 a[216:219], v1 offset:0
    s_waitcnt lgkmcnt(1)
    v_mfma_f32_16x16x32_bf16 v[56:59], a[232:235], a[116:119], v[56:59]
    v_fma_f32 v55, v55, s28, v9
    s_add_u32 s21, s21, 12032
    ds_read_b128 a[140:143], v105 offset:10240
    v_mfma_f32_16x16x32_bf16 v[60:63], a[212:215], a[120:123], 0
    ds_read_b128 a[224:227], v1 offset:1024
    s_waitcnt lgkmcnt(2)
    v_mfma_f32_16x16x32_bf16 v[60:63], a[216:219], a[124:127], v[60:63]
    ds_read_b128 a[228:231], v0 offset:2048
    v_mfma_f32_16x16x32_bf16 v[60:63], a[220:223], a[128:131], v[60:63]
    ds_read_b128 a[232:235], v1 offset:2048
    s_waitcnt lgkmcnt(2)
    v_mfma_f32_16x16x32_bf16 v[60:63], a[224:227], a[132:135], v[60:63]
    ds_read_b128 a[220:223], v0 offset:7168
    s_waitcnt lgkmcnt(2)
    v_mfma_f32_16x16x32_bf16 v[60:63], a[228:231], a[136:139], v[60:63]
    ds_read_b128 a[216:219], v1 offset:6144
    s_waitcnt lgkmcnt(2)
    v_mfma_f32_16x16x32_bf16 v[60:63], a[232:235], a[140:143], v[60:63]
    ds_read_b128 a[212:215], v0 offset:6144
    v_exp_f32 v55, v55
    s_waitcnt lgkmcnt(0)
    v_mfma_f32_16x16x32_bf16 v[64:67], a[212:215], a[120:123], 0
    ds_read_b128 a[232:235], v1 offset:8192
    ds_read_b128 a[228:231], v0 offset:8192
    v_mfma_f32_16x16x32_bf16 v[64:67], a[216:219], a[124:127], v[64:67]
    ds_read_b128 a[224:227], v1 offset:7168
    v_mfma_f32_16x16x32_bf16 v[64:67], a[220:223], a[128:131], v[64:67]
    ds_read_b128 a[220:223], v0 offset:13312
    s_waitcnt lgkmcnt(1)
    v_mfma_f32_16x16x32_bf16 v[64:67], a[224:227], a[132:135], v[64:67]
    ds_read_b128 a[216:219], v1 offset:12288
    s_waitcnt vmcnt(9)
    s_add_u32 m0, s22, 36864
    ds_read_b128 a[212:215], v0 offset:12288
    buffer_load_dwordx4 v6, s[8:11], s21 offen lds
    v_max3_f32 v98, v60, v61, v62
    s_add_u32 s21, s21, 128
    v_mfma_f32_16x16x32_bf16 v[64:67], a[228:231], a[136:139], v[64:67]
    s_add_u32 m0, s22, 37888
    s_nop 0
    buffer_load_dwordx4 v6, s[8:11], s21 offen lds
    s_add_u32 s21, s21, 128
    ds_read_b128 a[148:151], v105 offset:12288
    ds_read_b128 a[164:167], v105 offset:16384
    v_mfma_f32_16x16x32_bf16 v[64:67], a[232:235], a[140:143], v[64:67]
    s_add_u32 m0, s22, 38912
    s_nop 0
    buffer_load_dwordx4 v6, s[8:11], s21 offen lds
    ds_read_b128 a[224:227], v1 offset:13312
    v_fma_f32 v53, v53, s28, v9
    s_nop 2
    v_max3_f32 v98, v98, v63, v64
    ds_read_b128 a[228:231], v0 offset:14336
    v_max3_f32 v98, v98, v65, v66
    v_max_f32 v98, v98, v67
    v_mov_b32 v99, v98
    s_nop 1
    v_permlane32_swap_b32 v99, v98
    v_max_f32 v98, v98, v99
    v_mov_b32 v99, v98
    s_nop 1
    v_permlane16_swap_b32 v99, v98
    v_max_f32 v98, v98, v99
    v_mul_f32_e64 v10, -s28, v98
    v_fma_f32 v60, v60, s28, v10
    v_exp_f32 v60, v60
    v_fma_f32 v62, v62, s28, v10
    v_mfma_f32_16x16x32_bf16 v[44:47], a[236:239], v[14:17], 0
    v_fma_f32 v61, v61, s28, v10
    v_exp_f32 v62, v62
    v_exp_f32 v61, v61
    s_nop 0
    v_cvt_pk_bf16_f32 v20, v60, v61
    v_fma_f32 v66, v66, s28, v10
    v_fma_f32 v63, v63, s28, v10
    v_fma_f32 v64, v64, s28, v10
    v_exp_f32 v63, v63
    v_exp_f32 v66, v66
    ds_read_b128 a[232:235], v1 offset:14336
    v_cvt_pk_bf16_f32 v21, v62, v63
    v_fma_f32 v67, v67, s28, v10
    s_waitcnt lgkmcnt(1)
    v_mfma_f32_16x16x32_bf16 v[60:63], a[212:215], a[120:123], 0
    v_fma_f32 v65, v65, s28, v10
    ds_read_b128 a[152:155], v104 offset:14336
    v_exp_f32 v67, v67
    ds_read_b128 a[212:215], v0 offset:18432
    v_mfma_f32_16x16x32_bf16 v[60:63], a[216:219], a[124:127], v[60:63]
    ds_read_b128 a[216:219], v1 offset:18432
    v_mfma_f32_16x16x32_bf16 v[60:63], a[220:223], a[128:131], v[60:63]
    ds_read_b128 a[220:223], v0 offset:19456
    v_fma_f32 v54, v54, s28, v9
    ds_read_b128 a[156:159], v105 offset:14336
    v_exp_f32 v64, v64
    v_exp_f32 v65, v65
    v_mfma_f32_16x16x32_bf16 v[60:63], a[224:227], a[132:135], v[60:63]
    ds_read_b128 a[160:163], v104 offset:16384
    v_mfma_f32_16x16x32_bf16 v[60:63], a[228:231], a[136:139], v[60:63]
    v_cvt_pk_bf16_f32 v22, v64, v65
    ds_read_b128 a[224:227], v1 offset:19456
    s_waitcnt lgkmcnt(7)
    v_mfma_f32_16x16x32_bf16 v[60:63], a[232:235], a[140:143], v[60:63]
    v_cvt_pk_bf16_f32 v23, v66, v67
    ds_read_b128 a[228:231], v0 offset:20480
    s_waitcnt lgkmcnt(6)
    v_mfma_f32_16x16x32_bf16 v[64:67], a[212:215], a[120:123], 0
    ds_read_b128 a[144:147], v104 offset:12288
    s_waitcnt lgkmcnt(6)
    v_mfma_f32_16x16x32_bf16 v[64:67], a[216:219], a[124:127], v[64:67]
    ds_read_b128 a[212:215], v0 offset:0
    ds_read_b128 a[232:235], v1 offset:20480
    s_waitcnt lgkmcnt(7)
    v_mfma_f32_16x16x32_bf16 v[64:67], a[220:223], a[128:131], v[64:67]
    ds_read_b128 a[216:219], v1 offset:0
    v_exp_f32 v52, v52
    s_waitcnt lgkmcnt(5)
    v_mfma_f32_16x16x32_bf16 v[64:67], a[224:227], a[132:135], v[64:67]
    ds_read_b128 a[220:223], v0 offset:1024
    s_waitcnt lgkmcnt(5)
    v_mfma_f32_16x16x32_bf16 v[64:67], a[228:231], a[136:139], v[64:67]
    ds_read_b128 a[224:227], v1 offset:1024
    s_waitcnt lgkmcnt(3)
    v_mfma_f32_16x16x32_bf16 v[64:67], a[232:235], a[140:143], v[64:67]
    ds_read_b128 a[228:231], v0 offset:2048
    v_mfma_f32_16x16x32_bf16 v[68:71], a[212:215], a[144:147], 0
    s_waitcnt lgkmcnt(3)
    ds_read_b128 a[232:235], v1 offset:2048
    v_mfma_f32_16x16x32_bf16 v[68:71], a[216:219], a[148:151], v[68:71]
    ds_read_b128 a[212:215], v0 offset:6144
    s_waitcnt lgkmcnt(4)
    v_mfma_f32_16x16x32_bf16 v[68:71], a[220:223], a[152:155], v[68:71]
    v_exp_f32 v54, v54
    s_add_u32 s21, s21, 12032
    ds_read_b128 a[216:219], v1 offset:6144
    s_waitcnt lgkmcnt(4)
    v_mfma_f32_16x16x32_bf16 v[68:71], a[224:227], a[156:159], v[68:71]
    ds_read_b128 a[224:227], v1 offset:7168
    v_fma_f32 v61, v61, s28, v10
    s_waitcnt lgkmcnt(4)
    v_mfma_f32_16x16x32_bf16 v[68:71], a[228:231], a[160:163], v[68:71]
    ds_read_b128 a[220:223], v0 offset:7168
    s_waitcnt lgkmcnt(4)
    v_mfma_f32_16x16x32_bf16 v[68:71], a[232:235], a[164:167], v[68:71]
    ds_read_b128 a[228:231], v0 offset:8192
    s_waitcnt lgkmcnt(4)
    v_mfma_f32_16x16x32_bf16 v[72:75], a[212:215], a[144:147], 0
    ds_read_b128 a[232:235], v1 offset:8192
    s_waitcnt lgkmcnt(4)
    v_mfma_f32_16x16x32_bf16 v[72:75], a[216:219], a[148:151], v[72:75]
    ds_read_b128 a[216:219], v1 offset:12288
    s_nop 0
    v_max3_f32 v96, v68, v69, v70
    s_waitcnt lgkmcnt(3)
    v_mfma_f32_16x16x32_bf16 v[72:75], a[220:223], a[152:155], v[72:75]
    ds_read_b128 a[220:223], v0 offset:13312
    v_mfma_f32_16x16x32_bf16 v[72:75], a[224:227], a[156:159], v[72:75]
    s_waitcnt lgkmcnt(3)
    ds_read_b128 a[212:215], v0 offset:12288
    v_mfma_f32_16x16x32_bf16 v[72:75], a[228:231], a[160:163], v[72:75]
    s_waitcnt lgkmcnt(3)
    ds_read_b128 a[228:231], v0 offset:14336
    v_mfma_f32_16x16x32_bf16 v[72:75], a[232:235], a[164:167], v[72:75]
    s_nop 7
    v_max3_f32 v96, v96, v71, v72
    ds_read_b128 a[224:227], v1 offset:13312
    v_max3_f32 v96, v96, v73, v74
    v_max_f32 v96, v96, v75
    v_mov_b32 v97, v96
    s_nop 1
    v_permlane32_swap_b32 v97, v96
    v_max_f32 v96, v96, v97
    v_mov_b32 v97, v96
    s_nop 1
    v_permlane16_swap_b32 v97, v96
    v_max_f32 v96, v96, v97
    v_mfma_f32_16x16x32_bf16 v[44:47], a[240:243], v[20:23], v[44:47]
    ds_read_b128 a[232:235], v1 offset:14336
    v_mul_f32_e64 v11, -s28, v96
    v_fma_f32 v69, v69, s28, v11
    v_fma_f32 v73, v73, s28, v11
    v_fma_f32 v74, v74, s28, v11
    v_fma_f32 v70, v70, s28, v11
    v_fma_f32 v68, v68, s28, v11
    v_exp_f32 v70, v70
    v_fma_f32 v71, v71, s28, v11
    v_exp_f32 v69, v69
    v_exp_f32 v53, v53
    v_exp_f32 v68, v68
    v_exp_f32 v71, v71
    v_cvt_pk_bf16_f32 v26, v68, v69
    v_cvt_pk_bf16_f32 v27, v70, v71
    v_exp_f32 v74, v74
    v_exp_f32 v73, v73
    s_waitcnt lgkmcnt(1)
    v_mfma_f32_16x16x32_bf16 v[68:71], a[212:215], a[144:147], 0
    v_fma_f32 v75, v75, s28, v11
    v_fma_f32 v72, v72, s28, v11
    ds_read_b128 a[212:215], v0 offset:18432
    v_mfma_f32_16x16x32_bf16 v[68:71], a[216:219], a[148:151], v[68:71]
    v_cvt_pk_bf16_f32 v19, v54, v55
    ds_read_b128 a[216:219], v1 offset:18432
    v_mfma_f32_16x16x32_bf16 v[68:71], a[220:223], a[152:155], v[68:71]
    ds_read_b128 a[220:223], v0 offset:19456
    v_mfma_f32_16x16x32_bf16 v[68:71], a[224:227], a[156:159], v[68:71]
    ds_read_b128 a[224:227], v1 offset:19456
    v_exp_f32 v75, v75
    v_exp_f32 v61, v61
    v_exp_f32 v72, v72
    s_nop 0
    v_cvt_pk_bf16_f32 v28, v72, v73
    v_fma_f32 v60, v60, s28, v10
    v_mfma_f32_16x16x32_bf16 v[68:71], a[228:231], a[160:163], v[68:71]
    s_waitcnt lgkmcnt(4)
    ds_read_b128 a[228:231], v0 offset:20480
    v_cvt_pk_bf16_f32 v29, v74, v75
    v_mfma_f32_16x16x32_bf16 v[68:71], a[232:235], a[164:167], v[68:71]
    ds_read_b128 a[232:235], v1 offset:20480
    s_waitcnt lgkmcnt(5)
    v_mfma_f32_16x16x32_bf16 v[72:75], a[212:215], a[144:147], 0
    ds_read_b128 a[212:215], v0 offset:0
    s_waitcnt lgkmcnt(5)
    v_mfma_f32_16x16x32_bf16 v[72:75], a[216:219], a[148:151], v[72:75]
    ds_read_b128 a[216:219], v1 offset:0
    v_exp_f32 v60, v60
    s_waitcnt lgkmcnt(5)
    v_mfma_f32_16x16x32_bf16 v[72:75], a[220:223], a[152:155], v[72:75]
    s_waitcnt vmcnt(6)
    ds_read_b128 a[168:171], v104 offset:18432
    ds_read_b128 a[172:175], v105 offset:18432
    s_waitcnt lgkmcnt(6)
    v_mfma_f32_16x16x32_bf16 v[72:75], a[224:227], a[156:159], v[72:75]
    ds_read_b128 a[220:223], v0 offset:1024
    ds_read_b128 a[224:227], v1 offset:1024
    ds_read_b128 a[176:179], v104 offset:20480
    s_waitcnt lgkmcnt(8)
    v_mfma_f32_16x16x32_bf16 v[72:75], a[228:231], a[160:163], v[72:75]
    s_waitcnt lgkmcnt(7)
    ds_read_b128 a[180:183], v105 offset:20480
    v_mfma_f32_16x16x32_bf16 v[72:75], a[232:235], a[164:167], v[72:75]
    ds_read_b128 a[228:231], v0 offset:2048
    ds_read_b128 a[184:187], v104 offset:22528
    v_mfma_f32_16x16x32_bf16 v[44:47], a[244:247], v[26:29], v[44:47]
    ds_read_b128 a[232:235], v1 offset:2048
    ds_read_b128 a[188:191], v105 offset:22528
    s_waitcnt lgkmcnt(9)
    v_mfma_f32_16x16x32_bf16 v[76:79], a[212:215], a[168:171], 0
    s_waitcnt lgkmcnt(8)
    ds_read_b128 a[212:215], v0 offset:6144
    v_mfma_f32_16x16x32_bf16 v[76:79], a[216:219], a[172:175], v[76:79]
    ds_read_b128 a[216:219], v1 offset:6144
    s_waitcnt lgkmcnt(7)
    v_mfma_f32_16x16x32_bf16 v[76:79], a[220:223], a[176:179], v[76:79]
    ds_read_b128 a[220:223], v0 offset:7168
    s_waitcnt lgkmcnt(7)
    v_mfma_f32_16x16x32_bf16 v[76:79], a[224:227], a[180:183], v[76:79]
    ds_read_b128 a[224:227], v1 offset:7168
    s_waitcnt lgkmcnt(6)
    v_mfma_f32_16x16x32_bf16 v[76:79], a[228:231], a[184:187], v[76:79]
    ds_read_b128 a[228:231], v0 offset:8192
    s_waitcnt lgkmcnt(5)
    v_mfma_f32_16x16x32_bf16 v[76:79], a[232:235], a[188:191], v[76:79]
    ds_read_b128 a[232:235], v1 offset:8192
    s_waitcnt lgkmcnt(5)
    v_mfma_f32_16x16x32_bf16 v[80:83], a[212:215], a[168:171], 0
    s_waitcnt lgkmcnt(4)
    v_mfma_f32_16x16x32_bf16 v[80:83], a[216:219], a[172:175], v[80:83]
    s_nop 2
    v_max3_f32 v98, v76, v77, v78
    s_waitcnt lgkmcnt(3)
    v_mfma_f32_16x16x32_bf16 v[80:83], a[220:223], a[176:179], v[80:83]
    s_waitcnt vmcnt(63) lgkmcnt(0)
    s_barrier
    ds_read_b128 a[212:215], v0 offset:12288
    v_mfma_f32_16x16x32_bf16 v[80:83], a[224:227], a[180:183], v[80:83]
    s_add_u32 m0, s22, 0
    ds_read_b128 a[220:223], v0 offset:13312
    buffer_load_dwordx4 v6, s[4:7], s20 offen lds
    s_add_u32 s20, s20, 128
    v_mfma_f32_16x16x32_bf16 v[80:83], a[228:231], a[184:187], v[80:83]
    s_add_u32 m0, s22, 1024
    ds_read_b128 a[216:219], v1 offset:12288
    buffer_load_dwordx4 v6, s[4:7], s20 offen lds
    v_mfma_f32_16x16x32_bf16 v[80:83], a[232:235], a[188:191], v[80:83]
    s_add_u32 s20, s20, 128
    s_add_u32 m0, s22, 2048
    ds_read_b128 a[228:231], v0 offset:14336
    ds_read_b128 a[224:227], v1 offset:13312
    buffer_load_dwordx4 v6, s[4:7], s20 offen lds
    s_add_u32 s20, s20, 12032
    s_mov_b32 s39, s64
    s_add_u32 s37, s37, 1
    v_max3_f32 v98, v98, v79, v80
    v_max3_f32 v98, v98, v81, v82
    v_max_f32 v98, v98, v83
    v_mov_b32 v99, v98
    s_bitcmp1_b32 s63, s37
    s_cselect_b32 s62, 4294770688, 0
    v_permlane32_swap_b32 v99, v98
    v_max_f32 v98, v98, v99
    v_mov_b32 v99, v98
    s_cselect_b32 s42, 0, 325632
    s_add_u32 s35, s35, s42
    ds_read_b128 a[232:235], v1 offset:14336
    v_permlane16_swap_b32 v99, v98
    v_max_f32 v98, v98, v99
    v_mul_f32_e64 v12, -s28, v98
    s_lshl_b32 s42, s37, 1
    v_fma_f32 v77, v77, s28, v12
    v_fma_f32 v76, v76, s28, v12
    v_fma_f32 v79, v79, s28, v12
    v_fma_f32 v78, v78, s28, v12
    v_exp_f32 v79, v79
    v_exp_f32 v76, v76
    v_exp_f32 v77, v77
    v_exp_f32 v78, v78
    v_cvt_pk_bf16_f32 v32, v76, v77
    v_cvt_pk_bf16_f32 v33, v78, v79
    s_waitcnt lgkmcnt(1)
    v_mfma_f32_16x16x32_bf16 v[76:79], a[212:215], a[168:171], 0
    s_lshr_b32 s42, s31, s42
    s_and_b32 s42, s42, 3
    ds_read_b128 a[212:215], v0 offset:18432
    v_mfma_f32_16x16x32_bf16 v[76:79], a[216:219], a[172:175], v[76:79]
    s_add_u32 s42, s42, s36
    ds_read_b128 a[216:219], v1 offset:18432
    s_sub_u32 s43, s42, 3
    v_mfma_f32_16x16x32_bf16 v[76:79], a[220:223], a[176:179], v[76:79]
    s_cmp_ge_u32 s42, 3
    ds_read_b128 a[220:223], v0 offset:19456
    v_fma_f32 v83, v83, s28, v12
    v_mfma_f32_16x16x32_bf16 v[76:79], a[224:227], a[180:183], v[76:79]
    s_cselect_b32 s42, s43, s42
    ds_read_b128 a[224:227], v1 offset:19456
    s_mul_i32 s44, s3, 5
    v_mfma_f32_16x16x32_bf16 v[76:79], a[228:231], a[184:187], v[76:79]
    s_mov_b32 s32, 1
    ds_read_b128 a[228:231], v0 offset:20480
    s_waitcnt lgkmcnt(5)
    v_mfma_f32_16x16x32_bf16 v[76:79], a[232:235], a[188:191], v[76:79]
    s_lshl_b32 s43, s3, 2
    ds_read_b128 a[232:235], v1 offset:20480
    s_add_u32 s45, s43, 21
    s_cmp_eq_u32 s3, 0
    v_fma_f32 v80, v80, s28, v12
    s_cselect_b32 s45, 20, s45
    s_cselect_b32 s33, 1, 0
    s_cmp_eq_u32 s42, 1
    s_cselect_b32 s44, s45, s44
    s_cselect_b32 s32, s33, s32
    s_add_u32 s45, s43, 37
    s_cmp_eq_u32 s42, 2
    v_exp_f32 v83, v83
    s_cselect_b32 s44, s45, s44
    s_cselect_b32 s32, 0, s32
    s_mul_i32 s44, s44, 6144
    v_exp_f32 v80, v80
    s_add_u32 s33, s35, s44
    s_mul_i32 s42, s32, 6144
    v_fma_f32 v81, v81, s28, v12
    v_fma_f32 v82, v82, s28, v12
    s_add_u32 s42, s42, 24576
    s_add_u32 s42, s42, s33
    s_cmp_ge_u32 s37, 6
    v_exp_f32 v81, v81
    s_cselect_b32 s14, 0, s42
    s_add_u32 s24, s67, 6400
    s_add_u32 s25, s33, 6400
    v_exp_f32 v82, v82
    s_add_u32 s23, s38, 10240
    s_mov_b32 s27, 0x49249249
    v_cvt_pk_bf16_f32 v34, v80, v81
    v_cvt_pk_bf16_f32 v35, v82, v83
    s_mov_b32 s30, 0
    s_waitcnt vmcnt(6) lgkmcnt(0)
    v_mfma_f32_16x16x32_bf16 v[80:83], a[212:215], a[168:171], 0
    s_barrier
    ds_read_b64_tr_b16 a[212:213], v2 offset:0
    ds_read_b64_tr_b16 a[214:215], v2 offset:6144
    s_add_u32 m0, s22, 12288
    v_mfma_f32_16x16x32_bf16 v[80:83], a[216:219], a[172:175], v[80:83]
    ds_read_b64_tr_b16 a[216:217], v3 offset:0
    buffer_load_dwordx4 v6, s[4:7], s20 offen lds
    s_add_u32 s20, s20, 128
    v_mfma_f32_16x16x32_bf16 v[80:83], a[220:223], a[176:179], v[80:83]
    ds_read_b64_tr_b16 a[218:219], v3 offset:6144
    s_add_u32 m0, s22, 13312
    v_mfma_f32_16x16x32_bf16 v[80:83], a[224:227], a[180:183], v[80:83]
    buffer_load_dwordx4 v6, s[4:7], s20 offen lds
    v_cvt_pk_bf16_f32 v18, v52, v53
    s_add_u32 s20, s20, 128
    ds_read_b64_tr_b16 a[220:221], v4 offset:0
    v_mfma_f32_16x16x32_bf16 v[80:83], a[228:231], a[184:187], v[80:83]
    ds_read_b64_tr_b16 a[222:223], v4 offset:6144
    v_cvt_pk_bf16_f32 v24, v60, v61
    v_mfma_f32_16x16x32_bf16 v[44:47], a[248:251], v[32:35], v[44:47]
    ds_read_b64_tr_b16 a[224:225], v5 offset:0
    s_add_u32 m0, s22, 14336
    s_nop 0
    buffer_load_dwordx4 v6, s[4:7], s20 offen lds
    ds_read_b64_tr_b16 a[226:227], v5 offset:6144
    v_mfma_f32_16x16x32_bf16 v[80:83], a[232:235], a[188:191], v[80:83]
    s_add_u32 s20, s20, 12032
    s_waitcnt lgkmcnt(6)
    v_mfma_f32_16x16x32_bf16 v[112:115], a[212:215], v[14:17], 0
    ds_read_b64_tr_b16 a[234:235], v3 offset:7168
    v_fma_f32 v56, v56, s28, v9
    v_mfma_f32_16x16x32_bf16 v[160:163], a[212:215], v[20:23], 0
    ds_read_b64_tr_b16 a[228:229], v2 offset:1024
    v_mfma_f32_16x16x32_bf16 v[208:211], a[212:215], v[26:29], 0
    ds_read_b64_tr_b16 a[232:233], v3 offset:1024
    v_exp_f32 v56, v56
    v_fma_f32 v70, v70, s28, v11
    v_mfma_f32_16x16x32_bf16 a[0:3], a[212:215], v[32:35], 0
    s_waitcnt lgkmcnt(7)
    v_fma_f32 v69, v69, s28, v11
    v_fma_f32 v78, v78, s28, v12
    v_mfma_f32_16x16x32_bf16 a[4:7], a[216:219], v[32:35], 0
    ds_read_b64_tr_b16 a[230:231], v2 offset:7168
    v_fma_f32 v77, v77, s28, v12
    v_mfma_f32_16x16x32_bf16 v[212:215], a[216:219], v[26:29], 0
    v_add_u32 v8, 10240, v8
    v_fma_f32 v63, v63, s28, v10
    v_mfma_f32_16x16x32_bf16 v[164:167], a[216:219], v[20:23], 0
    v_exp_f32 v78, v78
    v_mfma_f32_16x16x32_bf16 v[116:119], a[216:219], v[14:17], 0
    s_waitcnt lgkmcnt(6)
    v_fma_f32 v66, v66, s28, v10
    v_fma_f32 v67, v67, s28, v10
    v_mfma_f32_16x16x32_bf16 v[120:123], a[220:223], v[14:17], 0
    v_fma_f32 v62, v62, s28, v10
    v_fma_f32 v65, v65, s28, v10
    v_mfma_f32_16x16x32_bf16 v[168:171], a[220:223], v[20:23], 0
    ds_read_b64_tr_b16 a[212:213], v4 offset:1024
    v_fma_f32 v71, v71, s28, v11
    v_mfma_f32_16x16x32_bf16 v[216:219], a[220:223], v[26:29], 0
    v_exp_f32 v62, v62
    v_mfma_f32_16x16x32_bf16 a[8:11], a[220:223], v[32:35], 0
    s_waitcnt lgkmcnt(3)
    ds_read_b64_tr_b16 a[220:221], v2 offset:2048
    v_fma_f32 v82, v82, s28, v12
    v_mfma_f32_16x16x32_bf16 a[12:15], a[224:227], v[32:35], 0
    ds_read_b64_tr_b16 a[218:219], v5 offset:7168
    v_fma_f32 v58, v58, s28, v9
    v_mfma_f32_16x16x32_bf16 v[220:223], a[224:227], v[26:29], 0
    ds_read_b64_tr_b16 a[214:215], v4 offset:7168
    v_fma_f32 v72, v72, s28, v11
    v_mfma_f32_16x16x32_bf16 v[172:175], a[224:227], v[20:23], 0
    v_exp_f32 v70, v70
    v_mfma_f32_16x16x32_bf16 v[124:127], a[224:227], v[14:17], 0
    s_waitcnt lgkmcnt(4)
    ds_read_b64_tr_b16 a[226:227], v3 offset:8192
    v_fma_f32 v59, v59, s28, v9
    v_mfma_f32_16x16x32_bf16 v[128:131], a[228:231], v[14:17], 0
    s_add_u32 s39, s39, 12288
    ds_read_b64_tr_b16 a[216:217], v5 offset:1024
    v_fma_f32 v74, v74, s28, v11
    v_mfma_f32_16x16x32_bf16 v[176:179], a[228:231], v[20:23], 0
    ds_read_b64_tr_b16 a[224:225], v3 offset:2048
    v_fma_f32 v76, v76, s28, v12
    v_mfma_f32_16x16x32_bf16 v[224:227], a[228:231], v[26:29], 0
    ds_read_b64_tr_b16 a[222:223], v2 offset:8192
    v_fma_f32 v75, v75, s28, v11
    v_mfma_f32_16x16x32_bf16 a[16:19], a[228:231], v[32:35], 0
    ds_read_b64_tr_b16 a[230:231], v4 offset:8192
    v_fma_f32 v57, v57, s28, v9
    v_mfma_f32_16x16x32_bf16 a[20:23], a[232:235], v[32:35], 0
    v_exp_f32 v76, v76
    v_mfma_f32_16x16x32_bf16 v[228:231], a[232:235], v[26:29], 0
    ds_read_b64_tr_b16 a[228:229], v4 offset:2048
    v_fma_f32 v68, v68, s28, v11
    v_mfma_f32_16x16x32_bf16 v[180:183], a[232:235], v[20:23], 0
    v_exp_f32 v58, v58
    v_mfma_f32_16x16x32_bf16 v[132:135], a[232:235], v[14:17], 0
    s_waitcnt lgkmcnt(6)
    ds_read_b64_tr_b16 a[234:235], v5 offset:8192
    v_fma_f32 v80, v80, s28, v12
    v_mfma_f32_16x16x32_bf16 v[136:139], a[212:215], v[14:17], 0
    ds_read_b64_tr_b16 a[232:233], v5 offset:2048
    v_mfma_f32_16x16x32_bf16 v[184:187], a[212:215], v[20:23], 0
    v_exp_f32 v69, v69
    v_mfma_f32_16x16x32_bf16 v[232:235], a[212:215], v[26:29], 0
    v_exp_f32 v72, v72
    v_mfma_f32_16x16x32_bf16 a[24:27], a[212:215], v[32:35], 0
    s_waitcnt lgkmcnt(5)
    v_exp_f32 v65, v65
    v_mfma_f32_16x16x32_bf16 a[28:31], a[216:219], v[32:35], 0
    v_exp_f32 v68, v68
    v_mfma_f32_16x16x32_bf16 v[236:239], a[216:219], v[26:29], 0
    v_exp_f32 v77, v77
    v_mfma_f32_16x16x32_bf16 v[188:191], a[216:219], v[20:23], 0
    v_exp_f32 v71, v71
    v_mfma_f32_16x16x32_bf16 v[140:143], a[216:219], v[14:17], 0
    s_waitcnt lgkmcnt(2)
    v_exp_f32 v59, v59
    v_mfma_f32_16x16x32_bf16 v[144:147], a[220:223], v[14:17], 0
    v_fma_f32 v79, v79, s28, v12
    v_fma_f32 v73, v73, s28, v11
    v_mfma_f32_16x16x32_bf16 v[192:195], a[220:223], v[20:23], 0
    v_fma_f32 v64, v64, s28, v10
    s_waitcnt vmcnt(3) lgkmcnt(0)
    v_mfma_f32_16x16x32_bf16 v[240:243], a[220:223], v[26:29], 0
    s_barrier
    v_mfma_f32_16x16x32_bf16 a[32:35], a[220:223], v[32:35], 0
    s_add_u32 m0, s22, 24576
    ds_read_b128 a[216:219], v1 offset:0
    v_fma_f32 v83, v83, s28, v12
    v_mfma_f32_16x16x32_bf16 a[36:39], a[224:227], v[32:35], 0
    buffer_load_dwordx4 v6, s[8:11], s21 offen lds
    v_mfma_f32_16x16x32_bf16 v[244:247], a[224:227], v[26:29], 0
    ds_read_b128 a[212:215], v0 offset:0
    v_cvt_pk_bf16_f32 v31, v70, v71
    v_mfma_f32_16x16x32_bf16 v[196:199], a[224:227], v[20:23], 0
    s_add_u32 s21, s21, 128
    ds_read_b128 a[220:223], v0 offset:1024
    s_add_u32 m0, s22, 25600
    v_mfma_f32_16x16x32_bf16 v[148:151], a[224:227], v[14:17], 0
    buffer_load_dwordx4 v6, s[8:11], s21 offen lds
    v_mfma_f32_16x16x32_bf16 v[152:155], a[228:231], v[14:17], 0
    s_add_u32 s21, s21, 128
    v_exp_f32 v64, v64
    v_mfma_f32_16x16x32_bf16 v[200:203], a[228:231], v[20:23], 0
    s_add_u32 m0, s22, 26624
    v_exp_f32 v67, v67
    v_mfma_f32_16x16x32_bf16 v[248:251], a[228:231], v[26:29], 0
    buffer_load_dwordx4 v6, s[8:11], s21 offen lds
    v_mfma_f32_16x16x32_bf16 a[40:43], a[228:231], v[32:35], 0
    v_exp_f32 v83, v83
    v_mfma_f32_16x16x32_bf16 a[44:47], a[232:235], v[32:35], 0
    ds_read_b128 a[224:227], v1 offset:1024
    v_mfma_f32_16x16x32_bf16 v[252:255], a[232:235], v[26:29], 0
    v_cvt_pk_bf16_f32 v36, v76, v77
    v_cvt_pk_bf16_f32 v30, v68, v69
    v_mfma_f32_16x16x32_bf16 v[204:207], a[232:235], v[20:23], 0
    s_add_u32 s21, s21, 12032
    ds_read_b128 a[228:231], v0 offset:2048
    v_fma_f32 v81, v81, s28, v12
    v_mfma_f32_16x16x32_bf16 v[156:159], a[232:235], v[14:17], 0
    s_waitcnt lgkmcnt(3)
    v_exp_f32 v63, v63
    v_mfma_f32_16x16x32_bf16 v[52:55], a[212:215], a[96:99], 0
    v_exp_f32 v79, v79
    v_mfma_f32_16x16x32_bf16 v[52:55], a[216:219], a[100:103], v[52:55]
    s_waitcnt lgkmcnt(2)
    v_exp_f32 v57, v57
    v_mfma_f32_16x16x32_bf16 v[52:55], a[220:223], a[104:107], v[52:55]
    v_cvt_pk_bf16_f32 v25, v62, v63
    v_mfma_f32_16x16x32_bf16 v[60:63], a[220:223], a[128:131], 0
    ds_read_b128 a[232:235], v1 offset:2048
    v_cvt_pk_bf16_f32 v37, v78, v79
    v_mfma_f32_16x16x32_bf16 v[60:63], a[216:219], a[124:127], v[60:63]
    v_exp_f32 v66, v66
    v_mfma_f32_16x16x32_bf16 v[60:63], a[212:215], a[120:123], v[60:63]
    v_exp_f32 v74, v74
    v_mfma_f32_16x16x32_bf16 v[68:71], a[212:215], a[144:147], 0
    v_exp_f32 v73, v73
    v_mfma_f32_16x16x32_bf16 v[68:71], a[216:219], a[148:151], v[68:71]
    s_add_u32 m0, s38, 0
    v_cvt_pk_bf16_f32 v28, v72, v73
    v_mfma_f32_16x16x32_bf16 v[68:71], a[220:223], a[152:155], v[68:71]
    buffer_load_dwordx4 v6, s[12:15], s33 offen nt lds
    v_mfma_f32_16x16x32_bf16 v[76:79], a[220:223], a[176:179], 0
    v_cvt_pk_bf16_f32 v17, v58, v59
    v_mfma_f32_16x16x32_bf16 v[76:79], a[216:219], a[172:175], v[76:79]
    s_add_u32 m0, s38, 1024
    ds_read_b128 a[220:223], v0 offset:7168
    v_mfma_f32_16x16x32_bf16 v[76:79], a[212:215], a[168:171], v[76:79]
    s_waitcnt lgkmcnt(2)
    ds_read_b128 a[212:215], v0 offset:6144
    v_cvt_pk_bf16_f32 v16, v56, v57
    v_mfma_f32_16x16x32_bf16 v[76:79], a[224:227], a[180:183], v[76:79]
    buffer_load_dwordx4 v7, s[12:15], s33 offen nt lds
    v_mfma_f32_16x16x32_bf16 v[76:79], a[228:231], a[184:187], v[76:79]
    s_waitcnt lgkmcnt(2)
    v_exp_f32 v82, v82
    v_mfma_f32_16x16x32_bf16 v[76:79], a[232:235], a[188:191], v[76:79]
    s_add_u32 s59, s33, 6144
    v_exp_f32 v75, v75
    v_mfma_f32_16x16x32_bf16 v[68:71], a[232:235], a[164:167], v[68:71]
    s_add_u32 m0, s38, 6144
    v_exp_f32 v80, v80
    v_mfma_f32_16x16x32_bf16 v[68:71], a[228:231], a[160:163], v[68:71]
    buffer_load_dwordx4 v6, s[12:15], s59 offen nt lds
    v_mfma_f32_16x16x32_bf16 v[68:71], a[224:227], a[156:159], v[68:71]
    s_add_u32 m0, s38, 7168
    ds_read_b128 a[216:219], v1 offset:6144
    v_cvt_pk_bf16_f32 v35, v82, v83
    v_mfma_f32_16x16x32_bf16 v[60:63], a[224:227], a[132:135], v[60:63]
    buffer_load_dwordx4 v7, s[12:15], s59 offen nt lds
    v_mfma_f32_16x16x32_bf16 v[60:63], a[228:231], a[136:139], v[60:63]
    v_cvt_pk_bf16_f32 v22, v64, v65
    s_add_u32 s58, s33, 128
    v_mfma_f32_16x16x32_bf16 v[60:63], a[232:235], a[140:143], v[60:63]
    s_add_u32 m0, s38, 2048
    v_exp_f32 v81, v81
    v_mfma_f32_16x16x32_bf16 v[48:51], a[236:239], v[16:19], v[44:47]
    buffer_load_dwordx4 v6, s[12:15], s58 offen nt lds
    v_mfma_f32_16x16x32_bf16 v[52:55], a[232:235], a[116:119], v[52:55]
    ds_read_b128 a[232:235], v1 offset:8192
    v_cvt_pk_bf16_f32 v23, v66, v67
    v_mfma_f32_16x16x32_bf16 v[52:55], a[228:231], a[112:115], v[52:55]
    ds_read_b128 a[228:231], v0 offset:8192
    s_add_u32 m0, s38, 3072
    v_mfma_f32_16x16x32_bf16 v[52:55], a[224:227], a[108:111], v[52:55]
    s_waitcnt lgkmcnt(3)
    ds_read_b128 a[224:227], v1 offset:7168
    v_cvt_pk_bf16_f32 v29, v74, v75
    v_mfma_f32_16x16x32_bf16 v[56:59], a[212:215], a[96:99], 0
    buffer_load_dwordx4 v7, s[12:15], s58 offen nt lds
    v_mfma_f32_16x16x32_bf16 v[48:51], a[240:243], v[22:25], v[48:51]
    s_add_u32 s59, s33, 6272
    v_cvt_pk_bf16_f32 v34, v80, v81
    s_add_u32 m0, s38, 8192
    v_mfma_f32_16x16x32_bf16 v[48:51], a[244:247], v[28:31], v[48:51]
    buffer_load_dwordx4 v6, s[12:15], s59 offen nt lds
    s_add_u32 m0, s38, 9216
    v_mfma_f32_16x16x32_bf16 v[48:51], a[248:251], v[34:37], v[48:51]
    buffer_load_dwordx4 v7, s[12:15], s59 offen nt lds
    s_waitcnt lgkmcnt(3)
    v_mfma_f32_16x16x32_bf16 v[56:59], a[216:219], a[100:103], v[56:59]
    s_add_u32 s58, s33, 256
    s_add_u32 m0, s38, 4096
    v_mfma_f32_16x16x32_bf16 v[56:59], a[220:223], a[104:107], v[56:59]
    buffer_load_dwordx4 v6, s[12:15], s58 offen nt lds
    v_mfma_f32_16x16x32_bf16 v[64:67], a[220:223], a[128:131], 0
    v_cmp_lt_f32 vcc, s29, v48
    s_add_u32 m0, s38, 5120
    v_mfma_f32_16x16x32_bf16 v[64:67], a[216:219], a[124:127], v[64:67]
    buffer_load_dwordx4 v7, s[12:15], s58 offen nt lds
    v_mfma_f32_16x16x32_bf16 v[64:67], a[212:215], a[120:123], v[64:67]
    s_waitcnt vmcnt(19) lgkmcnt(0)
    s_barrier
    v_mfma_f32_16x16x32_bf16 v[72:75], a[212:215], a[144:147], 0
    s_cbranch_vccnz L_rs_start4b
L_ret_start4b:
    s_add_u32 m0, s22, 0
    v_mfma_f32_16x16x32_bf16 v[72:75], a[216:219], a[148:151], v[72:75]
    buffer_load_dwordx4 v6, s[4:7], s20 offen lds
    v_mfma_f32_16x16x32_bf16 v[72:75], a[220:223], a[152:155], v[72:75]
    s_add_u32 s20, s20, 128
    v_fma_f32 v61, v61, s28, v10
    v_fma_f32 v53, v53, s28, v9
    v_mfma_f32_16x16x32_bf16 v[80:83], a[220:223], a[176:179], 0
    s_add_u32 m0, s22, 1024
    v_exp_f32 v53, v53
    v_mfma_f32_16x16x32_bf16 v[80:83], a[216:219], a[172:175], v[80:83]
    buffer_load_dwordx4 v6, s[4:7], s20 offen lds
    v_mfma_f32_16x16x32_bf16 v[80:83], a[212:215], a[168:171], v[80:83]
    ds_read_b64_tr_b16 a[212:213], v2 offset:18432
    v_fma_f32 v52, v52, s28, v9
    v_mfma_f32_16x16x32_bf16 v[80:83], a[224:227], a[180:183], v[80:83]
    s_add_u32 s20, s20, 128
    ds_read_b64_tr_b16 a[214:215], v2 offset:12288
    v_fma_f32 v55, v55, s28, v9
    v_mfma_f32_16x16x32_bf16 v[80:83], a[228:231], a[184:187], v[80:83]
    s_add_u32 m0, s22, 2048
    v_exp_f32 v55, v55
    v_mfma_f32_16x16x32_bf16 v[80:83], a[232:235], a[188:191], v[80:83]
    v_exp_f32 v52, v52
    v_mfma_f32_16x16x32_bf16 v[72:75], a[232:235], a[164:167], v[72:75]
    buffer_load_dwordx4 v6, s[4:7], s20 offen lds
    v_mfma_f32_16x16x32_bf16 v[72:75], a[228:231], a[160:163], v[72:75]
    ds_read_b64_tr_b16 a[216:217], v3 offset:18432
    v_fma_f32 v54, v54, s28, v9
    v_mfma_f32_16x16x32_bf16 v[72:75], a[224:227], a[156:159], v[72:75]
    v_exp_f32 v54, v54
    v_mfma_f32_16x16x32_bf16 v[64:67], a[224:227], a[132:135], v[64:67]
    ds_read_b64_tr_b16 a[218:219], v3 offset:12288
    v_fma_f32 v60, v60, s28, v10
    v_mfma_f32_16x16x32_bf16 v[64:67], a[228:231], a[136:139], v[64:67]
    ds_read_b64_tr_b16 a[220:221], v4 offset:18432
    v_cvt_pk_bf16_f32 v14, v52, v53
    v_cvt_pk_bf16_f32 v15, v54, v55
    v_mfma_f32_16x16x32_bf16 v[64:67], a[232:235], a[140:143], v[64:67]
    s_add_u32 s20, s20, 12032
    v_exp_f32 v60, v60
    v_mfma_f32_16x16x32_bf16 v[56:59], a[232:235], a[116:119], v[56:59]
    v_exp_f32 v61, v61
    v_mfma_f32_16x16x32_bf16 v[56:59], a[228:231], a[112:115], v[56:59]
    ds_read_b64_tr_b16 a[222:223], v4 offset:12288
    v_cvt_pk_bf16_f32 v20, v60, v61
    v_mfma_f32_16x16x32_bf16 v[56:59], a[224:227], a[108:111], v[56:59]
    ds_read_b64_tr_b16 a[224:225], v5 offset:18432
    ds_read_b64_tr_b16 a[226:227], v5 offset:12288
    s_branch L_loop4
L_loop5:
    .p2align 6
L_loop5w0:
    s_waitcnt lgkmcnt(4)
    v_mfma_f32_16x16x32_bf16 v[112:115], a[212:215], v[16:19], v[112:115]
    v_fma_f32 v68, v68, s28, v11
    v_mfma_f32_16x16x32_bf16 v[116:119], a[216:219], v[16:19], v[116:119]
    v_fma_f32 v80, v80, s28, v12
    v_fma_f32 v69, v69, s28, v11
    v_mfma_f32_16x16x32_bf16 v[164:167], a[216:219], v[22:25], v[164:167]
    ds_read_b64_tr_b16 a[230:231], v2 offset:13312
    v_mfma_f32_16x16x32_bf16 v[160:163], a[212:215], v[22:25], v[160:163]
    v_fma_f32 v71, v71, s28, v11
    v_fma_f32 v88, v88, s28, v13
    v_mfma_f32_16x16x32_bf16 v[208:211], a[212:215], v[28:31], v[208:211]
    v_exp_f32 v71, v71
    v_mfma_f32_16x16x32_bf16 v[212:215], a[216:219], v[28:31], v[212:215]
    v_fma_f32 v56, v56, s28, v9
    v_mfma_f32_16x16x32_bf16 a[4:7], a[216:219], v[34:37], a[4:7]
    ds_read_b64_tr_b16 a[232:233], v3 offset:19456
    v_fma_f32 v76, v76, s28, v12
    v_mfma_f32_16x16x32_bf16 a[0:3], a[212:215], v[34:37], a[0:3]
    v_fma_f32 v67, v67, s28, v10
    v_fma_f32 v72, v72, s28, v11
    v_mfma_f32_16x16x32_bf16 a[48:51], a[212:215], v[40:43], a[48:51]
    ds_read_b64_tr_b16 a[234:235], v3 offset:13312
    v_fma_f32 v89, v89, s28, v13
    v_mfma_f32_16x16x32_bf16 a[52:55], a[216:219], v[40:43], a[52:55]
    s_waitcnt lgkmcnt(3)
    ds_read_b64_tr_b16 a[228:229], v2 offset:19456
    v_fma_f32 v78, v78, s28, v12
    v_mfma_f32_16x16x32_bf16 a[56:59], a[220:223], v[40:43], a[56:59]
    v_fma_f32 v84, v84, s28, v13
    v_fma_f32 v90, v90, s28, v13
    v_mfma_f32_16x16x32_bf16 a[60:63], a[224:227], v[40:43], a[60:63]
    v_exp_f32 v80, v80
    v_mfma_f32_16x16x32_bf16 a[12:15], a[224:227], v[34:37], a[12:15]
    v_fma_f32 v70, v70, s28, v11
    v_fma_f32 v86, v86, s28, v13
    v_mfma_f32_16x16x32_bf16 a[8:11], a[220:223], v[34:37], a[8:11]
    ds_read_b64_tr_b16 a[212:213], v4 offset:19456
    v_mfma_f32_16x16x32_bf16 v[216:219], a[220:223], v[28:31], v[216:219]
    v_fma_f32 v82, v82, s28, v12
    v_mfma_f32_16x16x32_bf16 v[220:223], a[224:227], v[28:31], v[220:223]
    ds_read_b64_tr_b16 a[214:215], v4 offset:13312
    v_mfma_f32_16x16x32_bf16 v[172:175], a[224:227], v[22:25], v[172:175]
    v_fma_f32 v87, v87, s28, v13
    v_fma_f32 v77, v77, s28, v12
    v_mfma_f32_16x16x32_bf16 v[168:171], a[220:223], v[22:25], v[168:171]
    s_add_u32 s39, s39, 12288
    ds_read_b64_tr_b16 a[218:219], v5 offset:13312
    v_fma_f32 v79, v79, s28, v12
    v_mfma_f32_16x16x32_bf16 v[120:123], a[220:223], v[16:19], v[120:123]
    ds_read_b64_tr_b16 a[216:217], v5 offset:19456
    v_fma_f32 v73, v73, s28, v11
    v_mfma_f32_16x16x32_bf16 v[124:127], a[224:227], v[16:19], v[124:127]
    s_waitcnt lgkmcnt(4)
    ds_read_b64_tr_b16 a[222:223], v2 offset:14336
    v_fma_f32 v57, v57, s28, v9
    v_mfma_f32_16x16x32_bf16 v[128:131], a[228:231], v[16:19], v[128:131]
    v_exp_f32 v56, v56
    v_mfma_f32_16x16x32_bf16 v[132:135], a[232:235], v[16:19], v[132:135]
    v_exp_f32 v88, v88
    v_mfma_f32_16x16x32_bf16 v[180:183], a[232:235], v[22:25], v[180:183]
    v_exp_f32 v78, v78
    v_mfma_f32_16x16x32_bf16 v[176:179], a[228:231], v[22:25], v[176:179]
    ds_read_b128 v[96:99], v8 offset:0
    v_fma_f32 v66, v66, s28, v10
    v_mfma_f32_16x16x32_bf16 v[224:227], a[228:231], v[28:31], v[224:227]
    ds_read_b64_tr_b16 a[224:225], v3 offset:20480
    v_mfma_f32_16x16x32_bf16 v[228:231], a[232:235], v[28:31], v[228:231]
    ds_read_b64_tr_b16 a[220:221], v2 offset:20480
    v_mfma_f32_16x16x32_bf16 a[20:23], a[232:235], v[34:37], a[20:23]
    ds_read_b64_tr_b16 a[226:227], v3 offset:14336
    v_mfma_f32_16x16x32_bf16 a[16:19], a[228:231], v[34:37], a[16:19]
    v_exp_f32 v76, v76
    v_mfma_f32_16x16x32_bf16 a[64:67], a[228:231], v[40:43], a[64:67]
    ds_read_b64_tr_b16 a[228:229], v4 offset:20480
    v_mfma_f32_16x16x32_bf16 a[68:71], a[232:235], v[40:43], a[68:71]
    s_waitcnt lgkmcnt(5)
    v_exp_f32 v69, v69
    v_mfma_f32_16x16x32_bf16 a[72:75], a[212:215], v[40:43], a[72:75]
    v_exp_f32 v79, v79
    v_mfma_f32_16x16x32_bf16 a[76:79], a[216:219], v[40:43], a[76:79]
    v_exp_f32 v68, v68
    v_mfma_f32_16x16x32_bf16 a[28:31], a[216:219], v[34:37], a[28:31]
    ds_read_b64_tr_b16 a[232:233], v5 offset:20480
    v_mfma_f32_16x16x32_bf16 a[24:27], a[212:215], v[34:37], a[24:27]
    ds_read_b64_tr_b16 a[234:235], v5 offset:14336
    v_fma_f32 v85, v85, s28, v13
    v_mfma_f32_16x16x32_bf16 v[232:235], a[212:215], v[28:31], v[232:235]
    v_mfma_f32_16x16x32_bf16 v[236:239], a[216:219], v[28:31], v[236:239]
    ds_read_b64_tr_b16 a[230:231], v4 offset:14336
    v_fma_f32 v58, v58, s28, v9
    v_mfma_f32_16x16x32_bf16 v[188:191], a[216:219], v[22:25], v[188:191]
    v_exp_f32 v85, v85
    v_mfma_f32_16x16x32_bf16 v[184:187], a[212:215], v[22:25], v[184:187]
    v_mfma_f32_16x16x32_bf16 v[136:139], a[212:215], v[16:19], v[136:139]
    v_exp_f32 v73, v73
    v_mfma_f32_16x16x32_bf16 v[140:143], a[216:219], v[16:19], v[140:143]
    s_waitcnt lgkmcnt(3)
    v_fma_f32 v59, v59, s28, v9
    v_mfma_f32_16x16x32_bf16 v[144:147], a[220:223], v[16:19], v[144:147]
    v_exp_f32 v77, v77
    v_mfma_f32_16x16x32_bf16 v[148:151], a[224:227], v[16:19], v[148:151]
    v_exp_f32 v70, v70
    v_mfma_f32_16x16x32_bf16 v[196:199], a[224:227], v[22:25], v[196:199]
    v_fma_f32 v91, v91, s28, v13
    v_mfma_f32_16x16x32_bf16 v[192:195], a[220:223], v[22:25], v[192:195]
    v_fma_f32 v83, v83, s28, v12
    v_fma_f32 v74, v74, s28, v11
    v_mfma_f32_16x16x32_bf16 v[240:243], a[220:223], v[28:31], v[240:243]
    v_cvt_pk_bf16_f32 v32, v76, v77
    v_cvt_pk_bf16_f32 v27, v70, v71
    v_mfma_f32_16x16x32_bf16 v[244:247], a[224:227], v[28:31], v[244:247]
    s_waitcnt vmcnt(10) lgkmcnt(0)
    v_exp_f32 v91, v91
    v_mfma_f32_16x16x32_bf16 a[36:39], a[224:227], v[34:37], a[36:39]
    v_exp_f32 v87, v87
    v_mfma_f32_16x16x32_bf16 a[32:35], a[220:223], v[34:37], a[32:35]
    s_barrier
    v_mfma_f32_16x16x32_bf16 a[80:83], a[220:223], v[40:43], a[80:83]
    s_add_u32 m0, s22, 36864
    ds_read_b128 a[212:215], v0 offset:12288
    v_cvt_pk_bf16_f32 v26, v68, v69
    v_mfma_f32_16x16x32_bf16 a[84:87], a[224:227], v[40:43], a[84:87]
    ds_read_b128 a[216:219], v1 offset:12288
    v_fma_f32 v75, v75, s28, v11
    v_mfma_f32_16x16x32_bf16 a[88:91], a[228:231], v[40:43], a[88:91]
    ds_read_b128 a[220:223], v0 offset:13312
    v_mfma_f32_16x16x32_bf16 a[92:95], a[232:235], v[40:43], a[92:95]
    buffer_load_dwordx4 v6, s[8:11], s21 offen lds
    v_mfma_f32_16x16x32_bf16 a[44:47], a[232:235], v[34:37], a[44:47]
    s_add_u32 s21, s21, 128
    v_fma_f32 v65, v65, s28, v10
    v_cvt_pk_bf16_f32 v33, v78, v79
    v_mfma_f32_16x16x32_bf16 a[40:43], a[228:231], v[34:37], a[40:43]
    s_add_u32 m0, s22, 37888
    v_exp_f32 v67, v67
    v_mfma_f32_16x16x32_bf16 v[248:251], a[228:231], v[28:31], v[248:251]
    v_exp_f32 v74, v74
    v_mfma_f32_16x16x32_bf16 v[252:255], a[232:235], v[28:31], v[252:255]
    buffer_load_dwordx4 v6, s[8:11], s21 offen lds
    v_mfma_f32_16x16x32_bf16 v[204:207], a[232:235], v[22:25], v[204:207]
    v_exp_f32 v86, v86
    v_mfma_f32_16x16x32_bf16 v[200:203], a[228:231], v[22:25], v[200:203]
    s_add_u32 s21, s21, 128
    s_add_u32 m0, s22, 38912
    v_fma_f32 v64, v64, s28, v10
    v_mfma_f32_16x16x32_bf16 v[152:155], a[228:231], v[16:19], v[152:155]
    buffer_load_dwordx4 v6, s[8:11], s21 offen lds
    v_mfma_f32_16x16x32_bf16 v[156:159], a[232:235], v[16:19], v[156:159]
    s_waitcnt lgkmcnt(1)
    v_exp_f32 v84, v84
    v_mfma_f32_16x16x32_bf16 v[52:55], a[212:215], a[96:99], 0
    v_mfma_f32_16x16x32_bf16 v[52:55], a[216:219], a[100:103], v[52:55]
    s_waitcnt lgkmcnt(0)
    v_exp_f32 v57, v57
    v_mfma_f32_16x16x32_bf16 v[52:55], a[220:223], a[104:107], v[52:55]
    ds_read_b128 a[232:235], v1 offset:14336
    v_cvt_pk_bf16_f32 v38, v84, v85
    v_mfma_f32_16x16x32_bf16 v[60:63], a[220:223], a[128:131], 0
    ds_read_b128 a[224:227], v1 offset:13312
    v_fma_f32 v81, v81, s28, v12
    v_mfma_f32_16x16x32_bf16 v[60:63], a[216:219], a[124:127], v[60:63]
    v_exp_f32 v75, v75
    v_mfma_f32_16x16x32_bf16 v[60:63], a[212:215], a[120:123], v[60:63]
    ds_read_b128 a[228:231], v0 offset:14336
    v_mfma_f32_16x16x32_bf16 v[68:71], a[212:215], a[144:147], 0
    s_add_u32 s21, s21, 12032
    v_exp_f32 v58, v58
    v_mfma_f32_16x16x32_bf16 v[68:71], a[216:219], a[148:151], v[68:71]
    v_exp_f32 v90, v90
    v_mfma_f32_16x16x32_bf16 v[68:71], a[220:223], a[152:155], v[68:71]
    buffer_store_dwordx4 v[96:99], v102, s[16:19], s24 offen offset:0 nt
    v_cvt_pk_bf16_f32 v39, v86, v87
    v_exp_f32 v59, v59
    v_mfma_f32_16x16x32_bf16 v[76:79], a[220:223], a[176:179], 0
    v_mfma_f32_16x16x32_bf16 v[76:79], a[216:219], a[172:175], v[76:79]
    s_add_u32 m0, s23, 0
    v_exp_f32 v72, v72
    v_mfma_f32_16x16x32_bf16 v[76:79], a[212:215], a[168:171], v[76:79]
    v_exp_f32 v64, v64
    v_mfma_f32_16x16x32_bf16 v[84:87], a[212:215], a[192:195], 0
    v_exp_f32 v89, v89
    v_mfma_f32_16x16x32_bf16 v[84:87], a[216:219], a[196:199], v[84:87]
    v_exp_f32 v81, v81
    v_mfma_f32_16x16x32_bf16 v[84:87], a[220:223], a[200:203], v[84:87]
    s_waitcnt lgkmcnt(0)
    ds_read_b128 a[212:215], v0 offset:18432
    v_mfma_f32_16x16x32_bf16 v[84:87], a[224:227], a[204:207], v[84:87]
    v_exp_f32 v65, v65
    v_mfma_f32_16x16x32_bf16 v[84:87], a[228:231], a[208:211], v[84:87]
    buffer_load_dwordx4 v6, s[12:15], s25 offen nt lds
    v_mfma_f32_16x16x32_bf16 v[84:87], a[232:235], v[92:95], v[84:87]
    ds_read_b128 v[96:99], v8 offset:1024
    v_cvt_pk_bf16_f32 v16, v56, v57
    v_mfma_f32_16x16x32_bf16 v[76:79], a[232:235], a[188:191], v[76:79]
    v_exp_f32 v66, v66
    v_mfma_f32_16x16x32_bf16 v[76:79], a[228:231], a[184:187], v[76:79]
    v_cvt_pk_bf16_f32 v41, v90, v91
    v_cvt_pk_bf16_f32 v29, v74, v75
    v_mfma_f32_16x16x32_bf16 v[76:79], a[224:227], a[180:183], v[76:79]
    v_cvt_pk_bf16_f32 v34, v80, v81
    v_cvt_pk_bf16_f32 v17, v58, v59
    v_mfma_f32_16x16x32_bf16 v[68:71], a[224:227], a[156:159], v[68:71]
    ds_read_b128 a[220:223], v0 offset:19456
    v_mfma_f32_16x16x32_bf16 v[68:71], a[228:231], a[160:163], v[68:71]
    v_cvt_pk_bf16_f32 v22, v64, v65
    v_mfma_f32_16x16x32_bf16 v[68:71], a[232:235], a[164:167], v[68:71]
    v_cvt_pk_bf16_f32 v40, v88, v89
    v_mfma_f32_16x16x32_bf16 v[44:47], a[236:239], v[14:17], v[48:51]
    ds_read_b128 a[216:219], v1 offset:18432
    v_cvt_pk_bf16_f32 v28, v72, v73
    v_mfma_f32_16x16x32_bf16 v[60:63], a[232:235], a[140:143], v[60:63]
    v_exp_f32 v83, v83
    v_mfma_f32_16x16x32_bf16 v[60:63], a[228:231], a[136:139], v[60:63]
    v_exp_f32 v82, v82
    v_mfma_f32_16x16x32_bf16 v[60:63], a[224:227], a[132:135], v[60:63]
    v_cvt_pk_bf16_f32 v23, v66, v67
    v_mfma_f32_16x16x32_bf16 v[52:55], a[224:227], a[108:111], v[52:55]
    v_mfma_f32_16x16x32_bf16 v[52:55], a[228:231], a[112:115], v[52:55]
    v_cvt_pk_bf16_f32 v35, v82, v83
    v_mfma_f32_16x16x32_bf16 v[52:55], a[232:235], a[116:119], v[52:55]
    s_add_u32 m0, s23, 1024
    ds_read_b128 a[232:235], v1 offset:20480
    v_mfma_f32_16x16x32_bf16 v[44:47], a[240:243], v[20:23], v[44:47]
    ds_read_b128 a[228:231], v0 offset:20480
    v_mfma_f32_16x16x32_bf16 v[44:47], a[244:247], v[26:29], v[44:47]
    s_waitcnt lgkmcnt(3)
    ds_read_b128 a[224:227], v1 offset:19456
    v_mfma_f32_16x16x32_bf16 v[56:59], a[212:215], a[96:99], 0
    v_mfma_f32_16x16x32_bf16 v[44:47], a[248:251], v[32:35], v[44:47]
    buffer_load_dwordx4 v7, s[12:15], s25 offen nt lds
    v_mfma_f32_16x16x32_bf16 v[44:47], a[252:255], v[38:41], v[44:47]
    s_bitcmp1_b32 s27, 0
    s_cselect_b32 s26, s49, 128
    s_waitcnt lgkmcnt(3)
    v_mfma_f32_16x16x32_bf16 v[56:59], a[216:219], a[100:103], v[56:59]
    v_mfma_f32_16x16x32_bf16 v[56:59], a[220:223], a[104:107], v[56:59]
    s_lshr_b32 s27, s27, 1
    v_mfma_f32_16x16x32_bf16 v[64:67], a[220:223], a[128:131], 0
    s_nop 0
    v_cmp_lt_f32 vcc, s29, v44
    v_mfma_f32_16x16x32_bf16 v[64:67], a[216:219], a[124:127], v[64:67]
    buffer_store_dwordx4 v[96:99], v103, s[16:19], s24 offen offset:0 nt
    s_add_u32 s24, s24, s26
    s_add_u32 s25, s25, s26
    s_nop 0
    s_cbranch_vccnz L_rs_loop5w0a
L_ret_loop5w0a:
    v_mfma_f32_16x16x32_bf16 v[64:67], a[212:215], a[120:123], v[64:67]
    v_fma_f32 v61, v61, s28, v10
    s_waitcnt vmcnt(14) lgkmcnt(0)
    v_mfma_f32_16x16x32_bf16 v[72:75], a[212:215], a[144:147], 0
    s_barrier
    v_mfma_f32_16x16x32_bf16 v[72:75], a[216:219], a[148:151], v[72:75]
    s_add_u32 m0, s22, 12288
    v_fma_f32 v52, v52, s28, v9
    v_fma_f32 v63, v63, s28, v10
    v_mfma_f32_16x16x32_bf16 v[72:75], a[220:223], a[152:155], v[72:75]
    buffer_load_dwordx4 v6, s[4:7], s20 offen lds
    v_mfma_f32_16x16x32_bf16 v[80:83], a[220:223], a[176:179], 0
    s_add_u32 s20, s20, 128
    v_fma_f32 v62, v62, s28, v10
    v_fma_f32 v60, v60, s28, v10
    v_mfma_f32_16x16x32_bf16 v[80:83], a[216:219], a[172:175], v[80:83]
    s_add_u32 m0, s22, 13312
    v_exp_f32 v60, v60
    v_mfma_f32_16x16x32_bf16 v[80:83], a[212:215], a[168:171], v[80:83]
    buffer_load_dwordx4 v6, s[4:7], s20 offen lds
    v_mfma_f32_16x16x32_bf16 v[88:91], a[212:215], a[192:195], 0
    s_add_u32 s20, s20, 128
    ds_read_b64_tr_b16 a[212:213], v2 offset:0
    v_fma_f32 v55, v55, s28, v9
    v_mfma_f32_16x16x32_bf16 v[88:91], a[216:219], a[196:199], v[88:91]
    s_add_u32 m0, s22, 14336
    v_exp_f32 v52, v52
    v_mfma_f32_16x16x32_bf16 v[88:91], a[220:223], a[200:203], v[88:91]
    ds_read_b64_tr_b16 a[214:215], v2 offset:6144
    v_mfma_f32_16x16x32_bf16 v[88:91], a[224:227], a[204:207], v[88:91]
    buffer_load_dwordx4 v6, s[4:7], s20 offen lds
    v_mfma_f32_16x16x32_bf16 v[88:91], a[228:231], a[208:211], v[88:91]
    v_exp_f32 v62, v62
    v_mfma_f32_16x16x32_bf16 v[88:91], a[232:235], v[92:95], v[88:91]
    v_exp_f32 v55, v55
    v_mfma_f32_16x16x32_bf16 v[80:83], a[232:235], a[188:191], v[80:83]
    v_exp_f32 v61, v61
    v_mfma_f32_16x16x32_bf16 v[80:83], a[228:231], a[184:187], v[80:83]
    ds_read_b64_tr_b16 a[216:217], v3 offset:0
    v_fma_f32 v53, v53, s28, v9
    v_mfma_f32_16x16x32_bf16 v[80:83], a[224:227], a[180:183], v[80:83]
    s_add_u32 s20, s20, 12032
    ds_read_b64_tr_b16 a[218:219], v3 offset:6144
    v_fma_f32 v54, v54, s28, v9
    v_mfma_f32_16x16x32_bf16 v[72:75], a[224:227], a[156:159], v[72:75]
    v_exp_f32 v54, v54
    v_mfma_f32_16x16x32_bf16 v[72:75], a[228:231], a[160:163], v[72:75]
    ds_read_b64_tr_b16 a[220:221], v4 offset:0
    v_mfma_f32_16x16x32_bf16 v[72:75], a[232:235], a[164:167], v[72:75]
    v_exp_f32 v53, v53
    v_mfma_f32_16x16x32_bf16 v[64:67], a[232:235], a[140:143], v[64:67]
    v_exp_f32 v63, v63
    v_mfma_f32_16x16x32_bf16 v[64:67], a[228:231], a[136:139], v[64:67]
    v_cvt_pk_bf16_f32 v24, v60, v61
    v_mfma_f32_16x16x32_bf16 v[64:67], a[224:227], a[132:135], v[64:67]
    v_cvt_pk_bf16_f32 v19, v54, v55
    v_mfma_f32_16x16x32_bf16 v[56:59], a[224:227], a[108:111], v[56:59]
    ds_read_b64_tr_b16 a[222:223], v4 offset:6144
    v_cvt_pk_bf16_f32 v25, v62, v63
    v_mfma_f32_16x16x32_bf16 v[56:59], a[228:231], a[112:115], v[56:59]
    ds_read_b64_tr_b16 a[224:225], v5 offset:0
    v_cvt_pk_bf16_f32 v18, v52, v53
    v_mfma_f32_16x16x32_bf16 v[56:59], a[232:235], a[116:119], v[56:59]
    ds_read_b64_tr_b16 a[226:227], v5 offset:6144
    s_waitcnt lgkmcnt(4)
    v_mfma_f32_16x16x32_bf16 v[112:115], a[212:215], v[14:17], v[112:115]
    v_fma_f32 v80, v80, s28, v12
    v_mfma_f32_16x16x32_bf16 v[116:119], a[216:219], v[14:17], v[116:119]
    v_fma_f32 v71, v71, s28, v11
    v_fma_f32 v79, v79, s28, v12
    v_mfma_f32_16x16x32_bf16 v[164:167], a[216:219], v[20:23], v[164:167]
    ds_read_b64_tr_b16 a[228:229], v2 offset:1024
    v_mfma_f32_16x16x32_bf16 v[160:163], a[212:215], v[20:23], v[160:163]
    s_add_u32 s39, s39, 12288
    ds_read_b64_tr_b16 a[230:231], v2 offset:7168
    v_mfma_f32_16x16x32_bf16 v[208:211], a[212:215], v[26:29], v[208:211]
    ds_read_b64_tr_b16 a[232:233], v3 offset:1024
    v_mfma_f32_16x16x32_bf16 v[212:215], a[216:219], v[26:29], v[212:215]
    v_fma_f32 v76, v76, s28, v12
    v_fma_f32 v81, v81, s28, v12
    v_mfma_f32_16x16x32_bf16 a[4:7], a[216:219], v[32:35], a[4:7]
    ds_read_b64_tr_b16 a[234:235], v3 offset:7168
    v_fma_f32 v56, v56, s28, v9
    v_mfma_f32_16x16x32_bf16 a[0:3], a[212:215], v[32:35], a[0:3]
    v_exp_f32 v79, v79
    v_mfma_f32_16x16x32_bf16 a[48:51], a[212:215], v[38:41], a[48:51]
    v_fma_f32 v70, v70, s28, v11
    v_fma_f32 v86, v86, s28, v13
    v_mfma_f32_16x16x32_bf16 a[52:55], a[216:219], v[38:41], a[52:55]
    s_waitcnt lgkmcnt(4)
    v_exp_f32 v70, v70
    v_mfma_f32_16x16x32_bf16 a[56:59], a[220:223], v[38:41], a[56:59]
    v_fma_f32 v84, v84, s28, v13
    v_fma_f32 v83, v83, s28, v12
    v_mfma_f32_16x16x32_bf16 a[60:63], a[224:227], v[38:41], a[60:63]
    ds_read_b64_tr_b16 a[218:219], v5 offset:7168
    v_fma_f32 v57, v57, s28, v9
    v_mfma_f32_16x16x32_bf16 a[12:15], a[224:227], v[32:35], a[12:15]
    v_exp_f32 v84, v84
    v_mfma_f32_16x16x32_bf16 a[8:11], a[220:223], v[32:35], a[8:11]
    v_fma_f32 v68, v68, s28, v11
    v_fma_f32 v66, v66, s28, v10
    v_mfma_f32_16x16x32_bf16 v[216:219], a[220:223], v[26:29], v[216:219]
    v_exp_f32 v71, v71
    v_mfma_f32_16x16x32_bf16 v[220:223], a[224:227], v[26:29], v[220:223]
    ds_read_b64_tr_b16 a[212:213], v4 offset:1024
    v_fma_f32 v89, v89, s28, v13
    v_mfma_f32_16x16x32_bf16 v[172:175], a[224:227], v[20:23], v[172:175]
    v_fma_f32 v90, v90, s28, v13
    v_mfma_f32_16x16x32_bf16 v[168:171], a[220:223], v[20:23], v[168:171]
    ds_read_b64_tr_b16 a[216:217], v5 offset:1024
    v_fma_f32 v78, v78, s28, v12
    v_mfma_f32_16x16x32_bf16 v[120:123], a[220:223], v[14:17], v[120:123]
    ds_read_b64_tr_b16 a[214:215], v4 offset:7168
    v_fma_f32 v82, v82, s28, v12
    v_mfma_f32_16x16x32_bf16 v[124:127], a[224:227], v[14:17], v[124:127]
    s_waitcnt lgkmcnt(4)
    v_exp_f32 v68, v68
    v_mfma_f32_16x16x32_bf16 v[128:131], a[228:231], v[14:17], v[128:131]
    v_exp_f32 v83, v83
    v_mfma_f32_16x16x32_bf16 v[132:135], a[232:235], v[14:17], v[132:135]
    ds_read_b64_tr_b16 a[222:223], v2 offset:8192
    v_fma_f32 v73, v73, s28, v11
    v_mfma_f32_16x16x32_bf16 v[180:183], a[232:235], v[20:23], v[180:183]
    v_exp_f32 v86, v86
    v_mfma_f32_16x16x32_bf16 v[176:179], a[228:231], v[20:23], v[176:179]
    ds_read_b64_tr_b16 a[224:225], v3 offset:2048
    v_mfma_f32_16x16x32_bf16 v[224:227], a[228:231], v[26:29], v[224:227]
    ds_read_b64_tr_b16 a[220:221], v2 offset:2048
    v_fma_f32 v85, v85, s28, v13
    v_mfma_f32_16x16x32_bf16 v[228:231], a[232:235], v[26:29], v[228:231]
    v_exp_f32 v81, v81
    v_mfma_f32_16x16x32_bf16 a[20:23], a[232:235], v[32:35], a[20:23]
    ds_read_b64_tr_b16 a[226:227], v3 offset:8192
    v_fma_f32 v67, v67, s28, v10
    v_mfma_f32_16x16x32_bf16 a[16:19], a[228:231], v[32:35], a[16:19]
    v_fma_f32 v59, v59, s28, v9
    v_mfma_f32_16x16x32_bf16 a[64:67], a[228:231], v[38:41], a[64:67]
    v_fma_f32 v64, v64, s28, v10
    v_fma_f32 v74, v74, s28, v11
    v_mfma_f32_16x16x32_bf16 a[68:71], a[232:235], v[38:41], a[68:71]
    s_waitcnt lgkmcnt(4)
    ds_read_b64_tr_b16 a[232:233], v5 offset:2048
    v_mfma_f32_16x16x32_bf16 a[72:75], a[212:215], v[38:41], a[72:75]
    ds_read_b64_tr_b16 a[228:229], v4 offset:2048
    v_mfma_f32_16x16x32_bf16 a[76:79], a[216:219], v[38:41], a[76:79]
    ds_read_b64_tr_b16 a[230:231], v4 offset:8192
    v_fma_f32 v69, v69, s28, v11
    v_mfma_f32_16x16x32_bf16 a[28:31], a[216:219], v[32:35], a[28:31]
    ds_read_b64_tr_b16 a[234:235], v5 offset:8192
    v_mfma_f32_16x16x32_bf16 a[24:27], a[212:215], v[32:35], a[24:27]
    v_exp_f32 v76, v76
    v_mfma_f32_16x16x32_bf16 v[232:235], a[212:215], v[26:29], v[232:235]
    v_exp_f32 v90, v90
    v_mfma_f32_16x16x32_bf16 v[236:239], a[216:219], v[26:29], v[236:239]
    v_exp_f32 v82, v82
    v_mfma_f32_16x16x32_bf16 v[188:191], a[216:219], v[20:23], v[188:191]
    v_fma_f32 v91, v91, s28, v13
    v_mfma_f32_16x16x32_bf16 v[184:187], a[212:215], v[20:23], v[184:187]
    v_fma_f32 v77, v77, s28, v12
    v_fma_f32 v87, v87, s28, v13
    v_mfma_f32_16x16x32_bf16 v[136:139], a[212:215], v[14:17], v[136:139]
    v_exp_f32 v67, v67
    v_mfma_f32_16x16x32_bf16 v[140:143], a[216:219], v[14:17], v[140:143]
    s_waitcnt lgkmcnt(3)
    v_exp_f32 v78, v78
    v_mfma_f32_16x16x32_bf16 v[144:147], a[220:223], v[14:17], v[144:147]
    v_exp_f32 v77, v77
    v_mfma_f32_16x16x32_bf16 v[148:151], a[224:227], v[14:17], v[148:151]
    v_exp_f32 v80, v80
    v_mfma_f32_16x16x32_bf16 v[196:199], a[224:227], v[20:23], v[196:199]
    v_exp_f32 v87, v87
    v_mfma_f32_16x16x32_bf16 v[192:195], a[220:223], v[20:23], v[192:195]
    s_waitcnt vmcnt(10) lgkmcnt(0)
    v_fma_f32 v65, v65, s28, v10
    v_fma_f32 v58, v58, s28, v9
    v_mfma_f32_16x16x32_bf16 v[240:243], a[220:223], v[26:29], v[240:243]
    v_exp_f32 v64, v64
    v_mfma_f32_16x16x32_bf16 v[244:247], a[224:227], v[26:29], v[244:247]
    s_add_u32 m0, s22, 24576
    ds_read_b128 v[96:99], v8 offset:2048
    v_mfma_f32_16x16x32_bf16 a[36:39], a[224:227], v[32:35], a[36:39]
    v_cvt_pk_bf16_f32 v37, v78, v79
    v_fma_f32 v75, v75, s28, v11
    v_mfma_f32_16x16x32_bf16 a[32:35], a[220:223], v[32:35], a[32:35]
    s_barrier
    v_mfma_f32_16x16x32_bf16 a[80:83], a[220:223], v[38:41], a[80:83]
    buffer_load_dwordx4 v6, s[8:11], s21 offen lds
    v_mfma_f32_16x16x32_bf16 a[84:87], a[224:227], v[38:41], a[84:87]
    s_add_u32 s21, s21, 128
    ds_read_b128 a[212:215], v0 offset:0
    v_mfma_f32_16x16x32_bf16 a[88:91], a[228:231], v[38:41], a[88:91]
    ds_read_b128 a[216:219], v1 offset:0
    v_mfma_f32_16x16x32_bf16 a[92:95], a[232:235], v[38:41], a[92:95]
    ds_read_b128 a[220:223], v0 offset:1024
    v_mfma_f32_16x16x32_bf16 a[44:47], a[232:235], v[32:35], a[44:47]
    s_add_u32 m0, s22, 25600
    ds_read_b128 a[224:227], v1 offset:1024
    v_mfma_f32_16x16x32_bf16 a[40:43], a[228:231], v[32:35], a[40:43]
    buffer_load_dwordx4 v6, s[8:11], s21 offen lds
    v_mfma_f32_16x16x32_bf16 v[248:251], a[228:231], v[26:29], v[248:251]
    v_exp_f32 v73, v73
    v_mfma_f32_16x16x32_bf16 v[252:255], a[232:235], v[26:29], v[252:255]
    s_add_u32 s21, s21, 128
    v_exp_f32 v69, v69
    v_mfma_f32_16x16x32_bf16 v[204:207], a[232:235], v[20:23], v[204:207]
    v_cvt_pk_bf16_f32 v34, v80, v81
    v_cvt_pk_bf16_f32 v31, v70, v71
    v_mfma_f32_16x16x32_bf16 v[200:203], a[228:231], v[20:23], v[200:203]
    s_add_u32 m0, s22, 26624
    v_exp_f32 v58, v58
    v_mfma_f32_16x16x32_bf16 v[152:155], a[228:231], v[14:17], v[152:155]
    buffer_load_dwordx4 v6, s[8:11], s21 offen lds
    v_mfma_f32_16x16x32_bf16 v[156:159], a[232:235], v[14:17], v[156:159]
    s_waitcnt lgkmcnt(3)
    ds_read_b128 a[228:231], v0 offset:2048
    v_fma_f32 v88, v88, s28, v13
    v_mfma_f32_16x16x32_bf16 v[52:55], a[212:215], a[96:99], 0
    s_waitcnt lgkmcnt(3)
    ds_read_b128 a[232:235], v1 offset:2048
    v_mfma_f32_16x16x32_bf16 v[52:55], a[216:219], a[100:103], v[52:55]
    s_waitcnt lgkmcnt(3)
    v_mfma_f32_16x16x32_bf16 v[52:55], a[220:223], a[104:107], v[52:55]
    s_add_u32 s21, s21, 12032
    v_cvt_pk_bf16_f32 v30, v68, v69
    v_cvt_pk_bf16_f32 v36, v76, v77
    v_mfma_f32_16x16x32_bf16 v[60:63], a[220:223], a[128:131], 0
    v_exp_f32 v56, v56
    v_mfma_f32_16x16x32_bf16 v[60:63], a[216:219], a[124:127], v[60:63]
    v_exp_f32 v91, v91
    v_mfma_f32_16x16x32_bf16 v[60:63], a[212:215], a[120:123], v[60:63]
    v_fma_f32 v72, v72, s28, v11
    v_mfma_f32_16x16x32_bf16 v[68:71], a[212:215], a[144:147], 0
    v_exp_f32 v85, v85
    v_mfma_f32_16x16x32_bf16 v[68:71], a[216:219], a[148:151], v[68:71]
    v_exp_f32 v59, v59
    v_mfma_f32_16x16x32_bf16 v[68:71], a[220:223], a[152:155], v[68:71]
    buffer_store_dwordx4 v[96:99], v102, s[16:19], s24 offen offset:0 nt
    s_add_u32 m0, s23, 2048
    v_exp_f32 v57, v57
    v_cvt_pk_bf16_f32 v42, v84, v85
    v_mfma_f32_16x16x32_bf16 v[76:79], a[220:223], a[176:179], 0
    v_cvt_pk_bf16_f32 v17, v58, v59
    v_cvt_pk_bf16_f32 v43, v86, v87
    v_mfma_f32_16x16x32_bf16 v[76:79], a[216:219], a[172:175], v[76:79]
    v_exp_f32 v74, v74
    v_mfma_f32_16x16x32_bf16 v[76:79], a[212:215], a[168:171], v[76:79]
    v_exp_f32 v66, v66
    v_mfma_f32_16x16x32_bf16 v[84:87], a[212:215], a[192:195], 0
    v_mfma_f32_16x16x32_bf16 v[84:87], a[216:219], a[196:199], v[84:87]
    v_exp_f32 v65, v65
    v_mfma_f32_16x16x32_bf16 v[84:87], a[220:223], a[200:203], v[84:87]
    s_waitcnt lgkmcnt(0)
    v_exp_f32 v72, v72
    v_mfma_f32_16x16x32_bf16 v[84:87], a[224:227], a[204:207], v[84:87]
    ds_read_b128 a[220:223], v0 offset:7168
    v_cvt_pk_bf16_f32 v41, v90, v91
    v_mfma_f32_16x16x32_bf16 v[84:87], a[228:231], a[208:211], v[84:87]
    v_exp_f32 v75, v75
    v_mfma_f32_16x16x32_bf16 v[84:87], a[232:235], v[92:95], v[84:87]
    v_mfma_f32_16x16x32_bf16 v[76:79], a[232:235], a[188:191], v[76:79]
    buffer_load_dwordx4 v6, s[12:15], s25 offen nt lds
    v_mfma_f32_16x16x32_bf16 v[76:79], a[228:231], a[184:187], v[76:79]
    v_exp_f32 v89, v89
    v_mfma_f32_16x16x32_bf16 v[76:79], a[224:227], a[180:183], v[76:79]
    v_cvt_pk_bf16_f32 v23, v66, v67
    v_mfma_f32_16x16x32_bf16 v[68:71], a[224:227], a[156:159], v[68:71]
    v_exp_f32 v88, v88
    v_mfma_f32_16x16x32_bf16 v[68:71], a[228:231], a[160:163], v[68:71]
    ds_read_b128 v[96:99], v8 offset:3072
    v_mfma_f32_16x16x32_bf16 v[68:71], a[232:235], a[164:167], v[68:71]
    v_cvt_pk_bf16_f32 v40, v88, v89
    v_cvt_pk_bf16_f32 v16, v56, v57
    v_mfma_f32_16x16x32_bf16 v[60:63], a[232:235], a[140:143], v[60:63]
    ds_read_b128 a[216:219], v1 offset:6144
    v_mfma_f32_16x16x32_bf16 v[60:63], a[228:231], a[136:139], v[60:63]
    ds_read_b128 a[212:215], v0 offset:6144
    v_cvt_pk_bf16_f32 v35, v82, v83
    v_mfma_f32_16x16x32_bf16 v[60:63], a[224:227], a[132:135], v[60:63]
    v_mfma_f32_16x16x32_bf16 v[48:51], a[236:239], v[16:19], v[44:47]
    v_cvt_pk_bf16_f32 v22, v64, v65
    v_cvt_pk_bf16_f32 v29, v74, v75
    v_mfma_f32_16x16x32_bf16 v[52:55], a[224:227], a[108:111], v[52:55]
    v_cvt_pk_bf16_f32 v28, v72, v73
    v_mfma_f32_16x16x32_bf16 v[52:55], a[228:231], a[112:115], v[52:55]
    s_add_u32 m0, s23, 3072
    ds_read_b128 a[224:227], v1 offset:7168
    v_mfma_f32_16x16x32_bf16 v[48:51], a[240:243], v[22:25], v[48:51]
    ds_read_b128 a[228:231], v0 offset:8192
    v_mfma_f32_16x16x32_bf16 v[52:55], a[232:235], a[116:119], v[52:55]
    ds_read_b128 a[232:235], v1 offset:8192
    v_mfma_f32_16x16x32_bf16 v[48:51], a[244:247], v[28:31], v[48:51]
    s_waitcnt lgkmcnt(5)
    buffer_load_dwordx4 v7, s[12:15], s25 offen nt lds
    v_mfma_f32_16x16x32_bf16 v[48:51], a[248:251], v[34:37], v[48:51]
    s_bitcmp1_b32 s27, 0
    v_add_u32 v8, 4096, v8
    v_mfma_f32_16x16x32_bf16 v[48:51], a[252:255], v[40:43], v[48:51]
    s_cselect_b32 s26, s49, 128
    s_lshr_b32 s27, s27, 1
    s_waitcnt lgkmcnt(3)
    v_mfma_f32_16x16x32_bf16 v[56:59], a[212:215], a[96:99], 0
    buffer_store_dwordx4 v[96:99], v103, s[16:19], s24 offen offset:0 nt
    s_nop 2
    v_cmp_lt_f32 vcc, s29, v48
    s_add_u32 s24, s24, s26
    v_mfma_f32_16x16x32_bf16 v[56:59], a[216:219], a[100:103], v[56:59]
    s_add_u32 s25, s25, s26
    s_add_u32 s23, s23, 4096
    v_mfma_f32_16x16x32_bf16 v[56:59], a[220:223], a[104:107], v[56:59]
    s_cbranch_vccnz L_rs_loop5w0b
L_ret_loop5w0b:
    v_fma_f32 v54, v54, s28, v9
    v_mfma_f32_16x16x32_bf16 v[64:67], a[220:223], a[128:131], 0
    v_fma_f32 v53, v53, s28, v9
    v_mfma_f32_16x16x32_bf16 v[64:67], a[216:219], a[124:127], v[64:67]
    v_fma_f32 v55, v55, s28, v9
    v_mfma_f32_16x16x32_bf16 v[64:67], a[212:215], a[120:123], v[64:67]
    s_waitcnt vmcnt(14) lgkmcnt(0)
    s_cmp_eq_u32 s30, 5
    s_cselect_b32 s26, s62, 0
    v_mfma_f32_16x16x32_bf16 v[72:75], a[212:215], a[144:147], 0
    s_barrier
    v_mfma_f32_16x16x32_bf16 v[72:75], a[216:219], a[148:151], v[72:75]
    s_add_u32 s20, s20, s26
    s_add_u32 m0, s22, 0
    v_fma_f32 v62, v62, s28, v10
    v_mfma_f32_16x16x32_bf16 v[72:75], a[220:223], a[152:155], v[72:75]
    buffer_load_dwordx4 v6, s[4:7], s20 offen lds
    v_mfma_f32_16x16x32_bf16 v[80:83], a[220:223], a[176:179], 0
    s_add_u32 s20, s20, 128
    v_exp_f32 v62, v62
    v_mfma_f32_16x16x32_bf16 v[80:83], a[216:219], a[172:175], v[80:83]
    s_add_u32 m0, s22, 1024
    v_exp_f32 v54, v54
    v_mfma_f32_16x16x32_bf16 v[80:83], a[212:215], a[168:171], v[80:83]
    buffer_load_dwordx4 v6, s[4:7], s20 offen lds
    v_mfma_f32_16x16x32_bf16 v[88:91], a[212:215], a[192:195], 0
    ds_read_b64_tr_b16 a[212:213], v2 offset:18432
    v_fma_f32 v52, v52, s28, v9
    v_mfma_f32_16x16x32_bf16 v[88:91], a[216:219], a[196:199], v[88:91]
    s_add_u32 s20, s20, 128
    ds_read_b64_tr_b16 a[214:215], v2 offset:12288
    s_add_u32 m0, s22, 2048
    v_mfma_f32_16x16x32_bf16 v[88:91], a[220:223], a[200:203], v[88:91]
    buffer_load_dwordx4 v6, s[4:7], s20 offen lds
    v_mfma_f32_16x16x32_bf16 v[88:91], a[224:227], a[204:207], v[88:91]
    v_exp_f32 v53, v53
    v_mfma_f32_16x16x32_bf16 v[88:91], a[228:231], a[208:211], v[88:91]
    ds_read_b64_tr_b16 a[216:217], v3 offset:18432
    v_fma_f32 v61, v61, s28, v10
    v_mfma_f32_16x16x32_bf16 v[88:91], a[232:235], v[92:95], v[88:91]
    v_exp_f32 v55, v55
    v_mfma_f32_16x16x32_bf16 v[80:83], a[232:235], a[188:191], v[80:83]
    ds_read_b64_tr_b16 a[218:219], v3 offset:12288
    v_fma_f32 v60, v60, s28, v10
    v_mfma_f32_16x16x32_bf16 v[80:83], a[228:231], a[184:187], v[80:83]
    v_exp_f32 v52, v52
    v_mfma_f32_16x16x32_bf16 v[80:83], a[224:227], a[180:183], v[80:83]
    s_add_u32 s20, s20, 12032
    v_fma_f32 v63, v63, s28, v10
    v_mfma_f32_16x16x32_bf16 v[72:75], a[224:227], a[156:159], v[72:75]
    s_add_u32 s30, s30, 1
    v_exp_f32 v60, v60
    v_mfma_f32_16x16x32_bf16 v[72:75], a[228:231], a[160:163], v[72:75]
    ds_read_b64_tr_b16 a[220:221], v4 offset:18432
    v_cvt_pk_bf16_f32 v14, v52, v53
    v_mfma_f32_16x16x32_bf16 v[72:75], a[232:235], a[164:167], v[72:75]
    v_exp_f32 v61, v61
    v_mfma_f32_16x16x32_bf16 v[64:67], a[232:235], a[140:143], v[64:67]
    v_exp_f32 v63, v63
    v_mfma_f32_16x16x32_bf16 v[64:67], a[228:231], a[136:139], v[64:67]
    ds_read_b64_tr_b16 a[222:223], v4 offset:12288
    v_cvt_pk_bf16_f32 v15, v54, v55
    v_mfma_f32_16x16x32_bf16 v[64:67], a[224:227], a[132:135], v[64:67]
    v_cvt_pk_bf16_f32 v21, v62, v63
    v_mfma_f32_16x16x32_bf16 v[56:59], a[224:227], a[108:111], v[56:59]
    ds_read_b64_tr_b16 a[224:225], v5 offset:18432
    v_cvt_pk_bf16_f32 v20, v60, v61
    v_mfma_f32_16x16x32_bf16 v[56:59], a[228:231], a[112:115], v[56:59]
    s_cmp_lt_u32 s30, 6
    ds_read_b64_tr_b16 a[226:227], v5 offset:12288
    v_mfma_f32_16x16x32_bf16 v[56:59], a[232:235], a[116:119], v[56:59]
    s_cbranch_scc1 L_loop5w0
    s_cmp_ge_u32 s37, 6
    s_cbranch_scc1 L_end5
    s_cmp_eq_u32 s32, 0
    s_cbranch_scc1 L_tr54
    s_branch L_tr55
L_tr54:
    s_waitcnt lgkmcnt(4)
    v_mfma_f32_16x16x32_bf16 v[112:115], a[212:215], v[16:19], v[112:115]
    ds_read_b64_tr_b16 a[232:233], v3 offset:19456
    v_fma_f32 v56, v56, s28, v9
    v_mfma_f32_16x16x32_bf16 v[116:119], a[216:219], v[16:19], v[116:119]
    v_fma_f32 v77, v77, s28, v12
    v_mfma_f32_16x16x32_bf16 v[164:167], a[216:219], v[22:25], v[164:167]
    ds_read_b64_tr_b16 a[230:231], v2 offset:13312
    v_fma_f32 v59, v59, s28, v9
    v_mfma_f32_16x16x32_bf16 v[160:163], a[212:215], v[22:25], v[160:163]
    ds_read_b64_tr_b16 a[228:229], v2 offset:19456
    v_fma_f32 v75, v75, s28, v11
    v_mfma_f32_16x16x32_bf16 v[208:211], a[212:215], v[28:31], v[208:211]
    v_exp_f32 v59, v59
    v_mfma_f32_16x16x32_bf16 v[212:215], a[216:219], v[28:31], v[212:215]
    v_fma_f32 v73, v73, s28, v11
    v_fma_f32 v85, v85, s28, v13
    v_mfma_f32_16x16x32_bf16 a[4:7], a[216:219], v[34:37], a[4:7]
    v_fma_f32 v57, v57, s28, v9
    v_fma_f32 v68, v68, s28, v11
    v_mfma_f32_16x16x32_bf16 a[0:3], a[212:215], v[34:37], a[0:3]
    v_exp_f32 v85, v85
    v_mfma_f32_16x16x32_bf16 a[48:51], a[212:215], v[40:43], a[48:51]
    v_fma_f32 v66, v66, s28, v10
    v_fma_f32 v65, v65, s28, v10
    v_mfma_f32_16x16x32_bf16 a[52:55], a[216:219], v[40:43], a[52:55]
    s_waitcnt lgkmcnt(3)
    ds_read_b64_tr_b16 a[212:213], v4 offset:19456
    v_fma_f32 v87, v87, s28, v13
    v_mfma_f32_16x16x32_bf16 a[56:59], a[220:223], v[40:43], a[56:59]
    ds_read_b64_tr_b16 a[234:235], v3 offset:13312
    v_mfma_f32_16x16x32_bf16 a[60:63], a[224:227], v[40:43], a[60:63]
    ds_read_b64_tr_b16 a[218:219], v5 offset:13312
    v_mfma_f32_16x16x32_bf16 a[12:15], a[224:227], v[34:37], a[12:15]
    v_exp_f32 v77, v77
    v_mfma_f32_16x16x32_bf16 a[8:11], a[220:223], v[34:37], a[8:11]
    ds_read_b64_tr_b16 a[216:217], v5 offset:19456
    v_fma_f32 v88, v88, s28, v13
    v_mfma_f32_16x16x32_bf16 v[216:219], a[220:223], v[28:31], v[216:219]
    v_exp_f32 v56, v56
    v_mfma_f32_16x16x32_bf16 v[220:223], a[224:227], v[28:31], v[220:223]
    ds_read_b64_tr_b16 a[214:215], v4 offset:13312
    v_fma_f32 v72, v72, s28, v11
    v_mfma_f32_16x16x32_bf16 v[172:175], a[224:227], v[22:25], v[172:175]
    v_exp_f32 v75, v75
    v_mfma_f32_16x16x32_bf16 v[168:171], a[220:223], v[22:25], v[168:171]
    v_exp_f32 v87, v87
    v_mfma_f32_16x16x32_bf16 v[120:123], a[220:223], v[16:19], v[120:123]
    v_exp_f32 v88, v88
    v_mfma_f32_16x16x32_bf16 v[124:127], a[224:227], v[16:19], v[124:127]
    s_waitcnt lgkmcnt(4)
    v_fma_f32 v86, v86, s28, v13
    v_fma_f32 v58, v58, s28, v9
    v_mfma_f32_16x16x32_bf16 v[128:131], a[228:231], v[16:19], v[128:131]
    s_waitcnt lgkmcnt(3)
    v_fma_f32 v74, v74, s28, v11
    v_mfma_f32_16x16x32_bf16 v[132:135], a[232:235], v[16:19], v[132:135]
    v_fma_f32 v91, v91, s28, v13
    v_fma_f32 v69, v69, s28, v11
    v_mfma_f32_16x16x32_bf16 v[180:183], a[232:235], v[22:25], v[180:183]
    ds_read_b64_tr_b16 a[226:227], v3 offset:14336
    v_fma_f32 v64, v64, s28, v10
    v_mfma_f32_16x16x32_bf16 v[176:179], a[228:231], v[22:25], v[176:179]
    v_exp_f32 v86, v86
    v_mfma_f32_16x16x32_bf16 v[224:227], a[228:231], v[28:31], v[224:227]
    v_fma_f32 v78, v78, s28, v12
    v_fma_f32 v84, v84, s28, v13
    v_mfma_f32_16x16x32_bf16 v[228:231], a[232:235], v[28:31], v[228:231]
    v_mfma_f32_16x16x32_bf16 a[20:23], a[232:235], v[34:37], a[20:23]
    ds_read_b64_tr_b16 a[220:221], v2 offset:20480
    v_fma_f32 v79, v79, s28, v12
    v_mfma_f32_16x16x32_bf16 a[16:19], a[228:231], v[34:37], a[16:19]
    ds_read_b64_tr_b16 a[222:223], v2 offset:14336
    v_fma_f32 v82, v82, s28, v12
    v_mfma_f32_16x16x32_bf16 a[64:67], a[228:231], v[40:43], a[64:67]
    ds_read_b64_tr_b16 a[224:225], v3 offset:20480
    v_mfma_f32_16x16x32_bf16 a[68:71], a[232:235], v[40:43], a[68:71]
    s_waitcnt lgkmcnt(4)
    ds_read_b64_tr_b16 a[234:235], v5 offset:14336
    v_fma_f32 v89, v89, s28, v13
    v_mfma_f32_16x16x32_bf16 a[72:75], a[212:215], v[40:43], a[72:75]
    ds_read_b64_tr_b16 a[228:229], v4 offset:20480
    v_mfma_f32_16x16x32_bf16 a[76:79], a[216:219], v[40:43], a[76:79]
    v_exp_f32 v68, v68
    v_mfma_f32_16x16x32_bf16 a[28:31], a[216:219], v[34:37], a[28:31]
    v_exp_f32 v89, v89
    v_mfma_f32_16x16x32_bf16 a[24:27], a[212:215], v[34:37], a[24:27]
    v_fma_f32 v67, v67, s28, v10
    v_fma_f32 v83, v83, s28, v12
    v_mfma_f32_16x16x32_bf16 v[232:235], a[212:215], v[28:31], v[232:235]
    ds_read_b64_tr_b16 a[232:233], v5 offset:20480
    v_fma_f32 v76, v76, s28, v12
    v_mfma_f32_16x16x32_bf16 v[236:239], a[216:219], v[28:31], v[236:239]
    ds_read_b64_tr_b16 a[230:231], v4 offset:14336
    v_mfma_f32_16x16x32_bf16 v[188:191], a[216:219], v[22:25], v[188:191]
    v_exp_f32 v66, v66
    v_mfma_f32_16x16x32_bf16 v[184:187], a[212:215], v[22:25], v[184:187]
    s_add_u32 s39, s39, 12288
    v_exp_f32 v78, v78
    v_mfma_f32_16x16x32_bf16 v[136:139], a[212:215], v[16:19], v[136:139]
    v_exp_f32 v58, v58
    v_mfma_f32_16x16x32_bf16 v[140:143], a[216:219], v[16:19], v[140:143]
    s_waitcnt lgkmcnt(3)
    v_exp_f32 v64, v64
    v_mfma_f32_16x16x32_bf16 v[144:147], a[220:223], v[16:19], v[144:147]
    v_exp_f32 v76, v76
    v_mfma_f32_16x16x32_bf16 v[148:151], a[224:227], v[16:19], v[148:151]
    v_exp_f32 v73, v73
    v_mfma_f32_16x16x32_bf16 v[196:199], a[224:227], v[22:25], v[196:199]
    v_fma_f32 v70, v70, s28, v11
    v_fma_f32 v80, v80, s28, v12
    v_mfma_f32_16x16x32_bf16 v[192:195], a[220:223], v[22:25], v[192:195]
    v_fma_f32 v71, v71, s28, v11
    v_mfma_f32_16x16x32_bf16 v[240:243], a[220:223], v[28:31], v[240:243]
    v_cvt_pk_bf16_f32 v39, v86, v87
    v_mfma_f32_16x16x32_bf16 v[244:247], a[224:227], v[28:31], v[244:247]
    s_waitcnt vmcnt(10) lgkmcnt(0)
    v_exp_f32 v70, v70
    v_mfma_f32_16x16x32_bf16 a[36:39], a[224:227], v[34:37], a[36:39]
    s_add_u32 m0, s22, 36864
    v_exp_f32 v79, v79
    v_mfma_f32_16x16x32_bf16 a[32:35], a[220:223], v[34:37], a[32:35]
    s_barrier
    v_mfma_f32_16x16x32_bf16 a[80:83], a[220:223], v[40:43], a[80:83]
    ds_read_b128 a[212:215], v0 offset:12288
    v_fma_f32 v81, v81, s28, v12
    v_mfma_f32_16x16x32_bf16 a[84:87], a[224:227], v[40:43], a[84:87]
    v_exp_f32 v71, v71
    v_mfma_f32_16x16x32_bf16 a[88:91], a[228:231], v[40:43], a[88:91]
    ds_read_b128 a[216:219], v1 offset:12288
    v_cvt_pk_bf16_f32 v33, v78, v79
    v_mfma_f32_16x16x32_bf16 a[92:95], a[232:235], v[40:43], a[92:95]
    ds_read_b128 a[220:223], v0 offset:13312
    v_mfma_f32_16x16x32_bf16 a[44:47], a[232:235], v[34:37], a[44:47]
    buffer_load_dwordx4 v6, s[8:11], s21 offen lds
    v_mfma_f32_16x16x32_bf16 a[40:43], a[228:231], v[34:37], a[40:43]
    s_add_u32 s21, s21, 128
    v_cvt_pk_bf16_f32 v27, v70, v71
    s_add_u32 m0, s22, 37888
    v_mfma_f32_16x16x32_bf16 v[248:251], a[228:231], v[28:31], v[248:251]
    buffer_load_dwordx4 v6, s[8:11], s21 offen lds
    v_mfma_f32_16x16x32_bf16 v[252:255], a[232:235], v[28:31], v[252:255]
    v_exp_f32 v82, v82
    v_mfma_f32_16x16x32_bf16 v[204:207], a[232:235], v[22:25], v[204:207]
    s_add_u32 s21, s21, 128
    v_fma_f32 v90, v90, s28, v13
    s_add_u32 m0, s22, 38912
    v_mfma_f32_16x16x32_bf16 v[200:203], a[228:231], v[22:25], v[200:203]
    ds_read_b128 a[224:227], v1 offset:13312
    v_mfma_f32_16x16x32_bf16 v[152:155], a[228:231], v[16:19], v[152:155]
    buffer_load_dwordx4 v6, s[8:11], s21 offen lds
    v_mfma_f32_16x16x32_bf16 v[156:159], a[232:235], v[16:19], v[156:159]
    s_waitcnt lgkmcnt(3)
    ds_read_b128 a[228:231], v0 offset:14336
    v_cvt_pk_bf16_f32 v17, v58, v59
    v_mfma_f32_16x16x32_bf16 v[52:55], a[212:215], a[96:99], 0
    s_waitcnt lgkmcnt(3)
    v_exp_f32 v84, v84
    v_mfma_f32_16x16x32_bf16 v[52:55], a[216:219], a[100:103], v[52:55]
    s_waitcnt lgkmcnt(2)
    v_exp_f32 v74, v74
    v_mfma_f32_16x16x32_bf16 v[52:55], a[220:223], a[104:107], v[52:55]
    v_exp_f32 v83, v83
    v_mfma_f32_16x16x32_bf16 v[60:63], a[220:223], a[128:131], 0
    v_exp_f32 v69, v69
    v_mfma_f32_16x16x32_bf16 v[60:63], a[216:219], a[124:127], v[60:63]
    ds_read_b128 a[232:235], v1 offset:14336
    v_mfma_f32_16x16x32_bf16 v[60:63], a[212:215], a[120:123], v[60:63]
    v_cvt_pk_bf16_f32 v38, v84, v85
    v_cvt_pk_bf16_f32 v26, v68, v69
    v_mfma_f32_16x16x32_bf16 v[68:71], a[212:215], a[144:147], 0
    v_cvt_pk_bf16_f32 v32, v76, v77
    v_mfma_f32_16x16x32_bf16 v[68:71], a[216:219], a[148:151], v[68:71]
    v_mfma_f32_16x16x32_bf16 v[68:71], a[220:223], a[152:155], v[68:71]
    v_mfma_f32_16x16x32_bf16 v[76:79], a[220:223], a[176:179], 0
    v_exp_f32 v57, v57
    v_mfma_f32_16x16x32_bf16 v[76:79], a[216:219], a[172:175], v[76:79]
    v_exp_f32 v81, v81
    v_mfma_f32_16x16x32_bf16 v[76:79], a[212:215], a[168:171], v[76:79]
    v_mfma_f32_16x16x32_bf16 v[84:87], a[212:215], a[192:195], 0
    v_exp_f32 v65, v65
    v_mfma_f32_16x16x32_bf16 v[84:87], a[216:219], a[196:199], v[84:87]
    v_exp_f32 v80, v80
    v_mfma_f32_16x16x32_bf16 v[84:87], a[220:223], a[200:203], v[84:87]
    s_waitcnt lgkmcnt(0)
    v_mfma_f32_16x16x32_bf16 v[84:87], a[224:227], a[204:207], v[84:87]
    v_cvt_pk_bf16_f32 v35, v82, v83
    v_mfma_f32_16x16x32_bf16 v[84:87], a[228:231], a[208:211], v[84:87]
    v_exp_f32 v90, v90
    v_mfma_f32_16x16x32_bf16 v[84:87], a[232:235], v[92:95], v[84:87]
    v_exp_f32 v72, v72
    v_mfma_f32_16x16x32_bf16 v[76:79], a[232:235], a[188:191], v[76:79]
    ds_read_b128 a[220:223], v0 offset:19456
    v_cvt_pk_bf16_f32 v40, v88, v89
    v_mfma_f32_16x16x32_bf16 v[76:79], a[228:231], a[184:187], v[76:79]
    v_exp_f32 v91, v91
    v_mfma_f32_16x16x32_bf16 v[76:79], a[224:227], a[180:183], v[76:79]
    ds_read_b128 a[212:215], v0 offset:18432
    v_cvt_pk_bf16_f32 v34, v80, v81
    v_mfma_f32_16x16x32_bf16 v[68:71], a[224:227], a[156:159], v[68:71]
    v_cvt_pk_bf16_f32 v22, v64, v65
    v_cvt_pk_bf16_f32 v16, v56, v57
    v_mfma_f32_16x16x32_bf16 v[68:71], a[228:231], a[160:163], v[68:71]
    v_mfma_f32_16x16x32_bf16 v[68:71], a[232:235], a[164:167], v[68:71]
    v_exp_f32 v67, v67
    v_mfma_f32_16x16x32_bf16 v[60:63], a[232:235], a[140:143], v[60:63]
    ds_read_b128 a[216:219], v1 offset:18432
    v_mfma_f32_16x16x32_bf16 v[60:63], a[228:231], a[136:139], v[60:63]
    v_mfma_f32_16x16x32_bf16 v[60:63], a[224:227], a[132:135], v[60:63]
    v_cvt_pk_bf16_f32 v23, v66, v67
    v_mfma_f32_16x16x32_bf16 v[52:55], a[224:227], a[108:111], v[52:55]
    v_mfma_f32_16x16x32_bf16 v[52:55], a[228:231], a[112:115], v[52:55]
    ds_read_b128 a[228:231], v0 offset:20480
    v_cvt_pk_bf16_f32 v28, v72, v73
    v_mfma_f32_16x16x32_bf16 v[44:47], a[236:239], v[14:17], v[48:51]
    ds_read_b128 a[224:227], v1 offset:19456
    v_mfma_f32_16x16x32_bf16 v[52:55], a[232:235], a[116:119], v[52:55]
    s_waitcnt lgkmcnt(3)
    ds_read_b128 a[232:235], v1 offset:20480
    v_cvt_pk_bf16_f32 v29, v74, v75
    v_mfma_f32_16x16x32_bf16 v[56:59], a[212:215], a[96:99], 0
    v_mfma_f32_16x16x32_bf16 v[44:47], a[240:243], v[20:23], v[44:47]
    v_cvt_pk_bf16_f32 v41, v90, v91
    v_mfma_f32_16x16x32_bf16 v[44:47], a[244:247], v[26:29], v[44:47]
    v_mfma_f32_16x16x32_bf16 v[44:47], a[248:251], v[32:35], v[44:47]
    v_mfma_f32_16x16x32_bf16 v[44:47], a[252:255], v[38:41], v[44:47]
    s_add_u32 s21, s21, 12032
    s_waitcnt lgkmcnt(3)
    v_mfma_f32_16x16x32_bf16 v[56:59], a[216:219], a[100:103], v[56:59]
    v_mfma_f32_16x16x32_bf16 v[56:59], a[220:223], a[104:107], v[56:59]
    v_mfma_f32_16x16x32_bf16 v[64:67], a[220:223], a[128:131], 0
    v_mfma_f32_16x16x32_bf16 v[64:67], a[216:219], a[124:127], v[64:67]
    s_nop 1
    v_cmp_lt_f32 vcc, s29, v44
    v_mfma_f32_16x16x32_bf16 v[64:67], a[212:215], a[120:123], v[64:67]
    s_waitcnt vmcnt(7) lgkmcnt(0)
    v_mfma_f32_16x16x32_bf16 v[72:75], a[212:215], a[144:147], 0
    s_barrier
    v_mfma_f32_16x16x32_bf16 v[72:75], a[216:219], a[148:151], v[72:75]
    s_cbranch_vccnz L_rs_tr54a
L_ret_tr54a:
    v_fma_f32 v55, v55, s28, v9
    v_mfma_f32_16x16x32_bf16 v[72:75], a[220:223], a[152:155], v[72:75]
    v_fma_f32 v54, v54, s28, v9
    v_fma_f32 v63, v63, s28, v10
    v_mfma_f32_16x16x32_bf16 v[80:83], a[220:223], a[176:179], 0
    s_add_u32 m0, s22, 12288
    v_exp_f32 v55, v55
    v_mfma_f32_16x16x32_bf16 v[80:83], a[216:219], a[172:175], v[80:83]
    v_exp_f32 v54, v54
    v_mfma_f32_16x16x32_bf16 v[80:83], a[212:215], a[168:171], v[80:83]
    buffer_load_dwordx4 v6, s[4:7], s20 offen lds
    v_mfma_f32_16x16x32_bf16 v[88:91], a[212:215], a[192:195], 0
    s_add_u32 s20, s20, 128
    v_fma_f32 v53, v53, s28, v9
    s_add_u32 m0, s22, 13312
    v_mfma_f32_16x16x32_bf16 v[88:91], a[216:219], a[196:199], v[88:91]
    buffer_load_dwordx4 v6, s[4:7], s20 offen lds
    v_mfma_f32_16x16x32_bf16 v[88:91], a[220:223], a[200:203], v[88:91]
    s_add_u32 s20, s20, 128
    ds_read_b64_tr_b16 a[212:213], v2 offset:0
    v_mfma_f32_16x16x32_bf16 v[88:91], a[224:227], a[204:207], v[88:91]
    s_add_u32 m0, s22, 14336
    ds_read_b64_tr_b16 a[214:215], v2 offset:6144
    v_fma_f32 v61, v61, s28, v10
    v_mfma_f32_16x16x32_bf16 v[88:91], a[228:231], a[208:211], v[88:91]
    buffer_load_dwordx4 v6, s[4:7], s20 offen lds
    v_mfma_f32_16x16x32_bf16 v[88:91], a[232:235], v[92:95], v[88:91]
    ds_read_b64_tr_b16 a[216:217], v3 offset:0
    v_fma_f32 v60, v60, s28, v10
    v_mfma_f32_16x16x32_bf16 v[80:83], a[232:235], a[188:191], v[80:83]
    v_exp_f32 v63, v63
    v_mfma_f32_16x16x32_bf16 v[80:83], a[228:231], a[184:187], v[80:83]
    ds_read_b64_tr_b16 a[218:219], v3 offset:6144
    v_fma_f32 v52, v52, s28, v9
    v_mfma_f32_16x16x32_bf16 v[80:83], a[224:227], a[180:183], v[80:83]
    v_exp_f32 v52, v52
    v_mfma_f32_16x16x32_bf16 v[72:75], a[224:227], a[156:159], v[72:75]
    v_exp_f32 v60, v60
    v_mfma_f32_16x16x32_bf16 v[72:75], a[228:231], a[160:163], v[72:75]
    v_exp_f32 v53, v53
    v_mfma_f32_16x16x32_bf16 v[72:75], a[232:235], a[164:167], v[72:75]
    v_cvt_pk_bf16_f32 v19, v54, v55
    v_fma_f32 v62, v62, s28, v10
    v_mfma_f32_16x16x32_bf16 v[64:67], a[232:235], a[140:143], v[64:67]
    s_add_u32 s20, s20, 12032
    v_exp_f32 v62, v62
    v_mfma_f32_16x16x32_bf16 v[64:67], a[228:231], a[136:139], v[64:67]
    v_exp_f32 v61, v61
    v_mfma_f32_16x16x32_bf16 v[64:67], a[224:227], a[132:135], v[64:67]
    ds_read_b64_tr_b16 a[220:221], v4 offset:0
    v_cvt_pk_bf16_f32 v25, v62, v63
    v_mfma_f32_16x16x32_bf16 v[56:59], a[224:227], a[108:111], v[56:59]
    ds_read_b64_tr_b16 a[222:223], v4 offset:6144
    v_cvt_pk_bf16_f32 v24, v60, v61
    v_mfma_f32_16x16x32_bf16 v[56:59], a[228:231], a[112:115], v[56:59]
    ds_read_b64_tr_b16 a[224:225], v5 offset:0
    v_cvt_pk_bf16_f32 v18, v52, v53
    v_mfma_f32_16x16x32_bf16 v[56:59], a[232:235], a[116:119], v[56:59]
    ds_read_b64_tr_b16 a[226:227], v5 offset:6144
    s_waitcnt lgkmcnt(4)
    v_mfma_f32_16x16x32_bf16 v[112:115], a[212:215], v[14:17], v[112:115]
    v_fma_f32 v91, v91, s28, v13
    v_fma_f32 v64, v64, s28, v10
    v_mfma_f32_16x16x32_bf16 v[116:119], a[216:219], v[14:17], v[116:119]
    ds_read_b64_tr_b16 a[228:229], v2 offset:1024
    v_fma_f32 v75, v75, s28, v11
    v_mfma_f32_16x16x32_bf16 v[164:167], a[216:219], v[20:23], v[164:167]
    v_fma_f32 v78, v78, s28, v12
    v_fma_f32 v77, v77, s28, v12
    v_mfma_f32_16x16x32_bf16 v[160:163], a[212:215], v[20:23], v[160:163]
    ds_read_b64_tr_b16 a[232:233], v3 offset:1024
    v_lshrrev_b32 v105, 11, v0
    v_mfma_f32_16x16x32_bf16 v[208:211], a[212:215], v[26:29], v[208:211]
    v_and_b32 v104, 0x3ff, v0
    v_fma_f32 v73, v73, s28, v11
    v_mfma_f32_16x16x32_bf16 v[212:215], a[216:219], v[26:29], v[212:215]
    ds_read_b64_tr_b16 a[230:231], v2 offset:7168
    v_fma_f32 v81, v81, s28, v12
    v_mfma_f32_16x16x32_bf16 a[4:7], a[216:219], v[32:35], a[4:7]
    v_xor_b32 v105, s65, v105
    v_lshl_add_u32 v104, v105, 10, v104
    v_mfma_f32_16x16x32_bf16 a[0:3], a[212:215], v[32:35], a[0:3]
    ds_read_b64_tr_b16 a[234:235], v3 offset:7168
    v_add_u32 v104, s38, v104
    v_mfma_f32_16x16x32_bf16 a[48:51], a[212:215], v[38:41], a[48:51]
    v_exp_f32 v73, v73
    v_mfma_f32_16x16x32_bf16 a[52:55], a[216:219], v[38:41], a[52:55]
    s_waitcnt lgkmcnt(4)
    ds_read_b64_tr_b16 a[212:213], v4 offset:1024
    v_fma_f32 v76, v76, s28, v12
    v_mfma_f32_16x16x32_bf16 a[56:59], a[220:223], v[38:41], a[56:59]
    ds_read_b64_tr_b16 a[218:219], v5 offset:7168
    v_xor_b32 v105, 64, v104
    v_mfma_f32_16x16x32_bf16 a[60:63], a[224:227], v[38:41], a[60:63]
    ds_read_b64_tr_b16 a[216:217], v5 offset:1024
    v_fma_f32 v90, v90, s28, v13
    v_mfma_f32_16x16x32_bf16 a[12:15], a[224:227], v[32:35], a[12:15]
    ds_read_b128 a[152:155], v104 offset:14336
    v_fma_f32 v79, v79, s28, v12
    v_mfma_f32_16x16x32_bf16 a[8:11], a[220:223], v[32:35], a[8:11]
    ds_read_b128 a[140:143], v105 offset:10240
    v_fma_f32 v68, v68, s28, v11
    v_mfma_f32_16x16x32_bf16 v[216:219], a[220:223], v[26:29], v[216:219]
    ds_read_b64_tr_b16 a[214:215], v4 offset:7168
    v_fma_f32 v85, v85, s28, v13
    v_mfma_f32_16x16x32_bf16 v[220:223], a[224:227], v[26:29], v[220:223]
    v_exp_f32 v78, v78
    v_mfma_f32_16x16x32_bf16 v[172:175], a[224:227], v[20:23], v[172:175]
    ds_read_b128 a[180:183], v105 offset:20480
    v_fma_f32 v84, v84, s28, v13
    v_mfma_f32_16x16x32_bf16 v[168:171], a[220:223], v[20:23], v[168:171]
    v_exp_f32 v79, v79
    v_mfma_f32_16x16x32_bf16 v[120:123], a[220:223], v[14:17], v[120:123]
    ds_read_b64_tr_b16 a[222:223], v2 offset:8192
    v_fma_f32 v72, v72, s28, v11
    v_mfma_f32_16x16x32_bf16 v[124:127], a[224:227], v[14:17], v[124:127]
    s_waitcnt lgkmcnt(7)
    v_exp_f32 v77, v77
    v_mfma_f32_16x16x32_bf16 v[128:131], a[228:231], v[14:17], v[128:131]
    ds_read_b128 a[160:163], v104 offset:16384
    v_fma_f32 v69, v69, s28, v11
    v_mfma_f32_16x16x32_bf16 v[132:135], a[232:235], v[14:17], v[132:135]
    ds_read_b64_tr_b16 a[224:225], v3 offset:2048
    v_fma_f32 v89, v89, s28, v13
    v_mfma_f32_16x16x32_bf16 v[180:183], a[232:235], v[20:23], v[180:183]
    v_exp_f32 v68, v68
    v_mfma_f32_16x16x32_bf16 v[176:179], a[228:231], v[20:23], v[176:179]
    ds_read_b128 a[116:119], v105 offset:4096
    v_fma_f32 v59, v59, s28, v9
    v_mfma_f32_16x16x32_bf16 v[224:227], a[228:231], v[26:29], v[224:227]
    ds_read_b64_tr_b16 a[226:227], v3 offset:8192
    v_exp_f32 v64, v64
    v_mfma_f32_16x16x32_bf16 v[228:231], a[232:235], v[26:29], v[228:231]
    ds_read_b128 a[144:147], v104 offset:12288
    v_fma_f32 v66, v66, s28, v10
    v_mfma_f32_16x16x32_bf16 a[20:23], a[232:235], v[32:35], a[20:23]
    ds_read_b64_tr_b16 a[220:221], v2 offset:2048
    v_cvt_pk_bf16_f32 v37, v78, v79
    v_mfma_f32_16x16x32_bf16 a[16:19], a[228:231], v[32:35], a[16:19]
    ds_read_b128 a[128:131], v104 offset:8192
    v_fma_f32 v70, v70, s28, v11
    v_mfma_f32_16x16x32_bf16 a[64:67], a[228:231], v[38:41], a[64:67]
    ds_read_b64_tr_b16 a[230:231], v4 offset:8192
    v_fma_f32 v56, v56, s28, v9
    v_mfma_f32_16x16x32_bf16 a[68:71], a[232:235], v[38:41], a[68:71]
    s_waitcnt lgkmcnt(8)
    ds_read_b64_tr_b16 a[228:229], v4 offset:2048
    v_mfma_f32_16x16x32_bf16 a[72:75], a[212:215], v[38:41], a[72:75]
    ds_read_b128 a[176:179], v104 offset:20480
    v_fma_f32 v57, v57, s28, v9
    v_mfma_f32_16x16x32_bf16 a[76:79], a[216:219], v[38:41], a[76:79]
    ds_read_b64_tr_b16 a[232:233], v5 offset:2048
    v_fma_f32 v67, v67, s28, v10
    v_mfma_f32_16x16x32_bf16 a[28:31], a[216:219], v[32:35], a[28:31]
    v_exp_f32 v69, v69
    v_mfma_f32_16x16x32_bf16 a[24:27], a[212:215], v[32:35], a[24:27]
    v_exp_f32 v76, v76
    v_mfma_f32_16x16x32_bf16 v[232:235], a[212:215], v[26:29], v[232:235]
    ds_read_b64_tr_b16 a[234:235], v5 offset:8192
    v_fma_f32 v83, v83, s28, v12
    v_mfma_f32_16x16x32_bf16 v[236:239], a[216:219], v[26:29], v[236:239]
    v_exp_f32 v70, v70
    v_mfma_f32_16x16x32_bf16 v[188:191], a[216:219], v[20:23], v[188:191]
    ds_read_b128 a[156:159], v105 offset:14336
    v_fma_f32 v71, v71, s28, v11
    v_mfma_f32_16x16x32_bf16 v[184:187], a[212:215], v[20:23], v[184:187]
    v_exp_f32 v81, v81
    v_mfma_f32_16x16x32_bf16 v[136:139], a[212:215], v[14:17], v[136:139]
    ds_read_b128 a[136:139], v104 offset:10240
    s_add_u32 s39, s39, 12288
    v_mfma_f32_16x16x32_bf16 v[140:143], a[216:219], v[14:17], v[140:143]
    s_waitcnt lgkmcnt(5)
    v_exp_f32 v72, v72
    v_mfma_f32_16x16x32_bf16 v[144:147], a[220:223], v[14:17], v[144:147]
    ds_read_b128 a[104:107], v104 offset:2048
    v_fma_f32 v88, v88, s28, v13
    v_mfma_f32_16x16x32_bf16 v[148:151], a[224:227], v[14:17], v[148:151]
    ds_read_b128 a[100:103], v105 offset:0
    v_fma_f32 v82, v82, s28, v12
    v_mfma_f32_16x16x32_bf16 v[196:199], a[224:227], v[20:23], v[196:199]
    ds_read_b128 a[96:99], v104 offset:0
    v_fma_f32 v80, v80, s28, v12
    v_mfma_f32_16x16x32_bf16 v[192:195], a[220:223], v[20:23], v[192:195]
    v_exp_f32 v71, v71
    v_mfma_f32_16x16x32_bf16 v[240:243], a[220:223], v[26:29], v[240:243]
    ds_read_b128 a[168:171], v104 offset:18432
    s_waitcnt vmcnt(6) lgkmcnt(6)
    v_mfma_f32_16x16x32_bf16 v[244:247], a[224:227], v[26:29], v[244:247]
    v_exp_f32 v56, v56
    v_mfma_f32_16x16x32_bf16 a[36:39], a[224:227], v[32:35], a[36:39]
    ds_read_b128 a[184:187], v104 offset:22528
    v_exp_f32 v83, v83
    v_mfma_f32_16x16x32_bf16 a[32:35], a[220:223], v[32:35], a[32:35]
    s_barrier
    ds_read_b128 a[148:151], v105 offset:12288
    v_mfma_f32_16x16x32_bf16 a[80:83], a[220:223], v[38:41], a[80:83]
    s_add_u32 s21, s21, s62
    ds_read_b128 a[212:215], v0 offset:0
    v_cvt_pk_bf16_f32 v30, v68, v69
    v_mfma_f32_16x16x32_bf16 a[84:87], a[224:227], v[38:41], a[84:87]
    ds_read_b128 a[108:111], v105 offset:2048
    v_fma_f32 v74, v74, s28, v11
    v_mfma_f32_16x16x32_bf16 a[88:91], a[228:231], v[38:41], a[88:91]
    ds_read_b128 a[216:219], v1 offset:0
    v_fma_f32 v65, v65, s28, v10
    v_mfma_f32_16x16x32_bf16 a[92:95], a[232:235], v[38:41], a[92:95]
    s_add_u32 m0, s22, 24576
    ds_read_b128 a[220:223], v0 offset:1024
    buffer_load_dwordx4 v6, s[8:11], s21 offen lds
    v_cvt_pk_bf16_f32 v36, v76, v77
    v_mfma_f32_16x16x32_bf16 a[44:47], a[232:235], v[32:35], a[44:47]
    s_add_u32 s21, s21, 128
    ds_read_b128 a[124:127], v105 offset:6144
    v_exp_f32 v82, v82
    v_mfma_f32_16x16x32_bf16 a[40:43], a[228:231], v[32:35], a[40:43]
    s_add_u32 m0, s22, 25600
    ds_read_b128 a[120:123], v104 offset:6144
    v_fma_f32 v58, v58, s28, v9
    v_mfma_f32_16x16x32_bf16 v[248:251], a[228:231], v[26:29], v[248:251]
    buffer_load_dwordx4 v6, s[8:11], s21 offen lds
    v_mfma_f32_16x16x32_bf16 v[252:255], a[232:235], v[26:29], v[252:255]
    s_add_u32 s21, s21, 128
    ds_read_b128 a[172:175], v105 offset:18432
    v_cvt_pk_bf16_f32 v31, v70, v71
    v_mfma_f32_16x16x32_bf16 v[204:207], a[232:235], v[20:23], v[204:207]
    s_add_u32 m0, s22, 26624
    ds_read_b128 a[164:167], v105 offset:16384
    v_fma_f32 v86, v86, s28, v13
    v_mfma_f32_16x16x32_bf16 v[200:203], a[228:231], v[20:23], v[200:203]
    buffer_load_dwordx4 v6, s[8:11], s21 offen lds
    v_mfma_f32_16x16x32_bf16 v[152:155], a[228:231], v[14:17], v[152:155]
    ds_read_b128 a[224:227], v1 offset:1024
    v_mfma_f32_16x16x32_bf16 v[156:159], a[232:235], v[14:17], v[156:159]
    s_waitcnt lgkmcnt(6)
    v_exp_f32 v75, v75
    v_mfma_f32_16x16x32_bf16 v[52:55], a[212:215], a[96:99], 0
    ds_read_b128 a[228:231], v0 offset:2048
    v_cvt_pk_bf16_f32 v35, v82, v83
    v_mfma_f32_16x16x32_bf16 v[52:55], a[216:219], a[100:103], v[52:55]
    s_waitcnt lgkmcnt(6)
    ds_read_b128 a[232:235], v1 offset:2048
    v_exp_f32 v57, v57
    v_mfma_f32_16x16x32_bf16 v[52:55], a[220:223], a[104:107], v[52:55]
    ds_read_b128 a[112:115], v104 offset:4096
    v_cvt_pk_bf16_f32 v16, v56, v57
    v_mfma_f32_16x16x32_bf16 v[60:63], a[220:223], a[128:131], 0
    s_waitcnt lgkmcnt(6)
    ds_read_b128 a[188:191], v105 offset:22528
    v_cvt_pk_bf16_f32 v28, v72, v73
    v_mfma_f32_16x16x32_bf16 v[60:63], a[216:219], a[124:127], v[60:63]
    v_exp_f32 v65, v65
    v_mfma_f32_16x16x32_bf16 v[60:63], a[212:215], a[120:123], v[60:63]
    v_exp_f32 v89, v89
    v_mfma_f32_16x16x32_bf16 v[68:71], a[212:215], a[144:147], 0
    v_exp_f32 v86, v86
    v_mfma_f32_16x16x32_bf16 v[68:71], a[216:219], a[148:151], v[68:71]
    ds_read_b128 a[132:135], v105 offset:8192
    v_cvt_pk_bf16_f32 v22, v64, v65
    v_mfma_f32_16x16x32_bf16 v[68:71], a[220:223], a[152:155], v[68:71]
    v_exp_f32 v84, v84
    v_mfma_f32_16x16x32_bf16 v[76:79], a[220:223], a[176:179], 0
    s_waitcnt lgkmcnt(5)
    v_exp_f32 v90, v90
    v_mfma_f32_16x16x32_bf16 v[76:79], a[216:219], a[172:175], v[76:79]
    v_exp_f32 v58, v58
    v_mfma_f32_16x16x32_bf16 v[76:79], a[212:215], a[168:171], v[76:79]
    v_exp_f32 v74, v74
    v_mfma_f32_16x16x32_bf16 v[76:79], a[224:227], a[180:183], v[76:79]
    s_waitcnt lgkmcnt(2)
    v_exp_f32 v88, v88
    v_mfma_f32_16x16x32_bf16 v[76:79], a[228:231], a[184:187], v[76:79]
    s_waitcnt lgkmcnt(1)
    v_exp_f32 v85, v85
    v_mfma_f32_16x16x32_bf16 v[76:79], a[232:235], a[188:191], v[76:79]
    v_exp_f32 v59, v59
    v_mfma_f32_16x16x32_bf16 v[68:71], a[232:235], a[164:167], v[68:71]
    v_exp_f32 v67, v67
    v_mfma_f32_16x16x32_bf16 v[68:71], a[228:231], a[160:163], v[68:71]
    v_exp_f32 v66, v66
    v_mfma_f32_16x16x32_bf16 v[68:71], a[224:227], a[156:159], v[68:71]
    s_waitcnt lgkmcnt(0)
    ds_read_b128 a[212:215], v0 offset:6144
    v_fma_f32 v87, v87, s28, v13
    v_mfma_f32_16x16x32_bf16 v[60:63], a[224:227], a[132:135], v[60:63]
    ds_read_b128 a[220:223], v0 offset:7168
    v_cvt_pk_bf16_f32 v23, v66, v67
    v_mfma_f32_16x16x32_bf16 v[60:63], a[228:231], a[136:139], v[60:63]
    v_exp_f32 v91, v91
    v_mfma_f32_16x16x32_bf16 v[60:63], a[232:235], a[140:143], v[60:63]
    ds_read_b128 a[216:219], v1 offset:6144
    v_cvt_pk_bf16_f32 v17, v58, v59
    v_mfma_f32_16x16x32_bf16 v[52:55], a[232:235], a[116:119], v[52:55]
    ds_read_b128 a[232:235], v1 offset:8192
    v_cvt_pk_bf16_f32 v29, v74, v75
    v_mfma_f32_16x16x32_bf16 v[52:55], a[228:231], a[112:115], v[52:55]
    ds_read_b128 a[228:231], v0 offset:8192
    v_cvt_pk_bf16_f32 v40, v88, v89
    v_mfma_f32_16x16x32_bf16 v[52:55], a[224:227], a[108:111], v[52:55]
    ds_read_b128 a[224:227], v1 offset:7168
    v_exp_f32 v80, v80
    v_mfma_f32_16x16x32_bf16 v[48:51], a[236:239], v[16:19], v[44:47]
    v_exp_f32 v87, v87
    v_mfma_f32_16x16x32_bf16 v[48:51], a[240:243], v[22:25], v[48:51]
    v_cvt_pk_bf16_f32 v34, v80, v81
    v_cvt_pk_bf16_f32 v43, v86, v87
    v_mfma_f32_16x16x32_bf16 v[48:51], a[244:247], v[28:31], v[48:51]
    v_cvt_pk_bf16_f32 v42, v84, v85
    v_cvt_pk_bf16_f32 v41, v90, v91
    v_mfma_f32_16x16x32_bf16 v[48:51], a[248:251], v[34:37], v[48:51]
    s_nop 0
    v_mfma_f32_16x16x32_bf16 v[48:51], a[252:255], v[40:43], v[48:51]
    s_waitcnt lgkmcnt(4)
    v_mfma_f32_16x16x32_bf16 v[56:59], a[212:215], a[96:99], 0
    s_add_u32 s21, s21, 12032
    s_waitcnt lgkmcnt(3)
    v_mfma_f32_16x16x32_bf16 v[56:59], a[216:219], a[100:103], v[56:59]
    v_mfma_f32_16x16x32_bf16 v[56:59], a[220:223], a[104:107], v[56:59]
    s_nop 1
    v_cmp_lt_f32 vcc, s29, v48
    v_mfma_f32_16x16x32_bf16 v[64:67], a[220:223], a[128:131], 0
    s_waitcnt vmcnt(6) lgkmcnt(0)
    v_mfma_f32_16x16x32_bf16 v[64:67], a[216:219], a[124:127], v[64:67]
    s_barrier
    v_mfma_f32_16x16x32_bf16 v[64:67], a[212:215], a[120:123], v[64:67]
    s_cbranch_vccnz L_rs_tr54b
L_ret_tr54b:
    s_add_u32 m0, s22, 0
    v_mfma_f32_16x16x32_bf16 v[72:75], a[212:215], a[144:147], 0
    buffer_load_dwordx4 v6, s[4:7], s20 offen lds
    v_mfma_f32_16x16x32_bf16 v[72:75], a[216:219], a[148:151], v[72:75]
    v_mfma_f32_16x16x32_bf16 v[72:75], a[220:223], a[152:155], v[72:75]
    s_add_u32 s20, s20, 128
    v_mfma_f32_16x16x32_bf16 v[80:83], a[220:223], a[176:179], 0
    s_add_u32 m0, s22, 1024
    v_mfma_f32_16x16x32_bf16 v[80:83], a[216:219], a[172:175], v[80:83]
    buffer_load_dwordx4 v6, s[4:7], s20 offen lds
    v_mfma_f32_16x16x32_bf16 v[80:83], a[212:215], a[168:171], v[80:83]
    ds_read_b64_tr_b16 a[212:213], v2 offset:18432
    v_mfma_f32_16x16x32_bf16 v[80:83], a[224:227], a[180:183], v[80:83]
    ds_read_b64_tr_b16 a[214:215], v2 offset:12288
    s_add_u32 s20, s20, 128
    v_mfma_f32_16x16x32_bf16 v[80:83], a[228:231], a[184:187], v[80:83]
    ds_read_b64_tr_b16 a[216:217], v3 offset:18432
    s_add_u32 m0, s22, 2048
    v_mfma_f32_16x16x32_bf16 v[80:83], a[232:235], a[188:191], v[80:83]
    ds_read_b64_tr_b16 a[218:219], v3 offset:12288
    v_mfma_f32_16x16x32_bf16 v[72:75], a[232:235], a[164:167], v[72:75]
    buffer_load_dwordx4 v6, s[4:7], s20 offen lds
    v_mfma_f32_16x16x32_bf16 v[72:75], a[228:231], a[160:163], v[72:75]
    v_mfma_f32_16x16x32_bf16 v[72:75], a[224:227], a[156:159], v[72:75]
    v_mfma_f32_16x16x32_bf16 v[64:67], a[224:227], a[132:135], v[64:67]
    v_mfma_f32_16x16x32_bf16 v[64:67], a[228:231], a[136:139], v[64:67]
    ds_read_b64_tr_b16 a[220:221], v4 offset:18432
    v_mfma_f32_16x16x32_bf16 v[64:67], a[232:235], a[140:143], v[64:67]
    ds_read_b64_tr_b16 a[222:223], v4 offset:12288
    s_add_u32 s20, s20, 12032
    v_mfma_f32_16x16x32_bf16 v[56:59], a[232:235], a[116:119], v[56:59]
    v_mfma_f32_16x16x32_bf16 v[56:59], a[228:231], a[112:115], v[56:59]
    v_mfma_f32_16x16x32_bf16 v[56:59], a[224:227], a[108:111], v[56:59]
    ds_read_b64_tr_b16 a[224:225], v5 offset:18432
    ds_read_b64_tr_b16 a[226:227], v5 offset:12288
    s_waitcnt lgkmcnt(4)
    v_mfma_f32_16x16x32_bf16 v[112:115], a[212:215], v[16:19], v[112:115]
    v_mbcnt_lo_u32_b32 v104, -1, 0
    v_max3_f32 v96, v52, v53, v54
    s_nop 1
    v_max3_f32 v96, v96, v55, v56
    v_max3_f32 v96, v96, v57, v58
    v_max_f32 v96, v96, v59
    v_mov_b32 v97, v96
    v_mfma_f32_16x16x32_bf16 v[116:119], a[216:219], v[16:19], v[116:119]
    s_nop 0
    v_permlane32_swap_b32 v97, v96
    v_max_f32 v96, v96, v97
    v_mfma_f32_16x16x32_bf16 v[164:167], a[216:219], v[22:25], v[164:167]
    s_mov_b32 s67, s34
    ds_read_b64_tr_b16 a[230:231], v2 offset:13312
    v_mov_b32 v97, v96
    v_mfma_f32_16x16x32_bf16 v[160:163], a[212:215], v[22:25], v[160:163]
    s_add_u32 s18, s34, 30720
    v_permlane16_swap_b32 v97, v96
    v_max_f32 v96, v96, v97
    v_mul_f32_e64 v9, -s28, v96
    v_max3_f32 v96, v60, v61, v62
    v_mfma_f32_16x16x32_bf16 v[208:211], a[212:215], v[28:31], v[208:211]
    s_mov_b32 s34, s33
    v_mov_b32 v100, v48
    v_max3_f32 v96, v96, v63, v64
    v_max3_f32 v96, v96, v65, v66
    v_max_f32 v96, v96, v67
    v_mfma_f32_16x16x32_bf16 v[212:215], a[216:219], v[28:31], v[212:215]
    ds_read_b64_tr_b16 a[232:233], v3 offset:19456
    v_mov_b32 v97, v96
    v_mfma_f32_16x16x32_bf16 a[4:7], a[216:219], v[34:37], a[4:7]
    s_add_u32 s64, s64, s62
    ds_read_b64_tr_b16 a[234:235], v3 offset:13312
    v_mbcnt_hi_u32_b32 v104, -1, v104
    v_mfma_f32_16x16x32_bf16 a[0:3], a[212:215], v[34:37], a[0:3]
    s_add_u32 s64, s64, 196608
    v_rcp_f32 v49, v49
    v_permlane32_swap_b32 v97, v96
    v_max_f32 v96, v96, v97
    v_mov_b32 v97, v96
    v_mfma_f32_16x16x32_bf16 a[48:51], a[212:215], v[40:43], a[48:51]
    s_mov_b32 s39, s64
    v_permlane16_swap_b32 v97, v96
    v_mul_f32 v167, v167, v49
    v_max_f32 v96, v96, v97
    v_mul_f32_e64 v10, -s28, v96
    v_mfma_f32_16x16x32_bf16 a[52:55], a[216:219], v[40:43], a[52:55]
    s_waitcnt lgkmcnt(2)
    ds_read_b64_tr_b16 a[228:229], v2 offset:19456
    v_max3_f32 v96, v68, v69, v70
    v_mfma_f32_16x16x32_bf16 a[56:59], a[220:223], v[40:43], a[56:59]
    v_max3_f32 v96, v96, v71, v72
    v_max3_f32 v96, v96, v73, v74
    v_mfma_f32_16x16x32_bf16 a[60:63], a[224:227], v[40:43], a[60:63]
    v_max_f32 v96, v96, v75
    v_mul_f32 v166, v166, v49
    v_mfma_f32_16x16x32_bf16 a[12:15], a[224:227], v[34:37], a[12:15]
    s_add_u32 s37, s37, 1
    v_mov_b32 v97, v96
    v_and_b32 v107, 3, v104
    v_fma_f32 v57, v57, s28, v9
    v_permlane32_swap_b32 v97, v96
    v_mfma_f32_16x16x32_bf16 a[8:11], a[220:223], v[34:37], a[8:11]
    s_bitcmp1_b32 s63, s37
    v_max_f32 v96, v96, v97
    v_mov_b32 v97, v96
    v_accvgpr_read_b32 v110, a50
    v_mfma_f32_16x16x32_bf16 v[216:219], a[220:223], v[28:31], v[216:219]
    s_cselect_b32 s62, 4294770688, 0
    v_fma_f32 v66, v66, s28, v10
    v_permlane16_swap_b32 v97, v96
    v_mfma_f32_16x16x32_bf16 v[220:223], a[224:227], v[28:31], v[220:223]
    s_cselect_b32 s42, 0, 325632
    ds_read_b64_tr_b16 a[216:217], v5 offset:19456
    v_lshrrev_b32 v106, 5, v104
    v_fma_f32 v54, v54, s28, v9
    v_max_f32 v96, v96, v97
    v_mfma_f32_16x16x32_bf16 v[172:175], a[224:227], v[22:25], v[172:175]
    s_add_u32 s35, s35, s42
    ds_read_b64_tr_b16 a[218:219], v5 offset:13312
    v_fma_f32 v55, v55, s28, v9
    v_mfma_f32_16x16x32_bf16 v[168:171], a[220:223], v[22:25], v[168:171]
    s_lshl_b32 s42, s37, 1
    ds_read_b64_tr_b16 a[212:213], v4 offset:19456
    v_fma_f32 v52, v52, s28, v9
    v_mfma_f32_16x16x32_bf16 v[120:123], a[220:223], v[16:19], v[120:123]
    s_lshr_b32 s42, s31, s42
    ds_read_b64_tr_b16 a[222:223], v2 offset:14336
    v_fma_f32 v61, v61, s28, v10
    v_bfe_u32 v105, v104, 3, 1
    v_mul_f32 v160, v160, v49
    v_mul_f32_e64 v11, -s28, v96
    v_mfma_f32_16x16x32_bf16 v[124:127], a[224:227], v[16:19], v[124:127]
    s_waitcnt lgkmcnt(4)
    ds_read_b64_tr_b16 a[214:215], v4 offset:13312
    v_fma_f32 v56, v56, s28, v9
    v_mul_f32 v163, v163, v49
    v_mfma_f32_16x16x32_bf16 v[128:131], a[228:231], v[16:19], v[128:131]
    s_and_b32 s42, s42, 3
    v_fma_f32 v58, v58, s28, v9
    v_fma_f32 v67, v67, s28, v10
    v_mfma_f32_16x16x32_bf16 v[132:135], a[232:235], v[16:19], v[132:135]
    s_add_u32 s42, s42, s36
    v_mul_f32 v164, v164, v49
    v_fma_f32 v60, v60, s28, v10
    v_exp_f32 v55, v55
    v_mfma_f32_16x16x32_bf16 v[180:183], a[232:235], v[22:25], v[180:183]
    v_max3_f32 v96, v76, v77, v78
    v_mul_f32 v162, v162, v49
    v_mfma_f32_16x16x32_bf16 v[176:179], a[228:231], v[22:25], v[176:179]
    s_sub_u32 s43, s42, 3
    ds_read_b64_tr_b16 a[220:221], v2 offset:20480
    v_max3_f32 v96, v96, v79, v80
    v_mfma_f32_16x16x32_bf16 v[224:227], a[228:231], v[28:31], v[224:227]
    v_fma_f32 v70, v70, s28, v11
    v_exp_f32 v54, v54
    v_mfma_f32_16x16x32_bf16 v[228:231], a[232:235], v[28:31], v[228:231]
    s_cmp_ge_u32 s42, 3
    v_exp_f32 v61, v61
    v_max3_f32 v96, v96, v81, v82
    v_mfma_f32_16x16x32_bf16 a[20:23], a[232:235], v[34:37], a[20:23]
    s_cselect_b32 s42, s43, s42
    v_exp_f32 v60, v60
    v_mfma_f32_16x16x32_bf16 a[16:19], a[228:231], v[34:37], a[16:19]
    s_mul_i32 s44, s3, 5
    ds_read_b64_tr_b16 a[226:227], v3 offset:14336
    v_exp_f32 v52, v52
    v_mul_f32 v172, v172, v49
    v_max_f32 v96, v96, v83
    v_mfma_f32_16x16x32_bf16 a[64:67], a[228:231], v[40:43], a[64:67]
    s_mov_b32 s32, 1
    ds_read_b64_tr_b16 a[228:229], v4 offset:20480
    v_xor_b32 v106, v106, v105
    v_mfma_f32_16x16x32_bf16 a[68:71], a[232:235], v[40:43], a[68:71]
    s_waitcnt lgkmcnt(3)
    ds_read_b64_tr_b16 a[230:231], v4 offset:14336
    v_mov_b32 v97, v96
    v_mfma_f32_16x16x32_bf16 a[72:75], a[212:215], v[40:43], a[72:75]
    s_lshl_b32 s43, s3, 2
    ds_read_b64_tr_b16 a[224:225], v3 offset:20480
    v_mul_f32 v165, v165, v49
    v_mfma_f32_16x16x32_bf16 a[76:79], a[216:219], v[40:43], a[76:79]
    s_add_u32 s45, s43, 21
    v_permlane32_swap_b32 v97, v96
    v_max_f32 v96, v96, v97
    v_mfma_f32_16x16x32_bf16 a[28:31], a[216:219], v[34:37], a[28:31]
    s_cmp_eq_u32 s3, 0
    v_fma_f32 v62, v62, s28, v10
    v_fma_f32 v75, v75, s28, v11
    v_fma_f32 v68, v68, s28, v11
    v_mfma_f32_16x16x32_bf16 a[24:27], a[212:215], v[34:37], a[24:27]
    s_cselect_b32 s45, 20, s45
    v_fma_f32 v53, v53, s28, v9
    v_xor_b32 v105, s65, v105
    v_mfma_f32_16x16x32_bf16 v[232:235], a[212:215], v[28:31], v[232:235]
    s_cselect_b32 s33, 1, 0
    v_cvt_pk_bf16_f32 v15, v54, v55
    v_mov_b32 v97, v96
    v_exp_f32 v62, v62
    v_mfma_f32_16x16x32_bf16 v[236:239], a[216:219], v[28:31], v[236:239]
    s_cmp_eq_u32 s42, 1
    v_exp_f32 v53, v53
    v_mfma_f32_16x16x32_bf16 v[188:191], a[216:219], v[22:25], v[188:191]
    s_cselect_b32 s44, s45, s44
    ds_read_b64_tr_b16 a[234:235], v5 offset:14336
    v_fma_f32 v63, v63, s28, v10
    s_cselect_b32 s32, s33, s32
    v_mul_f32 v177, v177, v49
    v_mfma_f32_16x16x32_bf16 v[184:187], a[212:215], v[22:25], v[184:187]
    s_add_u32 s45, s43, 37
    v_permlane16_swap_b32 v97, v96
    v_mfma_f32_16x16x32_bf16 v[136:139], a[212:215], v[16:19], v[136:139]
    s_cmp_eq_u32 s42, 2
    v_exp_f32 v63, v63
    v_mfma_f32_16x16x32_bf16 v[140:143], a[216:219], v[16:19], v[140:143]
    s_waitcnt lgkmcnt(1)
    v_permlane32_swap_b32 v48, v100
    v_mfma_f32_16x16x32_bf16 v[144:147], a[220:223], v[16:19], v[144:147]
    s_cselect_b32 s44, s45, s44
    v_max_f32 v96, v96, v97
    v_fma_f32 v64, v64, s28, v10
    v_mfma_f32_16x16x32_bf16 v[148:151], a[224:227], v[16:19], v[148:151]
    s_cselect_b32 s32, 0, s32
    v_cvt_pk_bf16_f32 v20, v60, v61
    v_mul_f32_e64 v12, -s28, v96
    v_mfma_f32_16x16x32_bf16 v[196:199], a[224:227], v[22:25], v[196:199]
    s_mul_i32 s44, s44, 6144
    v_fma_f32 v77, v77, s28, v12
    v_mul_f32 v190, v190, v49
    v_mfma_f32_16x16x32_bf16 v[192:195], a[220:223], v[22:25], v[192:195]
    s_add_u32 s33, s35, s44
    v_fma_f32 v72, v72, s28, v11
    v_fma_f32 v73, v73, s28, v11
    s_mul_i32 s42, s32, 6144
    s_add_u32 s42, s42, 24576
    v_fma_f32 v80, v80, s28, v12
    v_mul_f32 v175, v175, v49
    v_lshl_or_b32 v106, v107, 1, v106
    v_mfma_f32_16x16x32_bf16 v[240:243], a[220:223], v[28:31], v[240:243]
    s_add_u32 s42, s42, s33
    ds_read_b64_tr_b16 a[232:233], v5 offset:20480
    v_mul_f32 v191, v191, v49
    v_exp_f32 v67, v67
    v_and_b32 v107, 7, v104
    v_mfma_f32_16x16x32_bf16 v[244:247], a[224:227], v[28:31], v[244:247]
    s_cmp_ge_u32 s37, 6
    v_fma_f32 v59, v59, s28, v9
    v_exp_f32 v57, v57
    v_mfma_f32_16x16x32_bf16 a[36:39], a[224:227], v[34:37], a[36:39]
    s_cselect_b32 s14, 0, s42
    v_fma_f32 v69, v69, s28, v11
    v_mul_f32 v195, v195, v49
    v_fma_f32 v71, v71, s28, v11
    v_lshl_add_u32 v101, v105, 10, s38
    v_mfma_f32_16x16x32_bf16 a[32:35], a[220:223], v[34:37], a[32:35]
    s_add_u32 s24, s67, 6400
    s_add_u32 s25, s33, 6400
    v_mul_f32 v189, v189, v49
    v_exp_f32 v64, v64
    v_fma_f32 v76, v76, s28, v12
    v_fma_f32 v79, v79, s28, v12
    v_mul_f32 v182, v182, v49
    v_fma_f32 v78, v78, s28, v12
    v_exp_f32 v77, v77
    v_mfma_f32_16x16x32_bf16 a[80:83], a[220:223], v[40:43], a[80:83]
    s_add_u32 s23, s38, 10240
    v_mul_f32 v186, v186, v49
    v_lshl_add_u32 v101, v106, 4, v101
    v_mfma_f32_16x16x32_bf16 a[84:87], a[224:227], v[40:43], a[84:87]
    s_mov_b32 s27, 0x49249249
    v_exp_f32 v80, v80
    v_fma_f32 v82, v82, s28, v12
    v_mfma_f32_16x16x32_bf16 a[88:91], a[228:231], v[40:43], a[88:91]
    s_mov_b32 s30, 0
    v_accvgpr_read_b32 v108, a48
    s_waitcnt vmcnt(6) lgkmcnt(0)
    v_mfma_f32_16x16x32_bf16 a[92:95], a[232:235], v[40:43], a[92:95]
    s_barrier
    ds_read_b128 a[216:219], v1 offset:12288
    v_exp_f32 v76, v76
    v_mfma_f32_16x16x32_bf16 a[44:47], a[232:235], v[34:37], a[44:47]
    s_add_u32 m0, s22, 36864
    ds_read_b128 a[212:215], v0 offset:12288
    v_mul_f32 v179, v179, v49
    v_fma_f32 v65, v65, s28, v10
    v_exp_f32 v70, v70
    v_mul_f32 v168, v168, v49
    v_mfma_f32_16x16x32_bf16 a[40:43], a[228:231], v[34:37], a[40:43]
    ds_read_b128 a[220:223], v0 offset:13312
    v_rcp_f32 v50, v50
    v_mfma_f32_16x16x32_bf16 v[248:251], a[228:231], v[28:31], v[248:251]
    v_exp_f32 v78, v78
    v_mfma_f32_16x16x32_bf16 v[252:255], a[232:235], v[28:31], v[252:255]
    v_exp_f32 v79, v79
    v_accvgpr_read_b32 v105, a1
    v_mul_f32 v161, v161, v49
    v_exp_f32 v56, v56
    v_mul_f32 v185, v185, v49
    v_accvgpr_read_b32 v106, a2
    v_exp_f32 v71, v71
    v_exp_f32 v68, v68
    v_lshl_add_u32 v101, v107, 7, v101
    v_exp_f32 v69, v69
    v_exp_f32 v82, v82
    v_mfma_f32_16x16x32_bf16 v[204:207], a[232:235], v[22:25], v[204:207]
    v_cvt_pk_bf16_f32 v33, v78, v79
    v_cvt_pk_bf16_f32 v160, v160, v161
    v_rcp_f32 v48, v48
    v_exp_f32 v58, v58
    v_mfma_f32_16x16x32_bf16 v[200:203], a[228:231], v[22:25], v[200:203]
    v_fma_f32 v81, v81, s28, v12
    v_cvt_pk_bf16_f32 v26, v68, v69
    v_exp_f32 v66, v66
    v_cvt_pk_bf16_f32 v32, v76, v77
    v_cvt_pk_bf16_f32 v14, v52, v53
    v_mfma_f32_16x16x32_bf16 v[152:155], a[228:231], v[16:19], v[152:155]
    buffer_load_dwordx4 v6, s[8:11], s21 offen lds
    v_mul_f32 v180, v180, v49
    v_exp_f32 v81, v81
    v_mfma_f32_16x16x32_bf16 v[156:159], a[232:235], v[16:19], v[156:159]
    s_waitcnt lgkmcnt(0)
    ds_read_b128 a[232:235], v1 offset:14336
    v_cvt_pk_bf16_f32 v21, v62, v63
    v_mfma_f32_16x16x32_bf16 v[52:55], a[212:215], a[96:99], 0
    ds_read_b128 a[224:227], v1 offset:13312
    v_cvt_pk_bf16_f32 v27, v70, v71
    v_mfma_f32_16x16x32_bf16 v[52:55], a[216:219], a[100:103], v[52:55]
    v_rcp_f32 v51, v51
    v_mfma_f32_16x16x32_bf16 v[52:55], a[220:223], a[104:107], v[52:55]
    ds_read_b128 a[228:231], v0 offset:14336
    v_mul_f32 v184, v184, v49
    v_mfma_f32_16x16x32_bf16 v[60:63], a[220:223], a[128:131], 0
    s_add_u32 s21, s21, 128
    v_bfe_u32 v107, v104, 4, 1
    v_mul_f32 v203, v203, v49
    v_mfma_f32_16x16x32_bf16 v[60:63], a[216:219], a[124:127], v[60:63]
    v_exp_f32 v73, v73
    v_mfma_f32_16x16x32_bf16 v[60:63], a[212:215], a[120:123], v[60:63]
    v_fma_f32 v83, v83, s28, v12
    v_mov_b32 v104, v100
    v_mfma_f32_16x16x32_bf16 v[68:71], a[212:215], a[144:147], 0
    s_nop 0
    v_permlane16_swap_b32 v100, v104
    v_mfma_f32_16x16x32_bf16 v[68:71], a[216:219], a[148:151], v[68:71]
    v_exp_f32 v72, v72
    v_mfma_f32_16x16x32_bf16 v[68:71], a[220:223], a[152:155], v[68:71]
    v_exp_f32 v65, v65
    v_mfma_f32_16x16x32_bf16 v[76:79], a[220:223], a[176:179], 0
    v_cvt_pk_bf16_f32 v16, v56, v57
    v_fma_f32 v74, v74, s28, v11
    v_mfma_f32_16x16x32_bf16 v[76:79], a[216:219], a[172:175], v[76:79]
    s_add_u32 m0, s22, 37888
    v_rcp_f32 v100, v100
    v_cvt_pk_bf16_f32 v23, v66, v67
    v_mul_f32 v199, v199, v49
    v_mfma_f32_16x16x32_bf16 v[76:79], a[212:215], a[168:171], v[76:79]
    s_waitcnt lgkmcnt(1)
    ds_read_b128 a[216:219], v1 offset:18432
    buffer_load_dwordx4 v6, s[8:11], s21 offen lds
    v_mfma_f32_16x16x32_bf16 v[76:79], a[224:227], a[180:183], v[76:79]
    s_waitcnt lgkmcnt(1)
    v_mul_f32 v174, v174, v49
    v_mul_f32 v171, v171, v49
    v_mfma_f32_16x16x32_bf16 v[76:79], a[228:231], a[184:187], v[76:79]
    v_lshl_add_u32 v101, v107, 3, v101
    v_cvt_pk_bf16_f32 v161, v162, v163
    v_mfma_f32_16x16x32_bf16 v[76:79], a[232:235], a[188:191], v[76:79]
    v_mul_f32 v197, v197, v49
    v_mul_f32 v187, v187, v49
    v_mfma_f32_16x16x32_bf16 v[68:71], a[232:235], a[164:167], v[68:71]
    v_exp_f32 v59, v59
    v_mfma_f32_16x16x32_bf16 v[68:71], a[228:231], a[160:163], v[68:71]
    v_exp_f32 v83, v83
    v_mfma_f32_16x16x32_bf16 v[68:71], a[224:227], a[156:159], v[68:71]
    ds_read_b128 a[212:215], v0 offset:18432
    v_cvt_pk_bf16_f32 v17, v58, v59
    v_cvt_pk_bf16_f32 v28, v72, v73
    v_mfma_f32_16x16x32_bf16 v[60:63], a[224:227], a[132:135], v[60:63]
    v_accvgpr_read_b32 v111, a51
    v_mul_f32 v200, v200, v49
    v_mul_f32 v105, v105, v51
    v_mfma_f32_16x16x32_bf16 v[60:63], a[228:231], a[136:139], v[60:63]
    s_add_u32 s21, s21, 128
    v_exp_f32 v75, v75
    v_mfma_f32_16x16x32_bf16 v[60:63], a[232:235], a[140:143], v[60:63]
    v_mul_f32 v196, v196, v49
    v_accvgpr_read_b32 v104, a0
    v_accvgpr_read_b32 v107, a3
    v_mfma_f32_16x16x32_bf16 v[52:55], a[232:235], a[116:119], v[52:55]
    ds_read_b128 a[220:223], v0 offset:19456
    v_mul_f32 v194, v194, v49
    v_exp_f32 v74, v74
    v_mul_f32 v106, v106, v51
    v_pk_mul_f32 v[216:217], v[216:217], v[50:51] op_sel_hi:[1,0]
    v_mul_f32 v188, v188, v49
    v_pk_mul_f32 v[122:123], v[122:123], v[48:49] op_sel_hi:[1,0]
    v_pk_mul_f32 v[116:117], v[116:117], v[48:49] op_sel_hi:[1,0]
    v_accvgpr_read_b32 v109, a49
    v_pk_mul_f32 v[220:221], v[220:221], v[50:51] op_sel_hi:[1,0]
    v_mul_f32 v204, v204, v49
    v_pk_mul_f32 v[214:215], v[214:215], v[50:51] op_sel_hi:[1,0]
    v_pk_mul_f32 v[134:135], v[134:135], v[48:49] op_sel_hi:[1,0]
    v_pk_mul_f32 v[126:127], v[126:127], v[48:49] op_sel_hi:[1,0]
    v_pk_mul_f32 v[112:113], v[112:113], v[48:49] op_sel_hi:[1,0]
    v_pk_mul_f32 v[128:129], v[128:129], v[48:49] op_sel_hi:[1,0]
    v_pk_mul_f32 v[130:131], v[130:131], v[48:49] op_sel_hi:[1,0]
    v_cvt_pk_bf16_f32 v184, v184, v185
    v_pk_mul_f32 v[210:211], v[210:211], v[50:51] op_sel_hi:[1,0]
    v_pk_mul_f32 v[212:213], v[212:213], v[50:51] op_sel_hi:[1,0]
    v_pk_mul_f32 v[108:109], v[108:109], v[100:101] op_sel_hi:[1,0]
    v_mul_f32 v193, v193, v49
    v_mul_f32 v104, v104, v51
    v_pk_mul_f32 v[114:115], v[114:115], v[48:49] op_sel_hi:[1,0]
    v_mul_f32 v107, v107, v51
    v_pk_mul_f32 v[208:209], v[208:209], v[50:51] op_sel_hi:[1,0]
    v_pk_mul_f32 v[124:125], v[124:125], v[48:49] op_sel_hi:[1,0]
    v_pk_mul_f32 v[118:119], v[118:119], v[48:49] op_sel_hi:[1,0]
    v_pk_mul_f32 v[120:121], v[120:121], v[48:49] op_sel_hi:[1,0]
    v_pk_mul_f32 v[110:111], v[110:111], v[100:101] op_sel_hi:[1,0]
    v_cvt_pk_bf16_f32 v104, v104, v105
    v_cvt_pk_bf16_f32 v35, v82, v83
    v_mfma_f32_16x16x32_bf16 v[52:55], a[228:231], a[112:115], v[52:55]
    v_mul_f32 v183, v183, v49
    v_cvt_pk_bf16_f32 v108, v108, v109
    v_mfma_f32_16x16x32_bf16 v[44:47], a[236:239], v[14:17], 0
    v_fma_f32 v79, v79, s28, v12
    v_mul_f32 v192, v192, v49
    v_cvt_pk_bf16_f32 v109, v110, v111
    v_cvt_pk_bf16_f32 v112, v112, v113
    v_mfma_f32_16x16x32_bf16 v[52:55], a[224:227], a[108:111], v[52:55]
    s_waitcnt lgkmcnt(0)
    ds_read_b128 a[228:231], v0 offset:20480
    v_cvt_pk_bf16_f32 v29, v74, v75
    v_mfma_f32_16x16x32_bf16 v[56:59], a[212:215], a[96:99], 0
    s_add_u32 m0, s22, 38912
    ds_read_b128 a[224:227], v1 offset:19456
    v_fma_f32 v70, v70, s28, v11
    v_cvt_pk_bf16_f32 v22, v64, v65
    v_mfma_f32_16x16x32_bf16 v[56:59], a[216:219], a[100:103], v[56:59]
    ds_read_b128 a[232:235], v1 offset:20480
    v_cvt_pk_bf16_f32 v113, v114, v115
    v_mfma_f32_16x16x32_bf16 v[56:59], a[220:223], a[104:107], v[56:59]
    v_fma_f32 v69, v69, s28, v11
    v_mul_f32 v181, v181, v49
    v_mfma_f32_16x16x32_bf16 v[64:67], a[220:223], a[128:131], 0
    v_mul_f32 v170, v170, v49
    v_fma_f32 v68, v68, s28, v11
    v_fma_f32 v60, v60, s28, v10
    v_mfma_f32_16x16x32_bf16 v[64:67], a[216:219], a[124:127], v[64:67]
    v_cvt_pk_bf16_f32 v34, v80, v81
    v_cvt_pk_bf16_f32 v220, v220, v221
    v_mfma_f32_16x16x32_bf16 v[44:47], a[240:243], v[20:23], v[44:47]
    v_cvt_pk_bf16_f32 v208, v208, v209
    v_fma_f32 v71, v71, s28, v11
    v_mfma_f32_16x16x32_bf16 v[64:67], a[212:215], a[120:123], v[64:67]
    v_cvt_pk_bf16_f32 v209, v210, v211
    v_cvt_pk_bf16_f32 v164, v164, v165
    v_mfma_f32_16x16x32_bf16 v[72:75], a[212:215], a[144:147], 0
    v_fma_f32 v62, v62, s28, v10
    v_accvgpr_read_b32 v110, a54
    v_mfma_f32_16x16x32_bf16 v[72:75], a[216:219], a[148:151], v[72:75]
    buffer_load_dwordx4 v6, s[8:11], s21 offen lds
    v_cvt_pk_bf16_f32 v105, v106, v107
    v_mul_f32 v202, v202, v49
    v_mul_f32 v173, v173, v49
    v_mfma_f32_16x16x32_bf16 v[72:75], a[220:223], a[152:155], v[72:75]
    s_add_u32 s21, s21, 12032
    v_cvt_pk_bf16_f32 v116, v116, v117
    v_accvgpr_read_b32 v107, a7
    v_mfma_f32_16x16x32_bf16 v[80:83], a[220:223], a[176:179], 0
    s_waitcnt vmcnt(6) lgkmcnt(0)
    ds_write2st64_b64 v101, v[112:113], v[160:161] offset0:0 offset1:12
    v_mfma_f32_16x16x32_bf16 v[80:83], a[216:219], a[172:175], v[80:83]
    s_barrier
    ds_write2st64_b64 v101, v[208:209], v[104:105] offset0:24 offset1:36
    v_cvt_pk_bf16_f32 v124, v124, v125
    v_accvgpr_read_b32 v106, a6
    v_mfma_f32_16x16x32_bf16 v[44:47], a[244:247], v[26:29], v[44:47]
    v_cvt_pk_bf16_f32 v172, v172, v173
    v_mul_f32 v176, v176, v49
    v_mfma_f32_16x16x32_bf16 v[80:83], a[212:215], a[168:171], v[80:83]
    v_cvt_pk_bf16_f32 v117, v118, v119
    v_accvgpr_read_b32 v111, a55
    v_fma_f32 v52, v52, s28, v9
    v_mul_f32 v205, v205, v49
    v_mfma_f32_16x16x32_bf16 v[80:83], a[224:227], a[180:183], v[80:83]
    ds_read_b64_tr_b16 a[212:213], v2 offset:0
    v_mul_f32 v178, v178, v49
    v_mul_f32 v169, v169, v49
    v_exp_f32 v79, v79
    v_mfma_f32_16x16x32_bf16 v[80:83], a[228:231], a[184:187], v[80:83]
    ds_write_b64 v101, v[108:109] offset:24576
    v_accvgpr_read_b32 v105, a5
    v_accvgpr_read_b32 v104, a4
    v_pk_mul_f32 v[136:137], v[136:137], v[48:49] op_sel_hi:[1,0]
    v_mul_f32 v107, v107, v51
    v_accvgpr_read_b32 v109, a53
    v_fma_f32 v55, v55, s28, v9
    v_cvt_pk_bf16_f32 v128, v128, v129
    v_pk_mul_f32 v[110:111], v[110:111], v[100:101] op_sel_hi:[1,0]
    v_cvt_pk_bf16_f32 v120, v120, v121
    v_cvt_pk_bf16_f32 v173, v174, v175
    v_accvgpr_read_b32 v108, a52
    v_exp_f32 v52, v52
    v_pk_mul_f32 v[218:219], v[218:219], v[50:51] op_sel_hi:[1,0]
    v_pk_mul_f32 v[108:109], v[108:109], v[100:101] op_sel_hi:[1,0]
    v_mul_f32 v104, v104, v51
    v_cvt_pk_bf16_f32 v129, v130, v131
    v_cvt_pk_bf16_f32 v168, v168, v169
    v_mul_f32 v105, v105, v51
    v_pk_mul_f32 v[146:147], v[146:147], v[48:49] op_sel_hi:[1,0]
    v_pk_mul_f32 v[142:143], v[142:143], v[48:49] op_sel_hi:[1,0]
    v_pk_mul_f32 v[228:229], v[228:229], v[50:51] op_sel_hi:[1,0]
    v_mul_f32 v201, v201, v49
    v_pk_mul_f32 v[250:251], v[250:251], v[50:51] op_sel_hi:[1,0]
    v_pk_mul_f32 v[244:245], v[244:245], v[50:51] op_sel_hi:[1,0]
    v_pk_mul_f32 v[234:235], v[234:235], v[50:51] op_sel_hi:[1,0]
    v_cvt_pk_bf16_f32 v165, v166, v167
    v_cvt_pk_bf16_f32 v104, v104, v105
    v_cvt_pk_bf16_f32 v216, v216, v217
    v_pk_mul_f32 v[132:133], v[132:133], v[48:49] op_sel_hi:[1,0]
    v_cvt_pk_bf16_f32 v212, v212, v213
    v_cvt_pk_bf16_f32 v188, v188, v189
    v_cvt_pk_bf16_f32 v213, v214, v215
    v_mfma_f32_16x16x32_bf16 v[80:83], a[232:235], a[188:191], v[80:83]
    s_add_u32 m0, s22, 12288
    v_fma_f32 v63, v63, s28, v10
    v_cvt_pk_bf16_f32 v176, v176, v177
    v_mfma_f32_16x16x32_bf16 v[72:75], a[232:235], a[164:167], v[72:75]
    ds_read_b64_tr_b16 a[214:215], v2 offset:6144
    v_cvt_pk_bf16_f32 v204, v204, v205
    v_mfma_f32_16x16x32_bf16 v[72:75], a[228:231], a[160:163], v[72:75]
    ds_read_b64_tr_b16 a[216:217], v3 offset:0
    v_cvt_pk_bf16_f32 v108, v108, v109
    v_mfma_f32_16x16x32_bf16 v[72:75], a[224:227], a[156:159], v[72:75]
    ds_read_b64_tr_b16 a[218:219], v3 offset:6144
    v_cvt_pk_bf16_f32 v125, v126, v127
    v_mul_f32 v106, v106, v51
    v_exp_f32 v63, v63
    v_cvt_pk_bf16_f32 v217, v218, v219
    v_mfma_f32_16x16x32_bf16 v[64:67], a[224:227], a[132:135], v[64:67]
    v_cvt_pk_bf16_f32 v192, v192, v193
    v_cvt_pk_bf16_f32 v177, v178, v179
    v_mfma_f32_16x16x32_bf16 v[64:67], a[228:231], a[136:139], v[64:67]
    ds_read_b64_tr_b16 a[220:221], v4 offset:0
    buffer_load_dwordx4 v6, s[4:7], s20 offen lds
    v_xor_b32 v101, 32, v101
    v_cvt_pk_bf16_f32 v105, v106, v107
    v_mfma_f32_16x16x32_bf16 v[64:67], a[232:235], a[140:143], v[64:67]
    s_add_u32 s20, s20, 128
    ds_write2st64_b64 v101, v[116:117], v[164:165] offset0:0 offset1:12
    v_fma_f32 v54, v54, s28, v9
    v_cvt_pk_bf16_f32 v109, v110, v111
    v_pk_mul_f32 v[236:237], v[236:237], v[50:51] op_sel_hi:[1,0]
    v_cvt_pk_bf16_f32 v169, v170, v171
    v_pk_mul_f32 v[224:225], v[224:225], v[50:51] op_sel_hi:[1,0]
    v_accvgpr_read_b32 v111, a59
    v_fma_f32 v53, v53, s28, v9
    v_accvgpr_read_b32 v106, a10
    v_mfma_f32_16x16x32_bf16 v[56:59], a[232:235], a[116:119], v[56:59]
    ds_read_b64_tr_b16 a[234:235], v3 offset:7168
    v_accvgpr_read_b32 v110, a58
    v_mfma_f32_16x16x32_bf16 v[56:59], a[228:231], a[112:115], v[56:59]
    ds_read_b64_tr_b16 a[222:223], v4 offset:6144
    v_mul_f32 v106, v106, v51
    v_cvt_pk_bf16_f32 v132, v132, v133
    v_mfma_f32_16x16x32_bf16 v[56:59], a[224:227], a[108:111], v[56:59]
    s_waitcnt lgkmcnt(4)
    ds_write2st64_b64 v101, v[212:213], v[104:105] offset0:24 offset1:36
    v_fma_f32 v76, v76, s28, v12
    v_mfma_f32_16x16x32_bf16 v[112:115], a[212:215], v[14:17], 0
    ds_read_b64_tr_b16 a[228:229], v2 offset:1024
    v_cvt_pk_bf16_f32 v228, v228, v229
    v_mfma_f32_16x16x32_bf16 v[160:163], a[212:215], v[20:23], 0
    s_add_u32 m0, s22, 13312
    ds_read_b64_tr_b16 a[230:231], v2 offset:7168
    v_fma_f32 v81, v81, s28, v12
    v_mfma_f32_16x16x32_bf16 v[208:211], a[212:215], v[26:29], 0
    ds_write_b64 v101, v[108:109] offset:24576
    v_accvgpr_read_b32 v104, a8
    v_cvt_pk_bf16_f32 v224, v224, v225
    v_pk_mul_f32 v[222:223], v[222:223], v[50:51] op_sel_hi:[1,0]
    v_accvgpr_read_b32 v108, a56
    v_mul_f32 v207, v207, v49
    v_pk_mul_f32 v[230:231], v[230:231], v[50:51] op_sel_hi:[1,0]
    v_pk_mul_f32 v[110:111], v[110:111], v[100:101] op_sel_hi:[1,0]
    v_accvgpr_read_b32 v107, a11
    v_accvgpr_read_b32 v109, a57
    v_cvt_pk_bf16_f32 v236, v236, v237
    v_mfma_f32_16x16x32_bf16 v[44:47], a[248:251], v[32:35], v[44:47]
    buffer_load_dwordx4 v6, s[4:7], s20 offen lds
    ds_read_b64_tr_b16 a[224:225], v5 offset:0
    v_exp_f32 v69, v69
    v_fma_f32 v66, v66, s28, v10
    v_pk_mul_f32 v[108:109], v[108:109], v[100:101] op_sel_hi:[1,0]
    v_accvgpr_read_b32 v105, a9
    v_fma_f32 v61, v61, s28, v10
    v_cvt_pk_bf16_f32 v185, v186, v187
    v_cvt_pk_bf16_f32 v108, v108, v109
    v_cvt_pk_bf16_f32 v109, v110, v111
    v_fma_f32 v83, v83, s28, v12
    v_exp_f32 v62, v62
    v_cvt_pk_bf16_f32 v121, v122, v123
    v_fma_f32 v57, v57, s28, v9
    v_exp_f32 v61, v61
    v_cvt_pk_bf16_f32 v189, v190, v191
    v_cvt_pk_bf16_f32 v229, v230, v231
    v_exp_f32 v54, v54
    v_fma_f32 v75, v75, s28, v11
    v_pk_mul_f32 v[240:241], v[240:241], v[50:51] op_sel_hi:[1,0]
    v_cvt_pk_bf16_f32 v196, v196, v197
    v_mul_f32 v104, v104, v51
    v_mul_f32 v105, v105, v51
    v_cvt_pk_bf16_f32 v180, v180, v181
    v_xor_b32 v101, 96, v101
    v_mfma_f32_16x16x32_bf16 a[0:3], a[212:215], v[32:35], 0
    ds_read_b64_tr_b16 a[226:227], v5 offset:6144
    v_exp_f32 v70, v70
    v_fma_f32 v65, v65, s28, v10
    v_cvt_pk_bf16_f32 v104, v104, v105
    v_pk_mul_f32 v[152:153], v[152:153], v[48:49] op_sel_hi:[1,0]
    v_accvgpr_read_b32 v110, a62
    v_cvt_pk_bf16_f32 v25, v62, v63
    v_fma_f32 v78, v78, s28, v12
    v_mul_f32 v107, v107, v51
    v_pk_mul_f32 v[238:239], v[238:239], v[50:51] op_sel_hi:[1,0]
    v_subrev_u32 v8, 28672, v8
    v_cvt_pk_bf16_f32 v105, v106, v107
    v_mfma_f32_16x16x32_bf16 a[4:7], a[216:219], v[32:35], 0
    s_add_u32 s20, s20, 128
    ds_write2st64_b64 v101, v[120:121], v[168:169] offset0:0 offset1:12
    v_mfma_f32_16x16x32_bf16 v[212:215], a[216:219], v[26:29], 0
    ds_write2st64_b64 v101, v[216:217], v[104:105] offset0:24 offset1:36
    v_accvgpr_read_b32 v104, a12
    v_accvgpr_read_b32 v111, a63
    v_mfma_f32_16x16x32_bf16 v[164:167], a[216:219], v[20:23], 0
    ds_read_b64_tr_b16 a[232:233], v3 offset:1024
    ds_read_b64_tr_b16 a[214:215], v4 offset:7168
    v_accvgpr_read_b32 v106, a14
    v_fma_f32 v56, v56, s28, v9
    v_cvt_pk_bf16_f32 v244, v244, v245
    v_mfma_f32_16x16x32_bf16 v[116:119], a[216:219], v[14:17], 0
    s_waitcnt lgkmcnt(5)
    ds_read_b64_tr_b16 a[212:213], v4 offset:1024
    ds_read_b64_tr_b16 a[216:217], v5 offset:1024
    v_exp_f32 v55, v55
    v_mfma_f32_16x16x32_bf16 v[120:123], a[220:223], v[14:17], 0
    s_add_u32 m0, s22, 14336
    ds_write_b64 v101, v[108:109] offset:24576
    v_mul_f32 v198, v198, v49
    v_accvgpr_read_b32 v105, a13
    v_pk_mul_f32 v[156:157], v[156:157], v[48:49] op_sel_hi:[1,0]
    v_pk_mul_f32 v[254:255], v[254:255], v[50:51] op_sel_hi:[1,0]
    v_exp_f32 v66, v66
    v_pk_mul_f32 v[148:149], v[148:149], v[48:49] op_sel_hi:[1,0]
    v_cvt_pk_bf16_f32 v136, v136, v137
    v_pk_mul_f32 v[144:145], v[144:145], v[48:49] op_sel_hi:[1,0]
    v_exp_f32 v68, v68
    v_mul_f32 v106, v106, v51
    v_accvgpr_read_b32 v107, a15
    v_pk_mul_f32 v[232:233], v[232:233], v[50:51] op_sel_hi:[1,0]
    v_cvt_pk_bf16_f32 v221, v222, v223
    v_cvt_pk_bf16_f32 v197, v198, v199
    v_xor_b32 v101, 32, v101
    v_mul_f32 v104, v104, v51
    v_pk_mul_f32 v[140:141], v[140:141], v[48:49] op_sel_hi:[1,0]
    v_pk_mul_f32 v[226:227], v[226:227], v[50:51] op_sel_hi:[1,0]
    v_pk_mul_f32 v[246:247], v[246:247], v[50:51] op_sel_hi:[1,0]
    v_mul_f32 v105, v105, v51
    v_accvgpr_read_b32 v109, a61
    v_mul_f32 v107, v107, v51
    v_cvt_pk_bf16_f32 v104, v104, v105
    v_pk_mul_f32 v[110:111], v[110:111], v[100:101] op_sel_hi:[1,0]
    v_pk_mul_f32 v[248:249], v[248:249], v[50:51] op_sel_hi:[1,0]
    v_accvgpr_read_b32 v108, a60
    v_cvt_pk_bf16_f32 v105, v106, v107
    v_cvt_pk_bf16_f32 v181, v182, v183
    v_accvgpr_read_b32 v106, a18
    v_mfma_f32_16x16x32_bf16 v[168:171], a[220:223], v[20:23], 0
    ds_write2st64_b64 v101, v[124:125], v[172:173] offset0:0 offset1:12
    v_cvt_pk_bf16_f32 v232, v232, v233
    v_pk_mul_f32 v[108:109], v[108:109], v[100:101] op_sel_hi:[1,0]
    v_pk_mul_f32 v[242:243], v[242:243], v[50:51] op_sel_hi:[1,0]
    v_cvt_pk_bf16_f32 v108, v108, v109
    v_accvgpr_read_b32 v107, a19
    v_cvt_pk_bf16_f32 v109, v110, v111
    v_mfma_f32_16x16x32_bf16 v[216:219], a[220:223], v[26:29], 0
    buffer_load_dwordx4 v6, s[4:7], s20 offen lds
    ds_write2st64_b64 v101, v[220:221], v[104:105] offset0:24 offset1:36
    v_cvt_pk_bf16_f32 v248, v248, v249
    v_accvgpr_read_b32 v104, a16
    v_cvt_pk_bf16_f32 v225, v226, v227
    v_mul_f32 v104, v104, v51
    v_mul_f32 v107, v107, v51
    v_accvgpr_read_b32 v105, a17
    v_mfma_f32_16x16x32_bf16 a[8:11], a[220:223], v[32:35], 0
    s_waitcnt lgkmcnt(2)
    ds_write_b64 v101, v[108:109] offset:24576
    v_mfma_f32_16x16x32_bf16 a[12:15], a[224:227], v[32:35], 0
    ds_read_b128 v[96:99], v8 offset:0
    v_mul_f32 v105, v105, v51
    v_accvgpr_read_b32 v111, a67
    v_fma_f32 v74, v74, s28, v11
    v_accvgpr_read_b32 v110, a66
    v_accvgpr_read_b32 v109, a65
    v_cvt_pk_bf16_f32 v104, v104, v105
    v_cvt_pk_bf16_f32 v237, v238, v239
    v_pk_mul_f32 v[110:111], v[110:111], v[100:101] op_sel_hi:[1,0]
    v_accvgpr_read_b32 v108, a64
    v_mul_f32 v106, v106, v51
    v_cvt_pk_bf16_f32 v240, v240, v241
    v_xor_b32 v101, 96, v101
    v_pk_mul_f32 v[108:109], v[108:109], v[100:101] op_sel_hi:[1,0]
    v_cvt_pk_bf16_f32 v105, v106, v107
    v_cvt_pk_bf16_f32 v233, v234, v235
    v_pk_mul_f32 v[150:151], v[150:151], v[48:49] op_sel_hi:[1,0]
    v_cvt_pk_bf16_f32 v108, v108, v109
    v_cvt_pk_bf16_f32 v109, v110, v111
    v_accvgpr_read_b32 v107, a23
    v_mfma_f32_16x16x32_bf16 v[220:223], a[224:227], v[26:29], 0
    ds_write2st64_b64 v101, v[128:129], v[176:177] offset0:4 offset1:16
    v_mfma_f32_16x16x32_bf16 v[172:175], a[224:227], v[20:23], 0
    ds_read_b64_tr_b16 a[218:219], v5 offset:7168
    ds_write2st64_b64 v101, v[224:225], v[104:105] offset0:28 offset1:40
    v_mul_f32 v107, v107, v51
    v_mfma_f32_16x16x32_bf16 v[124:127], a[224:227], v[14:17], 0
    s_add_u32 s20, s20, 12032
    ds_write_b64 v101, v[108:109] offset:26624
    v_accvgpr_read_b32 v104, a20
    v_exp_f32 v78, v78
    v_cvt_pk_bf16_f32 v133, v134, v135
    v_accvgpr_read_b32 v106, a22
    v_pk_mul_f32 v[252:253], v[252:253], v[50:51] op_sel_hi:[1,0]
    v_accvgpr_read_b32 v111, a71
    v_mul_f32 v106, v106, v51
    v_cvt_pk_bf16_f32 v245, v246, v247
    v_accvgpr_read_b32 v110, a70
    v_exp_f32 v53, v53
    v_xor_b32 v101, 32, v101
    v_accvgpr_read_b32 v105, a21
    v_accvgpr_read_b32 v108, a68
    v_mul_f32 v104, v104, v51
    v_exp_f32 v81, v81
    v_mfma_f32_16x16x32_bf16 v[128:131], a[228:231], v[14:17], 0
    s_waitcnt lgkmcnt(3)
    buffer_store_dwordx4 v[96:99], v102, s[16:19], s67 offen offset:0 nt
    ds_write2st64_b64 v101, v[132:133], v[180:181] offset0:4 offset1:16
    v_accvgpr_read_b32 v109, a69
    v_pk_mul_f32 v[154:155], v[154:155], v[48:49] op_sel_hi:[1,0]
    v_pk_mul_f32 v[138:139], v[138:139], v[48:49] op_sel_hi:[1,0]
    v_mul_f32 v105, v105, v51
    v_cvt_pk_bf16_f32 v104, v104, v105
    v_pk_mul_f32 v[110:111], v[110:111], v[100:101] op_sel_hi:[1,0]
    v_pk_mul_f32 v[108:109], v[108:109], v[100:101] op_sel_hi:[1,0]
    v_cvt_pk_bf16_f32 v193, v194, v195
    v_cvt_pk_bf16_f32 v108, v108, v109
    v_cvt_pk_bf16_f32 v105, v106, v107
    v_cvt_pk_bf16_f32 v109, v110, v111
    v_mfma_f32_16x16x32_bf16 v[176:179], a[228:231], v[20:23], 0
    s_add_u32 s56, s67, 6144
    ds_read_b128 v[88:91], v8 offset:6144
    v_exp_f32 v71, v71
    v_mfma_f32_16x16x32_bf16 v[224:227], a[228:231], v[26:29], 0
    s_add_u32 s58, s33, 6144
    ds_read_b64_tr_b16 a[226:227], v3 offset:8192
    ds_read_b64_tr_b16 a[220:221], v2 offset:2048
    ds_read_b128 v[84:87], v8 offset:1024
    v_accvgpr_read_b32 v106, a26
    v_cvt_pk_bf16_f32 v140, v140, v141
    v_accvgpr_read_b32 v111, a75
    v_accvgpr_read_b32 v110, a74
    v_mfma_f32_16x16x32_bf16 a[16:19], a[228:231], v[32:35], 0
    s_add_u32 m0, s38, 6144
    ds_write2st64_b64 v101, v[228:229], v[104:105] offset0:28 offset1:40
    v_mfma_f32_16x16x32_bf16 a[20:23], a[232:235], v[32:35], 0
    ds_write_b64 v101, v[108:109] offset:26624
    v_accvgpr_read_b32 v104, a24
    v_accvgpr_read_b32 v108, a72
    v_accvgpr_read_b32 v107, a27
    v_xor_b32 v101, 96, v101
    v_mul_f32 v104, v104, v51
    v_cvt_pk_bf16_f32 v200, v200, v201
    v_pk_mul_f32 v[110:111], v[110:111], v[100:101] op_sel_hi:[1,0]
    v_accvgpr_read_b32 v109, a73
    v_exp_f32 v83, v83
    v_cvt_pk_bf16_f32 v152, v152, v153
    v_mul_f32 v106, v106, v51
    v_accvgpr_read_b32 v105, a25
    v_pk_mul_f32 v[108:109], v[108:109], v[100:101] op_sel_hi:[1,0]
    v_mul_f32 v105, v105, v51
    v_cvt_pk_bf16_f32 v108, v108, v109
    v_cvt_pk_bf16_f32 v109, v110, v111
    v_cvt_pk_bf16_f32 v104, v104, v105
    v_fma_f32 v82, v82, s28, v12
    v_mul_f32 v107, v107, v51
    v_accvgpr_read_b32 v111, a79
    v_mfma_f32_16x16x32_bf16 v[228:231], a[232:235], v[26:29], 0
    ds_read_b128 v[96:99], v8 offset:7168
    v_cvt_pk_bf16_f32 v249, v250, v251
    v_cvt_pk_bf16_f32 v137, v138, v139
    v_mfma_f32_16x16x32_bf16 v[180:183], a[232:235], v[20:23], 0
    s_waitcnt lgkmcnt(3)
    ds_read_b64_tr_b16 a[230:231], v4 offset:8192
    buffer_load_dwordx4 v6, s[12:15], s58 offen nt lds
    ds_write2st64_b64 v101, v[136:137], v[184:185] offset0:4 offset1:16
    v_accvgpr_read_b32 v110, a78
    v_cvt_pk_bf16_f32 v105, v106, v107
    v_mfma_f32_16x16x32_bf16 v[132:135], a[232:235], v[14:17], 0
    ds_read_b64_tr_b16 a[222:223], v2 offset:8192
    ds_write2st64_b64 v101, v[232:233], v[104:105] offset0:28 offset1:40
    v_mfma_f32_16x16x32_bf16 v[136:139], a[212:215], v[14:17], 0
    buffer_store_dwordx4 v[84:87], v103, s[16:19], s67 offen offset:0 nt
    s_add_u32 m0, s38, 7168
    ds_write_b64 v101, v[108:109] offset:26624
    v_cvt_pk_bf16_f32 v141, v142, v143
    v_cvt_pk_bf16_f32 v144, v144, v145
    v_accvgpr_read_b32 v104, a28
    v_fma_f32 v64, v64, s28, v10
    v_accvgpr_read_b32 v105, a29
    v_accvgpr_read_b32 v109, a77
    v_mul_f32 v206, v206, v49
    v_mul_f32 v105, v105, v51
    v_mfma_f32_16x16x32_bf16 v[184:187], a[212:215], v[20:23], 0
    ds_read_b64_tr_b16 a[228:229], v4 offset:2048
    ds_read_b64_tr_b16 a[232:233], v5 offset:2048
    v_accvgpr_read_b32 v106, a30
    v_mul_f32 v106, v106, v51
    v_mfma_f32_16x16x32_bf16 v[232:235], a[212:215], v[26:29], 0
    s_waitcnt lgkmcnt(5)
    ds_read_b64_tr_b16 a[224:225], v3 offset:2048
    ds_read_b64_tr_b16 a[234:235], v5 offset:8192
    buffer_load_dwordx4 v7, s[12:15], s58 offen nt lds
    v_mul_f32 v104, v104, v51
    v_cvt_pk_bf16_f32 v104, v104, v105
    v_accvgpr_read_b32 v108, a76
    v_accvgpr_read_b32 v107, a31
    v_mul_f32 v107, v107, v51
    v_cvt_pk_bf16_f32 v105, v106, v107
    v_pk_mul_f32 v[108:109], v[108:109], v[100:101] op_sel_hi:[1,0]
    v_cvt_pk_bf16_f32 v145, v146, v147
    v_xor_b32 v101, 32, v101
    v_mfma_f32_16x16x32_bf16 a[24:27], a[212:215], v[32:35], 0
    s_add_u32 s39, s39, 12288
    ds_write2st64_b64 v101, v[140:141], v[188:189] offset0:4 offset1:16
    v_pk_mul_f32 v[110:111], v[110:111], v[100:101] op_sel_hi:[1,0]
    v_cvt_pk_bf16_f32 v108, v108, v109
    v_accvgpr_read_b32 v107, a35
    v_accvgpr_read_b32 v106, a34
    v_mfma_f32_16x16x32_bf16 a[28:31], a[216:219], v[32:35], 0
    ds_write2st64_b64 v101, v[236:237], v[104:105] offset0:28 offset1:40
    v_fma_f32 v67, v67, s28, v10
    v_cvt_pk_bf16_f32 v109, v110, v111
    v_cvt_pk_bf16_f32 v148, v148, v149
    v_mfma_f32_16x16x32_bf16 v[236:239], a[216:219], v[26:29], 0
    ds_write_b64 v101, v[108:109] offset:26624
    v_cvt_pk_bf16_f32 v156, v156, v157
    v_accvgpr_read_b32 v105, a33
    v_mul_f32 v106, v106, v51
    v_cvt_pk_bf16_f32 v205, v206, v207
    v_xor_b32 v101, 96, v101
    v_accvgpr_read_b32 v110, a82
    s_waitcnt vmcnt(10) lgkmcnt(3)
    buffer_store_dwordx4 v[88:91], v102, s[16:19], s56 offen offset:0 nt
    s_barrier
    v_cvt_pk_bf16_f32 v153, v154, v155
    v_accvgpr_read_b32 v109, a81
    v_accvgpr_read_b32 v108, a80
    v_mul_f32 v105, v105, v51
    v_accvgpr_read_b32 v104, a32
    v_mul_f32 v104, v104, v51
    v_cvt_pk_bf16_f32 v241, v242, v243
    v_cvt_pk_bf16_f32 v104, v104, v105
    v_mfma_f32_16x16x32_bf16 v[188:191], a[216:219], v[20:23], 0
    ds_write2st64_b64 v101, v[144:145], v[192:193] offset0:8 offset1:20
    v_mul_f32 v107, v107, v51
    v_cvt_pk_bf16_f32 v105, v106, v107
    v_accvgpr_read_b32 v111, a83
    v_mfma_f32_16x16x32_bf16 v[140:143], a[216:219], v[14:17], 0
    s_add_u32 m0, s22, 24576
    ds_write2st64_b64 v101, v[240:241], v[104:105] offset0:32 offset1:44
    v_pk_mul_f32 v[108:109], v[108:109], v[100:101] op_sel_hi:[1,0]
    v_pk_mul_f32 v[110:111], v[110:111], v[100:101] op_sel_hi:[1,0]
    v_cvt_pk_bf16_f32 v252, v252, v253
    v_cvt_pk_bf16_f32 v149, v150, v151
    v_cvt_pk_bf16_f32 v108, v108, v109
    v_accvgpr_read_b32 v107, a39
    v_pk_mul_f32 v[158:159], v[158:159], v[48:49] op_sel_hi:[1,0]
    v_exp_f32 v76, v76
    v_exp_f32 v60, v60
    v_mul_f32 v107, v107, v51
    v_cvt_pk_bf16_f32 v109, v110, v111
    v_accvgpr_read_b32 v105, a37
    v_mul_f32 v105, v105, v51
    v_accvgpr_read_b32 v104, a36
    v_accvgpr_read_b32 v106, a38
    v_mul_f32 v106, v106, v51
    v_fma_f32 v58, v58, s28, v9
    v_fma_f32 v77, v77, s28, v12
    v_mfma_f32_16x16x32_bf16 v[144:147], a[220:223], v[14:17], 0
    buffer_load_dwordx4 v6, s[8:11], s21 offen lds
    ds_write_b64 v101, v[108:109] offset:0
    v_xor_b32 v101, 32, v101
    v_mul_f32 v104, v104, v51
    v_cvt_pk_bf16_f32 v104, v104, v105
    v_cvt_pk_bf16_f32 v201, v202, v203
    v_cvt_pk_bf16_f32 v18, v52, v53
    v_mfma_f32_16x16x32_bf16 v[192:195], a[220:223], v[20:23], 0
    ds_write2st64_b64 v101, v[148:149], v[196:197] offset0:8 offset1:20
    v_accvgpr_read_b32 v110, a86
    v_cvt_pk_bf16_f32 v105, v106, v107
    v_accvgpr_read_b32 v111, a87
    v_mfma_f32_16x16x32_bf16 v[240:243], a[220:223], v[26:29], 0
    ds_write2st64_b64 v101, v[244:245], v[104:105] offset0:32 offset1:44
    v_accvgpr_read_b32 v104, a40
    v_accvgpr_read_b32 v108, a84
    v_accvgpr_read_b32 v105, a41
    v_pk_mul_f32 v[110:111], v[110:111], v[100:101] op_sel_hi:[1,0]
    v_mul_f32 v104, v104, v51
    v_fma_f32 v80, v80, s28, v12
    v_cvt_pk_bf16_f32 v19, v54, v55
    v_fma_f32 v59, v59, s28, v9
    v_exp_f32 v57, v57
    v_exp_f32 v56, v56
    v_accvgpr_read_b32 v109, a85
    v_accvgpr_read_b32 v107, a43
    v_mul_f32 v107, v107, v51
    v_mul_f32 v105, v105, v51
    v_accvgpr_read_b32 v106, a42
    v_pk_mul_f32 v[108:109], v[108:109], v[100:101] op_sel_hi:[1,0]
    v_mul_f32 v106, v106, v51
    v_cvt_pk_bf16_f32 v108, v108, v109
    v_cvt_pk_bf16_f32 v109, v110, v111
    v_cvt_pk_bf16_f32 v104, v104, v105
    v_mfma_f32_16x16x32_bf16 a[32:35], a[220:223], v[32:35], 0
    s_add_u32 s21, s21, 128
    ds_write_b64 v101, v[108:109] offset:0
    v_accvgpr_read_b32 v109, a89
    v_mfma_f32_16x16x32_bf16 a[36:39], a[224:227], v[32:35], 0
    ds_read_b128 a[212:215], v0 offset:0
    v_cvt_pk_bf16_f32 v105, v106, v107
    v_exp_f32 v74, v74
    v_mfma_f32_16x16x32_bf16 v[244:247], a[224:227], v[26:29], 0
    ds_read_b128 a[216:219], v1 offset:0
    v_accvgpr_read_b32 v110, a90
    v_xor_b32 v101, 96, v101
    v_cvt_pk_bf16_f32 v157, v158, v159
    v_mfma_f32_16x16x32_bf16 v[196:199], a[224:227], v[20:23], 0
    s_add_u32 m0, s22, 25600
    ds_read_b128 v[88:91], v8 offset:3072
    ds_read_b128 a[220:223], v0 offset:1024
    v_mfma_f32_16x16x32_bf16 v[148:151], a[224:227], v[14:17], 0
    ds_write2st64_b64 v101, v[152:153], v[200:201] offset0:8 offset1:20
    v_mfma_f32_16x16x32_bf16 v[152:155], a[228:231], v[14:17], 0
    buffer_load_dwordx4 v6, s[8:11], s21 offen lds
    ds_write2st64_b64 v101, v[248:249], v[104:105] offset0:32 offset1:44
    v_mfma_f32_16x16x32_bf16 v[200:203], a[228:231], v[20:23], 0
    s_add_u32 s21, s21, 128
    ds_read_b128 v[84:87], v8 offset:2048
    v_accvgpr_read_b32 v106, a46
    v_accvgpr_read_b32 v104, a44
    v_accvgpr_read_b32 v108, a88
    v_accvgpr_read_b32 v107, a47
    v_mul_f32 v106, v106, v51
    v_pk_mul_f32 v[108:109], v[108:109], v[100:101] op_sel_hi:[1,0]
    v_accvgpr_read_b32 v105, a45
    v_mul_f32 v107, v107, v51
    v_accvgpr_read_b32 v111, a91
    v_fma_f32 v72, v72, s28, v11
    v_cvt_pk_bf16_f32 v24, v60, v61
    v_mul_f32 v105, v105, v51
    v_mul_f32 v104, v104, v51
    v_cvt_pk_bf16_f32 v108, v108, v109
    v_cvt_pk_bf16_f32 v37, v78, v79
    v_pk_mul_f32 v[110:111], v[110:111], v[100:101] op_sel_hi:[1,0]
    v_exp_f32 v77, v77
    v_cvt_pk_bf16_f32 v253, v254, v255
    v_cvt_pk_bf16_f32 v104, v104, v105
    v_cvt_pk_bf16_f32 v109, v110, v111
    v_mfma_f32_16x16x32_bf16 v[248:251], a[228:231], v[26:29], 0
    ds_write_b64 v101, v[108:109] offset:0
    v_xor_b32 v101, 32, v101
    v_cvt_pk_bf16_f32 v105, v106, v107
    v_mfma_f32_16x16x32_bf16 a[40:43], a[228:231], v[32:35], 0
    ds_write2st64_b64 v101, v[156:157], v[204:205] offset0:8 offset1:20
    v_mfma_f32_16x16x32_bf16 a[44:47], a[232:235], v[32:35], 0
    s_add_u32 m0, s22, 26624
    ds_write2st64_b64 v101, v[252:253], v[104:105] offset0:32 offset1:44
    v_mfma_f32_16x16x32_bf16 v[252:255], a[232:235], v[26:29], 0
    buffer_load_dwordx4 v6, s[8:11], s21 offen lds
    v_mfma_f32_16x16x32_bf16 v[204:207], a[232:235], v[20:23], 0
    buffer_store_dwordx4 v[96:99], v103, s[16:19], s56 offen offset:0 nt
    s_add_u32 s21, s21, 12032
    s_add_u32 s56, s67, 128
    ds_read_b128 v[96:99], v8 offset:8192
    v_cvt_pk_bf16_f32 v31, v70, v71
    v_exp_f32 v72, v72
    v_mfma_f32_16x16x32_bf16 v[156:159], a[232:235], v[14:17], 0
    s_waitcnt lgkmcnt(4)
    ds_read_b128 a[224:227], v1 offset:1024
    v_accvgpr_read_b32 v109, a93
    v_mfma_f32_16x16x32_bf16 v[52:55], a[212:215], a[96:99], 0
    s_add_u32 s58, s33, 128
    ds_read_b128 a[232:235], v1 offset:2048
    v_cvt_pk_bf16_f32 v36, v76, v77
    v_mfma_f32_16x16x32_bf16 v[52:55], a[216:219], a[100:103], v[52:55]
    s_add_u32 m0, s38, 2048
    v_cvt_pk_bf16_f32 v30, v68, v69
    v_accvgpr_read_b32 v110, a94
    v_mfma_f32_16x16x32_bf16 v[52:55], a[220:223], a[104:107], v[52:55]
    buffer_load_dwordx4 v6, s[12:15], s58 offen nt lds
    v_mfma_f32_16x16x32_bf16 v[60:63], a[220:223], a[128:131], 0
    buffer_store_dwordx4 v[84:87], v102, s[16:19], s56 offen offset:0 nt
    s_add_u32 m0, s38, 3072
    ds_read_b128 v[84:87], v8 offset:9216
    v_exp_f32 v59, v59
    v_mfma_f32_16x16x32_bf16 v[60:63], a[216:219], a[124:127], v[60:63]
    v_exp_f32 v75, v75
    v_mfma_f32_16x16x32_bf16 v[60:63], a[212:215], a[120:123], v[60:63]
    buffer_load_dwordx4 v7, s[12:15], s58 offen nt lds
    ds_read_b128 a[228:231], v0 offset:2048
    v_mfma_f32_16x16x32_bf16 v[68:71], a[212:215], a[144:147], 0
    v_accvgpr_read_b32 v108, a92
    v_fma_f32 v73, v73, s28, v11
    v_mfma_f32_16x16x32_bf16 v[68:71], a[216:219], a[148:151], v[68:71]
    buffer_store_dwordx4 v[88:91], v103, s[16:19], s56 offen offset:0 nt
    s_nop 0
    ds_read_b128 v[88:91], v8 offset:4096
    v_pk_mul_f32 v[108:109], v[108:109], v[100:101] op_sel_hi:[1,0]
    v_cvt_pk_bf16_f32 v29, v74, v75
    v_accvgpr_read_b32 v111, a95
    v_mfma_f32_16x16x32_bf16 v[68:71], a[220:223], a[152:155], v[68:71]
    s_add_u32 s57, s67, 6272
    v_exp_f32 v73, v73
    v_mfma_f32_16x16x32_bf16 v[76:79], a[220:223], a[176:179], 0
    v_exp_f32 v82, v82
    v_mfma_f32_16x16x32_bf16 v[76:79], a[216:219], a[172:175], v[76:79]
    s_waitcnt lgkmcnt(3)
    buffer_store_dwordx4 v[96:99], v102, s[16:19], s57 offen offset:0 nt
    v_pk_mul_f32 v[110:111], v[110:111], v[100:101] op_sel_hi:[1,0]
    v_exp_f32 v65, v65
    v_cvt_pk_bf16_f32 v16, v56, v57
    v_mfma_f32_16x16x32_bf16 v[76:79], a[212:215], a[168:171], v[76:79]
    s_add_u32 s59, s33, 6272
    v_exp_f32 v67, v67
    v_mfma_f32_16x16x32_bf16 v[76:79], a[224:227], a[180:183], v[76:79]
    s_waitcnt lgkmcnt(1)
    ds_read_b128 a[216:219], v1 offset:6144
    v_cvt_pk_bf16_f32 v108, v108, v109
    v_mfma_f32_16x16x32_bf16 v[76:79], a[228:231], a[184:187], v[76:79]
    s_add_u32 m0, s38, 8192
    v_exp_f32 v64, v64
    v_mfma_f32_16x16x32_bf16 v[76:79], a[232:235], a[188:191], v[76:79]
    buffer_load_dwordx4 v6, s[12:15], s59 offen nt lds
    v_mfma_f32_16x16x32_bf16 v[68:71], a[232:235], a[164:167], v[68:71]
    s_add_u32 m0, s38, 9216
    v_exp_f32 v58, v58
    v_mfma_f32_16x16x32_bf16 v[68:71], a[228:231], a[160:163], v[68:71]
    buffer_load_dwordx4 v7, s[12:15], s59 offen nt lds
    ds_read_b128 a[212:215], v0 offset:6144
    v_mfma_f32_16x16x32_bf16 v[68:71], a[224:227], a[156:159], v[68:71]
    s_add_u32 s56, s67, 256
    ds_read_b128 v[96:99], v8 offset:5120
    v_cvt_pk_bf16_f32 v109, v110, v111
    v_mfma_f32_16x16x32_bf16 v[60:63], a[224:227], a[132:135], v[60:63]
    buffer_store_dwordx4 v[84:87], v103, s[16:19], s57 offen offset:0 nt
    s_add_u32 s58, s33, 256
    s_add_u32 m0, s38, 4096
    ds_write_b64 v101, v[108:109] offset:0
    v_mfma_f32_16x16x32_bf16 v[60:63], a[228:231], a[136:139], v[60:63]
    ds_read_b128 a[220:223], v0 offset:7168
    v_cvt_pk_bf16_f32 v17, v58, v59
    v_mfma_f32_16x16x32_bf16 v[60:63], a[232:235], a[140:143], v[60:63]
    s_waitcnt lgkmcnt(5)
    ds_read_b128 v[84:87], v8 offset:0
    buffer_load_dwordx4 v6, s[12:15], s58 offen nt lds
    v_mfma_f32_16x16x32_bf16 v[52:55], a[232:235], a[116:119], v[52:55]
    buffer_store_dwordx4 v[88:91], v102, s[16:19], s56 offen offset:0 nt
    s_add_u32 m0, s38, 5120
    ds_read_b128 v[88:91], v8 offset:1024
    v_cvt_pk_bf16_f32 v28, v72, v73
    v_cvt_pk_bf16_f32 v23, v66, v67
    v_mfma_f32_16x16x32_bf16 v[48:51], a[236:239], v[16:19], v[44:47]
    v_exp_f32 v80, v80
    v_mfma_f32_16x16x32_bf16 v[52:55], a[228:231], a[112:115], v[52:55]
    v_cvt_pk_bf16_f32 v22, v64, v65
    v_cvt_pk_bf16_f32 v35, v82, v83
    v_mfma_f32_16x16x32_bf16 v[52:55], a[224:227], a[108:111], v[52:55]
    s_waitcnt lgkmcnt(4)
    ds_read_b128 a[232:235], v1 offset:8192
    v_add_u32 v8, 10240, v8
    v_mfma_f32_16x16x32_bf16 v[56:59], a[212:215], a[96:99], 0
    buffer_load_dwordx4 v7, s[12:15], s58 offen nt lds
    v_mfma_f32_16x16x32_bf16 v[48:51], a[240:243], v[22:25], v[48:51]
    ds_read_b128 a[224:227], v1 offset:7168
    v_cvt_pk_bf16_f32 v34, v80, v81
    v_mfma_f32_16x16x32_bf16 v[48:51], a[244:247], v[28:31], v[48:51]
    ds_read_b128 a[228:231], v0 offset:8192
    v_mfma_f32_16x16x32_bf16 v[48:51], a[248:251], v[34:37], v[48:51]
    buffer_store_dwordx4 v[96:99], v103, s[16:19], s56 offen offset:0 nt
    v_mfma_f32_16x16x32_bf16 v[56:59], a[216:219], a[100:103], v[56:59]
    s_add_u32 s57, s67, 24832
    s_add_u32 m0, s38, 0
    s_waitcnt lgkmcnt(3)
    v_mfma_f32_16x16x32_bf16 v[56:59], a[220:223], a[104:107], v[56:59]
    buffer_load_dwordx4 v6, s[12:15], s33 offen nt lds
    v_mfma_f32_16x16x32_bf16 v[64:67], a[220:223], a[128:131], 0
    v_cmp_lt_f32 vcc, s29, v48
    s_add_u32 m0, s38, 1024
    v_mfma_f32_16x16x32_bf16 v[64:67], a[216:219], a[124:127], v[64:67]
    buffer_store_dwordx4 v[84:87], v102, s[16:19], s57 offen offset:0 nt
    s_nop 1
    s_cbranch_vccnz L_rs_tr54d
L_ret_tr54d:
    v_fma_f32 v61, v61, s28, v10
    v_mfma_f32_16x16x32_bf16 v[64:67], a[212:215], a[120:123], v[64:67]
    v_fma_f32 v54, v54, s28, v9
    v_fma_f32 v60, v60, s28, v10
    v_mfma_f32_16x16x32_bf16 v[72:75], a[212:215], a[144:147], 0
    buffer_load_dwordx4 v7, s[12:15], s33 offen nt lds
    v_mfma_f32_16x16x32_bf16 v[72:75], a[216:219], a[148:151], v[72:75]
    buffer_store_dwordx4 v[88:91], v103, s[16:19], s57 offen offset:0 nt
    s_waitcnt vmcnt(28) lgkmcnt(0)
    s_barrier
    v_fma_f32 v55, v55, s28, v9
    v_mfma_f32_16x16x32_bf16 v[72:75], a[220:223], a[152:155], v[72:75]
    s_add_u32 m0, s22, 0
    v_exp_f32 v60, v60
    v_mfma_f32_16x16x32_bf16 v[80:83], a[220:223], a[176:179], 0
    v_exp_f32 v61, v61
    v_mfma_f32_16x16x32_bf16 v[80:83], a[216:219], a[172:175], v[80:83]
    buffer_load_dwordx4 v6, s[4:7], s20 offen lds
    v_mfma_f32_16x16x32_bf16 v[80:83], a[212:215], a[168:171], v[80:83]
    ds_read_b64_tr_b16 a[212:213], v2 offset:18432
    v_fma_f32 v52, v52, s28, v9
    v_mfma_f32_16x16x32_bf16 v[80:83], a[224:227], a[180:183], v[80:83]
    s_add_u32 s20, s20, 128
    v_exp_f32 v55, v55
    v_mfma_f32_16x16x32_bf16 v[80:83], a[228:231], a[184:187], v[80:83]
    s_add_u32 m0, s22, 1024
    v_exp_f32 v52, v52
    v_mfma_f32_16x16x32_bf16 v[80:83], a[232:235], a[188:191], v[80:83]
    ds_read_b64_tr_b16 a[214:215], v2 offset:12288
    v_fma_f32 v53, v53, s28, v9
    v_mfma_f32_16x16x32_bf16 v[72:75], a[232:235], a[164:167], v[72:75]
    buffer_load_dwordx4 v6, s[4:7], s20 offen lds
    v_mfma_f32_16x16x32_bf16 v[72:75], a[228:231], a[160:163], v[72:75]
    ds_read_b64_tr_b16 a[216:217], v3 offset:18432
    v_cvt_pk_bf16_f32 v20, v60, v61
    v_mfma_f32_16x16x32_bf16 v[72:75], a[224:227], a[156:159], v[72:75]
    s_add_u32 s20, s20, 128
    v_exp_f32 v54, v54
    v_mfma_f32_16x16x32_bf16 v[64:67], a[224:227], a[132:135], v[64:67]
    ds_read_b64_tr_b16 a[218:219], v3 offset:12288
    v_mfma_f32_16x16x32_bf16 v[64:67], a[228:231], a[136:139], v[64:67]
    v_exp_f32 v53, v53
    v_mfma_f32_16x16x32_bf16 v[64:67], a[232:235], a[140:143], v[64:67]
    s_add_u32 m0, s22, 2048
    ds_read_b64_tr_b16 a[220:221], v4 offset:18432
    v_cvt_pk_bf16_f32 v15, v54, v55
    v_mfma_f32_16x16x32_bf16 v[56:59], a[232:235], a[116:119], v[56:59]
    buffer_load_dwordx4 v6, s[4:7], s20 offen lds
    v_mfma_f32_16x16x32_bf16 v[56:59], a[228:231], a[112:115], v[56:59]
    s_add_u32 s20, s20, 12032
    ds_read_b64_tr_b16 a[222:223], v4 offset:12288
    v_cvt_pk_bf16_f32 v14, v52, v53
    v_mfma_f32_16x16x32_bf16 v[56:59], a[224:227], a[108:111], v[56:59]
    ds_read_b64_tr_b16 a[224:225], v5 offset:18432
    ds_read_b64_tr_b16 a[226:227], v5 offset:12288
    s_branch L_loop4
L_tr55:
    s_waitcnt lgkmcnt(4)
    v_mfma_f32_16x16x32_bf16 v[112:115], a[212:215], v[16:19], v[112:115]
    ds_read_b64_tr_b16 a[232:233], v3 offset:19456
    v_mbcnt_lo_u32_b32 v97, -1, 0
    v_mfma_f32_16x16x32_bf16 v[116:119], a[216:219], v[16:19], v[116:119]
    s_add_u32 s39, s39, 12288
    ds_read_b64_tr_b16 a[228:229], v2 offset:19456
    v_fma_f32 v57, v57, s28, v9
    v_mfma_f32_16x16x32_bf16 v[164:167], a[216:219], v[22:25], v[164:167]
    v_fma_f32 v70, v70, s28, v11
    v_mfma_f32_16x16x32_bf16 v[160:163], a[212:215], v[22:25], v[160:163]
    v_fma_f32 v69, v69, s28, v11
    v_fma_f32 v77, v77, s28, v12
    v_mfma_f32_16x16x32_bf16 v[208:211], a[212:215], v[28:31], v[208:211]
    s_add_u32 s48, s33, 24576
    ds_read_b64_tr_b16 a[230:231], v2 offset:13312
    v_mbcnt_hi_u32_b32 v97, -1, v97
    v_mfma_f32_16x16x32_bf16 v[212:215], a[216:219], v[28:31], v[212:215]
    ds_read_b64_tr_b16 a[234:235], v3 offset:13312
    v_fma_f32 v82, v82, s28, v12
    v_mfma_f32_16x16x32_bf16 a[4:7], a[216:219], v[34:37], a[4:7]
    v_and_b32 v96, 15, v97
    v_lshrrev_b32 v97, 4, v97
    v_mfma_f32_16x16x32_bf16 a[0:3], a[212:215], v[34:37], a[0:3]
    v_mul_u32_u24 v96, 384, v96
    v_fma_f32 v79, v79, s28, v12
    v_mfma_f32_16x16x32_bf16 a[48:51], a[212:215], v[40:43], a[48:51]
    ds_read_b64_tr_b16 a[214:215], v4 offset:13312
    v_fma_f32 v59, v59, s28, v9
    v_mfma_f32_16x16x32_bf16 a[52:55], a[216:219], v[40:43], a[52:55]
    s_waitcnt lgkmcnt(5)
    v_fma_f32 v68, v68, s28, v11
    v_mfma_f32_16x16x32_bf16 a[56:59], a[220:223], v[40:43], a[56:59]
    v_lshl_add_u32 v96, v97, 4, v96
    v_fma_f32 v58, v58, s28, v9
    v_mfma_f32_16x16x32_bf16 a[60:63], a[224:227], v[40:43], a[60:63]
    buffer_load_dword v97, v96, s[12:15], s48 offen offset:256
    v_mfma_f32_16x16x32_bf16 a[12:15], a[224:227], v[34:37], a[12:15]
    ds_read_b64_tr_b16 a[218:219], v5 offset:13312
    v_fma_f32 v85, v85, s28, v13
    v_mfma_f32_16x16x32_bf16 a[8:11], a[220:223], v[34:37], a[8:11]
    ds_read_b64_tr_b16 a[212:213], v4 offset:19456
    v_fma_f32 v83, v83, s28, v12
    v_mfma_f32_16x16x32_bf16 v[216:219], a[220:223], v[28:31], v[216:219]
    v_fma_f32 v90, v90, s28, v13
    v_fma_f32 v56, v56, s28, v9
    v_mfma_f32_16x16x32_bf16 v[220:223], a[224:227], v[28:31], v[220:223]
    ds_read_b64_tr_b16 a[216:217], v5 offset:19456
    v_fma_f32 v78, v78, s28, v12
    v_mfma_f32_16x16x32_bf16 v[172:175], a[224:227], v[22:25], v[172:175]
    v_fma_f32 v73, v73, s28, v11
    v_fma_f32 v71, v71, s28, v11
    v_mfma_f32_16x16x32_bf16 v[168:171], a[220:223], v[22:25], v[168:171]
    v_exp_f32 v69, v69
    v_mfma_f32_16x16x32_bf16 v[120:123], a[220:223], v[16:19], v[120:123]
    v_fma_f32 v75, v75, s28, v11
    v_mfma_f32_16x16x32_bf16 v[124:127], a[224:227], v[16:19], v[124:127]
    s_waitcnt lgkmcnt(3)
    v_exp_f32 v57, v57
    v_mfma_f32_16x16x32_bf16 v[128:131], a[228:231], v[16:19], v[128:131]
    v_exp_f32 v78, v78
    v_mfma_f32_16x16x32_bf16 v[132:135], a[232:235], v[16:19], v[132:135]
    v_exp_f32 v79, v79
    v_mfma_f32_16x16x32_bf16 v[180:183], a[232:235], v[22:25], v[180:183]
    v_fma_f32 v72, v72, s28, v11
    v_fma_f32 v74, v74, s28, v11
    v_mfma_f32_16x16x32_bf16 v[176:179], a[228:231], v[22:25], v[176:179]
    ds_read_b64_tr_b16 a[220:221], v2 offset:20480
    v_fma_f32 v89, v89, s28, v13
    v_mfma_f32_16x16x32_bf16 v[224:227], a[228:231], v[28:31], v[224:227]
    ds_read_b64_tr_b16 a[222:223], v2 offset:14336
    v_mfma_f32_16x16x32_bf16 v[228:231], a[232:235], v[28:31], v[228:231]
    v_exp_f32 v85, v85
    v_mfma_f32_16x16x32_bf16 a[20:23], a[232:235], v[34:37], a[20:23]
    v_exp_f32 v77, v77
    v_mfma_f32_16x16x32_bf16 a[16:19], a[228:231], v[34:37], a[16:19]
    ds_read_b64_tr_b16 a[224:225], v3 offset:20480
    v_fma_f32 v87, v87, s28, v13
    v_mfma_f32_16x16x32_bf16 a[64:67], a[228:231], v[40:43], a[64:67]
    ds_read_b64_tr_b16 a[226:227], v3 offset:14336
    v_fma_f32 v86, v86, s28, v13
    v_mfma_f32_16x16x32_bf16 a[68:71], a[232:235], v[40:43], a[68:71]
    s_waitcnt lgkmcnt(4)
    ds_read_b64_tr_b16 a[230:231], v4 offset:14336
    v_mfma_f32_16x16x32_bf16 a[72:75], a[212:215], v[40:43], a[72:75]
    v_fma_f32 v81, v81, s28, v12
    v_fma_f32 v65, v65, s28, v10
    v_mfma_f32_16x16x32_bf16 a[76:79], a[216:219], v[40:43], a[76:79]
    ds_read_b64_tr_b16 a[232:233], v5 offset:20480
    v_mfma_f32_16x16x32_bf16 a[28:31], a[216:219], v[34:37], a[28:31]
    v_exp_f32 v87, v87
    v_mfma_f32_16x16x32_bf16 a[24:27], a[212:215], v[34:37], a[24:27]
    v_exp_f32 v71, v71
    v_mfma_f32_16x16x32_bf16 v[232:235], a[212:215], v[28:31], v[232:235]
    ds_read_b64_tr_b16 a[228:229], v4 offset:20480
    v_mfma_f32_16x16x32_bf16 v[236:239], a[216:219], v[28:31], v[236:239]
    v_mfma_f32_16x16x32_bf16 v[188:191], a[216:219], v[22:25], v[188:191]
    ds_read_b64_tr_b16 a[234:235], v5 offset:14336
    v_mfma_f32_16x16x32_bf16 v[184:187], a[212:215], v[22:25], v[184:187]
    v_fma_f32 v84, v84, s28, v13
    v_fma_f32 v88, v88, s28, v13
    v_mfma_f32_16x16x32_bf16 v[136:139], a[212:215], v[16:19], v[136:139]
    v_exp_f32 v56, v56
    v_mfma_f32_16x16x32_bf16 v[140:143], a[216:219], v[16:19], v[140:143]
    s_waitcnt lgkmcnt(3)
    v_fma_f32 v76, v76, s28, v12
    v_mfma_f32_16x16x32_bf16 v[144:147], a[220:223], v[16:19], v[144:147]
    v_exp_f32 v70, v70
    v_mfma_f32_16x16x32_bf16 v[148:151], a[224:227], v[16:19], v[148:151]
    v_exp_f32 v75, v75
    v_mfma_f32_16x16x32_bf16 v[196:199], a[224:227], v[22:25], v[196:199]
    v_fma_f32 v80, v80, s28, v12
    v_cvt_pk_bf16_f32 v33, v78, v79
    v_mfma_f32_16x16x32_bf16 v[192:195], a[220:223], v[22:25], v[192:195]
    v_exp_f32 v65, v65
    v_mfma_f32_16x16x32_bf16 v[240:243], a[220:223], v[28:31], v[240:243]
    v_exp_f32 v68, v68
    v_mfma_f32_16x16x32_bf16 v[244:247], a[224:227], v[28:31], v[244:247]
    v_exp_f32 v86, v86
    v_mfma_f32_16x16x32_bf16 a[36:39], a[224:227], v[34:37], a[36:39]
    s_waitcnt vmcnt(11) lgkmcnt(0)
    v_exp_f32 v90, v90
    v_mfma_f32_16x16x32_bf16 a[32:35], a[220:223], v[34:37], a[32:35]
    s_barrier
    v_mfma_f32_16x16x32_bf16 a[80:83], a[220:223], v[40:43], a[80:83]
    ds_read_b128 a[216:219], v1 offset:12288
    v_mfma_f32_16x16x32_bf16 a[84:87], a[224:227], v[40:43], a[84:87]
    ds_read_b128 a[212:215], v0 offset:12288
    s_add_u32 m0, s22, 36864
    v_mfma_f32_16x16x32_bf16 a[88:91], a[228:231], v[40:43], a[88:91]
    v_exp_f32 v84, v84
    v_mfma_f32_16x16x32_bf16 a[92:95], a[232:235], v[40:43], a[92:95]
    buffer_load_dwordx4 v6, s[8:11], s21 offen lds
    v_mfma_f32_16x16x32_bf16 a[44:47], a[232:235], v[34:37], a[44:47]
    s_add_u32 s21, s21, 128
    s_add_u32 m0, s22, 37888
    v_cvt_pk_bf16_f32 v27, v70, v71
    v_mfma_f32_16x16x32_bf16 a[40:43], a[228:231], v[34:37], a[40:43]
    buffer_load_dwordx4 v6, s[8:11], s21 offen lds
    v_mfma_f32_16x16x32_bf16 v[248:251], a[228:231], v[28:31], v[248:251]
    v_exp_f32 v76, v76
    v_mfma_f32_16x16x32_bf16 v[252:255], a[232:235], v[28:31], v[252:255]
    ds_read_b128 a[220:223], v0 offset:13312
    v_cvt_pk_bf16_f32 v26, v68, v69
    v_mfma_f32_16x16x32_bf16 v[204:207], a[232:235], v[22:25], v[204:207]
    s_add_u32 s21, s21, 128
    v_fma_f32 v91, v91, s28, v13
    s_add_u32 m0, s22, 38912
    v_mfma_f32_16x16x32_bf16 v[200:203], a[228:231], v[22:25], v[200:203]
    buffer_load_dwordx4 v6, s[8:11], s21 offen lds
    v_mfma_f32_16x16x32_bf16 v[152:155], a[228:231], v[16:19], v[152:155]
    ds_read_b128 a[228:231], v0 offset:14336
    v_fma_f32 v64, v64, s28, v10
    v_mfma_f32_16x16x32_bf16 v[156:159], a[232:235], v[16:19], v[156:159]
    s_waitcnt lgkmcnt(2)
    v_cvt_pk_bf16_f32 v38, v84, v85
    v_cvt_pk_bf16_f32 v39, v86, v87
    v_mfma_f32_16x16x32_bf16 v[52:55], a[212:215], a[96:99], 0
    v_exp_f32 v80, v80
    v_mfma_f32_16x16x32_bf16 v[60:63], a[212:215], a[120:123], 0
    ds_read_b128 a[224:227], v1 offset:13312
    v_cvt_pk_bf16_f32 v32, v76, v77
    v_mfma_f32_16x16x32_bf16 v[68:71], a[212:215], a[144:147], 0
    v_exp_f32 v72, v72
    v_mfma_f32_16x16x32_bf16 v[76:79], a[212:215], a[168:171], 0
    v_exp_f32 v82, v82
    v_mfma_f32_16x16x32_bf16 v[84:87], a[212:215], a[192:195], 0
    v_mfma_f32_16x16x32_bf16 v[52:55], a[216:219], a[100:103], v[52:55]
    v_exp_f32 v91, v91
    v_mfma_f32_16x16x32_bf16 v[60:63], a[216:219], a[124:127], v[60:63]
    ds_read_b128 a[232:235], v1 offset:14336
    v_fma_f32 v67, v67, s28, v10
    v_mfma_f32_16x16x32_bf16 v[68:71], a[216:219], a[148:151], v[68:71]
    v_exp_f32 v64, v64
    v_mfma_f32_16x16x32_bf16 v[76:79], a[216:219], a[172:175], v[76:79]
    v_exp_f32 v73, v73
    v_mfma_f32_16x16x32_bf16 v[84:87], a[216:219], a[196:199], v[84:87]
    s_waitcnt lgkmcnt(2)
    v_exp_f32 v67, v67
    v_mfma_f32_16x16x32_bf16 v[52:55], a[220:223], a[104:107], v[52:55]
    ds_read_b128 a[216:219], v1 offset:20480
    v_mfma_f32_16x16x32_bf16 v[60:63], a[220:223], a[128:131], v[60:63]
    v_exp_f32 v88, v88
    v_mfma_f32_16x16x32_bf16 v[68:71], a[220:223], a[152:155], v[68:71]
    v_exp_f32 v74, v74
    v_mfma_f32_16x16x32_bf16 v[76:79], a[220:223], a[176:179], v[76:79]
    v_exp_f32 v58, v58
    v_mfma_f32_16x16x32_bf16 v[84:87], a[220:223], a[200:203], v[84:87]
    s_waitcnt lgkmcnt(2)
    v_exp_f32 v59, v59
    v_mfma_f32_16x16x32_bf16 v[52:55], a[224:227], a[108:111], v[52:55]
    v_exp_f32 v83, v83
    v_mfma_f32_16x16x32_bf16 v[60:63], a[224:227], a[132:135], v[60:63]
    ds_read_b128 a[212:215], v0 offset:20480
    v_mfma_f32_16x16x32_bf16 v[68:71], a[224:227], a[156:159], v[68:71]
    v_exp_f32 v81, v81
    v_mfma_f32_16x16x32_bf16 v[76:79], a[224:227], a[180:183], v[76:79]
    v_exp_f32 v89, v89
    v_mfma_f32_16x16x32_bf16 v[84:87], a[224:227], a[204:207], v[84:87]
    v_cvt_pk_bf16_f32 v22, v64, v65
    v_mfma_f32_16x16x32_bf16 v[52:55], a[228:231], a[112:115], v[52:55]
    v_fma_f32 v66, v66, s28, v10
    v_cvt_pk_bf16_f32 v40, v88, v89
    v_mfma_f32_16x16x32_bf16 v[60:63], a[228:231], a[136:139], v[60:63]
    v_mfma_f32_16x16x32_bf16 v[68:71], a[228:231], a[160:163], v[68:71]
    s_add_u32 s21, s21, 12032
    ds_read_b128 a[220:223], v0 offset:18432
    v_cvt_pk_bf16_f32 v29, v74, v75
    v_mfma_f32_16x16x32_bf16 v[76:79], a[228:231], a[184:187], v[76:79]
    v_cvt_pk_bf16_f32 v17, v58, v59
    v_cvt_pk_bf16_f32 v16, v56, v57
    v_mfma_f32_16x16x32_bf16 v[84:87], a[228:231], a[208:211], v[84:87]
    s_waitcnt lgkmcnt(2)
    v_exp_f32 v66, v66
    v_mfma_f32_16x16x32_bf16 v[52:55], a[232:235], a[116:119], v[52:55]
    ds_read_b128 a[228:231], v0 offset:19456
    v_mfma_f32_16x16x32_bf16 v[60:63], a[232:235], a[140:143], v[60:63]
    ds_read_b128 a[224:227], v1 offset:18432
    v_mfma_f32_16x16x32_bf16 v[44:47], a[236:239], v[14:17], v[48:51]
    v_cvt_pk_bf16_f32 v35, v82, v83
    v_mfma_f32_16x16x32_bf16 v[68:71], a[232:235], a[164:167], v[68:71]
    v_cvt_pk_bf16_f32 v28, v72, v73
    v_mfma_f32_16x16x32_bf16 v[76:79], a[232:235], a[188:191], v[76:79]
    v_cvt_pk_bf16_f32 v23, v66, v67
    v_cvt_pk_bf16_f32 v41, v90, v91
    v_mfma_f32_16x16x32_bf16 v[84:87], a[232:235], v[92:95], v[84:87]
    ds_read_b128 a[232:235], v1 offset:19456
    v_cvt_pk_bf16_f32 v34, v80, v81
    v_mfma_f32_16x16x32_bf16 v[44:47], a[240:243], v[20:23], v[44:47]
    v_mfma_f32_16x16x32_bf16 v[44:47], a[244:247], v[26:29], v[44:47]
    v_mfma_f32_16x16x32_bf16 v[44:47], a[248:251], v[32:35], v[44:47]
    v_mfma_f32_16x16x32_bf16 v[44:47], a[252:255], v[38:41], v[44:47]
    s_waitcnt lgkmcnt(3)
    v_mfma_f32_16x16x32_bf16 v[56:59], a[212:215], a[112:115], 0
    v_mfma_f32_16x16x32_bf16 v[64:67], a[212:215], a[136:139], 0
    v_mfma_f32_16x16x32_bf16 v[72:75], a[212:215], a[160:163], 0
    v_mfma_f32_16x16x32_bf16 v[80:83], a[212:215], a[184:187], 0
    v_mfma_f32_16x16x32_bf16 v[88:91], a[212:215], a[208:211], 0
    s_nop 1
    v_cmp_lt_f32 vcc, s29, v44
    v_mfma_f32_16x16x32_bf16 v[56:59], a[216:219], a[116:119], v[56:59]
    s_waitcnt vmcnt(8) lgkmcnt(0)
    v_mfma_f32_16x16x32_bf16 v[64:67], a[216:219], a[140:143], v[64:67]
    s_barrier
    v_mfma_f32_16x16x32_bf16 v[72:75], a[216:219], a[164:167], v[72:75]
    s_cbranch_vccnz L_rs_tr55a
L_ret_tr55a:
    v_fma_f32 v60, v60, s28, v10
    v_mfma_f32_16x16x32_bf16 v[80:83], a[216:219], a[188:191], v[80:83]
    ds_read_b64_tr_b16 a[212:213], v2 offset:0
    v_fma_f32 v54, v54, s28, v9
    v_mfma_f32_16x16x32_bf16 v[88:91], a[216:219], v[92:95], v[88:91]
    s_add_u32 m0, s22, 12288
    v_fma_f32 v52, v52, s28, v9
    v_fma_f32 v61, v61, s28, v10
    v_mfma_f32_16x16x32_bf16 v[56:59], a[220:223], a[96:99], v[56:59]
    buffer_load_dwordx4 v6, s[4:7], s20 offen lds
    v_mfma_f32_16x16x32_bf16 v[64:67], a[220:223], a[120:123], v[64:67]
    v_fma_f32 v55, v55, s28, v9
    v_fma_f32 v63, v63, s28, v10
    v_mfma_f32_16x16x32_bf16 v[72:75], a[220:223], a[144:147], v[72:75]
    s_add_u32 s20, s20, 128
    v_exp_f32 v52, v52
    v_mfma_f32_16x16x32_bf16 v[80:83], a[220:223], a[168:171], v[80:83]
    s_add_u32 m0, s22, 13312
    v_exp_f32 v55, v55
    v_mfma_f32_16x16x32_bf16 v[88:91], a[220:223], a[192:195], v[88:91]
    buffer_load_dwordx4 v6, s[4:7], s20 offen lds
    v_mfma_f32_16x16x32_bf16 v[56:59], a[224:227], a[100:103], v[56:59]
    s_add_u32 s20, s20, 128
    v_exp_f32 v54, v54
    v_mfma_f32_16x16x32_bf16 v[64:67], a[224:227], a[124:127], v[64:67]
    s_add_u32 m0, s22, 14336
    ds_read_b64_tr_b16 a[214:215], v2 offset:6144
    v_fma_f32 v62, v62, s28, v10
    v_mfma_f32_16x16x32_bf16 v[72:75], a[224:227], a[148:151], v[72:75]
    buffer_load_dwordx4 v6, s[4:7], s20 offen lds
    v_mfma_f32_16x16x32_bf16 v[80:83], a[224:227], a[172:175], v[80:83]
    v_exp_f32 v63, v63
    v_mfma_f32_16x16x32_bf16 v[88:91], a[224:227], a[196:199], v[88:91]
    ds_read_b64_tr_b16 a[216:217], v3 offset:0
    v_fma_f32 v53, v53, s28, v9
    v_mfma_f32_16x16x32_bf16 v[56:59], a[228:231], a[104:107], v[56:59]
    ds_read_b64_tr_b16 a[218:219], v3 offset:6144
    v_cvt_pk_bf16_f32 v19, v54, v55
    v_mfma_f32_16x16x32_bf16 v[64:67], a[228:231], a[128:131], v[64:67]
    v_exp_f32 v62, v62
    v_mfma_f32_16x16x32_bf16 v[72:75], a[228:231], a[152:155], v[72:75]
    ds_read_b64_tr_b16 a[220:221], v4 offset:0
    v_exp_f32 v61, v61
    v_mfma_f32_16x16x32_bf16 v[80:83], a[228:231], a[176:179], v[80:83]
    ds_read_b64_tr_b16 a[222:223], v4 offset:6144
    v_cvt_pk_bf16_f32 v25, v62, v63
    v_mfma_f32_16x16x32_bf16 v[88:91], a[228:231], a[200:203], v[88:91]
    v_exp_f32 v60, v60
    v_mfma_f32_16x16x32_bf16 v[56:59], a[232:235], a[108:111], v[56:59]
    s_add_u32 s20, s20, 12032
    v_exp_f32 v53, v53
    v_mfma_f32_16x16x32_bf16 v[64:67], a[232:235], a[132:135], v[64:67]
    ds_read_b64_tr_b16 a[224:225], v5 offset:0
    v_cvt_pk_bf16_f32 v18, v52, v53
    v_mfma_f32_16x16x32_bf16 v[72:75], a[232:235], a[156:159], v[72:75]
    buffer_load_dwordx4 a[208:211], v96, s[12:15], s48 offen offset:256 nt
    v_mfma_f32_16x16x32_bf16 v[80:83], a[232:235], a[180:183], v[80:83]
    ds_read_b64_tr_b16 a[226:227], v5 offset:6144
    v_cvt_pk_bf16_f32 v24, v60, v61
    v_mfma_f32_16x16x32_bf16 v[88:91], a[232:235], a[204:207], v[88:91]
    buffer_load_dwordx4 v[92:95], v96, s[12:15], s48 offen offset:320 nt
    s_waitcnt lgkmcnt(4)
    v_mfma_f32_16x16x32_bf16 v[112:115], a[212:215], v[14:17], v[112:115]
    ds_read_b64_tr_b16 a[234:235], v3 offset:7168
    v_fma_f32 v66, v66, s28, v10
    v_mfma_f32_16x16x32_bf16 v[116:119], a[216:219], v[14:17], v[116:119]
    ds_read_b64_tr_b16 a[228:229], v2 offset:1024
    v_fma_f32 v68, v68, s28, v11
    v_mfma_f32_16x16x32_bf16 v[164:167], a[216:219], v[20:23], v[164:167]
    v_fma_f32 v73, v73, s28, v11
    v_fma_f32 v67, v67, s28, v10
    v_mfma_f32_16x16x32_bf16 v[160:163], a[212:215], v[20:23], v[160:163]
    v_lshrrev_b32 v105, 11, v0
    v_xor_b32 v105, s65, v105
    v_mfma_f32_16x16x32_bf16 v[208:211], a[212:215], v[26:29], v[208:211]
    v_fma_f32 v56, v56, s28, v9
    v_fma_f32 v88, v88, s28, v13
    v_mfma_f32_16x16x32_bf16 v[212:215], a[216:219], v[26:29], v[212:215]
    v_fma_f32 v79, v79, s28, v12
    v_fma_f32 v78, v78, s28, v12
    v_mfma_f32_16x16x32_bf16 a[4:7], a[216:219], v[32:35], a[4:7]
    ds_read_b64_tr_b16 a[232:233], v3 offset:1024
    v_fma_f32 v76, v76, s28, v12
    v_mfma_f32_16x16x32_bf16 a[0:3], a[212:215], v[32:35], a[0:3]
    ds_read_b64_tr_b16 a[230:231], v2 offset:7168
    v_fma_f32 v81, v81, s28, v12
    v_mfma_f32_16x16x32_bf16 a[48:51], a[212:215], v[38:41], a[48:51]
    ds_read_b64_tr_b16 a[212:213], v4 offset:1024
    v_and_b32 v104, 0x3ff, v0
    v_mfma_f32_16x16x32_bf16 a[52:55], a[216:219], v[38:41], a[52:55]
    s_waitcnt lgkmcnt(5)
    v_exp_f32 v67, v67
    v_mfma_f32_16x16x32_bf16 a[56:59], a[220:223], v[38:41], a[56:59]
    v_exp_f32 v66, v66
    v_mfma_f32_16x16x32_bf16 a[60:63], a[224:227], v[38:41], a[60:63]
    v_lshl_add_u32 v104, v105, 10, v104
    v_fma_f32 v83, v83, s28, v12
    v_mfma_f32_16x16x32_bf16 a[12:15], a[224:227], v[32:35], a[12:15]
    ds_read_b64_tr_b16 a[218:219], v5 offset:7168
    v_fma_f32 v90, v90, s28, v13
    v_mfma_f32_16x16x32_bf16 a[8:11], a[220:223], v[32:35], a[8:11]
    v_fma_f32 v84, v84, s28, v13
    v_exp_f32 v76, v76
    v_mfma_f32_16x16x32_bf16 v[216:219], a[220:223], v[26:29], v[216:219]
    ds_read_b64_tr_b16 a[214:215], v4 offset:7168
    v_fma_f32 v58, v58, s28, v9
    v_mfma_f32_16x16x32_bf16 v[220:223], a[224:227], v[26:29], v[220:223]
    ds_read_b64_tr_b16 a[216:217], v5 offset:1024
    v_add_u32 v104, s38, v104
    v_mfma_f32_16x16x32_bf16 v[172:175], a[224:227], v[20:23], v[172:175]
    ds_read_b128 a[200:203], v104 offset:26624
    v_xor_b32 v105, 64, v104
    v_mfma_f32_16x16x32_bf16 v[168:171], a[220:223], v[20:23], v[168:171]
    ds_read_b128 a[144:147], v104 offset:12288
    v_fma_f32 v75, v75, s28, v11
    v_mfma_f32_16x16x32_bf16 v[120:123], a[220:223], v[14:17], v[120:123]
    v_exp_f32 v58, v58
    v_mfma_f32_16x16x32_bf16 v[124:127], a[224:227], v[14:17], v[124:127]
    s_waitcnt lgkmcnt(5)
    ds_read_b128 a[128:131], v104 offset:8192
    v_fma_f32 v69, v69, s28, v11
    v_mfma_f32_16x16x32_bf16 v[128:131], a[228:231], v[14:17], v[128:131]
    v_exp_f32 v68, v68
    v_mfma_f32_16x16x32_bf16 v[132:135], a[232:235], v[14:17], v[132:135]
    ds_read_b128 a[124:127], v105 offset:6144
    v_fma_f32 v91, v91, s28, v13
    v_mfma_f32_16x16x32_bf16 v[180:183], a[232:235], v[20:23], v[180:183]
    ds_read_b128 a[172:175], v105 offset:18432
    v_fma_f32 v87, v87, s28, v13
    v_mfma_f32_16x16x32_bf16 v[176:179], a[228:231], v[20:23], v[176:179]
    v_exp_f32 v69, v69
    v_mfma_f32_16x16x32_bf16 v[224:227], a[228:231], v[26:29], v[224:227]
    ds_read_b64_tr_b16 a[222:223], v2 offset:8192
    v_exp_f32 v73, v73
    v_mfma_f32_16x16x32_bf16 v[228:231], a[232:235], v[26:29], v[228:231]
    ds_read_b64_tr_b16 a[224:225], v3 offset:2048
    v_fma_f32 v74, v74, s28, v11
    v_mfma_f32_16x16x32_bf16 a[20:23], a[232:235], v[32:35], a[20:23]
    ds_read_b128 a[96:99], v104 offset:0
    v_fma_f32 v85, v85, s28, v13
    v_mfma_f32_16x16x32_bf16 a[16:19], a[228:231], v[32:35], a[16:19]
    ds_read_b64_tr_b16 a[220:221], v2 offset:2048
    v_fma_f32 v64, v64, s28, v10
    v_fma_f32 v82, v82, s28, v12
    v_mfma_f32_16x16x32_bf16 a[64:67], a[228:231], v[38:41], a[64:67]
    ds_read_b64_tr_b16 a[226:227], v3 offset:8192
    v_fma_f32 v77, v77, s28, v12
    v_mfma_f32_16x16x32_bf16 a[68:71], a[232:235], v[38:41], a[68:71]
    s_waitcnt lgkmcnt(7)
    v_exp_f32 v84, v84
    v_mfma_f32_16x16x32_bf16 a[72:75], a[212:215], v[38:41], a[72:75]
    ds_read_b64_tr_b16 a[232:233], v5 offset:2048
    v_fma_f32 v86, v86, s28, v13
    v_mfma_f32_16x16x32_bf16 a[76:79], a[216:219], v[38:41], a[76:79]
    ds_read_b64_tr_b16 a[230:231], v4 offset:8192
    v_fma_f32 v70, v70, s28, v11
    v_mfma_f32_16x16x32_bf16 a[28:31], a[216:219], v[32:35], a[28:31]
    ds_read_b64_tr_b16 a[234:235], v5 offset:8192
    v_cvt_pk_bf16_f32 v30, v68, v69
    v_mfma_f32_16x16x32_bf16 a[24:27], a[212:215], v[32:35], a[24:27]
    ds_read_b64_tr_b16 a[228:229], v4 offset:2048
    v_fma_f32 v71, v71, s28, v11
    v_mfma_f32_16x16x32_bf16 v[232:235], a[212:215], v[26:29], v[232:235]
    v_exp_f32 v86, v86
    v_mfma_f32_16x16x32_bf16 v[236:239], a[216:219], v[26:29], v[236:239]
    v_exp_f32 v70, v70
    v_mfma_f32_16x16x32_bf16 v[188:191], a[216:219], v[20:23], v[188:191]
    ds_read_b128 a[156:159], v105 offset:14336
    v_fma_f32 v57, v57, s28, v9
    v_mfma_f32_16x16x32_bf16 v[184:187], a[212:215], v[20:23], v[184:187]
    s_add_u32 s39, s39, 12288
    v_exp_f32 v78, v78
    v_mfma_f32_16x16x32_bf16 v[136:139], a[212:215], v[14:17], v[136:139]
    v_exp_f32 v83, v83
    v_mfma_f32_16x16x32_bf16 v[140:143], a[216:219], v[14:17], v[140:143]
    s_waitcnt lgkmcnt(5)
    v_exp_f32 v71, v71
    v_mfma_f32_16x16x32_bf16 v[144:147], a[220:223], v[14:17], v[144:147]
    ds_read_b128 a[104:107], v104 offset:2048
    v_fma_f32 v89, v89, s28, v13
    v_mfma_f32_16x16x32_bf16 v[148:151], a[224:227], v[14:17], v[148:151]
    ds_read_b128 a[168:171], v104 offset:18432
    v_fma_f32 v65, v65, s28, v10
    v_mfma_f32_16x16x32_bf16 v[196:199], a[224:227], v[20:23], v[196:199]
    ds_read_b128 a[148:151], v105 offset:12288
    v_cvt_pk_bf16_f32 v31, v70, v71
    v_mfma_f32_16x16x32_bf16 v[192:195], a[220:223], v[20:23], v[192:195]
    s_waitcnt vmcnt(9) lgkmcnt(4)
    v_exp_f32 v77, v77
    v_mfma_f32_16x16x32_bf16 v[240:243], a[220:223], v[26:29], v[240:243]
    ds_read_b128 a[120:123], v104 offset:6144
    v_cvt_pk_bf16_f32 v36, v76, v77
    v_mfma_f32_16x16x32_bf16 v[244:247], a[224:227], v[26:29], v[244:247]
    s_add_u32 s21, s21, s62
    v_exp_f32 v65, v65
    v_mfma_f32_16x16x32_bf16 a[36:39], a[224:227], v[32:35], a[36:39]
    s_add_u32 m0, s22, 24576
    v_exp_f32 v79, v79
    v_mfma_f32_16x16x32_bf16 a[32:35], a[220:223], v[32:35], a[32:35]
    s_barrier
    ds_read_b128 a[216:219], v1 offset:0
    v_mfma_f32_16x16x32_bf16 a[80:83], a[220:223], v[38:41], a[80:83]
    buffer_load_dwordx4 v6, s[8:11], s21 offen lds
    v_mfma_f32_16x16x32_bf16 a[84:87], a[224:227], v[38:41], a[84:87]
    s_add_u32 s21, s21, 128
    ds_read_b128 a[212:215], v0 offset:0
    v_fma_f32 v59, v59, s28, v9
    v_mfma_f32_16x16x32_bf16 a[88:91], a[228:231], v[38:41], a[88:91]
    ds_read_b128 a[100:103], v105 offset:0
    v_fma_f32 v72, v72, s28, v11
    v_mfma_f32_16x16x32_bf16 a[92:95], a[232:235], v[38:41], a[92:95]
    s_add_u32 m0, s22, 25600
    ds_read_b128 a[192:195], v104 offset:24576
    buffer_load_dwordx4 v6, s[8:11], s21 offen lds
    v_mfma_f32_16x16x32_bf16 a[44:47], a[232:235], v[32:35], a[44:47]
    s_add_u32 s21, s21, 128
    v_exp_f32 v72, v72
    v_mfma_f32_16x16x32_bf16 a[40:43], a[228:231], v[32:35], a[40:43]
    ds_read_b128 a[224:227], v1 offset:1024
    v_exp_f32 v64, v64
    v_mfma_f32_16x16x32_bf16 v[248:251], a[228:231], v[26:29], v[248:251]
    s_add_u32 m0, s22, 26624
    v_exp_f32 v85, v85
    v_mfma_f32_16x16x32_bf16 v[252:255], a[232:235], v[26:29], v[252:255]
    v_exp_f32 v87, v87
    v_mfma_f32_16x16x32_bf16 v[204:207], a[232:235], v[20:23], v[204:207]
    buffer_load_dwordx4 v6, s[8:11], s21 offen lds
    v_mfma_f32_16x16x32_bf16 v[200:203], a[228:231], v[20:23], v[200:203]
    ds_read_b128 a[196:199], v105 offset:24576
    v_exp_f32 v82, v82
    v_mfma_f32_16x16x32_bf16 v[152:155], a[228:231], v[14:17], v[152:155]
    ds_read_b128 a[220:223], v0 offset:1024
    v_cvt_pk_bf16_f32 v43, v86, v87
    v_mfma_f32_16x16x32_bf16 v[156:159], a[232:235], v[14:17], v[156:159]
    s_waitcnt lgkmcnt(4)
    ds_read_b128 a[132:135], v105 offset:8192
    v_cvt_pk_bf16_f32 v28, v72, v73
    v_mfma_f32_16x16x32_bf16 v[52:55], a[212:215], a[96:99], 0
    ds_read_b128 a[152:155], v104 offset:14336
    v_cvt_pk_bf16_f32 v22, v64, v65
    v_mfma_f32_16x16x32_bf16 v[60:63], a[212:215], a[120:123], 0
    ds_read_b128 a[176:179], v104 offset:20480
    v_cvt_pk_bf16_f32 v37, v78, v79
    v_mfma_f32_16x16x32_bf16 v[68:71], a[212:215], a[144:147], 0
    v_exp_f32 v59, v59
    v_mfma_f32_16x16x32_bf16 v[76:79], a[212:215], a[168:171], 0
    s_waitcnt lgkmcnt(5)
    ds_read_b128 a[180:183], v105 offset:20480
    v_cvt_pk_bf16_f32 v42, v84, v85
    v_mfma_f32_16x16x32_bf16 v[84:87], a[212:215], a[192:195], 0
    ds_read_b128 a[108:111], v105 offset:2048
    v_cvt_pk_bf16_f32 v35, v82, v83
    v_mfma_f32_16x16x32_bf16 v[52:55], a[216:219], a[100:103], v[52:55]
    ds_read_b128 a[204:207], v105 offset:26624
    v_mfma_f32_16x16x32_bf16 v[60:63], a[216:219], a[124:127], v[60:63]
    ds_read_b128 a[228:231], v0 offset:6144
    v_cvt_pk_bf16_f32 v23, v66, v67
    v_mfma_f32_16x16x32_bf16 v[68:71], a[216:219], a[148:151], v[68:71]
    v_exp_f32 v88, v88
    v_mfma_f32_16x16x32_bf16 v[76:79], a[216:219], a[172:175], v[76:79]
    s_waitcnt lgkmcnt(7)
    v_exp_f32 v75, v75
    v_mfma_f32_16x16x32_bf16 v[84:87], a[216:219], a[196:199], v[84:87]
    v_exp_f32 v81, v81
    v_mfma_f32_16x16x32_bf16 v[52:55], a[220:223], a[104:107], v[52:55]
    v_exp_f32 v89, v89
    v_mfma_f32_16x16x32_bf16 v[60:63], a[220:223], a[128:131], v[60:63]
    s_waitcnt lgkmcnt(4)
    v_exp_f32 v74, v74
    v_mfma_f32_16x16x32_bf16 v[68:71], a[220:223], a[152:155], v[68:71]
    ds_read_b128 a[212:215], v0 offset:7168
    v_mfma_f32_16x16x32_bf16 v[76:79], a[220:223], a[176:179], v[76:79]
    s_add_u32 s21, s21, 12032
    v_exp_f32 v57, v57
    v_mfma_f32_16x16x32_bf16 v[84:87], a[220:223], a[200:203], v[84:87]
    s_waitcnt lgkmcnt(3)
    v_exp_f32 v90, v90
    v_mfma_f32_16x16x32_bf16 v[52:55], a[224:227], a[108:111], v[52:55]
    ds_read_b128 a[232:235], v1 offset:6144
    v_fma_f32 v80, v80, s28, v12
    v_mfma_f32_16x16x32_bf16 v[60:63], a[224:227], a[132:135], v[60:63]
    v_exp_f32 v56, v56
    v_mfma_f32_16x16x32_bf16 v[68:71], a[224:227], a[156:159], v[68:71]
    v_cvt_pk_bf16_f32 v17, v58, v59
    v_mfma_f32_16x16x32_bf16 v[76:79], a[224:227], a[180:183], v[76:79]
    s_waitcnt lgkmcnt(2)
    v_cvt_pk_bf16_f32 v16, v56, v57
    v_cvt_pk_bf16_f32 v40, v88, v89
    v_mfma_f32_16x16x32_bf16 v[84:87], a[224:227], a[204:207], v[84:87]
    v_exp_f32 v80, v80
    v_mfma_f32_16x16x32_bf16 v[56:59], a[228:231], a[96:99], 0
    ds_read_b128 a[216:219], v1 offset:7168
    v_mfma_f32_16x16x32_bf16 v[48:51], a[236:239], v[16:19], v[44:47]
    v_cvt_pk_bf16_f32 v29, v74, v75
    v_cvt_pk_bf16_f32 v34, v80, v81
    v_mfma_f32_16x16x32_bf16 v[64:67], a[228:231], a[120:123], 0
    v_exp_f32 v91, v91
    v_mfma_f32_16x16x32_bf16 v[72:75], a[228:231], a[144:147], 0
    v_mfma_f32_16x16x32_bf16 v[80:83], a[228:231], a[168:171], 0
    ds_read_b128 a[160:163], v104 offset:16384
    v_cvt_pk_bf16_f32 v41, v90, v91
    v_mfma_f32_16x16x32_bf16 v[88:91], a[228:231], a[192:195], 0
    s_waitcnt lgkmcnt(2)
    ds_read_b128 a[228:231], v0 offset:8192
    v_mfma_f32_16x16x32_bf16 v[56:59], a[232:235], a[100:103], v[56:59]
    ds_read_b128 a[220:223], v0 offset:2048
    v_mfma_f32_16x16x32_bf16 v[64:67], a[232:235], a[124:127], v[64:67]
    ds_read_b128 a[224:227], v1 offset:2048
    v_mfma_f32_16x16x32_bf16 v[72:75], a[232:235], a[148:151], v[72:75]
    ds_read_b128 a[136:139], v104 offset:10240
    v_mfma_f32_16x16x32_bf16 v[80:83], a[232:235], a[172:175], v[80:83]
    ds_read_b128 a[140:143], v105 offset:10240
    v_mfma_f32_16x16x32_bf16 v[88:91], a[232:235], a[196:199], v[88:91]
    ds_read_b128 a[232:235], v1 offset:8192
    v_mfma_f32_16x16x32_bf16 v[48:51], a[240:243], v[22:25], v[48:51]
    v_mfma_f32_16x16x32_bf16 v[48:51], a[244:247], v[28:31], v[48:51]
    ds_read_b128 a[112:115], v104 offset:4096
    v_mfma_f32_16x16x32_bf16 v[48:51], a[248:251], v[34:37], v[48:51]
    ds_read_b128 a[184:187], v104 offset:22528
    v_mfma_f32_16x16x32_bf16 v[48:51], a[252:255], v[40:43], v[48:51]
    ds_read_b128 a[188:191], v105 offset:22528
    v_mfma_f32_16x16x32_bf16 v[56:59], a[212:215], a[104:107], v[56:59]
    ds_read_b128 a[164:167], v105 offset:16384
    v_mfma_f32_16x16x32_bf16 v[64:67], a[212:215], a[128:131], v[64:67]
    ds_read_b128 a[116:119], v105 offset:4096
    v_mfma_f32_16x16x32_bf16 v[72:75], a[212:215], a[152:155], v[72:75]
    s_nop 1
    v_cmp_lt_f32 vcc, s29, v48
    v_mfma_f32_16x16x32_bf16 v[80:83], a[212:215], a[176:179], v[80:83]
    v_mfma_f32_16x16x32_bf16 v[88:91], a[212:215], a[200:203], v[88:91]
    s_waitcnt lgkmcnt(6)
    v_mfma_f32_16x16x32_bf16 v[56:59], a[216:219], a[108:111], v[56:59]
    s_waitcnt vmcnt(3)
    s_waitcnt vmcnt(8) lgkmcnt(5)
    v_mfma_f32_16x16x32_bf16 v[64:67], a[216:219], a[132:135], v[64:67]
    s_barrier
    v_mfma_f32_16x16x32_bf16 v[72:75], a[216:219], a[156:159], v[72:75]
    s_cbranch_vccnz L_rs_tr55b
L_ret_tr55b:
    s_add_u32 m0, s22, 0
    v_mfma_f32_16x16x32_bf16 v[80:83], a[216:219], a[180:183], v[80:83]
    buffer_load_dwordx4 v6, s[4:7], s20 offen lds
    v_mfma_f32_16x16x32_bf16 v[88:91], a[216:219], a[204:207], v[88:91]
    s_add_u32 s20, s20, 128
    ds_read_b64_tr_b16 a[212:213], v2 offset:18432
    s_waitcnt lgkmcnt(3)
    v_mfma_f32_16x16x32_bf16 v[52:55], a[220:223], a[112:115], v[52:55]
    ds_read_b64_tr_b16 a[214:215], v2 offset:12288
    s_add_u32 m0, s22, 1024
    v_mfma_f32_16x16x32_bf16 v[60:63], a[220:223], a[136:139], v[60:63]
    buffer_load_dwordx4 v6, s[4:7], s20 offen lds
    v_mfma_f32_16x16x32_bf16 v[68:71], a[220:223], a[160:163], v[68:71]
    v_mfma_f32_16x16x32_bf16 v[76:79], a[220:223], a[184:187], v[76:79]
    s_add_u32 s20, s20, 128
    s_add_u32 m0, s22, 2048
    v_mfma_f32_16x16x32_bf16 v[84:87], a[220:223], a[208:211], v[84:87]
    s_waitcnt lgkmcnt(2)
    v_mfma_f32_16x16x32_bf16 v[52:55], a[224:227], a[116:119], v[52:55]
    buffer_load_dwordx4 v6, s[4:7], s20 offen lds
    v_mfma_f32_16x16x32_bf16 v[60:63], a[224:227], a[140:143], v[60:63]
    v_mfma_f32_16x16x32_bf16 v[68:71], a[224:227], a[164:167], v[68:71]
    v_mfma_f32_16x16x32_bf16 v[76:79], a[224:227], a[188:191], v[76:79]
    ds_read_b64_tr_b16 a[216:217], v3 offset:18432
    v_mfma_f32_16x16x32_bf16 v[84:87], a[224:227], v[92:95], v[84:87]
    ds_read_b64_tr_b16 a[218:219], v3 offset:12288
    v_mfma_f32_16x16x32_bf16 v[56:59], a[228:231], a[112:115], v[56:59]
    v_mfma_f32_16x16x32_bf16 v[64:67], a[228:231], a[136:139], v[64:67]
    v_mfma_f32_16x16x32_bf16 v[72:75], a[228:231], a[160:163], v[72:75]
    v_mfma_f32_16x16x32_bf16 v[80:83], a[228:231], a[184:187], v[80:83]
    v_mfma_f32_16x16x32_bf16 v[88:91], a[228:231], a[208:211], v[88:91]
    s_add_u32 s20, s20, 12032
    ds_read_b64_tr_b16 a[220:221], v4 offset:18432
    v_mfma_f32_16x16x32_bf16 v[56:59], a[232:235], a[116:119], v[56:59]
    ds_read_b64_tr_b16 a[222:223], v4 offset:12288
    v_mfma_f32_16x16x32_bf16 v[64:67], a[232:235], a[140:143], v[64:67]
    ds_read_b64_tr_b16 a[224:225], v5 offset:18432
    v_mfma_f32_16x16x32_bf16 v[72:75], a[232:235], a[164:167], v[72:75]
    ds_read_b64_tr_b16 a[226:227], v5 offset:12288
    v_mfma_f32_16x16x32_bf16 v[80:83], a[232:235], a[188:191], v[80:83]
    v_mfma_f32_16x16x32_bf16 v[88:91], a[232:235], v[92:95], v[88:91]
    v_mbcnt_lo_u32_b32 v104, -1, 0
    s_waitcnt lgkmcnt(4)
    v_mfma_f32_16x16x32_bf16 v[112:115], a[212:215], v[16:19], v[112:115]
    v_max3_f32 v96, v52, v53, v54
    v_max3_f32 v96, v96, v55, v56
    v_max3_f32 v96, v96, v57, v58
    v_max_f32 v96, v96, v59
    v_mov_b32 v97, v96
    v_mfma_f32_16x16x32_bf16 v[116:119], a[216:219], v[16:19], v[116:119]
    s_mov_b32 s67, s34
    v_mbcnt_hi_u32_b32 v104, -1, v104
    v_permlane32_swap_b32 v97, v96
    v_max_f32 v96, v96, v97
    v_mov_b32 v97, v96
    v_mfma_f32_16x16x32_bf16 v[164:167], a[216:219], v[22:25], v[164:167]
    s_nop 0
    v_permlane16_swap_b32 v97, v96
    v_rcp_f32 v50, v50
    v_max_f32 v96, v96, v97
    v_mul_f32_e64 v9, -s28, v96
    v_lshrrev_b32 v106, 5, v104
    v_mfma_f32_16x16x32_bf16 v[160:163], a[212:215], v[22:25], v[160:163]
    s_add_u32 s18, s34, 30720
    ds_read_b64_tr_b16 a[232:233], v3 offset:19456
    v_max3_f32 v96, v60, v61, v62
    v_max3_f32 v96, v96, v63, v64
    v_max3_f32 v96, v96, v65, v66
    v_bfe_u32 v105, v104, 3, 1
    v_mfma_f32_16x16x32_bf16 v[208:211], a[212:215], v[28:31], v[208:211]
    s_mov_b32 s34, s33
    v_max_f32 v96, v96, v67
    v_mov_b32 v97, v96
    v_mfma_f32_16x16x32_bf16 v[212:215], a[216:219], v[28:31], v[212:215]
    s_add_u32 s64, s64, s62
    v_rcp_f32 v49, v49
    v_mov_b32 v100, v48
    v_mfma_f32_16x16x32_bf16 a[4:7], a[216:219], v[34:37], a[4:7]
    ds_read_b64_tr_b16 a[228:229], v2 offset:19456
    v_permlane32_swap_b32 v97, v96
    v_mfma_f32_16x16x32_bf16 a[0:3], a[212:215], v[34:37], a[0:3]
    s_add_u32 s64, s64, 196608
    v_max_f32 v96, v96, v97
    v_mov_b32 v97, v96
    v_mfma_f32_16x16x32_bf16 a[48:51], a[212:215], v[40:43], a[48:51]
    s_mov_b32 s39, s64
    v_permlane16_swap_b32 v97, v96
    v_max_f32 v96, v96, v97
    v_mfma_f32_16x16x32_bf16 a[52:55], a[216:219], v[40:43], a[52:55]
    s_waitcnt lgkmcnt(2)
    ds_read_b64_tr_b16 a[230:231], v2 offset:13312
    v_mul_f32_e64 v10, -s28, v96
    v_max3_f32 v96, v68, v69, v70
    v_mfma_f32_16x16x32_bf16 a[56:59], a[220:223], v[40:43], a[56:59]
    v_max3_f32 v96, v96, v71, v72
    v_max3_f32 v96, v96, v73, v74
    v_max_f32 v96, v96, v75
    v_mov_b32 v97, v96
    v_mfma_f32_16x16x32_bf16 a[60:63], a[224:227], v[40:43], a[60:63]
    s_add_u32 s37, s37, 1
    ds_read_b64_tr_b16 a[234:235], v3 offset:13312
    v_permlane32_swap_b32 v97, v96
    v_mfma_f32_16x16x32_bf16 a[12:15], a[224:227], v[34:37], a[12:15]
    s_bitcmp1_b32 s63, s37
    ds_read_b64_tr_b16 a[218:219], v5 offset:13312
    v_max_f32 v96, v96, v97
    v_mov_b32 v97, v96
    v_mfma_f32_16x16x32_bf16 a[8:11], a[220:223], v[34:37], a[8:11]
    s_nop 0
    v_permlane16_swap_b32 v97, v96
    v_mfma_f32_16x16x32_bf16 v[216:219], a[220:223], v[28:31], v[216:219]
    s_cselect_b32 s62, 4294770688, 0
    v_max_f32 v96, v96, v97
    v_mul_f32_e64 v11, -s28, v96
    v_fma_f32 v66, v66, s28, v10
    v_max3_f32 v96, v76, v77, v78
    v_max3_f32 v96, v96, v79, v80
    v_max3_f32 v96, v96, v81, v82
    v_xor_b32 v106, v106, v105
    v_max_f32 v96, v96, v83
    v_mfma_f32_16x16x32_bf16 v[220:223], a[224:227], v[28:31], v[220:223]
    s_cselect_b32 s42, 0, 325632
    v_and_b32 v107, 3, v104
    v_mov_b32 v97, v96
    v_mfma_f32_16x16x32_bf16 v[172:175], a[224:227], v[22:25], v[172:175]
    s_add_u32 s35, s35, s42
    ds_read_b64_tr_b16 a[212:213], v4 offset:19456
    v_fma_f32 v62, v62, s28, v10
    v_permlane32_swap_b32 v97, v96
    v_lshl_or_b32 v106, v107, 1, v106
    v_permlane32_swap_b32 v48, v100
    v_mfma_f32_16x16x32_bf16 v[168:171], a[220:223], v[22:25], v[168:171]
    s_lshl_b32 s42, s37, 1
    v_max_f32 v96, v96, v97
    v_mul_f32 v167, v167, v49
    v_fma_f32 v61, v61, s28, v10
    v_mfma_f32_16x16x32_bf16 v[120:123], a[220:223], v[16:19], v[120:123]
    s_lshr_b32 s42, s31, s42
    ds_read_b64_tr_b16 a[214:215], v4 offset:13312
    v_exp_f32 v62, v62
    v_mov_b32 v97, v96
    v_mfma_f32_16x16x32_bf16 v[124:127], a[224:227], v[16:19], v[124:127]
    s_and_b32 s42, s42, 3
    ds_read_b64_tr_b16 a[216:217], v5 offset:19456
    v_fma_f32 v55, v55, s28, v9
    s_waitcnt lgkmcnt(3)
    v_mfma_f32_16x16x32_bf16 v[128:131], a[228:231], v[16:19], v[128:131]
    s_add_u32 s42, s42, s36
    v_permlane16_swap_b32 v97, v96
    v_mfma_f32_16x16x32_bf16 v[132:135], a[232:235], v[16:19], v[132:135]
    s_sub_u32 s43, s42, 3
    ds_read_b64_tr_b16 a[220:221], v2 offset:20480
    v_fma_f32 v70, v70, s28, v11
    v_fma_f32 v63, v63, s28, v10
    v_max_f32 v96, v96, v97
    v_fma_f32 v72, v72, s28, v11
    v_xor_b32 v105, s65, v105
    v_mul_f32_e64 v12, -s28, v96
    v_max3_f32 v96, v84, v85, v86
    v_mfma_f32_16x16x32_bf16 v[180:183], a[232:235], v[22:25], v[180:183]
    s_cmp_ge_u32 s42, 3
    v_mul_f32 v171, v171, v49
    v_fma_f32 v68, v68, s28, v11
    v_fma_f32 v57, v57, s28, v9
    v_fma_f32 v59, v59, s28, v9
    v_fma_f32 v82, v82, s28, v12
    v_mfma_f32_16x16x32_bf16 v[176:179], a[228:231], v[22:25], v[176:179]
    s_cselect_b32 s42, s43, s42
    v_lshl_add_u32 v101, v105, 10, s38
    v_max3_f32 v96, v96, v87, v88
    v_mfma_f32_16x16x32_bf16 v[224:227], a[228:231], v[28:31], v[224:227]
    s_mul_i32 s44, s3, 5
    ds_read_b64_tr_b16 a[224:225], v3 offset:20480
    v_max3_f32 v96, v96, v89, v90
    v_mfma_f32_16x16x32_bf16 v[228:231], a[232:235], v[28:31], v[228:231]
    s_mov_b32 s32, 1
    v_fma_f32 v78, v78, s28, v12
    v_fma_f32 v81, v81, s28, v12
    v_mfma_f32_16x16x32_bf16 a[20:23], a[232:235], v[34:37], a[20:23]
    s_lshl_b32 s43, s3, 2
    ds_read_b64_tr_b16 a[222:223], v2 offset:14336
    v_rcp_f32 v48, v48
    v_mfma_f32_16x16x32_bf16 a[16:19], a[228:231], v[34:37], a[16:19]
    s_add_u32 s45, s43, 21
    v_accvgpr_read_b32 v108, a48
    v_fma_f32 v54, v54, s28, v9
    v_mfma_f32_16x16x32_bf16 a[64:67], a[228:231], v[40:43], a[64:67]
    s_cmp_eq_u32 s3, 0
    ds_read_b64_tr_b16 a[230:231], v4 offset:14336
    v_mul_f32 v161, v161, v49
    v_mfma_f32_16x16x32_bf16 a[68:71], a[232:235], v[40:43], a[68:71]
    s_waitcnt lgkmcnt(3)
    ds_read_b64_tr_b16 a[226:227], v3 offset:14336
    v_and_b32 v107, 7, v104
    v_mfma_f32_16x16x32_bf16 a[72:75], a[212:215], v[40:43], a[72:75]
    s_cselect_b32 s45, 20, s45
    v_max_f32 v96, v96, v91
    v_fma_f32 v53, v53, s28, v9
    v_mfma_f32_16x16x32_bf16 a[76:79], a[216:219], v[40:43], a[76:79]
    s_cselect_b32 s33, 1, 0
    ds_read_b64_tr_b16 a[228:229], v4 offset:20480
    v_fma_f32 v69, v69, s28, v11
    v_mfma_f32_16x16x32_bf16 a[28:31], a[216:219], v[34:37], a[28:31]
    s_cmp_eq_u32 s42, 1
    v_mul_f32 v169, v169, v49
    s_cselect_b32 s44, s45, s44
    v_mfma_f32_16x16x32_bf16 a[24:27], a[212:215], v[34:37], a[24:27]
    s_cselect_b32 s32, s33, s32
    v_fma_f32 v75, v75, s28, v11
    v_exp_f32 v61, v61
    v_mfma_f32_16x16x32_bf16 v[232:235], a[212:215], v[28:31], v[232:235]
    s_add_u32 s45, s43, 37
    v_mov_b32 v97, v96
    v_mul_f32 v164, v164, v49
    v_mfma_f32_16x16x32_bf16 v[236:239], a[216:219], v[28:31], v[236:239]
    s_cmp_eq_u32 s42, 2
    v_fma_f32 v71, v71, s28, v11
    v_permlane32_swap_b32 v97, v96
    v_mfma_f32_16x16x32_bf16 v[188:191], a[216:219], v[22:25], v[188:191]
    s_cselect_b32 s44, s45, s44
    ds_read_b64_tr_b16 a[234:235], v5 offset:14336
    v_fma_f32 v65, v65, s28, v10
    v_mfma_f32_16x16x32_bf16 v[184:187], a[212:215], v[22:25], v[184:187]
    s_cselect_b32 s32, 0, s32
    v_mul_f32 v172, v172, v49
    v_max_f32 v96, v96, v97
    v_exp_f32 v72, v72
    v_fma_f32 v80, v80, s28, v12
    v_exp_f32 v63, v63
    v_pk_mul_f32 v[212:213], v[212:213], v[50:51] op_sel_hi:[1,0]
    s_mul_i32 s44, s44, 6144
    v_mul_f32 v185, v185, v49
    v_mfma_f32_16x16x32_bf16 v[136:139], a[212:215], v[16:19], v[136:139]
    s_add_u32 s33, s35, s44
    ds_read_b64_tr_b16 a[232:233], v5 offset:20480
    v_lshl_add_u32 v101, v106, 4, v101
    v_mfma_f32_16x16x32_bf16 v[140:143], a[216:219], v[16:19], v[140:143]
    s_waitcnt lgkmcnt(2)
    v_exp_f32 v54, v54
    v_mul_f32 v176, v176, v49
    v_mfma_f32_16x16x32_bf16 v[144:147], a[220:223], v[16:19], v[144:147]
    s_mul_i32 s42, s32, 6144
    v_fma_f32 v76, v76, s28, v12
    v_mul_f32 v178, v178, v49
    v_exp_f32 v68, v68
    v_cvt_pk_bf16_f32 v21, v62, v63
    v_mfma_f32_16x16x32_bf16 v[148:151], a[224:227], v[16:19], v[148:151]
    s_add_u32 s42, s42, 24576
    v_exp_f32 v78, v78
    v_lshl_add_u32 v101, v107, 7, v101
    v_fma_f32 v60, v60, s28, v10
    v_mov_b32 v97, v96
    v_mfma_f32_16x16x32_bf16 v[196:199], a[224:227], v[22:25], v[196:199]
    s_add_u32 s42, s42, s33
    v_exp_f32 v53, v53
    v_mfma_f32_16x16x32_bf16 v[192:195], a[220:223], v[22:25], v[192:195]
    s_cmp_ge_u32 s37, 6
    v_permlane16_swap_b32 v97, v96
    v_fma_f32 v77, v77, s28, v12
    v_accvgpr_read_b32 v105, a1
    v_mfma_f32_16x16x32_bf16 v[240:243], a[220:223], v[28:31], v[240:243]
    s_cselect_b32 s14, 0, s42
    v_mul_f32 v160, v160, v49
    v_fma_f32 v52, v52, s28, v9
    v_mfma_f32_16x16x32_bf16 v[244:247], a[224:227], v[28:31], v[244:247]
    s_add_u32 s24, s67, 256
    v_mul_f32 v183, v183, v49
    v_exp_f32 v69, v69
    v_mfma_f32_16x16x32_bf16 a[36:39], a[224:227], v[34:37], a[36:39]
    s_add_u32 s25, s33, 256
    v_exp_f32 v52, v52
    v_fma_f32 v74, v74, s28, v11
    v_mfma_f32_16x16x32_bf16 a[32:35], a[220:223], v[34:37], a[32:35]
    s_add_u32 s23, s38, 4096
    v_exp_f32 v70, v70
    v_mfma_f32_16x16x32_bf16 a[80:83], a[220:223], v[40:43], a[80:83]
    s_mov_b32 s27, 0x49249249
    v_exp_f32 v71, v71
    v_mfma_f32_16x16x32_bf16 a[84:87], a[224:227], v[40:43], a[84:87]
    s_mov_b32 s30, 0
    v_max_f32 v96, v96, v97
    v_fma_f32 v79, v79, s28, v12
    v_mfma_f32_16x16x32_bf16 a[88:91], a[228:231], v[40:43], a[88:91]
    s_waitcnt vmcnt(8) lgkmcnt(0)
    v_exp_f32 v60, v60
    v_mul_f32_e64 v13, -s28, v96
    v_fma_f32 v86, v86, s28, v13
    v_mfma_f32_16x16x32_bf16 a[92:95], a[232:235], v[40:43], a[92:95]
    s_barrier
    ds_read_b128 a[216:219], v1 offset:12288
    v_mfma_f32_16x16x32_bf16 a[44:47], a[232:235], v[34:37], a[44:47]
    ds_read_b128 a[220:223], v0 offset:13312
    v_mul_f32 v197, v197, v49
    v_mul_f32 v186, v186, v49
    v_mfma_f32_16x16x32_bf16 a[40:43], a[228:231], v[34:37], a[40:43]
    v_mul_f32 v173, v173, v49
    v_exp_f32 v66, v66
    v_fma_f32 v91, v91, s28, v13
    v_bfe_u32 v107, v104, 4, 1
    v_fma_f32 v64, v64, s28, v10
    v_mfma_f32_16x16x32_bf16 v[248:251], a[228:231], v[28:31], v[248:251]
    ds_read_b128 a[212:215], v0 offset:12288
    v_exp_f32 v55, v55
    v_fma_f32 v58, v58, s28, v9
    v_exp_f32 v91, v91
    v_fma_f32 v85, v85, s28, v13
    v_pk_mul_f32 v[116:117], v[116:117], v[48:49] op_sel_hi:[1,0]
    v_exp_f32 v79, v79
    v_pk_mul_f32 v[112:113], v[112:113], v[48:49] op_sel_hi:[1,0]
    v_exp_f32 v86, v86
    v_fma_f32 v67, v67, s28, v10
    v_lshl_add_u32 v101, v107, 3, v101
    v_fma_f32 v87, v87, s28, v13
    v_mfma_f32_16x16x32_bf16 v[252:255], a[232:235], v[28:31], v[252:255]
    v_mul_f32 v190, v190, v49
    v_exp_f32 v80, v80
    v_cvt_pk_bf16_f32 v14, v52, v53
    v_rcp_f32 v51, v51
    v_mfma_f32_16x16x32_bf16 v[204:207], a[232:235], v[22:25], v[204:207]
    v_cvt_pk_bf16_f32 v15, v54, v55
    v_cvt_pk_bf16_f32 v26, v68, v69
    v_mul_f32 v165, v165, v49
    v_mfma_f32_16x16x32_bf16 v[200:203], a[228:231], v[22:25], v[200:203]
    v_exp_f32 v76, v76
    v_exp_f32 v67, v67
    v_mul_f32 v194, v194, v49
    v_mfma_f32_16x16x32_bf16 v[152:155], a[228:231], v[16:19], v[152:155]
    v_exp_f32 v77, v77
    v_cvt_pk_bf16_f32 v20, v60, v61
    v_mul_f32 v184, v184, v49
    v_mfma_f32_16x16x32_bf16 v[156:159], a[232:235], v[16:19], v[156:159]
    s_waitcnt lgkmcnt(0)
    v_fma_f32 v83, v83, s28, v12
    v_exp_f32 v65, v65
    v_mul_f32 v199, v199, v49
    v_mfma_f32_16x16x32_bf16 v[52:55], a[212:215], a[96:99], 0
    v_accvgpr_read_b32 v107, a3
    v_fma_f32 v88, v88, s28, v13
    v_mfma_f32_16x16x32_bf16 v[52:55], a[216:219], a[100:103], v[52:55]
    ds_read_b128 a[232:235], v1 offset:14336
    v_fma_f32 v56, v56, s28, v9
    v_cvt_pk_bf16_f32 v27, v70, v71
    v_cvt_pk_bf16_f32 v184, v184, v185
    v_mfma_f32_16x16x32_bf16 v[52:55], a[220:223], a[104:107], v[52:55]
    v_exp_f32 v74, v74
    v_mfma_f32_16x16x32_bf16 v[60:63], a[220:223], a[128:131], 0
    ds_read_b128 a[224:227], v1 offset:13312
    v_fma_f32 v90, v90, s28, v13
    v_mov_b32 v104, v100
    v_cvt_pk_bf16_f32 v33, v78, v79
    v_mfma_f32_16x16x32_bf16 v[60:63], a[216:219], a[124:127], v[60:63]
    s_add_u32 m0, s22, 36864
    ds_read_b128 a[228:231], v0 offset:14336
    v_exp_f32 v57, v57
    v_exp_f32 v75, v75
    v_mfma_f32_16x16x32_bf16 v[60:63], a[212:215], a[120:123], v[60:63]
    v_fma_f32 v84, v84, s28, v13
    v_exp_f32 v84, v84
    v_cvt_pk_bf16_f32 v32, v76, v77
    v_mul_f32 v182, v182, v49
    v_mfma_f32_16x16x32_bf16 v[68:71], a[212:215], a[144:147], 0
    v_exp_f32 v87, v87
    v_fma_f32 v73, v73, s28, v11
    v_mfma_f32_16x16x32_bf16 v[68:71], a[216:219], a[148:151], v[68:71]
    v_mul_f32 v163, v163, v49
    v_exp_f32 v85, v85
    v_cvt_pk_bf16_f32 v160, v160, v161
    v_mfma_f32_16x16x32_bf16 v[68:71], a[220:223], a[152:155], v[68:71]
    v_cvt_pk_bf16_f32 v39, v86, v87
    v_cvt_pk_bf16_f32 v38, v84, v85
    v_mfma_f32_16x16x32_bf16 v[76:79], a[220:223], a[176:179], 0
    buffer_load_dwordx4 v6, s[8:11], s21 offen lds
    v_permlane16_swap_b32 v100, v104
    v_mfma_f32_16x16x32_bf16 v[76:79], a[216:219], a[172:175], v[76:79]
    v_mul_f32 v201, v201, v49
    v_exp_f32 v81, v81
    v_mfma_f32_16x16x32_bf16 v[76:79], a[212:215], a[168:171], v[76:79]
    s_add_u32 s21, s21, 128
    v_mul_f32 v168, v168, v49
    v_cvt_pk_bf16_f32 v168, v168, v169
    v_mfma_f32_16x16x32_bf16 v[84:87], a[212:215], a[192:195], 0
    v_rcp_f32 v100, v100
    v_exp_f32 v90, v90
    v_mfma_f32_16x16x32_bf16 v[84:87], a[216:219], a[196:199], v[84:87]
    ds_read_b128 a[212:215], v0 offset:18432
    v_mul_f32 v198, v198, v49
    v_cvt_pk_bf16_f32 v34, v80, v81
    v_accvgpr_read_b32 v111, a51
    v_accvgpr_read_b32 v109, a49
    v_mfma_f32_16x16x32_bf16 v[84:87], a[220:223], a[200:203], v[84:87]
    s_waitcnt lgkmcnt(1)
    v_exp_f32 v59, v59
    v_exp_f32 v64, v64
    v_mfma_f32_16x16x32_bf16 v[84:87], a[224:227], a[204:207], v[84:87]
    v_mul_f32 v187, v187, v49
    v_accvgpr_read_b32 v104, a0
    v_mfma_f32_16x16x32_bf16 v[84:87], a[228:231], a[208:211], v[84:87]
    v_mul_f32 v107, v107, v51
    v_cvt_pk_bf16_f32 v112, v112, v113
    v_mfma_f32_16x16x32_bf16 v[84:87], a[232:235], v[92:95], v[84:87]
    v_exp_f32 v82, v82
    v_mfma_f32_16x16x32_bf16 v[76:79], a[232:235], a[188:191], v[76:79]
    s_add_u32 m0, s22, 37888
    v_mul_f32 v179, v179, v49
    v_mul_f32 v188, v188, v49
    v_mfma_f32_16x16x32_bf16 v[76:79], a[228:231], a[184:187], v[76:79]
    v_cvt_pk_bf16_f32 v23, v66, v67
    v_exp_f32 v83, v83
    v_mfma_f32_16x16x32_bf16 v[76:79], a[224:227], a[180:183], v[76:79]
    v_exp_f32 v56, v56
    v_mfma_f32_16x16x32_bf16 v[68:71], a[224:227], a[156:159], v[68:71]
    v_fma_f32 v89, v89, s28, v13
    v_mul_f32 v177, v177, v49
    v_mfma_f32_16x16x32_bf16 v[68:71], a[228:231], a[160:163], v[68:71]
    ds_read_b128 a[220:223], v0 offset:19456
    v_cvt_pk_bf16_f32 v35, v82, v83
    v_mul_f32 v193, v193, v49
    v_mfma_f32_16x16x32_bf16 v[68:71], a[232:235], a[164:167], v[68:71]
    v_cvt_pk_bf16_f32 v41, v90, v91
    v_fma_f32 v79, v79, s28, v12
    v_mfma_f32_16x16x32_bf16 v[60:63], a[232:235], a[140:143], v[60:63]
    ds_read_b128 a[216:219], v1 offset:18432
    buffer_load_dwordx4 v6, s[8:11], s21 offen lds
    v_mfma_f32_16x16x32_bf16 v[60:63], a[228:231], a[136:139], v[60:63]
    v_fma_f32 v78, v78, s28, v12
    v_accvgpr_read_b32 v110, a50
    v_exp_f32 v73, v73
    v_mfma_f32_16x16x32_bf16 v[60:63], a[224:227], a[132:135], v[60:63]
    v_exp_f32 v58, v58
    v_mfma_f32_16x16x32_bf16 v[52:55], a[224:227], a[108:111], v[52:55]
    v_mul_f32 v170, v170, v49
    v_exp_f32 v88, v88
    v_mul_f32 v162, v162, v49
    v_mfma_f32_16x16x32_bf16 v[52:55], a[228:231], a[112:115], v[52:55]
    ds_read_b128 a[228:231], v0 offset:20480
    v_cvt_pk_bf16_f32 v22, v64, v65
    v_exp_f32 v78, v78
    v_cvt_pk_bf16_f32 v172, v172, v173
    v_pk_mul_f32 v[208:209], v[208:209], v[50:51] op_sel_hi:[1,0]
    v_pk_mul_f32 v[118:119], v[118:119], v[48:49] op_sel_hi:[1,0]
    v_pk_mul_f32 v[120:121], v[120:121], v[48:49] op_sel_hi:[1,0]
    v_cvt_pk_bf16_f32 v116, v116, v117
    v_mul_f32 v104, v104, v51
    v_cvt_pk_bf16_f32 v161, v162, v163
    v_exp_f32 v89, v89
    v_pk_mul_f32 v[236:237], v[236:237], v[50:51] op_sel_hi:[1,0]
    v_cvt_pk_bf16_f32 v212, v212, v213
    v_accvgpr_read_b32 v106, a2
    v_pk_mul_f32 v[210:211], v[210:211], v[50:51] op_sel_hi:[1,0]
    v_pk_mul_f32 v[124:125], v[124:125], v[48:49] op_sel_hi:[1,0]
    v_pk_mul_f32 v[218:219], v[218:219], v[50:51] op_sel_hi:[1,0]
    v_cvt_pk_bf16_f32 v16, v56, v57
    v_pk_mul_f32 v[220:221], v[220:221], v[50:51] op_sel_hi:[1,0]
    v_pk_mul_f32 v[110:111], v[110:111], v[100:101] op_sel_hi:[1,0]
    v_pk_mul_f32 v[250:251], v[250:251], v[50:51] op_sel_hi:[1,0]
    v_pk_mul_f32 v[232:233], v[232:233], v[50:51] op_sel_hi:[1,0]
    v_fma_f32 v70, v70, s28, v11
    v_cvt_pk_bf16_f32 v17, v58, v59
    v_fma_f32 v60, v60, s28, v10
    v_cvt_pk_bf16_f32 v176, v176, v177
    v_pk_mul_f32 v[140:141], v[140:141], v[48:49] op_sel_hi:[1,0]
    v_pk_mul_f32 v[230:231], v[230:231], v[50:51] op_sel_hi:[1,0]
    v_mul_f32 v203, v203, v49
    v_pk_mul_f32 v[114:115], v[114:115], v[48:49] op_sel_hi:[1,0]
    v_mul_f32 v106, v106, v51
    v_fma_f32 v63, v63, s28, v10
    v_pk_mul_f32 v[214:215], v[214:215], v[50:51] op_sel_hi:[1,0]
    v_pk_mul_f32 v[108:109], v[108:109], v[100:101] op_sel_hi:[1,0]
    v_mul_f32 v105, v105, v51
    v_cvt_pk_bf16_f32 v108, v108, v109
    v_cvt_pk_bf16_f32 v28, v72, v73
    v_cvt_pk_bf16_f32 v124, v124, v125
    v_mul_f32 v166, v166, v49
    v_mul_f32 v195, v195, v49
    v_mfma_f32_16x16x32_bf16 v[44:47], a[236:239], v[14:17], 0
    v_fma_f32 v84, v84, s28, v13
    v_cvt_pk_bf16_f32 v40, v88, v89
    v_mfma_f32_16x16x32_bf16 v[52:55], a[232:235], a[116:119], v[52:55]
    s_waitcnt lgkmcnt(0)
    v_cvt_pk_bf16_f32 v208, v208, v209
    v_mul_f32 v205, v205, v49
    v_mfma_f32_16x16x32_bf16 v[56:59], a[212:215], a[96:99], 0
    ds_read_b128 a[224:227], v1 offset:19456
    v_cvt_pk_bf16_f32 v29, v74, v75
    v_cvt_pk_bf16_f32 v232, v232, v233
    v_cvt_pk_bf16_f32 v164, v164, v165
    v_cvt_pk_bf16_f32 v236, v236, v237
    v_pk_mul_f32 v[216:217], v[216:217], v[50:51] op_sel_hi:[1,0]
    v_pk_mul_f32 v[248:249], v[248:249], v[50:51] op_sel_hi:[1,0]
    v_pk_mul_f32 v[132:133], v[132:133], v[48:49] op_sel_hi:[1,0]
    v_pk_mul_f32 v[228:229], v[228:229], v[50:51] op_sel_hi:[1,0]
    v_cvt_pk_bf16_f32 v213, v214, v215
    v_fma_f32 v61, v61, s28, v10
    v_mfma_f32_16x16x32_bf16 v[56:59], a[216:219], a[100:103], v[56:59]
    ds_read_b128 a[232:235], v1 offset:20480
    v_fma_f32 v77, v77, s28, v12
    v_mfma_f32_16x16x32_bf16 v[56:59], a[220:223], a[104:107], v[56:59]
    v_cvt_pk_bf16_f32 v109, v110, v111
    v_accvgpr_read_b32 v110, a54
    v_mfma_f32_16x16x32_bf16 v[64:67], a[220:223], a[128:131], 0
    s_add_u32 s21, s21, 128
    v_exp_f32 v77, v77
    v_mfma_f32_16x16x32_bf16 v[64:67], a[216:219], a[124:127], v[64:67]
    v_cvt_pk_bf16_f32 v113, v114, v115
    v_fma_f32 v71, v71, s28, v11
    v_cvt_pk_bf16_f32 v104, v104, v105
    v_subrev_u32 v8, 28672, v8
    v_mfma_f32_16x16x32_bf16 v[64:67], a[212:215], a[120:123], v[64:67]
    s_add_u32 m0, s22, 38912
    v_exp_f32 v61, v61
    v_mfma_f32_16x16x32_bf16 v[72:75], a[212:215], a[144:147], 0
    v_exp_f32 v84, v84
    v_cvt_pk_bf16_f32 v209, v210, v211
    v_fma_f32 v69, v69, s28, v11
    v_mfma_f32_16x16x32_bf16 v[72:75], a[216:219], a[148:151], v[72:75]
    ds_write2st64_b64 v101, v[112:113], v[160:161] offset0:0 offset1:12
    v_mfma_f32_16x16x32_bf16 v[72:75], a[220:223], a[152:155], v[72:75]
    buffer_load_dwordx4 v6, s[8:11], s21 offen lds
    v_mfma_f32_16x16x32_bf16 v[80:83], a[220:223], a[176:179], 0
    s_add_u32 s21, s21, 12032
    v_cvt_pk_bf16_f32 v105, v106, v107
    v_fma_f32 v76, v76, s28, v12
    v_mfma_f32_16x16x32_bf16 v[80:83], a[216:219], a[172:175], v[80:83]
    s_waitcnt vmcnt(6) lgkmcnt(1)
    v_cvt_pk_bf16_f32 v177, v178, v179
    v_cvt_pk_bf16_f32 v117, v118, v119
    v_mfma_f32_16x16x32_bf16 v[80:83], a[212:215], a[168:171], v[80:83]
    s_barrier
    v_mul_f32 v202, v202, v49
    v_exp_f32 v63, v63
    v_mfma_f32_16x16x32_bf16 v[88:91], a[212:215], a[192:195], 0
    ds_read_b64_tr_b16 a[212:213], v2 offset:0
    v_fma_f32 v68, v68, s28, v11
    v_mfma_f32_16x16x32_bf16 v[88:91], a[216:219], a[196:199], v[88:91]
    v_mul_f32 v189, v189, v49
    v_cvt_pk_bf16_f32 v216, v216, v217
    v_mfma_f32_16x16x32_bf16 v[88:91], a[220:223], a[200:203], v[88:91]
    s_add_u32 m0, s22, 12288
    ds_write2st64_b64 v101, v[208:209], v[104:105] offset0:24 offset1:36
    v_fma_f32 v52, v52, s28, v9
    v_mfma_f32_16x16x32_bf16 v[44:47], a[240:243], v[20:23], v[44:47]
    ds_write_b64 v101, v[108:109] offset:24576
    v_fma_f32 v53, v53, s28, v9
    v_accvgpr_read_b32 v107, a7
    v_pk_mul_f32 v[144:145], v[144:145], v[48:49] op_sel_hi:[1,0]
    v_pk_mul_f32 v[136:137], v[136:137], v[48:49] op_sel_hi:[1,0]
    v_pk_mul_f32 v[244:245], v[244:245], v[50:51] op_sel_hi:[1,0]
    v_cvt_pk_bf16_f32 v169, v170, v171
    v_xor_b32 v101, 32, v101
    v_accvgpr_read_b32 v105, a5
    v_mfma_f32_16x16x32_bf16 v[88:91], a[224:227], a[204:207], v[88:91]
    v_cvt_pk_bf16_f32 v185, v186, v187
    v_accvgpr_read_b32 v104, a4
    v_cvt_pk_bf16_f32 v120, v120, v121
    v_mfma_f32_16x16x32_bf16 v[88:91], a[228:231], a[208:211], v[88:91]
    v_exp_f32 v79, v79
    v_mul_f32 v105, v105, v51
    v_mfma_f32_16x16x32_bf16 v[88:91], a[232:235], v[92:95], v[88:91]
    ds_read_b64_tr_b16 a[214:215], v2 offset:6144
    v_mul_f32 v104, v104, v51
    v_accvgpr_read_b32 v109, a53
    v_mfma_f32_16x16x32_bf16 v[80:83], a[232:235], a[188:191], v[80:83]
    v_mul_f32 v192, v192, v49
    v_mul_f32 v174, v174, v49
    v_mfma_f32_16x16x32_bf16 v[80:83], a[228:231], a[184:187], v[80:83]
    v_accvgpr_read_b32 v106, a6
    v_mul_f32 v106, v106, v51
    v_mfma_f32_16x16x32_bf16 v[80:83], a[224:227], a[180:183], v[80:83]
    v_cvt_pk_bf16_f32 v140, v140, v141
    v_fma_f32 v90, v90, s28, v13
    v_mfma_f32_16x16x32_bf16 v[72:75], a[224:227], a[156:159], v[72:75]
    ds_read_b64_tr_b16 a[216:217], v3 offset:0
    v_cvt_pk_bf16_f32 v165, v166, v167
    v_accvgpr_read_b32 v108, a52
    v_mfma_f32_16x16x32_bf16 v[72:75], a[228:231], a[160:163], v[72:75]
    ds_read_b64_tr_b16 a[218:219], v3 offset:6144
    v_fma_f32 v62, v62, s28, v10
    v_mfma_f32_16x16x32_bf16 v[72:75], a[232:235], a[164:167], v[72:75]
    ds_read_b64_tr_b16 a[220:221], v4 offset:0
    buffer_load_dwordx4 v6, s[4:7], s20 offen lds
    v_mfma_f32_16x16x32_bf16 v[64:67], a[232:235], a[140:143], v[64:67]
    ds_write2st64_b64 v101, v[116:117], v[164:165] offset0:0 offset1:12
    v_pk_mul_f32 v[240:241], v[240:241], v[50:51] op_sel_hi:[1,0]
    v_mul_f32 v200, v200, v49
    v_pk_mul_f32 v[126:127], v[126:127], v[48:49] op_sel_hi:[1,0]
    v_pk_mul_f32 v[122:123], v[122:123], v[48:49] op_sel_hi:[1,0]
    v_pk_mul_f32 v[154:155], v[154:155], v[48:49] op_sel_hi:[1,0]
    v_pk_mul_f32 v[152:153], v[152:153], v[48:49] op_sel_hi:[1,0]
    v_cvt_pk_bf16_f32 v104, v104, v105
    v_pk_mul_f32 v[128:129], v[128:129], v[48:49] op_sel_hi:[1,0]
    v_pk_mul_f32 v[108:109], v[108:109], v[100:101] op_sel_hi:[1,0]
    v_accvgpr_read_b32 v111, a55
    v_mul_f32 v107, v107, v51
    v_cvt_pk_bf16_f32 v105, v106, v107
    v_fma_f32 v55, v55, s28, v9
    v_fma_f32 v80, v80, s28, v12
    v_pk_mul_f32 v[224:225], v[224:225], v[50:51] op_sel_hi:[1,0]
    v_pk_mul_f32 v[110:111], v[110:111], v[100:101] op_sel_hi:[1,0]
    v_exp_f32 v68, v68
    v_cvt_pk_bf16_f32 v217, v218, v219
    v_mfma_f32_16x16x32_bf16 v[64:67], a[228:231], a[136:139], v[64:67]
    ds_read_b64_tr_b16 a[222:223], v4 offset:6144
    v_cvt_pk_bf16_f32 v108, v108, v109
    v_mfma_f32_16x16x32_bf16 v[64:67], a[224:227], a[132:135], v[64:67]
    s_add_u32 s20, s20, 128
    ds_write2st64_b64 v101, v[212:213], v[104:105] offset0:24 offset1:36
    v_cvt_pk_bf16_f32 v121, v122, v123
    v_fma_f32 v75, v75, s28, v11
    v_mfma_f32_16x16x32_bf16 v[56:59], a[224:227], a[108:111], v[56:59]
    v_exp_f32 v71, v71
    v_cvt_pk_bf16_f32 v109, v110, v111
    v_exp_f32 v60, v60
    v_pk_mul_f32 v[222:223], v[222:223], v[50:51] op_sel_hi:[1,0]
    v_cvt_pk_bf16_f32 v220, v220, v221
    v_exp_f32 v62, v62
    v_pk_mul_f32 v[138:139], v[138:139], v[48:49] op_sel_hi:[1,0]
    v_accvgpr_read_b32 v110, a58
    v_cvt_pk_bf16_f32 v192, v192, v193
    v_mfma_f32_16x16x32_bf16 v[44:47], a[244:247], v[26:29], v[44:47]
    ds_read_b64_tr_b16 a[224:225], v5 offset:0
    v_accvgpr_read_b32 v105, a9
    v_accvgpr_read_b32 v107, a11
    v_mfma_f32_16x16x32_bf16 v[56:59], a[228:231], a[112:115], v[56:59]
    s_add_u32 m0, s22, 13312
    ds_read_b64_tr_b16 a[226:227], v5 offset:6144
    buffer_load_dwordx4 v6, s[4:7], s20 offen lds
    v_accvgpr_read_b32 v104, a8
    v_cvt_pk_bf16_f32 v248, v248, v249
    v_mfma_f32_16x16x32_bf16 v[56:59], a[232:235], a[116:119], v[56:59]
    s_waitcnt lgkmcnt(3)
    v_cvt_pk_bf16_f32 v221, v222, v223
    v_mul_f32 v175, v175, v49
    v_mfma_f32_16x16x32_bf16 v[112:115], a[212:215], v[14:17], 0
    ds_write_b64 v101, v[108:109] offset:24576
    v_mul_f32 v104, v104, v51
    v_cvt_pk_bf16_f32 v188, v188, v189
    v_mfma_f32_16x16x32_bf16 v[116:119], a[216:219], v[14:17], 0
    ds_read_b64_tr_b16 a[228:229], v2 offset:1024
    v_accvgpr_read_b32 v106, a10
    v_accvgpr_read_b32 v109, a57
    v_mfma_f32_16x16x32_bf16 v[164:167], a[216:219], v[20:23], 0
    v_mul_f32 v105, v105, v51
    v_fma_f32 v88, v88, s28, v13
    v_mfma_f32_16x16x32_bf16 v[44:47], a[248:251], v[32:35], v[44:47]
    ds_read_b64_tr_b16 a[230:231], v2 offset:7168
    v_cvt_pk_bf16_f32 v128, v128, v129
    v_mfma_f32_16x16x32_bf16 v[160:163], a[212:215], v[20:23], 0
    v_fma_f32 v64, v64, s28, v10
    v_accvgpr_read_b32 v108, a56
    v_accvgpr_read_b32 v111, a59
    v_cvt_pk_bf16_f32 v104, v104, v105
    v_mul_f32 v191, v191, v49
    v_pk_mul_f32 v[238:239], v[238:239], v[50:51] op_sel_hi:[1,0]
    v_pk_mul_f32 v[242:243], v[242:243], v[50:51] op_sel_hi:[1,0]
    v_pk_mul_f32 v[108:109], v[108:109], v[100:101] op_sel_hi:[1,0]
    v_mul_f32 v106, v106, v51
    v_xor_b32 v101, 96, v101
    v_pk_mul_f32 v[148:149], v[148:149], v[48:49] op_sel_hi:[1,0]
    v_mul_f32 v107, v107, v51
    v_cvt_pk_bf16_f32 v108, v108, v109
    v_pk_mul_f32 v[110:111], v[110:111], v[100:101] op_sel_hi:[1,0]
    v_cvt_pk_bf16_f32 v105, v106, v107
    v_accvgpr_read_b32 v107, a15
    v_accvgpr_read_b32 v106, a14
    v_mfma_f32_16x16x32_bf16 v[208:211], a[212:215], v[26:29], 0
    v_exp_f32 v53, v53
    v_cvt_pk_bf16_f32 v109, v110, v111
    v_mfma_f32_16x16x32_bf16 v[212:215], a[216:219], v[26:29], 0
    ds_write2st64_b64 v101, v[120:121], v[168:169] offset0:0 offset1:12
    v_mfma_f32_16x16x32_bf16 a[4:7], a[216:219], v[32:35], 0
    ds_write2st64_b64 v101, v[216:217], v[104:105] offset0:24 offset1:36
    v_mfma_f32_16x16x32_bf16 a[0:3], a[212:215], v[32:35], 0
    ds_write_b64 v101, v[108:109] offset:24576
    v_mul_f32 v107, v107, v51
    v_accvgpr_read_b32 v105, a13
    v_pk_mul_f32 v[134:135], v[134:135], v[48:49] op_sel_hi:[1,0]
    v_cvt_pk_bf16_f32 v240, v240, v241
    v_mul_f32 v181, v181, v49
    v_cvt_pk_bf16_f32 v125, v126, v127
    v_mul_f32 v180, v180, v49
    v_pk_mul_f32 v[130:131], v[130:131], v[48:49] op_sel_hi:[1,0]
    v_mul_f32 v106, v106, v51
    v_accvgpr_read_b32 v111, a63
    v_mul_f32 v204, v204, v49
    v_fma_f32 v87, v87, s28, v13
    v_cvt_pk_bf16_f32 v180, v180, v181
    v_mfma_f32_16x16x32_bf16 a[48:51], a[212:215], v[38:41], 0
    ds_read_b64_tr_b16 a[234:235], v3 offset:7168
    v_cvt_pk_bf16_f32 v173, v174, v175
    v_accvgpr_read_b32 v110, a62
    v_cvt_pk_bf16_f32 v237, v238, v239
    v_fma_f32 v59, v59, s28, v9
    v_accvgpr_read_b32 v104, a12
    v_xor_b32 v101, 32, v101
    v_cvt_pk_bf16_f32 v228, v228, v229
    v_exp_f32 v64, v64
    v_mul_f32 v104, v104, v51
    v_cvt_pk_bf16_f32 v136, v136, v137
    v_cvt_pk_bf16_f32 v224, v224, v225
    v_pk_mul_f32 v[110:111], v[110:111], v[100:101] op_sel_hi:[1,0]
    v_pk_mul_f32 v[226:227], v[226:227], v[50:51] op_sel_hi:[1,0]
    v_pk_mul_f32 v[234:235], v[234:235], v[50:51] op_sel_hi:[1,0]
    v_pk_mul_f32 v[146:147], v[146:147], v[48:49] op_sel_hi:[1,0]
    v_mul_f32 v105, v105, v51
    v_exp_f32 v52, v52
    v_accvgpr_read_b32 v108, a60
    v_mfma_f32_16x16x32_bf16 a[52:55], a[216:219], v[38:41], 0
    s_add_u32 s20, s20, 128
    ds_read_b64_tr_b16 a[216:217], v5 offset:1024
    v_cvt_pk_bf16_f32 v204, v204, v205
    v_accvgpr_read_b32 v109, a61
    v_exp_f32 v69, v69
    v_cvt_pk_bf16_f32 v129, v130, v131
    v_pk_mul_f32 v[108:109], v[108:109], v[100:101] op_sel_hi:[1,0]
    v_exp_f32 v87, v87
    v_cvt_pk_bf16_f32 v108, v108, v109
    v_mfma_f32_16x16x32_bf16 a[56:59], a[220:223], v[38:41], 0
    s_waitcnt lgkmcnt(2)
    ds_read_b64_tr_b16 a[232:233], v3 offset:1024
    v_fma_f32 v82, v82, s28, v12
    v_fma_f32 v56, v56, s28, v9
    v_mfma_f32_16x16x32_bf16 a[60:63], a[224:227], v[38:41], 0
    ds_read_b64_tr_b16 a[218:219], v5 offset:7168
    v_cvt_pk_bf16_f32 v137, v138, v139
    v_cvt_pk_bf16_f32 v104, v104, v105
    v_mfma_f32_16x16x32_bf16 a[12:15], a[224:227], v[32:35], 0
    ds_write2st64_b64 v101, v[124:125], v[172:173] offset0:0 offset1:12
    v_cvt_pk_bf16_f32 v105, v106, v107
    v_mfma_f32_16x16x32_bf16 a[8:11], a[220:223], v[32:35], 0
    ds_write2st64_b64 v101, v[220:221], v[104:105] offset0:24 offset1:36
    v_accvgpr_read_b32 v106, a18
    v_cvt_pk_bf16_f32 v109, v110, v111
    v_mul_f32 v106, v106, v51
    v_accvgpr_read_b32 v107, a19
    v_accvgpr_read_b32 v105, a17
    v_mul_f32 v105, v105, v51
    v_mfma_f32_16x16x32_bf16 v[216:219], a[220:223], v[26:29], 0
    ds_write_b64 v101, v[108:109] offset:24576
    v_mul_f32 v206, v206, v49
    v_xor_b32 v101, 96, v101
    v_accvgpr_read_b32 v104, a16
    v_cvt_pk_bf16_f32 v233, v234, v235
    v_accvgpr_read_b32 v109, a65
    v_mul_f32 v196, v196, v49
    v_fma_f32 v73, v73, s28, v11
    v_mul_f32 v104, v104, v51
    v_cvt_pk_bf16_f32 v148, v148, v149
    v_accvgpr_read_b32 v111, a67
    v_fma_f32 v54, v54, s28, v9
    v_cvt_pk_bf16_f32 v132, v132, v133
    v_cvt_pk_bf16_f32 v104, v104, v105
    v_accvgpr_read_b32 v110, a66
    v_mul_f32 v107, v107, v51
    v_accvgpr_read_b32 v108, a64
    v_cvt_pk_bf16_f32 v105, v106, v107
    v_mfma_f32_16x16x32_bf16 v[220:223], a[224:227], v[26:29], 0
    ds_read_b128 v[96:99], v8 offset:0
    v_cvt_pk_bf16_f32 v225, v226, v227
    v_mfma_f32_16x16x32_bf16 v[172:175], a[224:227], v[20:23], 0
    ds_write2st64_b64 v101, v[128:129], v[176:177] offset0:4 offset1:16
    v_pk_mul_f32 v[156:157], v[156:157], v[48:49] op_sel_hi:[1,0]
    v_cvt_pk_bf16_f32 v244, v244, v245
    v_mul_f32 v207, v207, v49
    v_pk_mul_f32 v[108:109], v[108:109], v[100:101] op_sel_hi:[1,0]
    v_accvgpr_read_b32 v107, a23
    v_accvgpr_read_b32 v106, a22
    v_mfma_f32_16x16x32_bf16 v[168:171], a[220:223], v[20:23], 0
    ds_write2st64_b64 v101, v[224:225], v[104:105] offset0:28 offset1:40
    v_mul_f32 v107, v107, v51
    v_cvt_pk_bf16_f32 v108, v108, v109
    v_pk_mul_f32 v[110:111], v[110:111], v[100:101] op_sel_hi:[1,0]
    v_pk_mul_f32 v[246:247], v[246:247], v[50:51] op_sel_hi:[1,0]
    v_accvgpr_read_b32 v105, a21
    v_fma_f32 v81, v81, s28, v12
    v_cvt_pk_bf16_f32 v109, v110, v111
    v_accvgpr_read_b32 v104, a20
    v_accvgpr_read_b32 v111, a71
    v_cvt_pk_bf16_f32 v144, v144, v145
    v_mul_f32 v105, v105, v51
    v_mfma_f32_16x16x32_bf16 v[120:123], a[220:223], v[14:17], 0
    s_add_u32 m0, s22, 14336
    ds_write_b64 v101, v[108:109] offset:26624
    v_mul_f32 v104, v104, v51
    v_mul_f32 v106, v106, v51
    v_accvgpr_read_b32 v108, a68
    v_cvt_pk_bf16_f32 v133, v134, v135
    v_accvgpr_read_b32 v109, a69
    v_mfma_f32_16x16x32_bf16 v[124:127], a[224:227], v[14:17], 0
    ds_read_b64_tr_b16 a[224:225], v3 offset:2048
    v_cvt_pk_bf16_f32 v229, v230, v231
    v_cvt_pk_bf16_f32 v104, v104, v105
    v_cvt_pk_bf16_f32 v105, v106, v107
    v_xor_b32 v101, 32, v101
    v_exp_f32 v54, v54
    v_pk_mul_f32 v[142:143], v[142:143], v[48:49] op_sel_hi:[1,0]
    v_accvgpr_read_b32 v110, a70
    v_pk_mul_f32 v[108:109], v[108:109], v[100:101] op_sel_hi:[1,0]
    v_pk_mul_f32 v[110:111], v[110:111], v[100:101] op_sel_hi:[1,0]
    v_cvt_pk_bf16_f32 v108, v108, v109
    v_cvt_pk_bf16_f32 v181, v182, v183
    v_cvt_pk_bf16_f32 v193, v194, v195
    v_mfma_f32_16x16x32_bf16 v[128:131], a[228:231], v[14:17], 0
    s_waitcnt lgkmcnt(2)
    ds_write2st64_b64 v101, v[132:133], v[180:181] offset0:4 offset1:16
    v_mfma_f32_16x16x32_bf16 v[132:135], a[232:235], v[14:17], 0
    ds_write2st64_b64 v101, v[228:229], v[104:105] offset0:28 offset1:40
    v_accvgpr_read_b32 v107, a27
    v_cvt_pk_bf16_f32 v109, v110, v111
    v_accvgpr_read_b32 v106, a26
    v_accvgpr_read_b32 v104, a24
    v_accvgpr_read_b32 v105, a25
    v_mul_f32 v106, v106, v51
    v_mfma_f32_16x16x32_bf16 v[180:183], a[232:235], v[20:23], 0
    buffer_load_dwordx4 v6, s[4:7], s20 offen lds
    ds_write_b64 v101, v[108:109] offset:26624
    v_fma_f32 v67, v67, s28, v10
    v_xor_b32 v101, 96, v101
    v_accvgpr_read_b32 v111, a75
    v_accvgpr_read_b32 v109, a73
    v_accvgpr_read_b32 v110, a74
    v_accvgpr_read_b32 v108, a72
    v_mul_f32 v104, v104, v51
    v_fma_f32 v58, v58, s28, v9
    v_cvt_pk_bf16_f32 v18, v52, v53
    v_pk_mul_f32 v[158:159], v[158:159], v[48:49] op_sel_hi:[1,0]
    v_mul_f32 v105, v105, v51
    v_pk_mul_f32 v[108:109], v[108:109], v[100:101] op_sel_hi:[1,0]
    v_fma_f32 v85, v85, s28, v13
    v_pk_mul_f32 v[110:111], v[110:111], v[100:101] op_sel_hi:[1,0]
    v_cvt_pk_bf16_f32 v104, v104, v105
    v_cvt_pk_bf16_f32 v108, v108, v109
    v_fma_f32 v86, v86, s28, v13
    v_mfma_f32_16x16x32_bf16 v[176:179], a[228:231], v[20:23], 0
    s_add_u32 s20, s20, 12032
    ds_read_b64_tr_b16 a[212:213], v4 offset:1024
    ds_read_b64_tr_b16 a[214:215], v4 offset:7168
    v_mul_f32 v107, v107, v51
    v_cvt_pk_bf16_f32 v105, v106, v107
    v_mfma_f32_16x16x32_bf16 v[224:227], a[228:231], v[26:29], 0
    ds_write2st64_b64 v101, v[136:137], v[184:185] offset0:4 offset1:16
    v_accvgpr_read_b32 v106, a30
    v_cvt_pk_bf16_f32 v109, v110, v111
    v_mfma_f32_16x16x32_bf16 v[228:231], a[232:235], v[26:29], 0
    ds_write2st64_b64 v101, v[232:233], v[104:105] offset0:28 offset1:40
    v_mul_f32 v106, v106, v51
    v_fma_f32 v89, v89, s28, v13
    v_accvgpr_read_b32 v107, a31
    v_mfma_f32_16x16x32_bf16 v[44:47], a[252:255], v[38:41], v[44:47]
    ds_read_b64_tr_b16 a[222:223], v2 offset:8192
    v_cvt_pk_bf16_f32 v152, v152, v153
    v_accvgpr_read_b32 v104, a28
    v_accvgpr_read_b32 v105, a29
    v_mfma_f32_16x16x32_bf16 a[20:23], a[232:235], v[32:35], 0
    ds_write_b64 v101, v[108:109] offset:26624
    v_mfma_f32_16x16x32_bf16 a[16:19], a[228:231], v[32:35], 0
    ds_read_b64_tr_b16 a[226:227], v3 offset:8192
    v_accvgpr_read_b32 v109, a77
    v_cvt_pk_bf16_f32 v189, v190, v191
    v_mul_f32 v105, v105, v51
    v_mfma_f32_16x16x32_bf16 a[64:67], a[228:231], v[38:41], 0
    ds_read_b64_tr_b16 a[228:229], v4 offset:2048
    v_mul_f32 v107, v107, v51
    v_mfma_f32_16x16x32_bf16 a[68:71], a[232:235], v[38:41], 0
    s_waitcnt lgkmcnt(5)
    ds_read_b64_tr_b16 a[220:221], v2 offset:2048
    ds_read_b64_tr_b16 a[234:235], v5 offset:8192
    v_accvgpr_read_b32 v108, a76
    v_mfma_f32_16x16x32_bf16 a[72:75], a[212:215], v[38:41], 0
    ds_read_b64_tr_b16 a[232:233], v5 offset:2048
    ds_read_b64_tr_b16 a[230:231], v4 offset:8192
    v_fma_f32 v57, v57, s28, v9
    v_accvgpr_read_b32 v111, a79
    v_accvgpr_read_b32 v110, a78
    v_xor_b32 v101, 32, v101
    v_exp_f32 v58, v58
    v_mul_f32 v104, v104, v51
    v_pk_mul_f32 v[108:109], v[108:109], v[100:101] op_sel_hi:[1,0]
    v_cvt_pk_bf16_f32 v249, v250, v251
    v_cvt_pk_bf16_f32 v104, v104, v105
    v_cvt_pk_bf16_f32 v141, v142, v143
    v_cvt_pk_bf16_f32 v108, v108, v109
    v_cvt_pk_bf16_f32 v105, v106, v107
    v_mfma_f32_16x16x32_bf16 a[76:79], a[216:219], v[38:41], 0
    s_add_u32 s39, s39, 12288
    ds_write2st64_b64 v101, v[140:141], v[188:189] offset0:4 offset1:16
    v_mfma_f32_16x16x32_bf16 a[28:31], a[216:219], v[32:35], 0
    ds_write2st64_b64 v101, v[236:237], v[104:105] offset0:28 offset1:40
    v_cvt_pk_bf16_f32 v196, v196, v197
    v_exp_f32 v55, v55
    v_cvt_pk_bf16_f32 v25, v62, v63
    v_pk_mul_f32 v[110:111], v[110:111], v[100:101] op_sel_hi:[1,0]
    v_cvt_pk_bf16_f32 v145, v146, v147
    v_accvgpr_read_b32 v104, a32
    v_mul_f32 v104, v104, v51
    v_cvt_pk_bf16_f32 v109, v110, v111
    v_mfma_f32_16x16x32_bf16 a[24:27], a[212:215], v[32:35], 0
    s_waitcnt vmcnt(6) lgkmcnt(2)
    ds_write_b64 v101, v[108:109] offset:26624
    v_mfma_f32_16x16x32_bf16 v[232:235], a[212:215], v[26:29], 0
    buffer_store_dwordx4 v[96:99], v102, s[16:19], s67 offen offset:0 nt
    s_barrier
    ds_read_b128 v[96:99], v8 offset:1024
    v_accvgpr_read_b32 v110, a82
    v_cvt_pk_bf16_f32 v197, v198, v199
    v_accvgpr_read_b32 v109, a81
    v_accvgpr_read_b32 v106, a34
    v_accvgpr_read_b32 v111, a83
    v_pk_mul_f32 v[110:111], v[110:111], v[100:101] op_sel_hi:[1,0]
    v_exp_f32 v86, v86
    v_accvgpr_read_b32 v108, a80
    v_pk_mul_f32 v[108:109], v[108:109], v[100:101] op_sel_hi:[1,0]
    v_xor_b32 v101, 96, v101
    v_accvgpr_read_b32 v105, a33
    v_mfma_f32_16x16x32_bf16 v[236:239], a[216:219], v[26:29], 0
    v_mul_f32 v105, v105, v51
    v_cvt_pk_bf16_f32 v37, v78, v79
    v_cvt_pk_bf16_f32 v24, v60, v61
    v_accvgpr_read_b32 v107, a35
    v_cvt_pk_bf16_f32 v104, v104, v105
    v_cvt_pk_bf16_f32 v19, v54, v55
    v_mul_f32 v107, v107, v51
    v_mul_f32 v106, v106, v51
    v_cvt_pk_bf16_f32 v105, v106, v107
    v_accvgpr_read_b32 v107, a39
    v_cvt_pk_bf16_f32 v108, v108, v109
    v_cvt_pk_bf16_f32 v109, v110, v111
    v_mfma_f32_16x16x32_bf16 v[188:191], a[216:219], v[20:23], 0
    ds_write2st64_b64 v101, v[144:145], v[192:193] offset0:8 offset1:20
    v_cvt_pk_bf16_f32 v241, v242, v243
    v_cvt_pk_bf16_f32 v200, v200, v201
    v_cvt_pk_bf16_f32 v43, v86, v87
    v_cvt_pk_bf16_f32 v153, v154, v155
    v_cvt_pk_bf16_f32 v201, v202, v203
    v_mfma_f32_16x16x32_bf16 v[184:187], a[212:215], v[20:23], 0
    s_add_u32 m0, s22, 24576
    ds_write2st64_b64 v101, v[240:241], v[104:105] offset0:32 offset1:44
    v_mfma_f32_16x16x32_bf16 v[136:139], a[212:215], v[14:17], 0
    buffer_load_dwordx4 v6, s[8:11], s21 offen lds
    ds_write_b64 v101, v[108:109] offset:0
    v_accvgpr_read_b32 v106, a38
    v_accvgpr_read_b32 v104, a36
    v_accvgpr_read_b32 v111, a87
    v_pk_mul_f32 v[150:151], v[150:151], v[48:49] op_sel_hi:[1,0]
    v_accvgpr_read_b32 v109, a85
    v_accvgpr_read_b32 v108, a84
    v_mul_f32 v107, v107, v51
    v_mul_f32 v106, v106, v51
    v_accvgpr_read_b32 v105, a37
    v_cvt_pk_bf16_f32 v156, v156, v157
    v_mul_f32 v104, v104, v51
    v_mfma_f32_16x16x32_bf16 v[140:143], a[216:219], v[14:17], 0
    s_waitcnt lgkmcnt(3)
    buffer_store_dwordx4 v[96:99], v103, s[16:19], s67 offen offset:0 nt
    s_add_u32 s21, s21, 128
    v_mul_f32 v105, v105, v51
    v_cvt_pk_bf16_f32 v245, v246, v247
    v_accvgpr_read_b32 v110, a86
    v_cvt_pk_bf16_f32 v104, v104, v105
    v_pk_mul_f32 v[254:255], v[254:255], v[50:51] op_sel_hi:[1,0]
    v_pk_mul_f32 v[108:109], v[108:109], v[100:101] op_sel_hi:[1,0]
    v_cvt_pk_bf16_f32 v149, v150, v151
    v_pk_mul_f32 v[110:111], v[110:111], v[100:101] op_sel_hi:[1,0]
    v_cvt_pk_bf16_f32 v105, v106, v107
    v_cvt_pk_bf16_f32 v205, v206, v207
    v_pk_mul_f32 v[252:253], v[252:253], v[50:51] op_sel_hi:[1,0]
    v_xor_b32 v101, 32, v101
    v_accvgpr_read_b32 v107, a43
    v_mfma_f32_16x16x32_bf16 v[144:147], a[220:223], v[14:17], 0
    s_add_u32 m0, s22, 25600
    ds_write2st64_b64 v101, v[148:149], v[196:197] offset0:8 offset1:20
    v_cvt_pk_bf16_f32 v252, v252, v253
    v_cvt_pk_bf16_f32 v108, v108, v109
    v_mfma_f32_16x16x32_bf16 v[148:151], a[224:227], v[14:17], 0
    buffer_load_dwordx4 v6, s[8:11], s21 offen lds
    ds_write2st64_b64 v101, v[244:245], v[104:105] offset0:32 offset1:44
    v_cvt_pk_bf16_f32 v109, v110, v111
    v_mfma_f32_16x16x32_bf16 v[196:199], a[224:227], v[20:23], 0
    ds_read_b128 a[212:215], v0 offset:0
    v_accvgpr_read_b32 v104, a40
    v_mfma_f32_16x16x32_bf16 v[192:195], a[220:223], v[20:23], 0
    ds_write_b64 v101, v[108:109] offset:0
    v_accvgpr_read_b32 v105, a41
    v_accvgpr_read_b32 v106, a42
    v_mfma_f32_16x16x32_bf16 v[240:243], a[220:223], v[26:29], 0
    s_add_u32 s21, s21, 128
    ds_read_b128 v[96:99], v8 offset:2048
    v_mul_f32 v106, v106, v51
    v_mfma_f32_16x16x32_bf16 v[244:247], a[224:227], v[26:29], 0
    v_mul_f32 v105, v105, v51
    v_accvgpr_read_b32 v108, a88
    v_accvgpr_read_b32 v109, a89
    v_accvgpr_read_b32 v110, a90
    v_xor_b32 v101, 96, v101
    v_mul_f32 v107, v107, v51
    v_mul_f32 v104, v104, v51
    v_accvgpr_read_b32 v111, a91
    v_pk_mul_f32 v[108:109], v[108:109], v[100:101] op_sel_hi:[1,0]
    v_cvt_pk_bf16_f32 v104, v104, v105
    v_cvt_pk_bf16_f32 v108, v108, v109
    v_mfma_f32_16x16x32_bf16 a[36:39], a[224:227], v[32:35], 0
    ds_write2st64_b64 v101, v[152:153], v[200:201] offset0:8 offset1:20
    v_pk_mul_f32 v[110:111], v[110:111], v[100:101] op_sel_hi:[1,0]
    v_cvt_pk_bf16_f32 v105, v106, v107
    v_accvgpr_read_b32 v106, a46
    v_mfma_f32_16x16x32_bf16 a[32:35], a[220:223], v[32:35], 0
    ds_write2st64_b64 v101, v[248:249], v[104:105] offset0:32 offset1:44
    v_accvgpr_read_b32 v104, a44
    v_accvgpr_read_b32 v107, a47
    v_mfma_f32_16x16x32_bf16 a[80:83], a[220:223], v[38:41], 0
    s_add_u32 m0, s22, 26624
    v_accvgpr_read_b32 v105, a45
    v_mul_f32 v105, v105, v51
    v_cvt_pk_bf16_f32 v109, v110, v111
    v_fma_f32 v66, v66, s28, v10
    v_mul_f32 v104, v104, v51
    v_accvgpr_read_b32 v111, a95
    v_exp_f32 v56, v56
    v_mfma_f32_16x16x32_bf16 a[84:87], a[224:227], v[38:41], 0
    buffer_load_dwordx4 v6, s[8:11], s21 offen lds
    ds_write_b64 v101, v[108:109] offset:0
    v_cvt_pk_bf16_f32 v104, v104, v105
    v_accvgpr_read_b32 v110, a94
    v_accvgpr_read_b32 v109, a93
    v_accvgpr_read_b32 v108, a92
    v_mfma_f32_16x16x32_bf16 a[88:91], a[228:231], v[38:41], 0
    v_mul_f32 v107, v107, v51
    v_mul_f32 v106, v106, v51
    v_cvt_pk_bf16_f32 v105, v106, v107
    v_exp_f32 v57, v57
    v_mfma_f32_16x16x32_bf16 a[92:95], a[232:235], v[38:41], 0
    s_add_u32 s21, s21, 12032
    ds_read_b128 a[216:219], v1 offset:0
    v_cvt_pk_bf16_f32 v157, v158, v159
    v_mfma_f32_16x16x32_bf16 a[44:47], a[232:235], v[32:35], 0
    s_add_u32 s56, s67, 128
    ds_read_b128 a[220:223], v0 offset:1024
    v_cvt_pk_bf16_f32 v253, v254, v255
    v_xor_b32 v101, 32, v101
    v_mfma_f32_16x16x32_bf16 a[40:43], a[228:231], v[32:35], 0
    s_add_u32 s58, s33, 128
    ds_write2st64_b64 v101, v[156:157], v[204:205] offset0:8 offset1:20
    v_mfma_f32_16x16x32_bf16 v[248:251], a[228:231], v[26:29], 0
    ds_write2st64_b64 v101, v[252:253], v[104:105] offset0:32 offset1:44
    v_mfma_f32_16x16x32_bf16 v[252:255], a[232:235], v[26:29], 0
    s_add_u32 m0, s38, 2048
    v_exp_f32 v76, v76
    v_mfma_f32_16x16x32_bf16 v[204:207], a[232:235], v[20:23], 0
    v_cvt_pk_bf16_f32 v36, v76, v77
    v_fma_f32 v74, v74, s28, v11
    v_mfma_f32_16x16x32_bf16 v[200:203], a[228:231], v[20:23], 0
    v_exp_f32 v70, v70
    v_mfma_f32_16x16x32_bf16 v[152:155], a[228:231], v[14:17], 0
    s_waitcnt lgkmcnt(4)
    ds_read_b128 a[224:227], v1 offset:1024
    buffer_load_dwordx4 v6, s[12:15], s58 offen nt lds
    v_mfma_f32_16x16x32_bf16 v[156:159], a[232:235], v[14:17], 0
    buffer_store_dwordx4 v[96:99], v102, s[16:19], s56 offen offset:0 nt
    v_fma_f32 v65, v65, s28, v10
    v_pk_mul_f32 v[110:111], v[110:111], v[100:101] op_sel_hi:[1,0]
    v_pk_mul_f32 v[108:109], v[108:109], v[100:101] op_sel_hi:[1,0]
    v_fma_f32 v72, v72, s28, v11
    v_exp_f32 v85, v85
    v_mfma_f32_16x16x32_bf16 v[52:55], a[212:215], a[96:99], 0
    s_waitcnt lgkmcnt(2)
    ds_read_b128 v[96:99], v8 offset:3072
    v_cvt_pk_bf16_f32 v108, v108, v109
    v_mfma_f32_16x16x32_bf16 v[52:55], a[216:219], a[100:103], v[52:55]
    v_exp_f32 v65, v65
    v_mfma_f32_16x16x32_bf16 v[52:55], a[220:223], a[104:107], v[52:55]
    ds_read_b128 a[228:231], v0 offset:2048
    v_exp_f32 v72, v72
    v_mfma_f32_16x16x32_bf16 v[60:63], a[220:223], a[128:131], 0
    v_cvt_pk_bf16_f32 v30, v68, v69
    v_fma_f32 v83, v83, s28, v12
    v_mfma_f32_16x16x32_bf16 v[60:63], a[216:219], a[124:127], v[60:63]
    ds_read_b128 a[232:235], v1 offset:2048
    v_exp_f32 v74, v74
    v_mfma_f32_16x16x32_bf16 v[60:63], a[212:215], a[120:123], v[60:63]
    v_cvt_pk_bf16_f32 v31, v70, v71
    v_exp_f32 v82, v82
    v_mfma_f32_16x16x32_bf16 v[68:71], a[212:215], a[144:147], 0
    s_add_u32 m0, s38, 3072
    v_exp_f32 v66, v66
    v_mfma_f32_16x16x32_bf16 v[68:71], a[216:219], a[148:151], v[68:71]
    v_exp_f32 v59, v59
    v_mfma_f32_16x16x32_bf16 v[68:71], a[220:223], a[152:155], v[68:71]
    v_cvt_pk_bf16_f32 v109, v110, v111
    v_cvt_pk_bf16_f32 v42, v84, v85
    v_mfma_f32_16x16x32_bf16 v[76:79], a[220:223], a[176:179], 0
    v_exp_f32 v90, v90
    v_mfma_f32_16x16x32_bf16 v[76:79], a[216:219], a[172:175], v[76:79]
    v_fma_f32 v91, v91, s28, v13
    v_cvt_pk_bf16_f32 v17, v58, v59
    v_mfma_f32_16x16x32_bf16 v[76:79], a[212:215], a[168:171], v[76:79]
    v_exp_f32 v75, v75
    v_mfma_f32_16x16x32_bf16 v[84:87], a[212:215], a[192:195], 0
    v_exp_f32 v91, v91
    v_mfma_f32_16x16x32_bf16 v[84:87], a[216:219], a[196:199], v[84:87]
    v_exp_f32 v67, v67
    v_mfma_f32_16x16x32_bf16 v[84:87], a[220:223], a[200:203], v[84:87]
    s_waitcnt lgkmcnt(0)
    v_cvt_pk_bf16_f32 v29, v74, v75
    v_cvt_pk_bf16_f32 v16, v56, v57
    v_mfma_f32_16x16x32_bf16 v[84:87], a[224:227], a[204:207], v[84:87]
    buffer_load_dwordx4 v7, s[12:15], s58 offen nt lds
    v_mfma_f32_16x16x32_bf16 v[48:51], a[236:239], v[16:19], v[44:47]
    v_exp_f32 v81, v81
    v_mfma_f32_16x16x32_bf16 v[84:87], a[228:231], a[208:211], v[84:87]
    buffer_store_dwordx4 v[96:99], v103, s[16:19], s56 offen offset:0 nt
    ds_write_b64 v101, v[108:109] offset:0
    v_mfma_f32_16x16x32_bf16 v[84:87], a[232:235], v[92:95], v[84:87]
    v_exp_f32 v73, v73
    v_mfma_f32_16x16x32_bf16 v[76:79], a[232:235], a[188:191], v[76:79]
    ds_read_b128 v[96:99], v8 offset:0
    v_cvt_pk_bf16_f32 v22, v64, v65
    v_mfma_f32_16x16x32_bf16 v[76:79], a[228:231], a[184:187], v[76:79]
    v_exp_f32 v80, v80
    v_mfma_f32_16x16x32_bf16 v[76:79], a[224:227], a[180:183], v[76:79]
    v_cvt_pk_bf16_f32 v28, v72, v73
    v_cvt_pk_bf16_f32 v23, v66, v67
    v_mfma_f32_16x16x32_bf16 v[68:71], a[224:227], a[156:159], v[68:71]
    v_exp_f32 v88, v88
    v_mfma_f32_16x16x32_bf16 v[68:71], a[228:231], a[160:163], v[68:71]
    s_add_u32 s57, s67, 24832
    v_exp_f32 v89, v89
    v_mfma_f32_16x16x32_bf16 v[48:51], a[240:243], v[22:25], v[48:51]
    s_add_u32 m0, s38, 0
    v_exp_f32 v83, v83
    v_mfma_f32_16x16x32_bf16 v[48:51], a[244:247], v[28:31], v[48:51]
    ds_read_b128 a[212:215], v0 offset:6144
    v_cvt_pk_bf16_f32 v34, v80, v81
    v_mfma_f32_16x16x32_bf16 v[68:71], a[232:235], a[164:167], v[68:71]
    ds_read_b128 a[216:219], v1 offset:6144
    v_cvt_pk_bf16_f32 v40, v88, v89
    v_mfma_f32_16x16x32_bf16 v[60:63], a[232:235], a[140:143], v[60:63]
    v_cvt_pk_bf16_f32 v35, v82, v83
    v_cvt_pk_bf16_f32 v41, v90, v91
    v_mfma_f32_16x16x32_bf16 v[60:63], a[228:231], a[136:139], v[60:63]
    ds_read_b128 a[220:223], v0 offset:7168
    v_mfma_f32_16x16x32_bf16 v[48:51], a[248:251], v[34:37], v[48:51]
    v_mfma_f32_16x16x32_bf16 v[60:63], a[224:227], a[132:135], v[60:63]
    s_waitcnt lgkmcnt(3)
    buffer_load_dwordx4 v6, s[12:15], s33 offen nt lds
    v_mfma_f32_16x16x32_bf16 v[48:51], a[252:255], v[40:43], v[48:51]
    buffer_store_dwordx4 v[96:99], v102, s[16:19], s57 offen offset:0 nt
    s_nop 0
    ds_read_b128 v[96:99], v8 offset:1024
    v_mfma_f32_16x16x32_bf16 v[52:55], a[224:227], a[108:111], v[52:55]
    ds_read_b128 a[224:227], v1 offset:7168
    s_add_u32 m0, s38, 1024
    v_mfma_f32_16x16x32_bf16 v[52:55], a[228:231], a[112:115], v[52:55]
    s_nop 0
    v_cmp_lt_f32 vcc, s29, v48
    v_mfma_f32_16x16x32_bf16 v[52:55], a[232:235], a[116:119], v[52:55]
    s_waitcnt lgkmcnt(4)
    ds_read_b128 a[228:231], v0 offset:8192
    v_mfma_f32_16x16x32_bf16 v[56:59], a[212:215], a[96:99], 0
    s_waitcnt lgkmcnt(4)
    ds_read_b128 a[232:235], v1 offset:8192
    v_mfma_f32_16x16x32_bf16 v[56:59], a[216:219], a[100:103], v[56:59]
    s_waitcnt lgkmcnt(4)
    v_mfma_f32_16x16x32_bf16 v[56:59], a[220:223], a[104:107], v[56:59]
    s_cbranch_vccnz L_rs_tr55d
L_ret_tr55d:
    v_mfma_f32_16x16x32_bf16 v[64:67], a[220:223], a[128:131], 0
    v_fma_f32 v52, v52, s28, v9
    v_fma_f32 v54, v54, s28, v9
    v_mfma_f32_16x16x32_bf16 v[64:67], a[216:219], a[124:127], v[64:67]
    v_fma_f32 v60, v60, s28, v10
    v_fma_f32 v63, v63, s28, v10
    v_mfma_f32_16x16x32_bf16 v[64:67], a[212:215], a[120:123], v[64:67]
    v_exp_f32 v63, v63
    v_mfma_f32_16x16x32_bf16 v[72:75], a[212:215], a[144:147], 0
    s_waitcnt lgkmcnt(3)
    buffer_load_dwordx4 v7, s[12:15], s33 offen nt lds
    v_mfma_f32_16x16x32_bf16 v[72:75], a[216:219], a[148:151], v[72:75]
    v_exp_f32 v52, v52
    v_mfma_f32_16x16x32_bf16 v[72:75], a[220:223], a[152:155], v[72:75]
    buffer_store_dwordx4 v[96:99], v103, s[16:19], s57 offen offset:0 nt
    v_fma_f32 v62, v62, s28, v10
    s_waitcnt vmcnt(16) lgkmcnt(0)
    v_fma_f32 v61, v61, s28, v10
    v_mfma_f32_16x16x32_bf16 v[80:83], a[220:223], a[176:179], 0
    s_barrier
    v_mfma_f32_16x16x32_bf16 v[80:83], a[216:219], a[172:175], v[80:83]
    v_exp_f32 v62, v62
    v_mfma_f32_16x16x32_bf16 v[80:83], a[212:215], a[168:171], v[80:83]
    s_add_u32 m0, s22, 0
    v_exp_f32 v61, v61
    v_mfma_f32_16x16x32_bf16 v[88:91], a[212:215], a[192:195], 0
    v_fma_f32 v53, v53, s28, v9
    v_mfma_f32_16x16x32_bf16 v[88:91], a[216:219], a[196:199], v[88:91]
    ds_read_b64_tr_b16 a[212:213], v2 offset:18432
    v_mfma_f32_16x16x32_bf16 v[88:91], a[220:223], a[200:203], v[88:91]
    buffer_load_dwordx4 v6, s[4:7], s20 offen lds
    v_mfma_f32_16x16x32_bf16 v[88:91], a[224:227], a[204:207], v[88:91]
    s_add_u32 s20, s20, 128
    ds_read_b64_tr_b16 a[214:215], v2 offset:12288
    v_fma_f32 v55, v55, s28, v9
    v_mfma_f32_16x16x32_bf16 v[88:91], a[228:231], a[208:211], v[88:91]
    s_add_u32 m0, s22, 1024
    v_exp_f32 v54, v54
    v_mfma_f32_16x16x32_bf16 v[88:91], a[232:235], v[92:95], v[88:91]
    ds_read_b64_tr_b16 a[216:217], v3 offset:18432
    v_cvt_pk_bf16_f32 v21, v62, v63
    v_mfma_f32_16x16x32_bf16 v[80:83], a[232:235], a[188:191], v[80:83]
    ds_read_b64_tr_b16 a[218:219], v3 offset:12288
    v_mfma_f32_16x16x32_bf16 v[80:83], a[228:231], a[184:187], v[80:83]
    buffer_load_dwordx4 v6, s[4:7], s20 offen lds
    v_mfma_f32_16x16x32_bf16 v[80:83], a[224:227], a[180:183], v[80:83]
    s_add_u32 s20, s20, 128
    v_exp_f32 v55, v55
    v_mfma_f32_16x16x32_bf16 v[72:75], a[224:227], a[156:159], v[72:75]
    ds_read_b64_tr_b16 a[220:221], v4 offset:18432
    v_mfma_f32_16x16x32_bf16 v[72:75], a[228:231], a[160:163], v[72:75]
    v_exp_f32 v60, v60
    v_mfma_f32_16x16x32_bf16 v[72:75], a[232:235], a[164:167], v[72:75]
    v_exp_f32 v53, v53
    v_mfma_f32_16x16x32_bf16 v[64:67], a[232:235], a[140:143], v[64:67]
    v_mfma_f32_16x16x32_bf16 v[64:67], a[228:231], a[136:139], v[64:67]
    s_add_u32 m0, s22, 2048
    v_cvt_pk_bf16_f32 v20, v60, v61
    v_cvt_pk_bf16_f32 v15, v54, v55
    v_mfma_f32_16x16x32_bf16 v[64:67], a[224:227], a[132:135], v[64:67]
    buffer_load_dwordx4 v6, s[4:7], s20 offen lds
    v_mfma_f32_16x16x32_bf16 v[56:59], a[224:227], a[108:111], v[56:59]
    ds_read_b64_tr_b16 a[222:223], v4 offset:12288
    v_add_u32 v8, 4096, v8
    v_mfma_f32_16x16x32_bf16 v[56:59], a[228:231], a[112:115], v[56:59]
    ds_read_b64_tr_b16 a[224:225], v5 offset:18432
    v_cvt_pk_bf16_f32 v14, v52, v53
    v_mfma_f32_16x16x32_bf16 v[56:59], a[232:235], a[116:119], v[56:59]
    s_add_u32 s20, s20, 12032
    ds_read_b64_tr_b16 a[226:227], v5 offset:12288
    s_branch L_loop5
L_loop4:
    .p2align 6
L_loop4w0:
    s_waitcnt lgkmcnt(6)
    v_mfma_f32_16x16x32_bf16 v[112:115], a[212:215], v[16:19], v[112:115]
    ds_read_b64_tr_b16 a[228:229], v2 offset:19456
    v_fma_f32 v78, v78, s28, v12
    v_mfma_f32_16x16x32_bf16 v[160:163], a[212:215], v[22:25], v[160:163]
    v_fma_f32 v75, v75, s28, v11
    v_mfma_f32_16x16x32_bf16 v[208:211], a[212:215], v[28:31], v[208:211]
    ds_read_b64_tr_b16 a[234:235], v3 offset:13312
    v_fma_f32 v79, v79, s28, v12
    v_mfma_f32_16x16x32_bf16 a[0:3], a[212:215], v[34:37], a[0:3]
    ds_read_b64_tr_b16 a[230:231], v2 offset:13312
    s_waitcnt lgkmcnt(7)
    v_mfma_f32_16x16x32_bf16 a[4:7], a[216:219], v[34:37], a[4:7]
    ds_read_b64_tr_b16 a[232:233], v3 offset:19456
    v_fma_f32 v77, v77, s28, v12
    v_mfma_f32_16x16x32_bf16 v[212:215], a[216:219], v[28:31], v[212:215]
    v_exp_f32 v79, v79
    v_mfma_f32_16x16x32_bf16 v[164:167], a[216:219], v[22:25], v[164:167]
    ds_read_b64_tr_b16 a[214:215], v4 offset:13312
    v_fma_f32 v62, v62, s28, v10
    v_mfma_f32_16x16x32_bf16 v[116:119], a[216:219], v[16:19], v[116:119]
    v_fma_f32 v67, v67, s28, v10
    s_waitcnt lgkmcnt(7)
    v_mfma_f32_16x16x32_bf16 v[120:123], a[220:223], v[16:19], v[120:123]
    v_exp_f32 v78, v78
    v_mfma_f32_16x16x32_bf16 v[168:171], a[220:223], v[22:25], v[168:171]
    v_fma_f32 v71, v71, s28, v11
    v_fma_f32 v66, v66, s28, v10
    v_mfma_f32_16x16x32_bf16 v[216:219], a[220:223], v[28:31], v[216:219]
    v_exp_f32 v75, v75
    v_mfma_f32_16x16x32_bf16 a[8:11], a[220:223], v[34:37], a[8:11]
    s_waitcnt lgkmcnt(4)
    ds_read_b64_tr_b16 a[212:213], v4 offset:19456
    v_fma_f32 v56, v56, s28, v9
    v_mfma_f32_16x16x32_bf16 a[12:15], a[224:227], v[34:37], a[12:15]
    ds_read_b64_tr_b16 a[222:223], v2 offset:14336
    v_fma_f32 v70, v70, s28, v11
    v_mfma_f32_16x16x32_bf16 v[220:223], a[224:227], v[28:31], v[220:223]
    v_fma_f32 v59, v59, s28, v9
    v_fma_f32 v72, v72, s28, v11
    v_mfma_f32_16x16x32_bf16 v[172:175], a[224:227], v[22:25], v[172:175]
    v_fma_f32 v81, v81, s28, v12
    v_mfma_f32_16x16x32_bf16 v[124:127], a[224:227], v[16:19], v[124:127]
    s_waitcnt lgkmcnt(3)
    ds_read_b64_tr_b16 a[216:217], v5 offset:19456
    v_fma_f32 v58, v58, s28, v9
    v_mfma_f32_16x16x32_bf16 v[128:131], a[228:231], v[16:19], v[128:131]
    ds_read_b64_tr_b16 a[226:227], v3 offset:14336
    v_fma_f32 v73, v73, s28, v11
    v_mfma_f32_16x16x32_bf16 v[176:179], a[228:231], v[22:25], v[176:179]
    s_add_u32 s39, s39, 12288
    ds_read_b64_tr_b16 a[218:219], v5 offset:13312
    v_fma_f32 v83, v83, s28, v12
    v_mfma_f32_16x16x32_bf16 v[224:227], a[228:231], v[28:31], v[224:227]
    ds_read_b64_tr_b16 a[220:221], v2 offset:20480
    v_mfma_f32_16x16x32_bf16 a[16:19], a[228:231], v[34:37], a[16:19]
    ds_read_b64_tr_b16 a[224:225], v3 offset:20480
    v_fma_f32 v68, v68, s28, v11
    v_mfma_f32_16x16x32_bf16 a[20:23], a[232:235], v[34:37], a[20:23]
    ds_read_b64_tr_b16 a[230:231], v4 offset:14336
    v_fma_f32 v64, v64, s28, v10
    v_mfma_f32_16x16x32_bf16 v[228:231], a[232:235], v[28:31], v[228:231]
    ds_read_b64_tr_b16 a[228:229], v4 offset:20480
    v_fma_f32 v74, v74, s28, v11
    v_mfma_f32_16x16x32_bf16 v[180:183], a[232:235], v[22:25], v[180:183]
    v_exp_f32 v56, v56
    v_mfma_f32_16x16x32_bf16 v[132:135], a[232:235], v[16:19], v[132:135]
    s_waitcnt lgkmcnt(7)
    ds_read_b64_tr_b16 a[234:235], v5 offset:14336
    v_mfma_f32_16x16x32_bf16 v[136:139], a[212:215], v[16:19], v[136:139]
    ds_read_b64_tr_b16 a[232:233], v5 offset:20480
    v_fma_f32 v80, v80, s28, v12
    v_mfma_f32_16x16x32_bf16 v[184:187], a[212:215], v[22:25], v[184:187]
    v_exp_f32 v67, v67
    v_mfma_f32_16x16x32_bf16 v[232:235], a[212:215], v[28:31], v[232:235]
    v_fma_f32 v63, v63, s28, v10
    v_fma_f32 v76, v76, s28, v12
    v_mfma_f32_16x16x32_bf16 a[24:27], a[212:215], v[34:37], a[24:27]
    s_waitcnt lgkmcnt(6)
    v_exp_f32 v71, v71
    v_mfma_f32_16x16x32_bf16 a[28:31], a[216:219], v[34:37], a[28:31]
    v_exp_f32 v70, v70
    v_mfma_f32_16x16x32_bf16 v[236:239], a[216:219], v[28:31], v[236:239]
    v_exp_f32 v66, v66
    v_mfma_f32_16x16x32_bf16 v[188:191], a[216:219], v[22:25], v[188:191]
    v_exp_f32 v63, v63
    v_mfma_f32_16x16x32_bf16 v[140:143], a[216:219], v[16:19], v[140:143]
    s_waitcnt lgkmcnt(2)
    v_exp_f32 v81, v81
    v_mfma_f32_16x16x32_bf16 v[144:147], a[220:223], v[16:19], v[144:147]
    v_exp_f32 v58, v58
    v_mfma_f32_16x16x32_bf16 v[192:195], a[220:223], v[22:25], v[192:195]
    v_cvt_pk_bf16_f32 v27, v70, v71
    s_waitcnt vmcnt(10) lgkmcnt(0)
    v_mfma_f32_16x16x32_bf16 v[240:243], a[220:223], v[28:31], v[240:243]
    s_barrier
    v_mfma_f32_16x16x32_bf16 a[32:35], a[220:223], v[34:37], a[32:35]
    ds_read_b128 a[216:219], v1 offset:12288
    v_fma_f32 v57, v57, s28, v9
    v_mfma_f32_16x16x32_bf16 a[36:39], a[224:227], v[34:37], a[36:39]
    ds_read_b128 a[212:215], v0 offset:12288
    v_fma_f32 v82, v82, s28, v12
    v_mfma_f32_16x16x32_bf16 v[244:247], a[224:227], v[28:31], v[244:247]
    s_add_u32 m0, s22, 36864
    v_exp_f32 v76, v76
    v_mfma_f32_16x16x32_bf16 v[196:199], a[224:227], v[22:25], v[196:199]
    ds_read_b128 a[220:223], v0 offset:13312
    v_fma_f32 v65, v65, s28, v10
    v_mfma_f32_16x16x32_bf16 v[148:151], a[224:227], v[16:19], v[148:151]
    buffer_load_dwordx4 v6, s[8:11], s21 offen lds
    v_mfma_f32_16x16x32_bf16 v[152:155], a[228:231], v[16:19], v[152:155]
    s_add_u32 s21, s21, 128
    ds_read_b128 a[224:227], v1 offset:13312
    v_fma_f32 v69, v69, s28, v11
    v_mfma_f32_16x16x32_bf16 v[200:203], a[228:231], v[22:25], v[200:203]
    s_add_u32 m0, s22, 37888
    v_exp_f32 v68, v68
    v_mfma_f32_16x16x32_bf16 v[248:251], a[228:231], v[28:31], v[248:251]
    buffer_load_dwordx4 v6, s[8:11], s21 offen lds
    v_mfma_f32_16x16x32_bf16 a[40:43], a[228:231], v[34:37], a[40:43]
    s_add_u32 s21, s21, 128
    ds_read_b128 a[228:231], v0 offset:14336
    s_add_u32 m0, s22, 38912
    v_mfma_f32_16x16x32_bf16 a[44:47], a[232:235], v[34:37], a[44:47]
    buffer_load_dwordx4 v6, s[8:11], s21 offen lds
    v_mfma_f32_16x16x32_bf16 v[252:255], a[232:235], v[28:31], v[252:255]
    v_exp_f32 v77, v77
    v_mfma_f32_16x16x32_bf16 v[204:207], a[232:235], v[22:25], v[204:207]
    v_exp_f32 v64, v64
    v_mfma_f32_16x16x32_bf16 v[156:159], a[232:235], v[16:19], v[156:159]
    s_waitcnt lgkmcnt(3)
    v_exp_f32 v62, v62
    v_mfma_f32_16x16x32_bf16 v[52:55], a[212:215], a[96:99], 0
    v_exp_f32 v69, v69
    v_mfma_f32_16x16x32_bf16 v[52:55], a[216:219], a[100:103], v[52:55]
    s_waitcnt lgkmcnt(2)
    v_exp_f32 v73, v73
    v_mfma_f32_16x16x32_bf16 v[52:55], a[220:223], a[104:107], v[52:55]
    v_cvt_pk_bf16_f32 v21, v62, v63
    v_cvt_pk_bf16_f32 v26, v68, v69
    v_mfma_f32_16x16x32_bf16 v[60:63], a[220:223], a[128:131], 0
    ds_read_b128 a[232:235], v1 offset:14336
    v_mfma_f32_16x16x32_bf16 v[60:63], a[216:219], a[124:127], v[60:63]
    v_cvt_pk_bf16_f32 v23, v66, v67
    v_mfma_f32_16x16x32_bf16 v[60:63], a[212:215], a[120:123], v[60:63]
    v_exp_f32 v80, v80
    v_mfma_f32_16x16x32_bf16 v[68:71], a[212:215], a[144:147], 0
    v_exp_f32 v65, v65
    v_mfma_f32_16x16x32_bf16 v[68:71], a[216:219], a[148:151], v[68:71]
    v_cvt_pk_bf16_f32 v32, v76, v77
    v_cvt_pk_bf16_f32 v33, v78, v79
    v_mfma_f32_16x16x32_bf16 v[68:71], a[220:223], a[152:155], v[68:71]
    v_exp_f32 v59, v59
    v_mfma_f32_16x16x32_bf16 v[76:79], a[220:223], a[176:179], 0
    v_mfma_f32_16x16x32_bf16 v[76:79], a[216:219], a[172:175], v[76:79]
    v_exp_f32 v82, v82
    v_mfma_f32_16x16x32_bf16 v[76:79], a[212:215], a[168:171], v[76:79]
    s_waitcnt lgkmcnt(1)
    ds_read_b128 a[216:219], v1 offset:18432
    v_mfma_f32_16x16x32_bf16 v[76:79], a[224:227], a[180:183], v[76:79]
    v_exp_f32 v57, v57
    v_mfma_f32_16x16x32_bf16 v[76:79], a[228:231], a[184:187], v[76:79]
    s_waitcnt lgkmcnt(1)
    v_exp_f32 v83, v83
    v_mfma_f32_16x16x32_bf16 v[76:79], a[232:235], a[188:191], v[76:79]
    v_mfma_f32_16x16x32_bf16 v[68:71], a[232:235], a[164:167], v[68:71]
    v_cvt_pk_bf16_f32 v22, v64, v65
    v_cvt_pk_bf16_f32 v35, v82, v83
    v_mfma_f32_16x16x32_bf16 v[68:71], a[228:231], a[160:163], v[68:71]
    v_exp_f32 v72, v72
    v_mfma_f32_16x16x32_bf16 v[68:71], a[224:227], a[156:159], v[68:71]
    ds_read_b128 a[212:215], v0 offset:18432
    v_mfma_f32_16x16x32_bf16 v[60:63], a[224:227], a[132:135], v[60:63]
    ds_read_b128 a[220:223], v0 offset:19456
    v_mfma_f32_16x16x32_bf16 v[60:63], a[228:231], a[136:139], v[60:63]
    v_exp_f32 v74, v74
    v_mfma_f32_16x16x32_bf16 v[60:63], a[232:235], a[140:143], v[60:63]
    v_cvt_pk_bf16_f32 v17, v58, v59
    v_cvt_pk_bf16_f32 v16, v56, v57
    v_mfma_f32_16x16x32_bf16 v[52:55], a[232:235], a[116:119], v[52:55]
    s_add_u32 s21, s21, 12032
    ds_read_b128 a[232:235], v1 offset:20480
    v_cvt_pk_bf16_f32 v34, v80, v81
    v_mfma_f32_16x16x32_bf16 v[52:55], a[228:231], a[112:115], v[52:55]
    ds_read_b128 a[228:231], v0 offset:20480
    v_cvt_pk_bf16_f32 v28, v72, v73
    v_mfma_f32_16x16x32_bf16 v[52:55], a[224:227], a[108:111], v[52:55]
    ds_read_b128 a[224:227], v1 offset:19456
    v_mfma_f32_16x16x32_bf16 v[44:47], a[236:239], v[14:17], v[48:51]
    v_cvt_pk_bf16_f32 v29, v74, v75
    v_mfma_f32_16x16x32_bf16 v[44:47], a[240:243], v[20:23], v[44:47]
    s_nop 0
    v_mfma_f32_16x16x32_bf16 v[44:47], a[244:247], v[26:29], v[44:47]
    v_mfma_f32_16x16x32_bf16 v[44:47], a[248:251], v[32:35], v[44:47]
    s_waitcnt lgkmcnt(4)
    v_mfma_f32_16x16x32_bf16 v[56:59], a[212:215], a[96:99], 0
    v_mfma_f32_16x16x32_bf16 v[56:59], a[216:219], a[100:103], v[56:59]
    s_waitcnt lgkmcnt(3)
    v_mfma_f32_16x16x32_bf16 v[56:59], a[220:223], a[104:107], v[56:59]
    v_mfma_f32_16x16x32_bf16 v[64:67], a[220:223], a[128:131], 0
    s_nop 1
    v_cmp_lt_f32 vcc, s29, v44
    v_mfma_f32_16x16x32_bf16 v[64:67], a[216:219], a[124:127], v[64:67]
    s_waitcnt vmcnt(10) lgkmcnt(0)
    v_mfma_f32_16x16x32_bf16 v[64:67], a[212:215], a[120:123], v[64:67]
    s_barrier
    v_mfma_f32_16x16x32_bf16 v[72:75], a[212:215], a[144:147], 0
    s_cbranch_vccnz L_rs_loop4w0a
L_ret_loop4w0a:
    s_add_u32 m0, s22, 12288
    v_mfma_f32_16x16x32_bf16 v[72:75], a[216:219], a[148:151], v[72:75]
    buffer_load_dwordx4 v6, s[4:7], s20 offen lds
    v_mfma_f32_16x16x32_bf16 v[72:75], a[220:223], a[152:155], v[72:75]
    v_fma_f32 v55, v55, s28, v9
    v_fma_f32 v52, v52, s28, v9
    v_mfma_f32_16x16x32_bf16 v[80:83], a[220:223], a[176:179], 0
    v_fma_f32 v61, v61, s28, v10
    v_fma_f32 v60, v60, s28, v10
    v_mfma_f32_16x16x32_bf16 v[80:83], a[216:219], a[172:175], v[80:83]
    s_add_u32 s20, s20, 128
    v_exp_f32 v52, v52
    v_mfma_f32_16x16x32_bf16 v[80:83], a[212:215], a[168:171], v[80:83]
    s_add_u32 m0, s22, 13312
    ds_read_b64_tr_b16 a[212:213], v2 offset:0
    v_fma_f32 v54, v54, s28, v9
    v_mfma_f32_16x16x32_bf16 v[80:83], a[224:227], a[180:183], v[80:83]
    buffer_load_dwordx4 v6, s[4:7], s20 offen lds
    v_mfma_f32_16x16x32_bf16 v[80:83], a[228:231], a[184:187], v[80:83]
    s_add_u32 s20, s20, 128
    ds_read_b64_tr_b16 a[214:215], v2 offset:6144
    v_fma_f32 v53, v53, s28, v9
    v_mfma_f32_16x16x32_bf16 v[80:83], a[232:235], a[188:191], v[80:83]
    s_add_u32 m0, s22, 14336
    v_exp_f32 v61, v61
    v_mfma_f32_16x16x32_bf16 v[72:75], a[232:235], a[164:167], v[72:75]
    buffer_load_dwordx4 v6, s[4:7], s20 offen lds
    v_mfma_f32_16x16x32_bf16 v[72:75], a[228:231], a[160:163], v[72:75]
    ds_read_b64_tr_b16 a[216:217], v3 offset:0
    v_exp_f32 v60, v60
    v_mfma_f32_16x16x32_bf16 v[72:75], a[224:227], a[156:159], v[72:75]
    v_exp_f32 v53, v53
    v_mfma_f32_16x16x32_bf16 v[64:67], a[224:227], a[132:135], v[64:67]
    ds_read_b64_tr_b16 a[218:219], v3 offset:6144
    v_cvt_pk_bf16_f32 v24, v60, v61
    v_mfma_f32_16x16x32_bf16 v[64:67], a[228:231], a[136:139], v[64:67]
    s_add_u32 s20, s20, 12032
    v_exp_f32 v55, v55
    v_mfma_f32_16x16x32_bf16 v[64:67], a[232:235], a[140:143], v[64:67]
    v_exp_f32 v54, v54
    v_mfma_f32_16x16x32_bf16 v[56:59], a[232:235], a[116:119], v[56:59]
    ds_read_b64_tr_b16 a[220:221], v4 offset:0
    v_cvt_pk_bf16_f32 v19, v54, v55
    v_mfma_f32_16x16x32_bf16 v[56:59], a[228:231], a[112:115], v[56:59]
    ds_read_b64_tr_b16 a[222:223], v4 offset:6144
    v_cvt_pk_bf16_f32 v18, v52, v53
    v_mfma_f32_16x16x32_bf16 v[56:59], a[224:227], a[108:111], v[56:59]
    ds_read_b64_tr_b16 a[224:225], v5 offset:0
    ds_read_b64_tr_b16 a[226:227], v5 offset:6144
    s_waitcnt lgkmcnt(6)
    v_mfma_f32_16x16x32_bf16 v[112:115], a[212:215], v[14:17], v[112:115]
    ds_read_b64_tr_b16 a[228:229], v2 offset:1024
    v_fma_f32 v81, v81, s28, v12
    v_mfma_f32_16x16x32_bf16 v[160:163], a[212:215], v[20:23], v[160:163]
    ds_read_b64_tr_b16 a[232:233], v3 offset:1024
    v_fma_f32 v79, v79, s28, v12
    v_mfma_f32_16x16x32_bf16 v[208:211], a[212:215], v[26:29], v[208:211]
    ds_read_b128 v[84:87], v8 offset:0
    v_fma_f32 v64, v64, s28, v10
    v_mfma_f32_16x16x32_bf16 a[0:3], a[212:215], v[32:35], a[0:3]
    ds_read_b64_tr_b16 a[234:235], v3 offset:7168
    s_waitcnt lgkmcnt(8)
    v_mfma_f32_16x16x32_bf16 a[4:7], a[216:219], v[32:35], a[4:7]
    v_fma_f32 v82, v82, s28, v12
    v_fma_f32 v66, v66, s28, v10
    v_mfma_f32_16x16x32_bf16 v[212:215], a[216:219], v[26:29], v[212:215]
    ds_read_b64_tr_b16 a[230:231], v2 offset:7168
    v_fma_f32 v59, v59, s28, v9
    v_mfma_f32_16x16x32_bf16 v[164:167], a[216:219], v[20:23], v[164:167]
    ds_read_b64_tr_b16 a[214:215], v4 offset:7168
    v_fma_f32 v78, v78, s28, v12
    v_mfma_f32_16x16x32_bf16 v[116:119], a[216:219], v[14:17], v[116:119]
    ds_read_b64_tr_b16 a[212:213], v4 offset:1024
    s_waitcnt lgkmcnt(9)
    v_mfma_f32_16x16x32_bf16 v[120:123], a[220:223], v[14:17], v[120:123]
    v_exp_f32 v82, v82
    v_mfma_f32_16x16x32_bf16 v[168:171], a[220:223], v[20:23], v[168:171]
    v_fma_f32 v68, v68, s28, v11
    v_fma_f32 v58, v58, s28, v9
    v_mfma_f32_16x16x32_bf16 v[216:219], a[220:223], v[26:29], v[216:219]
    ds_read_b64_tr_b16 a[218:219], v5 offset:7168
    v_mfma_f32_16x16x32_bf16 a[8:11], a[220:223], v[32:35], a[8:11]
    s_waitcnt lgkmcnt(6)
    v_exp_f32 v68, v68
    v_mfma_f32_16x16x32_bf16 a[12:15], a[224:227], v[32:35], a[12:15]
    s_add_u32 s39, s39, 12288
    ds_read_b64_tr_b16 a[222:223], v2 offset:8192
    v_mfma_f32_16x16x32_bf16 v[220:223], a[224:227], v[26:29], v[220:223]
    v_fma_f32 v83, v83, s28, v12
    v_fma_f32 v72, v72, s28, v11
    v_mfma_f32_16x16x32_bf16 v[172:175], a[224:227], v[20:23], v[172:175]
    v_fma_f32 v67, v67, s28, v10
    v_fma_f32 v71, v71, s28, v11
    v_mfma_f32_16x16x32_bf16 v[124:127], a[224:227], v[14:17], v[124:127]
    s_waitcnt lgkmcnt(4)
    ds_read_b64_tr_b16 a[220:221], v2 offset:2048
    v_fma_f32 v80, v80, s28, v12
    v_mfma_f32_16x16x32_bf16 v[128:131], a[228:231], v[14:17], v[128:131]
    ds_read_b128 v[88:91], v8 offset:1024
    v_fma_f32 v70, v70, s28, v11
    v_mfma_f32_16x16x32_bf16 v[176:179], a[228:231], v[20:23], v[176:179]
    ds_read_b64_tr_b16 a[216:217], v5 offset:1024
    v_mfma_f32_16x16x32_bf16 v[224:227], a[228:231], v[26:29], v[224:227]
    ds_read_b64_tr_b16 a[226:227], v3 offset:8192
    v_fma_f32 v63, v63, s28, v10
    v_mfma_f32_16x16x32_bf16 a[16:19], a[228:231], v[32:35], a[16:19]
    ds_read_b64_tr_b16 a[230:231], v4 offset:8192
    v_fma_f32 v62, v62, s28, v10
    v_mfma_f32_16x16x32_bf16 a[20:23], a[232:235], v[32:35], a[20:23]
    v_fma_f32 v74, v74, s28, v11
    v_mfma_f32_16x16x32_bf16 v[228:231], a[232:235], v[26:29], v[228:231]
    ds_read_b64_tr_b16 a[228:229], v4 offset:2048
    v_fma_f32 v56, v56, s28, v9
    v_mfma_f32_16x16x32_bf16 v[180:183], a[232:235], v[20:23], v[180:183]
    ds_read_b64_tr_b16 a[224:225], v3 offset:2048
    v_fma_f32 v73, v73, s28, v11
    v_mfma_f32_16x16x32_bf16 v[132:135], a[232:235], v[14:17], v[132:135]
    s_waitcnt lgkmcnt(7)
    ds_read_b64_tr_b16 a[234:235], v5 offset:8192
    v_mfma_f32_16x16x32_bf16 v[136:139], a[212:215], v[14:17], v[136:139]
    ds_read_b64_tr_b16 a[232:233], v5 offset:2048
    v_mfma_f32_16x16x32_bf16 v[184:187], a[212:215], v[20:23], v[184:187]
    v_exp_f32 v74, v74
    v_mfma_f32_16x16x32_bf16 v[232:235], a[212:215], v[26:29], v[232:235]
    v_exp_f32 v62, v62
    v_mfma_f32_16x16x32_bf16 a[24:27], a[212:215], v[32:35], a[24:27]
    s_waitcnt lgkmcnt(6)
    v_exp_f32 v78, v78
    v_mfma_f32_16x16x32_bf16 a[28:31], a[216:219], v[32:35], a[28:31]
    v_exp_f32 v79, v79
    v_mfma_f32_16x16x32_bf16 v[236:239], a[216:219], v[26:29], v[236:239]
    v_exp_f32 v70, v70
    v_mfma_f32_16x16x32_bf16 v[188:191], a[216:219], v[20:23], v[188:191]
    v_exp_f32 v58, v58
    v_mfma_f32_16x16x32_bf16 v[140:143], a[216:219], v[14:17], v[140:143]
    v_exp_f32 v73, v73
    v_mfma_f32_16x16x32_bf16 v[144:147], a[220:223], v[14:17], v[144:147]
    v_fma_f32 v69, v69, s28, v11
    v_fma_f32 v65, v65, s28, v10
    v_mfma_f32_16x16x32_bf16 v[192:195], a[220:223], v[20:23], v[192:195]
    v_fma_f32 v76, v76, s28, v12
    s_waitcnt vmcnt(6) lgkmcnt(0)
    v_mfma_f32_16x16x32_bf16 v[240:243], a[220:223], v[26:29], v[240:243]
    s_barrier
    v_mfma_f32_16x16x32_bf16 a[32:35], a[220:223], v[32:35], a[32:35]
    v_exp_f32 v81, v81
    v_mfma_f32_16x16x32_bf16 a[36:39], a[224:227], v[32:35], a[36:39]
    ds_read_b128 a[212:215], v0 offset:0
    v_fma_f32 v77, v77, s28, v12
    v_mfma_f32_16x16x32_bf16 v[244:247], a[224:227], v[26:29], v[244:247]
    s_add_u32 m0, s22, 24576
    ds_read_b128 a[216:219], v1 offset:0
    v_mfma_f32_16x16x32_bf16 v[196:199], a[224:227], v[20:23], v[196:199]
    buffer_load_dwordx4 v6, s[8:11], s21 offen lds
    v_mfma_f32_16x16x32_bf16 v[148:151], a[224:227], v[14:17], v[148:151]
    ds_read_b128 a[220:223], v0 offset:1024
    s_add_u32 s21, s21, 128
    v_mfma_f32_16x16x32_bf16 v[152:155], a[228:231], v[14:17], v[152:155]
    s_add_u32 m0, s22, 25600
    v_exp_f32 v63, v63
    v_mfma_f32_16x16x32_bf16 v[200:203], a[228:231], v[20:23], v[200:203]
    v_exp_f32 v64, v64
    v_mfma_f32_16x16x32_bf16 v[248:251], a[228:231], v[26:29], v[248:251]
    buffer_load_dwordx4 v6, s[8:11], s21 offen lds
    v_mfma_f32_16x16x32_bf16 a[40:43], a[228:231], v[32:35], a[40:43]
    v_exp_f32 v77, v77
    v_mfma_f32_16x16x32_bf16 a[44:47], a[232:235], v[32:35], a[44:47]
    s_add_u32 s21, s21, 128
    ds_read_b128 a[224:227], v1 offset:1024
    s_add_u32 m0, s22, 26624
    v_mfma_f32_16x16x32_bf16 v[252:255], a[232:235], v[26:29], v[252:255]
    buffer_load_dwordx4 v6, s[8:11], s21 offen lds
    v_mfma_f32_16x16x32_bf16 v[204:207], a[232:235], v[20:23], v[204:207]
    v_exp_f32 v69, v69
    v_mfma_f32_16x16x32_bf16 v[156:159], a[232:235], v[14:17], v[156:159]
    s_waitcnt lgkmcnt(2)
    ds_read_b128 a[228:231], v0 offset:2048
    v_cvt_pk_bf16_f32 v25, v62, v63
    v_mfma_f32_16x16x32_bf16 v[52:55], a[212:215], a[96:99], 0
    v_exp_f32 v56, v56
    v_mfma_f32_16x16x32_bf16 v[52:55], a[216:219], a[100:103], v[52:55]
    s_waitcnt lgkmcnt(2)
    v_exp_f32 v76, v76
    v_mfma_f32_16x16x32_bf16 v[52:55], a[220:223], a[104:107], v[52:55]
    s_add_u32 s21, s21, 12032
    v_exp_f32 v71, v71
    v_mfma_f32_16x16x32_bf16 v[60:63], a[220:223], a[128:131], 0
    ds_read_b128 a[232:235], v1 offset:2048
    v_fma_f32 v75, v75, s28, v11
    v_mfma_f32_16x16x32_bf16 v[60:63], a[216:219], a[124:127], v[60:63]
    v_cvt_pk_bf16_f32 v36, v76, v77
    s_add_u32 m0, s23, 0
    v_mfma_f32_16x16x32_bf16 v[60:63], a[212:215], a[120:123], v[60:63]
    v_cvt_pk_bf16_f32 v31, v70, v71
    v_cvt_pk_bf16_f32 v30, v68, v69
    v_mfma_f32_16x16x32_bf16 v[68:71], a[212:215], a[144:147], 0
    v_exp_f32 v59, v59
    v_mfma_f32_16x16x32_bf16 v[68:71], a[216:219], a[148:151], v[68:71]
    buffer_load_dwordx4 v6, s[12:15], s25 offen nt lds
    v_mfma_f32_16x16x32_bf16 v[68:71], a[220:223], a[152:155], v[68:71]
    v_fma_f32 v57, v57, s28, v9
    v_cvt_pk_bf16_f32 v37, v78, v79
    v_mfma_f32_16x16x32_bf16 v[76:79], a[220:223], a[176:179], 0
    v_exp_f32 v83, v83
    v_mfma_f32_16x16x32_bf16 v[76:79], a[216:219], a[172:175], v[76:79]
    v_exp_f32 v57, v57
    v_mfma_f32_16x16x32_bf16 v[76:79], a[212:215], a[168:171], v[76:79]
    s_waitcnt lgkmcnt(1)
    v_exp_f32 v75, v75
    v_mfma_f32_16x16x32_bf16 v[76:79], a[224:227], a[180:183], v[76:79]
    ds_read_b128 a[212:215], v0 offset:6144
    v_cvt_pk_bf16_f32 v17, v58, v59
    v_mfma_f32_16x16x32_bf16 v[76:79], a[228:231], a[184:187], v[76:79]
    s_waitcnt lgkmcnt(1)
    v_exp_f32 v72, v72
    v_mfma_f32_16x16x32_bf16 v[76:79], a[232:235], a[188:191], v[76:79]
    v_exp_f32 v65, v65
    v_mfma_f32_16x16x32_bf16 v[68:71], a[232:235], a[164:167], v[68:71]
    ds_read_b128 a[220:223], v0 offset:7168
    v_cvt_pk_bf16_f32 v35, v82, v83
    v_mfma_f32_16x16x32_bf16 v[68:71], a[228:231], a[160:163], v[68:71]
    buffer_store_dwordx4 v[84:87], v102, s[16:19], s24 offen offset:0 nt
    ds_read_b128 a[216:219], v1 offset:6144
    v_exp_f32 v80, v80
    v_mfma_f32_16x16x32_bf16 v[68:71], a[224:227], a[156:159], v[68:71]
    v_exp_f32 v67, v67
    v_mfma_f32_16x16x32_bf16 v[60:63], a[224:227], a[132:135], v[60:63]
    v_cvt_pk_bf16_f32 v34, v80, v81
    v_mfma_f32_16x16x32_bf16 v[60:63], a[228:231], a[136:139], v[60:63]
    v_cvt_pk_bf16_f32 v16, v56, v57
    v_cvt_pk_bf16_f32 v29, v74, v75
    v_mfma_f32_16x16x32_bf16 v[60:63], a[232:235], a[140:143], v[60:63]
    v_exp_f32 v66, v66
    v_mfma_f32_16x16x32_bf16 v[52:55], a[232:235], a[116:119], v[52:55]
    ds_read_b128 a[232:235], v1 offset:8192
    v_cvt_pk_bf16_f32 v23, v66, v67
    v_mfma_f32_16x16x32_bf16 v[52:55], a[228:231], a[112:115], v[52:55]
    s_add_u32 m0, s23, 1024
    ds_read_b128 a[228:231], v0 offset:8192
    v_mfma_f32_16x16x32_bf16 v[52:55], a[224:227], a[108:111], v[52:55]
    ds_read_b128 a[224:227], v1 offset:7168
    v_cvt_pk_bf16_f32 v22, v64, v65
    v_mfma_f32_16x16x32_bf16 v[48:51], a[236:239], v[16:19], v[44:47]
    v_cvt_pk_bf16_f32 v28, v72, v73
    v_mfma_f32_16x16x32_bf16 v[48:51], a[240:243], v[22:25], v[48:51]
    s_nop 0
    v_mfma_f32_16x16x32_bf16 v[48:51], a[244:247], v[28:31], v[48:51]
    buffer_load_dwordx4 v7, s[12:15], s25 offen nt lds
    v_mfma_f32_16x16x32_bf16 v[48:51], a[248:251], v[34:37], v[48:51]
    s_bitcmp1_b32 s27, 0
    s_waitcnt lgkmcnt(3)
    v_mfma_f32_16x16x32_bf16 v[56:59], a[212:215], a[96:99], 0
    buffer_store_dwordx4 v[88:91], v103, s[16:19], s24 offen offset:0 nt
    s_cselect_b32 s26, s49, 128
    s_lshr_b32 s27, s27, 1
    s_nop 1
    v_cmp_lt_f32 vcc, s29, v48
    v_mfma_f32_16x16x32_bf16 v[56:59], a[216:219], a[100:103], v[56:59]
    s_add_u32 s24, s24, s26
    s_add_u32 s25, s25, s26
    s_add_u32 s23, s23, 2048
    v_mfma_f32_16x16x32_bf16 v[56:59], a[220:223], a[104:107], v[56:59]
    s_cbranch_vccnz L_rs_loop4w0b
L_ret_loop4w0b:
    v_add_u32 v8, 2048, v8
    v_mfma_f32_16x16x32_bf16 v[64:67], a[220:223], a[128:131], 0
    v_fma_f32 v52, v52, s28, v9
    v_fma_f32 v53, v53, s28, v9
    v_mfma_f32_16x16x32_bf16 v[64:67], a[216:219], a[124:127], v[64:67]
    s_waitcnt vmcnt(10) lgkmcnt(0)
    s_cmp_eq_u32 s30, 5
    s_cselect_b32 s26, s62, 0
    v_mfma_f32_16x16x32_bf16 v[64:67], a[212:215], a[120:123], v[64:67]
    s_barrier
    v_mfma_f32_16x16x32_bf16 v[72:75], a[212:215], a[144:147], 0
    s_add_u32 s20, s20, s26
    v_fma_f32 v54, v54, s28, v9
    s_add_u32 m0, s22, 0
    v_mfma_f32_16x16x32_bf16 v[72:75], a[216:219], a[148:151], v[72:75]
    buffer_load_dwordx4 v6, s[4:7], s20 offen lds
    v_mfma_f32_16x16x32_bf16 v[72:75], a[220:223], a[152:155], v[72:75]
    v_exp_f32 v52, v52
    v_mfma_f32_16x16x32_bf16 v[80:83], a[220:223], a[176:179], 0
    s_add_u32 s20, s20, 128
    v_exp_f32 v53, v53
    v_mfma_f32_16x16x32_bf16 v[80:83], a[216:219], a[172:175], v[80:83]
    s_add_u32 m0, s22, 1024
    v_cvt_pk_bf16_f32 v14, v52, v53
    v_fma_f32 v60, v60, s28, v10
    v_mfma_f32_16x16x32_bf16 v[80:83], a[212:215], a[168:171], v[80:83]
    buffer_load_dwordx4 v6, s[4:7], s20 offen lds
    v_mfma_f32_16x16x32_bf16 v[80:83], a[224:227], a[180:183], v[80:83]
    s_add_u32 s20, s20, 128
    ds_read_b64_tr_b16 a[212:213], v2 offset:18432
    s_add_u32 m0, s22, 2048
    v_mfma_f32_16x16x32_bf16 v[80:83], a[228:231], a[184:187], v[80:83]
    v_exp_f32 v60, v60
    v_mfma_f32_16x16x32_bf16 v[80:83], a[232:235], a[188:191], v[80:83]
    buffer_load_dwordx4 v6, s[4:7], s20 offen lds
    v_mfma_f32_16x16x32_bf16 v[72:75], a[232:235], a[164:167], v[72:75]
    s_add_u32 s20, s20, 12032
    ds_read_b64_tr_b16 a[214:215], v2 offset:12288
    v_fma_f32 v61, v61, s28, v10
    v_mfma_f32_16x16x32_bf16 v[72:75], a[228:231], a[160:163], v[72:75]
    v_exp_f32 v61, v61
    v_mfma_f32_16x16x32_bf16 v[72:75], a[224:227], a[156:159], v[72:75]
    ds_read_b64_tr_b16 a[216:217], v3 offset:18432
    v_mfma_f32_16x16x32_bf16 v[64:67], a[224:227], a[132:135], v[64:67]
    ds_read_b64_tr_b16 a[218:219], v3 offset:12288
    v_cvt_pk_bf16_f32 v20, v60, v61
    v_mfma_f32_16x16x32_bf16 v[64:67], a[228:231], a[136:139], v[64:67]
    v_exp_f32 v54, v54
    v_mfma_f32_16x16x32_bf16 v[64:67], a[232:235], a[140:143], v[64:67]
    s_add_u32 s30, s30, 1
    ds_read_b64_tr_b16 a[220:221], v4 offset:18432
    v_fma_f32 v55, v55, s28, v9
    v_mfma_f32_16x16x32_bf16 v[56:59], a[232:235], a[116:119], v[56:59]
    v_exp_f32 v55, v55
    v_mfma_f32_16x16x32_bf16 v[56:59], a[228:231], a[112:115], v[56:59]
    s_cmp_lt_u32 s30, 6
    ds_read_b64_tr_b16 a[222:223], v4 offset:12288
    v_cvt_pk_bf16_f32 v15, v54, v55
    v_mfma_f32_16x16x32_bf16 v[56:59], a[224:227], a[108:111], v[56:59]
    ds_read_b64_tr_b16 a[224:225], v5 offset:18432
    ds_read_b64_tr_b16 a[226:227], v5 offset:12288
    s_cbranch_scc1 L_loop4w0
    s_cmp_ge_u32 s37, 6
    s_cbranch_scc1 L_end4
    s_cmp_eq_u32 s32, 0
    s_cbranch_scc1 L_tr44
    s_branch L_tr45
L_tr45:
    s_waitcnt lgkmcnt(6)
    v_mfma_f32_16x16x32_bf16 v[112:115], a[212:215], v[16:19], v[112:115]
    v_mbcnt_lo_u32_b32 v107, -1, 0
    v_fma_f32 v65, v65, s28, v10
    v_mfma_f32_16x16x32_bf16 v[160:163], a[212:215], v[22:25], v[160:163]
    v_fma_f32 v82, v82, s28, v12
    v_fma_f32 v81, v81, s28, v12
    v_mbcnt_hi_u32_b32 v107, -1, v107
    v_fma_f32 v63, v63, s28, v10
    v_mfma_f32_16x16x32_bf16 v[208:211], a[212:215], v[28:31], v[208:211]
    ds_read_b64_tr_b16 a[230:231], v2 offset:13312
    v_fma_f32 v56, v56, s28, v9
    v_mfma_f32_16x16x32_bf16 a[0:3], a[212:215], v[34:37], a[0:3]
    s_waitcnt lgkmcnt(5)
    ds_read_b64_tr_b16 a[228:229], v2 offset:19456
    v_fma_f32 v72, v72, s28, v11
    v_mfma_f32_16x16x32_bf16 a[4:7], a[216:219], v[34:37], a[4:7]
    ds_read_b64_tr_b16 a[234:235], v3 offset:13312
    v_fma_f32 v78, v78, s28, v12
    v_mfma_f32_16x16x32_bf16 v[212:215], a[216:219], v[28:31], v[212:215]
    s_add_u32 s39, s39, 12288
    ds_read_b64_tr_b16 a[232:233], v3 offset:19456
    v_and_b32 v106, 15, v107
    v_mfma_f32_16x16x32_bf16 v[164:167], a[216:219], v[22:25], v[164:167]
    ds_read_b64_tr_b16 a[214:215], v4 offset:13312
    v_fma_f32 v80, v80, s28, v12
    v_mfma_f32_16x16x32_bf16 v[116:119], a[216:219], v[16:19], v[116:119]
    s_waitcnt lgkmcnt(7)
    ds_read_b64_tr_b16 a[212:213], v4 offset:19456
    v_lshrrev_b32 v107, 4, v107
    v_mfma_f32_16x16x32_bf16 v[120:123], a[220:223], v[16:19], v[120:123]
    s_add_u32 s48, s33, 24576
    v_mul_u32_u24 v106, 384, v106
    v_lshl_add_u32 v106, v107, 4, v106
    v_mfma_f32_16x16x32_bf16 v[168:171], a[220:223], v[22:25], v[168:171]
    ds_read_b64_tr_b16 a[218:219], v5 offset:13312
    v_fma_f32 v77, v77, s28, v12
    v_mfma_f32_16x16x32_bf16 v[216:219], a[220:223], v[28:31], v[216:219]
    buffer_load_dwordx4 a[208:211], v106, s[12:15], s48 offen offset:256 nt
    v_mfma_f32_16x16x32_bf16 a[8:11], a[220:223], v[34:37], a[8:11]
    s_waitcnt lgkmcnt(7)
    ds_read_b64_tr_b16 a[216:217], v5 offset:19456
    v_fma_f32 v67, v67, s28, v10
    v_mfma_f32_16x16x32_bf16 a[12:15], a[224:227], v[34:37], a[12:15]
    v_fma_f32 v70, v70, s28, v11
    v_fma_f32 v73, v73, s28, v11
    v_mfma_f32_16x16x32_bf16 v[220:223], a[224:227], v[28:31], v[220:223]
    buffer_load_dwordx4 v[92:95], v106, s[12:15], s48 offen offset:320 nt
    v_mfma_f32_16x16x32_bf16 v[172:175], a[224:227], v[22:25], v[172:175]
    ds_read_b64_tr_b16 a[222:223], v2 offset:14336
    v_fma_f32 v69, v69, s28, v11
    v_mfma_f32_16x16x32_bf16 v[124:127], a[224:227], v[16:19], v[124:127]
    s_waitcnt lgkmcnt(5)
    v_exp_f32 v77, v77
    v_mfma_f32_16x16x32_bf16 v[128:131], a[228:231], v[16:19], v[128:131]
    v_exp_f32 v78, v78
    v_fma_f32 v64, v64, s28, v10
    v_mfma_f32_16x16x32_bf16 v[176:179], a[228:231], v[22:25], v[176:179]
    ds_read_b64_tr_b16 a[224:225], v3 offset:20480
    v_fma_f32 v59, v59, s28, v9
    v_mfma_f32_16x16x32_bf16 v[224:227], a[228:231], v[28:31], v[224:227]
    ds_read_b64_tr_b16 a[220:221], v2 offset:20480
    v_fma_f32 v71, v71, s28, v11
    v_mfma_f32_16x16x32_bf16 a[16:19], a[228:231], v[34:37], a[16:19]
    ds_read_b64_tr_b16 a[226:227], v3 offset:14336
    v_fma_f32 v62, v62, s28, v10
    v_mfma_f32_16x16x32_bf16 a[20:23], a[232:235], v[34:37], a[20:23]
    ds_read_b64_tr_b16 a[228:229], v4 offset:20480
    v_fma_f32 v68, v68, s28, v11
    v_mfma_f32_16x16x32_bf16 v[228:231], a[232:235], v[28:31], v[228:231]
    v_exp_f32 v62, v62
    v_mfma_f32_16x16x32_bf16 v[180:183], a[232:235], v[22:25], v[180:183]
    ds_read_b64_tr_b16 a[230:231], v4 offset:14336
    v_fma_f32 v66, v66, s28, v10
    v_mfma_f32_16x16x32_bf16 v[132:135], a[232:235], v[16:19], v[132:135]
    s_waitcnt lgkmcnt(6)
    ds_read_b64_tr_b16 a[232:233], v5 offset:20480
    ds_read_b64_tr_b16 a[234:235], v5 offset:14336
    v_mfma_f32_16x16x32_bf16 v[136:139], a[212:215], v[16:19], v[136:139]
    v_exp_f32 v63, v63
    v_mfma_f32_16x16x32_bf16 v[184:187], a[212:215], v[22:25], v[184:187]
    ds_read_b128 v[96:99], v8 offset:2048
    v_exp_f32 v70, v70
    v_mfma_f32_16x16x32_bf16 v[232:235], a[212:215], v[28:31], v[232:235]
    ds_read_b128 v[84:87], v8 offset:3072
    v_fma_f32 v57, v57, s28, v9
    v_mfma_f32_16x16x32_bf16 a[24:27], a[212:215], v[34:37], a[24:27]
    v_fma_f32 v58, v58, s28, v9
    v_cvt_pk_bf16_f32 v21, v62, v63
    v_mfma_f32_16x16x32_bf16 a[28:31], a[216:219], v[34:37], a[28:31]
    v_exp_f32 v65, v65
    v_mfma_f32_16x16x32_bf16 v[236:239], a[216:219], v[28:31], v[236:239]
    v_exp_f32 v69, v69
    v_mfma_f32_16x16x32_bf16 v[188:191], a[216:219], v[22:25], v[188:191]
    v_exp_f32 v68, v68
    v_mfma_f32_16x16x32_bf16 v[140:143], a[216:219], v[16:19], v[140:143]
    s_waitcnt lgkmcnt(5)
    v_exp_f32 v67, v67
    v_mfma_f32_16x16x32_bf16 v[144:147], a[220:223], v[16:19], v[144:147]
    v_exp_f32 v59, v59
    v_mfma_f32_16x16x32_bf16 v[192:195], a[220:223], v[22:25], v[192:195]
    s_waitcnt vmcnt(12) lgkmcnt(2)
    ds_read_b128 v[88:91], v8 offset:4096
    v_fma_f32 v76, v76, s28, v12
    v_mfma_f32_16x16x32_bf16 v[240:243], a[220:223], v[28:31], v[240:243]
    s_barrier
    v_mfma_f32_16x16x32_bf16 a[32:35], a[220:223], v[34:37], a[32:35]
    s_add_u32 m0, s22, 36864
    ds_read_b128 a[212:215], v0 offset:12288
    v_fma_f32 v75, v75, s28, v11
    v_mfma_f32_16x16x32_bf16 a[36:39], a[224:227], v[34:37], a[36:39]
    buffer_load_dwordx4 v6, s[8:11], s21 offen lds
    v_mfma_f32_16x16x32_bf16 v[244:247], a[224:227], v[28:31], v[244:247]
    ds_read_b128 a[216:219], v1 offset:12288
    v_fma_f32 v79, v79, s28, v12
    v_mfma_f32_16x16x32_bf16 v[196:199], a[224:227], v[22:25], v[196:199]
    s_add_u32 s21, s21, 128
    ds_read_b128 a[220:223], v0 offset:13312
    v_fma_f32 v83, v83, s28, v12
    v_mfma_f32_16x16x32_bf16 v[148:151], a[224:227], v[16:19], v[148:151]
    v_exp_f32 v58, v58
    v_mfma_f32_16x16x32_bf16 v[152:155], a[228:231], v[16:19], v[152:155]
    s_add_u32 m0, s22, 37888
    v_exp_f32 v64, v64
    v_mfma_f32_16x16x32_bf16 v[200:203], a[228:231], v[22:25], v[200:203]
    buffer_load_dwordx4 v6, s[8:11], s21 offen lds
    v_mfma_f32_16x16x32_bf16 v[248:251], a[228:231], v[28:31], v[248:251]
    s_add_u32 s21, s21, 128
    v_exp_f32 v81, v81
    v_mfma_f32_16x16x32_bf16 a[40:43], a[228:231], v[34:37], a[40:43]
    s_add_u32 m0, s22, 38912
    v_exp_f32 v71, v71
    v_mfma_f32_16x16x32_bf16 a[44:47], a[232:235], v[34:37], a[44:47]
    buffer_load_dwordx4 v6, s[8:11], s21 offen lds
    v_mfma_f32_16x16x32_bf16 v[252:255], a[232:235], v[28:31], v[252:255]
    v_exp_f32 v79, v79
    v_mfma_f32_16x16x32_bf16 v[204:207], a[232:235], v[22:25], v[204:207]
    v_exp_f32 v66, v66
    v_mfma_f32_16x16x32_bf16 v[156:159], a[232:235], v[16:19], v[156:159]
    s_waitcnt lgkmcnt(1)
    ds_read_b128 a[228:231], v0 offset:14336
    v_cvt_pk_bf16_f32 v27, v70, v71
    v_mfma_f32_16x16x32_bf16 v[52:55], a[212:215], a[96:99], 0
    ds_read_b128 a[224:227], v1 offset:13312
    v_cvt_pk_bf16_f32 v26, v68, v69
    v_mfma_f32_16x16x32_bf16 v[52:55], a[216:219], a[100:103], v[52:55]
    s_waitcnt lgkmcnt(2)
    v_exp_f32 v75, v75
    v_mfma_f32_16x16x32_bf16 v[52:55], a[220:223], a[104:107], v[52:55]
    s_add_u32 s21, s21, 12032
    v_exp_f32 v76, v76
    v_mfma_f32_16x16x32_bf16 v[60:63], a[220:223], a[128:131], 0
    v_exp_f32 v72, v72
    v_mfma_f32_16x16x32_bf16 v[60:63], a[216:219], a[124:127], v[60:63]
    ds_read_b128 a[232:235], v1 offset:14336
    s_add_u32 s56, s24, 5888
    v_mfma_f32_16x16x32_bf16 v[60:63], a[212:215], a[120:123], v[60:63]
    v_cvt_pk_bf16_f32 v23, v66, v67
    v_fma_f32 v74, v74, s28, v11
    v_mfma_f32_16x16x32_bf16 v[68:71], a[212:215], a[144:147], 0
    s_add_u32 s58, s25, 5888
    v_cvt_pk_bf16_f32 v33, v78, v79
    v_cvt_pk_bf16_f32 v32, v76, v77
    v_mfma_f32_16x16x32_bf16 v[68:71], a[216:219], a[148:151], v[68:71]
    s_add_u32 m0, s38, 24576
    v_exp_f32 v80, v80
    v_mfma_f32_16x16x32_bf16 v[68:71], a[220:223], a[152:155], v[68:71]
    buffer_load_dwordx4 v6, s[12:15], s58 offen nt lds
    v_mfma_f32_16x16x32_bf16 v[76:79], a[220:223], a[176:179], 0
    buffer_store_dwordx4 v[96:99], v102, s[16:19], s56 offen offset:0 nt
    v_exp_f32 v56, v56
    v_mfma_f32_16x16x32_bf16 v[76:79], a[216:219], a[172:175], v[76:79]
    v_exp_f32 v82, v82
    v_mfma_f32_16x16x32_bf16 v[76:79], a[212:215], a[168:171], v[76:79]
    s_waitcnt lgkmcnt(1)
    v_exp_f32 v57, v57
    v_mfma_f32_16x16x32_bf16 v[76:79], a[224:227], a[180:183], v[76:79]
    buffer_store_dwordx4 v[84:87], v103, s[16:19], s56 offen offset:0 nt
    s_add_u32 m0, s38, 25600
    ds_read_b128 a[216:219], v1 offset:18432
    v_exp_f32 v83, v83
    v_mfma_f32_16x16x32_bf16 v[76:79], a[228:231], a[184:187], v[76:79]
    s_waitcnt lgkmcnt(1)
    ds_read_b128 v[96:99], v8 offset:5120
    v_cvt_pk_bf16_f32 v22, v64, v65
    v_mfma_f32_16x16x32_bf16 v[76:79], a[232:235], a[188:191], v[76:79]
    buffer_load_dwordx4 v7, s[12:15], s58 offen nt lds
    v_mfma_f32_16x16x32_bf16 v[68:71], a[232:235], a[164:167], v[68:71]
    v_cvt_pk_bf16_f32 v35, v82, v83
    s_add_u32 s57, s24, 6016
    v_mfma_f32_16x16x32_bf16 v[68:71], a[228:231], a[160:163], v[68:71]
    s_add_u32 s59, s25, 6016
    ds_read_b128 v[84:87], v8 offset:0
    v_cvt_pk_bf16_f32 v34, v80, v81
    v_mfma_f32_16x16x32_bf16 v[68:71], a[224:227], a[156:159], v[68:71]
    buffer_store_dwordx4 v[88:91], v102, s[16:19], s57 offen offset:0 nt
    v_cvt_pk_bf16_f32 v17, v58, v59
    v_exp_f32 v74, v74
    v_mfma_f32_16x16x32_bf16 v[60:63], a[224:227], a[132:135], v[60:63]
    s_add_u32 m0, s38, 26624
    ds_read_b128 a[212:215], v0 offset:18432
    v_cvt_pk_bf16_f32 v16, v56, v57
    v_mfma_f32_16x16x32_bf16 v[60:63], a[228:231], a[136:139], v[60:63]
    buffer_load_dwordx4 v6, s[12:15], s59 offen nt lds
    v_mfma_f32_16x16x32_bf16 v[60:63], a[232:235], a[140:143], v[60:63]
    ds_read_b128 v[88:91], v8 offset:1024
    v_mfma_f32_16x16x32_bf16 v[52:55], a[232:235], a[116:119], v[52:55]
    ds_read_b128 a[220:223], v0 offset:19456
    v_mfma_f32_16x16x32_bf16 v[52:55], a[228:231], a[112:115], v[52:55]
    s_add_u32 m0, s38, 27648
    v_exp_f32 v73, v73
    v_mfma_f32_16x16x32_bf16 v[44:47], a[236:239], v[14:17], v[48:51]
    ds_read_b128 a[228:231], v0 offset:20480
    v_cvt_pk_bf16_f32 v28, v72, v73
    v_mfma_f32_16x16x32_bf16 v[52:55], a[224:227], a[108:111], v[52:55]
    ds_read_b128 a[232:235], v1 offset:20480
    v_cvt_pk_bf16_f32 v29, v74, v75
    v_mfma_f32_16x16x32_bf16 v[44:47], a[240:243], v[20:23], v[44:47]
    ds_read_b128 a[224:227], v1 offset:19456
    v_mfma_f32_16x16x32_bf16 v[44:47], a[244:247], v[26:29], v[44:47]
    s_waitcnt lgkmcnt(6)
    buffer_load_dwordx4 v7, s[12:15], s59 offen nt lds
    v_mfma_f32_16x16x32_bf16 v[44:47], a[248:251], v[32:35], v[44:47]
    s_add_u32 m0, s38, 22528
    s_waitcnt lgkmcnt(5)
    v_mfma_f32_16x16x32_bf16 v[56:59], a[212:215], a[96:99], 0
    buffer_load_dwordx4 v6, s[12:15], s25 offen nt lds
    v_mfma_f32_16x16x32_bf16 v[56:59], a[216:219], a[100:103], v[56:59]
    buffer_store_dwordx4 v[96:99], v103, s[16:19], s57 offen offset:0 nt
    s_nop 1
    v_cmp_lt_f32 vcc, s29, v44
    s_add_u32 m0, s38, 23552
    s_waitcnt lgkmcnt(3)
    v_mfma_f32_16x16x32_bf16 v[56:59], a[220:223], a[104:107], v[56:59]
    v_mfma_f32_16x16x32_bf16 v[64:67], a[220:223], a[128:131], 0
    buffer_load_dwordx4 v7, s[12:15], s25 offen nt lds
    v_mfma_f32_16x16x32_bf16 v[64:67], a[216:219], a[124:127], v[64:67]
    buffer_store_dwordx4 v[84:87], v102, s[16:19], s24 offen offset:0 nt
    s_cbranch_vccnz L_rs_tr45a
L_ret_tr45a:
    v_fma_f32 v54, v54, s28, v9
    s_waitcnt vmcnt(20) lgkmcnt(0)
    s_add_u32 m0, s22, 12288
    v_mfma_f32_16x16x32_bf16 v[64:67], a[212:215], a[120:123], v[64:67]
    s_barrier
    v_mfma_f32_16x16x32_bf16 v[72:75], a[212:215], a[144:147], 0
    buffer_load_dwordx4 v6, s[4:7], s20 offen lds
    v_mfma_f32_16x16x32_bf16 v[72:75], a[216:219], a[148:151], v[72:75]
    s_add_u32 s20, s20, 128
    v_fma_f32 v60, v60, s28, v10
    s_add_u32 m0, s22, 13312
    v_mfma_f32_16x16x32_bf16 v[72:75], a[220:223], a[152:155], v[72:75]
    buffer_load_dwordx4 v6, s[4:7], s20 offen lds
    v_mfma_f32_16x16x32_bf16 v[80:83], a[220:223], a[176:179], 0
    s_add_u32 s20, s20, 128
    s_add_u32 m0, s22, 14336
    v_fma_f32 v53, v53, s28, v9
    v_mfma_f32_16x16x32_bf16 v[80:83], a[216:219], a[172:175], v[80:83]
    buffer_load_dwordx4 v6, s[4:7], s20 offen lds
    v_mfma_f32_16x16x32_bf16 v[80:83], a[212:215], a[168:171], v[80:83]
    v_exp_f32 v60, v60
    v_mfma_f32_16x16x32_bf16 v[80:83], a[224:227], a[180:183], v[80:83]
    ds_read_b64_tr_b16 a[212:213], v2 offset:0
    v_fma_f32 v61, v61, s28, v10
    v_mfma_f32_16x16x32_bf16 v[80:83], a[228:231], a[184:187], v[80:83]
    v_exp_f32 v61, v61
    v_mfma_f32_16x16x32_bf16 v[80:83], a[232:235], a[188:191], v[80:83]
    ds_read_b64_tr_b16 a[214:215], v2 offset:6144
    v_cvt_pk_bf16_f32 v24, v60, v61
    v_mfma_f32_16x16x32_bf16 v[72:75], a[232:235], a[164:167], v[72:75]
    ds_read_b64_tr_b16 a[216:217], v3 offset:0
    v_fma_f32 v55, v55, s28, v9
    v_mfma_f32_16x16x32_bf16 v[72:75], a[228:231], a[160:163], v[72:75]
    ds_read_b64_tr_b16 a[218:219], v3 offset:6144
    v_fma_f32 v52, v52, s28, v9
    v_mfma_f32_16x16x32_bf16 v[72:75], a[224:227], a[156:159], v[72:75]
    v_exp_f32 v55, v55
    v_mfma_f32_16x16x32_bf16 v[64:67], a[224:227], a[132:135], v[64:67]
    v_exp_f32 v54, v54
    v_mfma_f32_16x16x32_bf16 v[64:67], a[228:231], a[136:139], v[64:67]
    v_exp_f32 v52, v52
    v_mfma_f32_16x16x32_bf16 v[64:67], a[232:235], a[140:143], v[64:67]
    ds_read_b64_tr_b16 a[220:221], v4 offset:0
    v_mfma_f32_16x16x32_bf16 v[56:59], a[232:235], a[116:119], v[56:59]
    v_exp_f32 v53, v53
    v_mfma_f32_16x16x32_bf16 v[56:59], a[228:231], a[112:115], v[56:59]
    buffer_store_dwordx4 v[88:91], v103, s[16:19], s24 offen offset:0 nt
    ds_read_b64_tr_b16 a[222:223], v4 offset:6144
    v_cvt_pk_bf16_f32 v18, v52, v53
    v_cvt_pk_bf16_f32 v19, v54, v55
    v_mfma_f32_16x16x32_bf16 v[56:59], a[224:227], a[108:111], v[56:59]
    s_add_u32 s20, s20, 12032
    ds_read_b64_tr_b16 a[224:225], v5 offset:0
    ds_read_b64_tr_b16 a[226:227], v5 offset:6144
    v_fma_f32 v71, v71, s28, v11
    v_lshrrev_b32 v105, 11, v0
    s_waitcnt lgkmcnt(6)
    v_mfma_f32_16x16x32_bf16 v[112:115], a[212:215], v[14:17], v[112:115]
    ds_read_b64_tr_b16 a[230:231], v2 offset:7168
    v_xor_b32 v105, s65, v105
    v_mfma_f32_16x16x32_bf16 v[160:163], a[212:215], v[20:23], v[160:163]
    ds_read_b64_tr_b16 a[228:229], v2 offset:1024
    v_and_b32 v104, 0x3ff, v0
    v_mfma_f32_16x16x32_bf16 v[208:211], a[212:215], v[26:29], v[208:211]
    ds_read_b64_tr_b16 a[234:235], v3 offset:7168
    v_lshl_add_u32 v104, v105, 10, v104
    v_mfma_f32_16x16x32_bf16 a[0:3], a[212:215], v[32:35], a[0:3]
    s_waitcnt lgkmcnt(7)
    v_fma_f32 v69, v69, s28, v11
    v_fma_f32 v81, v81, s28, v12
    v_mfma_f32_16x16x32_bf16 a[4:7], a[216:219], v[32:35], a[4:7]
    ds_read_b64_tr_b16 a[212:213], v4 offset:1024
    v_fma_f32 v77, v77, s28, v12
    v_mfma_f32_16x16x32_bf16 v[212:215], a[216:219], v[26:29], v[212:215]
    ds_read_b64_tr_b16 a[232:233], v3 offset:1024
    v_exp_f32 v69, v69
    v_mfma_f32_16x16x32_bf16 v[164:167], a[216:219], v[20:23], v[164:167]
    v_add_u32 v104, s38, v104
    v_exp_f32 v71, v71
    v_mfma_f32_16x16x32_bf16 v[116:119], a[216:219], v[14:17], v[116:119]
    s_waitcnt lgkmcnt(7)
    ds_read_b64_tr_b16 a[218:219], v5 offset:7168
    v_fma_f32 v65, v65, s28, v10
    v_mfma_f32_16x16x32_bf16 v[120:123], a[220:223], v[14:17], v[120:123]
    ds_read_b64_tr_b16 a[216:217], v5 offset:1024
    v_fma_f32 v58, v58, s28, v9
    v_mfma_f32_16x16x32_bf16 v[168:171], a[220:223], v[20:23], v[168:171]
    ds_read_b128 a[104:107], v104 offset:2048
    v_fma_f32 v76, v76, s28, v12
    v_mfma_f32_16x16x32_bf16 v[216:219], a[220:223], v[26:29], v[216:219]
    ds_read_b128 a[128:131], v104 offset:8192
    v_fma_f32 v79, v79, s28, v12
    v_mfma_f32_16x16x32_bf16 a[8:11], a[220:223], v[32:35], a[8:11]
    s_waitcnt lgkmcnt(7)
    ds_read_b128 a[144:147], v104 offset:12288
    v_fma_f32 v70, v70, s28, v11
    v_mfma_f32_16x16x32_bf16 a[12:15], a[224:227], v[32:35], a[12:15]
    v_exp_f32 v70, v70
    v_mfma_f32_16x16x32_bf16 v[220:223], a[224:227], v[26:29], v[220:223]
    ds_read_b64_tr_b16 a[214:215], v4 offset:7168
    v_fma_f32 v78, v78, s28, v12
    v_mfma_f32_16x16x32_bf16 v[172:175], a[224:227], v[20:23], v[172:175]
    ds_read_b64_tr_b16 a[222:223], v2 offset:8192
    v_fma_f32 v68, v68, s28, v11
    v_mfma_f32_16x16x32_bf16 v[124:127], a[224:227], v[14:17], v[124:127]
    ds_read_b128 a[176:179], v104 offset:20480
    v_xor_b32 v105, 64, v104
    v_mfma_f32_16x16x32_bf16 v[128:131], a[228:231], v[14:17], v[128:131]
    ds_read_b64_tr_b16 a[220:221], v2 offset:2048
    v_fma_f32 v66, v66, s28, v10
    v_mfma_f32_16x16x32_bf16 v[176:179], a[228:231], v[20:23], v[176:179]
    ds_read_b64_tr_b16 a[226:227], v3 offset:8192
    v_fma_f32 v64, v64, s28, v10
    v_mfma_f32_16x16x32_bf16 v[224:227], a[228:231], v[26:29], v[224:227]
    s_add_u32 s39, s39, 12288
    ds_read_b128 a[120:123], v104 offset:6144
    v_fma_f32 v67, v67, s28, v10
    v_mfma_f32_16x16x32_bf16 a[16:19], a[228:231], v[32:35], a[16:19]
    s_waitcnt lgkmcnt(8)
    ds_read_b64_tr_b16 a[230:231], v4 offset:8192
    v_fma_f32 v75, v75, s28, v11
    v_mfma_f32_16x16x32_bf16 a[20:23], a[232:235], v[32:35], a[20:23]
    v_exp_f32 v78, v78
    v_mfma_f32_16x16x32_bf16 v[228:231], a[232:235], v[26:29], v[228:231]
    ds_read_b64_tr_b16 a[228:229], v4 offset:2048
    v_cvt_pk_bf16_f32 v31, v70, v71
    v_mfma_f32_16x16x32_bf16 v[180:183], a[232:235], v[20:23], v[180:183]
    ds_read_b64_tr_b16 a[224:225], v3 offset:2048
    v_fma_f32 v62, v62, s28, v10
    v_mfma_f32_16x16x32_bf16 v[132:135], a[232:235], v[14:17], v[132:135]
    s_waitcnt lgkmcnt(8)
    ds_read_b64_tr_b16 a[232:233], v5 offset:2048
    v_fma_f32 v57, v57, s28, v9
    v_mfma_f32_16x16x32_bf16 v[136:139], a[212:215], v[14:17], v[136:139]
    ds_read_b64_tr_b16 a[234:235], v5 offset:8192
    v_exp_f32 v76, v76
    v_mfma_f32_16x16x32_bf16 v[184:187], a[212:215], v[20:23], v[184:187]
    v_exp_f32 v62, v62
    v_mfma_f32_16x16x32_bf16 v[232:235], a[212:215], v[26:29], v[232:235]
    v_exp_f32 v68, v68
    v_mfma_f32_16x16x32_bf16 a[24:27], a[212:215], v[32:35], a[24:27]
    ds_read_b128 a[168:171], v104 offset:18432
    v_fma_f32 v73, v73, s28, v11
    v_mfma_f32_16x16x32_bf16 a[28:31], a[216:219], v[32:35], a[28:31]
    ds_read_b128 a[152:155], v104 offset:14336
    v_fma_f32 v63, v63, s28, v10
    v_mfma_f32_16x16x32_bf16 v[236:239], a[216:219], v[26:29], v[236:239]
    ds_read_b128 a[124:127], v105 offset:6144
    v_exp_f32 v77, v77
    v_mfma_f32_16x16x32_bf16 v[188:191], a[216:219], v[20:23], v[188:191]
    v_fma_f32 v59, v59, s28, v9
    v_fma_f32 v74, v74, s28, v11
    v_mfma_f32_16x16x32_bf16 v[140:143], a[216:219], v[14:17], v[140:143]
    s_waitcnt lgkmcnt(6)
    ds_read_b128 a[96:99], v104 offset:0
    v_mfma_f32_16x16x32_bf16 v[144:147], a[220:223], v[14:17], v[144:147]
    ds_read_b128 a[148:151], v105 offset:12288
    v_exp_f32 v67, v67
    v_mfma_f32_16x16x32_bf16 v[192:195], a[220:223], v[20:23], v[192:195]
    s_waitcnt vmcnt(20) lgkmcnt(5)
    ds_read_b128 a[112:115], v104 offset:4096
    v_fma_f32 v83, v83, s28, v12
    v_mfma_f32_16x16x32_bf16 v[240:243], a[220:223], v[26:29], v[240:243]
    s_barrier
    ds_read_b128 a[212:215], v0 offset:0
    v_mfma_f32_16x16x32_bf16 a[32:35], a[220:223], v[32:35], a[32:35]
    s_add_u32 s21, s21, s62
    ds_read_b128 a[216:219], v1 offset:0
    s_add_u32 m0, s22, 24576
    v_mfma_f32_16x16x32_bf16 a[36:39], a[224:227], v[32:35], a[36:39]
    buffer_load_dwordx4 v6, s[8:11], s21 offen lds
    ds_read_b128 a[108:111], v105 offset:2048
    v_mfma_f32_16x16x32_bf16 v[244:247], a[224:227], v[26:29], v[244:247]
    s_add_u32 s21, s21, 128
    v_exp_f32 v63, v63
    v_mfma_f32_16x16x32_bf16 v[196:199], a[224:227], v[20:23], v[196:199]
    s_add_u32 m0, s22, 25600
    ds_read_b128 a[220:223], v0 offset:1024
    buffer_load_dwordx4 v6, s[8:11], s21 offen lds
    v_mfma_f32_16x16x32_bf16 v[148:151], a[224:227], v[14:17], v[148:151]
    s_add_u32 s21, s21, 128
    ds_read_b128 a[172:175], v105 offset:18432
    v_cvt_pk_bf16_f32 v30, v68, v69
    v_mfma_f32_16x16x32_bf16 v[152:155], a[228:231], v[14:17], v[152:155]
    s_add_u32 m0, s22, 26624
    ds_read_b128 a[100:103], v105 offset:0
    buffer_load_dwordx4 v6, s[8:11], s21 offen lds
    v_mfma_f32_16x16x32_bf16 v[200:203], a[228:231], v[20:23], v[200:203]
    s_add_u32 s21, s21, 12032
    ds_read_b128 a[156:159], v105 offset:14336
    v_fma_f32 v80, v80, s28, v12
    v_mfma_f32_16x16x32_bf16 v[248:251], a[228:231], v[26:29], v[248:251]
    s_waitcnt vmcnt(14)
    ds_read_b128 a[192:195], v104 offset:24576
    v_exp_f32 v79, v79
    v_mfma_f32_16x16x32_bf16 a[40:43], a[228:231], v[32:35], a[40:43]
    ds_read_b128 a[224:227], v1 offset:1024
    v_cvt_pk_bf16_f32 v36, v76, v77
    v_mfma_f32_16x16x32_bf16 a[44:47], a[232:235], v[32:35], a[44:47]
    v_exp_f32 v75, v75
    v_mfma_f32_16x16x32_bf16 v[252:255], a[232:235], v[26:29], v[252:255]
    s_waitcnt vmcnt(11)
    ds_read_b128 a[196:199], v105 offset:24576
    v_fma_f32 v56, v56, s28, v9
    v_mfma_f32_16x16x32_bf16 v[204:207], a[232:235], v[20:23], v[204:207]
    v_exp_f32 v56, v56
    v_mfma_f32_16x16x32_bf16 v[156:159], a[232:235], v[14:17], v[156:159]
    s_waitcnt lgkmcnt(6)
    ds_read_b128 a[228:231], v0 offset:6144
    v_cvt_pk_bf16_f32 v25, v62, v63
    v_mfma_f32_16x16x32_bf16 v[52:55], a[212:215], a[96:99], 0
    ds_read_b128 a[132:135], v105 offset:8192
    v_cvt_pk_bf16_f32 v37, v78, v79
    v_mfma_f32_16x16x32_bf16 v[60:63], a[212:215], a[120:123], 0
    ds_read_b128 a[180:183], v105 offset:20480
    v_fma_f32 v82, v82, s28, v12
    v_mfma_f32_16x16x32_bf16 v[68:71], a[212:215], a[144:147], 0
    v_exp_f32 v81, v81
    v_mfma_f32_16x16x32_bf16 v[76:79], a[212:215], a[168:171], 0
    ds_read_b128 a[200:203], v104 offset:26624
    s_waitcnt lgkmcnt(6)
    v_mfma_f32_16x16x32_bf16 v[84:87], a[212:215], a[192:195], 0
    v_exp_f32 v74, v74
    v_mfma_f32_16x16x32_bf16 v[52:55], a[216:219], a[100:103], v[52:55]
    ds_read_b128 a[204:207], v105 offset:26624
    v_fma_f32 v72, v72, s28, v11
    v_mfma_f32_16x16x32_bf16 v[60:63], a[216:219], a[124:127], v[60:63]
    v_exp_f32 v57, v57
    v_mfma_f32_16x16x32_bf16 v[68:71], a[216:219], a[148:151], v[68:71]
    v_exp_f32 v59, v59
    v_mfma_f32_16x16x32_bf16 v[76:79], a[216:219], a[172:175], v[76:79]
    s_waitcnt lgkmcnt(5)
    v_exp_f32 v72, v72
    v_mfma_f32_16x16x32_bf16 v[84:87], a[216:219], a[196:199], v[84:87]
    v_exp_f32 v58, v58
    v_mfma_f32_16x16x32_bf16 v[52:55], a[220:223], a[104:107], v[52:55]
    v_exp_f32 v64, v64
    v_mfma_f32_16x16x32_bf16 v[60:63], a[220:223], a[128:131], v[60:63]
    v_exp_f32 v65, v65
    v_mfma_f32_16x16x32_bf16 v[68:71], a[220:223], a[152:155], v[68:71]
    v_exp_f32 v66, v66
    v_mfma_f32_16x16x32_bf16 v[76:79], a[220:223], a[176:179], v[76:79]
    s_waitcnt lgkmcnt(1)
    v_exp_f32 v83, v83
    v_mfma_f32_16x16x32_bf16 v[84:87], a[220:223], a[200:203], v[84:87]
    ds_read_b128 a[232:235], v1 offset:6144
    v_cvt_pk_bf16_f32 v16, v56, v57
    v_mfma_f32_16x16x32_bf16 v[52:55], a[224:227], a[108:111], v[52:55]
    v_exp_f32 v73, v73
    v_mfma_f32_16x16x32_bf16 v[60:63], a[224:227], a[132:135], v[60:63]
    v_cvt_pk_bf16_f32 v22, v64, v65
    v_cvt_pk_bf16_f32 v28, v72, v73
    v_mfma_f32_16x16x32_bf16 v[68:71], a[224:227], a[156:159], v[68:71]
    ds_read_b128 a[212:215], v0 offset:7168
    v_cvt_pk_bf16_f32 v23, v66, v67
    v_mfma_f32_16x16x32_bf16 v[76:79], a[224:227], a[180:183], v[76:79]
    s_waitcnt lgkmcnt(2)
    v_exp_f32 v82, v82
    v_mfma_f32_16x16x32_bf16 v[84:87], a[224:227], a[204:207], v[84:87]
    ds_read_b128 a[216:219], v1 offset:7168
    v_cvt_pk_bf16_f32 v17, v58, v59
    v_mfma_f32_16x16x32_bf16 v[56:59], a[228:231], a[96:99], 0
    v_cvt_pk_bf16_f32 v35, v82, v83
    v_cvt_pk_bf16_f32 v29, v74, v75
    v_mfma_f32_16x16x32_bf16 v[64:67], a[228:231], a[120:123], 0
    v_exp_f32 v80, v80
    v_mfma_f32_16x16x32_bf16 v[72:75], a[228:231], a[144:147], 0
    ds_read_b128 a[116:119], v105 offset:4096
    v_cvt_pk_bf16_f32 v34, v80, v81
    v_mfma_f32_16x16x32_bf16 v[80:83], a[228:231], a[168:171], 0
    ds_read_b128 a[224:227], v1 offset:2048
    v_mfma_f32_16x16x32_bf16 v[88:91], a[228:231], a[192:195], 0
    s_waitcnt lgkmcnt(4)
    ds_read_b128 a[164:167], v105 offset:16384
    v_mfma_f32_16x16x32_bf16 v[56:59], a[232:235], a[100:103], v[56:59]
    v_mfma_f32_16x16x32_bf16 v[64:67], a[232:235], a[124:127], v[64:67]
    ds_read_b128 a[136:139], v104 offset:10240
    s_waitcnt vmcnt(8)
    v_mfma_f32_16x16x32_bf16 v[72:75], a[232:235], a[148:151], v[72:75]
    ds_read_b128 a[220:223], v0 offset:2048
    v_mfma_f32_16x16x32_bf16 v[80:83], a[232:235], a[172:175], v[80:83]
    ds_read_b128 a[228:231], v0 offset:8192
    v_mfma_f32_16x16x32_bf16 v[88:91], a[232:235], a[196:199], v[88:91]
    ds_read_b128 a[160:163], v104 offset:16384
    v_mfma_f32_16x16x32_bf16 v[48:51], a[236:239], v[16:19], v[44:47]
    ds_read_b128 a[232:235], v1 offset:8192
    v_mfma_f32_16x16x32_bf16 v[48:51], a[240:243], v[22:25], v[48:51]
    v_mfma_f32_16x16x32_bf16 v[48:51], a[244:247], v[28:31], v[48:51]
    s_waitcnt lgkmcnt(7)
    ds_read_b128 a[140:143], v105 offset:10240
    v_mfma_f32_16x16x32_bf16 v[56:59], a[212:215], a[104:107], v[56:59]
    v_mfma_f32_16x16x32_bf16 v[48:51], a[248:251], v[34:37], v[48:51]
    v_mfma_f32_16x16x32_bf16 v[64:67], a[212:215], a[128:131], v[64:67]
    v_mfma_f32_16x16x32_bf16 v[72:75], a[212:215], a[152:155], v[72:75]
    ds_read_b128 a[184:187], v104 offset:22528
    v_mfma_f32_16x16x32_bf16 v[80:83], a[212:215], a[176:179], v[80:83]
    v_mfma_f32_16x16x32_bf16 v[88:91], a[212:215], a[200:203], v[88:91]
    ds_read_b128 a[188:191], v105 offset:22528
    v_mfma_f32_16x16x32_bf16 v[56:59], a[216:219], a[108:111], v[56:59]
    s_waitcnt vmcnt(21)
    v_cmp_lt_f32 vcc, s29, v48
    v_mfma_f32_16x16x32_bf16 v[64:67], a[216:219], a[132:135], v[64:67]
    s_waitcnt vmcnt(18) lgkmcnt(3)
    v_mfma_f32_16x16x32_bf16 v[72:75], a[216:219], a[156:159], v[72:75]
    s_barrier
    v_mfma_f32_16x16x32_bf16 v[80:83], a[216:219], a[180:183], v[80:83]
    s_cbranch_vccnz L_rs_tr45b
L_ret_tr45b:
    s_add_u32 m0, s22, 0
    v_mfma_f32_16x16x32_bf16 v[88:91], a[216:219], a[204:207], v[88:91]
    buffer_load_dwordx4 v6, s[4:7], s20 offen lds
    v_mfma_f32_16x16x32_bf16 v[52:55], a[220:223], a[112:115], v[52:55]
    s_add_u32 s20, s20, 128
    s_add_u32 m0, s22, 1024
    v_mfma_f32_16x16x32_bf16 v[60:63], a[220:223], a[136:139], v[60:63]
    buffer_load_dwordx4 v6, s[4:7], s20 offen lds
    v_mfma_f32_16x16x32_bf16 v[68:71], a[220:223], a[160:163], v[68:71]
    s_waitcnt lgkmcnt(1)
    ds_read_b64_tr_b16 a[212:213], v2 offset:18432
    v_mfma_f32_16x16x32_bf16 v[76:79], a[220:223], a[184:187], v[76:79]
    s_add_u32 s20, s20, 128
    s_add_u32 m0, s22, 2048
    ds_read_b64_tr_b16 a[214:215], v2 offset:12288
    v_mfma_f32_16x16x32_bf16 v[84:87], a[220:223], a[208:211], v[84:87]
    buffer_load_dwordx4 v6, s[4:7], s20 offen lds
    v_mfma_f32_16x16x32_bf16 v[52:55], a[224:227], a[116:119], v[52:55]
    ds_read_b64_tr_b16 a[216:217], v3 offset:18432
    v_mfma_f32_16x16x32_bf16 v[60:63], a[224:227], a[140:143], v[60:63]
    v_mfma_f32_16x16x32_bf16 v[68:71], a[224:227], a[164:167], v[68:71]
    s_waitcnt lgkmcnt(3)
    ds_read_b64_tr_b16 a[218:219], v3 offset:12288
    v_mfma_f32_16x16x32_bf16 v[76:79], a[224:227], a[188:191], v[76:79]
    v_mfma_f32_16x16x32_bf16 v[84:87], a[224:227], v[92:95], v[84:87]
    v_mfma_f32_16x16x32_bf16 v[56:59], a[228:231], a[112:115], v[56:59]
    v_mfma_f32_16x16x32_bf16 v[64:67], a[228:231], a[136:139], v[64:67]
    ds_read_b64_tr_b16 a[220:221], v4 offset:18432
    v_mfma_f32_16x16x32_bf16 v[72:75], a[228:231], a[160:163], v[72:75]
    v_mfma_f32_16x16x32_bf16 v[80:83], a[228:231], a[184:187], v[80:83]
    ds_read_b64_tr_b16 a[222:223], v4 offset:12288
    s_add_u32 s20, s20, 12032
    v_mfma_f32_16x16x32_bf16 v[88:91], a[228:231], a[208:211], v[88:91]
    ds_read_b64_tr_b16 a[224:225], v5 offset:18432
    v_mfma_f32_16x16x32_bf16 v[56:59], a[232:235], a[116:119], v[56:59]
    ds_read_b64_tr_b16 a[226:227], v5 offset:12288
    v_mfma_f32_16x16x32_bf16 v[64:67], a[232:235], a[140:143], v[64:67]
    v_mfma_f32_16x16x32_bf16 v[72:75], a[232:235], a[164:167], v[72:75]
    v_mfma_f32_16x16x32_bf16 v[80:83], a[232:235], a[188:191], v[80:83]
    v_mfma_f32_16x16x32_bf16 v[88:91], a[232:235], v[92:95], v[88:91]
    v_max3_f32 v96, v52, v53, v54
    s_nop 1
    v_max3_f32 v96, v96, v55, v56
    v_max3_f32 v96, v96, v57, v58
    v_max_f32 v96, v96, v59
    v_mov_b32 v97, v96
    s_waitcnt lgkmcnt(6)
    v_mfma_f32_16x16x32_bf16 v[112:115], a[212:215], v[16:19], v[112:115]
    s_mov_b32 s67, s34
    ds_read_b64_tr_b16 a[234:235], v3 offset:13312
    v_permlane32_swap_b32 v97, v96
    v_max_f32 v96, v96, v97
    v_mov_b32 v97, v96
    v_mfma_f32_16x16x32_bf16 v[160:163], a[212:215], v[22:25], v[160:163]
    s_nop 0
    v_permlane16_swap_b32 v97, v96
    v_max_f32 v96, v96, v97
    v_mfma_f32_16x16x32_bf16 v[208:211], a[212:215], v[28:31], v[208:211]
    s_add_u32 s18, s34, 24576
    v_mul_f32_e64 v9, -s28, v96
    v_max3_f32 v96, v60, v61, v62
    v_max3_f32 v96, v96, v63, v64
    v_max3_f32 v96, v96, v65, v66
    v_max_f32 v96, v96, v67
    v_fma_f32 v59, v59, s28, v9
    v_mfma_f32_16x16x32_bf16 a[0:3], a[212:215], v[34:37], a[0:3]
    s_waitcnt lgkmcnt(5)
    ds_read_b64_tr_b16 a[230:231], v2 offset:13312
    v_mov_b32 v97, v96
    v_mfma_f32_16x16x32_bf16 a[4:7], a[216:219], v[34:37], a[4:7]
    s_mov_b32 s34, s33
    v_permlane32_swap_b32 v97, v96
    v_max_f32 v96, v96, v97
    v_mov_b32 v97, v96
    v_mfma_f32_16x16x32_bf16 v[212:215], a[216:219], v[28:31], v[212:215]
    s_add_u32 s64, s64, s62
    v_permlane16_swap_b32 v97, v96
    v_max_f32 v96, v96, v97
    v_mul_f32_e64 v10, -s28, v96
    v_max3_f32 v96, v68, v69, v70
    v_mfma_f32_16x16x32_bf16 v[164:167], a[216:219], v[22:25], v[164:167]
    s_add_u32 s64, s64, 196608
    v_accvgpr_read_b32 v108, a4
    v_fma_f32 v60, v60, s28, v10
    v_max3_f32 v96, v96, v71, v72
    v_mfma_f32_16x16x32_bf16 v[116:119], a[216:219], v[16:19], v[116:119]
    s_waitcnt lgkmcnt(1)
    ds_read_b64_tr_b16 a[232:233], v3 offset:19456
    v_max3_f32 v96, v96, v73, v74
    v_mfma_f32_16x16x32_bf16 v[120:123], a[220:223], v[16:19], v[120:123]
    s_mov_b32 s39, s64
    ds_read_b64_tr_b16 a[228:229], v2 offset:19456
    v_mbcnt_lo_u32_b32 v104, -1, 0
    v_max_f32 v96, v96, v75
    v_rcp_f32 v50, v50
    v_mfma_f32_16x16x32_bf16 v[168:171], a[220:223], v[22:25], v[168:171]
    s_add_u32 s37, s37, 1
    ds_read_b64_tr_b16 a[212:213], v4 offset:19456
    v_mov_b32 v97, v96
    v_mfma_f32_16x16x32_bf16 v[216:219], a[220:223], v[28:31], v[216:219]
    s_bitcmp1_b32 s63, s37
    v_mbcnt_hi_u32_b32 v104, -1, v104
    v_fma_f32 v63, v63, s28, v10
    v_permlane32_swap_b32 v97, v96
    v_mfma_f32_16x16x32_bf16 a[8:11], a[220:223], v[34:37], a[8:11]
    s_cselect_b32 s62, 4294770688, 0
    v_max_f32 v96, v96, v97
    v_fma_f32 v54, v54, s28, v9
    v_mov_b32 v97, v96
    v_rcp_f32 v51, v51
    v_mfma_f32_16x16x32_bf16 a[12:15], a[224:227], v[34:37], a[12:15]
    s_cselect_b32 s42, 0, 325632
    ds_read_b64_tr_b16 a[218:219], v5 offset:13312
    v_permlane16_swap_b32 v97, v96
    v_max_f32 v96, v96, v97
    v_fma_f32 v67, v67, s28, v10
    v_mul_f32_e64 v11, -s28, v96
    v_rcp_f32 v49, v49
    v_max3_f32 v96, v76, v77, v78
    v_fma_f32 v56, v56, s28, v9
    v_max3_f32 v96, v96, v79, v80
    v_max3_f32 v96, v96, v81, v82
    v_mfma_f32_16x16x32_bf16 v[220:223], a[224:227], v[28:31], v[220:223]
    s_add_u32 s35, s35, s42
    ds_read_b64_tr_b16 a[216:217], v5 offset:19456
    v_accvgpr_read_b32 v109, a5
    v_fma_f32 v58, v58, s28, v9
    v_fma_f32 v53, v53, s28, v9
    v_fma_f32 v68, v68, s28, v11
    v_mfma_f32_16x16x32_bf16 v[172:175], a[224:227], v[22:25], v[172:175]
    s_lshl_b32 s42, s37, 1
    ds_read_b64_tr_b16 a[222:223], v2 offset:14336
    v_max_f32 v96, v96, v83
    v_mfma_f32_16x16x32_bf16 v[124:127], a[224:227], v[16:19], v[124:127]
    s_waitcnt lgkmcnt(3)
    ds_read_b64_tr_b16 a[220:221], v2 offset:20480
    v_mul_f32 v168, v168, v49
    v_mfma_f32_16x16x32_bf16 v[128:131], a[228:231], v[16:19], v[128:131]
    s_lshr_b32 s42, s31, s42
    ds_read_b64_tr_b16 a[214:215], v4 offset:13312
    v_fma_f32 v70, v70, s28, v11
    v_mul_f32 v108, v108, v51
    v_mfma_f32_16x16x32_bf16 v[176:179], a[228:231], v[22:25], v[176:179]
    s_and_b32 s42, s42, 3
    v_mov_b32 v97, v96
    v_fma_f32 v61, v61, s28, v10
    v_fma_f32 v64, v64, s28, v10
    v_permlane32_swap_b32 v97, v96
    v_max_f32 v96, v96, v97
    v_mov_b32 v97, v96
    v_mul_f32 v169, v169, v49
    v_mfma_f32_16x16x32_bf16 v[224:227], a[228:231], v[28:31], v[224:227]
    s_add_u32 s42, s42, s36
    v_permlane16_swap_b32 v97, v96
    v_max_f32 v96, v96, v97
    v_mul_f32_e64 v12, -s28, v96
    v_mfma_f32_16x16x32_bf16 a[16:19], a[228:231], v[34:37], a[16:19]
    s_sub_u32 s43, s42, 3
    ds_read_b64_tr_b16 a[224:225], v3 offset:20480
    v_fma_f32 v74, v74, s28, v11
    v_fma_f32 v71, v71, s28, v11
    v_max3_f32 v96, v84, v85, v86
    v_mfma_f32_16x16x32_bf16 a[20:23], a[232:235], v[34:37], a[20:23]
    s_cmp_ge_u32 s42, 3
    v_accvgpr_read_b32 v110, a6
    v_fma_f32 v82, v82, s28, v12
    v_mul_f32 v164, v164, v49
    v_mfma_f32_16x16x32_bf16 v[228:231], a[232:235], v[28:31], v[228:231]
    s_cselect_b32 s42, s43, s42
    v_max3_f32 v96, v96, v87, v88
    v_fma_f32 v77, v77, s28, v12
    v_mfma_f32_16x16x32_bf16 v[180:183], a[232:235], v[22:25], v[180:183]
    s_mul_i32 s44, s3, 5
    ds_read_b64_tr_b16 a[230:231], v4 offset:14336
    v_fma_f32 v75, v75, s28, v11
    v_fma_f32 v72, v72, s28, v11
    v_mul_f32 v163, v163, v49
    v_max3_f32 v96, v96, v89, v90
    v_lshrrev_b32 v106, 5, v104
    v_mfma_f32_16x16x32_bf16 v[132:135], a[232:235], v[16:19], v[132:135]
    s_waitcnt lgkmcnt(2)
    v_exp_f32 v59, v59
    v_fma_f32 v62, v62, s28, v10
    v_mfma_f32_16x16x32_bf16 v[136:139], a[212:215], v[16:19], v[136:139]
    s_mov_b32 s32, 1
    ds_read_b64_tr_b16 a[228:229], v4 offset:20480
    v_exp_f32 v82, v82
    v_mfma_f32_16x16x32_bf16 v[184:187], a[212:215], v[22:25], v[184:187]
    s_lshl_b32 s43, s3, 2
    ds_read_b64_tr_b16 a[226:227], v3 offset:14336
    v_fma_f32 v69, v69, s28, v11
    v_bfe_u32 v105, v104, 3, 1
    v_and_b32 v107, 3, v104
    v_mfma_f32_16x16x32_bf16 v[232:235], a[212:215], v[28:31], v[232:235]
    s_add_u32 s45, s43, 21
    v_exp_f32 v61, v61
    v_fma_f32 v80, v80, s28, v12
    v_max_f32 v96, v96, v91
    v_mul_f32 v170, v170, v49
    v_mov_b32 v97, v96
    v_exp_f32 v72, v72
    v_mfma_f32_16x16x32_bf16 a[24:27], a[212:215], v[34:37], a[24:27]
    s_cmp_eq_u32 s3, 0
    v_exp_f32 v69, v69
    v_permlane32_swap_b32 v97, v96
    v_mfma_f32_16x16x32_bf16 a[28:31], a[216:219], v[34:37], a[28:31]
    s_cselect_b32 s45, 20, s45
    v_fma_f32 v55, v55, s28, v9
    v_fma_f32 v78, v78, s28, v12
    v_max_f32 v96, v96, v97
    v_exp_f32 v60, v60
    v_fma_f32 v52, v52, s28, v9
    v_mfma_f32_16x16x32_bf16 v[236:239], a[216:219], v[28:31], v[236:239]
    s_cselect_b32 s33, 1, 0
    ds_read_b64_tr_b16 a[232:233], v5 offset:20480
    v_xor_b32 v106, v106, v105
    v_mfma_f32_16x16x32_bf16 v[188:191], a[216:219], v[22:25], v[188:191]
    s_cmp_eq_u32 s42, 1
    v_exp_f32 v54, v54
    v_mfma_f32_16x16x32_bf16 v[140:143], a[216:219], v[16:19], v[140:143]
    s_cselect_b32 s44, s45, s44
    v_fma_f32 v76, v76, s28, v12
    v_mov_b32 v97, v96
    v_mfma_f32_16x16x32_bf16 v[144:147], a[220:223], v[16:19], v[144:147]
    s_cselect_b32 s32, s33, s32
    v_mul_f32 v177, v177, v49
    s_add_u32 s45, s43, 37
    v_accvgpr_read_b32 v111, a7
    v_mfma_f32_16x16x32_bf16 v[192:195], a[220:223], v[22:25], v[192:195]
    s_cmp_eq_u32 s42, 2
    v_mul_f32 v162, v162, v49
    v_exp_f32 v68, v68
    v_mfma_f32_16x16x32_bf16 v[240:243], a[220:223], v[28:31], v[240:243]
    s_cselect_b32 s44, s45, s44
    ds_read_b64_tr_b16 a[234:235], v5 offset:14336
    v_exp_f32 v55, v55
    v_mfma_f32_16x16x32_bf16 a[32:35], a[220:223], v[34:37], a[32:35]
    s_waitcnt lgkmcnt(2)
    v_exp_f32 v71, v71
    v_exp_f32 v52, v52
    v_mfma_f32_16x16x32_bf16 a[36:39], a[224:227], v[34:37], a[36:39]
    s_cselect_b32 s32, 0, s32
    s_mul_i32 s44, s44, 6144
    v_exp_f32 v53, v53
    v_fma_f32 v57, v57, s28, v9
    v_lshl_or_b32 v106, v107, 1, v106
    v_mfma_f32_16x16x32_bf16 v[244:247], a[224:227], v[28:31], v[244:247]
    s_add_u32 s33, s35, s44
    v_mov_b32 v100, v48
    s_mul_i32 s42, s32, 6144
    v_fma_f32 v73, v73, s28, v11
    v_mfma_f32_16x16x32_bf16 v[196:199], a[224:227], v[22:25], v[196:199]
    s_add_u32 s42, s42, 24576
    v_permlane16_swap_b32 v97, v96
    s_add_u32 s42, s42, s33
    v_exp_f32 v77, v77
    v_mfma_f32_16x16x32_bf16 v[148:151], a[224:227], v[16:19], v[148:151]
    s_cmp_ge_u32 s37, 6
    v_exp_f32 v58, v58
    v_max_f32 v96, v96, v97
    v_cvt_pk_bf16_f32 v20, v60, v61
    v_mfma_f32_16x16x32_bf16 v[152:155], a[228:231], v[16:19], v[152:155]
    s_cselect_b32 s14, 0, s42
    v_exp_f32 v62, v62
    s_add_u32 s24, s67, 256
    s_add_u32 s25, s33, 256
    v_exp_f32 v76, v76
    v_mfma_f32_16x16x32_bf16 v[200:203], a[228:231], v[22:25], v[200:203]
    s_add_u32 s23, s38, 4096
    s_mov_b32 s27, 0x49249249
    v_fma_f32 v79, v79, s28, v12
    v_mfma_f32_16x16x32_bf16 v[248:251], a[228:231], v[28:31], v[248:251]
    s_mov_b32 s30, 0
    v_exp_f32 v64, v64
    v_mfma_f32_16x16x32_bf16 a[40:43], a[228:231], v[34:37], a[40:43]
    s_waitcnt vmcnt(7) lgkmcnt(0)
    s_barrier
    ds_read_b128 a[216:219], v1 offset:12288
    v_permlane32_swap_b32 v48, v100
    v_xor_b32 v105, s65, v105
    v_mfma_f32_16x16x32_bf16 a[44:47], a[232:235], v[34:37], a[44:47]
    s_add_u32 m0, s22, 36864
    ds_read_b128 a[212:215], v0 offset:12288
    v_cvt_pk_bf16_f32 v15, v54, v55
    v_cvt_pk_bf16_f32 v26, v68, v69
    v_mul_f32_e64 v13, -s28, v96
    v_fma_f32 v86, v86, s28, v13
    v_fma_f32 v90, v90, s28, v13
    v_lshl_add_u32 v101, v105, 10, s38
    v_mfma_f32_16x16x32_bf16 v[252:255], a[232:235], v[28:31], v[252:255]
    ds_read_b128 a[220:223], v0 offset:13312
    v_exp_f32 v79, v79
    v_mul_f32 v195, v195, v49
    v_mul_f32 v188, v188, v49
    v_cvt_pk_bf16_f32 v32, v76, v77
    v_mfma_f32_16x16x32_bf16 v[204:207], a[232:235], v[22:25], v[204:207]
    v_mul_f32 v109, v109, v51
    v_exp_f32 v78, v78
    v_lshl_add_u32 v101, v106, 4, v101
    v_mul_f32 v192, v192, v49
    v_and_b32 v107, 7, v104
    v_mul_f32 v160, v160, v49
    v_cvt_pk_bf16_f32 v33, v78, v79
    v_mul_f32 v185, v185, v49
    v_fma_f32 v87, v87, s28, v13
    v_fma_f32 v84, v84, s28, v13
    v_fma_f32 v85, v85, s28, v13
    v_exp_f32 v63, v63
    v_pk_mul_f32 v[210:211], v[210:211], v[50:51] op_sel_hi:[1,0]
    v_exp_f32 v70, v70
    v_fma_f32 v65, v65, s28, v10
    v_cvt_pk_bf16_f32 v21, v62, v63
    v_cvt_pk_bf16_f32 v27, v70, v71
    v_mul_f32 v200, v200, v49
    v_fma_f32 v91, v91, s28, v13
    v_cvt_pk_bf16_f32 v14, v52, v53
    v_mul_f32 v183, v183, v49
    v_mfma_f32_16x16x32_bf16 v[156:159], a[232:235], v[16:19], v[156:159]
    s_waitcnt lgkmcnt(1)
    v_exp_f32 v57, v57
    v_mfma_f32_16x16x32_bf16 v[52:55], a[212:215], a[96:99], 0
    v_exp_f32 v67, v67
    v_mfma_f32_16x16x32_bf16 v[52:55], a[216:219], a[100:103], v[52:55]
    s_waitcnt lgkmcnt(0)
    v_exp_f32 v87, v87
    v_lshl_add_u32 v101, v107, 7, v101
    v_mfma_f32_16x16x32_bf16 v[52:55], a[220:223], a[104:107], v[52:55]
    buffer_load_dwordx4 v6, s[8:11], s21 offen lds
    ds_read_b128 a[232:235], v1 offset:14336
    v_mfma_f32_16x16x32_bf16 v[60:63], a[220:223], a[128:131], 0
    v_exp_f32 v85, v85
    v_mul_f32 v176, v176, v49
    v_mfma_f32_16x16x32_bf16 v[60:63], a[216:219], a[124:127], v[60:63]
    ds_read_b128 a[228:231], v0 offset:14336
    v_mul_f32 v207, v207, v49
    v_bfe_u32 v107, v104, 4, 1
    v_mfma_f32_16x16x32_bf16 v[60:63], a[212:215], a[120:123], v[60:63]
    ds_read_b128 a[224:227], v1 offset:13312
    v_fma_f32 v81, v81, s28, v12
    v_fma_f32 v89, v89, s28, v13
    v_mfma_f32_16x16x32_bf16 v[68:71], a[212:215], a[144:147], 0
    v_mul_f32 v198, v198, v49
    v_mul_f32 v187, v187, v49
    v_mfma_f32_16x16x32_bf16 v[68:71], a[216:219], a[148:151], v[68:71]
    v_exp_f32 v84, v84
    v_mfma_f32_16x16x32_bf16 v[68:71], a[220:223], a[152:155], v[68:71]
    s_add_u32 s21, s21, 128
    v_exp_f32 v86, v86
    v_mfma_f32_16x16x32_bf16 v[76:79], a[220:223], a[176:179], 0
    v_cvt_pk_bf16_f32 v38, v84, v85
    v_rcp_f32 v48, v48
    v_mfma_f32_16x16x32_bf16 v[76:79], a[216:219], a[172:175], v[76:79]
    v_cvt_pk_bf16_f32 v39, v86, v87
    v_mul_f32 v165, v165, v49
    v_mfma_f32_16x16x32_bf16 v[76:79], a[212:215], a[168:171], v[76:79]
    v_lshl_add_u32 v101, v107, 3, v101
    v_accvgpr_read_b32 v104, a0
    v_mfma_f32_16x16x32_bf16 v[84:87], a[212:215], a[192:195], 0
    v_fma_f32 v66, v66, s28, v10
    v_cvt_pk_bf16_f32 v164, v164, v165
    v_mfma_f32_16x16x32_bf16 v[84:87], a[216:219], a[196:199], v[84:87]
    v_mul_f32 v191, v191, v49
    v_exp_f32 v65, v65
    v_mfma_f32_16x16x32_bf16 v[84:87], a[220:223], a[200:203], v[84:87]
    s_waitcnt lgkmcnt(0)
    v_exp_f32 v90, v90
    v_mfma_f32_16x16x32_bf16 v[84:87], a[224:227], a[204:207], v[84:87]
    v_mul_f32 v206, v206, v49
    v_cvt_pk_bf16_f32 v17, v58, v59
    v_mfma_f32_16x16x32_bf16 v[84:87], a[228:231], a[208:211], v[84:87]
    s_add_u32 m0, s22, 37888
    ds_read_b128 a[220:223], v0 offset:19456
    v_exp_f32 v80, v80
    v_mfma_f32_16x16x32_bf16 v[84:87], a[232:235], v[92:95], v[84:87]
    v_exp_f32 v74, v74
    v_mul_f32 v186, v186, v49
    v_accvgpr_read_b32 v106, a2
    v_mfma_f32_16x16x32_bf16 v[76:79], a[232:235], a[188:191], v[76:79]
    v_mul_f32 v161, v161, v49
    v_mul_f32 v181, v181, v49
    v_accvgpr_read_b32 v105, a1
    v_mfma_f32_16x16x32_bf16 v[76:79], a[228:231], a[184:187], v[76:79]
    v_exp_f32 v73, v73
    v_mfma_f32_16x16x32_bf16 v[76:79], a[224:227], a[180:183], v[76:79]
    v_exp_f32 v56, v56
    v_exp_f32 v75, v75
    v_mfma_f32_16x16x32_bf16 v[68:71], a[224:227], a[156:159], v[68:71]
    ds_read_b128 a[212:215], v0 offset:18432
    buffer_load_dwordx4 v6, s[8:11], s21 offen lds
    v_mfma_f32_16x16x32_bf16 v[68:71], a[228:231], a[160:163], v[68:71]
    v_exp_f32 v66, v66
    v_mfma_f32_16x16x32_bf16 v[68:71], a[232:235], a[164:167], v[68:71]
    v_exp_f32 v89, v89
    v_mfma_f32_16x16x32_bf16 v[60:63], a[232:235], a[140:143], v[60:63]
    s_add_u32 s21, s21, 128
    ds_read_b128 a[216:219], v1 offset:18432
    v_mul_f32 v106, v106, v51
    v_mfma_f32_16x16x32_bf16 v[60:63], a[228:231], a[136:139], v[60:63]
    v_exp_f32 v91, v91
    v_mul_f32 v105, v105, v51
    v_mfma_f32_16x16x32_bf16 v[60:63], a[224:227], a[132:135], v[60:63]
    v_fma_f32 v88, v88, s28, v13
    v_mul_f32 v111, v111, v51
    v_mfma_f32_16x16x32_bf16 v[52:55], a[224:227], a[108:111], v[52:55]
    s_add_u32 m0, s22, 38912
    v_fma_f32 v69, v69, s28, v11
    v_fma_f32 v78, v78, s28, v12
    v_mfma_f32_16x16x32_bf16 v[52:55], a[228:231], a[112:115], v[52:55]
    ds_read_b128 a[224:227], v1 offset:19456
    buffer_load_dwordx4 v6, s[8:11], s21 offen lds
    v_cvt_pk_bf16_f32 v168, v168, v169
    v_cvt_pk_bf16_f32 v16, v56, v57
    v_pk_mul_f32 v[222:223], v[222:223], v[50:51] op_sel_hi:[1,0]
    v_pk_mul_f32 v[118:119], v[118:119], v[48:49] op_sel_hi:[1,0]
    v_cvt_pk_bf16_f32 v160, v160, v161
    v_pk_mul_f32 v[214:215], v[214:215], v[50:51] op_sel_hi:[1,0]
    v_pk_mul_f32 v[208:209], v[208:209], v[50:51] op_sel_hi:[1,0]
    v_pk_mul_f32 v[116:117], v[116:117], v[48:49] op_sel_hi:[1,0]
    v_fma_f32 v85, v85, s28, v13
    v_pk_mul_f32 v[120:121], v[120:121], v[48:49] op_sel_hi:[1,0]
    v_mul_f32 v179, v179, v49
    v_pk_mul_f32 v[114:115], v[114:115], v[48:49] op_sel_hi:[1,0]
    v_pk_mul_f32 v[126:127], v[126:127], v[48:49] op_sel_hi:[1,0]
    v_pk_mul_f32 v[112:113], v[112:113], v[48:49] op_sel_hi:[1,0]
    v_pk_mul_f32 v[216:217], v[216:217], v[50:51] op_sel_hi:[1,0]
    v_cvt_pk_bf16_f32 v112, v112, v113
    v_cvt_pk_bf16_f32 v23, v66, v67
    v_mfma_f32_16x16x32_bf16 v[52:55], a[232:235], a[116:119], v[52:55]
    s_waitcnt lgkmcnt(1)
    v_fma_f32 v68, v68, s28, v11
    v_cvt_pk_bf16_f32 v208, v208, v209
    v_mfma_f32_16x16x32_bf16 v[56:59], a[212:215], a[96:99], 0
    v_cvt_pk_bf16_f32 v29, v74, v75
    v_fma_f32 v83, v83, s28, v12
    v_cvt_pk_bf16_f32 v22, v64, v65
    v_exp_f32 v81, v81
    v_mfma_f32_16x16x32_bf16 v[56:59], a[216:219], a[100:103], v[56:59]
    ds_read_b128 a[232:235], v1 offset:20480
    v_cvt_pk_bf16_f32 v28, v72, v73
    v_mul_f32 v180, v180, v49
    v_cvt_pk_bf16_f32 v209, v210, v211
    v_subrev_u32 v8, 22528, v8
    v_pk_mul_f32 v[212:213], v[212:213], v[50:51] op_sel_hi:[1,0]
    v_cvt_pk_bf16_f32 v34, v80, v81
    v_pk_mul_f32 v[124:125], v[124:125], v[48:49] op_sel_hi:[1,0]
    v_accvgpr_read_b32 v107, a3
    v_cvt_pk_bf16_f32 v212, v212, v213
    v_mfma_f32_16x16x32_bf16 v[56:59], a[220:223], a[104:107], v[56:59]
    s_add_u32 s21, s21, 12032
    v_mul_f32 v104, v104, v51
    v_mul_f32 v173, v173, v49
    v_exp_f32 v83, v83
    v_exp_f32 v88, v88
    v_mfma_f32_16x16x32_bf16 v[44:47], a[236:239], v[14:17], 0
    ds_read_b128 a[228:231], v0 offset:20480
    v_mul_f32 v171, v171, v49
    v_mfma_f32_16x16x32_bf16 v[64:67], a[220:223], a[128:131], 0
    v_mul_f32 v172, v172, v49
    v_fma_f32 v70, v70, s28, v11
    v_mul_f32 v167, v167, v49
    v_mfma_f32_16x16x32_bf16 v[64:67], a[216:219], a[124:127], v[64:67]
    v_cvt_pk_bf16_f32 v108, v108, v109
    v_cvt_pk_bf16_f32 v161, v162, v163
    v_cvt_pk_bf16_f32 v41, v90, v91
    v_fma_f32 v54, v54, s28, v9
    v_mfma_f32_16x16x32_bf16 v[44:47], a[240:243], v[20:23], v[44:47]
    v_mul_f32 v107, v107, v51
    v_fma_f32 v84, v84, s28, v13
    v_mfma_f32_16x16x32_bf16 v[64:67], a[212:215], a[120:123], v[64:67]
    v_mul_f32 v182, v182, v49
    v_cvt_pk_bf16_f32 v113, v114, v115
    v_mfma_f32_16x16x32_bf16 v[72:75], a[212:215], a[144:147], 0
    v_fma_f32 v86, v86, s28, v13
    v_cvt_pk_bf16_f32 v35, v82, v83
    v_cvt_pk_bf16_f32 v116, v116, v117
    v_mfma_f32_16x16x32_bf16 v[72:75], a[216:219], a[148:151], v[72:75]
    ds_write2st64_b64 v101, v[112:113], v[160:161] offset0:0 offset1:12
    v_mul_f32 v205, v205, v49
    v_mfma_f32_16x16x32_bf16 v[72:75], a[220:223], a[152:155], v[72:75]
    v_fma_f32 v61, v61, s28, v10
    v_mul_f32 v110, v110, v51
    v_mfma_f32_16x16x32_bf16 v[80:83], a[220:223], a[176:179], 0
    s_waitcnt vmcnt(6) lgkmcnt(1)
    v_cvt_pk_bf16_f32 v104, v104, v105
    v_mul_f32 v201, v201, v49
    v_mfma_f32_16x16x32_bf16 v[80:83], a[216:219], a[172:175], v[80:83]
    s_add_u32 m0, s22, 12288
    v_cvt_pk_bf16_f32 v40, v88, v89
    v_mul_f32 v189, v189, v49
    v_mfma_f32_16x16x32_bf16 v[80:83], a[212:215], a[168:171], v[80:83]
    s_barrier
    v_cvt_pk_bf16_f32 v216, v216, v217
    v_mfma_f32_16x16x32_bf16 v[88:91], a[212:215], a[192:195], 0
    buffer_load_dwordx4 v6, s[4:7], s20 offen lds
    ds_read_b64_tr_b16 a[212:213], v2 offset:0
    v_mul_f32 v204, v204, v49
    v_mfma_f32_16x16x32_bf16 v[44:47], a[244:247], v[26:29], v[44:47]
    v_fma_f32 v76, v76, s28, v12
    v_exp_f32 v68, v68
    v_mfma_f32_16x16x32_bf16 v[88:91], a[216:219], a[196:199], v[88:91]
    s_add_u32 s20, s20, 128
    v_mul_f32 v203, v203, v49
    v_cvt_pk_bf16_f32 v176, v176, v177
    v_cvt_pk_bf16_f32 v105, v106, v107
    v_fma_f32 v55, v55, s28, v9
    v_mul_f32 v166, v166, v49
    v_cvt_pk_bf16_f32 v172, v172, v173
    v_pk_mul_f32 v[148:149], v[148:149], v[48:49] op_sel_hi:[1,0]
    v_cvt_pk_bf16_f32 v109, v110, v111
    v_pk_mul_f32 v[220:221], v[220:221], v[50:51] op_sel_hi:[1,0]
    v_fma_f32 v52, v52, s28, v9
    v_accvgpr_read_b32 v106, a10
    v_cvt_pk_bf16_f32 v180, v180, v181
    v_mfma_f32_16x16x32_bf16 v[88:91], a[220:223], a[200:203], v[88:91]
    ds_read_b64_tr_b16 a[214:215], v2 offset:6144
    v_mul_f32 v175, v175, v49
    v_mfma_f32_16x16x32_bf16 v[88:91], a[224:227], a[204:207], v[88:91]
    v_cvt_pk_bf16_f32 v117, v118, v119
    v_cvt_pk_bf16_f32 v169, v170, v171
    v_mfma_f32_16x16x32_bf16 v[88:91], a[228:231], a[208:211], v[88:91]
    v_exp_f32 v69, v69
    v_mfma_f32_16x16x32_bf16 v[88:91], a[232:235], v[92:95], v[88:91]
    s_add_u32 m0, s22, 13312
    ds_read_b64_tr_b16 a[216:217], v3 offset:0
    v_exp_f32 v61, v61
    v_mfma_f32_16x16x32_bf16 v[80:83], a[232:235], a[188:191], v[80:83]
    ds_read_b64_tr_b16 a[218:219], v3 offset:6144
    v_cvt_pk_bf16_f32 v148, v148, v149
    v_mfma_f32_16x16x32_bf16 v[80:83], a[228:231], a[184:187], v[80:83]
    ds_write2st64_b64 v101, v[208:209], v[104:105] offset0:24 offset1:36
    v_mul_f32 v174, v174, v49
    v_pk_mul_f32 v[218:219], v[218:219], v[50:51] op_sel_hi:[1,0]
    v_pk_mul_f32 v[238:239], v[238:239], v[50:51] op_sel_hi:[1,0]
    v_accvgpr_read_b32 v111, a15
    v_pk_mul_f32 v[146:147], v[146:147], v[48:49] op_sel_hi:[1,0]
    v_pk_mul_f32 v[134:135], v[134:135], v[48:49] op_sel_hi:[1,0]
    v_pk_mul_f32 v[122:123], v[122:123], v[48:49] op_sel_hi:[1,0]
    v_pk_mul_f32 v[144:145], v[144:145], v[48:49] op_sel_hi:[1,0]
    v_pk_mul_f32 v[132:133], v[132:133], v[48:49] op_sel_hi:[1,0]
    v_pk_mul_f32 v[128:129], v[128:129], v[48:49] op_sel_hi:[1,0]
    v_mul_f32 v197, v197, v49
    v_pk_mul_f32 v[224:225], v[224:225], v[50:51] op_sel_hi:[1,0]
    v_pk_mul_f32 v[138:139], v[138:139], v[48:49] op_sel_hi:[1,0]
    v_mul_f32 v193, v193, v49
    v_pk_mul_f32 v[226:227], v[226:227], v[50:51] op_sel_hi:[1,0]
    v_mul_f32 v111, v111, v51
    v_xor_b32 v101, 32, v101
    v_mfma_f32_16x16x32_bf16 v[80:83], a[224:227], a[180:183], v[80:83]
    ds_read_b64_tr_b16 a[220:221], v4 offset:0
    v_cvt_pk_bf16_f32 v165, v166, v167
    v_mfma_f32_16x16x32_bf16 v[72:75], a[224:227], a[156:159], v[72:75]
    v_accvgpr_read_b32 v105, a9
    v_cvt_pk_bf16_f32 v173, v174, v175
    v_mfma_f32_16x16x32_bf16 v[72:75], a[228:231], a[160:163], v[72:75]
    v_fma_f32 v91, v91, s28, v13
    v_fma_f32 v79, v79, s28, v12
    v_fma_f32 v53, v53, s28, v9
    v_mfma_f32_16x16x32_bf16 v[72:75], a[232:235], a[164:167], v[72:75]
    ds_write2st64_b64 v101, v[116:117], v[164:165] offset0:0 offset1:12
    v_mul_f32 v196, v196, v49
    v_pk_mul_f32 v[152:153], v[152:153], v[48:49] op_sel_hi:[1,0]
    v_pk_mul_f32 v[130:131], v[130:131], v[48:49] op_sel_hi:[1,0]
    v_pk_mul_f32 v[246:247], v[246:247], v[50:51] op_sel_hi:[1,0]
    v_fma_f32 v60, v60, s28, v10
    v_cvt_pk_bf16_f32 v213, v214, v215
    v_mfma_f32_16x16x32_bf16 v[64:67], a[232:235], a[140:143], v[64:67]
    ds_write2st64_b64 v101, v[212:213], v[108:109] offset0:24 offset1:36
    v_mfma_f32_16x16x32_bf16 v[64:67], a[228:231], a[136:139], v[64:67]
    v_cvt_pk_bf16_f32 v144, v144, v145
    v_cvt_pk_bf16_f32 v120, v120, v121
    v_mfma_f32_16x16x32_bf16 v[64:67], a[224:227], a[132:135], v[64:67]
    buffer_load_dwordx4 v6, s[4:7], s20 offen lds
    v_mfma_f32_16x16x32_bf16 v[56:59], a[224:227], a[108:111], v[56:59]
    ds_read_b64_tr_b16 a[222:223], v4 offset:6144
    v_exp_f32 v54, v54
    v_cvt_pk_bf16_f32 v128, v128, v129
    v_mul_f32 v106, v106, v51
    v_pk_mul_f32 v[228:229], v[228:229], v[50:51] op_sel_hi:[1,0]
    v_cvt_pk_bf16_f32 v30, v68, v69
    v_pk_mul_f32 v[236:237], v[236:237], v[50:51] op_sel_hi:[1,0]
    v_fma_f32 v62, v62, s28, v10
    v_pk_mul_f32 v[140:141], v[140:141], v[48:49] op_sel_hi:[1,0]
    v_cvt_pk_bf16_f32 v132, v132, v133
    v_pk_mul_f32 v[156:157], v[156:157], v[48:49] op_sel_hi:[1,0]
    v_pk_mul_f32 v[234:235], v[234:235], v[50:51] op_sel_hi:[1,0]
    v_pk_mul_f32 v[240:241], v[240:241], v[50:51] op_sel_hi:[1,0]
    v_accvgpr_read_b32 v107, a11
    v_pk_mul_f32 v[242:243], v[242:243], v[50:51] op_sel_hi:[1,0]
    v_accvgpr_read_b32 v104, a8
    v_fma_f32 v71, v71, s28, v11
    v_exp_f32 v52, v52
    v_mfma_f32_16x16x32_bf16 v[56:59], a[228:231], a[112:115], v[56:59]
    v_accvgpr_read_b32 v109, a13
    v_fma_f32 v64, v64, s28, v10
    v_cvt_pk_bf16_f32 v220, v220, v221
    v_mul_f32 v178, v178, v49
    v_mul_f32 v199, v199, v49
    v_cvt_pk_bf16_f32 v217, v218, v219
    v_cvt_pk_bf16_f32 v200, v200, v201
    v_mfma_f32_16x16x32_bf16 v[56:59], a[232:235], a[116:119], v[56:59]
    s_waitcnt lgkmcnt(1)
    v_mul_f32 v190, v190, v49
    v_fma_f32 v75, v75, s28, v11
    v_exp_f32 v76, v76
    v_mfma_f32_16x16x32_bf16 v[112:115], a[212:215], v[14:17], 0
    ds_read_b64_tr_b16 a[232:233], v3 offset:1024
    v_mul_f32 v184, v184, v49
    v_mfma_f32_16x16x32_bf16 v[116:119], a[216:219], v[14:17], 0
    v_cvt_pk_bf16_f32 v121, v122, v123
    v_cvt_pk_bf16_f32 v228, v228, v229
    v_mul_f32 v109, v109, v51
    v_mul_f32 v105, v105, v51
    v_accvgpr_read_b32 v108, a12
    v_mul_f32 v108, v108, v51
    v_fma_f32 v58, v58, s28, v9
    v_fma_f32 v89, v89, s28, v13
    v_mul_f32 v104, v104, v51
    v_cvt_pk_bf16_f32 v188, v188, v189
    v_cvt_pk_bf16_f32 v184, v184, v185
    v_mfma_f32_16x16x32_bf16 v[164:167], a[216:219], v[20:23], 0
    ds_read_b64_tr_b16 a[224:225], v5 offset:0
    v_mul_f32 v107, v107, v51
    v_cvt_pk_bf16_f32 v104, v104, v105
    v_mul_f32 v202, v202, v49
    v_fma_f32 v81, v81, s28, v12
    v_xor_b32 v101, 96, v101
    v_mfma_f32_16x16x32_bf16 v[160:163], a[212:215], v[20:23], 0
    ds_write2st64_b64 v101, v[120:121], v[168:169] offset0:0 offset1:12
    v_pk_mul_f32 v[232:233], v[232:233], v[50:51] op_sel_hi:[1,0]
    v_cvt_pk_bf16_f32 v105, v106, v107
    v_exp_f32 v53, v53
    v_mfma_f32_16x16x32_bf16 v[208:211], a[212:215], v[26:29], 0
    ds_read_b64_tr_b16 a[226:227], v5 offset:6144
    v_accvgpr_read_b32 v110, a14
    v_cvt_pk_bf16_f32 v140, v140, v141
    v_mul_f32 v194, v194, v49
    v_accvgpr_read_b32 v107, a19
    v_pk_mul_f32 v[136:137], v[136:137], v[48:49] op_sel_hi:[1,0]
    v_cvt_pk_bf16_f32 v108, v108, v109
    v_cvt_pk_bf16_f32 v156, v156, v157
    v_mfma_f32_16x16x32_bf16 v[212:215], a[216:219], v[26:29], 0
    ds_write2st64_b64 v101, v[216:217], v[104:105] offset0:24 offset1:36
    v_cvt_pk_bf16_f32 v124, v124, v125
    v_mfma_f32_16x16x32_bf16 a[4:7], a[216:219], v[32:35], 0
    ds_read_b64_tr_b16 a[228:229], v2 offset:1024
    v_cvt_pk_bf16_f32 v152, v152, v153
    v_accvgpr_read_b32 v104, a16
    v_mul_f32 v110, v110, v51
    v_cvt_pk_bf16_f32 v236, v236, v237
    v_pk_mul_f32 v[252:253], v[252:253], v[50:51] op_sel_hi:[1,0]
    v_pk_mul_f32 v[150:151], v[150:151], v[48:49] op_sel_hi:[1,0]
    v_cvt_pk_bf16_f32 v125, v126, v127
    v_cvt_pk_bf16_f32 v177, v178, v179
    v_fma_f32 v57, v57, s28, v9
    v_pk_mul_f32 v[244:245], v[244:245], v[50:51] op_sel_hi:[1,0]
    v_mul_f32 v104, v104, v51
    v_accvgpr_read_b32 v106, a18
    v_cvt_pk_bf16_f32 v189, v190, v191
    v_cvt_pk_bf16_f32 v192, v192, v193
    v_xor_b32 v101, 32, v101
    v_mfma_f32_16x16x32_bf16 a[0:3], a[212:215], v[32:35], 0
    ds_write2st64_b64 v101, v[124:125], v[172:173] offset0:0 offset1:12
    v_cvt_pk_bf16_f32 v224, v224, v225
    v_pk_mul_f32 v[230:231], v[230:231], v[50:51] op_sel_hi:[1,0]
    v_exp_f32 v85, v85
    v_cvt_pk_bf16_f32 v240, v240, v241
    v_mfma_f32_16x16x32_bf16 a[48:51], a[212:215], v[38:41], 0
    ds_read_b128 v[96:99], v8 offset:0
    v_fma_f32 v77, v77, s28, v12
    v_cvt_pk_bf16_f32 v136, v136, v137
    v_accvgpr_read_b32 v105, a17
    v_exp_f32 v60, v60
    v_pk_mul_f32 v[142:143], v[142:143], v[48:49] op_sel_hi:[1,0]
    v_cvt_pk_bf16_f32 v109, v110, v111
    v_accvgpr_read_b32 v111, a23
    v_cvt_pk_bf16_f32 v221, v222, v223
    v_mfma_f32_16x16x32_bf16 a[52:55], a[216:219], v[38:41], 0
    s_waitcnt lgkmcnt(2)
    ds_read_b64_tr_b16 a[234:235], v3 offset:7168
    v_cvt_pk_bf16_f32 v204, v204, v205
    v_exp_f32 v75, v75
    v_mfma_f32_16x16x32_bf16 a[56:59], a[220:223], v[38:41], 0
    ds_write2st64_b64 v101, v[220:221], v[108:109] offset0:24 offset1:36
    v_cvt_pk_bf16_f32 v201, v202, v203
    v_exp_f32 v55, v55
    v_mul_f32 v105, v105, v51
    v_mfma_f32_16x16x32_bf16 a[60:63], a[224:227], v[38:41], 0
    ds_read_b64_tr_b16 a[230:231], v2 offset:7168
    v_fma_f32 v73, v73, s28, v11
    v_mul_f32 v106, v106, v51
    v_cvt_pk_bf16_f32 v129, v130, v131
    v_mfma_f32_16x16x32_bf16 a[12:15], a[224:227], v[32:35], 0
    s_add_u32 s20, s20, 128
    v_cvt_pk_bf16_f32 v137, v138, v139
    v_mul_f32 v107, v107, v51
    v_mfma_f32_16x16x32_bf16 a[8:11], a[220:223], v[32:35], 0
    v_exp_f32 v64, v64
    v_cvt_pk_bf16_f32 v133, v134, v135
    v_cvt_pk_bf16_f32 v232, v232, v233
    v_cvt_pk_bf16_f32 v196, v196, v197
    v_cvt_pk_bf16_f32 v104, v104, v105
    v_cvt_pk_bf16_f32 v237, v238, v239
    v_mfma_f32_16x16x32_bf16 v[216:219], a[220:223], v[26:29], 0
    v_cvt_pk_bf16_f32 v229, v230, v231
    v_cvt_pk_bf16_f32 v149, v150, v151
    v_accvgpr_read_b32 v110, a22
    v_xor_b32 v101, 96, v101
    v_cvt_pk_bf16_f32 v19, v54, v55
    v_accvgpr_read_b32 v108, a20
    v_cvt_pk_bf16_f32 v225, v226, v227
    v_mul_f32 v110, v110, v51
    v_fma_f32 v59, v59, s28, v9
    v_pk_mul_f32 v[158:159], v[158:159], v[48:49] op_sel_hi:[1,0]
    v_cvt_pk_bf16_f32 v105, v106, v107
    v_mul_f32 v108, v108, v51
    v_pk_mul_f32 v[248:249], v[248:249], v[50:51] op_sel_hi:[1,0]
    v_exp_f32 v70, v70
    v_cvt_pk_bf16_f32 v193, v194, v195
    v_accvgpr_read_b32 v107, a27
    v_mul_f32 v111, v111, v51
    v_cvt_pk_bf16_f32 v141, v142, v143
    v_mfma_f32_16x16x32_bf16 v[220:223], a[224:227], v[26:29], 0
    ds_write2st64_b64 v101, v[128:129], v[176:177] offset0:4 offset1:16
    v_fma_f32 v83, v83, s28, v12
    v_mfma_f32_16x16x32_bf16 v[172:175], a[224:227], v[20:23], 0
    s_add_u32 m0, s22, 14336
    ds_write2st64_b64 v101, v[224:225], v[104:105] offset0:28 offset1:40
    v_accvgpr_read_b32 v104, a24
    v_accvgpr_read_b32 v106, a26
    v_mul_f32 v104, v104, v51
    v_accvgpr_read_b32 v109, a21
    v_accvgpr_read_b32 v105, a25
    v_mul_f32 v109, v109, v51
    v_mfma_f32_16x16x32_bf16 v[44:47], a[248:251], v[32:35], v[44:47]
    v_cvt_pk_bf16_f32 v185, v186, v187
    v_cvt_pk_bf16_f32 v233, v234, v235
    v_cvt_pk_bf16_f32 v181, v182, v183
    v_cvt_pk_bf16_f32 v108, v108, v109
    v_fma_f32 v80, v80, s28, v12
    v_pk_mul_f32 v[250:251], v[250:251], v[50:51] op_sel_hi:[1,0]
    v_cvt_pk_bf16_f32 v145, v146, v147
    v_cvt_pk_bf16_f32 v244, v244, v245
    v_xor_b32 v101, 32, v101
    v_mfma_f32_16x16x32_bf16 v[168:171], a[220:223], v[20:23], 0
    ds_read_b64_tr_b16 a[218:219], v5 offset:7168
    buffer_load_dwordx4 v6, s[4:7], s20 offen lds
    v_mfma_f32_16x16x32_bf16 v[120:123], a[220:223], v[14:17], 0
    ds_write2st64_b64 v101, v[132:133], v[180:181] offset0:4 offset1:16
    v_mul_f32 v105, v105, v51
    v_mfma_f32_16x16x32_bf16 v[124:127], a[224:227], v[14:17], 0
    s_add_u32 s20, s20, 12032
    ds_read_b64_tr_b16 a[214:215], v4 offset:7168
    v_cvt_pk_bf16_f32 v109, v110, v111
    v_cvt_pk_bf16_f32 v104, v104, v105
    v_mfma_f32_16x16x32_bf16 v[44:47], a[252:255], v[38:41], v[44:47]
    s_waitcnt lgkmcnt(3)
    ds_write2st64_b64 v101, v[228:229], v[108:109] offset0:28 offset1:40
    v_cvt_pk_bf16_f32 v197, v198, v199
    v_mfma_f32_16x16x32_bf16 v[128:131], a[228:231], v[14:17], 0
    buffer_store_dwordx4 v[96:99], v102, s[16:19], s67 offen offset:0 nt
    ds_read_b64_tr_b16 a[222:223], v2 offset:8192
    v_pk_mul_f32 v[154:155], v[154:155], v[48:49] op_sel_hi:[1,0]
    v_mul_f32 v107, v107, v51
    v_cvt_pk_bf16_f32 v205, v206, v207
    v_accvgpr_read_b32 v110, a30
    v_mul_f32 v106, v106, v51
    v_accvgpr_read_b32 v111, a31
    v_mfma_f32_16x16x32_bf16 v[132:135], a[232:235], v[14:17], 0
    ds_read_b64_tr_b16 a[224:225], v3 offset:2048
    v_cvt_pk_bf16_f32 v105, v106, v107
    v_xor_b32 v101, 96, v101
    v_mfma_f32_16x16x32_bf16 v[180:183], a[232:235], v[20:23], 0
    s_add_u32 m0, s38, 0
    ds_read_b64_tr_b16 a[212:213], v4 offset:1024
    v_cvt_pk_bf16_f32 v248, v248, v249
    v_mfma_f32_16x16x32_bf16 v[176:179], a[228:231], v[20:23], 0
    ds_read_b64_tr_b16 a[220:221], v2 offset:2048
    v_accvgpr_read_b32 v108, a28
    v_mfma_f32_16x16x32_bf16 v[224:227], a[228:231], v[26:29], 0
    buffer_load_dwordx4 v6, s[12:15], s33 offen nt lds
    ds_read_b64_tr_b16 a[216:217], v5 offset:1024
    v_cvt_pk_bf16_f32 v241, v242, v243
    v_mfma_f32_16x16x32_bf16 v[228:231], a[232:235], v[26:29], 0
    ds_read_b128 v[96:99], v8 offset:1024
    v_mul_f32 v108, v108, v51
    v_fma_f32 v56, v56, s28, v9
    v_cvt_pk_bf16_f32 v245, v246, v247
    v_accvgpr_read_b32 v109, a29
    v_fma_f32 v66, v66, s28, v10
    v_mul_f32 v109, v109, v51
    v_mul_f32 v111, v111, v51
    v_mfma_f32_16x16x32_bf16 a[20:23], a[232:235], v[32:35], 0
    ds_write2st64_b64 v101, v[136:137], v[184:185] offset0:4 offset1:16
    v_mfma_f32_16x16x32_bf16 a[16:19], a[228:231], v[32:35], 0
    ds_write2st64_b64 v101, v[232:233], v[104:105] offset0:28 offset1:40
    v_pk_mul_f32 v[254:255], v[254:255], v[50:51] op_sel_hi:[1,0]
    v_mul_f32 v110, v110, v51
    v_cvt_pk_bf16_f32 v108, v108, v109
    v_accvgpr_read_b32 v106, a34
    v_xor_b32 v101, 32, v101
    v_cvt_pk_bf16_f32 v109, v110, v111
    v_accvgpr_read_b32 v110, a38
    v_exp_f32 v59, v59
    v_mfma_f32_16x16x32_bf16 a[64:67], a[228:231], v[38:41], 0
    ds_write2st64_b64 v101, v[140:141], v[188:189] offset0:4 offset1:16
    v_accvgpr_read_b32 v104, a32
    v_accvgpr_read_b32 v107, a35
    v_mfma_f32_16x16x32_bf16 a[68:71], a[232:235], v[38:41], 0
    s_waitcnt lgkmcnt(3)
    ds_write2st64_b64 v101, v[236:237], v[108:109] offset0:28 offset1:40
    v_mfma_f32_16x16x32_bf16 a[72:75], a[212:215], v[38:41], 0
    ds_read_b64_tr_b16 a[228:229], v4 offset:2048
    v_fma_f32 v63, v63, s28, v10
    v_mfma_f32_16x16x32_bf16 a[76:79], a[216:219], v[38:41], 0
    ds_read_b64_tr_b16 a[232:233], v5 offset:2048
    v_mul_f32 v110, v110, v51
    v_mfma_f32_16x16x32_bf16 a[28:31], a[216:219], v[32:35], 0
    ds_read_b64_tr_b16 a[226:227], v3 offset:8192
    v_cvt_pk_bf16_f32 v252, v252, v253
    v_accvgpr_read_b32 v111, a39
    v_mfma_f32_16x16x32_bf16 a[24:27], a[212:215], v[32:35], 0
    ds_read_b64_tr_b16 a[230:231], v4 offset:8192
    v_mul_f32 v107, v107, v51
    v_accvgpr_read_b32 v105, a33
    v_mul_f32 v104, v104, v51
    v_mfma_f32_16x16x32_bf16 v[232:235], a[212:215], v[26:29], 0
    s_add_u32 m0, s38, 1024
    v_mul_f32 v111, v111, v51
    v_xor_b32 v101, 96, v101
    v_cvt_pk_bf16_f32 v153, v154, v155
    v_mul_f32 v105, v105, v51
    v_cvt_pk_bf16_f32 v104, v104, v105
    v_mul_f32 v106, v106, v51
    v_mfma_f32_16x16x32_bf16 v[236:239], a[216:219], v[26:29], 0
    buffer_load_dwordx4 v7, s[12:15], s33 offen nt lds
    v_accvgpr_read_b32 v109, a37
    v_mfma_f32_16x16x32_bf16 v[188:191], a[216:219], v[20:23], 0
    ds_read_b64_tr_b16 a[234:235], v5 offset:8192
    v_accvgpr_read_b32 v108, a36
    v_mfma_f32_16x16x32_bf16 v[184:187], a[212:215], v[20:23], 0
    ds_write2st64_b64 v101, v[144:145], v[192:193] offset0:8 offset1:20
    v_mfma_f32_16x16x32_bf16 v[136:139], a[212:215], v[14:17], 0
    v_cvt_pk_bf16_f32 v105, v106, v107
    v_mul_f32 v108, v108, v51
    v_mfma_f32_16x16x32_bf16 v[140:143], a[216:219], v[14:17], 0
    ds_write2st64_b64 v101, v[240:241], v[104:105] offset0:32 offset1:44
    v_accvgpr_read_b32 v107, a43
    v_xor_b32 v101, 32, v101
    v_exp_f32 v71, v71
    v_accvgpr_read_b32 v104, a40
    v_mfma_f32_16x16x32_bf16 v[144:147], a[220:223], v[14:17], 0
    s_waitcnt lgkmcnt(3)
    ds_write2st64_b64 v101, v[148:149], v[196:197] offset0:8 offset1:20
    v_mul_f32 v107, v107, v51
    v_mfma_f32_16x16x32_bf16 v[148:151], a[224:227], v[14:17], 0
    s_add_u32 s39, s39, 12288
    v_mul_f32 v109, v109, v51
    v_cvt_pk_bf16_f32 v108, v108, v109
    v_mfma_f32_16x16x32_bf16 v[196:199], a[224:227], v[20:23], 0
    s_waitcnt vmcnt(9) lgkmcnt(3)
    v_accvgpr_read_b32 v106, a42
    v_cvt_pk_bf16_f32 v109, v110, v111
    v_exp_f32 v79, v79
    v_mfma_f32_16x16x32_bf16 v[192:195], a[220:223], v[20:23], 0
    buffer_store_dwordx4 v[96:99], v103, s[16:19], s67 offen offset:0 nt
    s_barrier
    v_exp_f32 v62, v62
    v_accvgpr_read_b32 v110, a46
    v_mfma_f32_16x16x32_bf16 v[240:243], a[220:223], v[26:29], 0
    ds_write2st64_b64 v101, v[244:245], v[108:109] offset0:32 offset1:44
    v_mul_f32 v106, v106, v51
    v_mfma_f32_16x16x32_bf16 v[244:247], a[224:227], v[26:29], 0
    ds_read_b128 a[216:219], v1 offset:0
    v_accvgpr_read_b32 v105, a41
    v_cvt_pk_bf16_f32 v249, v250, v251
    v_cvt_pk_bf16_f32 v157, v158, v159
    v_accvgpr_read_b32 v108, a44
    v_exp_f32 v83, v83
    v_fma_f32 v72, v72, s28, v11
    v_cvt_pk_bf16_f32 v253, v254, v255
    v_mul_f32 v105, v105, v51
    v_accvgpr_read_b32 v111, a47
    v_accvgpr_read_b32 v109, a45
    v_mul_f32 v109, v109, v51
    v_fma_f32 v90, v90, s28, v13
    v_fma_f32 v74, v74, s28, v11
    v_mfma_f32_16x16x32_bf16 a[36:39], a[224:227], v[32:35], 0
    v_xor_b32 v101, 96, v101
    v_cvt_pk_bf16_f32 v18, v52, v53
    v_mfma_f32_16x16x32_bf16 a[32:35], a[220:223], v[32:35], 0
    s_add_u32 m0, s22, 24576
    ds_read_b128 a[212:215], v0 offset:0
    v_mul_f32 v110, v110, v51
    v_mul_f32 v104, v104, v51
    v_mfma_f32_16x16x32_bf16 a[80:83], a[220:223], v[38:41], 0
    ds_read_b128 v[96:99], v8 offset:2048
    v_cvt_pk_bf16_f32 v104, v104, v105
    v_mul_f32 v108, v108, v51
    v_exp_f32 v72, v72
    v_mfma_f32_16x16x32_bf16 a[84:87], a[224:227], v[38:41], 0
    ds_write2st64_b64 v101, v[152:153], v[200:201] offset0:8 offset1:20
    v_cvt_pk_bf16_f32 v105, v106, v107
    v_mul_f32 v111, v111, v51
    v_mfma_f32_16x16x32_bf16 a[88:91], a[228:231], v[38:41], 0
    ds_read_b128 a[220:223], v0 offset:1024
    v_cvt_pk_bf16_f32 v24, v60, v61
    v_mfma_f32_16x16x32_bf16 a[92:95], a[232:235], v[38:41], 0
    ds_write2st64_b64 v101, v[248:249], v[104:105] offset0:32 offset1:44
    v_cvt_pk_bf16_f32 v108, v108, v109
    v_xor_b32 v101, 32, v101
    v_mfma_f32_16x16x32_bf16 a[44:47], a[232:235], v[32:35], 0
    buffer_load_dwordx4 v6, s[8:11], s21 offen lds
    v_mfma_f32_16x16x32_bf16 a[40:43], a[228:231], v[32:35], 0
    ds_write2st64_b64 v101, v[156:157], v[204:205] offset0:8 offset1:20
    v_cvt_pk_bf16_f32 v109, v110, v111
    v_mfma_f32_16x16x32_bf16 v[248:251], a[228:231], v[26:29], 0
    ds_write2st64_b64 v101, v[252:253], v[108:109] offset0:32 offset1:44
    v_mfma_f32_16x16x32_bf16 v[252:255], a[232:235], v[26:29], 0
    v_fma_f32 v82, v82, s28, v12
    v_fma_f32 v87, v87, s28, v13
    v_mfma_f32_16x16x32_bf16 v[204:207], a[232:235], v[20:23], 0
    v_fma_f32 v65, v65, s28, v10
    v_exp_f32 v90, v90
    v_mfma_f32_16x16x32_bf16 v[200:203], a[228:231], v[20:23], 0
    v_exp_f32 v77, v77
    v_mfma_f32_16x16x32_bf16 v[152:155], a[228:231], v[14:17], 0
    ds_read_b128 a[224:227], v1 offset:1024
    v_exp_f32 v78, v78
    v_cvt_pk_bf16_f32 v31, v70, v71
    v_mfma_f32_16x16x32_bf16 v[156:159], a[232:235], v[14:17], 0
    s_waitcnt lgkmcnt(3)
    v_exp_f32 v63, v63
    v_mfma_f32_16x16x32_bf16 v[52:55], a[212:215], a[96:99], 0
    ds_read_b128 a[228:231], v0 offset:2048
    v_cvt_pk_bf16_f32 v25, v62, v63
    v_mfma_f32_16x16x32_bf16 v[52:55], a[216:219], a[100:103], v[52:55]
    v_exp_f32 v58, v58
    v_mfma_f32_16x16x32_bf16 v[52:55], a[220:223], a[104:107], v[52:55]
    s_add_u32 s21, s21, 128
    v_exp_f32 v84, v84
    v_mfma_f32_16x16x32_bf16 v[60:63], a[220:223], a[128:131], 0
    v_exp_f32 v57, v57
    v_mfma_f32_16x16x32_bf16 v[60:63], a[216:219], a[124:127], v[60:63]
    ds_read_b128 a[232:235], v1 offset:2048
    v_cvt_pk_bf16_f32 v42, v84, v85
    v_mfma_f32_16x16x32_bf16 v[60:63], a[212:215], a[120:123], v[60:63]
    v_exp_f32 v56, v56
    v_mfma_f32_16x16x32_bf16 v[68:71], a[212:215], a[144:147], 0
    v_exp_f32 v86, v86
    v_mfma_f32_16x16x32_bf16 v[68:71], a[216:219], a[148:151], v[68:71]
    v_cvt_pk_bf16_f32 v36, v76, v77
    v_cvt_pk_bf16_f32 v37, v78, v79
    v_mfma_f32_16x16x32_bf16 v[68:71], a[220:223], a[152:155], v[68:71]
    v_exp_f32 v87, v87
    v_mfma_f32_16x16x32_bf16 v[76:79], a[220:223], a[176:179], 0
    v_cvt_pk_bf16_f32 v17, v58, v59
    v_cvt_pk_bf16_f32 v43, v86, v87
    v_mfma_f32_16x16x32_bf16 v[76:79], a[216:219], a[172:175], v[76:79]
    s_add_u32 m0, s22, 25600
    v_exp_f32 v82, v82
    v_mfma_f32_16x16x32_bf16 v[76:79], a[212:215], a[168:171], v[76:79]
    v_exp_f32 v66, v66
    v_mfma_f32_16x16x32_bf16 v[84:87], a[212:215], a[192:195], 0
    v_exp_f32 v74, v74
    v_mfma_f32_16x16x32_bf16 v[84:87], a[216:219], a[196:199], v[84:87]
    ds_read_b128 a[216:219], v1 offset:6144
    v_mfma_f32_16x16x32_bf16 v[84:87], a[220:223], a[200:203], v[84:87]
    s_waitcnt lgkmcnt(1)
    v_exp_f32 v73, v73
    v_mfma_f32_16x16x32_bf16 v[84:87], a[224:227], a[204:207], v[84:87]
    buffer_load_dwordx4 v6, s[8:11], s21 offen lds
    v_mfma_f32_16x16x32_bf16 v[84:87], a[228:231], a[208:211], v[84:87]
    v_cvt_pk_bf16_f32 v28, v72, v73
    v_cvt_pk_bf16_f32 v16, v56, v57
    v_mfma_f32_16x16x32_bf16 v[84:87], a[232:235], v[92:95], v[84:87]
    v_exp_f32 v81, v81
    v_mfma_f32_16x16x32_bf16 v[76:79], a[232:235], a[188:191], v[76:79]
    s_add_u32 s21, s21, 128
    v_fma_f32 v67, v67, s28, v10
    v_fma_f32 v88, v88, s28, v13
    v_mfma_f32_16x16x32_bf16 v[76:79], a[228:231], a[184:187], v[76:79]
    v_exp_f32 v67, v67
    v_mfma_f32_16x16x32_bf16 v[48:51], a[236:239], v[16:19], v[44:47]
    s_add_u32 m0, s22, 26624
    v_exp_f32 v65, v65
    v_mfma_f32_16x16x32_bf16 v[76:79], a[224:227], a[180:183], v[76:79]
    buffer_load_dwordx4 v6, s[8:11], s21 offen lds
    v_mfma_f32_16x16x32_bf16 v[68:71], a[224:227], a[156:159], v[68:71]
    s_add_u32 s21, s21, 12032
    v_exp_f32 v80, v80
    v_mfma_f32_16x16x32_bf16 v[68:71], a[228:231], a[160:163], v[68:71]
    v_exp_f32 v88, v88
    v_mfma_f32_16x16x32_bf16 v[68:71], a[232:235], a[164:167], v[68:71]
    ds_read_b128 a[212:215], v0 offset:6144
    v_cvt_pk_bf16_f32 v23, v66, v67
    v_mfma_f32_16x16x32_bf16 v[60:63], a[232:235], a[140:143], v[60:63]
    s_add_u32 s56, s67, 128
    v_cvt_pk_bf16_f32 v22, v64, v65
    v_cvt_pk_bf16_f32 v35, v82, v83
    v_mfma_f32_16x16x32_bf16 v[60:63], a[228:231], a[136:139], v[60:63]
    s_add_u32 s58, s33, 128
    ds_read_b128 a[220:223], v0 offset:7168
    v_cvt_pk_bf16_f32 v29, v74, v75
    v_mfma_f32_16x16x32_bf16 v[48:51], a[240:243], v[22:25], v[48:51]
    v_exp_f32 v91, v91
    v_mfma_f32_16x16x32_bf16 v[60:63], a[224:227], a[132:135], v[60:63]
    s_add_u32 m0, s38, 2048
    v_exp_f32 v89, v89
    v_mfma_f32_16x16x32_bf16 v[48:51], a[244:247], v[28:31], v[48:51]
    buffer_load_dwordx4 v6, s[12:15], s58 offen nt lds
    v_mfma_f32_16x16x32_bf16 v[52:55], a[224:227], a[108:111], v[52:55]
    buffer_store_dwordx4 v[96:99], v102, s[16:19], s56 offen offset:0 nt
    s_nop 0
    ds_read_b128 v[96:99], v8 offset:3072
    v_cvt_pk_bf16_f32 v34, v80, v81
    v_mfma_f32_16x16x32_bf16 v[52:55], a[228:231], a[112:115], v[52:55]
    v_cvt_pk_bf16_f32 v40, v88, v89
    v_cvt_pk_bf16_f32 v41, v90, v91
    v_mfma_f32_16x16x32_bf16 v[52:55], a[232:235], a[116:119], v[52:55]
    ds_read_b128 a[224:227], v1 offset:7168
    v_mfma_f32_16x16x32_bf16 v[48:51], a[248:251], v[34:37], v[48:51]
    s_add_u32 m0, s38, 3072
    ds_read_b128 a[228:231], v0 offset:8192
    v_mfma_f32_16x16x32_bf16 v[48:51], a[252:255], v[40:43], v[48:51]
    s_waitcnt lgkmcnt(4)
    ds_read_b128 a[232:235], v1 offset:8192
    v_mfma_f32_16x16x32_bf16 v[56:59], a[212:215], a[96:99], 0
    v_mfma_f32_16x16x32_bf16 v[56:59], a[216:219], a[100:103], v[56:59]
    s_waitcnt lgkmcnt(4)
    v_mfma_f32_16x16x32_bf16 v[56:59], a[220:223], a[104:107], v[56:59]
    v_mfma_f32_16x16x32_bf16 v[64:67], a[220:223], a[128:131], 0
    v_mfma_f32_16x16x32_bf16 v[64:67], a[216:219], a[124:127], v[64:67]
    v_cmp_lt_f32 vcc, s29, v48
    v_mfma_f32_16x16x32_bf16 v[64:67], a[212:215], a[120:123], v[64:67]
    s_waitcnt lgkmcnt(3)
    buffer_load_dwordx4 v7, s[12:15], s58 offen nt lds
    v_mfma_f32_16x16x32_bf16 v[72:75], a[212:215], a[144:147], 0
    buffer_store_dwordx4 v[96:99], v103, s[16:19], s56 offen offset:0 nt
    s_cbranch_vccnz L_rs_tr45d
L_ret_tr45d:
    v_fma_f32 v54, v54, s28, v9
    v_fma_f32 v62, v62, s28, v10
    v_fma_f32 v52, v52, s28, v9
    v_mfma_f32_16x16x32_bf16 v[72:75], a[216:219], a[148:151], v[72:75]
    s_waitcnt vmcnt(14) lgkmcnt(0)
    v_fma_f32 v53, v53, s28, v9
    v_mfma_f32_16x16x32_bf16 v[72:75], a[220:223], a[152:155], v[72:75]
    s_add_u32 m0, s22, 0
    v_fma_f32 v55, v55, s28, v9
    v_fma_f32 v63, v63, s28, v10
    v_mfma_f32_16x16x32_bf16 v[80:83], a[220:223], a[176:179], 0
    s_barrier
    v_mfma_f32_16x16x32_bf16 v[80:83], a[216:219], a[172:175], v[80:83]
    v_exp_f32 v55, v55
    v_mfma_f32_16x16x32_bf16 v[80:83], a[212:215], a[168:171], v[80:83]
    v_exp_f32 v52, v52
    v_mfma_f32_16x16x32_bf16 v[88:91], a[212:215], a[192:195], 0
    v_exp_f32 v54, v54
    v_mfma_f32_16x16x32_bf16 v[88:91], a[216:219], a[196:199], v[88:91]
    ds_read_b64_tr_b16 a[212:213], v2 offset:18432
    v_fma_f32 v60, v60, s28, v10
    v_mfma_f32_16x16x32_bf16 v[88:91], a[220:223], a[200:203], v[88:91]
    ds_read_b64_tr_b16 a[214:215], v2 offset:12288
    v_mfma_f32_16x16x32_bf16 v[88:91], a[224:227], a[204:207], v[88:91]
    v_exp_f32 v53, v53
    v_mfma_f32_16x16x32_bf16 v[88:91], a[228:231], a[208:211], v[88:91]
    buffer_load_dwordx4 v6, s[4:7], s20 offen lds
    v_mfma_f32_16x16x32_bf16 v[88:91], a[232:235], v[92:95], v[88:91]
    v_exp_f32 v62, v62
    v_mfma_f32_16x16x32_bf16 v[80:83], a[232:235], a[188:191], v[80:83]
    ds_read_b64_tr_b16 a[216:217], v3 offset:18432
    v_add_u32 v8, 4096, v8
    v_mfma_f32_16x16x32_bf16 v[80:83], a[228:231], a[184:187], v[80:83]
    ds_read_b64_tr_b16 a[218:219], v3 offset:12288
    v_fma_f32 v61, v61, s28, v10
    v_mfma_f32_16x16x32_bf16 v[80:83], a[224:227], a[180:183], v[80:83]
    s_add_u32 s20, s20, 128
    v_exp_f32 v60, v60
    v_mfma_f32_16x16x32_bf16 v[72:75], a[224:227], a[156:159], v[72:75]
    s_add_u32 m0, s22, 1024
    ds_read_b64_tr_b16 a[220:221], v4 offset:18432
    v_cvt_pk_bf16_f32 v15, v54, v55
    v_mfma_f32_16x16x32_bf16 v[72:75], a[228:231], a[160:163], v[72:75]
    buffer_load_dwordx4 v6, s[4:7], s20 offen lds
    v_mfma_f32_16x16x32_bf16 v[72:75], a[232:235], a[164:167], v[72:75]
    v_exp_f32 v63, v63
    v_mfma_f32_16x16x32_bf16 v[64:67], a[232:235], a[140:143], v[64:67]
    v_cvt_pk_bf16_f32 v21, v62, v63
    v_cvt_pk_bf16_f32 v14, v52, v53
    v_mfma_f32_16x16x32_bf16 v[64:67], a[228:231], a[136:139], v[64:67]
    v_exp_f32 v61, v61
    v_mfma_f32_16x16x32_bf16 v[64:67], a[224:227], a[132:135], v[64:67]
    s_add_u32 s20, s20, 128
    ds_read_b64_tr_b16 a[222:223], v4 offset:12288
    s_add_u32 m0, s22, 2048
    v_mfma_f32_16x16x32_bf16 v[56:59], a[224:227], a[108:111], v[56:59]
    buffer_load_dwordx4 v6, s[4:7], s20 offen lds
    v_mfma_f32_16x16x32_bf16 v[56:59], a[228:231], a[112:115], v[56:59]
    ds_read_b64_tr_b16 a[224:225], v5 offset:18432
    s_add_u32 s20, s20, 12032
    v_mfma_f32_16x16x32_bf16 v[56:59], a[232:235], a[116:119], v[56:59]
    ds_read_b64_tr_b16 a[226:227], v5 offset:12288
    v_cvt_pk_bf16_f32 v20, v60, v61
    s_branch L_loop5
L_tr44:
    s_waitcnt lgkmcnt(6)
    v_mfma_f32_16x16x32_bf16 v[112:115], a[212:215], v[16:19], v[112:115]
    ds_read_b64_tr_b16 a[230:231], v2 offset:13312
    v_mfma_f32_16x16x32_bf16 v[160:163], a[212:215], v[22:25], v[160:163]
    ds_read_b64_tr_b16 a[228:229], v2 offset:19456
    v_fma_f32 v79, v79, s28, v12
    v_mfma_f32_16x16x32_bf16 v[208:211], a[212:215], v[28:31], v[208:211]
    v_fma_f32 v77, v77, s28, v12
    v_fma_f32 v69, v69, s28, v11
    v_mfma_f32_16x16x32_bf16 a[0:3], a[212:215], v[34:37], a[0:3]
    ds_read_b64_tr_b16 a[232:233], v3 offset:19456
    s_waitcnt lgkmcnt(7)
    v_mfma_f32_16x16x32_bf16 a[4:7], a[216:219], v[34:37], a[4:7]
    v_fma_f32 v62, v62, s28, v10
    v_mfma_f32_16x16x32_bf16 v[212:215], a[216:219], v[28:31], v[212:215]
    v_fma_f32 v78, v78, s28, v12
    v_fma_f32 v58, v58, s28, v9
    v_mfma_f32_16x16x32_bf16 v[164:167], a[216:219], v[22:25], v[164:167]
    ds_read_b64_tr_b16 a[212:213], v4 offset:19456
    v_fma_f32 v70, v70, s28, v11
    v_mfma_f32_16x16x32_bf16 v[116:119], a[216:219], v[16:19], v[116:119]
    ds_read_b64_tr_b16 a[234:235], v3 offset:13312
    s_waitcnt lgkmcnt(7)
    v_mfma_f32_16x16x32_bf16 v[120:123], a[220:223], v[16:19], v[120:123]
    ds_read_b64_tr_b16 a[214:215], v4 offset:13312
    v_mfma_f32_16x16x32_bf16 v[168:171], a[220:223], v[22:25], v[168:171]
    v_fma_f32 v66, v66, s28, v10
    v_fma_f32 v81, v81, s28, v12
    v_mfma_f32_16x16x32_bf16 v[216:219], a[220:223], v[28:31], v[216:219]
    v_exp_f32 v70, v70
    v_mfma_f32_16x16x32_bf16 a[8:11], a[220:223], v[34:37], a[8:11]
    s_waitcnt lgkmcnt(4)
    ds_read_b128 v[88:91], v8 offset:3072
    v_fma_f32 v68, v68, s28, v11
    v_mfma_f32_16x16x32_bf16 a[12:15], a[224:227], v[34:37], a[12:15]
    ds_read_b64_tr_b16 a[222:223], v2 offset:14336
    v_fma_f32 v67, v67, s28, v10
    v_mfma_f32_16x16x32_bf16 v[220:223], a[224:227], v[28:31], v[220:223]
    ds_read_b64_tr_b16 a[218:219], v5 offset:13312
    v_fma_f32 v57, v57, s28, v9
    v_mfma_f32_16x16x32_bf16 v[172:175], a[224:227], v[22:25], v[172:175]
    ds_read_b64_tr_b16 a[216:217], v5 offset:19456
    v_fma_f32 v76, v76, s28, v12
    v_mfma_f32_16x16x32_bf16 v[124:127], a[224:227], v[16:19], v[124:127]
    ds_read_b64_tr_b16 a[220:221], v2 offset:20480
    v_mfma_f32_16x16x32_bf16 v[128:131], a[228:231], v[16:19], v[128:131]
    v_exp_f32 v78, v78
    v_mfma_f32_16x16x32_bf16 v[176:179], a[228:231], v[22:25], v[176:179]
    v_exp_f32 v62, v62
    v_mfma_f32_16x16x32_bf16 v[224:227], a[228:231], v[28:31], v[224:227]
    ds_read_b64_tr_b16 a[226:227], v3 offset:14336
    v_fma_f32 v71, v71, s28, v11
    v_mfma_f32_16x16x32_bf16 a[16:19], a[228:231], v[34:37], a[16:19]
    s_waitcnt lgkmcnt(6)
    ds_read_b64_tr_b16 a[228:229], v4 offset:20480
    v_fma_f32 v59, v59, s28, v9
    v_mfma_f32_16x16x32_bf16 a[20:23], a[232:235], v[34:37], a[20:23]
    ds_read_b64_tr_b16 a[230:231], v4 offset:14336
    v_mfma_f32_16x16x32_bf16 v[228:231], a[232:235], v[28:31], v[228:231]
    v_exp_f32 v68, v68
    v_mfma_f32_16x16x32_bf16 v[180:183], a[232:235], v[22:25], v[180:183]
    ds_read_b64_tr_b16 a[224:225], v3 offset:20480
    v_mfma_f32_16x16x32_bf16 v[132:135], a[232:235], v[16:19], v[132:135]
    ds_read_b64_tr_b16 a[234:235], v5 offset:14336
    v_fma_f32 v80, v80, s28, v12
    v_mfma_f32_16x16x32_bf16 v[136:139], a[212:215], v[16:19], v[136:139]
    ds_read_b64_tr_b16 a[232:233], v5 offset:20480
    v_fma_f32 v63, v63, s28, v10
    v_mfma_f32_16x16x32_bf16 v[184:187], a[212:215], v[22:25], v[184:187]
    ds_read_b128 v[96:99], v8 offset:4096
    v_fma_f32 v83, v83, s28, v12
    v_mfma_f32_16x16x32_bf16 v[232:235], a[212:215], v[28:31], v[232:235]
    v_exp_f32 v71, v71
    v_mfma_f32_16x16x32_bf16 a[24:27], a[212:215], v[34:37], a[24:27]
    s_waitcnt lgkmcnt(7)
    v_fma_f32 v75, v75, s28, v11
    s_add_u32 s39, s39, 12288
    v_mfma_f32_16x16x32_bf16 a[28:31], a[216:219], v[34:37], a[28:31]
    v_fma_f32 v73, v73, s28, v11
    v_fma_f32 v74, v74, s28, v11
    v_mfma_f32_16x16x32_bf16 v[236:239], a[216:219], v[28:31], v[236:239]
    ds_read_b128 v[84:87], v8 offset:2048
    v_mfma_f32_16x16x32_bf16 v[188:191], a[216:219], v[22:25], v[188:191]
    v_exp_f32 v59, v59
    v_mfma_f32_16x16x32_bf16 v[140:143], a[216:219], v[16:19], v[140:143]
    v_exp_f32 v63, v63
    v_mfma_f32_16x16x32_bf16 v[144:147], a[220:223], v[16:19], v[144:147]
    v_exp_f32 v69, v69
    v_mfma_f32_16x16x32_bf16 v[192:195], a[220:223], v[22:25], v[192:195]
    s_waitcnt vmcnt(10) lgkmcnt(2)
    v_mfma_f32_16x16x32_bf16 v[240:243], a[220:223], v[28:31], v[240:243]
    s_barrier
    v_mfma_f32_16x16x32_bf16 a[32:35], a[220:223], v[34:37], a[32:35]
    ds_read_b128 a[212:215], v0 offset:12288
    v_fma_f32 v56, v56, s28, v9
    v_mfma_f32_16x16x32_bf16 a[36:39], a[224:227], v[34:37], a[36:39]
    s_add_u32 m0, s22, 36864
    v_exp_f32 v57, v57
    v_mfma_f32_16x16x32_bf16 v[244:247], a[224:227], v[28:31], v[244:247]
    buffer_load_dwordx4 v6, s[8:11], s21 offen lds
    v_mfma_f32_16x16x32_bf16 v[196:199], a[224:227], v[22:25], v[196:199]
    ds_read_b128 a[216:219], v1 offset:12288
    v_cvt_pk_bf16_f32 v26, v68, v69
    v_mfma_f32_16x16x32_bf16 v[148:151], a[224:227], v[16:19], v[148:151]
    s_add_u32 s21, s21, 128
    ds_read_b128 a[220:223], v0 offset:13312
    s_add_u32 m0, s22, 37888
    v_mfma_f32_16x16x32_bf16 v[152:155], a[228:231], v[16:19], v[152:155]
    v_exp_f32 v81, v81
    v_mfma_f32_16x16x32_bf16 v[200:203], a[228:231], v[22:25], v[200:203]
    buffer_load_dwordx4 v6, s[8:11], s21 offen lds
    v_mfma_f32_16x16x32_bf16 v[248:251], a[228:231], v[28:31], v[248:251]
    s_add_u32 s21, s21, 128
    v_exp_f32 v76, v76
    v_mfma_f32_16x16x32_bf16 a[40:43], a[228:231], v[34:37], a[40:43]
    s_add_u32 m0, s22, 38912
    ds_read_b128 a[224:227], v1 offset:13312
    v_cvt_pk_bf16_f32 v27, v70, v71
    v_mfma_f32_16x16x32_bf16 a[44:47], a[232:235], v[34:37], a[44:47]
    buffer_load_dwordx4 v6, s[8:11], s21 offen lds
    v_mfma_f32_16x16x32_bf16 v[252:255], a[232:235], v[28:31], v[252:255]
    v_exp_f32 v79, v79
    v_mfma_f32_16x16x32_bf16 v[204:207], a[232:235], v[22:25], v[204:207]
    v_exp_f32 v83, v83
    v_mfma_f32_16x16x32_bf16 v[156:159], a[232:235], v[16:19], v[156:159]
    s_waitcnt lgkmcnt(3)
    v_exp_f32 v56, v56
    v_mfma_f32_16x16x32_bf16 v[52:55], a[212:215], a[96:99], 0
    s_waitcnt lgkmcnt(2)
    v_cvt_pk_bf16_f32 v21, v62, v63
    v_fma_f32 v82, v82, s28, v12
    v_mfma_f32_16x16x32_bf16 v[52:55], a[216:219], a[100:103], v[52:55]
    s_waitcnt lgkmcnt(1)
    v_cvt_pk_bf16_f32 v33, v78, v79
    v_fma_f32 v64, v64, s28, v10
    v_mfma_f32_16x16x32_bf16 v[52:55], a[220:223], a[104:107], v[52:55]
    v_exp_f32 v58, v58
    v_mfma_f32_16x16x32_bf16 v[60:63], a[220:223], a[128:131], 0
    s_add_u32 s21, s21, 12032
    ds_read_b128 a[228:231], v0 offset:14336
    v_cvt_pk_bf16_f32 v17, v58, v59
    v_mfma_f32_16x16x32_bf16 v[60:63], a[216:219], a[124:127], v[60:63]
    v_exp_f32 v77, v77
    v_mfma_f32_16x16x32_bf16 v[60:63], a[212:215], a[120:123], v[60:63]
    ds_read_b128 a[232:235], v1 offset:14336
    s_add_u32 s56, s24, 5888
    v_mfma_f32_16x16x32_bf16 v[68:71], a[212:215], a[144:147], 0
    buffer_store_dwordx4 v[84:87], v102, s[16:19], s56 offen offset:0 nt
    v_exp_f32 v80, v80
    v_cvt_pk_bf16_f32 v32, v76, v77
    v_mfma_f32_16x16x32_bf16 v[68:71], a[216:219], a[148:151], v[68:71]
    v_exp_f32 v82, v82
    v_mfma_f32_16x16x32_bf16 v[68:71], a[220:223], a[152:155], v[68:71]
    s_add_u32 s57, s24, 6016
    v_exp_f32 v67, v67
    v_mfma_f32_16x16x32_bf16 v[76:79], a[220:223], a[176:179], 0
    v_exp_f32 v64, v64
    v_mfma_f32_16x16x32_bf16 v[76:79], a[216:219], a[172:175], v[76:79]
    v_exp_f32 v66, v66
    v_mfma_f32_16x16x32_bf16 v[76:79], a[212:215], a[168:171], v[76:79]
    buffer_store_dwordx4 v[88:91], v103, s[16:19], s56 offen offset:0 nt
    v_exp_f32 v75, v75
    s_waitcnt lgkmcnt(1)
    v_mfma_f32_16x16x32_bf16 v[76:79], a[224:227], a[180:183], v[76:79]
    ds_read_b128 a[212:215], v0 offset:18432
    v_cvt_pk_bf16_f32 v16, v56, v57
    v_mfma_f32_16x16x32_bf16 v[76:79], a[228:231], a[184:187], v[76:79]
    s_waitcnt lgkmcnt(1)
    ds_read_b128 v[88:91], v8 offset:0
    v_fma_f32 v72, v72, s28, v11
    v_mfma_f32_16x16x32_bf16 v[76:79], a[232:235], a[188:191], v[76:79]
    ds_read_b128 v[84:87], v8 offset:5120
    v_fma_f32 v65, v65, s28, v10
    v_mfma_f32_16x16x32_bf16 v[68:71], a[232:235], a[164:167], v[68:71]
    buffer_store_dwordx4 v[96:99], v102, s[16:19], s57 offen offset:0 nt
    s_nop 0
    ds_read_b128 v[96:99], v8 offset:1024
    v_exp_f32 v74, v74
    v_mfma_f32_16x16x32_bf16 v[68:71], a[228:231], a[160:163], v[68:71]
    v_exp_f32 v72, v72
    v_mfma_f32_16x16x32_bf16 v[68:71], a[224:227], a[156:159], v[68:71]
    v_exp_f32 v73, v73
    v_mfma_f32_16x16x32_bf16 v[60:63], a[224:227], a[132:135], v[60:63]
    ds_read_b128 a[216:219], v1 offset:18432
    v_mfma_f32_16x16x32_bf16 v[60:63], a[228:231], a[136:139], v[60:63]
    v_exp_f32 v65, v65
    v_mfma_f32_16x16x32_bf16 v[60:63], a[232:235], a[140:143], v[60:63]
    v_cvt_pk_bf16_f32 v23, v66, v67
    v_cvt_pk_bf16_f32 v29, v74, v75
    v_mfma_f32_16x16x32_bf16 v[52:55], a[232:235], a[116:119], v[52:55]
    ds_read_b128 a[220:223], v0 offset:19456
    v_cvt_pk_bf16_f32 v28, v72, v73
    v_mfma_f32_16x16x32_bf16 v[52:55], a[228:231], a[112:115], v[52:55]
    ds_read_b128 a[232:235], v1 offset:20480
    v_cvt_pk_bf16_f32 v22, v64, v65
    v_mfma_f32_16x16x32_bf16 v[44:47], a[236:239], v[14:17], v[48:51]
    s_add_u32 m0, s38, 22528
    ds_read_b128 a[228:231], v0 offset:20480
    v_cvt_pk_bf16_f32 v35, v82, v83
    v_mfma_f32_16x16x32_bf16 v[52:55], a[224:227], a[108:111], v[52:55]
    ds_read_b128 a[224:227], v1 offset:19456
    v_mfma_f32_16x16x32_bf16 v[44:47], a[240:243], v[20:23], v[44:47]
    v_mfma_f32_16x16x32_bf16 v[44:47], a[244:247], v[26:29], v[44:47]
    s_waitcnt lgkmcnt(5)
    v_cvt_pk_bf16_f32 v34, v80, v81
    v_mfma_f32_16x16x32_bf16 v[56:59], a[212:215], a[96:99], 0
    buffer_load_dwordx4 v6, s[12:15], s25 offen nt lds
    v_mfma_f32_16x16x32_bf16 v[44:47], a[248:251], v[32:35], v[44:47]
    buffer_store_dwordx4 v[84:87], v103, s[16:19], s57 offen offset:0 nt
    s_waitcnt lgkmcnt(4)
    v_mfma_f32_16x16x32_bf16 v[56:59], a[216:219], a[100:103], v[56:59]
    s_add_u32 m0, s38, 23552
    s_waitcnt lgkmcnt(3)
    v_mfma_f32_16x16x32_bf16 v[56:59], a[220:223], a[104:107], v[56:59]
    s_nop 1
    v_cmp_lt_f32 vcc, s29, v44
    v_mfma_f32_16x16x32_bf16 v[64:67], a[220:223], a[128:131], 0
    buffer_load_dwordx4 v7, s[12:15], s25 offen nt lds
    v_mfma_f32_16x16x32_bf16 v[64:67], a[216:219], a[124:127], v[64:67]
    buffer_store_dwordx4 v[88:91], v102, s[16:19], s24 offen offset:0 nt
    s_waitcnt vmcnt(14) lgkmcnt(0)
    s_cbranch_vccnz L_rs_tr44a
L_ret_tr44a:
    s_add_u32 m0, s22, 12288
    v_fma_f32 v60, v60, s28, v10
    v_mfma_f32_16x16x32_bf16 v[64:67], a[212:215], a[120:123], v[64:67]
    s_barrier
    v_mfma_f32_16x16x32_bf16 v[72:75], a[212:215], a[144:147], 0
    buffer_load_dwordx4 v6, s[4:7], s20 offen lds
    v_mfma_f32_16x16x32_bf16 v[72:75], a[216:219], a[148:151], v[72:75]
    s_add_u32 s20, s20, 128
    s_add_u32 m0, s22, 13312
    v_fma_f32 v52, v52, s28, v9
    v_mfma_f32_16x16x32_bf16 v[72:75], a[220:223], a[152:155], v[72:75]
    buffer_load_dwordx4 v6, s[4:7], s20 offen lds
    v_mfma_f32_16x16x32_bf16 v[80:83], a[220:223], a[176:179], 0
    v_exp_f32 v52, v52
    v_mfma_f32_16x16x32_bf16 v[80:83], a[216:219], a[172:175], v[80:83]
    s_add_u32 s20, s20, 128
    v_fma_f32 v54, v54, s28, v9
    s_add_u32 m0, s22, 14336
    v_mfma_f32_16x16x32_bf16 v[80:83], a[212:215], a[168:171], v[80:83]
    buffer_load_dwordx4 v6, s[4:7], s20 offen lds
    v_mfma_f32_16x16x32_bf16 v[80:83], a[224:227], a[180:183], v[80:83]
    ds_read_b64_tr_b16 a[212:213], v2 offset:0
    v_fma_f32 v53, v53, s28, v9
    v_mfma_f32_16x16x32_bf16 v[80:83], a[228:231], a[184:187], v[80:83]
    ds_read_b64_tr_b16 a[214:215], v2 offset:6144
    v_fma_f32 v61, v61, s28, v10
    v_mfma_f32_16x16x32_bf16 v[80:83], a[232:235], a[188:191], v[80:83]
    v_exp_f32 v53, v53
    v_mfma_f32_16x16x32_bf16 v[72:75], a[232:235], a[164:167], v[72:75]
    v_exp_f32 v60, v60
    v_mfma_f32_16x16x32_bf16 v[72:75], a[228:231], a[160:163], v[72:75]
    ds_read_b64_tr_b16 a[216:217], v3 offset:0
    v_fma_f32 v55, v55, s28, v9
    v_mfma_f32_16x16x32_bf16 v[72:75], a[224:227], a[156:159], v[72:75]
    ds_read_b64_tr_b16 a[218:219], v3 offset:6144
    v_mfma_f32_16x16x32_bf16 v[64:67], a[224:227], a[132:135], v[64:67]
    v_exp_f32 v61, v61
    v_mfma_f32_16x16x32_bf16 v[64:67], a[228:231], a[136:139], v[64:67]
    ds_read_b64_tr_b16 a[220:221], v4 offset:0
    v_cvt_pk_bf16_f32 v24, v60, v61
    v_mfma_f32_16x16x32_bf16 v[64:67], a[232:235], a[140:143], v[64:67]
    v_exp_f32 v54, v54
    v_mfma_f32_16x16x32_bf16 v[56:59], a[232:235], a[116:119], v[56:59]
    buffer_store_dwordx4 v[96:99], v103, s[16:19], s24 offen offset:0 nt
    v_cvt_pk_bf16_f32 v18, v52, v53
    v_exp_f32 v55, v55
    v_mfma_f32_16x16x32_bf16 v[56:59], a[228:231], a[112:115], v[56:59]
    ds_read_b64_tr_b16 a[222:223], v4 offset:6144
    v_cvt_pk_bf16_f32 v19, v54, v55
    v_mfma_f32_16x16x32_bf16 v[56:59], a[224:227], a[108:111], v[56:59]
    s_add_u32 s20, s20, 12032
    ds_read_b64_tr_b16 a[224:225], v5 offset:0
    ds_read_b64_tr_b16 a[226:227], v5 offset:6144
    s_waitcnt lgkmcnt(6)
    v_mfma_f32_16x16x32_bf16 v[112:115], a[212:215], v[14:17], v[112:115]
    ds_read_b64_tr_b16 a[230:231], v2 offset:7168
    v_lshrrev_b32 v105, 11, v0
    v_and_b32 v104, 0x3ff, v0
    v_mfma_f32_16x16x32_bf16 v[160:163], a[212:215], v[20:23], v[160:163]
    v_fma_f32 v71, v71, s28, v11
    v_fma_f32 v56, v56, s28, v9
    v_xor_b32 v105, s65, v105
    v_mfma_f32_16x16x32_bf16 v[208:211], a[212:215], v[26:29], v[208:211]
    ds_read_b64_tr_b16 a[228:229], v2 offset:1024
    v_lshl_add_u32 v104, v105, 10, v104
    v_mfma_f32_16x16x32_bf16 a[0:3], a[212:215], v[32:35], a[0:3]
    s_waitcnt lgkmcnt(6)
    v_add_u32 v104, s38, v104
    v_fma_f32 v77, v77, s28, v12
    v_mfma_f32_16x16x32_bf16 a[4:7], a[216:219], v[32:35], a[4:7]
    v_exp_f32 v71, v71
    v_mfma_f32_16x16x32_bf16 v[212:215], a[216:219], v[26:29], v[212:215]
    ds_read_b64_tr_b16 a[212:213], v4 offset:1024
    v_fma_f32 v63, v63, s28, v10
    v_mfma_f32_16x16x32_bf16 v[164:167], a[216:219], v[20:23], v[164:167]
    ds_read_b64_tr_b16 a[232:233], v3 offset:1024
    v_fma_f32 v70, v70, s28, v11
    v_mfma_f32_16x16x32_bf16 v[116:119], a[216:219], v[14:17], v[116:119]
    s_waitcnt lgkmcnt(6)
    ds_read_b64_tr_b16 a[234:235], v3 offset:7168
    v_fma_f32 v79, v79, s28, v12
    v_mfma_f32_16x16x32_bf16 v[120:123], a[220:223], v[14:17], v[120:123]
    ds_read_b64_tr_b16 a[218:219], v5 offset:7168
    v_fma_f32 v72, v72, s28, v11
    v_mfma_f32_16x16x32_bf16 v[168:171], a[220:223], v[20:23], v[168:171]
    ds_read_b128 a[120:123], v104 offset:6144
    v_fma_f32 v66, v66, s28, v10
    v_mfma_f32_16x16x32_bf16 v[216:219], a[220:223], v[26:29], v[216:219]
    v_exp_f32 v70, v70
    v_mfma_f32_16x16x32_bf16 a[8:11], a[220:223], v[32:35], a[8:11]
    s_waitcnt lgkmcnt(6)
    ds_read_b64_tr_b16 a[214:215], v4 offset:7168
    v_fma_f32 v78, v78, s28, v12
    v_mfma_f32_16x16x32_bf16 a[12:15], a[224:227], v[32:35], a[12:15]
    ds_read_b64_tr_b16 a[220:221], v2 offset:2048
    v_fma_f32 v65, v65, s28, v10
    v_mfma_f32_16x16x32_bf16 v[220:223], a[224:227], v[26:29], v[220:223]
    ds_read_b128 a[104:107], v104 offset:2048
    v_fma_f32 v58, v58, s28, v9
    v_mfma_f32_16x16x32_bf16 v[172:175], a[224:227], v[20:23], v[172:175]
    ds_read_b64_tr_b16 a[222:223], v2 offset:8192
    v_fma_f32 v57, v57, s28, v9
    v_mfma_f32_16x16x32_bf16 v[124:127], a[224:227], v[14:17], v[124:127]
    s_waitcnt lgkmcnt(8)
    ds_read_b64_tr_b16 a[216:217], v5 offset:1024
    v_fma_f32 v67, v67, s28, v10
    v_mfma_f32_16x16x32_bf16 v[128:131], a[228:231], v[14:17], v[128:131]
    ds_read_b64_tr_b16 a[224:225], v3 offset:2048
    v_xor_b32 v105, 64, v104
    v_mfma_f32_16x16x32_bf16 v[176:179], a[228:231], v[20:23], v[176:179]
    v_exp_f32 v79, v79
    v_mfma_f32_16x16x32_bf16 v[224:227], a[228:231], v[26:29], v[224:227]
    v_exp_f32 v78, v78
    v_mfma_f32_16x16x32_bf16 a[16:19], a[228:231], v[32:35], a[16:19]
    s_waitcnt lgkmcnt(6)
    ds_read_b64_tr_b16 a[230:231], v4 offset:8192
    v_fma_f32 v76, v76, s28, v12
    v_mfma_f32_16x16x32_bf16 a[20:23], a[232:235], v[32:35], a[20:23]
    ds_read_b64_tr_b16 a[226:227], v3 offset:8192
    v_fma_f32 v83, v83, s28, v12
    v_mfma_f32_16x16x32_bf16 v[228:231], a[232:235], v[26:29], v[228:231]
    ds_read_b128 a[132:135], v105 offset:8192
    v_fma_f32 v59, v59, s28, v9
    v_mfma_f32_16x16x32_bf16 v[180:183], a[232:235], v[20:23], v[180:183]
    ds_read_b64_tr_b16 a[228:229], v4 offset:2048
    v_fma_f32 v68, v68, s28, v11
    v_mfma_f32_16x16x32_bf16 v[132:135], a[232:235], v[14:17], v[132:135]
    s_waitcnt lgkmcnt(7)
    ds_read_b64_tr_b16 a[232:233], v5 offset:2048
    v_fma_f32 v62, v62, s28, v10
    v_mfma_f32_16x16x32_bf16 v[136:139], a[212:215], v[14:17], v[136:139]
    ds_read_b64_tr_b16 a[234:235], v5 offset:8192
    v_cvt_pk_bf16_f32 v31, v70, v71
    v_mfma_f32_16x16x32_bf16 v[184:187], a[212:215], v[20:23], v[184:187]
    ds_read_b128 a[124:127], v105 offset:6144
    v_fma_f32 v64, v64, s28, v10
    v_mfma_f32_16x16x32_bf16 v[232:235], a[212:215], v[26:29], v[232:235]
    ds_read_b128 a[128:131], v104 offset:8192
    v_fma_f32 v75, v75, s28, v11
    v_mfma_f32_16x16x32_bf16 a[24:27], a[212:215], v[32:35], a[24:27]
    s_waitcnt lgkmcnt(8)
    ds_read_b128 a[168:171], v104 offset:18432
    v_fma_f32 v69, v69, s28, v11
    v_mfma_f32_16x16x32_bf16 a[28:31], a[216:219], v[32:35], a[28:31]
    ds_read_b128 a[144:147], v104 offset:12288
    v_fma_f32 v82, v82, s28, v12
    v_mfma_f32_16x16x32_bf16 v[236:239], a[216:219], v[26:29], v[236:239]
    s_add_u32 s39, s39, 12288
    v_exp_f32 v77, v77
    v_mfma_f32_16x16x32_bf16 v[188:191], a[216:219], v[20:23], v[188:191]
    ds_read_b128 a[172:175], v105 offset:18432
    v_exp_f32 v62, v62
    v_exp_f32 v76, v76
    v_mfma_f32_16x16x32_bf16 v[140:143], a[216:219], v[14:17], v[140:143]
    ds_read_b128 a[96:99], v104 offset:0
    v_exp_f32 v82, v82
    v_mfma_f32_16x16x32_bf16 v[144:147], a[220:223], v[14:17], v[144:147]
    ds_read_b128 a[148:151], v105 offset:12288
    v_fma_f32 v73, v73, s28, v11
    v_mfma_f32_16x16x32_bf16 v[192:195], a[220:223], v[20:23], v[192:195]
    s_waitcnt vmcnt(14) lgkmcnt(7)
    v_exp_f32 v69, v69
    v_mfma_f32_16x16x32_bf16 v[240:243], a[220:223], v[26:29], v[240:243]
    s_barrier
    v_mfma_f32_16x16x32_bf16 a[32:35], a[220:223], v[32:35], a[32:35]
    s_add_u32 s21, s21, s62
    ds_read_b128 a[100:103], v105 offset:0
    v_cvt_pk_bf16_f32 v36, v76, v77
    v_mfma_f32_16x16x32_bf16 a[36:39], a[224:227], v[32:35], a[36:39]
    s_add_u32 m0, s22, 24576
    ds_read_b128 a[212:215], v0 offset:0
    buffer_load_dwordx4 v6, s[8:11], s21 offen lds
    v_mfma_f32_16x16x32_bf16 v[244:247], a[224:227], v[26:29], v[244:247]
    s_add_u32 s21, s21, 128
    ds_read_b128 a[220:223], v0 offset:1024
    v_exp_f32 v68, v68
    v_mfma_f32_16x16x32_bf16 v[196:199], a[224:227], v[20:23], v[196:199]
    s_add_u32 m0, s22, 25600
    v_exp_f32 v73, v73
    v_mfma_f32_16x16x32_bf16 v[148:151], a[224:227], v[14:17], v[148:151]
    buffer_load_dwordx4 v6, s[8:11], s21 offen lds
    ds_read_b128 a[216:219], v1 offset:0
    v_mfma_f32_16x16x32_bf16 v[152:155], a[228:231], v[14:17], v[152:155]
    s_add_u32 s21, s21, 128
    v_exp_f32 v59, v59
    v_mfma_f32_16x16x32_bf16 v[200:203], a[228:231], v[20:23], v[200:203]
    s_add_u32 m0, s22, 26624
    ds_read_b128 a[176:179], v104 offset:20480
    v_cvt_pk_bf16_f32 v37, v78, v79
    v_mfma_f32_16x16x32_bf16 v[248:251], a[228:231], v[26:29], v[248:251]
    buffer_load_dwordx4 v6, s[8:11], s21 offen lds
    v_mfma_f32_16x16x32_bf16 a[40:43], a[228:231], v[32:35], a[40:43]
    ds_read_b128 a[152:155], v104 offset:14336
    v_exp_f32 v63, v63
    v_mfma_f32_16x16x32_bf16 a[44:47], a[232:235], v[32:35], a[44:47]
    v_exp_f32 v66, v66
    v_mfma_f32_16x16x32_bf16 v[252:255], a[232:235], v[26:29], v[252:255]
    ds_read_b128 a[228:231], v0 offset:6144
    v_fma_f32 v74, v74, s28, v11
    v_mfma_f32_16x16x32_bf16 v[204:207], a[232:235], v[20:23], v[204:207]
    ds_read_b128 a[156:159], v105 offset:14336
    v_fma_f32 v81, v81, s28, v12
    v_mfma_f32_16x16x32_bf16 v[156:159], a[232:235], v[14:17], v[156:159]
    s_waitcnt lgkmcnt(5)
    ds_read_b128 a[180:183], v105 offset:20480
    v_exp_f32 v57, v57
    v_mfma_f32_16x16x32_bf16 v[52:55], a[212:215], a[96:99], 0
    ds_read_b128 a[224:227], v1 offset:1024
    v_cvt_pk_bf16_f32 v25, v62, v63
    v_mfma_f32_16x16x32_bf16 v[60:63], a[212:215], a[120:123], 0
    ds_read_b128 a[108:111], v105 offset:2048
    v_cvt_pk_bf16_f32 v30, v68, v69
    v_mfma_f32_16x16x32_bf16 v[68:71], a[212:215], a[144:147], 0
    v_exp_f32 v83, v83
    v_mfma_f32_16x16x32_bf16 v[76:79], a[212:215], a[168:171], 0
    s_waitcnt lgkmcnt(6)
    v_exp_f32 v65, v65
    v_mfma_f32_16x16x32_bf16 v[52:55], a[216:219], a[100:103], v[52:55]
    s_add_u32 s21, s21, 12032
    v_cvt_pk_bf16_f32 v35, v82, v83
    v_exp_f32 v56, v56
    v_mfma_f32_16x16x32_bf16 v[60:63], a[216:219], a[124:127], v[60:63]
    v_exp_f32 v67, v67
    v_mfma_f32_16x16x32_bf16 v[68:71], a[216:219], a[148:151], v[68:71]
    v_exp_f32 v72, v72
    v_mfma_f32_16x16x32_bf16 v[76:79], a[216:219], a[172:175], v[76:79]
    v_exp_f32 v75, v75
    v_mfma_f32_16x16x32_bf16 v[52:55], a[220:223], a[104:107], v[52:55]
    v_exp_f32 v74, v74
    v_mfma_f32_16x16x32_bf16 v[60:63], a[220:223], a[128:131], v[60:63]
    s_waitcnt lgkmcnt(2)
    ds_read_b128 a[232:235], v1 offset:6144
    v_cvt_pk_bf16_f32 v28, v72, v73
    v_mfma_f32_16x16x32_bf16 v[68:71], a[220:223], a[152:155], v[68:71]
    ds_read_b128 a[216:219], v1 offset:7168
    v_exp_f32 v81, v81
    v_mfma_f32_16x16x32_bf16 v[76:79], a[220:223], a[176:179], v[76:79]
    s_waitcnt lgkmcnt(2)
    v_exp_f32 v58, v58
    v_mfma_f32_16x16x32_bf16 v[52:55], a[224:227], a[108:111], v[52:55]
    ds_read_b128 a[212:215], v0 offset:7168
    v_cvt_pk_bf16_f32 v16, v56, v57
    v_mfma_f32_16x16x32_bf16 v[60:63], a[224:227], a[132:135], v[60:63]
    v_cvt_pk_bf16_f32 v29, v74, v75
    v_cvt_pk_bf16_f32 v23, v66, v67
    v_mfma_f32_16x16x32_bf16 v[68:71], a[224:227], a[156:159], v[68:71]
    v_exp_f32 v64, v64
    v_mfma_f32_16x16x32_bf16 v[76:79], a[224:227], a[180:183], v[76:79]
    ds_read_b128 a[220:223], v0 offset:2048
    v_cvt_pk_bf16_f32 v17, v58, v59
    v_mfma_f32_16x16x32_bf16 v[56:59], a[228:231], a[96:99], 0
    v_fma_f32 v80, v80, s28, v12
    v_cvt_pk_bf16_f32 v22, v64, v65
    v_mfma_f32_16x16x32_bf16 v[64:67], a[228:231], a[120:123], 0
    v_exp_f32 v80, v80
    v_mfma_f32_16x16x32_bf16 v[72:75], a[228:231], a[144:147], 0
    ds_read_b128 a[112:115], v104 offset:4096
    v_cvt_pk_bf16_f32 v34, v80, v81
    v_mfma_f32_16x16x32_bf16 v[80:83], a[228:231], a[168:171], 0
    s_waitcnt lgkmcnt(4)
    ds_read_b128 a[160:163], v104 offset:16384
    v_mfma_f32_16x16x32_bf16 v[56:59], a[232:235], a[100:103], v[56:59]
    ds_read_b128 a[228:231], v0 offset:8192
    s_waitcnt vmcnt(8)
    v_mfma_f32_16x16x32_bf16 v[64:67], a[232:235], a[124:127], v[64:67]
    ds_read_b128 a[224:227], v1 offset:2048
    v_mfma_f32_16x16x32_bf16 v[72:75], a[232:235], a[148:151], v[72:75]
    ds_read_b128 a[136:139], v104 offset:10240
    v_mfma_f32_16x16x32_bf16 v[80:83], a[232:235], a[172:175], v[80:83]
    ds_read_b128 a[232:235], v1 offset:8192
    v_mfma_f32_16x16x32_bf16 v[48:51], a[236:239], v[16:19], v[44:47]
    v_mfma_f32_16x16x32_bf16 v[48:51], a[240:243], v[22:25], v[48:51]
    ds_read_b128 a[164:167], v105 offset:16384
    v_mfma_f32_16x16x32_bf16 v[48:51], a[244:247], v[28:31], v[48:51]
    ds_read_b128 a[188:191], v105 offset:22528
    v_mfma_f32_16x16x32_bf16 v[48:51], a[248:251], v[34:37], v[48:51]
    s_waitcnt lgkmcnt(8)
    ds_read_b128 a[140:143], v105 offset:10240
    v_mfma_f32_16x16x32_bf16 v[56:59], a[212:215], a[104:107], v[56:59]
    ds_read_b128 a[116:119], v105 offset:4096
    v_mfma_f32_16x16x32_bf16 v[64:67], a[212:215], a[128:131], v[64:67]
    ds_read_b128 a[184:187], v104 offset:22528
    v_mfma_f32_16x16x32_bf16 v[72:75], a[212:215], a[152:155], v[72:75]
    v_mfma_f32_16x16x32_bf16 v[80:83], a[212:215], a[176:179], v[80:83]
    v_cmp_lt_f32 vcc, s29, v48
    v_mfma_f32_16x16x32_bf16 v[56:59], a[216:219], a[108:111], v[56:59]
    s_waitcnt vmcnt(14) lgkmcnt(5)
    v_mfma_f32_16x16x32_bf16 v[64:67], a[216:219], a[132:135], v[64:67]
    s_barrier
    v_mfma_f32_16x16x32_bf16 v[72:75], a[216:219], a[156:159], v[72:75]
    s_cbranch_vccnz L_rs_tr44b
L_ret_tr44b:
    s_add_u32 m0, s22, 0
    v_mfma_f32_16x16x32_bf16 v[80:83], a[216:219], a[180:183], v[80:83]
    buffer_load_dwordx4 v6, s[4:7], s20 offen lds
    v_mfma_f32_16x16x32_bf16 v[52:55], a[220:223], a[112:115], v[52:55]
    s_add_u32 s20, s20, 128
    s_add_u32 m0, s22, 1024
    v_mfma_f32_16x16x32_bf16 v[60:63], a[220:223], a[136:139], v[60:63]
    buffer_load_dwordx4 v6, s[4:7], s20 offen lds
    v_mfma_f32_16x16x32_bf16 v[68:71], a[220:223], a[160:163], v[68:71]
    ds_read_b64_tr_b16 a[212:213], v2 offset:18432
    s_waitcnt lgkmcnt(1)
    v_mfma_f32_16x16x32_bf16 v[76:79], a[220:223], a[184:187], v[76:79]
    s_add_u32 s20, s20, 128
    s_add_u32 m0, s22, 2048
    ds_read_b64_tr_b16 a[214:215], v2 offset:12288
    v_mfma_f32_16x16x32_bf16 v[52:55], a[224:227], a[116:119], v[52:55]
    v_mfma_f32_16x16x32_bf16 v[60:63], a[224:227], a[140:143], v[60:63]
    buffer_load_dwordx4 v6, s[4:7], s20 offen lds
    v_mfma_f32_16x16x32_bf16 v[68:71], a[224:227], a[164:167], v[68:71]
    v_mfma_f32_16x16x32_bf16 v[76:79], a[224:227], a[188:191], v[76:79]
    ds_read_b64_tr_b16 a[216:217], v3 offset:18432
    v_mfma_f32_16x16x32_bf16 v[56:59], a[228:231], a[112:115], v[56:59]
    v_mfma_f32_16x16x32_bf16 v[64:67], a[228:231], a[136:139], v[64:67]
    ds_read_b64_tr_b16 a[218:219], v3 offset:12288
    v_mfma_f32_16x16x32_bf16 v[72:75], a[228:231], a[160:163], v[72:75]
    ds_read_b64_tr_b16 a[220:221], v4 offset:18432
    v_mfma_f32_16x16x32_bf16 v[80:83], a[228:231], a[184:187], v[80:83]
    v_mfma_f32_16x16x32_bf16 v[56:59], a[232:235], a[116:119], v[56:59]
    v_mfma_f32_16x16x32_bf16 v[64:67], a[232:235], a[140:143], v[64:67]
    s_add_u32 s20, s20, 12032
    ds_read_b64_tr_b16 a[222:223], v4 offset:12288
    v_mfma_f32_16x16x32_bf16 v[72:75], a[232:235], a[164:167], v[72:75]
    ds_read_b64_tr_b16 a[224:225], v5 offset:18432
    v_mfma_f32_16x16x32_bf16 v[80:83], a[232:235], a[188:191], v[80:83]
    ds_read_b64_tr_b16 a[226:227], v5 offset:12288
    v_max3_f32 v96, v52, v53, v54
    v_max3_f32 v96, v96, v55, v56
    v_rcp_f32 v50, v50
    v_max3_f32 v96, v96, v57, v58
    v_max_f32 v96, v96, v59
    v_rcp_f32 v49, v49
    v_mov_b32 v97, v96
    s_waitcnt lgkmcnt(6)
    v_mfma_f32_16x16x32_bf16 v[112:115], a[212:215], v[16:19], v[112:115]
    s_mov_b32 s67, s34
    v_permlane32_swap_b32 v97, v96
    v_max_f32 v96, v96, v97
    v_mov_b32 v97, v96
    v_mbcnt_lo_u32_b32 v104, -1, 0
    v_mfma_f32_16x16x32_bf16 v[160:163], a[212:215], v[22:25], v[160:163]
    s_add_u32 s18, s34, 24576
    ds_read_b64_tr_b16 a[234:235], v3 offset:13312
    v_permlane16_swap_b32 v97, v96
    v_max_f32 v96, v96, v97
    v_mul_f32_e64 v9, -s28, v96
    v_max3_f32 v96, v60, v61, v62
    v_max3_f32 v96, v96, v63, v64
    v_max3_f32 v96, v96, v65, v66
    v_max_f32 v96, v96, v67
    v_mfma_f32_16x16x32_bf16 v[208:211], a[212:215], v[28:31], v[208:211]
    s_mov_b32 s34, s33
    ds_read_b64_tr_b16 a[228:229], v2 offset:19456
    v_mov_b32 v97, v96
    v_mbcnt_hi_u32_b32 v104, -1, v104
    v_mul_f32 v162, v162, v49
    v_mfma_f32_16x16x32_bf16 a[0:3], a[212:215], v[34:37], a[0:3]
    s_waitcnt lgkmcnt(4)
    ds_read_b64_tr_b16 a[230:231], v2 offset:13312
    v_permlane32_swap_b32 v97, v96
    v_mfma_f32_16x16x32_bf16 a[4:7], a[216:219], v[34:37], a[4:7]
    s_add_u32 s64, s64, s62
    ds_read_b64_tr_b16 a[214:215], v4 offset:13312
    v_rcp_f32 v51, v51
    v_mul_f32 v163, v163, v49
    v_max_f32 v96, v96, v97
    v_mov_b32 v97, v96
    v_mfma_f32_16x16x32_bf16 v[212:215], a[216:219], v[28:31], v[212:215]
    s_add_u32 s64, s64, 196608
    v_permlane16_swap_b32 v97, v96
    v_max_f32 v96, v96, v97
    v_mul_f32_e64 v10, -s28, v96
    v_max3_f32 v96, v68, v69, v70
    v_mfma_f32_16x16x32_bf16 v[164:167], a[216:219], v[22:25], v[164:167]
    s_mov_b32 s39, s64
    ds_read_b64_tr_b16 a[212:213], v4 offset:19456
    v_and_b32 v107, 3, v104
    v_lshrrev_b32 v106, 5, v104
    v_mfma_f32_16x16x32_bf16 v[116:119], a[216:219], v[16:19], v[116:119]
    s_add_u32 s37, s37, 1
    ds_read_b64_tr_b16 a[216:217], v5 offset:19456
    v_max3_f32 v96, v96, v71, v72
    v_mfma_f32_16x16x32_bf16 v[120:123], a[220:223], v[16:19], v[120:123]
    s_bitcmp1_b32 s63, s37
    v_fma_f32 v52, v52, s28, v9
    v_fma_f32 v60, v60, s28, v10
    v_mfma_f32_16x16x32_bf16 v[168:171], a[220:223], v[22:25], v[168:171]
    s_cselect_b32 s62, 4294770688, 0
    ds_read_b64_tr_b16 a[218:219], v5 offset:13312
    v_max3_f32 v96, v96, v73, v74
    v_fma_f32 v61, v61, s28, v10
    v_bfe_u32 v105, v104, 3, 1
    v_max_f32 v96, v96, v75
    v_mov_b32 v97, v96
    v_mfma_f32_16x16x32_bf16 v[216:219], a[220:223], v[28:31], v[216:219]
    s_cselect_b32 s42, 0, 325632
    v_permlane32_swap_b32 v97, v96
    v_max_f32 v96, v96, v97
    v_mov_b32 v97, v96
    v_xor_b32 v106, v106, v105
    v_mov_b32 v100, v48
    v_fma_f32 v63, v63, s28, v10
    v_mfma_f32_16x16x32_bf16 a[8:11], a[220:223], v[34:37], a[8:11]
    s_waitcnt lgkmcnt(3)
    ds_read_b64_tr_b16 a[232:233], v3 offset:19456
    v_exp_f32 v60, v60
    v_mfma_f32_16x16x32_bf16 a[12:15], a[224:227], v[34:37], a[12:15]
    s_add_u32 s35, s35, s42
    v_permlane16_swap_b32 v97, v96
    v_mfma_f32_16x16x32_bf16 v[220:223], a[224:227], v[28:31], v[220:223]
    s_lshl_b32 s42, s37, 1
    v_max_f32 v96, v96, v97
    v_xor_b32 v105, s65, v105
    v_mul_f32_e64 v11, -s28, v96
    v_fma_f32 v74, v74, s28, v11
    v_mfma_f32_16x16x32_bf16 v[172:175], a[224:227], v[22:25], v[172:175]
    s_lshr_b32 s42, s31, s42
    v_fma_f32 v71, v71, s28, v11
    v_fma_f32 v70, v70, s28, v11
    v_mfma_f32_16x16x32_bf16 v[124:127], a[224:227], v[16:19], v[124:127]
    s_and_b32 s42, s42, 3
    ds_read_b64_tr_b16 a[220:221], v2 offset:20480
    v_fma_f32 v62, v62, s28, v10
    v_max3_f32 v96, v76, v77, v78
    v_max3_f32 v96, v96, v79, v80
    v_fma_f32 v69, v69, s28, v11
    v_mfma_f32_16x16x32_bf16 v[128:131], a[228:231], v[16:19], v[128:131]
    s_add_u32 s42, s42, s36
    v_fma_f32 v64, v64, s28, v10
    v_mul_f32 v170, v170, v49
    v_fma_f32 v54, v54, s28, v9
    v_mfma_f32_16x16x32_bf16 v[176:179], a[228:231], v[22:25], v[176:179]
    s_sub_u32 s43, s42, 3
    v_exp_f32 v61, v61
    v_mul_f32 v172, v172, v49
    v_exp_f32 v64, v64
    v_mfma_f32_16x16x32_bf16 v[224:227], a[228:231], v[28:31], v[224:227]
    s_cmp_ge_u32 s42, 3
    v_cvt_pk_bf16_f32 v20, v60, v61
    v_exp_f32 v63, v63
    v_mfma_f32_16x16x32_bf16 a[16:19], a[228:231], v[34:37], a[16:19]
    s_waitcnt lgkmcnt(1)
    ds_read_b64_tr_b16 a[226:227], v3 offset:14336
    v_fma_f32 v73, v73, s28, v11
    v_mfma_f32_16x16x32_bf16 a[20:23], a[232:235], v[34:37], a[20:23]
    s_cselect_b32 s42, s43, s42
    ds_read_b64_tr_b16 a[224:225], v3 offset:20480
    v_accvgpr_read_b32 v109, a5
    v_exp_f32 v70, v70
    v_lshl_or_b32 v106, v107, 1, v106
    v_mfma_f32_16x16x32_bf16 v[228:231], a[232:235], v[28:31], v[228:231]
    s_mul_i32 s44, s3, 5
    ds_read_b64_tr_b16 a[222:223], v2 offset:14336
    v_accvgpr_read_b32 v111, a7
    s_mov_b32 s32, 1
    v_exp_f32 v54, v54
    v_mfma_f32_16x16x32_bf16 v[180:183], a[232:235], v[22:25], v[180:183]
    s_lshl_b32 s43, s3, 2
    v_exp_f32 v71, v71
    v_fma_f32 v59, v59, s28, v9
    v_mul_f32 v175, v175, v49
    v_lshl_add_u32 v101, v105, 10, s38
    v_max3_f32 v96, v96, v81, v82
    v_mfma_f32_16x16x32_bf16 v[132:135], a[232:235], v[16:19], v[132:135]
    s_add_u32 s45, s43, 21
    v_max_f32 v96, v96, v83
    v_mov_b32 v97, v96
    v_mfma_f32_16x16x32_bf16 v[136:139], a[212:215], v[16:19], v[136:139]
    s_cmp_eq_u32 s3, 0
    v_fma_f32 v57, v57, s28, v9
    v_fma_f32 v65, v65, s28, v10
    v_mul_f32 v109, v109, v51
    v_and_b32 v107, 7, v104
    v_mfma_f32_16x16x32_bf16 v[184:187], a[212:215], v[22:25], v[184:187]
    s_cselect_b32 s45, 20, s45
    v_permlane32_swap_b32 v97, v96
    v_mfma_f32_16x16x32_bf16 v[232:235], a[212:215], v[28:31], v[232:235]
    s_cselect_b32 s33, 1, 0
    ds_read_b64_tr_b16 a[232:233], v5 offset:20480
    v_max_f32 v96, v96, v97
    v_mfma_f32_16x16x32_bf16 a[24:27], a[212:215], v[34:37], a[24:27]
    s_cmp_eq_u32 s42, 1
    v_lshl_add_u32 v101, v106, 4, v101
    v_mul_f32 v169, v169, v49
    v_mov_b32 v97, v96
    v_mfma_f32_16x16x32_bf16 a[28:31], a[216:219], v[34:37], a[28:31]
    s_cselect_b32 s44, s45, s44
    ds_read_b64_tr_b16 a[228:229], v4 offset:20480
    v_exp_f32 v62, v62
    v_permlane16_swap_b32 v97, v96
    v_mfma_f32_16x16x32_bf16 v[236:239], a[216:219], v[28:31], v[236:239]
    s_cselect_b32 s32, s33, s32
    ds_read_b64_tr_b16 a[230:231], v4 offset:14336
    v_fma_f32 v53, v53, s28, v9
    v_accvgpr_read_b32 v106, a2
    v_accvgpr_read_b32 v108, a4
    v_max_f32 v96, v96, v97
    v_mfma_f32_16x16x32_bf16 v[188:191], a[216:219], v[22:25], v[188:191]
    s_add_u32 s45, s43, 37
    s_cmp_eq_u32 s42, 2
    s_cselect_b32 s44, s45, s44
    v_mfma_f32_16x16x32_bf16 v[140:143], a[216:219], v[16:19], v[140:143]
    s_cselect_b32 s32, 0, s32
    ds_read_b64_tr_b16 a[234:235], v5 offset:14336
    s_waitcnt lgkmcnt(4)
    v_mfma_f32_16x16x32_bf16 v[144:147], a[220:223], v[16:19], v[144:147]
    s_mul_i32 s44, s44, 6144
    v_exp_f32 v53, v53
    v_mfma_f32_16x16x32_bf16 v[192:195], a[220:223], v[22:25], v[192:195]
    s_add_u32 s33, s35, s44
    v_lshl_add_u32 v101, v107, 7, v101
    v_fma_f32 v68, v68, s28, v11
    v_mfma_f32_16x16x32_bf16 v[240:243], a[220:223], v[28:31], v[240:243]
    s_mul_i32 s42, s32, 6144
    s_add_u32 s42, s42, 24576
    v_mul_f32 v161, v161, v49
    v_fma_f32 v56, v56, s28, v9
    s_add_u32 s42, s42, s33
    v_mfma_f32_16x16x32_bf16 a[32:35], a[220:223], v[34:37], a[32:35]
    s_cmp_ge_u32 s37, 6
    v_accvgpr_read_b32 v105, a1
    s_cselect_b32 s14, 0, s42
    v_fma_f32 v55, v55, s28, v9
    v_mul_f32_e64 v12, -s28, v96
    v_exp_f32 v65, v65
    v_mfma_f32_16x16x32_bf16 a[36:39], a[224:227], v[34:37], a[36:39]
    s_add_u32 s24, s67, 6400
    s_add_u32 s25, s33, 6400
    v_mul_f32 v173, v173, v49
    v_mfma_f32_16x16x32_bf16 v[244:247], a[224:227], v[28:31], v[244:247]
    s_add_u32 s23, s38, 10240
    v_fma_f32 v79, v79, s28, v12
    v_mul_f32 v160, v160, v49
    v_mfma_f32_16x16x32_bf16 v[196:199], a[224:227], v[22:25], v[196:199]
    s_mov_b32 s27, 0x49249249
    v_exp_f32 v55, v55
    v_mfma_f32_16x16x32_bf16 v[148:151], a[224:227], v[16:19], v[148:151]
    s_mov_b32 s30, 0
    v_cvt_pk_bf16_f32 v172, v172, v173
    s_waitcnt vmcnt(7) lgkmcnt(0)
    v_mfma_f32_16x16x32_bf16 v[152:155], a[228:231], v[16:19], v[152:155]
    s_barrier
    v_mfma_f32_16x16x32_bf16 v[200:203], a[228:231], v[22:25], v[200:203]
    v_permlane32_swap_b32 v48, v100
    v_fma_f32 v78, v78, s28, v12
    v_exp_f32 v52, v52
    v_mfma_f32_16x16x32_bf16 v[248:251], a[228:231], v[28:31], v[248:251]
    ds_read_b128 a[212:215], v0 offset:12288
    v_exp_f32 v57, v57
    v_mul_f32 v168, v168, v49
    v_mfma_f32_16x16x32_bf16 a[40:43], a[228:231], v[34:37], a[40:43]
    ds_read_b128 a[220:223], v0 offset:13312
    v_bfe_u32 v107, v104, 4, 1
    v_fma_f32 v58, v58, s28, v9
    v_mfma_f32_16x16x32_bf16 a[44:47], a[232:235], v[34:37], a[44:47]
    ds_read_b128 a[216:219], v1 offset:12288
    v_exp_f32 v69, v69
    v_cvt_pk_bf16_f32 v14, v52, v53
    v_fma_f32 v81, v81, s28, v12
    v_cvt_pk_bf16_f32 v15, v54, v55
    v_mul_f32 v191, v191, v49
    v_mul_f32 v196, v196, v49
    v_mul_f32 v105, v105, v51
    v_mul_f32 v182, v182, v49
    v_mfma_f32_16x16x32_bf16 v[252:255], a[232:235], v[28:31], v[252:255]
    v_exp_f32 v68, v68
    v_fma_f32 v67, v67, s28, v10
    v_rcp_f32 v48, v48
    v_lshl_add_u32 v101, v107, 3, v101
    v_fma_f32 v82, v82, s28, v12
    v_fma_f32 v77, v77, s28, v12
    v_cvt_pk_bf16_f32 v160, v160, v161
    v_subrev_u32 v8, 22528, v8
    v_mul_f32 v166, v166, v49
    v_exp_f32 v81, v81
    v_fma_f32 v80, v80, s28, v12
    v_exp_f32 v56, v56
    v_accvgpr_read_b32 v107, a3
    v_mfma_f32_16x16x32_bf16 v[204:207], a[232:235], v[22:25], v[204:207]
    v_fma_f32 v66, v66, s28, v10
    v_cvt_pk_bf16_f32 v27, v70, v71
    v_mul_f32 v197, v197, v49
    v_exp_f32 v79, v79
    v_cvt_pk_bf16_f32 v21, v62, v63
    v_exp_f32 v58, v58
    v_mfma_f32_16x16x32_bf16 v[156:159], a[232:235], v[16:19], v[156:159]
    s_waitcnt lgkmcnt(0)
    ds_read_b128 a[224:227], v1 offset:13312
    v_mul_f32 v188, v188, v49
    v_mfma_f32_16x16x32_bf16 v[52:55], a[212:215], a[96:99], 0
    ds_read_b128 a[228:231], v0 offset:14336
    v_exp_f32 v67, v67
    v_exp_f32 v78, v78
    v_mfma_f32_16x16x32_bf16 v[52:55], a[216:219], a[100:103], v[52:55]
    v_fma_f32 v76, v76, s28, v12
    v_exp_f32 v73, v73
    v_mfma_f32_16x16x32_bf16 v[52:55], a[220:223], a[104:107], v[52:55]
    v_cvt_pk_bf16_f32 v26, v68, v69
    v_fma_f32 v83, v83, s28, v12
    v_mul_f32 v179, v179, v49
    v_mfma_f32_16x16x32_bf16 v[60:63], a[220:223], a[128:131], 0
    ds_read_b128 a[232:235], v1 offset:14336
    v_cvt_pk_bf16_f32 v33, v78, v79
    v_mul_f32 v187, v187, v49
    v_mfma_f32_16x16x32_bf16 v[60:63], a[216:219], a[124:127], v[60:63]
    v_accvgpr_read_b32 v110, a6
    v_exp_f32 v80, v80
    v_mul_f32 v205, v205, v49
    v_mfma_f32_16x16x32_bf16 v[60:63], a[212:215], a[120:123], v[60:63]
    s_add_u32 m0, s22, 36864
    v_exp_f32 v76, v76
    v_mfma_f32_16x16x32_bf16 v[68:71], a[212:215], a[144:147], 0
    v_exp_f32 v77, v77
    v_cvt_pk_bf16_f32 v16, v56, v57
    v_mfma_f32_16x16x32_bf16 v[68:71], a[216:219], a[148:151], v[68:71]
    v_fma_f32 v72, v72, s28, v11
    v_mul_f32 v174, v174, v49
    v_mfma_f32_16x16x32_bf16 v[68:71], a[220:223], a[152:155], v[68:71]
    v_accvgpr_read_b32 v104, a0
    v_cvt_pk_bf16_f32 v32, v76, v77
    v_mfma_f32_16x16x32_bf16 v[76:79], a[220:223], a[176:179], 0
    buffer_load_dwordx4 v6, s[8:11], s21 offen lds
    v_mul_f32 v167, v167, v49
    v_mul_f32 v106, v106, v51
    v_mfma_f32_16x16x32_bf16 v[76:79], a[216:219], a[172:175], v[76:79]
    ds_read_b128 a[216:219], v1 offset:18432
    v_cvt_pk_bf16_f32 v161, v162, v163
    v_fma_f32 v75, v75, s28, v11
    v_mul_f32 v194, v194, v49
    v_mfma_f32_16x16x32_bf16 v[76:79], a[212:215], a[168:171], v[76:79]
    s_waitcnt lgkmcnt(1)
    v_exp_f32 v75, v75
    v_mfma_f32_16x16x32_bf16 v[76:79], a[224:227], a[180:183], v[76:79]
    v_mul_f32 v178, v178, v49
    v_cvt_pk_bf16_f32 v34, v80, v81
    v_mfma_f32_16x16x32_bf16 v[76:79], a[228:231], a[184:187], v[76:79]
    v_mul_f32 v181, v181, v49
    v_mul_f32 v107, v107, v51
    v_mul_f32 v204, v204, v49
    v_cvt_pk_bf16_f32 v22, v64, v65
    v_mfma_f32_16x16x32_bf16 v[76:79], a[232:235], a[188:191], v[76:79]
    v_exp_f32 v72, v72
    v_mfma_f32_16x16x32_bf16 v[68:71], a[232:235], a[164:167], v[68:71]
    v_exp_f32 v83, v83
    v_cvt_pk_bf16_f32 v204, v204, v205
    v_mfma_f32_16x16x32_bf16 v[68:71], a[228:231], a[160:163], v[68:71]
    v_mul_f32 v203, v203, v49
    v_mul_f32 v186, v186, v49
    v_mfma_f32_16x16x32_bf16 v[68:71], a[224:227], a[156:159], v[68:71]
    ds_read_b128 a[220:223], v0 offset:19456
    v_mul_f32 v207, v207, v49
    v_mfma_f32_16x16x32_bf16 v[60:63], a[224:227], a[132:135], v[60:63]
    s_add_u32 s21, s21, 128
    ds_read_b128 a[212:215], v0 offset:18432
    v_exp_f32 v66, v66
    v_mfma_f32_16x16x32_bf16 v[60:63], a[228:231], a[136:139], v[60:63]
    s_add_u32 m0, s22, 37888
    v_mul_f32 v190, v190, v49
    v_mul_f32 v189, v189, v49
    v_mfma_f32_16x16x32_bf16 v[60:63], a[232:235], a[140:143], v[60:63]
    v_mul_f32 v193, v193, v49
    v_exp_f32 v74, v74
    v_exp_f32 v59, v59
    v_pk_mul_f32 v[246:247], v[246:247], v[50:51] op_sel_hi:[1,0]
    v_pk_mul_f32 v[116:117], v[116:117], v[48:49] op_sel_hi:[1,0]
    v_cvt_pk_bf16_f32 v28, v72, v73
    v_mul_f32 v201, v201, v49
    v_pk_mul_f32 v[112:113], v[112:113], v[48:49] op_sel_hi:[1,0]
    v_fma_f32 v69, v69, s28, v11
    v_pk_mul_f32 v[128:129], v[128:129], v[48:49] op_sel_hi:[1,0]
    v_pk_mul_f32 v[212:213], v[212:213], v[50:51] op_sel_hi:[1,0]
    v_pk_mul_f32 v[114:115], v[114:115], v[48:49] op_sel_hi:[1,0]
    v_pk_mul_f32 v[124:125], v[124:125], v[48:49] op_sel_hi:[1,0]
    v_pk_mul_f32 v[118:119], v[118:119], v[48:49] op_sel_hi:[1,0]
    v_pk_mul_f32 v[132:133], v[132:133], v[48:49] op_sel_hi:[1,0]
    v_pk_mul_f32 v[142:143], v[142:143], v[48:49] op_sel_hi:[1,0]
    v_mul_f32 v164, v164, v49
    v_pk_mul_f32 v[226:227], v[226:227], v[50:51] op_sel_hi:[1,0]
    v_pk_mul_f32 v[244:245], v[244:245], v[50:51] op_sel_hi:[1,0]
    v_pk_mul_f32 v[130:131], v[130:131], v[48:49] op_sel_hi:[1,0]
    v_pk_mul_f32 v[216:217], v[216:217], v[50:51] op_sel_hi:[1,0]
    v_pk_mul_f32 v[120:121], v[120:121], v[48:49] op_sel_hi:[1,0]
    v_cvt_pk_bf16_f32 v124, v124, v125
    v_exp_f32 v82, v82
    v_pk_mul_f32 v[210:211], v[210:211], v[50:51] op_sel_hi:[1,0]
    v_mul_f32 v104, v104, v51
    v_pk_mul_f32 v[122:123], v[122:123], v[48:49] op_sel_hi:[1,0]
    v_pk_mul_f32 v[126:127], v[126:127], v[48:49] op_sel_hi:[1,0]
    v_pk_mul_f32 v[218:219], v[218:219], v[50:51] op_sel_hi:[1,0]
    v_pk_mul_f32 v[214:215], v[214:215], v[50:51] op_sel_hi:[1,0]
    v_pk_mul_f32 v[232:233], v[232:233], v[50:51] op_sel_hi:[1,0]
    v_mul_f32 v192, v192, v49
    v_mul_f32 v165, v165, v49
    v_pk_mul_f32 v[136:137], v[136:137], v[48:49] op_sel_hi:[1,0]
    v_pk_mul_f32 v[236:237], v[236:237], v[50:51] op_sel_hi:[1,0]
    v_pk_mul_f32 v[224:225], v[224:225], v[50:51] op_sel_hi:[1,0]
    v_cvt_pk_bf16_f32 v104, v104, v105
    v_fma_f32 v68, v68, s28, v11
    v_pk_mul_f32 v[208:209], v[208:209], v[50:51] op_sel_hi:[1,0]
    v_fma_f32 v76, v76, s28, v12
    v_cvt_pk_bf16_f32 v212, v212, v213
    v_cvt_pk_bf16_f32 v112, v112, v113
    v_cvt_pk_bf16_f32 v35, v82, v83
    v_mfma_f32_16x16x32_bf16 v[52:55], a[232:235], a[116:119], v[52:55]
    ds_read_b128 a[232:235], v1 offset:20480
    v_fma_f32 v79, v79, s28, v12
    v_fma_f32 v70, v70, s28, v11
    v_mfma_f32_16x16x32_bf16 v[52:55], a[228:231], a[112:115], v[52:55]
    v_mul_f32 v176, v176, v49
    v_cvt_pk_bf16_f32 v17, v58, v59
    v_mfma_f32_16x16x32_bf16 v[52:55], a[224:227], a[108:111], v[52:55]
    s_waitcnt lgkmcnt(1)
    v_mul_f32 v206, v206, v49
    v_mul_f32 v200, v200, v49
    v_mul_f32 v198, v198, v49
    v_mfma_f32_16x16x32_bf16 v[56:59], a[212:215], a[96:99], 0
    buffer_load_dwordx4 v6, s[8:11], s21 offen lds
    v_cvt_pk_bf16_f32 v116, v116, v117
    v_mfma_f32_16x16x32_bf16 v[56:59], a[216:219], a[100:103], v[56:59]
    s_add_u32 s21, s21, 128
    ds_read_b128 a[224:227], v1 offset:19456
    v_cvt_pk_bf16_f32 v132, v132, v133
    v_cvt_pk_bf16_f32 v23, v66, v67
    v_mfma_f32_16x16x32_bf16 v[44:47], a[236:239], v[14:17], 0
    ds_read_b128 a[228:231], v0 offset:20480
    v_fma_f32 v53, v53, s28, v9
    v_mfma_f32_16x16x32_bf16 v[56:59], a[220:223], a[104:107], v[56:59]
    v_cvt_pk_bf16_f32 v113, v114, v115
    v_cvt_pk_bf16_f32 v213, v214, v215
    v_cvt_pk_bf16_f32 v105, v106, v107
    v_accvgpr_read_b32 v106, a10
    v_mfma_f32_16x16x32_bf16 v[64:67], a[220:223], a[128:131], 0
    v_exp_f32 v79, v79
    v_mul_f32 v111, v111, v51
    v_cvt_pk_bf16_f32 v244, v244, v245
    v_mfma_f32_16x16x32_bf16 v[64:67], a[216:219], a[124:127], v[64:67]
    v_cvt_pk_bf16_f32 v29, v74, v75
    v_cvt_pk_bf16_f32 v188, v188, v189
    v_cvt_pk_bf16_f32 v208, v208, v209
    v_mul_f32 v180, v180, v49
    v_cvt_pk_bf16_f32 v173, v174, v175
    v_mfma_f32_16x16x32_bf16 v[64:67], a[212:215], a[120:123], v[64:67]
    v_exp_f32 v69, v69
    v_cvt_pk_bf16_f32 v224, v224, v225
    v_cvt_pk_bf16_f32 v164, v164, v165
    v_mfma_f32_16x16x32_bf16 v[72:75], a[212:215], a[144:147], 0
    s_add_u32 m0, s22, 38912
    ds_write2st64_b64 v101, v[112:113], v[160:161] offset0:0 offset1:12
    v_cvt_pk_bf16_f32 v192, v192, v193
    v_mfma_f32_16x16x32_bf16 v[72:75], a[216:219], a[148:151], v[72:75]
    v_fma_f32 v54, v54, s28, v9
    v_mul_f32 v183, v183, v49
    v_cvt_pk_bf16_f32 v209, v210, v211
    v_mfma_f32_16x16x32_bf16 v[72:75], a[220:223], a[152:155], v[72:75]
    buffer_load_dwordx4 v6, s[8:11], s21 offen lds
    v_mfma_f32_16x16x32_bf16 v[80:83], a[220:223], a[176:179], 0
    s_add_u32 s21, s21, 12032
    v_cvt_pk_bf16_f32 v205, v206, v207
    v_fma_f32 v55, v55, s28, v9
    v_mfma_f32_16x16x32_bf16 v[80:83], a[216:219], a[172:175], v[80:83]
    s_waitcnt vmcnt(6) lgkmcnt(1)
    v_mul_f32 v177, v177, v49
    v_mul_f32 v185, v185, v49
    v_mfma_f32_16x16x32_bf16 v[80:83], a[212:215], a[168:171], v[80:83]
    s_barrier
    ds_read_b64_tr_b16 a[212:213], v2 offset:0
    v_mfma_f32_16x16x32_bf16 v[80:83], a[224:227], a[180:183], v[80:83]
    v_fma_f32 v52, v52, s28, v9
    v_cvt_pk_bf16_f32 v216, v216, v217
    v_cvt_pk_bf16_f32 v120, v120, v121
    v_mfma_f32_16x16x32_bf16 v[80:83], a[228:231], a[184:187], v[80:83]
    s_add_u32 m0, s22, 12288
    v_fma_f32 v71, v71, s28, v11
    v_mul_f32 v171, v171, v49
    v_mfma_f32_16x16x32_bf16 v[80:83], a[232:235], a[188:191], v[80:83]
    buffer_load_dwordx4 v6, s[4:7], s20 offen lds
    v_mfma_f32_16x16x32_bf16 v[72:75], a[232:235], a[164:167], v[72:75]
    v_mul_f32 v184, v184, v49
    v_mul_f32 v108, v108, v51
    v_cvt_pk_bf16_f32 v165, v166, v167
    v_cvt_pk_bf16_f32 v168, v168, v169
    v_fma_f32 v77, v77, s28, v12
    v_mfma_f32_16x16x32_bf16 v[72:75], a[228:231], a[160:163], v[72:75]
    ds_write2st64_b64 v101, v[208:209], v[104:105] offset0:24 offset1:36
    v_pk_mul_f32 v[158:159], v[158:159], v[48:49] op_sel_hi:[1,0]
    v_cvt_pk_bf16_f32 v217, v218, v219
    v_cvt_pk_bf16_f32 v232, v232, v233
    v_mul_f32 v110, v110, v51
    v_exp_f32 v70, v70
    v_mfma_f32_16x16x32_bf16 v[72:75], a[224:227], a[156:159], v[72:75]
    s_add_u32 s20, s20, 128
    ds_read_b64_tr_b16 a[214:215], v2 offset:6144
    v_accvgpr_read_b32 v104, a8
    v_cvt_pk_bf16_f32 v189, v190, v191
    v_accvgpr_read_b32 v107, a11
    v_fma_f32 v61, v61, s28, v10
    v_pk_mul_f32 v[138:139], v[138:139], v[48:49] op_sel_hi:[1,0]
    v_pk_mul_f32 v[250:251], v[250:251], v[50:51] op_sel_hi:[1,0]
    v_cvt_pk_bf16_f32 v180, v180, v181
    v_accvgpr_read_b32 v105, a9
    v_exp_f32 v54, v54
    v_cvt_pk_bf16_f32 v236, v236, v237
    v_cvt_pk_bf16_f32 v117, v118, v119
    v_mul_f32 v104, v104, v51
    v_mfma_f32_16x16x32_bf16 v[64:67], a[224:227], a[132:135], v[64:67]
    ds_read_b64_tr_b16 a[216:217], v3 offset:0
    v_mul_f32 v106, v106, v51
    v_xor_b32 v101, 32, v101
    v_mfma_f32_16x16x32_bf16 v[64:67], a[228:231], a[136:139], v[64:67]
    ds_read_b64_tr_b16 a[218:219], v3 offset:6144
    v_cvt_pk_bf16_f32 v108, v108, v109
    v_mfma_f32_16x16x32_bf16 v[64:67], a[232:235], a[140:143], v[64:67]
    ds_read_b64_tr_b16 a[220:221], v4 offset:0
    v_mul_f32 v107, v107, v51
    v_fma_f32 v60, v60, s28, v10
    v_fma_f32 v63, v63, s28, v10
    v_cvt_pk_bf16_f32 v200, v200, v201
    v_cvt_pk_bf16_f32 v121, v122, v123
    v_mfma_f32_16x16x32_bf16 v[56:59], a[232:235], a[116:119], v[56:59]
    ds_write2st64_b64 v101, v[116:117], v[164:165] offset0:0 offset1:12
    v_cvt_pk_bf16_f32 v128, v128, v129
    v_mfma_f32_16x16x32_bf16 v[56:59], a[228:231], a[112:115], v[56:59]
    ds_read_b64_tr_b16 a[222:223], v4 offset:6144
    v_exp_f32 v61, v61
    v_mul_f32 v105, v105, v51
    v_cvt_pk_bf16_f32 v109, v110, v111
    v_mfma_f32_16x16x32_bf16 v[44:47], a[240:243], v[20:23], v[44:47]
    s_add_u32 m0, s22, 13312
    ds_write2st64_b64 v101, v[212:213], v[108:109] offset0:24 offset1:36
    v_pk_mul_f32 v[134:135], v[134:135], v[48:49] op_sel_hi:[1,0]
    v_pk_mul_f32 v[228:229], v[228:229], v[50:51] op_sel_hi:[1,0]
    v_pk_mul_f32 v[148:149], v[148:149], v[48:49] op_sel_hi:[1,0]
    v_cvt_pk_bf16_f32 v184, v184, v185
    v_cvt_pk_bf16_f32 v169, v170, v171
    v_accvgpr_read_b32 v108, a12
    v_mfma_f32_16x16x32_bf16 v[56:59], a[224:227], a[108:111], v[56:59]
    s_waitcnt lgkmcnt(4)
    ds_read_b64_tr_b16 a[230:231], v2 offset:7168
    v_cvt_pk_bf16_f32 v228, v228, v229
    v_mfma_f32_16x16x32_bf16 v[112:115], a[212:215], v[14:17], 0
    ds_read_b64_tr_b16 a[232:233], v3 offset:1024
    v_accvgpr_read_b32 v110, a14
    v_fma_f32 v73, v73, s28, v11
    v_xor_b32 v101, 96, v101
    v_cvt_pk_bf16_f32 v104, v104, v105
    v_exp_f32 v55, v55
    v_pk_mul_f32 v[230:231], v[230:231], v[50:51] op_sel_hi:[1,0]
    v_pk_mul_f32 v[220:221], v[220:221], v[50:51] op_sel_hi:[1,0]
    v_mul_f32 v110, v110, v51
    v_cvt_pk_bf16_f32 v176, v176, v177
    v_mfma_f32_16x16x32_bf16 v[160:163], a[212:215], v[20:23], 0
    buffer_load_dwordx4 v6, s[4:7], s20 offen lds
    ds_read_b64_tr_b16 a[224:225], v5 offset:0
    v_cvt_pk_bf16_f32 v129, v130, v131
    v_accvgpr_read_b32 v109, a13
    v_pk_mul_f32 v[144:145], v[144:145], v[48:49] op_sel_hi:[1,0]
    v_fma_f32 v64, v64, s28, v10
    v_mul_f32 v108, v108, v51
    v_accvgpr_read_b32 v111, a15
    v_cvt_pk_bf16_f32 v105, v106, v107
    v_pk_mul_f32 v[222:223], v[222:223], v[50:51] op_sel_hi:[1,0]
    v_cvt_pk_bf16_f32 v225, v226, v227
    v_mul_f32 v199, v199, v49
    v_mfma_f32_16x16x32_bf16 v[208:211], a[212:215], v[26:29], 0
    ds_read_b64_tr_b16 a[234:235], v3 offset:7168
    v_mul_f32 v111, v111, v51
    v_cvt_pk_bf16_f32 v125, v126, v127
    v_mfma_f32_16x16x32_bf16 a[0:3], a[212:215], v[32:35], 0
    ds_write2st64_b64 v101, v[120:121], v[168:169] offset0:0 offset1:12
    v_fma_f32 v67, v67, s28, v10
    v_pk_mul_f32 v[252:253], v[252:253], v[50:51] op_sel_hi:[1,0]
    v_accvgpr_read_b32 v107, a19
    v_mul_f32 v109, v109, v51
    v_cvt_pk_bf16_f32 v108, v108, v109
    v_pk_mul_f32 v[146:147], v[146:147], v[48:49] op_sel_hi:[1,0]
    v_pk_mul_f32 v[248:249], v[248:249], v[50:51] op_sel_hi:[1,0]
    v_mul_f32 v195, v195, v49
    v_cvt_pk_bf16_f32 v220, v220, v221
    v_exp_f32 v53, v53
    v_pk_mul_f32 v[154:155], v[154:155], v[48:49] op_sel_hi:[1,0]
    v_cvt_pk_bf16_f32 v148, v148, v149
    v_exp_f32 v52, v52
    v_fma_f32 v65, v65, s28, v10
    v_mfma_f32_16x16x32_bf16 a[4:7], a[216:219], v[32:35], 0
    ds_write2st64_b64 v101, v[216:217], v[104:105] offset0:24 offset1:36
    v_accvgpr_read_b32 v104, a16
    v_pk_mul_f32 v[240:241], v[240:241], v[50:51] op_sel_hi:[1,0]
    v_cvt_pk_bf16_f32 v144, v144, v145
    v_pk_mul_f32 v[152:153], v[152:153], v[48:49] op_sel_hi:[1,0]
    v_cvt_pk_bf16_f32 v109, v110, v111
    v_exp_f32 v60, v60
    v_fma_f32 v66, v66, s28, v10
    v_cvt_pk_bf16_f32 v136, v136, v137
    v_mfma_f32_16x16x32_bf16 v[212:215], a[216:219], v[26:29], 0
    s_add_u32 s20, s20, 128
    ds_read_b64_tr_b16 a[226:227], v5 offset:6144
    v_mul_f32 v107, v107, v51
    v_accvgpr_read_b32 v106, a18
    v_mul_f32 v202, v202, v49
    v_xor_b32 v101, 32, v101
    v_pk_mul_f32 v[238:239], v[238:239], v[50:51] op_sel_hi:[1,0]
    v_pk_mul_f32 v[140:141], v[140:141], v[48:49] op_sel_hi:[1,0]
    v_cvt_pk_bf16_f32 v152, v152, v153
    v_accvgpr_read_b32 v105, a17
    v_cvt_pk_bf16_f32 v221, v222, v223
    v_mfma_f32_16x16x32_bf16 v[164:167], a[216:219], v[20:23], 0
    s_add_u32 m0, s22, 14336
    ds_read_b64_tr_b16 a[212:213], v4 offset:1024
    buffer_load_dwordx4 v6, s[4:7], s20 offen lds
    v_mfma_f32_16x16x32_bf16 v[116:119], a[216:219], v[14:17], 0
    s_waitcnt lgkmcnt(3)
    ds_write2st64_b64 v101, v[124:125], v[172:173] offset0:0 offset1:12
    v_mfma_f32_16x16x32_bf16 v[120:123], a[220:223], v[14:17], 0
    ds_write2st64_b64 v101, v[220:221], v[108:109] offset0:24 offset1:36
    v_fma_f32 v72, v72, s28, v11
    v_accvgpr_read_b32 v108, a20
    v_mul_f32 v106, v106, v51
    v_mul_f32 v105, v105, v51
    v_pk_mul_f32 v[242:243], v[242:243], v[50:51] op_sel_hi:[1,0]
    v_cvt_pk_bf16_f32 v140, v140, v141
    v_pk_mul_f32 v[150:151], v[150:151], v[48:49] op_sel_hi:[1,0]
    v_pk_mul_f32 v[156:157], v[156:157], v[48:49] op_sel_hi:[1,0]
    v_pk_mul_f32 v[234:235], v[234:235], v[50:51] op_sel_hi:[1,0]
    v_accvgpr_read_b32 v109, a21
    v_mul_f32 v109, v109, v51
    v_xor_b32 v101, 96, v101
    v_mul_f32 v108, v108, v51
    v_mul_f32 v104, v104, v51
    v_accvgpr_read_b32 v110, a22
    v_mfma_f32_16x16x32_bf16 v[168:171], a[220:223], v[20:23], 0
    ds_read_b128 v[84:87], v8 offset:0
    v_cvt_pk_bf16_f32 v104, v104, v105
    v_cvt_pk_bf16_f32 v233, v234, v235
    v_cvt_pk_bf16_f32 v19, v54, v55
    v_cvt_pk_bf16_f32 v177, v178, v179
    v_mfma_f32_16x16x32_bf16 v[216:219], a[220:223], v[26:29], 0
    s_add_u32 s20, s20, 12032
    ds_read_b64_tr_b16 a[216:217], v5 offset:1024
    ds_read_b64_tr_b16 a[214:215], v4 offset:7168
    v_cvt_pk_bf16_f32 v105, v106, v107
    v_mfma_f32_16x16x32_bf16 a[8:11], a[220:223], v[32:35], 0
    s_waitcnt lgkmcnt(4)
    ds_read_b128 v[88:91], v8 offset:1024
    v_cvt_pk_bf16_f32 v137, v138, v139
    v_accvgpr_read_b32 v111, a23
    v_mfma_f32_16x16x32_bf16 a[12:15], a[224:227], v[32:35], 0
    ds_read_b64_tr_b16 a[228:229], v2 offset:1024
    v_cvt_pk_bf16_f32 v133, v134, v135
    v_exp_f32 v71, v71
    v_mul_f32 v111, v111, v51
    v_mfma_f32_16x16x32_bf16 v[44:47], a[244:247], v[26:29], v[44:47]
    ds_write2st64_b64 v101, v[128:129], v[176:177] offset0:4 offset1:16
    v_cvt_pk_bf16_f32 v248, v248, v249
    v_accvgpr_read_b32 v106, a26
    v_mul_f32 v110, v110, v51
    v_exp_f32 v68, v68
    v_cvt_pk_bf16_f32 v181, v182, v183
    v_mfma_f32_16x16x32_bf16 v[220:223], a[224:227], v[26:29], 0
    ds_write2st64_b64 v101, v[224:225], v[104:105] offset0:28 offset1:40
    v_fma_f32 v75, v75, s28, v11
    v_accvgpr_read_b32 v105, a25
    v_pk_mul_f32 v[254:255], v[254:255], v[50:51] op_sel_hi:[1,0]
    v_accvgpr_read_b32 v104, a24
    v_mul_f32 v104, v104, v51
    v_cvt_pk_bf16_f32 v108, v108, v109
    v_cvt_pk_bf16_f32 v240, v240, v241
    v_mul_f32 v106, v106, v51
    v_accvgpr_read_b32 v107, a27
    v_cvt_pk_bf16_f32 v249, v250, v251
    v_cvt_pk_bf16_f32 v145, v146, v147
    v_cvt_pk_bf16_f32 v229, v230, v231
    v_cvt_pk_bf16_f32 v149, v150, v151
    v_mfma_f32_16x16x32_bf16 v[172:175], a[224:227], v[20:23], 0
    s_add_u32 m0, s38, 0
    ds_read_b64_tr_b16 a[222:223], v2 offset:8192
    v_mul_f32 v105, v105, v51
    v_xor_b32 v101, 32, v101
    v_mfma_f32_16x16x32_bf16 v[124:127], a[224:227], v[14:17], 0
    s_waitcnt lgkmcnt(3)
    ds_read_b64_tr_b16 a[220:221], v2 offset:2048
    v_cvt_pk_bf16_f32 v109, v110, v111
    v_mfma_f32_16x16x32_bf16 v[128:131], a[228:231], v[14:17], 0
    ds_read_b64_tr_b16 a[224:225], v3 offset:2048
    v_cvt_pk_bf16_f32 v185, v186, v187
    v_accvgpr_read_b32 v110, a30
    v_mul_f32 v110, v110, v51
    v_mfma_f32_16x16x32_bf16 v[176:179], a[228:231], v[20:23], 0
    buffer_store_dwordx4 v[84:87], v102, s[16:19], s67 offen offset:0 nt
    ds_read_b64_tr_b16 a[218:219], v5 offset:7168
    v_cvt_pk_bf16_f32 v201, v202, v203
    v_cvt_pk_bf16_f32 v104, v104, v105
    v_cvt_pk_bf16_f32 v241, v242, v243
    v_mul_f32 v107, v107, v51
    v_mfma_f32_16x16x32_bf16 v[224:227], a[228:231], v[26:29], 0
    ds_write2st64_b64 v101, v[132:133], v[180:181] offset0:4 offset1:16
    v_cvt_pk_bf16_f32 v245, v246, v247
    v_cvt_pk_bf16_f32 v196, v196, v197
    v_cvt_pk_bf16_f32 v156, v156, v157
    v_fma_f32 v78, v78, s28, v12
    v_mfma_f32_16x16x32_bf16 a[16:19], a[228:231], v[32:35], 0
    ds_read_b128 v[96:99], v8 offset:6144
    buffer_load_dwordx4 v6, s[12:15], s33 offen nt lds
    v_mfma_f32_16x16x32_bf16 a[20:23], a[232:235], v[32:35], 0
    ds_write2st64_b64 v101, v[228:229], v[108:109] offset0:28 offset1:40
    v_mfma_f32_16x16x32_bf16 v[44:47], a[248:251], v[32:35], v[44:47]
    s_add_u32 m0, s38, 1024
    ds_read_b64_tr_b16 a[226:227], v3 offset:8192
    v_accvgpr_read_b32 v111, a31
    v_fma_f32 v83, v83, s28, v12
    v_mfma_f32_16x16x32_bf16 v[228:231], a[232:235], v[26:29], 0
    buffer_load_dwordx4 v7, s[12:15], s33 offen nt lds
    ds_read_b128 v[84:87], v8 offset:7168
    v_accvgpr_read_b32 v109, a29
    v_mul_f32 v109, v109, v51
    v_accvgpr_read_b32 v108, a28
    v_xor_b32 v101, 96, v101
    v_mul_f32 v111, v111, v51
    v_mul_f32 v108, v108, v51
    v_cvt_pk_bf16_f32 v193, v194, v195
    v_cvt_pk_bf16_f32 v108, v108, v109
    v_cvt_pk_bf16_f32 v105, v106, v107
    v_exp_f32 v65, v65
    v_mfma_f32_16x16x32_bf16 v[180:183], a[232:235], v[20:23], 0
    s_add_u32 s57, s67, 6144
    ds_write2st64_b64 v101, v[136:137], v[184:185] offset0:4 offset1:16
    v_cvt_pk_bf16_f32 v237, v238, v239
    v_mfma_f32_16x16x32_bf16 v[132:135], a[232:235], v[14:17], 0
    s_add_u32 s59, s33, 6144
    ds_write2st64_b64 v101, v[232:233], v[104:105] offset0:28 offset1:40
    v_xor_b32 v101, 32, v101
    v_cvt_pk_bf16_f32 v109, v110, v111
    v_accvgpr_read_b32 v110, a38
    v_cvt_pk_bf16_f32 v252, v252, v253
    v_cvt_pk_bf16_f32 v197, v198, v199
    v_accvgpr_read_b32 v104, a32
    v_cvt_pk_bf16_f32 v141, v142, v143
    v_cvt_pk_bf16_f32 v157, v158, v159
    v_cvt_pk_bf16_f32 v253, v254, v255
    v_accvgpr_read_b32 v106, a34
    v_accvgpr_read_b32 v107, a35
    v_mul_f32 v104, v104, v51
    v_accvgpr_read_b32 v105, a33
    v_mul_f32 v106, v106, v51
    v_mfma_f32_16x16x32_bf16 v[136:139], a[212:215], v[14:17], 0
    buffer_store_dwordx4 v[88:91], v103, s[16:19], s67 offen offset:0 nt
    s_add_u32 m0, s38, 6144
    ds_write2st64_b64 v101, v[140:141], v[188:189] offset0:4 offset1:16
    v_mfma_f32_16x16x32_bf16 v[184:187], a[212:215], v[20:23], 0
    ds_write2st64_b64 v101, v[236:237], v[108:109] offset0:28 offset1:40
    v_mul_f32 v105, v105, v51
    v_mfma_f32_16x16x32_bf16 v[232:235], a[212:215], v[26:29], 0
    s_waitcnt lgkmcnt(2)
    ds_read_b64_tr_b16 a[228:229], v4 offset:2048
    buffer_load_dwordx4 v6, s[12:15], s59 offen nt lds
    v_accvgpr_read_b32 v109, a37
    v_mul_f32 v107, v107, v51
    v_mfma_f32_16x16x32_bf16 a[24:27], a[212:215], v[32:35], 0
    buffer_store_dwordx4 v[96:99], v102, s[16:19], s57 offen offset:0 nt
    ds_read_b64_tr_b16 a[230:231], v4 offset:8192
    ds_read_b64_tr_b16 a[232:233], v5 offset:2048
    v_accvgpr_read_b32 v108, a36
    v_fma_f32 v80, v80, s28, v12
    v_xor_b32 v101, 96, v101
    v_cvt_pk_bf16_f32 v104, v104, v105
    v_mfma_f32_16x16x32_bf16 a[28:31], a[216:219], v[32:35], 0
    s_add_u32 m0, s38, 7168
    ds_read_b64_tr_b16 a[234:235], v5 offset:8192
    v_fma_f32 v82, v82, s28, v12
    v_cvt_pk_bf16_f32 v105, v106, v107
    v_fma_f32 v74, v74, s28, v11
    v_fma_f32 v62, v62, s28, v10
    v_exp_f32 v63, v63
    v_accvgpr_read_b32 v111, a39
    v_mfma_f32_16x16x32_bf16 v[236:239], a[216:219], v[26:29], 0
    buffer_load_dwordx4 v7, s[12:15], s59 offen nt lds
    ds_write2st64_b64 v101, v[144:145], v[192:193] offset0:8 offset1:20
    v_mfma_f32_16x16x32_bf16 v[188:191], a[216:219], v[20:23], 0
    ds_write2st64_b64 v101, v[240:241], v[104:105] offset0:32 offset1:44
    v_accvgpr_read_b32 v105, a41
    v_exp_f32 v62, v62
    v_accvgpr_read_b32 v106, a42
    v_mfma_f32_16x16x32_bf16 v[140:143], a[216:219], v[14:17], 0
    s_add_u32 s39, s39, 12288
    ds_read_b128 v[88:91], v8 offset:2048
    v_accvgpr_read_b32 v104, a40
    v_mul_f32 v109, v109, v51
    v_mul_f32 v104, v104, v51
    v_cvt_pk_bf16_f32 v18, v52, v53
    v_mul_f32 v108, v108, v51
    v_cvt_pk_bf16_f32 v31, v70, v71
    v_mul_f32 v110, v110, v51
    v_mfma_f32_16x16x32_bf16 v[144:147], a[220:223], v[14:17], 0
    s_waitcnt vmcnt(13) lgkmcnt(3)
    v_accvgpr_read_b32 v107, a43
    v_mul_f32 v111, v111, v51
    v_mfma_f32_16x16x32_bf16 v[192:195], a[220:223], v[20:23], 0
    buffer_store_dwordx4 v[84:87], v103, s[16:19], s57 offen offset:0 nt
    s_barrier
    v_xor_b32 v101, 32, v101
    v_cvt_pk_bf16_f32 v108, v108, v109
    v_cvt_pk_bf16_f32 v25, v62, v63
    v_mfma_f32_16x16x32_bf16 v[240:243], a[220:223], v[26:29], 0
    ds_write2st64_b64 v101, v[148:149], v[196:197] offset0:8 offset1:20
    v_cvt_pk_bf16_f32 v109, v110, v111
    v_mfma_f32_16x16x32_bf16 a[32:35], a[220:223], v[32:35], 0
    ds_write2st64_b64 v101, v[244:245], v[108:109] offset0:32 offset1:44
    v_cvt_pk_bf16_f32 v153, v154, v155
    v_mul_f32 v107, v107, v51
    v_mfma_f32_16x16x32_bf16 a[36:39], a[224:227], v[32:35], 0
    ds_read_b128 a[216:219], v1 offset:0
    v_cvt_pk_bf16_f32 v30, v68, v69
    v_xor_b32 v101, 96, v101
    v_mul_f32 v105, v105, v51
    v_mfma_f32_16x16x32_bf16 v[244:247], a[224:227], v[26:29], 0
    s_add_u32 m0, s22, 24576
    v_accvgpr_read_b32 v108, a44
    v_accvgpr_read_b32 v111, a47
    v_cvt_pk_bf16_f32 v104, v104, v105
    v_mul_f32 v106, v106, v51
    v_accvgpr_read_b32 v110, a46
    v_mul_f32 v111, v111, v51
    v_cvt_pk_bf16_f32 v105, v106, v107
    v_mfma_f32_16x16x32_bf16 v[196:199], a[224:227], v[20:23], 0
    ds_write2st64_b64 v101, v[152:153], v[200:201] offset0:8 offset1:20
    v_mfma_f32_16x16x32_bf16 v[148:151], a[224:227], v[14:17], 0
    ds_read_b128 a[220:223], v0 offset:1024
    v_exp_f32 v66, v66
    v_mfma_f32_16x16x32_bf16 v[152:155], a[228:231], v[14:17], 0
    ds_read_b128 a[212:215], v0 offset:0
    v_accvgpr_read_b32 v109, a45
    v_mul_f32 v109, v109, v51
    v_exp_f32 v67, v67
    v_mfma_f32_16x16x32_bf16 v[200:203], a[228:231], v[20:23], 0
    ds_write2st64_b64 v101, v[248:249], v[104:105] offset0:32 offset1:44
    v_mul_f32 v110, v110, v51
    v_exp_f32 v74, v74
    v_xor_b32 v101, 32, v101
    v_mfma_f32_16x16x32_bf16 v[248:251], a[228:231], v[26:29], 0
    ds_read_b128 v[84:87], v8 offset:8192
    v_mul_f32 v108, v108, v51
    v_fma_f32 v58, v58, s28, v9
    v_cvt_pk_bf16_f32 v108, v108, v109
    v_mfma_f32_16x16x32_bf16 a[40:43], a[228:231], v[32:35], 0
    ds_write2st64_b64 v101, v[156:157], v[204:205] offset0:8 offset1:20
    v_cvt_pk_bf16_f32 v109, v110, v111
    v_mfma_f32_16x16x32_bf16 a[44:47], a[232:235], v[32:35], 0
    ds_write2st64_b64 v101, v[252:253], v[108:109] offset0:32 offset1:44
    v_mfma_f32_16x16x32_bf16 v[252:255], a[232:235], v[26:29], 0
    buffer_load_dwordx4 v6, s[8:11], s21 offen lds
    v_mfma_f32_16x16x32_bf16 v[204:207], a[232:235], v[20:23], 0
    s_add_u32 s21, s21, 128
    v_fma_f32 v59, v59, s28, v9
    v_fma_f32 v56, v56, s28, v9
    v_mfma_f32_16x16x32_bf16 v[156:159], a[232:235], v[14:17], 0
    s_waitcnt lgkmcnt(3)
    v_exp_f32 v59, v59
    v_mfma_f32_16x16x32_bf16 v[52:55], a[212:215], a[96:99], 0
    s_add_u32 m0, s22, 25600
    ds_read_b128 a[224:227], v1 offset:1024
    v_cvt_pk_bf16_f32 v24, v60, v61
    v_mfma_f32_16x16x32_bf16 v[52:55], a[216:219], a[100:103], v[52:55]
    buffer_load_dwordx4 v6, s[8:11], s21 offen lds
    v_mfma_f32_16x16x32_bf16 v[52:55], a[220:223], a[104:107], v[52:55]
    s_add_u32 s21, s21, 128
    v_exp_f32 v78, v78
    v_mfma_f32_16x16x32_bf16 v[60:63], a[220:223], a[128:131], 0
    s_add_u32 m0, s22, 26624
    ds_read_b128 a[228:231], v0 offset:2048
    v_exp_f32 v77, v77
    v_mfma_f32_16x16x32_bf16 v[60:63], a[216:219], a[124:127], v[60:63]
    ds_read_b128 a[232:235], v1 offset:2048
    buffer_load_dwordx4 v6, s[8:11], s21 offen lds
    v_mfma_f32_16x16x32_bf16 v[60:63], a[212:215], a[120:123], v[60:63]
    s_add_u32 s21, s21, 12032
    ds_read_b128 v[96:99], v8 offset:3072
    v_exp_f32 v80, v80
    v_mfma_f32_16x16x32_bf16 v[68:71], a[212:215], a[144:147], 0
    v_exp_f32 v56, v56
    v_mfma_f32_16x16x32_bf16 v[68:71], a[216:219], a[148:151], v[68:71]
    v_exp_f32 v76, v76
    v_mfma_f32_16x16x32_bf16 v[68:71], a[220:223], a[152:155], v[68:71]
    s_add_u32 s56, s67, 128
    v_cvt_pk_bf16_f32 v37, v78, v79
    v_cvt_pk_bf16_f32 v36, v76, v77
    v_mfma_f32_16x16x32_bf16 v[76:79], a[220:223], a[176:179], 0
    buffer_store_dwordx4 v[88:91], v102, s[16:19], s56 offen offset:0 nt
    s_add_u32 s58, s33, 128
    v_exp_f32 v73, v73
    v_fma_f32 v57, v57, s28, v9
    v_mfma_f32_16x16x32_bf16 v[76:79], a[216:219], a[172:175], v[76:79]
    s_add_u32 m0, s38, 2048
    v_exp_f32 v57, v57
    v_mfma_f32_16x16x32_bf16 v[76:79], a[212:215], a[168:171], v[76:79]
    s_waitcnt lgkmcnt(2)
    v_exp_f32 v75, v75
    v_mfma_f32_16x16x32_bf16 v[76:79], a[224:227], a[180:183], v[76:79]
    ds_read_b128 a[220:223], v0 offset:7168
    buffer_load_dwordx4 v6, s[12:15], s58 offen nt lds
    v_mfma_f32_16x16x32_bf16 v[76:79], a[228:231], a[184:187], v[76:79]
    s_waitcnt lgkmcnt(1)
    v_exp_f32 v64, v64
    v_mfma_f32_16x16x32_bf16 v[76:79], a[232:235], a[188:191], v[76:79]
    ds_read_b128 a[216:219], v1 offset:6144
    v_fma_f32 v81, v81, s28, v12
    v_mfma_f32_16x16x32_bf16 v[68:71], a[232:235], a[164:167], v[68:71]
    buffer_store_dwordx4 v[96:99], v103, s[16:19], s56 offen offset:0 nt
    ds_read_b128 v[88:91], v8 offset:9216
    v_cvt_pk_bf16_f32 v23, v66, v67
    v_cvt_pk_bf16_f32 v16, v56, v57
    v_mfma_f32_16x16x32_bf16 v[68:71], a[228:231], a[160:163], v[68:71]
    s_add_u32 m0, s38, 3072
    ds_read_b128 a[212:215], v0 offset:6144
    v_exp_f32 v82, v82
    v_mfma_f32_16x16x32_bf16 v[68:71], a[224:227], a[156:159], v[68:71]
    buffer_load_dwordx4 v7, s[12:15], s58 offen nt lds
    ds_read_b128 v[96:99], v8 offset:4096
    v_mfma_f32_16x16x32_bf16 v[60:63], a[224:227], a[132:135], v[60:63]
    v_exp_f32 v81, v81
    v_mfma_f32_16x16x32_bf16 v[60:63], a[228:231], a[136:139], v[60:63]
    v_cvt_pk_bf16_f32 v34, v80, v81
    v_cvt_pk_bf16_f32 v22, v64, v65
    v_mfma_f32_16x16x32_bf16 v[60:63], a[232:235], a[140:143], v[60:63]
    v_exp_f32 v72, v72
    v_mfma_f32_16x16x32_bf16 v[52:55], a[232:235], a[116:119], v[52:55]
    s_add_u32 s57, s67, 6272
    v_exp_f32 v58, v58
    v_mfma_f32_16x16x32_bf16 v[52:55], a[228:231], a[112:115], v[52:55]
    v_cvt_pk_bf16_f32 v28, v72, v73
    v_cvt_pk_bf16_f32 v17, v58, v59
    v_mfma_f32_16x16x32_bf16 v[52:55], a[224:227], a[108:111], v[52:55]
    buffer_store_dwordx4 v[84:87], v102, s[16:19], s57 offen offset:0 nt
    s_add_u32 s59, s33, 6272
    s_add_u32 m0, s38, 8192
    ds_read_b128 a[224:227], v1 offset:7168
    v_exp_f32 v83, v83
    v_mfma_f32_16x16x32_bf16 v[48:51], a[236:239], v[16:19], v[44:47]
    v_cvt_pk_bf16_f32 v35, v82, v83
    v_cvt_pk_bf16_f32 v29, v74, v75
    v_mfma_f32_16x16x32_bf16 v[48:51], a[240:243], v[22:25], v[48:51]
    buffer_load_dwordx4 v6, s[12:15], s59 offen nt lds
    v_mfma_f32_16x16x32_bf16 v[48:51], a[244:247], v[28:31], v[48:51]
    s_add_u32 m0, s38, 9216
    ds_read_b128 v[84:87], v8 offset:5120
    s_waitcnt lgkmcnt(2)
    v_mfma_f32_16x16x32_bf16 v[56:59], a[212:215], a[96:99], 0
    buffer_load_dwordx4 v7, s[12:15], s59 offen nt lds
    v_mfma_f32_16x16x32_bf16 v[48:51], a[248:251], v[34:37], v[48:51]
    s_add_u32 s56, s67, 256
    ds_read_b128 a[228:231], v0 offset:8192
    s_add_u32 s58, s33, 256
    v_mfma_f32_16x16x32_bf16 v[56:59], a[216:219], a[100:103], v[56:59]
    ds_read_b128 a[232:235], v1 offset:8192
    s_add_u32 m0, s38, 4096
    v_mfma_f32_16x16x32_bf16 v[56:59], a[220:223], a[104:107], v[56:59]
    s_nop 0
    v_cmp_lt_f32 vcc, s29, v48
    v_mfma_f32_16x16x32_bf16 v[64:67], a[220:223], a[128:131], 0
    buffer_load_dwordx4 v6, s[12:15], s58 offen nt lds
    v_mfma_f32_16x16x32_bf16 v[64:67], a[216:219], a[124:127], v[64:67]
    buffer_store_dwordx4 v[88:91], v103, s[16:19], s57 offen offset:0 nt
    s_add_u32 m0, s38, 5120
    s_cbranch_vccnz L_rs_tr44d
L_ret_tr44d:
    v_fma_f32 v60, v60, s28, v10
    v_fma_f32 v53, v53, s28, v9
    v_mfma_f32_16x16x32_bf16 v[64:67], a[212:215], a[120:123], v[64:67]
    v_fma_f32 v52, v52, s28, v9
    v_fma_f32 v61, v61, s28, v10
    v_mfma_f32_16x16x32_bf16 v[72:75], a[212:215], a[144:147], 0
    v_exp_f32 v52, v52
    v_mfma_f32_16x16x32_bf16 v[72:75], a[216:219], a[148:151], v[72:75]
    s_waitcnt lgkmcnt(2)
    buffer_load_dwordx4 v7, s[12:15], s58 offen nt lds
    v_mfma_f32_16x16x32_bf16 v[72:75], a[220:223], a[152:155], v[72:75]
    v_fma_f32 v54, v54, s28, v9
    v_mfma_f32_16x16x32_bf16 v[80:83], a[220:223], a[176:179], 0
    s_waitcnt vmcnt(24) lgkmcnt(0)
    v_mfma_f32_16x16x32_bf16 v[80:83], a[216:219], a[172:175], v[80:83]
    v_exp_f32 v60, v60
    v_mfma_f32_16x16x32_bf16 v[80:83], a[212:215], a[168:171], v[80:83]
    buffer_store_dwordx4 v[96:99], v102, s[16:19], s56 offen offset:0 nt
    s_barrier
    ds_read_b64_tr_b16 a[212:213], v2 offset:18432
    v_add_u32 v8, 10240, v8
    v_mfma_f32_16x16x32_bf16 v[80:83], a[224:227], a[180:183], v[80:83]
    v_exp_f32 v54, v54
    v_mfma_f32_16x16x32_bf16 v[80:83], a[228:231], a[184:187], v[80:83]
    v_exp_f32 v61, v61
    v_mfma_f32_16x16x32_bf16 v[80:83], a[232:235], a[188:191], v[80:83]
    s_add_u32 m0, s22, 0
    ds_read_b64_tr_b16 a[214:215], v2 offset:12288
    v_fma_f32 v55, v55, s28, v9
    v_mfma_f32_16x16x32_bf16 v[72:75], a[232:235], a[164:167], v[72:75]
    buffer_load_dwordx4 v6, s[4:7], s20 offen lds
    v_mfma_f32_16x16x32_bf16 v[72:75], a[228:231], a[160:163], v[72:75]
    buffer_store_dwordx4 v[84:87], v103, s[16:19], s56 offen offset:0 nt
    ds_read_b64_tr_b16 a[216:217], v3 offset:18432
    v_exp_f32 v53, v53
    v_mfma_f32_16x16x32_bf16 v[72:75], a[224:227], a[156:159], v[72:75]
    s_add_u32 s20, s20, 128
    ds_read_b64_tr_b16 a[218:219], v3 offset:12288
    v_cvt_pk_bf16_f32 v20, v60, v61
    v_mfma_f32_16x16x32_bf16 v[64:67], a[224:227], a[132:135], v[64:67]
    s_add_u32 m0, s22, 1024
    v_exp_f32 v55, v55
    v_mfma_f32_16x16x32_bf16 v[64:67], a[228:231], a[136:139], v[64:67]
    buffer_load_dwordx4 v6, s[4:7], s20 offen lds
    v_mfma_f32_16x16x32_bf16 v[64:67], a[232:235], a[140:143], v[64:67]
    s_add_u32 s20, s20, 128
    ds_read_b64_tr_b16 a[220:221], v4 offset:18432
    v_cvt_pk_bf16_f32 v15, v54, v55
    v_mfma_f32_16x16x32_bf16 v[56:59], a[232:235], a[116:119], v[56:59]
    s_add_u32 m0, s22, 2048
    ds_read_b64_tr_b16 a[222:223], v4 offset:12288
    v_cvt_pk_bf16_f32 v14, v52, v53
    v_mfma_f32_16x16x32_bf16 v[56:59], a[228:231], a[112:115], v[56:59]
    buffer_load_dwordx4 v6, s[4:7], s20 offen lds
    v_mfma_f32_16x16x32_bf16 v[56:59], a[224:227], a[108:111], v[56:59]
    s_add_u32 s20, s20, 12032
    ds_read_b64_tr_b16 a[224:225], v5 offset:18432
    ds_read_b64_tr_b16 a[226:227], v5 offset:12288
    s_branch L_loop4
L_end5:
    s_waitcnt lgkmcnt(4)
    v_mfma_f32_16x16x32_bf16 v[112:115], a[212:215], v[16:19], v[112:115]
    v_mfma_f32_16x16x32_bf16 v[116:119], a[216:219], v[16:19], v[116:119]
    v_fma_f32 v85, v85, s28, v13
    v_fma_f32 v83, v83, s28, v12
    v_mfma_f32_16x16x32_bf16 v[164:167], a[216:219], v[22:25], v[164:167]
    v_fma_f32 v78, v78, s28, v12
    v_fma_f32 v68, v68, s28, v11
    v_mfma_f32_16x16x32_bf16 v[160:163], a[212:215], v[22:25], v[160:163]
    ds_read_b64_tr_b16 a[230:231], v2 offset:13312
    v_fma_f32 v84, v84, s28, v13
    v_mfma_f32_16x16x32_bf16 v[208:211], a[212:215], v[28:31], v[208:211]
    ds_read_b64_tr_b16 a[232:233], v3 offset:19456
    v_fma_f32 v79, v79, s28, v12
    v_mfma_f32_16x16x32_bf16 v[212:215], a[216:219], v[28:31], v[212:215]
    ds_read_b64_tr_b16 a[234:235], v3 offset:13312
    v_mfma_f32_16x16x32_bf16 a[4:7], a[216:219], v[34:37], a[4:7]
    v_fma_f32 v69, v69, s28, v11
    v_fma_f32 v81, v81, s28, v12
    v_mfma_f32_16x16x32_bf16 a[0:3], a[212:215], v[34:37], a[0:3]
    ds_read_b64_tr_b16 a[228:229], v2 offset:19456
    v_mfma_f32_16x16x32_bf16 a[48:51], a[212:215], v[40:43], a[48:51]
    v_fma_f32 v71, v71, s28, v11
    v_mfma_f32_16x16x32_bf16 a[52:55], a[216:219], v[40:43], a[52:55]
    s_waitcnt lgkmcnt(4)
    ds_read_b64_tr_b16 a[214:215], v4 offset:13312
    v_fma_f32 v59, v59, s28, v9
    v_mfma_f32_16x16x32_bf16 a[56:59], a[220:223], v[40:43], a[56:59]
    v_fma_f32 v76, v76, s28, v12
    v_fma_f32 v87, v87, s28, v13
    v_mfma_f32_16x16x32_bf16 a[60:63], a[224:227], v[40:43], a[60:63]
    ds_read_b64_tr_b16 a[216:217], v5 offset:19456
    v_mfma_f32_16x16x32_bf16 a[12:15], a[224:227], v[34:37], a[12:15]
    v_exp_f32 v83, v83
    v_mfma_f32_16x16x32_bf16 a[8:11], a[220:223], v[34:37], a[8:11]
    ds_read_b64_tr_b16 a[212:213], v4 offset:19456
    v_mfma_f32_16x16x32_bf16 v[216:219], a[220:223], v[28:31], v[216:219]
    v_fma_f32 v74, v74, s28, v11
    v_fma_f32 v89, v89, s28, v13
    v_mfma_f32_16x16x32_bf16 v[220:223], a[224:227], v[28:31], v[220:223]
    v_fma_f32 v82, v82, s28, v12
    v_mfma_f32_16x16x32_bf16 v[172:175], a[224:227], v[22:25], v[172:175]
    v_fma_f32 v90, v90, s28, v13
    v_mfma_f32_16x16x32_bf16 v[168:171], a[220:223], v[22:25], v[168:171]
    ds_read_b64_tr_b16 a[218:219], v5 offset:13312
    v_fma_f32 v57, v57, s28, v9
    v_mfma_f32_16x16x32_bf16 v[120:123], a[220:223], v[16:19], v[120:123]
    v_exp_f32 v69, v69
    v_mfma_f32_16x16x32_bf16 v[124:127], a[224:227], v[16:19], v[124:127]
    s_waitcnt lgkmcnt(3)
    v_exp_f32 v85, v85
    v_mfma_f32_16x16x32_bf16 v[128:131], a[228:231], v[16:19], v[128:131]
    ds_read_b64_tr_b16 a[220:221], v2 offset:20480
    v_fma_f32 v75, v75, s28, v11
    v_mfma_f32_16x16x32_bf16 v[132:135], a[232:235], v[16:19], v[132:135]
    ds_read_b64_tr_b16 a[222:223], v2 offset:14336
    v_mfma_f32_16x16x32_bf16 v[180:183], a[232:235], v[22:25], v[180:183]
    v_exp_f32 v84, v84
    v_mfma_f32_16x16x32_bf16 v[176:179], a[228:231], v[22:25], v[176:179]
    s_add_u32 s39, s39, 12288
    v_fma_f32 v56, v56, s28, v9
    v_fma_f32 v73, v73, s28, v11
    v_mfma_f32_16x16x32_bf16 v[224:227], a[228:231], v[28:31], v[224:227]
    v_exp_f32 v87, v87
    v_mfma_f32_16x16x32_bf16 v[228:231], a[232:235], v[28:31], v[228:231]
    v_fma_f32 v77, v77, s28, v12
    v_mfma_f32_16x16x32_bf16 a[20:23], a[232:235], v[34:37], a[20:23]
    ds_read_b64_tr_b16 a[226:227], v3 offset:14336
    v_fma_f32 v86, v86, s28, v13
    v_mfma_f32_16x16x32_bf16 a[16:19], a[228:231], v[34:37], a[16:19]
    v_exp_f32 v68, v68
    v_mfma_f32_16x16x32_bf16 a[64:67], a[228:231], v[40:43], a[64:67]
    v_fma_f32 v91, v91, s28, v13
    v_fma_f32 v70, v70, s28, v11
    v_mfma_f32_16x16x32_bf16 a[68:71], a[232:235], v[40:43], a[68:71]
    s_waitcnt lgkmcnt(3)
    ds_read_b64_tr_b16 a[228:229], v4 offset:20480
    v_fma_f32 v80, v80, s28, v12
    v_mfma_f32_16x16x32_bf16 a[72:75], a[212:215], v[40:43], a[72:75]
    ds_read_b64_tr_b16 a[224:225], v3 offset:20480
    v_fma_f32 v88, v88, s28, v13
    v_mfma_f32_16x16x32_bf16 a[76:79], a[216:219], v[40:43], a[76:79]
    v_exp_f32 v76, v76
    v_mfma_f32_16x16x32_bf16 a[28:31], a[216:219], v[34:37], a[28:31]
    ds_read_b64_tr_b16 a[232:233], v5 offset:20480
    v_mfma_f32_16x16x32_bf16 a[24:27], a[212:215], v[34:37], a[24:27]
    ds_read_b64_tr_b16 a[234:235], v5 offset:14336
    v_cvt_pk_bf16_f32 v38, v84, v85
    v_mfma_f32_16x16x32_bf16 v[232:235], a[212:215], v[28:31], v[232:235]
    ds_read_b64_tr_b16 a[230:231], v4 offset:14336
    v_mfma_f32_16x16x32_bf16 v[236:239], a[216:219], v[28:31], v[236:239]
    v_exp_f32 v77, v77
    v_mfma_f32_16x16x32_bf16 v[188:191], a[216:219], v[22:25], v[188:191]
    v_exp_f32 v57, v57
    v_mfma_f32_16x16x32_bf16 v[184:187], a[212:215], v[22:25], v[184:187]
    v_exp_f32 v78, v78
    v_mfma_f32_16x16x32_bf16 v[136:139], a[212:215], v[16:19], v[136:139]
    v_fma_f32 v72, v72, s28, v11
    v_cvt_pk_bf16_f32 v26, v68, v69
    v_mfma_f32_16x16x32_bf16 v[140:143], a[216:219], v[16:19], v[140:143]
    s_waitcnt lgkmcnt(4)
    v_mfma_f32_16x16x32_bf16 v[144:147], a[220:223], v[16:19], v[144:147]
    s_waitcnt lgkmcnt(3)
    v_exp_f32 v79, v79
    v_mfma_f32_16x16x32_bf16 v[148:151], a[224:227], v[16:19], v[148:151]
    v_exp_f32 v70, v70
    v_mfma_f32_16x16x32_bf16 v[196:199], a[224:227], v[22:25], v[196:199]
    v_exp_f32 v71, v71
    v_mfma_f32_16x16x32_bf16 v[192:195], a[220:223], v[22:25], v[192:195]
    v_exp_f32 v59, v59
    v_mfma_f32_16x16x32_bf16 v[240:243], a[220:223], v[28:31], v[240:243]
    v_exp_f32 v75, v75
    v_mfma_f32_16x16x32_bf16 v[244:247], a[224:227], v[28:31], v[244:247]
    s_waitcnt vmcnt(10) lgkmcnt(0)
    v_exp_f32 v89, v89
    v_mfma_f32_16x16x32_bf16 a[36:39], a[224:227], v[34:37], a[36:39]
    v_fma_f32 v67, v67, s28, v10
    v_mfma_f32_16x16x32_bf16 a[32:35], a[220:223], v[34:37], a[32:35]
    s_barrier
    v_mfma_f32_16x16x32_bf16 a[80:83], a[220:223], v[40:43], a[80:83]
    ds_read_b128 a[212:215], v0 offset:12288
    v_cvt_pk_bf16_f32 v32, v76, v77
    v_mfma_f32_16x16x32_bf16 a[84:87], a[224:227], v[40:43], a[84:87]
    ds_read_b128 a[220:223], v0 offset:13312
    s_add_u32 m0, s22, 36864
    v_mfma_f32_16x16x32_bf16 a[88:91], a[228:231], v[40:43], a[88:91]
    ds_read_b128 a[216:219], v1 offset:12288
    v_cvt_pk_bf16_f32 v27, v70, v71
    v_mfma_f32_16x16x32_bf16 a[92:95], a[232:235], v[40:43], a[92:95]
    v_exp_f32 v72, v72
    v_mfma_f32_16x16x32_bf16 a[44:47], a[232:235], v[34:37], a[44:47]
    buffer_load_dwordx4 v6, s[8:11], s21 offen lds
    v_mfma_f32_16x16x32_bf16 a[40:43], a[228:231], v[34:37], a[40:43]
    s_add_u32 s21, s21, 128
    s_add_u32 m0, s22, 37888
    v_fma_f32 v58, v58, s28, v9
    v_mfma_f32_16x16x32_bf16 v[248:251], a[228:231], v[28:31], v[248:251]
    buffer_load_dwordx4 v6, s[8:11], s21 offen lds
    v_mfma_f32_16x16x32_bf16 v[252:255], a[232:235], v[28:31], v[252:255]
    ds_read_b128 a[224:227], v1 offset:13312
    v_fma_f32 v64, v64, s28, v10
    v_mfma_f32_16x16x32_bf16 v[204:207], a[232:235], v[22:25], v[204:207]
    v_exp_f32 v64, v64
    v_mfma_f32_16x16x32_bf16 v[200:203], a[228:231], v[22:25], v[200:203]
    s_add_u32 s21, s21, 128
    s_add_u32 m0, s22, 38912
    v_mfma_f32_16x16x32_bf16 v[152:155], a[228:231], v[16:19], v[152:155]
    buffer_load_dwordx4 v6, s[8:11], s21 offen lds
    v_mfma_f32_16x16x32_bf16 v[156:159], a[232:235], v[16:19], v[156:159]
    s_waitcnt lgkmcnt(2)
    ds_read_b128 a[228:231], v0 offset:14336
    v_mfma_f32_16x16x32_bf16 v[52:55], a[212:215], a[96:99], 0
    s_waitcnt lgkmcnt(2)
    v_cvt_pk_bf16_f32 v33, v78, v79
    v_mfma_f32_16x16x32_bf16 v[52:55], a[216:219], a[100:103], v[52:55]
    v_exp_f32 v86, v86
    v_mfma_f32_16x16x32_bf16 v[52:55], a[220:223], a[104:107], v[52:55]
    v_exp_f32 v73, v73
    v_mfma_f32_16x16x32_bf16 v[60:63], a[220:223], a[128:131], 0
    v_exp_f32 v88, v88
    v_mfma_f32_16x16x32_bf16 v[60:63], a[216:219], a[124:127], v[60:63]
    v_exp_f32 v56, v56
    v_mfma_f32_16x16x32_bf16 v[60:63], a[212:215], a[120:123], v[60:63]
    v_exp_f32 v81, v81
    v_mfma_f32_16x16x32_bf16 v[68:71], a[212:215], a[144:147], 0
    ds_read_b128 a[232:235], v1 offset:14336
    v_cvt_pk_bf16_f32 v16, v56, v57
    v_mfma_f32_16x16x32_bf16 v[68:71], a[216:219], a[148:151], v[68:71]
    v_fma_f32 v65, v65, s28, v10
    v_fma_f32 v66, v66, s28, v10
    v_mfma_f32_16x16x32_bf16 v[68:71], a[220:223], a[152:155], v[68:71]
    v_exp_f32 v82, v82
    v_mfma_f32_16x16x32_bf16 v[76:79], a[220:223], a[176:179], 0
    v_cvt_pk_bf16_f32 v39, v86, v87
    v_cvt_pk_bf16_f32 v35, v82, v83
    v_mfma_f32_16x16x32_bf16 v[76:79], a[216:219], a[172:175], v[76:79]
    v_exp_f32 v58, v58
    v_mfma_f32_16x16x32_bf16 v[76:79], a[212:215], a[168:171], v[76:79]
    v_exp_f32 v66, v66
    v_mfma_f32_16x16x32_bf16 v[84:87], a[212:215], a[192:195], 0
    v_exp_f32 v65, v65
    v_mfma_f32_16x16x32_bf16 v[84:87], a[216:219], a[196:199], v[84:87]
    v_mfma_f32_16x16x32_bf16 v[84:87], a[220:223], a[200:203], v[84:87]
    s_waitcnt lgkmcnt(1)
    v_exp_f32 v74, v74
    v_mfma_f32_16x16x32_bf16 v[84:87], a[224:227], a[204:207], v[84:87]
    v_exp_f32 v80, v80
    v_mfma_f32_16x16x32_bf16 v[84:87], a[228:231], a[208:211], v[84:87]
    s_waitcnt lgkmcnt(0)
    ds_read_b128 a[212:215], v0 offset:18432
    v_mfma_f32_16x16x32_bf16 v[84:87], a[232:235], v[92:95], v[84:87]
    v_exp_f32 v67, v67
    v_mfma_f32_16x16x32_bf16 v[76:79], a[232:235], a[188:191], v[76:79]
    v_exp_f32 v90, v90
    v_mfma_f32_16x16x32_bf16 v[76:79], a[228:231], a[184:187], v[76:79]
    v_cvt_pk_bf16_f32 v22, v64, v65
    v_cvt_pk_bf16_f32 v17, v58, v59
    v_mfma_f32_16x16x32_bf16 v[76:79], a[224:227], a[180:183], v[76:79]
    ds_read_b128 a[216:219], v1 offset:18432
    v_mfma_f32_16x16x32_bf16 v[68:71], a[224:227], a[156:159], v[68:71]
    v_cvt_pk_bf16_f32 v23, v66, v67
    v_cvt_pk_bf16_f32 v29, v74, v75
    v_mfma_f32_16x16x32_bf16 v[68:71], a[228:231], a[160:163], v[68:71]
    ds_read_b128 a[220:223], v0 offset:19456
    v_cvt_pk_bf16_f32 v40, v88, v89
    v_mfma_f32_16x16x32_bf16 v[68:71], a[232:235], a[164:167], v[68:71]
    v_cvt_pk_bf16_f32 v28, v72, v73
    v_mfma_f32_16x16x32_bf16 v[60:63], a[232:235], a[140:143], v[60:63]
    v_mfma_f32_16x16x32_bf16 v[60:63], a[228:231], a[136:139], v[60:63]
    v_exp_f32 v91, v91
    v_mfma_f32_16x16x32_bf16 v[60:63], a[224:227], a[132:135], v[60:63]
    v_mfma_f32_16x16x32_bf16 v[52:55], a[224:227], a[108:111], v[52:55]
    v_cvt_pk_bf16_f32 v34, v80, v81
    v_mfma_f32_16x16x32_bf16 v[52:55], a[228:231], a[112:115], v[52:55]
    ds_read_b128 a[224:227], v1 offset:19456
    v_mfma_f32_16x16x32_bf16 v[52:55], a[232:235], a[116:119], v[52:55]
    ds_read_b128 a[228:231], v0 offset:20480
    v_mfma_f32_16x16x32_bf16 v[44:47], a[236:239], v[14:17], v[48:51]
    ds_read_b128 a[232:235], v1 offset:20480
    v_mfma_f32_16x16x32_bf16 v[44:47], a[240:243], v[20:23], v[44:47]
    s_add_u32 s21, s21, 12032
    v_mfma_f32_16x16x32_bf16 v[44:47], a[244:247], v[26:29], v[44:47]
    v_cvt_pk_bf16_f32 v41, v90, v91
    v_mfma_f32_16x16x32_bf16 v[44:47], a[248:251], v[32:35], v[44:47]
    s_nop 0
    v_mfma_f32_16x16x32_bf16 v[44:47], a[252:255], v[38:41], v[44:47]
    s_waitcnt lgkmcnt(3)
    v_mfma_f32_16x16x32_bf16 v[56:59], a[212:215], a[96:99], 0
    v_mfma_f32_16x16x32_bf16 v[56:59], a[216:219], a[100:103], v[56:59]
    v_mfma_f32_16x16x32_bf16 v[56:59], a[220:223], a[104:107], v[56:59]
    v_mfma_f32_16x16x32_bf16 v[64:67], a[220:223], a[128:131], 0
    v_mfma_f32_16x16x32_bf16 v[64:67], a[216:219], a[124:127], v[64:67]
    v_mfma_f32_16x16x32_bf16 v[64:67], a[212:215], a[120:123], v[64:67]
    s_nop 0
    v_cmp_lt_f32 vcc, s29, v44
    s_waitcnt vmcnt(7) lgkmcnt(0)
    v_mfma_f32_16x16x32_bf16 v[72:75], a[212:215], a[144:147], 0
    s_barrier
    v_mfma_f32_16x16x32_bf16 v[72:75], a[216:219], a[148:151], v[72:75]
    s_nop 0
    s_cbranch_vccnz L_rs_end5a
L_ret_end5a:
    v_mfma_f32_16x16x32_bf16 v[72:75], a[220:223], a[152:155], v[72:75]
    v_fma_f32 v55, v55, s28, v9
    v_mfma_f32_16x16x32_bf16 v[80:83], a[220:223], a[176:179], 0
    v_fma_f32 v52, v52, s28, v9
    v_fma_f32 v60, v60, s28, v10
    v_mfma_f32_16x16x32_bf16 v[80:83], a[216:219], a[172:175], v[80:83]
    v_fma_f32 v63, v63, s28, v10
    v_mfma_f32_16x16x32_bf16 v[80:83], a[212:215], a[168:171], v[80:83]
    v_fma_f32 v61, v61, s28, v10
    v_fma_f32 v53, v53, s28, v9
    v_mfma_f32_16x16x32_bf16 v[88:91], a[212:215], a[192:195], 0
    v_exp_f32 v52, v52
    v_mfma_f32_16x16x32_bf16 v[88:91], a[216:219], a[196:199], v[88:91]
    v_exp_f32 v55, v55
    v_mfma_f32_16x16x32_bf16 v[88:91], a[220:223], a[200:203], v[88:91]
    v_fma_f32 v54, v54, s28, v9
    v_mfma_f32_16x16x32_bf16 v[88:91], a[224:227], a[204:207], v[88:91]
    ds_read_b64_tr_b16 a[212:213], v2 offset:0
    v_mfma_f32_16x16x32_bf16 v[88:91], a[228:231], a[208:211], v[88:91]
    v_exp_f32 v54, v54
    v_mfma_f32_16x16x32_bf16 v[88:91], a[232:235], v[92:95], v[88:91]
    v_exp_f32 v53, v53
    v_mfma_f32_16x16x32_bf16 v[80:83], a[232:235], a[188:191], v[80:83]
    ds_read_b64_tr_b16 a[214:215], v2 offset:6144
    v_fma_f32 v62, v62, s28, v10
    v_mfma_f32_16x16x32_bf16 v[80:83], a[228:231], a[184:187], v[80:83]
    ds_read_b64_tr_b16 a[216:217], v3 offset:0
    v_cvt_pk_bf16_f32 v18, v52, v53
    v_mfma_f32_16x16x32_bf16 v[80:83], a[224:227], a[180:183], v[80:83]
    ds_read_b64_tr_b16 a[218:219], v3 offset:6144
    v_cvt_pk_bf16_f32 v19, v54, v55
    v_mfma_f32_16x16x32_bf16 v[72:75], a[224:227], a[156:159], v[72:75]
    v_exp_f32 v61, v61
    v_mfma_f32_16x16x32_bf16 v[72:75], a[228:231], a[160:163], v[72:75]
    v_exp_f32 v60, v60
    v_mfma_f32_16x16x32_bf16 v[72:75], a[232:235], a[164:167], v[72:75]
    v_exp_f32 v62, v62
    v_mfma_f32_16x16x32_bf16 v[64:67], a[232:235], a[140:143], v[64:67]
    ds_read_b64_tr_b16 a[220:221], v4 offset:0
    v_mfma_f32_16x16x32_bf16 v[64:67], a[228:231], a[136:139], v[64:67]
    ds_read_b64_tr_b16 a[222:223], v4 offset:6144
    v_cvt_pk_bf16_f32 v24, v60, v61
    v_mfma_f32_16x16x32_bf16 v[64:67], a[224:227], a[132:135], v[64:67]
    v_mfma_f32_16x16x32_bf16 v[56:59], a[224:227], a[108:111], v[56:59]
    v_exp_f32 v63, v63
    v_mfma_f32_16x16x32_bf16 v[56:59], a[228:231], a[112:115], v[56:59]
    ds_read_b64_tr_b16 a[224:225], v5 offset:0
    v_mfma_f32_16x16x32_bf16 v[56:59], a[232:235], a[116:119], v[56:59]
    ds_read_b64_tr_b16 a[226:227], v5 offset:6144
    v_cvt_pk_bf16_f32 v25, v62, v63
    s_waitcnt lgkmcnt(4)
    v_mfma_f32_16x16x32_bf16 v[112:115], a[212:215], v[14:17], v[112:115]
    s_nop 3
    v_fma_f32 v59, v59, s28, v9
    v_fma_f32 v84, v84, s28, v13
    v_mfma_f32_16x16x32_bf16 v[116:119], a[216:219], v[14:17], v[116:119]
    v_fma_f32 v91, v91, s28, v13
    v_fma_f32 v90, v90, s28, v13
    v_mfma_f32_16x16x32_bf16 v[164:167], a[216:219], v[20:23], v[164:167]
    s_add_u32 s39, s39, 12288
    v_fma_f32 v82, v82, s28, v12
    v_fma_f32 v70, v70, s28, v11
    v_mfma_f32_16x16x32_bf16 v[160:163], a[212:215], v[20:23], v[160:163]
    s_waitcnt vmcnt(0)
    v_fma_f32 v79, v79, s28, v12
    v_fma_f32 v83, v83, s28, v12
    v_mfma_f32_16x16x32_bf16 v[208:211], a[212:215], v[26:29], v[208:211]
    s_barrier
    v_mfma_f32_16x16x32_bf16 v[212:215], a[216:219], v[26:29], v[212:215]
    v_exp_f32 v79, v79
    v_mfma_f32_16x16x32_bf16 a[4:7], a[216:219], v[32:35], a[4:7]
    v_exp_f32 v82, v82
    v_mfma_f32_16x16x32_bf16 a[0:3], a[212:215], v[32:35], a[0:3]
    ds_read_b64_tr_b16 a[232:233], v3 offset:1024
    v_fma_f32 v78, v78, s28, v12
    v_mfma_f32_16x16x32_bf16 a[48:51], a[212:215], v[38:41], a[48:51]
    ds_read_b64_tr_b16 a[228:229], v2 offset:1024
    v_fma_f32 v75, v75, s28, v11
    v_mfma_f32_16x16x32_bf16 a[52:55], a[216:219], v[38:41], a[52:55]
    s_waitcnt lgkmcnt(2)
    ds_read_b64_tr_b16 a[230:231], v2 offset:7168
    v_fma_f32 v74, v74, s28, v11
    v_mfma_f32_16x16x32_bf16 a[56:59], a[220:223], v[38:41], a[56:59]
    ds_read_b64_tr_b16 a[234:235], v3 offset:7168
    v_fma_f32 v85, v85, s28, v13
    v_fma_f32 v72, v72, s28, v11
    v_mfma_f32_16x16x32_bf16 a[60:63], a[224:227], v[38:41], a[60:63]
    ds_read_b64_tr_b16 a[214:215], v4 offset:7168
    v_exp_f32 v78, v78
    v_mfma_f32_16x16x32_bf16 a[12:15], a[224:227], v[32:35], a[12:15]
    v_fma_f32 v73, v73, s28, v11
    v_fma_f32 v58, v58, s28, v9
    v_mfma_f32_16x16x32_bf16 a[8:11], a[220:223], v[32:35], a[8:11]
    v_fma_f32 v81, v81, s28, v12
    v_fma_f32 v56, v56, s28, v9
    v_mfma_f32_16x16x32_bf16 v[216:219], a[220:223], v[26:29], v[216:219]
    ds_read_b64_tr_b16 a[216:217], v5 offset:1024
    v_fma_f32 v88, v88, s28, v13
    v_mfma_f32_16x16x32_bf16 v[220:223], a[224:227], v[26:29], v[220:223]
    ds_read_b64_tr_b16 a[212:213], v4 offset:1024
    v_fma_f32 v68, v68, s28, v11
    v_mfma_f32_16x16x32_bf16 v[172:175], a[224:227], v[20:23], v[172:175]
    v_fma_f32 v65, v65, s28, v10
    v_fma_f32 v71, v71, s28, v11
    v_mfma_f32_16x16x32_bf16 v[168:171], a[220:223], v[20:23], v[168:171]
    v_exp_f32 v83, v83
    v_mfma_f32_16x16x32_bf16 v[120:123], a[220:223], v[14:17], v[120:123]
    ds_read_b64_tr_b16 a[220:221], v2 offset:2048
    v_fma_f32 v64, v64, s28, v10
    v_mfma_f32_16x16x32_bf16 v[124:127], a[224:227], v[14:17], v[124:127]
    s_waitcnt lgkmcnt(5)
    ds_read_b64_tr_b16 a[218:219], v5 offset:7168
    v_fma_f32 v69, v69, s28, v11
    v_mfma_f32_16x16x32_bf16 v[128:131], a[228:231], v[14:17], v[128:131]
    s_waitcnt lgkmcnt(5)
    ds_read_b64_tr_b16 a[222:223], v2 offset:8192
    v_fma_f32 v86, v86, s28, v13
    v_mfma_f32_16x16x32_bf16 v[132:135], a[232:235], v[14:17], v[132:135]
    v_exp_f32 v81, v81
    v_mfma_f32_16x16x32_bf16 v[180:183], a[232:235], v[20:23], v[180:183]
    v_exp_f32 v59, v59
    v_mfma_f32_16x16x32_bf16 v[176:179], a[228:231], v[20:23], v[176:179]
    v_exp_f32 v65, v65
    v_mfma_f32_16x16x32_bf16 v[224:227], a[228:231], v[26:29], v[224:227]
    ds_read_b64_tr_b16 a[224:225], v3 offset:2048
    v_fma_f32 v80, v80, s28, v12
    v_mfma_f32_16x16x32_bf16 v[228:231], a[232:235], v[26:29], v[228:231]
    v_exp_f32 v64, v64
    v_mfma_f32_16x16x32_bf16 a[20:23], a[232:235], v[32:35], a[20:23]
    v_fma_f32 v66, v66, s28, v10
    v_exp_f32 v91, v91
    v_mfma_f32_16x16x32_bf16 a[16:19], a[228:231], v[32:35], a[16:19]
    v_exp_f32 v68, v68
    v_mfma_f32_16x16x32_bf16 a[64:67], a[228:231], v[38:41], a[64:67]
    ds_read_b64_tr_b16 a[226:227], v3 offset:8192
    v_fma_f32 v67, v67, s28, v10
    v_mfma_f32_16x16x32_bf16 a[68:71], a[232:235], v[38:41], a[68:71]
    s_waitcnt lgkmcnt(3)
    ds_read_b64_tr_b16 a[232:233], v5 offset:2048
    v_fma_f32 v89, v89, s28, v13
    v_mfma_f32_16x16x32_bf16 a[72:75], a[212:215], v[38:41], a[72:75]
    v_exp_f32 v84, v84
    v_mfma_f32_16x16x32_bf16 a[76:79], a[216:219], v[38:41], a[76:79]
    v_exp_f32 v89, v89
    v_mfma_f32_16x16x32_bf16 a[28:31], a[216:219], v[32:35], a[28:31]
    ds_read_b64_tr_b16 a[234:235], v5 offset:8192
    v_fma_f32 v77, v77, s28, v12
    v_mfma_f32_16x16x32_bf16 a[24:27], a[212:215], v[32:35], a[24:27]
    v_exp_f32 v73, v73
    v_mfma_f32_16x16x32_bf16 v[232:235], a[212:215], v[26:29], v[232:235]
    v_fma_f32 v57, v57, s28, v9
    v_exp_f32 v88, v88
    v_mfma_f32_16x16x32_bf16 v[236:239], a[216:219], v[26:29], v[236:239]
    v_exp_f32 v66, v66
    v_mfma_f32_16x16x32_bf16 v[188:191], a[216:219], v[20:23], v[188:191]
    v_exp_f32 v85, v85
    v_mfma_f32_16x16x32_bf16 v[184:187], a[212:215], v[20:23], v[184:187]
    ds_read_b64_tr_b16 a[230:231], v4 offset:8192
    v_fma_f32 v76, v76, s28, v12
    v_mfma_f32_16x16x32_bf16 v[136:139], a[212:215], v[14:17], v[136:139]
    ds_read_b64_tr_b16 a[228:229], v4 offset:2048
    v_cvt_pk_bf16_f32 v42, v84, v85
    v_mfma_f32_16x16x32_bf16 v[140:143], a[216:219], v[14:17], v[140:143]
    s_waitcnt lgkmcnt(3)
    v_exp_f32 v74, v74
    v_mfma_f32_16x16x32_bf16 v[144:147], a[220:223], v[14:17], v[144:147]
    v_exp_f32 v77, v77
    v_mfma_f32_16x16x32_bf16 v[148:151], a[224:227], v[14:17], v[148:151]
    v_exp_f32 v71, v71
    v_mfma_f32_16x16x32_bf16 v[196:199], a[224:227], v[20:23], v[196:199]
    v_exp_f32 v80, v80
    v_mfma_f32_16x16x32_bf16 v[192:195], a[220:223], v[20:23], v[192:195]
    v_exp_f32 v90, v90
    v_mfma_f32_16x16x32_bf16 v[240:243], a[220:223], v[26:29], v[240:243]
    ds_read_b64_tr_b16 a[212:213], v2 offset:18432
    v_fma_f32 v87, v87, s28, v13
    v_mfma_f32_16x16x32_bf16 v[244:247], a[224:227], v[26:29], v[244:247]
    v_exp_f32 v72, v72
    v_mfma_f32_16x16x32_bf16 a[36:39], a[224:227], v[32:35], a[36:39]
    v_exp_f32 v56, v56
    v_mfma_f32_16x16x32_bf16 a[32:35], a[220:223], v[32:35], a[32:35]
    v_exp_f32 v76, v76
    v_mfma_f32_16x16x32_bf16 a[80:83], a[220:223], v[38:41], a[80:83]
    v_exp_f32 v87, v87
    v_cvt_pk_bf16_f32 v37, v78, v79
    v_mfma_f32_16x16x32_bf16 a[84:87], a[224:227], v[38:41], a[84:87]
    s_waitcnt lgkmcnt(1)
    ds_read_b64_tr_b16 a[214:215], v2 offset:12288
    v_exp_f32 v70, v70
    v_mfma_f32_16x16x32_bf16 a[88:91], a[228:231], v[38:41], a[88:91]
    v_exp_f32 v86, v86
    v_mfma_f32_16x16x32_bf16 a[92:95], a[232:235], v[38:41], a[92:95]
    v_exp_f32 v75, v75
    v_mfma_f32_16x16x32_bf16 a[44:47], a[232:235], v[32:35], a[44:47]
    v_exp_f32 v69, v69
    v_mfma_f32_16x16x32_bf16 a[40:43], a[228:231], v[32:35], a[40:43]
    v_exp_f32 v57, v57
    v_cvt_pk_bf16_f32 v35, v82, v83
    v_mfma_f32_16x16x32_bf16 v[248:251], a[228:231], v[26:29], v[248:251]
    ds_read_b64_tr_b16 a[216:217], v3 offset:18432
    v_exp_f32 v58, v58
    v_mfma_f32_16x16x32_bf16 v[252:255], a[232:235], v[26:29], v[252:255]
    ds_read_b64_tr_b16 a[218:219], v3 offset:12288
    v_cvt_pk_bf16_f32 v34, v80, v81
    v_mfma_f32_16x16x32_bf16 v[204:207], a[232:235], v[20:23], v[204:207]
    v_exp_f32 v67, v67
    v_mfma_f32_16x16x32_bf16 v[200:203], a[228:231], v[20:23], v[200:203]
    v_cvt_pk_bf16_f32 v31, v70, v71
    v_cvt_pk_bf16_f32 v30, v68, v69
    v_mfma_f32_16x16x32_bf16 v[152:155], a[228:231], v[14:17], v[152:155]
    v_cvt_pk_bf16_f32 v28, v72, v73
    v_cvt_pk_bf16_f32 v23, v66, v67
    v_mfma_f32_16x16x32_bf16 v[156:159], a[232:235], v[14:17], v[156:159]
    ds_read_b64_tr_b16 a[220:221], v4 offset:18432
    v_cvt_pk_bf16_f32 v16, v56, v57
    v_cvt_pk_bf16_f32 v17, v58, v59
    v_cvt_pk_bf16_f32 v43, v86, v87
    v_cvt_pk_bf16_f32 v22, v64, v65
    v_mfma_f32_16x16x32_bf16 v[48:51], a[236:239], v[16:19], v[44:47]
    v_cvt_pk_bf16_f32 v36, v76, v77
    v_cvt_pk_bf16_f32 v29, v74, v75
    v_mfma_f32_16x16x32_bf16 v[48:51], a[240:243], v[22:25], v[48:51]
    ds_read_b64_tr_b16 a[222:223], v4 offset:12288
    v_cvt_pk_bf16_f32 v41, v90, v91
    v_mfma_f32_16x16x32_bf16 v[48:51], a[244:247], v[28:31], v[48:51]
    ds_read_b64_tr_b16 a[224:225], v5 offset:18432
    v_cvt_pk_bf16_f32 v40, v88, v89
    v_mfma_f32_16x16x32_bf16 v[48:51], a[248:251], v[34:37], v[48:51]
    ds_read_b64_tr_b16 a[226:227], v5 offset:12288
    v_mfma_f32_16x16x32_bf16 v[48:51], a[252:255], v[40:43], v[48:51]
    s_nop 7
    v_cmp_lt_f32 vcc, s29, v48
    s_nop 4
    s_cbranch_vccnz L_rs_end5b
L_ret_end5b:
    s_waitcnt lgkmcnt(4)
    v_mfma_f32_16x16x32_bf16 v[112:115], a[212:215], v[16:19], v[112:115]
    v_mfma_f32_16x16x32_bf16 v[116:119], a[216:219], v[16:19], v[116:119]
    s_add_u32 s84, s34, 0
    v_mbcnt_lo_u32_b32 v104, -1, 0
    v_mbcnt_hi_u32_b32 v104, -1, v104
    v_mfma_f32_16x16x32_bf16 v[164:167], a[216:219], v[22:25], v[164:167]
    ds_read_b64_tr_b16 a[232:233], v3 offset:19456
    v_lshrrev_b32 v106, 5, v104
    v_mfma_f32_16x16x32_bf16 v[160:163], a[212:215], v[22:25], v[160:163]
    ds_read_b64_tr_b16 a[234:235], v3 offset:13312
    v_bfe_u32 v105, v104, 3, 1
    v_mfma_f32_16x16x32_bf16 v[208:211], a[212:215], v[28:31], v[208:211]
    v_rcp_f32 v50, v50
    v_mfma_f32_16x16x32_bf16 v[212:215], a[216:219], v[28:31], v[212:215]
    v_rcp_f32 v49, v49
    v_mfma_f32_16x16x32_bf16 a[4:7], a[216:219], v[34:37], a[4:7]
    v_rcp_f32 v51, v51
    v_mfma_f32_16x16x32_bf16 a[0:3], a[212:215], v[34:37], a[0:3]
    ds_read_b64_tr_b16 a[228:229], v2 offset:19456
    v_mul_f32 v162, v162, v49
    v_mfma_f32_16x16x32_bf16 a[48:51], a[212:215], v[40:43], a[48:51]
    ds_read_b64_tr_b16 a[230:231], v2 offset:13312
    v_xor_b32 v106, v106, v105
    v_mfma_f32_16x16x32_bf16 a[52:55], a[216:219], v[40:43], a[52:55]
    s_waitcnt lgkmcnt(4)
    ds_read_b64_tr_b16 a[214:215], v4 offset:13312
    v_xor_b32 v105, s65, v105
    v_mfma_f32_16x16x32_bf16 a[56:59], a[220:223], v[40:43], a[56:59]
    v_mul_f32 v167, v167, v49
    v_and_b32 v107, 3, v104
    v_mfma_f32_16x16x32_bf16 a[60:63], a[224:227], v[40:43], a[60:63]
    ds_read_b64_tr_b16 a[216:217], v5 offset:19456
    v_mfma_f32_16x16x32_bf16 a[12:15], a[224:227], v[34:37], a[12:15]
    s_add_u32 s85, s34, 6144
    v_mul_f32 v160, v160, v49
    v_mul_f32 v161, v161, v49
    v_mfma_f32_16x16x32_bf16 a[8:11], a[220:223], v[34:37], a[8:11]
    ds_read_b64_tr_b16 a[218:219], v5 offset:13312
    v_mul_f32 v166, v166, v49
    v_mfma_f32_16x16x32_bf16 v[216:219], a[220:223], v[28:31], v[216:219]
    v_accvgpr_read_b32 v108, a4
    v_mov_b32 v100, v48
    v_mfma_f32_16x16x32_bf16 v[220:223], a[224:227], v[28:31], v[220:223]
    v_lshl_add_u32 v101, v105, 10, s38
    v_mul_f32 v165, v165, v49
    v_mfma_f32_16x16x32_bf16 v[172:175], a[224:227], v[22:25], v[172:175]
    v_accvgpr_read_b32 v53, a9
    v_lshl_or_b32 v106, v107, 1, v106
    v_mfma_f32_16x16x32_bf16 v[168:171], a[220:223], v[22:25], v[168:171]
    v_mfma_f32_16x16x32_bf16 v[120:123], a[220:223], v[16:19], v[120:123]
    v_lshl_add_u32 v101, v106, 4, v101
    v_accvgpr_read_b32 v56, a12
    v_mfma_f32_16x16x32_bf16 v[124:127], a[224:227], v[16:19], v[124:127]
    s_waitcnt lgkmcnt(2)
    ds_read_b64_tr_b16 a[220:221], v2 offset:20480
    v_mul_f32 v174, v174, v49
    v_mfma_f32_16x16x32_bf16 v[128:131], a[228:231], v[16:19], v[128:131]
    ds_read_b64_tr_b16 a[212:213], v4 offset:19456
    v_mul_f32 v108, v108, v51
    v_mfma_f32_16x16x32_bf16 v[132:135], a[232:235], v[16:19], v[132:135]
    v_permlane32_swap_b32 v48, v100
    v_mfma_f32_16x16x32_bf16 v[180:183], a[232:235], v[22:25], v[180:183]
    s_add_u32 s86, s34, 12288
    v_mul_f32 v172, v172, v49
    v_and_b32 v107, 7, v104
    v_mfma_f32_16x16x32_bf16 v[176:179], a[228:231], v[22:25], v[176:179]
    v_subrev_u32 v8, 28672, v8
    v_mul_f32 v169, v169, v49
    v_mfma_f32_16x16x32_bf16 v[224:227], a[228:231], v[28:31], v[224:227]
    ds_read_b64_tr_b16 a[222:223], v2 offset:14336
    v_mul_f32 v173, v173, v49
    v_mfma_f32_16x16x32_bf16 v[228:231], a[232:235], v[28:31], v[228:231]
    ds_read_b64_tr_b16 a[226:227], v3 offset:14336
    v_accvgpr_read_b32 v58, a14
    v_mfma_f32_16x16x32_bf16 a[20:23], a[232:235], v[34:37], a[20:23]
    s_add_u32 s87, s34, 18432
    v_mul_f32 v56, v56, v51
    v_mul_f32 v168, v168, v49
    v_mfma_f32_16x16x32_bf16 a[16:19], a[228:231], v[34:37], a[16:19]
    ds_read_b64_tr_b16 a[224:225], v3 offset:20480
    v_accvgpr_read_b32 v57, a13
    v_mfma_f32_16x16x32_bf16 a[64:67], a[228:231], v[40:43], a[64:67]
    s_add_u32 s88, s34, 24576
    v_rcp_f32 v48, v48
    v_cvt_pk_bf16_f32 v168, v168, v169
    v_mul_f32 v164, v164, v49
    v_cvt_pk_bf16_f32 v160, v160, v161
    v_pk_mul_f32 v[208:209], v[208:209], v[50:51] op_sel_hi:[1,0]
    v_pk_mul_f32 v[118:119], v[118:119], v[48:49] op_sel_hi:[1,0]
    v_pk_mul_f32 v[124:125], v[124:125], v[48:49] op_sel_hi:[1,0]
    v_pk_mul_f32 v[218:219], v[218:219], v[50:51] op_sel_hi:[1,0]
    v_pk_mul_f32 v[120:121], v[120:121], v[48:49] op_sel_hi:[1,0]
    v_pk_mul_f32 v[222:223], v[222:223], v[50:51] op_sel_hi:[1,0]
    v_pk_mul_f32 v[114:115], v[114:115], v[48:49] op_sel_hi:[1,0]
    v_pk_mul_f32 v[116:117], v[116:117], v[48:49] op_sel_hi:[1,0]
    v_pk_mul_f32 v[112:113], v[112:113], v[48:49] op_sel_hi:[1,0]
    v_pk_mul_f32 v[126:127], v[126:127], v[48:49] op_sel_hi:[1,0]
    v_pk_mul_f32 v[122:123], v[122:123], v[48:49] op_sel_hi:[1,0]
    v_lshl_add_u32 v101, v107, 7, v101
    v_bfe_u32 v107, v104, 4, 1
    v_mfma_f32_16x16x32_bf16 a[68:71], a[232:235], v[40:43], a[68:71]
    s_waitcnt lgkmcnt(3)
    ds_read_b64_tr_b16 a[228:229], v4 offset:20480
    v_lshl_add_u32 v101, v107, 3, v101
    v_mfma_f32_16x16x32_bf16 a[72:75], a[212:215], v[40:43], a[72:75]
    ds_read_b64_tr_b16 a[234:235], v5 offset:14336
    v_accvgpr_read_b32 v54, a10
    v_mfma_f32_16x16x32_bf16 a[76:79], a[216:219], v[40:43], a[76:79]
    ds_read_b64_tr_b16 a[232:233], v5 offset:20480
    v_mul_f32 v170, v170, v49
    v_mfma_f32_16x16x32_bf16 a[28:31], a[216:219], v[34:37], a[28:31]
    v_mul_f32 v163, v163, v49
    v_mov_b32 v104, v100
    v_mfma_f32_16x16x32_bf16 a[24:27], a[212:215], v[34:37], a[24:27]
    v_cvt_pk_bf16_f32 v116, v116, v117
    v_accvgpr_read_b32 v106, a2
    v_mfma_f32_16x16x32_bf16 v[232:235], a[212:215], v[28:31], v[232:235]
    v_cvt_pk_bf16_f32 v124, v124, v125
    v_cvt_pk_bf16_f32 v172, v172, v173
    v_mfma_f32_16x16x32_bf16 v[236:239], a[216:219], v[28:31], v[236:239]
    v_cvt_pk_bf16_f32 v120, v120, v121
    v_accvgpr_read_b32 v55, a11
    v_mfma_f32_16x16x32_bf16 v[188:191], a[216:219], v[22:25], v[188:191]
    v_cvt_pk_bf16_f32 v121, v122, v123
    v_cvt_pk_bf16_f32 v112, v112, v113
    v_mfma_f32_16x16x32_bf16 v[184:187], a[212:215], v[22:25], v[184:187]
    v_mul_f32 v175, v175, v49
    v_cvt_pk_bf16_f32 v164, v164, v165
    v_mfma_f32_16x16x32_bf16 v[136:139], a[212:215], v[16:19], v[136:139]
    s_add_u32 s18, s34, 30720
    v_accvgpr_read_b32 v105, a1
    v_xor_b32 v94, 96, v101
    v_mfma_f32_16x16x32_bf16 v[140:143], a[216:219], v[16:19], v[140:143]
    s_waitcnt lgkmcnt(2)
    ds_read_b64_tr_b16 a[230:231], v4 offset:14336
    v_xor_b32 v92, 32, v101
    v_mfma_f32_16x16x32_bf16 v[144:147], a[220:223], v[16:19], v[144:147]
    v_cvt_pk_bf16_f32 v165, v166, v167
    v_cvt_pk_bf16_f32 v161, v162, v163
    v_mfma_f32_16x16x32_bf16 v[148:151], a[224:227], v[16:19], v[148:151]
    v_cvt_pk_bf16_f32 v125, v126, v127
    v_mul_f32 v171, v171, v49
    v_mfma_f32_16x16x32_bf16 v[196:199], a[224:227], v[22:25], v[196:199]
    v_xor_b32 v93, 64, v101
    v_cvt_pk_bf16_f32 v113, v114, v115
    v_mfma_f32_16x16x32_bf16 v[192:195], a[220:223], v[22:25], v[192:195]
    v_cvt_pk_bf16_f32 v173, v174, v175
    v_cvt_pk_bf16_f32 v117, v118, v119
    v_mfma_f32_16x16x32_bf16 v[240:243], a[220:223], v[28:31], v[240:243]
    ds_write2st64_b64 v101, v[112:113], v[160:161] offset0:0 offset1:12
    v_mfma_f32_16x16x32_bf16 v[244:247], a[224:227], v[28:31], v[244:247]
    v_cvt_pk_bf16_f32 v169, v170, v171
    v_accvgpr_read_b32 v109, a5
    v_mfma_f32_16x16x32_bf16 a[36:39], a[224:227], v[34:37], a[36:39]
    v_mul_f32 v190, v190, v49
    v_accvgpr_read_b32 v107, a3
    v_mfma_f32_16x16x32_bf16 a[32:35], a[220:223], v[34:37], a[32:35]
    ds_write2st64_b64 v92, v[116:117], v[164:165] offset0:0 offset1:12
    v_mfma_f32_16x16x32_bf16 a[80:83], a[220:223], v[40:43], a[80:83]
    ds_write2st64_b64 v93, v[120:121], v[168:169] offset0:0 offset1:12
    v_mfma_f32_16x16x32_bf16 a[84:87], a[224:227], v[40:43], a[84:87]
    s_waitcnt lgkmcnt(3)
    ds_write2st64_b64 v94, v[124:125], v[172:173] offset0:0 offset1:12
    v_mfma_f32_16x16x32_bf16 a[88:91], a[228:231], v[40:43], a[88:91]
    ds_read_b128 v[76:79], v8 offset:0
    v_mul_f32 v54, v54, v51
    v_mfma_f32_16x16x32_bf16 a[92:95], a[232:235], v[40:43], a[92:95]
    ds_read_b128 v[80:83], v8 offset:1024
    v_accvgpr_read_b32 v52, a8
    v_permlane16_swap_b32 v100, v104
    v_accvgpr_read_b32 v111, a7
    v_mul_f32 v107, v107, v51
    v_pk_mul_f32 v[216:217], v[216:217], v[50:51] op_sel_hi:[1,0]
    v_pk_mul_f32 v[212:213], v[212:213], v[50:51] op_sel_hi:[1,0]
    v_mul_f32 v106, v106, v51
    v_mul_f32 v191, v191, v49
    v_pk_mul_f32 v[140:141], v[140:141], v[48:49] op_sel_hi:[1,0]
    v_mul_f32 v53, v53, v51
    v_mul_f32 v55, v55, v51
    v_mul_f32 v105, v105, v51
    v_mfma_f32_16x16x32_bf16 a[44:47], a[232:235], v[34:37], a[44:47]
    v_mul_f32 v187, v187, v49
    v_mul_f32 v186, v186, v49
    v_mfma_f32_16x16x32_bf16 a[40:43], a[228:231], v[34:37], a[40:43]
    v_accvgpr_read_b32 v59, a15
    v_cvt_pk_bf16_f32 v208, v208, v209
    v_cvt_pk_bf16_f32 v212, v212, v213
    v_accvgpr_read_b32 v104, a0
    v_mfma_f32_16x16x32_bf16 v[248:251], a[228:231], v[28:31], v[248:251]
    ds_read_b128 v[84:87], v8 offset:6144
    v_accvgpr_read_b32 v110, a6
    v_mul_f32 v109, v109, v51
    v_mfma_f32_16x16x32_bf16 v[252:255], a[232:235], v[28:31], v[252:255]
    v_mul_f32 v182, v182, v49
    v_mul_f32 v58, v58, v51
    s_waitcnt lgkmcnt(2)
    buffer_store_dwordx4 v[76:79], v102, s[16:19], s84 offen offset:0 nt
    v_mul_f32 v104, v104, v51
    v_mul_f32 v110, v110, v51
    v_pk_mul_f32 v[136:137], v[136:137], v[48:49] op_sel_hi:[1,0]
    v_cvt_pk_bf16_f32 v104, v104, v105
    v_cvt_pk_bf16_f32 v216, v216, v217
    v_pk_mul_f32 v[252:253], v[252:253], v[50:51] op_sel_hi:[1,0]
    v_mul_f32 v52, v52, v51
    v_pk_mul_f32 v[210:211], v[210:211], v[50:51] op_sel_hi:[1,0]
    v_cvt_pk_bf16_f32 v105, v106, v107
    v_pk_mul_f32 v[148:149], v[148:149], v[48:49] op_sel_hi:[1,0]
    v_pk_mul_f32 v[214:215], v[214:215], v[50:51] op_sel_hi:[1,0]
    v_mul_f32 v184, v184, v49
    v_cvt_pk_bf16_f32 v209, v210, v211
    v_pk_mul_f32 v[220:221], v[220:221], v[50:51] op_sel_hi:[1,0]
    v_cvt_pk_bf16_f32 v108, v108, v109
    v_rcp_f32 v100, v100
    v_cvt_pk_bf16_f32 v52, v52, v53
    v_mul_f32 v57, v57, v51
    v_mul_f32 v111, v111, v51
    v_mfma_f32_16x16x32_bf16 v[204:207], a[232:235], v[22:25], v[204:207]
    ds_read_b128 v[88:91], v8 offset:7168
    v_cvt_pk_bf16_f32 v56, v56, v57
    v_accvgpr_read_b32 v107, a51
    v_mul_f32 v178, v178, v49
    v_cvt_pk_bf16_f32 v140, v140, v141
    v_cvt_pk_bf16_f32 v213, v214, v215
    v_mfma_f32_16x16x32_bf16 v[200:203], a[228:231], v[22:25], v[200:203]
    s_waitcnt lgkmcnt(1)
    buffer_store_dwordx4 v[80:83], v103, s[16:19], s84 offen offset:0 nt
    ds_write2st64_b64 v101, v[208:209], v[104:105] offset0:24 offset1:36
    v_cvt_pk_bf16_f32 v109, v110, v111
    v_accvgpr_read_b32 v110, a54
    v_mfma_f32_16x16x32_bf16 v[152:155], a[228:231], v[16:19], v[152:155]
    ds_write2st64_b64 v92, v[212:213], v[108:109] offset0:24 offset1:36
    v_mul_f32 v59, v59, v51
    v_mul_f32 v192, v192, v49
    v_pk_mul_f32 v[142:143], v[142:143], v[48:49] op_sel_hi:[1,0]
    v_pk_mul_f32 v[128:129], v[128:129], v[48:49] op_sel_hi:[1,0]
    v_cvt_pk_bf16_f32 v53, v54, v55
    v_mul_f32 v201, v201, v49
    v_accvgpr_read_b32 v104, a48
    v_pk_mul_f32 v[134:135], v[134:135], v[48:49] op_sel_hi:[1,0]
    v_accvgpr_read_b32 v105, a49
    v_cvt_pk_bf16_f32 v220, v220, v221
    v_accvgpr_read_b32 v111, a55
    v_mul_f32 v183, v183, v49
    v_cvt_pk_bf16_f32 v217, v218, v219
    v_mfma_f32_16x16x32_bf16 v[156:159], a[232:235], v[16:19], v[156:159]
    buffer_store_dwordx4 v[84:87], v102, s[16:19], s85 offen offset:0 nt
    v_mul_f32 v177, v177, v49
    v_pk_mul_f32 v[104:105], v[104:105], v[100:101] op_sel_hi:[1,0]
    v_mul_f32 v204, v204, v49
    v_pk_mul_f32 v[130:131], v[130:131], v[48:49] op_sel_hi:[1,0]
    v_pk_mul_f32 v[226:227], v[226:227], v[50:51] op_sel_hi:[1,0]
    v_cvt_pk_bf16_f32 v221, v222, v223
    v_mul_f32 v189, v189, v49
    ds_write2st64_b64 v93, v[216:217], v[52:53] offset0:24 offset1:36
    v_cvt_pk_bf16_f32 v57, v58, v59
    v_accvgpr_read_b32 v108, a52
    v_accvgpr_read_b32 v109, a53
    ds_write2st64_b64 v94, v[220:221], v[56:57] offset0:24 offset1:36
    ds_read_b128 v[60:63], v8 offset:12288
    v_accvgpr_read_b32 v55, a59
    v_mul_f32 v185, v185, v49
    s_waitcnt lgkmcnt(3)
    buffer_store_dwordx4 v[88:91], v103, s[16:19], s85 offen offset:0 nt
    v_accvgpr_read_b32 v54, a58
    v_accvgpr_read_b32 v56, a60
    v_mul_f32 v188, v188, v49
    v_pk_mul_f32 v[236:237], v[236:237], v[50:51] op_sel_hi:[1,0]
    v_pk_mul_f32 v[144:145], v[144:145], v[48:49] op_sel_hi:[1,0]
    v_accvgpr_read_b32 v57, a61
    v_mul_f32 v180, v180, v49
    v_pk_mul_f32 v[232:233], v[232:233], v[50:51] op_sel_hi:[1,0]
    v_cvt_pk_bf16_f32 v184, v184, v185
    v_accvgpr_read_b32 v106, a50
    v_pk_mul_f32 v[108:109], v[108:109], v[100:101] op_sel_hi:[1,0]
    v_cvt_pk_bf16_f32 v185, v186, v187
    v_pk_mul_f32 v[106:107], v[106:107], v[100:101] op_sel_hi:[1,0]
    ds_read_b128 v[64:67], v8 offset:13312
    v_cvt_pk_bf16_f32 v144, v144, v145
    v_accvgpr_read_b32 v52, a56
    v_pk_mul_f32 v[138:139], v[138:139], v[48:49] op_sel_hi:[1,0]
    s_waitcnt lgkmcnt(1)
    buffer_store_dwordx4 v[60:63], v102, s[16:19], s86 offen offset:0 nt
    v_accvgpr_read_b32 v53, a57
    v_cvt_pk_bf16_f32 v104, v104, v105
    v_pk_mul_f32 v[52:53], v[52:53], v[100:101] op_sel_hi:[1,0]
    v_pk_mul_f32 v[228:229], v[228:229], v[50:51] op_sel_hi:[1,0]
    v_pk_mul_f32 v[244:245], v[244:245], v[50:51] op_sel_hi:[1,0]
    v_pk_mul_f32 v[110:111], v[110:111], v[100:101] op_sel_hi:[1,0]
    v_pk_mul_f32 v[156:157], v[156:157], v[48:49] op_sel_hi:[1,0]
    ds_read_b128 v[68:71], v8 offset:18432
    ds_read_b128 v[72:75], v8 offset:19456
    v_cvt_pk_bf16_f32 v105, v106, v107
    v_pk_mul_f32 v[56:57], v[56:57], v[100:101] op_sel_hi:[1,0]
    v_pk_mul_f32 v[54:55], v[54:55], v[100:101] op_sel_hi:[1,0]
    v_cvt_pk_bf16_f32 v52, v52, v53
    v_mul_f32 v176, v176, v49
    v_accvgpr_read_b32 v59, a63
    v_cvt_pk_bf16_f32 v148, v148, v149
    v_pk_mul_f32 v[224:225], v[224:225], v[50:51] op_sel_hi:[1,0]
    v_accvgpr_read_b32 v58, a62
    v_pk_mul_f32 v[58:59], v[58:59], v[100:101] op_sel_hi:[1,0]
    ds_write_b64 v101, v[104:105] offset:24576
    v_pk_mul_f32 v[246:247], v[246:247], v[50:51] op_sel_hi:[1,0]
    s_waitcnt lgkmcnt(3)
    buffer_store_dwordx4 v[64:67], v103, s[16:19], s86 offen offset:0 nt
    v_cvt_pk_bf16_f32 v108, v108, v109
    v_cvt_pk_bf16_f32 v228, v228, v229
    v_cvt_pk_bf16_f32 v232, v232, v233
    v_pk_mul_f32 v[132:133], v[132:133], v[48:49] op_sel_hi:[1,0]
    v_cvt_pk_bf16_f32 v56, v56, v57
    v_cvt_pk_bf16_f32 v53, v54, v55
    v_mul_f32 v181, v181, v49
    v_cvt_pk_bf16_f32 v224, v224, v225
    v_accvgpr_read_b32 v107, a19
    v_cvt_pk_bf16_f32 v180, v180, v181
    v_cvt_pk_bf16_f32 v109, v110, v111
    v_cvt_pk_bf16_f32 v128, v128, v129
    v_cvt_pk_bf16_f32 v132, v132, v133
    v_cvt_pk_bf16_f32 v57, v58, v59
    v_pk_mul_f32 v[230:231], v[230:231], v[50:51] op_sel_hi:[1,0]
    ds_write_b64 v92, v[108:109] offset:24576
    v_accvgpr_read_b32 v59, a31
    v_mul_f32 v59, v59, v51
    v_accvgpr_read_b32 v54, a26
    v_mul_f32 v207, v207, v49
    v_cvt_pk_bf16_f32 v141, v142, v143
    v_mul_f32 v179, v179, v49
    v_cvt_pk_bf16_f32 v176, v176, v177
    s_waitcnt lgkmcnt(1)
    buffer_store_dwordx4 v[68:71], v102, s[16:19], s87 offen offset:0 nt
    ds_write_b64 v93, v[52:53] offset:24576
    ds_write_b64 v94, v[56:57] offset:24576
    v_accvgpr_read_b32 v58, a30
    v_accvgpr_read_b32 v57, a29
    v_accvgpr_read_b32 v55, a27
    ds_read_b128 v[76:79], v8 offset:24576
    v_pk_mul_f32 v[238:239], v[238:239], v[50:51] op_sel_hi:[1,0]
    v_accvgpr_read_b32 v110, a22
    v_accvgpr_read_b32 v56, a28
    v_cvt_pk_bf16_f32 v129, v130, v131
    v_accvgpr_read_b32 v111, a23
    v_mul_f32 v196, v196, v49
    v_mul_f32 v57, v57, v51
    v_mul_f32 v56, v56, v51
    v_cvt_pk_bf16_f32 v177, v178, v179
    v_cvt_pk_bf16_f32 v133, v134, v135
    v_accvgpr_read_b32 v108, a20
    v_accvgpr_read_b32 v106, a18
    v_cvt_pk_bf16_f32 v136, v136, v137
    v_mul_f32 v107, v107, v51
    v_mul_f32 v108, v108, v51
    v_accvgpr_read_b32 v109, a21
    v_cvt_pk_bf16_f32 v236, v236, v237
    buffer_store_dwordx4 v[72:75], v103, s[16:19], s87 offen offset:0 nt
    v_mul_f32 v55, v55, v51
    v_mul_f32 v205, v205, v49
    v_accvgpr_read_b32 v104, a16
    v_mul_f32 v104, v104, v51
    ds_read_b128 v[80:83], v8 offset:25600
    v_cvt_pk_bf16_f32 v188, v188, v189
    v_pk_mul_f32 v[248:249], v[248:249], v[50:51] op_sel_hi:[1,0]
    v_cvt_pk_bf16_f32 v56, v56, v57
    v_mul_f32 v54, v54, v51
    v_pk_mul_f32 v[234:235], v[234:235], v[50:51] op_sel_hi:[1,0]
    v_accvgpr_read_b32 v52, a24
    v_cvt_pk_bf16_f32 v181, v182, v183
    v_mul_f32 v198, v198, v49
    ds_write2st64_b64 v101, v[128:129], v[176:177] offset0:4 offset1:16
    v_cvt_pk_bf16_f32 v237, v238, v239
    v_mul_f32 v110, v110, v51
    v_mul_f32 v111, v111, v51
    v_mul_f32 v109, v109, v51
    v_accvgpr_read_b32 v105, a17
    v_cvt_pk_bf16_f32 v225, v226, v227
    s_waitcnt lgkmcnt(2)
    buffer_store_dwordx4 v[76:79], v102, s[16:19], s88 offen offset:0 nt
    v_pk_mul_f32 v[250:251], v[250:251], v[50:51] op_sel_hi:[1,0]
    v_cvt_pk_bf16_f32 v137, v138, v139
    v_cvt_pk_bf16_f32 v189, v190, v191
    v_accvgpr_read_b32 v53, a25
    v_cvt_pk_bf16_f32 v244, v244, v245
    v_mul_f32 v200, v200, v49
    ds_write2st64_b64 v92, v[132:133], v[180:181] offset0:4 offset1:16
    ds_write2st64_b64 v93, v[136:137], v[184:185] offset0:4 offset1:16
    ds_write2st64_b64 v94, v[140:141], v[188:189] offset0:4 offset1:16
    ds_read_b128 v[84:87], v8 offset:2048
    v_mul_f32 v197, v197, v49
    v_cvt_pk_bf16_f32 v108, v108, v109
    v_mul_f32 v52, v52, v51
    s_waitcnt lgkmcnt(4)
    buffer_store_dwordx4 v[80:83], v103, s[16:19], s88 offen offset:0 nt
    v_cvt_pk_bf16_f32 v229, v230, v231
    v_mul_f32 v105, v105, v51
    v_pk_mul_f32 v[154:155], v[154:155], v[48:49] op_sel_hi:[1,0]
    v_mul_f32 v53, v53, v51
    v_cvt_pk_bf16_f32 v233, v234, v235
    v_mul_f32 v106, v106, v51
    v_cvt_pk_bf16_f32 v52, v52, v53
    ds_read_b128 v[88:91], v8 offset:3072
    v_mul_f32 v199, v199, v49
    v_cvt_pk_bf16_f32 v104, v104, v105
    ds_read_b128 v[60:63], v8 offset:8192
    v_cvt_pk_bf16_f32 v105, v106, v107
    v_mul_f32 v206, v206, v49
    v_accvgpr_read_b32 v107, a67
    v_cvt_pk_bf16_f32 v109, v110, v111
    s_waitcnt lgkmcnt(2)
    buffer_store_dwordx4 v[84:87], v102, s[16:19], s84 offen offset:128 nt
    v_accvgpr_read_b32 v106, a66
    ds_read_b128 v[64:67], v8 offset:9216
    v_mul_f32 v202, v202, v49
    v_cvt_pk_bf16_f32 v53, v54, v55
    ds_write2st64_b64 v101, v[224:225], v[104:105] offset0:28 offset1:40
    v_accvgpr_read_b32 v105, a65
    ds_write2st64_b64 v92, v[228:229], v[108:109] offset0:28 offset1:40
    v_mul_f32 v58, v58, v51
    v_cvt_pk_bf16_f32 v252, v252, v253
    s_waitcnt lgkmcnt(3)
    buffer_store_dwordx4 v[88:91], v103, s[16:19], s84 offen offset:128 nt
    v_accvgpr_read_b32 v110, a70
    v_cvt_pk_bf16_f32 v57, v58, v59
    v_accvgpr_read_b32 v54, a74
    v_accvgpr_read_b32 v109, a69
    v_accvgpr_read_b32 v55, a75
    ds_write2st64_b64 v93, v[232:233], v[52:53] offset0:28 offset1:40
    v_mul_f32 v193, v193, v49
    v_accvgpr_read_b32 v108, a68
    v_accvgpr_read_b32 v58, a78
    v_cvt_pk_bf16_f32 v200, v200, v201
    ds_write2st64_b64 v94, v[236:237], v[56:57] offset0:28 offset1:40
    v_accvgpr_read_b32 v56, a76
    v_pk_mul_f32 v[152:153], v[152:153], v[48:49] op_sel_hi:[1,0]
    v_pk_mul_f32 v[146:147], v[146:147], v[48:49] op_sel_hi:[1,0]
    v_pk_mul_f32 v[108:109], v[108:109], v[100:101] op_sel_hi:[1,0]
    v_mul_f32 v195, v195, v49
    v_accvgpr_read_b32 v52, a72
    buffer_store_dwordx4 v[60:63], v102, s[16:19], s85 offen offset:128 nt
    ds_read_b128 v[68:71], v8 offset:14336
    v_pk_mul_f32 v[254:255], v[254:255], v[50:51] op_sel_hi:[1,0]
    ds_read_b128 v[72:75], v8 offset:15360
    v_cvt_pk_bf16_f32 v204, v204, v205
    v_accvgpr_read_b32 v111, a71
    v_pk_mul_f32 v[158:159], v[158:159], v[48:49] op_sel_hi:[1,0]
    v_accvgpr_read_b32 v104, a64
    v_cvt_pk_bf16_f32 v145, v146, v147
    v_accvgpr_read_b32 v59, a79
    v_cvt_pk_bf16_f32 v248, v248, v249
    ds_read_b128 v[76:79], v8 offset:20480
    v_pk_mul_f32 v[104:105], v[104:105], v[100:101] op_sel_hi:[1,0]
    v_cvt_pk_bf16_f32 v156, v156, v157
    v_accvgpr_read_b32 v57, a77
    v_cvt_pk_bf16_f32 v245, v246, v247
    v_pk_mul_f32 v[58:59], v[58:59], v[100:101] op_sel_hi:[1,0]
    v_accvgpr_read_b32 v53, a73
    v_cvt_pk_bf16_f32 v196, v196, v197
    v_cvt_pk_bf16_f32 v108, v108, v109
    s_waitcnt lgkmcnt(3)
    buffer_store_dwordx4 v[64:67], v103, s[16:19], s85 offen offset:128 nt
    v_pk_mul_f32 v[52:53], v[52:53], v[100:101] op_sel_hi:[1,0]
    v_pk_mul_f32 v[242:243], v[242:243], v[50:51] op_sel_hi:[1,0]
    v_pk_mul_f32 v[240:241], v[240:241], v[50:51] op_sel_hi:[1,0]
    v_pk_mul_f32 v[110:111], v[110:111], v[100:101] op_sel_hi:[1,0]
    v_cvt_pk_bf16_f32 v157, v158, v159
    v_pk_mul_f32 v[106:107], v[106:107], v[100:101] op_sel_hi:[1,0]
    v_cvt_pk_bf16_f32 v197, v198, v199
    v_cvt_pk_bf16_f32 v240, v240, v241
    v_mul_f32 v203, v203, v49
    v_pk_mul_f32 v[54:55], v[54:55], v[100:101] op_sel_hi:[1,0]
    v_cvt_pk_bf16_f32 v152, v152, v153
    v_cvt_pk_bf16_f32 v52, v52, v53
    v_cvt_pk_bf16_f32 v104, v104, v105
    v_pk_mul_f32 v[56:57], v[56:57], v[100:101] op_sel_hi:[1,0]
    ds_read_b128 v[80:83], v8 offset:21504
    v_cvt_pk_bf16_f32 v192, v192, v193
    v_cvt_pk_bf16_f32 v53, v54, v55
    v_cvt_pk_bf16_f32 v56, v56, v57
    v_cvt_pk_bf16_f32 v249, v250, v251
    v_cvt_pk_bf16_f32 v105, v106, v107
    v_cvt_pk_bf16_f32 v109, v110, v111
    v_cvt_pk_bf16_f32 v57, v58, v59
    v_accvgpr_read_b32 v55, a43
    v_pk_mul_f32 v[150:151], v[150:151], v[48:49] op_sel_hi:[1,0]
    v_cvt_pk_bf16_f32 v253, v254, v255
    s_waitcnt lgkmcnt(1)
    buffer_store_dwordx4 v[68:71], v102, s[16:19], s86 offen offset:128 nt
    ds_write_b64 v101, v[104:105] offset:26624
    v_accvgpr_read_b32 v54, a42
    v_mul_f32 v194, v194, v49
    ds_write_b64 v92, v[108:109] offset:26624
    ds_write_b64 v93, v[52:53] offset:26624
    v_cvt_pk_bf16_f32 v201, v202, v203
    buffer_store_dwordx4 v[72:75], v103, s[16:19], s86 offen offset:128 nt
    v_cvt_pk_bf16_f32 v193, v194, v195
    v_accvgpr_read_b32 v104, a32
    v_accvgpr_read_b32 v105, a33
    v_accvgpr_read_b32 v108, a36
    ds_write_b64 v94, v[56:57] offset:26624
    v_accvgpr_read_b32 v107, a35
    v_mul_f32 v54, v54, v51
    v_mul_f32 v104, v104, v51
    v_cvt_pk_bf16_f32 v205, v206, v207
    v_cvt_pk_bf16_f32 v153, v154, v155
    v_accvgpr_read_b32 v106, a34
    v_cvt_pk_bf16_f32 v241, v242, v243
    ds_read_b128 v[84:87], v8 offset:26624
    v_cvt_pk_bf16_f32 v149, v150, v151
    v_mul_f32 v55, v55, v51
    v_accvgpr_read_b32 v109, a37
    ds_read_b128 v[88:91], v8 offset:27648
    v_accvgpr_read_b32 v111, a39
    v_mul_f32 v105, v105, v51
    v_mul_f32 v107, v107, v51
    buffer_store_dwordx4 v[76:79], v102, s[16:19], s87 offen offset:128 nt
    v_accvgpr_read_b32 v52, a40
    ds_write2st64_b64 v101, v[144:145], v[192:193] offset0:8 offset1:20
    ds_write2st64_b64 v92, v[148:149], v[196:197] offset0:8 offset1:20
    ds_write2st64_b64 v93, v[152:153], v[200:201] offset0:8 offset1:20
    ds_write2st64_b64 v94, v[156:157], v[204:205] offset0:8 offset1:20
    v_mul_f32 v111, v111, v51
    ds_read_b128 v[60:63], v8 offset:4096
    v_cvt_pk_bf16_f32 v104, v104, v105
    v_mul_f32 v106, v106, v51
    s_waitcnt lgkmcnt(5)
    buffer_store_dwordx4 v[80:83], v103, s[16:19], s87 offen offset:128 nt
    v_mul_f32 v108, v108, v51
    ds_read_b128 v[64:67], v8 offset:5120
    ds_read_b128 v[68:71], v8 offset:10240
    ds_read_b128 v[72:75], v8 offset:11264
    v_cvt_pk_bf16_f32 v105, v106, v107
    v_accvgpr_read_b32 v57, a45
    v_accvgpr_read_b32 v58, a46
    v_accvgpr_read_b32 v56, a44
    v_mul_f32 v109, v109, v51
    ds_write2st64_b64 v101, v[240:241], v[104:105] offset0:32 offset1:44
    v_mul_f32 v57, v57, v51
    v_mul_f32 v56, v56, v51
    v_accvgpr_read_b32 v107, a83
    v_accvgpr_read_b32 v106, a82
    v_accvgpr_read_b32 v105, a81
    v_accvgpr_read_b32 v104, a80
    v_pk_mul_f32 v[106:107], v[106:107], v[100:101] op_sel_hi:[1,0]
    v_cvt_pk_bf16_f32 v108, v108, v109
    v_accvgpr_read_b32 v59, a47
    v_mul_f32 v58, v58, v51
    v_cvt_pk_bf16_f32 v56, v56, v57
    buffer_store_dwordx4 v[84:87], v102, s[16:19], s88 offen offset:128 nt
    buffer_store_dwordx4 v[88:91], v103, s[16:19], s88 offen offset:128 nt
    v_accvgpr_read_b32 v53, a41
    v_accvgpr_read_b32 v110, a38
    v_pk_mul_f32 v[104:105], v[104:105], v[100:101] op_sel_hi:[1,0]
    s_waitcnt lgkmcnt(0)
    buffer_store_dwordx4 v[60:63], v102, s[16:19], s84 offen offset:256 nt
    v_mul_f32 v52, v52, v51
    v_cvt_pk_bf16_f32 v104, v104, v105
    v_mul_f32 v53, v53, v51
    v_mul_f32 v110, v110, v51
    v_mul_f32 v59, v59, v51
    v_cvt_pk_bf16_f32 v109, v110, v111
    v_cvt_pk_bf16_f32 v52, v52, v53
    v_cvt_pk_bf16_f32 v53, v54, v55
    ds_write2st64_b64 v92, v[244:245], v[108:109] offset0:32 offset1:44
    v_cvt_pk_bf16_f32 v105, v106, v107
    v_cvt_pk_bf16_f32 v57, v58, v59
    ds_write2st64_b64 v93, v[248:249], v[52:53] offset0:32 offset1:44
    v_accvgpr_read_b32 v109, a85
    v_accvgpr_read_b32 v52, a88
    buffer_store_dwordx4 v[64:67], v103, s[16:19], s84 offen offset:256 nt
    v_accvgpr_read_b32 v55, a91
    v_accvgpr_read_b32 v58, a94
    ds_write2st64_b64 v94, v[252:253], v[56:57] offset0:32 offset1:44
    v_accvgpr_read_b32 v53, a89
    ds_read_b128 v[76:79], v8 offset:16384
    v_pk_mul_f32 v[52:53], v[52:53], v[100:101] op_sel_hi:[1,0]
    v_accvgpr_read_b32 v111, a87
    ds_read_b128 v[80:83], v8 offset:17408
    v_accvgpr_read_b32 v108, a84
    v_accvgpr_read_b32 v110, a86
    buffer_store_dwordx4 v[68:71], v102, s[16:19], s85 offen offset:256 nt
    ds_read_b128 v[84:87], v8 offset:22528
    v_accvgpr_read_b32 v54, a90
    v_pk_mul_f32 v[108:109], v[108:109], v[100:101] op_sel_hi:[1,0]
    v_pk_mul_f32 v[110:111], v[110:111], v[100:101] op_sel_hi:[1,0]
    v_cvt_pk_bf16_f32 v52, v52, v53
    v_pk_mul_f32 v[54:55], v[54:55], v[100:101] op_sel_hi:[1,0]
    v_accvgpr_read_b32 v59, a95
    v_accvgpr_read_b32 v57, a93
    v_pk_mul_f32 v[58:59], v[58:59], v[100:101] op_sel_hi:[1,0]
    buffer_store_dwordx4 v[72:75], v103, s[16:19], s85 offen offset:256 nt
    ds_read_b128 v[88:91], v8 offset:23552
    v_accvgpr_read_b32 v56, a92
    v_cvt_pk_bf16_f32 v53, v54, v55
    ds_write_b64 v101, v[104:105] offset:0
    v_cvt_pk_bf16_f32 v108, v108, v109
    v_pk_mul_f32 v[56:57], v[56:57], v[100:101] op_sel_hi:[1,0]
    s_nop 0
    v_cvt_pk_bf16_f32 v56, v56, v57
    v_cvt_pk_bf16_f32 v109, v110, v111
    ds_write_b64 v92, v[108:109] offset:0
    s_waitcnt lgkmcnt(3)
    buffer_store_dwordx4 v[76:79], v102, s[16:19], s86 offen offset:256 nt
    ds_write_b64 v93, v[52:53] offset:0
    buffer_store_dwordx4 v[80:83], v103, s[16:19], s86 offen offset:256 nt
    v_cvt_pk_bf16_f32 v57, v58, v59
    ds_write_b64 v94, v[56:57] offset:0
    buffer_store_dwordx4 v[84:87], v102, s[16:19], s87 offen offset:256 nt
    ds_read_b128 v[60:63], v8 offset:0
    ds_read_b128 v[64:67], v8 offset:1024
    s_waitcnt lgkmcnt(3)
    buffer_store_dwordx4 v[88:91], v103, s[16:19], s87 offen offset:256 nt
    s_waitcnt lgkmcnt(1)
    buffer_store_dwordx4 v[60:63], v102, s[16:19], s88 offen offset:256 nt
    s_waitcnt lgkmcnt(0)
    buffer_store_dwordx4 v[64:67], v103, s[16:19], s88 offen offset:256 nt
    s_branch L_fin
L_end4:
    s_waitcnt lgkmcnt(6)
    v_mfma_f32_16x16x32_bf16 v[112:115], a[212:215], v[16:19], v[112:115]
    v_fma_f32 v71, v71, s28, v11
    v_fma_f32 v70, v70, s28, v11
    v_mfma_f32_16x16x32_bf16 v[160:163], a[212:215], v[22:25], v[160:163]
    ds_read_b64_tr_b16 a[234:235], v3 offset:13312
    v_fma_f32 v56, v56, s28, v9
    v_mfma_f32_16x16x32_bf16 v[208:211], a[212:215], v[28:31], v[208:211]
    ds_read_b64_tr_b16 a[230:231], v2 offset:13312
    v_fma_f32 v66, v66, s28, v10
    v_mfma_f32_16x16x32_bf16 a[0:3], a[212:215], v[34:37], a[0:3]
    ds_read_b64_tr_b16 a[228:229], v2 offset:19456
    s_waitcnt lgkmcnt(7)
    v_mfma_f32_16x16x32_bf16 a[4:7], a[216:219], v[34:37], a[4:7]
    v_fma_f32 v76, v76, s28, v12
    v_fma_f32 v68, v68, s28, v11
    v_mfma_f32_16x16x32_bf16 v[212:215], a[216:219], v[28:31], v[212:215]
    ds_read_b64_tr_b16 a[212:213], v4 offset:19456
    v_mfma_f32_16x16x32_bf16 v[164:167], a[216:219], v[22:25], v[164:167]
    ds_read_b64_tr_b16 a[232:233], v3 offset:19456
    v_fma_f32 v80, v80, s28, v12
    v_mfma_f32_16x16x32_bf16 v[116:119], a[216:219], v[16:19], v[116:119]
    ds_read_b64_tr_b16 a[216:217], v5 offset:19456
    s_waitcnt lgkmcnt(8)
    v_mfma_f32_16x16x32_bf16 v[120:123], a[220:223], v[16:19], v[120:123]
    s_add_u32 s39, s39, 12288
    v_exp_f32 v76, v76
    v_mfma_f32_16x16x32_bf16 v[168:171], a[220:223], v[22:25], v[168:171]
    ds_read_b64_tr_b16 a[214:215], v4 offset:13312
    v_fma_f32 v62, v62, s28, v10
    v_mfma_f32_16x16x32_bf16 v[216:219], a[220:223], v[28:31], v[216:219]
    v_exp_f32 v80, v80
    v_mfma_f32_16x16x32_bf16 a[8:11], a[220:223], v[34:37], a[8:11]
    s_waitcnt lgkmcnt(6)
    ds_read_b64_tr_b16 a[218:219], v5 offset:13312
    v_fma_f32 v73, v73, s28, v11
    v_mfma_f32_16x16x32_bf16 a[12:15], a[224:227], v[34:37], a[12:15]
    v_fma_f32 v58, v58, s28, v9
    v_mfma_f32_16x16x32_bf16 v[220:223], a[224:227], v[28:31], v[220:223]
    v_exp_f32 v70, v70
    v_mfma_f32_16x16x32_bf16 v[172:175], a[224:227], v[22:25], v[172:175]
    ds_read_b64_tr_b16 a[222:223], v2 offset:14336
    v_fma_f32 v77, v77, s28, v12
    v_mfma_f32_16x16x32_bf16 v[124:127], a[224:227], v[16:19], v[124:127]
    s_waitcnt lgkmcnt(5)
    v_fma_f32 v74, v74, s28, v11
    v_fma_f32 v75, v75, s28, v11
    v_mfma_f32_16x16x32_bf16 v[128:131], a[228:231], v[16:19], v[128:131]
    ds_read_b64_tr_b16 a[224:225], v3 offset:20480
    v_fma_f32 v78, v78, s28, v12
    v_mfma_f32_16x16x32_bf16 v[176:179], a[228:231], v[22:25], v[176:179]
    ds_read_b64_tr_b16 a[220:221], v2 offset:20480
    v_fma_f32 v67, v67, s28, v10
    v_mfma_f32_16x16x32_bf16 v[224:227], a[228:231], v[28:31], v[224:227]
    v_exp_f32 v62, v62
    v_mfma_f32_16x16x32_bf16 a[16:19], a[228:231], v[34:37], a[16:19]
    s_waitcnt lgkmcnt(4)
    ds_read_b64_tr_b16 a[226:227], v3 offset:14336
    v_fma_f32 v64, v64, s28, v10
    v_mfma_f32_16x16x32_bf16 a[20:23], a[232:235], v[34:37], a[20:23]
    ds_read_b64_tr_b16 a[230:231], v4 offset:14336
    v_fma_f32 v59, v59, s28, v9
    v_mfma_f32_16x16x32_bf16 v[228:231], a[232:235], v[28:31], v[228:231]
    ds_read_b64_tr_b16 a[228:229], v4 offset:20480
    v_mfma_f32_16x16x32_bf16 v[180:183], a[232:235], v[22:25], v[180:183]
    v_exp_f32 v71, v71
    v_mfma_f32_16x16x32_bf16 v[132:135], a[232:235], v[16:19], v[132:135]
    ds_read_b64_tr_b16 a[232:233], v5 offset:20480
    v_fma_f32 v79, v79, s28, v12
    v_mfma_f32_16x16x32_bf16 v[136:139], a[212:215], v[16:19], v[136:139]
    ds_read_b64_tr_b16 a[234:235], v5 offset:14336
    v_fma_f32 v63, v63, s28, v10
    v_mfma_f32_16x16x32_bf16 v[184:187], a[212:215], v[22:25], v[184:187]
    v_exp_f32 v77, v77
    v_mfma_f32_16x16x32_bf16 v[232:235], a[212:215], v[28:31], v[232:235]
    v_cvt_pk_bf16_f32 v32, v76, v77
    v_fma_f32 v69, v69, s28, v11
    v_mfma_f32_16x16x32_bf16 a[24:27], a[212:215], v[34:37], a[24:27]
    s_waitcnt lgkmcnt(5)
    v_fma_f32 v57, v57, s28, v9
    v_mfma_f32_16x16x32_bf16 a[28:31], a[216:219], v[34:37], a[28:31]
    ds_read_b128 v[88:91], v8 offset:4096
    v_mfma_f32_16x16x32_bf16 v[236:239], a[216:219], v[28:31], v[236:239]
    v_exp_f32 v63, v63
    v_mfma_f32_16x16x32_bf16 v[188:191], a[216:219], v[22:25], v[188:191]
    v_exp_f32 v79, v79
    v_mfma_f32_16x16x32_bf16 v[140:143], a[216:219], v[16:19], v[140:143]
    v_exp_f32 v68, v68
    v_mfma_f32_16x16x32_bf16 v[144:147], a[220:223], v[16:19], v[144:147]
    v_exp_f32 v59, v59
    v_mfma_f32_16x16x32_bf16 v[192:195], a[220:223], v[22:25], v[192:195]
    ds_read_b128 v[96:99], v8 offset:2048
    s_waitcnt vmcnt(10) lgkmcnt(2)
    v_mfma_f32_16x16x32_bf16 v[240:243], a[220:223], v[28:31], v[240:243]
    s_barrier
    v_mfma_f32_16x16x32_bf16 a[32:35], a[220:223], v[34:37], a[32:35]
    ds_read_b128 a[212:215], v0 offset:12288
    v_cvt_pk_bf16_f32 v27, v70, v71
    v_mfma_f32_16x16x32_bf16 a[36:39], a[224:227], v[34:37], a[36:39]
    v_exp_f32 v69, v69
    v_mfma_f32_16x16x32_bf16 v[244:247], a[224:227], v[28:31], v[244:247]
    s_add_u32 m0, s22, 36864
    ds_read_b128 a[216:219], v1 offset:12288
    v_fma_f32 v82, v82, s28, v12
    v_mfma_f32_16x16x32_bf16 v[196:199], a[224:227], v[22:25], v[196:199]
    buffer_load_dwordx4 v6, s[8:11], s21 offen lds
    v_mfma_f32_16x16x32_bf16 v[148:151], a[224:227], v[16:19], v[148:151]
    s_add_u32 s21, s21, 128
    ds_read_b128 a[220:223], v0 offset:13312
    v_fma_f32 v72, v72, s28, v11
    v_mfma_f32_16x16x32_bf16 v[152:155], a[228:231], v[16:19], v[152:155]
    s_add_u32 m0, s22, 37888
    v_cvt_pk_bf16_f32 v26, v68, v69
    v_fma_f32 v65, v65, s28, v10
    v_mfma_f32_16x16x32_bf16 v[200:203], a[228:231], v[22:25], v[200:203]
    v_exp_f32 v64, v64
    v_mfma_f32_16x16x32_bf16 v[248:251], a[228:231], v[28:31], v[248:251]
    buffer_load_dwordx4 v6, s[8:11], s21 offen lds
    v_mfma_f32_16x16x32_bf16 a[40:43], a[228:231], v[34:37], a[40:43]
    s_add_u32 s21, s21, 128
    v_exp_f32 v78, v78
    v_mfma_f32_16x16x32_bf16 a[44:47], a[232:235], v[34:37], a[44:47]
    s_add_u32 m0, s22, 38912
    ds_read_b128 a[228:231], v0 offset:14336
    v_fma_f32 v81, v81, s28, v12
    v_mfma_f32_16x16x32_bf16 v[252:255], a[232:235], v[28:31], v[252:255]
    buffer_load_dwordx4 v6, s[8:11], s21 offen lds
    v_mfma_f32_16x16x32_bf16 v[204:207], a[232:235], v[22:25], v[204:207]
    v_exp_f32 v65, v65
    v_mfma_f32_16x16x32_bf16 v[156:159], a[232:235], v[16:19], v[156:159]
    s_waitcnt lgkmcnt(2)
    ds_read_b128 a[224:227], v1 offset:13312
    v_mfma_f32_16x16x32_bf16 v[52:55], a[212:215], a[96:99], 0
    v_cvt_pk_bf16_f32 v33, v78, v79
    v_fma_f32 v83, v83, s28, v12
    v_mfma_f32_16x16x32_bf16 v[52:55], a[216:219], a[100:103], v[52:55]
    s_waitcnt lgkmcnt(2)
    ds_read_b128 v[84:87], v8 offset:3072
    v_cvt_pk_bf16_f32 v21, v62, v63
    v_mfma_f32_16x16x32_bf16 v[52:55], a[220:223], a[104:107], v[52:55]
    ds_read_b128 a[232:235], v1 offset:14336
    v_cvt_pk_bf16_f32 v22, v64, v65
    v_mfma_f32_16x16x32_bf16 v[60:63], a[220:223], a[128:131], 0
    v_exp_f32 v67, v67
    v_mfma_f32_16x16x32_bf16 v[60:63], a[216:219], a[124:127], v[60:63]
    v_exp_f32 v66, v66
    v_mfma_f32_16x16x32_bf16 v[60:63], a[212:215], a[120:123], v[60:63]
    s_add_u32 s21, s21, 12032
    v_exp_f32 v57, v57
    v_mfma_f32_16x16x32_bf16 v[68:71], a[212:215], a[144:147], 0
    v_exp_f32 v58, v58
    v_mfma_f32_16x16x32_bf16 v[68:71], a[216:219], a[148:151], v[68:71]
    v_exp_f32 v75, v75
    v_mfma_f32_16x16x32_bf16 v[68:71], a[220:223], a[152:155], v[68:71]
    v_mfma_f32_16x16x32_bf16 v[76:79], a[220:223], a[176:179], 0
    v_exp_f32 v56, v56
    v_mfma_f32_16x16x32_bf16 v[76:79], a[216:219], a[172:175], v[76:79]
    v_cvt_pk_bf16_f32 v17, v58, v59
    v_mfma_f32_16x16x32_bf16 v[76:79], a[212:215], a[168:171], v[76:79]
    s_waitcnt lgkmcnt(1)
    v_exp_f32 v81, v81
    v_mfma_f32_16x16x32_bf16 v[76:79], a[224:227], a[180:183], v[76:79]
    v_exp_f32 v74, v74
    v_mfma_f32_16x16x32_bf16 v[76:79], a[228:231], a[184:187], v[76:79]
    s_waitcnt lgkmcnt(0)
    v_exp_f32 v83, v83
    v_mfma_f32_16x16x32_bf16 v[76:79], a[232:235], a[188:191], v[76:79]
    v_cvt_pk_bf16_f32 v23, v66, v67
    v_mfma_f32_16x16x32_bf16 v[68:71], a[232:235], a[164:167], v[68:71]
    v_cvt_pk_bf16_f32 v16, v56, v57
    v_mfma_f32_16x16x32_bf16 v[68:71], a[228:231], a[160:163], v[68:71]
    v_exp_f32 v72, v72
    v_mfma_f32_16x16x32_bf16 v[68:71], a[224:227], a[156:159], v[68:71]
    ds_read_b128 a[216:219], v1 offset:18432
    v_mfma_f32_16x16x32_bf16 v[60:63], a[224:227], a[132:135], v[60:63]
    s_add_u32 s56, s24, 5888
    ds_read_b128 a[212:215], v0 offset:18432
    v_mfma_f32_16x16x32_bf16 v[60:63], a[228:231], a[136:139], v[60:63]
    v_exp_f32 v82, v82
    v_mfma_f32_16x16x32_bf16 v[60:63], a[232:235], a[140:143], v[60:63]
    v_exp_f32 v73, v73
    v_mfma_f32_16x16x32_bf16 v[52:55], a[232:235], a[116:119], v[52:55]
    ds_read_b128 a[220:223], v0 offset:19456
    v_mfma_f32_16x16x32_bf16 v[44:47], a[236:239], v[14:17], v[48:51]
    ds_read_b128 a[232:235], v1 offset:20480
    s_add_u32 s57, s24, 6016
    v_mfma_f32_16x16x32_bf16 v[52:55], a[228:231], a[112:115], v[52:55]
    buffer_store_dwordx4 v[96:99], v102, s[16:19], s56 offen offset:0 nt
    ds_read_b128 a[228:231], v0 offset:20480
    v_cvt_pk_bf16_f32 v34, v80, v81
    v_mfma_f32_16x16x32_bf16 v[44:47], a[240:243], v[20:23], v[44:47]
    v_cvt_pk_bf16_f32 v29, v74, v75
    v_cvt_pk_bf16_f32 v28, v72, v73
    v_mfma_f32_16x16x32_bf16 v[52:55], a[224:227], a[108:111], v[52:55]
    ds_read_b128 a[224:227], v1 offset:19456
    v_cvt_pk_bf16_f32 v35, v82, v83
    v_mfma_f32_16x16x32_bf16 v[44:47], a[244:247], v[26:29], v[44:47]
    s_nop 0
    v_mfma_f32_16x16x32_bf16 v[44:47], a[248:251], v[32:35], v[44:47]
    s_waitcnt lgkmcnt(4)
    ds_read_b128 v[96:99], v8 offset:5120
    v_mfma_f32_16x16x32_bf16 v[56:59], a[212:215], a[96:99], 0
    buffer_store_dwordx4 v[84:87], v103, s[16:19], s56 offen offset:0 nt
    s_nop 3
    v_cmp_lt_f32 vcc, s29, v44
    v_mfma_f32_16x16x32_bf16 v[56:59], a[216:219], a[100:103], v[56:59]
    s_waitcnt lgkmcnt(4)
    v_mfma_f32_16x16x32_bf16 v[56:59], a[220:223], a[104:107], v[56:59]
    ds_read_b128 v[84:87], v8 offset:0
    v_mfma_f32_16x16x32_bf16 v[64:67], a[220:223], a[128:131], 0
    v_mfma_f32_16x16x32_bf16 v[64:67], a[216:219], a[124:127], v[64:67]
    buffer_store_dwordx4 v[88:91], v102, s[16:19], s57 offen offset:0 nt
    s_cbranch_vccnz L_rs_end4a
L_ret_end4a:
    ds_read_b128 v[88:91], v8 offset:1024
    s_waitcnt vmcnt(10) lgkmcnt(3)
    v_fma_f32 v55, v55, s28, v9
    v_mfma_f32_16x16x32_bf16 v[64:67], a[212:215], a[120:123], v[64:67]
    s_barrier
    v_mfma_f32_16x16x32_bf16 v[72:75], a[212:215], a[144:147], 0
    v_fma_f32 v53, v53, s28, v9
    v_fma_f32 v52, v52, s28, v9
    v_mfma_f32_16x16x32_bf16 v[72:75], a[216:219], a[148:151], v[72:75]
    v_exp_f32 v53, v53
    v_mfma_f32_16x16x32_bf16 v[72:75], a[220:223], a[152:155], v[72:75]
    v_exp_f32 v52, v52
    v_mfma_f32_16x16x32_bf16 v[80:83], a[220:223], a[176:179], 0
    v_fma_f32 v60, v60, s28, v10
    v_mfma_f32_16x16x32_bf16 v[80:83], a[216:219], a[172:175], v[80:83]
    v_mfma_f32_16x16x32_bf16 v[80:83], a[212:215], a[168:171], v[80:83]
    v_exp_f32 v55, v55
    v_mfma_f32_16x16x32_bf16 v[80:83], a[224:227], a[180:183], v[80:83]
    v_mfma_f32_16x16x32_bf16 v[80:83], a[228:231], a[184:187], v[80:83]
    ds_read_b64_tr_b16 a[212:213], v2 offset:0
    v_cvt_pk_bf16_f32 v18, v52, v53
    v_mfma_f32_16x16x32_bf16 v[80:83], a[232:235], a[188:191], v[80:83]
    ds_read_b64_tr_b16 a[214:215], v2 offset:6144
    v_fma_f32 v54, v54, s28, v9
    v_mfma_f32_16x16x32_bf16 v[72:75], a[232:235], a[164:167], v[72:75]
    v_exp_f32 v54, v54
    v_mfma_f32_16x16x32_bf16 v[72:75], a[228:231], a[160:163], v[72:75]
    s_waitcnt lgkmcnt(2)
    buffer_store_dwordx4 v[96:99], v103, s[16:19], s57 offen offset:0 nt
    ds_read_b64_tr_b16 a[216:217], v3 offset:0
    v_fma_f32 v61, v61, s28, v10
    v_mfma_f32_16x16x32_bf16 v[72:75], a[224:227], a[156:159], v[72:75]
    ds_read_b64_tr_b16 a[218:219], v3 offset:6144
    v_mfma_f32_16x16x32_bf16 v[64:67], a[224:227], a[132:135], v[64:67]
    v_exp_f32 v61, v61
    v_mfma_f32_16x16x32_bf16 v[64:67], a[228:231], a[136:139], v[64:67]
    buffer_store_dwordx4 v[84:87], v102, s[16:19], s24 offen offset:0 nt
    v_exp_f32 v60, v60
    v_cvt_pk_bf16_f32 v19, v54, v55
    v_mfma_f32_16x16x32_bf16 v[64:67], a[232:235], a[140:143], v[64:67]
    ds_read_b64_tr_b16 a[220:221], v4 offset:0
    v_mfma_f32_16x16x32_bf16 v[56:59], a[232:235], a[116:119], v[56:59]
    v_cvt_pk_bf16_f32 v24, v60, v61
    v_mfma_f32_16x16x32_bf16 v[56:59], a[228:231], a[112:115], v[56:59]
    buffer_store_dwordx4 v[88:91], v103, s[16:19], s24 offen offset:0 nt
    ds_read_b64_tr_b16 a[222:223], v4 offset:6144
    v_mfma_f32_16x16x32_bf16 v[56:59], a[224:227], a[108:111], v[56:59]
    ds_read_b64_tr_b16 a[224:225], v5 offset:0
    ds_read_b64_tr_b16 a[226:227], v5 offset:6144
    ds_read_b64_tr_b16 a[232:233], v3 offset:1024
    v_fma_f32 v68, v68, s28, v11
    s_waitcnt lgkmcnt(7)
    v_mfma_f32_16x16x32_bf16 v[112:115], a[212:215], v[14:17], v[112:115]
    s_add_u32 s39, s39, 12288
    ds_read_b64_tr_b16 a[234:235], v3 offset:7168
    v_fma_f32 v74, v74, s28, v11
    v_mfma_f32_16x16x32_bf16 v[160:163], a[212:215], v[20:23], v[160:163]
    ds_read_b64_tr_b16 a[228:229], v2 offset:1024
    v_fma_f32 v75, v75, s28, v11
    v_mfma_f32_16x16x32_bf16 v[208:211], a[212:215], v[26:29], v[208:211]
    s_waitcnt vmcnt(6)
    v_fma_f32 v77, v77, s28, v12
    v_fma_f32 v57, v57, s28, v9
    v_mfma_f32_16x16x32_bf16 a[0:3], a[212:215], v[32:35], a[0:3]
    s_waitcnt lgkmcnt(7)
    ds_read_b64_tr_b16 a[230:231], v2 offset:7168
    v_fma_f32 v79, v79, s28, v12
    v_mfma_f32_16x16x32_bf16 a[4:7], a[216:219], v[32:35], a[4:7]
    s_barrier
    v_mfma_f32_16x16x32_bf16 v[212:215], a[216:219], v[26:29], v[212:215]
    v_fma_f32 v73, v73, s28, v11
    v_fma_f32 v65, v65, s28, v10
    v_fma_f32 v64, v64, s28, v10
    v_mfma_f32_16x16x32_bf16 v[164:167], a[216:219], v[20:23], v[164:167]
    v_exp_f32 v74, v74
    v_fma_f32 v71, v71, s28, v11
    v_mfma_f32_16x16x32_bf16 v[116:119], a[216:219], v[14:17], v[116:119]
    s_waitcnt lgkmcnt(6)
    v_exp_f32 v68, v68
    v_mfma_f32_16x16x32_bf16 v[120:123], a[220:223], v[14:17], v[120:123]
    v_exp_f32 v75, v75
    v_mfma_f32_16x16x32_bf16 v[168:171], a[220:223], v[20:23], v[168:171]
    ds_read_b64_tr_b16 a[212:213], v4 offset:1024
    v_fma_f32 v81, v81, s28, v12
    v_mfma_f32_16x16x32_bf16 v[216:219], a[220:223], v[26:29], v[216:219]
    v_exp_f32 v77, v77
    v_mfma_f32_16x16x32_bf16 a[8:11], a[220:223], v[32:35], a[8:11]
    s_waitcnt lgkmcnt(2)
    ds_read_b64_tr_b16 a[218:219], v5 offset:7168
    v_fma_f32 v66, v66, s28, v10
    v_mfma_f32_16x16x32_bf16 a[12:15], a[224:227], v[32:35], a[12:15]
    ds_read_b64_tr_b16 a[214:215], v4 offset:7168
    v_fma_f32 v62, v62, s28, v10
    v_mfma_f32_16x16x32_bf16 v[220:223], a[224:227], v[26:29], v[220:223]
    ds_read_b64_tr_b16 a[216:217], v5 offset:1024
    v_fma_f32 v82, v82, s28, v12
    v_mfma_f32_16x16x32_bf16 v[172:175], a[224:227], v[20:23], v[172:175]
    ds_read_b64_tr_b16 a[220:221], v2 offset:2048
    v_fma_f32 v63, v63, s28, v10
    v_mfma_f32_16x16x32_bf16 v[124:127], a[224:227], v[14:17], v[124:127]
    s_waitcnt lgkmcnt(5)
    v_exp_f32 v64, v64
    v_mfma_f32_16x16x32_bf16 v[128:131], a[228:231], v[14:17], v[128:131]
    v_exp_f32 v82, v82
    v_mfma_f32_16x16x32_bf16 v[176:179], a[228:231], v[20:23], v[176:179]
    v_fma_f32 v70, v70, s28, v11
    v_fma_f32 v80, v80, s28, v12
    v_mfma_f32_16x16x32_bf16 v[224:227], a[228:231], v[26:29], v[224:227]
    ds_read_b64_tr_b16 a[222:223], v2 offset:8192
    v_fma_f32 v56, v56, s28, v9
    v_mfma_f32_16x16x32_bf16 a[16:19], a[228:231], v[32:35], a[16:19]
    ds_read_b64_tr_b16 a[226:227], v3 offset:8192
    v_fma_f32 v59, v59, s28, v9
    v_mfma_f32_16x16x32_bf16 a[20:23], a[232:235], v[32:35], a[20:23]
    v_exp_f32 v56, v56
    v_mfma_f32_16x16x32_bf16 v[228:231], a[232:235], v[26:29], v[228:231]
    v_fma_f32 v58, v58, s28, v9
    v_fma_f32 v69, v69, s28, v11
    v_mfma_f32_16x16x32_bf16 v[180:183], a[232:235], v[20:23], v[180:183]
    ds_read_b64_tr_b16 a[224:225], v3 offset:2048
    v_fma_f32 v78, v78, s28, v12
    v_mfma_f32_16x16x32_bf16 v[132:135], a[232:235], v[14:17], v[132:135]
    s_waitcnt lgkmcnt(4)
    v_exp_f32 v66, v66
    v_mfma_f32_16x16x32_bf16 v[136:139], a[212:215], v[14:17], v[136:139]
    v_exp_f32 v71, v71
    v_mfma_f32_16x16x32_bf16 v[184:187], a[212:215], v[20:23], v[184:187]
    ds_read_b64_tr_b16 a[228:229], v4 offset:2048
    v_fma_f32 v83, v83, s28, v12
    v_mfma_f32_16x16x32_bf16 v[232:235], a[212:215], v[26:29], v[232:235]
    v_exp_f32 v69, v69
    v_exp_f32 v63, v63
    v_mfma_f32_16x16x32_bf16 a[24:27], a[212:215], v[32:35], a[24:27]
    ds_read_b64_tr_b16 a[230:231], v4 offset:8192
    v_exp_f32 v78, v78
    v_mfma_f32_16x16x32_bf16 a[28:31], a[216:219], v[32:35], a[28:31]
    v_exp_f32 v57, v57
    v_mfma_f32_16x16x32_bf16 v[236:239], a[216:219], v[26:29], v[236:239]
    v_exp_f32 v81, v81
    v_mfma_f32_16x16x32_bf16 v[188:191], a[216:219], v[20:23], v[188:191]
    ds_read_b64_tr_b16 a[232:233], v5 offset:2048
    v_cvt_pk_bf16_f32 v30, v68, v69
    v_mfma_f32_16x16x32_bf16 v[140:143], a[216:219], v[14:17], v[140:143]
    s_waitcnt lgkmcnt(3)
    v_exp_f32 v65, v65
    v_mfma_f32_16x16x32_bf16 v[144:147], a[220:223], v[14:17], v[144:147]
    v_fma_f32 v76, v76, s28, v12
    v_exp_f32 v76, v76
    v_mfma_f32_16x16x32_bf16 v[192:195], a[220:223], v[20:23], v[192:195]
    ds_read_b64_tr_b16 a[234:235], v5 offset:8192
    v_fma_f32 v72, v72, s28, v11
    v_mfma_f32_16x16x32_bf16 v[240:243], a[220:223], v[26:29], v[240:243]
    v_exp_f32 v73, v73
    v_mfma_f32_16x16x32_bf16 a[32:35], a[220:223], v[32:35], a[32:35]
    ds_read_b64_tr_b16 a[212:213], v2 offset:18432
    v_fma_f32 v67, v67, s28, v10
    v_mfma_f32_16x16x32_bf16 a[36:39], a[224:227], v[32:35], a[36:39]
    ds_read_b64_tr_b16 a[214:215], v2 offset:12288
    v_exp_f32 v59, v59
    v_mfma_f32_16x16x32_bf16 v[244:247], a[224:227], v[26:29], v[244:247]
    ds_read_b64_tr_b16 a[216:217], v3 offset:18432
    v_exp_f32 v79, v79
    v_mfma_f32_16x16x32_bf16 v[196:199], a[224:227], v[20:23], v[196:199]
    ds_read_b64_tr_b16 a[218:219], v3 offset:12288
    v_exp_f32 v62, v62
    v_mfma_f32_16x16x32_bf16 v[148:151], a[224:227], v[14:17], v[148:151]
    s_waitcnt lgkmcnt(5)
    v_exp_f32 v72, v72
    v_mfma_f32_16x16x32_bf16 v[152:155], a[228:231], v[14:17], v[152:155]
    v_exp_f32 v58, v58
    v_mfma_f32_16x16x32_bf16 v[200:203], a[228:231], v[20:23], v[200:203]
    v_exp_f32 v67, v67
    v_mfma_f32_16x16x32_bf16 v[248:251], a[228:231], v[26:29], v[248:251]
    v_exp_f32 v83, v83
    v_mfma_f32_16x16x32_bf16 a[40:43], a[228:231], v[32:35], a[40:43]
    s_waitcnt lgkmcnt(4)
    ds_read_b64_tr_b16 a[220:221], v4 offset:18432
    v_cvt_pk_bf16_f32 v36, v76, v77
    v_mfma_f32_16x16x32_bf16 a[44:47], a[232:235], v[32:35], a[44:47]
    v_exp_f32 v70, v70
    v_mfma_f32_16x16x32_bf16 v[252:255], a[232:235], v[26:29], v[252:255]
    v_cvt_pk_bf16_f32 v25, v62, v63
    v_exp_f32 v80, v80
    v_mfma_f32_16x16x32_bf16 v[204:207], a[232:235], v[20:23], v[204:207]
    ds_read_b64_tr_b16 a[222:223], v4 offset:12288
    v_cvt_pk_bf16_f32 v31, v70, v71
    v_mfma_f32_16x16x32_bf16 v[156:159], a[232:235], v[14:17], v[156:159]
    v_cvt_pk_bf16_f32 v16, v56, v57
    v_cvt_pk_bf16_f32 v17, v58, v59
    v_cvt_pk_bf16_f32 v23, v66, v67
    v_cvt_pk_bf16_f32 v22, v64, v65
    v_mfma_f32_16x16x32_bf16 v[48:51], a[236:239], v[16:19], v[44:47]
    ds_read_b64_tr_b16 a[224:225], v5 offset:18432
    v_cvt_pk_bf16_f32 v28, v72, v73
    v_mfma_f32_16x16x32_bf16 v[48:51], a[240:243], v[22:25], v[48:51]
    v_cvt_pk_bf16_f32 v35, v82, v83
    v_cvt_pk_bf16_f32 v29, v74, v75
    v_cvt_pk_bf16_f32 v34, v80, v81
    v_cvt_pk_bf16_f32 v37, v78, v79
    v_mfma_f32_16x16x32_bf16 v[48:51], a[244:247], v[28:31], v[48:51]
    ds_read_b64_tr_b16 a[226:227], v5 offset:12288
    v_mfma_f32_16x16x32_bf16 v[48:51], a[248:251], v[34:37], v[48:51]
    s_nop 7
    v_cmp_lt_f32 vcc, s29, v48
    s_nop 4
    s_cbranch_vccnz L_rs_end4b
L_ret_end4b:
    s_waitcnt lgkmcnt(6)
    v_mfma_f32_16x16x32_bf16 v[112:115], a[212:215], v[16:19], v[112:115]
    ds_read_b64_tr_b16 a[228:229], v2 offset:19456
    v_mbcnt_lo_u32_b32 v104, -1, 0
    v_mfma_f32_16x16x32_bf16 v[160:163], a[212:215], v[22:25], v[160:163]
    ds_read_b64_tr_b16 a[234:235], v3 offset:13312
    v_mbcnt_hi_u32_b32 v104, -1, v104
    v_mfma_f32_16x16x32_bf16 v[208:211], a[212:215], v[28:31], v[208:211]
    v_rcp_f32 v49, v49
    v_mfma_f32_16x16x32_bf16 a[0:3], a[212:215], v[34:37], a[0:3]
    ds_read_b64_tr_b16 a[232:233], v3 offset:19456
    s_waitcnt lgkmcnt(7)
    v_mfma_f32_16x16x32_bf16 a[4:7], a[216:219], v[34:37], a[4:7]
    ds_read_b64_tr_b16 a[230:231], v2 offset:13312
    v_mov_b32 v100, v48
    v_mfma_f32_16x16x32_bf16 v[212:215], a[216:219], v[28:31], v[212:215]
    v_bfe_u32 v105, v104, 3, 1
    v_mul_f32 v161, v161, v49
    v_mfma_f32_16x16x32_bf16 v[164:167], a[216:219], v[22:25], v[164:167]
    s_add_u32 s84, s34, 0
    v_mul_f32 v163, v163, v49
    v_accvgpr_read_b32 v109, a5
    v_mfma_f32_16x16x32_bf16 v[116:119], a[216:219], v[16:19], v[116:119]
    ds_read_b64_tr_b16 a[212:213], v4 offset:19456
    s_waitcnt lgkmcnt(7)
    v_mfma_f32_16x16x32_bf16 v[120:123], a[220:223], v[16:19], v[120:123]
    v_permlane32_swap_b32 v48, v100
    v_mfma_f32_16x16x32_bf16 v[168:171], a[220:223], v[22:25], v[168:171]
    v_subrev_u32 v8, 22528, v8
    v_and_b32 v107, 3, v104
    v_mfma_f32_16x16x32_bf16 v[216:219], a[220:223], v[28:31], v[216:219]
    v_rcp_f32 v50, v50
    v_mfma_f32_16x16x32_bf16 a[8:11], a[220:223], v[34:37], a[8:11]
    s_waitcnt lgkmcnt(3)
    ds_read_b64_tr_b16 a[214:215], v4 offset:13312
    v_lshrrev_b32 v106, 5, v104
    v_mfma_f32_16x16x32_bf16 a[12:15], a[224:227], v[34:37], a[12:15]
    v_rcp_f32 v48, v48
    v_mfma_f32_16x16x32_bf16 v[220:223], a[224:227], v[28:31], v[220:223]
    ds_read_b64_tr_b16 a[216:217], v5 offset:19456
    v_mul_f32 v170, v170, v49
    v_mfma_f32_16x16x32_bf16 v[172:175], a[224:227], v[22:25], v[172:175]
    ds_read_b64_tr_b16 a[220:221], v2 offset:20480
    v_accvgpr_read_b32 v111, a7
    v_mfma_f32_16x16x32_bf16 v[124:127], a[224:227], v[16:19], v[124:127]
    s_waitcnt lgkmcnt(4)
    v_rcp_f32 v51, v51
    v_mfma_f32_16x16x32_bf16 v[128:131], a[228:231], v[16:19], v[128:131]
    v_mul_f32 v160, v160, v49
    v_xor_b32 v106, v106, v105
    v_mfma_f32_16x16x32_bf16 v[176:179], a[228:231], v[22:25], v[176:179]
    ds_read_b64_tr_b16 a[218:219], v5 offset:13312
    v_mul_f32 v165, v165, v49
    v_mfma_f32_16x16x32_bf16 v[224:227], a[228:231], v[28:31], v[224:227]
    ds_read_b64_tr_b16 a[222:223], v2 offset:14336
    v_cvt_pk_bf16_f32 v160, v160, v161
    v_mfma_f32_16x16x32_bf16 a[16:19], a[228:231], v[34:37], a[16:19]
    v_mul_f32 v172, v172, v49
    v_mul_f32 v164, v164, v49
    v_mfma_f32_16x16x32_bf16 a[20:23], a[232:235], v[34:37], a[20:23]
    v_mul_f32 v171, v171, v49
    v_xor_b32 v105, s65, v105
    v_mfma_f32_16x16x32_bf16 v[228:231], a[232:235], v[28:31], v[228:231]
    ds_read_b64_tr_b16 a[226:227], v3 offset:14336
    v_cvt_pk_bf16_f32 v164, v164, v165
    v_mfma_f32_16x16x32_bf16 v[180:183], a[232:235], v[22:25], v[180:183]
    v_accvgpr_read_b32 v55, a11
    v_mul_f32 v176, v176, v49
    v_mfma_f32_16x16x32_bf16 v[132:135], a[232:235], v[16:19], v[132:135]
    s_waitcnt lgkmcnt(4)
    ds_read_b64_tr_b16 a[224:225], v3 offset:20480
    v_lshl_or_b32 v106, v107, 1, v106
    v_mfma_f32_16x16x32_bf16 v[136:139], a[212:215], v[16:19], v[136:139]
    v_mul_f32 v55, v55, v51
    v_and_b32 v107, 7, v104
    v_mfma_f32_16x16x32_bf16 v[184:187], a[212:215], v[22:25], v[184:187]
    v_mul_f32 v168, v168, v49
    v_mul_f32 v175, v175, v49
    v_mfma_f32_16x16x32_bf16 v[232:235], a[212:215], v[28:31], v[232:235]
    ds_read_b64_tr_b16 a[228:229], v4 offset:20480
    v_mul_f32 v169, v169, v49
    v_mfma_f32_16x16x32_bf16 a[24:27], a[212:215], v[34:37], a[24:27]
    s_waitcnt lgkmcnt(4)
    ds_read_b64_tr_b16 a[232:233], v5 offset:20480
    v_lshl_add_u32 v101, v105, 10, s38
    v_mfma_f32_16x16x32_bf16 a[28:31], a[216:219], v[34:37], a[28:31]
    ds_read_b64_tr_b16 a[230:231], v4 offset:14336
    v_accvgpr_read_b32 v56, a12
    v_mfma_f32_16x16x32_bf16 v[236:239], a[216:219], v[28:31], v[236:239]
    v_accvgpr_read_b32 v57, a13
    v_mul_f32 v173, v173, v49
    v_mfma_f32_16x16x32_bf16 v[188:191], a[216:219], v[22:25], v[188:191]
    s_add_u32 s85, s34, 6144
    v_cvt_pk_bf16_f32 v168, v168, v169
    v_cvt_pk_bf16_f32 v172, v172, v173
    v_mfma_f32_16x16x32_bf16 v[140:143], a[216:219], v[16:19], v[140:143]
    s_waitcnt lgkmcnt(4)
    v_lshl_add_u32 v101, v106, 4, v101
    s_add_u32 s86, s34, 12288
    v_mfma_f32_16x16x32_bf16 v[144:147], a[220:223], v[16:19], v[144:147]
    v_mul_f32 v162, v162, v49
    v_accvgpr_read_b32 v105, a1
    v_mfma_f32_16x16x32_bf16 v[192:195], a[220:223], v[22:25], v[192:195]
    ds_read_b64_tr_b16 a[234:235], v5 offset:14336
    v_mul_f32 v167, v167, v49
    v_mfma_f32_16x16x32_bf16 v[240:243], a[220:223], v[28:31], v[240:243]
    v_mul_f32 v174, v174, v49
    v_accvgpr_read_b32 v58, a14
    v_mfma_f32_16x16x32_bf16 a[32:35], a[220:223], v[34:37], a[32:35]
    s_waitcnt lgkmcnt(4)
    v_mul_f32 v166, v166, v49
    v_lshl_add_u32 v101, v107, 7, v101
    v_mfma_f32_16x16x32_bf16 a[36:39], a[224:227], v[34:37], a[36:39]
    v_bfe_u32 v107, v104, 4, 1
    v_lshl_add_u32 v101, v107, 3, v101
    v_mfma_f32_16x16x32_bf16 v[244:247], a[224:227], v[28:31], v[244:247]
    v_cvt_pk_bf16_f32 v161, v162, v163
    v_accvgpr_read_b32 v54, a10
    v_mfma_f32_16x16x32_bf16 v[196:199], a[224:227], v[22:25], v[196:199]
    s_add_u32 s87, s34, 18432
    v_cvt_pk_bf16_f32 v169, v170, v171
    v_accvgpr_read_b32 v59, a15
    v_mfma_f32_16x16x32_bf16 v[148:151], a[224:227], v[16:19], v[148:151]
    s_waitcnt lgkmcnt(1)
    v_cvt_pk_bf16_f32 v173, v174, v175
    v_accvgpr_read_b32 v108, a4
    v_mfma_f32_16x16x32_bf16 v[152:155], a[228:231], v[16:19], v[152:155]
    v_mul_f32 v109, v109, v51
    v_xor_b32 v94, 96, v101
    v_xor_b32 v93, 64, v101
    v_xor_b32 v92, 32, v101
    v_cvt_pk_bf16_f32 v165, v166, v167
    v_pk_mul_f32 v[114:115], v[114:115], v[48:49] op_sel_hi:[1,0]
    v_pk_mul_f32 v[120:121], v[120:121], v[48:49] op_sel_hi:[1,0]
    v_pk_mul_f32 v[124:125], v[124:125], v[48:49] op_sel_hi:[1,0]
    v_pk_mul_f32 v[116:117], v[116:117], v[48:49] op_sel_hi:[1,0]
    v_pk_mul_f32 v[112:113], v[112:113], v[48:49] op_sel_hi:[1,0]
    v_pk_mul_f32 v[118:119], v[118:119], v[48:49] op_sel_hi:[1,0]
    v_cvt_pk_bf16_f32 v116, v116, v117
    v_cvt_pk_bf16_f32 v124, v124, v125
    v_pk_mul_f32 v[126:127], v[126:127], v[48:49] op_sel_hi:[1,0]
    v_cvt_pk_bf16_f32 v112, v112, v113
    v_cvt_pk_bf16_f32 v125, v126, v127
    v_pk_mul_f32 v[122:123], v[122:123], v[48:49] op_sel_hi:[1,0]
    v_cvt_pk_bf16_f32 v117, v118, v119
    v_cvt_pk_bf16_f32 v120, v120, v121
    v_cvt_pk_bf16_f32 v113, v114, v115
    s_add_u32 s18, s34, 24576
    ds_write2st64_b64 v101, v[112:113], v[160:161] offset0:0 offset1:12
    v_mfma_f32_16x16x32_bf16 v[200:203], a[228:231], v[22:25], v[200:203]
    ds_write2st64_b64 v92, v[116:117], v[164:165] offset0:0 offset1:12
    v_cvt_pk_bf16_f32 v121, v122, v123
    v_mfma_f32_16x16x32_bf16 v[248:251], a[228:231], v[28:31], v[248:251]
    ds_write2st64_b64 v93, v[120:121], v[168:169] offset0:0 offset1:12
    v_mfma_f32_16x16x32_bf16 a[40:43], a[228:231], v[34:37], a[40:43]
    ds_write2st64_b64 v94, v[124:125], v[172:173] offset0:0 offset1:12
    ds_read_b128 v[68:71], v8 offset:0
    v_pk_mul_f32 v[140:141], v[140:141], v[48:49] op_sel_hi:[1,0]
    v_mul_f32 v56, v56, v51
    v_pk_mul_f32 v[152:153], v[152:153], v[48:49] op_sel_hi:[1,0]
    v_pk_mul_f32 v[132:133], v[132:133], v[48:49] op_sel_hi:[1,0]
    v_mul_f32 v54, v54, v51
    v_pk_mul_f32 v[228:229], v[228:229], v[50:51] op_sel_hi:[1,0]
    v_pk_mul_f32 v[220:221], v[220:221], v[50:51] op_sel_hi:[1,0]
    v_pk_mul_f32 v[142:143], v[142:143], v[48:49] op_sel_hi:[1,0]
    v_pk_mul_f32 v[144:145], v[144:145], v[48:49] op_sel_hi:[1,0]
    v_mul_f32 v180, v180, v49
    v_mul_f32 v57, v57, v51
    v_accvgpr_read_b32 v52, a8
    v_accvgpr_read_b32 v53, a9
    v_pk_mul_f32 v[128:129], v[128:129], v[48:49] op_sel_hi:[1,0]
    v_mul_f32 v189, v189, v49
    v_mul_f32 v53, v53, v51
    v_pk_mul_f32 v[208:209], v[208:209], v[50:51] op_sel_hi:[1,0]
    v_pk_mul_f32 v[212:213], v[212:213], v[50:51] op_sel_hi:[1,0]
    v_accvgpr_read_b32 v107, a3
    s_waitcnt lgkmcnt(3)
    v_mfma_f32_16x16x32_bf16 a[44:47], a[232:235], v[34:37], a[44:47]
    ds_read_b128 v[72:75], v8 offset:1024
    v_mul_f32 v52, v52, v51
    v_cvt_pk_bf16_f32 v152, v152, v153
    v_cvt_pk_bf16_f32 v208, v208, v209
    v_pk_mul_f32 v[236:237], v[236:237], v[50:51] op_sel_hi:[1,0]
    v_mul_f32 v185, v185, v49
    v_cvt_pk_bf16_f32 v236, v236, v237
    v_mul_f32 v58, v58, v51
    v_mul_f32 v193, v193, v49
    v_cvt_pk_bf16_f32 v52, v52, v53
    v_mul_f32 v203, v203, v49
    v_cvt_pk_bf16_f32 v56, v56, v57
    v_mfma_f32_16x16x32_bf16 v[252:255], a[232:235], v[28:31], v[252:255]
    s_waitcnt lgkmcnt(1)
    buffer_store_dwordx4 v[68:71], v102, s[16:19], s84 offen offset:0 nt
    ds_read_b128 v[76:79], v8 offset:6144
    v_mul_f32 v182, v182, v49
    v_accvgpr_read_b32 v104, a0
    v_mul_f32 v59, v59, v51
    v_mul_f32 v111, v111, v51
    v_pk_mul_f32 v[248:249], v[248:249], v[50:51] op_sel_hi:[1,0]
    v_pk_mul_f32 v[134:135], v[134:135], v[48:49] op_sel_hi:[1,0]
    v_mul_f32 v194, v194, v49
    v_pk_mul_f32 v[130:131], v[130:131], v[48:49] op_sel_hi:[1,0]
    v_mul_f32 v104, v104, v51
    s_nop 0
    v_mfma_f32_16x16x32_bf16 v[204:207], a[232:235], v[22:25], v[204:207]
    v_mul_f32 v108, v108, v51
    v_accvgpr_read_b32 v110, a6
    ds_read_b128 v[80:83], v8 offset:7168
    v_pk_mul_f32 v[218:219], v[218:219], v[50:51] op_sel_hi:[1,0]
    v_mul_f32 v202, v202, v49
    v_pk_mul_f32 v[214:215], v[214:215], v[50:51] op_sel_hi:[1,0]
    v_mul_f32 v110, v110, v51
    v_accvgpr_read_b32 v106, a2
    v_mul_f32 v187, v187, v49
    v_mul_f32 v186, v186, v49
    v_pk_mul_f32 v[216:217], v[216:217], v[50:51] op_sel_hi:[1,0]
    v_mul_f32 v106, v106, v51
    v_mul_f32 v195, v195, v49
    v_mfma_f32_16x16x32_bf16 v[156:159], a[232:235], v[16:19], v[156:159]
    s_waitcnt lgkmcnt(2)
    buffer_store_dwordx4 v[72:75], v103, s[16:19], s84 offen offset:0 nt
    v_cvt_pk_bf16_f32 v108, v108, v109
    v_cvt_pk_bf16_f32 v216, v216, v217
    v_mul_f32 v188, v188, v49
    v_pk_mul_f32 v[230:231], v[230:231], v[50:51] op_sel_hi:[1,0]
    v_cvt_pk_bf16_f32 v144, v144, v145
    v_cvt_pk_bf16_f32 v212, v212, v213
    v_pk_mul_f32 v[136:137], v[136:137], v[48:49] op_sel_hi:[1,0]
    v_mul_f32 v105, v105, v51
    v_pk_mul_f32 v[138:139], v[138:139], v[48:49] op_sel_hi:[1,0]
    v_cvt_pk_bf16_f32 v104, v104, v105
    v_pk_mul_f32 v[222:223], v[222:223], v[50:51] op_sel_hi:[1,0]
    v_cvt_pk_bf16_f32 v109, v110, v111
    v_pk_mul_f32 v[226:227], v[226:227], v[50:51] op_sel_hi:[1,0]
    v_cvt_pk_bf16_f32 v220, v220, v221
    v_pk_mul_f32 v[244:245], v[244:245], v[50:51] op_sel_hi:[1,0]
    v_cvt_pk_bf16_f32 v53, v54, v55
    v_cvt_pk_bf16_f32 v213, v214, v215
    v_cvt_pk_bf16_f32 v217, v218, v219
    v_pk_mul_f32 v[242:243], v[242:243], v[50:51] op_sel_hi:[1,0]
    v_accvgpr_read_b32 v54, a26
    v_cvt_pk_bf16_f32 v221, v222, v223
    v_mul_f32 v190, v190, v49
    v_mul_f32 v107, v107, v51
    v_cvt_pk_bf16_f32 v188, v188, v189
    v_pk_mul_f32 v[210:211], v[210:211], v[50:51] op_sel_hi:[1,0]
    v_cvt_pk_bf16_f32 v57, v58, v59
    v_cvt_pk_bf16_f32 v209, v210, v211
    v_cvt_pk_bf16_f32 v132, v132, v133
    v_cvt_pk_bf16_f32 v105, v106, v107
    s_waitcnt lgkmcnt(0)
    buffer_store_dwordx4 v[76:79], v102, s[16:19], s85 offen offset:0 nt
    v_cvt_pk_bf16_f32 v136, v136, v137
    ds_write2st64_b64 v101, v[208:209], v[104:105] offset0:24 offset1:36
    v_mul_f32 v179, v179, v49
    ds_write2st64_b64 v92, v[212:213], v[108:109] offset0:24 offset1:36
    ds_write2st64_b64 v93, v[216:217], v[52:53] offset0:24 offset1:36
    ds_write2st64_b64 v94, v[220:221], v[56:57] offset0:24 offset1:36
    ds_read_b128 v[84:87], v8 offset:12288
    v_mul_f32 v181, v181, v49
    v_accvgpr_read_b32 v107, a19
    buffer_store_dwordx4 v[80:83], v103, s[16:19], s85 offen offset:0 nt
    v_cvt_pk_bf16_f32 v133, v134, v135
    v_mul_f32 v178, v178, v49
    v_accvgpr_read_b32 v57, a29
    v_pk_mul_f32 v[224:225], v[224:225], v[50:51] op_sel_hi:[1,0]
    v_mul_f32 v207, v207, v49
    v_accvgpr_read_b32 v53, a25
    v_pk_mul_f32 v[146:147], v[146:147], v[48:49] op_sel_hi:[1,0]
    v_mul_f32 v53, v53, v51
    v_cvt_pk_bf16_f32 v137, v138, v139
    ds_read_b128 v[88:91], v8 offset:13312
    v_pk_mul_f32 v[154:155], v[154:155], v[48:49] op_sel_hi:[1,0]
    v_mul_f32 v184, v184, v49
    v_accvgpr_read_b32 v52, a24
    v_cvt_pk_bf16_f32 v224, v224, v225
    v_pk_mul_f32 v[246:247], v[246:247], v[50:51] op_sel_hi:[1,0]
    v_accvgpr_read_b32 v108, a20
    v_pk_mul_f32 v[254:255], v[254:255], v[50:51] op_sel_hi:[1,0]
    v_pk_mul_f32 v[232:233], v[232:233], v[50:51] op_sel_hi:[1,0]
    v_mul_f32 v196, v196, v49
    v_mul_f32 v177, v177, v49
    v_cvt_pk_bf16_f32 v140, v140, v141
    v_pk_mul_f32 v[156:157], v[156:157], v[48:49] op_sel_hi:[1,0]
    v_cvt_pk_bf16_f32 v141, v142, v143
    v_cvt_pk_bf16_f32 v128, v128, v129
    v_accvgpr_read_b32 v59, a31
    v_cvt_pk_bf16_f32 v176, v176, v177
    v_cvt_pk_bf16_f32 v184, v184, v185
    s_waitcnt lgkmcnt(1)
    buffer_store_dwordx4 v[84:87], v102, s[16:19], s86 offen offset:0 nt
    v_cvt_pk_bf16_f32 v185, v186, v187
    v_cvt_pk_bf16_f32 v180, v180, v181
    v_accvgpr_read_b32 v55, a27
    v_pk_mul_f32 v[150:151], v[150:151], v[48:49] op_sel_hi:[1,0]
    v_mul_f32 v183, v183, v49
    v_cvt_pk_bf16_f32 v129, v130, v131
    v_cvt_pk_bf16_f32 v177, v178, v179
    v_accvgpr_read_b32 v110, a22
    v_mul_f32 v57, v57, v51
    v_mul_f32 v110, v110, v51
    v_cvt_pk_bf16_f32 v181, v182, v183
    v_cvt_pk_bf16_f32 v225, v226, v227
    ds_read_b128 v[60:63], v8 offset:18432
    ds_read_b128 v[64:67], v8 offset:19456
    v_pk_mul_f32 v[252:253], v[252:253], v[50:51] op_sel_hi:[1,0]
    v_cvt_pk_bf16_f32 v228, v228, v229
    ds_write2st64_b64 v101, v[128:129], v[176:177] offset0:4 offset1:16
    v_mul_f32 v199, v199, v49
    v_pk_mul_f32 v[238:239], v[238:239], v[50:51] op_sel_hi:[1,0]
    s_waitcnt lgkmcnt(3)
    buffer_store_dwordx4 v[88:91], v103, s[16:19], s86 offen offset:0 nt
    v_mul_f32 v206, v206, v49
    v_accvgpr_read_b32 v105, a17
    ds_write2st64_b64 v92, v[132:133], v[180:181] offset0:4 offset1:16
    v_mul_f32 v52, v52, v51
    v_pk_mul_f32 v[148:149], v[148:149], v[48:49] op_sel_hi:[1,0]
    v_mul_f32 v191, v191, v49
    v_cvt_pk_bf16_f32 v52, v52, v53
    v_mul_f32 v107, v107, v51
    v_accvgpr_read_b32 v111, a23
    v_accvgpr_read_b32 v104, a16
    v_mul_f32 v104, v104, v51
    v_mul_f32 v204, v204, v49
    v_mul_f32 v111, v111, v51
    v_pk_mul_f32 v[234:235], v[234:235], v[50:51] op_sel_hi:[1,0]
    v_accvgpr_read_b32 v56, a28
    v_cvt_pk_bf16_f32 v237, v238, v239
    v_cvt_pk_bf16_f32 v252, v252, v253
    v_mul_f32 v108, v108, v51
    v_mul_f32 v105, v105, v51
    v_mul_f32 v55, v55, v51
    v_mul_f32 v54, v54, v51
    v_accvgpr_read_b32 v106, a18
    v_mul_f32 v56, v56, v51
    s_waitcnt lgkmcnt(1)
    buffer_store_dwordx4 v[60:63], v102, s[16:19], s87 offen offset:0 nt
    v_accvgpr_read_b32 v109, a21
    v_cvt_pk_bf16_f32 v148, v148, v149
    v_cvt_pk_bf16_f32 v104, v104, v105
    v_cvt_pk_bf16_f32 v189, v190, v191
    v_mul_f32 v197, v197, v49
    v_mul_f32 v106, v106, v51
    ds_write2st64_b64 v93, v[136:137], v[184:185] offset0:4 offset1:16
    ds_write2st64_b64 v94, v[140:141], v[188:189] offset0:4 offset1:16
    v_cvt_pk_bf16_f32 v105, v106, v107
    v_accvgpr_read_b32 v58, a30
    v_mul_f32 v58, v58, v51
    v_mul_f32 v192, v192, v49
    ds_read_b128 v[68:71], v8 offset:2048
    buffer_store_dwordx4 v[64:67], v103, s[16:19], s87 offen offset:0 nt
    v_cvt_pk_bf16_f32 v153, v154, v155
    v_cvt_pk_bf16_f32 v232, v232, v233
    ds_read_b128 v[72:75], v8 offset:3072
    v_cvt_pk_bf16_f32 v229, v230, v231
    v_mul_f32 v59, v59, v51
    v_cvt_pk_bf16_f32 v156, v156, v157
    v_accvgpr_read_b32 v106, a34
    ds_read_b128 v[76:79], v8 offset:8192
    v_mul_f32 v109, v109, v51
    ds_read_b128 v[80:83], v8 offset:9216
    v_cvt_pk_bf16_f32 v56, v56, v57
    ds_write2st64_b64 v101, v[224:225], v[104:105] offset0:28 offset1:40
    v_cvt_pk_bf16_f32 v233, v234, v235
    v_cvt_pk_bf16_f32 v108, v108, v109
    v_cvt_pk_bf16_f32 v57, v58, v59
    v_cvt_pk_bf16_f32 v53, v54, v55
    s_waitcnt lgkmcnt(4)
    buffer_store_dwordx4 v[68:71], v102, s[16:19], s84 offen offset:128 nt
    v_cvt_pk_bf16_f32 v109, v110, v111
    v_accvgpr_read_b32 v107, a35
    v_pk_mul_f32 v[158:159], v[158:159], v[48:49] op_sel_hi:[1,0]
    ds_write2st64_b64 v92, v[228:229], v[108:109] offset0:28 offset1:40
    ds_write2st64_b64 v93, v[232:233], v[52:53] offset0:28 offset1:40
    v_mul_f32 v107, v107, v51
    v_mul_f32 v205, v205, v49
    v_accvgpr_read_b32 v55, a43
    s_waitcnt lgkmcnt(3)
    buffer_store_dwordx4 v[72:75], v103, s[16:19], s84 offen offset:128 nt
    ds_write2st64_b64 v94, v[236:237], v[56:57] offset0:28 offset1:40
    buffer_store_dwordx4 v[76:79], v102, s[16:19], s85 offen offset:128 nt
    v_cvt_pk_bf16_f32 v192, v192, v193
    ds_read_b128 v[84:87], v8 offset:14336
    v_cvt_pk_bf16_f32 v196, v196, v197
    v_mul_f32 v200, v200, v49
    v_cvt_pk_bf16_f32 v244, v244, v245
    v_cvt_pk_bf16_f32 v157, v158, v159
    v_mul_f32 v106, v106, v51
    v_accvgpr_read_b32 v53, a41
    v_accvgpr_read_b32 v52, a40
    v_accvgpr_read_b32 v108, a36
    v_accvgpr_read_b32 v110, a38
    v_accvgpr_read_b32 v58, a46
    v_accvgpr_read_b32 v105, a33
    v_mul_f32 v53, v53, v51
    v_cvt_pk_bf16_f32 v248, v248, v249
    v_mul_f32 v55, v55, v51
    v_pk_mul_f32 v[240:241], v[240:241], v[50:51] op_sel_hi:[1,0]
    v_mul_f32 v52, v52, v51
    v_accvgpr_read_b32 v109, a37
    v_accvgpr_read_b32 v59, a47
    buffer_store_dwordx4 v[80:83], v103, s[16:19], s85 offen offset:128 nt
    v_mul_f32 v201, v201, v49
    ds_read_b128 v[88:91], v8 offset:15360
    v_accvgpr_read_b32 v104, a32
    v_mul_f32 v198, v198, v49
    ds_read_b128 v[60:63], v8 offset:20480
    v_mul_f32 v110, v110, v51
    v_pk_mul_f32 v[250:251], v[250:251], v[50:51] op_sel_hi:[1,0]
    v_accvgpr_read_b32 v54, a42
    v_mul_f32 v54, v54, v51
    v_cvt_pk_bf16_f32 v200, v200, v201
    v_mul_f32 v109, v109, v51
    v_cvt_pk_bf16_f32 v204, v204, v205
    v_cvt_pk_bf16_f32 v193, v194, v195
    v_cvt_pk_bf16_f32 v240, v240, v241
    v_accvgpr_read_b32 v57, a45
    s_waitcnt lgkmcnt(2)
    buffer_store_dwordx4 v[84:87], v102, s[16:19], s86 offen offset:128 nt
    ds_read_b128 v[64:67], v8 offset:21504
    v_cvt_pk_bf16_f32 v145, v146, v147
    v_cvt_pk_bf16_f32 v201, v202, v203
    ds_write2st64_b64 v101, v[144:145], v[192:193] offset0:8 offset1:20
    v_accvgpr_read_b32 v111, a39
    v_cvt_pk_bf16_f32 v197, v198, v199
    v_mul_f32 v59, v59, v51
    v_cvt_pk_bf16_f32 v245, v246, v247
    v_mul_f32 v108, v108, v51
    v_cvt_pk_bf16_f32 v253, v254, v255
    v_accvgpr_read_b32 v56, a44
    v_cvt_pk_bf16_f32 v149, v150, v151
    v_cvt_pk_bf16_f32 v108, v108, v109
    v_mul_f32 v111, v111, v51
    s_waitcnt lgkmcnt(2)
    buffer_store_dwordx4 v[88:91], v103, s[16:19], s86 offen offset:128 nt
    v_cvt_pk_bf16_f32 v205, v206, v207
    v_cvt_pk_bf16_f32 v52, v52, v53
    v_cvt_pk_bf16_f32 v53, v54, v55
    ds_write2st64_b64 v92, v[148:149], v[196:197] offset0:8 offset1:20
    v_cvt_pk_bf16_f32 v241, v242, v243
    ds_write2st64_b64 v93, v[152:153], v[200:201] offset0:8 offset1:20
    buffer_store_dwordx4 v[60:63], v102, s[16:19], s87 offen offset:128 nt
    v_mul_f32 v58, v58, v51
    ds_write2st64_b64 v94, v[156:157], v[204:205] offset0:8 offset1:20
    v_mul_f32 v57, v57, v51
    v_mul_f32 v105, v105, v51
    ds_read_b128 v[68:71], v8 offset:4096
    v_mul_f32 v56, v56, v51
    s_waitcnt lgkmcnt(3)
    buffer_store_dwordx4 v[64:67], v103, s[16:19], s87 offen offset:128 nt
    ds_read_b128 v[72:75], v8 offset:5120
    ds_read_b128 v[76:79], v8 offset:10240
    v_cvt_pk_bf16_f32 v56, v56, v57
    ds_read_b128 v[80:83], v8 offset:11264
    v_mul_f32 v104, v104, v51
    v_cvt_pk_bf16_f32 v109, v110, v111
    v_cvt_pk_bf16_f32 v249, v250, v251
    v_cvt_pk_bf16_f32 v104, v104, v105
    v_cvt_pk_bf16_f32 v57, v58, v59
    s_waitcnt lgkmcnt(3)
    buffer_store_dwordx4 v[68:71], v102, s[16:19], s84 offen offset:256 nt
    v_cvt_pk_bf16_f32 v105, v106, v107
    s_waitcnt lgkmcnt(2)
    buffer_store_dwordx4 v[72:75], v103, s[16:19], s84 offen offset:256 nt
    ds_write2st64_b64 v101, v[240:241], v[104:105] offset0:32 offset1:44
    ds_write2st64_b64 v92, v[244:245], v[108:109] offset0:32 offset1:44
    ds_write2st64_b64 v93, v[248:249], v[52:53] offset0:32 offset1:44
    ds_write2st64_b64 v94, v[252:253], v[56:57] offset0:32 offset1:44
    ds_read_b128 v[84:87], v8 offset:16384
    ds_read_b128 v[88:91], v8 offset:17408
    ds_read_b128 v[60:63], v8 offset:22528
    ds_read_b128 v[64:67], v8 offset:23552
    s_waitcnt lgkmcnt(8)
    buffer_store_dwordx4 v[76:79], v102, s[16:19], s85 offen offset:256 nt
    buffer_store_dwordx4 v[80:83], v103, s[16:19], s85 offen offset:256 nt
    s_waitcnt lgkmcnt(0)
    buffer_store_dwordx4 v[84:87], v102, s[16:19], s86 offen offset:256 nt
    buffer_store_dwordx4 v[88:91], v103, s[16:19], s86 offen offset:256 nt
    buffer_store_dwordx4 v[60:63], v102, s[16:19], s87 offen offset:256 nt
    buffer_store_dwordx4 v[64:67], v103, s[16:19], s87 offen offset:256 nt
    s_branch L_fin
L_fin:
    s_waitcnt vmcnt(0)
L_end:
    s_endpgm
L_codeend:
L_rare5_0:
    s_nop 15
    v_mbcnt_lo_u32_b32 v31, -1, 0
    v_mbcnt_hi_u32_b32 v31, -1, v31
    v_and_b32 v30, 15, v31
    v_mul_u32_u24 v30, 384, v30
    v_lshrrev_b32 v31, 4, v31
    v_lshl_add_u32 v30, v31, 4, v30
    s_add_u32 s69, s39, 0
    buffer_load_dwordx4 v[44:47], v30, s[4:7], s69 offen offset:0
    s_waitcnt vmcnt(0)
    v_mfma_f32_16x16x32_bf16 v[104:107], v[44:47], a[96:99], 0
    s_nop 7
    buffer_load_dwordx4 v[44:47], v30, s[4:7], s69 offen offset:64
    s_waitcnt vmcnt(0)
    v_mfma_f32_16x16x32_bf16 v[104:107], v[44:47], a[100:103], v[104:107]
    s_nop 7
    buffer_load_dwordx4 v[44:47], v30, s[4:7], s69 offen offset:128
    s_waitcnt vmcnt(0)
    v_mfma_f32_16x16x32_bf16 v[104:107], v[44:47], a[104:107], v[104:107]
    s_nop 7
    buffer_load_dwordx4 v[44:47], v30, s[4:7], s69 offen offset:192
    s_waitcnt vmcnt(0)
    v_mfma_f32_16x16x32_bf16 v[104:107], v[44:47], a[108:111], v[104:107]
    s_nop 7
    buffer_load_dwordx4 v[44:47], v30, s[4:7], s69 offen offset:256
    s_waitcnt vmcnt(0)
    v_mfma_f32_16x16x32_bf16 v[104:107], v[44:47], a[112:115], v[104:107]
    s_nop 7
    buffer_load_dwordx4 v[44:47], v30, s[4:7], s69 offen offset:320
    s_waitcnt vmcnt(0)
    v_mfma_f32_16x16x32_bf16 v[104:107], v[44:47], a[116:119], v[104:107]
    s_nop 7
    s_add_u32 s69, s39, 6144
    buffer_load_dwordx4 v[44:47], v30, s[4:7], s69 offen offset:0
    s_waitcnt vmcnt(0)
    v_mfma_f32_16x16x32_bf16 v[108:111], v[44:47], a[96:99], 0
    s_nop 7
    buffer_load_dwordx4 v[44:47], v30, s[4:7], s69 offen offset:64
    s_waitcnt vmcnt(0)
    v_mfma_f32_16x16x32_bf16 v[108:111], v[44:47], a[100:103], v[108:111]
    s_nop 7
    buffer_load_dwordx4 v[44:47], v30, s[4:7], s69 offen offset:128
    s_waitcnt vmcnt(0)
    v_mfma_f32_16x16x32_bf16 v[108:111], v[44:47], a[104:107], v[108:111]
    s_nop 7
    buffer_load_dwordx4 v[44:47], v30, s[4:7], s69 offen offset:192
    s_waitcnt vmcnt(0)
    v_mfma_f32_16x16x32_bf16 v[108:111], v[44:47], a[108:111], v[108:111]
    s_nop 7
    buffer_load_dwordx4 v[44:47], v30, s[4:7], s69 offen offset:256
    s_waitcnt vmcnt(0)
    v_mfma_f32_16x16x32_bf16 v[108:111], v[44:47], a[112:115], v[108:111]
    s_nop 7
    buffer_load_dwordx4 v[44:47], v30, s[4:7], s69 offen offset:320
    s_waitcnt vmcnt(0)
    v_mfma_f32_16x16x32_bf16 v[108:111], v[44:47], a[116:119], v[108:111]
    s_nop 7
    s_nop 15
    v_max3_f32 v18, v104, v105, v106
    v_max3_f32 v18, v18, v107, v108
    v_max3_f32 v18, v18, v109, v110
    v_max_f32 v18, v18, v111
    v_mov_b32 v19, v18
    s_nop 1
    v_permlane32_swap_b32 v19, v18
    v_max_f32 v18, v18, v19
    v_mov_b32 v19, v18
    s_nop 1
    v_permlane16_swap_b32 v19, v18
    v_max_f32 v18, v18, v19
    v_fma_f32 v18, v18, s28, v9
    v_max_f32 v24, 0, v18
    v_sub_f32 v9, v9, v24
    v_sub_f32 v25, 0, v24
    v_exp_f32 v25, v25
    s_nop 0
    v_mul_f32 v19, v48, v25
    v_cndmask_b32_e64 v48, v19, v48, s[60:61]
    v_cndmask_b32_e64 v48, v48, 0, s[46:47]
    v_mul_f32 v112, v112, v25
    v_mul_f32 v113, v113, v25
    v_mul_f32 v114, v114, v25
    v_mul_f32 v115, v115, v25
    v_mul_f32 v116, v116, v25
    v_mul_f32 v117, v117, v25
    v_mul_f32 v118, v118, v25
    v_mul_f32 v119, v119, v25
    v_mul_f32 v120, v120, v25
    v_mul_f32 v121, v121, v25
    v_mul_f32 v122, v122, v25
    v_mul_f32 v123, v123, v25
    v_mul_f32 v124, v124, v25
    v_mul_f32 v125, v125, v25
    v_mul_f32 v126, v126, v25
    v_mul_f32 v127, v127, v25
    v_mul_f32 v128, v128, v25
    v_mul_f32 v129, v129, v25
    v_mul_f32 v130, v130, v25
    v_mul_f32 v131, v131, v25
    v_mul_f32 v132, v132, v25
    v_mul_f32 v133, v133, v25
    v_mul_f32 v134, v134, v25
    v_mul_f32 v135, v135, v25
    v_mul_f32 v136, v136, v25
    v_mul_f32 v137, v137, v25
    v_mul_f32 v138, v138, v25
    v_mul_f32 v139, v139, v25
    v_mul_f32 v140, v140, v25
    v_mul_f32 v141, v141, v25
    v_mul_f32 v142, v142, v25
    v_mul_f32 v143, v143, v25
    v_mul_f32 v144, v144, v25
    v_mul_f32 v145, v145, v25
    v_mul_f32 v146, v146, v25
    v_mul_f32 v147, v147, v25
    v_mul_f32 v148, v148, v25
    v_mul_f32 v149, v149, v25
    v_mul_f32 v150, v150, v25
    v_mul_f32 v151, v151, v25
    v_mul_f32 v152, v152, v25
    v_mul_f32 v153, v153, v25
    v_mul_f32 v154, v154, v25
    v_mul_f32 v155, v155, v25
    v_mul_f32 v156, v156, v25
    v_mul_f32 v157, v157, v25
    v_mul_f32 v158, v158, v25
    v_mul_f32 v159, v159, v25
    v_fma_f32 v104, v104, s28, v9
    v_fma_f32 v105, v105, s28, v9
    v_exp_f32 v104, v104
    v_exp_f32 v105, v105
    s_nop 0
    v_cvt_pk_bf16_f32 v14, v104, v105
    v_fma_f32 v106, v106, s28, v9
    v_fma_f32 v107, v107, s28, v9
    v_exp_f32 v106, v106
    v_exp_f32 v107, v107
    s_nop 0
    v_cvt_pk_bf16_f32 v15, v106, v107
    v_fma_f32 v108, v108, s28, v9
    v_fma_f32 v109, v109, s28, v9
    v_exp_f32 v108, v108
    v_exp_f32 v109, v109
    s_nop 0
    v_cvt_pk_bf16_f32 v16, v108, v109
    v_fma_f32 v110, v110, s28, v9
    v_fma_f32 v111, v111, s28, v9
    v_exp_f32 v110, v110
    v_exp_f32 v111, v111
    s_nop 0
    v_cvt_pk_bf16_f32 v17, v110, v111
    s_add_u32 s69, s39, 0
    buffer_load_dwordx4 v[44:47], v30, s[4:7], s69 offen offset:0
    s_waitcnt vmcnt(0)
    v_mfma_f32_16x16x32_bf16 v[104:107], v[44:47], a[120:123], 0
    s_nop 7
    buffer_load_dwordx4 v[44:47], v30, s[4:7], s69 offen offset:64
    s_waitcnt vmcnt(0)
    v_mfma_f32_16x16x32_bf16 v[104:107], v[44:47], a[124:127], v[104:107]
    s_nop 7
    buffer_load_dwordx4 v[44:47], v30, s[4:7], s69 offen offset:128
    s_waitcnt vmcnt(0)
    v_mfma_f32_16x16x32_bf16 v[104:107], v[44:47], a[128:131], v[104:107]
    s_nop 7
    buffer_load_dwordx4 v[44:47], v30, s[4:7], s69 offen offset:192
    s_waitcnt vmcnt(0)
    v_mfma_f32_16x16x32_bf16 v[104:107], v[44:47], a[132:135], v[104:107]
    s_nop 7
    buffer_load_dwordx4 v[44:47], v30, s[4:7], s69 offen offset:256
    s_waitcnt vmcnt(0)
    v_mfma_f32_16x16x32_bf16 v[104:107], v[44:47], a[136:139], v[104:107]
    s_nop 7
    buffer_load_dwordx4 v[44:47], v30, s[4:7], s69 offen offset:320
    s_waitcnt vmcnt(0)
    v_mfma_f32_16x16x32_bf16 v[104:107], v[44:47], a[140:143], v[104:107]
    s_nop 7
    s_add_u32 s69, s39, 6144
    buffer_load_dwordx4 v[44:47], v30, s[4:7], s69 offen offset:0
    s_waitcnt vmcnt(0)
    v_mfma_f32_16x16x32_bf16 v[108:111], v[44:47], a[120:123], 0
    s_nop 7
    buffer_load_dwordx4 v[44:47], v30, s[4:7], s69 offen offset:64
    s_waitcnt vmcnt(0)
    v_mfma_f32_16x16x32_bf16 v[108:111], v[44:47], a[124:127], v[108:111]
    s_nop 7
    buffer_load_dwordx4 v[44:47], v30, s[4:7], s69 offen offset:128
    s_waitcnt vmcnt(0)
    v_mfma_f32_16x16x32_bf16 v[108:111], v[44:47], a[128:131], v[108:111]
    s_nop 7
    buffer_load_dwordx4 v[44:47], v30, s[4:7], s69 offen offset:192
    s_waitcnt vmcnt(0)
    v_mfma_f32_16x16x32_bf16 v[108:111], v[44:47], a[132:135], v[108:111]
    s_nop 7
    buffer_load_dwordx4 v[44:47], v30, s[4:7], s69 offen offset:256
    s_waitcnt vmcnt(0)
    v_mfma_f32_16x16x32_bf16 v[108:111], v[44:47], a[136:139], v[108:111]
    s_nop 7
    buffer_load_dwordx4 v[44:47], v30, s[4:7], s69 offen offset:320
    s_waitcnt vmcnt(0)
    v_mfma_f32_16x16x32_bf16 v[108:111], v[44:47], a[140:143], v[108:111]
    s_nop 7
    s_nop 15
    v_max3_f32 v18, v104, v105, v106
    v_max3_f32 v18, v18, v107, v108
    v_max3_f32 v18, v18, v109, v110
    v_max_f32 v18, v18, v111
    v_mov_b32 v19, v18
    s_nop 1
    v_permlane32_swap_b32 v19, v18
    v_max_f32 v18, v18, v19
    v_mov_b32 v19, v18
    s_nop 1
    v_permlane16_swap_b32 v19, v18
    v_max_f32 v18, v18, v19
    v_fma_f32 v18, v18, s28, v10
    v_max_f32 v24, 0, v18
    v_sub_f32 v10, v10, v24
    v_sub_f32 v25, 0, v24
    v_exp_f32 v25, v25
    s_nop 0
    v_mul_f32 v49, v49, v25
    v_mul_f32 v160, v160, v25
    v_mul_f32 v161, v161, v25
    v_mul_f32 v162, v162, v25
    v_mul_f32 v163, v163, v25
    v_mul_f32 v164, v164, v25
    v_mul_f32 v165, v165, v25
    v_mul_f32 v166, v166, v25
    v_mul_f32 v167, v167, v25
    v_mul_f32 v168, v168, v25
    v_mul_f32 v169, v169, v25
    v_mul_f32 v170, v170, v25
    v_mul_f32 v171, v171, v25
    v_mul_f32 v172, v172, v25
    v_mul_f32 v173, v173, v25
    v_mul_f32 v174, v174, v25
    v_mul_f32 v175, v175, v25
    v_mul_f32 v176, v176, v25
    v_mul_f32 v177, v177, v25
    v_mul_f32 v178, v178, v25
    v_mul_f32 v179, v179, v25
    v_mul_f32 v180, v180, v25
    v_mul_f32 v181, v181, v25
    v_mul_f32 v182, v182, v25
    v_mul_f32 v183, v183, v25
    v_mul_f32 v184, v184, v25
    v_mul_f32 v185, v185, v25
    v_mul_f32 v186, v186, v25
    v_mul_f32 v187, v187, v25
    v_mul_f32 v188, v188, v25
    v_mul_f32 v189, v189, v25
    v_mul_f32 v190, v190, v25
    v_mul_f32 v191, v191, v25
    v_mul_f32 v192, v192, v25
    v_mul_f32 v193, v193, v25
    v_mul_f32 v194, v194, v25
    v_mul_f32 v195, v195, v25
    v_mul_f32 v196, v196, v25
    v_mul_f32 v197, v197, v25
    v_mul_f32 v198, v198, v25
    v_mul_f32 v199, v199, v25
    v_mul_f32 v200, v200, v25
    v_mul_f32 v201, v201, v25
    v_mul_f32 v202, v202, v25
    v_mul_f32 v203, v203, v25
    v_mul_f32 v204, v204, v25
    v_mul_f32 v205, v205, v25
    v_mul_f32 v206, v206, v25
    v_mul_f32 v207, v207, v25
    v_fma_f32 v104, v104, s28, v10
    v_fma_f32 v105, v105, s28, v10
    v_exp_f32 v104, v104
    v_exp_f32 v105, v105
    s_nop 0
    v_cvt_pk_bf16_f32 v20, v104, v105
    v_fma_f32 v106, v106, s28, v10
    v_fma_f32 v107, v107, s28, v10
    v_exp_f32 v106, v106
    v_exp_f32 v107, v107
    s_nop 0
    v_cvt_pk_bf16_f32 v21, v106, v107
    v_fma_f32 v108, v108, s28, v10
    v_fma_f32 v109, v109, s28, v10
    v_exp_f32 v108, v108
    v_exp_f32 v109, v109
    s_nop 0
    v_cvt_pk_bf16_f32 v22, v108, v109
    v_fma_f32 v110, v110, s28, v10
    v_fma_f32 v111, v111, s28, v10
    v_exp_f32 v110, v110
    v_exp_f32 v111, v111
    s_nop 0
    v_cvt_pk_bf16_f32 v23, v110, v111
    s_add_u32 s69, s39, 0
    buffer_load_dwordx4 v[44:47], v30, s[4:7], s69 offen offset:0
    s_waitcnt vmcnt(0)
    v_mfma_f32_16x16x32_bf16 v[104:107], v[44:47], a[144:147], 0
    s_nop 7
    buffer_load_dwordx4 v[44:47], v30, s[4:7], s69 offen offset:64
    s_waitcnt vmcnt(0)
    v_mfma_f32_16x16x32_bf16 v[104:107], v[44:47], a[148:151], v[104:107]
    s_nop 7
    buffer_load_dwordx4 v[44:47], v30, s[4:7], s69 offen offset:128
    s_waitcnt vmcnt(0)
    v_mfma_f32_16x16x32_bf16 v[104:107], v[44:47], a[152:155], v[104:107]
    s_nop 7
    buffer_load_dwordx4 v[44:47], v30, s[4:7], s69 offen offset:192
    s_waitcnt vmcnt(0)
    v_mfma_f32_16x16x32_bf16 v[104:107], v[44:47], a[156:159], v[104:107]
    s_nop 7
    buffer_load_dwordx4 v[44:47], v30, s[4:7], s69 offen offset:256
    s_waitcnt vmcnt(0)
    v_mfma_f32_16x16x32_bf16 v[104:107], v[44:47], a[160:163], v[104:107]
    s_nop 7
    buffer_load_dwordx4 v[44:47], v30, s[4:7], s69 offen offset:320
    s_waitcnt vmcnt(0)
    v_mfma_f32_16x16x32_bf16 v[104:107], v[44:47], a[164:167], v[104:107]
    s_nop 7
    s_add_u32 s69, s39, 6144
    buffer_load_dwordx4 v[44:47], v30, s[4:7], s69 offen offset:0
    s_waitcnt vmcnt(0)
    v_mfma_f32_16x16x32_bf16 v[108:111], v[44:47], a[144:147], 0
    s_nop 7
    buffer_load_dwordx4 v[44:47], v30, s[4:7], s69 offen offset:64
    s_waitcnt vmcnt(0)
    v_mfma_f32_16x16x32_bf16 v[108:111], v[44:47], a[148:151], v[108:111]
    s_nop 7
    buffer_load_dwordx4 v[44:47], v30, s[4:7], s69 offen offset:128
    s_waitcnt vmcnt(0)
    v_mfma_f32_16x16x32_bf16 v[108:111], v[44:47], a[152:155], v[108:111]
    s_nop 7
    buffer_load_dwordx4 v[44:47], v30, s[4:7], s69 offen offset:192
    s_waitcnt vmcnt(0)
    v_mfma_f32_16x16x32_bf16 v[108:111], v[44:47], a[156:159], v[108:111]
    s_nop 7
    buffer_load_dwordx4 v[44:47], v30, s[4:7], s69 offen offset:256
    s_waitcnt vmcnt(0)
    v_mfma_f32_16x16x32_bf16 v[108:111], v[44:47], a[160:163], v[108:111]
    s_nop 7
    buffer_load_dwordx4 v[44:47], v30, s[4:7], s69 offen offset:320
    s_waitcnt vmcnt(0)
    v_mfma_f32_16x16x32_bf16 v[108:111], v[44:47], a[164:167], v[108:111]
    s_nop 7
    s_nop 15
    v_max3_f32 v18, v104, v105, v106
    v_max3_f32 v18, v18, v107, v108
    v_max3_f32 v18, v18, v109, v110
    v_max_f32 v18, v18, v111
    v_mov_b32 v19, v18
    s_nop 1
    v_permlane32_swap_b32 v19, v18
    v_max_f32 v18, v18, v19
    v_mov_b32 v19, v18
    s_nop 1
    v_permlane16_swap_b32 v19, v18
    v_max_f32 v18, v18, v19
    v_fma_f32 v18, v18, s28, v11
    v_max_f32 v24, 0, v18
    v_sub_f32 v11, v11, v24
    v_sub_f32 v25, 0, v24
    v_exp_f32 v25, v25
    s_nop 0
    v_mul_f32 v50, v50, v25
    v_mul_f32 v208, v208, v25
    v_mul_f32 v209, v209, v25
    v_mul_f32 v210, v210, v25
    v_mul_f32 v211, v211, v25
    v_mul_f32 v212, v212, v25
    v_mul_f32 v213, v213, v25
    v_mul_f32 v214, v214, v25
    v_mul_f32 v215, v215, v25
    v_mul_f32 v216, v216, v25
    v_mul_f32 v217, v217, v25
    v_mul_f32 v218, v218, v25
    v_mul_f32 v219, v219, v25
    v_mul_f32 v220, v220, v25
    v_mul_f32 v221, v221, v25
    v_mul_f32 v222, v222, v25
    v_mul_f32 v223, v223, v25
    v_mul_f32 v224, v224, v25
    v_mul_f32 v225, v225, v25
    v_mul_f32 v226, v226, v25
    v_mul_f32 v227, v227, v25
    v_mul_f32 v228, v228, v25
    v_mul_f32 v229, v229, v25
    v_mul_f32 v230, v230, v25
    v_mul_f32 v231, v231, v25
    v_mul_f32 v232, v232, v25
    v_mul_f32 v233, v233, v25
    v_mul_f32 v234, v234, v25
    v_mul_f32 v235, v235, v25
    v_mul_f32 v236, v236, v25
    v_mul_f32 v237, v237, v25
    v_mul_f32 v238, v238, v25
    v_mul_f32 v239, v239, v25
    v_mul_f32 v240, v240, v25
    v_mul_f32 v241, v241, v25
    v_mul_f32 v242, v242, v25
    v_mul_f32 v243, v243, v25
    v_mul_f32 v244, v244, v25
    v_mul_f32 v245, v245, v25
    v_mul_f32 v246, v246, v25
    v_mul_f32 v247, v247, v25
    v_mul_f32 v248, v248, v25
    v_mul_f32 v249, v249, v25
    v_mul_f32 v250, v250, v25
    v_mul_f32 v251, v251, v25
    v_mul_f32 v252, v252, v25
    v_mul_f32 v253, v253, v25
    v_mul_f32 v254, v254, v25
    v_mul_f32 v255, v255, v25
    v_fma_f32 v104, v104, s28, v11
    v_fma_f32 v105, v105, s28, v11
    v_exp_f32 v104, v104
    v_exp_f32 v105, v105
    s_nop 0
    v_cvt_pk_bf16_f32 v26, v104, v105
    v_fma_f32 v106, v106, s28, v11
    v_fma_f32 v107, v107, s28, v11
    v_exp_f32 v106, v106
    v_exp_f32 v107, v107
    s_nop 0
    v_cvt_pk_bf16_f32 v27, v106, v107
    v_fma_f32 v108, v108, s28, v11
    v_fma_f32 v109, v109, s28, v11
    v_exp_f32 v108, v108
    v_exp_f32 v109, v109
    s_nop 0
    v_cvt_pk_bf16_f32 v28, v108, v109
    v_fma_f32 v110, v110, s28, v11
    v_fma_f32 v111, v111, s28, v11
    v_exp_f32 v110, v110
    v_exp_f32 v111, v111
    s_nop 0
    v_cvt_pk_bf16_f32 v29, v110, v111
    s_add_u32 s69, s39, 0
    buffer_load_dwordx4 v[44:47], v30, s[4:7], s69 offen offset:0
    s_waitcnt vmcnt(0)
    v_mfma_f32_16x16x32_bf16 v[104:107], v[44:47], a[168:171], 0
    s_nop 7
    buffer_load_dwordx4 v[44:47], v30, s[4:7], s69 offen offset:64
    s_waitcnt vmcnt(0)
    v_mfma_f32_16x16x32_bf16 v[104:107], v[44:47], a[172:175], v[104:107]
    s_nop 7
    buffer_load_dwordx4 v[44:47], v30, s[4:7], s69 offen offset:128
    s_waitcnt vmcnt(0)
    v_mfma_f32_16x16x32_bf16 v[104:107], v[44:47], a[176:179], v[104:107]
    s_nop 7
    buffer_load_dwordx4 v[44:47], v30, s[4:7], s69 offen offset:192
    s_waitcnt vmcnt(0)
    v_mfma_f32_16x16x32_bf16 v[104:107], v[44:47], a[180:183], v[104:107]
    s_nop 7
    buffer_load_dwordx4 v[44:47], v30, s[4:7], s69 offen offset:256
    s_waitcnt vmcnt(0)
    v_mfma_f32_16x16x32_bf16 v[104:107], v[44:47], a[184:187], v[104:107]
    s_nop 7
    buffer_load_dwordx4 v[44:47], v30, s[4:7], s69 offen offset:320
    s_waitcnt vmcnt(0)
    v_mfma_f32_16x16x32_bf16 v[104:107], v[44:47], a[188:191], v[104:107]
    s_nop 7
    s_add_u32 s69, s39, 6144
    buffer_load_dwordx4 v[44:47], v30, s[4:7], s69 offen offset:0
    s_waitcnt vmcnt(0)
    v_mfma_f32_16x16x32_bf16 v[108:111], v[44:47], a[168:171], 0
    s_nop 7
    buffer_load_dwordx4 v[44:47], v30, s[4:7], s69 offen offset:64
    s_waitcnt vmcnt(0)
    v_mfma_f32_16x16x32_bf16 v[108:111], v[44:47], a[172:175], v[108:111]
    s_nop 7
    buffer_load_dwordx4 v[44:47], v30, s[4:7], s69 offen offset:128
    s_waitcnt vmcnt(0)
    v_mfma_f32_16x16x32_bf16 v[108:111], v[44:47], a[176:179], v[108:111]
    s_nop 7
    buffer_load_dwordx4 v[44:47], v30, s[4:7], s69 offen offset:192
    s_waitcnt vmcnt(0)
    v_mfma_f32_16x16x32_bf16 v[108:111], v[44:47], a[180:183], v[108:111]
    s_nop 7
    buffer_load_dwordx4 v[44:47], v30, s[4:7], s69 offen offset:256
    s_waitcnt vmcnt(0)
    v_mfma_f32_16x16x32_bf16 v[108:111], v[44:47], a[184:187], v[108:111]
    s_nop 7
    buffer_load_dwordx4 v[44:47], v30, s[4:7], s69 offen offset:320
    s_waitcnt vmcnt(0)
    v_mfma_f32_16x16x32_bf16 v[108:111], v[44:47], a[188:191], v[108:111]
    s_nop 7
    s_nop 15
    v_max3_f32 v18, v104, v105, v106
    v_max3_f32 v18, v18, v107, v108
    v_max3_f32 v18, v18, v109, v110
    v_max_f32 v18, v18, v111
    v_mov_b32 v19, v18
    s_nop 1
    v_permlane32_swap_b32 v19, v18
    v_max_f32 v18, v18, v19
    v_mov_b32 v19, v18
    s_nop 1
    v_permlane16_swap_b32 v19, v18
    v_max_f32 v18, v18, v19
    v_fma_f32 v18, v18, s28, v12
    v_max_f32 v24, 0, v18
    v_sub_f32 v12, v12, v24
    v_sub_f32 v25, 0, v24
    v_exp_f32 v25, v25
    s_nop 0
    v_mul_f32 v51, v51, v25
    v_accvgpr_read_b32 v19, a0
    v_mul_f32 v19, v19, v25
    v_accvgpr_write_b32 a0, v19
    v_accvgpr_read_b32 v19, a1
    v_mul_f32 v19, v19, v25
    v_accvgpr_write_b32 a1, v19
    v_accvgpr_read_b32 v19, a2
    v_mul_f32 v19, v19, v25
    v_accvgpr_write_b32 a2, v19
    v_accvgpr_read_b32 v19, a3
    v_mul_f32 v19, v19, v25
    v_accvgpr_write_b32 a3, v19
    v_accvgpr_read_b32 v19, a4
    v_mul_f32 v19, v19, v25
    v_accvgpr_write_b32 a4, v19
    v_accvgpr_read_b32 v19, a5
    v_mul_f32 v19, v19, v25
    v_accvgpr_write_b32 a5, v19
    v_accvgpr_read_b32 v19, a6
    v_mul_f32 v19, v19, v25
    v_accvgpr_write_b32 a6, v19
    v_accvgpr_read_b32 v19, a7
    v_mul_f32 v19, v19, v25
    v_accvgpr_write_b32 a7, v19
    v_accvgpr_read_b32 v19, a8
    v_mul_f32 v19, v19, v25
    v_accvgpr_write_b32 a8, v19
    v_accvgpr_read_b32 v19, a9
    v_mul_f32 v19, v19, v25
    v_accvgpr_write_b32 a9, v19
    v_accvgpr_read_b32 v19, a10
    v_mul_f32 v19, v19, v25
    v_accvgpr_write_b32 a10, v19
    v_accvgpr_read_b32 v19, a11
    v_mul_f32 v19, v19, v25
    v_accvgpr_write_b32 a11, v19
    v_accvgpr_read_b32 v19, a12
    v_mul_f32 v19, v19, v25
    v_accvgpr_write_b32 a12, v19
    v_accvgpr_read_b32 v19, a13
    v_mul_f32 v19, v19, v25
    v_accvgpr_write_b32 a13, v19
    v_accvgpr_read_b32 v19, a14
    v_mul_f32 v19, v19, v25
    v_accvgpr_write_b32 a14, v19
    v_accvgpr_read_b32 v19, a15
    v_mul_f32 v19, v19, v25
    v_accvgpr_write_b32 a15, v19
    v_accvgpr_read_b32 v19, a16
    v_mul_f32 v19, v19, v25
    v_accvgpr_write_b32 a16, v19
    v_accvgpr_read_b32 v19, a17
    v_mul_f32 v19, v19, v25
    v_accvgpr_write_b32 a17, v19
    v_accvgpr_read_b32 v19, a18
    v_mul_f32 v19, v19, v25
    v_accvgpr_write_b32 a18, v19
    v_accvgpr_read_b32 v19, a19
    v_mul_f32 v19, v19, v25
    v_accvgpr_write_b32 a19, v19
    v_accvgpr_read_b32 v19, a20
    v_mul_f32 v19, v19, v25
    v_accvgpr_write_b32 a20, v19
    v_accvgpr_read_b32 v19, a21
    v_mul_f32 v19, v19, v25
    v_accvgpr_write_b32 a21, v19
    v_accvgpr_read_b32 v19, a22
    v_mul_f32 v19, v19, v25
    v_accvgpr_write_b32 a22, v19
    v_accvgpr_read_b32 v19, a23
    v_mul_f32 v19, v19, v25
    v_accvgpr_write_b32 a23, v19
    v_accvgpr_read_b32 v19, a24
    v_mul_f32 v19, v19, v25
    v_accvgpr_write_b32 a24, v19
    v_accvgpr_read_b32 v19, a25
    v_mul_f32 v19, v19, v25
    v_accvgpr_write_b32 a25, v19
    v_accvgpr_read_b32 v19, a26
    v_mul_f32 v19, v19, v25
    v_accvgpr_write_b32 a26, v19
    v_accvgpr_read_b32 v19, a27
    v_mul_f32 v19, v19, v25
    v_accvgpr_write_b32 a27, v19
    v_accvgpr_read_b32 v19, a28
    v_mul_f32 v19, v19, v25
    v_accvgpr_write_b32 a28, v19
    v_accvgpr_read_b32 v19, a29
    v_mul_f32 v19, v19, v25
    v_accvgpr_write_b32 a29, v19
    v_accvgpr_read_b32 v19, a30
    v_mul_f32 v19, v19, v25
    v_accvgpr_write_b32 a30, v19
    v_accvgpr_read_b32 v19, a31
    v_mul_f32 v19, v19, v25
    v_accvgpr_write_b32 a31, v19
    v_accvgpr_read_b32 v19, a32
    v_mul_f32 v19, v19, v25
    v_accvgpr_write_b32 a32, v19
    v_accvgpr_read_b32 v19, a33
    v_mul_f32 v19, v19, v25
    v_accvgpr_write_b32 a33, v19
    v_accvgpr_read_b32 v19, a34
    v_mul_f32 v19, v19, v25
    v_accvgpr_write_b32 a34, v19
    v_accvgpr_read_b32 v19, a35
    v_mul_f32 v19, v19, v25
    v_accvgpr_write_b32 a35, v19
    v_accvgpr_read_b32 v19, a36
    v_mul_f32 v19, v19, v25
    v_accvgpr_write_b32 a36, v19
    v_accvgpr_read_b32 v19, a37
    v_mul_f32 v19, v19, v25
    v_accvgpr_write_b32 a37, v19
    v_accvgpr_read_b32 v19, a38
    v_mul_f32 v19, v19, v25
    v_accvgpr_write_b32 a38, v19
    v_accvgpr_read_b32 v19, a39
    v_mul_f32 v19, v19, v25
    v_accvgpr_write_b32 a39, v19
    v_accvgpr_read_b32 v19, a40
    v_mul_f32 v19, v19, v25
    v_accvgpr_write_b32 a40, v19
    v_accvgpr_read_b32 v19, a41
    v_mul_f32 v19, v19, v25
    v_accvgpr_write_b32 a41, v19
    v_accvgpr_read_b32 v19, a42
    v_mul_f32 v19, v19, v25
    v_accvgpr_write_b32 a42, v19
    v_accvgpr_read_b32 v19, a43
    v_mul_f32 v19, v19, v25
    v_accvgpr_write_b32 a43, v19
    v_accvgpr_read_b32 v19, a44
    v_mul_f32 v19, v19, v25
    v_accvgpr_write_b32 a44, v19
    v_accvgpr_read_b32 v19, a45
    v_mul_f32 v19, v19, v25
    v_accvgpr_write_b32 a45, v19
    v_accvgpr_read_b32 v19, a46
    v_mul_f32 v19, v19, v25
    v_accvgpr_write_b32 a46, v19
    v_accvgpr_read_b32 v19, a47
    v_mul_f32 v19, v19, v25
    v_accvgpr_write_b32 a47, v19
    v_fma_f32 v104, v104, s28, v12
    v_fma_f32 v105, v105, s28, v12
    v_exp_f32 v104, v104
    v_exp_f32 v105, v105
    s_nop 0
    v_cvt_pk_bf16_f32 v32, v104, v105
    v_fma_f32 v106, v106, s28, v12
    v_fma_f32 v107, v107, s28, v12
    v_exp_f32 v106, v106
    v_exp_f32 v107, v107
    s_nop 0
    v_cvt_pk_bf16_f32 v33, v106, v107
    v_fma_f32 v108, v108, s28, v12
    v_fma_f32 v109, v109, s28, v12
    v_exp_f32 v108, v108
    v_exp_f32 v109, v109
    s_nop 0
    v_cvt_pk_bf16_f32 v34, v108, v109
    v_fma_f32 v110, v110, s28, v12
    v_fma_f32 v111, v111, s28, v12
    v_exp_f32 v110, v110
    v_exp_f32 v111, v111
    s_nop 0
    v_cvt_pk_bf16_f32 v35, v110, v111
    s_add_u32 s69, s39, 0
    buffer_load_dwordx4 v[44:47], v30, s[4:7], s69 offen offset:0
    s_waitcnt vmcnt(0)
    v_mfma_f32_16x16x32_bf16 v[104:107], v[44:47], a[192:195], 0
    s_nop 7
    buffer_load_dwordx4 v[44:47], v30, s[4:7], s69 offen offset:64
    s_waitcnt vmcnt(0)
    v_mfma_f32_16x16x32_bf16 v[104:107], v[44:47], a[196:199], v[104:107]
    s_nop 7
    buffer_load_dwordx4 v[44:47], v30, s[4:7], s69 offen offset:128
    s_waitcnt vmcnt(0)
    v_mfma_f32_16x16x32_bf16 v[104:107], v[44:47], a[200:203], v[104:107]
    s_nop 7
    buffer_load_dwordx4 v[44:47], v30, s[4:7], s69 offen offset:192
    s_waitcnt vmcnt(0)
    v_mfma_f32_16x16x32_bf16 v[104:107], v[44:47], a[204:207], v[104:107]
    s_nop 7
    buffer_load_dwordx4 v[44:47], v30, s[4:7], s69 offen offset:256
    s_waitcnt vmcnt(0)
    v_mfma_f32_16x16x32_bf16 v[104:107], v[44:47], a[208:211], v[104:107]
    s_nop 7
    buffer_load_dwordx4 v[44:47], v30, s[4:7], s69 offen offset:320
    s_waitcnt vmcnt(0)
    v_mfma_f32_16x16x32_bf16 v[104:107], v[44:47], v[92:95], v[104:107]
    s_nop 7
    s_add_u32 s69, s39, 6144
    buffer_load_dwordx4 v[44:47], v30, s[4:7], s69 offen offset:0
    s_waitcnt vmcnt(0)
    v_mfma_f32_16x16x32_bf16 v[108:111], v[44:47], a[192:195], 0
    s_nop 7
    buffer_load_dwordx4 v[44:47], v30, s[4:7], s69 offen offset:64
    s_waitcnt vmcnt(0)
    v_mfma_f32_16x16x32_bf16 v[108:111], v[44:47], a[196:199], v[108:111]
    s_nop 7
    buffer_load_dwordx4 v[44:47], v30, s[4:7], s69 offen offset:128
    s_waitcnt vmcnt(0)
    v_mfma_f32_16x16x32_bf16 v[108:111], v[44:47], a[200:203], v[108:111]
    s_nop 7
    buffer_load_dwordx4 v[44:47], v30, s[4:7], s69 offen offset:192
    s_waitcnt vmcnt(0)
    v_mfma_f32_16x16x32_bf16 v[108:111], v[44:47], a[204:207], v[108:111]
    s_nop 7
    buffer_load_dwordx4 v[44:47], v30, s[4:7], s69 offen offset:256
    s_waitcnt vmcnt(0)
    v_mfma_f32_16x16x32_bf16 v[108:111], v[44:47], a[208:211], v[108:111]
    s_nop 7
    buffer_load_dwordx4 v[44:47], v30, s[4:7], s69 offen offset:320
    s_waitcnt vmcnt(0)
    v_mfma_f32_16x16x32_bf16 v[108:111], v[44:47], v[92:95], v[108:111]
    s_nop 7
    s_nop 15
    v_max3_f32 v18, v104, v105, v106
    v_max3_f32 v18, v18, v107, v108
    v_max3_f32 v18, v18, v109, v110
    v_max_f32 v18, v18, v111
    v_mov_b32 v19, v18
    s_nop 1
    v_permlane32_swap_b32 v19, v18
    v_max_f32 v18, v18, v19
    v_mov_b32 v19, v18
    s_nop 1
    v_permlane16_swap_b32 v19, v18
    v_max_f32 v18, v18, v19
    v_fma_f32 v18, v18, s28, v13
    v_max_f32 v24, 0, v18
    v_sub_f32 v13, v13, v24
    v_sub_f32 v25, 0, v24
    v_exp_f32 v25, v25
    s_nop 0
    v_mul_f32 v19, v48, v25
    v_cndmask_b32_e64 v48, v48, v19, s[60:61]
    v_accvgpr_read_b32 v19, a48
    v_mul_f32 v19, v19, v25
    v_accvgpr_write_b32 a48, v19
    v_accvgpr_read_b32 v19, a49
    v_mul_f32 v19, v19, v25
    v_accvgpr_write_b32 a49, v19
    v_accvgpr_read_b32 v19, a50
    v_mul_f32 v19, v19, v25
    v_accvgpr_write_b32 a50, v19
    v_accvgpr_read_b32 v19, a51
    v_mul_f32 v19, v19, v25
    v_accvgpr_write_b32 a51, v19
    v_accvgpr_read_b32 v19, a52
    v_mul_f32 v19, v19, v25
    v_accvgpr_write_b32 a52, v19
    v_accvgpr_read_b32 v19, a53
    v_mul_f32 v19, v19, v25
    v_accvgpr_write_b32 a53, v19
    v_accvgpr_read_b32 v19, a54
    v_mul_f32 v19, v19, v25
    v_accvgpr_write_b32 a54, v19
    v_accvgpr_read_b32 v19, a55
    v_mul_f32 v19, v19, v25
    v_accvgpr_write_b32 a55, v19
    v_accvgpr_read_b32 v19, a56
    v_mul_f32 v19, v19, v25
    v_accvgpr_write_b32 a56, v19
    v_accvgpr_read_b32 v19, a57
    v_mul_f32 v19, v19, v25
    v_accvgpr_write_b32 a57, v19
    v_accvgpr_read_b32 v19, a58
    v_mul_f32 v19, v19, v25
    v_accvgpr_write_b32 a58, v19
    v_accvgpr_read_b32 v19, a59
    v_mul_f32 v19, v19, v25
    v_accvgpr_write_b32 a59, v19
    v_accvgpr_read_b32 v19, a60
    v_mul_f32 v19, v19, v25
    v_accvgpr_write_b32 a60, v19
    v_accvgpr_read_b32 v19, a61
    v_mul_f32 v19, v19, v25
    v_accvgpr_write_b32 a61, v19
    v_accvgpr_read_b32 v19, a62
    v_mul_f32 v19, v19, v25
    v_accvgpr_write_b32 a62, v19
    v_accvgpr_read_b32 v19, a63
    v_mul_f32 v19, v19, v25
    v_accvgpr_write_b32 a63, v19
    v_accvgpr_read_b32 v19, a64
    v_mul_f32 v19, v19, v25
    v_accvgpr_write_b32 a64, v19
    v_accvgpr_read_b32 v19, a65
    v_mul_f32 v19, v19, v25
    v_accvgpr_write_b32 a65, v19
    v_accvgpr_read_b32 v19, a66
    v_mul_f32 v19, v19, v25
    v_accvgpr_write_b32 a66, v19
    v_accvgpr_read_b32 v19, a67
    v_mul_f32 v19, v19, v25
    v_accvgpr_write_b32 a67, v19
    v_accvgpr_read_b32 v19, a68
    v_mul_f32 v19, v19, v25
    v_accvgpr_write_b32 a68, v19
    v_accvgpr_read_b32 v19, a69
    v_mul_f32 v19, v19, v25
    v_accvgpr_write_b32 a69, v19
    v_accvgpr_read_b32 v19, a70
    v_mul_f32 v19, v19, v25
    v_accvgpr_write_b32 a70, v19
    v_accvgpr_read_b32 v19, a71
    v_mul_f32 v19, v19, v25
    v_accvgpr_write_b32 a71, v19
    v_accvgpr_read_b32 v19, a72
    v_mul_f32 v19, v19, v25
    v_accvgpr_write_b32 a72, v19
    v_accvgpr_read_b32 v19, a73
    v_mul_f32 v19, v19, v25
    v_accvgpr_write_b32 a73, v19
    v_accvgpr_read_b32 v19, a74
    v_mul_f32 v19, v19, v25
    v_accvgpr_write_b32 a74, v19
    v_accvgpr_read_b32 v19, a75
    v_mul_f32 v19, v19, v25
    v_accvgpr_write_b32 a75, v19
    v_accvgpr_read_b32 v19, a76
    v_mul_f32 v19, v19, v25
    v_accvgpr_write_b32 a76, v19
    v_accvgpr_read_b32 v19, a77
    v_mul_f32 v19, v19, v25
    v_accvgpr_write_b32 a77, v19
    v_accvgpr_read_b32 v19, a78
    v_mul_f32 v19, v19, v25
    v_accvgpr_write_b32 a78, v19
    v_accvgpr_read_b32 v19, a79
    v_mul_f32 v19, v19, v25
    v_accvgpr_write_b32 a79, v19
    v_accvgpr_read_b32 v19, a80
    v_mul_f32 v19, v19, v25
    v_accvgpr_write_b32 a80, v19
    v_accvgpr_read_b32 v19, a81
    v_mul_f32 v19, v19, v25
    v_accvgpr_write_b32 a81, v19
    v_accvgpr_read_b32 v19, a82
    v_mul_f32 v19, v19, v25
    v_accvgpr_write_b32 a82, v19
    v_accvgpr_read_b32 v19, a83
    v_mul_f32 v19, v19, v25
    v_accvgpr_write_b32 a83, v19
    v_accvgpr_read_b32 v19, a84
    v_mul_f32 v19, v19, v25
    v_accvgpr_write_b32 a84, v19
    v_accvgpr_read_b32 v19, a85
    v_mul_f32 v19, v19, v25
    v_accvgpr_write_b32 a85, v19
    v_accvgpr_read_b32 v19, a86
    v_mul_f32 v19, v19, v25
    v_accvgpr_write_b32 a86, v19
    v_accvgpr_read_b32 v19, a87
    v_mul_f32 v19, v19, v25
    v_accvgpr_write_b32 a87, v19
    v_accvgpr_read_b32 v19, a88
    v_mul_f32 v19, v19, v25
    v_accvgpr_write_b32 a88, v19
    v_accvgpr_read_b32 v19, a89
    v_mul_f32 v19, v19, v25
    v_accvgpr_write_b32 a89, v19
    v_accvgpr_read_b32 v19, a90
    v_mul_f32 v19, v19, v25
    v_accvgpr_write_b32 a90, v19
    v_accvgpr_read_b32 v19, a91
    v_mul_f32 v19, v19, v25
    v_accvgpr_write_b32 a91, v19
    v_accvgpr_read_b32 v19, a92
    v_mul_f32 v19, v19, v25
    v_accvgpr_write_b32 a92, v19
    v_accvgpr_read_b32 v19, a93
    v_mul_f32 v19, v19, v25
    v_accvgpr_write_b32 a93, v19
    v_accvgpr_read_b32 v19, a94
    v_mul_f32 v19, v19, v25
    v_accvgpr_write_b32 a94, v19
    v_accvgpr_read_b32 v19, a95
    v_mul_f32 v19, v19, v25
    v_accvgpr_write_b32 a95, v19
    v_fma_f32 v104, v104, s28, v13
    v_fma_f32 v105, v105, s28, v13
    v_exp_f32 v104, v104
    v_exp_f32 v105, v105
    s_nop 0
    v_cvt_pk_bf16_f32 v38, v104, v105
    v_fma_f32 v106, v106, s28, v13
    v_fma_f32 v107, v107, s28, v13
    v_exp_f32 v106, v106
    v_exp_f32 v107, v107
    s_nop 0
    v_cvt_pk_bf16_f32 v39, v106, v107
    v_fma_f32 v108, v108, s28, v13
    v_fma_f32 v109, v109, s28, v13
    v_exp_f32 v108, v108
    v_exp_f32 v109, v109
    s_nop 0
    v_cvt_pk_bf16_f32 v40, v108, v109
    v_fma_f32 v110, v110, s28, v13
    v_fma_f32 v111, v111, s28, v13
    v_exp_f32 v110, v110
    v_exp_f32 v111, v111
    s_nop 0
    v_cvt_pk_bf16_f32 v41, v110, v111
    v_mfma_f32_16x16x32_bf16 v[44:47], a[236:239], v[14:17], v[48:51]
    v_mfma_f32_16x16x32_bf16 v[44:47], a[240:243], v[20:23], v[44:47]
    v_mfma_f32_16x16x32_bf16 v[44:47], a[244:247], v[26:29], v[44:47]
    v_mfma_f32_16x16x32_bf16 v[44:47], a[248:251], v[32:35], v[44:47]
    v_mfma_f32_16x16x32_bf16 v[44:47], a[252:255], v[38:41], v[44:47]
    s_nop 15
    s_setpc_b64 s[40:41]
L_rare5_1:
    s_nop 15
    v_mbcnt_lo_u32_b32 v27, -1, 0
    v_mbcnt_hi_u32_b32 v27, -1, v27
    v_and_b32 v26, 15, v27
    v_mul_u32_u24 v26, 384, v26
    v_lshrrev_b32 v27, 4, v27
    v_lshl_add_u32 v26, v27, 4, v26
    s_add_u32 s69, s39, 0
    buffer_load_dwordx4 v[48:51], v26, s[4:7], s69 offen offset:0
    s_waitcnt vmcnt(0)
    v_mfma_f32_16x16x32_bf16 v[104:107], v[48:51], a[96:99], 0
    s_nop 7
    buffer_load_dwordx4 v[48:51], v26, s[4:7], s69 offen offset:64
    s_waitcnt vmcnt(0)
    v_mfma_f32_16x16x32_bf16 v[104:107], v[48:51], a[100:103], v[104:107]
    s_nop 7
    buffer_load_dwordx4 v[48:51], v26, s[4:7], s69 offen offset:128
    s_waitcnt vmcnt(0)
    v_mfma_f32_16x16x32_bf16 v[104:107], v[48:51], a[104:107], v[104:107]
    s_nop 7
    buffer_load_dwordx4 v[48:51], v26, s[4:7], s69 offen offset:192
    s_waitcnt vmcnt(0)
    v_mfma_f32_16x16x32_bf16 v[104:107], v[48:51], a[108:111], v[104:107]
    s_nop 7
    buffer_load_dwordx4 v[48:51], v26, s[4:7], s69 offen offset:256
    s_waitcnt vmcnt(0)
    v_mfma_f32_16x16x32_bf16 v[104:107], v[48:51], a[112:115], v[104:107]
    s_nop 7
    buffer_load_dwordx4 v[48:51], v26, s[4:7], s69 offen offset:320
    s_waitcnt vmcnt(0)
    v_mfma_f32_16x16x32_bf16 v[104:107], v[48:51], a[116:119], v[104:107]
    s_nop 7
    s_add_u32 s69, s39, 6144
    buffer_load_dwordx4 v[48:51], v26, s[4:7], s69 offen offset:0
    s_waitcnt vmcnt(0)
    v_mfma_f32_16x16x32_bf16 v[108:111], v[48:51], a[96:99], 0
    s_nop 7
    buffer_load_dwordx4 v[48:51], v26, s[4:7], s69 offen offset:64
    s_waitcnt vmcnt(0)
    v_mfma_f32_16x16x32_bf16 v[108:111], v[48:51], a[100:103], v[108:111]
    s_nop 7
    buffer_load_dwordx4 v[48:51], v26, s[4:7], s69 offen offset:128
    s_waitcnt vmcnt(0)
    v_mfma_f32_16x16x32_bf16 v[108:111], v[48:51], a[104:107], v[108:111]
    s_nop 7
    buffer_load_dwordx4 v[48:51], v26, s[4:7], s69 offen offset:192
    s_waitcnt vmcnt(0)
    v_mfma_f32_16x16x32_bf16 v[108:111], v[48:51], a[108:111], v[108:111]
    s_nop 7
    buffer_load_dwordx4 v[48:51], v26, s[4:7], s69 offen offset:256
    s_waitcnt vmcnt(0)
    v_mfma_f32_16x16x32_bf16 v[108:111], v[48:51], a[112:115], v[108:111]
    s_nop 7
    buffer_load_dwordx4 v[48:51], v26, s[4:7], s69 offen offset:320
    s_waitcnt vmcnt(0)
    v_mfma_f32_16x16x32_bf16 v[108:111], v[48:51], a[116:119], v[108:111]
    s_nop 7
    s_nop 15
    v_max3_f32 v14, v104, v105, v106
    v_max3_f32 v14, v14, v107, v108
    v_max3_f32 v14, v14, v109, v110
    v_max_f32 v14, v14, v111
    v_mov_b32 v15, v14
    s_nop 1
    v_permlane32_swap_b32 v15, v14
    v_max_f32 v14, v14, v15
    v_mov_b32 v15, v14
    s_nop 1
    v_permlane16_swap_b32 v15, v14
    v_max_f32 v14, v14, v15
    v_fma_f32 v14, v14, s28, v9
    v_max_f32 v20, 0, v14
    v_sub_f32 v9, v9, v20
    v_sub_f32 v21, 0, v20
    v_exp_f32 v21, v21
    s_nop 0
    v_mul_f32 v15, v44, v21
    v_cndmask_b32_e64 v44, v15, v44, s[60:61]
    v_cndmask_b32_e64 v44, v44, 0, s[46:47]
    v_mul_f32 v112, v112, v21
    v_mul_f32 v113, v113, v21
    v_mul_f32 v114, v114, v21
    v_mul_f32 v115, v115, v21
    v_mul_f32 v116, v116, v21
    v_mul_f32 v117, v117, v21
    v_mul_f32 v118, v118, v21
    v_mul_f32 v119, v119, v21
    v_mul_f32 v120, v120, v21
    v_mul_f32 v121, v121, v21
    v_mul_f32 v122, v122, v21
    v_mul_f32 v123, v123, v21
    v_mul_f32 v124, v124, v21
    v_mul_f32 v125, v125, v21
    v_mul_f32 v126, v126, v21
    v_mul_f32 v127, v127, v21
    v_mul_f32 v128, v128, v21
    v_mul_f32 v129, v129, v21
    v_mul_f32 v130, v130, v21
    v_mul_f32 v131, v131, v21
    v_mul_f32 v132, v132, v21
    v_mul_f32 v133, v133, v21
    v_mul_f32 v134, v134, v21
    v_mul_f32 v135, v135, v21
    v_mul_f32 v136, v136, v21
    v_mul_f32 v137, v137, v21
    v_mul_f32 v138, v138, v21
    v_mul_f32 v139, v139, v21
    v_mul_f32 v140, v140, v21
    v_mul_f32 v141, v141, v21
    v_mul_f32 v142, v142, v21
    v_mul_f32 v143, v143, v21
    v_mul_f32 v144, v144, v21
    v_mul_f32 v145, v145, v21
    v_mul_f32 v146, v146, v21
    v_mul_f32 v147, v147, v21
    v_mul_f32 v148, v148, v21
    v_mul_f32 v149, v149, v21
    v_mul_f32 v150, v150, v21
    v_mul_f32 v151, v151, v21
    v_mul_f32 v152, v152, v21
    v_mul_f32 v153, v153, v21
    v_mul_f32 v154, v154, v21
    v_mul_f32 v155, v155, v21
    v_mul_f32 v156, v156, v21
    v_mul_f32 v157, v157, v21
    v_mul_f32 v158, v158, v21
    v_mul_f32 v159, v159, v21
    v_fma_f32 v104, v104, s28, v9
    v_fma_f32 v105, v105, s28, v9
    v_exp_f32 v104, v104
    v_exp_f32 v105, v105
    s_nop 0
    v_cvt_pk_bf16_f32 v18, v104, v105
    v_fma_f32 v106, v106, s28, v9
    v_fma_f32 v107, v107, s28, v9
    v_exp_f32 v106, v106
    v_exp_f32 v107, v107
    s_nop 0
    v_cvt_pk_bf16_f32 v19, v106, v107
    v_fma_f32 v108, v108, s28, v9
    v_fma_f32 v109, v109, s28, v9
    v_exp_f32 v108, v108
    v_exp_f32 v109, v109
    s_nop 0
    v_cvt_pk_bf16_f32 v16, v108, v109
    v_fma_f32 v110, v110, s28, v9
    v_fma_f32 v111, v111, s28, v9
    v_exp_f32 v110, v110
    v_exp_f32 v111, v111
    s_nop 0
    v_cvt_pk_bf16_f32 v17, v110, v111
    s_add_u32 s69, s39, 0
    buffer_load_dwordx4 v[48:51], v26, s[4:7], s69 offen offset:0
    s_waitcnt vmcnt(0)
    v_mfma_f32_16x16x32_bf16 v[104:107], v[48:51], a[120:123], 0
    s_nop 7
    buffer_load_dwordx4 v[48:51], v26, s[4:7], s69 offen offset:64
    s_waitcnt vmcnt(0)
    v_mfma_f32_16x16x32_bf16 v[104:107], v[48:51], a[124:127], v[104:107]
    s_nop 7
    buffer_load_dwordx4 v[48:51], v26, s[4:7], s69 offen offset:128
    s_waitcnt vmcnt(0)
    v_mfma_f32_16x16x32_bf16 v[104:107], v[48:51], a[128:131], v[104:107]
    s_nop 7
    buffer_load_dwordx4 v[48:51], v26, s[4:7], s69 offen offset:192
    s_waitcnt vmcnt(0)
    v_mfma_f32_16x16x32_bf16 v[104:107], v[48:51], a[132:135], v[104:107]
    s_nop 7
    buffer_load_dwordx4 v[48:51], v26, s[4:7], s69 offen offset:256
    s_waitcnt vmcnt(0)
    v_mfma_f32_16x16x32_bf16 v[104:107], v[48:51], a[136:139], v[104:107]
    s_nop 7
    buffer_load_dwordx4 v[48:51], v26, s[4:7], s69 offen offset:320
    s_waitcnt vmcnt(0)
    v_mfma_f32_16x16x32_bf16 v[104:107], v[48:51], a[140:143], v[104:107]
    s_nop 7
    s_add_u32 s69, s39, 6144
    buffer_load_dwordx4 v[48:51], v26, s[4:7], s69 offen offset:0
    s_waitcnt vmcnt(0)
    v_mfma_f32_16x16x32_bf16 v[108:111], v[48:51], a[120:123], 0
    s_nop 7
    buffer_load_dwordx4 v[48:51], v26, s[4:7], s69 offen offset:64
    s_waitcnt vmcnt(0)
    v_mfma_f32_16x16x32_bf16 v[108:111], v[48:51], a[124:127], v[108:111]
    s_nop 7
    buffer_load_dwordx4 v[48:51], v26, s[4:7], s69 offen offset:128
    s_waitcnt vmcnt(0)
    v_mfma_f32_16x16x32_bf16 v[108:111], v[48:51], a[128:131], v[108:111]
    s_nop 7
    buffer_load_dwordx4 v[48:51], v26, s[4:7], s69 offen offset:192
    s_waitcnt vmcnt(0)
    v_mfma_f32_16x16x32_bf16 v[108:111], v[48:51], a[132:135], v[108:111]
    s_nop 7
    buffer_load_dwordx4 v[48:51], v26, s[4:7], s69 offen offset:256
    s_waitcnt vmcnt(0)
    v_mfma_f32_16x16x32_bf16 v[108:111], v[48:51], a[136:139], v[108:111]
    s_nop 7
    buffer_load_dwordx4 v[48:51], v26, s[4:7], s69 offen offset:320
    s_waitcnt vmcnt(0)
    v_mfma_f32_16x16x32_bf16 v[108:111], v[48:51], a[140:143], v[108:111]
    s_nop 7
    s_nop 15
    v_max3_f32 v14, v104, v105, v106
    v_max3_f32 v14, v14, v107, v108
    v_max3_f32 v14, v14, v109, v110
    v_max_f32 v14, v14, v111
    v_mov_b32 v15, v14
    s_nop 1
    v_permlane32_swap_b32 v15, v14
    v_max_f32 v14, v14, v15
    v_mov_b32 v15, v14
    s_nop 1
    v_permlane16_swap_b32 v15, v14
    v_max_f32 v14, v14, v15
    v_fma_f32 v14, v14, s28, v10
    v_max_f32 v20, 0, v14
    v_sub_f32 v10, v10, v20
    v_sub_f32 v21, 0, v20
    v_exp_f32 v21, v21
    s_nop 0
    v_mul_f32 v45, v45, v21
    v_mul_f32 v160, v160, v21
    v_mul_f32 v161, v161, v21
    v_mul_f32 v162, v162, v21
    v_mul_f32 v163, v163, v21
    v_mul_f32 v164, v164, v21
    v_mul_f32 v165, v165, v21
    v_mul_f32 v166, v166, v21
    v_mul_f32 v167, v167, v21
    v_mul_f32 v168, v168, v21
    v_mul_f32 v169, v169, v21
    v_mul_f32 v170, v170, v21
    v_mul_f32 v171, v171, v21
    v_mul_f32 v172, v172, v21
    v_mul_f32 v173, v173, v21
    v_mul_f32 v174, v174, v21
    v_mul_f32 v175, v175, v21
    v_mul_f32 v176, v176, v21
    v_mul_f32 v177, v177, v21
    v_mul_f32 v178, v178, v21
    v_mul_f32 v179, v179, v21
    v_mul_f32 v180, v180, v21
    v_mul_f32 v181, v181, v21
    v_mul_f32 v182, v182, v21
    v_mul_f32 v183, v183, v21
    v_mul_f32 v184, v184, v21
    v_mul_f32 v185, v185, v21
    v_mul_f32 v186, v186, v21
    v_mul_f32 v187, v187, v21
    v_mul_f32 v188, v188, v21
    v_mul_f32 v189, v189, v21
    v_mul_f32 v190, v190, v21
    v_mul_f32 v191, v191, v21
    v_mul_f32 v192, v192, v21
    v_mul_f32 v193, v193, v21
    v_mul_f32 v194, v194, v21
    v_mul_f32 v195, v195, v21
    v_mul_f32 v196, v196, v21
    v_mul_f32 v197, v197, v21
    v_mul_f32 v198, v198, v21
    v_mul_f32 v199, v199, v21
    v_mul_f32 v200, v200, v21
    v_mul_f32 v201, v201, v21
    v_mul_f32 v202, v202, v21
    v_mul_f32 v203, v203, v21
    v_mul_f32 v204, v204, v21
    v_mul_f32 v205, v205, v21
    v_mul_f32 v206, v206, v21
    v_mul_f32 v207, v207, v21
    v_fma_f32 v104, v104, s28, v10
    v_fma_f32 v105, v105, s28, v10
    v_exp_f32 v104, v104
    v_exp_f32 v105, v105
    s_nop 0
    v_cvt_pk_bf16_f32 v24, v104, v105
    v_fma_f32 v106, v106, s28, v10
    v_fma_f32 v107, v107, s28, v10
    v_exp_f32 v106, v106
    v_exp_f32 v107, v107
    s_nop 0
    v_cvt_pk_bf16_f32 v25, v106, v107
    v_fma_f32 v108, v108, s28, v10
    v_fma_f32 v109, v109, s28, v10
    v_exp_f32 v108, v108
    v_exp_f32 v109, v109
    s_nop 0
    v_cvt_pk_bf16_f32 v22, v108, v109
    v_fma_f32 v110, v110, s28, v10
    v_fma_f32 v111, v111, s28, v10
    v_exp_f32 v110, v110
    v_exp_f32 v111, v111
    s_nop 0
    v_cvt_pk_bf16_f32 v23, v110, v111
    s_add_u32 s69, s39, 0
    buffer_load_dwordx4 v[48:51], v26, s[4:7], s69 offen offset:0
    s_waitcnt vmcnt(0)
    v_mfma_f32_16x16x32_bf16 v[104:107], v[48:51], a[144:147], 0
    s_nop 7
    buffer_load_dwordx4 v[48:51], v26, s[4:7], s69 offen offset:64
    s_waitcnt vmcnt(0)
    v_mfma_f32_16x16x32_bf16 v[104:107], v[48:51], a[148:151], v[104:107]
    s_nop 7
    buffer_load_dwordx4 v[48:51], v26, s[4:7], s69 offen offset:128
    s_waitcnt vmcnt(0)
    v_mfma_f32_16x16x32_bf16 v[104:107], v[48:51], a[152:155], v[104:107]
    s_nop 7
    buffer_load_dwordx4 v[48:51], v26, s[4:7], s69 offen offset:192
    s_waitcnt vmcnt(0)
    v_mfma_f32_16x16x32_bf16 v[104:107], v[48:51], a[156:159], v[104:107]
    s_nop 7
    buffer_load_dwordx4 v[48:51], v26, s[4:7], s69 offen offset:256
    s_waitcnt vmcnt(0)
    v_mfma_f32_16x16x32_bf16 v[104:107], v[48:51], a[160:163], v[104:107]
    s_nop 7
    buffer_load_dwordx4 v[48:51], v26, s[4:7], s69 offen offset:320
    s_waitcnt vmcnt(0)
    v_mfma_f32_16x16x32_bf16 v[104:107], v[48:51], a[164:167], v[104:107]
    s_nop 7
    s_add_u32 s69, s39, 6144
    buffer_load_dwordx4 v[48:51], v26, s[4:7], s69 offen offset:0
    s_waitcnt vmcnt(0)
    v_mfma_f32_16x16x32_bf16 v[108:111], v[48:51], a[144:147], 0
    s_nop 7
    buffer_load_dwordx4 v[48:51], v26, s[4:7], s69 offen offset:64
    s_waitcnt vmcnt(0)
    v_mfma_f32_16x16x32_bf16 v[108:111], v[48:51], a[148:151], v[108:111]
    s_nop 7
    buffer_load_dwordx4 v[48:51], v26, s[4:7], s69 offen offset:128
    s_waitcnt vmcnt(0)
    v_mfma_f32_16x16x32_bf16 v[108:111], v[48:51], a[152:155], v[108:111]
    s_nop 7
    buffer_load_dwordx4 v[48:51], v26, s[4:7], s69 offen offset:192
    s_waitcnt vmcnt(0)
    v_mfma_f32_16x16x32_bf16 v[108:111], v[48:51], a[156:159], v[108:111]
    s_nop 7
    buffer_load_dwordx4 v[48:51], v26, s[4:7], s69 offen offset:256
    s_waitcnt vmcnt(0)
    v_mfma_f32_16x16x32_bf16 v[108:111], v[48:51], a[160:163], v[108:111]
    s_nop 7
    buffer_load_dwordx4 v[48:51], v26, s[4:7], s69 offen offset:320
    s_waitcnt vmcnt(0)
    v_mfma_f32_16x16x32_bf16 v[108:111], v[48:51], a[164:167], v[108:111]
    s_nop 7
    s_nop 15
    v_max3_f32 v14, v104, v105, v106
    v_max3_f32 v14, v14, v107, v108
    v_max3_f32 v14, v14, v109, v110
    v_max_f32 v14, v14, v111
    v_mov_b32 v15, v14
    s_nop 1
    v_permlane32_swap_b32 v15, v14
    v_max_f32 v14, v14, v15
    v_mov_b32 v15, v14
    s_nop 1
    v_permlane16_swap_b32 v15, v14
    v_max_f32 v14, v14, v15
    v_fma_f32 v14, v14, s28, v11
    v_max_f32 v20, 0, v14
    v_sub_f32 v11, v11, v20
    v_sub_f32 v21, 0, v20
    v_exp_f32 v21, v21
    s_nop 0
    v_mul_f32 v46, v46, v21
    v_mul_f32 v208, v208, v21
    v_mul_f32 v209, v209, v21
    v_mul_f32 v210, v210, v21
    v_mul_f32 v211, v211, v21
    v_mul_f32 v212, v212, v21
    v_mul_f32 v213, v213, v21
    v_mul_f32 v214, v214, v21
    v_mul_f32 v215, v215, v21
    v_mul_f32 v216, v216, v21
    v_mul_f32 v217, v217, v21
    v_mul_f32 v218, v218, v21
    v_mul_f32 v219, v219, v21
    v_mul_f32 v220, v220, v21
    v_mul_f32 v221, v221, v21
    v_mul_f32 v222, v222, v21
    v_mul_f32 v223, v223, v21
    v_mul_f32 v224, v224, v21
    v_mul_f32 v225, v225, v21
    v_mul_f32 v226, v226, v21
    v_mul_f32 v227, v227, v21
    v_mul_f32 v228, v228, v21
    v_mul_f32 v229, v229, v21
    v_mul_f32 v230, v230, v21
    v_mul_f32 v231, v231, v21
    v_mul_f32 v232, v232, v21
    v_mul_f32 v233, v233, v21
    v_mul_f32 v234, v234, v21
    v_mul_f32 v235, v235, v21
    v_mul_f32 v236, v236, v21
    v_mul_f32 v237, v237, v21
    v_mul_f32 v238, v238, v21
    v_mul_f32 v239, v239, v21
    v_mul_f32 v240, v240, v21
    v_mul_f32 v241, v241, v21
    v_mul_f32 v242, v242, v21
    v_mul_f32 v243, v243, v21
    v_mul_f32 v244, v244, v21
    v_mul_f32 v245, v245, v21
    v_mul_f32 v246, v246, v21
    v_mul_f32 v247, v247, v21
    v_mul_f32 v248, v248, v21
    v_mul_f32 v249, v249, v21
    v_mul_f32 v250, v250, v21
    v_mul_f32 v251, v251, v21
    v_mul_f32 v252, v252, v21
    v_mul_f32 v253, v253, v21
    v_mul_f32 v254, v254, v21
    v_mul_f32 v255, v255, v21
    v_fma_f32 v104, v104, s28, v11
    v_fma_f32 v105, v105, s28, v11
    v_exp_f32 v104, v104
    v_exp_f32 v105, v105
    s_nop 0
    v_cvt_pk_bf16_f32 v30, v104, v105
    v_fma_f32 v106, v106, s28, v11
    v_fma_f32 v107, v107, s28, v11
    v_exp_f32 v106, v106
    v_exp_f32 v107, v107
    s_nop 0
    v_cvt_pk_bf16_f32 v31, v106, v107
    v_fma_f32 v108, v108, s28, v11
    v_fma_f32 v109, v109, s28, v11
    v_exp_f32 v108, v108
    v_exp_f32 v109, v109
    s_nop 0
    v_cvt_pk_bf16_f32 v28, v108, v109
    v_fma_f32 v110, v110, s28, v11
    v_fma_f32 v111, v111, s28, v11
    v_exp_f32 v110, v110
    v_exp_f32 v111, v111
    s_nop 0
    v_cvt_pk_bf16_f32 v29, v110, v111
    s_add_u32 s69, s39, 0
    buffer_load_dwordx4 v[48:51], v26, s[4:7], s69 offen offset:0
    s_waitcnt vmcnt(0)
    v_mfma_f32_16x16x32_bf16 v[104:107], v[48:51], a[168:171], 0
    s_nop 7
    buffer_load_dwordx4 v[48:51], v26, s[4:7], s69 offen offset:64
    s_waitcnt vmcnt(0)
    v_mfma_f32_16x16x32_bf16 v[104:107], v[48:51], a[172:175], v[104:107]
    s_nop 7
    buffer_load_dwordx4 v[48:51], v26, s[4:7], s69 offen offset:128
    s_waitcnt vmcnt(0)
    v_mfma_f32_16x16x32_bf16 v[104:107], v[48:51], a[176:179], v[104:107]
    s_nop 7
    buffer_load_dwordx4 v[48:51], v26, s[4:7], s69 offen offset:192
    s_waitcnt vmcnt(0)
    v_mfma_f32_16x16x32_bf16 v[104:107], v[48:51], a[180:183], v[104:107]
    s_nop 7
    buffer_load_dwordx4 v[48:51], v26, s[4:7], s69 offen offset:256
    s_waitcnt vmcnt(0)
    v_mfma_f32_16x16x32_bf16 v[104:107], v[48:51], a[184:187], v[104:107]
    s_nop 7
    buffer_load_dwordx4 v[48:51], v26, s[4:7], s69 offen offset:320
    s_waitcnt vmcnt(0)
    v_mfma_f32_16x16x32_bf16 v[104:107], v[48:51], a[188:191], v[104:107]
    s_nop 7
    s_add_u32 s69, s39, 6144
    buffer_load_dwordx4 v[48:51], v26, s[4:7], s69 offen offset:0
    s_waitcnt vmcnt(0)
    v_mfma_f32_16x16x32_bf16 v[108:111], v[48:51], a[168:171], 0
    s_nop 7
    buffer_load_dwordx4 v[48:51], v26, s[4:7], s69 offen offset:64
    s_waitcnt vmcnt(0)
    v_mfma_f32_16x16x32_bf16 v[108:111], v[48:51], a[172:175], v[108:111]
    s_nop 7
    buffer_load_dwordx4 v[48:51], v26, s[4:7], s69 offen offset:128
    s_waitcnt vmcnt(0)
    v_mfma_f32_16x16x32_bf16 v[108:111], v[48:51], a[176:179], v[108:111]
    s_nop 7
    buffer_load_dwordx4 v[48:51], v26, s[4:7], s69 offen offset:192
    s_waitcnt vmcnt(0)
    v_mfma_f32_16x16x32_bf16 v[108:111], v[48:51], a[180:183], v[108:111]
    s_nop 7
    buffer_load_dwordx4 v[48:51], v26, s[4:7], s69 offen offset:256
    s_waitcnt vmcnt(0)
    v_mfma_f32_16x16x32_bf16 v[108:111], v[48:51], a[184:187], v[108:111]
    s_nop 7
    buffer_load_dwordx4 v[48:51], v26, s[4:7], s69 offen offset:320
    s_waitcnt vmcnt(0)
    v_mfma_f32_16x16x32_bf16 v[108:111], v[48:51], a[188:191], v[108:111]
    s_nop 7
    s_nop 15
    v_max3_f32 v14, v104, v105, v106
    v_max3_f32 v14, v14, v107, v108
    v_max3_f32 v14, v14, v109, v110
    v_max_f32 v14, v14, v111
    v_mov_b32 v15, v14
    s_nop 1
    v_permlane32_swap_b32 v15, v14
    v_max_f32 v14, v14, v15
    v_mov_b32 v15, v14
    s_nop 1
    v_permlane16_swap_b32 v15, v14
    v_max_f32 v14, v14, v15
    v_fma_f32 v14, v14, s28, v12
    v_max_f32 v20, 0, v14
    v_sub_f32 v12, v12, v20
    v_sub_f32 v21, 0, v20
    v_exp_f32 v21, v21
    s_nop 0
    v_mul_f32 v47, v47, v21
    v_accvgpr_read_b32 v15, a0
    v_mul_f32 v15, v15, v21
    v_accvgpr_write_b32 a0, v15
    v_accvgpr_read_b32 v15, a1
    v_mul_f32 v15, v15, v21
    v_accvgpr_write_b32 a1, v15
    v_accvgpr_read_b32 v15, a2
    v_mul_f32 v15, v15, v21
    v_accvgpr_write_b32 a2, v15
    v_accvgpr_read_b32 v15, a3
    v_mul_f32 v15, v15, v21
    v_accvgpr_write_b32 a3, v15
    v_accvgpr_read_b32 v15, a4
    v_mul_f32 v15, v15, v21
    v_accvgpr_write_b32 a4, v15
    v_accvgpr_read_b32 v15, a5
    v_mul_f32 v15, v15, v21
    v_accvgpr_write_b32 a5, v15
    v_accvgpr_read_b32 v15, a6
    v_mul_f32 v15, v15, v21
    v_accvgpr_write_b32 a6, v15
    v_accvgpr_read_b32 v15, a7
    v_mul_f32 v15, v15, v21
    v_accvgpr_write_b32 a7, v15
    v_accvgpr_read_b32 v15, a8
    v_mul_f32 v15, v15, v21
    v_accvgpr_write_b32 a8, v15
    v_accvgpr_read_b32 v15, a9
    v_mul_f32 v15, v15, v21
    v_accvgpr_write_b32 a9, v15
    v_accvgpr_read_b32 v15, a10
    v_mul_f32 v15, v15, v21
    v_accvgpr_write_b32 a10, v15
    v_accvgpr_read_b32 v15, a11
    v_mul_f32 v15, v15, v21
    v_accvgpr_write_b32 a11, v15
    v_accvgpr_read_b32 v15, a12
    v_mul_f32 v15, v15, v21
    v_accvgpr_write_b32 a12, v15
    v_accvgpr_read_b32 v15, a13
    v_mul_f32 v15, v15, v21
    v_accvgpr_write_b32 a13, v15
    v_accvgpr_read_b32 v15, a14
    v_mul_f32 v15, v15, v21
    v_accvgpr_write_b32 a14, v15
    v_accvgpr_read_b32 v15, a15
    v_mul_f32 v15, v15, v21
    v_accvgpr_write_b32 a15, v15
    v_accvgpr_read_b32 v15, a16
    v_mul_f32 v15, v15, v21
    v_accvgpr_write_b32 a16, v15
    v_accvgpr_read_b32 v15, a17
    v_mul_f32 v15, v15, v21
    v_accvgpr_write_b32 a17, v15
    v_accvgpr_read_b32 v15, a18
    v_mul_f32 v15, v15, v21
    v_accvgpr_write_b32 a18, v15
    v_accvgpr_read_b32 v15, a19
    v_mul_f32 v15, v15, v21
    v_accvgpr_write_b32 a19, v15
    v_accvgpr_read_b32 v15, a20
    v_mul_f32 v15, v15, v21
    v_accvgpr_write_b32 a20, v15
    v_accvgpr_read_b32 v15, a21
    v_mul_f32 v15, v15, v21
    v_accvgpr_write_b32 a21, v15
    v_accvgpr_read_b32 v15, a22
    v_mul_f32 v15, v15, v21
    v_accvgpr_write_b32 a22, v15
    v_accvgpr_read_b32 v15, a23
    v_mul_f32 v15, v15, v21
    v_accvgpr_write_b32 a23, v15
    v_accvgpr_read_b32 v15, a24
    v_mul_f32 v15, v15, v21
    v_accvgpr_write_b32 a24, v15
    v_accvgpr_read_b32 v15, a25
    v_mul_f32 v15, v15, v21
    v_accvgpr_write_b32 a25, v15
    v_accvgpr_read_b32 v15, a26
    v_mul_f32 v15, v15, v21
    v_accvgpr_write_b32 a26, v15
    v_accvgpr_read_b32 v15, a27
    v_mul_f32 v15, v15, v21
    v_accvgpr_write_b32 a27, v15
    v_accvgpr_read_b32 v15, a28
    v_mul_f32 v15, v15, v21
    v_accvgpr_write_b32 a28, v15
    v_accvgpr_read_b32 v15, a29
    v_mul_f32 v15, v15, v21
    v_accvgpr_write_b32 a29, v15
    v_accvgpr_read_b32 v15, a30
    v_mul_f32 v15, v15, v21
    v_accvgpr_write_b32 a30, v15
    v_accvgpr_read_b32 v15, a31
    v_mul_f32 v15, v15, v21
    v_accvgpr_write_b32 a31, v15
    v_accvgpr_read_b32 v15, a32
    v_mul_f32 v15, v15, v21
    v_accvgpr_write_b32 a32, v15
    v_accvgpr_read_b32 v15, a33
    v_mul_f32 v15, v15, v21
    v_accvgpr_write_b32 a33, v15
    v_accvgpr_read_b32 v15, a34
    v_mul_f32 v15, v15, v21
    v_accvgpr_write_b32 a34, v15
    v_accvgpr_read_b32 v15, a35
    v_mul_f32 v15, v15, v21
    v_accvgpr_write_b32 a35, v15
    v_accvgpr_read_b32 v15, a36
    v_mul_f32 v15, v15, v21
    v_accvgpr_write_b32 a36, v15
    v_accvgpr_read_b32 v15, a37
    v_mul_f32 v15, v15, v21
    v_accvgpr_write_b32 a37, v15
    v_accvgpr_read_b32 v15, a38
    v_mul_f32 v15, v15, v21
    v_accvgpr_write_b32 a38, v15
    v_accvgpr_read_b32 v15, a39
    v_mul_f32 v15, v15, v21
    v_accvgpr_write_b32 a39, v15
    v_accvgpr_read_b32 v15, a40
    v_mul_f32 v15, v15, v21
    v_accvgpr_write_b32 a40, v15
    v_accvgpr_read_b32 v15, a41
    v_mul_f32 v15, v15, v21
    v_accvgpr_write_b32 a41, v15
    v_accvgpr_read_b32 v15, a42
    v_mul_f32 v15, v15, v21
    v_accvgpr_write_b32 a42, v15
    v_accvgpr_read_b32 v15, a43
    v_mul_f32 v15, v15, v21
    v_accvgpr_write_b32 a43, v15
    v_accvgpr_read_b32 v15, a44
    v_mul_f32 v15, v15, v21
    v_accvgpr_write_b32 a44, v15
    v_accvgpr_read_b32 v15, a45
    v_mul_f32 v15, v15, v21
    v_accvgpr_write_b32 a45, v15
    v_accvgpr_read_b32 v15, a46
    v_mul_f32 v15, v15, v21
    v_accvgpr_write_b32 a46, v15
    v_accvgpr_read_b32 v15, a47
    v_mul_f32 v15, v15, v21
    v_accvgpr_write_b32 a47, v15
    v_fma_f32 v104, v104, s28, v12
    v_fma_f32 v105, v105, s28, v12
    v_exp_f32 v104, v104
    v_exp_f32 v105, v105
    s_nop 0
    v_cvt_pk_bf16_f32 v36, v104, v105
    v_fma_f32 v106, v106, s28, v12
    v_fma_f32 v107, v107, s28, v12
    v_exp_f32 v106, v106
    v_exp_f32 v107, v107
    s_nop 0
    v_cvt_pk_bf16_f32 v37, v106, v107
    v_fma_f32 v108, v108, s28, v12
    v_fma_f32 v109, v109, s28, v12
    v_exp_f32 v108, v108
    v_exp_f32 v109, v109
    s_nop 0
    v_cvt_pk_bf16_f32 v34, v108, v109
    v_fma_f32 v110, v110, s28, v12
    v_fma_f32 v111, v111, s28, v12
    v_exp_f32 v110, v110
    v_exp_f32 v111, v111
    s_nop 0
    v_cvt_pk_bf16_f32 v35, v110, v111
    s_add_u32 s69, s39, 0
    buffer_load_dwordx4 v[48:51], v26, s[4:7], s69 offen offset:0
    s_waitcnt vmcnt(0)
    v_mfma_f32_16x16x32_bf16 v[104:107], v[48:51], a[192:195], 0
    s_nop 7
    buffer_load_dwordx4 v[48:51], v26, s[4:7], s69 offen offset:64
    s_waitcnt vmcnt(0)
    v_mfma_f32_16x16x32_bf16 v[104:107], v[48:51], a[196:199], v[104:107]
    s_nop 7
    buffer_load_dwordx4 v[48:51], v26, s[4:7], s69 offen offset:128
    s_waitcnt vmcnt(0)
    v_mfma_f32_16x16x32_bf16 v[104:107], v[48:51], a[200:203], v[104:107]
    s_nop 7
    buffer_load_dwordx4 v[48:51], v26, s[4:7], s69 offen offset:192
    s_waitcnt vmcnt(0)
    v_mfma_f32_16x16x32_bf16 v[104:107], v[48:51], a[204:207], v[104:107]
    s_nop 7
    buffer_load_dwordx4 v[48:51], v26, s[4:7], s69 offen offset:256
    s_waitcnt vmcnt(0)
    v_mfma_f32_16x16x32_bf16 v[104:107], v[48:51], a[208:211], v[104:107]
    s_nop 7
    buffer_load_dwordx4 v[48:51], v26, s[4:7], s69 offen offset:320
    s_waitcnt vmcnt(0)
    v_mfma_f32_16x16x32_bf16 v[104:107], v[48:51], v[92:95], v[104:107]
    s_nop 7
    s_add_u32 s69, s39, 6144
    buffer_load_dwordx4 v[48:51], v26, s[4:7], s69 offen offset:0
    s_waitcnt vmcnt(0)
    v_mfma_f32_16x16x32_bf16 v[108:111], v[48:51], a[192:195], 0
    s_nop 7
    buffer_load_dwordx4 v[48:51], v26, s[4:7], s69 offen offset:64
    s_waitcnt vmcnt(0)
    v_mfma_f32_16x16x32_bf16 v[108:111], v[48:51], a[196:199], v[108:111]
    s_nop 7
    buffer_load_dwordx4 v[48:51], v26, s[4:7], s69 offen offset:128
    s_waitcnt vmcnt(0)
    v_mfma_f32_16x16x32_bf16 v[108:111], v[48:51], a[200:203], v[108:111]
    s_nop 7
    buffer_load_dwordx4 v[48:51], v26, s[4:7], s69 offen offset:192
    s_waitcnt vmcnt(0)
    v_mfma_f32_16x16x32_bf16 v[108:111], v[48:51], a[204:207], v[108:111]
    s_nop 7
    buffer_load_dwordx4 v[48:51], v26, s[4:7], s69 offen offset:256
    s_waitcnt vmcnt(0)
    v_mfma_f32_16x16x32_bf16 v[108:111], v[48:51], a[208:211], v[108:111]
    s_nop 7
    buffer_load_dwordx4 v[48:51], v26, s[4:7], s69 offen offset:320
    s_waitcnt vmcnt(0)
    v_mfma_f32_16x16x32_bf16 v[108:111], v[48:51], v[92:95], v[108:111]
    s_nop 7
    s_nop 15
    v_max3_f32 v14, v104, v105, v106
    v_max3_f32 v14, v14, v107, v108
    v_max3_f32 v14, v14, v109, v110
    v_max_f32 v14, v14, v111
    v_mov_b32 v15, v14
    s_nop 1
    v_permlane32_swap_b32 v15, v14
    v_max_f32 v14, v14, v15
    v_mov_b32 v15, v14
    s_nop 1
    v_permlane16_swap_b32 v15, v14
    v_max_f32 v14, v14, v15
    v_fma_f32 v14, v14, s28, v13
    v_max_f32 v20, 0, v14
    v_sub_f32 v13, v13, v20
    v_sub_f32 v21, 0, v20
    v_exp_f32 v21, v21
    s_nop 0
    v_mul_f32 v15, v44, v21
    v_cndmask_b32_e64 v44, v44, v15, s[60:61]
    v_accvgpr_read_b32 v15, a48
    v_mul_f32 v15, v15, v21
    v_accvgpr_write_b32 a48, v15
    v_accvgpr_read_b32 v15, a49
    v_mul_f32 v15, v15, v21
    v_accvgpr_write_b32 a49, v15
    v_accvgpr_read_b32 v15, a50
    v_mul_f32 v15, v15, v21
    v_accvgpr_write_b32 a50, v15
    v_accvgpr_read_b32 v15, a51
    v_mul_f32 v15, v15, v21
    v_accvgpr_write_b32 a51, v15
    v_accvgpr_read_b32 v15, a52
    v_mul_f32 v15, v15, v21
    v_accvgpr_write_b32 a52, v15
    v_accvgpr_read_b32 v15, a53
    v_mul_f32 v15, v15, v21
    v_accvgpr_write_b32 a53, v15
    v_accvgpr_read_b32 v15, a54
    v_mul_f32 v15, v15, v21
    v_accvgpr_write_b32 a54, v15
    v_accvgpr_read_b32 v15, a55
    v_mul_f32 v15, v15, v21
    v_accvgpr_write_b32 a55, v15
    v_accvgpr_read_b32 v15, a56
    v_mul_f32 v15, v15, v21
    v_accvgpr_write_b32 a56, v15
    v_accvgpr_read_b32 v15, a57
    v_mul_f32 v15, v15, v21
    v_accvgpr_write_b32 a57, v15
    v_accvgpr_read_b32 v15, a58
    v_mul_f32 v15, v15, v21
    v_accvgpr_write_b32 a58, v15
    v_accvgpr_read_b32 v15, a59
    v_mul_f32 v15, v15, v21
    v_accvgpr_write_b32 a59, v15
    v_accvgpr_read_b32 v15, a60
    v_mul_f32 v15, v15, v21
    v_accvgpr_write_b32 a60, v15
    v_accvgpr_read_b32 v15, a61
    v_mul_f32 v15, v15, v21
    v_accvgpr_write_b32 a61, v15
    v_accvgpr_read_b32 v15, a62
    v_mul_f32 v15, v15, v21
    v_accvgpr_write_b32 a62, v15
    v_accvgpr_read_b32 v15, a63
    v_mul_f32 v15, v15, v21
    v_accvgpr_write_b32 a63, v15
    v_accvgpr_read_b32 v15, a64
    v_mul_f32 v15, v15, v21
    v_accvgpr_write_b32 a64, v15
    v_accvgpr_read_b32 v15, a65
    v_mul_f32 v15, v15, v21
    v_accvgpr_write_b32 a65, v15
    v_accvgpr_read_b32 v15, a66
    v_mul_f32 v15, v15, v21
    v_accvgpr_write_b32 a66, v15
    v_accvgpr_read_b32 v15, a67
    v_mul_f32 v15, v15, v21
    v_accvgpr_write_b32 a67, v15
    v_accvgpr_read_b32 v15, a68
    v_mul_f32 v15, v15, v21
    v_accvgpr_write_b32 a68, v15
    v_accvgpr_read_b32 v15, a69
    v_mul_f32 v15, v15, v21
    v_accvgpr_write_b32 a69, v15
    v_accvgpr_read_b32 v15, a70
    v_mul_f32 v15, v15, v21
    v_accvgpr_write_b32 a70, v15
    v_accvgpr_read_b32 v15, a71
    v_mul_f32 v15, v15, v21
    v_accvgpr_write_b32 a71, v15
    v_accvgpr_read_b32 v15, a72
    v_mul_f32 v15, v15, v21
    v_accvgpr_write_b32 a72, v15
    v_accvgpr_read_b32 v15, a73
    v_mul_f32 v15, v15, v21
    v_accvgpr_write_b32 a73, v15
    v_accvgpr_read_b32 v15, a74
    v_mul_f32 v15, v15, v21
    v_accvgpr_write_b32 a74, v15
    v_accvgpr_read_b32 v15, a75
    v_mul_f32 v15, v15, v21
    v_accvgpr_write_b32 a75, v15
    v_accvgpr_read_b32 v15, a76
    v_mul_f32 v15, v15, v21
    v_accvgpr_write_b32 a76, v15
    v_accvgpr_read_b32 v15, a77
    v_mul_f32 v15, v15, v21
    v_accvgpr_write_b32 a77, v15
    v_accvgpr_read_b32 v15, a78
    v_mul_f32 v15, v15, v21
    v_accvgpr_write_b32 a78, v15
    v_accvgpr_read_b32 v15, a79
    v_mul_f32 v15, v15, v21
    v_accvgpr_write_b32 a79, v15
    v_accvgpr_read_b32 v15, a80
    v_mul_f32 v15, v15, v21
    v_accvgpr_write_b32 a80, v15
    v_accvgpr_read_b32 v15, a81
    v_mul_f32 v15, v15, v21
    v_accvgpr_write_b32 a81, v15
    v_accvgpr_read_b32 v15, a82
    v_mul_f32 v15, v15, v21
    v_accvgpr_write_b32 a82, v15
    v_accvgpr_read_b32 v15, a83
    v_mul_f32 v15, v15, v21
    v_accvgpr_write_b32 a83, v15
    v_accvgpr_read_b32 v15, a84
    v_mul_f32 v15, v15, v21
    v_accvgpr_write_b32 a84, v15
    v_accvgpr_read_b32 v15, a85
    v_mul_f32 v15, v15, v21
    v_accvgpr_write_b32 a85, v15
    v_accvgpr_read_b32 v15, a86
    v_mul_f32 v15, v15, v21
    v_accvgpr_write_b32 a86, v15
    v_accvgpr_read_b32 v15, a87
    v_mul_f32 v15, v15, v21
    v_accvgpr_write_b32 a87, v15
    v_accvgpr_read_b32 v15, a88
    v_mul_f32 v15, v15, v21
    v_accvgpr_write_b32 a88, v15
    v_accvgpr_read_b32 v15, a89
    v_mul_f32 v15, v15, v21
    v_accvgpr_write_b32 a89, v15
    v_accvgpr_read_b32 v15, a90
    v_mul_f32 v15, v15, v21
    v_accvgpr_write_b32 a90, v15
    v_accvgpr_read_b32 v15, a91
    v_mul_f32 v15, v15, v21
    v_accvgpr_write_b32 a91, v15
    v_accvgpr_read_b32 v15, a92
    v_mul_f32 v15, v15, v21
    v_accvgpr_write_b32 a92, v15
    v_accvgpr_read_b32 v15, a93
    v_mul_f32 v15, v15, v21
    v_accvgpr_write_b32 a93, v15
    v_accvgpr_read_b32 v15, a94
    v_mul_f32 v15, v15, v21
    v_accvgpr_write_b32 a94, v15
    v_accvgpr_read_b32 v15, a95
    v_mul_f32 v15, v15, v21
    v_accvgpr_write_b32 a95, v15
    v_fma_f32 v104, v104, s28, v13
    v_fma_f32 v105, v105, s28, v13
    v_exp_f32 v104, v104
    v_exp_f32 v105, v105
    s_nop 0
    v_cvt_pk_bf16_f32 v42, v104, v105
    v_fma_f32 v106, v106, s28, v13
    v_fma_f32 v107, v107, s28, v13
    v_exp_f32 v106, v106
    v_exp_f32 v107, v107
    s_nop 0
    v_cvt_pk_bf16_f32 v43, v106, v107
    v_fma_f32 v108, v108, s28, v13
    v_fma_f32 v109, v109, s28, v13
    v_exp_f32 v108, v108
    v_exp_f32 v109, v109
    s_nop 0
    v_cvt_pk_bf16_f32 v40, v108, v109
    v_fma_f32 v110, v110, s28, v13
    v_fma_f32 v111, v111, s28, v13
    v_exp_f32 v110, v110
    v_exp_f32 v111, v111
    s_nop 0
    v_cvt_pk_bf16_f32 v41, v110, v111
    v_mfma_f32_16x16x32_bf16 v[48:51], a[236:239], v[16:19], v[44:47]
    v_mfma_f32_16x16x32_bf16 v[48:51], a[240:243], v[22:25], v[48:51]
    v_mfma_f32_16x16x32_bf16 v[48:51], a[244:247], v[28:31], v[48:51]
    v_mfma_f32_16x16x32_bf16 v[48:51], a[248:251], v[34:37], v[48:51]
    v_mfma_f32_16x16x32_bf16 v[48:51], a[252:255], v[40:43], v[48:51]
    s_nop 15
    s_setpc_b64 s[40:41]
L_rare4_0:
    s_nop 15
    v_mbcnt_lo_u32_b32 v31, -1, 0
    v_mbcnt_hi_u32_b32 v31, -1, v31
    v_and_b32 v30, 15, v31
    v_mul_u32_u24 v30, 384, v30
    v_lshrrev_b32 v31, 4, v31
    v_lshl_add_u32 v30, v31, 4, v30
    s_add_u32 s69, s39, 0
    buffer_load_dwordx4 v[44:47], v30, s[4:7], s69 offen offset:0
    s_waitcnt vmcnt(0)
    v_mfma_f32_16x16x32_bf16 v[104:107], v[44:47], a[96:99], 0
    s_nop 7
    buffer_load_dwordx4 v[44:47], v30, s[4:7], s69 offen offset:64
    s_waitcnt vmcnt(0)
    v_mfma_f32_16x16x32_bf16 v[104:107], v[44:47], a[100:103], v[104:107]
    s_nop 7
    buffer_load_dwordx4 v[44:47], v30, s[4:7], s69 offen offset:128
    s_waitcnt vmcnt(0)
    v_mfma_f32_16x16x32_bf16 v[104:107], v[44:47], a[104:107], v[104:107]
    s_nop 7
    buffer_load_dwordx4 v[44:47], v30, s[4:7], s69 offen offset:192
    s_waitcnt vmcnt(0)
    v_mfma_f32_16x16x32_bf16 v[104:107], v[44:47], a[108:111], v[104:107]
    s_nop 7
    buffer_load_dwordx4 v[44:47], v30, s[4:7], s69 offen offset:256
    s_waitcnt vmcnt(0)
    v_mfma_f32_16x16x32_bf16 v[104:107], v[44:47], a[112:115], v[104:107]
    s_nop 7
    buffer_load_dwordx4 v[44:47], v30, s[4:7], s69 offen offset:320
    s_waitcnt vmcnt(0)
    v_mfma_f32_16x16x32_bf16 v[104:107], v[44:47], a[116:119], v[104:107]
    s_nop 7
    s_add_u32 s69, s39, 6144
    buffer_load_dwordx4 v[44:47], v30, s[4:7], s69 offen offset:0
    s_waitcnt vmcnt(0)
    v_mfma_f32_16x16x32_bf16 v[108:111], v[44:47], a[96:99], 0
    s_nop 7
    buffer_load_dwordx4 v[44:47], v30, s[4:7], s69 offen offset:64
    s_waitcnt vmcnt(0)
    v_mfma_f32_16x16x32_bf16 v[108:111], v[44:47], a[100:103], v[108:111]
    s_nop 7
    buffer_load_dwordx4 v[44:47], v30, s[4:7], s69 offen offset:128
    s_waitcnt vmcnt(0)
    v_mfma_f32_16x16x32_bf16 v[108:111], v[44:47], a[104:107], v[108:111]
    s_nop 7
    buffer_load_dwordx4 v[44:47], v30, s[4:7], s69 offen offset:192
    s_waitcnt vmcnt(0)
    v_mfma_f32_16x16x32_bf16 v[108:111], v[44:47], a[108:111], v[108:111]
    s_nop 7
    buffer_load_dwordx4 v[44:47], v30, s[4:7], s69 offen offset:256
    s_waitcnt vmcnt(0)
    v_mfma_f32_16x16x32_bf16 v[108:111], v[44:47], a[112:115], v[108:111]
    s_nop 7
    buffer_load_dwordx4 v[44:47], v30, s[4:7], s69 offen offset:320
    s_waitcnt vmcnt(0)
    v_mfma_f32_16x16x32_bf16 v[108:111], v[44:47], a[116:119], v[108:111]
    s_nop 7
    s_nop 15
    v_max3_f32 v18, v104, v105, v106
    v_max3_f32 v18, v18, v107, v108
    v_max3_f32 v18, v18, v109, v110
    v_max_f32 v18, v18, v111
    v_mov_b32 v19, v18
    s_nop 1
    v_permlane32_swap_b32 v19, v18
    v_max_f32 v18, v18, v19
    v_mov_b32 v19, v18
    s_nop 1
    v_permlane16_swap_b32 v19, v18
    v_max_f32 v18, v18, v19
    v_fma_f32 v18, v18, s28, v9
    v_max_f32 v24, 0, v18
    v_sub_f32 v9, v9, v24
    v_sub_f32 v25, 0, v24
    v_exp_f32 v25, v25
    s_nop 0
    v_mul_f32 v19, v48, v25
    v_cndmask_b32_e64 v48, v19, v48, s[60:61]
    v_cndmask_b32_e64 v48, v48, 0, s[46:47]
    v_mul_f32 v112, v112, v25
    v_mul_f32 v113, v113, v25
    v_mul_f32 v114, v114, v25
    v_mul_f32 v115, v115, v25
    v_mul_f32 v116, v116, v25
    v_mul_f32 v117, v117, v25
    v_mul_f32 v118, v118, v25
    v_mul_f32 v119, v119, v25
    v_mul_f32 v120, v120, v25
    v_mul_f32 v121, v121, v25
    v_mul_f32 v122, v122, v25
    v_mul_f32 v123, v123, v25
    v_mul_f32 v124, v124, v25
    v_mul_f32 v125, v125, v25
    v_mul_f32 v126, v126, v25
    v_mul_f32 v127, v127, v25
    v_mul_f32 v128, v128, v25
    v_mul_f32 v129, v129, v25
    v_mul_f32 v130, v130, v25
    v_mul_f32 v131, v131, v25
    v_mul_f32 v132, v132, v25
    v_mul_f32 v133, v133, v25
    v_mul_f32 v134, v134, v25
    v_mul_f32 v135, v135, v25
    v_mul_f32 v136, v136, v25
    v_mul_f32 v137, v137, v25
    v_mul_f32 v138, v138, v25
    v_mul_f32 v139, v139, v25
    v_mul_f32 v140, v140, v25
    v_mul_f32 v141, v141, v25
    v_mul_f32 v142, v142, v25
    v_mul_f32 v143, v143, v25
    v_mul_f32 v144, v144, v25
    v_mul_f32 v145, v145, v25
    v_mul_f32 v146, v146, v25
    v_mul_f32 v147, v147, v25
    v_mul_f32 v148, v148, v25
    v_mul_f32 v149, v149, v25
    v_mul_f32 v150, v150, v25
    v_mul_f32 v151, v151, v25
    v_mul_f32 v152, v152, v25
    v_mul_f32 v153, v153, v25
    v_mul_f32 v154, v154, v25
    v_mul_f32 v155, v155, v25
    v_mul_f32 v156, v156, v25
    v_mul_f32 v157, v157, v25
    v_mul_f32 v158, v158, v25
    v_mul_f32 v159, v159, v25
    v_fma_f32 v104, v104, s28, v9
    v_fma_f32 v105, v105, s28, v9
    v_exp_f32 v104, v104
    v_exp_f32 v105, v105
    s_nop 0
    v_cvt_pk_bf16_f32 v14, v104, v105
    v_fma_f32 v106, v106, s28, v9
    v_fma_f32 v107, v107, s28, v9
    v_exp_f32 v106, v106
    v_exp_f32 v107, v107
    s_nop 0
    v_cvt_pk_bf16_f32 v15, v106, v107
    v_fma_f32 v108, v108, s28, v9
    v_fma_f32 v109, v109, s28, v9
    v_exp_f32 v108, v108
    v_exp_f32 v109, v109
    s_nop 0
    v_cvt_pk_bf16_f32 v16, v108, v109
    v_fma_f32 v110, v110, s28, v9
    v_fma_f32 v111, v111, s28, v9
    v_exp_f32 v110, v110
    v_exp_f32 v111, v111
    s_nop 0
    v_cvt_pk_bf16_f32 v17, v110, v111
    s_add_u32 s69, s39, 0
    buffer_load_dwordx4 v[44:47], v30, s[4:7], s69 offen offset:0
    s_waitcnt vmcnt(0)
    v_mfma_f32_16x16x32_bf16 v[104:107], v[44:47], a[120:123], 0
    s_nop 7
    buffer_load_dwordx4 v[44:47], v30, s[4:7], s69 offen offset:64
    s_waitcnt vmcnt(0)
    v_mfma_f32_16x16x32_bf16 v[104:107], v[44:47], a[124:127], v[104:107]
    s_nop 7
    buffer_load_dwordx4 v[44:47], v30, s[4:7], s69 offen offset:128
    s_waitcnt vmcnt(0)
    v_mfma_f32_16x16x32_bf16 v[104:107], v[44:47], a[128:131], v[104:107]
    s_nop 7
    buffer_load_dwordx4 v[44:47], v30, s[4:7], s69 offen offset:192
    s_waitcnt vmcnt(0)
    v_mfma_f32_16x16x32_bf16 v[104:107], v[44:47], a[132:135], v[104:107]
    s_nop 7
    buffer_load_dwordx4 v[44:47], v30, s[4:7], s69 offen offset:256
    s_waitcnt vmcnt(0)
    v_mfma_f32_16x16x32_bf16 v[104:107], v[44:47], a[136:139], v[104:107]
    s_nop 7
    buffer_load_dwordx4 v[44:47], v30, s[4:7], s69 offen offset:320
    s_waitcnt vmcnt(0)
    v_mfma_f32_16x16x32_bf16 v[104:107], v[44:47], a[140:143], v[104:107]
    s_nop 7
    s_add_u32 s69, s39, 6144
    buffer_load_dwordx4 v[44:47], v30, s[4:7], s69 offen offset:0
    s_waitcnt vmcnt(0)
    v_mfma_f32_16x16x32_bf16 v[108:111], v[44:47], a[120:123], 0
    s_nop 7
    buffer_load_dwordx4 v[44:47], v30, s[4:7], s69 offen offset:64
    s_waitcnt vmcnt(0)
    v_mfma_f32_16x16x32_bf16 v[108:111], v[44:47], a[124:127], v[108:111]
    s_nop 7
    buffer_load_dwordx4 v[44:47], v30, s[4:7], s69 offen offset:128
    s_waitcnt vmcnt(0)
    v_mfma_f32_16x16x32_bf16 v[108:111], v[44:47], a[128:131], v[108:111]
    s_nop 7
    buffer_load_dwordx4 v[44:47], v30, s[4:7], s69 offen offset:192
    s_waitcnt vmcnt(0)
    v_mfma_f32_16x16x32_bf16 v[108:111], v[44:47], a[132:135], v[108:111]
    s_nop 7
    buffer_load_dwordx4 v[44:47], v30, s[4:7], s69 offen offset:256
    s_waitcnt vmcnt(0)
    v_mfma_f32_16x16x32_bf16 v[108:111], v[44:47], a[136:139], v[108:111]
    s_nop 7
    buffer_load_dwordx4 v[44:47], v30, s[4:7], s69 offen offset:320
    s_waitcnt vmcnt(0)
    v_mfma_f32_16x16x32_bf16 v[108:111], v[44:47], a[140:143], v[108:111]
    s_nop 7
    s_nop 15
    v_max3_f32 v18, v104, v105, v106
    v_max3_f32 v18, v18, v107, v108
    v_max3_f32 v18, v18, v109, v110
    v_max_f32 v18, v18, v111
    v_mov_b32 v19, v18
    s_nop 1
    v_permlane32_swap_b32 v19, v18
    v_max_f32 v18, v18, v19
    v_mov_b32 v19, v18
    s_nop 1
    v_permlane16_swap_b32 v19, v18
    v_max_f32 v18, v18, v19
    v_fma_f32 v18, v18, s28, v10
    v_max_f32 v24, 0, v18
    v_sub_f32 v10, v10, v24
    v_sub_f32 v25, 0, v24
    v_exp_f32 v25, v25
    s_nop 0
    v_mul_f32 v49, v49, v25
    v_mul_f32 v160, v160, v25
    v_mul_f32 v161, v161, v25
    v_mul_f32 v162, v162, v25
    v_mul_f32 v163, v163, v25
    v_mul_f32 v164, v164, v25
    v_mul_f32 v165, v165, v25
    v_mul_f32 v166, v166, v25
    v_mul_f32 v167, v167, v25
    v_mul_f32 v168, v168, v25
    v_mul_f32 v169, v169, v25
    v_mul_f32 v170, v170, v25
    v_mul_f32 v171, v171, v25
    v_mul_f32 v172, v172, v25
    v_mul_f32 v173, v173, v25
    v_mul_f32 v174, v174, v25
    v_mul_f32 v175, v175, v25
    v_mul_f32 v176, v176, v25
    v_mul_f32 v177, v177, v25
    v_mul_f32 v178, v178, v25
    v_mul_f32 v179, v179, v25
    v_mul_f32 v180, v180, v25
    v_mul_f32 v181, v181, v25
    v_mul_f32 v182, v182, v25
    v_mul_f32 v183, v183, v25
    v_mul_f32 v184, v184, v25
    v_mul_f32 v185, v185, v25
    v_mul_f32 v186, v186, v25
    v_mul_f32 v187, v187, v25
    v_mul_f32 v188, v188, v25
    v_mul_f32 v189, v189, v25
    v_mul_f32 v190, v190, v25
    v_mul_f32 v191, v191, v25
    v_mul_f32 v192, v192, v25
    v_mul_f32 v193, v193, v25
    v_mul_f32 v194, v194, v25
    v_mul_f32 v195, v195, v25
    v_mul_f32 v196, v196, v25
    v_mul_f32 v197, v197, v25
    v_mul_f32 v198, v198, v25
    v_mul_f32 v199, v199, v25
    v_mul_f32 v200, v200, v25
    v_mul_f32 v201, v201, v25
    v_mul_f32 v202, v202, v25
    v_mul_f32 v203, v203, v25
    v_mul_f32 v204, v204, v25
    v_mul_f32 v205, v205, v25
    v_mul_f32 v206, v206, v25
    v_mul_f32 v207, v207, v25
    v_fma_f32 v104, v104, s28, v10
    v_fma_f32 v105, v105, s28, v10
    v_exp_f32 v104, v104
    v_exp_f32 v105, v105
    s_nop 0
    v_cvt_pk_bf16_f32 v20, v104, v105
    v_fma_f32 v106, v106, s28, v10
    v_fma_f32 v107, v107, s28, v10
    v_exp_f32 v106, v106
    v_exp_f32 v107, v107
    s_nop 0
    v_cvt_pk_bf16_f32 v21, v106, v107
    v_fma_f32 v108, v108, s28, v10
    v_fma_f32 v109, v109, s28, v10
    v_exp_f32 v108, v108
    v_exp_f32 v109, v109
    s_nop 0
    v_cvt_pk_bf16_f32 v22, v108, v109
    v_fma_f32 v110, v110, s28, v10
    v_fma_f32 v111, v111, s28, v10
    v_exp_f32 v110, v110
    v_exp_f32 v111, v111
    s_nop 0
    v_cvt_pk_bf16_f32 v23, v110, v111
    s_add_u32 s69, s39, 0
    buffer_load_dwordx4 v[44:47], v30, s[4:7], s69 offen offset:0
    s_waitcnt vmcnt(0)
    v_mfma_f32_16x16x32_bf16 v[104:107], v[44:47], a[144:147], 0
    s_nop 7
    buffer_load_dwordx4 v[44:47], v30, s[4:7], s69 offen offset:64
    s_waitcnt vmcnt(0)
    v_mfma_f32_16x16x32_bf16 v[104:107], v[44:47], a[148:151], v[104:107]
    s_nop 7
    buffer_load_dwordx4 v[44:47], v30, s[4:7], s69 offen offset:128
    s_waitcnt vmcnt(0)
    v_mfma_f32_16x16x32_bf16 v[104:107], v[44:47], a[152:155], v[104:107]
    s_nop 7
    buffer_load_dwordx4 v[44:47], v30, s[4:7], s69 offen offset:192
    s_waitcnt vmcnt(0)
    v_mfma_f32_16x16x32_bf16 v[104:107], v[44:47], a[156:159], v[104:107]
    s_nop 7
    buffer_load_dwordx4 v[44:47], v30, s[4:7], s69 offen offset:256
    s_waitcnt vmcnt(0)
    v_mfma_f32_16x16x32_bf16 v[104:107], v[44:47], a[160:163], v[104:107]
    s_nop 7
    buffer_load_dwordx4 v[44:47], v30, s[4:7], s69 offen offset:320
    s_waitcnt vmcnt(0)
    v_mfma_f32_16x16x32_bf16 v[104:107], v[44:47], a[164:167], v[104:107]
    s_nop 7
    s_add_u32 s69, s39, 6144
    buffer_load_dwordx4 v[44:47], v30, s[4:7], s69 offen offset:0
    s_waitcnt vmcnt(0)
    v_mfma_f32_16x16x32_bf16 v[108:111], v[44:47], a[144:147], 0
    s_nop 7
    buffer_load_dwordx4 v[44:47], v30, s[4:7], s69 offen offset:64
    s_waitcnt vmcnt(0)
    v_mfma_f32_16x16x32_bf16 v[108:111], v[44:47], a[148:151], v[108:111]
    s_nop 7
    buffer_load_dwordx4 v[44:47], v30, s[4:7], s69 offen offset:128
    s_waitcnt vmcnt(0)
    v_mfma_f32_16x16x32_bf16 v[108:111], v[44:47], a[152:155], v[108:111]
    s_nop 7
    buffer_load_dwordx4 v[44:47], v30, s[4:7], s69 offen offset:192
    s_waitcnt vmcnt(0)
    v_mfma_f32_16x16x32_bf16 v[108:111], v[44:47], a[156:159], v[108:111]
    s_nop 7
    buffer_load_dwordx4 v[44:47], v30, s[4:7], s69 offen offset:256
    s_waitcnt vmcnt(0)
    v_mfma_f32_16x16x32_bf16 v[108:111], v[44:47], a[160:163], v[108:111]
    s_nop 7
    buffer_load_dwordx4 v[44:47], v30, s[4:7], s69 offen offset:320
    s_waitcnt vmcnt(0)
    v_mfma_f32_16x16x32_bf16 v[108:111], v[44:47], a[164:167], v[108:111]
    s_nop 7
    s_nop 15
    v_max3_f32 v18, v104, v105, v106
    v_max3_f32 v18, v18, v107, v108
    v_max3_f32 v18, v18, v109, v110
    v_max_f32 v18, v18, v111
    v_mov_b32 v19, v18
    s_nop 1
    v_permlane32_swap_b32 v19, v18
    v_max_f32 v18, v18, v19
    v_mov_b32 v19, v18
    s_nop 1
    v_permlane16_swap_b32 v19, v18
    v_max_f32 v18, v18, v19
    v_fma_f32 v18, v18, s28, v11
    v_max_f32 v24, 0, v18
    v_sub_f32 v11, v11, v24
    v_sub_f32 v25, 0, v24
    v_exp_f32 v25, v25
    s_nop 0
    v_mul_f32 v50, v50, v25
    v_mul_f32 v208, v208, v25
    v_mul_f32 v209, v209, v25
    v_mul_f32 v210, v210, v25
    v_mul_f32 v211, v211, v25
    v_mul_f32 v212, v212, v25
    v_mul_f32 v213, v213, v25
    v_mul_f32 v214, v214, v25
    v_mul_f32 v215, v215, v25
    v_mul_f32 v216, v216, v25
    v_mul_f32 v217, v217, v25
    v_mul_f32 v218, v218, v25
    v_mul_f32 v219, v219, v25
    v_mul_f32 v220, v220, v25
    v_mul_f32 v221, v221, v25
    v_mul_f32 v222, v222, v25
    v_mul_f32 v223, v223, v25
    v_mul_f32 v224, v224, v25
    v_mul_f32 v225, v225, v25
    v_mul_f32 v226, v226, v25
    v_mul_f32 v227, v227, v25
    v_mul_f32 v228, v228, v25
    v_mul_f32 v229, v229, v25
    v_mul_f32 v230, v230, v25
    v_mul_f32 v231, v231, v25
    v_mul_f32 v232, v232, v25
    v_mul_f32 v233, v233, v25
    v_mul_f32 v234, v234, v25
    v_mul_f32 v235, v235, v25
    v_mul_f32 v236, v236, v25
    v_mul_f32 v237, v237, v25
    v_mul_f32 v238, v238, v25
    v_mul_f32 v239, v239, v25
    v_mul_f32 v240, v240, v25
    v_mul_f32 v241, v241, v25
    v_mul_f32 v242, v242, v25
    v_mul_f32 v243, v243, v25
    v_mul_f32 v244, v244, v25
    v_mul_f32 v245, v245, v25
    v_mul_f32 v246, v246, v25
    v_mul_f32 v247, v247, v25
    v_mul_f32 v248, v248, v25
    v_mul_f32 v249, v249, v25
    v_mul_f32 v250, v250, v25
    v_mul_f32 v251, v251, v25
    v_mul_f32 v252, v252, v25
    v_mul_f32 v253, v253, v25
    v_mul_f32 v254, v254, v25
    v_mul_f32 v255, v255, v25
    v_fma_f32 v104, v104, s28, v11
    v_fma_f32 v105, v105, s28, v11
    v_exp_f32 v104, v104
    v_exp_f32 v105, v105
    s_nop 0
    v_cvt_pk_bf16_f32 v26, v104, v105
    v_fma_f32 v106, v106, s28, v11
    v_fma_f32 v107, v107, s28, v11
    v_exp_f32 v106, v106
    v_exp_f32 v107, v107
    s_nop 0
    v_cvt_pk_bf16_f32 v27, v106, v107
    v_fma_f32 v108, v108, s28, v11
    v_fma_f32 v109, v109, s28, v11
    v_exp_f32 v108, v108
    v_exp_f32 v109, v109
    s_nop 0
    v_cvt_pk_bf16_f32 v28, v108, v109
    v_fma_f32 v110, v110, s28, v11
    v_fma_f32 v111, v111, s28, v11
    v_exp_f32 v110, v110
    v_exp_f32 v111, v111
    s_nop 0
    v_cvt_pk_bf16_f32 v29, v110, v111
    s_add_u32 s69, s39, 0
    buffer_load_dwordx4 v[44:47], v30, s[4:7], s69 offen offset:0
    s_waitcnt vmcnt(0)
    v_mfma_f32_16x16x32_bf16 v[104:107], v[44:47], a[168:171], 0
    s_nop 7
    buffer_load_dwordx4 v[44:47], v30, s[4:7], s69 offen offset:64
    s_waitcnt vmcnt(0)
    v_mfma_f32_16x16x32_bf16 v[104:107], v[44:47], a[172:175], v[104:107]
    s_nop 7
    buffer_load_dwordx4 v[44:47], v30, s[4:7], s69 offen offset:128
    s_waitcnt vmcnt(0)
    v_mfma_f32_16x16x32_bf16 v[104:107], v[44:47], a[176:179], v[104:107]
    s_nop 7
    buffer_load_dwordx4 v[44:47], v30, s[4:7], s69 offen offset:192
    s_waitcnt vmcnt(0)
    v_mfma_f32_16x16x32_bf16 v[104:107], v[44:47], a[180:183], v[104:107]
    s_nop 7
    buffer_load_dwordx4 v[44:47], v30, s[4:7], s69 offen offset:256
    s_waitcnt vmcnt(0)
    v_mfma_f32_16x16x32_bf16 v[104:107], v[44:47], a[184:187], v[104:107]
    s_nop 7
    buffer_load_dwordx4 v[44:47], v30, s[4:7], s69 offen offset:320
    s_waitcnt vmcnt(0)
    v_mfma_f32_16x16x32_bf16 v[104:107], v[44:47], a[188:191], v[104:107]
    s_nop 7
    s_add_u32 s69, s39, 6144
    buffer_load_dwordx4 v[44:47], v30, s[4:7], s69 offen offset:0
    s_waitcnt vmcnt(0)
    v_mfma_f32_16x16x32_bf16 v[108:111], v[44:47], a[168:171], 0
    s_nop 7
    buffer_load_dwordx4 v[44:47], v30, s[4:7], s69 offen offset:64
    s_waitcnt vmcnt(0)
    v_mfma_f32_16x16x32_bf16 v[108:111], v[44:47], a[172:175], v[108:111]
    s_nop 7
    buffer_load_dwordx4 v[44:47], v30, s[4:7], s69 offen offset:128
    s_waitcnt vmcnt(0)
    v_mfma_f32_16x16x32_bf16 v[108:111], v[44:47], a[176:179], v[108:111]
    s_nop 7
    buffer_load_dwordx4 v[44:47], v30, s[4:7], s69 offen offset:192
    s_waitcnt vmcnt(0)
    v_mfma_f32_16x16x32_bf16 v[108:111], v[44:47], a[180:183], v[108:111]
    s_nop 7
    buffer_load_dwordx4 v[44:47], v30, s[4:7], s69 offen offset:256
    s_waitcnt vmcnt(0)
    v_mfma_f32_16x16x32_bf16 v[108:111], v[44:47], a[184:187], v[108:111]
    s_nop 7
    buffer_load_dwordx4 v[44:47], v30, s[4:7], s69 offen offset:320
    s_waitcnt vmcnt(0)
    v_mfma_f32_16x16x32_bf16 v[108:111], v[44:47], a[188:191], v[108:111]
    s_nop 7
    s_nop 15
    v_max3_f32 v18, v104, v105, v106
    v_max3_f32 v18, v18, v107, v108
    v_max3_f32 v18, v18, v109, v110
    v_max_f32 v18, v18, v111
    v_mov_b32 v19, v18
    s_nop 1
    v_permlane32_swap_b32 v19, v18
    v_max_f32 v18, v18, v19
    v_mov_b32 v19, v18
    s_nop 1
    v_permlane16_swap_b32 v19, v18
    v_max_f32 v18, v18, v19
    v_fma_f32 v18, v18, s28, v12
    v_max_f32 v24, 0, v18
    v_sub_f32 v12, v12, v24
    v_sub_f32 v25, 0, v24
    v_exp_f32 v25, v25
    s_nop 0
    v_mul_f32 v51, v51, v25
    v_accvgpr_read_b32 v19, a0
    v_mul_f32 v19, v19, v25
    v_accvgpr_write_b32 a0, v19
    v_accvgpr_read_b32 v19, a1
    v_mul_f32 v19, v19, v25
    v_accvgpr_write_b32 a1, v19
    v_accvgpr_read_b32 v19, a2
    v_mul_f32 v19, v19, v25
    v_accvgpr_write_b32 a2, v19
    v_accvgpr_read_b32 v19, a3
    v_mul_f32 v19, v19, v25
    v_accvgpr_write_b32 a3, v19
    v_accvgpr_read_b32 v19, a4
    v_mul_f32 v19, v19, v25
    v_accvgpr_write_b32 a4, v19
    v_accvgpr_read_b32 v19, a5
    v_mul_f32 v19, v19, v25
    v_accvgpr_write_b32 a5, v19
    v_accvgpr_read_b32 v19, a6
    v_mul_f32 v19, v19, v25
    v_accvgpr_write_b32 a6, v19
    v_accvgpr_read_b32 v19, a7
    v_mul_f32 v19, v19, v25
    v_accvgpr_write_b32 a7, v19
    v_accvgpr_read_b32 v19, a8
    v_mul_f32 v19, v19, v25
    v_accvgpr_write_b32 a8, v19
    v_accvgpr_read_b32 v19, a9
    v_mul_f32 v19, v19, v25
    v_accvgpr_write_b32 a9, v19
    v_accvgpr_read_b32 v19, a10
    v_mul_f32 v19, v19, v25
    v_accvgpr_write_b32 a10, v19
    v_accvgpr_read_b32 v19, a11
    v_mul_f32 v19, v19, v25
    v_accvgpr_write_b32 a11, v19
    v_accvgpr_read_b32 v19, a12
    v_mul_f32 v19, v19, v25
    v_accvgpr_write_b32 a12, v19
    v_accvgpr_read_b32 v19, a13
    v_mul_f32 v19, v19, v25
    v_accvgpr_write_b32 a13, v19
    v_accvgpr_read_b32 v19, a14
    v_mul_f32 v19, v19, v25
    v_accvgpr_write_b32 a14, v19
    v_accvgpr_read_b32 v19, a15
    v_mul_f32 v19, v19, v25
    v_accvgpr_write_b32 a15, v19
    v_accvgpr_read_b32 v19, a16
    v_mul_f32 v19, v19, v25
    v_accvgpr_write_b32 a16, v19
    v_accvgpr_read_b32 v19, a17
    v_mul_f32 v19, v19, v25
    v_accvgpr_write_b32 a17, v19
    v_accvgpr_read_b32 v19, a18
    v_mul_f32 v19, v19, v25
    v_accvgpr_write_b32 a18, v19
    v_accvgpr_read_b32 v19, a19
    v_mul_f32 v19, v19, v25
    v_accvgpr_write_b32 a19, v19
    v_accvgpr_read_b32 v19, a20
    v_mul_f32 v19, v19, v25
    v_accvgpr_write_b32 a20, v19
    v_accvgpr_read_b32 v19, a21
    v_mul_f32 v19, v19, v25
    v_accvgpr_write_b32 a21, v19
    v_accvgpr_read_b32 v19, a22
    v_mul_f32 v19, v19, v25
    v_accvgpr_write_b32 a22, v19
    v_accvgpr_read_b32 v19, a23
    v_mul_f32 v19, v19, v25
    v_accvgpr_write_b32 a23, v19
    v_accvgpr_read_b32 v19, a24
    v_mul_f32 v19, v19, v25
    v_accvgpr_write_b32 a24, v19
    v_accvgpr_read_b32 v19, a25
    v_mul_f32 v19, v19, v25
    v_accvgpr_write_b32 a25, v19
    v_accvgpr_read_b32 v19, a26
    v_mul_f32 v19, v19, v25
    v_accvgpr_write_b32 a26, v19
    v_accvgpr_read_b32 v19, a27
    v_mul_f32 v19, v19, v25
    v_accvgpr_write_b32 a27, v19
    v_accvgpr_read_b32 v19, a28
    v_mul_f32 v19, v19, v25
    v_accvgpr_write_b32 a28, v19
    v_accvgpr_read_b32 v19, a29
    v_mul_f32 v19, v19, v25
    v_accvgpr_write_b32 a29, v19
    v_accvgpr_read_b32 v19, a30
    v_mul_f32 v19, v19, v25
    v_accvgpr_write_b32 a30, v19
    v_accvgpr_read_b32 v19, a31
    v_mul_f32 v19, v19, v25
    v_accvgpr_write_b32 a31, v19
    v_accvgpr_read_b32 v19, a32
    v_mul_f32 v19, v19, v25
    v_accvgpr_write_b32 a32, v19
    v_accvgpr_read_b32 v19, a33
    v_mul_f32 v19, v19, v25
    v_accvgpr_write_b32 a33, v19
    v_accvgpr_read_b32 v19, a34
    v_mul_f32 v19, v19, v25
    v_accvgpr_write_b32 a34, v19
    v_accvgpr_read_b32 v19, a35
    v_mul_f32 v19, v19, v25
    v_accvgpr_write_b32 a35, v19
    v_accvgpr_read_b32 v19, a36
    v_mul_f32 v19, v19, v25
    v_accvgpr_write_b32 a36, v19
    v_accvgpr_read_b32 v19, a37
    v_mul_f32 v19, v19, v25
    v_accvgpr_write_b32 a37, v19
    v_accvgpr_read_b32 v19, a38
    v_mul_f32 v19, v19, v25
    v_accvgpr_write_b32 a38, v19
    v_accvgpr_read_b32 v19, a39
    v_mul_f32 v19, v19, v25
    v_accvgpr_write_b32 a39, v19
    v_accvgpr_read_b32 v19, a40
    v_mul_f32 v19, v19, v25
    v_accvgpr_write_b32 a40, v19
    v_accvgpr_read_b32 v19, a41
    v_mul_f32 v19, v19, v25
    v_accvgpr_write_b32 a41, v19
    v_accvgpr_read_b32 v19, a42
    v_mul_f32 v19, v19, v25
    v_accvgpr_write_b32 a42, v19
    v_accvgpr_read_b32 v19, a43
    v_mul_f32 v19, v19, v25
    v_accvgpr_write_b32 a43, v19
    v_accvgpr_read_b32 v19, a44
    v_mul_f32 v19, v19, v25
    v_accvgpr_write_b32 a44, v19
    v_accvgpr_read_b32 v19, a45
    v_mul_f32 v19, v19, v25
    v_accvgpr_write_b32 a45, v19
    v_accvgpr_read_b32 v19, a46
    v_mul_f32 v19, v19, v25
    v_accvgpr_write_b32 a46, v19
    v_accvgpr_read_b32 v19, a47
    v_mul_f32 v19, v19, v25
    v_accvgpr_write_b32 a47, v19
    v_fma_f32 v104, v104, s28, v12
    v_fma_f32 v105, v105, s28, v12
    v_exp_f32 v104, v104
    v_exp_f32 v105, v105
    s_nop 0
    v_cvt_pk_bf16_f32 v32, v104, v105
    v_fma_f32 v106, v106, s28, v12
    v_fma_f32 v107, v107, s28, v12
    v_exp_f32 v106, v106
    v_exp_f32 v107, v107
    s_nop 0
    v_cvt_pk_bf16_f32 v33, v106, v107
    v_fma_f32 v108, v108, s28, v12
    v_fma_f32 v109, v109, s28, v12
    v_exp_f32 v108, v108
    v_exp_f32 v109, v109
    s_nop 0
    v_cvt_pk_bf16_f32 v34, v108, v109
    v_fma_f32 v110, v110, s28, v12
    v_fma_f32 v111, v111, s28, v12
    v_exp_f32 v110, v110
    v_exp_f32 v111, v111
    s_nop 0
    v_cvt_pk_bf16_f32 v35, v110, v111
    v_mfma_f32_16x16x32_bf16 v[44:47], a[236:239], v[14:17], v[48:51]
    v_mfma_f32_16x16x32_bf16 v[44:47], a[240:243], v[20:23], v[44:47]
    v_mfma_f32_16x16x32_bf16 v[44:47], a[244:247], v[26:29], v[44:47]
    v_mfma_f32_16x16x32_bf16 v[44:47], a[248:251], v[32:35], v[44:47]
    s_nop 15
    s_setpc_b64 s[40:41]
L_rare4_1:
    s_nop 15
    v_mbcnt_lo_u32_b32 v27, -1, 0
    v_mbcnt_hi_u32_b32 v27, -1, v27
    v_and_b32 v26, 15, v27
    v_mul_u32_u24 v26, 384, v26
    v_lshrrev_b32 v27, 4, v27
    v_lshl_add_u32 v26, v27, 4, v26
    s_add_u32 s69, s39, 0
    buffer_load_dwordx4 v[48:51], v26, s[4:7], s69 offen offset:0
    s_waitcnt vmcnt(0)
    v_mfma_f32_16x16x32_bf16 v[104:107], v[48:51], a[96:99], 0
    s_nop 7
    buffer_load_dwordx4 v[48:51], v26, s[4:7], s69 offen offset:64
    s_waitcnt vmcnt(0)
    v_mfma_f32_16x16x32_bf16 v[104:107], v[48:51], a[100:103], v[104:107]
    s_nop 7
    buffer_load_dwordx4 v[48:51], v26, s[4:7], s69 offen offset:128
    s_waitcnt vmcnt(0)
    v_mfma_f32_16x16x32_bf16 v[104:107], v[48:51], a[104:107], v[104:107]
    s_nop 7
    buffer_load_dwordx4 v[48:51], v26, s[4:7], s69 offen offset:192
    s_waitcnt vmcnt(0)
    v_mfma_f32_16x16x32_bf16 v[104:107], v[48:51], a[108:111], v[104:107]
    s_nop 7
    buffer_load_dwordx4 v[48:51], v26, s[4:7], s69 offen offset:256
    s_waitcnt vmcnt(0)
    v_mfma_f32_16x16x32_bf16 v[104:107], v[48:51], a[112:115], v[104:107]
    s_nop 7
    buffer_load_dwordx4 v[48:51], v26, s[4:7], s69 offen offset:320
    s_waitcnt vmcnt(0)
    v_mfma_f32_16x16x32_bf16 v[104:107], v[48:51], a[116:119], v[104:107]
    s_nop 7
    s_add_u32 s69, s39, 6144
    buffer_load_dwordx4 v[48:51], v26, s[4:7], s69 offen offset:0
    s_waitcnt vmcnt(0)
    v_mfma_f32_16x16x32_bf16 v[108:111], v[48:51], a[96:99], 0
    s_nop 7
    buffer_load_dwordx4 v[48:51], v26, s[4:7], s69 offen offset:64
    s_waitcnt vmcnt(0)
    v_mfma_f32_16x16x32_bf16 v[108:111], v[48:51], a[100:103], v[108:111]
    s_nop 7
    buffer_load_dwordx4 v[48:51], v26, s[4:7], s69 offen offset:128
    s_waitcnt vmcnt(0)
    v_mfma_f32_16x16x32_bf16 v[108:111], v[48:51], a[104:107], v[108:111]
    s_nop 7
    buffer_load_dwordx4 v[48:51], v26, s[4:7], s69 offen offset:192
    s_waitcnt vmcnt(0)
    v_mfma_f32_16x16x32_bf16 v[108:111], v[48:51], a[108:111], v[108:111]
    s_nop 7
    buffer_load_dwordx4 v[48:51], v26, s[4:7], s69 offen offset:256
    s_waitcnt vmcnt(0)
    v_mfma_f32_16x16x32_bf16 v[108:111], v[48:51], a[112:115], v[108:111]
    s_nop 7
    buffer_load_dwordx4 v[48:51], v26, s[4:7], s69 offen offset:320
    s_waitcnt vmcnt(0)
    v_mfma_f32_16x16x32_bf16 v[108:111], v[48:51], a[116:119], v[108:111]
    s_nop 7
    s_nop 15
    v_max3_f32 v14, v104, v105, v106
    v_max3_f32 v14, v14, v107, v108
    v_max3_f32 v14, v14, v109, v110
    v_max_f32 v14, v14, v111
    v_mov_b32 v15, v14
    s_nop 1
    v_permlane32_swap_b32 v15, v14
    v_max_f32 v14, v14, v15
    v_mov_b32 v15, v14
    s_nop 1
    v_permlane16_swap_b32 v15, v14
    v_max_f32 v14, v14, v15
    v_fma_f32 v14, v14, s28, v9
    v_max_f32 v20, 0, v14
    v_sub_f32 v9, v9, v20
    v_sub_f32 v21, 0, v20
    v_exp_f32 v21, v21
    s_nop 0
    v_mul_f32 v15, v44, v21
    v_cndmask_b32_e64 v44, v15, v44, s[60:61]
    v_cndmask_b32_e64 v44, v44, 0, s[46:47]
    v_mul_f32 v112, v112, v21
    v_mul_f32 v113, v113, v21
    v_mul_f32 v114, v114, v21
    v_mul_f32 v115, v115, v21
    v_mul_f32 v116, v116, v21
    v_mul_f32 v117, v117, v21
    v_mul_f32 v118, v118, v21
    v_mul_f32 v119, v119, v21
    v_mul_f32 v120, v120, v21
    v_mul_f32 v121, v121, v21
    v_mul_f32 v122, v122, v21
    v_mul_f32 v123, v123, v21
    v_mul_f32 v124, v124, v21
    v_mul_f32 v125, v125, v21
    v_mul_f32 v126, v126, v21
    v_mul_f32 v127, v127, v21
    v_mul_f32 v128, v128, v21
    v_mul_f32 v129, v129, v21
    v_mul_f32 v130, v130, v21
    v_mul_f32 v131, v131, v21
    v_mul_f32 v132, v132, v21
    v_mul_f32 v133, v133, v21
    v_mul_f32 v134, v134, v21
    v_mul_f32 v135, v135, v21
    v_mul_f32 v136, v136, v21
    v_mul_f32 v137, v137, v21
    v_mul_f32 v138, v138, v21
    v_mul_f32 v139, v139, v21
    v_mul_f32 v140, v140, v21
    v_mul_f32 v141, v141, v21
    v_mul_f32 v142, v142, v21
    v_mul_f32 v143, v143, v21
    v_mul_f32 v144, v144, v21
    v_mul_f32 v145, v145, v21
    v_mul_f32 v146, v146, v21
    v_mul_f32 v147, v147, v21
    v_mul_f32 v148, v148, v21
    v_mul_f32 v149, v149, v21
    v_mul_f32 v150, v150, v21
    v_mul_f32 v151, v151, v21
    v_mul_f32 v152, v152, v21
    v_mul_f32 v153, v153, v21
    v_mul_f32 v154, v154, v21
    v_mul_f32 v155, v155, v21
    v_mul_f32 v156, v156, v21
    v_mul_f32 v157, v157, v21
    v_mul_f32 v158, v158, v21
    v_mul_f32 v159, v159, v21
    v_fma_f32 v104, v104, s28, v9
    v_fma_f32 v105, v105, s28, v9
    v_exp_f32 v104, v104
    v_exp_f32 v105, v105
    s_nop 0
    v_cvt_pk_bf16_f32 v18, v104, v105
    v_fma_f32 v106, v106, s28, v9
    v_fma_f32 v107, v107, s28, v9
    v_exp_f32 v106, v106
    v_exp_f32 v107, v107
    s_nop 0
    v_cvt_pk_bf16_f32 v19, v106, v107
    v_fma_f32 v108, v108, s28, v9
    v_fma_f32 v109, v109, s28, v9
    v_exp_f32 v108, v108
    v_exp_f32 v109, v109
    s_nop 0
    v_cvt_pk_bf16_f32 v16, v108, v109
    v_fma_f32 v110, v110, s28, v9
    v_fma_f32 v111, v111, s28, v9
    v_exp_f32 v110, v110
    v_exp_f32 v111, v111
    s_nop 0
    v_cvt_pk_bf16_f32 v17, v110, v111
    s_add_u32 s69, s39, 0
    buffer_load_dwordx4 v[48:51], v26, s[4:7], s69 offen offset:0
    s_waitcnt vmcnt(0)
    v_mfma_f32_16x16x32_bf16 v[104:107], v[48:51], a[120:123], 0
    s_nop 7
    buffer_load_dwordx4 v[48:51], v26, s[4:7], s69 offen offset:64
    s_waitcnt vmcnt(0)
    v_mfma_f32_16x16x32_bf16 v[104:107], v[48:51], a[124:127], v[104:107]
    s_nop 7
    buffer_load_dwordx4 v[48:51], v26, s[4:7], s69 offen offset:128
    s_waitcnt vmcnt(0)
    v_mfma_f32_16x16x32_bf16 v[104:107], v[48:51], a[128:131], v[104:107]
    s_nop 7
    buffer_load_dwordx4 v[48:51], v26, s[4:7], s69 offen offset:192
    s_waitcnt vmcnt(0)
    v_mfma_f32_16x16x32_bf16 v[104:107], v[48:51], a[132:135], v[104:107]
    s_nop 7
    buffer_load_dwordx4 v[48:51], v26, s[4:7], s69 offen offset:256
    s_waitcnt vmcnt(0)
    v_mfma_f32_16x16x32_bf16 v[104:107], v[48:51], a[136:139], v[104:107]
    s_nop 7
    buffer_load_dwordx4 v[48:51], v26, s[4:7], s69 offen offset:320
    s_waitcnt vmcnt(0)
    v_mfma_f32_16x16x32_bf16 v[104:107], v[48:51], a[140:143], v[104:107]
    s_nop 7
    s_add_u32 s69, s39, 6144
    buffer_load_dwordx4 v[48:51], v26, s[4:7], s69 offen offset:0
    s_waitcnt vmcnt(0)
    v_mfma_f32_16x16x32_bf16 v[108:111], v[48:51], a[120:123], 0
    s_nop 7
    buffer_load_dwordx4 v[48:51], v26, s[4:7], s69 offen offset:64
    s_waitcnt vmcnt(0)
    v_mfma_f32_16x16x32_bf16 v[108:111], v[48:51], a[124:127], v[108:111]
    s_nop 7
    buffer_load_dwordx4 v[48:51], v26, s[4:7], s69 offen offset:128
    s_waitcnt vmcnt(0)
    v_mfma_f32_16x16x32_bf16 v[108:111], v[48:51], a[128:131], v[108:111]
    s_nop 7
    buffer_load_dwordx4 v[48:51], v26, s[4:7], s69 offen offset:192
    s_waitcnt vmcnt(0)
    v_mfma_f32_16x16x32_bf16 v[108:111], v[48:51], a[132:135], v[108:111]
    s_nop 7
    buffer_load_dwordx4 v[48:51], v26, s[4:7], s69 offen offset:256
    s_waitcnt vmcnt(0)
    v_mfma_f32_16x16x32_bf16 v[108:111], v[48:51], a[136:139], v[108:111]
    s_nop 7
    buffer_load_dwordx4 v[48:51], v26, s[4:7], s69 offen offset:320
    s_waitcnt vmcnt(0)
    v_mfma_f32_16x16x32_bf16 v[108:111], v[48:51], a[140:143], v[108:111]
    s_nop 7
    s_nop 15
    v_max3_f32 v14, v104, v105, v106
    v_max3_f32 v14, v14, v107, v108
    v_max3_f32 v14, v14, v109, v110
    v_max_f32 v14, v14, v111
    v_mov_b32 v15, v14
    s_nop 1
    v_permlane32_swap_b32 v15, v14
    v_max_f32 v14, v14, v15
    v_mov_b32 v15, v14
    s_nop 1
    v_permlane16_swap_b32 v15, v14
    v_max_f32 v14, v14, v15
    v_fma_f32 v14, v14, s28, v10
    v_max_f32 v20, 0, v14
    v_sub_f32 v10, v10, v20
    v_sub_f32 v21, 0, v20
    v_exp_f32 v21, v21
    s_nop 0
    v_mul_f32 v45, v45, v21
    v_mul_f32 v160, v160, v21
    v_mul_f32 v161, v161, v21
    v_mul_f32 v162, v162, v21
    v_mul_f32 v163, v163, v21
    v_mul_f32 v164, v164, v21
    v_mul_f32 v165, v165, v21
    v_mul_f32 v166, v166, v21
    v_mul_f32 v167, v167, v21
    v_mul_f32 v168, v168, v21
    v_mul_f32 v169, v169, v21
    v_mul_f32 v170, v170, v21
    v_mul_f32 v171, v171, v21
    v_mul_f32 v172, v172, v21
    v_mul_f32 v173, v173, v21
    v_mul_f32 v174, v174, v21
    v_mul_f32 v175, v175, v21
    v_mul_f32 v176, v176, v21
    v_mul_f32 v177, v177, v21
    v_mul_f32 v178, v178, v21
    v_mul_f32 v179, v179, v21
    v_mul_f32 v180, v180, v21
    v_mul_f32 v181, v181, v21
    v_mul_f32 v182, v182, v21
    v_mul_f32 v183, v183, v21
    v_mul_f32 v184, v184, v21
    v_mul_f32 v185, v185, v21
    v_mul_f32 v186, v186, v21
    v_mul_f32 v187, v187, v21
    v_mul_f32 v188, v188, v21
    v_mul_f32 v189, v189, v21
    v_mul_f32 v190, v190, v21
    v_mul_f32 v191, v191, v21
    v_mul_f32 v192, v192, v21
    v_mul_f32 v193, v193, v21
    v_mul_f32 v194, v194, v21
    v_mul_f32 v195, v195, v21
    v_mul_f32 v196, v196, v21
    v_mul_f32 v197, v197, v21
    v_mul_f32 v198, v198, v21
    v_mul_f32 v199, v199, v21
    v_mul_f32 v200, v200, v21
    v_mul_f32 v201, v201, v21
    v_mul_f32 v202, v202, v21
    v_mul_f32 v203, v203, v21
    v_mul_f32 v204, v204, v21
    v_mul_f32 v205, v205, v21
    v_mul_f32 v206, v206, v21
    v_mul_f32 v207, v207, v21
    v_fma_f32 v104, v104, s28, v10
    v_fma_f32 v105, v105, s28, v10
    v_exp_f32 v104, v104
    v_exp_f32 v105, v105
    s_nop 0
    v_cvt_pk_bf16_f32 v24, v104, v105
    v_fma_f32 v106, v106, s28, v10
    v_fma_f32 v107, v107, s28, v10
    v_exp_f32 v106, v106
    v_exp_f32 v107, v107
    s_nop 0
    v_cvt_pk_bf16_f32 v25, v106, v107
    v_fma_f32 v108, v108, s28, v10
    v_fma_f32 v109, v109, s28, v10
    v_exp_f32 v108, v108
    v_exp_f32 v109, v109
    s_nop 0
    v_cvt_pk_bf16_f32 v22, v108, v109
    v_fma_f32 v110, v110, s28, v10
    v_fma_f32 v111, v111, s28, v10
    v_exp_f32 v110, v110
    v_exp_f32 v111, v111
    s_nop 0
    v_cvt_pk_bf16_f32 v23, v110, v111
    s_add_u32 s69, s39, 0
    buffer_load_dwordx4 v[48:51], v26, s[4:7], s69 offen offset:0
    s_waitcnt vmcnt(0)
    v_mfma_f32_16x16x32_bf16 v[104:107], v[48:51], a[144:147], 0
    s_nop 7
    buffer_load_dwordx4 v[48:51], v26, s[4:7], s69 offen offset:64
    s_waitcnt vmcnt(0)
    v_mfma_f32_16x16x32_bf16 v[104:107], v[48:51], a[148:151], v[104:107]
    s_nop 7
    buffer_load_dwordx4 v[48:51], v26, s[4:7], s69 offen offset:128
    s_waitcnt vmcnt(0)
    v_mfma_f32_16x16x32_bf16 v[104:107], v[48:51], a[152:155], v[104:107]
    s_nop 7
    buffer_load_dwordx4 v[48:51], v26, s[4:7], s69 offen offset:192
    s_waitcnt vmcnt(0)
    v_mfma_f32_16x16x32_bf16 v[104:107], v[48:51], a[156:159], v[104:107]
    s_nop 7
    buffer_load_dwordx4 v[48:51], v26, s[4:7], s69 offen offset:256
    s_waitcnt vmcnt(0)
    v_mfma_f32_16x16x32_bf16 v[104:107], v[48:51], a[160:163], v[104:107]
    s_nop 7
    buffer_load_dwordx4 v[48:51], v26, s[4:7], s69 offen offset:320
    s_waitcnt vmcnt(0)
    v_mfma_f32_16x16x32_bf16 v[104:107], v[48:51], a[164:167], v[104:107]
    s_nop 7
    s_add_u32 s69, s39, 6144
    buffer_load_dwordx4 v[48:51], v26, s[4:7], s69 offen offset:0
    s_waitcnt vmcnt(0)
    v_mfma_f32_16x16x32_bf16 v[108:111], v[48:51], a[144:147], 0
    s_nop 7
    buffer_load_dwordx4 v[48:51], v26, s[4:7], s69 offen offset:64
    s_waitcnt vmcnt(0)
    v_mfma_f32_16x16x32_bf16 v[108:111], v[48:51], a[148:151], v[108:111]
    s_nop 7
    buffer_load_dwordx4 v[48:51], v26, s[4:7], s69 offen offset:128
    s_waitcnt vmcnt(0)
    v_mfma_f32_16x16x32_bf16 v[108:111], v[48:51], a[152:155], v[108:111]
    s_nop 7
    buffer_load_dwordx4 v[48:51], v26, s[4:7], s69 offen offset:192
    s_waitcnt vmcnt(0)
    v_mfma_f32_16x16x32_bf16 v[108:111], v[48:51], a[156:159], v[108:111]
    s_nop 7
    buffer_load_dwordx4 v[48:51], v26, s[4:7], s69 offen offset:256
    s_waitcnt vmcnt(0)
    v_mfma_f32_16x16x32_bf16 v[108:111], v[48:51], a[160:163], v[108:111]
    s_nop 7
    buffer_load_dwordx4 v[48:51], v26, s[4:7], s69 offen offset:320
    s_waitcnt vmcnt(0)
    v_mfma_f32_16x16x32_bf16 v[108:111], v[48:51], a[164:167], v[108:111]
    s_nop 7
    s_nop 15
    v_max3_f32 v14, v104, v105, v106
    v_max3_f32 v14, v14, v107, v108
    v_max3_f32 v14, v14, v109, v110
    v_max_f32 v14, v14, v111
    v_mov_b32 v15, v14
    s_nop 1
    v_permlane32_swap_b32 v15, v14
    v_max_f32 v14, v14, v15
    v_mov_b32 v15, v14
    s_nop 1
    v_permlane16_swap_b32 v15, v14
    v_max_f32 v14, v14, v15
    v_fma_f32 v14, v14, s28, v11
    v_max_f32 v20, 0, v14
    v_sub_f32 v11, v11, v20
    v_sub_f32 v21, 0, v20
    v_exp_f32 v21, v21
    s_nop 0
    v_mul_f32 v46, v46, v21
    v_mul_f32 v208, v208, v21
    v_mul_f32 v209, v209, v21
    v_mul_f32 v210, v210, v21
    v_mul_f32 v211, v211, v21
    v_mul_f32 v212, v212, v21
    v_mul_f32 v213, v213, v21
    v_mul_f32 v214, v214, v21
    v_mul_f32 v215, v215, v21
    v_mul_f32 v216, v216, v21
    v_mul_f32 v217, v217, v21
    v_mul_f32 v218, v218, v21
    v_mul_f32 v219, v219, v21
    v_mul_f32 v220, v220, v21
    v_mul_f32 v221, v221, v21
    v_mul_f32 v222, v222, v21
    v_mul_f32 v223, v223, v21
    v_mul_f32 v224, v224, v21
    v_mul_f32 v225, v225, v21
    v_mul_f32 v226, v226, v21
    v_mul_f32 v227, v227, v21
    v_mul_f32 v228, v228, v21
    v_mul_f32 v229, v229, v21
    v_mul_f32 v230, v230, v21
    v_mul_f32 v231, v231, v21
    v_mul_f32 v232, v232, v21
    v_mul_f32 v233, v233, v21
    v_mul_f32 v234, v234, v21
    v_mul_f32 v235, v235, v21
    v_mul_f32 v236, v236, v21
    v_mul_f32 v237, v237, v21
    v_mul_f32 v238, v238, v21
    v_mul_f32 v239, v239, v21
    v_mul_f32 v240, v240, v21
    v_mul_f32 v241, v241, v21
    v_mul_f32 v242, v242, v21
    v_mul_f32 v243, v243, v21
    v_mul_f32 v244, v244, v21
    v_mul_f32 v245, v245, v21
    v_mul_f32 v246, v246, v21
    v_mul_f32 v247, v247, v21
    v_mul_f32 v248, v248, v21
    v_mul_f32 v249, v249, v21
    v_mul_f32 v250, v250, v21
    v_mul_f32 v251, v251, v21
    v_mul_f32 v252, v252, v21
    v_mul_f32 v253, v253, v21
    v_mul_f32 v254, v254, v21
    v_mul_f32 v255, v255, v21
    v_fma_f32 v104, v104, s28, v11
    v_fma_f32 v105, v105, s28, v11
    v_exp_f32 v104, v104
    v_exp_f32 v105, v105
    s_nop 0
    v_cvt_pk_bf16_f32 v30, v104, v105
    v_fma_f32 v106, v106, s28, v11
    v_fma_f32 v107, v107, s28, v11
    v_exp_f32 v106, v106
    v_exp_f32 v107, v107
    s_nop 0
    v_cvt_pk_bf16_f32 v31, v106, v107
    v_fma_f32 v108, v108, s28, v11
    v_fma_f32 v109, v109, s28, v11
    v_exp_f32 v108, v108
    v_exp_f32 v109, v109
    s_nop 0
    v_cvt_pk_bf16_f32 v28, v108, v109
    v_fma_f32 v110, v110, s28, v11
    v_fma_f32 v111, v111, s28, v11
    v_exp_f32 v110, v110
    v_exp_f32 v111, v111
    s_nop 0
    v_cvt_pk_bf16_f32 v29, v110, v111
    s_add_u32 s69, s39, 0
    buffer_load_dwordx4 v[48:51], v26, s[4:7], s69 offen offset:0
    s_waitcnt vmcnt(0)
    v_mfma_f32_16x16x32_bf16 v[104:107], v[48:51], a[168:171], 0
    s_nop 7
    buffer_load_dwordx4 v[48:51], v26, s[4:7], s69 offen offset:64
    s_waitcnt vmcnt(0)
    v_mfma_f32_16x16x32_bf16 v[104:107], v[48:51], a[172:175], v[104:107]
    s_nop 7
    buffer_load_dwordx4 v[48:51], v26, s[4:7], s69 offen offset:128
    s_waitcnt vmcnt(0)
    v_mfma_f32_16x16x32_bf16 v[104:107], v[48:51], a[176:179], v[104:107]
    s_nop 7
    buffer_load_dwordx4 v[48:51], v26, s[4:7], s69 offen offset:192
    s_waitcnt vmcnt(0)
    v_mfma_f32_16x16x32_bf16 v[104:107], v[48:51], a[180:183], v[104:107]
    s_nop 7
    buffer_load_dwordx4 v[48:51], v26, s[4:7], s69 offen offset:256
    s_waitcnt vmcnt(0)
    v_mfma_f32_16x16x32_bf16 v[104:107], v[48:51], a[184:187], v[104:107]
    s_nop 7
    buffer_load_dwordx4 v[48:51], v26, s[4:7], s69 offen offset:320
    s_waitcnt vmcnt(0)
    v_mfma_f32_16x16x32_bf16 v[104:107], v[48:51], a[188:191], v[104:107]
    s_nop 7
    s_add_u32 s69, s39, 6144
    buffer_load_dwordx4 v[48:51], v26, s[4:7], s69 offen offset:0
    s_waitcnt vmcnt(0)
    v_mfma_f32_16x16x32_bf16 v[108:111], v[48:51], a[168:171], 0
    s_nop 7
    buffer_load_dwordx4 v[48:51], v26, s[4:7], s69 offen offset:64
    s_waitcnt vmcnt(0)
    v_mfma_f32_16x16x32_bf16 v[108:111], v[48:51], a[172:175], v[108:111]
    s_nop 7
    buffer_load_dwordx4 v[48:51], v26, s[4:7], s69 offen offset:128
    s_waitcnt vmcnt(0)
    v_mfma_f32_16x16x32_bf16 v[108:111], v[48:51], a[176:179], v[108:111]
    s_nop 7
    buffer_load_dwordx4 v[48:51], v26, s[4:7], s69 offen offset:192
    s_waitcnt vmcnt(0)
    v_mfma_f32_16x16x32_bf16 v[108:111], v[48:51], a[180:183], v[108:111]
    s_nop 7
    buffer_load_dwordx4 v[48:51], v26, s[4:7], s69 offen offset:256
    s_waitcnt vmcnt(0)
    v_mfma_f32_16x16x32_bf16 v[108:111], v[48:51], a[184:187], v[108:111]
    s_nop 7
    buffer_load_dwordx4 v[48:51], v26, s[4:7], s69 offen offset:320
    s_waitcnt vmcnt(0)
    v_mfma_f32_16x16x32_bf16 v[108:111], v[48:51], a[188:191], v[108:111]
    s_nop 7
    s_nop 15
    v_max3_f32 v14, v104, v105, v106
    v_max3_f32 v14, v14, v107, v108
    v_max3_f32 v14, v14, v109, v110
    v_max_f32 v14, v14, v111
    v_mov_b32 v15, v14
    s_nop 1
    v_permlane32_swap_b32 v15, v14
    v_max_f32 v14, v14, v15
    v_mov_b32 v15, v14
    s_nop 1
    v_permlane16_swap_b32 v15, v14
    v_max_f32 v14, v14, v15
    v_fma_f32 v14, v14, s28, v12
    v_max_f32 v20, 0, v14
    v_sub_f32 v12, v12, v20
    v_sub_f32 v21, 0, v20
    v_exp_f32 v21, v21
    s_nop 0
    v_mul_f32 v47, v47, v21
    v_accvgpr_read_b32 v15, a0
    v_mul_f32 v15, v15, v21
    v_accvgpr_write_b32 a0, v15
    v_accvgpr_read_b32 v15, a1
    v_mul_f32 v15, v15, v21
    v_accvgpr_write_b32 a1, v15
    v_accvgpr_read_b32 v15, a2
    v_mul_f32 v15, v15, v21
    v_accvgpr_write_b32 a2, v15
    v_accvgpr_read_b32 v15, a3
    v_mul_f32 v15, v15, v21
    v_accvgpr_write_b32 a3, v15
    v_accvgpr_read_b32 v15, a4
    v_mul_f32 v15, v15, v21
    v_accvgpr_write_b32 a4, v15
    v_accvgpr_read_b32 v15, a5
    v_mul_f32 v15, v15, v21
    v_accvgpr_write_b32 a5, v15
    v_accvgpr_read_b32 v15, a6
    v_mul_f32 v15, v15, v21
    v_accvgpr_write_b32 a6, v15
    v_accvgpr_read_b32 v15, a7
    v_mul_f32 v15, v15, v21
    v_accvgpr_write_b32 a7, v15
    v_accvgpr_read_b32 v15, a8
    v_mul_f32 v15, v15, v21
    v_accvgpr_write_b32 a8, v15
    v_accvgpr_read_b32 v15, a9
    v_mul_f32 v15, v15, v21
    v_accvgpr_write_b32 a9, v15
    v_accvgpr_read_b32 v15, a10
    v_mul_f32 v15, v15, v21
    v_accvgpr_write_b32 a10, v15
    v_accvgpr_read_b32 v15, a11
    v_mul_f32 v15, v15, v21
    v_accvgpr_write_b32 a11, v15
    v_accvgpr_read_b32 v15, a12
    v_mul_f32 v15, v15, v21
    v_accvgpr_write_b32 a12, v15
    v_accvgpr_read_b32 v15, a13
    v_mul_f32 v15, v15, v21
    v_accvgpr_write_b32 a13, v15
    v_accvgpr_read_b32 v15, a14
    v_mul_f32 v15, v15, v21
    v_accvgpr_write_b32 a14, v15
    v_accvgpr_read_b32 v15, a15
    v_mul_f32 v15, v15, v21
    v_accvgpr_write_b32 a15, v15
    v_accvgpr_read_b32 v15, a16
    v_mul_f32 v15, v15, v21
    v_accvgpr_write_b32 a16, v15
    v_accvgpr_read_b32 v15, a17
    v_mul_f32 v15, v15, v21
    v_accvgpr_write_b32 a17, v15
    v_accvgpr_read_b32 v15, a18
    v_mul_f32 v15, v15, v21
    v_accvgpr_write_b32 a18, v15
    v_accvgpr_read_b32 v15, a19
    v_mul_f32 v15, v15, v21
    v_accvgpr_write_b32 a19, v15
    v_accvgpr_read_b32 v15, a20
    v_mul_f32 v15, v15, v21
    v_accvgpr_write_b32 a20, v15
    v_accvgpr_read_b32 v15, a21
    v_mul_f32 v15, v15, v21
    v_accvgpr_write_b32 a21, v15
    v_accvgpr_read_b32 v15, a22
    v_mul_f32 v15, v15, v21
    v_accvgpr_write_b32 a22, v15
    v_accvgpr_read_b32 v15, a23
    v_mul_f32 v15, v15, v21
    v_accvgpr_write_b32 a23, v15
    v_accvgpr_read_b32 v15, a24
    v_mul_f32 v15, v15, v21
    v_accvgpr_write_b32 a24, v15
    v_accvgpr_read_b32 v15, a25
    v_mul_f32 v15, v15, v21
    v_accvgpr_write_b32 a25, v15
    v_accvgpr_read_b32 v15, a26
    v_mul_f32 v15, v15, v21
    v_accvgpr_write_b32 a26, v15
    v_accvgpr_read_b32 v15, a27
    v_mul_f32 v15, v15, v21
    v_accvgpr_write_b32 a27, v15
    v_accvgpr_read_b32 v15, a28
    v_mul_f32 v15, v15, v21
    v_accvgpr_write_b32 a28, v15
    v_accvgpr_read_b32 v15, a29
    v_mul_f32 v15, v15, v21
    v_accvgpr_write_b32 a29, v15
    v_accvgpr_read_b32 v15, a30
    v_mul_f32 v15, v15, v21
    v_accvgpr_write_b32 a30, v15
    v_accvgpr_read_b32 v15, a31
    v_mul_f32 v15, v15, v21
    v_accvgpr_write_b32 a31, v15
    v_accvgpr_read_b32 v15, a32
    v_mul_f32 v15, v15, v21
    v_accvgpr_write_b32 a32, v15
    v_accvgpr_read_b32 v15, a33
    v_mul_f32 v15, v15, v21
    v_accvgpr_write_b32 a33, v15
    v_accvgpr_read_b32 v15, a34
    v_mul_f32 v15, v15, v21
    v_accvgpr_write_b32 a34, v15
    v_accvgpr_read_b32 v15, a35
    v_mul_f32 v15, v15, v21
    v_accvgpr_write_b32 a35, v15
    v_accvgpr_read_b32 v15, a36
    v_mul_f32 v15, v15, v21
    v_accvgpr_write_b32 a36, v15
    v_accvgpr_read_b32 v15, a37
    v_mul_f32 v15, v15, v21
    v_accvgpr_write_b32 a37, v15
    v_accvgpr_read_b32 v15, a38
    v_mul_f32 v15, v15, v21
    v_accvgpr_write_b32 a38, v15
    v_accvgpr_read_b32 v15, a39
    v_mul_f32 v15, v15, v21
    v_accvgpr_write_b32 a39, v15
    v_accvgpr_read_b32 v15, a40
    v_mul_f32 v15, v15, v21
    v_accvgpr_write_b32 a40, v15
    v_accvgpr_read_b32 v15, a41
    v_mul_f32 v15, v15, v21
    v_accvgpr_write_b32 a41, v15
    v_accvgpr_read_b32 v15, a42
    v_mul_f32 v15, v15, v21
    v_accvgpr_write_b32 a42, v15
    v_accvgpr_read_b32 v15, a43
    v_mul_f32 v15, v15, v21
    v_accvgpr_write_b32 a43, v15
    v_accvgpr_read_b32 v15, a44
    v_mul_f32 v15, v15, v21
    v_accvgpr_write_b32 a44, v15
    v_accvgpr_read_b32 v15, a45
    v_mul_f32 v15, v15, v21
    v_accvgpr_write_b32 a45, v15
    v_accvgpr_read_b32 v15, a46
    v_mul_f32 v15, v15, v21
    v_accvgpr_write_b32 a46, v15
    v_accvgpr_read_b32 v15, a47
    v_mul_f32 v15, v15, v21
    v_accvgpr_write_b32 a47, v15
    v_fma_f32 v104, v104, s28, v12
    v_fma_f32 v105, v105, s28, v12
    v_exp_f32 v104, v104
    v_exp_f32 v105, v105
    s_nop 0
    v_cvt_pk_bf16_f32 v36, v104, v105
    v_fma_f32 v106, v106, s28, v12
    v_fma_f32 v107, v107, s28, v12
    v_exp_f32 v106, v106
    v_exp_f32 v107, v107
    s_nop 0
    v_cvt_pk_bf16_f32 v37, v106, v107
    v_fma_f32 v108, v108, s28, v12
    v_fma_f32 v109, v109, s28, v12
    v_exp_f32 v108, v108
    v_exp_f32 v109, v109
    s_nop 0
    v_cvt_pk_bf16_f32 v34, v108, v109
    v_fma_f32 v110, v110, s28, v12
    v_fma_f32 v111, v111, s28, v12
    v_exp_f32 v110, v110
    v_exp_f32 v111, v111
    s_nop 0
    v_cvt_pk_bf16_f32 v35, v110, v111
    v_mfma_f32_16x16x32_bf16 v[48:51], a[236:239], v[16:19], v[44:47]
    v_mfma_f32_16x16x32_bf16 v[48:51], a[240:243], v[22:25], v[48:51]
    v_mfma_f32_16x16x32_bf16 v[48:51], a[244:247], v[28:31], v[48:51]
    v_mfma_f32_16x16x32_bf16 v[48:51], a[248:251], v[34:37], v[48:51]
    s_nop 15
    s_setpc_b64 s[40:41]
L_rs_start5b:
    s_call_b64 s[40:41], L_rare5_1
    s_branch L_ret_start5b
L_rs_loop5w0a:
    s_call_b64 s[40:41], L_rare5_0
    s_branch L_ret_loop5w0a
L_rs_loop5w0b:
    s_call_b64 s[40:41], L_rare5_1
    s_branch L_ret_loop5w0b
L_rs_end5a:
    s_call_b64 s[40:41], L_rare5_0
    s_branch L_ret_end5a
L_rs_end5b:
    s_call_b64 s[40:41], L_rare5_1
    s_branch L_ret_end5b
L_rs_start4b:
    s_call_b64 s[40:41], L_rare4_1
    s_branch L_ret_start4b
L_rs_loop4w0a:
    s_call_b64 s[40:41], L_rare4_0
    s_branch L_ret_loop4w0a
L_rs_loop4w0b:
    s_call_b64 s[40:41], L_rare4_1
    s_branch L_ret_loop4w0b
L_rs_end4a:
    s_call_b64 s[40:41], L_rare4_0
    s_branch L_ret_end4a
L_rs_end4b:
    s_call_b64 s[40:41], L_rare4_1
    s_branch L_ret_end4b
L_rs_tr54a:
    s_call_b64 s[40:41], L_rare5_0
    s_branch L_ret_tr54a
L_rs_tr54b:
    s_nop 15
    s_waitcnt vmcnt(0) lgkmcnt(0)
    s_mov_b32 s68, s14
    s_mov_b32 s14, 166723584
    v_mbcnt_lo_u32_b32 v105, -1, 0
    v_mbcnt_hi_u32_b32 v105, -1, v105
    v_and_b32 v104, 15, v105
    v_mul_u32_u24 v104, 384, v104
    v_lshrrev_b32 v105, 4, v105
    v_lshl_add_u32 v104, v105, 4, v104
    s_add_u32 s69, s34, 0
    buffer_load_dwordx4 a[96:99], v104, s[12:15], s69 offen offset:0
    buffer_load_dwordx4 a[100:103], v104, s[12:15], s69 offen offset:64
    buffer_load_dwordx4 a[104:107], v104, s[12:15], s69 offen offset:128
    buffer_load_dwordx4 a[108:111], v104, s[12:15], s69 offen offset:192
    buffer_load_dwordx4 a[112:115], v104, s[12:15], s69 offen offset:256
    buffer_load_dwordx4 a[116:119], v104, s[12:15], s69 offen offset:320
    s_add_u32 s69, s34, 6144
    buffer_load_dwordx4 a[120:123], v104, s[12:15], s69 offen offset:0
    buffer_load_dwordx4 a[124:127], v104, s[12:15], s69 offen offset:64
    buffer_load_dwordx4 a[128:131], v104, s[12:15], s69 offen offset:128
    buffer_load_dwordx4 a[132:135], v104, s[12:15], s69 offen offset:192
    buffer_load_dwordx4 a[136:139], v104, s[12:15], s69 offen offset:256
    buffer_load_dwordx4 a[140:143], v104, s[12:15], s69 offen offset:320
    s_add_u32 s69, s34, 12288
    buffer_load_dwordx4 a[144:147], v104, s[12:15], s69 offen offset:0
    buffer_load_dwordx4 a[148:151], v104, s[12:15], s69 offen offset:64
    buffer_load_dwordx4 a[152:155], v104, s[12:15], s69 offen offset:128
    buffer_load_dwordx4 a[156:159], v104, s[12:15], s69 offen offset:192
    buffer_load_dwordx4 a[160:163], v104, s[12:15], s69 offen offset:256
    buffer_load_dwordx4 a[164:167], v104, s[12:15], s69 offen offset:320
    s_add_u32 s69, s34, 18432
    buffer_load_dwordx4 a[168:171], v104, s[12:15], s69 offen offset:0
    buffer_load_dwordx4 a[172:175], v104, s[12:15], s69 offen offset:64
    buffer_load_dwordx4 a[176:179], v104, s[12:15], s69 offen offset:128
    buffer_load_dwordx4 a[180:183], v104, s[12:15], s69 offen offset:192
    buffer_load_dwordx4 a[184:187], v104, s[12:15], s69 offen offset:256
    buffer_load_dwordx4 a[188:191], v104, s[12:15], s69 offen offset:320
    s_add_u32 s69, s34, 24576
    buffer_load_dwordx4 a[192:195], v104, s[12:15], s69 offen offset:0
    buffer_load_dwordx4 a[196:199], v104, s[12:15], s69 offen offset:64
    buffer_load_dwordx4 a[200:203], v104, s[12:15], s69 offen offset:128
    buffer_load_dwordx4 a[204:207], v104, s[12:15], s69 offen offset:192
    buffer_load_dwordx4 a[208:211], v104, s[12:15], s69 offen offset:256
    buffer_load_dwordx4 v[92:95], v104, s[12:15], s69 offen offset:320
    s_waitcnt vmcnt(0)
    s_call_b64 s[40:41], L_rare5_1
    v_mbcnt_lo_u32_b32 v105, -1, 0
    v_mbcnt_hi_u32_b32 v105, -1, v105
    v_and_b32 v104, 15, v105
    v_mul_u32_u24 v104, 384, v104
    v_lshrrev_b32 v105, 4, v105
    v_lshl_add_u32 v104, v105, 4, v104
    s_add_u32 s69, s33, 0
    buffer_load_dwordx4 a[96:99], v104, s[12:15], s69 offen offset:0
    buffer_load_dwordx4 a[100:103], v104, s[12:15], s69 offen offset:64
    buffer_load_dwordx4 a[104:107], v104, s[12:15], s69 offen offset:128
    buffer_load_dwordx4 a[108:111], v104, s[12:15], s69 offen offset:192
    buffer_load_dwordx4 a[112:115], v104, s[12:15], s69 offen offset:256
    buffer_load_dwordx4 a[116:119], v104, s[12:15], s69 offen offset:320
    s_add_u32 s69, s33, 6144
    buffer_load_dwordx4 a[120:123], v104, s[12:15], s69 offen offset:0
    buffer_load_dwordx4 a[124:127], v104, s[12:15], s69 offen offset:64
    buffer_load_dwordx4 a[128:131], v104, s[12:15], s69 offen offset:128
    buffer_load_dwordx4 a[132:135], v104, s[12:15], s69 offen offset:192
    buffer_load_dwordx4 a[136:139], v104, s[12:15], s69 offen offset:256
    buffer_load_dwordx4 a[140:143], v104, s[12:15], s69 offen offset:320
    s_add_u32 s69, s33, 12288
    buffer_load_dwordx4 a[144:147], v104, s[12:15], s69 offen offset:0
    buffer_load_dwordx4 a[148:151], v104, s[12:15], s69 offen offset:64
    buffer_load_dwordx4 a[152:155], v104, s[12:15], s69 offen offset:128
    buffer_load_dwordx4 a[156:159], v104, s[12:15], s69 offen offset:192
    buffer_load_dwordx4 a[160:163], v104, s[12:15], s69 offen offset:256
    buffer_load_dwordx4 a[164:167], v104, s[12:15], s69 offen offset:320
    s_add_u32 s69, s33, 18432
    buffer_load_dwordx4 a[168:171], v104, s[12:15], s69 offen offset:0
    buffer_load_dwordx4 a[172:175], v104, s[12:15], s69 offen offset:64
    buffer_load_dwordx4 a[176:179], v104, s[12:15], s69 offen offset:128
    buffer_load_dwordx4 a[180:183], v104, s[12:15], s69 offen offset:192
    buffer_load_dwordx4 a[184:187], v104, s[12:15], s69 offen offset:256
    buffer_load_dwordx4 a[188:191], v104, s[12:15], s69 offen offset:320
    s_waitcnt vmcnt(0)
    s_mov_b32 s14, s68
    s_branch L_ret_tr54b
L_rs_tr54d:
    s_call_b64 s[40:41], L_rare4_1
    s_branch L_ret_tr54d
L_rs_tr45a:
    s_call_b64 s[40:41], L_rare4_0
    s_branch L_ret_tr45a
L_rs_tr45b:
    s_nop 15
    s_waitcnt vmcnt(0) lgkmcnt(0)
    s_mov_b32 s68, s14
    s_mov_b32 s14, 166723584
    v_mbcnt_lo_u32_b32 v105, -1, 0
    v_mbcnt_hi_u32_b32 v105, -1, v105
    v_and_b32 v104, 15, v105
    v_mul_u32_u24 v104, 384, v104
    v_lshrrev_b32 v105, 4, v105
    v_lshl_add_u32 v104, v105, 4, v104
    s_add_u32 s69, s34, 0
    buffer_load_dwordx4 a[96:99], v104, s[12:15], s69 offen offset:0
    buffer_load_dwordx4 a[100:103], v104, s[12:15], s69 offen offset:64
    buffer_load_dwordx4 a[104:107], v104, s[12:15], s69 offen offset:128
    buffer_load_dwordx4 a[108:111], v104, s[12:15], s69 offen offset:192
    buffer_load_dwordx4 a[112:115], v104, s[12:15], s69 offen offset:256
    buffer_load_dwordx4 a[116:119], v104, s[12:15], s69 offen offset:320
    s_add_u32 s69, s34, 6144
    buffer_load_dwordx4 a[120:123], v104, s[12:15], s69 offen offset:0
    buffer_load_dwordx4 a[124:127], v104, s[12:15], s69 offen offset:64
    buffer_load_dwordx4 a[128:131], v104, s[12:15], s69 offen offset:128
    buffer_load_dwordx4 a[132:135], v104, s[12:15], s69 offen offset:192
    buffer_load_dwordx4 a[136:139], v104, s[12:15], s69 offen offset:256
    buffer_load_dwordx4 a[140:143], v104, s[12:15], s69 offen offset:320
    s_add_u32 s69, s34, 12288
    buffer_load_dwordx4 a[144:147], v104, s[12:15], s69 offen offset:0
    buffer_load_dwordx4 a[148:151], v104, s[12:15], s69 offen offset:64
    buffer_load_dwordx4 a[152:155], v104, s[12:15], s69 offen offset:128
    buffer_load_dwordx4 a[156:159], v104, s[12:15], s69 offen offset:192
    buffer_load_dwordx4 a[160:163], v104, s[12:15], s69 offen offset:256
    buffer_load_dwordx4 a[164:167], v104, s[12:15], s69 offen offset:320
    s_add_u32 s69, s34, 18432
    buffer_load_dwordx4 a[168:171], v104, s[12:15], s69 offen offset:0
    buffer_load_dwordx4 a[172:175], v104, s[12:15], s69 offen offset:64
    buffer_load_dwordx4 a[176:179], v104, s[12:15], s69 offen offset:128
    buffer_load_dwordx4 a[180:183], v104, s[12:15], s69 offen offset:192
    buffer_load_dwordx4 a[184:187], v104, s[12:15], s69 offen offset:256
    buffer_load_dwordx4 a[188:191], v104, s[12:15], s69 offen offset:320
    s_waitcnt vmcnt(0)
    s_call_b64 s[40:41], L_rare4_1
    v_mbcnt_lo_u32_b32 v105, -1, 0
    v_mbcnt_hi_u32_b32 v105, -1, v105
    v_and_b32 v104, 15, v105
    v_mul_u32_u24 v104, 384, v104
    v_lshrrev_b32 v105, 4, v105
    v_lshl_add_u32 v104, v105, 4, v104
    s_add_u32 s69, s33, 0
    buffer_load_dwordx4 a[96:99], v104, s[12:15], s69 offen offset:0
    buffer_load_dwordx4 a[100:103], v104, s[12:15], s69 offen offset:64
    buffer_load_dwordx4 a[104:107], v104, s[12:15], s69 offen offset:128
    buffer_load_dwordx4 a[108:111], v104, s[12:15], s69 offen offset:192
    buffer_load_dwordx4 a[112:115], v104, s[12:15], s69 offen offset:256
    buffer_load_dwordx4 a[116:119], v104, s[12:15], s69 offen offset:320
    s_add_u32 s69, s33, 6144
    buffer_load_dwordx4 a[120:123], v104, s[12:15], s69 offen offset:0
    buffer_load_dwordx4 a[124:127], v104, s[12:15], s69 offen offset:64
    buffer_load_dwordx4 a[128:131], v104, s[12:15], s69 offen offset:128
    buffer_load_dwordx4 a[132:135], v104, s[12:15], s69 offen offset:192
    buffer_load_dwordx4 a[136:139], v104, s[12:15], s69 offen offset:256
    buffer_load_dwordx4 a[140:143], v104, s[12:15], s69 offen offset:320
    s_add_u32 s69, s33, 12288
    buffer_load_dwordx4 a[144:147], v104, s[12:15], s69 offen offset:0
    buffer_load_dwordx4 a[148:151], v104, s[12:15], s69 offen offset:64
    buffer_load_dwordx4 a[152:155], v104, s[12:15], s69 offen offset:128
    buffer_load_dwordx4 a[156:159], v104, s[12:15], s69 offen offset:192
    buffer_load_dwordx4 a[160:163], v104, s[12:15], s69 offen offset:256
    buffer_load_dwordx4 a[164:167], v104, s[12:15], s69 offen offset:320
    s_add_u32 s69, s33, 18432
    buffer_load_dwordx4 a[168:171], v104, s[12:15], s69 offen offset:0
    buffer_load_dwordx4 a[172:175], v104, s[12:15], s69 offen offset:64
    buffer_load_dwordx4 a[176:179], v104, s[12:15], s69 offen offset:128
    buffer_load_dwordx4 a[180:183], v104, s[12:15], s69 offen offset:192
    buffer_load_dwordx4 a[184:187], v104, s[12:15], s69 offen offset:256
    buffer_load_dwordx4 a[188:191], v104, s[12:15], s69 offen offset:320
    s_add_u32 s69, s33, 24576
    buffer_load_dwordx4 a[192:195], v104, s[12:15], s69 offen offset:0
    buffer_load_dwordx4 a[196:199], v104, s[12:15], s69 offen offset:64
    buffer_load_dwordx4 a[200:203], v104, s[12:15], s69 offen offset:128
    buffer_load_dwordx4 a[204:207], v104, s[12:15], s69 offen offset:192
    buffer_load_dwordx4 a[208:211], v104, s[12:15], s69 offen offset:256
    buffer_load_dwordx4 v[92:95], v104, s[12:15], s69 offen offset:320
    s_waitcnt vmcnt(0)
    s_mov_b32 s14, s68
    s_branch L_ret_tr45b
L_rs_tr45d:
    s_call_b64 s[40:41], L_rare5_1
    s_branch L_ret_tr45d
L_rs_tr44a:
    s_call_b64 s[40:41], L_rare4_0
    s_branch L_ret_tr44a
L_rs_tr44b:
    s_nop 15
    s_waitcnt vmcnt(0) lgkmcnt(0)
    s_mov_b32 s68, s14
    s_mov_b32 s14, 166723584
    v_mbcnt_lo_u32_b32 v105, -1, 0
    v_mbcnt_hi_u32_b32 v105, -1, v105
    v_and_b32 v104, 15, v105
    v_mul_u32_u24 v104, 384, v104
    v_lshrrev_b32 v105, 4, v105
    v_lshl_add_u32 v104, v105, 4, v104
    s_add_u32 s69, s34, 0
    buffer_load_dwordx4 a[96:99], v104, s[12:15], s69 offen offset:0
    buffer_load_dwordx4 a[100:103], v104, s[12:15], s69 offen offset:64
    buffer_load_dwordx4 a[104:107], v104, s[12:15], s69 offen offset:128
    buffer_load_dwordx4 a[108:111], v104, s[12:15], s69 offen offset:192
    buffer_load_dwordx4 a[112:115], v104, s[12:15], s69 offen offset:256
    buffer_load_dwordx4 a[116:119], v104, s[12:15], s69 offen offset:320
    s_add_u32 s69, s34, 6144
    buffer_load_dwordx4 a[120:123], v104, s[12:15], s69 offen offset:0
    buffer_load_dwordx4 a[124:127], v104, s[12:15], s69 offen offset:64
    buffer_load_dwordx4 a[128:131], v104, s[12:15], s69 offen offset:128
    buffer_load_dwordx4 a[132:135], v104, s[12:15], s69 offen offset:192
    buffer_load_dwordx4 a[136:139], v104, s[12:15], s69 offen offset:256
    buffer_load_dwordx4 a[140:143], v104, s[12:15], s69 offen offset:320
    s_add_u32 s69, s34, 12288
    buffer_load_dwordx4 a[144:147], v104, s[12:15], s69 offen offset:0
    buffer_load_dwordx4 a[148:151], v104, s[12:15], s69 offen offset:64
    buffer_load_dwordx4 a[152:155], v104, s[12:15], s69 offen offset:128
    buffer_load_dwordx4 a[156:159], v104, s[12:15], s69 offen offset:192
    buffer_load_dwordx4 a[160:163], v104, s[12:15], s69 offen offset:256
    buffer_load_dwordx4 a[164:167], v104, s[12:15], s69 offen offset:320
    s_add_u32 s69, s34, 18432
    buffer_load_dwordx4 a[168:171], v104, s[12:15], s69 offen offset:0
    buffer_load_dwordx4 a[172:175], v104, s[12:15], s69 offen offset:64
    buffer_load_dwordx4 a[176:179], v104, s[12:15], s69 offen offset:128
    buffer_load_dwordx4 a[180:183], v104, s[12:15], s69 offen offset:192
    buffer_load_dwordx4 a[184:187], v104, s[12:15], s69 offen offset:256
    buffer_load_dwordx4 a[188:191], v104, s[12:15], s69 offen offset:320
    s_waitcnt vmcnt(0)
    s_call_b64 s[40:41], L_rare4_1
    v_mbcnt_lo_u32_b32 v105, -1, 0
    v_mbcnt_hi_u32_b32 v105, -1, v105
    v_and_b32 v104, 15, v105
    v_mul_u32_u24 v104, 384, v104
    v_lshrrev_b32 v105, 4, v105
    v_lshl_add_u32 v104, v105, 4, v104
    s_add_u32 s69, s33, 0
    buffer_load_dwordx4 a[96:99], v104, s[12:15], s69 offen offset:0
    buffer_load_dwordx4 a[100:103], v104, s[12:15], s69 offen offset:64
    buffer_load_dwordx4 a[104:107], v104, s[12:15], s69 offen offset:128
    buffer_load_dwordx4 a[108:111], v104, s[12:15], s69 offen offset:192
    buffer_load_dwordx4 a[112:115], v104, s[12:15], s69 offen offset:256
    buffer_load_dwordx4 a[116:119], v104, s[12:15], s69 offen offset:320
    s_add_u32 s69, s33, 6144
    buffer_load_dwordx4 a[120:123], v104, s[12:15], s69 offen offset:0
    buffer_load_dwordx4 a[124:127], v104, s[12:15], s69 offen offset:64
    buffer_load_dwordx4 a[128:131], v104, s[12:15], s69 offen offset:128
    buffer_load_dwordx4 a[132:135], v104, s[12:15], s69 offen offset:192
    buffer_load_dwordx4 a[136:139], v104, s[12:15], s69 offen offset:256
    buffer_load_dwordx4 a[140:143], v104, s[12:15], s69 offen offset:320
    s_add_u32 s69, s33, 12288
    buffer_load_dwordx4 a[144:147], v104, s[12:15], s69 offen offset:0
    buffer_load_dwordx4 a[148:151], v104, s[12:15], s69 offen offset:64
    buffer_load_dwordx4 a[152:155], v104, s[12:15], s69 offen offset:128
    buffer_load_dwordx4 a[156:159], v104, s[12:15], s69 offen offset:192
    buffer_load_dwordx4 a[160:163], v104, s[12:15], s69 offen offset:256
    buffer_load_dwordx4 a[164:167], v104, s[12:15], s69 offen offset:320
    s_add_u32 s69, s33, 18432
    buffer_load_dwordx4 a[168:171], v104, s[12:15], s69 offen offset:0
    buffer_load_dwordx4 a[172:175], v104, s[12:15], s69 offen offset:64
    buffer_load_dwordx4 a[176:179], v104, s[12:15], s69 offen offset:128
    buffer_load_dwordx4 a[180:183], v104, s[12:15], s69 offen offset:192
    buffer_load_dwordx4 a[184:187], v104, s[12:15], s69 offen offset:256
    buffer_load_dwordx4 a[188:191], v104, s[12:15], s69 offen offset:320
    s_waitcnt vmcnt(0)
    s_mov_b32 s14, s68
    s_branch L_ret_tr44b
L_rs_tr44d:
    s_call_b64 s[40:41], L_rare4_1
    s_branch L_ret_tr44d
L_rs_tr55a:
    s_call_b64 s[40:41], L_rare5_0
    s_branch L_ret_tr55a
L_rs_tr55b:
    s_nop 15
    s_waitcnt vmcnt(0) lgkmcnt(0)
    s_mov_b32 s68, s14
    s_mov_b32 s14, 166723584
    v_mbcnt_lo_u32_b32 v105, -1, 0
    v_mbcnt_hi_u32_b32 v105, -1, v105
    v_and_b32 v104, 15, v105
    v_mul_u32_u24 v104, 384, v104
    v_lshrrev_b32 v105, 4, v105
    v_lshl_add_u32 v104, v105, 4, v104
    s_add_u32 s69, s34, 0
    buffer_load_dwordx4 a[96:99], v104, s[12:15], s69 offen offset:0
    buffer_load_dwordx4 a[100:103], v104, s[12:15], s69 offen offset:64
    buffer_load_dwordx4 a[104:107], v104, s[12:15], s69 offen offset:128
    buffer_load_dwordx4 a[108:111], v104, s[12:15], s69 offen offset:192
    buffer_load_dwordx4 a[112:115], v104, s[12:15], s69 offen offset:256
    buffer_load_dwordx4 a[116:119], v104, s[12:15], s69 offen offset:320
    s_add_u32 s69, s34, 6144
    buffer_load_dwordx4 a[120:123], v104, s[12:15], s69 offen offset:0
    buffer_load_dwordx4 a[124:127], v104, s[12:15], s69 offen offset:64
    buffer_load_dwordx4 a[128:131], v104, s[12:15], s69 offen offset:128
    buffer_load_dwordx4 a[132:135], v104, s[12:15], s69 offen offset:192
    buffer_load_dwordx4 a[136:139], v104, s[12:15], s69 offen offset:256
    buffer_load_dwordx4 a[140:143], v104, s[12:15], s69 offen offset:320
    s_add_u32 s69, s34, 12288
    buffer_load_dwordx4 a[144:147], v104, s[12:15], s69 offen offset:0
    buffer_load_dwordx4 a[148:151], v104, s[12:15], s69 offen offset:64
    buffer_load_dwordx4 a[152:155], v104, s[12:15], s69 offen offset:128
    buffer_load_dwordx4 a[156:159], v104, s[12:15], s69 offen offset:192
    buffer_load_dwordx4 a[160:163], v104, s[12:15], s69 offen offset:256
    buffer_load_dwordx4 a[164:167], v104, s[12:15], s69 offen offset:320
    s_add_u32 s69, s34, 18432
    buffer_load_dwordx4 a[168:171], v104, s[12:15], s69 offen offset:0
    buffer_load_dwordx4 a[172:175], v104, s[12:15], s69 offen offset:64
    buffer_load_dwordx4 a[176:179], v104, s[12:15], s69 offen offset:128
    buffer_load_dwordx4 a[180:183], v104, s[12:15], s69 offen offset:192
    buffer_load_dwordx4 a[184:187], v104, s[12:15], s69 offen offset:256
    buffer_load_dwordx4 a[188:191], v104, s[12:15], s69 offen offset:320
    s_add_u32 s69, s34, 24576
    buffer_load_dwordx4 a[192:195], v104, s[12:15], s69 offen offset:0
    buffer_load_dwordx4 a[196:199], v104, s[12:15], s69 offen offset:64
    buffer_load_dwordx4 a[200:203], v104, s[12:15], s69 offen offset:128
    buffer_load_dwordx4 a[204:207], v104, s[12:15], s69 offen offset:192
    buffer_load_dwordx4 a[208:211], v104, s[12:15], s69 offen offset:256
    buffer_load_dwordx4 v[92:95], v104, s[12:15], s69 offen offset:320
    s_waitcnt vmcnt(0)
    s_call_b64 s[40:41], L_rare5_1
    v_mbcnt_lo_u32_b32 v105, -1, 0
    v_mbcnt_hi_u32_b32 v105, -1, v105
    v_and_b32 v104, 15, v105
    v_mul_u32_u24 v104, 384, v104
    v_lshrrev_b32 v105, 4, v105
    v_lshl_add_u32 v104, v105, 4, v104
    s_add_u32 s69, s33, 0
    buffer_load_dwordx4 a[96:99], v104, s[12:15], s69 offen offset:0
    buffer_load_dwordx4 a[100:103], v104, s[12:15], s69 offen offset:64
    buffer_load_dwordx4 a[104:107], v104, s[12:15], s69 offen offset:128
    buffer_load_dwordx4 a[108:111], v104, s[12:15], s69 offen offset:192
    buffer_load_dwordx4 a[112:115], v104, s[12:15], s69 offen offset:256
    buffer_load_dwordx4 a[116:119], v104, s[12:15], s69 offen offset:320
    s_add_u32 s69, s33, 6144
    buffer_load_dwordx4 a[120:123], v104, s[12:15], s69 offen offset:0
    buffer_load_dwordx4 a[124:127], v104, s[12:15], s69 offen offset:64
    buffer_load_dwordx4 a[128:131], v104, s[12:15], s69 offen offset:128
    buffer_load_dwordx4 a[132:135], v104, s[12:15], s69 offen offset:192
    buffer_load_dwordx4 a[136:139], v104, s[12:15], s69 offen offset:256
    buffer_load_dwordx4 a[140:143], v104, s[12:15], s69 offen offset:320
    s_add_u32 s69, s33, 12288
    buffer_load_dwordx4 a[144:147], v104, s[12:15], s69 offen offset:0
    buffer_load_dwordx4 a[148:151], v104, s[12:15], s69 offen offset:64
    buffer_load_dwordx4 a[152:155], v104, s[12:15], s69 offen offset:128
    buffer_load_dwordx4 a[156:159], v104, s[12:15], s69 offen offset:192
    buffer_load_dwordx4 a[160:163], v104, s[12:15], s69 offen offset:256
    buffer_load_dwordx4 a[164:167], v104, s[12:15], s69 offen offset:320
    s_add_u32 s69, s33, 18432
    buffer_load_dwordx4 a[168:171], v104, s[12:15], s69 offen offset:0
    buffer_load_dwordx4 a[172:175], v104, s[12:15], s69 offen offset:64
    buffer_load_dwordx4 a[176:179], v104, s[12:15], s69 offen offset:128
    buffer_load_dwordx4 a[180:183], v104, s[12:15], s69 offen offset:192
    buffer_load_dwordx4 a[184:187], v104, s[12:15], s69 offen offset:256
    buffer_load_dwordx4 a[188:191], v104, s[12:15], s69 offen offset:320
    s_add_u32 s69, s33, 24576
    buffer_load_dwordx4 a[192:195], v104, s[12:15], s69 offen offset:0
    buffer_load_dwordx4 a[196:199], v104, s[12:15], s69 offen offset:64
    buffer_load_dwordx4 a[200:203], v104, s[12:15], s69 offen offset:128
    buffer_load_dwordx4 a[204:207], v104, s[12:15], s69 offen offset:192
    buffer_load_dwordx4 a[208:211], v104, s[12:15], s69 offen offset:256
    buffer_load_dwordx4 v[92:95], v104, s[12:15], s69 offen offset:320
    s_waitcnt vmcnt(0)
    s_mov_b32 s14, s68
    s_branch L_ret_tr55b
L_rs_tr55d:
    s_call_b64 s[40:41], L_rare5_1
    s_branch L_ret_tr55d
.section .rodata,"a"
.p2align 6
.amdhsa_kernel standalone__gqa_softmax__near_ridge_kernel
  .amdhsa_next_free_vgpr 512
  .amdhsa_next_free_sgpr 102
  .amdhsa_accum_offset 256
  .amdhsa_group_segment_fixed_size 0
  .amdhsa_kernarg_size 48
  .amdhsa_user_sgpr_count 2
  .amdhsa_user_sgpr_kernarg_segment_ptr 1
  .amdhsa_system_sgpr_workgroup_id_x 1
.end_amdhsa_kernel
```

```asm
; @launch grid=(256,1,1) block=(256,1,1) lds=163840
.amdgcn_target "amdgcn-amd-amdhsa--gfx950"
.text
.globl standalone__gqa_softmax__near_ridge_kernel
.p2align 8
.type standalone__gqa_softmax__near_ridge_kernel,@function
standalone__gqa_softmax__near_ridge_kernel:
    s_cmp_ge_u32 s2, 256
    s_cbranch_scc1 L_end
    s_load_dwordx4 s[84:87], s[0:1], 0
    s_load_dwordx4 s[88:91], s[0:1], 16
    v_lshrrev_b32 v110, 6, v0
    v_and_b32 v111, 63, v0
    s_getpc_b64 s[60:61]
L_pc:
    s_lshr_b32 s62, s2, 3
    v_lshl_add_u32 v53, s62, 2, v110
    v_min_u32 v52, ((L_codeend-L_pc+16383)/16384)-1, v111
    v_mul_u32_u24 v53, ((L_codeend-L_pc+16383)/16384), v53
    v_add_lshl_u32 v52, v52, v53, 7
    v_min_u32 v52, L_codeend-L_pc-4, v52
    global_load_dword v53, v52, s[60:61]
    v_readfirstlane_b32 s3, v110
    v_lshrrev_b32 v96, 3, v111
    v_mul_u32_u24 v7, 384, v96
    v_lshrrev_b32 v97, 1, v96
    v_lshlrev_b32 v97, 1, v97
    v_and_b32 v98, 7, v111
    v_xor_b32 v97, v97, v98
    v_lshl_add_u32 v7, v97, 4, v7
    s_and_b32 s65, s3, 1
    s_mul_i32 s42, s65, 80
    s_mul_i32 s43, s65, 3072
    v_xor_b32 v6, s42, v7
    v_xor_b32 v7, 80, v6
    v_add_u32 v6, s43, v6
    s_sub_u32 s43, 3072, s43
    v_add_u32 v7, s43, v7
    s_mov_b32 s28, 0x3dd53b95
    s_mov_b32 s29, 0x4e800000
    s_mov_b32 s49, 5888
    s_mov_b32 s66, 0x28301800
    s_mov_b32 s46, 0
    s_mov_b32 s47, 0xffff0000
    s_and_b32 s42, s2, 7
    s_lshr_b32 s43, s2, 3
    s_mul_i32 s44, s43, 43
    s_lshr_b32 s44, s44, 7
    s_mov_b32 s39, s44
    s_mul_i32 s45, s44, 3
    s_sub_u32 s36, s43, s45
    s_lshl_b32 s42, s42, 6
    s_lshl_b32 s45, s45, 1
    s_add_u32 s42, s42, s45
    s_mul_i32 s64, s42, 196608
    s_mul_i32 s35, s42, 325632
    s_lshr_b32 s42, s44, 1
    s_mov_b32 s31, 0x6900924
    s_cmp_eq_u32 s42, 1
    s_cselect_b32 s31, 0x14a0489, s31
    s_cmp_eq_u32 s42, 2
    s_cselect_b32 s31, 0x8250258, s31
    s_cmp_eq_u32 s42, 3
    s_cselect_b32 s31, 0x8940912, s31
    s_cmp_eq_u32 s42, 4
    s_cselect_b32 s31, 0x1a10606, s31
    s_and_b32 s42, s44, 1
    s_lshl_b32 s42, s42, 4
    s_lshr_b32 s31, s31, s42
    s_and_b32 s31, s31, 0xffff
    s_cmp_eq_u32 s43, 30
    s_cselect_b32 s31, 0x120648, s31
    s_cmp_eq_u32 s43, 31
    s_cselect_b32 s31, 0x240219, s31
    s_lshr_b32 s63, s31, 16
    s_cmp_ge_u32 s43, 30
    s_cselect_b32 s36, 0, s36
    s_cselect_b32 s42, 4, 6
    s_mul_i32 s42, s42, 196608
    s_add_u32 s6, s64, s42
    s_mov_b32 s10, s6
    s_mul_i32 s22, s3, 3072
    s_mul_i32 s38, s3, 28672
    s_add_u32 s38, s38, 49152
    s_and_b32 s42, s3, 2
    s_mul_i32 s42, s42, 3072
    s_add_u32 s20, s64, s42
    s_mov_b32 s21, s20
    s_mov_b32 s14, 166723584
    s_mov_b32 s18, 0
    s_mov_b32 s67, 0
    s_mov_b32 s37, 0
    s_mov_b32 s60, 0
    s_mov_b32 s61, 0xffff
    s_lshl_b32 s42, s37, 1
    s_lshr_b32 s42, s31, s42
    s_and_b32 s42, s42, 3
    s_add_u32 s42, s42, s36
    s_sub_u32 s43, s42, 3
    s_cmp_ge_u32 s42, 3
    s_cselect_b32 s42, s43, s42
    s_mul_i32 s44, s3, 5
    s_mov_b32 s32, 1
    s_lshl_b32 s43, s3, 2
    s_add_u32 s45, s43, 21
    s_cmp_eq_u32 s3, 0
    s_cselect_b32 s45, 20, s45
    s_cselect_b32 s34, 1, 0
    s_cmp_eq_u32 s42, 1
    s_cselect_b32 s44, s45, s44
    s_cselect_b32 s32, s34, s32
    s_add_u32 s45, s43, 37
    s_cmp_eq_u32 s42, 2
    s_cselect_b32 s44, s45, s44
    s_cselect_b32 s32, 0, s32
    s_mul_i32 s44, s44, 6144
    s_add_u32 s34, s35, s44
    s_waitcnt lgkmcnt(0)
    s_mov_b32 s12, s84
    s_and_b32 s13, s85, 0xffff
    s_mov_b32 s15, 0x20000
    s_mov_b32 s4, s86
    s_and_b32 s5, s87, 0xffff
    s_mov_b32 s7, 0x20000
    s_mov_b32 s8, s88
    s_and_b32 s9, s89, 0xffff
    s_mov_b32 s11, 0x20000
    s_mov_b32 s16, s90
    s_and_b32 s17, s91, 0xffff
    s_mov_b32 s19, 0x20000
    s_cmp_eq_u32 s32, 0
    s_cbranch_scc1 L_start4
L_start5:
    s_add_u32 m0, s22, 0
    s_nop 0
    buffer_load_dwordx4 v6, s[4:7], s20 offen lds
    s_add_u32 s20, s20, 128
    s_add_u32 m0, s22, 1024
    s_nop 0
    buffer_load_dwordx4 v6, s[4:7], s20 offen lds
    s_add_u32 s20, s20, 128
    s_add_u32 m0, s22, 2048
    s_nop 0
    buffer_load_dwordx4 v6, s[4:7], s20 offen lds
    s_add_u32 s20, s20, 12032
    s_add_u32 m0, s22, 12288
    s_nop 0
    buffer_load_dwordx4 v6, s[4:7], s20 offen lds
    s_add_u32 s20, s20, 128
    s_add_u32 m0, s22, 13312
    s_nop 0
    buffer_load_dwordx4 v6, s[4:7], s20 offen lds
    s_add_u32 s20, s20, 128
    s_add_u32 m0, s22, 14336
    s_nop 0
    buffer_load_dwordx4 v6, s[4:7], s20 offen lds
    s_add_u32 s20, s20, 12032
    s_add_u32 s48, s34, 0
    s_add_u32 m0, s38, 0
    s_nop 0
    buffer_load_dwordx4 v6, s[12:15], s48 offen nt lds
    s_add_u32 m0, s38, 1024
    s_nop 0
    buffer_load_dwordx4 v7, s[12:15], s48 offen nt lds
    s_add_u32 s48, s34, 128
    s_add_u32 m0, s38, 2048
    s_nop 0
    buffer_load_dwordx4 v6, s[12:15], s48 offen nt lds
    s_add_u32 m0, s38, 3072
    s_nop 0
    buffer_load_dwordx4 v7, s[12:15], s48 offen nt lds
    s_add_u32 s48, s34, 256
    s_add_u32 m0, s38, 4096
    s_nop 0
    buffer_load_dwordx4 v6, s[12:15], s48 offen nt lds
    s_add_u32 m0, s38, 5120
    s_nop 0
    buffer_load_dwordx4 v7, s[12:15], s48 offen nt lds
    s_add_u32 s48, s34, 6144
    s_add_u32 m0, s38, 6144
    s_nop 0
    buffer_load_dwordx4 v6, s[12:15], s48 offen nt lds
    s_add_u32 m0, s38, 7168
    s_nop 0
    buffer_load_dwordx4 v7, s[12:15], s48 offen nt lds
    s_add_u32 s48, s34, 6272
    s_add_u32 m0, s38, 8192
    s_nop 0
    buffer_load_dwordx4 v6, s[12:15], s48 offen nt lds
    s_add_u32 m0, s38, 9216
    s_nop 0
    buffer_load_dwordx4 v7, s[12:15], s48 offen nt lds
    s_add_u32 s48, s34, 6400
    s_add_u32 m0, s38, 10240
    s_nop 0
    buffer_load_dwordx4 v6, s[12:15], s48 offen nt lds
    s_add_u32 m0, s38, 11264
    s_nop 0
    buffer_load_dwordx4 v7, s[12:15], s48 offen nt lds
    s_add_u32 s48, s34, 12288
    s_add_u32 m0, s38, 12288
    s_nop 0
    buffer_load_dwordx4 v6, s[12:15], s48 offen nt lds
    s_add_u32 m0, s38, 13312
    s_nop 0
    buffer_load_dwordx4 v7, s[12:15], s48 offen nt lds
    s_add_u32 s48, s34, 12416
    s_add_u32 m0, s38, 14336
    s_nop 0
    buffer_load_dwordx4 v6, s[12:15], s48 offen nt lds
    s_add_u32 m0, s38, 15360
    s_nop 0
    buffer_load_dwordx4 v7, s[12:15], s48 offen nt lds
    s_add_u32 s48, s34, 12544
    s_add_u32 m0, s38, 16384
    s_nop 0
    buffer_load_dwordx4 v6, s[12:15], s48 offen nt lds
    s_add_u32 m0, s38, 17408
    s_nop 0
    buffer_load_dwordx4 v7, s[12:15], s48 offen nt lds
    v_and_b32 v96, 15, v111
    v_lshrrev_b32 v97, 4, v111
    v_lshrrev_b32 v98, 3, v96
    v_and_b32 v99, 7, v96
    v_lshlrev_b32 v0, 7, v99
    v_bfe_u32 v99, v96, 1, 2
    v_lshlrev_b32 v99, 1, v99
    v_mul_u32_u24 v100, 5, v98
    v_xor_b32 v99, v99, v100
    v_xor_b32 v99, v99, v97
    v_lshl_add_u32 v0, v99, 4, v0
    v_mul_u32_u24 v100, 3072, v98
    v_add_u32 v0, v100, v0
    v_xor_b32 v1, 64, v0
    v_lshrrev_b32 v98, 1, v97
    v_mul_u32_u24 v2, 3072, v98
    v_and_b32 v99, 1, v97
    v_bfe_u32 v100, v111, 2, 2
    v_lshl_add_u32 v96, v99, 2, v100
    v_lshl_add_u32 v2, v96, 7, v2
    v_lshrrev_b32 v96, 1, v96
    v_lshlrev_b32 v96, 1, v96
    v_mul_u32_u24 v98, 5, v98
    v_xor_b32 v96, v96, v98
    v_bfe_u32 v99, v111, 1, 1
    v_xor_b32 v96, v96, v99
    v_lshl_add_u32 v2, v96, 4, v2
    v_and_b32 v99, 1, v111
    v_lshl_add_u32 v2, v99, 3, v2
    v_add_u32 v2, 24576, v2
    v_xor_b32 v3, 32, v2
    v_xor_b32 v4, 64, v2
    v_xor_b32 v5, 96, v2
    v_lshl_add_u32 v103, v111, 4, s38
    v_and_b32 v96, 15, v111
    s_mov_b32 s42, 0x1011
    v_bfe_i32 v97, s42, v96, 1
    v_and_b32 v97, 0x3f803f80, v97
    v_accvgpr_write_b32 a236, v97
    v_accvgpr_write_b32 a237, v97
    v_accvgpr_write_b32 a238, v97
    v_accvgpr_write_b32 a239, v97
    s_mov_b32 s42, 0x3222
    v_bfe_i32 v97, s42, v96, 1
    v_and_b32 v97, 0x3f803f80, v97
    v_accvgpr_write_b32 a240, v97
    v_accvgpr_write_b32 a241, v97
    v_accvgpr_write_b32 a242, v97
    v_accvgpr_write_b32 a243, v97
    s_mov_b32 s42, 0x5444
    v_bfe_i32 v97, s42, v96, 1
    v_and_b32 v97, 0x3f803f80, v97
    v_accvgpr_write_b32 a244, v97
    v_accvgpr_write_b32 a245, v97
    v_accvgpr_write_b32 a246, v97
    v_accvgpr_write_b32 a247, v97
    s_mov_b32 s42, 0x9888
    v_bfe_i32 v97, s42, v96, 1
    v_and_b32 v97, 0x3f803f80, v97
    v_accvgpr_write_b32 a248, v97
    v_accvgpr_write_b32 a249, v97
    v_accvgpr_write_b32 a250, v97
    v_accvgpr_write_b32 a251, v97
    s_mov_b32 s42, 0x1100
    v_bfe_i32 v97, s42, v96, 1
    v_and_b32 v97, 0x3f803f80, v97
    v_accvgpr_write_b32 a252, v97
    v_accvgpr_write_b32 a253, v97
    v_accvgpr_write_b32 a254, v97
    v_accvgpr_write_b32 a255, v97
    s_waitcnt vmcnt(18)
    s_barrier
    s_waitcnt vmcnt(12)
    s_add_u32 s48, s34, 18432
    s_add_u32 m0, s38, 18432
    s_nop 0
    buffer_load_dwordx4 v6, s[12:15], s48 offen nt lds
    s_add_u32 m0, s38, 19456
    s_nop 0
    buffer_load_dwordx4 v7, s[12:15], s48 offen nt lds
    ds_read_b128 a[216:219], v1 offset:0
    s_add_u32 s48, s34, 18560
    s_add_u32 m0, s38, 20480
    v_mbcnt_lo_u32_b32 v107, -1, 0
    v_and_b32 v104, 0x3ff, v0
    v_mbcnt_hi_u32_b32 v107, -1, v107
    buffer_load_dwordx4 v6, s[12:15], s48 offen nt lds
    s_add_u32 m0, s38, 21504
    ds_read_b128 a[212:215], v0 offset:0
    v_lshrrev_b32 v105, 11, v0
    buffer_load_dwordx4 v7, s[12:15], s48 offen nt lds
    s_add_u32 s48, s34, 18688
    v_and_b32 v106, 15, v107
    s_add_u32 m0, s38, 22528
    s_nop 0
    buffer_load_dwordx4 v6, s[12:15], s48 offen nt lds
    v_xor_b32 v105, s65, v105
    v_lshl_add_u32 v104, v105, 10, v104
    v_add_u32 v104, s38, v104
    s_add_u32 m0, s38, 23552
    s_nop 0
    buffer_load_dwordx4 v7, s[12:15], s48 offen nt lds
    v_xor_b32 v105, 64, v104
    ds_read_b128 a[96:99], v104 offset:0
    ds_read_b128 a[116:119], v105 offset:4096
    ds_read_b128 a[100:103], v105 offset:0
    ds_read_b128 a[220:223], v0 offset:1024
    ds_read_b128 a[112:115], v104 offset:4096
    ds_read_b128 a[104:107], v104 offset:2048
    ds_read_b128 a[108:111], v105 offset:2048
    s_waitcnt lgkmcnt(6)
    v_mfma_f32_16x16x32_bf16 v[52:55], a[212:215], a[96:99], 0
    s_waitcnt lgkmcnt(4)
    ds_read_b128 a[228:231], v0 offset:2048
    v_mfma_f32_16x16x32_bf16 v[52:55], a[216:219], a[100:103], v[52:55]
    s_waitcnt lgkmcnt(1)
    ds_read_b128 a[224:227], v1 offset:1024
    v_mfma_f32_16x16x32_bf16 v[52:55], a[220:223], a[104:107], v[52:55]
    ds_read_b128 a[232:235], v1 offset:2048
    ds_read_b128 a[220:223], v0 offset:7168
    s_waitcnt lgkmcnt(2)
    v_mfma_f32_16x16x32_bf16 v[52:55], a[224:227], a[108:111], v[52:55]
    ds_read_b128 a[212:215], v0 offset:6144
    v_mfma_f32_16x16x32_bf16 v[52:55], a[228:231], a[112:115], v[52:55]
    s_waitcnt lgkmcnt(1)
    ds_read_b128 a[224:227], v1 offset:7168
    v_mfma_f32_16x16x32_bf16 v[52:55], a[232:235], a[116:119], v[52:55]
    ds_read_b128 a[232:235], v1 offset:8192
    s_waitcnt lgkmcnt(2)
    v_mfma_f32_16x16x32_bf16 v[56:59], a[212:215], a[96:99], 0
    ds_read_b128 a[216:219], v1 offset:6144
    s_waitcnt lgkmcnt(0)
    v_mfma_f32_16x16x32_bf16 v[56:59], a[216:219], a[100:103], v[56:59]
    ds_read_b128 a[212:215], v0 offset:12288
    s_nop 0
    v_max3_f32 v96, v52, v53, v54
    v_mfma_f32_16x16x32_bf16 v[56:59], a[220:223], a[104:107], v[56:59]
    ds_read_b128 a[228:231], v0 offset:8192
    v_mfma_f32_16x16x32_bf16 v[56:59], a[224:227], a[108:111], v[56:59]
    ds_read_b128 a[220:223], v0 offset:13312
    s_waitcnt lgkmcnt(1)
    v_mfma_f32_16x16x32_bf16 v[56:59], a[228:231], a[112:115], v[56:59]
    ds_read_b128 a[216:219], v1 offset:12288
    v_mfma_f32_16x16x32_bf16 v[56:59], a[232:235], a[116:119], v[56:59]
    s_nop 7
    v_max3_f32 v96, v96, v55, v56
    v_max3_f32 v96, v96, v57, v58
    v_max_f32 v96, v96, v59
    v_mov_b32 v97, v96
    s_nop 1
    v_permlane32_swap_b32 v97, v96
    v_max_f32 v96, v96, v97
    v_mov_b32 v97, v96
    s_nop 1
    v_permlane16_swap_b32 v97, v96
    v_max_f32 v96, v96, v97
    v_mul_f32_e64 v9, -s28, v96
    ds_read_b128 a[228:231], v0 offset:14336
    v_fma_f32 v52, v52, s28, v9
    v_mul_u32_u24 v106, 384, v106
    v_lshrrev_b32 v107, 4, v107
    v_fma_f32 v58, v58, s28, v9
    v_fma_f32 v54, v54, s28, v9
    v_fma_f32 v59, v59, s28, v9
    v_fma_f32 v55, v55, s28, v9
    v_exp_f32 v54, v54
    v_fma_f32 v53, v53, s28, v9
    ds_read_b128 a[224:227], v1 offset:13312
    v_fma_f32 v57, v57, s28, v9
    v_fma_f32 v56, v56, s28, v9
    v_exp_f32 v57, v57
    v_exp_f32 v58, v58
    v_lshl_add_u32 v106, v107, 4, v106
    v_exp_f32 v55, v55
    s_nop 0
    v_cvt_pk_bf16_f32 v15, v54, v55
    v_exp_f32 v53, v53
    v_exp_f32 v52, v52
    s_nop 0
    v_cvt_pk_bf16_f32 v14, v52, v53
    v_exp_f32 v56, v56
    s_waitcnt vmcnt(12)
    s_add_u32 s48, s34, 24576
    s_add_u32 m0, s38, 24576
    s_nop 0
    buffer_load_dwordx4 v6, s[12:15], s48 offen nt lds
    s_add_u32 m0, s38, 25600
    v_mfma_f32_16x16x32_bf16 v[52:55], a[212:215], a[96:99], 0
    buffer_load_dwordx4 v7, s[12:15], s48 offen nt lds
    s_add_u32 s48, s34, 24704
    v_exp_f32 v59, v59
    s_add_u32 m0, s38, 26624
    ds_read_b128 a[212:215], v0 offset:18432
    s_waitcnt lgkmcnt(1)
    v_mfma_f32_16x16x32_bf16 v[52:55], a[216:219], a[100:103], v[52:55]
    buffer_load_dwordx4 v6, s[12:15], s48 offen nt lds
    ds_read_b128 a[216:219], v1 offset:18432
    v_mfma_f32_16x16x32_bf16 v[52:55], a[220:223], a[104:107], v[52:55]
    ds_read_b128 a[136:139], v104 offset:10240
    s_add_u32 m0, s38, 27648
    s_nop 0
    buffer_load_dwordx4 v7, s[12:15], s48 offen nt lds
    v_cvt_pk_bf16_f32 v17, v58, v59
    v_mfma_f32_16x16x32_bf16 v[52:55], a[224:227], a[108:111], v[52:55]
    s_add_u32 s48, s34, 24576
    v_cvt_pk_bf16_f32 v16, v56, v57
    buffer_load_dwordx4 a[208:211], v106, s[12:15], s48 offen offset:256 nt
    ds_read_b128 a[232:235], v1 offset:14336
    ds_read_b128 a[120:123], v104 offset:6144
    v_mfma_f32_16x16x32_bf16 v[52:55], a[228:231], a[112:115], v[52:55]
    ds_read_b128 a[132:135], v105 offset:8192
    buffer_load_dwordx4 v[92:95], v106, s[12:15], s48 offen offset:320 nt
    s_waitcnt lgkmcnt(2)
    v_mfma_f32_16x16x32_bf16 v[52:55], a[232:235], a[116:119], v[52:55]
    ds_read_b128 a[228:231], v0 offset:20480
    ds_read_b128 a[220:223], v0 offset:19456
    ds_read_b128 a[140:143], v105 offset:10240
    v_mfma_f32_16x16x32_bf16 v[56:59], a[212:215], a[96:99], 0
    ds_read_b128 a[224:227], v1 offset:19456
    ds_read_b128 a[128:131], v104 offset:8192
    v_mfma_f32_16x16x32_bf16 v[56:59], a[216:219], a[100:103], v[56:59]
    ds_read_b128 a[212:215], v0 offset:0
    s_waitcnt lgkmcnt(4)
    v_mfma_f32_16x16x32_bf16 v[56:59], a[220:223], a[104:107], v[56:59]
    ds_read_b128 a[124:127], v105 offset:6144
    s_waitcnt lgkmcnt(3)
    v_mfma_f32_16x16x32_bf16 v[56:59], a[224:227], a[108:111], v[56:59]
    ds_read_b128 a[232:235], v1 offset:20480
    v_mfma_f32_16x16x32_bf16 v[56:59], a[228:231], a[112:115], v[56:59]
    ds_read_b128 a[216:219], v1 offset:0
    s_waitcnt lgkmcnt(1)
    v_mfma_f32_16x16x32_bf16 v[56:59], a[232:235], a[116:119], v[56:59]
    ds_read_b128 a[224:227], v1 offset:1024
    v_mfma_f32_16x16x32_bf16 v[60:63], a[212:215], a[120:123], 0
    s_waitcnt lgkmcnt(1)
    ds_read_b128 a[220:223], v0 offset:1024
    v_mfma_f32_16x16x32_bf16 v[60:63], a[216:219], a[124:127], v[60:63]
    ds_read_b128 a[228:231], v0 offset:2048
    s_waitcnt lgkmcnt(1)
    v_mfma_f32_16x16x32_bf16 v[60:63], a[220:223], a[128:131], v[60:63]
    ds_read_b128 a[232:235], v1 offset:2048
    ds_read_b128 a[212:215], v0 offset:6144
    v_mfma_f32_16x16x32_bf16 v[60:63], a[224:227], a[132:135], v[60:63]
    s_waitcnt lgkmcnt(2)
    ds_read_b128 a[224:227], v1 offset:7168
    v_mfma_f32_16x16x32_bf16 v[60:63], a[228:231], a[136:139], v[60:63]
    ds_read_b128 a[220:223], v0 offset:7168
    s_waitcnt lgkmcnt(3)
    v_mfma_f32_16x16x32_bf16 v[60:63], a[232:235], a[140:143], v[60:63]
    s_waitcnt lgkmcnt(2)
    ds_read_b128 a[216:219], v1 offset:6144
    v_mfma_f32_16x16x32_bf16 v[64:67], a[212:215], a[120:123], 0
    ds_read_b128 a[232:235], v1 offset:8192
    s_nop 3
    v_max3_f32 v98, v60, v61, v62
    s_waitcnt lgkmcnt(1)
    v_mfma_f32_16x16x32_bf16 v[64:67], a[216:219], a[124:127], v[64:67]
    ds_read_b128 a[228:231], v0 offset:8192
    v_mfma_f32_16x16x32_bf16 v[64:67], a[220:223], a[128:131], v[64:67]
    ds_read_b128 a[212:215], v0 offset:12288
    v_fma_f32 v52, v52, s28, v9
    v_mfma_f32_16x16x32_bf16 v[64:67], a[224:227], a[132:135], v[64:67]
    ds_read_b128 a[220:223], v0 offset:13312
    s_waitcnt lgkmcnt(2)
    v_mfma_f32_16x16x32_bf16 v[64:67], a[228:231], a[136:139], v[64:67]
    ds_read_b128 a[216:219], v1 offset:12288
    v_mfma_f32_16x16x32_bf16 v[64:67], a[232:235], a[140:143], v[64:67]
    ds_read_b128 a[224:227], v1 offset:13312
    s_nop 6
    v_max3_f32 v98, v98, v63, v64
    ds_read_b128 a[228:231], v0 offset:14336
    v_max3_f32 v98, v98, v65, v66
    v_max_f32 v98, v98, v67
    v_mov_b32 v99, v98
    s_nop 1
    v_permlane32_swap_b32 v99, v98
    v_max_f32 v98, v98, v99
    v_mov_b32 v99, v98
    s_nop 1
    v_permlane16_swap_b32 v99, v98
    v_max_f32 v98, v98, v99
    s_waitcnt vmcnt(12)
    s_add_u32 m0, s22, 24576
    s_nop 0
    buffer_load_dwordx4 v6, s[8:11], s21 offen lds
    s_add_u32 s21, s21, 128
    s_add_u32 m0, s22, 25600
    v_mfma_f32_16x16x32_bf16 v[44:47], a[236:239], v[14:17], 0
    buffer_load_dwordx4 v6, s[8:11], s21 offen lds
    v_mul_f32_e64 v10, -s28, v98
    s_add_u32 s21, s21, 128
    v_fma_f32 v65, v65, s28, v10
    ds_read_b128 a[144:147], v104 offset:12288
    s_add_u32 m0, s22, 26624
    s_nop 0
    buffer_load_dwordx4 v6, s[8:11], s21 offen lds
    v_exp_f32 v65, v65
    ds_read_b128 a[152:155], v104 offset:14336
    v_fma_f32 v60, v60, s28, v10
    v_fma_f32 v62, v62, s28, v10
    v_exp_f32 v60, v60
    v_fma_f32 v67, v67, s28, v10
    v_fma_f32 v53, v53, s28, v9
    v_fma_f32 v63, v63, s28, v10
    v_fma_f32 v66, v66, s28, v10
    v_exp_f32 v67, v67
    v_fma_f32 v61, v61, s28, v10
    v_exp_f32 v61, v61
    v_exp_f32 v62, v62
    v_exp_f32 v66, v66
    v_exp_f32 v63, v63
    v_cvt_pk_bf16_f32 v20, v60, v61
    v_cvt_pk_bf16_f32 v21, v62, v63
    v_fma_f32 v64, v64, s28, v10
    s_waitcnt lgkmcnt(2)
    v_mfma_f32_16x16x32_bf16 v[60:63], a[212:215], a[120:123], 0
    ds_read_b128 a[232:235], v1 offset:14336
    v_mfma_f32_16x16x32_bf16 v[60:63], a[216:219], a[124:127], v[60:63]
    ds_read_b128 a[148:151], v105 offset:12288
    v_mfma_f32_16x16x32_bf16 v[60:63], a[220:223], a[128:131], v[60:63]
    v_cvt_pk_bf16_f32 v23, v66, v67
    ds_read_b128 a[220:223], v0 offset:19456
    v_mfma_f32_16x16x32_bf16 v[60:63], a[224:227], a[132:135], v[60:63]
    ds_read_b128 a[216:219], v1 offset:18432
    v_mfma_f32_16x16x32_bf16 v[60:63], a[228:231], a[136:139], v[60:63]
    v_exp_f32 v64, v64
    ds_read_b128 a[224:227], v1 offset:19456
    ds_read_b128 a[212:215], v0 offset:18432
    v_cvt_pk_bf16_f32 v22, v64, v65
    s_waitcnt lgkmcnt(5)
    v_mfma_f32_16x16x32_bf16 v[60:63], a[232:235], a[140:143], v[60:63]
    ds_read_b128 a[156:159], v105 offset:14336
    s_waitcnt lgkmcnt(1)
    v_mfma_f32_16x16x32_bf16 v[64:67], a[212:215], a[120:123], 0
    ds_read_b128 a[228:231], v0 offset:20480
    v_mfma_f32_16x16x32_bf16 v[64:67], a[216:219], a[124:127], v[64:67]
    s_nop 2
    v_fma_f32 v60, v60, s28, v10
    ds_read_b128 a[232:235], v1 offset:20480
    v_mfma_f32_16x16x32_bf16 v[64:67], a[220:223], a[128:131], v[64:67]
    ds_read_b128 a[216:219], v1 offset:0
    v_mfma_f32_16x16x32_bf16 v[64:67], a[224:227], a[132:135], v[64:67]
    s_add_u32 s21, s21, 12032
    ds_read_b128 a[212:215], v0 offset:0
    s_waitcnt lgkmcnt(3)
    v_mfma_f32_16x16x32_bf16 v[64:67], a[228:231], a[136:139], v[64:67]
    ds_read_b128 a[224:227], v1 offset:1024
    s_waitcnt lgkmcnt(3)
    v_mfma_f32_16x16x32_bf16 v[64:67], a[232:235], a[140:143], v[64:67]
    ds_read_b128 a[160:163], v104 offset:16384
    s_waitcnt lgkmcnt(2)
    v_mfma_f32_16x16x32_bf16 v[68:71], a[212:215], a[144:147], 0
    ds_read_b128 a[220:223], v0 offset:1024
    v_mfma_f32_16x16x32_bf16 v[68:71], a[216:219], a[148:151], v[68:71]
    ds_read_b128 a[228:231], v0 offset:2048
    s_waitcnt lgkmcnt(1)
    v_mfma_f32_16x16x32_bf16 v[68:71], a[220:223], a[152:155], v[68:71]
    ds_read_b128 a[164:167], v105 offset:16384
    v_mfma_f32_16x16x32_bf16 v[68:71], a[224:227], a[156:159], v[68:71]
    s_waitcnt lgkmcnt(1)
    ds_read_b128 a[232:235], v1 offset:2048
    ds_read_b128 a[212:215], v0 offset:6144
    v_mfma_f32_16x16x32_bf16 v[68:71], a[228:231], a[160:163], v[68:71]
    ds_read_b128 a[220:223], v0 offset:7168
    ds_read_b128 a[216:219], v1 offset:6144
    s_waitcnt lgkmcnt(3)
    v_mfma_f32_16x16x32_bf16 v[68:71], a[232:235], a[164:167], v[68:71]
    s_waitcnt lgkmcnt(2)
    ds_read_b128 a[232:235], v1 offset:8192
    v_mfma_f32_16x16x32_bf16 v[72:75], a[212:215], a[144:147], 0
    s_waitcnt lgkmcnt(1)
    ds_read_b128 a[224:227], v1 offset:7168
    v_mfma_f32_16x16x32_bf16 v[72:75], a[216:219], a[148:151], v[72:75]
    ds_read_b128 a[228:231], v0 offset:8192
    v_exp_f32 v53, v53
    v_mfma_f32_16x16x32_bf16 v[72:75], a[220:223], a[152:155], v[72:75]
    ds_read_b128 a[216:219], v1 offset:12288
    s_waitcnt lgkmcnt(2)
    v_mfma_f32_16x16x32_bf16 v[72:75], a[224:227], a[156:159], v[72:75]
    ds_read_b128 a[220:223], v0 offset:13312
    v_max3_f32 v96, v68, v69, v70
    s_waitcnt lgkmcnt(2)
    v_mfma_f32_16x16x32_bf16 v[72:75], a[228:231], a[160:163], v[72:75]
    ds_read_b128 a[212:215], v0 offset:12288
    v_mfma_f32_16x16x32_bf16 v[72:75], a[232:235], a[164:167], v[72:75]
    s_nop 7
    v_max3_f32 v96, v96, v71, v72
    v_max3_f32 v96, v96, v73, v74
    v_max_f32 v96, v96, v75
    v_mov_b32 v97, v96
    s_nop 1
    v_permlane32_swap_b32 v97, v96
    v_max_f32 v96, v96, v97
    v_mov_b32 v97, v96
    s_nop 1
    v_permlane16_swap_b32 v97, v96
    v_max_f32 v96, v96, v97
    ds_read_b128 a[224:227], v1 offset:13312
    v_mul_f32_e64 v11, -s28, v96
    v_fma_f32 v71, v71, s28, v11
    v_fma_f32 v74, v74, s28, v11
    v_fma_f32 v70, v70, s28, v11
    v_fma_f32 v73, v73, s28, v11
    v_fma_f32 v72, v72, s28, v11
    v_exp_f32 v74, v74
    v_fma_f32 v75, v75, s28, v11
    v_fma_f32 v69, v69, s28, v11
    v_fma_f32 v68, v68, s28, v11
    v_exp_f32 v72, v72
    v_exp_f32 v69, v69
    v_exp_f32 v68, v68
    v_exp_f32 v71, v71
    v_exp_f32 v70, v70
    s_nop 0
    v_cvt_pk_bf16_f32 v27, v70, v71
    v_cvt_pk_bf16_f32 v26, v68, v69
    v_exp_f32 v73, v73
    s_waitcnt vmcnt(9)
    s_add_u32 m0, s22, 36864
    s_nop 0
    buffer_load_dwordx4 v6, s[8:11], s21 offen lds
    s_add_u32 s21, s21, 128
    s_add_u32 m0, s22, 37888
    s_waitcnt lgkmcnt(0)
    v_mfma_f32_16x16x32_bf16 v[68:71], a[212:215], a[144:147], 0
    buffer_load_dwordx4 v6, s[8:11], s21 offen lds
    ds_read_b128 a[232:235], v1 offset:14336
    s_add_u32 s21, s21, 128
    v_mfma_f32_16x16x32_bf16 v[68:71], a[216:219], a[148:151], v[68:71]
    s_add_u32 m0, s22, 38912
    ds_read_b128 a[228:231], v0 offset:14336
    ds_read_b128 a[212:215], v0 offset:18432
    buffer_load_dwordx4 v6, s[8:11], s21 offen lds
    v_mfma_f32_16x16x32_bf16 v[44:47], a[240:243], v[20:23], v[44:47]
    ds_read_b128 a[168:171], v104 offset:18432
    v_mfma_f32_16x16x32_bf16 v[68:71], a[220:223], a[152:155], v[68:71]
    v_fma_f32 v63, v63, s28, v10
    v_exp_f32 v75, v75
    ds_read_b128 a[220:223], v0 offset:19456
    v_fma_f32 v55, v55, s28, v9
    v_exp_f32 v52, v52
    ds_read_b128 a[216:219], v1 offset:18432
    v_mfma_f32_16x16x32_bf16 v[68:71], a[224:227], a[156:159], v[68:71]
    ds_read_b128 a[224:227], v1 offset:19456
    s_waitcnt lgkmcnt(5)
    v_mfma_f32_16x16x32_bf16 v[68:71], a[228:231], a[160:163], v[68:71]
    v_cvt_pk_bf16_f32 v29, v74, v75
    ds_read_b128 a[184:187], v104 offset:22528
    v_cvt_pk_bf16_f32 v28, v72, v73
    v_mfma_f32_16x16x32_bf16 v[68:71], a[232:235], a[164:167], v[68:71]
    s_waitcnt lgkmcnt(4)
    v_exp_f32 v55, v55
    ds_read_b128 a[176:179], v104 offset:20480
    v_mfma_f32_16x16x32_bf16 v[72:75], a[212:215], a[144:147], 0
    ds_read_b128 a[228:231], v0 offset:20480
    s_waitcnt lgkmcnt(4)
    v_mfma_f32_16x16x32_bf16 v[72:75], a[216:219], a[148:151], v[72:75]
    v_fma_f32 v61, v61, s28, v10
    ds_read_b128 a[232:235], v1 offset:20480
    v_mfma_f32_16x16x32_bf16 v[72:75], a[220:223], a[152:155], v[72:75]
    ds_read_b128 a[212:215], v0 offset:0
    ds_read_b128 a[216:219], v1 offset:0
    ds_read_b128 a[172:175], v105 offset:18432
    v_exp_f32 v63, v63
    ds_read_b128 a[220:223], v0 offset:1024
    s_waitcnt lgkmcnt(8)
    v_mfma_f32_16x16x32_bf16 v[72:75], a[224:227], a[156:159], v[72:75]
    ds_read_b128 a[224:227], v1 offset:1024
    ds_read_b128 a[180:183], v105 offset:20480
    s_waitcnt lgkmcnt(7)
    v_mfma_f32_16x16x32_bf16 v[72:75], a[228:231], a[160:163], v[72:75]
    v_exp_f32 v61, v61
    ds_read_b128 a[188:191], v105 offset:22528
    s_waitcnt lgkmcnt(7)
    v_mfma_f32_16x16x32_bf16 v[72:75], a[232:235], a[164:167], v[72:75]
    ds_read_b128 a[232:235], v1 offset:2048
    s_waitcnt lgkmcnt(6)
    v_mfma_f32_16x16x32_bf16 v[76:79], a[212:215], a[168:171], 0
    s_waitcnt lgkmcnt(5)
    ds_read_b128 a[228:231], v0 offset:2048
    v_mfma_f32_16x16x32_bf16 v[76:79], a[216:219], a[172:175], v[76:79]
    s_waitcnt lgkmcnt(5)
    ds_read_b128 a[212:215], v0 offset:6144
    v_mfma_f32_16x16x32_bf16 v[76:79], a[220:223], a[176:179], v[76:79]
    ds_read_b128 a[216:219], v1 offset:6144
    s_waitcnt lgkmcnt(5)
    v_mfma_f32_16x16x32_bf16 v[76:79], a[224:227], a[180:183], v[76:79]
    ds_read_b128 a[220:223], v0 offset:7168
    s_waitcnt lgkmcnt(3)
    v_mfma_f32_16x16x32_bf16 v[76:79], a[228:231], a[184:187], v[76:79]
    ds_read_b128 a[224:227], v1 offset:7168
    v_mfma_f32_16x16x32_bf16 v[76:79], a[232:235], a[188:191], v[76:79]
    s_waitcnt lgkmcnt(3)
    ds_read_b128 a[232:235], v1 offset:8192
    v_mfma_f32_16x16x32_bf16 v[80:83], a[212:215], a[168:171], 0
    s_waitcnt lgkmcnt(3)
    ds_read_b128 a[212:215], v0 offset:12288
    v_mfma_f32_16x16x32_bf16 v[80:83], a[216:219], a[172:175], v[80:83]
    s_waitcnt lgkmcnt(3)
    ds_read_b128 a[216:219], v1 offset:12288
    v_mfma_f32_16x16x32_bf16 v[80:83], a[220:223], a[176:179], v[80:83]
    v_max3_f32 v98, v76, v77, v78
    ds_read_b128 a[228:231], v0 offset:8192
    s_add_u32 s21, s21, 12032
    s_waitcnt lgkmcnt(4)
    v_mfma_f32_16x16x32_bf16 v[80:83], a[224:227], a[180:183], v[80:83]
    ds_read_b128 a[220:223], v0 offset:13312
    s_waitcnt lgkmcnt(1)
    v_mfma_f32_16x16x32_bf16 v[80:83], a[228:231], a[184:187], v[80:83]
    ds_read_b128 a[224:227], v1 offset:13312
    v_fma_f32 v54, v54, s28, v9
    v_mfma_f32_16x16x32_bf16 v[80:83], a[232:235], a[188:191], v[80:83]
    s_nop 7
    v_max3_f32 v98, v98, v79, v80
    v_max3_f32 v98, v98, v81, v82
    v_max_f32 v98, v98, v83
    v_mov_b32 v99, v98
    s_nop 1
    v_permlane32_swap_b32 v99, v98
    v_max_f32 v98, v98, v99
    v_mov_b32 v99, v98
    s_nop 1
    v_permlane16_swap_b32 v99, v98
    ds_read_b128 a[232:235], v1 offset:14336
    v_max_f32 v98, v98, v99
    v_mul_f32_e64 v12, -s28, v98
    v_fma_f32 v76, v76, s28, v12
    v_fma_f32 v79, v79, s28, v12
    v_fma_f32 v83, v83, s28, v12
    v_fma_f32 v77, v77, s28, v12
    v_fma_f32 v62, v62, s28, v10
    v_fma_f32 v78, v78, s28, v12
    v_exp_f32 v76, v76
    v_exp_f32 v79, v79
    v_exp_f32 v78, v78
    v_fma_f32 v82, v82, s28, v12
    v_exp_f32 v60, v60
    v_exp_f32 v77, v77
    s_nop 0
    v_cvt_pk_bf16_f32 v32, v76, v77
    v_cvt_pk_bf16_f32 v33, v78, v79
    v_mfma_f32_16x16x32_bf16 v[76:79], a[212:215], a[168:171], 0
    ds_read_b128 a[228:231], v0 offset:14336
    v_exp_f32 v83, v83
    v_mfma_f32_16x16x32_bf16 v[76:79], a[216:219], a[172:175], v[76:79]
    s_waitcnt lgkmcnt(2)
    ds_read_b128 a[216:219], v1 offset:18432
    v_exp_f32 v62, v62
    v_mfma_f32_16x16x32_bf16 v[76:79], a[220:223], a[176:179], v[76:79]
    v_fma_f32 v81, v81, s28, v12
    ds_read_b128 a[212:215], v0 offset:18432
    v_exp_f32 v82, v82
    v_exp_f32 v81, v81
    v_mfma_f32_16x16x32_bf16 v[76:79], a[224:227], a[180:183], v[76:79]
    ds_read_b128 a[224:227], v1 offset:19456
    s_waitcnt lgkmcnt(3)
    v_mfma_f32_16x16x32_bf16 v[76:79], a[228:231], a[184:187], v[76:79]
    v_fma_f32 v80, v80, s28, v12
    ds_read_b128 a[220:223], v0 offset:19456
    v_mfma_f32_16x16x32_bf16 v[76:79], a[232:235], a[188:191], v[76:79]
    v_cvt_pk_bf16_f32 v35, v82, v83
    v_exp_f32 v80, v80
    s_nop 0
    v_cvt_pk_bf16_f32 v34, v80, v81
    ds_read_b128 a[228:231], v0 offset:20480
    s_waitcnt lgkmcnt(3)
    v_mfma_f32_16x16x32_bf16 v[80:83], a[212:215], a[168:171], 0
    ds_read_b128 a[232:235], v1 offset:20480
    v_mfma_f32_16x16x32_bf16 v[80:83], a[216:219], a[172:175], v[80:83]
    ds_read_b128 a[216:219], v1 offset:0
    s_waitcnt lgkmcnt(3)
    v_mfma_f32_16x16x32_bf16 v[80:83], a[220:223], a[176:179], v[80:83]
    ds_read_b128 a[220:223], v0 offset:1024
    v_mfma_f32_16x16x32_bf16 v[44:47], a[244:247], v[26:29], v[44:47]
    v_cvt_pk_bf16_f32 v18, v52, v53
    ds_read_b128 a[212:215], v0 offset:0
    v_mfma_f32_16x16x32_bf16 v[80:83], a[224:227], a[180:183], v[80:83]
    s_waitcnt vmcnt(6)
    ds_read_b128 a[192:195], v104 offset:24576
    ds_read_b128 a[200:203], v104 offset:26624
    ds_read_b128 a[224:227], v1 offset:1024
    ds_read_b128 a[196:199], v105 offset:24576
    s_waitcnt lgkmcnt(6)
    v_mfma_f32_16x16x32_bf16 v[80:83], a[228:231], a[184:187], v[80:83]
    ds_read_b128 a[204:207], v105 offset:26624
    v_mfma_f32_16x16x32_bf16 v[80:83], a[232:235], a[188:191], v[80:83]
    ds_read_b128 a[232:235], v1 offset:2048
    v_mfma_f32_16x16x32_bf16 v[44:47], a[248:251], v[32:35], v[44:47]
    ds_read_b128 a[228:231], v0 offset:2048
    v_exp_f32 v54, v54
    s_waitcnt lgkmcnt(6)
    v_mfma_f32_16x16x32_bf16 v[84:87], a[212:215], a[192:195], 0
    ds_read_b128 a[212:215], v0 offset:6144
    s_waitcnt lgkmcnt(4)
    v_mfma_f32_16x16x32_bf16 v[84:87], a[216:219], a[196:199], v[84:87]
    ds_read_b128 a[216:219], v1 offset:6144
    v_mfma_f32_16x16x32_bf16 v[84:87], a[220:223], a[200:203], v[84:87]
    s_waitcnt lgkmcnt(4)
    ds_read_b128 a[220:223], v0 offset:7168
    v_mfma_f32_16x16x32_bf16 v[84:87], a[224:227], a[204:207], v[84:87]
    ds_read_b128 a[224:227], v1 offset:7168
    s_waitcnt lgkmcnt(4)
    v_mfma_f32_16x16x32_bf16 v[84:87], a[228:231], a[208:211], v[84:87]
    ds_read_b128 a[228:231], v0 offset:8192
    v_mfma_f32_16x16x32_bf16 v[84:87], a[232:235], v[92:95], v[84:87]
    ds_read_b128 a[232:235], v1 offset:8192
    s_waitcnt lgkmcnt(5)
    v_mfma_f32_16x16x32_bf16 v[88:91], a[212:215], a[192:195], 0
    s_waitcnt lgkmcnt(4)
    v_mfma_f32_16x16x32_bf16 v[88:91], a[216:219], a[196:199], v[88:91]
    s_waitcnt lgkmcnt(3)
    v_mfma_f32_16x16x32_bf16 v[88:91], a[220:223], a[200:203], v[88:91]
    s_nop 0
    v_max3_f32 v96, v84, v85, v86
    s_waitcnt vmcnt(63) lgkmcnt(0)
    s_barrier
    ds_read_b128 a[216:219], v1 offset:12288
    v_mfma_f32_16x16x32_bf16 v[88:91], a[224:227], a[204:207], v[88:91]
    s_add_u32 m0, s22, 0
    ds_read_b128 a[224:227], v1 offset:13312
    buffer_load_dwordx4 v6, s[4:7], s20 offen lds
    s_add_u32 s20, s20, 128
    v_mfma_f32_16x16x32_bf16 v[88:91], a[228:231], a[208:211], v[88:91]
    s_add_u32 m0, s22, 1024
    ds_read_b128 a[212:215], v0 offset:12288
    buffer_load_dwordx4 v6, s[4:7], s20 offen lds
    v_mfma_f32_16x16x32_bf16 v[88:91], a[232:235], v[92:95], v[88:91]
    s_add_u32 s20, s20, 128
    s_add_u32 m0, s22, 2048
    ds_read_b128 a[220:223], v0 offset:13312
    buffer_load_dwordx4 v6, s[4:7], s20 offen lds
    s_add_u32 s20, s20, 12032
    ds_read_b128 a[232:235], v1 offset:14336
    s_mov_b32 s39, s64
    ds_read_b128 a[228:231], v0 offset:14336
    v_max3_f32 v96, v96, v87, v88
    v_max3_f32 v96, v96, v89, v90
    v_max_f32 v96, v96, v91
    v_mov_b32 v97, v96
    s_add_u32 s37, s37, 1
    s_bitcmp1_b32 s63, s37
    v_permlane32_swap_b32 v97, v96
    v_max_f32 v96, v96, v97
    v_mov_b32 v97, v96
    s_cselect_b32 s62, 4294770688, 0
    s_cselect_b32 s42, 0, 325632
    v_permlane16_swap_b32 v97, v96
    v_max_f32 v96, v96, v97
    v_mul_f32_e64 v13, -s28, v96
    v_fma_f32 v87, v87, s28, v13
    v_fma_f32 v86, v86, s28, v13
    v_fma_f32 v84, v84, s28, v13
    v_fma_f32 v85, v85, s28, v13
    v_exp_f32 v85, v85
    v_exp_f32 v84, v84
    v_exp_f32 v87, v87
    s_add_u32 s35, s35, s42
    v_exp_f32 v86, v86
    v_cvt_pk_bf16_f32 v38, v84, v85
    v_cvt_pk_bf16_f32 v39, v86, v87
    s_waitcnt lgkmcnt(2)
    v_mfma_f32_16x16x32_bf16 v[84:87], a[212:215], a[192:195], 0
    s_lshl_b32 s42, s37, 1
    ds_read_b128 a[212:215], v0 offset:18432
    v_fma_f32 v88, v88, s28, v13
    v_mfma_f32_16x16x32_bf16 v[84:87], a[216:219], a[196:199], v[84:87]
    s_lshr_b32 s42, s31, s42
    ds_read_b128 a[216:219], v1 offset:18432
    v_fma_f32 v89, v89, s28, v13
    v_mfma_f32_16x16x32_bf16 v[84:87], a[220:223], a[200:203], v[84:87]
    s_and_b32 s42, s42, 3
    ds_read_b128 a[220:223], v0 offset:19456
    v_fma_f32 v90, v90, s28, v13
    v_mfma_f32_16x16x32_bf16 v[84:87], a[224:227], a[204:207], v[84:87]
    s_waitcnt lgkmcnt(3)
    ds_read_b128 a[224:227], v1 offset:19456
    s_add_u32 s42, s42, s36
    v_mfma_f32_16x16x32_bf16 v[84:87], a[228:231], a[208:211], v[84:87]
    s_sub_u32 s43, s42, 3
    ds_read_b128 a[228:231], v0 offset:20480
    v_fma_f32 v91, v91, s28, v13
    v_mfma_f32_16x16x32_bf16 v[84:87], a[232:235], v[92:95], v[84:87]
    s_cmp_ge_u32 s42, 3
    ds_read_b128 a[232:235], v1 offset:20480
    s_cselect_b32 s42, s43, s42
    s_mul_i32 s44, s3, 5
    s_mov_b32 s32, 1
    v_exp_f32 v89, v89
    s_lshl_b32 s43, s3, 2
    s_add_u32 s45, s43, 21
    s_cmp_eq_u32 s3, 0
    s_cselect_b32 s45, 20, s45
    s_cselect_b32 s33, 1, 0
    s_cmp_eq_u32 s42, 1
    s_cselect_b32 s44, s45, s44
    s_cselect_b32 s32, s33, s32
    s_add_u32 s45, s43, 37
    s_cmp_eq_u32 s42, 2
    s_cselect_b32 s44, s45, s44
    v_exp_f32 v88, v88
    s_cselect_b32 s32, 0, s32
    v_exp_f32 v90, v90
    s_mul_i32 s44, s44, 6144
    s_add_u32 s33, s35, s44
    s_mul_i32 s42, s32, 6144
    v_exp_f32 v91, v91
    s_add_u32 s42, s42, 24576
    s_add_u32 s42, s42, s33
    s_cmp_ge_u32 s37, 6
    s_cselect_b32 s14, 0, s42
    s_add_u32 s24, s67, 256
    v_cvt_pk_bf16_f32 v41, v90, v91
    v_cvt_pk_bf16_f32 v40, v88, v89
    s_add_u32 s25, s33, 256
    s_add_u32 s23, s38, 4096
    s_mov_b32 s27, 0x249
    s_mov_b32 s30, 0
    s_waitcnt vmcnt(6) lgkmcnt(0)
    v_mfma_f32_16x16x32_bf16 v[88:91], a[212:215], a[192:195], 0
    s_barrier
    ds_read_b64_tr_b16 a[212:213], v2 offset:0
    ds_read_b64_tr_b16 a[214:215], v2 offset:6144
    v_mfma_f32_16x16x32_bf16 v[88:91], a[216:219], a[196:199], v[88:91]
    s_add_u32 m0, s22, 12288
    ds_read_b64_tr_b16 a[216:217], v3 offset:0
    ds_read_b64_tr_b16 a[218:219], v3 offset:6144
    buffer_load_dwordx4 v6, s[4:7], s20 offen lds
    v_mfma_f32_16x16x32_bf16 v[88:91], a[220:223], a[200:203], v[88:91]
    v_cvt_pk_bf16_f32 v25, v62, v63
    ds_read_b64_tr_b16 a[220:221], v4 offset:0
    v_mfma_f32_16x16x32_bf16 v[88:91], a[224:227], a[204:207], v[88:91]
    ds_read_b64_tr_b16 a[222:223], v4 offset:6144
    s_add_u32 s20, s20, 128
    s_add_u32 m0, s22, 13312
    s_nop 0
    buffer_load_dwordx4 v6, s[4:7], s20 offen lds
    v_mfma_f32_16x16x32_bf16 v[88:91], a[228:231], a[208:211], v[88:91]
    ds_read_b64_tr_b16 a[224:225], v5 offset:0
    v_cvt_pk_bf16_f32 v24, v60, v61
    s_add_u32 s20, s20, 128
    v_mfma_f32_16x16x32_bf16 v[44:47], a[252:255], v[38:41], v[44:47]
    ds_read_b64_tr_b16 a[226:227], v5 offset:6144
    v_cvt_pk_bf16_f32 v19, v54, v55
    s_add_u32 m0, s22, 14336
    s_nop 0
    buffer_load_dwordx4 v6, s[4:7], s20 offen lds
    s_add_u32 s20, s20, 12032
    v_mfma_f32_16x16x32_bf16 v[88:91], a[232:235], v[92:95], v[88:91]
    s_waitcnt lgkmcnt(4)
    v_mfma_f32_16x16x32_bf16 v[112:115], a[212:215], v[14:17], 0
    ds_read_b64_tr_b16 a[234:235], v3 offset:7168
    v_add_u32 v103, 4096, v103
    v_mfma_f32_16x16x32_bf16 v[116:119], a[216:219], v[14:17], 0
    v_fma_f32 v82, v82, s28, v12
    v_fma_f32 v59, v59, s28, v9
    v_mfma_f32_16x16x32_bf16 v[164:167], a[216:219], v[20:23], 0
    v_fma_f32 v57, v57, s28, v9
    v_mfma_f32_16x16x32_bf16 v[160:163], a[212:215], v[20:23], 0
    v_fma_f32 v75, v75, s28, v11
    v_fma_f32 v91, v91, s28, v13
    v_mfma_f32_16x16x32_bf16 v[208:211], a[212:215], v[26:29], 0
    ds_read_b64_tr_b16 a[230:231], v2 offset:7168
    v_fma_f32 v84, v84, s28, v13
    v_mfma_f32_16x16x32_bf16 v[212:215], a[216:219], v[26:29], 0
    ds_read_b64_tr_b16 a[228:229], v2 offset:1024
    v_mfma_f32_16x16x32_bf16 a[4:7], a[216:219], v[32:35], 0
    v_mfma_f32_16x16x32_bf16 a[0:3], a[212:215], v[32:35], 0
    v_fma_f32 v70, v70, s28, v11
    v_mfma_f32_16x16x32_bf16 a[48:51], a[212:215], v[38:41], 0
    ds_read_b64_tr_b16 a[232:233], v3 offset:1024
    v_fma_f32 v71, v71, s28, v11
    v_mfma_f32_16x16x32_bf16 a[52:55], a[216:219], v[38:41], 0
    s_waitcnt lgkmcnt(4)
    ds_read_b64_tr_b16 a[214:215], v4 offset:7168
    v_fma_f32 v79, v79, s28, v12
    v_mfma_f32_16x16x32_bf16 a[56:59], a[220:223], v[38:41], 0
    v_fma_f32 v69, v69, s28, v11
    v_mfma_f32_16x16x32_bf16 a[60:63], a[224:227], v[38:41], 0
    ds_read_b64_tr_b16 a[216:217], v5 offset:1024
    v_fma_f32 v81, v81, s28, v12
    v_mfma_f32_16x16x32_bf16 a[12:15], a[224:227], v[32:35], 0
    v_exp_f32 v69, v69
    v_mfma_f32_16x16x32_bf16 a[8:11], a[220:223], v[32:35], 0
    v_fma_f32 v76, v76, s28, v12
    v_fma_f32 v87, v87, s28, v13
    v_mfma_f32_16x16x32_bf16 v[216:219], a[220:223], v[26:29], 0
    ds_read_b64_tr_b16 a[212:213], v4 offset:1024
    v_fma_f32 v56, v56, s28, v9
    v_mfma_f32_16x16x32_bf16 v[220:223], a[224:227], v[26:29], 0
    v_exp_f32 v79, v79
    v_mfma_f32_16x16x32_bf16 v[172:175], a[224:227], v[20:23], 0
    ds_read_b64_tr_b16 a[218:219], v5 offset:7168
    v_fma_f32 v58, v58, s28, v9
    v_mfma_f32_16x16x32_bf16 v[168:171], a[220:223], v[20:23], 0
    v_exp_f32 v87, v87
    v_mfma_f32_16x16x32_bf16 v[120:123], a[220:223], v[14:17], 0
    v_fma_f32 v64, v64, s28, v10
    v_fma_f32 v67, v67, s28, v10
    v_mfma_f32_16x16x32_bf16 v[124:127], a[224:227], v[14:17], 0
    s_waitcnt lgkmcnt(3)
    v_fma_f32 v83, v83, s28, v12
    v_fma_f32 v86, v86, s28, v13
    v_mfma_f32_16x16x32_bf16 v[128:131], a[228:231], v[14:17], 0
    s_add_u32 s39, s39, 12288
    v_exp_f32 v70, v70
    v_mfma_f32_16x16x32_bf16 v[132:135], a[232:235], v[14:17], 0
    ds_read_b64_tr_b16 a[220:221], v2 offset:2048
    v_mfma_f32_16x16x32_bf16 v[180:183], a[232:235], v[20:23], 0
    ds_read_b64_tr_b16 a[224:225], v3 offset:2048
    v_fma_f32 v65, v65, s28, v10
    v_mfma_f32_16x16x32_bf16 v[176:179], a[228:231], v[20:23], 0
    ds_read_b64_tr_b16 a[226:227], v3 offset:8192
    v_fma_f32 v77, v77, s28, v12
    v_mfma_f32_16x16x32_bf16 v[224:227], a[228:231], v[26:29], 0
    v_fma_f32 v90, v90, s28, v13
    v_fma_f32 v89, v89, s28, v13
    v_mfma_f32_16x16x32_bf16 v[228:231], a[232:235], v[26:29], 0
    v_exp_f32 v71, v71
    v_mfma_f32_16x16x32_bf16 a[20:23], a[232:235], v[32:35], 0
    v_exp_f32 v76, v76
    v_mfma_f32_16x16x32_bf16 a[16:19], a[228:231], v[32:35], 0
    ds_read_b64_tr_b16 a[222:223], v2 offset:8192
    v_fma_f32 v74, v74, s28, v11
    v_mfma_f32_16x16x32_bf16 a[64:67], a[228:231], v[38:41], 0
    ds_read_b64_tr_b16 a[228:229], v4 offset:2048
    v_fma_f32 v68, v68, s28, v11
    v_mfma_f32_16x16x32_bf16 a[68:71], a[232:235], v[38:41], 0
    s_waitcnt lgkmcnt(5)
    v_exp_f32 v58, v58
    v_mfma_f32_16x16x32_bf16 a[72:75], a[212:215], v[38:41], 0
    v_exp_f32 v57, v57
    v_mfma_f32_16x16x32_bf16 a[76:79], a[216:219], v[38:41], 0
    v_exp_f32 v91, v91
    v_mfma_f32_16x16x32_bf16 a[28:31], a[216:219], v[32:35], 0
    ds_read_b64_tr_b16 a[234:235], v5 offset:8192
    v_cvt_pk_bf16_f32 v31, v70, v71
    v_mfma_f32_16x16x32_bf16 a[24:27], a[212:215], v[32:35], 0
    ds_read_b64_tr_b16 a[230:231], v4 offset:8192
    v_mfma_f32_16x16x32_bf16 v[232:235], a[212:215], v[26:29], 0
    ds_read_b64_tr_b16 a[232:233], v5 offset:2048
    v_mfma_f32_16x16x32_bf16 v[236:239], a[216:219], v[26:29], 0
    v_exp_f32 v74, v74
    v_mfma_f32_16x16x32_bf16 v[188:191], a[216:219], v[20:23], 0
    v_exp_f32 v64, v64
    v_mfma_f32_16x16x32_bf16 v[184:187], a[212:215], v[20:23], 0
    v_exp_f32 v68, v68
    v_mfma_f32_16x16x32_bf16 v[136:139], a[212:215], v[14:17], 0
    v_fma_f32 v73, v73, s28, v11
    v_mfma_f32_16x16x32_bf16 v[140:143], a[216:219], v[14:17], 0
    s_waitcnt lgkmcnt(3)
    v_exp_f32 v77, v77
    v_mfma_f32_16x16x32_bf16 v[144:147], a[220:223], v[14:17], 0
    v_fma_f32 v85, v85, s28, v13
    v_fma_f32 v78, v78, s28, v12
    v_mfma_f32_16x16x32_bf16 v[148:151], a[224:227], v[14:17], 0
    v_exp_f32 v84, v84
    v_mfma_f32_16x16x32_bf16 v[196:199], a[224:227], v[20:23], 0
    v_exp_f32 v59, v59
    v_mfma_f32_16x16x32_bf16 v[192:195], a[220:223], v[20:23], 0
    v_exp_f32 v86, v86
    v_mfma_f32_16x16x32_bf16 v[240:243], a[220:223], v[26:29], 0
    s_waitcnt vmcnt(3) lgkmcnt(0)
    v_exp_f32 v90, v90
    v_mfma_f32_16x16x32_bf16 v[244:247], a[224:227], v[26:29], 0
    v_exp_f32 v85, v85
    v_mfma_f32_16x16x32_bf16 a[36:39], a[224:227], v[32:35], 0
    s_add_u32 m0, s22, 24576
    v_exp_f32 v78, v78
    v_mfma_f32_16x16x32_bf16 a[32:35], a[220:223], v[32:35], 0
    s_barrier
    v_mfma_f32_16x16x32_bf16 a[80:83], a[220:223], v[38:41], 0
    buffer_load_dwordx4 v6, s[8:11], s21 offen lds
    v_mfma_f32_16x16x32_bf16 a[84:87], a[224:227], v[38:41], 0
    ds_read_b128 a[212:215], v0 offset:0
    v_cvt_pk_bf16_f32 v30, v68, v69
    v_mfma_f32_16x16x32_bf16 a[88:91], a[228:231], v[38:41], 0
    s_add_u32 s21, s21, 128
    ds_read_b128 a[216:219], v1 offset:0
    v_mfma_f32_16x16x32_bf16 a[92:95], a[232:235], v[38:41], 0
    ds_read_b128 a[220:223], v0 offset:1024
    v_cvt_pk_bf16_f32 v37, v78, v79
    v_mfma_f32_16x16x32_bf16 a[44:47], a[232:235], v[32:35], 0
    v_exp_f32 v56, v56
    v_mfma_f32_16x16x32_bf16 a[40:43], a[228:231], v[32:35], 0
    s_add_u32 m0, s22, 25600
    v_mfma_f32_16x16x32_bf16 v[248:251], a[228:231], v[26:29], 0
    buffer_load_dwordx4 v6, s[8:11], s21 offen lds
    v_mfma_f32_16x16x32_bf16 v[252:255], a[232:235], v[26:29], 0
    s_add_u32 s21, s21, 128
    v_cvt_pk_bf16_f32 v43, v86, v87
    v_mfma_f32_16x16x32_bf16 v[204:207], a[232:235], v[20:23], 0
    v_mfma_f32_16x16x32_bf16 v[200:203], a[228:231], v[20:23], 0
    s_add_u32 m0, s22, 26624
    v_mfma_f32_16x16x32_bf16 v[152:155], a[228:231], v[14:17], 0
    buffer_load_dwordx4 v6, s[8:11], s21 offen lds
    v_mfma_f32_16x16x32_bf16 v[156:159], a[232:235], v[14:17], 0
    s_waitcnt lgkmcnt(2)
    v_cvt_pk_bf16_f32 v16, v56, v57
    v_fma_f32 v88, v88, s28, v13
    v_mfma_f32_16x16x32_bf16 v[52:55], a[212:215], a[96:99], 0
    s_waitcnt lgkmcnt(1)
    ds_read_b128 a[232:235], v1 offset:2048
    v_fma_f32 v80, v80, s28, v12
    v_mfma_f32_16x16x32_bf16 v[52:55], a[216:219], a[100:103], v[52:55]
    s_waitcnt lgkmcnt(1)
    v_cvt_pk_bf16_f32 v42, v84, v85
    v_fma_f32 v72, v72, s28, v11
    v_mfma_f32_16x16x32_bf16 v[52:55], a[220:223], a[104:107], v[52:55]
    v_cvt_pk_bf16_f32 v41, v90, v91
    v_mfma_f32_16x16x32_bf16 v[60:63], a[220:223], a[128:131], 0
    ds_read_b128 a[228:231], v0 offset:2048
    v_mfma_f32_16x16x32_bf16 v[60:63], a[216:219], a[124:127], v[60:63]
    ds_read_b128 a[224:227], v1 offset:1024
    v_cvt_pk_bf16_f32 v36, v76, v77
    v_mfma_f32_16x16x32_bf16 v[60:63], a[212:215], a[120:123], v[60:63]
    v_exp_f32 v73, v73
    v_mfma_f32_16x16x32_bf16 v[68:71], a[212:215], a[144:147], 0
    v_exp_f32 v81, v81
    v_mfma_f32_16x16x32_bf16 v[68:71], a[216:219], a[148:151], v[68:71]
    v_exp_f32 v82, v82
    v_mfma_f32_16x16x32_bf16 v[68:71], a[220:223], a[152:155], v[68:71]
    v_exp_f32 v88, v88
    v_mfma_f32_16x16x32_bf16 v[76:79], a[220:223], a[176:179], 0
    v_exp_f32 v65, v65
    v_mfma_f32_16x16x32_bf16 v[76:79], a[216:219], a[172:175], v[76:79]
    v_exp_f32 v67, v67
    v_mfma_f32_16x16x32_bf16 v[76:79], a[212:215], a[168:171], v[76:79]
    v_exp_f32 v89, v89
    v_mfma_f32_16x16x32_bf16 v[84:87], a[212:215], a[192:195], 0
    v_exp_f32 v83, v83
    v_mfma_f32_16x16x32_bf16 v[84:87], a[216:219], a[196:199], v[84:87]
    v_exp_f32 v80, v80
    v_mfma_f32_16x16x32_bf16 v[84:87], a[220:223], a[200:203], v[84:87]
    s_waitcnt lgkmcnt(0)
    ds_read_b128 a[212:215], v0 offset:6144
    v_mfma_f32_16x16x32_bf16 v[84:87], a[224:227], a[204:207], v[84:87]
    s_add_u32 s21, s21, 12032
    v_fma_f32 v66, v66, s28, v10
    v_cvt_pk_bf16_f32 v22, v64, v65
    v_mfma_f32_16x16x32_bf16 v[84:87], a[228:231], a[208:211], v[84:87]
    s_add_u32 m0, s38, 0
    v_exp_f32 v66, v66
    v_mfma_f32_16x16x32_bf16 v[84:87], a[232:235], v[92:95], v[84:87]
    v_mfma_f32_16x16x32_bf16 v[76:79], a[232:235], a[188:191], v[76:79]
    v_exp_f32 v75, v75
    v_mfma_f32_16x16x32_bf16 v[76:79], a[228:231], a[184:187], v[76:79]
    buffer_load_dwordx4 v6, s[12:15], s33 offen nt lds
    v_mfma_f32_16x16x32_bf16 v[76:79], a[224:227], a[180:183], v[76:79]
    v_exp_f32 v72, v72
    v_mfma_f32_16x16x32_bf16 v[68:71], a[224:227], a[156:159], v[68:71]
    v_cvt_pk_bf16_f32 v40, v88, v89
    v_mfma_f32_16x16x32_bf16 v[68:71], a[228:231], a[160:163], v[68:71]
    ds_read_b128 a[220:223], v0 offset:7168
    v_mfma_f32_16x16x32_bf16 v[68:71], a[232:235], a[164:167], v[68:71]
    ds_read_b128 a[216:219], v1 offset:6144
    s_add_u32 m0, s38, 1024
    v_mfma_f32_16x16x32_bf16 v[60:63], a[232:235], a[140:143], v[60:63]
    v_cvt_pk_bf16_f32 v29, v74, v75
    v_cvt_pk_bf16_f32 v35, v82, v83
    v_mfma_f32_16x16x32_bf16 v[60:63], a[228:231], a[136:139], v[60:63]
    buffer_load_dwordx4 v7, s[12:15], s33 offen nt lds
    v_mfma_f32_16x16x32_bf16 v[60:63], a[224:227], a[132:135], v[60:63]
    v_mfma_f32_16x16x32_bf16 v[52:55], a[224:227], a[108:111], v[52:55]
    ds_read_b128 a[224:227], v1 offset:7168
    v_mfma_f32_16x16x32_bf16 v[52:55], a[228:231], a[112:115], v[52:55]
    v_cvt_pk_bf16_f32 v17, v58, v59
    v_cvt_pk_bf16_f32 v23, v66, v67
    v_mfma_f32_16x16x32_bf16 v[52:55], a[232:235], a[116:119], v[52:55]
    ds_read_b128 a[228:231], v0 offset:8192
    v_cvt_pk_bf16_f32 v34, v80, v81
    v_mfma_f32_16x16x32_bf16 v[48:51], a[236:239], v[16:19], v[44:47]
    ds_read_b128 a[232:235], v1 offset:8192
    v_cvt_pk_bf16_f32 v28, v72, v73
    v_mfma_f32_16x16x32_bf16 v[48:51], a[240:243], v[22:25], v[48:51]
    s_nop 0
    v_mfma_f32_16x16x32_bf16 v[48:51], a[244:247], v[28:31], v[48:51]
    v_mfma_f32_16x16x32_bf16 v[48:51], a[248:251], v[34:37], v[48:51]
    v_mfma_f32_16x16x32_bf16 v[48:51], a[252:255], v[40:43], v[48:51]
    s_add_u32 s59, s33, 128
    s_add_u32 m0, s38, 2048
    s_waitcnt lgkmcnt(3)
    v_mfma_f32_16x16x32_bf16 v[56:59], a[212:215], a[96:99], 0
    buffer_load_dwordx4 v6, s[12:15], s59 offen nt lds
    v_mfma_f32_16x16x32_bf16 v[56:59], a[216:219], a[100:103], v[56:59]
    s_add_u32 m0, s38, 3072
    s_nop 0
    v_cmp_lt_f32 vcc, s29, v48
    v_mfma_f32_16x16x32_bf16 v[56:59], a[220:223], a[104:107], v[56:59]
    v_mfma_f32_16x16x32_bf16 v[64:67], a[220:223], a[128:131], 0
    buffer_load_dwordx4 v7, s[12:15], s59 offen nt lds
    v_mfma_f32_16x16x32_bf16 v[64:67], a[216:219], a[124:127], v[64:67]
    s_nop 0
    s_cbranch_vccnz L_rs_start5b
L_ret_start5b:
    v_mfma_f32_16x16x32_bf16 v[64:67], a[212:215], a[120:123], v[64:67]
    s_waitcnt vmcnt(13) lgkmcnt(0)
    v_fma_f32 v63, v63, s28, v10
    v_fma_f32 v62, v62, s28, v10
    v_mfma_f32_16x16x32_bf16 v[72:75], a[212:215], a[144:147], 0
    s_barrier
    v_mfma_f32_16x16x32_bf16 v[72:75], a[216:219], a[148:151], v[72:75]
    v_fma_f32 v60, v60, s28, v10
    v_mfma_f32_16x16x32_bf16 v[72:75], a[220:223], a[152:155], v[72:75]
    v_exp_f32 v62, v62
    v_mfma_f32_16x16x32_bf16 v[80:83], a[220:223], a[176:179], 0
    s_add_u32 m0, s22, 0
    v_fma_f32 v53, v53, s28, v9
    v_fma_f32 v61, v61, s28, v10
    v_mfma_f32_16x16x32_bf16 v[80:83], a[216:219], a[172:175], v[80:83]
    buffer_load_dwordx4 v6, s[4:7], s20 offen lds
    v_mfma_f32_16x16x32_bf16 v[80:83], a[212:215], a[168:171], v[80:83]
    v_fma_f32 v55, v55, s28, v9
    s_add_u32 s20, s20, 128
    v_mfma_f32_16x16x32_bf16 v[88:91], a[212:215], a[192:195], 0
    ds_read_b64_tr_b16 a[212:213], v2 offset:18432
    s_add_u32 m0, s22, 1024
    v_mfma_f32_16x16x32_bf16 v[88:91], a[216:219], a[196:199], v[88:91]
    buffer_load_dwordx4 v6, s[4:7], s20 offen lds
    v_mfma_f32_16x16x32_bf16 v[88:91], a[220:223], a[200:203], v[88:91]
    ds_read_b64_tr_b16 a[214:215], v2 offset:12288
    s_add_u32 s20, s20, 128
    v_mfma_f32_16x16x32_bf16 v[88:91], a[224:227], a[204:207], v[88:91]
    s_add_u32 m0, s22, 2048
    v_exp_f32 v63, v63
    v_mfma_f32_16x16x32_bf16 v[88:91], a[228:231], a[208:211], v[88:91]
    ds_read_b64_tr_b16 a[216:217], v3 offset:18432
    v_fma_f32 v52, v52, s28, v9
    v_mfma_f32_16x16x32_bf16 v[88:91], a[232:235], v[92:95], v[88:91]
    buffer_load_dwordx4 v6, s[4:7], s20 offen lds
    v_mfma_f32_16x16x32_bf16 v[80:83], a[232:235], a[188:191], v[80:83]
    ds_read_b64_tr_b16 a[218:219], v3 offset:12288
    v_fma_f32 v54, v54, s28, v9
    v_mfma_f32_16x16x32_bf16 v[80:83], a[228:231], a[184:187], v[80:83]
    v_exp_f32 v54, v54
    v_mfma_f32_16x16x32_bf16 v[80:83], a[224:227], a[180:183], v[80:83]
    v_exp_f32 v60, v60
    v_mfma_f32_16x16x32_bf16 v[72:75], a[224:227], a[156:159], v[72:75]
    v_exp_f32 v61, v61
    v_mfma_f32_16x16x32_bf16 v[72:75], a[228:231], a[160:163], v[72:75]
    ds_read_b64_tr_b16 a[220:221], v4 offset:18432
    v_mfma_f32_16x16x32_bf16 v[72:75], a[232:235], a[164:167], v[72:75]
    ds_read_b64_tr_b16 a[222:223], v4 offset:12288
    v_mfma_f32_16x16x32_bf16 v[64:67], a[232:235], a[140:143], v[64:67]
    v_exp_f32 v52, v52
    v_mfma_f32_16x16x32_bf16 v[64:67], a[228:231], a[136:139], v[64:67]
    v_exp_f32 v53, v53
    v_mfma_f32_16x16x32_bf16 v[64:67], a[224:227], a[132:135], v[64:67]
    v_exp_f32 v55, v55
    v_mfma_f32_16x16x32_bf16 v[56:59], a[224:227], a[108:111], v[56:59]
    v_cvt_pk_bf16_f32 v15, v54, v55
    v_cvt_pk_bf16_f32 v20, v60, v61
    v_mfma_f32_16x16x32_bf16 v[56:59], a[228:231], a[112:115], v[56:59]
    ds_read_b64_tr_b16 a[224:225], v5 offset:18432
    v_cvt_pk_bf16_f32 v14, v52, v53
    v_mfma_f32_16x16x32_bf16 v[56:59], a[232:235], a[116:119], v[56:59]
    s_add_u32 s20, s20, 12032
    ds_read_b64_tr_b16 a[226:227], v5 offset:12288
    v_cvt_pk_bf16_f32 v21, v62, v63
    s_branch L_loop5
L_start4:
    s_add_u32 m0, s22, 0
    s_nop 0
    buffer_load_dwordx4 v6, s[4:7], s20 offen lds
    s_add_u32 s20, s20, 128
    s_add_u32 m0, s22, 1024
    s_nop 0
    buffer_load_dwordx4 v6, s[4:7], s20 offen lds
    s_add_u32 s20, s20, 128
    s_add_u32 m0, s22, 2048
    s_nop 0
    buffer_load_dwordx4 v6, s[4:7], s20 offen lds
    s_add_u32 s20, s20, 12032
    s_add_u32 m0, s22, 12288
    s_nop 0
    buffer_load_dwordx4 v6, s[4:7], s20 offen lds
    s_add_u32 s20, s20, 128
    s_add_u32 m0, s22, 13312
    s_nop 0
    buffer_load_dwordx4 v6, s[4:7], s20 offen lds
    s_add_u32 s20, s20, 128
    s_add_u32 m0, s22, 14336
    s_nop 0
    buffer_load_dwordx4 v6, s[4:7], s20 offen lds
    s_add_u32 s20, s20, 12032
    s_add_u32 s48, s34, 0
    s_add_u32 m0, s38, 0
    s_nop 0
    buffer_load_dwordx4 v6, s[12:15], s48 offen nt lds
    s_add_u32 m0, s38, 1024
    s_nop 0
    buffer_load_dwordx4 v7, s[12:15], s48 offen nt lds
    s_add_u32 s48, s34, 128
    s_add_u32 m0, s38, 2048
    s_nop 0
    buffer_load_dwordx4 v6, s[12:15], s48 offen nt lds
    s_add_u32 m0, s38, 3072
    s_nop 0
    buffer_load_dwordx4 v7, s[12:15], s48 offen nt lds
    s_add_u32 s48, s34, 256
    s_add_u32 m0, s38, 4096
    s_nop 0
    buffer_load_dwordx4 v6, s[12:15], s48 offen nt lds
    s_add_u32 m0, s38, 5120
    s_nop 0
    buffer_load_dwordx4 v7, s[12:15], s48 offen nt lds
    s_add_u32 s48, s34, 6144
    s_add_u32 m0, s38, 6144
    s_nop 0
    buffer_load_dwordx4 v6, s[12:15], s48 offen nt lds
    s_add_u32 m0, s38, 7168
    s_nop 0
    buffer_load_dwordx4 v7, s[12:15], s48 offen nt lds
    s_add_u32 s48, s34, 6272
    s_add_u32 m0, s38, 8192
    s_nop 0
    buffer_load_dwordx4 v6, s[12:15], s48 offen nt lds
    s_add_u32 m0, s38, 9216
    s_nop 0
    buffer_load_dwordx4 v7, s[12:15], s48 offen nt lds
    s_add_u32 s48, s34, 6400
    s_add_u32 m0, s38, 10240
    s_nop 0
    buffer_load_dwordx4 v6, s[12:15], s48 offen nt lds
    s_add_u32 m0, s38, 11264
    s_nop 0
    buffer_load_dwordx4 v7, s[12:15], s48 offen nt lds
    s_add_u32 s48, s34, 12288
    s_add_u32 m0, s38, 12288
    s_nop 0
    buffer_load_dwordx4 v6, s[12:15], s48 offen nt lds
    s_add_u32 m0, s38, 13312
    s_nop 0
    buffer_load_dwordx4 v7, s[12:15], s48 offen nt lds
    s_add_u32 s48, s34, 12416
    s_add_u32 m0, s38, 14336
    s_nop 0
    buffer_load_dwordx4 v6, s[12:15], s48 offen nt lds
    s_add_u32 m0, s38, 15360
    s_nop 0
    buffer_load_dwordx4 v7, s[12:15], s48 offen nt lds
    s_add_u32 s48, s34, 12544
    s_add_u32 m0, s38, 16384
    s_nop 0
    buffer_load_dwordx4 v6, s[12:15], s48 offen nt lds
    s_add_u32 m0, s38, 17408
    s_nop 0
    buffer_load_dwordx4 v7, s[12:15], s48 offen nt lds
    v_and_b32 v96, 15, v111
    v_lshrrev_b32 v97, 4, v111
    v_lshrrev_b32 v98, 3, v96
    v_and_b32 v99, 7, v96
    v_lshlrev_b32 v0, 7, v99
    v_bfe_u32 v99, v96, 1, 2
    v_lshlrev_b32 v99, 1, v99
    v_mul_u32_u24 v100, 5, v98
    v_xor_b32 v99, v99, v100
    v_xor_b32 v99, v99, v97
    v_lshl_add_u32 v0, v99, 4, v0
    v_mul_u32_u24 v100, 3072, v98
    v_add_u32 v0, v100, v0
    v_xor_b32 v1, 64, v0
    v_lshrrev_b32 v98, 1, v97
    v_mul_u32_u24 v2, 3072, v98
    v_and_b32 v99, 1, v97
    v_bfe_u32 v100, v111, 2, 2
    v_lshl_add_u32 v96, v99, 2, v100
    v_lshl_add_u32 v2, v96, 7, v2
    v_lshrrev_b32 v96, 1, v96
    v_lshlrev_b32 v96, 1, v96
    v_mul_u32_u24 v98, 5, v98
    v_xor_b32 v96, v96, v98
    v_bfe_u32 v99, v111, 1, 1
    v_xor_b32 v96, v96, v99
    v_lshl_add_u32 v2, v96, 4, v2
    v_and_b32 v99, 1, v111
    v_lshl_add_u32 v2, v99, 3, v2
    v_add_u32 v2, 24576, v2
    v_xor_b32 v3, 32, v2
    v_xor_b32 v4, 64, v2
    v_xor_b32 v5, 96, v2
    v_lshl_add_u32 v103, v111, 4, s38
    v_and_b32 v96, 15, v111
    s_mov_b32 s42, 0x1011
    v_bfe_i32 v97, s42, v96, 1
    v_and_b32 v97, 0x3f803f80, v97
    v_accvgpr_write_b32 a236, v97
    v_accvgpr_write_b32 a237, v97
    v_accvgpr_write_b32 a238, v97
    v_accvgpr_write_b32 a239, v97
    s_mov_b32 s42, 0x3222
    v_bfe_i32 v97, s42, v96, 1
    v_and_b32 v97, 0x3f803f80, v97
    v_accvgpr_write_b32 a240, v97
    v_accvgpr_write_b32 a241, v97
    v_accvgpr_write_b32 a242, v97
    v_accvgpr_write_b32 a243, v97
    s_mov_b32 s42, 0x5444
    v_bfe_i32 v97, s42, v96, 1
    v_and_b32 v97, 0x3f803f80, v97
    v_accvgpr_write_b32 a244, v97
    v_accvgpr_write_b32 a245, v97
    v_accvgpr_write_b32 a246, v97
    v_accvgpr_write_b32 a247, v97
    s_mov_b32 s42, 0x9888
    v_bfe_i32 v97, s42, v96, 1
    v_and_b32 v97, 0x3f803f80, v97
    v_accvgpr_write_b32 a248, v97
    v_accvgpr_write_b32 a249, v97
    v_accvgpr_write_b32 a250, v97
    v_accvgpr_write_b32 a251, v97
    s_mov_b32 s42, 0x1100
    v_bfe_i32 v97, s42, v96, 1
    v_and_b32 v97, 0x3f803f80, v97
    v_accvgpr_write_b32 a252, v97
    v_accvgpr_write_b32 a253, v97
    v_accvgpr_write_b32 a254, v97
    v_accvgpr_write_b32 a255, v97
    s_waitcnt vmcnt(18)
    s_barrier
    s_waitcnt vmcnt(12)
    s_add_u32 s48, s34, 18432
    s_add_u32 m0, s38, 18432
    s_nop 0
    buffer_load_dwordx4 v6, s[12:15], s48 offen nt lds
    v_lshrrev_b32 v105, 11, v0
    s_add_u32 m0, s38, 19456
    s_nop 0
    buffer_load_dwordx4 v7, s[12:15], s48 offen nt lds
    s_add_u32 s48, s34, 18560
    s_add_u32 m0, s38, 20480
    ds_read_b128 a[232:235], v1 offset:2048
    v_xor_b32 v105, s65, v105
    v_and_b32 v104, 0x3ff, v0
    buffer_load_dwordx4 v6, s[12:15], s48 offen nt lds
    v_lshl_add_u32 v104, v105, 10, v104
    s_add_u32 m0, s38, 21504
    v_add_u32 v104, s38, v104
    ds_read_b128 a[96:99], v104 offset:0
    ds_read_b128 a[216:219], v1 offset:0
    buffer_load_dwordx4 v7, s[12:15], s48 offen nt lds
    v_xor_b32 v105, 64, v104
    s_add_u32 s48, s34, 18688
    ds_read_b128 a[108:111], v105 offset:2048
    ds_read_b128 a[116:119], v105 offset:4096
    s_add_u32 m0, s38, 22528
    ds_read_b128 a[220:223], v0 offset:1024
    ds_read_b128 a[212:215], v0 offset:0
    ds_read_b128 a[100:103], v105 offset:0
    buffer_load_dwordx4 v6, s[12:15], s48 offen nt lds
    ds_read_b128 a[224:227], v1 offset:1024
    s_add_u32 m0, s38, 23552
    s_nop 0
    buffer_load_dwordx4 v7, s[12:15], s48 offen nt lds
    s_waitcnt lgkmcnt(2)
    v_mfma_f32_16x16x32_bf16 v[52:55], a[212:215], a[96:99], 0
    s_waitcnt lgkmcnt(1)
    ds_read_b128 a[104:107], v104 offset:2048
    v_mfma_f32_16x16x32_bf16 v[52:55], a[216:219], a[100:103], v[52:55]
    ds_read_b128 a[228:231], v0 offset:2048
    s_waitcnt lgkmcnt(1)
    v_mfma_f32_16x16x32_bf16 v[52:55], a[220:223], a[104:107], v[52:55]
    ds_read_b128 a[220:223], v0 offset:7168
    v_mfma_f32_16x16x32_bf16 v[52:55], a[224:227], a[108:111], v[52:55]
    ds_read_b128 a[112:115], v104 offset:4096
    s_waitcnt lgkmcnt(0)
    v_mfma_f32_16x16x32_bf16 v[52:55], a[228:231], a[112:115], v[52:55]
    ds_read_b128 a[212:215], v0 offset:6144
    v_mfma_f32_16x16x32_bf16 v[52:55], a[232:235], a[116:119], v[52:55]
    ds_read_b128 a[228:231], v0 offset:8192
    ds_read_b128 a[216:219], v1 offset:6144
    s_waitcnt lgkmcnt(2)
    v_mfma_f32_16x16x32_bf16 v[56:59], a[212:215], a[96:99], 0
    ds_read_b128 a[224:227], v1 offset:7168
    s_waitcnt lgkmcnt(1)
    v_mfma_f32_16x16x32_bf16 v[56:59], a[216:219], a[100:103], v[56:59]
    ds_read_b128 a[232:235], v1 offset:8192
    s_waitcnt vmcnt(12)
    s_add_u32 m0, s22, 24576
    ds_read_b128 a[120:123], v104 offset:6144
    buffer_load_dwordx4 v6, s[8:11], s21 offen lds
    s_add_u32 s21, s21, 128
    s_add_u32 m0, s22, 25600
    v_mfma_f32_16x16x32_bf16 v[56:59], a[220:223], a[104:107], v[56:59]
    s_waitcnt lgkmcnt(1)
    ds_read_b128 a[216:219], v1 offset:12288
    buffer_load_dwordx4 v6, s[8:11], s21 offen lds
    v_mfma_f32_16x16x32_bf16 v[56:59], a[224:227], a[108:111], v[56:59]
    s_add_u32 s21, s21, 128
    s_add_u32 m0, s22, 26624
    ds_read_b128 a[220:223], v0 offset:13312
    v_max3_f32 v96, v52, v53, v54
    v_mfma_f32_16x16x32_bf16 v[56:59], a[228:231], a[112:115], v[56:59]
    buffer_load_dwordx4 v6, s[8:11], s21 offen lds
    ds_read_b128 a[224:227], v1 offset:13312
    v_mfma_f32_16x16x32_bf16 v[56:59], a[232:235], a[116:119], v[56:59]
    s_nop 7
    v_max3_f32 v96, v96, v55, v56
    v_max3_f32 v96, v96, v57, v58
    ds_read_b128 a[212:215], v0 offset:12288
    v_max_f32 v96, v96, v59
    v_mov_b32 v97, v96
    ds_read_b128 a[228:231], v0 offset:14336
    s_nop 0
    v_permlane32_swap_b32 v97, v96
    v_max_f32 v96, v96, v97
    v_mov_b32 v97, v96
    s_nop 1
    v_permlane16_swap_b32 v97, v96
    v_max_f32 v96, v96, v97
    v_mul_f32_e64 v9, -s28, v96
    v_fma_f32 v54, v54, s28, v9
    v_fma_f32 v53, v53, s28, v9
    v_fma_f32 v55, v55, s28, v9
    v_exp_f32 v55, v55
    v_fma_f32 v58, v58, s28, v9
    v_exp_f32 v58, v58
    v_fma_f32 v59, v59, s28, v9
    v_fma_f32 v56, v56, s28, v9
    v_fma_f32 v57, v57, s28, v9
    v_fma_f32 v52, v52, s28, v9
    v_exp_f32 v57, v57
    v_exp_f32 v52, v52
    v_exp_f32 v53, v53
    v_exp_f32 v54, v54
    s_nop 0
    v_cvt_pk_bf16_f32 v15, v54, v55
    v_cvt_pk_bf16_f32 v14, v52, v53
    s_waitcnt lgkmcnt(1)
    v_mfma_f32_16x16x32_bf16 v[52:55], a[212:215], a[96:99], 0
    ds_read_b128 a[232:235], v1 offset:14336
    v_mfma_f32_16x16x32_bf16 v[52:55], a[216:219], a[100:103], v[52:55]
    ds_read_b128 a[212:215], v0 offset:18432
    v_mfma_f32_16x16x32_bf16 v[52:55], a[220:223], a[104:107], v[52:55]
    ds_read_b128 a[124:127], v105 offset:6144
    v_mfma_f32_16x16x32_bf16 v[52:55], a[224:227], a[108:111], v[52:55]
    s_waitcnt lgkmcnt(3)
    ds_read_b128 a[136:139], v104 offset:10240
    v_mfma_f32_16x16x32_bf16 v[52:55], a[228:231], a[112:115], v[52:55]
    ds_read_b128 a[224:227], v1 offset:19456
    ds_read_b128 a[216:219], v1 offset:18432
    ds_read_b128 a[220:223], v0 offset:19456
    v_exp_f32 v56, v56
    s_waitcnt lgkmcnt(6)
    v_mfma_f32_16x16x32_bf16 v[52:55], a[232:235], a[116:119], v[52:55]
    v_cvt_pk_bf16_f32 v16, v56, v57
    v_exp_f32 v59, v59
    ds_read_b128 a[140:143], v105 offset:10240
    v_cvt_pk_bf16_f32 v17, v58, v59
    s_waitcnt lgkmcnt(5)
    v_mfma_f32_16x16x32_bf16 v[56:59], a[212:215], a[96:99], 0
    ds_read_b128 a[212:215], v0 offset:0
    ds_read_b128 a[228:231], v0 offset:20480
    s_waitcnt lgkmcnt(4)
    v_mfma_f32_16x16x32_bf16 v[56:59], a[216:219], a[100:103], v[56:59]
    s_waitcnt lgkmcnt(3)
    ds_read_b128 a[232:235], v1 offset:20480
    v_mfma_f32_16x16x32_bf16 v[56:59], a[220:223], a[104:107], v[56:59]
    ds_read_b128 a[216:219], v1 offset:0
    v_fma_f32 v54, v54, s28, v9
    v_mfma_f32_16x16x32_bf16 v[56:59], a[224:227], a[108:111], v[56:59]
    v_fma_f32 v53, v53, s28, v9
    ds_read_b128 a[128:131], v104 offset:8192
    s_waitcnt lgkmcnt(3)
    v_mfma_f32_16x16x32_bf16 v[56:59], a[228:231], a[112:115], v[56:59]
    ds_read_b128 a[132:135], v105 offset:8192
    s_waitcnt lgkmcnt(3)
    v_mfma_f32_16x16x32_bf16 v[56:59], a[232:235], a[116:119], v[56:59]
    ds_read_b128 a[224:227], v1 offset:1024
    v_mfma_f32_16x16x32_bf16 v[60:63], a[212:215], a[120:123], 0
    s_waitcnt lgkmcnt(3)
    ds_read_b128 a[228:231], v0 offset:2048
    v_mfma_f32_16x16x32_bf16 v[60:63], a[216:219], a[124:127], v[60:63]
    ds_read_b128 a[220:223], v0 offset:1024
    s_waitcnt lgkmcnt(0)
    v_mfma_f32_16x16x32_bf16 v[60:63], a[220:223], a[128:131], v[60:63]
    ds_read_b128 a[216:219], v1 offset:6144
    v_mfma_f32_16x16x32_bf16 v[60:63], a[224:227], a[132:135], v[60:63]
    ds_read_b128 a[232:235], v1 offset:2048
    ds_read_b128 a[220:223], v0 offset:7168
    v_mfma_f32_16x16x32_bf16 v[60:63], a[228:231], a[136:139], v[60:63]
    s_add_u32 s21, s21, 12032
    ds_read_b128 a[212:215], v0 offset:6144
    s_waitcnt lgkmcnt(2)
    v_mfma_f32_16x16x32_bf16 v[60:63], a[232:235], a[140:143], v[60:63]
    ds_read_b128 a[224:227], v1 offset:7168
    s_waitcnt lgkmcnt(1)
    v_mfma_f32_16x16x32_bf16 v[64:67], a[212:215], a[120:123], 0
    ds_read_b128 a[232:235], v1 offset:8192
    v_mfma_f32_16x16x32_bf16 v[64:67], a[216:219], a[124:127], v[64:67]
    ds_read_b128 a[212:215], v0 offset:12288
    v_mfma_f32_16x16x32_bf16 v[64:67], a[220:223], a[128:131], v[64:67]
    s_nop 0
    v_max3_f32 v98, v60, v61, v62
    ds_read_b128 a[228:231], v0 offset:8192
    s_waitcnt lgkmcnt(3)
    v_mfma_f32_16x16x32_bf16 v[64:67], a[224:227], a[132:135], v[64:67]
    ds_read_b128 a[220:223], v0 offset:13312
    s_waitcnt lgkmcnt(1)
    v_mfma_f32_16x16x32_bf16 v[64:67], a[228:231], a[136:139], v[64:67]
    ds_read_b128 a[216:219], v1 offset:12288
    v_mfma_f32_16x16x32_bf16 v[64:67], a[232:235], a[140:143], v[64:67]
    s_nop 7
    v_max3_f32 v98, v98, v63, v64
    v_max3_f32 v98, v98, v65, v66
    v_max_f32 v98, v98, v67
    v_mov_b32 v99, v98
    s_nop 1
    v_permlane32_swap_b32 v99, v98
    v_max_f32 v98, v98, v99
    v_mov_b32 v99, v98
    ds_read_b128 a[224:227], v1 offset:13312
    s_nop 0
    v_permlane16_swap_b32 v99, v98
    ds_read_b128 a[228:231], v0 offset:14336
    v_max_f32 v98, v98, v99
    v_mul_f32_e64 v10, -s28, v98
    v_fma_f32 v63, v63, s28, v10
    v_fma_f32 v60, v60, s28, v10
    v_fma_f32 v66, v66, s28, v10
    v_fma_f32 v61, v61, s28, v10
    v_fma_f32 v62, v62, s28, v10
    v_fma_f32 v67, v67, s28, v10
    v_exp_f32 v63, v63
    v_exp_f32 v61, v61
    v_exp_f32 v60, v60
    v_exp_f32 v62, v62
    s_nop 0
    v_cvt_pk_bf16_f32 v21, v62, v63
    s_waitcnt vmcnt(9)
    s_add_u32 m0, s22, 36864
    s_nop 0
    buffer_load_dwordx4 v6, s[8:11], s21 offen lds
    v_mfma_f32_16x16x32_bf16 v[44:47], a[236:239], v[14:17], 0
    s_add_u32 s21, s21, 128
    s_add_u32 m0, s22, 37888
    ds_read_b128 a[160:163], v104 offset:16384
    buffer_load_dwordx4 v6, s[8:11], s21 offen lds
    v_cvt_pk_bf16_f32 v20, v60, v61
    v_mfma_f32_16x16x32_bf16 v[60:63], a[212:215], a[120:123], 0
    s_add_u32 s21, s21, 128
    ds_read_b128 a[232:235], v1 offset:14336
    s_add_u32 m0, s22, 38912
    s_nop 0
    buffer_load_dwordx4 v6, s[8:11], s21 offen lds
    s_waitcnt lgkmcnt(2)
    v_mfma_f32_16x16x32_bf16 v[60:63], a[216:219], a[124:127], v[60:63]
    ds_read_b128 a[212:215], v0 offset:18432
    v_exp_f32 v67, v67
    v_mfma_f32_16x16x32_bf16 v[60:63], a[220:223], a[128:131], v[60:63]
    v_fma_f32 v64, v64, s28, v10
    ds_read_b128 a[216:219], v1 offset:18432
    v_exp_f32 v64, v64
    v_fma_f32 v65, v65, s28, v10
    ds_read_b128 a[148:151], v105 offset:12288
    v_mfma_f32_16x16x32_bf16 v[60:63], a[224:227], a[132:135], v[60:63]
    v_exp_f32 v65, v65
    ds_read_b128 a[220:223], v0 offset:19456
    v_mfma_f32_16x16x32_bf16 v[60:63], a[228:231], a[136:139], v[60:63]
    v_exp_f32 v66, v66
    s_nop 0
    v_cvt_pk_bf16_f32 v23, v66, v67
    v_exp_f32 v53, v53
    v_cvt_pk_bf16_f32 v22, v64, v65
    ds_read_b128 a[224:227], v1 offset:19456
    s_waitcnt lgkmcnt(5)
    v_mfma_f32_16x16x32_bf16 v[60:63], a[232:235], a[140:143], v[60:63]
    ds_read_b128 a[144:147], v104 offset:12288
    v_fma_f32 v52, v52, s28, v9
    ds_read_b128 a[232:235], v1 offset:20480
    s_waitcnt lgkmcnt(6)
    v_mfma_f32_16x16x32_bf16 v[64:67], a[212:215], a[120:123], 0
    ds_read_b128 a[156:159], v105 offset:14336
    v_mfma_f32_16x16x32_bf16 v[44:47], a[240:243], v[20:23], v[44:47]
    s_waitcnt lgkmcnt(6)
    ds_read_b128 a[228:231], v0 offset:20480
    v_mfma_f32_16x16x32_bf16 v[64:67], a[216:219], a[124:127], v[64:67]
    ds_read_b128 a[212:215], v0 offset:0
    s_waitcnt lgkmcnt(6)
    v_mfma_f32_16x16x32_bf16 v[64:67], a[220:223], a[128:131], v[64:67]
    ds_read_b128 a[152:155], v104 offset:14336
    s_waitcnt lgkmcnt(6)
    v_mfma_f32_16x16x32_bf16 v[64:67], a[224:227], a[132:135], v[64:67]
    ds_read_b128 a[216:219], v1 offset:0
    v_fma_f32 v60, v60, s28, v10
    v_fma_f32 v61, v61, s28, v10
    s_waitcnt lgkmcnt(3)
    v_mfma_f32_16x16x32_bf16 v[64:67], a[228:231], a[136:139], v[64:67]
    ds_read_b128 a[220:223], v0 offset:1024
    v_mfma_f32_16x16x32_bf16 v[64:67], a[232:235], a[140:143], v[64:67]
    s_waitcnt lgkmcnt(3)
    ds_read_b128 a[224:227], v1 offset:1024
    v_mfma_f32_16x16x32_bf16 v[68:71], a[212:215], a[144:147], 0
    ds_read_b128 a[228:231], v0 offset:2048
    s_waitcnt lgkmcnt(3)
    v_mfma_f32_16x16x32_bf16 v[68:71], a[216:219], a[148:151], v[68:71]
    ds_read_b128 a[164:167], v105 offset:16384
    s_waitcnt lgkmcnt(3)
    v_mfma_f32_16x16x32_bf16 v[68:71], a[220:223], a[152:155], v[68:71]
    ds_read_b128 a[232:235], v1 offset:2048
    s_add_u32 s21, s21, 12032
    s_waitcnt lgkmcnt(3)
    v_mfma_f32_16x16x32_bf16 v[68:71], a[224:227], a[156:159], v[68:71]
    ds_read_b128 a[212:215], v0 offset:6144
    ds_read_b128 a[216:219], v1 offset:6144
    s_waitcnt lgkmcnt(4)
    v_mfma_f32_16x16x32_bf16 v[68:71], a[228:231], a[160:163], v[68:71]
    ds_read_b128 a[228:231], v0 offset:8192
    s_waitcnt lgkmcnt(3)
    v_mfma_f32_16x16x32_bf16 v[68:71], a[232:235], a[164:167], v[68:71]
    ds_read_b128 a[224:227], v1 offset:7168
    s_waitcnt lgkmcnt(3)
    v_mfma_f32_16x16x32_bf16 v[72:75], a[212:215], a[144:147], 0
    s_waitcnt lgkmcnt(2)
    ds_read_b128 a[220:223], v0 offset:7168
    v_mfma_f32_16x16x32_bf16 v[72:75], a[216:219], a[148:151], v[72:75]
    ds_read_b128 a[232:235], v1 offset:8192
    v_exp_f32 v52, v52
    s_waitcnt lgkmcnt(1)
    v_mfma_f32_16x16x32_bf16 v[72:75], a[220:223], a[152:155], v[72:75]
    ds_read_b128 a[212:215], v0 offset:12288
    v_max3_f32 v96, v68, v69, v70
    v_mfma_f32_16x16x32_bf16 v[72:75], a[224:227], a[156:159], v[72:75]
    ds_read_b128 a[216:219], v1 offset:12288
    v_mfma_f32_16x16x32_bf16 v[72:75], a[228:231], a[160:163], v[72:75]
    s_waitcnt lgkmcnt(2)
    ds_read_b128 a[228:231], v0 offset:14336
    v_mfma_f32_16x16x32_bf16 v[72:75], a[232:235], a[164:167], v[72:75]
    s_nop 7
    v_max3_f32 v96, v96, v71, v72
    v_max3_f32 v96, v96, v73, v74
    v_max_f32 v96, v96, v75
    v_mov_b32 v97, v96
    s_nop 1
    v_permlane32_swap_b32 v97, v96
    v_max_f32 v96, v96, v97
    v_mov_b32 v97, v96
    s_nop 1
    v_permlane16_swap_b32 v97, v96
    v_max_f32 v96, v96, v97
    v_mul_f32_e64 v11, -s28, v96
    v_fma_f32 v71, v71, s28, v11
    v_exp_f32 v54, v54
    v_fma_f32 v75, v75, s28, v11
    ds_read_b128 a[220:223], v0 offset:13312
    v_fma_f32 v69, v69, s28, v11
    v_fma_f32 v70, v70, s28, v11
    v_fma_f32 v68, v68, s28, v11
    v_exp_f32 v68, v68
    ds_read_b128 a[224:227], v1 offset:13312
    v_fma_f32 v74, v74, s28, v11
    v_fma_f32 v72, v72, s28, v11
    v_exp_f32 v70, v70
    v_exp_f32 v69, v69
    v_exp_f32 v71, v71
    s_nop 0
    v_cvt_pk_bf16_f32 v27, v70, v71
    v_cvt_pk_bf16_f32 v26, v68, v69
    s_waitcnt lgkmcnt(2)
    v_mfma_f32_16x16x32_bf16 v[68:71], a[212:215], a[144:147], 0
    v_fma_f32 v73, v73, s28, v11
    ds_read_b128 a[232:235], v1 offset:14336
    v_exp_f32 v72, v72
    v_exp_f32 v73, v73
    v_mfma_f32_16x16x32_bf16 v[68:71], a[216:219], a[148:151], v[68:71]
    v_fma_f32 v55, v55, s28, v9
    ds_read_b128 a[212:215], v0 offset:18432
    s_waitcnt lgkmcnt(3)
    v_mfma_f32_16x16x32_bf16 v[68:71], a[220:223], a[152:155], v[68:71]
    ds_read_b128 a[220:223], v0 offset:19456
    v_exp_f32 v74, v74
    s_waitcnt lgkmcnt(3)
    v_mfma_f32_16x16x32_bf16 v[68:71], a[224:227], a[156:159], v[68:71]
    ds_read_b128 a[216:219], v1 offset:18432
    v_exp_f32 v75, v75
    v_mfma_f32_16x16x32_bf16 v[68:71], a[228:231], a[160:163], v[68:71]
    v_cvt_pk_bf16_f32 v29, v74, v75
    v_exp_f32 v60, v60
    v_exp_f32 v61, v61
    v_cvt_pk_bf16_f32 v28, v72, v73
    ds_read_b128 a[224:227], v1 offset:19456
    v_exp_f32 v55, v55
    s_waitcnt lgkmcnt(4)
    v_mfma_f32_16x16x32_bf16 v[68:71], a[232:235], a[164:167], v[68:71]
    ds_read_b128 a[232:235], v1 offset:20480
    ds_read_b128 a[228:231], v0 offset:20480
    s_waitcnt lgkmcnt(5)
    v_mfma_f32_16x16x32_bf16 v[72:75], a[212:215], a[144:147], 0
    ds_read_b128 a[212:215], v0 offset:0
    s_waitcnt lgkmcnt(4)
    v_mfma_f32_16x16x32_bf16 v[72:75], a[216:219], a[148:151], v[72:75]
    s_waitcnt vmcnt(6)
    ds_read_b128 a[168:171], v104 offset:18432
    ds_read_b128 a[172:175], v105 offset:18432
    ds_read_b128 a[216:219], v1 offset:0
    ds_read_b128 a[176:179], v104 offset:20480
    v_mfma_f32_16x16x32_bf16 v[72:75], a[220:223], a[152:155], v[72:75]
    s_waitcnt lgkmcnt(7)
    ds_read_b128 a[220:223], v0 offset:1024
    ds_read_b128 a[184:187], v104 offset:22528
    v_mfma_f32_16x16x32_bf16 v[72:75], a[224:227], a[156:159], v[72:75]
    ds_read_b128 a[224:227], v1 offset:1024
    ds_read_b128 a[180:183], v105 offset:20480
    s_waitcnt lgkmcnt(9)
    v_mfma_f32_16x16x32_bf16 v[72:75], a[228:231], a[160:163], v[72:75]
    ds_read_b128 a[188:191], v105 offset:22528
    ds_read_b128 a[228:231], v0 offset:2048
    v_mfma_f32_16x16x32_bf16 v[72:75], a[232:235], a[164:167], v[72:75]
    ds_read_b128 a[232:235], v1 offset:2048
    s_waitcnt lgkmcnt(10)
    v_mfma_f32_16x16x32_bf16 v[76:79], a[212:215], a[168:171], 0
    s_waitcnt lgkmcnt(8)
    ds_read_b128 a[212:215], v0 offset:6144
    v_mfma_f32_16x16x32_bf16 v[76:79], a[216:219], a[172:175], v[76:79]
    s_waitcnt lgkmcnt(7)
    ds_read_b128 a[216:219], v1 offset:6144
    v_mfma_f32_16x16x32_bf16 v[76:79], a[220:223], a[176:179], v[76:79]
    ds_read_b128 a[220:223], v0 offset:7168
    s_waitcnt lgkmcnt(6)
    v_mfma_f32_16x16x32_bf16 v[76:79], a[224:227], a[180:183], v[76:79]
    ds_read_b128 a[224:227], v1 offset:7168
    s_waitcnt lgkmcnt(5)
    v_mfma_f32_16x16x32_bf16 v[76:79], a[228:231], a[184:187], v[76:79]
    ds_read_b128 a[228:231], v0 offset:8192
    s_waitcnt lgkmcnt(5)
    v_mfma_f32_16x16x32_bf16 v[76:79], a[232:235], a[188:191], v[76:79]
    ds_read_b128 a[232:235], v1 offset:8192
    s_waitcnt lgkmcnt(5)
    v_mfma_f32_16x16x32_bf16 v[80:83], a[212:215], a[168:171], 0
    v_cvt_pk_bf16_f32 v18, v52, v53
    s_nop 3
    v_max3_f32 v98, v76, v77, v78
    s_waitcnt lgkmcnt(3)
    v_mfma_f32_16x16x32_bf16 v[80:83], a[216:219], a[172:175], v[80:83]
    v_cvt_pk_bf16_f32 v19, v54, v55
    v_mfma_f32_16x16x32_bf16 v[80:83], a[220:223], a[176:179], v[80:83]
    s_waitcnt vmcnt(63) lgkmcnt(0)
    ds_read_b128 a[212:215], v0 offset:12288
    v_mfma_f32_16x16x32_bf16 v[80:83], a[224:227], a[180:183], v[80:83]
    s_barrier
    ds_read_b128 a[220:223], v0 offset:13312
    v_mfma_f32_16x16x32_bf16 v[80:83], a[228:231], a[184:187], v[80:83]
    s_add_u32 m0, s22, 0
    ds_read_b128 a[216:219], v1 offset:12288
    buffer_load_dwordx4 v6, s[4:7], s20 offen lds
    v_mfma_f32_16x16x32_bf16 v[80:83], a[232:235], a[188:191], v[80:83]
    s_add_u32 s20, s20, 128
    s_add_u32 m0, s22, 1024
    ds_read_b128 a[224:227], v1 offset:13312
    buffer_load_dwordx4 v6, s[4:7], s20 offen lds
    s_add_u32 s20, s20, 128
    v_mfma_f32_16x16x32_bf16 v[44:47], a[244:247], v[26:29], v[44:47]
    s_add_u32 m0, s22, 2048
    ds_read_b128 a[228:231], v0 offset:14336
    ds_read_b128 a[232:235], v1 offset:14336
    buffer_load_dwordx4 v6, s[4:7], s20 offen lds
    v_max3_f32 v98, v98, v79, v80
    v_max3_f32 v98, v98, v81, v82
    v_max_f32 v98, v98, v83
    v_mov_b32 v99, v98
    s_add_u32 s20, s20, 12032
    s_mov_b32 s39, s64
    v_permlane32_swap_b32 v99, v98
    v_max_f32 v98, v98, v99
    v_mov_b32 v99, v98
    s_add_u32 s37, s37, 1
    s_bitcmp1_b32 s63, s37
    s_cselect_b32 s62, 4294770688, 0
    s_cselect_b32 s42, 0, 325632
    v_permlane16_swap_b32 v99, v98
    s_add_u32 s35, s35, s42
    v_max_f32 v98, v98, v99
    v_mul_f32_e64 v12, -s28, v98
    v_fma_f32 v77, v77, s28, v12
    s_lshl_b32 s42, s37, 1
    v_fma_f32 v79, v79, s28, v12
    v_fma_f32 v78, v78, s28, v12
    v_exp_f32 v78, v78
    v_fma_f32 v76, v76, s28, v12
    v_exp_f32 v77, v77
    v_exp_f32 v79, v79
    v_exp_f32 v76, v76
    s_lshr_b32 s42, s31, s42
    v_cvt_pk_bf16_f32 v33, v78, v79
    v_cvt_pk_bf16_f32 v32, v76, v77
    s_waitcnt lgkmcnt(0)
    v_mfma_f32_16x16x32_bf16 v[76:79], a[212:215], a[168:171], 0
    s_and_b32 s42, s42, 3
    ds_read_b128 a[212:215], v0 offset:18432
    v_fma_f32 v83, v83, s28, v12
    v_mfma_f32_16x16x32_bf16 v[76:79], a[216:219], a[172:175], v[76:79]
    s_add_u32 s42, s42, s36
    ds_read_b128 a[216:219], v1 offset:18432
    v_fma_f32 v82, v82, s28, v12
    v_mfma_f32_16x16x32_bf16 v[76:79], a[220:223], a[176:179], v[76:79]
    s_sub_u32 s43, s42, 3
    ds_read_b128 a[220:223], v0 offset:19456
    s_cmp_ge_u32 s42, 3
    v_mfma_f32_16x16x32_bf16 v[76:79], a[224:227], a[180:183], v[76:79]
    s_cselect_b32 s42, s43, s42
    s_mul_i32 s44, s3, 5
    ds_read_b128 a[224:227], v1 offset:19456
    v_mfma_f32_16x16x32_bf16 v[76:79], a[228:231], a[184:187], v[76:79]
    s_mov_b32 s32, 1
    ds_read_b128 a[228:231], v0 offset:20480
    s_lshl_b32 s43, s3, 2
    v_mfma_f32_16x16x32_bf16 v[76:79], a[232:235], a[188:191], v[76:79]
    s_add_u32 s45, s43, 21
    ds_read_b128 a[232:235], v1 offset:20480
    s_cmp_eq_u32 s3, 0
    s_cselect_b32 s45, 20, s45
    s_cselect_b32 s33, 1, 0
    s_cmp_eq_u32 s42, 1
    s_cselect_b32 s44, s45, s44
    s_cselect_b32 s32, s33, s32
    v_fma_f32 v81, v81, s28, v12
    s_add_u32 s45, s43, 37
    s_cmp_eq_u32 s42, 2
    v_exp_f32 v81, v81
    v_exp_f32 v83, v83
    s_cselect_b32 s44, s45, s44
    v_fma_f32 v80, v80, s28, v12
    s_cselect_b32 s32, 0, s32
    s_mul_i32 s44, s44, 6144
    v_exp_f32 v80, v80
    v_exp_f32 v82, v82
    s_add_u32 s33, s35, s44
    s_mul_i32 s42, s32, 6144
    s_add_u32 s42, s42, 24576
    v_cvt_pk_bf16_f32 v35, v82, v83
    v_cvt_pk_bf16_f32 v34, v80, v81
    s_add_u32 s42, s42, s33
    s_cmp_ge_u32 s37, 6
    s_waitcnt lgkmcnt(3)
    v_mfma_f32_16x16x32_bf16 v[80:83], a[212:215], a[168:171], 0
    s_cselect_b32 s14, 0, s42
    s_add_u32 s24, s67, 6144
    s_add_u32 s25, s33, 6144
    s_add_u32 s23, s38, 6144
    s_mov_b32 s27, 0x30c30
    s_mov_b32 s89, 0xaaaaaaaa
    s_mov_b32 s30, 0
    s_waitcnt vmcnt(6) lgkmcnt(0)
    s_barrier
    ds_read_b64_tr_b16 a[212:213], v2 offset:0
    ds_read_b64_tr_b16 a[214:215], v2 offset:6144
    s_add_u32 m0, s22, 12288
    s_nop 0
    buffer_load_dwordx4 v6, s[4:7], s20 offen lds
    s_add_u32 s20, s20, 128
    v_mfma_f32_16x16x32_bf16 v[80:83], a[216:219], a[172:175], v[80:83]
    s_add_u32 m0, s22, 13312
    ds_read_b64_tr_b16 a[216:217], v3 offset:0
    v_mfma_f32_16x16x32_bf16 v[80:83], a[220:223], a[176:179], v[80:83]
    ds_read_b64_tr_b16 a[218:219], v3 offset:6144
    buffer_load_dwordx4 v6, s[4:7], s20 offen lds
    s_add_u32 s20, s20, 128
    v_mfma_f32_16x16x32_bf16 v[44:47], a[248:251], v[32:35], v[44:47]
    ds_read_b64_tr_b16 a[220:221], v4 offset:0
    v_mfma_f32_16x16x32_bf16 v[80:83], a[224:227], a[180:183], v[80:83]
    ds_read_b64_tr_b16 a[222:223], v4 offset:6144
    v_cvt_pk_bf16_f32 v24, v60, v61
    s_add_u32 m0, s22, 14336
    ds_read_b64_tr_b16 a[224:225], v5 offset:0
    v_mfma_f32_16x16x32_bf16 v[80:83], a[228:231], a[184:187], v[80:83]
    buffer_load_dwordx4 v6, s[4:7], s20 offen lds
    ds_read_b64_tr_b16 a[226:227], v5 offset:6144
    v_mfma_f32_16x16x32_bf16 v[80:83], a[232:235], a[188:191], v[80:83]
    s_add_u32 s20, s20, 12032
    s_waitcnt lgkmcnt(6)
    v_mfma_f32_16x16x32_bf16 v[112:115], a[212:215], v[14:17], 0
    s_nop 4
    v_fma_f32 v80, v80, s28, v12
    v_mfma_f32_16x16x32_bf16 v[160:163], a[212:215], v[20:23], 0
    ds_read_b64_tr_b16 a[228:229], v2 offset:1024
    v_fma_f32 v63, v63, s28, v10
    v_mfma_f32_16x16x32_bf16 v[208:211], a[212:215], v[26:29], 0
    v_fma_f32 v67, v67, s28, v10
    v_fma_f32 v62, v62, s28, v10
    v_mfma_f32_16x16x32_bf16 a[0:3], a[212:215], v[32:35], 0
    ds_read_b64_tr_b16 a[230:231], v2 offset:7168
    s_waitcnt lgkmcnt(6)
    v_mfma_f32_16x16x32_bf16 a[4:7], a[216:219], v[32:35], 0
    v_fma_f32 v56, v56, s28, v9
    v_fma_f32 v76, v76, s28, v12
    v_mfma_f32_16x16x32_bf16 v[212:215], a[216:219], v[26:29], 0
    ds_read_b64_tr_b16 a[234:235], v3 offset:7168
    v_fma_f32 v74, v74, s28, v11
    v_mfma_f32_16x16x32_bf16 v[164:167], a[216:219], v[20:23], 0
    v_add_u32 v103, 6144, v103
    v_fma_f32 v64, v64, s28, v10
    v_mfma_f32_16x16x32_bf16 v[116:119], a[216:219], v[14:17], 0
    ds_read_b64_tr_b16 a[232:233], v3 offset:1024
    s_waitcnt lgkmcnt(6)
    v_mfma_f32_16x16x32_bf16 v[120:123], a[220:223], v[14:17], 0
    ds_read_b64_tr_b16 a[216:217], v5 offset:1024
    v_mfma_f32_16x16x32_bf16 v[168:171], a[220:223], v[20:23], 0
    ds_read_b64_tr_b16 a[214:215], v4 offset:7168
    v_fma_f32 v77, v77, s28, v12
    v_mfma_f32_16x16x32_bf16 v[216:219], a[220:223], v[26:29], 0
    ds_read_b64_tr_b16 a[212:213], v4 offset:1024
    v_fma_f32 v81, v81, s28, v12
    v_mfma_f32_16x16x32_bf16 a[8:11], a[220:223], v[32:35], 0
    s_waitcnt lgkmcnt(6)
    v_fma_f32 v57, v57, s28, v9
    v_mfma_f32_16x16x32_bf16 a[12:15], a[224:227], v[32:35], 0
    v_exp_f32 v63, v63
    v_mfma_f32_16x16x32_bf16 v[220:223], a[224:227], v[26:29], 0
    ds_read_b64_tr_b16 a[222:223], v2 offset:8192
    v_fma_f32 v58, v58, s28, v9
    v_mfma_f32_16x16x32_bf16 v[172:175], a[224:227], v[20:23], 0
    ds_read_b64_tr_b16 a[218:219], v5 offset:7168
    v_fma_f32 v78, v78, s28, v12
    v_mfma_f32_16x16x32_bf16 v[124:127], a[224:227], v[14:17], 0
    s_waitcnt lgkmcnt(6)
    ds_read_b64_tr_b16 a[226:227], v3 offset:8192
    v_fma_f32 v79, v79, s28, v12
    v_mfma_f32_16x16x32_bf16 v[128:131], a[228:231], v[14:17], 0
    s_add_u32 s39, s39, 12288
    v_exp_f32 v56, v56
    v_mfma_f32_16x16x32_bf16 v[176:179], a[228:231], v[20:23], 0
    ds_read_b64_tr_b16 a[224:225], v3 offset:2048
    v_fma_f32 v65, v65, s28, v10
    v_mfma_f32_16x16x32_bf16 v[224:227], a[228:231], v[26:29], 0
    ds_read_b64_tr_b16 a[220:221], v2 offset:2048
    v_fma_f32 v69, v69, s28, v11
    v_mfma_f32_16x16x32_bf16 a[16:19], a[228:231], v[32:35], 0
    s_waitcnt lgkmcnt(6)
    v_exp_f32 v76, v76
    v_mfma_f32_16x16x32_bf16 a[20:23], a[232:235], v[32:35], 0
    ds_read_b64_tr_b16 a[230:231], v4 offset:8192
    v_fma_f32 v73, v73, s28, v11
    v_mfma_f32_16x16x32_bf16 v[228:231], a[232:235], v[26:29], 0
    ds_read_b64_tr_b16 a[228:229], v4 offset:2048
    v_fma_f32 v68, v68, s28, v11
    v_mfma_f32_16x16x32_bf16 v[180:183], a[232:235], v[20:23], 0
    v_exp_f32 v80, v80
    v_mfma_f32_16x16x32_bf16 v[132:135], a[232:235], v[14:17], 0
    s_waitcnt lgkmcnt(6)
    ds_read_b64_tr_b16 a[232:233], v5 offset:2048
    ds_read_b64_tr_b16 a[234:235], v5 offset:8192
    v_mfma_f32_16x16x32_bf16 v[136:139], a[212:215], v[14:17], 0
    v_fma_f32 v66, v66, s28, v10
    v_fma_f32 v71, v71, s28, v11
    v_mfma_f32_16x16x32_bf16 v[184:187], a[212:215], v[20:23], 0
    v_exp_f32 v69, v69
    v_mfma_f32_16x16x32_bf16 v[232:235], a[212:215], v[26:29], 0
    v_exp_f32 v68, v68
    v_mfma_f32_16x16x32_bf16 a[24:27], a[212:215], v[32:35], 0
    s_waitcnt lgkmcnt(5)
    v_exp_f32 v66, v66
    v_mfma_f32_16x16x32_bf16 a[28:31], a[216:219], v[32:35], 0
    v_fma_f32 v75, v75, s28, v11
    v_mov_b32 v39, v7
    v_mfma_f32_16x16x32_bf16 v[236:239], a[216:219], v[26:29], 0
    v_exp_f32 v71, v71
    v_mfma_f32_16x16x32_bf16 v[188:191], a[216:219], v[20:23], 0
    v_exp_f32 v78, v78
    v_mfma_f32_16x16x32_bf16 v[140:143], a[216:219], v[14:17], 0
    s_waitcnt lgkmcnt(2)
    v_exp_f32 v81, v81
    v_mfma_f32_16x16x32_bf16 v[144:147], a[220:223], v[14:17], 0
    v_exp_f32 v65, v65
    v_mfma_f32_16x16x32_bf16 v[192:195], a[220:223], v[20:23], 0
    s_waitcnt vmcnt(3) lgkmcnt(0)
    v_exp_f32 v64, v64
    v_mfma_f32_16x16x32_bf16 v[240:243], a[220:223], v[26:29], 0
    s_barrier
    v_mfma_f32_16x16x32_bf16 a[32:35], a[220:223], v[32:35], 0
    s_add_u32 m0, s22, 24576
    ds_read_b128 a[212:215], v0 offset:0
    v_mfma_f32_16x16x32_bf16 a[36:39], a[224:227], v[32:35], 0
    ds_read_b128 a[216:219], v1 offset:0
    v_mov_b32 v38, v6
    v_mfma_f32_16x16x32_bf16 v[244:247], a[224:227], v[26:29], 0
    buffer_load_dwordx4 v6, s[8:11], s21 offen lds
    v_mfma_f32_16x16x32_bf16 v[196:199], a[224:227], v[20:23], 0
    s_add_u32 s21, s21, 128
    v_exp_f32 v62, v62
    v_mfma_f32_16x16x32_bf16 v[148:151], a[224:227], v[14:17], 0
    ds_read_b128 a[220:223], v0 offset:1024
    s_add_u32 m0, s22, 25600
    v_mfma_f32_16x16x32_bf16 v[152:155], a[228:231], v[14:17], 0
    buffer_load_dwordx4 v6, s[8:11], s21 offen lds
    v_mfma_f32_16x16x32_bf16 v[200:203], a[228:231], v[20:23], 0
    s_add_u32 s21, s21, 128
    v_fma_f32 v70, v70, s28, v11
    v_cvt_pk_bf16_f32 v25, v62, v63
    v_mfma_f32_16x16x32_bf16 v[248:251], a[228:231], v[26:29], 0
    ds_read_b128 a[224:227], v1 offset:1024
    v_cvt_pk_bf16_f32 v30, v68, v69
    v_mfma_f32_16x16x32_bf16 a[40:43], a[228:231], v[32:35], 0
    s_add_u32 m0, s22, 26624
    v_exp_f32 v70, v70
    v_mfma_f32_16x16x32_bf16 a[44:47], a[232:235], v[32:35], 0
    v_exp_f32 v77, v77
    v_mfma_f32_16x16x32_bf16 v[252:255], a[232:235], v[26:29], 0
    buffer_load_dwordx4 v6, s[8:11], s21 offen lds
    v_mfma_f32_16x16x32_bf16 v[204:207], a[232:235], v[20:23], 0
    v_exp_f32 v57, v57
    v_mfma_f32_16x16x32_bf16 v[156:159], a[232:235], v[14:17], 0
    s_waitcnt lgkmcnt(2)
    v_cvt_pk_bf16_f32 v36, v76, v77
    v_mfma_f32_16x16x32_bf16 v[52:55], a[212:215], a[96:99], 0
    ds_read_b128 a[228:231], v0 offset:2048
    v_fma_f32 v72, v72, s28, v11
    v_mfma_f32_16x16x32_bf16 v[52:55], a[216:219], a[100:103], v[52:55]
    s_waitcnt lgkmcnt(2)
    v_fma_f32 v59, v59, s28, v9
    s_add_u32 s21, s21, 12032
    v_mfma_f32_16x16x32_bf16 v[52:55], a[220:223], a[104:107], v[52:55]
    ds_read_b128 a[232:235], v1 offset:2048
    v_mfma_f32_16x16x32_bf16 v[60:63], a[220:223], a[128:131], 0
    v_exp_f32 v72, v72
    v_mfma_f32_16x16x32_bf16 v[60:63], a[216:219], a[124:127], v[60:63]
    v_exp_f32 v74, v74
    v_mfma_f32_16x16x32_bf16 v[60:63], a[212:215], a[120:123], v[60:63]
    v_cvt_pk_bf16_f32 v31, v70, v71
    v_fma_f32 v83, v83, s28, v12
    v_mfma_f32_16x16x32_bf16 v[68:71], a[212:215], a[144:147], 0
    s_add_u32 m0, s38, 0
    v_exp_f32 v79, v79
    v_mfma_f32_16x16x32_bf16 v[68:71], a[216:219], a[148:151], v[68:71]
    v_cvt_pk_bf16_f32 v37, v78, v79
    v_cvt_pk_bf16_f32 v22, v64, v65
    v_mfma_f32_16x16x32_bf16 v[68:71], a[220:223], a[152:155], v[68:71]
    v_exp_f32 v59, v59
    v_mfma_f32_16x16x32_bf16 v[76:79], a[220:223], a[176:179], 0
    buffer_load_dwordx4 v6, s[12:15], s33 offen nt lds
    v_mfma_f32_16x16x32_bf16 v[76:79], a[216:219], a[172:175], v[76:79]
    s_add_u32 m0, s38, 1024
    v_exp_f32 v58, v58
    v_mfma_f32_16x16x32_bf16 v[76:79], a[212:215], a[168:171], v[76:79]
    s_waitcnt lgkmcnt(1)
    v_exp_f32 v75, v75
    v_mfma_f32_16x16x32_bf16 v[76:79], a[224:227], a[180:183], v[76:79]
    ds_read_b128 a[212:215], v0 offset:6144
    v_cvt_pk_bf16_f32 v34, v80, v81
    v_mfma_f32_16x16x32_bf16 v[76:79], a[228:231], a[184:187], v[76:79]
    s_waitcnt lgkmcnt(1)
    v_exp_f32 v67, v67
    v_mfma_f32_16x16x32_bf16 v[76:79], a[232:235], a[188:191], v[76:79]
    buffer_load_dwordx4 v7, s[12:15], s33 offen nt lds
    v_mfma_f32_16x16x32_bf16 v[68:71], a[232:235], a[164:167], v[68:71]
    ds_read_b128 a[220:223], v0 offset:7168
    s_add_u32 s59, s33, 128
    v_mfma_f32_16x16x32_bf16 v[68:71], a[228:231], a[160:163], v[68:71]
    s_add_u32 m0, s38, 2048
    v_exp_f32 v83, v83
    v_mfma_f32_16x16x32_bf16 v[68:71], a[224:227], a[156:159], v[68:71]
    ds_read_b128 a[216:219], v1 offset:6144
    v_cvt_pk_bf16_f32 v17, v58, v59
    v_mfma_f32_16x16x32_bf16 v[60:63], a[224:227], a[132:135], v[60:63]
    v_cvt_pk_bf16_f32 v23, v66, v67
    v_fma_f32 v82, v82, s28, v12
    v_mfma_f32_16x16x32_bf16 v[60:63], a[228:231], a[136:139], v[60:63]
    buffer_load_dwordx4 v6, s[12:15], s59 offen nt lds
    v_mfma_f32_16x16x32_bf16 v[60:63], a[232:235], a[140:143], v[60:63]
    v_exp_f32 v73, v73
    v_mfma_f32_16x16x32_bf16 v[52:55], a[232:235], a[116:119], v[52:55]
    ds_read_b128 a[232:235], v1 offset:8192
    v_cvt_pk_bf16_f32 v16, v56, v57
    v_mfma_f32_16x16x32_bf16 v[52:55], a[228:231], a[112:115], v[52:55]
    ds_read_b128 a[228:231], v0 offset:8192
    v_cvt_pk_bf16_f32 v29, v74, v75
    v_mfma_f32_16x16x32_bf16 v[52:55], a[224:227], a[108:111], v[52:55]
    ds_read_b128 a[224:227], v1 offset:7168
    v_mfma_f32_16x16x32_bf16 v[48:51], a[236:239], v[16:19], v[44:47]
    s_waitcnt lgkmcnt(5)
    v_exp_f32 v82, v82
    v_mfma_f32_16x16x32_bf16 v[56:59], a[212:215], a[96:99], 0
    s_add_u32 m0, s38, 3072
    v_cvt_pk_bf16_f32 v35, v82, v83
    v_cvt_pk_bf16_f32 v28, v72, v73
    v_mfma_f32_16x16x32_bf16 v[48:51], a[240:243], v[22:25], v[48:51]
    buffer_load_dwordx4 v7, s[12:15], s59 offen nt lds
    v_mfma_f32_16x16x32_bf16 v[48:51], a[244:247], v[28:31], v[48:51]
    v_mfma_f32_16x16x32_bf16 v[48:51], a[248:251], v[34:37], v[48:51]
    s_add_u32 s58, s33, 256
    s_add_u32 m0, s38, 4096
    s_waitcnt lgkmcnt(3)
    v_mfma_f32_16x16x32_bf16 v[56:59], a[216:219], a[100:103], v[56:59]
    buffer_load_dwordx4 v6, s[12:15], s58 offen nt lds
    v_mfma_f32_16x16x32_bf16 v[56:59], a[220:223], a[104:107], v[56:59]
    s_add_u32 m0, s38, 5120
    s_nop 0
    v_cmp_lt_f32 vcc, s29, v48
    v_mfma_f32_16x16x32_bf16 v[64:67], a[220:223], a[128:131], 0
    buffer_load_dwordx4 v7, s[12:15], s58 offen nt lds
    v_mfma_f32_16x16x32_bf16 v[64:67], a[216:219], a[124:127], v[64:67]
    s_waitcnt vmcnt(15) lgkmcnt(0)
    v_mfma_f32_16x16x32_bf16 v[64:67], a[212:215], a[120:123], v[64:67]
    s_barrier
    v_mfma_f32_16x16x32_bf16 v[72:75], a[212:215], a[144:147], 0
    s_cbranch_vccnz L_rs_start4b
L_ret_start4b:
    v_fma_f32 v55, v55, s28, v9
    v_mfma_f32_16x16x32_bf16 v[72:75], a[216:219], a[148:151], v[72:75]
    s_add_u32 m0, s22, 0
    v_fma_f32 v60, v60, s28, v10
    v_fma_f32 v61, v61, s28, v10
    v_mfma_f32_16x16x32_bf16 v[72:75], a[220:223], a[152:155], v[72:75]
    buffer_load_dwordx4 v6, s[4:7], s20 offen lds
    v_mfma_f32_16x16x32_bf16 v[80:83], a[220:223], a[176:179], 0
    s_add_u32 s20, s20, 128
    v_exp_f32 v55, v55
    v_mfma_f32_16x16x32_bf16 v[80:83], a[216:219], a[172:175], v[80:83]
    s_add_u32 m0, s22, 1024
    v_fma_f32 v52, v52, s28, v9
    v_fma_f32 v54, v54, s28, v9
    v_mfma_f32_16x16x32_bf16 v[80:83], a[212:215], a[168:171], v[80:83]
    ds_read_b64_tr_b16 a[212:213], v2 offset:18432
    buffer_load_dwordx4 v6, s[4:7], s20 offen lds
    v_mfma_f32_16x16x32_bf16 v[80:83], a[224:227], a[180:183], v[80:83]
    ds_read_b64_tr_b16 a[214:215], v2 offset:12288
    s_add_u32 s20, s20, 128
    v_mfma_f32_16x16x32_bf16 v[80:83], a[228:231], a[184:187], v[80:83]
    s_add_u32 m0, s22, 2048
    v_exp_f32 v54, v54
    v_mfma_f32_16x16x32_bf16 v[80:83], a[232:235], a[188:191], v[80:83]
    ds_read_b64_tr_b16 a[216:217], v3 offset:18432
    v_cvt_pk_bf16_f32 v15, v54, v55
    v_mfma_f32_16x16x32_bf16 v[72:75], a[232:235], a[164:167], v[72:75]
    v_exp_f32 v61, v61
    v_mfma_f32_16x16x32_bf16 v[72:75], a[228:231], a[160:163], v[72:75]
    buffer_load_dwordx4 v6, s[4:7], s20 offen lds
    v_mfma_f32_16x16x32_bf16 v[72:75], a[224:227], a[156:159], v[72:75]
    ds_read_b64_tr_b16 a[218:219], v3 offset:12288
    v_fma_f32 v53, v53, s28, v9
    v_mfma_f32_16x16x32_bf16 v[64:67], a[224:227], a[132:135], v[64:67]
    v_exp_f32 v60, v60
    v_mfma_f32_16x16x32_bf16 v[64:67], a[228:231], a[136:139], v[64:67]
    v_exp_f32 v53, v53
    v_mfma_f32_16x16x32_bf16 v[64:67], a[232:235], a[140:143], v[64:67]
    ds_read_b64_tr_b16 a[220:221], v4 offset:18432
    v_cvt_pk_bf16_f32 v20, v60, v61
    v_mfma_f32_16x16x32_bf16 v[56:59], a[232:235], a[116:119], v[56:59]
    s_add_u32 s20, s20, 12032
    v_exp_f32 v52, v52
    v_mfma_f32_16x16x32_bf16 v[56:59], a[228:231], a[112:115], v[56:59]
    ds_read_b64_tr_b16 a[222:223], v4 offset:12288
    v_cvt_pk_bf16_f32 v14, v52, v53
    v_mfma_f32_16x16x32_bf16 v[56:59], a[224:227], a[108:111], v[56:59]
    ds_read_b64_tr_b16 a[224:225], v5 offset:18432
    ds_read_b64_tr_b16 a[226:227], v5 offset:12288
    s_branch L_loop4
L_loop5:
    .p2align 6
L_loop5w0:
    s_waitcnt lgkmcnt(4)
    v_mfma_f32_16x16x32_bf16 v[112:115], a[212:215], v[16:19], v[112:115]
    v_fma_f32 v68, v68, s28, v11
    v_mfma_f32_16x16x32_bf16 v[116:119], a[216:219], v[16:19], v[116:119]
    v_fma_f32 v80, v80, s28, v12
    v_fma_f32 v69, v69, s28, v11
    v_mfma_f32_16x16x32_bf16 v[164:167], a[216:219], v[22:25], v[164:167]
    ds_read_b64_tr_b16 a[230:231], v2 offset:13312
    v_mfma_f32_16x16x32_bf16 v[160:163], a[212:215], v[22:25], v[160:163]
    v_fma_f32 v71, v71, s28, v11
    v_fma_f32 v88, v88, s28, v13
    v_mfma_f32_16x16x32_bf16 v[208:211], a[212:215], v[28:31], v[208:211]
    v_exp_f32 v71, v71
    v_mfma_f32_16x16x32_bf16 v[212:215], a[216:219], v[28:31], v[212:215]
    v_fma_f32 v56, v56, s28, v9
    v_mfma_f32_16x16x32_bf16 a[4:7], a[216:219], v[34:37], a[4:7]
    ds_read_b64_tr_b16 a[232:233], v3 offset:19456
    v_fma_f32 v76, v76, s28, v12
    v_mfma_f32_16x16x32_bf16 a[0:3], a[212:215], v[34:37], a[0:3]
    v_fma_f32 v67, v67, s28, v10
    v_fma_f32 v72, v72, s28, v11
    v_mfma_f32_16x16x32_bf16 a[48:51], a[212:215], v[40:43], a[48:51]
    ds_read_b64_tr_b16 a[234:235], v3 offset:13312
    v_fma_f32 v89, v89, s28, v13
    v_mfma_f32_16x16x32_bf16 a[52:55], a[216:219], v[40:43], a[52:55]
    s_waitcnt lgkmcnt(3)
    ds_read_b64_tr_b16 a[228:229], v2 offset:19456
    v_fma_f32 v78, v78, s28, v12
    v_mfma_f32_16x16x32_bf16 a[56:59], a[220:223], v[40:43], a[56:59]
    v_fma_f32 v84, v84, s28, v13
    v_fma_f32 v90, v90, s28, v13
    v_mfma_f32_16x16x32_bf16 a[60:63], a[224:227], v[40:43], a[60:63]
    v_exp_f32 v80, v80
    v_mfma_f32_16x16x32_bf16 a[12:15], a[224:227], v[34:37], a[12:15]
    v_fma_f32 v70, v70, s28, v11
    v_fma_f32 v86, v86, s28, v13
    v_mfma_f32_16x16x32_bf16 a[8:11], a[220:223], v[34:37], a[8:11]
    ds_read_b64_tr_b16 a[212:213], v4 offset:19456
    v_mfma_f32_16x16x32_bf16 v[216:219], a[220:223], v[28:31], v[216:219]
    v_fma_f32 v82, v82, s28, v12
    v_mfma_f32_16x16x32_bf16 v[220:223], a[224:227], v[28:31], v[220:223]
    ds_read_b64_tr_b16 a[214:215], v4 offset:13312
    v_mfma_f32_16x16x32_bf16 v[172:175], a[224:227], v[22:25], v[172:175]
    v_fma_f32 v87, v87, s28, v13
    v_fma_f32 v77, v77, s28, v12
    v_mfma_f32_16x16x32_bf16 v[168:171], a[220:223], v[22:25], v[168:171]
    s_add_u32 s39, s39, 12288
    ds_read_b64_tr_b16 a[218:219], v5 offset:13312
    v_fma_f32 v79, v79, s28, v12
    v_mfma_f32_16x16x32_bf16 v[120:123], a[220:223], v[16:19], v[120:123]
    ds_read_b64_tr_b16 a[216:217], v5 offset:19456
    v_fma_f32 v73, v73, s28, v11
    v_mfma_f32_16x16x32_bf16 v[124:127], a[224:227], v[16:19], v[124:127]
    s_waitcnt lgkmcnt(4)
    ds_read_b64_tr_b16 a[222:223], v2 offset:14336
    v_fma_f32 v57, v57, s28, v9
    v_mfma_f32_16x16x32_bf16 v[128:131], a[228:231], v[16:19], v[128:131]
    v_exp_f32 v56, v56
    v_mfma_f32_16x16x32_bf16 v[132:135], a[232:235], v[16:19], v[132:135]
    v_exp_f32 v88, v88
    v_mfma_f32_16x16x32_bf16 v[180:183], a[232:235], v[22:25], v[180:183]
    v_exp_f32 v78, v78
    v_mfma_f32_16x16x32_bf16 v[176:179], a[228:231], v[22:25], v[176:179]
    ds_read_b128 v[96:99], v103 offset:0
    v_fma_f32 v66, v66, s28, v10
    v_mfma_f32_16x16x32_bf16 v[224:227], a[228:231], v[28:31], v[224:227]
    ds_read_b64_tr_b16 a[224:225], v3 offset:20480
    v_mfma_f32_16x16x32_bf16 v[228:231], a[232:235], v[28:31], v[228:231]
    ds_read_b64_tr_b16 a[220:221], v2 offset:20480
    v_mfma_f32_16x16x32_bf16 a[20:23], a[232:235], v[34:37], a[20:23]
    ds_read_b64_tr_b16 a[226:227], v3 offset:14336
    v_mfma_f32_16x16x32_bf16 a[16:19], a[228:231], v[34:37], a[16:19]
    v_exp_f32 v76, v76
    v_mfma_f32_16x16x32_bf16 a[64:67], a[228:231], v[40:43], a[64:67]
    ds_read_b64_tr_b16 a[228:229], v4 offset:20480
    v_mfma_f32_16x16x32_bf16 a[68:71], a[232:235], v[40:43], a[68:71]
    s_waitcnt lgkmcnt(5)
    v_exp_f32 v69, v69
    v_mfma_f32_16x16x32_bf16 a[72:75], a[212:215], v[40:43], a[72:75]
    v_exp_f32 v79, v79
    v_mfma_f32_16x16x32_bf16 a[76:79], a[216:219], v[40:43], a[76:79]
    v_exp_f32 v68, v68
    v_mfma_f32_16x16x32_bf16 a[28:31], a[216:219], v[34:37], a[28:31]
    ds_read_b64_tr_b16 a[232:233], v5 offset:20480
    v_mfma_f32_16x16x32_bf16 a[24:27], a[212:215], v[34:37], a[24:27]
    ds_read_b64_tr_b16 a[234:235], v5 offset:14336
    v_fma_f32 v85, v85, s28, v13
    v_mfma_f32_16x16x32_bf16 v[232:235], a[212:215], v[28:31], v[232:235]
    v_mfma_f32_16x16x32_bf16 v[236:239], a[216:219], v[28:31], v[236:239]
    ds_read_b64_tr_b16 a[230:231], v4 offset:14336
    v_fma_f32 v58, v58, s28, v9
    v_mfma_f32_16x16x32_bf16 v[188:191], a[216:219], v[22:25], v[188:191]
    v_exp_f32 v85, v85
    v_mfma_f32_16x16x32_bf16 v[184:187], a[212:215], v[22:25], v[184:187]
    v_mfma_f32_16x16x32_bf16 v[136:139], a[212:215], v[16:19], v[136:139]
    v_exp_f32 v73, v73
    v_mfma_f32_16x16x32_bf16 v[140:143], a[216:219], v[16:19], v[140:143]
    s_waitcnt lgkmcnt(3)
    v_fma_f32 v59, v59, s28, v9
    v_mfma_f32_16x16x32_bf16 v[144:147], a[220:223], v[16:19], v[144:147]
    v_exp_f32 v77, v77
    v_mfma_f32_16x16x32_bf16 v[148:151], a[224:227], v[16:19], v[148:151]
    v_exp_f32 v70, v70
    v_mfma_f32_16x16x32_bf16 v[196:199], a[224:227], v[22:25], v[196:199]
    v_fma_f32 v91, v91, s28, v13
    v_mfma_f32_16x16x32_bf16 v[192:195], a[220:223], v[22:25], v[192:195]
    v_fma_f32 v83, v83, s28, v12
    v_fma_f32 v74, v74, s28, v11
    v_mfma_f32_16x16x32_bf16 v[240:243], a[220:223], v[28:31], v[240:243]
    v_cvt_pk_bf16_f32 v32, v76, v77
    v_cvt_pk_bf16_f32 v27, v70, v71
    v_mfma_f32_16x16x32_bf16 v[244:247], a[224:227], v[28:31], v[244:247]
    s_waitcnt vmcnt(10) lgkmcnt(0)
    v_exp_f32 v91, v91
    v_mfma_f32_16x16x32_bf16 a[36:39], a[224:227], v[34:37], a[36:39]
    v_exp_f32 v87, v87
    v_mfma_f32_16x16x32_bf16 a[32:35], a[220:223], v[34:37], a[32:35]
    s_barrier
    v_mfma_f32_16x16x32_bf16 a[80:83], a[220:223], v[40:43], a[80:83]
    s_add_u32 m0, s22, 36864
    ds_read_b128 a[212:215], v0 offset:12288
    v_cvt_pk_bf16_f32 v26, v68, v69
    v_mfma_f32_16x16x32_bf16 a[84:87], a[224:227], v[40:43], a[84:87]
    ds_read_b128 a[216:219], v1 offset:12288
    v_fma_f32 v75, v75, s28, v11
    v_mfma_f32_16x16x32_bf16 a[88:91], a[228:231], v[40:43], a[88:91]
    ds_read_b128 a[220:223], v0 offset:13312
    v_mfma_f32_16x16x32_bf16 a[92:95], a[232:235], v[40:43], a[92:95]
    buffer_load_dwordx4 v6, s[8:11], s21 offen lds
    v_mfma_f32_16x16x32_bf16 a[44:47], a[232:235], v[34:37], a[44:47]
    s_add_u32 s21, s21, 128
    v_fma_f32 v65, v65, s28, v10
    v_cvt_pk_bf16_f32 v33, v78, v79
    v_mfma_f32_16x16x32_bf16 a[40:43], a[228:231], v[34:37], a[40:43]
    s_add_u32 m0, s22, 37888
    v_exp_f32 v67, v67
    v_mfma_f32_16x16x32_bf16 v[248:251], a[228:231], v[28:31], v[248:251]
    v_exp_f32 v74, v74
    v_mfma_f32_16x16x32_bf16 v[252:255], a[232:235], v[28:31], v[252:255]
    buffer_load_dwordx4 v6, s[8:11], s21 offen lds
    v_mfma_f32_16x16x32_bf16 v[204:207], a[232:235], v[22:25], v[204:207]
    v_exp_f32 v86, v86
    v_mfma_f32_16x16x32_bf16 v[200:203], a[228:231], v[22:25], v[200:203]
    s_add_u32 s21, s21, 128
    s_add_u32 m0, s22, 38912
    v_fma_f32 v64, v64, s28, v10
    v_mfma_f32_16x16x32_bf16 v[152:155], a[228:231], v[16:19], v[152:155]
    buffer_load_dwordx4 v6, s[8:11], s21 offen lds
    v_mfma_f32_16x16x32_bf16 v[156:159], a[232:235], v[16:19], v[156:159]
    s_waitcnt lgkmcnt(1)
    v_exp_f32 v84, v84
    v_mfma_f32_16x16x32_bf16 v[52:55], a[212:215], a[96:99], 0
    v_mfma_f32_16x16x32_bf16 v[52:55], a[216:219], a[100:103], v[52:55]
    s_waitcnt lgkmcnt(0)
    v_exp_f32 v57, v57
    v_mfma_f32_16x16x32_bf16 v[52:55], a[220:223], a[104:107], v[52:55]
    ds_read_b128 a[232:235], v1 offset:14336
    v_cvt_pk_bf16_f32 v38, v84, v85
    v_mfma_f32_16x16x32_bf16 v[60:63], a[220:223], a[128:131], 0
    ds_read_b128 a[224:227], v1 offset:13312
    v_fma_f32 v81, v81, s28, v12
    v_mfma_f32_16x16x32_bf16 v[60:63], a[216:219], a[124:127], v[60:63]
    v_exp_f32 v75, v75
    v_mfma_f32_16x16x32_bf16 v[60:63], a[212:215], a[120:123], v[60:63]
    ds_read_b128 a[228:231], v0 offset:14336
    v_mfma_f32_16x16x32_bf16 v[68:71], a[212:215], a[144:147], 0
    s_add_u32 s21, s21, 12032
    v_exp_f32 v58, v58
    v_mfma_f32_16x16x32_bf16 v[68:71], a[216:219], a[148:151], v[68:71]
    v_exp_f32 v90, v90
    v_mfma_f32_16x16x32_bf16 v[68:71], a[220:223], a[152:155], v[68:71]
    buffer_store_dwordx4 v[96:99], v6, s[16:19], s24 offen offset:0 nt
    v_cvt_pk_bf16_f32 v39, v86, v87
    v_exp_f32 v59, v59
    v_mfma_f32_16x16x32_bf16 v[76:79], a[220:223], a[176:179], 0
    v_mfma_f32_16x16x32_bf16 v[76:79], a[216:219], a[172:175], v[76:79]
    s_add_u32 m0, s23, 0
    v_exp_f32 v72, v72
    v_mfma_f32_16x16x32_bf16 v[76:79], a[212:215], a[168:171], v[76:79]
    v_exp_f32 v64, v64
    v_mfma_f32_16x16x32_bf16 v[84:87], a[212:215], a[192:195], 0
    v_exp_f32 v89, v89
    v_mfma_f32_16x16x32_bf16 v[84:87], a[216:219], a[196:199], v[84:87]
    v_exp_f32 v81, v81
    v_mfma_f32_16x16x32_bf16 v[84:87], a[220:223], a[200:203], v[84:87]
    s_waitcnt lgkmcnt(0)
    ds_read_b128 a[212:215], v0 offset:18432
    v_mfma_f32_16x16x32_bf16 v[84:87], a[224:227], a[204:207], v[84:87]
    v_exp_f32 v65, v65
    v_mfma_f32_16x16x32_bf16 v[84:87], a[228:231], a[208:211], v[84:87]
    buffer_load_dwordx4 v6, s[12:15], s25 offen nt lds
    v_mfma_f32_16x16x32_bf16 v[84:87], a[232:235], v[92:95], v[84:87]
    ds_read_b128 v[96:99], v103 offset:1024
    v_cvt_pk_bf16_f32 v16, v56, v57
    v_mfma_f32_16x16x32_bf16 v[76:79], a[232:235], a[188:191], v[76:79]
    v_exp_f32 v66, v66
    v_mfma_f32_16x16x32_bf16 v[76:79], a[228:231], a[184:187], v[76:79]
    v_cvt_pk_bf16_f32 v41, v90, v91
    v_cvt_pk_bf16_f32 v29, v74, v75
    v_mfma_f32_16x16x32_bf16 v[76:79], a[224:227], a[180:183], v[76:79]
    v_cvt_pk_bf16_f32 v34, v80, v81
    v_cvt_pk_bf16_f32 v17, v58, v59
    v_mfma_f32_16x16x32_bf16 v[68:71], a[224:227], a[156:159], v[68:71]
    ds_read_b128 a[220:223], v0 offset:19456
    v_mfma_f32_16x16x32_bf16 v[68:71], a[228:231], a[160:163], v[68:71]
    v_cvt_pk_bf16_f32 v22, v64, v65
    v_mfma_f32_16x16x32_bf16 v[68:71], a[232:235], a[164:167], v[68:71]
    v_cvt_pk_bf16_f32 v40, v88, v89
    v_mfma_f32_16x16x32_bf16 v[44:47], a[236:239], v[14:17], v[48:51]
    ds_read_b128 a[216:219], v1 offset:18432
    v_cvt_pk_bf16_f32 v28, v72, v73
    v_mfma_f32_16x16x32_bf16 v[60:63], a[232:235], a[140:143], v[60:63]
    v_exp_f32 v83, v83
    v_mfma_f32_16x16x32_bf16 v[60:63], a[228:231], a[136:139], v[60:63]
    v_exp_f32 v82, v82
    v_mfma_f32_16x16x32_bf16 v[60:63], a[224:227], a[132:135], v[60:63]
    v_cvt_pk_bf16_f32 v23, v66, v67
    v_mfma_f32_16x16x32_bf16 v[52:55], a[224:227], a[108:111], v[52:55]
    v_mfma_f32_16x16x32_bf16 v[52:55], a[228:231], a[112:115], v[52:55]
    v_cvt_pk_bf16_f32 v35, v82, v83
    v_mfma_f32_16x16x32_bf16 v[52:55], a[232:235], a[116:119], v[52:55]
    s_add_u32 m0, s23, 1024
    ds_read_b128 a[232:235], v1 offset:20480
    v_mfma_f32_16x16x32_bf16 v[44:47], a[240:243], v[20:23], v[44:47]
    ds_read_b128 a[228:231], v0 offset:20480
    v_mfma_f32_16x16x32_bf16 v[44:47], a[244:247], v[26:29], v[44:47]
    s_waitcnt lgkmcnt(3)
    ds_read_b128 a[224:227], v1 offset:19456
    v_mfma_f32_16x16x32_bf16 v[56:59], a[212:215], a[96:99], 0
    v_mfma_f32_16x16x32_bf16 v[44:47], a[248:251], v[32:35], v[44:47]
    buffer_load_dwordx4 v7, s[12:15], s25 offen nt lds
    v_mfma_f32_16x16x32_bf16 v[44:47], a[252:255], v[38:41], v[44:47]
    s_bitcmp1_b32 s27, 0
    s_cselect_b32 s26, s49, 128
    s_waitcnt lgkmcnt(3)
    v_mfma_f32_16x16x32_bf16 v[56:59], a[216:219], a[100:103], v[56:59]
    v_mfma_f32_16x16x32_bf16 v[56:59], a[220:223], a[104:107], v[56:59]
    s_lshr_b32 s27, s27, 1
    v_mfma_f32_16x16x32_bf16 v[64:67], a[220:223], a[128:131], 0
    s_nop 0
    v_cmp_lt_f32 vcc, s29, v44
    v_mfma_f32_16x16x32_bf16 v[64:67], a[216:219], a[124:127], v[64:67]
    buffer_store_dwordx4 v[96:99], v7, s[16:19], s24 offen offset:0 nt
    s_add_u32 s24, s24, s26
    s_add_u32 s25, s25, s26
    s_nop 0
    s_cbranch_vccnz L_rs_loop5w0a
L_ret_loop5w0a:
    v_mfma_f32_16x16x32_bf16 v[64:67], a[212:215], a[120:123], v[64:67]
    v_fma_f32 v61, v61, s28, v10
    s_waitcnt vmcnt(14) lgkmcnt(0)
    v_mfma_f32_16x16x32_bf16 v[72:75], a[212:215], a[144:147], 0
    s_barrier
    v_mfma_f32_16x16x32_bf16 v[72:75], a[216:219], a[148:151], v[72:75]
    s_add_u32 m0, s22, 12288
    v_fma_f32 v52, v52, s28, v9
    v_fma_f32 v63, v63, s28, v10
    v_mfma_f32_16x16x32_bf16 v[72:75], a[220:223], a[152:155], v[72:75]
    buffer_load_dwordx4 v6, s[4:7], s20 offen lds
    v_mfma_f32_16x16x32_bf16 v[80:83], a[220:223], a[176:179], 0
    s_add_u32 s20, s20, 128
    v_fma_f32 v62, v62, s28, v10
    v_fma_f32 v60, v60, s28, v10
    v_mfma_f32_16x16x32_bf16 v[80:83], a[216:219], a[172:175], v[80:83]
    s_add_u32 m0, s22, 13312
    v_exp_f32 v60, v60
    v_mfma_f32_16x16x32_bf16 v[80:83], a[212:215], a[168:171], v[80:83]
    buffer_load_dwordx4 v6, s[4:7], s20 offen lds
    v_mfma_f32_16x16x32_bf16 v[88:91], a[212:215], a[192:195], 0
    s_add_u32 s20, s20, 128
    ds_read_b64_tr_b16 a[212:213], v2 offset:0
    v_fma_f32 v55, v55, s28, v9
    v_mfma_f32_16x16x32_bf16 v[88:91], a[216:219], a[196:199], v[88:91]
    s_add_u32 m0, s22, 14336
    v_exp_f32 v52, v52
    v_mfma_f32_16x16x32_bf16 v[88:91], a[220:223], a[200:203], v[88:91]
    ds_read_b64_tr_b16 a[214:215], v2 offset:6144
    v_mfma_f32_16x16x32_bf16 v[88:91], a[224:227], a[204:207], v[88:91]
    buffer_load_dwordx4 v6, s[4:7], s20 offen lds
    v_mfma_f32_16x16x32_bf16 v[88:91], a[228:231], a[208:211], v[88:91]
    v_exp_f32 v62, v62
    v_mfma_f32_16x16x32_bf16 v[88:91], a[232:235], v[92:95], v[88:91]
    v_exp_f32 v55, v55
    v_mfma_f32_16x16x32_bf16 v[80:83], a[232:235], a[188:191], v[80:83]
    v_exp_f32 v61, v61
    v_mfma_f32_16x16x32_bf16 v[80:83], a[228:231], a[184:187], v[80:83]
    ds_read_b64_tr_b16 a[216:217], v3 offset:0
    v_fma_f32 v53, v53, s28, v9
    v_mfma_f32_16x16x32_bf16 v[80:83], a[224:227], a[180:183], v[80:83]
    s_add_u32 s20, s20, 12032
    ds_read_b64_tr_b16 a[218:219], v3 offset:6144
    v_fma_f32 v54, v54, s28, v9
    v_mfma_f32_16x16x32_bf16 v[72:75], a[224:227], a[156:159], v[72:75]
    v_exp_f32 v54, v54
    v_mfma_f32_16x16x32_bf16 v[72:75], a[228:231], a[160:163], v[72:75]
    ds_read_b64_tr_b16 a[220:221], v4 offset:0
    v_mfma_f32_16x16x32_bf16 v[72:75], a[232:235], a[164:167], v[72:75]
    v_exp_f32 v53, v53
    v_mfma_f32_16x16x32_bf16 v[64:67], a[232:235], a[140:143], v[64:67]
    v_exp_f32 v63, v63
    v_mfma_f32_16x16x32_bf16 v[64:67], a[228:231], a[136:139], v[64:67]
    v_cvt_pk_bf16_f32 v24, v60, v61
    v_mfma_f32_16x16x32_bf16 v[64:67], a[224:227], a[132:135], v[64:67]
    v_cvt_pk_bf16_f32 v19, v54, v55
    v_mfma_f32_16x16x32_bf16 v[56:59], a[224:227], a[108:111], v[56:59]
    ds_read_b64_tr_b16 a[222:223], v4 offset:6144
    v_cvt_pk_bf16_f32 v25, v62, v63
    v_mfma_f32_16x16x32_bf16 v[56:59], a[228:231], a[112:115], v[56:59]
    ds_read_b64_tr_b16 a[224:225], v5 offset:0
    v_cvt_pk_bf16_f32 v18, v52, v53
    v_mfma_f32_16x16x32_bf16 v[56:59], a[232:235], a[116:119], v[56:59]
    ds_read_b64_tr_b16 a[226:227], v5 offset:6144
    s_waitcnt lgkmcnt(4)
    v_mfma_f32_16x16x32_bf16 v[112:115], a[212:215], v[14:17], v[112:115]
    v_fma_f32 v80, v80, s28, v12
    v_mfma_f32_16x16x32_bf16 v[116:119], a[216:219], v[14:17], v[116:119]
    v_fma_f32 v71, v71, s28, v11
    v_fma_f32 v79, v79, s28, v12
    v_mfma_f32_16x16x32_bf16 v[164:167], a[216:219], v[20:23], v[164:167]
    ds_read_b64_tr_b16 a[228:229], v2 offset:1024
    v_mfma_f32_16x16x32_bf16 v[160:163], a[212:215], v[20:23], v[160:163]
    s_add_u32 s39, s39, 12288
    ds_read_b64_tr_b16 a[230:231], v2 offset:7168
    v_mfma_f32_16x16x32_bf16 v[208:211], a[212:215], v[26:29], v[208:211]
    ds_read_b64_tr_b16 a[232:233], v3 offset:1024
    v_mfma_f32_16x16x32_bf16 v[212:215], a[216:219], v[26:29], v[212:215]
    v_fma_f32 v76, v76, s28, v12
    v_fma_f32 v81, v81, s28, v12
    v_mfma_f32_16x16x32_bf16 a[4:7], a[216:219], v[32:35], a[4:7]
    ds_read_b64_tr_b16 a[234:235], v3 offset:7168
    v_fma_f32 v56, v56, s28, v9
    v_mfma_f32_16x16x32_bf16 a[0:3], a[212:215], v[32:35], a[0:3]
    v_exp_f32 v79, v79
    v_mfma_f32_16x16x32_bf16 a[48:51], a[212:215], v[38:41], a[48:51]
    v_fma_f32 v70, v70, s28, v11
    v_fma_f32 v86, v86, s28, v13
    v_mfma_f32_16x16x32_bf16 a[52:55], a[216:219], v[38:41], a[52:55]
    s_waitcnt lgkmcnt(4)
    v_exp_f32 v70, v70
    v_mfma_f32_16x16x32_bf16 a[56:59], a[220:223], v[38:41], a[56:59]
    v_fma_f32 v84, v84, s28, v13
    v_fma_f32 v83, v83, s28, v12
    v_mfma_f32_16x16x32_bf16 a[60:63], a[224:227], v[38:41], a[60:63]
    ds_read_b64_tr_b16 a[218:219], v5 offset:7168
    v_fma_f32 v57, v57, s28, v9
    v_mfma_f32_16x16x32_bf16 a[12:15], a[224:227], v[32:35], a[12:15]
    v_exp_f32 v84, v84
    v_mfma_f32_16x16x32_bf16 a[8:11], a[220:223], v[32:35], a[8:11]
    v_fma_f32 v68, v68, s28, v11
    v_fma_f32 v66, v66, s28, v10
    v_mfma_f32_16x16x32_bf16 v[216:219], a[220:223], v[26:29], v[216:219]
    v_exp_f32 v71, v71
    v_mfma_f32_16x16x32_bf16 v[220:223], a[224:227], v[26:29], v[220:223]
    ds_read_b64_tr_b16 a[212:213], v4 offset:1024
    v_fma_f32 v89, v89, s28, v13
    v_mfma_f32_16x16x32_bf16 v[172:175], a[224:227], v[20:23], v[172:175]
    v_fma_f32 v90, v90, s28, v13
    v_mfma_f32_16x16x32_bf16 v[168:171], a[220:223], v[20:23], v[168:171]
    ds_read_b64_tr_b16 a[216:217], v5 offset:1024
    v_fma_f32 v78, v78, s28, v12
    v_mfma_f32_16x16x32_bf16 v[120:123], a[220:223], v[14:17], v[120:123]
    ds_read_b64_tr_b16 a[214:215], v4 offset:7168
    v_fma_f32 v82, v82, s28, v12
    v_mfma_f32_16x16x32_bf16 v[124:127], a[224:227], v[14:17], v[124:127]
    s_waitcnt lgkmcnt(4)
    v_exp_f32 v68, v68
    v_mfma_f32_16x16x32_bf16 v[128:131], a[228:231], v[14:17], v[128:131]
    v_exp_f32 v83, v83
    v_mfma_f32_16x16x32_bf16 v[132:135], a[232:235], v[14:17], v[132:135]
    ds_read_b64_tr_b16 a[222:223], v2 offset:8192
    v_fma_f32 v73, v73, s28, v11
    v_mfma_f32_16x16x32_bf16 v[180:183], a[232:235], v[20:23], v[180:183]
    v_exp_f32 v86, v86
    v_mfma_f32_16x16x32_bf16 v[176:179], a[228:231], v[20:23], v[176:179]
    ds_read_b64_tr_b16 a[224:225], v3 offset:2048
    v_mfma_f32_16x16x32_bf16 v[224:227], a[228:231], v[26:29], v[224:227]
    ds_read_b64_tr_b16 a[220:221], v2 offset:2048
    v_fma_f32 v85, v85, s28, v13
    v_mfma_f32_16x16x32_bf16 v[228:231], a[232:235], v[26:29], v[228:231]
    v_exp_f32 v81, v81
    v_mfma_f32_16x16x32_bf16 a[20:23], a[232:235], v[32:35], a[20:23]
    ds_read_b64_tr_b16 a[226:227], v3 offset:8192
    v_fma_f32 v67, v67, s28, v10
    v_mfma_f32_16x16x32_bf16 a[16:19], a[228:231], v[32:35], a[16:19]
    v_fma_f32 v59, v59, s28, v9
    v_mfma_f32_16x16x32_bf16 a[64:67], a[228:231], v[38:41], a[64:67]
    v_fma_f32 v64, v64, s28, v10
    v_fma_f32 v74, v74, s28, v11
    v_mfma_f32_16x16x32_bf16 a[68:71], a[232:235], v[38:41], a[68:71]
    s_waitcnt lgkmcnt(4)
    ds_read_b64_tr_b16 a[232:233], v5 offset:2048
    v_mfma_f32_16x16x32_bf16 a[72:75], a[212:215], v[38:41], a[72:75]
    ds_read_b64_tr_b16 a[228:229], v4 offset:2048
    v_mfma_f32_16x16x32_bf16 a[76:79], a[216:219], v[38:41], a[76:79]
    ds_read_b64_tr_b16 a[230:231], v4 offset:8192
    v_fma_f32 v69, v69, s28, v11
    v_mfma_f32_16x16x32_bf16 a[28:31], a[216:219], v[32:35], a[28:31]
    ds_read_b64_tr_b16 a[234:235], v5 offset:8192
    v_mfma_f32_16x16x32_bf16 a[24:27], a[212:215], v[32:35], a[24:27]
    v_exp_f32 v76, v76
    v_mfma_f32_16x16x32_bf16 v[232:235], a[212:215], v[26:29], v[232:235]
    v_exp_f32 v90, v90
    v_mfma_f32_16x16x32_bf16 v[236:239], a[216:219], v[26:29], v[236:239]
    v_exp_f32 v82, v82
    v_mfma_f32_16x16x32_bf16 v[188:191], a[216:219], v[20:23], v[188:191]
    v_fma_f32 v91, v91, s28, v13
    v_mfma_f32_16x16x32_bf16 v[184:187], a[212:215], v[20:23], v[184:187]
    v_fma_f32 v77, v77, s28, v12
    v_fma_f32 v87, v87, s28, v13
    v_mfma_f32_16x16x32_bf16 v[136:139], a[212:215], v[14:17], v[136:139]
    v_exp_f32 v67, v67
    v_mfma_f32_16x16x32_bf16 v[140:143], a[216:219], v[14:17], v[140:143]
    s_waitcnt lgkmcnt(3)
    v_exp_f32 v78, v78
    v_mfma_f32_16x16x32_bf16 v[144:147], a[220:223], v[14:17], v[144:147]
    v_exp_f32 v77, v77
    v_mfma_f32_16x16x32_bf16 v[148:151], a[224:227], v[14:17], v[148:151]
    v_exp_f32 v80, v80
    v_mfma_f32_16x16x32_bf16 v[196:199], a[224:227], v[20:23], v[196:199]
    v_exp_f32 v87, v87
    v_mfma_f32_16x16x32_bf16 v[192:195], a[220:223], v[20:23], v[192:195]
    s_waitcnt vmcnt(10) lgkmcnt(0)
    v_fma_f32 v65, v65, s28, v10
    v_fma_f32 v58, v58, s28, v9
    v_mfma_f32_16x16x32_bf16 v[240:243], a[220:223], v[26:29], v[240:243]
    v_exp_f32 v64, v64
    v_mfma_f32_16x16x32_bf16 v[244:247], a[224:227], v[26:29], v[244:247]
    s_add_u32 m0, s22, 24576
    ds_read_b128 v[96:99], v103 offset:2048
    v_mfma_f32_16x16x32_bf16 a[36:39], a[224:227], v[32:35], a[36:39]
    v_cvt_pk_bf16_f32 v37, v78, v79
    v_fma_f32 v75, v75, s28, v11
    v_mfma_f32_16x16x32_bf16 a[32:35], a[220:223], v[32:35], a[32:35]
    s_barrier
    v_mfma_f32_16x16x32_bf16 a[80:83], a[220:223], v[38:41], a[80:83]
    buffer_load_dwordx4 v6, s[8:11], s21 offen lds
    v_mfma_f32_16x16x32_bf16 a[84:87], a[224:227], v[38:41], a[84:87]
    s_add_u32 s21, s21, 128
    ds_read_b128 a[212:215], v0 offset:0
    v_mfma_f32_16x16x32_bf16 a[88:91], a[228:231], v[38:41], a[88:91]
    ds_read_b128 a[216:219], v1 offset:0
    v_mfma_f32_16x16x32_bf16 a[92:95], a[232:235], v[38:41], a[92:95]
    ds_read_b128 a[220:223], v0 offset:1024
    v_mfma_f32_16x16x32_bf16 a[44:47], a[232:235], v[32:35], a[44:47]
    s_add_u32 m0, s22, 25600
    ds_read_b128 a[224:227], v1 offset:1024
    v_mfma_f32_16x16x32_bf16 a[40:43], a[228:231], v[32:35], a[40:43]
    buffer_load_dwordx4 v6, s[8:11], s21 offen lds
    v_mfma_f32_16x16x32_bf16 v[248:251], a[228:231], v[26:29], v[248:251]
    v_exp_f32 v73, v73
    v_mfma_f32_16x16x32_bf16 v[252:255], a[232:235], v[26:29], v[252:255]
    s_add_u32 s21, s21, 128
    v_exp_f32 v69, v69
    v_mfma_f32_16x16x32_bf16 v[204:207], a[232:235], v[20:23], v[204:207]
    v_cvt_pk_bf16_f32 v34, v80, v81
    v_cvt_pk_bf16_f32 v31, v70, v71
    v_mfma_f32_16x16x32_bf16 v[200:203], a[228:231], v[20:23], v[200:203]
    s_add_u32 m0, s22, 26624
    v_exp_f32 v58, v58
    v_mfma_f32_16x16x32_bf16 v[152:155], a[228:231], v[14:17], v[152:155]
    buffer_load_dwordx4 v6, s[8:11], s21 offen lds
    v_mfma_f32_16x16x32_bf16 v[156:159], a[232:235], v[14:17], v[156:159]
    s_waitcnt lgkmcnt(3)
    ds_read_b128 a[228:231], v0 offset:2048
    v_fma_f32 v88, v88, s28, v13
    v_mfma_f32_16x16x32_bf16 v[52:55], a[212:215], a[96:99], 0
    s_waitcnt lgkmcnt(3)
    ds_read_b128 a[232:235], v1 offset:2048
    v_mfma_f32_16x16x32_bf16 v[52:55], a[216:219], a[100:103], v[52:55]
    s_waitcnt lgkmcnt(3)
    v_mfma_f32_16x16x32_bf16 v[52:55], a[220:223], a[104:107], v[52:55]
    s_add_u32 s21, s21, 12032
    v_cvt_pk_bf16_f32 v30, v68, v69
    v_cvt_pk_bf16_f32 v36, v76, v77
    v_mfma_f32_16x16x32_bf16 v[60:63], a[220:223], a[128:131], 0
    v_exp_f32 v56, v56
    v_mfma_f32_16x16x32_bf16 v[60:63], a[216:219], a[124:127], v[60:63]
    v_exp_f32 v91, v91
    v_mfma_f32_16x16x32_bf16 v[60:63], a[212:215], a[120:123], v[60:63]
    v_fma_f32 v72, v72, s28, v11
    v_mfma_f32_16x16x32_bf16 v[68:71], a[212:215], a[144:147], 0
    v_exp_f32 v85, v85
    v_mfma_f32_16x16x32_bf16 v[68:71], a[216:219], a[148:151], v[68:71]
    v_exp_f32 v59, v59
    v_mfma_f32_16x16x32_bf16 v[68:71], a[220:223], a[152:155], v[68:71]
    buffer_store_dwordx4 v[96:99], v6, s[16:19], s24 offen offset:0 nt
    s_add_u32 m0, s23, 2048
    v_exp_f32 v57, v57
    v_cvt_pk_bf16_f32 v42, v84, v85
    v_mfma_f32_16x16x32_bf16 v[76:79], a[220:223], a[176:179], 0
    v_cvt_pk_bf16_f32 v17, v58, v59
    v_cvt_pk_bf16_f32 v43, v86, v87
    v_mfma_f32_16x16x32_bf16 v[76:79], a[216:219], a[172:175], v[76:79]
    v_exp_f32 v74, v74
    v_mfma_f32_16x16x32_bf16 v[76:79], a[212:215], a[168:171], v[76:79]
    v_exp_f32 v66, v66
    v_mfma_f32_16x16x32_bf16 v[84:87], a[212:215], a[192:195], 0
    v_mfma_f32_16x16x32_bf16 v[84:87], a[216:219], a[196:199], v[84:87]
    v_exp_f32 v65, v65
    v_mfma_f32_16x16x32_bf16 v[84:87], a[220:223], a[200:203], v[84:87]
    s_waitcnt lgkmcnt(0)
    v_exp_f32 v72, v72
    v_mfma_f32_16x16x32_bf16 v[84:87], a[224:227], a[204:207], v[84:87]
    ds_read_b128 a[220:223], v0 offset:7168
    v_cvt_pk_bf16_f32 v41, v90, v91
    v_mfma_f32_16x16x32_bf16 v[84:87], a[228:231], a[208:211], v[84:87]
    v_exp_f32 v75, v75
    v_mfma_f32_16x16x32_bf16 v[84:87], a[232:235], v[92:95], v[84:87]
    v_mfma_f32_16x16x32_bf16 v[76:79], a[232:235], a[188:191], v[76:79]
    buffer_load_dwordx4 v6, s[12:15], s25 offen nt lds
    v_mfma_f32_16x16x32_bf16 v[76:79], a[228:231], a[184:187], v[76:79]
    v_exp_f32 v89, v89
    v_mfma_f32_16x16x32_bf16 v[76:79], a[224:227], a[180:183], v[76:79]
    v_cvt_pk_bf16_f32 v23, v66, v67
    v_mfma_f32_16x16x32_bf16 v[68:71], a[224:227], a[156:159], v[68:71]
    v_exp_f32 v88, v88
    v_mfma_f32_16x16x32_bf16 v[68:71], a[228:231], a[160:163], v[68:71]
    ds_read_b128 v[96:99], v103 offset:3072
    v_mfma_f32_16x16x32_bf16 v[68:71], a[232:235], a[164:167], v[68:71]
    v_cvt_pk_bf16_f32 v40, v88, v89
    v_cvt_pk_bf16_f32 v16, v56, v57
    v_mfma_f32_16x16x32_bf16 v[60:63], a[232:235], a[140:143], v[60:63]
    ds_read_b128 a[216:219], v1 offset:6144
    v_mfma_f32_16x16x32_bf16 v[60:63], a[228:231], a[136:139], v[60:63]
    ds_read_b128 a[212:215], v0 offset:6144
    v_cvt_pk_bf16_f32 v35, v82, v83
    v_mfma_f32_16x16x32_bf16 v[60:63], a[224:227], a[132:135], v[60:63]
    v_mfma_f32_16x16x32_bf16 v[48:51], a[236:239], v[16:19], v[44:47]
    v_cvt_pk_bf16_f32 v22, v64, v65
    v_cvt_pk_bf16_f32 v29, v74, v75
    v_mfma_f32_16x16x32_bf16 v[52:55], a[224:227], a[108:111], v[52:55]
    v_cvt_pk_bf16_f32 v28, v72, v73
    v_mfma_f32_16x16x32_bf16 v[52:55], a[228:231], a[112:115], v[52:55]
    s_add_u32 m0, s23, 3072
    ds_read_b128 a[224:227], v1 offset:7168
    v_mfma_f32_16x16x32_bf16 v[48:51], a[240:243], v[22:25], v[48:51]
    ds_read_b128 a[228:231], v0 offset:8192
    v_mfma_f32_16x16x32_bf16 v[52:55], a[232:235], a[116:119], v[52:55]
    ds_read_b128 a[232:235], v1 offset:8192
    v_mfma_f32_16x16x32_bf16 v[48:51], a[244:247], v[28:31], v[48:51]
    s_waitcnt lgkmcnt(5)
    buffer_load_dwordx4 v7, s[12:15], s25 offen nt lds
    v_mfma_f32_16x16x32_bf16 v[48:51], a[248:251], v[34:37], v[48:51]
    s_bitcmp1_b32 s27, 0
    v_add_u32 v103, 4096, v103
    v_mfma_f32_16x16x32_bf16 v[48:51], a[252:255], v[40:43], v[48:51]
    s_cselect_b32 s26, s49, 128
    s_lshr_b32 s27, s27, 1
    s_waitcnt lgkmcnt(3)
    v_mfma_f32_16x16x32_bf16 v[56:59], a[212:215], a[96:99], 0
    buffer_store_dwordx4 v[96:99], v7, s[16:19], s24 offen offset:0 nt
    s_nop 2
    v_cmp_lt_f32 vcc, s29, v48
    s_add_u32 s24, s24, s26
    v_mfma_f32_16x16x32_bf16 v[56:59], a[216:219], a[100:103], v[56:59]
    s_add_u32 s25, s25, s26
    s_add_u32 s23, s23, 4096
    v_mfma_f32_16x16x32_bf16 v[56:59], a[220:223], a[104:107], v[56:59]
    s_cbranch_vccnz L_rs_loop5w0b
L_ret_loop5w0b:
    v_fma_f32 v54, v54, s28, v9
    v_mfma_f32_16x16x32_bf16 v[64:67], a[220:223], a[128:131], 0
    v_fma_f32 v53, v53, s28, v9
    v_mfma_f32_16x16x32_bf16 v[64:67], a[216:219], a[124:127], v[64:67]
    v_fma_f32 v55, v55, s28, v9
    v_mfma_f32_16x16x32_bf16 v[64:67], a[212:215], a[120:123], v[64:67]
    s_waitcnt vmcnt(14) lgkmcnt(0)
    s_cmp_eq_u32 s30, 5
    s_cselect_b32 s26, s62, 0
    v_mfma_f32_16x16x32_bf16 v[72:75], a[212:215], a[144:147], 0
    s_barrier
    v_mfma_f32_16x16x32_bf16 v[72:75], a[216:219], a[148:151], v[72:75]
    s_add_u32 s20, s20, s26
    s_add_u32 m0, s22, 0
    v_fma_f32 v62, v62, s28, v10
    v_mfma_f32_16x16x32_bf16 v[72:75], a[220:223], a[152:155], v[72:75]
    buffer_load_dwordx4 v6, s[4:7], s20 offen lds
    v_mfma_f32_16x16x32_bf16 v[80:83], a[220:223], a[176:179], 0
    s_add_u32 s20, s20, 128
    v_exp_f32 v62, v62
    v_mfma_f32_16x16x32_bf16 v[80:83], a[216:219], a[172:175], v[80:83]
    s_add_u32 m0, s22, 1024
    v_exp_f32 v54, v54
    v_mfma_f32_16x16x32_bf16 v[80:83], a[212:215], a[168:171], v[80:83]
    buffer_load_dwordx4 v6, s[4:7], s20 offen lds
    v_mfma_f32_16x16x32_bf16 v[88:91], a[212:215], a[192:195], 0
    ds_read_b64_tr_b16 a[212:213], v2 offset:18432
    v_fma_f32 v52, v52, s28, v9
    v_mfma_f32_16x16x32_bf16 v[88:91], a[216:219], a[196:199], v[88:91]
    s_add_u32 s20, s20, 128
    ds_read_b64_tr_b16 a[214:215], v2 offset:12288
    s_add_u32 m0, s22, 2048
    v_mfma_f32_16x16x32_bf16 v[88:91], a[220:223], a[200:203], v[88:91]
    buffer_load_dwordx4 v6, s[4:7], s20 offen lds
    v_mfma_f32_16x16x32_bf16 v[88:91], a[224:227], a[204:207], v[88:91]
    v_exp_f32 v53, v53
    v_mfma_f32_16x16x32_bf16 v[88:91], a[228:231], a[208:211], v[88:91]
    ds_read_b64_tr_b16 a[216:217], v3 offset:18432
    v_fma_f32 v61, v61, s28, v10
    v_mfma_f32_16x16x32_bf16 v[88:91], a[232:235], v[92:95], v[88:91]
    v_exp_f32 v55, v55
    v_mfma_f32_16x16x32_bf16 v[80:83], a[232:235], a[188:191], v[80:83]
    ds_read_b64_tr_b16 a[218:219], v3 offset:12288
    v_fma_f32 v60, v60, s28, v10
    v_mfma_f32_16x16x32_bf16 v[80:83], a[228:231], a[184:187], v[80:83]
    v_exp_f32 v52, v52
    v_mfma_f32_16x16x32_bf16 v[80:83], a[224:227], a[180:183], v[80:83]
    s_add_u32 s20, s20, 12032
    v_fma_f32 v63, v63, s28, v10
    v_mfma_f32_16x16x32_bf16 v[72:75], a[224:227], a[156:159], v[72:75]
    s_add_u32 s30, s30, 1
    v_exp_f32 v60, v60
    v_mfma_f32_16x16x32_bf16 v[72:75], a[228:231], a[160:163], v[72:75]
    ds_read_b64_tr_b16 a[220:221], v4 offset:18432
    v_cvt_pk_bf16_f32 v14, v52, v53
    v_mfma_f32_16x16x32_bf16 v[72:75], a[232:235], a[164:167], v[72:75]
    v_exp_f32 v61, v61
    v_mfma_f32_16x16x32_bf16 v[64:67], a[232:235], a[140:143], v[64:67]
    v_exp_f32 v63, v63
    v_mfma_f32_16x16x32_bf16 v[64:67], a[228:231], a[136:139], v[64:67]
    ds_read_b64_tr_b16 a[222:223], v4 offset:12288
    v_cvt_pk_bf16_f32 v15, v54, v55
    v_mfma_f32_16x16x32_bf16 v[64:67], a[224:227], a[132:135], v[64:67]
    v_cvt_pk_bf16_f32 v21, v62, v63
    v_mfma_f32_16x16x32_bf16 v[56:59], a[224:227], a[108:111], v[56:59]
    ds_read_b64_tr_b16 a[224:225], v5 offset:18432
    v_cvt_pk_bf16_f32 v20, v60, v61
    v_mfma_f32_16x16x32_bf16 v[56:59], a[228:231], a[112:115], v[56:59]
    s_cmp_lt_u32 s30, 6
    ds_read_b64_tr_b16 a[226:227], v5 offset:12288
    v_mfma_f32_16x16x32_bf16 v[56:59], a[232:235], a[116:119], v[56:59]
    s_cbranch_scc1 L_loop5w0
    s_cmp_ge_u32 s37, 6
    s_cbranch_scc1 L_end5
    s_cmp_eq_u32 s32, 0
    s_cbranch_scc1 L_tr54
    s_branch L_tr55
L_tr54:
    s_waitcnt lgkmcnt(4)
    v_mfma_f32_16x16x32_bf16 v[112:115], a[212:215], v[16:19], v[112:115]
    ds_read_b64_tr_b16 a[232:233], v3 offset:19456
    v_fma_f32 v56, v56, s28, v9
    v_mfma_f32_16x16x32_bf16 v[116:119], a[216:219], v[16:19], v[116:119]
    v_fma_f32 v77, v77, s28, v12
    v_mfma_f32_16x16x32_bf16 v[164:167], a[216:219], v[22:25], v[164:167]
    ds_read_b64_tr_b16 a[230:231], v2 offset:13312
    v_fma_f32 v59, v59, s28, v9
    v_mfma_f32_16x16x32_bf16 v[160:163], a[212:215], v[22:25], v[160:163]
    ds_read_b64_tr_b16 a[228:229], v2 offset:19456
    v_fma_f32 v75, v75, s28, v11
    v_mfma_f32_16x16x32_bf16 v[208:211], a[212:215], v[28:31], v[208:211]
    v_exp_f32 v59, v59
    v_mfma_f32_16x16x32_bf16 v[212:215], a[216:219], v[28:31], v[212:215]
    v_fma_f32 v73, v73, s28, v11
    v_fma_f32 v85, v85, s28, v13
    v_mfma_f32_16x16x32_bf16 a[4:7], a[216:219], v[34:37], a[4:7]
    v_fma_f32 v57, v57, s28, v9
    v_fma_f32 v68, v68, s28, v11
    v_mfma_f32_16x16x32_bf16 a[0:3], a[212:215], v[34:37], a[0:3]
    v_exp_f32 v85, v85
    v_mfma_f32_16x16x32_bf16 a[48:51], a[212:215], v[40:43], a[48:51]
    v_fma_f32 v66, v66, s28, v10
    v_fma_f32 v65, v65, s28, v10
    v_mfma_f32_16x16x32_bf16 a[52:55], a[216:219], v[40:43], a[52:55]
    s_waitcnt lgkmcnt(3)
    ds_read_b64_tr_b16 a[212:213], v4 offset:19456
    v_fma_f32 v87, v87, s28, v13
    v_mfma_f32_16x16x32_bf16 a[56:59], a[220:223], v[40:43], a[56:59]
    ds_read_b64_tr_b16 a[234:235], v3 offset:13312
    v_mfma_f32_16x16x32_bf16 a[60:63], a[224:227], v[40:43], a[60:63]
    ds_read_b64_tr_b16 a[218:219], v5 offset:13312
    v_mfma_f32_16x16x32_bf16 a[12:15], a[224:227], v[34:37], a[12:15]
    v_exp_f32 v77, v77
    v_mfma_f32_16x16x32_bf16 a[8:11], a[220:223], v[34:37], a[8:11]
    ds_read_b64_tr_b16 a[216:217], v5 offset:19456
    v_fma_f32 v88, v88, s28, v13
    v_mfma_f32_16x16x32_bf16 v[216:219], a[220:223], v[28:31], v[216:219]
    v_exp_f32 v56, v56
    v_mfma_f32_16x16x32_bf16 v[220:223], a[224:227], v[28:31], v[220:223]
    ds_read_b64_tr_b16 a[214:215], v4 offset:13312
    v_fma_f32 v72, v72, s28, v11
    v_mfma_f32_16x16x32_bf16 v[172:175], a[224:227], v[22:25], v[172:175]
    v_exp_f32 v75, v75
    v_mfma_f32_16x16x32_bf16 v[168:171], a[220:223], v[22:25], v[168:171]
    v_exp_f32 v87, v87
    v_mfma_f32_16x16x32_bf16 v[120:123], a[220:223], v[16:19], v[120:123]
    v_exp_f32 v88, v88
    v_mfma_f32_16x16x32_bf16 v[124:127], a[224:227], v[16:19], v[124:127]
    s_waitcnt lgkmcnt(4)
    v_fma_f32 v86, v86, s28, v13
    v_fma_f32 v58, v58, s28, v9
    v_mfma_f32_16x16x32_bf16 v[128:131], a[228:231], v[16:19], v[128:131]
    s_waitcnt lgkmcnt(3)
    v_fma_f32 v74, v74, s28, v11
    v_mfma_f32_16x16x32_bf16 v[132:135], a[232:235], v[16:19], v[132:135]
    v_fma_f32 v91, v91, s28, v13
    v_fma_f32 v69, v69, s28, v11
    v_mfma_f32_16x16x32_bf16 v[180:183], a[232:235], v[22:25], v[180:183]
    ds_read_b64_tr_b16 a[226:227], v3 offset:14336
    v_fma_f32 v64, v64, s28, v10
    v_mfma_f32_16x16x32_bf16 v[176:179], a[228:231], v[22:25], v[176:179]
    v_exp_f32 v86, v86
    v_mfma_f32_16x16x32_bf16 v[224:227], a[228:231], v[28:31], v[224:227]
    v_fma_f32 v78, v78, s28, v12
    v_fma_f32 v84, v84, s28, v13
    v_mfma_f32_16x16x32_bf16 v[228:231], a[232:235], v[28:31], v[228:231]
    v_mfma_f32_16x16x32_bf16 a[20:23], a[232:235], v[34:37], a[20:23]
    ds_read_b64_tr_b16 a[220:221], v2 offset:20480
    v_fma_f32 v79, v79, s28, v12
    v_mfma_f32_16x16x32_bf16 a[16:19], a[228:231], v[34:37], a[16:19]
    ds_read_b64_tr_b16 a[222:223], v2 offset:14336
    v_fma_f32 v82, v82, s28, v12
    v_mfma_f32_16x16x32_bf16 a[64:67], a[228:231], v[40:43], a[64:67]
    ds_read_b64_tr_b16 a[224:225], v3 offset:20480
    v_mfma_f32_16x16x32_bf16 a[68:71], a[232:235], v[40:43], a[68:71]
    s_waitcnt lgkmcnt(4)
    ds_read_b64_tr_b16 a[234:235], v5 offset:14336
    v_fma_f32 v89, v89, s28, v13
    v_mfma_f32_16x16x32_bf16 a[72:75], a[212:215], v[40:43], a[72:75]
    ds_read_b64_tr_b16 a[228:229], v4 offset:20480
    v_mfma_f32_16x16x32_bf16 a[76:79], a[216:219], v[40:43], a[76:79]
    v_exp_f32 v68, v68
    v_mfma_f32_16x16x32_bf16 a[28:31], a[216:219], v[34:37], a[28:31]
    v_exp_f32 v89, v89
    v_mfma_f32_16x16x32_bf16 a[24:27], a[212:215], v[34:37], a[24:27]
    v_fma_f32 v67, v67, s28, v10
    v_fma_f32 v83, v83, s28, v12
    v_mfma_f32_16x16x32_bf16 v[232:235], a[212:215], v[28:31], v[232:235]
    ds_read_b64_tr_b16 a[232:233], v5 offset:20480
    v_fma_f32 v76, v76, s28, v12
    v_mfma_f32_16x16x32_bf16 v[236:239], a[216:219], v[28:31], v[236:239]
    ds_read_b64_tr_b16 a[230:231], v4 offset:14336
    v_mfma_f32_16x16x32_bf16 v[188:191], a[216:219], v[22:25], v[188:191]
    v_exp_f32 v66, v66
    v_mfma_f32_16x16x32_bf16 v[184:187], a[212:215], v[22:25], v[184:187]
    s_add_u32 s39, s39, 12288
    v_exp_f32 v78, v78
    v_mfma_f32_16x16x32_bf16 v[136:139], a[212:215], v[16:19], v[136:139]
    v_exp_f32 v58, v58
    v_mfma_f32_16x16x32_bf16 v[140:143], a[216:219], v[16:19], v[140:143]
    s_waitcnt lgkmcnt(3)
    v_exp_f32 v64, v64
    v_mfma_f32_16x16x32_bf16 v[144:147], a[220:223], v[16:19], v[144:147]
    v_exp_f32 v76, v76
    v_mfma_f32_16x16x32_bf16 v[148:151], a[224:227], v[16:19], v[148:151]
    v_exp_f32 v73, v73
    v_mfma_f32_16x16x32_bf16 v[196:199], a[224:227], v[22:25], v[196:199]
    v_fma_f32 v70, v70, s28, v11
    v_fma_f32 v80, v80, s28, v12
    v_mfma_f32_16x16x32_bf16 v[192:195], a[220:223], v[22:25], v[192:195]
    v_fma_f32 v71, v71, s28, v11
    v_mfma_f32_16x16x32_bf16 v[240:243], a[220:223], v[28:31], v[240:243]
    v_cvt_pk_bf16_f32 v39, v86, v87
    v_mfma_f32_16x16x32_bf16 v[244:247], a[224:227], v[28:31], v[244:247]
    s_waitcnt vmcnt(10) lgkmcnt(0)
    v_exp_f32 v70, v70
    v_mfma_f32_16x16x32_bf16 a[36:39], a[224:227], v[34:37], a[36:39]
    s_add_u32 m0, s22, 36864
    v_exp_f32 v79, v79
    v_mfma_f32_16x16x32_bf16 a[32:35], a[220:223], v[34:37], a[32:35]
    s_barrier
    v_mfma_f32_16x16x32_bf16 a[80:83], a[220:223], v[40:43], a[80:83]
    ds_read_b128 a[212:215], v0 offset:12288
    v_fma_f32 v81, v81, s28, v12
    v_mfma_f32_16x16x32_bf16 a[84:87], a[224:227], v[40:43], a[84:87]
    v_exp_f32 v71, v71
    v_mfma_f32_16x16x32_bf16 a[88:91], a[228:231], v[40:43], a[88:91]
    ds_read_b128 a[216:219], v1 offset:12288
    v_cvt_pk_bf16_f32 v33, v78, v79
    v_mfma_f32_16x16x32_bf16 a[92:95], a[232:235], v[40:43], a[92:95]
    ds_read_b128 a[220:223], v0 offset:13312
    v_mfma_f32_16x16x32_bf16 a[44:47], a[232:235], v[34:37], a[44:47]
    buffer_load_dwordx4 v6, s[8:11], s21 offen lds
    v_mfma_f32_16x16x32_bf16 a[40:43], a[228:231], v[34:37], a[40:43]
    s_add_u32 s21, s21, 128
    v_cvt_pk_bf16_f32 v27, v70, v71
    s_add_u32 m0, s22, 37888
    v_mfma_f32_16x16x32_bf16 v[248:251], a[228:231], v[28:31], v[248:251]
    buffer_load_dwordx4 v6, s[8:11], s21 offen lds
    v_mfma_f32_16x16x32_bf16 v[252:255], a[232:235], v[28:31], v[252:255]
    v_exp_f32 v82, v82
    v_mfma_f32_16x16x32_bf16 v[204:207], a[232:235], v[22:25], v[204:207]
    s_add_u32 s21, s21, 128
    v_fma_f32 v90, v90, s28, v13
    s_add_u32 m0, s22, 38912
    v_mfma_f32_16x16x32_bf16 v[200:203], a[228:231], v[22:25], v[200:203]
    ds_read_b128 a[224:227], v1 offset:13312
    v_mfma_f32_16x16x32_bf16 v[152:155], a[228:231], v[16:19], v[152:155]
    buffer_load_dwordx4 v6, s[8:11], s21 offen lds
    v_mfma_f32_16x16x32_bf16 v[156:159], a[232:235], v[16:19], v[156:159]
    s_waitcnt lgkmcnt(3)
    ds_read_b128 a[228:231], v0 offset:14336
    v_cvt_pk_bf16_f32 v17, v58, v59
    v_mfma_f32_16x16x32_bf16 v[52:55], a[212:215], a[96:99], 0
    s_waitcnt lgkmcnt(3)
    v_exp_f32 v84, v84
    v_mfma_f32_16x16x32_bf16 v[52:55], a[216:219], a[100:103], v[52:55]
    s_waitcnt lgkmcnt(2)
    v_exp_f32 v74, v74
    v_mfma_f32_16x16x32_bf16 v[52:55], a[220:223], a[104:107], v[52:55]
    v_exp_f32 v83, v83
    v_mfma_f32_16x16x32_bf16 v[60:63], a[220:223], a[128:131], 0
    v_exp_f32 v69, v69
    v_mfma_f32_16x16x32_bf16 v[60:63], a[216:219], a[124:127], v[60:63]
    ds_read_b128 a[232:235], v1 offset:14336
    v_mfma_f32_16x16x32_bf16 v[60:63], a[212:215], a[120:123], v[60:63]
    v_cvt_pk_bf16_f32 v38, v84, v85
    v_cvt_pk_bf16_f32 v26, v68, v69
    v_mfma_f32_16x16x32_bf16 v[68:71], a[212:215], a[144:147], 0
    v_cvt_pk_bf16_f32 v32, v76, v77
    v_mfma_f32_16x16x32_bf16 v[68:71], a[216:219], a[148:151], v[68:71]
    v_mfma_f32_16x16x32_bf16 v[68:71], a[220:223], a[152:155], v[68:71]
    v_mfma_f32_16x16x32_bf16 v[76:79], a[220:223], a[176:179], 0
    v_exp_f32 v57, v57
    v_mfma_f32_16x16x32_bf16 v[76:79], a[216:219], a[172:175], v[76:79]
    v_exp_f32 v81, v81
    v_mfma_f32_16x16x32_bf16 v[76:79], a[212:215], a[168:171], v[76:79]
    v_mfma_f32_16x16x32_bf16 v[84:87], a[212:215], a[192:195], 0
    v_exp_f32 v65, v65
    v_mfma_f32_16x16x32_bf16 v[84:87], a[216:219], a[196:199], v[84:87]
    v_exp_f32 v80, v80
    v_mfma_f32_16x16x32_bf16 v[84:87], a[220:223], a[200:203], v[84:87]
    s_waitcnt lgkmcnt(0)
    v_mfma_f32_16x16x32_bf16 v[84:87], a[224:227], a[204:207], v[84:87]
    v_cvt_pk_bf16_f32 v35, v82, v83
    v_mfma_f32_16x16x32_bf16 v[84:87], a[228:231], a[208:211], v[84:87]
    v_exp_f32 v90, v90
    v_mfma_f32_16x16x32_bf16 v[84:87], a[232:235], v[92:95], v[84:87]
    v_exp_f32 v72, v72
    v_mfma_f32_16x16x32_bf16 v[76:79], a[232:235], a[188:191], v[76:79]
    ds_read_b128 a[220:223], v0 offset:19456
    v_cvt_pk_bf16_f32 v40, v88, v89
    v_mfma_f32_16x16x32_bf16 v[76:79], a[228:231], a[184:187], v[76:79]
    v_exp_f32 v91, v91
    v_mfma_f32_16x16x32_bf16 v[76:79], a[224:227], a[180:183], v[76:79]
    ds_read_b128 a[212:215], v0 offset:18432
    v_cvt_pk_bf16_f32 v34, v80, v81
    v_mfma_f32_16x16x32_bf16 v[68:71], a[224:227], a[156:159], v[68:71]
    v_cvt_pk_bf16_f32 v22, v64, v65
    v_cvt_pk_bf16_f32 v16, v56, v57
    v_mfma_f32_16x16x32_bf16 v[68:71], a[228:231], a[160:163], v[68:71]
    v_mfma_f32_16x16x32_bf16 v[68:71], a[232:235], a[164:167], v[68:71]
    v_exp_f32 v67, v67
    v_mfma_f32_16x16x32_bf16 v[60:63], a[232:235], a[140:143], v[60:63]
    ds_read_b128 a[216:219], v1 offset:18432
    v_mfma_f32_16x16x32_bf16 v[60:63], a[228:231], a[136:139], v[60:63]
    v_mfma_f32_16x16x32_bf16 v[60:63], a[224:227], a[132:135], v[60:63]
    v_cvt_pk_bf16_f32 v23, v66, v67
    v_mfma_f32_16x16x32_bf16 v[52:55], a[224:227], a[108:111], v[52:55]
    v_mfma_f32_16x16x32_bf16 v[52:55], a[228:231], a[112:115], v[52:55]
    ds_read_b128 a[228:231], v0 offset:20480
    v_cvt_pk_bf16_f32 v28, v72, v73
    v_mfma_f32_16x16x32_bf16 v[44:47], a[236:239], v[14:17], v[48:51]
    ds_read_b128 a[224:227], v1 offset:19456
    v_mfma_f32_16x16x32_bf16 v[52:55], a[232:235], a[116:119], v[52:55]
    s_waitcnt lgkmcnt(3)
    ds_read_b128 a[232:235], v1 offset:20480
    v_cvt_pk_bf16_f32 v29, v74, v75
    v_mfma_f32_16x16x32_bf16 v[56:59], a[212:215], a[96:99], 0
    v_mfma_f32_16x16x32_bf16 v[44:47], a[240:243], v[20:23], v[44:47]
    v_cvt_pk_bf16_f32 v41, v90, v91
    v_mfma_f32_16x16x32_bf16 v[44:47], a[244:247], v[26:29], v[44:47]
    v_mfma_f32_16x16x32_bf16 v[44:47], a[248:251], v[32:35], v[44:47]
    v_mfma_f32_16x16x32_bf16 v[44:47], a[252:255], v[38:41], v[44:47]
    s_add_u32 s21, s21, 12032
    s_waitcnt lgkmcnt(3)
    v_mfma_f32_16x16x32_bf16 v[56:59], a[216:219], a[100:103], v[56:59]
    v_mfma_f32_16x16x32_bf16 v[56:59], a[220:223], a[104:107], v[56:59]
    v_mfma_f32_16x16x32_bf16 v[64:67], a[220:223], a[128:131], 0
    v_mfma_f32_16x16x32_bf16 v[64:67], a[216:219], a[124:127], v[64:67]
    s_nop 1
    v_cmp_lt_f32 vcc, s29, v44
    v_mfma_f32_16x16x32_bf16 v[64:67], a[212:215], a[120:123], v[64:67]
    s_waitcnt vmcnt(7) lgkmcnt(0)
    v_mfma_f32_16x16x32_bf16 v[72:75], a[212:215], a[144:147], 0
    s_barrier
    v_mfma_f32_16x16x32_bf16 v[72:75], a[216:219], a[148:151], v[72:75]
    s_cbranch_vccnz L_rs_tr54a
L_ret_tr54a:
    v_fma_f32 v55, v55, s28, v9
    v_mfma_f32_16x16x32_bf16 v[72:75], a[220:223], a[152:155], v[72:75]
    v_fma_f32 v54, v54, s28, v9
    v_fma_f32 v63, v63, s28, v10
    v_mfma_f32_16x16x32_bf16 v[80:83], a[220:223], a[176:179], 0
    s_add_u32 m0, s22, 12288
    v_exp_f32 v55, v55
    v_mfma_f32_16x16x32_bf16 v[80:83], a[216:219], a[172:175], v[80:83]
    v_exp_f32 v54, v54
    v_mfma_f32_16x16x32_bf16 v[80:83], a[212:215], a[168:171], v[80:83]
    buffer_load_dwordx4 v6, s[4:7], s20 offen lds
    v_mfma_f32_16x16x32_bf16 v[88:91], a[212:215], a[192:195], 0
    s_add_u32 s20, s20, 128
    v_fma_f32 v53, v53, s28, v9
    s_add_u32 m0, s22, 13312
    v_mfma_f32_16x16x32_bf16 v[88:91], a[216:219], a[196:199], v[88:91]
    buffer_load_dwordx4 v6, s[4:7], s20 offen lds
    v_mfma_f32_16x16x32_bf16 v[88:91], a[220:223], a[200:203], v[88:91]
    s_add_u32 s20, s20, 128
    ds_read_b64_tr_b16 a[212:213], v2 offset:0
    v_mfma_f32_16x16x32_bf16 v[88:91], a[224:227], a[204:207], v[88:91]
    s_add_u32 m0, s22, 14336
    ds_read_b64_tr_b16 a[214:215], v2 offset:6144
    v_fma_f32 v61, v61, s28, v10
    v_mfma_f32_16x16x32_bf16 v[88:91], a[228:231], a[208:211], v[88:91]
    buffer_load_dwordx4 v6, s[4:7], s20 offen lds
    v_mfma_f32_16x16x32_bf16 v[88:91], a[232:235], v[92:95], v[88:91]
    ds_read_b64_tr_b16 a[216:217], v3 offset:0
    v_fma_f32 v60, v60, s28, v10
    v_mfma_f32_16x16x32_bf16 v[80:83], a[232:235], a[188:191], v[80:83]
    v_exp_f32 v63, v63
    v_mfma_f32_16x16x32_bf16 v[80:83], a[228:231], a[184:187], v[80:83]
    ds_read_b64_tr_b16 a[218:219], v3 offset:6144
    v_fma_f32 v52, v52, s28, v9
    v_mfma_f32_16x16x32_bf16 v[80:83], a[224:227], a[180:183], v[80:83]
    v_exp_f32 v52, v52
    v_mfma_f32_16x16x32_bf16 v[72:75], a[224:227], a[156:159], v[72:75]
    v_exp_f32 v60, v60
    v_mfma_f32_16x16x32_bf16 v[72:75], a[228:231], a[160:163], v[72:75]
    v_exp_f32 v53, v53
    v_mfma_f32_16x16x32_bf16 v[72:75], a[232:235], a[164:167], v[72:75]
    v_cvt_pk_bf16_f32 v19, v54, v55
    v_fma_f32 v62, v62, s28, v10
    v_mfma_f32_16x16x32_bf16 v[64:67], a[232:235], a[140:143], v[64:67]
    s_add_u32 s20, s20, 12032
    v_exp_f32 v62, v62
    v_mfma_f32_16x16x32_bf16 v[64:67], a[228:231], a[136:139], v[64:67]
    v_exp_f32 v61, v61
    v_mfma_f32_16x16x32_bf16 v[64:67], a[224:227], a[132:135], v[64:67]
    ds_read_b64_tr_b16 a[220:221], v4 offset:0
    v_cvt_pk_bf16_f32 v25, v62, v63
    v_mfma_f32_16x16x32_bf16 v[56:59], a[224:227], a[108:111], v[56:59]
    ds_read_b64_tr_b16 a[222:223], v4 offset:6144
    v_cvt_pk_bf16_f32 v24, v60, v61
    v_mfma_f32_16x16x32_bf16 v[56:59], a[228:231], a[112:115], v[56:59]
    ds_read_b64_tr_b16 a[224:225], v5 offset:0
    v_cvt_pk_bf16_f32 v18, v52, v53
    v_mfma_f32_16x16x32_bf16 v[56:59], a[232:235], a[116:119], v[56:59]
    ds_read_b64_tr_b16 a[226:227], v5 offset:6144
    s_waitcnt lgkmcnt(4)
    v_mfma_f32_16x16x32_bf16 v[112:115], a[212:215], v[14:17], v[112:115]
    v_lshrrev_b32 v105, 11, v0
    v_and_b32 v104, 0x3ff, v0
    v_mfma_f32_16x16x32_bf16 v[116:119], a[216:219], v[14:17], v[116:119]
    v_fma_f32 v67, v67, s28, v10
    v_xor_b32 v105, s65, v105
    v_mfma_f32_16x16x32_bf16 v[164:167], a[216:219], v[20:23], v[164:167]
    ds_read_b64_tr_b16 a[234:235], v3 offset:7168
    v_fma_f32 v86, v86, s28, v13
    v_mfma_f32_16x16x32_bf16 v[160:163], a[212:215], v[20:23], v[160:163]
    ds_read_b64_tr_b16 a[230:231], v2 offset:7168
    v_fma_f32 v79, v79, s28, v12
    v_mfma_f32_16x16x32_bf16 v[208:211], a[212:215], v[26:29], v[208:211]
    v_fma_f32 v88, v88, s28, v13
    v_fma_f32 v76, v76, s28, v12
    v_mfma_f32_16x16x32_bf16 v[212:215], a[216:219], v[26:29], v[212:215]
    ds_read_b64_tr_b16 a[232:233], v3 offset:1024
    v_fma_f32 v69, v69, s28, v11
    v_mfma_f32_16x16x32_bf16 a[4:7], a[216:219], v[32:35], a[4:7]
    v_exp_f32 v79, v79
    v_mfma_f32_16x16x32_bf16 a[0:3], a[212:215], v[32:35], a[0:3]
    v_exp_f32 v76, v76
    v_mfma_f32_16x16x32_bf16 a[48:51], a[212:215], v[38:41], a[48:51]
    ds_read_b64_tr_b16 a[228:229], v2 offset:1024
    v_fma_f32 v78, v78, s28, v12
    v_mfma_f32_16x16x32_bf16 a[52:55], a[216:219], v[38:41], a[52:55]
    s_waitcnt lgkmcnt(4)
    v_fma_f32 v74, v74, s28, v11
    v_lshl_add_u32 v104, v105, 10, v104
    v_mfma_f32_16x16x32_bf16 a[56:59], a[220:223], v[38:41], a[56:59]
    ds_read_b64_tr_b16 a[216:217], v5 offset:1024
    v_fma_f32 v90, v90, s28, v13
    v_mfma_f32_16x16x32_bf16 a[60:63], a[224:227], v[38:41], a[60:63]
    v_exp_f32 v78, v78
    v_mfma_f32_16x16x32_bf16 a[12:15], a[224:227], v[32:35], a[12:15]
    ds_read_b64_tr_b16 a[214:215], v4 offset:7168
    v_add_u32 v104, s38, v104
    v_mfma_f32_16x16x32_bf16 a[8:11], a[220:223], v[32:35], a[8:11]
    ds_read_b128 a[168:171], v104 offset:18432
    v_fma_f32 v81, v81, s28, v12
    v_mfma_f32_16x16x32_bf16 v[216:219], a[220:223], v[26:29], v[216:219]
    ds_read_b64_tr_b16 a[212:213], v4 offset:1024
    v_fma_f32 v59, v59, s28, v9
    v_mfma_f32_16x16x32_bf16 v[220:223], a[224:227], v[26:29], v[220:223]
    ds_read_b128 a[160:163], v104 offset:16384
    v_exp_f32 v69, v69
    v_mfma_f32_16x16x32_bf16 v[172:175], a[224:227], v[20:23], v[172:175]
    ds_read_b64_tr_b16 a[218:219], v5 offset:7168
    v_xor_b32 v105, 64, v104
    v_mfma_f32_16x16x32_bf16 v[168:171], a[220:223], v[20:23], v[168:171]
    v_exp_f32 v86, v86
    v_mfma_f32_16x16x32_bf16 v[120:123], a[220:223], v[14:17], v[120:123]
    ds_read_b128 a[156:159], v105 offset:14336
    v_fma_f32 v68, v68, s28, v11
    v_mfma_f32_16x16x32_bf16 v[124:127], a[224:227], v[14:17], v[124:127]
    s_waitcnt lgkmcnt(7)
    ds_read_b128 a[184:187], v104 offset:22528
    v_fma_f32 v89, v89, s28, v13
    v_mfma_f32_16x16x32_bf16 v[128:131], a[228:231], v[14:17], v[128:131]
    s_add_u32 s39, s39, 12288
    v_exp_f32 v90, v90
    v_mfma_f32_16x16x32_bf16 v[132:135], a[232:235], v[14:17], v[132:135]
    ds_read_b64_tr_b16 a[226:227], v3 offset:8192
    v_fma_f32 v82, v82, s28, v12
    v_mfma_f32_16x16x32_bf16 v[180:183], a[232:235], v[20:23], v[180:183]
    v_exp_f32 v81, v81
    v_mfma_f32_16x16x32_bf16 v[176:179], a[228:231], v[20:23], v[176:179]
    v_exp_f32 v68, v68
    v_mfma_f32_16x16x32_bf16 v[224:227], a[228:231], v[26:29], v[224:227]
    ds_read_b128 a[144:147], v104 offset:12288
    v_cvt_pk_bf16_f32 v37, v78, v79
    v_mfma_f32_16x16x32_bf16 v[228:231], a[232:235], v[26:29], v[228:231]
    ds_read_b64_tr_b16 a[224:225], v3 offset:2048
    v_fma_f32 v72, v72, s28, v11
    v_mfma_f32_16x16x32_bf16 a[20:23], a[232:235], v[32:35], a[20:23]
    v_exp_f32 v88, v88
    v_mfma_f32_16x16x32_bf16 a[16:19], a[228:231], v[32:35], a[16:19]
    ds_read_b64_tr_b16 a[222:223], v2 offset:8192
    v_fma_f32 v57, v57, s28, v9
    v_mfma_f32_16x16x32_bf16 a[64:67], a[228:231], v[38:41], a[64:67]
    v_exp_f32 v89, v89
    v_mfma_f32_16x16x32_bf16 a[68:71], a[232:235], v[38:41], a[68:71]
    s_waitcnt lgkmcnt(4)
    ds_read_b64_tr_b16 a[220:221], v2 offset:2048
    v_fma_f32 v66, v66, s28, v10
    v_mfma_f32_16x16x32_bf16 a[72:75], a[212:215], v[38:41], a[72:75]
    ds_read_b64_tr_b16 a[234:235], v5 offset:8192
    v_fma_f32 v71, v71, s28, v11
    v_mfma_f32_16x16x32_bf16 a[76:79], a[216:219], v[38:41], a[76:79]
    ds_read_b64_tr_b16 a[230:231], v4 offset:8192
    ds_read_b64_tr_b16 a[228:229], v4 offset:2048
    v_mfma_f32_16x16x32_bf16 a[28:31], a[216:219], v[32:35], a[28:31]
    ds_read_b64_tr_b16 a[232:233], v5 offset:2048
    v_fma_f32 v56, v56, s28, v9
    v_mfma_f32_16x16x32_bf16 a[24:27], a[212:215], v[32:35], a[24:27]
    ds_read_b128 a[132:135], v105 offset:8192
    v_fma_f32 v70, v70, s28, v11
    v_mfma_f32_16x16x32_bf16 v[232:235], a[212:215], v[26:29], v[232:235]
    v_exp_f32 v67, v67
    v_mfma_f32_16x16x32_bf16 v[236:239], a[216:219], v[26:29], v[236:239]
    ds_read_b128 a[104:107], v104 offset:2048
    v_cvt_pk_bf16_f32 v30, v68, v69
    v_mfma_f32_16x16x32_bf16 v[188:191], a[216:219], v[20:23], v[188:191]
    ds_read_b128 a[96:99], v104 offset:0
    v_fma_f32 v80, v80, s28, v12
    v_mfma_f32_16x16x32_bf16 v[184:187], a[212:215], v[20:23], v[184:187]
    ds_read_b128 a[148:151], v105 offset:12288
    v_fma_f32 v75, v75, s28, v11
    v_mfma_f32_16x16x32_bf16 v[136:139], a[212:215], v[14:17], v[136:139]
    ds_read_b128 a[124:127], v105 offset:6144
    v_fma_f32 v83, v83, s28, v12
    v_mfma_f32_16x16x32_bf16 v[140:143], a[216:219], v[14:17], v[140:143]
    s_waitcnt lgkmcnt(9)
    ds_read_b128 a[188:191], v105 offset:22528
    v_fma_f32 v64, v64, s28, v10
    v_mfma_f32_16x16x32_bf16 v[144:147], a[220:223], v[14:17], v[144:147]
    ds_read_b128 a[120:123], v104 offset:6144
    v_exp_f32 v70, v70
    v_mfma_f32_16x16x32_bf16 v[148:151], a[224:227], v[14:17], v[148:151]
    ds_read_b128 a[112:115], v104 offset:4096
    v_fma_f32 v91, v91, s28, v13
    v_mfma_f32_16x16x32_bf16 v[196:199], a[224:227], v[20:23], v[196:199]
    v_exp_f32 v82, v82
    v_mfma_f32_16x16x32_bf16 v[192:195], a[220:223], v[20:23], v[192:195]
    s_waitcnt vmcnt(6) lgkmcnt(7)
    ds_read_b128 a[100:103], v105 offset:0
    v_mfma_f32_16x16x32_bf16 v[240:243], a[220:223], v[26:29], v[240:243]
    s_add_u32 s21, s21, s62
    ds_read_b128 a[176:179], v104 offset:20480
    v_fma_f32 v85, v85, s28, v13
    v_mfma_f32_16x16x32_bf16 v[244:247], a[224:227], v[26:29], v[244:247]
    ds_read_b128 a[128:131], v104 offset:8192
    v_fma_f32 v58, v58, s28, v9
    v_mfma_f32_16x16x32_bf16 a[36:39], a[224:227], v[32:35], a[36:39]
    v_exp_f32 v71, v71
    v_mfma_f32_16x16x32_bf16 a[32:35], a[220:223], v[32:35], a[32:35]
    s_barrier
    v_mfma_f32_16x16x32_bf16 a[80:83], a[220:223], v[38:41], a[80:83]
    s_add_u32 m0, s22, 24576
    ds_read_b128 a[152:155], v104 offset:14336
    v_mfma_f32_16x16x32_bf16 a[84:87], a[224:227], v[38:41], a[84:87]
    ds_read_b128 a[212:215], v0 offset:0
    v_fma_f32 v65, v65, s28, v10
    v_mfma_f32_16x16x32_bf16 a[88:91], a[228:231], v[38:41], a[88:91]
    buffer_load_dwordx4 v6, s[8:11], s21 offen lds
    ds_read_b128 a[216:219], v1 offset:0
    v_mfma_f32_16x16x32_bf16 a[92:95], a[232:235], v[38:41], a[92:95]
    s_add_u32 s21, s21, 128
    s_add_u32 m0, s22, 25600
    ds_read_b128 a[220:223], v0 offset:1024
    v_mfma_f32_16x16x32_bf16 a[44:47], a[232:235], v[32:35], a[44:47]
    buffer_load_dwordx4 v6, s[8:11], s21 offen lds
    v_mfma_f32_16x16x32_bf16 a[40:43], a[228:231], v[32:35], a[40:43]
    v_exp_f32 v83, v83
    v_mfma_f32_16x16x32_bf16 v[248:251], a[228:231], v[26:29], v[248:251]
    s_add_u32 s21, s21, 128
    v_exp_f32 v80, v80
    v_mfma_f32_16x16x32_bf16 v[252:255], a[232:235], v[26:29], v[252:255]
    s_add_u32 m0, s22, 26624
    ds_read_b128 a[180:183], v105 offset:20480
    v_fma_f32 v84, v84, s28, v13
    v_mfma_f32_16x16x32_bf16 v[204:207], a[232:235], v[20:23], v[204:207]
    buffer_load_dwordx4 v6, s[8:11], s21 offen lds
    v_mfma_f32_16x16x32_bf16 v[200:203], a[228:231], v[20:23], v[200:203]
    ds_read_b128 a[172:175], v105 offset:18432
    v_fma_f32 v87, v87, s28, v13
    v_mfma_f32_16x16x32_bf16 v[152:155], a[228:231], v[14:17], v[152:155]
    ds_read_b128 a[224:227], v1 offset:1024
    v_fma_f32 v77, v77, s28, v12
    v_mfma_f32_16x16x32_bf16 v[156:159], a[232:235], v[14:17], v[156:159]
    s_waitcnt lgkmcnt(5)
    v_exp_f32 v77, v77
    v_mfma_f32_16x16x32_bf16 v[52:55], a[212:215], a[96:99], 0
    s_waitcnt lgkmcnt(4)
    ds_read_b128 a[116:119], v105 offset:4096
    v_cvt_pk_bf16_f32 v40, v88, v89
    v_mfma_f32_16x16x32_bf16 v[52:55], a[216:219], a[100:103], v[52:55]
    s_waitcnt lgkmcnt(4)
    ds_read_b128 a[228:231], v0 offset:2048
    v_cvt_pk_bf16_f32 v31, v70, v71
    v_mfma_f32_16x16x32_bf16 v[52:55], a[220:223], a[104:107], v[52:55]
    ds_read_b128 a[232:235], v1 offset:2048
    v_exp_f32 v85, v85
    v_mfma_f32_16x16x32_bf16 v[60:63], a[220:223], a[128:131], 0
    ds_read_b128 a[136:139], v104 offset:10240
    v_cvt_pk_bf16_f32 v36, v76, v77
    v_mfma_f32_16x16x32_bf16 v[60:63], a[216:219], a[124:127], v[60:63]
    ds_read_b128 a[164:167], v105 offset:16384
    v_fma_f32 v73, v73, s28, v11
    v_mfma_f32_16x16x32_bf16 v[60:63], a[212:215], a[120:123], v[60:63]
    v_exp_f32 v75, v75
    v_mfma_f32_16x16x32_bf16 v[68:71], a[212:215], a[144:147], 0
    v_exp_f32 v58, v58
    v_mfma_f32_16x16x32_bf16 v[68:71], a[216:219], a[148:151], v[68:71]
    ds_read_b128 a[140:143], v105 offset:10240
    v_cvt_pk_bf16_f32 v35, v82, v83
    v_mfma_f32_16x16x32_bf16 v[68:71], a[220:223], a[152:155], v[68:71]
    v_exp_f32 v65, v65
    v_mfma_f32_16x16x32_bf16 v[76:79], a[220:223], a[176:179], 0
    s_waitcnt lgkmcnt(6)
    v_exp_f32 v57, v57
    v_mfma_f32_16x16x32_bf16 v[76:79], a[216:219], a[172:175], v[76:79]
    v_exp_f32 v72, v72
    v_mfma_f32_16x16x32_bf16 v[76:79], a[212:215], a[168:171], v[76:79]
    v_exp_f32 v59, v59
    v_mfma_f32_16x16x32_bf16 v[76:79], a[224:227], a[180:183], v[76:79]
    s_waitcnt lgkmcnt(3)
    ds_read_b128 a[108:111], v105 offset:2048
    v_exp_f32 v87, v87
    v_mfma_f32_16x16x32_bf16 v[76:79], a[228:231], a[184:187], v[76:79]
    ds_read_b128 a[212:215], v0 offset:6144
    v_cvt_pk_bf16_f32 v34, v80, v81
    v_mfma_f32_16x16x32_bf16 v[76:79], a[232:235], a[188:191], v[76:79]
    s_waitcnt lgkmcnt(3)
    v_exp_f32 v66, v66
    v_mfma_f32_16x16x32_bf16 v[68:71], a[232:235], a[164:167], v[68:71]
    v_exp_f32 v73, v73
    v_mfma_f32_16x16x32_bf16 v[68:71], a[228:231], a[160:163], v[68:71]
    v_exp_f32 v84, v84
    v_mfma_f32_16x16x32_bf16 v[68:71], a[224:227], a[156:159], v[68:71]
    ds_read_b128 a[220:223], v0 offset:7168
    v_cvt_pk_bf16_f32 v17, v58, v59
    v_mfma_f32_16x16x32_bf16 v[60:63], a[224:227], a[132:135], v[60:63]
    ds_read_b128 a[216:219], v1 offset:6144
    v_cvt_pk_bf16_f32 v28, v72, v73
    v_mfma_f32_16x16x32_bf16 v[60:63], a[228:231], a[136:139], v[60:63]
    s_waitcnt lgkmcnt(4)
    v_exp_f32 v74, v74
    v_mfma_f32_16x16x32_bf16 v[60:63], a[232:235], a[140:143], v[60:63]
    v_exp_f32 v64, v64
    v_mfma_f32_16x16x32_bf16 v[52:55], a[232:235], a[116:119], v[52:55]
    v_exp_f32 v56, v56
    v_mfma_f32_16x16x32_bf16 v[52:55], a[228:231], a[112:115], v[52:55]
    s_waitcnt lgkmcnt(3)
    ds_read_b128 a[228:231], v0 offset:8192
    v_cvt_pk_bf16_f32 v16, v56, v57
    v_mfma_f32_16x16x32_bf16 v[52:55], a[224:227], a[108:111], v[52:55]
    s_waitcnt lgkmcnt(3)
    ds_read_b128 a[232:235], v1 offset:8192
    v_cvt_pk_bf16_f32 v22, v64, v65
    v_mfma_f32_16x16x32_bf16 v[56:59], a[212:215], a[96:99], 0
    ds_read_b128 a[224:227], v1 offset:7168
    v_cvt_pk_bf16_f32 v23, v66, v67
    v_mfma_f32_16x16x32_bf16 v[48:51], a[236:239], v[16:19], v[44:47]
    v_cvt_pk_bf16_f32 v29, v74, v75
    v_cvt_pk_bf16_f32 v43, v86, v87
    v_mfma_f32_16x16x32_bf16 v[48:51], a[240:243], v[22:25], v[48:51]
    v_exp_f32 v91, v91
    v_mfma_f32_16x16x32_bf16 v[48:51], a[244:247], v[28:31], v[48:51]
    v_cvt_pk_bf16_f32 v41, v90, v91
    v_cvt_pk_bf16_f32 v42, v84, v85
    v_mfma_f32_16x16x32_bf16 v[48:51], a[248:251], v[34:37], v[48:51]
    s_nop 0
    v_mfma_f32_16x16x32_bf16 v[48:51], a[252:255], v[40:43], v[48:51]
    s_add_u32 s21, s21, 12032
    s_waitcnt lgkmcnt(3)
    v_mfma_f32_16x16x32_bf16 v[56:59], a[216:219], a[100:103], v[56:59]
    s_nop 4
    v_cmp_lt_f32 vcc, s29, v48
    v_mfma_f32_16x16x32_bf16 v[56:59], a[220:223], a[104:107], v[56:59]
    s_nop 3
    s_cbranch_vccnz L_rs_tr54b
L_ret_tr54b:
    v_mfma_f32_16x16x32_bf16 v[64:67], a[220:223], a[128:131], 0
    s_waitcnt vmcnt(6) lgkmcnt(0)
    s_add_u32 m0, s22, 0
    v_and_b32 v101, 0x3ff, v0
    v_mfma_f32_16x16x32_bf16 v[64:67], a[216:219], a[124:127], v[64:67]
    s_barrier
    v_mfma_f32_16x16x32_bf16 v[64:67], a[212:215], a[120:123], v[64:67]
    buffer_load_dwordx4 v6, s[4:7], s20 offen lds
    v_mfma_f32_16x16x32_bf16 v[72:75], a[212:215], a[144:147], 0
    s_add_u32 s20, s20, 128
    v_lshrrev_b32 v108, 11, v0
    v_xor_b32 v108, s65, v108
    v_mfma_f32_16x16x32_bf16 v[72:75], a[216:219], a[148:151], v[72:75]
    v_lshl_add_u32 v101, v108, 10, v101
    v_mbcnt_lo_u32_b32 v108, -1, 0
    v_mfma_f32_16x16x32_bf16 v[72:75], a[220:223], a[152:155], v[72:75]
    s_add_u32 m0, s22, 1024
    v_rcp_f32 v50, v50
    v_mfma_f32_16x16x32_bf16 v[80:83], a[220:223], a[176:179], 0
    buffer_load_dwordx4 v6, s[4:7], s20 offen lds
    v_mfma_f32_16x16x32_bf16 v[80:83], a[216:219], a[172:175], v[80:83]
    s_add_u32 s20, s20, 128
    v_mbcnt_hi_u32_b32 v108, -1, v108
    v_mov_b32 v100, v48
    v_mfma_f32_16x16x32_bf16 v[80:83], a[212:215], a[168:171], v[80:83]
    s_add_u32 m0, s22, 2048
    ds_read_b64_tr_b16 a[212:213], v2 offset:18432
    buffer_load_dwordx4 v6, s[4:7], s20 offen lds
    v_mfma_f32_16x16x32_bf16 v[80:83], a[224:227], a[180:183], v[80:83]
    ds_read_b64_tr_b16 a[214:215], v2 offset:12288
    v_lshrrev_b32 v108, 1, v108
    v_add_u32 v101, s38, v101
    v_mfma_f32_16x16x32_bf16 v[80:83], a[228:231], a[184:187], v[80:83]
    ds_read_b64_tr_b16 a[216:217], v3 offset:18432
    v_and_b32 v108, 24, v108
    v_mfma_f32_16x16x32_bf16 v[80:83], a[232:235], a[188:191], v[80:83]
    ds_read_b64_tr_b16 a[218:219], v3 offset:12288
    v_bfe_u32 v108, s66, v108, 8
    v_mfma_f32_16x16x32_bf16 v[72:75], a[232:235], a[164:167], v[72:75]
    v_permlane32_swap_b32 v48, v100
    v_mfma_f32_16x16x32_bf16 v[72:75], a[228:231], a[160:163], v[72:75]
    v_rcp_f32 v102, v49
    v_mfma_f32_16x16x32_bf16 v[72:75], a[224:227], a[156:159], v[72:75]
    v_rcp_f32 v8, v51
    v_mfma_f32_16x16x32_bf16 v[64:67], a[224:227], a[132:135], v[64:67]
    ds_read_b64_tr_b16 a[220:221], v4 offset:18432
    v_xor_b32 v101, v101, v108
    v_mfma_f32_16x16x32_bf16 v[64:67], a[228:231], a[136:139], v[64:67]
    ds_read_b64_tr_b16 a[222:223], v4 offset:12288
    v_mov_b32 v108, v100
    v_mfma_f32_16x16x32_bf16 v[64:67], a[232:235], a[140:143], v[64:67]
    s_nop 0
    v_permlane16_swap_b32 v100, v108
    v_mfma_f32_16x16x32_bf16 v[56:59], a[232:235], a[116:119], v[56:59]
    v_rcp_f32 v48, v48
    v_mfma_f32_16x16x32_bf16 v[56:59], a[228:231], a[112:115], v[56:59]
    s_add_u32 s20, s20, 12032
    v_rcp_f32 v100, v100
    v_mfma_f32_16x16x32_bf16 v[56:59], a[224:227], a[108:111], v[56:59]
    ds_read_b64_tr_b16 a[224:225], v5 offset:18432
    ds_read_b64_tr_b16 a[226:227], v5 offset:12288
    s_waitcnt lgkmcnt(4)
    v_mfma_f32_16x16x32_bf16 v[112:115], a[212:215], v[16:19], v[112:115]
    v_max3_f32 v96, v52, v53, v54
    v_max3_f32 v98, v60, v61, v62
    v_mfma_f32_16x16x32_bf16 v[116:119], a[216:219], v[16:19], v[116:119]
    ds_read_b64_tr_b16 a[230:231], v2 offset:13312
    v_max3_f32 v96, v96, v55, v56
    v_mfma_f32_16x16x32_bf16 v[164:167], a[216:219], v[22:25], v[164:167]
    ds_read_b64_tr_b16 a[232:233], v3 offset:19456
    v_max3_f32 v96, v96, v57, v58
    v_mfma_f32_16x16x32_bf16 v[160:163], a[212:215], v[22:25], v[160:163]
    s_mov_b32 s67, s34
    v_max3_f32 v98, v98, v63, v64
    v_max3_f32 v98, v98, v65, v66
    v_max_f32 v98, v98, v67
    v_mov_b32 v99, v98
    v_mfma_f32_16x16x32_bf16 v[208:211], a[212:215], v[28:31], v[208:211]
    v_max_f32 v96, v96, v59
    v_mov_b32 v97, v96
    v_mfma_f32_16x16x32_bf16 v[212:215], a[216:219], v[28:31], v[212:215]
    s_add_u32 s18, s34, 30720
    v_permlane32_swap_b32 v97, v96
    v_mfma_f32_16x16x32_bf16 a[4:7], a[216:219], v[34:37], a[4:7]
    s_mov_b32 s34, s33
    v_permlane32_swap_b32 v99, v98
    v_mfma_f32_16x16x32_bf16 a[0:3], a[212:215], v[34:37], a[0:3]
    s_add_u32 s64, s64, s62
    ds_read_b64_tr_b16 a[228:229], v2 offset:19456
    v_max_f32 v96, v96, v97
    v_mfma_f32_16x16x32_bf16 a[48:51], a[212:215], v[40:43], a[48:51]
    ds_read_b64_tr_b16 a[234:235], v3 offset:13312
    v_mov_b32 v97, v96
    v_mfma_f32_16x16x32_bf16 a[52:55], a[216:219], v[40:43], a[52:55]
    s_waitcnt lgkmcnt(4)
    v_max_f32 v98, v98, v99
    v_permlane16_swap_b32 v97, v96
    v_max_f32 v96, v96, v97
    v_mfma_f32_16x16x32_bf16 a[56:59], a[220:223], v[40:43], a[56:59]
    s_add_u32 s64, s64, 196608
    v_mov_b32 v99, v98
    v_mul_f32_e64 v9, -s28, v96
    v_mfma_f32_16x16x32_bf16 a[60:63], a[224:227], v[40:43], a[60:63]
    v_permlane16_swap_b32 v99, v98
    v_mfma_f32_16x16x32_bf16 a[12:15], a[224:227], v[34:37], a[12:15]
    s_mov_b32 s39, s64
    v_max_f32 v98, v98, v99
    v_fma_f32 v59, v59, s28, v9
    v_mfma_f32_16x16x32_bf16 a[8:11], a[220:223], v[34:37], a[8:11]
    s_add_u32 s37, s37, 1
    ds_read_b64_tr_b16 a[218:219], v5 offset:13312
    v_mul_f32_e64 v10, -s28, v98
    v_mfma_f32_16x16x32_bf16 v[216:219], a[220:223], v[28:31], v[216:219]
    s_bitcmp1_b32 s63, s37
    ds_read_b64_tr_b16 a[214:215], v4 offset:13312
    v_max3_f32 v96, v68, v69, v70
    v_mfma_f32_16x16x32_bf16 v[220:223], a[224:227], v[28:31], v[220:223]
    s_cselect_b32 s62, 4294770688, 0
    v_max3_f32 v98, v76, v77, v78
    v_max3_f32 v96, v96, v71, v72
    v_mfma_f32_16x16x32_bf16 v[172:175], a[224:227], v[22:25], v[172:175]
    ds_read_b64_tr_b16 a[216:217], v5 offset:19456
    v_max3_f32 v98, v98, v79, v80
    v_max3_f32 v98, v98, v81, v82
    v_mfma_f32_16x16x32_bf16 v[168:171], a[220:223], v[22:25], v[168:171]
    s_cselect_b32 s42, 0, 325632
    v_fma_f32 v55, v55, s28, v9
    v_fma_f32 v54, v54, s28, v9
    v_mfma_f32_16x16x32_bf16 v[120:123], a[220:223], v[16:19], v[120:123]
    s_add_u32 s35, s35, s42
    v_max_f32 v98, v98, v83
    v_max3_f32 v96, v96, v73, v74
    v_mov_b32 v99, v98
    v_mfma_f32_16x16x32_bf16 v[124:127], a[224:227], v[16:19], v[124:127]
    s_waitcnt lgkmcnt(3)
    v_max_f32 v96, v96, v75
    v_mov_b32 v97, v96
    v_mfma_f32_16x16x32_bf16 v[128:131], a[228:231], v[16:19], v[128:131]
    s_lshl_b32 s42, s37, 1
    ds_read_b64_tr_b16 a[212:213], v4 offset:19456
    v_fma_f32 v67, v67, s28, v10
    v_mfma_f32_16x16x32_bf16 v[132:135], a[232:235], v[16:19], v[132:135]
    s_lshr_b32 s42, s31, s42
    v_exp_f32 v54, v54
    v_mfma_f32_16x16x32_bf16 v[180:183], a[232:235], v[22:25], v[180:183]
    s_and_b32 s42, s42, 3
    v_permlane32_swap_b32 v99, v98
    v_max_f32 v98, v98, v99
    v_mfma_f32_16x16x32_bf16 v[176:179], a[228:231], v[22:25], v[176:179]
    s_add_u32 s42, s42, s36
    v_permlane32_swap_b32 v97, v96
    v_mfma_f32_16x16x32_bf16 v[224:227], a[228:231], v[28:31], v[224:227]
    s_sub_u32 s43, s42, 3
    v_max_f32 v96, v96, v97
    v_mov_b32 v99, v98
    v_fma_f32 v58, v58, s28, v9
    v_mfma_f32_16x16x32_bf16 v[228:231], a[232:235], v[28:31], v[228:231]
    s_cmp_ge_u32 s42, 3
    v_fma_f32 v63, v63, s28, v10
    v_mov_b32 v97, v96
    v_fma_f32 v57, v57, s28, v9
    v_mfma_f32_16x16x32_bf16 a[20:23], a[232:235], v[34:37], a[20:23]
    s_cselect_b32 s42, s43, s42
    ds_read_b64_tr_b16 a[226:227], v3 offset:14336
    v_fma_f32 v61, v61, s28, v10
    v_mfma_f32_16x16x32_bf16 a[16:19], a[228:231], v[34:37], a[16:19]
    s_mul_i32 s44, s3, 5
    v_permlane16_swap_b32 v99, v98
    v_mfma_f32_16x16x32_bf16 a[64:67], a[228:231], v[40:43], a[64:67]
    s_mov_b32 s32, 1
    ds_read_b64_tr_b16 a[224:225], v3 offset:20480
    v_permlane16_swap_b32 v97, v96
    v_mfma_f32_16x16x32_bf16 a[68:71], a[232:235], v[40:43], a[68:71]
    s_waitcnt lgkmcnt(2)
    ds_read_b64_tr_b16 a[220:221], v2 offset:20480
    v_accvgpr_read_b32 v109, a49
    v_mfma_f32_16x16x32_bf16 a[72:75], a[212:215], v[40:43], a[72:75]
    s_lshl_b32 s43, s3, 2
    ds_read_b64_tr_b16 a[222:223], v2 offset:14336
    v_max_f32 v96, v96, v97
    v_mfma_f32_16x16x32_bf16 a[76:79], a[216:219], v[40:43], a[76:79]
    s_add_u32 s45, s43, 21
    ds_read_b64_tr_b16 a[232:233], v5 offset:20480
    v_fma_f32 v53, v53, s28, v9
    v_mfma_f32_16x16x32_bf16 a[28:31], a[216:219], v[34:37], a[28:31]
    s_cmp_eq_u32 s3, 0
    v_exp_f32 v58, v58
    v_mfma_f32_16x16x32_bf16 a[24:27], a[212:215], v[34:37], a[24:27]
    s_cselect_b32 s45, 20, s45
    v_mul_f32_e64 v11, -s28, v96
    v_fma_f32 v70, v70, s28, v11
    v_mfma_f32_16x16x32_bf16 v[232:235], a[212:215], v[28:31], v[232:235]
    s_cselect_b32 s33, 1, 0
    ds_read_b64_tr_b16 a[234:235], v5 offset:14336
    v_fma_f32 v65, v65, s28, v10
    v_mfma_f32_16x16x32_bf16 v[236:239], a[216:219], v[28:31], v[236:239]
    s_cmp_eq_u32 s42, 1
    v_fma_f32 v73, v73, s28, v11
    v_fma_f32 v52, v52, s28, v9
    v_max_f32 v98, v98, v99
    s_cselect_b32 s44, s45, s44
    v_mfma_f32_16x16x32_bf16 v[188:191], a[216:219], v[22:25], v[188:191]
    s_cselect_b32 s32, s33, s32
    v_mul_f32_e64 v12, -s28, v98
    s_add_u32 s45, s43, 37
    v_mfma_f32_16x16x32_bf16 v[184:187], a[212:215], v[22:25], v[184:187]
    s_cmp_eq_u32 s42, 2
    ds_read_b64_tr_b16 a[228:229], v4 offset:20480
    v_fma_f32 v62, v62, s28, v10
    v_mfma_f32_16x16x32_bf16 v[136:139], a[212:215], v[16:19], v[136:139]
    s_cselect_b32 s44, s45, s44
    s_cselect_b32 s32, 0, s32
    v_exp_f32 v62, v62
    v_mfma_f32_16x16x32_bf16 v[140:143], a[216:219], v[16:19], v[140:143]
    s_waitcnt lgkmcnt(3)
    v_exp_f32 v70, v70
    v_mfma_f32_16x16x32_bf16 v[144:147], a[220:223], v[16:19], v[144:147]
    s_mul_i32 s44, s44, 6144
    ds_read_b64_tr_b16 a[230:231], v4 offset:14336
    v_fma_f32 v60, v60, s28, v10
    v_fma_f32 v69, v69, s28, v11
    v_mfma_f32_16x16x32_bf16 v[148:151], a[224:227], v[16:19], v[148:151]
    s_add_u32 s33, s35, s44
    v_exp_f32 v63, v63
    v_mfma_f32_16x16x32_bf16 v[196:199], a[224:227], v[22:25], v[196:199]
    s_mul_i32 s42, s32, 6144
    v_exp_f32 v53, v53
    v_mfma_f32_16x16x32_bf16 v[192:195], a[220:223], v[22:25], v[192:195]
    s_add_u32 s42, s42, 24576
    v_fma_f32 v71, v71, s28, v11
    v_fma_f32 v78, v78, s28, v12
    v_mfma_f32_16x16x32_bf16 v[240:243], a[220:223], v[28:31], v[240:243]
    s_add_u32 s42, s42, s33
    v_accvgpr_read_b32 v105, a1
    v_fma_f32 v68, v68, s28, v11
    v_mfma_f32_16x16x32_bf16 v[244:247], a[224:227], v[28:31], v[244:247]
    s_cmp_ge_u32 s37, 6
    v_exp_f32 v78, v78
    v_mfma_f32_16x16x32_bf16 a[36:39], a[224:227], v[34:37], a[36:39]
    s_cselect_b32 s14, 0, s42
    v_exp_f32 v55, v55
    s_add_u32 s24, s67, 6144
    v_exp_f32 v69, v69
    v_pk_mul_f32 v[164:165], v[164:165], v[102:103] op_sel_hi:[1,0]
    v_pk_mul_f32 v[114:115], v[114:115], v[48:49] op_sel_hi:[1,0]
    v_fma_f32 v66, v66, s28, v10
    v_fma_f32 v79, v79, s28, v12
    s_add_u32 s25, s33, 6144
    v_mfma_f32_16x16x32_bf16 a[32:35], a[220:223], v[34:37], a[32:35]
    s_add_u32 s23, s38, 6144
    v_fma_f32 v56, v56, s28, v9
    v_fma_f32 v83, v83, s28, v12
    v_mfma_f32_16x16x32_bf16 a[80:83], a[220:223], v[40:43], a[80:83]
    s_mov_b32 s27, 0x30c30
    v_fma_f32 v81, v81, s28, v12
    s_mov_b32 s89, 0xaaaaaaaa
    v_mfma_f32_16x16x32_bf16 a[84:87], a[224:227], v[40:43], a[84:87]
    s_mov_b32 s30, 0
    s_waitcnt vmcnt(6) lgkmcnt(0)
    v_exp_f32 v71, v71
    v_mfma_f32_16x16x32_bf16 a[88:91], a[228:231], v[40:43], a[88:91]
    s_barrier
    ds_read_b128 a[212:215], v0 offset:12288
    v_exp_f32 v52, v52
    v_mfma_f32_16x16x32_bf16 a[92:95], a[232:235], v[40:43], a[92:95]
    ds_read_b128 a[220:223], v0 offset:13312
    v_cvt_pk_bf16_f32 v164, v164, v165
    v_mfma_f32_16x16x32_bf16 a[44:47], a[232:235], v[34:37], a[44:47]
    ds_read_b128 a[216:219], v1 offset:12288
    v_exp_f32 v68, v68
    v_mfma_f32_16x16x32_bf16 a[40:43], a[228:231], v[34:37], a[40:43]
    v_fma_f32 v80, v80, s28, v12
    v_cvt_pk_bf16_f32 v21, v62, v63
    v_exp_f32 v56, v56
    v_mfma_f32_16x16x32_bf16 v[248:251], a[228:231], v[28:31], v[248:251]
    v_exp_f32 v79, v79
    v_mfma_f32_16x16x32_bf16 v[252:255], a[232:235], v[28:31], v[252:255]
    v_exp_f32 v66, v66
    v_cvt_pk_bf16_f32 v27, v70, v71
    v_cvt_pk_bf16_f32 v15, v54, v55
    v_mfma_f32_16x16x32_bf16 v[204:207], a[232:235], v[22:25], v[204:207]
    v_fma_f32 v76, v76, s28, v12
    v_cvt_pk_bf16_f32 v33, v78, v79
    v_mfma_f32_16x16x32_bf16 v[200:203], a[228:231], v[22:25], v[200:203]
    v_exp_f32 v83, v83
    v_mfma_f32_16x16x32_bf16 v[152:155], a[228:231], v[16:19], v[152:155]
    v_cvt_pk_bf16_f32 v14, v52, v53
    v_exp_f32 v61, v61
    v_fma_f32 v75, v75, s28, v11
    v_mfma_f32_16x16x32_bf16 v[156:159], a[232:235], v[16:19], v[156:159]
    s_waitcnt lgkmcnt(1)
    v_exp_f32 v60, v60
    v_mfma_f32_16x16x32_bf16 v[52:55], a[212:215], a[96:99], 0
    s_waitcnt lgkmcnt(0)
    ds_read_b128 a[228:231], v0 offset:14336
    v_cvt_pk_bf16_f32 v20, v60, v61
    v_mfma_f32_16x16x32_bf16 v[52:55], a[216:219], a[100:103], v[52:55]
    ds_read_b128 a[224:227], v1 offset:13312
    v_cvt_pk_bf16_f32 v26, v68, v69
    v_fma_f32 v77, v77, s28, v12
    v_mfma_f32_16x16x32_bf16 v[52:55], a[220:223], a[104:107], v[52:55]
    ds_read_b128 a[232:235], v1 offset:14336
    v_fma_f32 v64, v64, s28, v10
    v_mfma_f32_16x16x32_bf16 v[60:63], a[220:223], a[128:131], 0
    v_exp_f32 v76, v76
    v_mfma_f32_16x16x32_bf16 v[60:63], a[216:219], a[124:127], v[60:63]
    v_exp_f32 v77, v77
    v_mfma_f32_16x16x32_bf16 v[60:63], a[212:215], a[120:123], v[60:63]
    v_exp_f32 v64, v64
    v_mfma_f32_16x16x32_bf16 v[68:71], a[212:215], a[144:147], 0
    s_add_u32 m0, s22, 36864
    v_exp_f32 v75, v75
    v_mfma_f32_16x16x32_bf16 v[68:71], a[216:219], a[148:151], v[68:71]
    v_cvt_pk_bf16_f32 v32, v76, v77
    v_fma_f32 v74, v74, s28, v11
    v_mfma_f32_16x16x32_bf16 v[68:71], a[220:223], a[152:155], v[68:71]
    buffer_load_dwordx4 v6, s[8:11], s21 offen lds
    v_mfma_f32_16x16x32_bf16 v[76:79], a[220:223], a[176:179], 0
    v_exp_f32 v59, v59
    v_mfma_f32_16x16x32_bf16 v[76:79], a[216:219], a[172:175], v[76:79]
    v_exp_f32 v67, v67
    v_mfma_f32_16x16x32_bf16 v[76:79], a[212:215], a[168:171], v[76:79]
    s_waitcnt lgkmcnt(1)
    v_exp_f32 v74, v74
    v_mfma_f32_16x16x32_bf16 v[76:79], a[224:227], a[180:183], v[76:79]
    ds_read_b128 a[212:215], v0 offset:18432
    v_accvgpr_read_b32 v108, a48
    v_mfma_f32_16x16x32_bf16 v[76:79], a[228:231], a[184:187], v[76:79]
    s_waitcnt lgkmcnt(1)
    v_fma_f32 v72, v72, s28, v11
    v_fma_f32 v82, v82, s28, v12
    v_mfma_f32_16x16x32_bf16 v[76:79], a[232:235], a[188:191], v[76:79]
    v_accvgpr_read_b32 v106, a2
    v_cvt_pk_bf16_f32 v29, v74, v75
    v_mfma_f32_16x16x32_bf16 v[68:71], a[232:235], a[164:167], v[68:71]
    ds_read_b128 a[216:219], v1 offset:18432
    v_cvt_pk_bf16_f32 v17, v58, v59
    v_mfma_f32_16x16x32_bf16 v[68:71], a[228:231], a[160:163], v[68:71]
    v_exp_f32 v80, v80
    v_mfma_f32_16x16x32_bf16 v[68:71], a[224:227], a[156:159], v[68:71]
    ds_read_b128 a[220:223], v0 offset:19456
    v_accvgpr_read_b32 v107, a3
    v_mfma_f32_16x16x32_bf16 v[60:63], a[224:227], a[132:135], v[60:63]
    v_exp_f32 v72, v72
    v_mfma_f32_16x16x32_bf16 v[60:63], a[228:231], a[136:139], v[60:63]
    v_exp_f32 v57, v57
    v_mfma_f32_16x16x32_bf16 v[60:63], a[232:235], a[140:143], v[60:63]
    s_add_u32 s21, s21, 128
    v_exp_f32 v81, v81
    v_mfma_f32_16x16x32_bf16 v[52:55], a[232:235], a[116:119], v[52:55]
    v_cvt_pk_bf16_f32 v23, v66, v67
    v_exp_f32 v65, v65
    v_exp_f32 v73, v73
    v_fma_f32 v70, v70, s28, v11
    v_pk_mul_f32 v[210:211], v[210:211], v[50:51] op_sel_hi:[1,0]
    v_pk_mul_f32 v[208:209], v[208:209], v[50:51] op_sel_hi:[1,0]
    v_cvt_pk_bf16_f32 v34, v80, v81
    v_pk_mul_f32 v[108:109], v[108:109], v[100:101] op_sel_hi:[1,0]
    v_pk_mul_f32 v[212:213], v[212:213], v[50:51] op_sel_hi:[1,0]
    v_cvt_pk_bf16_f32 v22, v64, v65
    v_mov_b32 v38, v6
    v_mfma_f32_16x16x32_bf16 v[52:55], a[228:231], a[112:115], v[52:55]
    v_mov_b32 v39, v7
    v_cvt_pk_bf16_f32 v28, v72, v73
    v_mfma_f32_16x16x32_bf16 v[52:55], a[224:227], a[108:111], v[52:55]
    s_waitcnt lgkmcnt(1)
    ds_read_b128 a[228:231], v0 offset:20480
    v_cvt_pk_bf16_f32 v16, v56, v57
    v_mfma_f32_16x16x32_bf16 v[56:59], a[212:215], a[96:99], 0
    v_accvgpr_read_b32 v111, a51
    v_cvt_pk_bf16_f32 v208, v208, v209
    v_mfma_f32_16x16x32_bf16 v[56:59], a[216:219], a[100:103], v[56:59]
    s_waitcnt lgkmcnt(1)
    ds_read_b128 a[224:227], v1 offset:19456
    v_subrev_u32 v103, 28672, v103
    v_mfma_f32_16x16x32_bf16 v[56:59], a[220:223], a[104:107], v[56:59]
    v_exp_f32 v82, v82
    v_mfma_f32_16x16x32_bf16 v[64:67], a[220:223], a[128:131], 0
    ds_read_b128 a[232:235], v1 offset:20480
    v_accvgpr_read_b32 v110, a50
    v_mfma_f32_16x16x32_bf16 v[64:67], a[216:219], a[124:127], v[64:67]
    s_add_u32 m0, s22, 37888
    v_cvt_pk_bf16_f32 v35, v82, v83
    v_fma_f32 v71, v71, s28, v11
    v_mfma_f32_16x16x32_bf16 v[64:67], a[212:215], a[120:123], v[64:67]
    buffer_load_dwordx4 v6, s[8:11], s21 offen lds
    v_mfma_f32_16x16x32_bf16 v[72:75], a[212:215], a[144:147], 0
    v_cvt_pk_bf16_f32 v108, v108, v109
    v_fma_f32 v55, v55, s28, v9
    v_mfma_f32_16x16x32_bf16 v[72:75], a[216:219], a[148:151], v[72:75]
    s_add_u32 s21, s21, 128
    v_exp_f32 v70, v70
    v_mfma_f32_16x16x32_bf16 v[72:75], a[220:223], a[152:155], v[72:75]
    s_add_u32 m0, s22, 38912
    v_fma_f32 v62, v62, s28, v10
    v_fma_f32 v68, v68, s28, v11
    v_mfma_f32_16x16x32_bf16 v[80:83], a[220:223], a[176:179], 0
    v_fma_f32 v78, v78, s28, v12
    v_fma_f32 v60, v60, s28, v10
    v_mfma_f32_16x16x32_bf16 v[80:83], a[216:219], a[172:175], v[80:83]
    buffer_load_dwordx4 v6, s[8:11], s21 offen lds
    v_mfma_f32_16x16x32_bf16 v[80:83], a[212:215], a[168:171], v[80:83]
    s_waitcnt lgkmcnt(1)
    v_cvt_pk_bf16_f32 v209, v210, v211
    v_exp_f32 v71, v71
    v_mfma_f32_16x16x32_bf16 v[80:83], a[224:227], a[180:183], v[80:83]
    s_add_u32 s21, s21, 12032
    v_exp_f32 v68, v68
    v_mfma_f32_16x16x32_bf16 v[80:83], a[228:231], a[184:187], v[80:83]
    s_waitcnt vmcnt(6) lgkmcnt(0)
    v_exp_f32 v55, v55
    v_mfma_f32_16x16x32_bf16 v[80:83], a[232:235], a[188:191], v[80:83]
    s_barrier
    v_mfma_f32_16x16x32_bf16 v[72:75], a[232:235], a[164:167], v[72:75]
    s_add_u32 m0, s22, 12288
    v_accvgpr_read_b32 v104, a0
    v_fma_f32 v69, v69, s28, v11
    v_cvt_pk_bf16_f32 v212, v212, v213
    v_fma_f32 v63, v63, s28, v10
    v_mfma_f32_16x16x32_bf16 v[72:75], a[228:231], a[160:163], v[72:75]
    ds_read_b64_tr_b16 a[212:213], v2 offset:0
    buffer_load_dwordx4 v6, s[4:7], s20 offen lds
    v_exp_f32 v78, v78
    v_pk_mul_f32 v[156:157], v[156:157], v[48:49] op_sel_hi:[1,0]
    v_pk_mul_f32 v[112:113], v[112:113], v[48:49] op_sel_hi:[1,0]
    v_pk_mul_f32 v[116:117], v[116:117], v[48:49] op_sel_hi:[1,0]
    v_pk_mul_f32 v[148:149], v[148:149], v[48:49] op_sel_hi:[1,0]
    v_pk_mul_f32 v[220:221], v[220:221], v[50:51] op_sel_hi:[1,0]
    v_pk_mul_f32 v[160:161], v[160:161], v[102:103] op_sel_hi:[1,0]
    v_pk_mul_f32 v[182:183], v[182:183], v[102:103] op_sel_hi:[1,0]
    v_pk_mul_f32 v[180:181], v[180:181], v[102:103] op_sel_hi:[1,0]
    v_pk_mul_f32 v[228:229], v[228:229], v[50:51] op_sel_hi:[1,0]
    v_pk_mul_f32 v[118:119], v[118:119], v[48:49] op_sel_hi:[1,0]
    v_pk_mul_f32 v[252:253], v[252:253], v[50:51] op_sel_hi:[1,0]
    v_pk_mul_f32 v[216:217], v[216:217], v[50:51] op_sel_hi:[1,0]
    v_cvt_pk_bf16_f32 v160, v160, v161
    v_cvt_pk_bf16_f32 v116, v116, v117
    v_pk_mul_f32 v[194:195], v[194:195], v[102:103] op_sel_hi:[1,0]
    v_pk_mul_f32 v[110:111], v[110:111], v[100:101] op_sel_hi:[1,0]
    v_fma_f32 v52, v52, s28, v9
    v_pk_mul_f32 v[176:177], v[176:177], v[102:103] op_sel_hi:[1,0]
    v_pk_mul_f32 v[214:215], v[214:215], v[50:51] op_sel_hi:[1,0]
    v_pk_mul_f32 v[166:167], v[166:167], v[102:103] op_sel_hi:[1,0]
    v_pk_mul_f32 v[104:105], v[104:105], v[8:9] op_sel_hi:[1,0]
    v_pk_mul_f32 v[248:249], v[248:249], v[50:51] op_sel_hi:[1,0]
    v_cvt_pk_bf16_f32 v156, v156, v157
    v_pk_mul_f32 v[168:169], v[168:169], v[102:103] op_sel_hi:[1,0]
    v_fma_f32 v54, v54, s28, v9
    v_pk_mul_f32 v[254:255], v[254:255], v[50:51] op_sel_hi:[1,0]
    v_pk_mul_f32 v[120:121], v[120:121], v[48:49] op_sel_hi:[1,0]
    v_pk_mul_f32 v[184:185], v[184:185], v[102:103] op_sel_hi:[1,0]
    v_pk_mul_f32 v[106:107], v[106:107], v[8:9] op_sel_hi:[1,0]
    v_cvt_pk_bf16_f32 v104, v104, v105
    v_pk_mul_f32 v[128:129], v[128:129], v[48:49] op_sel_hi:[1,0]
    v_pk_mul_f32 v[224:225], v[224:225], v[50:51] op_sel_hi:[1,0]
    v_pk_mul_f32 v[250:251], v[250:251], v[50:51] op_sel_hi:[1,0]
    v_pk_mul_f32 v[192:193], v[192:193], v[102:103] op_sel_hi:[1,0]
    v_pk_mul_f32 v[236:237], v[236:237], v[50:51] op_sel_hi:[1,0]
    v_pk_mul_f32 v[162:163], v[162:163], v[102:103] op_sel_hi:[1,0]
    v_exp_f32 v69, v69
    v_pk_mul_f32 v[170:171], v[170:171], v[102:103] op_sel_hi:[1,0]
    v_cvt_pk_bf16_f32 v117, v118, v119
    v_cvt_pk_bf16_f32 v112, v112, v113
    v_pk_mul_f32 v[218:219], v[218:219], v[50:51] op_sel_hi:[1,0]
    v_pk_mul_f32 v[130:131], v[130:131], v[48:49] op_sel_hi:[1,0]
    v_cvt_pk_bf16_f32 v161, v162, v163
    v_cvt_pk_bf16_f32 v220, v220, v221
    v_pk_mul_f32 v[232:233], v[232:233], v[50:51] op_sel_hi:[1,0]
    v_pk_mul_f32 v[178:179], v[178:179], v[102:103] op_sel_hi:[1,0]
    v_fma_f32 v79, v79, s28, v12
    v_pk_mul_f32 v[134:135], v[134:135], v[48:49] op_sel_hi:[1,0]
    v_pk_mul_f32 v[124:125], v[124:125], v[48:49] op_sel_hi:[1,0]
    v_pk_mul_f32 v[140:141], v[140:141], v[48:49] op_sel_hi:[1,0]
    v_pk_mul_f32 v[172:173], v[172:173], v[102:103] op_sel_hi:[1,0]
    v_pk_mul_f32 v[144:145], v[144:145], v[48:49] op_sel_hi:[1,0]
    v_pk_mul_f32 v[244:245], v[244:245], v[50:51] op_sel_hi:[1,0]
    v_cvt_pk_bf16_f32 v216, v216, v217
    v_cvt_pk_bf16_f32 v113, v114, v115
    v_mfma_f32_16x16x32_bf16 v[72:75], a[224:227], a[156:159], v[72:75]
    s_add_u32 s20, s20, 128
    v_cvt_pk_bf16_f32 v109, v110, v111
    v_cvt_pk_bf16_f32 v105, v106, v107
    v_mfma_f32_16x16x32_bf16 v[64:67], a[224:227], a[132:135], v[64:67]
    s_add_u32 m0, s22, 13312
    ds_read_b64_tr_b16 a[214:215], v2 offset:6144
    v_cvt_pk_bf16_f32 v228, v228, v229
    v_fma_f32 v77, v77, s28, v12
    v_mfma_f32_16x16x32_bf16 v[44:47], a[236:239], v[14:17], 0
    ds_write2st64_b64 v101, v[112:113], v[160:161] offset0:0 offset1:12
    v_cvt_pk_bf16_f32 v172, v172, v173
    v_mfma_f32_16x16x32_bf16 v[64:67], a[228:231], a[136:139], v[64:67]
    ds_read_b64_tr_b16 a[216:217], v3 offset:0
    v_accvgpr_read_b32 v107, a7
    v_mfma_f32_16x16x32_bf16 v[44:47], a[240:243], v[20:23], v[44:47]
    ds_write2st64_b64 v101, v[208:209], v[104:105] offset0:24 offset1:36
    v_mfma_f32_16x16x32_bf16 v[64:67], a[232:235], a[140:143], v[64:67]
    v_cvt_pk_bf16_f32 v184, v184, v185
    v_cvt_pk_bf16_f32 v128, v128, v129
    v_mfma_f32_16x16x32_bf16 v[56:59], a[232:235], a[116:119], v[56:59]
    ds_read_b64_tr_b16 a[218:219], v3 offset:6144
    v_cvt_pk_bf16_f32 v168, v168, v169
    v_exp_f32 v79, v79
    v_cvt_pk_bf16_f32 v165, v166, v167
    v_pk_mul_f32 v[122:123], v[122:123], v[48:49] op_sel_hi:[1,0]
    v_cvt_pk_bf16_f32 v140, v140, v141
    v_pk_mul_f32 v[174:175], v[174:175], v[102:103] op_sel_hi:[1,0]
    v_accvgpr_read_b32 v104, a4
    v_cvt_pk_bf16_f32 v180, v180, v181
    v_pk_mul_f32 v[152:153], v[152:153], v[48:49] op_sel_hi:[1,0]
    v_pk_mul_f32 v[126:127], v[126:127], v[48:49] op_sel_hi:[1,0]
    v_fma_f32 v72, v72, s28, v11
    v_accvgpr_read_b32 v111, a55
    v_mfma_f32_16x16x32_bf16 v[56:59], a[228:231], a[112:115], v[56:59]
    ds_write_b64 v101, v[108:109] offset:24576
    v_cvt_pk_bf16_f32 v124, v124, v125
    v_fma_f32 v83, v83, s28, v12
    v_mfma_f32_16x16x32_bf16 v[44:47], a[244:247], v[26:29], v[44:47]
    ds_read_b64_tr_b16 a[228:229], v2 offset:1024
    v_cvt_pk_bf16_f32 v120, v120, v121
    v_cvt_pk_bf16_f32 v248, v248, v249
    v_mfma_f32_16x16x32_bf16 v[56:59], a[224:227], a[108:111], v[56:59]
    s_waitcnt lgkmcnt(3)
    ds_read_b64_tr_b16 a[220:221], v4 offset:0
    v_cvt_pk_bf16_f32 v121, v122, v123
    v_cvt_pk_bf16_f32 v176, v176, v177
    v_mfma_f32_16x16x32_bf16 v[112:115], a[212:215], v[14:17], 0
    v_cvt_pk_bf16_f32 v236, v236, v237
    v_cvt_pk_bf16_f32 v129, v130, v131
    v_cvt_pk_bf16_f32 v213, v214, v215
    v_fma_f32 v80, v80, s28, v12
    v_accvgpr_read_b32 v105, a5
    v_exp_f32 v52, v52
    v_mfma_f32_16x16x32_bf16 v[160:163], a[212:215], v[20:23], 0
    buffer_load_dwordx4 v6, s[4:7], s20 offen lds
    ds_read_b64_tr_b16 a[222:223], v4 offset:6144
    v_accvgpr_read_b32 v110, a54
    v_xor_b32 v101, 32, v101
    v_accvgpr_read_b32 v108, a52
    v_accvgpr_read_b32 v109, a53
    v_cvt_pk_bf16_f32 v148, v148, v149
    v_cvt_pk_bf16_f32 v217, v218, v219
    v_mfma_f32_16x16x32_bf16 v[208:211], a[212:215], v[26:29], 0
    s_add_u32 s20, s20, 128
    ds_write2st64_b64 v101, v[116:117], v[164:165] offset0:0 offset1:12
    v_accvgpr_read_b32 v106, a6
    v_cvt_pk_bf16_f32 v173, v174, v175
    v_pk_mul_f32 v[186:187], v[186:187], v[102:103] op_sel_hi:[1,0]
    v_cvt_pk_bf16_f32 v192, v192, v193
    v_pk_mul_f32 v[110:111], v[110:111], v[100:101] op_sel_hi:[1,0]
    v_pk_mul_f32 v[146:147], v[146:147], v[48:49] op_sel_hi:[1,0]
    v_fma_f32 v56, v56, s28, v9
    v_pk_mul_f32 v[104:105], v[104:105], v[8:9] op_sel_hi:[1,0]
    v_pk_mul_f32 v[142:143], v[142:143], v[48:49] op_sel_hi:[1,0]
    v_cvt_pk_bf16_f32 v169, v170, v171
    v_pk_mul_f32 v[204:205], v[204:205], v[102:103] op_sel_hi:[1,0]
    v_pk_mul_f32 v[108:109], v[108:109], v[100:101] op_sel_hi:[1,0]
    v_pk_mul_f32 v[222:223], v[222:223], v[50:51] op_sel_hi:[1,0]
    v_pk_mul_f32 v[132:133], v[132:133], v[48:49] op_sel_hi:[1,0]
    v_cvt_pk_bf16_f32 v104, v104, v105
    v_fma_f32 v59, v59, s28, v9
    v_pk_mul_f32 v[234:235], v[234:235], v[50:51] op_sel_hi:[1,0]
    v_pk_mul_f32 v[106:107], v[106:107], v[8:9] op_sel_hi:[1,0]
    v_cvt_pk_bf16_f32 v108, v108, v109
    v_cvt_pk_bf16_f32 v109, v110, v111
    v_cvt_pk_bf16_f32 v224, v224, v225
    v_cvt_pk_bf16_f32 v105, v106, v107
    v_cvt_pk_bf16_f32 v221, v222, v223
    v_mfma_f32_16x16x32_bf16 a[0:3], a[212:215], v[32:35], 0
    s_waitcnt lgkmcnt(1)
    ds_write2st64_b64 v101, v[212:213], v[104:105] offset0:24 offset1:36
    v_accvgpr_read_b32 v110, a58
    v_mfma_f32_16x16x32_bf16 a[4:7], a[216:219], v[32:35], 0
    ds_write_b64 v101, v[108:109] offset:24576
    v_accvgpr_read_b32 v105, a9
    v_fma_f32 v58, v58, s28, v9
    v_cvt_pk_bf16_f32 v125, v126, v127
    v_cvt_pk_bf16_f32 v232, v232, v233
    v_accvgpr_read_b32 v111, a59
    v_accvgpr_read_b32 v107, a11
    v_accvgpr_read_b32 v104, a8
    v_pk_mul_f32 v[104:105], v[104:105], v[8:9] op_sel_hi:[1,0]
    v_pk_mul_f32 v[138:139], v[138:139], v[48:49] op_sel_hi:[1,0]
    v_xor_b32 v101, 96, v101
    v_cvt_pk_bf16_f32 v104, v104, v105
    v_mfma_f32_16x16x32_bf16 v[212:215], a[216:219], v[26:29], 0
    ds_read_b64_tr_b16 a[230:231], v2 offset:7168
    v_accvgpr_read_b32 v106, a10
    v_accvgpr_read_b32 v108, a56
    v_cvt_pk_bf16_f32 v252, v252, v253
    v_accvgpr_read_b32 v109, a57
    v_pk_mul_f32 v[108:109], v[108:109], v[100:101] op_sel_hi:[1,0]
    v_cvt_pk_bf16_f32 v181, v182, v183
    v_pk_mul_f32 v[106:107], v[106:107], v[8:9] op_sel_hi:[1,0]
    v_pk_mul_f32 v[110:111], v[110:111], v[100:101] op_sel_hi:[1,0]
    v_cvt_pk_bf16_f32 v108, v108, v109
    v_cvt_pk_bf16_f32 v109, v110, v111
    v_mfma_f32_16x16x32_bf16 v[164:167], a[216:219], v[20:23], 0
    ds_write2st64_b64 v101, v[120:121], v[168:169] offset0:0 offset1:12
    v_cvt_pk_bf16_f32 v105, v106, v107
    v_pk_mul_f32 v[230:231], v[230:231], v[50:51] op_sel_hi:[1,0]
    v_pk_mul_f32 v[202:203], v[202:203], v[102:103] op_sel_hi:[1,0]
    v_cvt_pk_bf16_f32 v177, v178, v179
    v_fma_f32 v57, v57, s28, v9
    v_mfma_f32_16x16x32_bf16 v[116:119], a[216:219], v[14:17], 0
    ds_read_b64_tr_b16 a[224:225], v5 offset:0
    ds_read_b64_tr_b16 a[226:227], v5 offset:6144
    v_mfma_f32_16x16x32_bf16 v[120:123], a[220:223], v[14:17], 0
    ds_write2st64_b64 v101, v[216:217], v[104:105] offset0:24 offset1:36
    v_pk_mul_f32 v[200:201], v[200:201], v[102:103] op_sel_hi:[1,0]
    v_accvgpr_read_b32 v111, a63
    v_accvgpr_read_b32 v106, a14
    v_mfma_f32_16x16x32_bf16 v[168:171], a[220:223], v[20:23], 0
    ds_write_b64 v101, v[108:109] offset:24576
    v_accvgpr_read_b32 v109, a61
    v_accvgpr_read_b32 v108, a60
    v_accvgpr_read_b32 v104, a12
    v_pk_mul_f32 v[108:109], v[108:109], v[100:101] op_sel_hi:[1,0]
    v_accvgpr_read_b32 v105, a13
    v_accvgpr_read_b32 v110, a62
    v_pk_mul_f32 v[110:111], v[110:111], v[100:101] op_sel_hi:[1,0]
    v_pk_mul_f32 v[188:189], v[188:189], v[102:103] op_sel_hi:[1,0]
    v_cvt_pk_bf16_f32 v108, v108, v109
    v_fma_f32 v53, v53, s28, v9
    v_pk_mul_f32 v[104:105], v[104:105], v[8:9] op_sel_hi:[1,0]
    v_pk_mul_f32 v[240:241], v[240:241], v[50:51] op_sel_hi:[1,0]
    v_cvt_pk_bf16_f32 v132, v132, v133
    v_pk_mul_f32 v[242:243], v[242:243], v[50:51] op_sel_hi:[1,0]
    v_xor_b32 v101, 32, v101
    v_accvgpr_read_b32 v107, a15
    v_mfma_f32_16x16x32_bf16 v[216:219], a[220:223], v[26:29], 0
    s_add_u32 m0, s22, 14336
    ds_read_b64_tr_b16 a[214:215], v4 offset:7168
    buffer_load_dwordx4 v6, s[4:7], s20 offen lds
    ds_read_b64_tr_b16 a[234:235], v3 offset:7168
    v_cvt_pk_bf16_f32 v104, v104, v105
    v_cvt_pk_bf16_f32 v31, v70, v71
    v_pk_mul_f32 v[206:207], v[206:207], v[102:103] op_sel_hi:[1,0]
    v_pk_mul_f32 v[106:107], v[106:107], v[8:9] op_sel_hi:[1,0]
    v_pk_mul_f32 v[136:137], v[136:137], v[48:49] op_sel_hi:[1,0]
    v_exp_f32 v53, v53
    v_cvt_pk_bf16_f32 v105, v106, v107
    v_cvt_pk_bf16_f32 v233, v234, v235
    v_mfma_f32_16x16x32_bf16 a[8:11], a[220:223], v[32:35], 0
    s_waitcnt lgkmcnt(3)
    ds_write2st64_b64 v101, v[124:125], v[172:173] offset0:0 offset1:12
    v_cvt_pk_bf16_f32 v109, v110, v111
    v_mfma_f32_16x16x32_bf16 a[12:15], a[224:227], v[32:35], 0
    ds_write2st64_b64 v101, v[220:221], v[104:105] offset0:24 offset1:36
    v_exp_f32 v83, v83
    v_mfma_f32_16x16x32_bf16 v[220:223], a[224:227], v[26:29], 0
    ds_read_b128 v[88:91], v103 offset:0
    ds_read_b64_tr_b16 a[232:233], v3 offset:1024
    v_cvt_pk_bf16_f32 v30, v68, v69
    v_accvgpr_read_b32 v107, a19
    v_accvgpr_read_b32 v111, a67
    v_accvgpr_read_b32 v104, a16
    v_mfma_f32_16x16x32_bf16 v[44:47], a[248:251], v[32:35], v[44:47]
    s_add_u32 s20, s20, 12032
    ds_write_b64 v101, v[108:109] offset:24576
    v_accvgpr_read_b32 v105, a17
    v_exp_f32 v77, v77
    v_pk_mul_f32 v[104:105], v[104:105], v[8:9] op_sel_hi:[1,0]
    v_cvt_pk_bf16_f32 v240, v240, v241
    v_accvgpr_read_b32 v110, a66
    v_pk_mul_f32 v[226:227], v[226:227], v[50:51] op_sel_hi:[1,0]
    v_exp_f32 v54, v54
    v_accvgpr_read_b32 v106, a18
    v_pk_mul_f32 v[110:111], v[110:111], v[100:101] op_sel_hi:[1,0]
    v_cvt_pk_bf16_f32 v104, v104, v105
    v_cvt_pk_bf16_f32 v185, v186, v187
    v_pk_mul_f32 v[238:239], v[238:239], v[50:51] op_sel_hi:[1,0]
    v_accvgpr_read_b32 v109, a65
    v_accvgpr_read_b32 v108, a64
    v_pk_mul_f32 v[108:109], v[108:109], v[100:101] op_sel_hi:[1,0]
    v_cvt_pk_bf16_f32 v225, v226, v227
    v_pk_mul_f32 v[106:107], v[106:107], v[8:9] op_sel_hi:[1,0]
    v_exp_f32 v62, v62
    v_cvt_pk_bf16_f32 v105, v106, v107
    v_xor_b32 v101, 96, v101
    v_mfma_f32_16x16x32_bf16 v[172:175], a[224:227], v[20:23], 0
    ds_write2st64_b64 v101, v[128:129], v[176:177] offset0:4 offset1:16
    v_cvt_pk_bf16_f32 v237, v238, v239
    v_mfma_f32_16x16x32_bf16 v[124:127], a[224:227], v[14:17], 0
    ds_write2st64_b64 v101, v[224:225], v[104:105] offset0:28 offset1:40
    ds_read_b64_tr_b16 a[220:221], v2 offset:2048
    v_accvgpr_read_b32 v105, a21
    v_pk_mul_f32 v[158:159], v[158:159], v[48:49] op_sel_hi:[1,0]
    v_cvt_pk_bf16_f32 v108, v108, v109
    v_cvt_pk_bf16_f32 v193, v194, v195
    v_mfma_f32_16x16x32_bf16 v[128:131], a[228:231], v[14:17], 0
    ds_read_b64_tr_b16 a[226:227], v3 offset:8192
    ds_read_b64_tr_b16 a[222:223], v2 offset:8192
    v_accvgpr_read_b32 v104, a20
    v_cvt_pk_bf16_f32 v109, v110, v111
    v_cvt_pk_bf16_f32 v188, v188, v189
    v_mfma_f32_16x16x32_bf16 v[176:179], a[228:231], v[20:23], 0
    ds_read_b128 v[96:99], v103 offset:1024
    v_cvt_pk_bf16_f32 v136, v136, v137
    v_mfma_f32_16x16x32_bf16 v[224:227], a[228:231], v[26:29], 0
    ds_read_b64_tr_b16 a[212:213], v4 offset:1024
    ds_write_b64 v101, v[108:109] offset:26624
    v_cvt_pk_bf16_f32 v244, v244, v245
    v_pk_mul_f32 v[196:197], v[196:197], v[102:103] op_sel_hi:[1,0]
    v_accvgpr_read_b32 v107, a23
    v_cvt_pk_bf16_f32 v18, v52, v53
    v_cvt_pk_bf16_f32 v204, v204, v205
    v_cvt_pk_bf16_f32 v152, v152, v153
    v_accvgpr_read_b32 v111, a71
    v_cvt_pk_bf16_f32 v133, v134, v135
    v_pk_mul_f32 v[198:199], v[198:199], v[102:103] op_sel_hi:[1,0]
    v_cvt_pk_bf16_f32 v144, v144, v145
    v_exp_f32 v80, v80
    v_accvgpr_read_b32 v109, a69
    v_accvgpr_read_b32 v110, a70
    v_pk_mul_f32 v[246:247], v[246:247], v[50:51] op_sel_hi:[1,0]
    v_accvgpr_read_b32 v108, a68
    v_pk_mul_f32 v[154:155], v[154:155], v[48:49] op_sel_hi:[1,0]
    v_pk_mul_f32 v[108:109], v[108:109], v[100:101] op_sel_hi:[1,0]
    v_pk_mul_f32 v[104:105], v[104:105], v[8:9] op_sel_hi:[1,0]
    v_fma_f32 v76, v76, s28, v12
    v_pk_mul_f32 v[110:111], v[110:111], v[100:101] op_sel_hi:[1,0]
    v_cvt_pk_bf16_f32 v104, v104, v105
    v_accvgpr_read_b32 v106, a22
    v_pk_mul_f32 v[106:107], v[106:107], v[8:9] op_sel_hi:[1,0]
    v_cvt_pk_bf16_f32 v145, v146, v147
    v_cvt_pk_bf16_f32 v249, v250, v251
    v_xor_b32 v101, 32, v101
    v_cvt_pk_bf16_f32 v229, v230, v231
    v_exp_f32 v72, v72
    v_fma_f32 v82, v82, s28, v12
    v_cvt_pk_bf16_f32 v141, v142, v143
    v_cvt_pk_bf16_f32 v108, v108, v109
    v_cvt_pk_bf16_f32 v105, v106, v107
    v_mfma_f32_16x16x32_bf16 a[16:19], a[228:231], v[32:35], 0
    s_waitcnt lgkmcnt(0)
    ds_write2st64_b64 v101, v[132:133], v[180:181] offset0:4 offset1:16
    v_mfma_f32_16x16x32_bf16 a[20:23], a[232:235], v[32:35], 0
    ds_write2st64_b64 v101, v[228:229], v[104:105] offset0:28 offset1:40
    v_accvgpr_read_b32 v106, a26
    v_cvt_pk_bf16_f32 v205, v206, v207
    v_cvt_pk_bf16_f32 v109, v110, v111
    v_mfma_f32_16x16x32_bf16 v[228:231], a[232:235], v[26:29], 0
    s_add_u32 s39, s39, 12288
    ds_write_b64 v101, v[108:109] offset:26624
    v_accvgpr_read_b32 v104, a24
    v_xor_b32 v101, 96, v101
    v_accvgpr_read_b32 v109, a73
    v_accvgpr_read_b32 v108, a72
    v_pk_mul_f32 v[190:191], v[190:191], v[102:103] op_sel_hi:[1,0]
    v_fma_f32 v74, v74, s28, v11
    v_accvgpr_read_b32 v105, a25
    v_accvgpr_read_b32 v107, a27
    v_cvt_pk_bf16_f32 v241, v242, v243
    v_pk_mul_f32 v[150:151], v[150:151], v[48:49] op_sel_hi:[1,0]
    v_pk_mul_f32 v[108:109], v[108:109], v[100:101] op_sel_hi:[1,0]
    v_accvgpr_read_b32 v111, a75
    v_cvt_pk_bf16_f32 v137, v138, v139
    v_cvt_pk_bf16_f32 v245, v246, v247
    v_pk_mul_f32 v[106:107], v[106:107], v[8:9] op_sel_hi:[1,0]
    v_cvt_pk_bf16_f32 v108, v108, v109
    v_pk_mul_f32 v[104:105], v[104:105], v[8:9] op_sel_hi:[1,0]
    v_accvgpr_read_b32 v110, a74
    v_pk_mul_f32 v[110:111], v[110:111], v[100:101] op_sel_hi:[1,0]
    v_cvt_pk_bf16_f32 v104, v104, v105
    v_cvt_pk_bf16_f32 v105, v106, v107
    v_accvgpr_read_b32 v106, a30
    v_mfma_f32_16x16x32_bf16 v[180:183], a[232:235], v[20:23], 0
    ds_read_b64_tr_b16 a[218:219], v5 offset:7168
    ds_write2st64_b64 v101, v[136:137], v[184:185] offset0:4 offset1:16
    ds_read_b64_tr_b16 a[228:229], v4 offset:2048
    ds_read_b64_tr_b16 a[216:217], v5 offset:1024
    v_mfma_f32_16x16x32_bf16 v[132:135], a[232:235], v[14:17], 0
    ds_write2st64_b64 v101, v[232:233], v[104:105] offset0:28 offset1:40
    v_cvt_pk_bf16_f32 v109, v110, v111
    v_accvgpr_read_b32 v111, a79
    v_mfma_f32_16x16x32_bf16 v[136:139], a[212:215], v[14:17], 0
    ds_write_b64 v101, v[108:109] offset:26624
    v_accvgpr_read_b32 v108, a76
    v_fma_f32 v66, v66, s28, v10
    v_accvgpr_read_b32 v105, a29
    v_cvt_pk_bf16_f32 v189, v190, v191
    v_accvgpr_read_b32 v104, a28
    v_xor_b32 v101, 32, v101
    v_accvgpr_read_b32 v107, a31
    v_cvt_pk_bf16_f32 v149, v150, v151
    v_exp_f32 v76, v76
    v_pk_mul_f32 v[106:107], v[106:107], v[8:9] op_sel_hi:[1,0]
    v_accvgpr_read_b32 v109, a77
    v_exp_f32 v60, v60
    v_cvt_pk_bf16_f32 v200, v200, v201
    v_pk_mul_f32 v[108:109], v[108:109], v[100:101] op_sel_hi:[1,0]
    v_accvgpr_read_b32 v110, a78
    v_fma_f32 v73, v73, s28, v11
    v_mfma_f32_16x16x32_bf16 v[184:187], a[212:215], v[20:23], 0
    ds_write2st64_b64 v101, v[140:141], v[188:189] offset0:4 offset1:16
    v_pk_mul_f32 v[104:105], v[104:105], v[8:9] op_sel_hi:[1,0]
    v_cvt_pk_bf16_f32 v108, v108, v109
    v_cvt_pk_bf16_f32 v196, v196, v197
    v_cvt_pk_bf16_f32 v104, v104, v105
    v_cvt_pk_bf16_f32 v105, v106, v107
    v_mfma_f32_16x16x32_bf16 v[232:235], a[212:215], v[26:29], 0
    ds_read_b64_tr_b16 a[230:231], v4 offset:8192
    ds_read_b64_tr_b16 a[224:225], v3 offset:2048
    v_mfma_f32_16x16x32_bf16 a[24:27], a[212:215], v[32:35], 0
    s_waitcnt lgkmcnt(3)
    ds_read_b64_tr_b16 a[232:233], v5 offset:2048
    ds_read_b64_tr_b16 a[234:235], v5 offset:8192
    v_mfma_f32_16x16x32_bf16 a[28:31], a[216:219], v[32:35], 0
    ds_write2st64_b64 v101, v[236:237], v[104:105] offset0:28 offset1:40
    v_accvgpr_read_b32 v106, a34
    v_accvgpr_read_b32 v104, a32
    v_pk_mul_f32 v[110:111], v[110:111], v[100:101] op_sel_hi:[1,0]
    v_cvt_pk_bf16_f32 v253, v254, v255
    v_cvt_pk_bf16_f32 v109, v110, v111
    v_accvgpr_read_b32 v105, a33
    v_mfma_f32_16x16x32_bf16 v[236:239], a[216:219], v[26:29], 0
    buffer_store_dwordx4 v[88:91], v6, s[16:19], s67 offen offset:0 nt
    ds_write_b64 v101, v[108:109] offset:26624
    v_accvgpr_read_b32 v109, a81
    v_accvgpr_read_b32 v107, a35
    v_pk_mul_f32 v[104:105], v[104:105], v[8:9] op_sel_hi:[1,0]
    v_xor_b32 v101, 96, v101
    v_accvgpr_read_b32 v108, a80
    v_pk_mul_f32 v[106:107], v[106:107], v[8:9] op_sel_hi:[1,0]
    v_accvgpr_read_b32 v110, a82
    v_fma_f32 v61, v61, s28, v10
    v_accvgpr_read_b32 v111, a83
    v_pk_mul_f32 v[110:111], v[110:111], v[100:101] op_sel_hi:[1,0]
    v_pk_mul_f32 v[108:109], v[108:109], v[100:101] op_sel_hi:[1,0]
    v_exp_f32 v61, v61
    v_cvt_pk_bf16_f32 v19, v54, v55
    v_cvt_pk_bf16_f32 v104, v104, v105
    v_cvt_pk_bf16_f32 v108, v108, v109
    v_cvt_pk_bf16_f32 v201, v202, v203
    v_cvt_pk_bf16_f32 v105, v106, v107
    v_mfma_f32_16x16x32_bf16 v[188:191], a[216:219], v[20:23], 0
    s_waitcnt vmcnt(7) lgkmcnt(1)
    ds_read_b128 v[88:91], v103 offset:3072
    v_accvgpr_read_b32 v106, a38
    v_cvt_pk_bf16_f32 v109, v110, v111
    v_accvgpr_read_b32 v111, a87
    v_mfma_f32_16x16x32_bf16 v[140:143], a[216:219], v[14:17], 0
    ds_write2st64_b64 v101, v[144:145], v[192:193] offset0:8 offset1:20
    v_mfma_f32_16x16x32_bf16 v[144:147], a[220:223], v[14:17], 0
    ds_write2st64_b64 v101, v[240:241], v[104:105] offset0:32 offset1:44
    v_mfma_f32_16x16x32_bf16 v[192:195], a[220:223], v[20:23], 0
    buffer_store_dwordx4 v[96:99], v7, s[16:19], s67 offen offset:0 nt
    s_barrier
    ds_write_b64 v101, v[108:109] offset:0
    v_exp_f32 v63, v63
    v_accvgpr_read_b32 v109, a85
    v_cvt_pk_bf16_f32 v197, v198, v199
    v_accvgpr_read_b32 v110, a86
    v_accvgpr_read_b32 v107, a39
    v_cvt_pk_bf16_f32 v153, v154, v155
    v_accvgpr_read_b32 v105, a37
    v_accvgpr_read_b32 v108, a84
    v_pk_mul_f32 v[108:109], v[108:109], v[100:101] op_sel_hi:[1,0]
    v_accvgpr_read_b32 v104, a36
    v_pk_mul_f32 v[110:111], v[110:111], v[100:101] op_sel_hi:[1,0]
    v_pk_mul_f32 v[104:105], v[104:105], v[8:9] op_sel_hi:[1,0]
    v_pk_mul_f32 v[106:107], v[106:107], v[8:9] op_sel_hi:[1,0]
    v_cvt_pk_bf16_f32 v108, v108, v109
    v_exp_f32 v66, v66
    v_cvt_pk_bf16_f32 v104, v104, v105
    v_xor_b32 v101, 32, v101
    v_cvt_pk_bf16_f32 v105, v106, v107
    v_mfma_f32_16x16x32_bf16 v[240:243], a[220:223], v[26:29], 0
    ds_write2st64_b64 v101, v[148:149], v[196:197] offset0:8 offset1:20
    v_accvgpr_read_b32 v106, a42
    v_cvt_pk_bf16_f32 v109, v110, v111
    v_mfma_f32_16x16x32_bf16 a[32:35], a[220:223], v[32:35], 0
    ds_write2st64_b64 v101, v[244:245], v[104:105] offset0:32 offset1:44
    v_accvgpr_read_b32 v111, a91
    v_accvgpr_read_b32 v110, a90
    v_mfma_f32_16x16x32_bf16 a[36:39], a[224:227], v[32:35], 0
    ds_write_b64 v101, v[108:109] offset:0
    v_mfma_f32_16x16x32_bf16 v[244:247], a[224:227], v[26:29], 0
    ds_read_b128 a[220:223], v0 offset:1024
    v_xor_b32 v101, 96, v101
    v_cvt_pk_bf16_f32 v24, v60, v61
    v_exp_f32 v58, v58
    v_mfma_f32_16x16x32_bf16 v[196:199], a[224:227], v[20:23], 0
    s_add_u32 m0, s22, 24576
    ds_read_b128 a[216:219], v1 offset:0
    v_accvgpr_read_b32 v105, a41
    v_accvgpr_read_b32 v104, a40
    v_mfma_f32_16x16x32_bf16 v[148:151], a[224:227], v[14:17], 0
    buffer_load_dwordx4 v6, s[8:11], s21 offen lds
    ds_write2st64_b64 v101, v[152:153], v[200:201] offset0:8 offset1:20
    v_accvgpr_read_b32 v107, a43
    v_accvgpr_read_b32 v109, a89
    v_pk_mul_f32 v[104:105], v[104:105], v[8:9] op_sel_hi:[1,0]
    v_pk_mul_f32 v[106:107], v[106:107], v[8:9] op_sel_hi:[1,0]
    v_cvt_pk_bf16_f32 v104, v104, v105
    v_cvt_pk_bf16_f32 v105, v106, v107
    v_accvgpr_read_b32 v107, a47
    v_accvgpr_read_b32 v108, a88
    v_mfma_f32_16x16x32_bf16 v[152:155], a[228:231], v[14:17], 0
    ds_write2st64_b64 v101, v[248:249], v[104:105] offset0:32 offset1:44
    v_pk_mul_f32 v[110:111], v[110:111], v[100:101] op_sel_hi:[1,0]
    v_pk_mul_f32 v[108:109], v[108:109], v[100:101] op_sel_hi:[1,0]
    v_fma_f32 v64, v64, s28, v10
    v_cvt_pk_bf16_f32 v108, v108, v109
    v_accvgpr_read_b32 v106, a46
    v_accvgpr_read_b32 v105, a45
    v_mfma_f32_16x16x32_bf16 v[200:203], a[228:231], v[20:23], 0
    ds_read_b128 a[212:215], v0 offset:0
    v_cvt_pk_bf16_f32 v109, v110, v111
    v_mfma_f32_16x16x32_bf16 v[248:251], a[228:231], v[26:29], 0
    ds_write_b64 v101, v[108:109] offset:0
    v_cvt_pk_bf16_f32 v157, v158, v159
    v_accvgpr_read_b32 v104, a44
    v_pk_mul_f32 v[104:105], v[104:105], v[8:9] op_sel_hi:[1,0]
    v_pk_mul_f32 v[106:107], v[106:107], v[8:9] op_sel_hi:[1,0]
    v_cvt_pk_bf16_f32 v25, v62, v63
    v_cvt_pk_bf16_f32 v104, v104, v105
    v_xor_b32 v101, 32, v101
    v_cvt_pk_bf16_f32 v105, v106, v107
    v_mfma_f32_16x16x32_bf16 a[40:43], a[228:231], v[32:35], 0
    ds_write2st64_b64 v101, v[156:157], v[204:205] offset0:8 offset1:20
    v_mfma_f32_16x16x32_bf16 a[44:47], a[232:235], v[32:35], 0
    ds_write2st64_b64 v101, v[252:253], v[104:105] offset0:32 offset1:44
    v_mfma_f32_16x16x32_bf16 v[252:255], a[232:235], v[26:29], 0
    ds_read_b128 a[224:227], v1 offset:1024
    v_fma_f32 v75, v75, s28, v11
    v_mfma_f32_16x16x32_bf16 v[204:207], a[232:235], v[20:23], 0
    ds_read_b128 v[84:87], v103 offset:2048
    v_exp_f32 v74, v74
    v_mfma_f32_16x16x32_bf16 v[156:159], a[232:235], v[14:17], 0
    s_waitcnt lgkmcnt(5)
    ds_read_b128 v[96:99], v103 offset:4096
    v_accvgpr_read_b32 v108, a92
    v_mfma_f32_16x16x32_bf16 v[52:55], a[212:215], a[96:99], 0
    s_add_u32 s21, s21, 128
    ds_read_b128 a[232:235], v1 offset:2048
    v_accvgpr_read_b32 v109, a93
    v_mfma_f32_16x16x32_bf16 v[52:55], a[216:219], a[100:103], v[52:55]
    s_add_u32 m0, s22, 25600
    ds_read_b128 a[228:231], v0 offset:2048
    v_cvt_pk_bf16_f32 v37, v78, v79
    v_mfma_f32_16x16x32_bf16 v[52:55], a[220:223], a[104:107], v[52:55]
    buffer_load_dwordx4 v6, s[8:11], s21 offen lds
    v_mfma_f32_16x16x32_bf16 v[60:63], a[220:223], a[128:131], 0
    s_add_u32 s21, s21, 128
    v_exp_f32 v56, v56
    v_mfma_f32_16x16x32_bf16 v[60:63], a[216:219], a[124:127], v[60:63]
    v_cvt_pk_bf16_f32 v36, v76, v77
    v_fma_f32 v67, v67, s28, v10
    v_mfma_f32_16x16x32_bf16 v[60:63], a[212:215], a[120:123], v[60:63]
    v_accvgpr_read_b32 v110, a94
    v_accvgpr_read_b32 v111, a95
    v_mfma_f32_16x16x32_bf16 v[68:71], a[212:215], a[144:147], 0
    s_add_u32 m0, s22, 26624
    v_exp_f32 v59, v59
    v_mfma_f32_16x16x32_bf16 v[68:71], a[216:219], a[148:151], v[68:71]
    v_exp_f32 v73, v73
    v_mfma_f32_16x16x32_bf16 v[68:71], a[220:223], a[152:155], v[68:71]
    buffer_load_dwordx4 v6, s[8:11], s21 offen lds
    v_mfma_f32_16x16x32_bf16 v[76:79], a[220:223], a[176:179], 0
    s_add_u32 s21, s21, 12032
    ds_read_b128 a[220:223], v0 offset:7168
    v_mfma_f32_16x16x32_bf16 v[76:79], a[216:219], a[172:175], v[76:79]
    s_add_u32 s56, s67, 128
    v_exp_f32 v75, v75
    v_mfma_f32_16x16x32_bf16 v[76:79], a[212:215], a[168:171], v[76:79]
    s_waitcnt lgkmcnt(1)
    buffer_store_dwordx4 v[84:87], v6, s[16:19], s56 offen offset:0 nt
    v_pk_mul_f32 v[108:109], v[108:109], v[100:101] op_sel_hi:[1,0]
    v_pk_mul_f32 v[110:111], v[110:111], v[100:101] op_sel_hi:[1,0]
    v_fma_f32 v81, v81, s28, v12
    v_fma_f32 v65, v65, s28, v10
    v_mfma_f32_16x16x32_bf16 v[76:79], a[224:227], a[180:183], v[76:79]
    s_add_u32 s58, s33, 128
    v_exp_f32 v57, v57
    v_mfma_f32_16x16x32_bf16 v[76:79], a[228:231], a[184:187], v[76:79]
    s_add_u32 m0, s38, 2048
    ds_read_b128 a[216:219], v1 offset:6144
    v_cvt_pk_bf16_f32 v17, v58, v59
    v_mfma_f32_16x16x32_bf16 v[76:79], a[232:235], a[188:191], v[76:79]
    buffer_load_dwordx4 v6, s[12:15], s58 offen nt lds
    v_mfma_f32_16x16x32_bf16 v[68:71], a[232:235], a[164:167], v[68:71]
    ds_read_b128 v[84:87], v103 offset:5120
    v_cvt_pk_bf16_f32 v108, v108, v109
    v_mfma_f32_16x16x32_bf16 v[68:71], a[228:231], a[160:163], v[68:71]
    s_add_u32 m0, s38, 3072
    ds_read_b128 a[212:215], v0 offset:6144
    v_exp_f32 v64, v64
    v_mfma_f32_16x16x32_bf16 v[68:71], a[224:227], a[156:159], v[68:71]
    v_exp_f32 v65, v65
    v_mfma_f32_16x16x32_bf16 v[60:63], a[224:227], a[132:135], v[60:63]
    v_cvt_pk_bf16_f32 v16, v56, v57
    v_exp_f32 v81, v81
    v_mfma_f32_16x16x32_bf16 v[60:63], a[228:231], a[136:139], v[60:63]
    buffer_load_dwordx4 v7, s[12:15], s58 offen nt lds
    v_mfma_f32_16x16x32_bf16 v[60:63], a[232:235], a[140:143], v[60:63]
    buffer_store_dwordx4 v[88:91], v7, s[16:19], s56 offen offset:0 nt
    v_cvt_pk_bf16_f32 v22, v64, v65
    v_exp_f32 v67, v67
    v_mfma_f32_16x16x32_bf16 v[52:55], a[232:235], a[116:119], v[52:55]
    s_add_u32 s57, s67, 256
    v_exp_f32 v82, v82
    v_mfma_f32_16x16x32_bf16 v[48:51], a[236:239], v[16:19], v[44:47]
    v_cvt_pk_bf16_f32 v23, v66, v67
    v_cvt_pk_bf16_f32 v109, v110, v111
    v_mfma_f32_16x16x32_bf16 v[52:55], a[228:231], a[112:115], v[52:55]
    buffer_store_dwordx4 v[96:99], v6, s[16:19], s57 offen offset:0 nt
    ds_write_b64 v101, v[108:109] offset:0
    v_mfma_f32_16x16x32_bf16 v[52:55], a[224:227], a[108:111], v[52:55]
    ds_read_b128 v[88:91], v103 offset:0
    v_cvt_pk_bf16_f32 v35, v82, v83
    v_mfma_f32_16x16x32_bf16 v[48:51], a[240:243], v[22:25], v[48:51]
    s_waitcnt lgkmcnt(2)
    v_cvt_pk_bf16_f32 v28, v72, v73
    v_cvt_pk_bf16_f32 v34, v80, v81
    v_mfma_f32_16x16x32_bf16 v[56:59], a[212:215], a[96:99], 0
    ds_read_b128 a[228:231], v0 offset:8192
    v_cvt_pk_bf16_f32 v29, v74, v75
    v_mfma_f32_16x16x32_bf16 v[56:59], a[216:219], a[100:103], v[56:59]
    s_add_u32 s59, s33, 256
    s_add_u32 m0, s38, 4096
    ds_read_b128 a[232:235], v1 offset:8192
    v_mfma_f32_16x16x32_bf16 v[48:51], a[244:247], v[28:31], v[48:51]
    buffer_load_dwordx4 v6, s[12:15], s59 offen nt lds
    v_mfma_f32_16x16x32_bf16 v[48:51], a[248:251], v[34:37], v[48:51]
    buffer_store_dwordx4 v[84:87], v7, s[16:19], s57 offen offset:0 nt
    ds_read_b128 v[96:99], v103 offset:1024
    s_add_u32 m0, s38, 5120
    v_mfma_f32_16x16x32_bf16 v[56:59], a[220:223], a[104:107], v[56:59]
    ds_read_b128 a[224:227], v1 offset:7168
    v_mfma_f32_16x16x32_bf16 v[64:67], a[220:223], a[128:131], 0
    buffer_load_dwordx4 v7, s[12:15], s59 offen nt lds
    v_mfma_f32_16x16x32_bf16 v[64:67], a[216:219], a[124:127], v[64:67]
    s_add_u32 s56, s67, 24832
    v_cmp_lt_f32 vcc, s29, v48
    s_add_u32 m0, s38, 0
    v_mfma_f32_16x16x32_bf16 v[64:67], a[212:215], a[120:123], v[64:67]
    s_waitcnt lgkmcnt(4)
    buffer_load_dwordx4 v6, s[12:15], s33 offen nt lds
    v_mfma_f32_16x16x32_bf16 v[72:75], a[212:215], a[144:147], 0
    s_add_u32 m0, s38, 1024
    v_add_u32 v103, 6144, v103
    v_mfma_f32_16x16x32_bf16 v[72:75], a[216:219], a[148:151], v[72:75]
    buffer_store_dwordx4 v[88:91], v6, s[16:19], s56 offen offset:0 nt
    s_cbranch_vccnz L_rs_tr54d
L_ret_tr54d:
    v_fma_f32 v53, v53, s28, v9
    v_fma_f32 v55, v55, s28, v9
    v_fma_f32 v60, v60, s28, v10
    v_mfma_f32_16x16x32_bf16 v[72:75], a[220:223], a[152:155], v[72:75]
    v_exp_f32 v53, v53
    v_mfma_f32_16x16x32_bf16 v[80:83], a[220:223], a[176:179], 0
    s_waitcnt lgkmcnt(1)
    buffer_load_dwordx4 v7, s[12:15], s33 offen nt lds
    v_mfma_f32_16x16x32_bf16 v[80:83], a[216:219], a[172:175], v[80:83]
    v_fma_f32 v61, v61, s28, v10
    v_fma_f32 v54, v54, s28, v9
    v_mfma_f32_16x16x32_bf16 v[80:83], a[212:215], a[168:171], v[80:83]
    s_waitcnt vmcnt(19) lgkmcnt(0)
    v_exp_f32 v61, v61
    v_mfma_f32_16x16x32_bf16 v[80:83], a[224:227], a[180:183], v[80:83]
    buffer_store_dwordx4 v[96:99], v7, s[16:19], s56 offen offset:0 nt
    s_barrier
    v_exp_f32 v55, v55
    v_mfma_f32_16x16x32_bf16 v[80:83], a[228:231], a[184:187], v[80:83]
    s_add_u32 m0, s22, 0
    ds_read_b64_tr_b16 a[212:213], v2 offset:18432
    v_exp_f32 v60, v60
    v_mfma_f32_16x16x32_bf16 v[80:83], a[232:235], a[188:191], v[80:83]
    ds_read_b64_tr_b16 a[214:215], v2 offset:12288
    buffer_load_dwordx4 v6, s[4:7], s20 offen lds
    v_mfma_f32_16x16x32_bf16 v[72:75], a[232:235], a[164:167], v[72:75]
    s_add_u32 s20, s20, 128
    ds_read_b64_tr_b16 a[216:217], v3 offset:18432
    v_fma_f32 v52, v52, s28, v9
    v_mfma_f32_16x16x32_bf16 v[72:75], a[228:231], a[160:163], v[72:75]
    ds_read_b64_tr_b16 a[218:219], v3 offset:12288
    v_cvt_pk_bf16_f32 v20, v60, v61
    v_mfma_f32_16x16x32_bf16 v[72:75], a[224:227], a[156:159], v[72:75]
    s_add_u32 m0, s22, 1024
    v_exp_f32 v54, v54
    v_mfma_f32_16x16x32_bf16 v[64:67], a[224:227], a[132:135], v[64:67]
    buffer_load_dwordx4 v6, s[4:7], s20 offen lds
    v_mfma_f32_16x16x32_bf16 v[64:67], a[228:231], a[136:139], v[64:67]
    s_add_u32 s20, s20, 128
    v_exp_f32 v52, v52
    v_mfma_f32_16x16x32_bf16 v[64:67], a[232:235], a[140:143], v[64:67]
    s_add_u32 m0, s22, 2048
    ds_read_b64_tr_b16 a[220:221], v4 offset:18432
    v_cvt_pk_bf16_f32 v15, v54, v55
    v_mfma_f32_16x16x32_bf16 v[56:59], a[232:235], a[116:119], v[56:59]
    ds_read_b64_tr_b16 a[222:223], v4 offset:12288
    v_cvt_pk_bf16_f32 v14, v52, v53
    v_mfma_f32_16x16x32_bf16 v[56:59], a[228:231], a[112:115], v[56:59]
    buffer_load_dwordx4 v6, s[4:7], s20 offen lds
    v_mfma_f32_16x16x32_bf16 v[56:59], a[224:227], a[108:111], v[56:59]
    s_add_u32 s20, s20, 12032
    ds_read_b64_tr_b16 a[224:225], v5 offset:18432
    ds_read_b64_tr_b16 a[226:227], v5 offset:12288
    s_branch L_loop4
L_tr55:
    s_waitcnt lgkmcnt(4)
    v_mfma_f32_16x16x32_bf16 v[112:115], a[212:215], v[16:19], v[112:115]
    ds_read_b64_tr_b16 a[232:233], v3 offset:19456
    v_mbcnt_lo_u32_b32 v97, -1, 0
    v_mfma_f32_16x16x32_bf16 v[116:119], a[216:219], v[16:19], v[116:119]
    s_add_u32 s39, s39, 12288
    ds_read_b64_tr_b16 a[228:229], v2 offset:19456
    v_fma_f32 v57, v57, s28, v9
    v_mfma_f32_16x16x32_bf16 v[164:167], a[216:219], v[22:25], v[164:167]
    v_fma_f32 v70, v70, s28, v11
    v_mfma_f32_16x16x32_bf16 v[160:163], a[212:215], v[22:25], v[160:163]
    v_fma_f32 v69, v69, s28, v11
    v_fma_f32 v77, v77, s28, v12
    v_mfma_f32_16x16x32_bf16 v[208:211], a[212:215], v[28:31], v[208:211]
    s_add_u32 s48, s33, 24576
    ds_read_b64_tr_b16 a[230:231], v2 offset:13312
    v_mbcnt_hi_u32_b32 v97, -1, v97
    v_mfma_f32_16x16x32_bf16 v[212:215], a[216:219], v[28:31], v[212:215]
    ds_read_b64_tr_b16 a[234:235], v3 offset:13312
    v_fma_f32 v82, v82, s28, v12
    v_mfma_f32_16x16x32_bf16 a[4:7], a[216:219], v[34:37], a[4:7]
    v_and_b32 v96, 15, v97
    v_lshrrev_b32 v97, 4, v97
    v_mfma_f32_16x16x32_bf16 a[0:3], a[212:215], v[34:37], a[0:3]
    v_mul_u32_u24 v96, 384, v96
    v_fma_f32 v79, v79, s28, v12
    v_mfma_f32_16x16x32_bf16 a[48:51], a[212:215], v[40:43], a[48:51]
    ds_read_b64_tr_b16 a[214:215], v4 offset:13312
    v_fma_f32 v59, v59, s28, v9
    v_mfma_f32_16x16x32_bf16 a[52:55], a[216:219], v[40:43], a[52:55]
    s_waitcnt lgkmcnt(5)
    v_fma_f32 v68, v68, s28, v11
    v_mfma_f32_16x16x32_bf16 a[56:59], a[220:223], v[40:43], a[56:59]
    v_lshl_add_u32 v96, v97, 4, v96
    v_fma_f32 v58, v58, s28, v9
    v_mfma_f32_16x16x32_bf16 a[60:63], a[224:227], v[40:43], a[60:63]
    buffer_load_dword v97, v96, s[12:15], s48 offen offset:256
    v_mfma_f32_16x16x32_bf16 a[12:15], a[224:227], v[34:37], a[12:15]
    ds_read_b64_tr_b16 a[218:219], v5 offset:13312
    v_fma_f32 v85, v85, s28, v13
    v_mfma_f32_16x16x32_bf16 a[8:11], a[220:223], v[34:37], a[8:11]
    ds_read_b64_tr_b16 a[212:213], v4 offset:19456
    v_fma_f32 v83, v83, s28, v12
    v_mfma_f32_16x16x32_bf16 v[216:219], a[220:223], v[28:31], v[216:219]
    v_fma_f32 v90, v90, s28, v13
    v_fma_f32 v56, v56, s28, v9
    v_mfma_f32_16x16x32_bf16 v[220:223], a[224:227], v[28:31], v[220:223]
    ds_read_b64_tr_b16 a[216:217], v5 offset:19456
    v_fma_f32 v78, v78, s28, v12
    v_mfma_f32_16x16x32_bf16 v[172:175], a[224:227], v[22:25], v[172:175]
    v_fma_f32 v73, v73, s28, v11
    v_fma_f32 v71, v71, s28, v11
    v_mfma_f32_16x16x32_bf16 v[168:171], a[220:223], v[22:25], v[168:171]
    v_exp_f32 v69, v69
    v_mfma_f32_16x16x32_bf16 v[120:123], a[220:223], v[16:19], v[120:123]
    v_fma_f32 v75, v75, s28, v11
    v_mfma_f32_16x16x32_bf16 v[124:127], a[224:227], v[16:19], v[124:127]
    s_waitcnt lgkmcnt(3)
    v_exp_f32 v57, v57
    v_mfma_f32_16x16x32_bf16 v[128:131], a[228:231], v[16:19], v[128:131]
    v_exp_f32 v78, v78
    v_mfma_f32_16x16x32_bf16 v[132:135], a[232:235], v[16:19], v[132:135]
    v_exp_f32 v79, v79
    v_mfma_f32_16x16x32_bf16 v[180:183], a[232:235], v[22:25], v[180:183]
    v_fma_f32 v72, v72, s28, v11
    v_fma_f32 v74, v74, s28, v11
    v_mfma_f32_16x16x32_bf16 v[176:179], a[228:231], v[22:25], v[176:179]
    ds_read_b64_tr_b16 a[220:221], v2 offset:20480
    v_fma_f32 v89, v89, s28, v13
    v_mfma_f32_16x16x32_bf16 v[224:227], a[228:231], v[28:31], v[224:227]
    ds_read_b64_tr_b16 a[222:223], v2 offset:14336
    v_mfma_f32_16x16x32_bf16 v[228:231], a[232:235], v[28:31], v[228:231]
    v_exp_f32 v85, v85
    v_mfma_f32_16x16x32_bf16 a[20:23], a[232:235], v[34:37], a[20:23]
    v_exp_f32 v77, v77
    v_mfma_f32_16x16x32_bf16 a[16:19], a[228:231], v[34:37], a[16:19]
    ds_read_b64_tr_b16 a[224:225], v3 offset:20480
    v_fma_f32 v87, v87, s28, v13
    v_mfma_f32_16x16x32_bf16 a[64:67], a[228:231], v[40:43], a[64:67]
    ds_read_b64_tr_b16 a[226:227], v3 offset:14336
    v_fma_f32 v86, v86, s28, v13
    v_mfma_f32_16x16x32_bf16 a[68:71], a[232:235], v[40:43], a[68:71]
    s_waitcnt lgkmcnt(4)
    ds_read_b64_tr_b16 a[230:231], v4 offset:14336
    v_mfma_f32_16x16x32_bf16 a[72:75], a[212:215], v[40:43], a[72:75]
    v_fma_f32 v81, v81, s28, v12
    v_fma_f32 v65, v65, s28, v10
    v_mfma_f32_16x16x32_bf16 a[76:79], a[216:219], v[40:43], a[76:79]
    ds_read_b64_tr_b16 a[232:233], v5 offset:20480
    v_mfma_f32_16x16x32_bf16 a[28:31], a[216:219], v[34:37], a[28:31]
    v_exp_f32 v87, v87
    v_mfma_f32_16x16x32_bf16 a[24:27], a[212:215], v[34:37], a[24:27]
    v_exp_f32 v71, v71
    v_mfma_f32_16x16x32_bf16 v[232:235], a[212:215], v[28:31], v[232:235]
    ds_read_b64_tr_b16 a[228:229], v4 offset:20480
    v_mfma_f32_16x16x32_bf16 v[236:239], a[216:219], v[28:31], v[236:239]
    v_mfma_f32_16x16x32_bf16 v[188:191], a[216:219], v[22:25], v[188:191]
    ds_read_b64_tr_b16 a[234:235], v5 offset:14336
    v_mfma_f32_16x16x32_bf16 v[184:187], a[212:215], v[22:25], v[184:187]
    v_fma_f32 v84, v84, s28, v13
    v_fma_f32 v88, v88, s28, v13
    v_mfma_f32_16x16x32_bf16 v[136:139], a[212:215], v[16:19], v[136:139]
    v_exp_f32 v56, v56
    v_mfma_f32_16x16x32_bf16 v[140:143], a[216:219], v[16:19], v[140:143]
    s_waitcnt lgkmcnt(3)
    v_fma_f32 v76, v76, s28, v12
    v_mfma_f32_16x16x32_bf16 v[144:147], a[220:223], v[16:19], v[144:147]
    v_exp_f32 v70, v70
    v_mfma_f32_16x16x32_bf16 v[148:151], a[224:227], v[16:19], v[148:151]
    v_exp_f32 v75, v75
    v_mfma_f32_16x16x32_bf16 v[196:199], a[224:227], v[22:25], v[196:199]
    v_fma_f32 v80, v80, s28, v12
    v_cvt_pk_bf16_f32 v33, v78, v79
    v_mfma_f32_16x16x32_bf16 v[192:195], a[220:223], v[22:25], v[192:195]
    v_exp_f32 v65, v65
    v_mfma_f32_16x16x32_bf16 v[240:243], a[220:223], v[28:31], v[240:243]
    v_exp_f32 v68, v68
    v_mfma_f32_16x16x32_bf16 v[244:247], a[224:227], v[28:31], v[244:247]
    v_exp_f32 v86, v86
    v_mfma_f32_16x16x32_bf16 a[36:39], a[224:227], v[34:37], a[36:39]
    s_waitcnt vmcnt(11) lgkmcnt(0)
    v_exp_f32 v90, v90
    v_mfma_f32_16x16x32_bf16 a[32:35], a[220:223], v[34:37], a[32:35]
    s_barrier
    v_mfma_f32_16x16x32_bf16 a[80:83], a[220:223], v[40:43], a[80:83]
    ds_read_b128 a[216:219], v1 offset:12288
    v_mfma_f32_16x16x32_bf16 a[84:87], a[224:227], v[40:43], a[84:87]
    ds_read_b128 a[212:215], v0 offset:12288
    s_add_u32 m0, s22, 36864
    v_mfma_f32_16x16x32_bf16 a[88:91], a[228:231], v[40:43], a[88:91]
    v_exp_f32 v84, v84
    v_mfma_f32_16x16x32_bf16 a[92:95], a[232:235], v[40:43], a[92:95]
    buffer_load_dwordx4 v6, s[8:11], s21 offen lds
    v_mfma_f32_16x16x32_bf16 a[44:47], a[232:235], v[34:37], a[44:47]
    s_add_u32 s21, s21, 128
    s_add_u32 m0, s22, 37888
    v_cvt_pk_bf16_f32 v27, v70, v71
    v_mfma_f32_16x16x32_bf16 a[40:43], a[228:231], v[34:37], a[40:43]
    buffer_load_dwordx4 v6, s[8:11], s21 offen lds
    v_mfma_f32_16x16x32_bf16 v[248:251], a[228:231], v[28:31], v[248:251]
    v_exp_f32 v76, v76
    v_mfma_f32_16x16x32_bf16 v[252:255], a[232:235], v[28:31], v[252:255]
    ds_read_b128 a[220:223], v0 offset:13312
    v_cvt_pk_bf16_f32 v26, v68, v69
    v_mfma_f32_16x16x32_bf16 v[204:207], a[232:235], v[22:25], v[204:207]
    s_add_u32 s21, s21, 128
    v_fma_f32 v91, v91, s28, v13
    s_add_u32 m0, s22, 38912
    v_mfma_f32_16x16x32_bf16 v[200:203], a[228:231], v[22:25], v[200:203]
    buffer_load_dwordx4 v6, s[8:11], s21 offen lds
    v_mfma_f32_16x16x32_bf16 v[152:155], a[228:231], v[16:19], v[152:155]
    ds_read_b128 a[228:231], v0 offset:14336
    v_fma_f32 v64, v64, s28, v10
    v_mfma_f32_16x16x32_bf16 v[156:159], a[232:235], v[16:19], v[156:159]
    s_waitcnt lgkmcnt(2)
    v_cvt_pk_bf16_f32 v38, v84, v85
    v_cvt_pk_bf16_f32 v39, v86, v87
    v_mfma_f32_16x16x32_bf16 v[52:55], a[212:215], a[96:99], 0
    v_exp_f32 v80, v80
    v_mfma_f32_16x16x32_bf16 v[60:63], a[212:215], a[120:123], 0
    ds_read_b128 a[224:227], v1 offset:13312
    v_cvt_pk_bf16_f32 v32, v76, v77
    v_mfma_f32_16x16x32_bf16 v[68:71], a[212:215], a[144:147], 0
    v_exp_f32 v72, v72
    v_mfma_f32_16x16x32_bf16 v[76:79], a[212:215], a[168:171], 0
    v_exp_f32 v82, v82
    v_mfma_f32_16x16x32_bf16 v[84:87], a[212:215], a[192:195], 0
    v_mfma_f32_16x16x32_bf16 v[52:55], a[216:219], a[100:103], v[52:55]
    v_exp_f32 v91, v91
    v_mfma_f32_16x16x32_bf16 v[60:63], a[216:219], a[124:127], v[60:63]
    ds_read_b128 a[232:235], v1 offset:14336
    v_fma_f32 v67, v67, s28, v10
    v_mfma_f32_16x16x32_bf16 v[68:71], a[216:219], a[148:151], v[68:71]
    v_exp_f32 v64, v64
    v_mfma_f32_16x16x32_bf16 v[76:79], a[216:219], a[172:175], v[76:79]
    v_exp_f32 v73, v73
    v_mfma_f32_16x16x32_bf16 v[84:87], a[216:219], a[196:199], v[84:87]
    s_waitcnt lgkmcnt(2)
    v_exp_f32 v67, v67
    v_mfma_f32_16x16x32_bf16 v[52:55], a[220:223], a[104:107], v[52:55]
    ds_read_b128 a[216:219], v1 offset:20480
    v_mfma_f32_16x16x32_bf16 v[60:63], a[220:223], a[128:131], v[60:63]
    v_exp_f32 v88, v88
    v_mfma_f32_16x16x32_bf16 v[68:71], a[220:223], a[152:155], v[68:71]
    v_exp_f32 v74, v74
    v_mfma_f32_16x16x32_bf16 v[76:79], a[220:223], a[176:179], v[76:79]
    v_exp_f32 v58, v58
    v_mfma_f32_16x16x32_bf16 v[84:87], a[220:223], a[200:203], v[84:87]
    s_waitcnt lgkmcnt(2)
    v_exp_f32 v59, v59
    v_mfma_f32_16x16x32_bf16 v[52:55], a[224:227], a[108:111], v[52:55]
    v_exp_f32 v83, v83
    v_mfma_f32_16x16x32_bf16 v[60:63], a[224:227], a[132:135], v[60:63]
    ds_read_b128 a[212:215], v0 offset:20480
    v_mfma_f32_16x16x32_bf16 v[68:71], a[224:227], a[156:159], v[68:71]
    v_exp_f32 v81, v81
    v_mfma_f32_16x16x32_bf16 v[76:79], a[224:227], a[180:183], v[76:79]
    v_exp_f32 v89, v89
    v_mfma_f32_16x16x32_bf16 v[84:87], a[224:227], a[204:207], v[84:87]
    v_cvt_pk_bf16_f32 v22, v64, v65
    v_mfma_f32_16x16x32_bf16 v[52:55], a[228:231], a[112:115], v[52:55]
    v_fma_f32 v66, v66, s28, v10
    v_cvt_pk_bf16_f32 v40, v88, v89
    v_mfma_f32_16x16x32_bf16 v[60:63], a[228:231], a[136:139], v[60:63]
    v_mfma_f32_16x16x32_bf16 v[68:71], a[228:231], a[160:163], v[68:71]
    s_add_u32 s21, s21, 12032
    ds_read_b128 a[220:223], v0 offset:18432
    v_cvt_pk_bf16_f32 v29, v74, v75
    v_mfma_f32_16x16x32_bf16 v[76:79], a[228:231], a[184:187], v[76:79]
    v_cvt_pk_bf16_f32 v17, v58, v59
    v_cvt_pk_bf16_f32 v16, v56, v57
    v_mfma_f32_16x16x32_bf16 v[84:87], a[228:231], a[208:211], v[84:87]
    s_waitcnt lgkmcnt(2)
    v_exp_f32 v66, v66
    v_mfma_f32_16x16x32_bf16 v[52:55], a[232:235], a[116:119], v[52:55]
    ds_read_b128 a[228:231], v0 offset:19456
    v_mfma_f32_16x16x32_bf16 v[60:63], a[232:235], a[140:143], v[60:63]
    ds_read_b128 a[224:227], v1 offset:18432
    v_mfma_f32_16x16x32_bf16 v[44:47], a[236:239], v[14:17], v[48:51]
    v_cvt_pk_bf16_f32 v35, v82, v83
    v_mfma_f32_16x16x32_bf16 v[68:71], a[232:235], a[164:167], v[68:71]
    v_cvt_pk_bf16_f32 v28, v72, v73
    v_mfma_f32_16x16x32_bf16 v[76:79], a[232:235], a[188:191], v[76:79]
    v_cvt_pk_bf16_f32 v23, v66, v67
    v_cvt_pk_bf16_f32 v41, v90, v91
    v_mfma_f32_16x16x32_bf16 v[84:87], a[232:235], v[92:95], v[84:87]
    ds_read_b128 a[232:235], v1 offset:19456
    v_cvt_pk_bf16_f32 v34, v80, v81
    v_mfma_f32_16x16x32_bf16 v[44:47], a[240:243], v[20:23], v[44:47]
    v_mfma_f32_16x16x32_bf16 v[44:47], a[244:247], v[26:29], v[44:47]
    v_mfma_f32_16x16x32_bf16 v[44:47], a[248:251], v[32:35], v[44:47]
    v_mfma_f32_16x16x32_bf16 v[44:47], a[252:255], v[38:41], v[44:47]
    s_waitcnt lgkmcnt(3)
    v_mfma_f32_16x16x32_bf16 v[56:59], a[212:215], a[112:115], 0
    v_mfma_f32_16x16x32_bf16 v[64:67], a[212:215], a[136:139], 0
    v_mfma_f32_16x16x32_bf16 v[72:75], a[212:215], a[160:163], 0
    v_mfma_f32_16x16x32_bf16 v[80:83], a[212:215], a[184:187], 0
    v_mfma_f32_16x16x32_bf16 v[88:91], a[212:215], a[208:211], 0
    s_nop 1
    v_cmp_lt_f32 vcc, s29, v44
    v_mfma_f32_16x16x32_bf16 v[56:59], a[216:219], a[116:119], v[56:59]
    s_waitcnt vmcnt(8) lgkmcnt(0)
    v_mfma_f32_16x16x32_bf16 v[64:67], a[216:219], a[140:143], v[64:67]
    s_barrier
    v_mfma_f32_16x16x32_bf16 v[72:75], a[216:219], a[164:167], v[72:75]
    s_cbranch_vccnz L_rs_tr55a
L_ret_tr55a:
    v_fma_f32 v60, v60, s28, v10
    v_mfma_f32_16x16x32_bf16 v[80:83], a[216:219], a[188:191], v[80:83]
    ds_read_b64_tr_b16 a[212:213], v2 offset:0
    v_fma_f32 v54, v54, s28, v9
    v_mfma_f32_16x16x32_bf16 v[88:91], a[216:219], v[92:95], v[88:91]
    s_add_u32 m0, s22, 12288
    v_fma_f32 v52, v52, s28, v9
    v_fma_f32 v61, v61, s28, v10
    v_mfma_f32_16x16x32_bf16 v[56:59], a[220:223], a[96:99], v[56:59]
    buffer_load_dwordx4 v6, s[4:7], s20 offen lds
    v_mfma_f32_16x16x32_bf16 v[64:67], a[220:223], a[120:123], v[64:67]
    v_fma_f32 v55, v55, s28, v9
    v_fma_f32 v63, v63, s28, v10
    v_mfma_f32_16x16x32_bf16 v[72:75], a[220:223], a[144:147], v[72:75]
    s_add_u32 s20, s20, 128
    v_exp_f32 v52, v52
    v_mfma_f32_16x16x32_bf16 v[80:83], a[220:223], a[168:171], v[80:83]
    s_add_u32 m0, s22, 13312
    v_exp_f32 v55, v55
    v_mfma_f32_16x16x32_bf16 v[88:91], a[220:223], a[192:195], v[88:91]
    buffer_load_dwordx4 v6, s[4:7], s20 offen lds
    v_mfma_f32_16x16x32_bf16 v[56:59], a[224:227], a[100:103], v[56:59]
    s_add_u32 s20, s20, 128
    v_exp_f32 v54, v54
    v_mfma_f32_16x16x32_bf16 v[64:67], a[224:227], a[124:127], v[64:67]
    s_add_u32 m0, s22, 14336
    ds_read_b64_tr_b16 a[214:215], v2 offset:6144
    v_fma_f32 v62, v62, s28, v10
    v_mfma_f32_16x16x32_bf16 v[72:75], a[224:227], a[148:151], v[72:75]
    buffer_load_dwordx4 v6, s[4:7], s20 offen lds
    v_mfma_f32_16x16x32_bf16 v[80:83], a[224:227], a[172:175], v[80:83]
    v_exp_f32 v63, v63
    v_mfma_f32_16x16x32_bf16 v[88:91], a[224:227], a[196:199], v[88:91]
    ds_read_b64_tr_b16 a[216:217], v3 offset:0
    v_fma_f32 v53, v53, s28, v9
    v_mfma_f32_16x16x32_bf16 v[56:59], a[228:231], a[104:107], v[56:59]
    ds_read_b64_tr_b16 a[218:219], v3 offset:6144
    v_cvt_pk_bf16_f32 v19, v54, v55
    v_mfma_f32_16x16x32_bf16 v[64:67], a[228:231], a[128:131], v[64:67]
    v_exp_f32 v62, v62
    v_mfma_f32_16x16x32_bf16 v[72:75], a[228:231], a[152:155], v[72:75]
    ds_read_b64_tr_b16 a[220:221], v4 offset:0
    v_exp_f32 v61, v61
    v_mfma_f32_16x16x32_bf16 v[80:83], a[228:231], a[176:179], v[80:83]
    ds_read_b64_tr_b16 a[222:223], v4 offset:6144
    v_cvt_pk_bf16_f32 v25, v62, v63
    v_mfma_f32_16x16x32_bf16 v[88:91], a[228:231], a[200:203], v[88:91]
    v_exp_f32 v60, v60
    v_mfma_f32_16x16x32_bf16 v[56:59], a[232:235], a[108:111], v[56:59]
    s_add_u32 s20, s20, 12032
    v_exp_f32 v53, v53
    v_mfma_f32_16x16x32_bf16 v[64:67], a[232:235], a[132:135], v[64:67]
    ds_read_b64_tr_b16 a[224:225], v5 offset:0
    v_cvt_pk_bf16_f32 v18, v52, v53
    v_mfma_f32_16x16x32_bf16 v[72:75], a[232:235], a[156:159], v[72:75]
    buffer_load_dwordx4 a[208:211], v96, s[12:15], s48 offen offset:256 nt
    v_mfma_f32_16x16x32_bf16 v[80:83], a[232:235], a[180:183], v[80:83]
    ds_read_b64_tr_b16 a[226:227], v5 offset:6144
    v_cvt_pk_bf16_f32 v24, v60, v61
    v_mfma_f32_16x16x32_bf16 v[88:91], a[232:235], a[204:207], v[88:91]
    buffer_load_dwordx4 v[92:95], v96, s[12:15], s48 offen offset:320 nt
    s_waitcnt lgkmcnt(4)
    v_mfma_f32_16x16x32_bf16 v[112:115], a[212:215], v[14:17], v[112:115]
    ds_read_b64_tr_b16 a[230:231], v2 offset:7168
    v_fma_f32 v74, v74, s28, v11
    v_mfma_f32_16x16x32_bf16 v[116:119], a[216:219], v[14:17], v[116:119]
    v_lshrrev_b32 v105, 11, v0
    v_fma_f32 v68, v68, s28, v11
    v_mfma_f32_16x16x32_bf16 v[164:167], a[216:219], v[20:23], v[164:167]
    v_and_b32 v104, 0x3ff, v0
    v_fma_f32 v87, v87, s28, v13
    v_mfma_f32_16x16x32_bf16 v[160:163], a[212:215], v[20:23], v[160:163]
    s_add_u32 s39, s39, 12288
    ds_read_b64_tr_b16 a[228:229], v2 offset:1024
    v_fma_f32 v69, v69, s28, v11
    v_mfma_f32_16x16x32_bf16 v[208:211], a[212:215], v[26:29], v[208:211]
    v_xor_b32 v105, s65, v105
    v_fma_f32 v71, v71, s28, v11
    v_mfma_f32_16x16x32_bf16 v[212:215], a[216:219], v[26:29], v[212:215]
    ds_read_b64_tr_b16 a[234:235], v3 offset:7168
    v_fma_f32 v90, v90, s28, v13
    v_mfma_f32_16x16x32_bf16 a[4:7], a[216:219], v[32:35], a[4:7]
    v_lshl_add_u32 v104, v105, 10, v104
    v_add_u32 v104, s38, v104
    v_mfma_f32_16x16x32_bf16 a[0:3], a[212:215], v[32:35], a[0:3]
    ds_read_b128 a[96:99], v104 offset:0
    v_fma_f32 v81, v81, s28, v12
    v_mfma_f32_16x16x32_bf16 a[48:51], a[212:215], v[38:41], a[48:51]
    v_exp_f32 v69, v69
    v_mfma_f32_16x16x32_bf16 a[52:55], a[216:219], v[38:41], a[52:55]
    s_waitcnt lgkmcnt(4)
    ds_read_b128 a[104:107], v104 offset:2048
    v_fma_f32 v73, v73, s28, v11
    v_mfma_f32_16x16x32_bf16 a[56:59], a[220:223], v[38:41], a[56:59]
    ds_read_b64_tr_b16 a[232:233], v3 offset:1024
    v_fma_f32 v78, v78, s28, v12
    v_mfma_f32_16x16x32_bf16 a[60:63], a[224:227], v[38:41], a[60:63]
    ds_read_b64_tr_b16 a[212:213], v4 offset:1024
    v_fma_f32 v79, v79, s28, v12
    v_mfma_f32_16x16x32_bf16 a[12:15], a[224:227], v[32:35], a[12:15]
    v_exp_f32 v74, v74
    v_mfma_f32_16x16x32_bf16 a[8:11], a[220:223], v[32:35], a[8:11]
    v_exp_f32 v87, v87
    v_mfma_f32_16x16x32_bf16 v[216:219], a[220:223], v[26:29], v[216:219]
    ds_read_b64_tr_b16 a[218:219], v5 offset:7168
    v_fma_f32 v70, v70, s28, v11
    v_mfma_f32_16x16x32_bf16 v[220:223], a[224:227], v[26:29], v[220:223]
    v_exp_f32 v68, v68
    v_mfma_f32_16x16x32_bf16 v[172:175], a[224:227], v[20:23], v[172:175]
    v_exp_f32 v78, v78
    v_mfma_f32_16x16x32_bf16 v[168:171], a[220:223], v[20:23], v[168:171]
    ds_read_b64_tr_b16 a[214:215], v4 offset:7168
    v_xor_b32 v105, 64, v104
    v_mfma_f32_16x16x32_bf16 v[120:123], a[220:223], v[14:17], v[120:123]
    ds_read_b64_tr_b16 a[216:217], v5 offset:1024
    v_fma_f32 v80, v80, s28, v12
    v_mfma_f32_16x16x32_bf16 v[124:127], a[224:227], v[14:17], v[124:127]
    s_waitcnt lgkmcnt(5)
    ds_read_b64_tr_b16 a[220:221], v2 offset:2048
    v_fma_f32 v75, v75, s28, v11
    v_mfma_f32_16x16x32_bf16 v[128:131], a[228:231], v[14:17], v[128:131]
    s_waitcnt lgkmcnt(5)
    ds_read_b128 a[180:183], v105 offset:20480
    v_fma_f32 v86, v86, s28, v13
    v_mfma_f32_16x16x32_bf16 v[132:135], a[232:235], v[14:17], v[132:135]
    v_exp_f32 v79, v79
    v_mfma_f32_16x16x32_bf16 v[180:183], a[232:235], v[20:23], v[180:183]
    v_exp_f32 v81, v81
    v_mfma_f32_16x16x32_bf16 v[176:179], a[228:231], v[20:23], v[176:179]
    ds_read_b64_tr_b16 a[226:227], v3 offset:8192
    v_fma_f32 v88, v88, s28, v13
    v_mfma_f32_16x16x32_bf16 v[224:227], a[228:231], v[26:29], v[224:227]
    v_exp_f32 v86, v86
    v_mfma_f32_16x16x32_bf16 v[228:231], a[232:235], v[26:29], v[228:231]
    ds_read_b128 a[148:151], v105 offset:12288
    v_fma_f32 v58, v58, s28, v9
    v_mfma_f32_16x16x32_bf16 a[20:23], a[232:235], v[32:35], a[20:23]
    ds_read_b128 a[144:147], v104 offset:12288
    v_fma_f32 v85, v85, s28, v13
    v_mfma_f32_16x16x32_bf16 a[16:19], a[228:231], v[32:35], a[16:19]
    ds_read_b64_tr_b16 a[222:223], v2 offset:8192
    v_fma_f32 v57, v57, s28, v9
    v_mfma_f32_16x16x32_bf16 a[64:67], a[228:231], v[38:41], a[64:67]
    v_fma_f32 v77, v77, s28, v12
    v_fma_f32 v56, v56, s28, v9
    v_mfma_f32_16x16x32_bf16 a[68:71], a[232:235], v[38:41], a[68:71]
    s_waitcnt lgkmcnt(5)
    ds_read_b64_tr_b16 a[224:225], v3 offset:2048
    v_fma_f32 v84, v84, s28, v13
    v_mfma_f32_16x16x32_bf16 a[72:75], a[212:215], v[38:41], a[72:75]
    ds_read_b64_tr_b16 a[228:229], v4 offset:2048
    v_fma_f32 v64, v64, s28, v10
    v_mfma_f32_16x16x32_bf16 a[76:79], a[216:219], v[38:41], a[76:79]
    ds_read_b64_tr_b16 a[230:231], v4 offset:8192
    v_fma_f32 v76, v76, s28, v12
    v_mfma_f32_16x16x32_bf16 a[28:31], a[216:219], v[32:35], a[28:31]
    v_exp_f32 v76, v76
    v_mfma_f32_16x16x32_bf16 a[24:27], a[212:215], v[32:35], a[24:27]
    ds_read_b64_tr_b16 a[232:233], v5 offset:2048
    v_fma_f32 v72, v72, s28, v11
    v_mfma_f32_16x16x32_bf16 v[232:235], a[212:215], v[26:29], v[232:235]
    ds_read_b64_tr_b16 a[234:235], v5 offset:8192
    v_cvt_pk_bf16_f32 v37, v78, v79
    v_mfma_f32_16x16x32_bf16 v[236:239], a[216:219], v[26:29], v[236:239]
    ds_read_b128 a[200:203], v104 offset:26624
    v_fma_f32 v65, v65, s28, v10
    v_mfma_f32_16x16x32_bf16 v[188:191], a[216:219], v[20:23], v[188:191]
    v_exp_f32 v75, v75
    v_mfma_f32_16x16x32_bf16 v[184:187], a[212:215], v[20:23], v[184:187]
    ds_read_b128 a[100:103], v105 offset:0
    v_exp_f32 v77, v77
    v_mfma_f32_16x16x32_bf16 v[136:139], a[212:215], v[14:17], v[136:139]
    ds_read_b128 a[192:195], v104 offset:24576
    v_cvt_pk_bf16_f32 v43, v86, v87
    v_mfma_f32_16x16x32_bf16 v[140:143], a[216:219], v[14:17], v[140:143]
    s_waitcnt lgkmcnt(7)
    ds_read_b128 a[132:135], v105 offset:8192
    v_fma_f32 v59, v59, s28, v9
    v_mfma_f32_16x16x32_bf16 v[144:147], a[220:223], v[14:17], v[144:147]
    ds_read_b128 a[168:171], v104 offset:18432
    v_fma_f32 v82, v82, s28, v12
    v_mfma_f32_16x16x32_bf16 v[148:151], a[224:227], v[14:17], v[148:151]
    v_exp_f32 v88, v88
    v_mfma_f32_16x16x32_bf16 v[196:199], a[224:227], v[20:23], v[196:199]
    v_exp_f32 v84, v84
    v_mfma_f32_16x16x32_bf16 v[192:195], a[220:223], v[20:23], v[192:195]
    v_exp_f32 v71, v71
    v_mfma_f32_16x16x32_bf16 v[240:243], a[220:223], v[26:29], v[240:243]
    s_waitcnt vmcnt(9) lgkmcnt(5)
    v_exp_f32 v85, v85
    v_mfma_f32_16x16x32_bf16 v[244:247], a[224:227], v[26:29], v[244:247]
    ds_read_b128 a[120:123], v104 offset:6144
    v_cvt_pk_bf16_f32 v42, v84, v85
    v_mfma_f32_16x16x32_bf16 a[36:39], a[224:227], v[32:35], a[36:39]
    s_add_u32 s21, s21, s62
    ds_read_b128 a[176:179], v104 offset:20480
    v_cvt_pk_bf16_f32 v30, v68, v69
    v_mfma_f32_16x16x32_bf16 a[32:35], a[220:223], v[32:35], a[32:35]
    s_barrier
    v_mfma_f32_16x16x32_bf16 a[80:83], a[220:223], v[38:41], a[80:83]
    s_add_u32 m0, s22, 24576
    v_exp_f32 v65, v65
    v_mfma_f32_16x16x32_bf16 a[84:87], a[224:227], v[38:41], a[84:87]
    ds_read_b128 a[212:215], v0 offset:0
    buffer_load_dwordx4 v6, s[8:11], s21 offen lds
    v_mfma_f32_16x16x32_bf16 a[88:91], a[228:231], v[38:41], a[88:91]
    v_exp_f32 v70, v70
    v_mfma_f32_16x16x32_bf16 a[92:95], a[232:235], v[38:41], a[92:95]
    ds_read_b128 a[128:131], v104 offset:8192
    v_fma_f32 v66, v66, s28, v10
    v_mfma_f32_16x16x32_bf16 a[44:47], a[232:235], v[32:35], a[44:47]
    s_add_u32 s21, s21, 128
    ds_read_b128 a[220:223], v0 offset:1024
    v_fma_f32 v67, v67, s28, v10
    v_mfma_f32_16x16x32_bf16 a[40:43], a[228:231], v[32:35], a[40:43]
    s_add_u32 m0, s22, 25600
    ds_read_b128 a[124:127], v105 offset:6144
    buffer_load_dwordx4 v6, s[8:11], s21 offen lds
    v_mfma_f32_16x16x32_bf16 v[248:251], a[228:231], v[26:29], v[248:251]
    ds_read_b128 a[216:219], v1 offset:0
    v_fma_f32 v83, v83, s28, v12
    v_mfma_f32_16x16x32_bf16 v[252:255], a[232:235], v[26:29], v[252:255]
    s_add_u32 s21, s21, 128
    ds_read_b128 a[172:175], v105 offset:18432
    v_fma_f32 v89, v89, s28, v13
    v_mfma_f32_16x16x32_bf16 v[204:207], a[232:235], v[20:23], v[204:207]
    ds_read_b128 a[196:199], v105 offset:24576
    v_cvt_pk_bf16_f32 v36, v76, v77
    v_mfma_f32_16x16x32_bf16 v[200:203], a[228:231], v[20:23], v[200:203]
    s_add_u32 m0, s22, 26624
    ds_read_b128 a[152:155], v104 offset:14336
    buffer_load_dwordx4 v6, s[8:11], s21 offen lds
    v_mfma_f32_16x16x32_bf16 v[152:155], a[228:231], v[14:17], v[152:155]
    v_exp_f32 v56, v56
    v_mfma_f32_16x16x32_bf16 v[156:159], a[232:235], v[14:17], v[156:159]
    s_waitcnt lgkmcnt(7)
    ds_read_b128 a[156:159], v105 offset:14336
    v_cvt_pk_bf16_f32 v31, v70, v71
    v_mfma_f32_16x16x32_bf16 v[52:55], a[212:215], a[96:99], 0
    ds_read_b128 a[108:111], v105 offset:2048
    v_fma_f32 v91, v91, s28, v13
    v_mfma_f32_16x16x32_bf16 v[60:63], a[212:215], a[120:123], 0
    v_exp_f32 v80, v80
    v_mfma_f32_16x16x32_bf16 v[68:71], a[212:215], a[144:147], 0
    v_exp_f32 v64, v64
    v_mfma_f32_16x16x32_bf16 v[76:79], a[212:215], a[168:171], 0
    ds_read_b128 a[228:231], v0 offset:6144
    v_cvt_pk_bf16_f32 v22, v64, v65
    v_mfma_f32_16x16x32_bf16 v[84:87], a[212:215], a[192:195], 0
    s_waitcnt lgkmcnt(6)
    ds_read_b128 a[224:227], v1 offset:1024
    v_exp_f32 v82, v82
    v_mfma_f32_16x16x32_bf16 v[52:55], a[216:219], a[100:103], v[52:55]
    v_exp_f32 v73, v73
    v_mfma_f32_16x16x32_bf16 v[60:63], a[216:219], a[124:127], v[60:63]
    ds_read_b128 a[204:207], v105 offset:26624
    v_cvt_pk_bf16_f32 v34, v80, v81
    v_mfma_f32_16x16x32_bf16 v[68:71], a[216:219], a[148:151], v[68:71]
    s_waitcnt lgkmcnt(5)
    v_exp_f32 v57, v57
    v_mfma_f32_16x16x32_bf16 v[76:79], a[216:219], a[172:175], v[76:79]
    v_exp_f32 v83, v83
    v_mfma_f32_16x16x32_bf16 v[84:87], a[216:219], a[196:199], v[84:87]
    v_exp_f32 v90, v90
    v_mfma_f32_16x16x32_bf16 v[52:55], a[220:223], a[104:107], v[52:55]
    v_exp_f32 v66, v66
    v_mfma_f32_16x16x32_bf16 v[60:63], a[220:223], a[128:131], v[60:63]
    v_exp_f32 v59, v59
    v_mfma_f32_16x16x32_bf16 v[68:71], a[220:223], a[152:155], v[68:71]
    v_exp_f32 v58, v58
    v_mfma_f32_16x16x32_bf16 v[76:79], a[220:223], a[176:179], v[76:79]
    v_exp_f32 v89, v89
    v_mfma_f32_16x16x32_bf16 v[84:87], a[220:223], a[200:203], v[84:87]
    s_waitcnt lgkmcnt(1)
    v_exp_f32 v67, v67
    v_mfma_f32_16x16x32_bf16 v[52:55], a[224:227], a[108:111], v[52:55]
    v_cvt_pk_bf16_f32 v17, v58, v59
    v_cvt_pk_bf16_f32 v16, v56, v57
    v_mfma_f32_16x16x32_bf16 v[60:63], a[224:227], a[132:135], v[60:63]
    ds_read_b128 a[232:235], v1 offset:6144
    v_cvt_pk_bf16_f32 v23, v66, v67
    v_mfma_f32_16x16x32_bf16 v[68:71], a[224:227], a[156:159], v[68:71]
    v_cvt_pk_bf16_f32 v29, v74, v75
    v_cvt_pk_bf16_f32 v35, v82, v83
    v_mfma_f32_16x16x32_bf16 v[76:79], a[224:227], a[180:183], v[76:79]
    s_waitcnt lgkmcnt(1)
    v_mfma_f32_16x16x32_bf16 v[84:87], a[224:227], a[204:207], v[84:87]
    ds_read_b128 a[216:219], v1 offset:7168
    v_mfma_f32_16x16x32_bf16 v[56:59], a[228:231], a[96:99], 0
    v_exp_f32 v72, v72
    v_mfma_f32_16x16x32_bf16 v[48:51], a[236:239], v[16:19], v[44:47]
    ds_read_b128 a[112:115], v104 offset:4096
    v_cvt_pk_bf16_f32 v40, v88, v89
    v_mfma_f32_16x16x32_bf16 v[48:51], a[240:243], v[22:25], v[48:51]
    ds_read_b128 a[212:215], v0 offset:7168
    v_cvt_pk_bf16_f32 v28, v72, v73
    v_mfma_f32_16x16x32_bf16 v[64:67], a[228:231], a[120:123], 0
    v_exp_f32 v91, v91
    v_mfma_f32_16x16x32_bf16 v[72:75], a[228:231], a[144:147], 0
    ds_read_b128 a[184:187], v104 offset:22528
    v_mfma_f32_16x16x32_bf16 v[80:83], a[228:231], a[168:171], 0
    ds_read_b128 a[136:139], v104 offset:10240
    v_cvt_pk_bf16_f32 v41, v90, v91
    v_mfma_f32_16x16x32_bf16 v[88:91], a[228:231], a[192:195], 0
    s_waitcnt lgkmcnt(5)
    ds_read_b128 a[224:227], v1 offset:2048
    v_mfma_f32_16x16x32_bf16 v[56:59], a[232:235], a[100:103], v[56:59]
    v_mfma_f32_16x16x32_bf16 v[64:67], a[232:235], a[124:127], v[64:67]
    ds_read_b128 a[220:223], v0 offset:2048
    v_mfma_f32_16x16x32_bf16 v[72:75], a[232:235], a[148:151], v[72:75]
    ds_read_b128 a[140:143], v105 offset:10240
    v_mfma_f32_16x16x32_bf16 v[80:83], a[232:235], a[172:175], v[80:83]
    ds_read_b128 a[228:231], v0 offset:8192
    v_mfma_f32_16x16x32_bf16 v[88:91], a[232:235], a[196:199], v[88:91]
    ds_read_b128 a[232:235], v1 offset:8192
    v_mfma_f32_16x16x32_bf16 v[48:51], a[244:247], v[28:31], v[48:51]
    ds_read_b128 a[160:163], v104 offset:16384
    v_mfma_f32_16x16x32_bf16 v[48:51], a[248:251], v[34:37], v[48:51]
    ds_read_b128 a[164:167], v105 offset:16384
    v_mfma_f32_16x16x32_bf16 v[48:51], a[252:255], v[40:43], v[48:51]
    s_waitcnt lgkmcnt(8)
    ds_read_b128 a[116:119], v105 offset:4096
    s_add_u32 s21, s21, 12032
    v_mfma_f32_16x16x32_bf16 v[56:59], a[212:215], a[104:107], v[56:59]
    ds_read_b128 a[188:191], v105 offset:22528
    v_mfma_f32_16x16x32_bf16 v[64:67], a[212:215], a[128:131], v[64:67]
    s_nop 1
    v_cmp_lt_f32 vcc, s29, v48
    v_mfma_f32_16x16x32_bf16 v[72:75], a[212:215], a[152:155], v[72:75]
    s_waitcnt vmcnt(3)
    v_mfma_f32_16x16x32_bf16 v[80:83], a[212:215], a[176:179], v[80:83]
    v_mfma_f32_16x16x32_bf16 v[88:91], a[212:215], a[200:203], v[88:91]
    s_nop 0
    s_cbranch_vccnz L_rs_tr55b
L_ret_tr55b:
    v_mfma_f32_16x16x32_bf16 v[56:59], a[216:219], a[108:111], v[56:59]
    v_lshrrev_b32 v108, 11, v0
    s_waitcnt vmcnt(8) lgkmcnt(4)
    v_mfma_f32_16x16x32_bf16 v[64:67], a[216:219], a[132:135], v[64:67]
    s_barrier
    v_mfma_f32_16x16x32_bf16 v[72:75], a[216:219], a[156:159], v[72:75]
    v_and_b32 v101, 0x3ff, v0
    s_add_u32 m0, s22, 0
    v_mfma_f32_16x16x32_bf16 v[80:83], a[216:219], a[180:183], v[80:83]
    buffer_load_dwordx4 v6, s[4:7], s20 offen lds
    v_mfma_f32_16x16x32_bf16 v[88:91], a[216:219], a[204:207], v[88:91]
    ds_read_b64_tr_b16 a[212:213], v2 offset:18432
    v_mfma_f32_16x16x32_bf16 v[52:55], a[220:223], a[112:115], v[52:55]
    s_add_u32 s20, s20, 128
    v_xor_b32 v108, s65, v108
    v_mfma_f32_16x16x32_bf16 v[60:63], a[220:223], a[136:139], v[60:63]
    s_add_u32 m0, s22, 1024
    ds_read_b64_tr_b16 a[214:215], v2 offset:12288
    s_waitcnt lgkmcnt(2)
    v_mfma_f32_16x16x32_bf16 v[68:71], a[220:223], a[160:163], v[68:71]
    buffer_load_dwordx4 v6, s[4:7], s20 offen lds
    v_mfma_f32_16x16x32_bf16 v[76:79], a[220:223], a[184:187], v[76:79]
    s_add_u32 s20, s20, 128
    ds_read_b64_tr_b16 a[216:217], v3 offset:18432
    s_add_u32 m0, s22, 2048
    v_mfma_f32_16x16x32_bf16 v[84:87], a[220:223], a[208:211], v[84:87]
    buffer_load_dwordx4 v6, s[4:7], s20 offen lds
    v_mfma_f32_16x16x32_bf16 v[52:55], a[224:227], a[116:119], v[52:55]
    v_lshl_add_u32 v101, v108, 10, v101
    v_mov_b32 v100, v48
    v_mfma_f32_16x16x32_bf16 v[60:63], a[224:227], a[140:143], v[60:63]
    ds_read_b64_tr_b16 a[218:219], v3 offset:12288
    v_mbcnt_lo_u32_b32 v108, -1, 0
    v_mfma_f32_16x16x32_bf16 v[68:71], a[224:227], a[164:167], v[68:71]
    v_rcp_f32 v102, v49
    v_mfma_f32_16x16x32_bf16 v[76:79], a[224:227], a[188:191], v[76:79]
    ds_read_b64_tr_b16 a[220:221], v4 offset:18432
    v_add_u32 v101, s38, v101
    v_mfma_f32_16x16x32_bf16 v[84:87], a[224:227], v[92:95], v[84:87]
    v_rcp_f32 v8, v51
    v_mfma_f32_16x16x32_bf16 v[56:59], a[228:231], a[112:115], v[56:59]
    v_mbcnt_hi_u32_b32 v108, -1, v108
    v_lshrrev_b32 v108, 1, v108
    v_mfma_f32_16x16x32_bf16 v[64:67], a[228:231], a[136:139], v[64:67]
    v_permlane32_swap_b32 v48, v100
    v_mfma_f32_16x16x32_bf16 v[72:75], a[228:231], a[160:163], v[72:75]
    v_and_b32 v108, 24, v108
    v_bfe_u32 v108, s66, v108, 8
    v_mfma_f32_16x16x32_bf16 v[80:83], a[228:231], a[184:187], v[80:83]
    ds_read_b64_tr_b16 a[222:223], v4 offset:12288
    v_mfma_f32_16x16x32_bf16 v[88:91], a[228:231], a[208:211], v[88:91]
    v_rcp_f32 v48, v48
    v_mfma_f32_16x16x32_bf16 v[56:59], a[232:235], a[116:119], v[56:59]
    ds_read_b64_tr_b16 a[224:225], v5 offset:18432
    v_xor_b32 v101, v101, v108
    v_mfma_f32_16x16x32_bf16 v[64:67], a[232:235], a[140:143], v[64:67]
    s_add_u32 s20, s20, 12032
    ds_read_b64_tr_b16 a[226:227], v5 offset:12288
    v_mov_b32 v108, v100
    v_mfma_f32_16x16x32_bf16 v[72:75], a[232:235], a[164:167], v[72:75]
    s_nop 0
    v_permlane16_swap_b32 v100, v108
    v_mfma_f32_16x16x32_bf16 v[80:83], a[232:235], a[188:191], v[80:83]
    v_rcp_f32 v50, v50
    v_mfma_f32_16x16x32_bf16 v[88:91], a[232:235], v[92:95], v[88:91]
    v_rcp_f32 v100, v100
    s_waitcnt lgkmcnt(4)
    v_mfma_f32_16x16x32_bf16 v[112:115], a[212:215], v[16:19], v[112:115]
    s_mov_b32 s67, s34
    v_max3_f32 v96, v52, v53, v54
    v_max3_f32 v98, v60, v61, v62
    v_max3_f32 v98, v98, v63, v64
    v_max3_f32 v96, v96, v55, v56
    v_max3_f32 v96, v96, v57, v58
    v_max_f32 v96, v96, v59
    v_max3_f32 v98, v98, v65, v66
    v_max_f32 v98, v98, v67
    v_mov_b32 v97, v96
    v_mfma_f32_16x16x32_bf16 v[116:119], a[216:219], v[16:19], v[116:119]
    s_add_u32 s18, s34, 30720
    v_permlane32_swap_b32 v97, v96
    v_mfma_f32_16x16x32_bf16 v[164:167], a[216:219], v[22:25], v[164:167]
    v_max_f32 v96, v96, v97
    v_mov_b32 v99, v98
    v_mov_b32 v97, v96
    v_mfma_f32_16x16x32_bf16 v[160:163], a[212:215], v[22:25], v[160:163]
    s_nop 0
    v_permlane16_swap_b32 v97, v96
    v_mfma_f32_16x16x32_bf16 v[208:211], a[212:215], v[28:31], v[208:211]
    s_mov_b32 s34, s33
    ds_read_b64_tr_b16 a[232:233], v3 offset:19456
    v_max_f32 v96, v96, v97
    v_mul_f32_e64 v9, -s28, v96
    v_permlane32_swap_b32 v99, v98
    v_max3_f32 v96, v68, v69, v70
    v_mfma_f32_16x16x32_bf16 v[212:215], a[216:219], v[28:31], v[212:215]
    ds_read_b64_tr_b16 a[228:229], v2 offset:19456
    v_max3_f32 v96, v96, v71, v72
    v_max_f32 v98, v98, v99
    v_mfma_f32_16x16x32_bf16 a[4:7], a[216:219], v[34:37], a[4:7]
    s_add_u32 s64, s64, s62
    v_max3_f32 v96, v96, v73, v74
    v_fma_f32 v52, v52, s28, v9
    v_max_f32 v96, v96, v75
    v_mfma_f32_16x16x32_bf16 a[0:3], a[212:215], v[34:37], a[0:3]
    v_mov_b32 v97, v96
    v_mov_b32 v99, v98
    v_mfma_f32_16x16x32_bf16 a[48:51], a[212:215], v[40:43], a[48:51]
    s_add_u32 s64, s64, 196608
    v_permlane32_swap_b32 v97, v96
    v_mfma_f32_16x16x32_bf16 a[52:55], a[216:219], v[40:43], a[52:55]
    s_waitcnt lgkmcnt(2)
    ds_read_b64_tr_b16 a[230:231], v2 offset:13312
    v_permlane16_swap_b32 v99, v98
    v_mfma_f32_16x16x32_bf16 a[56:59], a[220:223], v[40:43], a[56:59]
    s_mov_b32 s39, s64
    ds_read_b64_tr_b16 a[234:235], v3 offset:13312
    v_max_f32 v98, v98, v99
    v_max_f32 v96, v96, v97
    v_mfma_f32_16x16x32_bf16 a[60:63], a[224:227], v[40:43], a[60:63]
    s_add_u32 s37, s37, 1
    v_mul_f32_e64 v10, -s28, v98
    v_mov_b32 v97, v96
    v_max3_f32 v98, v76, v77, v78
    v_max3_f32 v98, v98, v79, v80
    v_permlane16_swap_b32 v97, v96
    v_mfma_f32_16x16x32_bf16 a[12:15], a[224:227], v[34:37], a[12:15]
    v_fma_f32 v54, v54, s28, v9
    v_max_f32 v96, v96, v97
    v_mfma_f32_16x16x32_bf16 a[8:11], a[220:223], v[34:37], a[8:11]
    v_exp_f32 v52, v52
    v_mfma_f32_16x16x32_bf16 v[216:219], a[220:223], v[28:31], v[216:219]
    s_bitcmp1_b32 s63, s37
    ds_read_b64_tr_b16 a[212:213], v4 offset:19456
    v_fma_f32 v57, v57, s28, v9
    v_mfma_f32_16x16x32_bf16 v[220:223], a[224:227], v[28:31], v[220:223]
    s_cselect_b32 s62, 4294770688, 0
    v_mul_f32_e64 v11, -s28, v96
    v_max3_f32 v98, v98, v81, v82
    v_mfma_f32_16x16x32_bf16 v[172:175], a[224:227], v[22:25], v[172:175]
    s_cselect_b32 s42, 0, 325632
    ds_read_b64_tr_b16 a[218:219], v5 offset:13312
    v_max3_f32 v96, v84, v85, v86
    v_mfma_f32_16x16x32_bf16 v[168:171], a[220:223], v[22:25], v[168:171]
    s_add_u32 s35, s35, s42
    v_fma_f32 v75, v75, s28, v11
    v_max3_f32 v96, v96, v87, v88
    v_mfma_f32_16x16x32_bf16 v[120:123], a[220:223], v[16:19], v[120:123]
    s_lshl_b32 s42, s37, 1
    v_max_f32 v98, v98, v83
    v_mov_b32 v99, v98
    v_mfma_f32_16x16x32_bf16 v[124:127], a[224:227], v[16:19], v[124:127]
    s_waitcnt lgkmcnt(2)
    ds_read_b64_tr_b16 a[216:217], v5 offset:19456
    v_max3_f32 v96, v96, v89, v90
    v_mfma_f32_16x16x32_bf16 v[128:131], a[228:231], v[16:19], v[128:131]
    s_lshr_b32 s42, s31, s42
    ds_read_b64_tr_b16 a[214:215], v4 offset:13312
    v_fma_f32 v64, v64, s28, v10
    v_mfma_f32_16x16x32_bf16 v[132:135], a[232:235], v[16:19], v[132:135]
    s_and_b32 s42, s42, 3
    v_permlane32_swap_b32 v99, v98
    v_mfma_f32_16x16x32_bf16 v[180:183], a[232:235], v[22:25], v[180:183]
    s_add_u32 s42, s42, s36
    v_max_f32 v98, v98, v99
    v_fma_f32 v61, v61, s28, v10
    v_fma_f32 v53, v53, s28, v9
    v_mfma_f32_16x16x32_bf16 v[176:179], a[228:231], v[22:25], v[176:179]
    s_sub_u32 s43, s42, 3
    ds_read_b64_tr_b16 a[226:227], v3 offset:14336
    v_mov_b32 v99, v98
    v_mfma_f32_16x16x32_bf16 v[224:227], a[228:231], v[28:31], v[224:227]
    s_cmp_ge_u32 s42, 3
    ds_read_b64_tr_b16 a[220:221], v2 offset:20480
    v_fma_f32 v62, v62, s28, v10
    v_mfma_f32_16x16x32_bf16 v[228:231], a[232:235], v[28:31], v[228:231]
    ds_read_b64_tr_b16 a[224:225], v3 offset:20480
    v_max_f32 v96, v96, v91
    v_mfma_f32_16x16x32_bf16 a[20:23], a[232:235], v[34:37], a[20:23]
    s_cselect_b32 s42, s43, s42
    v_fma_f32 v59, v59, s28, v9
    v_exp_f32 v59, v59
    v_mfma_f32_16x16x32_bf16 a[16:19], a[228:231], v[34:37], a[16:19]
    s_mul_i32 s44, s3, 5
    v_exp_f32 v64, v64
    v_accvgpr_read_b32 v104, a0
    v_mfma_f32_16x16x32_bf16 a[64:67], a[228:231], v[40:43], a[64:67]
    s_mov_b32 s32, 1
    v_accvgpr_read_b32 v107, a3
    v_mov_b32 v97, v96
    v_mfma_f32_16x16x32_bf16 a[68:71], a[232:235], v[40:43], a[68:71]
    s_waitcnt lgkmcnt(3)
    ds_read_b64_tr_b16 a[222:223], v2 offset:14336
    v_fma_f32 v60, v60, s28, v10
    v_mfma_f32_16x16x32_bf16 a[72:75], a[212:215], v[40:43], a[72:75]
    s_lshl_b32 s43, s3, 2
    v_fma_f32 v66, v66, s28, v10
    v_fma_f32 v55, v55, s28, v9
    v_mfma_f32_16x16x32_bf16 a[76:79], a[216:219], v[40:43], a[76:79]
    s_add_u32 s45, s43, 21
    v_permlane16_swap_b32 v99, v98
    v_mfma_f32_16x16x32_bf16 a[28:31], a[216:219], v[34:37], a[28:31]
    s_cmp_eq_u32 s3, 0
    v_exp_f32 v53, v53
    v_mfma_f32_16x16x32_bf16 a[24:27], a[212:215], v[34:37], a[24:27]
    s_cselect_b32 s45, 20, s45
    v_fma_f32 v70, v70, s28, v11
    v_max_f32 v98, v98, v99
    v_mfma_f32_16x16x32_bf16 v[232:235], a[212:215], v[28:31], v[232:235]
    s_cselect_b32 s33, 1, 0
    ds_read_b64_tr_b16 a[230:231], v4 offset:14336
    v_fma_f32 v69, v69, s28, v11
    v_mfma_f32_16x16x32_bf16 v[236:239], a[216:219], v[28:31], v[236:239]
    s_cmp_eq_u32 s42, 1
    v_mul_f32_e64 v12, -s28, v98
    v_fma_f32 v79, v79, s28, v12
    v_permlane32_swap_b32 v97, v96
    v_max_f32 v96, v96, v97
    s_cselect_b32 s44, s45, s44
    v_fma_f32 v74, v74, s28, v11
    v_fma_f32 v71, v71, s28, v11
    v_fma_f32 v68, v68, s28, v11
    v_mfma_f32_16x16x32_bf16 v[188:191], a[216:219], v[22:25], v[188:191]
    s_cselect_b32 s32, s33, s32
    v_exp_f32 v57, v57
    v_mfma_f32_16x16x32_bf16 v[184:187], a[212:215], v[22:25], v[184:187]
    s_add_u32 s45, s43, 37
    v_fma_f32 v82, v82, s28, v12
    v_fma_f32 v76, v76, s28, v12
    v_mfma_f32_16x16x32_bf16 v[136:139], a[212:215], v[16:19], v[136:139]
    s_cmp_eq_u32 s42, 2
    s_cselect_b32 s44, s45, s44
    ds_read_b64_tr_b16 a[234:235], v5 offset:14336
    v_mfma_f32_16x16x32_bf16 v[140:143], a[216:219], v[16:19], v[140:143]
    s_waitcnt lgkmcnt(2)
    ds_read_b64_tr_b16 a[232:233], v5 offset:20480
    v_exp_f32 v68, v68
    v_mfma_f32_16x16x32_bf16 v[144:147], a[220:223], v[16:19], v[144:147]
    s_cselect_b32 s32, 0, s32
    v_mov_b32 v97, v96
    v_exp_f32 v54, v54
    v_mfma_f32_16x16x32_bf16 v[148:151], a[224:227], v[16:19], v[148:151]
    s_mul_i32 s44, s44, 6144
    ds_read_b64_tr_b16 a[228:229], v4 offset:20480
    v_fma_f32 v83, v83, s28, v12
    v_mfma_f32_16x16x32_bf16 v[196:199], a[224:227], v[22:25], v[196:199]
    s_add_u32 s33, s35, s44
    v_exp_f32 v71, v71
    v_exp_f32 v61, v61
    v_permlane16_swap_b32 v97, v96
    v_max_f32 v96, v96, v97
    v_mfma_f32_16x16x32_bf16 v[192:195], a[220:223], v[22:25], v[192:195]
    s_mul_i32 s42, s32, 6144
    v_exp_f32 v70, v70
    v_exp_f32 v55, v55
    v_fma_f32 v58, v58, s28, v9
    v_pk_mul_f32 v[112:113], v[112:113], v[48:49] op_sel_hi:[1,0]
    s_add_u32 s42, s42, 24576
    v_mul_f32_e64 v13, -s28, v96
    s_add_u32 s42, s42, s33
    v_mfma_f32_16x16x32_bf16 v[240:243], a[220:223], v[28:31], v[240:243]
    s_cmp_ge_u32 s37, 6
    v_exp_f32 v60, v60
    v_fma_f32 v84, v84, s28, v13
    v_mfma_f32_16x16x32_bf16 v[244:247], a[224:227], v[28:31], v[244:247]
    s_cselect_b32 s14, 0, s42
    v_fma_f32 v77, v77, s28, v12
    v_cvt_pk_bf16_f32 v15, v54, v55
    v_mfma_f32_16x16x32_bf16 a[36:39], a[224:227], v[34:37], a[36:39]
    s_add_u32 s24, s67, 256
    v_cvt_pk_bf16_f32 v20, v60, v61
    s_add_u32 s25, s33, 256
    v_mfma_f32_16x16x32_bf16 a[32:35], a[220:223], v[34:37], a[32:35]
    s_add_u32 s23, s38, 4096
    s_mov_b32 s27, 0x249
    v_fma_f32 v78, v78, s28, v12
    v_exp_f32 v79, v79
    v_mfma_f32_16x16x32_bf16 a[80:83], a[220:223], v[40:43], a[80:83]
    s_mov_b32 s30, 0
    v_exp_f32 v62, v62
    v_mfma_f32_16x16x32_bf16 a[84:87], a[224:227], v[40:43], a[84:87]
    s_waitcnt vmcnt(8) lgkmcnt(0)
    v_fma_f32 v85, v85, s28, v13
    v_fma_f32 v81, v81, s28, v12
    v_mfma_f32_16x16x32_bf16 a[88:91], a[228:231], v[40:43], a[88:91]
    s_barrier
    ds_read_b128 a[224:227], v1 offset:13312
    v_exp_f32 v83, v83
    v_fma_f32 v73, v73, s28, v11
    v_mfma_f32_16x16x32_bf16 a[92:95], a[232:235], v[40:43], a[92:95]
    ds_read_b128 a[212:215], v0 offset:12288
    v_cvt_pk_bf16_f32 v14, v52, v53
    v_mfma_f32_16x16x32_bf16 a[44:47], a[232:235], v[34:37], a[44:47]
    ds_read_b128 a[216:219], v1 offset:12288
    v_exp_f32 v84, v84
    v_mfma_f32_16x16x32_bf16 a[40:43], a[228:231], v[34:37], a[40:43]
    ds_read_b128 a[220:223], v0 offset:13312
    v_fma_f32 v65, v65, s28, v10
    v_mfma_f32_16x16x32_bf16 v[248:251], a[228:231], v[28:31], v[248:251]
    v_fma_f32 v91, v91, s28, v13
    v_exp_f32 v69, v69
    v_exp_f32 v76, v76
    v_pk_mul_f32 v[164:165], v[164:165], v[102:103] op_sel_hi:[1,0]
    v_pk_mul_f32 v[208:209], v[208:209], v[50:51] op_sel_hi:[1,0]
    v_fma_f32 v56, v56, s28, v9
    v_fma_f32 v63, v63, s28, v10
    v_mfma_f32_16x16x32_bf16 v[252:255], a[232:235], v[28:31], v[252:255]
    v_exp_f32 v77, v77
    v_mfma_f32_16x16x32_bf16 v[204:207], a[232:235], v[22:25], v[204:207]
    v_exp_f32 v78, v78
    v_mfma_f32_16x16x32_bf16 v[200:203], a[228:231], v[22:25], v[200:203]
    v_exp_f32 v63, v63
    v_accvgpr_read_b32 v110, a50
    v_fma_f32 v72, v72, s28, v11
    v_mfma_f32_16x16x32_bf16 v[152:155], a[228:231], v[16:19], v[152:155]
    v_exp_f32 v66, v66
    v_cvt_pk_bf16_f32 v27, v70, v71
    v_mfma_f32_16x16x32_bf16 v[156:159], a[232:235], v[16:19], v[156:159]
    s_waitcnt lgkmcnt(1)
    ds_read_b128 a[232:235], v1 offset:14336
    v_cvt_pk_bf16_f32 v21, v62, v63
    v_mfma_f32_16x16x32_bf16 v[52:55], a[212:215], a[96:99], 0
    v_exp_f32 v85, v85
    v_mfma_f32_16x16x32_bf16 v[52:55], a[216:219], a[100:103], v[52:55]
    s_waitcnt lgkmcnt(1)
    v_fma_f32 v86, v86, s28, v13
    v_subrev_u32 v103, 28672, v103
    v_mfma_f32_16x16x32_bf16 v[52:55], a[220:223], a[104:107], v[52:55]
    v_fma_f32 v87, v87, s28, v13
    v_fma_f32 v67, v67, s28, v10
    v_mfma_f32_16x16x32_bf16 v[60:63], a[220:223], a[128:131], 0
    v_exp_f32 v86, v86
    v_mfma_f32_16x16x32_bf16 v[60:63], a[216:219], a[124:127], v[60:63]
    v_fma_f32 v80, v80, s28, v12
    v_cvt_pk_bf16_f32 v33, v78, v79
    v_cvt_pk_bf16_f32 v26, v68, v69
    v_cvt_pk_bf16_f32 v38, v84, v85
    v_mfma_f32_16x16x32_bf16 v[60:63], a[212:215], a[120:123], v[60:63]
    ds_read_b128 a[228:231], v0 offset:14336
    v_exp_f32 v56, v56
    v_mfma_f32_16x16x32_bf16 v[68:71], a[212:215], a[144:147], 0
    v_exp_f32 v73, v73
    v_mfma_f32_16x16x32_bf16 v[68:71], a[216:219], a[148:151], v[68:71]
    v_exp_f32 v87, v87
    v_mfma_f32_16x16x32_bf16 v[68:71], a[220:223], a[152:155], v[68:71]
    v_cvt_pk_bf16_f32 v39, v86, v87
    v_cvt_pk_bf16_f32 v32, v76, v77
    v_mfma_f32_16x16x32_bf16 v[76:79], a[220:223], a[176:179], 0
    v_exp_f32 v75, v75
    v_mfma_f32_16x16x32_bf16 v[76:79], a[216:219], a[172:175], v[76:79]
    v_exp_f32 v91, v91
    v_mfma_f32_16x16x32_bf16 v[76:79], a[212:215], a[168:171], v[76:79]
    s_add_u32 m0, s22, 36864
    v_fma_f32 v89, v89, s28, v13
    v_exp_f32 v80, v80
    v_mfma_f32_16x16x32_bf16 v[84:87], a[212:215], a[192:195], 0
    v_exp_f32 v72, v72
    v_mfma_f32_16x16x32_bf16 v[84:87], a[216:219], a[196:199], v[84:87]
    v_exp_f32 v74, v74
    v_mfma_f32_16x16x32_bf16 v[84:87], a[220:223], a[200:203], v[84:87]
    v_exp_f32 v65, v65
    v_mfma_f32_16x16x32_bf16 v[84:87], a[224:227], a[204:207], v[84:87]
    s_waitcnt lgkmcnt(0)
    v_exp_f32 v82, v82
    v_mfma_f32_16x16x32_bf16 v[84:87], a[228:231], a[208:211], v[84:87]
    v_exp_f32 v81, v81
    v_mfma_f32_16x16x32_bf16 v[84:87], a[232:235], v[92:95], v[84:87]
    v_accvgpr_read_b32 v108, a48
    v_fma_f32 v88, v88, s28, v13
    v_mfma_f32_16x16x32_bf16 v[76:79], a[232:235], a[188:191], v[76:79]
    ds_read_b128 a[220:223], v0 offset:19456
    v_cvt_pk_bf16_f32 v34, v80, v81
    v_mfma_f32_16x16x32_bf16 v[76:79], a[228:231], a[184:187], v[76:79]
    ds_read_b128 a[212:215], v0 offset:18432
    buffer_load_dwordx4 v6, s[8:11], s21 offen lds
    v_mfma_f32_16x16x32_bf16 v[76:79], a[224:227], a[180:183], v[76:79]
    ds_read_b128 a[216:219], v1 offset:18432
    v_fma_f32 v90, v90, s28, v13
    v_mfma_f32_16x16x32_bf16 v[68:71], a[224:227], a[156:159], v[68:71]
    v_exp_f32 v58, v58
    v_mfma_f32_16x16x32_bf16 v[68:71], a[228:231], a[160:163], v[68:71]
    v_cvt_pk_bf16_f32 v29, v74, v75
    v_cvt_pk_bf16_f32 v17, v58, v59
    v_mfma_f32_16x16x32_bf16 v[68:71], a[232:235], a[164:167], v[68:71]
    v_exp_f32 v90, v90
    v_mfma_f32_16x16x32_bf16 v[60:63], a[232:235], a[140:143], v[60:63]
    v_cvt_pk_bf16_f32 v16, v56, v57
    v_accvgpr_read_b32 v105, a1
    v_mfma_f32_16x16x32_bf16 v[60:63], a[228:231], a[136:139], v[60:63]
    v_exp_f32 v67, v67
    v_mfma_f32_16x16x32_bf16 v[44:47], a[236:239], v[14:17], 0
    s_add_u32 s21, s21, 128
    v_exp_f32 v88, v88
    v_accvgpr_read_b32 v111, a51
    v_mfma_f32_16x16x32_bf16 v[60:63], a[224:227], a[132:135], v[60:63]
    v_fma_f32 v76, v76, s28, v12
    v_fma_f32 v70, v70, s28, v11
    v_mfma_f32_16x16x32_bf16 v[52:55], a[224:227], a[108:111], v[52:55]
    v_cvt_pk_bf16_f32 v35, v82, v83
    v_cvt_pk_bf16_f32 v23, v66, v67
    v_mfma_f32_16x16x32_bf16 v[52:55], a[228:231], a[112:115], v[52:55]
    v_exp_f32 v76, v76
    v_mfma_f32_16x16x32_bf16 v[52:55], a[232:235], a[116:119], v[52:55]
    s_waitcnt lgkmcnt(0)
    v_cvt_pk_bf16_f32 v164, v164, v165
    v_cvt_pk_bf16_f32 v22, v64, v65
    v_mfma_f32_16x16x32_bf16 v[56:59], a[212:215], a[96:99], 0
    v_fma_f32 v87, v87, s28, v13
    v_exp_f32 v89, v89
    v_fma_f32 v85, v85, s28, v13
    v_mfma_f32_16x16x32_bf16 v[56:59], a[216:219], a[100:103], v[56:59]
    s_add_u32 m0, s22, 37888
    v_fma_f32 v78, v78, s28, v12
    v_fma_f32 v69, v69, s28, v11
    v_mfma_f32_16x16x32_bf16 v[56:59], a[220:223], a[104:107], v[56:59]
    buffer_load_dwordx4 v6, s[8:11], s21 offen lds
    ds_read_b128 a[228:231], v0 offset:20480
    v_mfma_f32_16x16x32_bf16 v[64:67], a[220:223], a[128:131], 0
    ds_read_b128 a[232:235], v1 offset:20480
    v_cvt_pk_bf16_f32 v28, v72, v73
    v_mfma_f32_16x16x32_bf16 v[64:67], a[216:219], a[124:127], v[64:67]
    v_exp_f32 v78, v78
    v_mfma_f32_16x16x32_bf16 v[44:47], a[240:243], v[20:23], v[44:47]
    v_fma_f32 v61, v61, s28, v10
    v_accvgpr_read_b32 v106, a2
    v_mfma_f32_16x16x32_bf16 v[64:67], a[212:215], a[120:123], v[64:67]
    s_add_u32 s21, s21, 128
    v_accvgpr_read_b32 v109, a49
    v_fma_f32 v62, v62, s28, v10
    v_mfma_f32_16x16x32_bf16 v[72:75], a[212:215], a[144:147], 0
    v_cvt_pk_bf16_f32 v41, v90, v91
    v_fma_f32 v53, v53, s28, v9
    v_mfma_f32_16x16x32_bf16 v[72:75], a[216:219], a[148:151], v[72:75]
    s_add_u32 m0, s22, 38912
    v_fma_f32 v77, v77, s28, v12
    v_cvt_pk_bf16_f32 v112, v112, v113
    v_mfma_f32_16x16x32_bf16 v[72:75], a[220:223], a[152:155], v[72:75]
    ds_read_b128 a[224:227], v1 offset:19456
    v_cvt_pk_bf16_f32 v40, v88, v89
    v_mfma_f32_16x16x32_bf16 v[80:83], a[220:223], a[176:179], 0
    v_exp_f32 v69, v69
    v_mfma_f32_16x16x32_bf16 v[80:83], a[216:219], a[172:175], v[80:83]
    buffer_load_dwordx4 v6, s[8:11], s21 offen lds
    v_mfma_f32_16x16x32_bf16 v[80:83], a[212:215], a[168:171], v[80:83]
    s_add_u32 s21, s21, 12032
    v_exp_f32 v53, v53
    v_mfma_f32_16x16x32_bf16 v[88:91], a[212:215], a[192:195], 0
    v_fma_f32 v71, v71, s28, v11
    v_fma_f32 v68, v68, s28, v11
    v_cvt_pk_bf16_f32 v208, v208, v209
    v_exp_f32 v77, v77
    v_pk_mul_f32 v[108:109], v[108:109], v[100:101] op_sel_hi:[1,0]
    v_pk_mul_f32 v[188:189], v[188:189], v[102:103] op_sel_hi:[1,0]
    v_pk_mul_f32 v[238:239], v[238:239], v[50:51] op_sel_hi:[1,0]
    v_pk_mul_f32 v[114:115], v[114:115], v[48:49] op_sel_hi:[1,0]
    v_pk_mul_f32 v[172:173], v[172:173], v[102:103] op_sel_hi:[1,0]
    v_pk_mul_f32 v[204:205], v[204:205], v[102:103] op_sel_hi:[1,0]
    v_pk_mul_f32 v[128:129], v[128:129], v[48:49] op_sel_hi:[1,0]
    v_pk_mul_f32 v[120:121], v[120:121], v[48:49] op_sel_hi:[1,0]
    v_pk_mul_f32 v[160:161], v[160:161], v[102:103] op_sel_hi:[1,0]
    v_pk_mul_f32 v[180:181], v[180:181], v[102:103] op_sel_hi:[1,0]
    v_pk_mul_f32 v[210:211], v[210:211], v[50:51] op_sel_hi:[1,0]
    v_pk_mul_f32 v[196:197], v[196:197], v[102:103] op_sel_hi:[1,0]
    v_pk_mul_f32 v[184:185], v[184:185], v[102:103] op_sel_hi:[1,0]
    v_cvt_pk_bf16_f32 v113, v114, v115
    v_pk_mul_f32 v[216:217], v[216:217], v[50:51] op_sel_hi:[1,0]
    v_pk_mul_f32 v[162:163], v[162:163], v[102:103] op_sel_hi:[1,0]
    v_pk_mul_f32 v[230:231], v[230:231], v[50:51] op_sel_hi:[1,0]
    v_pk_mul_f32 v[104:105], v[104:105], v[8:9] op_sel_hi:[1,0]
    v_pk_mul_f32 v[228:229], v[228:229], v[50:51] op_sel_hi:[1,0]
    v_cvt_pk_bf16_f32 v160, v160, v161
    v_pk_mul_f32 v[224:225], v[224:225], v[50:51] op_sel_hi:[1,0]
    v_cvt_pk_bf16_f32 v196, v196, v197
    v_cvt_pk_bf16_f32 v161, v162, v163
    v_mfma_f32_16x16x32_bf16 v[88:91], a[216:219], a[196:199], v[88:91]
    s_waitcnt vmcnt(6) lgkmcnt(0)
    v_cvt_pk_bf16_f32 v209, v210, v211
    v_cvt_pk_bf16_f32 v228, v228, v229
    v_mfma_f32_16x16x32_bf16 v[88:91], a[220:223], a[200:203], v[88:91]
    s_barrier
    v_mfma_f32_16x16x32_bf16 v[88:91], a[224:227], a[204:207], v[88:91]
    v_cvt_pk_bf16_f32 v108, v108, v109
    v_exp_f32 v85, v85
    v_mfma_f32_16x16x32_bf16 v[88:91], a[228:231], a[208:211], v[88:91]
    ds_write2st64_b64 v101, v[112:113], v[160:161] offset0:0 offset1:12
    v_pk_mul_f32 v[226:227], v[226:227], v[50:51] op_sel_hi:[1,0]
    v_pk_mul_f32 v[220:221], v[220:221], v[50:51] op_sel_hi:[1,0]
    v_pk_mul_f32 v[170:171], v[170:171], v[102:103] op_sel_hi:[1,0]
    v_pk_mul_f32 v[126:127], v[126:127], v[48:49] op_sel_hi:[1,0]
    v_pk_mul_f32 v[214:215], v[214:215], v[50:51] op_sel_hi:[1,0]
    v_pk_mul_f32 v[144:145], v[144:145], v[48:49] op_sel_hi:[1,0]
    v_pk_mul_f32 v[140:141], v[140:141], v[48:49] op_sel_hi:[1,0]
    v_pk_mul_f32 v[212:213], v[212:213], v[50:51] op_sel_hi:[1,0]
    v_pk_mul_f32 v[192:193], v[192:193], v[102:103] op_sel_hi:[1,0]
    v_pk_mul_f32 v[218:219], v[218:219], v[50:51] op_sel_hi:[1,0]
    v_cvt_pk_bf16_f32 v104, v104, v105
    v_pk_mul_f32 v[176:177], v[176:177], v[102:103] op_sel_hi:[1,0]
    v_pk_mul_f32 v[246:247], v[246:247], v[50:51] op_sel_hi:[1,0]
    v_pk_mul_f32 v[110:111], v[110:111], v[100:101] op_sel_hi:[1,0]
    v_pk_mul_f32 v[186:187], v[186:187], v[102:103] op_sel_hi:[1,0]
    v_pk_mul_f32 v[166:167], v[166:167], v[102:103] op_sel_hi:[1,0]
    v_cvt_pk_bf16_f32 v120, v120, v121
    v_pk_mul_f32 v[236:237], v[236:237], v[50:51] op_sel_hi:[1,0]
    v_pk_mul_f32 v[122:123], v[122:123], v[48:49] op_sel_hi:[1,0]
    v_pk_mul_f32 v[118:119], v[118:119], v[48:49] op_sel_hi:[1,0]
    v_pk_mul_f32 v[232:233], v[232:233], v[50:51] op_sel_hi:[1,0]
    v_pk_mul_f32 v[248:249], v[248:249], v[50:51] op_sel_hi:[1,0]
    v_pk_mul_f32 v[174:175], v[174:175], v[102:103] op_sel_hi:[1,0]
    v_pk_mul_f32 v[244:245], v[244:245], v[50:51] op_sel_hi:[1,0]
    v_pk_mul_f32 v[242:243], v[242:243], v[50:51] op_sel_hi:[1,0]
    v_pk_mul_f32 v[152:153], v[152:153], v[48:49] op_sel_hi:[1,0]
    v_pk_mul_f32 v[106:107], v[106:107], v[8:9] op_sel_hi:[1,0]
    v_pk_mul_f32 v[132:133], v[132:133], v[48:49] op_sel_hi:[1,0]
    v_fma_f32 v60, v60, s28, v10
    v_pk_mul_f32 v[168:169], v[168:169], v[102:103] op_sel_hi:[1,0]
    v_pk_mul_f32 v[116:117], v[116:117], v[48:49] op_sel_hi:[1,0]
    v_cvt_pk_bf16_f32 v165, v166, v167
    v_cvt_pk_bf16_f32 v105, v106, v107
    v_mfma_f32_16x16x32_bf16 v[88:91], a[232:235], v[92:95], v[88:91]
    ds_read_b64_tr_b16 a[212:213], v2 offset:0
    v_cvt_pk_bf16_f32 v109, v110, v111
    v_mfma_f32_16x16x32_bf16 v[80:83], a[232:235], a[188:191], v[80:83]
    s_add_u32 m0, s22, 12288
    v_exp_f32 v87, v87
    v_accvgpr_read_b32 v110, a54
    v_mfma_f32_16x16x32_bf16 v[80:83], a[228:231], a[184:187], v[80:83]
    ds_write2st64_b64 v101, v[208:209], v[104:105] offset0:24 offset1:36
    v_accvgpr_read_b32 v111, a55
    v_mfma_f32_16x16x32_bf16 v[80:83], a[224:227], a[180:183], v[80:83]
    v_accvgpr_read_b32 v104, a4
    v_cvt_pk_bf16_f32 v116, v116, v117
    v_cvt_pk_bf16_f32 v188, v188, v189
    v_accvgpr_read_b32 v106, a6
    v_mfma_f32_16x16x32_bf16 v[72:75], a[224:227], a[156:159], v[72:75]
    v_accvgpr_read_b32 v105, a5
    v_accvgpr_read_b32 v107, a7
    v_mfma_f32_16x16x32_bf16 v[44:47], a[244:247], v[26:29], v[44:47]
    buffer_load_dwordx4 v6, s[4:7], s20 offen lds
    v_mfma_f32_16x16x32_bf16 v[72:75], a[228:231], a[160:163], v[72:75]
    ds_write_b64 v101, v[108:109] offset:24576
    v_cvt_pk_bf16_f32 v244, v244, v245
    v_mfma_f32_16x16x32_bf16 v[72:75], a[232:235], a[164:167], v[72:75]
    ds_read_b64_tr_b16 a[214:215], v2 offset:6144
    v_accvgpr_read_b32 v109, a53
    v_mfma_f32_16x16x32_bf16 v[64:67], a[232:235], a[140:143], v[64:67]
    ds_read_b64_tr_b16 a[216:217], v3 offset:0
    v_cvt_pk_bf16_f32 v168, v168, v169
    v_mfma_f32_16x16x32_bf16 v[64:67], a[228:231], a[136:139], v[64:67]
    s_add_u32 s20, s20, 128
    v_cvt_pk_bf16_f32 v128, v128, v129
    v_fma_f32 v54, v54, s28, v9
    v_fma_f32 v83, v83, s28, v12
    v_cvt_pk_bf16_f32 v212, v212, v213
    v_cvt_pk_bf16_f32 v172, v172, v173
    v_pk_mul_f32 v[104:105], v[104:105], v[8:9] op_sel_hi:[1,0]
    v_accvgpr_read_b32 v108, a52
    v_cvt_pk_bf16_f32 v169, v170, v171
    v_mfma_f32_16x16x32_bf16 v[64:67], a[224:227], a[132:135], v[64:67]
    ds_read_b64_tr_b16 a[218:219], v3 offset:6144
    v_fma_f32 v88, v88, s28, v13
    v_xor_b32 v101, 32, v101
    v_cvt_pk_bf16_f32 v184, v184, v185
    v_cvt_pk_bf16_f32 v216, v216, v217
    v_pk_mul_f32 v[148:149], v[148:149], v[48:49] op_sel_hi:[1,0]
    v_pk_mul_f32 v[240:241], v[240:241], v[50:51] op_sel_hi:[1,0]
    v_pk_mul_f32 v[110:111], v[110:111], v[100:101] op_sel_hi:[1,0]
    v_pk_mul_f32 v[136:137], v[136:137], v[48:49] op_sel_hi:[1,0]
    v_pk_mul_f32 v[108:109], v[108:109], v[100:101] op_sel_hi:[1,0]
    v_pk_mul_f32 v[124:125], v[124:125], v[48:49] op_sel_hi:[1,0]
    v_pk_mul_f32 v[178:179], v[178:179], v[102:103] op_sel_hi:[1,0]
    v_cvt_pk_bf16_f32 v176, v176, v177
    v_fma_f32 v80, v80, s28, v12
    v_pk_mul_f32 v[222:223], v[222:223], v[50:51] op_sel_hi:[1,0]
    v_pk_mul_f32 v[202:203], v[202:203], v[102:103] op_sel_hi:[1,0]
    v_pk_mul_f32 v[106:107], v[106:107], v[8:9] op_sel_hi:[1,0]
    v_cvt_pk_bf16_f32 v136, v136, v137
    v_pk_mul_f32 v[130:131], v[130:131], v[48:49] op_sel_hi:[1,0]
    v_cvt_pk_bf16_f32 v229, v230, v231
    v_exp_f32 v60, v60
    v_cvt_pk_bf16_f32 v108, v108, v109
    v_cvt_pk_bf16_f32 v248, v248, v249
    v_cvt_pk_bf16_f32 v117, v118, v119
    v_cvt_pk_bf16_f32 v104, v104, v105
    v_cvt_pk_bf16_f32 v213, v214, v215
    v_cvt_pk_bf16_f32 v36, v76, v77
    v_cvt_pk_bf16_f32 v224, v224, v225
    v_mfma_f32_16x16x32_bf16 v[56:59], a[224:227], a[108:111], v[56:59]
    ds_read_b64_tr_b16 a[220:221], v4 offset:0
    v_fma_f32 v52, v52, s28, v9
    v_mfma_f32_16x16x32_bf16 v[56:59], a[228:231], a[112:115], v[56:59]
    ds_write2st64_b64 v101, v[116:117], v[164:165] offset0:0 offset1:12
    v_mfma_f32_16x16x32_bf16 v[44:47], a[248:251], v[32:35], v[44:47]
    v_cvt_pk_bf16_f32 v124, v124, v125
    v_exp_f32 v71, v71
    v_cvt_pk_bf16_f32 v109, v110, v111
    v_cvt_pk_bf16_f32 v180, v180, v181
    v_cvt_pk_bf16_f32 v132, v132, v133
    v_mfma_f32_16x16x32_bf16 v[56:59], a[232:235], a[116:119], v[56:59]
    s_waitcnt lgkmcnt(2)
    ds_read_b64_tr_b16 a[234:235], v3 offset:7168
    v_cvt_pk_bf16_f32 v105, v106, v107
    v_mfma_f32_16x16x32_bf16 v[112:115], a[212:215], v[14:17], 0
    v_exp_f32 v61, v61
    v_accvgpr_read_b32 v107, a11
    v_mfma_f32_16x16x32_bf16 v[116:119], a[216:219], v[14:17], 0
    ds_read_b64_tr_b16 a[222:223], v4 offset:6144
    v_cvt_pk_bf16_f32 v121, v122, v123
    v_cvt_pk_bf16_f32 v245, v246, v247
    v_cvt_pk_bf16_f32 v217, v218, v219
    v_cvt_pk_bf16_f32 v220, v220, v221
    v_mfma_f32_16x16x32_bf16 v[164:167], a[216:219], v[20:23], 0
    ds_write2st64_b64 v101, v[212:213], v[104:105] offset0:24 offset1:36
    v_pk_mul_f32 v[150:151], v[150:151], v[48:49] op_sel_hi:[1,0]
    v_pk_mul_f32 v[198:199], v[198:199], v[102:103] op_sel_hi:[1,0]
    v_pk_mul_f32 v[134:135], v[134:135], v[48:49] op_sel_hi:[1,0]
    v_accvgpr_read_b32 v106, a10
    v_cvt_pk_bf16_f32 v225, v226, v227
    v_accvgpr_read_b32 v105, a9
    v_mfma_f32_16x16x32_bf16 v[44:47], a[252:255], v[38:41], v[44:47]
    s_add_u32 m0, s22, 13312
    ds_read_b64_tr_b16 a[224:225], v5 offset:0
    buffer_load_dwordx4 v6, s[4:7], s20 offen lds
    v_accvgpr_read_b32 v104, a8
    v_mfma_f32_16x16x32_bf16 v[160:163], a[212:215], v[20:23], 0
    ds_write_b64 v101, v[108:109] offset:24576
    v_accvgpr_read_b32 v108, a56
    v_xor_b32 v101, 96, v101
    v_fma_f32 v90, v90, s28, v13
    v_accvgpr_read_b32 v109, a57
    v_pk_mul_f32 v[104:105], v[104:105], v[8:9] op_sel_hi:[1,0]
    v_accvgpr_read_b32 v111, a59
    v_cvt_pk_bf16_f32 v125, v126, v127
    v_cvt_pk_bf16_f32 v24, v60, v61
    v_cvt_pk_bf16_f32 v144, v144, v145
    v_mfma_f32_16x16x32_bf16 v[208:211], a[212:215], v[26:29], 0
    s_add_u32 s20, s20, 128
    ds_read_b64_tr_b16 a[232:233], v3 offset:1024
    v_accvgpr_read_b32 v110, a58
    v_cvt_pk_bf16_f32 v221, v222, v223
    v_cvt_pk_bf16_f32 v173, v174, v175
    v_cvt_pk_bf16_f32 v104, v104, v105
    v_cvt_pk_bf16_f32 v240, v240, v241
    v_mfma_f32_16x16x32_bf16 v[212:215], a[216:219], v[26:29], 0
    ds_read_b64_tr_b16 a[226:227], v5 offset:6144
    v_cvt_pk_bf16_f32 v177, v178, v179
    v_exp_f32 v52, v52
    v_mfma_f32_16x16x32_bf16 a[4:7], a[216:219], v[32:35], 0
    ds_write2st64_b64 v101, v[120:121], v[168:169] offset0:0 offset1:12
    v_pk_mul_f32 v[252:253], v[252:253], v[50:51] op_sel_hi:[1,0]
    v_pk_mul_f32 v[146:147], v[146:147], v[48:49] op_sel_hi:[1,0]
    v_pk_mul_f32 v[108:109], v[108:109], v[100:101] op_sel_hi:[1,0]
    v_pk_mul_f32 v[106:107], v[106:107], v[8:9] op_sel_hi:[1,0]
    v_pk_mul_f32 v[110:111], v[110:111], v[100:101] op_sel_hi:[1,0]
    v_cvt_pk_bf16_f32 v108, v108, v109
    v_cvt_pk_bf16_f32 v133, v134, v135
    v_fma_f32 v72, v72, s28, v11
    v_cvt_pk_bf16_f32 v105, v106, v107
    v_cvt_pk_bf16_f32 v109, v110, v111
    v_mfma_f32_16x16x32_bf16 a[0:3], a[212:215], v[32:35], 0
    ds_write2st64_b64 v101, v[216:217], v[104:105] offset0:24 offset1:36
    v_pk_mul_f32 v[234:235], v[234:235], v[50:51] op_sel_hi:[1,0]
    v_accvgpr_read_b32 v107, a15
    v_pk_mul_f32 v[156:157], v[156:157], v[48:49] op_sel_hi:[1,0]
    v_fma_f32 v64, v64, s28, v10
    v_pk_mul_f32 v[154:155], v[154:155], v[48:49] op_sel_hi:[1,0]
    v_accvgpr_read_b32 v104, a12
    v_fma_f32 v63, v63, s28, v10
    v_accvgpr_read_b32 v110, a62
    v_mfma_f32_16x16x32_bf16 a[48:51], a[212:215], v[38:41], 0
    ds_read_b64_tr_b16 a[230:231], v2 offset:7168
    v_accvgpr_read_b32 v105, a13
    v_cvt_pk_bf16_f32 v148, v148, v149
    v_mfma_f32_16x16x32_bf16 a[52:55], a[216:219], v[38:41], 0
    s_waitcnt lgkmcnt(3)
    ds_read_b64_tr_b16 a[214:215], v4 offset:7168
    v_cvt_pk_bf16_f32 v252, v252, v253
    v_mfma_f32_16x16x32_bf16 a[56:59], a[220:223], v[38:41], 0
    ds_write_b64 v101, v[108:109] offset:24576
    v_fma_f32 v86, v86, s28, v13
    v_cvt_pk_bf16_f32 v145, v146, v147
    v_accvgpr_read_b32 v108, a60
    v_pk_mul_f32 v[104:105], v[104:105], v[8:9] op_sel_hi:[1,0]
    v_cvt_pk_bf16_f32 v152, v152, v153
    v_accvgpr_read_b32 v109, a61
    v_exp_f32 v54, v54
    v_fma_f32 v56, v56, s28, v9
    v_pk_mul_f32 v[138:139], v[138:139], v[48:49] op_sel_hi:[1,0]
    v_cvt_pk_bf16_f32 v241, v242, v243
    v_exp_f32 v68, v68
    v_accvgpr_read_b32 v106, a14
    v_accvgpr_read_b32 v111, a63
    v_xor_b32 v101, 32, v101
    v_mfma_f32_16x16x32_bf16 a[60:63], a[224:227], v[38:41], 0
    s_add_u32 m0, s22, 14336
    ds_write2st64_b64 v101, v[124:125], v[172:173] offset0:0 offset1:12
    v_cvt_pk_bf16_f32 v104, v104, v105
    v_fma_f32 v58, v58, s28, v9
    v_pk_mul_f32 v[110:111], v[110:111], v[100:101] op_sel_hi:[1,0]
    v_pk_mul_f32 v[108:109], v[108:109], v[100:101] op_sel_hi:[1,0]
    v_cvt_pk_bf16_f32 v192, v192, v193
    v_pk_mul_f32 v[142:143], v[142:143], v[48:49] op_sel_hi:[1,0]
    v_cvt_pk_bf16_f32 v153, v154, v155
    v_pk_mul_f32 v[106:107], v[106:107], v[8:9] op_sel_hi:[1,0]
    v_pk_mul_f32 v[200:201], v[200:201], v[102:103] op_sel_hi:[1,0]
    v_cvt_pk_bf16_f32 v105, v106, v107
    v_cvt_pk_bf16_f32 v108, v108, v109
    v_cvt_pk_bf16_f32 v232, v232, v233
    v_cvt_pk_bf16_f32 v109, v110, v111
    v_pk_mul_f32 v[182:183], v[182:183], v[102:103] op_sel_hi:[1,0]
    v_cvt_pk_bf16_f32 v137, v138, v139
    v_cvt_pk_bf16_f32 v129, v130, v131
    v_mfma_f32_16x16x32_bf16 a[12:15], a[224:227], v[32:35], 0
    ds_write2st64_b64 v101, v[220:221], v[104:105] offset0:24 offset1:36
    v_cvt_pk_bf16_f32 v181, v182, v183
    v_cvt_pk_bf16_f32 v156, v156, v157
    v_mfma_f32_16x16x32_bf16 a[8:11], a[220:223], v[32:35], 0
    ds_read_b64_tr_b16 a[228:229], v2 offset:1024
    v_exp_f32 v86, v86
    v_mfma_f32_16x16x32_bf16 v[216:219], a[220:223], v[26:29], 0
    ds_read_b128 v[96:99], v103 offset:0
    v_accvgpr_read_b32 v107, a19
    v_accvgpr_read_b32 v104, a16
    v_accvgpr_read_b32 v110, a66
    v_accvgpr_read_b32 v105, a17
    v_mfma_f32_16x16x32_bf16 v[220:223], a[224:227], v[26:29], 0
    ds_write_b64 v101, v[108:109] offset:24576
    v_fma_f32 v82, v82, s28, v12
    v_mfma_f32_16x16x32_bf16 v[172:175], a[224:227], v[20:23], 0
    ds_read_b64_tr_b16 a[212:213], v4 offset:1024
    buffer_load_dwordx4 v6, s[4:7], s20 offen lds
    v_accvgpr_read_b32 v109, a65
    v_accvgpr_read_b32 v111, a67
    v_fma_f32 v84, v84, s28, v13
    v_xor_b32 v101, 96, v101
    v_accvgpr_read_b32 v108, a64
    v_accvgpr_read_b32 v106, a18
    v_mfma_f32_16x16x32_bf16 v[168:171], a[220:223], v[20:23], 0
    ds_write2st64_b64 v101, v[128:129], v[176:177] offset0:4 offset1:16
    v_pk_mul_f32 v[108:109], v[108:109], v[100:101] op_sel_hi:[1,0]
    v_cvt_pk_bf16_f32 v233, v234, v235
    v_cvt_pk_bf16_f32 v200, v200, v201
    v_pk_mul_f32 v[104:105], v[104:105], v[8:9] op_sel_hi:[1,0]
    v_pk_mul_f32 v[110:111], v[110:111], v[100:101] op_sel_hi:[1,0]
    v_pk_mul_f32 v[106:107], v[106:107], v[8:9] op_sel_hi:[1,0]
    v_cvt_pk_bf16_f32 v104, v104, v105
    v_fma_f32 v79, v79, s28, v12
    v_cvt_pk_bf16_f32 v185, v186, v187
    v_cvt_pk_bf16_f32 v105, v106, v107
    v_mfma_f32_16x16x32_bf16 v[120:123], a[220:223], v[14:17], 0
    ds_write2st64_b64 v101, v[224:225], v[104:105] offset0:28 offset1:40
    v_cvt_pk_bf16_f32 v108, v108, v109
    v_cvt_pk_bf16_f32 v109, v110, v111
    v_mfma_f32_16x16x32_bf16 v[124:127], a[224:227], v[14:17], 0
    s_waitcnt lgkmcnt(3)
    ds_write_b64 v101, v[108:109] offset:26624
    v_xor_b32 v101, 32, v101
    v_exp_f32 v84, v84
    v_mfma_f32_16x16x32_bf16 v[128:131], a[228:231], v[14:17], 0
    ds_write2st64_b64 v101, v[132:133], v[180:181] offset0:4 offset1:16
    v_accvgpr_read_b32 v111, a71
    v_accvgpr_read_b32 v106, a22
    v_accvgpr_read_b32 v109, a69
    v_accvgpr_read_b32 v108, a68
    v_accvgpr_read_b32 v105, a21
    v_cvt_pk_bf16_f32 v236, v236, v237
    v_accvgpr_read_b32 v104, a20
    v_accvgpr_read_b32 v110, a70
    v_exp_f32 v70, v70
    v_cvt_pk_bf16_f32 v140, v140, v141
    v_accvgpr_read_b32 v107, a23
    v_pk_mul_f32 v[190:191], v[190:191], v[102:103] op_sel_hi:[1,0]
    v_pk_mul_f32 v[110:111], v[110:111], v[100:101] op_sel_hi:[1,0]
    v_pk_mul_f32 v[104:105], v[104:105], v[8:9] op_sel_hi:[1,0]
    v_cvt_pk_bf16_f32 v237, v238, v239
    v_pk_mul_f32 v[108:109], v[108:109], v[100:101] op_sel_hi:[1,0]
    v_fma_f32 v65, v65, s28, v10
    v_cvt_pk_bf16_f32 v104, v104, v105
    v_pk_mul_f32 v[106:107], v[106:107], v[8:9] op_sel_hi:[1,0]
    v_cvt_pk_bf16_f32 v108, v108, v109
    v_pk_mul_f32 v[194:195], v[194:195], v[102:103] op_sel_hi:[1,0]
    v_cvt_pk_bf16_f32 v30, v68, v69
    v_cvt_pk_bf16_f32 v109, v110, v111
    v_mfma_f32_16x16x32_bf16 v[132:135], a[232:235], v[14:17], 0
    buffer_store_dwordx4 v[96:99], v6, s[16:19], s67 offen offset:0 nt
    ds_read_b64_tr_b16 a[220:221], v2 offset:2048
    ds_read_b64_tr_b16 a[218:219], v5 offset:7168
    v_cvt_pk_bf16_f32 v105, v106, v107
    v_accvgpr_read_b32 v107, a27
    v_cvt_pk_bf16_f32 v141, v142, v143
    v_mfma_f32_16x16x32_bf16 v[180:183], a[232:235], v[20:23], 0
    ds_write2st64_b64 v101, v[228:229], v[104:105] offset0:28 offset1:40
    v_exp_f32 v62, v62
    v_mfma_f32_16x16x32_bf16 v[176:179], a[228:231], v[20:23], 0
    ds_write_b64 v101, v[108:109] offset:26624
    v_mfma_f32_16x16x32_bf16 v[224:227], a[228:231], v[26:29], 0
    ds_read_b64_tr_b16 a[216:217], v5 offset:1024
    v_accvgpr_read_b32 v105, a25
    v_accvgpr_read_b32 v104, a24
    v_accvgpr_read_b32 v109, a73
    v_accvgpr_read_b32 v106, a26
    v_xor_b32 v101, 96, v101
    v_pk_mul_f32 v[106:107], v[106:107], v[8:9] op_sel_hi:[1,0]
    v_pk_mul_f32 v[104:105], v[104:105], v[8:9] op_sel_hi:[1,0]
    v_accvgpr_read_b32 v110, a74
    v_accvgpr_read_b32 v108, a72
    v_accvgpr_read_b32 v111, a75
    v_pk_mul_f32 v[158:159], v[158:159], v[48:49] op_sel_hi:[1,0]
    v_pk_mul_f32 v[108:109], v[108:109], v[100:101] op_sel_hi:[1,0]
    v_pk_mul_f32 v[110:111], v[110:111], v[100:101] op_sel_hi:[1,0]
    v_fma_f32 v89, v89, s28, v13
    v_cvt_pk_bf16_f32 v104, v104, v105
    v_cvt_pk_bf16_f32 v18, v52, v53
    v_mfma_f32_16x16x32_bf16 v[228:231], a[232:235], v[26:29], 0
    ds_read_b64_tr_b16 a[226:227], v3 offset:8192
    ds_read_b64_tr_b16 a[222:223], v2 offset:8192
    v_cvt_pk_bf16_f32 v149, v150, v151
    v_mfma_f32_16x16x32_bf16 a[20:23], a[232:235], v[32:35], 0
    ds_read_b64_tr_b16 a[224:225], v3 offset:2048
    v_cvt_pk_bf16_f32 v105, v106, v107
    v_mfma_f32_16x16x32_bf16 a[16:19], a[228:231], v[32:35], 0
    ds_write2st64_b64 v101, v[136:137], v[184:185] offset0:4 offset1:16
    v_mfma_f32_16x16x32_bf16 a[64:67], a[228:231], v[38:41], 0
    s_add_u32 s20, s20, 12032
    ds_write2st64_b64 v101, v[232:233], v[104:105] offset0:28 offset1:40
    v_cvt_pk_bf16_f32 v108, v108, v109
    v_cvt_pk_bf16_f32 v109, v110, v111
    v_accvgpr_read_b32 v105, a29
    v_cvt_pk_bf16_f32 v189, v190, v191
    v_mfma_f32_16x16x32_bf16 a[68:71], a[232:235], v[38:41], 0
    s_waitcnt lgkmcnt(5)
    ds_write_b64 v101, v[108:109] offset:26624
    v_accvgpr_read_b32 v110, a78
    v_accvgpr_read_b32 v109, a77
    v_mfma_f32_16x16x32_bf16 a[72:75], a[212:215], v[38:41], 0
    ds_read_b128 v[96:99], v103 offset:1024
    v_accvgpr_read_b32 v111, a79
    v_accvgpr_read_b32 v108, a76
    v_xor_b32 v101, 32, v101
    v_mfma_f32_16x16x32_bf16 a[76:79], a[216:219], v[38:41], 0
    ds_write2st64_b64 v101, v[140:141], v[188:189] offset0:4 offset1:16
    v_cvt_pk_bf16_f32 v197, v198, v199
    v_pk_mul_f32 v[206:207], v[206:207], v[102:103] op_sel_hi:[1,0]
    v_accvgpr_read_b32 v104, a28
    v_pk_mul_f32 v[108:109], v[108:109], v[100:101] op_sel_hi:[1,0]
    v_pk_mul_f32 v[110:111], v[110:111], v[100:101] op_sel_hi:[1,0]
    v_pk_mul_f32 v[104:105], v[104:105], v[8:9] op_sel_hi:[1,0]
    v_cvt_pk_bf16_f32 v157, v158, v159
    v_accvgpr_read_b32 v106, a30
    v_accvgpr_read_b32 v107, a31
    v_cvt_pk_bf16_f32 v104, v104, v105
    v_pk_mul_f32 v[106:107], v[106:107], v[8:9] op_sel_hi:[1,0]
    v_cvt_pk_bf16_f32 v108, v108, v109
    v_cvt_pk_bf16_f32 v109, v110, v111
    v_cvt_pk_bf16_f32 v31, v70, v71
    v_mfma_f32_16x16x32_bf16 a[28:31], a[216:219], v[32:35], 0
    ds_read_b64_tr_b16 a[228:229], v4 offset:2048
    ds_read_b64_tr_b16 a[230:231], v4 offset:8192
    v_mfma_f32_16x16x32_bf16 a[24:27], a[212:215], v[32:35], 0
    ds_read_b64_tr_b16 a[232:233], v5 offset:2048
    ds_read_b64_tr_b16 a[234:235], v5 offset:8192
    v_cvt_pk_bf16_f32 v105, v106, v107
    v_accvgpr_read_b32 v111, a83
    v_mfma_f32_16x16x32_bf16 v[232:235], a[212:215], v[26:29], 0
    s_add_u32 s39, s39, 12288
    ds_write2st64_b64 v101, v[236:237], v[104:105] offset0:28 offset1:40
    v_accvgpr_read_b32 v105, a33
    v_mfma_f32_16x16x32_bf16 v[236:239], a[216:219], v[26:29], 0
    ds_write_b64 v101, v[108:109] offset:26624
    v_accvgpr_read_b32 v110, a82
    v_accvgpr_read_b32 v104, a32
    v_accvgpr_read_b32 v109, a81
    v_accvgpr_read_b32 v107, a35
    v_accvgpr_read_b32 v108, a80
    v_pk_mul_f32 v[108:109], v[108:109], v[100:101] op_sel_hi:[1,0]
    v_pk_mul_f32 v[104:105], v[104:105], v[8:9] op_sel_hi:[1,0]
    v_cvt_pk_bf16_f32 v193, v194, v195
    v_accvgpr_read_b32 v106, a34
    v_fma_f32 v74, v74, s28, v11
    v_pk_mul_f32 v[106:107], v[106:107], v[8:9] op_sel_hi:[1,0]
    v_cvt_pk_bf16_f32 v108, v108, v109
    v_cvt_pk_bf16_f32 v104, v104, v105
    v_xor_b32 v101, 96, v101
    v_cvt_pk_bf16_f32 v105, v106, v107
    v_exp_f32 v58, v58
    v_pk_mul_f32 v[110:111], v[110:111], v[100:101] op_sel_hi:[1,0]
    v_pk_mul_f32 v[254:255], v[254:255], v[50:51] op_sel_hi:[1,0]
    v_accvgpr_read_b32 v107, a39
    v_cvt_pk_bf16_f32 v109, v110, v111
    v_mfma_f32_16x16x32_bf16 v[188:191], a[216:219], v[20:23], 0
    s_waitcnt vmcnt(7) lgkmcnt(2)
    v_accvgpr_read_b32 v110, a86
    v_accvgpr_read_b32 v106, a38
    v_mfma_f32_16x16x32_bf16 v[184:187], a[212:215], v[20:23], 0
    buffer_store_dwordx4 v[96:99], v7, s[16:19], s67 offen offset:0 nt
    s_barrier
    ds_write2st64_b64 v101, v[144:145], v[192:193] offset0:8 offset1:20
    v_mfma_f32_16x16x32_bf16 v[136:139], a[212:215], v[14:17], 0
    ds_write2st64_b64 v101, v[240:241], v[104:105] offset0:32 offset1:44
    v_accvgpr_read_b32 v105, a37
    v_pk_mul_f32 v[250:251], v[250:251], v[50:51] op_sel_hi:[1,0]
    v_cvt_pk_bf16_f32 v201, v202, v203
    v_cvt_pk_bf16_f32 v253, v254, v255
    v_mfma_f32_16x16x32_bf16 v[140:143], a[216:219], v[14:17], 0
    s_add_u32 m0, s22, 24576
    ds_write_b64 v101, v[108:109] offset:0
    v_accvgpr_read_b32 v104, a36
    v_accvgpr_read_b32 v109, a85
    v_xor_b32 v101, 32, v101
    v_mfma_f32_16x16x32_bf16 v[144:147], a[220:223], v[14:17], 0
    ds_write2st64_b64 v101, v[148:149], v[196:197] offset0:8 offset1:20
    v_accvgpr_read_b32 v108, a84
    v_pk_mul_f32 v[104:105], v[104:105], v[8:9] op_sel_hi:[1,0]
    v_accvgpr_read_b32 v111, a87
    v_pk_mul_f32 v[106:107], v[106:107], v[8:9] op_sel_hi:[1,0]
    v_pk_mul_f32 v[108:109], v[108:109], v[100:101] op_sel_hi:[1,0]
    v_cvt_pk_bf16_f32 v204, v204, v205
    v_pk_mul_f32 v[110:111], v[110:111], v[100:101] op_sel_hi:[1,0]
    v_cvt_pk_bf16_f32 v108, v108, v109
    v_fma_f32 v55, v55, s28, v9
    v_cvt_pk_bf16_f32 v42, v84, v85
    v_cvt_pk_bf16_f32 v104, v104, v105
    v_cvt_pk_bf16_f32 v105, v106, v107
    v_cvt_pk_bf16_f32 v109, v110, v111
    v_accvgpr_read_b32 v110, a90
    v_mfma_f32_16x16x32_bf16 v[148:151], a[224:227], v[14:17], 0
    ds_read_b128 a[212:215], v0 offset:0
    buffer_load_dwordx4 v6, s[8:11], s21 offen lds
    v_accvgpr_read_b32 v107, a43
    v_fma_f32 v59, v59, s28, v9
    v_mfma_f32_16x16x32_bf16 v[196:199], a[224:227], v[20:23], 0
    ds_write2st64_b64 v101, v[244:245], v[104:105] offset0:32 offset1:44
    v_mfma_f32_16x16x32_bf16 v[192:195], a[220:223], v[20:23], 0
    s_add_u32 s21, s21, 128
    ds_write_b64 v101, v[108:109] offset:0
    v_accvgpr_read_b32 v111, a91
    v_accvgpr_read_b32 v109, a89
    v_accvgpr_read_b32 v104, a40
    v_accvgpr_read_b32 v105, a41
    v_pk_mul_f32 v[104:105], v[104:105], v[8:9] op_sel_hi:[1,0]
    v_accvgpr_read_b32 v108, a88
    v_pk_mul_f32 v[108:109], v[108:109], v[100:101] op_sel_hi:[1,0]
    v_accvgpr_read_b32 v106, a42
    v_pk_mul_f32 v[106:107], v[106:107], v[8:9] op_sel_hi:[1,0]
    v_cvt_pk_bf16_f32 v104, v104, v105
    v_cvt_pk_bf16_f32 v108, v108, v109
    v_pk_mul_f32 v[110:111], v[110:111], v[100:101] op_sel_hi:[1,0]
    v_cvt_pk_bf16_f32 v105, v106, v107
    v_accvgpr_read_b32 v106, a46
    v_cvt_pk_bf16_f32 v249, v250, v251
    v_mfma_f32_16x16x32_bf16 v[240:243], a[220:223], v[26:29], 0
    v_cvt_pk_bf16_f32 v109, v110, v111
    v_xor_b32 v101, 96, v101
    v_mfma_f32_16x16x32_bf16 v[244:247], a[224:227], v[26:29], 0
    ds_read_b128 v[96:99], v103 offset:2048
    v_accvgpr_read_b32 v107, a47
    v_mfma_f32_16x16x32_bf16 a[36:39], a[224:227], v[32:35], 0
    ds_write2st64_b64 v101, v[152:153], v[200:201] offset0:8 offset1:20
    v_mfma_f32_16x16x32_bf16 a[32:35], a[220:223], v[32:35], 0
    s_add_u32 m0, s22, 25600
    ds_write2st64_b64 v101, v[248:249], v[104:105] offset0:32 offset1:44
    v_accvgpr_read_b32 v110, a94
    v_accvgpr_read_b32 v104, a44
    v_mfma_f32_16x16x32_bf16 a[80:83], a[220:223], v[38:41], 0
    buffer_load_dwordx4 v6, s[8:11], s21 offen lds
    ds_read_b128 a[216:219], v1 offset:0
    v_mfma_f32_16x16x32_bf16 a[84:87], a[224:227], v[38:41], 0
    ds_write_b64 v101, v[108:109] offset:0
    v_accvgpr_read_b32 v109, a93
    v_exp_f32 v74, v74
    v_mfma_f32_16x16x32_bf16 a[88:91], a[228:231], v[38:41], 0
    s_add_u32 s21, s21, 128
    v_accvgpr_read_b32 v108, a92
    v_fma_f32 v67, v67, s28, v10
    v_fma_f32 v81, v81, s28, v12
    v_accvgpr_read_b32 v111, a95
    v_fma_f32 v66, v66, s28, v10
    v_xor_b32 v101, 32, v101
    v_pk_mul_f32 v[108:109], v[108:109], v[100:101] op_sel_hi:[1,0]
    v_pk_mul_f32 v[106:107], v[106:107], v[8:9] op_sel_hi:[1,0]
    v_accvgpr_read_b32 v105, a45
    v_pk_mul_f32 v[104:105], v[104:105], v[8:9] op_sel_hi:[1,0]
    v_cvt_pk_bf16_f32 v205, v206, v207
    v_cvt_pk_bf16_f32 v108, v108, v109
    v_pk_mul_f32 v[110:111], v[110:111], v[100:101] op_sel_hi:[1,0]
    v_cvt_pk_bf16_f32 v104, v104, v105
    v_exp_f32 v56, v56
    v_mfma_f32_16x16x32_bf16 a[92:95], a[232:235], v[38:41], 0
    s_add_u32 m0, s22, 26624
    ds_read_b128 a[220:223], v0 offset:1024
    v_exp_f32 v81, v81
    v_mfma_f32_16x16x32_bf16 a[44:47], a[232:235], v[32:35], 0
    ds_write2st64_b64 v101, v[156:157], v[204:205] offset0:8 offset1:20
    v_cvt_pk_bf16_f32 v105, v106, v107
    v_fma_f32 v57, v57, s28, v9
    v_mfma_f32_16x16x32_bf16 a[40:43], a[228:231], v[32:35], 0
    buffer_load_dwordx4 v6, s[8:11], s21 offen lds
    v_mfma_f32_16x16x32_bf16 v[248:251], a[228:231], v[26:29], 0
    ds_write2st64_b64 v101, v[252:253], v[104:105] offset0:32 offset1:44
    v_mfma_f32_16x16x32_bf16 v[252:255], a[232:235], v[26:29], 0
    s_add_u32 s21, s21, 12032
    v_exp_f32 v64, v64
    v_mfma_f32_16x16x32_bf16 v[204:207], a[232:235], v[20:23], 0
    s_add_u32 s56, s67, 128
    v_exp_f32 v63, v63
    v_mfma_f32_16x16x32_bf16 v[200:203], a[228:231], v[20:23], 0
    v_exp_f32 v55, v55
    v_mfma_f32_16x16x32_bf16 v[152:155], a[228:231], v[14:17], 0
    ds_read_b128 a[228:231], v0 offset:2048
    v_cvt_pk_bf16_f32 v19, v54, v55
    v_exp_f32 v65, v65
    v_mfma_f32_16x16x32_bf16 v[156:159], a[232:235], v[14:17], 0
    s_waitcnt lgkmcnt(3)
    ds_read_b128 a[232:235], v1 offset:2048
    v_fma_f32 v73, v73, s28, v11
    v_mfma_f32_16x16x32_bf16 v[52:55], a[212:215], a[96:99], 0
    s_add_u32 s58, s33, 128
    v_exp_f32 v89, v89
    v_mfma_f32_16x16x32_bf16 v[52:55], a[216:219], a[100:103], v[52:55]
    ds_read_b128 a[224:227], v1 offset:1024
    v_cvt_pk_bf16_f32 v25, v62, v63
    v_mfma_f32_16x16x32_bf16 v[52:55], a[220:223], a[104:107], v[52:55]
    v_exp_f32 v57, v57
    v_mfma_f32_16x16x32_bf16 v[60:63], a[220:223], a[128:131], 0
    s_add_u32 m0, s38, 2048
    v_exp_f32 v79, v79
    v_mfma_f32_16x16x32_bf16 v[60:63], a[216:219], a[124:127], v[60:63]
    buffer_load_dwordx4 v6, s[12:15], s58 offen nt lds
    v_mfma_f32_16x16x32_bf16 v[60:63], a[212:215], a[120:123], v[60:63]
    buffer_store_dwordx4 v[96:99], v6, s[16:19], s56 offen offset:0 nt
    s_nop 0
    ds_read_b128 v[96:99], v103 offset:3072
    v_exp_f32 v88, v88
    v_mfma_f32_16x16x32_bf16 v[68:71], a[212:215], a[144:147], 0
    s_add_u32 m0, s38, 3072
    v_exp_f32 v59, v59
    v_mfma_f32_16x16x32_bf16 v[68:71], a[216:219], a[148:151], v[68:71]
    v_cvt_pk_bf16_f32 v16, v56, v57
    v_cvt_pk_bf16_f32 v37, v78, v79
    v_mfma_f32_16x16x32_bf16 v[68:71], a[220:223], a[152:155], v[68:71]
    v_exp_f32 v90, v90
    v_mfma_f32_16x16x32_bf16 v[76:79], a[220:223], a[176:179], 0
    v_exp_f32 v67, v67
    v_mfma_f32_16x16x32_bf16 v[76:79], a[216:219], a[172:175], v[76:79]
    v_cvt_pk_bf16_f32 v43, v86, v87
    v_cvt_pk_bf16_f32 v17, v58, v59
    v_mfma_f32_16x16x32_bf16 v[76:79], a[212:215], a[168:171], v[76:79]
    v_cvt_pk_bf16_f32 v22, v64, v65
    v_fma_f32 v75, v75, s28, v11
    v_mfma_f32_16x16x32_bf16 v[84:87], a[212:215], a[192:195], 0
    v_exp_f32 v73, v73
    v_mfma_f32_16x16x32_bf16 v[48:51], a[236:239], v[16:19], v[44:47]
    v_exp_f32 v66, v66
    v_mfma_f32_16x16x32_bf16 v[84:87], a[216:219], a[196:199], v[84:87]
    v_fma_f32 v91, v91, s28, v13
    v_cvt_pk_bf16_f32 v109, v110, v111
    v_mfma_f32_16x16x32_bf16 v[84:87], a[220:223], a[200:203], v[84:87]
    s_waitcnt lgkmcnt(0)
    v_exp_f32 v82, v82
    v_mfma_f32_16x16x32_bf16 v[84:87], a[224:227], a[204:207], v[84:87]
    buffer_store_dwordx4 v[96:99], v7, s[16:19], s56 offen offset:0 nt
    ds_write_b64 v101, v[108:109] offset:0
    v_mfma_f32_16x16x32_bf16 v[84:87], a[228:231], a[208:211], v[84:87]
    v_exp_f32 v91, v91
    v_mfma_f32_16x16x32_bf16 v[84:87], a[232:235], v[92:95], v[84:87]
    v_exp_f32 v80, v80
    v_mfma_f32_16x16x32_bf16 v[76:79], a[232:235], a[188:191], v[76:79]
    buffer_load_dwordx4 v7, s[12:15], s58 offen nt lds
    v_mfma_f32_16x16x32_bf16 v[76:79], a[228:231], a[184:187], v[76:79]
    s_add_u32 s57, s67, 24832
    v_exp_f32 v75, v75
    v_mfma_f32_16x16x32_bf16 v[76:79], a[224:227], a[180:183], v[76:79]
    ds_read_b128 v[96:99], v103 offset:0
    v_cvt_pk_bf16_f32 v23, v66, v67
    v_mfma_f32_16x16x32_bf16 v[68:71], a[224:227], a[156:159], v[68:71]
    v_exp_f32 v83, v83
    v_mfma_f32_16x16x32_bf16 v[68:71], a[228:231], a[160:163], v[68:71]
    v_cvt_pk_bf16_f32 v29, v74, v75
    v_mfma_f32_16x16x32_bf16 v[48:51], a[240:243], v[22:25], v[48:51]
    ds_read_b128 a[216:219], v1 offset:6144
    v_cvt_pk_bf16_f32 v41, v90, v91
    v_mfma_f32_16x16x32_bf16 v[68:71], a[232:235], a[164:167], v[68:71]
    v_exp_f32 v72, v72
    v_mfma_f32_16x16x32_bf16 v[60:63], a[232:235], a[140:143], v[60:63]
    ds_read_b128 a[212:215], v0 offset:6144
    v_cvt_pk_bf16_f32 v28, v72, v73
    v_mfma_f32_16x16x32_bf16 v[60:63], a[228:231], a[136:139], v[60:63]
    ds_read_b128 a[220:223], v0 offset:7168
    v_cvt_pk_bf16_f32 v35, v82, v83
    v_mfma_f32_16x16x32_bf16 v[48:51], a[244:247], v[28:31], v[48:51]
    v_cvt_pk_bf16_f32 v34, v80, v81
    v_cvt_pk_bf16_f32 v40, v88, v89
    v_mfma_f32_16x16x32_bf16 v[60:63], a[224:227], a[132:135], v[60:63]
    v_mfma_f32_16x16x32_bf16 v[48:51], a[248:251], v[34:37], v[48:51]
    s_add_u32 m0, s38, 0
    v_mfma_f32_16x16x32_bf16 v[48:51], a[252:255], v[40:43], v[48:51]
    s_waitcnt lgkmcnt(3)
    buffer_load_dwordx4 v6, s[12:15], s33 offen nt lds
    v_mfma_f32_16x16x32_bf16 v[52:55], a[224:227], a[108:111], v[52:55]
    buffer_store_dwordx4 v[96:99], v6, s[16:19], s57 offen offset:0 nt
    s_nop 0
    ds_read_b128 v[96:99], v103 offset:1024
    v_mfma_f32_16x16x32_bf16 v[52:55], a[228:231], a[112:115], v[52:55]
    ds_read_b128 a[224:227], v1 offset:7168
    v_cmp_lt_f32 vcc, s29, v48
    v_mfma_f32_16x16x32_bf16 v[52:55], a[232:235], a[116:119], v[52:55]
    s_add_u32 m0, s38, 1024
    ds_read_b128 a[232:235], v1 offset:8192
    s_waitcnt lgkmcnt(4)
    v_mfma_f32_16x16x32_bf16 v[56:59], a[212:215], a[96:99], 0
    ds_read_b128 a[228:231], v0 offset:8192
    v_mfma_f32_16x16x32_bf16 v[56:59], a[216:219], a[100:103], v[56:59]
    s_waitcnt lgkmcnt(4)
    v_mfma_f32_16x16x32_bf16 v[56:59], a[220:223], a[104:107], v[56:59]
    s_cbranch_vccnz L_rs_tr55d
L_ret_tr55d:
    v_fma_f32 v60, v60, s28, v10
    v_mfma_f32_16x16x32_bf16 v[64:67], a[220:223], a[128:131], 0
    v_fma_f32 v54, v54, s28, v9
    v_fma_f32 v52, v52, s28, v9
    v_mfma_f32_16x16x32_bf16 v[64:67], a[216:219], a[124:127], v[64:67]
    v_fma_f32 v63, v63, s28, v10
    v_fma_f32 v53, v53, s28, v9
    v_mfma_f32_16x16x32_bf16 v[64:67], a[212:215], a[120:123], v[64:67]
    v_exp_f32 v52, v52
    v_mfma_f32_16x16x32_bf16 v[72:75], a[212:215], a[144:147], 0
    v_fma_f32 v61, v61, s28, v10
    v_fma_f32 v55, v55, s28, v9
    v_mfma_f32_16x16x32_bf16 v[72:75], a[216:219], a[148:151], v[72:75]
    v_exp_f32 v60, v60
    v_mfma_f32_16x16x32_bf16 v[72:75], a[220:223], a[152:155], v[72:75]
    v_exp_f32 v55, v55
    v_mfma_f32_16x16x32_bf16 v[80:83], a[220:223], a[176:179], 0
    s_waitcnt lgkmcnt(1)
    buffer_load_dwordx4 v7, s[12:15], s33 offen nt lds
    v_mfma_f32_16x16x32_bf16 v[80:83], a[216:219], a[172:175], v[80:83]
    v_exp_f32 v63, v63
    v_mfma_f32_16x16x32_bf16 v[80:83], a[212:215], a[168:171], v[80:83]
    v_fma_f32 v62, v62, s28, v10
    s_waitcnt vmcnt(15) lgkmcnt(0)
    v_mfma_f32_16x16x32_bf16 v[88:91], a[212:215], a[192:195], 0
    s_barrier
    v_mfma_f32_16x16x32_bf16 v[88:91], a[216:219], a[196:199], v[88:91]
    v_exp_f32 v53, v53
    v_mfma_f32_16x16x32_bf16 v[88:91], a[220:223], a[200:203], v[88:91]
    v_exp_f32 v61, v61
    v_mfma_f32_16x16x32_bf16 v[88:91], a[224:227], a[204:207], v[88:91]
    buffer_store_dwordx4 v[96:99], v7, s[16:19], s57 offen offset:0 nt
    ds_read_b64_tr_b16 a[212:213], v2 offset:18432
    v_exp_f32 v54, v54
    v_mfma_f32_16x16x32_bf16 v[88:91], a[228:231], a[208:211], v[88:91]
    s_add_u32 m0, s22, 0
    v_cvt_pk_bf16_f32 v15, v54, v55
    v_cvt_pk_bf16_f32 v14, v52, v53
    v_mfma_f32_16x16x32_bf16 v[88:91], a[232:235], v[92:95], v[88:91]
    ds_read_b64_tr_b16 a[214:215], v2 offset:12288
    v_add_u32 v103, 4096, v103
    v_mfma_f32_16x16x32_bf16 v[80:83], a[232:235], a[188:191], v[80:83]
    buffer_load_dwordx4 v6, s[4:7], s20 offen lds
    v_mfma_f32_16x16x32_bf16 v[80:83], a[228:231], a[184:187], v[80:83]
    ds_read_b64_tr_b16 a[216:217], v3 offset:18432
    v_mfma_f32_16x16x32_bf16 v[80:83], a[224:227], a[180:183], v[80:83]
    s_add_u32 s20, s20, 128
    ds_read_b64_tr_b16 a[218:219], v3 offset:12288
    v_cvt_pk_bf16_f32 v20, v60, v61
    v_mfma_f32_16x16x32_bf16 v[72:75], a[224:227], a[156:159], v[72:75]
    v_exp_f32 v62, v62
    v_mfma_f32_16x16x32_bf16 v[72:75], a[228:231], a[160:163], v[72:75]
    ds_read_b64_tr_b16 a[220:221], v4 offset:18432
    v_mfma_f32_16x16x32_bf16 v[72:75], a[232:235], a[164:167], v[72:75]
    v_cvt_pk_bf16_f32 v21, v62, v63
    s_add_u32 m0, s22, 1024
    v_mfma_f32_16x16x32_bf16 v[64:67], a[232:235], a[140:143], v[64:67]
    v_mfma_f32_16x16x32_bf16 v[64:67], a[228:231], a[136:139], v[64:67]
    buffer_load_dwordx4 v6, s[4:7], s20 offen lds
    v_mfma_f32_16x16x32_bf16 v[64:67], a[224:227], a[132:135], v[64:67]
    s_add_u32 s20, s20, 128
    s_add_u32 m0, s22, 2048
    ds_read_b64_tr_b16 a[222:223], v4 offset:12288
    v_mfma_f32_16x16x32_bf16 v[56:59], a[224:227], a[108:111], v[56:59]
    buffer_load_dwordx4 v6, s[4:7], s20 offen lds
    v_mfma_f32_16x16x32_bf16 v[56:59], a[228:231], a[112:115], v[56:59]
    ds_read_b64_tr_b16 a[224:225], v5 offset:18432
    v_mfma_f32_16x16x32_bf16 v[56:59], a[232:235], a[116:119], v[56:59]
    s_add_u32 s20, s20, 12032
    ds_read_b64_tr_b16 a[226:227], v5 offset:12288
    s_branch L_loop5
L_loop4:
    .p2align 6
L_loop4w0:
    s_waitcnt lgkmcnt(6)
    v_mfma_f32_16x16x32_bf16 v[112:115], a[212:215], v[16:19], v[112:115]
    ds_read_b64_tr_b16 a[234:235], v3 offset:13312
    v_fma_f32 v71, v71, s28, v11
    v_mfma_f32_16x16x32_bf16 v[160:163], a[212:215], v[22:25], v[160:163]
    v_mfma_f32_16x16x32_bf16 v[208:211], a[212:215], v[28:31], v[208:211]
    v_fma_f32 v62, v62, s28, v10
    v_fma_f32 v63, v63, s28, v10
    v_mfma_f32_16x16x32_bf16 a[0:3], a[212:215], v[34:37], a[0:3]
    ds_read_b64_tr_b16 a[230:231], v2 offset:13312
    s_waitcnt lgkmcnt(6)
    v_mfma_f32_16x16x32_bf16 a[4:7], a[216:219], v[34:37], a[4:7]
    ds_read_b64_tr_b16 a[232:233], v3 offset:19456
    v_fma_f32 v73, v73, s28, v11
    v_mfma_f32_16x16x32_bf16 v[212:215], a[216:219], v[28:31], v[212:215]
    ds_read_b64_tr_b16 a[228:229], v2 offset:19456
    v_fma_f32 v59, v59, s28, v9
    v_mfma_f32_16x16x32_bf16 v[164:167], a[216:219], v[22:25], v[164:167]
    ds_read_b64_tr_b16 a[212:213], v4 offset:19456
    v_fma_f32 v75, v75, s28, v11
    v_mfma_f32_16x16x32_bf16 v[116:119], a[216:219], v[16:19], v[116:119]
    ds_read_b64_tr_b16 a[214:215], v4 offset:13312
    s_waitcnt lgkmcnt(8)
    v_mfma_f32_16x16x32_bf16 v[120:123], a[220:223], v[16:19], v[120:123]
    v_exp_f32 v71, v71
    v_mfma_f32_16x16x32_bf16 v[168:171], a[220:223], v[22:25], v[168:171]
    ds_read_b64_tr_b16 a[216:217], v5 offset:19456
    v_fma_f32 v64, v64, s28, v10
    v_mfma_f32_16x16x32_bf16 v[216:219], a[220:223], v[28:31], v[216:219]
    v_exp_f32 v73, v73
    v_mfma_f32_16x16x32_bf16 a[8:11], a[220:223], v[34:37], a[8:11]
    s_waitcnt lgkmcnt(6)
    v_fma_f32 v70, v70, s28, v11
    v_fma_f32 v82, v82, s28, v12
    v_mfma_f32_16x16x32_bf16 a[12:15], a[224:227], v[34:37], a[12:15]
    v_fma_f32 v78, v78, s28, v12
    v_fma_f32 v76, v76, s28, v12
    v_mfma_f32_16x16x32_bf16 v[220:223], a[224:227], v[28:31], v[220:223]
    v_fma_f32 v81, v81, s28, v12
    v_fma_f32 v79, v79, s28, v12
    v_mfma_f32_16x16x32_bf16 v[172:175], a[224:227], v[22:25], v[172:175]
    v_exp_f32 v64, v64
    v_mfma_f32_16x16x32_bf16 v[124:127], a[224:227], v[16:19], v[124:127]
    s_waitcnt lgkmcnt(3)
    ds_read_b64_tr_b16 a[226:227], v3 offset:14336
    v_fma_f32 v77, v77, s28, v12
    v_mfma_f32_16x16x32_bf16 v[128:131], a[228:231], v[16:19], v[128:131]
    ds_read_b64_tr_b16 a[218:219], v5 offset:13312
    v_fma_f32 v68, v68, s28, v11
    v_mfma_f32_16x16x32_bf16 v[176:179], a[228:231], v[22:25], v[176:179]
    s_add_u32 s39, s39, 12288
    ds_read_b64_tr_b16 a[224:225], v3 offset:20480
    v_mfma_f32_16x16x32_bf16 v[224:227], a[228:231], v[28:31], v[224:227]
    ds_read_b64_tr_b16 a[220:221], v2 offset:20480
    v_fma_f32 v56, v56, s28, v9
    v_mfma_f32_16x16x32_bf16 a[16:19], a[228:231], v[34:37], a[16:19]
    v_exp_f32 v78, v78
    v_mfma_f32_16x16x32_bf16 a[20:23], a[232:235], v[34:37], a[20:23]
    ds_read_b64_tr_b16 a[230:231], v4 offset:14336
    v_fma_f32 v57, v57, s28, v9
    v_mfma_f32_16x16x32_bf16 v[228:231], a[232:235], v[28:31], v[228:231]
    ds_read_b64_tr_b16 a[222:223], v2 offset:14336
    v_fma_f32 v58, v58, s28, v9
    v_mfma_f32_16x16x32_bf16 v[180:183], a[232:235], v[22:25], v[180:183]
    ds_read_b64_tr_b16 a[228:229], v4 offset:20480
    v_fma_f32 v65, v65, s28, v10
    v_mfma_f32_16x16x32_bf16 v[132:135], a[232:235], v[16:19], v[132:135]
    s_waitcnt lgkmcnt(7)
    ds_read_b64_tr_b16 a[234:235], v5 offset:14336
    v_fma_f32 v67, v67, s28, v10
    v_mfma_f32_16x16x32_bf16 v[136:139], a[212:215], v[16:19], v[136:139]
    ds_read_b64_tr_b16 a[232:233], v5 offset:20480
    v_fma_f32 v83, v83, s28, v12
    v_mfma_f32_16x16x32_bf16 v[184:187], a[212:215], v[22:25], v[184:187]
    v_exp_f32 v70, v70
    v_mfma_f32_16x16x32_bf16 v[232:235], a[212:215], v[28:31], v[232:235]
    v_exp_f32 v76, v76
    v_mfma_f32_16x16x32_bf16 a[24:27], a[212:215], v[34:37], a[24:27]
    s_waitcnt lgkmcnt(6)
    v_exp_f32 v57, v57
    v_mfma_f32_16x16x32_bf16 a[28:31], a[216:219], v[34:37], a[28:31]
    v_exp_f32 v79, v79
    v_mfma_f32_16x16x32_bf16 v[236:239], a[216:219], v[28:31], v[236:239]
    v_exp_f32 v82, v82
    v_mfma_f32_16x16x32_bf16 v[188:191], a[216:219], v[22:25], v[188:191]
    v_exp_f32 v68, v68
    v_mfma_f32_16x16x32_bf16 v[140:143], a[216:219], v[16:19], v[140:143]
    s_waitcnt lgkmcnt(3)
    v_exp_f32 v75, v75
    v_mfma_f32_16x16x32_bf16 v[144:147], a[220:223], v[16:19], v[144:147]
    v_exp_f32 v77, v77
    v_mfma_f32_16x16x32_bf16 v[192:195], a[220:223], v[22:25], v[192:195]
    v_fma_f32 v66, v66, s28, v10
    s_waitcnt vmcnt(10) lgkmcnt(0)
    v_mfma_f32_16x16x32_bf16 v[240:243], a[220:223], v[28:31], v[240:243]
    s_barrier
    v_mfma_f32_16x16x32_bf16 a[32:35], a[220:223], v[34:37], a[32:35]
    s_add_u32 m0, s22, 36864
    ds_read_b128 a[212:215], v0 offset:12288
    v_fma_f32 v80, v80, s28, v12
    v_mfma_f32_16x16x32_bf16 a[36:39], a[224:227], v[34:37], a[36:39]
    buffer_load_dwordx4 v6, s[8:11], s21 offen lds
    v_mfma_f32_16x16x32_bf16 v[244:247], a[224:227], v[28:31], v[244:247]
    ds_read_b128 a[220:223], v0 offset:13312
    v_fma_f32 v69, v69, s28, v11
    v_mfma_f32_16x16x32_bf16 v[196:199], a[224:227], v[22:25], v[196:199]
    s_add_u32 s21, s21, 128
    ds_read_b128 a[216:219], v1 offset:12288
    s_add_u32 m0, s22, 37888
    v_mfma_f32_16x16x32_bf16 v[148:151], a[224:227], v[16:19], v[148:151]
    ds_read_b128 v[84:87], v103 offset:0
    v_mfma_f32_16x16x32_bf16 v[152:155], a[228:231], v[16:19], v[152:155]
    buffer_load_dwordx4 v6, s[8:11], s21 offen lds
    v_mfma_f32_16x16x32_bf16 v[200:203], a[228:231], v[22:25], v[200:203]
    s_add_u32 s21, s21, 128
    ds_read_b128 a[224:227], v1 offset:13312
    v_fma_f32 v72, v72, s28, v11
    v_mfma_f32_16x16x32_bf16 v[248:251], a[228:231], v[28:31], v[248:251]
    s_add_u32 m0, s22, 38912
    v_exp_f32 v81, v81
    v_mfma_f32_16x16x32_bf16 a[40:43], a[228:231], v[34:37], a[40:43]
    buffer_load_dwordx4 v6, s[8:11], s21 offen lds
    v_mfma_f32_16x16x32_bf16 a[44:47], a[232:235], v[34:37], a[44:47]
    v_exp_f32 v80, v80
    v_mfma_f32_16x16x32_bf16 v[252:255], a[232:235], v[28:31], v[252:255]
    v_exp_f32 v62, v62
    v_mfma_f32_16x16x32_bf16 v[204:207], a[232:235], v[22:25], v[204:207]
    ds_read_b128 a[228:231], v0 offset:14336
    v_mfma_f32_16x16x32_bf16 v[156:159], a[232:235], v[16:19], v[156:159]
    s_waitcnt lgkmcnt(4)
    ds_read_b128 a[232:235], v1 offset:14336
    v_cvt_pk_bf16_f32 v32, v76, v77
    v_mfma_f32_16x16x32_bf16 v[52:55], a[212:215], a[96:99], 0
    s_waitcnt lgkmcnt(4)
    v_exp_f32 v63, v63
    v_mfma_f32_16x16x32_bf16 v[52:55], a[216:219], a[100:103], v[52:55]
    v_exp_f32 v65, v65
    v_mfma_f32_16x16x32_bf16 v[52:55], a[220:223], a[104:107], v[52:55]
    v_cvt_pk_bf16_f32 v27, v70, v71
    v_cvt_pk_bf16_f32 v21, v62, v63
    v_mfma_f32_16x16x32_bf16 v[60:63], a[220:223], a[128:131], 0
    s_add_u32 s21, s21, 12032
    v_exp_f32 v69, v69
    v_mfma_f32_16x16x32_bf16 v[60:63], a[216:219], a[124:127], v[60:63]
    v_exp_f32 v59, v59
    v_mfma_f32_16x16x32_bf16 v[60:63], a[212:215], a[120:123], v[60:63]
    v_cvt_pk_bf16_f32 v26, v68, v69
    v_cvt_pk_bf16_f32 v22, v64, v65
    v_mfma_f32_16x16x32_bf16 v[68:71], a[212:215], a[144:147], 0
    v_exp_f32 v83, v83
    v_mfma_f32_16x16x32_bf16 v[68:71], a[216:219], a[148:151], v[68:71]
    v_cvt_pk_bf16_f32 v33, v78, v79
    v_mfma_f32_16x16x32_bf16 v[68:71], a[220:223], a[152:155], v[68:71]
    v_fma_f32 v74, v74, s28, v11
    v_mfma_f32_16x16x32_bf16 v[76:79], a[220:223], a[176:179], 0
    s_add_u32 m0, s23, 0
    v_exp_f32 v67, v67
    v_mfma_f32_16x16x32_bf16 v[76:79], a[216:219], a[172:175], v[76:79]
    v_exp_f32 v56, v56
    v_mfma_f32_16x16x32_bf16 v[76:79], a[212:215], a[168:171], v[76:79]
    s_waitcnt lgkmcnt(0)
    v_exp_f32 v66, v66
    v_mfma_f32_16x16x32_bf16 v[76:79], a[224:227], a[180:183], v[76:79]
    v_exp_f32 v58, v58
    v_mfma_f32_16x16x32_bf16 v[76:79], a[228:231], a[184:187], v[76:79]
    buffer_load_dwordx4 v38, s[12:15], s25 offen nt lds
    v_mfma_f32_16x16x32_bf16 v[76:79], a[232:235], a[188:191], v[76:79]
    ds_read_b128 a[220:223], v0 offset:19456
    v_mfma_f32_16x16x32_bf16 v[68:71], a[232:235], a[164:167], v[68:71]
    v_cvt_pk_bf16_f32 v35, v82, v83
    v_cvt_pk_bf16_f32 v16, v56, v57
    v_mfma_f32_16x16x32_bf16 v[68:71], a[228:231], a[160:163], v[68:71]
    s_bitcmp1_b32 s27, 0
    v_exp_f32 v74, v74
    v_mfma_f32_16x16x32_bf16 v[68:71], a[224:227], a[156:159], v[68:71]
    v_exp_f32 v72, v72
    v_mfma_f32_16x16x32_bf16 v[60:63], a[224:227], a[132:135], v[60:63]
    ds_read_b128 a[212:215], v0 offset:18432
    v_cvt_pk_bf16_f32 v17, v58, v59
    v_mfma_f32_16x16x32_bf16 v[60:63], a[228:231], a[136:139], v[60:63]
    v_mfma_f32_16x16x32_bf16 v[60:63], a[232:235], a[140:143], v[60:63]
    ds_read_b128 a[216:219], v1 offset:18432
    v_cvt_pk_bf16_f32 v28, v72, v73
    v_mfma_f32_16x16x32_bf16 v[52:55], a[232:235], a[116:119], v[52:55]
    v_cvt_pk_bf16_f32 v29, v74, v75
    s_cselect_b32 s26, s49, 128
    v_mfma_f32_16x16x32_bf16 v[44:47], a[236:239], v[14:17], v[48:51]
    ds_read_b128 a[232:235], v1 offset:20480
    v_cvt_pk_bf16_f32 v23, v66, v67
    v_mfma_f32_16x16x32_bf16 v[52:55], a[228:231], a[112:115], v[52:55]
    ds_read_b128 a[228:231], v0 offset:20480
    v_mfma_f32_16x16x32_bf16 v[52:55], a[224:227], a[108:111], v[52:55]
    s_bitcmp1_b32 s89, 0
    ds_read_b128 a[224:227], v1 offset:19456
    v_cvt_pk_bf16_f32 v34, v80, v81
    v_mfma_f32_16x16x32_bf16 v[44:47], a[240:243], v[20:23], v[44:47]
    v_mfma_f32_16x16x32_bf16 v[44:47], a[244:247], v[26:29], v[44:47]
    v_mfma_f32_16x16x32_bf16 v[44:47], a[248:251], v[32:35], v[44:47]
    buffer_store_dwordx4 v[84:87], v38, s[16:19], s24 offen offset:0 nt
    s_cselect_b32 s26, s26, 0
    s_lshr_b32 s27, s27, 1
    s_waitcnt lgkmcnt(4)
    v_mfma_f32_16x16x32_bf16 v[56:59], a[212:215], a[96:99], 0
    s_waitcnt lgkmcnt(3)
    v_mfma_f32_16x16x32_bf16 v[56:59], a[216:219], a[100:103], v[56:59]
    s_nop 0
    v_cmp_lt_f32 vcc, s29, v44
    v_mfma_f32_16x16x32_bf16 v[56:59], a[220:223], a[104:107], v[56:59]
    s_lshr_b32 s89, s89, 1
    s_add_u32 s24, s24, s26
    s_add_u32 s25, s25, s26
    v_mfma_f32_16x16x32_bf16 v[64:67], a[220:223], a[128:131], 0
    s_cbranch_vccnz L_rs_loop4w0a
L_ret_loop4w0a:
    v_fma_f32 v55, v55, s28, v9
    v_mfma_f32_16x16x32_bf16 v[64:67], a[216:219], a[124:127], v[64:67]
    v_fma_f32 v60, v60, s28, v10
    s_waitcnt vmcnt(12) lgkmcnt(0)
    v_mfma_f32_16x16x32_bf16 v[64:67], a[212:215], a[120:123], v[64:67]
    s_barrier
    v_mfma_f32_16x16x32_bf16 v[72:75], a[212:215], a[144:147], 0
    s_add_u32 m0, s22, 12288
    v_exp_f32 v55, v55
    v_mfma_f32_16x16x32_bf16 v[72:75], a[216:219], a[148:151], v[72:75]
    buffer_load_dwordx4 v6, s[4:7], s20 offen lds
    v_mfma_f32_16x16x32_bf16 v[72:75], a[220:223], a[152:155], v[72:75]
    s_add_u32 s20, s20, 128
    v_fma_f32 v61, v61, s28, v10
    v_fma_f32 v52, v52, s28, v9
    v_mfma_f32_16x16x32_bf16 v[80:83], a[220:223], a[176:179], 0
    v_exp_f32 v61, v61
    v_mfma_f32_16x16x32_bf16 v[80:83], a[216:219], a[172:175], v[80:83]
    s_add_u32 m0, s22, 13312
    v_exp_f32 v60, v60
    v_mfma_f32_16x16x32_bf16 v[80:83], a[212:215], a[168:171], v[80:83]
    buffer_load_dwordx4 v6, s[4:7], s20 offen lds
    v_mfma_f32_16x16x32_bf16 v[80:83], a[224:227], a[180:183], v[80:83]
    s_add_u32 s20, s20, 128
    ds_read_b64_tr_b16 a[212:213], v2 offset:0
    s_add_u32 m0, s22, 14336
    v_mfma_f32_16x16x32_bf16 v[80:83], a[228:231], a[184:187], v[80:83]
    ds_read_b64_tr_b16 a[214:215], v2 offset:6144
    v_fma_f32 v54, v54, s28, v9
    v_mfma_f32_16x16x32_bf16 v[80:83], a[232:235], a[188:191], v[80:83]
    ds_read_b64_tr_b16 a[216:217], v3 offset:0
    v_mfma_f32_16x16x32_bf16 v[72:75], a[232:235], a[164:167], v[72:75]
    buffer_load_dwordx4 v6, s[4:7], s20 offen lds
    v_mfma_f32_16x16x32_bf16 v[72:75], a[228:231], a[160:163], v[72:75]
    v_exp_f32 v54, v54
    v_mfma_f32_16x16x32_bf16 v[72:75], a[224:227], a[156:159], v[72:75]
    ds_read_b64_tr_b16 a[218:219], v3 offset:6144
    v_cvt_pk_bf16_f32 v19, v54, v55
    v_mfma_f32_16x16x32_bf16 v[64:67], a[224:227], a[132:135], v[64:67]
    ds_read_b64_tr_b16 a[220:221], v4 offset:0
    v_fma_f32 v53, v53, s28, v9
    v_mfma_f32_16x16x32_bf16 v[64:67], a[228:231], a[136:139], v[64:67]
    v_exp_f32 v52, v52
    v_mfma_f32_16x16x32_bf16 v[64:67], a[232:235], a[140:143], v[64:67]
    v_exp_f32 v53, v53
    v_mfma_f32_16x16x32_bf16 v[56:59], a[232:235], a[116:119], v[56:59]
    ds_read_b64_tr_b16 a[222:223], v4 offset:6144
    v_mfma_f32_16x16x32_bf16 v[56:59], a[228:231], a[112:115], v[56:59]
    s_add_u32 s20, s20, 12032
    v_cvt_pk_bf16_f32 v24, v60, v61
    v_cvt_pk_bf16_f32 v18, v52, v53
    v_mfma_f32_16x16x32_bf16 v[56:59], a[224:227], a[108:111], v[56:59]
    ds_read_b64_tr_b16 a[224:225], v5 offset:0
    ds_read_b64_tr_b16 a[226:227], v5 offset:6144
    s_waitcnt lgkmcnt(6)
    v_mfma_f32_16x16x32_bf16 v[112:115], a[212:215], v[14:17], v[112:115]
    ds_read_b64_tr_b16 a[232:233], v3 offset:1024
    v_fma_f32 v83, v83, s28, v12
    v_mfma_f32_16x16x32_bf16 v[160:163], a[212:215], v[20:23], v[160:163]
    v_fma_f32 v73, v73, s28, v11
    v_fma_f32 v66, v66, s28, v10
    v_mfma_f32_16x16x32_bf16 v[208:211], a[212:215], v[26:29], v[208:211]
    ds_read_b64_tr_b16 a[230:231], v2 offset:7168
    v_mfma_f32_16x16x32_bf16 a[0:3], a[212:215], v[32:35], a[0:3]
    v_fma_f32 v62, v62, s28, v10
    s_waitcnt lgkmcnt(6)
    v_mfma_f32_16x16x32_bf16 a[4:7], a[216:219], v[32:35], a[4:7]
    ds_read_b64_tr_b16 a[228:229], v2 offset:1024
    v_mfma_f32_16x16x32_bf16 v[212:215], a[216:219], v[26:29], v[212:215]
    v_fma_f32 v78, v78, s28, v12
    v_fma_f32 v76, v76, s28, v12
    v_mfma_f32_16x16x32_bf16 v[164:167], a[216:219], v[20:23], v[164:167]
    ds_read_b64_tr_b16 a[212:213], v4 offset:1024
    v_fma_f32 v71, v71, s28, v11
    v_mfma_f32_16x16x32_bf16 v[116:119], a[216:219], v[14:17], v[116:119]
    ds_read_b64_tr_b16 a[214:215], v4 offset:7168
    s_waitcnt lgkmcnt(7)
    v_mfma_f32_16x16x32_bf16 v[120:123], a[220:223], v[14:17], v[120:123]
    v_exp_f32 v71, v71
    v_mfma_f32_16x16x32_bf16 v[168:171], a[220:223], v[20:23], v[168:171]
    ds_read_b64_tr_b16 a[234:235], v3 offset:7168
    v_fma_f32 v79, v79, s28, v12
    v_mfma_f32_16x16x32_bf16 v[216:219], a[220:223], v[26:29], v[216:219]
    v_exp_f32 v62, v62
    v_mfma_f32_16x16x32_bf16 a[8:11], a[220:223], v[32:35], a[8:11]
    s_waitcnt lgkmcnt(5)
    ds_read_b64_tr_b16 a[220:221], v2 offset:2048
    v_fma_f32 v77, v77, s28, v12
    v_mfma_f32_16x16x32_bf16 a[12:15], a[224:227], v[32:35], a[12:15]
    ds_read_b64_tr_b16 a[222:223], v2 offset:8192
    v_fma_f32 v59, v59, s28, v9
    v_mfma_f32_16x16x32_bf16 v[220:223], a[224:227], v[26:29], v[220:223]
    ds_read_b64_tr_b16 a[216:217], v5 offset:1024
    v_fma_f32 v82, v82, s28, v12
    v_mfma_f32_16x16x32_bf16 v[172:175], a[224:227], v[20:23], v[172:175]
    v_exp_f32 v77, v77
    v_mfma_f32_16x16x32_bf16 v[124:127], a[224:227], v[14:17], v[124:127]
    s_waitcnt lgkmcnt(6)
    ds_read_b64_tr_b16 a[218:219], v5 offset:7168
    v_fma_f32 v69, v69, s28, v11
    v_mfma_f32_16x16x32_bf16 v[128:131], a[228:231], v[14:17], v[128:131]
    v_fma_f32 v63, v63, s28, v10
    v_fma_f32 v80, v80, s28, v12
    v_mfma_f32_16x16x32_bf16 v[176:179], a[228:231], v[20:23], v[176:179]
    v_exp_f32 v83, v83
    v_mfma_f32_16x16x32_bf16 v[224:227], a[228:231], v[26:29], v[224:227]
    ds_read_b64_tr_b16 a[224:225], v3 offset:2048
    v_fma_f32 v74, v74, s28, v11
    v_mfma_f32_16x16x32_bf16 a[16:19], a[228:231], v[32:35], a[16:19]
    s_waitcnt lgkmcnt(5)
    v_exp_f32 v79, v79
    v_mfma_f32_16x16x32_bf16 a[20:23], a[232:235], v[32:35], a[20:23]
    ds_read_b64_tr_b16 a[230:231], v4 offset:8192
    v_fma_f32 v75, v75, s28, v11
    v_mfma_f32_16x16x32_bf16 v[228:231], a[232:235], v[26:29], v[228:231]
    ds_read_b64_tr_b16 a[226:227], v3 offset:8192
    v_mfma_f32_16x16x32_bf16 v[180:183], a[232:235], v[20:23], v[180:183]
    ds_read_b64_tr_b16 a[228:229], v4 offset:2048
    v_fma_f32 v57, v57, s28, v9
    v_mfma_f32_16x16x32_bf16 v[132:135], a[232:235], v[14:17], v[132:135]
    ds_read_b64_tr_b16 a[232:233], v5 offset:2048
    v_fma_f32 v68, v68, s28, v11
    v_mfma_f32_16x16x32_bf16 v[136:139], a[212:215], v[14:17], v[136:139]
    s_add_u32 s39, s39, 12288
    ds_read_b64_tr_b16 a[234:235], v5 offset:8192
    v_fma_f32 v67, v67, s28, v10
    v_mfma_f32_16x16x32_bf16 v[184:187], a[212:215], v[20:23], v[184:187]
    v_exp_f32 v63, v63
    v_mfma_f32_16x16x32_bf16 v[232:235], a[212:215], v[26:29], v[232:235]
    v_fma_f32 v70, v70, s28, v11
    v_cvt_pk_bf16_f32 v25, v62, v63
    v_mfma_f32_16x16x32_bf16 a[24:27], a[212:215], v[32:35], a[24:27]
    s_waitcnt lgkmcnt(6)
    v_exp_f32 v67, v67
    v_mfma_f32_16x16x32_bf16 a[28:31], a[216:219], v[32:35], a[28:31]
    v_exp_f32 v69, v69
    v_mfma_f32_16x16x32_bf16 v[236:239], a[216:219], v[26:29], v[236:239]
    v_exp_f32 v75, v75
    v_mfma_f32_16x16x32_bf16 v[188:191], a[216:219], v[20:23], v[188:191]
    v_fma_f32 v56, v56, s28, v9
    v_fma_f32 v58, v58, s28, v9
    v_mfma_f32_16x16x32_bf16 v[140:143], a[216:219], v[14:17], v[140:143]
    v_exp_f32 v58, v58
    v_mfma_f32_16x16x32_bf16 v[144:147], a[220:223], v[14:17], v[144:147]
    v_exp_f32 v76, v76
    v_mfma_f32_16x16x32_bf16 v[192:195], a[220:223], v[20:23], v[192:195]
    ds_read_b128 v[88:91], v103 offset:1024
    s_waitcnt vmcnt(8) lgkmcnt(1)
    v_mfma_f32_16x16x32_bf16 v[240:243], a[220:223], v[26:29], v[240:243]
    s_barrier
    v_mfma_f32_16x16x32_bf16 a[32:35], a[220:223], v[32:35], a[32:35]
    ds_read_b128 a[216:219], v1 offset:0
    v_fma_f32 v64, v64, s28, v10
    v_mfma_f32_16x16x32_bf16 a[36:39], a[224:227], v[32:35], a[36:39]
    s_add_u32 m0, s22, 24576
    ds_read_b128 a[212:215], v0 offset:0
    v_fma_f32 v81, v81, s28, v12
    v_mfma_f32_16x16x32_bf16 v[244:247], a[224:227], v[26:29], v[244:247]
    v_exp_f32 v70, v70
    v_mfma_f32_16x16x32_bf16 v[196:199], a[224:227], v[20:23], v[196:199]
    ds_read_b128 a[220:223], v0 offset:1024
    v_fma_f32 v65, v65, s28, v10
    v_mfma_f32_16x16x32_bf16 v[148:151], a[224:227], v[14:17], v[148:151]
    buffer_load_dwordx4 v6, s[8:11], s21 offen lds
    v_mfma_f32_16x16x32_bf16 v[152:155], a[228:231], v[14:17], v[152:155]
    s_add_u32 s21, s21, 128
    v_exp_f32 v78, v78
    v_mfma_f32_16x16x32_bf16 v[200:203], a[228:231], v[20:23], v[200:203]
    s_add_u32 m0, s22, 25600
    v_exp_f32 v57, v57
    v_mfma_f32_16x16x32_bf16 v[248:251], a[228:231], v[26:29], v[248:251]
    buffer_load_dwordx4 v6, s[8:11], s21 offen lds
    v_mfma_f32_16x16x32_bf16 a[40:43], a[228:231], v[32:35], a[40:43]
    s_add_u32 s21, s21, 128
    v_exp_f32 v68, v68
    v_mfma_f32_16x16x32_bf16 a[44:47], a[232:235], v[32:35], a[44:47]
    v_fma_f32 v72, v72, s28, v11
    s_add_u32 m0, s22, 26624
    v_mfma_f32_16x16x32_bf16 v[252:255], a[232:235], v[26:29], v[252:255]
    buffer_load_dwordx4 v6, s[8:11], s21 offen lds
    v_mfma_f32_16x16x32_bf16 v[204:207], a[232:235], v[20:23], v[204:207]
    v_cvt_pk_bf16_f32 v31, v70, v71
    s_add_u32 s21, s21, 12032
    v_mfma_f32_16x16x32_bf16 v[156:159], a[232:235], v[14:17], v[156:159]
    s_waitcnt lgkmcnt(1)
    ds_read_b128 a[224:227], v1 offset:1024
    v_cvt_pk_bf16_f32 v30, v68, v69
    v_mfma_f32_16x16x32_bf16 v[52:55], a[212:215], a[96:99], 0
    v_exp_f32 v74, v74
    v_mfma_f32_16x16x32_bf16 v[52:55], a[216:219], a[100:103], v[52:55]
    s_waitcnt lgkmcnt(1)
    ds_read_b128 a[232:235], v1 offset:2048
    v_cvt_pk_bf16_f32 v37, v78, v79
    v_mfma_f32_16x16x32_bf16 v[52:55], a[220:223], a[104:107], v[52:55]
    ds_read_b128 v[96:99], v103 offset:2048
    s_add_u32 m0, s23, 1024
    v_mfma_f32_16x16x32_bf16 v[60:63], a[220:223], a[128:131], 0
    ds_read_b128 a[228:231], v0 offset:2048
    v_mfma_f32_16x16x32_bf16 v[60:63], a[216:219], a[124:127], v[60:63]
    v_exp_f32 v64, v64
    v_mfma_f32_16x16x32_bf16 v[60:63], a[212:215], a[120:123], v[60:63]
    buffer_load_dwordx4 v39, s[12:15], s25 offen nt lds
    v_mfma_f32_16x16x32_bf16 v[68:71], a[212:215], a[144:147], 0
    buffer_store_dwordx4 v[88:91], v39, s[16:19], s24 offen offset:0 nt
    s_bitcmp1_b32 s27, 0
    v_exp_f32 v82, v82
    v_mfma_f32_16x16x32_bf16 v[68:71], a[216:219], a[148:151], v[68:71]
    s_cselect_b32 s26, s49, 128
    v_exp_f32 v72, v72
    v_mfma_f32_16x16x32_bf16 v[68:71], a[220:223], a[152:155], v[68:71]
    v_cvt_pk_bf16_f32 v36, v76, v77
    s_bitcmp1_b32 s89, 0
    v_mfma_f32_16x16x32_bf16 v[76:79], a[220:223], a[176:179], 0
    v_exp_f32 v59, v59
    v_mfma_f32_16x16x32_bf16 v[76:79], a[216:219], a[172:175], v[76:79]
    v_exp_f32 v66, v66
    v_mfma_f32_16x16x32_bf16 v[76:79], a[212:215], a[168:171], v[76:79]
    s_waitcnt lgkmcnt(1)
    v_exp_f32 v73, v73
    v_mfma_f32_16x16x32_bf16 v[76:79], a[224:227], a[180:183], v[76:79]
    s_waitcnt lgkmcnt(0)
    v_exp_f32 v81, v81
    v_mfma_f32_16x16x32_bf16 v[76:79], a[228:231], a[184:187], v[76:79]
    ds_read_b128 a[212:215], v0 offset:6144
    v_add_u32 v103, 3072, v103
    v_mfma_f32_16x16x32_bf16 v[76:79], a[232:235], a[188:191], v[76:79]
    v_exp_f32 v80, v80
    v_mfma_f32_16x16x32_bf16 v[68:71], a[232:235], a[164:167], v[68:71]
    v_exp_f32 v65, v65
    v_mfma_f32_16x16x32_bf16 v[68:71], a[228:231], a[160:163], v[68:71]
    s_cselect_b32 s26, s26, 0
    ds_read_b128 a[216:219], v1 offset:6144
    s_lshr_b32 s27, s27, 1
    v_mfma_f32_16x16x32_bf16 v[68:71], a[224:227], a[156:159], v[68:71]
    v_exp_f32 v56, v56
    v_mfma_f32_16x16x32_bf16 v[60:63], a[224:227], a[132:135], v[60:63]
    v_cvt_pk_bf16_f32 v28, v72, v73
    v_cvt_pk_bf16_f32 v23, v66, v67
    v_mfma_f32_16x16x32_bf16 v[60:63], a[228:231], a[136:139], v[60:63]
    s_lshr_b32 s89, s89, 1
    ds_read_b128 a[220:223], v0 offset:7168
    v_mfma_f32_16x16x32_bf16 v[60:63], a[232:235], a[140:143], v[60:63]
    s_add_u32 s24, s24, s26
    v_cvt_pk_bf16_f32 v29, v74, v75
    v_cvt_pk_bf16_f32 v17, v58, v59
    v_mfma_f32_16x16x32_bf16 v[52:55], a[232:235], a[116:119], v[52:55]
    v_cvt_pk_bf16_f32 v16, v56, v57
    v_mfma_f32_16x16x32_bf16 v[52:55], a[228:231], a[112:115], v[52:55]
    ds_read_b128 a[228:231], v0 offset:8192
    v_cvt_pk_bf16_f32 v34, v80, v81
    v_mfma_f32_16x16x32_bf16 v[52:55], a[224:227], a[108:111], v[52:55]
    s_waitcnt lgkmcnt(3)
    ds_read_b128 a[224:227], v1 offset:7168
    s_add_u32 s25, s25, s26
    v_mfma_f32_16x16x32_bf16 v[56:59], a[212:215], a[96:99], 0
    s_add_u32 m0, s23, 2048
    ds_read_b128 a[232:235], v1 offset:8192
    v_cvt_pk_bf16_f32 v22, v64, v65
    v_mfma_f32_16x16x32_bf16 v[48:51], a[236:239], v[16:19], v[44:47]
    buffer_load_dwordx4 v38, s[12:15], s25 offen nt lds
    v_mfma_f32_16x16x32_bf16 v[48:51], a[240:243], v[22:25], v[48:51]
    v_cvt_pk_bf16_f32 v35, v82, v83
    v_mfma_f32_16x16x32_bf16 v[48:51], a[244:247], v[28:31], v[48:51]
    s_bitcmp1_b32 s27, 0
    v_mfma_f32_16x16x32_bf16 v[48:51], a[248:251], v[34:37], v[48:51]
    buffer_store_dwordx4 v[96:99], v38, s[16:19], s24 offen offset:0 nt
    s_cselect_b32 s26, s49, 128
    s_bitcmp1_b32 s89, 0
    s_cselect_b32 s26, s26, 0
    s_lshr_b32 s27, s27, 1
    s_waitcnt lgkmcnt(3)
    v_mfma_f32_16x16x32_bf16 v[56:59], a[216:219], a[100:103], v[56:59]
    s_lshr_b32 s89, s89, 1
    s_add_u32 s24, s24, s26
    v_cmp_lt_f32 vcc, s29, v48
    v_mfma_f32_16x16x32_bf16 v[56:59], a[220:223], a[104:107], v[56:59]
    s_add_u32 s25, s25, s26
    v_swap_b32 v38, v39
    v_mfma_f32_16x16x32_bf16 v[64:67], a[220:223], a[128:131], 0
    s_add_u32 s23, s23, 3072
    s_cbranch_vccnz L_rs_loop4w0b
L_ret_loop4w0b:
    v_mfma_f32_16x16x32_bf16 v[64:67], a[216:219], a[124:127], v[64:67]
    v_fma_f32 v53, v53, s28, v9
    s_waitcnt vmcnt(12) lgkmcnt(0)
    v_mfma_f32_16x16x32_bf16 v[64:67], a[212:215], a[120:123], v[64:67]
    s_barrier
    v_mfma_f32_16x16x32_bf16 v[72:75], a[212:215], a[144:147], 0
    s_cmp_eq_u32 s30, 5
    v_fma_f32 v55, v55, s28, v9
    s_cselect_b32 s26, s62, 0
    v_mfma_f32_16x16x32_bf16 v[72:75], a[216:219], a[148:151], v[72:75]
    s_add_u32 s20, s20, s26
    v_fma_f32 v54, v54, s28, v9
    s_add_u32 m0, s22, 0
    v_mfma_f32_16x16x32_bf16 v[72:75], a[220:223], a[152:155], v[72:75]
    buffer_load_dwordx4 v6, s[4:7], s20 offen lds
    v_mfma_f32_16x16x32_bf16 v[80:83], a[220:223], a[176:179], 0
    s_add_u32 s20, s20, 128
    v_exp_f32 v53, v53
    v_mfma_f32_16x16x32_bf16 v[80:83], a[216:219], a[172:175], v[80:83]
    s_add_u32 m0, s22, 1024
    v_exp_f32 v54, v54
    v_mfma_f32_16x16x32_bf16 v[80:83], a[212:215], a[168:171], v[80:83]
    buffer_load_dwordx4 v6, s[4:7], s20 offen lds
    v_mfma_f32_16x16x32_bf16 v[80:83], a[224:227], a[180:183], v[80:83]
    s_add_u32 s20, s20, 128
    ds_read_b64_tr_b16 a[212:213], v2 offset:18432
    v_fma_f32 v60, v60, s28, v10
    v_mfma_f32_16x16x32_bf16 v[80:83], a[228:231], a[184:187], v[80:83]
    s_add_u32 m0, s22, 2048
    ds_read_b64_tr_b16 a[214:215], v2 offset:12288
    v_fma_f32 v61, v61, s28, v10
    v_mfma_f32_16x16x32_bf16 v[80:83], a[232:235], a[188:191], v[80:83]
    buffer_load_dwordx4 v6, s[4:7], s20 offen lds
    v_mfma_f32_16x16x32_bf16 v[72:75], a[232:235], a[164:167], v[72:75]
    v_exp_f32 v61, v61
    v_mfma_f32_16x16x32_bf16 v[72:75], a[228:231], a[160:163], v[72:75]
    v_exp_f32 v55, v55
    v_mfma_f32_16x16x32_bf16 v[72:75], a[224:227], a[156:159], v[72:75]
    s_add_u32 s20, s20, 12032
    ds_read_b64_tr_b16 a[216:217], v3 offset:18432
    v_fma_f32 v52, v52, s28, v9
    v_mfma_f32_16x16x32_bf16 v[64:67], a[224:227], a[132:135], v[64:67]
    v_exp_f32 v60, v60
    v_mfma_f32_16x16x32_bf16 v[64:67], a[228:231], a[136:139], v[64:67]
    ds_read_b64_tr_b16 a[218:219], v3 offset:12288
    v_cvt_pk_bf16_f32 v20, v60, v61
    v_mfma_f32_16x16x32_bf16 v[64:67], a[232:235], a[140:143], v[64:67]
    ds_read_b64_tr_b16 a[220:221], v4 offset:18432
    v_cvt_pk_bf16_f32 v15, v54, v55
    v_mfma_f32_16x16x32_bf16 v[56:59], a[232:235], a[116:119], v[56:59]
    v_exp_f32 v52, v52
    v_mfma_f32_16x16x32_bf16 v[56:59], a[228:231], a[112:115], v[56:59]
    s_add_u32 s30, s30, 1
    ds_read_b64_tr_b16 a[222:223], v4 offset:12288
    v_cvt_pk_bf16_f32 v14, v52, v53
    v_mfma_f32_16x16x32_bf16 v[56:59], a[224:227], a[108:111], v[56:59]
    s_cmp_lt_u32 s30, 6
    ds_read_b64_tr_b16 a[224:225], v5 offset:18432
    ds_read_b64_tr_b16 a[226:227], v5 offset:12288
    s_cbranch_scc1 L_loop4w0
    s_cmp_ge_u32 s37, 6
    s_cbranch_scc1 L_end4
    s_cmp_eq_u32 s32, 0
    s_cbranch_scc1 L_tr44
    s_branch L_tr45
L_tr45:
    s_waitcnt lgkmcnt(6)
    v_mfma_f32_16x16x32_bf16 v[112:115], a[212:215], v[16:19], v[112:115]
    ds_read_b64_tr_b16 a[230:231], v2 offset:13312
    v_mbcnt_lo_u32_b32 v107, -1, 0
    v_mfma_f32_16x16x32_bf16 v[160:163], a[212:215], v[22:25], v[160:163]
    v_mbcnt_hi_u32_b32 v107, -1, v107
    v_fma_f32 v79, v79, s28, v12
    v_mfma_f32_16x16x32_bf16 v[208:211], a[212:215], v[28:31], v[208:211]
    v_fma_f32 v62, v62, s28, v10
    v_fma_f32 v65, v65, s28, v10
    v_mfma_f32_16x16x32_bf16 a[0:3], a[212:215], v[34:37], a[0:3]
    v_and_b32 v106, 15, v107
    s_waitcnt lgkmcnt(5)
    v_mfma_f32_16x16x32_bf16 a[4:7], a[216:219], v[34:37], a[4:7]
    s_add_u32 s39, s39, 12288
    ds_read_b64_tr_b16 a[228:229], v2 offset:19456
    v_fma_f32 v69, v69, s28, v11
    v_mfma_f32_16x16x32_bf16 v[212:215], a[216:219], v[28:31], v[212:215]
    s_add_u32 s48, s33, 24576
    v_fma_f32 v56, v56, s28, v9
    v_lshrrev_b32 v107, 4, v107
    v_mfma_f32_16x16x32_bf16 v[164:167], a[216:219], v[22:25], v[164:167]
    ds_read_b64_tr_b16 a[232:233], v3 offset:19456
    v_mul_u32_u24 v106, 384, v106
    v_mfma_f32_16x16x32_bf16 v[116:119], a[216:219], v[16:19], v[116:119]
    ds_read_b64_tr_b16 a[214:215], v4 offset:13312
    s_waitcnt lgkmcnt(6)
    v_mfma_f32_16x16x32_bf16 v[120:123], a[220:223], v[16:19], v[120:123]
    ds_read_b64_tr_b16 a[234:235], v3 offset:13312
    v_lshl_add_u32 v106, v107, 4, v106
    v_mfma_f32_16x16x32_bf16 v[168:171], a[220:223], v[22:25], v[168:171]
    buffer_load_dwordx4 a[208:211], v106, s[12:15], s48 offen offset:256 nt
    v_mfma_f32_16x16x32_bf16 v[216:219], a[220:223], v[28:31], v[216:219]
    v_fma_f32 v59, v59, s28, v9
    v_fma_f32 v63, v63, s28, v10
    v_mfma_f32_16x16x32_bf16 a[8:11], a[220:223], v[34:37], a[8:11]
    s_waitcnt lgkmcnt(4)
    ds_read_b64_tr_b16 a[216:217], v5 offset:19456
    v_fma_f32 v57, v57, s28, v9
    v_mfma_f32_16x16x32_bf16 a[12:15], a[224:227], v[34:37], a[12:15]
    ds_read_b64_tr_b16 a[212:213], v4 offset:19456
    v_fma_f32 v83, v83, s28, v12
    v_mfma_f32_16x16x32_bf16 v[220:223], a[224:227], v[28:31], v[220:223]
    buffer_load_dwordx4 v[92:95], v106, s[12:15], s48 offen offset:320 nt
    v_mfma_f32_16x16x32_bf16 v[172:175], a[224:227], v[22:25], v[172:175]
    ds_read_b64_tr_b16 a[218:219], v5 offset:13312
    v_fma_f32 v70, v70, s28, v11
    v_mfma_f32_16x16x32_bf16 v[124:127], a[224:227], v[16:19], v[124:127]
    s_waitcnt lgkmcnt(6)
    ds_read_b64_tr_b16 a[226:227], v3 offset:14336
    v_fma_f32 v68, v68, s28, v11
    v_mfma_f32_16x16x32_bf16 v[128:131], a[228:231], v[16:19], v[128:131]
    ds_read_b64_tr_b16 a[224:225], v3 offset:20480
    v_fma_f32 v77, v77, s28, v12
    v_mfma_f32_16x16x32_bf16 v[176:179], a[228:231], v[22:25], v[176:179]
    ds_read_b64_tr_b16 a[222:223], v2 offset:14336
    v_fma_f32 v78, v78, s28, v12
    v_mfma_f32_16x16x32_bf16 v[224:227], a[228:231], v[28:31], v[224:227]
    v_exp_f32 v63, v63
    v_mfma_f32_16x16x32_bf16 a[16:19], a[228:231], v[34:37], a[16:19]
    s_waitcnt lgkmcnt(6)
    v_fma_f32 v71, v71, s28, v11
    v_fma_f32 v66, v66, s28, v10
    v_mfma_f32_16x16x32_bf16 a[20:23], a[232:235], v[34:37], a[20:23]
    ds_read_b64_tr_b16 a[220:221], v2 offset:20480
    v_fma_f32 v81, v81, s28, v12
    v_mfma_f32_16x16x32_bf16 v[228:231], a[232:235], v[28:31], v[228:231]
    ds_read_b64_tr_b16 a[230:231], v4 offset:14336
    v_fma_f32 v67, v67, s28, v10
    v_mfma_f32_16x16x32_bf16 v[180:183], a[232:235], v[22:25], v[180:183]
    ds_read_b64_tr_b16 a[228:229], v4 offset:20480
    v_fma_f32 v72, v72, s28, v11
    v_mfma_f32_16x16x32_bf16 v[132:135], a[232:235], v[16:19], v[132:135]
    s_waitcnt lgkmcnt(7)
    ds_read_b64_tr_b16 a[234:235], v5 offset:14336
    ds_read_b64_tr_b16 a[232:233], v5 offset:20480
    v_mfma_f32_16x16x32_bf16 v[136:139], a[212:215], v[16:19], v[136:139]
    v_exp_f32 v62, v62
    v_mfma_f32_16x16x32_bf16 v[184:187], a[212:215], v[22:25], v[184:187]
    v_fma_f32 v58, v58, s28, v9
    v_fma_f32 v76, v76, s28, v12
    v_mfma_f32_16x16x32_bf16 v[232:235], a[212:215], v[28:31], v[232:235]
    v_exp_f32 v67, v67
    v_mfma_f32_16x16x32_bf16 a[24:27], a[212:215], v[34:37], a[24:27]
    s_waitcnt lgkmcnt(5)
    v_exp_f32 v69, v69
    v_mfma_f32_16x16x32_bf16 a[28:31], a[216:219], v[34:37], a[28:31]
    v_exp_f32 v70, v70
    v_mfma_f32_16x16x32_bf16 v[236:239], a[216:219], v[28:31], v[236:239]
    v_exp_f32 v58, v58
    v_mfma_f32_16x16x32_bf16 v[188:191], a[216:219], v[22:25], v[188:191]
    v_exp_f32 v68, v68
    v_mfma_f32_16x16x32_bf16 v[140:143], a[216:219], v[16:19], v[140:143]
    s_waitcnt lgkmcnt(3)
    v_exp_f32 v71, v71
    v_mfma_f32_16x16x32_bf16 v[144:147], a[220:223], v[16:19], v[144:147]
    ds_read_b128 v[84:87], v103 offset:0
    v_fma_f32 v64, v64, s28, v10
    v_mfma_f32_16x16x32_bf16 v[192:195], a[220:223], v[22:25], v[192:195]
    s_waitcnt vmcnt(12) lgkmcnt(1)
    v_exp_f32 v59, v59
    v_mfma_f32_16x16x32_bf16 v[240:243], a[220:223], v[28:31], v[240:243]
    s_barrier
    v_mfma_f32_16x16x32_bf16 a[32:35], a[220:223], v[34:37], a[32:35]
    ds_read_b128 a[220:223], v0 offset:13312
    v_fma_f32 v80, v80, s28, v12
    v_mfma_f32_16x16x32_bf16 a[36:39], a[224:227], v[34:37], a[36:39]
    ds_read_b128 a[212:215], v0 offset:12288
    v_exp_f32 v77, v77
    v_mfma_f32_16x16x32_bf16 v[244:247], a[224:227], v[28:31], v[244:247]
    ds_read_b128 a[216:219], v1 offset:12288
    s_add_u32 m0, s22, 36864
    v_mfma_f32_16x16x32_bf16 v[196:199], a[224:227], v[22:25], v[196:199]
    ds_read_b128 v[88:91], v103 offset:1024
    v_fma_f32 v75, v75, s28, v11
    v_mfma_f32_16x16x32_bf16 v[148:151], a[224:227], v[16:19], v[148:151]
    buffer_load_dwordx4 v6, s[8:11], s21 offen lds
    v_mfma_f32_16x16x32_bf16 v[152:155], a[228:231], v[16:19], v[152:155]
    s_add_u32 s21, s21, 128
    v_exp_f32 v75, v75
    v_mfma_f32_16x16x32_bf16 v[200:203], a[228:231], v[22:25], v[200:203]
    s_add_u32 m0, s22, 37888
    v_exp_f32 v78, v78
    v_mfma_f32_16x16x32_bf16 v[248:251], a[228:231], v[28:31], v[248:251]
    buffer_load_dwordx4 v6, s[8:11], s21 offen lds
    v_mfma_f32_16x16x32_bf16 a[40:43], a[228:231], v[34:37], a[40:43]
    s_add_u32 s21, s21, 128
    v_exp_f32 v79, v79
    v_mfma_f32_16x16x32_bf16 a[44:47], a[232:235], v[34:37], a[44:47]
    s_add_u32 m0, s22, 38912
    v_exp_f32 v57, v57
    v_mfma_f32_16x16x32_bf16 v[252:255], a[232:235], v[28:31], v[252:255]
    buffer_load_dwordx4 v6, s[8:11], s21 offen lds
    v_mfma_f32_16x16x32_bf16 v[204:207], a[232:235], v[22:25], v[204:207]
    ds_read_b128 a[224:227], v1 offset:13312
    v_cvt_pk_bf16_f32 v21, v62, v63
    v_mfma_f32_16x16x32_bf16 v[156:159], a[232:235], v[16:19], v[156:159]
    s_waitcnt lgkmcnt(2)
    v_exp_f32 v66, v66
    v_mfma_f32_16x16x32_bf16 v[52:55], a[212:215], a[96:99], 0
    buffer_store_dwordx4 v[84:87], v6, s[16:19], s24 offen offset:0 nt
    ds_read_b128 a[228:231], v0 offset:14336
    v_cvt_pk_bf16_f32 v26, v68, v69
    v_cvt_pk_bf16_f32 v33, v78, v79
    v_mfma_f32_16x16x32_bf16 v[52:55], a[216:219], a[100:103], v[52:55]
    v_fma_f32 v74, v74, s28, v11
    v_cvt_pk_bf16_f32 v23, v66, v67
    v_mfma_f32_16x16x32_bf16 v[52:55], a[220:223], a[104:107], v[52:55]
    s_add_u32 s21, s21, 12032
    v_exp_f32 v56, v56
    v_mfma_f32_16x16x32_bf16 v[60:63], a[220:223], a[128:131], 0
    ds_read_b128 a[232:235], v1 offset:14336
    v_cvt_pk_bf16_f32 v27, v70, v71
    v_mfma_f32_16x16x32_bf16 v[60:63], a[216:219], a[124:127], v[60:63]
    v_exp_f32 v76, v76
    v_mfma_f32_16x16x32_bf16 v[60:63], a[212:215], a[120:123], v[60:63]
    s_add_u32 m0, s38, 24576
    v_exp_f32 v72, v72
    v_mfma_f32_16x16x32_bf16 v[68:71], a[212:215], a[144:147], 0
    buffer_load_dwordx4 v6, s[12:15], s25 offen nt lds
    v_mfma_f32_16x16x32_bf16 v[68:71], a[216:219], a[148:151], v[68:71]
    v_cvt_pk_bf16_f32 v32, v76, v77
    v_cvt_pk_bf16_f32 v17, v58, v59
    v_mfma_f32_16x16x32_bf16 v[68:71], a[220:223], a[152:155], v[68:71]
    v_exp_f32 v74, v74
    v_mfma_f32_16x16x32_bf16 v[76:79], a[220:223], a[176:179], 0
    s_add_u32 m0, s38, 25600
    v_exp_f32 v83, v83
    v_mfma_f32_16x16x32_bf16 v[76:79], a[216:219], a[172:175], v[76:79]
    ds_read_b128 v[84:87], v103 offset:3072
    v_mfma_f32_16x16x32_bf16 v[76:79], a[212:215], a[168:171], v[76:79]
    s_waitcnt lgkmcnt(2)
    ds_read_b128 v[96:99], v103 offset:2048
    v_fma_f32 v73, v73, s28, v11
    v_mfma_f32_16x16x32_bf16 v[76:79], a[224:227], a[180:183], v[76:79]
    ds_read_b128 a[212:215], v0 offset:18432
    v_mfma_f32_16x16x32_bf16 v[76:79], a[228:231], a[184:187], v[76:79]
    s_waitcnt lgkmcnt(3)
    v_exp_f32 v73, v73
    v_mfma_f32_16x16x32_bf16 v[76:79], a[232:235], a[188:191], v[76:79]
    v_exp_f32 v65, v65
    v_mfma_f32_16x16x32_bf16 v[68:71], a[232:235], a[164:167], v[68:71]
    buffer_load_dwordx4 v7, s[12:15], s25 offen nt lds
    v_mfma_f32_16x16x32_bf16 v[68:71], a[228:231], a[160:163], v[68:71]
    v_exp_f32 v64, v64
    v_mfma_f32_16x16x32_bf16 v[68:71], a[224:227], a[156:159], v[68:71]
    ds_read_b128 a[220:223], v0 offset:19456
    v_cvt_pk_bf16_f32 v22, v64, v65
    v_mfma_f32_16x16x32_bf16 v[60:63], a[224:227], a[132:135], v[60:63]
    ds_read_b128 a[216:219], v1 offset:18432
    v_fma_f32 v82, v82, s28, v12
    v_cvt_pk_bf16_f32 v16, v56, v57
    v_mfma_f32_16x16x32_bf16 v[60:63], a[228:231], a[136:139], v[60:63]
    v_exp_f32 v81, v81
    v_mfma_f32_16x16x32_bf16 v[60:63], a[232:235], a[140:143], v[60:63]
    v_exp_f32 v80, v80
    v_mfma_f32_16x16x32_bf16 v[52:55], a[232:235], a[116:119], v[52:55]
    v_exp_f32 v82, v82
    v_mfma_f32_16x16x32_bf16 v[52:55], a[228:231], a[112:115], v[52:55]
    ds_read_b128 a[232:235], v1 offset:20480
    v_cvt_pk_bf16_f32 v29, v74, v75
    v_mfma_f32_16x16x32_bf16 v[44:47], a[236:239], v[14:17], v[48:51]
    ds_read_b128 a[228:231], v0 offset:20480
    s_add_u32 s57, s24, 128
    v_mfma_f32_16x16x32_bf16 v[52:55], a[224:227], a[108:111], v[52:55]
    ds_read_b128 a[224:227], v1 offset:19456
    v_cvt_pk_bf16_f32 v28, v72, v73
    v_mfma_f32_16x16x32_bf16 v[44:47], a[240:243], v[20:23], v[44:47]
    v_cvt_pk_bf16_f32 v34, v80, v81
    v_cvt_pk_bf16_f32 v35, v82, v83
    v_mfma_f32_16x16x32_bf16 v[44:47], a[244:247], v[26:29], v[44:47]
    s_nop 0
    v_mfma_f32_16x16x32_bf16 v[44:47], a[248:251], v[32:35], v[44:47]
    s_add_u32 s59, s25, 128
    s_add_u32 m0, s38, 26624
    s_waitcnt lgkmcnt(3)
    v_mfma_f32_16x16x32_bf16 v[56:59], a[212:215], a[96:99], 0
    buffer_load_dwordx4 v6, s[12:15], s59 offen nt lds
    v_mfma_f32_16x16x32_bf16 v[56:59], a[216:219], a[100:103], v[56:59]
    s_add_u32 m0, s38, 27648
    s_nop 0
    v_cmp_lt_f32 vcc, s29, v44
    v_mfma_f32_16x16x32_bf16 v[56:59], a[220:223], a[104:107], v[56:59]
    buffer_load_dwordx4 v7, s[12:15], s59 offen nt lds
    v_mfma_f32_16x16x32_bf16 v[64:67], a[220:223], a[128:131], 0
    buffer_store_dwordx4 v[88:91], v7, s[16:19], s24 offen offset:0 nt
    s_nop 0
    s_cbranch_vccnz L_rs_tr45a
L_ret_tr45a:
    v_fma_f32 v55, v55, s28, v9
    v_mfma_f32_16x16x32_bf16 v[64:67], a[216:219], a[124:127], v[64:67]
    s_waitcnt vmcnt(15) lgkmcnt(0)
    s_add_u32 m0, s22, 12288
    v_mfma_f32_16x16x32_bf16 v[64:67], a[212:215], a[120:123], v[64:67]
    s_barrier
    v_mfma_f32_16x16x32_bf16 v[72:75], a[212:215], a[144:147], 0
    buffer_load_dwordx4 v6, s[4:7], s20 offen lds
    v_mfma_f32_16x16x32_bf16 v[72:75], a[216:219], a[148:151], v[72:75]
    v_fma_f32 v53, v53, s28, v9
    v_mfma_f32_16x16x32_bf16 v[72:75], a[220:223], a[152:155], v[72:75]
    s_add_u32 s20, s20, 128
    v_fma_f32 v54, v54, s28, v9
    s_add_u32 m0, s22, 13312
    v_mfma_f32_16x16x32_bf16 v[80:83], a[220:223], a[176:179], 0
    buffer_load_dwordx4 v6, s[4:7], s20 offen lds
    v_mfma_f32_16x16x32_bf16 v[80:83], a[216:219], a[172:175], v[80:83]
    s_add_u32 s20, s20, 128
    v_exp_f32 v55, v55
    v_mfma_f32_16x16x32_bf16 v[80:83], a[212:215], a[168:171], v[80:83]
    s_add_u32 m0, s22, 14336
    v_exp_f32 v53, v53
    v_mfma_f32_16x16x32_bf16 v[80:83], a[224:227], a[180:183], v[80:83]
    buffer_load_dwordx4 v6, s[4:7], s20 offen lds
    v_mfma_f32_16x16x32_bf16 v[80:83], a[228:231], a[184:187], v[80:83]
    buffer_store_dwordx4 v[96:99], v6, s[16:19], s57 offen offset:0 nt
    ds_read_b64_tr_b16 a[212:213], v2 offset:0
    v_fma_f32 v61, v61, s28, v10
    v_fma_f32 v60, v60, s28, v10
    v_mfma_f32_16x16x32_bf16 v[80:83], a[232:235], a[188:191], v[80:83]
    s_add_u32 s20, s20, 12032
    ds_read_b64_tr_b16 a[214:215], v2 offset:6144
    v_fma_f32 v52, v52, s28, v9
    v_mfma_f32_16x16x32_bf16 v[72:75], a[232:235], a[164:167], v[72:75]
    v_exp_f32 v60, v60
    v_mfma_f32_16x16x32_bf16 v[72:75], a[228:231], a[160:163], v[72:75]
    buffer_store_dwordx4 v[84:87], v7, s[16:19], s57 offen offset:0 nt
    ds_read_b64_tr_b16 a[216:217], v3 offset:0
    v_exp_f32 v61, v61
    v_mfma_f32_16x16x32_bf16 v[72:75], a[224:227], a[156:159], v[72:75]
    ds_read_b64_tr_b16 a[218:219], v3 offset:6144
    v_mfma_f32_16x16x32_bf16 v[64:67], a[224:227], a[132:135], v[64:67]
    v_exp_f32 v52, v52
    v_mfma_f32_16x16x32_bf16 v[64:67], a[228:231], a[136:139], v[64:67]
    ds_read_b64_tr_b16 a[220:221], v4 offset:0
    v_mfma_f32_16x16x32_bf16 v[64:67], a[232:235], a[140:143], v[64:67]
    v_exp_f32 v54, v54
    v_mfma_f32_16x16x32_bf16 v[56:59], a[232:235], a[116:119], v[56:59]
    ds_read_b64_tr_b16 a[222:223], v4 offset:6144
    v_cvt_pk_bf16_f32 v19, v54, v55
    v_mfma_f32_16x16x32_bf16 v[56:59], a[228:231], a[112:115], v[56:59]
    v_cvt_pk_bf16_f32 v18, v52, v53
    v_cvt_pk_bf16_f32 v24, v60, v61
    v_mfma_f32_16x16x32_bf16 v[56:59], a[224:227], a[108:111], v[56:59]
    ds_read_b64_tr_b16 a[224:225], v5 offset:0
    ds_read_b64_tr_b16 a[226:227], v5 offset:6144
    ds_read_b64_tr_b16 a[228:229], v2 offset:1024
    v_fma_f32 v64, v64, s28, v10
    s_waitcnt lgkmcnt(7)
    v_mfma_f32_16x16x32_bf16 v[112:115], a[212:215], v[14:17], v[112:115]
    ds_read_b64_tr_b16 a[230:231], v2 offset:7168
    v_fma_f32 v62, v62, s28, v10
    v_mfma_f32_16x16x32_bf16 v[160:163], a[212:215], v[20:23], v[160:163]
    v_lshrrev_b32 v105, 11, v0
    v_fma_f32 v70, v70, s28, v11
    v_mfma_f32_16x16x32_bf16 v[208:211], a[212:215], v[26:29], v[208:211]
    v_fma_f32 v59, v59, s28, v9
    v_and_b32 v104, 0x3ff, v0
    v_mfma_f32_16x16x32_bf16 a[0:3], a[212:215], v[32:35], a[0:3]
    s_waitcnt lgkmcnt(6)
    ds_read_b64_tr_b16 a[212:213], v4 offset:1024
    v_xor_b32 v105, s65, v105
    v_mfma_f32_16x16x32_bf16 a[4:7], a[216:219], v[32:35], a[4:7]
    ds_read_b64_tr_b16 a[232:233], v3 offset:1024
    v_fma_f32 v76, v76, s28, v12
    v_mfma_f32_16x16x32_bf16 v[212:215], a[216:219], v[26:29], v[212:215]
    v_exp_f32 v76, v76
    v_mfma_f32_16x16x32_bf16 v[164:167], a[216:219], v[20:23], v[164:167]
    v_exp_f32 v59, v59
    v_mfma_f32_16x16x32_bf16 v[116:119], a[216:219], v[14:17], v[116:119]
    s_waitcnt lgkmcnt(6)
    v_exp_f32 v70, v70
    v_mfma_f32_16x16x32_bf16 v[120:123], a[220:223], v[14:17], v[120:123]
    v_fma_f32 v69, v69, s28, v11
    v_fma_f32 v78, v78, s28, v12
    v_mfma_f32_16x16x32_bf16 v[168:171], a[220:223], v[20:23], v[168:171]
    ds_read_b64_tr_b16 a[234:235], v3 offset:7168
    v_fma_f32 v63, v63, s28, v10
    v_mfma_f32_16x16x32_bf16 v[216:219], a[220:223], v[26:29], v[216:219]
    ds_read_b64_tr_b16 a[214:215], v4 offset:7168
    v_lshl_add_u32 v104, v105, 10, v104
    v_mfma_f32_16x16x32_bf16 a[8:11], a[220:223], v[32:35], a[8:11]
    s_waitcnt lgkmcnt(4)
    v_fma_f32 v67, v67, s28, v10
    v_add_u32 v104, s38, v104
    v_mfma_f32_16x16x32_bf16 a[12:15], a[224:227], v[32:35], a[12:15]
    ds_read_b64_tr_b16 a[218:219], v5 offset:7168
    v_fma_f32 v77, v77, s28, v12
    v_mfma_f32_16x16x32_bf16 v[220:223], a[224:227], v[26:29], v[220:223]
    ds_read_b64_tr_b16 a[216:217], v5 offset:1024
    v_fma_f32 v73, v73, s28, v11
    v_mfma_f32_16x16x32_bf16 v[172:175], a[224:227], v[20:23], v[172:175]
    v_exp_f32 v62, v62
    v_mfma_f32_16x16x32_bf16 v[124:127], a[224:227], v[14:17], v[124:127]
    v_exp_f32 v69, v69
    v_mfma_f32_16x16x32_bf16 v[128:131], a[228:231], v[14:17], v[128:131]
    ds_read_b64_tr_b16 a[222:223], v2 offset:8192
    v_fma_f32 v58, v58, s28, v9
    v_mfma_f32_16x16x32_bf16 v[176:179], a[228:231], v[20:23], v[176:179]
    ds_read_b64_tr_b16 a[220:221], v2 offset:2048
    v_fma_f32 v80, v80, s28, v12
    v_mfma_f32_16x16x32_bf16 v[224:227], a[228:231], v[26:29], v[224:227]
    ds_read_b64_tr_b16 a[226:227], v3 offset:8192
    v_fma_f32 v68, v68, s28, v11
    v_mfma_f32_16x16x32_bf16 a[16:19], a[228:231], v[32:35], a[16:19]
    s_waitcnt lgkmcnt(6)
    ds_read_b64_tr_b16 a[228:229], v4 offset:2048
    v_fma_f32 v79, v79, s28, v12
    v_mfma_f32_16x16x32_bf16 a[20:23], a[232:235], v[32:35], a[20:23]
    v_exp_f32 v63, v63
    v_mfma_f32_16x16x32_bf16 v[228:231], a[232:235], v[26:29], v[228:231]
    ds_read_b64_tr_b16 a[230:231], v4 offset:8192
    v_fma_f32 v74, v74, s28, v11
    v_mfma_f32_16x16x32_bf16 v[180:183], a[232:235], v[20:23], v[180:183]
    ds_read_b64_tr_b16 a[224:225], v3 offset:2048
    v_fma_f32 v83, v83, s28, v12
    v_mfma_f32_16x16x32_bf16 v[132:135], a[232:235], v[14:17], v[132:135]
    s_waitcnt lgkmcnt(6)
    ds_read_b64_tr_b16 a[232:233], v5 offset:2048
    v_xor_b32 v105, 64, v104
    v_mfma_f32_16x16x32_bf16 v[136:139], a[212:215], v[14:17], v[136:139]
    ds_read_b64_tr_b16 a[234:235], v5 offset:8192
    v_exp_f32 v68, v68
    v_mfma_f32_16x16x32_bf16 v[184:187], a[212:215], v[20:23], v[184:187]
    s_add_u32 s39, s39, 12288
    v_exp_f32 v77, v77
    v_mfma_f32_16x16x32_bf16 v[232:235], a[212:215], v[26:29], v[232:235]
    ds_read_b128 a[176:179], v104 offset:20480
    v_fma_f32 v71, v71, s28, v11
    v_mfma_f32_16x16x32_bf16 a[24:27], a[212:215], v[32:35], a[24:27]
    ds_read_b128 a[120:123], v104 offset:6144
    v_exp_f32 v78, v78
    v_mfma_f32_16x16x32_bf16 a[28:31], a[216:219], v[32:35], a[28:31]
    ds_read_b128 a[152:155], v104 offset:14336
    v_cvt_pk_bf16_f32 v36, v76, v77
    v_mfma_f32_16x16x32_bf16 v[236:239], a[216:219], v[26:29], v[236:239]
    ds_read_b128 a[144:147], v104 offset:12288
    v_fma_f32 v82, v82, s28, v12
    v_mfma_f32_16x16x32_bf16 v[188:191], a[216:219], v[20:23], v[188:191]
    ds_read_b128 a[128:131], v104 offset:8192
    v_exp_f32 v71, v71
    v_mfma_f32_16x16x32_bf16 v[140:143], a[216:219], v[14:17], v[140:143]
    s_waitcnt lgkmcnt(7)
    v_cvt_pk_bf16_f32 v25, v62, v63
    v_fma_f32 v57, v57, s28, v9
    v_mfma_f32_16x16x32_bf16 v[144:147], a[220:223], v[14:17], v[144:147]
    ds_read_b128 a[96:99], v104 offset:0
    v_exp_f32 v58, v58
    v_mfma_f32_16x16x32_bf16 v[192:195], a[220:223], v[20:23], v[192:195]
    s_waitcnt vmcnt(16) lgkmcnt(6)
    ds_read_b128 a[168:171], v104 offset:18432
    v_fma_f32 v66, v66, s28, v10
    v_mfma_f32_16x16x32_bf16 v[240:243], a[220:223], v[26:29], v[240:243]
    s_barrier
    v_mfma_f32_16x16x32_bf16 a[32:35], a[220:223], v[32:35], a[32:35]
    s_add_u32 s21, s21, s62
    ds_read_b128 a[100:103], v105 offset:0
    v_exp_f32 v83, v83
    v_mfma_f32_16x16x32_bf16 a[36:39], a[224:227], v[32:35], a[36:39]
    s_add_u32 m0, s22, 24576
    ds_read_b128 a[124:127], v105 offset:6144
    buffer_load_dwordx4 v6, s[8:11], s21 offen lds
    v_mfma_f32_16x16x32_bf16 v[244:247], a[224:227], v[26:29], v[244:247]
    s_add_u32 s21, s21, 128
    ds_read_b128 a[172:175], v105 offset:18432
    v_fma_f32 v72, v72, s28, v11
    v_mfma_f32_16x16x32_bf16 v[196:199], a[224:227], v[20:23], v[196:199]
    ds_read_b128 a[212:215], v0 offset:0
    v_cvt_pk_bf16_f32 v31, v70, v71
    v_mfma_f32_16x16x32_bf16 v[148:151], a[224:227], v[14:17], v[148:151]
    s_add_u32 m0, s22, 25600
    ds_read_b128 a[216:219], v1 offset:0
    buffer_load_dwordx4 v6, s[8:11], s21 offen lds
    v_mfma_f32_16x16x32_bf16 v[152:155], a[228:231], v[14:17], v[152:155]
    s_add_u32 s21, s21, 128
    ds_read_b128 a[104:107], v104 offset:2048
    v_cvt_pk_bf16_f32 v30, v68, v69
    v_mfma_f32_16x16x32_bf16 v[200:203], a[228:231], v[20:23], v[200:203]
    s_add_u32 m0, s22, 26624
    ds_read_b128 a[220:223], v0 offset:1024
    buffer_load_dwordx4 v6, s[8:11], s21 offen lds
    v_mfma_f32_16x16x32_bf16 v[248:251], a[228:231], v[26:29], v[248:251]
    s_add_u32 s21, s21, 12032
    s_waitcnt vmcnt(11)
    ds_read_b128 a[192:195], v104 offset:24576
    v_mfma_f32_16x16x32_bf16 a[40:43], a[228:231], v[32:35], a[40:43]
    ds_read_b128 a[148:151], v105 offset:12288
    v_mfma_f32_16x16x32_bf16 a[44:47], a[232:235], v[32:35], a[44:47]
    ds_read_b128 a[196:199], v105 offset:24576
    v_exp_f32 v79, v79
    v_mfma_f32_16x16x32_bf16 v[252:255], a[232:235], v[26:29], v[252:255]
    ds_read_b128 a[108:111], v105 offset:2048
    v_cvt_pk_bf16_f32 v37, v78, v79
    v_mfma_f32_16x16x32_bf16 v[204:207], a[232:235], v[20:23], v[204:207]
    v_exp_f32 v66, v66
    v_mfma_f32_16x16x32_bf16 v[156:159], a[232:235], v[14:17], v[156:159]
    s_waitcnt lgkmcnt(7)
    ds_read_b128 a[180:183], v105 offset:20480
    s_waitcnt vmcnt(9)
    v_mfma_f32_16x16x32_bf16 v[52:55], a[212:215], a[96:99], 0
    ds_read_b128 a[224:227], v1 offset:1024
    v_exp_f32 v82, v82
    v_mfma_f32_16x16x32_bf16 v[60:63], a[212:215], a[120:123], 0
    ds_read_b128 a[200:203], v104 offset:26624
    v_fma_f32 v56, v56, s28, v9
    v_mfma_f32_16x16x32_bf16 v[68:71], a[212:215], a[144:147], 0
    ds_read_b128 a[132:135], v105 offset:8192
    v_cvt_pk_bf16_f32 v17, v58, v59
    v_mfma_f32_16x16x32_bf16 v[76:79], a[212:215], a[168:171], 0
    ds_read_b128 a[232:235], v1 offset:6144
    s_waitcnt lgkmcnt(8)
    v_mfma_f32_16x16x32_bf16 v[84:87], a[212:215], a[192:195], 0
    ds_read_b128 a[156:159], v105 offset:14336
    v_mfma_f32_16x16x32_bf16 v[52:55], a[216:219], a[100:103], v[52:55]
    v_exp_f32 v67, v67
    v_mfma_f32_16x16x32_bf16 v[60:63], a[216:219], a[124:127], v[60:63]
    s_waitcnt lgkmcnt(7)
    ds_read_b128 a[212:215], v0 offset:7168
    v_fma_f32 v65, v65, s28, v10
    v_mfma_f32_16x16x32_bf16 v[68:71], a[216:219], a[148:151], v[68:71]
    ds_read_b128 a[204:207], v105 offset:26624
    v_fma_f32 v81, v81, s28, v12
    v_mfma_f32_16x16x32_bf16 v[76:79], a[216:219], a[172:175], v[76:79]
    ds_read_b128 a[228:231], v0 offset:6144
    v_fma_f32 v75, v75, s28, v11
    v_mfma_f32_16x16x32_bf16 v[84:87], a[216:219], a[196:199], v[84:87]
    v_exp_f32 v57, v57
    v_mfma_f32_16x16x32_bf16 v[52:55], a[220:223], a[104:107], v[52:55]
    v_exp_f32 v56, v56
    v_mfma_f32_16x16x32_bf16 v[60:63], a[220:223], a[128:131], v[60:63]
    v_exp_f32 v64, v64
    v_mfma_f32_16x16x32_bf16 v[68:71], a[220:223], a[152:155], v[68:71]
    v_exp_f32 v72, v72
    v_mfma_f32_16x16x32_bf16 v[76:79], a[220:223], a[176:179], v[76:79]
    s_waitcnt lgkmcnt(4)
    v_exp_f32 v73, v73
    v_mfma_f32_16x16x32_bf16 v[84:87], a[220:223], a[200:203], v[84:87]
    v_exp_f32 v65, v65
    v_mfma_f32_16x16x32_bf16 v[52:55], a[224:227], a[108:111], v[52:55]
    v_exp_f32 v81, v81
    v_mfma_f32_16x16x32_bf16 v[60:63], a[224:227], a[132:135], v[60:63]
    s_waitcnt lgkmcnt(2)
    ds_read_b128 a[136:139], v104 offset:10240
    v_cvt_pk_bf16_f32 v22, v64, v65
    v_mfma_f32_16x16x32_bf16 v[68:71], a[224:227], a[156:159], v[68:71]
    v_exp_f32 v80, v80
    v_mfma_f32_16x16x32_bf16 v[76:79], a[224:227], a[180:183], v[76:79]
    s_waitcnt lgkmcnt(1)
    v_cvt_pk_bf16_f32 v16, v56, v57
    v_cvt_pk_bf16_f32 v23, v66, v67
    v_mfma_f32_16x16x32_bf16 v[84:87], a[224:227], a[204:207], v[84:87]
    v_exp_f32 v74, v74
    v_mfma_f32_16x16x32_bf16 v[48:51], a[236:239], v[16:19], v[44:47]
    ds_read_b128 a[224:227], v1 offset:2048
    v_cvt_pk_bf16_f32 v28, v72, v73
    v_mfma_f32_16x16x32_bf16 v[56:59], a[228:231], a[96:99], 0
    v_exp_f32 v75, v75
    v_mfma_f32_16x16x32_bf16 v[64:67], a[228:231], a[120:123], 0
    ds_read_b128 a[188:191], v105 offset:22528
    v_cvt_pk_bf16_f32 v29, v74, v75
    v_mfma_f32_16x16x32_bf16 v[72:75], a[228:231], a[144:147], 0
    v_cvt_pk_bf16_f32 v35, v82, v83
    v_cvt_pk_bf16_f32 v34, v80, v81
    v_mfma_f32_16x16x32_bf16 v[80:83], a[228:231], a[168:171], 0
    ds_read_b128 a[116:119], v105 offset:4096
    v_mfma_f32_16x16x32_bf16 v[88:91], a[228:231], a[192:195], 0
    ds_read_b128 a[216:219], v1 offset:7168
    v_mfma_f32_16x16x32_bf16 v[56:59], a[232:235], a[100:103], v[56:59]
    ds_read_b128 a[160:163], v104 offset:16384
    v_mfma_f32_16x16x32_bf16 v[64:67], a[232:235], a[124:127], v[64:67]
    ds_read_b128 a[220:223], v0 offset:2048
    v_mfma_f32_16x16x32_bf16 v[72:75], a[232:235], a[148:151], v[72:75]
    ds_read_b128 a[112:115], v104 offset:4096
    v_mfma_f32_16x16x32_bf16 v[80:83], a[232:235], a[172:175], v[80:83]
    ds_read_b128 a[228:231], v0 offset:8192
    v_mfma_f32_16x16x32_bf16 v[88:91], a[232:235], a[196:199], v[88:91]
    ds_read_b128 a[232:235], v1 offset:8192
    v_mfma_f32_16x16x32_bf16 v[56:59], a[212:215], a[104:107], v[56:59]
    ds_read_b128 a[140:143], v105 offset:10240
    v_mfma_f32_16x16x32_bf16 v[64:67], a[212:215], a[128:131], v[64:67]
    ds_read_b128 a[164:167], v105 offset:16384
    v_mfma_f32_16x16x32_bf16 v[48:51], a[240:243], v[22:25], v[48:51]
    v_mfma_f32_16x16x32_bf16 v[48:51], a[244:247], v[28:31], v[48:51]
    v_mfma_f32_16x16x32_bf16 v[72:75], a[212:215], a[152:155], v[72:75]
    v_mfma_f32_16x16x32_bf16 v[48:51], a[248:251], v[34:37], v[48:51]
    ds_read_b128 a[184:187], v104 offset:22528
    v_mfma_f32_16x16x32_bf16 v[80:83], a[212:215], a[176:179], v[80:83]
    s_waitcnt vmcnt(17)
    v_mfma_f32_16x16x32_bf16 v[88:91], a[212:215], a[200:203], v[88:91]
    s_waitcnt lgkmcnt(5)
    v_mfma_f32_16x16x32_bf16 v[56:59], a[216:219], a[108:111], v[56:59]
    s_nop 1
    v_cmp_lt_f32 vcc, s29, v48
    v_mfma_f32_16x16x32_bf16 v[64:67], a[216:219], a[132:135], v[64:67]
    s_waitcnt vmcnt(14) lgkmcnt(3)
    v_mfma_f32_16x16x32_bf16 v[72:75], a[216:219], a[156:159], v[72:75]
    s_barrier
    v_mfma_f32_16x16x32_bf16 v[80:83], a[216:219], a[180:183], v[80:83]
    s_cbranch_vccnz L_rs_tr45b
L_ret_tr45b:
    s_add_u32 m0, s22, 0
    v_mfma_f32_16x16x32_bf16 v[88:91], a[216:219], a[204:207], v[88:91]
    buffer_load_dwordx4 v6, s[4:7], s20 offen lds
    v_mfma_f32_16x16x32_bf16 v[52:55], a[220:223], a[112:115], v[52:55]
    s_add_u32 s20, s20, 128
    s_add_u32 m0, s22, 1024
    v_mfma_f32_16x16x32_bf16 v[60:63], a[220:223], a[136:139], v[60:63]
    buffer_load_dwordx4 v6, s[4:7], s20 offen lds
    v_mfma_f32_16x16x32_bf16 v[68:71], a[220:223], a[160:163], v[68:71]
    s_waitcnt lgkmcnt(0)
    ds_read_b64_tr_b16 a[212:213], v2 offset:18432
    s_add_u32 s20, s20, 128
    v_mfma_f32_16x16x32_bf16 v[76:79], a[220:223], a[184:187], v[76:79]
    s_add_u32 m0, s22, 2048
    ds_read_b64_tr_b16 a[214:215], v2 offset:12288
    v_lshrrev_b32 v108, 11, v0
    v_mfma_f32_16x16x32_bf16 v[84:87], a[220:223], a[208:211], v[84:87]
    buffer_load_dwordx4 v6, s[4:7], s20 offen lds
    v_mfma_f32_16x16x32_bf16 v[52:55], a[224:227], a[116:119], v[52:55]
    s_add_u32 s20, s20, 12032
    ds_read_b64_tr_b16 a[216:217], v3 offset:18432
    v_and_b32 v101, 0x3ff, v0
    v_mfma_f32_16x16x32_bf16 v[60:63], a[224:227], a[140:143], v[60:63]
    v_rcp_f32 v50, v50
    v_mfma_f32_16x16x32_bf16 v[68:71], a[224:227], a[164:167], v[68:71]
    ds_read_b64_tr_b16 a[218:219], v3 offset:12288
    v_mfma_f32_16x16x32_bf16 v[76:79], a[224:227], a[188:191], v[76:79]
    v_xor_b32 v108, s65, v108
    v_lshl_add_u32 v101, v108, 10, v101
    v_mfma_f32_16x16x32_bf16 v[84:87], a[224:227], v[92:95], v[84:87]
    v_rcp_f32 v8, v51
    v_mfma_f32_16x16x32_bf16 v[56:59], a[228:231], a[112:115], v[56:59]
    ds_read_b64_tr_b16 a[220:221], v4 offset:18432
    v_mov_b32 v100, v48
    v_mfma_f32_16x16x32_bf16 v[64:67], a[228:231], a[136:139], v[64:67]
    v_mbcnt_lo_u32_b32 v108, -1, 0
    v_mbcnt_hi_u32_b32 v108, -1, v108
    v_mfma_f32_16x16x32_bf16 v[72:75], a[228:231], a[160:163], v[72:75]
    v_rcp_f32 v102, v49
    v_mfma_f32_16x16x32_bf16 v[80:83], a[228:231], a[184:187], v[80:83]
    v_lshrrev_b32 v108, 1, v108
    v_add_u32 v101, s38, v101
    v_mfma_f32_16x16x32_bf16 v[88:91], a[228:231], a[208:211], v[88:91]
    ds_read_b64_tr_b16 a[222:223], v4 offset:12288
    v_and_b32 v108, 24, v108
    v_mfma_f32_16x16x32_bf16 v[56:59], a[232:235], a[116:119], v[56:59]
    ds_read_b64_tr_b16 a[224:225], v5 offset:18432
    v_mfma_f32_16x16x32_bf16 v[64:67], a[232:235], a[140:143], v[64:67]
    ds_read_b64_tr_b16 a[226:227], v5 offset:12288
    v_bfe_u32 v108, s66, v108, 8
    v_mfma_f32_16x16x32_bf16 v[72:75], a[232:235], a[164:167], v[72:75]
    v_permlane32_swap_b32 v48, v100
    v_mfma_f32_16x16x32_bf16 v[80:83], a[232:235], a[188:191], v[80:83]
    v_xor_b32 v101, v101, v108
    v_mfma_f32_16x16x32_bf16 v[88:91], a[232:235], v[92:95], v[88:91]
    v_rcp_f32 v48, v48
    v_max3_f32 v96, v52, v53, v54
    s_waitcnt lgkmcnt(6)
    v_mfma_f32_16x16x32_bf16 v[112:115], a[212:215], v[16:19], v[112:115]
    v_max3_f32 v96, v96, v55, v56
    v_max3_f32 v96, v96, v57, v58
    v_max_f32 v96, v96, v59
    v_max3_f32 v98, v60, v61, v62
    v_max3_f32 v98, v98, v63, v64
    v_max3_f32 v98, v98, v65, v66
    v_max_f32 v98, v98, v67
    v_mov_b32 v99, v98
    v_mov_b32 v97, v96
    v_mfma_f32_16x16x32_bf16 v[160:163], a[212:215], v[22:25], v[160:163]
    s_mov_b32 s67, s34
    ds_read_b64_tr_b16 a[232:233], v3 offset:19456
    v_permlane32_swap_b32 v99, v98
    v_max_f32 v98, v98, v99
    v_mfma_f32_16x16x32_bf16 v[208:211], a[212:215], v[28:31], v[208:211]
    s_add_u32 s18, s34, 24576
    v_permlane32_swap_b32 v97, v96
    v_max_f32 v96, v96, v97
    v_mfma_f32_16x16x32_bf16 a[0:3], a[212:215], v[34:37], a[0:3]
    s_waitcnt lgkmcnt(5)
    ds_read_b64_tr_b16 a[230:231], v2 offset:13312
    v_mov_b32 v99, v98
    v_mov_b32 v97, v96
    v_mfma_f32_16x16x32_bf16 a[4:7], a[216:219], v[34:37], a[4:7]
    s_mov_b32 s34, s33
    v_permlane16_swap_b32 v97, v96
    v_max_f32 v96, v96, v97
    v_mul_f32_e64 v9, -s28, v96
    v_mfma_f32_16x16x32_bf16 v[212:215], a[216:219], v[28:31], v[212:215]
    s_add_u32 s64, s64, s62
    ds_read_b64_tr_b16 a[228:229], v2 offset:19456
    v_max3_f32 v96, v68, v69, v70
    v_max3_f32 v96, v96, v71, v72
    v_max3_f32 v96, v96, v73, v74
    v_mfma_f32_16x16x32_bf16 v[164:167], a[216:219], v[22:25], v[164:167]
    s_add_u32 s64, s64, 196608
    ds_read_b64_tr_b16 a[234:235], v3 offset:13312
    v_max_f32 v96, v96, v75
    v_permlane16_swap_b32 v99, v98
    v_mov_b32 v97, v96
    v_mfma_f32_16x16x32_bf16 v[116:119], a[216:219], v[16:19], v[116:119]
    s_waitcnt lgkmcnt(4)
    v_fma_f32 v52, v52, s28, v9
    v_permlane32_swap_b32 v97, v96
    v_mfma_f32_16x16x32_bf16 v[120:123], a[220:223], v[16:19], v[120:123]
    ds_read_b64_tr_b16 a[214:215], v4 offset:13312
    v_max_f32 v98, v98, v99
    v_max_f32 v96, v96, v97
    v_fma_f32 v54, v54, s28, v9
    v_mfma_f32_16x16x32_bf16 v[168:171], a[220:223], v[22:25], v[168:171]
    s_mov_b32 s39, s64
    ds_read_b64_tr_b16 a[218:219], v5 offset:13312
    v_fma_f32 v57, v57, s28, v9
    v_mfma_f32_16x16x32_bf16 v[216:219], a[220:223], v[28:31], v[216:219]
    s_add_u32 s37, s37, 1
    ds_read_b64_tr_b16 a[212:213], v4 offset:19456
    v_mov_b32 v97, v96
    v_mfma_f32_16x16x32_bf16 a[8:11], a[220:223], v[34:37], a[8:11]
    s_bitcmp1_b32 s63, s37
    ds_read_b64_tr_b16 a[220:221], v2 offset:20480
    v_mul_f32_e64 v10, -s28, v98
    v_mfma_f32_16x16x32_bf16 a[12:15], a[224:227], v[34:37], a[12:15]
    s_cselect_b32 s62, 4294770688, 0
    v_fma_f32 v53, v53, s28, v9
    v_permlane16_swap_b32 v97, v96
    v_max_f32 v96, v96, v97
    v_max3_f32 v98, v76, v77, v78
    v_mfma_f32_16x16x32_bf16 v[220:223], a[224:227], v[28:31], v[220:223]
    s_cselect_b32 s42, 0, 325632
    ds_read_b64_tr_b16 a[216:217], v5 offset:19456
    v_fma_f32 v55, v55, s28, v9
    v_mfma_f32_16x16x32_bf16 v[172:175], a[224:227], v[22:25], v[172:175]
    s_add_u32 s35, s35, s42
    ds_read_b64_tr_b16 a[222:223], v2 offset:14336
    v_mul_f32_e64 v11, -s28, v96
    v_mfma_f32_16x16x32_bf16 v[124:127], a[224:227], v[16:19], v[124:127]
    s_waitcnt lgkmcnt(6)
    ds_read_b64_tr_b16 a[226:227], v3 offset:14336
    v_fma_f32 v75, v75, s28, v11
    v_mfma_f32_16x16x32_bf16 v[128:131], a[228:231], v[16:19], v[128:131]
    s_lshl_b32 s42, s37, 1
    v_max3_f32 v98, v98, v79, v80
    v_fma_f32 v58, v58, s28, v9
    v_mfma_f32_16x16x32_bf16 v[176:179], a[228:231], v[22:25], v[176:179]
    s_lshr_b32 s42, s31, s42
    v_max3_f32 v98, v98, v81, v82
    v_max3_f32 v96, v84, v85, v86
    v_mfma_f32_16x16x32_bf16 v[224:227], a[228:231], v[28:31], v[224:227]
    s_and_b32 s42, s42, 3
    v_fma_f32 v70, v70, s28, v11
    v_fma_f32 v67, v67, s28, v10
    v_mfma_f32_16x16x32_bf16 a[16:19], a[228:231], v[34:37], a[16:19]
    s_add_u32 s42, s42, s36
    ds_read_b64_tr_b16 a[224:225], v3 offset:20480
    v_max_f32 v98, v98, v83
    v_mfma_f32_16x16x32_bf16 a[20:23], a[232:235], v[34:37], a[20:23]
    s_sub_u32 s43, s42, 3
    v_fma_f32 v68, v68, s28, v11
    v_max3_f32 v96, v96, v87, v88
    v_exp_f32 v55, v55
    v_mfma_f32_16x16x32_bf16 v[228:231], a[232:235], v[28:31], v[228:231]
    s_cmp_ge_u32 s42, 3
    v_mov_b32 v99, v98
    v_exp_f32 v52, v52
    v_max3_f32 v96, v96, v89, v90
    v_permlane32_swap_b32 v99, v98
    v_mfma_f32_16x16x32_bf16 v[180:183], a[232:235], v[22:25], v[180:183]
    s_cselect_b32 s42, s43, s42
    ds_read_b64_tr_b16 a[230:231], v4 offset:14336
    v_max_f32 v98, v98, v99
    v_exp_f32 v54, v54
    v_mfma_f32_16x16x32_bf16 v[132:135], a[232:235], v[16:19], v[132:135]
    s_waitcnt lgkmcnt(2)
    v_fma_f32 v71, v71, s28, v11
    v_max_f32 v96, v96, v91
    v_mfma_f32_16x16x32_bf16 v[136:139], a[212:215], v[16:19], v[136:139]
    s_mul_i32 s44, s3, 5
    ds_read_b64_tr_b16 a[228:229], v4 offset:20480
    v_fma_f32 v69, v69, s28, v11
    v_mov_b32 v97, v96
    v_mfma_f32_16x16x32_bf16 v[184:187], a[212:215], v[22:25], v[184:187]
    s_mov_b32 s32, 1
    v_permlane32_swap_b32 v97, v96
    v_mfma_f32_16x16x32_bf16 v[232:235], a[212:215], v[28:31], v[232:235]
    s_lshl_b32 s43, s3, 2
    v_fma_f32 v61, v61, s28, v10
    v_subrev_u32 v103, 24576, v103
    v_mfma_f32_16x16x32_bf16 a[24:27], a[212:215], v[34:37], a[24:27]
    s_add_u32 s45, s43, 21
    v_max_f32 v96, v96, v97
    v_mov_b32 v99, v98
    v_mfma_f32_16x16x32_bf16 a[28:31], a[216:219], v[34:37], a[28:31]
    s_cmp_eq_u32 s3, 0
    v_exp_f32 v53, v53
    v_mfma_f32_16x16x32_bf16 v[236:239], a[216:219], v[28:31], v[236:239]
    s_cselect_b32 s45, 20, s45
    v_permlane16_swap_b32 v99, v98
    v_mov_b32 v97, v96
    v_mfma_f32_16x16x32_bf16 v[188:191], a[216:219], v[22:25], v[188:191]
    s_cselect_b32 s33, 1, 0
    v_exp_f32 v69, v69
    v_mfma_f32_16x16x32_bf16 v[140:143], a[216:219], v[16:19], v[140:143]
    s_cmp_eq_u32 s42, 1
    ds_read_b64_tr_b16 a[232:233], v5 offset:20480
    v_fma_f32 v64, v64, s28, v10
    v_mfma_f32_16x16x32_bf16 v[144:147], a[220:223], v[16:19], v[144:147]
    s_cselect_b32 s44, s45, s44
    v_permlane16_swap_b32 v97, v96
    s_cselect_b32 s32, s33, s32
    v_mfma_f32_16x16x32_bf16 v[192:195], a[220:223], v[22:25], v[192:195]
    s_add_u32 s45, s43, 37
    ds_read_b64_tr_b16 a[234:235], v5 offset:14336
    v_fma_f32 v60, v60, s28, v10
    v_mfma_f32_16x16x32_bf16 v[240:243], a[220:223], v[28:31], v[240:243]
    s_cmp_eq_u32 s42, 2
    s_cselect_b32 s44, s45, s44
    v_cvt_pk_bf16_f32 v15, v54, v55
    v_max_f32 v96, v96, v97
    v_fma_f32 v63, v63, s28, v10
    v_fma_f32 v59, v59, s28, v9
    v_mfma_f32_16x16x32_bf16 a[32:35], a[220:223], v[34:37], a[32:35]
    s_waitcnt lgkmcnt(2)
    v_max_f32 v98, v98, v99
    s_cselect_b32 s32, 0, s32
    v_mfma_f32_16x16x32_bf16 a[36:39], a[224:227], v[34:37], a[36:39]
    s_mul_i32 s44, s44, 6144
    v_exp_f32 v68, v68
    v_mul_f32_e64 v12, -s28, v98
    v_mfma_f32_16x16x32_bf16 v[244:247], a[224:227], v[28:31], v[244:247]
    s_add_u32 s33, s35, s44
    v_exp_f32 v59, v59
    v_mfma_f32_16x16x32_bf16 v[196:199], a[224:227], v[22:25], v[196:199]
    s_mul_i32 s42, s32, 6144
    s_add_u32 s42, s42, 24576
    v_fma_f32 v77, v77, s28, v12
    v_mfma_f32_16x16x32_bf16 v[148:151], a[224:227], v[16:19], v[148:151]
    s_add_u32 s42, s42, s33
    s_cmp_ge_u32 s37, 6
    v_fma_f32 v76, v76, s28, v12
    v_mfma_f32_16x16x32_bf16 v[152:155], a[228:231], v[16:19], v[152:155]
    s_cselect_b32 s14, 0, s42
    s_add_u32 s24, s67, 256
    v_mul_f32_e64 v13, -s28, v96
    s_add_u32 s25, s33, 256
    v_fma_f32 v62, v62, s28, v10
    s_add_u32 s23, s38, 4096
    v_fma_f32 v83, v83, s28, v12
    v_mfma_f32_16x16x32_bf16 v[200:203], a[228:231], v[22:25], v[200:203]
    s_mov_b32 s27, 0x249
    s_mov_b32 s30, 0
    s_waitcnt vmcnt(8) lgkmcnt(0)
    v_accvgpr_read_b32 v108, a4
    v_mfma_f32_16x16x32_bf16 v[248:251], a[228:231], v[28:31], v[248:251]
    s_barrier
    ds_read_b128 a[216:219], v1 offset:12288
    v_mfma_f32_16x16x32_bf16 a[40:43], a[228:231], v[34:37], a[40:43]
    ds_read_b128 a[212:215], v0 offset:12288
    v_fma_f32 v72, v72, s28, v11
    v_exp_f32 v70, v70
    v_fma_f32 v56, v56, s28, v9
    v_mfma_f32_16x16x32_bf16 a[44:47], a[232:235], v[34:37], a[44:47]
    s_add_u32 m0, s22, 36864
    ds_read_b128 a[220:223], v0 offset:13312
    v_fma_f32 v86, v86, s28, v13
    v_exp_f32 v61, v61
    v_fma_f32 v82, v82, s28, v12
    v_exp_f32 v71, v71
    v_exp_f32 v77, v77
    v_exp_f32 v60, v60
    v_mfma_f32_16x16x32_bf16 v[252:255], a[232:235], v[28:31], v[252:255]
    v_fma_f32 v87, v87, s28, v13
    v_exp_f32 v63, v63
    v_exp_f32 v62, v62
    v_exp_f32 v76, v76
    v_cvt_pk_bf16_f32 v14, v52, v53
    v_fma_f32 v79, v79, s28, v12
    v_fma_f32 v85, v85, s28, v13
    v_fma_f32 v84, v84, s28, v13
    v_fma_f32 v65, v65, s28, v10
    v_mfma_f32_16x16x32_bf16 v[204:207], a[232:235], v[22:25], v[204:207]
    v_fma_f32 v89, v89, s28, v13
    v_fma_f32 v73, v73, s28, v11
    v_cvt_pk_bf16_f32 v26, v68, v69
    v_exp_f32 v86, v86
    v_exp_f32 v65, v65
    v_cvt_pk_bf16_f32 v32, v76, v77
    v_fma_f32 v78, v78, s28, v12
    v_mfma_f32_16x16x32_bf16 v[156:159], a[232:235], v[16:19], v[156:159]
    s_waitcnt lgkmcnt(1)
    v_exp_f32 v87, v87
    v_mfma_f32_16x16x32_bf16 v[52:55], a[212:215], a[96:99], 0
    v_accvgpr_read_b32 v106, a2
    v_cvt_pk_bf16_f32 v20, v60, v61
    v_mfma_f32_16x16x32_bf16 v[52:55], a[216:219], a[100:103], v[52:55]
    s_waitcnt lgkmcnt(0)
    ds_read_b128 a[224:227], v1 offset:13312
    v_cvt_pk_bf16_f32 v21, v62, v63
    v_mfma_f32_16x16x32_bf16 v[52:55], a[220:223], a[104:107], v[52:55]
    ds_read_b128 a[232:235], v1 offset:14336
    v_exp_f32 v85, v85
    v_cvt_pk_bf16_f32 v27, v70, v71
    v_exp_f32 v79, v79
    v_mfma_f32_16x16x32_bf16 v[60:63], a[220:223], a[128:131], 0
    v_fma_f32 v91, v91, s28, v13
    v_fma_f32 v88, v88, s28, v13
    v_mfma_f32_16x16x32_bf16 v[60:63], a[216:219], a[124:127], v[60:63]
    ds_read_b128 a[228:231], v0 offset:14336
    v_fma_f32 v74, v74, s28, v11
    v_mfma_f32_16x16x32_bf16 v[60:63], a[212:215], a[120:123], v[60:63]
    buffer_load_dwordx4 v6, s[8:11], s21 offen lds
    v_mfma_f32_16x16x32_bf16 v[68:71], a[212:215], a[144:147], 0
    v_exp_f32 v84, v84
    v_mfma_f32_16x16x32_bf16 v[68:71], a[216:219], a[148:151], v[68:71]
    v_fma_f32 v66, v66, s28, v10
    v_exp_f32 v78, v78
    v_cvt_pk_bf16_f32 v39, v86, v87
    v_cvt_pk_bf16_f32 v33, v78, v79
    v_mfma_f32_16x16x32_bf16 v[68:71], a[220:223], a[152:155], v[68:71]
    v_exp_f32 v57, v57
    v_mfma_f32_16x16x32_bf16 v[76:79], a[220:223], a[176:179], 0
    v_exp_f32 v75, v75
    v_mfma_f32_16x16x32_bf16 v[76:79], a[216:219], a[172:175], v[76:79]
    s_add_u32 s21, s21, 128
    v_exp_f32 v56, v56
    v_cvt_pk_bf16_f32 v38, v84, v85
    v_mfma_f32_16x16x32_bf16 v[76:79], a[212:215], a[168:171], v[76:79]
    v_exp_f32 v74, v74
    v_mfma_f32_16x16x32_bf16 v[84:87], a[212:215], a[192:195], 0
    v_exp_f32 v64, v64
    v_mfma_f32_16x16x32_bf16 v[84:87], a[216:219], a[196:199], v[84:87]
    v_exp_f32 v66, v66
    v_mfma_f32_16x16x32_bf16 v[84:87], a[220:223], a[200:203], v[84:87]
    s_waitcnt lgkmcnt(0)
    ds_read_b128 a[212:215], v0 offset:18432
    v_exp_f32 v58, v58
    v_mfma_f32_16x16x32_bf16 v[84:87], a[224:227], a[204:207], v[84:87]
    ds_read_b128 a[220:223], v0 offset:19456
    v_accvgpr_read_b32 v109, a5
    v_exp_f32 v88, v88
    v_mfma_f32_16x16x32_bf16 v[84:87], a[228:231], a[208:211], v[84:87]
    v_accvgpr_read_b32 v110, a6
    v_cvt_pk_bf16_f32 v17, v58, v59
    v_mfma_f32_16x16x32_bf16 v[84:87], a[232:235], v[92:95], v[84:87]
    v_fma_f32 v81, v81, s28, v12
    v_cvt_pk_bf16_f32 v22, v64, v65
    v_mfma_f32_16x16x32_bf16 v[76:79], a[232:235], a[188:191], v[76:79]
    v_fma_f32 v90, v90, s28, v13
    v_exp_f32 v73, v73
    v_exp_f32 v72, v72
    v_mfma_f32_16x16x32_bf16 v[76:79], a[228:231], a[184:187], v[76:79]
    s_add_u32 m0, s22, 37888
    ds_read_b128 a[216:219], v1 offset:18432
    v_cvt_pk_bf16_f32 v16, v56, v57
    v_mfma_f32_16x16x32_bf16 v[76:79], a[224:227], a[180:183], v[76:79]
    v_exp_f32 v81, v81
    v_mfma_f32_16x16x32_bf16 v[68:71], a[224:227], a[156:159], v[68:71]
    v_exp_f32 v67, v67
    v_mfma_f32_16x16x32_bf16 v[68:71], a[228:231], a[160:163], v[68:71]
    v_accvgpr_read_b32 v107, a3
    v_cvt_pk_bf16_f32 v29, v74, v75
    v_mfma_f32_16x16x32_bf16 v[68:71], a[232:235], a[164:167], v[68:71]
    v_accvgpr_read_b32 v111, a7
    v_cvt_pk_bf16_f32 v28, v72, v73
    v_mfma_f32_16x16x32_bf16 v[60:63], a[232:235], a[140:143], v[60:63]
    v_fma_f32 v77, v77, s28, v12
    v_exp_f32 v83, v83
    v_fma_f32 v80, v80, s28, v12
    v_mfma_f32_16x16x32_bf16 v[60:63], a[228:231], a[136:139], v[60:63]
    v_exp_f32 v82, v82
    v_mfma_f32_16x16x32_bf16 v[60:63], a[224:227], a[132:135], v[60:63]
    v_fma_f32 v69, v69, s28, v11
    v_exp_f32 v89, v89
    v_mfma_f32_16x16x32_bf16 v[52:55], a[224:227], a[108:111], v[52:55]
    v_exp_f32 v90, v90
    v_mfma_f32_16x16x32_bf16 v[52:55], a[228:231], a[112:115], v[52:55]
    buffer_load_dwordx4 v6, s[8:11], s21 offen lds
    v_mfma_f32_16x16x32_bf16 v[52:55], a[232:235], a[116:119], v[52:55]
    s_waitcnt lgkmcnt(0)
    ds_read_b128 a[228:231], v0 offset:20480
    v_fma_f32 v87, v87, s28, v13
    v_mfma_f32_16x16x32_bf16 v[56:59], a[212:215], a[96:99], 0
    ds_read_b128 a[224:227], v1 offset:19456
    v_fma_f32 v61, v61, s28, v10
    v_mfma_f32_16x16x32_bf16 v[56:59], a[216:219], a[100:103], v[56:59]
    s_add_u32 s21, s21, 128
    v_exp_f32 v91, v91
    v_mfma_f32_16x16x32_bf16 v[56:59], a[220:223], a[104:107], v[56:59]
    v_cvt_pk_bf16_f32 v23, v66, v67
    v_fma_f32 v78, v78, s28, v12
    v_mfma_f32_16x16x32_bf16 v[64:67], a[220:223], a[128:131], 0
    v_exp_f32 v80, v80
    v_mfma_f32_16x16x32_bf16 v[64:67], a[216:219], a[124:127], v[64:67]
    v_exp_f32 v87, v87
    v_fma_f32 v55, v55, s28, v9
    v_accvgpr_read_b32 v105, a1
    v_accvgpr_read_b32 v104, a0
    v_pk_mul_f32 v[210:211], v[210:211], v[50:51] op_sel_hi:[1,0]
    v_pk_mul_f32 v[176:177], v[176:177], v[102:103] op_sel_hi:[1,0]
    v_pk_mul_f32 v[162:163], v[162:163], v[102:103] op_sel_hi:[1,0]
    v_cvt_pk_bf16_f32 v34, v80, v81
    v_pk_mul_f32 v[108:109], v[108:109], v[8:9] op_sel_hi:[1,0]
    v_pk_mul_f32 v[106:107], v[106:107], v[8:9] op_sel_hi:[1,0]
    v_pk_mul_f32 v[224:225], v[224:225], v[50:51] op_sel_hi:[1,0]
    v_pk_mul_f32 v[116:117], v[116:117], v[48:49] op_sel_hi:[1,0]
    v_pk_mul_f32 v[114:115], v[114:115], v[48:49] op_sel_hi:[1,0]
    v_fma_f32 v79, v79, s28, v12
    v_cvt_pk_bf16_f32 v41, v90, v91
    v_mfma_f32_16x16x32_bf16 v[64:67], a[212:215], a[120:123], v[64:67]
    s_add_u32 m0, s22, 38912
    ds_read_b128 a[232:235], v1 offset:20480
    buffer_load_dwordx4 v6, s[8:11], s21 offen lds
    v_fma_f32 v54, v54, s28, v9
    v_exp_f32 v55, v55
    v_pk_mul_f32 v[110:111], v[110:111], v[8:9] op_sel_hi:[1,0]
    v_pk_mul_f32 v[112:113], v[112:113], v[48:49] op_sel_hi:[1,0]
    v_pk_mul_f32 v[164:165], v[164:165], v[102:103] op_sel_hi:[1,0]
    v_pk_mul_f32 v[208:209], v[208:209], v[50:51] op_sel_hi:[1,0]
    v_pk_mul_f32 v[132:133], v[132:133], v[48:49] op_sel_hi:[1,0]
    v_pk_mul_f32 v[178:179], v[178:179], v[102:103] op_sel_hi:[1,0]
    v_pk_mul_f32 v[118:119], v[118:119], v[48:49] op_sel_hi:[1,0]
    v_fma_f32 v68, v68, s28, v11
    v_pk_mul_f32 v[172:173], v[172:173], v[102:103] op_sel_hi:[1,0]
    v_pk_mul_f32 v[160:161], v[160:161], v[102:103] op_sel_hi:[1,0]
    v_pk_mul_f32 v[120:121], v[120:121], v[48:49] op_sel_hi:[1,0]
    v_pk_mul_f32 v[104:105], v[104:105], v[8:9] op_sel_hi:[1,0]
    v_pk_mul_f32 v[134:135], v[134:135], v[48:49] op_sel_hi:[1,0]
    v_pk_mul_f32 v[218:219], v[218:219], v[50:51] op_sel_hi:[1,0]
    v_pk_mul_f32 v[168:169], v[168:169], v[102:103] op_sel_hi:[1,0]
    v_pk_mul_f32 v[136:137], v[136:137], v[48:49] op_sel_hi:[1,0]
    v_pk_mul_f32 v[228:229], v[228:229], v[50:51] op_sel_hi:[1,0]
    v_pk_mul_f32 v[186:187], v[186:187], v[102:103] op_sel_hi:[1,0]
    v_pk_mul_f32 v[220:221], v[220:221], v[50:51] op_sel_hi:[1,0]
    v_pk_mul_f32 v[214:215], v[214:215], v[50:51] op_sel_hi:[1,0]
    v_pk_mul_f32 v[212:213], v[212:213], v[50:51] op_sel_hi:[1,0]
    v_pk_mul_f32 v[166:167], v[166:167], v[102:103] op_sel_hi:[1,0]
    v_cvt_pk_bf16_f32 v176, v176, v177
    v_fma_f32 v70, v70, s28, v11
    v_mfma_f32_16x16x32_bf16 v[72:75], a[212:215], a[144:147], 0
    v_cvt_pk_bf16_f32 v208, v208, v209
    v_cvt_pk_bf16_f32 v136, v136, v137
    v_mfma_f32_16x16x32_bf16 v[72:75], a[216:219], a[148:151], v[72:75]
    s_add_u32 s21, s21, 12032
    v_cvt_pk_bf16_f32 v112, v112, v113
    v_cvt_pk_bf16_f32 v35, v82, v83
    v_mfma_f32_16x16x32_bf16 v[72:75], a[220:223], a[152:155], v[72:75]
    v_cvt_pk_bf16_f32 v228, v228, v229
    v_cvt_pk_bf16_f32 v40, v88, v89
    v_mfma_f32_16x16x32_bf16 v[80:83], a[220:223], a[176:179], 0
    s_waitcnt vmcnt(6) lgkmcnt(0)
    v_fma_f32 v86, v86, s28, v13
    v_exp_f32 v79, v79
    v_cvt_pk_bf16_f32 v164, v164, v165
    v_mfma_f32_16x16x32_bf16 v[80:83], a[216:219], a[172:175], v[80:83]
    v_exp_f32 v86, v86
    v_mfma_f32_16x16x32_bf16 v[44:47], a[236:239], v[14:17], 0
    s_barrier
    v_fma_f32 v52, v52, s28, v9
    v_mfma_f32_16x16x32_bf16 v[80:83], a[212:215], a[168:171], v[80:83]
    v_cvt_pk_bf16_f32 v160, v160, v161
    v_fma_f32 v76, v76, s28, v12
    v_cvt_pk_bf16_f32 v108, v108, v109
    v_fma_f32 v71, v71, s28, v11
    v_mfma_f32_16x16x32_bf16 v[88:91], a[212:215], a[192:195], 0
    s_add_u32 m0, s22, 12288
    v_cvt_pk_bf16_f32 v109, v110, v111
    v_cvt_pk_bf16_f32 v113, v114, v115
    v_mfma_f32_16x16x32_bf16 v[88:91], a[216:219], a[196:199], v[88:91]
    buffer_load_dwordx4 v6, s[4:7], s20 offen lds
    v_mfma_f32_16x16x32_bf16 v[88:91], a[220:223], a[200:203], v[88:91]
    ds_read_b64_tr_b16 a[212:213], v2 offset:0
    v_fma_f32 v60, v60, s28, v10
    v_mfma_f32_16x16x32_bf16 v[88:91], a[224:227], a[204:207], v[88:91]
    v_cvt_pk_bf16_f32 v168, v168, v169
    v_exp_f32 v69, v69
    v_mfma_f32_16x16x32_bf16 v[88:91], a[228:231], a[208:211], v[88:91]
    s_add_u32 s20, s20, 128
    v_exp_f32 v60, v60
    v_mfma_f32_16x16x32_bf16 v[88:91], a[232:235], v[92:95], v[88:91]
    v_cvt_pk_bf16_f32 v165, v166, v167
    v_exp_f32 v77, v77
    v_cvt_pk_bf16_f32 v116, v116, v117
    v_mfma_f32_16x16x32_bf16 v[80:83], a[232:235], a[188:191], v[80:83]
    ds_read_b64_tr_b16 a[214:215], v2 offset:6144
    v_fma_f32 v62, v62, s28, v10
    v_mfma_f32_16x16x32_bf16 v[80:83], a[228:231], a[184:187], v[80:83]
    v_fma_f32 v84, v84, s28, v13
    v_cvt_pk_bf16_f32 v104, v104, v105
    v_cvt_pk_bf16_f32 v161, v162, v163
    v_mfma_f32_16x16x32_bf16 v[80:83], a[224:227], a[180:183], v[80:83]
    ds_read_b64_tr_b16 a[216:217], v3 offset:0
    v_accvgpr_read_b32 v111, a15
    v_mfma_f32_16x16x32_bf16 v[44:47], a[240:243], v[20:23], v[44:47]
    v_exp_f32 v76, v76
    v_mfma_f32_16x16x32_bf16 v[72:75], a[224:227], a[156:159], v[72:75]
    ds_write2st64_b64 v101, v[112:113], v[160:161] offset0:0 offset1:12
    v_mfma_f32_16x16x32_bf16 v[72:75], a[228:231], a[160:163], v[72:75]
    v_cvt_pk_bf16_f32 v105, v106, v107
    v_cvt_pk_bf16_f32 v212, v212, v213
    v_mfma_f32_16x16x32_bf16 v[72:75], a[232:235], a[164:167], v[72:75]
    ds_read_b64_tr_b16 a[218:219], v3 offset:6144
    v_cvt_pk_bf16_f32 v224, v224, v225
    v_mfma_f32_16x16x32_bf16 v[64:67], a[232:235], a[140:143], v[64:67]
    v_fma_f32 v91, v91, s28, v13
    v_accvgpr_read_b32 v110, a14
    v_mfma_f32_16x16x32_bf16 v[64:67], a[228:231], a[136:139], v[64:67]
    v_accvgpr_read_b32 v107, a11
    v_cvt_pk_bf16_f32 v209, v210, v211
    v_mfma_f32_16x16x32_bf16 v[64:67], a[224:227], a[132:135], v[64:67]
    ds_write2st64_b64 v101, v[208:209], v[104:105] offset0:24 offset1:36
    v_pk_mul_f32 v[152:153], v[152:153], v[48:49] op_sel_hi:[1,0]
    v_cvt_pk_bf16_f32 v117, v118, v119
    v_pk_mul_f32 v[240:241], v[240:241], v[50:51] op_sel_hi:[1,0]
    v_pk_mul_f32 v[154:155], v[154:155], v[48:49] op_sel_hi:[1,0]
    v_cvt_pk_bf16_f32 v240, v240, v241
    v_cvt_pk_bf16_f32 v177, v178, v179
    v_pk_mul_f32 v[216:217], v[216:217], v[50:51] op_sel_hi:[1,0]
    v_pk_mul_f32 v[144:145], v[144:145], v[48:49] op_sel_hi:[1,0]
    v_pk_mul_f32 v[124:125], v[124:125], v[48:49] op_sel_hi:[1,0]
    v_pk_mul_f32 v[180:181], v[180:181], v[102:103] op_sel_hi:[1,0]
    v_pk_mul_f32 v[156:157], v[156:157], v[48:49] op_sel_hi:[1,0]
    v_pk_mul_f32 v[128:129], v[128:129], v[48:49] op_sel_hi:[1,0]
    v_pk_mul_f32 v[236:237], v[236:237], v[50:51] op_sel_hi:[1,0]
    v_xor_b32 v101, 32, v101
    v_pk_mul_f32 v[174:175], v[174:175], v[102:103] op_sel_hi:[1,0]
    v_pk_mul_f32 v[130:131], v[130:131], v[48:49] op_sel_hi:[1,0]
    v_pk_mul_f32 v[182:183], v[182:183], v[102:103] op_sel_hi:[1,0]
    v_pk_mul_f32 v[170:171], v[170:171], v[102:103] op_sel_hi:[1,0]
    v_exp_f32 v71, v71
    v_cvt_pk_bf16_f32 v213, v214, v215
    v_fma_f32 v83, v83, s28, v12
    v_mfma_f32_16x16x32_bf16 v[44:47], a[244:247], v[26:29], v[44:47]
    v_fma_f32 v53, v53, s28, v9
    v_accvgpr_read_b32 v105, a9
    v_mfma_f32_16x16x32_bf16 v[44:47], a[248:251], v[32:35], v[44:47]
    v_exp_f32 v68, v68
    v_mfma_f32_16x16x32_bf16 v[56:59], a[224:227], a[108:111], v[56:59]
    ds_read_b64_tr_b16 a[220:221], v4 offset:0
    v_cvt_pk_bf16_f32 v169, v170, v171
    v_mfma_f32_16x16x32_bf16 v[56:59], a[228:231], a[112:115], v[56:59]
    ds_write2st64_b64 v101, v[116:117], v[164:165] offset0:0 offset1:12
    v_accvgpr_read_b32 v104, a8
    v_cvt_pk_bf16_f32 v220, v220, v221
    v_mfma_f32_16x16x32_bf16 v[56:59], a[232:235], a[116:119], v[56:59]
    s_waitcnt lgkmcnt(2)
    v_cvt_pk_bf16_f32 v216, v216, v217
    v_cvt_pk_bf16_f32 v172, v172, v173
    v_mfma_f32_16x16x32_bf16 v[112:115], a[212:215], v[14:17], 0
    ds_write2st64_b64 v101, v[212:213], v[108:109] offset0:24 offset1:36
    v_pk_mul_f32 v[234:235], v[234:235], v[50:51] op_sel_hi:[1,0]
    v_cvt_pk_bf16_f32 v120, v120, v121
    v_pk_mul_f32 v[138:139], v[138:139], v[48:49] op_sel_hi:[1,0]
    v_accvgpr_read_b32 v106, a10
    v_pk_mul_f32 v[202:203], v[202:203], v[102:103] op_sel_hi:[1,0]
    v_pk_mul_f32 v[150:151], v[150:151], v[48:49] op_sel_hi:[1,0]
    v_pk_mul_f32 v[126:127], v[126:127], v[48:49] op_sel_hi:[1,0]
    v_pk_mul_f32 v[184:185], v[184:185], v[102:103] op_sel_hi:[1,0]
    v_pk_mul_f32 v[122:123], v[122:123], v[48:49] op_sel_hi:[1,0]
    v_pk_mul_f32 v[158:159], v[158:159], v[48:49] op_sel_hi:[1,0]
    v_cvt_pk_bf16_f32 v124, v124, v125
    v_cvt_pk_bf16_f32 v137, v138, v139
    v_pk_mul_f32 v[146:147], v[146:147], v[48:49] op_sel_hi:[1,0]
    v_pk_mul_f32 v[104:105], v[104:105], v[8:9] op_sel_hi:[1,0]
    v_pk_mul_f32 v[226:227], v[226:227], v[50:51] op_sel_hi:[1,0]
    v_cvt_pk_bf16_f32 v104, v104, v105
    v_pk_mul_f32 v[242:243], v[242:243], v[50:51] op_sel_hi:[1,0]
    v_fma_f32 v63, v63, s28, v10
    v_pk_mul_f32 v[110:111], v[110:111], v[8:9] op_sel_hi:[1,0]
    v_pk_mul_f32 v[200:201], v[200:201], v[102:103] op_sel_hi:[1,0]
    v_pk_mul_f32 v[250:251], v[250:251], v[50:51] op_sel_hi:[1,0]
    v_pk_mul_f32 v[106:107], v[106:107], v[8:9] op_sel_hi:[1,0]
    v_cvt_pk_bf16_f32 v125, v126, v127
    v_accvgpr_read_b32 v109, a13
    v_pk_mul_f32 v[192:193], v[192:193], v[102:103] op_sel_hi:[1,0]
    v_pk_mul_f32 v[232:233], v[232:233], v[50:51] op_sel_hi:[1,0]
    v_cvt_pk_bf16_f32 v173, v174, v175
    v_pk_mul_f32 v[196:197], v[196:197], v[102:103] op_sel_hi:[1,0]
    v_fma_f32 v80, v80, s28, v12
    v_pk_mul_f32 v[230:231], v[230:231], v[50:51] op_sel_hi:[1,0]
    v_cvt_pk_bf16_f32 v105, v106, v107
    v_cvt_pk_bf16_f32 v232, v232, v233
    v_exp_f32 v61, v61
    v_cvt_pk_bf16_f32 v132, v132, v133
    v_xor_b32 v101, 96, v101
    v_pk_mul_f32 v[190:191], v[190:191], v[102:103] op_sel_hi:[1,0]
    v_pk_mul_f32 v[244:245], v[244:245], v[50:51] op_sel_hi:[1,0]
    v_pk_mul_f32 v[148:149], v[148:149], v[48:49] op_sel_hi:[1,0]
    v_accvgpr_read_b32 v108, a12
    v_cvt_pk_bf16_f32 v217, v218, v219
    v_pk_mul_f32 v[140:141], v[140:141], v[48:49] op_sel_hi:[1,0]
    v_accvgpr_read_b32 v106, a18
    v_pk_mul_f32 v[246:247], v[246:247], v[50:51] op_sel_hi:[1,0]
    v_pk_mul_f32 v[222:223], v[222:223], v[50:51] op_sel_hi:[1,0]
    v_cvt_pk_bf16_f32 v225, v226, v227
    v_pk_mul_f32 v[108:109], v[108:109], v[8:9] op_sel_hi:[1,0]
    v_cvt_pk_bf16_f32 v241, v242, v243
    v_fma_f32 v56, v56, s28, v9
    v_cvt_pk_bf16_f32 v121, v122, v123
    v_cvt_pk_bf16_f32 v108, v108, v109
    v_mfma_f32_16x16x32_bf16 v[116:119], a[216:219], v[14:17], 0
    ds_read_b64_tr_b16 a[228:229], v2 offset:1024
    v_exp_f32 v52, v52
    v_mfma_f32_16x16x32_bf16 v[164:167], a[216:219], v[20:23], 0
    ds_write2st64_b64 v101, v[120:121], v[168:169] offset0:0 offset1:12
    v_cvt_pk_bf16_f32 v133, v134, v135
    v_pk_mul_f32 v[142:143], v[142:143], v[48:49] op_sel_hi:[1,0]
    v_cvt_pk_bf16_f32 v180, v180, v181
    v_cvt_pk_bf16_f32 v184, v184, v185
    v_cvt_pk_bf16_f32 v144, v144, v145
    v_cvt_pk_bf16_f32 v109, v110, v111
    v_accvgpr_read_b32 v107, a19
    v_mfma_f32_16x16x32_bf16 v[160:163], a[212:215], v[20:23], 0
    s_add_u32 m0, s22, 13312
    ds_write2st64_b64 v101, v[216:217], v[104:105] offset0:24 offset1:36
    v_mfma_f32_16x16x32_bf16 v[208:211], a[212:215], v[26:29], 0
    buffer_load_dwordx4 v6, s[4:7], s20 offen lds
    ds_read_b64_tr_b16 a[232:233], v3 offset:1024
    v_mfma_f32_16x16x32_bf16 v[212:215], a[216:219], v[26:29], 0
    ds_read_b64_tr_b16 a[222:223], v4 offset:6144
    v_cvt_pk_bf16_f32 v128, v128, v129
    v_mfma_f32_16x16x32_bf16 a[4:7], a[216:219], v[32:35], 0
    s_add_u32 s20, s20, 128
    ds_read_b64_tr_b16 a[224:225], v5 offset:0
    v_cvt_pk_bf16_f32 v129, v130, v131
    v_mfma_f32_16x16x32_bf16 a[0:3], a[212:215], v[32:35], 0
    ds_read_b64_tr_b16 a[226:227], v5 offset:6144
    v_exp_f32 v53, v53
    v_cvt_pk_bf16_f32 v229, v230, v231
    v_exp_f32 v62, v62
    v_accvgpr_read_b32 v105, a17
    v_pk_mul_f32 v[252:253], v[252:253], v[50:51] op_sel_hi:[1,0]
    v_fma_f32 v75, v75, s28, v11
    v_cvt_pk_bf16_f32 v221, v222, v223
    v_pk_mul_f32 v[194:195], v[194:195], v[102:103] op_sel_hi:[1,0]
    v_fma_f32 v66, v66, s28, v10
    v_pk_mul_f32 v[248:249], v[248:249], v[50:51] op_sel_hi:[1,0]
    v_exp_f32 v78, v78
    v_cvt_pk_bf16_f32 v200, v200, v201
    v_pk_mul_f32 v[188:189], v[188:189], v[102:103] op_sel_hi:[1,0]
    v_accvgpr_read_b32 v110, a22
    v_pk_mul_f32 v[106:107], v[106:107], v[8:9] op_sel_hi:[1,0]
    v_fma_f32 v58, v58, s28, v9
    v_pk_mul_f32 v[238:239], v[238:239], v[50:51] op_sel_hi:[1,0]
    v_cvt_pk_bf16_f32 v152, v152, v153
    v_cvt_pk_bf16_f32 v252, v252, v253
    v_cvt_pk_bf16_f32 v148, v148, v149
    v_exp_f32 v83, v83
    v_fma_f32 v90, v90, s28, v13
    v_fma_f32 v88, v88, s28, v13
    v_xor_b32 v101, 32, v101
    v_mfma_f32_16x16x32_bf16 a[48:51], a[212:215], v[38:41], 0
    ds_write2st64_b64 v101, v[124:125], v[172:173] offset0:0 offset1:12
    v_cvt_pk_bf16_f32 v181, v182, v183
    v_fma_f32 v73, v73, s28, v11
    v_accvgpr_read_b32 v104, a16
    v_fma_f32 v64, v64, s28, v10
    v_mfma_f32_16x16x32_bf16 v[44:47], a[252:255], v[38:41], v[44:47]
    ds_read_b64_tr_b16 a[230:231], v2 offset:7168
    v_cvt_pk_bf16_f32 v185, v186, v187
    v_cvt_pk_bf16_f32 v153, v154, v155
    v_mfma_f32_16x16x32_bf16 a[52:55], a[216:219], v[38:41], 0
    s_waitcnt lgkmcnt(2)
    ds_write2st64_b64 v101, v[220:221], v[108:109] offset0:24 offset1:36
    v_mfma_f32_16x16x32_bf16 a[56:59], a[220:223], v[38:41], 0
    ds_read_b64_tr_b16 a[216:217], v5 offset:1024
    v_accvgpr_read_b32 v109, a21
    v_accvgpr_read_b32 v108, a20
    v_cvt_pk_bf16_f32 v236, v236, v237
    v_accvgpr_read_b32 v111, a23
    v_pk_mul_f32 v[108:109], v[108:109], v[8:9] op_sel_hi:[1,0]
    v_pk_mul_f32 v[110:111], v[110:111], v[8:9] op_sel_hi:[1,0]
    v_pk_mul_f32 v[104:105], v[104:105], v[8:9] op_sel_hi:[1,0]
    v_xor_b32 v101, 96, v101
    v_fma_f32 v89, v89, s28, v13
    v_fma_f32 v59, v59, s28, v9
    v_cvt_pk_bf16_f32 v108, v108, v109
    v_pk_mul_f32 v[198:199], v[198:199], v[102:103] op_sel_hi:[1,0]
    v_cvt_pk_bf16_f32 v188, v188, v189
    v_cvt_pk_bf16_f32 v109, v110, v111
    v_mfma_f32_16x16x32_bf16 a[60:63], a[224:227], v[38:41], 0
    ds_write2st64_b64 v101, v[128:129], v[176:177] offset0:4 offset1:16
    v_mfma_f32_16x16x32_bf16 a[12:15], a[224:227], v[32:35], 0
    v_cvt_pk_bf16_f32 v140, v140, v141
    v_exp_f32 v84, v84
    v_cvt_pk_bf16_f32 v104, v104, v105
    v_cvt_pk_bf16_f32 v105, v106, v107
    v_cvt_pk_bf16_f32 v233, v234, v235
    v_cvt_pk_bf16_f32 v248, v248, v249
    v_mfma_f32_16x16x32_bf16 a[8:11], a[220:223], v[32:35], 0
    ds_read_b64_tr_b16 a[234:235], v3 offset:7168
    v_cvt_pk_bf16_f32 v201, v202, v203
    v_mfma_f32_16x16x32_bf16 v[216:219], a[220:223], v[26:29], 0
    ds_write2st64_b64 v101, v[224:225], v[104:105] offset0:28 offset1:40
    v_cvt_pk_bf16_f32 v196, v196, v197
    v_mfma_f32_16x16x32_bf16 v[220:223], a[224:227], v[26:29], 0
    ds_read_b64_tr_b16 a[214:215], v4 offset:7168
    v_accvgpr_read_b32 v106, a26
    v_accvgpr_read_b32 v107, a27
    v_mfma_f32_16x16x32_bf16 v[172:175], a[224:227], v[20:23], 0
    v_xor_b32 v101, 32, v101
    v_accvgpr_read_b32 v111, a31
    v_fma_f32 v82, v82, s28, v12
    v_exp_f32 v80, v80
    v_mfma_f32_16x16x32_bf16 v[168:171], a[220:223], v[20:23], 0
    ds_read_b64_tr_b16 a[218:219], v5 offset:7168
    v_accvgpr_read_b32 v105, a25
    v_exp_f32 v63, v63
    v_mfma_f32_16x16x32_bf16 v[120:123], a[220:223], v[14:17], 0
    s_add_u32 m0, s22, 14336
    ds_read_b128 v[96:99], v103 offset:0
    v_cvt_pk_bf16_f32 v192, v192, v193
    v_mfma_f32_16x16x32_bf16 v[124:127], a[224:227], v[14:17], 0
    s_waitcnt lgkmcnt(5)
    ds_write2st64_b64 v101, v[132:133], v[180:181] offset0:4 offset1:16
    v_mfma_f32_16x16x32_bf16 v[128:131], a[228:231], v[14:17], 0
    s_waitcnt lgkmcnt(5)
    ds_read_b64_tr_b16 a[224:225], v3 offset:2048
    v_cvt_pk_bf16_f32 v193, v194, v195
    v_mfma_f32_16x16x32_bf16 v[132:135], a[232:235], v[14:17], 0
    v_cvt_pk_bf16_f32 v244, v244, v245
    v_accvgpr_read_b32 v104, a24
    v_mfma_f32_16x16x32_bf16 v[180:183], a[232:235], v[20:23], 0
    ds_write2st64_b64 v101, v[228:229], v[108:109] offset0:28 offset1:40
    v_accvgpr_read_b32 v110, a30
    v_mfma_f32_16x16x32_bf16 v[176:179], a[228:231], v[20:23], 0
    ds_read_b64_tr_b16 a[212:213], v4 offset:1024
    buffer_load_dwordx4 v6, s[4:7], s20 offen lds
    v_cvt_pk_bf16_f32 v149, v150, v151
    v_xor_b32 v101, 96, v101
    v_pk_mul_f32 v[104:105], v[104:105], v[8:9] op_sel_hi:[1,0]
    v_pk_mul_f32 v[110:111], v[110:111], v[8:9] op_sel_hi:[1,0]
    v_pk_mul_f32 v[206:207], v[206:207], v[102:103] op_sel_hi:[1,0]
    v_pk_mul_f32 v[204:205], v[204:205], v[102:103] op_sel_hi:[1,0]
    v_accvgpr_read_b32 v108, a28
    v_accvgpr_read_b32 v109, a29
    v_pk_mul_f32 v[108:109], v[108:109], v[8:9] op_sel_hi:[1,0]
    v_pk_mul_f32 v[106:107], v[106:107], v[8:9] op_sel_hi:[1,0]
    v_cvt_pk_bf16_f32 v245, v246, v247
    v_cvt_pk_bf16_f32 v108, v108, v109
    v_mfma_f32_16x16x32_bf16 v[224:227], a[228:231], v[26:29], 0
    ds_write2st64_b64 v101, v[136:137], v[184:185] offset0:4 offset1:16
    v_cvt_pk_bf16_f32 v104, v104, v105
    v_mfma_f32_16x16x32_bf16 v[228:231], a[232:235], v[26:29], 0
    v_cvt_pk_bf16_f32 v18, v52, v53
    v_cvt_pk_bf16_f32 v105, v106, v107
    v_cvt_pk_bf16_f32 v197, v198, v199
    v_mfma_f32_16x16x32_bf16 a[20:23], a[232:235], v[32:35], 0
    ds_write2st64_b64 v101, v[232:233], v[104:105] offset0:28 offset1:40
    v_cvt_pk_bf16_f32 v30, v68, v69
    v_mfma_f32_16x16x32_bf16 a[16:19], a[228:231], v[32:35], 0
    v_cvt_pk_bf16_f32 v237, v238, v239
    v_accvgpr_read_b32 v104, a32
    v_accvgpr_read_b32 v105, a33
    v_accvgpr_read_b32 v106, a34
    v_mfma_f32_16x16x32_bf16 a[64:67], a[228:231], v[38:41], 0
    s_add_u32 s20, s20, 12032
    ds_read_b64_tr_b16 a[226:227], v3 offset:8192
    v_fma_f32 v81, v81, s28, v12
    v_mfma_f32_16x16x32_bf16 a[68:71], a[232:235], v[38:41], 0
    s_waitcnt lgkmcnt(3)
    ds_read_b64_tr_b16 a[230:231], v4 offset:8192
    v_xor_b32 v101, 32, v101
    v_cvt_pk_bf16_f32 v141, v142, v143
    v_mfma_f32_16x16x32_bf16 a[72:75], a[212:215], v[38:41], 0
    ds_read_b64_tr_b16 a[222:223], v2 offset:8192
    v_cvt_pk_bf16_f32 v204, v204, v205
    v_mfma_f32_16x16x32_bf16 a[76:79], a[216:219], v[38:41], 0
    buffer_store_dwordx4 v[96:99], v6, s[16:19], s67 offen offset:0 nt
    ds_read_b64_tr_b16 a[220:221], v2 offset:2048
    v_cvt_pk_bf16_f32 v189, v190, v191
    v_pk_mul_f32 v[104:105], v[104:105], v[8:9] op_sel_hi:[1,0]
    v_cvt_pk_bf16_f32 v145, v146, v147
    v_cvt_pk_bf16_f32 v109, v110, v111
    v_mfma_f32_16x16x32_bf16 a[28:31], a[216:219], v[32:35], 0
    s_add_u32 m0, s38, 0
    ds_write2st64_b64 v101, v[140:141], v[188:189] offset0:4 offset1:16
    v_mfma_f32_16x16x32_bf16 a[24:27], a[212:215], v[32:35], 0
    buffer_load_dwordx4 v6, s[12:15], s33 offen nt lds
    ds_write2st64_b64 v101, v[236:237], v[108:109] offset0:28 offset1:40
    v_accvgpr_read_b32 v107, a35
    v_accvgpr_read_b32 v111, a39
    v_accvgpr_read_b32 v110, a38
    v_mfma_f32_16x16x32_bf16 v[232:235], a[212:215], v[26:29], 0
    ds_read_b128 v[96:99], v103 offset:1024
    v_accvgpr_read_b32 v108, a36
    v_accvgpr_read_b32 v109, a37
    v_exp_f32 v54, v54
    v_pk_mul_f32 v[106:107], v[106:107], v[8:9] op_sel_hi:[1,0]
    v_cvt_pk_bf16_f32 v24, v60, v61
    v_cvt_pk_bf16_f32 v104, v104, v105
    v_pk_mul_f32 v[108:109], v[108:109], v[8:9] op_sel_hi:[1,0]
    v_cvt_pk_bf16_f32 v105, v106, v107
    v_xor_b32 v101, 96, v101
    v_cvt_pk_bf16_f32 v108, v108, v109
    v_cvt_pk_bf16_f32 v37, v78, v79
    v_mfma_f32_16x16x32_bf16 v[236:239], a[216:219], v[26:29], 0
    ds_write2st64_b64 v101, v[144:145], v[192:193] offset0:8 offset1:20
    v_pk_mul_f32 v[110:111], v[110:111], v[8:9] op_sel_hi:[1,0]
    v_fma_f32 v72, v72, s28, v11
    v_cvt_pk_bf16_f32 v109, v110, v111
    v_mfma_f32_16x16x32_bf16 v[188:191], a[216:219], v[20:23], 0
    s_add_u32 m0, s38, 1024
    ds_write2st64_b64 v101, v[240:241], v[104:105] offset0:32 offset1:44
    v_mfma_f32_16x16x32_bf16 v[184:187], a[212:215], v[20:23], 0
    ds_read_b64_tr_b16 a[234:235], v5 offset:8192
    v_accvgpr_read_b32 v104, a40
    v_cvt_pk_bf16_f32 v249, v250, v251
    v_mfma_f32_16x16x32_bf16 v[136:139], a[212:215], v[14:17], 0
    ds_read_b64_tr_b16 a[228:229], v4 offset:2048
    v_fma_f32 v74, v74, s28, v11
    v_mfma_f32_16x16x32_bf16 v[140:143], a[216:219], v[14:17], 0
    s_waitcnt lgkmcnt(4)
    ds_read_b64_tr_b16 a[232:233], v5 offset:2048
    v_xor_b32 v101, 32, v101
    v_cvt_pk_bf16_f32 v156, v156, v157
    v_mfma_f32_16x16x32_bf16 v[144:147], a[220:223], v[14:17], 0
    ds_write2st64_b64 v101, v[148:149], v[196:197] offset0:8 offset1:20
    v_accvgpr_read_b32 v106, a42
    v_mfma_f32_16x16x32_bf16 v[148:151], a[224:227], v[14:17], 0
    buffer_load_dwordx4 v7, s[12:15], s33 offen nt lds
    v_cvt_pk_bf16_f32 v205, v206, v207
    v_mfma_f32_16x16x32_bf16 v[196:199], a[224:227], v[20:23], 0
    buffer_store_dwordx4 v[96:99], v7, s[16:19], s67 offen offset:0 nt
    ds_write2st64_b64 v101, v[244:245], v[108:109] offset0:32 offset1:44
    v_mfma_f32_16x16x32_bf16 v[192:195], a[220:223], v[20:23], 0
    v_accvgpr_read_b32 v109, a45
    v_accvgpr_read_b32 v107, a43
    v_mfma_f32_16x16x32_bf16 v[240:243], a[220:223], v[26:29], 0
    s_add_u32 s39, s39, 12288
    v_xor_b32 v101, 96, v101
    v_accvgpr_read_b32 v108, a44
    v_mfma_f32_16x16x32_bf16 v[244:247], a[224:227], v[26:29], 0
    v_accvgpr_read_b32 v105, a41
    v_accvgpr_read_b32 v110, a46
    v_mfma_f32_16x16x32_bf16 a[36:39], a[224:227], v[32:35], 0
    s_waitcnt vmcnt(10) lgkmcnt(2)
    ds_write2st64_b64 v101, v[152:153], v[200:201] offset0:8 offset1:20
    v_pk_mul_f32 v[104:105], v[104:105], v[8:9] op_sel_hi:[1,0]
    v_pk_mul_f32 v[254:255], v[254:255], v[50:51] op_sel_hi:[1,0]
    v_accvgpr_read_b32 v111, a47
    v_pk_mul_f32 v[106:107], v[106:107], v[8:9] op_sel_hi:[1,0]
    v_pk_mul_f32 v[108:109], v[108:109], v[8:9] op_sel_hi:[1,0]
    v_cvt_pk_bf16_f32 v104, v104, v105
    v_pk_mul_f32 v[110:111], v[110:111], v[8:9] op_sel_hi:[1,0]
    v_cvt_pk_bf16_f32 v105, v106, v107
    v_cvt_pk_bf16_f32 v253, v254, v255
    v_mfma_f32_16x16x32_bf16 a[32:35], a[220:223], v[32:35], 0
    s_barrier
    v_mfma_f32_16x16x32_bf16 a[80:83], a[220:223], v[38:41], 0
    ds_write2st64_b64 v101, v[248:249], v[104:105] offset0:32 offset1:44
    v_mfma_f32_16x16x32_bf16 a[84:87], a[224:227], v[38:41], 0
    ds_read_b128 a[212:215], v0 offset:0
    v_xor_b32 v101, 32, v101
    v_mfma_f32_16x16x32_bf16 a[88:91], a[228:231], v[38:41], 0
    v_cvt_pk_bf16_f32 v108, v108, v109
    v_fma_f32 v57, v57, s28, v9
    v_mfma_f32_16x16x32_bf16 a[92:95], a[232:235], v[38:41], 0
    s_add_u32 m0, s22, 24576
    ds_read_b128 a[220:223], v0 offset:1024
    v_cvt_pk_bf16_f32 v19, v54, v55
    v_mfma_f32_16x16x32_bf16 a[44:47], a[232:235], v[32:35], 0
    ds_read_b128 a[216:219], v1 offset:0
    v_cvt_pk_bf16_f32 v157, v158, v159
    v_mfma_f32_16x16x32_bf16 a[40:43], a[228:231], v[32:35], 0
    ds_write2st64_b64 v101, v[156:157], v[204:205] offset0:8 offset1:20
    v_cvt_pk_bf16_f32 v109, v110, v111
    v_mfma_f32_16x16x32_bf16 v[248:251], a[228:231], v[26:29], 0
    ds_write2st64_b64 v101, v[252:253], v[108:109] offset0:32 offset1:44
    v_mfma_f32_16x16x32_bf16 v[252:255], a[232:235], v[26:29], 0
    v_exp_f32 v57, v57
    v_mfma_f32_16x16x32_bf16 v[204:207], a[232:235], v[20:23], 0
    v_exp_f32 v59, v59
    v_mfma_f32_16x16x32_bf16 v[200:203], a[228:231], v[20:23], 0
    ds_read_b128 a[224:227], v1 offset:1024
    v_fma_f32 v65, v65, s28, v10
    v_mfma_f32_16x16x32_bf16 v[152:155], a[228:231], v[14:17], 0
    ds_read_b128 v[96:99], v103 offset:2048
    v_exp_f32 v66, v66
    v_mfma_f32_16x16x32_bf16 v[156:159], a[232:235], v[14:17], 0
    s_waitcnt lgkmcnt(5)
    v_exp_f32 v70, v70
    v_mfma_f32_16x16x32_bf16 v[52:55], a[212:215], a[96:99], 0
    s_waitcnt lgkmcnt(4)
    ds_read_b128 a[232:235], v1 offset:2048
    v_cvt_pk_bf16_f32 v25, v62, v63
    v_mfma_f32_16x16x32_bf16 v[52:55], a[216:219], a[100:103], v[52:55]
    ds_read_b128 a[228:231], v0 offset:2048
    v_cvt_pk_bf16_f32 v43, v86, v87
    v_mfma_f32_16x16x32_bf16 v[52:55], a[220:223], a[104:107], v[52:55]
    buffer_load_dwordx4 v6, s[8:11], s21 offen lds
    v_mfma_f32_16x16x32_bf16 v[60:63], a[220:223], a[128:131], 0
    v_cvt_pk_bf16_f32 v36, v76, v77
    v_cvt_pk_bf16_f32 v31, v70, v71
    v_mfma_f32_16x16x32_bf16 v[60:63], a[216:219], a[124:127], v[60:63]
    v_exp_f32 v88, v88
    v_mfma_f32_16x16x32_bf16 v[60:63], a[212:215], a[120:123], v[60:63]
    s_add_u32 s21, s21, 128
    v_exp_f32 v90, v90
    v_mfma_f32_16x16x32_bf16 v[68:71], a[212:215], a[144:147], 0
    v_exp_f32 v89, v89
    v_mfma_f32_16x16x32_bf16 v[68:71], a[216:219], a[148:151], v[68:71]
    v_exp_f32 v56, v56
    v_mfma_f32_16x16x32_bf16 v[68:71], a[220:223], a[152:155], v[68:71]
    v_fma_f32 v85, v85, s28, v13
    v_cvt_pk_bf16_f32 v16, v56, v57
    v_mfma_f32_16x16x32_bf16 v[76:79], a[220:223], a[176:179], 0
    v_exp_f32 v58, v58
    v_mfma_f32_16x16x32_bf16 v[76:79], a[216:219], a[172:175], v[76:79]
    s_add_u32 m0, s22, 25600
    v_exp_f32 v85, v85
    v_mfma_f32_16x16x32_bf16 v[76:79], a[212:215], a[168:171], v[76:79]
    v_fma_f32 v67, v67, s28, v10
    v_cvt_pk_bf16_f32 v42, v84, v85
    v_mfma_f32_16x16x32_bf16 v[84:87], a[212:215], a[192:195], 0
    v_exp_f32 v81, v81
    v_mfma_f32_16x16x32_bf16 v[84:87], a[216:219], a[196:199], v[84:87]
    buffer_load_dwordx4 v6, s[8:11], s21 offen lds
    v_mfma_f32_16x16x32_bf16 v[84:87], a[220:223], a[200:203], v[84:87]
    s_waitcnt lgkmcnt(0)
    v_exp_f32 v64, v64
    v_mfma_f32_16x16x32_bf16 v[84:87], a[224:227], a[204:207], v[84:87]
    v_exp_f32 v75, v75
    v_mfma_f32_16x16x32_bf16 v[84:87], a[228:231], a[208:211], v[84:87]
    s_add_u32 s21, s21, 128
    v_exp_f32 v67, v67
    v_mfma_f32_16x16x32_bf16 v[84:87], a[232:235], v[92:95], v[84:87]
    v_exp_f32 v73, v73
    v_mfma_f32_16x16x32_bf16 v[76:79], a[232:235], a[188:191], v[76:79]
    v_exp_f32 v65, v65
    v_mfma_f32_16x16x32_bf16 v[76:79], a[228:231], a[184:187], v[76:79]
    ds_read_b128 a[212:215], v0 offset:6144
    v_cvt_pk_bf16_f32 v17, v58, v59
    v_mfma_f32_16x16x32_bf16 v[76:79], a[224:227], a[180:183], v[76:79]
    s_add_u32 m0, s22, 26624
    v_exp_f32 v91, v91
    v_cvt_pk_bf16_f32 v40, v88, v89
    v_mfma_f32_16x16x32_bf16 v[68:71], a[224:227], a[156:159], v[68:71]
    v_exp_f32 v74, v74
    v_mfma_f32_16x16x32_bf16 v[68:71], a[228:231], a[160:163], v[68:71]
    v_exp_f32 v82, v82
    v_mfma_f32_16x16x32_bf16 v[68:71], a[232:235], a[164:167], v[68:71]
    buffer_load_dwordx4 v6, s[8:11], s21 offen lds
    v_mfma_f32_16x16x32_bf16 v[60:63], a[232:235], a[140:143], v[60:63]
    v_exp_f32 v72, v72
    v_mfma_f32_16x16x32_bf16 v[48:51], a[236:239], v[16:19], v[44:47]
    s_add_u32 s21, s21, 12032
    ds_read_b128 a[216:219], v1 offset:6144
    v_cvt_pk_bf16_f32 v28, v72, v73
    v_mfma_f32_16x16x32_bf16 v[60:63], a[228:231], a[136:139], v[60:63]
    s_add_u32 s56, s67, 128
    ds_read_b128 a[220:223], v0 offset:7168
    v_cvt_pk_bf16_f32 v23, v66, v67
    v_mfma_f32_16x16x32_bf16 v[60:63], a[224:227], a[132:135], v[60:63]
    buffer_store_dwordx4 v[96:99], v6, s[16:19], s56 offen offset:0 nt
    v_cvt_pk_bf16_f32 v22, v64, v65
    s_add_u32 s58, s33, 128
    v_cvt_pk_bf16_f32 v29, v74, v75
    v_mfma_f32_16x16x32_bf16 v[48:51], a[240:243], v[22:25], v[48:51]
    v_cvt_pk_bf16_f32 v34, v80, v81
    v_cvt_pk_bf16_f32 v35, v82, v83
    v_mfma_f32_16x16x32_bf16 v[48:51], a[244:247], v[28:31], v[48:51]
    v_mfma_f32_16x16x32_bf16 v[52:55], a[224:227], a[108:111], v[52:55]
    s_add_u32 m0, s38, 2048
    v_cvt_pk_bf16_f32 v41, v90, v91
    v_mfma_f32_16x16x32_bf16 v[48:51], a[248:251], v[34:37], v[48:51]
    buffer_load_dwordx4 v6, s[12:15], s58 offen nt lds
    v_mfma_f32_16x16x32_bf16 v[48:51], a[252:255], v[40:43], v[48:51]
    ds_read_b128 a[224:227], v1 offset:7168
    v_mfma_f32_16x16x32_bf16 v[52:55], a[228:231], a[112:115], v[52:55]
    ds_read_b128 v[96:99], v103 offset:3072
    v_mfma_f32_16x16x32_bf16 v[52:55], a[232:235], a[116:119], v[52:55]
    s_add_u32 m0, s38, 3072
    s_waitcnt lgkmcnt(3)
    v_mfma_f32_16x16x32_bf16 v[56:59], a[212:215], a[96:99], 0
    ds_read_b128 a[228:231], v0 offset:8192
    v_cmp_lt_f32 vcc, s29, v48
    v_mfma_f32_16x16x32_bf16 v[56:59], a[216:219], a[100:103], v[56:59]
    s_waitcnt lgkmcnt(3)
    ds_read_b128 a[232:235], v1 offset:8192
    v_mfma_f32_16x16x32_bf16 v[56:59], a[220:223], a[104:107], v[56:59]
    v_mfma_f32_16x16x32_bf16 v[64:67], a[220:223], a[128:131], 0
    s_cbranch_vccnz L_rs_tr45d
L_ret_tr45d:
    v_fma_f32 v62, v62, s28, v10
    v_mfma_f32_16x16x32_bf16 v[64:67], a[216:219], a[124:127], v[64:67]
    v_fma_f32 v60, v60, s28, v10
    v_fma_f32 v61, v61, s28, v10
    v_mfma_f32_16x16x32_bf16 v[64:67], a[212:215], a[120:123], v[64:67]
    v_fma_f32 v55, v55, s28, v9
    v_fma_f32 v54, v54, s28, v9
    v_mfma_f32_16x16x32_bf16 v[72:75], a[212:215], a[144:147], 0
    v_fma_f32 v63, v63, s28, v10
    v_fma_f32 v52, v52, s28, v9
    v_mfma_f32_16x16x32_bf16 v[72:75], a[216:219], a[148:151], v[72:75]
    v_exp_f32 v61, v61
    v_mfma_f32_16x16x32_bf16 v[72:75], a[220:223], a[152:155], v[72:75]
    s_waitcnt lgkmcnt(2)
    buffer_load_dwordx4 v7, s[12:15], s58 offen nt lds
    v_mfma_f32_16x16x32_bf16 v[80:83], a[220:223], a[176:179], 0
    v_exp_f32 v54, v54
    v_mfma_f32_16x16x32_bf16 v[80:83], a[216:219], a[172:175], v[80:83]
    v_exp_f32 v63, v63
    v_mfma_f32_16x16x32_bf16 v[80:83], a[212:215], a[168:171], v[80:83]
    s_waitcnt vmcnt(13) lgkmcnt(0)
    v_fma_f32 v53, v53, s28, v9
    v_mfma_f32_16x16x32_bf16 v[88:91], a[212:215], a[192:195], 0
    buffer_store_dwordx4 v[96:99], v7, s[16:19], s56 offen offset:0 nt
    s_barrier
    v_exp_f32 v55, v55
    v_mfma_f32_16x16x32_bf16 v[88:91], a[216:219], a[196:199], v[88:91]
    v_exp_f32 v60, v60
    v_mfma_f32_16x16x32_bf16 v[88:91], a[220:223], a[200:203], v[88:91]
    ds_read_b64_tr_b16 a[212:213], v2 offset:18432
    v_mfma_f32_16x16x32_bf16 v[88:91], a[224:227], a[204:207], v[88:91]
    v_add_u32 v103, 4096, v103
    v_mfma_f32_16x16x32_bf16 v[88:91], a[228:231], a[208:211], v[88:91]
    ds_read_b64_tr_b16 a[214:215], v2 offset:12288
    v_cvt_pk_bf16_f32 v15, v54, v55
    v_mfma_f32_16x16x32_bf16 v[88:91], a[232:235], v[92:95], v[88:91]
    s_add_u32 m0, s22, 0
    ds_read_b64_tr_b16 a[216:217], v3 offset:18432
    v_mfma_f32_16x16x32_bf16 v[80:83], a[232:235], a[188:191], v[80:83]
    ds_read_b64_tr_b16 a[218:219], v3 offset:12288
    v_mfma_f32_16x16x32_bf16 v[80:83], a[228:231], a[184:187], v[80:83]
    v_exp_f32 v52, v52
    v_mfma_f32_16x16x32_bf16 v[80:83], a[224:227], a[180:183], v[80:83]
    buffer_load_dwordx4 v6, s[4:7], s20 offen lds
    v_mfma_f32_16x16x32_bf16 v[72:75], a[224:227], a[156:159], v[72:75]
    s_add_u32 s20, s20, 128
    v_exp_f32 v62, v62
    v_mfma_f32_16x16x32_bf16 v[72:75], a[228:231], a[160:163], v[72:75]
    v_exp_f32 v53, v53
    v_mfma_f32_16x16x32_bf16 v[72:75], a[232:235], a[164:167], v[72:75]
    v_cvt_pk_bf16_f32 v21, v62, v63
    v_cvt_pk_bf16_f32 v20, v60, v61
    v_mfma_f32_16x16x32_bf16 v[64:67], a[232:235], a[140:143], v[64:67]
    ds_read_b64_tr_b16 a[220:221], v4 offset:18432
    s_add_u32 m0, s22, 1024
    v_mfma_f32_16x16x32_bf16 v[64:67], a[228:231], a[136:139], v[64:67]
    buffer_load_dwordx4 v6, s[4:7], s20 offen lds
    v_mfma_f32_16x16x32_bf16 v[64:67], a[224:227], a[132:135], v[64:67]
    s_add_u32 s20, s20, 128
    ds_read_b64_tr_b16 a[222:223], v4 offset:12288
    v_mfma_f32_16x16x32_bf16 v[56:59], a[224:227], a[108:111], v[56:59]
    s_add_u32 m0, s22, 2048
    ds_read_b64_tr_b16 a[224:225], v5 offset:18432
    v_mfma_f32_16x16x32_bf16 v[56:59], a[228:231], a[112:115], v[56:59]
    buffer_load_dwordx4 v6, s[4:7], s20 offen lds
    v_mfma_f32_16x16x32_bf16 v[56:59], a[232:235], a[116:119], v[56:59]
    s_add_u32 s20, s20, 12032
    ds_read_b64_tr_b16 a[226:227], v5 offset:12288
    v_cvt_pk_bf16_f32 v14, v52, v53
    s_branch L_loop5
L_tr44:
    s_waitcnt lgkmcnt(6)
    v_mfma_f32_16x16x32_bf16 v[112:115], a[212:215], v[16:19], v[112:115]
    v_fma_f32 v77, v77, s28, v12
    v_mfma_f32_16x16x32_bf16 v[160:163], a[212:215], v[22:25], v[160:163]
    ds_read_b64_tr_b16 a[230:231], v2 offset:13312
    v_fma_f32 v81, v81, s28, v12
    v_mfma_f32_16x16x32_bf16 v[208:211], a[212:215], v[28:31], v[208:211]
    ds_read_b64_tr_b16 a[234:235], v3 offset:13312
    v_fma_f32 v79, v79, s28, v12
    v_mfma_f32_16x16x32_bf16 a[0:3], a[212:215], v[34:37], a[0:3]
    ds_read_b64_tr_b16 a[212:213], v4 offset:19456
    s_waitcnt lgkmcnt(7)
    v_mfma_f32_16x16x32_bf16 a[4:7], a[216:219], v[34:37], a[4:7]
    ds_read_b64_tr_b16 a[228:229], v2 offset:19456
    v_mfma_f32_16x16x32_bf16 v[212:215], a[216:219], v[28:31], v[212:215]
    v_fma_f32 v76, v76, s28, v12
    v_fma_f32 v75, v75, s28, v11
    v_mfma_f32_16x16x32_bf16 v[164:167], a[216:219], v[22:25], v[164:167]
    ds_read_b64_tr_b16 a[214:215], v4 offset:13312
    v_fma_f32 v71, v71, s28, v11
    v_mfma_f32_16x16x32_bf16 v[116:119], a[216:219], v[16:19], v[116:119]
    ds_read_b64_tr_b16 a[232:233], v3 offset:19456
    s_waitcnt lgkmcnt(8)
    v_mfma_f32_16x16x32_bf16 v[120:123], a[220:223], v[16:19], v[120:123]
    v_fma_f32 v82, v82, s28, v12
    v_mfma_f32_16x16x32_bf16 v[168:171], a[220:223], v[22:25], v[168:171]
    ds_read_b64_tr_b16 a[216:217], v5 offset:19456
    v_fma_f32 v80, v80, s28, v12
    v_mfma_f32_16x16x32_bf16 v[216:219], a[220:223], v[28:31], v[216:219]
    v_exp_f32 v76, v76
    v_mfma_f32_16x16x32_bf16 a[8:11], a[220:223], v[34:37], a[8:11]
    s_waitcnt lgkmcnt(6)
    v_exp_f32 v77, v77
    v_mfma_f32_16x16x32_bf16 a[12:15], a[224:227], v[34:37], a[12:15]
    ds_read_b64_tr_b16 a[218:219], v5 offset:13312
    v_fma_f32 v73, v73, s28, v11
    v_mfma_f32_16x16x32_bf16 v[220:223], a[224:227], v[28:31], v[220:223]
    v_fma_f32 v78, v78, s28, v12
    v_fma_f32 v69, v69, s28, v11
    v_mfma_f32_16x16x32_bf16 v[172:175], a[224:227], v[22:25], v[172:175]
    ds_read_b64_tr_b16 a[222:223], v2 offset:14336
    v_fma_f32 v56, v56, s28, v9
    v_mfma_f32_16x16x32_bf16 v[124:127], a[224:227], v[16:19], v[124:127]
    s_waitcnt lgkmcnt(5)
    ds_read_b64_tr_b16 a[224:225], v3 offset:20480
    v_mfma_f32_16x16x32_bf16 v[128:131], a[228:231], v[16:19], v[128:131]
    v_exp_f32 v79, v79
    v_mfma_f32_16x16x32_bf16 v[176:179], a[228:231], v[22:25], v[176:179]
    ds_read_b64_tr_b16 a[220:221], v2 offset:20480
    v_fma_f32 v63, v63, s28, v10
    v_mfma_f32_16x16x32_bf16 v[224:227], a[228:231], v[28:31], v[224:227]
    v_exp_f32 v81, v81
    v_mfma_f32_16x16x32_bf16 a[16:19], a[228:231], v[34:37], a[16:19]
    s_waitcnt lgkmcnt(4)
    ds_read_b64_tr_b16 a[228:229], v4 offset:20480
    v_fma_f32 v67, v67, s28, v10
    v_mfma_f32_16x16x32_bf16 a[20:23], a[232:235], v[34:37], a[20:23]
    ds_read_b64_tr_b16 a[226:227], v3 offset:14336
    v_fma_f32 v72, v72, s28, v11
    v_mfma_f32_16x16x32_bf16 v[228:231], a[232:235], v[28:31], v[228:231]
    v_exp_f32 v72, v72
    v_mfma_f32_16x16x32_bf16 v[180:183], a[232:235], v[22:25], v[180:183]
    ds_read_b64_tr_b16 a[230:231], v4 offset:14336
    v_fma_f32 v64, v64, s28, v10
    v_mfma_f32_16x16x32_bf16 v[132:135], a[232:235], v[16:19], v[132:135]
    s_add_u32 s39, s39, 12288
    ds_read_b64_tr_b16 a[234:235], v5 offset:14336
    v_fma_f32 v62, v62, s28, v10
    v_mfma_f32_16x16x32_bf16 v[136:139], a[212:215], v[16:19], v[136:139]
    ds_read_b64_tr_b16 a[232:233], v5 offset:20480
    v_fma_f32 v70, v70, s28, v11
    v_mfma_f32_16x16x32_bf16 v[184:187], a[212:215], v[22:25], v[184:187]
    v_exp_f32 v63, v63
    v_mfma_f32_16x16x32_bf16 v[232:235], a[212:215], v[28:31], v[232:235]
    v_fma_f32 v68, v68, s28, v11
    v_fma_f32 v57, v57, s28, v9
    v_mfma_f32_16x16x32_bf16 a[24:27], a[212:215], v[34:37], a[24:27]
    s_waitcnt lgkmcnt(5)
    v_exp_f32 v71, v71
    v_mfma_f32_16x16x32_bf16 a[28:31], a[216:219], v[34:37], a[28:31]
    v_exp_f32 v70, v70
    v_mfma_f32_16x16x32_bf16 v[236:239], a[216:219], v[28:31], v[236:239]
    v_exp_f32 v62, v62
    v_mfma_f32_16x16x32_bf16 v[188:191], a[216:219], v[22:25], v[188:191]
    v_exp_f32 v64, v64
    v_mfma_f32_16x16x32_bf16 v[140:143], a[216:219], v[16:19], v[140:143]
    v_fma_f32 v59, v59, s28, v9
    v_cvt_pk_bf16_f32 v21, v62, v63
    v_mfma_f32_16x16x32_bf16 v[144:147], a[220:223], v[16:19], v[144:147]
    v_exp_f32 v68, v68
    v_mfma_f32_16x16x32_bf16 v[192:195], a[220:223], v[22:25], v[192:195]
    ds_read_b128 v[96:99], v103 offset:0
    s_waitcnt vmcnt(10) lgkmcnt(1)
    v_mfma_f32_16x16x32_bf16 v[240:243], a[220:223], v[28:31], v[240:243]
    s_barrier
    v_mfma_f32_16x16x32_bf16 a[32:35], a[220:223], v[34:37], a[32:35]
    v_exp_f32 v75, v75
    v_mfma_f32_16x16x32_bf16 a[36:39], a[224:227], v[34:37], a[36:39]
    s_add_u32 m0, s22, 36864
    ds_read_b128 a[212:215], v0 offset:12288
    v_fma_f32 v74, v74, s28, v11
    v_mfma_f32_16x16x32_bf16 v[244:247], a[224:227], v[28:31], v[244:247]
    buffer_load_dwordx4 v6, s[8:11], s21 offen lds
    v_mfma_f32_16x16x32_bf16 v[196:199], a[224:227], v[22:25], v[196:199]
    ds_read_b128 a[216:219], v1 offset:12288
    s_add_u32 s21, s21, 128
    v_mfma_f32_16x16x32_bf16 v[148:151], a[224:227], v[16:19], v[148:151]
    s_add_u32 m0, s22, 37888
    ds_read_b128 a[220:223], v0 offset:13312
    v_fma_f32 v65, v65, s28, v10
    v_mfma_f32_16x16x32_bf16 v[152:155], a[228:231], v[16:19], v[152:155]
    buffer_load_dwordx4 v6, s[8:11], s21 offen lds
    v_mfma_f32_16x16x32_bf16 v[200:203], a[228:231], v[22:25], v[200:203]
    v_fma_f32 v66, v66, s28, v10
    v_fma_f32 v83, v83, s28, v12
    v_mfma_f32_16x16x32_bf16 v[248:251], a[228:231], v[28:31], v[248:251]
    s_add_u32 s21, s21, 128
    v_exp_f32 v56, v56
    v_mfma_f32_16x16x32_bf16 a[40:43], a[228:231], v[34:37], a[40:43]
    s_add_u32 m0, s22, 38912
    v_exp_f32 v78, v78
    v_mfma_f32_16x16x32_bf16 a[44:47], a[232:235], v[34:37], a[44:47]
    buffer_load_dwordx4 v6, s[8:11], s21 offen lds
    v_mfma_f32_16x16x32_bf16 v[252:255], a[232:235], v[28:31], v[252:255]
    ds_read_b128 a[228:231], v0 offset:14336
    v_fma_f32 v58, v58, s28, v9
    v_mfma_f32_16x16x32_bf16 v[204:207], a[232:235], v[22:25], v[204:207]
    v_cvt_pk_bf16_f32 v27, v70, v71
    v_cvt_pk_bf16_f32 v32, v76, v77
    v_mfma_f32_16x16x32_bf16 v[156:159], a[232:235], v[16:19], v[156:159]
    s_waitcnt lgkmcnt(3)
    v_exp_f32 v69, v69
    v_mfma_f32_16x16x32_bf16 v[52:55], a[212:215], a[96:99], 0
    s_waitcnt lgkmcnt(2)
    v_exp_f32 v74, v74
    v_mfma_f32_16x16x32_bf16 v[52:55], a[216:219], a[100:103], v[52:55]
    s_waitcnt lgkmcnt(1)
    ds_read_b128 a[224:227], v1 offset:13312
    v_cvt_pk_bf16_f32 v26, v68, v69
    v_mfma_f32_16x16x32_bf16 v[52:55], a[220:223], a[104:107], v[52:55]
    v_exp_f32 v67, v67
    v_mfma_f32_16x16x32_bf16 v[60:63], a[220:223], a[128:131], 0
    ds_read_b128 a[232:235], v1 offset:14336
    v_cvt_pk_bf16_f32 v33, v78, v79
    v_mfma_f32_16x16x32_bf16 v[60:63], a[216:219], a[124:127], v[60:63]
    v_exp_f32 v73, v73
    v_mfma_f32_16x16x32_bf16 v[60:63], a[212:215], a[120:123], v[60:63]
    v_exp_f32 v65, v65
    v_mfma_f32_16x16x32_bf16 v[68:71], a[212:215], a[144:147], 0
    v_cvt_pk_bf16_f32 v28, v72, v73
    v_mfma_f32_16x16x32_bf16 v[68:71], a[216:219], a[148:151], v[68:71]
    v_exp_f32 v82, v82
    v_mfma_f32_16x16x32_bf16 v[68:71], a[220:223], a[152:155], v[68:71]
    v_exp_f32 v58, v58
    v_mfma_f32_16x16x32_bf16 v[76:79], a[220:223], a[176:179], 0
    ds_read_b128 v[84:87], v103 offset:1024
    v_mfma_f32_16x16x32_bf16 v[76:79], a[216:219], a[172:175], v[76:79]
    ds_read_b128 a[220:223], v0 offset:19456
    v_cvt_pk_bf16_f32 v22, v64, v65
    v_mfma_f32_16x16x32_bf16 v[76:79], a[212:215], a[168:171], v[76:79]
    s_waitcnt lgkmcnt(3)
    v_exp_f32 v66, v66
    v_mfma_f32_16x16x32_bf16 v[76:79], a[224:227], a[180:183], v[76:79]
    v_exp_f32 v80, v80
    v_mfma_f32_16x16x32_bf16 v[76:79], a[228:231], a[184:187], v[76:79]
    s_waitcnt lgkmcnt(2)
    ds_read_b128 a[216:219], v1 offset:18432
    v_mfma_f32_16x16x32_bf16 v[76:79], a[232:235], a[188:191], v[76:79]
    s_add_u32 s21, s21, 12032
    v_cvt_pk_bf16_f32 v23, v66, v67
    v_mfma_f32_16x16x32_bf16 v[68:71], a[232:235], a[164:167], v[68:71]
    v_exp_f32 v83, v83
    v_mfma_f32_16x16x32_bf16 v[68:71], a[228:231], a[160:163], v[68:71]
    s_add_u32 s57, s24, 128
    ds_read_b128 a[212:215], v0 offset:18432
    v_cvt_pk_bf16_f32 v29, v74, v75
    v_mfma_f32_16x16x32_bf16 v[68:71], a[224:227], a[156:159], v[68:71]
    v_mfma_f32_16x16x32_bf16 v[60:63], a[224:227], a[132:135], v[60:63]
    v_mfma_f32_16x16x32_bf16 v[60:63], a[228:231], a[136:139], v[60:63]
    v_exp_f32 v57, v57
    v_mfma_f32_16x16x32_bf16 v[60:63], a[232:235], a[140:143], v[60:63]
    v_exp_f32 v59, v59
    v_mfma_f32_16x16x32_bf16 v[52:55], a[232:235], a[116:119], v[52:55]
    v_cvt_pk_bf16_f32 v17, v58, v59
    v_mfma_f32_16x16x32_bf16 v[52:55], a[228:231], a[112:115], v[52:55]
    v_cvt_pk_bf16_f32 v16, v56, v57
    v_cvt_pk_bf16_f32 v34, v80, v81
    v_mfma_f32_16x16x32_bf16 v[52:55], a[224:227], a[108:111], v[52:55]
    ds_read_b128 a[228:231], v0 offset:20480
    v_cvt_pk_bf16_f32 v35, v82, v83
    v_mfma_f32_16x16x32_bf16 v[44:47], a[236:239], v[14:17], v[48:51]
    ds_read_b128 a[224:227], v1 offset:19456
    v_mfma_f32_16x16x32_bf16 v[44:47], a[240:243], v[20:23], v[44:47]
    ds_read_b128 a[232:235], v1 offset:20480
    v_mfma_f32_16x16x32_bf16 v[44:47], a[244:247], v[26:29], v[44:47]
    v_mfma_f32_16x16x32_bf16 v[44:47], a[248:251], v[32:35], v[44:47]
    s_waitcnt lgkmcnt(3)
    ds_read_b128 v[88:91], v103 offset:2048
    v_mfma_f32_16x16x32_bf16 v[56:59], a[212:215], a[96:99], 0
    buffer_store_dwordx4 v[96:99], v6, s[16:19], s24 offen offset:0 nt
    s_nop 3
    v_cmp_lt_f32 vcc, s29, v44
    v_mfma_f32_16x16x32_bf16 v[56:59], a[216:219], a[100:103], v[56:59]
    ds_read_b128 v[96:99], v103 offset:3072
    v_mfma_f32_16x16x32_bf16 v[56:59], a[220:223], a[104:107], v[56:59]
    v_mfma_f32_16x16x32_bf16 v[64:67], a[220:223], a[128:131], 0
    buffer_store_dwordx4 v[84:87], v7, s[16:19], s24 offen offset:0 nt
    s_cbranch_vccnz L_rs_tr44a
L_ret_tr44a:
    v_fma_f32 v55, v55, s28, v9
    v_mfma_f32_16x16x32_bf16 v[64:67], a[216:219], a[124:127], v[64:67]
    s_waitcnt vmcnt(9) lgkmcnt(2)
    v_fma_f32 v61, v61, s28, v10
    v_mfma_f32_16x16x32_bf16 v[64:67], a[212:215], a[120:123], v[64:67]
    s_barrier
    v_mfma_f32_16x16x32_bf16 v[72:75], a[212:215], a[144:147], 0
    v_fma_f32 v53, v53, s28, v9
    s_add_u32 m0, s22, 12288
    v_mfma_f32_16x16x32_bf16 v[72:75], a[216:219], a[148:151], v[72:75]
    buffer_load_dwordx4 v6, s[4:7], s20 offen lds
    v_mfma_f32_16x16x32_bf16 v[72:75], a[220:223], a[152:155], v[72:75]
    v_fma_f32 v52, v52, s28, v9
    s_add_u32 s20, s20, 128
    v_mfma_f32_16x16x32_bf16 v[80:83], a[220:223], a[176:179], 0
    s_add_u32 m0, s22, 13312
    v_exp_f32 v53, v53
    v_mfma_f32_16x16x32_bf16 v[80:83], a[216:219], a[172:175], v[80:83]
    buffer_load_dwordx4 v6, s[4:7], s20 offen lds
    v_mfma_f32_16x16x32_bf16 v[80:83], a[212:215], a[168:171], v[80:83]
    v_exp_f32 v55, v55
    v_mfma_f32_16x16x32_bf16 v[80:83], a[224:227], a[180:183], v[80:83]
    s_add_u32 s20, s20, 128
    v_fma_f32 v54, v54, s28, v9
    s_add_u32 m0, s22, 14336
    v_mfma_f32_16x16x32_bf16 v[80:83], a[228:231], a[184:187], v[80:83]
    ds_read_b64_tr_b16 a[212:213], v2 offset:0
    v_fma_f32 v60, v60, s28, v10
    v_mfma_f32_16x16x32_bf16 v[80:83], a[232:235], a[188:191], v[80:83]
    buffer_load_dwordx4 v6, s[4:7], s20 offen lds
    v_mfma_f32_16x16x32_bf16 v[72:75], a[232:235], a[164:167], v[72:75]
    s_add_u32 s20, s20, 12032
    ds_read_b64_tr_b16 a[214:215], v2 offset:6144
    v_mfma_f32_16x16x32_bf16 v[72:75], a[228:231], a[160:163], v[72:75]
    v_exp_f32 v52, v52
    v_mfma_f32_16x16x32_bf16 v[72:75], a[224:227], a[156:159], v[72:75]
    ds_read_b64_tr_b16 a[216:217], v3 offset:0
    v_cvt_pk_bf16_f32 v18, v52, v53
    v_mfma_f32_16x16x32_bf16 v[64:67], a[224:227], a[132:135], v[64:67]
    v_exp_f32 v60, v60
    v_mfma_f32_16x16x32_bf16 v[64:67], a[228:231], a[136:139], v[64:67]
    s_waitcnt lgkmcnt(3)
    buffer_store_dwordx4 v[88:91], v6, s[16:19], s57 offen offset:0 nt
    ds_read_b64_tr_b16 a[218:219], v3 offset:6144
    v_exp_f32 v54, v54
    v_mfma_f32_16x16x32_bf16 v[64:67], a[232:235], a[140:143], v[64:67]
    ds_read_b64_tr_b16 a[220:221], v4 offset:0
    v_cvt_pk_bf16_f32 v19, v54, v55
    v_mfma_f32_16x16x32_bf16 v[56:59], a[232:235], a[116:119], v[56:59]
    v_exp_f32 v61, v61
    v_mfma_f32_16x16x32_bf16 v[56:59], a[228:231], a[112:115], v[56:59]
    ds_read_b64_tr_b16 a[222:223], v4 offset:6144
    v_mfma_f32_16x16x32_bf16 v[56:59], a[224:227], a[108:111], v[56:59]
    buffer_store_dwordx4 v[96:99], v7, s[16:19], s57 offen offset:0 nt
    ds_read_b64_tr_b16 a[224:225], v5 offset:0
    ds_read_b64_tr_b16 a[226:227], v5 offset:6144
    v_cvt_pk_bf16_f32 v24, v60, v61
    ds_read_b64_tr_b16 a[234:235], v3 offset:7168
    s_waitcnt lgkmcnt(7)
    v_mfma_f32_16x16x32_bf16 v[112:115], a[212:215], v[14:17], v[112:115]
    v_lshrrev_b32 v105, 11, v0
    v_and_b32 v104, 0x3ff, v0
    v_mfma_f32_16x16x32_bf16 v[160:163], a[212:215], v[20:23], v[160:163]
    v_fma_f32 v68, v68, s28, v11
    v_fma_f32 v77, v77, s28, v12
    v_fma_f32 v70, v70, s28, v11
    v_mfma_f32_16x16x32_bf16 v[208:211], a[212:215], v[26:29], v[208:211]
    ds_read_b64_tr_b16 a[230:231], v2 offset:7168
    v_fma_f32 v76, v76, s28, v12
    v_mfma_f32_16x16x32_bf16 a[0:3], a[212:215], v[32:35], a[0:3]
    s_waitcnt lgkmcnt(6)
    v_exp_f32 v76, v76
    v_mfma_f32_16x16x32_bf16 a[4:7], a[216:219], v[32:35], a[4:7]
    v_exp_f32 v70, v70
    v_mfma_f32_16x16x32_bf16 v[212:215], a[216:219], v[26:29], v[212:215]
    ds_read_b64_tr_b16 a[228:229], v2 offset:1024
    v_fma_f32 v66, v66, s28, v10
    v_mfma_f32_16x16x32_bf16 v[164:167], a[216:219], v[20:23], v[164:167]
    ds_read_b64_tr_b16 a[212:213], v4 offset:1024
    v_fma_f32 v79, v79, s28, v12
    v_mfma_f32_16x16x32_bf16 v[116:119], a[216:219], v[14:17], v[116:119]
    s_waitcnt lgkmcnt(6)
    ds_read_b64_tr_b16 a[216:217], v5 offset:1024
    v_fma_f32 v62, v62, s28, v10
    v_mfma_f32_16x16x32_bf16 v[120:123], a[220:223], v[14:17], v[120:123]
    v_fma_f32 v73, v73, s28, v11
    v_fma_f32 v58, v58, s28, v9
    v_mfma_f32_16x16x32_bf16 v[168:171], a[220:223], v[20:23], v[168:171]
    ds_read_b64_tr_b16 a[232:233], v3 offset:1024
    v_xor_b32 v105, s65, v105
    v_mfma_f32_16x16x32_bf16 v[216:219], a[220:223], v[26:29], v[216:219]
    v_fma_f32 v83, v83, s28, v12
    v_fma_f32 v72, v72, s28, v11
    v_mfma_f32_16x16x32_bf16 a[8:11], a[220:223], v[32:35], a[8:11]
    s_waitcnt lgkmcnt(5)
    ds_read_b64_tr_b16 a[218:219], v5 offset:7168
    v_fma_f32 v59, v59, s28, v9
    v_mfma_f32_16x16x32_bf16 a[12:15], a[224:227], v[32:35], a[12:15]
    v_fma_f32 v80, v80, s28, v12
    v_fma_f32 v69, v69, s28, v11
    v_mfma_f32_16x16x32_bf16 v[220:223], a[224:227], v[26:29], v[220:223]
    ds_read_b64_tr_b16 a[214:215], v4 offset:7168
    v_fma_f32 v63, v63, s28, v10
    v_mfma_f32_16x16x32_bf16 v[172:175], a[224:227], v[20:23], v[172:175]
    ds_read_b64_tr_b16 a[220:221], v2 offset:2048
    v_lshl_add_u32 v104, v105, 10, v104
    v_mfma_f32_16x16x32_bf16 v[124:127], a[224:227], v[14:17], v[124:127]
    s_waitcnt lgkmcnt(6)
    ds_read_b64_tr_b16 a[224:225], v3 offset:2048
    v_add_u32 v104, s38, v104
    v_mfma_f32_16x16x32_bf16 v[128:131], a[228:231], v[14:17], v[128:131]
    ds_read_b64_tr_b16 a[226:227], v3 offset:8192
    v_fma_f32 v71, v71, s28, v11
    v_mfma_f32_16x16x32_bf16 v[176:179], a[228:231], v[20:23], v[176:179]
    v_exp_f32 v62, v62
    v_mfma_f32_16x16x32_bf16 v[224:227], a[228:231], v[26:29], v[224:227]
    v_exp_f32 v77, v77
    v_mfma_f32_16x16x32_bf16 a[16:19], a[228:231], v[32:35], a[16:19]
    s_waitcnt lgkmcnt(5)
    ds_read_b64_tr_b16 a[230:231], v4 offset:8192
    v_xor_b32 v105, 64, v104
    v_mfma_f32_16x16x32_bf16 a[20:23], a[232:235], v[32:35], a[20:23]
    s_add_u32 s39, s39, 12288
    v_fma_f32 v82, v82, s28, v12
    v_fma_f32 v57, v57, s28, v9
    v_mfma_f32_16x16x32_bf16 v[228:231], a[232:235], v[26:29], v[228:231]
    ds_read_b64_tr_b16 a[228:229], v4 offset:2048
    v_fma_f32 v67, v67, s28, v10
    v_mfma_f32_16x16x32_bf16 v[180:183], a[232:235], v[20:23], v[180:183]
    ds_read_b64_tr_b16 a[222:223], v2 offset:8192
    v_fma_f32 v64, v64, s28, v10
    v_mfma_f32_16x16x32_bf16 v[132:135], a[232:235], v[14:17], v[132:135]
    s_waitcnt lgkmcnt(6)
    ds_read_b64_tr_b16 a[234:235], v5 offset:8192
    v_fma_f32 v78, v78, s28, v12
    v_mfma_f32_16x16x32_bf16 v[136:139], a[212:215], v[14:17], v[136:139]
    ds_read_b64_tr_b16 a[232:233], v5 offset:2048
    v_exp_f32 v63, v63
    v_mfma_f32_16x16x32_bf16 v[184:187], a[212:215], v[20:23], v[184:187]
    ds_read_b128 a[180:183], v105 offset:20480
    v_fma_f32 v65, v65, s28, v10
    v_mfma_f32_16x16x32_bf16 v[232:235], a[212:215], v[26:29], v[232:235]
    ds_read_b128 a[144:147], v104 offset:12288
    v_exp_f32 v79, v79
    v_mfma_f32_16x16x32_bf16 a[24:27], a[212:215], v[32:35], a[24:27]
    v_exp_f32 v71, v71
    v_mfma_f32_16x16x32_bf16 a[28:31], a[216:219], v[32:35], a[28:31]
    v_exp_f32 v72, v72
    v_mfma_f32_16x16x32_bf16 v[236:239], a[216:219], v[26:29], v[236:239]
    ds_read_b128 a[176:179], v104 offset:20480
    v_exp_f32 v78, v78
    v_mfma_f32_16x16x32_bf16 v[188:191], a[216:219], v[20:23], v[188:191]
    ds_read_b128 a[172:175], v105 offset:18432
    v_cvt_pk_bf16_f32 v36, v76, v77
    v_mfma_f32_16x16x32_bf16 v[140:143], a[216:219], v[14:17], v[140:143]
    s_waitcnt lgkmcnt(6)
    ds_read_b128 a[120:123], v104 offset:6144
    v_fma_f32 v56, v56, s28, v9
    v_mfma_f32_16x16x32_bf16 v[144:147], a[220:223], v[14:17], v[144:147]
    ds_read_b128 a[168:171], v104 offset:18432
    v_cvt_pk_bf16_f32 v25, v62, v63
    v_mfma_f32_16x16x32_bf16 v[192:195], a[220:223], v[20:23], v[192:195]
    s_waitcnt vmcnt(10) lgkmcnt(6)
    s_add_u32 s21, s21, s62
    ds_read_b128 a[100:103], v105 offset:0
    v_mfma_f32_16x16x32_bf16 v[240:243], a[220:223], v[26:29], v[240:243]
    s_barrier
    ds_read_b128 a[96:99], v104 offset:0
    v_mfma_f32_16x16x32_bf16 a[32:35], a[220:223], v[32:35], a[32:35]
    ds_read_b128 a[212:215], v0 offset:0
    v_fma_f32 v74, v74, s28, v11
    v_mfma_f32_16x16x32_bf16 a[36:39], a[224:227], v[32:35], a[36:39]
    s_add_u32 m0, s22, 24576
    ds_read_b128 a[216:219], v1 offset:0
    buffer_load_dwordx4 v6, s[8:11], s21 offen lds
    v_mfma_f32_16x16x32_bf16 v[244:247], a[224:227], v[26:29], v[244:247]
    v_exp_f32 v66, v66
    v_mfma_f32_16x16x32_bf16 v[196:199], a[224:227], v[20:23], v[196:199]
    s_add_u32 s21, s21, 128
    ds_read_b128 a[124:127], v105 offset:6144
    v_exp_f32 v69, v69
    v_mfma_f32_16x16x32_bf16 v[148:151], a[224:227], v[14:17], v[148:151]
    s_add_u32 m0, s22, 25600
    ds_read_b128 a[108:111], v105 offset:2048
    buffer_load_dwordx4 v6, s[8:11], s21 offen lds
    v_mfma_f32_16x16x32_bf16 v[152:155], a[228:231], v[14:17], v[152:155]
    s_add_u32 s21, s21, 128
    ds_read_b128 a[132:135], v105 offset:8192
    v_cvt_pk_bf16_f32 v31, v70, v71
    v_mfma_f32_16x16x32_bf16 v[200:203], a[228:231], v[20:23], v[200:203]
    s_add_u32 m0, s22, 26624
    ds_read_b128 a[148:151], v105 offset:12288
    v_fma_f32 v81, v81, s28, v12
    v_mfma_f32_16x16x32_bf16 v[248:251], a[228:231], v[26:29], v[248:251]
    ds_read_b128 a[128:131], v104 offset:8192
    v_exp_f32 v80, v80
    v_mfma_f32_16x16x32_bf16 a[40:43], a[228:231], v[32:35], a[40:43]
    buffer_load_dwordx4 v6, s[8:11], s21 offen lds
    v_mfma_f32_16x16x32_bf16 a[44:47], a[232:235], v[32:35], a[44:47]
    ds_read_b128 a[104:107], v104 offset:2048
    v_exp_f32 v59, v59
    v_mfma_f32_16x16x32_bf16 v[252:255], a[232:235], v[26:29], v[252:255]
    ds_read_b128 a[220:223], v0 offset:1024
    v_fma_f32 v75, v75, s28, v11
    v_mfma_f32_16x16x32_bf16 v[204:207], a[232:235], v[20:23], v[204:207]
    ds_read_b128 a[152:155], v104 offset:14336
    v_cvt_pk_bf16_f32 v37, v78, v79
    v_mfma_f32_16x16x32_bf16 v[156:159], a[232:235], v[14:17], v[156:159]
    s_waitcnt lgkmcnt(7)
    v_exp_f32 v68, v68
    v_mfma_f32_16x16x32_bf16 v[52:55], a[212:215], a[96:99], 0
    v_exp_f32 v82, v82
    v_mfma_f32_16x16x32_bf16 v[60:63], a[212:215], a[120:123], 0
    ds_read_b128 a[224:227], v1 offset:1024
    v_cvt_pk_bf16_f32 v30, v68, v69
    v_mfma_f32_16x16x32_bf16 v[68:71], a[212:215], a[144:147], 0
    v_exp_f32 v73, v73
    v_mfma_f32_16x16x32_bf16 v[76:79], a[212:215], a[168:171], 0
    v_exp_f32 v58, v58
    v_mfma_f32_16x16x32_bf16 v[52:55], a[216:219], a[100:103], v[52:55]
    ds_read_b128 a[156:159], v105 offset:14336
    v_cvt_pk_bf16_f32 v17, v58, v59
    v_mfma_f32_16x16x32_bf16 v[60:63], a[216:219], a[124:127], v[60:63]
    s_waitcnt lgkmcnt(5)
    ds_read_b128 a[228:231], v0 offset:6144
    v_exp_f32 v57, v57
    v_mfma_f32_16x16x32_bf16 v[68:71], a[216:219], a[148:151], v[68:71]
    ds_read_b128 a[136:139], v104 offset:10240
    v_exp_f32 v56, v56
    v_mfma_f32_16x16x32_bf16 v[76:79], a[216:219], a[172:175], v[76:79]
    s_waitcnt lgkmcnt(5)
    v_exp_f32 v83, v83
    v_mfma_f32_16x16x32_bf16 v[52:55], a[220:223], a[104:107], v[52:55]
    v_exp_f32 v74, v74
    v_mfma_f32_16x16x32_bf16 v[60:63], a[220:223], a[128:131], v[60:63]
    s_waitcnt lgkmcnt(4)
    ds_read_b128 a[232:235], v1 offset:6144
    v_exp_f32 v67, v67
    v_mfma_f32_16x16x32_bf16 v[68:71], a[220:223], a[152:155], v[68:71]
    ds_read_b128 a[212:215], v0 offset:7168
    v_cvt_pk_bf16_f32 v16, v56, v57
    v_mfma_f32_16x16x32_bf16 v[76:79], a[220:223], a[176:179], v[76:79]
    s_waitcnt lgkmcnt(5)
    v_exp_f32 v64, v64
    v_mfma_f32_16x16x32_bf16 v[52:55], a[224:227], a[108:111], v[52:55]
    v_exp_f32 v65, v65
    v_mfma_f32_16x16x32_bf16 v[60:63], a[224:227], a[132:135], v[60:63]
    s_waitcnt lgkmcnt(4)
    ds_read_b128 a[220:223], v0 offset:2048
    v_cvt_pk_bf16_f32 v28, v72, v73
    v_mfma_f32_16x16x32_bf16 v[68:71], a[224:227], a[156:159], v[68:71]
    v_exp_f32 v81, v81
    v_mfma_f32_16x16x32_bf16 v[76:79], a[224:227], a[180:183], v[76:79]
    s_waitcnt lgkmcnt(4)
    v_exp_f32 v75, v75
    v_mfma_f32_16x16x32_bf16 v[56:59], a[228:231], a[96:99], 0
    v_cvt_pk_bf16_f32 v22, v64, v65
    v_cvt_pk_bf16_f32 v23, v66, v67
    v_mfma_f32_16x16x32_bf16 v[64:67], a[228:231], a[120:123], 0
    v_cvt_pk_bf16_f32 v35, v82, v83
    v_cvt_pk_bf16_f32 v29, v74, v75
    v_mfma_f32_16x16x32_bf16 v[72:75], a[228:231], a[144:147], 0
    ds_read_b128 a[160:163], v104 offset:16384
    v_cvt_pk_bf16_f32 v34, v80, v81
    v_mfma_f32_16x16x32_bf16 v[80:83], a[228:231], a[168:171], 0
    s_waitcnt lgkmcnt(3)
    ds_read_b128 a[228:231], v0 offset:8192
    v_mfma_f32_16x16x32_bf16 v[56:59], a[232:235], a[100:103], v[56:59]
    ds_read_b128 a[224:227], v1 offset:2048
    v_mfma_f32_16x16x32_bf16 v[64:67], a[232:235], a[124:127], v[64:67]
    ds_read_b128 a[216:219], v1 offset:7168
    v_mfma_f32_16x16x32_bf16 v[72:75], a[232:235], a[148:151], v[72:75]
    ds_read_b128 a[112:115], v104 offset:4096
    v_mfma_f32_16x16x32_bf16 v[80:83], a[232:235], a[172:175], v[80:83]
    ds_read_b128 a[232:235], v1 offset:8192
    v_mfma_f32_16x16x32_bf16 v[48:51], a[236:239], v[16:19], v[44:47]
    ds_read_b128 a[140:143], v105 offset:10240
    v_mfma_f32_16x16x32_bf16 v[48:51], a[240:243], v[22:25], v[48:51]
    ds_read_b128 a[188:191], v105 offset:22528
    v_mfma_f32_16x16x32_bf16 v[48:51], a[244:247], v[28:31], v[48:51]
    v_mfma_f32_16x16x32_bf16 v[48:51], a[248:251], v[34:37], v[48:51]
    s_waitcnt lgkmcnt(8)
    ds_read_b128 a[116:119], v105 offset:4096
    v_mfma_f32_16x16x32_bf16 v[56:59], a[212:215], a[104:107], v[56:59]
    ds_read_b128 a[184:187], v104 offset:22528
    v_mfma_f32_16x16x32_bf16 v[64:67], a[212:215], a[128:131], v[64:67]
    ds_read_b128 a[164:167], v105 offset:16384
    v_mfma_f32_16x16x32_bf16 v[72:75], a[212:215], a[152:155], v[72:75]
    s_nop 0
    v_cmp_lt_f32 vcc, s29, v48
    s_add_u32 s21, s21, 12032
    v_mfma_f32_16x16x32_bf16 v[80:83], a[212:215], a[176:179], v[80:83]
    s_waitcnt lgkmcnt(7)
    v_mfma_f32_16x16x32_bf16 v[56:59], a[216:219], a[108:111], v[56:59]
    s_nop 0
    s_cbranch_vccnz L_rs_tr44b
L_ret_tr44b:
    s_waitcnt vmcnt(10) lgkmcnt(5)
    v_mfma_f32_16x16x32_bf16 v[64:67], a[216:219], a[132:135], v[64:67]
    s_barrier
    v_mfma_f32_16x16x32_bf16 v[72:75], a[216:219], a[156:159], v[72:75]
    s_add_u32 m0, s22, 0
    ds_read_b64_tr_b16 a[212:213], v2 offset:18432
    buffer_load_dwordx4 v6, s[4:7], s20 offen lds
    v_mfma_f32_16x16x32_bf16 v[80:83], a[216:219], a[180:183], v[80:83]
    s_add_u32 s20, s20, 128
    ds_read_b64_tr_b16 a[214:215], v2 offset:12288
    s_add_u32 m0, s22, 1024
    v_mfma_f32_16x16x32_bf16 v[52:55], a[220:223], a[112:115], v[52:55]
    buffer_load_dwordx4 v6, s[4:7], s20 offen lds
    v_mfma_f32_16x16x32_bf16 v[60:63], a[220:223], a[136:139], v[60:63]
    s_add_u32 s20, s20, 128
    ds_read_b64_tr_b16 a[216:217], v3 offset:18432
    v_and_b32 v101, 0x3ff, v0
    v_mfma_f32_16x16x32_bf16 v[68:71], a[220:223], a[160:163], v[68:71]
    s_waitcnt lgkmcnt(4)
    ds_read_b64_tr_b16 a[218:219], v3 offset:12288
    v_lshrrev_b32 v108, 11, v0
    v_mfma_f32_16x16x32_bf16 v[76:79], a[220:223], a[184:187], v[76:79]
    s_add_u32 m0, s22, 2048
    ds_read_b64_tr_b16 a[220:221], v4 offset:18432
    v_xor_b32 v108, s65, v108
    v_mfma_f32_16x16x32_bf16 v[52:55], a[224:227], a[116:119], v[52:55]
    buffer_load_dwordx4 v6, s[4:7], s20 offen lds
    v_mfma_f32_16x16x32_bf16 v[60:63], a[224:227], a[140:143], v[60:63]
    s_waitcnt lgkmcnt(5)
    ds_read_b64_tr_b16 a[222:223], v4 offset:12288
    v_mov_b32 v100, v48
    v_mfma_f32_16x16x32_bf16 v[68:71], a[224:227], a[164:167], v[68:71]
    v_lshl_add_u32 v101, v108, 10, v101
    v_add_u32 v101, s38, v101
    v_mfma_f32_16x16x32_bf16 v[76:79], a[224:227], a[188:191], v[76:79]
    v_rcp_f32 v102, v49
    v_mfma_f32_16x16x32_bf16 v[56:59], a[228:231], a[112:115], v[56:59]
    v_rcp_f32 v8, v51
    v_mfma_f32_16x16x32_bf16 v[64:67], a[228:231], a[136:139], v[64:67]
    ds_read_b64_tr_b16 a[224:225], v5 offset:18432
    v_mbcnt_lo_u32_b32 v108, -1, 0
    v_mfma_f32_16x16x32_bf16 v[72:75], a[228:231], a[160:163], v[72:75]
    v_mbcnt_hi_u32_b32 v108, -1, v108
    v_lshrrev_b32 v108, 1, v108
    v_mfma_f32_16x16x32_bf16 v[80:83], a[228:231], a[184:187], v[80:83]
    ds_read_b64_tr_b16 a[226:227], v5 offset:12288
    v_and_b32 v108, 24, v108
    v_mfma_f32_16x16x32_bf16 v[56:59], a[232:235], a[116:119], v[56:59]
    s_add_u32 s20, s20, 12032
    v_rcp_f32 v50, v50
    v_mfma_f32_16x16x32_bf16 v[64:67], a[232:235], a[140:143], v[64:67]
    v_permlane32_swap_b32 v48, v100
    v_mfma_f32_16x16x32_bf16 v[72:75], a[232:235], a[164:167], v[72:75]
    v_bfe_u32 v108, s66, v108, 8
    v_xor_b32 v101, v101, v108
    v_mfma_f32_16x16x32_bf16 v[80:83], a[232:235], a[188:191], v[80:83]
    v_rcp_f32 v48, v48
    v_max3_f32 v96, v52, v53, v54
    s_waitcnt lgkmcnt(6)
    v_mfma_f32_16x16x32_bf16 v[112:115], a[212:215], v[16:19], v[112:115]
    s_mov_b32 s67, s34
    ds_read_b64_tr_b16 a[228:229], v2 offset:19456
    v_max3_f32 v98, v60, v61, v62
    v_max3_f32 v98, v98, v63, v64
    v_max3_f32 v98, v98, v65, v66
    v_max_f32 v98, v98, v67
    v_max3_f32 v96, v96, v55, v56
    v_max3_f32 v96, v96, v57, v58
    v_max_f32 v96, v96, v59
    v_mfma_f32_16x16x32_bf16 v[160:163], a[212:215], v[22:25], v[160:163]
    ds_read_b64_tr_b16 a[232:233], v3 offset:19456
    v_mov_b32 v99, v98
    v_mov_b32 v97, v96
    v_mfma_f32_16x16x32_bf16 v[208:211], a[212:215], v[28:31], v[208:211]
    s_add_u32 s18, s34, 24576
    v_permlane32_swap_b32 v99, v98
    v_permlane32_swap_b32 v97, v96
    v_max_f32 v96, v96, v97
    v_mfma_f32_16x16x32_bf16 a[0:3], a[212:215], v[34:37], a[0:3]
    s_waitcnt lgkmcnt(6)
    ds_read_b64_tr_b16 a[230:231], v2 offset:13312
    v_mov_b32 v97, v96
    v_mfma_f32_16x16x32_bf16 a[4:7], a[216:219], v[34:37], a[4:7]
    s_mov_b32 s34, s33
    v_permlane16_swap_b32 v97, v96
    v_mfma_f32_16x16x32_bf16 v[212:215], a[216:219], v[28:31], v[212:215]
    s_add_u32 s64, s64, s62
    ds_read_b64_tr_b16 a[234:235], v3 offset:13312
    v_max_f32 v96, v96, v97
    v_mfma_f32_16x16x32_bf16 v[164:167], a[216:219], v[22:25], v[164:167]
    s_add_u32 s64, s64, 196608
    v_mul_f32_e64 v9, -s28, v96
    v_max_f32 v98, v98, v99
    v_mfma_f32_16x16x32_bf16 v[116:119], a[216:219], v[16:19], v[116:119]
    s_waitcnt lgkmcnt(4)
    v_max3_f32 v96, v68, v69, v70
    v_mov_b32 v99, v98
    v_mfma_f32_16x16x32_bf16 v[120:123], a[220:223], v[16:19], v[120:123]
    s_mov_b32 s39, s64
    ds_read_b64_tr_b16 a[218:219], v5 offset:13312
    v_max3_f32 v96, v96, v71, v72
    v_mfma_f32_16x16x32_bf16 v[168:171], a[220:223], v[22:25], v[168:171]
    s_add_u32 s37, s37, 1
    ds_read_b64_tr_b16 a[212:213], v4 offset:19456
    v_fma_f32 v53, v53, s28, v9
    v_max3_f32 v96, v96, v73, v74
    v_mfma_f32_16x16x32_bf16 v[216:219], a[220:223], v[28:31], v[216:219]
    s_bitcmp1_b32 s63, s37
    ds_read_b64_tr_b16 a[216:217], v5 offset:19456
    v_fma_f32 v59, v59, s28, v9
    v_mfma_f32_16x16x32_bf16 a[8:11], a[220:223], v[34:37], a[8:11]
    s_cselect_b32 s62, 4294770688, 0
    ds_read_b64_tr_b16 a[214:215], v4 offset:13312
    v_permlane16_swap_b32 v99, v98
    v_mfma_f32_16x16x32_bf16 a[12:15], a[224:227], v[34:37], a[12:15]
    v_max_f32 v96, v96, v75
    v_accvgpr_read_b32 v106, a2
    v_mov_b32 v97, v96
    v_mfma_f32_16x16x32_bf16 v[220:223], a[224:227], v[28:31], v[220:223]
    s_cselect_b32 s42, 0, 325632
    v_max_f32 v98, v98, v99
    v_permlane32_swap_b32 v97, v96
    v_mfma_f32_16x16x32_bf16 v[172:175], a[224:227], v[22:25], v[172:175]
    s_add_u32 s35, s35, s42
    ds_read_b64_tr_b16 a[222:223], v2 offset:14336
    v_mul_f32_e64 v10, -s28, v98
    v_accvgpr_read_b32 v111, a7
    v_max3_f32 v98, v76, v77, v78
    v_mfma_f32_16x16x32_bf16 v[124:127], a[224:227], v[16:19], v[124:127]
    s_waitcnt lgkmcnt(5)
    ds_read_b64_tr_b16 a[220:221], v2 offset:20480
    v_accvgpr_read_b32 v105, a1
    v_max_f32 v96, v96, v97
    v_mfma_f32_16x16x32_bf16 v[128:131], a[228:231], v[16:19], v[128:131]
    s_lshl_b32 s42, s37, 1
    ds_read_b64_tr_b16 a[226:227], v3 offset:14336
    v_fma_f32 v52, v52, s28, v9
    v_mfma_f32_16x16x32_bf16 v[176:179], a[228:231], v[22:25], v[176:179]
    s_lshr_b32 s42, s31, s42
    v_mov_b32 v97, v96
    v_max3_f32 v98, v98, v79, v80
    v_fma_f32 v63, v63, s28, v10
    v_exp_f32 v59, v59
    v_fma_f32 v55, v55, s28, v9
    v_mfma_f32_16x16x32_bf16 v[224:227], a[228:231], v[28:31], v[224:227]
    s_and_b32 s42, s42, 3
    v_fma_f32 v64, v64, s28, v10
    v_accvgpr_read_b32 v104, a0
    v_mfma_f32_16x16x32_bf16 a[16:19], a[228:231], v[34:37], a[16:19]
    s_add_u32 s42, s42, s36
    ds_read_b64_tr_b16 a[230:231], v4 offset:14336
    v_permlane16_swap_b32 v97, v96
    v_accvgpr_read_b32 v109, a5
    v_mfma_f32_16x16x32_bf16 a[20:23], a[232:235], v[34:37], a[20:23]
    s_sub_u32 s43, s42, 3
    v_max_f32 v96, v96, v97
    v_max3_f32 v98, v98, v81, v82
    v_fma_f32 v60, v60, s28, v10
    v_mul_f32_e64 v11, -s28, v96
    v_mfma_f32_16x16x32_bf16 v[228:231], a[232:235], v[28:31], v[228:231]
    s_cmp_ge_u32 s42, 3
    v_max_f32 v98, v98, v83
    v_fma_f32 v74, v74, s28, v11
    v_fma_f32 v62, v62, s28, v10
    v_mfma_f32_16x16x32_bf16 v[180:183], a[232:235], v[22:25], v[180:183]
    s_cselect_b32 s42, s43, s42
    v_exp_f32 v63, v63
    v_mfma_f32_16x16x32_bf16 v[132:135], a[232:235], v[16:19], v[132:135]
    s_mul_i32 s44, s3, 5
    v_fma_f32 v61, v61, s28, v10
    v_accvgpr_read_b32 v108, a4
    s_waitcnt lgkmcnt(1)
    v_mfma_f32_16x16x32_bf16 v[136:139], a[212:215], v[16:19], v[136:139]
    s_mov_b32 s32, 1
    v_exp_f32 v62, v62
    v_mfma_f32_16x16x32_bf16 v[184:187], a[212:215], v[22:25], v[184:187]
    s_lshl_b32 s43, s3, 2
    v_exp_f32 v61, v61
    v_mfma_f32_16x16x32_bf16 v[232:235], a[212:215], v[28:31], v[232:235]
    s_add_u32 s45, s43, 21
    v_exp_f32 v53, v53
    v_mfma_f32_16x16x32_bf16 a[24:27], a[212:215], v[34:37], a[24:27]
    s_cmp_eq_u32 s3, 0
    s_cselect_b32 s45, 20, s45
    ds_read_b64_tr_b16 a[224:225], v3 offset:20480
    v_mfma_f32_16x16x32_bf16 a[28:31], a[216:219], v[34:37], a[28:31]
    s_cselect_b32 s33, 1, 0
    ds_read_b64_tr_b16 a[228:229], v4 offset:20480
    s_cmp_eq_u32 s42, 1
    v_mfma_f32_16x16x32_bf16 v[236:239], a[216:219], v[28:31], v[236:239]
    s_cselect_b32 s44, s45, s44
    v_exp_f32 v52, v52
    v_fma_f32 v57, v57, s28, v9
    v_mfma_f32_16x16x32_bf16 v[188:191], a[216:219], v[22:25], v[188:191]
    s_cselect_b32 s32, s33, s32
    ds_read_b64_tr_b16 a[234:235], v5 offset:14336
    v_mov_b32 v99, v98
    v_mfma_f32_16x16x32_bf16 v[140:143], a[216:219], v[16:19], v[140:143]
    s_add_u32 s45, s43, 37
    v_permlane32_swap_b32 v99, v98
    v_fma_f32 v66, v66, s28, v10
    v_mfma_f32_16x16x32_bf16 v[144:147], a[220:223], v[16:19], v[144:147]
    s_cmp_eq_u32 s42, 2
    ds_read_b64_tr_b16 a[232:233], v5 offset:20480
    v_max_f32 v98, v98, v99
    v_mfma_f32_16x16x32_bf16 v[192:195], a[220:223], v[22:25], v[192:195]
    s_cselect_b32 s44, s45, s44
    v_exp_f32 v55, v55
    v_cvt_pk_bf16_f32 v21, v62, v63
    v_exp_f32 v60, v60
    v_pk_mul_f32 v[178:179], v[178:179], v[102:103] op_sel_hi:[1,0]
    v_pk_mul_f32 v[114:115], v[114:115], v[48:49] op_sel_hi:[1,0]
    v_pk_mul_f32 v[212:213], v[212:213], v[50:51] op_sel_hi:[1,0]
    v_pk_mul_f32 v[166:167], v[166:167], v[102:103] op_sel_hi:[1,0]
    v_cvt_pk_bf16_f32 v14, v52, v53
    v_mov_b32 v99, v98
    v_accvgpr_read_b32 v107, a3
    v_pk_mul_f32 v[112:113], v[112:113], v[48:49] op_sel_hi:[1,0]
    v_cvt_pk_bf16_f32 v20, v60, v61
    s_cselect_b32 s32, 0, s32
    s_mul_i32 s44, s44, 6144
    v_pk_mul_f32 v[104:105], v[104:105], v[8:9] op_sel_hi:[1,0]
    v_pk_mul_f32 v[116:117], v[116:117], v[48:49] op_sel_hi:[1,0]
    v_pk_mul_f32 v[176:177], v[176:177], v[102:103] op_sel_hi:[1,0]
    v_pk_mul_f32 v[164:165], v[164:165], v[102:103] op_sel_hi:[1,0]
    v_pk_mul_f32 v[160:161], v[160:161], v[102:103] op_sel_hi:[1,0]
    v_fma_f32 v54, v54, s28, v9
    v_fma_f32 v56, v56, s28, v9
    v_mfma_f32_16x16x32_bf16 v[240:243], a[220:223], v[28:31], v[240:243]
    s_add_u32 s33, s35, s44
    v_fma_f32 v71, v71, s28, v11
    s_mul_i32 s42, s32, 6144
    v_mfma_f32_16x16x32_bf16 a[32:35], a[220:223], v[34:37], a[32:35]
    s_waitcnt lgkmcnt(1)
    v_exp_f32 v54, v54
    v_mfma_f32_16x16x32_bf16 a[36:39], a[224:227], v[34:37], a[36:39]
    s_add_u32 s42, s42, 24576
    s_add_u32 s42, s42, s33
    v_fma_f32 v69, v69, s28, v11
    s_cmp_ge_u32 s37, 6
    v_mfma_f32_16x16x32_bf16 v[244:247], a[224:227], v[28:31], v[244:247]
    s_cselect_b32 s14, 0, s42
    v_cvt_pk_bf16_f32 v164, v164, v165
    v_fma_f32 v72, v72, s28, v11
    v_permlane16_swap_b32 v99, v98
    v_mfma_f32_16x16x32_bf16 v[196:199], a[224:227], v[22:25], v[196:199]
    s_add_u32 s24, s67, 6144
    v_fma_f32 v75, v75, s28, v11
    v_fma_f32 v68, v68, s28, v11
    v_mfma_f32_16x16x32_bf16 v[148:151], a[224:227], v[16:19], v[148:151]
    s_add_u32 s25, s33, 6144
    v_max_f32 v98, v98, v99
    s_add_u32 s23, s38, 6144
    v_mfma_f32_16x16x32_bf16 v[152:155], a[228:231], v[16:19], v[152:155]
    s_mov_b32 s27, 0x30c30
    v_exp_f32 v71, v71
    v_mfma_f32_16x16x32_bf16 v[200:203], a[228:231], v[22:25], v[200:203]
    s_mov_b32 s89, 0xaaaaaaaa
    v_mul_f32_e64 v12, -s28, v98
    s_mov_b32 s30, 0
    v_mfma_f32_16x16x32_bf16 v[248:251], a[228:231], v[28:31], v[248:251]
    s_waitcnt vmcnt(8) lgkmcnt(0)
    v_cvt_pk_bf16_f32 v15, v54, v55
    v_mov_b32 v38, v6
    v_mfma_f32_16x16x32_bf16 a[40:43], a[228:231], v[34:37], a[40:43]
    s_barrier
    ds_read_b128 a[216:219], v1 offset:12288
    v_mfma_f32_16x16x32_bf16 a[44:47], a[232:235], v[34:37], a[44:47]
    ds_read_b128 a[212:215], v0 offset:12288
    v_fma_f32 v80, v80, s28, v12
    v_mfma_f32_16x16x32_bf16 v[252:255], a[232:235], v[28:31], v[252:255]
    ds_read_b128 a[220:223], v0 offset:13312
    v_fma_f32 v76, v76, s28, v12
    v_fma_f32 v79, v79, s28, v12
    v_exp_f32 v68, v68
    v_pk_mul_f32 v[128:129], v[128:129], v[48:49] op_sel_hi:[1,0]
    v_pk_mul_f32 v[120:121], v[120:121], v[48:49] op_sel_hi:[1,0]
    v_pk_mul_f32 v[140:141], v[140:141], v[48:49] op_sel_hi:[1,0]
    v_pk_mul_f32 v[124:125], v[124:125], v[48:49] op_sel_hi:[1,0]
    v_fma_f32 v77, v77, s28, v12
    v_pk_mul_f32 v[182:183], v[182:183], v[102:103] op_sel_hi:[1,0]
    v_fma_f32 v67, v67, s28, v10
    v_pk_mul_f32 v[108:109], v[108:109], v[8:9] op_sel_hi:[1,0]
    v_fma_f32 v70, v70, s28, v11
    v_pk_mul_f32 v[168:169], v[168:169], v[102:103] op_sel_hi:[1,0]
    v_fma_f32 v78, v78, s28, v12
    v_pk_mul_f32 v[142:143], v[142:143], v[48:49] op_sel_hi:[1,0]
    v_pk_mul_f32 v[136:137], v[136:137], v[48:49] op_sel_hi:[1,0]
    v_pk_mul_f32 v[208:209], v[208:209], v[50:51] op_sel_hi:[1,0]
    v_pk_mul_f32 v[224:225], v[224:225], v[50:51] op_sel_hi:[1,0]
    v_pk_mul_f32 v[214:215], v[214:215], v[50:51] op_sel_hi:[1,0]
    v_pk_mul_f32 v[126:127], v[126:127], v[48:49] op_sel_hi:[1,0]
    v_fma_f32 v83, v83, s28, v12
    v_cvt_pk_bf16_f32 v104, v104, v105
    v_exp_f32 v70, v70
    v_exp_f32 v67, v67
    v_mfma_f32_16x16x32_bf16 v[204:207], a[232:235], v[22:25], v[204:207]
    s_add_u32 m0, s22, 36864
    ds_read_b128 a[228:231], v0 offset:14336
    v_exp_f32 v69, v69
    v_fma_f32 v58, v58, s28, v9
    v_mfma_f32_16x16x32_bf16 v[156:159], a[232:235], v[16:19], v[156:159]
    s_waitcnt lgkmcnt(2)
    v_exp_f32 v76, v76
    v_cvt_pk_bf16_f32 v26, v68, v69
    v_exp_f32 v83, v83
    v_mfma_f32_16x16x32_bf16 v[52:55], a[212:215], a[96:99], 0
    ds_read_b128 a[224:227], v1 offset:13312
    v_exp_f32 v57, v57
    v_mfma_f32_16x16x32_bf16 v[52:55], a[216:219], a[100:103], v[52:55]
    s_waitcnt lgkmcnt(2)
    v_exp_f32 v79, v79
    v_mfma_f32_16x16x32_bf16 v[52:55], a[220:223], a[104:107], v[52:55]
    v_fma_f32 v65, v65, s28, v10
    v_cvt_pk_bf16_f32 v112, v112, v113
    v_cvt_pk_bf16_f32 v124, v124, v125
    v_fma_f32 v81, v81, s28, v12
    v_mfma_f32_16x16x32_bf16 v[60:63], a[220:223], a[128:131], 0
    buffer_load_dwordx4 v6, s[8:11], s21 offen lds
    v_cvt_pk_bf16_f32 v27, v70, v71
    v_exp_f32 v77, v77
    v_mfma_f32_16x16x32_bf16 v[60:63], a[216:219], a[124:127], v[60:63]
    v_exp_f32 v78, v78
    v_mfma_f32_16x16x32_bf16 v[60:63], a[212:215], a[120:123], v[60:63]
    v_cvt_pk_bf16_f32 v208, v208, v209
    v_cvt_pk_bf16_f32 v32, v76, v77
    v_mfma_f32_16x16x32_bf16 v[68:71], a[212:215], a[144:147], 0
    v_exp_f32 v75, v75
    v_mfma_f32_16x16x32_bf16 v[68:71], a[216:219], a[148:151], v[68:71]
    ds_read_b128 a[232:235], v1 offset:14336
    v_cvt_pk_bf16_f32 v33, v78, v79
    v_mfma_f32_16x16x32_bf16 v[68:71], a[220:223], a[152:155], v[68:71]
    v_cvt_pk_bf16_f32 v113, v114, v115
    v_exp_f32 v56, v56
    v_mfma_f32_16x16x32_bf16 v[76:79], a[220:223], a[176:179], 0
    v_exp_f32 v64, v64
    v_mfma_f32_16x16x32_bf16 v[76:79], a[216:219], a[172:175], v[76:79]
    v_exp_f32 v58, v58
    v_exp_f32 v65, v65
    v_cvt_pk_bf16_f32 v16, v56, v57
    v_cvt_pk_bf16_f32 v17, v58, v59
    v_pk_mul_f32 v[122:123], v[122:123], v[48:49] op_sel_hi:[1,0]
    v_pk_mul_f32 v[240:241], v[240:241], v[50:51] op_sel_hi:[1,0]
    v_pk_mul_f32 v[220:221], v[220:221], v[50:51] op_sel_hi:[1,0]
    v_pk_mul_f32 v[162:163], v[162:163], v[102:103] op_sel_hi:[1,0]
    v_pk_mul_f32 v[180:181], v[180:181], v[102:103] op_sel_hi:[1,0]
    v_pk_mul_f32 v[152:153], v[152:153], v[48:49] op_sel_hi:[1,0]
    v_pk_mul_f32 v[106:107], v[106:107], v[8:9] op_sel_hi:[1,0]
    v_pk_mul_f32 v[156:157], v[156:157], v[48:49] op_sel_hi:[1,0]
    v_cvt_pk_bf16_f32 v125, v126, v127
    v_cvt_pk_bf16_f32 v22, v64, v65
    v_mfma_f32_16x16x32_bf16 v[76:79], a[212:215], a[168:171], v[76:79]
    s_waitcnt lgkmcnt(1)
    v_fma_f32 v82, v82, s28, v12
    v_cvt_pk_bf16_f32 v220, v220, v221
    v_mfma_f32_16x16x32_bf16 v[76:79], a[224:227], a[180:183], v[76:79]
    s_add_u32 s21, s21, 128
    v_exp_f32 v72, v72
    v_cvt_pk_bf16_f32 v165, v166, v167
    v_mfma_f32_16x16x32_bf16 v[76:79], a[228:231], a[184:187], v[76:79]
    s_waitcnt lgkmcnt(0)
    v_cvt_pk_bf16_f32 v120, v120, v121
    v_cvt_pk_bf16_f32 v240, v240, v241
    v_mfma_f32_16x16x32_bf16 v[76:79], a[232:235], a[188:191], v[76:79]
    s_add_u32 m0, s22, 37888
    v_exp_f32 v80, v80
    v_mfma_f32_16x16x32_bf16 v[68:71], a[232:235], a[164:167], v[68:71]
    buffer_load_dwordx4 v6, s[8:11], s21 offen lds
    v_mfma_f32_16x16x32_bf16 v[68:71], a[228:231], a[160:163], v[68:71]
    v_exp_f32 v82, v82
    v_mfma_f32_16x16x32_bf16 v[68:71], a[224:227], a[156:159], v[68:71]
    v_cvt_pk_bf16_f32 v140, v140, v141
    v_subrev_u32 v103, 24576, v103
    v_mfma_f32_16x16x32_bf16 v[60:63], a[224:227], a[132:135], v[60:63]
    ds_read_b128 a[212:215], v0 offset:18432
    v_exp_f32 v81, v81
    v_mfma_f32_16x16x32_bf16 v[60:63], a[228:231], a[136:139], v[60:63]
    s_add_u32 s21, s21, 128
    ds_read_b128 a[216:219], v1 offset:18432
    v_fma_f32 v73, v73, s28, v11
    v_mfma_f32_16x16x32_bf16 v[60:63], a[232:235], a[140:143], v[60:63]
    ds_read_b128 a[220:223], v0 offset:19456
    v_cvt_pk_bf16_f32 v105, v106, v107
    v_cvt_pk_bf16_f32 v34, v80, v81
    v_cvt_pk_bf16_f32 v160, v160, v161
    v_exp_f32 v66, v66
    v_pk_mul_f32 v[200:201], v[200:201], v[102:103] op_sel_hi:[1,0]
    v_accvgpr_read_b32 v110, a6
    v_pk_mul_f32 v[118:119], v[118:119], v[48:49] op_sel_hi:[1,0]
    v_pk_mul_f32 v[184:185], v[184:185], v[102:103] op_sel_hi:[1,0]
    v_pk_mul_f32 v[252:253], v[252:253], v[50:51] op_sel_hi:[1,0]
    v_pk_mul_f32 v[172:173], v[172:173], v[102:103] op_sel_hi:[1,0]
    v_pk_mul_f32 v[210:211], v[210:211], v[50:51] op_sel_hi:[1,0]
    v_exp_f32 v74, v74
    v_pk_mul_f32 v[254:255], v[254:255], v[50:51] op_sel_hi:[1,0]
    v_pk_mul_f32 v[216:217], v[216:217], v[50:51] op_sel_hi:[1,0]
    v_pk_mul_f32 v[110:111], v[110:111], v[8:9] op_sel_hi:[1,0]
    v_fma_f32 v78, v78, s28, v12
    v_cvt_pk_bf16_f32 v23, v66, v67
    v_mfma_f32_16x16x32_bf16 v[52:55], a[232:235], a[116:119], v[52:55]
    v_exp_f32 v73, v73
    v_fma_f32 v70, v70, s28, v11
    v_mfma_f32_16x16x32_bf16 v[52:55], a[228:231], a[112:115], v[52:55]
    v_cvt_pk_bf16_f32 v136, v136, v137
    v_cvt_pk_bf16_f32 v180, v180, v181
    v_cvt_pk_bf16_f32 v116, v116, v117
    v_mfma_f32_16x16x32_bf16 v[52:55], a[224:227], a[108:111], v[52:55]
    s_waitcnt lgkmcnt(2)
    ds_read_b128 a[224:227], v1 offset:19456
    v_cvt_pk_bf16_f32 v181, v182, v183
    v_mfma_f32_16x16x32_bf16 v[56:59], a[212:215], a[96:99], 0
    s_waitcnt lgkmcnt(2)
    v_cvt_pk_bf16_f32 v209, v210, v211
    v_cvt_pk_bf16_f32 v212, v212, v213
    v_mfma_f32_16x16x32_bf16 v[56:59], a[216:219], a[100:103], v[56:59]
    s_waitcnt lgkmcnt(1)
    v_cvt_pk_bf16_f32 v200, v200, v201
    v_cvt_pk_bf16_f32 v224, v224, v225
    v_mfma_f32_16x16x32_bf16 v[56:59], a[220:223], a[104:107], v[56:59]
    s_add_u32 m0, s22, 38912
    v_cvt_pk_bf16_f32 v35, v82, v83
    v_cvt_pk_bf16_f32 v161, v162, v163
    v_mfma_f32_16x16x32_bf16 v[64:67], a[220:223], a[128:131], 0
    ds_read_b128 a[228:231], v0 offset:20480
    v_cvt_pk_bf16_f32 v29, v74, v75
    v_mfma_f32_16x16x32_bf16 v[64:67], a[216:219], a[124:127], v[64:67]
    ds_read_b128 a[232:235], v1 offset:20480
    v_fma_f32 v69, v69, s28, v11
    v_mfma_f32_16x16x32_bf16 v[64:67], a[212:215], a[120:123], v[64:67]
    v_cvt_pk_bf16_f32 v28, v72, v73
    v_cvt_pk_bf16_f32 v108, v108, v109
    v_fma_f32 v60, v60, s28, v10
    v_mfma_f32_16x16x32_bf16 v[72:75], a[212:215], a[144:147], 0
    v_exp_f32 v69, v69
    v_cvt_pk_bf16_f32 v172, v172, v173
    v_mfma_f32_16x16x32_bf16 v[72:75], a[216:219], a[148:151], v[72:75]
    v_cvt_pk_bf16_f32 v252, v252, v253
    v_fma_f32 v62, v62, s28, v10
    v_mfma_f32_16x16x32_bf16 v[72:75], a[220:223], a[152:155], v[72:75]
    buffer_load_dwordx4 v6, s[8:11], s21 offen lds
    v_mfma_f32_16x16x32_bf16 v[80:83], a[220:223], a[176:179], 0
    s_add_u32 s21, s21, 12032
    ds_write2st64_b64 v101, v[112:113], v[160:161] offset0:0 offset1:12
    v_accvgpr_read_b32 v106, a10
    v_fma_f32 v53, v53, s28, v9
    v_pk_mul_f32 v[232:233], v[232:233], v[50:51] op_sel_hi:[1,0]
    v_pk_mul_f32 v[188:189], v[188:189], v[102:103] op_sel_hi:[1,0]
    v_pk_mul_f32 v[242:243], v[242:243], v[50:51] op_sel_hi:[1,0]
    v_fma_f32 v55, v55, s28, v9
    v_cvt_pk_bf16_f32 v176, v176, v177
    v_mfma_f32_16x16x32_bf16 v[80:83], a[216:219], a[172:175], v[80:83]
    v_cvt_pk_bf16_f32 v152, v152, v153
    v_cvt_pk_bf16_f32 v117, v118, v119
    v_mfma_f32_16x16x32_bf16 v[80:83], a[212:215], a[168:171], v[80:83]
    s_waitcnt vmcnt(6) lgkmcnt(1)
    v_cvt_pk_bf16_f32 v109, v110, v111
    v_accvgpr_read_b32 v107, a11
    v_mfma_f32_16x16x32_bf16 v[80:83], a[224:227], a[180:183], v[80:83]
    s_barrier
    v_cvt_pk_bf16_f32 v213, v214, v215
    v_mfma_f32_16x16x32_bf16 v[80:83], a[228:231], a[184:187], v[80:83]
    ds_read_b64_tr_b16 a[212:213], v2 offset:0
    v_cvt_pk_bf16_f32 v184, v184, v185
    v_mfma_f32_16x16x32_bf16 v[80:83], a[232:235], a[188:191], v[80:83]
    s_add_u32 m0, s22, 12288
    ds_write2st64_b64 v101, v[208:209], v[104:105] offset0:24 offset1:36
    v_mfma_f32_16x16x32_bf16 v[72:75], a[232:235], a[164:167], v[72:75]
    v_fma_f32 v63, v63, s28, v10
    v_cvt_pk_bf16_f32 v156, v156, v157
    v_fma_f32 v68, v68, s28, v11
    v_mfma_f32_16x16x32_bf16 v[72:75], a[228:231], a[160:163], v[72:75]
    ds_read_b64_tr_b16 a[214:215], v2 offset:6144
    v_accvgpr_read_b32 v110, a14
    v_mfma_f32_16x16x32_bf16 v[72:75], a[224:227], a[156:159], v[72:75]
    ds_read_b64_tr_b16 a[216:217], v3 offset:0
    v_accvgpr_read_b32 v111, a15
    v_mfma_f32_16x16x32_bf16 v[64:67], a[224:227], a[132:135], v[64:67]
    v_cvt_pk_bf16_f32 v168, v168, v169
    v_xor_b32 v101, 32, v101
    v_mfma_f32_16x16x32_bf16 v[64:67], a[228:231], a[136:139], v[64:67]
    ds_read_b64_tr_b16 a[218:219], v3 offset:6144
    v_exp_f32 v63, v63
    v_accvgpr_read_b32 v104, a8
    v_mfma_f32_16x16x32_bf16 v[64:67], a[232:235], a[140:143], v[64:67]
    buffer_load_dwordx4 v6, s[4:7], s20 offen lds
    ds_read_b64_tr_b16 a[220:221], v4 offset:0
    v_mfma_f32_16x16x32_bf16 v[56:59], a[232:235], a[116:119], v[56:59]
    v_cvt_pk_bf16_f32 v232, v232, v233
    v_exp_f32 v62, v62
    v_mfma_f32_16x16x32_bf16 v[56:59], a[228:231], a[112:115], v[56:59]
    ds_write2st64_b64 v101, v[116:117], v[164:165] offset0:0 offset1:12
    v_cvt_pk_bf16_f32 v128, v128, v129
    v_mfma_f32_16x16x32_bf16 v[56:59], a[224:227], a[108:111], v[56:59]
    s_add_u32 s20, s20, 128
    v_cvt_pk_bf16_f32 v177, v178, v179
    v_fma_f32 v83, v83, s28, v12
    v_mfma_f32_16x16x32_bf16 v[44:47], a[236:239], v[14:17], 0
    s_waitcnt lgkmcnt(4)
    ds_write2st64_b64 v101, v[212:213], v[108:109] offset0:24 offset1:36
    v_accvgpr_read_b32 v108, a12
    v_mfma_f32_16x16x32_bf16 v[112:115], a[212:215], v[14:17], 0
    s_add_u32 m0, s22, 13312
    ds_read_b64_tr_b16 a[234:235], v3 offset:7168
    v_fma_f32 v71, v71, s28, v11
    v_mfma_f32_16x16x32_bf16 v[160:163], a[212:215], v[20:23], 0
    buffer_load_dwordx4 v6, s[4:7], s20 offen lds
    ds_read_b64_tr_b16 a[222:223], v4 offset:6144
    v_accvgpr_read_b32 v109, a13
    v_accvgpr_read_b32 v105, a9
    v_cvt_pk_bf16_f32 v25, v62, v63
    v_pk_mul_f32 v[190:191], v[190:191], v[102:103] op_sel_hi:[1,0]
    v_pk_mul_f32 v[194:195], v[194:195], v[102:103] op_sel_hi:[1,0]
    v_pk_mul_f32 v[170:171], v[170:171], v[102:103] op_sel_hi:[1,0]
    v_pk_mul_f32 v[144:145], v[144:145], v[48:49] op_sel_hi:[1,0]
    v_pk_mul_f32 v[104:105], v[104:105], v[8:9] op_sel_hi:[1,0]
    v_pk_mul_f32 v[222:223], v[222:223], v[50:51] op_sel_hi:[1,0]
    v_pk_mul_f32 v[110:111], v[110:111], v[8:9] op_sel_hi:[1,0]
    v_cvt_pk_bf16_f32 v144, v144, v145
    v_cvt_pk_bf16_f32 v169, v170, v171
    v_pk_mul_f32 v[192:193], v[192:193], v[102:103] op_sel_hi:[1,0]
    v_pk_mul_f32 v[108:109], v[108:109], v[8:9] op_sel_hi:[1,0]
    v_exp_f32 v53, v53
    v_cvt_pk_bf16_f32 v108, v108, v109
    v_fma_f32 v75, v75, s28, v11
    v_pk_mul_f32 v[228:229], v[228:229], v[50:51] op_sel_hi:[1,0]
    v_pk_mul_f32 v[226:227], v[226:227], v[50:51] op_sel_hi:[1,0]
    v_pk_mul_f32 v[218:219], v[218:219], v[50:51] op_sel_hi:[1,0]
    v_pk_mul_f32 v[106:107], v[106:107], v[8:9] op_sel_hi:[1,0]
    v_cvt_pk_bf16_f32 v228, v228, v229
    v_exp_f32 v55, v55
    v_cvt_pk_bf16_f32 v121, v122, v123
    v_pk_mul_f32 v[248:249], v[248:249], v[50:51] op_sel_hi:[1,0]
    v_fma_f32 v57, v57, s28, v9
    v_pk_mul_f32 v[204:205], v[204:205], v[102:103] op_sel_hi:[1,0]
    v_pk_mul_f32 v[244:245], v[244:245], v[50:51] op_sel_hi:[1,0]
    v_fma_f32 v59, v59, s28, v9
    v_exp_f32 v60, v60
    v_pk_mul_f32 v[132:133], v[132:133], v[48:49] op_sel_hi:[1,0]
    v_pk_mul_f32 v[148:149], v[148:149], v[48:49] op_sel_hi:[1,0]
    v_pk_mul_f32 v[186:187], v[186:187], v[102:103] op_sel_hi:[1,0]
    v_mov_b32 v39, v7
    v_fma_f32 v54, v54, s28, v9
    v_mfma_f32_16x16x32_bf16 v[44:47], a[240:243], v[20:23], v[44:47]
    ds_read_b64_tr_b16 a[232:233], v3 offset:1024
    v_cvt_pk_bf16_f32 v225, v226, v227
    v_fma_f32 v73, v73, s28, v11
    v_cvt_pk_bf16_f32 v216, v216, v217
    v_cvt_pk_bf16_f32 v104, v104, v105
    v_cvt_pk_bf16_f32 v192, v192, v193
    v_pk_mul_f32 v[130:131], v[130:131], v[48:49] op_sel_hi:[1,0]
    v_cvt_pk_bf16_f32 v109, v110, v111
    v_cvt_pk_bf16_f32 v105, v106, v107
    v_cvt_pk_bf16_f32 v217, v218, v219
    v_mfma_f32_16x16x32_bf16 v[208:211], a[212:215], v[26:29], 0
    ds_read_b64_tr_b16 a[228:229], v2 offset:1024
    v_xor_b32 v101, 96, v101
    v_mfma_f32_16x16x32_bf16 a[0:3], a[212:215], v[32:35], 0
    ds_read_b64_tr_b16 a[214:215], v4 offset:7168
    v_cvt_pk_bf16_f32 v129, v130, v131
    v_mfma_f32_16x16x32_bf16 v[44:47], a[244:247], v[26:29], v[44:47]
    s_waitcnt lgkmcnt(3)
    ds_write2st64_b64 v101, v[120:121], v[168:169] offset0:0 offset1:12
    v_mfma_f32_16x16x32_bf16 a[4:7], a[216:219], v[32:35], 0
    s_add_u32 s20, s20, 128
    ds_write2st64_b64 v101, v[216:217], v[104:105] offset0:24 offset1:36
    v_cvt_pk_bf16_f32 v221, v222, v223
    v_pk_mul_f32 v[234:235], v[234:235], v[50:51] op_sel_hi:[1,0]
    v_pk_mul_f32 v[174:175], v[174:175], v[102:103] op_sel_hi:[1,0]
    v_pk_mul_f32 v[198:199], v[198:199], v[102:103] op_sel_hi:[1,0]
    v_accvgpr_read_b32 v111, a23
    v_pk_mul_f32 v[246:247], v[246:247], v[50:51] op_sel_hi:[1,0]
    v_pk_mul_f32 v[146:147], v[146:147], v[48:49] op_sel_hi:[1,0]
    v_cvt_pk_bf16_f32 v173, v174, v175
    v_pk_mul_f32 v[206:207], v[206:207], v[102:103] op_sel_hi:[1,0]
    v_pk_mul_f32 v[196:197], v[196:197], v[102:103] op_sel_hi:[1,0]
    v_pk_mul_f32 v[134:135], v[134:135], v[48:49] op_sel_hi:[1,0]
    v_fma_f32 v80, v80, s28, v12
    v_cvt_pk_bf16_f32 v188, v188, v189
    v_cvt_pk_bf16_f32 v132, v132, v133
    v_mfma_f32_16x16x32_bf16 v[212:215], a[216:219], v[26:29], 0
    ds_read_b64_tr_b16 a[212:213], v4 offset:1024
    v_xor_b32 v101, 32, v101
    v_mfma_f32_16x16x32_bf16 v[164:167], a[216:219], v[20:23], 0
    ds_read_b64_tr_b16 a[224:225], v5 offset:0
    v_accvgpr_read_b32 v104, a16
    v_accvgpr_read_b32 v107, a19
    v_fma_f32 v56, v56, s28, v9
    v_accvgpr_read_b32 v110, a22
    v_mfma_f32_16x16x32_bf16 v[116:119], a[216:219], v[14:17], 0
    ds_read_b64_tr_b16 a[226:227], v5 offset:6144
    v_accvgpr_read_b32 v105, a17
    v_mfma_f32_16x16x32_bf16 v[120:123], a[220:223], v[14:17], 0
    ds_read_b64_tr_b16 a[230:231], v2 offset:7168
    v_fma_f32 v52, v52, s28, v9
    v_mfma_f32_16x16x32_bf16 v[168:171], a[220:223], v[20:23], 0
    s_add_u32 m0, s22, 14336
    ds_write2st64_b64 v101, v[124:125], v[172:173] offset0:0 offset1:12
    v_fma_f32 v77, v77, s28, v12
    v_mfma_f32_16x16x32_bf16 v[216:219], a[220:223], v[26:29], 0
    buffer_load_dwordx4 v6, s[4:7], s20 offen lds
    ds_read_b64_tr_b16 a[216:217], v5 offset:1024
    v_cvt_pk_bf16_f32 v145, v146, v147
    v_cvt_pk_bf16_f32 v204, v204, v205
    v_pk_mul_f32 v[104:105], v[104:105], v[8:9] op_sel_hi:[1,0]
    v_pk_mul_f32 v[150:151], v[150:151], v[48:49] op_sel_hi:[1,0]
    v_pk_mul_f32 v[230:231], v[230:231], v[50:51] op_sel_hi:[1,0]
    v_cvt_pk_bf16_f32 v196, v196, v197
    v_fma_f32 v81, v81, s28, v12
    v_cvt_pk_bf16_f32 v229, v230, v231
    v_pk_mul_f32 v[250:251], v[250:251], v[50:51] op_sel_hi:[1,0]
    v_pk_mul_f32 v[202:203], v[202:203], v[102:103] op_sel_hi:[1,0]
    v_accvgpr_read_b32 v106, a18
    v_fma_f32 v76, v76, s28, v12
    v_pk_mul_f32 v[238:239], v[238:239], v[50:51] op_sel_hi:[1,0]
    v_pk_mul_f32 v[106:107], v[106:107], v[8:9] op_sel_hi:[1,0]
    v_cvt_pk_bf16_f32 v253, v254, v255
    v_cvt_pk_bf16_f32 v104, v104, v105
    v_mfma_f32_16x16x32_bf16 v[44:47], a[248:251], v[32:35], v[44:47]
    ds_write2st64_b64 v101, v[220:221], v[108:109] offset0:24 offset1:36
    v_cvt_pk_bf16_f32 v105, v106, v107
    v_cvt_pk_bf16_f32 v133, v134, v135
    v_xor_b32 v101, 96, v101
    v_mfma_f32_16x16x32_bf16 a[8:11], a[220:223], v[32:35], 0
    s_waitcnt lgkmcnt(2)
    ds_read_b128 v[84:87], v103 offset:0
    v_accvgpr_read_b32 v109, a21
    v_mfma_f32_16x16x32_bf16 a[12:15], a[224:227], v[32:35], 0
    ds_write2st64_b64 v101, v[128:129], v[176:177] offset0:4 offset1:16
    v_mfma_f32_16x16x32_bf16 v[220:223], a[224:227], v[26:29], 0
    ds_write2st64_b64 v101, v[224:225], v[104:105] offset0:28 offset1:40
    v_mfma_f32_16x16x32_bf16 v[172:175], a[224:227], v[20:23], 0
    s_add_u32 s20, s20, 12032
    ds_read_b64_tr_b16 a[222:223], v2 offset:8192
    v_fma_f32 v64, v64, s28, v10
    v_accvgpr_read_b32 v108, a20
    v_accvgpr_read_b32 v106, a26
    v_accvgpr_read_b32 v107, a27
    v_pk_mul_f32 v[108:109], v[108:109], v[8:9] op_sel_hi:[1,0]
    v_pk_mul_f32 v[110:111], v[110:111], v[8:9] op_sel_hi:[1,0]
    v_cvt_pk_bf16_f32 v108, v108, v109
    v_cvt_pk_bf16_f32 v109, v110, v111
    v_fma_f32 v61, v61, s28, v10
    v_pk_mul_f32 v[236:237], v[236:237], v[50:51] op_sel_hi:[1,0]
    v_pk_mul_f32 v[154:155], v[154:155], v[48:49] op_sel_hi:[1,0]
    v_pk_mul_f32 v[106:107], v[106:107], v[8:9] op_sel_hi:[1,0]
    v_pk_mul_f32 v[158:159], v[158:159], v[48:49] op_sel_hi:[1,0]
    v_exp_f32 v64, v64
    v_cvt_pk_bf16_f32 v189, v190, v191
    v_exp_f32 v76, v76
    v_mfma_f32_16x16x32_bf16 v[124:127], a[224:227], v[14:17], 0
    ds_read_b64_tr_b16 a[218:219], v5 offset:7168
    v_cvt_pk_bf16_f32 v236, v236, v237
    v_cvt_pk_bf16_f32 v201, v202, v203
    v_cvt_pk_bf16_f32 v248, v248, v249
    v_xor_b32 v101, 32, v101
    v_mfma_f32_16x16x32_bf16 v[128:131], a[228:231], v[14:17], 0
    s_add_u32 m0, s38, 0
    ds_read_b64_tr_b16 a[220:221], v2 offset:2048
    v_fma_f32 v58, v58, s28, v9
    v_mfma_f32_16x16x32_bf16 v[176:179], a[228:231], v[20:23], 0
    ds_read_b128 v[88:91], v103 offset:1024
    v_cvt_pk_bf16_f32 v185, v186, v187
    v_mfma_f32_16x16x32_bf16 v[224:227], a[228:231], v[26:29], 0
    ds_write2st64_b64 v101, v[132:133], v[180:181] offset0:4 offset1:16
    v_cvt_pk_bf16_f32 v241, v242, v243
    v_accvgpr_read_b32 v111, a31
    v_accvgpr_read_b32 v104, a24
    v_mfma_f32_16x16x32_bf16 a[16:19], a[228:231], v[32:35], 0
    ds_write2st64_b64 v101, v[228:229], v[108:109] offset0:28 offset1:40
    v_cvt_pk_bf16_f32 v197, v198, v199
    v_xor_b32 v101, 96, v101
    v_exp_f32 v54, v54
    v_pk_mul_f32 v[138:139], v[138:139], v[48:49] op_sel_hi:[1,0]
    v_accvgpr_read_b32 v108, a28
    v_cvt_pk_bf16_f32 v141, v142, v143
    v_accvgpr_read_b32 v109, a29
    v_cvt_pk_bf16_f32 v137, v138, v139
    v_fma_f32 v65, v65, s28, v10
    v_cvt_pk_bf16_f32 v233, v234, v235
    v_accvgpr_read_b32 v105, a25
    v_pk_mul_f32 v[104:105], v[104:105], v[8:9] op_sel_hi:[1,0]
    v_cvt_pk_bf16_f32 v157, v158, v159
    v_cvt_pk_bf16_f32 v148, v148, v149
    v_accvgpr_read_b32 v110, a30
    v_cvt_pk_bf16_f32 v104, v104, v105
    v_pk_mul_f32 v[108:109], v[108:109], v[8:9] op_sel_hi:[1,0]
    v_exp_f32 v52, v52
    v_cvt_pk_bf16_f32 v108, v108, v109
    v_cvt_pk_bf16_f32 v18, v52, v53
    v_cvt_pk_bf16_f32 v105, v106, v107
    v_mfma_f32_16x16x32_bf16 a[20:23], a[232:235], v[32:35], 0
    ds_write2st64_b64 v101, v[136:137], v[184:185] offset0:4 offset1:16
    v_mfma_f32_16x16x32_bf16 v[228:231], a[232:235], v[26:29], 0
    s_waitcnt lgkmcnt(2)
    ds_read_b64_tr_b16 a[226:227], v3 offset:8192
    buffer_load_dwordx4 v6, s[12:15], s33 offen nt lds
    v_accvgpr_read_b32 v106, a34
    v_mfma_f32_16x16x32_bf16 v[180:183], a[232:235], v[20:23], 0
    ds_write2st64_b64 v101, v[232:233], v[104:105] offset0:28 offset1:40
    v_pk_mul_f32 v[110:111], v[110:111], v[8:9] op_sel_hi:[1,0]
    v_cvt_pk_bf16_f32 v193, v194, v195
    v_xor_b32 v101, 32, v101
    v_mfma_f32_16x16x32_bf16 v[132:135], a[232:235], v[14:17], 0
    ds_write2st64_b64 v101, v[140:141], v[188:189] offset0:4 offset1:16
    v_fma_f32 v82, v82, s28, v12
    v_accvgpr_read_b32 v105, a33
    v_mfma_f32_16x16x32_bf16 v[136:139], a[212:215], v[14:17], 0
    ds_read_b64_tr_b16 a[230:231], v4 offset:8192
    v_cvt_pk_bf16_f32 v109, v110, v111
    v_cvt_pk_bf16_f32 v149, v150, v151
    v_fma_f32 v79, v79, s28, v12
    v_accvgpr_read_b32 v107, a35
    v_mfma_f32_16x16x32_bf16 v[184:187], a[212:215], v[20:23], 0
    ds_read_b64_tr_b16 a[228:229], v4 offset:2048
    v_accvgpr_read_b32 v111, a39
    v_fma_f32 v67, v67, s28, v10
    v_cvt_pk_bf16_f32 v244, v244, v245
    v_mfma_f32_16x16x32_bf16 v[232:235], a[212:215], v[26:29], 0
    s_add_u32 m0, s38, 1024
    ds_read_b64_tr_b16 a[232:233], v5 offset:2048
    v_cvt_pk_bf16_f32 v237, v238, v239
    v_mfma_f32_16x16x32_bf16 a[24:27], a[212:215], v[32:35], 0
    ds_write2st64_b64 v101, v[236:237], v[108:109] offset0:28 offset1:40
    v_accvgpr_read_b32 v108, a36
    v_pk_mul_f32 v[106:107], v[106:107], v[8:9] op_sel_hi:[1,0]
    v_xor_b32 v101, 96, v101
    v_accvgpr_read_b32 v104, a32
    v_mfma_f32_16x16x32_bf16 a[28:31], a[216:219], v[32:35], 0
    ds_write2st64_b64 v101, v[144:145], v[192:193] offset0:8 offset1:20
    v_pk_mul_f32 v[104:105], v[104:105], v[8:9] op_sel_hi:[1,0]
    v_accvgpr_read_b32 v109, a37
    v_pk_mul_f32 v[108:109], v[108:109], v[8:9] op_sel_hi:[1,0]
    v_cvt_pk_bf16_f32 v104, v104, v105
    v_accvgpr_read_b32 v110, a38
    v_mfma_f32_16x16x32_bf16 v[236:239], a[216:219], v[26:29], 0
    ds_read_b64_tr_b16 a[234:235], v5 offset:8192
    buffer_load_dwordx4 v7, s[12:15], s33 offen nt lds
    v_cvt_pk_bf16_f32 v105, v106, v107
    v_accvgpr_read_b32 v107, a43
    v_mfma_f32_16x16x32_bf16 v[188:191], a[216:219], v[20:23], 0
    s_add_u32 s39, s39, 12288
    ds_read_b64_tr_b16 a[224:225], v3 offset:2048
    v_cvt_pk_bf16_f32 v245, v246, v247
    v_mfma_f32_16x16x32_bf16 v[140:143], a[216:219], v[14:17], 0
    ds_write2st64_b64 v101, v[240:241], v[104:105] offset0:32 offset1:44
    v_accvgpr_read_b32 v106, a42
    v_accvgpr_read_b32 v104, a40
    v_xor_b32 v101, 32, v101
    v_pk_mul_f32 v[110:111], v[110:111], v[8:9] op_sel_hi:[1,0]
    v_accvgpr_read_b32 v105, a41
    v_cvt_pk_bf16_f32 v108, v108, v109
    v_mfma_f32_16x16x32_bf16 v[144:147], a[220:223], v[14:17], 0
    buffer_store_dwordx4 v[84:87], v6, s[16:19], s67 offen offset:0 nt
    v_exp_f32 v71, v71
    v_pk_mul_f32 v[104:105], v[104:105], v[8:9] op_sel_hi:[1,0]
    v_cvt_pk_bf16_f32 v109, v110, v111
    v_fma_f32 v66, v66, s28, v10
    v_mfma_f32_16x16x32_bf16 v[192:195], a[220:223], v[20:23], 0
    ds_write2st64_b64 v101, v[148:149], v[196:197] offset0:8 offset1:20
    v_mfma_f32_16x16x32_bf16 v[240:243], a[220:223], v[26:29], 0
    v_fma_f32 v72, v72, s28, v11
    v_accvgpr_read_b32 v110, a46
    v_mfma_f32_16x16x32_bf16 a[32:35], a[220:223], v[32:35], 0
    s_waitcnt vmcnt(9) lgkmcnt(2)
    ds_read_b128 v[96:99], v103 offset:2048
    v_exp_f32 v67, v67
    v_mfma_f32_16x16x32_bf16 a[36:39], a[224:227], v[32:35], 0
    ds_write2st64_b64 v101, v[244:245], v[108:109] offset0:32 offset1:44
    v_cvt_pk_bf16_f32 v205, v206, v207
    v_mfma_f32_16x16x32_bf16 v[244:247], a[224:227], v[26:29], 0
    buffer_store_dwordx4 v[88:91], v7, s[16:19], s67 offen offset:0 nt
    s_barrier
    ds_read_b128 a[220:223], v0 offset:1024
    v_accvgpr_read_b32 v111, a47
    v_exp_f32 v78, v78
    v_accvgpr_read_b32 v109, a45
    v_accvgpr_read_b32 v108, a44
    v_pk_mul_f32 v[110:111], v[110:111], v[8:9] op_sel_hi:[1,0]
    v_pk_mul_f32 v[106:107], v[106:107], v[8:9] op_sel_hi:[1,0]
    v_cvt_pk_bf16_f32 v153, v154, v155
    v_xor_b32 v101, 96, v101
    v_pk_mul_f32 v[108:109], v[108:109], v[8:9] op_sel_hi:[1,0]
    v_cvt_pk_bf16_f32 v249, v250, v251
    v_cvt_pk_bf16_f32 v108, v108, v109
    v_mfma_f32_16x16x32_bf16 v[196:199], a[224:227], v[20:23], 0
    s_add_u32 m0, s22, 24576
    ds_read_b128 a[216:219], v1 offset:0
    v_cvt_pk_bf16_f32 v19, v54, v55
    v_exp_f32 v70, v70
    v_cvt_pk_bf16_f32 v104, v104, v105
    v_mfma_f32_16x16x32_bf16 v[148:151], a[224:227], v[14:17], 0
    ds_write2st64_b64 v101, v[152:153], v[200:201] offset0:8 offset1:20
    v_cvt_pk_bf16_f32 v105, v106, v107
    v_mfma_f32_16x16x32_bf16 v[152:155], a[228:231], v[14:17], 0
    ds_read_b128 a[212:215], v0 offset:0
    v_exp_f32 v68, v68
    v_mfma_f32_16x16x32_bf16 v[200:203], a[228:231], v[20:23], 0
    ds_write2st64_b64 v101, v[248:249], v[104:105] offset0:32 offset1:44
    v_xor_b32 v101, 32, v101
    v_cvt_pk_bf16_f32 v109, v110, v111
    v_mfma_f32_16x16x32_bf16 v[248:251], a[228:231], v[26:29], 0
    ds_write2st64_b64 v101, v[156:157], v[204:205] offset0:8 offset1:20
    v_mfma_f32_16x16x32_bf16 a[40:43], a[228:231], v[32:35], 0
    ds_read_b128 a[224:227], v1 offset:1024
    v_exp_f32 v61, v61
    v_cvt_pk_bf16_f32 v30, v68, v69
    v_mfma_f32_16x16x32_bf16 a[44:47], a[232:235], v[32:35], 0
    ds_write2st64_b64 v101, v[252:253], v[108:109] offset0:32 offset1:44
    v_cvt_pk_bf16_f32 v24, v60, v61
    v_mfma_f32_16x16x32_bf16 v[252:255], a[232:235], v[26:29], 0
    ds_read_b128 a[228:231], v0 offset:2048
    buffer_load_dwordx4 v6, s[8:11], s21 offen lds
    v_mfma_f32_16x16x32_bf16 v[204:207], a[232:235], v[20:23], 0
    v_exp_f32 v58, v58
    v_mfma_f32_16x16x32_bf16 v[156:159], a[232:235], v[14:17], 0
    s_waitcnt lgkmcnt(4)
    v_exp_f32 v77, v77
    v_mfma_f32_16x16x32_bf16 v[52:55], a[212:215], a[96:99], 0
    s_add_u32 s21, s21, 128
    ds_read_b128 v[84:87], v103 offset:3072
    v_cvt_pk_bf16_f32 v36, v76, v77
    v_mfma_f32_16x16x32_bf16 v[52:55], a[216:219], a[100:103], v[52:55]
    ds_read_b128 a[232:235], v1 offset:2048
    v_cvt_pk_bf16_f32 v31, v70, v71
    v_mfma_f32_16x16x32_bf16 v[52:55], a[220:223], a[104:107], v[52:55]
    s_add_u32 m0, s22, 25600
    v_exp_f32 v79, v79
    v_mfma_f32_16x16x32_bf16 v[60:63], a[220:223], a[128:131], 0
    v_exp_f32 v59, v59
    v_mfma_f32_16x16x32_bf16 v[60:63], a[216:219], a[124:127], v[60:63]
    buffer_load_dwordx4 v6, s[8:11], s21 offen lds
    v_mfma_f32_16x16x32_bf16 v[60:63], a[212:215], a[120:123], v[60:63]
    s_add_u32 s21, s21, 128
    v_exp_f32 v66, v66
    v_mfma_f32_16x16x32_bf16 v[68:71], a[212:215], a[144:147], 0
    s_add_u32 m0, s22, 26624
    v_exp_f32 v57, v57
    v_mfma_f32_16x16x32_bf16 v[68:71], a[216:219], a[148:151], v[68:71]
    buffer_load_dwordx4 v6, s[8:11], s21 offen lds
    v_exp_f32 v56, v56
    v_mfma_f32_16x16x32_bf16 v[68:71], a[220:223], a[152:155], v[68:71]
    s_add_u32 s21, s21, 12032
    ds_read_b128 v[88:91], v103 offset:4096
    v_cvt_pk_bf16_f32 v37, v78, v79
    v_mfma_f32_16x16x32_bf16 v[76:79], a[220:223], a[176:179], 0
    s_add_u32 s56, s67, 128
    v_cvt_pk_bf16_f32 v17, v58, v59
    v_fma_f32 v74, v74, s28, v11
    v_mfma_f32_16x16x32_bf16 v[76:79], a[216:219], a[172:175], v[76:79]
    ds_read_b128 a[216:219], v1 offset:6144
    v_cvt_pk_bf16_f32 v16, v56, v57
    v_mfma_f32_16x16x32_bf16 v[76:79], a[212:215], a[168:171], v[76:79]
    ds_read_b128 a[220:223], v0 offset:7168
    v_exp_f32 v80, v80
    v_mfma_f32_16x16x32_bf16 v[48:51], a[236:239], v[16:19], v[44:47]
    s_waitcnt lgkmcnt(3)
    v_exp_f32 v65, v65
    v_mfma_f32_16x16x32_bf16 v[76:79], a[224:227], a[180:183], v[76:79]
    s_add_u32 s58, s33, 128
    ds_read_b128 a[212:215], v0 offset:6144
    v_cvt_pk_bf16_f32 v22, v64, v65
    v_mfma_f32_16x16x32_bf16 v[76:79], a[228:231], a[184:187], v[76:79]
    buffer_store_dwordx4 v[96:99], v6, s[16:19], s56 offen offset:0 nt
    v_exp_f32 v82, v82
    v_exp_f32 v75, v75
    v_mfma_f32_16x16x32_bf16 v[76:79], a[232:235], a[188:191], v[76:79]
    v_exp_f32 v73, v73
    v_mfma_f32_16x16x32_bf16 v[68:71], a[232:235], a[164:167], v[68:71]
    s_add_u32 m0, s38, 2048
    v_exp_f32 v81, v81
    v_mfma_f32_16x16x32_bf16 v[68:71], a[228:231], a[160:163], v[68:71]
    buffer_load_dwordx4 v6, s[12:15], s58 offen nt lds
    v_mfma_f32_16x16x32_bf16 v[68:71], a[224:227], a[156:159], v[68:71]
    s_add_u32 m0, s38, 3072
    ds_read_b128 v[96:99], v103 offset:5120
    v_cvt_pk_bf16_f32 v23, v66, v67
    v_mfma_f32_16x16x32_bf16 v[60:63], a[224:227], a[132:135], v[60:63]
    v_exp_f32 v72, v72
    v_mfma_f32_16x16x32_bf16 v[60:63], a[228:231], a[136:139], v[60:63]
    v_exp_f32 v74, v74
    v_mfma_f32_16x16x32_bf16 v[60:63], a[232:235], a[140:143], v[60:63]
    buffer_load_dwordx4 v7, s[12:15], s58 offen nt lds
    v_mfma_f32_16x16x32_bf16 v[52:55], a[232:235], a[116:119], v[52:55]
    v_cvt_pk_bf16_f32 v34, v80, v81
    v_exp_f32 v83, v83
    v_mfma_f32_16x16x32_bf16 v[48:51], a[240:243], v[22:25], v[48:51]
    v_cvt_pk_bf16_f32 v29, v74, v75
    v_cvt_pk_bf16_f32 v28, v72, v73
    v_mfma_f32_16x16x32_bf16 v[52:55], a[228:231], a[112:115], v[52:55]
    v_cvt_pk_bf16_f32 v35, v82, v83
    v_mfma_f32_16x16x32_bf16 v[52:55], a[224:227], a[108:111], v[52:55]
    s_add_u32 s57, s67, 256
    s_add_u32 s59, s33, 256
    ds_read_b128 a[228:231], v0 offset:8192
    v_mfma_f32_16x16x32_bf16 v[48:51], a[244:247], v[28:31], v[48:51]
    ds_read_b128 a[232:235], v1 offset:8192
    v_mfma_f32_16x16x32_bf16 v[48:51], a[248:251], v[34:37], v[48:51]
    s_add_u32 m0, s38, 4096
    ds_read_b128 a[224:227], v1 offset:7168
    s_waitcnt lgkmcnt(3)
    v_mfma_f32_16x16x32_bf16 v[56:59], a[212:215], a[96:99], 0
    buffer_load_dwordx4 v6, s[12:15], s59 offen nt lds
    v_mfma_f32_16x16x32_bf16 v[56:59], a[216:219], a[100:103], v[56:59]
    s_add_u32 m0, s38, 5120
    s_nop 0
    v_cmp_lt_f32 vcc, s29, v48
    v_mfma_f32_16x16x32_bf16 v[56:59], a[220:223], a[104:107], v[56:59]
    buffer_load_dwordx4 v7, s[12:15], s59 offen nt lds
    v_mfma_f32_16x16x32_bf16 v[64:67], a[220:223], a[128:131], 0
    buffer_store_dwordx4 v[84:87], v7, s[16:19], s56 offen offset:0 nt
    s_nop 0
    s_cbranch_vccnz L_rs_tr44d
L_ret_tr44d:
    v_fma_f32 v54, v54, s28, v9
    v_mfma_f32_16x16x32_bf16 v[64:67], a[216:219], a[124:127], v[64:67]
    v_add_u32 v103, 6144, v103
    v_mfma_f32_16x16x32_bf16 v[64:67], a[212:215], a[120:123], v[64:67]
    v_fma_f32 v61, v61, s28, v10
    v_fma_f32 v53, v53, s28, v9
    v_mfma_f32_16x16x32_bf16 v[72:75], a[212:215], a[144:147], 0
    v_fma_f32 v52, v52, s28, v9
    v_fma_f32 v55, v55, s28, v9
    v_mfma_f32_16x16x32_bf16 v[72:75], a[216:219], a[148:151], v[72:75]
    v_exp_f32 v55, v55
    v_mfma_f32_16x16x32_bf16 v[72:75], a[220:223], a[152:155], v[72:75]
    s_waitcnt vmcnt(16) lgkmcnt(0)
    v_fma_f32 v60, v60, s28, v10
    s_add_u32 m0, s22, 0
    v_mfma_f32_16x16x32_bf16 v[80:83], a[220:223], a[176:179], 0
    buffer_store_dwordx4 v[88:91], v6, s[16:19], s57 offen offset:0 nt
    s_barrier
    v_exp_f32 v60, v60
    v_mfma_f32_16x16x32_bf16 v[80:83], a[216:219], a[172:175], v[80:83]
    v_exp_f32 v52, v52
    v_mfma_f32_16x16x32_bf16 v[80:83], a[212:215], a[168:171], v[80:83]
    v_exp_f32 v53, v53
    v_mfma_f32_16x16x32_bf16 v[80:83], a[224:227], a[180:183], v[80:83]
    buffer_load_dwordx4 v6, s[4:7], s20 offen lds
    v_mfma_f32_16x16x32_bf16 v[80:83], a[228:231], a[184:187], v[80:83]
    v_exp_f32 v54, v54
    v_mfma_f32_16x16x32_bf16 v[80:83], a[232:235], a[188:191], v[80:83]
    ds_read_b64_tr_b16 a[212:213], v2 offset:18432
    v_cvt_pk_bf16_f32 v14, v52, v53
    v_mfma_f32_16x16x32_bf16 v[72:75], a[232:235], a[164:167], v[72:75]
    ds_read_b64_tr_b16 a[214:215], v2 offset:12288
    s_add_u32 s20, s20, 128
    v_mfma_f32_16x16x32_bf16 v[72:75], a[228:231], a[160:163], v[72:75]
    s_add_u32 m0, s22, 1024
    ds_read_b64_tr_b16 a[216:217], v3 offset:18432
    v_mfma_f32_16x16x32_bf16 v[72:75], a[224:227], a[156:159], v[72:75]
    v_exp_f32 v61, v61
    v_mfma_f32_16x16x32_bf16 v[64:67], a[224:227], a[132:135], v[64:67]
    ds_read_b64_tr_b16 a[218:219], v3 offset:12288
    v_mfma_f32_16x16x32_bf16 v[64:67], a[228:231], a[136:139], v[64:67]
    buffer_load_dwordx4 v6, s[4:7], s20 offen lds
    v_mfma_f32_16x16x32_bf16 v[64:67], a[232:235], a[140:143], v[64:67]
    buffer_store_dwordx4 v[96:99], v7, s[16:19], s57 offen offset:0 nt
    s_add_u32 s20, s20, 128
    ds_read_b64_tr_b16 a[220:221], v4 offset:18432
    v_cvt_pk_bf16_f32 v20, v60, v61
    v_cvt_pk_bf16_f32 v15, v54, v55
    v_mfma_f32_16x16x32_bf16 v[56:59], a[232:235], a[116:119], v[56:59]
    s_add_u32 m0, s22, 2048
    ds_read_b64_tr_b16 a[222:223], v4 offset:12288
    v_mfma_f32_16x16x32_bf16 v[56:59], a[228:231], a[112:115], v[56:59]
    buffer_load_dwordx4 v6, s[4:7], s20 offen lds
    v_mfma_f32_16x16x32_bf16 v[56:59], a[224:227], a[108:111], v[56:59]
    s_add_u32 s20, s20, 12032
    ds_read_b64_tr_b16 a[224:225], v5 offset:18432
    ds_read_b64_tr_b16 a[226:227], v5 offset:12288
    s_branch L_loop4
L_end5:
    s_waitcnt lgkmcnt(4)
    v_mfma_f32_16x16x32_bf16 v[112:115], a[212:215], v[16:19], v[112:115]
    v_mfma_f32_16x16x32_bf16 v[116:119], a[216:219], v[16:19], v[116:119]
    v_fma_f32 v85, v85, s28, v13
    v_fma_f32 v83, v83, s28, v12
    v_mfma_f32_16x16x32_bf16 v[164:167], a[216:219], v[22:25], v[164:167]
    v_fma_f32 v78, v78, s28, v12
    v_fma_f32 v68, v68, s28, v11
    v_mfma_f32_16x16x32_bf16 v[160:163], a[212:215], v[22:25], v[160:163]
    ds_read_b64_tr_b16 a[230:231], v2 offset:13312
    v_fma_f32 v84, v84, s28, v13
    v_mfma_f32_16x16x32_bf16 v[208:211], a[212:215], v[28:31], v[208:211]
    ds_read_b64_tr_b16 a[232:233], v3 offset:19456
    v_fma_f32 v79, v79, s28, v12
    v_mfma_f32_16x16x32_bf16 v[212:215], a[216:219], v[28:31], v[212:215]
    ds_read_b64_tr_b16 a[234:235], v3 offset:13312
    v_mfma_f32_16x16x32_bf16 a[4:7], a[216:219], v[34:37], a[4:7]
    v_fma_f32 v69, v69, s28, v11
    v_fma_f32 v81, v81, s28, v12
    v_mfma_f32_16x16x32_bf16 a[0:3], a[212:215], v[34:37], a[0:3]
    ds_read_b64_tr_b16 a[228:229], v2 offset:19456
    v_mfma_f32_16x16x32_bf16 a[48:51], a[212:215], v[40:43], a[48:51]
    v_fma_f32 v71, v71, s28, v11
    v_mfma_f32_16x16x32_bf16 a[52:55], a[216:219], v[40:43], a[52:55]
    s_waitcnt lgkmcnt(4)
    ds_read_b64_tr_b16 a[214:215], v4 offset:13312
    v_fma_f32 v59, v59, s28, v9
    v_mfma_f32_16x16x32_bf16 a[56:59], a[220:223], v[40:43], a[56:59]
    v_fma_f32 v76, v76, s28, v12
    v_fma_f32 v87, v87, s28, v13
    v_mfma_f32_16x16x32_bf16 a[60:63], a[224:227], v[40:43], a[60:63]
    ds_read_b64_tr_b16 a[216:217], v5 offset:19456
    v_mfma_f32_16x16x32_bf16 a[12:15], a[224:227], v[34:37], a[12:15]
    v_exp_f32 v83, v83
    v_mfma_f32_16x16x32_bf16 a[8:11], a[220:223], v[34:37], a[8:11]
    ds_read_b64_tr_b16 a[212:213], v4 offset:19456
    v_mfma_f32_16x16x32_bf16 v[216:219], a[220:223], v[28:31], v[216:219]
    v_fma_f32 v74, v74, s28, v11
    v_fma_f32 v89, v89, s28, v13
    v_mfma_f32_16x16x32_bf16 v[220:223], a[224:227], v[28:31], v[220:223]
    v_fma_f32 v82, v82, s28, v12
    v_mfma_f32_16x16x32_bf16 v[172:175], a[224:227], v[22:25], v[172:175]
    v_fma_f32 v90, v90, s28, v13
    v_mfma_f32_16x16x32_bf16 v[168:171], a[220:223], v[22:25], v[168:171]
    ds_read_b64_tr_b16 a[218:219], v5 offset:13312
    v_fma_f32 v57, v57, s28, v9
    v_mfma_f32_16x16x32_bf16 v[120:123], a[220:223], v[16:19], v[120:123]
    v_exp_f32 v69, v69
    v_mfma_f32_16x16x32_bf16 v[124:127], a[224:227], v[16:19], v[124:127]
    s_waitcnt lgkmcnt(3)
    v_exp_f32 v85, v85
    v_mfma_f32_16x16x32_bf16 v[128:131], a[228:231], v[16:19], v[128:131]
    ds_read_b64_tr_b16 a[220:221], v2 offset:20480
    v_fma_f32 v75, v75, s28, v11
    v_mfma_f32_16x16x32_bf16 v[132:135], a[232:235], v[16:19], v[132:135]
    ds_read_b64_tr_b16 a[222:223], v2 offset:14336
    v_mfma_f32_16x16x32_bf16 v[180:183], a[232:235], v[22:25], v[180:183]
    v_exp_f32 v84, v84
    v_mfma_f32_16x16x32_bf16 v[176:179], a[228:231], v[22:25], v[176:179]
    s_add_u32 s39, s39, 12288
    v_fma_f32 v56, v56, s28, v9
    v_fma_f32 v73, v73, s28, v11
    v_mfma_f32_16x16x32_bf16 v[224:227], a[228:231], v[28:31], v[224:227]
    v_exp_f32 v87, v87
    v_mfma_f32_16x16x32_bf16 v[228:231], a[232:235], v[28:31], v[228:231]
    v_fma_f32 v77, v77, s28, v12
    v_mfma_f32_16x16x32_bf16 a[20:23], a[232:235], v[34:37], a[20:23]
    ds_read_b64_tr_b16 a[226:227], v3 offset:14336
    v_fma_f32 v86, v86, s28, v13
    v_mfma_f32_16x16x32_bf16 a[16:19], a[228:231], v[34:37], a[16:19]
    v_exp_f32 v68, v68
    v_mfma_f32_16x16x32_bf16 a[64:67], a[228:231], v[40:43], a[64:67]
    v_fma_f32 v91, v91, s28, v13
    v_fma_f32 v70, v70, s28, v11
    v_mfma_f32_16x16x32_bf16 a[68:71], a[232:235], v[40:43], a[68:71]
    s_waitcnt lgkmcnt(3)
    ds_read_b64_tr_b16 a[228:229], v4 offset:20480
    v_fma_f32 v80, v80, s28, v12
    v_mfma_f32_16x16x32_bf16 a[72:75], a[212:215], v[40:43], a[72:75]
    ds_read_b64_tr_b16 a[224:225], v3 offset:20480
    v_fma_f32 v88, v88, s28, v13
    v_mfma_f32_16x16x32_bf16 a[76:79], a[216:219], v[40:43], a[76:79]
    v_exp_f32 v76, v76
    v_mfma_f32_16x16x32_bf16 a[28:31], a[216:219], v[34:37], a[28:31]
    ds_read_b64_tr_b16 a[232:233], v5 offset:20480
    v_mfma_f32_16x16x32_bf16 a[24:27], a[212:215], v[34:37], a[24:27]
    ds_read_b64_tr_b16 a[234:235], v5 offset:14336
    v_cvt_pk_bf16_f32 v38, v84, v85
    v_mfma_f32_16x16x32_bf16 v[232:235], a[212:215], v[28:31], v[232:235]
    ds_read_b64_tr_b16 a[230:231], v4 offset:14336
    v_mfma_f32_16x16x32_bf16 v[236:239], a[216:219], v[28:31], v[236:239]
    v_exp_f32 v77, v77
    v_mfma_f32_16x16x32_bf16 v[188:191], a[216:219], v[22:25], v[188:191]
    v_exp_f32 v57, v57
    v_mfma_f32_16x16x32_bf16 v[184:187], a[212:215], v[22:25], v[184:187]
    v_exp_f32 v78, v78
    v_mfma_f32_16x16x32_bf16 v[136:139], a[212:215], v[16:19], v[136:139]
    v_fma_f32 v72, v72, s28, v11
    v_cvt_pk_bf16_f32 v26, v68, v69
    v_mfma_f32_16x16x32_bf16 v[140:143], a[216:219], v[16:19], v[140:143]
    s_waitcnt lgkmcnt(4)
    v_mfma_f32_16x16x32_bf16 v[144:147], a[220:223], v[16:19], v[144:147]
    s_waitcnt lgkmcnt(3)
    v_exp_f32 v79, v79
    v_mfma_f32_16x16x32_bf16 v[148:151], a[224:227], v[16:19], v[148:151]
    v_exp_f32 v70, v70
    v_mfma_f32_16x16x32_bf16 v[196:199], a[224:227], v[22:25], v[196:199]
    v_exp_f32 v71, v71
    v_mfma_f32_16x16x32_bf16 v[192:195], a[220:223], v[22:25], v[192:195]
    v_exp_f32 v59, v59
    v_mfma_f32_16x16x32_bf16 v[240:243], a[220:223], v[28:31], v[240:243]
    v_exp_f32 v75, v75
    v_mfma_f32_16x16x32_bf16 v[244:247], a[224:227], v[28:31], v[244:247]
    s_waitcnt vmcnt(10) lgkmcnt(0)
    v_exp_f32 v89, v89
    v_mfma_f32_16x16x32_bf16 a[36:39], a[224:227], v[34:37], a[36:39]
    v_fma_f32 v67, v67, s28, v10
    v_mfma_f32_16x16x32_bf16 a[32:35], a[220:223], v[34:37], a[32:35]
    s_barrier
    v_mfma_f32_16x16x32_bf16 a[80:83], a[220:223], v[40:43], a[80:83]
    ds_read_b128 a[212:215], v0 offset:12288
    v_cvt_pk_bf16_f32 v32, v76, v77
    v_mfma_f32_16x16x32_bf16 a[84:87], a[224:227], v[40:43], a[84:87]
    ds_read_b128 a[220:223], v0 offset:13312
    s_add_u32 m0, s22, 36864
    v_mfma_f32_16x16x32_bf16 a[88:91], a[228:231], v[40:43], a[88:91]
    ds_read_b128 a[216:219], v1 offset:12288
    v_cvt_pk_bf16_f32 v27, v70, v71
    v_mfma_f32_16x16x32_bf16 a[92:95], a[232:235], v[40:43], a[92:95]
    v_exp_f32 v72, v72
    v_mfma_f32_16x16x32_bf16 a[44:47], a[232:235], v[34:37], a[44:47]
    buffer_load_dwordx4 v6, s[8:11], s21 offen lds
    v_mfma_f32_16x16x32_bf16 a[40:43], a[228:231], v[34:37], a[40:43]
    s_add_u32 s21, s21, 128
    s_add_u32 m0, s22, 37888
    v_fma_f32 v58, v58, s28, v9
    v_mfma_f32_16x16x32_bf16 v[248:251], a[228:231], v[28:31], v[248:251]
    buffer_load_dwordx4 v6, s[8:11], s21 offen lds
    v_mfma_f32_16x16x32_bf16 v[252:255], a[232:235], v[28:31], v[252:255]
    ds_read_b128 a[224:227], v1 offset:13312
    v_fma_f32 v64, v64, s28, v10
    v_mfma_f32_16x16x32_bf16 v[204:207], a[232:235], v[22:25], v[204:207]
    v_exp_f32 v64, v64
    v_mfma_f32_16x16x32_bf16 v[200:203], a[228:231], v[22:25], v[200:203]
    s_add_u32 s21, s21, 128
    s_add_u32 m0, s22, 38912
    v_mfma_f32_16x16x32_bf16 v[152:155], a[228:231], v[16:19], v[152:155]
    buffer_load_dwordx4 v6, s[8:11], s21 offen lds
    v_mfma_f32_16x16x32_bf16 v[156:159], a[232:235], v[16:19], v[156:159]
    s_waitcnt lgkmcnt(2)
    ds_read_b128 a[228:231], v0 offset:14336
    v_mfma_f32_16x16x32_bf16 v[52:55], a[212:215], a[96:99], 0
    s_waitcnt lgkmcnt(2)
    v_cvt_pk_bf16_f32 v33, v78, v79
    v_mfma_f32_16x16x32_bf16 v[52:55], a[216:219], a[100:103], v[52:55]
    v_exp_f32 v86, v86
    v_mfma_f32_16x16x32_bf16 v[52:55], a[220:223], a[104:107], v[52:55]
    v_exp_f32 v73, v73
    v_mfma_f32_16x16x32_bf16 v[60:63], a[220:223], a[128:131], 0
    v_exp_f32 v88, v88
    v_mfma_f32_16x16x32_bf16 v[60:63], a[216:219], a[124:127], v[60:63]
    v_exp_f32 v56, v56
    v_mfma_f32_16x16x32_bf16 v[60:63], a[212:215], a[120:123], v[60:63]
    v_exp_f32 v81, v81
    v_mfma_f32_16x16x32_bf16 v[68:71], a[212:215], a[144:147], 0
    ds_read_b128 a[232:235], v1 offset:14336
    v_cvt_pk_bf16_f32 v16, v56, v57
    v_mfma_f32_16x16x32_bf16 v[68:71], a[216:219], a[148:151], v[68:71]
    v_fma_f32 v65, v65, s28, v10
    v_fma_f32 v66, v66, s28, v10
    v_mfma_f32_16x16x32_bf16 v[68:71], a[220:223], a[152:155], v[68:71]
    v_exp_f32 v82, v82
    v_mfma_f32_16x16x32_bf16 v[76:79], a[220:223], a[176:179], 0
    v_cvt_pk_bf16_f32 v39, v86, v87
    v_cvt_pk_bf16_f32 v35, v82, v83
    v_mfma_f32_16x16x32_bf16 v[76:79], a[216:219], a[172:175], v[76:79]
    v_exp_f32 v58, v58
    v_mfma_f32_16x16x32_bf16 v[76:79], a[212:215], a[168:171], v[76:79]
    v_exp_f32 v66, v66
    v_mfma_f32_16x16x32_bf16 v[84:87], a[212:215], a[192:195], 0
    v_exp_f32 v65, v65
    v_mfma_f32_16x16x32_bf16 v[84:87], a[216:219], a[196:199], v[84:87]
    v_mfma_f32_16x16x32_bf16 v[84:87], a[220:223], a[200:203], v[84:87]
    s_waitcnt lgkmcnt(1)
    v_exp_f32 v74, v74
    v_mfma_f32_16x16x32_bf16 v[84:87], a[224:227], a[204:207], v[84:87]
    v_exp_f32 v80, v80
    v_mfma_f32_16x16x32_bf16 v[84:87], a[228:231], a[208:211], v[84:87]
    s_waitcnt lgkmcnt(0)
    ds_read_b128 a[212:215], v0 offset:18432
    v_mfma_f32_16x16x32_bf16 v[84:87], a[232:235], v[92:95], v[84:87]
    v_exp_f32 v67, v67
    v_mfma_f32_16x16x32_bf16 v[76:79], a[232:235], a[188:191], v[76:79]
    v_exp_f32 v90, v90
    v_mfma_f32_16x16x32_bf16 v[76:79], a[228:231], a[184:187], v[76:79]
    v_cvt_pk_bf16_f32 v22, v64, v65
    v_cvt_pk_bf16_f32 v17, v58, v59
    v_mfma_f32_16x16x32_bf16 v[76:79], a[224:227], a[180:183], v[76:79]
    ds_read_b128 a[216:219], v1 offset:18432
    v_mfma_f32_16x16x32_bf16 v[68:71], a[224:227], a[156:159], v[68:71]
    v_cvt_pk_bf16_f32 v23, v66, v67
    v_cvt_pk_bf16_f32 v29, v74, v75
    v_mfma_f32_16x16x32_bf16 v[68:71], a[228:231], a[160:163], v[68:71]
    ds_read_b128 a[220:223], v0 offset:19456
    v_cvt_pk_bf16_f32 v40, v88, v89
    v_mfma_f32_16x16x32_bf16 v[68:71], a[232:235], a[164:167], v[68:71]
    v_cvt_pk_bf16_f32 v28, v72, v73
    v_mfma_f32_16x16x32_bf16 v[60:63], a[232:235], a[140:143], v[60:63]
    v_mfma_f32_16x16x32_bf16 v[60:63], a[228:231], a[136:139], v[60:63]
    v_exp_f32 v91, v91
    v_mfma_f32_16x16x32_bf16 v[60:63], a[224:227], a[132:135], v[60:63]
    v_mfma_f32_16x16x32_bf16 v[52:55], a[224:227], a[108:111], v[52:55]
    v_cvt_pk_bf16_f32 v34, v80, v81
    v_mfma_f32_16x16x32_bf16 v[52:55], a[228:231], a[112:115], v[52:55]
    ds_read_b128 a[224:227], v1 offset:19456
    v_mfma_f32_16x16x32_bf16 v[52:55], a[232:235], a[116:119], v[52:55]
    ds_read_b128 a[228:231], v0 offset:20480
    v_mfma_f32_16x16x32_bf16 v[44:47], a[236:239], v[14:17], v[48:51]
    ds_read_b128 a[232:235], v1 offset:20480
    v_mfma_f32_16x16x32_bf16 v[44:47], a[240:243], v[20:23], v[44:47]
    s_add_u32 s21, s21, 12032
    v_mfma_f32_16x16x32_bf16 v[44:47], a[244:247], v[26:29], v[44:47]
    v_cvt_pk_bf16_f32 v41, v90, v91
    v_mfma_f32_16x16x32_bf16 v[44:47], a[248:251], v[32:35], v[44:47]
    s_nop 0
    v_mfma_f32_16x16x32_bf16 v[44:47], a[252:255], v[38:41], v[44:47]
    s_waitcnt lgkmcnt(3)
    v_mfma_f32_16x16x32_bf16 v[56:59], a[212:215], a[96:99], 0
    v_mfma_f32_16x16x32_bf16 v[56:59], a[216:219], a[100:103], v[56:59]
    v_mfma_f32_16x16x32_bf16 v[56:59], a[220:223], a[104:107], v[56:59]
    v_mfma_f32_16x16x32_bf16 v[64:67], a[220:223], a[128:131], 0
    v_mfma_f32_16x16x32_bf16 v[64:67], a[216:219], a[124:127], v[64:67]
    v_mfma_f32_16x16x32_bf16 v[64:67], a[212:215], a[120:123], v[64:67]
    s_nop 0
    v_cmp_lt_f32 vcc, s29, v44
    s_waitcnt vmcnt(7) lgkmcnt(0)
    v_mfma_f32_16x16x32_bf16 v[72:75], a[212:215], a[144:147], 0
    s_barrier
    v_mfma_f32_16x16x32_bf16 v[72:75], a[216:219], a[148:151], v[72:75]
    s_nop 0
    s_cbranch_vccnz L_rs_end5a
L_ret_end5a:
    v_mfma_f32_16x16x32_bf16 v[72:75], a[220:223], a[152:155], v[72:75]
    v_fma_f32 v55, v55, s28, v9
    v_mfma_f32_16x16x32_bf16 v[80:83], a[220:223], a[176:179], 0
    v_fma_f32 v52, v52, s28, v9
    v_fma_f32 v60, v60, s28, v10
    v_mfma_f32_16x16x32_bf16 v[80:83], a[216:219], a[172:175], v[80:83]
    v_fma_f32 v63, v63, s28, v10
    v_mfma_f32_16x16x32_bf16 v[80:83], a[212:215], a[168:171], v[80:83]
    v_fma_f32 v61, v61, s28, v10
    v_fma_f32 v53, v53, s28, v9
    v_mfma_f32_16x16x32_bf16 v[88:91], a[212:215], a[192:195], 0
    v_exp_f32 v52, v52
    v_mfma_f32_16x16x32_bf16 v[88:91], a[216:219], a[196:199], v[88:91]
    v_exp_f32 v55, v55
    v_mfma_f32_16x16x32_bf16 v[88:91], a[220:223], a[200:203], v[88:91]
    v_fma_f32 v54, v54, s28, v9
    v_mfma_f32_16x16x32_bf16 v[88:91], a[224:227], a[204:207], v[88:91]
    ds_read_b64_tr_b16 a[212:213], v2 offset:0
    v_mfma_f32_16x16x32_bf16 v[88:91], a[228:231], a[208:211], v[88:91]
    v_exp_f32 v54, v54
    v_mfma_f32_16x16x32_bf16 v[88:91], a[232:235], v[92:95], v[88:91]
    v_exp_f32 v53, v53
    v_mfma_f32_16x16x32_bf16 v[80:83], a[232:235], a[188:191], v[80:83]
    ds_read_b64_tr_b16 a[214:215], v2 offset:6144
    v_fma_f32 v62, v62, s28, v10
    v_mfma_f32_16x16x32_bf16 v[80:83], a[228:231], a[184:187], v[80:83]
    ds_read_b64_tr_b16 a[216:217], v3 offset:0
    v_cvt_pk_bf16_f32 v18, v52, v53
    v_mfma_f32_16x16x32_bf16 v[80:83], a[224:227], a[180:183], v[80:83]
    ds_read_b64_tr_b16 a[218:219], v3 offset:6144
    v_cvt_pk_bf16_f32 v19, v54, v55
    v_mfma_f32_16x16x32_bf16 v[72:75], a[224:227], a[156:159], v[72:75]
    v_exp_f32 v61, v61
    v_mfma_f32_16x16x32_bf16 v[72:75], a[228:231], a[160:163], v[72:75]
    v_exp_f32 v60, v60
    v_mfma_f32_16x16x32_bf16 v[72:75], a[232:235], a[164:167], v[72:75]
    v_exp_f32 v62, v62
    v_mfma_f32_16x16x32_bf16 v[64:67], a[232:235], a[140:143], v[64:67]
    ds_read_b64_tr_b16 a[220:221], v4 offset:0
    v_mfma_f32_16x16x32_bf16 v[64:67], a[228:231], a[136:139], v[64:67]
    ds_read_b64_tr_b16 a[222:223], v4 offset:6144
    v_cvt_pk_bf16_f32 v24, v60, v61
    v_mfma_f32_16x16x32_bf16 v[64:67], a[224:227], a[132:135], v[64:67]
    v_mfma_f32_16x16x32_bf16 v[56:59], a[224:227], a[108:111], v[56:59]
    v_exp_f32 v63, v63
    v_mfma_f32_16x16x32_bf16 v[56:59], a[228:231], a[112:115], v[56:59]
    ds_read_b64_tr_b16 a[224:225], v5 offset:0
    v_mfma_f32_16x16x32_bf16 v[56:59], a[232:235], a[116:119], v[56:59]
    ds_read_b64_tr_b16 a[226:227], v5 offset:6144
    v_cvt_pk_bf16_f32 v25, v62, v63
    s_waitcnt lgkmcnt(4)
    v_mfma_f32_16x16x32_bf16 v[112:115], a[212:215], v[14:17], v[112:115]
    ds_read_b64_tr_b16 a[232:233], v3 offset:1024
    v_fma_f32 v90, v90, s28, v13
    v_mfma_f32_16x16x32_bf16 v[116:119], a[216:219], v[14:17], v[116:119]
    v_fma_f32 v70, v70, s28, v11
    v_fma_f32 v89, v89, s28, v13
    v_mfma_f32_16x16x32_bf16 v[164:167], a[216:219], v[20:23], v[164:167]
    s_add_u32 s39, s39, 12288
    v_exp_f32 v90, v90
    v_mfma_f32_16x16x32_bf16 v[160:163], a[212:215], v[20:23], v[160:163]
    v_fma_f32 v88, v88, s28, v13
    v_fma_f32 v71, v71, s28, v11
    v_mfma_f32_16x16x32_bf16 v[208:211], a[212:215], v[26:29], v[208:211]
    ds_read_b64_tr_b16 a[230:231], v2 offset:7168
    v_fma_f32 v57, v57, s28, v9
    v_mfma_f32_16x16x32_bf16 v[212:215], a[216:219], v[26:29], v[212:215]
    ds_read_b64_tr_b16 a[228:229], v2 offset:1024
    v_fma_f32 v67, v67, s28, v10
    v_mfma_f32_16x16x32_bf16 a[4:7], a[216:219], v[32:35], a[4:7]
    s_waitcnt vmcnt(0)
    v_fma_f32 v75, v75, s28, v11
    v_fma_f32 v83, v83, s28, v12
    v_mfma_f32_16x16x32_bf16 a[0:3], a[212:215], v[32:35], a[0:3]
    s_barrier
    v_mfma_f32_16x16x32_bf16 a[48:51], a[212:215], v[38:41], a[48:51]
    v_exp_f32 v75, v75
    v_fma_f32 v64, v64, s28, v10
    v_mfma_f32_16x16x32_bf16 a[52:55], a[216:219], v[38:41], a[52:55]
    s_waitcnt lgkmcnt(3)
    ds_read_b64_tr_b16 a[234:235], v3 offset:7168
    v_fma_f32 v77, v77, s28, v12
    v_mfma_f32_16x16x32_bf16 a[56:59], a[220:223], v[38:41], a[56:59]
    v_fma_f32 v74, v74, s28, v11
    v_fma_f32 v81, v81, s28, v12
    v_mfma_f32_16x16x32_bf16 a[60:63], a[224:227], v[38:41], a[60:63]
    ds_read_b64_tr_b16 a[212:213], v4 offset:1024
    v_fma_f32 v59, v59, s28, v9
    v_mfma_f32_16x16x32_bf16 a[12:15], a[224:227], v[32:35], a[12:15]
    v_fma_f32 v66, v66, s28, v10
    v_fma_f32 v79, v79, s28, v12
    v_mfma_f32_16x16x32_bf16 a[8:11], a[220:223], v[32:35], a[8:11]
    ds_read_b64_tr_b16 a[214:215], v4 offset:7168
    v_fma_f32 v91, v91, s28, v13
    v_mfma_f32_16x16x32_bf16 v[216:219], a[220:223], v[26:29], v[216:219]
    ds_read_b64_tr_b16 a[218:219], v5 offset:7168
    v_fma_f32 v56, v56, s28, v9
    v_mfma_f32_16x16x32_bf16 v[220:223], a[224:227], v[26:29], v[220:223]
    v_exp_f32 v56, v56
    v_mfma_f32_16x16x32_bf16 v[172:175], a[224:227], v[20:23], v[172:175]
    v_exp_f32 v88, v88
    v_mfma_f32_16x16x32_bf16 v[168:171], a[220:223], v[20:23], v[168:171]
    v_exp_f32 v57, v57
    v_mfma_f32_16x16x32_bf16 v[120:123], a[220:223], v[14:17], v[120:123]
    ds_read_b64_tr_b16 a[216:217], v5 offset:1024
    v_fma_f32 v85, v85, s28, v13
    v_mfma_f32_16x16x32_bf16 v[124:127], a[224:227], v[14:17], v[124:127]
    s_waitcnt lgkmcnt(4)
    v_fma_f32 v58, v58, s28, v9
    v_fma_f32 v68, v68, s28, v11
    v_mfma_f32_16x16x32_bf16 v[128:131], a[228:231], v[14:17], v[128:131]
    v_exp_f32 v79, v79
    v_mfma_f32_16x16x32_bf16 v[132:135], a[232:235], v[14:17], v[132:135]
    v_fma_f32 v80, v80, s28, v12
    v_exp_f32 v66, v66
    v_mfma_f32_16x16x32_bf16 v[180:183], a[232:235], v[20:23], v[180:183]
    ds_read_b64_tr_b16 a[226:227], v3 offset:8192
    v_fma_f32 v76, v76, s28, v12
    v_mfma_f32_16x16x32_bf16 v[176:179], a[228:231], v[20:23], v[176:179]
    v_exp_f32 v59, v59
    v_mfma_f32_16x16x32_bf16 v[224:227], a[228:231], v[26:29], v[224:227]
    ds_read_b64_tr_b16 a[220:221], v2 offset:2048
    v_fma_f32 v69, v69, s28, v11
    v_mfma_f32_16x16x32_bf16 v[228:231], a[232:235], v[26:29], v[228:231]
    ds_read_b64_tr_b16 a[222:223], v2 offset:8192
    v_fma_f32 v78, v78, s28, v12
    v_mfma_f32_16x16x32_bf16 a[20:23], a[232:235], v[32:35], a[20:23]
    v_exp_f32 v78, v78
    v_mfma_f32_16x16x32_bf16 a[16:19], a[228:231], v[32:35], a[16:19]
    ds_read_b64_tr_b16 a[224:225], v3 offset:2048
    v_fma_f32 v84, v84, s28, v13
    v_mfma_f32_16x16x32_bf16 a[64:67], a[228:231], v[38:41], a[64:67]
    v_exp_f32 v81, v81
    v_mfma_f32_16x16x32_bf16 a[68:71], a[232:235], v[38:41], a[68:71]
    s_waitcnt lgkmcnt(4)
    v_fma_f32 v86, v86, s28, v13
    v_fma_f32 v65, v65, s28, v10
    v_mfma_f32_16x16x32_bf16 a[72:75], a[212:215], v[38:41], a[72:75]
    ds_read_b64_tr_b16 a[228:229], v4 offset:2048
    v_fma_f32 v87, v87, s28, v13
    v_mfma_f32_16x16x32_bf16 a[76:79], a[216:219], v[38:41], a[76:79]
    ds_read_b64_tr_b16 a[234:235], v5 offset:8192
    v_exp_f32 v67, v67
    v_mfma_f32_16x16x32_bf16 a[28:31], a[216:219], v[32:35], a[28:31]
    v_exp_f32 v76, v76
    v_mfma_f32_16x16x32_bf16 a[24:27], a[212:215], v[32:35], a[24:27]
    v_exp_f32 v70, v70
    v_mfma_f32_16x16x32_bf16 v[232:235], a[212:215], v[26:29], v[232:235]
    v_exp_f32 v83, v83
    v_mfma_f32_16x16x32_bf16 v[236:239], a[216:219], v[26:29], v[236:239]
    ds_read_b64_tr_b16 a[230:231], v4 offset:8192
    v_fma_f32 v73, v73, s28, v11
    v_mfma_f32_16x16x32_bf16 v[188:191], a[216:219], v[20:23], v[188:191]
    v_exp_f32 v68, v68
    v_mfma_f32_16x16x32_bf16 v[184:187], a[212:215], v[20:23], v[184:187]
    v_exp_f32 v65, v65
    v_mfma_f32_16x16x32_bf16 v[136:139], a[212:215], v[14:17], v[136:139]
    v_exp_f32 v80, v80
    v_mfma_f32_16x16x32_bf16 v[140:143], a[216:219], v[14:17], v[140:143]
    s_waitcnt lgkmcnt(3)
    v_exp_f32 v74, v74
    v_mfma_f32_16x16x32_bf16 v[144:147], a[220:223], v[14:17], v[144:147]
    ds_read_b64_tr_b16 a[232:233], v5 offset:2048
    v_fma_f32 v82, v82, s28, v12
    v_mfma_f32_16x16x32_bf16 v[148:151], a[224:227], v[14:17], v[148:151]
    v_exp_f32 v77, v77
    v_exp_f32 v89, v89
    v_mfma_f32_16x16x32_bf16 v[196:199], a[224:227], v[20:23], v[196:199]
    v_exp_f32 v86, v86
    v_mfma_f32_16x16x32_bf16 v[192:195], a[220:223], v[20:23], v[192:195]
    ds_read_b64_tr_b16 a[212:213], v2 offset:18432
    v_exp_f32 v85, v85
    v_mfma_f32_16x16x32_bf16 v[240:243], a[220:223], v[26:29], v[240:243]
    v_exp_f32 v58, v58
    v_mfma_f32_16x16x32_bf16 v[244:247], a[224:227], v[26:29], v[244:247]
    v_exp_f32 v84, v84
    v_mfma_f32_16x16x32_bf16 a[36:39], a[224:227], v[32:35], a[36:39]
    v_cvt_pk_bf16_f32 v37, v78, v79
    v_cvt_pk_bf16_f32 v42, v84, v85
    v_mfma_f32_16x16x32_bf16 a[32:35], a[220:223], v[32:35], a[32:35]
    v_exp_f32 v69, v69
    v_mfma_f32_16x16x32_bf16 a[80:83], a[220:223], v[38:41], a[80:83]
    v_exp_f32 v73, v73
    v_mfma_f32_16x16x32_bf16 a[84:87], a[224:227], v[38:41], a[84:87]
    s_waitcnt lgkmcnt(1)
    ds_read_b64_tr_b16 a[214:215], v2 offset:12288
    v_cvt_pk_bf16_f32 v30, v68, v69
    v_mfma_f32_16x16x32_bf16 a[88:91], a[228:231], v[38:41], a[88:91]
    v_exp_f32 v82, v82
    v_fma_f32 v72, v72, s28, v11
    v_mfma_f32_16x16x32_bf16 a[92:95], a[232:235], v[38:41], a[92:95]
    v_exp_f32 v64, v64
    v_mfma_f32_16x16x32_bf16 a[44:47], a[232:235], v[32:35], a[44:47]
    v_exp_f32 v71, v71
    v_mfma_f32_16x16x32_bf16 a[40:43], a[228:231], v[32:35], a[40:43]
    v_exp_f32 v91, v91
    v_mfma_f32_16x16x32_bf16 v[248:251], a[228:231], v[26:29], v[248:251]
    ds_read_b64_tr_b16 a[216:217], v3 offset:18432
    v_cvt_pk_bf16_f32 v40, v88, v89
    v_mfma_f32_16x16x32_bf16 v[252:255], a[232:235], v[26:29], v[252:255]
    ds_read_b64_tr_b16 a[218:219], v3 offset:12288
    v_cvt_pk_bf16_f32 v35, v82, v83
    v_mfma_f32_16x16x32_bf16 v[204:207], a[232:235], v[20:23], v[204:207]
    ds_read_b64_tr_b16 a[220:221], v4 offset:18432
    v_exp_f32 v72, v72
    v_mfma_f32_16x16x32_bf16 v[200:203], a[228:231], v[20:23], v[200:203]
    ds_read_b64_tr_b16 a[222:223], v4 offset:12288
    v_cvt_pk_bf16_f32 v23, v66, v67
    v_mfma_f32_16x16x32_bf16 v[152:155], a[228:231], v[14:17], v[152:155]
    v_cvt_pk_bf16_f32 v31, v70, v71
    v_cvt_pk_bf16_f32 v28, v72, v73
    v_cvt_pk_bf16_f32 v22, v64, v65
    v_mfma_f32_16x16x32_bf16 v[156:159], a[232:235], v[14:17], v[156:159]
    v_cvt_pk_bf16_f32 v17, v58, v59
    v_cvt_pk_bf16_f32 v16, v56, v57
    v_cvt_pk_bf16_f32 v29, v74, v75
    v_cvt_pk_bf16_f32 v36, v76, v77
    v_mfma_f32_16x16x32_bf16 v[48:51], a[236:239], v[16:19], v[44:47]
    v_exp_f32 v87, v87
    v_mfma_f32_16x16x32_bf16 v[48:51], a[240:243], v[22:25], v[48:51]
    v_cvt_pk_bf16_f32 v43, v86, v87
    v_cvt_pk_bf16_f32 v34, v80, v81
    v_mfma_f32_16x16x32_bf16 v[48:51], a[244:247], v[28:31], v[48:51]
    ds_read_b64_tr_b16 a[224:225], v5 offset:18432
    v_cvt_pk_bf16_f32 v41, v90, v91
    v_mfma_f32_16x16x32_bf16 v[48:51], a[248:251], v[34:37], v[48:51]
    ds_read_b64_tr_b16 a[226:227], v5 offset:12288
    v_mfma_f32_16x16x32_bf16 v[48:51], a[252:255], v[40:43], v[48:51]
    s_nop 7
    v_cmp_lt_f32 vcc, s29, v48
    s_nop 4
    s_cbranch_vccnz L_rs_end5b
L_ret_end5b:
    v_and_b32 v101, 0x3ff, v0
    v_lshrrev_b32 v108, 11, v0
    v_rcp_f32 v8, v51
    v_rcp_f32 v50, v50
    v_xor_b32 v108, s65, v108
    v_lshl_add_u32 v101, v108, 10, v101
    v_mov_b32 v100, v48
    v_add_u32 v101, s38, v101
    v_mbcnt_lo_u32_b32 v108, -1, 0
    v_mbcnt_hi_u32_b32 v108, -1, v108
    v_lshrrev_b32 v108, 1, v108
    v_permlane32_swap_b32 v48, v100
    v_and_b32 v108, 24, v108
    v_bfe_u32 v108, s66, v108, 8
    v_xor_b32 v101, v101, v108
    v_mov_b32 v108, v100
    v_rcp_f32 v48, v48
    v_rcp_f32 v102, v49
    v_permlane16_swap_b32 v100, v108
    v_rcp_f32 v100, v100
    s_waitcnt lgkmcnt(4)
    v_mfma_f32_16x16x32_bf16 v[112:115], a[212:215], v[16:19], v[112:115]
    v_mfma_f32_16x16x32_bf16 v[116:119], a[216:219], v[16:19], v[116:119]
    v_mfma_f32_16x16x32_bf16 v[164:167], a[216:219], v[22:25], v[164:167]
    v_mfma_f32_16x16x32_bf16 v[160:163], a[212:215], v[22:25], v[160:163]
    v_mfma_f32_16x16x32_bf16 v[208:211], a[212:215], v[28:31], v[208:211]
    v_mfma_f32_16x16x32_bf16 v[212:215], a[216:219], v[28:31], v[212:215]
    ds_read_b64_tr_b16 a[232:233], v3 offset:19456
    v_subrev_u32 v103, 28672, v103
    v_mfma_f32_16x16x32_bf16 a[4:7], a[216:219], v[34:37], a[4:7]
    ds_read_b64_tr_b16 a[234:235], v3 offset:13312
    v_mfma_f32_16x16x32_bf16 a[0:3], a[212:215], v[34:37], a[0:3]
    v_mfma_f32_16x16x32_bf16 a[48:51], a[212:215], v[40:43], a[48:51]
    ds_read_b64_tr_b16 a[228:229], v2 offset:19456
    v_mfma_f32_16x16x32_bf16 a[52:55], a[216:219], v[40:43], a[52:55]
    s_waitcnt lgkmcnt(3)
    ds_read_b64_tr_b16 a[230:231], v2 offset:13312
    v_xor_b32 v92, 32, v101
    v_mfma_f32_16x16x32_bf16 a[56:59], a[220:223], v[40:43], a[56:59]
    v_xor_b32 v94, 96, v101
    v_accvgpr_read_b32 v104, a0
    v_mfma_f32_16x16x32_bf16 a[60:63], a[224:227], v[40:43], a[60:63]
    v_accvgpr_read_b32 v106, a2
    v_accvgpr_read_b32 v105, a1
    v_mfma_f32_16x16x32_bf16 a[12:15], a[224:227], v[34:37], a[12:15]
    ds_read_b64_tr_b16 a[218:219], v5 offset:13312
    v_mfma_f32_16x16x32_bf16 a[8:11], a[220:223], v[34:37], a[8:11]
    v_mfma_f32_16x16x32_bf16 v[216:219], a[220:223], v[28:31], v[216:219]
    s_add_u32 s84, s34, 0
    v_accvgpr_read_b32 v108, a4
    v_mfma_f32_16x16x32_bf16 v[220:223], a[224:227], v[28:31], v[220:223]
    v_mfma_f32_16x16x32_bf16 v[172:175], a[224:227], v[22:25], v[172:175]
    ds_read_b64_tr_b16 a[212:213], v4 offset:19456
    v_mfma_f32_16x16x32_bf16 v[168:171], a[220:223], v[22:25], v[168:171]
    ds_read_b64_tr_b16 a[216:217], v5 offset:19456
    v_mfma_f32_16x16x32_bf16 v[120:123], a[220:223], v[16:19], v[120:123]
    ds_read_b64_tr_b16 a[214:215], v4 offset:13312
    v_mfma_f32_16x16x32_bf16 v[124:127], a[224:227], v[16:19], v[124:127]
    s_waitcnt lgkmcnt(4)
    v_accvgpr_read_b32 v110, a6
    v_accvgpr_read_b32 v109, a5
    v_mfma_f32_16x16x32_bf16 v[128:131], a[228:231], v[16:19], v[128:131]
    v_accvgpr_read_b32 v111, a7
    v_mfma_f32_16x16x32_bf16 v[132:135], a[232:235], v[16:19], v[132:135]
    ds_read_b64_tr_b16 a[220:221], v2 offset:20480
    v_accvgpr_read_b32 v56, a12
    v_mfma_f32_16x16x32_bf16 v[180:183], a[232:235], v[22:25], v[180:183]
    ds_read_b64_tr_b16 a[224:225], v3 offset:20480
    v_xor_b32 v93, 64, v101
    v_mfma_f32_16x16x32_bf16 v[176:179], a[228:231], v[22:25], v[176:179]
    v_accvgpr_read_b32 v53, a9
    v_mfma_f32_16x16x32_bf16 v[224:227], a[228:231], v[28:31], v[224:227]
    v_accvgpr_read_b32 v57, a13
    v_mfma_f32_16x16x32_bf16 v[228:231], a[232:235], v[28:31], v[228:231]
    v_accvgpr_read_b32 v107, a3
    v_mfma_f32_16x16x32_bf16 a[20:23], a[232:235], v[34:37], a[20:23]
    v_accvgpr_read_b32 v59, a15
    v_mfma_f32_16x16x32_bf16 a[16:19], a[228:231], v[34:37], a[16:19]
    ds_read_b64_tr_b16 a[226:227], v3 offset:14336
    s_add_u32 s85, s34, 6144
    v_mfma_f32_16x16x32_bf16 a[64:67], a[228:231], v[40:43], a[64:67]
    ds_read_b64_tr_b16 a[222:223], v2 offset:14336
    v_mfma_f32_16x16x32_bf16 a[68:71], a[232:235], v[40:43], a[68:71]
    s_waitcnt lgkmcnt(4)
    ds_read_b64_tr_b16 a[234:235], v5 offset:14336
    v_mfma_f32_16x16x32_bf16 a[72:75], a[212:215], v[40:43], a[72:75]
    v_accvgpr_read_b32 v52, a8
    v_pk_mul_f32 v[122:123], v[122:123], v[48:49] op_sel_hi:[1,0]
    v_pk_mul_f32 v[106:107], v[106:107], v[8:9] op_sel_hi:[1,0]
    v_pk_mul_f32 v[162:163], v[162:163], v[102:103] op_sel_hi:[1,0]
    v_pk_mul_f32 v[168:169], v[168:169], v[102:103] op_sel_hi:[1,0]
    v_pk_mul_f32 v[166:167], v[166:167], v[102:103] op_sel_hi:[1,0]
    v_pk_mul_f32 v[128:129], v[128:129], v[48:49] op_sel_hi:[1,0]
    v_pk_mul_f32 v[118:119], v[118:119], v[48:49] op_sel_hi:[1,0]
    v_pk_mul_f32 v[174:175], v[174:175], v[102:103] op_sel_hi:[1,0]
    v_pk_mul_f32 v[212:213], v[212:213], v[50:51] op_sel_hi:[1,0]
    v_pk_mul_f32 v[56:57], v[56:57], v[8:9] op_sel_hi:[1,0]
    v_pk_mul_f32 v[160:161], v[160:161], v[102:103] op_sel_hi:[1,0]
    v_pk_mul_f32 v[170:171], v[170:171], v[102:103] op_sel_hi:[1,0]
    v_pk_mul_f32 v[120:121], v[120:121], v[48:49] op_sel_hi:[1,0]
    v_pk_mul_f32 v[214:215], v[214:215], v[50:51] op_sel_hi:[1,0]
    v_pk_mul_f32 v[124:125], v[124:125], v[48:49] op_sel_hi:[1,0]
    v_pk_mul_f32 v[164:165], v[164:165], v[102:103] op_sel_hi:[1,0]
    v_pk_mul_f32 v[114:115], v[114:115], v[48:49] op_sel_hi:[1,0]
    v_pk_mul_f32 v[228:229], v[228:229], v[50:51] op_sel_hi:[1,0]
    v_pk_mul_f32 v[172:173], v[172:173], v[102:103] op_sel_hi:[1,0]
    v_pk_mul_f32 v[210:211], v[210:211], v[50:51] op_sel_hi:[1,0]
    v_pk_mul_f32 v[126:127], v[126:127], v[48:49] op_sel_hi:[1,0]
    v_pk_mul_f32 v[216:217], v[216:217], v[50:51] op_sel_hi:[1,0]
    v_pk_mul_f32 v[218:219], v[218:219], v[50:51] op_sel_hi:[1,0]
    v_pk_mul_f32 v[52:53], v[52:53], v[8:9] op_sel_hi:[1,0]
    v_pk_mul_f32 v[208:209], v[208:209], v[50:51] op_sel_hi:[1,0]
    v_pk_mul_f32 v[116:117], v[116:117], v[48:49] op_sel_hi:[1,0]
    v_pk_mul_f32 v[112:113], v[112:113], v[48:49] op_sel_hi:[1,0]
    v_cvt_pk_bf16_f32 v164, v164, v165
    v_cvt_pk_bf16_f32 v112, v112, v113
    v_mfma_f32_16x16x32_bf16 a[76:79], a[216:219], v[40:43], a[76:79]
    v_cvt_pk_bf16_f32 v116, v116, v117
    v_cvt_pk_bf16_f32 v172, v172, v173
    v_mfma_f32_16x16x32_bf16 a[28:31], a[216:219], v[34:37], a[28:31]
    ds_read_b64_tr_b16 a[232:233], v5 offset:20480
    v_cvt_pk_bf16_f32 v113, v114, v115
    v_mfma_f32_16x16x32_bf16 a[24:27], a[212:215], v[34:37], a[24:27]
    v_cvt_pk_bf16_f32 v168, v168, v169
    v_cvt_pk_bf16_f32 v120, v120, v121
    v_mfma_f32_16x16x32_bf16 v[232:235], a[212:215], v[28:31], v[232:235]
    v_cvt_pk_bf16_f32 v121, v122, v123
    v_cvt_pk_bf16_f32 v160, v160, v161
    v_mfma_f32_16x16x32_bf16 v[236:239], a[216:219], v[28:31], v[236:239]
    v_cvt_pk_bf16_f32 v124, v124, v125
    v_cvt_pk_bf16_f32 v173, v174, v175
    v_mfma_f32_16x16x32_bf16 v[188:191], a[216:219], v[22:25], v[188:191]
    v_cvt_pk_bf16_f32 v125, v126, v127
    v_cvt_pk_bf16_f32 v216, v216, v217
    v_mfma_f32_16x16x32_bf16 v[184:187], a[212:215], v[22:25], v[184:187]
    ds_read_b64_tr_b16 a[230:231], v4 offset:14336
    v_cvt_pk_bf16_f32 v165, v166, v167
    v_mfma_f32_16x16x32_bf16 v[136:139], a[212:215], v[16:19], v[136:139]
    v_cvt_pk_bf16_f32 v117, v118, v119
    v_cvt_pk_bf16_f32 v161, v162, v163
    v_mfma_f32_16x16x32_bf16 v[140:143], a[216:219], v[16:19], v[140:143]
    s_waitcnt lgkmcnt(2)
    ds_write2st64_b64 v101, v[112:113], v[160:161] offset0:0 offset1:12
    v_mfma_f32_16x16x32_bf16 v[144:147], a[220:223], v[16:19], v[144:147]
    ds_read_b64_tr_b16 a[228:229], v4 offset:20480
    v_cvt_pk_bf16_f32 v169, v170, v171
    v_mfma_f32_16x16x32_bf16 v[148:151], a[224:227], v[16:19], v[148:151]
    s_add_u32 s86, s34, 12288
    ds_write2st64_b64 v92, v[116:117], v[164:165] offset0:0 offset1:12
    v_mfma_f32_16x16x32_bf16 v[196:199], a[224:227], v[22:25], v[196:199]
    ds_write2st64_b64 v93, v[120:121], v[168:169] offset0:0 offset1:12
    v_mfma_f32_16x16x32_bf16 v[192:195], a[220:223], v[22:25], v[192:195]
    ds_write2st64_b64 v94, v[124:125], v[172:173] offset0:0 offset1:12
    v_mfma_f32_16x16x32_bf16 v[240:243], a[220:223], v[28:31], v[240:243]
    ds_read_b128 v[76:79], v103 offset:0
    v_accvgpr_read_b32 v55, a11
    v_mfma_f32_16x16x32_bf16 v[244:247], a[224:227], v[28:31], v[244:247]
    s_add_u32 s87, s34, 18432
    ds_read_b128 v[80:83], v103 offset:1024
    v_mfma_f32_16x16x32_bf16 a[36:39], a[224:227], v[34:37], a[36:39]
    v_accvgpr_read_b32 v54, a10
    v_mfma_f32_16x16x32_bf16 a[32:35], a[220:223], v[34:37], a[32:35]
    v_cvt_pk_bf16_f32 v217, v218, v219
    v_mfma_f32_16x16x32_bf16 a[80:83], a[220:223], v[40:43], a[80:83]
    s_add_u32 s88, s34, 24576
    ds_read_b128 v[84:87], v103 offset:6144
    v_cvt_pk_bf16_f32 v208, v208, v209
    v_mfma_f32_16x16x32_bf16 a[84:87], a[224:227], v[40:43], a[84:87]
    s_waitcnt lgkmcnt(5)
    v_mfma_f32_16x16x32_bf16 a[88:91], a[228:231], v[40:43], a[88:91]
    v_mfma_f32_16x16x32_bf16 a[92:95], a[232:235], v[40:43], a[92:95]
    v_accvgpr_read_b32 v58, a14
    v_cvt_pk_bf16_f32 v52, v52, v53
    v_mfma_f32_16x16x32_bf16 a[44:47], a[232:235], v[34:37], a[44:47]
    v_cvt_pk_bf16_f32 v212, v212, v213
    v_mfma_f32_16x16x32_bf16 a[40:43], a[228:231], v[34:37], a[40:43]
    ds_read_b128 v[88:91], v103 offset:7168
    s_add_u32 s18, s34, 30720
    v_mfma_f32_16x16x32_bf16 v[248:251], a[228:231], v[28:31], v[248:251]
    s_waitcnt lgkmcnt(3)
    buffer_store_dwordx4 v[76:79], v6, s[16:19], s84 offen offset:0 nt
    v_pk_mul_f32 v[132:133], v[132:133], v[48:49] op_sel_hi:[1,0]
    v_pk_mul_f32 v[144:145], v[144:145], v[48:49] op_sel_hi:[1,0]
    v_cvt_pk_bf16_f32 v209, v210, v211
    v_pk_mul_f32 v[110:111], v[110:111], v[8:9] op_sel_hi:[1,0]
    v_cvt_pk_bf16_f32 v213, v214, v215
    v_pk_mul_f32 v[104:105], v[104:105], v[8:9] op_sel_hi:[1,0]
    v_pk_mul_f32 v[244:245], v[244:245], v[50:51] op_sel_hi:[1,0]
    v_pk_mul_f32 v[58:59], v[58:59], v[8:9] op_sel_hi:[1,0]
    v_pk_mul_f32 v[108:109], v[108:109], v[8:9] op_sel_hi:[1,0]
    v_cvt_pk_bf16_f32 v56, v56, v57
    v_pk_mul_f32 v[54:55], v[54:55], v[8:9] op_sel_hi:[1,0]
    v_cvt_pk_bf16_f32 v57, v58, v59
    v_pk_mul_f32 v[238:239], v[238:239], v[50:51] op_sel_hi:[1,0]
    v_pk_mul_f32 v[222:223], v[222:223], v[50:51] op_sel_hi:[1,0]
    v_cvt_pk_bf16_f32 v104, v104, v105
    v_cvt_pk_bf16_f32 v108, v108, v109
    v_pk_mul_f32 v[220:221], v[220:221], v[50:51] op_sel_hi:[1,0]
    v_cvt_pk_bf16_f32 v109, v110, v111
    v_cvt_pk_bf16_f32 v105, v106, v107
    v_pk_mul_f32 v[226:227], v[226:227], v[50:51] op_sel_hi:[1,0]
    ds_write2st64_b64 v101, v[208:209], v[104:105] offset0:24 offset1:36
    v_cvt_pk_bf16_f32 v53, v54, v55
    v_mfma_f32_16x16x32_bf16 v[252:255], a[232:235], v[28:31], v[252:255]
    s_waitcnt lgkmcnt(1)
    buffer_store_dwordx4 v[80:83], v7, s[16:19], s84 offen offset:0 nt
    ds_write2st64_b64 v92, v[212:213], v[108:109] offset0:24 offset1:36
    v_mfma_f32_16x16x32_bf16 v[204:207], a[232:235], v[22:25], v[204:207]
    v_pk_mul_f32 v[184:185], v[184:185], v[102:103] op_sel_hi:[1,0]
    v_accvgpr_read_b32 v107, a51
    v_cvt_pk_bf16_f32 v220, v220, v221
    v_pk_mul_f32 v[234:235], v[234:235], v[50:51] op_sel_hi:[1,0]
    ds_write2st64_b64 v93, v[216:217], v[52:53] offset0:24 offset1:36
    v_pk_mul_f32 v[232:233], v[232:233], v[50:51] op_sel_hi:[1,0]
    v_accvgpr_read_b32 v58, a62
    v_cvt_pk_bf16_f32 v221, v222, v223
    v_mfma_f32_16x16x32_bf16 v[200:203], a[228:231], v[22:25], v[200:203]
    v_accvgpr_read_b32 v52, a56
    buffer_store_dwordx4 v[84:87], v6, s[16:19], s85 offen offset:0 nt
    v_pk_mul_f32 v[186:187], v[186:187], v[102:103] op_sel_hi:[1,0]
    v_accvgpr_read_b32 v104, a48
    v_accvgpr_read_b32 v53, a57
    ds_write2st64_b64 v94, v[220:221], v[56:57] offset0:24 offset1:36
    v_mfma_f32_16x16x32_bf16 v[152:155], a[228:231], v[16:19], v[152:155]
    v_accvgpr_read_b32 v110, a54
    v_accvgpr_read_b32 v106, a50
    v_pk_mul_f32 v[242:243], v[242:243], v[50:51] op_sel_hi:[1,0]
    v_pk_mul_f32 v[254:255], v[254:255], v[50:51] op_sel_hi:[1,0]
    v_pk_mul_f32 v[136:137], v[136:137], v[48:49] op_sel_hi:[1,0]
    v_pk_mul_f32 v[190:191], v[190:191], v[102:103] op_sel_hi:[1,0]
    v_accvgpr_read_b32 v111, a55
    v_pk_mul_f32 v[176:177], v[176:177], v[102:103] op_sel_hi:[1,0]
    ds_read_b128 v[60:63], v103 offset:12288
    v_pk_mul_f32 v[182:183], v[182:183], v[102:103] op_sel_hi:[1,0]
    s_nop 1
    v_mfma_f32_16x16x32_bf16 v[156:159], a[232:235], v[16:19], v[156:159]
    buffer_store_dwordx4 v[88:91], v7, s[16:19], s85 offen offset:0 nt
    v_accvgpr_read_b32 v55, a59
    v_accvgpr_read_b32 v105, a49
    v_accvgpr_read_b32 v108, a52
    v_pk_mul_f32 v[192:193], v[192:193], v[102:103] op_sel_hi:[1,0]
    v_pk_mul_f32 v[178:179], v[178:179], v[102:103] op_sel_hi:[1,0]
    v_accvgpr_read_b32 v109, a53
    v_pk_mul_f32 v[110:111], v[110:111], v[100:101] op_sel_hi:[1,0]
    v_pk_mul_f32 v[52:53], v[52:53], v[100:101] op_sel_hi:[1,0]
    v_pk_mul_f32 v[106:107], v[106:107], v[100:101] op_sel_hi:[1,0]
    v_pk_mul_f32 v[140:141], v[140:141], v[48:49] op_sel_hi:[1,0]
    v_pk_mul_f32 v[224:225], v[224:225], v[50:51] op_sel_hi:[1,0]
    v_accvgpr_read_b32 v57, a61
    v_cvt_pk_bf16_f32 v144, v144, v145
    v_pk_mul_f32 v[104:105], v[104:105], v[100:101] op_sel_hi:[1,0]
    v_cvt_pk_bf16_f32 v52, v52, v53
    v_accvgpr_read_b32 v56, a60
    v_cvt_pk_bf16_f32 v232, v232, v233
    ds_read_b128 v[64:67], v103 offset:13312
    v_cvt_pk_bf16_f32 v104, v104, v105
    v_pk_mul_f32 v[196:197], v[196:197], v[102:103] op_sel_hi:[1,0]
    v_pk_mul_f32 v[252:253], v[252:253], v[50:51] op_sel_hi:[1,0]
    v_pk_mul_f32 v[180:181], v[180:181], v[102:103] op_sel_hi:[1,0]
    v_accvgpr_read_b32 v54, a58
    s_waitcnt lgkmcnt(1)
    buffer_store_dwordx4 v[60:63], v6, s[16:19], s86 offen offset:0 nt
    v_cvt_pk_bf16_f32 v105, v106, v107
    v_pk_mul_f32 v[108:109], v[108:109], v[100:101] op_sel_hi:[1,0]
    v_accvgpr_read_b32 v59, a63
    v_pk_mul_f32 v[54:55], v[54:55], v[100:101] op_sel_hi:[1,0]
    v_pk_mul_f32 v[56:57], v[56:57], v[100:101] op_sel_hi:[1,0]
    v_pk_mul_f32 v[134:135], v[134:135], v[48:49] op_sel_hi:[1,0]
    v_cvt_pk_bf16_f32 v108, v108, v109
    ds_read_b128 v[68:71], v103 offset:18432
    ds_read_b128 v[72:75], v103 offset:19456
    v_accvgpr_read_b32 v107, a19
    v_pk_mul_f32 v[58:59], v[58:59], v[100:101] op_sel_hi:[1,0]
    ds_write_b64 v101, v[104:105] offset:24576
    v_pk_mul_f32 v[130:131], v[130:131], v[48:49] op_sel_hi:[1,0]
    v_pk_mul_f32 v[188:189], v[188:189], v[102:103] op_sel_hi:[1,0]
    v_cvt_pk_bf16_f32 v109, v110, v111
    v_pk_mul_f32 v[246:247], v[246:247], v[50:51] op_sel_hi:[1,0]
    v_pk_mul_f32 v[154:155], v[154:155], v[48:49] op_sel_hi:[1,0]
    v_cvt_pk_bf16_f32 v228, v228, v229
    v_cvt_pk_bf16_f32 v53, v54, v55
    v_cvt_pk_bf16_f32 v184, v184, v185
    v_cvt_pk_bf16_f32 v136, v136, v137
    v_accvgpr_read_b32 v106, a18
    v_cvt_pk_bf16_f32 v188, v188, v189
    s_waitcnt lgkmcnt(3)
    buffer_store_dwordx4 v[64:67], v7, s[16:19], s86 offen offset:0 nt
    v_cvt_pk_bf16_f32 v128, v128, v129
    v_pk_mul_f32 v[230:231], v[230:231], v[50:51] op_sel_hi:[1,0]
    v_accvgpr_read_b32 v104, a16
    v_cvt_pk_bf16_f32 v180, v180, v181
    v_cvt_pk_bf16_f32 v185, v186, v187
    v_pk_mul_f32 v[250:251], v[250:251], v[50:51] op_sel_hi:[1,0]
    v_cvt_pk_bf16_f32 v56, v56, v57
    v_cvt_pk_bf16_f32 v224, v224, v225
    v_cvt_pk_bf16_f32 v229, v230, v231
    v_cvt_pk_bf16_f32 v140, v140, v141
    ds_write_b64 v92, v[108:109] offset:24576
    v_pk_mul_f32 v[202:203], v[202:203], v[102:103] op_sel_hi:[1,0]
    v_cvt_pk_bf16_f32 v129, v130, v131
    v_accvgpr_read_b32 v108, a20
    v_cvt_pk_bf16_f32 v252, v252, v253
    ds_write_b64 v93, v[52:53] offset:24576
    v_accvgpr_read_b32 v53, a25
    v_pk_mul_f32 v[156:157], v[156:157], v[48:49] op_sel_hi:[1,0]
    v_pk_mul_f32 v[152:153], v[152:153], v[48:49] op_sel_hi:[1,0]
    v_accvgpr_read_b32 v105, a17
    s_waitcnt lgkmcnt(2)
    buffer_store_dwordx4 v[68:71], v6, s[16:19], s87 offen offset:0 nt
    v_accvgpr_read_b32 v111, a23
    v_cvt_pk_bf16_f32 v132, v132, v133
    v_pk_mul_f32 v[150:151], v[150:151], v[48:49] op_sel_hi:[1,0]
    v_cvt_pk_bf16_f32 v156, v156, v157
    v_cvt_pk_bf16_f32 v57, v58, v59
    v_accvgpr_read_b32 v55, a27
    v_accvgpr_read_b32 v110, a22
    ds_write_b64 v94, v[56:57] offset:24576
    v_pk_mul_f32 v[138:139], v[138:139], v[48:49] op_sel_hi:[1,0]
    s_nop 0
    v_cvt_pk_bf16_f32 v137, v138, v139
    v_accvgpr_read_b32 v57, a29
    v_accvgpr_read_b32 v56, a28
    v_accvgpr_read_b32 v59, a31
    v_pk_mul_f32 v[142:143], v[142:143], v[48:49] op_sel_hi:[1,0]
    v_accvgpr_read_b32 v109, a21
    v_accvgpr_read_b32 v58, a30
    ds_read_b128 v[76:79], v103 offset:24576
    v_accvgpr_read_b32 v54, a26
    v_pk_mul_f32 v[104:105], v[104:105], v[8:9] op_sel_hi:[1,0]
    v_cvt_pk_bf16_f32 v176, v176, v177
    v_cvt_pk_bf16_f32 v177, v178, v179
    v_accvgpr_read_b32 v52, a24
    buffer_store_dwordx4 v[72:75], v7, s[16:19], s87 offen offset:0 nt
    v_cvt_pk_bf16_f32 v141, v142, v143
    v_pk_mul_f32 v[200:201], v[200:201], v[102:103] op_sel_hi:[1,0]
    v_cvt_pk_bf16_f32 v189, v190, v191
    ds_read_b128 v[80:83], v103 offset:25600
    v_pk_mul_f32 v[248:249], v[248:249], v[50:51] op_sel_hi:[1,0]
    v_cvt_pk_bf16_f32 v133, v134, v135
    v_pk_mul_f32 v[56:57], v[56:57], v[8:9] op_sel_hi:[1,0]
    v_cvt_pk_bf16_f32 v200, v200, v201
    v_pk_mul_f32 v[106:107], v[106:107], v[8:9] op_sel_hi:[1,0]
    v_pk_mul_f32 v[240:241], v[240:241], v[50:51] op_sel_hi:[1,0]
    v_cvt_pk_bf16_f32 v244, v244, v245
    v_pk_mul_f32 v[158:159], v[158:159], v[48:49] op_sel_hi:[1,0]
    ds_write2st64_b64 v101, v[128:129], v[176:177] offset0:4 offset1:16
    v_cvt_pk_bf16_f32 v181, v182, v183
    v_cvt_pk_bf16_f32 v104, v104, v105
    v_pk_mul_f32 v[204:205], v[204:205], v[102:103] op_sel_hi:[1,0]
    v_cvt_pk_bf16_f32 v56, v56, v57
    v_pk_mul_f32 v[54:55], v[54:55], v[8:9] op_sel_hi:[1,0]
    v_pk_mul_f32 v[52:53], v[52:53], v[8:9] op_sel_hi:[1,0]
    v_cvt_pk_bf16_f32 v105, v106, v107
    s_waitcnt lgkmcnt(2)
    buffer_store_dwordx4 v[76:79], v6, s[16:19], s88 offen offset:0 nt
    v_accvgpr_read_b32 v106, a66
    ds_write2st64_b64 v92, v[132:133], v[180:181] offset0:4 offset1:16
    ds_write2st64_b64 v93, v[136:137], v[184:185] offset0:4 offset1:16
    ds_write2st64_b64 v94, v[140:141], v[188:189] offset0:4 offset1:16
    ds_read_b128 v[84:87], v103 offset:2048
    ds_read_b128 v[88:91], v103 offset:3072
    v_cvt_pk_bf16_f32 v253, v254, v255
    v_cvt_pk_bf16_f32 v233, v234, v235
    ds_read_b128 v[60:63], v103 offset:8192
    ds_read_b128 v[64:67], v103 offset:9216
    v_pk_mul_f32 v[110:111], v[110:111], v[8:9] op_sel_hi:[1,0]
    v_pk_mul_f32 v[108:109], v[108:109], v[8:9] op_sel_hi:[1,0]
    s_waitcnt lgkmcnt(7)
    buffer_store_dwordx4 v[80:83], v7, s[16:19], s88 offen offset:0 nt
    v_pk_mul_f32 v[58:59], v[58:59], v[8:9] op_sel_hi:[1,0]
    v_accvgpr_read_b32 v107, a67
    v_pk_mul_f32 v[194:195], v[194:195], v[102:103] op_sel_hi:[1,0]
    v_cvt_pk_bf16_f32 v192, v192, v193
    v_cvt_pk_bf16_f32 v57, v58, v59
    v_cvt_pk_bf16_f32 v52, v52, v53
    v_pk_mul_f32 v[206:207], v[206:207], v[102:103] op_sel_hi:[1,0]
    v_cvt_pk_bf16_f32 v152, v152, v153
    v_cvt_pk_bf16_f32 v225, v226, v227
    v_pk_mul_f32 v[236:237], v[236:237], v[50:51] op_sel_hi:[1,0]
    v_cvt_pk_bf16_f32 v108, v108, v109
    v_cvt_pk_bf16_f32 v109, v110, v111
    v_cvt_pk_bf16_f32 v236, v236, v237
    ds_write2st64_b64 v101, v[224:225], v[104:105] offset0:28 offset1:40
    ds_write2st64_b64 v92, v[228:229], v[108:109] offset0:28 offset1:40
    v_accvgpr_read_b32 v111, a71
    v_accvgpr_read_b32 v108, a68
    s_waitcnt lgkmcnt(3)
    buffer_store_dwordx4 v[84:87], v6, s[16:19], s84 offen offset:128 nt
    v_accvgpr_read_b32 v105, a65
    v_cvt_pk_bf16_f32 v240, v240, v241
    v_pk_mul_f32 v[148:149], v[148:149], v[48:49] op_sel_hi:[1,0]
    v_pk_mul_f32 v[146:147], v[146:147], v[48:49] op_sel_hi:[1,0]
    v_cvt_pk_bf16_f32 v148, v148, v149
    v_accvgpr_read_b32 v109, a69
    v_accvgpr_read_b32 v104, a64
    v_accvgpr_read_b32 v110, a70
    v_pk_mul_f32 v[104:105], v[104:105], v[100:101] op_sel_hi:[1,0]
    v_pk_mul_f32 v[198:199], v[198:199], v[102:103] op_sel_hi:[1,0]
    v_cvt_pk_bf16_f32 v237, v238, v239
    v_cvt_pk_bf16_f32 v196, v196, v197
    v_accvgpr_read_b32 v59, a79
    v_cvt_pk_bf16_f32 v53, v54, v55
    ds_write2st64_b64 v93, v[232:233], v[52:53] offset0:28 offset1:40
    buffer_store_dwordx4 v[88:91], v7, s[16:19], s84 offen offset:128 nt
    v_cvt_pk_bf16_f32 v153, v154, v155
    ds_write2st64_b64 v94, v[236:237], v[56:57] offset0:28 offset1:40
    v_accvgpr_read_b32 v52, a72
    v_pk_mul_f32 v[106:107], v[106:107], v[100:101] op_sel_hi:[1,0]
    v_pk_mul_f32 v[108:109], v[108:109], v[100:101] op_sel_hi:[1,0]
    v_cvt_pk_bf16_f32 v104, v104, v105
    v_accvgpr_read_b32 v53, a73
    buffer_store_dwordx4 v[60:63], v6, s[16:19], s85 offen offset:128 nt
    v_accvgpr_read_b32 v57, a77
    ds_read_b128 v[68:71], v103 offset:14336
    v_accvgpr_read_b32 v55, a75
    ds_read_b128 v[72:75], v103 offset:15360
    v_accvgpr_read_b32 v58, a78
    v_accvgpr_read_b32 v56, a76
    v_cvt_pk_bf16_f32 v157, v158, v159
    v_cvt_pk_bf16_f32 v105, v106, v107
    ds_read_b128 v[76:79], v103 offset:20480
    v_pk_mul_f32 v[56:57], v[56:57], v[100:101] op_sel_hi:[1,0]
    v_cvt_pk_bf16_f32 v248, v248, v249
    v_pk_mul_f32 v[110:111], v[110:111], v[100:101] op_sel_hi:[1,0]
    v_cvt_pk_bf16_f32 v56, v56, v57
    v_cvt_pk_bf16_f32 v145, v146, v147
    v_pk_mul_f32 v[52:53], v[52:53], v[100:101] op_sel_hi:[1,0]
    s_waitcnt lgkmcnt(3)
    buffer_store_dwordx4 v[64:67], v7, s[16:19], s85 offen offset:128 nt
    v_cvt_pk_bf16_f32 v201, v202, v203
    v_pk_mul_f32 v[58:59], v[58:59], v[100:101] op_sel_hi:[1,0]
    v_cvt_pk_bf16_f32 v108, v108, v109
    ds_read_b128 v[80:83], v103 offset:21504
    ds_write_b64 v101, v[104:105] offset:26624
    v_cvt_pk_bf16_f32 v109, v110, v111
    v_cvt_pk_bf16_f32 v57, v58, v59
    v_cvt_pk_bf16_f32 v197, v198, v199
    v_cvt_pk_bf16_f32 v52, v52, v53
    v_accvgpr_read_b32 v54, a74
    v_pk_mul_f32 v[54:55], v[54:55], v[100:101] op_sel_hi:[1,0]
    ds_write_b64 v92, v[108:109] offset:26624
    s_waitcnt lgkmcnt(3)
    buffer_store_dwordx4 v[68:71], v6, s[16:19], s86 offen offset:128 nt
    v_cvt_pk_bf16_f32 v53, v54, v55
    v_cvt_pk_bf16_f32 v249, v250, v251
    ds_write_b64 v93, v[52:53] offset:26624
    v_accvgpr_read_b32 v105, a33
    ds_write_b64 v94, v[56:57] offset:26624
    v_accvgpr_read_b32 v58, a46
    v_cvt_pk_bf16_f32 v149, v150, v151
    v_accvgpr_read_b32 v109, a37
    v_accvgpr_read_b32 v54, a42
    v_cvt_pk_bf16_f32 v204, v204, v205
    buffer_store_dwordx4 v[72:75], v7, s[16:19], s86 offen offset:128 nt
    v_accvgpr_read_b32 v104, a32
    ds_read_b128 v[84:87], v103 offset:26624
    v_accvgpr_read_b32 v57, a45
    ds_read_b128 v[88:91], v103 offset:27648
    v_accvgpr_read_b32 v56, a44
    v_accvgpr_read_b32 v108, a36
    v_accvgpr_read_b32 v106, a34
    v_accvgpr_read_b32 v53, a41
    v_accvgpr_read_b32 v59, a47
    v_cvt_pk_bf16_f32 v193, v194, v195
    buffer_store_dwordx4 v[76:79], v6, s[16:19], s87 offen offset:128 nt
    v_accvgpr_read_b32 v55, a43
    v_pk_mul_f32 v[104:105], v[104:105], v[8:9] op_sel_hi:[1,0]
    s_waitcnt lgkmcnt(2)
    buffer_store_dwordx4 v[80:83], v7, s[16:19], s87 offen offset:128 nt
    v_accvgpr_read_b32 v110, a38
    v_accvgpr_read_b32 v107, a35
    v_pk_mul_f32 v[58:59], v[58:59], v[8:9] op_sel_hi:[1,0]
    ds_write2st64_b64 v101, v[144:145], v[192:193] offset0:8 offset1:20
    v_cvt_pk_bf16_f32 v205, v206, v207
    ds_write2st64_b64 v92, v[148:149], v[196:197] offset0:8 offset1:20
    v_accvgpr_read_b32 v52, a40
    s_waitcnt lgkmcnt(2)
    buffer_store_dwordx4 v[84:87], v6, s[16:19], s88 offen offset:128 nt
    ds_write2st64_b64 v93, v[152:153], v[200:201] offset0:8 offset1:20
    v_pk_mul_f32 v[108:109], v[108:109], v[8:9] op_sel_hi:[1,0]
    v_pk_mul_f32 v[106:107], v[106:107], v[8:9] op_sel_hi:[1,0]
    ds_write2st64_b64 v94, v[156:157], v[204:205] offset0:8 offset1:20
    v_cvt_pk_bf16_f32 v108, v108, v109
    ds_read_b128 v[60:63], v103 offset:4096
    v_accvgpr_read_b32 v111, a39
    ds_read_b128 v[64:67], v103 offset:5120
    v_pk_mul_f32 v[52:53], v[52:53], v[8:9] op_sel_hi:[1,0]
    ds_read_b128 v[68:71], v103 offset:10240
    buffer_store_dwordx4 v[88:91], v7, s[16:19], s88 offen offset:128 nt
    v_cvt_pk_bf16_f32 v104, v104, v105
    ds_read_b128 v[72:75], v103 offset:11264
    v_cvt_pk_bf16_f32 v105, v106, v107
    v_pk_mul_f32 v[110:111], v[110:111], v[8:9] op_sel_hi:[1,0]
    v_accvgpr_read_b32 v106, a82
    v_cvt_pk_bf16_f32 v245, v246, v247
    s_waitcnt lgkmcnt(3)
    buffer_store_dwordx4 v[60:63], v6, s[16:19], s84 offen offset:256 nt
    v_accvgpr_read_b32 v107, a83
    v_cvt_pk_bf16_f32 v52, v52, v53
    v_pk_mul_f32 v[56:57], v[56:57], v[8:9] op_sel_hi:[1,0]
    v_pk_mul_f32 v[54:55], v[54:55], v[8:9] op_sel_hi:[1,0]
    v_cvt_pk_bf16_f32 v241, v242, v243
    v_cvt_pk_bf16_f32 v109, v110, v111
    ds_write2st64_b64 v101, v[240:241], v[104:105] offset0:32 offset1:44
    ds_write2st64_b64 v92, v[244:245], v[108:109] offset0:32 offset1:44
    v_pk_mul_f32 v[106:107], v[106:107], v[100:101] op_sel_hi:[1,0]
    v_cvt_pk_bf16_f32 v53, v54, v55
    v_accvgpr_read_b32 v104, a80
    s_waitcnt lgkmcnt(2)
    buffer_store_dwordx4 v[64:67], v7, s[16:19], s84 offen offset:256 nt
    v_cvt_pk_bf16_f32 v56, v56, v57
    ds_write2st64_b64 v93, v[248:249], v[52:53] offset0:32 offset1:44
    v_accvgpr_read_b32 v110, a86
    v_cvt_pk_bf16_f32 v57, v58, v59
    v_accvgpr_read_b32 v108, a84
    v_accvgpr_read_b32 v105, a81
    ds_write2st64_b64 v94, v[252:253], v[56:57] offset0:32 offset1:44
    buffer_store_dwordx4 v[68:71], v6, s[16:19], s85 offen offset:256 nt
    v_accvgpr_read_b32 v58, a94
    v_accvgpr_read_b32 v53, a89
    v_accvgpr_read_b32 v109, a85
    v_accvgpr_read_b32 v111, a87
    ds_read_b128 v[76:79], v103 offset:16384
    v_accvgpr_read_b32 v57, a93
    v_accvgpr_read_b32 v56, a92
    v_accvgpr_read_b32 v59, a95
    v_accvgpr_read_b32 v52, a88
    v_pk_mul_f32 v[110:111], v[110:111], v[100:101] op_sel_hi:[1,0]
    ds_read_b128 v[80:83], v103 offset:17408
    v_pk_mul_f32 v[52:53], v[52:53], v[100:101] op_sel_hi:[1,0]
    v_pk_mul_f32 v[108:109], v[108:109], v[100:101] op_sel_hi:[1,0]
    buffer_store_dwordx4 v[72:75], v7, s[16:19], s85 offen offset:256 nt
    v_cvt_pk_bf16_f32 v108, v108, v109
    v_pk_mul_f32 v[104:105], v[104:105], v[100:101] op_sel_hi:[1,0]
    v_accvgpr_read_b32 v54, a90
    v_cvt_pk_bf16_f32 v104, v104, v105
    s_waitcnt lgkmcnt(1)
    buffer_store_dwordx4 v[76:79], v6, s[16:19], s86 offen offset:256 nt
    ds_read_b128 v[84:87], v103 offset:22528
    ds_read_b128 v[88:91], v103 offset:23552
    v_accvgpr_read_b32 v55, a91
    v_cvt_pk_bf16_f32 v105, v106, v107
    v_cvt_pk_bf16_f32 v52, v52, v53
    ds_write_b64 v101, v[104:105] offset:0
    v_pk_mul_f32 v[56:57], v[56:57], v[100:101] op_sel_hi:[1,0]
    s_nop 0
    v_cvt_pk_bf16_f32 v56, v56, v57
    v_pk_mul_f32 v[58:59], v[58:59], v[100:101] op_sel_hi:[1,0]
    s_nop 0
    v_cvt_pk_bf16_f32 v57, v58, v59
    v_pk_mul_f32 v[54:55], v[54:55], v[100:101] op_sel_hi:[1,0]
    s_nop 0
    v_cvt_pk_bf16_f32 v53, v54, v55
    s_waitcnt lgkmcnt(3)
    buffer_store_dwordx4 v[80:83], v7, s[16:19], s86 offen offset:256 nt
    v_cvt_pk_bf16_f32 v109, v110, v111
    ds_write_b64 v92, v[108:109] offset:0
    ds_write_b64 v93, v[52:53] offset:0
    ds_write_b64 v94, v[56:57] offset:0
    s_waitcnt lgkmcnt(3)
    buffer_store_dwordx4 v[84:87], v6, s[16:19], s87 offen offset:256 nt
    ds_read_b128 v[60:63], v103 offset:0
    ds_read_b128 v[64:67], v103 offset:1024
    buffer_store_dwordx4 v[88:91], v7, s[16:19], s87 offen offset:256 nt
    s_waitcnt lgkmcnt(1)
    buffer_store_dwordx4 v[60:63], v6, s[16:19], s88 offen offset:256 nt
    s_waitcnt lgkmcnt(0)
    buffer_store_dwordx4 v[64:67], v7, s[16:19], s88 offen offset:256 nt
    s_branch L_fin
L_end4:
    s_waitcnt lgkmcnt(6)
    v_mfma_f32_16x16x32_bf16 v[112:115], a[212:215], v[16:19], v[112:115]
    v_mfma_f32_16x16x32_bf16 v[160:163], a[212:215], v[22:25], v[160:163]
    ds_read_b64_tr_b16 a[230:231], v2 offset:13312
    v_mfma_f32_16x16x32_bf16 v[208:211], a[212:215], v[28:31], v[208:211]
    ds_read_b64_tr_b16 a[228:229], v2 offset:19456
    v_fma_f32 v74, v74, s28, v11
    v_mfma_f32_16x16x32_bf16 a[0:3], a[212:215], v[34:37], a[0:3]
    v_fma_f32 v75, v75, s28, v11
    s_waitcnt lgkmcnt(6)
    v_mfma_f32_16x16x32_bf16 a[4:7], a[216:219], v[34:37], a[4:7]
    ds_read_b64_tr_b16 a[214:215], v4 offset:13312
    v_fma_f32 v58, v58, s28, v9
    v_mfma_f32_16x16x32_bf16 v[212:215], a[216:219], v[28:31], v[212:215]
    v_fma_f32 v62, v62, s28, v10
    v_fma_f32 v57, v57, s28, v9
    v_mfma_f32_16x16x32_bf16 v[164:167], a[216:219], v[22:25], v[164:167]
    ds_read_b64_tr_b16 a[212:213], v4 offset:19456
    v_fma_f32 v77, v77, s28, v12
    v_mfma_f32_16x16x32_bf16 v[116:119], a[216:219], v[16:19], v[116:119]
    v_fma_f32 v78, v78, s28, v12
    s_waitcnt lgkmcnt(6)
    v_mfma_f32_16x16x32_bf16 v[120:123], a[220:223], v[16:19], v[120:123]
    s_add_u32 s39, s39, 12288
    ds_read_b64_tr_b16 a[234:235], v3 offset:13312
    v_fma_f32 v79, v79, s28, v12
    v_mfma_f32_16x16x32_bf16 v[168:171], a[220:223], v[22:25], v[168:171]
    ds_read_b64_tr_b16 a[232:233], v3 offset:19456
    v_fma_f32 v71, v71, s28, v11
    v_mfma_f32_16x16x32_bf16 v[216:219], a[220:223], v[28:31], v[216:219]
    ds_read_b64_tr_b16 a[216:217], v5 offset:19456
    v_fma_f32 v83, v83, s28, v12
    v_mfma_f32_16x16x32_bf16 a[8:11], a[220:223], v[34:37], a[8:11]
    s_waitcnt lgkmcnt(6)
    ds_read_b64_tr_b16 a[218:219], v5 offset:13312
    v_fma_f32 v70, v70, s28, v11
    v_mfma_f32_16x16x32_bf16 a[12:15], a[224:227], v[34:37], a[12:15]
    v_fma_f32 v66, v66, s28, v10
    v_mfma_f32_16x16x32_bf16 v[220:223], a[224:227], v[28:31], v[220:223]
    v_exp_f32 v71, v71
    v_mfma_f32_16x16x32_bf16 v[172:175], a[224:227], v[22:25], v[172:175]
    v_exp_f32 v74, v74
    v_mfma_f32_16x16x32_bf16 v[124:127], a[224:227], v[16:19], v[124:127]
    s_waitcnt lgkmcnt(5)
    ds_read_b64_tr_b16 a[224:225], v3 offset:20480
    v_mfma_f32_16x16x32_bf16 v[128:131], a[228:231], v[16:19], v[128:131]
    ds_read_b64_tr_b16 a[220:221], v2 offset:20480
    v_fma_f32 v73, v73, s28, v11
    v_mfma_f32_16x16x32_bf16 v[176:179], a[228:231], v[22:25], v[176:179]
    ds_read_b64_tr_b16 a[226:227], v3 offset:14336
    v_fma_f32 v72, v72, s28, v11
    v_mfma_f32_16x16x32_bf16 v[224:227], a[228:231], v[28:31], v[224:227]
    v_exp_f32 v83, v83
    v_mfma_f32_16x16x32_bf16 a[16:19], a[228:231], v[34:37], a[16:19]
    s_waitcnt lgkmcnt(5)
    ds_read_b64_tr_b16 a[222:223], v2 offset:14336
    v_fma_f32 v56, v56, s28, v9
    v_mfma_f32_16x16x32_bf16 a[20:23], a[232:235], v[34:37], a[20:23]
    ds_read_b64_tr_b16 a[230:231], v4 offset:14336
    v_fma_f32 v69, v69, s28, v11
    v_mfma_f32_16x16x32_bf16 v[228:231], a[232:235], v[28:31], v[228:231]
    v_exp_f32 v62, v62
    v_mfma_f32_16x16x32_bf16 v[180:183], a[232:235], v[22:25], v[180:183]
    ds_read_b64_tr_b16 a[228:229], v4 offset:20480
    v_mfma_f32_16x16x32_bf16 v[132:135], a[232:235], v[16:19], v[132:135]
    ds_read_b64_tr_b16 a[232:233], v5 offset:20480
    v_fma_f32 v68, v68, s28, v11
    v_mfma_f32_16x16x32_bf16 v[136:139], a[212:215], v[16:19], v[136:139]
    ds_read_b64_tr_b16 a[234:235], v5 offset:14336
    v_fma_f32 v63, v63, s28, v10
    v_mfma_f32_16x16x32_bf16 v[184:187], a[212:215], v[22:25], v[184:187]
    v_exp_f32 v70, v70
    v_mfma_f32_16x16x32_bf16 v[232:235], a[212:215], v[28:31], v[232:235]
    ds_read_b128 v[96:99], v103 offset:2048
    v_cvt_pk_bf16_f32 v27, v70, v71
    v_mfma_f32_16x16x32_bf16 a[24:27], a[212:215], v[34:37], a[24:27]
    s_waitcnt lgkmcnt(6)
    v_exp_f32 v79, v79
    v_mfma_f32_16x16x32_bf16 a[28:31], a[216:219], v[34:37], a[28:31]
    v_exp_f32 v63, v63
    v_mfma_f32_16x16x32_bf16 v[236:239], a[216:219], v[28:31], v[236:239]
    ds_read_b128 v[84:87], v103 offset:0
    v_fma_f32 v67, v67, s28, v10
    v_mfma_f32_16x16x32_bf16 v[188:191], a[216:219], v[22:25], v[188:191]
    v_exp_f32 v75, v75
    v_mfma_f32_16x16x32_bf16 v[140:143], a[216:219], v[16:19], v[140:143]
    s_waitcnt lgkmcnt(5)
    v_exp_f32 v69, v69
    v_mfma_f32_16x16x32_bf16 v[144:147], a[220:223], v[16:19], v[144:147]
    v_exp_f32 v66, v66
    v_mfma_f32_16x16x32_bf16 v[192:195], a[220:223], v[22:25], v[192:195]
    v_fma_f32 v76, v76, s28, v12
    s_waitcnt vmcnt(10) lgkmcnt(2)
    v_mfma_f32_16x16x32_bf16 v[240:243], a[220:223], v[28:31], v[240:243]
    s_barrier
    v_mfma_f32_16x16x32_bf16 a[32:35], a[220:223], v[34:37], a[32:35]
    ds_read_b128 a[212:215], v0 offset:12288
    v_cvt_pk_bf16_f32 v21, v62, v63
    v_mfma_f32_16x16x32_bf16 a[36:39], a[224:227], v[34:37], a[36:39]
    ds_read_b128 a[220:223], v0 offset:13312
    v_fma_f32 v82, v82, s28, v12
    v_mfma_f32_16x16x32_bf16 v[244:247], a[224:227], v[28:31], v[244:247]
    s_add_u32 m0, s22, 36864
    v_exp_f32 v78, v78
    v_mfma_f32_16x16x32_bf16 v[196:199], a[224:227], v[22:25], v[196:199]
    ds_read_b128 a[216:219], v1 offset:12288
    v_fma_f32 v80, v80, s28, v12
    v_mfma_f32_16x16x32_bf16 v[148:151], a[224:227], v[16:19], v[148:151]
    buffer_load_dwordx4 v6, s[8:11], s21 offen lds
    v_mfma_f32_16x16x32_bf16 v[152:155], a[228:231], v[16:19], v[152:155]
    s_add_u32 s21, s21, 128
    v_exp_f32 v68, v68
    v_mfma_f32_16x16x32_bf16 v[200:203], a[228:231], v[22:25], v[200:203]
    s_add_u32 m0, s22, 37888
    v_exp_f32 v80, v80
    v_mfma_f32_16x16x32_bf16 v[248:251], a[228:231], v[28:31], v[248:251]
    buffer_load_dwordx4 v6, s[8:11], s21 offen lds
    v_mfma_f32_16x16x32_bf16 a[40:43], a[228:231], v[34:37], a[40:43]
    s_add_u32 s21, s21, 128
    ds_read_b128 a[228:231], v0 offset:14336
    v_fma_f32 v59, v59, s28, v9
    v_mfma_f32_16x16x32_bf16 a[44:47], a[232:235], v[34:37], a[44:47]
    s_add_u32 m0, s22, 38912
    v_exp_f32 v76, v76
    v_mfma_f32_16x16x32_bf16 v[252:255], a[232:235], v[28:31], v[252:255]
    buffer_load_dwordx4 v6, s[8:11], s21 offen lds
    v_mfma_f32_16x16x32_bf16 v[204:207], a[232:235], v[22:25], v[204:207]
    v_exp_f32 v82, v82
    v_mfma_f32_16x16x32_bf16 v[156:159], a[232:235], v[16:19], v[156:159]
    s_waitcnt lgkmcnt(2)
    v_exp_f32 v73, v73
    v_mfma_f32_16x16x32_bf16 v[52:55], a[212:215], a[96:99], 0
    s_waitcnt lgkmcnt(1)
    ds_read_b128 a[224:227], v1 offset:13312
    v_cvt_pk_bf16_f32 v26, v68, v69
    v_mfma_f32_16x16x32_bf16 v[52:55], a[216:219], a[100:103], v[52:55]
    buffer_store_dwordx4 v[84:87], v6, s[16:19], s24 offen offset:0 nt
    v_exp_f32 v56, v56
    v_mfma_f32_16x16x32_bf16 v[52:55], a[220:223], a[104:107], v[52:55]
    ds_read_b128 a[232:235], v1 offset:14336
    v_mfma_f32_16x16x32_bf16 v[60:63], a[220:223], a[128:131], 0
    v_fma_f32 v81, v81, s28, v12
    v_mfma_f32_16x16x32_bf16 v[60:63], a[216:219], a[124:127], v[60:63]
    v_exp_f32 v77, v77
    v_mfma_f32_16x16x32_bf16 v[60:63], a[212:215], a[120:123], v[60:63]
    v_exp_f32 v57, v57
    v_mfma_f32_16x16x32_bf16 v[68:71], a[212:215], a[144:147], 0
    ds_read_b128 v[88:91], v103 offset:1024
    v_mfma_f32_16x16x32_bf16 v[68:71], a[216:219], a[148:151], v[68:71]
    v_cvt_pk_bf16_f32 v32, v76, v77
    v_cvt_pk_bf16_f32 v33, v78, v79
    v_mfma_f32_16x16x32_bf16 v[68:71], a[220:223], a[152:155], v[68:71]
    v_exp_f32 v58, v58
    v_mfma_f32_16x16x32_bf16 v[76:79], a[220:223], a[176:179], 0
    v_fma_f32 v65, v65, s28, v10
    v_fma_f32 v64, v64, s28, v10
    v_mfma_f32_16x16x32_bf16 v[76:79], a[216:219], a[172:175], v[76:79]
    v_exp_f32 v81, v81
    v_mfma_f32_16x16x32_bf16 v[76:79], a[212:215], a[168:171], v[76:79]
    s_waitcnt lgkmcnt(2)
    v_exp_f32 v64, v64
    v_mfma_f32_16x16x32_bf16 v[76:79], a[224:227], a[180:183], v[76:79]
    v_exp_f32 v59, v59
    v_mfma_f32_16x16x32_bf16 v[76:79], a[228:231], a[184:187], v[76:79]
    s_waitcnt lgkmcnt(1)
    ds_read_b128 a[220:223], v0 offset:19456
    v_cvt_pk_bf16_f32 v34, v80, v81
    v_mfma_f32_16x16x32_bf16 v[76:79], a[232:235], a[188:191], v[76:79]
    v_exp_f32 v67, v67
    v_mfma_f32_16x16x32_bf16 v[68:71], a[232:235], a[164:167], v[68:71]
    v_cvt_pk_bf16_f32 v17, v58, v59
    v_cvt_pk_bf16_f32 v23, v66, v67
    v_mfma_f32_16x16x32_bf16 v[68:71], a[228:231], a[160:163], v[68:71]
    s_add_u32 s21, s21, 12032
    ds_read_b128 a[212:215], v0 offset:18432
    v_cvt_pk_bf16_f32 v29, v74, v75
    v_mfma_f32_16x16x32_bf16 v[68:71], a[224:227], a[156:159], v[68:71]
    v_exp_f32 v65, v65
    v_mfma_f32_16x16x32_bf16 v[60:63], a[224:227], a[132:135], v[60:63]
    ds_read_b128 a[216:219], v1 offset:18432
    s_add_u32 s57, s24, 128
    v_mfma_f32_16x16x32_bf16 v[60:63], a[228:231], a[136:139], v[60:63]
    v_cvt_pk_bf16_f32 v16, v56, v57
    v_cvt_pk_bf16_f32 v22, v64, v65
    v_mfma_f32_16x16x32_bf16 v[60:63], a[232:235], a[140:143], v[60:63]
    ds_read_b128 v[84:87], v103 offset:3072
    v_mfma_f32_16x16x32_bf16 v[52:55], a[232:235], a[116:119], v[52:55]
    v_exp_f32 v72, v72
    v_mfma_f32_16x16x32_bf16 v[52:55], a[228:231], a[112:115], v[52:55]
    ds_read_b128 a[228:231], v0 offset:20480
    v_mfma_f32_16x16x32_bf16 v[52:55], a[224:227], a[108:111], v[52:55]
    ds_read_b128 a[224:227], v1 offset:19456
    v_cvt_pk_bf16_f32 v35, v82, v83
    v_mfma_f32_16x16x32_bf16 v[44:47], a[236:239], v[14:17], v[48:51]
    ds_read_b128 a[232:235], v1 offset:20480
    v_cvt_pk_bf16_f32 v28, v72, v73
    v_mfma_f32_16x16x32_bf16 v[44:47], a[240:243], v[20:23], v[44:47]
    s_nop 0
    v_mfma_f32_16x16x32_bf16 v[44:47], a[244:247], v[26:29], v[44:47]
    v_mfma_f32_16x16x32_bf16 v[44:47], a[248:251], v[32:35], v[44:47]
    s_waitcnt lgkmcnt(5)
    v_mfma_f32_16x16x32_bf16 v[56:59], a[212:215], a[96:99], 0
    s_waitcnt lgkmcnt(4)
    v_mfma_f32_16x16x32_bf16 v[56:59], a[216:219], a[100:103], v[56:59]
    buffer_store_dwordx4 v[88:91], v7, s[16:19], s24 offen offset:0 nt
    v_mfma_f32_16x16x32_bf16 v[56:59], a[220:223], a[104:107], v[56:59]
    v_mfma_f32_16x16x32_bf16 v[64:67], a[220:223], a[128:131], 0
    s_nop 0
    v_cmp_lt_f32 vcc, s29, v44
    v_mfma_f32_16x16x32_bf16 v[64:67], a[216:219], a[124:127], v[64:67]
    s_waitcnt vmcnt(9) lgkmcnt(0)
    v_mfma_f32_16x16x32_bf16 v[64:67], a[212:215], a[120:123], v[64:67]
    s_barrier
    v_mfma_f32_16x16x32_bf16 v[72:75], a[212:215], a[144:147], 0
    v_mfma_f32_16x16x32_bf16 v[72:75], a[216:219], a[148:151], v[72:75]
    s_cbranch_vccnz L_rs_end4a
L_ret_end4a:
    v_fma_f32 v54, v54, s28, v9
    v_mfma_f32_16x16x32_bf16 v[72:75], a[220:223], a[152:155], v[72:75]
    v_fma_f32 v61, v61, s28, v10
    v_fma_f32 v55, v55, s28, v9
    v_mfma_f32_16x16x32_bf16 v[80:83], a[220:223], a[176:179], 0
    v_exp_f32 v61, v61
    v_mfma_f32_16x16x32_bf16 v[80:83], a[216:219], a[172:175], v[80:83]
    v_mfma_f32_16x16x32_bf16 v[80:83], a[212:215], a[168:171], v[80:83]
    v_fma_f32 v53, v53, s28, v9
    v_fma_f32 v60, v60, s28, v10
    v_mfma_f32_16x16x32_bf16 v[80:83], a[224:227], a[180:183], v[80:83]
    buffer_store_dwordx4 v[96:99], v6, s[16:19], s57 offen offset:0 nt
    ds_read_b64_tr_b16 a[212:213], v2 offset:0
    v_exp_f32 v53, v53
    v_mfma_f32_16x16x32_bf16 v[80:83], a[228:231], a[184:187], v[80:83]
    v_exp_f32 v55, v55
    v_mfma_f32_16x16x32_bf16 v[80:83], a[232:235], a[188:191], v[80:83]
    ds_read_b64_tr_b16 a[214:215], v2 offset:6144
    v_fma_f32 v52, v52, s28, v9
    v_mfma_f32_16x16x32_bf16 v[72:75], a[232:235], a[164:167], v[72:75]
    buffer_store_dwordx4 v[84:87], v7, s[16:19], s57 offen offset:0 nt
    ds_read_b64_tr_b16 a[216:217], v3 offset:0
    v_exp_f32 v60, v60
    v_mfma_f32_16x16x32_bf16 v[72:75], a[228:231], a[160:163], v[72:75]
    v_exp_f32 v52, v52
    v_mfma_f32_16x16x32_bf16 v[72:75], a[224:227], a[156:159], v[72:75]
    ds_read_b64_tr_b16 a[218:219], v3 offset:6144
    v_mfma_f32_16x16x32_bf16 v[64:67], a[224:227], a[132:135], v[64:67]
    ds_read_b64_tr_b16 a[220:221], v4 offset:0
    v_cvt_pk_bf16_f32 v24, v60, v61
    v_mfma_f32_16x16x32_bf16 v[64:67], a[228:231], a[136:139], v[64:67]
    v_exp_f32 v54, v54
    v_mfma_f32_16x16x32_bf16 v[64:67], a[232:235], a[140:143], v[64:67]
    v_cvt_pk_bf16_f32 v18, v52, v53
    v_mfma_f32_16x16x32_bf16 v[56:59], a[232:235], a[116:119], v[56:59]
    v_mfma_f32_16x16x32_bf16 v[56:59], a[228:231], a[112:115], v[56:59]
    ds_read_b64_tr_b16 a[222:223], v4 offset:6144
    v_cvt_pk_bf16_f32 v19, v54, v55
    v_mfma_f32_16x16x32_bf16 v[56:59], a[224:227], a[108:111], v[56:59]
    ds_read_b64_tr_b16 a[224:225], v5 offset:0
    ds_read_b64_tr_b16 a[226:227], v5 offset:6144
    s_waitcnt lgkmcnt(6)
    v_mfma_f32_16x16x32_bf16 v[112:115], a[212:215], v[14:17], v[112:115]
    v_fma_f32 v78, v78, s28, v12
    v_fma_f32 v63, v63, s28, v10
    v_fma_f32 v67, v67, s28, v10
    v_mfma_f32_16x16x32_bf16 v[160:163], a[212:215], v[20:23], v[160:163]
    v_fma_f32 v80, v80, s28, v12
    v_fma_f32 v56, v56, s28, v9
    v_fma_f32 v77, v77, s28, v12
    v_mfma_f32_16x16x32_bf16 v[208:211], a[212:215], v[26:29], v[208:211]
    s_add_u32 s39, s39, 12288
    ds_read_b64_tr_b16 a[228:229], v2 offset:1024
    v_fma_f32 v66, v66, s28, v10
    v_mfma_f32_16x16x32_bf16 a[0:3], a[212:215], v[32:35], a[0:3]
    s_waitcnt lgkmcnt(5)
    ds_read_b64_tr_b16 a[230:231], v2 offset:7168
    v_fma_f32 v62, v62, s28, v10
    v_mfma_f32_16x16x32_bf16 a[4:7], a[216:219], v[32:35], a[4:7]
    ds_read_b64_tr_b16 a[232:233], v3 offset:1024
    v_fma_f32 v64, v64, s28, v10
    v_mfma_f32_16x16x32_bf16 v[212:215], a[216:219], v[26:29], v[212:215]
    s_waitcnt vmcnt(4)
    v_exp_f32 v66, v66
    v_mfma_f32_16x16x32_bf16 v[164:167], a[216:219], v[20:23], v[164:167]
    v_fma_f32 v73, v73, s28, v11
    v_fma_f32 v69, v69, s28, v11
    v_mfma_f32_16x16x32_bf16 v[116:119], a[216:219], v[14:17], v[116:119]
    s_waitcnt lgkmcnt(5)
    ds_read_b64_tr_b16 a[234:235], v3 offset:7168
    v_fma_f32 v71, v71, s28, v11
    v_mfma_f32_16x16x32_bf16 v[120:123], a[220:223], v[14:17], v[120:123]
    s_barrier
    v_mfma_f32_16x16x32_bf16 v[168:171], a[220:223], v[20:23], v[168:171]
    ds_read_b64_tr_b16 a[218:219], v5 offset:7168
    v_fma_f32 v72, v72, s28, v11
    v_mfma_f32_16x16x32_bf16 v[216:219], a[220:223], v[26:29], v[216:219]
    v_exp_f32 v77, v77
    v_mfma_f32_16x16x32_bf16 a[8:11], a[220:223], v[32:35], a[8:11]
    s_waitcnt lgkmcnt(5)
    ds_read_b64_tr_b16 a[212:213], v4 offset:1024
    v_fma_f32 v70, v70, s28, v11
    v_mfma_f32_16x16x32_bf16 a[12:15], a[224:227], v[32:35], a[12:15]
    v_exp_f32 v69, v69
    v_mfma_f32_16x16x32_bf16 v[220:223], a[224:227], v[26:29], v[220:223]
    ds_read_b64_tr_b16 a[214:215], v4 offset:7168
    v_fma_f32 v75, v75, s28, v11
    v_mfma_f32_16x16x32_bf16 v[172:175], a[224:227], v[20:23], v[172:175]
    ds_read_b64_tr_b16 a[216:217], v5 offset:1024
    v_fma_f32 v83, v83, s28, v12
    v_fma_f32 v76, v76, s28, v12
    v_mfma_f32_16x16x32_bf16 v[124:127], a[224:227], v[14:17], v[124:127]
    s_waitcnt lgkmcnt(5)
    v_exp_f32 v71, v71
    v_mfma_f32_16x16x32_bf16 v[128:131], a[228:231], v[14:17], v[128:131]
    ds_read_b64_tr_b16 a[220:221], v2 offset:2048
    v_fma_f32 v81, v81, s28, v12
    v_mfma_f32_16x16x32_bf16 v[176:179], a[228:231], v[20:23], v[176:179]
    v_fma_f32 v65, v65, s28, v10
    v_fma_f32 v74, v74, s28, v11
    v_mfma_f32_16x16x32_bf16 v[224:227], a[228:231], v[26:29], v[224:227]
    ds_read_b64_tr_b16 a[222:223], v2 offset:8192
    v_fma_f32 v82, v82, s28, v12
    v_fma_f32 v79, v79, s28, v12
    v_mfma_f32_16x16x32_bf16 a[16:19], a[228:231], v[32:35], a[16:19]
    s_waitcnt lgkmcnt(5)
    v_exp_f32 v73, v73
    v_mfma_f32_16x16x32_bf16 a[20:23], a[232:235], v[32:35], a[20:23]
    v_exp_f32 v64, v64
    v_mfma_f32_16x16x32_bf16 v[228:231], a[232:235], v[26:29], v[228:231]
    v_exp_f32 v70, v70
    v_mfma_f32_16x16x32_bf16 v[180:183], a[232:235], v[20:23], v[180:183]
    v_exp_f32 v56, v56
    v_mfma_f32_16x16x32_bf16 v[132:135], a[232:235], v[14:17], v[132:135]
    s_waitcnt lgkmcnt(3)
    v_exp_f32 v76, v76
    v_mfma_f32_16x16x32_bf16 v[136:139], a[212:215], v[14:17], v[136:139]
    ds_read_b64_tr_b16 a[234:235], v5 offset:8192
    v_exp_f32 v81, v81
    v_mfma_f32_16x16x32_bf16 v[184:187], a[212:215], v[20:23], v[184:187]
    ds_read_b64_tr_b16 a[224:225], v3 offset:2048
    v_fma_f32 v59, v59, s28, v9
    v_mfma_f32_16x16x32_bf16 v[232:235], a[212:215], v[26:29], v[232:235]
    ds_read_b64_tr_b16 a[226:227], v3 offset:8192
    v_fma_f32 v58, v58, s28, v9
    v_mfma_f32_16x16x32_bf16 a[24:27], a[212:215], v[32:35], a[24:27]
    s_waitcnt lgkmcnt(4)
    v_exp_f32 v67, v67
    v_mfma_f32_16x16x32_bf16 a[28:31], a[216:219], v[32:35], a[28:31]
    ds_read_b64_tr_b16 a[228:229], v4 offset:2048
    v_exp_f32 v80, v80
    v_mfma_f32_16x16x32_bf16 v[236:239], a[216:219], v[26:29], v[236:239]
    ds_read_b64_tr_b16 a[230:231], v4 offset:8192
    v_cvt_pk_bf16_f32 v31, v70, v71
    v_mfma_f32_16x16x32_bf16 v[188:191], a[216:219], v[20:23], v[188:191]
    ds_read_b64_tr_b16 a[232:233], v5 offset:2048
    v_exp_f32 v82, v82
    v_mfma_f32_16x16x32_bf16 v[140:143], a[216:219], v[14:17], v[140:143]
    s_waitcnt lgkmcnt(6)
    v_exp_f32 v65, v65
    v_mfma_f32_16x16x32_bf16 v[144:147], a[220:223], v[14:17], v[144:147]
    v_exp_f32 v74, v74
    v_mfma_f32_16x16x32_bf16 v[192:195], a[220:223], v[20:23], v[192:195]
    v_exp_f32 v62, v62
    v_mfma_f32_16x16x32_bf16 v[240:243], a[220:223], v[26:29], v[240:243]
    v_exp_f32 v79, v79
    v_fma_f32 v57, v57, s28, v9
    v_mfma_f32_16x16x32_bf16 a[32:35], a[220:223], v[32:35], a[32:35]
    s_waitcnt lgkmcnt(3)
    v_exp_f32 v58, v58
    v_mfma_f32_16x16x32_bf16 a[36:39], a[224:227], v[32:35], a[36:39]
    v_exp_f32 v59, v59
    v_mfma_f32_16x16x32_bf16 v[244:247], a[224:227], v[26:29], v[244:247]
    v_exp_f32 v78, v78
    v_exp_f32 v75, v75
    v_mfma_f32_16x16x32_bf16 v[196:199], a[224:227], v[20:23], v[196:199]
    v_exp_f32 v63, v63
    v_mfma_f32_16x16x32_bf16 v[148:151], a[224:227], v[14:17], v[148:151]
    s_waitcnt lgkmcnt(0)
    v_exp_f32 v57, v57
    v_mfma_f32_16x16x32_bf16 v[152:155], a[228:231], v[14:17], v[152:155]
    v_exp_f32 v72, v72
    v_mfma_f32_16x16x32_bf16 v[200:203], a[228:231], v[20:23], v[200:203]
    ds_read_b64_tr_b16 a[212:213], v2 offset:18432
    v_fma_f32 v68, v68, s28, v11
    v_mfma_f32_16x16x32_bf16 v[248:251], a[228:231], v[26:29], v[248:251]
    ds_read_b64_tr_b16 a[214:215], v2 offset:12288
    v_cvt_pk_bf16_f32 v25, v62, v63
    v_mfma_f32_16x16x32_bf16 a[40:43], a[228:231], v[32:35], a[40:43]
    v_exp_f32 v83, v83
    v_mfma_f32_16x16x32_bf16 a[44:47], a[232:235], v[32:35], a[44:47]
    ds_read_b64_tr_b16 a[216:217], v3 offset:18432
    v_cvt_pk_bf16_f32 v37, v78, v79
    v_mfma_f32_16x16x32_bf16 v[252:255], a[232:235], v[26:29], v[252:255]
    v_exp_f32 v68, v68
    v_mfma_f32_16x16x32_bf16 v[204:207], a[232:235], v[20:23], v[204:207]
    ds_read_b64_tr_b16 a[218:219], v3 offset:12288
    v_cvt_pk_bf16_f32 v22, v64, v65
    v_cvt_pk_bf16_f32 v29, v74, v75
    v_cvt_pk_bf16_f32 v36, v76, v77
    v_cvt_pk_bf16_f32 v28, v72, v73
    v_mfma_f32_16x16x32_bf16 v[156:159], a[232:235], v[14:17], v[156:159]
    v_cvt_pk_bf16_f32 v17, v58, v59
    v_cvt_pk_bf16_f32 v16, v56, v57
    v_cvt_pk_bf16_f32 v30, v68, v69
    v_cvt_pk_bf16_f32 v23, v66, v67
    v_mfma_f32_16x16x32_bf16 v[48:51], a[236:239], v[16:19], v[44:47]
    ds_read_b64_tr_b16 a[220:221], v4 offset:18432
    v_cvt_pk_bf16_f32 v35, v82, v83
    v_mfma_f32_16x16x32_bf16 v[48:51], a[240:243], v[22:25], v[48:51]
    ds_read_b64_tr_b16 a[222:223], v4 offset:12288
    v_cvt_pk_bf16_f32 v34, v80, v81
    v_mfma_f32_16x16x32_bf16 v[48:51], a[244:247], v[28:31], v[48:51]
    ds_read_b64_tr_b16 a[224:225], v5 offset:18432
    v_mfma_f32_16x16x32_bf16 v[48:51], a[248:251], v[34:37], v[48:51]
    ds_read_b64_tr_b16 a[226:227], v5 offset:12288
    s_nop 6
    v_cmp_lt_f32 vcc, s29, v48
    s_nop 4
    s_cbranch_vccnz L_rs_end4b
L_ret_end4b:
    v_mov_b32 v100, v48
    v_and_b32 v101, 0x3ff, v0
    v_rcp_f32 v50, v50
    v_lshrrev_b32 v108, 11, v0
    v_xor_b32 v108, s65, v108
    v_lshl_add_u32 v101, v108, 10, v101
    v_mbcnt_lo_u32_b32 v108, -1, 0
    v_mbcnt_hi_u32_b32 v108, -1, v108
    v_add_u32 v101, s38, v101
    v_lshrrev_b32 v108, 1, v108
    v_and_b32 v108, 24, v108
    v_permlane32_swap_b32 v48, v100
    v_rcp_f32 v8, v51
    v_bfe_u32 v108, s66, v108, 8
    v_rcp_f32 v102, v49
    v_rcp_f32 v48, v48
    v_xor_b32 v101, v101, v108
    s_waitcnt lgkmcnt(6)
    v_mfma_f32_16x16x32_bf16 v[112:115], a[212:215], v[16:19], v[112:115]
    v_mfma_f32_16x16x32_bf16 v[160:163], a[212:215], v[22:25], v[160:163]
    ds_read_b64_tr_b16 a[228:229], v2 offset:19456
    v_mfma_f32_16x16x32_bf16 v[208:211], a[212:215], v[28:31], v[208:211]
    v_mfma_f32_16x16x32_bf16 a[0:3], a[212:215], v[34:37], a[0:3]
    ds_read_b64_tr_b16 a[232:233], v3 offset:19456
    s_waitcnt lgkmcnt(6)
    v_mfma_f32_16x16x32_bf16 a[4:7], a[216:219], v[34:37], a[4:7]
    ds_read_b64_tr_b16 a[234:235], v3 offset:13312
    v_mfma_f32_16x16x32_bf16 v[212:215], a[216:219], v[28:31], v[212:215]
    ds_read_b64_tr_b16 a[230:231], v2 offset:13312
    v_xor_b32 v93, 64, v101
    v_mfma_f32_16x16x32_bf16 v[164:167], a[216:219], v[22:25], v[164:167]
    v_mfma_f32_16x16x32_bf16 v[116:119], a[216:219], v[16:19], v[116:119]
    ds_read_b64_tr_b16 a[216:217], v5 offset:19456
    s_waitcnt lgkmcnt(7)
    v_mfma_f32_16x16x32_bf16 v[120:123], a[220:223], v[16:19], v[120:123]
    v_mfma_f32_16x16x32_bf16 v[168:171], a[220:223], v[22:25], v[168:171]
    ds_read_b64_tr_b16 a[212:213], v4 offset:19456
    v_accvgpr_read_b32 v109, a5
    v_mfma_f32_16x16x32_bf16 v[216:219], a[220:223], v[28:31], v[216:219]
    v_accvgpr_read_b32 v106, a2
    v_mfma_f32_16x16x32_bf16 a[8:11], a[220:223], v[34:37], a[8:11]
    s_waitcnt lgkmcnt(5)
    ds_read_b64_tr_b16 a[218:219], v5 offset:13312
    v_mfma_f32_16x16x32_bf16 a[12:15], a[224:227], v[34:37], a[12:15]
    v_mfma_f32_16x16x32_bf16 v[220:223], a[224:227], v[28:31], v[220:223]
    ds_read_b64_tr_b16 a[214:215], v4 offset:13312
    v_mfma_f32_16x16x32_bf16 v[172:175], a[224:227], v[22:25], v[172:175]
    v_mfma_f32_16x16x32_bf16 v[124:127], a[224:227], v[16:19], v[124:127]
    s_waitcnt lgkmcnt(4)
    v_xor_b32 v92, 32, v101
    v_mfma_f32_16x16x32_bf16 v[128:131], a[228:231], v[16:19], v[128:131]
    v_mfma_f32_16x16x32_bf16 v[176:179], a[228:231], v[22:25], v[176:179]
    v_accvgpr_read_b32 v52, a8
    v_mfma_f32_16x16x32_bf16 v[224:227], a[228:231], v[28:31], v[224:227]
    ds_read_b64_tr_b16 a[220:221], v2 offset:20480
    v_mfma_f32_16x16x32_bf16 a[16:19], a[228:231], v[34:37], a[16:19]
    s_add_u32 s84, s34, 0
    v_mfma_f32_16x16x32_bf16 a[20:23], a[232:235], v[34:37], a[20:23]
    s_add_u32 s85, s34, 6144
    ds_read_b64_tr_b16 a[224:225], v3 offset:20480
    v_xor_b32 v94, 96, v101
    v_mfma_f32_16x16x32_bf16 v[228:231], a[232:235], v[28:31], v[228:231]
    ds_read_b64_tr_b16 a[226:227], v3 offset:14336
    v_mfma_f32_16x16x32_bf16 v[180:183], a[232:235], v[22:25], v[180:183]
    ds_read_b64_tr_b16 a[222:223], v2 offset:14336
    v_mfma_f32_16x16x32_bf16 v[132:135], a[232:235], v[16:19], v[132:135]
    s_waitcnt lgkmcnt(4)
    ds_read_b64_tr_b16 a[234:235], v5 offset:14336
    v_subrev_u32 v103, 24576, v103
    v_mfma_f32_16x16x32_bf16 v[136:139], a[212:215], v[16:19], v[136:139]
    s_add_u32 s86, s34, 12288
    ds_read_b64_tr_b16 a[228:229], v4 offset:20480
    v_accvgpr_read_b32 v108, a4
    v_accvgpr_read_b32 v54, a10
    v_pk_mul_f32 v[164:165], v[164:165], v[102:103] op_sel_hi:[1,0]
    v_pk_mul_f32 v[222:223], v[222:223], v[50:51] op_sel_hi:[1,0]
    v_pk_mul_f32 v[116:117], v[116:117], v[48:49] op_sel_hi:[1,0]
    v_pk_mul_f32 v[114:115], v[114:115], v[48:49] op_sel_hi:[1,0]
    v_pk_mul_f32 v[112:113], v[112:113], v[48:49] op_sel_hi:[1,0]
    v_pk_mul_f32 v[126:127], v[126:127], v[48:49] op_sel_hi:[1,0]
    v_pk_mul_f32 v[168:169], v[168:169], v[102:103] op_sel_hi:[1,0]
    v_pk_mul_f32 v[166:167], v[166:167], v[102:103] op_sel_hi:[1,0]
    v_pk_mul_f32 v[108:109], v[108:109], v[8:9] op_sel_hi:[1,0]
    v_pk_mul_f32 v[122:123], v[122:123], v[48:49] op_sel_hi:[1,0]
    v_pk_mul_f32 v[172:173], v[172:173], v[102:103] op_sel_hi:[1,0]
    v_pk_mul_f32 v[214:215], v[214:215], v[50:51] op_sel_hi:[1,0]
    v_pk_mul_f32 v[220:221], v[220:221], v[50:51] op_sel_hi:[1,0]
    v_pk_mul_f32 v[124:125], v[124:125], v[48:49] op_sel_hi:[1,0]
    v_pk_mul_f32 v[208:209], v[208:209], v[50:51] op_sel_hi:[1,0]
    v_pk_mul_f32 v[182:183], v[182:183], v[102:103] op_sel_hi:[1,0]
    v_pk_mul_f32 v[160:161], v[160:161], v[102:103] op_sel_hi:[1,0]
    v_pk_mul_f32 v[170:171], v[170:171], v[102:103] op_sel_hi:[1,0]
    v_pk_mul_f32 v[118:119], v[118:119], v[48:49] op_sel_hi:[1,0]
    v_pk_mul_f32 v[224:225], v[224:225], v[50:51] op_sel_hi:[1,0]
    v_pk_mul_f32 v[120:121], v[120:121], v[48:49] op_sel_hi:[1,0]
    v_pk_mul_f32 v[174:175], v[174:175], v[102:103] op_sel_hi:[1,0]
    v_pk_mul_f32 v[216:217], v[216:217], v[50:51] op_sel_hi:[1,0]
    v_pk_mul_f32 v[162:163], v[162:163], v[102:103] op_sel_hi:[1,0]
    v_cvt_pk_bf16_f32 v116, v116, v117
    v_cvt_pk_bf16_f32 v168, v168, v169
    v_mfma_f32_16x16x32_bf16 v[184:187], a[212:215], v[22:25], v[184:187]
    v_cvt_pk_bf16_f32 v164, v164, v165
    v_cvt_pk_bf16_f32 v169, v170, v171
    v_mfma_f32_16x16x32_bf16 v[232:235], a[212:215], v[28:31], v[232:235]
    v_cvt_pk_bf16_f32 v165, v166, v167
    v_cvt_pk_bf16_f32 v160, v160, v161
    v_mfma_f32_16x16x32_bf16 a[24:27], a[212:215], v[34:37], a[24:27]
    ds_read_b64_tr_b16 a[232:233], v5 offset:20480
    v_cvt_pk_bf16_f32 v112, v112, v113
    v_mfma_f32_16x16x32_bf16 a[28:31], a[216:219], v[34:37], a[28:31]
    v_cvt_pk_bf16_f32 v124, v124, v125
    v_cvt_pk_bf16_f32 v161, v162, v163
    v_mfma_f32_16x16x32_bf16 v[236:239], a[216:219], v[28:31], v[236:239]
    v_cvt_pk_bf16_f32 v120, v120, v121
    v_cvt_pk_bf16_f32 v113, v114, v115
    v_mfma_f32_16x16x32_bf16 v[188:191], a[216:219], v[22:25], v[188:191]
    ds_write2st64_b64 v101, v[112:113], v[160:161] offset0:0 offset1:12
    v_mfma_f32_16x16x32_bf16 v[140:143], a[216:219], v[16:19], v[140:143]
    s_waitcnt lgkmcnt(2)
    ds_read_b64_tr_b16 a[230:231], v4 offset:14336
    v_cvt_pk_bf16_f32 v125, v126, v127
    v_mfma_f32_16x16x32_bf16 v[144:147], a[220:223], v[16:19], v[144:147]
    v_cvt_pk_bf16_f32 v121, v122, v123
    v_cvt_pk_bf16_f32 v172, v172, v173
    v_mfma_f32_16x16x32_bf16 v[192:195], a[220:223], v[22:25], v[192:195]
    v_cvt_pk_bf16_f32 v117, v118, v119
    v_cvt_pk_bf16_f32 v173, v174, v175
    v_mfma_f32_16x16x32_bf16 v[240:243], a[220:223], v[28:31], v[240:243]
    v_accvgpr_read_b32 v104, a0
    v_mfma_f32_16x16x32_bf16 a[32:35], a[220:223], v[34:37], a[32:35]
    ds_write2st64_b64 v92, v[116:117], v[164:165] offset0:0 offset1:12
    v_mfma_f32_16x16x32_bf16 a[36:39], a[224:227], v[34:37], a[36:39]
    ds_write2st64_b64 v93, v[120:121], v[168:169] offset0:0 offset1:12
    v_mfma_f32_16x16x32_bf16 v[244:247], a[224:227], v[28:31], v[244:247]
    ds_write2st64_b64 v94, v[124:125], v[172:173] offset0:0 offset1:12
    v_mfma_f32_16x16x32_bf16 v[196:199], a[224:227], v[22:25], v[196:199]
    ds_read_b128 v[64:67], v103 offset:0
    v_mfma_f32_16x16x32_bf16 v[148:151], a[224:227], v[16:19], v[148:151]
    s_waitcnt lgkmcnt(4)
    v_mfma_f32_16x16x32_bf16 v[152:155], a[228:231], v[16:19], v[152:155]
    ds_read_b128 v[68:71], v103 offset:1024
    v_accvgpr_read_b32 v55, a11
    v_mfma_f32_16x16x32_bf16 v[200:203], a[228:231], v[22:25], v[200:203]
    v_accvgpr_read_b32 v56, a12
    v_accvgpr_read_b32 v105, a1
    v_mfma_f32_16x16x32_bf16 v[248:251], a[228:231], v[28:31], v[248:251]
    v_accvgpr_read_b32 v111, a7
    v_accvgpr_read_b32 v107, a3
    s_add_u32 s87, s34, 18432
    s_nop 1
    v_pk_mul_f32 v[200:201], v[200:201], v[102:103] op_sel_hi:[1,0]
    v_accvgpr_read_b32 v57, a13
    v_accvgpr_read_b32 v110, a6
    v_pk_mul_f32 v[228:229], v[228:229], v[50:51] op_sel_hi:[1,0]
    v_cvt_pk_bf16_f32 v208, v208, v209
    v_pk_mul_f32 v[202:203], v[202:203], v[102:103] op_sel_hi:[1,0]
    s_add_u32 s18, s34, 24576
    v_pk_mul_f32 v[106:107], v[106:107], v[8:9] op_sel_hi:[1,0]
    v_pk_mul_f32 v[138:139], v[138:139], v[48:49] op_sel_hi:[1,0]
    v_accvgpr_read_b32 v53, a9
    v_pk_mul_f32 v[104:105], v[104:105], v[8:9] op_sel_hi:[1,0]
    v_pk_mul_f32 v[136:137], v[136:137], v[48:49] op_sel_hi:[1,0]
    v_pk_mul_f32 v[212:213], v[212:213], v[50:51] op_sel_hi:[1,0]
    v_cvt_pk_bf16_f32 v220, v220, v221
    s_nop 0
    v_mfma_f32_16x16x32_bf16 a[40:43], a[228:231], v[34:37], a[40:43]
    s_waitcnt lgkmcnt(1)
    buffer_store_dwordx4 v[64:67], v6, s[16:19], s84 offen offset:0 nt
    v_pk_mul_f32 v[198:199], v[198:199], v[102:103] op_sel_hi:[1,0]
    v_accvgpr_read_b32 v59, a15
    v_pk_mul_f32 v[52:53], v[52:53], v[8:9] op_sel_hi:[1,0]
    v_pk_mul_f32 v[56:57], v[56:57], v[8:9] op_sel_hi:[1,0]
    v_cvt_pk_bf16_f32 v212, v212, v213
    v_pk_mul_f32 v[248:249], v[248:249], v[50:51] op_sel_hi:[1,0]
    v_pk_mul_f32 v[132:133], v[132:133], v[48:49] op_sel_hi:[1,0]
    v_pk_mul_f32 v[152:153], v[152:153], v[48:49] op_sel_hi:[1,0]
    v_pk_mul_f32 v[218:219], v[218:219], v[50:51] op_sel_hi:[1,0]
    ds_read_b128 v[72:75], v103 offset:6144
    v_pk_mul_f32 v[250:251], v[250:251], v[50:51] op_sel_hi:[1,0]
    v_pk_mul_f32 v[184:185], v[184:185], v[102:103] op_sel_hi:[1,0]
    v_pk_mul_f32 v[176:177], v[176:177], v[102:103] op_sel_hi:[1,0]
    v_pk_mul_f32 v[210:211], v[210:211], v[50:51] op_sel_hi:[1,0]
    v_pk_mul_f32 v[128:129], v[128:129], v[48:49] op_sel_hi:[1,0]
    v_cvt_pk_bf16_f32 v56, v56, v57
    s_nop 0
    v_mfma_f32_16x16x32_bf16 a[44:47], a[232:235], v[34:37], a[44:47]
    v_cvt_pk_bf16_f32 v209, v210, v211
    v_accvgpr_read_b32 v58, a14
    v_cvt_pk_bf16_f32 v216, v216, v217
    v_cvt_pk_bf16_f32 v104, v104, v105
    v_mfma_f32_16x16x32_bf16 v[252:255], a[232:235], v[28:31], v[252:255]
    s_waitcnt lgkmcnt(1)
    ds_read_b128 v[76:79], v103 offset:7168
    buffer_store_dwordx4 v[68:71], v7, s[16:19], s84 offen offset:0 nt
    v_cvt_pk_bf16_f32 v52, v52, v53
    v_cvt_pk_bf16_f32 v200, v200, v201
    v_cvt_pk_bf16_f32 v176, v176, v177
    v_mfma_f32_16x16x32_bf16 v[204:207], a[232:235], v[22:25], v[204:207]
    v_cvt_pk_bf16_f32 v213, v214, v215
    v_pk_mul_f32 v[180:181], v[180:181], v[102:103] op_sel_hi:[1,0]
    v_pk_mul_f32 v[188:189], v[188:189], v[102:103] op_sel_hi:[1,0]
    v_cvt_pk_bf16_f32 v221, v222, v223
    v_pk_mul_f32 v[240:241], v[240:241], v[50:51] op_sel_hi:[1,0]
    v_pk_mul_f32 v[58:59], v[58:59], v[8:9] op_sel_hi:[1,0]
    v_pk_mul_f32 v[130:131], v[130:131], v[48:49] op_sel_hi:[1,0]
    v_cvt_pk_bf16_f32 v105, v106, v107
    v_pk_mul_f32 v[54:55], v[54:55], v[8:9] op_sel_hi:[1,0]
    v_cvt_pk_bf16_f32 v57, v58, v59
    v_pk_mul_f32 v[178:179], v[178:179], v[102:103] op_sel_hi:[1,0]
    v_pk_mul_f32 v[232:233], v[232:233], v[50:51] op_sel_hi:[1,0]
    v_pk_mul_f32 v[110:111], v[110:111], v[8:9] op_sel_hi:[1,0]
    v_pk_mul_f32 v[140:141], v[140:141], v[48:49] op_sel_hi:[1,0]
    v_cvt_pk_bf16_f32 v108, v108, v109
    v_cvt_pk_bf16_f32 v109, v110, v111
    v_cvt_pk_bf16_f32 v53, v54, v55
    v_cvt_pk_bf16_f32 v128, v128, v129
    v_cvt_pk_bf16_f32 v228, v228, v229
    v_mfma_f32_16x16x32_bf16 v[156:159], a[232:235], v[16:19], v[156:159]
    s_waitcnt lgkmcnt(1)
    buffer_store_dwordx4 v[72:75], v6, s[16:19], s85 offen offset:0 nt
    v_cvt_pk_bf16_f32 v217, v218, v219
    ds_write2st64_b64 v101, v[208:209], v[104:105] offset0:24 offset1:36
    ds_write2st64_b64 v92, v[212:213], v[108:109] offset0:24 offset1:36
    ds_write2st64_b64 v93, v[216:217], v[52:53] offset0:24 offset1:36
    ds_write2st64_b64 v94, v[220:221], v[56:57] offset0:24 offset1:36
    v_cvt_pk_bf16_f32 v132, v132, v133
    v_pk_mul_f32 v[154:155], v[154:155], v[48:49] op_sel_hi:[1,0]
    ds_read_b128 v[80:83], v103 offset:12288
    v_accvgpr_read_b32 v104, a16
    v_accvgpr_read_b32 v108, a20
    s_waitcnt lgkmcnt(5)
    buffer_store_dwordx4 v[76:79], v7, s[16:19], s85 offen offset:0 nt
    v_accvgpr_read_b32 v111, a23
    v_pk_mul_f32 v[190:191], v[190:191], v[102:103] op_sel_hi:[1,0]
    v_accvgpr_read_b32 v59, a31
    v_pk_mul_f32 v[148:149], v[148:149], v[48:49] op_sel_hi:[1,0]
    v_pk_mul_f32 v[252:253], v[252:253], v[50:51] op_sel_hi:[1,0]
    v_accvgpr_read_b32 v55, a27
    v_pk_mul_f32 v[158:159], v[158:159], v[48:49] op_sel_hi:[1,0]
    v_cvt_pk_bf16_f32 v129, v130, v131
    v_pk_mul_f32 v[242:243], v[242:243], v[50:51] op_sel_hi:[1,0]
    ds_read_b128 v[84:87], v103 offset:13312
    v_accvgpr_read_b32 v56, a28
    v_cvt_pk_bf16_f32 v177, v178, v179
    v_pk_mul_f32 v[196:197], v[196:197], v[102:103] op_sel_hi:[1,0]
    v_pk_mul_f32 v[238:239], v[238:239], v[50:51] op_sel_hi:[1,0]
    v_pk_mul_f32 v[234:235], v[234:235], v[50:51] op_sel_hi:[1,0]
    v_cvt_pk_bf16_f32 v188, v188, v189
    v_accvgpr_read_b32 v58, a30
    v_pk_mul_f32 v[146:147], v[146:147], v[48:49] op_sel_hi:[1,0]
    v_pk_mul_f32 v[236:237], v[236:237], v[50:51] op_sel_hi:[1,0]
    v_cvt_pk_bf16_f32 v184, v184, v185
    v_pk_mul_f32 v[192:193], v[192:193], v[102:103] op_sel_hi:[1,0]
    v_accvgpr_read_b32 v109, a21
    v_accvgpr_read_b32 v53, a25
    v_pk_mul_f32 v[134:135], v[134:135], v[48:49] op_sel_hi:[1,0]
    v_pk_mul_f32 v[206:207], v[206:207], v[102:103] op_sel_hi:[1,0]
    v_accvgpr_read_b32 v106, a18
    v_pk_mul_f32 v[230:231], v[230:231], v[50:51] op_sel_hi:[1,0]
    s_waitcnt lgkmcnt(1)
    buffer_store_dwordx4 v[80:83], v6, s[16:19], s86 offen offset:0 nt
    v_cvt_pk_bf16_f32 v180, v180, v181
    v_cvt_pk_bf16_f32 v248, v248, v249
    v_accvgpr_read_b32 v105, a17
    ds_read_b128 v[88:91], v103 offset:18432
    v_cvt_pk_bf16_f32 v181, v182, v183
    v_cvt_pk_bf16_f32 v140, v140, v141
    v_pk_mul_f32 v[194:195], v[194:195], v[102:103] op_sel_hi:[1,0]
    v_cvt_pk_bf16_f32 v189, v190, v191
    v_pk_mul_f32 v[104:105], v[104:105], v[8:9] op_sel_hi:[1,0]
    v_cvt_pk_bf16_f32 v136, v136, v137
    ds_read_b128 v[60:63], v103 offset:19456
    v_accvgpr_read_b32 v107, a19
    v_cvt_pk_bf16_f32 v196, v196, v197
    v_pk_mul_f32 v[186:187], v[186:187], v[102:103] op_sel_hi:[1,0]
    v_accvgpr_read_b32 v57, a29
    s_waitcnt lgkmcnt(2)
    buffer_store_dwordx4 v[84:87], v7, s[16:19], s86 offen offset:0 nt
    v_accvgpr_read_b32 v52, a24
    v_cvt_pk_bf16_f32 v192, v192, v193
    v_cvt_pk_bf16_f32 v137, v138, v139
    v_cvt_pk_bf16_f32 v224, v224, v225
    v_accvgpr_read_b32 v54, a26
    v_cvt_pk_bf16_f32 v185, v186, v187
    v_cvt_pk_bf16_f32 v133, v134, v135
    v_pk_mul_f32 v[56:57], v[56:57], v[8:9] op_sel_hi:[1,0]
    v_cvt_pk_bf16_f32 v104, v104, v105
    v_pk_mul_f32 v[156:157], v[156:157], v[48:49] op_sel_hi:[1,0]
    v_cvt_pk_bf16_f32 v240, v240, v241
    v_cvt_pk_bf16_f32 v156, v156, v157
    v_pk_mul_f32 v[142:143], v[142:143], v[48:49] op_sel_hi:[1,0]
    ds_write2st64_b64 v101, v[128:129], v[176:177] offset0:4 offset1:16
    v_cvt_pk_bf16_f32 v152, v152, v153
    v_cvt_pk_bf16_f32 v141, v142, v143
    v_pk_mul_f32 v[52:53], v[52:53], v[8:9] op_sel_hi:[1,0]
    v_pk_mul_f32 v[144:145], v[144:145], v[48:49] op_sel_hi:[1,0]
    v_pk_mul_f32 v[54:55], v[54:55], v[8:9] op_sel_hi:[1,0]
    s_waitcnt lgkmcnt(1)
    buffer_store_dwordx4 v[88:91], v6, s[16:19], s87 offen offset:0 nt
    v_pk_mul_f32 v[226:227], v[226:227], v[50:51] op_sel_hi:[1,0]
    ds_write2st64_b64 v92, v[132:133], v[180:181] offset0:4 offset1:16
    ds_write2st64_b64 v93, v[136:137], v[184:185] offset0:4 offset1:16
    v_cvt_pk_bf16_f32 v232, v232, v233
    v_cvt_pk_bf16_f32 v236, v236, v237
    v_cvt_pk_bf16_f32 v233, v234, v235
    v_cvt_pk_bf16_f32 v148, v148, v149
    ds_write2st64_b64 v94, v[140:141], v[188:189] offset0:4 offset1:16
    ds_read_b128 v[64:67], v103 offset:2048
    buffer_store_dwordx4 v[60:63], v7, s[16:19], s87 offen offset:0 nt
    v_pk_mul_f32 v[106:107], v[106:107], v[8:9] op_sel_hi:[1,0]
    v_cvt_pk_bf16_f32 v56, v56, v57
    v_cvt_pk_bf16_f32 v229, v230, v231
    v_accvgpr_read_b32 v110, a22
    ds_read_b128 v[68:71], v103 offset:3072
    v_cvt_pk_bf16_f32 v52, v52, v53
    v_pk_mul_f32 v[108:109], v[108:109], v[8:9] op_sel_hi:[1,0]
    ds_read_b128 v[72:75], v103 offset:8192
    v_pk_mul_f32 v[58:59], v[58:59], v[8:9] op_sel_hi:[1,0]
    v_pk_mul_f32 v[110:111], v[110:111], v[8:9] op_sel_hi:[1,0]
    v_pk_mul_f32 v[244:245], v[244:245], v[50:51] op_sel_hi:[1,0]
    v_cvt_pk_bf16_f32 v108, v108, v109
    ds_read_b128 v[76:79], v103 offset:9216
    v_cvt_pk_bf16_f32 v53, v54, v55
    v_pk_mul_f32 v[150:151], v[150:151], v[48:49] op_sel_hi:[1,0]
    v_cvt_pk_bf16_f32 v201, v202, v203
    v_cvt_pk_bf16_f32 v109, v110, v111
    v_cvt_pk_bf16_f32 v57, v58, v59
    v_pk_mul_f32 v[204:205], v[204:205], v[102:103] op_sel_hi:[1,0]
    v_cvt_pk_bf16_f32 v193, v194, v195
    v_accvgpr_read_b32 v55, a43
    s_waitcnt lgkmcnt(3)
    buffer_store_dwordx4 v[64:67], v6, s[16:19], s84 offen offset:128 nt
    v_cvt_pk_bf16_f32 v225, v226, v227
    v_cvt_pk_bf16_f32 v153, v154, v155
    v_cvt_pk_bf16_f32 v105, v106, v107
    v_cvt_pk_bf16_f32 v157, v158, v159
    s_waitcnt lgkmcnt(2)
    buffer_store_dwordx4 v[68:71], v7, s[16:19], s84 offen offset:128 nt
    v_accvgpr_read_b32 v58, a46
    v_accvgpr_read_b32 v111, a39
    ds_write2st64_b64 v101, v[224:225], v[104:105] offset0:28 offset1:40
    v_accvgpr_read_b32 v59, a47
    v_cvt_pk_bf16_f32 v144, v144, v145
    v_accvgpr_read_b32 v106, a34
    v_cvt_pk_bf16_f32 v204, v204, v205
    v_accvgpr_read_b32 v110, a38
    v_accvgpr_read_b32 v104, a32
    v_cvt_pk_bf16_f32 v237, v238, v239
    v_cvt_pk_bf16_f32 v149, v150, v151
    ds_write2st64_b64 v92, v[228:229], v[108:109] offset0:28 offset1:40
    s_waitcnt lgkmcnt(2)
    buffer_store_dwordx4 v[72:75], v6, s[16:19], s85 offen offset:128 nt
    v_cvt_pk_bf16_f32 v205, v206, v207
    ds_write2st64_b64 v93, v[232:233], v[52:53] offset0:28 offset1:40
    v_accvgpr_read_b32 v105, a33
    ds_write2st64_b64 v94, v[236:237], v[56:57] offset0:28 offset1:40
    v_cvt_pk_bf16_f32 v145, v146, v147
    v_accvgpr_read_b32 v52, a40
    v_accvgpr_read_b32 v53, a41
    v_accvgpr_read_b32 v54, a42
    ds_read_b128 v[80:83], v103 offset:14336
    v_cvt_pk_bf16_f32 v252, v252, v253
    v_pk_mul_f32 v[110:111], v[110:111], v[8:9] op_sel_hi:[1,0]
    ds_read_b128 v[84:87], v103 offset:15360
    buffer_store_dwordx4 v[76:79], v7, s[16:19], s85 offen offset:128 nt
    v_accvgpr_read_b32 v107, a35
    v_cvt_pk_bf16_f32 v197, v198, v199
    s_waitcnt lgkmcnt(1)
    buffer_store_dwordx4 v[80:83], v6, s[16:19], s86 offen offset:128 nt
    v_cvt_pk_bf16_f32 v244, v244, v245
    v_accvgpr_read_b32 v56, a44
    ds_read_b128 v[88:91], v103 offset:20480
    v_accvgpr_read_b32 v57, a45
    v_pk_mul_f32 v[58:59], v[58:59], v[8:9] op_sel_hi:[1,0]
    ds_read_b128 v[60:63], v103 offset:21504
    v_pk_mul_f32 v[104:105], v[104:105], v[8:9] op_sel_hi:[1,0]
    v_pk_mul_f32 v[52:53], v[52:53], v[8:9] op_sel_hi:[1,0]
    v_accvgpr_read_b32 v109, a37
    v_cvt_pk_bf16_f32 v104, v104, v105
    ds_write2st64_b64 v101, v[144:145], v[192:193] offset0:8 offset1:20
    v_pk_mul_f32 v[106:107], v[106:107], v[8:9] op_sel_hi:[1,0]
    v_accvgpr_read_b32 v108, a36
    v_pk_mul_f32 v[254:255], v[254:255], v[50:51] op_sel_hi:[1,0]
    v_pk_mul_f32 v[108:109], v[108:109], v[8:9] op_sel_hi:[1,0]
    v_cvt_pk_bf16_f32 v249, v250, v251
    v_cvt_pk_bf16_f32 v241, v242, v243
    s_waitcnt lgkmcnt(3)
    buffer_store_dwordx4 v[84:87], v7, s[16:19], s86 offen offset:128 nt
    ds_write2st64_b64 v92, v[148:149], v[196:197] offset0:8 offset1:20
    v_pk_mul_f32 v[246:247], v[246:247], v[50:51] op_sel_hi:[1,0]
    v_pk_mul_f32 v[54:55], v[54:55], v[8:9] op_sel_hi:[1,0]
    v_cvt_pk_bf16_f32 v108, v108, v109
    v_cvt_pk_bf16_f32 v52, v52, v53
    v_cvt_pk_bf16_f32 v53, v54, v55
    ds_write2st64_b64 v93, v[152:153], v[200:201] offset0:8 offset1:20
    ds_write2st64_b64 v94, v[156:157], v[204:205] offset0:8 offset1:20
    ds_read_b128 v[64:67], v103 offset:4096
    v_cvt_pk_bf16_f32 v245, v246, v247
    v_cvt_pk_bf16_f32 v109, v110, v111
    s_waitcnt lgkmcnt(4)
    buffer_store_dwordx4 v[88:91], v6, s[16:19], s87 offen offset:128 nt
    v_pk_mul_f32 v[56:57], v[56:57], v[8:9] op_sel_hi:[1,0]
    ds_read_b128 v[68:71], v103 offset:5120
    v_cvt_pk_bf16_f32 v56, v56, v57
    ds_read_b128 v[72:75], v103 offset:10240
    buffer_store_dwordx4 v[60:63], v7, s[16:19], s87 offen offset:128 nt
    v_cvt_pk_bf16_f32 v57, v58, v59
    v_cvt_pk_bf16_f32 v105, v106, v107
    ds_read_b128 v[76:79], v103 offset:11264
    ds_write2st64_b64 v101, v[240:241], v[104:105] offset0:32 offset1:44
    v_cvt_pk_bf16_f32 v253, v254, v255
    ds_write2st64_b64 v92, v[244:245], v[108:109] offset0:32 offset1:44
    s_waitcnt lgkmcnt(3)
    buffer_store_dwordx4 v[64:67], v6, s[16:19], s84 offen offset:256 nt
    ds_write2st64_b64 v93, v[248:249], v[52:53] offset0:32 offset1:44
    buffer_store_dwordx4 v[68:71], v7, s[16:19], s84 offen offset:256 nt
    ds_write2st64_b64 v94, v[252:253], v[56:57] offset0:32 offset1:44
    ds_read_b128 v[80:83], v103 offset:16384
    buffer_store_dwordx4 v[72:75], v6, s[16:19], s85 offen offset:256 nt
    ds_read_b128 v[84:87], v103 offset:17408
    ds_read_b128 v[88:91], v103 offset:22528
    s_waitcnt lgkmcnt(4)
    buffer_store_dwordx4 v[76:79], v7, s[16:19], s85 offen offset:256 nt
    s_waitcnt lgkmcnt(2)
    buffer_store_dwordx4 v[80:83], v6, s[16:19], s86 offen offset:256 nt
    s_waitcnt lgkmcnt(0)
    buffer_store_dwordx4 v[84:87], v7, s[16:19], s86 offen offset:256 nt
    ds_read_b128 v[60:63], v103 offset:23552
    buffer_store_dwordx4 v[88:91], v6, s[16:19], s87 offen offset:256 nt
    s_waitcnt lgkmcnt(0)
    buffer_store_dwordx4 v[60:63], v7, s[16:19], s87 offen offset:256 nt
    s_branch L_fin
L_fin:
    s_waitcnt vmcnt(0)
L_end:
    s_endpgm
L_codeend:
L_rare5_0:
    s_nop 15
    v_mbcnt_lo_u32_b32 v31, -1, 0
    v_mbcnt_hi_u32_b32 v31, -1, v31
    v_and_b32 v30, 15, v31
    v_mul_u32_u24 v30, 384, v30
    v_lshrrev_b32 v31, 4, v31
    v_lshl_add_u32 v30, v31, 4, v30
    s_add_u32 s69, s39, 0
    buffer_load_dwordx4 v[44:47], v30, s[4:7], s69 offen offset:0
    s_waitcnt vmcnt(0)
    v_mfma_f32_16x16x32_bf16 v[104:107], v[44:47], a[96:99], 0
    s_nop 7
    buffer_load_dwordx4 v[44:47], v30, s[4:7], s69 offen offset:64
    s_waitcnt vmcnt(0)
    v_mfma_f32_16x16x32_bf16 v[104:107], v[44:47], a[100:103], v[104:107]
    s_nop 7
    buffer_load_dwordx4 v[44:47], v30, s[4:7], s69 offen offset:128
    s_waitcnt vmcnt(0)
    v_mfma_f32_16x16x32_bf16 v[104:107], v[44:47], a[104:107], v[104:107]
    s_nop 7
    buffer_load_dwordx4 v[44:47], v30, s[4:7], s69 offen offset:192
    s_waitcnt vmcnt(0)
    v_mfma_f32_16x16x32_bf16 v[104:107], v[44:47], a[108:111], v[104:107]
    s_nop 7
    buffer_load_dwordx4 v[44:47], v30, s[4:7], s69 offen offset:256
    s_waitcnt vmcnt(0)
    v_mfma_f32_16x16x32_bf16 v[104:107], v[44:47], a[112:115], v[104:107]
    s_nop 7
    buffer_load_dwordx4 v[44:47], v30, s[4:7], s69 offen offset:320
    s_waitcnt vmcnt(0)
    v_mfma_f32_16x16x32_bf16 v[104:107], v[44:47], a[116:119], v[104:107]
    s_nop 7
    s_add_u32 s69, s39, 6144
    buffer_load_dwordx4 v[44:47], v30, s[4:7], s69 offen offset:0
    s_waitcnt vmcnt(0)
    v_mfma_f32_16x16x32_bf16 v[108:111], v[44:47], a[96:99], 0
    s_nop 7
    buffer_load_dwordx4 v[44:47], v30, s[4:7], s69 offen offset:64
    s_waitcnt vmcnt(0)
    v_mfma_f32_16x16x32_bf16 v[108:111], v[44:47], a[100:103], v[108:111]
    s_nop 7
    buffer_load_dwordx4 v[44:47], v30, s[4:7], s69 offen offset:128
    s_waitcnt vmcnt(0)
    v_mfma_f32_16x16x32_bf16 v[108:111], v[44:47], a[104:107], v[108:111]
    s_nop 7
    buffer_load_dwordx4 v[44:47], v30, s[4:7], s69 offen offset:192
    s_waitcnt vmcnt(0)
    v_mfma_f32_16x16x32_bf16 v[108:111], v[44:47], a[108:111], v[108:111]
    s_nop 7
    buffer_load_dwordx4 v[44:47], v30, s[4:7], s69 offen offset:256
    s_waitcnt vmcnt(0)
    v_mfma_f32_16x16x32_bf16 v[108:111], v[44:47], a[112:115], v[108:111]
    s_nop 7
    buffer_load_dwordx4 v[44:47], v30, s[4:7], s69 offen offset:320
    s_waitcnt vmcnt(0)
    v_mfma_f32_16x16x32_bf16 v[108:111], v[44:47], a[116:119], v[108:111]
    s_nop 7
    s_nop 15
    v_max3_f32 v18, v104, v105, v106
    v_max3_f32 v18, v18, v107, v108
    v_max3_f32 v18, v18, v109, v110
    v_max_f32 v18, v18, v111
    v_mov_b32 v19, v18
    s_nop 1
    v_permlane32_swap_b32 v19, v18
    v_max_f32 v18, v18, v19
    v_mov_b32 v19, v18
    s_nop 1
    v_permlane16_swap_b32 v19, v18
    v_max_f32 v18, v18, v19
    v_fma_f32 v18, v18, s28, v9
    v_max_f32 v24, 0, v18
    v_sub_f32 v9, v9, v24
    v_sub_f32 v25, 0, v24
    v_exp_f32 v25, v25
    s_nop 0
    v_mul_f32 v19, v48, v25
    v_cndmask_b32_e64 v48, v19, v48, s[60:61]
    v_cndmask_b32_e64 v48, v48, 0, s[46:47]
    v_mul_f32 v112, v112, v25
    v_mul_f32 v113, v113, v25
    v_mul_f32 v114, v114, v25
    v_mul_f32 v115, v115, v25
    v_mul_f32 v116, v116, v25
    v_mul_f32 v117, v117, v25
    v_mul_f32 v118, v118, v25
    v_mul_f32 v119, v119, v25
    v_mul_f32 v120, v120, v25
    v_mul_f32 v121, v121, v25
    v_mul_f32 v122, v122, v25
    v_mul_f32 v123, v123, v25
    v_mul_f32 v124, v124, v25
    v_mul_f32 v125, v125, v25
    v_mul_f32 v126, v126, v25
    v_mul_f32 v127, v127, v25
    v_mul_f32 v128, v128, v25
    v_mul_f32 v129, v129, v25
    v_mul_f32 v130, v130, v25
    v_mul_f32 v131, v131, v25
    v_mul_f32 v132, v132, v25
    v_mul_f32 v133, v133, v25
    v_mul_f32 v134, v134, v25
    v_mul_f32 v135, v135, v25
    v_mul_f32 v136, v136, v25
    v_mul_f32 v137, v137, v25
    v_mul_f32 v138, v138, v25
    v_mul_f32 v139, v139, v25
    v_mul_f32 v140, v140, v25
    v_mul_f32 v141, v141, v25
    v_mul_f32 v142, v142, v25
    v_mul_f32 v143, v143, v25
    v_mul_f32 v144, v144, v25
    v_mul_f32 v145, v145, v25
    v_mul_f32 v146, v146, v25
    v_mul_f32 v147, v147, v25
    v_mul_f32 v148, v148, v25
    v_mul_f32 v149, v149, v25
    v_mul_f32 v150, v150, v25
    v_mul_f32 v151, v151, v25
    v_mul_f32 v152, v152, v25
    v_mul_f32 v153, v153, v25
    v_mul_f32 v154, v154, v25
    v_mul_f32 v155, v155, v25
    v_mul_f32 v156, v156, v25
    v_mul_f32 v157, v157, v25
    v_mul_f32 v158, v158, v25
    v_mul_f32 v159, v159, v25
    v_fma_f32 v104, v104, s28, v9
    v_fma_f32 v105, v105, s28, v9
    v_exp_f32 v104, v104
    v_exp_f32 v105, v105
    s_nop 0
    v_cvt_pk_bf16_f32 v14, v104, v105
    v_fma_f32 v106, v106, s28, v9
    v_fma_f32 v107, v107, s28, v9
    v_exp_f32 v106, v106
    v_exp_f32 v107, v107
    s_nop 0
    v_cvt_pk_bf16_f32 v15, v106, v107
    v_fma_f32 v108, v108, s28, v9
    v_fma_f32 v109, v109, s28, v9
    v_exp_f32 v108, v108
    v_exp_f32 v109, v109
    s_nop 0
    v_cvt_pk_bf16_f32 v16, v108, v109
    v_fma_f32 v110, v110, s28, v9
    v_fma_f32 v111, v111, s28, v9
    v_exp_f32 v110, v110
    v_exp_f32 v111, v111
    s_nop 0
    v_cvt_pk_bf16_f32 v17, v110, v111
    s_add_u32 s69, s39, 0
    buffer_load_dwordx4 v[44:47], v30, s[4:7], s69 offen offset:0
    s_waitcnt vmcnt(0)
    v_mfma_f32_16x16x32_bf16 v[104:107], v[44:47], a[120:123], 0
    s_nop 7
    buffer_load_dwordx4 v[44:47], v30, s[4:7], s69 offen offset:64
    s_waitcnt vmcnt(0)
    v_mfma_f32_16x16x32_bf16 v[104:107], v[44:47], a[124:127], v[104:107]
    s_nop 7
    buffer_load_dwordx4 v[44:47], v30, s[4:7], s69 offen offset:128
    s_waitcnt vmcnt(0)
    v_mfma_f32_16x16x32_bf16 v[104:107], v[44:47], a[128:131], v[104:107]
    s_nop 7
    buffer_load_dwordx4 v[44:47], v30, s[4:7], s69 offen offset:192
    s_waitcnt vmcnt(0)
    v_mfma_f32_16x16x32_bf16 v[104:107], v[44:47], a[132:135], v[104:107]
    s_nop 7
    buffer_load_dwordx4 v[44:47], v30, s[4:7], s69 offen offset:256
    s_waitcnt vmcnt(0)
    v_mfma_f32_16x16x32_bf16 v[104:107], v[44:47], a[136:139], v[104:107]
    s_nop 7
    buffer_load_dwordx4 v[44:47], v30, s[4:7], s69 offen offset:320
    s_waitcnt vmcnt(0)
    v_mfma_f32_16x16x32_bf16 v[104:107], v[44:47], a[140:143], v[104:107]
    s_nop 7
    s_add_u32 s69, s39, 6144
    buffer_load_dwordx4 v[44:47], v30, s[4:7], s69 offen offset:0
    s_waitcnt vmcnt(0)
    v_mfma_f32_16x16x32_bf16 v[108:111], v[44:47], a[120:123], 0
    s_nop 7
    buffer_load_dwordx4 v[44:47], v30, s[4:7], s69 offen offset:64
    s_waitcnt vmcnt(0)
    v_mfma_f32_16x16x32_bf16 v[108:111], v[44:47], a[124:127], v[108:111]
    s_nop 7
    buffer_load_dwordx4 v[44:47], v30, s[4:7], s69 offen offset:128
    s_waitcnt vmcnt(0)
    v_mfma_f32_16x16x32_bf16 v[108:111], v[44:47], a[128:131], v[108:111]
    s_nop 7
    buffer_load_dwordx4 v[44:47], v30, s[4:7], s69 offen offset:192
    s_waitcnt vmcnt(0)
    v_mfma_f32_16x16x32_bf16 v[108:111], v[44:47], a[132:135], v[108:111]
    s_nop 7
    buffer_load_dwordx4 v[44:47], v30, s[4:7], s69 offen offset:256
    s_waitcnt vmcnt(0)
    v_mfma_f32_16x16x32_bf16 v[108:111], v[44:47], a[136:139], v[108:111]
    s_nop 7
    buffer_load_dwordx4 v[44:47], v30, s[4:7], s69 offen offset:320
    s_waitcnt vmcnt(0)
    v_mfma_f32_16x16x32_bf16 v[108:111], v[44:47], a[140:143], v[108:111]
    s_nop 7
    s_nop 15
    v_max3_f32 v18, v104, v105, v106
    v_max3_f32 v18, v18, v107, v108
    v_max3_f32 v18, v18, v109, v110
    v_max_f32 v18, v18, v111
    v_mov_b32 v19, v18
    s_nop 1
    v_permlane32_swap_b32 v19, v18
    v_max_f32 v18, v18, v19
    v_mov_b32 v19, v18
    s_nop 1
    v_permlane16_swap_b32 v19, v18
    v_max_f32 v18, v18, v19
    v_fma_f32 v18, v18, s28, v10
    v_max_f32 v24, 0, v18
    v_sub_f32 v10, v10, v24
    v_sub_f32 v25, 0, v24
    v_exp_f32 v25, v25
    s_nop 0
    v_mul_f32 v49, v49, v25
    v_mul_f32 v160, v160, v25
    v_mul_f32 v161, v161, v25
    v_mul_f32 v162, v162, v25
    v_mul_f32 v163, v163, v25
    v_mul_f32 v164, v164, v25
    v_mul_f32 v165, v165, v25
    v_mul_f32 v166, v166, v25
    v_mul_f32 v167, v167, v25
    v_mul_f32 v168, v168, v25
    v_mul_f32 v169, v169, v25
    v_mul_f32 v170, v170, v25
    v_mul_f32 v171, v171, v25
    v_mul_f32 v172, v172, v25
    v_mul_f32 v173, v173, v25
    v_mul_f32 v174, v174, v25
    v_mul_f32 v175, v175, v25
    v_mul_f32 v176, v176, v25
    v_mul_f32 v177, v177, v25
    v_mul_f32 v178, v178, v25
    v_mul_f32 v179, v179, v25
    v_mul_f32 v180, v180, v25
    v_mul_f32 v181, v181, v25
    v_mul_f32 v182, v182, v25
    v_mul_f32 v183, v183, v25
    v_mul_f32 v184, v184, v25
    v_mul_f32 v185, v185, v25
    v_mul_f32 v186, v186, v25
    v_mul_f32 v187, v187, v25
    v_mul_f32 v188, v188, v25
    v_mul_f32 v189, v189, v25
    v_mul_f32 v190, v190, v25
    v_mul_f32 v191, v191, v25
    v_mul_f32 v192, v192, v25
    v_mul_f32 v193, v193, v25
    v_mul_f32 v194, v194, v25
    v_mul_f32 v195, v195, v25
    v_mul_f32 v196, v196, v25
    v_mul_f32 v197, v197, v25
    v_mul_f32 v198, v198, v25
    v_mul_f32 v199, v199, v25
    v_mul_f32 v200, v200, v25
    v_mul_f32 v201, v201, v25
    v_mul_f32 v202, v202, v25
    v_mul_f32 v203, v203, v25
    v_mul_f32 v204, v204, v25
    v_mul_f32 v205, v205, v25
    v_mul_f32 v206, v206, v25
    v_mul_f32 v207, v207, v25
    v_fma_f32 v104, v104, s28, v10
    v_fma_f32 v105, v105, s28, v10
    v_exp_f32 v104, v104
    v_exp_f32 v105, v105
    s_nop 0
    v_cvt_pk_bf16_f32 v20, v104, v105
    v_fma_f32 v106, v106, s28, v10
    v_fma_f32 v107, v107, s28, v10
    v_exp_f32 v106, v106
    v_exp_f32 v107, v107
    s_nop 0
    v_cvt_pk_bf16_f32 v21, v106, v107
    v_fma_f32 v108, v108, s28, v10
    v_fma_f32 v109, v109, s28, v10
    v_exp_f32 v108, v108
    v_exp_f32 v109, v109
    s_nop 0
    v_cvt_pk_bf16_f32 v22, v108, v109
    v_fma_f32 v110, v110, s28, v10
    v_fma_f32 v111, v111, s28, v10
    v_exp_f32 v110, v110
    v_exp_f32 v111, v111
    s_nop 0
    v_cvt_pk_bf16_f32 v23, v110, v111
    s_add_u32 s69, s39, 0
    buffer_load_dwordx4 v[44:47], v30, s[4:7], s69 offen offset:0
    s_waitcnt vmcnt(0)
    v_mfma_f32_16x16x32_bf16 v[104:107], v[44:47], a[144:147], 0
    s_nop 7
    buffer_load_dwordx4 v[44:47], v30, s[4:7], s69 offen offset:64
    s_waitcnt vmcnt(0)
    v_mfma_f32_16x16x32_bf16 v[104:107], v[44:47], a[148:151], v[104:107]
    s_nop 7
    buffer_load_dwordx4 v[44:47], v30, s[4:7], s69 offen offset:128
    s_waitcnt vmcnt(0)
    v_mfma_f32_16x16x32_bf16 v[104:107], v[44:47], a[152:155], v[104:107]
    s_nop 7
    buffer_load_dwordx4 v[44:47], v30, s[4:7], s69 offen offset:192
    s_waitcnt vmcnt(0)
    v_mfma_f32_16x16x32_bf16 v[104:107], v[44:47], a[156:159], v[104:107]
    s_nop 7
    buffer_load_dwordx4 v[44:47], v30, s[4:7], s69 offen offset:256
    s_waitcnt vmcnt(0)
    v_mfma_f32_16x16x32_bf16 v[104:107], v[44:47], a[160:163], v[104:107]
    s_nop 7
    buffer_load_dwordx4 v[44:47], v30, s[4:7], s69 offen offset:320
    s_waitcnt vmcnt(0)
    v_mfma_f32_16x16x32_bf16 v[104:107], v[44:47], a[164:167], v[104:107]
    s_nop 7
    s_add_u32 s69, s39, 6144
    buffer_load_dwordx4 v[44:47], v30, s[4:7], s69 offen offset:0
    s_waitcnt vmcnt(0)
    v_mfma_f32_16x16x32_bf16 v[108:111], v[44:47], a[144:147], 0
    s_nop 7
    buffer_load_dwordx4 v[44:47], v30, s[4:7], s69 offen offset:64
    s_waitcnt vmcnt(0)
    v_mfma_f32_16x16x32_bf16 v[108:111], v[44:47], a[148:151], v[108:111]
    s_nop 7
    buffer_load_dwordx4 v[44:47], v30, s[4:7], s69 offen offset:128
    s_waitcnt vmcnt(0)
    v_mfma_f32_16x16x32_bf16 v[108:111], v[44:47], a[152:155], v[108:111]
    s_nop 7
    buffer_load_dwordx4 v[44:47], v30, s[4:7], s69 offen offset:192
    s_waitcnt vmcnt(0)
    v_mfma_f32_16x16x32_bf16 v[108:111], v[44:47], a[156:159], v[108:111]
    s_nop 7
    buffer_load_dwordx4 v[44:47], v30, s[4:7], s69 offen offset:256
    s_waitcnt vmcnt(0)
    v_mfma_f32_16x16x32_bf16 v[108:111], v[44:47], a[160:163], v[108:111]
    s_nop 7
    buffer_load_dwordx4 v[44:47], v30, s[4:7], s69 offen offset:320
    s_waitcnt vmcnt(0)
    v_mfma_f32_16x16x32_bf16 v[108:111], v[44:47], a[164:167], v[108:111]
    s_nop 7
    s_nop 15
    v_max3_f32 v18, v104, v105, v106
    v_max3_f32 v18, v18, v107, v108
    v_max3_f32 v18, v18, v109, v110
    v_max_f32 v18, v18, v111
    v_mov_b32 v19, v18
    s_nop 1
    v_permlane32_swap_b32 v19, v18
    v_max_f32 v18, v18, v19
    v_mov_b32 v19, v18
    s_nop 1
    v_permlane16_swap_b32 v19, v18
    v_max_f32 v18, v18, v19
    v_fma_f32 v18, v18, s28, v11
    v_max_f32 v24, 0, v18
    v_sub_f32 v11, v11, v24
    v_sub_f32 v25, 0, v24
    v_exp_f32 v25, v25
    s_nop 0
    v_mul_f32 v50, v50, v25
    v_mul_f32 v208, v208, v25
    v_mul_f32 v209, v209, v25
    v_mul_f32 v210, v210, v25
    v_mul_f32 v211, v211, v25
    v_mul_f32 v212, v212, v25
    v_mul_f32 v213, v213, v25
    v_mul_f32 v214, v214, v25
    v_mul_f32 v215, v215, v25
    v_mul_f32 v216, v216, v25
    v_mul_f32 v217, v217, v25
    v_mul_f32 v218, v218, v25
    v_mul_f32 v219, v219, v25
    v_mul_f32 v220, v220, v25
    v_mul_f32 v221, v221, v25
    v_mul_f32 v222, v222, v25
    v_mul_f32 v223, v223, v25
    v_mul_f32 v224, v224, v25
    v_mul_f32 v225, v225, v25
    v_mul_f32 v226, v226, v25
    v_mul_f32 v227, v227, v25
    v_mul_f32 v228, v228, v25
    v_mul_f32 v229, v229, v25
    v_mul_f32 v230, v230, v25
    v_mul_f32 v231, v231, v25
    v_mul_f32 v232, v232, v25
    v_mul_f32 v233, v233, v25
    v_mul_f32 v234, v234, v25
    v_mul_f32 v235, v235, v25
    v_mul_f32 v236, v236, v25
    v_mul_f32 v237, v237, v25
    v_mul_f32 v238, v238, v25
    v_mul_f32 v239, v239, v25
    v_mul_f32 v240, v240, v25
    v_mul_f32 v241, v241, v25
    v_mul_f32 v242, v242, v25
    v_mul_f32 v243, v243, v25
    v_mul_f32 v244, v244, v25
    v_mul_f32 v245, v245, v25
    v_mul_f32 v246, v246, v25
    v_mul_f32 v247, v247, v25
    v_mul_f32 v248, v248, v25
    v_mul_f32 v249, v249, v25
    v_mul_f32 v250, v250, v25
    v_mul_f32 v251, v251, v25
    v_mul_f32 v252, v252, v25
    v_mul_f32 v253, v253, v25
    v_mul_f32 v254, v254, v25
    v_mul_f32 v255, v255, v25
    v_fma_f32 v104, v104, s28, v11
    v_fma_f32 v105, v105, s28, v11
    v_exp_f32 v104, v104
    v_exp_f32 v105, v105
    s_nop 0
    v_cvt_pk_bf16_f32 v26, v104, v105
    v_fma_f32 v106, v106, s28, v11
    v_fma_f32 v107, v107, s28, v11
    v_exp_f32 v106, v106
    v_exp_f32 v107, v107
    s_nop 0
    v_cvt_pk_bf16_f32 v27, v106, v107
    v_fma_f32 v108, v108, s28, v11
    v_fma_f32 v109, v109, s28, v11
    v_exp_f32 v108, v108
    v_exp_f32 v109, v109
    s_nop 0
    v_cvt_pk_bf16_f32 v28, v108, v109
    v_fma_f32 v110, v110, s28, v11
    v_fma_f32 v111, v111, s28, v11
    v_exp_f32 v110, v110
    v_exp_f32 v111, v111
    s_nop 0
    v_cvt_pk_bf16_f32 v29, v110, v111
    s_add_u32 s69, s39, 0
    buffer_load_dwordx4 v[44:47], v30, s[4:7], s69 offen offset:0
    s_waitcnt vmcnt(0)
    v_mfma_f32_16x16x32_bf16 v[104:107], v[44:47], a[168:171], 0
    s_nop 7
    buffer_load_dwordx4 v[44:47], v30, s[4:7], s69 offen offset:64
    s_waitcnt vmcnt(0)
    v_mfma_f32_16x16x32_bf16 v[104:107], v[44:47], a[172:175], v[104:107]
    s_nop 7
    buffer_load_dwordx4 v[44:47], v30, s[4:7], s69 offen offset:128
    s_waitcnt vmcnt(0)
    v_mfma_f32_16x16x32_bf16 v[104:107], v[44:47], a[176:179], v[104:107]
    s_nop 7
    buffer_load_dwordx4 v[44:47], v30, s[4:7], s69 offen offset:192
    s_waitcnt vmcnt(0)
    v_mfma_f32_16x16x32_bf16 v[104:107], v[44:47], a[180:183], v[104:107]
    s_nop 7
    buffer_load_dwordx4 v[44:47], v30, s[4:7], s69 offen offset:256
    s_waitcnt vmcnt(0)
    v_mfma_f32_16x16x32_bf16 v[104:107], v[44:47], a[184:187], v[104:107]
    s_nop 7
    buffer_load_dwordx4 v[44:47], v30, s[4:7], s69 offen offset:320
    s_waitcnt vmcnt(0)
    v_mfma_f32_16x16x32_bf16 v[104:107], v[44:47], a[188:191], v[104:107]
    s_nop 7
    s_add_u32 s69, s39, 6144
    buffer_load_dwordx4 v[44:47], v30, s[4:7], s69 offen offset:0
    s_waitcnt vmcnt(0)
    v_mfma_f32_16x16x32_bf16 v[108:111], v[44:47], a[168:171], 0
    s_nop 7
    buffer_load_dwordx4 v[44:47], v30, s[4:7], s69 offen offset:64
    s_waitcnt vmcnt(0)
    v_mfma_f32_16x16x32_bf16 v[108:111], v[44:47], a[172:175], v[108:111]
    s_nop 7
    buffer_load_dwordx4 v[44:47], v30, s[4:7], s69 offen offset:128
    s_waitcnt vmcnt(0)
    v_mfma_f32_16x16x32_bf16 v[108:111], v[44:47], a[176:179], v[108:111]
    s_nop 7
    buffer_load_dwordx4 v[44:47], v30, s[4:7], s69 offen offset:192
    s_waitcnt vmcnt(0)
    v_mfma_f32_16x16x32_bf16 v[108:111], v[44:47], a[180:183], v[108:111]
    s_nop 7
    buffer_load_dwordx4 v[44:47], v30, s[4:7], s69 offen offset:256
    s_waitcnt vmcnt(0)
    v_mfma_f32_16x16x32_bf16 v[108:111], v[44:47], a[184:187], v[108:111]
    s_nop 7
    buffer_load_dwordx4 v[44:47], v30, s[4:7], s69 offen offset:320
    s_waitcnt vmcnt(0)
    v_mfma_f32_16x16x32_bf16 v[108:111], v[44:47], a[188:191], v[108:111]
    s_nop 7
    s_nop 15
    v_max3_f32 v18, v104, v105, v106
    v_max3_f32 v18, v18, v107, v108
    v_max3_f32 v18, v18, v109, v110
    v_max_f32 v18, v18, v111
    v_mov_b32 v19, v18
    s_nop 1
    v_permlane32_swap_b32 v19, v18
    v_max_f32 v18, v18, v19
    v_mov_b32 v19, v18
    s_nop 1
    v_permlane16_swap_b32 v19, v18
    v_max_f32 v18, v18, v19
    v_fma_f32 v18, v18, s28, v12
    v_max_f32 v24, 0, v18
    v_sub_f32 v12, v12, v24
    v_sub_f32 v25, 0, v24
    v_exp_f32 v25, v25
    s_nop 0
    v_mul_f32 v51, v51, v25
    v_accvgpr_read_b32 v19, a0
    v_mul_f32 v19, v19, v25
    v_accvgpr_write_b32 a0, v19
    v_accvgpr_read_b32 v19, a1
    v_mul_f32 v19, v19, v25
    v_accvgpr_write_b32 a1, v19
    v_accvgpr_read_b32 v19, a2
    v_mul_f32 v19, v19, v25
    v_accvgpr_write_b32 a2, v19
    v_accvgpr_read_b32 v19, a3
    v_mul_f32 v19, v19, v25
    v_accvgpr_write_b32 a3, v19
    v_accvgpr_read_b32 v19, a4
    v_mul_f32 v19, v19, v25
    v_accvgpr_write_b32 a4, v19
    v_accvgpr_read_b32 v19, a5
    v_mul_f32 v19, v19, v25
    v_accvgpr_write_b32 a5, v19
    v_accvgpr_read_b32 v19, a6
    v_mul_f32 v19, v19, v25
    v_accvgpr_write_b32 a6, v19
    v_accvgpr_read_b32 v19, a7
    v_mul_f32 v19, v19, v25
    v_accvgpr_write_b32 a7, v19
    v_accvgpr_read_b32 v19, a8
    v_mul_f32 v19, v19, v25
    v_accvgpr_write_b32 a8, v19
    v_accvgpr_read_b32 v19, a9
    v_mul_f32 v19, v19, v25
    v_accvgpr_write_b32 a9, v19
    v_accvgpr_read_b32 v19, a10
    v_mul_f32 v19, v19, v25
    v_accvgpr_write_b32 a10, v19
    v_accvgpr_read_b32 v19, a11
    v_mul_f32 v19, v19, v25
    v_accvgpr_write_b32 a11, v19
    v_accvgpr_read_b32 v19, a12
    v_mul_f32 v19, v19, v25
    v_accvgpr_write_b32 a12, v19
    v_accvgpr_read_b32 v19, a13
    v_mul_f32 v19, v19, v25
    v_accvgpr_write_b32 a13, v19
    v_accvgpr_read_b32 v19, a14
    v_mul_f32 v19, v19, v25
    v_accvgpr_write_b32 a14, v19
    v_accvgpr_read_b32 v19, a15
    v_mul_f32 v19, v19, v25
    v_accvgpr_write_b32 a15, v19
    v_accvgpr_read_b32 v19, a16
    v_mul_f32 v19, v19, v25
    v_accvgpr_write_b32 a16, v19
    v_accvgpr_read_b32 v19, a17
    v_mul_f32 v19, v19, v25
    v_accvgpr_write_b32 a17, v19
    v_accvgpr_read_b32 v19, a18
    v_mul_f32 v19, v19, v25
    v_accvgpr_write_b32 a18, v19
    v_accvgpr_read_b32 v19, a19
    v_mul_f32 v19, v19, v25
    v_accvgpr_write_b32 a19, v19
    v_accvgpr_read_b32 v19, a20
    v_mul_f32 v19, v19, v25
    v_accvgpr_write_b32 a20, v19
    v_accvgpr_read_b32 v19, a21
    v_mul_f32 v19, v19, v25
    v_accvgpr_write_b32 a21, v19
    v_accvgpr_read_b32 v19, a22
    v_mul_f32 v19, v19, v25
    v_accvgpr_write_b32 a22, v19
    v_accvgpr_read_b32 v19, a23
    v_mul_f32 v19, v19, v25
    v_accvgpr_write_b32 a23, v19
    v_accvgpr_read_b32 v19, a24
    v_mul_f32 v19, v19, v25
    v_accvgpr_write_b32 a24, v19
    v_accvgpr_read_b32 v19, a25
    v_mul_f32 v19, v19, v25
    v_accvgpr_write_b32 a25, v19
    v_accvgpr_read_b32 v19, a26
    v_mul_f32 v19, v19, v25
    v_accvgpr_write_b32 a26, v19
    v_accvgpr_read_b32 v19, a27
    v_mul_f32 v19, v19, v25
    v_accvgpr_write_b32 a27, v19
    v_accvgpr_read_b32 v19, a28
    v_mul_f32 v19, v19, v25
    v_accvgpr_write_b32 a28, v19
    v_accvgpr_read_b32 v19, a29
    v_mul_f32 v19, v19, v25
    v_accvgpr_write_b32 a29, v19
    v_accvgpr_read_b32 v19, a30
    v_mul_f32 v19, v19, v25
    v_accvgpr_write_b32 a30, v19
    v_accvgpr_read_b32 v19, a31
    v_mul_f32 v19, v19, v25
    v_accvgpr_write_b32 a31, v19
    v_accvgpr_read_b32 v19, a32
    v_mul_f32 v19, v19, v25
    v_accvgpr_write_b32 a32, v19
    v_accvgpr_read_b32 v19, a33
    v_mul_f32 v19, v19, v25
    v_accvgpr_write_b32 a33, v19
    v_accvgpr_read_b32 v19, a34
    v_mul_f32 v19, v19, v25
    v_accvgpr_write_b32 a34, v19
    v_accvgpr_read_b32 v19, a35
    v_mul_f32 v19, v19, v25
    v_accvgpr_write_b32 a35, v19
    v_accvgpr_read_b32 v19, a36
    v_mul_f32 v19, v19, v25
    v_accvgpr_write_b32 a36, v19
    v_accvgpr_read_b32 v19, a37
    v_mul_f32 v19, v19, v25
    v_accvgpr_write_b32 a37, v19
    v_accvgpr_read_b32 v19, a38
    v_mul_f32 v19, v19, v25
    v_accvgpr_write_b32 a38, v19
    v_accvgpr_read_b32 v19, a39
    v_mul_f32 v19, v19, v25
    v_accvgpr_write_b32 a39, v19
    v_accvgpr_read_b32 v19, a40
    v_mul_f32 v19, v19, v25
    v_accvgpr_write_b32 a40, v19
    v_accvgpr_read_b32 v19, a41
    v_mul_f32 v19, v19, v25
    v_accvgpr_write_b32 a41, v19
    v_accvgpr_read_b32 v19, a42
    v_mul_f32 v19, v19, v25
    v_accvgpr_write_b32 a42, v19
    v_accvgpr_read_b32 v19, a43
    v_mul_f32 v19, v19, v25
    v_accvgpr_write_b32 a43, v19
    v_accvgpr_read_b32 v19, a44
    v_mul_f32 v19, v19, v25
    v_accvgpr_write_b32 a44, v19
    v_accvgpr_read_b32 v19, a45
    v_mul_f32 v19, v19, v25
    v_accvgpr_write_b32 a45, v19
    v_accvgpr_read_b32 v19, a46
    v_mul_f32 v19, v19, v25
    v_accvgpr_write_b32 a46, v19
    v_accvgpr_read_b32 v19, a47
    v_mul_f32 v19, v19, v25
    v_accvgpr_write_b32 a47, v19
    v_fma_f32 v104, v104, s28, v12
    v_fma_f32 v105, v105, s28, v12
    v_exp_f32 v104, v104
    v_exp_f32 v105, v105
    s_nop 0
    v_cvt_pk_bf16_f32 v32, v104, v105
    v_fma_f32 v106, v106, s28, v12
    v_fma_f32 v107, v107, s28, v12
    v_exp_f32 v106, v106
    v_exp_f32 v107, v107
    s_nop 0
    v_cvt_pk_bf16_f32 v33, v106, v107
    v_fma_f32 v108, v108, s28, v12
    v_fma_f32 v109, v109, s28, v12
    v_exp_f32 v108, v108
    v_exp_f32 v109, v109
    s_nop 0
    v_cvt_pk_bf16_f32 v34, v108, v109
    v_fma_f32 v110, v110, s28, v12
    v_fma_f32 v111, v111, s28, v12
    v_exp_f32 v110, v110
    v_exp_f32 v111, v111
    s_nop 0
    v_cvt_pk_bf16_f32 v35, v110, v111
    s_add_u32 s69, s39, 0
    buffer_load_dwordx4 v[44:47], v30, s[4:7], s69 offen offset:0
    s_waitcnt vmcnt(0)
    v_mfma_f32_16x16x32_bf16 v[104:107], v[44:47], a[192:195], 0
    s_nop 7
    buffer_load_dwordx4 v[44:47], v30, s[4:7], s69 offen offset:64
    s_waitcnt vmcnt(0)
    v_mfma_f32_16x16x32_bf16 v[104:107], v[44:47], a[196:199], v[104:107]
    s_nop 7
    buffer_load_dwordx4 v[44:47], v30, s[4:7], s69 offen offset:128
    s_waitcnt vmcnt(0)
    v_mfma_f32_16x16x32_bf16 v[104:107], v[44:47], a[200:203], v[104:107]
    s_nop 7
    buffer_load_dwordx4 v[44:47], v30, s[4:7], s69 offen offset:192
    s_waitcnt vmcnt(0)
    v_mfma_f32_16x16x32_bf16 v[104:107], v[44:47], a[204:207], v[104:107]
    s_nop 7
    buffer_load_dwordx4 v[44:47], v30, s[4:7], s69 offen offset:256
    s_waitcnt vmcnt(0)
    v_mfma_f32_16x16x32_bf16 v[104:107], v[44:47], a[208:211], v[104:107]
    s_nop 7
    buffer_load_dwordx4 v[44:47], v30, s[4:7], s69 offen offset:320
    s_waitcnt vmcnt(0)
    v_mfma_f32_16x16x32_bf16 v[104:107], v[44:47], v[92:95], v[104:107]
    s_nop 7
    s_add_u32 s69, s39, 6144
    buffer_load_dwordx4 v[44:47], v30, s[4:7], s69 offen offset:0
    s_waitcnt vmcnt(0)
    v_mfma_f32_16x16x32_bf16 v[108:111], v[44:47], a[192:195], 0
    s_nop 7
    buffer_load_dwordx4 v[44:47], v30, s[4:7], s69 offen offset:64
    s_waitcnt vmcnt(0)
    v_mfma_f32_16x16x32_bf16 v[108:111], v[44:47], a[196:199], v[108:111]
    s_nop 7
    buffer_load_dwordx4 v[44:47], v30, s[4:7], s69 offen offset:128
    s_waitcnt vmcnt(0)
    v_mfma_f32_16x16x32_bf16 v[108:111], v[44:47], a[200:203], v[108:111]
    s_nop 7
    buffer_load_dwordx4 v[44:47], v30, s[4:7], s69 offen offset:192
    s_waitcnt vmcnt(0)
    v_mfma_f32_16x16x32_bf16 v[108:111], v[44:47], a[204:207], v[108:111]
    s_nop 7
    buffer_load_dwordx4 v[44:47], v30, s[4:7], s69 offen offset:256
    s_waitcnt vmcnt(0)
    v_mfma_f32_16x16x32_bf16 v[108:111], v[44:47], a[208:211], v[108:111]
    s_nop 7
    buffer_load_dwordx4 v[44:47], v30, s[4:7], s69 offen offset:320
    s_waitcnt vmcnt(0)
    v_mfma_f32_16x16x32_bf16 v[108:111], v[44:47], v[92:95], v[108:111]
    s_nop 7
    s_nop 15
    v_max3_f32 v18, v104, v105, v106
    v_max3_f32 v18, v18, v107, v108
    v_max3_f32 v18, v18, v109, v110
    v_max_f32 v18, v18, v111
    v_mov_b32 v19, v18
    s_nop 1
    v_permlane32_swap_b32 v19, v18
    v_max_f32 v18, v18, v19
    v_mov_b32 v19, v18
    s_nop 1
    v_permlane16_swap_b32 v19, v18
    v_max_f32 v18, v18, v19
    v_fma_f32 v18, v18, s28, v13
    v_max_f32 v24, 0, v18
    v_sub_f32 v13, v13, v24
    v_sub_f32 v25, 0, v24
    v_exp_f32 v25, v25
    s_nop 0
    v_mul_f32 v19, v48, v25
    v_cndmask_b32_e64 v48, v48, v19, s[60:61]
    v_accvgpr_read_b32 v19, a48
    v_mul_f32 v19, v19, v25
    v_accvgpr_write_b32 a48, v19
    v_accvgpr_read_b32 v19, a49
    v_mul_f32 v19, v19, v25
    v_accvgpr_write_b32 a49, v19
    v_accvgpr_read_b32 v19, a50
    v_mul_f32 v19, v19, v25
    v_accvgpr_write_b32 a50, v19
    v_accvgpr_read_b32 v19, a51
    v_mul_f32 v19, v19, v25
    v_accvgpr_write_b32 a51, v19
    v_accvgpr_read_b32 v19, a52
    v_mul_f32 v19, v19, v25
    v_accvgpr_write_b32 a52, v19
    v_accvgpr_read_b32 v19, a53
    v_mul_f32 v19, v19, v25
    v_accvgpr_write_b32 a53, v19
    v_accvgpr_read_b32 v19, a54
    v_mul_f32 v19, v19, v25
    v_accvgpr_write_b32 a54, v19
    v_accvgpr_read_b32 v19, a55
    v_mul_f32 v19, v19, v25
    v_accvgpr_write_b32 a55, v19
    v_accvgpr_read_b32 v19, a56
    v_mul_f32 v19, v19, v25
    v_accvgpr_write_b32 a56, v19
    v_accvgpr_read_b32 v19, a57
    v_mul_f32 v19, v19, v25
    v_accvgpr_write_b32 a57, v19
    v_accvgpr_read_b32 v19, a58
    v_mul_f32 v19, v19, v25
    v_accvgpr_write_b32 a58, v19
    v_accvgpr_read_b32 v19, a59
    v_mul_f32 v19, v19, v25
    v_accvgpr_write_b32 a59, v19
    v_accvgpr_read_b32 v19, a60
    v_mul_f32 v19, v19, v25
    v_accvgpr_write_b32 a60, v19
    v_accvgpr_read_b32 v19, a61
    v_mul_f32 v19, v19, v25
    v_accvgpr_write_b32 a61, v19
    v_accvgpr_read_b32 v19, a62
    v_mul_f32 v19, v19, v25
    v_accvgpr_write_b32 a62, v19
    v_accvgpr_read_b32 v19, a63
    v_mul_f32 v19, v19, v25
    v_accvgpr_write_b32 a63, v19
    v_accvgpr_read_b32 v19, a64
    v_mul_f32 v19, v19, v25
    v_accvgpr_write_b32 a64, v19
    v_accvgpr_read_b32 v19, a65
    v_mul_f32 v19, v19, v25
    v_accvgpr_write_b32 a65, v19
    v_accvgpr_read_b32 v19, a66
    v_mul_f32 v19, v19, v25
    v_accvgpr_write_b32 a66, v19
    v_accvgpr_read_b32 v19, a67
    v_mul_f32 v19, v19, v25
    v_accvgpr_write_b32 a67, v19
    v_accvgpr_read_b32 v19, a68
    v_mul_f32 v19, v19, v25
    v_accvgpr_write_b32 a68, v19
    v_accvgpr_read_b32 v19, a69
    v_mul_f32 v19, v19, v25
    v_accvgpr_write_b32 a69, v19
    v_accvgpr_read_b32 v19, a70
    v_mul_f32 v19, v19, v25
    v_accvgpr_write_b32 a70, v19
    v_accvgpr_read_b32 v19, a71
    v_mul_f32 v19, v19, v25
    v_accvgpr_write_b32 a71, v19
    v_accvgpr_read_b32 v19, a72
    v_mul_f32 v19, v19, v25
    v_accvgpr_write_b32 a72, v19
    v_accvgpr_read_b32 v19, a73
    v_mul_f32 v19, v19, v25
    v_accvgpr_write_b32 a73, v19
    v_accvgpr_read_b32 v19, a74
    v_mul_f32 v19, v19, v25
    v_accvgpr_write_b32 a74, v19
    v_accvgpr_read_b32 v19, a75
    v_mul_f32 v19, v19, v25
    v_accvgpr_write_b32 a75, v19
    v_accvgpr_read_b32 v19, a76
    v_mul_f32 v19, v19, v25
    v_accvgpr_write_b32 a76, v19
    v_accvgpr_read_b32 v19, a77
    v_mul_f32 v19, v19, v25
    v_accvgpr_write_b32 a77, v19
    v_accvgpr_read_b32 v19, a78
    v_mul_f32 v19, v19, v25
    v_accvgpr_write_b32 a78, v19
    v_accvgpr_read_b32 v19, a79
    v_mul_f32 v19, v19, v25
    v_accvgpr_write_b32 a79, v19
    v_accvgpr_read_b32 v19, a80
    v_mul_f32 v19, v19, v25
    v_accvgpr_write_b32 a80, v19
    v_accvgpr_read_b32 v19, a81
    v_mul_f32 v19, v19, v25
    v_accvgpr_write_b32 a81, v19
    v_accvgpr_read_b32 v19, a82
    v_mul_f32 v19, v19, v25
    v_accvgpr_write_b32 a82, v19
    v_accvgpr_read_b32 v19, a83
    v_mul_f32 v19, v19, v25
    v_accvgpr_write_b32 a83, v19
    v_accvgpr_read_b32 v19, a84
    v_mul_f32 v19, v19, v25
    v_accvgpr_write_b32 a84, v19
    v_accvgpr_read_b32 v19, a85
    v_mul_f32 v19, v19, v25
    v_accvgpr_write_b32 a85, v19
    v_accvgpr_read_b32 v19, a86
    v_mul_f32 v19, v19, v25
    v_accvgpr_write_b32 a86, v19
    v_accvgpr_read_b32 v19, a87
    v_mul_f32 v19, v19, v25
    v_accvgpr_write_b32 a87, v19
    v_accvgpr_read_b32 v19, a88
    v_mul_f32 v19, v19, v25
    v_accvgpr_write_b32 a88, v19
    v_accvgpr_read_b32 v19, a89
    v_mul_f32 v19, v19, v25
    v_accvgpr_write_b32 a89, v19
    v_accvgpr_read_b32 v19, a90
    v_mul_f32 v19, v19, v25
    v_accvgpr_write_b32 a90, v19
    v_accvgpr_read_b32 v19, a91
    v_mul_f32 v19, v19, v25
    v_accvgpr_write_b32 a91, v19
    v_accvgpr_read_b32 v19, a92
    v_mul_f32 v19, v19, v25
    v_accvgpr_write_b32 a92, v19
    v_accvgpr_read_b32 v19, a93
    v_mul_f32 v19, v19, v25
    v_accvgpr_write_b32 a93, v19
    v_accvgpr_read_b32 v19, a94
    v_mul_f32 v19, v19, v25
    v_accvgpr_write_b32 a94, v19
    v_accvgpr_read_b32 v19, a95
    v_mul_f32 v19, v19, v25
    v_accvgpr_write_b32 a95, v19
    v_fma_f32 v104, v104, s28, v13
    v_fma_f32 v105, v105, s28, v13
    v_exp_f32 v104, v104
    v_exp_f32 v105, v105
    s_nop 0
    v_cvt_pk_bf16_f32 v38, v104, v105
    v_fma_f32 v106, v106, s28, v13
    v_fma_f32 v107, v107, s28, v13
    v_exp_f32 v106, v106
    v_exp_f32 v107, v107
    s_nop 0
    v_cvt_pk_bf16_f32 v39, v106, v107
    v_fma_f32 v108, v108, s28, v13
    v_fma_f32 v109, v109, s28, v13
    v_exp_f32 v108, v108
    v_exp_f32 v109, v109
    s_nop 0
    v_cvt_pk_bf16_f32 v40, v108, v109
    v_fma_f32 v110, v110, s28, v13
    v_fma_f32 v111, v111, s28, v13
    v_exp_f32 v110, v110
    v_exp_f32 v111, v111
    s_nop 0
    v_cvt_pk_bf16_f32 v41, v110, v111
    v_mfma_f32_16x16x32_bf16 v[44:47], a[236:239], v[14:17], v[48:51]
    v_mfma_f32_16x16x32_bf16 v[44:47], a[240:243], v[20:23], v[44:47]
    v_mfma_f32_16x16x32_bf16 v[44:47], a[244:247], v[26:29], v[44:47]
    v_mfma_f32_16x16x32_bf16 v[44:47], a[248:251], v[32:35], v[44:47]
    v_mfma_f32_16x16x32_bf16 v[44:47], a[252:255], v[38:41], v[44:47]
    s_nop 15
    s_setpc_b64 s[40:41]
L_rare5_1:
    s_nop 15
    v_mbcnt_lo_u32_b32 v27, -1, 0
    v_mbcnt_hi_u32_b32 v27, -1, v27
    v_and_b32 v26, 15, v27
    v_mul_u32_u24 v26, 384, v26
    v_lshrrev_b32 v27, 4, v27
    v_lshl_add_u32 v26, v27, 4, v26
    s_add_u32 s69, s39, 0
    buffer_load_dwordx4 v[48:51], v26, s[4:7], s69 offen offset:0
    s_waitcnt vmcnt(0)
    v_mfma_f32_16x16x32_bf16 v[104:107], v[48:51], a[96:99], 0
    s_nop 7
    buffer_load_dwordx4 v[48:51], v26, s[4:7], s69 offen offset:64
    s_waitcnt vmcnt(0)
    v_mfma_f32_16x16x32_bf16 v[104:107], v[48:51], a[100:103], v[104:107]
    s_nop 7
    buffer_load_dwordx4 v[48:51], v26, s[4:7], s69 offen offset:128
    s_waitcnt vmcnt(0)
    v_mfma_f32_16x16x32_bf16 v[104:107], v[48:51], a[104:107], v[104:107]
    s_nop 7
    buffer_load_dwordx4 v[48:51], v26, s[4:7], s69 offen offset:192
    s_waitcnt vmcnt(0)
    v_mfma_f32_16x16x32_bf16 v[104:107], v[48:51], a[108:111], v[104:107]
    s_nop 7
    buffer_load_dwordx4 v[48:51], v26, s[4:7], s69 offen offset:256
    s_waitcnt vmcnt(0)
    v_mfma_f32_16x16x32_bf16 v[104:107], v[48:51], a[112:115], v[104:107]
    s_nop 7
    buffer_load_dwordx4 v[48:51], v26, s[4:7], s69 offen offset:320
    s_waitcnt vmcnt(0)
    v_mfma_f32_16x16x32_bf16 v[104:107], v[48:51], a[116:119], v[104:107]
    s_nop 7
    s_add_u32 s69, s39, 6144
    buffer_load_dwordx4 v[48:51], v26, s[4:7], s69 offen offset:0
    s_waitcnt vmcnt(0)
    v_mfma_f32_16x16x32_bf16 v[108:111], v[48:51], a[96:99], 0
    s_nop 7
    buffer_load_dwordx4 v[48:51], v26, s[4:7], s69 offen offset:64
    s_waitcnt vmcnt(0)
    v_mfma_f32_16x16x32_bf16 v[108:111], v[48:51], a[100:103], v[108:111]
    s_nop 7
    buffer_load_dwordx4 v[48:51], v26, s[4:7], s69 offen offset:128
    s_waitcnt vmcnt(0)
    v_mfma_f32_16x16x32_bf16 v[108:111], v[48:51], a[104:107], v[108:111]
    s_nop 7
    buffer_load_dwordx4 v[48:51], v26, s[4:7], s69 offen offset:192
    s_waitcnt vmcnt(0)
    v_mfma_f32_16x16x32_bf16 v[108:111], v[48:51], a[108:111], v[108:111]
    s_nop 7
    buffer_load_dwordx4 v[48:51], v26, s[4:7], s69 offen offset:256
    s_waitcnt vmcnt(0)
    v_mfma_f32_16x16x32_bf16 v[108:111], v[48:51], a[112:115], v[108:111]
    s_nop 7
    buffer_load_dwordx4 v[48:51], v26, s[4:7], s69 offen offset:320
    s_waitcnt vmcnt(0)
    v_mfma_f32_16x16x32_bf16 v[108:111], v[48:51], a[116:119], v[108:111]
    s_nop 7
    s_nop 15
    v_max3_f32 v14, v104, v105, v106
    v_max3_f32 v14, v14, v107, v108
    v_max3_f32 v14, v14, v109, v110
    v_max_f32 v14, v14, v111
    v_mov_b32 v15, v14
    s_nop 1
    v_permlane32_swap_b32 v15, v14
    v_max_f32 v14, v14, v15
    v_mov_b32 v15, v14
    s_nop 1
    v_permlane16_swap_b32 v15, v14
    v_max_f32 v14, v14, v15
    v_fma_f32 v14, v14, s28, v9
    v_max_f32 v20, 0, v14
    v_sub_f32 v9, v9, v20
    v_sub_f32 v21, 0, v20
    v_exp_f32 v21, v21
    s_nop 0
    v_mul_f32 v15, v44, v21
    v_cndmask_b32_e64 v44, v15, v44, s[60:61]
    v_cndmask_b32_e64 v44, v44, 0, s[46:47]
    v_mul_f32 v112, v112, v21
    v_mul_f32 v113, v113, v21
    v_mul_f32 v114, v114, v21
    v_mul_f32 v115, v115, v21
    v_mul_f32 v116, v116, v21
    v_mul_f32 v117, v117, v21
    v_mul_f32 v118, v118, v21
    v_mul_f32 v119, v119, v21
    v_mul_f32 v120, v120, v21
    v_mul_f32 v121, v121, v21
    v_mul_f32 v122, v122, v21
    v_mul_f32 v123, v123, v21
    v_mul_f32 v124, v124, v21
    v_mul_f32 v125, v125, v21
    v_mul_f32 v126, v126, v21
    v_mul_f32 v127, v127, v21
    v_mul_f32 v128, v128, v21
    v_mul_f32 v129, v129, v21
    v_mul_f32 v130, v130, v21
    v_mul_f32 v131, v131, v21
    v_mul_f32 v132, v132, v21
    v_mul_f32 v133, v133, v21
    v_mul_f32 v134, v134, v21
    v_mul_f32 v135, v135, v21
    v_mul_f32 v136, v136, v21
    v_mul_f32 v137, v137, v21
    v_mul_f32 v138, v138, v21
    v_mul_f32 v139, v139, v21
    v_mul_f32 v140, v140, v21
    v_mul_f32 v141, v141, v21
    v_mul_f32 v142, v142, v21
    v_mul_f32 v143, v143, v21
    v_mul_f32 v144, v144, v21
    v_mul_f32 v145, v145, v21
    v_mul_f32 v146, v146, v21
    v_mul_f32 v147, v147, v21
    v_mul_f32 v148, v148, v21
    v_mul_f32 v149, v149, v21
    v_mul_f32 v150, v150, v21
    v_mul_f32 v151, v151, v21
    v_mul_f32 v152, v152, v21
    v_mul_f32 v153, v153, v21
    v_mul_f32 v154, v154, v21
    v_mul_f32 v155, v155, v21
    v_mul_f32 v156, v156, v21
    v_mul_f32 v157, v157, v21
    v_mul_f32 v158, v158, v21
    v_mul_f32 v159, v159, v21
    v_fma_f32 v104, v104, s28, v9
    v_fma_f32 v105, v105, s28, v9
    v_exp_f32 v104, v104
    v_exp_f32 v105, v105
    s_nop 0
    v_cvt_pk_bf16_f32 v18, v104, v105
    v_fma_f32 v106, v106, s28, v9
    v_fma_f32 v107, v107, s28, v9
    v_exp_f32 v106, v106
    v_exp_f32 v107, v107
    s_nop 0
    v_cvt_pk_bf16_f32 v19, v106, v107
    v_fma_f32 v108, v108, s28, v9
    v_fma_f32 v109, v109, s28, v9
    v_exp_f32 v108, v108
    v_exp_f32 v109, v109
    s_nop 0
    v_cvt_pk_bf16_f32 v16, v108, v109
    v_fma_f32 v110, v110, s28, v9
    v_fma_f32 v111, v111, s28, v9
    v_exp_f32 v110, v110
    v_exp_f32 v111, v111
    s_nop 0
    v_cvt_pk_bf16_f32 v17, v110, v111
    s_add_u32 s69, s39, 0
    buffer_load_dwordx4 v[48:51], v26, s[4:7], s69 offen offset:0
    s_waitcnt vmcnt(0)
    v_mfma_f32_16x16x32_bf16 v[104:107], v[48:51], a[120:123], 0
    s_nop 7
    buffer_load_dwordx4 v[48:51], v26, s[4:7], s69 offen offset:64
    s_waitcnt vmcnt(0)
    v_mfma_f32_16x16x32_bf16 v[104:107], v[48:51], a[124:127], v[104:107]
    s_nop 7
    buffer_load_dwordx4 v[48:51], v26, s[4:7], s69 offen offset:128
    s_waitcnt vmcnt(0)
    v_mfma_f32_16x16x32_bf16 v[104:107], v[48:51], a[128:131], v[104:107]
    s_nop 7
    buffer_load_dwordx4 v[48:51], v26, s[4:7], s69 offen offset:192
    s_waitcnt vmcnt(0)
    v_mfma_f32_16x16x32_bf16 v[104:107], v[48:51], a[132:135], v[104:107]
    s_nop 7
    buffer_load_dwordx4 v[48:51], v26, s[4:7], s69 offen offset:256
    s_waitcnt vmcnt(0)
    v_mfma_f32_16x16x32_bf16 v[104:107], v[48:51], a[136:139], v[104:107]
    s_nop 7
    buffer_load_dwordx4 v[48:51], v26, s[4:7], s69 offen offset:320
    s_waitcnt vmcnt(0)
    v_mfma_f32_16x16x32_bf16 v[104:107], v[48:51], a[140:143], v[104:107]
    s_nop 7
    s_add_u32 s69, s39, 6144
    buffer_load_dwordx4 v[48:51], v26, s[4:7], s69 offen offset:0
    s_waitcnt vmcnt(0)
    v_mfma_f32_16x16x32_bf16 v[108:111], v[48:51], a[120:123], 0
    s_nop 7
    buffer_load_dwordx4 v[48:51], v26, s[4:7], s69 offen offset:64
    s_waitcnt vmcnt(0)
    v_mfma_f32_16x16x32_bf16 v[108:111], v[48:51], a[124:127], v[108:111]
    s_nop 7
    buffer_load_dwordx4 v[48:51], v26, s[4:7], s69 offen offset:128
    s_waitcnt vmcnt(0)
    v_mfma_f32_16x16x32_bf16 v[108:111], v[48:51], a[128:131], v[108:111]
    s_nop 7
    buffer_load_dwordx4 v[48:51], v26, s[4:7], s69 offen offset:192
    s_waitcnt vmcnt(0)
    v_mfma_f32_16x16x32_bf16 v[108:111], v[48:51], a[132:135], v[108:111]
    s_nop 7
    buffer_load_dwordx4 v[48:51], v26, s[4:7], s69 offen offset:256
    s_waitcnt vmcnt(0)
    v_mfma_f32_16x16x32_bf16 v[108:111], v[48:51], a[136:139], v[108:111]
    s_nop 7
    buffer_load_dwordx4 v[48:51], v26, s[4:7], s69 offen offset:320
    s_waitcnt vmcnt(0)
    v_mfma_f32_16x16x32_bf16 v[108:111], v[48:51], a[140:143], v[108:111]
    s_nop 7
    s_nop 15
    v_max3_f32 v14, v104, v105, v106
    v_max3_f32 v14, v14, v107, v108
    v_max3_f32 v14, v14, v109, v110
    v_max_f32 v14, v14, v111
    v_mov_b32 v15, v14
    s_nop 1
    v_permlane32_swap_b32 v15, v14
    v_max_f32 v14, v14, v15
    v_mov_b32 v15, v14
    s_nop 1
    v_permlane16_swap_b32 v15, v14
    v_max_f32 v14, v14, v15
    v_fma_f32 v14, v14, s28, v10
    v_max_f32 v20, 0, v14
    v_sub_f32 v10, v10, v20
    v_sub_f32 v21, 0, v20
    v_exp_f32 v21, v21
    s_nop 0
    v_mul_f32 v45, v45, v21
    v_mul_f32 v160, v160, v21
    v_mul_f32 v161, v161, v21
    v_mul_f32 v162, v162, v21
    v_mul_f32 v163, v163, v21
    v_mul_f32 v164, v164, v21
    v_mul_f32 v165, v165, v21
    v_mul_f32 v166, v166, v21
    v_mul_f32 v167, v167, v21
    v_mul_f32 v168, v168, v21
    v_mul_f32 v169, v169, v21
    v_mul_f32 v170, v170, v21
    v_mul_f32 v171, v171, v21
    v_mul_f32 v172, v172, v21
    v_mul_f32 v173, v173, v21
    v_mul_f32 v174, v174, v21
    v_mul_f32 v175, v175, v21
    v_mul_f32 v176, v176, v21
    v_mul_f32 v177, v177, v21
    v_mul_f32 v178, v178, v21
    v_mul_f32 v179, v179, v21
    v_mul_f32 v180, v180, v21
    v_mul_f32 v181, v181, v21
    v_mul_f32 v182, v182, v21
    v_mul_f32 v183, v183, v21
    v_mul_f32 v184, v184, v21
    v_mul_f32 v185, v185, v21
    v_mul_f32 v186, v186, v21
    v_mul_f32 v187, v187, v21
    v_mul_f32 v188, v188, v21
    v_mul_f32 v189, v189, v21
    v_mul_f32 v190, v190, v21
    v_mul_f32 v191, v191, v21
    v_mul_f32 v192, v192, v21
    v_mul_f32 v193, v193, v21
    v_mul_f32 v194, v194, v21
    v_mul_f32 v195, v195, v21
    v_mul_f32 v196, v196, v21
    v_mul_f32 v197, v197, v21
    v_mul_f32 v198, v198, v21
    v_mul_f32 v199, v199, v21
    v_mul_f32 v200, v200, v21
    v_mul_f32 v201, v201, v21
    v_mul_f32 v202, v202, v21
    v_mul_f32 v203, v203, v21
    v_mul_f32 v204, v204, v21
    v_mul_f32 v205, v205, v21
    v_mul_f32 v206, v206, v21
    v_mul_f32 v207, v207, v21
    v_fma_f32 v104, v104, s28, v10
    v_fma_f32 v105, v105, s28, v10
    v_exp_f32 v104, v104
    v_exp_f32 v105, v105
    s_nop 0
    v_cvt_pk_bf16_f32 v24, v104, v105
    v_fma_f32 v106, v106, s28, v10
    v_fma_f32 v107, v107, s28, v10
    v_exp_f32 v106, v106
    v_exp_f32 v107, v107
    s_nop 0
    v_cvt_pk_bf16_f32 v25, v106, v107
    v_fma_f32 v108, v108, s28, v10
    v_fma_f32 v109, v109, s28, v10
    v_exp_f32 v108, v108
    v_exp_f32 v109, v109
    s_nop 0
    v_cvt_pk_bf16_f32 v22, v108, v109
    v_fma_f32 v110, v110, s28, v10
    v_fma_f32 v111, v111, s28, v10
    v_exp_f32 v110, v110
    v_exp_f32 v111, v111
    s_nop 0
    v_cvt_pk_bf16_f32 v23, v110, v111
    s_add_u32 s69, s39, 0
    buffer_load_dwordx4 v[48:51], v26, s[4:7], s69 offen offset:0
    s_waitcnt vmcnt(0)
    v_mfma_f32_16x16x32_bf16 v[104:107], v[48:51], a[144:147], 0
    s_nop 7
    buffer_load_dwordx4 v[48:51], v26, s[4:7], s69 offen offset:64
    s_waitcnt vmcnt(0)
    v_mfma_f32_16x16x32_bf16 v[104:107], v[48:51], a[148:151], v[104:107]
    s_nop 7
    buffer_load_dwordx4 v[48:51], v26, s[4:7], s69 offen offset:128
    s_waitcnt vmcnt(0)
    v_mfma_f32_16x16x32_bf16 v[104:107], v[48:51], a[152:155], v[104:107]
    s_nop 7
    buffer_load_dwordx4 v[48:51], v26, s[4:7], s69 offen offset:192
    s_waitcnt vmcnt(0)
    v_mfma_f32_16x16x32_bf16 v[104:107], v[48:51], a[156:159], v[104:107]
    s_nop 7
    buffer_load_dwordx4 v[48:51], v26, s[4:7], s69 offen offset:256
    s_waitcnt vmcnt(0)
    v_mfma_f32_16x16x32_bf16 v[104:107], v[48:51], a[160:163], v[104:107]
    s_nop 7
    buffer_load_dwordx4 v[48:51], v26, s[4:7], s69 offen offset:320
    s_waitcnt vmcnt(0)
    v_mfma_f32_16x16x32_bf16 v[104:107], v[48:51], a[164:167], v[104:107]
    s_nop 7
    s_add_u32 s69, s39, 6144
    buffer_load_dwordx4 v[48:51], v26, s[4:7], s69 offen offset:0
    s_waitcnt vmcnt(0)
    v_mfma_f32_16x16x32_bf16 v[108:111], v[48:51], a[144:147], 0
    s_nop 7
    buffer_load_dwordx4 v[48:51], v26, s[4:7], s69 offen offset:64
    s_waitcnt vmcnt(0)
    v_mfma_f32_16x16x32_bf16 v[108:111], v[48:51], a[148:151], v[108:111]
    s_nop 7
    buffer_load_dwordx4 v[48:51], v26, s[4:7], s69 offen offset:128
    s_waitcnt vmcnt(0)
    v_mfma_f32_16x16x32_bf16 v[108:111], v[48:51], a[152:155], v[108:111]
    s_nop 7
    buffer_load_dwordx4 v[48:51], v26, s[4:7], s69 offen offset:192
    s_waitcnt vmcnt(0)
    v_mfma_f32_16x16x32_bf16 v[108:111], v[48:51], a[156:159], v[108:111]
    s_nop 7
    buffer_load_dwordx4 v[48:51], v26, s[4:7], s69 offen offset:256
    s_waitcnt vmcnt(0)
    v_mfma_f32_16x16x32_bf16 v[108:111], v[48:51], a[160:163], v[108:111]
    s_nop 7
    buffer_load_dwordx4 v[48:51], v26, s[4:7], s69 offen offset:320
    s_waitcnt vmcnt(0)
    v_mfma_f32_16x16x32_bf16 v[108:111], v[48:51], a[164:167], v[108:111]
    s_nop 7
    s_nop 15
    v_max3_f32 v14, v104, v105, v106
    v_max3_f32 v14, v14, v107, v108
    v_max3_f32 v14, v14, v109, v110
    v_max_f32 v14, v14, v111
    v_mov_b32 v15, v14
    s_nop 1
    v_permlane32_swap_b32 v15, v14
    v_max_f32 v14, v14, v15
    v_mov_b32 v15, v14
    s_nop 1
    v_permlane16_swap_b32 v15, v14
    v_max_f32 v14, v14, v15
    v_fma_f32 v14, v14, s28, v11
    v_max_f32 v20, 0, v14
    v_sub_f32 v11, v11, v20
    v_sub_f32 v21, 0, v20
    v_exp_f32 v21, v21
    s_nop 0
    v_mul_f32 v46, v46, v21
    v_mul_f32 v208, v208, v21
    v_mul_f32 v209, v209, v21
    v_mul_f32 v210, v210, v21
    v_mul_f32 v211, v211, v21
    v_mul_f32 v212, v212, v21
    v_mul_f32 v213, v213, v21
    v_mul_f32 v214, v214, v21
    v_mul_f32 v215, v215, v21
    v_mul_f32 v216, v216, v21
    v_mul_f32 v217, v217, v21
    v_mul_f32 v218, v218, v21
    v_mul_f32 v219, v219, v21
    v_mul_f32 v220, v220, v21
    v_mul_f32 v221, v221, v21
    v_mul_f32 v222, v222, v21
    v_mul_f32 v223, v223, v21
    v_mul_f32 v224, v224, v21
    v_mul_f32 v225, v225, v21
    v_mul_f32 v226, v226, v21
    v_mul_f32 v227, v227, v21
    v_mul_f32 v228, v228, v21
    v_mul_f32 v229, v229, v21
    v_mul_f32 v230, v230, v21
    v_mul_f32 v231, v231, v21
    v_mul_f32 v232, v232, v21
    v_mul_f32 v233, v233, v21
    v_mul_f32 v234, v234, v21
    v_mul_f32 v235, v235, v21
    v_mul_f32 v236, v236, v21
    v_mul_f32 v237, v237, v21
    v_mul_f32 v238, v238, v21
    v_mul_f32 v239, v239, v21
    v_mul_f32 v240, v240, v21
    v_mul_f32 v241, v241, v21
    v_mul_f32 v242, v242, v21
    v_mul_f32 v243, v243, v21
    v_mul_f32 v244, v244, v21
    v_mul_f32 v245, v245, v21
    v_mul_f32 v246, v246, v21
    v_mul_f32 v247, v247, v21
    v_mul_f32 v248, v248, v21
    v_mul_f32 v249, v249, v21
    v_mul_f32 v250, v250, v21
    v_mul_f32 v251, v251, v21
    v_mul_f32 v252, v252, v21
    v_mul_f32 v253, v253, v21
    v_mul_f32 v254, v254, v21
    v_mul_f32 v255, v255, v21
    v_fma_f32 v104, v104, s28, v11
    v_fma_f32 v105, v105, s28, v11
    v_exp_f32 v104, v104
    v_exp_f32 v105, v105
    s_nop 0
    v_cvt_pk_bf16_f32 v30, v104, v105
    v_fma_f32 v106, v106, s28, v11
    v_fma_f32 v107, v107, s28, v11
    v_exp_f32 v106, v106
    v_exp_f32 v107, v107
    s_nop 0
    v_cvt_pk_bf16_f32 v31, v106, v107
    v_fma_f32 v108, v108, s28, v11
    v_fma_f32 v109, v109, s28, v11
    v_exp_f32 v108, v108
    v_exp_f32 v109, v109
    s_nop 0
    v_cvt_pk_bf16_f32 v28, v108, v109
    v_fma_f32 v110, v110, s28, v11
    v_fma_f32 v111, v111, s28, v11
    v_exp_f32 v110, v110
    v_exp_f32 v111, v111
    s_nop 0
    v_cvt_pk_bf16_f32 v29, v110, v111
    s_add_u32 s69, s39, 0
    buffer_load_dwordx4 v[48:51], v26, s[4:7], s69 offen offset:0
    s_waitcnt vmcnt(0)
    v_mfma_f32_16x16x32_bf16 v[104:107], v[48:51], a[168:171], 0
    s_nop 7
    buffer_load_dwordx4 v[48:51], v26, s[4:7], s69 offen offset:64
    s_waitcnt vmcnt(0)
    v_mfma_f32_16x16x32_bf16 v[104:107], v[48:51], a[172:175], v[104:107]
    s_nop 7
    buffer_load_dwordx4 v[48:51], v26, s[4:7], s69 offen offset:128
    s_waitcnt vmcnt(0)
    v_mfma_f32_16x16x32_bf16 v[104:107], v[48:51], a[176:179], v[104:107]
    s_nop 7
    buffer_load_dwordx4 v[48:51], v26, s[4:7], s69 offen offset:192
    s_waitcnt vmcnt(0)
    v_mfma_f32_16x16x32_bf16 v[104:107], v[48:51], a[180:183], v[104:107]
    s_nop 7
    buffer_load_dwordx4 v[48:51], v26, s[4:7], s69 offen offset:256
    s_waitcnt vmcnt(0)
    v_mfma_f32_16x16x32_bf16 v[104:107], v[48:51], a[184:187], v[104:107]
    s_nop 7
    buffer_load_dwordx4 v[48:51], v26, s[4:7], s69 offen offset:320
    s_waitcnt vmcnt(0)
    v_mfma_f32_16x16x32_bf16 v[104:107], v[48:51], a[188:191], v[104:107]
    s_nop 7
    s_add_u32 s69, s39, 6144
    buffer_load_dwordx4 v[48:51], v26, s[4:7], s69 offen offset:0
    s_waitcnt vmcnt(0)
    v_mfma_f32_16x16x32_bf16 v[108:111], v[48:51], a[168:171], 0
    s_nop 7
    buffer_load_dwordx4 v[48:51], v26, s[4:7], s69 offen offset:64
    s_waitcnt vmcnt(0)
    v_mfma_f32_16x16x32_bf16 v[108:111], v[48:51], a[172:175], v[108:111]
    s_nop 7
    buffer_load_dwordx4 v[48:51], v26, s[4:7], s69 offen offset:128
    s_waitcnt vmcnt(0)
    v_mfma_f32_16x16x32_bf16 v[108:111], v[48:51], a[176:179], v[108:111]
    s_nop 7
    buffer_load_dwordx4 v[48:51], v26, s[4:7], s69 offen offset:192
    s_waitcnt vmcnt(0)
    v_mfma_f32_16x16x32_bf16 v[108:111], v[48:51], a[180:183], v[108:111]
    s_nop 7
    buffer_load_dwordx4 v[48:51], v26, s[4:7], s69 offen offset:256
    s_waitcnt vmcnt(0)
    v_mfma_f32_16x16x32_bf16 v[108:111], v[48:51], a[184:187], v[108:111]
    s_nop 7
    buffer_load_dwordx4 v[48:51], v26, s[4:7], s69 offen offset:320
    s_waitcnt vmcnt(0)
    v_mfma_f32_16x16x32_bf16 v[108:111], v[48:51], a[188:191], v[108:111]
    s_nop 7
    s_nop 15
    v_max3_f32 v14, v104, v105, v106
    v_max3_f32 v14, v14, v107, v108
    v_max3_f32 v14, v14, v109, v110
    v_max_f32 v14, v14, v111
    v_mov_b32 v15, v14
    s_nop 1
    v_permlane32_swap_b32 v15, v14
    v_max_f32 v14, v14, v15
    v_mov_b32 v15, v14
    s_nop 1
    v_permlane16_swap_b32 v15, v14
    v_max_f32 v14, v14, v15
    v_fma_f32 v14, v14, s28, v12
    v_max_f32 v20, 0, v14
    v_sub_f32 v12, v12, v20
    v_sub_f32 v21, 0, v20
    v_exp_f32 v21, v21
    s_nop 0
    v_mul_f32 v47, v47, v21
    v_accvgpr_read_b32 v15, a0
    v_mul_f32 v15, v15, v21
    v_accvgpr_write_b32 a0, v15
    v_accvgpr_read_b32 v15, a1
    v_mul_f32 v15, v15, v21
    v_accvgpr_write_b32 a1, v15
    v_accvgpr_read_b32 v15, a2
    v_mul_f32 v15, v15, v21
    v_accvgpr_write_b32 a2, v15
    v_accvgpr_read_b32 v15, a3
    v_mul_f32 v15, v15, v21
    v_accvgpr_write_b32 a3, v15
    v_accvgpr_read_b32 v15, a4
    v_mul_f32 v15, v15, v21
    v_accvgpr_write_b32 a4, v15
    v_accvgpr_read_b32 v15, a5
    v_mul_f32 v15, v15, v21
    v_accvgpr_write_b32 a5, v15
    v_accvgpr_read_b32 v15, a6
    v_mul_f32 v15, v15, v21
    v_accvgpr_write_b32 a6, v15
    v_accvgpr_read_b32 v15, a7
    v_mul_f32 v15, v15, v21
    v_accvgpr_write_b32 a7, v15
    v_accvgpr_read_b32 v15, a8
    v_mul_f32 v15, v15, v21
    v_accvgpr_write_b32 a8, v15
    v_accvgpr_read_b32 v15, a9
    v_mul_f32 v15, v15, v21
    v_accvgpr_write_b32 a9, v15
    v_accvgpr_read_b32 v15, a10
    v_mul_f32 v15, v15, v21
    v_accvgpr_write_b32 a10, v15
    v_accvgpr_read_b32 v15, a11
    v_mul_f32 v15, v15, v21
    v_accvgpr_write_b32 a11, v15
    v_accvgpr_read_b32 v15, a12
    v_mul_f32 v15, v15, v21
    v_accvgpr_write_b32 a12, v15
    v_accvgpr_read_b32 v15, a13
    v_mul_f32 v15, v15, v21
    v_accvgpr_write_b32 a13, v15
    v_accvgpr_read_b32 v15, a14
    v_mul_f32 v15, v15, v21
    v_accvgpr_write_b32 a14, v15
    v_accvgpr_read_b32 v15, a15
    v_mul_f32 v15, v15, v21
    v_accvgpr_write_b32 a15, v15
    v_accvgpr_read_b32 v15, a16
    v_mul_f32 v15, v15, v21
    v_accvgpr_write_b32 a16, v15
    v_accvgpr_read_b32 v15, a17
    v_mul_f32 v15, v15, v21
    v_accvgpr_write_b32 a17, v15
    v_accvgpr_read_b32 v15, a18
    v_mul_f32 v15, v15, v21
    v_accvgpr_write_b32 a18, v15
    v_accvgpr_read_b32 v15, a19
    v_mul_f32 v15, v15, v21
    v_accvgpr_write_b32 a19, v15
    v_accvgpr_read_b32 v15, a20
    v_mul_f32 v15, v15, v21
    v_accvgpr_write_b32 a20, v15
    v_accvgpr_read_b32 v15, a21
    v_mul_f32 v15, v15, v21
    v_accvgpr_write_b32 a21, v15
    v_accvgpr_read_b32 v15, a22
    v_mul_f32 v15, v15, v21
    v_accvgpr_write_b32 a22, v15
    v_accvgpr_read_b32 v15, a23
    v_mul_f32 v15, v15, v21
    v_accvgpr_write_b32 a23, v15
    v_accvgpr_read_b32 v15, a24
    v_mul_f32 v15, v15, v21
    v_accvgpr_write_b32 a24, v15
    v_accvgpr_read_b32 v15, a25
    v_mul_f32 v15, v15, v21
    v_accvgpr_write_b32 a25, v15
    v_accvgpr_read_b32 v15, a26
    v_mul_f32 v15, v15, v21
    v_accvgpr_write_b32 a26, v15
    v_accvgpr_read_b32 v15, a27
    v_mul_f32 v15, v15, v21
    v_accvgpr_write_b32 a27, v15
    v_accvgpr_read_b32 v15, a28
    v_mul_f32 v15, v15, v21
    v_accvgpr_write_b32 a28, v15
    v_accvgpr_read_b32 v15, a29
    v_mul_f32 v15, v15, v21
    v_accvgpr_write_b32 a29, v15
    v_accvgpr_read_b32 v15, a30
    v_mul_f32 v15, v15, v21
    v_accvgpr_write_b32 a30, v15
    v_accvgpr_read_b32 v15, a31
    v_mul_f32 v15, v15, v21
    v_accvgpr_write_b32 a31, v15
    v_accvgpr_read_b32 v15, a32
    v_mul_f32 v15, v15, v21
    v_accvgpr_write_b32 a32, v15
    v_accvgpr_read_b32 v15, a33
    v_mul_f32 v15, v15, v21
    v_accvgpr_write_b32 a33, v15
    v_accvgpr_read_b32 v15, a34
    v_mul_f32 v15, v15, v21
    v_accvgpr_write_b32 a34, v15
    v_accvgpr_read_b32 v15, a35
    v_mul_f32 v15, v15, v21
    v_accvgpr_write_b32 a35, v15
    v_accvgpr_read_b32 v15, a36
    v_mul_f32 v15, v15, v21
    v_accvgpr_write_b32 a36, v15
    v_accvgpr_read_b32 v15, a37
    v_mul_f32 v15, v15, v21
    v_accvgpr_write_b32 a37, v15
    v_accvgpr_read_b32 v15, a38
    v_mul_f32 v15, v15, v21
    v_accvgpr_write_b32 a38, v15
    v_accvgpr_read_b32 v15, a39
    v_mul_f32 v15, v15, v21
    v_accvgpr_write_b32 a39, v15
    v_accvgpr_read_b32 v15, a40
    v_mul_f32 v15, v15, v21
    v_accvgpr_write_b32 a40, v15
    v_accvgpr_read_b32 v15, a41
    v_mul_f32 v15, v15, v21
    v_accvgpr_write_b32 a41, v15
    v_accvgpr_read_b32 v15, a42
    v_mul_f32 v15, v15, v21
    v_accvgpr_write_b32 a42, v15
    v_accvgpr_read_b32 v15, a43
    v_mul_f32 v15, v15, v21
    v_accvgpr_write_b32 a43, v15
    v_accvgpr_read_b32 v15, a44
    v_mul_f32 v15, v15, v21
    v_accvgpr_write_b32 a44, v15
    v_accvgpr_read_b32 v15, a45
    v_mul_f32 v15, v15, v21
    v_accvgpr_write_b32 a45, v15
    v_accvgpr_read_b32 v15, a46
    v_mul_f32 v15, v15, v21
    v_accvgpr_write_b32 a46, v15
    v_accvgpr_read_b32 v15, a47
    v_mul_f32 v15, v15, v21
    v_accvgpr_write_b32 a47, v15
    v_fma_f32 v104, v104, s28, v12
    v_fma_f32 v105, v105, s28, v12
    v_exp_f32 v104, v104
    v_exp_f32 v105, v105
    s_nop 0
    v_cvt_pk_bf16_f32 v36, v104, v105
    v_fma_f32 v106, v106, s28, v12
    v_fma_f32 v107, v107, s28, v12
    v_exp_f32 v106, v106
    v_exp_f32 v107, v107
    s_nop 0
    v_cvt_pk_bf16_f32 v37, v106, v107
    v_fma_f32 v108, v108, s28, v12
    v_fma_f32 v109, v109, s28, v12
    v_exp_f32 v108, v108
    v_exp_f32 v109, v109
    s_nop 0
    v_cvt_pk_bf16_f32 v34, v108, v109
    v_fma_f32 v110, v110, s28, v12
    v_fma_f32 v111, v111, s28, v12
    v_exp_f32 v110, v110
    v_exp_f32 v111, v111
    s_nop 0
    v_cvt_pk_bf16_f32 v35, v110, v111
    s_add_u32 s69, s39, 0
    buffer_load_dwordx4 v[48:51], v26, s[4:7], s69 offen offset:0
    s_waitcnt vmcnt(0)
    v_mfma_f32_16x16x32_bf16 v[104:107], v[48:51], a[192:195], 0
    s_nop 7
    buffer_load_dwordx4 v[48:51], v26, s[4:7], s69 offen offset:64
    s_waitcnt vmcnt(0)
    v_mfma_f32_16x16x32_bf16 v[104:107], v[48:51], a[196:199], v[104:107]
    s_nop 7
    buffer_load_dwordx4 v[48:51], v26, s[4:7], s69 offen offset:128
    s_waitcnt vmcnt(0)
    v_mfma_f32_16x16x32_bf16 v[104:107], v[48:51], a[200:203], v[104:107]
    s_nop 7
    buffer_load_dwordx4 v[48:51], v26, s[4:7], s69 offen offset:192
    s_waitcnt vmcnt(0)
    v_mfma_f32_16x16x32_bf16 v[104:107], v[48:51], a[204:207], v[104:107]
    s_nop 7
    buffer_load_dwordx4 v[48:51], v26, s[4:7], s69 offen offset:256
    s_waitcnt vmcnt(0)
    v_mfma_f32_16x16x32_bf16 v[104:107], v[48:51], a[208:211], v[104:107]
    s_nop 7
    buffer_load_dwordx4 v[48:51], v26, s[4:7], s69 offen offset:320
    s_waitcnt vmcnt(0)
    v_mfma_f32_16x16x32_bf16 v[104:107], v[48:51], v[92:95], v[104:107]
    s_nop 7
    s_add_u32 s69, s39, 6144
    buffer_load_dwordx4 v[48:51], v26, s[4:7], s69 offen offset:0
    s_waitcnt vmcnt(0)
    v_mfma_f32_16x16x32_bf16 v[108:111], v[48:51], a[192:195], 0
    s_nop 7
    buffer_load_dwordx4 v[48:51], v26, s[4:7], s69 offen offset:64
    s_waitcnt vmcnt(0)
    v_mfma_f32_16x16x32_bf16 v[108:111], v[48:51], a[196:199], v[108:111]
    s_nop 7
    buffer_load_dwordx4 v[48:51], v26, s[4:7], s69 offen offset:128
    s_waitcnt vmcnt(0)
    v_mfma_f32_16x16x32_bf16 v[108:111], v[48:51], a[200:203], v[108:111]
    s_nop 7
    buffer_load_dwordx4 v[48:51], v26, s[4:7], s69 offen offset:192
    s_waitcnt vmcnt(0)
    v_mfma_f32_16x16x32_bf16 v[108:111], v[48:51], a[204:207], v[108:111]
    s_nop 7
    buffer_load_dwordx4 v[48:51], v26, s[4:7], s69 offen offset:256
    s_waitcnt vmcnt(0)
    v_mfma_f32_16x16x32_bf16 v[108:111], v[48:51], a[208:211], v[108:111]
    s_nop 7
    buffer_load_dwordx4 v[48:51], v26, s[4:7], s69 offen offset:320
    s_waitcnt vmcnt(0)
    v_mfma_f32_16x16x32_bf16 v[108:111], v[48:51], v[92:95], v[108:111]
    s_nop 7
    s_nop 15
    v_max3_f32 v14, v104, v105, v106
    v_max3_f32 v14, v14, v107, v108
    v_max3_f32 v14, v14, v109, v110
    v_max_f32 v14, v14, v111
    v_mov_b32 v15, v14
    s_nop 1
    v_permlane32_swap_b32 v15, v14
    v_max_f32 v14, v14, v15
    v_mov_b32 v15, v14
    s_nop 1
    v_permlane16_swap_b32 v15, v14
    v_max_f32 v14, v14, v15
    v_fma_f32 v14, v14, s28, v13
    v_max_f32 v20, 0, v14
    v_sub_f32 v13, v13, v20
    v_sub_f32 v21, 0, v20
    v_exp_f32 v21, v21
    s_nop 0
    v_mul_f32 v15, v44, v21
    v_cndmask_b32_e64 v44, v44, v15, s[60:61]
    v_accvgpr_read_b32 v15, a48
    v_mul_f32 v15, v15, v21
    v_accvgpr_write_b32 a48, v15
    v_accvgpr_read_b32 v15, a49
    v_mul_f32 v15, v15, v21
    v_accvgpr_write_b32 a49, v15
    v_accvgpr_read_b32 v15, a50
    v_mul_f32 v15, v15, v21
    v_accvgpr_write_b32 a50, v15
    v_accvgpr_read_b32 v15, a51
    v_mul_f32 v15, v15, v21
    v_accvgpr_write_b32 a51, v15
    v_accvgpr_read_b32 v15, a52
    v_mul_f32 v15, v15, v21
    v_accvgpr_write_b32 a52, v15
    v_accvgpr_read_b32 v15, a53
    v_mul_f32 v15, v15, v21
    v_accvgpr_write_b32 a53, v15
    v_accvgpr_read_b32 v15, a54
    v_mul_f32 v15, v15, v21
    v_accvgpr_write_b32 a54, v15
    v_accvgpr_read_b32 v15, a55
    v_mul_f32 v15, v15, v21
    v_accvgpr_write_b32 a55, v15
    v_accvgpr_read_b32 v15, a56
    v_mul_f32 v15, v15, v21
    v_accvgpr_write_b32 a56, v15
    v_accvgpr_read_b32 v15, a57
    v_mul_f32 v15, v15, v21
    v_accvgpr_write_b32 a57, v15
    v_accvgpr_read_b32 v15, a58
    v_mul_f32 v15, v15, v21
    v_accvgpr_write_b32 a58, v15
    v_accvgpr_read_b32 v15, a59
    v_mul_f32 v15, v15, v21
    v_accvgpr_write_b32 a59, v15
    v_accvgpr_read_b32 v15, a60
    v_mul_f32 v15, v15, v21
    v_accvgpr_write_b32 a60, v15
    v_accvgpr_read_b32 v15, a61
    v_mul_f32 v15, v15, v21
    v_accvgpr_write_b32 a61, v15
    v_accvgpr_read_b32 v15, a62
    v_mul_f32 v15, v15, v21
    v_accvgpr_write_b32 a62, v15
    v_accvgpr_read_b32 v15, a63
    v_mul_f32 v15, v15, v21
    v_accvgpr_write_b32 a63, v15
    v_accvgpr_read_b32 v15, a64
    v_mul_f32 v15, v15, v21
    v_accvgpr_write_b32 a64, v15
    v_accvgpr_read_b32 v15, a65
    v_mul_f32 v15, v15, v21
    v_accvgpr_write_b32 a65, v15
    v_accvgpr_read_b32 v15, a66
    v_mul_f32 v15, v15, v21
    v_accvgpr_write_b32 a66, v15
    v_accvgpr_read_b32 v15, a67
    v_mul_f32 v15, v15, v21
    v_accvgpr_write_b32 a67, v15
    v_accvgpr_read_b32 v15, a68
    v_mul_f32 v15, v15, v21
    v_accvgpr_write_b32 a68, v15
    v_accvgpr_read_b32 v15, a69
    v_mul_f32 v15, v15, v21
    v_accvgpr_write_b32 a69, v15
    v_accvgpr_read_b32 v15, a70
    v_mul_f32 v15, v15, v21
    v_accvgpr_write_b32 a70, v15
    v_accvgpr_read_b32 v15, a71
    v_mul_f32 v15, v15, v21
    v_accvgpr_write_b32 a71, v15
    v_accvgpr_read_b32 v15, a72
    v_mul_f32 v15, v15, v21
    v_accvgpr_write_b32 a72, v15
    v_accvgpr_read_b32 v15, a73
    v_mul_f32 v15, v15, v21
    v_accvgpr_write_b32 a73, v15
    v_accvgpr_read_b32 v15, a74
    v_mul_f32 v15, v15, v21
    v_accvgpr_write_b32 a74, v15
    v_accvgpr_read_b32 v15, a75
    v_mul_f32 v15, v15, v21
    v_accvgpr_write_b32 a75, v15
    v_accvgpr_read_b32 v15, a76
    v_mul_f32 v15, v15, v21
    v_accvgpr_write_b32 a76, v15
    v_accvgpr_read_b32 v15, a77
    v_mul_f32 v15, v15, v21
    v_accvgpr_write_b32 a77, v15
    v_accvgpr_read_b32 v15, a78
    v_mul_f32 v15, v15, v21
    v_accvgpr_write_b32 a78, v15
    v_accvgpr_read_b32 v15, a79
    v_mul_f32 v15, v15, v21
    v_accvgpr_write_b32 a79, v15
    v_accvgpr_read_b32 v15, a80
    v_mul_f32 v15, v15, v21
    v_accvgpr_write_b32 a80, v15
    v_accvgpr_read_b32 v15, a81
    v_mul_f32 v15, v15, v21
    v_accvgpr_write_b32 a81, v15
    v_accvgpr_read_b32 v15, a82
    v_mul_f32 v15, v15, v21
    v_accvgpr_write_b32 a82, v15
    v_accvgpr_read_b32 v15, a83
    v_mul_f32 v15, v15, v21
    v_accvgpr_write_b32 a83, v15
    v_accvgpr_read_b32 v15, a84
    v_mul_f32 v15, v15, v21
    v_accvgpr_write_b32 a84, v15
    v_accvgpr_read_b32 v15, a85
    v_mul_f32 v15, v15, v21
    v_accvgpr_write_b32 a85, v15
    v_accvgpr_read_b32 v15, a86
    v_mul_f32 v15, v15, v21
    v_accvgpr_write_b32 a86, v15
    v_accvgpr_read_b32 v15, a87
    v_mul_f32 v15, v15, v21
    v_accvgpr_write_b32 a87, v15
    v_accvgpr_read_b32 v15, a88
    v_mul_f32 v15, v15, v21
    v_accvgpr_write_b32 a88, v15
    v_accvgpr_read_b32 v15, a89
    v_mul_f32 v15, v15, v21
    v_accvgpr_write_b32 a89, v15
    v_accvgpr_read_b32 v15, a90
    v_mul_f32 v15, v15, v21
    v_accvgpr_write_b32 a90, v15
    v_accvgpr_read_b32 v15, a91
    v_mul_f32 v15, v15, v21
    v_accvgpr_write_b32 a91, v15
    v_accvgpr_read_b32 v15, a92
    v_mul_f32 v15, v15, v21
    v_accvgpr_write_b32 a92, v15
    v_accvgpr_read_b32 v15, a93
    v_mul_f32 v15, v15, v21
    v_accvgpr_write_b32 a93, v15
    v_accvgpr_read_b32 v15, a94
    v_mul_f32 v15, v15, v21
    v_accvgpr_write_b32 a94, v15
    v_accvgpr_read_b32 v15, a95
    v_mul_f32 v15, v15, v21
    v_accvgpr_write_b32 a95, v15
    v_fma_f32 v104, v104, s28, v13
    v_fma_f32 v105, v105, s28, v13
    v_exp_f32 v104, v104
    v_exp_f32 v105, v105
    s_nop 0
    v_cvt_pk_bf16_f32 v42, v104, v105
    v_fma_f32 v106, v106, s28, v13
    v_fma_f32 v107, v107, s28, v13
    v_exp_f32 v106, v106
    v_exp_f32 v107, v107
    s_nop 0
    v_cvt_pk_bf16_f32 v43, v106, v107
    v_fma_f32 v108, v108, s28, v13
    v_fma_f32 v109, v109, s28, v13
    v_exp_f32 v108, v108
    v_exp_f32 v109, v109
    s_nop 0
    v_cvt_pk_bf16_f32 v40, v108, v109
    v_fma_f32 v110, v110, s28, v13
    v_fma_f32 v111, v111, s28, v13
    v_exp_f32 v110, v110
    v_exp_f32 v111, v111
    s_nop 0
    v_cvt_pk_bf16_f32 v41, v110, v111
    v_mfma_f32_16x16x32_bf16 v[48:51], a[236:239], v[16:19], v[44:47]
    v_mfma_f32_16x16x32_bf16 v[48:51], a[240:243], v[22:25], v[48:51]
    v_mfma_f32_16x16x32_bf16 v[48:51], a[244:247], v[28:31], v[48:51]
    v_mfma_f32_16x16x32_bf16 v[48:51], a[248:251], v[34:37], v[48:51]
    v_mfma_f32_16x16x32_bf16 v[48:51], a[252:255], v[40:43], v[48:51]
    s_nop 15
    s_setpc_b64 s[40:41]
L_rare4_0:
    s_nop 15
    v_mbcnt_lo_u32_b32 v31, -1, 0
    v_mbcnt_hi_u32_b32 v31, -1, v31
    v_and_b32 v30, 15, v31
    v_mul_u32_u24 v30, 384, v30
    v_lshrrev_b32 v31, 4, v31
    v_lshl_add_u32 v30, v31, 4, v30
    s_add_u32 s69, s39, 0
    buffer_load_dwordx4 v[44:47], v30, s[4:7], s69 offen offset:0
    s_waitcnt vmcnt(0)
    v_mfma_f32_16x16x32_bf16 v[104:107], v[44:47], a[96:99], 0
    s_nop 7
    buffer_load_dwordx4 v[44:47], v30, s[4:7], s69 offen offset:64
    s_waitcnt vmcnt(0)
    v_mfma_f32_16x16x32_bf16 v[104:107], v[44:47], a[100:103], v[104:107]
    s_nop 7
    buffer_load_dwordx4 v[44:47], v30, s[4:7], s69 offen offset:128
    s_waitcnt vmcnt(0)
    v_mfma_f32_16x16x32_bf16 v[104:107], v[44:47], a[104:107], v[104:107]
    s_nop 7
    buffer_load_dwordx4 v[44:47], v30, s[4:7], s69 offen offset:192
    s_waitcnt vmcnt(0)
    v_mfma_f32_16x16x32_bf16 v[104:107], v[44:47], a[108:111], v[104:107]
    s_nop 7
    buffer_load_dwordx4 v[44:47], v30, s[4:7], s69 offen offset:256
    s_waitcnt vmcnt(0)
    v_mfma_f32_16x16x32_bf16 v[104:107], v[44:47], a[112:115], v[104:107]
    s_nop 7
    buffer_load_dwordx4 v[44:47], v30, s[4:7], s69 offen offset:320
    s_waitcnt vmcnt(0)
    v_mfma_f32_16x16x32_bf16 v[104:107], v[44:47], a[116:119], v[104:107]
    s_nop 7
    s_add_u32 s69, s39, 6144
    buffer_load_dwordx4 v[44:47], v30, s[4:7], s69 offen offset:0
    s_waitcnt vmcnt(0)
    v_mfma_f32_16x16x32_bf16 v[108:111], v[44:47], a[96:99], 0
    s_nop 7
    buffer_load_dwordx4 v[44:47], v30, s[4:7], s69 offen offset:64
    s_waitcnt vmcnt(0)
    v_mfma_f32_16x16x32_bf16 v[108:111], v[44:47], a[100:103], v[108:111]
    s_nop 7
    buffer_load_dwordx4 v[44:47], v30, s[4:7], s69 offen offset:128
    s_waitcnt vmcnt(0)
    v_mfma_f32_16x16x32_bf16 v[108:111], v[44:47], a[104:107], v[108:111]
    s_nop 7
    buffer_load_dwordx4 v[44:47], v30, s[4:7], s69 offen offset:192
    s_waitcnt vmcnt(0)
    v_mfma_f32_16x16x32_bf16 v[108:111], v[44:47], a[108:111], v[108:111]
    s_nop 7
    buffer_load_dwordx4 v[44:47], v30, s[4:7], s69 offen offset:256
    s_waitcnt vmcnt(0)
    v_mfma_f32_16x16x32_bf16 v[108:111], v[44:47], a[112:115], v[108:111]
    s_nop 7
    buffer_load_dwordx4 v[44:47], v30, s[4:7], s69 offen offset:320
    s_waitcnt vmcnt(0)
    v_mfma_f32_16x16x32_bf16 v[108:111], v[44:47], a[116:119], v[108:111]
    s_nop 7
    s_nop 15
    v_max3_f32 v18, v104, v105, v106
    v_max3_f32 v18, v18, v107, v108
    v_max3_f32 v18, v18, v109, v110
    v_max_f32 v18, v18, v111
    v_mov_b32 v19, v18
    s_nop 1
    v_permlane32_swap_b32 v19, v18
    v_max_f32 v18, v18, v19
    v_mov_b32 v19, v18
    s_nop 1
    v_permlane16_swap_b32 v19, v18
    v_max_f32 v18, v18, v19
    v_fma_f32 v18, v18, s28, v9
    v_max_f32 v24, 0, v18
    v_sub_f32 v9, v9, v24
    v_sub_f32 v25, 0, v24
    v_exp_f32 v25, v25
    s_nop 0
    v_mul_f32 v19, v48, v25
    v_cndmask_b32_e64 v48, v19, v48, s[60:61]
    v_cndmask_b32_e64 v48, v48, 0, s[46:47]
    v_mul_f32 v112, v112, v25
    v_mul_f32 v113, v113, v25
    v_mul_f32 v114, v114, v25
    v_mul_f32 v115, v115, v25
    v_mul_f32 v116, v116, v25
    v_mul_f32 v117, v117, v25
    v_mul_f32 v118, v118, v25
    v_mul_f32 v119, v119, v25
    v_mul_f32 v120, v120, v25
    v_mul_f32 v121, v121, v25
    v_mul_f32 v122, v122, v25
    v_mul_f32 v123, v123, v25
    v_mul_f32 v124, v124, v25
    v_mul_f32 v125, v125, v25
    v_mul_f32 v126, v126, v25
    v_mul_f32 v127, v127, v25
    v_mul_f32 v128, v128, v25
    v_mul_f32 v129, v129, v25
    v_mul_f32 v130, v130, v25
    v_mul_f32 v131, v131, v25
    v_mul_f32 v132, v132, v25
    v_mul_f32 v133, v133, v25
    v_mul_f32 v134, v134, v25
    v_mul_f32 v135, v135, v25
    v_mul_f32 v136, v136, v25
    v_mul_f32 v137, v137, v25
    v_mul_f32 v138, v138, v25
    v_mul_f32 v139, v139, v25
    v_mul_f32 v140, v140, v25
    v_mul_f32 v141, v141, v25
    v_mul_f32 v142, v142, v25
    v_mul_f32 v143, v143, v25
    v_mul_f32 v144, v144, v25
    v_mul_f32 v145, v145, v25
    v_mul_f32 v146, v146, v25
    v_mul_f32 v147, v147, v25
    v_mul_f32 v148, v148, v25
    v_mul_f32 v149, v149, v25
    v_mul_f32 v150, v150, v25
    v_mul_f32 v151, v151, v25
    v_mul_f32 v152, v152, v25
    v_mul_f32 v153, v153, v25
    v_mul_f32 v154, v154, v25
    v_mul_f32 v155, v155, v25
    v_mul_f32 v156, v156, v25
    v_mul_f32 v157, v157, v25
    v_mul_f32 v158, v158, v25
    v_mul_f32 v159, v159, v25
    v_fma_f32 v104, v104, s28, v9
    v_fma_f32 v105, v105, s28, v9
    v_exp_f32 v104, v104
    v_exp_f32 v105, v105
    s_nop 0
    v_cvt_pk_bf16_f32 v14, v104, v105
    v_fma_f32 v106, v106, s28, v9
    v_fma_f32 v107, v107, s28, v9
    v_exp_f32 v106, v106
    v_exp_f32 v107, v107
    s_nop 0
    v_cvt_pk_bf16_f32 v15, v106, v107
    v_fma_f32 v108, v108, s28, v9
    v_fma_f32 v109, v109, s28, v9
    v_exp_f32 v108, v108
    v_exp_f32 v109, v109
    s_nop 0
    v_cvt_pk_bf16_f32 v16, v108, v109
    v_fma_f32 v110, v110, s28, v9
    v_fma_f32 v111, v111, s28, v9
    v_exp_f32 v110, v110
    v_exp_f32 v111, v111
    s_nop 0
    v_cvt_pk_bf16_f32 v17, v110, v111
    s_add_u32 s69, s39, 0
    buffer_load_dwordx4 v[44:47], v30, s[4:7], s69 offen offset:0
    s_waitcnt vmcnt(0)
    v_mfma_f32_16x16x32_bf16 v[104:107], v[44:47], a[120:123], 0
    s_nop 7
    buffer_load_dwordx4 v[44:47], v30, s[4:7], s69 offen offset:64
    s_waitcnt vmcnt(0)
    v_mfma_f32_16x16x32_bf16 v[104:107], v[44:47], a[124:127], v[104:107]
    s_nop 7
    buffer_load_dwordx4 v[44:47], v30, s[4:7], s69 offen offset:128
    s_waitcnt vmcnt(0)
    v_mfma_f32_16x16x32_bf16 v[104:107], v[44:47], a[128:131], v[104:107]
    s_nop 7
    buffer_load_dwordx4 v[44:47], v30, s[4:7], s69 offen offset:192
    s_waitcnt vmcnt(0)
    v_mfma_f32_16x16x32_bf16 v[104:107], v[44:47], a[132:135], v[104:107]
    s_nop 7
    buffer_load_dwordx4 v[44:47], v30, s[4:7], s69 offen offset:256
    s_waitcnt vmcnt(0)
    v_mfma_f32_16x16x32_bf16 v[104:107], v[44:47], a[136:139], v[104:107]
    s_nop 7
    buffer_load_dwordx4 v[44:47], v30, s[4:7], s69 offen offset:320
    s_waitcnt vmcnt(0)
    v_mfma_f32_16x16x32_bf16 v[104:107], v[44:47], a[140:143], v[104:107]
    s_nop 7
    s_add_u32 s69, s39, 6144
    buffer_load_dwordx4 v[44:47], v30, s[4:7], s69 offen offset:0
    s_waitcnt vmcnt(0)
    v_mfma_f32_16x16x32_bf16 v[108:111], v[44:47], a[120:123], 0
    s_nop 7
    buffer_load_dwordx4 v[44:47], v30, s[4:7], s69 offen offset:64
    s_waitcnt vmcnt(0)
    v_mfma_f32_16x16x32_bf16 v[108:111], v[44:47], a[124:127], v[108:111]
    s_nop 7
    buffer_load_dwordx4 v[44:47], v30, s[4:7], s69 offen offset:128
    s_waitcnt vmcnt(0)
    v_mfma_f32_16x16x32_bf16 v[108:111], v[44:47], a[128:131], v[108:111]
    s_nop 7
    buffer_load_dwordx4 v[44:47], v30, s[4:7], s69 offen offset:192
    s_waitcnt vmcnt(0)
    v_mfma_f32_16x16x32_bf16 v[108:111], v[44:47], a[132:135], v[108:111]
    s_nop 7
    buffer_load_dwordx4 v[44:47], v30, s[4:7], s69 offen offset:256
    s_waitcnt vmcnt(0)
    v_mfma_f32_16x16x32_bf16 v[108:111], v[44:47], a[136:139], v[108:111]
    s_nop 7
    buffer_load_dwordx4 v[44:47], v30, s[4:7], s69 offen offset:320
    s_waitcnt vmcnt(0)
    v_mfma_f32_16x16x32_bf16 v[108:111], v[44:47], a[140:143], v[108:111]
    s_nop 7
    s_nop 15
    v_max3_f32 v18, v104, v105, v106
    v_max3_f32 v18, v18, v107, v108
    v_max3_f32 v18, v18, v109, v110
    v_max_f32 v18, v18, v111
    v_mov_b32 v19, v18
    s_nop 1
    v_permlane32_swap_b32 v19, v18
    v_max_f32 v18, v18, v19
    v_mov_b32 v19, v18
    s_nop 1
    v_permlane16_swap_b32 v19, v18
    v_max_f32 v18, v18, v19
    v_fma_f32 v18, v18, s28, v10
    v_max_f32 v24, 0, v18
    v_sub_f32 v10, v10, v24
    v_sub_f32 v25, 0, v24
    v_exp_f32 v25, v25
    s_nop 0
    v_mul_f32 v49, v49, v25
    v_mul_f32 v160, v160, v25
    v_mul_f32 v161, v161, v25
    v_mul_f32 v162, v162, v25
    v_mul_f32 v163, v163, v25
    v_mul_f32 v164, v164, v25
    v_mul_f32 v165, v165, v25
    v_mul_f32 v166, v166, v25
    v_mul_f32 v167, v167, v25
    v_mul_f32 v168, v168, v25
    v_mul_f32 v169, v169, v25
    v_mul_f32 v170, v170, v25
    v_mul_f32 v171, v171, v25
    v_mul_f32 v172, v172, v25
    v_mul_f32 v173, v173, v25
    v_mul_f32 v174, v174, v25
    v_mul_f32 v175, v175, v25
    v_mul_f32 v176, v176, v25
    v_mul_f32 v177, v177, v25
    v_mul_f32 v178, v178, v25
    v_mul_f32 v179, v179, v25
    v_mul_f32 v180, v180, v25
    v_mul_f32 v181, v181, v25
    v_mul_f32 v182, v182, v25
    v_mul_f32 v183, v183, v25
    v_mul_f32 v184, v184, v25
    v_mul_f32 v185, v185, v25
    v_mul_f32 v186, v186, v25
    v_mul_f32 v187, v187, v25
    v_mul_f32 v188, v188, v25
    v_mul_f32 v189, v189, v25
    v_mul_f32 v190, v190, v25
    v_mul_f32 v191, v191, v25
    v_mul_f32 v192, v192, v25
    v_mul_f32 v193, v193, v25
    v_mul_f32 v194, v194, v25
    v_mul_f32 v195, v195, v25
    v_mul_f32 v196, v196, v25
    v_mul_f32 v197, v197, v25
    v_mul_f32 v198, v198, v25
    v_mul_f32 v199, v199, v25
    v_mul_f32 v200, v200, v25
    v_mul_f32 v201, v201, v25
    v_mul_f32 v202, v202, v25
    v_mul_f32 v203, v203, v25
    v_mul_f32 v204, v204, v25
    v_mul_f32 v205, v205, v25
    v_mul_f32 v206, v206, v25
    v_mul_f32 v207, v207, v25
    v_fma_f32 v104, v104, s28, v10
    v_fma_f32 v105, v105, s28, v10
    v_exp_f32 v104, v104
    v_exp_f32 v105, v105
    s_nop 0
    v_cvt_pk_bf16_f32 v20, v104, v105
    v_fma_f32 v106, v106, s28, v10
    v_fma_f32 v107, v107, s28, v10
    v_exp_f32 v106, v106
    v_exp_f32 v107, v107
    s_nop 0
    v_cvt_pk_bf16_f32 v21, v106, v107
    v_fma_f32 v108, v108, s28, v10
    v_fma_f32 v109, v109, s28, v10
    v_exp_f32 v108, v108
    v_exp_f32 v109, v109
    s_nop 0
    v_cvt_pk_bf16_f32 v22, v108, v109
    v_fma_f32 v110, v110, s28, v10
    v_fma_f32 v111, v111, s28, v10
    v_exp_f32 v110, v110
    v_exp_f32 v111, v111
    s_nop 0
    v_cvt_pk_bf16_f32 v23, v110, v111
    s_add_u32 s69, s39, 0
    buffer_load_dwordx4 v[44:47], v30, s[4:7], s69 offen offset:0
    s_waitcnt vmcnt(0)
    v_mfma_f32_16x16x32_bf16 v[104:107], v[44:47], a[144:147], 0
    s_nop 7
    buffer_load_dwordx4 v[44:47], v30, s[4:7], s69 offen offset:64
    s_waitcnt vmcnt(0)
    v_mfma_f32_16x16x32_bf16 v[104:107], v[44:47], a[148:151], v[104:107]
    s_nop 7
    buffer_load_dwordx4 v[44:47], v30, s[4:7], s69 offen offset:128
    s_waitcnt vmcnt(0)
    v_mfma_f32_16x16x32_bf16 v[104:107], v[44:47], a[152:155], v[104:107]
    s_nop 7
    buffer_load_dwordx4 v[44:47], v30, s[4:7], s69 offen offset:192
    s_waitcnt vmcnt(0)
    v_mfma_f32_16x16x32_bf16 v[104:107], v[44:47], a[156:159], v[104:107]
    s_nop 7
    buffer_load_dwordx4 v[44:47], v30, s[4:7], s69 offen offset:256
    s_waitcnt vmcnt(0)
    v_mfma_f32_16x16x32_bf16 v[104:107], v[44:47], a[160:163], v[104:107]
    s_nop 7
    buffer_load_dwordx4 v[44:47], v30, s[4:7], s69 offen offset:320
    s_waitcnt vmcnt(0)
    v_mfma_f32_16x16x32_bf16 v[104:107], v[44:47], a[164:167], v[104:107]
    s_nop 7
    s_add_u32 s69, s39, 6144
    buffer_load_dwordx4 v[44:47], v30, s[4:7], s69 offen offset:0
    s_waitcnt vmcnt(0)
    v_mfma_f32_16x16x32_bf16 v[108:111], v[44:47], a[144:147], 0
    s_nop 7
    buffer_load_dwordx4 v[44:47], v30, s[4:7], s69 offen offset:64
    s_waitcnt vmcnt(0)
    v_mfma_f32_16x16x32_bf16 v[108:111], v[44:47], a[148:151], v[108:111]
    s_nop 7
    buffer_load_dwordx4 v[44:47], v30, s[4:7], s69 offen offset:128
    s_waitcnt vmcnt(0)
    v_mfma_f32_16x16x32_bf16 v[108:111], v[44:47], a[152:155], v[108:111]
    s_nop 7
    buffer_load_dwordx4 v[44:47], v30, s[4:7], s69 offen offset:192
    s_waitcnt vmcnt(0)
    v_mfma_f32_16x16x32_bf16 v[108:111], v[44:47], a[156:159], v[108:111]
    s_nop 7
    buffer_load_dwordx4 v[44:47], v30, s[4:7], s69 offen offset:256
    s_waitcnt vmcnt(0)
    v_mfma_f32_16x16x32_bf16 v[108:111], v[44:47], a[160:163], v[108:111]
    s_nop 7
    buffer_load_dwordx4 v[44:47], v30, s[4:7], s69 offen offset:320
    s_waitcnt vmcnt(0)
    v_mfma_f32_16x16x32_bf16 v[108:111], v[44:47], a[164:167], v[108:111]
    s_nop 7
    s_nop 15
    v_max3_f32 v18, v104, v105, v106
    v_max3_f32 v18, v18, v107, v108
    v_max3_f32 v18, v18, v109, v110
    v_max_f32 v18, v18, v111
    v_mov_b32 v19, v18
    s_nop 1
    v_permlane32_swap_b32 v19, v18
    v_max_f32 v18, v18, v19
    v_mov_b32 v19, v18
    s_nop 1
    v_permlane16_swap_b32 v19, v18
    v_max_f32 v18, v18, v19
    v_fma_f32 v18, v18, s28, v11
    v_max_f32 v24, 0, v18
    v_sub_f32 v11, v11, v24
    v_sub_f32 v25, 0, v24
    v_exp_f32 v25, v25
    s_nop 0
    v_mul_f32 v50, v50, v25
    v_mul_f32 v208, v208, v25
    v_mul_f32 v209, v209, v25
    v_mul_f32 v210, v210, v25
    v_mul_f32 v211, v211, v25
    v_mul_f32 v212, v212, v25
    v_mul_f32 v213, v213, v25
    v_mul_f32 v214, v214, v25
    v_mul_f32 v215, v215, v25
    v_mul_f32 v216, v216, v25
    v_mul_f32 v217, v217, v25
    v_mul_f32 v218, v218, v25
    v_mul_f32 v219, v219, v25
    v_mul_f32 v220, v220, v25
    v_mul_f32 v221, v221, v25
    v_mul_f32 v222, v222, v25
    v_mul_f32 v223, v223, v25
    v_mul_f32 v224, v224, v25
    v_mul_f32 v225, v225, v25
    v_mul_f32 v226, v226, v25
    v_mul_f32 v227, v227, v25
    v_mul_f32 v228, v228, v25
    v_mul_f32 v229, v229, v25
    v_mul_f32 v230, v230, v25
    v_mul_f32 v231, v231, v25
    v_mul_f32 v232, v232, v25
    v_mul_f32 v233, v233, v25
    v_mul_f32 v234, v234, v25
    v_mul_f32 v235, v235, v25
    v_mul_f32 v236, v236, v25
    v_mul_f32 v237, v237, v25
    v_mul_f32 v238, v238, v25
    v_mul_f32 v239, v239, v25
    v_mul_f32 v240, v240, v25
    v_mul_f32 v241, v241, v25
    v_mul_f32 v242, v242, v25
    v_mul_f32 v243, v243, v25
    v_mul_f32 v244, v244, v25
    v_mul_f32 v245, v245, v25
    v_mul_f32 v246, v246, v25
    v_mul_f32 v247, v247, v25
    v_mul_f32 v248, v248, v25
    v_mul_f32 v249, v249, v25
    v_mul_f32 v250, v250, v25
    v_mul_f32 v251, v251, v25
    v_mul_f32 v252, v252, v25
    v_mul_f32 v253, v253, v25
    v_mul_f32 v254, v254, v25
    v_mul_f32 v255, v255, v25
    v_fma_f32 v104, v104, s28, v11
    v_fma_f32 v105, v105, s28, v11
    v_exp_f32 v104, v104
    v_exp_f32 v105, v105
    s_nop 0
    v_cvt_pk_bf16_f32 v26, v104, v105
    v_fma_f32 v106, v106, s28, v11
    v_fma_f32 v107, v107, s28, v11
    v_exp_f32 v106, v106
    v_exp_f32 v107, v107
    s_nop 0
    v_cvt_pk_bf16_f32 v27, v106, v107
    v_fma_f32 v108, v108, s28, v11
    v_fma_f32 v109, v109, s28, v11
    v_exp_f32 v108, v108
    v_exp_f32 v109, v109
    s_nop 0
    v_cvt_pk_bf16_f32 v28, v108, v109
    v_fma_f32 v110, v110, s28, v11
    v_fma_f32 v111, v111, s28, v11
    v_exp_f32 v110, v110
    v_exp_f32 v111, v111
    s_nop 0
    v_cvt_pk_bf16_f32 v29, v110, v111
    s_add_u32 s69, s39, 0
    buffer_load_dwordx4 v[44:47], v30, s[4:7], s69 offen offset:0
    s_waitcnt vmcnt(0)
    v_mfma_f32_16x16x32_bf16 v[104:107], v[44:47], a[168:171], 0
    s_nop 7
    buffer_load_dwordx4 v[44:47], v30, s[4:7], s69 offen offset:64
    s_waitcnt vmcnt(0)
    v_mfma_f32_16x16x32_bf16 v[104:107], v[44:47], a[172:175], v[104:107]
    s_nop 7
    buffer_load_dwordx4 v[44:47], v30, s[4:7], s69 offen offset:128
    s_waitcnt vmcnt(0)
    v_mfma_f32_16x16x32_bf16 v[104:107], v[44:47], a[176:179], v[104:107]
    s_nop 7
    buffer_load_dwordx4 v[44:47], v30, s[4:7], s69 offen offset:192
    s_waitcnt vmcnt(0)
    v_mfma_f32_16x16x32_bf16 v[104:107], v[44:47], a[180:183], v[104:107]
    s_nop 7
    buffer_load_dwordx4 v[44:47], v30, s[4:7], s69 offen offset:256
    s_waitcnt vmcnt(0)
    v_mfma_f32_16x16x32_bf16 v[104:107], v[44:47], a[184:187], v[104:107]
    s_nop 7
    buffer_load_dwordx4 v[44:47], v30, s[4:7], s69 offen offset:320
    s_waitcnt vmcnt(0)
    v_mfma_f32_16x16x32_bf16 v[104:107], v[44:47], a[188:191], v[104:107]
    s_nop 7
    s_add_u32 s69, s39, 6144
    buffer_load_dwordx4 v[44:47], v30, s[4:7], s69 offen offset:0
    s_waitcnt vmcnt(0)
    v_mfma_f32_16x16x32_bf16 v[108:111], v[44:47], a[168:171], 0
    s_nop 7
    buffer_load_dwordx4 v[44:47], v30, s[4:7], s69 offen offset:64
    s_waitcnt vmcnt(0)
    v_mfma_f32_16x16x32_bf16 v[108:111], v[44:47], a[172:175], v[108:111]
    s_nop 7
    buffer_load_dwordx4 v[44:47], v30, s[4:7], s69 offen offset:128
    s_waitcnt vmcnt(0)
    v_mfma_f32_16x16x32_bf16 v[108:111], v[44:47], a[176:179], v[108:111]
    s_nop 7
    buffer_load_dwordx4 v[44:47], v30, s[4:7], s69 offen offset:192
    s_waitcnt vmcnt(0)
    v_mfma_f32_16x16x32_bf16 v[108:111], v[44:47], a[180:183], v[108:111]
    s_nop 7
    buffer_load_dwordx4 v[44:47], v30, s[4:7], s69 offen offset:256
    s_waitcnt vmcnt(0)
    v_mfma_f32_16x16x32_bf16 v[108:111], v[44:47], a[184:187], v[108:111]
    s_nop 7
    buffer_load_dwordx4 v[44:47], v30, s[4:7], s69 offen offset:320
    s_waitcnt vmcnt(0)
    v_mfma_f32_16x16x32_bf16 v[108:111], v[44:47], a[188:191], v[108:111]
    s_nop 7
    s_nop 15
    v_max3_f32 v18, v104, v105, v106
    v_max3_f32 v18, v18, v107, v108
    v_max3_f32 v18, v18, v109, v110
    v_max_f32 v18, v18, v111
    v_mov_b32 v19, v18
    s_nop 1
    v_permlane32_swap_b32 v19, v18
    v_max_f32 v18, v18, v19
    v_mov_b32 v19, v18
    s_nop 1
    v_permlane16_swap_b32 v19, v18
    v_max_f32 v18, v18, v19
    v_fma_f32 v18, v18, s28, v12
    v_max_f32 v24, 0, v18
    v_sub_f32 v12, v12, v24
    v_sub_f32 v25, 0, v24
    v_exp_f32 v25, v25
    s_nop 0
    v_mul_f32 v51, v51, v25
    v_accvgpr_read_b32 v19, a0
    v_mul_f32 v19, v19, v25
    v_accvgpr_write_b32 a0, v19
    v_accvgpr_read_b32 v19, a1
    v_mul_f32 v19, v19, v25
    v_accvgpr_write_b32 a1, v19
    v_accvgpr_read_b32 v19, a2
    v_mul_f32 v19, v19, v25
    v_accvgpr_write_b32 a2, v19
    v_accvgpr_read_b32 v19, a3
    v_mul_f32 v19, v19, v25
    v_accvgpr_write_b32 a3, v19
    v_accvgpr_read_b32 v19, a4
    v_mul_f32 v19, v19, v25
    v_accvgpr_write_b32 a4, v19
    v_accvgpr_read_b32 v19, a5
    v_mul_f32 v19, v19, v25
    v_accvgpr_write_b32 a5, v19
    v_accvgpr_read_b32 v19, a6
    v_mul_f32 v19, v19, v25
    v_accvgpr_write_b32 a6, v19
    v_accvgpr_read_b32 v19, a7
    v_mul_f32 v19, v19, v25
    v_accvgpr_write_b32 a7, v19
    v_accvgpr_read_b32 v19, a8
    v_mul_f32 v19, v19, v25
    v_accvgpr_write_b32 a8, v19
    v_accvgpr_read_b32 v19, a9
    v_mul_f32 v19, v19, v25
    v_accvgpr_write_b32 a9, v19
    v_accvgpr_read_b32 v19, a10
    v_mul_f32 v19, v19, v25
    v_accvgpr_write_b32 a10, v19
    v_accvgpr_read_b32 v19, a11
    v_mul_f32 v19, v19, v25
    v_accvgpr_write_b32 a11, v19
    v_accvgpr_read_b32 v19, a12
    v_mul_f32 v19, v19, v25
    v_accvgpr_write_b32 a12, v19
    v_accvgpr_read_b32 v19, a13
    v_mul_f32 v19, v19, v25
    v_accvgpr_write_b32 a13, v19
    v_accvgpr_read_b32 v19, a14
    v_mul_f32 v19, v19, v25
    v_accvgpr_write_b32 a14, v19
    v_accvgpr_read_b32 v19, a15
    v_mul_f32 v19, v19, v25
    v_accvgpr_write_b32 a15, v19
    v_accvgpr_read_b32 v19, a16
    v_mul_f32 v19, v19, v25
    v_accvgpr_write_b32 a16, v19
    v_accvgpr_read_b32 v19, a17
    v_mul_f32 v19, v19, v25
    v_accvgpr_write_b32 a17, v19
    v_accvgpr_read_b32 v19, a18
    v_mul_f32 v19, v19, v25
    v_accvgpr_write_b32 a18, v19
    v_accvgpr_read_b32 v19, a19
    v_mul_f32 v19, v19, v25
    v_accvgpr_write_b32 a19, v19
    v_accvgpr_read_b32 v19, a20
    v_mul_f32 v19, v19, v25
    v_accvgpr_write_b32 a20, v19
    v_accvgpr_read_b32 v19, a21
    v_mul_f32 v19, v19, v25
    v_accvgpr_write_b32 a21, v19
    v_accvgpr_read_b32 v19, a22
    v_mul_f32 v19, v19, v25
    v_accvgpr_write_b32 a22, v19
    v_accvgpr_read_b32 v19, a23
    v_mul_f32 v19, v19, v25
    v_accvgpr_write_b32 a23, v19
    v_accvgpr_read_b32 v19, a24
    v_mul_f32 v19, v19, v25
    v_accvgpr_write_b32 a24, v19
    v_accvgpr_read_b32 v19, a25
    v_mul_f32 v19, v19, v25
    v_accvgpr_write_b32 a25, v19
    v_accvgpr_read_b32 v19, a26
    v_mul_f32 v19, v19, v25
    v_accvgpr_write_b32 a26, v19
    v_accvgpr_read_b32 v19, a27
    v_mul_f32 v19, v19, v25
    v_accvgpr_write_b32 a27, v19
    v_accvgpr_read_b32 v19, a28
    v_mul_f32 v19, v19, v25
    v_accvgpr_write_b32 a28, v19
    v_accvgpr_read_b32 v19, a29
    v_mul_f32 v19, v19, v25
    v_accvgpr_write_b32 a29, v19
    v_accvgpr_read_b32 v19, a30
    v_mul_f32 v19, v19, v25
    v_accvgpr_write_b32 a30, v19
    v_accvgpr_read_b32 v19, a31
    v_mul_f32 v19, v19, v25
    v_accvgpr_write_b32 a31, v19
    v_accvgpr_read_b32 v19, a32
    v_mul_f32 v19, v19, v25
    v_accvgpr_write_b32 a32, v19
    v_accvgpr_read_b32 v19, a33
    v_mul_f32 v19, v19, v25
    v_accvgpr_write_b32 a33, v19
    v_accvgpr_read_b32 v19, a34
    v_mul_f32 v19, v19, v25
    v_accvgpr_write_b32 a34, v19
    v_accvgpr_read_b32 v19, a35
    v_mul_f32 v19, v19, v25
    v_accvgpr_write_b32 a35, v19
    v_accvgpr_read_b32 v19, a36
    v_mul_f32 v19, v19, v25
    v_accvgpr_write_b32 a36, v19
    v_accvgpr_read_b32 v19, a37
    v_mul_f32 v19, v19, v25
    v_accvgpr_write_b32 a37, v19
    v_accvgpr_read_b32 v19, a38
    v_mul_f32 v19, v19, v25
    v_accvgpr_write_b32 a38, v19
    v_accvgpr_read_b32 v19, a39
    v_mul_f32 v19, v19, v25
    v_accvgpr_write_b32 a39, v19
    v_accvgpr_read_b32 v19, a40
    v_mul_f32 v19, v19, v25
    v_accvgpr_write_b32 a40, v19
    v_accvgpr_read_b32 v19, a41
    v_mul_f32 v19, v19, v25
    v_accvgpr_write_b32 a41, v19
    v_accvgpr_read_b32 v19, a42
    v_mul_f32 v19, v19, v25
    v_accvgpr_write_b32 a42, v19
    v_accvgpr_read_b32 v19, a43
    v_mul_f32 v19, v19, v25
    v_accvgpr_write_b32 a43, v19
    v_accvgpr_read_b32 v19, a44
    v_mul_f32 v19, v19, v25
    v_accvgpr_write_b32 a44, v19
    v_accvgpr_read_b32 v19, a45
    v_mul_f32 v19, v19, v25
    v_accvgpr_write_b32 a45, v19
    v_accvgpr_read_b32 v19, a46
    v_mul_f32 v19, v19, v25
    v_accvgpr_write_b32 a46, v19
    v_accvgpr_read_b32 v19, a47
    v_mul_f32 v19, v19, v25
    v_accvgpr_write_b32 a47, v19
    v_fma_f32 v104, v104, s28, v12
    v_fma_f32 v105, v105, s28, v12
    v_exp_f32 v104, v104
    v_exp_f32 v105, v105
    s_nop 0
    v_cvt_pk_bf16_f32 v32, v104, v105
    v_fma_f32 v106, v106, s28, v12
    v_fma_f32 v107, v107, s28, v12
    v_exp_f32 v106, v106
    v_exp_f32 v107, v107
    s_nop 0
    v_cvt_pk_bf16_f32 v33, v106, v107
    v_fma_f32 v108, v108, s28, v12
    v_fma_f32 v109, v109, s28, v12
    v_exp_f32 v108, v108
    v_exp_f32 v109, v109
    s_nop 0
    v_cvt_pk_bf16_f32 v34, v108, v109
    v_fma_f32 v110, v110, s28, v12
    v_fma_f32 v111, v111, s28, v12
    v_exp_f32 v110, v110
    v_exp_f32 v111, v111
    s_nop 0
    v_cvt_pk_bf16_f32 v35, v110, v111
    v_mfma_f32_16x16x32_bf16 v[44:47], a[236:239], v[14:17], v[48:51]
    v_mfma_f32_16x16x32_bf16 v[44:47], a[240:243], v[20:23], v[44:47]
    v_mfma_f32_16x16x32_bf16 v[44:47], a[244:247], v[26:29], v[44:47]
    v_mfma_f32_16x16x32_bf16 v[44:47], a[248:251], v[32:35], v[44:47]
    s_nop 15
    s_setpc_b64 s[40:41]
L_rare4_1:
    s_nop 15
    v_mbcnt_lo_u32_b32 v27, -1, 0
    v_mbcnt_hi_u32_b32 v27, -1, v27
    v_and_b32 v26, 15, v27
    v_mul_u32_u24 v26, 384, v26
    v_lshrrev_b32 v27, 4, v27
    v_lshl_add_u32 v26, v27, 4, v26
    s_add_u32 s69, s39, 0
    buffer_load_dwordx4 v[48:51], v26, s[4:7], s69 offen offset:0
    s_waitcnt vmcnt(0)
    v_mfma_f32_16x16x32_bf16 v[104:107], v[48:51], a[96:99], 0
    s_nop 7
    buffer_load_dwordx4 v[48:51], v26, s[4:7], s69 offen offset:64
    s_waitcnt vmcnt(0)
    v_mfma_f32_16x16x32_bf16 v[104:107], v[48:51], a[100:103], v[104:107]
    s_nop 7
    buffer_load_dwordx4 v[48:51], v26, s[4:7], s69 offen offset:128
    s_waitcnt vmcnt(0)
    v_mfma_f32_16x16x32_bf16 v[104:107], v[48:51], a[104:107], v[104:107]
    s_nop 7
    buffer_load_dwordx4 v[48:51], v26, s[4:7], s69 offen offset:192
    s_waitcnt vmcnt(0)
    v_mfma_f32_16x16x32_bf16 v[104:107], v[48:51], a[108:111], v[104:107]
    s_nop 7
    buffer_load_dwordx4 v[48:51], v26, s[4:7], s69 offen offset:256
    s_waitcnt vmcnt(0)
    v_mfma_f32_16x16x32_bf16 v[104:107], v[48:51], a[112:115], v[104:107]
    s_nop 7
    buffer_load_dwordx4 v[48:51], v26, s[4:7], s69 offen offset:320
    s_waitcnt vmcnt(0)
    v_mfma_f32_16x16x32_bf16 v[104:107], v[48:51], a[116:119], v[104:107]
    s_nop 7
    s_add_u32 s69, s39, 6144
    buffer_load_dwordx4 v[48:51], v26, s[4:7], s69 offen offset:0
    s_waitcnt vmcnt(0)
    v_mfma_f32_16x16x32_bf16 v[108:111], v[48:51], a[96:99], 0
    s_nop 7
    buffer_load_dwordx4 v[48:51], v26, s[4:7], s69 offen offset:64
    s_waitcnt vmcnt(0)
    v_mfma_f32_16x16x32_bf16 v[108:111], v[48:51], a[100:103], v[108:111]
    s_nop 7
    buffer_load_dwordx4 v[48:51], v26, s[4:7], s69 offen offset:128
    s_waitcnt vmcnt(0)
    v_mfma_f32_16x16x32_bf16 v[108:111], v[48:51], a[104:107], v[108:111]
    s_nop 7
    buffer_load_dwordx4 v[48:51], v26, s[4:7], s69 offen offset:192
    s_waitcnt vmcnt(0)
    v_mfma_f32_16x16x32_bf16 v[108:111], v[48:51], a[108:111], v[108:111]
    s_nop 7
    buffer_load_dwordx4 v[48:51], v26, s[4:7], s69 offen offset:256
    s_waitcnt vmcnt(0)
    v_mfma_f32_16x16x32_bf16 v[108:111], v[48:51], a[112:115], v[108:111]
    s_nop 7
    buffer_load_dwordx4 v[48:51], v26, s[4:7], s69 offen offset:320
    s_waitcnt vmcnt(0)
    v_mfma_f32_16x16x32_bf16 v[108:111], v[48:51], a[116:119], v[108:111]
    s_nop 7
    s_nop 15
    v_max3_f32 v14, v104, v105, v106
    v_max3_f32 v14, v14, v107, v108
    v_max3_f32 v14, v14, v109, v110
    v_max_f32 v14, v14, v111
    v_mov_b32 v15, v14
    s_nop 1
    v_permlane32_swap_b32 v15, v14
    v_max_f32 v14, v14, v15
    v_mov_b32 v15, v14
    s_nop 1
    v_permlane16_swap_b32 v15, v14
    v_max_f32 v14, v14, v15
    v_fma_f32 v14, v14, s28, v9
    v_max_f32 v20, 0, v14
    v_sub_f32 v9, v9, v20
    v_sub_f32 v21, 0, v20
    v_exp_f32 v21, v21
    s_nop 0
    v_mul_f32 v15, v44, v21
    v_cndmask_b32_e64 v44, v15, v44, s[60:61]
    v_cndmask_b32_e64 v44, v44, 0, s[46:47]
    v_mul_f32 v112, v112, v21
    v_mul_f32 v113, v113, v21
    v_mul_f32 v114, v114, v21
    v_mul_f32 v115, v115, v21
    v_mul_f32 v116, v116, v21
    v_mul_f32 v117, v117, v21
    v_mul_f32 v118, v118, v21
    v_mul_f32 v119, v119, v21
    v_mul_f32 v120, v120, v21
    v_mul_f32 v121, v121, v21
    v_mul_f32 v122, v122, v21
    v_mul_f32 v123, v123, v21
    v_mul_f32 v124, v124, v21
    v_mul_f32 v125, v125, v21
    v_mul_f32 v126, v126, v21
    v_mul_f32 v127, v127, v21
    v_mul_f32 v128, v128, v21
    v_mul_f32 v129, v129, v21
    v_mul_f32 v130, v130, v21
    v_mul_f32 v131, v131, v21
    v_mul_f32 v132, v132, v21
    v_mul_f32 v133, v133, v21
    v_mul_f32 v134, v134, v21
    v_mul_f32 v135, v135, v21
    v_mul_f32 v136, v136, v21
    v_mul_f32 v137, v137, v21
    v_mul_f32 v138, v138, v21
    v_mul_f32 v139, v139, v21
    v_mul_f32 v140, v140, v21
    v_mul_f32 v141, v141, v21
    v_mul_f32 v142, v142, v21
    v_mul_f32 v143, v143, v21
    v_mul_f32 v144, v144, v21
    v_mul_f32 v145, v145, v21
    v_mul_f32 v146, v146, v21
    v_mul_f32 v147, v147, v21
    v_mul_f32 v148, v148, v21
    v_mul_f32 v149, v149, v21
    v_mul_f32 v150, v150, v21
    v_mul_f32 v151, v151, v21
    v_mul_f32 v152, v152, v21
    v_mul_f32 v153, v153, v21
    v_mul_f32 v154, v154, v21
    v_mul_f32 v155, v155, v21
    v_mul_f32 v156, v156, v21
    v_mul_f32 v157, v157, v21
    v_mul_f32 v158, v158, v21
    v_mul_f32 v159, v159, v21
    v_fma_f32 v104, v104, s28, v9
    v_fma_f32 v105, v105, s28, v9
    v_exp_f32 v104, v104
    v_exp_f32 v105, v105
    s_nop 0
    v_cvt_pk_bf16_f32 v18, v104, v105
    v_fma_f32 v106, v106, s28, v9
    v_fma_f32 v107, v107, s28, v9
    v_exp_f32 v106, v106
    v_exp_f32 v107, v107
    s_nop 0
    v_cvt_pk_bf16_f32 v19, v106, v107
    v_fma_f32 v108, v108, s28, v9
    v_fma_f32 v109, v109, s28, v9
    v_exp_f32 v108, v108
    v_exp_f32 v109, v109
    s_nop 0
    v_cvt_pk_bf16_f32 v16, v108, v109
    v_fma_f32 v110, v110, s28, v9
    v_fma_f32 v111, v111, s28, v9
    v_exp_f32 v110, v110
    v_exp_f32 v111, v111
    s_nop 0
    v_cvt_pk_bf16_f32 v17, v110, v111
    s_add_u32 s69, s39, 0
    buffer_load_dwordx4 v[48:51], v26, s[4:7], s69 offen offset:0
    s_waitcnt vmcnt(0)
    v_mfma_f32_16x16x32_bf16 v[104:107], v[48:51], a[120:123], 0
    s_nop 7
    buffer_load_dwordx4 v[48:51], v26, s[4:7], s69 offen offset:64
    s_waitcnt vmcnt(0)
    v_mfma_f32_16x16x32_bf16 v[104:107], v[48:51], a[124:127], v[104:107]
    s_nop 7
    buffer_load_dwordx4 v[48:51], v26, s[4:7], s69 offen offset:128
    s_waitcnt vmcnt(0)
    v_mfma_f32_16x16x32_bf16 v[104:107], v[48:51], a[128:131], v[104:107]
    s_nop 7
    buffer_load_dwordx4 v[48:51], v26, s[4:7], s69 offen offset:192
    s_waitcnt vmcnt(0)
    v_mfma_f32_16x16x32_bf16 v[104:107], v[48:51], a[132:135], v[104:107]
    s_nop 7
    buffer_load_dwordx4 v[48:51], v26, s[4:7], s69 offen offset:256
    s_waitcnt vmcnt(0)
    v_mfma_f32_16x16x32_bf16 v[104:107], v[48:51], a[136:139], v[104:107]
    s_nop 7
    buffer_load_dwordx4 v[48:51], v26, s[4:7], s69 offen offset:320
    s_waitcnt vmcnt(0)
    v_mfma_f32_16x16x32_bf16 v[104:107], v[48:51], a[140:143], v[104:107]
    s_nop 7
    s_add_u32 s69, s39, 6144
    buffer_load_dwordx4 v[48:51], v26, s[4:7], s69 offen offset:0
    s_waitcnt vmcnt(0)
    v_mfma_f32_16x16x32_bf16 v[108:111], v[48:51], a[120:123], 0
    s_nop 7
    buffer_load_dwordx4 v[48:51], v26, s[4:7], s69 offen offset:64
    s_waitcnt vmcnt(0)
    v_mfma_f32_16x16x32_bf16 v[108:111], v[48:51], a[124:127], v[108:111]
    s_nop 7
    buffer_load_dwordx4 v[48:51], v26, s[4:7], s69 offen offset:128
    s_waitcnt vmcnt(0)
    v_mfma_f32_16x16x32_bf16 v[108:111], v[48:51], a[128:131], v[108:111]
    s_nop 7
    buffer_load_dwordx4 v[48:51], v26, s[4:7], s69 offen offset:192
    s_waitcnt vmcnt(0)
    v_mfma_f32_16x16x32_bf16 v[108:111], v[48:51], a[132:135], v[108:111]
    s_nop 7
    buffer_load_dwordx4 v[48:51], v26, s[4:7], s69 offen offset:256
    s_waitcnt vmcnt(0)
    v_mfma_f32_16x16x32_bf16 v[108:111], v[48:51], a[136:139], v[108:111]
    s_nop 7
    buffer_load_dwordx4 v[48:51], v26, s[4:7], s69 offen offset:320
    s_waitcnt vmcnt(0)
    v_mfma_f32_16x16x32_bf16 v[108:111], v[48:51], a[140:143], v[108:111]
    s_nop 7
    s_nop 15
    v_max3_f32 v14, v104, v105, v106
    v_max3_f32 v14, v14, v107, v108
    v_max3_f32 v14, v14, v109, v110
    v_max_f32 v14, v14, v111
    v_mov_b32 v15, v14
    s_nop 1
    v_permlane32_swap_b32 v15, v14
    v_max_f32 v14, v14, v15
    v_mov_b32 v15, v14
    s_nop 1
    v_permlane16_swap_b32 v15, v14
    v_max_f32 v14, v14, v15
    v_fma_f32 v14, v14, s28, v10
    v_max_f32 v20, 0, v14
    v_sub_f32 v10, v10, v20
    v_sub_f32 v21, 0, v20
    v_exp_f32 v21, v21
    s_nop 0
    v_mul_f32 v45, v45, v21
    v_mul_f32 v160, v160, v21
    v_mul_f32 v161, v161, v21
    v_mul_f32 v162, v162, v21
    v_mul_f32 v163, v163, v21
    v_mul_f32 v164, v164, v21
    v_mul_f32 v165, v165, v21
    v_mul_f32 v166, v166, v21
    v_mul_f32 v167, v167, v21
    v_mul_f32 v168, v168, v21
    v_mul_f32 v169, v169, v21
    v_mul_f32 v170, v170, v21
    v_mul_f32 v171, v171, v21
    v_mul_f32 v172, v172, v21
    v_mul_f32 v173, v173, v21
    v_mul_f32 v174, v174, v21
    v_mul_f32 v175, v175, v21
    v_mul_f32 v176, v176, v21
    v_mul_f32 v177, v177, v21
    v_mul_f32 v178, v178, v21
    v_mul_f32 v179, v179, v21
    v_mul_f32 v180, v180, v21
    v_mul_f32 v181, v181, v21
    v_mul_f32 v182, v182, v21
    v_mul_f32 v183, v183, v21
    v_mul_f32 v184, v184, v21
    v_mul_f32 v185, v185, v21
    v_mul_f32 v186, v186, v21
    v_mul_f32 v187, v187, v21
    v_mul_f32 v188, v188, v21
    v_mul_f32 v189, v189, v21
    v_mul_f32 v190, v190, v21
    v_mul_f32 v191, v191, v21
    v_mul_f32 v192, v192, v21
    v_mul_f32 v193, v193, v21
    v_mul_f32 v194, v194, v21
    v_mul_f32 v195, v195, v21
    v_mul_f32 v196, v196, v21
    v_mul_f32 v197, v197, v21
    v_mul_f32 v198, v198, v21
    v_mul_f32 v199, v199, v21
    v_mul_f32 v200, v200, v21
    v_mul_f32 v201, v201, v21
    v_mul_f32 v202, v202, v21
    v_mul_f32 v203, v203, v21
    v_mul_f32 v204, v204, v21
    v_mul_f32 v205, v205, v21
    v_mul_f32 v206, v206, v21
    v_mul_f32 v207, v207, v21
    v_fma_f32 v104, v104, s28, v10
    v_fma_f32 v105, v105, s28, v10
    v_exp_f32 v104, v104
    v_exp_f32 v105, v105
    s_nop 0
    v_cvt_pk_bf16_f32 v24, v104, v105
    v_fma_f32 v106, v106, s28, v10
    v_fma_f32 v107, v107, s28, v10
    v_exp_f32 v106, v106
    v_exp_f32 v107, v107
    s_nop 0
    v_cvt_pk_bf16_f32 v25, v106, v107
    v_fma_f32 v108, v108, s28, v10
    v_fma_f32 v109, v109, s28, v10
    v_exp_f32 v108, v108
    v_exp_f32 v109, v109
    s_nop 0
    v_cvt_pk_bf16_f32 v22, v108, v109
    v_fma_f32 v110, v110, s28, v10
    v_fma_f32 v111, v111, s28, v10
    v_exp_f32 v110, v110
    v_exp_f32 v111, v111
    s_nop 0
    v_cvt_pk_bf16_f32 v23, v110, v111
    s_add_u32 s69, s39, 0
    buffer_load_dwordx4 v[48:51], v26, s[4:7], s69 offen offset:0
    s_waitcnt vmcnt(0)
    v_mfma_f32_16x16x32_bf16 v[104:107], v[48:51], a[144:147], 0
    s_nop 7
    buffer_load_dwordx4 v[48:51], v26, s[4:7], s69 offen offset:64
    s_waitcnt vmcnt(0)
    v_mfma_f32_16x16x32_bf16 v[104:107], v[48:51], a[148:151], v[104:107]
    s_nop 7
    buffer_load_dwordx4 v[48:51], v26, s[4:7], s69 offen offset:128
    s_waitcnt vmcnt(0)
    v_mfma_f32_16x16x32_bf16 v[104:107], v[48:51], a[152:155], v[104:107]
    s_nop 7
    buffer_load_dwordx4 v[48:51], v26, s[4:7], s69 offen offset:192
    s_waitcnt vmcnt(0)
    v_mfma_f32_16x16x32_bf16 v[104:107], v[48:51], a[156:159], v[104:107]
    s_nop 7
    buffer_load_dwordx4 v[48:51], v26, s[4:7], s69 offen offset:256
    s_waitcnt vmcnt(0)
    v_mfma_f32_16x16x32_bf16 v[104:107], v[48:51], a[160:163], v[104:107]
    s_nop 7
    buffer_load_dwordx4 v[48:51], v26, s[4:7], s69 offen offset:320
    s_waitcnt vmcnt(0)
    v_mfma_f32_16x16x32_bf16 v[104:107], v[48:51], a[164:167], v[104:107]
    s_nop 7
    s_add_u32 s69, s39, 6144
    buffer_load_dwordx4 v[48:51], v26, s[4:7], s69 offen offset:0
    s_waitcnt vmcnt(0)
    v_mfma_f32_16x16x32_bf16 v[108:111], v[48:51], a[144:147], 0
    s_nop 7
    buffer_load_dwordx4 v[48:51], v26, s[4:7], s69 offen offset:64
    s_waitcnt vmcnt(0)
    v_mfma_f32_16x16x32_bf16 v[108:111], v[48:51], a[148:151], v[108:111]
    s_nop 7
    buffer_load_dwordx4 v[48:51], v26, s[4:7], s69 offen offset:128
    s_waitcnt vmcnt(0)
    v_mfma_f32_16x16x32_bf16 v[108:111], v[48:51], a[152:155], v[108:111]
    s_nop 7
    buffer_load_dwordx4 v[48:51], v26, s[4:7], s69 offen offset:192
    s_waitcnt vmcnt(0)
    v_mfma_f32_16x16x32_bf16 v[108:111], v[48:51], a[156:159], v[108:111]
    s_nop 7
    buffer_load_dwordx4 v[48:51], v26, s[4:7], s69 offen offset:256
    s_waitcnt vmcnt(0)
    v_mfma_f32_16x16x32_bf16 v[108:111], v[48:51], a[160:163], v[108:111]
    s_nop 7
    buffer_load_dwordx4 v[48:51], v26, s[4:7], s69 offen offset:320
    s_waitcnt vmcnt(0)
    v_mfma_f32_16x16x32_bf16 v[108:111], v[48:51], a[164:167], v[108:111]
    s_nop 7
    s_nop 15
    v_max3_f32 v14, v104, v105, v106
    v_max3_f32 v14, v14, v107, v108
    v_max3_f32 v14, v14, v109, v110
    v_max_f32 v14, v14, v111
    v_mov_b32 v15, v14
    s_nop 1
    v_permlane32_swap_b32 v15, v14
    v_max_f32 v14, v14, v15
    v_mov_b32 v15, v14
    s_nop 1
    v_permlane16_swap_b32 v15, v14
    v_max_f32 v14, v14, v15
    v_fma_f32 v14, v14, s28, v11
    v_max_f32 v20, 0, v14
    v_sub_f32 v11, v11, v20
    v_sub_f32 v21, 0, v20
    v_exp_f32 v21, v21
    s_nop 0
    v_mul_f32 v46, v46, v21
    v_mul_f32 v208, v208, v21
    v_mul_f32 v209, v209, v21
    v_mul_f32 v210, v210, v21
    v_mul_f32 v211, v211, v21
    v_mul_f32 v212, v212, v21
    v_mul_f32 v213, v213, v21
    v_mul_f32 v214, v214, v21
    v_mul_f32 v215, v215, v21
    v_mul_f32 v216, v216, v21
    v_mul_f32 v217, v217, v21
    v_mul_f32 v218, v218, v21
    v_mul_f32 v219, v219, v21
    v_mul_f32 v220, v220, v21
    v_mul_f32 v221, v221, v21
    v_mul_f32 v222, v222, v21
    v_mul_f32 v223, v223, v21
    v_mul_f32 v224, v224, v21
    v_mul_f32 v225, v225, v21
    v_mul_f32 v226, v226, v21
    v_mul_f32 v227, v227, v21
    v_mul_f32 v228, v228, v21
    v_mul_f32 v229, v229, v21
    v_mul_f32 v230, v230, v21
    v_mul_f32 v231, v231, v21
    v_mul_f32 v232, v232, v21
    v_mul_f32 v233, v233, v21
    v_mul_f32 v234, v234, v21
    v_mul_f32 v235, v235, v21
    v_mul_f32 v236, v236, v21
    v_mul_f32 v237, v237, v21
    v_mul_f32 v238, v238, v21
    v_mul_f32 v239, v239, v21
    v_mul_f32 v240, v240, v21
    v_mul_f32 v241, v241, v21
    v_mul_f32 v242, v242, v21
    v_mul_f32 v243, v243, v21
    v_mul_f32 v244, v244, v21
    v_mul_f32 v245, v245, v21
    v_mul_f32 v246, v246, v21
    v_mul_f32 v247, v247, v21
    v_mul_f32 v248, v248, v21
    v_mul_f32 v249, v249, v21
    v_mul_f32 v250, v250, v21
    v_mul_f32 v251, v251, v21
    v_mul_f32 v252, v252, v21
    v_mul_f32 v253, v253, v21
    v_mul_f32 v254, v254, v21
    v_mul_f32 v255, v255, v21
    v_fma_f32 v104, v104, s28, v11
    v_fma_f32 v105, v105, s28, v11
    v_exp_f32 v104, v104
    v_exp_f32 v105, v105
    s_nop 0
    v_cvt_pk_bf16_f32 v30, v104, v105
    v_fma_f32 v106, v106, s28, v11
    v_fma_f32 v107, v107, s28, v11
    v_exp_f32 v106, v106
    v_exp_f32 v107, v107
    s_nop 0
    v_cvt_pk_bf16_f32 v31, v106, v107
    v_fma_f32 v108, v108, s28, v11
    v_fma_f32 v109, v109, s28, v11
    v_exp_f32 v108, v108
    v_exp_f32 v109, v109
    s_nop 0
    v_cvt_pk_bf16_f32 v28, v108, v109
    v_fma_f32 v110, v110, s28, v11
    v_fma_f32 v111, v111, s28, v11
    v_exp_f32 v110, v110
    v_exp_f32 v111, v111
    s_nop 0
    v_cvt_pk_bf16_f32 v29, v110, v111
    s_add_u32 s69, s39, 0
    buffer_load_dwordx4 v[48:51], v26, s[4:7], s69 offen offset:0
    s_waitcnt vmcnt(0)
    v_mfma_f32_16x16x32_bf16 v[104:107], v[48:51], a[168:171], 0
    s_nop 7
    buffer_load_dwordx4 v[48:51], v26, s[4:7], s69 offen offset:64
    s_waitcnt vmcnt(0)
    v_mfma_f32_16x16x32_bf16 v[104:107], v[48:51], a[172:175], v[104:107]
    s_nop 7
    buffer_load_dwordx4 v[48:51], v26, s[4:7], s69 offen offset:128
    s_waitcnt vmcnt(0)
    v_mfma_f32_16x16x32_bf16 v[104:107], v[48:51], a[176:179], v[104:107]
    s_nop 7
    buffer_load_dwordx4 v[48:51], v26, s[4:7], s69 offen offset:192
    s_waitcnt vmcnt(0)
    v_mfma_f32_16x16x32_bf16 v[104:107], v[48:51], a[180:183], v[104:107]
    s_nop 7
    buffer_load_dwordx4 v[48:51], v26, s[4:7], s69 offen offset:256
    s_waitcnt vmcnt(0)
    v_mfma_f32_16x16x32_bf16 v[104:107], v[48:51], a[184:187], v[104:107]
    s_nop 7
    buffer_load_dwordx4 v[48:51], v26, s[4:7], s69 offen offset:320
    s_waitcnt vmcnt(0)
    v_mfma_f32_16x16x32_bf16 v[104:107], v[48:51], a[188:191], v[104:107]
    s_nop 7
    s_add_u32 s69, s39, 6144
    buffer_load_dwordx4 v[48:51], v26, s[4:7], s69 offen offset:0
    s_waitcnt vmcnt(0)
    v_mfma_f32_16x16x32_bf16 v[108:111], v[48:51], a[168:171], 0
    s_nop 7
    buffer_load_dwordx4 v[48:51], v26, s[4:7], s69 offen offset:64
    s_waitcnt vmcnt(0)
    v_mfma_f32_16x16x32_bf16 v[108:111], v[48:51], a[172:175], v[108:111]
    s_nop 7
    buffer_load_dwordx4 v[48:51], v26, s[4:7], s69 offen offset:128
    s_waitcnt vmcnt(0)
    v_mfma_f32_16x16x32_bf16 v[108:111], v[48:51], a[176:179], v[108:111]
    s_nop 7
    buffer_load_dwordx4 v[48:51], v26, s[4:7], s69 offen offset:192
    s_waitcnt vmcnt(0)
    v_mfma_f32_16x16x32_bf16 v[108:111], v[48:51], a[180:183], v[108:111]
    s_nop 7
    buffer_load_dwordx4 v[48:51], v26, s[4:7], s69 offen offset:256
    s_waitcnt vmcnt(0)
    v_mfma_f32_16x16x32_bf16 v[108:111], v[48:51], a[184:187], v[108:111]
    s_nop 7
    buffer_load_dwordx4 v[48:51], v26, s[4:7], s69 offen offset:320
    s_waitcnt vmcnt(0)
    v_mfma_f32_16x16x32_bf16 v[108:111], v[48:51], a[188:191], v[108:111]
    s_nop 7
    s_nop 15
    v_max3_f32 v14, v104, v105, v106
    v_max3_f32 v14, v14, v107, v108
    v_max3_f32 v14, v14, v109, v110
    v_max_f32 v14, v14, v111
    v_mov_b32 v15, v14
    s_nop 1
    v_permlane32_swap_b32 v15, v14
    v_max_f32 v14, v14, v15
    v_mov_b32 v15, v14
    s_nop 1
    v_permlane16_swap_b32 v15, v14
    v_max_f32 v14, v14, v15
    v_fma_f32 v14, v14, s28, v12
    v_max_f32 v20, 0, v14
    v_sub_f32 v12, v12, v20
    v_sub_f32 v21, 0, v20
    v_exp_f32 v21, v21
    s_nop 0
    v_mul_f32 v47, v47, v21
    v_accvgpr_read_b32 v15, a0
    v_mul_f32 v15, v15, v21
    v_accvgpr_write_b32 a0, v15
    v_accvgpr_read_b32 v15, a1
    v_mul_f32 v15, v15, v21
    v_accvgpr_write_b32 a1, v15
    v_accvgpr_read_b32 v15, a2
    v_mul_f32 v15, v15, v21
    v_accvgpr_write_b32 a2, v15
    v_accvgpr_read_b32 v15, a3
    v_mul_f32 v15, v15, v21
    v_accvgpr_write_b32 a3, v15
    v_accvgpr_read_b32 v15, a4
    v_mul_f32 v15, v15, v21
    v_accvgpr_write_b32 a4, v15
    v_accvgpr_read_b32 v15, a5
    v_mul_f32 v15, v15, v21
    v_accvgpr_write_b32 a5, v15
    v_accvgpr_read_b32 v15, a6
    v_mul_f32 v15, v15, v21
    v_accvgpr_write_b32 a6, v15
    v_accvgpr_read_b32 v15, a7
    v_mul_f32 v15, v15, v21
    v_accvgpr_write_b32 a7, v15
    v_accvgpr_read_b32 v15, a8
    v_mul_f32 v15, v15, v21
    v_accvgpr_write_b32 a8, v15
    v_accvgpr_read_b32 v15, a9
    v_mul_f32 v15, v15, v21
    v_accvgpr_write_b32 a9, v15
    v_accvgpr_read_b32 v15, a10
    v_mul_f32 v15, v15, v21
    v_accvgpr_write_b32 a10, v15
    v_accvgpr_read_b32 v15, a11
    v_mul_f32 v15, v15, v21
    v_accvgpr_write_b32 a11, v15
    v_accvgpr_read_b32 v15, a12
    v_mul_f32 v15, v15, v21
    v_accvgpr_write_b32 a12, v15
    v_accvgpr_read_b32 v15, a13
    v_mul_f32 v15, v15, v21
    v_accvgpr_write_b32 a13, v15
    v_accvgpr_read_b32 v15, a14
    v_mul_f32 v15, v15, v21
    v_accvgpr_write_b32 a14, v15
    v_accvgpr_read_b32 v15, a15
    v_mul_f32 v15, v15, v21
    v_accvgpr_write_b32 a15, v15
    v_accvgpr_read_b32 v15, a16
    v_mul_f32 v15, v15, v21
    v_accvgpr_write_b32 a16, v15
    v_accvgpr_read_b32 v15, a17
    v_mul_f32 v15, v15, v21
    v_accvgpr_write_b32 a17, v15
    v_accvgpr_read_b32 v15, a18
    v_mul_f32 v15, v15, v21
    v_accvgpr_write_b32 a18, v15
    v_accvgpr_read_b32 v15, a19
    v_mul_f32 v15, v15, v21
    v_accvgpr_write_b32 a19, v15
    v_accvgpr_read_b32 v15, a20
    v_mul_f32 v15, v15, v21
    v_accvgpr_write_b32 a20, v15
    v_accvgpr_read_b32 v15, a21
    v_mul_f32 v15, v15, v21
    v_accvgpr_write_b32 a21, v15
    v_accvgpr_read_b32 v15, a22
    v_mul_f32 v15, v15, v21
    v_accvgpr_write_b32 a22, v15
    v_accvgpr_read_b32 v15, a23
    v_mul_f32 v15, v15, v21
    v_accvgpr_write_b32 a23, v15
    v_accvgpr_read_b32 v15, a24
    v_mul_f32 v15, v15, v21
    v_accvgpr_write_b32 a24, v15
    v_accvgpr_read_b32 v15, a25
    v_mul_f32 v15, v15, v21
    v_accvgpr_write_b32 a25, v15
    v_accvgpr_read_b32 v15, a26
    v_mul_f32 v15, v15, v21
    v_accvgpr_write_b32 a26, v15
    v_accvgpr_read_b32 v15, a27
    v_mul_f32 v15, v15, v21
    v_accvgpr_write_b32 a27, v15
    v_accvgpr_read_b32 v15, a28
    v_mul_f32 v15, v15, v21
    v_accvgpr_write_b32 a28, v15
    v_accvgpr_read_b32 v15, a29
    v_mul_f32 v15, v15, v21
    v_accvgpr_write_b32 a29, v15
    v_accvgpr_read_b32 v15, a30
    v_mul_f32 v15, v15, v21
    v_accvgpr_write_b32 a30, v15
    v_accvgpr_read_b32 v15, a31
    v_mul_f32 v15, v15, v21
    v_accvgpr_write_b32 a31, v15
    v_accvgpr_read_b32 v15, a32
    v_mul_f32 v15, v15, v21
    v_accvgpr_write_b32 a32, v15
    v_accvgpr_read_b32 v15, a33
    v_mul_f32 v15, v15, v21
    v_accvgpr_write_b32 a33, v15
    v_accvgpr_read_b32 v15, a34
    v_mul_f32 v15, v15, v21
    v_accvgpr_write_b32 a34, v15
    v_accvgpr_read_b32 v15, a35
    v_mul_f32 v15, v15, v21
    v_accvgpr_write_b32 a35, v15
    v_accvgpr_read_b32 v15, a36
    v_mul_f32 v15, v15, v21
    v_accvgpr_write_b32 a36, v15
    v_accvgpr_read_b32 v15, a37
    v_mul_f32 v15, v15, v21
    v_accvgpr_write_b32 a37, v15
    v_accvgpr_read_b32 v15, a38
    v_mul_f32 v15, v15, v21
    v_accvgpr_write_b32 a38, v15
    v_accvgpr_read_b32 v15, a39
    v_mul_f32 v15, v15, v21
    v_accvgpr_write_b32 a39, v15
    v_accvgpr_read_b32 v15, a40
    v_mul_f32 v15, v15, v21
    v_accvgpr_write_b32 a40, v15
    v_accvgpr_read_b32 v15, a41
    v_mul_f32 v15, v15, v21
    v_accvgpr_write_b32 a41, v15
    v_accvgpr_read_b32 v15, a42
    v_mul_f32 v15, v15, v21
    v_accvgpr_write_b32 a42, v15
    v_accvgpr_read_b32 v15, a43
    v_mul_f32 v15, v15, v21
    v_accvgpr_write_b32 a43, v15
    v_accvgpr_read_b32 v15, a44
    v_mul_f32 v15, v15, v21
    v_accvgpr_write_b32 a44, v15
    v_accvgpr_read_b32 v15, a45
    v_mul_f32 v15, v15, v21
    v_accvgpr_write_b32 a45, v15
    v_accvgpr_read_b32 v15, a46
    v_mul_f32 v15, v15, v21
    v_accvgpr_write_b32 a46, v15
    v_accvgpr_read_b32 v15, a47
    v_mul_f32 v15, v15, v21
    v_accvgpr_write_b32 a47, v15
    v_fma_f32 v104, v104, s28, v12
    v_fma_f32 v105, v105, s28, v12
    v_exp_f32 v104, v104
    v_exp_f32 v105, v105
    s_nop 0
    v_cvt_pk_bf16_f32 v36, v104, v105
    v_fma_f32 v106, v106, s28, v12
    v_fma_f32 v107, v107, s28, v12
    v_exp_f32 v106, v106
    v_exp_f32 v107, v107
    s_nop 0
    v_cvt_pk_bf16_f32 v37, v106, v107
    v_fma_f32 v108, v108, s28, v12
    v_fma_f32 v109, v109, s28, v12
    v_exp_f32 v108, v108
    v_exp_f32 v109, v109
    s_nop 0
    v_cvt_pk_bf16_f32 v34, v108, v109
    v_fma_f32 v110, v110, s28, v12
    v_fma_f32 v111, v111, s28, v12
    v_exp_f32 v110, v110
    v_exp_f32 v111, v111
    s_nop 0
    v_cvt_pk_bf16_f32 v35, v110, v111
    v_mfma_f32_16x16x32_bf16 v[48:51], a[236:239], v[16:19], v[44:47]
    v_mfma_f32_16x16x32_bf16 v[48:51], a[240:243], v[22:25], v[48:51]
    v_mfma_f32_16x16x32_bf16 v[48:51], a[244:247], v[28:31], v[48:51]
    v_mfma_f32_16x16x32_bf16 v[48:51], a[248:251], v[34:37], v[48:51]
    s_nop 15
    s_setpc_b64 s[40:41]
L_rs_start5b:
    s_call_b64 s[40:41], L_rare5_1
    s_branch L_ret_start5b
L_rs_loop5w0a:
    s_call_b64 s[40:41], L_rare5_0
    s_branch L_ret_loop5w0a
L_rs_loop5w0b:
    s_call_b64 s[40:41], L_rare5_1
    s_branch L_ret_loop5w0b
L_rs_end5a:
    s_call_b64 s[40:41], L_rare5_0
    s_branch L_ret_end5a
L_rs_end5b:
    s_call_b64 s[40:41], L_rare5_1
    s_branch L_ret_end5b
L_rs_start4b:
    s_call_b64 s[40:41], L_rare4_1
    s_branch L_ret_start4b
L_rs_loop4w0a:
    s_call_b64 s[40:41], L_rare4_0
    s_branch L_ret_loop4w0a
L_rs_loop4w0b:
    s_call_b64 s[40:41], L_rare4_1
    s_branch L_ret_loop4w0b
L_rs_end4a:
    s_call_b64 s[40:41], L_rare4_0
    s_branch L_ret_end4a
L_rs_end4b:
    s_call_b64 s[40:41], L_rare4_1
    s_branch L_ret_end4b
L_rs_tr54a:
    s_call_b64 s[40:41], L_rare5_0
    s_branch L_ret_tr54a
L_rs_tr54b:
    s_nop 15
    s_waitcnt vmcnt(0) lgkmcnt(0)
    s_mov_b32 s68, s14
    s_mov_b32 s14, 166723584
    v_mbcnt_lo_u32_b32 v105, -1, 0
    v_mbcnt_hi_u32_b32 v105, -1, v105
    v_and_b32 v104, 15, v105
    v_mul_u32_u24 v104, 384, v104
    v_lshrrev_b32 v105, 4, v105
    v_lshl_add_u32 v104, v105, 4, v104
    s_add_u32 s69, s34, 0
    buffer_load_dwordx4 a[96:99], v104, s[12:15], s69 offen offset:0
    buffer_load_dwordx4 a[100:103], v104, s[12:15], s69 offen offset:64
    buffer_load_dwordx4 a[104:107], v104, s[12:15], s69 offen offset:128
    buffer_load_dwordx4 a[108:111], v104, s[12:15], s69 offen offset:192
    buffer_load_dwordx4 a[112:115], v104, s[12:15], s69 offen offset:256
    buffer_load_dwordx4 a[116:119], v104, s[12:15], s69 offen offset:320
    s_add_u32 s69, s34, 6144
    buffer_load_dwordx4 a[120:123], v104, s[12:15], s69 offen offset:0
    buffer_load_dwordx4 a[124:127], v104, s[12:15], s69 offen offset:64
    buffer_load_dwordx4 a[128:131], v104, s[12:15], s69 offen offset:128
    buffer_load_dwordx4 a[132:135], v104, s[12:15], s69 offen offset:192
    buffer_load_dwordx4 a[136:139], v104, s[12:15], s69 offen offset:256
    buffer_load_dwordx4 a[140:143], v104, s[12:15], s69 offen offset:320
    s_add_u32 s69, s34, 12288
    buffer_load_dwordx4 a[144:147], v104, s[12:15], s69 offen offset:0
    buffer_load_dwordx4 a[148:151], v104, s[12:15], s69 offen offset:64
    buffer_load_dwordx4 a[152:155], v104, s[12:15], s69 offen offset:128
    buffer_load_dwordx4 a[156:159], v104, s[12:15], s69 offen offset:192
    buffer_load_dwordx4 a[160:163], v104, s[12:15], s69 offen offset:256
    buffer_load_dwordx4 a[164:167], v104, s[12:15], s69 offen offset:320
    s_add_u32 s69, s34, 18432
    buffer_load_dwordx4 a[168:171], v104, s[12:15], s69 offen offset:0
    buffer_load_dwordx4 a[172:175], v104, s[12:15], s69 offen offset:64
    buffer_load_dwordx4 a[176:179], v104, s[12:15], s69 offen offset:128
    buffer_load_dwordx4 a[180:183], v104, s[12:15], s69 offen offset:192
    buffer_load_dwordx4 a[184:187], v104, s[12:15], s69 offen offset:256
    buffer_load_dwordx4 a[188:191], v104, s[12:15], s69 offen offset:320
    s_add_u32 s69, s34, 24576
    buffer_load_dwordx4 a[192:195], v104, s[12:15], s69 offen offset:0
    buffer_load_dwordx4 a[196:199], v104, s[12:15], s69 offen offset:64
    buffer_load_dwordx4 a[200:203], v104, s[12:15], s69 offen offset:128
    buffer_load_dwordx4 a[204:207], v104, s[12:15], s69 offen offset:192
    buffer_load_dwordx4 a[208:211], v104, s[12:15], s69 offen offset:256
    buffer_load_dwordx4 v[92:95], v104, s[12:15], s69 offen offset:320
    s_waitcnt vmcnt(0)
    s_call_b64 s[40:41], L_rare5_1
    v_mbcnt_lo_u32_b32 v105, -1, 0
    v_mbcnt_hi_u32_b32 v105, -1, v105
    v_and_b32 v104, 15, v105
    v_mul_u32_u24 v104, 384, v104
    v_lshrrev_b32 v105, 4, v105
    v_lshl_add_u32 v104, v105, 4, v104
    s_add_u32 s69, s33, 0
    buffer_load_dwordx4 a[96:99], v104, s[12:15], s69 offen offset:0
    buffer_load_dwordx4 a[100:103], v104, s[12:15], s69 offen offset:64
    buffer_load_dwordx4 a[104:107], v104, s[12:15], s69 offen offset:128
    buffer_load_dwordx4 a[108:111], v104, s[12:15], s69 offen offset:192
    buffer_load_dwordx4 a[112:115], v104, s[12:15], s69 offen offset:256
    buffer_load_dwordx4 a[116:119], v104, s[12:15], s69 offen offset:320
    s_add_u32 s69, s33, 6144
    buffer_load_dwordx4 a[120:123], v104, s[12:15], s69 offen offset:0
    buffer_load_dwordx4 a[124:127], v104, s[12:15], s69 offen offset:64
    buffer_load_dwordx4 a[128:131], v104, s[12:15], s69 offen offset:128
    buffer_load_dwordx4 a[132:135], v104, s[12:15], s69 offen offset:192
    buffer_load_dwordx4 a[136:139], v104, s[12:15], s69 offen offset:256
    buffer_load_dwordx4 a[140:143], v104, s[12:15], s69 offen offset:320
    s_add_u32 s69, s33, 12288
    buffer_load_dwordx4 a[144:147], v104, s[12:15], s69 offen offset:0
    buffer_load_dwordx4 a[148:151], v104, s[12:15], s69 offen offset:64
    buffer_load_dwordx4 a[152:155], v104, s[12:15], s69 offen offset:128
    buffer_load_dwordx4 a[156:159], v104, s[12:15], s69 offen offset:192
    buffer_load_dwordx4 a[160:163], v104, s[12:15], s69 offen offset:256
    buffer_load_dwordx4 a[164:167], v104, s[12:15], s69 offen offset:320
    s_add_u32 s69, s33, 18432
    buffer_load_dwordx4 a[168:171], v104, s[12:15], s69 offen offset:0
    buffer_load_dwordx4 a[172:175], v104, s[12:15], s69 offen offset:64
    buffer_load_dwordx4 a[176:179], v104, s[12:15], s69 offen offset:128
    buffer_load_dwordx4 a[180:183], v104, s[12:15], s69 offen offset:192
    buffer_load_dwordx4 a[184:187], v104, s[12:15], s69 offen offset:256
    buffer_load_dwordx4 a[188:191], v104, s[12:15], s69 offen offset:320
    s_waitcnt vmcnt(0)
    s_mov_b32 s14, s68
    s_branch L_ret_tr54b
L_rs_tr54d:
    s_call_b64 s[40:41], L_rare4_1
    s_branch L_ret_tr54d
L_rs_tr45a:
    s_call_b64 s[40:41], L_rare4_0
    s_branch L_ret_tr45a
L_rs_tr45b:
    s_nop 15
    s_waitcnt vmcnt(0) lgkmcnt(0)
    s_mov_b32 s68, s14
    s_mov_b32 s14, 166723584
    v_mbcnt_lo_u32_b32 v105, -1, 0
    v_mbcnt_hi_u32_b32 v105, -1, v105
    v_and_b32 v104, 15, v105
    v_mul_u32_u24 v104, 384, v104
    v_lshrrev_b32 v105, 4, v105
    v_lshl_add_u32 v104, v105, 4, v104
    s_add_u32 s69, s34, 0
    buffer_load_dwordx4 a[96:99], v104, s[12:15], s69 offen offset:0
    buffer_load_dwordx4 a[100:103], v104, s[12:15], s69 offen offset:64
    buffer_load_dwordx4 a[104:107], v104, s[12:15], s69 offen offset:128
    buffer_load_dwordx4 a[108:111], v104, s[12:15], s69 offen offset:192
    buffer_load_dwordx4 a[112:115], v104, s[12:15], s69 offen offset:256
    buffer_load_dwordx4 a[116:119], v104, s[12:15], s69 offen offset:320
    s_add_u32 s69, s34, 6144
    buffer_load_dwordx4 a[120:123], v104, s[12:15], s69 offen offset:0
    buffer_load_dwordx4 a[124:127], v104, s[12:15], s69 offen offset:64
    buffer_load_dwordx4 a[128:131], v104, s[12:15], s69 offen offset:128
    buffer_load_dwordx4 a[132:135], v104, s[12:15], s69 offen offset:192
    buffer_load_dwordx4 a[136:139], v104, s[12:15], s69 offen offset:256
    buffer_load_dwordx4 a[140:143], v104, s[12:15], s69 offen offset:320
    s_add_u32 s69, s34, 12288
    buffer_load_dwordx4 a[144:147], v104, s[12:15], s69 offen offset:0
    buffer_load_dwordx4 a[148:151], v104, s[12:15], s69 offen offset:64
    buffer_load_dwordx4 a[152:155], v104, s[12:15], s69 offen offset:128
    buffer_load_dwordx4 a[156:159], v104, s[12:15], s69 offen offset:192
    buffer_load_dwordx4 a[160:163], v104, s[12:15], s69 offen offset:256
    buffer_load_dwordx4 a[164:167], v104, s[12:15], s69 offen offset:320
    s_add_u32 s69, s34, 18432
    buffer_load_dwordx4 a[168:171], v104, s[12:15], s69 offen offset:0
    buffer_load_dwordx4 a[172:175], v104, s[12:15], s69 offen offset:64
    buffer_load_dwordx4 a[176:179], v104, s[12:15], s69 offen offset:128
    buffer_load_dwordx4 a[180:183], v104, s[12:15], s69 offen offset:192
    buffer_load_dwordx4 a[184:187], v104, s[12:15], s69 offen offset:256
    buffer_load_dwordx4 a[188:191], v104, s[12:15], s69 offen offset:320
    s_waitcnt vmcnt(0)
    s_call_b64 s[40:41], L_rare4_1
    v_mbcnt_lo_u32_b32 v105, -1, 0
    v_mbcnt_hi_u32_b32 v105, -1, v105
    v_and_b32 v104, 15, v105
    v_mul_u32_u24 v104, 384, v104
    v_lshrrev_b32 v105, 4, v105
    v_lshl_add_u32 v104, v105, 4, v104
    s_add_u32 s69, s33, 0
    buffer_load_dwordx4 a[96:99], v104, s[12:15], s69 offen offset:0
    buffer_load_dwordx4 a[100:103], v104, s[12:15], s69 offen offset:64
    buffer_load_dwordx4 a[104:107], v104, s[12:15], s69 offen offset:128
    buffer_load_dwordx4 a[108:111], v104, s[12:15], s69 offen offset:192
    buffer_load_dwordx4 a[112:115], v104, s[12:15], s69 offen offset:256
    buffer_load_dwordx4 a[116:119], v104, s[12:15], s69 offen offset:320
    s_add_u32 s69, s33, 6144
    buffer_load_dwordx4 a[120:123], v104, s[12:15], s69 offen offset:0
    buffer_load_dwordx4 a[124:127], v104, s[12:15], s69 offen offset:64
    buffer_load_dwordx4 a[128:131], v104, s[12:15], s69 offen offset:128
    buffer_load_dwordx4 a[132:135], v104, s[12:15], s69 offen offset:192
    buffer_load_dwordx4 a[136:139], v104, s[12:15], s69 offen offset:256
    buffer_load_dwordx4 a[140:143], v104, s[12:15], s69 offen offset:320
    s_add_u32 s69, s33, 12288
    buffer_load_dwordx4 a[144:147], v104, s[12:15], s69 offen offset:0
    buffer_load_dwordx4 a[148:151], v104, s[12:15], s69 offen offset:64
    buffer_load_dwordx4 a[152:155], v104, s[12:15], s69 offen offset:128
    buffer_load_dwordx4 a[156:159], v104, s[12:15], s69 offen offset:192
    buffer_load_dwordx4 a[160:163], v104, s[12:15], s69 offen offset:256
    buffer_load_dwordx4 a[164:167], v104, s[12:15], s69 offen offset:320
    s_add_u32 s69, s33, 18432
    buffer_load_dwordx4 a[168:171], v104, s[12:15], s69 offen offset:0
    buffer_load_dwordx4 a[172:175], v104, s[12:15], s69 offen offset:64
    buffer_load_dwordx4 a[176:179], v104, s[12:15], s69 offen offset:128
    buffer_load_dwordx4 a[180:183], v104, s[12:15], s69 offen offset:192
    buffer_load_dwordx4 a[184:187], v104, s[12:15], s69 offen offset:256
    buffer_load_dwordx4 a[188:191], v104, s[12:15], s69 offen offset:320
    s_add_u32 s69, s33, 24576
    buffer_load_dwordx4 a[192:195], v104, s[12:15], s69 offen offset:0
    buffer_load_dwordx4 a[196:199], v104, s[12:15], s69 offen offset:64
    buffer_load_dwordx4 a[200:203], v104, s[12:15], s69 offen offset:128
    buffer_load_dwordx4 a[204:207], v104, s[12:15], s69 offen offset:192
    buffer_load_dwordx4 a[208:211], v104, s[12:15], s69 offen offset:256
    buffer_load_dwordx4 v[92:95], v104, s[12:15], s69 offen offset:320
    s_waitcnt vmcnt(0)
    s_mov_b32 s14, s68
    s_branch L_ret_tr45b
L_rs_tr45d:
    s_call_b64 s[40:41], L_rare5_1
    s_branch L_ret_tr45d
L_rs_tr44a:
    s_call_b64 s[40:41], L_rare4_0
    s_branch L_ret_tr44a
L_rs_tr44b:
    s_nop 15
    s_waitcnt vmcnt(0) lgkmcnt(0)
    s_mov_b32 s68, s14
    s_mov_b32 s14, 166723584
    v_mbcnt_lo_u32_b32 v105, -1, 0
    v_mbcnt_hi_u32_b32 v105, -1, v105
    v_and_b32 v104, 15, v105
    v_mul_u32_u24 v104, 384, v104
    v_lshrrev_b32 v105, 4, v105
    v_lshl_add_u32 v104, v105, 4, v104
    s_add_u32 s69, s34, 0
    buffer_load_dwordx4 a[96:99], v104, s[12:15], s69 offen offset:0
    buffer_load_dwordx4 a[100:103], v104, s[12:15], s69 offen offset:64
    buffer_load_dwordx4 a[104:107], v104, s[12:15], s69 offen offset:128
    buffer_load_dwordx4 a[108:111], v104, s[12:15], s69 offen offset:192
    buffer_load_dwordx4 a[112:115], v104, s[12:15], s69 offen offset:256
    buffer_load_dwordx4 a[116:119], v104, s[12:15], s69 offen offset:320
    s_add_u32 s69, s34, 6144
    buffer_load_dwordx4 a[120:123], v104, s[12:15], s69 offen offset:0
    buffer_load_dwordx4 a[124:127], v104, s[12:15], s69 offen offset:64
    buffer_load_dwordx4 a[128:131], v104, s[12:15], s69 offen offset:128
    buffer_load_dwordx4 a[132:135], v104, s[12:15], s69 offen offset:192
    buffer_load_dwordx4 a[136:139], v104, s[12:15], s69 offen offset:256
    buffer_load_dwordx4 a[140:143], v104, s[12:15], s69 offen offset:320
    s_add_u32 s69, s34, 12288
    buffer_load_dwordx4 a[144:147], v104, s[12:15], s69 offen offset:0
    buffer_load_dwordx4 a[148:151], v104, s[12:15], s69 offen offset:64
    buffer_load_dwordx4 a[152:155], v104, s[12:15], s69 offen offset:128
    buffer_load_dwordx4 a[156:159], v104, s[12:15], s69 offen offset:192
    buffer_load_dwordx4 a[160:163], v104, s[12:15], s69 offen offset:256
    buffer_load_dwordx4 a[164:167], v104, s[12:15], s69 offen offset:320
    s_add_u32 s69, s34, 18432
    buffer_load_dwordx4 a[168:171], v104, s[12:15], s69 offen offset:0
    buffer_load_dwordx4 a[172:175], v104, s[12:15], s69 offen offset:64
    buffer_load_dwordx4 a[176:179], v104, s[12:15], s69 offen offset:128
    buffer_load_dwordx4 a[180:183], v104, s[12:15], s69 offen offset:192
    buffer_load_dwordx4 a[184:187], v104, s[12:15], s69 offen offset:256
    buffer_load_dwordx4 a[188:191], v104, s[12:15], s69 offen offset:320
    s_waitcnt vmcnt(0)
    s_call_b64 s[40:41], L_rare4_1
    v_mbcnt_lo_u32_b32 v105, -1, 0
    v_mbcnt_hi_u32_b32 v105, -1, v105
    v_and_b32 v104, 15, v105
    v_mul_u32_u24 v104, 384, v104
    v_lshrrev_b32 v105, 4, v105
    v_lshl_add_u32 v104, v105, 4, v104
    s_add_u32 s69, s33, 0
    buffer_load_dwordx4 a[96:99], v104, s[12:15], s69 offen offset:0
    buffer_load_dwordx4 a[100:103], v104, s[12:15], s69 offen offset:64
    buffer_load_dwordx4 a[104:107], v104, s[12:15], s69 offen offset:128
    buffer_load_dwordx4 a[108:111], v104, s[12:15], s69 offen offset:192
    buffer_load_dwordx4 a[112:115], v104, s[12:15], s69 offen offset:256
    buffer_load_dwordx4 a[116:119], v104, s[12:15], s69 offen offset:320
    s_add_u32 s69, s33, 6144
    buffer_load_dwordx4 a[120:123], v104, s[12:15], s69 offen offset:0
    buffer_load_dwordx4 a[124:127], v104, s[12:15], s69 offen offset:64
    buffer_load_dwordx4 a[128:131], v104, s[12:15], s69 offen offset:128
    buffer_load_dwordx4 a[132:135], v104, s[12:15], s69 offen offset:192
    buffer_load_dwordx4 a[136:139], v104, s[12:15], s69 offen offset:256
    buffer_load_dwordx4 a[140:143], v104, s[12:15], s69 offen offset:320
    s_add_u32 s69, s33, 12288
    buffer_load_dwordx4 a[144:147], v104, s[12:15], s69 offen offset:0
    buffer_load_dwordx4 a[148:151], v104, s[12:15], s69 offen offset:64
    buffer_load_dwordx4 a[152:155], v104, s[12:15], s69 offen offset:128
    buffer_load_dwordx4 a[156:159], v104, s[12:15], s69 offen offset:192
    buffer_load_dwordx4 a[160:163], v104, s[12:15], s69 offen offset:256
    buffer_load_dwordx4 a[164:167], v104, s[12:15], s69 offen offset:320
    s_add_u32 s69, s33, 18432
    buffer_load_dwordx4 a[168:171], v104, s[12:15], s69 offen offset:0
    buffer_load_dwordx4 a[172:175], v104, s[12:15], s69 offen offset:64
    buffer_load_dwordx4 a[176:179], v104, s[12:15], s69 offen offset:128
    buffer_load_dwordx4 a[180:183], v104, s[12:15], s69 offen offset:192
    buffer_load_dwordx4 a[184:187], v104, s[12:15], s69 offen offset:256
    buffer_load_dwordx4 a[188:191], v104, s[12:15], s69 offen offset:320
    s_waitcnt vmcnt(0)
    s_mov_b32 s14, s68
    s_branch L_ret_tr44b
L_rs_tr44d:
    s_call_b64 s[40:41], L_rare4_1
    s_branch L_ret_tr44d
L_rs_tr55a:
    s_call_b64 s[40:41], L_rare5_0
    s_branch L_ret_tr55a
L_rs_tr55b:
    s_nop 15
    s_waitcnt vmcnt(0) lgkmcnt(0)
    s_mov_b32 s68, s14
    s_mov_b32 s14, 166723584
    v_mbcnt_lo_u32_b32 v105, -1, 0
    v_mbcnt_hi_u32_b32 v105, -1, v105
    v_and_b32 v104, 15, v105
    v_mul_u32_u24 v104, 384, v104
    v_lshrrev_b32 v105, 4, v105
    v_lshl_add_u32 v104, v105, 4, v104
    s_add_u32 s69, s34, 0
    buffer_load_dwordx4 a[96:99], v104, s[12:15], s69 offen offset:0
    buffer_load_dwordx4 a[100:103], v104, s[12:15], s69 offen offset:64
    buffer_load_dwordx4 a[104:107], v104, s[12:15], s69 offen offset:128
    buffer_load_dwordx4 a[108:111], v104, s[12:15], s69 offen offset:192
    buffer_load_dwordx4 a[112:115], v104, s[12:15], s69 offen offset:256
    buffer_load_dwordx4 a[116:119], v104, s[12:15], s69 offen offset:320
    s_add_u32 s69, s34, 6144
    buffer_load_dwordx4 a[120:123], v104, s[12:15], s69 offen offset:0
    buffer_load_dwordx4 a[124:127], v104, s[12:15], s69 offen offset:64
    buffer_load_dwordx4 a[128:131], v104, s[12:15], s69 offen offset:128
    buffer_load_dwordx4 a[132:135], v104, s[12:15], s69 offen offset:192
    buffer_load_dwordx4 a[136:139], v104, s[12:15], s69 offen offset:256
    buffer_load_dwordx4 a[140:143], v104, s[12:15], s69 offen offset:320
    s_add_u32 s69, s34, 12288
    buffer_load_dwordx4 a[144:147], v104, s[12:15], s69 offen offset:0
    buffer_load_dwordx4 a[148:151], v104, s[12:15], s69 offen offset:64
    buffer_load_dwordx4 a[152:155], v104, s[12:15], s69 offen offset:128
    buffer_load_dwordx4 a[156:159], v104, s[12:15], s69 offen offset:192
    buffer_load_dwordx4 a[160:163], v104, s[12:15], s69 offen offset:256
    buffer_load_dwordx4 a[164:167], v104, s[12:15], s69 offen offset:320
    s_add_u32 s69, s34, 18432
    buffer_load_dwordx4 a[168:171], v104, s[12:15], s69 offen offset:0
    buffer_load_dwordx4 a[172:175], v104, s[12:15], s69 offen offset:64
    buffer_load_dwordx4 a[176:179], v104, s[12:15], s69 offen offset:128
    buffer_load_dwordx4 a[180:183], v104, s[12:15], s69 offen offset:192
    buffer_load_dwordx4 a[184:187], v104, s[12:15], s69 offen offset:256
    buffer_load_dwordx4 a[188:191], v104, s[12:15], s69 offen offset:320
    s_add_u32 s69, s34, 24576
    buffer_load_dwordx4 a[192:195], v104, s[12:15], s69 offen offset:0
    buffer_load_dwordx4 a[196:199], v104, s[12:15], s69 offen offset:64
    buffer_load_dwordx4 a[200:203], v104, s[12:15], s69 offen offset:128
    buffer_load_dwordx4 a[204:207], v104, s[12:15], s69 offen offset:192
    buffer_load_dwordx4 a[208:211], v104, s[12:15], s69 offen offset:256
    buffer_load_dwordx4 v[92:95], v104, s[12:15], s69 offen offset:320
    s_waitcnt vmcnt(0)
    s_call_b64 s[40:41], L_rare5_1
    v_mbcnt_lo_u32_b32 v105, -1, 0
    v_mbcnt_hi_u32_b32 v105, -1, v105
    v_and_b32 v104, 15, v105
    v_mul_u32_u24 v104, 384, v104
    v_lshrrev_b32 v105, 4, v105
    v_lshl_add_u32 v104, v105, 4, v104
    s_add_u32 s69, s33, 0
    buffer_load_dwordx4 a[96:99], v104, s[12:15], s69 offen offset:0
    buffer_load_dwordx4 a[100:103], v104, s[12:15], s69 offen offset:64
    buffer_load_dwordx4 a[104:107], v104, s[12:15], s69 offen offset:128
    buffer_load_dwordx4 a[108:111], v104, s[12:15], s69 offen offset:192
    buffer_load_dwordx4 a[112:115], v104, s[12:15], s69 offen offset:256
    buffer_load_dwordx4 a[116:119], v104, s[12:15], s69 offen offset:320
    s_add_u32 s69, s33, 6144
    buffer_load_dwordx4 a[120:123], v104, s[12:15], s69 offen offset:0
    buffer_load_dwordx4 a[124:127], v104, s[12:15], s69 offen offset:64
    buffer_load_dwordx4 a[128:131], v104, s[12:15], s69 offen offset:128
    buffer_load_dwordx4 a[132:135], v104, s[12:15], s69 offen offset:192
    buffer_load_dwordx4 a[136:139], v104, s[12:15], s69 offen offset:256
    buffer_load_dwordx4 a[140:143], v104, s[12:15], s69 offen offset:320
    s_add_u32 s69, s33, 12288
    buffer_load_dwordx4 a[144:147], v104, s[12:15], s69 offen offset:0
    buffer_load_dwordx4 a[148:151], v104, s[12:15], s69 offen offset:64
    buffer_load_dwordx4 a[152:155], v104, s[12:15], s69 offen offset:128
    buffer_load_dwordx4 a[156:159], v104, s[12:15], s69 offen offset:192
    buffer_load_dwordx4 a[160:163], v104, s[12:15], s69 offen offset:256
    buffer_load_dwordx4 a[164:167], v104, s[12:15], s69 offen offset:320
    s_add_u32 s69, s33, 18432
    buffer_load_dwordx4 a[168:171], v104, s[12:15], s69 offen offset:0
    buffer_load_dwordx4 a[172:175], v104, s[12:15], s69 offen offset:64
    buffer_load_dwordx4 a[176:179], v104, s[12:15], s69 offen offset:128
    buffer_load_dwordx4 a[180:183], v104, s[12:15], s69 offen offset:192
    buffer_load_dwordx4 a[184:187], v104, s[12:15], s69 offen offset:256
    buffer_load_dwordx4 a[188:191], v104, s[12:15], s69 offen offset:320
    s_add_u32 s69, s33, 24576
    buffer_load_dwordx4 a[192:195], v104, s[12:15], s69 offen offset:0
    buffer_load_dwordx4 a[196:199], v104, s[12:15], s69 offen offset:64
    buffer_load_dwordx4 a[200:203], v104, s[12:15], s69 offen offset:128
    buffer_load_dwordx4 a[204:207], v104, s[12:15], s69 offen offset:192
    buffer_load_dwordx4 a[208:211], v104, s[12:15], s69 offen offset:256
    buffer_load_dwordx4 v[92:95], v104, s[12:15], s69 offen offset:320
    s_waitcnt vmcnt(0)
    s_mov_b32 s14, s68
    s_branch L_ret_tr55b
L_rs_tr55d:
    s_call_b64 s[40:41], L_rare5_1
    s_branch L_ret_tr55d
.section .rodata,"a"
.p2align 6
.amdhsa_kernel standalone__gqa_softmax__near_ridge_kernel
  .amdhsa_next_free_vgpr 512
  .amdhsa_next_free_sgpr 102
  .amdhsa_accum_offset 256
  .amdhsa_group_segment_fixed_size 0
  .amdhsa_kernarg_size 48
  .amdhsa_user_sgpr_count 2
  .amdhsa_user_sgpr_kernarg_segment_ptr 1
  .amdhsa_system_sgpr_workgroup_id_x 1
.end_amdhsa_kernel
```

```asm
; @launch grid=(256,1,1) block=(256,1,1) lds=163840
.amdgcn_target "amdgcn-amd-amdhsa--gfx950"
.text
.globl standalone__gqa_softmax__near_ridge_kernel
.p2align 8
.type standalone__gqa_softmax__near_ridge_kernel,@function
standalone__gqa_softmax__near_ridge_kernel:
    s_cmp_ge_u32 s2, 256
    s_cbranch_scc1 L_end
    s_load_dwordx4 s[84:87], s[0:1], 0
    s_load_dwordx4 s[88:91], s[0:1], 16
    v_lshrrev_b32 v110, 6, v0
    v_and_b32 v111, 63, v0
    s_getpc_b64 s[60:61]
L_pc:
    s_lshr_b32 s62, s2, 3
    v_lshl_add_u32 v53, s62, 2, v110
    v_min_u32 v52, ((L_codeend-L_pc+16383)/16384)-1, v111
    v_mul_u32_u24 v53, ((L_codeend-L_pc+16383)/16384), v53
    v_add_lshl_u32 v52, v52, v53, 7
    v_min_u32 v52, L_codeend-L_pc-4, v52
    global_load_dword v53, v52, s[60:61]
    v_readfirstlane_b32 s3, v110
    v_lshrrev_b32 v96, 3, v111
    v_mul_u32_u24 v7, 384, v96
    v_lshrrev_b32 v97, 1, v96
    v_lshlrev_b32 v97, 1, v97
    v_and_b32 v98, 7, v111
    v_xor_b32 v97, v97, v98
    v_lshl_add_u32 v7, v97, 4, v7
    s_and_b32 s65, s3, 1
    s_mul_i32 s42, s65, 80
    s_mul_i32 s43, s65, 3072
    v_xor_b32 v6, s42, v7
    v_xor_b32 v7, 80, v6
    v_add_u32 v6, s43, v6
    s_sub_u32 s43, 3072, s43
    v_add_u32 v7, s43, v7
    s_mov_b32 s28, 0x3dd53b95
    s_mov_b32 s29, 0x4e800000
    s_mov_b32 s49, 5888
    s_mov_b32 s66, 0x28301800
    s_mov_b32 s46, 0
    s_mov_b32 s47, 0xffff0000
    s_and_b32 s42, s2, 7
    s_lshr_b32 s43, s2, 3
    s_mul_i32 s44, s43, 43
    s_lshr_b32 s44, s44, 7
    s_mov_b32 s39, s44
    s_mul_i32 s45, s44, 3
    s_sub_u32 s36, s43, s45
    s_lshl_b32 s42, s42, 6
    s_lshl_b32 s45, s45, 1
    s_add_u32 s42, s42, s45
    s_mul_i32 s64, s42, 196608
    s_mul_i32 s35, s42, 325632
    s_lshr_b32 s42, s44, 1
    s_mov_b32 s31, 0x6900924
    s_cmp_eq_u32 s42, 1
    s_cselect_b32 s31, 0x14a0489, s31
    s_cmp_eq_u32 s42, 2
    s_cselect_b32 s31, 0x8250258, s31
    s_cmp_eq_u32 s42, 3
    s_cselect_b32 s31, 0x8940912, s31
    s_cmp_eq_u32 s42, 4
    s_cselect_b32 s31, 0x1a10606, s31
    s_and_b32 s42, s44, 1
    s_lshl_b32 s42, s42, 4
    s_lshr_b32 s31, s31, s42
    s_and_b32 s31, s31, 0xffff
    s_cmp_eq_u32 s43, 30
    s_cselect_b32 s31, 0x120648, s31
    s_cmp_eq_u32 s43, 31
    s_cselect_b32 s31, 0x240219, s31
    s_lshr_b32 s63, s31, 16
    s_cmp_ge_u32 s43, 30
    s_cselect_b32 s36, 0, s36
    s_cselect_b32 s42, 4, 6
    s_mul_i32 s42, s42, 196608
    s_add_u32 s6, s64, s42
    s_mov_b32 s10, s6
    s_mul_i32 s22, s3, 3072
    s_mul_i32 s38, s3, 28672
    s_add_u32 s38, s38, 49152
    s_and_b32 s42, s3, 2
    s_mul_i32 s42, s42, 3072
    s_add_u32 s20, s64, s42
    s_mov_b32 s21, s20
    s_mov_b32 s14, 166723584
    s_mov_b32 s18, 0
    s_mov_b32 s67, 0
    s_mov_b32 s37, 0
    s_mov_b32 s60, 0
    s_mov_b32 s61, 0xffff
    s_lshl_b32 s42, s37, 1
    s_lshr_b32 s42, s31, s42
    s_and_b32 s42, s42, 3
    s_add_u32 s42, s42, s36
    s_sub_u32 s43, s42, 3
    s_cmp_ge_u32 s42, 3
    s_cselect_b32 s42, s43, s42
    s_mul_i32 s44, s3, 5
    s_mov_b32 s32, 1
    s_lshl_b32 s43, s3, 2
    s_add_u32 s45, s43, 21
    s_cmp_eq_u32 s3, 0
    s_cselect_b32 s45, 20, s45
    s_cselect_b32 s34, 1, 0
    s_cmp_eq_u32 s42, 1
    s_cselect_b32 s44, s45, s44
    s_cselect_b32 s32, s34, s32
    s_add_u32 s45, s43, 37
    s_cmp_eq_u32 s42, 2
    s_cselect_b32 s44, s45, s44
    s_cselect_b32 s32, 0, s32
    s_mul_i32 s44, s44, 6144
    s_add_u32 s34, s35, s44
    s_waitcnt lgkmcnt(0)
    s_mov_b32 s12, s84
    s_and_b32 s13, s85, 0xffff
    s_mov_b32 s15, 0x20000
    s_mov_b32 s4, s86
    s_and_b32 s5, s87, 0xffff
    s_mov_b32 s7, 0x20000
    s_mov_b32 s8, s88
    s_and_b32 s9, s89, 0xffff
    s_mov_b32 s11, 0x20000
    s_mov_b32 s16, s90
    s_and_b32 s17, s91, 0xffff
    s_mov_b32 s19, 0x20000
    s_cmp_eq_u32 s32, 0
    s_cbranch_scc1 L_start4
L_start5:
    s_add_u32 m0, s22, 0
    s_nop 0
    buffer_load_dwordx4 v6, s[4:7], s20 offen lds
    s_add_u32 s20, s20, 128
    s_add_u32 m0, s22, 1024
    s_nop 0
    buffer_load_dwordx4 v6, s[4:7], s20 offen lds
    s_add_u32 s20, s20, 128
    s_add_u32 m0, s22, 2048
    s_nop 0
    buffer_load_dwordx4 v6, s[4:7], s20 offen lds
    s_add_u32 s20, s20, 12032
    s_add_u32 m0, s22, 12288
    s_nop 0
    buffer_load_dwordx4 v6, s[4:7], s20 offen lds
    s_add_u32 s20, s20, 128
    s_add_u32 m0, s22, 13312
    s_nop 0
    buffer_load_dwordx4 v6, s[4:7], s20 offen lds
    s_add_u32 s20, s20, 128
    s_add_u32 m0, s22, 14336
    s_nop 0
    buffer_load_dwordx4 v6, s[4:7], s20 offen lds
    s_add_u32 s20, s20, 12032
    s_add_u32 s48, s34, 0
    s_add_u32 m0, s38, 0
    s_nop 0
    buffer_load_dwordx4 v6, s[12:15], s48 offen nt lds
    s_add_u32 m0, s38, 1024
    s_nop 0
    buffer_load_dwordx4 v7, s[12:15], s48 offen nt lds
    s_add_u32 s48, s34, 128
    s_add_u32 m0, s38, 2048
    s_nop 0
    buffer_load_dwordx4 v6, s[12:15], s48 offen nt lds
    s_add_u32 m0, s38, 3072
    s_nop 0
    buffer_load_dwordx4 v7, s[12:15], s48 offen nt lds
    s_add_u32 s48, s34, 256
    s_add_u32 m0, s38, 4096
    s_nop 0
    buffer_load_dwordx4 v6, s[12:15], s48 offen nt lds
    s_add_u32 m0, s38, 5120
    s_nop 0
    buffer_load_dwordx4 v7, s[12:15], s48 offen nt lds
    s_add_u32 s48, s34, 6144
    s_add_u32 m0, s38, 6144
    s_nop 0
    buffer_load_dwordx4 v6, s[12:15], s48 offen nt lds
    s_add_u32 m0, s38, 7168
    s_nop 0
    buffer_load_dwordx4 v7, s[12:15], s48 offen nt lds
    s_add_u32 s48, s34, 6272
    s_add_u32 m0, s38, 8192
    s_nop 0
    buffer_load_dwordx4 v6, s[12:15], s48 offen nt lds
    s_add_u32 m0, s38, 9216
    s_nop 0
    buffer_load_dwordx4 v7, s[12:15], s48 offen nt lds
    s_add_u32 s48, s34, 6400
    s_add_u32 m0, s38, 10240
    s_nop 0
    buffer_load_dwordx4 v6, s[12:15], s48 offen nt lds
    s_add_u32 m0, s38, 11264
    s_nop 0
    buffer_load_dwordx4 v7, s[12:15], s48 offen nt lds
    s_add_u32 s48, s34, 12288
    s_add_u32 m0, s38, 12288
    s_nop 0
    buffer_load_dwordx4 v6, s[12:15], s48 offen nt lds
    s_add_u32 m0, s38, 13312
    s_nop 0
    buffer_load_dwordx4 v7, s[12:15], s48 offen nt lds
    s_add_u32 s48, s34, 12416
    s_add_u32 m0, s38, 14336
    s_nop 0
    buffer_load_dwordx4 v6, s[12:15], s48 offen nt lds
    s_add_u32 m0, s38, 15360
    s_nop 0
    buffer_load_dwordx4 v7, s[12:15], s48 offen nt lds
    s_add_u32 s48, s34, 12544
    s_add_u32 m0, s38, 16384
    s_nop 0
    buffer_load_dwordx4 v6, s[12:15], s48 offen nt lds
    s_add_u32 m0, s38, 17408
    s_nop 0
    buffer_load_dwordx4 v7, s[12:15], s48 offen nt lds
    v_and_b32 v96, 15, v111
    v_lshrrev_b32 v97, 4, v111
    v_lshrrev_b32 v98, 3, v96
    v_and_b32 v99, 7, v96
    v_lshlrev_b32 v0, 7, v99
    v_bfe_u32 v99, v96, 1, 2
    v_lshlrev_b32 v99, 1, v99
    v_mul_u32_u24 v100, 5, v98
    v_xor_b32 v99, v99, v100
    v_xor_b32 v99, v99, v97
    v_lshl_add_u32 v0, v99, 4, v0
    v_mul_u32_u24 v100, 3072, v98
    v_add_u32 v0, v100, v0
    v_xor_b32 v1, 64, v0
    v_lshrrev_b32 v98, 1, v97
    v_mul_u32_u24 v2, 3072, v98
    v_and_b32 v99, 1, v97
    v_bfe_u32 v100, v111, 2, 2
    v_lshl_add_u32 v96, v99, 2, v100
    v_lshl_add_u32 v2, v96, 7, v2
    v_lshrrev_b32 v96, 1, v96
    v_lshlrev_b32 v96, 1, v96
    v_mul_u32_u24 v98, 5, v98
    v_xor_b32 v96, v96, v98
    v_bfe_u32 v99, v111, 1, 1
    v_xor_b32 v96, v96, v99
    v_lshl_add_u32 v2, v96, 4, v2
    v_and_b32 v99, 1, v111
    v_lshl_add_u32 v2, v99, 3, v2
    v_add_u32 v2, 24576, v2
    v_xor_b32 v3, 32, v2
    v_xor_b32 v4, 64, v2
    v_xor_b32 v5, 96, v2
    v_lshl_add_u32 v103, v111, 4, s38
    v_and_b32 v96, 15, v111
    s_mov_b32 s42, 0x1011
    v_bfe_i32 v97, s42, v96, 1
    v_and_b32 v97, 0x3f803f80, v97
    v_accvgpr_write_b32 a236, v97
    v_accvgpr_write_b32 a237, v97
    v_accvgpr_write_b32 a238, v97
    v_accvgpr_write_b32 a239, v97
    s_mov_b32 s42, 0x3222
    v_bfe_i32 v97, s42, v96, 1
    v_and_b32 v97, 0x3f803f80, v97
    v_accvgpr_write_b32 a240, v97
    v_accvgpr_write_b32 a241, v97
    v_accvgpr_write_b32 a242, v97
    v_accvgpr_write_b32 a243, v97
    s_mov_b32 s42, 0x5444
    v_bfe_i32 v97, s42, v96, 1
    v_and_b32 v97, 0x3f803f80, v97
    v_accvgpr_write_b32 a244, v97
    v_accvgpr_write_b32 a245, v97
    v_accvgpr_write_b32 a246, v97
    v_accvgpr_write_b32 a247, v97
    s_mov_b32 s42, 0x9888
    v_bfe_i32 v97, s42, v96, 1
    v_and_b32 v97, 0x3f803f80, v97
    v_accvgpr_write_b32 a248, v97
    v_accvgpr_write_b32 a249, v97
    v_accvgpr_write_b32 a250, v97
    v_accvgpr_write_b32 a251, v97
    s_mov_b32 s42, 0x1100
    v_bfe_i32 v97, s42, v96, 1
    v_and_b32 v97, 0x3f803f80, v97
    v_accvgpr_write_b32 a252, v97
    v_accvgpr_write_b32 a253, v97
    v_accvgpr_write_b32 a254, v97
    v_accvgpr_write_b32 a255, v97
    s_waitcnt vmcnt(18)
    s_barrier
    s_waitcnt vmcnt(12)
    s_add_u32 s48, s34, 18432
    s_add_u32 m0, s38, 18432
    ds_read_b128 a[212:215], v0 offset:0
    buffer_load_dwordx4 v6, s[12:15], s48 offen nt lds
    v_lshrrev_b32 v105, 11, v0
    s_add_u32 m0, s38, 19456
    s_nop 0
    buffer_load_dwordx4 v7, s[12:15], s48 offen nt lds
    ds_read_b128 a[216:219], v1 offset:0
    ds_read_b128 a[220:223], v0 offset:1024
    s_add_u32 s48, s34, 18560
    v_xor_b32 v105, s65, v105
    s_add_u32 m0, s38, 20480
    v_and_b32 v104, 0x3ff, v0
    buffer_load_dwordx4 v6, s[12:15], s48 offen nt lds
    v_mbcnt_lo_u32_b32 v107, -1, 0
    v_lshl_add_u32 v104, v105, 10, v104
    s_add_u32 m0, s38, 21504
    s_nop 0
    buffer_load_dwordx4 v7, s[12:15], s48 offen nt lds
    v_add_u32 v104, s38, v104
    s_add_u32 s48, s34, 18688
    ds_read_b128 a[96:99], v104 offset:0
    ds_read_b128 a[104:107], v104 offset:2048
    s_add_u32 m0, s38, 22528
    s_nop 0
    buffer_load_dwordx4 v6, s[12:15], s48 offen nt lds
    s_add_u32 m0, s38, 23552
    v_xor_b32 v105, 64, v104
    buffer_load_dwordx4 v7, s[12:15], s48 offen nt lds
    ds_read_b128 a[100:103], v105 offset:0
    ds_read_b128 a[112:115], v104 offset:4096
    s_waitcnt lgkmcnt(3)
    v_mfma_f32_16x16x32_bf16 v[52:55], a[212:215], a[96:99], 0
    ds_read_b128 a[224:227], v1 offset:1024
    s_waitcnt lgkmcnt(2)
    v_mfma_f32_16x16x32_bf16 v[52:55], a[216:219], a[100:103], v[52:55]
    ds_read_b128 a[108:111], v105 offset:2048
    v_mbcnt_hi_u32_b32 v107, -1, v107
    v_mfma_f32_16x16x32_bf16 v[52:55], a[220:223], a[104:107], v[52:55]
    ds_read_b128 a[232:235], v1 offset:2048
    ds_read_b128 a[228:231], v0 offset:2048
    s_waitcnt lgkmcnt(2)
    v_mfma_f32_16x16x32_bf16 v[52:55], a[224:227], a[108:111], v[52:55]
    ds_read_b128 a[116:119], v105 offset:4096
    s_waitcnt lgkmcnt(1)
    v_mfma_f32_16x16x32_bf16 v[52:55], a[228:231], a[112:115], v[52:55]
    ds_read_b128 a[216:219], v1 offset:6144
    s_waitcnt lgkmcnt(1)
    v_mfma_f32_16x16x32_bf16 v[52:55], a[232:235], a[116:119], v[52:55]
    ds_read_b128 a[212:215], v0 offset:6144
    s_nop 6
    v_max3_f32 v96, v52, v53, v54
    ds_read_b128 a[220:223], v0 offset:7168
    s_waitcnt lgkmcnt(1)
    v_mfma_f32_16x16x32_bf16 v[56:59], a[212:215], a[96:99], 0
    ds_read_b128 a[228:231], v0 offset:8192
    v_mfma_f32_16x16x32_bf16 v[56:59], a[216:219], a[100:103], v[56:59]
    ds_read_b128 a[224:227], v1 offset:7168
    ds_read_b128 a[232:235], v1 offset:8192
    s_waitcnt lgkmcnt(3)
    v_mfma_f32_16x16x32_bf16 v[56:59], a[220:223], a[104:107], v[56:59]
    ds_read_b128 a[212:215], v0 offset:12288
    s_waitcnt lgkmcnt(2)
    v_mfma_f32_16x16x32_bf16 v[56:59], a[224:227], a[108:111], v[56:59]
    v_and_b32 v106, 15, v107
    ds_read_b128 a[216:219], v1 offset:12288
    v_mfma_f32_16x16x32_bf16 v[56:59], a[228:231], a[112:115], v[56:59]
    s_waitcnt lgkmcnt(1)
    ds_read_b128 a[228:231], v0 offset:14336
    v_mfma_f32_16x16x32_bf16 v[56:59], a[232:235], a[116:119], v[56:59]
    v_mul_u32_u24 v106, 384, v106
    s_nop 6
    v_max3_f32 v96, v96, v55, v56
    v_max3_f32 v96, v96, v57, v58
    v_max_f32 v96, v96, v59
    v_mov_b32 v97, v96
    s_nop 1
    v_permlane32_swap_b32 v97, v96
    ds_read_b128 a[224:227], v1 offset:13312
    v_max_f32 v96, v96, v97
    v_lshrrev_b32 v107, 4, v107
    v_mov_b32 v97, v96
    s_nop 1
    v_permlane16_swap_b32 v97, v96
    v_max_f32 v96, v96, v97
    v_mul_f32_e64 v9, -s28, v96
    v_fma_f32 v59, v59, s28, v9
    v_fma_f32 v57, v57, s28, v9
    v_fma_f32 v56, v56, s28, v9
    v_exp_f32 v59, v59
    v_fma_f32 v54, v54, s28, v9
    v_fma_f32 v52, v52, s28, v9
    v_fma_f32 v53, v53, s28, v9
    ds_read_b128 a[220:223], v0 offset:13312
    v_lshl_add_u32 v106, v107, 4, v106
    v_fma_f32 v55, v55, s28, v9
    v_exp_f32 v55, v55
    v_exp_f32 v52, v52
    v_exp_f32 v56, v56
    v_fma_f32 v58, v58, s28, v9
    v_exp_f32 v53, v53
    v_exp_f32 v54, v54
    v_exp_f32 v58, v58
    v_cvt_pk_bf16_f32 v14, v52, v53
    v_cvt_pk_bf16_f32 v17, v58, v59
    v_cvt_pk_bf16_f32 v15, v54, v55
    s_waitcnt vmcnt(12)
    s_add_u32 s48, s34, 24576
    s_add_u32 m0, s38, 24576
    s_nop 0
    buffer_load_dwordx4 v6, s[12:15], s48 offen nt lds
    s_add_u32 m0, s38, 25600
    v_mfma_f32_16x16x32_bf16 v[52:55], a[212:215], a[96:99], 0
    buffer_load_dwordx4 v7, s[12:15], s48 offen nt lds
    s_add_u32 s48, s34, 24704
    ds_read_b128 a[124:127], v105 offset:6144
    s_waitcnt lgkmcnt(1)
    v_mfma_f32_16x16x32_bf16 v[52:55], a[216:219], a[100:103], v[52:55]
    s_add_u32 m0, s38, 26624
    ds_read_b128 a[232:235], v1 offset:14336
    buffer_load_dwordx4 v6, s[12:15], s48 offen nt lds
    v_exp_f32 v57, v57
    v_mfma_f32_16x16x32_bf16 v[52:55], a[220:223], a[104:107], v[52:55]
    s_add_u32 m0, s38, 27648
    ds_read_b128 a[216:219], v1 offset:18432
    buffer_load_dwordx4 v7, s[12:15], s48 offen nt lds
    ds_read_b128 a[120:123], v104 offset:6144
    ds_read_b128 a[220:223], v0 offset:19456
    v_mfma_f32_16x16x32_bf16 v[52:55], a[224:227], a[108:111], v[52:55]
    s_add_u32 s48, s34, 24576
    ds_read_b128 a[212:215], v0 offset:18432
    buffer_load_dwordx4 a[208:211], v106, s[12:15], s48 offen offset:256 nt
    v_mfma_f32_16x16x32_bf16 v[52:55], a[228:231], a[112:115], v[52:55]
    ds_read_b128 a[132:135], v105 offset:8192
    buffer_load_dwordx4 v[92:95], v106, s[12:15], s48 offen offset:320 nt
    v_cvt_pk_bf16_f32 v16, v56, v57
    s_waitcnt lgkmcnt(5)
    v_mfma_f32_16x16x32_bf16 v[52:55], a[232:235], a[116:119], v[52:55]
    s_nop 7
    v_fma_f32 v52, v52, s28, v9
    ds_read_b128 a[224:227], v1 offset:19456
    ds_read_b128 a[232:235], v1 offset:20480
    s_waitcnt lgkmcnt(3)
    v_mfma_f32_16x16x32_bf16 v[56:59], a[212:215], a[96:99], 0
    ds_read_b128 a[128:131], v104 offset:8192
    v_mfma_f32_16x16x32_bf16 v[56:59], a[216:219], a[100:103], v[56:59]
    ds_read_b128 a[212:215], v0 offset:0
    v_mfma_f32_16x16x32_bf16 v[56:59], a[220:223], a[104:107], v[56:59]
    ds_read_b128 a[228:231], v0 offset:20480
    s_waitcnt lgkmcnt(4)
    v_mfma_f32_16x16x32_bf16 v[56:59], a[224:227], a[108:111], v[56:59]
    ds_read_b128 a[216:219], v1 offset:0
    s_waitcnt lgkmcnt(1)
    v_mfma_f32_16x16x32_bf16 v[56:59], a[228:231], a[112:115], v[56:59]
    ds_read_b128 a[220:223], v0 offset:1024
    v_mfma_f32_16x16x32_bf16 v[56:59], a[232:235], a[116:119], v[56:59]
    ds_read_b128 a[228:231], v0 offset:2048
    v_mfma_f32_16x16x32_bf16 v[60:63], a[212:215], a[120:123], 0
    ds_read_b128 a[224:227], v1 offset:1024
    s_waitcnt lgkmcnt(3)
    v_mfma_f32_16x16x32_bf16 v[60:63], a[216:219], a[124:127], v[60:63]
    v_fma_f32 v55, v55, s28, v9
    ds_read_b128 a[136:139], v104 offset:10240
    s_waitcnt lgkmcnt(3)
    v_mfma_f32_16x16x32_bf16 v[60:63], a[220:223], a[128:131], v[60:63]
    ds_read_b128 a[232:235], v1 offset:2048
    s_waitcnt lgkmcnt(2)
    v_mfma_f32_16x16x32_bf16 v[60:63], a[224:227], a[132:135], v[60:63]
    ds_read_b128 a[212:215], v0 offset:6144
    ds_read_b128 a[140:143], v105 offset:10240
    s_waitcnt lgkmcnt(3)
    v_mfma_f32_16x16x32_bf16 v[60:63], a[228:231], a[136:139], v[60:63]
    ds_read_b128 a[220:223], v0 offset:7168
    s_waitcnt lgkmcnt(1)
    v_mfma_f32_16x16x32_bf16 v[60:63], a[232:235], a[140:143], v[60:63]
    ds_read_b128 a[216:219], v1 offset:6144
    v_mfma_f32_16x16x32_bf16 v[64:67], a[212:215], a[120:123], 0
    ds_read_b128 a[224:227], v1 offset:7168
    s_waitcnt lgkmcnt(1)
    v_mfma_f32_16x16x32_bf16 v[64:67], a[216:219], a[124:127], v[64:67]
    ds_read_b128 a[232:235], v1 offset:8192
    v_mfma_f32_16x16x32_bf16 v[64:67], a[220:223], a[128:131], v[64:67]
    s_waitcnt lgkmcnt(1)
    ds_read_b128 a[216:219], v1 offset:12288
    v_mfma_f32_16x16x32_bf16 v[64:67], a[224:227], a[132:135], v[64:67]
    v_max3_f32 v98, v60, v61, v62
    ds_read_b128 a[228:231], v0 offset:8192
    ds_read_b128 a[220:223], v0 offset:13312
    ds_read_b128 a[224:227], v1 offset:13312
    s_waitcnt lgkmcnt(2)
    v_mfma_f32_16x16x32_bf16 v[64:67], a[228:231], a[136:139], v[64:67]
    ds_read_b128 a[212:215], v0 offset:12288
    v_mfma_f32_16x16x32_bf16 v[64:67], a[232:235], a[140:143], v[64:67]
    s_nop 7
    v_max3_f32 v98, v98, v63, v64
    s_waitcnt vmcnt(12)
    s_add_u32 m0, s22, 24576
    s_nop 0
    buffer_load_dwordx4 v6, s[8:11], s21 offen lds
    s_add_u32 s21, s21, 128
    s_add_u32 m0, s22, 25600
    ds_read_b128 a[228:231], v0 offset:14336
    buffer_load_dwordx4 v6, s[8:11], s21 offen lds
    v_max3_f32 v98, v98, v65, v66
    v_mfma_f32_16x16x32_bf16 v[44:47], a[236:239], v[14:17], 0
    s_add_u32 s21, s21, 128
    v_max_f32 v98, v98, v67
    v_mov_b32 v99, v98
    s_add_u32 m0, s22, 26624
    s_nop 0
    buffer_load_dwordx4 v6, s[8:11], s21 offen lds
    v_permlane32_swap_b32 v99, v98
    v_max_f32 v98, v98, v99
    v_exp_f32 v52, v52
    v_mov_b32 v99, v98
    s_nop 1
    v_permlane16_swap_b32 v99, v98
    v_max_f32 v98, v98, v99
    v_mul_f32_e64 v10, -s28, v98
    v_fma_f32 v61, v61, s28, v10
    v_exp_f32 v61, v61
    v_fma_f32 v63, v63, s28, v10
    v_fma_f32 v60, v60, s28, v10
    v_fma_f32 v66, v66, s28, v10
    v_fma_f32 v62, v62, s28, v10
    v_exp_f32 v62, v62
    v_fma_f32 v65, v65, s28, v10
    v_exp_f32 v60, v60
    v_exp_f32 v63, v63
    v_cvt_pk_bf16_f32 v20, v60, v61
    v_fma_f32 v67, v67, s28, v10
    v_cvt_pk_bf16_f32 v21, v62, v63
    ds_read_b128 a[164:167], v105 offset:16384
    v_exp_f32 v65, v65
    v_fma_f32 v64, v64, s28, v10
    s_waitcnt lgkmcnt(1)
    v_mfma_f32_16x16x32_bf16 v[60:63], a[212:215], a[120:123], 0
    ds_read_b128 a[232:235], v1 offset:14336
    v_exp_f32 v66, v66
    v_mfma_f32_16x16x32_bf16 v[60:63], a[216:219], a[124:127], v[60:63]
    ds_read_b128 a[160:163], v104 offset:16384
    v_mfma_f32_16x16x32_bf16 v[60:63], a[220:223], a[128:131], v[60:63]
    ds_read_b128 a[152:155], v104 offset:14336
    v_mfma_f32_16x16x32_bf16 v[60:63], a[224:227], a[132:135], v[60:63]
    ds_read_b128 a[212:215], v0 offset:18432
    v_fma_f32 v54, v54, s28, v9
    v_mfma_f32_16x16x32_bf16 v[60:63], a[228:231], a[136:139], v[60:63]
    ds_read_b128 a[220:223], v0 offset:19456
    ds_read_b128 a[144:147], v104 offset:12288
    v_exp_f32 v67, v67
    ds_read_b128 a[228:231], v0 offset:20480
    ds_read_b128 a[216:219], v1 offset:18432
    s_waitcnt lgkmcnt(7)
    v_mfma_f32_16x16x32_bf16 v[60:63], a[232:235], a[140:143], v[60:63]
    v_exp_f32 v64, v64
    ds_read_b128 a[156:159], v105 offset:14336
    v_cvt_pk_bf16_f32 v23, v66, v67
    v_cvt_pk_bf16_f32 v22, v64, v65
    s_waitcnt lgkmcnt(5)
    v_mfma_f32_16x16x32_bf16 v[64:67], a[212:215], a[120:123], 0
    ds_read_b128 a[148:151], v105 offset:12288
    s_add_u32 s21, s21, 12032
    ds_read_b128 a[224:227], v1 offset:19456
    s_waitcnt lgkmcnt(3)
    v_mfma_f32_16x16x32_bf16 v[64:67], a[216:219], a[124:127], v[64:67]
    ds_read_b128 a[232:235], v1 offset:20480
    v_mfma_f32_16x16x32_bf16 v[64:67], a[220:223], a[128:131], v[64:67]
    ds_read_b128 a[212:215], v0 offset:0
    s_waitcnt lgkmcnt(2)
    v_mfma_f32_16x16x32_bf16 v[64:67], a[224:227], a[132:135], v[64:67]
    ds_read_b128 a[220:223], v0 offset:1024
    v_mfma_f32_16x16x32_bf16 v[64:67], a[228:231], a[136:139], v[64:67]
    ds_read_b128 a[228:231], v0 offset:2048
    s_waitcnt lgkmcnt(3)
    v_mfma_f32_16x16x32_bf16 v[64:67], a[232:235], a[140:143], v[64:67]
    ds_read_b128 a[216:219], v1 offset:0
    s_waitcnt lgkmcnt(3)
    v_mfma_f32_16x16x32_bf16 v[68:71], a[212:215], a[144:147], 0
    ds_read_b128 a[224:227], v1 offset:1024
    s_waitcnt lgkmcnt(1)
    v_mfma_f32_16x16x32_bf16 v[68:71], a[216:219], a[148:151], v[68:71]
    ds_read_b128 a[212:215], v0 offset:6144
    v_mfma_f32_16x16x32_bf16 v[68:71], a[220:223], a[152:155], v[68:71]
    s_waitcnt lgkmcnt(1)
    ds_read_b128 a[232:235], v1 offset:2048
    v_mfma_f32_16x16x32_bf16 v[68:71], a[224:227], a[156:159], v[68:71]
    ds_read_b128 a[216:219], v1 offset:6144
    v_mfma_f32_16x16x32_bf16 v[68:71], a[228:231], a[160:163], v[68:71]
    ds_read_b128 a[224:227], v1 offset:7168
    s_waitcnt lgkmcnt(2)
    v_mfma_f32_16x16x32_bf16 v[68:71], a[232:235], a[164:167], v[68:71]
    ds_read_b128 a[232:235], v1 offset:8192
    v_mfma_f32_16x16x32_bf16 v[72:75], a[212:215], a[144:147], 0
    s_waitcnt lgkmcnt(2)
    ds_read_b128 a[220:223], v0 offset:7168
    v_mfma_f32_16x16x32_bf16 v[72:75], a[216:219], a[148:151], v[72:75]
    ds_read_b128 a[228:231], v0 offset:8192
    s_waitcnt lgkmcnt(1)
    v_mfma_f32_16x16x32_bf16 v[72:75], a[220:223], a[152:155], v[72:75]
    ds_read_b128 a[216:219], v1 offset:12288
    v_mfma_f32_16x16x32_bf16 v[72:75], a[224:227], a[156:159], v[72:75]
    s_waitcnt lgkmcnt(1)
    ds_read_b128 a[224:227], v1 offset:13312
    v_fma_f32 v60, v60, s28, v10
    v_mfma_f32_16x16x32_bf16 v[72:75], a[228:231], a[160:163], v[72:75]
    ds_read_b128 a[212:215], v0 offset:12288
    v_mfma_f32_16x16x32_bf16 v[72:75], a[232:235], a[164:167], v[72:75]
    v_max3_f32 v96, v68, v69, v70
    s_nop 6
    v_max3_f32 v96, v96, v71, v72
    ds_read_b128 a[232:235], v1 offset:14336
    v_max3_f32 v96, v96, v73, v74
    v_max_f32 v96, v96, v75
    v_mov_b32 v97, v96
    s_nop 1
    v_permlane32_swap_b32 v97, v96
    v_max_f32 v96, v96, v97
    ds_read_b128 a[228:231], v0 offset:14336
    v_mov_b32 v97, v96
    s_nop 1
    v_permlane16_swap_b32 v97, v96
    v_max_f32 v96, v96, v97
    v_mul_f32_e64 v11, -s28, v96
    v_fma_f32 v72, v72, s28, v11
    v_exp_f32 v55, v55
    v_fma_f32 v71, v71, s28, v11
    v_exp_f32 v71, v71
    v_exp_f32 v72, v72
    v_fma_f32 v74, v74, s28, v11
    v_fma_f32 v75, v75, s28, v11
    v_fma_f32 v70, v70, s28, v11
    v_fma_f32 v68, v68, s28, v11
    v_fma_f32 v73, v73, s28, v11
    ds_read_b128 a[220:223], v0 offset:13312
    v_fma_f32 v63, v63, s28, v10
    v_exp_f32 v70, v70
    v_exp_f32 v68, v68
    v_fma_f32 v69, v69, s28, v11
    v_mfma_f32_16x16x32_bf16 v[44:47], a[240:243], v[20:23], v[44:47]
    v_cvt_pk_bf16_f32 v27, v70, v71
    v_fma_f32 v61, v61, s28, v10
    v_exp_f32 v69, v69
    s_waitcnt vmcnt(9)
    s_add_u32 m0, s22, 36864
    ds_read_b128 a[172:175], v105 offset:18432
    buffer_load_dwordx4 v6, s[8:11], s21 offen lds
    s_add_u32 s21, s21, 128
    s_add_u32 m0, s22, 37888
    v_cvt_pk_bf16_f32 v26, v68, v69
    s_waitcnt lgkmcnt(2)
    v_mfma_f32_16x16x32_bf16 v[68:71], a[212:215], a[144:147], 0
    buffer_load_dwordx4 v6, s[8:11], s21 offen lds
    ds_read_b128 a[168:171], v104 offset:18432
    v_mfma_f32_16x16x32_bf16 v[68:71], a[216:219], a[148:151], v[68:71]
    s_waitcnt lgkmcnt(2)
    ds_read_b128 a[212:215], v0 offset:18432
    s_add_u32 s21, s21, 128
    s_add_u32 m0, s22, 38912
    v_mfma_f32_16x16x32_bf16 v[68:71], a[220:223], a[152:155], v[68:71]
    buffer_load_dwordx4 v6, s[8:11], s21 offen lds
    ds_read_b128 a[176:179], v104 offset:20480
    v_mfma_f32_16x16x32_bf16 v[68:71], a[224:227], a[156:159], v[68:71]
    v_exp_f32 v74, v74
    ds_read_b128 a[184:187], v104 offset:22528
    v_exp_f32 v73, v73
    v_mfma_f32_16x16x32_bf16 v[68:71], a[228:231], a[160:163], v[68:71]
    v_fma_f32 v53, v53, s28, v9
    ds_read_b128 a[220:223], v0 offset:19456
    v_cvt_pk_bf16_f32 v28, v72, v73
    ds_read_b128 a[228:231], v0 offset:20480
    v_mfma_f32_16x16x32_bf16 v[68:71], a[232:235], a[164:167], v[68:71]
    v_exp_f32 v61, v61
    ds_read_b128 a[224:227], v1 offset:19456
    ds_read_b128 a[216:219], v1 offset:18432
    v_exp_f32 v75, v75
    ds_read_b128 a[232:235], v1 offset:20480
    v_cvt_pk_bf16_f32 v29, v74, v75
    s_waitcnt lgkmcnt(7)
    v_mfma_f32_16x16x32_bf16 v[72:75], a[212:215], a[144:147], 0
    ds_read_b128 a[212:215], v0 offset:0
    s_waitcnt lgkmcnt(2)
    v_mfma_f32_16x16x32_bf16 v[72:75], a[216:219], a[148:151], v[72:75]
    ds_read_b128 a[180:183], v105 offset:20480
    v_mfma_f32_16x16x32_bf16 v[72:75], a[220:223], a[152:155], v[72:75]
    ds_read_b128 a[216:219], v1 offset:0
    v_mfma_f32_16x16x32_bf16 v[72:75], a[224:227], a[156:159], v[72:75]
    ds_read_b128 a[220:223], v0 offset:1024
    v_mfma_f32_16x16x32_bf16 v[72:75], a[228:231], a[160:163], v[72:75]
    s_waitcnt lgkmcnt(3)
    ds_read_b128 a[224:227], v1 offset:1024
    v_fma_f32 v62, v62, s28, v10
    v_mfma_f32_16x16x32_bf16 v[72:75], a[232:235], a[164:167], v[72:75]
    ds_read_b128 a[228:231], v0 offset:2048
    v_mfma_f32_16x16x32_bf16 v[76:79], a[212:215], a[168:171], 0
    v_exp_f32 v54, v54
    ds_read_b128 a[188:191], v105 offset:22528
    s_waitcnt lgkmcnt(4)
    v_mfma_f32_16x16x32_bf16 v[76:79], a[216:219], a[172:175], v[76:79]
    ds_read_b128 a[216:219], v1 offset:6144
    s_waitcnt lgkmcnt(4)
    v_mfma_f32_16x16x32_bf16 v[76:79], a[220:223], a[176:179], v[76:79]
    ds_read_b128 a[232:235], v1 offset:2048
    s_waitcnt lgkmcnt(4)
    v_mfma_f32_16x16x32_bf16 v[76:79], a[224:227], a[180:183], v[76:79]
    ds_read_b128 a[224:227], v1 offset:7168
    s_waitcnt lgkmcnt(4)
    v_mfma_f32_16x16x32_bf16 v[76:79], a[228:231], a[184:187], v[76:79]
    ds_read_b128 a[212:215], v0 offset:6144
    s_waitcnt lgkmcnt(2)
    v_mfma_f32_16x16x32_bf16 v[76:79], a[232:235], a[188:191], v[76:79]
    ds_read_b128 a[220:223], v0 offset:7168
    s_waitcnt lgkmcnt(1)
    v_mfma_f32_16x16x32_bf16 v[80:83], a[212:215], a[168:171], 0
    ds_read_b128 a[232:235], v1 offset:8192
    v_mfma_f32_16x16x32_bf16 v[80:83], a[216:219], a[172:175], v[80:83]
    ds_read_b128 a[228:231], v0 offset:8192
    s_waitcnt lgkmcnt(2)
    v_mfma_f32_16x16x32_bf16 v[80:83], a[220:223], a[176:179], v[80:83]
    ds_read_b128 a[220:223], v0 offset:13312
    v_mfma_f32_16x16x32_bf16 v[80:83], a[224:227], a[180:183], v[80:83]
    ds_read_b128 a[212:215], v0 offset:12288
    s_waitcnt lgkmcnt(2)
    v_mfma_f32_16x16x32_bf16 v[80:83], a[228:231], a[184:187], v[80:83]
    ds_read_b128 a[216:219], v1 offset:12288
    v_max3_f32 v98, v76, v77, v78
    s_add_u32 s21, s21, 12032
    v_mfma_f32_16x16x32_bf16 v[80:83], a[232:235], a[188:191], v[80:83]
    ds_read_b128 a[228:231], v0 offset:14336
    s_nop 6
    v_max3_f32 v98, v98, v79, v80
    v_max3_f32 v98, v98, v81, v82
    v_max_f32 v98, v98, v83
    v_mov_b32 v99, v98
    s_nop 1
    v_permlane32_swap_b32 v99, v98
    v_max_f32 v98, v98, v99
    v_mov_b32 v99, v98
    s_nop 1
    v_permlane16_swap_b32 v99, v98
    v_max_f32 v98, v98, v99
    v_mul_f32_e64 v12, -s28, v98
    v_fma_f32 v77, v77, s28, v12
    v_exp_f32 v77, v77
    v_fma_f32 v76, v76, s28, v12
    v_fma_f32 v78, v78, s28, v12
    v_exp_f32 v76, v76
    v_mfma_f32_16x16x32_bf16 v[44:47], a[244:247], v[26:29], v[44:47]
    v_fma_f32 v79, v79, s28, v12
    v_exp_f32 v78, v78
    v_exp_f32 v79, v79
    v_cvt_pk_bf16_f32 v32, v76, v77
    ds_read_b128 a[224:227], v1 offset:13312
    v_cvt_pk_bf16_f32 v33, v78, v79
    v_fma_f32 v81, v81, s28, v12
    v_exp_f32 v81, v81
    s_waitcnt lgkmcnt(1)
    v_mfma_f32_16x16x32_bf16 v[76:79], a[212:215], a[168:171], 0
    ds_read_b128 a[232:235], v1 offset:14336
    v_fma_f32 v82, v82, s28, v12
    v_mfma_f32_16x16x32_bf16 v[76:79], a[216:219], a[172:175], v[76:79]
    v_exp_f32 v60, v60
    v_fma_f32 v80, v80, s28, v12
    ds_read_b128 a[212:215], v0 offset:18432
    v_fma_f32 v83, v83, s28, v12
    v_mfma_f32_16x16x32_bf16 v[76:79], a[220:223], a[176:179], v[76:79]
    ds_read_b128 a[220:223], v0 offset:19456
    s_waitcnt lgkmcnt(3)
    v_mfma_f32_16x16x32_bf16 v[76:79], a[224:227], a[180:183], v[76:79]
    ds_read_b128 a[216:219], v1 offset:18432
    v_cvt_pk_bf16_f32 v19, v54, v55
    v_exp_f32 v83, v83
    v_mfma_f32_16x16x32_bf16 v[76:79], a[228:231], a[184:187], v[76:79]
    s_waitcnt lgkmcnt(3)
    ds_read_b128 a[228:231], v0 offset:20480
    v_exp_f32 v82, v82
    v_mfma_f32_16x16x32_bf16 v[76:79], a[232:235], a[188:191], v[76:79]
    ds_read_b128 a[224:227], v1 offset:19456
    v_cvt_pk_bf16_f32 v35, v82, v83
    v_exp_f32 v80, v80
    s_nop 0
    v_cvt_pk_bf16_f32 v34, v80, v81
    v_exp_f32 v53, v53
    s_waitcnt lgkmcnt(3)
    v_mfma_f32_16x16x32_bf16 v[80:83], a[212:215], a[168:171], 0
    ds_read_b128 a[232:235], v1 offset:20480
    s_waitcnt lgkmcnt(3)
    v_mfma_f32_16x16x32_bf16 v[80:83], a[216:219], a[172:175], v[80:83]
    ds_read_b128 a[216:219], v1 offset:0
    v_mfma_f32_16x16x32_bf16 v[80:83], a[220:223], a[176:179], v[80:83]
    ds_read_b128 a[220:223], v0 offset:1024
    s_waitcnt lgkmcnt(3)
    v_mfma_f32_16x16x32_bf16 v[80:83], a[224:227], a[180:183], v[80:83]
    ds_read_b128 a[212:215], v0 offset:0
    s_waitcnt vmcnt(6)
    ds_read_b128 a[192:195], v104 offset:24576
    v_mfma_f32_16x16x32_bf16 v[80:83], a[228:231], a[184:187], v[80:83]
    s_waitcnt lgkmcnt(4)
    ds_read_b128 a[196:199], v105 offset:24576
    ds_read_b128 a[200:203], v104 offset:26624
    ds_read_b128 a[204:207], v105 offset:26624
    v_mfma_f32_16x16x32_bf16 v[80:83], a[232:235], a[188:191], v[80:83]
    ds_read_b128 a[228:231], v0 offset:2048
    ds_read_b128 a[224:227], v1 offset:1024
    v_mfma_f32_16x16x32_bf16 v[44:47], a[248:251], v[32:35], v[44:47]
    ds_read_b128 a[232:235], v1 offset:2048
    s_waitcnt lgkmcnt(6)
    v_mfma_f32_16x16x32_bf16 v[84:87], a[212:215], a[192:195], 0
    ds_read_b128 a[212:215], v0 offset:6144
    s_waitcnt lgkmcnt(5)
    v_mfma_f32_16x16x32_bf16 v[84:87], a[216:219], a[196:199], v[84:87]
    ds_read_b128 a[216:219], v1 offset:6144
    v_cvt_pk_bf16_f32 v24, v60, v61
    v_mfma_f32_16x16x32_bf16 v[84:87], a[220:223], a[200:203], v[84:87]
    s_waitcnt lgkmcnt(3)
    ds_read_b128 a[220:223], v0 offset:7168
    v_mfma_f32_16x16x32_bf16 v[84:87], a[224:227], a[204:207], v[84:87]
    ds_read_b128 a[224:227], v1 offset:7168
    v_mfma_f32_16x16x32_bf16 v[84:87], a[228:231], a[208:211], v[84:87]
    s_waitcnt lgkmcnt(4)
    ds_read_b128 a[228:231], v0 offset:8192
    v_mfma_f32_16x16x32_bf16 v[84:87], a[232:235], v[92:95], v[84:87]
    ds_read_b128 a[232:235], v1 offset:8192
    s_waitcnt lgkmcnt(5)
    v_mfma_f32_16x16x32_bf16 v[88:91], a[212:215], a[192:195], 0
    s_waitcnt lgkmcnt(4)
    v_mfma_f32_16x16x32_bf16 v[88:91], a[216:219], a[196:199], v[88:91]
    s_waitcnt lgkmcnt(3)
    v_mfma_f32_16x16x32_bf16 v[88:91], a[220:223], a[200:203], v[88:91]
    v_cvt_pk_bf16_f32 v18, v52, v53
    s_waitcnt lgkmcnt(2)
    v_mfma_f32_16x16x32_bf16 v[88:91], a[224:227], a[204:207], v[88:91]
    v_exp_f32 v63, v63
    v_max3_f32 v96, v84, v85, v86
    s_waitcnt vmcnt(63) lgkmcnt(0)
    s_barrier
    ds_read_b128 a[212:215], v0 offset:12288
    v_mfma_f32_16x16x32_bf16 v[88:91], a[228:231], a[208:211], v[88:91]
    s_add_u32 m0, s22, 0
    ds_read_b128 a[228:231], v0 offset:14336
    buffer_load_dwordx4 v6, s[4:7], s20 offen lds
    v_mfma_f32_16x16x32_bf16 v[88:91], a[232:235], v[92:95], v[88:91]
    s_add_u32 s20, s20, 128
    s_add_u32 m0, s22, 1024
    ds_read_b128 a[220:223], v0 offset:13312
    buffer_load_dwordx4 v6, s[4:7], s20 offen lds
    ds_read_b128 a[224:227], v1 offset:13312
    ds_read_b128 a[216:219], v1 offset:12288
    ds_read_b128 a[232:235], v1 offset:14336
    s_nop 0
    v_max3_f32 v96, v96, v87, v88
    v_max3_f32 v96, v96, v89, v90
    v_max_f32 v96, v96, v91
    v_mov_b32 v97, v96
    s_add_u32 s20, s20, 128
    s_nop 0
    v_permlane32_swap_b32 v97, v96
    v_max_f32 v96, v96, v97
    v_mov_b32 v97, v96
    s_add_u32 m0, s22, 2048
    s_nop 0
    v_permlane16_swap_b32 v97, v96
    v_max_f32 v96, v96, v97
    v_mul_f32_e64 v13, -s28, v96
    v_fma_f32 v87, v87, s28, v13
    v_fma_f32 v84, v84, s28, v13
    v_fma_f32 v86, v86, s28, v13
    v_exp_f32 v87, v87
    v_fma_f32 v90, v90, s28, v13
    v_fma_f32 v85, v85, s28, v13
    v_exp_f32 v84, v84
    v_exp_f32 v90, v90
    v_exp_f32 v86, v86
    v_exp_f32 v85, v85
    v_cvt_pk_bf16_f32 v39, v86, v87
    v_cvt_pk_bf16_f32 v38, v84, v85
    v_fma_f32 v91, v91, s28, v13
    s_waitcnt lgkmcnt(2)
    v_mfma_f32_16x16x32_bf16 v[84:87], a[212:215], a[192:195], 0
    s_waitcnt lgkmcnt(0)
    ds_read_b128 a[212:215], v0 offset:18432
    buffer_load_dwordx4 v6, s[4:7], s20 offen lds
    v_mfma_f32_16x16x32_bf16 v[84:87], a[216:219], a[196:199], v[84:87]
    s_add_u32 s20, s20, 12032
    ds_read_b128 a[216:219], v1 offset:18432
    s_mov_b32 s39, s64
    v_mfma_f32_16x16x32_bf16 v[84:87], a[220:223], a[200:203], v[84:87]
    s_add_u32 s37, s37, 1
    s_bitcmp1_b32 s63, s37
    s_cselect_b32 s62, 4294770688, 0
    s_cselect_b32 s42, 0, 325632
    ds_read_b128 a[220:223], v0 offset:19456
    v_mfma_f32_16x16x32_bf16 v[84:87], a[224:227], a[204:207], v[84:87]
    s_add_u32 s35, s35, s42
    ds_read_b128 a[224:227], v1 offset:19456
    s_lshl_b32 s42, s37, 1
    s_lshr_b32 s42, s31, s42
    s_and_b32 s42, s42, 3
    v_mfma_f32_16x16x32_bf16 v[84:87], a[228:231], a[208:211], v[84:87]
    s_add_u32 s42, s42, s36
    ds_read_b128 a[228:231], v0 offset:20480
    s_sub_u32 s43, s42, 3
    v_mfma_f32_16x16x32_bf16 v[84:87], a[232:235], v[92:95], v[84:87]
    s_cmp_ge_u32 s42, 3
    ds_read_b128 a[232:235], v1 offset:20480
    s_cselect_b32 s42, s43, s42
    v_exp_f32 v91, v91
    v_fma_f32 v88, v88, s28, v13
    v_exp_f32 v88, v88
    s_mul_i32 s44, s3, 5
    s_mov_b32 s32, 1
    s_lshl_b32 s43, s3, 2
    s_add_u32 s45, s43, 21
    s_cmp_eq_u32 s3, 0
    s_cselect_b32 s45, 20, s45
    s_cselect_b32 s33, 1, 0
    s_cmp_eq_u32 s42, 1
    s_cselect_b32 s44, s45, s44
    v_fma_f32 v89, v89, s28, v13
    s_cselect_b32 s32, s33, s32
    v_exp_f32 v89, v89
    s_add_u32 s45, s43, 37
    s_cmp_eq_u32 s42, 2
    v_cvt_pk_bf16_f32 v41, v90, v91
    s_cselect_b32 s44, s45, s44
    s_cselect_b32 s32, 0, s32
    s_mul_i32 s44, s44, 6144
    v_cvt_pk_bf16_f32 v40, v88, v89
    s_add_u32 s33, s35, s44
    s_mul_i32 s42, s32, 6144
    s_add_u32 s42, s42, 24576
    s_add_u32 s42, s42, s33
    s_cmp_ge_u32 s37, 6
    s_cselect_b32 s14, 0, s42
    s_add_u32 s24, s67, 256
    s_add_u32 s25, s33, 256
    s_add_u32 s23, s38, 4096
    s_mov_b32 s27, 0x249
    s_mov_b32 s30, 0
    s_waitcnt vmcnt(6) lgkmcnt(0)
    v_mfma_f32_16x16x32_bf16 v[88:91], a[212:215], a[192:195], 0
    s_barrier
    ds_read_b64_tr_b16 a[212:213], v2 offset:0
    ds_read_b64_tr_b16 a[214:215], v2 offset:6144
    v_mfma_f32_16x16x32_bf16 v[88:91], a[216:219], a[196:199], v[88:91]
    ds_read_b64_tr_b16 a[216:217], v3 offset:0
    ds_read_b64_tr_b16 a[218:219], v3 offset:6144
    s_add_u32 m0, s22, 12288
    v_mfma_f32_16x16x32_bf16 v[88:91], a[220:223], a[200:203], v[88:91]
    buffer_load_dwordx4 v6, s[4:7], s20 offen lds
    s_add_u32 s20, s20, 128
    ds_read_b64_tr_b16 a[220:221], v4 offset:0
    v_mfma_f32_16x16x32_bf16 v[44:47], a[252:255], v[38:41], v[44:47]
    s_add_u32 m0, s22, 13312
    v_exp_f32 v62, v62
    buffer_load_dwordx4 v6, s[4:7], s20 offen lds
    s_add_u32 s20, s20, 128
    v_cvt_pk_bf16_f32 v25, v62, v63
    ds_read_b64_tr_b16 a[222:223], v4 offset:6144
    v_mfma_f32_16x16x32_bf16 v[88:91], a[224:227], a[204:207], v[88:91]
    ds_read_b64_tr_b16 a[224:225], v5 offset:0
    s_add_u32 m0, s22, 14336
    s_nop 0
    buffer_load_dwordx4 v6, s[4:7], s20 offen lds
    v_mfma_f32_16x16x32_bf16 v[88:91], a[228:231], a[208:211], v[88:91]
    s_add_u32 s20, s20, 12032
    ds_read_b64_tr_b16 a[226:227], v5 offset:6144
    v_mfma_f32_16x16x32_bf16 v[88:91], a[232:235], v[92:95], v[88:91]
    s_waitcnt lgkmcnt(4)
    v_mfma_f32_16x16x32_bf16 v[112:115], a[212:215], v[14:17], 0
    v_fma_f32 v87, v87, s28, v13
    v_fma_f32 v69, v69, s28, v11
    v_mfma_f32_16x16x32_bf16 v[116:119], a[216:219], v[14:17], 0
    v_fma_f32 v57, v57, s28, v9
    v_mfma_f32_16x16x32_bf16 v[164:167], a[216:219], v[20:23], 0
    v_fma_f32 v68, v68, s28, v11
    v_fma_f32 v71, v71, s28, v11
    v_mfma_f32_16x16x32_bf16 v[160:163], a[212:215], v[20:23], 0
    v_fma_f32 v70, v70, s28, v11
    v_fma_f32 v58, v58, s28, v9
    v_mfma_f32_16x16x32_bf16 v[208:211], a[212:215], v[26:29], 0
    ds_read_b64_tr_b16 a[232:233], v3 offset:1024
    v_mfma_f32_16x16x32_bf16 v[212:215], a[216:219], v[26:29], 0
    v_fma_f32 v75, v75, s28, v11
    v_fma_f32 v82, v82, s28, v12
    v_mfma_f32_16x16x32_bf16 a[4:7], a[216:219], v[32:35], 0
    ds_read_b64_tr_b16 a[234:235], v3 offset:7168
    v_mfma_f32_16x16x32_bf16 a[0:3], a[212:215], v[32:35], 0
    ds_read_b64_tr_b16 a[230:231], v2 offset:7168
    v_fma_f32 v77, v77, s28, v12
    v_mfma_f32_16x16x32_bf16 a[48:51], a[212:215], v[38:41], 0
    v_fma_f32 v66, v66, s28, v10
    v_fma_f32 v80, v80, s28, v12
    v_mfma_f32_16x16x32_bf16 a[52:55], a[216:219], v[38:41], 0
    s_waitcnt lgkmcnt(3)
    ds_read_b64_tr_b16 a[228:229], v2 offset:1024
    v_fma_f32 v59, v59, s28, v9
    v_mfma_f32_16x16x32_bf16 a[56:59], a[220:223], v[38:41], 0
    ds_read_b64_tr_b16 a[212:213], v4 offset:1024
    v_fma_f32 v56, v56, s28, v9
    v_mfma_f32_16x16x32_bf16 a[60:63], a[224:227], v[38:41], 0
    v_fma_f32 v86, v86, s28, v13
    v_mfma_f32_16x16x32_bf16 a[12:15], a[224:227], v[32:35], 0
    v_exp_f32 v77, v77
    v_mfma_f32_16x16x32_bf16 a[8:11], a[220:223], v[32:35], 0
    v_fma_f32 v72, v72, s28, v11
    v_mfma_f32_16x16x32_bf16 v[216:219], a[220:223], v[26:29], 0
    v_fma_f32 v85, v85, s28, v13
    v_fma_f32 v79, v79, s28, v12
    v_mfma_f32_16x16x32_bf16 v[220:223], a[224:227], v[26:29], 0
    ds_read_b64_tr_b16 a[214:215], v4 offset:7168
    v_fma_f32 v84, v84, s28, v13
    v_mfma_f32_16x16x32_bf16 v[172:175], a[224:227], v[20:23], 0
    ds_read_b64_tr_b16 a[216:217], v5 offset:1024
    v_mfma_f32_16x16x32_bf16 v[168:171], a[220:223], v[20:23], 0
    ds_read_b64_tr_b16 a[218:219], v5 offset:7168
    v_fma_f32 v65, v65, s28, v10
    v_mfma_f32_16x16x32_bf16 v[120:123], a[220:223], v[14:17], 0
    v_exp_f32 v69, v69
    v_mfma_f32_16x16x32_bf16 v[124:127], a[224:227], v[14:17], 0
    s_waitcnt lgkmcnt(4)
    v_exp_f32 v68, v68
    v_mfma_f32_16x16x32_bf16 v[128:131], a[228:231], v[14:17], 0
    ds_read_b64_tr_b16 a[222:223], v2 offset:8192
    v_mfma_f32_16x16x32_bf16 v[132:135], a[232:235], v[14:17], 0
    v_exp_f32 v71, v71
    v_mfma_f32_16x16x32_bf16 v[180:183], a[232:235], v[20:23], 0
    v_exp_f32 v79, v79
    v_mfma_f32_16x16x32_bf16 v[176:179], a[228:231], v[20:23], 0
    v_fma_f32 v90, v90, s28, v13
    v_fma_f32 v76, v76, s28, v12
    v_mfma_f32_16x16x32_bf16 v[224:227], a[228:231], v[26:29], 0
    v_exp_f32 v76, v76
    v_mfma_f32_16x16x32_bf16 v[228:231], a[232:235], v[26:29], 0
    ds_read_b64_tr_b16 a[220:221], v2 offset:2048
    v_fma_f32 v83, v83, s28, v12
    v_mfma_f32_16x16x32_bf16 a[20:23], a[232:235], v[32:35], 0
    v_exp_f32 v75, v75
    v_mfma_f32_16x16x32_bf16 a[16:19], a[228:231], v[32:35], 0
    ds_read_b64_tr_b16 a[224:225], v3 offset:2048
    v_fma_f32 v73, v73, s28, v11
    v_mfma_f32_16x16x32_bf16 a[64:67], a[228:231], v[38:41], 0
    v_exp_f32 v87, v87
    v_mfma_f32_16x16x32_bf16 a[68:71], a[232:235], v[38:41], 0
    s_waitcnt lgkmcnt(3)
    ds_read_b64_tr_b16 a[226:227], v3 offset:8192
    v_mfma_f32_16x16x32_bf16 a[72:75], a[212:215], v[38:41], 0
    v_exp_f32 v90, v90
    v_mfma_f32_16x16x32_bf16 a[76:79], a[216:219], v[38:41], 0
    ds_read_b64_tr_b16 a[228:229], v4 offset:2048
    v_fma_f32 v91, v91, s28, v13
    v_mfma_f32_16x16x32_bf16 a[28:31], a[216:219], v[32:35], 0
    ds_read_b64_tr_b16 a[234:235], v5 offset:8192
    s_add_u32 s39, s39, 12288
    v_mfma_f32_16x16x32_bf16 a[24:27], a[212:215], v[32:35], 0
    ds_read_b64_tr_b16 a[230:231], v4 offset:8192
    v_cvt_pk_bf16_f32 v30, v68, v69
    v_mfma_f32_16x16x32_bf16 v[232:235], a[212:215], v[26:29], 0
    v_exp_f32 v84, v84
    v_mfma_f32_16x16x32_bf16 v[236:239], a[216:219], v[26:29], 0
    ds_read_b64_tr_b16 a[232:233], v5 offset:2048
    v_fma_f32 v67, v67, s28, v10
    v_mfma_f32_16x16x32_bf16 v[188:191], a[216:219], v[20:23], 0
    v_exp_f32 v86, v86
    v_mfma_f32_16x16x32_bf16 v[184:187], a[212:215], v[20:23], 0
    v_exp_f32 v66, v66
    v_mfma_f32_16x16x32_bf16 v[136:139], a[212:215], v[14:17], 0
    v_exp_f32 v58, v58
    v_mfma_f32_16x16x32_bf16 v[140:143], a[216:219], v[14:17], 0
    s_waitcnt lgkmcnt(4)
    v_exp_f32 v83, v83
    v_mfma_f32_16x16x32_bf16 v[144:147], a[220:223], v[14:17], 0
    v_exp_f32 v59, v59
    v_mfma_f32_16x16x32_bf16 v[148:151], a[224:227], v[14:17], 0
    v_exp_f32 v65, v65
    v_mfma_f32_16x16x32_bf16 v[196:199], a[224:227], v[20:23], 0
    v_exp_f32 v91, v91
    v_mfma_f32_16x16x32_bf16 v[192:195], a[220:223], v[20:23], 0
    v_exp_f32 v70, v70
    v_mfma_f32_16x16x32_bf16 v[240:243], a[220:223], v[26:29], 0
    v_exp_f32 v57, v57
    v_mfma_f32_16x16x32_bf16 v[244:247], a[224:227], v[26:29], 0
    v_exp_f32 v85, v85
    v_mfma_f32_16x16x32_bf16 a[36:39], a[224:227], v[32:35], 0
    v_exp_f32 v82, v82
    v_mfma_f32_16x16x32_bf16 a[32:35], a[220:223], v[32:35], 0
    s_waitcnt vmcnt(3) lgkmcnt(0)
    v_fma_f32 v74, v74, s28, v11
    v_mfma_f32_16x16x32_bf16 a[80:83], a[220:223], v[38:41], 0
    v_exp_f32 v67, v67
    v_mfma_f32_16x16x32_bf16 a[84:87], a[224:227], v[38:41], 0
    s_barrier
    v_mfma_f32_16x16x32_bf16 a[88:91], a[228:231], v[38:41], 0
    ds_read_b128 a[212:215], v0 offset:0
    v_fma_f32 v89, v89, s28, v13
    v_mfma_f32_16x16x32_bf16 a[92:95], a[232:235], v[38:41], 0
    ds_read_b128 a[216:219], v1 offset:0
    v_fma_f32 v81, v81, s28, v12
    v_mfma_f32_16x16x32_bf16 a[44:47], a[232:235], v[32:35], 0
    s_add_u32 m0, s22, 24576
    ds_read_b128 a[220:223], v0 offset:1024
    v_cvt_pk_bf16_f32 v31, v70, v71
    v_mfma_f32_16x16x32_bf16 a[40:43], a[228:231], v[32:35], 0
    buffer_load_dwordx4 v6, s[8:11], s21 offen lds
    v_mfma_f32_16x16x32_bf16 v[248:251], a[228:231], v[26:29], 0
    s_add_u32 s21, s21, 128
    s_add_u32 m0, s22, 25600
    v_fma_f32 v64, v64, s28, v10
    v_mfma_f32_16x16x32_bf16 v[252:255], a[232:235], v[26:29], 0
    buffer_load_dwordx4 v6, s[8:11], s21 offen lds
    v_mfma_f32_16x16x32_bf16 v[204:207], a[232:235], v[20:23], 0
    s_add_u32 s21, s21, 128
    v_cvt_pk_bf16_f32 v41, v90, v91
    s_add_u32 m0, s22, 26624
    v_mfma_f32_16x16x32_bf16 v[200:203], a[228:231], v[20:23], 0
    v_fma_f32 v78, v78, s28, v12
    v_cvt_pk_bf16_f32 v36, v76, v77
    v_mfma_f32_16x16x32_bf16 v[152:155], a[228:231], v[14:17], 0
    buffer_load_dwordx4 v6, s[8:11], s21 offen lds
    v_mfma_f32_16x16x32_bf16 v[156:159], a[232:235], v[14:17], 0
    s_add_u32 s21, s21, 12032
    v_fma_f32 v88, v88, s28, v13
    s_waitcnt lgkmcnt(2)
    v_mfma_f32_16x16x32_bf16 v[52:55], a[212:215], a[96:99], 0
    s_waitcnt lgkmcnt(1)
    v_mfma_f32_16x16x32_bf16 v[52:55], a[216:219], a[100:103], v[52:55]
    ds_read_b128 a[224:227], v1 offset:1024
    s_waitcnt lgkmcnt(1)
    v_mfma_f32_16x16x32_bf16 v[52:55], a[220:223], a[104:107], v[52:55]
    ds_read_b128 a[232:235], v1 offset:2048
    s_add_u32 m0, s38, 0
    v_mfma_f32_16x16x32_bf16 v[60:63], a[220:223], a[128:131], 0
    v_exp_f32 v78, v78
    v_mfma_f32_16x16x32_bf16 v[60:63], a[216:219], a[124:127], v[60:63]
    v_cvt_pk_bf16_f32 v37, v78, v79
    v_cvt_pk_bf16_f32 v23, v66, v67
    v_mfma_f32_16x16x32_bf16 v[60:63], a[212:215], a[120:123], v[60:63]
    ds_read_b128 a[228:231], v0 offset:2048
    v_cvt_pk_bf16_f32 v43, v86, v87
    v_mfma_f32_16x16x32_bf16 v[68:71], a[212:215], a[144:147], 0
    buffer_load_dwordx4 v6, s[12:15], s33 offen nt lds
    v_mfma_f32_16x16x32_bf16 v[68:71], a[216:219], a[148:151], v[68:71]
    v_exp_f32 v81, v81
    v_mfma_f32_16x16x32_bf16 v[68:71], a[220:223], a[152:155], v[68:71]
    v_cvt_pk_bf16_f32 v42, v84, v85
    v_mfma_f32_16x16x32_bf16 v[76:79], a[220:223], a[176:179], 0
    v_exp_f32 v88, v88
    v_mfma_f32_16x16x32_bf16 v[76:79], a[216:219], a[172:175], v[76:79]
    v_exp_f32 v56, v56
    v_mfma_f32_16x16x32_bf16 v[76:79], a[212:215], a[168:171], v[76:79]
    v_exp_f32 v89, v89
    v_mfma_f32_16x16x32_bf16 v[84:87], a[212:215], a[192:195], 0
    v_cvt_pk_bf16_f32 v16, v56, v57
    v_mfma_f32_16x16x32_bf16 v[84:87], a[216:219], a[196:199], v[84:87]
    v_cvt_pk_bf16_f32 v35, v82, v83
    v_mfma_f32_16x16x32_bf16 v[84:87], a[220:223], a[200:203], v[84:87]
    s_waitcnt lgkmcnt(1)
    v_exp_f32 v64, v64
    v_mfma_f32_16x16x32_bf16 v[84:87], a[224:227], a[204:207], v[84:87]
    s_waitcnt lgkmcnt(0)
    v_exp_f32 v80, v80
    v_mfma_f32_16x16x32_bf16 v[84:87], a[228:231], a[208:211], v[84:87]
    v_exp_f32 v73, v73
    v_mfma_f32_16x16x32_bf16 v[84:87], a[232:235], v[92:95], v[84:87]
    s_add_u32 m0, s38, 1024
    v_mfma_f32_16x16x32_bf16 v[76:79], a[232:235], a[188:191], v[76:79]
    v_exp_f32 v74, v74
    v_mfma_f32_16x16x32_bf16 v[76:79], a[228:231], a[184:187], v[76:79]
    ds_read_b128 a[216:219], v1 offset:6144
    v_mfma_f32_16x16x32_bf16 v[76:79], a[224:227], a[180:183], v[76:79]
    v_exp_f32 v72, v72
    v_mfma_f32_16x16x32_bf16 v[68:71], a[224:227], a[156:159], v[68:71]
    v_cvt_pk_bf16_f32 v17, v58, v59
    v_cvt_pk_bf16_f32 v22, v64, v65
    v_mfma_f32_16x16x32_bf16 v[68:71], a[228:231], a[160:163], v[68:71]
    ds_read_b128 a[212:215], v0 offset:6144
    v_mfma_f32_16x16x32_bf16 v[68:71], a[232:235], a[164:167], v[68:71]
    ds_read_b128 a[220:223], v0 offset:7168
    v_mfma_f32_16x16x32_bf16 v[48:51], a[236:239], v[16:19], v[44:47]
    v_cvt_pk_bf16_f32 v40, v88, v89
    v_mfma_f32_16x16x32_bf16 v[60:63], a[232:235], a[140:143], v[60:63]
    v_cvt_pk_bf16_f32 v34, v80, v81
    v_cvt_pk_bf16_f32 v28, v72, v73
    v_mfma_f32_16x16x32_bf16 v[60:63], a[228:231], a[136:139], v[60:63]
    buffer_load_dwordx4 v7, s[12:15], s33 offen nt lds
    v_mfma_f32_16x16x32_bf16 v[48:51], a[240:243], v[22:25], v[48:51]
    v_cvt_pk_bf16_f32 v29, v74, v75
    v_mfma_f32_16x16x32_bf16 v[60:63], a[224:227], a[132:135], v[60:63]
    v_mfma_f32_16x16x32_bf16 v[52:55], a[224:227], a[108:111], v[52:55]
    ds_read_b128 a[224:227], v1 offset:7168
    v_add_u32 v103, 4096, v103
    v_mfma_f32_16x16x32_bf16 v[52:55], a[228:231], a[112:115], v[52:55]
    s_add_u32 s59, s33, 128
    v_mfma_f32_16x16x32_bf16 v[52:55], a[232:235], a[116:119], v[52:55]
    s_add_u32 m0, s38, 2048
    ds_read_b128 a[232:235], v1 offset:8192
    v_mfma_f32_16x16x32_bf16 v[48:51], a[244:247], v[28:31], v[48:51]
    ds_read_b128 a[228:231], v0 offset:8192
    v_mfma_f32_16x16x32_bf16 v[48:51], a[248:251], v[34:37], v[48:51]
    v_mfma_f32_16x16x32_bf16 v[48:51], a[252:255], v[40:43], v[48:51]
    s_waitcnt lgkmcnt(3)
    v_mfma_f32_16x16x32_bf16 v[56:59], a[212:215], a[96:99], 0
    buffer_load_dwordx4 v6, s[12:15], s59 offen nt lds
    v_mfma_f32_16x16x32_bf16 v[56:59], a[216:219], a[100:103], v[56:59]
    s_add_u32 m0, s38, 3072
    v_mfma_f32_16x16x32_bf16 v[56:59], a[220:223], a[104:107], v[56:59]
    s_nop 1
    v_cmp_lt_f32 vcc, s29, v48
    v_mfma_f32_16x16x32_bf16 v[64:67], a[220:223], a[128:131], 0
    buffer_load_dwordx4 v7, s[12:15], s59 offen nt lds
    v_mfma_f32_16x16x32_bf16 v[64:67], a[216:219], a[124:127], v[64:67]
    v_mfma_f32_16x16x32_bf16 v[64:67], a[212:215], a[120:123], v[64:67]
    s_nop 0
    s_cbranch_vccnz L_rs_start5b
L_ret_start5b:
    v_mfma_f32_16x16x32_bf16 v[72:75], a[212:215], a[144:147], 0
    v_fma_f32 v62, v62, s28, v10
    v_fma_f32 v54, v54, s28, v9
    v_mfma_f32_16x16x32_bf16 v[72:75], a[216:219], a[148:151], v[72:75]
    s_waitcnt vmcnt(13) lgkmcnt(0)
    v_fma_f32 v61, v61, s28, v10
    v_fma_f32 v53, v53, s28, v9
    v_mfma_f32_16x16x32_bf16 v[72:75], a[220:223], a[152:155], v[72:75]
    v_fma_f32 v63, v63, s28, v10
    v_fma_f32 v60, v60, s28, v10
    v_mfma_f32_16x16x32_bf16 v[80:83], a[220:223], a[176:179], 0
    s_barrier
    v_mfma_f32_16x16x32_bf16 v[80:83], a[216:219], a[172:175], v[80:83]
    s_add_u32 m0, s22, 0
    v_exp_f32 v60, v60
    v_mfma_f32_16x16x32_bf16 v[80:83], a[212:215], a[168:171], v[80:83]
    buffer_load_dwordx4 v6, s[4:7], s20 offen lds
    v_mfma_f32_16x16x32_bf16 v[88:91], a[212:215], a[192:195], 0
    ds_read_b64_tr_b16 a[212:213], v2 offset:18432
    s_add_u32 s20, s20, 128
    v_mfma_f32_16x16x32_bf16 v[88:91], a[216:219], a[196:199], v[88:91]
    ds_read_b64_tr_b16 a[214:215], v2 offset:12288
    s_add_u32 m0, s22, 1024
    v_mfma_f32_16x16x32_bf16 v[88:91], a[220:223], a[200:203], v[88:91]
    buffer_load_dwordx4 v6, s[4:7], s20 offen lds
    v_mfma_f32_16x16x32_bf16 v[88:91], a[224:227], a[204:207], v[88:91]
    v_exp_f32 v53, v53
    v_mfma_f32_16x16x32_bf16 v[88:91], a[228:231], a[208:211], v[88:91]
    v_exp_f32 v63, v63
    v_mfma_f32_16x16x32_bf16 v[88:91], a[232:235], v[92:95], v[88:91]
    ds_read_b64_tr_b16 a[216:217], v3 offset:18432
    v_fma_f32 v55, v55, s28, v9
    v_mfma_f32_16x16x32_bf16 v[80:83], a[232:235], a[188:191], v[80:83]
    s_add_u32 s20, s20, 128
    ds_read_b64_tr_b16 a[218:219], v3 offset:12288
    v_fma_f32 v52, v52, s28, v9
    v_mfma_f32_16x16x32_bf16 v[80:83], a[228:231], a[184:187], v[80:83]
    s_add_u32 m0, s22, 2048
    v_exp_f32 v54, v54
    v_mfma_f32_16x16x32_bf16 v[80:83], a[224:227], a[180:183], v[80:83]
    buffer_load_dwordx4 v6, s[4:7], s20 offen lds
    v_mfma_f32_16x16x32_bf16 v[72:75], a[224:227], a[156:159], v[72:75]
    v_exp_f32 v62, v62
    v_mfma_f32_16x16x32_bf16 v[72:75], a[228:231], a[160:163], v[72:75]
    v_exp_f32 v52, v52
    v_mfma_f32_16x16x32_bf16 v[72:75], a[232:235], a[164:167], v[72:75]
    v_exp_f32 v61, v61
    v_mfma_f32_16x16x32_bf16 v[64:67], a[232:235], a[140:143], v[64:67]
    v_exp_f32 v55, v55
    v_mfma_f32_16x16x32_bf16 v[64:67], a[228:231], a[136:139], v[64:67]
    ds_read_b64_tr_b16 a[220:221], v4 offset:18432
    v_cvt_pk_bf16_f32 v20, v60, v61
    v_mfma_f32_16x16x32_bf16 v[64:67], a[224:227], a[132:135], v[64:67]
    ds_read_b64_tr_b16 a[222:223], v4 offset:12288
    v_mfma_f32_16x16x32_bf16 v[56:59], a[224:227], a[108:111], v[56:59]
    ds_read_b64_tr_b16 a[224:225], v5 offset:18432
    v_cvt_pk_bf16_f32 v15, v54, v55
    v_mfma_f32_16x16x32_bf16 v[56:59], a[228:231], a[112:115], v[56:59]
    v_cvt_pk_bf16_f32 v14, v52, v53
    v_cvt_pk_bf16_f32 v21, v62, v63
    v_mfma_f32_16x16x32_bf16 v[56:59], a[232:235], a[116:119], v[56:59]
    ds_read_b64_tr_b16 a[226:227], v5 offset:12288
    s_add_u32 s20, s20, 12032
    s_branch L_loop5
L_start4:
    s_add_u32 m0, s22, 0
    s_nop 0
    buffer_load_dwordx4 v6, s[4:7], s20 offen lds
    s_add_u32 s20, s20, 128
    s_add_u32 m0, s22, 1024
    s_nop 0
    buffer_load_dwordx4 v6, s[4:7], s20 offen lds
    s_add_u32 s20, s20, 128
    s_add_u32 m0, s22, 2048
    s_nop 0
    buffer_load_dwordx4 v6, s[4:7], s20 offen lds
    s_add_u32 s20, s20, 12032
    s_add_u32 m0, s22, 12288
    s_nop 0
    buffer_load_dwordx4 v6, s[4:7], s20 offen lds
    s_add_u32 s20, s20, 128
    s_add_u32 m0, s22, 13312
    s_nop 0
    buffer_load_dwordx4 v6, s[4:7], s20 offen lds
    s_add_u32 s20, s20, 128
    s_add_u32 m0, s22, 14336
    s_nop 0
    buffer_load_dwordx4 v6, s[4:7], s20 offen lds
    s_add_u32 s20, s20, 12032
    s_add_u32 s48, s34, 0
    s_add_u32 m0, s38, 0
    s_nop 0
    buffer_load_dwordx4 v6, s[12:15], s48 offen nt lds
    s_add_u32 m0, s38, 1024
    s_nop 0
    buffer_load_dwordx4 v7, s[12:15], s48 offen nt lds
    s_add_u32 s48, s34, 128
    s_add_u32 m0, s38, 2048
    s_nop 0
    buffer_load_dwordx4 v6, s[12:15], s48 offen nt lds
    s_add_u32 m0, s38, 3072
    s_nop 0
    buffer_load_dwordx4 v7, s[12:15], s48 offen nt lds
    s_add_u32 s48, s34, 256
    s_add_u32 m0, s38, 4096
    s_nop 0
    buffer_load_dwordx4 v6, s[12:15], s48 offen nt lds
    s_add_u32 m0, s38, 5120
    s_nop 0
    buffer_load_dwordx4 v7, s[12:15], s48 offen nt lds
    s_add_u32 s48, s34, 6144
    s_add_u32 m0, s38, 6144
    s_nop 0
    buffer_load_dwordx4 v6, s[12:15], s48 offen nt lds
    s_add_u32 m0, s38, 7168
    s_nop 0
    buffer_load_dwordx4 v7, s[12:15], s48 offen nt lds
    s_add_u32 s48, s34, 6272
    s_add_u32 m0, s38, 8192
    s_nop 0
    buffer_load_dwordx4 v6, s[12:15], s48 offen nt lds
    s_add_u32 m0, s38, 9216
    s_nop 0
    buffer_load_dwordx4 v7, s[12:15], s48 offen nt lds
    s_add_u32 s48, s34, 6400
    s_add_u32 m0, s38, 10240
    s_nop 0
    buffer_load_dwordx4 v6, s[12:15], s48 offen nt lds
    s_add_u32 m0, s38, 11264
    s_nop 0
    buffer_load_dwordx4 v7, s[12:15], s48 offen nt lds
    s_add_u32 s48, s34, 12288
    s_add_u32 m0, s38, 12288
    s_nop 0
    buffer_load_dwordx4 v6, s[12:15], s48 offen nt lds
    s_add_u32 m0, s38, 13312
    s_nop 0
    buffer_load_dwordx4 v7, s[12:15], s48 offen nt lds
    s_add_u32 s48, s34, 12416
    s_add_u32 m0, s38, 14336
    s_nop 0
    buffer_load_dwordx4 v6, s[12:15], s48 offen nt lds
    s_add_u32 m0, s38, 15360
    s_nop 0
    buffer_load_dwordx4 v7, s[12:15], s48 offen nt lds
    s_add_u32 s48, s34, 12544
    s_add_u32 m0, s38, 16384
    s_nop 0
    buffer_load_dwordx4 v6, s[12:15], s48 offen nt lds
    s_add_u32 m0, s38, 17408
    s_nop 0
    buffer_load_dwordx4 v7, s[12:15], s48 offen nt lds
    v_and_b32 v96, 15, v111
    v_lshrrev_b32 v97, 4, v111
    v_lshrrev_b32 v98, 3, v96
    v_and_b32 v99, 7, v96
    v_lshlrev_b32 v0, 7, v99
    v_bfe_u32 v99, v96, 1, 2
    v_lshlrev_b32 v99, 1, v99
    v_mul_u32_u24 v100, 5, v98
    v_xor_b32 v99, v99, v100
    v_xor_b32 v99, v99, v97
    v_lshl_add_u32 v0, v99, 4, v0
    v_mul_u32_u24 v100, 3072, v98
    v_add_u32 v0, v100, v0
    v_xor_b32 v1, 64, v0
    v_lshrrev_b32 v98, 1, v97
    v_mul_u32_u24 v2, 3072, v98
    v_and_b32 v99, 1, v97
    v_bfe_u32 v100, v111, 2, 2
    v_lshl_add_u32 v96, v99, 2, v100
    v_lshl_add_u32 v2, v96, 7, v2
    v_lshrrev_b32 v96, 1, v96
    v_lshlrev_b32 v96, 1, v96
    v_mul_u32_u24 v98, 5, v98
    v_xor_b32 v96, v96, v98
    v_bfe_u32 v99, v111, 1, 1
    v_xor_b32 v96, v96, v99
    v_lshl_add_u32 v2, v96, 4, v2
    v_and_b32 v99, 1, v111
    v_lshl_add_u32 v2, v99, 3, v2
    v_add_u32 v2, 24576, v2
    v_xor_b32 v3, 32, v2
    v_xor_b32 v4, 64, v2
    v_xor_b32 v5, 96, v2
    v_lshl_add_u32 v103, v111, 4, s38
    v_and_b32 v96, 15, v111
    s_mov_b32 s42, 0x1011
    v_bfe_i32 v97, s42, v96, 1
    v_and_b32 v97, 0x3f803f80, v97
    v_accvgpr_write_b32 a236, v97
    v_accvgpr_write_b32 a237, v97
    v_accvgpr_write_b32 a238, v97
    v_accvgpr_write_b32 a239, v97
    s_mov_b32 s42, 0x3222
    v_bfe_i32 v97, s42, v96, 1
    v_and_b32 v97, 0x3f803f80, v97
    v_accvgpr_write_b32 a240, v97
    v_accvgpr_write_b32 a241, v97
    v_accvgpr_write_b32 a242, v97
    v_accvgpr_write_b32 a243, v97
    s_mov_b32 s42, 0x5444
    v_bfe_i32 v97, s42, v96, 1
    v_and_b32 v97, 0x3f803f80, v97
    v_accvgpr_write_b32 a244, v97
    v_accvgpr_write_b32 a245, v97
    v_accvgpr_write_b32 a246, v97
    v_accvgpr_write_b32 a247, v97
    s_mov_b32 s42, 0x9888
    v_bfe_i32 v97, s42, v96, 1
    v_and_b32 v97, 0x3f803f80, v97
    v_accvgpr_write_b32 a248, v97
    v_accvgpr_write_b32 a249, v97
    v_accvgpr_write_b32 a250, v97
    v_accvgpr_write_b32 a251, v97
    s_mov_b32 s42, 0x1100
    v_bfe_i32 v97, s42, v96, 1
    v_and_b32 v97, 0x3f803f80, v97
    v_accvgpr_write_b32 a252, v97
    v_accvgpr_write_b32 a253, v97
    v_accvgpr_write_b32 a254, v97
    v_accvgpr_write_b32 a255, v97
    s_waitcnt vmcnt(18)
    s_barrier
    s_waitcnt vmcnt(12)
    s_add_u32 s48, s34, 18432
    s_add_u32 m0, s38, 18432
    s_nop 0
    buffer_load_dwordx4 v6, s[12:15], s48 offen nt lds
    s_add_u32 m0, s38, 19456
    s_nop 0
    buffer_load_dwordx4 v7, s[12:15], s48 offen nt lds
    v_lshrrev_b32 v105, 11, v0
    s_add_u32 s48, s34, 18560
    s_add_u32 m0, s38, 20480
    v_and_b32 v104, 0x3ff, v0
    buffer_load_dwordx4 v6, s[12:15], s48 offen nt lds
    v_xor_b32 v105, s65, v105
    s_add_u32 m0, s38, 21504
    v_lshl_add_u32 v104, v105, 10, v104
    ds_read_b128 a[212:215], v0 offset:0
    v_add_u32 v104, s38, v104
    buffer_load_dwordx4 v7, s[12:15], s48 offen nt lds
    ds_read_b128 a[112:115], v104 offset:4096
    ds_read_b128 a[224:227], v1 offset:1024
    s_add_u32 s48, s34, 18688
    s_add_u32 m0, s38, 22528
    ds_read_b128 a[104:107], v104 offset:2048
    ds_read_b128 a[220:223], v0 offset:1024
    buffer_load_dwordx4 v6, s[12:15], s48 offen nt lds
    s_add_u32 m0, s38, 23552
    v_xor_b32 v105, 64, v104
    ds_read_b128 a[96:99], v104 offset:0
    ds_read_b128 a[216:219], v1 offset:0
    ds_read_b128 a[100:103], v105 offset:0
    buffer_load_dwordx4 v7, s[12:15], s48 offen nt lds
    s_waitcnt lgkmcnt(2)
    v_mfma_f32_16x16x32_bf16 v[52:55], a[212:215], a[96:99], 0
    s_waitcnt lgkmcnt(0)
    ds_read_b128 a[108:111], v105 offset:2048
    v_mfma_f32_16x16x32_bf16 v[52:55], a[216:219], a[100:103], v[52:55]
    ds_read_b128 a[228:231], v0 offset:2048
    v_mfma_f32_16x16x32_bf16 v[52:55], a[220:223], a[104:107], v[52:55]
    ds_read_b128 a[232:235], v1 offset:2048
    s_waitcnt lgkmcnt(2)
    v_mfma_f32_16x16x32_bf16 v[52:55], a[224:227], a[108:111], v[52:55]
    ds_read_b128 a[212:215], v0 offset:6144
    s_waitcnt lgkmcnt(2)
    v_mfma_f32_16x16x32_bf16 v[52:55], a[228:231], a[112:115], v[52:55]
    ds_read_b128 a[116:119], v105 offset:4096
    s_waitcnt lgkmcnt(0)
    v_mfma_f32_16x16x32_bf16 v[52:55], a[232:235], a[116:119], v[52:55]
    ds_read_b128 a[216:219], v1 offset:6144
    ds_read_b128 a[220:223], v0 offset:7168
    v_mfma_f32_16x16x32_bf16 v[56:59], a[212:215], a[96:99], 0
    ds_read_b128 a[224:227], v1 offset:7168
    s_waitcnt lgkmcnt(2)
    v_mfma_f32_16x16x32_bf16 v[56:59], a[216:219], a[100:103], v[56:59]
    s_waitcnt lgkmcnt(1)
    ds_read_b128 a[232:235], v1 offset:8192
    v_mfma_f32_16x16x32_bf16 v[56:59], a[220:223], a[104:107], v[56:59]
    s_waitcnt lgkmcnt(1)
    ds_read_b128 a[216:219], v1 offset:12288
    v_max3_f32 v96, v52, v53, v54
    v_mfma_f32_16x16x32_bf16 v[56:59], a[224:227], a[108:111], v[56:59]
    ds_read_b128 a[228:231], v0 offset:8192
    ds_read_b128 a[212:215], v0 offset:12288
    s_waitcnt lgkmcnt(1)
    v_mfma_f32_16x16x32_bf16 v[56:59], a[228:231], a[112:115], v[56:59]
    ds_read_b128 a[224:227], v1 offset:13312
    v_mfma_f32_16x16x32_bf16 v[56:59], a[232:235], a[116:119], v[56:59]
    ds_read_b128 a[220:223], v0 offset:13312
    s_nop 6
    v_max3_f32 v96, v96, v55, v56
    v_max3_f32 v96, v96, v57, v58
    v_max_f32 v96, v96, v59
    ds_read_b128 a[232:235], v1 offset:14336
    v_mov_b32 v97, v96
    s_nop 1
    v_permlane32_swap_b32 v97, v96
    v_max_f32 v96, v96, v97
    v_mov_b32 v97, v96
    s_nop 1
    v_permlane16_swap_b32 v97, v96
    v_max_f32 v96, v96, v97
    v_mul_f32_e64 v9, -s28, v96
    v_fma_f32 v56, v56, s28, v9
    v_fma_f32 v57, v57, s28, v9
    v_fma_f32 v52, v52, s28, v9
    v_fma_f32 v53, v53, s28, v9
    v_fma_f32 v54, v54, s28, v9
    v_fma_f32 v58, v58, s28, v9
    v_fma_f32 v59, v59, s28, v9
    v_exp_f32 v52, v52
    v_exp_f32 v57, v57
    v_fma_f32 v55, v55, s28, v9
    v_exp_f32 v58, v58
    v_exp_f32 v55, v55
    v_exp_f32 v54, v54
    v_exp_f32 v53, v53
    s_nop 0
    v_cvt_pk_bf16_f32 v14, v52, v53
    v_exp_f32 v59, v59
    v_cvt_pk_bf16_f32 v15, v54, v55
    s_waitcnt lgkmcnt(0)
    v_mfma_f32_16x16x32_bf16 v[52:55], a[212:215], a[96:99], 0
    ds_read_b128 a[228:231], v0 offset:14336
    v_mfma_f32_16x16x32_bf16 v[52:55], a[216:219], a[100:103], v[52:55]
    s_waitcnt vmcnt(12)
    s_add_u32 m0, s22, 24576
    ds_read_b128 a[136:139], v104 offset:10240
    buffer_load_dwordx4 v6, s[8:11], s21 offen lds
    s_add_u32 s21, s21, 128
    s_add_u32 m0, s22, 25600
    v_mfma_f32_16x16x32_bf16 v[52:55], a[220:223], a[104:107], v[52:55]
    ds_read_b128 a[216:219], v1 offset:18432
    buffer_load_dwordx4 v6, s[8:11], s21 offen lds
    s_add_u32 s21, s21, 128
    s_add_u32 m0, s22, 26624
    v_mfma_f32_16x16x32_bf16 v[52:55], a[224:227], a[108:111], v[52:55]
    v_exp_f32 v56, v56
    buffer_load_dwordx4 v6, s[8:11], s21 offen lds
    v_cvt_pk_bf16_f32 v17, v58, v59
    ds_read_b128 a[212:215], v0 offset:18432
    s_waitcnt lgkmcnt(3)
    v_mfma_f32_16x16x32_bf16 v[52:55], a[228:231], a[112:115], v[52:55]
    ds_read_b128 a[120:123], v104 offset:6144
    v_cvt_pk_bf16_f32 v16, v56, v57
    v_mfma_f32_16x16x32_bf16 v[52:55], a[232:235], a[116:119], v[52:55]
    ds_read_b128 a[220:223], v0 offset:19456
    ds_read_b128 a[228:231], v0 offset:20480
    ds_read_b128 a[124:127], v105 offset:6144
    s_waitcnt lgkmcnt(4)
    v_mfma_f32_16x16x32_bf16 v[56:59], a[212:215], a[96:99], 0
    ds_read_b128 a[232:235], v1 offset:20480
    v_mfma_f32_16x16x32_bf16 v[56:59], a[216:219], a[100:103], v[56:59]
    s_add_u32 s21, s21, 12032
    ds_read_b128 a[224:227], v1 offset:19456
    v_fma_f32 v55, v55, s28, v9
    s_waitcnt lgkmcnt(3)
    v_mfma_f32_16x16x32_bf16 v[56:59], a[220:223], a[104:107], v[56:59]
    ds_read_b128 a[212:215], v0 offset:0
    s_waitcnt lgkmcnt(1)
    v_mfma_f32_16x16x32_bf16 v[56:59], a[224:227], a[108:111], v[56:59]
    v_fma_f32 v53, v53, s28, v9
    ds_read_b128 a[216:219], v1 offset:0
    v_mfma_f32_16x16x32_bf16 v[56:59], a[228:231], a[112:115], v[56:59]
    ds_read_b128 a[224:227], v1 offset:1024
    ds_read_b128 a[220:223], v0 offset:1024
    v_mfma_f32_16x16x32_bf16 v[56:59], a[232:235], a[116:119], v[56:59]
    s_waitcnt lgkmcnt(3)
    ds_read_b128 a[232:235], v1 offset:2048
    v_mfma_f32_16x16x32_bf16 v[60:63], a[212:215], a[120:123], 0
    v_exp_f32 v53, v53
    ds_read_b128 a[128:131], v104 offset:8192
    ds_read_b128 a[140:143], v105 offset:10240
    s_waitcnt lgkmcnt(5)
    v_mfma_f32_16x16x32_bf16 v[60:63], a[216:219], a[124:127], v[60:63]
    ds_read_b128 a[132:135], v105 offset:8192
    v_mfma_f32_16x16x32_bf16 v[44:47], a[236:239], v[14:17], 0
    ds_read_b128 a[228:231], v0 offset:2048
    s_waitcnt lgkmcnt(3)
    v_mfma_f32_16x16x32_bf16 v[60:63], a[220:223], a[128:131], v[60:63]
    ds_read_b128 a[212:215], v0 offset:6144
    s_waitcnt lgkmcnt(2)
    v_mfma_f32_16x16x32_bf16 v[60:63], a[224:227], a[132:135], v[60:63]
    ds_read_b128 a[224:227], v1 offset:7168
    s_waitcnt lgkmcnt(2)
    v_mfma_f32_16x16x32_bf16 v[60:63], a[228:231], a[136:139], v[60:63]
    ds_read_b128 a[220:223], v0 offset:7168
    v_mfma_f32_16x16x32_bf16 v[60:63], a[232:235], a[140:143], v[60:63]
    ds_read_b128 a[216:219], v1 offset:6144
    s_waitcnt lgkmcnt(3)
    v_mfma_f32_16x16x32_bf16 v[64:67], a[212:215], a[120:123], 0
    ds_read_b128 a[228:231], v0 offset:8192
    s_waitcnt lgkmcnt(1)
    v_mfma_f32_16x16x32_bf16 v[64:67], a[216:219], a[124:127], v[64:67]
    ds_read_b128 a[212:215], v0 offset:12288
    v_mfma_f32_16x16x32_bf16 v[64:67], a[220:223], a[128:131], v[64:67]
    ds_read_b128 a[232:235], v1 offset:8192
    v_mfma_f32_16x16x32_bf16 v[64:67], a[224:227], a[132:135], v[64:67]
    s_waitcnt lgkmcnt(2)
    ds_read_b128 a[224:227], v1 offset:13312
    v_exp_f32 v55, v55
    ds_read_b128 a[220:223], v0 offset:13312
    v_mfma_f32_16x16x32_bf16 v[64:67], a[228:231], a[136:139], v[64:67]
    ds_read_b128 a[216:219], v1 offset:12288
    s_waitcnt lgkmcnt(3)
    v_mfma_f32_16x16x32_bf16 v[64:67], a[232:235], a[140:143], v[64:67]
    v_max3_f32 v98, v60, v61, v62
    ds_read_b128 a[232:235], v1 offset:14336
    s_nop 5
    v_max3_f32 v98, v98, v63, v64
    v_max3_f32 v98, v98, v65, v66
    v_max_f32 v98, v98, v67
    v_mov_b32 v99, v98
    s_nop 1
    v_permlane32_swap_b32 v99, v98
    v_max_f32 v98, v98, v99
    v_mov_b32 v99, v98
    s_nop 1
    v_permlane16_swap_b32 v99, v98
    v_max_f32 v98, v98, v99
    v_mul_f32_e64 v10, -s28, v98
    v_fma_f32 v62, v62, s28, v10
    v_fma_f32 v64, v64, s28, v10
    v_fma_f32 v63, v63, s28, v10
    v_exp_f32 v62, v62
    v_fma_f32 v60, v60, s28, v10
    v_exp_f32 v60, v60
    v_fma_f32 v67, v67, s28, v10
    v_fma_f32 v66, v66, s28, v10
    v_fma_f32 v54, v54, s28, v9
    v_exp_f32 v64, v64
    v_fma_f32 v61, v61, s28, v10
    v_fma_f32 v65, v65, s28, v10
    v_exp_f32 v63, v63
    v_exp_f32 v65, v65
    ds_read_b128 a[228:231], v0 offset:14336
    v_exp_f32 v61, v61
    v_cvt_pk_bf16_f32 v21, v62, v63
    v_exp_f32 v67, v67
    v_cvt_pk_bf16_f32 v20, v60, v61
    v_exp_f32 v66, v66
    s_waitcnt vmcnt(9)
    s_add_u32 m0, s22, 36864
    s_nop 0
    buffer_load_dwordx4 v6, s[8:11], s21 offen lds
    s_add_u32 s21, s21, 128
    s_add_u32 m0, s22, 37888
    v_mfma_f32_16x16x32_bf16 v[60:63], a[212:215], a[120:123], 0
    buffer_load_dwordx4 v6, s[8:11], s21 offen lds
    s_add_u32 s21, s21, 128
    ds_read_b128 a[212:215], v0 offset:18432
    s_waitcnt lgkmcnt(1)
    v_mfma_f32_16x16x32_bf16 v[60:63], a[216:219], a[124:127], v[60:63]
    s_add_u32 m0, s22, 38912
    ds_read_b128 a[144:147], v104 offset:12288
    v_mfma_f32_16x16x32_bf16 v[60:63], a[220:223], a[128:131], v[60:63]
    buffer_load_dwordx4 v6, s[8:11], s21 offen lds
    ds_read_b128 a[160:163], v104 offset:16384
    ds_read_b128 a[216:219], v1 offset:18432
    ds_read_b128 a[220:223], v0 offset:19456
    v_fma_f32 v52, v52, s28, v9
    v_exp_f32 v54, v54
    v_mfma_f32_16x16x32_bf16 v[60:63], a[224:227], a[132:135], v[60:63]
    ds_read_b128 a[224:227], v1 offset:19456
    v_cvt_pk_bf16_f32 v22, v64, v65
    v_mfma_f32_16x16x32_bf16 v[60:63], a[228:231], a[136:139], v[60:63]
    ds_read_b128 a[156:159], v105 offset:14336
    v_mfma_f32_16x16x32_bf16 v[60:63], a[232:235], a[140:143], v[60:63]
    ds_read_b128 a[228:231], v0 offset:20480
    v_cvt_pk_bf16_f32 v23, v66, v67
    s_waitcnt lgkmcnt(7)
    v_mfma_f32_16x16x32_bf16 v[64:67], a[212:215], a[120:123], 0
    s_nop 3
    v_fma_f32 v60, v60, s28, v10
    ds_read_b128 a[148:151], v105 offset:12288
    v_exp_f32 v60, v60
    ds_read_b128 a[212:215], v0 offset:0
    s_waitcnt lgkmcnt(5)
    v_mfma_f32_16x16x32_bf16 v[64:67], a[216:219], a[124:127], v[64:67]
    ds_read_b128 a[216:219], v1 offset:0
    v_mfma_f32_16x16x32_bf16 v[64:67], a[220:223], a[128:131], v[64:67]
    s_waitcnt lgkmcnt(5)
    ds_read_b128 a[232:235], v1 offset:20480
    v_mfma_f32_16x16x32_bf16 v[64:67], a[224:227], a[132:135], v[64:67]
    ds_read_b128 a[220:223], v0 offset:1024
    s_waitcnt lgkmcnt(5)
    v_mfma_f32_16x16x32_bf16 v[64:67], a[228:231], a[136:139], v[64:67]
    ds_read_b128 a[152:155], v104 offset:14336
    s_waitcnt lgkmcnt(2)
    v_mfma_f32_16x16x32_bf16 v[64:67], a[232:235], a[140:143], v[64:67]
    ds_read_b128 a[224:227], v1 offset:1024
    ds_read_b128 a[164:167], v105 offset:16384
    v_mfma_f32_16x16x32_bf16 v[68:71], a[212:215], a[144:147], 0
    ds_read_b128 a[212:215], v0 offset:6144
    ds_read_b128 a[232:235], v1 offset:2048
    v_mfma_f32_16x16x32_bf16 v[68:71], a[216:219], a[148:151], v[68:71]
    s_waitcnt lgkmcnt(4)
    ds_read_b128 a[228:231], v0 offset:2048
    v_mfma_f32_16x16x32_bf16 v[68:71], a[220:223], a[152:155], v[68:71]
    ds_read_b128 a[216:219], v1 offset:6144
    s_waitcnt lgkmcnt(5)
    v_mfma_f32_16x16x32_bf16 v[68:71], a[224:227], a[156:159], v[68:71]
    ds_read_b128 a[220:223], v0 offset:7168
    s_waitcnt lgkmcnt(2)
    v_mfma_f32_16x16x32_bf16 v[68:71], a[228:231], a[160:163], v[68:71]
    ds_read_b128 a[224:227], v1 offset:7168
    v_mfma_f32_16x16x32_bf16 v[68:71], a[232:235], a[164:167], v[68:71]
    ds_read_b128 a[228:231], v0 offset:8192
    v_mfma_f32_16x16x32_bf16 v[72:75], a[212:215], a[144:147], 0
    s_waitcnt lgkmcnt(3)
    ds_read_b128 a[232:235], v1 offset:8192
    s_nop 4
    v_max3_f32 v96, v68, v69, v70
    v_mfma_f32_16x16x32_bf16 v[72:75], a[216:219], a[148:151], v[72:75]
    ds_read_b128 a[212:215], v0 offset:12288
    s_waitcnt lgkmcnt(4)
    v_mfma_f32_16x16x32_bf16 v[72:75], a[220:223], a[152:155], v[72:75]
    ds_read_b128 a[216:219], v1 offset:12288
    s_waitcnt lgkmcnt(4)
    v_mfma_f32_16x16x32_bf16 v[72:75], a[224:227], a[156:159], v[72:75]
    ds_read_b128 a[220:223], v0 offset:13312
    s_waitcnt lgkmcnt(4)
    v_mfma_f32_16x16x32_bf16 v[72:75], a[228:231], a[160:163], v[72:75]
    ds_read_b128 a[224:227], v1 offset:13312
    s_waitcnt lgkmcnt(4)
    v_mfma_f32_16x16x32_bf16 v[72:75], a[232:235], a[164:167], v[72:75]
    s_nop 7
    v_max3_f32 v96, v96, v71, v72
    v_max3_f32 v96, v96, v73, v74
    v_max_f32 v96, v96, v75
    v_mov_b32 v97, v96
    s_nop 1
    v_permlane32_swap_b32 v97, v96
    v_fma_f32 v61, v61, s28, v10
    ds_read_b128 a[232:235], v1 offset:14336
    v_max_f32 v96, v96, v97
    v_mov_b32 v97, v96
    s_nop 1
    v_permlane16_swap_b32 v97, v96
    v_max_f32 v96, v96, v97
    v_mul_f32_e64 v11, -s28, v96
    v_fma_f32 v70, v70, s28, v11
    v_fma_f32 v68, v68, s28, v11
    v_fma_f32 v69, v69, s28, v11
    v_fma_f32 v71, v71, s28, v11
    v_exp_f32 v71, v71
    v_exp_f32 v68, v68
    v_exp_f32 v70, v70
    v_exp_f32 v69, v69
    s_nop 0
    v_cvt_pk_bf16_f32 v26, v68, v69
    v_fma_f32 v72, v72, s28, v11
    v_fma_f32 v74, v74, s28, v11
    v_cvt_pk_bf16_f32 v27, v70, v71
    s_waitcnt lgkmcnt(1)
    v_mfma_f32_16x16x32_bf16 v[68:71], a[212:215], a[144:147], 0
    ds_read_b128 a[212:215], v0 offset:18432
    v_mfma_f32_16x16x32_bf16 v[68:71], a[216:219], a[148:151], v[68:71]
    v_fma_f32 v75, v75, s28, v11
    ds_read_b128 a[216:219], v1 offset:18432
    v_fma_f32 v73, v73, s28, v11
    v_mfma_f32_16x16x32_bf16 v[68:71], a[220:223], a[152:155], v[68:71]
    v_exp_f32 v73, v73
    v_exp_f32 v74, v74
    v_exp_f32 v72, v72
    v_exp_f32 v61, v61
    v_exp_f32 v75, v75
    v_cvt_pk_bf16_f32 v28, v72, v73
    ds_read_b128 a[220:223], v0 offset:19456
    v_cvt_pk_bf16_f32 v29, v74, v75
    v_mfma_f32_16x16x32_bf16 v[68:71], a[224:227], a[156:159], v[68:71]
    ds_read_b128 a[228:231], v0 offset:14336
    s_add_u32 s21, s21, 12032
    s_waitcnt lgkmcnt(0)
    v_mfma_f32_16x16x32_bf16 v[68:71], a[228:231], a[160:163], v[68:71]
    ds_read_b128 a[224:227], v1 offset:19456
    v_mfma_f32_16x16x32_bf16 v[68:71], a[232:235], a[164:167], v[68:71]
    ds_read_b128 a[228:231], v0 offset:20480
    v_mfma_f32_16x16x32_bf16 v[72:75], a[212:215], a[144:147], 0
    v_cvt_pk_bf16_f32 v19, v54, v55
    ds_read_b128 a[232:235], v1 offset:20480
    v_mfma_f32_16x16x32_bf16 v[72:75], a[216:219], a[148:151], v[72:75]
    ds_read_b128 a[212:215], v0 offset:0
    v_mfma_f32_16x16x32_bf16 v[72:75], a[220:223], a[152:155], v[72:75]
    v_exp_f32 v52, v52
    s_nop 0
    v_cvt_pk_bf16_f32 v18, v52, v53
    ds_read_b128 a[220:223], v0 offset:1024
    s_waitcnt lgkmcnt(4)
    v_mfma_f32_16x16x32_bf16 v[72:75], a[224:227], a[156:159], v[72:75]
    ds_read_b128 a[216:219], v1 offset:0
    s_waitcnt vmcnt(6)
    ds_read_b128 a[168:171], v104 offset:18432
    ds_read_b128 a[172:175], v105 offset:18432
    s_waitcnt lgkmcnt(4)
    v_mfma_f32_16x16x32_bf16 v[72:75], a[228:231], a[160:163], v[72:75]
    ds_read_b128 a[176:179], v104 offset:20480
    ds_read_b128 a[180:183], v105 offset:20480
    ds_read_b128 a[228:231], v0 offset:2048
    v_mfma_f32_16x16x32_bf16 v[72:75], a[232:235], a[164:167], v[72:75]
    ds_read_b128 a[224:227], v1 offset:1024
    v_mfma_f32_16x16x32_bf16 v[44:47], a[240:243], v[20:23], v[44:47]
    ds_read_b128 a[232:235], v1 offset:2048
    ds_read_b128 a[184:187], v104 offset:22528
    ds_read_b128 a[188:191], v105 offset:22528
    s_waitcnt lgkmcnt(8)
    v_mfma_f32_16x16x32_bf16 v[76:79], a[212:215], a[168:171], 0
    s_waitcnt lgkmcnt(7)
    ds_read_b128 a[212:215], v0 offset:6144
    v_mfma_f32_16x16x32_bf16 v[76:79], a[216:219], a[172:175], v[76:79]
    s_waitcnt lgkmcnt(6)
    ds_read_b128 a[216:219], v1 offset:6144
    v_mfma_f32_16x16x32_bf16 v[76:79], a[220:223], a[176:179], v[76:79]
    s_waitcnt lgkmcnt(5)
    ds_read_b128 a[220:223], v0 offset:7168
    v_cvt_pk_bf16_f32 v24, v60, v61
    v_mfma_f32_16x16x32_bf16 v[76:79], a[224:227], a[180:183], v[76:79]
    ds_read_b128 a[224:227], v1 offset:7168
    s_waitcnt lgkmcnt(4)
    v_mfma_f32_16x16x32_bf16 v[76:79], a[228:231], a[184:187], v[76:79]
    ds_read_b128 a[228:231], v0 offset:8192
    v_mfma_f32_16x16x32_bf16 v[76:79], a[232:235], a[188:191], v[76:79]
    ds_read_b128 a[232:235], v1 offset:8192
    s_waitcnt lgkmcnt(5)
    v_mfma_f32_16x16x32_bf16 v[80:83], a[212:215], a[168:171], 0
    s_nop 4
    v_max3_f32 v98, v76, v77, v78
    s_waitcnt lgkmcnt(3)
    v_mfma_f32_16x16x32_bf16 v[80:83], a[216:219], a[172:175], v[80:83]
    v_mfma_f32_16x16x32_bf16 v[80:83], a[220:223], a[176:179], v[80:83]
    s_waitcnt vmcnt(63) lgkmcnt(0)
    s_barrier
    ds_read_b128 a[216:219], v1 offset:12288
    v_mfma_f32_16x16x32_bf16 v[80:83], a[224:227], a[180:183], v[80:83]
    s_add_u32 m0, s22, 0
    ds_read_b128 a[220:223], v0 offset:13312
    buffer_load_dwordx4 v6, s[4:7], s20 offen lds
    s_add_u32 s20, s20, 128
    v_mfma_f32_16x16x32_bf16 v[80:83], a[228:231], a[184:187], v[80:83]
    s_add_u32 m0, s22, 1024
    ds_read_b128 a[212:215], v0 offset:12288
    buffer_load_dwordx4 v6, s[4:7], s20 offen lds
    v_mfma_f32_16x16x32_bf16 v[80:83], a[232:235], a[188:191], v[80:83]
    s_add_u32 s20, s20, 128
    s_add_u32 m0, s22, 2048
    ds_read_b128 a[232:235], v1 offset:14336
    buffer_load_dwordx4 v6, s[4:7], s20 offen lds
    ds_read_b128 a[228:231], v0 offset:14336
    s_add_u32 s20, s20, 12032
    s_mov_b32 s39, s64
    ds_read_b128 a[224:227], v1 offset:13312
    v_max3_f32 v98, v98, v79, v80
    v_max3_f32 v98, v98, v81, v82
    v_max_f32 v98, v98, v83
    v_mov_b32 v99, v98
    s_add_u32 s37, s37, 1
    s_bitcmp1_b32 s63, s37
    v_permlane32_swap_b32 v99, v98
    v_max_f32 v98, v98, v99
    v_mov_b32 v99, v98
    s_cselect_b32 s62, 4294770688, 0
    s_cselect_b32 s42, 0, 325632
    v_permlane16_swap_b32 v99, v98
    v_max_f32 v98, v98, v99
    v_mul_f32_e64 v12, -s28, v98
    v_fma_f32 v79, v79, s28, v12
    v_fma_f32 v77, v77, s28, v12
    v_fma_f32 v78, v78, s28, v12
    v_fma_f32 v76, v76, s28, v12
    v_exp_f32 v77, v77
    v_exp_f32 v76, v76
    v_exp_f32 v78, v78
    v_exp_f32 v79, v79
    s_add_u32 s35, s35, s42
    v_fma_f32 v81, v81, s28, v12
    v_cvt_pk_bf16_f32 v32, v76, v77
    v_cvt_pk_bf16_f32 v33, v78, v79
    s_waitcnt lgkmcnt(2)
    v_mfma_f32_16x16x32_bf16 v[76:79], a[212:215], a[168:171], 0
    s_lshl_b32 s42, s37, 1
    ds_read_b128 a[212:215], v0 offset:18432
    s_lshr_b32 s42, s31, s42
    v_mfma_f32_16x16x32_bf16 v[76:79], a[216:219], a[172:175], v[76:79]
    s_and_b32 s42, s42, 3
    ds_read_b128 a[216:219], v1 offset:18432
    s_add_u32 s42, s42, s36
    v_mfma_f32_16x16x32_bf16 v[76:79], a[220:223], a[176:179], v[76:79]
    s_waitcnt lgkmcnt(2)
    ds_read_b128 a[220:223], v0 offset:19456
    s_sub_u32 s43, s42, 3
    v_mfma_f32_16x16x32_bf16 v[76:79], a[224:227], a[180:183], v[76:79]
    s_cmp_ge_u32 s42, 3
    s_cselect_b32 s42, s43, s42
    ds_read_b128 a[224:227], v1 offset:19456
    v_mfma_f32_16x16x32_bf16 v[76:79], a[228:231], a[184:187], v[76:79]
    s_mul_i32 s44, s3, 5
    s_mov_b32 s32, 1
    ds_read_b128 a[228:231], v0 offset:20480
    v_mfma_f32_16x16x32_bf16 v[76:79], a[232:235], a[188:191], v[76:79]
    s_lshl_b32 s43, s3, 2
    ds_read_b128 a[232:235], v1 offset:20480
    v_fma_f32 v83, v83, s28, v12
    s_add_u32 s45, s43, 21
    s_cmp_eq_u32 s3, 0
    v_fma_f32 v82, v82, s28, v12
    s_cselect_b32 s45, 20, s45
    s_cselect_b32 s33, 1, 0
    s_cmp_eq_u32 s42, 1
    s_cselect_b32 s44, s45, s44
    v_fma_f32 v80, v80, s28, v12
    v_exp_f32 v81, v81
    s_cselect_b32 s32, s33, s32
    v_exp_f32 v82, v82
    s_add_u32 s45, s43, 37
    s_cmp_eq_u32 s42, 2
    v_exp_f32 v83, v83
    s_cselect_b32 s44, s45, s44
    s_cselect_b32 s32, 0, s32
    s_mul_i32 s44, s44, 6144
    s_add_u32 s33, s35, s44
    s_mul_i32 s42, s32, 6144
    s_add_u32 s42, s42, 24576
    s_add_u32 s42, s42, s33
    s_cmp_ge_u32 s37, 6
    v_exp_f32 v80, v80
    s_cselect_b32 s14, 0, s42
    s_add_u32 s24, s67, 6144
    s_add_u32 s25, s33, 6144
    s_add_u32 s23, s38, 6144
    v_cvt_pk_bf16_f32 v34, v80, v81
    s_mov_b32 s27, 0x30c30
    v_cvt_pk_bf16_f32 v35, v82, v83
    s_mov_b32 s89, 0xaaaaaaaa
    s_mov_b32 s30, 0
    s_waitcnt vmcnt(6) lgkmcnt(0)
    v_mfma_f32_16x16x32_bf16 v[80:83], a[212:215], a[168:171], 0
    s_barrier
    ds_read_b64_tr_b16 a[212:213], v2 offset:0
    ds_read_b64_tr_b16 a[214:215], v2 offset:6144
    s_add_u32 m0, s22, 12288
    v_mfma_f32_16x16x32_bf16 v[80:83], a[216:219], a[172:175], v[80:83]
    buffer_load_dwordx4 v6, s[4:7], s20 offen lds
    ds_read_b64_tr_b16 a[216:217], v3 offset:0
    v_mfma_f32_16x16x32_bf16 v[80:83], a[220:223], a[176:179], v[80:83]
    s_add_u32 s20, s20, 128
    ds_read_b64_tr_b16 a[218:219], v3 offset:6144
    v_mfma_f32_16x16x32_bf16 v[44:47], a[244:247], v[26:29], v[44:47]
    ds_read_b64_tr_b16 a[220:221], v4 offset:0
    v_mfma_f32_16x16x32_bf16 v[80:83], a[224:227], a[180:183], v[80:83]
    s_add_u32 m0, s22, 13312
    ds_read_b64_tr_b16 a[222:223], v4 offset:6144
    buffer_load_dwordx4 v6, s[4:7], s20 offen lds
    v_mfma_f32_16x16x32_bf16 v[44:47], a[248:251], v[32:35], v[44:47]
    ds_read_b64_tr_b16 a[224:225], v5 offset:0
    v_mfma_f32_16x16x32_bf16 v[80:83], a[228:231], a[184:187], v[80:83]
    s_add_u32 s20, s20, 128
    s_add_u32 m0, s22, 14336
    s_nop 0
    buffer_load_dwordx4 v6, s[4:7], s20 offen lds
    ds_read_b64_tr_b16 a[226:227], v5 offset:6144
    s_add_u32 s20, s20, 12032
    v_mfma_f32_16x16x32_bf16 v[80:83], a[232:235], a[188:191], v[80:83]
    s_waitcnt lgkmcnt(6)
    v_mfma_f32_16x16x32_bf16 v[112:115], a[212:215], v[14:17], 0
    ds_read_b64_tr_b16 a[230:231], v2 offset:7168
    v_mfma_f32_16x16x32_bf16 v[160:163], a[212:215], v[20:23], 0
    v_fma_f32 v72, v72, s28, v11
    v_fma_f32 v62, v62, s28, v10
    v_mfma_f32_16x16x32_bf16 v[208:211], a[212:215], v[26:29], 0
    ds_read_b64_tr_b16 a[228:229], v2 offset:1024
    v_mfma_f32_16x16x32_bf16 a[0:3], a[212:215], v[32:35], 0
    s_waitcnt lgkmcnt(6)
    v_mfma_f32_16x16x32_bf16 a[4:7], a[216:219], v[32:35], 0
    ds_read_b64_tr_b16 a[214:215], v4 offset:7168
    v_fma_f32 v65, v65, s28, v10
    v_mfma_f32_16x16x32_bf16 v[212:215], a[216:219], v[26:29], 0
    ds_read_b64_tr_b16 a[212:213], v4 offset:1024
    v_fma_f32 v66, v66, s28, v10
    v_mfma_f32_16x16x32_bf16 v[164:167], a[216:219], v[20:23], 0
    v_mfma_f32_16x16x32_bf16 v[116:119], a[216:219], v[14:17], 0
    ds_read_b64_tr_b16 a[234:235], v3 offset:7168
    s_waitcnt lgkmcnt(7)
    v_mfma_f32_16x16x32_bf16 v[120:123], a[220:223], v[14:17], 0
    ds_read_b64_tr_b16 a[218:219], v5 offset:7168
    v_fma_f32 v74, v74, s28, v11
    v_mfma_f32_16x16x32_bf16 v[168:171], a[220:223], v[20:23], 0
    ds_read_b64_tr_b16 a[232:233], v3 offset:1024
    v_fma_f32 v56, v56, s28, v9
    v_mfma_f32_16x16x32_bf16 v[216:219], a[220:223], v[26:29], 0
    v_fma_f32 v57, v57, s28, v9
    v_fma_f32 v68, v68, s28, v11
    v_mfma_f32_16x16x32_bf16 a[8:11], a[220:223], v[32:35], 0
    s_waitcnt lgkmcnt(6)
    ds_read_b64_tr_b16 a[220:221], v2 offset:2048
    v_fma_f32 v78, v78, s28, v12
    v_mfma_f32_16x16x32_bf16 a[12:15], a[224:227], v[32:35], 0
    ds_read_b64_tr_b16 a[216:217], v5 offset:1024
    v_fma_f32 v70, v70, s28, v11
    v_mfma_f32_16x16x32_bf16 v[220:223], a[224:227], v[26:29], 0
    v_fma_f32 v79, v79, s28, v12
    v_fma_f32 v69, v69, s28, v11
    v_mfma_f32_16x16x32_bf16 v[172:175], a[224:227], v[20:23], 0
    v_fma_f32 v83, v83, s28, v12
    v_mfma_f32_16x16x32_bf16 v[124:127], a[224:227], v[14:17], 0
    s_waitcnt lgkmcnt(5)
    v_exp_f32 v74, v74
    v_mfma_f32_16x16x32_bf16 v[128:131], a[228:231], v[14:17], 0
    ds_read_b64_tr_b16 a[226:227], v3 offset:8192
    v_fma_f32 v67, v67, s28, v10
    v_mfma_f32_16x16x32_bf16 v[176:179], a[228:231], v[20:23], 0
    v_fma_f32 v76, v76, s28, v12
    v_fma_f32 v82, v82, s28, v12
    v_mfma_f32_16x16x32_bf16 v[224:227], a[228:231], v[26:29], 0
    ds_read_b64_tr_b16 a[222:223], v2 offset:8192
    v_fma_f32 v73, v73, s28, v11
    v_mfma_f32_16x16x32_bf16 a[16:19], a[228:231], v[32:35], 0
    s_waitcnt lgkmcnt(4)
    ds_read_b64_tr_b16 a[230:231], v4 offset:8192
    v_fma_f32 v77, v77, s28, v12
    v_mfma_f32_16x16x32_bf16 a[20:23], a[232:235], v[32:35], 0
    ds_read_b64_tr_b16 a[228:229], v4 offset:2048
    v_fma_f32 v75, v75, s28, v11
    v_mfma_f32_16x16x32_bf16 v[228:231], a[232:235], v[26:29], 0
    ds_read_b64_tr_b16 a[224:225], v3 offset:2048
    v_fma_f32 v81, v81, s28, v12
    v_mfma_f32_16x16x32_bf16 v[180:183], a[232:235], v[20:23], 0
    v_exp_f32 v65, v65
    v_mfma_f32_16x16x32_bf16 v[132:135], a[232:235], v[14:17], 0
    ds_read_b64_tr_b16 a[232:233], v5 offset:2048
    ds_read_b64_tr_b16 a[234:235], v5 offset:8192
    v_mfma_f32_16x16x32_bf16 v[136:139], a[212:215], v[14:17], 0
    v_fma_f32 v71, v71, s28, v11
    v_fma_f32 v63, v63, s28, v10
    v_mfma_f32_16x16x32_bf16 v[184:187], a[212:215], v[20:23], 0
    v_exp_f32 v62, v62
    v_mfma_f32_16x16x32_bf16 v[232:235], a[212:215], v[26:29], 0
    v_exp_f32 v68, v68
    v_mfma_f32_16x16x32_bf16 a[24:27], a[212:215], v[32:35], 0
    s_waitcnt lgkmcnt(6)
    v_exp_f32 v75, v75
    v_mfma_f32_16x16x32_bf16 a[28:31], a[216:219], v[32:35], 0
    v_exp_f32 v69, v69
    v_mfma_f32_16x16x32_bf16 v[236:239], a[216:219], v[26:29], 0
    s_add_u32 s39, s39, 12288
    v_exp_f32 v70, v70
    v_mfma_f32_16x16x32_bf16 v[188:191], a[216:219], v[20:23], 0
    v_exp_f32 v76, v76
    v_mfma_f32_16x16x32_bf16 v[140:143], a[216:219], v[14:17], 0
    s_waitcnt lgkmcnt(2)
    v_exp_f32 v63, v63
    v_mfma_f32_16x16x32_bf16 v[144:147], a[220:223], v[14:17], 0
    v_exp_f32 v71, v71
    v_mfma_f32_16x16x32_bf16 v[192:195], a[220:223], v[20:23], 0
    s_waitcnt vmcnt(3) lgkmcnt(0)
    v_exp_f32 v66, v66
    v_mfma_f32_16x16x32_bf16 v[240:243], a[220:223], v[26:29], 0
    s_barrier
    v_mfma_f32_16x16x32_bf16 a[32:35], a[220:223], v[32:35], 0
    ds_read_b128 a[216:219], v1 offset:0
    v_mfma_f32_16x16x32_bf16 a[36:39], a[224:227], v[32:35], 0
    ds_read_b128 a[220:223], v0 offset:1024
    v_cvt_pk_bf16_f32 v25, v62, v63
    v_mfma_f32_16x16x32_bf16 v[244:247], a[224:227], v[26:29], 0
    s_add_u32 m0, s22, 24576
    ds_read_b128 a[212:215], v0 offset:0
    v_fma_f32 v59, v59, s28, v9
    v_mfma_f32_16x16x32_bf16 v[196:199], a[224:227], v[20:23], 0
    buffer_load_dwordx4 v6, s[8:11], s21 offen lds
    v_mfma_f32_16x16x32_bf16 v[148:151], a[224:227], v[14:17], 0
    s_add_u32 s21, s21, 128
    v_exp_f32 v67, v67
    v_mfma_f32_16x16x32_bf16 v[152:155], a[228:231], v[14:17], 0
    s_add_u32 m0, s22, 25600
    v_exp_f32 v79, v79
    v_mfma_f32_16x16x32_bf16 v[200:203], a[228:231], v[20:23], 0
    buffer_load_dwordx4 v6, s[8:11], s21 offen lds
    v_mfma_f32_16x16x32_bf16 v[248:251], a[228:231], v[26:29], 0
    v_exp_f32 v82, v82
    v_mfma_f32_16x16x32_bf16 a[40:43], a[228:231], v[32:35], 0
    v_exp_f32 v83, v83
    v_mfma_f32_16x16x32_bf16 a[44:47], a[232:235], v[32:35], 0
    s_add_u32 s21, s21, 128
    v_cvt_pk_bf16_f32 v31, v70, v71
    v_fma_f32 v80, v80, s28, v12
    v_mfma_f32_16x16x32_bf16 v[252:255], a[232:235], v[26:29], 0
    s_add_u32 m0, s22, 26624
    ds_read_b128 a[224:227], v1 offset:1024
    v_mfma_f32_16x16x32_bf16 v[204:207], a[232:235], v[20:23], 0
    buffer_load_dwordx4 v6, s[8:11], s21 offen lds
    v_mfma_f32_16x16x32_bf16 v[156:159], a[232:235], v[14:17], 0
    s_waitcnt lgkmcnt(1)
    ds_read_b128 a[228:231], v0 offset:2048
    s_add_u32 s21, s21, 12032
    v_mfma_f32_16x16x32_bf16 v[52:55], a[212:215], a[96:99], 0
    s_add_u32 m0, s38, 0
    v_exp_f32 v77, v77
    v_mfma_f32_16x16x32_bf16 v[52:55], a[216:219], a[100:103], v[52:55]
    ds_read_b128 a[232:235], v1 offset:2048
    v_cvt_pk_bf16_f32 v30, v68, v69
    v_mfma_f32_16x16x32_bf16 v[52:55], a[220:223], a[104:107], v[52:55]
    buffer_load_dwordx4 v6, s[12:15], s33 offen nt lds
    v_mfma_f32_16x16x32_bf16 v[60:63], a[220:223], a[128:131], 0
    s_add_u32 m0, s38, 1024
    v_cvt_pk_bf16_f32 v36, v76, v77
    v_cvt_pk_bf16_f32 v29, v74, v75
    v_mfma_f32_16x16x32_bf16 v[60:63], a[216:219], a[124:127], v[60:63]
    v_exp_f32 v57, v57
    v_mfma_f32_16x16x32_bf16 v[60:63], a[212:215], a[120:123], v[60:63]
    v_mov_b32 v38, v6
    v_mfma_f32_16x16x32_bf16 v[68:71], a[212:215], a[144:147], 0
    v_exp_f32 v78, v78
    v_mfma_f32_16x16x32_bf16 v[68:71], a[216:219], a[148:151], v[68:71]
    v_cvt_pk_bf16_f32 v37, v78, v79
    v_cvt_pk_bf16_f32 v23, v66, v67
    v_mfma_f32_16x16x32_bf16 v[68:71], a[220:223], a[152:155], v[68:71]
    v_exp_f32 v81, v81
    v_mfma_f32_16x16x32_bf16 v[76:79], a[220:223], a[176:179], 0
    buffer_load_dwordx4 v7, s[12:15], s33 offen nt lds
    v_mfma_f32_16x16x32_bf16 v[76:79], a[216:219], a[172:175], v[76:79]
    s_add_u32 s59, s33, 128
    v_exp_f32 v73, v73
    v_mfma_f32_16x16x32_bf16 v[76:79], a[212:215], a[168:171], v[76:79]
    s_add_u32 m0, s38, 2048
    ds_read_b128 a[212:215], v0 offset:6144
    s_waitcnt lgkmcnt(1)
    v_mfma_f32_16x16x32_bf16 v[76:79], a[224:227], a[180:183], v[76:79]
    ds_read_b128 a[216:219], v1 offset:6144
    v_mfma_f32_16x16x32_bf16 v[76:79], a[228:231], a[184:187], v[76:79]
    v_exp_f32 v80, v80
    v_mfma_f32_16x16x32_bf16 v[76:79], a[232:235], a[188:191], v[76:79]
    buffer_load_dwordx4 v6, s[12:15], s59 offen nt lds
    v_mfma_f32_16x16x32_bf16 v[68:71], a[232:235], a[164:167], v[68:71]
    v_fma_f32 v58, v58, s28, v9
    v_fma_f32 v64, v64, s28, v10
    v_mfma_f32_16x16x32_bf16 v[68:71], a[228:231], a[160:163], v[68:71]
    v_exp_f32 v56, v56
    v_mfma_f32_16x16x32_bf16 v[68:71], a[224:227], a[156:159], v[68:71]
    ds_read_b128 a[220:223], v0 offset:7168
    v_cvt_pk_bf16_f32 v16, v56, v57
    v_mfma_f32_16x16x32_bf16 v[60:63], a[224:227], a[132:135], v[60:63]
    s_add_u32 m0, s38, 3072
    v_exp_f32 v58, v58
    v_mfma_f32_16x16x32_bf16 v[60:63], a[228:231], a[136:139], v[60:63]
    v_exp_f32 v64, v64
    v_mfma_f32_16x16x32_bf16 v[60:63], a[232:235], a[140:143], v[60:63]
    v_exp_f32 v59, v59
    v_mfma_f32_16x16x32_bf16 v[52:55], a[232:235], a[116:119], v[52:55]
    ds_read_b128 a[232:235], v1 offset:8192
    v_cvt_pk_bf16_f32 v22, v64, v65
    v_mfma_f32_16x16x32_bf16 v[52:55], a[228:231], a[112:115], v[52:55]
    ds_read_b128 a[228:231], v0 offset:8192
    v_cvt_pk_bf16_f32 v17, v58, v59
    v_mfma_f32_16x16x32_bf16 v[52:55], a[224:227], a[108:111], v[52:55]
    v_exp_f32 v72, v72
    v_mfma_f32_16x16x32_bf16 v[48:51], a[236:239], v[16:19], v[44:47]
    ds_read_b128 a[224:227], v1 offset:7168
    v_cvt_pk_bf16_f32 v28, v72, v73
    v_mfma_f32_16x16x32_bf16 v[48:51], a[240:243], v[22:25], v[48:51]
    v_cvt_pk_bf16_f32 v35, v82, v83
    v_cvt_pk_bf16_f32 v34, v80, v81
    v_mfma_f32_16x16x32_bf16 v[48:51], a[244:247], v[28:31], v[48:51]
    buffer_load_dwordx4 v7, s[12:15], s59 offen nt lds
    v_mfma_f32_16x16x32_bf16 v[48:51], a[248:251], v[34:37], v[48:51]
    s_add_u32 s58, s33, 256
    s_add_u32 m0, s38, 4096
    s_waitcnt lgkmcnt(3)
    v_mfma_f32_16x16x32_bf16 v[56:59], a[212:215], a[96:99], 0
    buffer_load_dwordx4 v6, s[12:15], s58 offen nt lds
    v_mfma_f32_16x16x32_bf16 v[56:59], a[216:219], a[100:103], v[56:59]
    s_nop 1
    v_cmp_lt_f32 vcc, s29, v48
    v_mfma_f32_16x16x32_bf16 v[56:59], a[220:223], a[104:107], v[56:59]
    s_add_u32 m0, s38, 5120
    v_mov_b32 v39, v7
    v_add_u32 v103, 6144, v103
    v_mfma_f32_16x16x32_bf16 v[64:67], a[220:223], a[128:131], 0
    s_cbranch_vccnz L_rs_start4b
L_ret_start4b:
    v_fma_f32 v60, v60, s28, v10
    v_mfma_f32_16x16x32_bf16 v[64:67], a[216:219], a[124:127], v[64:67]
    v_exp_f32 v60, v60
    v_mfma_f32_16x16x32_bf16 v[64:67], a[212:215], a[120:123], v[64:67]
    buffer_load_dwordx4 v7, s[12:15], s58 offen nt lds
    v_mfma_f32_16x16x32_bf16 v[72:75], a[212:215], a[144:147], 0
    s_waitcnt vmcnt(15) lgkmcnt(0)
    v_fma_f32 v55, v55, s28, v9
    v_fma_f32 v61, v61, s28, v10
    v_mfma_f32_16x16x32_bf16 v[72:75], a[216:219], a[148:151], v[72:75]
    s_barrier
    v_mfma_f32_16x16x32_bf16 v[72:75], a[220:223], a[152:155], v[72:75]
    v_fma_f32 v53, v53, s28, v9
    s_add_u32 m0, s22, 0
    v_mfma_f32_16x16x32_bf16 v[80:83], a[220:223], a[176:179], 0
    v_exp_f32 v61, v61
    v_mfma_f32_16x16x32_bf16 v[80:83], a[216:219], a[172:175], v[80:83]
    buffer_load_dwordx4 v6, s[4:7], s20 offen lds
    v_mfma_f32_16x16x32_bf16 v[80:83], a[212:215], a[168:171], v[80:83]
    s_add_u32 s20, s20, 128
    ds_read_b64_tr_b16 a[212:213], v2 offset:18432
    v_fma_f32 v54, v54, s28, v9
    v_mfma_f32_16x16x32_bf16 v[80:83], a[224:227], a[180:183], v[80:83]
    v_exp_f32 v55, v55
    v_mfma_f32_16x16x32_bf16 v[80:83], a[228:231], a[184:187], v[80:83]
    s_add_u32 m0, s22, 1024
    ds_read_b64_tr_b16 a[214:215], v2 offset:12288
    v_mfma_f32_16x16x32_bf16 v[80:83], a[232:235], a[188:191], v[80:83]
    buffer_load_dwordx4 v6, s[4:7], s20 offen lds
    v_mfma_f32_16x16x32_bf16 v[72:75], a[232:235], a[164:167], v[72:75]
    ds_read_b64_tr_b16 a[216:217], v3 offset:18432
    v_fma_f32 v52, v52, s28, v9
    v_mfma_f32_16x16x32_bf16 v[72:75], a[228:231], a[160:163], v[72:75]
    s_add_u32 s20, s20, 128
    v_exp_f32 v54, v54
    v_mfma_f32_16x16x32_bf16 v[72:75], a[224:227], a[156:159], v[72:75]
    ds_read_b64_tr_b16 a[218:219], v3 offset:12288
    v_cvt_pk_bf16_f32 v15, v54, v55
    v_mfma_f32_16x16x32_bf16 v[64:67], a[224:227], a[132:135], v[64:67]
    s_add_u32 m0, s22, 2048
    ds_read_b64_tr_b16 a[220:221], v4 offset:18432
    v_cvt_pk_bf16_f32 v20, v60, v61
    v_mfma_f32_16x16x32_bf16 v[64:67], a[228:231], a[136:139], v[64:67]
    buffer_load_dwordx4 v6, s[4:7], s20 offen lds
    v_mfma_f32_16x16x32_bf16 v[64:67], a[232:235], a[140:143], v[64:67]
    v_exp_f32 v52, v52
    v_mfma_f32_16x16x32_bf16 v[56:59], a[232:235], a[116:119], v[56:59]
    s_add_u32 s20, s20, 12032
    v_exp_f32 v53, v53
    v_mfma_f32_16x16x32_bf16 v[56:59], a[228:231], a[112:115], v[56:59]
    ds_read_b64_tr_b16 a[222:223], v4 offset:12288
    v_cvt_pk_bf16_f32 v14, v52, v53
    v_mfma_f32_16x16x32_bf16 v[56:59], a[224:227], a[108:111], v[56:59]
    ds_read_b64_tr_b16 a[224:225], v5 offset:18432
    ds_read_b64_tr_b16 a[226:227], v5 offset:12288
    s_branch L_loop4
L_loop5:
    s_bitcmp1_b32 s3, 1
    s_cbranch_scc1 L_loop5w1
    .p2align 6
L_loop5w0:
    ds_read_b128 v[96:99], v103 offset:0
    s_waitcnt lgkmcnt(5)
    v_mfma_f32_16x16x32_bf16 v[112:115], a[212:215], v[16:19], v[112:115]
    ds_read_b64_tr_b16 a[232:233], v3 offset:19456
    v_fma_f32 v84, v84, s28, v13
    v_mfma_f32_16x16x32_bf16 v[116:119], a[216:219], v[16:19], v[116:119]
    v_fma_f32 v79, v79, s28, v12
    v_fma_f32 v56, v56, s28, v9
    v_mfma_f32_16x16x32_bf16 v[164:167], a[216:219], v[22:25], v[164:167]
    v_fma_f32 v80, v80, s28, v12
    v_mfma_f32_16x16x32_bf16 v[160:163], a[212:215], v[22:25], v[160:163]
    v_fma_f32 v69, v69, s28, v11
    v_fma_f32 v70, v70, s28, v11
    v_mfma_f32_16x16x32_bf16 v[208:211], a[212:215], v[28:31], v[208:211]
    v_fma_f32 v90, v90, s28, v13
    v_mfma_f32_16x16x32_bf16 v[212:215], a[216:219], v[28:31], v[212:215]
    ds_read_b64_tr_b16 a[230:231], v2 offset:13312
    v_fma_f32 v67, v67, s28, v10
    v_mfma_f32_16x16x32_bf16 a[4:7], a[216:219], v[34:37], a[4:7]
    v_fma_f32 v68, v68, s28, v11
    v_fma_f32 v91, v91, s28, v13
    v_mfma_f32_16x16x32_bf16 a[0:3], a[212:215], v[34:37], a[0:3]
    ds_read_b64_tr_b16 a[234:235], v3 offset:13312
    v_fma_f32 v83, v83, s28, v12
    v_mfma_f32_16x16x32_bf16 a[48:51], a[212:215], v[40:43], a[48:51]
    ds_read_b64_tr_b16 a[212:213], v4 offset:19456
    v_fma_f32 v89, v89, s28, v13
    v_mfma_f32_16x16x32_bf16 a[52:55], a[216:219], v[40:43], a[52:55]
    s_waitcnt lgkmcnt(4)
    ds_read_b64_tr_b16 a[228:229], v2 offset:19456
    ds_read_b64_tr_b16 a[214:215], v4 offset:13312
    v_mfma_f32_16x16x32_bf16 a[56:59], a[220:223], v[40:43], a[56:59]
    buffer_store_dwordx4 v[96:99], v6, s[16:19], s24 offen offset:0 nt
    v_fma_f32 v86, v86, s28, v13
    v_mfma_f32_16x16x32_bf16 a[60:63], a[224:227], v[40:43], a[60:63]
    v_fma_f32 v85, v85, s28, v13
    v_fma_f32 v78, v78, s28, v12
    v_mfma_f32_16x16x32_bf16 a[12:15], a[224:227], v[34:37], a[12:15]
    v_fma_f32 v75, v75, s28, v11
    v_fma_f32 v87, v87, s28, v13
    v_mfma_f32_16x16x32_bf16 a[8:11], a[220:223], v[34:37], a[8:11]
    v_fma_f32 v65, v65, s28, v10
    v_mfma_f32_16x16x32_bf16 v[216:219], a[220:223], v[28:31], v[216:219]
    v_fma_f32 v71, v71, s28, v11
    s_add_u32 s39, s39, 12288
    v_mfma_f32_16x16x32_bf16 v[220:223], a[224:227], v[28:31], v[220:223]
    s_add_u32 m0, s23, 0
    ds_read_b64_tr_b16 a[216:217], v5 offset:19456
    v_fma_f32 v76, v76, s28, v12
    v_mfma_f32_16x16x32_bf16 v[172:175], a[224:227], v[22:25], v[172:175]
    ds_read_b64_tr_b16 a[218:219], v5 offset:13312
    v_mfma_f32_16x16x32_bf16 v[168:171], a[220:223], v[22:25], v[168:171]
    v_exp_f32 v85, v85
    v_mfma_f32_16x16x32_bf16 v[120:123], a[220:223], v[16:19], v[120:123]
    buffer_load_dwordx4 v6, s[12:15], s25 offen nt lds
    v_mfma_f32_16x16x32_bf16 v[124:127], a[224:227], v[16:19], v[124:127]
    s_waitcnt lgkmcnt(2)
    v_exp_f32 v75, v75
    v_mfma_f32_16x16x32_bf16 v[128:131], a[228:231], v[16:19], v[128:131]
    ds_read_b64_tr_b16 a[220:221], v2 offset:20480
    v_mfma_f32_16x16x32_bf16 v[132:135], a[232:235], v[16:19], v[132:135]
    v_exp_f32 v69, v69
    v_mfma_f32_16x16x32_bf16 v[180:183], a[232:235], v[22:25], v[180:183]
    ds_read_b64_tr_b16 a[222:223], v2 offset:14336
    v_mfma_f32_16x16x32_bf16 v[176:179], a[228:231], v[22:25], v[176:179]
    ds_read_b64_tr_b16 a[224:225], v3 offset:20480
    v_fma_f32 v81, v81, s28, v12
    v_mfma_f32_16x16x32_bf16 v[224:227], a[228:231], v[28:31], v[224:227]
    v_exp_f32 v78, v78
    v_mfma_f32_16x16x32_bf16 v[228:231], a[232:235], v[28:31], v[228:231]
    v_exp_f32 v70, v70
    v_mfma_f32_16x16x32_bf16 a[20:23], a[232:235], v[34:37], a[20:23]
    v_fma_f32 v66, v66, s28, v10
    v_mfma_f32_16x16x32_bf16 a[16:19], a[228:231], v[34:37], a[16:19]
    v_fma_f32 v82, v82, s28, v12
    v_mfma_f32_16x16x32_bf16 a[64:67], a[228:231], v[40:43], a[64:67]
    v_exp_f32 v71, v71
    v_mfma_f32_16x16x32_bf16 a[68:71], a[232:235], v[40:43], a[68:71]
    v_exp_f32 v79, v79
    v_mfma_f32_16x16x32_bf16 a[72:75], a[212:215], v[40:43], a[72:75]
    s_waitcnt lgkmcnt(2)
    ds_read_b64_tr_b16 a[226:227], v3 offset:14336
    ds_read_b128 v[96:99], v103 offset:1024
    v_mfma_f32_16x16x32_bf16 a[76:79], a[216:219], v[40:43], a[76:79]
    v_fma_f32 v57, v57, s28, v9
    v_mfma_f32_16x16x32_bf16 a[28:31], a[216:219], v[34:37], a[28:31]
    ds_read_b64_tr_b16 a[234:235], v5 offset:14336
    v_fma_f32 v58, v58, s28, v9
    v_mfma_f32_16x16x32_bf16 a[24:27], a[212:215], v[34:37], a[24:27]
    v_exp_f32 v91, v91
    v_mfma_f32_16x16x32_bf16 v[232:235], a[212:215], v[28:31], v[232:235]
    v_mfma_f32_16x16x32_bf16 v[236:239], a[216:219], v[28:31], v[236:239]
    v_fma_f32 v88, v88, s28, v13
    v_cvt_pk_bf16_f32 v27, v70, v71
    v_mfma_f32_16x16x32_bf16 v[188:191], a[216:219], v[22:25], v[188:191]
    ds_read_b64_tr_b16 a[232:233], v5 offset:20480
    ds_read_b64_tr_b16 a[228:229], v4 offset:20480
    v_mfma_f32_16x16x32_bf16 v[184:187], a[212:215], v[22:25], v[184:187]
    ds_read_b64_tr_b16 a[230:231], v4 offset:14336
    v_mfma_f32_16x16x32_bf16 v[136:139], a[212:215], v[16:19], v[136:139]
    v_exp_f32 v86, v86
    v_mfma_f32_16x16x32_bf16 v[140:143], a[216:219], v[16:19], v[140:143]
    s_waitcnt lgkmcnt(6)
    v_exp_f32 v76, v76
    v_mfma_f32_16x16x32_bf16 v[144:147], a[220:223], v[16:19], v[144:147]
    s_waitcnt lgkmcnt(4)
    v_exp_f32 v68, v68
    v_mfma_f32_16x16x32_bf16 v[148:151], a[224:227], v[16:19], v[148:151]
    v_fma_f32 v64, v64, s28, v10
    v_fma_f32 v77, v77, s28, v12
    v_mfma_f32_16x16x32_bf16 v[196:199], a[224:227], v[22:25], v[196:199]
    v_exp_f32 v87, v87
    v_mfma_f32_16x16x32_bf16 v[192:195], a[220:223], v[22:25], v[192:195]
    v_fma_f32 v73, v73, s28, v11
    v_fma_f32 v74, v74, s28, v11
    v_mfma_f32_16x16x32_bf16 v[240:243], a[220:223], v[28:31], v[240:243]
    v_exp_f32 v80, v80
    v_mfma_f32_16x16x32_bf16 v[244:247], a[224:227], v[28:31], v[244:247]
    v_exp_f32 v77, v77
    v_mfma_f32_16x16x32_bf16 a[36:39], a[224:227], v[34:37], a[36:39]
    v_exp_f32 v84, v84
    v_mfma_f32_16x16x32_bf16 a[32:35], a[220:223], v[34:37], a[32:35]
    v_fma_f32 v72, v72, s28, v11
    v_cvt_pk_bf16_f32 v39, v86, v87
    v_mfma_f32_16x16x32_bf16 a[80:83], a[220:223], v[40:43], a[80:83]
    s_waitcnt vmcnt(12) lgkmcnt(0)
    v_fma_f32 v59, v59, s28, v9
    v_cvt_pk_bf16_f32 v32, v76, v77
    v_mfma_f32_16x16x32_bf16 a[84:87], a[224:227], v[40:43], a[84:87]
    s_barrier
    ds_read_b128 a[212:215], v0 offset:12288
    v_mfma_f32_16x16x32_bf16 a[88:91], a[228:231], v[40:43], a[88:91]
    ds_read_b128 a[216:219], v1 offset:12288
    v_mfma_f32_16x16x32_bf16 a[92:95], a[232:235], v[40:43], a[92:95]
    ds_read_b128 a[220:223], v0 offset:13312
    v_mfma_f32_16x16x32_bf16 a[44:47], a[232:235], v[34:37], a[44:47]
    ds_read_b128 a[224:227], v1 offset:13312
    s_add_u32 m0, s22, 36864
    v_mfma_f32_16x16x32_bf16 a[40:43], a[228:231], v[34:37], a[40:43]
    buffer_load_dwordx4 v6, s[8:11], s21 offen lds
    v_mfma_f32_16x16x32_bf16 v[248:251], a[228:231], v[28:31], v[248:251]
    s_add_u32 s21, s21, 128
    v_cvt_pk_bf16_f32 v33, v78, v79
    s_add_u32 m0, s22, 37888
    v_mfma_f32_16x16x32_bf16 v[252:255], a[232:235], v[28:31], v[252:255]
    buffer_load_dwordx4 v6, s[8:11], s21 offen lds
    v_mfma_f32_16x16x32_bf16 v[204:207], a[232:235], v[22:25], v[204:207]
    v_cvt_pk_bf16_f32 v38, v84, v85
    s_add_u32 s21, s21, 128
    v_mfma_f32_16x16x32_bf16 v[200:203], a[228:231], v[22:25], v[200:203]
    s_add_u32 m0, s22, 38912
    v_exp_f32 v57, v57
    v_mfma_f32_16x16x32_bf16 v[152:155], a[228:231], v[16:19], v[152:155]
    buffer_load_dwordx4 v6, s[8:11], s21 offen lds
    v_mfma_f32_16x16x32_bf16 v[156:159], a[232:235], v[16:19], v[156:159]
    s_waitcnt lgkmcnt(3)
    ds_read_b128 a[228:231], v0 offset:14336
    v_mfma_f32_16x16x32_bf16 v[52:55], a[212:215], a[96:99], 0
    s_waitcnt lgkmcnt(3)
    v_exp_f32 v89, v89
    v_mfma_f32_16x16x32_bf16 v[52:55], a[216:219], a[100:103], v[52:55]
    s_waitcnt lgkmcnt(2)
    v_exp_f32 v90, v90
    v_mfma_f32_16x16x32_bf16 v[52:55], a[220:223], a[104:107], v[52:55]
    ds_read_b128 a[232:235], v1 offset:14336
    v_cvt_pk_bf16_f32 v26, v68, v69
    v_mfma_f32_16x16x32_bf16 v[60:63], a[220:223], a[128:131], 0
    v_exp_f32 v67, v67
    v_mfma_f32_16x16x32_bf16 v[60:63], a[216:219], a[124:127], v[60:63]
    v_exp_f32 v88, v88
    v_mfma_f32_16x16x32_bf16 v[60:63], a[212:215], a[120:123], v[60:63]
    v_exp_f32 v82, v82
    v_mfma_f32_16x16x32_bf16 v[68:71], a[212:215], a[144:147], 0
    buffer_store_dwordx4 v[96:99], v7, s[16:19], s24 offen offset:0 nt
    v_exp_f32 v74, v74
    v_mfma_f32_16x16x32_bf16 v[68:71], a[216:219], a[148:151], v[68:71]
    v_exp_f32 v72, v72
    v_mfma_f32_16x16x32_bf16 v[68:71], a[220:223], a[152:155], v[68:71]
    v_exp_f32 v81, v81
    v_mfma_f32_16x16x32_bf16 v[76:79], a[220:223], a[176:179], 0
    v_exp_f32 v56, v56
    v_mfma_f32_16x16x32_bf16 v[76:79], a[216:219], a[172:175], v[76:79]
    v_exp_f32 v65, v65
    v_mfma_f32_16x16x32_bf16 v[76:79], a[212:215], a[168:171], v[76:79]
    s_add_u32 s21, s21, 12032
    v_mfma_f32_16x16x32_bf16 v[84:87], a[212:215], a[192:195], 0
    v_exp_f32 v83, v83
    v_mfma_f32_16x16x32_bf16 v[84:87], a[216:219], a[196:199], v[84:87]
    ds_read_b128 a[212:215], v0 offset:18432
    v_cvt_pk_bf16_f32 v40, v88, v89
    v_mfma_f32_16x16x32_bf16 v[84:87], a[220:223], a[200:203], v[84:87]
    s_waitcnt lgkmcnt(1)
    v_exp_f32 v66, v66
    v_mfma_f32_16x16x32_bf16 v[84:87], a[224:227], a[204:207], v[84:87]
    v_exp_f32 v64, v64
    v_mfma_f32_16x16x32_bf16 v[84:87], a[228:231], a[208:211], v[84:87]
    v_exp_f32 v58, v58
    v_mfma_f32_16x16x32_bf16 v[84:87], a[232:235], v[92:95], v[84:87]
    s_add_u32 m0, s23, 1024
    ds_read_b128 a[216:219], v1 offset:18432
    v_mfma_f32_16x16x32_bf16 v[76:79], a[232:235], a[188:191], v[76:79]
    v_cvt_pk_bf16_f32 v29, v74, v75
    v_mfma_f32_16x16x32_bf16 v[76:79], a[228:231], a[184:187], v[76:79]
    buffer_load_dwordx4 v7, s[12:15], s25 offen nt lds
    v_mfma_f32_16x16x32_bf16 v[76:79], a[224:227], a[180:183], v[76:79]
    v_exp_f32 v59, v59
    v_mfma_f32_16x16x32_bf16 v[68:71], a[224:227], a[156:159], v[68:71]
    v_mfma_f32_16x16x32_bf16 v[68:71], a[228:231], a[160:163], v[68:71]
    v_cvt_pk_bf16_f32 v35, v82, v83
    v_cvt_pk_bf16_f32 v16, v56, v57
    v_mfma_f32_16x16x32_bf16 v[68:71], a[232:235], a[164:167], v[68:71]
    v_cvt_pk_bf16_f32 v34, v80, v81
    v_mfma_f32_16x16x32_bf16 v[60:63], a[232:235], a[140:143], v[60:63]
    s_bitcmp1_b32 s27, 0
    v_exp_f32 v73, v73
    v_mfma_f32_16x16x32_bf16 v[60:63], a[228:231], a[136:139], v[60:63]
    ds_read_b128 a[220:223], v0 offset:19456
    v_cvt_pk_bf16_f32 v41, v90, v91
    v_mfma_f32_16x16x32_bf16 v[60:63], a[224:227], a[132:135], v[60:63]
    v_cvt_pk_bf16_f32 v28, v72, v73
    v_mfma_f32_16x16x32_bf16 v[52:55], a[224:227], a[108:111], v[52:55]
    v_cvt_pk_bf16_f32 v17, v58, v59
    v_mfma_f32_16x16x32_bf16 v[52:55], a[228:231], a[112:115], v[52:55]
    ds_read_b128 a[228:231], v0 offset:20480
    v_cvt_pk_bf16_f32 v23, v66, v67
    v_mfma_f32_16x16x32_bf16 v[52:55], a[232:235], a[116:119], v[52:55]
    v_cvt_pk_bf16_f32 v22, v64, v65
    s_cselect_b32 s26, s49, 128
    v_mfma_f32_16x16x32_bf16 v[44:47], a[236:239], v[14:17], v[48:51]
    ds_read_b128 a[232:235], v1 offset:20480
    v_mfma_f32_16x16x32_bf16 v[44:47], a[240:243], v[20:23], v[44:47]
    s_lshr_b32 s27, s27, 1
    ds_read_b128 a[224:227], v1 offset:19456
    v_mfma_f32_16x16x32_bf16 v[44:47], a[244:247], v[26:29], v[44:47]
    v_mfma_f32_16x16x32_bf16 v[44:47], a[248:251], v[32:35], v[44:47]
    v_mfma_f32_16x16x32_bf16 v[44:47], a[252:255], v[38:41], v[44:47]
    s_waitcnt lgkmcnt(4)
    v_mfma_f32_16x16x32_bf16 v[56:59], a[212:215], a[96:99], 0
    s_add_u32 s24, s24, s26
    v_mfma_f32_16x16x32_bf16 v[56:59], a[216:219], a[100:103], v[56:59]
    s_waitcnt lgkmcnt(3)
    v_mfma_f32_16x16x32_bf16 v[56:59], a[220:223], a[104:107], v[56:59]
    s_nop 1
    v_cmp_lt_f32 vcc, s29, v44
    v_mfma_f32_16x16x32_bf16 v[64:67], a[220:223], a[128:131], 0
    s_add_u32 s25, s25, s26
    v_mfma_f32_16x16x32_bf16 v[64:67], a[216:219], a[124:127], v[64:67]
    v_mfma_f32_16x16x32_bf16 v[64:67], a[212:215], a[120:123], v[64:67]
    s_nop 0
    s_cbranch_vccnz L_rs_loop5w0a
L_ret_loop5w0a:
    v_mfma_f32_16x16x32_bf16 v[72:75], a[212:215], a[144:147], 0
    v_fma_f32 v53, v53, s28, v9
    v_fma_f32 v54, v54, s28, v9
    v_mfma_f32_16x16x32_bf16 v[72:75], a[216:219], a[148:151], v[72:75]
    v_fma_f32 v52, v52, s28, v9
    v_fma_f32 v63, v63, s28, v10
    v_mfma_f32_16x16x32_bf16 v[72:75], a[220:223], a[152:155], v[72:75]
    s_waitcnt vmcnt(12) lgkmcnt(0)
    v_exp_f32 v54, v54
    v_mfma_f32_16x16x32_bf16 v[80:83], a[220:223], a[176:179], 0
    s_barrier
    v_mfma_f32_16x16x32_bf16 v[80:83], a[216:219], a[172:175], v[80:83]
    s_add_u32 m0, s22, 12288
    v_fma_f32 v62, v62, s28, v10
    v_fma_f32 v55, v55, s28, v9
    v_mfma_f32_16x16x32_bf16 v[80:83], a[212:215], a[168:171], v[80:83]
    buffer_load_dwordx4 v6, s[4:7], s20 offen lds
    v_mfma_f32_16x16x32_bf16 v[88:91], a[212:215], a[192:195], 0
    v_exp_f32 v63, v63
    v_mfma_f32_16x16x32_bf16 v[88:91], a[216:219], a[196:199], v[88:91]
    s_add_u32 s20, s20, 128
    v_fma_f32 v61, v61, s28, v10
    s_add_u32 m0, s22, 13312
    v_mfma_f32_16x16x32_bf16 v[88:91], a[220:223], a[200:203], v[88:91]
    buffer_load_dwordx4 v6, s[4:7], s20 offen lds
    v_mfma_f32_16x16x32_bf16 v[88:91], a[224:227], a[204:207], v[88:91]
    s_add_u32 s20, s20, 128
    ds_read_b64_tr_b16 a[212:213], v2 offset:0
    ds_read_b64_tr_b16 a[214:215], v2 offset:6144
    v_mfma_f32_16x16x32_bf16 v[88:91], a[228:231], a[208:211], v[88:91]
    s_add_u32 m0, s22, 14336
    ds_read_b64_tr_b16 a[216:217], v3 offset:0
    v_fma_f32 v60, v60, s28, v10
    v_mfma_f32_16x16x32_bf16 v[88:91], a[232:235], v[92:95], v[88:91]
    buffer_load_dwordx4 v6, s[4:7], s20 offen lds
    v_mfma_f32_16x16x32_bf16 v[80:83], a[232:235], a[188:191], v[80:83]
    v_exp_f32 v53, v53
    v_mfma_f32_16x16x32_bf16 v[80:83], a[228:231], a[184:187], v[80:83]
    v_exp_f32 v61, v61
    v_mfma_f32_16x16x32_bf16 v[80:83], a[224:227], a[180:183], v[80:83]
    ds_read_b64_tr_b16 a[218:219], v3 offset:6144
    v_mfma_f32_16x16x32_bf16 v[72:75], a[224:227], a[156:159], v[72:75]
    v_exp_f32 v60, v60
    v_mfma_f32_16x16x32_bf16 v[72:75], a[228:231], a[160:163], v[72:75]
    v_exp_f32 v52, v52
    v_mfma_f32_16x16x32_bf16 v[72:75], a[232:235], a[164:167], v[72:75]
    v_exp_f32 v62, v62
    v_mfma_f32_16x16x32_bf16 v[64:67], a[232:235], a[140:143], v[64:67]
    ds_read_b64_tr_b16 a[220:221], v4 offset:0
    ds_read_b64_tr_b16 a[222:223], v4 offset:6144
    v_mfma_f32_16x16x32_bf16 v[64:67], a[228:231], a[136:139], v[64:67]
    v_cvt_pk_bf16_f32 v24, v60, v61
    v_mfma_f32_16x16x32_bf16 v[64:67], a[224:227], a[132:135], v[64:67]
    v_cvt_pk_bf16_f32 v18, v52, v53
    v_mfma_f32_16x16x32_bf16 v[56:59], a[224:227], a[108:111], v[56:59]
    v_exp_f32 v55, v55
    v_mfma_f32_16x16x32_bf16 v[56:59], a[228:231], a[112:115], v[56:59]
    s_add_u32 s20, s20, 12032
    ds_read_b64_tr_b16 a[224:225], v5 offset:0
    v_cvt_pk_bf16_f32 v25, v62, v63
    v_mfma_f32_16x16x32_bf16 v[56:59], a[232:235], a[116:119], v[56:59]
    ds_read_b64_tr_b16 a[226:227], v5 offset:6144
    v_cvt_pk_bf16_f32 v19, v54, v55
    ds_read_b128 v[96:99], v103 offset:2048
    s_waitcnt lgkmcnt(5)
    v_mfma_f32_16x16x32_bf16 v[112:115], a[212:215], v[14:17], v[112:115]
    v_mfma_f32_16x16x32_bf16 v[116:119], a[216:219], v[14:17], v[116:119]
    v_fma_f32 v69, v69, s28, v11
    v_fma_f32 v84, v84, s28, v13
    v_mfma_f32_16x16x32_bf16 v[164:167], a[216:219], v[20:23], v[164:167]
    ds_read_b64_tr_b16 a[228:229], v2 offset:1024
    ds_read_b64_tr_b16 a[234:235], v3 offset:7168
    v_mfma_f32_16x16x32_bf16 v[160:163], a[212:215], v[20:23], v[160:163]
    v_fma_f32 v56, v56, s28, v9
    v_fma_f32 v70, v70, s28, v11
    v_mfma_f32_16x16x32_bf16 v[208:211], a[212:215], v[26:29], v[208:211]
    v_fma_f32 v90, v90, s28, v13
    v_fma_f32 v85, v85, s28, v13
    v_mfma_f32_16x16x32_bf16 v[212:215], a[216:219], v[26:29], v[212:215]
    s_add_u32 s39, s39, 12288
    v_fma_f32 v67, v67, s28, v10
    v_fma_f32 v73, v73, s28, v11
    v_mfma_f32_16x16x32_bf16 a[4:7], a[216:219], v[32:35], a[4:7]
    v_fma_f32 v87, v87, s28, v13
    v_fma_f32 v72, v72, s28, v11
    v_mfma_f32_16x16x32_bf16 a[0:3], a[212:215], v[32:35], a[0:3]
    v_fma_f32 v78, v78, s28, v12
    v_fma_f32 v74, v74, s28, v11
    v_mfma_f32_16x16x32_bf16 a[48:51], a[212:215], v[38:41], a[48:51]
    ds_read_b64_tr_b16 a[230:231], v2 offset:7168
    v_fma_f32 v80, v80, s28, v12
    v_mfma_f32_16x16x32_bf16 a[52:55], a[216:219], v[38:41], a[52:55]
    s_waitcnt lgkmcnt(3)
    v_fma_f32 v91, v91, s28, v13
    v_mfma_f32_16x16x32_bf16 a[56:59], a[220:223], v[38:41], a[56:59]
    buffer_store_dwordx4 v[96:99], v6, s[16:19], s24 offen offset:0 nt
    ds_read_b64_tr_b16 a[212:213], v4 offset:1024
    ds_read_b64_tr_b16 a[232:233], v3 offset:1024
    ds_read_b64_tr_b16 a[214:215], v4 offset:7168
    v_mfma_f32_16x16x32_bf16 a[60:63], a[224:227], v[38:41], a[60:63]
    v_fma_f32 v88, v88, s28, v13
    v_fma_f32 v59, v59, s28, v9
    v_mfma_f32_16x16x32_bf16 a[12:15], a[224:227], v[32:35], a[12:15]
    v_mfma_f32_16x16x32_bf16 a[8:11], a[220:223], v[32:35], a[8:11]
    ds_read_b64_tr_b16 a[218:219], v5 offset:7168
    v_fma_f32 v57, v57, s28, v9
    v_mfma_f32_16x16x32_bf16 v[216:219], a[220:223], v[26:29], v[216:219]
    v_fma_f32 v86, v86, s28, v13
    v_fma_f32 v76, v76, s28, v12
    v_mfma_f32_16x16x32_bf16 v[220:223], a[224:227], v[26:29], v[220:223]
    v_fma_f32 v58, v58, s28, v9
    v_fma_f32 v65, v65, s28, v10
    v_mfma_f32_16x16x32_bf16 v[172:175], a[224:227], v[20:23], v[172:175]
    v_fma_f32 v79, v79, s28, v12
    v_fma_f32 v82, v82, s28, v12
    v_mfma_f32_16x16x32_bf16 v[168:171], a[220:223], v[20:23], v[168:171]
    s_add_u32 m0, s23, 2048
    v_exp_f32 v70, v70
    v_mfma_f32_16x16x32_bf16 v[120:123], a[220:223], v[14:17], v[120:123]
    buffer_load_dwordx4 v6, s[12:15], s25 offen nt lds
    v_mfma_f32_16x16x32_bf16 v[124:127], a[224:227], v[14:17], v[124:127]
    s_waitcnt lgkmcnt(4)
    ds_read_b64_tr_b16 a[224:225], v3 offset:2048
    v_fma_f32 v66, v66, s28, v10
    v_mfma_f32_16x16x32_bf16 v[128:131], a[228:231], v[14:17], v[128:131]
    s_waitcnt lgkmcnt(2)
    ds_read_b64_tr_b16 a[216:217], v5 offset:1024
    ds_read_b128 v[96:99], v103 offset:3072
    v_mfma_f32_16x16x32_bf16 v[132:135], a[232:235], v[14:17], v[132:135]
    v_exp_f32 v58, v58
    v_mfma_f32_16x16x32_bf16 v[180:183], a[232:235], v[20:23], v[180:183]
    v_exp_f32 v69, v69
    v_mfma_f32_16x16x32_bf16 v[176:179], a[228:231], v[20:23], v[176:179]
    ds_read_b64_tr_b16 a[222:223], v2 offset:8192
    v_fma_f32 v71, v71, s28, v11
    v_mfma_f32_16x16x32_bf16 v[224:227], a[228:231], v[26:29], v[224:227]
    v_exp_f32 v85, v85
    v_mfma_f32_16x16x32_bf16 v[228:231], a[232:235], v[26:29], v[228:231]
    ds_read_b64_tr_b16 a[220:221], v2 offset:2048
    v_fma_f32 v81, v81, s28, v12
    v_mfma_f32_16x16x32_bf16 a[20:23], a[232:235], v[32:35], a[20:23]
    v_exp_f32 v66, v66
    v_mfma_f32_16x16x32_bf16 a[16:19], a[228:231], v[32:35], a[16:19]
    v_exp_f32 v84, v84
    v_mfma_f32_16x16x32_bf16 a[64:67], a[228:231], v[38:41], a[64:67]
    v_exp_f32 v82, v82
    v_mfma_f32_16x16x32_bf16 a[68:71], a[232:235], v[38:41], a[68:71]
    v_exp_f32 v76, v76
    v_mfma_f32_16x16x32_bf16 a[72:75], a[212:215], v[38:41], a[72:75]
    s_waitcnt lgkmcnt(2)
    ds_read_b64_tr_b16 a[228:229], v4 offset:2048
    ds_read_b64_tr_b16 a[226:227], v3 offset:8192
    v_mfma_f32_16x16x32_bf16 a[76:79], a[216:219], v[38:41], a[76:79]
    v_exp_f32 v78, v78
    v_mfma_f32_16x16x32_bf16 a[28:31], a[216:219], v[32:35], a[28:31]
    ds_read_b64_tr_b16 a[234:235], v5 offset:8192
    ds_read_b64_tr_b16 a[232:233], v5 offset:2048
    v_mfma_f32_16x16x32_bf16 a[24:27], a[212:215], v[32:35], a[24:27]
    ds_read_b64_tr_b16 a[230:231], v4 offset:8192
    v_fma_f32 v68, v68, s28, v11
    v_mfma_f32_16x16x32_bf16 v[232:235], a[212:215], v[26:29], v[232:235]
    v_exp_f32 v79, v79
    v_mfma_f32_16x16x32_bf16 v[236:239], a[216:219], v[26:29], v[236:239]
    v_exp_f32 v59, v59
    v_mfma_f32_16x16x32_bf16 v[188:191], a[216:219], v[20:23], v[188:191]
    v_mfma_f32_16x16x32_bf16 v[184:187], a[212:215], v[20:23], v[184:187]
    v_mfma_f32_16x16x32_bf16 v[136:139], a[212:215], v[14:17], v[136:139]
    v_mfma_f32_16x16x32_bf16 v[140:143], a[216:219], v[14:17], v[140:143]
    s_waitcnt lgkmcnt(5)
    v_cvt_pk_bf16_f32 v42, v84, v85
    v_fma_f32 v77, v77, s28, v12
    v_mfma_f32_16x16x32_bf16 v[144:147], a[220:223], v[14:17], v[144:147]
    s_waitcnt lgkmcnt(3)
    v_exp_f32 v77, v77
    v_mfma_f32_16x16x32_bf16 v[148:151], a[224:227], v[14:17], v[148:151]
    v_exp_f32 v90, v90
    v_mfma_f32_16x16x32_bf16 v[196:199], a[224:227], v[20:23], v[196:199]
    v_exp_f32 v65, v65
    v_mfma_f32_16x16x32_bf16 v[192:195], a[220:223], v[20:23], v[192:195]
    v_exp_f32 v81, v81
    v_mfma_f32_16x16x32_bf16 v[240:243], a[220:223], v[26:29], v[240:243]
    v_exp_f32 v57, v57
    v_mfma_f32_16x16x32_bf16 v[244:247], a[224:227], v[26:29], v[244:247]
    v_exp_f32 v71, v71
    v_mfma_f32_16x16x32_bf16 a[36:39], a[224:227], v[32:35], a[36:39]
    s_waitcnt vmcnt(12) lgkmcnt(0)
    v_exp_f32 v68, v68
    v_mfma_f32_16x16x32_bf16 a[32:35], a[220:223], v[32:35], a[32:35]
    v_cvt_pk_bf16_f32 v31, v70, v71
    v_mfma_f32_16x16x32_bf16 a[80:83], a[220:223], v[38:41], a[80:83]
    v_mfma_f32_16x16x32_bf16 a[84:87], a[224:227], v[38:41], a[84:87]
    s_barrier
    v_mfma_f32_16x16x32_bf16 a[88:91], a[228:231], v[38:41], a[88:91]
    ds_read_b128 a[212:215], v0 offset:0
    v_cvt_pk_bf16_f32 v30, v68, v69
    v_mfma_f32_16x16x32_bf16 a[92:95], a[232:235], v[38:41], a[92:95]
    ds_read_b128 a[216:219], v1 offset:0
    v_fma_f32 v64, v64, s28, v10
    v_mfma_f32_16x16x32_bf16 a[44:47], a[232:235], v[32:35], a[44:47]
    s_add_u32 m0, s22, 24576
    ds_read_b128 a[220:223], v0 offset:1024
    v_cvt_pk_bf16_f32 v36, v76, v77
    v_mfma_f32_16x16x32_bf16 a[40:43], a[228:231], v[32:35], a[40:43]
    buffer_load_dwordx4 v6, s[8:11], s21 offen lds
    v_mfma_f32_16x16x32_bf16 v[248:251], a[228:231], v[26:29], v[248:251]
    s_add_u32 s21, s21, 128
    s_add_u32 m0, s22, 25600
    v_mfma_f32_16x16x32_bf16 v[252:255], a[232:235], v[26:29], v[252:255]
    buffer_load_dwordx4 v6, s[8:11], s21 offen lds
    v_mfma_f32_16x16x32_bf16 v[204:207], a[232:235], v[20:23], v[204:207]
    v_exp_f32 v73, v73
    v_mfma_f32_16x16x32_bf16 v[200:203], a[228:231], v[20:23], v[200:203]
    s_add_u32 s21, s21, 128
    s_add_u32 m0, s22, 26624
    ds_read_b128 a[224:227], v1 offset:1024
    v_mfma_f32_16x16x32_bf16 v[152:155], a[228:231], v[14:17], v[152:155]
    buffer_load_dwordx4 v6, s[8:11], s21 offen lds
    v_mfma_f32_16x16x32_bf16 v[156:159], a[232:235], v[14:17], v[156:159]
    s_waitcnt lgkmcnt(3)
    v_mfma_f32_16x16x32_bf16 v[52:55], a[212:215], a[96:99], 0
    s_waitcnt lgkmcnt(2)
    v_mfma_f32_16x16x32_bf16 v[52:55], a[216:219], a[100:103], v[52:55]
    v_fma_f32 v75, v75, s28, v11
    s_waitcnt lgkmcnt(1)
    v_mfma_f32_16x16x32_bf16 v[52:55], a[220:223], a[104:107], v[52:55]
    v_exp_f32 v91, v91
    v_mfma_f32_16x16x32_bf16 v[60:63], a[220:223], a[128:131], 0
    v_cvt_pk_bf16_f32 v17, v58, v59
    v_cvt_pk_bf16_f32 v37, v78, v79
    v_mfma_f32_16x16x32_bf16 v[60:63], a[216:219], a[124:127], v[60:63]
    ds_read_b128 a[232:235], v1 offset:2048
    v_fma_f32 v83, v83, s28, v12
    v_mfma_f32_16x16x32_bf16 v[60:63], a[212:215], a[120:123], v[60:63]
    v_exp_f32 v86, v86
    v_mfma_f32_16x16x32_bf16 v[68:71], a[212:215], a[144:147], 0
    ds_read_b128 a[228:231], v0 offset:2048
    v_fma_f32 v89, v89, s28, v13
    v_mfma_f32_16x16x32_bf16 v[68:71], a[216:219], a[148:151], v[68:71]
    v_exp_f32 v87, v87
    v_mfma_f32_16x16x32_bf16 v[68:71], a[220:223], a[152:155], v[68:71]
    buffer_store_dwordx4 v[96:99], v7, s[16:19], s24 offen offset:0 nt
    v_cvt_pk_bf16_f32 v43, v86, v87
    v_exp_f32 v74, v74
    v_mfma_f32_16x16x32_bf16 v[76:79], a[220:223], a[176:179], 0
    v_exp_f32 v83, v83
    v_mfma_f32_16x16x32_bf16 v[76:79], a[216:219], a[172:175], v[76:79]
    v_cvt_pk_bf16_f32 v35, v82, v83
    v_mfma_f32_16x16x32_bf16 v[76:79], a[212:215], a[168:171], v[76:79]
    v_exp_f32 v88, v88
    v_mfma_f32_16x16x32_bf16 v[84:87], a[212:215], a[192:195], 0
    s_add_u32 s21, s21, 12032
    v_exp_f32 v67, v67
    v_mfma_f32_16x16x32_bf16 v[84:87], a[216:219], a[196:199], v[84:87]
    v_exp_f32 v80, v80
    v_mfma_f32_16x16x32_bf16 v[84:87], a[220:223], a[200:203], v[84:87]
    s_waitcnt lgkmcnt(1)
    v_mfma_f32_16x16x32_bf16 v[84:87], a[224:227], a[204:207], v[84:87]
    s_waitcnt lgkmcnt(0)
    v_exp_f32 v89, v89
    v_mfma_f32_16x16x32_bf16 v[84:87], a[228:231], a[208:211], v[84:87]
    s_add_u32 m0, s23, 3072
    ds_read_b128 a[216:219], v1 offset:6144
    v_cvt_pk_bf16_f32 v40, v88, v89
    v_mfma_f32_16x16x32_bf16 v[84:87], a[232:235], v[92:95], v[84:87]
    v_exp_f32 v64, v64
    v_mfma_f32_16x16x32_bf16 v[76:79], a[232:235], a[188:191], v[76:79]
    ds_read_b128 a[212:215], v0 offset:6144
    v_mfma_f32_16x16x32_bf16 v[76:79], a[228:231], a[184:187], v[76:79]
    buffer_load_dwordx4 v7, s[12:15], s25 offen nt lds
    v_mfma_f32_16x16x32_bf16 v[76:79], a[224:227], a[180:183], v[76:79]
    ds_read_b128 a[220:223], v0 offset:7168
    v_mfma_f32_16x16x32_bf16 v[68:71], a[224:227], a[156:159], v[68:71]
    v_cvt_pk_bf16_f32 v41, v90, v91
    v_mfma_f32_16x16x32_bf16 v[68:71], a[228:231], a[160:163], v[68:71]
    v_exp_f32 v56, v56
    v_mfma_f32_16x16x32_bf16 v[68:71], a[232:235], a[164:167], v[68:71]
    v_mfma_f32_16x16x32_bf16 v[60:63], a[232:235], a[140:143], v[60:63]
    v_cvt_pk_bf16_f32 v16, v56, v57
    v_cvt_pk_bf16_f32 v34, v80, v81
    v_mfma_f32_16x16x32_bf16 v[60:63], a[228:231], a[136:139], v[60:63]
    s_bitcmp1_b32 s27, 0
    v_exp_f32 v72, v72
    v_mfma_f32_16x16x32_bf16 v[60:63], a[224:227], a[132:135], v[60:63]
    v_cvt_pk_bf16_f32 v28, v72, v73
    v_mfma_f32_16x16x32_bf16 v[52:55], a[224:227], a[108:111], v[52:55]
    v_cvt_pk_bf16_f32 v22, v64, v65
    v_mfma_f32_16x16x32_bf16 v[52:55], a[228:231], a[112:115], v[52:55]
    ds_read_b128 a[228:231], v0 offset:8192
    v_cvt_pk_bf16_f32 v23, v66, v67
    v_mfma_f32_16x16x32_bf16 v[52:55], a[232:235], a[116:119], v[52:55]
    v_exp_f32 v75, v75
    v_mfma_f32_16x16x32_bf16 v[48:51], a[236:239], v[16:19], v[44:47]
    ds_read_b128 a[224:227], v1 offset:7168
    v_cvt_pk_bf16_f32 v29, v74, v75
    v_mfma_f32_16x16x32_bf16 v[48:51], a[240:243], v[22:25], v[48:51]
    ds_read_b128 a[232:235], v1 offset:8192
    v_mfma_f32_16x16x32_bf16 v[48:51], a[244:247], v[28:31], v[48:51]
    v_mfma_f32_16x16x32_bf16 v[48:51], a[248:251], v[34:37], v[48:51]
    s_cselect_b32 s26, s49, 128
    v_mfma_f32_16x16x32_bf16 v[48:51], a[252:255], v[40:43], v[48:51]
    s_waitcnt lgkmcnt(3)
    v_mfma_f32_16x16x32_bf16 v[56:59], a[212:215], a[96:99], 0
    s_lshr_b32 s27, s27, 1
    s_add_u32 s24, s24, s26
    s_add_u32 s25, s25, s26
    v_mfma_f32_16x16x32_bf16 v[56:59], a[216:219], a[100:103], v[56:59]
    v_add_u32 v103, 4096, v103
    v_mfma_f32_16x16x32_bf16 v[56:59], a[220:223], a[104:107], v[56:59]
    v_cmp_lt_f32 vcc, s29, v48
    v_mfma_f32_16x16x32_bf16 v[64:67], a[220:223], a[128:131], 0
    v_mfma_f32_16x16x32_bf16 v[64:67], a[216:219], a[124:127], v[64:67]
    s_add_u32 s23, s23, 4096
    v_mfma_f32_16x16x32_bf16 v[64:67], a[212:215], a[120:123], v[64:67]
    s_nop 0
    s_cbranch_vccnz L_rs_loop5w0b
L_ret_loop5w0b:
    v_mfma_f32_16x16x32_bf16 v[72:75], a[212:215], a[144:147], 0
    s_waitcnt vmcnt(12) lgkmcnt(0)
    v_fma_f32 v62, v62, s28, v10
    v_fma_f32 v52, v52, s28, v9
    v_mfma_f32_16x16x32_bf16 v[72:75], a[216:219], a[148:151], v[72:75]
    s_cmp_eq_u32 s30, 5
    v_fma_f32 v60, v60, s28, v10
    v_fma_f32 v55, v55, s28, v9
    v_mfma_f32_16x16x32_bf16 v[72:75], a[220:223], a[152:155], v[72:75]
    s_cselect_b32 s26, s62, 0
    v_fma_f32 v63, v63, s28, v10
    s_add_u32 s20, s20, s26
    v_mfma_f32_16x16x32_bf16 v[80:83], a[220:223], a[176:179], 0
    s_barrier
    v_mfma_f32_16x16x32_bf16 v[80:83], a[216:219], a[172:175], v[80:83]
    s_add_u32 m0, s22, 0
    v_exp_f32 v52, v52
    v_mfma_f32_16x16x32_bf16 v[80:83], a[212:215], a[168:171], v[80:83]
    buffer_load_dwordx4 v6, s[4:7], s20 offen lds
    v_mfma_f32_16x16x32_bf16 v[88:91], a[212:215], a[192:195], 0
    s_add_u32 s20, s20, 128
    s_add_u32 m0, s22, 1024
    ds_read_b64_tr_b16 a[212:213], v2 offset:18432
    v_mfma_f32_16x16x32_bf16 v[88:91], a[216:219], a[196:199], v[88:91]
    buffer_load_dwordx4 v6, s[4:7], s20 offen lds
    v_mfma_f32_16x16x32_bf16 v[88:91], a[220:223], a[200:203], v[88:91]
    s_add_u32 s20, s20, 128
    v_exp_f32 v55, v55
    v_mfma_f32_16x16x32_bf16 v[88:91], a[224:227], a[204:207], v[88:91]
    v_exp_f32 v62, v62
    v_mfma_f32_16x16x32_bf16 v[88:91], a[228:231], a[208:211], v[88:91]
    s_add_u32 m0, s22, 2048
    v_fma_f32 v61, v61, s28, v10
    v_fma_f32 v54, v54, s28, v9
    v_mfma_f32_16x16x32_bf16 v[88:91], a[232:235], v[92:95], v[88:91]
    buffer_load_dwordx4 v6, s[4:7], s20 offen lds
    v_mfma_f32_16x16x32_bf16 v[80:83], a[232:235], a[188:191], v[80:83]
    v_exp_f32 v54, v54
    v_mfma_f32_16x16x32_bf16 v[80:83], a[228:231], a[184:187], v[80:83]
    v_exp_f32 v61, v61
    v_mfma_f32_16x16x32_bf16 v[80:83], a[224:227], a[180:183], v[80:83]
    ds_read_b64_tr_b16 a[214:215], v2 offset:12288
    ds_read_b64_tr_b16 a[216:217], v3 offset:18432
    v_mfma_f32_16x16x32_bf16 v[72:75], a[224:227], a[156:159], v[72:75]
    s_add_u32 s20, s20, 12032
    ds_read_b64_tr_b16 a[218:219], v3 offset:12288
    ds_read_b64_tr_b16 a[220:221], v4 offset:18432
    v_mfma_f32_16x16x32_bf16 v[72:75], a[228:231], a[160:163], v[72:75]
    v_exp_f32 v60, v60
    v_mfma_f32_16x16x32_bf16 v[72:75], a[232:235], a[164:167], v[72:75]
    ds_read_b64_tr_b16 a[222:223], v4 offset:12288
    v_fma_f32 v53, v53, s28, v9
    v_mfma_f32_16x16x32_bf16 v[64:67], a[232:235], a[140:143], v[64:67]
    s_add_u32 s30, s30, 1
    v_cvt_pk_bf16_f32 v20, v60, v61
    v_cvt_pk_bf16_f32 v15, v54, v55
    v_mfma_f32_16x16x32_bf16 v[64:67], a[228:231], a[136:139], v[64:67]
    v_exp_f32 v63, v63
    v_mfma_f32_16x16x32_bf16 v[64:67], a[224:227], a[132:135], v[64:67]
    v_exp_f32 v53, v53
    v_mfma_f32_16x16x32_bf16 v[56:59], a[224:227], a[108:111], v[56:59]
    ds_read_b64_tr_b16 a[224:225], v5 offset:18432
    v_cvt_pk_bf16_f32 v14, v52, v53
    v_mfma_f32_16x16x32_bf16 v[56:59], a[228:231], a[112:115], v[56:59]
    s_cmp_lt_u32 s30, 6
    ds_read_b64_tr_b16 a[226:227], v5 offset:12288
    v_cvt_pk_bf16_f32 v21, v62, v63
    v_mfma_f32_16x16x32_bf16 v[56:59], a[232:235], a[116:119], v[56:59]
    s_cbranch_scc1 L_loop5w0
    s_cmp_ge_u32 s37, 6
    s_cbranch_scc1 L_end5
    s_cmp_eq_u32 s32, 0
    s_cbranch_scc1 L_tr54
    s_branch L_tr55
    .p2align 6
L_loop5w1:
    s_waitcnt lgkmcnt(4)
    v_mfma_f32_16x16x32_bf16 v[112:115], a[212:215], v[16:19], v[112:115]
    ds_read_b128 v[96:99], v103 offset:0
    v_fma_f32 v74, v74, s28, v11
    v_mfma_f32_16x16x32_bf16 v[116:119], a[216:219], v[16:19], v[116:119]
    v_fma_f32 v89, v89, s28, v13
    v_mfma_f32_16x16x32_bf16 v[164:167], a[216:219], v[22:25], v[164:167]
    ds_read_b64_tr_b16 a[228:229], v2 offset:19456
    v_fma_f32 v90, v90, s28, v13
    v_mfma_f32_16x16x32_bf16 v[160:163], a[212:215], v[22:25], v[160:163]
    ds_read_b64_tr_b16 a[230:231], v2 offset:13312
    s_add_u32 s39, s39, 12288
    v_mfma_f32_16x16x32_bf16 v[208:211], a[212:215], v[28:31], v[208:211]
    v_fma_f32 v86, v86, s28, v13
    v_fma_f32 v76, v76, s28, v12
    v_mfma_f32_16x16x32_bf16 v[212:215], a[216:219], v[28:31], v[212:215]
    v_fma_f32 v69, v69, s28, v11
    v_mfma_f32_16x16x32_bf16 a[4:7], a[216:219], v[34:37], a[4:7]
    v_fma_f32 v64, v64, s28, v10
    v_mfma_f32_16x16x32_bf16 a[0:3], a[212:215], v[34:37], a[0:3]
    v_fma_f32 v87, v87, s28, v13
    v_fma_f32 v84, v84, s28, v13
    v_mfma_f32_16x16x32_bf16 a[48:51], a[212:215], v[40:43], a[48:51]
    s_add_u32 m0, s23, 0
    v_exp_f32 v76, v76
    v_mfma_f32_16x16x32_bf16 a[52:55], a[216:219], v[40:43], a[52:55]
    s_waitcnt lgkmcnt(3)
    ds_read_b64_tr_b16 a[216:217], v5 offset:19456
    v_mfma_f32_16x16x32_bf16 a[56:59], a[220:223], v[40:43], a[56:59]
    s_waitcnt lgkmcnt(3)
    buffer_store_dwordx4 v[96:99], v6, s[16:19], s24 offen offset:0 nt
    ds_read_b64_tr_b16 a[232:233], v3 offset:19456
    ds_read_b64_tr_b16 a[234:235], v3 offset:13312
    v_fma_f32 v79, v79, s28, v12
    v_mfma_f32_16x16x32_bf16 a[60:63], a[224:227], v[40:43], a[60:63]
    ds_read_b64_tr_b16 a[218:219], v5 offset:13312
    ds_read_b64_tr_b16 a[214:215], v4 offset:13312
    v_mfma_f32_16x16x32_bf16 a[12:15], a[224:227], v[34:37], a[12:15]
    v_exp_f32 v87, v87
    v_mfma_f32_16x16x32_bf16 a[8:11], a[220:223], v[34:37], a[8:11]
    v_fma_f32 v65, v65, s28, v10
    v_mfma_f32_16x16x32_bf16 v[216:219], a[220:223], v[28:31], v[216:219]
    v_fma_f32 v80, v80, s28, v12
    v_fma_f32 v88, v88, s28, v13
    v_mfma_f32_16x16x32_bf16 v[220:223], a[224:227], v[28:31], v[220:223]
    v_fma_f32 v77, v77, s28, v12
    v_fma_f32 v70, v70, s28, v11
    v_mfma_f32_16x16x32_bf16 v[172:175], a[224:227], v[22:25], v[172:175]
    buffer_load_dwordx4 v6, s[12:15], s25 offen nt lds
    v_mfma_f32_16x16x32_bf16 v[168:171], a[220:223], v[22:25], v[168:171]
    ds_read_b64_tr_b16 a[212:213], v4 offset:19456
    v_fma_f32 v68, v68, s28, v11
    v_mfma_f32_16x16x32_bf16 v[120:123], a[220:223], v[16:19], v[120:123]
    v_fma_f32 v73, v73, s28, v11
    v_mfma_f32_16x16x32_bf16 v[124:127], a[224:227], v[16:19], v[124:127]
    s_waitcnt lgkmcnt(5)
    ds_read_b64_tr_b16 a[220:221], v2 offset:20480
    v_fma_f32 v91, v91, s28, v13
    v_mfma_f32_16x16x32_bf16 v[128:131], a[228:231], v[16:19], v[128:131]
    s_waitcnt lgkmcnt(4)
    ds_read_b64_tr_b16 a[226:227], v3 offset:14336
    v_fma_f32 v59, v59, s28, v9
    v_mfma_f32_16x16x32_bf16 v[132:135], a[232:235], v[16:19], v[132:135]
    ds_read_b64_tr_b16 a[222:223], v2 offset:14336
    v_fma_f32 v85, v85, s28, v13
    v_mfma_f32_16x16x32_bf16 v[180:183], a[232:235], v[22:25], v[180:183]
    v_fma_f32 v81, v81, s28, v12
    v_fma_f32 v67, v67, s28, v10
    v_mfma_f32_16x16x32_bf16 v[176:179], a[228:231], v[22:25], v[176:179]
    ds_read_b128 v[96:99], v103 offset:1024
    v_fma_f32 v71, v71, s28, v11
    v_mfma_f32_16x16x32_bf16 v[224:227], a[228:231], v[28:31], v[224:227]
    v_exp_f32 v65, v65
    v_mfma_f32_16x16x32_bf16 v[228:231], a[232:235], v[28:31], v[228:231]
    v_exp_f32 v71, v71
    v_mfma_f32_16x16x32_bf16 a[20:23], a[232:235], v[34:37], a[20:23]
    v_exp_f32 v90, v90
    v_mfma_f32_16x16x32_bf16 a[16:19], a[228:231], v[34:37], a[16:19]
    v_exp_f32 v70, v70
    v_mfma_f32_16x16x32_bf16 a[64:67], a[228:231], v[40:43], a[64:67]
    v_exp_f32 v84, v84
    v_mfma_f32_16x16x32_bf16 a[68:71], a[232:235], v[40:43], a[68:71]
    s_waitcnt lgkmcnt(3)
    ds_read_b64_tr_b16 a[232:233], v5 offset:20480
    v_fma_f32 v58, v58, s28, v9
    v_mfma_f32_16x16x32_bf16 a[72:75], a[212:215], v[40:43], a[72:75]
    ds_read_b64_tr_b16 a[230:231], v4 offset:14336
    ds_read_b64_tr_b16 a[224:225], v3 offset:20480
    v_mfma_f32_16x16x32_bf16 a[76:79], a[216:219], v[40:43], a[76:79]
    ds_read_b64_tr_b16 a[234:235], v5 offset:14336
    v_mfma_f32_16x16x32_bf16 a[28:31], a[216:219], v[34:37], a[28:31]
    ds_read_b64_tr_b16 a[228:229], v4 offset:20480
    v_fma_f32 v57, v57, s28, v9
    v_mfma_f32_16x16x32_bf16 a[24:27], a[212:215], v[34:37], a[24:27]
    v_exp_f32 v69, v69
    v_mfma_f32_16x16x32_bf16 v[232:235], a[212:215], v[28:31], v[232:235]
    v_mfma_f32_16x16x32_bf16 v[236:239], a[216:219], v[28:31], v[236:239]
    v_exp_f32 v59, v59
    v_mfma_f32_16x16x32_bf16 v[188:191], a[216:219], v[22:25], v[188:191]
    v_exp_f32 v88, v88
    v_mfma_f32_16x16x32_bf16 v[184:187], a[212:215], v[22:25], v[184:187]
    v_exp_f32 v74, v74
    v_mfma_f32_16x16x32_bf16 v[136:139], a[212:215], v[16:19], v[136:139]
    v_fma_f32 v56, v56, s28, v9
    v_mfma_f32_16x16x32_bf16 v[140:143], a[216:219], v[16:19], v[140:143]
    s_waitcnt lgkmcnt(4)
    v_fma_f32 v66, v66, s28, v10
    v_fma_f32 v83, v83, s28, v12
    v_mfma_f32_16x16x32_bf16 v[144:147], a[220:223], v[16:19], v[144:147]
    s_waitcnt lgkmcnt(2)
    v_exp_f32 v85, v85
    v_mfma_f32_16x16x32_bf16 v[148:151], a[224:227], v[16:19], v[148:151]
    v_fma_f32 v82, v82, s28, v12
    v_mfma_f32_16x16x32_bf16 v[196:199], a[224:227], v[22:25], v[196:199]
    s_waitcnt vmcnt(12) lgkmcnt(0)
    v_fma_f32 v75, v75, s28, v11
    v_cvt_pk_bf16_f32 v27, v70, v71
    v_mfma_f32_16x16x32_bf16 v[192:195], a[220:223], v[22:25], v[192:195]
    s_add_u32 m0, s22, 36864
    v_exp_f32 v86, v86
    v_mfma_f32_16x16x32_bf16 v[240:243], a[220:223], v[28:31], v[240:243]
    v_exp_f32 v79, v79
    v_mfma_f32_16x16x32_bf16 v[244:247], a[224:227], v[28:31], v[244:247]
    s_barrier
    v_mfma_f32_16x16x32_bf16 a[36:39], a[224:227], v[34:37], a[36:39]
    v_mfma_f32_16x16x32_bf16 a[32:35], a[220:223], v[34:37], a[32:35]
    buffer_load_dwordx4 v6, s[8:11], s21 offen lds
    v_mfma_f32_16x16x32_bf16 a[80:83], a[220:223], v[40:43], a[80:83]
    v_exp_f32 v68, v68
    v_mfma_f32_16x16x32_bf16 a[84:87], a[224:227], v[40:43], a[84:87]
    ds_read_b128 a[212:215], v0 offset:12288
    v_fma_f32 v78, v78, s28, v12
    v_mfma_f32_16x16x32_bf16 a[88:91], a[228:231], v[40:43], a[88:91]
    s_add_u32 s21, s21, 128
    ds_read_b128 a[216:219], v1 offset:12288
    v_cvt_pk_bf16_f32 v38, v84, v85
    v_mfma_f32_16x16x32_bf16 a[92:95], a[232:235], v[40:43], a[92:95]
    ds_read_b128 a[220:223], v0 offset:13312
    s_add_u32 m0, s22, 37888
    v_mfma_f32_16x16x32_bf16 a[44:47], a[232:235], v[34:37], a[44:47]
    buffer_load_dwordx4 v6, s[8:11], s21 offen lds
    v_mfma_f32_16x16x32_bf16 a[40:43], a[228:231], v[34:37], a[40:43]
    v_exp_f32 v83, v83
    v_mfma_f32_16x16x32_bf16 v[248:251], a[228:231], v[28:31], v[248:251]
    s_add_u32 s21, s21, 128
    v_exp_f32 v56, v56
    v_mfma_f32_16x16x32_bf16 v[252:255], a[232:235], v[28:31], v[252:255]
    v_exp_f32 v75, v75
    v_mfma_f32_16x16x32_bf16 v[204:207], a[232:235], v[22:25], v[204:207]
    v_exp_f32 v66, v66
    v_mfma_f32_16x16x32_bf16 v[200:203], a[228:231], v[22:25], v[200:203]
    s_add_u32 m0, s22, 38912
    v_exp_f32 v67, v67
    v_mfma_f32_16x16x32_bf16 v[152:155], a[228:231], v[16:19], v[152:155]
    buffer_load_dwordx4 v6, s[8:11], s21 offen lds
    v_mfma_f32_16x16x32_bf16 v[156:159], a[232:235], v[16:19], v[156:159]
    s_waitcnt lgkmcnt(2)
    ds_read_b128 a[228:231], v0 offset:14336
    v_cvt_pk_bf16_f32 v26, v68, v69
    v_mfma_f32_16x16x32_bf16 v[52:55], a[212:215], a[96:99], 0
    s_waitcnt lgkmcnt(2)
    v_exp_f32 v78, v78
    v_mfma_f32_16x16x32_bf16 v[52:55], a[216:219], a[100:103], v[52:55]
    s_waitcnt lgkmcnt(1)
    v_cvt_pk_bf16_f32 v23, v66, v67
    v_mfma_f32_16x16x32_bf16 v[52:55], a[220:223], a[104:107], v[52:55]
    v_exp_f32 v77, v77
    v_mfma_f32_16x16x32_bf16 v[60:63], a[220:223], a[128:131], 0
    ds_read_b128 a[224:227], v1 offset:13312
    v_mfma_f32_16x16x32_bf16 v[60:63], a[216:219], a[124:127], v[60:63]
    v_mfma_f32_16x16x32_bf16 v[60:63], a[212:215], a[120:123], v[60:63]
    v_cvt_pk_bf16_f32 v39, v86, v87
    v_mfma_f32_16x16x32_bf16 v[68:71], a[212:215], a[144:147], 0
    buffer_store_dwordx4 v[96:99], v7, s[16:19], s24 offen offset:0 nt
    s_add_u32 s21, s21, 12032
    ds_read_b128 a[232:235], v1 offset:14336
    v_exp_f32 v89, v89
    v_mfma_f32_16x16x32_bf16 v[68:71], a[216:219], a[148:151], v[68:71]
    v_cvt_pk_bf16_f32 v32, v76, v77
    v_cvt_pk_bf16_f32 v33, v78, v79
    v_mfma_f32_16x16x32_bf16 v[68:71], a[220:223], a[152:155], v[68:71]
    v_exp_f32 v57, v57
    v_mfma_f32_16x16x32_bf16 v[76:79], a[220:223], a[176:179], 0
    v_exp_f32 v81, v81
    v_mfma_f32_16x16x32_bf16 v[76:79], a[216:219], a[172:175], v[76:79]
    v_exp_f32 v58, v58
    v_mfma_f32_16x16x32_bf16 v[76:79], a[212:215], a[168:171], v[76:79]
    v_mfma_f32_16x16x32_bf16 v[84:87], a[212:215], a[192:195], 0
    v_exp_f32 v73, v73
    v_mfma_f32_16x16x32_bf16 v[84:87], a[216:219], a[196:199], v[84:87]
    s_add_u32 m0, s23, 1024
    v_exp_f32 v80, v80
    v_mfma_f32_16x16x32_bf16 v[84:87], a[220:223], a[200:203], v[84:87]
    s_waitcnt lgkmcnt(1)
    v_exp_f32 v64, v64
    v_mfma_f32_16x16x32_bf16 v[84:87], a[224:227], a[204:207], v[84:87]
    v_mfma_f32_16x16x32_bf16 v[84:87], a[228:231], a[208:211], v[84:87]
    s_waitcnt lgkmcnt(0)
    v_cvt_pk_bf16_f32 v16, v56, v57
    v_fma_f32 v72, v72, s28, v11
    v_mfma_f32_16x16x32_bf16 v[84:87], a[232:235], v[92:95], v[84:87]
    buffer_load_dwordx4 v7, s[12:15], s25 offen nt lds
    v_mfma_f32_16x16x32_bf16 v[76:79], a[232:235], a[188:191], v[76:79]
    v_exp_f32 v82, v82
    v_mfma_f32_16x16x32_bf16 v[76:79], a[228:231], a[184:187], v[76:79]
    v_exp_f32 v91, v91
    v_mfma_f32_16x16x32_bf16 v[76:79], a[224:227], a[180:183], v[76:79]
    ds_read_b128 a[216:219], v1 offset:18432
    v_mfma_f32_16x16x32_bf16 v[68:71], a[224:227], a[156:159], v[68:71]
    v_cvt_pk_bf16_f32 v34, v80, v81
    v_cvt_pk_bf16_f32 v17, v58, v59
    v_mfma_f32_16x16x32_bf16 v[68:71], a[228:231], a[160:163], v[68:71]
    v_exp_f32 v72, v72
    v_mfma_f32_16x16x32_bf16 v[68:71], a[232:235], a[164:167], v[68:71]
    ds_read_b128 a[212:215], v0 offset:18432
    v_cvt_pk_bf16_f32 v41, v90, v91
    v_mfma_f32_16x16x32_bf16 v[60:63], a[232:235], a[140:143], v[60:63]
    v_cvt_pk_bf16_f32 v29, v74, v75
    v_mfma_f32_16x16x32_bf16 v[60:63], a[228:231], a[136:139], v[60:63]
    s_bitcmp1_b32 s27, 0
    ds_read_b128 a[220:223], v0 offset:19456
    v_cvt_pk_bf16_f32 v28, v72, v73
    v_mfma_f32_16x16x32_bf16 v[60:63], a[224:227], a[132:135], v[60:63]
    s_cselect_b32 s26, s49, 128
    v_cvt_pk_bf16_f32 v22, v64, v65
    v_mfma_f32_16x16x32_bf16 v[52:55], a[224:227], a[108:111], v[52:55]
    v_cvt_pk_bf16_f32 v35, v82, v83
    v_cvt_pk_bf16_f32 v40, v88, v89
    v_mfma_f32_16x16x32_bf16 v[52:55], a[228:231], a[112:115], v[52:55]
    ds_read_b128 a[228:231], v0 offset:20480
    v_mfma_f32_16x16x32_bf16 v[52:55], a[232:235], a[116:119], v[52:55]
    ds_read_b128 a[224:227], v1 offset:19456
    v_mfma_f32_16x16x32_bf16 v[44:47], a[236:239], v[14:17], v[48:51]
    s_lshr_b32 s27, s27, 1
    ds_read_b128 a[232:235], v1 offset:20480
    v_mfma_f32_16x16x32_bf16 v[44:47], a[240:243], v[20:23], v[44:47]
    v_mfma_f32_16x16x32_bf16 v[44:47], a[244:247], v[26:29], v[44:47]
    v_mfma_f32_16x16x32_bf16 v[44:47], a[248:251], v[32:35], v[44:47]
    v_mfma_f32_16x16x32_bf16 v[44:47], a[252:255], v[38:41], v[44:47]
    s_add_u32 s24, s24, s26
    s_waitcnt lgkmcnt(4)
    v_mfma_f32_16x16x32_bf16 v[56:59], a[212:215], a[96:99], 0
    v_mfma_f32_16x16x32_bf16 v[56:59], a[216:219], a[100:103], v[56:59]
    s_waitcnt lgkmcnt(3)
    v_mfma_f32_16x16x32_bf16 v[56:59], a[220:223], a[104:107], v[56:59]
    s_nop 1
    v_cmp_lt_f32 vcc, s29, v44
    v_mfma_f32_16x16x32_bf16 v[64:67], a[220:223], a[128:131], 0
    s_add_u32 s25, s25, s26
    v_mfma_f32_16x16x32_bf16 v[64:67], a[216:219], a[124:127], v[64:67]
    s_waitcnt vmcnt(12) lgkmcnt(0)
    v_mfma_f32_16x16x32_bf16 v[64:67], a[212:215], a[120:123], v[64:67]
    s_barrier
    v_mfma_f32_16x16x32_bf16 v[72:75], a[212:215], a[144:147], 0
    s_cbranch_vccnz L_rs_loop5w1a
L_ret_loop5w1a:
    v_fma_f32 v52, v52, s28, v9
    v_mfma_f32_16x16x32_bf16 v[72:75], a[216:219], a[148:151], v[72:75]
    v_fma_f32 v60, v60, s28, v10
    v_fma_f32 v61, v61, s28, v10
    v_mfma_f32_16x16x32_bf16 v[72:75], a[220:223], a[152:155], v[72:75]
    s_add_u32 m0, s22, 12288
    v_fma_f32 v54, v54, s28, v9
    v_mfma_f32_16x16x32_bf16 v[80:83], a[220:223], a[176:179], 0
    buffer_load_dwordx4 v6, s[4:7], s20 offen lds
    v_mfma_f32_16x16x32_bf16 v[80:83], a[216:219], a[172:175], v[80:83]
    v_exp_f32 v61, v61
    v_mfma_f32_16x16x32_bf16 v[80:83], a[212:215], a[168:171], v[80:83]
    v_exp_f32 v54, v54
    v_mfma_f32_16x16x32_bf16 v[88:91], a[212:215], a[192:195], 0
    ds_read_b64_tr_b16 a[212:213], v2 offset:0
    ds_read_b64_tr_b16 a[214:215], v2 offset:6144
    v_mfma_f32_16x16x32_bf16 v[88:91], a[216:219], a[196:199], v[88:91]
    s_add_u32 s20, s20, 128
    s_add_u32 m0, s22, 13312
    v_fma_f32 v53, v53, s28, v9
    v_mfma_f32_16x16x32_bf16 v[88:91], a[220:223], a[200:203], v[88:91]
    buffer_load_dwordx4 v6, s[4:7], s20 offen lds
    v_mfma_f32_16x16x32_bf16 v[88:91], a[224:227], a[204:207], v[88:91]
    v_fma_f32 v62, v62, s28, v10
    s_add_u32 s20, s20, 128
    v_mfma_f32_16x16x32_bf16 v[88:91], a[228:231], a[208:211], v[88:91]
    s_add_u32 m0, s22, 14336
    v_exp_f32 v60, v60
    v_mfma_f32_16x16x32_bf16 v[88:91], a[232:235], v[92:95], v[88:91]
    buffer_load_dwordx4 v6, s[4:7], s20 offen lds
    v_mfma_f32_16x16x32_bf16 v[80:83], a[232:235], a[188:191], v[80:83]
    ds_read_b64_tr_b16 a[216:217], v3 offset:0
    v_mfma_f32_16x16x32_bf16 v[80:83], a[228:231], a[184:187], v[80:83]
    ds_read_b64_tr_b16 a[218:219], v3 offset:6144
    v_fma_f32 v63, v63, s28, v10
    v_mfma_f32_16x16x32_bf16 v[80:83], a[224:227], a[180:183], v[80:83]
    ds_read_b64_tr_b16 a[220:221], v4 offset:0
    v_cvt_pk_bf16_f32 v24, v60, v61
    v_mfma_f32_16x16x32_bf16 v[72:75], a[224:227], a[156:159], v[72:75]
    s_add_u32 s20, s20, 12032
    v_exp_f32 v63, v63
    v_mfma_f32_16x16x32_bf16 v[72:75], a[228:231], a[160:163], v[72:75]
    v_exp_f32 v52, v52
    v_mfma_f32_16x16x32_bf16 v[72:75], a[232:235], a[164:167], v[72:75]
    v_fma_f32 v55, v55, s28, v9
    v_mfma_f32_16x16x32_bf16 v[64:67], a[232:235], a[140:143], v[64:67]
    v_exp_f32 v53, v53
    v_mfma_f32_16x16x32_bf16 v[64:67], a[228:231], a[136:139], v[64:67]
    v_exp_f32 v55, v55
    v_mfma_f32_16x16x32_bf16 v[64:67], a[224:227], a[132:135], v[64:67]
    v_exp_f32 v62, v62
    v_mfma_f32_16x16x32_bf16 v[56:59], a[224:227], a[108:111], v[56:59]
    v_cvt_pk_bf16_f32 v25, v62, v63
    v_cvt_pk_bf16_f32 v19, v54, v55
    v_mfma_f32_16x16x32_bf16 v[56:59], a[228:231], a[112:115], v[56:59]
    ds_read_b64_tr_b16 a[222:223], v4 offset:6144
    ds_read_b64_tr_b16 a[224:225], v5 offset:0
    v_mfma_f32_16x16x32_bf16 v[56:59], a[232:235], a[116:119], v[56:59]
    ds_read_b64_tr_b16 a[226:227], v5 offset:6144
    v_cvt_pk_bf16_f32 v18, v52, v53
    ds_read_b128 v[96:99], v103 offset:2048
    s_waitcnt lgkmcnt(5)
    v_mfma_f32_16x16x32_bf16 v[112:115], a[212:215], v[14:17], v[112:115]
    ds_read_b64_tr_b16 a[228:229], v2 offset:1024
    v_fma_f32 v82, v82, s28, v12
    v_mfma_f32_16x16x32_bf16 v[116:119], a[216:219], v[14:17], v[116:119]
    v_mfma_f32_16x16x32_bf16 v[164:167], a[216:219], v[20:23], v[164:167]
    v_fma_f32 v89, v89, s28, v13
    v_fma_f32 v77, v77, s28, v12
    v_mfma_f32_16x16x32_bf16 v[160:163], a[212:215], v[20:23], v[160:163]
    v_fma_f32 v81, v81, s28, v12
    v_fma_f32 v78, v78, s28, v12
    v_mfma_f32_16x16x32_bf16 v[208:211], a[212:215], v[26:29], v[208:211]
    s_add_u32 s39, s39, 12288
    ds_read_b64_tr_b16 a[232:233], v3 offset:1024
    v_fma_f32 v65, v65, s28, v10
    v_mfma_f32_16x16x32_bf16 v[212:215], a[216:219], v[26:29], v[212:215]
    ds_read_b64_tr_b16 a[234:235], v3 offset:7168
    v_fma_f32 v84, v84, s28, v13
    v_mfma_f32_16x16x32_bf16 a[4:7], a[216:219], v[32:35], a[4:7]
    v_fma_f32 v87, v87, s28, v13
    v_fma_f32 v83, v83, s28, v12
    v_mfma_f32_16x16x32_bf16 a[0:3], a[212:215], v[32:35], a[0:3]
    ds_read_b64_tr_b16 a[230:231], v2 offset:7168
    v_fma_f32 v80, v80, s28, v12
    v_mfma_f32_16x16x32_bf16 a[48:51], a[212:215], v[38:41], a[48:51]
    v_mfma_f32_16x16x32_bf16 a[52:55], a[216:219], v[38:41], a[52:55]
    s_waitcnt lgkmcnt(4)
    v_fma_f32 v70, v70, s28, v11
    v_mfma_f32_16x16x32_bf16 a[56:59], a[220:223], v[38:41], a[56:59]
    buffer_store_dwordx4 v[96:99], v6, s[16:19], s24 offen offset:0 nt
    ds_read_b64_tr_b16 a[216:217], v5 offset:1024
    v_exp_f32 v83, v83
    v_mfma_f32_16x16x32_bf16 a[60:63], a[224:227], v[38:41], a[60:63]
    v_exp_f32 v78, v78
    v_mfma_f32_16x16x32_bf16 a[12:15], a[224:227], v[32:35], a[12:15]
    v_exp_f32 v81, v81
    v_mfma_f32_16x16x32_bf16 a[8:11], a[220:223], v[32:35], a[8:11]
    s_add_u32 m0, s23, 2048
    v_fma_f32 v79, v79, s28, v12
    v_fma_f32 v64, v64, s28, v10
    v_mfma_f32_16x16x32_bf16 v[216:219], a[220:223], v[26:29], v[216:219]
    v_fma_f32 v71, v71, s28, v11
    v_fma_f32 v67, v67, s28, v10
    v_mfma_f32_16x16x32_bf16 v[220:223], a[224:227], v[26:29], v[220:223]
    ds_read_b64_tr_b16 a[212:213], v4 offset:1024
    v_mfma_f32_16x16x32_bf16 v[172:175], a[224:227], v[20:23], v[172:175]
    v_fma_f32 v74, v74, s28, v11
    v_fma_f32 v59, v59, s28, v9
    v_mfma_f32_16x16x32_bf16 v[168:171], a[220:223], v[20:23], v[168:171]
    buffer_load_dwordx4 v6, s[12:15], s25 offen nt lds
    v_mfma_f32_16x16x32_bf16 v[120:123], a[220:223], v[14:17], v[120:123]
    ds_read_b64_tr_b16 a[218:219], v5 offset:7168
    ds_read_b64_tr_b16 a[214:215], v4 offset:7168
    v_mfma_f32_16x16x32_bf16 v[124:127], a[224:227], v[14:17], v[124:127]
    s_waitcnt lgkmcnt(4)
    v_exp_f32 v79, v79
    v_mfma_f32_16x16x32_bf16 v[128:131], a[228:231], v[14:17], v[128:131]
    v_mfma_f32_16x16x32_bf16 v[132:135], a[232:235], v[14:17], v[132:135]
    ds_read_b64_tr_b16 a[220:221], v2 offset:2048
    ds_read_b64_tr_b16 a[222:223], v2 offset:8192
    v_mfma_f32_16x16x32_bf16 v[180:183], a[232:235], v[20:23], v[180:183]
    v_fma_f32 v86, v86, s28, v13
    v_cvt_pk_bf16_f32 v37, v78, v79
    v_mfma_f32_16x16x32_bf16 v[176:179], a[228:231], v[20:23], v[176:179]
    ds_read_b128 v[96:99], v103 offset:3072
    v_mfma_f32_16x16x32_bf16 v[224:227], a[228:231], v[26:29], v[224:227]
    ds_read_b64_tr_b16 a[226:227], v3 offset:8192
    v_fma_f32 v85, v85, s28, v13
    v_mfma_f32_16x16x32_bf16 v[228:231], a[232:235], v[26:29], v[228:231]
    v_fma_f32 v75, v75, s28, v11
    v_fma_f32 v69, v69, s28, v11
    v_mfma_f32_16x16x32_bf16 a[20:23], a[232:235], v[32:35], a[20:23]
    v_exp_f32 v71, v71
    v_mfma_f32_16x16x32_bf16 a[16:19], a[228:231], v[32:35], a[16:19]
    v_fma_f32 v91, v91, s28, v13
    v_fma_f32 v76, v76, s28, v12
    v_mfma_f32_16x16x32_bf16 a[64:67], a[228:231], v[38:41], a[64:67]
    v_exp_f32 v75, v75
    v_mfma_f32_16x16x32_bf16 a[68:71], a[232:235], v[38:41], a[68:71]
    s_waitcnt lgkmcnt(4)
    ds_read_b64_tr_b16 a[224:225], v3 offset:2048
    ds_read_b64_tr_b16 a[228:229], v4 offset:2048
    v_mfma_f32_16x16x32_bf16 a[72:75], a[212:215], v[38:41], a[72:75]
    ds_read_b64_tr_b16 a[232:233], v5 offset:2048
    v_fma_f32 v68, v68, s28, v11
    v_mfma_f32_16x16x32_bf16 a[76:79], a[216:219], v[38:41], a[76:79]
    ds_read_b64_tr_b16 a[230:231], v4 offset:8192
    ds_read_b64_tr_b16 a[234:235], v5 offset:8192
    v_mfma_f32_16x16x32_bf16 a[28:31], a[216:219], v[32:35], a[28:31]
    v_exp_f32 v74, v74
    v_mfma_f32_16x16x32_bf16 a[24:27], a[212:215], v[32:35], a[24:27]
    v_fma_f32 v88, v88, s28, v13
    v_mfma_f32_16x16x32_bf16 v[232:235], a[212:215], v[26:29], v[232:235]
    v_fma_f32 v90, v90, s28, v13
    v_fma_f32 v73, v73, s28, v11
    v_mfma_f32_16x16x32_bf16 v[236:239], a[216:219], v[26:29], v[236:239]
    v_exp_f32 v90, v90
    v_mfma_f32_16x16x32_bf16 v[188:191], a[216:219], v[20:23], v[188:191]
    v_exp_f32 v67, v67
    v_mfma_f32_16x16x32_bf16 v[184:187], a[212:215], v[20:23], v[184:187]
    v_exp_f32 v70, v70
    v_mfma_f32_16x16x32_bf16 v[136:139], a[212:215], v[14:17], v[136:139]
    v_exp_f32 v76, v76
    v_mfma_f32_16x16x32_bf16 v[140:143], a[216:219], v[14:17], v[140:143]
    s_waitcnt lgkmcnt(3)
    v_exp_f32 v86, v86
    v_mfma_f32_16x16x32_bf16 v[144:147], a[220:223], v[14:17], v[144:147]
    v_exp_f32 v87, v87
    v_mfma_f32_16x16x32_bf16 v[148:151], a[224:227], v[14:17], v[148:151]
    v_exp_f32 v64, v64
    v_mfma_f32_16x16x32_bf16 v[196:199], a[224:227], v[20:23], v[196:199]
    v_exp_f32 v77, v77
    v_mfma_f32_16x16x32_bf16 v[192:195], a[220:223], v[20:23], v[192:195]
    s_waitcnt vmcnt(12) lgkmcnt(0)
    v_exp_f32 v88, v88
    v_mfma_f32_16x16x32_bf16 v[240:243], a[220:223], v[26:29], v[240:243]
    v_exp_f32 v65, v65
    v_mfma_f32_16x16x32_bf16 v[244:247], a[224:227], v[26:29], v[244:247]
    s_barrier
    v_mfma_f32_16x16x32_bf16 a[36:39], a[224:227], v[32:35], a[36:39]
    v_fma_f32 v72, v72, s28, v11
    s_add_u32 m0, s22, 24576
    v_mfma_f32_16x16x32_bf16 a[32:35], a[220:223], v[32:35], a[32:35]
    buffer_load_dwordx4 v6, s[8:11], s21 offen lds
    v_mfma_f32_16x16x32_bf16 a[80:83], a[220:223], v[38:41], a[80:83]
    s_add_u32 s21, s21, 128
    v_exp_f32 v68, v68
    v_mfma_f32_16x16x32_bf16 a[84:87], a[224:227], v[38:41], a[84:87]
    ds_read_b128 a[212:215], v0 offset:0
    v_mfma_f32_16x16x32_bf16 a[88:91], a[228:231], v[38:41], a[88:91]
    ds_read_b128 a[216:219], v1 offset:0
    v_mfma_f32_16x16x32_bf16 a[92:95], a[232:235], v[38:41], a[92:95]
    s_add_u32 m0, s22, 25600
    ds_read_b128 a[220:223], v0 offset:1024
    v_fma_f32 v66, v66, s28, v10
    v_mfma_f32_16x16x32_bf16 a[44:47], a[232:235], v[32:35], a[44:47]
    buffer_load_dwordx4 v6, s[8:11], s21 offen lds
    v_mfma_f32_16x16x32_bf16 a[40:43], a[228:231], v[32:35], a[40:43]
    v_cvt_pk_bf16_f32 v36, v76, v77
    v_mfma_f32_16x16x32_bf16 v[248:251], a[228:231], v[26:29], v[248:251]
    s_add_u32 s21, s21, 128
    ds_read_b128 a[224:227], v1 offset:1024
    v_fma_f32 v56, v56, s28, v9
    v_mfma_f32_16x16x32_bf16 v[252:255], a[232:235], v[26:29], v[252:255]
    v_exp_f32 v80, v80
    v_mfma_f32_16x16x32_bf16 v[204:207], a[232:235], v[20:23], v[204:207]
    s_add_u32 m0, s22, 26624
    v_exp_f32 v59, v59
    v_mfma_f32_16x16x32_bf16 v[200:203], a[228:231], v[20:23], v[200:203]
    buffer_load_dwordx4 v6, s[8:11], s21 offen lds
    v_mfma_f32_16x16x32_bf16 v[152:155], a[228:231], v[14:17], v[152:155]
    ds_read_b128 a[228:231], v0 offset:2048
    v_cvt_pk_bf16_f32 v31, v70, v71
    v_mfma_f32_16x16x32_bf16 v[156:159], a[232:235], v[14:17], v[156:159]
    s_waitcnt lgkmcnt(4)
    v_exp_f32 v85, v85
    v_mfma_f32_16x16x32_bf16 v[52:55], a[212:215], a[96:99], 0
    s_waitcnt lgkmcnt(3)
    v_exp_f32 v91, v91
    v_mfma_f32_16x16x32_bf16 v[52:55], a[216:219], a[100:103], v[52:55]
    s_waitcnt lgkmcnt(2)
    v_exp_f32 v69, v69
    v_mfma_f32_16x16x32_bf16 v[52:55], a[220:223], a[104:107], v[52:55]
    s_add_u32 s21, s21, 12032
    v_mfma_f32_16x16x32_bf16 v[60:63], a[220:223], a[128:131], 0
    v_exp_f32 v84, v84
    v_mfma_f32_16x16x32_bf16 v[60:63], a[216:219], a[124:127], v[60:63]
    v_fma_f32 v58, v58, s28, v9
    v_cvt_pk_bf16_f32 v30, v68, v69
    v_mfma_f32_16x16x32_bf16 v[60:63], a[212:215], a[120:123], v[60:63]
    v_exp_f32 v82, v82
    v_mfma_f32_16x16x32_bf16 v[68:71], a[212:215], a[144:147], 0
    ds_read_b128 a[232:235], v1 offset:2048
    v_cvt_pk_bf16_f32 v42, v84, v85
    v_mfma_f32_16x16x32_bf16 v[68:71], a[216:219], a[148:151], v[68:71]
    buffer_store_dwordx4 v[96:99], v7, s[16:19], s24 offen offset:0 nt
    v_fma_f32 v57, v57, s28, v9
    v_mfma_f32_16x16x32_bf16 v[68:71], a[220:223], a[152:155], v[68:71]
    v_exp_f32 v66, v66
    v_mfma_f32_16x16x32_bf16 v[76:79], a[220:223], a[176:179], 0
    v_exp_f32 v89, v89
    v_mfma_f32_16x16x32_bf16 v[76:79], a[216:219], a[172:175], v[76:79]
    v_cvt_pk_bf16_f32 v43, v86, v87
    v_mfma_f32_16x16x32_bf16 v[76:79], a[212:215], a[168:171], v[76:79]
    v_exp_f32 v58, v58
    v_mfma_f32_16x16x32_bf16 v[84:87], a[212:215], a[192:195], 0
    v_exp_f32 v72, v72
    v_mfma_f32_16x16x32_bf16 v[84:87], a[216:219], a[196:199], v[84:87]
    ds_read_b128 a[212:215], v0 offset:6144
    v_mfma_f32_16x16x32_bf16 v[84:87], a[220:223], a[200:203], v[84:87]
    s_waitcnt lgkmcnt(2)
    v_cvt_pk_bf16_f32 v35, v82, v83
    v_cvt_pk_bf16_f32 v17, v58, v59
    v_mfma_f32_16x16x32_bf16 v[84:87], a[224:227], a[204:207], v[84:87]
    s_add_u32 m0, s23, 3072
    v_cvt_pk_bf16_f32 v29, v74, v75
    v_mfma_f32_16x16x32_bf16 v[84:87], a[228:231], a[208:211], v[84:87]
    s_waitcnt lgkmcnt(1)
    v_mfma_f32_16x16x32_bf16 v[84:87], a[232:235], v[92:95], v[84:87]
    buffer_load_dwordx4 v7, s[12:15], s25 offen nt lds
    v_mfma_f32_16x16x32_bf16 v[76:79], a[232:235], a[188:191], v[76:79]
    ds_read_b128 a[220:223], v0 offset:7168
    v_cvt_pk_bf16_f32 v41, v90, v91
    v_mfma_f32_16x16x32_bf16 v[76:79], a[228:231], a[184:187], v[76:79]
    v_exp_f32 v56, v56
    v_mfma_f32_16x16x32_bf16 v[76:79], a[224:227], a[180:183], v[76:79]
    v_exp_f32 v73, v73
    v_mfma_f32_16x16x32_bf16 v[68:71], a[224:227], a[156:159], v[68:71]
    ds_read_b128 a[216:219], v1 offset:6144
    v_mfma_f32_16x16x32_bf16 v[68:71], a[228:231], a[160:163], v[68:71]
    s_bitcmp1_b32 s27, 0
    v_cvt_pk_bf16_f32 v23, v66, v67
    v_mfma_f32_16x16x32_bf16 v[68:71], a[232:235], a[164:167], v[68:71]
    v_mfma_f32_16x16x32_bf16 v[60:63], a[232:235], a[140:143], v[60:63]
    s_cselect_b32 s26, s49, 128
    v_exp_f32 v57, v57
    v_mfma_f32_16x16x32_bf16 v[60:63], a[228:231], a[136:139], v[60:63]
    v_cvt_pk_bf16_f32 v34, v80, v81
    v_mfma_f32_16x16x32_bf16 v[60:63], a[224:227], a[132:135], v[60:63]
    s_lshr_b32 s27, s27, 1
    v_cvt_pk_bf16_f32 v40, v88, v89
    v_cvt_pk_bf16_f32 v16, v56, v57
    v_mfma_f32_16x16x32_bf16 v[52:55], a[224:227], a[108:111], v[52:55]
    v_mfma_f32_16x16x32_bf16 v[52:55], a[228:231], a[112:115], v[52:55]
    ds_read_b128 a[224:227], v1 offset:7168
    v_mfma_f32_16x16x32_bf16 v[48:51], a[236:239], v[16:19], v[44:47]
    ds_read_b128 a[228:231], v0 offset:8192
    v_cvt_pk_bf16_f32 v22, v64, v65
    v_mfma_f32_16x16x32_bf16 v[52:55], a[232:235], a[116:119], v[52:55]
    ds_read_b128 a[232:235], v1 offset:8192
    v_cvt_pk_bf16_f32 v28, v72, v73
    v_mfma_f32_16x16x32_bf16 v[48:51], a[240:243], v[22:25], v[48:51]
    s_nop 0
    v_mfma_f32_16x16x32_bf16 v[48:51], a[244:247], v[28:31], v[48:51]
    s_waitcnt lgkmcnt(3)
    v_mfma_f32_16x16x32_bf16 v[56:59], a[212:215], a[96:99], 0
    v_mfma_f32_16x16x32_bf16 v[48:51], a[248:251], v[34:37], v[48:51]
    v_mfma_f32_16x16x32_bf16 v[56:59], a[216:219], a[100:103], v[56:59]
    v_mfma_f32_16x16x32_bf16 v[48:51], a[252:255], v[40:43], v[48:51]
    v_add_u32 v103, 4096, v103
    s_add_u32 s24, s24, s26
    v_mfma_f32_16x16x32_bf16 v[56:59], a[220:223], a[104:107], v[56:59]
    s_add_u32 s25, s25, s26
    s_add_u32 s23, s23, 4096
    v_mfma_f32_16x16x32_bf16 v[64:67], a[220:223], a[128:131], 0
    s_nop 1
    v_cmp_lt_f32 vcc, s29, v48
    v_mfma_f32_16x16x32_bf16 v[64:67], a[216:219], a[124:127], v[64:67]
    s_waitcnt vmcnt(12) lgkmcnt(0)
    v_mfma_f32_16x16x32_bf16 v[64:67], a[212:215], a[120:123], v[64:67]
    s_barrier
    v_mfma_f32_16x16x32_bf16 v[72:75], a[212:215], a[144:147], 0
    s_cbranch_vccnz L_rs_loop5w1b
L_ret_loop5w1b:
    v_fma_f32 v60, v60, s28, v10
    v_mfma_f32_16x16x32_bf16 v[72:75], a[216:219], a[148:151], v[72:75]
    s_cmp_eq_u32 s30, 5
    v_fma_f32 v61, v61, s28, v10
    v_fma_f32 v52, v52, s28, v9
    v_mfma_f32_16x16x32_bf16 v[72:75], a[220:223], a[152:155], v[72:75]
    s_cselect_b32 s26, s62, 0
    v_exp_f32 v52, v52
    v_mfma_f32_16x16x32_bf16 v[80:83], a[220:223], a[176:179], 0
    s_add_u32 s20, s20, s26
    s_add_u32 m0, s22, 0
    v_fma_f32 v54, v54, s28, v9
    v_mfma_f32_16x16x32_bf16 v[80:83], a[216:219], a[172:175], v[80:83]
    buffer_load_dwordx4 v6, s[4:7], s20 offen lds
    v_mfma_f32_16x16x32_bf16 v[80:83], a[212:215], a[168:171], v[80:83]
    v_fma_f32 v53, v53, s28, v9
    v_fma_f32 v63, v63, s28, v10
    v_mfma_f32_16x16x32_bf16 v[88:91], a[212:215], a[192:195], 0
    ds_read_b64_tr_b16 a[212:213], v2 offset:18432
    s_add_u32 s20, s20, 128
    v_mfma_f32_16x16x32_bf16 v[88:91], a[216:219], a[196:199], v[88:91]
    s_add_u32 m0, s22, 1024
    ds_read_b64_tr_b16 a[214:215], v2 offset:12288
    v_fma_f32 v62, v62, s28, v10
    v_mfma_f32_16x16x32_bf16 v[88:91], a[220:223], a[200:203], v[88:91]
    buffer_load_dwordx4 v6, s[4:7], s20 offen lds
    v_mfma_f32_16x16x32_bf16 v[88:91], a[224:227], a[204:207], v[88:91]
    s_add_u32 s20, s20, 128
    ds_read_b64_tr_b16 a[216:217], v3 offset:18432
    v_mfma_f32_16x16x32_bf16 v[88:91], a[228:231], a[208:211], v[88:91]
    s_add_u32 m0, s22, 2048
    v_exp_f32 v63, v63
    v_mfma_f32_16x16x32_bf16 v[88:91], a[232:235], v[92:95], v[88:91]
    buffer_load_dwordx4 v6, s[4:7], s20 offen lds
    v_mfma_f32_16x16x32_bf16 v[80:83], a[232:235], a[188:191], v[80:83]
    v_exp_f32 v53, v53
    v_mfma_f32_16x16x32_bf16 v[80:83], a[228:231], a[184:187], v[80:83]
    s_add_u32 s20, s20, 12032
    ds_read_b64_tr_b16 a[218:219], v3 offset:12288
    v_cvt_pk_bf16_f32 v14, v52, v53
    v_mfma_f32_16x16x32_bf16 v[80:83], a[224:227], a[180:183], v[80:83]
    v_exp_f32 v54, v54
    v_mfma_f32_16x16x32_bf16 v[72:75], a[224:227], a[156:159], v[72:75]
    v_exp_f32 v60, v60
    v_mfma_f32_16x16x32_bf16 v[72:75], a[228:231], a[160:163], v[72:75]
    v_exp_f32 v61, v61
    v_mfma_f32_16x16x32_bf16 v[72:75], a[232:235], a[164:167], v[72:75]
    v_exp_f32 v62, v62
    v_mfma_f32_16x16x32_bf16 v[64:67], a[232:235], a[140:143], v[64:67]
    ds_read_b64_tr_b16 a[220:221], v4 offset:18432
    v_cvt_pk_bf16_f32 v21, v62, v63
    v_mfma_f32_16x16x32_bf16 v[64:67], a[228:231], a[136:139], v[64:67]
    v_fma_f32 v55, v55, s28, v9
    v_cvt_pk_bf16_f32 v20, v60, v61
    v_mfma_f32_16x16x32_bf16 v[64:67], a[224:227], a[132:135], v[64:67]
    s_add_u32 s30, s30, 1
    v_exp_f32 v55, v55
    v_mfma_f32_16x16x32_bf16 v[56:59], a[224:227], a[108:111], v[56:59]
    s_cmp_lt_u32 s30, 6
    ds_read_b64_tr_b16 a[222:223], v4 offset:12288
    ds_read_b64_tr_b16 a[224:225], v5 offset:18432
    v_mfma_f32_16x16x32_bf16 v[56:59], a[228:231], a[112:115], v[56:59]
    ds_read_b64_tr_b16 a[226:227], v5 offset:12288
    v_cvt_pk_bf16_f32 v15, v54, v55
    v_mfma_f32_16x16x32_bf16 v[56:59], a[232:235], a[116:119], v[56:59]
    s_cbranch_scc1 L_loop5w1
    s_cmp_ge_u32 s37, 6
    s_cbranch_scc1 L_end5
    s_cmp_eq_u32 s32, 0
    s_cbranch_scc1 L_tr54
    s_branch L_tr55
L_tr54:
    s_waitcnt lgkmcnt(4)
    v_mfma_f32_16x16x32_bf16 v[112:115], a[212:215], v[16:19], v[112:115]
    v_fma_f32 v79, v79, s28, v12
    v_fma_f32 v69, v69, s28, v11
    v_mfma_f32_16x16x32_bf16 v[116:119], a[216:219], v[16:19], v[116:119]
    ds_read_b64_tr_b16 a[232:233], v3 offset:19456
    v_fma_f32 v89, v89, s28, v13
    v_mfma_f32_16x16x32_bf16 v[164:167], a[216:219], v[22:25], v[164:167]
    v_fma_f32 v58, v58, s28, v9
    v_fma_f32 v66, v66, s28, v10
    v_mfma_f32_16x16x32_bf16 v[160:163], a[212:215], v[22:25], v[160:163]
    v_exp_f32 v58, v58
    v_mfma_f32_16x16x32_bf16 v[208:211], a[212:215], v[28:31], v[208:211]
    ds_read_b64_tr_b16 a[230:231], v2 offset:13312
    v_fma_f32 v68, v68, s28, v11
    v_mfma_f32_16x16x32_bf16 v[212:215], a[216:219], v[28:31], v[212:215]
    v_fma_f32 v71, v71, s28, v11
    v_mfma_f32_16x16x32_bf16 a[4:7], a[216:219], v[34:37], a[4:7]
    ds_read_b64_tr_b16 a[228:229], v2 offset:19456
    v_fma_f32 v88, v88, s28, v13
    v_mfma_f32_16x16x32_bf16 a[0:3], a[212:215], v[34:37], a[0:3]
    ds_read_b64_tr_b16 a[234:235], v3 offset:13312
    v_fma_f32 v81, v81, s28, v12
    v_mfma_f32_16x16x32_bf16 a[48:51], a[212:215], v[40:43], a[48:51]
    v_fma_f32 v90, v90, s28, v13
    v_fma_f32 v65, v65, s28, v10
    v_mfma_f32_16x16x32_bf16 a[52:55], a[216:219], v[40:43], a[52:55]
    s_waitcnt lgkmcnt(4)
    v_fma_f32 v84, v84, s28, v13
    v_mfma_f32_16x16x32_bf16 a[56:59], a[220:223], v[40:43], a[56:59]
    v_fma_f32 v83, v83, s28, v12
    v_fma_f32 v59, v59, s28, v9
    v_mfma_f32_16x16x32_bf16 a[60:63], a[224:227], v[40:43], a[60:63]
    v_exp_f32 v65, v65
    v_mfma_f32_16x16x32_bf16 a[12:15], a[224:227], v[34:37], a[12:15]
    v_exp_f32 v89, v89
    v_mfma_f32_16x16x32_bf16 a[8:11], a[220:223], v[34:37], a[8:11]
    v_fma_f32 v76, v76, s28, v12
    v_mfma_f32_16x16x32_bf16 v[216:219], a[220:223], v[28:31], v[216:219]
    ds_read_b64_tr_b16 a[216:217], v5 offset:19456
    v_fma_f32 v70, v70, s28, v11
    v_mfma_f32_16x16x32_bf16 v[220:223], a[224:227], v[28:31], v[220:223]
    s_add_u32 s39, s39, 12288
    v_fma_f32 v86, v86, s28, v13
    v_fma_f32 v77, v77, s28, v12
    v_mfma_f32_16x16x32_bf16 v[172:175], a[224:227], v[22:25], v[172:175]
    ds_read_b64_tr_b16 a[218:219], v5 offset:13312
    v_fma_f32 v80, v80, s28, v12
    v_mfma_f32_16x16x32_bf16 v[168:171], a[220:223], v[22:25], v[168:171]
    v_exp_f32 v68, v68
    v_mfma_f32_16x16x32_bf16 v[120:123], a[220:223], v[16:19], v[120:123]
    ds_read_b64_tr_b16 a[214:215], v4 offset:13312
    v_fma_f32 v87, v87, s28, v13
    v_mfma_f32_16x16x32_bf16 v[124:127], a[224:227], v[16:19], v[124:127]
    s_waitcnt lgkmcnt(3)
    ds_read_b64_tr_b16 a[212:213], v4 offset:19456
    v_fma_f32 v64, v64, s28, v10
    v_mfma_f32_16x16x32_bf16 v[128:131], a[228:231], v[16:19], v[128:131]
    ds_read_b64_tr_b16 a[220:221], v2 offset:20480
    v_mfma_f32_16x16x32_bf16 v[132:135], a[232:235], v[16:19], v[132:135]
    ds_read_b64_tr_b16 a[226:227], v3 offset:14336
    v_fma_f32 v85, v85, s28, v13
    v_mfma_f32_16x16x32_bf16 v[180:183], a[232:235], v[22:25], v[180:183]
    ds_read_b64_tr_b16 a[222:223], v2 offset:14336
    v_fma_f32 v56, v56, s28, v9
    v_mfma_f32_16x16x32_bf16 v[176:179], a[228:231], v[22:25], v[176:179]
    v_exp_f32 v90, v90
    v_mfma_f32_16x16x32_bf16 v[224:227], a[228:231], v[28:31], v[224:227]
    v_fma_f32 v57, v57, s28, v9
    v_mfma_f32_16x16x32_bf16 v[228:231], a[232:235], v[28:31], v[228:231]
    v_exp_f32 v80, v80
    v_mfma_f32_16x16x32_bf16 a[20:23], a[232:235], v[34:37], a[20:23]
    v_fma_f32 v82, v82, s28, v12
    v_mfma_f32_16x16x32_bf16 a[16:19], a[228:231], v[34:37], a[16:19]
    v_exp_f32 v69, v69
    v_mfma_f32_16x16x32_bf16 a[64:67], a[228:231], v[40:43], a[64:67]
    ds_read_b64_tr_b16 a[224:225], v3 offset:20480
    v_mfma_f32_16x16x32_bf16 a[68:71], a[232:235], v[40:43], a[68:71]
    s_waitcnt lgkmcnt(4)
    v_exp_f32 v59, v59
    v_mfma_f32_16x16x32_bf16 a[72:75], a[212:215], v[40:43], a[72:75]
    v_cvt_pk_bf16_f32 v26, v68, v69
    v_mfma_f32_16x16x32_bf16 a[76:79], a[216:219], v[40:43], a[76:79]
    v_exp_f32 v87, v87
    v_mfma_f32_16x16x32_bf16 a[28:31], a[216:219], v[34:37], a[28:31]
    ds_read_b64_tr_b16 a[228:229], v4 offset:20480
    v_fma_f32 v78, v78, s28, v12
    v_mfma_f32_16x16x32_bf16 a[24:27], a[212:215], v[34:37], a[24:27]
    ds_read_b64_tr_b16 a[230:231], v4 offset:14336
    v_mfma_f32_16x16x32_bf16 v[232:235], a[212:215], v[28:31], v[232:235]
    ds_read_b64_tr_b16 a[234:235], v5 offset:14336
    v_mfma_f32_16x16x32_bf16 v[236:239], a[216:219], v[28:31], v[236:239]
    ds_read_b64_tr_b16 a[232:233], v5 offset:20480
    v_fma_f32 v67, v67, s28, v10
    v_mfma_f32_16x16x32_bf16 v[188:191], a[216:219], v[22:25], v[188:191]
    v_exp_f32 v77, v77
    v_mfma_f32_16x16x32_bf16 v[184:187], a[212:215], v[22:25], v[184:187]
    v_exp_f32 v79, v79
    v_mfma_f32_16x16x32_bf16 v[136:139], a[212:215], v[16:19], v[136:139]
    v_mfma_f32_16x16x32_bf16 v[140:143], a[216:219], v[16:19], v[140:143]
    s_waitcnt lgkmcnt(4)
    v_exp_f32 v57, v57
    v_mfma_f32_16x16x32_bf16 v[144:147], a[220:223], v[16:19], v[144:147]
    v_mfma_f32_16x16x32_bf16 v[148:151], a[224:227], v[16:19], v[148:151]
    v_exp_f32 v76, v76
    v_mfma_f32_16x16x32_bf16 v[196:199], a[224:227], v[22:25], v[196:199]
    v_exp_f32 v56, v56
    v_mfma_f32_16x16x32_bf16 v[192:195], a[220:223], v[22:25], v[192:195]
    v_exp_f32 v83, v83
    v_mfma_f32_16x16x32_bf16 v[240:243], a[220:223], v[28:31], v[240:243]
    v_exp_f32 v70, v70
    v_mfma_f32_16x16x32_bf16 v[244:247], a[224:227], v[28:31], v[244:247]
    v_fma_f32 v72, v72, s28, v11
    v_fma_f32 v91, v91, s28, v13
    v_mfma_f32_16x16x32_bf16 a[36:39], a[224:227], v[34:37], a[36:39]
    v_exp_f32 v84, v84
    v_mfma_f32_16x16x32_bf16 a[32:35], a[220:223], v[34:37], a[32:35]
    v_exp_f32 v67, v67
    v_mfma_f32_16x16x32_bf16 a[80:83], a[220:223], v[40:43], a[80:83]
    s_waitcnt vmcnt(10) lgkmcnt(0)
    v_exp_f32 v85, v85
    v_mfma_f32_16x16x32_bf16 a[84:87], a[224:227], v[40:43], a[84:87]
    s_barrier
    ds_read_b128 a[216:219], v1 offset:12288
    v_mfma_f32_16x16x32_bf16 a[88:91], a[228:231], v[40:43], a[88:91]
    ds_read_b128 a[212:215], v0 offset:12288
    v_mfma_f32_16x16x32_bf16 a[92:95], a[232:235], v[40:43], a[92:95]
    ds_read_b128 a[220:223], v0 offset:13312
    s_add_u32 m0, s22, 36864
    v_mfma_f32_16x16x32_bf16 a[44:47], a[232:235], v[34:37], a[44:47]
    buffer_load_dwordx4 v6, s[8:11], s21 offen lds
    v_mfma_f32_16x16x32_bf16 a[40:43], a[228:231], v[34:37], a[40:43]
    v_exp_f32 v71, v71
    v_mfma_f32_16x16x32_bf16 v[248:251], a[228:231], v[28:31], v[248:251]
    s_add_u32 s21, s21, 128
    v_mfma_f32_16x16x32_bf16 v[252:255], a[232:235], v[28:31], v[252:255]
    v_cvt_pk_bf16_f32 v27, v70, v71
    v_mfma_f32_16x16x32_bf16 v[204:207], a[232:235], v[22:25], v[204:207]
    s_add_u32 m0, s22, 37888
    v_exp_f32 v86, v86
    v_mfma_f32_16x16x32_bf16 v[200:203], a[228:231], v[22:25], v[200:203]
    buffer_load_dwordx4 v6, s[8:11], s21 offen lds
    v_mfma_f32_16x16x32_bf16 v[152:155], a[228:231], v[16:19], v[152:155]
    s_add_u32 s21, s21, 128
    ds_read_b128 a[224:227], v1 offset:13312
    v_cvt_pk_bf16_f32 v32, v76, v77
    v_mfma_f32_16x16x32_bf16 v[156:159], a[232:235], v[16:19], v[156:159]
    s_add_u32 m0, s22, 38912
    v_fma_f32 v73, v73, s28, v11
    s_waitcnt lgkmcnt(2)
    v_mfma_f32_16x16x32_bf16 v[52:55], a[212:215], a[96:99], 0
    buffer_load_dwordx4 v6, s[8:11], s21 offen lds
    v_mfma_f32_16x16x32_bf16 v[52:55], a[216:219], a[100:103], v[52:55]
    s_waitcnt lgkmcnt(1)
    v_exp_f32 v66, v66
    v_mfma_f32_16x16x32_bf16 v[52:55], a[220:223], a[104:107], v[52:55]
    v_exp_f32 v81, v81
    v_mfma_f32_16x16x32_bf16 v[60:63], a[220:223], a[128:131], 0
    ds_read_b128 a[232:235], v1 offset:14336
    v_fma_f32 v75, v75, s28, v11
    v_mfma_f32_16x16x32_bf16 v[60:63], a[216:219], a[124:127], v[60:63]
    v_exp_f32 v82, v82
    v_mfma_f32_16x16x32_bf16 v[60:63], a[212:215], a[120:123], v[60:63]
    v_exp_f32 v78, v78
    v_mfma_f32_16x16x32_bf16 v[68:71], a[212:215], a[144:147], 0
    ds_read_b128 a[228:231], v0 offset:14336
    v_cvt_pk_bf16_f32 v38, v84, v85
    v_mfma_f32_16x16x32_bf16 v[68:71], a[216:219], a[148:151], v[68:71]
    v_fma_f32 v74, v74, s28, v11
    v_cvt_pk_bf16_f32 v33, v78, v79
    v_mfma_f32_16x16x32_bf16 v[68:71], a[220:223], a[152:155], v[68:71]
    v_exp_f32 v74, v74
    v_mfma_f32_16x16x32_bf16 v[76:79], a[220:223], a[176:179], 0
    v_cvt_pk_bf16_f32 v17, v58, v59
    v_mfma_f32_16x16x32_bf16 v[76:79], a[216:219], a[172:175], v[76:79]
    v_exp_f32 v75, v75
    v_mfma_f32_16x16x32_bf16 v[76:79], a[212:215], a[168:171], v[76:79]
    v_cvt_pk_bf16_f32 v39, v86, v87
    v_cvt_pk_bf16_f32 v16, v56, v57
    v_mfma_f32_16x16x32_bf16 v[84:87], a[212:215], a[192:195], 0
    v_exp_f32 v72, v72
    v_mfma_f32_16x16x32_bf16 v[84:87], a[216:219], a[196:199], v[84:87]
    v_cvt_pk_bf16_f32 v23, v66, v67
    v_mfma_f32_16x16x32_bf16 v[84:87], a[220:223], a[200:203], v[84:87]
    s_waitcnt lgkmcnt(1)
    v_mfma_f32_16x16x32_bf16 v[84:87], a[224:227], a[204:207], v[84:87]
    v_exp_f32 v91, v91
    v_mfma_f32_16x16x32_bf16 v[44:47], a[236:239], v[14:17], v[48:51]
    s_waitcnt lgkmcnt(0)
    v_exp_f32 v73, v73
    v_mfma_f32_16x16x32_bf16 v[84:87], a[228:231], a[208:211], v[84:87]
    v_exp_f32 v88, v88
    v_mfma_f32_16x16x32_bf16 v[84:87], a[232:235], v[92:95], v[84:87]
    v_mfma_f32_16x16x32_bf16 v[76:79], a[232:235], a[188:191], v[76:79]
    v_cvt_pk_bf16_f32 v28, v72, v73
    v_mfma_f32_16x16x32_bf16 v[76:79], a[228:231], a[184:187], v[76:79]
    v_exp_f32 v64, v64
    v_mfma_f32_16x16x32_bf16 v[76:79], a[224:227], a[180:183], v[76:79]
    ds_read_b128 a[212:215], v0 offset:18432
    v_cvt_pk_bf16_f32 v35, v82, v83
    v_mfma_f32_16x16x32_bf16 v[68:71], a[224:227], a[156:159], v[68:71]
    v_cvt_pk_bf16_f32 v40, v88, v89
    v_cvt_pk_bf16_f32 v22, v64, v65
    v_mfma_f32_16x16x32_bf16 v[68:71], a[228:231], a[160:163], v[68:71]
    v_mfma_f32_16x16x32_bf16 v[68:71], a[232:235], a[164:167], v[68:71]
    v_cvt_pk_bf16_f32 v41, v90, v91
    v_mfma_f32_16x16x32_bf16 v[60:63], a[232:235], a[140:143], v[60:63]
    ds_read_b128 a[216:219], v1 offset:18432
    v_mfma_f32_16x16x32_bf16 v[60:63], a[228:231], a[136:139], v[60:63]
    ds_read_b128 a[220:223], v0 offset:19456
    v_mfma_f32_16x16x32_bf16 v[60:63], a[224:227], a[132:135], v[60:63]
    v_mfma_f32_16x16x32_bf16 v[52:55], a[224:227], a[108:111], v[52:55]
    v_cvt_pk_bf16_f32 v29, v74, v75
    v_cvt_pk_bf16_f32 v34, v80, v81
    v_mfma_f32_16x16x32_bf16 v[52:55], a[228:231], a[112:115], v[52:55]
    ds_read_b128 a[224:227], v1 offset:19456
    v_mfma_f32_16x16x32_bf16 v[44:47], a[240:243], v[20:23], v[44:47]
    v_mfma_f32_16x16x32_bf16 v[52:55], a[232:235], a[116:119], v[52:55]
    ds_read_b128 a[232:235], v1 offset:20480
    v_mfma_f32_16x16x32_bf16 v[44:47], a[244:247], v[26:29], v[44:47]
    ds_read_b128 a[228:231], v0 offset:20480
    v_mfma_f32_16x16x32_bf16 v[44:47], a[248:251], v[32:35], v[44:47]
    v_mfma_f32_16x16x32_bf16 v[44:47], a[252:255], v[38:41], v[44:47]
    s_waitcnt lgkmcnt(5)
    v_mfma_f32_16x16x32_bf16 v[56:59], a[212:215], a[96:99], 0
    s_waitcnt lgkmcnt(4)
    v_mfma_f32_16x16x32_bf16 v[56:59], a[216:219], a[100:103], v[56:59]
    s_waitcnt lgkmcnt(3)
    v_mfma_f32_16x16x32_bf16 v[56:59], a[220:223], a[104:107], v[56:59]
    s_nop 1
    v_cmp_lt_f32 vcc, s29, v44
    v_mfma_f32_16x16x32_bf16 v[64:67], a[220:223], a[128:131], 0
    s_add_u32 s21, s21, 12032
    v_mfma_f32_16x16x32_bf16 v[64:67], a[216:219], a[124:127], v[64:67]
    v_mfma_f32_16x16x32_bf16 v[64:67], a[212:215], a[120:123], v[64:67]
    s_nop 0
    s_cbranch_vccnz L_rs_tr54a
L_ret_tr54a:
    v_mfma_f32_16x16x32_bf16 v[72:75], a[212:215], a[144:147], 0
    v_fma_f32 v62, v62, s28, v10
    v_fma_f32 v60, v60, s28, v10
    v_mfma_f32_16x16x32_bf16 v[72:75], a[216:219], a[148:151], v[72:75]
    v_fma_f32 v61, v61, s28, v10
    v_fma_f32 v63, v63, s28, v10
    v_mfma_f32_16x16x32_bf16 v[72:75], a[220:223], a[152:155], v[72:75]
    s_waitcnt vmcnt(6) lgkmcnt(0)
    v_fma_f32 v54, v54, s28, v9
    v_mfma_f32_16x16x32_bf16 v[80:83], a[220:223], a[176:179], 0
    s_barrier
    v_mfma_f32_16x16x32_bf16 v[80:83], a[216:219], a[172:175], v[80:83]
    v_exp_f32 v63, v63
    v_mfma_f32_16x16x32_bf16 v[80:83], a[212:215], a[168:171], v[80:83]
    v_exp_f32 v62, v62
    v_mfma_f32_16x16x32_bf16 v[88:91], a[212:215], a[192:195], 0
    s_add_u32 m0, s22, 12288
    ds_read_b64_tr_b16 a[212:213], v2 offset:0
    v_fma_f32 v53, v53, s28, v9
    v_mfma_f32_16x16x32_bf16 v[88:91], a[216:219], a[196:199], v[88:91]
    buffer_load_dwordx4 v6, s[4:7], s20 offen lds
    v_mfma_f32_16x16x32_bf16 v[88:91], a[220:223], a[200:203], v[88:91]
    s_add_u32 s20, s20, 128
    ds_read_b64_tr_b16 a[214:215], v2 offset:6144
    v_mfma_f32_16x16x32_bf16 v[88:91], a[224:227], a[204:207], v[88:91]
    s_add_u32 m0, s22, 13312
    v_exp_f32 v60, v60
    v_mfma_f32_16x16x32_bf16 v[88:91], a[228:231], a[208:211], v[88:91]
    buffer_load_dwordx4 v6, s[4:7], s20 offen lds
    v_mfma_f32_16x16x32_bf16 v[88:91], a[232:235], v[92:95], v[88:91]
    ds_read_b64_tr_b16 a[216:217], v3 offset:0
    v_fma_f32 v55, v55, s28, v9
    v_mfma_f32_16x16x32_bf16 v[80:83], a[232:235], a[188:191], v[80:83]
    s_add_u32 s20, s20, 128
    ds_read_b64_tr_b16 a[218:219], v3 offset:6144
    v_fma_f32 v52, v52, s28, v9
    v_mfma_f32_16x16x32_bf16 v[80:83], a[228:231], a[184:187], v[80:83]
    s_add_u32 m0, s22, 14336
    v_exp_f32 v61, v61
    v_mfma_f32_16x16x32_bf16 v[80:83], a[224:227], a[180:183], v[80:83]
    buffer_load_dwordx4 v6, s[4:7], s20 offen lds
    v_mfma_f32_16x16x32_bf16 v[72:75], a[224:227], a[156:159], v[72:75]
    v_exp_f32 v55, v55
    v_mfma_f32_16x16x32_bf16 v[72:75], a[228:231], a[160:163], v[72:75]
    s_add_u32 s20, s20, 12032
    v_exp_f32 v54, v54
    v_mfma_f32_16x16x32_bf16 v[72:75], a[232:235], a[164:167], v[72:75]
    v_exp_f32 v53, v53
    v_mfma_f32_16x16x32_bf16 v[64:67], a[232:235], a[140:143], v[64:67]
    v_exp_f32 v52, v52
    v_mfma_f32_16x16x32_bf16 v[64:67], a[228:231], a[136:139], v[64:67]
    ds_read_b64_tr_b16 a[220:221], v4 offset:0
    v_cvt_pk_bf16_f32 v18, v52, v53
    v_mfma_f32_16x16x32_bf16 v[64:67], a[224:227], a[132:135], v[64:67]
    v_cvt_pk_bf16_f32 v19, v54, v55
    v_cvt_pk_bf16_f32 v24, v60, v61
    v_mfma_f32_16x16x32_bf16 v[56:59], a[224:227], a[108:111], v[56:59]
    ds_read_b64_tr_b16 a[222:223], v4 offset:6144
    v_mfma_f32_16x16x32_bf16 v[56:59], a[228:231], a[112:115], v[56:59]
    ds_read_b64_tr_b16 a[224:225], v5 offset:0
    v_cvt_pk_bf16_f32 v25, v62, v63
    v_mfma_f32_16x16x32_bf16 v[56:59], a[232:235], a[116:119], v[56:59]
    ds_read_b64_tr_b16 a[226:227], v5 offset:6144
    s_waitcnt lgkmcnt(4)
    v_mfma_f32_16x16x32_bf16 v[112:115], a[212:215], v[14:17], v[112:115]
    v_fma_f32 v65, v65, s28, v10
    v_fma_f32 v69, v69, s28, v11
    v_mfma_f32_16x16x32_bf16 v[116:119], a[216:219], v[14:17], v[116:119]
    ds_read_b64_tr_b16 a[230:231], v2 offset:7168
    v_fma_f32 v68, v68, s28, v11
    v_mfma_f32_16x16x32_bf16 v[164:167], a[216:219], v[20:23], v[164:167]
    ds_read_b64_tr_b16 a[234:235], v3 offset:7168
    v_fma_f32 v70, v70, s28, v11
    v_mfma_f32_16x16x32_bf16 v[160:163], a[212:215], v[20:23], v[160:163]
    v_lshrrev_b32 v105, 11, v0
    v_xor_b32 v105, s65, v105
    v_mfma_f32_16x16x32_bf16 v[208:211], a[212:215], v[26:29], v[208:211]
    v_exp_f32 v69, v69
    v_mfma_f32_16x16x32_bf16 v[212:215], a[216:219], v[26:29], v[212:215]
    v_fma_f32 v86, v86, s28, v13
    v_and_b32 v104, 0x3ff, v0
    v_mfma_f32_16x16x32_bf16 a[4:7], a[216:219], v[32:35], a[4:7]
    v_lshl_add_u32 v104, v105, 10, v104
    v_fma_f32 v88, v88, s28, v13
    v_fma_f32 v56, v56, s28, v9
    v_mfma_f32_16x16x32_bf16 a[0:3], a[212:215], v[32:35], a[0:3]
    ds_read_b64_tr_b16 a[232:233], v3 offset:1024
    v_add_u32 v104, s38, v104
    v_mfma_f32_16x16x32_bf16 a[48:51], a[212:215], v[38:41], a[48:51]
    ds_read_b64_tr_b16 a[228:229], v2 offset:1024
    v_fma_f32 v73, v73, s28, v11
    v_mfma_f32_16x16x32_bf16 a[52:55], a[216:219], v[38:41], a[52:55]
    s_waitcnt lgkmcnt(4)
    ds_read_b64_tr_b16 a[212:213], v4 offset:1024
    v_fma_f32 v75, v75, s28, v11
    v_mfma_f32_16x16x32_bf16 a[56:59], a[220:223], v[38:41], a[56:59]
    ds_read_b64_tr_b16 a[218:219], v5 offset:7168
    v_fma_f32 v79, v79, s28, v12
    v_mfma_f32_16x16x32_bf16 a[60:63], a[224:227], v[38:41], a[60:63]
    ds_read_b64_tr_b16 a[216:217], v5 offset:1024
    v_fma_f32 v81, v81, s28, v12
    v_mfma_f32_16x16x32_bf16 a[12:15], a[224:227], v[32:35], a[12:15]
    ds_read_b64_tr_b16 a[214:215], v4 offset:7168
    v_fma_f32 v72, v72, s28, v11
    v_mfma_f32_16x16x32_bf16 a[8:11], a[220:223], v[32:35], a[8:11]
    ds_read_b128 a[96:99], v104 offset:0
    v_fma_f32 v71, v71, s28, v11
    v_mfma_f32_16x16x32_bf16 v[216:219], a[220:223], v[26:29], v[216:219]
    ds_read_b128 a[128:131], v104 offset:8192
    v_fma_f32 v59, v59, s28, v9
    v_mfma_f32_16x16x32_bf16 v[220:223], a[224:227], v[26:29], v[220:223]
    s_add_u32 s39, s39, 12288
    v_xor_b32 v105, 64, v104
    v_fma_f32 v85, v85, s28, v13
    v_mfma_f32_16x16x32_bf16 v[172:175], a[224:227], v[20:23], v[172:175]
    ds_read_b128 a[148:151], v105 offset:12288
    v_fma_f32 v76, v76, s28, v12
    v_mfma_f32_16x16x32_bf16 v[168:171], a[220:223], v[20:23], v[168:171]
    v_exp_f32 v71, v71
    v_mfma_f32_16x16x32_bf16 v[120:123], a[220:223], v[14:17], v[120:123]
    ds_read_b128 a[160:163], v104 offset:16384
    v_exp_f32 v86, v86
    v_mfma_f32_16x16x32_bf16 v[124:127], a[224:227], v[14:17], v[124:127]
    s_waitcnt lgkmcnt(7)
    v_exp_f32 v65, v65
    v_mfma_f32_16x16x32_bf16 v[128:131], a[228:231], v[14:17], v[128:131]
    ds_read_b128 a[176:179], v104 offset:20480
    v_fma_f32 v77, v77, s28, v12
    v_mfma_f32_16x16x32_bf16 v[132:135], a[232:235], v[14:17], v[132:135]
    ds_read_b64_tr_b16 a[224:225], v3 offset:2048
    v_fma_f32 v64, v64, s28, v10
    v_mfma_f32_16x16x32_bf16 v[180:183], a[232:235], v[20:23], v[180:183]
    ds_read_b128 a[132:135], v105 offset:8192
    v_fma_f32 v84, v84, s28, v13
    v_mfma_f32_16x16x32_bf16 v[176:179], a[228:231], v[20:23], v[176:179]
    ds_read_b64_tr_b16 a[222:223], v2 offset:8192
    v_fma_f32 v67, v67, s28, v10
    v_mfma_f32_16x16x32_bf16 v[224:227], a[228:231], v[26:29], v[224:227]
    v_exp_f32 v77, v77
    v_mfma_f32_16x16x32_bf16 v[228:231], a[232:235], v[26:29], v[228:231]
    ds_read_b128 a[112:115], v104 offset:4096
    v_exp_f32 v64, v64
    v_mfma_f32_16x16x32_bf16 a[20:23], a[232:235], v[32:35], a[20:23]
    v_exp_f32 v67, v67
    v_mfma_f32_16x16x32_bf16 a[16:19], a[228:231], v[32:35], a[16:19]
    ds_read_b64_tr_b16 a[226:227], v3 offset:8192
    v_fma_f32 v78, v78, s28, v12
    v_mfma_f32_16x16x32_bf16 a[64:67], a[228:231], v[38:41], a[64:67]
    v_exp_f32 v76, v76
    v_mfma_f32_16x16x32_bf16 a[68:71], a[232:235], v[38:41], a[68:71]
    s_waitcnt lgkmcnt(6)
    ds_read_b64_tr_b16 a[220:221], v2 offset:2048
    v_fma_f32 v66, v66, s28, v10
    v_mfma_f32_16x16x32_bf16 a[72:75], a[212:215], v[38:41], a[72:75]
    ds_read_b64_tr_b16 a[230:231], v4 offset:8192
    v_fma_f32 v83, v83, s28, v12
    v_mfma_f32_16x16x32_bf16 a[76:79], a[216:219], v[38:41], a[76:79]
    ds_read_b128 a[140:143], v105 offset:10240
    v_fma_f32 v82, v82, s28, v12
    v_mfma_f32_16x16x32_bf16 a[28:31], a[216:219], v[32:35], a[28:31]
    ds_read_b64_tr_b16 a[232:233], v5 offset:2048
    v_fma_f32 v74, v74, s28, v11
    v_mfma_f32_16x16x32_bf16 a[24:27], a[212:215], v[32:35], a[24:27]
    ds_read_b128 a[100:103], v105 offset:0
    v_fma_f32 v58, v58, s28, v9
    v_mfma_f32_16x16x32_bf16 v[232:235], a[212:215], v[26:29], v[232:235]
    v_exp_f32 v78, v78
    v_mfma_f32_16x16x32_bf16 v[236:239], a[216:219], v[26:29], v[236:239]
    ds_read_b64_tr_b16 a[228:229], v4 offset:2048
    v_cvt_pk_bf16_f32 v36, v76, v77
    v_mfma_f32_16x16x32_bf16 v[188:191], a[216:219], v[20:23], v[188:191]
    ds_read_b64_tr_b16 a[234:235], v5 offset:8192
    v_fma_f32 v80, v80, s28, v12
    v_mfma_f32_16x16x32_bf16 v[184:187], a[212:215], v[20:23], v[184:187]
    v_exp_f32 v68, v68
    v_mfma_f32_16x16x32_bf16 v[136:139], a[212:215], v[14:17], v[136:139]
    ds_read_b128 a[152:155], v104 offset:14336
    v_exp_f32 v83, v83
    v_mfma_f32_16x16x32_bf16 v[140:143], a[216:219], v[14:17], v[140:143]
    s_waitcnt lgkmcnt(7)
    v_exp_f32 v59, v59
    v_mfma_f32_16x16x32_bf16 v[144:147], a[220:223], v[14:17], v[144:147]
    ds_read_b128 a[124:127], v105 offset:6144
    v_fma_f32 v87, v87, s28, v13
    v_mfma_f32_16x16x32_bf16 v[148:151], a[224:227], v[14:17], v[148:151]
    ds_read_b128 a[104:107], v104 offset:2048
    v_fma_f32 v57, v57, s28, v9
    v_mfma_f32_16x16x32_bf16 v[196:199], a[224:227], v[20:23], v[196:199]
    v_exp_f32 v81, v81
    v_mfma_f32_16x16x32_bf16 v[192:195], a[220:223], v[20:23], v[192:195]
    ds_read_b128 a[120:123], v104 offset:6144
    v_mfma_f32_16x16x32_bf16 v[240:243], a[220:223], v[26:29], v[240:243]
    v_exp_f32 v58, v58
    v_mfma_f32_16x16x32_bf16 v[244:247], a[224:227], v[26:29], v[244:247]
    v_exp_f32 v74, v74
    v_mfma_f32_16x16x32_bf16 a[36:39], a[224:227], v[32:35], a[36:39]
    s_waitcnt vmcnt(6) lgkmcnt(4)
    ds_read_b128 a[188:191], v105 offset:22528
    v_fma_f32 v91, v91, s28, v13
    v_mfma_f32_16x16x32_bf16 a[32:35], a[220:223], v[32:35], a[32:35]
    s_add_u32 s21, s21, s62
    ds_read_b128 a[180:183], v105 offset:20480
    v_exp_f32 v70, v70
    v_mfma_f32_16x16x32_bf16 a[80:83], a[220:223], v[38:41], a[80:83]
    s_add_u32 m0, s22, 24576
    ds_read_b128 a[144:147], v104 offset:12288
    v_cvt_pk_bf16_f32 v30, v68, v69
    v_mfma_f32_16x16x32_bf16 a[84:87], a[224:227], v[38:41], a[84:87]
    s_barrier
    ds_read_b128 a[212:215], v0 offset:0
    v_mfma_f32_16x16x32_bf16 a[88:91], a[228:231], v[38:41], a[88:91]
    buffer_load_dwordx4 v6, s[8:11], s21 offen lds
    v_mfma_f32_16x16x32_bf16 a[92:95], a[232:235], v[38:41], a[92:95]
    ds_read_b128 a[216:219], v1 offset:0
    v_mfma_f32_16x16x32_bf16 a[44:47], a[232:235], v[32:35], a[44:47]
    s_add_u32 s21, s21, 128
    ds_read_b128 a[220:223], v0 offset:1024
    s_add_u32 m0, s22, 25600
    v_mfma_f32_16x16x32_bf16 a[40:43], a[228:231], v[32:35], a[40:43]
    ds_read_b128 a[168:171], v104 offset:18432
    v_exp_f32 v56, v56
    v_mfma_f32_16x16x32_bf16 v[248:251], a[228:231], v[26:29], v[248:251]
    buffer_load_dwordx4 v6, s[8:11], s21 offen lds
    v_cvt_pk_bf16_f32 v31, v70, v71
    v_mfma_f32_16x16x32_bf16 v[252:255], a[232:235], v[26:29], v[252:255]
    s_add_u32 s21, s21, 128
    v_exp_f32 v80, v80
    v_mfma_f32_16x16x32_bf16 v[204:207], a[232:235], v[20:23], v[204:207]
    s_add_u32 m0, s22, 26624
    ds_read_b128 a[172:175], v105 offset:18432
    v_cvt_pk_bf16_f32 v34, v80, v81
    v_mfma_f32_16x16x32_bf16 v[200:203], a[228:231], v[20:23], v[200:203]
    buffer_load_dwordx4 v6, s[8:11], s21 offen lds
    ds_read_b128 a[184:187], v104 offset:22528
    v_mfma_f32_16x16x32_bf16 v[152:155], a[228:231], v[14:17], v[152:155]
    v_exp_f32 v79, v79
    v_mfma_f32_16x16x32_bf16 v[156:159], a[232:235], v[14:17], v[156:159]
    s_waitcnt lgkmcnt(5)
    v_exp_f32 v66, v66
    v_mfma_f32_16x16x32_bf16 v[52:55], a[212:215], a[96:99], 0
    s_waitcnt lgkmcnt(4)
    v_exp_f32 v57, v57
    v_mfma_f32_16x16x32_bf16 v[52:55], a[216:219], a[100:103], v[52:55]
    s_waitcnt lgkmcnt(3)
    ds_read_b128 a[156:159], v105 offset:14336
    v_cvt_pk_bf16_f32 v16, v56, v57
    v_mfma_f32_16x16x32_bf16 v[52:55], a[220:223], a[104:107], v[52:55]
    ds_read_b128 a[224:227], v1 offset:1024
    v_cvt_pk_bf16_f32 v17, v58, v59
    v_mfma_f32_16x16x32_bf16 v[60:63], a[220:223], a[128:131], 0
    ds_read_b128 a[228:231], v0 offset:2048
    v_fma_f32 v89, v89, s28, v13
    v_mfma_f32_16x16x32_bf16 v[60:63], a[216:219], a[124:127], v[60:63]
    ds_read_b128 a[232:235], v1 offset:2048
    v_cvt_pk_bf16_f32 v22, v64, v65
    v_mfma_f32_16x16x32_bf16 v[60:63], a[212:215], a[120:123], v[60:63]
    ds_read_b128 a[164:167], v105 offset:16384
    v_cvt_pk_bf16_f32 v37, v78, v79
    v_mfma_f32_16x16x32_bf16 v[68:71], a[212:215], a[144:147], 0
    ds_read_b128 a[108:111], v105 offset:2048
    v_mfma_f32_16x16x32_bf16 v[68:71], a[216:219], a[148:151], v[68:71]
    v_exp_f32 v91, v91
    v_mfma_f32_16x16x32_bf16 v[68:71], a[220:223], a[152:155], v[68:71]
    ds_read_b128 a[136:139], v104 offset:10240
    v_mfma_f32_16x16x32_bf16 v[76:79], a[220:223], a[176:179], 0
    s_waitcnt lgkmcnt(7)
    ds_read_b128 a[116:119], v105 offset:4096
    v_fma_f32 v90, v90, s28, v13
    v_mfma_f32_16x16x32_bf16 v[76:79], a[216:219], a[172:175], v[76:79]
    v_exp_f32 v73, v73
    v_mfma_f32_16x16x32_bf16 v[48:51], a[236:239], v[16:19], v[44:47]
    ds_read_b128 a[216:219], v1 offset:6144
    v_cvt_pk_bf16_f32 v23, v66, v67
    v_mfma_f32_16x16x32_bf16 v[76:79], a[212:215], a[168:171], v[76:79]
    s_waitcnt lgkmcnt(7)
    v_exp_f32 v84, v84
    v_mfma_f32_16x16x32_bf16 v[76:79], a[224:227], a[180:183], v[76:79]
    s_waitcnt lgkmcnt(6)
    v_exp_f32 v82, v82
    v_mfma_f32_16x16x32_bf16 v[76:79], a[228:231], a[184:187], v[76:79]
    s_waitcnt lgkmcnt(5)
    v_exp_f32 v72, v72
    v_mfma_f32_16x16x32_bf16 v[76:79], a[232:235], a[188:191], v[76:79]
    s_waitcnt lgkmcnt(4)
    v_exp_f32 v75, v75
    v_mfma_f32_16x16x32_bf16 v[68:71], a[232:235], a[164:167], v[68:71]
    ds_read_b128 a[212:215], v0 offset:6144
    v_cvt_pk_bf16_f32 v29, v74, v75
    v_mfma_f32_16x16x32_bf16 v[68:71], a[228:231], a[160:163], v[68:71]
    v_exp_f32 v89, v89
    v_mfma_f32_16x16x32_bf16 v[68:71], a[224:227], a[156:159], v[68:71]
    v_exp_f32 v90, v90
    v_mfma_f32_16x16x32_bf16 v[60:63], a[224:227], a[132:135], v[60:63]
    s_waitcnt lgkmcnt(2)
    v_exp_f32 v88, v88
    v_mfma_f32_16x16x32_bf16 v[60:63], a[228:231], a[136:139], v[60:63]
    v_exp_f32 v87, v87
    v_mfma_f32_16x16x32_bf16 v[60:63], a[232:235], a[140:143], v[60:63]
    ds_read_b128 a[220:223], v0 offset:7168
    v_cvt_pk_bf16_f32 v41, v90, v91
    v_mfma_f32_16x16x32_bf16 v[52:55], a[232:235], a[116:119], v[52:55]
    v_exp_f32 v85, v85
    v_mfma_f32_16x16x32_bf16 v[52:55], a[228:231], a[112:115], v[52:55]
    ds_read_b128 a[232:235], v1 offset:8192
    v_cvt_pk_bf16_f32 v35, v82, v83
    v_mfma_f32_16x16x32_bf16 v[48:51], a[240:243], v[22:25], v[48:51]
    ds_read_b128 a[228:231], v0 offset:8192
    v_cvt_pk_bf16_f32 v28, v72, v73
    v_mfma_f32_16x16x32_bf16 v[52:55], a[224:227], a[108:111], v[52:55]
    ds_read_b128 a[224:227], v1 offset:7168
    v_cvt_pk_bf16_f32 v42, v84, v85
    v_mfma_f32_16x16x32_bf16 v[48:51], a[244:247], v[28:31], v[48:51]
    v_cvt_pk_bf16_f32 v40, v88, v89
    v_cvt_pk_bf16_f32 v43, v86, v87
    v_mfma_f32_16x16x32_bf16 v[48:51], a[248:251], v[34:37], v[48:51]
    s_nop 0
    v_mfma_f32_16x16x32_bf16 v[48:51], a[252:255], v[40:43], v[48:51]
    s_waitcnt lgkmcnt(4)
    v_mfma_f32_16x16x32_bf16 v[56:59], a[212:215], a[96:99], 0
    s_nop 5
    v_cmp_lt_f32 vcc, s29, v48
    v_mfma_f32_16x16x32_bf16 v[56:59], a[216:219], a[100:103], v[56:59]
    s_add_u32 s21, s21, 12032
    s_waitcnt lgkmcnt(3)
    v_mfma_f32_16x16x32_bf16 v[56:59], a[220:223], a[104:107], v[56:59]
    s_nop 0
    s_cbranch_vccnz L_rs_tr54b
L_ret_tr54b:
    v_mfma_f32_16x16x32_bf16 v[64:67], a[220:223], a[128:131], 0
    v_lshrrev_b32 v108, 11, v0
    v_and_b32 v101, 0x3ff, v0
    v_mfma_f32_16x16x32_bf16 v[64:67], a[216:219], a[124:127], v[64:67]
    v_mov_b32 v100, v48
    v_xor_b32 v108, s65, v108
    v_mfma_f32_16x16x32_bf16 v[64:67], a[212:215], a[120:123], v[64:67]
    s_waitcnt vmcnt(6) lgkmcnt(0)
    s_add_u32 m0, s22, 0
    v_lshl_add_u32 v101, v108, 10, v101
    v_mfma_f32_16x16x32_bf16 v[72:75], a[212:215], a[144:147], 0
    s_barrier
    v_mfma_f32_16x16x32_bf16 v[72:75], a[216:219], a[148:151], v[72:75]
    buffer_load_dwordx4 v6, s[4:7], s20 offen lds
    v_mfma_f32_16x16x32_bf16 v[72:75], a[220:223], a[152:155], v[72:75]
    s_add_u32 s20, s20, 128
    v_rcp_f32 v8, v51
    v_mfma_f32_16x16x32_bf16 v[80:83], a[220:223], a[176:179], 0
    s_add_u32 m0, s22, 1024
    v_mbcnt_lo_u32_b32 v108, -1, 0
    v_mbcnt_hi_u32_b32 v108, -1, v108
    v_mfma_f32_16x16x32_bf16 v[80:83], a[216:219], a[172:175], v[80:83]
    buffer_load_dwordx4 v6, s[4:7], s20 offen lds
    v_mfma_f32_16x16x32_bf16 v[80:83], a[212:215], a[168:171], v[80:83]
    s_add_u32 s20, s20, 128
    ds_read_b64_tr_b16 a[212:213], v2 offset:18432
    v_lshrrev_b32 v108, 1, v108
    v_mfma_f32_16x16x32_bf16 v[80:83], a[224:227], a[180:183], v[80:83]
    ds_read_b64_tr_b16 a[214:215], v2 offset:12288
    v_add_u32 v101, s38, v101
    v_mfma_f32_16x16x32_bf16 v[80:83], a[228:231], a[184:187], v[80:83]
    s_add_u32 m0, s22, 2048
    ds_read_b64_tr_b16 a[216:217], v3 offset:18432
    v_and_b32 v108, 24, v108
    v_mfma_f32_16x16x32_bf16 v[80:83], a[232:235], a[188:191], v[80:83]
    buffer_load_dwordx4 v6, s[4:7], s20 offen lds
    ds_read_b64_tr_b16 a[218:219], v3 offset:12288
    v_mfma_f32_16x16x32_bf16 v[72:75], a[232:235], a[164:167], v[72:75]
    v_permlane32_swap_b32 v48, v100
    v_mfma_f32_16x16x32_bf16 v[72:75], a[228:231], a[160:163], v[72:75]
    v_rcp_f32 v102, v49
    v_mfma_f32_16x16x32_bf16 v[72:75], a[224:227], a[156:159], v[72:75]
    ds_read_b64_tr_b16 a[220:221], v4 offset:18432
    v_bfe_u32 v108, s66, v108, 8
    v_mfma_f32_16x16x32_bf16 v[64:67], a[224:227], a[132:135], v[64:67]
    v_rcp_f32 v48, v48
    v_mfma_f32_16x16x32_bf16 v[64:67], a[228:231], a[136:139], v[64:67]
    s_add_u32 s20, s20, 12032
    v_xor_b32 v101, v101, v108
    v_mov_b32 v108, v100
    v_mfma_f32_16x16x32_bf16 v[64:67], a[232:235], a[140:143], v[64:67]
    ds_read_b64_tr_b16 a[222:223], v4 offset:12288
    v_permlane16_swap_b32 v100, v108
    v_mfma_f32_16x16x32_bf16 v[56:59], a[232:235], a[116:119], v[56:59]
    v_rcp_f32 v50, v50
    v_mfma_f32_16x16x32_bf16 v[56:59], a[228:231], a[112:115], v[56:59]
    v_rcp_f32 v100, v100
    v_mfma_f32_16x16x32_bf16 v[56:59], a[224:227], a[108:111], v[56:59]
    ds_read_b64_tr_b16 a[224:225], v5 offset:18432
    ds_read_b64_tr_b16 a[226:227], v5 offset:12288
    v_max3_f32 v96, v52, v53, v54
    v_max3_f32 v98, v60, v61, v62
    s_nop 3
    v_max3_f32 v96, v96, v55, v56
    s_waitcnt lgkmcnt(4)
    v_mfma_f32_16x16x32_bf16 v[112:115], a[212:215], v[16:19], v[112:115]
    ds_read_b64_tr_b16 a[234:235], v3 offset:13312
    v_max3_f32 v98, v98, v63, v64
    v_mfma_f32_16x16x32_bf16 v[116:119], a[216:219], v[16:19], v[116:119]
    v_max3_f32 v96, v96, v57, v58
    v_max_f32 v96, v96, v59
    v_mov_b32 v97, v96
    v_mfma_f32_16x16x32_bf16 v[164:167], a[216:219], v[22:25], v[164:167]
    s_nop 0
    v_permlane32_swap_b32 v97, v96
    v_max3_f32 v98, v98, v65, v66
    v_mfma_f32_16x16x32_bf16 v[160:163], a[212:215], v[22:25], v[160:163]
    ds_read_b64_tr_b16 a[232:233], v3 offset:19456
    v_max_f32 v96, v96, v97
    v_mfma_f32_16x16x32_bf16 v[208:211], a[212:215], v[28:31], v[208:211]
    s_mov_b32 s67, s34
    ds_read_b64_tr_b16 a[230:231], v2 offset:13312
    v_max_f32 v98, v98, v67
    v_mfma_f32_16x16x32_bf16 v[212:215], a[216:219], v[28:31], v[212:215]
    s_add_u32 s18, s34, 30720
    v_mov_b32 v97, v96
    v_mov_b32 v99, v98
    v_mfma_f32_16x16x32_bf16 a[4:7], a[216:219], v[34:37], a[4:7]
    s_mov_b32 s34, s33
    v_permlane16_swap_b32 v97, v96
    v_mfma_f32_16x16x32_bf16 a[0:3], a[212:215], v[34:37], a[0:3]
    v_max_f32 v96, v96, v97
    v_mul_f32_e64 v9, -s28, v96
    v_mfma_f32_16x16x32_bf16 a[48:51], a[212:215], v[40:43], a[48:51]
    v_permlane32_swap_b32 v99, v98
    v_mfma_f32_16x16x32_bf16 a[52:55], a[216:219], v[40:43], a[52:55]
    s_waitcnt lgkmcnt(3)
    ds_read_b64_tr_b16 a[228:229], v2 offset:19456
    v_fma_f32 v59, v59, s28, v9
    v_mfma_f32_16x16x32_bf16 a[56:59], a[220:223], v[40:43], a[56:59]
    s_add_u32 s64, s64, s62
    v_fma_f32 v54, v54, s28, v9
    v_max_f32 v98, v98, v99
    v_mov_b32 v99, v98
    v_mfma_f32_16x16x32_bf16 a[60:63], a[224:227], v[40:43], a[60:63]
    s_add_u32 s64, s64, 196608
    v_permlane16_swap_b32 v99, v98
    v_mfma_f32_16x16x32_bf16 a[12:15], a[224:227], v[34:37], a[12:15]
    s_mov_b32 s39, s64
    v_max_f32 v98, v98, v99
    v_mul_f32_e64 v10, -s28, v98
    v_mfma_f32_16x16x32_bf16 a[8:11], a[220:223], v[34:37], a[8:11]
    s_add_u32 s37, s37, 1
    ds_read_b64_tr_b16 a[212:213], v4 offset:19456
    v_max3_f32 v96, v68, v69, v70
    v_mfma_f32_16x16x32_bf16 v[216:219], a[220:223], v[28:31], v[216:219]
    s_bitcmp1_b32 s63, s37
    v_accvgpr_read_b32 v109, a49
    v_max3_f32 v98, v76, v77, v78
    v_mfma_f32_16x16x32_bf16 v[220:223], a[224:227], v[28:31], v[220:223]
    s_cselect_b32 s62, 4294770688, 0
    ds_read_b64_tr_b16 a[214:215], v4 offset:13312
    v_max3_f32 v96, v96, v71, v72
    v_max3_f32 v96, v96, v73, v74
    v_mfma_f32_16x16x32_bf16 v[172:175], a[224:227], v[22:25], v[172:175]
    s_cselect_b32 s42, 0, 325632
    v_max3_f32 v98, v98, v79, v80
    v_fma_f32 v55, v55, s28, v9
    v_mfma_f32_16x16x32_bf16 v[168:171], a[220:223], v[22:25], v[168:171]
    s_add_u32 s35, s35, s42
    ds_read_b64_tr_b16 a[218:219], v5 offset:13312
    v_max3_f32 v98, v98, v81, v82
    v_max_f32 v98, v98, v83
    v_mfma_f32_16x16x32_bf16 v[120:123], a[220:223], v[16:19], v[120:123]
    s_lshl_b32 s42, s37, 1
    ds_read_b64_tr_b16 a[220:221], v2 offset:20480
    v_fma_f32 v52, v52, s28, v9
    v_max_f32 v96, v96, v75
    v_mfma_f32_16x16x32_bf16 v[124:127], a[224:227], v[16:19], v[124:127]
    s_waitcnt lgkmcnt(4)
    ds_read_b64_tr_b16 a[216:217], v5 offset:19456
    v_mov_b32 v99, v98
    v_fma_f32 v60, v60, s28, v10
    v_mfma_f32_16x16x32_bf16 v[128:131], a[228:231], v[16:19], v[128:131]
    s_lshr_b32 s42, s31, s42
    v_mov_b32 v97, v96
    v_exp_f32 v60, v60
    v_mfma_f32_16x16x32_bf16 v[132:135], a[232:235], v[16:19], v[132:135]
    s_and_b32 s42, s42, 3
    v_fma_f32 v57, v57, s28, v9
    v_accvgpr_read_b32 v111, a51
    v_mfma_f32_16x16x32_bf16 v[180:183], a[232:235], v[22:25], v[180:183]
    s_add_u32 s42, s42, s36
    v_permlane32_swap_b32 v97, v96
    v_mfma_f32_16x16x32_bf16 v[176:179], a[228:231], v[22:25], v[176:179]
    s_sub_u32 s43, s42, 3
    v_permlane32_swap_b32 v99, v98
    v_mfma_f32_16x16x32_bf16 v[224:227], a[228:231], v[28:31], v[224:227]
    s_cmp_ge_u32 s42, 3
    ds_read_b64_tr_b16 a[224:225], v3 offset:20480
    v_fma_f32 v61, v61, s28, v10
    v_mfma_f32_16x16x32_bf16 v[228:231], a[232:235], v[28:31], v[228:231]
    s_cselect_b32 s42, s43, s42
    ds_read_b64_tr_b16 a[226:227], v3 offset:14336
    v_accvgpr_read_b32 v106, a2
    v_mfma_f32_16x16x32_bf16 a[20:23], a[232:235], v[34:37], a[20:23]
    s_mul_i32 s44, s3, 5
    v_max_f32 v96, v96, v97
    v_max_f32 v98, v98, v99
    v_mfma_f32_16x16x32_bf16 a[16:19], a[228:231], v[34:37], a[16:19]
    s_mov_b32 s32, 1
    ds_read_b64_tr_b16 a[222:223], v2 offset:14336
    v_fma_f32 v63, v63, s28, v10
    v_mfma_f32_16x16x32_bf16 a[64:67], a[228:231], v[40:43], a[64:67]
    s_lshl_b32 s43, s3, 2
    v_mov_b32 v99, v98
    v_mov_b32 v97, v96
    v_fma_f32 v53, v53, s28, v9
    v_mfma_f32_16x16x32_bf16 a[68:71], a[232:235], v[40:43], a[68:71]
    s_waitcnt lgkmcnt(3)
    v_permlane16_swap_b32 v97, v96
    v_mfma_f32_16x16x32_bf16 a[72:75], a[212:215], v[40:43], a[72:75]
    s_add_u32 s45, s43, 21
    ds_read_b64_tr_b16 a[230:231], v4 offset:14336
    v_max_f32 v96, v96, v97
    v_mfma_f32_16x16x32_bf16 a[76:79], a[216:219], v[40:43], a[76:79]
    s_cmp_eq_u32 s3, 0
    ds_read_b64_tr_b16 a[232:233], v5 offset:20480
    v_exp_f32 v63, v63
    v_mfma_f32_16x16x32_bf16 a[28:31], a[216:219], v[34:37], a[28:31]
    s_cselect_b32 s45, 20, s45
    v_mul_f32_e64 v11, -s28, v96
    v_permlane16_swap_b32 v99, v98
    v_mfma_f32_16x16x32_bf16 a[24:27], a[212:215], v[34:37], a[24:27]
    s_cselect_b32 s33, 1, 0
    v_exp_f32 v52, v52
    v_mfma_f32_16x16x32_bf16 v[232:235], a[212:215], v[28:31], v[232:235]
    s_cmp_eq_u32 s42, 1
    v_exp_f32 v61, v61
    v_mfma_f32_16x16x32_bf16 v[236:239], a[216:219], v[28:31], v[236:239]
    s_cselect_b32 s44, s45, s44
    v_fma_f32 v66, v66, s28, v10
    v_exp_f32 v54, v54
    v_mfma_f32_16x16x32_bf16 v[188:191], a[216:219], v[22:25], v[188:191]
    s_cselect_b32 s32, s33, s32
    ds_read_b64_tr_b16 a[234:235], v5 offset:14336
    v_fma_f32 v69, v69, s28, v11
    v_mfma_f32_16x16x32_bf16 v[184:187], a[212:215], v[22:25], v[184:187]
    s_add_u32 s45, s43, 37
    ds_read_b64_tr_b16 a[228:229], v4 offset:20480
    s_cmp_eq_u32 s42, 2
    v_mfma_f32_16x16x32_bf16 v[136:139], a[212:215], v[16:19], v[136:139]
    s_cselect_b32 s44, s45, s44
    v_exp_f32 v53, v53
    v_mfma_f32_16x16x32_bf16 v[140:143], a[216:219], v[16:19], v[140:143]
    s_cselect_b32 s32, 0, s32
    v_fma_f32 v62, v62, s28, v10
    s_waitcnt lgkmcnt(3)
    v_mfma_f32_16x16x32_bf16 v[144:147], a[220:223], v[16:19], v[144:147]
    s_mul_i32 s44, s44, 6144
    v_accvgpr_read_b32 v110, a50
    v_fma_f32 v67, v67, s28, v10
    v_mfma_f32_16x16x32_bf16 v[148:151], a[224:227], v[16:19], v[148:151]
    s_add_u32 s33, s35, s44
    v_exp_f32 v55, v55
    s_mul_i32 s42, s32, 6144
    v_mfma_f32_16x16x32_bf16 v[196:199], a[224:227], v[22:25], v[196:199]
    s_add_u32 s42, s42, 24576
    v_exp_f32 v66, v66
    v_mfma_f32_16x16x32_bf16 v[192:195], a[220:223], v[22:25], v[192:195]
    s_add_u32 s42, s42, s33
    v_exp_f32 v57, v57
    v_mfma_f32_16x16x32_bf16 v[240:243], a[220:223], v[28:31], v[240:243]
    s_cmp_ge_u32 s37, 6
    v_exp_f32 v59, v59
    v_mfma_f32_16x16x32_bf16 v[244:247], a[224:227], v[28:31], v[244:247]
    s_cselect_b32 s14, 0, s42
    v_max_f32 v98, v98, v99
    v_mul_f32_e64 v12, -s28, v98
    v_mfma_f32_16x16x32_bf16 a[36:39], a[224:227], v[34:37], a[36:39]
    s_add_u32 s24, s67, 6144
    v_fma_f32 v76, v76, s28, v12
    v_fma_f32 v70, v70, s28, v11
    v_mfma_f32_16x16x32_bf16 a[32:35], a[220:223], v[34:37], a[32:35]
    s_add_u32 s25, s33, 6144
    v_fma_f32 v79, v79, s28, v12
    v_fma_f32 v71, v71, s28, v11
    v_mfma_f32_16x16x32_bf16 a[80:83], a[220:223], v[40:43], a[80:83]
    s_add_u32 s23, s38, 6144
    v_exp_f32 v79, v79
    v_accvgpr_read_b32 v105, a1
    v_mfma_f32_16x16x32_bf16 a[84:87], a[224:227], v[40:43], a[84:87]
    s_waitcnt lgkmcnt(0)
    v_fma_f32 v68, v68, s28, v11
    s_mov_b32 s27, 0x30c30
    v_mfma_f32_16x16x32_bf16 a[88:91], a[228:231], v[40:43], a[88:91]
    s_mov_b32 s89, 0xaaaaaaaa
    v_fma_f32 v58, v58, s28, v9
    v_exp_f32 v69, v69
    v_mfma_f32_16x16x32_bf16 a[92:95], a[232:235], v[40:43], a[92:95]
    s_mov_b32 s30, 0
    v_exp_f32 v71, v71
    v_mfma_f32_16x16x32_bf16 a[44:47], a[232:235], v[34:37], a[44:47]
    s_waitcnt vmcnt(6)
    v_fma_f32 v78, v78, s28, v12
    v_fma_f32 v56, v56, s28, v9
    v_mfma_f32_16x16x32_bf16 a[40:43], a[228:231], v[34:37], a[40:43]
    s_barrier
    ds_read_b128 a[220:223], v0 offset:13312
    v_fma_f32 v64, v64, s28, v10
    v_mfma_f32_16x16x32_bf16 v[248:251], a[228:231], v[28:31], v[248:251]
    ds_read_b128 a[216:219], v1 offset:12288
    v_cvt_pk_bf16_f32 v15, v54, v55
    v_mfma_f32_16x16x32_bf16 v[252:255], a[232:235], v[28:31], v[252:255]
    v_exp_f32 v62, v62
    v_mfma_f32_16x16x32_bf16 v[204:207], a[232:235], v[22:25], v[204:207]
    ds_read_b128 a[212:215], v0 offset:12288
    v_cvt_pk_bf16_f32 v20, v60, v61
    v_exp_f32 v76, v76
    v_fma_f32 v75, v75, s28, v11
    v_mfma_f32_16x16x32_bf16 v[200:203], a[228:231], v[22:25], v[200:203]
    v_exp_f32 v78, v78
    v_fma_f32 v72, v72, s28, v11
    v_fma_f32 v73, v73, s28, v11
    v_fma_f32 v77, v77, s28, v12
    v_exp_f32 v70, v70
    v_pk_mul_f32 v[162:163], v[162:163], v[102:103] op_sel_hi:[1,0]
    v_pk_mul_f32 v[114:115], v[114:115], v[48:49] op_sel_hi:[1,0]
    v_fma_f32 v82, v82, s28, v12
    v_pk_mul_f32 v[208:209], v[208:209], v[50:51] op_sel_hi:[1,0]
    v_cvt_pk_bf16_f32 v27, v70, v71
    v_pk_mul_f32 v[164:165], v[164:165], v[102:103] op_sel_hi:[1,0]
    v_pk_mul_f32 v[166:167], v[166:167], v[102:103] op_sel_hi:[1,0]
    v_cvt_pk_bf16_f32 v14, v52, v53
    v_pk_mul_f32 v[112:113], v[112:113], v[48:49] op_sel_hi:[1,0]
    v_pk_mul_f32 v[180:181], v[180:181], v[102:103] op_sel_hi:[1,0]
    v_pk_mul_f32 v[210:211], v[210:211], v[50:51] op_sel_hi:[1,0]
    v_fma_f32 v83, v83, s28, v12
    v_pk_mul_f32 v[116:117], v[116:117], v[48:49] op_sel_hi:[1,0]
    v_cvt_pk_bf16_f32 v33, v78, v79
    v_fma_f32 v80, v80, s28, v12
    v_pk_mul_f32 v[220:221], v[220:221], v[50:51] op_sel_hi:[1,0]
    v_exp_f32 v77, v77
    v_cvt_pk_bf16_f32 v220, v220, v221
    v_mfma_f32_16x16x32_bf16 v[152:155], a[228:231], v[16:19], v[152:155]
    v_exp_f32 v82, v82
    v_mfma_f32_16x16x32_bf16 v[156:159], a[232:235], v[16:19], v[156:159]
    s_waitcnt lgkmcnt(0)
    ds_read_b128 a[224:227], v1 offset:13312
    v_subrev_u32 v103, 28672, v103
    v_mfma_f32_16x16x32_bf16 v[52:55], a[212:215], a[96:99], 0
    v_cvt_pk_bf16_f32 v32, v76, v77
    v_fma_f32 v65, v65, s28, v10
    v_mfma_f32_16x16x32_bf16 v[52:55], a[216:219], a[100:103], v[52:55]
    s_add_u32 m0, s22, 36864
    v_cvt_pk_bf16_f32 v21, v62, v63
    v_exp_f32 v68, v68
    v_mfma_f32_16x16x32_bf16 v[52:55], a[220:223], a[104:107], v[52:55]
    ds_read_b128 a[228:231], v0 offset:14336
    v_cvt_pk_bf16_f32 v26, v68, v69
    v_mfma_f32_16x16x32_bf16 v[60:63], a[220:223], a[128:131], 0
    ds_read_b128 a[232:235], v1 offset:14336
    v_accvgpr_read_b32 v107, a3
    v_mfma_f32_16x16x32_bf16 v[60:63], a[216:219], a[124:127], v[60:63]
    buffer_load_dwordx4 v6, s[8:11], s21 offen lds
    v_mfma_f32_16x16x32_bf16 v[60:63], a[212:215], a[120:123], v[60:63]
    v_exp_f32 v72, v72
    v_mfma_f32_16x16x32_bf16 v[68:71], a[212:215], a[144:147], 0
    s_add_u32 s21, s21, 128
    v_exp_f32 v80, v80
    v_mfma_f32_16x16x32_bf16 v[68:71], a[216:219], a[148:151], v[68:71]
    s_add_u32 m0, s22, 37888
    v_accvgpr_read_b32 v104, a0
    v_accvgpr_read_b32 v108, a48
    v_mfma_f32_16x16x32_bf16 v[68:71], a[220:223], a[152:155], v[68:71]
    buffer_load_dwordx4 v6, s[8:11], s21 offen lds
    v_mfma_f32_16x16x32_bf16 v[76:79], a[220:223], a[176:179], 0
    v_exp_f32 v58, v58
    v_mfma_f32_16x16x32_bf16 v[76:79], a[216:219], a[172:175], v[76:79]
    v_fma_f32 v81, v81, s28, v12
    v_exp_f32 v81, v81
    v_mfma_f32_16x16x32_bf16 v[76:79], a[212:215], a[168:171], v[76:79]
    s_waitcnt lgkmcnt(2)
    v_exp_f32 v83, v83
    v_mfma_f32_16x16x32_bf16 v[76:79], a[224:227], a[180:183], v[76:79]
    s_waitcnt lgkmcnt(1)
    ds_read_b128 a[216:219], v1 offset:18432
    v_fma_f32 v74, v74, s28, v11
    v_mfma_f32_16x16x32_bf16 v[76:79], a[228:231], a[184:187], v[76:79]
    s_waitcnt lgkmcnt(1)
    ds_read_b128 a[212:215], v0 offset:18432
    v_cvt_pk_bf16_f32 v112, v112, v113
    v_mfma_f32_16x16x32_bf16 v[76:79], a[232:235], a[188:191], v[76:79]
    ds_read_b128 a[220:223], v0 offset:19456
    v_exp_f32 v64, v64
    v_mfma_f32_16x16x32_bf16 v[68:71], a[232:235], a[164:167], v[68:71]
    v_exp_f32 v56, v56
    v_mfma_f32_16x16x32_bf16 v[68:71], a[228:231], a[160:163], v[68:71]
    v_exp_f32 v67, v67
    v_mfma_f32_16x16x32_bf16 v[68:71], a[224:227], a[156:159], v[68:71]
    v_cvt_pk_bf16_f32 v116, v116, v117
    v_cvt_pk_bf16_f32 v35, v82, v83
    v_mfma_f32_16x16x32_bf16 v[60:63], a[224:227], a[132:135], v[60:63]
    s_add_u32 s21, s21, 128
    v_exp_f32 v73, v73
    v_mfma_f32_16x16x32_bf16 v[60:63], a[228:231], a[136:139], v[60:63]
    v_exp_f32 v65, v65
    v_mfma_f32_16x16x32_bf16 v[60:63], a[232:235], a[140:143], v[60:63]
    v_cvt_pk_bf16_f32 v22, v64, v65
    v_cvt_pk_bf16_f32 v17, v58, v59
    v_mfma_f32_16x16x32_bf16 v[52:55], a[232:235], a[116:119], v[52:55]
    v_exp_f32 v75, v75
    v_mfma_f32_16x16x32_bf16 v[52:55], a[228:231], a[112:115], v[52:55]
    v_exp_f32 v74, v74
    v_mfma_f32_16x16x32_bf16 v[52:55], a[224:227], a[108:111], v[52:55]
    s_waitcnt lgkmcnt(1)
    ds_read_b128 a[228:231], v0 offset:20480
    v_cvt_pk_bf16_f32 v16, v56, v57
    v_mfma_f32_16x16x32_bf16 v[56:59], a[212:215], a[96:99], 0
    v_cvt_pk_bf16_f32 v23, v66, v67
    v_fma_f32 v70, v70, s28, v11
    v_mfma_f32_16x16x32_bf16 v[56:59], a[216:219], a[100:103], v[56:59]
    s_waitcnt lgkmcnt(1)
    ds_read_b128 a[232:235], v1 offset:20480
    v_fma_f32 v77, v77, s28, v12
    v_mfma_f32_16x16x32_bf16 v[56:59], a[220:223], a[104:107], v[56:59]
    ds_read_b128 a[224:227], v1 offset:19456
    v_fma_f32 v79, v79, s28, v12
    v_mfma_f32_16x16x32_bf16 v[64:67], a[220:223], a[128:131], 0
    v_fma_f32 v52, v52, s28, v9
    v_cvt_pk_bf16_f32 v28, v72, v73
    v_fma_f32 v69, v69, s28, v11
    v_cvt_pk_bf16_f32 v208, v208, v209
    v_cvt_pk_bf16_f32 v164, v164, v165
    v_pk_mul_f32 v[104:105], v[104:105], v[8:9] op_sel_hi:[1,0]
    v_pk_mul_f32 v[172:173], v[172:173], v[102:103] op_sel_hi:[1,0]
    v_cvt_pk_bf16_f32 v104, v104, v105
    v_pk_mul_f32 v[120:121], v[120:121], v[48:49] op_sel_hi:[1,0]
    v_pk_mul_f32 v[160:161], v[160:161], v[102:103] op_sel_hi:[1,0]
    v_pk_mul_f32 v[108:109], v[108:109], v[100:101] op_sel_hi:[1,0]
    v_pk_mul_f32 v[126:127], v[126:127], v[48:49] op_sel_hi:[1,0]
    v_pk_mul_f32 v[124:125], v[124:125], v[48:49] op_sel_hi:[1,0]
    v_pk_mul_f32 v[170:171], v[170:171], v[102:103] op_sel_hi:[1,0]
    v_pk_mul_f32 v[128:129], v[128:129], v[48:49] op_sel_hi:[1,0]
    v_pk_mul_f32 v[118:119], v[118:119], v[48:49] op_sel_hi:[1,0]
    v_pk_mul_f32 v[106:107], v[106:107], v[8:9] op_sel_hi:[1,0]
    v_pk_mul_f32 v[232:233], v[232:233], v[50:51] op_sel_hi:[1,0]
    v_cvt_pk_bf16_f32 v29, v74, v75
    v_pk_mul_f32 v[212:213], v[212:213], v[50:51] op_sel_hi:[1,0]
    v_cvt_pk_bf16_f32 v160, v160, v161
    v_pk_mul_f32 v[216:217], v[216:217], v[50:51] op_sel_hi:[1,0]
    v_cvt_pk_bf16_f32 v209, v210, v211
    v_pk_mul_f32 v[168:169], v[168:169], v[102:103] op_sel_hi:[1,0]
    v_cvt_pk_bf16_f32 v108, v108, v109
    v_pk_mul_f32 v[110:111], v[110:111], v[100:101] op_sel_hi:[1,0]
    v_pk_mul_f32 v[248:249], v[248:249], v[50:51] op_sel_hi:[1,0]
    v_cvt_pk_bf16_f32 v109, v110, v111
    v_cvt_pk_bf16_f32 v34, v80, v81
    v_mfma_f32_16x16x32_bf16 v[64:67], a[216:219], a[124:127], v[64:67]
    s_add_u32 m0, s22, 38912
    v_exp_f32 v69, v69
    v_mfma_f32_16x16x32_bf16 v[64:67], a[212:215], a[120:123], v[64:67]
    v_fma_f32 v60, v60, s28, v10
    v_cvt_pk_bf16_f32 v216, v216, v217
    v_mfma_f32_16x16x32_bf16 v[72:75], a[212:215], a[144:147], 0
    buffer_load_dwordx4 v6, s[8:11], s21 offen lds
    v_mfma_f32_16x16x32_bf16 v[72:75], a[216:219], a[148:151], v[72:75]
    s_add_u32 s21, s21, 12032
    v_cvt_pk_bf16_f32 v105, v106, v107
    v_cvt_pk_bf16_f32 v180, v180, v181
    v_mfma_f32_16x16x32_bf16 v[72:75], a[220:223], a[152:155], v[72:75]
    v_cvt_pk_bf16_f32 v113, v114, v115
    v_cvt_pk_bf16_f32 v161, v162, v163
    v_fma_f32 v54, v54, s28, v9
    v_mfma_f32_16x16x32_bf16 v[80:83], a[220:223], a[176:179], 0
    s_waitcnt vmcnt(6) lgkmcnt(0)
    ds_write2st64_b64 v101, v[112:113], v[160:161] offset0:0 offset1:12
    v_mfma_f32_16x16x32_bf16 v[80:83], a[216:219], a[172:175], v[80:83]
    s_barrier
    v_mfma_f32_16x16x32_bf16 v[80:83], a[212:215], a[168:171], v[80:83]
    v_exp_f32 v70, v70
    v_cvt_pk_bf16_f32 v117, v118, v119
    v_mfma_f32_16x16x32_bf16 v[80:83], a[224:227], a[180:183], v[80:83]
    ds_write2st64_b64 v101, v[208:209], v[104:105] offset0:24 offset1:36
    v_mfma_f32_16x16x32_bf16 v[80:83], a[228:231], a[184:187], v[80:83]
    v_exp_f32 v60, v60
    v_mfma_f32_16x16x32_bf16 v[80:83], a[232:235], a[188:191], v[80:83]
    v_fma_f32 v62, v62, s28, v10
    v_cvt_pk_bf16_f32 v124, v124, v125
    v_fma_f32 v63, v63, s28, v10
    v_mfma_f32_16x16x32_bf16 v[72:75], a[232:235], a[164:167], v[72:75]
    ds_read_b64_tr_b16 a[212:213], v2 offset:0
    v_exp_f32 v79, v79
    v_fma_f32 v68, v68, s28, v11
    v_cvt_pk_bf16_f32 v168, v168, v169
    v_mfma_f32_16x16x32_bf16 v[44:47], a[236:239], v[14:17], 0
    s_add_u32 m0, s22, 12288
    ds_write_b64 v101, v[108:109] offset:24576
    v_mfma_f32_16x16x32_bf16 v[72:75], a[228:231], a[160:163], v[72:75]
    ds_read_b64_tr_b16 a[214:215], v2 offset:6144
    v_accvgpr_read_b32 v106, a6
    v_mfma_f32_16x16x32_bf16 v[72:75], a[224:227], a[156:159], v[72:75]
    v_exp_f32 v77, v77
    v_mfma_f32_16x16x32_bf16 v[64:67], a[224:227], a[132:135], v[64:67]
    ds_read_b64_tr_b16 a[216:217], v3 offset:0
    v_fma_f32 v53, v53, s28, v9
    v_cvt_pk_bf16_f32 v125, v126, v127
    v_accvgpr_read_b32 v109, a53
    v_mfma_f32_16x16x32_bf16 v[64:67], a[228:231], a[136:139], v[64:67]
    buffer_load_dwordx4 v6, s[4:7], s20 offen lds
    v_mfma_f32_16x16x32_bf16 v[64:67], a[232:235], a[140:143], v[64:67]
    ds_read_b64_tr_b16 a[218:219], v3 offset:6144
    v_accvgpr_read_b32 v108, a52
    v_mfma_f32_16x16x32_bf16 v[56:59], a[232:235], a[116:119], v[56:59]
    v_accvgpr_read_b32 v105, a5
    v_fma_f32 v83, v83, s28, v12
    v_mfma_f32_16x16x32_bf16 v[56:59], a[228:231], a[112:115], v[56:59]
    ds_read_b64_tr_b16 a[220:221], v4 offset:0
    v_accvgpr_read_b32 v107, a7
    v_xor_b32 v101, 32, v101
    v_mfma_f32_16x16x32_bf16 v[56:59], a[224:227], a[108:111], v[56:59]
    ds_read_b64_tr_b16 a[228:229], v2 offset:1024
    v_exp_f32 v53, v53
    v_accvgpr_read_b32 v110, a54
    v_fma_f32 v80, v80, s28, v12
    v_pk_mul_f32 v[146:147], v[146:147], v[48:49] op_sel_hi:[1,0]
    v_pk_mul_f32 v[130:131], v[130:131], v[48:49] op_sel_hi:[1,0]
    v_accvgpr_read_b32 v111, a55
    v_fma_f32 v82, v82, s28, v12
    v_pk_mul_f32 v[176:177], v[176:177], v[102:103] op_sel_hi:[1,0]
    v_accvgpr_read_b32 v104, a4
    v_pk_mul_f32 v[104:105], v[104:105], v[8:9] op_sel_hi:[1,0]
    v_pk_mul_f32 v[234:235], v[234:235], v[50:51] op_sel_hi:[1,0]
    v_pk_mul_f32 v[174:175], v[174:175], v[102:103] op_sel_hi:[1,0]
    v_fma_f32 v61, v61, s28, v10
    v_pk_mul_f32 v[182:183], v[182:183], v[102:103] op_sel_hi:[1,0]
    v_pk_mul_f32 v[108:109], v[108:109], v[100:101] op_sel_hi:[1,0]
    v_pk_mul_f32 v[224:225], v[224:225], v[50:51] op_sel_hi:[1,0]
    v_cvt_pk_bf16_f32 v172, v172, v173
    v_pk_mul_f32 v[110:111], v[110:111], v[100:101] op_sel_hi:[1,0]
    v_pk_mul_f32 v[214:215], v[214:215], v[50:51] op_sel_hi:[1,0]
    v_fma_f32 v56, v56, s28, v9
    v_pk_mul_f32 v[106:107], v[106:107], v[8:9] op_sel_hi:[1,0]
    v_pk_mul_f32 v[186:187], v[186:187], v[102:103] op_sel_hi:[1,0]
    v_pk_mul_f32 v[222:223], v[222:223], v[50:51] op_sel_hi:[1,0]
    v_pk_mul_f32 v[136:137], v[136:137], v[48:49] op_sel_hi:[1,0]
    v_cvt_pk_bf16_f32 v120, v120, v121
    v_pk_mul_f32 v[226:227], v[226:227], v[50:51] op_sel_hi:[1,0]
    v_cvt_pk_bf16_f32 v108, v108, v109
    v_cvt_pk_bf16_f32 v212, v212, v213
    v_mfma_f32_16x16x32_bf16 v[44:47], a[240:243], v[20:23], v[44:47]
    s_waitcnt lgkmcnt(2)
    ds_read_b64_tr_b16 a[222:223], v4 offset:6144
    v_cvt_pk_bf16_f32 v213, v214, v215
    v_exp_f32 v68, v68
    v_mfma_f32_16x16x32_bf16 v[112:115], a[212:215], v[14:17], 0
    ds_read_b64_tr_b16 a[234:235], v3 offset:7168
    v_exp_f32 v52, v52
    v_exp_f32 v82, v82
    v_pk_mul_f32 v[194:195], v[194:195], v[102:103] op_sel_hi:[1,0]
    v_pk_mul_f32 v[122:123], v[122:123], v[48:49] op_sel_hi:[1,0]
    v_cvt_pk_bf16_f32 v18, v52, v53
    v_cvt_pk_bf16_f32 v173, v174, v175
    v_pk_mul_f32 v[138:139], v[138:139], v[48:49] op_sel_hi:[1,0]
    v_fma_f32 v57, v57, s28, v9
    v_cvt_pk_bf16_f32 v104, v104, v105
    v_pk_mul_f32 v[152:153], v[152:153], v[48:49] op_sel_hi:[1,0]
    v_fma_f32 v55, v55, s28, v9
    v_cvt_pk_bf16_f32 v128, v128, v129
    v_cvt_pk_bf16_f32 v165, v166, v167
    v_pk_mul_f32 v[244:245], v[244:245], v[50:51] op_sel_hi:[1,0]
    v_cvt_pk_bf16_f32 v121, v122, v123
    v_pk_mul_f32 v[184:185], v[184:185], v[102:103] op_sel_hi:[1,0]
    v_cvt_pk_bf16_f32 v109, v110, v111
    v_cvt_pk_bf16_f32 v224, v224, v225
    v_mfma_f32_16x16x32_bf16 v[160:163], a[212:215], v[20:23], 0
    s_add_u32 s20, s20, 128
    ds_read_b64_tr_b16 a[232:233], v3 offset:1024
    v_fma_f32 v59, v59, s28, v9
    v_mfma_f32_16x16x32_bf16 v[44:47], a[244:247], v[26:29], v[44:47]
    ds_write2st64_b64 v101, v[116:117], v[164:165] offset0:0 offset1:12
    v_mfma_f32_16x16x32_bf16 v[208:211], a[212:215], v[26:29], 0
    ds_read_b64_tr_b16 a[230:231], v2 offset:7168
    v_cvt_pk_bf16_f32 v105, v106, v107
    v_mfma_f32_16x16x32_bf16 v[44:47], a[248:251], v[32:35], v[44:47]
    ds_write2st64_b64 v101, v[212:213], v[104:105] offset0:24 offset1:36
    v_accvgpr_read_b32 v106, a10
    v_cvt_pk_bf16_f32 v136, v136, v137
    v_exp_f32 v55, v55
    v_cvt_pk_bf16_f32 v248, v248, v249
    v_mfma_f32_16x16x32_bf16 a[0:3], a[212:215], v[32:35], 0
    ds_read_b64_tr_b16 a[224:225], v5 offset:0
    v_cvt_pk_bf16_f32 v232, v232, v233
    v_mfma_f32_16x16x32_bf16 a[4:7], a[216:219], v[32:35], 0
    ds_write_b64 v101, v[108:109] offset:24576
    v_mfma_f32_16x16x32_bf16 v[212:215], a[216:219], v[26:29], 0
    s_add_u32 m0, s22, 13312
    ds_read_b64_tr_b16 a[226:227], v5 offset:6144
    buffer_load_dwordx4 v6, s[4:7], s20 offen lds
    v_accvgpr_read_b32 v104, a8
    v_accvgpr_read_b32 v111, a59
    v_pk_mul_f32 v[134:135], v[134:135], v[48:49] op_sel_hi:[1,0]
    v_pk_mul_f32 v[156:157], v[156:157], v[48:49] op_sel_hi:[1,0]
    v_pk_mul_f32 v[228:229], v[228:229], v[50:51] op_sel_hi:[1,0]
    v_pk_mul_f32 v[192:193], v[192:193], v[102:103] op_sel_hi:[1,0]
    v_fma_f32 v73, v73, s28, v11
    v_accvgpr_read_b32 v105, a9
    v_accvgpr_read_b32 v110, a58
    v_mfma_f32_16x16x32_bf16 v[164:167], a[216:219], v[20:23], 0
    ds_read_b64_tr_b16 a[212:213], v4 offset:1024
    v_accvgpr_read_b32 v108, a56
    v_accvgpr_read_b32 v109, a57
    v_accvgpr_read_b32 v107, a11
    v_cvt_pk_bf16_f32 v221, v222, v223
    v_pk_mul_f32 v[218:219], v[218:219], v[50:51] op_sel_hi:[1,0]
    v_cvt_pk_bf16_f32 v176, v176, v177
    v_pk_mul_f32 v[106:107], v[106:107], v[8:9] op_sel_hi:[1,0]
    v_pk_mul_f32 v[108:109], v[108:109], v[100:101] op_sel_hi:[1,0]
    v_pk_mul_f32 v[238:239], v[238:239], v[50:51] op_sel_hi:[1,0]
    v_fma_f32 v65, v65, s28, v10
    v_cvt_pk_bf16_f32 v217, v218, v219
    v_fma_f32 v76, v76, s28, v12
    v_pk_mul_f32 v[110:111], v[110:111], v[100:101] op_sel_hi:[1,0]
    v_pk_mul_f32 v[104:105], v[104:105], v[8:9] op_sel_hi:[1,0]
    v_pk_mul_f32 v[240:241], v[240:241], v[50:51] op_sel_hi:[1,0]
    v_cvt_pk_bf16_f32 v104, v104, v105
    v_pk_mul_f32 v[142:143], v[142:143], v[48:49] op_sel_hi:[1,0]
    v_cvt_pk_bf16_f32 v105, v106, v107
    v_xor_b32 v101, 96, v101
    v_cvt_pk_bf16_f32 v30, v68, v69
    v_pk_mul_f32 v[190:191], v[190:191], v[102:103] op_sel_hi:[1,0]
    v_cvt_pk_bf16_f32 v108, v108, v109
    v_pk_mul_f32 v[252:253], v[252:253], v[50:51] op_sel_hi:[1,0]
    v_fma_f32 v66, v66, s28, v10
    v_pk_mul_f32 v[236:237], v[236:237], v[50:51] op_sel_hi:[1,0]
    v_cvt_pk_bf16_f32 v225, v226, v227
    v_cvt_pk_bf16_f32 v169, v170, v171
    v_cvt_pk_bf16_f32 v109, v110, v111
    v_mfma_f32_16x16x32_bf16 v[116:119], a[216:219], v[14:17], 0
    s_waitcnt lgkmcnt(1)
    ds_write2st64_b64 v101, v[120:121], v[168:169] offset0:0 offset1:12
    v_accvgpr_read_b32 v106, a14
    v_mfma_f32_16x16x32_bf16 v[120:123], a[220:223], v[14:17], 0
    ds_write2st64_b64 v101, v[216:217], v[104:105] offset0:24 offset1:36
    v_mfma_f32_16x16x32_bf16 v[168:171], a[220:223], v[20:23], 0
    s_add_u32 s20, s20, 128
    ds_write_b64 v101, v[108:109] offset:24576
    v_cvt_pk_bf16_f32 v236, v236, v237
    v_accvgpr_read_b32 v111, a63
    v_pk_mul_f32 v[132:133], v[132:133], v[48:49] op_sel_hi:[1,0]
    v_accvgpr_read_b32 v110, a62
    v_pk_mul_f32 v[110:111], v[110:111], v[100:101] op_sel_hi:[1,0]
    v_cvt_pk_bf16_f32 v181, v182, v183
    v_accvgpr_read_b32 v107, a15
    v_pk_mul_f32 v[188:189], v[188:189], v[102:103] op_sel_hi:[1,0]
    v_pk_mul_f32 v[140:141], v[140:141], v[48:49] op_sel_hi:[1,0]
    v_pk_mul_f32 v[106:107], v[106:107], v[8:9] op_sel_hi:[1,0]
    v_cvt_pk_bf16_f32 v132, v132, v133
    v_pk_mul_f32 v[178:179], v[178:179], v[102:103] op_sel_hi:[1,0]
    v_pk_mul_f32 v[144:145], v[144:145], v[48:49] op_sel_hi:[1,0]
    v_pk_mul_f32 v[230:231], v[230:231], v[50:51] op_sel_hi:[1,0]
    v_accvgpr_read_b32 v104, a12
    v_xor_b32 v101, 32, v101
    v_accvgpr_read_b32 v108, a60
    v_mfma_f32_16x16x32_bf16 v[216:219], a[220:223], v[26:29], 0
    ds_write2st64_b64 v101, v[124:125], v[172:173] offset0:0 offset1:12
    v_accvgpr_read_b32 v105, a13
    v_pk_mul_f32 v[104:105], v[104:105], v[8:9] op_sel_hi:[1,0]
    v_cvt_pk_bf16_f32 v237, v238, v239
    v_cvt_pk_bf16_f32 v184, v184, v185
    v_mfma_f32_16x16x32_bf16 a[8:11], a[220:223], v[32:35], 0
    ds_read_b128 v[84:87], v103 offset:1024
    v_cvt_pk_bf16_f32 v104, v104, v105
    v_cvt_pk_bf16_f32 v129, v130, v131
    v_cvt_pk_bf16_f32 v156, v156, v157
    v_accvgpr_read_b32 v109, a61
    v_pk_mul_f32 v[108:109], v[108:109], v[100:101] op_sel_hi:[1,0]
    v_cvt_pk_bf16_f32 v105, v106, v107
    v_pk_mul_f32 v[158:159], v[158:159], v[48:49] op_sel_hi:[1,0]
    v_cvt_pk_bf16_f32 v108, v108, v109
    v_cvt_pk_bf16_f32 v192, v192, v193
    v_accvgpr_read_b32 v107, a19
    v_mfma_f32_16x16x32_bf16 a[12:15], a[224:227], v[32:35], 0
    ds_write2st64_b64 v101, v[220:221], v[104:105] offset0:24 offset1:36
    v_accvgpr_read_b32 v104, a16
    v_accvgpr_read_b32 v105, a17
    v_cvt_pk_bf16_f32 v109, v110, v111
    v_pk_mul_f32 v[154:155], v[154:155], v[48:49] op_sel_hi:[1,0]
    v_cvt_pk_bf16_f32 v177, v178, v179
    v_accvgpr_read_b32 v106, a18
    v_pk_mul_f32 v[104:105], v[104:105], v[8:9] op_sel_hi:[1,0]
    v_pk_mul_f32 v[242:243], v[242:243], v[50:51] op_sel_hi:[1,0]
    v_accvgpr_read_b32 v111, a67
    v_cvt_pk_bf16_f32 v137, v138, v139
    v_mfma_f32_16x16x32_bf16 v[220:223], a[224:227], v[26:29], 0
    ds_write_b64 v101, v[108:109] offset:24576
    ds_read_b64_tr_b16 a[214:215], v4 offset:7168
    v_cvt_pk_bf16_f32 v228, v228, v229
    v_pk_mul_f32 v[200:201], v[200:201], v[102:103] op_sel_hi:[1,0]
    v_pk_mul_f32 v[202:203], v[202:203], v[102:103] op_sel_hi:[1,0]
    v_accvgpr_read_b32 v109, a65
    v_cvt_pk_bf16_f32 v104, v104, v105
    v_exp_f32 v61, v61
    v_xor_b32 v101, 96, v101
    v_accvgpr_read_b32 v110, a66
    v_fma_f32 v75, v75, s28, v11
    v_accvgpr_read_b32 v108, a64
    v_pk_mul_f32 v[254:255], v[254:255], v[50:51] op_sel_hi:[1,0]
    v_pk_mul_f32 v[198:199], v[198:199], v[102:103] op_sel_hi:[1,0]
    v_pk_mul_f32 v[106:107], v[106:107], v[8:9] op_sel_hi:[1,0]
    v_cvt_pk_bf16_f32 v133, v134, v135
    v_pk_mul_f32 v[196:197], v[196:197], v[102:103] op_sel_hi:[1,0]
    v_exp_f32 v62, v62
    v_cvt_pk_bf16_f32 v244, v244, v245
    v_cvt_pk_bf16_f32 v229, v230, v231
    v_cvt_pk_bf16_f32 v105, v106, v107
    v_pk_mul_f32 v[108:109], v[108:109], v[100:101] op_sel_hi:[1,0]
    v_pk_mul_f32 v[250:251], v[250:251], v[50:51] op_sel_hi:[1,0]
    v_pk_mul_f32 v[110:111], v[110:111], v[100:101] op_sel_hi:[1,0]
    v_exp_f32 v63, v63
    v_cvt_pk_bf16_f32 v233, v234, v235
    v_cvt_pk_bf16_f32 v108, v108, v109
    v_cvt_pk_bf16_f32 v200, v200, v201
    v_mfma_f32_16x16x32_bf16 v[172:175], a[224:227], v[20:23], 0
    ds_write2st64_b64 v101, v[128:129], v[176:177] offset0:4 offset1:16
    ds_read_b128 v[96:99], v103 offset:0
    v_mfma_f32_16x16x32_bf16 v[124:127], a[224:227], v[14:17], 0
    ds_write2st64_b64 v101, v[224:225], v[104:105] offset0:28 offset1:40
    v_cvt_pk_bf16_f32 v109, v110, v111
    v_cvt_pk_bf16_f32 v252, v252, v253
    v_accvgpr_read_b32 v104, a20
    v_mfma_f32_16x16x32_bf16 v[128:131], a[228:231], v[14:17], 0
    s_add_u32 m0, s22, 14336
    ds_read_b64_tr_b16 a[226:227], v3 offset:8192
    ds_write_b64 v101, v[108:109] offset:26624
    v_xor_b32 v101, 32, v101
    v_accvgpr_read_b32 v105, a21
    v_accvgpr_read_b32 v106, a22
    v_mfma_f32_16x16x32_bf16 v[176:179], a[228:231], v[20:23], 0
    ds_write2st64_b64 v101, v[132:133], v[180:181] offset0:4 offset1:16
    v_accvgpr_read_b32 v109, a69
    v_accvgpr_read_b32 v108, a68
    v_pk_mul_f32 v[148:149], v[148:149], v[48:49] op_sel_hi:[1,0]
    v_cvt_pk_bf16_f32 v253, v254, v255
    v_pk_mul_f32 v[104:105], v[104:105], v[8:9] op_sel_hi:[1,0]
    v_fma_f32 v71, v71, s28, v11
    v_cvt_pk_bf16_f32 v140, v140, v141
    v_accvgpr_read_b32 v107, a23
    v_fma_f32 v58, v58, s28, v9
    v_cvt_pk_bf16_f32 v188, v188, v189
    v_cvt_pk_bf16_f32 v24, v60, v61
    v_fma_f32 v78, v78, s28, v12
    v_pk_mul_f32 v[106:107], v[106:107], v[8:9] op_sel_hi:[1,0]
    v_pk_mul_f32 v[204:205], v[204:205], v[102:103] op_sel_hi:[1,0]
    v_pk_mul_f32 v[108:109], v[108:109], v[100:101] op_sel_hi:[1,0]
    v_cvt_pk_bf16_f32 v104, v104, v105
    v_cvt_pk_bf16_f32 v144, v144, v145
    v_mfma_f32_16x16x32_bf16 v[224:227], a[228:231], v[26:29], 0
    ds_read_b64_tr_b16 a[222:223], v2 offset:8192
    ds_read_b64_tr_b16 a[220:221], v2 offset:2048
    v_accvgpr_read_b32 v110, a70
    v_accvgpr_read_b32 v111, a71
    v_cvt_pk_bf16_f32 v105, v106, v107
    v_cvt_pk_bf16_f32 v249, v250, v251
    v_accvgpr_read_b32 v107, a27
    v_cvt_pk_bf16_f32 v108, v108, v109
    v_mfma_f32_16x16x32_bf16 a[16:19], a[228:231], v[32:35], 0
    ds_read_b64_tr_b16 a[216:217], v5 offset:1024
    buffer_load_dwordx4 v6, s[4:7], s20 offen lds
    ds_read_b64_tr_b16 a[218:219], v5 offset:7168
    v_cvt_pk_bf16_f32 v141, v142, v143
    v_mfma_f32_16x16x32_bf16 a[20:23], a[232:235], v[32:35], 0
    ds_write2st64_b64 v101, v[228:229], v[104:105] offset0:28 offset1:40
    v_cvt_pk_bf16_f32 v152, v152, v153
    v_pk_mul_f32 v[110:111], v[110:111], v[100:101] op_sel_hi:[1,0]
    v_cvt_pk_bf16_f32 v185, v186, v187
    v_cvt_pk_bf16_f32 v189, v190, v191
    v_cvt_pk_bf16_f32 v109, v110, v111
    v_mfma_f32_16x16x32_bf16 v[228:231], a[232:235], v[26:29], 0
    s_add_u32 s20, s20, 12032
    ds_write_b64 v101, v[108:109] offset:26624
    v_accvgpr_read_b32 v105, a25
    v_accvgpr_read_b32 v110, a74
    v_accvgpr_read_b32 v111, a75
    v_mfma_f32_16x16x32_bf16 v[180:183], a[232:235], v[20:23], 0
    ds_read_b64_tr_b16 a[230:231], v4 offset:8192
    ds_read_b64_tr_b16 a[228:229], v4 offset:2048
    v_accvgpr_read_b32 v104, a24
    v_accvgpr_read_b32 v109, a73
    v_cvt_pk_bf16_f32 v148, v148, v149
    v_pk_mul_f32 v[246:247], v[246:247], v[50:51] op_sel_hi:[1,0]
    v_pk_mul_f32 v[104:105], v[104:105], v[8:9] op_sel_hi:[1,0]
    v_accvgpr_read_b32 v106, a26
    v_fma_f32 v74, v74, s28, v11
    v_accvgpr_read_b32 v108, a72
    v_pk_mul_f32 v[110:111], v[110:111], v[100:101] op_sel_hi:[1,0]
    v_fma_f32 v72, v72, s28, v11
    v_cvt_pk_bf16_f32 v240, v240, v241
    v_pk_mul_f32 v[106:107], v[106:107], v[8:9] op_sel_hi:[1,0]
    v_pk_mul_f32 v[108:109], v[108:109], v[100:101] op_sel_hi:[1,0]
    v_xor_b32 v101, 96, v101
    v_cvt_pk_bf16_f32 v108, v108, v109
    v_cvt_pk_bf16_f32 v104, v104, v105
    v_cvt_pk_bf16_f32 v109, v110, v111
    v_cvt_pk_bf16_f32 v105, v106, v107
    v_accvgpr_read_b32 v111, a79
    v_cvt_pk_bf16_f32 v196, v196, v197
    v_accvgpr_read_b32 v110, a78
    v_mfma_f32_16x16x32_bf16 v[132:135], a[232:235], v[14:17], 0
    s_waitcnt lgkmcnt(3)
    ds_write2st64_b64 v101, v[136:137], v[184:185] offset0:4 offset1:16
    v_mfma_f32_16x16x32_bf16 v[136:139], a[212:215], v[14:17], 0
    ds_write2st64_b64 v101, v[232:233], v[104:105] offset0:28 offset1:40
    v_mfma_f32_16x16x32_bf16 v[184:187], a[212:215], v[20:23], 0
    s_add_u32 s39, s39, 12288
    ds_write_b64 v101, v[108:109] offset:26624
    v_accvgpr_read_b32 v109, a77
    v_exp_f32 v54, v54
    v_exp_f32 v78, v78
    v_accvgpr_read_b32 v107, a31
    v_accvgpr_read_b32 v104, a28
    v_accvgpr_read_b32 v105, a29
    v_pk_mul_f32 v[110:111], v[110:111], v[100:101] op_sel_hi:[1,0]
    v_cvt_pk_bf16_f32 v204, v204, v205
    v_xor_b32 v101, 32, v101
    v_mfma_f32_16x16x32_bf16 v[232:235], a[212:215], v[26:29], 0
    ds_read_b64_tr_b16 a[232:233], v5 offset:2048
    ds_read_b64_tr_b16 a[234:235], v5 offset:8192
    ds_read_b64_tr_b16 a[224:225], v3 offset:2048
    v_cvt_pk_bf16_f32 v19, v54, v55
    v_mfma_f32_16x16x32_bf16 a[24:27], a[212:215], v[32:35], 0
    ds_write2st64_b64 v101, v[140:141], v[188:189] offset0:4 offset1:16
    v_pk_mul_f32 v[104:105], v[104:105], v[8:9] op_sel_hi:[1,0]
    v_accvgpr_read_b32 v108, a76
    v_pk_mul_f32 v[108:109], v[108:109], v[100:101] op_sel_hi:[1,0]
    v_accvgpr_read_b32 v106, a30
    v_cvt_pk_bf16_f32 v25, v62, v63
    v_cvt_pk_bf16_f32 v104, v104, v105
    v_cvt_pk_bf16_f32 v108, v108, v109
    v_exp_f32 v73, v73
    v_pk_mul_f32 v[106:107], v[106:107], v[8:9] op_sel_hi:[1,0]
    v_cvt_pk_bf16_f32 v109, v110, v111
    v_cvt_pk_bf16_f32 v193, v194, v195
    v_cvt_pk_bf16_f32 v105, v106, v107
    v_accvgpr_read_b32 v111, a83
    v_exp_f32 v71, v71
    v_fma_f32 v81, v81, s28, v12
    v_mfma_f32_16x16x32_bf16 a[28:31], a[216:219], v[32:35], 0
    buffer_store_dwordx4 v[96:99], v6, s[16:19], s67 offen offset:0 nt
    ds_write2st64_b64 v101, v[236:237], v[104:105] offset0:28 offset1:40
    v_accvgpr_read_b32 v110, a82
    v_mfma_f32_16x16x32_bf16 v[236:239], a[216:219], v[26:29], 0
    s_waitcnt vmcnt(7) lgkmcnt(2)
    ds_write_b64 v101, v[108:109] offset:26624
    v_accvgpr_read_b32 v105, a33
    v_cvt_pk_bf16_f32 v197, v198, v199
    v_xor_b32 v101, 96, v101
    v_pk_mul_f32 v[110:111], v[110:111], v[100:101] op_sel_hi:[1,0]
    v_accvgpr_read_b32 v108, a80
    v_cvt_pk_bf16_f32 v145, v146, v147
    v_accvgpr_read_b32 v109, a81
    v_pk_mul_f32 v[108:109], v[108:109], v[100:101] op_sel_hi:[1,0]
    v_accvgpr_read_b32 v104, a32
    v_pk_mul_f32 v[206:207], v[206:207], v[102:103] op_sel_hi:[1,0]
    v_accvgpr_read_b32 v107, a35
    v_pk_mul_f32 v[150:151], v[150:151], v[48:49] op_sel_hi:[1,0]
    v_cvt_pk_bf16_f32 v108, v108, v109
    v_cvt_pk_bf16_f32 v241, v242, v243
    v_mfma_f32_16x16x32_bf16 v[188:191], a[216:219], v[20:23], 0
    buffer_store_dwordx4 v[84:87], v7, s[16:19], s67 offen offset:0 nt
    s_barrier
    ds_write2st64_b64 v101, v[144:145], v[192:193] offset0:8 offset1:20
    v_pk_mul_f32 v[104:105], v[104:105], v[8:9] op_sel_hi:[1,0]
    v_accvgpr_read_b32 v106, a34
    v_pk_mul_f32 v[106:107], v[106:107], v[8:9] op_sel_hi:[1,0]
    v_mov_b32 v38, v6
    v_cvt_pk_bf16_f32 v104, v104, v105
    v_cvt_pk_bf16_f32 v105, v106, v107
    v_cvt_pk_bf16_f32 v109, v110, v111
    v_mfma_f32_16x16x32_bf16 v[140:143], a[216:219], v[14:17], 0
    ds_write2st64_b64 v101, v[240:241], v[104:105] offset0:32 offset1:44
    v_cvt_pk_bf16_f32 v245, v246, v247
    v_mfma_f32_16x16x32_bf16 v[144:147], a[220:223], v[14:17], 0
    ds_write_b64 v101, v[108:109] offset:0
    v_accvgpr_read_b32 v110, a86
    v_cvt_pk_bf16_f32 v153, v154, v155
    v_cvt_pk_bf16_f32 v31, v70, v71
    v_accvgpr_read_b32 v109, a85
    v_accvgpr_read_b32 v111, a87
    v_mfma_f32_16x16x32_bf16 v[192:195], a[220:223], v[20:23], 0
    s_add_u32 m0, s22, 24576
    ds_read_b128 v[96:99], v103 offset:3072
    v_accvgpr_read_b32 v106, a38
    v_accvgpr_read_b32 v107, a39
    v_accvgpr_read_b32 v108, a84
    v_accvgpr_read_b32 v105, a37
    v_accvgpr_read_b32 v104, a36
    v_pk_mul_f32 v[104:105], v[104:105], v[8:9] op_sel_hi:[1,0]
    v_pk_mul_f32 v[106:107], v[106:107], v[8:9] op_sel_hi:[1,0]
    v_pk_mul_f32 v[108:109], v[108:109], v[100:101] op_sel_hi:[1,0]
    v_cvt_pk_bf16_f32 v201, v202, v203
    v_cvt_pk_bf16_f32 v149, v150, v151
    v_xor_b32 v101, 32, v101
    v_cvt_pk_bf16_f32 v104, v104, v105
    v_pk_mul_f32 v[110:111], v[110:111], v[100:101] op_sel_hi:[1,0]
    v_cvt_pk_bf16_f32 v108, v108, v109
    v_cvt_pk_bf16_f32 v105, v106, v107
    v_accvgpr_read_b32 v106, a42
    v_mfma_f32_16x16x32_bf16 v[240:243], a[220:223], v[26:29], 0
    ds_write2st64_b64 v101, v[148:149], v[196:197] offset0:8 offset1:20
    v_cvt_pk_bf16_f32 v109, v110, v111
    v_mfma_f32_16x16x32_bf16 a[32:35], a[220:223], v[32:35], 0
    ds_write2st64_b64 v101, v[244:245], v[104:105] offset0:32 offset1:44
    v_accvgpr_read_b32 v104, a40
    v_mfma_f32_16x16x32_bf16 a[36:39], a[224:227], v[32:35], 0
    ds_write_b64 v101, v[108:109] offset:0
    v_exp_f32 v66, v66
    v_accvgpr_read_b32 v105, a41
    v_xor_b32 v101, 96, v101
    v_mfma_f32_16x16x32_bf16 v[244:247], a[224:227], v[26:29], 0
    ds_write2st64_b64 v101, v[152:153], v[200:201] offset0:8 offset1:20
    v_accvgpr_read_b32 v110, a90
    v_cvt_pk_bf16_f32 v205, v206, v207
    v_accvgpr_read_b32 v109, a89
    v_accvgpr_read_b32 v108, a88
    v_cvt_pk_bf16_f32 v157, v158, v159
    v_accvgpr_read_b32 v111, a91
    v_mfma_f32_16x16x32_bf16 v[196:199], a[224:227], v[20:23], 0
    ds_read_b128 a[220:223], v0 offset:1024
    buffer_load_dwordx4 v6, s[8:11], s21 offen lds
    v_accvgpr_read_b32 v107, a43
    v_exp_f32 v76, v76
    v_pk_mul_f32 v[104:105], v[104:105], v[8:9] op_sel_hi:[1,0]
    v_pk_mul_f32 v[110:111], v[110:111], v[100:101] op_sel_hi:[1,0]
    v_pk_mul_f32 v[108:109], v[108:109], v[100:101] op_sel_hi:[1,0]
    v_pk_mul_f32 v[106:107], v[106:107], v[8:9] op_sel_hi:[1,0]
    v_cvt_pk_bf16_f32 v104, v104, v105
    v_cvt_pk_bf16_f32 v105, v106, v107
    v_mfma_f32_16x16x32_bf16 v[148:151], a[224:227], v[14:17], 0
    ds_read_b128 v[88:91], v103 offset:2048
    ds_read_b128 a[212:215], v0 offset:0
    v_accvgpr_read_b32 v107, a47
    v_mfma_f32_16x16x32_bf16 v[152:155], a[228:231], v[14:17], 0
    s_add_u32 s21, s21, 128
    ds_read_b128 a[216:219], v1 offset:0
    v_cvt_pk_bf16_f32 v108, v108, v109
    v_cvt_pk_bf16_f32 v109, v110, v111
    v_mfma_f32_16x16x32_bf16 v[200:203], a[228:231], v[20:23], 0
    s_add_u32 m0, s22, 25600
    ds_write2st64_b64 v101, v[248:249], v[104:105] offset0:32 offset1:44
    v_mfma_f32_16x16x32_bf16 v[248:251], a[228:231], v[26:29], 0
    buffer_load_dwordx4 v6, s[8:11], s21 offen lds
    ds_write_b64 v101, v[108:109] offset:0
    v_accvgpr_read_b32 v110, a94
    v_xor_b32 v101, 32, v101
    v_accvgpr_read_b32 v106, a46
    v_accvgpr_read_b32 v104, a44
    v_accvgpr_read_b32 v105, a45
    v_mfma_f32_16x16x32_bf16 a[40:43], a[228:231], v[32:35], 0
    s_add_u32 s21, s21, 128
    ds_write2st64_b64 v101, v[156:157], v[204:205] offset0:8 offset1:20
    v_pk_mul_f32 v[104:105], v[104:105], v[8:9] op_sel_hi:[1,0]
    v_pk_mul_f32 v[106:107], v[106:107], v[8:9] op_sel_hi:[1,0]
    v_cvt_pk_bf16_f32 v104, v104, v105
    v_cvt_pk_bf16_f32 v105, v106, v107
    v_mfma_f32_16x16x32_bf16 a[44:47], a[232:235], v[32:35], 0
    s_add_u32 m0, s22, 26624
    ds_write2st64_b64 v101, v[252:253], v[104:105] offset0:32 offset1:44
    v_accvgpr_read_b32 v111, a95
    v_mfma_f32_16x16x32_bf16 v[252:255], a[232:235], v[26:29], 0
    buffer_load_dwordx4 v6, s[8:11], s21 offen lds
    v_mfma_f32_16x16x32_bf16 v[204:207], a[232:235], v[20:23], 0
    v_exp_f32 v80, v80
    v_mfma_f32_16x16x32_bf16 v[156:159], a[232:235], v[14:17], 0
    s_waitcnt lgkmcnt(3)
    v_exp_f32 v58, v58
    v_fma_f32 v64, v64, s28, v10
    v_mfma_f32_16x16x32_bf16 v[52:55], a[212:215], a[96:99], 0
    s_add_u32 s21, s21, 12032
    v_exp_f32 v59, v59
    v_mfma_f32_16x16x32_bf16 v[52:55], a[216:219], a[100:103], v[52:55]
    ds_read_b128 a[224:227], v1 offset:1024
    v_accvgpr_read_b32 v108, a92
    v_mfma_f32_16x16x32_bf16 v[52:55], a[220:223], a[104:107], v[52:55]
    v_exp_f32 v81, v81
    v_cvt_pk_bf16_f32 v17, v58, v59
    v_mfma_f32_16x16x32_bf16 v[60:63], a[220:223], a[128:131], 0
    s_add_u32 s56, s67, 128
    ds_read_b128 v[84:87], v103 offset:4096
    v_cvt_pk_bf16_f32 v37, v78, v79
    v_mfma_f32_16x16x32_bf16 v[60:63], a[216:219], a[124:127], v[60:63]
    s_add_u32 s58, s33, 128
    ds_read_b128 a[228:231], v0 offset:2048
    v_cvt_pk_bf16_f32 v36, v76, v77
    v_mfma_f32_16x16x32_bf16 v[60:63], a[212:215], a[120:123], v[60:63]
    s_add_u32 m0, s38, 2048
    ds_read_b128 a[232:235], v1 offset:2048
    v_fma_f32 v67, v67, s28, v10
    v_mfma_f32_16x16x32_bf16 v[68:71], a[212:215], a[144:147], 0
    buffer_load_dwordx4 v6, s[12:15], s58 offen nt lds
    v_mfma_f32_16x16x32_bf16 v[68:71], a[216:219], a[148:151], v[68:71]
    buffer_store_dwordx4 v[88:91], v6, s[16:19], s56 offen offset:0 nt
    s_add_u32 m0, s38, 3072
    v_exp_f32 v75, v75
    v_accvgpr_read_b32 v109, a93
    v_mfma_f32_16x16x32_bf16 v[68:71], a[220:223], a[152:155], v[68:71]
    v_exp_f32 v57, v57
    v_mfma_f32_16x16x32_bf16 v[76:79], a[220:223], a[176:179], 0
    v_exp_f32 v64, v64
    v_mfma_f32_16x16x32_bf16 v[76:79], a[216:219], a[172:175], v[76:79]
    buffer_load_dwordx4 v7, s[12:15], s58 offen nt lds
    v_mfma_f32_16x16x32_bf16 v[76:79], a[212:215], a[168:171], v[76:79]
    buffer_store_dwordx4 v[96:99], v7, s[16:19], s56 offen offset:0 nt
    ds_read_b128 a[216:219], v1 offset:6144
    v_pk_mul_f32 v[108:109], v[108:109], v[100:101] op_sel_hi:[1,0]
    v_pk_mul_f32 v[110:111], v[110:111], v[100:101] op_sel_hi:[1,0]
    v_exp_f32 v67, v67
    s_waitcnt lgkmcnt(1)
    v_mfma_f32_16x16x32_bf16 v[76:79], a[224:227], a[180:183], v[76:79]
    v_exp_f32 v56, v56
    v_mfma_f32_16x16x32_bf16 v[76:79], a[228:231], a[184:187], v[76:79]
    s_add_u32 s57, s67, 256
    v_exp_f32 v72, v72
    v_mfma_f32_16x16x32_bf16 v[76:79], a[232:235], a[188:191], v[76:79]
    s_add_u32 s59, s33, 256
    ds_read_b128 a[212:215], v0 offset:6144
    v_cvt_pk_bf16_f32 v108, v108, v109
    v_mfma_f32_16x16x32_bf16 v[68:71], a[232:235], a[164:167], v[68:71]
    s_add_u32 m0, s38, 4096
    ds_read_b128 v[88:91], v103 offset:5120
    v_cvt_pk_bf16_f32 v109, v110, v111
    v_mfma_f32_16x16x32_bf16 v[68:71], a[228:231], a[160:163], v[68:71]
    v_cvt_pk_bf16_f32 v23, v66, v67
    v_mfma_f32_16x16x32_bf16 v[68:71], a[224:227], a[156:159], v[68:71]
    buffer_store_dwordx4 v[84:87], v6, s[16:19], s57 offen offset:0 nt
    ds_write_b64 v101, v[108:109] offset:0
    v_mfma_f32_16x16x32_bf16 v[60:63], a[224:227], a[132:135], v[60:63]
    ds_read_b128 v[96:99], v103 offset:0
    v_cvt_pk_bf16_f32 v16, v56, v57
    v_mfma_f32_16x16x32_bf16 v[60:63], a[228:231], a[136:139], v[60:63]
    ds_read_b128 a[220:223], v0 offset:7168
    v_cvt_pk_bf16_f32 v28, v72, v73
    v_mfma_f32_16x16x32_bf16 v[48:51], a[236:239], v[16:19], v[44:47]
    buffer_load_dwordx4 v6, s[12:15], s59 offen nt lds
    v_mfma_f32_16x16x32_bf16 v[60:63], a[232:235], a[140:143], v[60:63]
    ds_read_b128 v[84:87], v103 offset:1024
    v_exp_f32 v74, v74
    v_mfma_f32_16x16x32_bf16 v[52:55], a[232:235], a[116:119], v[52:55]
    v_exp_f32 v83, v83
    v_mfma_f32_16x16x32_bf16 v[52:55], a[228:231], a[112:115], v[52:55]
    v_exp_f32 v65, v65
    v_mfma_f32_16x16x32_bf16 v[52:55], a[224:227], a[108:111], v[52:55]
    s_waitcnt lgkmcnt(4)
    ds_read_b128 a[228:231], v0 offset:8192
    v_cvt_pk_bf16_f32 v22, v64, v65
    v_mfma_f32_16x16x32_bf16 v[56:59], a[212:215], a[96:99], 0
    s_add_u32 m0, s38, 5120
    ds_read_b128 a[232:235], v1 offset:8192
    v_cvt_pk_bf16_f32 v29, v74, v75
    v_mfma_f32_16x16x32_bf16 v[56:59], a[216:219], a[100:103], v[56:59]
    ds_read_b128 a[224:227], v1 offset:7168
    v_cvt_pk_bf16_f32 v34, v80, v81
    v_mfma_f32_16x16x32_bf16 v[48:51], a[240:243], v[22:25], v[48:51]
    buffer_load_dwordx4 v7, s[12:15], s59 offen nt lds
    v_mfma_f32_16x16x32_bf16 v[48:51], a[244:247], v[28:31], v[48:51]
    buffer_store_dwordx4 v[88:91], v7, s[16:19], s57 offen offset:0 nt
    v_cvt_pk_bf16_f32 v35, v82, v83
    s_nop 1
    v_mfma_f32_16x16x32_bf16 v[48:51], a[248:251], v[34:37], v[48:51]
    s_add_u32 s56, s67, 24832
    s_add_u32 m0, s38, 0
    s_waitcnt lgkmcnt(3)
    v_mfma_f32_16x16x32_bf16 v[56:59], a[220:223], a[104:107], v[56:59]
    buffer_load_dwordx4 v6, s[12:15], s33 offen nt lds
    v_mfma_f32_16x16x32_bf16 v[64:67], a[220:223], a[128:131], 0
    s_add_u32 m0, s38, 1024
    v_add_u32 v103, 6144, v103
    v_cmp_lt_f32 vcc, s29, v48
    v_mfma_f32_16x16x32_bf16 v[64:67], a[216:219], a[124:127], v[64:67]
    buffer_load_dwordx4 v7, s[12:15], s33 offen nt lds
    v_mfma_f32_16x16x32_bf16 v[64:67], a[212:215], a[120:123], v[64:67]
    v_mov_b32 v39, v7
    v_mfma_f32_16x16x32_bf16 v[72:75], a[212:215], a[144:147], 0
    s_cbranch_vccnz L_rs_tr54d
L_ret_tr54d:
    v_fma_f32 v54, v54, s28, v9
    v_mfma_f32_16x16x32_bf16 v[72:75], a[216:219], a[148:151], v[72:75]
    s_waitcnt vmcnt(18) lgkmcnt(0)
    v_fma_f32 v60, v60, s28, v10
    v_fma_f32 v61, v61, s28, v10
    v_mfma_f32_16x16x32_bf16 v[72:75], a[220:223], a[152:155], v[72:75]
    buffer_store_dwordx4 v[96:99], v6, s[16:19], s56 offen offset:0 nt
    s_barrier
    v_fma_f32 v55, v55, s28, v9
    v_fma_f32 v53, v53, s28, v9
    v_mfma_f32_16x16x32_bf16 v[80:83], a[220:223], a[176:179], 0
    v_exp_f32 v55, v55
    v_mfma_f32_16x16x32_bf16 v[80:83], a[216:219], a[172:175], v[80:83]
    s_add_u32 m0, s22, 0
    v_exp_f32 v54, v54
    v_mfma_f32_16x16x32_bf16 v[80:83], a[212:215], a[168:171], v[80:83]
    v_exp_f32 v60, v60
    v_mfma_f32_16x16x32_bf16 v[80:83], a[224:227], a[180:183], v[80:83]
    ds_read_b64_tr_b16 a[212:213], v2 offset:18432
    v_cvt_pk_bf16_f32 v15, v54, v55
    v_mfma_f32_16x16x32_bf16 v[80:83], a[228:231], a[184:187], v[80:83]
    buffer_load_dwordx4 v6, s[4:7], s20 offen lds
    v_mfma_f32_16x16x32_bf16 v[80:83], a[232:235], a[188:191], v[80:83]
    ds_read_b64_tr_b16 a[214:215], v2 offset:12288
    v_fma_f32 v52, v52, s28, v9
    v_mfma_f32_16x16x32_bf16 v[72:75], a[232:235], a[164:167], v[72:75]
    s_add_u32 s20, s20, 128
    v_exp_f32 v53, v53
    v_mfma_f32_16x16x32_bf16 v[72:75], a[228:231], a[160:163], v[72:75]
    v_exp_f32 v61, v61
    v_mfma_f32_16x16x32_bf16 v[72:75], a[224:227], a[156:159], v[72:75]
    buffer_store_dwordx4 v[84:87], v7, s[16:19], s56 offen offset:0 nt
    ds_read_b64_tr_b16 a[216:217], v3 offset:18432
    v_exp_f32 v52, v52
    v_mfma_f32_16x16x32_bf16 v[64:67], a[224:227], a[132:135], v[64:67]
    s_add_u32 m0, s22, 1024
    ds_read_b64_tr_b16 a[218:219], v3 offset:12288
    v_cvt_pk_bf16_f32 v20, v60, v61
    v_mfma_f32_16x16x32_bf16 v[64:67], a[228:231], a[136:139], v[64:67]
    ds_read_b64_tr_b16 a[220:221], v4 offset:18432
    v_cvt_pk_bf16_f32 v14, v52, v53
    v_mfma_f32_16x16x32_bf16 v[64:67], a[232:235], a[140:143], v[64:67]
    buffer_load_dwordx4 v6, s[4:7], s20 offen lds
    v_mfma_f32_16x16x32_bf16 v[56:59], a[232:235], a[116:119], v[56:59]
    s_add_u32 s20, s20, 128
    s_add_u32 m0, s22, 2048
    ds_read_b64_tr_b16 a[222:223], v4 offset:12288
    v_mfma_f32_16x16x32_bf16 v[56:59], a[228:231], a[112:115], v[56:59]
    buffer_load_dwordx4 v6, s[4:7], s20 offen lds
    v_mfma_f32_16x16x32_bf16 v[56:59], a[224:227], a[108:111], v[56:59]
    s_add_u32 s20, s20, 12032
    ds_read_b64_tr_b16 a[224:225], v5 offset:18432
    ds_read_b64_tr_b16 a[226:227], v5 offset:12288
    s_branch L_loop4
L_tr55:
    s_waitcnt lgkmcnt(4)
    v_mfma_f32_16x16x32_bf16 v[112:115], a[212:215], v[16:19], v[112:115]
    s_add_u32 s39, s39, 12288
    v_fma_f32 v79, v79, s28, v12
    v_mbcnt_lo_u32_b32 v97, -1, 0
    v_mfma_f32_16x16x32_bf16 v[116:119], a[216:219], v[16:19], v[116:119]
    s_add_u32 s48, s33, 24576
    ds_read_b64_tr_b16 a[228:229], v2 offset:19456
    v_mbcnt_hi_u32_b32 v97, -1, v97
    v_mfma_f32_16x16x32_bf16 v[164:167], a[216:219], v[22:25], v[164:167]
    ds_read_b64_tr_b16 a[230:231], v2 offset:13312
    v_fma_f32 v76, v76, s28, v12
    v_mfma_f32_16x16x32_bf16 v[160:163], a[212:215], v[22:25], v[160:163]
    v_and_b32 v96, 15, v97
    v_fma_f32 v82, v82, s28, v12
    v_mfma_f32_16x16x32_bf16 v[208:211], a[212:215], v[28:31], v[208:211]
    v_fma_f32 v87, v87, s28, v13
    v_fma_f32 v75, v75, s28, v11
    v_mfma_f32_16x16x32_bf16 v[212:215], a[216:219], v[28:31], v[212:215]
    v_mul_u32_u24 v96, 384, v96
    v_fma_f32 v64, v64, s28, v10
    v_mfma_f32_16x16x32_bf16 a[4:7], a[216:219], v[34:37], a[4:7]
    ds_read_b64_tr_b16 a[232:233], v3 offset:19456
    v_fma_f32 v85, v85, s28, v13
    v_mfma_f32_16x16x32_bf16 a[0:3], a[212:215], v[34:37], a[0:3]
    v_fma_f32 v69, v69, s28, v11
    v_fma_f32 v86, v86, s28, v13
    v_mfma_f32_16x16x32_bf16 a[48:51], a[212:215], v[40:43], a[48:51]
    v_lshrrev_b32 v97, 4, v97
    v_fma_f32 v58, v58, s28, v9
    v_mfma_f32_16x16x32_bf16 a[52:55], a[216:219], v[40:43], a[52:55]
    s_waitcnt lgkmcnt(3)
    ds_read_b64_tr_b16 a[234:235], v3 offset:13312
    v_fma_f32 v56, v56, s28, v9
    v_mfma_f32_16x16x32_bf16 a[56:59], a[220:223], v[40:43], a[56:59]
    ds_read_b64_tr_b16 a[212:213], v4 offset:19456
    v_lshl_add_u32 v96, v97, 4, v96
    v_mfma_f32_16x16x32_bf16 a[60:63], a[224:227], v[40:43], a[60:63]
    ds_read_b64_tr_b16 a[216:217], v5 offset:19456
    v_fma_f32 v89, v89, s28, v13
    v_mfma_f32_16x16x32_bf16 a[12:15], a[224:227], v[34:37], a[12:15]
    v_fma_f32 v80, v80, s28, v12
    v_fma_f32 v74, v74, s28, v11
    v_mfma_f32_16x16x32_bf16 a[8:11], a[220:223], v[34:37], a[8:11]
    buffer_load_dword v97, v96, s[12:15], s48 offen offset:256
    v_mfma_f32_16x16x32_bf16 v[216:219], a[220:223], v[28:31], v[216:219]
    ds_read_b64_tr_b16 a[214:215], v4 offset:13312
    v_fma_f32 v71, v71, s28, v11
    v_mfma_f32_16x16x32_bf16 v[220:223], a[224:227], v[28:31], v[220:223]
    ds_read_b64_tr_b16 a[218:219], v5 offset:13312
    v_mfma_f32_16x16x32_bf16 v[172:175], a[224:227], v[22:25], v[172:175]
    v_exp_f32 v76, v76
    v_mfma_f32_16x16x32_bf16 v[168:171], a[220:223], v[22:25], v[168:171]
    v_fma_f32 v84, v84, s28, v13
    v_fma_f32 v70, v70, s28, v11
    v_mfma_f32_16x16x32_bf16 v[120:123], a[220:223], v[16:19], v[120:123]
    v_exp_f32 v85, v85
    v_mfma_f32_16x16x32_bf16 v[124:127], a[224:227], v[16:19], v[124:127]
    s_waitcnt lgkmcnt(4)
    ds_read_b64_tr_b16 a[220:221], v2 offset:20480
    v_fma_f32 v66, v66, s28, v10
    v_mfma_f32_16x16x32_bf16 v[128:131], a[228:231], v[16:19], v[128:131]
    v_fma_f32 v90, v90, s28, v13
    v_fma_f32 v59, v59, s28, v9
    v_mfma_f32_16x16x32_bf16 v[132:135], a[232:235], v[16:19], v[132:135]
    v_fma_f32 v81, v81, s28, v12
    v_fma_f32 v68, v68, s28, v11
    v_mfma_f32_16x16x32_bf16 v[180:183], a[232:235], v[22:25], v[180:183]
    v_exp_f32 v81, v81
    v_mfma_f32_16x16x32_bf16 v[176:179], a[228:231], v[22:25], v[176:179]
    ds_read_b64_tr_b16 a[224:225], v3 offset:20480
    v_fma_f32 v78, v78, s28, v12
    v_mfma_f32_16x16x32_bf16 v[224:227], a[228:231], v[28:31], v[224:227]
    ds_read_b64_tr_b16 a[222:223], v2 offset:14336
    v_mfma_f32_16x16x32_bf16 v[228:231], a[232:235], v[28:31], v[228:231]
    v_exp_f32 v68, v68
    v_mfma_f32_16x16x32_bf16 a[20:23], a[232:235], v[34:37], a[20:23]
    v_fma_f32 v72, v72, s28, v11
    v_fma_f32 v77, v77, s28, v12
    v_mfma_f32_16x16x32_bf16 a[16:19], a[228:231], v[34:37], a[16:19]
    v_exp_f32 v84, v84
    v_mfma_f32_16x16x32_bf16 a[64:67], a[228:231], v[40:43], a[64:67]
    ds_read_b64_tr_b16 a[228:229], v4 offset:20480
    v_fma_f32 v67, v67, s28, v10
    v_mfma_f32_16x16x32_bf16 a[68:71], a[232:235], v[40:43], a[68:71]
    s_waitcnt lgkmcnt(3)
    v_exp_f32 v71, v71
    v_mfma_f32_16x16x32_bf16 a[72:75], a[212:215], v[40:43], a[72:75]
    ds_read_b64_tr_b16 a[226:227], v3 offset:14336
    v_fma_f32 v88, v88, s28, v13
    v_mfma_f32_16x16x32_bf16 a[76:79], a[216:219], v[40:43], a[76:79]
    ds_read_b64_tr_b16 a[232:233], v5 offset:20480
    v_fma_f32 v91, v91, s28, v13
    v_mfma_f32_16x16x32_bf16 a[28:31], a[216:219], v[34:37], a[28:31]
    ds_read_b64_tr_b16 a[230:231], v4 offset:14336
    v_fma_f32 v57, v57, s28, v9
    v_mfma_f32_16x16x32_bf16 a[24:27], a[212:215], v[34:37], a[24:27]
    ds_read_b64_tr_b16 a[234:235], v5 offset:14336
    v_mfma_f32_16x16x32_bf16 v[232:235], a[212:215], v[28:31], v[232:235]
    v_exp_f32 v86, v86
    v_mfma_f32_16x16x32_bf16 v[236:239], a[216:219], v[28:31], v[236:239]
    v_exp_f32 v87, v87
    v_mfma_f32_16x16x32_bf16 v[188:191], a[216:219], v[22:25], v[188:191]
    v_exp_f32 v79, v79
    v_mfma_f32_16x16x32_bf16 v[184:187], a[212:215], v[22:25], v[184:187]
    v_exp_f32 v74, v74
    v_mfma_f32_16x16x32_bf16 v[136:139], a[212:215], v[16:19], v[136:139]
    v_exp_f32 v70, v70
    v_mfma_f32_16x16x32_bf16 v[140:143], a[216:219], v[16:19], v[140:143]
    s_waitcnt lgkmcnt(4)
    v_exp_f32 v78, v78
    v_mfma_f32_16x16x32_bf16 v[144:147], a[220:223], v[16:19], v[144:147]
    s_waitcnt lgkmcnt(3)
    v_exp_f32 v64, v64
    v_mfma_f32_16x16x32_bf16 v[148:151], a[224:227], v[16:19], v[148:151]
    v_exp_f32 v77, v77
    v_mfma_f32_16x16x32_bf16 v[196:199], a[224:227], v[22:25], v[196:199]
    v_exp_f32 v69, v69
    v_mfma_f32_16x16x32_bf16 v[192:195], a[220:223], v[22:25], v[192:195]
    s_waitcnt vmcnt(11) lgkmcnt(0)
    v_fma_f32 v83, v83, s28, v12
    v_cvt_pk_bf16_f32 v32, v76, v77
    v_mfma_f32_16x16x32_bf16 v[240:243], a[220:223], v[28:31], v[240:243]
    v_exp_f32 v58, v58
    v_mfma_f32_16x16x32_bf16 v[244:247], a[224:227], v[28:31], v[244:247]
    v_exp_f32 v57, v57
    v_mfma_f32_16x16x32_bf16 a[36:39], a[224:227], v[34:37], a[36:39]
    v_exp_f32 v66, v66
    v_mfma_f32_16x16x32_bf16 a[32:35], a[220:223], v[34:37], a[32:35]
    s_add_u32 m0, s22, 36864
    v_exp_f32 v90, v90
    v_mfma_f32_16x16x32_bf16 a[80:83], a[220:223], v[40:43], a[80:83]
    v_exp_f32 v67, v67
    v_mfma_f32_16x16x32_bf16 a[84:87], a[224:227], v[40:43], a[84:87]
    s_barrier
    v_mfma_f32_16x16x32_bf16 a[88:91], a[228:231], v[40:43], a[88:91]
    ds_read_b128 a[212:215], v0 offset:12288
    v_cvt_pk_bf16_f32 v39, v86, v87
    v_mfma_f32_16x16x32_bf16 a[92:95], a[232:235], v[40:43], a[92:95]
    ds_read_b128 a[216:219], v1 offset:12288
    v_mfma_f32_16x16x32_bf16 a[44:47], a[232:235], v[34:37], a[44:47]
    v_cvt_pk_bf16_f32 v33, v78, v79
    v_cvt_pk_bf16_f32 v27, v70, v71
    v_mfma_f32_16x16x32_bf16 a[40:43], a[228:231], v[34:37], a[40:43]
    buffer_load_dwordx4 v6, s[8:11], s21 offen lds
    v_mfma_f32_16x16x32_bf16 v[248:251], a[228:231], v[28:31], v[248:251]
    s_add_u32 s21, s21, 128
    v_exp_f32 v56, v56
    v_mfma_f32_16x16x32_bf16 v[252:255], a[232:235], v[28:31], v[252:255]
    ds_read_b128 a[220:223], v0 offset:13312
    v_fma_f32 v73, v73, s28, v11
    v_mfma_f32_16x16x32_bf16 v[204:207], a[232:235], v[22:25], v[204:207]
    s_add_u32 m0, s22, 37888
    v_exp_f32 v91, v91
    v_mfma_f32_16x16x32_bf16 v[200:203], a[228:231], v[22:25], v[200:203]
    buffer_load_dwordx4 v6, s[8:11], s21 offen lds
    v_mfma_f32_16x16x32_bf16 v[152:155], a[228:231], v[16:19], v[152:155]
    v_cvt_pk_bf16_f32 v26, v68, v69
    v_cvt_pk_bf16_f32 v38, v84, v85
    v_mfma_f32_16x16x32_bf16 v[156:159], a[232:235], v[16:19], v[156:159]
    s_add_u32 s21, s21, 128
    s_add_u32 m0, s22, 38912
    s_waitcnt lgkmcnt(2)
    v_mfma_f32_16x16x32_bf16 v[52:55], a[212:215], a[96:99], 0
    v_exp_f32 v83, v83
    v_mfma_f32_16x16x32_bf16 v[60:63], a[212:215], a[120:123], 0
    buffer_load_dwordx4 v6, s[8:11], s21 offen lds
    v_mfma_f32_16x16x32_bf16 v[68:71], a[212:215], a[144:147], 0
    v_mfma_f32_16x16x32_bf16 v[76:79], a[212:215], a[168:171], 0
    v_exp_f32 v59, v59
    v_mfma_f32_16x16x32_bf16 v[84:87], a[212:215], a[192:195], 0
    s_waitcnt lgkmcnt(1)
    v_exp_f32 v75, v75
    v_mfma_f32_16x16x32_bf16 v[52:55], a[216:219], a[100:103], v[52:55]
    ds_read_b128 a[224:227], v1 offset:13312
    v_cvt_pk_bf16_f32 v16, v56, v57
    v_mfma_f32_16x16x32_bf16 v[60:63], a[216:219], a[124:127], v[60:63]
    v_exp_f32 v82, v82
    v_mfma_f32_16x16x32_bf16 v[68:71], a[216:219], a[148:151], v[68:71]
    v_mfma_f32_16x16x32_bf16 v[76:79], a[216:219], a[172:175], v[76:79]
    v_fma_f32 v65, v65, s28, v10
    v_mfma_f32_16x16x32_bf16 v[84:87], a[216:219], a[196:199], v[84:87]
    s_waitcnt lgkmcnt(1)
    ds_read_b128 a[228:231], v0 offset:14336
    v_cvt_pk_bf16_f32 v17, v58, v59
    v_mfma_f32_16x16x32_bf16 v[52:55], a[220:223], a[104:107], v[52:55]
    v_exp_f32 v65, v65
    v_mfma_f32_16x16x32_bf16 v[60:63], a[220:223], a[128:131], v[60:63]
    v_exp_f32 v72, v72
    v_mfma_f32_16x16x32_bf16 v[68:71], a[220:223], a[152:155], v[68:71]
    v_mfma_f32_16x16x32_bf16 v[76:79], a[220:223], a[176:179], v[76:79]
    v_cvt_pk_bf16_f32 v41, v90, v91
    v_mfma_f32_16x16x32_bf16 v[84:87], a[220:223], a[200:203], v[84:87]
    v_exp_f32 v80, v80
    v_mfma_f32_16x16x32_bf16 v[44:47], a[236:239], v[14:17], v[48:51]
    s_waitcnt lgkmcnt(1)
    ds_read_b128 a[232:235], v1 offset:14336
    v_cvt_pk_bf16_f32 v22, v64, v65
    v_mfma_f32_16x16x32_bf16 v[52:55], a[224:227], a[108:111], v[52:55]
    v_exp_f32 v88, v88
    v_mfma_f32_16x16x32_bf16 v[60:63], a[224:227], a[132:135], v[60:63]
    v_exp_f32 v73, v73
    v_mfma_f32_16x16x32_bf16 v[68:71], a[224:227], a[156:159], v[68:71]
    v_cvt_pk_bf16_f32 v23, v66, v67
    v_cvt_pk_bf16_f32 v29, v74, v75
    v_mfma_f32_16x16x32_bf16 v[76:79], a[224:227], a[180:183], v[76:79]
    ds_read_b128 a[212:215], v0 offset:20480
    v_mfma_f32_16x16x32_bf16 v[84:87], a[224:227], a[204:207], v[84:87]
    s_waitcnt lgkmcnt(2)
    v_exp_f32 v89, v89
    v_mfma_f32_16x16x32_bf16 v[52:55], a[228:231], a[112:115], v[52:55]
    v_mfma_f32_16x16x32_bf16 v[60:63], a[228:231], a[136:139], v[60:63]
    v_cvt_pk_bf16_f32 v35, v82, v83
    v_cvt_pk_bf16_f32 v40, v88, v89
    v_mfma_f32_16x16x32_bf16 v[44:47], a[240:243], v[20:23], v[44:47]
    v_cvt_pk_bf16_f32 v28, v72, v73
    v_mfma_f32_16x16x32_bf16 v[68:71], a[228:231], a[160:163], v[68:71]
    s_nop 0
    v_mfma_f32_16x16x32_bf16 v[44:47], a[244:247], v[26:29], v[44:47]
    v_cvt_pk_bf16_f32 v34, v80, v81
    v_mfma_f32_16x16x32_bf16 v[76:79], a[228:231], a[184:187], v[76:79]
    s_nop 0
    v_mfma_f32_16x16x32_bf16 v[44:47], a[248:251], v[32:35], v[44:47]
    ds_read_b128 a[216:219], v1 offset:20480
    v_mfma_f32_16x16x32_bf16 v[44:47], a[252:255], v[38:41], v[44:47]
    ds_read_b128 a[220:223], v0 offset:18432
    v_mfma_f32_16x16x32_bf16 v[84:87], a[228:231], a[208:211], v[84:87]
    s_add_u32 s21, s21, 12032
    s_waitcnt lgkmcnt(2)
    v_mfma_f32_16x16x32_bf16 v[52:55], a[232:235], a[116:119], v[52:55]
    ds_read_b128 a[228:231], v0 offset:19456
    v_mfma_f32_16x16x32_bf16 v[60:63], a[232:235], a[140:143], v[60:63]
    s_nop 0
    v_cmp_lt_f32 vcc, s29, v44
    v_mfma_f32_16x16x32_bf16 v[68:71], a[232:235], a[164:167], v[68:71]
    ds_read_b128 a[224:227], v1 offset:18432
    v_mfma_f32_16x16x32_bf16 v[76:79], a[232:235], a[188:191], v[76:79]
    v_mfma_f32_16x16x32_bf16 v[84:87], a[232:235], v[92:95], v[84:87]
    ds_read_b128 a[232:235], v1 offset:19456
    v_mfma_f32_16x16x32_bf16 v[56:59], a[212:215], a[112:115], 0
    s_cbranch_vccnz L_rs_tr55a
L_ret_tr55a:
    v_fma_f32 v52, v52, s28, v9
    v_mfma_f32_16x16x32_bf16 v[64:67], a[212:215], a[136:139], 0
    v_fma_f32 v63, v63, s28, v10
    v_mfma_f32_16x16x32_bf16 v[72:75], a[212:215], a[160:163], 0
    v_exp_f32 v52, v52
    v_mfma_f32_16x16x32_bf16 v[80:83], a[212:215], a[184:187], 0
    v_fma_f32 v62, v62, s28, v10
    v_mfma_f32_16x16x32_bf16 v[88:91], a[212:215], a[208:211], 0
    s_waitcnt lgkmcnt(3)
    v_fma_f32 v54, v54, s28, v9
    v_mfma_f32_16x16x32_bf16 v[56:59], a[216:219], a[116:119], v[56:59]
    v_exp_f32 v54, v54
    v_mfma_f32_16x16x32_bf16 v[64:67], a[216:219], a[140:143], v[64:67]
    v_exp_f32 v63, v63
    v_mfma_f32_16x16x32_bf16 v[72:75], a[216:219], a[164:167], v[72:75]
    v_fma_f32 v61, v61, s28, v10
    v_fma_f32 v55, v55, s28, v9
    v_mfma_f32_16x16x32_bf16 v[80:83], a[216:219], a[188:191], v[80:83]
    v_fma_f32 v53, v53, s28, v9
    s_waitcnt vmcnt(7) lgkmcnt(0)
    v_mfma_f32_16x16x32_bf16 v[88:91], a[216:219], v[92:95], v[88:91]
    s_barrier
    v_mfma_f32_16x16x32_bf16 v[56:59], a[220:223], a[96:99], v[56:59]
    ds_read_b64_tr_b16 a[212:213], v2 offset:0
    s_add_u32 m0, s22, 12288
    v_mfma_f32_16x16x32_bf16 v[64:67], a[220:223], a[120:123], v[64:67]
    buffer_load_dwordx4 v6, s[4:7], s20 offen lds
    v_mfma_f32_16x16x32_bf16 v[72:75], a[220:223], a[144:147], v[72:75]
    s_add_u32 s20, s20, 128
    v_exp_f32 v62, v62
    v_mfma_f32_16x16x32_bf16 v[80:83], a[220:223], a[168:171], v[80:83]
    s_add_u32 m0, s22, 13312
    v_exp_f32 v53, v53
    v_mfma_f32_16x16x32_bf16 v[88:91], a[220:223], a[192:195], v[88:91]
    buffer_load_dwordx4 v6, s[4:7], s20 offen lds
    v_mfma_f32_16x16x32_bf16 v[56:59], a[224:227], a[100:103], v[56:59]
    ds_read_b64_tr_b16 a[214:215], v2 offset:6144
    v_mfma_f32_16x16x32_bf16 v[64:67], a[224:227], a[124:127], v[64:67]
    v_cvt_pk_bf16_f32 v18, v52, v53
    s_add_u32 s20, s20, 128
    v_mfma_f32_16x16x32_bf16 v[72:75], a[224:227], a[148:151], v[72:75]
    ds_read_b64_tr_b16 a[216:217], v3 offset:0
    v_mfma_f32_16x16x32_bf16 v[80:83], a[224:227], a[172:175], v[80:83]
    s_add_u32 m0, s22, 14336
    v_exp_f32 v61, v61
    v_mfma_f32_16x16x32_bf16 v[88:91], a[224:227], a[196:199], v[88:91]
    ds_read_b64_tr_b16 a[218:219], v3 offset:6144
    v_mfma_f32_16x16x32_bf16 v[56:59], a[228:231], a[104:107], v[56:59]
    buffer_load_dwordx4 v6, s[4:7], s20 offen lds
    v_mfma_f32_16x16x32_bf16 v[64:67], a[228:231], a[128:131], v[64:67]
    ds_read_b64_tr_b16 a[220:221], v4 offset:0
    v_fma_f32 v60, v60, s28, v10
    v_mfma_f32_16x16x32_bf16 v[72:75], a[228:231], a[152:155], v[72:75]
    v_exp_f32 v60, v60
    v_mfma_f32_16x16x32_bf16 v[80:83], a[228:231], a[176:179], v[80:83]
    v_exp_f32 v55, v55
    v_mfma_f32_16x16x32_bf16 v[88:91], a[228:231], a[200:203], v[88:91]
    ds_read_b64_tr_b16 a[222:223], v4 offset:6144
    v_mfma_f32_16x16x32_bf16 v[56:59], a[232:235], a[108:111], v[56:59]
    s_add_u32 s20, s20, 12032
    v_cvt_pk_bf16_f32 v24, v60, v61
    v_mfma_f32_16x16x32_bf16 v[64:67], a[232:235], a[132:135], v[64:67]
    ds_read_b64_tr_b16 a[224:225], v5 offset:0
    v_cvt_pk_bf16_f32 v25, v62, v63
    v_mfma_f32_16x16x32_bf16 v[72:75], a[232:235], a[156:159], v[72:75]
    ds_read_b64_tr_b16 a[226:227], v5 offset:6144
    v_cvt_pk_bf16_f32 v19, v54, v55
    v_mfma_f32_16x16x32_bf16 v[80:83], a[232:235], a[180:183], v[80:83]
    buffer_load_dwordx4 a[208:211], v96, s[12:15], s48 offen offset:256 nt
    v_mfma_f32_16x16x32_bf16 v[88:91], a[232:235], a[204:207], v[88:91]
    buffer_load_dwordx4 v[92:95], v96, s[12:15], s48 offen offset:320 nt
    v_fma_f32 v71, v71, s28, v11
    s_waitcnt lgkmcnt(4)
    v_mfma_f32_16x16x32_bf16 v[112:115], a[212:215], v[14:17], v[112:115]
    ds_read_b64_tr_b16 a[230:231], v2 offset:7168
    s_nop 0
    v_fma_f32 v83, v83, s28, v12
    v_fma_f32 v73, v73, s28, v11
    v_mfma_f32_16x16x32_bf16 v[116:119], a[216:219], v[14:17], v[116:119]
    ds_read_b64_tr_b16 a[228:229], v2 offset:1024
    v_and_b32 v104, 0x3ff, v0
    v_mfma_f32_16x16x32_bf16 v[164:167], a[216:219], v[20:23], v[164:167]
    v_lshrrev_b32 v105, 11, v0
    v_fma_f32 v81, v81, s28, v12
    v_mfma_f32_16x16x32_bf16 v[160:163], a[212:215], v[20:23], v[160:163]
    ds_read_b64_tr_b16 a[232:233], v3 offset:1024
    v_fma_f32 v79, v79, s28, v12
    v_mfma_f32_16x16x32_bf16 v[208:211], a[212:215], v[26:29], v[208:211]
    v_fma_f32 v84, v84, s28, v13
    v_fma_f32 v91, v91, s28, v13
    v_mfma_f32_16x16x32_bf16 v[212:215], a[216:219], v[26:29], v[212:215]
    v_fma_f32 v57, v57, s28, v9
    v_xor_b32 v105, s65, v105
    v_mfma_f32_16x16x32_bf16 a[4:7], a[216:219], v[32:35], a[4:7]
    ds_read_b64_tr_b16 a[234:235], v3 offset:7168
    v_fma_f32 v89, v89, s28, v13
    v_mfma_f32_16x16x32_bf16 a[0:3], a[212:215], v[32:35], a[0:3]
    v_fma_f32 v56, v56, s28, v9
    v_lshl_add_u32 v104, v105, 10, v104
    v_mfma_f32_16x16x32_bf16 a[48:51], a[212:215], v[38:41], a[48:51]
    v_fma_f32 v76, v76, s28, v12
    v_fma_f32 v68, v68, s28, v11
    v_mfma_f32_16x16x32_bf16 a[52:55], a[216:219], v[38:41], a[52:55]
    s_waitcnt lgkmcnt(4)
    ds_read_b64_tr_b16 a[216:217], v5 offset:1024
    v_fma_f32 v75, v75, s28, v11
    v_mfma_f32_16x16x32_bf16 a[56:59], a[220:223], v[38:41], a[56:59]
    v_fma_f32 v85, v85, s28, v13
    v_fma_f32 v77, v77, s28, v12
    v_mfma_f32_16x16x32_bf16 a[60:63], a[224:227], v[38:41], a[60:63]
    v_add_u32 v104, s38, v104
    v_fma_f32 v65, v65, s28, v10
    v_mfma_f32_16x16x32_bf16 a[12:15], a[224:227], v[32:35], a[12:15]
    ds_read_b128 a[152:155], v104 offset:14336
    v_fma_f32 v58, v58, s28, v9
    v_mfma_f32_16x16x32_bf16 a[8:11], a[220:223], v[32:35], a[8:11]
    ds_read_b128 a[144:147], v104 offset:12288
    v_fma_f32 v70, v70, s28, v11
    v_mfma_f32_16x16x32_bf16 v[216:219], a[220:223], v[26:29], v[216:219]
    v_exp_f32 v57, v57
    v_mfma_f32_16x16x32_bf16 v[220:223], a[224:227], v[26:29], v[220:223]
    ds_read_b64_tr_b16 a[212:213], v4 offset:1024
    v_xor_b32 v105, 64, v104
    v_mfma_f32_16x16x32_bf16 v[172:175], a[224:227], v[20:23], v[172:175]
    v_exp_f32 v85, v85
    v_mfma_f32_16x16x32_bf16 v[168:171], a[220:223], v[20:23], v[168:171]
    ds_read_b64_tr_b16 a[218:219], v5 offset:7168
    v_fma_f32 v72, v72, s28, v11
    v_mfma_f32_16x16x32_bf16 v[120:123], a[220:223], v[14:17], v[120:123]
    ds_read_b64_tr_b16 a[214:215], v4 offset:7168
    v_fma_f32 v87, v87, s28, v13
    v_mfma_f32_16x16x32_bf16 v[124:127], a[224:227], v[14:17], v[124:127]
    s_waitcnt lgkmcnt(5)
    v_exp_f32 v70, v70
    v_exp_f32 v58, v58
    v_mfma_f32_16x16x32_bf16 v[128:131], a[228:231], v[14:17], v[128:131]
    ds_read_b64_tr_b16 a[226:227], v3 offset:8192
    v_exp_f32 v77, v77
    v_mfma_f32_16x16x32_bf16 v[132:135], a[232:235], v[14:17], v[132:135]
    v_exp_f32 v56, v56
    v_mfma_f32_16x16x32_bf16 v[180:183], a[232:235], v[20:23], v[180:183]
    ds_read_b128 a[100:103], v105 offset:0
    v_exp_f32 v84, v84
    v_mfma_f32_16x16x32_bf16 v[176:179], a[228:231], v[20:23], v[176:179]
    ds_read_b128 a[184:187], v104 offset:22528
    v_fma_f32 v80, v80, s28, v12
    v_mfma_f32_16x16x32_bf16 v[224:227], a[228:231], v[26:29], v[224:227]
    v_exp_f32 v73, v73
    v_mfma_f32_16x16x32_bf16 v[228:231], a[232:235], v[26:29], v[228:231]
    v_exp_f32 v71, v71
    v_mfma_f32_16x16x32_bf16 a[20:23], a[232:235], v[32:35], a[20:23]
    ds_read_b128 a[120:123], v104 offset:6144
    v_fma_f32 v64, v64, s28, v10
    v_mfma_f32_16x16x32_bf16 a[16:19], a[228:231], v[32:35], a[16:19]
    ds_read_b64_tr_b16 a[222:223], v2 offset:8192
    v_fma_f32 v78, v78, s28, v12
    v_mfma_f32_16x16x32_bf16 a[64:67], a[228:231], v[38:41], a[64:67]
    ds_read_b64_tr_b16 a[220:221], v2 offset:2048
    v_fma_f32 v90, v90, s28, v13
    v_mfma_f32_16x16x32_bf16 a[68:71], a[232:235], v[38:41], a[68:71]
    s_waitcnt lgkmcnt(6)
    v_exp_f32 v76, v76
    v_mfma_f32_16x16x32_bf16 a[72:75], a[212:215], v[38:41], a[72:75]
    ds_read_b64_tr_b16 a[224:225], v3 offset:2048
    v_fma_f32 v59, v59, s28, v9
    v_mfma_f32_16x16x32_bf16 a[76:79], a[216:219], v[38:41], a[76:79]
    ds_read_b64_tr_b16 a[228:229], v4 offset:2048
    v_cvt_pk_bf16_f32 v31, v70, v71
    v_mfma_f32_16x16x32_bf16 a[28:31], a[216:219], v[32:35], a[28:31]
    v_exp_f32 v87, v87
    v_mfma_f32_16x16x32_bf16 a[24:27], a[212:215], v[32:35], a[24:27]
    ds_read_b64_tr_b16 a[234:235], v5 offset:8192
    v_fma_f32 v66, v66, s28, v10
    v_mfma_f32_16x16x32_bf16 v[232:235], a[212:215], v[26:29], v[232:235]
    s_add_u32 s39, s39, 12288
    ds_read_b128 a[96:99], v104 offset:0
    v_cvt_pk_bf16_f32 v36, v76, v77
    v_mfma_f32_16x16x32_bf16 v[236:239], a[216:219], v[26:29], v[236:239]
    ds_read_b64_tr_b16 a[230:231], v4 offset:8192
    v_fma_f32 v82, v82, s28, v12
    v_mfma_f32_16x16x32_bf16 v[188:191], a[216:219], v[20:23], v[188:191]
    ds_read_b64_tr_b16 a[232:233], v5 offset:2048
    v_fma_f32 v74, v74, s28, v11
    v_mfma_f32_16x16x32_bf16 v[184:187], a[212:215], v[20:23], v[184:187]
    ds_read_b128 a[148:151], v105 offset:12288
    v_fma_f32 v86, v86, s28, v13
    v_mfma_f32_16x16x32_bf16 v[136:139], a[212:215], v[14:17], v[136:139]
    v_exp_f32 v64, v64
    v_mfma_f32_16x16x32_bf16 v[140:143], a[216:219], v[14:17], v[140:143]
    s_waitcnt lgkmcnt(7)
    v_exp_f32 v68, v68
    v_mfma_f32_16x16x32_bf16 v[144:147], a[220:223], v[14:17], v[144:147]
    s_waitcnt lgkmcnt(6)
    ds_read_b128 a[116:119], v105 offset:4096
    v_fma_f32 v67, v67, s28, v10
    v_mfma_f32_16x16x32_bf16 v[148:151], a[224:227], v[14:17], v[148:151]
    v_exp_f32 v72, v72
    v_mfma_f32_16x16x32_bf16 v[196:199], a[224:227], v[20:23], v[196:199]
    v_exp_f32 v66, v66
    v_mfma_f32_16x16x32_bf16 v[192:195], a[220:223], v[20:23], v[192:195]
    v_exp_f32 v79, v79
    v_mfma_f32_16x16x32_bf16 v[240:243], a[220:223], v[26:29], v[240:243]
    v_exp_f32 v65, v65
    v_mfma_f32_16x16x32_bf16 v[244:247], a[224:227], v[26:29], v[244:247]
    v_exp_f32 v78, v78
    v_mfma_f32_16x16x32_bf16 a[36:39], a[224:227], v[32:35], a[36:39]
    s_waitcnt vmcnt(9) lgkmcnt(2)
    v_exp_f32 v86, v86
    v_mfma_f32_16x16x32_bf16 a[32:35], a[220:223], v[32:35], a[32:35]
    s_add_u32 s21, s21, s62
    ds_read_b128 a[192:195], v104 offset:24576
    v_exp_f32 v59, v59
    v_mfma_f32_16x16x32_bf16 a[80:83], a[220:223], v[38:41], a[80:83]
    ds_read_b128 a[172:175], v105 offset:18432
    v_cvt_pk_bf16_f32 v37, v78, v79
    v_mfma_f32_16x16x32_bf16 a[84:87], a[224:227], v[38:41], a[84:87]
    s_barrier
    ds_read_b128 a[212:215], v0 offset:0
    v_mfma_f32_16x16x32_bf16 a[88:91], a[228:231], v[38:41], a[88:91]
    s_add_u32 m0, s22, 24576
    ds_read_b128 a[168:171], v104 offset:18432
    buffer_load_dwordx4 v6, s[8:11], s21 offen lds
    v_mfma_f32_16x16x32_bf16 a[92:95], a[232:235], v[38:41], a[92:95]
    ds_read_b128 a[108:111], v105 offset:2048
    v_cvt_pk_bf16_f32 v42, v84, v85
    v_mfma_f32_16x16x32_bf16 a[44:47], a[232:235], v[32:35], a[44:47]
    s_add_u32 s21, s21, 128
    ds_read_b128 a[128:131], v104 offset:8192
    v_fma_f32 v69, v69, s28, v11
    v_mfma_f32_16x16x32_bf16 a[40:43], a[228:231], v[32:35], a[40:43]
    ds_read_b128 a[216:219], v1 offset:0
    v_cvt_pk_bf16_f32 v43, v86, v87
    v_mfma_f32_16x16x32_bf16 v[248:251], a[228:231], v[26:29], v[248:251]
    s_add_u32 m0, s22, 25600
    v_exp_f32 v69, v69
    v_mfma_f32_16x16x32_bf16 v[252:255], a[232:235], v[26:29], v[252:255]
    buffer_load_dwordx4 v6, s[8:11], s21 offen lds
    ds_read_b128 a[200:203], v104 offset:26624
    v_mfma_f32_16x16x32_bf16 v[204:207], a[232:235], v[20:23], v[204:207]
    s_add_u32 s21, s21, 128
    ds_read_b128 a[104:107], v104 offset:2048
    v_exp_f32 v67, v67
    v_mfma_f32_16x16x32_bf16 v[200:203], a[228:231], v[20:23], v[200:203]
    s_add_u32 m0, s22, 26624
    ds_read_b128 a[124:127], v105 offset:6144
    buffer_load_dwordx4 v6, s[8:11], s21 offen lds
    v_mfma_f32_16x16x32_bf16 v[152:155], a[228:231], v[14:17], v[152:155]
    ds_read_b128 a[220:223], v0 offset:1024
    v_cvt_pk_bf16_f32 v30, v68, v69
    v_mfma_f32_16x16x32_bf16 v[156:159], a[232:235], v[14:17], v[156:159]
    s_waitcnt lgkmcnt(7)
    ds_read_b128 a[196:199], v105 offset:24576
    v_cvt_pk_bf16_f32 v17, v58, v59
    v_mfma_f32_16x16x32_bf16 v[52:55], a[212:215], a[96:99], 0
    ds_read_b128 a[132:135], v105 offset:8192
    v_cvt_pk_bf16_f32 v16, v56, v57
    v_mfma_f32_16x16x32_bf16 v[60:63], a[212:215], a[120:123], 0
    ds_read_b128 a[140:143], v105 offset:10240
    v_fma_f32 v88, v88, s28, v13
    v_mfma_f32_16x16x32_bf16 v[68:71], a[212:215], a[144:147], 0
    ds_read_b128 a[224:227], v1 offset:1024
    v_cvt_pk_bf16_f32 v28, v72, v73
    v_mfma_f32_16x16x32_bf16 v[48:51], a[236:239], v[16:19], v[44:47]
    ds_read_b128 a[180:183], v105 offset:20480
    v_cvt_pk_bf16_f32 v22, v64, v65
    v_mfma_f32_16x16x32_bf16 v[76:79], a[212:215], a[168:171], 0
    ds_read_b128 a[176:179], v104 offset:20480
    v_cvt_pk_bf16_f32 v23, v66, v67
    v_mfma_f32_16x16x32_bf16 v[84:87], a[212:215], a[192:195], 0
    s_waitcnt lgkmcnt(9)
    v_exp_f32 v90, v90
    v_mfma_f32_16x16x32_bf16 v[52:55], a[216:219], a[100:103], v[52:55]
    ds_read_b128 a[156:159], v105 offset:14336
    v_mfma_f32_16x16x32_bf16 v[48:51], a[240:243], v[22:25], v[48:51]
    s_waitcnt lgkmcnt(8)
    v_exp_f32 v75, v75
    v_mfma_f32_16x16x32_bf16 v[60:63], a[216:219], a[124:127], v[60:63]
    ds_read_b128 a[204:207], v105 offset:26624
    v_mfma_f32_16x16x32_bf16 v[68:71], a[216:219], a[148:151], v[68:71]
    v_exp_f32 v74, v74
    v_mfma_f32_16x16x32_bf16 v[76:79], a[216:219], a[172:175], v[76:79]
    s_waitcnt lgkmcnt(6)
    v_exp_f32 v91, v91
    v_mfma_f32_16x16x32_bf16 v[84:87], a[216:219], a[196:199], v[84:87]
    v_exp_f32 v82, v82
    v_mfma_f32_16x16x32_bf16 v[52:55], a[220:223], a[104:107], v[52:55]
    ds_read_b128 a[228:231], v0 offset:6144
    v_cvt_pk_bf16_f32 v29, v74, v75
    v_mfma_f32_16x16x32_bf16 v[60:63], a[220:223], a[128:131], v[60:63]
    v_exp_f32 v83, v83
    v_mfma_f32_16x16x32_bf16 v[68:71], a[220:223], a[152:155], v[68:71]
    s_waitcnt lgkmcnt(3)
    v_exp_f32 v89, v89
    v_mfma_f32_16x16x32_bf16 v[76:79], a[220:223], a[176:179], v[76:79]
    v_exp_f32 v88, v88
    v_mfma_f32_16x16x32_bf16 v[48:51], a[244:247], v[28:31], v[48:51]
    v_exp_f32 v80, v80
    v_mfma_f32_16x16x32_bf16 v[84:87], a[220:223], a[200:203], v[84:87]
    v_exp_f32 v81, v81
    v_mfma_f32_16x16x32_bf16 v[52:55], a[224:227], a[108:111], v[52:55]
    ds_read_b128 a[112:115], v104 offset:4096
    v_cvt_pk_bf16_f32 v35, v82, v83
    v_mfma_f32_16x16x32_bf16 v[60:63], a[224:227], a[132:135], v[60:63]
    s_waitcnt lgkmcnt(2)
    ds_read_b128 a[232:235], v1 offset:6144
    v_cvt_pk_bf16_f32 v34, v80, v81
    v_mfma_f32_16x16x32_bf16 v[68:71], a[224:227], a[156:159], v[68:71]
    ds_read_b128 a[188:191], v105 offset:22528
    v_mfma_f32_16x16x32_bf16 v[76:79], a[224:227], a[180:183], v[76:79]
    ds_read_b128 a[212:215], v0 offset:7168
    v_cvt_pk_bf16_f32 v40, v88, v89
    v_mfma_f32_16x16x32_bf16 v[48:51], a[248:251], v[34:37], v[48:51]
    v_cvt_pk_bf16_f32 v41, v90, v91
    v_mfma_f32_16x16x32_bf16 v[84:87], a[224:227], a[204:207], v[84:87]
    ds_read_b128 a[136:139], v104 offset:10240
    v_mfma_f32_16x16x32_bf16 v[48:51], a[252:255], v[40:43], v[48:51]
    s_waitcnt lgkmcnt(5)
    ds_read_b128 a[160:163], v104 offset:16384
    v_mfma_f32_16x16x32_bf16 v[56:59], a[228:231], a[96:99], 0
    v_mfma_f32_16x16x32_bf16 v[64:67], a[228:231], a[120:123], 0
    ds_read_b128 a[220:223], v0 offset:2048
    v_mfma_f32_16x16x32_bf16 v[72:75], a[228:231], a[144:147], 0
    v_mfma_f32_16x16x32_bf16 v[80:83], a[228:231], a[168:171], 0
    s_add_u32 s21, s21, 12032
    ds_read_b128 a[164:167], v105 offset:16384
    v_cmp_lt_f32 vcc, s29, v48
    v_mfma_f32_16x16x32_bf16 v[88:91], a[228:231], a[192:195], 0
    s_waitcnt lgkmcnt(6)
    ds_read_b128 a[216:219], v1 offset:7168
    v_mfma_f32_16x16x32_bf16 v[56:59], a[232:235], a[100:103], v[56:59]
    ds_read_b128 a[224:227], v1 offset:2048
    v_mfma_f32_16x16x32_bf16 v[64:67], a[232:235], a[124:127], v[64:67]
    s_cbranch_vccnz L_rs_tr55b
L_ret_tr55b:
    v_lshrrev_b32 v108, 11, v0
    v_mfma_f32_16x16x32_bf16 v[72:75], a[232:235], a[148:151], v[72:75]
    ds_read_b128 a[228:231], v0 offset:8192
    v_xor_b32 v108, s65, v108
    v_mfma_f32_16x16x32_bf16 v[80:83], a[232:235], a[172:175], v[80:83]
    v_mov_b32 v100, v48
    v_mfma_f32_16x16x32_bf16 v[88:91], a[232:235], a[196:199], v[88:91]
    s_waitcnt lgkmcnt(5)
    ds_read_b128 a[232:235], v1 offset:8192
    v_and_b32 v101, 0x3ff, v0
    v_mfma_f32_16x16x32_bf16 v[56:59], a[212:215], a[104:107], v[56:59]
    v_lshl_add_u32 v101, v108, 10, v101
    v_mbcnt_lo_u32_b32 v108, -1, 0
    v_mfma_f32_16x16x32_bf16 v[64:67], a[212:215], a[128:131], v[64:67]
    v_mfma_f32_16x16x32_bf16 v[72:75], a[212:215], a[152:155], v[72:75]
    v_rcp_f32 v102, v49
    v_mfma_f32_16x16x32_bf16 v[80:83], a[212:215], a[176:179], v[80:83]
    v_mfma_f32_16x16x32_bf16 v[88:91], a[212:215], a[200:203], v[88:91]
    s_waitcnt vmcnt(3)
    v_add_u32 v101, s38, v101
    s_waitcnt lgkmcnt(3)
    v_mfma_f32_16x16x32_bf16 v[56:59], a[216:219], a[108:111], v[56:59]
    v_mfma_f32_16x16x32_bf16 v[64:67], a[216:219], a[132:135], v[64:67]
    v_mfma_f32_16x16x32_bf16 v[72:75], a[216:219], a[156:159], v[72:75]
    v_mfma_f32_16x16x32_bf16 v[80:83], a[216:219], a[180:183], v[80:83]
    s_waitcnt vmcnt(8) lgkmcnt(0)
    v_mfma_f32_16x16x32_bf16 v[88:91], a[216:219], a[204:207], v[88:91]
    s_barrier
    v_mfma_f32_16x16x32_bf16 v[52:55], a[220:223], a[112:115], v[52:55]
    s_add_u32 m0, s22, 0
    v_permlane32_swap_b32 v48, v100
    v_mfma_f32_16x16x32_bf16 v[60:63], a[220:223], a[136:139], v[60:63]
    buffer_load_dwordx4 v6, s[4:7], s20 offen lds
    v_mfma_f32_16x16x32_bf16 v[68:71], a[220:223], a[160:163], v[68:71]
    s_add_u32 s20, s20, 128
    s_add_u32 m0, s22, 1024
    v_mbcnt_hi_u32_b32 v108, -1, v108
    v_mfma_f32_16x16x32_bf16 v[76:79], a[220:223], a[184:187], v[76:79]
    buffer_load_dwordx4 v6, s[4:7], s20 offen lds
    v_mfma_f32_16x16x32_bf16 v[84:87], a[220:223], a[208:211], v[84:87]
    s_add_u32 s20, s20, 128
    ds_read_b64_tr_b16 a[212:213], v2 offset:18432
    v_mfma_f32_16x16x32_bf16 v[52:55], a[224:227], a[116:119], v[52:55]
    ds_read_b64_tr_b16 a[214:215], v2 offset:12288
    s_add_u32 m0, s22, 2048
    v_mfma_f32_16x16x32_bf16 v[60:63], a[224:227], a[140:143], v[60:63]
    ds_read_b64_tr_b16 a[216:217], v3 offset:18432
    v_lshrrev_b32 v108, 1, v108
    v_mfma_f32_16x16x32_bf16 v[68:71], a[224:227], a[164:167], v[68:71]
    buffer_load_dwordx4 v6, s[4:7], s20 offen lds
    v_mfma_f32_16x16x32_bf16 v[76:79], a[224:227], a[188:191], v[76:79]
    v_rcp_f32 v48, v48
    v_mfma_f32_16x16x32_bf16 v[84:87], a[224:227], v[92:95], v[84:87]
    ds_read_b64_tr_b16 a[218:219], v3 offset:12288
    v_and_b32 v108, 24, v108
    v_mfma_f32_16x16x32_bf16 v[56:59], a[228:231], a[112:115], v[56:59]
    ds_read_b64_tr_b16 a[220:221], v4 offset:18432
    v_bfe_u32 v108, s66, v108, 8
    v_mfma_f32_16x16x32_bf16 v[64:67], a[228:231], a[136:139], v[64:67]
    v_mfma_f32_16x16x32_bf16 v[72:75], a[228:231], a[160:163], v[72:75]
    ds_read_b64_tr_b16 a[222:223], v4 offset:12288
    v_xor_b32 v101, v101, v108
    v_mfma_f32_16x16x32_bf16 v[80:83], a[228:231], a[184:187], v[80:83]
    ds_read_b64_tr_b16 a[224:225], v5 offset:18432
    v_mov_b32 v108, v100
    v_mfma_f32_16x16x32_bf16 v[88:91], a[228:231], a[208:211], v[88:91]
    v_rcp_f32 v8, v51
    v_mfma_f32_16x16x32_bf16 v[56:59], a[232:235], a[116:119], v[56:59]
    v_rcp_f32 v50, v50
    v_mfma_f32_16x16x32_bf16 v[64:67], a[232:235], a[140:143], v[64:67]
    v_permlane16_swap_b32 v100, v108
    v_mfma_f32_16x16x32_bf16 v[72:75], a[232:235], a[164:167], v[72:75]
    v_rcp_f32 v100, v100
    v_mfma_f32_16x16x32_bf16 v[80:83], a[232:235], a[188:191], v[80:83]
    v_mfma_f32_16x16x32_bf16 v[88:91], a[232:235], v[92:95], v[88:91]
    ds_read_b64_tr_b16 a[226:227], v5 offset:12288
    s_add_u32 s20, s20, 12032
    v_max3_f32 v96, v52, v53, v54
    v_max3_f32 v96, v96, v55, v56
    v_max3_f32 v96, v96, v57, v58
    v_max3_f32 v98, v60, v61, v62
    v_max3_f32 v98, v98, v63, v64
    v_max3_f32 v98, v98, v65, v66
    s_waitcnt lgkmcnt(4)
    v_mfma_f32_16x16x32_bf16 v[112:115], a[212:215], v[16:19], v[112:115]
    v_max_f32 v96, v96, v59
    v_max_f32 v98, v98, v67
    v_mov_b32 v99, v98
    v_mov_b32 v97, v96
    v_mfma_f32_16x16x32_bf16 v[116:119], a[216:219], v[16:19], v[116:119]
    v_permlane32_swap_b32 v99, v98
    v_permlane32_swap_b32 v97, v96
    v_mfma_f32_16x16x32_bf16 v[164:167], a[216:219], v[22:25], v[164:167]
    s_mov_b32 s67, s34
    ds_read_b64_tr_b16 a[234:235], v3 offset:13312
    v_max_f32 v98, v98, v99
    v_mfma_f32_16x16x32_bf16 v[160:163], a[212:215], v[22:25], v[160:163]
    s_add_u32 s18, s34, 30720
    v_max_f32 v96, v96, v97
    v_mov_b32 v97, v96
    v_mfma_f32_16x16x32_bf16 v[208:211], a[212:215], v[28:31], v[208:211]
    s_mov_b32 s34, s33
    v_permlane16_swap_b32 v97, v96
    v_mfma_f32_16x16x32_bf16 v[212:215], a[216:219], v[28:31], v[212:215]
    ds_read_b64_tr_b16 a[232:233], v3 offset:19456
    v_mov_b32 v99, v98
    v_max_f32 v96, v96, v97
    v_mfma_f32_16x16x32_bf16 a[4:7], a[216:219], v[34:37], a[4:7]
    v_permlane16_swap_b32 v99, v98
    v_mul_f32_e64 v9, -s28, v96
    v_mfma_f32_16x16x32_bf16 a[0:3], a[212:215], v[34:37], a[0:3]
    s_add_u32 s64, s64, s62
    ds_read_b64_tr_b16 a[228:229], v2 offset:19456
    v_max3_f32 v96, v68, v69, v70
    v_mfma_f32_16x16x32_bf16 a[48:51], a[212:215], v[40:43], a[48:51]
    v_max3_f32 v96, v96, v71, v72
    v_max3_f32 v96, v96, v73, v74
    v_mfma_f32_16x16x32_bf16 a[52:55], a[216:219], v[40:43], a[52:55]
    s_waitcnt lgkmcnt(3)
    v_max_f32 v96, v96, v75
    v_mov_b32 v97, v96
    v_mfma_f32_16x16x32_bf16 a[56:59], a[220:223], v[40:43], a[56:59]
    ds_read_b64_tr_b16 a[230:231], v2 offset:13312
    v_permlane32_swap_b32 v97, v96
    v_max_f32 v96, v96, v97
    v_mfma_f32_16x16x32_bf16 a[60:63], a[224:227], v[40:43], a[60:63]
    v_mov_b32 v97, v96
    v_max_f32 v98, v98, v99
    v_accvgpr_read_b32 v104, a0
    v_mfma_f32_16x16x32_bf16 a[12:15], a[224:227], v[34:37], a[12:15]
    ds_read_b64_tr_b16 a[212:213], v4 offset:19456
    v_permlane16_swap_b32 v97, v96
    v_mfma_f32_16x16x32_bf16 a[8:11], a[220:223], v[34:37], a[8:11]
    s_add_u32 s64, s64, 196608
    ds_read_b64_tr_b16 a[218:219], v5 offset:13312
    v_mul_f32_e64 v10, -s28, v98
    v_mfma_f32_16x16x32_bf16 v[216:219], a[220:223], v[28:31], v[216:219]
    s_mov_b32 s39, s64
    v_fma_f32 v60, v60, s28, v10
    v_max3_f32 v98, v76, v77, v78
    v_max3_f32 v98, v98, v79, v80
    v_max_f32 v96, v96, v97
    v_mfma_f32_16x16x32_bf16 v[220:223], a[224:227], v[28:31], v[220:223]
    s_add_u32 s37, s37, 1
    ds_read_b64_tr_b16 a[214:215], v4 offset:13312
    v_max3_f32 v98, v98, v81, v82
    v_mfma_f32_16x16x32_bf16 v[172:175], a[224:227], v[22:25], v[172:175]
    s_bitcmp1_b32 s63, s37
    v_fma_f32 v62, v62, s28, v10
    v_max_f32 v98, v98, v83
    v_mfma_f32_16x16x32_bf16 v[168:171], a[220:223], v[22:25], v[168:171]
    s_cselect_b32 s62, 4294770688, 0
    v_mul_f32_e64 v11, -s28, v96
    v_max3_f32 v96, v84, v85, v86
    v_mfma_f32_16x16x32_bf16 v[120:123], a[220:223], v[16:19], v[120:123]
    s_cselect_b32 s42, 0, 325632
    ds_read_b64_tr_b16 a[216:217], v5 offset:19456
    v_fma_f32 v54, v54, s28, v9
    v_mfma_f32_16x16x32_bf16 v[124:127], a[224:227], v[16:19], v[124:127]
    s_waitcnt lgkmcnt(4)
    ds_read_b64_tr_b16 a[226:227], v3 offset:14336
    v_mov_b32 v99, v98
    v_exp_f32 v60, v60
    v_mfma_f32_16x16x32_bf16 v[128:131], a[228:231], v[16:19], v[128:131]
    s_add_u32 s35, s35, s42
    ds_read_b64_tr_b16 a[222:223], v2 offset:14336
    v_fma_f32 v63, v63, s28, v10
    v_fma_f32 v65, v65, s28, v10
    v_mfma_f32_16x16x32_bf16 v[132:135], a[232:235], v[16:19], v[132:135]
    v_max3_f32 v96, v96, v87, v88
    v_fma_f32 v55, v55, s28, v9
    v_mfma_f32_16x16x32_bf16 v[180:183], a[232:235], v[22:25], v[180:183]
    v_max3_f32 v96, v96, v89, v90
    v_exp_f32 v54, v54
    v_mfma_f32_16x16x32_bf16 v[176:179], a[228:231], v[22:25], v[176:179]
    s_lshl_b32 s42, s37, 1
    v_accvgpr_read_b32 v110, a50
    v_fma_f32 v71, v71, s28, v11
    v_mfma_f32_16x16x32_bf16 v[224:227], a[228:231], v[28:31], v[224:227]
    s_lshr_b32 s42, s31, s42
    v_fma_f32 v68, v68, s28, v11
    v_max_f32 v96, v96, v91
    v_mfma_f32_16x16x32_bf16 v[228:231], a[232:235], v[28:31], v[228:231]
    s_and_b32 s42, s42, 3
    ds_read_b64_tr_b16 a[220:221], v2 offset:20480
    v_fma_f32 v74, v74, s28, v11
    v_mov_b32 v97, v96
    v_mfma_f32_16x16x32_bf16 a[20:23], a[232:235], v[34:37], a[20:23]
    s_add_u32 s42, s42, s36
    v_permlane32_swap_b32 v99, v98
    v_mfma_f32_16x16x32_bf16 a[16:19], a[228:231], v[34:37], a[16:19]
    s_sub_u32 s43, s42, 3
    v_permlane32_swap_b32 v97, v96
    v_mfma_f32_16x16x32_bf16 a[64:67], a[228:231], v[40:43], a[64:67]
    s_cmp_ge_u32 s42, 3
    v_fma_f32 v61, v61, s28, v10
    v_max_f32 v96, v96, v97
    v_mfma_f32_16x16x32_bf16 a[68:71], a[232:235], v[40:43], a[68:71]
    s_waitcnt lgkmcnt(1)
    ds_read_b64_tr_b16 a[224:225], v3 offset:20480
    v_fma_f32 v75, v75, s28, v11
    v_mfma_f32_16x16x32_bf16 a[72:75], a[212:215], v[40:43], a[72:75]
    s_cselect_b32 s42, s43, s42
    v_exp_f32 v63, v63
    v_exp_f32 v61, v61
    v_mfma_f32_16x16x32_bf16 a[76:79], a[216:219], v[40:43], a[76:79]
    s_mul_i32 s44, s3, 5
    ds_read_b64_tr_b16 a[232:233], v5 offset:20480
    v_mov_b32 v97, v96
    v_max_f32 v98, v98, v99
    v_mfma_f32_16x16x32_bf16 a[28:31], a[216:219], v[34:37], a[28:31]
    s_mov_b32 s32, 1
    v_permlane16_swap_b32 v97, v96
    v_mfma_f32_16x16x32_bf16 a[24:27], a[212:215], v[34:37], a[24:27]
    s_lshl_b32 s43, s3, 2
    ds_read_b64_tr_b16 a[234:235], v5 offset:14336
    v_fma_f32 v53, v53, s28, v9
    v_mfma_f32_16x16x32_bf16 v[232:235], a[212:215], v[28:31], v[232:235]
    s_add_u32 s45, s43, 21
    v_fma_f32 v70, v70, s28, v11
    v_mov_b32 v99, v98
    v_mfma_f32_16x16x32_bf16 v[236:239], a[216:219], v[28:31], v[236:239]
    s_cmp_eq_u32 s3, 0
    v_exp_f32 v62, v62
    v_mfma_f32_16x16x32_bf16 v[188:191], a[216:219], v[22:25], v[188:191]
    s_cselect_b32 s45, 20, s45
    v_fma_f32 v59, v59, s28, v9
    v_fma_f32 v64, v64, s28, v10
    v_mfma_f32_16x16x32_bf16 v[184:187], a[212:215], v[22:25], v[184:187]
    s_cselect_b32 s33, 1, 0
    ds_read_b64_tr_b16 a[230:231], v4 offset:14336
    v_fma_f32 v52, v52, s28, v9
    v_mfma_f32_16x16x32_bf16 v[136:139], a[212:215], v[16:19], v[136:139]
    s_cmp_eq_u32 s42, 1
    v_exp_f32 v53, v53
    v_mfma_f32_16x16x32_bf16 v[140:143], a[216:219], v[16:19], v[140:143]
    s_waitcnt lgkmcnt(3)
    ds_read_b64_tr_b16 a[228:229], v4 offset:20480
    s_cselect_b32 s44, s45, s44
    v_mfma_f32_16x16x32_bf16 v[144:147], a[220:223], v[16:19], v[144:147]
    s_cselect_b32 s32, s33, s32
    v_exp_f32 v70, v70
    v_mfma_f32_16x16x32_bf16 v[148:151], a[224:227], v[16:19], v[148:151]
    s_add_u32 s45, s43, 37
    v_exp_f32 v52, v52
    v_mfma_f32_16x16x32_bf16 v[196:199], a[224:227], v[22:25], v[196:199]
    s_cmp_eq_u32 s42, 2
    v_permlane16_swap_b32 v99, v98
    v_mfma_f32_16x16x32_bf16 v[192:195], a[220:223], v[22:25], v[192:195]
    s_cselect_b32 s44, s45, s44
    v_exp_f32 v55, v55
    v_mfma_f32_16x16x32_bf16 v[240:243], a[220:223], v[28:31], v[240:243]
    s_cselect_b32 s32, 0, s32
    v_max_f32 v98, v98, v99
    s_mul_i32 s44, s44, 6144
    v_mfma_f32_16x16x32_bf16 v[244:247], a[224:227], v[28:31], v[244:247]
    s_add_u32 s33, s35, s44
    v_mul_f32_e64 v12, -s28, v98
    s_mul_i32 s42, s32, 6144
    v_fma_f32 v57, v57, s28, v9
    v_mfma_f32_16x16x32_bf16 a[36:39], a[224:227], v[34:37], a[36:39]
    s_add_u32 s42, s42, 24576
    v_fma_f32 v67, v67, s28, v10
    v_cvt_pk_bf16_f32 v15, v54, v55
    v_mfma_f32_16x16x32_bf16 a[32:35], a[220:223], v[34:37], a[32:35]
    s_add_u32 s42, s42, s33
    s_cmp_ge_u32 s37, 6
    v_max_f32 v96, v96, v97
    v_fma_f32 v78, v78, s28, v12
    v_mfma_f32_16x16x32_bf16 a[80:83], a[220:223], v[40:43], a[80:83]
    s_cselect_b32 s14, 0, s42
    v_exp_f32 v78, v78
    v_mfma_f32_16x16x32_bf16 a[84:87], a[224:227], v[40:43], a[84:87]
    s_waitcnt lgkmcnt(0)
    v_fma_f32 v66, v66, s28, v10
    v_mul_f32_e64 v13, -s28, v96
    v_fma_f32 v79, v79, s28, v12
    v_mfma_f32_16x16x32_bf16 a[88:91], a[228:231], v[40:43], a[88:91]
    s_add_u32 s24, s67, 256
    s_add_u32 s25, s33, 256
    v_fma_f32 v56, v56, s28, v9
    v_mfma_f32_16x16x32_bf16 a[92:95], a[232:235], v[40:43], a[92:95]
    s_add_u32 s23, s38, 4096
    v_exp_f32 v64, v64
    v_mfma_f32_16x16x32_bf16 a[44:47], a[232:235], v[34:37], a[44:47]
    s_mov_b32 s27, 0x249
    v_exp_f32 v68, v68
    v_mfma_f32_16x16x32_bf16 a[40:43], a[228:231], v[34:37], a[40:43]
    s_mov_b32 s30, 0
    v_fma_f32 v80, v80, s28, v12
    v_fma_f32 v81, v81, s28, v12
    s_waitcnt vmcnt(8)
    v_mfma_f32_16x16x32_bf16 v[248:251], a[228:231], v[28:31], v[248:251]
    s_barrier
    ds_read_b128 a[212:215], v0 offset:12288
    v_mfma_f32_16x16x32_bf16 v[252:255], a[232:235], v[28:31], v[252:255]
    ds_read_b128 a[216:219], v1 offset:12288
    v_fma_f32 v69, v69, s28, v11
    v_fma_f32 v87, v87, s28, v13
    v_mfma_f32_16x16x32_bf16 v[204:207], a[232:235], v[22:25], v[204:207]
    s_add_u32 m0, s22, 36864
    v_exp_f32 v67, v67
    v_mfma_f32_16x16x32_bf16 v[200:203], a[228:231], v[22:25], v[200:203]
    ds_read_b128 a[220:223], v0 offset:13312
    v_cvt_pk_bf16_f32 v20, v60, v61
    v_exp_f32 v75, v75
    v_fma_f32 v83, v83, s28, v12
    v_exp_f32 v74, v74
    v_pk_mul_f32 v[112:113], v[112:113], v[48:49] op_sel_hi:[1,0]
    v_fma_f32 v76, v76, s28, v12
    v_fma_f32 v84, v84, s28, v13
    v_exp_f32 v71, v71
    v_pk_mul_f32 v[208:209], v[208:209], v[50:51] op_sel_hi:[1,0]
    v_exp_f32 v65, v65
    v_cvt_pk_bf16_f32 v14, v52, v53
    v_fma_f32 v72, v72, s28, v11
    v_exp_f32 v66, v66
    v_cvt_pk_bf16_f32 v21, v62, v63
    v_accvgpr_read_b32 v111, a51
    v_exp_f32 v76, v76
    v_exp_f32 v69, v69
    v_mfma_f32_16x16x32_bf16 v[152:155], a[228:231], v[16:19], v[152:155]
    v_exp_f32 v79, v79
    v_exp_f32 v81, v81
    v_fma_f32 v73, v73, s28, v11
    v_cvt_pk_bf16_f32 v27, v70, v71
    v_mfma_f32_16x16x32_bf16 v[156:159], a[232:235], v[16:19], v[156:159]
    s_waitcnt lgkmcnt(1)
    v_fma_f32 v90, v90, s28, v13
    v_fma_f32 v85, v85, s28, v13
    v_fma_f32 v58, v58, s28, v9
    v_mfma_f32_16x16x32_bf16 v[52:55], a[212:215], a[96:99], 0
    ds_read_b128 a[228:231], v0 offset:14336
    v_fma_f32 v77, v77, s28, v12
    v_mfma_f32_16x16x32_bf16 v[52:55], a[216:219], a[100:103], v[52:55]
    s_waitcnt lgkmcnt(1)
    ds_read_b128 a[224:227], v1 offset:13312
    v_fma_f32 v86, v86, s28, v13
    v_mfma_f32_16x16x32_bf16 v[52:55], a[220:223], a[104:107], v[52:55]
    ds_read_b128 a[232:235], v1 offset:14336
    v_cvt_pk_bf16_f32 v26, v68, v69
    v_exp_f32 v77, v77
    v_cvt_pk_bf16_f32 v33, v78, v79
    v_mfma_f32_16x16x32_bf16 v[60:63], a[220:223], a[128:131], 0
    v_exp_f32 v86, v86
    v_mfma_f32_16x16x32_bf16 v[60:63], a[216:219], a[124:127], v[60:63]
    v_exp_f32 v87, v87
    v_mfma_f32_16x16x32_bf16 v[60:63], a[212:215], a[120:123], v[60:63]
    v_fma_f32 v89, v89, s28, v13
    v_cvt_pk_bf16_f32 v32, v76, v77
    v_mfma_f32_16x16x32_bf16 v[68:71], a[212:215], a[144:147], 0
    v_exp_f32 v85, v85
    v_mfma_f32_16x16x32_bf16 v[68:71], a[216:219], a[148:151], v[68:71]
    v_cvt_pk_bf16_f32 v39, v86, v87
    v_exp_f32 v84, v84
    v_mfma_f32_16x16x32_bf16 v[68:71], a[220:223], a[152:155], v[68:71]
    v_exp_f32 v56, v56
    v_mfma_f32_16x16x32_bf16 v[76:79], a[220:223], a[176:179], 0
    v_exp_f32 v57, v57
    v_cvt_pk_bf16_f32 v38, v84, v85
    v_mfma_f32_16x16x32_bf16 v[76:79], a[216:219], a[172:175], v[76:79]
    v_exp_f32 v73, v73
    v_mfma_f32_16x16x32_bf16 v[76:79], a[212:215], a[168:171], v[76:79]
    v_exp_f32 v80, v80
    v_mfma_f32_16x16x32_bf16 v[84:87], a[212:215], a[192:195], 0
    v_fma_f32 v91, v91, s28, v13
    v_fma_f32 v82, v82, s28, v12
    v_mfma_f32_16x16x32_bf16 v[84:87], a[216:219], a[196:199], v[84:87]
    buffer_load_dwordx4 v6, s[8:11], s21 offen lds
    v_mfma_f32_16x16x32_bf16 v[84:87], a[220:223], a[200:203], v[84:87]
    s_waitcnt lgkmcnt(0)
    v_exp_f32 v82, v82
    v_mfma_f32_16x16x32_bf16 v[84:87], a[224:227], a[204:207], v[84:87]
    v_exp_f32 v72, v72
    v_mfma_f32_16x16x32_bf16 v[84:87], a[228:231], a[208:211], v[84:87]
    v_exp_f32 v58, v58
    v_mfma_f32_16x16x32_bf16 v[84:87], a[232:235], v[92:95], v[84:87]
    s_add_u32 s21, s21, 128
    ds_read_b128 a[216:219], v1 offset:18432
    v_cvt_pk_bf16_f32 v22, v64, v65
    v_mfma_f32_16x16x32_bf16 v[76:79], a[232:235], a[188:191], v[76:79]
    v_accvgpr_read_b32 v107, a3
    v_cvt_pk_bf16_f32 v208, v208, v209
    v_mfma_f32_16x16x32_bf16 v[76:79], a[228:231], a[184:187], v[76:79]
    ds_read_b128 a[212:215], v0 offset:18432
    v_accvgpr_read_b32 v105, a1
    v_mfma_f32_16x16x32_bf16 v[76:79], a[224:227], a[180:183], v[76:79]
    v_exp_f32 v59, v59
    v_mfma_f32_16x16x32_bf16 v[68:71], a[224:227], a[156:159], v[68:71]
    v_cvt_pk_bf16_f32 v17, v58, v59
    v_accvgpr_read_b32 v106, a2
    v_mfma_f32_16x16x32_bf16 v[68:71], a[228:231], a[160:163], v[68:71]
    s_add_u32 m0, s22, 37888
    v_exp_f32 v90, v90
    v_mfma_f32_16x16x32_bf16 v[68:71], a[232:235], a[164:167], v[68:71]
    v_exp_f32 v91, v91
    v_mfma_f32_16x16x32_bf16 v[60:63], a[232:235], a[140:143], v[60:63]
    ds_read_b128 a[220:223], v0 offset:19456
    v_cvt_pk_bf16_f32 v16, v56, v57
    v_mfma_f32_16x16x32_bf16 v[60:63], a[228:231], a[136:139], v[60:63]
    v_cvt_pk_bf16_f32 v28, v72, v73
    v_cvt_pk_bf16_f32 v23, v66, v67
    v_mfma_f32_16x16x32_bf16 v[60:63], a[224:227], a[132:135], v[60:63]
    v_exp_f32 v83, v83
    v_accvgpr_read_b32 v109, a49
    v_fma_f32 v85, v85, s28, v13
    v_fma_f32 v71, v71, s28, v11
    v_pk_mul_f32 v[110:111], v[110:111], v[100:101] op_sel_hi:[1,0]
    v_pk_mul_f32 v[184:185], v[184:185], v[102:103] op_sel_hi:[1,0]
    v_pk_mul_f32 v[160:161], v[160:161], v[102:103] op_sel_hi:[1,0]
    v_pk_mul_f32 v[120:121], v[120:121], v[48:49] op_sel_hi:[1,0]
    v_pk_mul_f32 v[116:117], v[116:117], v[48:49] op_sel_hi:[1,0]
    v_pk_mul_f32 v[212:213], v[212:213], v[50:51] op_sel_hi:[1,0]
    v_pk_mul_f32 v[104:105], v[104:105], v[8:9] op_sel_hi:[1,0]
    v_cvt_pk_bf16_f32 v29, v74, v75
    v_accvgpr_read_b32 v108, a48
    v_mfma_f32_16x16x32_bf16 v[52:55], a[224:227], a[108:111], v[52:55]
    v_exp_f32 v89, v89
    v_mfma_f32_16x16x32_bf16 v[52:55], a[228:231], a[112:115], v[52:55]
    v_fma_f32 v69, v69, s28, v11
    v_cvt_pk_bf16_f32 v34, v80, v81
    v_mfma_f32_16x16x32_bf16 v[52:55], a[232:235], a[116:119], v[52:55]
    s_waitcnt lgkmcnt(1)
    ds_read_b128 a[224:227], v1 offset:19456
    v_fma_f32 v86, v86, s28, v13
    v_mfma_f32_16x16x32_bf16 v[56:59], a[212:215], a[96:99], 0
    v_fma_f32 v87, v87, s28, v13
    v_cvt_pk_bf16_f32 v35, v82, v83
    v_mfma_f32_16x16x32_bf16 v[56:59], a[216:219], a[100:103], v[56:59]
    s_waitcnt lgkmcnt(1)
    v_fma_f32 v84, v84, s28, v13
    v_fma_f32 v88, v88, s28, v13
    v_fma_f32 v70, v70, s28, v11
    v_mfma_f32_16x16x32_bf16 v[56:59], a[220:223], a[104:107], v[56:59]
    v_exp_f32 v86, v86
    v_mfma_f32_16x16x32_bf16 v[64:67], a[220:223], a[128:131], 0
    v_exp_f32 v85, v85
    v_mfma_f32_16x16x32_bf16 v[44:47], a[236:239], v[14:17], 0
    ds_read_b128 a[232:235], v1 offset:20480
    v_fma_f32 v76, v76, s28, v12
    v_cvt_pk_bf16_f32 v112, v112, v113
    v_mfma_f32_16x16x32_bf16 v[64:67], a[216:219], a[124:127], v[64:67]
    v_fma_f32 v52, v52, s28, v9
    v_cvt_pk_bf16_f32 v184, v184, v185
    v_mfma_f32_16x16x32_bf16 v[64:67], a[212:215], a[120:123], v[64:67]
    buffer_load_dwordx4 v6, s[8:11], s21 offen lds
    v_mfma_f32_16x16x32_bf16 v[72:75], a[212:215], a[144:147], 0
    s_add_u32 s21, s21, 128
    ds_read_b128 a[228:231], v0 offset:20480
    v_cvt_pk_bf16_f32 v104, v104, v105
    v_mfma_f32_16x16x32_bf16 v[72:75], a[216:219], a[148:151], v[72:75]
    s_add_u32 m0, s22, 38912
    v_exp_f32 v88, v88
    v_mfma_f32_16x16x32_bf16 v[72:75], a[220:223], a[152:155], v[72:75]
    v_fma_f32 v78, v78, s28, v12
    v_fma_f32 v53, v53, s28, v9
    v_mfma_f32_16x16x32_bf16 v[80:83], a[220:223], a[176:179], 0
    v_fma_f32 v55, v55, s28, v9
    v_fma_f32 v79, v79, s28, v12
    v_mfma_f32_16x16x32_bf16 v[44:47], a[240:243], v[20:23], v[44:47]
    buffer_load_dwordx4 v6, s[8:11], s21 offen lds
    v_mfma_f32_16x16x32_bf16 v[80:83], a[216:219], a[172:175], v[80:83]
    s_add_u32 s21, s21, 12032
    v_cvt_pk_bf16_f32 v212, v212, v213
    v_fma_f32 v77, v77, s28, v12
    v_mfma_f32_16x16x32_bf16 v[80:83], a[212:215], a[168:171], v[80:83]
    v_cvt_pk_bf16_f32 v41, v90, v91
    v_cvt_pk_bf16_f32 v40, v88, v89
    v_mfma_f32_16x16x32_bf16 v[88:91], a[212:215], a[192:195], 0
    v_exp_f32 v55, v55
    v_mfma_f32_16x16x32_bf16 v[88:91], a[216:219], a[196:199], v[88:91]
    v_cvt_pk_bf16_f32 v160, v160, v161
    v_fma_f32 v54, v54, s28, v9
    v_subrev_u32 v103, 28672, v103
    v_mfma_f32_16x16x32_bf16 v[88:91], a[220:223], a[200:203], v[88:91]
    s_waitcnt lgkmcnt(1)
    v_exp_f32 v52, v52
    v_mfma_f32_16x16x32_bf16 v[88:91], a[224:227], a[204:207], v[88:91]
    s_waitcnt vmcnt(6) lgkmcnt(0)
    v_exp_f32 v76, v76
    v_mfma_f32_16x16x32_bf16 v[88:91], a[228:231], a[208:211], v[88:91]
    s_barrier
    v_mfma_f32_16x16x32_bf16 v[88:91], a[232:235], v[92:95], v[88:91]
    v_exp_f32 v84, v84
    v_mfma_f32_16x16x32_bf16 v[80:83], a[232:235], a[188:191], v[80:83]
    v_exp_f32 v79, v79
    v_mfma_f32_16x16x32_bf16 v[80:83], a[228:231], a[184:187], v[80:83]
    s_add_u32 m0, s22, 12288
    ds_read_b64_tr_b16 a[212:213], v2 offset:0
    v_exp_f32 v69, v69
    v_mfma_f32_16x16x32_bf16 v[80:83], a[224:227], a[180:183], v[80:83]
    v_exp_f32 v53, v53
    v_mfma_f32_16x16x32_bf16 v[72:75], a[224:227], a[156:159], v[72:75]
    buffer_load_dwordx4 v6, s[4:7], s20 offen lds
    v_exp_f32 v87, v87
    v_cvt_pk_bf16_f32 v116, v116, v117
    v_pk_mul_f32 v[146:147], v[146:147], v[48:49] op_sel_hi:[1,0]
    v_pk_mul_f32 v[164:165], v[164:165], v[102:103] op_sel_hi:[1,0]
    v_pk_mul_f32 v[244:245], v[244:245], v[50:51] op_sel_hi:[1,0]
    v_pk_mul_f32 v[124:125], v[124:125], v[48:49] op_sel_hi:[1,0]
    v_pk_mul_f32 v[108:109], v[108:109], v[100:101] op_sel_hi:[1,0]
    v_pk_mul_f32 v[192:193], v[192:193], v[102:103] op_sel_hi:[1,0]
    v_pk_mul_f32 v[144:145], v[144:145], v[48:49] op_sel_hi:[1,0]
    v_pk_mul_f32 v[234:235], v[234:235], v[50:51] op_sel_hi:[1,0]
    v_pk_mul_f32 v[210:211], v[210:211], v[50:51] op_sel_hi:[1,0]
    v_pk_mul_f32 v[166:167], v[166:167], v[102:103] op_sel_hi:[1,0]
    v_pk_mul_f32 v[222:223], v[222:223], v[50:51] op_sel_hi:[1,0]
    v_pk_mul_f32 v[130:131], v[130:131], v[48:49] op_sel_hi:[1,0]
    v_exp_f32 v71, v71
    v_pk_mul_f32 v[200:201], v[200:201], v[102:103] op_sel_hi:[1,0]
    v_pk_mul_f32 v[148:149], v[148:149], v[48:49] op_sel_hi:[1,0]
    v_pk_mul_f32 v[242:243], v[242:243], v[50:51] op_sel_hi:[1,0]
    v_pk_mul_f32 v[236:237], v[236:237], v[50:51] op_sel_hi:[1,0]
    v_pk_mul_f32 v[220:221], v[220:221], v[50:51] op_sel_hi:[1,0]
    v_pk_mul_f32 v[232:233], v[232:233], v[50:51] op_sel_hi:[1,0]
    v_pk_mul_f32 v[140:141], v[140:141], v[48:49] op_sel_hi:[1,0]
    v_pk_mul_f32 v[114:115], v[114:115], v[48:49] op_sel_hi:[1,0]
    v_pk_mul_f32 v[106:107], v[106:107], v[8:9] op_sel_hi:[1,0]
    v_fma_f32 v90, v90, s28, v13
    v_pk_mul_f32 v[126:127], v[126:127], v[48:49] op_sel_hi:[1,0]
    v_pk_mul_f32 v[216:217], v[216:217], v[50:51] op_sel_hi:[1,0]
    v_pk_mul_f32 v[162:163], v[162:163], v[102:103] op_sel_hi:[1,0]
    v_pk_mul_f32 v[168:169], v[168:169], v[102:103] op_sel_hi:[1,0]
    v_pk_mul_f32 v[214:215], v[214:215], v[50:51] op_sel_hi:[1,0]
    v_pk_mul_f32 v[122:123], v[122:123], v[48:49] op_sel_hi:[1,0]
    v_pk_mul_f32 v[118:119], v[118:119], v[48:49] op_sel_hi:[1,0]
    v_cvt_pk_bf16_f32 v113, v114, v115
    v_cvt_pk_bf16_f32 v108, v108, v109
    v_pk_mul_f32 v[188:189], v[188:189], v[102:103] op_sel_hi:[1,0]
    v_fma_f32 v63, v63, s28, v10
    v_cvt_pk_bf16_f32 v161, v162, v163
    v_pk_mul_f32 v[170:171], v[170:171], v[102:103] op_sel_hi:[1,0]
    v_pk_mul_f32 v[172:173], v[172:173], v[102:103] op_sel_hi:[1,0]
    v_cvt_pk_bf16_f32 v105, v106, v107
    v_cvt_pk_bf16_f32 v209, v210, v211
    v_mfma_f32_16x16x32_bf16 v[44:47], a[244:247], v[26:29], v[44:47]
    ds_write2st64_b64 v101, v[112:113], v[160:161] offset0:0 offset1:12
    v_mfma_f32_16x16x32_bf16 v[72:75], a[228:231], a[160:163], v[72:75]
    v_cvt_pk_bf16_f32 v109, v110, v111
    v_cvt_pk_bf16_f32 v164, v164, v165
    v_mfma_f32_16x16x32_bf16 v[72:75], a[232:235], a[164:167], v[72:75]
    s_add_u32 s20, s20, 128
    ds_write2st64_b64 v101, v[208:209], v[104:105] offset0:24 offset1:36
    v_mfma_f32_16x16x32_bf16 v[64:67], a[232:235], a[140:143], v[64:67]
    v_accvgpr_read_b32 v105, a5
    v_fma_f32 v68, v68, s28, v11
    v_accvgpr_read_b32 v111, a55
    v_mfma_f32_16x16x32_bf16 v[64:67], a[228:231], a[136:139], v[64:67]
    ds_write_b64 v101, v[108:109] offset:24576
    v_accvgpr_read_b32 v109, a53
    v_cvt_pk_bf16_f32 v124, v124, v125
    v_cvt_pk_bf16_f32 v117, v118, v119
    v_mfma_f32_16x16x32_bf16 v[64:67], a[224:227], a[132:135], v[64:67]
    ds_read_b64_tr_b16 a[214:215], v2 offset:6144
    v_accvgpr_read_b32 v104, a4
    v_mfma_f32_16x16x32_bf16 v[56:59], a[224:227], a[108:111], v[56:59]
    ds_read_b64_tr_b16 a[216:217], v3 offset:0
    v_accvgpr_read_b32 v108, a52
    v_mfma_f32_16x16x32_bf16 v[56:59], a[228:231], a[112:115], v[56:59]
    s_add_u32 m0, s22, 13312
    ds_read_b64_tr_b16 a[218:219], v3 offset:6144
    v_xor_b32 v101, 32, v101
    v_cvt_pk_bf16_f32 v232, v232, v233
    v_cvt_pk_bf16_f32 v220, v220, v221
    v_accvgpr_read_b32 v106, a6
    v_accvgpr_read_b32 v107, a7
    v_pk_mul_f32 v[154:155], v[154:155], v[48:49] op_sel_hi:[1,0]
    v_accvgpr_read_b32 v110, a54
    v_pk_mul_f32 v[204:205], v[204:205], v[102:103] op_sel_hi:[1,0]
    v_pk_mul_f32 v[226:227], v[226:227], v[50:51] op_sel_hi:[1,0]
    v_fma_f32 v81, v81, s28, v12
    v_cvt_pk_bf16_f32 v213, v214, v215
    v_pk_mul_f32 v[110:111], v[110:111], v[100:101] op_sel_hi:[1,0]
    v_pk_mul_f32 v[108:109], v[108:109], v[100:101] op_sel_hi:[1,0]
    v_pk_mul_f32 v[224:225], v[224:225], v[50:51] op_sel_hi:[1,0]
    v_pk_mul_f32 v[198:199], v[198:199], v[102:103] op_sel_hi:[1,0]
    v_pk_mul_f32 v[142:143], v[142:143], v[48:49] op_sel_hi:[1,0]
    v_pk_mul_f32 v[128:129], v[128:129], v[48:49] op_sel_hi:[1,0]
    v_fma_f32 v88, v88, s28, v13
    v_pk_mul_f32 v[250:251], v[250:251], v[50:51] op_sel_hi:[1,0]
    v_cvt_pk_bf16_f32 v224, v224, v225
    v_fma_f32 v80, v80, s28, v12
    v_fma_f32 v61, v61, s28, v10
    v_cvt_pk_bf16_f32 v128, v128, v129
    v_cvt_pk_bf16_f32 v120, v120, v121
    v_pk_mul_f32 v[132:133], v[132:133], v[48:49] op_sel_hi:[1,0]
    v_pk_mul_f32 v[180:181], v[180:181], v[102:103] op_sel_hi:[1,0]
    v_cvt_pk_bf16_f32 v108, v108, v109
    v_pk_mul_f32 v[104:105], v[104:105], v[8:9] op_sel_hi:[1,0]
    v_pk_mul_f32 v[248:249], v[248:249], v[50:51] op_sel_hi:[1,0]
    v_pk_mul_f32 v[106:107], v[106:107], v[8:9] op_sel_hi:[1,0]
    v_pk_mul_f32 v[196:197], v[196:197], v[102:103] op_sel_hi:[1,0]
    v_cvt_pk_bf16_f32 v121, v122, v123
    v_pk_mul_f32 v[150:151], v[150:151], v[48:49] op_sel_hi:[1,0]
    v_cvt_pk_bf16_f32 v192, v192, v193
    v_cvt_pk_bf16_f32 v168, v168, v169
    v_cvt_pk_bf16_f32 v104, v104, v105
    v_fma_f32 v62, v62, s28, v10
    v_mfma_f32_16x16x32_bf16 v[56:59], a[232:235], a[116:119], v[56:59]
    ds_read_b64_tr_b16 a[220:221], v4 offset:0
    v_cvt_pk_bf16_f32 v248, v248, v249
    v_cvt_pk_bf16_f32 v105, v106, v107
    v_cvt_pk_bf16_f32 v221, v222, v223
    v_cvt_pk_bf16_f32 v165, v166, v167
    v_pk_mul_f32 v[174:175], v[174:175], v[102:103] op_sel_hi:[1,0]
    v_cvt_pk_bf16_f32 v109, v110, v111
    v_exp_f32 v78, v78
    v_exp_f32 v81, v81
    v_mfma_f32_16x16x32_bf16 v[44:47], a[248:251], v[32:35], v[44:47]
    s_waitcnt lgkmcnt(1)
    ds_write2st64_b64 v101, v[116:117], v[164:165] offset0:0 offset1:12
    v_pk_mul_f32 v[218:219], v[218:219], v[50:51] op_sel_hi:[1,0]
    v_cvt_pk_bf16_f32 v129, v130, v131
    s_nop 0
    v_mfma_f32_16x16x32_bf16 v[112:115], a[212:215], v[14:17], 0
    ds_read_b64_tr_b16 a[222:223], v4 offset:6144
    buffer_load_dwordx4 v6, s[4:7], s20 offen lds
    v_mfma_f32_16x16x32_bf16 v[116:119], a[216:219], v[14:17], 0
    ds_write2st64_b64 v101, v[212:213], v[104:105] offset0:24 offset1:36
    v_mfma_f32_16x16x32_bf16 v[44:47], a[252:255], v[38:41], v[44:47]
    ds_read_b64_tr_b16 a[228:229], v2 offset:1024
    v_cvt_pk_bf16_f32 v216, v216, v217
    v_mfma_f32_16x16x32_bf16 v[164:167], a[216:219], v[20:23], 0
    ds_write_b64 v101, v[108:109] offset:24576
    v_fma_f32 v60, v60, s28, v10
    v_xor_b32 v101, 96, v101
    v_cvt_pk_bf16_f32 v148, v148, v149
    v_pk_mul_f32 v[176:177], v[176:177], v[102:103] op_sel_hi:[1,0]
    v_pk_mul_f32 v[178:179], v[178:179], v[102:103] op_sel_hi:[1,0]
    v_accvgpr_read_b32 v108, a56
    v_accvgpr_read_b32 v106, a10
    v_pk_mul_f32 v[136:137], v[136:137], v[48:49] op_sel_hi:[1,0]
    v_fma_f32 v74, v74, s28, v11
    v_cvt_pk_bf16_f32 v169, v170, v171
    v_mfma_f32_16x16x32_bf16 v[160:163], a[212:215], v[20:23], 0
    ds_read_b64_tr_b16 a[224:225], v5 offset:0
    ds_read_b64_tr_b16 a[226:227], v5 offset:6144
    v_accvgpr_read_b32 v104, a8
    v_accvgpr_read_b32 v105, a9
    v_accvgpr_read_b32 v111, a59
    v_accvgpr_read_b32 v107, a11
    v_pk_mul_f32 v[246:247], v[246:247], v[50:51] op_sel_hi:[1,0]
    v_fma_f32 v65, v65, s28, v10
    v_pk_mul_f32 v[138:139], v[138:139], v[48:49] op_sel_hi:[1,0]
    v_cvt_pk_bf16_f32 v172, v172, v173
    v_accvgpr_read_b32 v110, a58
    v_pk_mul_f32 v[230:231], v[230:231], v[50:51] op_sel_hi:[1,0]
    v_accvgpr_read_b32 v109, a57
    v_cvt_pk_bf16_f32 v132, v132, v133
    v_mfma_f32_16x16x32_bf16 v[208:211], a[212:215], v[26:29], 0
    ds_write2st64_b64 v101, v[120:121], v[168:169] offset0:0 offset1:12
    v_pk_mul_f32 v[228:229], v[228:229], v[50:51] op_sel_hi:[1,0]
    v_pk_mul_f32 v[110:111], v[110:111], v[100:101] op_sel_hi:[1,0]
    v_pk_mul_f32 v[240:241], v[240:241], v[50:51] op_sel_hi:[1,0]
    v_pk_mul_f32 v[104:105], v[104:105], v[8:9] op_sel_hi:[1,0]
    v_pk_mul_f32 v[182:183], v[182:183], v[102:103] op_sel_hi:[1,0]
    v_fma_f32 v58, v58, s28, v9
    v_pk_mul_f32 v[106:107], v[106:107], v[8:9] op_sel_hi:[1,0]
    v_pk_mul_f32 v[108:109], v[108:109], v[100:101] op_sel_hi:[1,0]
    v_cvt_pk_bf16_f32 v104, v104, v105
    v_cvt_pk_bf16_f32 v233, v234, v235
    v_mfma_f32_16x16x32_bf16 v[212:215], a[216:219], v[26:29], 0
    ds_read_b64_tr_b16 a[232:233], v3 offset:1024
    v_cvt_pk_bf16_f32 v176, v176, v177
    v_cvt_pk_bf16_f32 v105, v106, v107
    v_mfma_f32_16x16x32_bf16 a[4:7], a[216:219], v[32:35], 0
    ds_read_b64_tr_b16 a[230:231], v2 offset:7168
    v_cvt_pk_bf16_f32 v217, v218, v219
    v_cvt_pk_bf16_f32 v196, v196, v197
    v_cvt_pk_bf16_f32 v136, v136, v137
    v_mfma_f32_16x16x32_bf16 a[0:3], a[212:215], v[32:35], 0
    ds_write2st64_b64 v101, v[216:217], v[104:105] offset0:24 offset1:36
    v_exp_f32 v62, v62
    v_pk_mul_f32 v[190:191], v[190:191], v[102:103] op_sel_hi:[1,0]
    v_accvgpr_read_b32 v106, a14
    v_cvt_pk_bf16_f32 v108, v108, v109
    v_cvt_pk_bf16_f32 v137, v138, v139
    v_accvgpr_read_b32 v107, a15
    v_cvt_pk_bf16_f32 v236, v236, v237
    v_pk_mul_f32 v[202:203], v[202:203], v[102:103] op_sel_hi:[1,0]
    v_cvt_pk_bf16_f32 v109, v110, v111
    v_accvgpr_read_b32 v104, a12
    v_accvgpr_read_b32 v105, a13
    v_cvt_pk_bf16_f32 v240, v240, v241
    v_cvt_pk_bf16_f32 v180, v180, v181
    v_pk_mul_f32 v[186:187], v[186:187], v[102:103] op_sel_hi:[1,0]
    v_pk_mul_f32 v[104:105], v[104:105], v[8:9] op_sel_hi:[1,0]
    v_cvt_pk_bf16_f32 v181, v182, v183
    v_fma_f32 v59, v59, s28, v9
    v_pk_mul_f32 v[106:107], v[106:107], v[8:9] op_sel_hi:[1,0]
    v_cvt_pk_bf16_f32 v140, v140, v141
    v_pk_mul_f32 v[238:239], v[238:239], v[50:51] op_sel_hi:[1,0]
    v_cvt_pk_bf16_f32 v125, v126, v127
    v_cvt_pk_bf16_f32 v104, v104, v105
    v_mfma_f32_16x16x32_bf16 a[48:51], a[212:215], v[38:41], 0
    ds_write_b64 v101, v[108:109] offset:24576
    v_accvgpr_read_b32 v110, a62
    v_cvt_pk_bf16_f32 v200, v200, v201
    v_cvt_pk_bf16_f32 v105, v106, v107
    v_accvgpr_read_b32 v111, a63
    v_mfma_f32_16x16x32_bf16 a[52:55], a[216:219], v[38:41], 0
    s_waitcnt lgkmcnt(1)
    ds_read_b64_tr_b16 a[234:235], v3 offset:7168
    v_accvgpr_read_b32 v107, a19
    v_mfma_f32_16x16x32_bf16 a[56:59], a[220:223], v[38:41], 0
    s_add_u32 s20, s20, 128
    ds_read_b64_tr_b16 a[214:215], v4 offset:7168
    v_accvgpr_read_b32 v108, a60
    v_xor_b32 v101, 32, v101
    v_cvt_pk_bf16_f32 v37, v78, v79
    v_cvt_pk_bf16_f32 v228, v228, v229
    v_pk_mul_f32 v[110:111], v[110:111], v[100:101] op_sel_hi:[1,0]
    v_cvt_pk_bf16_f32 v173, v174, v175
    v_cvt_pk_bf16_f32 v188, v188, v189
    v_fma_f32 v57, v57, s28, v9
    v_accvgpr_read_b32 v109, a61
    v_cvt_pk_bf16_f32 v177, v178, v179
    v_pk_mul_f32 v[108:109], v[108:109], v[100:101] op_sel_hi:[1,0]
    v_accvgpr_read_b32 v106, a18
    v_cvt_pk_bf16_f32 v108, v108, v109
    v_mfma_f32_16x16x32_bf16 a[60:63], a[224:227], v[38:41], 0
    ds_write2st64_b64 v101, v[124:125], v[172:173] offset0:0 offset1:12
    v_pk_mul_f32 v[134:135], v[134:135], v[48:49] op_sel_hi:[1,0]
    v_pk_mul_f32 v[106:107], v[106:107], v[8:9] op_sel_hi:[1,0]
    v_fma_f32 v91, v91, s28, v13
    v_cvt_pk_bf16_f32 v109, v110, v111
    v_mfma_f32_16x16x32_bf16 a[12:15], a[224:227], v[32:35], 0
    ds_write2st64_b64 v101, v[220:221], v[104:105] offset0:24 offset1:36
    v_mfma_f32_16x16x32_bf16 a[8:11], a[220:223], v[32:35], 0
    ds_read_b128 v[96:99], v103 offset:0
    v_cvt_pk_bf16_f32 v141, v142, v143
    v_accvgpr_read_b32 v111, a67
    v_accvgpr_read_b32 v105, a17
    v_mfma_f32_16x16x32_bf16 v[216:219], a[220:223], v[26:29], 0
    ds_write_b64 v101, v[108:109] offset:24576
    v_cvt_pk_bf16_f32 v225, v226, v227
    v_accvgpr_read_b32 v104, a16
    v_cvt_pk_bf16_f32 v237, v238, v239
    v_cvt_pk_bf16_f32 v133, v134, v135
    v_accvgpr_read_b32 v109, a65
    v_cvt_pk_bf16_f32 v201, v202, v203
    v_pk_mul_f32 v[254:255], v[254:255], v[50:51] op_sel_hi:[1,0]
    v_accvgpr_read_b32 v108, a64
    v_xor_b32 v101, 96, v101
    v_pk_mul_f32 v[104:105], v[104:105], v[8:9] op_sel_hi:[1,0]
    v_pk_mul_f32 v[156:157], v[156:157], v[48:49] op_sel_hi:[1,0]
    v_cvt_pk_bf16_f32 v144, v144, v145
    v_accvgpr_read_b32 v110, a66
    v_fma_f32 v64, v64, s28, v10
    v_pk_mul_f32 v[108:109], v[108:109], v[100:101] op_sel_hi:[1,0]
    v_cvt_pk_bf16_f32 v104, v104, v105
    v_pk_mul_f32 v[110:111], v[110:111], v[100:101] op_sel_hi:[1,0]
    v_cvt_pk_bf16_f32 v108, v108, v109
    v_cvt_pk_bf16_f32 v109, v110, v111
    v_cvt_pk_bf16_f32 v185, v186, v187
    v_accvgpr_read_b32 v111, a71
    v_mfma_f32_16x16x32_bf16 v[220:223], a[224:227], v[26:29], 0
    ds_write2st64_b64 v101, v[128:129], v[176:177] offset0:4 offset1:16
    v_mfma_f32_16x16x32_bf16 v[172:175], a[224:227], v[20:23], 0
    ds_read_b64_tr_b16 a[216:217], v5 offset:1024
    v_exp_f32 v61, v61
    v_exp_f32 v64, v64
    v_cvt_pk_bf16_f32 v249, v250, v251
    v_pk_mul_f32 v[194:195], v[194:195], v[102:103] op_sel_hi:[1,0]
    v_pk_mul_f32 v[252:253], v[252:253], v[50:51] op_sel_hi:[1,0]
    v_cvt_pk_bf16_f32 v229, v230, v231
    v_cvt_pk_bf16_f32 v105, v106, v107
    v_mfma_f32_16x16x32_bf16 v[168:171], a[220:223], v[20:23], 0
    ds_write2st64_b64 v101, v[224:225], v[104:105] offset0:28 offset1:40
    v_accvgpr_read_b32 v104, a20
    v_exp_f32 v58, v58
    v_mfma_f32_16x16x32_bf16 v[120:123], a[220:223], v[14:17], 0
    s_add_u32 m0, s22, 14336
    ds_write_b64 v101, v[108:109] offset:26624
    v_accvgpr_read_b32 v105, a21
    v_accvgpr_read_b32 v108, a68
    v_accvgpr_read_b32 v107, a23
    v_accvgpr_read_b32 v109, a69
    v_pk_mul_f32 v[206:207], v[206:207], v[102:103] op_sel_hi:[1,0]
    v_accvgpr_read_b32 v106, a22
    v_pk_mul_f32 v[106:107], v[106:107], v[8:9] op_sel_hi:[1,0]
    v_pk_mul_f32 v[108:109], v[108:109], v[100:101] op_sel_hi:[1,0]
    v_pk_mul_f32 v[104:105], v[104:105], v[8:9] op_sel_hi:[1,0]
    v_cvt_pk_bf16_f32 v193, v194, v195
    v_xor_b32 v101, 32, v101
    v_accvgpr_read_b32 v110, a70
    v_fma_f32 v89, v89, s28, v13
    v_pk_mul_f32 v[110:111], v[110:111], v[100:101] op_sel_hi:[1,0]
    v_fma_f32 v82, v82, s28, v12
    v_cvt_pk_bf16_f32 v241, v242, v243
    v_mfma_f32_16x16x32_bf16 v[124:127], a[224:227], v[14:17], 0
    buffer_load_dwordx4 v6, s[4:7], s20 offen lds
    ds_read_b64_tr_b16 a[212:213], v4 offset:1024
    v_cvt_pk_bf16_f32 v104, v104, v105
    v_cvt_pk_bf16_f32 v105, v106, v107
    v_accvgpr_read_b32 v106, a26
    v_cvt_pk_bf16_f32 v108, v108, v109
    v_pk_mul_f32 v[152:153], v[152:153], v[48:49] op_sel_hi:[1,0]
    v_cvt_pk_bf16_f32 v109, v110, v111
    v_accvgpr_read_b32 v107, a27
    v_mfma_f32_16x16x32_bf16 v[128:131], a[228:231], v[14:17], 0
    s_waitcnt lgkmcnt(2)
    ds_write2st64_b64 v101, v[132:133], v[180:181] offset0:4 offset1:16
    v_mfma_f32_16x16x32_bf16 v[132:135], a[232:235], v[14:17], 0
    ds_write2st64_b64 v101, v[228:229], v[104:105] offset0:28 offset1:40
    v_cvt_pk_bf16_f32 v145, v146, v147
    v_accvgpr_read_b32 v105, a25
    v_accvgpr_read_b32 v111, a75
    v_mfma_f32_16x16x32_bf16 v[180:183], a[232:235], v[20:23], 0
    s_add_u32 s20, s20, 12032
    ds_write_b64 v101, v[108:109] offset:26624
    v_accvgpr_read_b32 v110, a74
    v_mfma_f32_16x16x32_bf16 v[176:179], a[228:231], v[20:23], 0
    buffer_store_dwordx4 v[96:99], v6, s[16:19], s67 offen offset:0 nt
    s_nop 0
    ds_read_b128 v[96:99], v103 offset:1024
    v_accvgpr_read_b32 v109, a73
    v_pk_mul_f32 v[106:107], v[106:107], v[8:9] op_sel_hi:[1,0]
    v_accvgpr_read_b32 v108, a72
    v_cvt_pk_bf16_f32 v189, v190, v191
    v_xor_b32 v101, 96, v101
    v_mfma_f32_16x16x32_bf16 v[224:227], a[228:231], v[26:29], 0
    ds_write2st64_b64 v101, v[136:137], v[184:185] offset0:4 offset1:16
    v_pk_mul_f32 v[108:109], v[108:109], v[100:101] op_sel_hi:[1,0]
    v_fma_f32 v75, v75, s28, v11
    v_accvgpr_read_b32 v104, a24
    v_cvt_pk_bf16_f32 v244, v244, v245
    v_pk_mul_f32 v[110:111], v[110:111], v[100:101] op_sel_hi:[1,0]
    v_pk_mul_f32 v[104:105], v[104:105], v[8:9] op_sel_hi:[1,0]
    v_cvt_pk_bf16_f32 v204, v204, v205
    v_cvt_pk_bf16_f32 v104, v104, v105
    v_cvt_pk_bf16_f32 v105, v106, v107
    v_cvt_pk_bf16_f32 v108, v108, v109
    v_mfma_f32_16x16x32_bf16 v[228:231], a[232:235], v[26:29], 0
    ds_write2st64_b64 v101, v[232:233], v[104:105] offset0:28 offset1:40
    v_cvt_pk_bf16_f32 v109, v110, v111
    v_mfma_f32_16x16x32_bf16 a[20:23], a[232:235], v[32:35], 0
    ds_read_b64_tr_b16 a[218:219], v5 offset:7168
    v_accvgpr_read_b32 v107, a31
    v_accvgpr_read_b32 v106, a30
    v_accvgpr_read_b32 v105, a29
    v_accvgpr_read_b32 v111, a79
    v_mfma_f32_16x16x32_bf16 a[16:19], a[228:231], v[32:35], 0
    ds_write_b64 v101, v[108:109] offset:26624
    v_accvgpr_read_b32 v109, a77
    v_accvgpr_read_b32 v104, a28
    v_accvgpr_read_b32 v110, a78
    v_pk_mul_f32 v[104:105], v[104:105], v[8:9] op_sel_hi:[1,0]
    v_xor_b32 v101, 32, v101
    v_pk_mul_f32 v[110:111], v[110:111], v[100:101] op_sel_hi:[1,0]
    v_accvgpr_read_b32 v108, a76
    v_cvt_pk_bf16_f32 v152, v152, v153
    v_cvt_pk_bf16_f32 v149, v150, v151
    v_cvt_pk_bf16_f32 v156, v156, v157
    v_cvt_pk_bf16_f32 v43, v86, v87
    v_pk_mul_f32 v[108:109], v[108:109], v[100:101] op_sel_hi:[1,0]
    v_cvt_pk_bf16_f32 v104, v104, v105
    v_pk_mul_f32 v[106:107], v[106:107], v[8:9] op_sel_hi:[1,0]
    v_cvt_pk_bf16_f32 v108, v108, v109
    v_cvt_pk_bf16_f32 v105, v106, v107
    v_mfma_f32_16x16x32_bf16 a[64:67], a[228:231], v[38:41], 0
    ds_write2st64_b64 v101, v[140:141], v[188:189] offset0:4 offset1:16
    v_mfma_f32_16x16x32_bf16 a[68:71], a[232:235], v[38:41], 0
    s_waitcnt lgkmcnt(3)
    ds_write2st64_b64 v101, v[236:237], v[104:105] offset0:28 offset1:40
    v_mfma_f32_16x16x32_bf16 a[72:75], a[212:215], v[38:41], 0
    s_waitcnt lgkmcnt(3)
    ds_read_b64_tr_b16 a[234:235], v5 offset:8192
    v_accvgpr_read_b32 v105, a33
    v_mfma_f32_16x16x32_bf16 a[76:79], a[216:219], v[38:41], 0
    ds_read_b64_tr_b16 a[222:223], v2 offset:8192
    v_accvgpr_read_b32 v104, a32
    v_cvt_pk_bf16_f32 v109, v110, v111
    v_accvgpr_read_b32 v110, a82
    v_mfma_f32_16x16x32_bf16 a[28:31], a[216:219], v[32:35], 0
    ds_read_b64_tr_b16 a[232:233], v5 offset:2048
    ds_read_b64_tr_b16 a[230:231], v4 offset:8192
    v_cvt_pk_bf16_f32 v153, v154, v155
    v_mfma_f32_16x16x32_bf16 a[24:27], a[212:215], v[32:35], 0
    s_add_u32 s39, s39, 12288
    ds_read_b64_tr_b16 a[220:221], v2 offset:2048
    ds_read_b64_tr_b16 a[224:225], v3 offset:2048
    v_accvgpr_read_b32 v107, a35
    v_mfma_f32_16x16x32_bf16 v[232:235], a[212:215], v[26:29], 0
    ds_write_b64 v101, v[108:109] offset:26624
    v_mfma_f32_16x16x32_bf16 v[236:239], a[216:219], v[26:29], 0
    ds_read_b64_tr_b16 a[228:229], v4 offset:2048
    ds_read_b64_tr_b16 a[226:227], v3 offset:8192
    v_accvgpr_read_b32 v106, a34
    v_cvt_pk_bf16_f32 v252, v252, v253
    v_accvgpr_read_b32 v108, a80
    v_fma_f32 v72, v72, s28, v11
    v_exp_f32 v54, v54
    v_accvgpr_read_b32 v111, a83
    v_pk_mul_f32 v[104:105], v[104:105], v[8:9] op_sel_hi:[1,0]
    v_accvgpr_read_b32 v109, a81
    v_pk_mul_f32 v[106:107], v[106:107], v[8:9] op_sel_hi:[1,0]
    v_cvt_pk_bf16_f32 v197, v198, v199
    v_xor_b32 v101, 96, v101
    v_pk_mul_f32 v[108:109], v[108:109], v[100:101] op_sel_hi:[1,0]
    v_pk_mul_f32 v[110:111], v[110:111], v[100:101] op_sel_hi:[1,0]
    v_cvt_pk_bf16_f32 v104, v104, v105
    v_cvt_pk_bf16_f32 v108, v108, v109
    v_mfma_f32_16x16x32_bf16 v[188:191], a[216:219], v[20:23], 0
    ds_write2st64_b64 v101, v[144:145], v[192:193] offset0:8 offset1:20
    v_fma_f32 v66, v66, s28, v10
    v_cvt_pk_bf16_f32 v109, v110, v111
    v_cvt_pk_bf16_f32 v105, v106, v107
    v_mfma_f32_16x16x32_bf16 v[184:187], a[212:215], v[20:23], 0
    ds_write2st64_b64 v101, v[240:241], v[104:105] offset0:32 offset1:44
    v_accvgpr_read_b32 v104, a36
    v_accvgpr_read_b32 v107, a39
    v_accvgpr_read_b32 v105, a37
    v_accvgpr_read_b32 v106, a38
    v_mfma_f32_16x16x32_bf16 v[136:139], a[212:215], v[14:17], 0
    s_waitcnt vmcnt(7) lgkmcnt(2)
    ds_write_b64 v101, v[108:109] offset:0
    v_mfma_f32_16x16x32_bf16 v[140:143], a[216:219], v[14:17], 0
    buffer_store_dwordx4 v[96:99], v7, s[16:19], s67 offen offset:0 nt
    s_barrier
    v_accvgpr_read_b32 v108, a84
    v_pk_mul_f32 v[104:105], v[104:105], v[8:9] op_sel_hi:[1,0]
    v_accvgpr_read_b32 v111, a87
    v_exp_f32 v60, v60
    v_xor_b32 v101, 32, v101
    v_accvgpr_read_b32 v109, a85
    v_pk_mul_f32 v[106:107], v[106:107], v[8:9] op_sel_hi:[1,0]
    v_exp_f32 v70, v70
    v_pk_mul_f32 v[108:109], v[108:109], v[100:101] op_sel_hi:[1,0]
    v_accvgpr_read_b32 v110, a86
    v_cvt_pk_bf16_f32 v108, v108, v109
    v_cvt_pk_bf16_f32 v245, v246, v247
    v_cvt_pk_bf16_f32 v104, v104, v105
    v_mfma_f32_16x16x32_bf16 v[144:147], a[220:223], v[14:17], 0
    s_add_u32 m0, s22, 24576
    ds_write2st64_b64 v101, v[148:149], v[196:197] offset0:8 offset1:20
    v_pk_mul_f32 v[110:111], v[110:111], v[100:101] op_sel_hi:[1,0]
    v_cvt_pk_bf16_f32 v105, v106, v107
    v_pk_mul_f32 v[158:159], v[158:159], v[48:49] op_sel_hi:[1,0]
    v_accvgpr_read_b32 v106, a42
    v_cvt_pk_bf16_f32 v19, v54, v55
    v_mfma_f32_16x16x32_bf16 v[148:151], a[224:227], v[14:17], 0
    buffer_load_dwordx4 v6, s[8:11], s21 offen lds
    ds_write2st64_b64 v101, v[244:245], v[104:105] offset0:32 offset1:44
    v_cvt_pk_bf16_f32 v109, v110, v111
    v_mfma_f32_16x16x32_bf16 v[196:199], a[224:227], v[20:23], 0
    s_add_u32 s21, s21, 128
    ds_write_b64 v101, v[108:109] offset:0
    v_mfma_f32_16x16x32_bf16 v[192:195], a[220:223], v[20:23], 0
    s_add_u32 m0, s22, 25600
    v_accvgpr_read_b32 v107, a43
    v_accvgpr_read_b32 v105, a41
    v_accvgpr_read_b32 v111, a91
    v_mfma_f32_16x16x32_bf16 v[240:243], a[220:223], v[26:29], 0
    ds_read_b128 v[96:99], v103 offset:2048
    v_accvgpr_read_b32 v109, a89
    v_mfma_f32_16x16x32_bf16 v[244:247], a[224:227], v[26:29], 0
    ds_read_b128 a[216:219], v1 offset:0
    buffer_load_dwordx4 v6, s[8:11], s21 offen lds
    v_accvgpr_read_b32 v110, a90
    v_exp_f32 v59, v59
    v_accvgpr_read_b32 v104, a40
    v_accvgpr_read_b32 v108, a88
    v_pk_mul_f32 v[110:111], v[110:111], v[100:101] op_sel_hi:[1,0]
    v_pk_mul_f32 v[106:107], v[106:107], v[8:9] op_sel_hi:[1,0]
    v_pk_mul_f32 v[104:105], v[104:105], v[8:9] op_sel_hi:[1,0]
    v_pk_mul_f32 v[108:109], v[108:109], v[100:101] op_sel_hi:[1,0]
    v_xor_b32 v101, 96, v101
    v_cvt_pk_bf16_f32 v108, v108, v109
    v_cvt_pk_bf16_f32 v157, v158, v159
    v_mfma_f32_16x16x32_bf16 a[36:39], a[224:227], v[32:35], 0
    ds_read_b128 a[212:215], v0 offset:0
    v_cvt_pk_bf16_f32 v104, v104, v105
    v_cvt_pk_bf16_f32 v109, v110, v111
    v_cvt_pk_bf16_f32 v105, v106, v107
    v_accvgpr_read_b32 v106, a46
    v_cvt_pk_bf16_f32 v31, v70, v71
    v_mfma_f32_16x16x32_bf16 a[32:35], a[220:223], v[32:35], 0
    s_add_u32 s21, s21, 128
    ds_write2st64_b64 v101, v[152:153], v[200:201] offset0:8 offset1:20
    v_mfma_f32_16x16x32_bf16 a[80:83], a[220:223], v[38:41], 0
    s_add_u32 m0, s22, 26624
    ds_write2st64_b64 v101, v[248:249], v[104:105] offset0:32 offset1:44
    v_accvgpr_read_b32 v110, a94
    v_accvgpr_read_b32 v105, a45
    v_mfma_f32_16x16x32_bf16 a[84:87], a[224:227], v[38:41], 0
    buffer_load_dwordx4 v6, s[8:11], s21 offen lds
    v_fma_f32 v67, v67, s28, v10
    v_accvgpr_read_b32 v104, a44
    v_mfma_f32_16x16x32_bf16 a[88:91], a[228:231], v[38:41], 0
    s_add_u32 s21, s21, 12032
    ds_write_b64 v101, v[108:109] offset:0
    v_accvgpr_read_b32 v109, a93
    v_cvt_pk_bf16_f32 v18, v52, v53
    v_accvgpr_read_b32 v108, a92
    v_pk_mul_f32 v[108:109], v[108:109], v[100:101] op_sel_hi:[1,0]
    v_cvt_pk_bf16_f32 v253, v254, v255
    v_accvgpr_read_b32 v107, a47
    v_cvt_pk_bf16_f32 v24, v60, v61
    v_pk_mul_f32 v[106:107], v[106:107], v[8:9] op_sel_hi:[1,0]
    v_pk_mul_f32 v[104:105], v[104:105], v[8:9] op_sel_hi:[1,0]
    v_accvgpr_read_b32 v111, a95
    v_cvt_pk_bf16_f32 v104, v104, v105
    v_cvt_pk_bf16_f32 v108, v108, v109
    v_xor_b32 v101, 32, v101
    v_mfma_f32_16x16x32_bf16 a[92:95], a[232:235], v[38:41], 0
    ds_read_b128 a[220:223], v0 offset:1024
    v_cvt_pk_bf16_f32 v205, v206, v207
    v_mfma_f32_16x16x32_bf16 a[44:47], a[232:235], v[32:35], 0
    s_add_u32 s56, s67, 128
    ds_write2st64_b64 v101, v[156:157], v[204:205] offset0:8 offset1:20
    v_mfma_f32_16x16x32_bf16 a[40:43], a[228:231], v[32:35], 0
    s_waitcnt lgkmcnt(3)
    buffer_store_dwordx4 v[96:99], v6, s[16:19], s56 offen offset:0 nt
    v_pk_mul_f32 v[110:111], v[110:111], v[100:101] op_sel_hi:[1,0]
    v_fma_f32 v73, v73, s28, v11
    v_cvt_pk_bf16_f32 v105, v106, v107
    v_mfma_f32_16x16x32_bf16 v[248:251], a[228:231], v[26:29], 0
    ds_write2st64_b64 v101, v[252:253], v[104:105] offset0:32 offset1:44
    v_mfma_f32_16x16x32_bf16 v[252:255], a[232:235], v[26:29], 0
    s_add_u32 s58, s33, 128
    v_exp_f32 v63, v63
    v_mfma_f32_16x16x32_bf16 v[204:207], a[232:235], v[20:23], 0
    v_exp_f32 v88, v88
    v_mfma_f32_16x16x32_bf16 v[200:203], a[228:231], v[20:23], 0
    v_exp_f32 v68, v68
    v_mfma_f32_16x16x32_bf16 v[152:155], a[228:231], v[14:17], 0
    s_add_u32 m0, s38, 2048
    ds_read_b128 a[224:227], v1 offset:1024
    v_cvt_pk_bf16_f32 v25, v62, v63
    v_mfma_f32_16x16x32_bf16 v[156:159], a[232:235], v[14:17], 0
    v_exp_f32 v89, v89
    v_mfma_f32_16x16x32_bf16 v[52:55], a[212:215], a[96:99], 0
    ds_read_b128 a[228:231], v0 offset:2048
    v_fma_f32 v83, v83, s28, v12
    v_mfma_f32_16x16x32_bf16 v[52:55], a[216:219], a[100:103], v[52:55]
    s_waitcnt lgkmcnt(3)
    ds_read_b128 a[232:235], v1 offset:2048
    v_exp_f32 v77, v77
    v_mfma_f32_16x16x32_bf16 v[52:55], a[220:223], a[104:107], v[52:55]
    v_exp_f32 v66, v66
    v_mfma_f32_16x16x32_bf16 v[60:63], a[220:223], a[128:131], 0
    buffer_load_dwordx4 v6, s[12:15], s58 offen nt lds
    v_mfma_f32_16x16x32_bf16 v[60:63], a[216:219], a[124:127], v[60:63]
    ds_read_b128 v[96:99], v103 offset:3072
    v_fma_f32 v56, v56, s28, v9
    v_mfma_f32_16x16x32_bf16 v[60:63], a[212:215], a[120:123], v[60:63]
    v_cvt_pk_bf16_f32 v30, v68, v69
    v_cvt_pk_bf16_f32 v42, v84, v85
    v_mfma_f32_16x16x32_bf16 v[68:71], a[212:215], a[144:147], 0
    v_exp_f32 v65, v65
    v_mfma_f32_16x16x32_bf16 v[68:71], a[216:219], a[148:151], v[68:71]
    v_cvt_pk_bf16_f32 v36, v76, v77
    v_mfma_f32_16x16x32_bf16 v[68:71], a[220:223], a[152:155], v[68:71]
    v_exp_f32 v74, v74
    v_mfma_f32_16x16x32_bf16 v[76:79], a[220:223], a[176:179], 0
    v_exp_f32 v80, v80
    v_mfma_f32_16x16x32_bf16 v[76:79], a[216:219], a[172:175], v[76:79]
    s_add_u32 m0, s38, 3072
    v_exp_f32 v57, v57
    v_mfma_f32_16x16x32_bf16 v[76:79], a[212:215], a[168:171], v[76:79]
    v_exp_f32 v67, v67
    v_mfma_f32_16x16x32_bf16 v[84:87], a[212:215], a[192:195], 0
    v_exp_f32 v75, v75
    v_mfma_f32_16x16x32_bf16 v[84:87], a[216:219], a[196:199], v[84:87]
    v_exp_f32 v56, v56
    v_mfma_f32_16x16x32_bf16 v[84:87], a[220:223], a[200:203], v[84:87]
    s_waitcnt lgkmcnt(0)
    ds_read_b128 a[212:215], v0 offset:6144
    v_mfma_f32_16x16x32_bf16 v[84:87], a[224:227], a[204:207], v[84:87]
    v_cvt_pk_bf16_f32 v16, v56, v57
    v_cvt_pk_bf16_f32 v109, v110, v111
    v_mfma_f32_16x16x32_bf16 v[84:87], a[228:231], a[208:211], v[84:87]
    v_exp_f32 v73, v73
    v_mfma_f32_16x16x32_bf16 v[84:87], a[232:235], v[92:95], v[84:87]
    buffer_load_dwordx4 v7, s[12:15], s58 offen nt lds
    v_mfma_f32_16x16x32_bf16 v[76:79], a[232:235], a[188:191], v[76:79]
    v_cvt_pk_bf16_f32 v17, v58, v59
    v_cvt_pk_bf16_f32 v34, v80, v81
    v_mfma_f32_16x16x32_bf16 v[76:79], a[228:231], a[184:187], v[76:79]
    ds_read_b128 a[216:219], v1 offset:6144
    v_cvt_pk_bf16_f32 v23, v66, v67
    v_mfma_f32_16x16x32_bf16 v[76:79], a[224:227], a[180:183], v[76:79]
    buffer_store_dwordx4 v[96:99], v7, s[16:19], s56 offen offset:0 nt
    ds_write_b64 v101, v[108:109] offset:0
    v_mfma_f32_16x16x32_bf16 v[48:51], a[236:239], v[16:19], v[44:47]
    v_exp_f32 v82, v82
    v_mfma_f32_16x16x32_bf16 v[68:71], a[224:227], a[156:159], v[68:71]
    ds_read_b128 v[96:99], v103 offset:0
    v_mfma_f32_16x16x32_bf16 v[68:71], a[228:231], a[160:163], v[68:71]
    v_exp_f32 v91, v91
    v_mfma_f32_16x16x32_bf16 v[68:71], a[232:235], a[164:167], v[68:71]
    v_exp_f32 v72, v72
    v_mfma_f32_16x16x32_bf16 v[60:63], a[232:235], a[140:143], v[60:63]
    ds_read_b128 a[220:223], v0 offset:7168
    v_cvt_pk_bf16_f32 v28, v72, v73
    v_mfma_f32_16x16x32_bf16 v[60:63], a[228:231], a[136:139], v[60:63]
    v_exp_f32 v83, v83
    v_mfma_f32_16x16x32_bf16 v[60:63], a[224:227], a[132:135], v[60:63]
    v_cvt_pk_bf16_f32 v40, v88, v89
    v_mfma_f32_16x16x32_bf16 v[52:55], a[224:227], a[108:111], v[52:55]
    v_cvt_pk_bf16_f32 v29, v74, v75
    v_cvt_pk_bf16_f32 v22, v64, v65
    v_mfma_f32_16x16x32_bf16 v[52:55], a[228:231], a[112:115], v[52:55]
    v_exp_f32 v90, v90
    v_mfma_f32_16x16x32_bf16 v[48:51], a[240:243], v[22:25], v[48:51]
    ds_read_b128 a[224:227], v1 offset:7168
    v_mfma_f32_16x16x32_bf16 v[52:55], a[232:235], a[116:119], v[52:55]
    v_cvt_pk_bf16_f32 v41, v90, v91
    v_cvt_pk_bf16_f32 v35, v82, v83
    v_mfma_f32_16x16x32_bf16 v[48:51], a[244:247], v[28:31], v[48:51]
    s_nop 0
    v_mfma_f32_16x16x32_bf16 v[48:51], a[248:251], v[34:37], v[48:51]
    ds_read_b128 a[228:231], v0 offset:8192
    s_add_u32 s57, s67, 24832
    v_mfma_f32_16x16x32_bf16 v[48:51], a[252:255], v[40:43], v[48:51]
    s_add_u32 m0, s38, 0
    ds_read_b128 a[232:235], v1 offset:8192
    s_waitcnt lgkmcnt(4)
    v_mfma_f32_16x16x32_bf16 v[56:59], a[212:215], a[96:99], 0
    buffer_load_dwordx4 v6, s[12:15], s33 offen nt lds
    v_mfma_f32_16x16x32_bf16 v[56:59], a[216:219], a[100:103], v[56:59]
    buffer_store_dwordx4 v[96:99], v6, s[16:19], s57 offen offset:0 nt
    s_nop 0
    ds_read_b128 v[96:99], v103 offset:1024
    v_cmp_lt_f32 vcc, s29, v48
    s_waitcnt lgkmcnt(4)
    v_mfma_f32_16x16x32_bf16 v[56:59], a[220:223], a[104:107], v[56:59]
    s_add_u32 m0, s38, 1024
    v_mfma_f32_16x16x32_bf16 v[64:67], a[220:223], a[128:131], 0
    s_nop 0
    s_cbranch_vccnz L_rs_tr55d
L_ret_tr55d:
    v_mfma_f32_16x16x32_bf16 v[64:67], a[216:219], a[124:127], v[64:67]
    v_fma_f32 v62, v62, s28, v10
    v_fma_f32 v63, v63, s28, v10
    v_mfma_f32_16x16x32_bf16 v[64:67], a[212:215], a[120:123], v[64:67]
    v_fma_f32 v55, v55, s28, v9
    v_fma_f32 v54, v54, s28, v9
    v_mfma_f32_16x16x32_bf16 v[72:75], a[212:215], a[144:147], 0
    v_fma_f32 v53, v53, s28, v9
    v_fma_f32 v60, v60, s28, v10
    v_mfma_f32_16x16x32_bf16 v[72:75], a[216:219], a[148:151], v[72:75]
    v_exp_f32 v62, v62
    v_mfma_f32_16x16x32_bf16 v[72:75], a[220:223], a[152:155], v[72:75]
    v_exp_f32 v54, v54
    v_mfma_f32_16x16x32_bf16 v[80:83], a[220:223], a[176:179], 0
    v_exp_f32 v60, v60
    v_mfma_f32_16x16x32_bf16 v[80:83], a[216:219], a[172:175], v[80:83]
    v_exp_f32 v53, v53
    v_mfma_f32_16x16x32_bf16 v[80:83], a[212:215], a[168:171], v[80:83]
    s_waitcnt lgkmcnt(0)
    buffer_load_dwordx4 v7, s[12:15], s33 offen nt lds
    v_mfma_f32_16x16x32_bf16 v[88:91], a[212:215], a[192:195], 0
    s_waitcnt vmcnt(15)
    v_fma_f32 v61, v61, s28, v10
    v_add_u32 v103, 4096, v103
    v_mfma_f32_16x16x32_bf16 v[88:91], a[216:219], a[196:199], v[88:91]
    s_barrier
    v_mfma_f32_16x16x32_bf16 v[88:91], a[220:223], a[200:203], v[88:91]
    ds_read_b64_tr_b16 a[212:213], v2 offset:18432
    v_fma_f32 v52, v52, s28, v9
    v_mfma_f32_16x16x32_bf16 v[88:91], a[224:227], a[204:207], v[88:91]
    v_exp_f32 v63, v63
    v_mfma_f32_16x16x32_bf16 v[88:91], a[228:231], a[208:211], v[88:91]
    s_add_u32 m0, s22, 0
    v_exp_f32 v55, v55
    v_mfma_f32_16x16x32_bf16 v[88:91], a[232:235], v[92:95], v[88:91]
    v_exp_f32 v61, v61
    v_mfma_f32_16x16x32_bf16 v[80:83], a[232:235], a[188:191], v[80:83]
    buffer_load_dwordx4 v6, s[4:7], s20 offen lds
    v_mfma_f32_16x16x32_bf16 v[80:83], a[228:231], a[184:187], v[80:83]
    s_add_u32 s20, s20, 128
    ds_read_b64_tr_b16 a[214:215], v2 offset:12288
    s_add_u32 m0, s22, 1024
    v_mfma_f32_16x16x32_bf16 v[80:83], a[224:227], a[180:183], v[80:83]
    ds_read_b64_tr_b16 a[216:217], v3 offset:18432
    v_cvt_pk_bf16_f32 v15, v54, v55
    v_mfma_f32_16x16x32_bf16 v[72:75], a[224:227], a[156:159], v[72:75]
    ds_read_b64_tr_b16 a[218:219], v3 offset:12288
    v_cvt_pk_bf16_f32 v20, v60, v61
    v_mfma_f32_16x16x32_bf16 v[72:75], a[228:231], a[160:163], v[72:75]
    buffer_load_dwordx4 v6, s[4:7], s20 offen lds
    v_mfma_f32_16x16x32_bf16 v[72:75], a[232:235], a[164:167], v[72:75]
    v_exp_f32 v52, v52
    v_mfma_f32_16x16x32_bf16 v[64:67], a[232:235], a[140:143], v[64:67]
    ds_read_b64_tr_b16 a[220:221], v4 offset:18432
    v_cvt_pk_bf16_f32 v14, v52, v53
    v_mfma_f32_16x16x32_bf16 v[64:67], a[228:231], a[136:139], v[64:67]
    s_add_u32 s20, s20, 128
    ds_read_b64_tr_b16 a[222:223], v4 offset:12288
    v_mfma_f32_16x16x32_bf16 v[64:67], a[224:227], a[132:135], v[64:67]
    v_mfma_f32_16x16x32_bf16 v[56:59], a[224:227], a[108:111], v[56:59]
    s_add_u32 m0, s22, 2048
    ds_read_b64_tr_b16 a[224:225], v5 offset:18432
    v_cvt_pk_bf16_f32 v21, v62, v63
    v_mfma_f32_16x16x32_bf16 v[56:59], a[228:231], a[112:115], v[56:59]
    buffer_load_dwordx4 v6, s[4:7], s20 offen lds
    v_mfma_f32_16x16x32_bf16 v[56:59], a[232:235], a[116:119], v[56:59]
    buffer_store_dwordx4 v[96:99], v7, s[16:19], s57 offen offset:0 nt
    ds_read_b64_tr_b16 a[226:227], v5 offset:12288
    s_add_u32 s20, s20, 12032
    s_branch L_loop5
L_loop4:
    .p2align 6
L_loop4w0:
    s_waitcnt lgkmcnt(6)
    v_mfma_f32_16x16x32_bf16 v[112:115], a[212:215], v[16:19], v[112:115]
    v_fma_f32 v80, v80, s28, v12
    v_fma_f32 v64, v64, s28, v10
    v_mfma_f32_16x16x32_bf16 v[160:163], a[212:215], v[22:25], v[160:163]
    ds_read_b64_tr_b16 a[234:235], v3 offset:13312
    v_fma_f32 v58, v58, s28, v9
    v_mfma_f32_16x16x32_bf16 v[208:211], a[212:215], v[28:31], v[208:211]
    ds_read_b128 v[88:91], v103 offset:0
    v_fma_f32 v71, v71, s28, v11
    v_mfma_f32_16x16x32_bf16 a[0:3], a[212:215], v[34:37], a[0:3]
    ds_read_b64_tr_b16 a[230:231], v2 offset:13312
    s_waitcnt lgkmcnt(7)
    v_mfma_f32_16x16x32_bf16 a[4:7], a[216:219], v[34:37], a[4:7]
    ds_read_b64_tr_b16 a[232:233], v3 offset:19456
    v_fma_f32 v76, v76, s28, v12
    v_mfma_f32_16x16x32_bf16 v[212:215], a[216:219], v[28:31], v[212:215]
    ds_read_b64_tr_b16 a[228:229], v2 offset:19456
    v_fma_f32 v67, v67, s28, v10
    v_mfma_f32_16x16x32_bf16 v[164:167], a[216:219], v[22:25], v[164:167]
    ds_read_b64_tr_b16 a[212:213], v4 offset:19456
    v_fma_f32 v75, v75, s28, v11
    v_mfma_f32_16x16x32_bf16 v[116:119], a[216:219], v[16:19], v[116:119]
    ds_read_b64_tr_b16 a[214:215], v4 offset:13312
    s_waitcnt lgkmcnt(9)
    v_mfma_f32_16x16x32_bf16 v[120:123], a[220:223], v[16:19], v[120:123]
    v_fma_f32 v62, v62, s28, v10
    v_fma_f32 v66, v66, s28, v10
    v_mfma_f32_16x16x32_bf16 v[168:171], a[220:223], v[22:25], v[168:171]
    v_fma_f32 v78, v78, s28, v12
    v_fma_f32 v63, v63, s28, v10
    v_mfma_f32_16x16x32_bf16 v[216:219], a[220:223], v[28:31], v[216:219]
    v_exp_f32 v71, v71
    v_mfma_f32_16x16x32_bf16 a[8:11], a[220:223], v[34:37], a[8:11]
    s_waitcnt lgkmcnt(6)
    ds_read_b64_tr_b16 a[222:223], v2 offset:14336
    v_fma_f32 v72, v72, s28, v11
    v_mfma_f32_16x16x32_bf16 a[12:15], a[224:227], v[34:37], a[12:15]
    ds_read_b64_tr_b16 a[218:219], v5 offset:13312
    v_fma_f32 v69, v69, s28, v11
    v_mfma_f32_16x16x32_bf16 v[220:223], a[224:227], v[28:31], v[220:223]
    ds_read_b64_tr_b16 a[216:217], v5 offset:19456
    v_fma_f32 v82, v82, s28, v12
    v_mfma_f32_16x16x32_bf16 v[172:175], a[224:227], v[22:25], v[172:175]
    v_exp_f32 v62, v62
    v_mfma_f32_16x16x32_bf16 v[124:127], a[224:227], v[16:19], v[124:127]
    s_waitcnt lgkmcnt(5)
    ds_read_b64_tr_b16 a[226:227], v3 offset:14336
    v_fma_f32 v74, v74, s28, v11
    v_mfma_f32_16x16x32_bf16 v[128:131], a[228:231], v[16:19], v[128:131]
    ds_read_b64_tr_b16 a[220:221], v2 offset:20480
    v_fma_f32 v59, v59, s28, v9
    v_mfma_f32_16x16x32_bf16 v[176:179], a[228:231], v[22:25], v[176:179]
    v_fma_f32 v65, v65, s28, v10
    s_add_u32 s39, s39, 12288
    v_mfma_f32_16x16x32_bf16 v[224:227], a[228:231], v[28:31], v[224:227]
    v_exp_f32 v74, v74
    v_mfma_f32_16x16x32_bf16 a[16:19], a[228:231], v[34:37], a[16:19]
    v_fma_f32 v56, v56, s28, v9
    v_fma_f32 v79, v79, s28, v12
    v_mfma_f32_16x16x32_bf16 a[20:23], a[232:235], v[34:37], a[20:23]
    ds_read_b64_tr_b16 a[224:225], v3 offset:20480
    v_fma_f32 v77, v77, s28, v12
    v_mfma_f32_16x16x32_bf16 v[228:231], a[232:235], v[28:31], v[228:231]
    ds_read_b64_tr_b16 a[230:231], v4 offset:14336
    v_fma_f32 v68, v68, s28, v11
    v_mfma_f32_16x16x32_bf16 v[180:183], a[232:235], v[22:25], v[180:183]
    ds_read_b64_tr_b16 a[228:229], v4 offset:20480
    v_fma_f32 v57, v57, s28, v9
    v_mfma_f32_16x16x32_bf16 v[132:135], a[232:235], v[16:19], v[132:135]
    s_waitcnt lgkmcnt(5)
    ds_read_b64_tr_b16 a[234:235], v5 offset:14336
    v_mfma_f32_16x16x32_bf16 v[136:139], a[212:215], v[16:19], v[136:139]
    ds_read_b64_tr_b16 a[232:233], v5 offset:20480
    v_fma_f32 v70, v70, s28, v11
    v_mfma_f32_16x16x32_bf16 v[184:187], a[212:215], v[22:25], v[184:187]
    v_exp_f32 v66, v66
    v_mfma_f32_16x16x32_bf16 v[232:235], a[212:215], v[28:31], v[232:235]
    v_exp_f32 v76, v76
    v_mfma_f32_16x16x32_bf16 a[24:27], a[212:215], v[34:37], a[24:27]
    v_exp_f32 v77, v77
    v_mfma_f32_16x16x32_bf16 a[28:31], a[216:219], v[34:37], a[28:31]
    v_exp_f32 v82, v82
    v_mfma_f32_16x16x32_bf16 v[236:239], a[216:219], v[28:31], v[236:239]
    v_exp_f32 v58, v58
    v_mfma_f32_16x16x32_bf16 v[188:191], a[216:219], v[22:25], v[188:191]
    v_exp_f32 v79, v79
    v_mfma_f32_16x16x32_bf16 v[140:143], a[216:219], v[16:19], v[140:143]
    s_waitcnt lgkmcnt(3)
    v_exp_f32 v63, v63
    v_mfma_f32_16x16x32_bf16 v[144:147], a[220:223], v[16:19], v[144:147]
    v_exp_f32 v78, v78
    v_mfma_f32_16x16x32_bf16 v[192:195], a[220:223], v[22:25], v[192:195]
    s_waitcnt vmcnt(10) lgkmcnt(0)
    v_mfma_f32_16x16x32_bf16 v[240:243], a[220:223], v[28:31], v[240:243]
    s_barrier
    v_mfma_f32_16x16x32_bf16 a[32:35], a[220:223], v[34:37], a[32:35]
    s_add_u32 m0, s22, 36864
    ds_read_b128 a[212:215], v0 offset:12288
    v_cvt_pk_bf16_f32 v33, v78, v79
    v_mfma_f32_16x16x32_bf16 a[36:39], a[224:227], v[34:37], a[36:39]
    buffer_load_dwordx4 v6, s[8:11], s21 offen lds
    v_mfma_f32_16x16x32_bf16 v[244:247], a[224:227], v[28:31], v[244:247]
    ds_read_b128 a[220:223], v0 offset:13312
    s_add_u32 s21, s21, 128
    v_mfma_f32_16x16x32_bf16 v[196:199], a[224:227], v[22:25], v[196:199]
    ds_read_b128 a[216:219], v1 offset:12288
    v_fma_f32 v73, v73, s28, v11
    v_mfma_f32_16x16x32_bf16 v[148:151], a[224:227], v[16:19], v[148:151]
    ds_read_b128 a[224:227], v1 offset:13312
    s_add_u32 m0, s22, 37888
    v_mfma_f32_16x16x32_bf16 v[152:155], a[228:231], v[16:19], v[152:155]
    v_exp_f32 v70, v70
    v_mfma_f32_16x16x32_bf16 v[200:203], a[228:231], v[22:25], v[200:203]
    buffer_load_dwordx4 v6, s[8:11], s21 offen lds
    v_mfma_f32_16x16x32_bf16 v[248:251], a[228:231], v[28:31], v[248:251]
    s_add_u32 s21, s21, 128
    v_exp_f32 v68, v68
    v_mfma_f32_16x16x32_bf16 a[40:43], a[228:231], v[34:37], a[40:43]
    s_add_u32 m0, s22, 38912
    v_mfma_f32_16x16x32_bf16 a[44:47], a[232:235], v[34:37], a[44:47]
    ds_read_b128 a[228:231], v0 offset:14336
    v_cvt_pk_bf16_f32 v27, v70, v71
    v_mfma_f32_16x16x32_bf16 v[252:255], a[232:235], v[28:31], v[252:255]
    buffer_load_dwordx4 v6, s[8:11], s21 offen lds
    v_mfma_f32_16x16x32_bf16 v[204:207], a[232:235], v[22:25], v[204:207]
    v_exp_f32 v65, v65
    v_mfma_f32_16x16x32_bf16 v[156:159], a[232:235], v[16:19], v[156:159]
    s_waitcnt lgkmcnt(3)
    v_exp_f32 v80, v80
    v_mfma_f32_16x16x32_bf16 v[52:55], a[212:215], a[96:99], 0
    s_waitcnt lgkmcnt(2)
    v_exp_f32 v69, v69
    v_mfma_f32_16x16x32_bf16 v[52:55], a[216:219], a[100:103], v[52:55]
    v_cvt_pk_bf16_f32 v21, v62, v63
    v_cvt_pk_bf16_f32 v32, v76, v77
    v_mfma_f32_16x16x32_bf16 v[52:55], a[220:223], a[104:107], v[52:55]
    v_exp_f32 v64, v64
    v_mfma_f32_16x16x32_bf16 v[60:63], a[220:223], a[128:131], 0
    v_fma_f32 v81, v81, s28, v12
    v_cvt_pk_bf16_f32 v26, v68, v69
    v_mfma_f32_16x16x32_bf16 v[60:63], a[216:219], a[124:127], v[60:63]
    v_exp_f32 v73, v73
    v_mfma_f32_16x16x32_bf16 v[60:63], a[212:215], a[120:123], v[60:63]
    ds_read_b128 a[232:235], v1 offset:14336
    v_fma_f32 v83, v83, s28, v12
    v_mfma_f32_16x16x32_bf16 v[68:71], a[212:215], a[144:147], 0
    buffer_store_dwordx4 v[88:91], v38, s[16:19], s24 offen offset:0 nt
    v_exp_f32 v81, v81
    v_mfma_f32_16x16x32_bf16 v[68:71], a[216:219], a[148:151], v[68:71]
    v_exp_f32 v57, v57
    v_mfma_f32_16x16x32_bf16 v[68:71], a[220:223], a[152:155], v[68:71]
    v_exp_f32 v56, v56
    v_mfma_f32_16x16x32_bf16 v[76:79], a[220:223], a[176:179], 0
    s_add_u32 s21, s21, 12032
    v_exp_f32 v72, v72
    v_mfma_f32_16x16x32_bf16 v[76:79], a[216:219], a[172:175], v[76:79]
    v_exp_f32 v59, v59
    v_mfma_f32_16x16x32_bf16 v[76:79], a[212:215], a[168:171], v[76:79]
    s_waitcnt lgkmcnt(1)
    ds_read_b128 a[212:215], v0 offset:18432
    v_cvt_pk_bf16_f32 v16, v56, v57
    v_mfma_f32_16x16x32_bf16 v[76:79], a[224:227], a[180:183], v[76:79]
    v_exp_f32 v67, v67
    v_mfma_f32_16x16x32_bf16 v[76:79], a[228:231], a[184:187], v[76:79]
    s_add_u32 m0, s23, 0
    v_cvt_pk_bf16_f32 v17, v58, v59
    s_waitcnt lgkmcnt(1)
    v_mfma_f32_16x16x32_bf16 v[76:79], a[232:235], a[188:191], v[76:79]
    ds_read_b128 a[220:223], v0 offset:19456
    v_mfma_f32_16x16x32_bf16 v[68:71], a[232:235], a[164:167], v[68:71]
    v_exp_f32 v83, v83
    v_mfma_f32_16x16x32_bf16 v[68:71], a[228:231], a[160:163], v[68:71]
    v_exp_f32 v75, v75
    v_mfma_f32_16x16x32_bf16 v[68:71], a[224:227], a[156:159], v[68:71]
    buffer_load_dwordx4 v38, s[12:15], s25 offen nt lds
    v_mfma_f32_16x16x32_bf16 v[60:63], a[224:227], a[132:135], v[60:63]
    ds_read_b128 a[216:219], v1 offset:18432
    v_cvt_pk_bf16_f32 v23, v66, v67
    v_mfma_f32_16x16x32_bf16 v[60:63], a[228:231], a[136:139], v[60:63]
    s_bitcmp1_b32 s27, 0
    v_cvt_pk_bf16_f32 v22, v64, v65
    s_cselect_b32 s26, s49, 128
    v_mfma_f32_16x16x32_bf16 v[60:63], a[232:235], a[140:143], v[60:63]
    v_cvt_pk_bf16_f32 v35, v82, v83
    v_mfma_f32_16x16x32_bf16 v[52:55], a[232:235], a[116:119], v[52:55]
    s_bitcmp1_b32 s89, 0
    v_cvt_pk_bf16_f32 v29, v74, v75
    v_cvt_pk_bf16_f32 v34, v80, v81
    v_mfma_f32_16x16x32_bf16 v[52:55], a[228:231], a[112:115], v[52:55]
    ds_read_b128 a[232:235], v1 offset:20480
    v_cvt_pk_bf16_f32 v28, v72, v73
    v_mfma_f32_16x16x32_bf16 v[44:47], a[236:239], v[14:17], v[48:51]
    ds_read_b128 a[228:231], v0 offset:20480
    v_mfma_f32_16x16x32_bf16 v[52:55], a[224:227], a[108:111], v[52:55]
    ds_read_b128 a[224:227], v1 offset:19456
    v_mfma_f32_16x16x32_bf16 v[44:47], a[240:243], v[20:23], v[44:47]
    v_mfma_f32_16x16x32_bf16 v[44:47], a[244:247], v[26:29], v[44:47]
    v_mfma_f32_16x16x32_bf16 v[44:47], a[248:251], v[32:35], v[44:47]
    s_cselect_b32 s26, s26, 0
    s_lshr_b32 s89, s89, 1
    s_waitcnt lgkmcnt(4)
    v_mfma_f32_16x16x32_bf16 v[56:59], a[212:215], a[96:99], 0
    s_waitcnt lgkmcnt(3)
    v_mfma_f32_16x16x32_bf16 v[56:59], a[216:219], a[100:103], v[56:59]
    s_lshr_b32 s27, s27, 1
    s_nop 0
    v_cmp_lt_f32 vcc, s29, v44
    v_mfma_f32_16x16x32_bf16 v[56:59], a[220:223], a[104:107], v[56:59]
    s_add_u32 s24, s24, s26
    s_add_u32 s25, s25, s26
    v_mfma_f32_16x16x32_bf16 v[64:67], a[220:223], a[128:131], 0
    s_nop 0
    s_cbranch_vccnz L_rs_loop4w0a
L_ret_loop4w0a:
    v_mfma_f32_16x16x32_bf16 v[64:67], a[216:219], a[124:127], v[64:67]
    v_fma_f32 v55, v55, s28, v9
    v_fma_f32 v52, v52, s28, v9
    v_mfma_f32_16x16x32_bf16 v[64:67], a[212:215], a[120:123], v[64:67]
    v_exp_f32 v52, v52
    v_mfma_f32_16x16x32_bf16 v[72:75], a[212:215], a[144:147], 0
    v_fma_f32 v60, v60, s28, v10
    s_waitcnt vmcnt(10) lgkmcnt(0)
    v_mfma_f32_16x16x32_bf16 v[72:75], a[216:219], a[148:151], v[72:75]
    s_barrier
    v_mfma_f32_16x16x32_bf16 v[72:75], a[220:223], a[152:155], v[72:75]
    s_add_u32 m0, s22, 12288
    v_exp_f32 v60, v60
    v_mfma_f32_16x16x32_bf16 v[80:83], a[220:223], a[176:179], 0
    v_fma_f32 v54, v54, s28, v9
    v_mfma_f32_16x16x32_bf16 v[80:83], a[216:219], a[172:175], v[80:83]
    buffer_load_dwordx4 v6, s[4:7], s20 offen lds
    v_mfma_f32_16x16x32_bf16 v[80:83], a[212:215], a[168:171], v[80:83]
    v_exp_f32 v55, v55
    v_mfma_f32_16x16x32_bf16 v[80:83], a[224:227], a[180:183], v[80:83]
    s_add_u32 s20, s20, 128
    s_add_u32 m0, s22, 13312
    ds_read_b64_tr_b16 a[212:213], v2 offset:0
    v_mfma_f32_16x16x32_bf16 v[80:83], a[228:231], a[184:187], v[80:83]
    ds_read_b64_tr_b16 a[214:215], v2 offset:6144
    v_fma_f32 v53, v53, s28, v9
    v_mfma_f32_16x16x32_bf16 v[80:83], a[232:235], a[188:191], v[80:83]
    buffer_load_dwordx4 v6, s[4:7], s20 offen lds
    v_mfma_f32_16x16x32_bf16 v[72:75], a[232:235], a[164:167], v[72:75]
    s_add_u32 s20, s20, 128
    v_exp_f32 v54, v54
    v_mfma_f32_16x16x32_bf16 v[72:75], a[228:231], a[160:163], v[72:75]
    s_add_u32 m0, s22, 14336
    ds_read_b64_tr_b16 a[216:217], v3 offset:0
    v_cvt_pk_bf16_f32 v19, v54, v55
    v_mfma_f32_16x16x32_bf16 v[72:75], a[224:227], a[156:159], v[72:75]
    buffer_load_dwordx4 v6, s[4:7], s20 offen lds
    v_mfma_f32_16x16x32_bf16 v[64:67], a[224:227], a[132:135], v[64:67]
    ds_read_b64_tr_b16 a[218:219], v3 offset:6144
    v_fma_f32 v61, v61, s28, v10
    v_mfma_f32_16x16x32_bf16 v[64:67], a[228:231], a[136:139], v[64:67]
    v_exp_f32 v61, v61
    v_mfma_f32_16x16x32_bf16 v[64:67], a[232:235], a[140:143], v[64:67]
    s_add_u32 s20, s20, 12032
    v_exp_f32 v53, v53
    v_mfma_f32_16x16x32_bf16 v[56:59], a[232:235], a[116:119], v[56:59]
    ds_read_b64_tr_b16 a[220:221], v4 offset:0
    v_cvt_pk_bf16_f32 v18, v52, v53
    v_mfma_f32_16x16x32_bf16 v[56:59], a[228:231], a[112:115], v[56:59]
    ds_read_b64_tr_b16 a[222:223], v4 offset:6144
    v_cvt_pk_bf16_f32 v24, v60, v61
    v_mfma_f32_16x16x32_bf16 v[56:59], a[224:227], a[108:111], v[56:59]
    ds_read_b64_tr_b16 a[224:225], v5 offset:0
    ds_read_b64_tr_b16 a[226:227], v5 offset:6144
    s_waitcnt lgkmcnt(6)
    v_mfma_f32_16x16x32_bf16 v[112:115], a[212:215], v[14:17], v[112:115]
    v_fma_f32 v73, v73, s28, v11
    v_fma_f32 v77, v77, s28, v12
    v_mfma_f32_16x16x32_bf16 v[160:163], a[212:215], v[20:23], v[160:163]
    ds_read_b128 v[96:99], v103 offset:1024
    v_fma_f32 v59, v59, s28, v9
    v_mfma_f32_16x16x32_bf16 v[208:211], a[212:215], v[26:29], v[208:211]
    ds_read_b64_tr_b16 a[234:235], v3 offset:7168
    v_fma_f32 v69, v69, s28, v11
    v_mfma_f32_16x16x32_bf16 a[0:3], a[212:215], v[32:35], a[0:3]
    v_fma_f32 v78, v78, s28, v12
    s_waitcnt lgkmcnt(6)
    v_mfma_f32_16x16x32_bf16 a[4:7], a[216:219], v[32:35], a[4:7]
    ds_read_b64_tr_b16 a[228:229], v2 offset:1024
    v_fma_f32 v75, v75, s28, v11
    v_mfma_f32_16x16x32_bf16 v[212:215], a[216:219], v[26:29], v[212:215]
    ds_read_b64_tr_b16 a[232:233], v3 offset:1024
    v_fma_f32 v62, v62, s28, v10
    v_mfma_f32_16x16x32_bf16 v[164:167], a[216:219], v[20:23], v[164:167]
    v_fma_f32 v76, v76, s28, v12
    v_fma_f32 v80, v80, s28, v12
    v_mfma_f32_16x16x32_bf16 v[116:119], a[216:219], v[14:17], v[116:119]
    ds_read_b64_tr_b16 a[230:231], v2 offset:7168
    s_waitcnt lgkmcnt(7)
    v_mfma_f32_16x16x32_bf16 v[120:123], a[220:223], v[14:17], v[120:123]
    ds_read_b64_tr_b16 a[216:217], v5 offset:1024
    v_fma_f32 v79, v79, s28, v12
    v_mfma_f32_16x16x32_bf16 v[168:171], a[220:223], v[20:23], v[168:171]
    v_exp_f32 v73, v73
    v_mfma_f32_16x16x32_bf16 v[216:219], a[220:223], v[26:29], v[216:219]
    s_add_u32 s39, s39, 12288
    ds_read_b64_tr_b16 a[212:213], v4 offset:1024
    v_fma_f32 v58, v58, s28, v9
    v_mfma_f32_16x16x32_bf16 a[8:11], a[220:223], v[32:35], a[8:11]
    s_waitcnt lgkmcnt(6)
    ds_read_b64_tr_b16 a[214:215], v4 offset:7168
    v_fma_f32 v68, v68, s28, v11
    v_mfma_f32_16x16x32_bf16 a[12:15], a[224:227], v[32:35], a[12:15]
    buffer_store_dwordx4 v[96:99], v39, s[16:19], s24 offen offset:0 nt
    ds_read_b64_tr_b16 a[218:219], v5 offset:7168
    v_exp_f32 v76, v76
    v_mfma_f32_16x16x32_bf16 v[220:223], a[224:227], v[26:29], v[220:223]
    s_add_u32 m0, s23, 1024
    v_fma_f32 v66, v66, s28, v10
    v_fma_f32 v67, v67, s28, v10
    v_mfma_f32_16x16x32_bf16 v[172:175], a[224:227], v[20:23], v[172:175]
    buffer_load_dwordx4 v39, s[12:15], s25 offen nt lds
    v_mfma_f32_16x16x32_bf16 v[124:127], a[224:227], v[14:17], v[124:127]
    ds_read_b64_tr_b16 a[220:221], v2 offset:2048
    s_waitcnt lgkmcnt(5)
    v_mfma_f32_16x16x32_bf16 v[128:131], a[228:231], v[14:17], v[128:131]
    s_bitcmp1_b32 s27, 0
    ds_read_b64_tr_b16 a[222:223], v2 offset:8192
    v_fma_f32 v56, v56, s28, v9
    v_mfma_f32_16x16x32_bf16 v[176:179], a[228:231], v[20:23], v[176:179]
    ds_read_b64_tr_b16 a[226:227], v3 offset:8192
    v_mfma_f32_16x16x32_bf16 v[224:227], a[228:231], v[26:29], v[224:227]
    ds_read_b128 v[84:87], v103 offset:2048
    v_fma_f32 v81, v81, s28, v12
    v_mfma_f32_16x16x32_bf16 a[16:19], a[228:231], v[32:35], a[16:19]
    ds_read_b64_tr_b16 a[228:229], v4 offset:2048
    v_fma_f32 v64, v64, s28, v10
    v_mfma_f32_16x16x32_bf16 a[20:23], a[232:235], v[32:35], a[20:23]
    ds_read_b64_tr_b16 a[230:231], v4 offset:8192
    s_cselect_b32 s26, s49, 128
    v_mfma_f32_16x16x32_bf16 v[228:231], a[232:235], v[26:29], v[228:231]
    ds_read_b64_tr_b16 a[224:225], v3 offset:2048
    s_bitcmp1_b32 s89, 0
    v_mfma_f32_16x16x32_bf16 v[180:183], a[232:235], v[20:23], v[180:183]
    v_exp_f32 v69, v69
    v_mfma_f32_16x16x32_bf16 v[132:135], a[232:235], v[14:17], v[132:135]
    s_waitcnt lgkmcnt(7)
    ds_read_b64_tr_b16 a[232:233], v5 offset:2048
    s_cselect_b32 s26, s26, 0
    v_mfma_f32_16x16x32_bf16 v[136:139], a[212:215], v[14:17], v[136:139]
    s_lshr_b32 s89, s89, 1
    ds_read_b64_tr_b16 a[234:235], v5 offset:8192
    v_fma_f32 v72, v72, s28, v11
    v_mfma_f32_16x16x32_bf16 v[184:187], a[212:215], v[20:23], v[184:187]
    v_exp_f32 v56, v56
    v_mfma_f32_16x16x32_bf16 v[232:235], a[212:215], v[26:29], v[232:235]
    v_exp_f32 v68, v68
    v_mfma_f32_16x16x32_bf16 a[24:27], a[212:215], v[32:35], a[24:27]
    v_exp_f32 v58, v58
    v_mfma_f32_16x16x32_bf16 a[28:31], a[216:219], v[32:35], a[28:31]
    v_exp_f32 v62, v62
    v_mfma_f32_16x16x32_bf16 v[236:239], a[216:219], v[26:29], v[236:239]
    v_fma_f32 v63, v63, s28, v10
    v_fma_f32 v70, v70, s28, v11
    v_mfma_f32_16x16x32_bf16 v[188:191], a[216:219], v[20:23], v[188:191]
    s_lshr_b32 s27, s27, 1
    v_exp_f32 v63, v63
    v_mfma_f32_16x16x32_bf16 v[140:143], a[216:219], v[14:17], v[140:143]
    s_waitcnt lgkmcnt(2)
    v_fma_f32 v57, v57, s28, v9
    v_fma_f32 v82, v82, s28, v12
    v_mfma_f32_16x16x32_bf16 v[144:147], a[220:223], v[14:17], v[144:147]
    s_add_u32 s24, s24, s26
    v_exp_f32 v66, v66
    v_mfma_f32_16x16x32_bf16 v[192:195], a[220:223], v[20:23], v[192:195]
    s_add_u32 s25, s25, s26
    v_fma_f32 v71, v71, s28, v11
    s_waitcnt vmcnt(10) lgkmcnt(0)
    v_mfma_f32_16x16x32_bf16 v[240:243], a[220:223], v[26:29], v[240:243]
    s_barrier
    v_mfma_f32_16x16x32_bf16 a[32:35], a[220:223], v[32:35], a[32:35]
    ds_read_b128 a[216:219], v1 offset:0
    s_add_u32 m0, s22, 24576
    v_mfma_f32_16x16x32_bf16 a[36:39], a[224:227], v[32:35], a[36:39]
    ds_read_b128 a[212:215], v0 offset:0
    v_mfma_f32_16x16x32_bf16 v[244:247], a[224:227], v[26:29], v[244:247]
    buffer_load_dwordx4 v6, s[8:11], s21 offen lds
    v_mfma_f32_16x16x32_bf16 v[196:199], a[224:227], v[20:23], v[196:199]
    s_add_u32 s21, s21, 128
    v_exp_f32 v77, v77
    v_mfma_f32_16x16x32_bf16 v[148:151], a[224:227], v[14:17], v[148:151]
    s_add_u32 m0, s22, 25600
    ds_read_b128 a[220:223], v0 offset:1024
    v_add_u32 v103, 3072, v103
    v_mfma_f32_16x16x32_bf16 v[152:155], a[228:231], v[14:17], v[152:155]
    buffer_load_dwordx4 v6, s[8:11], s21 offen lds
    v_mfma_f32_16x16x32_bf16 v[200:203], a[228:231], v[20:23], v[200:203]
    v_exp_f32 v70, v70
    v_mfma_f32_16x16x32_bf16 v[248:251], a[228:231], v[26:29], v[248:251]
    s_add_u32 s21, s21, 128
    v_exp_f32 v81, v81
    v_mfma_f32_16x16x32_bf16 a[40:43], a[228:231], v[32:35], a[40:43]
    s_add_u32 m0, s22, 26624
    v_exp_f32 v57, v57
    v_mfma_f32_16x16x32_bf16 a[44:47], a[232:235], v[32:35], a[44:47]
    buffer_load_dwordx4 v6, s[8:11], s21 offen lds
    v_mfma_f32_16x16x32_bf16 v[252:255], a[232:235], v[26:29], v[252:255]
    v_exp_f32 v79, v79
    v_mfma_f32_16x16x32_bf16 v[204:207], a[232:235], v[20:23], v[204:207]
    v_cvt_pk_bf16_f32 v25, v62, v63
    v_fma_f32 v65, v65, s28, v10
    v_mfma_f32_16x16x32_bf16 v[156:159], a[232:235], v[14:17], v[156:159]
    s_waitcnt lgkmcnt(1)
    ds_read_b128 a[232:235], v1 offset:2048
    v_cvt_pk_bf16_f32 v30, v68, v69
    v_mfma_f32_16x16x32_bf16 v[52:55], a[212:215], a[96:99], 0
    v_exp_f32 v71, v71
    v_mfma_f32_16x16x32_bf16 v[52:55], a[216:219], a[100:103], v[52:55]
    s_waitcnt lgkmcnt(1)
    ds_read_b128 a[224:227], v1 offset:1024
    v_mfma_f32_16x16x32_bf16 v[52:55], a[220:223], a[104:107], v[52:55]
    ds_read_b128 a[228:231], v0 offset:2048
    v_mfma_f32_16x16x32_bf16 v[60:63], a[220:223], a[128:131], 0
    v_exp_f32 v59, v59
    v_mfma_f32_16x16x32_bf16 v[60:63], a[216:219], a[124:127], v[60:63]
    s_add_u32 s21, s21, 12032
    v_exp_f32 v78, v78
    v_mfma_f32_16x16x32_bf16 v[60:63], a[212:215], a[120:123], v[60:63]
    buffer_store_dwordx4 v[84:87], v38, s[16:19], s24 offen offset:0 nt
    v_cvt_pk_bf16_f32 v36, v76, v77
    v_fma_f32 v83, v83, s28, v12
    v_cvt_pk_bf16_f32 v31, v70, v71
    v_mfma_f32_16x16x32_bf16 v[68:71], a[212:215], a[144:147], 0
    s_add_u32 m0, s23, 2048
    v_cvt_pk_bf16_f32 v16, v56, v57
    v_cvt_pk_bf16_f32 v37, v78, v79
    v_mfma_f32_16x16x32_bf16 v[68:71], a[216:219], a[148:151], v[68:71]
    v_exp_f32 v72, v72
    v_mfma_f32_16x16x32_bf16 v[68:71], a[220:223], a[152:155], v[68:71]
    v_exp_f32 v75, v75
    v_mfma_f32_16x16x32_bf16 v[76:79], a[220:223], a[176:179], 0
    v_exp_f32 v67, v67
    v_mfma_f32_16x16x32_bf16 v[76:79], a[216:219], a[172:175], v[76:79]
    v_cvt_pk_bf16_f32 v17, v58, v59
    v_cvt_pk_bf16_f32 v28, v72, v73
    v_mfma_f32_16x16x32_bf16 v[76:79], a[212:215], a[168:171], v[76:79]
    s_waitcnt lgkmcnt(0)
    v_exp_f32 v82, v82
    v_mfma_f32_16x16x32_bf16 v[76:79], a[224:227], a[180:183], v[76:79]
    ds_read_b128 a[220:223], v0 offset:7168
    v_mfma_f32_16x16x32_bf16 v[48:51], a[236:239], v[16:19], v[44:47]
    buffer_load_dwordx4 v38, s[12:15], s25 offen nt lds
    v_mfma_f32_16x16x32_bf16 v[76:79], a[228:231], a[184:187], v[76:79]
    v_exp_f32 v65, v65
    v_mfma_f32_16x16x32_bf16 v[76:79], a[232:235], a[188:191], v[76:79]
    ds_read_b128 a[212:215], v0 offset:6144
    v_mfma_f32_16x16x32_bf16 v[68:71], a[232:235], a[164:167], v[68:71]
    v_exp_f32 v64, v64
    v_mfma_f32_16x16x32_bf16 v[68:71], a[228:231], a[160:163], v[68:71]
    ds_read_b128 a[216:219], v1 offset:6144
    v_cvt_pk_bf16_f32 v23, v66, v67
    v_mfma_f32_16x16x32_bf16 v[68:71], a[224:227], a[156:159], v[68:71]
    v_exp_f32 v83, v83
    v_mfma_f32_16x16x32_bf16 v[60:63], a[224:227], a[132:135], v[60:63]
    v_exp_f32 v80, v80
    v_mfma_f32_16x16x32_bf16 v[60:63], a[228:231], a[136:139], v[60:63]
    v_cvt_pk_bf16_f32 v22, v64, v65
    v_fma_f32 v74, v74, s28, v11
    v_mfma_f32_16x16x32_bf16 v[60:63], a[232:235], a[140:143], v[60:63]
    v_exp_f32 v74, v74
    v_mfma_f32_16x16x32_bf16 v[52:55], a[232:235], a[116:119], v[52:55]
    ds_read_b128 a[232:235], v1 offset:8192
    v_mfma_f32_16x16x32_bf16 v[52:55], a[228:231], a[112:115], v[52:55]
    ds_read_b128 a[228:231], v0 offset:8192
    s_bitcmp1_b32 s27, 0
    v_mfma_f32_16x16x32_bf16 v[52:55], a[224:227], a[108:111], v[52:55]
    s_cselect_b32 s26, s49, 128
    ds_read_b128 a[224:227], v1 offset:7168
    v_cvt_pk_bf16_f32 v29, v74, v75
    v_mfma_f32_16x16x32_bf16 v[48:51], a[240:243], v[22:25], v[48:51]
    s_bitcmp1_b32 s89, 0
    v_cvt_pk_bf16_f32 v34, v80, v81
    v_cvt_pk_bf16_f32 v35, v82, v83
    v_mfma_f32_16x16x32_bf16 v[48:51], a[244:247], v[28:31], v[48:51]
    v_swap_b32 v38, v39
    v_mfma_f32_16x16x32_bf16 v[48:51], a[248:251], v[34:37], v[48:51]
    s_cselect_b32 s26, s26, 0
    s_waitcnt lgkmcnt(3)
    v_mfma_f32_16x16x32_bf16 v[56:59], a[212:215], a[96:99], 0
    s_lshr_b32 s89, s89, 1
    s_lshr_b32 s27, s27, 1
    v_mfma_f32_16x16x32_bf16 v[56:59], a[216:219], a[100:103], v[56:59]
    s_nop 1
    v_cmp_lt_f32 vcc, s29, v48
    v_mfma_f32_16x16x32_bf16 v[56:59], a[220:223], a[104:107], v[56:59]
    s_add_u32 s24, s24, s26
    s_add_u32 s25, s25, s26
    v_mfma_f32_16x16x32_bf16 v[64:67], a[220:223], a[128:131], 0
    s_add_u32 s23, s23, 3072
    s_cbranch_vccnz L_rs_loop4w0b
L_ret_loop4w0b:
    v_mfma_f32_16x16x32_bf16 v[64:67], a[216:219], a[124:127], v[64:67]
    v_fma_f32 v55, v55, s28, v9
    v_fma_f32 v53, v53, s28, v9
    v_mfma_f32_16x16x32_bf16 v[64:67], a[212:215], a[120:123], v[64:67]
    v_fma_f32 v61, v61, s28, v10
    v_fma_f32 v60, v60, s28, v10
    v_mfma_f32_16x16x32_bf16 v[72:75], a[212:215], a[144:147], 0
    s_waitcnt vmcnt(12) lgkmcnt(0)
    s_cmp_eq_u32 s30, 5
    s_cselect_b32 s26, s62, 0
    v_mfma_f32_16x16x32_bf16 v[72:75], a[216:219], a[148:151], v[72:75]
    s_barrier
    v_mfma_f32_16x16x32_bf16 v[72:75], a[220:223], a[152:155], v[72:75]
    s_add_u32 s20, s20, s26
    v_fma_f32 v54, v54, s28, v9
    v_fma_f32 v52, v52, s28, v9
    v_mfma_f32_16x16x32_bf16 v[80:83], a[220:223], a[176:179], 0
    s_add_u32 m0, s22, 0
    v_exp_f32 v60, v60
    v_mfma_f32_16x16x32_bf16 v[80:83], a[216:219], a[172:175], v[80:83]
    buffer_load_dwordx4 v6, s[4:7], s20 offen lds
    v_mfma_f32_16x16x32_bf16 v[80:83], a[212:215], a[168:171], v[80:83]
    s_add_u32 s20, s20, 128
    s_add_u32 m0, s22, 1024
    ds_read_b64_tr_b16 a[212:213], v2 offset:18432
    v_mfma_f32_16x16x32_bf16 v[80:83], a[224:227], a[180:183], v[80:83]
    buffer_load_dwordx4 v6, s[4:7], s20 offen lds
    v_mfma_f32_16x16x32_bf16 v[80:83], a[228:231], a[184:187], v[80:83]
    s_add_u32 s20, s20, 128
    v_exp_f32 v55, v55
    v_mfma_f32_16x16x32_bf16 v[80:83], a[232:235], a[188:191], v[80:83]
    s_add_u32 m0, s22, 2048
    v_exp_f32 v52, v52
    v_mfma_f32_16x16x32_bf16 v[72:75], a[232:235], a[164:167], v[72:75]
    buffer_load_dwordx4 v6, s[4:7], s20 offen lds
    ds_read_b64_tr_b16 a[214:215], v2 offset:12288
    v_mfma_f32_16x16x32_bf16 v[72:75], a[228:231], a[160:163], v[72:75]
    v_exp_f32 v53, v53
    v_mfma_f32_16x16x32_bf16 v[72:75], a[224:227], a[156:159], v[72:75]
    v_exp_f32 v61, v61
    v_mfma_f32_16x16x32_bf16 v[64:67], a[224:227], a[132:135], v[64:67]
    ds_read_b64_tr_b16 a[216:217], v3 offset:18432
    v_cvt_pk_bf16_f32 v14, v52, v53
    v_mfma_f32_16x16x32_bf16 v[64:67], a[228:231], a[136:139], v[64:67]
    ds_read_b64_tr_b16 a[218:219], v3 offset:12288
    s_add_u32 s20, s20, 12032
    v_mfma_f32_16x16x32_bf16 v[64:67], a[232:235], a[140:143], v[64:67]
    v_exp_f32 v54, v54
    v_mfma_f32_16x16x32_bf16 v[56:59], a[232:235], a[116:119], v[56:59]
    ds_read_b64_tr_b16 a[220:221], v4 offset:18432
    v_cvt_pk_bf16_f32 v15, v54, v55
    v_mfma_f32_16x16x32_bf16 v[56:59], a[228:231], a[112:115], v[56:59]
    s_add_u32 s30, s30, 1
    ds_read_b64_tr_b16 a[222:223], v4 offset:12288
    v_cvt_pk_bf16_f32 v20, v60, v61
    v_mfma_f32_16x16x32_bf16 v[56:59], a[224:227], a[108:111], v[56:59]
    s_cmp_lt_u32 s30, 6
    ds_read_b64_tr_b16 a[224:225], v5 offset:18432
    ds_read_b64_tr_b16 a[226:227], v5 offset:12288
    s_cbranch_scc1 L_loop4w0
    s_cmp_ge_u32 s37, 6
    s_cbranch_scc1 L_end4
    s_cmp_eq_u32 s32, 0
    s_cbranch_scc1 L_tr44
    s_branch L_tr45
L_tr45:
    v_fma_f32 v62, v62, s28, v10
    s_waitcnt lgkmcnt(6)
    v_mfma_f32_16x16x32_bf16 v[112:115], a[212:215], v[16:19], v[112:115]
    v_fma_f32 v71, v71, s28, v11
    v_fma_f32 v65, v65, s28, v10
    v_mfma_f32_16x16x32_bf16 v[160:163], a[212:215], v[22:25], v[160:163]
    ds_read_b64_tr_b16 a[230:231], v2 offset:13312
    v_mbcnt_lo_u32_b32 v107, -1, 0
    v_mfma_f32_16x16x32_bf16 v[208:211], a[212:215], v[28:31], v[208:211]
    ds_read_b64_tr_b16 a[234:235], v3 offset:13312
    v_fma_f32 v78, v78, s28, v12
    v_fma_f32 v79, v79, s28, v12
    v_mfma_f32_16x16x32_bf16 a[0:3], a[212:215], v[34:37], a[0:3]
    s_waitcnt lgkmcnt(6)
    ds_read_b64_tr_b16 a[228:229], v2 offset:19456
    v_mbcnt_hi_u32_b32 v107, -1, v107
    v_mfma_f32_16x16x32_bf16 a[4:7], a[216:219], v[34:37], a[4:7]
    s_add_u32 s39, s39, 12288
    v_fma_f32 v73, v73, s28, v11
    v_fma_f32 v66, v66, s28, v10
    v_mfma_f32_16x16x32_bf16 v[212:215], a[216:219], v[28:31], v[212:215]
    v_fma_f32 v70, v70, s28, v11
    v_and_b32 v106, 15, v107
    v_mfma_f32_16x16x32_bf16 v[164:167], a[216:219], v[22:25], v[164:167]
    v_lshrrev_b32 v107, 4, v107
    v_fma_f32 v56, v56, s28, v9
    v_mfma_f32_16x16x32_bf16 v[116:119], a[216:219], v[16:19], v[116:119]
    s_waitcnt lgkmcnt(5)
    ds_read_b64_tr_b16 a[214:215], v4 offset:13312
    v_mul_u32_u24 v106, 384, v106
    v_mfma_f32_16x16x32_bf16 v[120:123], a[220:223], v[16:19], v[120:123]
    ds_read_b64_tr_b16 a[232:233], v3 offset:19456
    v_fma_f32 v76, v76, s28, v12
    v_mfma_f32_16x16x32_bf16 v[168:171], a[220:223], v[22:25], v[168:171]
    s_add_u32 s48, s33, 24576
    ds_read_b64_tr_b16 a[216:217], v5 offset:19456
    v_lshl_add_u32 v106, v107, 4, v106
    v_mfma_f32_16x16x32_bf16 v[216:219], a[220:223], v[28:31], v[216:219]
    buffer_load_dwordx4 a[208:211], v106, s[12:15], s48 offen offset:256 nt
    v_mfma_f32_16x16x32_bf16 a[8:11], a[220:223], v[34:37], a[8:11]
    s_waitcnt lgkmcnt(5)
    ds_read_b64_tr_b16 a[212:213], v4 offset:19456
    buffer_load_dwordx4 v[92:95], v106, s[12:15], s48 offen offset:320 nt
    v_mfma_f32_16x16x32_bf16 a[12:15], a[224:227], v[34:37], a[12:15]
    ds_read_b128 v[88:91], v103 offset:0
    v_fma_f32 v68, v68, s28, v11
    v_mfma_f32_16x16x32_bf16 v[220:223], a[224:227], v[28:31], v[220:223]
    v_exp_f32 v78, v78
    v_mfma_f32_16x16x32_bf16 v[172:175], a[224:227], v[22:25], v[172:175]
    v_exp_f32 v76, v76
    v_mfma_f32_16x16x32_bf16 v[124:127], a[224:227], v[16:19], v[124:127]
    s_waitcnt lgkmcnt(5)
    v_exp_f32 v79, v79
    v_mfma_f32_16x16x32_bf16 v[128:131], a[228:231], v[16:19], v[128:131]
    ds_read_b64_tr_b16 a[218:219], v5 offset:13312
    v_fma_f32 v67, v67, s28, v10
    v_mfma_f32_16x16x32_bf16 v[176:179], a[228:231], v[22:25], v[176:179]
    ds_read_b64_tr_b16 a[222:223], v2 offset:14336
    v_fma_f32 v58, v58, s28, v9
    v_mfma_f32_16x16x32_bf16 v[224:227], a[228:231], v[28:31], v[224:227]
    ds_read_b64_tr_b16 a[226:227], v3 offset:14336
    v_fma_f32 v59, v59, s28, v9
    v_mfma_f32_16x16x32_bf16 a[16:19], a[228:231], v[34:37], a[16:19]
    s_waitcnt lgkmcnt(5)
    ds_read_b64_tr_b16 a[220:221], v2 offset:20480
    v_fma_f32 v64, v64, s28, v10
    v_mfma_f32_16x16x32_bf16 a[20:23], a[232:235], v[34:37], a[20:23]
    ds_read_b64_tr_b16 a[224:225], v3 offset:20480
    v_fma_f32 v81, v81, s28, v12
    v_mfma_f32_16x16x32_bf16 v[228:231], a[232:235], v[28:31], v[228:231]
    ds_read_b64_tr_b16 a[230:231], v4 offset:14336
    v_fma_f32 v69, v69, s28, v11
    v_mfma_f32_16x16x32_bf16 v[180:183], a[232:235], v[22:25], v[180:183]
    ds_read_b64_tr_b16 a[228:229], v4 offset:20480
    v_fma_f32 v57, v57, s28, v9
    v_mfma_f32_16x16x32_bf16 v[132:135], a[232:235], v[16:19], v[132:135]
    s_waitcnt lgkmcnt(7)
    ds_read_b64_tr_b16 a[234:235], v5 offset:14336
    v_fma_f32 v83, v83, s28, v12
    v_mfma_f32_16x16x32_bf16 v[136:139], a[212:215], v[16:19], v[136:139]
    ds_read_b64_tr_b16 a[232:233], v5 offset:20480
    v_fma_f32 v72, v72, s28, v11
    v_mfma_f32_16x16x32_bf16 v[184:187], a[212:215], v[22:25], v[184:187]
    v_exp_f32 v56, v56
    v_mfma_f32_16x16x32_bf16 v[232:235], a[212:215], v[28:31], v[232:235]
    v_exp_f32 v62, v62
    v_cvt_pk_bf16_f32 v33, v78, v79
    v_mfma_f32_16x16x32_bf16 a[24:27], a[212:215], v[34:37], a[24:27]
    s_waitcnt lgkmcnt(7)
    v_fma_f32 v74, v74, s28, v11
    v_fma_f32 v63, v63, s28, v10
    v_mfma_f32_16x16x32_bf16 a[28:31], a[216:219], v[34:37], a[28:31]
    v_exp_f32 v67, v67
    v_mfma_f32_16x16x32_bf16 v[236:239], a[216:219], v[28:31], v[236:239]
    v_exp_f32 v70, v70
    v_mfma_f32_16x16x32_bf16 v[188:191], a[216:219], v[22:25], v[188:191]
    v_exp_f32 v68, v68
    v_mfma_f32_16x16x32_bf16 v[140:143], a[216:219], v[16:19], v[140:143]
    s_waitcnt lgkmcnt(3)
    v_exp_f32 v71, v71
    v_mfma_f32_16x16x32_bf16 v[144:147], a[220:223], v[16:19], v[144:147]
    v_exp_f32 v63, v63
    v_mfma_f32_16x16x32_bf16 v[192:195], a[220:223], v[22:25], v[192:195]
    v_cvt_pk_bf16_f32 v27, v70, v71
    s_waitcnt vmcnt(12) lgkmcnt(0)
    v_mfma_f32_16x16x32_bf16 v[240:243], a[220:223], v[28:31], v[240:243]
    s_barrier
    v_mfma_f32_16x16x32_bf16 a[32:35], a[220:223], v[34:37], a[32:35]
    ds_read_b128 a[216:219], v1 offset:12288
    v_fma_f32 v80, v80, s28, v12
    v_mfma_f32_16x16x32_bf16 a[36:39], a[224:227], v[34:37], a[36:39]
    s_add_u32 m0, s22, 36864
    v_exp_f32 v80, v80
    v_mfma_f32_16x16x32_bf16 v[244:247], a[224:227], v[28:31], v[244:247]
    buffer_load_dwordx4 v6, s[8:11], s21 offen lds
    v_mfma_f32_16x16x32_bf16 v[196:199], a[224:227], v[22:25], v[196:199]
    s_add_u32 s21, s21, 128
    s_add_u32 m0, s22, 37888
    ds_read_b128 a[212:215], v0 offset:12288
    v_mfma_f32_16x16x32_bf16 v[148:151], a[224:227], v[16:19], v[148:151]
    buffer_load_dwordx4 v6, s[8:11], s21 offen lds
    v_mfma_f32_16x16x32_bf16 v[152:155], a[228:231], v[16:19], v[152:155]
    s_add_u32 s21, s21, 128
    ds_read_b128 a[220:223], v0 offset:13312
    s_add_u32 m0, s22, 38912
    v_mfma_f32_16x16x32_bf16 v[200:203], a[228:231], v[22:25], v[200:203]
    ds_read_b128 a[224:227], v1 offset:13312
    v_fma_f32 v77, v77, s28, v12
    v_mfma_f32_16x16x32_bf16 v[248:251], a[228:231], v[28:31], v[248:251]
    buffer_load_dwordx4 v6, s[8:11], s21 offen lds
    v_mfma_f32_16x16x32_bf16 a[40:43], a[228:231], v[34:37], a[40:43]
    v_exp_f32 v69, v69
    v_mfma_f32_16x16x32_bf16 a[44:47], a[232:235], v[34:37], a[44:47]
    v_exp_f32 v66, v66
    v_mfma_f32_16x16x32_bf16 v[252:255], a[232:235], v[28:31], v[252:255]
    ds_read_b128 v[96:99], v103 offset:1024
    v_cvt_pk_bf16_f32 v21, v62, v63
    v_mfma_f32_16x16x32_bf16 v[204:207], a[232:235], v[22:25], v[204:207]
    buffer_store_dwordx4 v[88:91], v6, s[16:19], s24 offen offset:0 nt
    ds_read_b128 a[228:231], v0 offset:14336
    v_exp_f32 v77, v77
    v_mfma_f32_16x16x32_bf16 v[156:159], a[232:235], v[16:19], v[156:159]
    s_waitcnt lgkmcnt(4)
    v_exp_f32 v74, v74
    v_mfma_f32_16x16x32_bf16 v[52:55], a[212:215], a[96:99], 0
    v_exp_f32 v73, v73
    v_mfma_f32_16x16x32_bf16 v[52:55], a[216:219], a[100:103], v[52:55]
    s_waitcnt lgkmcnt(3)
    v_exp_f32 v64, v64
    v_mfma_f32_16x16x32_bf16 v[52:55], a[220:223], a[104:107], v[52:55]
    s_add_u32 s21, s21, 12032
    ds_read_b128 a[232:235], v1 offset:14336
    s_add_u32 m0, s38, 24576
    v_mfma_f32_16x16x32_bf16 v[60:63], a[220:223], a[128:131], 0
    v_fma_f32 v82, v82, s28, v12
    v_cvt_pk_bf16_f32 v32, v76, v77
    v_mfma_f32_16x16x32_bf16 v[60:63], a[216:219], a[124:127], v[60:63]
    v_exp_f32 v82, v82
    v_mfma_f32_16x16x32_bf16 v[60:63], a[212:215], a[120:123], v[60:63]
    v_fma_f32 v75, v75, s28, v11
    v_cvt_pk_bf16_f32 v26, v68, v69
    v_mfma_f32_16x16x32_bf16 v[68:71], a[212:215], a[144:147], 0
    v_exp_f32 v57, v57
    v_mfma_f32_16x16x32_bf16 v[68:71], a[216:219], a[148:151], v[68:71]
    v_exp_f32 v58, v58
    v_mfma_f32_16x16x32_bf16 v[68:71], a[220:223], a[152:155], v[68:71]
    v_exp_f32 v75, v75
    v_mfma_f32_16x16x32_bf16 v[76:79], a[220:223], a[176:179], 0
    buffer_load_dwordx4 v6, s[12:15], s25 offen nt lds
    v_mfma_f32_16x16x32_bf16 v[76:79], a[216:219], a[172:175], v[76:79]
    v_exp_f32 v65, v65
    v_mfma_f32_16x16x32_bf16 v[76:79], a[212:215], a[168:171], v[76:79]
    s_add_u32 m0, s38, 25600
    v_cvt_pk_bf16_f32 v22, v64, v65
    s_waitcnt lgkmcnt(1)
    v_mfma_f32_16x16x32_bf16 v[76:79], a[224:227], a[180:183], v[76:79]
    v_exp_f32 v72, v72
    v_mfma_f32_16x16x32_bf16 v[76:79], a[228:231], a[184:187], v[76:79]
    s_waitcnt lgkmcnt(0)
    ds_read_b128 a[220:223], v0 offset:19456
    v_cvt_pk_bf16_f32 v28, v72, v73
    v_mfma_f32_16x16x32_bf16 v[76:79], a[232:235], a[188:191], v[76:79]
    ds_read_b128 v[88:91], v103 offset:3072
    v_cvt_pk_bf16_f32 v16, v56, v57
    v_mfma_f32_16x16x32_bf16 v[68:71], a[232:235], a[164:167], v[68:71]
    v_exp_f32 v59, v59
    v_mfma_f32_16x16x32_bf16 v[68:71], a[228:231], a[160:163], v[68:71]
    ds_read_b128 a[216:219], v1 offset:18432
    v_mfma_f32_16x16x32_bf16 v[68:71], a[224:227], a[156:159], v[68:71]
    ds_read_b128 v[84:87], v103 offset:2048
    v_mfma_f32_16x16x32_bf16 v[60:63], a[224:227], a[132:135], v[60:63]
    v_exp_f32 v81, v81
    v_mfma_f32_16x16x32_bf16 v[60:63], a[228:231], a[136:139], v[60:63]
    ds_read_b128 a[212:215], v0 offset:18432
    v_cvt_pk_bf16_f32 v17, v58, v59
    v_mfma_f32_16x16x32_bf16 v[60:63], a[232:235], a[140:143], v[60:63]
    buffer_load_dwordx4 v7, s[12:15], s25 offen nt lds
    v_mfma_f32_16x16x32_bf16 v[52:55], a[232:235], a[116:119], v[52:55]
    v_cvt_pk_bf16_f32 v23, v66, v67
    v_cvt_pk_bf16_f32 v29, v74, v75
    v_mfma_f32_16x16x32_bf16 v[52:55], a[228:231], a[112:115], v[52:55]
    v_exp_f32 v83, v83
    v_mfma_f32_16x16x32_bf16 v[52:55], a[224:227], a[108:111], v[52:55]
    ds_read_b128 a[224:227], v1 offset:19456
    v_cvt_pk_bf16_f32 v34, v80, v81
    v_mfma_f32_16x16x32_bf16 v[44:47], a[236:239], v[14:17], v[48:51]
    s_add_u32 s57, s24, 128
    ds_read_b128 a[228:231], v0 offset:20480
    v_mfma_f32_16x16x32_bf16 v[44:47], a[240:243], v[20:23], v[44:47]
    ds_read_b128 a[232:235], v1 offset:20480
    v_cvt_pk_bf16_f32 v35, v82, v83
    v_mfma_f32_16x16x32_bf16 v[44:47], a[244:247], v[26:29], v[44:47]
    s_nop 0
    v_mfma_f32_16x16x32_bf16 v[44:47], a[248:251], v[32:35], v[44:47]
    buffer_store_dwordx4 v[96:99], v7, s[16:19], s24 offen offset:0 nt
    s_waitcnt lgkmcnt(3)
    v_mfma_f32_16x16x32_bf16 v[56:59], a[212:215], a[96:99], 0
    s_add_u32 s59, s25, 128
    s_add_u32 m0, s38, 26624
    v_mfma_f32_16x16x32_bf16 v[56:59], a[216:219], a[100:103], v[56:59]
    buffer_load_dwordx4 v6, s[12:15], s59 offen nt lds
    v_mfma_f32_16x16x32_bf16 v[56:59], a[220:223], a[104:107], v[56:59]
    v_cmp_lt_f32 vcc, s29, v44
    s_add_u32 m0, s38, 27648
    v_mfma_f32_16x16x32_bf16 v[64:67], a[220:223], a[128:131], 0
    buffer_load_dwordx4 v7, s[12:15], s59 offen nt lds
    v_mfma_f32_16x16x32_bf16 v[64:67], a[216:219], a[124:127], v[64:67]
    s_nop 0
    s_cbranch_vccnz L_rs_tr45a
L_ret_tr45a:
    v_fma_f32 v53, v53, s28, v9
    v_mfma_f32_16x16x32_bf16 v[64:67], a[212:215], a[120:123], v[64:67]
    v_exp_f32 v53, v53
    v_mfma_f32_16x16x32_bf16 v[72:75], a[212:215], a[144:147], 0
    s_waitcnt vmcnt(14) lgkmcnt(0)
    v_fma_f32 v61, v61, s28, v10
    s_add_u32 m0, s22, 12288
    v_mfma_f32_16x16x32_bf16 v[72:75], a[216:219], a[148:151], v[72:75]
    s_barrier
    v_mfma_f32_16x16x32_bf16 v[72:75], a[220:223], a[152:155], v[72:75]
    buffer_load_dwordx4 v6, s[4:7], s20 offen lds
    v_mfma_f32_16x16x32_bf16 v[80:83], a[220:223], a[176:179], 0
    s_add_u32 s20, s20, 128
    s_add_u32 m0, s22, 13312
    v_fma_f32 v52, v52, s28, v9
    v_mfma_f32_16x16x32_bf16 v[80:83], a[216:219], a[172:175], v[80:83]
    buffer_load_dwordx4 v6, s[4:7], s20 offen lds
    v_mfma_f32_16x16x32_bf16 v[80:83], a[212:215], a[168:171], v[80:83]
    s_add_u32 s20, s20, 128
    ds_read_b64_tr_b16 a[212:213], v2 offset:0
    v_fma_f32 v54, v54, s28, v9
    v_mfma_f32_16x16x32_bf16 v[80:83], a[224:227], a[180:183], v[80:83]
    s_add_u32 m0, s22, 14336
    ds_read_b64_tr_b16 a[214:215], v2 offset:6144
    v_fma_f32 v60, v60, s28, v10
    v_mfma_f32_16x16x32_bf16 v[80:83], a[228:231], a[184:187], v[80:83]
    buffer_load_dwordx4 v6, s[4:7], s20 offen lds
    v_mfma_f32_16x16x32_bf16 v[80:83], a[232:235], a[188:191], v[80:83]
    v_exp_f32 v60, v60
    v_mfma_f32_16x16x32_bf16 v[72:75], a[232:235], a[164:167], v[72:75]
    ds_read_b64_tr_b16 a[216:217], v3 offset:0
    v_fma_f32 v55, v55, s28, v9
    v_mfma_f32_16x16x32_bf16 v[72:75], a[228:231], a[160:163], v[72:75]
    buffer_store_dwordx4 v[84:87], v6, s[16:19], s57 offen offset:0 nt
    ds_read_b64_tr_b16 a[218:219], v3 offset:6144
    v_exp_f32 v52, v52
    v_mfma_f32_16x16x32_bf16 v[72:75], a[224:227], a[156:159], v[72:75]
    v_exp_f32 v61, v61
    v_mfma_f32_16x16x32_bf16 v[64:67], a[224:227], a[132:135], v[64:67]
    buffer_store_dwordx4 v[88:91], v7, s[16:19], s57 offen offset:0 nt
    ds_read_b64_tr_b16 a[220:221], v4 offset:0
    v_mfma_f32_16x16x32_bf16 v[64:67], a[228:231], a[136:139], v[64:67]
    v_exp_f32 v54, v54
    v_mfma_f32_16x16x32_bf16 v[64:67], a[232:235], a[140:143], v[64:67]
    v_exp_f32 v55, v55
    v_mfma_f32_16x16x32_bf16 v[56:59], a[232:235], a[116:119], v[56:59]
    v_cvt_pk_bf16_f32 v19, v54, v55
    v_cvt_pk_bf16_f32 v24, v60, v61
    v_mfma_f32_16x16x32_bf16 v[56:59], a[228:231], a[112:115], v[56:59]
    s_add_u32 s20, s20, 12032
    ds_read_b64_tr_b16 a[222:223], v4 offset:6144
    v_cvt_pk_bf16_f32 v18, v52, v53
    v_mfma_f32_16x16x32_bf16 v[56:59], a[224:227], a[108:111], v[56:59]
    ds_read_b64_tr_b16 a[224:225], v5 offset:0
    ds_read_b64_tr_b16 a[226:227], v5 offset:6144
    s_waitcnt lgkmcnt(6)
    v_mfma_f32_16x16x32_bf16 v[112:115], a[212:215], v[14:17], v[112:115]
    ds_read_b64_tr_b16 a[232:233], v3 offset:1024
    s_nop 2
    v_fma_f32 v58, v58, s28, v9
    v_mfma_f32_16x16x32_bf16 v[160:163], a[212:215], v[20:23], v[160:163]
    v_fma_f32 v70, v70, s28, v11
    v_fma_f32 v71, v71, s28, v11
    v_fma_f32 v59, v59, s28, v9
    v_mfma_f32_16x16x32_bf16 v[208:211], a[212:215], v[26:29], v[208:211]
    ds_read_b64_tr_b16 a[228:229], v2 offset:1024
    v_fma_f32 v63, v63, s28, v10
    v_lshrrev_b32 v105, 11, v0
    v_mfma_f32_16x16x32_bf16 a[0:3], a[212:215], v[32:35], a[0:3]
    s_waitcnt lgkmcnt(6)
    ds_read_b64_tr_b16 a[230:231], v2 offset:7168
    v_fma_f32 v56, v56, s28, v9
    v_mfma_f32_16x16x32_bf16 a[4:7], a[216:219], v[32:35], a[4:7]
    ds_read_b64_tr_b16 a[212:213], v4 offset:1024
    v_and_b32 v104, 0x3ff, v0
    v_mfma_f32_16x16x32_bf16 v[212:215], a[216:219], v[26:29], v[212:215]
    ds_read_b64_tr_b16 a[214:215], v4 offset:7168
    v_fma_f32 v69, v69, s28, v11
    v_mfma_f32_16x16x32_bf16 v[164:167], a[216:219], v[20:23], v[164:167]
    v_fma_f32 v68, v68, s28, v11
    v_xor_b32 v105, s65, v105
    v_mfma_f32_16x16x32_bf16 v[116:119], a[216:219], v[14:17], v[116:119]
    s_waitcnt lgkmcnt(7)
    ds_read_b64_tr_b16 a[234:235], v3 offset:7168
    v_fma_f32 v57, v57, s28, v9
    v_mfma_f32_16x16x32_bf16 v[120:123], a[220:223], v[14:17], v[120:123]
    v_lshl_add_u32 v104, v105, 10, v104
    v_fma_f32 v82, v82, s28, v12
    v_mfma_f32_16x16x32_bf16 v[168:171], a[220:223], v[20:23], v[168:171]
    ds_read_b64_tr_b16 a[218:219], v5 offset:7168
    v_add_u32 v104, s38, v104
    v_mfma_f32_16x16x32_bf16 v[216:219], a[220:223], v[26:29], v[216:219]
    ds_read_b128 a[168:171], v104 offset:18432
    v_exp_f32 v70, v70
    v_mfma_f32_16x16x32_bf16 a[8:11], a[220:223], v[32:35], a[8:11]
    s_waitcnt lgkmcnt(7)
    v_exp_f32 v56, v56
    v_mfma_f32_16x16x32_bf16 a[12:15], a[224:227], v[32:35], a[12:15]
    v_exp_f32 v71, v71
    v_mfma_f32_16x16x32_bf16 v[220:223], a[224:227], v[26:29], v[220:223]
    ds_read_b64_tr_b16 a[216:217], v5 offset:1024
    v_fma_f32 v73, v73, s28, v11
    v_mfma_f32_16x16x32_bf16 v[172:175], a[224:227], v[20:23], v[172:175]
    v_exp_f32 v68, v68
    v_mfma_f32_16x16x32_bf16 v[124:127], a[224:227], v[14:17], v[124:127]
    s_waitcnt lgkmcnt(4)
    ds_read_b64_tr_b16 a[222:223], v2 offset:8192
    v_fma_f32 v80, v80, s28, v12
    v_mfma_f32_16x16x32_bf16 v[128:131], a[228:231], v[14:17], v[128:131]
    ds_read_b64_tr_b16 a[220:221], v2 offset:2048
    v_fma_f32 v75, v75, s28, v11
    v_mfma_f32_16x16x32_bf16 v[176:179], a[228:231], v[20:23], v[176:179]
    ds_read_b128 a[104:107], v104 offset:2048
    v_fma_f32 v77, v77, s28, v12
    v_mfma_f32_16x16x32_bf16 v[224:227], a[228:231], v[26:29], v[224:227]
    ds_read_b64_tr_b16 a[226:227], v3 offset:8192
    v_fma_f32 v76, v76, s28, v12
    v_mfma_f32_16x16x32_bf16 a[16:19], a[228:231], v[32:35], a[16:19]
    s_waitcnt lgkmcnt(6)
    ds_read_b64_tr_b16 a[228:229], v4 offset:2048
    v_fma_f32 v78, v78, s28, v12
    v_mfma_f32_16x16x32_bf16 a[20:23], a[232:235], v[32:35], a[20:23]
    ds_read_b64_tr_b16 a[224:225], v3 offset:2048
    v_fma_f32 v79, v79, s28, v12
    v_mfma_f32_16x16x32_bf16 v[228:231], a[232:235], v[26:29], v[228:231]
    ds_read_b64_tr_b16 a[230:231], v4 offset:8192
    v_fma_f32 v74, v74, s28, v11
    v_mfma_f32_16x16x32_bf16 v[180:183], a[232:235], v[20:23], v[180:183]
    ds_read_b128 a[152:155], v104 offset:14336
    v_fma_f32 v66, v66, s28, v10
    v_mfma_f32_16x16x32_bf16 v[132:135], a[232:235], v[14:17], v[132:135]
    ds_read_b64_tr_b16 a[232:233], v5 offset:2048
    v_fma_f32 v67, v67, s28, v10
    v_mfma_f32_16x16x32_bf16 v[136:139], a[212:215], v[14:17], v[136:139]
    ds_read_b64_tr_b16 a[234:235], v5 offset:8192
    v_exp_f32 v78, v78
    v_mfma_f32_16x16x32_bf16 v[184:187], a[212:215], v[20:23], v[184:187]
    v_exp_f32 v79, v79
    v_mfma_f32_16x16x32_bf16 v[232:235], a[212:215], v[26:29], v[232:235]
    ds_read_b128 a[176:179], v104 offset:20480
    v_fma_f32 v62, v62, s28, v10
    v_mfma_f32_16x16x32_bf16 a[24:27], a[212:215], v[32:35], a[24:27]
    s_waitcnt lgkmcnt(8)
    ds_read_b128 a[144:147], v104 offset:12288
    v_exp_f32 v63, v63
    v_mfma_f32_16x16x32_bf16 a[28:31], a[216:219], v[32:35], a[28:31]
    v_exp_f32 v62, v62
    v_mfma_f32_16x16x32_bf16 v[236:239], a[216:219], v[26:29], v[236:239]
    s_add_u32 s39, s39, 12288
    ds_read_b128 a[96:99], v104 offset:0
    v_xor_b32 v105, 64, v104
    v_mfma_f32_16x16x32_bf16 v[188:191], a[216:219], v[20:23], v[188:191]
    ds_read_b128 a[120:123], v104 offset:6144
    v_exp_f32 v73, v73
    v_mfma_f32_16x16x32_bf16 v[140:143], a[216:219], v[14:17], v[140:143]
    ds_read_b128 a[172:175], v105 offset:18432
    v_fma_f32 v64, v64, s28, v10
    v_mfma_f32_16x16x32_bf16 v[144:147], a[220:223], v[14:17], v[144:147]
    v_exp_f32 v77, v77
    v_mfma_f32_16x16x32_bf16 v[192:195], a[220:223], v[20:23], v[192:195]
    s_waitcnt vmcnt(16) lgkmcnt(5)
    s_add_u32 s21, s21, s62
    ds_read_b128 a[180:183], v105 offset:20480
    v_mfma_f32_16x16x32_bf16 v[240:243], a[220:223], v[26:29], v[240:243]
    s_barrier
    ds_read_b128 a[212:215], v0 offset:0
    v_mfma_f32_16x16x32_bf16 a[32:35], a[220:223], v[32:35], a[32:35]
    s_add_u32 m0, s22, 24576
    ds_read_b128 a[216:219], v1 offset:0
    buffer_load_dwordx4 v6, s[8:11], s21 offen lds
    v_mfma_f32_16x16x32_bf16 a[36:39], a[224:227], v[32:35], a[36:39]
    s_add_u32 s21, s21, 128
    v_exp_f32 v76, v76
    v_mfma_f32_16x16x32_bf16 v[244:247], a[224:227], v[26:29], v[244:247]
    s_add_u32 m0, s22, 25600
    ds_read_b128 a[124:127], v105 offset:6144
    buffer_load_dwordx4 v6, s[8:11], s21 offen lds
    v_mfma_f32_16x16x32_bf16 v[196:199], a[224:227], v[20:23], v[196:199]
    s_add_u32 s21, s21, 128
    v_exp_f32 v69, v69
    v_mfma_f32_16x16x32_bf16 v[148:151], a[224:227], v[14:17], v[148:151]
    s_add_u32 m0, s22, 26624
    ds_read_b128 a[100:103], v105 offset:0
    v_cvt_pk_bf16_f32 v37, v78, v79
    v_mfma_f32_16x16x32_bf16 v[152:155], a[228:231], v[14:17], v[152:155]
    ds_read_b128 a[220:223], v0 offset:1024
    buffer_load_dwordx4 v6, s[8:11], s21 offen lds
    v_mfma_f32_16x16x32_bf16 v[200:203], a[228:231], v[20:23], v[200:203]
    s_add_u32 s21, s21, 12032
    ds_read_b128 a[188:191], v105 offset:22528
    v_cvt_pk_bf16_f32 v25, v62, v63
    v_mfma_f32_16x16x32_bf16 v[248:251], a[228:231], v[26:29], v[248:251]
    s_waitcnt vmcnt(11)
    ds_read_b128 a[192:195], v104 offset:24576
    v_cvt_pk_bf16_f32 v30, v68, v69
    v_mfma_f32_16x16x32_bf16 a[40:43], a[228:231], v[32:35], a[40:43]
    ds_read_b128 a[224:227], v1 offset:1024
    v_cvt_pk_bf16_f32 v31, v70, v71
    v_mfma_f32_16x16x32_bf16 a[44:47], a[232:235], v[32:35], a[44:47]
    ds_read_b128 a[148:151], v105 offset:12288
    v_fma_f32 v65, v65, s28, v10
    v_mfma_f32_16x16x32_bf16 v[252:255], a[232:235], v[26:29], v[252:255]
    ds_read_b128 a[196:199], v105 offset:24576
    v_exp_f32 v57, v57
    v_mfma_f32_16x16x32_bf16 v[204:207], a[232:235], v[20:23], v[204:207]
    v_exp_f32 v59, v59
    v_mfma_f32_16x16x32_bf16 v[156:159], a[232:235], v[14:17], v[156:159]
    s_waitcnt lgkmcnt(7)
    ds_read_b128 a[132:135], v105 offset:8192
    v_exp_f32 v65, v65
    v_mfma_f32_16x16x32_bf16 v[52:55], a[212:215], a[96:99], 0
    ds_read_b128 a[128:131], v104 offset:8192
    v_cvt_pk_bf16_f32 v36, v76, v77
    v_mfma_f32_16x16x32_bf16 v[60:63], a[212:215], a[120:123], 0
    v_exp_f32 v58, v58
    v_mfma_f32_16x16x32_bf16 v[68:71], a[212:215], a[144:147], 0
    ds_read_b128 a[112:115], v104 offset:4096
    v_cvt_pk_bf16_f32 v16, v56, v57
    v_mfma_f32_16x16x32_bf16 v[76:79], a[212:215], a[168:171], 0
    s_waitcnt vmcnt(8)
    ds_read_b128 a[200:203], v104 offset:26624
    s_waitcnt lgkmcnt(7)
    v_mfma_f32_16x16x32_bf16 v[84:87], a[212:215], a[192:195], 0
    ds_read_b128 a[108:111], v105 offset:2048
    v_fma_f32 v72, v72, s28, v11
    v_mfma_f32_16x16x32_bf16 v[52:55], a[216:219], a[100:103], v[52:55]
    v_exp_f32 v66, v66
    v_mfma_f32_16x16x32_bf16 v[60:63], a[216:219], a[124:127], v[60:63]
    s_waitcnt lgkmcnt(6)
    ds_read_b128 a[204:207], v105 offset:26624
    v_cvt_pk_bf16_f32 v17, v58, v59
    v_mfma_f32_16x16x32_bf16 v[68:71], a[216:219], a[148:151], v[68:71]
    ds_read_b128 a[156:159], v105 offset:14336
    v_mfma_f32_16x16x32_bf16 v[76:79], a[216:219], a[172:175], v[76:79]
    s_waitcnt lgkmcnt(7)
    v_exp_f32 v64, v64
    v_mfma_f32_16x16x32_bf16 v[84:87], a[216:219], a[196:199], v[84:87]
    ds_read_b128 a[228:231], v0 offset:6144
    v_cvt_pk_bf16_f32 v22, v64, v65
    v_mfma_f32_16x16x32_bf16 v[52:55], a[220:223], a[104:107], v[52:55]
    v_exp_f32 v72, v72
    v_mfma_f32_16x16x32_bf16 v[48:51], a[236:239], v[16:19], v[44:47]
    s_waitcnt lgkmcnt(6)
    v_fma_f32 v83, v83, s28, v12
    v_fma_f32 v81, v81, s28, v12
    v_mfma_f32_16x16x32_bf16 v[60:63], a[220:223], a[128:131], v[60:63]
    v_exp_f32 v67, v67
    v_mfma_f32_16x16x32_bf16 v[68:71], a[220:223], a[152:155], v[68:71]
    v_exp_f32 v74, v74
    v_mfma_f32_16x16x32_bf16 v[76:79], a[220:223], a[176:179], v[76:79]
    s_waitcnt lgkmcnt(3)
    v_exp_f32 v81, v81
    v_mfma_f32_16x16x32_bf16 v[84:87], a[220:223], a[200:203], v[84:87]
    v_exp_f32 v75, v75
    v_mfma_f32_16x16x32_bf16 v[52:55], a[224:227], a[108:111], v[52:55]
    v_exp_f32 v80, v80
    v_mfma_f32_16x16x32_bf16 v[60:63], a[224:227], a[132:135], v[60:63]
    s_waitcnt lgkmcnt(1)
    ds_read_b128 a[164:167], v105 offset:16384
    v_cvt_pk_bf16_f32 v28, v72, v73
    v_mfma_f32_16x16x32_bf16 v[68:71], a[224:227], a[156:159], v[68:71]
    ds_read_b128 a[232:235], v1 offset:6144
    v_cvt_pk_bf16_f32 v23, v66, v67
    v_mfma_f32_16x16x32_bf16 v[76:79], a[224:227], a[180:183], v[76:79]
    v_exp_f32 v82, v82
    v_mfma_f32_16x16x32_bf16 v[48:51], a[240:243], v[22:25], v[48:51]
    ds_read_b128 a[212:215], v0 offset:7168
    v_cvt_pk_bf16_f32 v29, v74, v75
    v_mfma_f32_16x16x32_bf16 v[84:87], a[224:227], a[204:207], v[84:87]
    s_waitcnt lgkmcnt(3)
    ds_read_b128 a[140:143], v105 offset:10240
    v_mfma_f32_16x16x32_bf16 v[56:59], a[228:231], a[96:99], 0
    v_cvt_pk_bf16_f32 v34, v80, v81
    v_mfma_f32_16x16x32_bf16 v[48:51], a[244:247], v[28:31], v[48:51]
    v_exp_f32 v83, v83
    v_mfma_f32_16x16x32_bf16 v[64:67], a[228:231], a[120:123], 0
    ds_read_b128 a[184:187], v104 offset:22528
    v_cvt_pk_bf16_f32 v35, v82, v83
    v_mfma_f32_16x16x32_bf16 v[72:75], a[228:231], a[144:147], 0
    ds_read_b128 a[216:219], v1 offset:7168
    v_mfma_f32_16x16x32_bf16 v[48:51], a[248:251], v[34:37], v[48:51]
    ds_read_b128 a[116:119], v105 offset:4096
    v_mfma_f32_16x16x32_bf16 v[80:83], a[228:231], a[168:171], 0
    ds_read_b128 a[136:139], v104 offset:10240
    v_mfma_f32_16x16x32_bf16 v[88:91], a[228:231], a[192:195], 0
    s_waitcnt lgkmcnt(6)
    ds_read_b128 a[228:231], v0 offset:8192
    v_mfma_f32_16x16x32_bf16 v[56:59], a[232:235], a[100:103], v[56:59]
    v_mfma_f32_16x16x32_bf16 v[64:67], a[232:235], a[124:127], v[64:67]
    ds_read_b128 a[160:163], v104 offset:16384
    v_cmp_lt_f32 vcc, s29, v48
    v_mfma_f32_16x16x32_bf16 v[72:75], a[232:235], a[148:151], v[72:75]
    ds_read_b128 a[224:227], v1 offset:2048
    v_mfma_f32_16x16x32_bf16 v[80:83], a[232:235], a[172:175], v[80:83]
    ds_read_b128 a[220:223], v0 offset:2048
    v_mfma_f32_16x16x32_bf16 v[88:91], a[232:235], a[196:199], v[88:91]
    s_waitcnt lgkmcnt(8)
    ds_read_b128 a[232:235], v1 offset:8192
    v_mfma_f32_16x16x32_bf16 v[56:59], a[212:215], a[104:107], v[56:59]
    s_cbranch_vccnz L_rs_tr45b
L_ret_tr45b:
    v_mov_b32 v100, v48
    v_mfma_f32_16x16x32_bf16 v[64:67], a[212:215], a[128:131], v[64:67]
    v_lshrrev_b32 v108, 11, v0
    s_waitcnt vmcnt(17)
    v_mfma_f32_16x16x32_bf16 v[72:75], a[212:215], a[152:155], v[72:75]
    v_rcp_f32 v102, v49
    v_mfma_f32_16x16x32_bf16 v[80:83], a[212:215], a[176:179], v[80:83]
    v_and_b32 v101, 0x3ff, v0
    v_mfma_f32_16x16x32_bf16 v[88:91], a[212:215], a[200:203], v[88:91]
    s_waitcnt lgkmcnt(4)
    v_mfma_f32_16x16x32_bf16 v[56:59], a[216:219], a[108:111], v[56:59]
    v_mfma_f32_16x16x32_bf16 v[64:67], a[216:219], a[132:135], v[64:67]
    v_xor_b32 v108, s65, v108
    v_lshl_add_u32 v101, v108, 10, v101
    v_mfma_f32_16x16x32_bf16 v[72:75], a[216:219], a[156:159], v[72:75]
    v_mbcnt_lo_u32_b32 v108, -1, 0
    v_mfma_f32_16x16x32_bf16 v[80:83], a[216:219], a[180:183], v[80:83]
    v_mbcnt_hi_u32_b32 v108, -1, v108
    s_waitcnt vmcnt(14) lgkmcnt(0)
    v_mfma_f32_16x16x32_bf16 v[88:91], a[216:219], a[204:207], v[88:91]
    s_barrier
    v_mfma_f32_16x16x32_bf16 v[52:55], a[220:223], a[112:115], v[52:55]
    s_add_u32 m0, s22, 0
    ds_read_b64_tr_b16 a[212:213], v2 offset:18432
    v_mfma_f32_16x16x32_bf16 v[60:63], a[220:223], a[136:139], v[60:63]
    buffer_load_dwordx4 v6, s[4:7], s20 offen lds
    v_mfma_f32_16x16x32_bf16 v[68:71], a[220:223], a[160:163], v[68:71]
    s_add_u32 s20, s20, 128
    v_lshrrev_b32 v108, 1, v108
    v_mfma_f32_16x16x32_bf16 v[76:79], a[220:223], a[184:187], v[76:79]
    s_add_u32 m0, s22, 1024
    v_permlane32_swap_b32 v48, v100
    v_mfma_f32_16x16x32_bf16 v[84:87], a[220:223], a[208:211], v[84:87]
    buffer_load_dwordx4 v6, s[4:7], s20 offen lds
    v_mfma_f32_16x16x32_bf16 v[52:55], a[224:227], a[116:119], v[52:55]
    s_add_u32 s20, s20, 128
    s_add_u32 m0, s22, 2048
    ds_read_b64_tr_b16 a[214:215], v2 offset:12288
    v_mfma_f32_16x16x32_bf16 v[60:63], a[224:227], a[140:143], v[60:63]
    v_add_u32 v101, s38, v101
    v_mfma_f32_16x16x32_bf16 v[68:71], a[224:227], a[164:167], v[68:71]
    buffer_load_dwordx4 v6, s[4:7], s20 offen lds
    v_mfma_f32_16x16x32_bf16 v[76:79], a[224:227], a[188:191], v[76:79]
    ds_read_b64_tr_b16 a[216:217], v3 offset:18432
    v_and_b32 v108, 24, v108
    v_mfma_f32_16x16x32_bf16 v[84:87], a[224:227], v[92:95], v[84:87]
    v_rcp_f32 v50, v50
    v_mfma_f32_16x16x32_bf16 v[56:59], a[228:231], a[112:115], v[56:59]
    ds_read_b64_tr_b16 a[218:219], v3 offset:12288
    v_mfma_f32_16x16x32_bf16 v[64:67], a[228:231], a[136:139], v[64:67]
    v_rcp_f32 v48, v48
    v_mfma_f32_16x16x32_bf16 v[72:75], a[228:231], a[160:163], v[72:75]
    ds_read_b64_tr_b16 a[220:221], v4 offset:18432
    v_mfma_f32_16x16x32_bf16 v[80:83], a[228:231], a[184:187], v[80:83]
    s_add_u32 s20, s20, 12032
    ds_read_b64_tr_b16 a[222:223], v4 offset:12288
    v_mfma_f32_16x16x32_bf16 v[88:91], a[228:231], a[208:211], v[88:91]
    ds_read_b64_tr_b16 a[224:225], v5 offset:18432
    v_mfma_f32_16x16x32_bf16 v[56:59], a[232:235], a[116:119], v[56:59]
    v_rcp_f32 v8, v51
    v_mfma_f32_16x16x32_bf16 v[64:67], a[232:235], a[140:143], v[64:67]
    ds_read_b64_tr_b16 a[226:227], v5 offset:12288
    v_bfe_u32 v108, s66, v108, 8
    v_mfma_f32_16x16x32_bf16 v[72:75], a[232:235], a[164:167], v[72:75]
    v_xor_b32 v101, v101, v108
    v_mfma_f32_16x16x32_bf16 v[80:83], a[232:235], a[188:191], v[80:83]
    v_mfma_f32_16x16x32_bf16 v[88:91], a[232:235], v[92:95], v[88:91]
    v_max3_f32 v98, v60, v61, v62
    v_max3_f32 v96, v52, v53, v54
    v_max3_f32 v96, v96, v55, v56
    v_max3_f32 v98, v98, v63, v64
    v_max3_f32 v96, v96, v57, v58
    v_max3_f32 v98, v98, v65, v66
    s_waitcnt lgkmcnt(6)
    v_mfma_f32_16x16x32_bf16 v[112:115], a[212:215], v[16:19], v[112:115]
    v_max_f32 v96, v96, v59
    v_mov_b32 v97, v96
    v_mfma_f32_16x16x32_bf16 v[160:163], a[212:215], v[22:25], v[160:163]
    s_mov_b32 s67, s34
    ds_read_b64_tr_b16 a[230:231], v2 offset:13312
    v_permlane32_swap_b32 v97, v96
    v_mfma_f32_16x16x32_bf16 v[208:211], a[212:215], v[28:31], v[208:211]
    s_add_u32 s18, s34, 24576
    ds_read_b64_tr_b16 a[228:229], v2 offset:19456
    v_max_f32 v96, v96, v97
    v_mfma_f32_16x16x32_bf16 a[0:3], a[212:215], v[34:37], a[0:3]
    s_waitcnt lgkmcnt(6)
    v_max_f32 v98, v98, v67
    v_mov_b32 v97, v96
    v_mfma_f32_16x16x32_bf16 a[4:7], a[216:219], v[34:37], a[4:7]
    s_nop 0
    v_permlane16_swap_b32 v97, v96
    v_mfma_f32_16x16x32_bf16 v[212:215], a[216:219], v[28:31], v[212:215]
    s_mov_b32 s34, s33
    v_max_f32 v96, v96, v97
    v_mov_b32 v99, v98
    v_mfma_f32_16x16x32_bf16 v[164:167], a[216:219], v[22:25], v[164:167]
    s_add_u32 s64, s64, s62
    ds_read_b64_tr_b16 a[234:235], v3 offset:13312
    v_permlane32_swap_b32 v99, v98
    v_mfma_f32_16x16x32_bf16 v[116:119], a[216:219], v[16:19], v[116:119]
    s_waitcnt lgkmcnt(3)
    ds_read_b64_tr_b16 a[212:213], v4 offset:19456
    v_max_f32 v98, v98, v99
    v_mfma_f32_16x16x32_bf16 v[120:123], a[220:223], v[16:19], v[120:123]
    s_add_u32 s64, s64, 196608
    v_mov_b32 v99, v98
    v_mul_f32_e64 v9, -s28, v96
    v_mfma_f32_16x16x32_bf16 v[168:171], a[220:223], v[22:25], v[168:171]
    s_mov_b32 s39, s64
    ds_read_b64_tr_b16 a[214:215], v4 offset:13312
    v_fma_f32 v53, v53, s28, v9
    v_mfma_f32_16x16x32_bf16 v[216:219], a[220:223], v[28:31], v[216:219]
    s_add_u32 s37, s37, 1
    ds_read_b64_tr_b16 a[216:217], v5 offset:19456
    v_fma_f32 v58, v58, s28, v9
    v_mfma_f32_16x16x32_bf16 a[8:11], a[220:223], v[34:37], a[8:11]
    s_bitcmp1_b32 s63, s37
    ds_read_b64_tr_b16 a[222:223], v2 offset:14336
    v_max3_f32 v96, v68, v69, v70
    v_mfma_f32_16x16x32_bf16 a[12:15], a[224:227], v[34:37], a[12:15]
    ds_read_b64_tr_b16 a[232:233], v3 offset:19456
    v_max3_f32 v96, v96, v71, v72
    v_max3_f32 v96, v96, v73, v74
    v_mfma_f32_16x16x32_bf16 v[220:223], a[224:227], v[28:31], v[220:223]
    s_cselect_b32 s62, 4294770688, 0
    ds_read_b64_tr_b16 a[220:221], v2 offset:20480
    v_permlane16_swap_b32 v99, v98
    v_accvgpr_read_b32 v109, a5
    v_mfma_f32_16x16x32_bf16 v[172:175], a[224:227], v[22:25], v[172:175]
    s_cselect_b32 s42, 0, 325632
    v_fma_f32 v54, v54, s28, v9
    v_max_f32 v98, v98, v99
    v_max_f32 v96, v96, v75
    v_mfma_f32_16x16x32_bf16 v[124:127], a[224:227], v[16:19], v[124:127]
    s_waitcnt lgkmcnt(6)
    ds_read_b64_tr_b16 a[218:219], v5 offset:13312
    v_mov_b32 v97, v96
    v_mfma_f32_16x16x32_bf16 v[128:131], a[228:231], v[16:19], v[128:131]
    s_add_u32 s35, s35, s42
    ds_read_b64_tr_b16 a[226:227], v3 offset:14336
    v_mul_f32_e64 v10, -s28, v98
    v_permlane32_swap_b32 v97, v96
    v_mfma_f32_16x16x32_bf16 v[176:179], a[228:231], v[22:25], v[176:179]
    s_lshl_b32 s42, s37, 1
    v_max_f32 v96, v96, v97
    v_mov_b32 v97, v96
    v_fma_f32 v59, v59, s28, v9
    v_max3_f32 v98, v76, v77, v78
    v_permlane16_swap_b32 v97, v96
    v_max3_f32 v98, v98, v79, v80
    v_mfma_f32_16x16x32_bf16 v[224:227], a[228:231], v[28:31], v[224:227]
    s_lshr_b32 s42, s31, s42
    v_fma_f32 v52, v52, s28, v9
    v_fma_f32 v60, v60, s28, v10
    v_fma_f32 v62, v62, s28, v10
    v_mfma_f32_16x16x32_bf16 a[16:19], a[228:231], v[34:37], a[16:19]
    s_waitcnt lgkmcnt(3)
    v_exp_f32 v52, v52
    v_max_f32 v96, v96, v97
    v_mfma_f32_16x16x32_bf16 a[20:23], a[232:235], v[34:37], a[20:23]
    s_and_b32 s42, s42, 3
    ds_read_b64_tr_b16 a[224:225], v3 offset:20480
    v_fma_f32 v56, v56, s28, v9
    v_mfma_f32_16x16x32_bf16 v[228:231], a[232:235], v[28:31], v[228:231]
    s_add_u32 s42, s42, s36
    v_max3_f32 v98, v98, v81, v82
    v_mul_f32_e64 v11, -s28, v96
    v_mfma_f32_16x16x32_bf16 v[180:183], a[232:235], v[22:25], v[180:183]
    s_sub_u32 s43, s42, 3
    s_cmp_ge_u32 s42, 3
    v_exp_f32 v58, v58
    v_max_f32 v98, v98, v83
    v_mfma_f32_16x16x32_bf16 v[132:135], a[232:235], v[16:19], v[132:135]
    s_cselect_b32 s42, s43, s42
    v_max3_f32 v96, v84, v85, v86
    v_fma_f32 v57, v57, s28, v9
    v_mfma_f32_16x16x32_bf16 v[136:139], a[212:215], v[16:19], v[136:139]
    s_mul_i32 s44, s3, 5
    v_mov_b32 v99, v98
    v_fma_f32 v71, v71, s28, v11
    v_fma_f32 v70, v70, s28, v11
    v_mfma_f32_16x16x32_bf16 v[184:187], a[212:215], v[22:25], v[184:187]
    s_mov_b32 s32, 1
    ds_read_b64_tr_b16 a[234:235], v5 offset:14336
    s_lshl_b32 s43, s3, 2
    v_exp_f32 v71, v71
    v_max3_f32 v96, v96, v87, v88
    v_mfma_f32_16x16x32_bf16 v[232:235], a[212:215], v[28:31], v[232:235]
    s_add_u32 s45, s43, 21
    v_permlane32_swap_b32 v99, v98
    v_max_f32 v98, v98, v99
    v_mfma_f32_16x16x32_bf16 a[24:27], a[212:215], v[34:37], a[24:27]
    s_waitcnt lgkmcnt(2)
    v_exp_f32 v53, v53
    v_max3_f32 v96, v96, v89, v90
    v_fma_f32 v65, v65, s28, v10
    v_mfma_f32_16x16x32_bf16 a[28:31], a[216:219], v[34:37], a[28:31]
    s_cmp_eq_u32 s3, 0
    v_max_f32 v96, v96, v91
    s_cselect_b32 s45, 20, s45
    s_cselect_b32 s33, 1, 0
    ds_read_b64_tr_b16 a[228:229], v4 offset:20480
    v_mov_b32 v99, v98
    v_mfma_f32_16x16x32_bf16 v[236:239], a[216:219], v[28:31], v[236:239]
    s_cmp_eq_u32 s42, 1
    ds_read_b64_tr_b16 a[230:231], v4 offset:14336
    v_fma_f32 v67, v67, s28, v10
    v_mov_b32 v97, v96
    s_cselect_b32 s44, s45, s44
    v_mfma_f32_16x16x32_bf16 v[188:191], a[216:219], v[22:25], v[188:191]
    s_cselect_b32 s32, s33, s32
    s_add_u32 s45, s43, 37
    ds_read_b64_tr_b16 a[232:233], v5 offset:20480
    v_mfma_f32_16x16x32_bf16 v[140:143], a[216:219], v[16:19], v[140:143]
    s_cmp_eq_u32 s42, 2
    v_fma_f32 v69, v69, s28, v11
    v_exp_f32 v62, v62
    v_mfma_f32_16x16x32_bf16 v[144:147], a[220:223], v[16:19], v[144:147]
    s_cselect_b32 s44, s45, s44
    v_fma_f32 v64, v64, s28, v10
    v_permlane32_swap_b32 v97, v96
    v_accvgpr_read_b32 v110, a6
    v_fma_f32 v75, v75, s28, v11
    v_permlane16_swap_b32 v99, v98
    v_max_f32 v98, v98, v99
    v_fma_f32 v66, v66, s28, v10
    v_max_f32 v96, v96, v97
    v_mul_f32_e64 v12, -s28, v98
    v_fma_f32 v68, v68, s28, v11
    v_fma_f32 v79, v79, s28, v12
    v_fma_f32 v76, v76, s28, v12
    v_mfma_f32_16x16x32_bf16 v[192:195], a[220:223], v[22:25], v[192:195]
    s_cselect_b32 s32, 0, s32
    v_accvgpr_read_b32 v104, a0
    v_fma_f32 v63, v63, s28, v10
    v_mfma_f32_16x16x32_bf16 v[240:243], a[220:223], v[28:31], v[240:243]
    s_mul_i32 s44, s44, 6144
    s_add_u32 s33, s35, s44
    v_fma_f32 v80, v80, s28, v12
    v_mfma_f32_16x16x32_bf16 a[32:35], a[220:223], v[34:37], a[32:35]
    s_mul_i32 s42, s32, 6144
    v_fma_f32 v72, v72, s28, v11
    v_mov_b32 v97, v96
    s_waitcnt lgkmcnt(1)
    v_mfma_f32_16x16x32_bf16 a[36:39], a[224:227], v[34:37], a[36:39]
    s_add_u32 s42, s42, 24576
    v_fma_f32 v55, v55, s28, v9
    s_add_u32 s42, s42, s33
    v_fma_f32 v77, v77, s28, v12
    s_cmp_ge_u32 s37, 6
    v_mfma_f32_16x16x32_bf16 v[244:247], a[224:227], v[28:31], v[244:247]
    s_cselect_b32 s14, 0, s42
    v_exp_f32 v54, v54
    v_mfma_f32_16x16x32_bf16 v[196:199], a[224:227], v[22:25], v[196:199]
    s_add_u32 s24, s67, 256
    v_permlane16_swap_b32 v97, v96
    v_mfma_f32_16x16x32_bf16 v[148:151], a[224:227], v[16:19], v[148:151]
    s_add_u32 s25, s33, 256
    s_add_u32 s23, s38, 4096
    v_exp_f32 v70, v70
    v_mfma_f32_16x16x32_bf16 v[152:155], a[228:231], v[16:19], v[152:155]
    s_mov_b32 s27, 0x249
    v_fma_f32 v61, v61, s28, v10
    v_fma_f32 v78, v78, s28, v12
    v_max_f32 v96, v96, v97
    s_mov_b32 s30, 0
    v_mfma_f32_16x16x32_bf16 v[200:203], a[228:231], v[22:25], v[200:203]
    s_waitcnt vmcnt(8) lgkmcnt(0)
    v_exp_f32 v78, v78
    v_mfma_f32_16x16x32_bf16 v[248:251], a[228:231], v[28:31], v[248:251]
    s_barrier
    ds_read_b128 a[212:215], v0 offset:12288
    v_mfma_f32_16x16x32_bf16 a[40:43], a[228:231], v[34:37], a[40:43]
    v_exp_f32 v76, v76
    v_mul_f32_e64 v13, -s28, v96
    v_exp_f32 v61, v61
    v_exp_f32 v75, v75
    v_mfma_f32_16x16x32_bf16 a[44:47], a[232:235], v[34:37], a[44:47]
    ds_read_b128 a[216:219], v1 offset:12288
    v_exp_f32 v55, v55
    v_mfma_f32_16x16x32_bf16 v[252:255], a[232:235], v[28:31], v[252:255]
    ds_read_b128 a[220:223], v0 offset:13312
    v_fma_f32 v73, v73, s28, v11
    v_accvgpr_read_b32 v105, a1
    v_exp_f32 v68, v68
    v_fma_f32 v86, v86, s28, v13
    v_exp_f32 v69, v69
    v_exp_f32 v60, v60
    v_pk_mul_f32 v[160:161], v[160:161], v[102:103] op_sel_hi:[1,0]
    v_exp_f32 v77, v77
    v_cvt_pk_bf16_f32 v20, v60, v61
    v_pk_mul_f32 v[116:117], v[116:117], v[48:49] op_sel_hi:[1,0]
    v_exp_f32 v59, v59
    v_fma_f32 v84, v84, s28, v13
    v_cvt_pk_bf16_f32 v15, v54, v55
    v_pk_mul_f32 v[164:165], v[164:165], v[102:103] op_sel_hi:[1,0]
    v_cvt_pk_bf16_f32 v27, v70, v71
    v_cvt_pk_bf16_f32 v32, v76, v77
    v_accvgpr_read_b32 v108, a4
    v_fma_f32 v83, v83, s28, v12
    v_fma_f32 v91, v91, s28, v13
    v_pk_mul_f32 v[216:217], v[216:217], v[50:51] op_sel_hi:[1,0]
    v_pk_mul_f32 v[112:113], v[112:113], v[48:49] op_sel_hi:[1,0]
    v_fma_f32 v74, v74, s28, v11
    v_exp_f32 v79, v79
    v_mfma_f32_16x16x32_bf16 v[204:207], a[232:235], v[22:25], v[204:207]
    v_exp_f32 v64, v64
    v_fma_f32 v87, v87, s28, v13
    v_mfma_f32_16x16x32_bf16 v[156:159], a[232:235], v[16:19], v[156:159]
    s_waitcnt lgkmcnt(1)
    ds_read_b128 a[228:231], v0 offset:14336
    v_cvt_pk_bf16_f32 v14, v52, v53
    v_mfma_f32_16x16x32_bf16 v[52:55], a[212:215], a[96:99], 0
    v_cvt_pk_bf16_f32 v26, v68, v69
    v_exp_f32 v56, v56
    v_mfma_f32_16x16x32_bf16 v[52:55], a[216:219], a[100:103], v[52:55]
    s_waitcnt lgkmcnt(1)
    v_exp_f32 v63, v63
    v_fma_f32 v85, v85, s28, v13
    v_mfma_f32_16x16x32_bf16 v[52:55], a[220:223], a[104:107], v[52:55]
    ds_read_b128 a[224:227], v1 offset:13312
    v_cvt_pk_bf16_f32 v21, v62, v63
    v_mfma_f32_16x16x32_bf16 v[60:63], a[220:223], a[128:131], 0
    v_accvgpr_read_b32 v111, a7
    v_cvt_pk_bf16_f32 v33, v78, v79
    v_mfma_f32_16x16x32_bf16 v[60:63], a[216:219], a[124:127], v[60:63]
    s_add_u32 m0, s22, 36864
    ds_read_b128 a[232:235], v1 offset:14336
    v_exp_f32 v86, v86
    v_mfma_f32_16x16x32_bf16 v[60:63], a[212:215], a[120:123], v[60:63]
    v_exp_f32 v85, v85
    v_mfma_f32_16x16x32_bf16 v[68:71], a[212:215], a[144:147], 0
    v_exp_f32 v84, v84
    v_mfma_f32_16x16x32_bf16 v[68:71], a[216:219], a[148:151], v[68:71]
    v_exp_f32 v66, v66
    v_mfma_f32_16x16x32_bf16 v[68:71], a[220:223], a[152:155], v[68:71]
    v_exp_f32 v87, v87
    v_mfma_f32_16x16x32_bf16 v[76:79], a[220:223], a[176:179], 0
    v_cvt_pk_bf16_f32 v38, v84, v85
    v_fma_f32 v82, v82, s28, v12
    v_mfma_f32_16x16x32_bf16 v[76:79], a[216:219], a[172:175], v[76:79]
    v_exp_f32 v83, v83
    v_fma_f32 v90, v90, s28, v13
    v_mfma_f32_16x16x32_bf16 v[76:79], a[212:215], a[168:171], v[76:79]
    v_cvt_pk_bf16_f32 v39, v86, v87
    v_fma_f32 v89, v89, s28, v13
    v_mfma_f32_16x16x32_bf16 v[84:87], a[212:215], a[192:195], 0
    v_exp_f32 v74, v74
    v_mfma_f32_16x16x32_bf16 v[84:87], a[216:219], a[196:199], v[84:87]
    v_cvt_pk_bf16_f32 v17, v58, v59
    v_accvgpr_read_b32 v107, a3
    v_mfma_f32_16x16x32_bf16 v[84:87], a[220:223], a[200:203], v[84:87]
    s_waitcnt lgkmcnt(0)
    v_exp_f32 v72, v72
    v_mfma_f32_16x16x32_bf16 v[84:87], a[224:227], a[204:207], v[84:87]
    v_exp_f32 v65, v65
    v_cvt_pk_bf16_f32 v160, v160, v161
    v_mfma_f32_16x16x32_bf16 v[84:87], a[228:231], a[208:211], v[84:87]
    v_fma_f32 v81, v81, s28, v12
    v_cvt_pk_bf16_f32 v112, v112, v113
    v_mfma_f32_16x16x32_bf16 v[84:87], a[232:235], v[92:95], v[84:87]
    ds_read_b128 a[220:223], v0 offset:19456
    buffer_load_dwordx4 v6, s[8:11], s21 offen lds
    v_mfma_f32_16x16x32_bf16 v[76:79], a[232:235], a[188:191], v[76:79]
    ds_read_b128 a[212:215], v0 offset:18432
    v_cvt_pk_bf16_f32 v22, v64, v65
    v_mfma_f32_16x16x32_bf16 v[76:79], a[228:231], a[184:187], v[76:79]
    v_exp_f32 v73, v73
    v_mfma_f32_16x16x32_bf16 v[76:79], a[224:227], a[180:183], v[76:79]
    ds_read_b128 a[216:219], v1 offset:18432
    v_fma_f32 v87, v87, s28, v13
    v_mfma_f32_16x16x32_bf16 v[68:71], a[224:227], a[156:159], v[68:71]
    v_exp_f32 v81, v81
    v_mfma_f32_16x16x32_bf16 v[68:71], a[228:231], a[160:163], v[68:71]
    v_exp_f32 v89, v89
    v_mfma_f32_16x16x32_bf16 v[68:71], a[232:235], a[164:167], v[68:71]
    v_exp_f32 v57, v57
    v_mfma_f32_16x16x32_bf16 v[60:63], a[232:235], a[140:143], v[60:63]
    s_add_u32 s21, s21, 128
    v_fma_f32 v77, v77, s28, v12
    v_fma_f32 v88, v88, s28, v13
    v_mfma_f32_16x16x32_bf16 v[60:63], a[228:231], a[136:139], v[60:63]
    v_exp_f32 v67, v67
    v_mfma_f32_16x16x32_bf16 v[60:63], a[224:227], a[132:135], v[60:63]
    v_exp_f32 v82, v82
    v_fma_f32 v76, v76, s28, v12
    v_mfma_f32_16x16x32_bf16 v[52:55], a[224:227], a[108:111], v[52:55]
    v_cvt_pk_bf16_f32 v16, v56, v57
    v_exp_f32 v76, v76
    v_mfma_f32_16x16x32_bf16 v[52:55], a[228:231], a[112:115], v[52:55]
    s_add_u32 m0, s22, 37888
    v_exp_f32 v88, v88
    v_mfma_f32_16x16x32_bf16 v[52:55], a[232:235], a[116:119], v[52:55]
    s_waitcnt lgkmcnt(1)
    v_fma_f32 v63, v63, s28, v10
    v_cvt_pk_bf16_f32 v23, v66, v67
    v_mfma_f32_16x16x32_bf16 v[56:59], a[212:215], a[96:99], 0
    s_waitcnt lgkmcnt(0)
    ds_read_b128 a[224:227], v1 offset:19456
    v_cvt_pk_bf16_f32 v28, v72, v73
    v_mfma_f32_16x16x32_bf16 v[56:59], a[216:219], a[100:103], v[56:59]
    buffer_load_dwordx4 v6, s[8:11], s21 offen lds
    v_mfma_f32_16x16x32_bf16 v[44:47], a[236:239], v[14:17], 0
    s_add_u32 s21, s21, 128
    v_exp_f32 v91, v91
    v_cvt_pk_bf16_f32 v40, v88, v89
    v_accvgpr_read_b32 v106, a2
    v_exp_f32 v80, v80
    v_cvt_pk_bf16_f32 v35, v82, v83
    v_mfma_f32_16x16x32_bf16 v[56:59], a[220:223], a[104:107], v[56:59]
    s_add_u32 m0, s22, 38912
    v_fma_f32 v52, v52, s28, v9
    v_fma_f32 v84, v84, s28, v13
    v_mfma_f32_16x16x32_bf16 v[64:67], a[220:223], a[128:131], 0
    ds_read_b128 a[228:231], v0 offset:20480
    v_cvt_pk_bf16_f32 v34, v80, v81
    v_mfma_f32_16x16x32_bf16 v[64:67], a[216:219], a[124:127], v[64:67]
    ds_read_b128 a[232:235], v1 offset:20480
    v_cvt_pk_bf16_f32 v116, v116, v117
    v_fma_f32 v79, v79, s28, v12
    v_exp_f32 v90, v90
    v_cvt_pk_bf16_f32 v29, v74, v75
    v_pk_mul_f32 v[228:229], v[228:229], v[50:51] op_sel_hi:[1,0]
    v_pk_mul_f32 v[172:173], v[172:173], v[102:103] op_sel_hi:[1,0]
    v_pk_mul_f32 v[134:135], v[134:135], v[48:49] op_sel_hi:[1,0]
    v_pk_mul_f32 v[236:237], v[236:237], v[50:51] op_sel_hi:[1,0]
    v_pk_mul_f32 v[166:167], v[166:167], v[102:103] op_sel_hi:[1,0]
    v_pk_mul_f32 v[220:221], v[220:221], v[50:51] op_sel_hi:[1,0]
    v_pk_mul_f32 v[210:211], v[210:211], v[50:51] op_sel_hi:[1,0]
    v_pk_mul_f32 v[140:141], v[140:141], v[48:49] op_sel_hi:[1,0]
    v_pk_mul_f32 v[154:155], v[154:155], v[48:49] op_sel_hi:[1,0]
    v_pk_mul_f32 v[208:209], v[208:209], v[50:51] op_sel_hi:[1,0]
    v_pk_mul_f32 v[114:115], v[114:115], v[48:49] op_sel_hi:[1,0]
    v_pk_mul_f32 v[248:249], v[248:249], v[50:51] op_sel_hi:[1,0]
    v_pk_mul_f32 v[110:111], v[110:111], v[8:9] op_sel_hi:[1,0]
    v_pk_mul_f32 v[214:215], v[214:215], v[50:51] op_sel_hi:[1,0]
    v_pk_mul_f32 v[118:119], v[118:119], v[48:49] op_sel_hi:[1,0]
    v_pk_mul_f32 v[104:105], v[104:105], v[8:9] op_sel_hi:[1,0]
    v_pk_mul_f32 v[108:109], v[108:109], v[8:9] op_sel_hi:[1,0]
    v_pk_mul_f32 v[212:213], v[212:213], v[50:51] op_sel_hi:[1,0]
    v_pk_mul_f32 v[162:163], v[162:163], v[102:103] op_sel_hi:[1,0]
    v_pk_mul_f32 v[186:187], v[186:187], v[102:103] op_sel_hi:[1,0]
    v_pk_mul_f32 v[106:107], v[106:107], v[8:9] op_sel_hi:[1,0]
    v_fma_f32 v86, v86, s28, v13
    v_fma_f32 v53, v53, s28, v9
    v_pk_mul_f32 v[182:183], v[182:183], v[102:103] op_sel_hi:[1,0]
    v_fma_f32 v71, v71, s28, v11
    v_cvt_pk_bf16_f32 v208, v208, v209
    v_cvt_pk_bf16_f32 v41, v90, v91
    v_mfma_f32_16x16x32_bf16 v[64:67], a[212:215], a[120:123], v[64:67]
    buffer_load_dwordx4 v6, s[8:11], s21 offen lds
    v_mfma_f32_16x16x32_bf16 v[72:75], a[212:215], a[144:147], 0
    v_cvt_pk_bf16_f32 v164, v164, v165
    v_fma_f32 v85, v85, s28, v13
    v_mfma_f32_16x16x32_bf16 v[72:75], a[216:219], a[148:151], v[72:75]
    s_add_u32 s21, s21, 12032
    v_cvt_pk_bf16_f32 v161, v162, v163
    v_exp_f32 v77, v77
    v_mfma_f32_16x16x32_bf16 v[44:47], a[240:243], v[20:23], v[44:47]
    v_exp_f32 v86, v86
    v_mfma_f32_16x16x32_bf16 v[72:75], a[220:223], a[152:155], v[72:75]
    v_cvt_pk_bf16_f32 v108, v108, v109
    v_exp_f32 v85, v85
    v_mfma_f32_16x16x32_bf16 v[80:83], a[220:223], a[176:179], 0
    s_waitcnt vmcnt(6) lgkmcnt(0)
    v_exp_f32 v52, v52
    v_mfma_f32_16x16x32_bf16 v[80:83], a[216:219], a[172:175], v[80:83]
    s_barrier
    v_mfma_f32_16x16x32_bf16 v[80:83], a[212:215], a[168:171], v[80:83]
    v_exp_f32 v79, v79
    v_mfma_f32_16x16x32_bf16 v[88:91], a[212:215], a[192:195], 0
    v_fma_f32 v62, v62, s28, v10
    v_cvt_pk_bf16_f32 v104, v104, v105
    v_cvt_pk_bf16_f32 v109, v110, v111
    v_mfma_f32_16x16x32_bf16 v[88:91], a[216:219], a[196:199], v[88:91]
    v_cvt_pk_bf16_f32 v228, v228, v229
    v_exp_f32 v87, v87
    v_mfma_f32_16x16x32_bf16 v[88:91], a[220:223], a[200:203], v[88:91]
    ds_read_b64_tr_b16 a[212:213], v2 offset:0
    v_accvgpr_read_b32 v111, a15
    v_mfma_f32_16x16x32_bf16 v[88:91], a[224:227], a[204:207], v[88:91]
    v_exp_f32 v63, v63
    v_cvt_pk_bf16_f32 v113, v114, v115
    v_mfma_f32_16x16x32_bf16 v[88:91], a[228:231], a[208:211], v[88:91]
    ds_read_b64_tr_b16 a[214:215], v2 offset:6144
    v_exp_f32 v62, v62
    v_mfma_f32_16x16x32_bf16 v[88:91], a[232:235], v[92:95], v[88:91]
    v_exp_f32 v84, v84
    v_mfma_f32_16x16x32_bf16 v[80:83], a[232:235], a[188:191], v[80:83]
    v_fma_f32 v60, v60, s28, v10
    v_cvt_pk_bf16_f32 v117, v118, v119
    v_mfma_f32_16x16x32_bf16 v[80:83], a[228:231], a[184:187], v[80:83]
    v_cvt_pk_bf16_f32 v105, v106, v107
    v_fma_f32 v61, v61, s28, v10
    v_mfma_f32_16x16x32_bf16 v[80:83], a[224:227], a[180:183], v[80:83]
    v_fma_f32 v78, v78, s28, v12
    v_cvt_pk_bf16_f32 v140, v140, v141
    v_cvt_pk_bf16_f32 v165, v166, v167
    v_fma_f32 v68, v68, s28, v11
    v_mfma_f32_16x16x32_bf16 v[44:47], a[244:247], v[26:29], v[44:47]
    ds_write2st64_b64 v101, v[112:113], v[160:161] offset0:0 offset1:12
    v_cvt_pk_bf16_f32 v209, v210, v211
    v_mfma_f32_16x16x32_bf16 v[72:75], a[224:227], a[156:159], v[72:75]
    s_add_u32 m0, s22, 12288
    v_cvt_pk_bf16_f32 v212, v212, v213
    v_cvt_pk_bf16_f32 v213, v214, v215
    v_mfma_f32_16x16x32_bf16 v[72:75], a[228:231], a[160:163], v[72:75]
    ds_write2st64_b64 v101, v[208:209], v[104:105] offset0:24 offset1:36
    v_cvt_pk_bf16_f32 v172, v172, v173
    v_mfma_f32_16x16x32_bf16 v[72:75], a[232:235], a[164:167], v[72:75]
    ds_read_b64_tr_b16 a[216:217], v3 offset:0
    v_xor_b32 v101, 32, v101
    v_mfma_f32_16x16x32_bf16 v[64:67], a[232:235], a[140:143], v[64:67]
    v_subrev_u32 v103, 24576, v103
    v_exp_f32 v71, v71
    v_mfma_f32_16x16x32_bf16 v[64:67], a[228:231], a[136:139], v[64:67]
    ds_write2st64_b64 v101, v[116:117], v[164:165] offset0:0 offset1:12
    v_pk_mul_f32 v[144:145], v[144:145], v[48:49] op_sel_hi:[1,0]
    v_pk_mul_f32 v[124:125], v[124:125], v[48:49] op_sel_hi:[1,0]
    v_pk_mul_f32 v[226:227], v[226:227], v[50:51] op_sel_hi:[1,0]
    v_pk_mul_f32 v[170:171], v[170:171], v[102:103] op_sel_hi:[1,0]
    v_pk_mul_f32 v[252:253], v[252:253], v[50:51] op_sel_hi:[1,0]
    v_pk_mul_f32 v[178:179], v[178:179], v[102:103] op_sel_hi:[1,0]
    v_pk_mul_f32 v[120:121], v[120:121], v[48:49] op_sel_hi:[1,0]
    v_fma_f32 v54, v54, s28, v9
    v_pk_mul_f32 v[232:233], v[232:233], v[50:51] op_sel_hi:[1,0]
    v_pk_mul_f32 v[176:177], v[176:177], v[102:103] op_sel_hi:[1,0]
    v_pk_mul_f32 v[230:231], v[230:231], v[50:51] op_sel_hi:[1,0]
    v_pk_mul_f32 v[168:169], v[168:169], v[102:103] op_sel_hi:[1,0]
    v_pk_mul_f32 v[196:197], v[196:197], v[102:103] op_sel_hi:[1,0]
    v_pk_mul_f32 v[202:203], v[202:203], v[102:103] op_sel_hi:[1,0]
    v_cvt_pk_bf16_f32 v120, v120, v121
    v_pk_mul_f32 v[224:225], v[224:225], v[50:51] op_sel_hi:[1,0]
    v_pk_mul_f32 v[244:245], v[244:245], v[50:51] op_sel_hi:[1,0]
    v_pk_mul_f32 v[174:175], v[174:175], v[102:103] op_sel_hi:[1,0]
    v_pk_mul_f32 v[180:181], v[180:181], v[102:103] op_sel_hi:[1,0]
    v_pk_mul_f32 v[218:219], v[218:219], v[50:51] op_sel_hi:[1,0]
    v_cvt_pk_bf16_f32 v124, v124, v125
    v_cvt_pk_bf16_f32 v176, v176, v177
    v_mfma_f32_16x16x32_bf16 v[64:67], a[224:227], a[132:135], v[64:67]
    ds_read_b64_tr_b16 a[218:219], v3 offset:6144
    v_cvt_pk_bf16_f32 v168, v168, v169
    v_cvt_pk_bf16_f32 v169, v170, v171
    v_cvt_pk_bf16_f32 v43, v86, v87
    v_cvt_pk_bf16_f32 v177, v178, v179
    v_mfma_f32_16x16x32_bf16 v[56:59], a[224:227], a[108:111], v[56:59]
    v_cvt_pk_bf16_f32 v216, v216, v217
    v_accvgpr_read_b32 v110, a14
    v_fma_f32 v81, v81, s28, v12
    v_mfma_f32_16x16x32_bf16 v[56:59], a[228:231], a[112:115], v[56:59]
    ds_write2st64_b64 v101, v[212:213], v[108:109] offset0:24 offset1:36
    v_fma_f32 v80, v80, s28, v12
    v_accvgpr_read_b32 v105, a9
    v_exp_f32 v68, v68
    v_pk_mul_f32 v[194:195], v[194:195], v[102:103] op_sel_hi:[1,0]
    v_pk_mul_f32 v[136:137], v[136:137], v[48:49] op_sel_hi:[1,0]
    v_pk_mul_f32 v[126:127], v[126:127], v[48:49] op_sel_hi:[1,0]
    v_pk_mul_f32 v[240:241], v[240:241], v[50:51] op_sel_hi:[1,0]
    v_pk_mul_f32 v[130:131], v[130:131], v[48:49] op_sel_hi:[1,0]
    v_accvgpr_read_b32 v108, a12
    v_accvgpr_read_b32 v106, a10
    v_xor_b32 v101, 96, v101
    v_cvt_pk_bf16_f32 v196, v196, v197
    v_pk_mul_f32 v[238:239], v[238:239], v[50:51] op_sel_hi:[1,0]
    v_pk_mul_f32 v[192:193], v[192:193], v[102:103] op_sel_hi:[1,0]
    v_cvt_pk_bf16_f32 v220, v220, v221
    v_fma_f32 v65, v65, s28, v10
    v_exp_f32 v53, v53
    v_pk_mul_f32 v[138:139], v[138:139], v[48:49] op_sel_hi:[1,0]
    v_cvt_pk_bf16_f32 v240, v240, v241
    v_pk_mul_f32 v[122:123], v[122:123], v[48:49] op_sel_hi:[1,0]
    v_pk_mul_f32 v[188:189], v[188:189], v[102:103] op_sel_hi:[1,0]
    v_pk_mul_f32 v[132:133], v[132:133], v[48:49] op_sel_hi:[1,0]
    v_cvt_pk_bf16_f32 v217, v218, v219
    v_pk_mul_f32 v[146:147], v[146:147], v[48:49] op_sel_hi:[1,0]
    v_accvgpr_read_b32 v104, a8
    v_pk_mul_f32 v[148:149], v[148:149], v[48:49] op_sel_hi:[1,0]
    v_pk_mul_f32 v[222:223], v[222:223], v[50:51] op_sel_hi:[1,0]
    v_pk_mul_f32 v[104:105], v[104:105], v[8:9] op_sel_hi:[1,0]
    v_pk_mul_f32 v[204:205], v[204:205], v[102:103] op_sel_hi:[1,0]
    v_fma_f32 v55, v55, s28, v9
    v_fma_f32 v83, v83, s28, v12
    v_pk_mul_f32 v[250:251], v[250:251], v[50:51] op_sel_hi:[1,0]
    v_accvgpr_read_b32 v109, a13
    v_accvgpr_read_b32 v107, a11
    v_cvt_pk_bf16_f32 v104, v104, v105
    v_pk_mul_f32 v[184:185], v[184:185], v[102:103] op_sel_hi:[1,0]
    v_cvt_pk_bf16_f32 v221, v222, v223
    v_pk_mul_f32 v[110:111], v[110:111], v[8:9] op_sel_hi:[1,0]
    v_pk_mul_f32 v[108:109], v[108:109], v[8:9] op_sel_hi:[1,0]
    v_pk_mul_f32 v[234:235], v[234:235], v[50:51] op_sel_hi:[1,0]
    v_exp_f32 v55, v55
    v_cvt_pk_bf16_f32 v132, v132, v133
    v_pk_mul_f32 v[106:107], v[106:107], v[8:9] op_sel_hi:[1,0]
    v_exp_f32 v83, v83
    v_fma_f32 v64, v64, s28, v10
    v_mfma_f32_16x16x32_bf16 v[56:59], a[232:235], a[116:119], v[56:59]
    s_waitcnt lgkmcnt(0)
    v_cvt_pk_bf16_f32 v105, v106, v107
    v_exp_f32 v78, v78
    v_mfma_f32_16x16x32_bf16 v[112:115], a[212:215], v[14:17], 0
    v_exp_f32 v54, v54
    v_cvt_pk_bf16_f32 v108, v108, v109
    v_cvt_pk_bf16_f32 v148, v148, v149
    v_cvt_pk_bf16_f32 v121, v122, v123
    v_mfma_f32_16x16x32_bf16 v[116:119], a[216:219], v[14:17], 0
    ds_read_b64_tr_b16 a[220:221], v4 offset:0
    v_fma_f32 v72, v72, s28, v11
    v_cvt_pk_bf16_f32 v224, v224, v225
    v_cvt_pk_bf16_f32 v248, v248, v249
    v_mfma_f32_16x16x32_bf16 v[164:167], a[216:219], v[20:23], 0
    ds_read_b64_tr_b16 a[222:223], v4 offset:6144
    buffer_load_dwordx4 v6, s[4:7], s20 offen lds
    v_cvt_pk_bf16_f32 v244, v244, v245
    v_mfma_f32_16x16x32_bf16 v[44:47], a[248:251], v[32:35], v[44:47]
    ds_read_b64_tr_b16 a[224:225], v5 offset:0
    v_fma_f32 v88, v88, s28, v13
    v_cvt_pk_bf16_f32 v109, v110, v111
    v_cvt_pk_bf16_f32 v173, v174, v175
    v_cvt_pk_bf16_f32 v232, v232, v233
    v_mfma_f32_16x16x32_bf16 v[160:163], a[212:215], v[20:23], 0
    ds_read_b64_tr_b16 a[226:227], v5 offset:6144
    v_cvt_pk_bf16_f32 v144, v144, v145
    v_mfma_f32_16x16x32_bf16 v[208:211], a[212:215], v[26:29], 0
    ds_read_b64_tr_b16 a[230:231], v2 offset:7168
    v_cvt_pk_bf16_f32 v192, v192, v193
    v_mfma_f32_16x16x32_bf16 v[212:215], a[216:219], v[26:29], 0
    s_add_u32 s20, s20, 128
    ds_write2st64_b64 v101, v[120:121], v[168:169] offset0:0 offset1:12
    v_mfma_f32_16x16x32_bf16 a[4:7], a[216:219], v[32:35], 0
    s_add_u32 m0, s22, 13312
    ds_read_b64_tr_b16 a[234:235], v3 offset:7168
    v_accvgpr_read_b32 v106, a18
    v_exp_f32 v88, v88
    v_cvt_pk_bf16_f32 v136, v136, v137
    v_mfma_f32_16x16x32_bf16 a[0:3], a[212:215], v[32:35], 0
    ds_write2st64_b64 v101, v[216:217], v[104:105] offset0:24 offset1:36
    v_cvt_pk_bf16_f32 v252, v252, v253
    v_cvt_pk_bf16_f32 v125, v126, v127
    v_fma_f32 v89, v89, s28, v13
    v_pk_mul_f32 v[206:207], v[206:207], v[102:103] op_sel_hi:[1,0]
    v_pk_mul_f32 v[128:129], v[128:129], v[48:49] op_sel_hi:[1,0]
    v_accvgpr_read_b32 v111, a23
    v_xor_b32 v101, 32, v101
    v_mfma_f32_16x16x32_bf16 a[48:51], a[212:215], v[38:41], 0
    ds_write2st64_b64 v101, v[124:125], v[172:173] offset0:0 offset1:12
    v_accvgpr_read_b32 v107, a19
    v_mfma_f32_16x16x32_bf16 v[44:47], a[252:255], v[38:41], v[44:47]
    buffer_load_dwordx4 v6, s[4:7], s20 offen lds
    ds_read_b64_tr_b16 a[232:233], v3 offset:1024
    v_mfma_f32_16x16x32_bf16 a[52:55], a[216:219], v[38:41], 0
    s_waitcnt lgkmcnt(4)
    ds_write2st64_b64 v101, v[220:221], v[108:109] offset0:24 offset1:36
    v_cvt_pk_bf16_f32 v128, v128, v129
    v_cvt_pk_bf16_f32 v188, v188, v189
    v_mfma_f32_16x16x32_bf16 a[56:59], a[220:223], v[38:41], 0
    ds_read_b64_tr_b16 a[228:229], v2 offset:1024
    v_fma_f32 v91, v91, s28, v13
    v_accvgpr_read_b32 v110, a22
    v_accvgpr_read_b32 v108, a20
    v_accvgpr_read_b32 v105, a17
    v_pk_mul_f32 v[142:143], v[142:143], v[48:49] op_sel_hi:[1,0]
    v_pk_mul_f32 v[246:247], v[246:247], v[50:51] op_sel_hi:[1,0]
    v_pk_mul_f32 v[106:107], v[106:107], v[8:9] op_sel_hi:[1,0]
    v_accvgpr_read_b32 v109, a21
    v_cvt_pk_bf16_f32 v236, v236, v237
    v_cvt_pk_bf16_f32 v133, v134, v135
    v_xor_b32 v101, 96, v101
    v_accvgpr_read_b32 v104, a16
    v_pk_mul_f32 v[200:201], v[200:201], v[102:103] op_sel_hi:[1,0]
    v_cvt_pk_bf16_f32 v145, v146, v147
    v_pk_mul_f32 v[198:199], v[198:199], v[102:103] op_sel_hi:[1,0]
    v_pk_mul_f32 v[156:157], v[156:157], v[48:49] op_sel_hi:[1,0]
    v_pk_mul_f32 v[104:105], v[104:105], v[8:9] op_sel_hi:[1,0]
    v_pk_mul_f32 v[108:109], v[108:109], v[8:9] op_sel_hi:[1,0]
    v_fma_f32 v67, v67, s28, v10
    v_fma_f32 v69, v69, s28, v11
    v_mfma_f32_16x16x32_bf16 a[60:63], a[224:227], v[38:41], 0
    v_cvt_pk_bf16_f32 v108, v108, v109
    v_cvt_pk_bf16_f32 v229, v230, v231
    v_cvt_pk_bf16_f32 v129, v130, v131
    v_fma_f32 v73, v73, s28, v11
    v_cvt_pk_bf16_f32 v137, v138, v139
    v_pk_mul_f32 v[254:255], v[254:255], v[50:51] op_sel_hi:[1,0]
    v_pk_mul_f32 v[152:153], v[152:153], v[48:49] op_sel_hi:[1,0]
    v_cvt_pk_bf16_f32 v180, v180, v181
    v_cvt_pk_bf16_f32 v225, v226, v227
    v_mfma_f32_16x16x32_bf16 a[12:15], a[224:227], v[32:35], 0
    ds_read_b128 v[96:99], v103 offset:0
    v_cvt_pk_bf16_f32 v200, v200, v201
    v_exp_f32 v64, v64
    v_cvt_pk_bf16_f32 v104, v104, v105
    v_fma_f32 v75, v75, s28, v11
    v_mfma_f32_16x16x32_bf16 a[8:11], a[220:223], v[32:35], 0
    s_add_u32 s20, s20, 128
    ds_read_b64_tr_b16 a[212:213], v4 offset:1024
    v_cvt_pk_bf16_f32 v37, v78, v79
    v_cvt_pk_bf16_f32 v201, v202, v203
    v_cvt_pk_bf16_f32 v141, v142, v143
    v_cvt_pk_bf16_f32 v156, v156, v157
    v_cvt_pk_bf16_f32 v184, v184, v185
    v_cvt_pk_bf16_f32 v105, v106, v107
    v_mfma_f32_16x16x32_bf16 v[216:219], a[220:223], v[26:29], 0
    ds_write2st64_b64 v101, v[128:129], v[176:177] offset0:4 offset1:16
    v_pk_mul_f32 v[110:111], v[110:111], v[8:9] op_sel_hi:[1,0]
    v_pk_mul_f32 v[242:243], v[242:243], v[50:51] op_sel_hi:[1,0]
    v_cvt_pk_bf16_f32 v181, v182, v183
    v_pk_mul_f32 v[158:159], v[158:159], v[48:49] op_sel_hi:[1,0]
    v_pk_mul_f32 v[150:151], v[150:151], v[48:49] op_sel_hi:[1,0]
    v_cvt_pk_bf16_f32 v241, v242, v243
    v_accvgpr_read_b32 v107, a27
    v_mfma_f32_16x16x32_bf16 v[220:223], a[224:227], v[26:29], 0
    ds_read_b64_tr_b16 a[214:215], v4 offset:7168
    v_exp_f32 v65, v65
    v_cvt_pk_bf16_f32 v249, v250, v251
    v_cvt_pk_bf16_f32 v197, v198, v199
    v_mfma_f32_16x16x32_bf16 v[172:175], a[224:227], v[20:23], 0
    s_add_u32 m0, s22, 14336
    ds_write2st64_b64 v101, v[224:225], v[104:105] offset0:28 offset1:40
    v_fma_f32 v59, v59, s28, v9
    v_cvt_pk_bf16_f32 v245, v246, v247
    v_mfma_f32_16x16x32_bf16 v[168:171], a[220:223], v[20:23], 0
    ds_read_b64_tr_b16 a[218:219], v5 offset:7168
    v_exp_f32 v60, v60
    v_cvt_pk_bf16_f32 v109, v110, v111
    v_accvgpr_read_b32 v110, a30
    v_mfma_f32_16x16x32_bf16 v[120:123], a[220:223], v[14:17], 0
    buffer_load_dwordx4 v6, s[4:7], s20 offen lds
    ds_read_b64_tr_b16 a[222:223], v2 offset:8192
    v_cvt_pk_bf16_f32 v253, v254, v255
    v_mfma_f32_16x16x32_bf16 v[124:127], a[224:227], v[14:17], 0
    s_waitcnt lgkmcnt(4)
    v_cvt_pk_bf16_f32 v185, v186, v187
    v_xor_b32 v101, 32, v101
    v_exp_f32 v91, v91
    v_mfma_f32_16x16x32_bf16 v[128:131], a[228:231], v[14:17], 0
    buffer_store_dwordx4 v[96:99], v6, s[16:19], s67 offen offset:0 nt
    ds_write2st64_b64 v101, v[132:133], v[180:181] offset0:4 offset1:16
    v_mfma_f32_16x16x32_bf16 v[132:135], a[232:235], v[14:17], 0
    ds_write2st64_b64 v101, v[228:229], v[108:109] offset0:28 offset1:40
    v_accvgpr_read_b32 v106, a26
    v_accvgpr_read_b32 v105, a25
    v_xor_b32 v101, 96, v101
    v_mfma_f32_16x16x32_bf16 v[180:183], a[232:235], v[20:23], 0
    ds_read_b64_tr_b16 a[226:227], v3 offset:8192
    v_accvgpr_read_b32 v111, a31
    v_mfma_f32_16x16x32_bf16 v[176:179], a[228:231], v[20:23], 0
    ds_write2st64_b64 v101, v[136:137], v[184:185] offset0:4 offset1:16
    v_accvgpr_read_b32 v109, a29
    v_accvgpr_read_b32 v104, a24
    v_accvgpr_read_b32 v108, a28
    v_pk_mul_f32 v[106:107], v[106:107], v[8:9] op_sel_hi:[1,0]
    v_pk_mul_f32 v[190:191], v[190:191], v[102:103] op_sel_hi:[1,0]
    v_pk_mul_f32 v[108:109], v[108:109], v[8:9] op_sel_hi:[1,0]
    v_pk_mul_f32 v[104:105], v[104:105], v[8:9] op_sel_hi:[1,0]
    v_pk_mul_f32 v[110:111], v[110:111], v[8:9] op_sel_hi:[1,0]
    v_cvt_pk_bf16_f32 v204, v204, v205
    v_cvt_pk_bf16_f32 v157, v158, v159
    v_mfma_f32_16x16x32_bf16 v[224:227], a[228:231], v[26:29], 0
    ds_read_b64_tr_b16 a[216:217], v5 offset:1024
    v_fma_f32 v74, v74, s28, v11
    v_cvt_pk_bf16_f32 v152, v152, v153
    v_cvt_pk_bf16_f32 v233, v234, v235
    v_cvt_pk_bf16_f32 v104, v104, v105
    v_cvt_pk_bf16_f32 v108, v108, v109
    v_cvt_pk_bf16_f32 v237, v238, v239
    v_mfma_f32_16x16x32_bf16 v[228:231], a[232:235], v[26:29], 0
    ds_read_b64_tr_b16 a[224:225], v3 offset:2048
    v_cvt_pk_bf16_f32 v109, v110, v111
    v_mfma_f32_16x16x32_bf16 a[20:23], a[232:235], v[32:35], 0
    s_add_u32 s20, s20, 12032
    ds_read_b64_tr_b16 a[220:221], v2 offset:2048
    v_cvt_pk_bf16_f32 v149, v150, v151
    v_fma_f32 v66, v66, s28, v10
    v_cvt_pk_bf16_f32 v105, v106, v107
    v_cvt_pk_bf16_f32 v42, v84, v85
    v_mfma_f32_16x16x32_bf16 a[16:19], a[228:231], v[32:35], 0
    s_add_u32 m0, s38, 0
    v_cvt_pk_bf16_f32 v189, v190, v191
    v_fma_f32 v82, v82, s28, v12
    v_cvt_pk_bf16_f32 v18, v52, v53
    v_mfma_f32_16x16x32_bf16 a[64:67], a[228:231], v[38:41], 0
    ds_write2st64_b64 v101, v[232:233], v[104:105] offset0:28 offset1:40
    v_xor_b32 v101, 32, v101
    v_accvgpr_read_b32 v111, a39
    v_mfma_f32_16x16x32_bf16 a[68:71], a[232:235], v[38:41], 0
    s_waitcnt lgkmcnt(4)
    ds_write2st64_b64 v101, v[140:141], v[188:189] offset0:4 offset1:16
    v_fma_f32 v58, v58, s28, v9
    v_mfma_f32_16x16x32_bf16 a[72:75], a[212:215], v[38:41], 0
    s_waitcnt lgkmcnt(4)
    ds_read_b64_tr_b16 a[232:233], v5 offset:2048
    buffer_load_dwordx4 v6, s[12:15], s33 offen nt lds
    v_accvgpr_read_b32 v105, a33
    v_mfma_f32_16x16x32_bf16 a[76:79], a[216:219], v[38:41], 0
    ds_write2st64_b64 v101, v[236:237], v[108:109] offset0:28 offset1:40
    v_mfma_f32_16x16x32_bf16 a[28:31], a[216:219], v[32:35], 0
    ds_read_b128 v[96:99], v103 offset:1024
    v_accvgpr_read_b32 v109, a37
    v_mfma_f32_16x16x32_bf16 a[24:27], a[212:215], v[32:35], 0
    ds_read_b64_tr_b16 a[230:231], v4 offset:8192
    v_cvt_pk_bf16_f32 v193, v194, v195
    v_accvgpr_read_b32 v110, a38
    v_mfma_f32_16x16x32_bf16 v[232:235], a[212:215], v[26:29], 0
    ds_read_b64_tr_b16 a[228:229], v4 offset:2048
    v_xor_b32 v101, 96, v101
    v_mfma_f32_16x16x32_bf16 v[236:239], a[216:219], v[26:29], 0
    ds_read_b64_tr_b16 a[234:235], v5 offset:8192
    v_accvgpr_read_b32 v108, a36
    v_accvgpr_read_b32 v106, a34
    v_accvgpr_read_b32 v104, a32
    v_accvgpr_read_b32 v107, a35
    v_pk_mul_f32 v[108:109], v[108:109], v[8:9] op_sel_hi:[1,0]
    v_pk_mul_f32 v[104:105], v[104:105], v[8:9] op_sel_hi:[1,0]
    v_pk_mul_f32 v[106:107], v[106:107], v[8:9] op_sel_hi:[1,0]
    v_pk_mul_f32 v[110:111], v[110:111], v[8:9] op_sel_hi:[1,0]
    v_cvt_pk_bf16_f32 v104, v104, v105
    v_cvt_pk_bf16_f32 v105, v106, v107
    v_mfma_f32_16x16x32_bf16 v[188:191], a[216:219], v[20:23], 0
    ds_write2st64_b64 v101, v[144:145], v[192:193] offset0:8 offset1:20
    v_fma_f32 v57, v57, s28, v9
    v_cvt_pk_bf16_f32 v108, v108, v109
    v_mfma_f32_16x16x32_bf16 v[184:187], a[212:215], v[20:23], 0
    ds_write2st64_b64 v101, v[240:241], v[104:105] offset0:32 offset1:44
    v_mfma_f32_16x16x32_bf16 v[136:139], a[212:215], v[14:17], 0
    s_add_u32 m0, s38, 1024
    v_fma_f32 v56, v56, s28, v9
    v_accvgpr_read_b32 v106, a42
    v_mfma_f32_16x16x32_bf16 v[140:143], a[216:219], v[14:17], 0
    s_waitcnt lgkmcnt(4)
    v_cvt_pk_bf16_f32 v109, v110, v111
    v_xor_b32 v101, 32, v101
    v_mfma_f32_16x16x32_bf16 v[144:147], a[220:223], v[14:17], 0
    ds_write2st64_b64 v101, v[148:149], v[196:197] offset0:8 offset1:20
    v_mfma_f32_16x16x32_bf16 v[148:151], a[224:227], v[14:17], 0
    buffer_load_dwordx4 v7, s[12:15], s33 offen nt lds
    v_accvgpr_read_b32 v111, a47
    v_cvt_pk_bf16_f32 v205, v206, v207
    v_mfma_f32_16x16x32_bf16 v[196:199], a[224:227], v[20:23], 0
    ds_write2st64_b64 v101, v[244:245], v[108:109] offset0:32 offset1:44
    v_mfma_f32_16x16x32_bf16 v[192:195], a[220:223], v[20:23], 0
    s_add_u32 s39, s39, 12288
    v_accvgpr_read_b32 v110, a46
    v_accvgpr_read_b32 v104, a40
    v_accvgpr_read_b32 v107, a43
    v_mfma_f32_16x16x32_bf16 v[240:243], a[220:223], v[26:29], 0
    s_waitcnt vmcnt(9) lgkmcnt(2)
    v_fma_f32 v70, v70, s28, v11
    v_accvgpr_read_b32 v105, a41
    v_mfma_f32_16x16x32_bf16 v[244:247], a[224:227], v[26:29], 0
    buffer_store_dwordx4 v[96:99], v7, s[16:19], s67 offen offset:0 nt
    v_accvgpr_read_b32 v109, a45
    v_accvgpr_read_b32 v108, a44
    v_pk_mul_f32 v[106:107], v[106:107], v[8:9] op_sel_hi:[1,0]
    v_pk_mul_f32 v[110:111], v[110:111], v[8:9] op_sel_hi:[1,0]
    v_pk_mul_f32 v[104:105], v[104:105], v[8:9] op_sel_hi:[1,0]
    v_pk_mul_f32 v[108:109], v[108:109], v[8:9] op_sel_hi:[1,0]
    v_exp_f32 v69, v69
    v_cvt_pk_bf16_f32 v104, v104, v105
    v_mfma_f32_16x16x32_bf16 a[36:39], a[224:227], v[32:35], 0
    s_barrier
    v_mfma_f32_16x16x32_bf16 a[32:35], a[220:223], v[32:35], 0
    ds_read_b128 a[216:219], v1 offset:0
    v_cvt_pk_bf16_f32 v153, v154, v155
    v_mfma_f32_16x16x32_bf16 a[80:83], a[220:223], v[38:41], 0
    v_cvt_pk_bf16_f32 v108, v108, v109
    v_xor_b32 v101, 96, v101
    v_mfma_f32_16x16x32_bf16 a[84:87], a[224:227], v[38:41], 0
    ds_write2st64_b64 v101, v[152:153], v[200:201] offset0:8 offset1:20
    v_exp_f32 v67, v67
    v_mfma_f32_16x16x32_bf16 a[88:91], a[228:231], v[38:41], 0
    ds_read_b128 a[220:223], v0 offset:1024
    v_cvt_pk_bf16_f32 v105, v106, v107
    v_mfma_f32_16x16x32_bf16 a[92:95], a[232:235], v[38:41], 0
    ds_read_b128 a[212:215], v0 offset:0
    v_cvt_pk_bf16_f32 v109, v110, v111
    v_mfma_f32_16x16x32_bf16 a[44:47], a[232:235], v[32:35], 0
    ds_write2st64_b64 v101, v[248:249], v[104:105] offset0:32 offset1:44
    v_xor_b32 v101, 32, v101
    v_mfma_f32_16x16x32_bf16 a[40:43], a[228:231], v[32:35], 0
    ds_write2st64_b64 v101, v[156:157], v[204:205] offset0:8 offset1:20
    v_mfma_f32_16x16x32_bf16 v[248:251], a[228:231], v[26:29], 0
    ds_write2st64_b64 v101, v[252:253], v[108:109] offset0:32 offset1:44
    v_mfma_f32_16x16x32_bf16 v[252:255], a[232:235], v[26:29], 0
    s_add_u32 m0, s22, 24576
    v_exp_f32 v61, v61
    v_mfma_f32_16x16x32_bf16 v[204:207], a[232:235], v[20:23], 0
    buffer_load_dwordx4 v6, s[8:11], s21 offen lds
    v_mfma_f32_16x16x32_bf16 v[200:203], a[228:231], v[20:23], 0
    v_exp_f32 v74, v74
    v_mfma_f32_16x16x32_bf16 v[152:155], a[228:231], v[14:17], 0
    v_cvt_pk_bf16_f32 v25, v62, v63
    v_cvt_pk_bf16_f32 v19, v54, v55
    v_mfma_f32_16x16x32_bf16 v[156:159], a[232:235], v[14:17], 0
    s_waitcnt lgkmcnt(3)
    v_exp_f32 v80, v80
    v_mfma_f32_16x16x32_bf16 v[52:55], a[212:215], a[96:99], 0
    s_add_u32 s21, s21, 128
    v_exp_f32 v70, v70
    v_mfma_f32_16x16x32_bf16 v[52:55], a[216:219], a[100:103], v[52:55]
    ds_read_b128 v[96:99], v103 offset:2048
    v_cvt_pk_bf16_f32 v31, v70, v71
    v_mfma_f32_16x16x32_bf16 v[52:55], a[220:223], a[104:107], v[52:55]
    ds_read_b128 a[224:227], v1 offset:1024
    v_cvt_pk_bf16_f32 v24, v60, v61
    v_mfma_f32_16x16x32_bf16 v[60:63], a[220:223], a[128:131], 0
    s_add_u32 m0, s22, 25600
    ds_read_b128 a[228:231], v0 offset:2048
    v_cvt_pk_bf16_f32 v30, v68, v69
    v_mfma_f32_16x16x32_bf16 v[60:63], a[216:219], a[124:127], v[60:63]
    buffer_load_dwordx4 v6, s[8:11], s21 offen lds
    v_mfma_f32_16x16x32_bf16 v[60:63], a[212:215], a[120:123], v[60:63]
    s_add_u32 s21, s21, 128
    v_exp_f32 v81, v81
    v_mfma_f32_16x16x32_bf16 v[68:71], a[212:215], a[144:147], 0
    s_add_u32 m0, s22, 26624
    ds_read_b128 a[232:235], v1 offset:2048
    v_cvt_pk_bf16_f32 v36, v76, v77
    v_mfma_f32_16x16x32_bf16 v[68:71], a[216:219], a[148:151], v[68:71]
    buffer_load_dwordx4 v6, s[8:11], s21 offen lds
    v_mfma_f32_16x16x32_bf16 v[68:71], a[220:223], a[152:155], v[68:71]
    s_add_u32 s21, s21, 12032
    v_exp_f32 v73, v73
    v_mfma_f32_16x16x32_bf16 v[76:79], a[220:223], a[176:179], 0
    v_exp_f32 v66, v66
    v_mfma_f32_16x16x32_bf16 v[76:79], a[216:219], a[172:175], v[76:79]
    v_fma_f32 v90, v90, s28, v13
    v_exp_f32 v57, v57
    v_mfma_f32_16x16x32_bf16 v[76:79], a[212:215], a[168:171], v[76:79]
    v_exp_f32 v82, v82
    v_mfma_f32_16x16x32_bf16 v[84:87], a[212:215], a[192:195], 0
    v_exp_f32 v58, v58
    v_mfma_f32_16x16x32_bf16 v[84:87], a[216:219], a[196:199], v[84:87]
    ds_read_b128 a[216:219], v1 offset:6144
    s_add_u32 s56, s67, 128
    v_mfma_f32_16x16x32_bf16 v[84:87], a[220:223], a[200:203], v[84:87]
    s_waitcnt lgkmcnt(2)
    v_exp_f32 v59, v59
    v_mfma_f32_16x16x32_bf16 v[84:87], a[224:227], a[204:207], v[84:87]
    buffer_store_dwordx4 v[96:99], v6, s[16:19], s56 offen offset:0 nt
    v_exp_f32 v72, v72
    s_add_u32 s58, s33, 128
    v_mfma_f32_16x16x32_bf16 v[84:87], a[228:231], a[208:211], v[84:87]
    s_add_u32 m0, s38, 2048
    v_cvt_pk_bf16_f32 v17, v58, v59
    s_waitcnt lgkmcnt(1)
    v_mfma_f32_16x16x32_bf16 v[84:87], a[232:235], v[92:95], v[84:87]
    v_exp_f32 v56, v56
    v_mfma_f32_16x16x32_bf16 v[76:79], a[232:235], a[188:191], v[76:79]
    v_exp_f32 v90, v90
    v_mfma_f32_16x16x32_bf16 v[76:79], a[228:231], a[184:187], v[76:79]
    v_cvt_pk_bf16_f32 v35, v82, v83
    v_cvt_pk_bf16_f32 v34, v80, v81
    v_mfma_f32_16x16x32_bf16 v[76:79], a[224:227], a[180:183], v[76:79]
    v_cvt_pk_bf16_f32 v22, v64, v65
    v_cvt_pk_bf16_f32 v16, v56, v57
    v_mfma_f32_16x16x32_bf16 v[68:71], a[224:227], a[156:159], v[68:71]
    ds_read_b128 a[220:223], v0 offset:7168
    v_cvt_pk_bf16_f32 v23, v66, v67
    v_mfma_f32_16x16x32_bf16 v[68:71], a[228:231], a[160:163], v[68:71]
    buffer_load_dwordx4 v6, s[12:15], s58 offen nt lds
    v_mfma_f32_16x16x32_bf16 v[68:71], a[232:235], a[164:167], v[68:71]
    ds_read_b128 a[212:215], v0 offset:6144
    v_cvt_pk_bf16_f32 v28, v72, v73
    v_mfma_f32_16x16x32_bf16 v[60:63], a[232:235], a[140:143], v[60:63]
    ds_read_b128 v[96:99], v103 offset:3072
    v_cvt_pk_bf16_f32 v41, v90, v91
    v_mfma_f32_16x16x32_bf16 v[60:63], a[228:231], a[136:139], v[60:63]
    v_exp_f32 v89, v89
    v_mfma_f32_16x16x32_bf16 v[48:51], a[236:239], v[16:19], v[44:47]
    v_exp_f32 v75, v75
    v_mfma_f32_16x16x32_bf16 v[48:51], a[240:243], v[22:25], v[48:51]
    v_mfma_f32_16x16x32_bf16 v[60:63], a[224:227], a[132:135], v[60:63]
    v_cvt_pk_bf16_f32 v29, v74, v75
    v_mfma_f32_16x16x32_bf16 v[52:55], a[224:227], a[108:111], v[52:55]
    v_cvt_pk_bf16_f32 v40, v88, v89
    v_mfma_f32_16x16x32_bf16 v[52:55], a[228:231], a[112:115], v[52:55]
    ds_read_b128 a[228:231], v0 offset:8192
    v_mfma_f32_16x16x32_bf16 v[48:51], a[244:247], v[28:31], v[48:51]
    v_mfma_f32_16x16x32_bf16 v[48:51], a[248:251], v[34:37], v[48:51]
    v_mfma_f32_16x16x32_bf16 v[48:51], a[252:255], v[40:43], v[48:51]
    ds_read_b128 a[224:227], v1 offset:7168
    s_add_u32 m0, s38, 3072
    v_mfma_f32_16x16x32_bf16 v[52:55], a[232:235], a[116:119], v[52:55]
    s_waitcnt lgkmcnt(2)
    ds_read_b128 a[232:235], v1 offset:8192
    v_add_u32 v103, 4096, v103
    v_mfma_f32_16x16x32_bf16 v[56:59], a[212:215], a[96:99], 0
    s_nop 0
    v_cmp_lt_f32 vcc, s29, v48
    v_mfma_f32_16x16x32_bf16 v[56:59], a[216:219], a[100:103], v[56:59]
    v_mfma_f32_16x16x32_bf16 v[56:59], a[220:223], a[104:107], v[56:59]
    buffer_load_dwordx4 v7, s[12:15], s58 offen nt lds
    v_mfma_f32_16x16x32_bf16 v[64:67], a[220:223], a[128:131], 0
    v_mfma_f32_16x16x32_bf16 v[64:67], a[216:219], a[124:127], v[64:67]
    s_cbranch_vccnz L_rs_tr45d
L_ret_tr45d:
    v_fma_f32 v60, v60, s28, v10
    v_mfma_f32_16x16x32_bf16 v[64:67], a[212:215], a[120:123], v[64:67]
    v_fma_f32 v54, v54, s28, v9
    v_mfma_f32_16x16x32_bf16 v[72:75], a[212:215], a[144:147], 0
    v_exp_f32 v60, v60
    v_mfma_f32_16x16x32_bf16 v[72:75], a[216:219], a[148:151], v[72:75]
    v_fma_f32 v52, v52, s28, v9
    v_fma_f32 v53, v53, s28, v9
    v_mfma_f32_16x16x32_bf16 v[72:75], a[220:223], a[152:155], v[72:75]
    v_fma_f32 v62, v62, s28, v10
    v_fma_f32 v63, v63, s28, v10
    v_mfma_f32_16x16x32_bf16 v[80:83], a[220:223], a[176:179], 0
    s_waitcnt vmcnt(13) lgkmcnt(0)
    v_mfma_f32_16x16x32_bf16 v[80:83], a[216:219], a[172:175], v[80:83]
    s_barrier
    v_mfma_f32_16x16x32_bf16 v[80:83], a[212:215], a[168:171], v[80:83]
    buffer_store_dwordx4 v[96:99], v7, s[16:19], s56 offen offset:0 nt
    v_exp_f32 v63, v63
    v_mfma_f32_16x16x32_bf16 v[88:91], a[212:215], a[192:195], 0
    v_exp_f32 v62, v62
    v_mfma_f32_16x16x32_bf16 v[88:91], a[216:219], a[196:199], v[88:91]
    ds_read_b64_tr_b16 a[212:213], v2 offset:18432
    v_fma_f32 v61, v61, s28, v10
    v_mfma_f32_16x16x32_bf16 v[88:91], a[220:223], a[200:203], v[88:91]
    s_add_u32 m0, s22, 0
    ds_read_b64_tr_b16 a[214:215], v2 offset:12288
    v_mfma_f32_16x16x32_bf16 v[88:91], a[224:227], a[204:207], v[88:91]
    buffer_load_dwordx4 v6, s[4:7], s20 offen lds
    v_mfma_f32_16x16x32_bf16 v[88:91], a[228:231], a[208:211], v[88:91]
    v_exp_f32 v61, v61
    v_mfma_f32_16x16x32_bf16 v[88:91], a[232:235], v[92:95], v[88:91]
    ds_read_b64_tr_b16 a[216:217], v3 offset:18432
    v_fma_f32 v55, v55, s28, v9
    v_mfma_f32_16x16x32_bf16 v[80:83], a[232:235], a[188:191], v[80:83]
    s_add_u32 s20, s20, 128
    v_exp_f32 v55, v55
    v_mfma_f32_16x16x32_bf16 v[80:83], a[228:231], a[184:187], v[80:83]
    ds_read_b64_tr_b16 a[218:219], v3 offset:12288
    s_add_u32 m0, s22, 1024
    v_mfma_f32_16x16x32_bf16 v[80:83], a[224:227], a[180:183], v[80:83]
    buffer_load_dwordx4 v6, s[4:7], s20 offen lds
    v_mfma_f32_16x16x32_bf16 v[72:75], a[224:227], a[156:159], v[72:75]
    s_add_u32 s20, s20, 128
    v_exp_f32 v53, v53
    v_mfma_f32_16x16x32_bf16 v[72:75], a[228:231], a[160:163], v[72:75]
    v_cvt_pk_bf16_f32 v20, v60, v61
    v_mfma_f32_16x16x32_bf16 v[72:75], a[232:235], a[164:167], v[72:75]
    s_add_u32 m0, s22, 2048
    v_exp_f32 v54, v54
    v_mfma_f32_16x16x32_bf16 v[64:67], a[232:235], a[140:143], v[64:67]
    buffer_load_dwordx4 v6, s[4:7], s20 offen lds
    v_mfma_f32_16x16x32_bf16 v[64:67], a[228:231], a[136:139], v[64:67]
    v_exp_f32 v52, v52
    v_mfma_f32_16x16x32_bf16 v[64:67], a[224:227], a[132:135], v[64:67]
    ds_read_b64_tr_b16 a[220:221], v4 offset:18432
    v_cvt_pk_bf16_f32 v15, v54, v55
    v_mfma_f32_16x16x32_bf16 v[56:59], a[224:227], a[108:111], v[56:59]
    ds_read_b64_tr_b16 a[222:223], v4 offset:12288
    v_cvt_pk_bf16_f32 v21, v62, v63
    v_mfma_f32_16x16x32_bf16 v[56:59], a[228:231], a[112:115], v[56:59]
    ds_read_b64_tr_b16 a[224:225], v5 offset:18432
    v_cvt_pk_bf16_f32 v14, v52, v53
    v_mfma_f32_16x16x32_bf16 v[56:59], a[232:235], a[116:119], v[56:59]
    s_add_u32 s20, s20, 12032
    ds_read_b64_tr_b16 a[226:227], v5 offset:12288
    s_branch L_loop5
L_tr44:
    s_waitcnt lgkmcnt(6)
    v_mfma_f32_16x16x32_bf16 v[112:115], a[212:215], v[16:19], v[112:115]
    ds_read_b64_tr_b16 a[234:235], v3 offset:13312
    v_fma_f32 v81, v81, s28, v12
    v_mfma_f32_16x16x32_bf16 v[160:163], a[212:215], v[22:25], v[160:163]
    ds_read_b64_tr_b16 a[232:233], v3 offset:19456
    v_fma_f32 v62, v62, s28, v10
    v_mfma_f32_16x16x32_bf16 v[208:211], a[212:215], v[28:31], v[208:211]
    ds_read_b64_tr_b16 a[228:229], v2 offset:19456
    v_fma_f32 v80, v80, s28, v12
    v_mfma_f32_16x16x32_bf16 a[0:3], a[212:215], v[34:37], a[0:3]
    ds_read_b128 v[84:87], v103 offset:0
    s_waitcnt lgkmcnt(8)
    v_mfma_f32_16x16x32_bf16 a[4:7], a[216:219], v[34:37], a[4:7]
    ds_read_b64_tr_b16 a[230:231], v2 offset:13312
    v_fma_f32 v65, v65, s28, v10
    v_mfma_f32_16x16x32_bf16 v[212:215], a[216:219], v[28:31], v[212:215]
    ds_read_b64_tr_b16 a[214:215], v4 offset:13312
    v_mfma_f32_16x16x32_bf16 v[164:167], a[216:219], v[22:25], v[164:167]
    s_add_u32 s39, s39, 12288
    ds_read_b64_tr_b16 a[212:213], v4 offset:19456
    v_fma_f32 v58, v58, s28, v9
    v_mfma_f32_16x16x32_bf16 v[116:119], a[216:219], v[16:19], v[116:119]
    v_fma_f32 v57, v57, s28, v9
    s_waitcnt lgkmcnt(9)
    v_mfma_f32_16x16x32_bf16 v[120:123], a[220:223], v[16:19], v[120:123]
    ds_read_b64_tr_b16 a[216:217], v5 offset:19456
    v_mfma_f32_16x16x32_bf16 v[168:171], a[220:223], v[22:25], v[168:171]
    v_fma_f32 v66, v66, s28, v10
    v_fma_f32 v72, v72, s28, v11
    v_mfma_f32_16x16x32_bf16 v[216:219], a[220:223], v[28:31], v[216:219]
    v_fma_f32 v63, v63, s28, v10
    v_mfma_f32_16x16x32_bf16 a[8:11], a[220:223], v[34:37], a[8:11]
    s_waitcnt lgkmcnt(6)
    v_exp_f32 v80, v80
    v_mfma_f32_16x16x32_bf16 a[12:15], a[224:227], v[34:37], a[12:15]
    v_fma_f32 v64, v64, s28, v10
    v_fma_f32 v78, v78, s28, v12
    v_mfma_f32_16x16x32_bf16 v[220:223], a[224:227], v[28:31], v[220:223]
    ds_read_b64_tr_b16 a[222:223], v2 offset:14336
    v_fma_f32 v69, v69, s28, v11
    v_mfma_f32_16x16x32_bf16 v[172:175], a[224:227], v[22:25], v[172:175]
    ds_read_b128 v[96:99], v103 offset:2048
    v_fma_f32 v76, v76, s28, v12
    v_mfma_f32_16x16x32_bf16 v[124:127], a[224:227], v[16:19], v[124:127]
    s_waitcnt lgkmcnt(4)
    ds_read_b64_tr_b16 a[224:225], v3 offset:20480
    v_mfma_f32_16x16x32_bf16 v[128:131], a[228:231], v[16:19], v[128:131]
    ds_read_b64_tr_b16 a[218:219], v5 offset:13312
    v_mfma_f32_16x16x32_bf16 v[176:179], a[228:231], v[22:25], v[176:179]
    v_fma_f32 v82, v82, s28, v12
    v_fma_f32 v70, v70, s28, v11
    v_mfma_f32_16x16x32_bf16 v[224:227], a[228:231], v[28:31], v[224:227]
    ds_read_b64_tr_b16 a[226:227], v3 offset:14336
    v_fma_f32 v67, v67, s28, v10
    v_mfma_f32_16x16x32_bf16 a[16:19], a[228:231], v[34:37], a[16:19]
    v_exp_f32 v62, v62
    v_mfma_f32_16x16x32_bf16 a[20:23], a[232:235], v[34:37], a[20:23]
    v_exp_f32 v69, v69
    v_mfma_f32_16x16x32_bf16 v[228:231], a[232:235], v[28:31], v[228:231]
    ds_read_b64_tr_b16 a[220:221], v2 offset:20480
    v_fma_f32 v59, v59, s28, v9
    v_mfma_f32_16x16x32_bf16 v[180:183], a[232:235], v[22:25], v[180:183]
    ds_read_b64_tr_b16 a[228:229], v4 offset:20480
    v_fma_f32 v68, v68, s28, v11
    v_mfma_f32_16x16x32_bf16 v[132:135], a[232:235], v[16:19], v[132:135]
    s_waitcnt lgkmcnt(6)
    ds_read_b64_tr_b16 a[230:231], v4 offset:14336
    v_fma_f32 v56, v56, s28, v9
    v_mfma_f32_16x16x32_bf16 v[136:139], a[212:215], v[16:19], v[136:139]
    ds_read_b64_tr_b16 a[232:233], v5 offset:20480
    v_mfma_f32_16x16x32_bf16 v[184:187], a[212:215], v[22:25], v[184:187]
    ds_read_b64_tr_b16 a[234:235], v5 offset:14336
    v_mfma_f32_16x16x32_bf16 v[232:235], a[212:215], v[28:31], v[232:235]
    v_fma_f32 v71, v71, s28, v11
    v_mfma_f32_16x16x32_bf16 a[24:27], a[212:215], v[34:37], a[24:27]
    s_waitcnt lgkmcnt(6)
    v_exp_f32 v71, v71
    v_mfma_f32_16x16x32_bf16 a[28:31], a[216:219], v[34:37], a[28:31]
    v_exp_f32 v68, v68
    v_mfma_f32_16x16x32_bf16 v[236:239], a[216:219], v[28:31], v[236:239]
    v_fma_f32 v77, v77, s28, v12
    v_fma_f32 v74, v74, s28, v11
    v_mfma_f32_16x16x32_bf16 v[188:191], a[216:219], v[22:25], v[188:191]
    v_exp_f32 v63, v63
    v_mfma_f32_16x16x32_bf16 v[140:143], a[216:219], v[16:19], v[140:143]
    s_waitcnt lgkmcnt(4)
    v_exp_f32 v70, v70
    v_mfma_f32_16x16x32_bf16 v[144:147], a[220:223], v[16:19], v[144:147]
    v_exp_f32 v58, v58
    v_mfma_f32_16x16x32_bf16 v[192:195], a[220:223], v[22:25], v[192:195]
    v_exp_f32 v76, v76
    v_mfma_f32_16x16x32_bf16 v[240:243], a[220:223], v[28:31], v[240:243]
    buffer_store_dwordx4 v[84:87], v6, s[16:19], s24 offen offset:0 nt
    s_waitcnt vmcnt(11) lgkmcnt(0)
    s_barrier
    ds_read_b128 a[212:215], v0 offset:12288
    v_mfma_f32_16x16x32_bf16 a[32:35], a[220:223], v[34:37], a[32:35]
    ds_read_b128 a[220:223], v0 offset:13312
    v_cvt_pk_bf16_f32 v26, v68, v69
    v_mfma_f32_16x16x32_bf16 a[36:39], a[224:227], v[34:37], a[36:39]
    s_add_u32 m0, s22, 36864
    v_fma_f32 v79, v79, s28, v12
    v_cvt_pk_bf16_f32 v21, v62, v63
    v_mfma_f32_16x16x32_bf16 v[244:247], a[224:227], v[28:31], v[244:247]
    buffer_load_dwordx4 v6, s[8:11], s21 offen lds
    v_mfma_f32_16x16x32_bf16 v[196:199], a[224:227], v[22:25], v[196:199]
    s_add_u32 s21, s21, 128
    ds_read_b128 a[216:219], v1 offset:12288
    v_cvt_pk_bf16_f32 v27, v70, v71
    v_mfma_f32_16x16x32_bf16 v[148:151], a[224:227], v[16:19], v[148:151]
    s_add_u32 m0, s22, 37888
    v_exp_f32 v79, v79
    v_mfma_f32_16x16x32_bf16 v[152:155], a[228:231], v[16:19], v[152:155]
    buffer_load_dwordx4 v6, s[8:11], s21 offen lds
    v_mfma_f32_16x16x32_bf16 v[200:203], a[228:231], v[22:25], v[200:203]
    s_add_u32 s21, s21, 128
    v_exp_f32 v77, v77
    v_mfma_f32_16x16x32_bf16 v[248:251], a[228:231], v[28:31], v[248:251]
    s_add_u32 m0, s22, 38912
    ds_read_b128 a[224:227], v1 offset:13312
    v_mfma_f32_16x16x32_bf16 a[40:43], a[228:231], v[34:37], a[40:43]
    v_exp_f32 v67, v67
    v_mfma_f32_16x16x32_bf16 a[44:47], a[232:235], v[34:37], a[44:47]
    buffer_load_dwordx4 v6, s[8:11], s21 offen lds
    v_mfma_f32_16x16x32_bf16 v[252:255], a[232:235], v[28:31], v[252:255]
    v_exp_f32 v74, v74
    v_mfma_f32_16x16x32_bf16 v[204:207], a[232:235], v[22:25], v[204:207]
    v_exp_f32 v78, v78
    v_mfma_f32_16x16x32_bf16 v[156:159], a[232:235], v[16:19], v[156:159]
    s_waitcnt lgkmcnt(2)
    v_cvt_pk_bf16_f32 v33, v78, v79
    v_mfma_f32_16x16x32_bf16 v[52:55], a[212:215], a[96:99], 0
    s_waitcnt lgkmcnt(1)
    v_exp_f32 v66, v66
    v_mfma_f32_16x16x32_bf16 v[52:55], a[216:219], a[100:103], v[52:55]
    ds_read_b128 a[232:235], v1 offset:14336
    v_cvt_pk_bf16_f32 v32, v76, v77
    v_mfma_f32_16x16x32_bf16 v[52:55], a[220:223], a[104:107], v[52:55]
    ds_read_b128 a[228:231], v0 offset:14336
    v_mfma_f32_16x16x32_bf16 v[60:63], a[220:223], a[128:131], 0
    ds_read_b128 v[88:91], v103 offset:1024
    v_mfma_f32_16x16x32_bf16 v[60:63], a[216:219], a[124:127], v[60:63]
    v_exp_f32 v57, v57
    v_mfma_f32_16x16x32_bf16 v[60:63], a[212:215], a[120:123], v[60:63]
    v_exp_f32 v65, v65
    v_mfma_f32_16x16x32_bf16 v[68:71], a[212:215], a[144:147], 0
    v_exp_f32 v59, v59
    v_mfma_f32_16x16x32_bf16 v[68:71], a[216:219], a[148:151], v[68:71]
    v_exp_f32 v82, v82
    v_mfma_f32_16x16x32_bf16 v[68:71], a[220:223], a[152:155], v[68:71]
    v_exp_f32 v64, v64
    v_mfma_f32_16x16x32_bf16 v[76:79], a[220:223], a[176:179], 0
    v_fma_f32 v75, v75, s28, v11
    v_cvt_pk_bf16_f32 v17, v58, v59
    v_mfma_f32_16x16x32_bf16 v[76:79], a[216:219], a[172:175], v[76:79]
    v_exp_f32 v56, v56
    v_mfma_f32_16x16x32_bf16 v[76:79], a[212:215], a[168:171], v[76:79]
    s_waitcnt lgkmcnt(2)
    v_exp_f32 v81, v81
    v_mfma_f32_16x16x32_bf16 v[76:79], a[224:227], a[180:183], v[76:79]
    s_waitcnt lgkmcnt(1)
    v_exp_f32 v72, v72
    v_mfma_f32_16x16x32_bf16 v[76:79], a[228:231], a[184:187], v[76:79]
    v_fma_f32 v73, v73, s28, v11
    v_cvt_pk_bf16_f32 v16, v56, v57
    v_mfma_f32_16x16x32_bf16 v[76:79], a[232:235], a[188:191], v[76:79]
    v_exp_f32 v73, v73
    v_mfma_f32_16x16x32_bf16 v[44:47], a[236:239], v[14:17], v[48:51]
    ds_read_b128 v[84:87], v103 offset:3072
    v_cvt_pk_bf16_f32 v22, v64, v65
    v_mfma_f32_16x16x32_bf16 v[68:71], a[232:235], a[164:167], v[68:71]
    ds_read_b128 a[212:215], v0 offset:18432
    v_mfma_f32_16x16x32_bf16 v[68:71], a[228:231], a[160:163], v[68:71]
    ds_read_b128 a[216:219], v1 offset:18432
    v_mfma_f32_16x16x32_bf16 v[68:71], a[224:227], a[156:159], v[68:71]
    v_exp_f32 v75, v75
    v_mfma_f32_16x16x32_bf16 v[60:63], a[224:227], a[132:135], v[60:63]
    ds_read_b128 a[220:223], v0 offset:19456
    v_fma_f32 v83, v83, s28, v12
    v_mfma_f32_16x16x32_bf16 v[60:63], a[228:231], a[136:139], v[60:63]
    v_cvt_pk_bf16_f32 v23, v66, v67
    v_cvt_pk_bf16_f32 v29, v74, v75
    v_mfma_f32_16x16x32_bf16 v[60:63], a[232:235], a[140:143], v[60:63]
    v_exp_f32 v83, v83
    v_mfma_f32_16x16x32_bf16 v[52:55], a[232:235], a[116:119], v[52:55]
    ds_read_b128 a[232:235], v1 offset:20480
    v_cvt_pk_bf16_f32 v34, v80, v81
    v_mfma_f32_16x16x32_bf16 v[52:55], a[228:231], a[112:115], v[52:55]
    v_mfma_f32_16x16x32_bf16 v[52:55], a[224:227], a[108:111], v[52:55]
    ds_read_b128 a[224:227], v1 offset:19456
    v_cvt_pk_bf16_f32 v28, v72, v73
    v_mfma_f32_16x16x32_bf16 v[44:47], a[240:243], v[20:23], v[44:47]
    ds_read_b128 a[228:231], v0 offset:20480
    v_cvt_pk_bf16_f32 v35, v82, v83
    v_mfma_f32_16x16x32_bf16 v[44:47], a[244:247], v[26:29], v[44:47]
    s_nop 0
    v_mfma_f32_16x16x32_bf16 v[44:47], a[248:251], v[32:35], v[44:47]
    s_waitcnt lgkmcnt(4)
    v_mfma_f32_16x16x32_bf16 v[56:59], a[212:215], a[96:99], 0
    v_mfma_f32_16x16x32_bf16 v[56:59], a[216:219], a[100:103], v[56:59]
    s_add_u32 s21, s21, 12032
    s_waitcnt lgkmcnt(3)
    v_mfma_f32_16x16x32_bf16 v[56:59], a[220:223], a[104:107], v[56:59]
    s_nop 1
    v_cmp_lt_f32 vcc, s29, v44
    v_mfma_f32_16x16x32_bf16 v[64:67], a[220:223], a[128:131], 0
    v_mfma_f32_16x16x32_bf16 v[64:67], a[216:219], a[124:127], v[64:67]
    s_add_u32 s57, s24, 128
    v_mfma_f32_16x16x32_bf16 v[64:67], a[212:215], a[120:123], v[64:67]
    buffer_store_dwordx4 v[88:91], v7, s[16:19], s24 offen offset:0 nt
    s_cbranch_vccnz L_rs_tr44a
L_ret_tr44a:
    v_fma_f32 v54, v54, s28, v9
    v_exp_f32 v54, v54
    v_mfma_f32_16x16x32_bf16 v[72:75], a[212:215], a[144:147], 0
    s_waitcnt vmcnt(8) lgkmcnt(0)
    s_add_u32 m0, s22, 12288
    v_fma_f32 v60, v60, s28, v10
    v_mfma_f32_16x16x32_bf16 v[72:75], a[216:219], a[148:151], v[72:75]
    s_barrier
    v_mfma_f32_16x16x32_bf16 v[72:75], a[220:223], a[152:155], v[72:75]
    buffer_load_dwordx4 v6, s[4:7], s20 offen lds
    v_mfma_f32_16x16x32_bf16 v[80:83], a[220:223], a[176:179], 0
    v_exp_f32 v60, v60
    v_mfma_f32_16x16x32_bf16 v[80:83], a[216:219], a[172:175], v[80:83]
    s_add_u32 s20, s20, 128
    s_add_u32 m0, s22, 13312
    v_fma_f32 v55, v55, s28, v9
    v_mfma_f32_16x16x32_bf16 v[80:83], a[212:215], a[168:171], v[80:83]
    buffer_load_dwordx4 v6, s[4:7], s20 offen lds
    v_mfma_f32_16x16x32_bf16 v[80:83], a[224:227], a[180:183], v[80:83]
    s_add_u32 s20, s20, 128
    ds_read_b64_tr_b16 a[212:213], v2 offset:0
    v_fma_f32 v52, v52, s28, v9
    v_mfma_f32_16x16x32_bf16 v[80:83], a[228:231], a[184:187], v[80:83]
    ds_read_b64_tr_b16 a[214:215], v2 offset:6144
    v_fma_f32 v53, v53, s28, v9
    v_mfma_f32_16x16x32_bf16 v[80:83], a[232:235], a[188:191], v[80:83]
    ds_read_b64_tr_b16 a[216:217], v3 offset:0
    v_fma_f32 v61, v61, s28, v10
    v_mfma_f32_16x16x32_bf16 v[72:75], a[232:235], a[164:167], v[72:75]
    s_add_u32 m0, s22, 14336
    ds_read_b64_tr_b16 a[218:219], v3 offset:6144
    v_mfma_f32_16x16x32_bf16 v[72:75], a[228:231], a[160:163], v[72:75]
    buffer_load_dwordx4 v6, s[4:7], s20 offen lds
    v_mfma_f32_16x16x32_bf16 v[72:75], a[224:227], a[156:159], v[72:75]
    v_exp_f32 v61, v61
    v_mfma_f32_16x16x32_bf16 v[64:67], a[224:227], a[132:135], v[64:67]
    v_exp_f32 v52, v52
    v_mfma_f32_16x16x32_bf16 v[64:67], a[228:231], a[136:139], v[64:67]
    ds_read_b64_tr_b16 a[220:221], v4 offset:0
    v_mfma_f32_16x16x32_bf16 v[64:67], a[232:235], a[140:143], v[64:67]
    buffer_store_dwordx4 v[96:99], v6, s[16:19], s57 offen offset:0 nt
    v_cvt_pk_bf16_f32 v24, v60, v61
    v_exp_f32 v55, v55
    v_mfma_f32_16x16x32_bf16 v[56:59], a[232:235], a[116:119], v[56:59]
    v_exp_f32 v53, v53
    v_mfma_f32_16x16x32_bf16 v[56:59], a[228:231], a[112:115], v[56:59]
    buffer_store_dwordx4 v[84:87], v7, s[16:19], s57 offen offset:0 nt
    s_add_u32 s20, s20, 12032
    ds_read_b64_tr_b16 a[222:223], v4 offset:6144
    v_cvt_pk_bf16_f32 v18, v52, v53
    v_cvt_pk_bf16_f32 v19, v54, v55
    v_mfma_f32_16x16x32_bf16 v[56:59], a[224:227], a[108:111], v[56:59]
    ds_read_b64_tr_b16 a[224:225], v5 offset:0
    ds_read_b64_tr_b16 a[226:227], v5 offset:6144
    s_waitcnt lgkmcnt(6)
    v_mfma_f32_16x16x32_bf16 v[112:115], a[212:215], v[14:17], v[112:115]
    v_lshrrev_b32 v105, 11, v0
    v_fma_f32 v62, v62, s28, v10
    v_xor_b32 v105, s65, v105
    v_mfma_f32_16x16x32_bf16 v[160:163], a[212:215], v[20:23], v[160:163]
    v_fma_f32 v67, v67, s28, v10
    v_and_b32 v104, 0x3ff, v0
    v_fma_f32 v79, v79, s28, v12
    v_mfma_f32_16x16x32_bf16 v[208:211], a[212:215], v[26:29], v[208:211]
    ds_read_b64_tr_b16 a[230:231], v2 offset:7168
    v_fma_f32 v71, v71, s28, v11
    v_mfma_f32_16x16x32_bf16 a[0:3], a[212:215], v[32:35], a[0:3]
    s_waitcnt lgkmcnt(5)
    ds_read_b64_tr_b16 a[228:229], v2 offset:1024
    v_lshl_add_u32 v104, v105, 10, v104
    v_mfma_f32_16x16x32_bf16 a[4:7], a[216:219], v[32:35], a[4:7]
    ds_read_b64_tr_b16 a[232:233], v3 offset:1024
    v_fma_f32 v69, v69, s28, v11
    v_mfma_f32_16x16x32_bf16 v[212:215], a[216:219], v[26:29], v[212:215]
    v_fma_f32 v63, v63, s28, v10
    v_fma_f32 v80, v80, s28, v12
    v_mfma_f32_16x16x32_bf16 v[164:167], a[216:219], v[20:23], v[164:167]
    ds_read_b64_tr_b16 a[234:235], v3 offset:7168
    v_fma_f32 v56, v56, s28, v9
    v_mfma_f32_16x16x32_bf16 v[116:119], a[216:219], v[14:17], v[116:119]
    s_waitcnt lgkmcnt(6)
    ds_read_b64_tr_b16 a[214:215], v4 offset:7168
    v_fma_f32 v68, v68, s28, v11
    v_mfma_f32_16x16x32_bf16 v[120:123], a[220:223], v[14:17], v[120:123]
    ds_read_b64_tr_b16 a[212:213], v4 offset:1024
    v_add_u32 v104, s38, v104
    v_mfma_f32_16x16x32_bf16 v[168:171], a[220:223], v[20:23], v[168:171]
    v_fma_f32 v65, v65, s28, v10
    v_fma_f32 v70, v70, s28, v11
    v_mfma_f32_16x16x32_bf16 v[216:219], a[220:223], v[26:29], v[216:219]
    ds_read_b128 a[168:171], v104 offset:18432
    v_fma_f32 v58, v58, s28, v9
    v_mfma_f32_16x16x32_bf16 a[8:11], a[220:223], v[32:35], a[8:11]
    s_waitcnt lgkmcnt(7)
    ds_read_b128 a[104:107], v104 offset:2048
    v_fma_f32 v76, v76, s28, v12
    v_mfma_f32_16x16x32_bf16 a[12:15], a[224:227], v[32:35], a[12:15]
    v_exp_f32 v76, v76
    v_mfma_f32_16x16x32_bf16 v[220:223], a[224:227], v[26:29], v[220:223]
    v_exp_f32 v62, v62
    v_mfma_f32_16x16x32_bf16 v[172:175], a[224:227], v[20:23], v[172:175]
    s_add_u32 s39, s39, 12288
    ds_read_b64_tr_b16 a[220:221], v2 offset:2048
    v_fma_f32 v77, v77, s28, v12
    v_mfma_f32_16x16x32_bf16 v[124:127], a[224:227], v[14:17], v[124:127]
    s_waitcnt lgkmcnt(6)
    ds_read_b64_tr_b16 a[226:227], v3 offset:8192
    v_fma_f32 v78, v78, s28, v12
    v_mfma_f32_16x16x32_bf16 v[128:131], a[228:231], v[14:17], v[128:131]
    ds_read_b64_tr_b16 a[216:217], v5 offset:1024
    v_fma_f32 v74, v74, s28, v11
    v_mfma_f32_16x16x32_bf16 v[176:179], a[228:231], v[20:23], v[176:179]
    ds_read_b64_tr_b16 a[218:219], v5 offset:7168
    v_fma_f32 v59, v59, s28, v9
    v_mfma_f32_16x16x32_bf16 v[224:227], a[228:231], v[26:29], v[224:227]
    v_exp_f32 v70, v70
    v_mfma_f32_16x16x32_bf16 a[16:19], a[228:231], v[32:35], a[16:19]
    s_waitcnt lgkmcnt(6)
    ds_read_b64_tr_b16 a[230:231], v4 offset:8192
    v_exp_f32 v74, v74
    v_mfma_f32_16x16x32_bf16 a[20:23], a[232:235], v[32:35], a[20:23]
    ds_read_b64_tr_b16 a[228:229], v4 offset:2048
    v_fma_f32 v72, v72, s28, v11
    v_mfma_f32_16x16x32_bf16 v[228:231], a[232:235], v[26:29], v[228:231]
    ds_read_b64_tr_b16 a[222:223], v2 offset:8192
    v_fma_f32 v66, v66, s28, v10
    v_mfma_f32_16x16x32_bf16 v[180:183], a[232:235], v[20:23], v[180:183]
    ds_read_b64_tr_b16 a[224:225], v3 offset:2048
    v_xor_b32 v105, 64, v104
    v_mfma_f32_16x16x32_bf16 v[132:135], a[232:235], v[14:17], v[132:135]
    ds_read_b64_tr_b16 a[232:233], v5 offset:2048
    ds_read_b64_tr_b16 a[234:235], v5 offset:8192
    v_mfma_f32_16x16x32_bf16 v[136:139], a[212:215], v[14:17], v[136:139]
    ds_read_b128 a[172:175], v105 offset:18432
    v_fma_f32 v73, v73, s28, v11
    v_mfma_f32_16x16x32_bf16 v[184:187], a[212:215], v[20:23], v[184:187]
    ds_read_b128 a[124:127], v105 offset:6144
    v_fma_f32 v81, v81, s28, v12
    v_mfma_f32_16x16x32_bf16 v[232:235], a[212:215], v[26:29], v[232:235]
    ds_read_b128 a[120:123], v104 offset:6144
    v_exp_f32 v56, v56
    v_mfma_f32_16x16x32_bf16 a[24:27], a[212:215], v[32:35], a[24:27]
    s_waitcnt lgkmcnt(9)
    ds_read_b128 a[96:99], v104 offset:0
    v_exp_f32 v68, v68
    v_mfma_f32_16x16x32_bf16 a[28:31], a[216:219], v[32:35], a[28:31]
    v_exp_f32 v79, v79
    v_mfma_f32_16x16x32_bf16 v[236:239], a[216:219], v[26:29], v[236:239]
    ds_read_b128 a[144:147], v104 offset:12288
    v_fma_f32 v64, v64, s28, v10
    v_mfma_f32_16x16x32_bf16 v[188:191], a[216:219], v[20:23], v[188:191]
    ds_read_b128 a[160:163], v104 offset:16384
    v_exp_f32 v78, v78
    v_mfma_f32_16x16x32_bf16 v[140:143], a[216:219], v[14:17], v[140:143]
    s_waitcnt lgkmcnt(8)
    ds_read_b128 a[132:135], v105 offset:8192
    v_exp_f32 v63, v63
    v_mfma_f32_16x16x32_bf16 v[144:147], a[220:223], v[14:17], v[144:147]
    s_waitcnt vmcnt(10) lgkmcnt(7)
    v_exp_f32 v65, v65
    v_mfma_f32_16x16x32_bf16 v[192:195], a[220:223], v[20:23], v[192:195]
    v_exp_f32 v69, v69
    v_mfma_f32_16x16x32_bf16 v[240:243], a[220:223], v[26:29], v[240:243]
    s_barrier
    ds_read_b128 a[180:183], v105 offset:20480
    v_mfma_f32_16x16x32_bf16 a[32:35], a[220:223], v[32:35], a[32:35]
    s_add_u32 s21, s21, s62
    ds_read_b128 a[212:215], v0 offset:0
    v_fma_f32 v82, v82, s28, v12
    v_mfma_f32_16x16x32_bf16 a[36:39], a[224:227], v[32:35], a[36:39]
    s_add_u32 m0, s22, 24576
    ds_read_b128 a[128:131], v104 offset:8192
    buffer_load_dwordx4 v6, s[8:11], s21 offen lds
    v_mfma_f32_16x16x32_bf16 v[244:247], a[224:227], v[26:29], v[244:247]
    s_add_u32 s21, s21, 128
    ds_read_b128 a[216:219], v1 offset:0
    v_fma_f32 v57, v57, s28, v9
    v_mfma_f32_16x16x32_bf16 v[196:199], a[224:227], v[20:23], v[196:199]
    v_exp_f32 v77, v77
    v_mfma_f32_16x16x32_bf16 v[148:151], a[224:227], v[14:17], v[148:151]
    s_add_u32 m0, s22, 25600
    ds_read_b128 a[100:103], v105 offset:0
    buffer_load_dwordx4 v6, s[8:11], s21 offen lds
    v_mfma_f32_16x16x32_bf16 v[152:155], a[228:231], v[14:17], v[152:155]
    ds_read_b128 a[148:151], v105 offset:12288
    v_fma_f32 v83, v83, s28, v12
    v_mfma_f32_16x16x32_bf16 v[200:203], a[228:231], v[20:23], v[200:203]
    s_add_u32 s21, s21, 128
    ds_read_b128 a[176:179], v104 offset:20480
    v_exp_f32 v71, v71
    v_mfma_f32_16x16x32_bf16 v[248:251], a[228:231], v[26:29], v[248:251]
    s_add_u32 m0, s22, 26624
    ds_read_b128 a[220:223], v0 offset:1024
    buffer_load_dwordx4 v6, s[8:11], s21 offen lds
    v_mfma_f32_16x16x32_bf16 a[40:43], a[228:231], v[32:35], a[40:43]
    ds_read_b128 a[152:155], v104 offset:14336
    v_fma_f32 v75, v75, s28, v11
    v_mfma_f32_16x16x32_bf16 a[44:47], a[232:235], v[32:35], a[44:47]
    ds_read_b128 a[156:159], v105 offset:14336
    v_cvt_pk_bf16_f32 v25, v62, v63
    v_mfma_f32_16x16x32_bf16 v[252:255], a[232:235], v[26:29], v[252:255]
    ds_read_b128 a[108:111], v105 offset:2048
    v_cvt_pk_bf16_f32 v37, v78, v79
    v_mfma_f32_16x16x32_bf16 v[204:207], a[232:235], v[20:23], v[204:207]
    v_exp_f32 v75, v75
    v_mfma_f32_16x16x32_bf16 v[156:159], a[232:235], v[14:17], v[156:159]
    s_waitcnt lgkmcnt(7)
    ds_read_b128 a[224:227], v1 offset:1024
    v_cvt_pk_bf16_f32 v31, v70, v71
    v_mfma_f32_16x16x32_bf16 v[52:55], a[212:215], a[96:99], 0
    ds_read_b128 a[112:115], v104 offset:4096
    v_cvt_pk_bf16_f32 v30, v68, v69
    v_mfma_f32_16x16x32_bf16 v[60:63], a[212:215], a[120:123], 0
    ds_read_b128 a[228:231], v0 offset:6144
    v_cvt_pk_bf16_f32 v36, v76, v77
    v_mfma_f32_16x16x32_bf16 v[68:71], a[212:215], a[144:147], 0
    v_exp_f32 v82, v82
    v_mfma_f32_16x16x32_bf16 v[76:79], a[212:215], a[168:171], 0
    s_waitcnt lgkmcnt(7)
    v_exp_f32 v83, v83
    v_mfma_f32_16x16x32_bf16 v[52:55], a[216:219], a[100:103], v[52:55]
    v_exp_f32 v58, v58
    v_mfma_f32_16x16x32_bf16 v[60:63], a[216:219], a[124:127], v[60:63]
    v_exp_f32 v80, v80
    v_mfma_f32_16x16x32_bf16 v[68:71], a[216:219], a[148:151], v[68:71]
    v_exp_f32 v59, v59
    v_mfma_f32_16x16x32_bf16 v[76:79], a[216:219], a[172:175], v[76:79]
    s_waitcnt lgkmcnt(3)
    v_exp_f32 v73, v73
    v_mfma_f32_16x16x32_bf16 v[52:55], a[220:223], a[104:107], v[52:55]
    v_exp_f32 v81, v81
    v_mfma_f32_16x16x32_bf16 v[60:63], a[220:223], a[128:131], v[60:63]
    v_exp_f32 v72, v72
    v_mfma_f32_16x16x32_bf16 v[68:71], a[220:223], a[152:155], v[68:71]
    v_exp_f32 v67, v67
    v_mfma_f32_16x16x32_bf16 v[76:79], a[220:223], a[176:179], v[76:79]
    s_waitcnt lgkmcnt(0)
    v_exp_f32 v57, v57
    v_mfma_f32_16x16x32_bf16 v[52:55], a[224:227], a[108:111], v[52:55]
    ds_read_b128 a[232:235], v1 offset:6144
    v_cvt_pk_bf16_f32 v17, v58, v59
    v_mfma_f32_16x16x32_bf16 v[60:63], a[224:227], a[132:135], v[60:63]
    ds_read_b128 a[212:215], v0 offset:7168
    v_cvt_pk_bf16_f32 v16, v56, v57
    v_mfma_f32_16x16x32_bf16 v[68:71], a[224:227], a[156:159], v[68:71]
    v_exp_f32 v64, v64
    v_mfma_f32_16x16x32_bf16 v[76:79], a[224:227], a[180:183], v[76:79]
    v_exp_f32 v66, v66
    v_cvt_pk_bf16_f32 v29, v74, v75
    v_mfma_f32_16x16x32_bf16 v[48:51], a[236:239], v[16:19], v[44:47]
    ds_read_b128 a[188:191], v105 offset:22528
    v_cvt_pk_bf16_f32 v22, v64, v65
    v_mfma_f32_16x16x32_bf16 v[56:59], a[228:231], a[96:99], 0
    ds_read_b128 a[216:219], v1 offset:7168
    v_cvt_pk_bf16_f32 v23, v66, v67
    v_mfma_f32_16x16x32_bf16 v[64:67], a[228:231], a[120:123], 0
    v_cvt_pk_bf16_f32 v28, v72, v73
    v_cvt_pk_bf16_f32 v35, v82, v83
    v_mfma_f32_16x16x32_bf16 v[48:51], a[240:243], v[22:25], v[48:51]
    ds_read_b128 a[136:139], v104 offset:10240
    v_mfma_f32_16x16x32_bf16 v[48:51], a[244:247], v[28:31], v[48:51]
    ds_read_b128 a[116:119], v105 offset:4096
    v_cvt_pk_bf16_f32 v34, v80, v81
    v_mfma_f32_16x16x32_bf16 v[72:75], a[228:231], a[144:147], 0
    ds_read_b128 a[184:187], v104 offset:22528
    v_mfma_f32_16x16x32_bf16 v[48:51], a[248:251], v[34:37], v[48:51]
    ds_read_b128 a[140:143], v105 offset:10240
    v_mfma_f32_16x16x32_bf16 v[80:83], a[228:231], a[168:171], 0
    s_waitcnt lgkmcnt(6)
    ds_read_b128 a[228:231], v0 offset:8192
    v_mfma_f32_16x16x32_bf16 v[56:59], a[232:235], a[100:103], v[56:59]
    s_add_u32 s21, s21, 12032
    ds_read_b128 a[224:227], v1 offset:2048
    v_mfma_f32_16x16x32_bf16 v[64:67], a[232:235], a[124:127], v[64:67]
    ds_read_b128 a[164:167], v105 offset:16384
    v_cmp_lt_f32 vcc, s29, v48
    v_mfma_f32_16x16x32_bf16 v[72:75], a[232:235], a[148:151], v[72:75]
    ds_read_b128 a[220:223], v0 offset:2048
    v_mfma_f32_16x16x32_bf16 v[80:83], a[232:235], a[172:175], v[80:83]
    ds_read_b128 a[232:235], v1 offset:8192
    v_mfma_f32_16x16x32_bf16 v[56:59], a[212:215], a[104:107], v[56:59]
    s_cbranch_vccnz L_rs_tr44b
L_ret_tr44b:
    v_mfma_f32_16x16x32_bf16 v[64:67], a[212:215], a[128:131], v[64:67]
    v_rcp_f32 v102, v49
    v_mfma_f32_16x16x32_bf16 v[72:75], a[212:215], a[152:155], v[72:75]
    v_lshrrev_b32 v108, 11, v0
    v_xor_b32 v108, s65, v108
    v_mfma_f32_16x16x32_bf16 v[80:83], a[212:215], a[176:179], v[80:83]
    s_waitcnt lgkmcnt(6)
    v_mfma_f32_16x16x32_bf16 v[56:59], a[216:219], a[108:111], v[56:59]
    v_mov_b32 v100, v48
    s_nop 1
    v_permlane32_swap_b32 v48, v100
    v_and_b32 v101, 0x3ff, v0
    v_lshl_add_u32 v101, v108, 10, v101
    v_mbcnt_lo_u32_b32 v108, -1, 0
    v_mfma_f32_16x16x32_bf16 v[64:67], a[216:219], a[132:135], v[64:67]
    v_mbcnt_hi_u32_b32 v108, -1, v108
    v_lshrrev_b32 v108, 1, v108
    v_mfma_f32_16x16x32_bf16 v[72:75], a[216:219], a[156:159], v[72:75]
    v_mfma_f32_16x16x32_bf16 v[80:83], a[216:219], a[180:183], v[80:83]
    s_waitcnt vmcnt(9) lgkmcnt(0)
    s_barrier
    v_mfma_f32_16x16x32_bf16 v[52:55], a[220:223], a[112:115], v[52:55]
    s_add_u32 m0, s22, 0
    ds_read_b64_tr_b16 a[212:213], v2 offset:18432
    v_and_b32 v108, 24, v108
    v_mfma_f32_16x16x32_bf16 v[60:63], a[220:223], a[136:139], v[60:63]
    buffer_load_dwordx4 v6, s[4:7], s20 offen lds
    v_mfma_f32_16x16x32_bf16 v[68:71], a[220:223], a[160:163], v[68:71]
    s_add_u32 s20, s20, 128
    s_add_u32 m0, s22, 1024
    ds_read_b64_tr_b16 a[214:215], v2 offset:12288
    v_mfma_f32_16x16x32_bf16 v[76:79], a[220:223], a[184:187], v[76:79]
    buffer_load_dwordx4 v6, s[4:7], s20 offen lds
    v_mfma_f32_16x16x32_bf16 v[52:55], a[224:227], a[116:119], v[52:55]
    s_add_u32 s20, s20, 128
    ds_read_b64_tr_b16 a[216:217], v3 offset:18432
    s_add_u32 m0, s22, 2048
    v_mfma_f32_16x16x32_bf16 v[60:63], a[224:227], a[140:143], v[60:63]
    buffer_load_dwordx4 v6, s[4:7], s20 offen lds
    v_mfma_f32_16x16x32_bf16 v[68:71], a[224:227], a[164:167], v[68:71]
    ds_read_b64_tr_b16 a[218:219], v3 offset:12288
    v_bfe_u32 v108, s66, v108, 8
    v_mfma_f32_16x16x32_bf16 v[76:79], a[224:227], a[188:191], v[76:79]
    v_rcp_f32 v8, v51
    v_mfma_f32_16x16x32_bf16 v[56:59], a[228:231], a[112:115], v[56:59]
    v_mfma_f32_16x16x32_bf16 v[64:67], a[228:231], a[136:139], v[64:67]
    ds_read_b64_tr_b16 a[220:221], v4 offset:18432
    v_add_u32 v101, s38, v101
    v_mfma_f32_16x16x32_bf16 v[72:75], a[228:231], a[160:163], v[72:75]
    s_add_u32 s20, s20, 12032
    ds_read_b64_tr_b16 a[222:223], v4 offset:12288
    v_mfma_f32_16x16x32_bf16 v[80:83], a[228:231], a[184:187], v[80:83]
    ds_read_b64_tr_b16 a[224:225], v5 offset:18432
    v_mfma_f32_16x16x32_bf16 v[56:59], a[232:235], a[116:119], v[56:59]
    v_rcp_f32 v50, v50
    v_mfma_f32_16x16x32_bf16 v[64:67], a[232:235], a[140:143], v[64:67]
    v_xor_b32 v101, v101, v108
    v_mfma_f32_16x16x32_bf16 v[72:75], a[232:235], a[164:167], v[72:75]
    ds_read_b64_tr_b16 a[226:227], v5 offset:12288
    v_mfma_f32_16x16x32_bf16 v[80:83], a[232:235], a[188:191], v[80:83]
    v_rcp_f32 v48, v48
    v_max3_f32 v98, v60, v61, v62
    v_max3_f32 v96, v52, v53, v54
    v_max3_f32 v96, v96, v55, v56
    v_max3_f32 v96, v96, v57, v58
    v_max3_f32 v98, v98, v63, v64
    s_waitcnt lgkmcnt(6)
    v_mfma_f32_16x16x32_bf16 v[112:115], a[212:215], v[16:19], v[112:115]
    v_max3_f32 v98, v98, v65, v66
    v_max_f32 v98, v98, v67
    v_mov_b32 v99, v98
    v_mfma_f32_16x16x32_bf16 v[160:163], a[212:215], v[22:25], v[160:163]
    s_mov_b32 s67, s34
    ds_read_b64_tr_b16 a[230:231], v2 offset:13312
    v_permlane32_swap_b32 v99, v98
    v_mfma_f32_16x16x32_bf16 v[208:211], a[212:215], v[28:31], v[208:211]
    s_add_u32 s18, s34, 24576
    ds_read_b64_tr_b16 a[228:229], v2 offset:19456
    v_max_f32 v98, v98, v99
    v_mfma_f32_16x16x32_bf16 a[0:3], a[212:215], v[34:37], a[0:3]
    s_waitcnt lgkmcnt(6)
    v_max_f32 v96, v96, v59
    v_mov_b32 v97, v96
    v_mfma_f32_16x16x32_bf16 a[4:7], a[216:219], v[34:37], a[4:7]
    s_mov_b32 s34, s33
    ds_read_b64_tr_b16 a[232:233], v3 offset:19456
    v_mov_b32 v99, v98
    v_mfma_f32_16x16x32_bf16 v[212:215], a[216:219], v[28:31], v[212:215]
    ds_read_b64_tr_b16 a[234:235], v3 offset:13312
    v_permlane32_swap_b32 v97, v96
    v_mfma_f32_16x16x32_bf16 v[164:167], a[216:219], v[22:25], v[164:167]
    s_add_u32 s64, s64, s62
    ds_read_b64_tr_b16 a[212:213], v4 offset:19456
    v_max_f32 v96, v96, v97
    v_mfma_f32_16x16x32_bf16 v[116:119], a[216:219], v[16:19], v[116:119]
    s_waitcnt lgkmcnt(5)
    ds_read_b64_tr_b16 a[216:217], v5 offset:19456
    v_permlane16_swap_b32 v99, v98
    v_mfma_f32_16x16x32_bf16 v[120:123], a[220:223], v[16:19], v[120:123]
    s_add_u32 s64, s64, 196608
    v_max_f32 v98, v98, v99
    v_mul_f32_e64 v10, -s28, v98
    v_max3_f32 v98, v76, v77, v78
    v_mov_b32 v97, v96
    v_max3_f32 v98, v98, v79, v80
    v_mfma_f32_16x16x32_bf16 v[168:171], a[220:223], v[22:25], v[168:171]
    s_mov_b32 s39, s64
    ds_read_b64_tr_b16 a[218:219], v5 offset:13312
    v_permlane16_swap_b32 v97, v96
    v_max3_f32 v98, v98, v81, v82
    v_mfma_f32_16x16x32_bf16 v[216:219], a[220:223], v[28:31], v[216:219]
    s_add_u32 s37, s37, 1
    ds_read_b64_tr_b16 a[214:215], v4 offset:13312
    v_max_f32 v96, v96, v97
    v_mfma_f32_16x16x32_bf16 a[8:11], a[220:223], v[34:37], a[8:11]
    s_bitcmp1_b32 s63, s37
    v_mul_f32_e64 v9, -s28, v96
    v_fma_f32 v63, v63, s28, v10
    v_mfma_f32_16x16x32_bf16 a[12:15], a[224:227], v[34:37], a[12:15]
    v_max_f32 v98, v98, v83
    v_max3_f32 v96, v68, v69, v70
    v_mfma_f32_16x16x32_bf16 v[220:223], a[224:227], v[28:31], v[220:223]
    s_cselect_b32 s62, 4294770688, 0
    v_accvgpr_read_b32 v104, a0
    v_max3_f32 v96, v96, v71, v72
    v_mfma_f32_16x16x32_bf16 v[172:175], a[224:227], v[22:25], v[172:175]
    s_cselect_b32 s42, 0, 325632
    v_mov_b32 v99, v98
    v_fma_f32 v61, v61, s28, v10
    v_max3_f32 v96, v96, v73, v74
    v_mfma_f32_16x16x32_bf16 v[124:127], a[224:227], v[16:19], v[124:127]
    s_waitcnt lgkmcnt(2)
    v_exp_f32 v63, v63
    v_mfma_f32_16x16x32_bf16 v[128:131], a[228:231], v[16:19], v[128:131]
    s_add_u32 s35, s35, s42
    v_max_f32 v96, v96, v75
    v_fma_f32 v60, v60, s28, v10
    v_mfma_f32_16x16x32_bf16 v[176:179], a[228:231], v[22:25], v[176:179]
    s_lshl_b32 s42, s37, 1
    ds_read_b64_tr_b16 a[222:223], v2 offset:14336
    v_mov_b32 v97, v96
    v_mfma_f32_16x16x32_bf16 v[224:227], a[228:231], v[28:31], v[224:227]
    s_lshr_b32 s42, s31, s42
    v_permlane32_swap_b32 v97, v96
    v_permlane32_swap_b32 v99, v98
    v_mfma_f32_16x16x32_bf16 a[16:19], a[228:231], v[34:37], a[16:19]
    s_and_b32 s42, s42, 3
    s_add_u32 s42, s42, s36
    v_fma_f32 v54, v54, s28, v9
    v_mfma_f32_16x16x32_bf16 a[20:23], a[232:235], v[34:37], a[20:23]
    s_sub_u32 s43, s42, 3
    ds_read_b64_tr_b16 a[228:229], v4 offset:20480
    v_max_f32 v98, v98, v99
    v_mfma_f32_16x16x32_bf16 v[228:231], a[232:235], v[28:31], v[228:231]
    s_cmp_ge_u32 s42, 3
    s_cselect_b32 s42, s43, s42
    ds_read_b64_tr_b16 a[220:221], v2 offset:20480
    v_fma_f32 v52, v52, s28, v9
    v_mfma_f32_16x16x32_bf16 v[180:183], a[232:235], v[22:25], v[180:183]
    s_mul_i32 s44, s3, 5
    ds_read_b64_tr_b16 a[230:231], v4 offset:14336
    v_fma_f32 v64, v64, s28, v10
    v_mov_b32 v99, v98
    v_mfma_f32_16x16x32_bf16 v[132:135], a[232:235], v[16:19], v[132:135]
    s_waitcnt lgkmcnt(4)
    ds_read_b64_tr_b16 a[224:225], v3 offset:20480
    v_permlane16_swap_b32 v99, v98
    v_max_f32 v96, v96, v97
    v_mfma_f32_16x16x32_bf16 v[136:139], a[212:215], v[16:19], v[136:139]
    s_mov_b32 s32, 1
    v_fma_f32 v67, v67, s28, v10
    v_mov_b32 v97, v96
    v_mfma_f32_16x16x32_bf16 v[184:187], a[212:215], v[22:25], v[184:187]
    s_lshl_b32 s43, s3, 2
    s_add_u32 s45, s43, 21
    ds_read_b64_tr_b16 a[226:227], v3 offset:14336
    v_mfma_f32_16x16x32_bf16 v[232:235], a[212:215], v[28:31], v[232:235]
    s_cmp_eq_u32 s3, 0
    ds_read_b64_tr_b16 a[234:235], v5 offset:14336
    s_cselect_b32 s45, 20, s45
    v_fma_f32 v56, v56, s28, v9
    v_mfma_f32_16x16x32_bf16 a[24:27], a[212:215], v[34:37], a[24:27]
    s_cselect_b32 s33, 1, 0
    v_exp_f32 v54, v54
    v_exp_f32 v60, v60
    s_cmp_eq_u32 s42, 1
    v_fma_f32 v53, v53, s28, v9
    s_cselect_b32 s44, s45, s44
    v_fma_f32 v57, v57, s28, v9
    v_fma_f32 v62, v62, s28, v10
    v_fma_f32 v66, v66, s28, v10
    v_max_f32 v98, v98, v99
    s_cselect_b32 s32, s33, s32
    v_mfma_f32_16x16x32_bf16 a[28:31], a[216:219], v[34:37], a[28:31]
    s_add_u32 s45, s43, 37
    s_cmp_eq_u32 s42, 2
    v_mul_f32_e64 v12, -s28, v98
    v_mfma_f32_16x16x32_bf16 v[236:239], a[216:219], v[28:31], v[236:239]
    s_cselect_b32 s44, s45, s44
    s_cselect_b32 s32, 0, s32
    v_exp_f32 v53, v53
    v_fma_f32 v55, v55, s28, v9
    v_permlane16_swap_b32 v97, v96
    v_pk_mul_f32 v[114:115], v[114:115], v[48:49] op_sel_hi:[1,0]
    v_max_f32 v96, v96, v97
    v_fma_f32 v83, v83, s28, v12
    v_mfma_f32_16x16x32_bf16 v[188:191], a[216:219], v[22:25], v[188:191]
    s_mul_i32 s44, s44, 6144
    v_mul_f32_e64 v11, -s28, v96
    v_fma_f32 v59, v59, s28, v9
    v_mfma_f32_16x16x32_bf16 v[140:143], a[216:219], v[16:19], v[140:143]
    s_waitcnt lgkmcnt(1)
    ds_read_b64_tr_b16 a[232:233], v5 offset:20480
    v_fma_f32 v71, v71, s28, v11
    v_mfma_f32_16x16x32_bf16 v[144:147], a[220:223], v[16:19], v[144:147]
    s_add_u32 s33, s35, s44
    s_mul_i32 s42, s32, 6144
    v_fma_f32 v78, v78, s28, v12
    v_mfma_f32_16x16x32_bf16 v[192:195], a[220:223], v[22:25], v[192:195]
    s_add_u32 s42, s42, 24576
    v_exp_f32 v62, v62
    v_mfma_f32_16x16x32_bf16 v[240:243], a[220:223], v[28:31], v[240:243]
    s_add_u32 s42, s42, s33
    v_fma_f32 v70, v70, s28, v11
    v_exp_f32 v61, v61
    v_cvt_pk_bf16_f32 v21, v62, v63
    v_mfma_f32_16x16x32_bf16 a[32:35], a[220:223], v[34:37], a[32:35]
    s_cmp_ge_u32 s37, 6
    v_fma_f32 v69, v69, s28, v11
    v_fma_f32 v79, v79, s28, v12
    v_mfma_f32_16x16x32_bf16 a[36:39], a[224:227], v[34:37], a[36:39]
    s_cselect_b32 s14, 0, s42
    v_fma_f32 v81, v81, s28, v12
    v_fma_f32 v75, v75, s28, v11
    v_mfma_f32_16x16x32_bf16 v[244:247], a[224:227], v[28:31], v[244:247]
    s_add_u32 s24, s67, 6144
    v_exp_f32 v52, v52
    v_mfma_f32_16x16x32_bf16 v[196:199], a[224:227], v[22:25], v[196:199]
    s_add_u32 s25, s33, 6144
    s_add_u32 s23, s38, 6144
    v_fma_f32 v72, v72, s28, v11
    v_mfma_f32_16x16x32_bf16 v[148:151], a[224:227], v[16:19], v[148:151]
    s_mov_b32 s27, 0x30c30
    v_fma_f32 v74, v74, s28, v11
    v_fma_f32 v82, v82, s28, v12
    v_fma_f32 v76, v76, s28, v12
    s_mov_b32 s89, 0xaaaaaaaa
    v_fma_f32 v68, v68, s28, v11
    v_mfma_f32_16x16x32_bf16 v[152:155], a[228:231], v[16:19], v[152:155]
    s_mov_b32 s30, 0
    s_waitcnt vmcnt(8) lgkmcnt(0)
    v_exp_f32 v76, v76
    v_mfma_f32_16x16x32_bf16 v[200:203], a[228:231], v[22:25], v[200:203]
    s_barrier
    ds_read_b128 a[212:215], v0 offset:12288
    v_exp_f32 v78, v78
    v_mfma_f32_16x16x32_bf16 v[248:251], a[228:231], v[28:31], v[248:251]
    ds_read_b128 a[216:219], v1 offset:12288
    v_exp_f32 v55, v55
    v_exp_f32 v69, v69
    v_mfma_f32_16x16x32_bf16 a[40:43], a[228:231], v[34:37], a[40:43]
    ds_read_b128 a[220:223], v0 offset:13312
    v_exp_f32 v70, v70
    v_cvt_pk_bf16_f32 v15, v54, v55
    v_fma_f32 v73, v73, s28, v11
    v_exp_f32 v64, v64
    v_fma_f32 v77, v77, s28, v12
    v_pk_mul_f32 v[172:173], v[172:173], v[102:103] op_sel_hi:[1,0]
    v_exp_f32 v77, v77
    v_fma_f32 v65, v65, s28, v10
    v_exp_f32 v79, v79
    v_mfma_f32_16x16x32_bf16 a[44:47], a[232:235], v[34:37], a[44:47]
    ds_read_b128 a[228:231], v0 offset:14336
    v_cvt_pk_bf16_f32 v33, v78, v79
    v_mfma_f32_16x16x32_bf16 v[252:255], a[232:235], v[28:31], v[252:255]
    v_cvt_pk_bf16_f32 v14, v52, v53
    v_exp_f32 v71, v71
    v_mfma_f32_16x16x32_bf16 v[204:207], a[232:235], v[22:25], v[204:207]
    v_exp_f32 v66, v66
    v_exp_f32 v82, v82
    v_mfma_f32_16x16x32_bf16 v[156:159], a[232:235], v[16:19], v[156:159]
    s_waitcnt lgkmcnt(3)
    v_cvt_pk_bf16_f32 v20, v60, v61
    v_exp_f32 v68, v68
    v_mfma_f32_16x16x32_bf16 v[52:55], a[212:215], a[96:99], 0
    s_waitcnt lgkmcnt(2)
    v_accvgpr_read_b32 v109, a5
    v_accvgpr_read_b32 v108, a4
    v_mfma_f32_16x16x32_bf16 v[52:55], a[216:219], a[100:103], v[52:55]
    s_waitcnt lgkmcnt(1)
    ds_read_b128 a[232:235], v1 offset:14336
    v_cvt_pk_bf16_f32 v32, v76, v77
    v_mfma_f32_16x16x32_bf16 v[52:55], a[220:223], a[104:107], v[52:55]
    ds_read_b128 a[224:227], v1 offset:13312
    v_cvt_pk_bf16_f32 v27, v70, v71
    v_mfma_f32_16x16x32_bf16 v[60:63], a[220:223], a[128:131], 0
    v_accvgpr_read_b32 v105, a1
    v_cvt_pk_bf16_f32 v26, v68, v69
    v_exp_f32 v59, v59
    v_mfma_f32_16x16x32_bf16 v[60:63], a[216:219], a[124:127], v[60:63]
    v_exp_f32 v75, v75
    v_mfma_f32_16x16x32_bf16 v[60:63], a[212:215], a[120:123], v[60:63]
    s_add_u32 m0, s22, 36864
    v_exp_f32 v83, v83
    v_mfma_f32_16x16x32_bf16 v[68:71], a[212:215], a[144:147], 0
    v_fma_f32 v80, v80, s28, v12
    v_exp_f32 v81, v81
    v_fma_f32 v58, v58, s28, v9
    v_mfma_f32_16x16x32_bf16 v[68:71], a[216:219], a[148:151], v[68:71]
    v_exp_f32 v72, v72
    v_mfma_f32_16x16x32_bf16 v[68:71], a[220:223], a[152:155], v[68:71]
    v_exp_f32 v58, v58
    v_mfma_f32_16x16x32_bf16 v[76:79], a[220:223], a[176:179], 0
    buffer_load_dwordx4 v6, s[8:11], s21 offen lds
    v_mfma_f32_16x16x32_bf16 v[76:79], a[216:219], a[172:175], v[76:79]
    v_exp_f32 v67, v67
    v_mfma_f32_16x16x32_bf16 v[76:79], a[212:215], a[168:171], v[76:79]
    s_waitcnt lgkmcnt(0)
    v_exp_f32 v65, v65
    v_mfma_f32_16x16x32_bf16 v[76:79], a[224:227], a[180:183], v[76:79]
    v_exp_f32 v73, v73
    v_mfma_f32_16x16x32_bf16 v[76:79], a[228:231], a[184:187], v[76:79]
    v_exp_f32 v74, v74
    v_mfma_f32_16x16x32_bf16 v[76:79], a[232:235], a[188:191], v[76:79]
    s_add_u32 s21, s21, 128
    ds_read_b128 a[212:215], v0 offset:18432
    v_accvgpr_read_b32 v111, a7
    v_mfma_f32_16x16x32_bf16 v[68:71], a[232:235], a[164:167], v[68:71]
    s_add_u32 m0, s22, 37888
    v_exp_f32 v57, v57
    v_mfma_f32_16x16x32_bf16 v[68:71], a[228:231], a[160:163], v[68:71]
    v_exp_f32 v80, v80
    v_mfma_f32_16x16x32_bf16 v[68:71], a[224:227], a[156:159], v[68:71]
    v_cvt_pk_bf16_f32 v23, v66, v67
    v_cvt_pk_bf16_f32 v29, v74, v75
    v_mfma_f32_16x16x32_bf16 v[60:63], a[224:227], a[132:135], v[60:63]
    v_cvt_pk_bf16_f32 v28, v72, v73
    v_fma_f32 v79, v79, s28, v12
    v_mfma_f32_16x16x32_bf16 v[60:63], a[228:231], a[136:139], v[60:63]
    v_exp_f32 v56, v56
    v_mfma_f32_16x16x32_bf16 v[60:63], a[232:235], a[140:143], v[60:63]
    buffer_load_dwordx4 v6, s[8:11], s21 offen lds
    v_mfma_f32_16x16x32_bf16 v[52:55], a[232:235], a[116:119], v[52:55]
    ds_read_b128 a[216:219], v1 offset:18432
    v_accvgpr_read_b32 v107, a3
    v_mfma_f32_16x16x32_bf16 v[52:55], a[228:231], a[112:115], v[52:55]
    s_add_u32 s21, s21, 128
    ds_read_b128 a[232:235], v1 offset:20480
    v_accvgpr_read_b32 v106, a2
    v_mfma_f32_16x16x32_bf16 v[52:55], a[224:227], a[108:111], v[52:55]
    s_add_u32 m0, s22, 38912
    ds_read_b128 a[220:223], v0 offset:19456
    buffer_load_dwordx4 v6, s[8:11], s21 offen lds
    v_fma_f32 v68, v68, s28, v11
    v_cvt_pk_bf16_f32 v17, v58, v59
    v_pk_mul_f32 v[238:239], v[238:239], v[50:51] op_sel_hi:[1,0]
    v_accvgpr_read_b32 v110, a6
    v_pk_mul_f32 v[214:215], v[214:215], v[50:51] op_sel_hi:[1,0]
    v_pk_mul_f32 v[166:167], v[166:167], v[102:103] op_sel_hi:[1,0]
    v_pk_mul_f32 v[224:225], v[224:225], v[50:51] op_sel_hi:[1,0]
    v_pk_mul_f32 v[212:213], v[212:213], v[50:51] op_sel_hi:[1,0]
    v_pk_mul_f32 v[180:181], v[180:181], v[102:103] op_sel_hi:[1,0]
    v_pk_mul_f32 v[106:107], v[106:107], v[8:9] op_sel_hi:[1,0]
    v_cvt_pk_bf16_f32 v34, v80, v81
    v_pk_mul_f32 v[124:125], v[124:125], v[48:49] op_sel_hi:[1,0]
    v_pk_mul_f32 v[192:193], v[192:193], v[102:103] op_sel_hi:[1,0]
    v_pk_mul_f32 v[136:137], v[136:137], v[48:49] op_sel_hi:[1,0]
    v_fma_f32 v53, v53, s28, v9
    v_pk_mul_f32 v[208:209], v[208:209], v[50:51] op_sel_hi:[1,0]
    v_pk_mul_f32 v[112:113], v[112:113], v[48:49] op_sel_hi:[1,0]
    v_pk_mul_f32 v[116:117], v[116:117], v[48:49] op_sel_hi:[1,0]
    v_fma_f32 v76, v76, s28, v12
    v_pk_mul_f32 v[220:221], v[220:221], v[50:51] op_sel_hi:[1,0]
    v_pk_mul_f32 v[118:119], v[118:119], v[48:49] op_sel_hi:[1,0]
    v_pk_mul_f32 v[120:121], v[120:121], v[48:49] op_sel_hi:[1,0]
    v_pk_mul_f32 v[126:127], v[126:127], v[48:49] op_sel_hi:[1,0]
    v_cvt_pk_bf16_f32 v16, v56, v57
    v_pk_mul_f32 v[128:129], v[128:129], v[48:49] op_sel_hi:[1,0]
    v_pk_mul_f32 v[176:177], v[176:177], v[102:103] op_sel_hi:[1,0]
    v_pk_mul_f32 v[110:111], v[110:111], v[8:9] op_sel_hi:[1,0]
    v_pk_mul_f32 v[144:145], v[144:145], v[48:49] op_sel_hi:[1,0]
    v_fma_f32 v62, v62, s28, v10
    v_fma_f32 v60, v60, s28, v10
    v_pk_mul_f32 v[188:189], v[188:189], v[102:103] op_sel_hi:[1,0]
    v_fma_f32 v71, v71, s28, v11
    v_pk_mul_f32 v[160:161], v[160:161], v[102:103] op_sel_hi:[1,0]
    v_pk_mul_f32 v[108:109], v[108:109], v[8:9] op_sel_hi:[1,0]
    v_pk_mul_f32 v[104:105], v[104:105], v[8:9] op_sel_hi:[1,0]
    v_pk_mul_f32 v[162:163], v[162:163], v[102:103] op_sel_hi:[1,0]
    v_pk_mul_f32 v[210:211], v[210:211], v[50:51] op_sel_hi:[1,0]
    v_pk_mul_f32 v[164:165], v[164:165], v[102:103] op_sel_hi:[1,0]
    v_pk_mul_f32 v[216:217], v[216:217], v[50:51] op_sel_hi:[1,0]
    v_fma_f32 v55, v55, s28, v9
    s_waitcnt lgkmcnt(0)
    v_mfma_f32_16x16x32_bf16 v[56:59], a[212:215], a[96:99], 0
    ds_read_b128 a[228:231], v0 offset:20480
    v_cvt_pk_bf16_f32 v22, v64, v65
    v_mfma_f32_16x16x32_bf16 v[56:59], a[216:219], a[100:103], v[56:59]
    s_add_u32 s21, s21, 12032
    ds_read_b128 a[224:227], v1 offset:19456
    v_fma_f32 v78, v78, s28, v12
    v_mfma_f32_16x16x32_bf16 v[56:59], a[220:223], a[104:107], v[56:59]
    v_exp_f32 v62, v62
    v_mfma_f32_16x16x32_bf16 v[64:67], a[220:223], a[128:131], 0
    v_exp_f32 v53, v53
    v_mfma_f32_16x16x32_bf16 v[64:67], a[216:219], a[124:127], v[64:67]
    v_cvt_pk_bf16_f32 v108, v108, v109
    v_cvt_pk_bf16_f32 v116, v116, v117
    v_cvt_pk_bf16_f32 v117, v118, v119
    v_mfma_f32_16x16x32_bf16 v[64:67], a[212:215], a[120:123], v[64:67]
    v_cvt_pk_bf16_f32 v104, v104, v105
    v_cvt_pk_bf16_f32 v35, v82, v83
    v_mfma_f32_16x16x32_bf16 v[72:75], a[212:215], a[144:147], 0
    v_cvt_pk_bf16_f32 v208, v208, v209
    v_fma_f32 v63, v63, s28, v10
    v_cvt_pk_bf16_f32 v172, v172, v173
    v_cvt_pk_bf16_f32 v224, v224, v225
    v_mfma_f32_16x16x32_bf16 v[72:75], a[216:219], a[148:151], v[72:75]
    v_fma_f32 v52, v52, s28, v9
    v_cvt_pk_bf16_f32 v164, v164, v165
    v_mfma_f32_16x16x32_bf16 v[72:75], a[220:223], a[152:155], v[72:75]
    v_cvt_pk_bf16_f32 v105, v106, v107
    v_fma_f32 v61, v61, s28, v10
    v_mfma_f32_16x16x32_bf16 v[80:83], a[220:223], a[176:179], 0
    v_accvgpr_read_b32 v107, a11
    v_cvt_pk_bf16_f32 v212, v212, v213
    v_mfma_f32_16x16x32_bf16 v[80:83], a[216:219], a[172:175], v[80:83]
    s_waitcnt vmcnt(6) lgkmcnt(0)
    v_cvt_pk_bf16_f32 v160, v160, v161
    v_cvt_pk_bf16_f32 v161, v162, v163
    v_cvt_pk_bf16_f32 v180, v180, v181
    v_mfma_f32_16x16x32_bf16 v[80:83], a[212:215], a[168:171], v[80:83]
    s_barrier
    v_mfma_f32_16x16x32_bf16 v[80:83], a[224:227], a[180:183], v[80:83]
    ds_read_b64_tr_b16 a[212:213], v2 offset:0
    v_cvt_pk_bf16_f32 v112, v112, v113
    v_mfma_f32_16x16x32_bf16 v[80:83], a[228:231], a[184:187], v[80:83]
    v_cvt_pk_bf16_f32 v120, v120, v121
    v_cvt_pk_bf16_f32 v209, v210, v211
    v_cvt_pk_bf16_f32 v136, v136, v137
    v_mfma_f32_16x16x32_bf16 v[80:83], a[232:235], a[188:191], v[80:83]
    v_cvt_pk_bf16_f32 v176, v176, v177
    v_exp_f32 v52, v52
    v_mfma_f32_16x16x32_bf16 v[72:75], a[232:235], a[164:167], v[72:75]
    v_cvt_pk_bf16_f32 v216, v216, v217
    v_cvt_pk_bf16_f32 v113, v114, v115
    v_mfma_f32_16x16x32_bf16 v[72:75], a[228:231], a[160:163], v[72:75]
    ds_read_b64_tr_b16 a[214:215], v2 offset:6144
    v_exp_f32 v55, v55
    v_mfma_f32_16x16x32_bf16 v[72:75], a[224:227], a[156:159], v[72:75]
    s_add_u32 m0, s22, 12288
    v_cvt_pk_bf16_f32 v144, v144, v145
    v_fma_f32 v69, v69, s28, v11
    v_mfma_f32_16x16x32_bf16 v[64:67], a[224:227], a[132:135], v[64:67]
    ds_write2st64_b64 v101, v[112:113], v[160:161] offset0:0 offset1:12
    v_mfma_f32_16x16x32_bf16 v[64:67], a[228:231], a[136:139], v[64:67]
    ds_read_b64_tr_b16 a[216:217], v3 offset:0
    v_cvt_pk_bf16_f32 v109, v110, v111
    v_fma_f32 v73, v73, s28, v11
    v_mfma_f32_16x16x32_bf16 v[64:67], a[232:235], a[140:143], v[64:67]
    ds_read_b64_tr_b16 a[218:219], v3 offset:6144
    v_accvgpr_read_b32 v106, a10
    v_mfma_f32_16x16x32_bf16 v[56:59], a[232:235], a[116:119], v[56:59]
    ds_write2st64_b64 v101, v[208:209], v[104:105] offset0:24 offset1:36
    v_subrev_u32 v103, 24576, v103
    v_pk_mul_f32 v[232:233], v[232:233], v[50:51] op_sel_hi:[1,0]
    v_pk_mul_f32 v[194:195], v[194:195], v[102:103] op_sel_hi:[1,0]
    v_pk_mul_f32 v[244:245], v[244:245], v[50:51] op_sel_hi:[1,0]
    v_accvgpr_read_b32 v104, a8
    v_pk_mul_f32 v[146:147], v[146:147], v[48:49] op_sel_hi:[1,0]
    v_pk_mul_f32 v[226:227], v[226:227], v[50:51] op_sel_hi:[1,0]
    v_pk_mul_f32 v[236:237], v[236:237], v[50:51] op_sel_hi:[1,0]
    v_pk_mul_f32 v[218:219], v[218:219], v[50:51] op_sel_hi:[1,0]
    v_pk_mul_f32 v[130:131], v[130:131], v[48:49] op_sel_hi:[1,0]
    v_pk_mul_f32 v[138:139], v[138:139], v[48:49] op_sel_hi:[1,0]
    v_pk_mul_f32 v[184:185], v[184:185], v[102:103] op_sel_hi:[1,0]
    v_cvt_pk_bf16_f32 v213, v214, v215
    v_pk_mul_f32 v[234:235], v[234:235], v[50:51] op_sel_hi:[1,0]
    v_pk_mul_f32 v[170:171], v[170:171], v[102:103] op_sel_hi:[1,0]
    v_pk_mul_f32 v[148:149], v[148:149], v[48:49] op_sel_hi:[1,0]
    v_cvt_pk_bf16_f32 v165, v166, v167
    v_pk_mul_f32 v[204:205], v[204:205], v[102:103] op_sel_hi:[1,0]
    v_accvgpr_read_b32 v105, a9
    v_pk_mul_f32 v[240:241], v[240:241], v[50:51] op_sel_hi:[1,0]
    v_xor_b32 v101, 32, v101
    v_pk_mul_f32 v[168:169], v[168:169], v[102:103] op_sel_hi:[1,0]
    v_pk_mul_f32 v[196:197], v[196:197], v[102:103] op_sel_hi:[1,0]
    v_pk_mul_f32 v[106:107], v[106:107], v[8:9] op_sel_hi:[1,0]
    v_pk_mul_f32 v[140:141], v[140:141], v[48:49] op_sel_hi:[1,0]
    v_cvt_pk_bf16_f32 v232, v232, v233
    v_cvt_pk_bf16_f32 v244, v244, v245
    v_accvgpr_read_b32 v111, a15
    v_cvt_pk_bf16_f32 v184, v184, v185
    v_pk_mul_f32 v[222:223], v[222:223], v[50:51] op_sel_hi:[1,0]
    v_pk_mul_f32 v[132:133], v[132:133], v[48:49] op_sel_hi:[1,0]
    v_pk_mul_f32 v[178:179], v[178:179], v[102:103] op_sel_hi:[1,0]
    v_pk_mul_f32 v[200:201], v[200:201], v[102:103] op_sel_hi:[1,0]
    v_cvt_pk_bf16_f32 v225, v226, v227
    v_pk_mul_f32 v[228:229], v[228:229], v[50:51] op_sel_hi:[1,0]
    v_exp_f32 v76, v76
    v_pk_mul_f32 v[104:105], v[104:105], v[8:9] op_sel_hi:[1,0]
    v_cvt_pk_bf16_f32 v217, v218, v219
    v_fma_f32 v77, v77, s28, v12
    v_fma_f32 v82, v82, s28, v12
    v_cvt_pk_bf16_f32 v132, v132, v133
    v_cvt_pk_bf16_f32 v104, v104, v105
    v_cvt_pk_bf16_f32 v168, v168, v169
    v_mfma_f32_16x16x32_bf16 v[56:59], a[228:231], a[112:115], v[56:59]
    ds_write2st64_b64 v101, v[116:117], v[164:165] offset0:0 offset1:12
    v_cvt_pk_bf16_f32 v192, v192, v193
    v_mfma_f32_16x16x32_bf16 v[56:59], a[224:227], a[108:111], v[56:59]
    buffer_load_dwordx4 v6, s[4:7], s20 offen lds
    v_mfma_f32_16x16x32_bf16 v[44:47], a[236:239], v[14:17], 0
    s_waitcnt lgkmcnt(1)
    ds_write2st64_b64 v101, v[212:213], v[108:109] offset0:24 offset1:36
    v_mfma_f32_16x16x32_bf16 v[112:115], a[212:215], v[14:17], 0
    ds_read_b64_tr_b16 a[220:221], v4 offset:0
    v_exp_f32 v61, v61
    v_mfma_f32_16x16x32_bf16 v[160:163], a[212:215], v[20:23], 0
    ds_read_b64_tr_b16 a[222:223], v4 offset:6144
    v_accvgpr_read_b32 v109, a13
    v_mfma_f32_16x16x32_bf16 v[208:211], a[212:215], v[26:29], 0
    ds_read_b64_tr_b16 a[224:225], v5 offset:0
    v_cvt_pk_bf16_f32 v128, v128, v129
    v_fma_f32 v57, v57, s28, v9
    v_cvt_pk_bf16_f32 v196, v196, v197
    v_mfma_f32_16x16x32_bf16 a[0:3], a[212:215], v[32:35], 0
    ds_read_b64_tr_b16 a[230:231], v2 offset:7168
    v_accvgpr_read_b32 v108, a12
    v_fma_f32 v56, v56, s28, v9
    v_cvt_pk_bf16_f32 v140, v140, v141
    v_cvt_pk_bf16_f32 v228, v228, v229
    v_mfma_f32_16x16x32_bf16 a[4:7], a[216:219], v[32:35], 0
    ds_read_b64_tr_b16 a[226:227], v5 offset:6144
    v_fma_f32 v65, v65, s28, v10
    v_cvt_pk_bf16_f32 v220, v220, v221
    v_xor_b32 v101, 96, v101
    v_cvt_pk_bf16_f32 v236, v236, v237
    v_exp_f32 v68, v68
    v_mfma_f32_16x16x32_bf16 v[212:215], a[216:219], v[26:29], 0
    ds_read_b64_tr_b16 a[232:233], v3 offset:1024
    v_cvt_pk_bf16_f32 v105, v106, v107
    v_cvt_pk_bf16_f32 v124, v124, v125
    v_cvt_pk_bf16_f32 v129, v130, v131
    v_fma_f32 v72, v72, s28, v11
    v_pk_mul_f32 v[190:191], v[190:191], v[102:103] op_sel_hi:[1,0]
    v_cvt_pk_bf16_f32 v137, v138, v139
    v_accvgpr_read_b32 v110, a14
    v_pk_mul_f32 v[122:123], v[122:123], v[48:49] op_sel_hi:[1,0]
    v_pk_mul_f32 v[156:157], v[156:157], v[48:49] op_sel_hi:[1,0]
    v_pk_mul_f32 v[248:249], v[248:249], v[50:51] op_sel_hi:[1,0]
    v_accvgpr_read_b32 v106, a18
    v_pk_mul_f32 v[252:253], v[252:253], v[50:51] op_sel_hi:[1,0]
    v_pk_mul_f32 v[186:187], v[186:187], v[102:103] op_sel_hi:[1,0]
    v_cvt_pk_bf16_f32 v240, v240, v241
    v_cvt_pk_bf16_f32 v177, v178, v179
    v_pk_mul_f32 v[174:175], v[174:175], v[102:103] op_sel_hi:[1,0]
    v_exp_f32 v72, v72
    v_pk_mul_f32 v[108:109], v[108:109], v[8:9] op_sel_hi:[1,0]
    v_exp_f32 v77, v77
    v_cvt_pk_bf16_f32 v121, v122, v123
    v_mfma_f32_16x16x32_bf16 v[164:167], a[216:219], v[20:23], 0
    ds_read_b64_tr_b16 a[228:229], v2 offset:1024
    v_cvt_pk_bf16_f32 v237, v238, v239
    v_cvt_pk_bf16_f32 v125, v126, v127
    v_mfma_f32_16x16x32_bf16 v[116:119], a[216:219], v[14:17], 0
    ds_read_b64_tr_b16 a[214:215], v4 offset:7168
    v_cvt_pk_bf16_f32 v108, v108, v109
    v_fma_f32 v74, v74, s28, v11
    v_cvt_pk_bf16_f32 v173, v174, v175
    v_exp_f32 v73, v73
    v_pk_mul_f32 v[142:143], v[142:143], v[48:49] op_sel_hi:[1,0]
    v_pk_mul_f32 v[110:111], v[110:111], v[8:9] op_sel_hi:[1,0]
    v_pk_mul_f32 v[230:231], v[230:231], v[50:51] op_sel_hi:[1,0]
    v_pk_mul_f32 v[158:159], v[158:159], v[48:49] op_sel_hi:[1,0]
    v_cvt_pk_bf16_f32 v169, v170, v171
    v_pk_mul_f32 v[206:207], v[206:207], v[102:103] op_sel_hi:[1,0]
    v_cvt_pk_bf16_f32 v109, v110, v111
    v_cvt_pk_bf16_f32 v221, v222, v223
    v_mfma_f32_16x16x32_bf16 v[44:47], a[240:243], v[20:23], v[44:47]
    s_add_u32 s20, s20, 128
    ds_read_b64_tr_b16 a[218:219], v5 offset:7168
    v_cvt_pk_bf16_f32 v204, v204, v205
    v_mfma_f32_16x16x32_bf16 v[44:47], a[244:247], v[26:29], v[44:47]
    s_waitcnt lgkmcnt(3)
    ds_write2st64_b64 v101, v[120:121], v[168:169] offset0:0 offset1:12
    v_mfma_f32_16x16x32_bf16 v[120:123], a[220:223], v[14:17], 0
    ds_write2st64_b64 v101, v[216:217], v[104:105] offset0:24 offset1:36
    v_xor_b32 v101, 32, v101
    v_mfma_f32_16x16x32_bf16 v[168:171], a[220:223], v[20:23], 0
    ds_write2st64_b64 v101, v[124:125], v[172:173] offset0:0 offset1:12
    v_mfma_f32_16x16x32_bf16 v[216:219], a[220:223], v[26:29], 0
    s_add_u32 m0, s22, 13312
    ds_write2st64_b64 v101, v[220:221], v[108:109] offset0:24 offset1:36
    v_accvgpr_read_b32 v107, a19
    v_accvgpr_read_b32 v111, a23
    v_cvt_pk_bf16_f32 v156, v156, v157
    v_xor_b32 v101, 96, v101
    v_pk_mul_f32 v[242:243], v[242:243], v[50:51] op_sel_hi:[1,0]
    v_fma_f32 v54, v54, s28, v9
    v_pk_mul_f32 v[154:155], v[154:155], v[48:49] op_sel_hi:[1,0]
    v_accvgpr_read_b32 v105, a17
    v_pk_mul_f32 v[106:107], v[106:107], v[8:9] op_sel_hi:[1,0]
    v_exp_f32 v78, v78
    v_accvgpr_read_b32 v109, a21
    v_mfma_f32_16x16x32_bf16 a[8:11], a[220:223], v[32:35], 0
    ds_read_b64_tr_b16 a[212:213], v4 offset:1024
    v_accvgpr_read_b32 v104, a16
    v_fma_f32 v67, v67, s28, v10
    v_mfma_f32_16x16x32_bf16 a[12:15], a[224:227], v[32:35], 0
    ds_read_b64_tr_b16 a[234:235], v3 offset:7168
    v_accvgpr_read_b32 v108, a20
    v_exp_f32 v54, v54
    v_mfma_f32_16x16x32_bf16 v[220:223], a[224:227], v[26:29], 0
    ds_write2st64_b64 v101, v[128:129], v[176:177] offset0:4 offset1:16
    v_accvgpr_read_b32 v110, a22
    v_pk_mul_f32 v[182:183], v[182:183], v[102:103] op_sel_hi:[1,0]
    v_pk_mul_f32 v[108:109], v[108:109], v[8:9] op_sel_hi:[1,0]
    v_pk_mul_f32 v[110:111], v[110:111], v[8:9] op_sel_hi:[1,0]
    v_pk_mul_f32 v[198:199], v[198:199], v[102:103] op_sel_hi:[1,0]
    v_pk_mul_f32 v[134:135], v[134:135], v[48:49] op_sel_hi:[1,0]
    v_pk_mul_f32 v[104:105], v[104:105], v[8:9] op_sel_hi:[1,0]
    v_fma_f32 v83, v83, s28, v12
    v_fma_f32 v70, v70, s28, v11
    v_cvt_pk_bf16_f32 v205, v206, v207
    v_cvt_pk_bf16_f32 v19, v54, v55
    v_exp_f32 v69, v69
    v_mov_b32 v39, v7
    v_cvt_pk_bf16_f32 v241, v242, v243
    v_cvt_pk_bf16_f32 v229, v230, v231
    v_cvt_pk_bf16_f32 v108, v108, v109
    v_cvt_pk_bf16_f32 v141, v142, v143
    v_cvt_pk_bf16_f32 v109, v110, v111
    v_cvt_pk_bf16_f32 v188, v188, v189
    v_cvt_pk_bf16_f32 v104, v104, v105
    v_pk_mul_f32 v[152:153], v[152:153], v[48:49] op_sel_hi:[1,0]
    v_accvgpr_read_b32 v111, a31
    v_cvt_pk_bf16_f32 v36, v76, v77
    v_mfma_f32_16x16x32_bf16 v[172:175], a[224:227], v[20:23], 0
    buffer_load_dwordx4 v6, s[4:7], s20 offen lds
    ds_read_b128 v[96:99], v103 offset:1024
    v_mfma_f32_16x16x32_bf16 v[124:127], a[224:227], v[14:17], 0
    ds_read_b128 v[88:91], v103 offset:0
    v_cvt_pk_bf16_f32 v185, v186, v187
    v_cvt_pk_bf16_f32 v105, v106, v107
    v_mfma_f32_16x16x32_bf16 v[44:47], a[248:251], v[32:35], v[44:47]
    s_waitcnt lgkmcnt(2)
    ds_write2st64_b64 v101, v[224:225], v[104:105] offset0:28 offset1:40
    v_cvt_pk_bf16_f32 v148, v148, v149
    v_mfma_f32_16x16x32_bf16 v[128:131], a[228:231], v[14:17], 0
    s_add_u32 s20, s20, 128
    ds_read_b64_tr_b16 a[216:217], v5 offset:1024
    v_cvt_pk_bf16_f32 v197, v198, v199
    v_cvt_pk_bf16_f32 v181, v182, v183
    v_cvt_pk_bf16_f32 v233, v234, v235
    v_accvgpr_read_b32 v105, a25
    v_cvt_pk_bf16_f32 v133, v134, v135
    v_xor_b32 v101, 32, v101
    v_mfma_f32_16x16x32_bf16 v[176:179], a[228:231], v[20:23], 0
    ds_write2st64_b64 v101, v[132:133], v[180:181] offset0:4 offset1:16
    v_cvt_pk_bf16_f32 v152, v152, v153
    v_mfma_f32_16x16x32_bf16 v[224:227], a[228:231], v[26:29], 0
    s_add_u32 m0, s22, 14336
    ds_read_b64_tr_b16 a[220:221], v2 offset:2048
    v_accvgpr_read_b32 v104, a24
    v_exp_f32 v82, v82
    v_mfma_f32_16x16x32_bf16 a[16:19], a[228:231], v[32:35], 0
    ds_write2st64_b64 v101, v[228:229], v[108:109] offset0:28 offset1:40
    v_accvgpr_read_b32 v106, a26
    v_accvgpr_read_b32 v109, a29
    v_pk_mul_f32 v[246:247], v[246:247], v[50:51] op_sel_hi:[1,0]
    v_accvgpr_read_b32 v108, a28
    v_cvt_pk_bf16_f32 v252, v252, v253
    v_accvgpr_read_b32 v110, a30
    v_fma_f32 v59, v59, s28, v9
    v_pk_mul_f32 v[104:105], v[104:105], v[8:9] op_sel_hi:[1,0]
    v_pk_mul_f32 v[108:109], v[108:109], v[8:9] op_sel_hi:[1,0]
    v_cvt_pk_bf16_f32 v245, v246, v247
    v_pk_mul_f32 v[110:111], v[110:111], v[8:9] op_sel_hi:[1,0]
    v_cvt_pk_bf16_f32 v153, v154, v155
    v_xor_b32 v101, 96, v101
    v_cvt_pk_bf16_f32 v145, v146, v147
    v_cvt_pk_bf16_f32 v104, v104, v105
    v_cvt_pk_bf16_f32 v200, v200, v201
    v_mfma_f32_16x16x32_bf16 a[20:23], a[232:235], v[32:35], 0
    ds_read_b64_tr_b16 a[224:225], v3 offset:2048
    ds_read_b64_tr_b16 a[222:223], v2 offset:8192
    v_mfma_f32_16x16x32_bf16 v[228:231], a[232:235], v[26:29], 0
    buffer_load_dwordx4 v6, s[4:7], s20 offen lds
    ds_read_b64_tr_b16 a[226:227], v3 offset:8192
    v_accvgpr_read_b32 v107, a27
    v_mfma_f32_16x16x32_bf16 v[180:183], a[232:235], v[20:23], 0
    ds_write2st64_b64 v101, v[136:137], v[184:185] offset0:4 offset1:16
    v_pk_mul_f32 v[106:107], v[106:107], v[8:9] op_sel_hi:[1,0]
    v_cvt_pk_bf16_f32 v108, v108, v109
    v_exp_f32 v71, v71
    v_cvt_pk_bf16_f32 v105, v106, v107
    v_mfma_f32_16x16x32_bf16 v[132:135], a[232:235], v[14:17], 0
    s_add_u32 s20, s20, 12032
    ds_write2st64_b64 v101, v[232:233], v[104:105] offset0:28 offset1:40
    v_accvgpr_read_b32 v104, a32
    v_pk_mul_f32 v[150:151], v[150:151], v[48:49] op_sel_hi:[1,0]
    v_xor_b32 v101, 32, v101
    v_accvgpr_read_b32 v105, a33
    v_pk_mul_f32 v[104:105], v[104:105], v[8:9] op_sel_hi:[1,0]
    v_accvgpr_read_b32 v107, a35
    v_cvt_pk_bf16_f32 v104, v104, v105
    v_cvt_pk_bf16_f32 v189, v190, v191
    v_mfma_f32_16x16x32_bf16 v[136:139], a[212:215], v[14:17], 0
    s_add_u32 m0, s38, 0
    ds_write2st64_b64 v101, v[140:141], v[188:189] offset0:4 offset1:16
    v_mfma_f32_16x16x32_bf16 v[184:187], a[212:215], v[20:23], 0
    s_waitcnt lgkmcnt(4)
    ds_read_b64_tr_b16 a[230:231], v4 offset:8192
    buffer_load_dwordx4 v6, s[12:15], s33 offen nt lds
    v_mfma_f32_16x16x32_bf16 v[232:235], a[212:215], v[26:29], 0
    s_add_u32 m0, s38, 1024
    ds_read_b64_tr_b16 a[228:229], v4 offset:2048
    v_cvt_pk_bf16_f32 v109, v110, v111
    v_accvgpr_read_b32 v106, a34
    v_fma_f32 v66, v66, s28, v10
    v_mfma_f32_16x16x32_bf16 a[24:27], a[212:215], v[32:35], 0
    ds_read_b64_tr_b16 a[232:233], v5 offset:2048
    buffer_load_dwordx4 v7, s[12:15], s33 offen nt lds
    ds_read_b64_tr_b16 a[234:235], v5 offset:8192
    v_mfma_f32_16x16x32_bf16 a[28:31], a[216:219], v[32:35], 0
    ds_write2st64_b64 v101, v[236:237], v[108:109] offset0:28 offset1:40
    v_exp_f32 v65, v65
    v_mov_b32 v38, v6
    v_cvt_pk_bf16_f32 v193, v194, v195
    v_pk_mul_f32 v[106:107], v[106:107], v[8:9] op_sel_hi:[1,0]
    v_xor_b32 v101, 96, v101
    v_cvt_pk_bf16_f32 v157, v158, v159
    v_accvgpr_read_b32 v108, a36
    v_accvgpr_read_b32 v111, a39
    v_cvt_pk_bf16_f32 v105, v106, v107
    v_exp_f32 v79, v79
    v_mfma_f32_16x16x32_bf16 v[236:239], a[216:219], v[26:29], 0
    buffer_store_dwordx4 v[88:91], v6, s[16:19], s67 offen offset:0 nt
    s_add_u32 s39, s39, 12288
    ds_write2st64_b64 v101, v[144:145], v[192:193] offset0:8 offset1:20
    v_mfma_f32_16x16x32_bf16 v[188:191], a[216:219], v[20:23], 0
    ds_write2st64_b64 v101, v[240:241], v[104:105] offset0:32 offset1:44
    v_exp_f32 v60, v60
    v_accvgpr_read_b32 v109, a37
    v_pk_mul_f32 v[202:203], v[202:203], v[102:103] op_sel_hi:[1,0]
    v_cvt_pk_bf16_f32 v37, v78, v79
    v_pk_mul_f32 v[108:109], v[108:109], v[8:9] op_sel_hi:[1,0]
    v_accvgpr_read_b32 v105, a41
    v_accvgpr_read_b32 v110, a38
    v_fma_f32 v58, v58, s28, v9
    v_mfma_f32_16x16x32_bf16 v[140:143], a[216:219], v[14:17], 0
    s_waitcnt vmcnt(9) lgkmcnt(2)
    v_xor_b32 v101, 32, v101
    v_accvgpr_read_b32 v106, a42
    v_mfma_f32_16x16x32_bf16 v[144:147], a[220:223], v[14:17], 0
    s_barrier
    v_fma_f32 v80, v80, s28, v12
    v_cvt_pk_bf16_f32 v248, v248, v249
    v_cvt_pk_bf16_f32 v149, v150, v151
    v_cvt_pk_bf16_f32 v24, v60, v61
    v_mfma_f32_16x16x32_bf16 v[192:195], a[220:223], v[20:23], 0
    ds_write2st64_b64 v101, v[148:149], v[196:197] offset0:8 offset1:20
    v_pk_mul_f32 v[110:111], v[110:111], v[8:9] op_sel_hi:[1,0]
    v_cvt_pk_bf16_f32 v108, v108, v109
    v_accvgpr_read_b32 v107, a43
    v_mfma_f32_16x16x32_bf16 v[240:243], a[220:223], v[26:29], 0
    v_cvt_pk_bf16_f32 v109, v110, v111
    v_accvgpr_read_b32 v104, a40
    v_fma_f32 v64, v64, s28, v10
    v_mfma_f32_16x16x32_bf16 a[32:35], a[220:223], v[32:35], 0
    ds_write2st64_b64 v101, v[244:245], v[108:109] offset0:32 offset1:44
    v_pk_mul_f32 v[106:107], v[106:107], v[8:9] op_sel_hi:[1,0]
    v_cvt_pk_bf16_f32 v201, v202, v203
    v_exp_f32 v63, v63
    v_cvt_pk_bf16_f32 v30, v68, v69
    v_pk_mul_f32 v[250:251], v[250:251], v[50:51] op_sel_hi:[1,0]
    v_pk_mul_f32 v[104:105], v[104:105], v[8:9] op_sel_hi:[1,0]
    v_accvgpr_read_b32 v108, a44
    v_cvt_pk_bf16_f32 v104, v104, v105
    v_mfma_f32_16x16x32_bf16 a[36:39], a[224:227], v[32:35], 0
    ds_read_b128 a[216:219], v1 offset:0
    v_cvt_pk_bf16_f32 v105, v106, v107
    v_cvt_pk_bf16_f32 v249, v250, v251
    v_mfma_f32_16x16x32_bf16 v[244:247], a[224:227], v[26:29], 0
    ds_read_b128 a[212:215], v0 offset:0
    v_xor_b32 v101, 96, v101
    v_mfma_f32_16x16x32_bf16 v[196:199], a[224:227], v[20:23], 0
    ds_write2st64_b64 v101, v[152:153], v[200:201] offset0:8 offset1:20
    v_mfma_f32_16x16x32_bf16 v[148:151], a[224:227], v[14:17], 0
    s_add_u32 m0, s22, 24576
    v_cvt_pk_bf16_f32 v18, v52, v53
    v_accvgpr_read_b32 v109, a45
    v_accvgpr_read_b32 v111, a47
    v_mfma_f32_16x16x32_bf16 v[152:155], a[228:231], v[14:17], 0
    ds_write2st64_b64 v101, v[248:249], v[104:105] offset0:32 offset1:44
    v_pk_mul_f32 v[254:255], v[254:255], v[50:51] op_sel_hi:[1,0]
    v_pk_mul_f32 v[108:109], v[108:109], v[8:9] op_sel_hi:[1,0]
    v_accvgpr_read_b32 v110, a46
    v_pk_mul_f32 v[110:111], v[110:111], v[8:9] op_sel_hi:[1,0]
    v_cvt_pk_bf16_f32 v108, v108, v109
    v_xor_b32 v101, 32, v101
    v_mfma_f32_16x16x32_bf16 v[200:203], a[228:231], v[20:23], 0
    ds_read_b128 a[220:223], v0 offset:1024
    v_cvt_pk_bf16_f32 v109, v110, v111
    v_mfma_f32_16x16x32_bf16 v[248:251], a[228:231], v[26:29], 0
    buffer_store_dwordx4 v[96:99], v7, s[16:19], s67 offen offset:0 nt
    ds_write2st64_b64 v101, v[156:157], v[204:205] offset0:8 offset1:20
    v_mfma_f32_16x16x32_bf16 a[40:43], a[228:231], v[32:35], 0
    ds_read_b128 a[224:227], v1 offset:1024
    v_cvt_pk_bf16_f32 v253, v254, v255
    v_mfma_f32_16x16x32_bf16 a[44:47], a[232:235], v[32:35], 0
    ds_write2st64_b64 v101, v[252:253], v[108:109] offset0:32 offset1:44
    v_mfma_f32_16x16x32_bf16 v[252:255], a[232:235], v[26:29], 0
    buffer_load_dwordx4 v6, s[8:11], s21 offen lds
    v_mfma_f32_16x16x32_bf16 v[204:207], a[232:235], v[20:23], 0
    v_exp_f32 v58, v58
    v_mfma_f32_16x16x32_bf16 v[156:159], a[232:235], v[14:17], 0
    s_waitcnt lgkmcnt(4)
    v_exp_f32 v70, v70
    v_mfma_f32_16x16x32_bf16 v[52:55], a[212:215], a[96:99], 0
    ds_read_b128 a[232:235], v1 offset:2048
    v_cvt_pk_bf16_f32 v25, v62, v63
    v_mfma_f32_16x16x32_bf16 v[52:55], a[216:219], a[100:103], v[52:55]
    s_waitcnt lgkmcnt(4)
    ds_read_b128 a[228:231], v0 offset:2048
    v_cvt_pk_bf16_f32 v31, v70, v71
    v_mfma_f32_16x16x32_bf16 v[52:55], a[220:223], a[104:107], v[52:55]
    v_exp_f32 v80, v80
    v_mfma_f32_16x16x32_bf16 v[60:63], a[220:223], a[128:131], 0
    v_exp_f32 v59, v59
    v_mfma_f32_16x16x32_bf16 v[60:63], a[216:219], a[124:127], v[60:63]
    s_add_u32 s21, s21, 128
    v_exp_f32 v56, v56
    v_mfma_f32_16x16x32_bf16 v[60:63], a[212:215], a[120:123], v[60:63]
    v_exp_f32 v64, v64
    v_mfma_f32_16x16x32_bf16 v[68:71], a[212:215], a[144:147], 0
    v_exp_f32 v66, v66
    v_mfma_f32_16x16x32_bf16 v[68:71], a[216:219], a[148:151], v[68:71]
    ds_read_b128 v[84:87], v103 offset:2048
    v_fma_f32 v81, v81, s28, v12
    v_mfma_f32_16x16x32_bf16 v[68:71], a[220:223], a[152:155], v[68:71]
    v_exp_f32 v57, v57
    v_mfma_f32_16x16x32_bf16 v[76:79], a[220:223], a[176:179], 0
    v_cvt_pk_bf16_f32 v16, v56, v57
    v_cvt_pk_bf16_f32 v17, v58, v59
    v_mfma_f32_16x16x32_bf16 v[76:79], a[216:219], a[172:175], v[76:79]
    ds_read_b128 a[216:219], v1 offset:6144
    v_cvt_pk_bf16_f32 v22, v64, v65
    v_mfma_f32_16x16x32_bf16 v[48:51], a[236:239], v[16:19], v[44:47]
    ds_read_b128 v[88:91], v103 offset:3072
    s_add_u32 m0, s22, 25600
    v_mfma_f32_16x16x32_bf16 v[76:79], a[212:215], a[168:171], v[76:79]
    s_waitcnt lgkmcnt(3)
    ds_read_b128 a[212:215], v0 offset:6144
    buffer_load_dwordx4 v6, s[8:11], s21 offen lds
    v_mfma_f32_16x16x32_bf16 v[76:79], a[224:227], a[180:183], v[76:79]
    s_add_u32 s21, s21, 128
    v_exp_f32 v81, v81
    v_mfma_f32_16x16x32_bf16 v[76:79], a[228:231], a[184:187], v[76:79]
    s_add_u32 m0, s22, 26624
    v_exp_f32 v83, v83
    v_mfma_f32_16x16x32_bf16 v[76:79], a[232:235], a[188:191], v[76:79]
    v_exp_f32 v67, v67
    v_mfma_f32_16x16x32_bf16 v[68:71], a[232:235], a[164:167], v[68:71]
    buffer_load_dwordx4 v6, s[8:11], s21 offen lds
    v_mfma_f32_16x16x32_bf16 v[68:71], a[228:231], a[160:163], v[68:71]
    s_add_u32 s21, s21, 12032
    v_fma_f32 v75, v75, s28, v11
    v_mfma_f32_16x16x32_bf16 v[68:71], a[224:227], a[156:159], v[68:71]
    v_cvt_pk_bf16_f32 v23, v66, v67
    s_add_u32 s56, s67, 128
    v_mfma_f32_16x16x32_bf16 v[60:63], a[224:227], a[132:135], v[60:63]
    s_add_u32 s58, s33, 128
    v_exp_f32 v74, v74
    v_mfma_f32_16x16x32_bf16 v[60:63], a[228:231], a[136:139], v[60:63]
    v_exp_f32 v75, v75
    v_mfma_f32_16x16x32_bf16 v[48:51], a[240:243], v[22:25], v[48:51]
    s_add_u32 m0, s38, 2048
    ds_read_b128 v[96:99], v103 offset:4096
    v_cvt_pk_bf16_f32 v35, v82, v83
    v_mfma_f32_16x16x32_bf16 v[60:63], a[232:235], a[140:143], v[60:63]
    s_waitcnt lgkmcnt(1)
    ds_read_b128 a[220:223], v0 offset:7168
    buffer_load_dwordx4 v6, s[12:15], s58 offen nt lds
    v_mfma_f32_16x16x32_bf16 v[52:55], a[232:235], a[116:119], v[52:55]
    buffer_store_dwordx4 v[84:87], v6, s[16:19], s56 offen offset:0 nt
    s_add_u32 m0, s38, 3072
    v_cvt_pk_bf16_f32 v34, v80, v81
    v_cvt_pk_bf16_f32 v29, v74, v75
    v_cvt_pk_bf16_f32 v28, v72, v73
    v_mfma_f32_16x16x32_bf16 v[52:55], a[228:231], a[112:115], v[52:55]
    ds_read_b128 a[232:235], v1 offset:8192
    v_mfma_f32_16x16x32_bf16 v[52:55], a[224:227], a[108:111], v[52:55]
    buffer_load_dwordx4 v7, s[12:15], s58 offen nt lds
    v_mfma_f32_16x16x32_bf16 v[48:51], a[244:247], v[28:31], v[48:51]
    s_add_u32 s57, s67, 256
    ds_read_b128 v[84:87], v103 offset:5120
    v_mfma_f32_16x16x32_bf16 v[48:51], a[248:251], v[34:37], v[48:51]
    buffer_store_dwordx4 v[88:91], v7, s[16:19], s56 offen offset:0 nt
    s_add_u32 s59, s33, 256
    ds_read_b128 a[224:227], v1 offset:7168
    v_mfma_f32_16x16x32_bf16 v[56:59], a[212:215], a[96:99], 0
    ds_read_b128 a[228:231], v0 offset:8192
    v_add_u32 v103, 6144, v103
    v_mfma_f32_16x16x32_bf16 v[56:59], a[216:219], a[100:103], v[56:59]
    s_add_u32 m0, s38, 4096
    v_cmp_lt_f32 vcc, s29, v48
    s_waitcnt lgkmcnt(4)
    v_mfma_f32_16x16x32_bf16 v[56:59], a[220:223], a[104:107], v[56:59]
    buffer_load_dwordx4 v6, s[12:15], s59 offen nt lds
    v_mfma_f32_16x16x32_bf16 v[64:67], a[220:223], a[128:131], 0
    s_add_u32 m0, s38, 5120
    s_cbranch_vccnz L_rs_tr44d
L_ret_tr44d:
    v_mfma_f32_16x16x32_bf16 v[64:67], a[216:219], a[124:127], v[64:67]
    v_fma_f32 v52, v52, s28, v9
    v_fma_f32 v55, v55, s28, v9
    v_mfma_f32_16x16x32_bf16 v[64:67], a[212:215], a[120:123], v[64:67]
    v_fma_f32 v53, v53, s28, v9
    v_fma_f32 v54, v54, s28, v9
    v_mfma_f32_16x16x32_bf16 v[72:75], a[212:215], a[144:147], 0
    v_exp_f32 v55, v55
    v_mfma_f32_16x16x32_bf16 v[72:75], a[216:219], a[148:151], v[72:75]
    v_exp_f32 v54, v54
    v_mfma_f32_16x16x32_bf16 v[72:75], a[220:223], a[152:155], v[72:75]
    s_waitcnt lgkmcnt(2)
    buffer_load_dwordx4 v7, s[12:15], s59 offen nt lds
    v_mfma_f32_16x16x32_bf16 v[80:83], a[220:223], a[176:179], 0
    buffer_store_dwordx4 v[96:99], v6, s[16:19], s57 offen offset:0 nt
    s_waitcnt vmcnt(17) lgkmcnt(0)
    s_barrier
    v_mfma_f32_16x16x32_bf16 v[80:83], a[216:219], a[172:175], v[80:83]
    s_add_u32 m0, s22, 0
    v_exp_f32 v53, v53
    v_mfma_f32_16x16x32_bf16 v[80:83], a[212:215], a[168:171], v[80:83]
    buffer_load_dwordx4 v6, s[4:7], s20 offen lds
    v_mfma_f32_16x16x32_bf16 v[80:83], a[224:227], a[180:183], v[80:83]
    v_exp_f32 v52, v52
    v_mfma_f32_16x16x32_bf16 v[80:83], a[228:231], a[184:187], v[80:83]
    s_add_u32 s20, s20, 128
    ds_read_b64_tr_b16 a[212:213], v2 offset:18432
    v_fma_f32 v60, v60, s28, v10
    v_mfma_f32_16x16x32_bf16 v[80:83], a[232:235], a[188:191], v[80:83]
    s_add_u32 m0, s22, 1024
    ds_read_b64_tr_b16 a[214:215], v2 offset:12288
    v_fma_f32 v61, v61, s28, v10
    v_mfma_f32_16x16x32_bf16 v[72:75], a[232:235], a[164:167], v[72:75]
    ds_read_b64_tr_b16 a[216:217], v3 offset:18432
    v_mfma_f32_16x16x32_bf16 v[72:75], a[228:231], a[160:163], v[72:75]
    v_exp_f32 v61, v61
    v_mfma_f32_16x16x32_bf16 v[72:75], a[224:227], a[156:159], v[72:75]
    buffer_load_dwordx4 v6, s[4:7], s20 offen lds
    v_mfma_f32_16x16x32_bf16 v[64:67], a[224:227], a[132:135], v[64:67]
    s_add_u32 s20, s20, 128
    ds_read_b64_tr_b16 a[218:219], v3 offset:12288
    v_mfma_f32_16x16x32_bf16 v[64:67], a[228:231], a[136:139], v[64:67]
    ds_read_b64_tr_b16 a[220:221], v4 offset:18432
    v_cvt_pk_bf16_f32 v14, v52, v53
    v_mfma_f32_16x16x32_bf16 v[64:67], a[232:235], a[140:143], v[64:67]
    buffer_store_dwordx4 v[84:87], v7, s[16:19], s57 offen offset:0 nt
    s_add_u32 m0, s22, 2048
    ds_read_b64_tr_b16 a[222:223], v4 offset:12288
    v_exp_f32 v60, v60
    v_mfma_f32_16x16x32_bf16 v[56:59], a[232:235], a[116:119], v[56:59]
    v_cvt_pk_bf16_f32 v15, v54, v55
    v_cvt_pk_bf16_f32 v20, v60, v61
    v_mfma_f32_16x16x32_bf16 v[56:59], a[228:231], a[112:115], v[56:59]
    buffer_load_dwordx4 v6, s[4:7], s20 offen lds
    v_mfma_f32_16x16x32_bf16 v[56:59], a[224:227], a[108:111], v[56:59]
    s_add_u32 s20, s20, 12032
    ds_read_b64_tr_b16 a[224:225], v5 offset:18432
    ds_read_b64_tr_b16 a[226:227], v5 offset:12288
    s_branch L_loop4
L_end5:
    s_waitcnt lgkmcnt(4)
    v_mfma_f32_16x16x32_bf16 v[112:115], a[212:215], v[16:19], v[112:115]
    ds_read_b64_tr_b16 a[228:229], v2 offset:19456
    v_mfma_f32_16x16x32_bf16 v[116:119], a[216:219], v[16:19], v[116:119]
    v_mfma_f32_16x16x32_bf16 v[164:167], a[216:219], v[22:25], v[164:167]
    ds_read_b64_tr_b16 a[232:233], v3 offset:19456
    v_fma_f32 v75, v75, s28, v11
    v_mfma_f32_16x16x32_bf16 v[160:163], a[212:215], v[22:25], v[160:163]
    v_fma_f32 v83, v83, s28, v12
    v_fma_f32 v68, v68, s28, v11
    v_mfma_f32_16x16x32_bf16 v[208:211], a[212:215], v[28:31], v[208:211]
    v_fma_f32 v82, v82, s28, v12
    v_fma_f32 v90, v90, s28, v13
    v_mfma_f32_16x16x32_bf16 v[212:215], a[216:219], v[28:31], v[212:215]
    ds_read_b64_tr_b16 a[230:231], v2 offset:13312
    v_fma_f32 v65, v65, s28, v10
    v_mfma_f32_16x16x32_bf16 a[4:7], a[216:219], v[34:37], a[4:7]
    v_fma_f32 v57, v57, s28, v9
    v_mfma_f32_16x16x32_bf16 a[0:3], a[212:215], v[34:37], a[0:3]
    ds_read_b64_tr_b16 a[234:235], v3 offset:13312
    v_mfma_f32_16x16x32_bf16 a[48:51], a[212:215], v[40:43], a[48:51]
    v_fma_f32 v77, v77, s28, v12
    v_mfma_f32_16x16x32_bf16 a[52:55], a[216:219], v[40:43], a[52:55]
    s_waitcnt lgkmcnt(4)
    ds_read_b64_tr_b16 a[218:219], v5 offset:13312
    v_fma_f32 v59, v59, s28, v9
    v_mfma_f32_16x16x32_bf16 a[56:59], a[220:223], v[40:43], a[56:59]
    v_fma_f32 v91, v91, s28, v13
    v_fma_f32 v66, v66, s28, v10
    v_mfma_f32_16x16x32_bf16 a[60:63], a[224:227], v[40:43], a[60:63]
    v_fma_f32 v86, v86, s28, v13
    v_fma_f32 v84, v84, s28, v13
    v_mfma_f32_16x16x32_bf16 a[12:15], a[224:227], v[34:37], a[12:15]
    v_exp_f32 v77, v77
    v_mfma_f32_16x16x32_bf16 a[8:11], a[220:223], v[34:37], a[8:11]
    ds_read_b64_tr_b16 a[216:217], v5 offset:19456
    v_fma_f32 v64, v64, s28, v10
    v_mfma_f32_16x16x32_bf16 v[216:219], a[220:223], v[28:31], v[216:219]
    ds_read_b64_tr_b16 a[214:215], v4 offset:13312
    v_fma_f32 v89, v89, s28, v13
    v_mfma_f32_16x16x32_bf16 v[220:223], a[224:227], v[28:31], v[220:223]
    v_fma_f32 v85, v85, s28, v13
    v_fma_f32 v78, v78, s28, v12
    v_mfma_f32_16x16x32_bf16 v[172:175], a[224:227], v[22:25], v[172:175]
    v_fma_f32 v87, v87, s28, v13
    v_fma_f32 v81, v81, s28, v12
    v_mfma_f32_16x16x32_bf16 v[168:171], a[220:223], v[22:25], v[168:171]
    ds_read_b64_tr_b16 a[212:213], v4 offset:19456
    v_fma_f32 v76, v76, s28, v12
    v_mfma_f32_16x16x32_bf16 v[120:123], a[220:223], v[16:19], v[120:123]
    ds_read_b64_tr_b16 a[220:221], v2 offset:20480
    v_fma_f32 v71, v71, s28, v11
    v_mfma_f32_16x16x32_bf16 v[124:127], a[224:227], v[16:19], v[124:127]
    s_waitcnt lgkmcnt(4)
    ds_read_b64_tr_b16 a[226:227], v3 offset:14336
    v_fma_f32 v80, v80, s28, v12
    v_mfma_f32_16x16x32_bf16 v[128:131], a[228:231], v[16:19], v[128:131]
    ds_read_b64_tr_b16 a[224:225], v3 offset:20480
    v_fma_f32 v58, v58, s28, v9
    v_mfma_f32_16x16x32_bf16 v[132:135], a[232:235], v[16:19], v[132:135]
    v_exp_f32 v76, v76
    v_mfma_f32_16x16x32_bf16 v[180:183], a[232:235], v[22:25], v[180:183]
    ds_read_b64_tr_b16 a[222:223], v2 offset:14336
    v_fma_f32 v74, v74, s28, v11
    v_mfma_f32_16x16x32_bf16 v[176:179], a[228:231], v[22:25], v[176:179]
    v_fma_f32 v56, v56, s28, v9
    v_fma_f32 v70, v70, s28, v11
    v_mfma_f32_16x16x32_bf16 v[224:227], a[228:231], v[28:31], v[224:227]
    v_exp_f32 v82, v82
    v_mfma_f32_16x16x32_bf16 v[228:231], a[232:235], v[28:31], v[228:231]
    v_cvt_pk_bf16_f32 v32, v76, v77
    v_mfma_f32_16x16x32_bf16 a[20:23], a[232:235], v[34:37], a[20:23]
    s_add_u32 s39, s39, 12288
    v_exp_f32 v87, v87
    v_mfma_f32_16x16x32_bf16 a[16:19], a[228:231], v[34:37], a[16:19]
    v_exp_f32 v83, v83
    v_mfma_f32_16x16x32_bf16 a[64:67], a[228:231], v[40:43], a[64:67]
    v_fma_f32 v79, v79, s28, v12
    v_fma_f32 v69, v69, s28, v11
    v_mfma_f32_16x16x32_bf16 a[68:71], a[232:235], v[40:43], a[68:71]
    s_waitcnt lgkmcnt(2)
    v_exp_f32 v71, v71
    v_mfma_f32_16x16x32_bf16 a[72:75], a[212:215], v[40:43], a[72:75]
    ds_read_b64_tr_b16 a[230:231], v4 offset:14336
    v_fma_f32 v72, v72, s28, v11
    v_mfma_f32_16x16x32_bf16 a[76:79], a[216:219], v[40:43], a[76:79]
    v_mfma_f32_16x16x32_bf16 a[28:31], a[216:219], v[34:37], a[28:31]
    ds_read_b64_tr_b16 a[232:233], v5 offset:20480
    v_mfma_f32_16x16x32_bf16 a[24:27], a[212:215], v[34:37], a[24:27]
    v_fma_f32 v88, v88, s28, v13
    v_mfma_f32_16x16x32_bf16 v[232:235], a[212:215], v[28:31], v[232:235]
    v_exp_f32 v79, v79
    v_mfma_f32_16x16x32_bf16 v[236:239], a[216:219], v[28:31], v[236:239]
    v_exp_f32 v68, v68
    v_mfma_f32_16x16x32_bf16 v[188:191], a[216:219], v[22:25], v[188:191]
    ds_read_b64_tr_b16 a[234:235], v5 offset:14336
    v_mfma_f32_16x16x32_bf16 v[184:187], a[212:215], v[22:25], v[184:187]
    v_exp_f32 v78, v78
    v_mfma_f32_16x16x32_bf16 v[136:139], a[212:215], v[16:19], v[136:139]
    ds_read_b64_tr_b16 a[228:229], v4 offset:20480
    v_mfma_f32_16x16x32_bf16 v[140:143], a[216:219], v[16:19], v[140:143]
    s_waitcnt lgkmcnt(4)
    v_exp_f32 v56, v56
    v_mfma_f32_16x16x32_bf16 v[144:147], a[220:223], v[16:19], v[144:147]
    v_exp_f32 v70, v70
    v_mfma_f32_16x16x32_bf16 v[148:151], a[224:227], v[16:19], v[148:151]
    v_exp_f32 v86, v86
    v_mfma_f32_16x16x32_bf16 v[196:199], a[224:227], v[22:25], v[196:199]
    v_exp_f32 v91, v91
    v_mfma_f32_16x16x32_bf16 v[192:195], a[220:223], v[22:25], v[192:195]
    v_exp_f32 v85, v85
    v_mfma_f32_16x16x32_bf16 v[240:243], a[220:223], v[28:31], v[240:243]
    v_exp_f32 v84, v84
    v_mfma_f32_16x16x32_bf16 v[244:247], a[224:227], v[28:31], v[244:247]
    v_exp_f32 v90, v90
    v_mfma_f32_16x16x32_bf16 a[36:39], a[224:227], v[34:37], a[36:39]
    v_exp_f32 v88, v88
    v_mfma_f32_16x16x32_bf16 a[32:35], a[220:223], v[34:37], a[32:35]
    v_exp_f32 v59, v59
    v_mfma_f32_16x16x32_bf16 a[80:83], a[220:223], v[40:43], a[80:83]
    s_waitcnt vmcnt(10) lgkmcnt(0)
    v_exp_f32 v57, v57
    v_mfma_f32_16x16x32_bf16 a[84:87], a[224:227], v[40:43], a[84:87]
    s_barrier
    ds_read_b128 a[212:215], v0 offset:12288
    v_mfma_f32_16x16x32_bf16 a[88:91], a[228:231], v[40:43], a[88:91]
    s_add_u32 m0, s22, 36864
    ds_read_b128 a[216:219], v1 offset:12288
    v_mfma_f32_16x16x32_bf16 a[92:95], a[232:235], v[40:43], a[92:95]
    ds_read_b128 a[220:223], v0 offset:13312
    v_mfma_f32_16x16x32_bf16 a[44:47], a[232:235], v[34:37], a[44:47]
    v_exp_f32 v80, v80
    v_mfma_f32_16x16x32_bf16 a[40:43], a[228:231], v[34:37], a[40:43]
    v_exp_f32 v69, v69
    v_mfma_f32_16x16x32_bf16 v[248:251], a[228:231], v[28:31], v[248:251]
    buffer_load_dwordx4 v6, s[8:11], s21 offen lds
    v_mfma_f32_16x16x32_bf16 v[252:255], a[232:235], v[28:31], v[252:255]
    s_add_u32 s21, s21, 128
    v_fma_f32 v67, v67, s28, v10
    s_add_u32 m0, s22, 37888
    v_mfma_f32_16x16x32_bf16 v[204:207], a[232:235], v[22:25], v[204:207]
    buffer_load_dwordx4 v6, s[8:11], s21 offen lds
    v_mfma_f32_16x16x32_bf16 v[200:203], a[228:231], v[22:25], v[200:203]
    s_add_u32 s21, s21, 128
    s_add_u32 m0, s22, 38912
    v_mfma_f32_16x16x32_bf16 v[152:155], a[228:231], v[16:19], v[152:155]
    buffer_load_dwordx4 v6, s[8:11], s21 offen lds
    v_mfma_f32_16x16x32_bf16 v[156:159], a[232:235], v[16:19], v[156:159]
    s_waitcnt lgkmcnt(2)
    v_cvt_pk_bf16_f32 v39, v86, v87
    v_mfma_f32_16x16x32_bf16 v[52:55], a[212:215], a[96:99], 0
    s_waitcnt lgkmcnt(1)
    ds_read_b128 a[224:227], v1 offset:13312
    v_cvt_pk_bf16_f32 v26, v68, v69
    v_mfma_f32_16x16x32_bf16 v[52:55], a[216:219], a[100:103], v[52:55]
    s_waitcnt lgkmcnt(1)
    v_cvt_pk_bf16_f32 v27, v70, v71
    v_mfma_f32_16x16x32_bf16 v[52:55], a[220:223], a[104:107], v[52:55]
    ds_read_b128 a[228:231], v0 offset:14336
    v_mfma_f32_16x16x32_bf16 v[60:63], a[220:223], a[128:131], 0
    v_exp_f32 v89, v89
    v_mfma_f32_16x16x32_bf16 v[60:63], a[216:219], a[124:127], v[60:63]
    v_exp_f32 v75, v75
    v_mfma_f32_16x16x32_bf16 v[60:63], a[212:215], a[120:123], v[60:63]
    ds_read_b128 a[232:235], v1 offset:14336
    v_mfma_f32_16x16x32_bf16 v[68:71], a[212:215], a[144:147], 0
    v_cvt_pk_bf16_f32 v33, v78, v79
    v_mfma_f32_16x16x32_bf16 v[68:71], a[216:219], a[148:151], v[68:71]
    v_cvt_pk_bf16_f32 v38, v84, v85
    v_mfma_f32_16x16x32_bf16 v[68:71], a[220:223], a[152:155], v[68:71]
    v_exp_f32 v58, v58
    v_mfma_f32_16x16x32_bf16 v[76:79], a[220:223], a[176:179], 0
    v_cvt_pk_bf16_f32 v16, v56, v57
    v_mfma_f32_16x16x32_bf16 v[76:79], a[216:219], a[172:175], v[76:79]
    v_exp_f32 v72, v72
    v_mfma_f32_16x16x32_bf16 v[76:79], a[212:215], a[168:171], v[76:79]
    v_exp_f32 v67, v67
    v_mfma_f32_16x16x32_bf16 v[84:87], a[212:215], a[192:195], 0
    v_mfma_f32_16x16x32_bf16 v[84:87], a[216:219], a[196:199], v[84:87]
    v_cvt_pk_bf16_f32 v40, v88, v89
    v_mfma_f32_16x16x32_bf16 v[84:87], a[220:223], a[200:203], v[84:87]
    s_waitcnt lgkmcnt(1)
    v_exp_f32 v74, v74
    v_mfma_f32_16x16x32_bf16 v[84:87], a[224:227], a[204:207], v[84:87]
    v_mfma_f32_16x16x32_bf16 v[84:87], a[228:231], a[208:211], v[84:87]
    s_waitcnt lgkmcnt(0)
    v_mfma_f32_16x16x32_bf16 v[84:87], a[232:235], v[92:95], v[84:87]
    v_exp_f32 v64, v64
    v_mfma_f32_16x16x32_bf16 v[76:79], a[232:235], a[188:191], v[76:79]
    v_exp_f32 v65, v65
    v_mfma_f32_16x16x32_bf16 v[76:79], a[228:231], a[184:187], v[76:79]
    ds_read_b128 a[216:219], v1 offset:18432
    v_cvt_pk_bf16_f32 v17, v58, v59
    v_mfma_f32_16x16x32_bf16 v[76:79], a[224:227], a[180:183], v[76:79]
    v_fma_f32 v73, v73, s28, v11
    v_mfma_f32_16x16x32_bf16 v[44:47], a[236:239], v[14:17], v[48:51]
    v_exp_f32 v81, v81
    v_mfma_f32_16x16x32_bf16 v[68:71], a[224:227], a[156:159], v[68:71]
    v_exp_f32 v66, v66
    v_mfma_f32_16x16x32_bf16 v[68:71], a[228:231], a[160:163], v[68:71]
    v_exp_f32 v73, v73
    v_mfma_f32_16x16x32_bf16 v[68:71], a[232:235], a[164:167], v[68:71]
    ds_read_b128 a[212:215], v0 offset:18432
    v_cvt_pk_bf16_f32 v22, v64, v65
    v_mfma_f32_16x16x32_bf16 v[60:63], a[232:235], a[140:143], v[60:63]
    v_cvt_pk_bf16_f32 v23, v66, v67
    v_cvt_pk_bf16_f32 v35, v82, v83
    v_mfma_f32_16x16x32_bf16 v[60:63], a[228:231], a[136:139], v[60:63]
    ds_read_b128 a[220:223], v0 offset:19456
    v_cvt_pk_bf16_f32 v41, v90, v91
    v_mfma_f32_16x16x32_bf16 v[60:63], a[224:227], a[132:135], v[60:63]
    v_cvt_pk_bf16_f32 v29, v74, v75
    v_mfma_f32_16x16x32_bf16 v[52:55], a[224:227], a[108:111], v[52:55]
    v_cvt_pk_bf16_f32 v28, v72, v73
    v_cvt_pk_bf16_f32 v34, v80, v81
    v_mfma_f32_16x16x32_bf16 v[52:55], a[228:231], a[112:115], v[52:55]
    ds_read_b128 a[224:227], v1 offset:19456
    v_mfma_f32_16x16x32_bf16 v[44:47], a[240:243], v[20:23], v[44:47]
    ds_read_b128 a[228:231], v0 offset:20480
    v_mfma_f32_16x16x32_bf16 v[52:55], a[232:235], a[116:119], v[52:55]
    v_mfma_f32_16x16x32_bf16 v[44:47], a[244:247], v[26:29], v[44:47]
    v_mfma_f32_16x16x32_bf16 v[44:47], a[248:251], v[32:35], v[44:47]
    ds_read_b128 a[232:235], v1 offset:20480
    v_mfma_f32_16x16x32_bf16 v[44:47], a[252:255], v[38:41], v[44:47]
    s_waitcnt lgkmcnt(4)
    v_mfma_f32_16x16x32_bf16 v[56:59], a[212:215], a[96:99], 0
    s_add_u32 s21, s21, 12032
    v_mfma_f32_16x16x32_bf16 v[56:59], a[216:219], a[100:103], v[56:59]
    s_waitcnt lgkmcnt(3)
    v_mfma_f32_16x16x32_bf16 v[56:59], a[220:223], a[104:107], v[56:59]
    s_nop 1
    v_cmp_lt_f32 vcc, s29, v44
    v_mfma_f32_16x16x32_bf16 v[64:67], a[220:223], a[128:131], 0
    v_mfma_f32_16x16x32_bf16 v[64:67], a[216:219], a[124:127], v[64:67]
    v_mfma_f32_16x16x32_bf16 v[64:67], a[212:215], a[120:123], v[64:67]
    v_mfma_f32_16x16x32_bf16 v[72:75], a[212:215], a[144:147], 0
    s_nop 0
    s_cbranch_vccnz L_rs_end5a
L_ret_end5a:
    v_mfma_f32_16x16x32_bf16 v[72:75], a[216:219], a[148:151], v[72:75]
    v_fma_f32 v61, v61, s28, v10
    v_mfma_f32_16x16x32_bf16 v[72:75], a[220:223], a[152:155], v[72:75]
    s_waitcnt vmcnt(6) lgkmcnt(0)
    v_fma_f32 v52, v52, s28, v9
    v_mfma_f32_16x16x32_bf16 v[80:83], a[220:223], a[176:179], 0
    s_barrier
    v_mfma_f32_16x16x32_bf16 v[80:83], a[216:219], a[172:175], v[80:83]
    v_fma_f32 v63, v63, s28, v10
    v_fma_f32 v53, v53, s28, v9
    v_mfma_f32_16x16x32_bf16 v[80:83], a[212:215], a[168:171], v[80:83]
    v_exp_f32 v53, v53
    v_mfma_f32_16x16x32_bf16 v[88:91], a[212:215], a[192:195], 0
    v_mfma_f32_16x16x32_bf16 v[88:91], a[216:219], a[196:199], v[88:91]
    v_exp_f32 v52, v52
    v_mfma_f32_16x16x32_bf16 v[88:91], a[220:223], a[200:203], v[88:91]
    ds_read_b64_tr_b16 a[212:213], v2 offset:0
    v_mfma_f32_16x16x32_bf16 v[88:91], a[224:227], a[204:207], v[88:91]
    ds_read_b64_tr_b16 a[214:215], v2 offset:6144
    v_fma_f32 v55, v55, s28, v9
    v_mfma_f32_16x16x32_bf16 v[88:91], a[228:231], a[208:211], v[88:91]
    ds_read_b64_tr_b16 a[216:217], v3 offset:0
    v_mfma_f32_16x16x32_bf16 v[88:91], a[232:235], v[92:95], v[88:91]
    ds_read_b64_tr_b16 a[218:219], v3 offset:6144
    v_fma_f32 v54, v54, s28, v9
    v_mfma_f32_16x16x32_bf16 v[80:83], a[232:235], a[188:191], v[80:83]
    ds_read_b64_tr_b16 a[220:221], v4 offset:0
    v_fma_f32 v62, v62, s28, v10
    v_mfma_f32_16x16x32_bf16 v[80:83], a[228:231], a[184:187], v[80:83]
    v_exp_f32 v62, v62
    v_mfma_f32_16x16x32_bf16 v[80:83], a[224:227], a[180:183], v[80:83]
    v_exp_f32 v61, v61
    v_mfma_f32_16x16x32_bf16 v[72:75], a[224:227], a[156:159], v[72:75]
    v_fma_f32 v60, v60, s28, v10
    v_mfma_f32_16x16x32_bf16 v[72:75], a[228:231], a[160:163], v[72:75]
    v_exp_f32 v63, v63
    v_mfma_f32_16x16x32_bf16 v[72:75], a[232:235], a[164:167], v[72:75]
    v_exp_f32 v60, v60
    v_mfma_f32_16x16x32_bf16 v[64:67], a[232:235], a[140:143], v[64:67]
    v_exp_f32 v55, v55
    v_mfma_f32_16x16x32_bf16 v[64:67], a[228:231], a[136:139], v[64:67]
    v_exp_f32 v54, v54
    v_mfma_f32_16x16x32_bf16 v[64:67], a[224:227], a[132:135], v[64:67]
    v_cvt_pk_bf16_f32 v19, v54, v55
    v_cvt_pk_bf16_f32 v25, v62, v63
    v_mfma_f32_16x16x32_bf16 v[56:59], a[224:227], a[108:111], v[56:59]
    ds_read_b64_tr_b16 a[222:223], v4 offset:6144
    v_cvt_pk_bf16_f32 v24, v60, v61
    v_mfma_f32_16x16x32_bf16 v[56:59], a[228:231], a[112:115], v[56:59]
    ds_read_b64_tr_b16 a[224:225], v5 offset:0
    v_mfma_f32_16x16x32_bf16 v[56:59], a[232:235], a[116:119], v[56:59]
    ds_read_b64_tr_b16 a[226:227], v5 offset:6144
    v_cvt_pk_bf16_f32 v18, v52, v53
    s_waitcnt lgkmcnt(4)
    v_mfma_f32_16x16x32_bf16 v[112:115], a[212:215], v[14:17], v[112:115]
    ds_read_b64_tr_b16 a[232:233], v3 offset:1024
    v_fma_f32 v90, v90, s28, v13
    v_mfma_f32_16x16x32_bf16 v[116:119], a[216:219], v[14:17], v[116:119]
    v_fma_f32 v70, v70, s28, v11
    v_fma_f32 v89, v89, s28, v13
    v_mfma_f32_16x16x32_bf16 v[164:167], a[216:219], v[20:23], v[164:167]
    s_add_u32 s39, s39, 12288
    v_exp_f32 v90, v90
    v_mfma_f32_16x16x32_bf16 v[160:163], a[212:215], v[20:23], v[160:163]
    v_fma_f32 v88, v88, s28, v13
    v_fma_f32 v71, v71, s28, v11
    v_mfma_f32_16x16x32_bf16 v[208:211], a[212:215], v[26:29], v[208:211]
    ds_read_b64_tr_b16 a[230:231], v2 offset:7168
    v_fma_f32 v57, v57, s28, v9
    v_mfma_f32_16x16x32_bf16 v[212:215], a[216:219], v[26:29], v[212:215]
    ds_read_b64_tr_b16 a[228:229], v2 offset:1024
    v_fma_f32 v67, v67, s28, v10
    v_mfma_f32_16x16x32_bf16 a[4:7], a[216:219], v[32:35], a[4:7]
    s_waitcnt vmcnt(0)
    v_fma_f32 v75, v75, s28, v11
    v_fma_f32 v83, v83, s28, v12
    v_mfma_f32_16x16x32_bf16 a[0:3], a[212:215], v[32:35], a[0:3]
    s_barrier
    v_mfma_f32_16x16x32_bf16 a[48:51], a[212:215], v[38:41], a[48:51]
    v_exp_f32 v75, v75
    v_fma_f32 v64, v64, s28, v10
    v_mfma_f32_16x16x32_bf16 a[52:55], a[216:219], v[38:41], a[52:55]
    s_waitcnt lgkmcnt(3)
    ds_read_b64_tr_b16 a[234:235], v3 offset:7168
    v_fma_f32 v77, v77, s28, v12
    v_mfma_f32_16x16x32_bf16 a[56:59], a[220:223], v[38:41], a[56:59]
    v_fma_f32 v74, v74, s28, v11
    v_fma_f32 v81, v81, s28, v12
    v_mfma_f32_16x16x32_bf16 a[60:63], a[224:227], v[38:41], a[60:63]
    ds_read_b64_tr_b16 a[212:213], v4 offset:1024
    v_fma_f32 v59, v59, s28, v9
    v_mfma_f32_16x16x32_bf16 a[12:15], a[224:227], v[32:35], a[12:15]
    v_fma_f32 v66, v66, s28, v10
    v_fma_f32 v79, v79, s28, v12
    v_mfma_f32_16x16x32_bf16 a[8:11], a[220:223], v[32:35], a[8:11]
    ds_read_b64_tr_b16 a[214:215], v4 offset:7168
    v_fma_f32 v91, v91, s28, v13
    v_mfma_f32_16x16x32_bf16 v[216:219], a[220:223], v[26:29], v[216:219]
    ds_read_b64_tr_b16 a[218:219], v5 offset:7168
    v_fma_f32 v56, v56, s28, v9
    v_mfma_f32_16x16x32_bf16 v[220:223], a[224:227], v[26:29], v[220:223]
    v_exp_f32 v56, v56
    v_mfma_f32_16x16x32_bf16 v[172:175], a[224:227], v[20:23], v[172:175]
    v_exp_f32 v88, v88
    v_mfma_f32_16x16x32_bf16 v[168:171], a[220:223], v[20:23], v[168:171]
    v_exp_f32 v57, v57
    v_mfma_f32_16x16x32_bf16 v[120:123], a[220:223], v[14:17], v[120:123]
    ds_read_b64_tr_b16 a[216:217], v5 offset:1024
    v_fma_f32 v85, v85, s28, v13
    v_mfma_f32_16x16x32_bf16 v[124:127], a[224:227], v[14:17], v[124:127]
    s_waitcnt lgkmcnt(4)
    v_fma_f32 v58, v58, s28, v9
    v_fma_f32 v68, v68, s28, v11
    v_mfma_f32_16x16x32_bf16 v[128:131], a[228:231], v[14:17], v[128:131]
    v_exp_f32 v79, v79
    v_mfma_f32_16x16x32_bf16 v[132:135], a[232:235], v[14:17], v[132:135]
    v_fma_f32 v80, v80, s28, v12
    v_exp_f32 v66, v66
    v_mfma_f32_16x16x32_bf16 v[180:183], a[232:235], v[20:23], v[180:183]
    ds_read_b64_tr_b16 a[226:227], v3 offset:8192
    v_fma_f32 v76, v76, s28, v12
    v_mfma_f32_16x16x32_bf16 v[176:179], a[228:231], v[20:23], v[176:179]
    v_exp_f32 v59, v59
    v_mfma_f32_16x16x32_bf16 v[224:227], a[228:231], v[26:29], v[224:227]
    ds_read_b64_tr_b16 a[220:221], v2 offset:2048
    v_fma_f32 v69, v69, s28, v11
    v_mfma_f32_16x16x32_bf16 v[228:231], a[232:235], v[26:29], v[228:231]
    ds_read_b64_tr_b16 a[222:223], v2 offset:8192
    v_fma_f32 v78, v78, s28, v12
    v_mfma_f32_16x16x32_bf16 a[20:23], a[232:235], v[32:35], a[20:23]
    v_exp_f32 v78, v78
    v_mfma_f32_16x16x32_bf16 a[16:19], a[228:231], v[32:35], a[16:19]
    ds_read_b64_tr_b16 a[224:225], v3 offset:2048
    v_fma_f32 v84, v84, s28, v13
    v_mfma_f32_16x16x32_bf16 a[64:67], a[228:231], v[38:41], a[64:67]
    v_exp_f32 v81, v81
    v_mfma_f32_16x16x32_bf16 a[68:71], a[232:235], v[38:41], a[68:71]
    s_waitcnt lgkmcnt(4)
    v_fma_f32 v86, v86, s28, v13
    v_fma_f32 v65, v65, s28, v10
    v_mfma_f32_16x16x32_bf16 a[72:75], a[212:215], v[38:41], a[72:75]
    ds_read_b64_tr_b16 a[228:229], v4 offset:2048
    v_fma_f32 v87, v87, s28, v13
    v_mfma_f32_16x16x32_bf16 a[76:79], a[216:219], v[38:41], a[76:79]
    ds_read_b64_tr_b16 a[234:235], v5 offset:8192
    v_exp_f32 v67, v67
    v_mfma_f32_16x16x32_bf16 a[28:31], a[216:219], v[32:35], a[28:31]
    v_exp_f32 v76, v76
    v_mfma_f32_16x16x32_bf16 a[24:27], a[212:215], v[32:35], a[24:27]
    v_exp_f32 v70, v70
    v_mfma_f32_16x16x32_bf16 v[232:235], a[212:215], v[26:29], v[232:235]
    v_exp_f32 v83, v83
    v_mfma_f32_16x16x32_bf16 v[236:239], a[216:219], v[26:29], v[236:239]
    ds_read_b64_tr_b16 a[230:231], v4 offset:8192
    v_fma_f32 v73, v73, s28, v11
    v_mfma_f32_16x16x32_bf16 v[188:191], a[216:219], v[20:23], v[188:191]
    v_exp_f32 v68, v68
    v_mfma_f32_16x16x32_bf16 v[184:187], a[212:215], v[20:23], v[184:187]
    v_exp_f32 v65, v65
    v_mfma_f32_16x16x32_bf16 v[136:139], a[212:215], v[14:17], v[136:139]
    v_exp_f32 v80, v80
    v_mfma_f32_16x16x32_bf16 v[140:143], a[216:219], v[14:17], v[140:143]
    s_waitcnt lgkmcnt(3)
    v_exp_f32 v74, v74
    v_mfma_f32_16x16x32_bf16 v[144:147], a[220:223], v[14:17], v[144:147]
    ds_read_b64_tr_b16 a[232:233], v5 offset:2048
    v_fma_f32 v82, v82, s28, v12
    v_mfma_f32_16x16x32_bf16 v[148:151], a[224:227], v[14:17], v[148:151]
    v_exp_f32 v77, v77
    v_exp_f32 v89, v89
    v_mfma_f32_16x16x32_bf16 v[196:199], a[224:227], v[20:23], v[196:199]
    v_exp_f32 v86, v86
    v_mfma_f32_16x16x32_bf16 v[192:195], a[220:223], v[20:23], v[192:195]
    ds_read_b64_tr_b16 a[212:213], v2 offset:18432
    v_exp_f32 v85, v85
    v_mfma_f32_16x16x32_bf16 v[240:243], a[220:223], v[26:29], v[240:243]
    v_exp_f32 v58, v58
    v_mfma_f32_16x16x32_bf16 v[244:247], a[224:227], v[26:29], v[244:247]
    v_exp_f32 v84, v84
    v_mfma_f32_16x16x32_bf16 a[36:39], a[224:227], v[32:35], a[36:39]
    v_cvt_pk_bf16_f32 v37, v78, v79
    v_cvt_pk_bf16_f32 v42, v84, v85
    v_mfma_f32_16x16x32_bf16 a[32:35], a[220:223], v[32:35], a[32:35]
    v_exp_f32 v69, v69
    v_mfma_f32_16x16x32_bf16 a[80:83], a[220:223], v[38:41], a[80:83]
    v_exp_f32 v73, v73
    v_mfma_f32_16x16x32_bf16 a[84:87], a[224:227], v[38:41], a[84:87]
    s_waitcnt lgkmcnt(1)
    ds_read_b64_tr_b16 a[214:215], v2 offset:12288
    v_cvt_pk_bf16_f32 v30, v68, v69
    v_mfma_f32_16x16x32_bf16 a[88:91], a[228:231], v[38:41], a[88:91]
    v_exp_f32 v82, v82
    v_fma_f32 v72, v72, s28, v11
    v_mfma_f32_16x16x32_bf16 a[92:95], a[232:235], v[38:41], a[92:95]
    v_exp_f32 v64, v64
    v_mfma_f32_16x16x32_bf16 a[44:47], a[232:235], v[32:35], a[44:47]
    v_exp_f32 v71, v71
    v_mfma_f32_16x16x32_bf16 a[40:43], a[228:231], v[32:35], a[40:43]
    v_exp_f32 v91, v91
    v_mfma_f32_16x16x32_bf16 v[248:251], a[228:231], v[26:29], v[248:251]
    ds_read_b64_tr_b16 a[216:217], v3 offset:18432
    v_cvt_pk_bf16_f32 v40, v88, v89
    v_mfma_f32_16x16x32_bf16 v[252:255], a[232:235], v[26:29], v[252:255]
    ds_read_b64_tr_b16 a[218:219], v3 offset:12288
    v_cvt_pk_bf16_f32 v35, v82, v83
    v_mfma_f32_16x16x32_bf16 v[204:207], a[232:235], v[20:23], v[204:207]
    ds_read_b64_tr_b16 a[220:221], v4 offset:18432
    v_exp_f32 v72, v72
    v_mfma_f32_16x16x32_bf16 v[200:203], a[228:231], v[20:23], v[200:203]
    ds_read_b64_tr_b16 a[222:223], v4 offset:12288
    v_cvt_pk_bf16_f32 v23, v66, v67
    v_mfma_f32_16x16x32_bf16 v[152:155], a[228:231], v[14:17], v[152:155]
    v_cvt_pk_bf16_f32 v31, v70, v71
    v_cvt_pk_bf16_f32 v28, v72, v73
    v_cvt_pk_bf16_f32 v22, v64, v65
    v_mfma_f32_16x16x32_bf16 v[156:159], a[232:235], v[14:17], v[156:159]
    v_cvt_pk_bf16_f32 v17, v58, v59
    v_cvt_pk_bf16_f32 v16, v56, v57
    v_cvt_pk_bf16_f32 v29, v74, v75
    v_cvt_pk_bf16_f32 v36, v76, v77
    v_mfma_f32_16x16x32_bf16 v[48:51], a[236:239], v[16:19], v[44:47]
    v_exp_f32 v87, v87
    v_mfma_f32_16x16x32_bf16 v[48:51], a[240:243], v[22:25], v[48:51]
    v_cvt_pk_bf16_f32 v43, v86, v87
    v_cvt_pk_bf16_f32 v34, v80, v81
    v_mfma_f32_16x16x32_bf16 v[48:51], a[244:247], v[28:31], v[48:51]
    ds_read_b64_tr_b16 a[224:225], v5 offset:18432
    v_cvt_pk_bf16_f32 v41, v90, v91
    v_mfma_f32_16x16x32_bf16 v[48:51], a[248:251], v[34:37], v[48:51]
    ds_read_b64_tr_b16 a[226:227], v5 offset:12288
    v_mfma_f32_16x16x32_bf16 v[48:51], a[252:255], v[40:43], v[48:51]
    s_nop 7
    v_cmp_lt_f32 vcc, s29, v48
    s_nop 4
    s_cbranch_vccnz L_rs_end5b
L_ret_end5b:
    v_and_b32 v101, 0x3ff, v0
    v_lshrrev_b32 v108, 11, v0
    v_rcp_f32 v8, v51
    v_rcp_f32 v50, v50
    v_xor_b32 v108, s65, v108
    v_lshl_add_u32 v101, v108, 10, v101
    v_mov_b32 v100, v48
    v_add_u32 v101, s38, v101
    v_mbcnt_lo_u32_b32 v108, -1, 0
    v_mbcnt_hi_u32_b32 v108, -1, v108
    v_lshrrev_b32 v108, 1, v108
    v_permlane32_swap_b32 v48, v100
    v_and_b32 v108, 24, v108
    v_bfe_u32 v108, s66, v108, 8
    v_xor_b32 v101, v101, v108
    v_mov_b32 v108, v100
    v_rcp_f32 v48, v48
    v_rcp_f32 v102, v49
    v_permlane16_swap_b32 v100, v108
    v_rcp_f32 v100, v100
    s_waitcnt lgkmcnt(4)
    v_mfma_f32_16x16x32_bf16 v[112:115], a[212:215], v[16:19], v[112:115]
    v_mfma_f32_16x16x32_bf16 v[116:119], a[216:219], v[16:19], v[116:119]
    v_mfma_f32_16x16x32_bf16 v[164:167], a[216:219], v[22:25], v[164:167]
    v_mfma_f32_16x16x32_bf16 v[160:163], a[212:215], v[22:25], v[160:163]
    ds_read_b64_tr_b16 a[232:233], v3 offset:19456
    v_mfma_f32_16x16x32_bf16 v[208:211], a[212:215], v[28:31], v[208:211]
    v_mfma_f32_16x16x32_bf16 v[212:215], a[216:219], v[28:31], v[212:215]
    s_add_u32 s84, s34, 0
    ds_read_b64_tr_b16 a[234:235], v3 offset:13312
    v_mfma_f32_16x16x32_bf16 a[4:7], a[216:219], v[34:37], a[4:7]
    v_mfma_f32_16x16x32_bf16 a[0:3], a[212:215], v[34:37], a[0:3]
    v_mfma_f32_16x16x32_bf16 a[48:51], a[212:215], v[40:43], a[48:51]
    ds_read_b64_tr_b16 a[230:231], v2 offset:13312
    v_mfma_f32_16x16x32_bf16 a[52:55], a[216:219], v[40:43], a[52:55]
    s_waitcnt lgkmcnt(3)
    ds_read_b64_tr_b16 a[228:229], v2 offset:19456
    v_mfma_f32_16x16x32_bf16 a[56:59], a[220:223], v[40:43], a[56:59]
    s_nop 0
    v_accvgpr_read_b32 v108, a4
    v_xor_b32 v94, 96, v101
    v_mfma_f32_16x16x32_bf16 a[60:63], a[224:227], v[40:43], a[60:63]
    v_accvgpr_read_b32 v109, a5
    s_add_u32 s85, s34, 6144
    v_mfma_f32_16x16x32_bf16 a[12:15], a[224:227], v[34:37], a[12:15]
    s_add_u32 s86, s34, 12288
    v_mfma_f32_16x16x32_bf16 a[8:11], a[220:223], v[34:37], a[8:11]
    v_mfma_f32_16x16x32_bf16 v[216:219], a[220:223], v[28:31], v[216:219]
    s_add_u32 s87, s34, 18432
    v_mfma_f32_16x16x32_bf16 v[220:223], a[224:227], v[28:31], v[220:223]
    ds_read_b64_tr_b16 a[218:219], v5 offset:13312
    v_accvgpr_read_b32 v107, a3
    v_mfma_f32_16x16x32_bf16 v[172:175], a[224:227], v[22:25], v[172:175]
    v_mfma_f32_16x16x32_bf16 v[168:171], a[220:223], v[22:25], v[168:171]
    v_mfma_f32_16x16x32_bf16 v[120:123], a[220:223], v[16:19], v[120:123]
    ds_read_b64_tr_b16 a[212:213], v4 offset:19456
    v_mfma_f32_16x16x32_bf16 v[124:127], a[224:227], v[16:19], v[124:127]
    s_waitcnt lgkmcnt(2)
    v_accvgpr_read_b32 v105, a1
    v_mfma_f32_16x16x32_bf16 v[128:131], a[228:231], v[16:19], v[128:131]
    ds_read_b64_tr_b16 a[220:221], v2 offset:20480
    v_mfma_f32_16x16x32_bf16 v[132:135], a[232:235], v[16:19], v[132:135]
    ds_read_b64_tr_b16 a[216:217], v5 offset:19456
    v_mfma_f32_16x16x32_bf16 v[180:183], a[232:235], v[22:25], v[180:183]
    ds_read_b64_tr_b16 a[224:225], v3 offset:20480
    v_mfma_f32_16x16x32_bf16 v[176:179], a[228:231], v[22:25], v[176:179]
    ds_read_b64_tr_b16 a[214:215], v4 offset:13312
    v_accvgpr_read_b32 v111, a7
    v_mfma_f32_16x16x32_bf16 v[224:227], a[228:231], v[28:31], v[224:227]
    v_accvgpr_read_b32 v52, a8
    v_mfma_f32_16x16x32_bf16 v[228:231], a[232:235], v[28:31], v[228:231]
    ds_read_b64_tr_b16 a[226:227], v3 offset:14336
    v_accvgpr_read_b32 v104, a0
    v_xor_b32 v92, 32, v101
    v_accvgpr_read_b32 v110, a6
    v_accvgpr_read_b32 v59, a15
    v_pk_mul_f32 v[170:171], v[170:171], v[102:103] op_sel_hi:[1,0]
    v_pk_mul_f32 v[166:167], v[166:167], v[102:103] op_sel_hi:[1,0]
    v_pk_mul_f32 v[214:215], v[214:215], v[50:51] op_sel_hi:[1,0]
    v_pk_mul_f32 v[116:117], v[116:117], v[48:49] op_sel_hi:[1,0]
    v_pk_mul_f32 v[108:109], v[108:109], v[8:9] op_sel_hi:[1,0]
    v_pk_mul_f32 v[120:121], v[120:121], v[48:49] op_sel_hi:[1,0]
    v_pk_mul_f32 v[104:105], v[104:105], v[8:9] op_sel_hi:[1,0]
    v_pk_mul_f32 v[118:119], v[118:119], v[48:49] op_sel_hi:[1,0]
    v_pk_mul_f32 v[122:123], v[122:123], v[48:49] op_sel_hi:[1,0]
    v_pk_mul_f32 v[208:209], v[208:209], v[50:51] op_sel_hi:[1,0]
    v_pk_mul_f32 v[172:173], v[172:173], v[102:103] op_sel_hi:[1,0]
    v_pk_mul_f32 v[168:169], v[168:169], v[102:103] op_sel_hi:[1,0]
    v_pk_mul_f32 v[112:113], v[112:113], v[48:49] op_sel_hi:[1,0]
    v_pk_mul_f32 v[114:115], v[114:115], v[48:49] op_sel_hi:[1,0]
    v_pk_mul_f32 v[124:125], v[124:125], v[48:49] op_sel_hi:[1,0]
    v_pk_mul_f32 v[126:127], v[126:127], v[48:49] op_sel_hi:[1,0]
    v_pk_mul_f32 v[164:165], v[164:165], v[102:103] op_sel_hi:[1,0]
    v_pk_mul_f32 v[174:175], v[174:175], v[102:103] op_sel_hi:[1,0]
    v_pk_mul_f32 v[162:163], v[162:163], v[102:103] op_sel_hi:[1,0]
    v_pk_mul_f32 v[216:217], v[216:217], v[50:51] op_sel_hi:[1,0]
    v_pk_mul_f32 v[160:161], v[160:161], v[102:103] op_sel_hi:[1,0]
    v_cvt_pk_bf16_f32 v120, v120, v121
    s_nop 0
    v_mfma_f32_16x16x32_bf16 a[20:23], a[232:235], v[34:37], a[20:23]
    s_add_u32 s88, s34, 24576
    ds_read_b64_tr_b16 a[222:223], v2 offset:14336
    v_cvt_pk_bf16_f32 v116, v116, v117
    v_mfma_f32_16x16x32_bf16 a[16:19], a[228:231], v[34:37], a[16:19]
    v_accvgpr_read_b32 v106, a2
    v_cvt_pk_bf16_f32 v112, v112, v113
    v_mfma_f32_16x16x32_bf16 a[64:67], a[228:231], v[40:43], a[64:67]
    v_cvt_pk_bf16_f32 v117, v118, v119
    v_cvt_pk_bf16_f32 v208, v208, v209
    v_mfma_f32_16x16x32_bf16 a[68:71], a[232:235], v[40:43], a[68:71]
    s_waitcnt lgkmcnt(1)
    ds_read_b64_tr_b16 a[232:233], v5 offset:20480
    v_cvt_pk_bf16_f32 v160, v160, v161
    v_mfma_f32_16x16x32_bf16 a[72:75], a[212:215], v[40:43], a[72:75]
    v_cvt_pk_bf16_f32 v113, v114, v115
    v_accvgpr_read_b32 v57, a13
    v_mfma_f32_16x16x32_bf16 a[76:79], a[216:219], v[40:43], a[76:79]
    v_cvt_pk_bf16_f32 v164, v164, v165
    v_cvt_pk_bf16_f32 v121, v122, v123
    v_mfma_f32_16x16x32_bf16 a[28:31], a[216:219], v[34:37], a[28:31]
    v_cvt_pk_bf16_f32 v168, v168, v169
    v_cvt_pk_bf16_f32 v172, v172, v173
    v_mfma_f32_16x16x32_bf16 a[24:27], a[212:215], v[34:37], a[24:27]
    v_cvt_pk_bf16_f32 v173, v174, v175
    v_cvt_pk_bf16_f32 v161, v162, v163
    v_mfma_f32_16x16x32_bf16 v[232:235], a[212:215], v[28:31], v[232:235]
    v_mfma_f32_16x16x32_bf16 v[236:239], a[216:219], v[28:31], v[236:239]
    ds_read_b64_tr_b16 a[230:231], v4 offset:14336
    v_cvt_pk_bf16_f32 v124, v124, v125
    v_mfma_f32_16x16x32_bf16 v[188:191], a[216:219], v[22:25], v[188:191]
    ds_read_b64_tr_b16 a[234:235], v5 offset:14336
    v_cvt_pk_bf16_f32 v169, v170, v171
    v_mfma_f32_16x16x32_bf16 v[184:187], a[212:215], v[22:25], v[184:187]
    s_add_u32 s18, s34, 30720
    v_subrev_u32 v103, 28672, v103
    v_cvt_pk_bf16_f32 v104, v104, v105
    v_mfma_f32_16x16x32_bf16 v[136:139], a[212:215], v[16:19], v[136:139]
    ds_write2st64_b64 v101, v[112:113], v[160:161] offset0:0 offset1:12
    v_mfma_f32_16x16x32_bf16 v[140:143], a[216:219], v[16:19], v[140:143]
    s_waitcnt lgkmcnt(3)
    ds_read_b64_tr_b16 a[228:229], v4 offset:20480
    v_cvt_pk_bf16_f32 v165, v166, v167
    v_mfma_f32_16x16x32_bf16 v[144:147], a[220:223], v[16:19], v[144:147]
    ds_write2st64_b64 v92, v[116:117], v[164:165] offset0:0 offset1:12
    v_mfma_f32_16x16x32_bf16 v[148:151], a[224:227], v[16:19], v[148:151]
    v_xor_b32 v93, 64, v101
    v_cvt_pk_bf16_f32 v125, v126, v127
    v_mfma_f32_16x16x32_bf16 v[196:199], a[224:227], v[22:25], v[196:199]
    ds_write2st64_b64 v93, v[120:121], v[168:169] offset0:0 offset1:12
    v_mfma_f32_16x16x32_bf16 v[192:195], a[220:223], v[22:25], v[192:195]
    ds_write2st64_b64 v94, v[124:125], v[172:173] offset0:0 offset1:12
    v_mfma_f32_16x16x32_bf16 v[240:243], a[220:223], v[28:31], v[240:243]
    ds_read_b128 v[60:63], v103 offset:0
    v_accvgpr_read_b32 v54, a10
    v_accvgpr_read_b32 v58, a14
    v_mfma_f32_16x16x32_bf16 v[244:247], a[224:227], v[28:31], v[244:247]
    v_accvgpr_read_b32 v53, a9
    v_mfma_f32_16x16x32_bf16 a[36:39], a[224:227], v[34:37], a[36:39]
    v_accvgpr_read_b32 v56, a12
    v_cvt_pk_bf16_f32 v216, v216, v217
    v_mfma_f32_16x16x32_bf16 a[32:35], a[220:223], v[34:37], a[32:35]
    v_pk_mul_f32 v[218:219], v[218:219], v[50:51] op_sel_hi:[1,0]
    v_pk_mul_f32 v[132:133], v[132:133], v[48:49] op_sel_hi:[1,0]
    s_nop 1
    v_mfma_f32_16x16x32_bf16 a[80:83], a[220:223], v[40:43], a[80:83]
    v_cvt_pk_bf16_f32 v108, v108, v109
    ds_read_b128 v[64:67], v103 offset:1024
    v_mfma_f32_16x16x32_bf16 a[84:87], a[224:227], v[40:43], a[84:87]
    s_waitcnt lgkmcnt(3)
    v_mfma_f32_16x16x32_bf16 a[88:91], a[228:231], v[40:43], a[88:91]
    v_mfma_f32_16x16x32_bf16 a[92:95], a[232:235], v[40:43], a[92:95]
    s_waitcnt lgkmcnt(1)
    buffer_store_dwordx4 v[60:63], v6, s[16:19], s84 offen offset:0 nt
    v_pk_mul_f32 v[212:213], v[212:213], v[50:51] op_sel_hi:[1,0]
    v_pk_mul_f32 v[140:141], v[140:141], v[48:49] op_sel_hi:[1,0]
    v_pk_mul_f32 v[110:111], v[110:111], v[8:9] op_sel_hi:[1,0]
    v_accvgpr_read_b32 v55, a11
    v_pk_mul_f32 v[56:57], v[56:57], v[8:9] op_sel_hi:[1,0]
    ds_read_b128 v[68:71], v103 offset:6144
    v_pk_mul_f32 v[130:131], v[130:131], v[48:49] op_sel_hi:[1,0]
    v_pk_mul_f32 v[210:211], v[210:211], v[50:51] op_sel_hi:[1,0]
    v_cvt_pk_bf16_f32 v217, v218, v219
    v_pk_mul_f32 v[58:59], v[58:59], v[8:9] op_sel_hi:[1,0]
    v_pk_mul_f32 v[136:137], v[136:137], v[48:49] op_sel_hi:[1,0]
    v_cvt_pk_bf16_f32 v56, v56, v57
    v_pk_mul_f32 v[54:55], v[54:55], v[8:9] op_sel_hi:[1,0]
    v_cvt_pk_bf16_f32 v212, v212, v213
    v_pk_mul_f32 v[138:139], v[138:139], v[48:49] op_sel_hi:[1,0]
    v_pk_mul_f32 v[220:221], v[220:221], v[50:51] op_sel_hi:[1,0]
    v_pk_mul_f32 v[222:223], v[222:223], v[50:51] op_sel_hi:[1,0]
    v_pk_mul_f32 v[142:143], v[142:143], v[48:49] op_sel_hi:[1,0]
    v_pk_mul_f32 v[236:237], v[236:237], v[50:51] op_sel_hi:[1,0]
    v_pk_mul_f32 v[106:107], v[106:107], v[8:9] op_sel_hi:[1,0]
    v_cvt_pk_bf16_f32 v132, v132, v133
    v_cvt_pk_bf16_f32 v213, v214, v215
    v_mfma_f32_16x16x32_bf16 a[44:47], a[232:235], v[34:37], a[44:47]
    ds_read_b128 v[72:75], v103 offset:7168
    v_mfma_f32_16x16x32_bf16 a[40:43], a[228:231], v[34:37], a[40:43]
    s_waitcnt lgkmcnt(2)
    buffer_store_dwordx4 v[64:67], v7, s[16:19], s84 offen offset:0 nt
    v_cvt_pk_bf16_f32 v220, v220, v221
    v_pk_mul_f32 v[52:53], v[52:53], v[8:9] op_sel_hi:[1,0]
    v_cvt_pk_bf16_f32 v109, v110, v111
    v_cvt_pk_bf16_f32 v209, v210, v211
    v_cvt_pk_bf16_f32 v105, v106, v107
    v_cvt_pk_bf16_f32 v52, v52, v53
    v_pk_mul_f32 v[240:241], v[240:241], v[50:51] op_sel_hi:[1,0]
    v_cvt_pk_bf16_f32 v53, v54, v55
    v_cvt_pk_bf16_f32 v221, v222, v223
    v_cvt_pk_bf16_f32 v57, v58, v59
    ds_write2st64_b64 v101, v[208:209], v[104:105] offset0:24 offset1:36
    v_mfma_f32_16x16x32_bf16 v[248:251], a[228:231], v[28:31], v[248:251]
    ds_write2st64_b64 v92, v[212:213], v[108:109] offset0:24 offset1:36
    v_cvt_pk_bf16_f32 v236, v236, v237
    v_mfma_f32_16x16x32_bf16 v[252:255], a[232:235], v[28:31], v[252:255]
    s_waitcnt lgkmcnt(3)
    buffer_store_dwordx4 v[68:71], v6, s[16:19], s85 offen offset:0 nt
    v_accvgpr_read_b32 v104, a48
    ds_write2st64_b64 v93, v[216:217], v[52:53] offset0:24 offset1:36
    v_mfma_f32_16x16x32_bf16 v[204:207], a[232:235], v[22:25], v[204:207]
    v_accvgpr_read_b32 v106, a50
    ds_write2st64_b64 v94, v[220:221], v[56:57] offset0:24 offset1:36
    v_accvgpr_read_b32 v56, a60
    v_mfma_f32_16x16x32_bf16 v[200:203], a[228:231], v[22:25], v[200:203]
    v_accvgpr_read_b32 v110, a54
    ds_read_b128 v[76:79], v103 offset:12288
    v_accvgpr_read_b32 v105, a49
    v_accvgpr_read_b32 v57, a61
    v_pk_mul_f32 v[128:129], v[128:129], v[48:49] op_sel_hi:[1,0]
    v_accvgpr_read_b32 v53, a57
    s_waitcnt lgkmcnt(3)
    buffer_store_dwordx4 v[72:75], v7, s[16:19], s85 offen offset:0 nt
    v_accvgpr_read_b32 v111, a55
    v_accvgpr_read_b32 v107, a51
    v_accvgpr_read_b32 v58, a62
    v_pk_mul_f32 v[184:185], v[184:185], v[102:103] op_sel_hi:[1,0]
    v_accvgpr_read_b32 v54, a58
    v_pk_mul_f32 v[228:229], v[228:229], v[50:51] op_sel_hi:[1,0]
    v_accvgpr_read_b32 v109, a53
    v_cvt_pk_bf16_f32 v240, v240, v241
    v_accvgpr_read_b32 v59, a63
    v_pk_mul_f32 v[104:105], v[104:105], v[100:101] op_sel_hi:[1,0]
    v_pk_mul_f32 v[110:111], v[110:111], v[100:101] op_sel_hi:[1,0]
    v_pk_mul_f32 v[176:177], v[176:177], v[102:103] op_sel_hi:[1,0]
    v_pk_mul_f32 v[56:57], v[56:57], v[100:101] op_sel_hi:[1,0]
    s_nop 1
    v_mfma_f32_16x16x32_bf16 v[152:155], a[228:231], v[16:19], v[152:155]
    ds_read_b128 v[80:83], v103 offset:13312
    v_mfma_f32_16x16x32_bf16 v[156:159], a[232:235], v[16:19], v[156:159]
    v_cvt_pk_bf16_f32 v56, v56, v57
    v_accvgpr_read_b32 v52, a56
    v_accvgpr_read_b32 v108, a52
    ds_read_b128 v[84:87], v103 offset:18432
    v_pk_mul_f32 v[106:107], v[106:107], v[100:101] op_sel_hi:[1,0]
    v_cvt_pk_bf16_f32 v136, v136, v137
    s_waitcnt lgkmcnt(2)
    buffer_store_dwordx4 v[76:79], v6, s[16:19], s86 offen offset:0 nt
    v_pk_mul_f32 v[180:181], v[180:181], v[102:103] op_sel_hi:[1,0]
    v_pk_mul_f32 v[52:53], v[52:53], v[100:101] op_sel_hi:[1,0]
    v_cvt_pk_bf16_f32 v140, v140, v141
    v_accvgpr_read_b32 v55, a59
    v_pk_mul_f32 v[108:109], v[108:109], v[100:101] op_sel_hi:[1,0]
    v_cvt_pk_bf16_f32 v184, v184, v185
    v_pk_mul_f32 v[54:55], v[54:55], v[100:101] op_sel_hi:[1,0]
    ds_read_b128 v[88:91], v103 offset:19456
    v_pk_mul_f32 v[190:191], v[190:191], v[102:103] op_sel_hi:[1,0]
    v_pk_mul_f32 v[224:225], v[224:225], v[50:51] op_sel_hi:[1,0]
    v_pk_mul_f32 v[58:59], v[58:59], v[100:101] op_sel_hi:[1,0]
    v_pk_mul_f32 v[156:157], v[156:157], v[48:49] op_sel_hi:[1,0]
    v_pk_mul_f32 v[144:145], v[144:145], v[48:49] op_sel_hi:[1,0]
    v_cvt_pk_bf16_f32 v52, v52, v53
    v_cvt_pk_bf16_f32 v104, v104, v105
    v_cvt_pk_bf16_f32 v108, v108, v109
    v_cvt_pk_bf16_f32 v105, v106, v107
    v_cvt_pk_bf16_f32 v57, v58, v59
    v_pk_mul_f32 v[178:179], v[178:179], v[102:103] op_sel_hi:[1,0]
    v_pk_mul_f32 v[204:205], v[204:205], v[102:103] op_sel_hi:[1,0]
    v_pk_mul_f32 v[188:189], v[188:189], v[102:103] op_sel_hi:[1,0]
    v_cvt_pk_bf16_f32 v53, v54, v55
    v_pk_mul_f32 v[186:187], v[186:187], v[102:103] op_sel_hi:[1,0]
    v_cvt_pk_bf16_f32 v176, v176, v177
    s_waitcnt lgkmcnt(2)
    buffer_store_dwordx4 v[80:83], v7, s[16:19], s86 offen offset:0 nt
    v_accvgpr_read_b32 v107, a19
    v_cvt_pk_bf16_f32 v128, v128, v129
    v_cvt_pk_bf16_f32 v204, v204, v205
    v_accvgpr_read_b32 v106, a18
    v_cvt_pk_bf16_f32 v109, v110, v111
    v_cvt_pk_bf16_f32 v228, v228, v229
    v_accvgpr_read_b32 v58, a30
    ds_write_b64 v101, v[104:105] offset:24576
    v_cvt_pk_bf16_f32 v141, v142, v143
    v_pk_mul_f32 v[134:135], v[134:135], v[48:49] op_sel_hi:[1,0]
    v_pk_mul_f32 v[202:203], v[202:203], v[102:103] op_sel_hi:[1,0]
    v_pk_mul_f32 v[194:195], v[194:195], v[102:103] op_sel_hi:[1,0]
    ds_write_b64 v92, v[108:109] offset:24576
    ds_write_b64 v93, v[52:53] offset:24576
    v_cvt_pk_bf16_f32 v156, v156, v157
    v_cvt_pk_bf16_f32 v180, v180, v181
    s_waitcnt lgkmcnt(3)
    buffer_store_dwordx4 v[84:87], v6, s[16:19], s87 offen offset:0 nt
    ds_write_b64 v94, v[56:57] offset:24576
    v_pk_mul_f32 v[248:249], v[248:249], v[50:51] op_sel_hi:[1,0]
    v_pk_mul_f32 v[230:231], v[230:231], v[50:51] op_sel_hi:[1,0]
    v_cvt_pk_bf16_f32 v133, v134, v135
    v_accvgpr_read_b32 v53, a25
    v_pk_mul_f32 v[196:197], v[196:197], v[102:103] op_sel_hi:[1,0]
    v_pk_mul_f32 v[242:243], v[242:243], v[50:51] op_sel_hi:[1,0]
    v_cvt_pk_bf16_f32 v177, v178, v179
    v_accvgpr_read_b32 v111, a23
    v_cvt_pk_bf16_f32 v129, v130, v131
    v_pk_mul_f32 v[226:227], v[226:227], v[50:51] op_sel_hi:[1,0]
    v_pk_mul_f32 v[238:239], v[238:239], v[50:51] op_sel_hi:[1,0]
    v_pk_mul_f32 v[182:183], v[182:183], v[102:103] op_sel_hi:[1,0]
    v_pk_mul_f32 v[106:107], v[106:107], v[8:9] op_sel_hi:[1,0]
    v_accvgpr_read_b32 v110, a22
    v_accvgpr_read_b32 v59, a31
    v_pk_mul_f32 v[192:193], v[192:193], v[102:103] op_sel_hi:[1,0]
    v_pk_mul_f32 v[58:59], v[58:59], v[8:9] op_sel_hi:[1,0]
    v_pk_mul_f32 v[232:233], v[232:233], v[50:51] op_sel_hi:[1,0]
    ds_read_b128 v[60:63], v103 offset:24576
    v_pk_mul_f32 v[152:153], v[152:153], v[48:49] op_sel_hi:[1,0]
    v_accvgpr_read_b32 v52, a24
    v_pk_mul_f32 v[234:235], v[234:235], v[50:51] op_sel_hi:[1,0]
    v_accvgpr_read_b32 v105, a17
    buffer_store_dwordx4 v[88:91], v7, s[16:19], s87 offen offset:0 nt
    v_pk_mul_f32 v[158:159], v[158:159], v[48:49] op_sel_hi:[1,0]
    v_cvt_pk_bf16_f32 v196, v196, v197
    v_pk_mul_f32 v[110:111], v[110:111], v[8:9] op_sel_hi:[1,0]
    v_accvgpr_read_b32 v56, a28
    v_accvgpr_read_b32 v55, a27
    v_accvgpr_read_b32 v109, a21
    v_cvt_pk_bf16_f32 v188, v188, v189
    ds_read_b128 v[64:67], v103 offset:25600
    v_accvgpr_read_b32 v57, a29
    v_cvt_pk_bf16_f32 v192, v192, v193
    v_pk_mul_f32 v[56:57], v[56:57], v[8:9] op_sel_hi:[1,0]
    v_cvt_pk_bf16_f32 v232, v232, v233
    v_cvt_pk_bf16_f32 v152, v152, v153
    v_cvt_pk_bf16_f32 v185, v186, v187
    v_cvt_pk_bf16_f32 v137, v138, v139
    v_accvgpr_read_b32 v54, a26
    v_cvt_pk_bf16_f32 v224, v224, v225
    v_pk_mul_f32 v[200:201], v[200:201], v[102:103] op_sel_hi:[1,0]
    ds_write2st64_b64 v101, v[128:129], v[176:177] offset0:4 offset1:16
    v_cvt_pk_bf16_f32 v181, v182, v183
    v_cvt_pk_bf16_f32 v229, v230, v231
    s_waitcnt lgkmcnt(2)
    buffer_store_dwordx4 v[60:63], v6, s[16:19], s88 offen offset:0 nt
    v_pk_mul_f32 v[52:53], v[52:53], v[8:9] op_sel_hi:[1,0]
    ds_write2st64_b64 v92, v[132:133], v[180:181] offset0:4 offset1:16
    v_cvt_pk_bf16_f32 v189, v190, v191
    v_cvt_pk_bf16_f32 v52, v52, v53
    v_pk_mul_f32 v[244:245], v[244:245], v[50:51] op_sel_hi:[1,0]
    ds_write2st64_b64 v93, v[136:137], v[184:185] offset0:4 offset1:16
    ds_write2st64_b64 v94, v[140:141], v[188:189] offset0:4 offset1:16
    ds_read_b128 v[68:71], v103 offset:2048
    v_cvt_pk_bf16_f32 v225, v226, v227
    ds_read_b128 v[72:75], v103 offset:3072
    v_cvt_pk_bf16_f32 v56, v56, v57
    s_waitcnt lgkmcnt(5)
    buffer_store_dwordx4 v[64:67], v7, s[16:19], s88 offen offset:0 nt
    v_cvt_pk_bf16_f32 v233, v234, v235
    v_accvgpr_read_b32 v104, a16
    v_pk_mul_f32 v[54:55], v[54:55], v[8:9] op_sel_hi:[1,0]
    v_pk_mul_f32 v[104:105], v[104:105], v[8:9] op_sel_hi:[1,0]
    v_pk_mul_f32 v[148:149], v[148:149], v[48:49] op_sel_hi:[1,0]
    v_cvt_pk_bf16_f32 v104, v104, v105
    ds_read_b128 v[76:79], v103 offset:8192
    v_pk_mul_f32 v[252:253], v[252:253], v[50:51] op_sel_hi:[1,0]
    v_accvgpr_read_b32 v108, a20
    ds_read_b128 v[80:83], v103 offset:9216
    v_cvt_pk_bf16_f32 v105, v106, v107
    v_cvt_pk_bf16_f32 v144, v144, v145
    v_cvt_pk_bf16_f32 v200, v200, v201
    v_pk_mul_f32 v[206:207], v[206:207], v[102:103] op_sel_hi:[1,0]
    v_cvt_pk_bf16_f32 v148, v148, v149
    v_accvgpr_read_b32 v107, a67
    v_cvt_pk_bf16_f32 v157, v158, v159
    v_pk_mul_f32 v[108:109], v[108:109], v[8:9] op_sel_hi:[1,0]
    v_cvt_pk_bf16_f32 v57, v58, v59
    v_cvt_pk_bf16_f32 v237, v238, v239
    s_waitcnt lgkmcnt(3)
    buffer_store_dwordx4 v[68:71], v6, s[16:19], s84 offen offset:128 nt
    v_cvt_pk_bf16_f32 v244, v244, v245
    ds_write2st64_b64 v101, v[224:225], v[104:105] offset0:28 offset1:40
    v_cvt_pk_bf16_f32 v108, v108, v109
    v_accvgpr_read_b32 v104, a64
    v_accvgpr_read_b32 v105, a65
    v_pk_mul_f32 v[250:251], v[250:251], v[50:51] op_sel_hi:[1,0]
    v_cvt_pk_bf16_f32 v53, v54, v55
    v_pk_mul_f32 v[150:151], v[150:151], v[48:49] op_sel_hi:[1,0]
    v_cvt_pk_bf16_f32 v109, v110, v111
    ds_write2st64_b64 v92, v[228:229], v[108:109] offset0:28 offset1:40
    v_pk_mul_f32 v[154:155], v[154:155], v[48:49] op_sel_hi:[1,0]
    s_waitcnt lgkmcnt(2)
    buffer_store_dwordx4 v[72:75], v7, s[16:19], s84 offen offset:128 nt
    v_pk_mul_f32 v[104:105], v[104:105], v[100:101] op_sel_hi:[1,0]
    v_accvgpr_read_b32 v59, a79
    ds_write2st64_b64 v93, v[232:233], v[52:53] offset0:28 offset1:40
    v_accvgpr_read_b32 v110, a70
    ds_write2st64_b64 v94, v[236:237], v[56:57] offset0:28 offset1:40
    ds_read_b128 v[84:87], v103 offset:14336
    v_accvgpr_read_b32 v56, a76
    v_accvgpr_read_b32 v111, a71
    v_pk_mul_f32 v[146:147], v[146:147], v[48:49] op_sel_hi:[1,0]
    v_accvgpr_read_b32 v108, a68
    v_accvgpr_read_b32 v55, a75
    v_cvt_pk_bf16_f32 v248, v248, v249
    v_accvgpr_read_b32 v54, a74
    buffer_store_dwordx4 v[76:79], v6, s[16:19], s85 offen offset:128 nt
    v_accvgpr_read_b32 v106, a66
    v_accvgpr_read_b32 v58, a78
    v_accvgpr_read_b32 v109, a69
    v_cvt_pk_bf16_f32 v104, v104, v105
    v_pk_mul_f32 v[54:55], v[54:55], v[100:101] op_sel_hi:[1,0]
    ds_read_b128 v[88:91], v103 offset:15360
    v_pk_mul_f32 v[108:109], v[108:109], v[100:101] op_sel_hi:[1,0]
    v_accvgpr_read_b32 v57, a77
    v_accvgpr_read_b32 v53, a73
    buffer_store_dwordx4 v[80:83], v7, s[16:19], s85 offen offset:128 nt
    ds_read_b128 v[60:63], v103 offset:20480
    v_pk_mul_f32 v[56:57], v[56:57], v[100:101] op_sel_hi:[1,0]
    v_pk_mul_f32 v[58:59], v[58:59], v[100:101] op_sel_hi:[1,0]
    v_pk_mul_f32 v[106:107], v[106:107], v[100:101] op_sel_hi:[1,0]
    v_cvt_pk_bf16_f32 v193, v194, v195
    v_cvt_pk_bf16_f32 v205, v206, v207
    v_accvgpr_read_b32 v52, a72
    v_cvt_pk_bf16_f32 v56, v56, v57
    v_pk_mul_f32 v[246:247], v[246:247], v[50:51] op_sel_hi:[1,0]
    ds_read_b128 v[64:67], v103 offset:21504
    s_waitcnt lgkmcnt(2)
    buffer_store_dwordx4 v[84:87], v6, s[16:19], s86 offen offset:128 nt
    v_pk_mul_f32 v[110:111], v[110:111], v[100:101] op_sel_hi:[1,0]
    v_cvt_pk_bf16_f32 v245, v246, v247
    v_cvt_pk_bf16_f32 v149, v150, v151
    v_cvt_pk_bf16_f32 v108, v108, v109
    v_cvt_pk_bf16_f32 v105, v106, v107
    v_pk_mul_f32 v[52:53], v[52:53], v[100:101] op_sel_hi:[1,0]
    ds_write_b64 v101, v[104:105] offset:26624
    v_pk_mul_f32 v[198:199], v[198:199], v[102:103] op_sel_hi:[1,0]
    v_cvt_pk_bf16_f32 v109, v110, v111
    ds_write_b64 v92, v[108:109] offset:26624
    v_accvgpr_read_b32 v110, a38
    v_cvt_pk_bf16_f32 v57, v58, v59
    v_cvt_pk_bf16_f32 v52, v52, v53
    v_accvgpr_read_b32 v111, a39
    v_cvt_pk_bf16_f32 v53, v54, v55
    buffer_store_dwordx4 v[88:91], v7, s[16:19], s86 offen offset:128 nt
    v_accvgpr_read_b32 v106, a34
    v_cvt_pk_bf16_f32 v197, v198, v199
    v_pk_mul_f32 v[110:111], v[110:111], v[8:9] op_sel_hi:[1,0]
    ds_write_b64 v93, v[52:53] offset:26624
    v_accvgpr_read_b32 v108, a36
    v_accvgpr_read_b32 v52, a40
    ds_write_b64 v94, v[56:57] offset:26624
    v_cvt_pk_bf16_f32 v145, v146, v147
    v_accvgpr_read_b32 v57, a45
    v_accvgpr_read_b32 v109, a37
    s_waitcnt lgkmcnt(2)
    buffer_store_dwordx4 v[60:63], v6, s[16:19], s87 offen offset:128 nt
    v_accvgpr_read_b32 v55, a43
    v_cvt_pk_bf16_f32 v201, v202, v203
    v_pk_mul_f32 v[108:109], v[108:109], v[8:9] op_sel_hi:[1,0]
    v_accvgpr_read_b32 v104, a32
    v_accvgpr_read_b32 v56, a44
    ds_read_b128 v[68:71], v103 offset:26624
    v_accvgpr_read_b32 v53, a41
    v_accvgpr_read_b32 v107, a35
    v_accvgpr_read_b32 v59, a47
    ds_read_b128 v[72:75], v103 offset:27648
    v_pk_mul_f32 v[106:107], v[106:107], v[8:9] op_sel_hi:[1,0]
    v_cvt_pk_bf16_f32 v108, v108, v109
    v_pk_mul_f32 v[52:53], v[52:53], v[8:9] op_sel_hi:[1,0]
    v_accvgpr_read_b32 v105, a33
    v_cvt_pk_bf16_f32 v52, v52, v53
    v_cvt_pk_bf16_f32 v241, v242, v243
    buffer_store_dwordx4 v[64:67], v7, s[16:19], s87 offen offset:128 nt
    ds_write2st64_b64 v101, v[144:145], v[192:193] offset0:8 offset1:20
    v_pk_mul_f32 v[104:105], v[104:105], v[8:9] op_sel_hi:[1,0]
    v_accvgpr_read_b32 v54, a42
    v_cvt_pk_bf16_f32 v104, v104, v105
    v_cvt_pk_bf16_f32 v153, v154, v155
    ds_write2st64_b64 v92, v[148:149], v[196:197] offset0:8 offset1:20
    v_cvt_pk_bf16_f32 v252, v252, v253
    ds_write2st64_b64 v93, v[152:153], v[200:201] offset0:8 offset1:20
    v_pk_mul_f32 v[54:55], v[54:55], v[8:9] op_sel_hi:[1,0]
    s_nop 0
    v_cvt_pk_bf16_f32 v53, v54, v55
    s_waitcnt lgkmcnt(3)
    buffer_store_dwordx4 v[68:71], v6, s[16:19], s88 offen offset:128 nt
    ds_write2st64_b64 v94, v[156:157], v[204:205] offset0:8 offset1:20
    v_pk_mul_f32 v[56:57], v[56:57], v[8:9] op_sel_hi:[1,0]
    ds_read_b128 v[76:79], v103 offset:4096
    v_cvt_pk_bf16_f32 v105, v106, v107
    ds_read_b128 v[80:83], v103 offset:5120
    ds_read_b128 v[84:87], v103 offset:10240
    v_accvgpr_read_b32 v54, a90
    v_cvt_pk_bf16_f32 v109, v110, v111
    buffer_store_dwordx4 v[72:75], v7, s[16:19], s88 offen offset:128 nt
    v_cvt_pk_bf16_f32 v56, v56, v57
    v_accvgpr_read_b32 v58, a46
    v_accvgpr_read_b32 v111, a87
    ds_read_b128 v[88:91], v103 offset:11264
    ds_write2st64_b64 v101, v[240:241], v[104:105] offset0:32 offset1:44
    v_pk_mul_f32 v[58:59], v[58:59], v[8:9] op_sel_hi:[1,0]
    ds_write2st64_b64 v92, v[244:245], v[108:109] offset0:32 offset1:44
    s_waitcnt lgkmcnt(3)
    buffer_store_dwordx4 v[76:79], v6, s[16:19], s84 offen offset:256 nt
    v_cvt_pk_bf16_f32 v57, v58, v59
    v_accvgpr_read_b32 v110, a86
    buffer_store_dwordx4 v[80:83], v7, s[16:19], s84 offen offset:256 nt
    v_accvgpr_read_b32 v108, a84
    v_cvt_pk_bf16_f32 v249, v250, v251
    v_accvgpr_read_b32 v109, a85
    v_accvgpr_read_b32 v104, a80
    v_pk_mul_f32 v[110:111], v[110:111], v[100:101] op_sel_hi:[1,0]
    v_accvgpr_read_b32 v105, a81
    v_pk_mul_f32 v[108:109], v[108:109], v[100:101] op_sel_hi:[1,0]
    v_pk_mul_f32 v[104:105], v[104:105], v[100:101] op_sel_hi:[1,0]
    buffer_store_dwordx4 v[84:87], v6, s[16:19], s85 offen offset:256 nt
    v_accvgpr_read_b32 v106, a82
    v_pk_mul_f32 v[254:255], v[254:255], v[50:51] op_sel_hi:[1,0]
    s_nop 0
    v_cvt_pk_bf16_f32 v253, v254, v255
    ds_write2st64_b64 v93, v[248:249], v[52:53] offset0:32 offset1:44
    v_accvgpr_read_b32 v52, a88
    ds_write2st64_b64 v94, v[252:253], v[56:57] offset0:32 offset1:44
    ds_read_b128 v[60:63], v103 offset:16384
    s_waitcnt lgkmcnt(3)
    buffer_store_dwordx4 v[88:91], v7, s[16:19], s85 offen offset:256 nt
    ds_read_b128 v[64:67], v103 offset:17408
    v_cvt_pk_bf16_f32 v104, v104, v105
    v_accvgpr_read_b32 v107, a83
    v_cvt_pk_bf16_f32 v108, v108, v109
    s_waitcnt lgkmcnt(1)
    buffer_store_dwordx4 v[60:63], v6, s[16:19], s86 offen offset:256 nt
    v_accvgpr_read_b32 v53, a89
    ds_read_b128 v[68:71], v103 offset:22528
    v_accvgpr_read_b32 v59, a95
    v_pk_mul_f32 v[106:107], v[106:107], v[100:101] op_sel_hi:[1,0]
    v_accvgpr_read_b32 v55, a91
    v_pk_mul_f32 v[52:53], v[52:53], v[100:101] op_sel_hi:[1,0]
    ds_read_b128 v[72:75], v103 offset:23552
    v_pk_mul_f32 v[54:55], v[54:55], v[100:101] op_sel_hi:[1,0]
    v_accvgpr_read_b32 v57, a93
    v_accvgpr_read_b32 v56, a92
    v_cvt_pk_bf16_f32 v109, v110, v111
    v_cvt_pk_bf16_f32 v105, v106, v107
    v_pk_mul_f32 v[56:57], v[56:57], v[100:101] op_sel_hi:[1,0]
    ds_write_b64 v101, v[104:105] offset:0
    s_waitcnt lgkmcnt(3)
    buffer_store_dwordx4 v[64:67], v7, s[16:19], s86 offen offset:256 nt
    v_cvt_pk_bf16_f32 v52, v52, v53
    v_cvt_pk_bf16_f32 v56, v56, v57
    ds_write_b64 v92, v[108:109] offset:0
    s_waitcnt lgkmcnt(3)
    buffer_store_dwordx4 v[68:71], v6, s[16:19], s87 offen offset:256 nt
    v_cvt_pk_bf16_f32 v53, v54, v55
    v_accvgpr_read_b32 v58, a94
    ds_write_b64 v93, v[52:53] offset:0
    v_pk_mul_f32 v[58:59], v[58:59], v[100:101] op_sel_hi:[1,0]
    s_nop 0
    v_cvt_pk_bf16_f32 v57, v58, v59
    ds_write_b64 v94, v[56:57] offset:0
    ds_read_b128 v[76:79], v103 offset:0
    ds_read_b128 v[80:83], v103 offset:1024
    s_waitcnt lgkmcnt(4)
    buffer_store_dwordx4 v[72:75], v7, s[16:19], s87 offen offset:256 nt
    s_waitcnt lgkmcnt(1)
    buffer_store_dwordx4 v[76:79], v6, s[16:19], s88 offen offset:256 nt
    s_waitcnt lgkmcnt(0)
    buffer_store_dwordx4 v[80:83], v7, s[16:19], s88 offen offset:256 nt
    s_branch L_fin
L_end4:
    s_waitcnt lgkmcnt(6)
    v_mfma_f32_16x16x32_bf16 v[112:115], a[212:215], v[16:19], v[112:115]
    ds_read_b128 v[96:99], v103 offset:1024
    v_mfma_f32_16x16x32_bf16 v[160:163], a[212:215], v[22:25], v[160:163]
    ds_read_b64_tr_b16 a[230:231], v2 offset:13312
    v_fma_f32 v67, v67, s28, v10
    v_mfma_f32_16x16x32_bf16 v[208:211], a[212:215], v[28:31], v[208:211]
    v_fma_f32 v64, v64, s28, v10
    v_fma_f32 v57, v57, s28, v9
    v_mfma_f32_16x16x32_bf16 a[0:3], a[212:215], v[34:37], a[0:3]
    ds_read_b128 v[88:91], v103 offset:0
    s_waitcnt lgkmcnt(7)
    v_mfma_f32_16x16x32_bf16 a[4:7], a[216:219], v[34:37], a[4:7]
    v_fma_f32 v76, v76, s28, v12
    v_mfma_f32_16x16x32_bf16 v[212:215], a[216:219], v[28:31], v[212:215]
    ds_read_b64_tr_b16 a[228:229], v2 offset:19456
    v_fma_f32 v68, v68, s28, v11
    v_mfma_f32_16x16x32_bf16 v[164:167], a[216:219], v[22:25], v[164:167]
    v_fma_f32 v63, v63, s28, v10
    v_fma_f32 v71, v71, s28, v11
    v_mfma_f32_16x16x32_bf16 v[116:119], a[216:219], v[16:19], v[116:119]
    ds_read_b64_tr_b16 a[234:235], v3 offset:13312
    s_waitcnt lgkmcnt(7)
    v_mfma_f32_16x16x32_bf16 v[120:123], a[220:223], v[16:19], v[120:123]
    ds_read_b64_tr_b16 a[214:215], v4 offset:13312
    v_fma_f32 v65, v65, s28, v10
    v_mfma_f32_16x16x32_bf16 v[168:171], a[220:223], v[22:25], v[168:171]
    ds_read_b64_tr_b16 a[232:233], v3 offset:19456
    v_mfma_f32_16x16x32_bf16 v[216:219], a[220:223], v[28:31], v[216:219]
    v_exp_f32 v68, v68
    v_mfma_f32_16x16x32_bf16 a[8:11], a[220:223], v[34:37], a[8:11]
    s_waitcnt lgkmcnt(5)
    ds_read_b64_tr_b16 a[222:223], v2 offset:14336
    v_mfma_f32_16x16x32_bf16 a[12:15], a[224:227], v[34:37], a[12:15]
    ds_read_b64_tr_b16 a[218:219], v5 offset:13312
    v_fma_f32 v69, v69, s28, v11
    v_mfma_f32_16x16x32_bf16 v[220:223], a[224:227], v[28:31], v[220:223]
    ds_read_b64_tr_b16 a[212:213], v4 offset:19456
    v_fma_f32 v66, v66, s28, v10
    v_mfma_f32_16x16x32_bf16 v[172:175], a[224:227], v[22:25], v[172:175]
    ds_read_b64_tr_b16 a[220:221], v2 offset:20480
    v_fma_f32 v74, v74, s28, v11
    v_mfma_f32_16x16x32_bf16 v[124:127], a[224:227], v[16:19], v[124:127]
    s_waitcnt lgkmcnt(7)
    ds_read_b64_tr_b16 a[226:227], v3 offset:14336
    v_fma_f32 v80, v80, s28, v12
    v_mfma_f32_16x16x32_bf16 v[128:131], a[228:231], v[16:19], v[128:131]
    ds_read_b64_tr_b16 a[216:217], v5 offset:19456
    v_fma_f32 v58, v58, s28, v9
    v_mfma_f32_16x16x32_bf16 v[176:179], a[228:231], v[22:25], v[176:179]
    ds_read_b64_tr_b16 a[224:225], v3 offset:20480
    v_fma_f32 v77, v77, s28, v12
    v_mfma_f32_16x16x32_bf16 v[224:227], a[228:231], v[28:31], v[224:227]
    v_exp_f32 v76, v76
    v_mfma_f32_16x16x32_bf16 a[16:19], a[228:231], v[34:37], a[16:19]
    s_waitcnt lgkmcnt(7)
    ds_read_b64_tr_b16 a[228:229], v4 offset:20480
    v_mfma_f32_16x16x32_bf16 a[20:23], a[232:235], v[34:37], a[20:23]
    ds_read_b64_tr_b16 a[230:231], v4 offset:14336
    v_fma_f32 v81, v81, s28, v12
    v_mfma_f32_16x16x32_bf16 v[228:231], a[232:235], v[28:31], v[228:231]
    v_exp_f32 v63, v63
    v_mfma_f32_16x16x32_bf16 v[180:183], a[232:235], v[22:25], v[180:183]
    v_exp_f32 v67, v67
    v_mfma_f32_16x16x32_bf16 v[132:135], a[232:235], v[16:19], v[132:135]
    s_waitcnt lgkmcnt(6)
    ds_read_b64_tr_b16 a[232:233], v5 offset:20480
    v_fma_f32 v56, v56, s28, v9
    v_mfma_f32_16x16x32_bf16 v[136:139], a[212:215], v[16:19], v[136:139]
    ds_read_b64_tr_b16 a[234:235], v5 offset:14336
    v_fma_f32 v62, v62, s28, v10
    v_mfma_f32_16x16x32_bf16 v[184:187], a[212:215], v[22:25], v[184:187]
    v_fma_f32 v59, v59, s28, v9
    v_mfma_f32_16x16x32_bf16 v[232:235], a[212:215], v[28:31], v[232:235]
    v_exp_f32 v69, v69
    v_mfma_f32_16x16x32_bf16 a[24:27], a[212:215], v[34:37], a[24:27]
    s_waitcnt lgkmcnt(4)
    v_exp_f32 v62, v62
    v_mfma_f32_16x16x32_bf16 a[28:31], a[216:219], v[34:37], a[28:31]
    v_fma_f32 v78, v78, s28, v12
    v_cvt_pk_bf16_f32 v21, v62, v63
    v_mfma_f32_16x16x32_bf16 v[236:239], a[216:219], v[28:31], v[236:239]
    v_exp_f32 v71, v71
    v_mfma_f32_16x16x32_bf16 v[188:191], a[216:219], v[22:25], v[188:191]
    v_exp_f32 v65, v65
    v_mfma_f32_16x16x32_bf16 v[140:143], a[216:219], v[16:19], v[140:143]
    v_fma_f32 v79, v79, s28, v12
    v_fma_f32 v70, v70, s28, v11
    v_mfma_f32_16x16x32_bf16 v[144:147], a[220:223], v[16:19], v[144:147]
    v_exp_f32 v70, v70
    v_mfma_f32_16x16x32_bf16 v[192:195], a[220:223], v[22:25], v[192:195]
    s_add_u32 s39, s39, 12288
    s_waitcnt vmcnt(10) lgkmcnt(0)
    v_mfma_f32_16x16x32_bf16 v[240:243], a[220:223], v[28:31], v[240:243]
    s_barrier
    v_mfma_f32_16x16x32_bf16 a[32:35], a[220:223], v[34:37], a[32:35]
    v_exp_f32 v78, v78
    v_mfma_f32_16x16x32_bf16 a[36:39], a[224:227], v[34:37], a[36:39]
    s_add_u32 m0, s22, 36864
    ds_read_b128 a[212:215], v0 offset:12288
    v_fma_f32 v82, v82, s28, v12
    v_mfma_f32_16x16x32_bf16 v[244:247], a[224:227], v[28:31], v[244:247]
    buffer_load_dwordx4 v6, s[8:11], s21 offen lds
    v_mfma_f32_16x16x32_bf16 v[196:199], a[224:227], v[22:25], v[196:199]
    ds_read_b128 a[216:219], v1 offset:12288
    v_mfma_f32_16x16x32_bf16 v[148:151], a[224:227], v[16:19], v[148:151]
    s_add_u32 s21, s21, 128
    ds_read_b128 a[220:223], v0 offset:13312
    s_add_u32 m0, s22, 37888
    v_mfma_f32_16x16x32_bf16 v[152:155], a[228:231], v[16:19], v[152:155]
    buffer_load_dwordx4 v6, s[8:11], s21 offen lds
    v_mfma_f32_16x16x32_bf16 v[200:203], a[228:231], v[22:25], v[200:203]
    s_add_u32 s21, s21, 128
    v_fma_f32 v83, v83, s28, v12
    v_mfma_f32_16x16x32_bf16 v[248:251], a[228:231], v[28:31], v[248:251]
    v_exp_f32 v80, v80
    v_mfma_f32_16x16x32_bf16 a[40:43], a[228:231], v[34:37], a[40:43]
    s_add_u32 m0, s22, 38912
    v_exp_f32 v79, v79
    v_mfma_f32_16x16x32_bf16 a[44:47], a[232:235], v[34:37], a[44:47]
    buffer_load_dwordx4 v6, s[8:11], s21 offen lds
    v_mfma_f32_16x16x32_bf16 v[252:255], a[232:235], v[28:31], v[252:255]
    v_fma_f32 v73, v73, s28, v11
    v_mfma_f32_16x16x32_bf16 v[204:207], a[232:235], v[22:25], v[204:207]
    ds_read_b128 a[228:231], v0 offset:14336
    v_mfma_f32_16x16x32_bf16 v[156:159], a[232:235], v[16:19], v[156:159]
    s_waitcnt lgkmcnt(3)
    ds_read_b128 a[224:227], v1 offset:13312
    v_cvt_pk_bf16_f32 v27, v70, v71
    v_mfma_f32_16x16x32_bf16 v[52:55], a[212:215], a[96:99], 0
    s_waitcnt lgkmcnt(3)
    v_exp_f32 v56, v56
    v_mfma_f32_16x16x32_bf16 v[52:55], a[216:219], a[100:103], v[52:55]
    s_waitcnt lgkmcnt(2)
    v_exp_f32 v77, v77
    v_mfma_f32_16x16x32_bf16 v[52:55], a[220:223], a[104:107], v[52:55]
    v_exp_f32 v59, v59
    v_mfma_f32_16x16x32_bf16 v[60:63], a[220:223], a[128:131], 0
    v_cvt_pk_bf16_f32 v26, v68, v69
    v_cvt_pk_bf16_f32 v32, v76, v77
    v_mfma_f32_16x16x32_bf16 v[60:63], a[216:219], a[124:127], v[60:63]
    ds_read_b128 a[232:235], v1 offset:14336
    v_mfma_f32_16x16x32_bf16 v[60:63], a[212:215], a[120:123], v[60:63]
    v_exp_f32 v64, v64
    v_mfma_f32_16x16x32_bf16 v[68:71], a[212:215], a[144:147], 0
    ds_read_b128 v[84:87], v103 offset:2048
    v_fma_f32 v75, v75, s28, v11
    v_mfma_f32_16x16x32_bf16 v[68:71], a[216:219], a[148:151], v[68:71]
    buffer_store_dwordx4 v[88:91], v6, s[16:19], s24 offen offset:0 nt
    v_exp_f32 v58, v58
    v_cvt_pk_bf16_f32 v33, v78, v79
    v_mfma_f32_16x16x32_bf16 v[68:71], a[220:223], a[152:155], v[68:71]
    v_cvt_pk_bf16_f32 v22, v64, v65
    v_fma_f32 v72, v72, s28, v11
    v_mfma_f32_16x16x32_bf16 v[76:79], a[220:223], a[176:179], 0
    v_exp_f32 v81, v81
    v_mfma_f32_16x16x32_bf16 v[76:79], a[216:219], a[172:175], v[76:79]
    v_exp_f32 v73, v73
    v_mfma_f32_16x16x32_bf16 v[76:79], a[212:215], a[168:171], v[76:79]
    s_waitcnt lgkmcnt(2)
    ds_read_b128 a[216:219], v1 offset:18432
    v_mfma_f32_16x16x32_bf16 v[76:79], a[224:227], a[180:183], v[76:79]
    v_exp_f32 v83, v83
    v_mfma_f32_16x16x32_bf16 v[76:79], a[228:231], a[184:187], v[76:79]
    s_waitcnt lgkmcnt(2)
    v_exp_f32 v75, v75
    v_mfma_f32_16x16x32_bf16 v[76:79], a[232:235], a[188:191], v[76:79]
    v_exp_f32 v66, v66
    v_mfma_f32_16x16x32_bf16 v[68:71], a[232:235], a[164:167], v[68:71]
    v_exp_f32 v57, v57
    v_mfma_f32_16x16x32_bf16 v[68:71], a[228:231], a[160:163], v[68:71]
    v_exp_f32 v72, v72
    v_mfma_f32_16x16x32_bf16 v[68:71], a[224:227], a[156:159], v[68:71]
    ds_read_b128 a[212:215], v0 offset:18432
    v_cvt_pk_bf16_f32 v17, v58, v59
    v_mfma_f32_16x16x32_bf16 v[60:63], a[224:227], a[132:135], v[60:63]
    v_exp_f32 v74, v74
    v_mfma_f32_16x16x32_bf16 v[60:63], a[228:231], a[136:139], v[60:63]
    v_cvt_pk_bf16_f32 v16, v56, v57
    v_mfma_f32_16x16x32_bf16 v[60:63], a[232:235], a[140:143], v[60:63]
    v_exp_f32 v82, v82
    v_mfma_f32_16x16x32_bf16 v[52:55], a[232:235], a[116:119], v[52:55]
    ds_read_b128 a[220:223], v0 offset:19456
    s_add_u32 s21, s21, 12032
    v_mfma_f32_16x16x32_bf16 v[52:55], a[228:231], a[112:115], v[52:55]
    v_cvt_pk_bf16_f32 v28, v72, v73
    v_cvt_pk_bf16_f32 v29, v74, v75
    v_mfma_f32_16x16x32_bf16 v[52:55], a[224:227], a[108:111], v[52:55]
    v_cvt_pk_bf16_f32 v23, v66, v67
    v_mfma_f32_16x16x32_bf16 v[44:47], a[236:239], v[14:17], v[48:51]
    ds_read_b128 a[228:231], v0 offset:20480
    v_cvt_pk_bf16_f32 v35, v82, v83
    v_mfma_f32_16x16x32_bf16 v[44:47], a[240:243], v[20:23], v[44:47]
    ds_read_b128 v[88:91], v103 offset:3072
    v_cvt_pk_bf16_f32 v34, v80, v81
    v_mfma_f32_16x16x32_bf16 v[44:47], a[244:247], v[26:29], v[44:47]
    ds_read_b128 a[232:235], v1 offset:20480
    s_add_u32 s57, s24, 128
    v_mfma_f32_16x16x32_bf16 v[44:47], a[248:251], v[32:35], v[44:47]
    s_waitcnt lgkmcnt(4)
    ds_read_b128 a[224:227], v1 offset:19456
    v_mfma_f32_16x16x32_bf16 v[56:59], a[212:215], a[96:99], 0
    buffer_store_dwordx4 v[96:99], v7, s[16:19], s24 offen offset:0 nt
    s_nop 3
    v_cmp_lt_f32 vcc, s29, v44
    v_mfma_f32_16x16x32_bf16 v[56:59], a[216:219], a[100:103], v[56:59]
    s_waitcnt lgkmcnt(4)
    v_mfma_f32_16x16x32_bf16 v[56:59], a[220:223], a[104:107], v[56:59]
    v_mfma_f32_16x16x32_bf16 v[64:67], a[220:223], a[128:131], 0
    buffer_store_dwordx4 v[84:87], v6, s[16:19], s57 offen offset:0 nt
    s_cbranch_vccnz L_rs_end4a
L_ret_end4a:
    v_fma_f32 v55, v55, s28, v9
    v_fma_f32 v60, v60, s28, v10
    v_fma_f32 v54, v54, s28, v9
    v_mfma_f32_16x16x32_bf16 v[64:67], a[216:219], a[124:127], v[64:67]
    v_exp_f32 v55, v55
    v_mfma_f32_16x16x32_bf16 v[64:67], a[212:215], a[120:123], v[64:67]
    v_exp_f32 v60, v60
    v_mfma_f32_16x16x32_bf16 v[72:75], a[212:215], a[144:147], 0
    v_fma_f32 v61, v61, s28, v10
    s_waitcnt vmcnt(9) lgkmcnt(0)
    v_mfma_f32_16x16x32_bf16 v[72:75], a[216:219], a[148:151], v[72:75]
    s_barrier
    v_mfma_f32_16x16x32_bf16 v[72:75], a[220:223], a[152:155], v[72:75]
    v_fma_f32 v52, v52, s28, v9
    v_mfma_f32_16x16x32_bf16 v[80:83], a[220:223], a[176:179], 0
    v_mfma_f32_16x16x32_bf16 v[80:83], a[216:219], a[172:175], v[80:83]
    v_exp_f32 v54, v54
    v_mfma_f32_16x16x32_bf16 v[80:83], a[212:215], a[168:171], v[80:83]
    ds_read_b64_tr_b16 a[212:213], v2 offset:0
    v_mfma_f32_16x16x32_bf16 v[80:83], a[224:227], a[180:183], v[80:83]
    v_exp_f32 v52, v52
    v_mfma_f32_16x16x32_bf16 v[80:83], a[228:231], a[184:187], v[80:83]
    ds_read_b64_tr_b16 a[214:215], v2 offset:6144
    v_mfma_f32_16x16x32_bf16 v[80:83], a[232:235], a[188:191], v[80:83]
    ds_read_b64_tr_b16 a[216:217], v3 offset:0
    v_mfma_f32_16x16x32_bf16 v[72:75], a[232:235], a[164:167], v[72:75]
    v_cvt_pk_bf16_f32 v19, v54, v55
    v_mfma_f32_16x16x32_bf16 v[72:75], a[228:231], a[160:163], v[72:75]
    v_mfma_f32_16x16x32_bf16 v[72:75], a[224:227], a[156:159], v[72:75]
    v_exp_f32 v61, v61
    v_mfma_f32_16x16x32_bf16 v[64:67], a[224:227], a[132:135], v[64:67]
    ds_read_b64_tr_b16 a[218:219], v3 offset:6144
    v_fma_f32 v53, v53, s28, v9
    v_mfma_f32_16x16x32_bf16 v[64:67], a[228:231], a[136:139], v[64:67]
    ds_read_b64_tr_b16 a[220:221], v4 offset:0
    v_mfma_f32_16x16x32_bf16 v[64:67], a[232:235], a[140:143], v[64:67]
    ds_read_b64_tr_b16 a[222:223], v4 offset:6144
    v_mfma_f32_16x16x32_bf16 v[56:59], a[232:235], a[116:119], v[56:59]
    v_exp_f32 v53, v53
    v_mfma_f32_16x16x32_bf16 v[56:59], a[228:231], a[112:115], v[56:59]
    buffer_store_dwordx4 v[88:91], v7, s[16:19], s57 offen offset:0 nt
    v_cvt_pk_bf16_f32 v18, v52, v53
    v_cvt_pk_bf16_f32 v24, v60, v61
    v_mfma_f32_16x16x32_bf16 v[56:59], a[224:227], a[108:111], v[56:59]
    ds_read_b64_tr_b16 a[224:225], v5 offset:0
    ds_read_b64_tr_b16 a[226:227], v5 offset:6144
    s_waitcnt lgkmcnt(6)
    v_mfma_f32_16x16x32_bf16 v[112:115], a[212:215], v[14:17], v[112:115]
    v_fma_f32 v78, v78, s28, v12
    v_fma_f32 v63, v63, s28, v10
    v_fma_f32 v67, v67, s28, v10
    v_mfma_f32_16x16x32_bf16 v[160:163], a[212:215], v[20:23], v[160:163]
    v_fma_f32 v80, v80, s28, v12
    v_fma_f32 v56, v56, s28, v9
    v_fma_f32 v77, v77, s28, v12
    v_mfma_f32_16x16x32_bf16 v[208:211], a[212:215], v[26:29], v[208:211]
    s_add_u32 s39, s39, 12288
    ds_read_b64_tr_b16 a[228:229], v2 offset:1024
    v_fma_f32 v66, v66, s28, v10
    v_mfma_f32_16x16x32_bf16 a[0:3], a[212:215], v[32:35], a[0:3]
    s_waitcnt lgkmcnt(5)
    ds_read_b64_tr_b16 a[230:231], v2 offset:7168
    v_fma_f32 v62, v62, s28, v10
    v_mfma_f32_16x16x32_bf16 a[4:7], a[216:219], v[32:35], a[4:7]
    ds_read_b64_tr_b16 a[232:233], v3 offset:1024
    v_fma_f32 v64, v64, s28, v10
    v_mfma_f32_16x16x32_bf16 v[212:215], a[216:219], v[26:29], v[212:215]
    s_waitcnt vmcnt(4)
    v_exp_f32 v66, v66
    v_mfma_f32_16x16x32_bf16 v[164:167], a[216:219], v[20:23], v[164:167]
    v_fma_f32 v73, v73, s28, v11
    v_fma_f32 v69, v69, s28, v11
    v_mfma_f32_16x16x32_bf16 v[116:119], a[216:219], v[14:17], v[116:119]
    s_waitcnt lgkmcnt(5)
    ds_read_b64_tr_b16 a[234:235], v3 offset:7168
    v_fma_f32 v71, v71, s28, v11
    v_mfma_f32_16x16x32_bf16 v[120:123], a[220:223], v[14:17], v[120:123]
    s_barrier
    v_mfma_f32_16x16x32_bf16 v[168:171], a[220:223], v[20:23], v[168:171]
    ds_read_b64_tr_b16 a[218:219], v5 offset:7168
    v_fma_f32 v72, v72, s28, v11
    v_mfma_f32_16x16x32_bf16 v[216:219], a[220:223], v[26:29], v[216:219]
    v_exp_f32 v77, v77
    v_mfma_f32_16x16x32_bf16 a[8:11], a[220:223], v[32:35], a[8:11]
    s_waitcnt lgkmcnt(5)
    ds_read_b64_tr_b16 a[212:213], v4 offset:1024
    v_fma_f32 v70, v70, s28, v11
    v_mfma_f32_16x16x32_bf16 a[12:15], a[224:227], v[32:35], a[12:15]
    v_exp_f32 v69, v69
    v_mfma_f32_16x16x32_bf16 v[220:223], a[224:227], v[26:29], v[220:223]
    ds_read_b64_tr_b16 a[214:215], v4 offset:7168
    v_fma_f32 v75, v75, s28, v11
    v_mfma_f32_16x16x32_bf16 v[172:175], a[224:227], v[20:23], v[172:175]
    ds_read_b64_tr_b16 a[216:217], v5 offset:1024
    v_fma_f32 v83, v83, s28, v12
    v_fma_f32 v76, v76, s28, v12
    v_mfma_f32_16x16x32_bf16 v[124:127], a[224:227], v[14:17], v[124:127]
    s_waitcnt lgkmcnt(5)
    v_exp_f32 v71, v71
    v_mfma_f32_16x16x32_bf16 v[128:131], a[228:231], v[14:17], v[128:131]
    ds_read_b64_tr_b16 a[220:221], v2 offset:2048
    v_fma_f32 v81, v81, s28, v12
    v_mfma_f32_16x16x32_bf16 v[176:179], a[228:231], v[20:23], v[176:179]
    v_fma_f32 v65, v65, s28, v10
    v_fma_f32 v74, v74, s28, v11
    v_mfma_f32_16x16x32_bf16 v[224:227], a[228:231], v[26:29], v[224:227]
    ds_read_b64_tr_b16 a[222:223], v2 offset:8192
    v_fma_f32 v82, v82, s28, v12
    v_fma_f32 v79, v79, s28, v12
    v_mfma_f32_16x16x32_bf16 a[16:19], a[228:231], v[32:35], a[16:19]
    s_waitcnt lgkmcnt(5)
    v_exp_f32 v73, v73
    v_mfma_f32_16x16x32_bf16 a[20:23], a[232:235], v[32:35], a[20:23]
    v_exp_f32 v64, v64
    v_mfma_f32_16x16x32_bf16 v[228:231], a[232:235], v[26:29], v[228:231]
    v_exp_f32 v70, v70
    v_mfma_f32_16x16x32_bf16 v[180:183], a[232:235], v[20:23], v[180:183]
    v_exp_f32 v56, v56
    v_mfma_f32_16x16x32_bf16 v[132:135], a[232:235], v[14:17], v[132:135]
    s_waitcnt lgkmcnt(3)
    v_exp_f32 v76, v76
    v_mfma_f32_16x16x32_bf16 v[136:139], a[212:215], v[14:17], v[136:139]
    ds_read_b64_tr_b16 a[234:235], v5 offset:8192
    v_exp_f32 v81, v81
    v_mfma_f32_16x16x32_bf16 v[184:187], a[212:215], v[20:23], v[184:187]
    ds_read_b64_tr_b16 a[224:225], v3 offset:2048
    v_fma_f32 v59, v59, s28, v9
    v_mfma_f32_16x16x32_bf16 v[232:235], a[212:215], v[26:29], v[232:235]
    ds_read_b64_tr_b16 a[226:227], v3 offset:8192
    v_fma_f32 v58, v58, s28, v9
    v_mfma_f32_16x16x32_bf16 a[24:27], a[212:215], v[32:35], a[24:27]
    s_waitcnt lgkmcnt(4)
    v_exp_f32 v67, v67
    v_mfma_f32_16x16x32_bf16 a[28:31], a[216:219], v[32:35], a[28:31]
    ds_read_b64_tr_b16 a[228:229], v4 offset:2048
    v_exp_f32 v80, v80
    v_mfma_f32_16x16x32_bf16 v[236:239], a[216:219], v[26:29], v[236:239]
    ds_read_b64_tr_b16 a[230:231], v4 offset:8192
    v_cvt_pk_bf16_f32 v31, v70, v71
    v_mfma_f32_16x16x32_bf16 v[188:191], a[216:219], v[20:23], v[188:191]
    ds_read_b64_tr_b16 a[232:233], v5 offset:2048
    v_exp_f32 v82, v82
    v_mfma_f32_16x16x32_bf16 v[140:143], a[216:219], v[14:17], v[140:143]
    s_waitcnt lgkmcnt(6)
    v_exp_f32 v65, v65
    v_mfma_f32_16x16x32_bf16 v[144:147], a[220:223], v[14:17], v[144:147]
    v_exp_f32 v74, v74
    v_mfma_f32_16x16x32_bf16 v[192:195], a[220:223], v[20:23], v[192:195]
    v_exp_f32 v62, v62
    v_mfma_f32_16x16x32_bf16 v[240:243], a[220:223], v[26:29], v[240:243]
    v_exp_f32 v79, v79
    v_fma_f32 v57, v57, s28, v9
    v_mfma_f32_16x16x32_bf16 a[32:35], a[220:223], v[32:35], a[32:35]
    s_waitcnt lgkmcnt(3)
    v_exp_f32 v58, v58
    v_mfma_f32_16x16x32_bf16 a[36:39], a[224:227], v[32:35], a[36:39]
    v_exp_f32 v59, v59
    v_mfma_f32_16x16x32_bf16 v[244:247], a[224:227], v[26:29], v[244:247]
    v_exp_f32 v78, v78
    v_exp_f32 v75, v75
    v_mfma_f32_16x16x32_bf16 v[196:199], a[224:227], v[20:23], v[196:199]
    v_exp_f32 v63, v63
    v_mfma_f32_16x16x32_bf16 v[148:151], a[224:227], v[14:17], v[148:151]
    s_waitcnt lgkmcnt(0)
    v_exp_f32 v57, v57
    v_mfma_f32_16x16x32_bf16 v[152:155], a[228:231], v[14:17], v[152:155]
    v_exp_f32 v72, v72
    v_mfma_f32_16x16x32_bf16 v[200:203], a[228:231], v[20:23], v[200:203]
    ds_read_b64_tr_b16 a[212:213], v2 offset:18432
    v_fma_f32 v68, v68, s28, v11
    v_mfma_f32_16x16x32_bf16 v[248:251], a[228:231], v[26:29], v[248:251]
    ds_read_b64_tr_b16 a[214:215], v2 offset:12288
    v_cvt_pk_bf16_f32 v25, v62, v63
    v_mfma_f32_16x16x32_bf16 a[40:43], a[228:231], v[32:35], a[40:43]
    v_exp_f32 v83, v83
    v_mfma_f32_16x16x32_bf16 a[44:47], a[232:235], v[32:35], a[44:47]
    ds_read_b64_tr_b16 a[216:217], v3 offset:18432
    v_cvt_pk_bf16_f32 v37, v78, v79
    v_mfma_f32_16x16x32_bf16 v[252:255], a[232:235], v[26:29], v[252:255]
    v_exp_f32 v68, v68
    v_mfma_f32_16x16x32_bf16 v[204:207], a[232:235], v[20:23], v[204:207]
    ds_read_b64_tr_b16 a[218:219], v3 offset:12288
    v_cvt_pk_bf16_f32 v22, v64, v65
    v_cvt_pk_bf16_f32 v29, v74, v75
    v_cvt_pk_bf16_f32 v36, v76, v77
    v_cvt_pk_bf16_f32 v28, v72, v73
    v_mfma_f32_16x16x32_bf16 v[156:159], a[232:235], v[14:17], v[156:159]
    v_cvt_pk_bf16_f32 v17, v58, v59
    v_cvt_pk_bf16_f32 v16, v56, v57
    v_cvt_pk_bf16_f32 v30, v68, v69
    v_cvt_pk_bf16_f32 v23, v66, v67
    v_mfma_f32_16x16x32_bf16 v[48:51], a[236:239], v[16:19], v[44:47]
    ds_read_b64_tr_b16 a[220:221], v4 offset:18432
    v_cvt_pk_bf16_f32 v35, v82, v83
    v_mfma_f32_16x16x32_bf16 v[48:51], a[240:243], v[22:25], v[48:51]
    ds_read_b64_tr_b16 a[222:223], v4 offset:12288
    v_cvt_pk_bf16_f32 v34, v80, v81
    v_mfma_f32_16x16x32_bf16 v[48:51], a[244:247], v[28:31], v[48:51]
    ds_read_b64_tr_b16 a[224:225], v5 offset:18432
    v_mfma_f32_16x16x32_bf16 v[48:51], a[248:251], v[34:37], v[48:51]
    ds_read_b64_tr_b16 a[226:227], v5 offset:12288
    s_nop 6
    v_cmp_lt_f32 vcc, s29, v48
    s_nop 4
    s_cbranch_vccnz L_rs_end4b
L_ret_end4b:
    v_mov_b32 v100, v48
    v_and_b32 v101, 0x3ff, v0
    v_rcp_f32 v50, v50
    v_lshrrev_b32 v108, 11, v0
    v_xor_b32 v108, s65, v108
    v_lshl_add_u32 v101, v108, 10, v101
    v_mbcnt_lo_u32_b32 v108, -1, 0
    v_mbcnt_hi_u32_b32 v108, -1, v108
    v_add_u32 v101, s38, v101
    v_lshrrev_b32 v108, 1, v108
    v_and_b32 v108, 24, v108
    v_permlane32_swap_b32 v48, v100
    v_rcp_f32 v8, v51
    v_bfe_u32 v108, s66, v108, 8
    v_rcp_f32 v102, v49
    v_rcp_f32 v48, v48
    v_xor_b32 v101, v101, v108
    s_waitcnt lgkmcnt(6)
    v_mfma_f32_16x16x32_bf16 v[112:115], a[212:215], v[16:19], v[112:115]
    v_mfma_f32_16x16x32_bf16 v[160:163], a[212:215], v[22:25], v[160:163]
    v_mfma_f32_16x16x32_bf16 v[208:211], a[212:215], v[28:31], v[208:211]
    ds_read_b64_tr_b16 a[230:231], v2 offset:13312
    v_mfma_f32_16x16x32_bf16 a[0:3], a[212:215], v[34:37], a[0:3]
    ds_read_b64_tr_b16 a[234:235], v3 offset:13312
    s_waitcnt lgkmcnt(6)
    v_mfma_f32_16x16x32_bf16 a[4:7], a[216:219], v[34:37], a[4:7]
    ds_read_b64_tr_b16 a[228:229], v2 offset:19456
    v_xor_b32 v93, 64, v101
    v_mfma_f32_16x16x32_bf16 v[212:215], a[216:219], v[28:31], v[212:215]
    v_mfma_f32_16x16x32_bf16 v[164:167], a[216:219], v[22:25], v[164:167]
    ds_read_b64_tr_b16 a[212:213], v4 offset:19456
    v_mfma_f32_16x16x32_bf16 v[116:119], a[216:219], v[16:19], v[116:119]
    s_waitcnt lgkmcnt(6)
    v_mfma_f32_16x16x32_bf16 v[120:123], a[220:223], v[16:19], v[120:123]
    ds_read_b64_tr_b16 a[214:215], v4 offset:13312
    v_mfma_f32_16x16x32_bf16 v[168:171], a[220:223], v[22:25], v[168:171]
    ds_read_b64_tr_b16 a[232:233], v3 offset:19456
    s_add_u32 s84, s34, 0
    v_mfma_f32_16x16x32_bf16 v[216:219], a[220:223], v[28:31], v[216:219]
    v_accvgpr_read_b32 v109, a5
    v_mfma_f32_16x16x32_bf16 a[8:11], a[220:223], v[34:37], a[8:11]
    s_waitcnt lgkmcnt(6)
    ds_read_b64_tr_b16 a[220:221], v2 offset:20480
    v_xor_b32 v94, 96, v101
    v_mfma_f32_16x16x32_bf16 a[12:15], a[224:227], v[34:37], a[12:15]
    ds_read_b64_tr_b16 a[216:217], v5 offset:19456
    v_mfma_f32_16x16x32_bf16 v[220:223], a[224:227], v[28:31], v[220:223]
    ds_read_b64_tr_b16 a[218:219], v5 offset:13312
    v_mfma_f32_16x16x32_bf16 v[172:175], a[224:227], v[22:25], v[172:175]
    v_accvgpr_read_b32 v108, a4
    v_mfma_f32_16x16x32_bf16 v[124:127], a[224:227], v[16:19], v[124:127]
    s_waitcnt lgkmcnt(6)
    v_accvgpr_read_b32 v111, a7
    v_mfma_f32_16x16x32_bf16 v[128:131], a[228:231], v[16:19], v[128:131]
    s_add_u32 s85, s34, 6144
    v_mfma_f32_16x16x32_bf16 v[176:179], a[228:231], v[22:25], v[176:179]
    v_accvgpr_read_b32 v106, a2
    v_accvgpr_read_b32 v56, a12
    v_mfma_f32_16x16x32_bf16 v[224:227], a[228:231], v[28:31], v[224:227]
    v_accvgpr_read_b32 v104, a0
    v_mfma_f32_16x16x32_bf16 a[16:19], a[228:231], v[34:37], a[16:19]
    s_waitcnt lgkmcnt(3)
    ds_read_b64_tr_b16 a[224:225], v3 offset:20480
    v_mfma_f32_16x16x32_bf16 a[20:23], a[232:235], v[34:37], a[20:23]
    ds_read_b64_tr_b16 a[228:229], v4 offset:20480
    s_add_u32 s86, s34, 12288
    v_mfma_f32_16x16x32_bf16 v[228:231], a[232:235], v[28:31], v[228:231]
    ds_read_b64_tr_b16 a[230:231], v4 offset:14336
    v_accvgpr_read_b32 v53, a9
    v_mfma_f32_16x16x32_bf16 v[180:183], a[232:235], v[22:25], v[180:183]
    ds_read_b64_tr_b16 a[222:223], v2 offset:14336
    v_xor_b32 v92, 32, v101
    v_mfma_f32_16x16x32_bf16 v[132:135], a[232:235], v[16:19], v[132:135]
    ds_read_b64_tr_b16 a[226:227], v3 offset:14336
    v_mfma_f32_16x16x32_bf16 v[136:139], a[212:215], v[16:19], v[136:139]
    v_accvgpr_read_b32 v105, a1
    v_accvgpr_read_b32 v110, a6
    v_subrev_u32 v103, 24576, v103
    v_pk_mul_f32 v[118:119], v[118:119], v[48:49] op_sel_hi:[1,0]
    v_pk_mul_f32 v[216:217], v[216:217], v[50:51] op_sel_hi:[1,0]
    v_pk_mul_f32 v[174:175], v[174:175], v[102:103] op_sel_hi:[1,0]
    v_pk_mul_f32 v[116:117], v[116:117], v[48:49] op_sel_hi:[1,0]
    v_pk_mul_f32 v[222:223], v[222:223], v[50:51] op_sel_hi:[1,0]
    v_pk_mul_f32 v[120:121], v[120:121], v[48:49] op_sel_hi:[1,0]
    v_pk_mul_f32 v[166:167], v[166:167], v[102:103] op_sel_hi:[1,0]
    v_pk_mul_f32 v[122:123], v[122:123], v[48:49] op_sel_hi:[1,0]
    v_pk_mul_f32 v[160:161], v[160:161], v[102:103] op_sel_hi:[1,0]
    v_pk_mul_f32 v[126:127], v[126:127], v[48:49] op_sel_hi:[1,0]
    v_pk_mul_f32 v[168:169], v[168:169], v[102:103] op_sel_hi:[1,0]
    v_pk_mul_f32 v[208:209], v[208:209], v[50:51] op_sel_hi:[1,0]
    v_pk_mul_f32 v[112:113], v[112:113], v[48:49] op_sel_hi:[1,0]
    v_pk_mul_f32 v[220:221], v[220:221], v[50:51] op_sel_hi:[1,0]
    v_pk_mul_f32 v[114:115], v[114:115], v[48:49] op_sel_hi:[1,0]
    v_pk_mul_f32 v[224:225], v[224:225], v[50:51] op_sel_hi:[1,0]
    v_pk_mul_f32 v[162:163], v[162:163], v[102:103] op_sel_hi:[1,0]
    v_pk_mul_f32 v[108:109], v[108:109], v[8:9] op_sel_hi:[1,0]
    v_pk_mul_f32 v[124:125], v[124:125], v[48:49] op_sel_hi:[1,0]
    v_pk_mul_f32 v[170:171], v[170:171], v[102:103] op_sel_hi:[1,0]
    v_pk_mul_f32 v[164:165], v[164:165], v[102:103] op_sel_hi:[1,0]
    v_pk_mul_f32 v[172:173], v[172:173], v[102:103] op_sel_hi:[1,0]
    v_pk_mul_f32 v[182:183], v[182:183], v[102:103] op_sel_hi:[1,0]
    v_cvt_pk_bf16_f32 v160, v160, v161
    v_cvt_pk_bf16_f32 v124, v124, v125
    v_mfma_f32_16x16x32_bf16 v[184:187], a[212:215], v[22:25], v[184:187]
    v_cvt_pk_bf16_f32 v112, v112, v113
    v_cvt_pk_bf16_f32 v116, v116, v117
    v_mfma_f32_16x16x32_bf16 v[232:235], a[212:215], v[28:31], v[232:235]
    ds_read_b64_tr_b16 a[234:235], v5 offset:14336
    v_cvt_pk_bf16_f32 v120, v120, v121
    v_mfma_f32_16x16x32_bf16 a[24:27], a[212:215], v[34:37], a[24:27]
    s_waitcnt lgkmcnt(1)
    v_cvt_pk_bf16_f32 v208, v208, v209
    v_cvt_pk_bf16_f32 v168, v168, v169
    v_mfma_f32_16x16x32_bf16 a[28:31], a[216:219], v[34:37], a[28:31]
    ds_read_b64_tr_b16 a[232:233], v5 offset:20480
    v_cvt_pk_bf16_f32 v164, v164, v165
    v_mfma_f32_16x16x32_bf16 v[236:239], a[216:219], v[28:31], v[236:239]
    v_cvt_pk_bf16_f32 v113, v114, v115
    v_cvt_pk_bf16_f32 v117, v118, v119
    v_mfma_f32_16x16x32_bf16 v[188:191], a[216:219], v[22:25], v[188:191]
    v_cvt_pk_bf16_f32 v165, v166, v167
    v_cvt_pk_bf16_f32 v169, v170, v171
    v_mfma_f32_16x16x32_bf16 v[140:143], a[216:219], v[16:19], v[140:143]
    v_cvt_pk_bf16_f32 v161, v162, v163
    v_cvt_pk_bf16_f32 v121, v122, v123
    v_mfma_f32_16x16x32_bf16 v[144:147], a[220:223], v[16:19], v[144:147]
    ds_write2st64_b64 v101, v[112:113], v[160:161] offset0:0 offset1:12
    v_mfma_f32_16x16x32_bf16 v[192:195], a[220:223], v[22:25], v[192:195]
    v_cvt_pk_bf16_f32 v125, v126, v127
    v_cvt_pk_bf16_f32 v172, v172, v173
    v_mfma_f32_16x16x32_bf16 v[240:243], a[220:223], v[28:31], v[240:243]
    ds_write2st64_b64 v92, v[116:117], v[164:165] offset0:0 offset1:12
    v_mfma_f32_16x16x32_bf16 a[32:35], a[220:223], v[34:37], a[32:35]
    ds_write2st64_b64 v93, v[120:121], v[168:169] offset0:0 offset1:12
    v_mfma_f32_16x16x32_bf16 a[36:39], a[224:227], v[34:37], a[36:39]
    v_cvt_pk_bf16_f32 v173, v174, v175
    s_add_u32 s87, s34, 18432
    v_mfma_f32_16x16x32_bf16 v[244:247], a[224:227], v[28:31], v[244:247]
    ds_write2st64_b64 v94, v[124:125], v[172:173] offset0:0 offset1:12
    v_mfma_f32_16x16x32_bf16 v[196:199], a[224:227], v[22:25], v[196:199]
    ds_read_b128 v[80:83], v103 offset:0
    s_add_u32 s18, s34, 24576
    v_mfma_f32_16x16x32_bf16 v[148:151], a[224:227], v[16:19], v[148:151]
    v_accvgpr_read_b32 v57, a13
    v_cvt_pk_bf16_f32 v108, v108, v109
    v_mfma_f32_16x16x32_bf16 v[152:155], a[228:231], v[16:19], v[152:155]
    v_accvgpr_read_b32 v58, a14
    v_accvgpr_read_b32 v54, a10
    v_mfma_f32_16x16x32_bf16 v[200:203], a[228:231], v[22:25], v[200:203]
    v_mfma_f32_16x16x32_bf16 v[248:251], a[228:231], v[28:31], v[248:251]
    v_accvgpr_read_b32 v55, a11
    ds_read_b128 v[84:87], v103 offset:1024
    v_cvt_pk_bf16_f32 v216, v216, v217
    v_pk_mul_f32 v[128:129], v[128:129], v[48:49] op_sel_hi:[1,0]
    v_pk_mul_f32 v[196:197], v[196:197], v[102:103] op_sel_hi:[1,0]
    v_pk_mul_f32 v[214:215], v[214:215], v[50:51] op_sel_hi:[1,0]
    v_pk_mul_f32 v[188:189], v[188:189], v[102:103] op_sel_hi:[1,0]
    v_pk_mul_f32 v[104:105], v[104:105], v[8:9] op_sel_hi:[1,0]
    v_accvgpr_read_b32 v107, a3
    v_accvgpr_read_b32 v59, a15
    v_mfma_f32_16x16x32_bf16 a[40:43], a[228:231], v[34:37], a[40:43]
    s_waitcnt lgkmcnt(3)
    ds_read_b128 v[88:91], v103 offset:6144
    v_mfma_f32_16x16x32_bf16 a[44:47], a[232:235], v[34:37], a[44:47]
    v_cvt_pk_bf16_f32 v220, v220, v221
    v_cvt_pk_bf16_f32 v104, v104, v105
    v_mfma_f32_16x16x32_bf16 v[252:255], a[232:235], v[28:31], v[252:255]
    s_waitcnt lgkmcnt(2)
    buffer_store_dwordx4 v[80:83], v6, s[16:19], s84 offen offset:0 nt
    v_pk_mul_f32 v[210:211], v[210:211], v[50:51] op_sel_hi:[1,0]
    v_pk_mul_f32 v[184:185], v[184:185], v[102:103] op_sel_hi:[1,0]
    v_pk_mul_f32 v[192:193], v[192:193], v[102:103] op_sel_hi:[1,0]
    v_pk_mul_f32 v[218:219], v[218:219], v[50:51] op_sel_hi:[1,0]
    v_accvgpr_read_b32 v52, a8
    v_pk_mul_f32 v[212:213], v[212:213], v[50:51] op_sel_hi:[1,0]
    v_pk_mul_f32 v[176:177], v[176:177], v[102:103] op_sel_hi:[1,0]
    v_cvt_pk_bf16_f32 v212, v212, v213
    v_pk_mul_f32 v[154:155], v[154:155], v[48:49] op_sel_hi:[1,0]
    v_pk_mul_f32 v[240:241], v[240:241], v[50:51] op_sel_hi:[1,0]
    v_pk_mul_f32 v[136:137], v[136:137], v[48:49] op_sel_hi:[1,0]
    v_pk_mul_f32 v[146:147], v[146:147], v[48:49] op_sel_hi:[1,0]
    v_pk_mul_f32 v[106:107], v[106:107], v[8:9] op_sel_hi:[1,0]
    v_pk_mul_f32 v[152:153], v[152:153], v[48:49] op_sel_hi:[1,0]
    ds_read_b128 v[60:63], v103 offset:7168
    v_pk_mul_f32 v[52:53], v[52:53], v[8:9] op_sel_hi:[1,0]
    v_cvt_pk_bf16_f32 v209, v210, v211
    v_pk_mul_f32 v[180:181], v[180:181], v[102:103] op_sel_hi:[1,0]
    v_pk_mul_f32 v[58:59], v[58:59], v[8:9] op_sel_hi:[1,0]
    v_pk_mul_f32 v[56:57], v[56:57], v[8:9] op_sel_hi:[1,0]
    v_cvt_pk_bf16_f32 v221, v222, v223
    v_cvt_pk_bf16_f32 v192, v192, v193
    v_mfma_f32_16x16x32_bf16 v[204:207], a[232:235], v[22:25], v[204:207]
    v_mfma_f32_16x16x32_bf16 v[156:159], a[232:235], v[16:19], v[156:159]
    s_waitcnt lgkmcnt(1)
    buffer_store_dwordx4 v[84:87], v7, s[16:19], s84 offen offset:0 nt
    v_pk_mul_f32 v[252:253], v[252:253], v[50:51] op_sel_hi:[1,0]
    v_pk_mul_f32 v[250:251], v[250:251], v[50:51] op_sel_hi:[1,0]
    v_cvt_pk_bf16_f32 v56, v56, v57
    v_pk_mul_f32 v[110:111], v[110:111], v[8:9] op_sel_hi:[1,0]
    v_cvt_pk_bf16_f32 v105, v106, v107
    v_pk_mul_f32 v[144:145], v[144:145], v[48:49] op_sel_hi:[1,0]
    v_cvt_pk_bf16_f32 v109, v110, v111
    v_cvt_pk_bf16_f32 v176, v176, v177
    v_cvt_pk_bf16_f32 v52, v52, v53
    ds_write2st64_b64 v101, v[208:209], v[104:105] offset0:24 offset1:36
    v_pk_mul_f32 v[186:187], v[186:187], v[102:103] op_sel_hi:[1,0]
    v_pk_mul_f32 v[130:131], v[130:131], v[48:49] op_sel_hi:[1,0]
    v_pk_mul_f32 v[158:159], v[158:159], v[48:49] op_sel_hi:[1,0]
    v_cvt_pk_bf16_f32 v213, v214, v215
    v_cvt_pk_bf16_f32 v217, v218, v219
    ds_write2st64_b64 v92, v[212:213], v[108:109] offset0:24 offset1:36
    v_pk_mul_f32 v[232:233], v[232:233], v[50:51] op_sel_hi:[1,0]
    buffer_store_dwordx4 v[88:91], v6, s[16:19], s85 offen offset:0 nt
    v_pk_mul_f32 v[134:135], v[134:135], v[48:49] op_sel_hi:[1,0]
    v_pk_mul_f32 v[54:55], v[54:55], v[8:9] op_sel_hi:[1,0]
    v_cvt_pk_bf16_f32 v57, v58, v59
    v_cvt_pk_bf16_f32 v53, v54, v55
    v_accvgpr_read_b32 v55, a27
    v_cvt_pk_bf16_f32 v128, v128, v129
    v_cvt_pk_bf16_f32 v136, v136, v137
    v_pk_mul_f32 v[190:191], v[190:191], v[102:103] op_sel_hi:[1,0]
    v_accvgpr_read_b32 v109, a21
    v_pk_mul_f32 v[178:179], v[178:179], v[102:103] op_sel_hi:[1,0]
    ds_write2st64_b64 v93, v[216:217], v[52:53] offset0:24 offset1:36
    ds_write2st64_b64 v94, v[220:221], v[56:57] offset0:24 offset1:36
    ds_read_b128 v[64:67], v103 offset:12288
    v_accvgpr_read_b32 v106, a18
    v_accvgpr_read_b32 v110, a22
    v_pk_mul_f32 v[132:133], v[132:133], v[48:49] op_sel_hi:[1,0]
    s_waitcnt lgkmcnt(3)
    buffer_store_dwordx4 v[60:63], v7, s[16:19], s85 offen offset:0 nt
    ds_read_b128 v[68:71], v103 offset:13312
    v_accvgpr_read_b32 v54, a26
    v_pk_mul_f32 v[228:229], v[228:229], v[50:51] op_sel_hi:[1,0]
    v_cvt_pk_bf16_f32 v188, v188, v189
    v_cvt_pk_bf16_f32 v184, v184, v185
    v_cvt_pk_bf16_f32 v240, v240, v241
    v_pk_mul_f32 v[142:143], v[142:143], v[48:49] op_sel_hi:[1,0]
    v_cvt_pk_bf16_f32 v228, v228, v229
    v_accvgpr_read_b32 v52, a24
    v_pk_mul_f32 v[198:199], v[198:199], v[102:103] op_sel_hi:[1,0]
    v_accvgpr_read_b32 v108, a20
    v_pk_mul_f32 v[200:201], v[200:201], v[102:103] op_sel_hi:[1,0]
    v_accvgpr_read_b32 v111, a23
    ds_read_b128 v[72:75], v103 offset:18432
    v_pk_mul_f32 v[244:245], v[244:245], v[50:51] op_sel_hi:[1,0]
    v_cvt_pk_bf16_f32 v132, v132, v133
    v_pk_mul_f32 v[140:141], v[140:141], v[48:49] op_sel_hi:[1,0]
    v_cvt_pk_bf16_f32 v133, v134, v135
    v_pk_mul_f32 v[138:139], v[138:139], v[48:49] op_sel_hi:[1,0]
    v_accvgpr_read_b32 v53, a25
    v_pk_mul_f32 v[230:231], v[230:231], v[50:51] op_sel_hi:[1,0]
    v_cvt_pk_bf16_f32 v129, v130, v131
    v_pk_mul_f32 v[54:55], v[54:55], v[8:9] op_sel_hi:[1,0]
    s_waitcnt lgkmcnt(2)
    buffer_store_dwordx4 v[64:67], v6, s[16:19], s86 offen offset:0 nt
    v_accvgpr_read_b32 v104, a16
    v_accvgpr_read_b32 v59, a31
    v_pk_mul_f32 v[226:227], v[226:227], v[50:51] op_sel_hi:[1,0]
    v_cvt_pk_bf16_f32 v224, v224, v225
    v_cvt_pk_bf16_f32 v177, v178, v179
    v_cvt_pk_bf16_f32 v140, v140, v141
    v_cvt_pk_bf16_f32 v180, v180, v181
    v_cvt_pk_bf16_f32 v152, v152, v153
    ds_read_b128 v[76:79], v103 offset:19456
    v_cvt_pk_bf16_f32 v189, v190, v191
    v_cvt_pk_bf16_f32 v232, v232, v233
    v_cvt_pk_bf16_f32 v185, v186, v187
    v_accvgpr_read_b32 v56, a28
    v_cvt_pk_bf16_f32 v137, v138, v139
    v_pk_mul_f32 v[202:203], v[202:203], v[102:103] op_sel_hi:[1,0]
    v_cvt_pk_bf16_f32 v225, v226, v227
    ds_write2st64_b64 v101, v[128:129], v[176:177] offset0:4 offset1:16
    v_pk_mul_f32 v[234:235], v[234:235], v[50:51] op_sel_hi:[1,0]
    v_cvt_pk_bf16_f32 v144, v144, v145
    v_pk_mul_f32 v[194:195], v[194:195], v[102:103] op_sel_hi:[1,0]
    v_accvgpr_read_b32 v57, a29
    s_waitcnt lgkmcnt(2)
    buffer_store_dwordx4 v[68:71], v7, s[16:19], s86 offen offset:0 nt
    v_accvgpr_read_b32 v105, a17
    v_cvt_pk_bf16_f32 v141, v142, v143
    v_cvt_pk_bf16_f32 v181, v182, v183
    v_pk_mul_f32 v[108:109], v[108:109], v[8:9] op_sel_hi:[1,0]
    v_cvt_pk_bf16_f32 v196, v196, v197
    v_pk_mul_f32 v[206:207], v[206:207], v[102:103] op_sel_hi:[1,0]
    ds_write2st64_b64 v92, v[132:133], v[180:181] offset0:4 offset1:16
    v_pk_mul_f32 v[52:53], v[52:53], v[8:9] op_sel_hi:[1,0]
    v_cvt_pk_bf16_f32 v108, v108, v109
    v_pk_mul_f32 v[150:151], v[150:151], v[48:49] op_sel_hi:[1,0]
    v_accvgpr_read_b32 v107, a19
    v_pk_mul_f32 v[238:239], v[238:239], v[50:51] op_sel_hi:[1,0]
    v_pk_mul_f32 v[156:157], v[156:157], v[48:49] op_sel_hi:[1,0]
    v_pk_mul_f32 v[104:105], v[104:105], v[8:9] op_sel_hi:[1,0]
    ds_write2st64_b64 v93, v[136:137], v[184:185] offset0:4 offset1:16
    buffer_store_dwordx4 v[72:75], v6, s[16:19], s87 offen offset:0 nt
    ds_write2st64_b64 v94, v[140:141], v[188:189] offset0:4 offset1:16
    v_pk_mul_f32 v[106:107], v[106:107], v[8:9] op_sel_hi:[1,0]
    v_pk_mul_f32 v[56:57], v[56:57], v[8:9] op_sel_hi:[1,0]
    v_pk_mul_f32 v[236:237], v[236:237], v[50:51] op_sel_hi:[1,0]
    v_accvgpr_read_b32 v58, a30
    v_cvt_pk_bf16_f32 v56, v56, v57
    v_cvt_pk_bf16_f32 v229, v230, v231
    v_cvt_pk_bf16_f32 v104, v104, v105
    ds_read_b128 v[80:83], v103 offset:2048
    v_cvt_pk_bf16_f32 v105, v106, v107
    v_pk_mul_f32 v[148:149], v[148:149], v[48:49] op_sel_hi:[1,0]
    v_cvt_pk_bf16_f32 v52, v52, v53
    ds_read_b128 v[84:87], v103 offset:3072
    v_cvt_pk_bf16_f32 v156, v156, v157
    v_pk_mul_f32 v[246:247], v[246:247], v[50:51] op_sel_hi:[1,0]
    s_waitcnt lgkmcnt(4)
    buffer_store_dwordx4 v[76:79], v7, s[16:19], s87 offen offset:0 nt
    ds_read_b128 v[88:91], v103 offset:8192
    v_cvt_pk_bf16_f32 v148, v148, v149
    v_cvt_pk_bf16_f32 v236, v236, v237
    ds_read_b128 v[60:63], v103 offset:9216
    v_cvt_pk_bf16_f32 v157, v158, v159
    v_cvt_pk_bf16_f32 v233, v234, v235
    v_cvt_pk_bf16_f32 v153, v154, v155
    v_cvt_pk_bf16_f32 v53, v54, v55
    s_waitcnt lgkmcnt(3)
    buffer_store_dwordx4 v[80:83], v6, s[16:19], s84 offen offset:128 nt
    v_pk_mul_f32 v[110:111], v[110:111], v[8:9] op_sel_hi:[1,0]
    ds_write2st64_b64 v101, v[224:225], v[104:105] offset0:28 offset1:40
    v_pk_mul_f32 v[204:205], v[204:205], v[102:103] op_sel_hi:[1,0]
    v_accvgpr_read_b32 v106, a34
    v_pk_mul_f32 v[248:249], v[248:249], v[50:51] op_sel_hi:[1,0]
    v_cvt_pk_bf16_f32 v244, v244, v245
    v_cvt_pk_bf16_f32 v109, v110, v111
    s_waitcnt lgkmcnt(1)
    buffer_store_dwordx4 v[84:87], v7, s[16:19], s84 offen offset:128 nt
    v_pk_mul_f32 v[58:59], v[58:59], v[8:9] op_sel_hi:[1,0]
    v_cvt_pk_bf16_f32 v237, v238, v239
    ds_write2st64_b64 v92, v[228:229], v[108:109] offset0:28 offset1:40
    v_accvgpr_read_b32 v107, a35
    v_cvt_pk_bf16_f32 v145, v146, v147
    ds_write2st64_b64 v93, v[232:233], v[52:53] offset0:28 offset1:40
    v_cvt_pk_bf16_f32 v57, v58, v59
    buffer_store_dwordx4 v[88:91], v6, s[16:19], s85 offen offset:128 nt
    ds_write2st64_b64 v94, v[236:237], v[56:57] offset0:28 offset1:40
    v_pk_mul_f32 v[254:255], v[254:255], v[50:51] op_sel_hi:[1,0]
    v_accvgpr_read_b32 v55, a43
    v_accvgpr_read_b32 v56, a44
    ds_read_b128 v[64:67], v103 offset:14336
    v_accvgpr_read_b32 v57, a45
    v_cvt_pk_bf16_f32 v204, v204, v205
    v_pk_mul_f32 v[56:57], v[56:57], v[8:9] op_sel_hi:[1,0]
    v_accvgpr_read_b32 v52, a40
    v_cvt_pk_bf16_f32 v149, v150, v151
    v_cvt_pk_bf16_f32 v193, v194, v195
    buffer_store_dwordx4 v[60:63], v7, s[16:19], s85 offen offset:128 nt
    v_accvgpr_read_b32 v54, a42
    v_cvt_pk_bf16_f32 v252, v252, v253
    ds_read_b128 v[68:71], v103 offset:15360
    v_pk_mul_f32 v[242:243], v[242:243], v[50:51] op_sel_hi:[1,0]
    v_accvgpr_read_b32 v108, a36
    v_cvt_pk_bf16_f32 v197, v198, v199
    v_pk_mul_f32 v[106:107], v[106:107], v[8:9] op_sel_hi:[1,0]
    ds_read_b128 v[72:75], v103 offset:20480
    v_cvt_pk_bf16_f32 v248, v248, v249
    v_cvt_pk_bf16_f32 v249, v250, v251
    v_accvgpr_read_b32 v53, a41
    v_cvt_pk_bf16_f32 v205, v206, v207
    v_accvgpr_read_b32 v111, a39
    s_waitcnt lgkmcnt(2)
    buffer_store_dwordx4 v[64:67], v6, s[16:19], s86 offen offset:128 nt
    v_accvgpr_read_b32 v104, a32
    ds_read_b128 v[76:79], v103 offset:21504
    ds_write2st64_b64 v101, v[144:145], v[192:193] offset0:8 offset1:20
    v_cvt_pk_bf16_f32 v200, v200, v201
    v_cvt_pk_bf16_f32 v241, v242, v243
    v_accvgpr_read_b32 v105, a33
    v_cvt_pk_bf16_f32 v201, v202, v203
    ds_write2st64_b64 v92, v[148:149], v[196:197] offset0:8 offset1:20
    s_waitcnt lgkmcnt(3)
    buffer_store_dwordx4 v[68:71], v7, s[16:19], s86 offen offset:128 nt
    v_accvgpr_read_b32 v110, a38
    v_pk_mul_f32 v[104:105], v[104:105], v[8:9] op_sel_hi:[1,0]
    v_accvgpr_read_b32 v59, a47
    v_pk_mul_f32 v[110:111], v[110:111], v[8:9] op_sel_hi:[1,0]
    buffer_store_dwordx4 v[72:75], v6, s[16:19], s87 offen offset:128 nt
    v_cvt_pk_bf16_f32 v104, v104, v105
    ds_write2st64_b64 v93, v[152:153], v[200:201] offset0:8 offset1:20
    v_cvt_pk_bf16_f32 v253, v254, v255
    v_cvt_pk_bf16_f32 v245, v246, v247
    v_pk_mul_f32 v[54:55], v[54:55], v[8:9] op_sel_hi:[1,0]
    v_cvt_pk_bf16_f32 v56, v56, v57
    v_accvgpr_read_b32 v58, a46
    v_pk_mul_f32 v[58:59], v[58:59], v[8:9] op_sel_hi:[1,0]
    v_accvgpr_read_b32 v109, a37
    v_pk_mul_f32 v[108:109], v[108:109], v[8:9] op_sel_hi:[1,0]
    ds_write2st64_b64 v94, v[156:157], v[204:205] offset0:8 offset1:20
    ds_read_b128 v[80:83], v103 offset:4096
    v_cvt_pk_bf16_f32 v57, v58, v59
    s_waitcnt lgkmcnt(3)
    buffer_store_dwordx4 v[76:79], v7, s[16:19], s87 offen offset:128 nt
    v_cvt_pk_bf16_f32 v105, v106, v107
    ds_read_b128 v[84:87], v103 offset:5120
    ds_read_b128 v[88:91], v103 offset:10240
    ds_read_b128 v[60:63], v103 offset:11264
    v_cvt_pk_bf16_f32 v108, v108, v109
    s_waitcnt lgkmcnt(3)
    buffer_store_dwordx4 v[80:83], v6, s[16:19], s84 offen offset:256 nt
    v_pk_mul_f32 v[52:53], v[52:53], v[8:9] op_sel_hi:[1,0]
    s_waitcnt lgkmcnt(2)
    buffer_store_dwordx4 v[84:87], v7, s[16:19], s84 offen offset:256 nt
    v_cvt_pk_bf16_f32 v109, v110, v111
    v_cvt_pk_bf16_f32 v52, v52, v53
    ds_write2st64_b64 v101, v[240:241], v[104:105] offset0:32 offset1:44
    ds_write2st64_b64 v92, v[244:245], v[108:109] offset0:32 offset1:44
    v_cvt_pk_bf16_f32 v53, v54, v55
    s_waitcnt lgkmcnt(2)
    buffer_store_dwordx4 v[88:91], v6, s[16:19], s85 offen offset:256 nt
    ds_write2st64_b64 v93, v[248:249], v[52:53] offset0:32 offset1:44
    ds_write2st64_b64 v94, v[252:253], v[56:57] offset0:32 offset1:44
    ds_read_b128 v[64:67], v103 offset:16384
    ds_read_b128 v[68:71], v103 offset:17408
    buffer_store_dwordx4 v[60:63], v7, s[16:19], s85 offen offset:256 nt
    s_waitcnt lgkmcnt(1)
    buffer_store_dwordx4 v[64:67], v6, s[16:19], s86 offen offset:256 nt
    ds_read_b128 v[72:75], v103 offset:22528
    s_waitcnt lgkmcnt(1)
    buffer_store_dwordx4 v[68:71], v7, s[16:19], s86 offen offset:256 nt
    ds_read_b128 v[76:79], v103 offset:23552
    s_waitcnt lgkmcnt(1)
    buffer_store_dwordx4 v[72:75], v6, s[16:19], s87 offen offset:256 nt
    s_waitcnt lgkmcnt(0)
    buffer_store_dwordx4 v[76:79], v7, s[16:19], s87 offen offset:256 nt
    s_branch L_fin
L_fin:
    s_waitcnt vmcnt(0)
L_end:
    s_endpgm
L_codeend:
L_rare5_0:
    s_nop 15
    v_mbcnt_lo_u32_b32 v31, -1, 0
    v_mbcnt_hi_u32_b32 v31, -1, v31
    v_and_b32 v30, 15, v31
    v_mul_u32_u24 v30, 384, v30
    v_lshrrev_b32 v31, 4, v31
    v_lshl_add_u32 v30, v31, 4, v30
    s_add_u32 s69, s39, 0
    buffer_load_dwordx4 v[44:47], v30, s[4:7], s69 offen offset:0
    s_waitcnt vmcnt(0)
    v_mfma_f32_16x16x32_bf16 v[104:107], v[44:47], a[96:99], 0
    s_nop 7
    buffer_load_dwordx4 v[44:47], v30, s[4:7], s69 offen offset:64
    s_waitcnt vmcnt(0)
    v_mfma_f32_16x16x32_bf16 v[104:107], v[44:47], a[100:103], v[104:107]
    s_nop 7
    buffer_load_dwordx4 v[44:47], v30, s[4:7], s69 offen offset:128
    s_waitcnt vmcnt(0)
    v_mfma_f32_16x16x32_bf16 v[104:107], v[44:47], a[104:107], v[104:107]
    s_nop 7
    buffer_load_dwordx4 v[44:47], v30, s[4:7], s69 offen offset:192
    s_waitcnt vmcnt(0)
    v_mfma_f32_16x16x32_bf16 v[104:107], v[44:47], a[108:111], v[104:107]
    s_nop 7
    buffer_load_dwordx4 v[44:47], v30, s[4:7], s69 offen offset:256
    s_waitcnt vmcnt(0)
    v_mfma_f32_16x16x32_bf16 v[104:107], v[44:47], a[112:115], v[104:107]
    s_nop 7
    buffer_load_dwordx4 v[44:47], v30, s[4:7], s69 offen offset:320
    s_waitcnt vmcnt(0)
    v_mfma_f32_16x16x32_bf16 v[104:107], v[44:47], a[116:119], v[104:107]
    s_nop 7
    s_add_u32 s69, s39, 6144
    buffer_load_dwordx4 v[44:47], v30, s[4:7], s69 offen offset:0
    s_waitcnt vmcnt(0)
    v_mfma_f32_16x16x32_bf16 v[108:111], v[44:47], a[96:99], 0
    s_nop 7
    buffer_load_dwordx4 v[44:47], v30, s[4:7], s69 offen offset:64
    s_waitcnt vmcnt(0)
    v_mfma_f32_16x16x32_bf16 v[108:111], v[44:47], a[100:103], v[108:111]
    s_nop 7
    buffer_load_dwordx4 v[44:47], v30, s[4:7], s69 offen offset:128
    s_waitcnt vmcnt(0)
    v_mfma_f32_16x16x32_bf16 v[108:111], v[44:47], a[104:107], v[108:111]
    s_nop 7
    buffer_load_dwordx4 v[44:47], v30, s[4:7], s69 offen offset:192
    s_waitcnt vmcnt(0)
    v_mfma_f32_16x16x32_bf16 v[108:111], v[44:47], a[108:111], v[108:111]
    s_nop 7
    buffer_load_dwordx4 v[44:47], v30, s[4:7], s69 offen offset:256
    s_waitcnt vmcnt(0)
    v_mfma_f32_16x16x32_bf16 v[108:111], v[44:47], a[112:115], v[108:111]
    s_nop 7
    buffer_load_dwordx4 v[44:47], v30, s[4:7], s69 offen offset:320
    s_waitcnt vmcnt(0)
    v_mfma_f32_16x16x32_bf16 v[108:111], v[44:47], a[116:119], v[108:111]
    s_nop 7
    s_nop 15
    v_max3_f32 v18, v104, v105, v106
    v_max3_f32 v18, v18, v107, v108
    v_max3_f32 v18, v18, v109, v110
    v_max_f32 v18, v18, v111
    v_mov_b32 v19, v18
    s_nop 1
    v_permlane32_swap_b32 v19, v18
    v_max_f32 v18, v18, v19
    v_mov_b32 v19, v18
    s_nop 1
    v_permlane16_swap_b32 v19, v18
    v_max_f32 v18, v18, v19
    v_fma_f32 v18, v18, s28, v9
    v_max_f32 v24, 0, v18
    v_sub_f32 v9, v9, v24
    v_sub_f32 v25, 0, v24
    v_exp_f32 v25, v25
    s_nop 0
    v_mul_f32 v19, v48, v25
    v_cndmask_b32_e64 v48, v19, v48, s[60:61]
    v_cndmask_b32_e64 v48, v48, 0, s[46:47]
    v_mul_f32 v112, v112, v25
    v_mul_f32 v113, v113, v25
    v_mul_f32 v114, v114, v25
    v_mul_f32 v115, v115, v25
    v_mul_f32 v116, v116, v25
    v_mul_f32 v117, v117, v25
    v_mul_f32 v118, v118, v25
    v_mul_f32 v119, v119, v25
    v_mul_f32 v120, v120, v25
    v_mul_f32 v121, v121, v25
    v_mul_f32 v122, v122, v25
    v_mul_f32 v123, v123, v25
    v_mul_f32 v124, v124, v25
    v_mul_f32 v125, v125, v25
    v_mul_f32 v126, v126, v25
    v_mul_f32 v127, v127, v25
    v_mul_f32 v128, v128, v25
    v_mul_f32 v129, v129, v25
    v_mul_f32 v130, v130, v25
    v_mul_f32 v131, v131, v25
    v_mul_f32 v132, v132, v25
    v_mul_f32 v133, v133, v25
    v_mul_f32 v134, v134, v25
    v_mul_f32 v135, v135, v25
    v_mul_f32 v136, v136, v25
    v_mul_f32 v137, v137, v25
    v_mul_f32 v138, v138, v25
    v_mul_f32 v139, v139, v25
    v_mul_f32 v140, v140, v25
    v_mul_f32 v141, v141, v25
    v_mul_f32 v142, v142, v25
    v_mul_f32 v143, v143, v25
    v_mul_f32 v144, v144, v25
    v_mul_f32 v145, v145, v25
    v_mul_f32 v146, v146, v25
    v_mul_f32 v147, v147, v25
    v_mul_f32 v148, v148, v25
    v_mul_f32 v149, v149, v25
    v_mul_f32 v150, v150, v25
    v_mul_f32 v151, v151, v25
    v_mul_f32 v152, v152, v25
    v_mul_f32 v153, v153, v25
    v_mul_f32 v154, v154, v25
    v_mul_f32 v155, v155, v25
    v_mul_f32 v156, v156, v25
    v_mul_f32 v157, v157, v25
    v_mul_f32 v158, v158, v25
    v_mul_f32 v159, v159, v25
    v_fma_f32 v104, v104, s28, v9
    v_fma_f32 v105, v105, s28, v9
    v_exp_f32 v104, v104
    v_exp_f32 v105, v105
    s_nop 0
    v_cvt_pk_bf16_f32 v14, v104, v105
    v_fma_f32 v106, v106, s28, v9
    v_fma_f32 v107, v107, s28, v9
    v_exp_f32 v106, v106
    v_exp_f32 v107, v107
    s_nop 0
    v_cvt_pk_bf16_f32 v15, v106, v107
    v_fma_f32 v108, v108, s28, v9
    v_fma_f32 v109, v109, s28, v9
    v_exp_f32 v108, v108
    v_exp_f32 v109, v109
    s_nop 0
    v_cvt_pk_bf16_f32 v16, v108, v109
    v_fma_f32 v110, v110, s28, v9
    v_fma_f32 v111, v111, s28, v9
    v_exp_f32 v110, v110
    v_exp_f32 v111, v111
    s_nop 0
    v_cvt_pk_bf16_f32 v17, v110, v111
    s_add_u32 s69, s39, 0
    buffer_load_dwordx4 v[44:47], v30, s[4:7], s69 offen offset:0
    s_waitcnt vmcnt(0)
    v_mfma_f32_16x16x32_bf16 v[104:107], v[44:47], a[120:123], 0
    s_nop 7
    buffer_load_dwordx4 v[44:47], v30, s[4:7], s69 offen offset:64
    s_waitcnt vmcnt(0)
    v_mfma_f32_16x16x32_bf16 v[104:107], v[44:47], a[124:127], v[104:107]
    s_nop 7
    buffer_load_dwordx4 v[44:47], v30, s[4:7], s69 offen offset:128
    s_waitcnt vmcnt(0)
    v_mfma_f32_16x16x32_bf16 v[104:107], v[44:47], a[128:131], v[104:107]
    s_nop 7
    buffer_load_dwordx4 v[44:47], v30, s[4:7], s69 offen offset:192
    s_waitcnt vmcnt(0)
    v_mfma_f32_16x16x32_bf16 v[104:107], v[44:47], a[132:135], v[104:107]
    s_nop 7
    buffer_load_dwordx4 v[44:47], v30, s[4:7], s69 offen offset:256
    s_waitcnt vmcnt(0)
    v_mfma_f32_16x16x32_bf16 v[104:107], v[44:47], a[136:139], v[104:107]
    s_nop 7
    buffer_load_dwordx4 v[44:47], v30, s[4:7], s69 offen offset:320
    s_waitcnt vmcnt(0)
    v_mfma_f32_16x16x32_bf16 v[104:107], v[44:47], a[140:143], v[104:107]
    s_nop 7
    s_add_u32 s69, s39, 6144
    buffer_load_dwordx4 v[44:47], v30, s[4:7], s69 offen offset:0
    s_waitcnt vmcnt(0)
    v_mfma_f32_16x16x32_bf16 v[108:111], v[44:47], a[120:123], 0
    s_nop 7
    buffer_load_dwordx4 v[44:47], v30, s[4:7], s69 offen offset:64
    s_waitcnt vmcnt(0)
    v_mfma_f32_16x16x32_bf16 v[108:111], v[44:47], a[124:127], v[108:111]
    s_nop 7
    buffer_load_dwordx4 v[44:47], v30, s[4:7], s69 offen offset:128
    s_waitcnt vmcnt(0)
    v_mfma_f32_16x16x32_bf16 v[108:111], v[44:47], a[128:131], v[108:111]
    s_nop 7
    buffer_load_dwordx4 v[44:47], v30, s[4:7], s69 offen offset:192
    s_waitcnt vmcnt(0)
    v_mfma_f32_16x16x32_bf16 v[108:111], v[44:47], a[132:135], v[108:111]
    s_nop 7
    buffer_load_dwordx4 v[44:47], v30, s[4:7], s69 offen offset:256
    s_waitcnt vmcnt(0)
    v_mfma_f32_16x16x32_bf16 v[108:111], v[44:47], a[136:139], v[108:111]
    s_nop 7
    buffer_load_dwordx4 v[44:47], v30, s[4:7], s69 offen offset:320
    s_waitcnt vmcnt(0)
    v_mfma_f32_16x16x32_bf16 v[108:111], v[44:47], a[140:143], v[108:111]
    s_nop 7
    s_nop 15
    v_max3_f32 v18, v104, v105, v106
    v_max3_f32 v18, v18, v107, v108
    v_max3_f32 v18, v18, v109, v110
    v_max_f32 v18, v18, v111
    v_mov_b32 v19, v18
    s_nop 1
    v_permlane32_swap_b32 v19, v18
    v_max_f32 v18, v18, v19
    v_mov_b32 v19, v18
    s_nop 1
    v_permlane16_swap_b32 v19, v18
    v_max_f32 v18, v18, v19
    v_fma_f32 v18, v18, s28, v10
    v_max_f32 v24, 0, v18
    v_sub_f32 v10, v10, v24
    v_sub_f32 v25, 0, v24
    v_exp_f32 v25, v25
    s_nop 0
    v_mul_f32 v49, v49, v25
    v_mul_f32 v160, v160, v25
    v_mul_f32 v161, v161, v25
    v_mul_f32 v162, v162, v25
    v_mul_f32 v163, v163, v25
    v_mul_f32 v164, v164, v25
    v_mul_f32 v165, v165, v25
    v_mul_f32 v166, v166, v25
    v_mul_f32 v167, v167, v25
    v_mul_f32 v168, v168, v25
    v_mul_f32 v169, v169, v25
    v_mul_f32 v170, v170, v25
    v_mul_f32 v171, v171, v25
    v_mul_f32 v172, v172, v25
    v_mul_f32 v173, v173, v25
    v_mul_f32 v174, v174, v25
    v_mul_f32 v175, v175, v25
    v_mul_f32 v176, v176, v25
    v_mul_f32 v177, v177, v25
    v_mul_f32 v178, v178, v25
    v_mul_f32 v179, v179, v25
    v_mul_f32 v180, v180, v25
    v_mul_f32 v181, v181, v25
    v_mul_f32 v182, v182, v25
    v_mul_f32 v183, v183, v25
    v_mul_f32 v184, v184, v25
    v_mul_f32 v185, v185, v25
    v_mul_f32 v186, v186, v25
    v_mul_f32 v187, v187, v25
    v_mul_f32 v188, v188, v25
    v_mul_f32 v189, v189, v25
    v_mul_f32 v190, v190, v25
    v_mul_f32 v191, v191, v25
    v_mul_f32 v192, v192, v25
    v_mul_f32 v193, v193, v25
    v_mul_f32 v194, v194, v25
    v_mul_f32 v195, v195, v25
    v_mul_f32 v196, v196, v25
    v_mul_f32 v197, v197, v25
    v_mul_f32 v198, v198, v25
    v_mul_f32 v199, v199, v25
    v_mul_f32 v200, v200, v25
    v_mul_f32 v201, v201, v25
    v_mul_f32 v202, v202, v25
    v_mul_f32 v203, v203, v25
    v_mul_f32 v204, v204, v25
    v_mul_f32 v205, v205, v25
    v_mul_f32 v206, v206, v25
    v_mul_f32 v207, v207, v25
    v_fma_f32 v104, v104, s28, v10
    v_fma_f32 v105, v105, s28, v10
    v_exp_f32 v104, v104
    v_exp_f32 v105, v105
    s_nop 0
    v_cvt_pk_bf16_f32 v20, v104, v105
    v_fma_f32 v106, v106, s28, v10
    v_fma_f32 v107, v107, s28, v10
    v_exp_f32 v106, v106
    v_exp_f32 v107, v107
    s_nop 0
    v_cvt_pk_bf16_f32 v21, v106, v107
    v_fma_f32 v108, v108, s28, v10
    v_fma_f32 v109, v109, s28, v10
    v_exp_f32 v108, v108
    v_exp_f32 v109, v109
    s_nop 0
    v_cvt_pk_bf16_f32 v22, v108, v109
    v_fma_f32 v110, v110, s28, v10
    v_fma_f32 v111, v111, s28, v10
    v_exp_f32 v110, v110
    v_exp_f32 v111, v111
    s_nop 0
    v_cvt_pk_bf16_f32 v23, v110, v111
    s_add_u32 s69, s39, 0
    buffer_load_dwordx4 v[44:47], v30, s[4:7], s69 offen offset:0
    s_waitcnt vmcnt(0)
    v_mfma_f32_16x16x32_bf16 v[104:107], v[44:47], a[144:147], 0
    s_nop 7
    buffer_load_dwordx4 v[44:47], v30, s[4:7], s69 offen offset:64
    s_waitcnt vmcnt(0)
    v_mfma_f32_16x16x32_bf16 v[104:107], v[44:47], a[148:151], v[104:107]
    s_nop 7
    buffer_load_dwordx4 v[44:47], v30, s[4:7], s69 offen offset:128
    s_waitcnt vmcnt(0)
    v_mfma_f32_16x16x32_bf16 v[104:107], v[44:47], a[152:155], v[104:107]
    s_nop 7
    buffer_load_dwordx4 v[44:47], v30, s[4:7], s69 offen offset:192
    s_waitcnt vmcnt(0)
    v_mfma_f32_16x16x32_bf16 v[104:107], v[44:47], a[156:159], v[104:107]
    s_nop 7
    buffer_load_dwordx4 v[44:47], v30, s[4:7], s69 offen offset:256
    s_waitcnt vmcnt(0)
    v_mfma_f32_16x16x32_bf16 v[104:107], v[44:47], a[160:163], v[104:107]
    s_nop 7
    buffer_load_dwordx4 v[44:47], v30, s[4:7], s69 offen offset:320
    s_waitcnt vmcnt(0)
    v_mfma_f32_16x16x32_bf16 v[104:107], v[44:47], a[164:167], v[104:107]
    s_nop 7
    s_add_u32 s69, s39, 6144
    buffer_load_dwordx4 v[44:47], v30, s[4:7], s69 offen offset:0
    s_waitcnt vmcnt(0)
    v_mfma_f32_16x16x32_bf16 v[108:111], v[44:47], a[144:147], 0
    s_nop 7
    buffer_load_dwordx4 v[44:47], v30, s[4:7], s69 offen offset:64
    s_waitcnt vmcnt(0)
    v_mfma_f32_16x16x32_bf16 v[108:111], v[44:47], a[148:151], v[108:111]
    s_nop 7
    buffer_load_dwordx4 v[44:47], v30, s[4:7], s69 offen offset:128
    s_waitcnt vmcnt(0)
    v_mfma_f32_16x16x32_bf16 v[108:111], v[44:47], a[152:155], v[108:111]
    s_nop 7
    buffer_load_dwordx4 v[44:47], v30, s[4:7], s69 offen offset:192
    s_waitcnt vmcnt(0)
    v_mfma_f32_16x16x32_bf16 v[108:111], v[44:47], a[156:159], v[108:111]
    s_nop 7
    buffer_load_dwordx4 v[44:47], v30, s[4:7], s69 offen offset:256
    s_waitcnt vmcnt(0)
    v_mfma_f32_16x16x32_bf16 v[108:111], v[44:47], a[160:163], v[108:111]
    s_nop 7
    buffer_load_dwordx4 v[44:47], v30, s[4:7], s69 offen offset:320
    s_waitcnt vmcnt(0)
    v_mfma_f32_16x16x32_bf16 v[108:111], v[44:47], a[164:167], v[108:111]
    s_nop 7
    s_nop 15
    v_max3_f32 v18, v104, v105, v106
    v_max3_f32 v18, v18, v107, v108
    v_max3_f32 v18, v18, v109, v110
    v_max_f32 v18, v18, v111
    v_mov_b32 v19, v18
    s_nop 1
    v_permlane32_swap_b32 v19, v18
    v_max_f32 v18, v18, v19
    v_mov_b32 v19, v18
    s_nop 1
    v_permlane16_swap_b32 v19, v18
    v_max_f32 v18, v18, v19
    v_fma_f32 v18, v18, s28, v11
    v_max_f32 v24, 0, v18
    v_sub_f32 v11, v11, v24
    v_sub_f32 v25, 0, v24
    v_exp_f32 v25, v25
    s_nop 0
    v_mul_f32 v50, v50, v25
    v_mul_f32 v208, v208, v25
    v_mul_f32 v209, v209, v25
    v_mul_f32 v210, v210, v25
    v_mul_f32 v211, v211, v25
    v_mul_f32 v212, v212, v25
    v_mul_f32 v213, v213, v25
    v_mul_f32 v214, v214, v25
    v_mul_f32 v215, v215, v25
    v_mul_f32 v216, v216, v25
    v_mul_f32 v217, v217, v25
    v_mul_f32 v218, v218, v25
    v_mul_f32 v219, v219, v25
    v_mul_f32 v220, v220, v25
    v_mul_f32 v221, v221, v25
    v_mul_f32 v222, v222, v25
    v_mul_f32 v223, v223, v25
    v_mul_f32 v224, v224, v25
    v_mul_f32 v225, v225, v25
    v_mul_f32 v226, v226, v25
    v_mul_f32 v227, v227, v25
    v_mul_f32 v228, v228, v25
    v_mul_f32 v229, v229, v25
    v_mul_f32 v230, v230, v25
    v_mul_f32 v231, v231, v25
    v_mul_f32 v232, v232, v25
    v_mul_f32 v233, v233, v25
    v_mul_f32 v234, v234, v25
    v_mul_f32 v235, v235, v25
    v_mul_f32 v236, v236, v25
    v_mul_f32 v237, v237, v25
    v_mul_f32 v238, v238, v25
    v_mul_f32 v239, v239, v25
    v_mul_f32 v240, v240, v25
    v_mul_f32 v241, v241, v25
    v_mul_f32 v242, v242, v25
    v_mul_f32 v243, v243, v25
    v_mul_f32 v244, v244, v25
    v_mul_f32 v245, v245, v25
    v_mul_f32 v246, v246, v25
    v_mul_f32 v247, v247, v25
    v_mul_f32 v248, v248, v25
    v_mul_f32 v249, v249, v25
    v_mul_f32 v250, v250, v25
    v_mul_f32 v251, v251, v25
    v_mul_f32 v252, v252, v25
    v_mul_f32 v253, v253, v25
    v_mul_f32 v254, v254, v25
    v_mul_f32 v255, v255, v25
    v_fma_f32 v104, v104, s28, v11
    v_fma_f32 v105, v105, s28, v11
    v_exp_f32 v104, v104
    v_exp_f32 v105, v105
    s_nop 0
    v_cvt_pk_bf16_f32 v26, v104, v105
    v_fma_f32 v106, v106, s28, v11
    v_fma_f32 v107, v107, s28, v11
    v_exp_f32 v106, v106
    v_exp_f32 v107, v107
    s_nop 0
    v_cvt_pk_bf16_f32 v27, v106, v107
    v_fma_f32 v108, v108, s28, v11
    v_fma_f32 v109, v109, s28, v11
    v_exp_f32 v108, v108
    v_exp_f32 v109, v109
    s_nop 0
    v_cvt_pk_bf16_f32 v28, v108, v109
    v_fma_f32 v110, v110, s28, v11
    v_fma_f32 v111, v111, s28, v11
    v_exp_f32 v110, v110
    v_exp_f32 v111, v111
    s_nop 0
    v_cvt_pk_bf16_f32 v29, v110, v111
    s_add_u32 s69, s39, 0
    buffer_load_dwordx4 v[44:47], v30, s[4:7], s69 offen offset:0
    s_waitcnt vmcnt(0)
    v_mfma_f32_16x16x32_bf16 v[104:107], v[44:47], a[168:171], 0
    s_nop 7
    buffer_load_dwordx4 v[44:47], v30, s[4:7], s69 offen offset:64
    s_waitcnt vmcnt(0)
    v_mfma_f32_16x16x32_bf16 v[104:107], v[44:47], a[172:175], v[104:107]
    s_nop 7
    buffer_load_dwordx4 v[44:47], v30, s[4:7], s69 offen offset:128
    s_waitcnt vmcnt(0)
    v_mfma_f32_16x16x32_bf16 v[104:107], v[44:47], a[176:179], v[104:107]
    s_nop 7
    buffer_load_dwordx4 v[44:47], v30, s[4:7], s69 offen offset:192
    s_waitcnt vmcnt(0)
    v_mfma_f32_16x16x32_bf16 v[104:107], v[44:47], a[180:183], v[104:107]
    s_nop 7
    buffer_load_dwordx4 v[44:47], v30, s[4:7], s69 offen offset:256
    s_waitcnt vmcnt(0)
    v_mfma_f32_16x16x32_bf16 v[104:107], v[44:47], a[184:187], v[104:107]
    s_nop 7
    buffer_load_dwordx4 v[44:47], v30, s[4:7], s69 offen offset:320
    s_waitcnt vmcnt(0)
    v_mfma_f32_16x16x32_bf16 v[104:107], v[44:47], a[188:191], v[104:107]
    s_nop 7
    s_add_u32 s69, s39, 6144
    buffer_load_dwordx4 v[44:47], v30, s[4:7], s69 offen offset:0
    s_waitcnt vmcnt(0)
    v_mfma_f32_16x16x32_bf16 v[108:111], v[44:47], a[168:171], 0
    s_nop 7
    buffer_load_dwordx4 v[44:47], v30, s[4:7], s69 offen offset:64
    s_waitcnt vmcnt(0)
    v_mfma_f32_16x16x32_bf16 v[108:111], v[44:47], a[172:175], v[108:111]
    s_nop 7
    buffer_load_dwordx4 v[44:47], v30, s[4:7], s69 offen offset:128
    s_waitcnt vmcnt(0)
    v_mfma_f32_16x16x32_bf16 v[108:111], v[44:47], a[176:179], v[108:111]
    s_nop 7
    buffer_load_dwordx4 v[44:47], v30, s[4:7], s69 offen offset:192
    s_waitcnt vmcnt(0)
    v_mfma_f32_16x16x32_bf16 v[108:111], v[44:47], a[180:183], v[108:111]
    s_nop 7
    buffer_load_dwordx4 v[44:47], v30, s[4:7], s69 offen offset:256
    s_waitcnt vmcnt(0)
    v_mfma_f32_16x16x32_bf16 v[108:111], v[44:47], a[184:187], v[108:111]
    s_nop 7
    buffer_load_dwordx4 v[44:47], v30, s[4:7], s69 offen offset:320
    s_waitcnt vmcnt(0)
    v_mfma_f32_16x16x32_bf16 v[108:111], v[44:47], a[188:191], v[108:111]
    s_nop 7
    s_nop 15
    v_max3_f32 v18, v104, v105, v106
    v_max3_f32 v18, v18, v107, v108
    v_max3_f32 v18, v18, v109, v110
    v_max_f32 v18, v18, v111
    v_mov_b32 v19, v18
    s_nop 1
    v_permlane32_swap_b32 v19, v18
    v_max_f32 v18, v18, v19
    v_mov_b32 v19, v18
    s_nop 1
    v_permlane16_swap_b32 v19, v18
    v_max_f32 v18, v18, v19
    v_fma_f32 v18, v18, s28, v12
    v_max_f32 v24, 0, v18
    v_sub_f32 v12, v12, v24
    v_sub_f32 v25, 0, v24
    v_exp_f32 v25, v25
    s_nop 0
    v_mul_f32 v51, v51, v25
    v_accvgpr_read_b32 v19, a0
    v_mul_f32 v19, v19, v25
    v_accvgpr_write_b32 a0, v19
    v_accvgpr_read_b32 v19, a1
    v_mul_f32 v19, v19, v25
    v_accvgpr_write_b32 a1, v19
    v_accvgpr_read_b32 v19, a2
    v_mul_f32 v19, v19, v25
    v_accvgpr_write_b32 a2, v19
    v_accvgpr_read_b32 v19, a3
    v_mul_f32 v19, v19, v25
    v_accvgpr_write_b32 a3, v19
    v_accvgpr_read_b32 v19, a4
    v_mul_f32 v19, v19, v25
    v_accvgpr_write_b32 a4, v19
    v_accvgpr_read_b32 v19, a5
    v_mul_f32 v19, v19, v25
    v_accvgpr_write_b32 a5, v19
    v_accvgpr_read_b32 v19, a6
    v_mul_f32 v19, v19, v25
    v_accvgpr_write_b32 a6, v19
    v_accvgpr_read_b32 v19, a7
    v_mul_f32 v19, v19, v25
    v_accvgpr_write_b32 a7, v19
    v_accvgpr_read_b32 v19, a8
    v_mul_f32 v19, v19, v25
    v_accvgpr_write_b32 a8, v19
    v_accvgpr_read_b32 v19, a9
    v_mul_f32 v19, v19, v25
    v_accvgpr_write_b32 a9, v19
    v_accvgpr_read_b32 v19, a10
    v_mul_f32 v19, v19, v25
    v_accvgpr_write_b32 a10, v19
    v_accvgpr_read_b32 v19, a11
    v_mul_f32 v19, v19, v25
    v_accvgpr_write_b32 a11, v19
    v_accvgpr_read_b32 v19, a12
    v_mul_f32 v19, v19, v25
    v_accvgpr_write_b32 a12, v19
    v_accvgpr_read_b32 v19, a13
    v_mul_f32 v19, v19, v25
    v_accvgpr_write_b32 a13, v19
    v_accvgpr_read_b32 v19, a14
    v_mul_f32 v19, v19, v25
    v_accvgpr_write_b32 a14, v19
    v_accvgpr_read_b32 v19, a15
    v_mul_f32 v19, v19, v25
    v_accvgpr_write_b32 a15, v19
    v_accvgpr_read_b32 v19, a16
    v_mul_f32 v19, v19, v25
    v_accvgpr_write_b32 a16, v19
    v_accvgpr_read_b32 v19, a17
    v_mul_f32 v19, v19, v25
    v_accvgpr_write_b32 a17, v19
    v_accvgpr_read_b32 v19, a18
    v_mul_f32 v19, v19, v25
    v_accvgpr_write_b32 a18, v19
    v_accvgpr_read_b32 v19, a19
    v_mul_f32 v19, v19, v25
    v_accvgpr_write_b32 a19, v19
    v_accvgpr_read_b32 v19, a20
    v_mul_f32 v19, v19, v25
    v_accvgpr_write_b32 a20, v19
    v_accvgpr_read_b32 v19, a21
    v_mul_f32 v19, v19, v25
    v_accvgpr_write_b32 a21, v19
    v_accvgpr_read_b32 v19, a22
    v_mul_f32 v19, v19, v25
    v_accvgpr_write_b32 a22, v19
    v_accvgpr_read_b32 v19, a23
    v_mul_f32 v19, v19, v25
    v_accvgpr_write_b32 a23, v19
    v_accvgpr_read_b32 v19, a24
    v_mul_f32 v19, v19, v25
    v_accvgpr_write_b32 a24, v19
    v_accvgpr_read_b32 v19, a25
    v_mul_f32 v19, v19, v25
    v_accvgpr_write_b32 a25, v19
    v_accvgpr_read_b32 v19, a26
    v_mul_f32 v19, v19, v25
    v_accvgpr_write_b32 a26, v19
    v_accvgpr_read_b32 v19, a27
    v_mul_f32 v19, v19, v25
    v_accvgpr_write_b32 a27, v19
    v_accvgpr_read_b32 v19, a28
    v_mul_f32 v19, v19, v25
    v_accvgpr_write_b32 a28, v19
    v_accvgpr_read_b32 v19, a29
    v_mul_f32 v19, v19, v25
    v_accvgpr_write_b32 a29, v19
    v_accvgpr_read_b32 v19, a30
    v_mul_f32 v19, v19, v25
    v_accvgpr_write_b32 a30, v19
    v_accvgpr_read_b32 v19, a31
    v_mul_f32 v19, v19, v25
    v_accvgpr_write_b32 a31, v19
    v_accvgpr_read_b32 v19, a32
    v_mul_f32 v19, v19, v25
    v_accvgpr_write_b32 a32, v19
    v_accvgpr_read_b32 v19, a33
    v_mul_f32 v19, v19, v25
    v_accvgpr_write_b32 a33, v19
    v_accvgpr_read_b32 v19, a34
    v_mul_f32 v19, v19, v25
    v_accvgpr_write_b32 a34, v19
    v_accvgpr_read_b32 v19, a35
    v_mul_f32 v19, v19, v25
    v_accvgpr_write_b32 a35, v19
    v_accvgpr_read_b32 v19, a36
    v_mul_f32 v19, v19, v25
    v_accvgpr_write_b32 a36, v19
    v_accvgpr_read_b32 v19, a37
    v_mul_f32 v19, v19, v25
    v_accvgpr_write_b32 a37, v19
    v_accvgpr_read_b32 v19, a38
    v_mul_f32 v19, v19, v25
    v_accvgpr_write_b32 a38, v19
    v_accvgpr_read_b32 v19, a39
    v_mul_f32 v19, v19, v25
    v_accvgpr_write_b32 a39, v19
    v_accvgpr_read_b32 v19, a40
    v_mul_f32 v19, v19, v25
    v_accvgpr_write_b32 a40, v19
    v_accvgpr_read_b32 v19, a41
    v_mul_f32 v19, v19, v25
    v_accvgpr_write_b32 a41, v19
    v_accvgpr_read_b32 v19, a42
    v_mul_f32 v19, v19, v25
    v_accvgpr_write_b32 a42, v19
    v_accvgpr_read_b32 v19, a43
    v_mul_f32 v19, v19, v25
    v_accvgpr_write_b32 a43, v19
    v_accvgpr_read_b32 v19, a44
    v_mul_f32 v19, v19, v25
    v_accvgpr_write_b32 a44, v19
    v_accvgpr_read_b32 v19, a45
    v_mul_f32 v19, v19, v25
    v_accvgpr_write_b32 a45, v19
    v_accvgpr_read_b32 v19, a46
    v_mul_f32 v19, v19, v25
    v_accvgpr_write_b32 a46, v19
    v_accvgpr_read_b32 v19, a47
    v_mul_f32 v19, v19, v25
    v_accvgpr_write_b32 a47, v19
    v_fma_f32 v104, v104, s28, v12
    v_fma_f32 v105, v105, s28, v12
    v_exp_f32 v104, v104
    v_exp_f32 v105, v105
    s_nop 0
    v_cvt_pk_bf16_f32 v32, v104, v105
    v_fma_f32 v106, v106, s28, v12
    v_fma_f32 v107, v107, s28, v12
    v_exp_f32 v106, v106
    v_exp_f32 v107, v107
    s_nop 0
    v_cvt_pk_bf16_f32 v33, v106, v107
    v_fma_f32 v108, v108, s28, v12
    v_fma_f32 v109, v109, s28, v12
    v_exp_f32 v108, v108
    v_exp_f32 v109, v109
    s_nop 0
    v_cvt_pk_bf16_f32 v34, v108, v109
    v_fma_f32 v110, v110, s28, v12
    v_fma_f32 v111, v111, s28, v12
    v_exp_f32 v110, v110
    v_exp_f32 v111, v111
    s_nop 0
    v_cvt_pk_bf16_f32 v35, v110, v111
    s_add_u32 s69, s39, 0
    buffer_load_dwordx4 v[44:47], v30, s[4:7], s69 offen offset:0
    s_waitcnt vmcnt(0)
    v_mfma_f32_16x16x32_bf16 v[104:107], v[44:47], a[192:195], 0
    s_nop 7
    buffer_load_dwordx4 v[44:47], v30, s[4:7], s69 offen offset:64
    s_waitcnt vmcnt(0)
    v_mfma_f32_16x16x32_bf16 v[104:107], v[44:47], a[196:199], v[104:107]
    s_nop 7
    buffer_load_dwordx4 v[44:47], v30, s[4:7], s69 offen offset:128
    s_waitcnt vmcnt(0)
    v_mfma_f32_16x16x32_bf16 v[104:107], v[44:47], a[200:203], v[104:107]
    s_nop 7
    buffer_load_dwordx4 v[44:47], v30, s[4:7], s69 offen offset:192
    s_waitcnt vmcnt(0)
    v_mfma_f32_16x16x32_bf16 v[104:107], v[44:47], a[204:207], v[104:107]
    s_nop 7
    buffer_load_dwordx4 v[44:47], v30, s[4:7], s69 offen offset:256
    s_waitcnt vmcnt(0)
    v_mfma_f32_16x16x32_bf16 v[104:107], v[44:47], a[208:211], v[104:107]
    s_nop 7
    buffer_load_dwordx4 v[44:47], v30, s[4:7], s69 offen offset:320
    s_waitcnt vmcnt(0)
    v_mfma_f32_16x16x32_bf16 v[104:107], v[44:47], v[92:95], v[104:107]
    s_nop 7
    s_add_u32 s69, s39, 6144
    buffer_load_dwordx4 v[44:47], v30, s[4:7], s69 offen offset:0
    s_waitcnt vmcnt(0)
    v_mfma_f32_16x16x32_bf16 v[108:111], v[44:47], a[192:195], 0
    s_nop 7
    buffer_load_dwordx4 v[44:47], v30, s[4:7], s69 offen offset:64
    s_waitcnt vmcnt(0)
    v_mfma_f32_16x16x32_bf16 v[108:111], v[44:47], a[196:199], v[108:111]
    s_nop 7
    buffer_load_dwordx4 v[44:47], v30, s[4:7], s69 offen offset:128
    s_waitcnt vmcnt(0)
    v_mfma_f32_16x16x32_bf16 v[108:111], v[44:47], a[200:203], v[108:111]
    s_nop 7
    buffer_load_dwordx4 v[44:47], v30, s[4:7], s69 offen offset:192
    s_waitcnt vmcnt(0)
    v_mfma_f32_16x16x32_bf16 v[108:111], v[44:47], a[204:207], v[108:111]
    s_nop 7
    buffer_load_dwordx4 v[44:47], v30, s[4:7], s69 offen offset:256
    s_waitcnt vmcnt(0)
    v_mfma_f32_16x16x32_bf16 v[108:111], v[44:47], a[208:211], v[108:111]
    s_nop 7
    buffer_load_dwordx4 v[44:47], v30, s[4:7], s69 offen offset:320
    s_waitcnt vmcnt(0)
    v_mfma_f32_16x16x32_bf16 v[108:111], v[44:47], v[92:95], v[108:111]
    s_nop 7
    s_nop 15
    v_max3_f32 v18, v104, v105, v106
    v_max3_f32 v18, v18, v107, v108
    v_max3_f32 v18, v18, v109, v110
    v_max_f32 v18, v18, v111
    v_mov_b32 v19, v18
    s_nop 1
    v_permlane32_swap_b32 v19, v18
    v_max_f32 v18, v18, v19
    v_mov_b32 v19, v18
    s_nop 1
    v_permlane16_swap_b32 v19, v18
    v_max_f32 v18, v18, v19
    v_fma_f32 v18, v18, s28, v13
    v_max_f32 v24, 0, v18
    v_sub_f32 v13, v13, v24
    v_sub_f32 v25, 0, v24
    v_exp_f32 v25, v25
    s_nop 0
    v_mul_f32 v19, v48, v25
    v_cndmask_b32_e64 v48, v48, v19, s[60:61]
    v_accvgpr_read_b32 v19, a48
    v_mul_f32 v19, v19, v25
    v_accvgpr_write_b32 a48, v19
    v_accvgpr_read_b32 v19, a49
    v_mul_f32 v19, v19, v25
    v_accvgpr_write_b32 a49, v19
    v_accvgpr_read_b32 v19, a50
    v_mul_f32 v19, v19, v25
    v_accvgpr_write_b32 a50, v19
    v_accvgpr_read_b32 v19, a51
    v_mul_f32 v19, v19, v25
    v_accvgpr_write_b32 a51, v19
    v_accvgpr_read_b32 v19, a52
    v_mul_f32 v19, v19, v25
    v_accvgpr_write_b32 a52, v19
    v_accvgpr_read_b32 v19, a53
    v_mul_f32 v19, v19, v25
    v_accvgpr_write_b32 a53, v19
    v_accvgpr_read_b32 v19, a54
    v_mul_f32 v19, v19, v25
    v_accvgpr_write_b32 a54, v19
    v_accvgpr_read_b32 v19, a55
    v_mul_f32 v19, v19, v25
    v_accvgpr_write_b32 a55, v19
    v_accvgpr_read_b32 v19, a56
    v_mul_f32 v19, v19, v25
    v_accvgpr_write_b32 a56, v19
    v_accvgpr_read_b32 v19, a57
    v_mul_f32 v19, v19, v25
    v_accvgpr_write_b32 a57, v19
    v_accvgpr_read_b32 v19, a58
    v_mul_f32 v19, v19, v25
    v_accvgpr_write_b32 a58, v19
    v_accvgpr_read_b32 v19, a59
    v_mul_f32 v19, v19, v25
    v_accvgpr_write_b32 a59, v19
    v_accvgpr_read_b32 v19, a60
    v_mul_f32 v19, v19, v25
    v_accvgpr_write_b32 a60, v19
    v_accvgpr_read_b32 v19, a61
    v_mul_f32 v19, v19, v25
    v_accvgpr_write_b32 a61, v19
    v_accvgpr_read_b32 v19, a62
    v_mul_f32 v19, v19, v25
    v_accvgpr_write_b32 a62, v19
    v_accvgpr_read_b32 v19, a63
    v_mul_f32 v19, v19, v25
    v_accvgpr_write_b32 a63, v19
    v_accvgpr_read_b32 v19, a64
    v_mul_f32 v19, v19, v25
    v_accvgpr_write_b32 a64, v19
    v_accvgpr_read_b32 v19, a65
    v_mul_f32 v19, v19, v25
    v_accvgpr_write_b32 a65, v19
    v_accvgpr_read_b32 v19, a66
    v_mul_f32 v19, v19, v25
    v_accvgpr_write_b32 a66, v19
    v_accvgpr_read_b32 v19, a67
    v_mul_f32 v19, v19, v25
    v_accvgpr_write_b32 a67, v19
    v_accvgpr_read_b32 v19, a68
    v_mul_f32 v19, v19, v25
    v_accvgpr_write_b32 a68, v19
    v_accvgpr_read_b32 v19, a69
    v_mul_f32 v19, v19, v25
    v_accvgpr_write_b32 a69, v19
    v_accvgpr_read_b32 v19, a70
    v_mul_f32 v19, v19, v25
    v_accvgpr_write_b32 a70, v19
    v_accvgpr_read_b32 v19, a71
    v_mul_f32 v19, v19, v25
    v_accvgpr_write_b32 a71, v19
    v_accvgpr_read_b32 v19, a72
    v_mul_f32 v19, v19, v25
    v_accvgpr_write_b32 a72, v19
    v_accvgpr_read_b32 v19, a73
    v_mul_f32 v19, v19, v25
    v_accvgpr_write_b32 a73, v19
    v_accvgpr_read_b32 v19, a74
    v_mul_f32 v19, v19, v25
    v_accvgpr_write_b32 a74, v19
    v_accvgpr_read_b32 v19, a75
    v_mul_f32 v19, v19, v25
    v_accvgpr_write_b32 a75, v19
    v_accvgpr_read_b32 v19, a76
    v_mul_f32 v19, v19, v25
    v_accvgpr_write_b32 a76, v19
    v_accvgpr_read_b32 v19, a77
    v_mul_f32 v19, v19, v25
    v_accvgpr_write_b32 a77, v19
    v_accvgpr_read_b32 v19, a78
    v_mul_f32 v19, v19, v25
    v_accvgpr_write_b32 a78, v19
    v_accvgpr_read_b32 v19, a79
    v_mul_f32 v19, v19, v25
    v_accvgpr_write_b32 a79, v19
    v_accvgpr_read_b32 v19, a80
    v_mul_f32 v19, v19, v25
    v_accvgpr_write_b32 a80, v19
    v_accvgpr_read_b32 v19, a81
    v_mul_f32 v19, v19, v25
    v_accvgpr_write_b32 a81, v19
    v_accvgpr_read_b32 v19, a82
    v_mul_f32 v19, v19, v25
    v_accvgpr_write_b32 a82, v19
    v_accvgpr_read_b32 v19, a83
    v_mul_f32 v19, v19, v25
    v_accvgpr_write_b32 a83, v19
    v_accvgpr_read_b32 v19, a84
    v_mul_f32 v19, v19, v25
    v_accvgpr_write_b32 a84, v19
    v_accvgpr_read_b32 v19, a85
    v_mul_f32 v19, v19, v25
    v_accvgpr_write_b32 a85, v19
    v_accvgpr_read_b32 v19, a86
    v_mul_f32 v19, v19, v25
    v_accvgpr_write_b32 a86, v19
    v_accvgpr_read_b32 v19, a87
    v_mul_f32 v19, v19, v25
    v_accvgpr_write_b32 a87, v19
    v_accvgpr_read_b32 v19, a88
    v_mul_f32 v19, v19, v25
    v_accvgpr_write_b32 a88, v19
    v_accvgpr_read_b32 v19, a89
    v_mul_f32 v19, v19, v25
    v_accvgpr_write_b32 a89, v19
    v_accvgpr_read_b32 v19, a90
    v_mul_f32 v19, v19, v25
    v_accvgpr_write_b32 a90, v19
    v_accvgpr_read_b32 v19, a91
    v_mul_f32 v19, v19, v25
    v_accvgpr_write_b32 a91, v19
    v_accvgpr_read_b32 v19, a92
    v_mul_f32 v19, v19, v25
    v_accvgpr_write_b32 a92, v19
    v_accvgpr_read_b32 v19, a93
    v_mul_f32 v19, v19, v25
    v_accvgpr_write_b32 a93, v19
    v_accvgpr_read_b32 v19, a94
    v_mul_f32 v19, v19, v25
    v_accvgpr_write_b32 a94, v19
    v_accvgpr_read_b32 v19, a95
    v_mul_f32 v19, v19, v25
    v_accvgpr_write_b32 a95, v19
    v_fma_f32 v104, v104, s28, v13
    v_fma_f32 v105, v105, s28, v13
    v_exp_f32 v104, v104
    v_exp_f32 v105, v105
    s_nop 0
    v_cvt_pk_bf16_f32 v38, v104, v105
    v_fma_f32 v106, v106, s28, v13
    v_fma_f32 v107, v107, s28, v13
    v_exp_f32 v106, v106
    v_exp_f32 v107, v107
    s_nop 0
    v_cvt_pk_bf16_f32 v39, v106, v107
    v_fma_f32 v108, v108, s28, v13
    v_fma_f32 v109, v109, s28, v13
    v_exp_f32 v108, v108
    v_exp_f32 v109, v109
    s_nop 0
    v_cvt_pk_bf16_f32 v40, v108, v109
    v_fma_f32 v110, v110, s28, v13
    v_fma_f32 v111, v111, s28, v13
    v_exp_f32 v110, v110
    v_exp_f32 v111, v111
    s_nop 0
    v_cvt_pk_bf16_f32 v41, v110, v111
    v_mfma_f32_16x16x32_bf16 v[44:47], a[236:239], v[14:17], v[48:51]
    v_mfma_f32_16x16x32_bf16 v[44:47], a[240:243], v[20:23], v[44:47]
    v_mfma_f32_16x16x32_bf16 v[44:47], a[244:247], v[26:29], v[44:47]
    v_mfma_f32_16x16x32_bf16 v[44:47], a[248:251], v[32:35], v[44:47]
    v_mfma_f32_16x16x32_bf16 v[44:47], a[252:255], v[38:41], v[44:47]
    s_nop 15
    s_setpc_b64 s[40:41]
L_rare5_1:
    s_nop 15
    v_mbcnt_lo_u32_b32 v27, -1, 0
    v_mbcnt_hi_u32_b32 v27, -1, v27
    v_and_b32 v26, 15, v27
    v_mul_u32_u24 v26, 384, v26
    v_lshrrev_b32 v27, 4, v27
    v_lshl_add_u32 v26, v27, 4, v26
    s_add_u32 s69, s39, 0
    buffer_load_dwordx4 v[48:51], v26, s[4:7], s69 offen offset:0
    s_waitcnt vmcnt(0)
    v_mfma_f32_16x16x32_bf16 v[104:107], v[48:51], a[96:99], 0
    s_nop 7
    buffer_load_dwordx4 v[48:51], v26, s[4:7], s69 offen offset:64
    s_waitcnt vmcnt(0)
    v_mfma_f32_16x16x32_bf16 v[104:107], v[48:51], a[100:103], v[104:107]
    s_nop 7
    buffer_load_dwordx4 v[48:51], v26, s[4:7], s69 offen offset:128
    s_waitcnt vmcnt(0)
    v_mfma_f32_16x16x32_bf16 v[104:107], v[48:51], a[104:107], v[104:107]
    s_nop 7
    buffer_load_dwordx4 v[48:51], v26, s[4:7], s69 offen offset:192
    s_waitcnt vmcnt(0)
    v_mfma_f32_16x16x32_bf16 v[104:107], v[48:51], a[108:111], v[104:107]
    s_nop 7
    buffer_load_dwordx4 v[48:51], v26, s[4:7], s69 offen offset:256
    s_waitcnt vmcnt(0)
    v_mfma_f32_16x16x32_bf16 v[104:107], v[48:51], a[112:115], v[104:107]
    s_nop 7
    buffer_load_dwordx4 v[48:51], v26, s[4:7], s69 offen offset:320
    s_waitcnt vmcnt(0)
    v_mfma_f32_16x16x32_bf16 v[104:107], v[48:51], a[116:119], v[104:107]
    s_nop 7
    s_add_u32 s69, s39, 6144
    buffer_load_dwordx4 v[48:51], v26, s[4:7], s69 offen offset:0
    s_waitcnt vmcnt(0)
    v_mfma_f32_16x16x32_bf16 v[108:111], v[48:51], a[96:99], 0
    s_nop 7
    buffer_load_dwordx4 v[48:51], v26, s[4:7], s69 offen offset:64
    s_waitcnt vmcnt(0)
    v_mfma_f32_16x16x32_bf16 v[108:111], v[48:51], a[100:103], v[108:111]
    s_nop 7
    buffer_load_dwordx4 v[48:51], v26, s[4:7], s69 offen offset:128
    s_waitcnt vmcnt(0)
    v_mfma_f32_16x16x32_bf16 v[108:111], v[48:51], a[104:107], v[108:111]
    s_nop 7
    buffer_load_dwordx4 v[48:51], v26, s[4:7], s69 offen offset:192
    s_waitcnt vmcnt(0)
    v_mfma_f32_16x16x32_bf16 v[108:111], v[48:51], a[108:111], v[108:111]
    s_nop 7
    buffer_load_dwordx4 v[48:51], v26, s[4:7], s69 offen offset:256
    s_waitcnt vmcnt(0)
    v_mfma_f32_16x16x32_bf16 v[108:111], v[48:51], a[112:115], v[108:111]
    s_nop 7
    buffer_load_dwordx4 v[48:51], v26, s[4:7], s69 offen offset:320
    s_waitcnt vmcnt(0)
    v_mfma_f32_16x16x32_bf16 v[108:111], v[48:51], a[116:119], v[108:111]
    s_nop 7
    s_nop 15
    v_max3_f32 v14, v104, v105, v106
    v_max3_f32 v14, v14, v107, v108
    v_max3_f32 v14, v14, v109, v110
    v_max_f32 v14, v14, v111
    v_mov_b32 v15, v14
    s_nop 1
    v_permlane32_swap_b32 v15, v14
    v_max_f32 v14, v14, v15
    v_mov_b32 v15, v14
    s_nop 1
    v_permlane16_swap_b32 v15, v14
    v_max_f32 v14, v14, v15
    v_fma_f32 v14, v14, s28, v9
    v_max_f32 v20, 0, v14
    v_sub_f32 v9, v9, v20
    v_sub_f32 v21, 0, v20
    v_exp_f32 v21, v21
    s_nop 0
    v_mul_f32 v15, v44, v21
    v_cndmask_b32_e64 v44, v15, v44, s[60:61]
    v_cndmask_b32_e64 v44, v44, 0, s[46:47]
    v_mul_f32 v112, v112, v21
    v_mul_f32 v113, v113, v21
    v_mul_f32 v114, v114, v21
    v_mul_f32 v115, v115, v21
    v_mul_f32 v116, v116, v21
    v_mul_f32 v117, v117, v21
    v_mul_f32 v118, v118, v21
    v_mul_f32 v119, v119, v21
    v_mul_f32 v120, v120, v21
    v_mul_f32 v121, v121, v21
    v_mul_f32 v122, v122, v21
    v_mul_f32 v123, v123, v21
    v_mul_f32 v124, v124, v21
    v_mul_f32 v125, v125, v21
    v_mul_f32 v126, v126, v21
    v_mul_f32 v127, v127, v21
    v_mul_f32 v128, v128, v21
    v_mul_f32 v129, v129, v21
    v_mul_f32 v130, v130, v21
    v_mul_f32 v131, v131, v21
    v_mul_f32 v132, v132, v21
    v_mul_f32 v133, v133, v21
    v_mul_f32 v134, v134, v21
    v_mul_f32 v135, v135, v21
    v_mul_f32 v136, v136, v21
    v_mul_f32 v137, v137, v21
    v_mul_f32 v138, v138, v21
    v_mul_f32 v139, v139, v21
    v_mul_f32 v140, v140, v21
    v_mul_f32 v141, v141, v21
    v_mul_f32 v142, v142, v21
    v_mul_f32 v143, v143, v21
    v_mul_f32 v144, v144, v21
    v_mul_f32 v145, v145, v21
    v_mul_f32 v146, v146, v21
    v_mul_f32 v147, v147, v21
    v_mul_f32 v148, v148, v21
    v_mul_f32 v149, v149, v21
    v_mul_f32 v150, v150, v21
    v_mul_f32 v151, v151, v21
    v_mul_f32 v152, v152, v21
    v_mul_f32 v153, v153, v21
    v_mul_f32 v154, v154, v21
    v_mul_f32 v155, v155, v21
    v_mul_f32 v156, v156, v21
    v_mul_f32 v157, v157, v21
    v_mul_f32 v158, v158, v21
    v_mul_f32 v159, v159, v21
    v_fma_f32 v104, v104, s28, v9
    v_fma_f32 v105, v105, s28, v9
    v_exp_f32 v104, v104
    v_exp_f32 v105, v105
    s_nop 0
    v_cvt_pk_bf16_f32 v18, v104, v105
    v_fma_f32 v106, v106, s28, v9
    v_fma_f32 v107, v107, s28, v9
    v_exp_f32 v106, v106
    v_exp_f32 v107, v107
    s_nop 0
    v_cvt_pk_bf16_f32 v19, v106, v107
    v_fma_f32 v108, v108, s28, v9
    v_fma_f32 v109, v109, s28, v9
    v_exp_f32 v108, v108
    v_exp_f32 v109, v109
    s_nop 0
    v_cvt_pk_bf16_f32 v16, v108, v109
    v_fma_f32 v110, v110, s28, v9
    v_fma_f32 v111, v111, s28, v9
    v_exp_f32 v110, v110
    v_exp_f32 v111, v111
    s_nop 0
    v_cvt_pk_bf16_f32 v17, v110, v111
    s_add_u32 s69, s39, 0
    buffer_load_dwordx4 v[48:51], v26, s[4:7], s69 offen offset:0
    s_waitcnt vmcnt(0)
    v_mfma_f32_16x16x32_bf16 v[104:107], v[48:51], a[120:123], 0
    s_nop 7
    buffer_load_dwordx4 v[48:51], v26, s[4:7], s69 offen offset:64
    s_waitcnt vmcnt(0)
    v_mfma_f32_16x16x32_bf16 v[104:107], v[48:51], a[124:127], v[104:107]
    s_nop 7
    buffer_load_dwordx4 v[48:51], v26, s[4:7], s69 offen offset:128
    s_waitcnt vmcnt(0)
    v_mfma_f32_16x16x32_bf16 v[104:107], v[48:51], a[128:131], v[104:107]
    s_nop 7
    buffer_load_dwordx4 v[48:51], v26, s[4:7], s69 offen offset:192
    s_waitcnt vmcnt(0)
    v_mfma_f32_16x16x32_bf16 v[104:107], v[48:51], a[132:135], v[104:107]
    s_nop 7
    buffer_load_dwordx4 v[48:51], v26, s[4:7], s69 offen offset:256
    s_waitcnt vmcnt(0)
    v_mfma_f32_16x16x32_bf16 v[104:107], v[48:51], a[136:139], v[104:107]
    s_nop 7
    buffer_load_dwordx4 v[48:51], v26, s[4:7], s69 offen offset:320
    s_waitcnt vmcnt(0)
    v_mfma_f32_16x16x32_bf16 v[104:107], v[48:51], a[140:143], v[104:107]
    s_nop 7
    s_add_u32 s69, s39, 6144
    buffer_load_dwordx4 v[48:51], v26, s[4:7], s69 offen offset:0
    s_waitcnt vmcnt(0)
    v_mfma_f32_16x16x32_bf16 v[108:111], v[48:51], a[120:123], 0
    s_nop 7
    buffer_load_dwordx4 v[48:51], v26, s[4:7], s69 offen offset:64
    s_waitcnt vmcnt(0)
    v_mfma_f32_16x16x32_bf16 v[108:111], v[48:51], a[124:127], v[108:111]
    s_nop 7
    buffer_load_dwordx4 v[48:51], v26, s[4:7], s69 offen offset:128
    s_waitcnt vmcnt(0)
    v_mfma_f32_16x16x32_bf16 v[108:111], v[48:51], a[128:131], v[108:111]
    s_nop 7
    buffer_load_dwordx4 v[48:51], v26, s[4:7], s69 offen offset:192
    s_waitcnt vmcnt(0)
    v_mfma_f32_16x16x32_bf16 v[108:111], v[48:51], a[132:135], v[108:111]
    s_nop 7
    buffer_load_dwordx4 v[48:51], v26, s[4:7], s69 offen offset:256
    s_waitcnt vmcnt(0)
    v_mfma_f32_16x16x32_bf16 v[108:111], v[48:51], a[136:139], v[108:111]
    s_nop 7
    buffer_load_dwordx4 v[48:51], v26, s[4:7], s69 offen offset:320
    s_waitcnt vmcnt(0)
    v_mfma_f32_16x16x32_bf16 v[108:111], v[48:51], a[140:143], v[108:111]
    s_nop 7
    s_nop 15
    v_max3_f32 v14, v104, v105, v106
    v_max3_f32 v14, v14, v107, v108
    v_max3_f32 v14, v14, v109, v110
    v_max_f32 v14, v14, v111
    v_mov_b32 v15, v14
    s_nop 1
    v_permlane32_swap_b32 v15, v14
    v_max_f32 v14, v14, v15
    v_mov_b32 v15, v14
    s_nop 1
    v_permlane16_swap_b32 v15, v14
    v_max_f32 v14, v14, v15
    v_fma_f32 v14, v14, s28, v10
    v_max_f32 v20, 0, v14
    v_sub_f32 v10, v10, v20
    v_sub_f32 v21, 0, v20
    v_exp_f32 v21, v21
    s_nop 0
    v_mul_f32 v45, v45, v21
    v_mul_f32 v160, v160, v21
    v_mul_f32 v161, v161, v21
    v_mul_f32 v162, v162, v21
    v_mul_f32 v163, v163, v21
    v_mul_f32 v164, v164, v21
    v_mul_f32 v165, v165, v21
    v_mul_f32 v166, v166, v21
    v_mul_f32 v167, v167, v21
    v_mul_f32 v168, v168, v21
    v_mul_f32 v169, v169, v21
    v_mul_f32 v170, v170, v21
    v_mul_f32 v171, v171, v21
    v_mul_f32 v172, v172, v21
    v_mul_f32 v173, v173, v21
    v_mul_f32 v174, v174, v21
    v_mul_f32 v175, v175, v21
    v_mul_f32 v176, v176, v21
    v_mul_f32 v177, v177, v21
    v_mul_f32 v178, v178, v21
    v_mul_f32 v179, v179, v21
    v_mul_f32 v180, v180, v21
    v_mul_f32 v181, v181, v21
    v_mul_f32 v182, v182, v21
    v_mul_f32 v183, v183, v21
    v_mul_f32 v184, v184, v21
    v_mul_f32 v185, v185, v21
    v_mul_f32 v186, v186, v21
    v_mul_f32 v187, v187, v21
    v_mul_f32 v188, v188, v21
    v_mul_f32 v189, v189, v21
    v_mul_f32 v190, v190, v21
    v_mul_f32 v191, v191, v21
    v_mul_f32 v192, v192, v21
    v_mul_f32 v193, v193, v21
    v_mul_f32 v194, v194, v21
    v_mul_f32 v195, v195, v21
    v_mul_f32 v196, v196, v21
    v_mul_f32 v197, v197, v21
    v_mul_f32 v198, v198, v21
    v_mul_f32 v199, v199, v21
    v_mul_f32 v200, v200, v21
    v_mul_f32 v201, v201, v21
    v_mul_f32 v202, v202, v21
    v_mul_f32 v203, v203, v21
    v_mul_f32 v204, v204, v21
    v_mul_f32 v205, v205, v21
    v_mul_f32 v206, v206, v21
    v_mul_f32 v207, v207, v21
    v_fma_f32 v104, v104, s28, v10
    v_fma_f32 v105, v105, s28, v10
    v_exp_f32 v104, v104
    v_exp_f32 v105, v105
    s_nop 0
    v_cvt_pk_bf16_f32 v24, v104, v105
    v_fma_f32 v106, v106, s28, v10
    v_fma_f32 v107, v107, s28, v10
    v_exp_f32 v106, v106
    v_exp_f32 v107, v107
    s_nop 0
    v_cvt_pk_bf16_f32 v25, v106, v107
    v_fma_f32 v108, v108, s28, v10
    v_fma_f32 v109, v109, s28, v10
    v_exp_f32 v108, v108
    v_exp_f32 v109, v109
    s_nop 0
    v_cvt_pk_bf16_f32 v22, v108, v109
    v_fma_f32 v110, v110, s28, v10
    v_fma_f32 v111, v111, s28, v10
    v_exp_f32 v110, v110
    v_exp_f32 v111, v111
    s_nop 0
    v_cvt_pk_bf16_f32 v23, v110, v111
    s_add_u32 s69, s39, 0
    buffer_load_dwordx4 v[48:51], v26, s[4:7], s69 offen offset:0
    s_waitcnt vmcnt(0)
    v_mfma_f32_16x16x32_bf16 v[104:107], v[48:51], a[144:147], 0
    s_nop 7
    buffer_load_dwordx4 v[48:51], v26, s[4:7], s69 offen offset:64
    s_waitcnt vmcnt(0)
    v_mfma_f32_16x16x32_bf16 v[104:107], v[48:51], a[148:151], v[104:107]
    s_nop 7
    buffer_load_dwordx4 v[48:51], v26, s[4:7], s69 offen offset:128
    s_waitcnt vmcnt(0)
    v_mfma_f32_16x16x32_bf16 v[104:107], v[48:51], a[152:155], v[104:107]
    s_nop 7
    buffer_load_dwordx4 v[48:51], v26, s[4:7], s69 offen offset:192
    s_waitcnt vmcnt(0)
    v_mfma_f32_16x16x32_bf16 v[104:107], v[48:51], a[156:159], v[104:107]
    s_nop 7
    buffer_load_dwordx4 v[48:51], v26, s[4:7], s69 offen offset:256
    s_waitcnt vmcnt(0)
    v_mfma_f32_16x16x32_bf16 v[104:107], v[48:51], a[160:163], v[104:107]
    s_nop 7
    buffer_load_dwordx4 v[48:51], v26, s[4:7], s69 offen offset:320
    s_waitcnt vmcnt(0)
    v_mfma_f32_16x16x32_bf16 v[104:107], v[48:51], a[164:167], v[104:107]
    s_nop 7
    s_add_u32 s69, s39, 6144
    buffer_load_dwordx4 v[48:51], v26, s[4:7], s69 offen offset:0
    s_waitcnt vmcnt(0)
    v_mfma_f32_16x16x32_bf16 v[108:111], v[48:51], a[144:147], 0
    s_nop 7
    buffer_load_dwordx4 v[48:51], v26, s[4:7], s69 offen offset:64
    s_waitcnt vmcnt(0)
    v_mfma_f32_16x16x32_bf16 v[108:111], v[48:51], a[148:151], v[108:111]
    s_nop 7
    buffer_load_dwordx4 v[48:51], v26, s[4:7], s69 offen offset:128
    s_waitcnt vmcnt(0)
    v_mfma_f32_16x16x32_bf16 v[108:111], v[48:51], a[152:155], v[108:111]
    s_nop 7
    buffer_load_dwordx4 v[48:51], v26, s[4:7], s69 offen offset:192
    s_waitcnt vmcnt(0)
    v_mfma_f32_16x16x32_bf16 v[108:111], v[48:51], a[156:159], v[108:111]
    s_nop 7
    buffer_load_dwordx4 v[48:51], v26, s[4:7], s69 offen offset:256
    s_waitcnt vmcnt(0)
    v_mfma_f32_16x16x32_bf16 v[108:111], v[48:51], a[160:163], v[108:111]
    s_nop 7
    buffer_load_dwordx4 v[48:51], v26, s[4:7], s69 offen offset:320
    s_waitcnt vmcnt(0)
    v_mfma_f32_16x16x32_bf16 v[108:111], v[48:51], a[164:167], v[108:111]
    s_nop 7
    s_nop 15
    v_max3_f32 v14, v104, v105, v106
    v_max3_f32 v14, v14, v107, v108
    v_max3_f32 v14, v14, v109, v110
    v_max_f32 v14, v14, v111
    v_mov_b32 v15, v14
    s_nop 1
    v_permlane32_swap_b32 v15, v14
    v_max_f32 v14, v14, v15
    v_mov_b32 v15, v14
    s_nop 1
    v_permlane16_swap_b32 v15, v14
    v_max_f32 v14, v14, v15
    v_fma_f32 v14, v14, s28, v11
    v_max_f32 v20, 0, v14
    v_sub_f32 v11, v11, v20
    v_sub_f32 v21, 0, v20
    v_exp_f32 v21, v21
    s_nop 0
    v_mul_f32 v46, v46, v21
    v_mul_f32 v208, v208, v21
    v_mul_f32 v209, v209, v21
    v_mul_f32 v210, v210, v21
    v_mul_f32 v211, v211, v21
    v_mul_f32 v212, v212, v21
    v_mul_f32 v213, v213, v21
    v_mul_f32 v214, v214, v21
    v_mul_f32 v215, v215, v21
    v_mul_f32 v216, v216, v21
    v_mul_f32 v217, v217, v21
    v_mul_f32 v218, v218, v21
    v_mul_f32 v219, v219, v21
    v_mul_f32 v220, v220, v21
    v_mul_f32 v221, v221, v21
    v_mul_f32 v222, v222, v21
    v_mul_f32 v223, v223, v21
    v_mul_f32 v224, v224, v21
    v_mul_f32 v225, v225, v21
    v_mul_f32 v226, v226, v21
    v_mul_f32 v227, v227, v21
    v_mul_f32 v228, v228, v21
    v_mul_f32 v229, v229, v21
    v_mul_f32 v230, v230, v21
    v_mul_f32 v231, v231, v21
    v_mul_f32 v232, v232, v21
    v_mul_f32 v233, v233, v21
    v_mul_f32 v234, v234, v21
    v_mul_f32 v235, v235, v21
    v_mul_f32 v236, v236, v21
    v_mul_f32 v237, v237, v21
    v_mul_f32 v238, v238, v21
    v_mul_f32 v239, v239, v21
    v_mul_f32 v240, v240, v21
    v_mul_f32 v241, v241, v21
    v_mul_f32 v242, v242, v21
    v_mul_f32 v243, v243, v21
    v_mul_f32 v244, v244, v21
    v_mul_f32 v245, v245, v21
    v_mul_f32 v246, v246, v21
    v_mul_f32 v247, v247, v21
    v_mul_f32 v248, v248, v21
    v_mul_f32 v249, v249, v21
    v_mul_f32 v250, v250, v21
    v_mul_f32 v251, v251, v21
    v_mul_f32 v252, v252, v21
    v_mul_f32 v253, v253, v21
    v_mul_f32 v254, v254, v21
    v_mul_f32 v255, v255, v21
    v_fma_f32 v104, v104, s28, v11
    v_fma_f32 v105, v105, s28, v11
    v_exp_f32 v104, v104
    v_exp_f32 v105, v105
    s_nop 0
    v_cvt_pk_bf16_f32 v30, v104, v105
    v_fma_f32 v106, v106, s28, v11
    v_fma_f32 v107, v107, s28, v11
    v_exp_f32 v106, v106
    v_exp_f32 v107, v107
    s_nop 0
    v_cvt_pk_bf16_f32 v31, v106, v107
    v_fma_f32 v108, v108, s28, v11
    v_fma_f32 v109, v109, s28, v11
    v_exp_f32 v108, v108
    v_exp_f32 v109, v109
    s_nop 0
    v_cvt_pk_bf16_f32 v28, v108, v109
    v_fma_f32 v110, v110, s28, v11
    v_fma_f32 v111, v111, s28, v11
    v_exp_f32 v110, v110
    v_exp_f32 v111, v111
    s_nop 0
    v_cvt_pk_bf16_f32 v29, v110, v111
    s_add_u32 s69, s39, 0
    buffer_load_dwordx4 v[48:51], v26, s[4:7], s69 offen offset:0
    s_waitcnt vmcnt(0)
    v_mfma_f32_16x16x32_bf16 v[104:107], v[48:51], a[168:171], 0
    s_nop 7
    buffer_load_dwordx4 v[48:51], v26, s[4:7], s69 offen offset:64
    s_waitcnt vmcnt(0)
    v_mfma_f32_16x16x32_bf16 v[104:107], v[48:51], a[172:175], v[104:107]
    s_nop 7
    buffer_load_dwordx4 v[48:51], v26, s[4:7], s69 offen offset:128
    s_waitcnt vmcnt(0)
    v_mfma_f32_16x16x32_bf16 v[104:107], v[48:51], a[176:179], v[104:107]
    s_nop 7
    buffer_load_dwordx4 v[48:51], v26, s[4:7], s69 offen offset:192
    s_waitcnt vmcnt(0)
    v_mfma_f32_16x16x32_bf16 v[104:107], v[48:51], a[180:183], v[104:107]
    s_nop 7
    buffer_load_dwordx4 v[48:51], v26, s[4:7], s69 offen offset:256
    s_waitcnt vmcnt(0)
    v_mfma_f32_16x16x32_bf16 v[104:107], v[48:51], a[184:187], v[104:107]
    s_nop 7
    buffer_load_dwordx4 v[48:51], v26, s[4:7], s69 offen offset:320
    s_waitcnt vmcnt(0)
    v_mfma_f32_16x16x32_bf16 v[104:107], v[48:51], a[188:191], v[104:107]
    s_nop 7
    s_add_u32 s69, s39, 6144
    buffer_load_dwordx4 v[48:51], v26, s[4:7], s69 offen offset:0
    s_waitcnt vmcnt(0)
    v_mfma_f32_16x16x32_bf16 v[108:111], v[48:51], a[168:171], 0
    s_nop 7
    buffer_load_dwordx4 v[48:51], v26, s[4:7], s69 offen offset:64
    s_waitcnt vmcnt(0)
    v_mfma_f32_16x16x32_bf16 v[108:111], v[48:51], a[172:175], v[108:111]
    s_nop 7
    buffer_load_dwordx4 v[48:51], v26, s[4:7], s69 offen offset:128
    s_waitcnt vmcnt(0)
    v_mfma_f32_16x16x32_bf16 v[108:111], v[48:51], a[176:179], v[108:111]
    s_nop 7
    buffer_load_dwordx4 v[48:51], v26, s[4:7], s69 offen offset:192
    s_waitcnt vmcnt(0)
    v_mfma_f32_16x16x32_bf16 v[108:111], v[48:51], a[180:183], v[108:111]
    s_nop 7
    buffer_load_dwordx4 v[48:51], v26, s[4:7], s69 offen offset:256
    s_waitcnt vmcnt(0)
    v_mfma_f32_16x16x32_bf16 v[108:111], v[48:51], a[184:187], v[108:111]
    s_nop 7
    buffer_load_dwordx4 v[48:51], v26, s[4:7], s69 offen offset:320
    s_waitcnt vmcnt(0)
    v_mfma_f32_16x16x32_bf16 v[108:111], v[48:51], a[188:191], v[108:111]
    s_nop 7
    s_nop 15
    v_max3_f32 v14, v104, v105, v106
    v_max3_f32 v14, v14, v107, v108
    v_max3_f32 v14, v14, v109, v110
    v_max_f32 v14, v14, v111
    v_mov_b32 v15, v14
    s_nop 1
    v_permlane32_swap_b32 v15, v14
    v_max_f32 v14, v14, v15
    v_mov_b32 v15, v14
    s_nop 1
    v_permlane16_swap_b32 v15, v14
    v_max_f32 v14, v14, v15
    v_fma_f32 v14, v14, s28, v12
    v_max_f32 v20, 0, v14
    v_sub_f32 v12, v12, v20
    v_sub_f32 v21, 0, v20
    v_exp_f32 v21, v21
    s_nop 0
    v_mul_f32 v47, v47, v21
    v_accvgpr_read_b32 v15, a0
    v_mul_f32 v15, v15, v21
    v_accvgpr_write_b32 a0, v15
    v_accvgpr_read_b32 v15, a1
    v_mul_f32 v15, v15, v21
    v_accvgpr_write_b32 a1, v15
    v_accvgpr_read_b32 v15, a2
    v_mul_f32 v15, v15, v21
    v_accvgpr_write_b32 a2, v15
    v_accvgpr_read_b32 v15, a3
    v_mul_f32 v15, v15, v21
    v_accvgpr_write_b32 a3, v15
    v_accvgpr_read_b32 v15, a4
    v_mul_f32 v15, v15, v21
    v_accvgpr_write_b32 a4, v15
    v_accvgpr_read_b32 v15, a5
    v_mul_f32 v15, v15, v21
    v_accvgpr_write_b32 a5, v15
    v_accvgpr_read_b32 v15, a6
    v_mul_f32 v15, v15, v21
    v_accvgpr_write_b32 a6, v15
    v_accvgpr_read_b32 v15, a7
    v_mul_f32 v15, v15, v21
    v_accvgpr_write_b32 a7, v15
    v_accvgpr_read_b32 v15, a8
    v_mul_f32 v15, v15, v21
    v_accvgpr_write_b32 a8, v15
    v_accvgpr_read_b32 v15, a9
    v_mul_f32 v15, v15, v21
    v_accvgpr_write_b32 a9, v15
    v_accvgpr_read_b32 v15, a10
    v_mul_f32 v15, v15, v21
    v_accvgpr_write_b32 a10, v15
    v_accvgpr_read_b32 v15, a11
    v_mul_f32 v15, v15, v21
    v_accvgpr_write_b32 a11, v15
    v_accvgpr_read_b32 v15, a12
    v_mul_f32 v15, v15, v21
    v_accvgpr_write_b32 a12, v15
    v_accvgpr_read_b32 v15, a13
    v_mul_f32 v15, v15, v21
    v_accvgpr_write_b32 a13, v15
    v_accvgpr_read_b32 v15, a14
    v_mul_f32 v15, v15, v21
    v_accvgpr_write_b32 a14, v15
    v_accvgpr_read_b32 v15, a15
    v_mul_f32 v15, v15, v21
    v_accvgpr_write_b32 a15, v15
    v_accvgpr_read_b32 v15, a16
    v_mul_f32 v15, v15, v21
    v_accvgpr_write_b32 a16, v15
    v_accvgpr_read_b32 v15, a17
    v_mul_f32 v15, v15, v21
    v_accvgpr_write_b32 a17, v15
    v_accvgpr_read_b32 v15, a18
    v_mul_f32 v15, v15, v21
    v_accvgpr_write_b32 a18, v15
    v_accvgpr_read_b32 v15, a19
    v_mul_f32 v15, v15, v21
    v_accvgpr_write_b32 a19, v15
    v_accvgpr_read_b32 v15, a20
    v_mul_f32 v15, v15, v21
    v_accvgpr_write_b32 a20, v15
    v_accvgpr_read_b32 v15, a21
    v_mul_f32 v15, v15, v21
    v_accvgpr_write_b32 a21, v15
    v_accvgpr_read_b32 v15, a22
    v_mul_f32 v15, v15, v21
    v_accvgpr_write_b32 a22, v15
    v_accvgpr_read_b32 v15, a23
    v_mul_f32 v15, v15, v21
    v_accvgpr_write_b32 a23, v15
    v_accvgpr_read_b32 v15, a24
    v_mul_f32 v15, v15, v21
    v_accvgpr_write_b32 a24, v15
    v_accvgpr_read_b32 v15, a25
    v_mul_f32 v15, v15, v21
    v_accvgpr_write_b32 a25, v15
    v_accvgpr_read_b32 v15, a26
    v_mul_f32 v15, v15, v21
    v_accvgpr_write_b32 a26, v15
    v_accvgpr_read_b32 v15, a27
    v_mul_f32 v15, v15, v21
    v_accvgpr_write_b32 a27, v15
    v_accvgpr_read_b32 v15, a28
    v_mul_f32 v15, v15, v21
    v_accvgpr_write_b32 a28, v15
    v_accvgpr_read_b32 v15, a29
    v_mul_f32 v15, v15, v21
    v_accvgpr_write_b32 a29, v15
    v_accvgpr_read_b32 v15, a30
    v_mul_f32 v15, v15, v21
    v_accvgpr_write_b32 a30, v15
    v_accvgpr_read_b32 v15, a31
    v_mul_f32 v15, v15, v21
    v_accvgpr_write_b32 a31, v15
    v_accvgpr_read_b32 v15, a32
    v_mul_f32 v15, v15, v21
    v_accvgpr_write_b32 a32, v15
    v_accvgpr_read_b32 v15, a33
    v_mul_f32 v15, v15, v21
    v_accvgpr_write_b32 a33, v15
    v_accvgpr_read_b32 v15, a34
    v_mul_f32 v15, v15, v21
    v_accvgpr_write_b32 a34, v15
    v_accvgpr_read_b32 v15, a35
    v_mul_f32 v15, v15, v21
    v_accvgpr_write_b32 a35, v15
    v_accvgpr_read_b32 v15, a36
    v_mul_f32 v15, v15, v21
    v_accvgpr_write_b32 a36, v15
    v_accvgpr_read_b32 v15, a37
    v_mul_f32 v15, v15, v21
    v_accvgpr_write_b32 a37, v15
    v_accvgpr_read_b32 v15, a38
    v_mul_f32 v15, v15, v21
    v_accvgpr_write_b32 a38, v15
    v_accvgpr_read_b32 v15, a39
    v_mul_f32 v15, v15, v21
    v_accvgpr_write_b32 a39, v15
    v_accvgpr_read_b32 v15, a40
    v_mul_f32 v15, v15, v21
    v_accvgpr_write_b32 a40, v15
    v_accvgpr_read_b32 v15, a41
    v_mul_f32 v15, v15, v21
    v_accvgpr_write_b32 a41, v15
    v_accvgpr_read_b32 v15, a42
    v_mul_f32 v15, v15, v21
    v_accvgpr_write_b32 a42, v15
    v_accvgpr_read_b32 v15, a43
    v_mul_f32 v15, v15, v21
    v_accvgpr_write_b32 a43, v15
    v_accvgpr_read_b32 v15, a44
    v_mul_f32 v15, v15, v21
    v_accvgpr_write_b32 a44, v15
    v_accvgpr_read_b32 v15, a45
    v_mul_f32 v15, v15, v21
    v_accvgpr_write_b32 a45, v15
    v_accvgpr_read_b32 v15, a46
    v_mul_f32 v15, v15, v21
    v_accvgpr_write_b32 a46, v15
    v_accvgpr_read_b32 v15, a47
    v_mul_f32 v15, v15, v21
    v_accvgpr_write_b32 a47, v15
    v_fma_f32 v104, v104, s28, v12
    v_fma_f32 v105, v105, s28, v12
    v_exp_f32 v104, v104
    v_exp_f32 v105, v105
    s_nop 0
    v_cvt_pk_bf16_f32 v36, v104, v105
    v_fma_f32 v106, v106, s28, v12
    v_fma_f32 v107, v107, s28, v12
    v_exp_f32 v106, v106
    v_exp_f32 v107, v107
    s_nop 0
    v_cvt_pk_bf16_f32 v37, v106, v107
    v_fma_f32 v108, v108, s28, v12
    v_fma_f32 v109, v109, s28, v12
    v_exp_f32 v108, v108
    v_exp_f32 v109, v109
    s_nop 0
    v_cvt_pk_bf16_f32 v34, v108, v109
    v_fma_f32 v110, v110, s28, v12
    v_fma_f32 v111, v111, s28, v12
    v_exp_f32 v110, v110
    v_exp_f32 v111, v111
    s_nop 0
    v_cvt_pk_bf16_f32 v35, v110, v111
    s_add_u32 s69, s39, 0
    buffer_load_dwordx4 v[48:51], v26, s[4:7], s69 offen offset:0
    s_waitcnt vmcnt(0)
    v_mfma_f32_16x16x32_bf16 v[104:107], v[48:51], a[192:195], 0
    s_nop 7
    buffer_load_dwordx4 v[48:51], v26, s[4:7], s69 offen offset:64
    s_waitcnt vmcnt(0)
    v_mfma_f32_16x16x32_bf16 v[104:107], v[48:51], a[196:199], v[104:107]
    s_nop 7
    buffer_load_dwordx4 v[48:51], v26, s[4:7], s69 offen offset:128
    s_waitcnt vmcnt(0)
    v_mfma_f32_16x16x32_bf16 v[104:107], v[48:51], a[200:203], v[104:107]
    s_nop 7
    buffer_load_dwordx4 v[48:51], v26, s[4:7], s69 offen offset:192
    s_waitcnt vmcnt(0)
    v_mfma_f32_16x16x32_bf16 v[104:107], v[48:51], a[204:207], v[104:107]
    s_nop 7
    buffer_load_dwordx4 v[48:51], v26, s[4:7], s69 offen offset:256
    s_waitcnt vmcnt(0)
    v_mfma_f32_16x16x32_bf16 v[104:107], v[48:51], a[208:211], v[104:107]
    s_nop 7
    buffer_load_dwordx4 v[48:51], v26, s[4:7], s69 offen offset:320
    s_waitcnt vmcnt(0)
    v_mfma_f32_16x16x32_bf16 v[104:107], v[48:51], v[92:95], v[104:107]
    s_nop 7
    s_add_u32 s69, s39, 6144
    buffer_load_dwordx4 v[48:51], v26, s[4:7], s69 offen offset:0
    s_waitcnt vmcnt(0)
    v_mfma_f32_16x16x32_bf16 v[108:111], v[48:51], a[192:195], 0
    s_nop 7
    buffer_load_dwordx4 v[48:51], v26, s[4:7], s69 offen offset:64
    s_waitcnt vmcnt(0)
    v_mfma_f32_16x16x32_bf16 v[108:111], v[48:51], a[196:199], v[108:111]
    s_nop 7
    buffer_load_dwordx4 v[48:51], v26, s[4:7], s69 offen offset:128
    s_waitcnt vmcnt(0)
    v_mfma_f32_16x16x32_bf16 v[108:111], v[48:51], a[200:203], v[108:111]
    s_nop 7
    buffer_load_dwordx4 v[48:51], v26, s[4:7], s69 offen offset:192
    s_waitcnt vmcnt(0)
    v_mfma_f32_16x16x32_bf16 v[108:111], v[48:51], a[204:207], v[108:111]
    s_nop 7
    buffer_load_dwordx4 v[48:51], v26, s[4:7], s69 offen offset:256
    s_waitcnt vmcnt(0)
    v_mfma_f32_16x16x32_bf16 v[108:111], v[48:51], a[208:211], v[108:111]
    s_nop 7
    buffer_load_dwordx4 v[48:51], v26, s[4:7], s69 offen offset:320
    s_waitcnt vmcnt(0)
    v_mfma_f32_16x16x32_bf16 v[108:111], v[48:51], v[92:95], v[108:111]
    s_nop 7
    s_nop 15
    v_max3_f32 v14, v104, v105, v106
    v_max3_f32 v14, v14, v107, v108
    v_max3_f32 v14, v14, v109, v110
    v_max_f32 v14, v14, v111
    v_mov_b32 v15, v14
    s_nop 1
    v_permlane32_swap_b32 v15, v14
    v_max_f32 v14, v14, v15
    v_mov_b32 v15, v14
    s_nop 1
    v_permlane16_swap_b32 v15, v14
    v_max_f32 v14, v14, v15
    v_fma_f32 v14, v14, s28, v13
    v_max_f32 v20, 0, v14
    v_sub_f32 v13, v13, v20
    v_sub_f32 v21, 0, v20
    v_exp_f32 v21, v21
    s_nop 0
    v_mul_f32 v15, v44, v21
    v_cndmask_b32_e64 v44, v44, v15, s[60:61]
    v_accvgpr_read_b32 v15, a48
    v_mul_f32 v15, v15, v21
    v_accvgpr_write_b32 a48, v15
    v_accvgpr_read_b32 v15, a49
    v_mul_f32 v15, v15, v21
    v_accvgpr_write_b32 a49, v15
    v_accvgpr_read_b32 v15, a50
    v_mul_f32 v15, v15, v21
    v_accvgpr_write_b32 a50, v15
    v_accvgpr_read_b32 v15, a51
    v_mul_f32 v15, v15, v21
    v_accvgpr_write_b32 a51, v15
    v_accvgpr_read_b32 v15, a52
    v_mul_f32 v15, v15, v21
    v_accvgpr_write_b32 a52, v15
    v_accvgpr_read_b32 v15, a53
    v_mul_f32 v15, v15, v21
    v_accvgpr_write_b32 a53, v15
    v_accvgpr_read_b32 v15, a54
    v_mul_f32 v15, v15, v21
    v_accvgpr_write_b32 a54, v15
    v_accvgpr_read_b32 v15, a55
    v_mul_f32 v15, v15, v21
    v_accvgpr_write_b32 a55, v15
    v_accvgpr_read_b32 v15, a56
    v_mul_f32 v15, v15, v21
    v_accvgpr_write_b32 a56, v15
    v_accvgpr_read_b32 v15, a57
    v_mul_f32 v15, v15, v21
    v_accvgpr_write_b32 a57, v15
    v_accvgpr_read_b32 v15, a58
    v_mul_f32 v15, v15, v21
    v_accvgpr_write_b32 a58, v15
    v_accvgpr_read_b32 v15, a59
    v_mul_f32 v15, v15, v21
    v_accvgpr_write_b32 a59, v15
    v_accvgpr_read_b32 v15, a60
    v_mul_f32 v15, v15, v21
    v_accvgpr_write_b32 a60, v15
    v_accvgpr_read_b32 v15, a61
    v_mul_f32 v15, v15, v21
    v_accvgpr_write_b32 a61, v15
    v_accvgpr_read_b32 v15, a62
    v_mul_f32 v15, v15, v21
    v_accvgpr_write_b32 a62, v15
    v_accvgpr_read_b32 v15, a63
    v_mul_f32 v15, v15, v21
    v_accvgpr_write_b32 a63, v15
    v_accvgpr_read_b32 v15, a64
    v_mul_f32 v15, v15, v21
    v_accvgpr_write_b32 a64, v15
    v_accvgpr_read_b32 v15, a65
    v_mul_f32 v15, v15, v21
    v_accvgpr_write_b32 a65, v15
    v_accvgpr_read_b32 v15, a66
    v_mul_f32 v15, v15, v21
    v_accvgpr_write_b32 a66, v15
    v_accvgpr_read_b32 v15, a67
    v_mul_f32 v15, v15, v21
    v_accvgpr_write_b32 a67, v15
    v_accvgpr_read_b32 v15, a68
    v_mul_f32 v15, v15, v21
    v_accvgpr_write_b32 a68, v15
    v_accvgpr_read_b32 v15, a69
    v_mul_f32 v15, v15, v21
    v_accvgpr_write_b32 a69, v15
    v_accvgpr_read_b32 v15, a70
    v_mul_f32 v15, v15, v21
    v_accvgpr_write_b32 a70, v15
    v_accvgpr_read_b32 v15, a71
    v_mul_f32 v15, v15, v21
    v_accvgpr_write_b32 a71, v15
    v_accvgpr_read_b32 v15, a72
    v_mul_f32 v15, v15, v21
    v_accvgpr_write_b32 a72, v15
    v_accvgpr_read_b32 v15, a73
    v_mul_f32 v15, v15, v21
    v_accvgpr_write_b32 a73, v15
    v_accvgpr_read_b32 v15, a74
    v_mul_f32 v15, v15, v21
    v_accvgpr_write_b32 a74, v15
    v_accvgpr_read_b32 v15, a75
    v_mul_f32 v15, v15, v21
    v_accvgpr_write_b32 a75, v15
    v_accvgpr_read_b32 v15, a76
    v_mul_f32 v15, v15, v21
    v_accvgpr_write_b32 a76, v15
    v_accvgpr_read_b32 v15, a77
    v_mul_f32 v15, v15, v21
    v_accvgpr_write_b32 a77, v15
    v_accvgpr_read_b32 v15, a78
    v_mul_f32 v15, v15, v21
    v_accvgpr_write_b32 a78, v15
    v_accvgpr_read_b32 v15, a79
    v_mul_f32 v15, v15, v21
    v_accvgpr_write_b32 a79, v15
    v_accvgpr_read_b32 v15, a80
    v_mul_f32 v15, v15, v21
    v_accvgpr_write_b32 a80, v15
    v_accvgpr_read_b32 v15, a81
    v_mul_f32 v15, v15, v21
    v_accvgpr_write_b32 a81, v15
    v_accvgpr_read_b32 v15, a82
    v_mul_f32 v15, v15, v21
    v_accvgpr_write_b32 a82, v15
    v_accvgpr_read_b32 v15, a83
    v_mul_f32 v15, v15, v21
    v_accvgpr_write_b32 a83, v15
    v_accvgpr_read_b32 v15, a84
    v_mul_f32 v15, v15, v21
    v_accvgpr_write_b32 a84, v15
    v_accvgpr_read_b32 v15, a85
    v_mul_f32 v15, v15, v21
    v_accvgpr_write_b32 a85, v15
    v_accvgpr_read_b32 v15, a86
    v_mul_f32 v15, v15, v21
    v_accvgpr_write_b32 a86, v15
    v_accvgpr_read_b32 v15, a87
    v_mul_f32 v15, v15, v21
    v_accvgpr_write_b32 a87, v15
    v_accvgpr_read_b32 v15, a88
    v_mul_f32 v15, v15, v21
    v_accvgpr_write_b32 a88, v15
    v_accvgpr_read_b32 v15, a89
    v_mul_f32 v15, v15, v21
    v_accvgpr_write_b32 a89, v15
    v_accvgpr_read_b32 v15, a90
    v_mul_f32 v15, v15, v21
    v_accvgpr_write_b32 a90, v15
    v_accvgpr_read_b32 v15, a91
    v_mul_f32 v15, v15, v21
    v_accvgpr_write_b32 a91, v15
    v_accvgpr_read_b32 v15, a92
    v_mul_f32 v15, v15, v21
    v_accvgpr_write_b32 a92, v15
    v_accvgpr_read_b32 v15, a93
    v_mul_f32 v15, v15, v21
    v_accvgpr_write_b32 a93, v15
    v_accvgpr_read_b32 v15, a94
    v_mul_f32 v15, v15, v21
    v_accvgpr_write_b32 a94, v15
    v_accvgpr_read_b32 v15, a95
    v_mul_f32 v15, v15, v21
    v_accvgpr_write_b32 a95, v15
    v_fma_f32 v104, v104, s28, v13
    v_fma_f32 v105, v105, s28, v13
    v_exp_f32 v104, v104
    v_exp_f32 v105, v105
    s_nop 0
    v_cvt_pk_bf16_f32 v42, v104, v105
    v_fma_f32 v106, v106, s28, v13
    v_fma_f32 v107, v107, s28, v13
    v_exp_f32 v106, v106
    v_exp_f32 v107, v107
    s_nop 0
    v_cvt_pk_bf16_f32 v43, v106, v107
    v_fma_f32 v108, v108, s28, v13
    v_fma_f32 v109, v109, s28, v13
    v_exp_f32 v108, v108
    v_exp_f32 v109, v109
    s_nop 0
    v_cvt_pk_bf16_f32 v40, v108, v109
    v_fma_f32 v110, v110, s28, v13
    v_fma_f32 v111, v111, s28, v13
    v_exp_f32 v110, v110
    v_exp_f32 v111, v111
    s_nop 0
    v_cvt_pk_bf16_f32 v41, v110, v111
    v_mfma_f32_16x16x32_bf16 v[48:51], a[236:239], v[16:19], v[44:47]
    v_mfma_f32_16x16x32_bf16 v[48:51], a[240:243], v[22:25], v[48:51]
    v_mfma_f32_16x16x32_bf16 v[48:51], a[244:247], v[28:31], v[48:51]
    v_mfma_f32_16x16x32_bf16 v[48:51], a[248:251], v[34:37], v[48:51]
    v_mfma_f32_16x16x32_bf16 v[48:51], a[252:255], v[40:43], v[48:51]
    s_nop 15
    s_setpc_b64 s[40:41]
L_rare4_0:
    s_nop 15
    v_mbcnt_lo_u32_b32 v31, -1, 0
    v_mbcnt_hi_u32_b32 v31, -1, v31
    v_and_b32 v30, 15, v31
    v_mul_u32_u24 v30, 384, v30
    v_lshrrev_b32 v31, 4, v31
    v_lshl_add_u32 v30, v31, 4, v30
    s_add_u32 s69, s39, 0
    buffer_load_dwordx4 v[44:47], v30, s[4:7], s69 offen offset:0
    s_waitcnt vmcnt(0)
    v_mfma_f32_16x16x32_bf16 v[104:107], v[44:47], a[96:99], 0
    s_nop 7
    buffer_load_dwordx4 v[44:47], v30, s[4:7], s69 offen offset:64
    s_waitcnt vmcnt(0)
    v_mfma_f32_16x16x32_bf16 v[104:107], v[44:47], a[100:103], v[104:107]
    s_nop 7
    buffer_load_dwordx4 v[44:47], v30, s[4:7], s69 offen offset:128
    s_waitcnt vmcnt(0)
    v_mfma_f32_16x16x32_bf16 v[104:107], v[44:47], a[104:107], v[104:107]
    s_nop 7
    buffer_load_dwordx4 v[44:47], v30, s[4:7], s69 offen offset:192
    s_waitcnt vmcnt(0)
    v_mfma_f32_16x16x32_bf16 v[104:107], v[44:47], a[108:111], v[104:107]
    s_nop 7
    buffer_load_dwordx4 v[44:47], v30, s[4:7], s69 offen offset:256
    s_waitcnt vmcnt(0)
    v_mfma_f32_16x16x32_bf16 v[104:107], v[44:47], a[112:115], v[104:107]
    s_nop 7
    buffer_load_dwordx4 v[44:47], v30, s[4:7], s69 offen offset:320
    s_waitcnt vmcnt(0)
    v_mfma_f32_16x16x32_bf16 v[104:107], v[44:47], a[116:119], v[104:107]
    s_nop 7
    s_add_u32 s69, s39, 6144
    buffer_load_dwordx4 v[44:47], v30, s[4:7], s69 offen offset:0
    s_waitcnt vmcnt(0)
    v_mfma_f32_16x16x32_bf16 v[108:111], v[44:47], a[96:99], 0
    s_nop 7
    buffer_load_dwordx4 v[44:47], v30, s[4:7], s69 offen offset:64
    s_waitcnt vmcnt(0)
    v_mfma_f32_16x16x32_bf16 v[108:111], v[44:47], a[100:103], v[108:111]
    s_nop 7
    buffer_load_dwordx4 v[44:47], v30, s[4:7], s69 offen offset:128
    s_waitcnt vmcnt(0)
    v_mfma_f32_16x16x32_bf16 v[108:111], v[44:47], a[104:107], v[108:111]
    s_nop 7
    buffer_load_dwordx4 v[44:47], v30, s[4:7], s69 offen offset:192
    s_waitcnt vmcnt(0)
    v_mfma_f32_16x16x32_bf16 v[108:111], v[44:47], a[108:111], v[108:111]
    s_nop 7
    buffer_load_dwordx4 v[44:47], v30, s[4:7], s69 offen offset:256
    s_waitcnt vmcnt(0)
    v_mfma_f32_16x16x32_bf16 v[108:111], v[44:47], a[112:115], v[108:111]
    s_nop 7
    buffer_load_dwordx4 v[44:47], v30, s[4:7], s69 offen offset:320
    s_waitcnt vmcnt(0)
    v_mfma_f32_16x16x32_bf16 v[108:111], v[44:47], a[116:119], v[108:111]
    s_nop 7
    s_nop 15
    v_max3_f32 v18, v104, v105, v106
    v_max3_f32 v18, v18, v107, v108
    v_max3_f32 v18, v18, v109, v110
    v_max_f32 v18, v18, v111
    v_mov_b32 v19, v18
    s_nop 1
    v_permlane32_swap_b32 v19, v18
    v_max_f32 v18, v18, v19
    v_mov_b32 v19, v18
    s_nop 1
    v_permlane16_swap_b32 v19, v18
    v_max_f32 v18, v18, v19
    v_fma_f32 v18, v18, s28, v9
    v_max_f32 v24, 0, v18
    v_sub_f32 v9, v9, v24
    v_sub_f32 v25, 0, v24
    v_exp_f32 v25, v25
    s_nop 0
    v_mul_f32 v19, v48, v25
    v_cndmask_b32_e64 v48, v19, v48, s[60:61]
    v_cndmask_b32_e64 v48, v48, 0, s[46:47]
    v_mul_f32 v112, v112, v25
    v_mul_f32 v113, v113, v25
    v_mul_f32 v114, v114, v25
    v_mul_f32 v115, v115, v25
    v_mul_f32 v116, v116, v25
    v_mul_f32 v117, v117, v25
    v_mul_f32 v118, v118, v25
    v_mul_f32 v119, v119, v25
    v_mul_f32 v120, v120, v25
    v_mul_f32 v121, v121, v25
    v_mul_f32 v122, v122, v25
    v_mul_f32 v123, v123, v25
    v_mul_f32 v124, v124, v25
    v_mul_f32 v125, v125, v25
    v_mul_f32 v126, v126, v25
    v_mul_f32 v127, v127, v25
    v_mul_f32 v128, v128, v25
    v_mul_f32 v129, v129, v25
    v_mul_f32 v130, v130, v25
    v_mul_f32 v131, v131, v25
    v_mul_f32 v132, v132, v25
    v_mul_f32 v133, v133, v25
    v_mul_f32 v134, v134, v25
    v_mul_f32 v135, v135, v25
    v_mul_f32 v136, v136, v25
    v_mul_f32 v137, v137, v25
    v_mul_f32 v138, v138, v25
    v_mul_f32 v139, v139, v25
    v_mul_f32 v140, v140, v25
    v_mul_f32 v141, v141, v25
    v_mul_f32 v142, v142, v25
    v_mul_f32 v143, v143, v25
    v_mul_f32 v144, v144, v25
    v_mul_f32 v145, v145, v25
    v_mul_f32 v146, v146, v25
    v_mul_f32 v147, v147, v25
    v_mul_f32 v148, v148, v25
    v_mul_f32 v149, v149, v25
    v_mul_f32 v150, v150, v25
    v_mul_f32 v151, v151, v25
    v_mul_f32 v152, v152, v25
    v_mul_f32 v153, v153, v25
    v_mul_f32 v154, v154, v25
    v_mul_f32 v155, v155, v25
    v_mul_f32 v156, v156, v25
    v_mul_f32 v157, v157, v25
    v_mul_f32 v158, v158, v25
    v_mul_f32 v159, v159, v25
    v_fma_f32 v104, v104, s28, v9
    v_fma_f32 v105, v105, s28, v9
    v_exp_f32 v104, v104
    v_exp_f32 v105, v105
    s_nop 0
    v_cvt_pk_bf16_f32 v14, v104, v105
    v_fma_f32 v106, v106, s28, v9
    v_fma_f32 v107, v107, s28, v9
    v_exp_f32 v106, v106
    v_exp_f32 v107, v107
    s_nop 0
    v_cvt_pk_bf16_f32 v15, v106, v107
    v_fma_f32 v108, v108, s28, v9
    v_fma_f32 v109, v109, s28, v9
    v_exp_f32 v108, v108
    v_exp_f32 v109, v109
    s_nop 0
    v_cvt_pk_bf16_f32 v16, v108, v109
    v_fma_f32 v110, v110, s28, v9
    v_fma_f32 v111, v111, s28, v9
    v_exp_f32 v110, v110
    v_exp_f32 v111, v111
    s_nop 0
    v_cvt_pk_bf16_f32 v17, v110, v111
    s_add_u32 s69, s39, 0
    buffer_load_dwordx4 v[44:47], v30, s[4:7], s69 offen offset:0
    s_waitcnt vmcnt(0)
    v_mfma_f32_16x16x32_bf16 v[104:107], v[44:47], a[120:123], 0
    s_nop 7
    buffer_load_dwordx4 v[44:47], v30, s[4:7], s69 offen offset:64
    s_waitcnt vmcnt(0)
    v_mfma_f32_16x16x32_bf16 v[104:107], v[44:47], a[124:127], v[104:107]
    s_nop 7
    buffer_load_dwordx4 v[44:47], v30, s[4:7], s69 offen offset:128
    s_waitcnt vmcnt(0)
    v_mfma_f32_16x16x32_bf16 v[104:107], v[44:47], a[128:131], v[104:107]
    s_nop 7
    buffer_load_dwordx4 v[44:47], v30, s[4:7], s69 offen offset:192
    s_waitcnt vmcnt(0)
    v_mfma_f32_16x16x32_bf16 v[104:107], v[44:47], a[132:135], v[104:107]
    s_nop 7
    buffer_load_dwordx4 v[44:47], v30, s[4:7], s69 offen offset:256
    s_waitcnt vmcnt(0)
    v_mfma_f32_16x16x32_bf16 v[104:107], v[44:47], a[136:139], v[104:107]
    s_nop 7
    buffer_load_dwordx4 v[44:47], v30, s[4:7], s69 offen offset:320
    s_waitcnt vmcnt(0)
    v_mfma_f32_16x16x32_bf16 v[104:107], v[44:47], a[140:143], v[104:107]
    s_nop 7
    s_add_u32 s69, s39, 6144
    buffer_load_dwordx4 v[44:47], v30, s[4:7], s69 offen offset:0
    s_waitcnt vmcnt(0)
    v_mfma_f32_16x16x32_bf16 v[108:111], v[44:47], a[120:123], 0
    s_nop 7
    buffer_load_dwordx4 v[44:47], v30, s[4:7], s69 offen offset:64
    s_waitcnt vmcnt(0)
    v_mfma_f32_16x16x32_bf16 v[108:111], v[44:47], a[124:127], v[108:111]
    s_nop 7
    buffer_load_dwordx4 v[44:47], v30, s[4:7], s69 offen offset:128
    s_waitcnt vmcnt(0)
    v_mfma_f32_16x16x32_bf16 v[108:111], v[44:47], a[128:131], v[108:111]
    s_nop 7
    buffer_load_dwordx4 v[44:47], v30, s[4:7], s69 offen offset:192
    s_waitcnt vmcnt(0)
    v_mfma_f32_16x16x32_bf16 v[108:111], v[44:47], a[132:135], v[108:111]
    s_nop 7
    buffer_load_dwordx4 v[44:47], v30, s[4:7], s69 offen offset:256
    s_waitcnt vmcnt(0)
    v_mfma_f32_16x16x32_bf16 v[108:111], v[44:47], a[136:139], v[108:111]
    s_nop 7
    buffer_load_dwordx4 v[44:47], v30, s[4:7], s69 offen offset:320
    s_waitcnt vmcnt(0)
    v_mfma_f32_16x16x32_bf16 v[108:111], v[44:47], a[140:143], v[108:111]
    s_nop 7
    s_nop 15
    v_max3_f32 v18, v104, v105, v106
    v_max3_f32 v18, v18, v107, v108
    v_max3_f32 v18, v18, v109, v110
    v_max_f32 v18, v18, v111
    v_mov_b32 v19, v18
    s_nop 1
    v_permlane32_swap_b32 v19, v18
    v_max_f32 v18, v18, v19
    v_mov_b32 v19, v18
    s_nop 1
    v_permlane16_swap_b32 v19, v18
    v_max_f32 v18, v18, v19
    v_fma_f32 v18, v18, s28, v10
    v_max_f32 v24, 0, v18
    v_sub_f32 v10, v10, v24
    v_sub_f32 v25, 0, v24
    v_exp_f32 v25, v25
    s_nop 0
    v_mul_f32 v49, v49, v25
    v_mul_f32 v160, v160, v25
    v_mul_f32 v161, v161, v25
    v_mul_f32 v162, v162, v25
    v_mul_f32 v163, v163, v25
    v_mul_f32 v164, v164, v25
    v_mul_f32 v165, v165, v25
    v_mul_f32 v166, v166, v25
    v_mul_f32 v167, v167, v25
    v_mul_f32 v168, v168, v25
    v_mul_f32 v169, v169, v25
    v_mul_f32 v170, v170, v25
    v_mul_f32 v171, v171, v25
    v_mul_f32 v172, v172, v25
    v_mul_f32 v173, v173, v25
    v_mul_f32 v174, v174, v25
    v_mul_f32 v175, v175, v25
    v_mul_f32 v176, v176, v25
    v_mul_f32 v177, v177, v25
    v_mul_f32 v178, v178, v25
    v_mul_f32 v179, v179, v25
    v_mul_f32 v180, v180, v25
    v_mul_f32 v181, v181, v25
    v_mul_f32 v182, v182, v25
    v_mul_f32 v183, v183, v25
    v_mul_f32 v184, v184, v25
    v_mul_f32 v185, v185, v25
    v_mul_f32 v186, v186, v25
    v_mul_f32 v187, v187, v25
    v_mul_f32 v188, v188, v25
    v_mul_f32 v189, v189, v25
    v_mul_f32 v190, v190, v25
    v_mul_f32 v191, v191, v25
    v_mul_f32 v192, v192, v25
    v_mul_f32 v193, v193, v25
    v_mul_f32 v194, v194, v25
    v_mul_f32 v195, v195, v25
    v_mul_f32 v196, v196, v25
    v_mul_f32 v197, v197, v25
    v_mul_f32 v198, v198, v25
    v_mul_f32 v199, v199, v25
    v_mul_f32 v200, v200, v25
    v_mul_f32 v201, v201, v25
    v_mul_f32 v202, v202, v25
    v_mul_f32 v203, v203, v25
    v_mul_f32 v204, v204, v25
    v_mul_f32 v205, v205, v25
    v_mul_f32 v206, v206, v25
    v_mul_f32 v207, v207, v25
    v_fma_f32 v104, v104, s28, v10
    v_fma_f32 v105, v105, s28, v10
    v_exp_f32 v104, v104
    v_exp_f32 v105, v105
    s_nop 0
    v_cvt_pk_bf16_f32 v20, v104, v105
    v_fma_f32 v106, v106, s28, v10
    v_fma_f32 v107, v107, s28, v10
    v_exp_f32 v106, v106
    v_exp_f32 v107, v107
    s_nop 0
    v_cvt_pk_bf16_f32 v21, v106, v107
    v_fma_f32 v108, v108, s28, v10
    v_fma_f32 v109, v109, s28, v10
    v_exp_f32 v108, v108
    v_exp_f32 v109, v109
    s_nop 0
    v_cvt_pk_bf16_f32 v22, v108, v109
    v_fma_f32 v110, v110, s28, v10
    v_fma_f32 v111, v111, s28, v10
    v_exp_f32 v110, v110
    v_exp_f32 v111, v111
    s_nop 0
    v_cvt_pk_bf16_f32 v23, v110, v111
    s_add_u32 s69, s39, 0
    buffer_load_dwordx4 v[44:47], v30, s[4:7], s69 offen offset:0
    s_waitcnt vmcnt(0)
    v_mfma_f32_16x16x32_bf16 v[104:107], v[44:47], a[144:147], 0
    s_nop 7
    buffer_load_dwordx4 v[44:47], v30, s[4:7], s69 offen offset:64
    s_waitcnt vmcnt(0)
    v_mfma_f32_16x16x32_bf16 v[104:107], v[44:47], a[148:151], v[104:107]
    s_nop 7
    buffer_load_dwordx4 v[44:47], v30, s[4:7], s69 offen offset:128
    s_waitcnt vmcnt(0)
    v_mfma_f32_16x16x32_bf16 v[104:107], v[44:47], a[152:155], v[104:107]
    s_nop 7
    buffer_load_dwordx4 v[44:47], v30, s[4:7], s69 offen offset:192
    s_waitcnt vmcnt(0)
    v_mfma_f32_16x16x32_bf16 v[104:107], v[44:47], a[156:159], v[104:107]
    s_nop 7
    buffer_load_dwordx4 v[44:47], v30, s[4:7], s69 offen offset:256
    s_waitcnt vmcnt(0)
    v_mfma_f32_16x16x32_bf16 v[104:107], v[44:47], a[160:163], v[104:107]
    s_nop 7
    buffer_load_dwordx4 v[44:47], v30, s[4:7], s69 offen offset:320
    s_waitcnt vmcnt(0)
    v_mfma_f32_16x16x32_bf16 v[104:107], v[44:47], a[164:167], v[104:107]
    s_nop 7
    s_add_u32 s69, s39, 6144
    buffer_load_dwordx4 v[44:47], v30, s[4:7], s69 offen offset:0
    s_waitcnt vmcnt(0)
    v_mfma_f32_16x16x32_bf16 v[108:111], v[44:47], a[144:147], 0
    s_nop 7
    buffer_load_dwordx4 v[44:47], v30, s[4:7], s69 offen offset:64
    s_waitcnt vmcnt(0)
    v_mfma_f32_16x16x32_bf16 v[108:111], v[44:47], a[148:151], v[108:111]
    s_nop 7
    buffer_load_dwordx4 v[44:47], v30, s[4:7], s69 offen offset:128
    s_waitcnt vmcnt(0)
    v_mfma_f32_16x16x32_bf16 v[108:111], v[44:47], a[152:155], v[108:111]
    s_nop 7
    buffer_load_dwordx4 v[44:47], v30, s[4:7], s69 offen offset:192
    s_waitcnt vmcnt(0)
    v_mfma_f32_16x16x32_bf16 v[108:111], v[44:47], a[156:159], v[108:111]
    s_nop 7
    buffer_load_dwordx4 v[44:47], v30, s[4:7], s69 offen offset:256
    s_waitcnt vmcnt(0)
    v_mfma_f32_16x16x32_bf16 v[108:111], v[44:47], a[160:163], v[108:111]
    s_nop 7
    buffer_load_dwordx4 v[44:47], v30, s[4:7], s69 offen offset:320
    s_waitcnt vmcnt(0)
    v_mfma_f32_16x16x32_bf16 v[108:111], v[44:47], a[164:167], v[108:111]
    s_nop 7
    s_nop 15
    v_max3_f32 v18, v104, v105, v106
    v_max3_f32 v18, v18, v107, v108
    v_max3_f32 v18, v18, v109, v110
    v_max_f32 v18, v18, v111
    v_mov_b32 v19, v18
    s_nop 1
    v_permlane32_swap_b32 v19, v18
    v_max_f32 v18, v18, v19
    v_mov_b32 v19, v18
    s_nop 1
    v_permlane16_swap_b32 v19, v18
    v_max_f32 v18, v18, v19
    v_fma_f32 v18, v18, s28, v11
    v_max_f32 v24, 0, v18
    v_sub_f32 v11, v11, v24
    v_sub_f32 v25, 0, v24
    v_exp_f32 v25, v25
    s_nop 0
    v_mul_f32 v50, v50, v25
    v_mul_f32 v208, v208, v25
    v_mul_f32 v209, v209, v25
    v_mul_f32 v210, v210, v25
    v_mul_f32 v211, v211, v25
    v_mul_f32 v212, v212, v25
    v_mul_f32 v213, v213, v25
    v_mul_f32 v214, v214, v25
    v_mul_f32 v215, v215, v25
    v_mul_f32 v216, v216, v25
    v_mul_f32 v217, v217, v25
    v_mul_f32 v218, v218, v25
    v_mul_f32 v219, v219, v25
    v_mul_f32 v220, v220, v25
    v_mul_f32 v221, v221, v25
    v_mul_f32 v222, v222, v25
    v_mul_f32 v223, v223, v25
    v_mul_f32 v224, v224, v25
    v_mul_f32 v225, v225, v25
    v_mul_f32 v226, v226, v25
    v_mul_f32 v227, v227, v25
    v_mul_f32 v228, v228, v25
    v_mul_f32 v229, v229, v25
    v_mul_f32 v230, v230, v25
    v_mul_f32 v231, v231, v25
    v_mul_f32 v232, v232, v25
    v_mul_f32 v233, v233, v25
    v_mul_f32 v234, v234, v25
    v_mul_f32 v235, v235, v25
    v_mul_f32 v236, v236, v25
    v_mul_f32 v237, v237, v25
    v_mul_f32 v238, v238, v25
    v_mul_f32 v239, v239, v25
    v_mul_f32 v240, v240, v25
    v_mul_f32 v241, v241, v25
    v_mul_f32 v242, v242, v25
    v_mul_f32 v243, v243, v25
    v_mul_f32 v244, v244, v25
    v_mul_f32 v245, v245, v25
    v_mul_f32 v246, v246, v25
    v_mul_f32 v247, v247, v25
    v_mul_f32 v248, v248, v25
    v_mul_f32 v249, v249, v25
    v_mul_f32 v250, v250, v25
    v_mul_f32 v251, v251, v25
    v_mul_f32 v252, v252, v25
    v_mul_f32 v253, v253, v25
    v_mul_f32 v254, v254, v25
    v_mul_f32 v255, v255, v25
    v_fma_f32 v104, v104, s28, v11
    v_fma_f32 v105, v105, s28, v11
    v_exp_f32 v104, v104
    v_exp_f32 v105, v105
    s_nop 0
    v_cvt_pk_bf16_f32 v26, v104, v105
    v_fma_f32 v106, v106, s28, v11
    v_fma_f32 v107, v107, s28, v11
    v_exp_f32 v106, v106
    v_exp_f32 v107, v107
    s_nop 0
    v_cvt_pk_bf16_f32 v27, v106, v107
    v_fma_f32 v108, v108, s28, v11
    v_fma_f32 v109, v109, s28, v11
    v_exp_f32 v108, v108
    v_exp_f32 v109, v109
    s_nop 0
    v_cvt_pk_bf16_f32 v28, v108, v109
    v_fma_f32 v110, v110, s28, v11
    v_fma_f32 v111, v111, s28, v11
    v_exp_f32 v110, v110
    v_exp_f32 v111, v111
    s_nop 0
    v_cvt_pk_bf16_f32 v29, v110, v111
    s_add_u32 s69, s39, 0
    buffer_load_dwordx4 v[44:47], v30, s[4:7], s69 offen offset:0
    s_waitcnt vmcnt(0)
    v_mfma_f32_16x16x32_bf16 v[104:107], v[44:47], a[168:171], 0
    s_nop 7
    buffer_load_dwordx4 v[44:47], v30, s[4:7], s69 offen offset:64
    s_waitcnt vmcnt(0)
    v_mfma_f32_16x16x32_bf16 v[104:107], v[44:47], a[172:175], v[104:107]
    s_nop 7
    buffer_load_dwordx4 v[44:47], v30, s[4:7], s69 offen offset:128
    s_waitcnt vmcnt(0)
    v_mfma_f32_16x16x32_bf16 v[104:107], v[44:47], a[176:179], v[104:107]
    s_nop 7
    buffer_load_dwordx4 v[44:47], v30, s[4:7], s69 offen offset:192
    s_waitcnt vmcnt(0)
    v_mfma_f32_16x16x32_bf16 v[104:107], v[44:47], a[180:183], v[104:107]
    s_nop 7
    buffer_load_dwordx4 v[44:47], v30, s[4:7], s69 offen offset:256
    s_waitcnt vmcnt(0)
    v_mfma_f32_16x16x32_bf16 v[104:107], v[44:47], a[184:187], v[104:107]
    s_nop 7
    buffer_load_dwordx4 v[44:47], v30, s[4:7], s69 offen offset:320
    s_waitcnt vmcnt(0)
    v_mfma_f32_16x16x32_bf16 v[104:107], v[44:47], a[188:191], v[104:107]
    s_nop 7
    s_add_u32 s69, s39, 6144
    buffer_load_dwordx4 v[44:47], v30, s[4:7], s69 offen offset:0
    s_waitcnt vmcnt(0)
    v_mfma_f32_16x16x32_bf16 v[108:111], v[44:47], a[168:171], 0
    s_nop 7
    buffer_load_dwordx4 v[44:47], v30, s[4:7], s69 offen offset:64
    s_waitcnt vmcnt(0)
    v_mfma_f32_16x16x32_bf16 v[108:111], v[44:47], a[172:175], v[108:111]
    s_nop 7
    buffer_load_dwordx4 v[44:47], v30, s[4:7], s69 offen offset:128
    s_waitcnt vmcnt(0)
    v_mfma_f32_16x16x32_bf16 v[108:111], v[44:47], a[176:179], v[108:111]
    s_nop 7
    buffer_load_dwordx4 v[44:47], v30, s[4:7], s69 offen offset:192
    s_waitcnt vmcnt(0)
    v_mfma_f32_16x16x32_bf16 v[108:111], v[44:47], a[180:183], v[108:111]
    s_nop 7
    buffer_load_dwordx4 v[44:47], v30, s[4:7], s69 offen offset:256
    s_waitcnt vmcnt(0)
    v_mfma_f32_16x16x32_bf16 v[108:111], v[44:47], a[184:187], v[108:111]
    s_nop 7
    buffer_load_dwordx4 v[44:47], v30, s[4:7], s69 offen offset:320
    s_waitcnt vmcnt(0)
    v_mfma_f32_16x16x32_bf16 v[108:111], v[44:47], a[188:191], v[108:111]
    s_nop 7
    s_nop 15
    v_max3_f32 v18, v104, v105, v106
    v_max3_f32 v18, v18, v107, v108
    v_max3_f32 v18, v18, v109, v110
    v_max_f32 v18, v18, v111
    v_mov_b32 v19, v18
    s_nop 1
    v_permlane32_swap_b32 v19, v18
    v_max_f32 v18, v18, v19
    v_mov_b32 v19, v18
    s_nop 1
    v_permlane16_swap_b32 v19, v18
    v_max_f32 v18, v18, v19
    v_fma_f32 v18, v18, s28, v12
    v_max_f32 v24, 0, v18
    v_sub_f32 v12, v12, v24
    v_sub_f32 v25, 0, v24
    v_exp_f32 v25, v25
    s_nop 0
    v_mul_f32 v51, v51, v25
    v_accvgpr_read_b32 v19, a0
    v_mul_f32 v19, v19, v25
    v_accvgpr_write_b32 a0, v19
    v_accvgpr_read_b32 v19, a1
    v_mul_f32 v19, v19, v25
    v_accvgpr_write_b32 a1, v19
    v_accvgpr_read_b32 v19, a2
    v_mul_f32 v19, v19, v25
    v_accvgpr_write_b32 a2, v19
    v_accvgpr_read_b32 v19, a3
    v_mul_f32 v19, v19, v25
    v_accvgpr_write_b32 a3, v19
    v_accvgpr_read_b32 v19, a4
    v_mul_f32 v19, v19, v25
    v_accvgpr_write_b32 a4, v19
    v_accvgpr_read_b32 v19, a5
    v_mul_f32 v19, v19, v25
    v_accvgpr_write_b32 a5, v19
    v_accvgpr_read_b32 v19, a6
    v_mul_f32 v19, v19, v25
    v_accvgpr_write_b32 a6, v19
    v_accvgpr_read_b32 v19, a7
    v_mul_f32 v19, v19, v25
    v_accvgpr_write_b32 a7, v19
    v_accvgpr_read_b32 v19, a8
    v_mul_f32 v19, v19, v25
    v_accvgpr_write_b32 a8, v19
    v_accvgpr_read_b32 v19, a9
    v_mul_f32 v19, v19, v25
    v_accvgpr_write_b32 a9, v19
    v_accvgpr_read_b32 v19, a10
    v_mul_f32 v19, v19, v25
    v_accvgpr_write_b32 a10, v19
    v_accvgpr_read_b32 v19, a11
    v_mul_f32 v19, v19, v25
    v_accvgpr_write_b32 a11, v19
    v_accvgpr_read_b32 v19, a12
    v_mul_f32 v19, v19, v25
    v_accvgpr_write_b32 a12, v19
    v_accvgpr_read_b32 v19, a13
    v_mul_f32 v19, v19, v25
    v_accvgpr_write_b32 a13, v19
    v_accvgpr_read_b32 v19, a14
    v_mul_f32 v19, v19, v25
    v_accvgpr_write_b32 a14, v19
    v_accvgpr_read_b32 v19, a15
    v_mul_f32 v19, v19, v25
    v_accvgpr_write_b32 a15, v19
    v_accvgpr_read_b32 v19, a16
    v_mul_f32 v19, v19, v25
    v_accvgpr_write_b32 a16, v19
    v_accvgpr_read_b32 v19, a17
    v_mul_f32 v19, v19, v25
    v_accvgpr_write_b32 a17, v19
    v_accvgpr_read_b32 v19, a18
    v_mul_f32 v19, v19, v25
    v_accvgpr_write_b32 a18, v19
    v_accvgpr_read_b32 v19, a19
    v_mul_f32 v19, v19, v25
    v_accvgpr_write_b32 a19, v19
    v_accvgpr_read_b32 v19, a20
    v_mul_f32 v19, v19, v25
    v_accvgpr_write_b32 a20, v19
    v_accvgpr_read_b32 v19, a21
    v_mul_f32 v19, v19, v25
    v_accvgpr_write_b32 a21, v19
    v_accvgpr_read_b32 v19, a22
    v_mul_f32 v19, v19, v25
    v_accvgpr_write_b32 a22, v19
    v_accvgpr_read_b32 v19, a23
    v_mul_f32 v19, v19, v25
    v_accvgpr_write_b32 a23, v19
    v_accvgpr_read_b32 v19, a24
    v_mul_f32 v19, v19, v25
    v_accvgpr_write_b32 a24, v19
    v_accvgpr_read_b32 v19, a25
    v_mul_f32 v19, v19, v25
    v_accvgpr_write_b32 a25, v19
    v_accvgpr_read_b32 v19, a26
    v_mul_f32 v19, v19, v25
    v_accvgpr_write_b32 a26, v19
    v_accvgpr_read_b32 v19, a27
    v_mul_f32 v19, v19, v25
    v_accvgpr_write_b32 a27, v19
    v_accvgpr_read_b32 v19, a28
    v_mul_f32 v19, v19, v25
    v_accvgpr_write_b32 a28, v19
    v_accvgpr_read_b32 v19, a29
    v_mul_f32 v19, v19, v25
    v_accvgpr_write_b32 a29, v19
    v_accvgpr_read_b32 v19, a30
    v_mul_f32 v19, v19, v25
    v_accvgpr_write_b32 a30, v19
    v_accvgpr_read_b32 v19, a31
    v_mul_f32 v19, v19, v25
    v_accvgpr_write_b32 a31, v19
    v_accvgpr_read_b32 v19, a32
    v_mul_f32 v19, v19, v25
    v_accvgpr_write_b32 a32, v19
    v_accvgpr_read_b32 v19, a33
    v_mul_f32 v19, v19, v25
    v_accvgpr_write_b32 a33, v19
    v_accvgpr_read_b32 v19, a34
    v_mul_f32 v19, v19, v25
    v_accvgpr_write_b32 a34, v19
    v_accvgpr_read_b32 v19, a35
    v_mul_f32 v19, v19, v25
    v_accvgpr_write_b32 a35, v19
    v_accvgpr_read_b32 v19, a36
    v_mul_f32 v19, v19, v25
    v_accvgpr_write_b32 a36, v19
    v_accvgpr_read_b32 v19, a37
    v_mul_f32 v19, v19, v25
    v_accvgpr_write_b32 a37, v19
    v_accvgpr_read_b32 v19, a38
    v_mul_f32 v19, v19, v25
    v_accvgpr_write_b32 a38, v19
    v_accvgpr_read_b32 v19, a39
    v_mul_f32 v19, v19, v25
    v_accvgpr_write_b32 a39, v19
    v_accvgpr_read_b32 v19, a40
    v_mul_f32 v19, v19, v25
    v_accvgpr_write_b32 a40, v19
    v_accvgpr_read_b32 v19, a41
    v_mul_f32 v19, v19, v25
    v_accvgpr_write_b32 a41, v19
    v_accvgpr_read_b32 v19, a42
    v_mul_f32 v19, v19, v25
    v_accvgpr_write_b32 a42, v19
    v_accvgpr_read_b32 v19, a43
    v_mul_f32 v19, v19, v25
    v_accvgpr_write_b32 a43, v19
    v_accvgpr_read_b32 v19, a44
    v_mul_f32 v19, v19, v25
    v_accvgpr_write_b32 a44, v19
    v_accvgpr_read_b32 v19, a45
    v_mul_f32 v19, v19, v25
    v_accvgpr_write_b32 a45, v19
    v_accvgpr_read_b32 v19, a46
    v_mul_f32 v19, v19, v25
    v_accvgpr_write_b32 a46, v19
    v_accvgpr_read_b32 v19, a47
    v_mul_f32 v19, v19, v25
    v_accvgpr_write_b32 a47, v19
    v_fma_f32 v104, v104, s28, v12
    v_fma_f32 v105, v105, s28, v12
    v_exp_f32 v104, v104
    v_exp_f32 v105, v105
    s_nop 0
    v_cvt_pk_bf16_f32 v32, v104, v105
    v_fma_f32 v106, v106, s28, v12
    v_fma_f32 v107, v107, s28, v12
    v_exp_f32 v106, v106
    v_exp_f32 v107, v107
    s_nop 0
    v_cvt_pk_bf16_f32 v33, v106, v107
    v_fma_f32 v108, v108, s28, v12
    v_fma_f32 v109, v109, s28, v12
    v_exp_f32 v108, v108
    v_exp_f32 v109, v109
    s_nop 0
    v_cvt_pk_bf16_f32 v34, v108, v109
    v_fma_f32 v110, v110, s28, v12
    v_fma_f32 v111, v111, s28, v12
    v_exp_f32 v110, v110
    v_exp_f32 v111, v111
    s_nop 0
    v_cvt_pk_bf16_f32 v35, v110, v111
    v_mfma_f32_16x16x32_bf16 v[44:47], a[236:239], v[14:17], v[48:51]
    v_mfma_f32_16x16x32_bf16 v[44:47], a[240:243], v[20:23], v[44:47]
    v_mfma_f32_16x16x32_bf16 v[44:47], a[244:247], v[26:29], v[44:47]
    v_mfma_f32_16x16x32_bf16 v[44:47], a[248:251], v[32:35], v[44:47]
    s_nop 15
    s_setpc_b64 s[40:41]
L_rare4_1:
    s_nop 15
    v_mbcnt_lo_u32_b32 v27, -1, 0
    v_mbcnt_hi_u32_b32 v27, -1, v27
    v_and_b32 v26, 15, v27
    v_mul_u32_u24 v26, 384, v26
    v_lshrrev_b32 v27, 4, v27
    v_lshl_add_u32 v26, v27, 4, v26
    s_add_u32 s69, s39, 0
    buffer_load_dwordx4 v[48:51], v26, s[4:7], s69 offen offset:0
    s_waitcnt vmcnt(0)
    v_mfma_f32_16x16x32_bf16 v[104:107], v[48:51], a[96:99], 0
    s_nop 7
    buffer_load_dwordx4 v[48:51], v26, s[4:7], s69 offen offset:64
    s_waitcnt vmcnt(0)
    v_mfma_f32_16x16x32_bf16 v[104:107], v[48:51], a[100:103], v[104:107]
    s_nop 7
    buffer_load_dwordx4 v[48:51], v26, s[4:7], s69 offen offset:128
    s_waitcnt vmcnt(0)
    v_mfma_f32_16x16x32_bf16 v[104:107], v[48:51], a[104:107], v[104:107]
    s_nop 7
    buffer_load_dwordx4 v[48:51], v26, s[4:7], s69 offen offset:192
    s_waitcnt vmcnt(0)
    v_mfma_f32_16x16x32_bf16 v[104:107], v[48:51], a[108:111], v[104:107]
    s_nop 7
    buffer_load_dwordx4 v[48:51], v26, s[4:7], s69 offen offset:256
    s_waitcnt vmcnt(0)
    v_mfma_f32_16x16x32_bf16 v[104:107], v[48:51], a[112:115], v[104:107]
    s_nop 7
    buffer_load_dwordx4 v[48:51], v26, s[4:7], s69 offen offset:320
    s_waitcnt vmcnt(0)
    v_mfma_f32_16x16x32_bf16 v[104:107], v[48:51], a[116:119], v[104:107]
    s_nop 7
    s_add_u32 s69, s39, 6144
    buffer_load_dwordx4 v[48:51], v26, s[4:7], s69 offen offset:0
    s_waitcnt vmcnt(0)
    v_mfma_f32_16x16x32_bf16 v[108:111], v[48:51], a[96:99], 0
    s_nop 7
    buffer_load_dwordx4 v[48:51], v26, s[4:7], s69 offen offset:64
    s_waitcnt vmcnt(0)
    v_mfma_f32_16x16x32_bf16 v[108:111], v[48:51], a[100:103], v[108:111]
    s_nop 7
    buffer_load_dwordx4 v[48:51], v26, s[4:7], s69 offen offset:128
    s_waitcnt vmcnt(0)
    v_mfma_f32_16x16x32_bf16 v[108:111], v[48:51], a[104:107], v[108:111]
    s_nop 7
    buffer_load_dwordx4 v[48:51], v26, s[4:7], s69 offen offset:192
    s_waitcnt vmcnt(0)
    v_mfma_f32_16x16x32_bf16 v[108:111], v[48:51], a[108:111], v[108:111]
    s_nop 7
    buffer_load_dwordx4 v[48:51], v26, s[4:7], s69 offen offset:256
    s_waitcnt vmcnt(0)
    v_mfma_f32_16x16x32_bf16 v[108:111], v[48:51], a[112:115], v[108:111]
    s_nop 7
    buffer_load_dwordx4 v[48:51], v26, s[4:7], s69 offen offset:320
    s_waitcnt vmcnt(0)
    v_mfma_f32_16x16x32_bf16 v[108:111], v[48:51], a[116:119], v[108:111]
    s_nop 7
    s_nop 15
    v_max3_f32 v14, v104, v105, v106
    v_max3_f32 v14, v14, v107, v108
    v_max3_f32 v14, v14, v109, v110
    v_max_f32 v14, v14, v111
    v_mov_b32 v15, v14
    s_nop 1
    v_permlane32_swap_b32 v15, v14
    v_max_f32 v14, v14, v15
    v_mov_b32 v15, v14
    s_nop 1
    v_permlane16_swap_b32 v15, v14
    v_max_f32 v14, v14, v15
    v_fma_f32 v14, v14, s28, v9
    v_max_f32 v20, 0, v14
    v_sub_f32 v9, v9, v20
    v_sub_f32 v21, 0, v20
    v_exp_f32 v21, v21
    s_nop 0
    v_mul_f32 v15, v44, v21
    v_cndmask_b32_e64 v44, v15, v44, s[60:61]
    v_cndmask_b32_e64 v44, v44, 0, s[46:47]
    v_mul_f32 v112, v112, v21
    v_mul_f32 v113, v113, v21
    v_mul_f32 v114, v114, v21
    v_mul_f32 v115, v115, v21
    v_mul_f32 v116, v116, v21
    v_mul_f32 v117, v117, v21
    v_mul_f32 v118, v118, v21
    v_mul_f32 v119, v119, v21
    v_mul_f32 v120, v120, v21
    v_mul_f32 v121, v121, v21
    v_mul_f32 v122, v122, v21
    v_mul_f32 v123, v123, v21
    v_mul_f32 v124, v124, v21
    v_mul_f32 v125, v125, v21
    v_mul_f32 v126, v126, v21
    v_mul_f32 v127, v127, v21
    v_mul_f32 v128, v128, v21
    v_mul_f32 v129, v129, v21
    v_mul_f32 v130, v130, v21
    v_mul_f32 v131, v131, v21
    v_mul_f32 v132, v132, v21
    v_mul_f32 v133, v133, v21
    v_mul_f32 v134, v134, v21
    v_mul_f32 v135, v135, v21
    v_mul_f32 v136, v136, v21
    v_mul_f32 v137, v137, v21
    v_mul_f32 v138, v138, v21
    v_mul_f32 v139, v139, v21
    v_mul_f32 v140, v140, v21
    v_mul_f32 v141, v141, v21
    v_mul_f32 v142, v142, v21
    v_mul_f32 v143, v143, v21
    v_mul_f32 v144, v144, v21
    v_mul_f32 v145, v145, v21
    v_mul_f32 v146, v146, v21
    v_mul_f32 v147, v147, v21
    v_mul_f32 v148, v148, v21
    v_mul_f32 v149, v149, v21
    v_mul_f32 v150, v150, v21
    v_mul_f32 v151, v151, v21
    v_mul_f32 v152, v152, v21
    v_mul_f32 v153, v153, v21
    v_mul_f32 v154, v154, v21
    v_mul_f32 v155, v155, v21
    v_mul_f32 v156, v156, v21
    v_mul_f32 v157, v157, v21
    v_mul_f32 v158, v158, v21
    v_mul_f32 v159, v159, v21
    v_fma_f32 v104, v104, s28, v9
    v_fma_f32 v105, v105, s28, v9
    v_exp_f32 v104, v104
    v_exp_f32 v105, v105
    s_nop 0
    v_cvt_pk_bf16_f32 v18, v104, v105
    v_fma_f32 v106, v106, s28, v9
    v_fma_f32 v107, v107, s28, v9
    v_exp_f32 v106, v106
    v_exp_f32 v107, v107
    s_nop 0
    v_cvt_pk_bf16_f32 v19, v106, v107
    v_fma_f32 v108, v108, s28, v9
    v_fma_f32 v109, v109, s28, v9
    v_exp_f32 v108, v108
    v_exp_f32 v109, v109
    s_nop 0
    v_cvt_pk_bf16_f32 v16, v108, v109
    v_fma_f32 v110, v110, s28, v9
    v_fma_f32 v111, v111, s28, v9
    v_exp_f32 v110, v110
    v_exp_f32 v111, v111
    s_nop 0
    v_cvt_pk_bf16_f32 v17, v110, v111
    s_add_u32 s69, s39, 0
    buffer_load_dwordx4 v[48:51], v26, s[4:7], s69 offen offset:0
    s_waitcnt vmcnt(0)
    v_mfma_f32_16x16x32_bf16 v[104:107], v[48:51], a[120:123], 0
    s_nop 7
    buffer_load_dwordx4 v[48:51], v26, s[4:7], s69 offen offset:64
    s_waitcnt vmcnt(0)
    v_mfma_f32_16x16x32_bf16 v[104:107], v[48:51], a[124:127], v[104:107]
    s_nop 7
    buffer_load_dwordx4 v[48:51], v26, s[4:7], s69 offen offset:128
    s_waitcnt vmcnt(0)
    v_mfma_f32_16x16x32_bf16 v[104:107], v[48:51], a[128:131], v[104:107]
    s_nop 7
    buffer_load_dwordx4 v[48:51], v26, s[4:7], s69 offen offset:192
    s_waitcnt vmcnt(0)
    v_mfma_f32_16x16x32_bf16 v[104:107], v[48:51], a[132:135], v[104:107]
    s_nop 7
    buffer_load_dwordx4 v[48:51], v26, s[4:7], s69 offen offset:256
    s_waitcnt vmcnt(0)
    v_mfma_f32_16x16x32_bf16 v[104:107], v[48:51], a[136:139], v[104:107]
    s_nop 7
    buffer_load_dwordx4 v[48:51], v26, s[4:7], s69 offen offset:320
    s_waitcnt vmcnt(0)
    v_mfma_f32_16x16x32_bf16 v[104:107], v[48:51], a[140:143], v[104:107]
    s_nop 7
    s_add_u32 s69, s39, 6144
    buffer_load_dwordx4 v[48:51], v26, s[4:7], s69 offen offset:0
    s_waitcnt vmcnt(0)
    v_mfma_f32_16x16x32_bf16 v[108:111], v[48:51], a[120:123], 0
    s_nop 7
    buffer_load_dwordx4 v[48:51], v26, s[4:7], s69 offen offset:64
    s_waitcnt vmcnt(0)
    v_mfma_f32_16x16x32_bf16 v[108:111], v[48:51], a[124:127], v[108:111]
    s_nop 7
    buffer_load_dwordx4 v[48:51], v26, s[4:7], s69 offen offset:128
    s_waitcnt vmcnt(0)
    v_mfma_f32_16x16x32_bf16 v[108:111], v[48:51], a[128:131], v[108:111]
    s_nop 7
    buffer_load_dwordx4 v[48:51], v26, s[4:7], s69 offen offset:192
    s_waitcnt vmcnt(0)
    v_mfma_f32_16x16x32_bf16 v[108:111], v[48:51], a[132:135], v[108:111]
    s_nop 7
    buffer_load_dwordx4 v[48:51], v26, s[4:7], s69 offen offset:256
    s_waitcnt vmcnt(0)
    v_mfma_f32_16x16x32_bf16 v[108:111], v[48:51], a[136:139], v[108:111]
    s_nop 7
    buffer_load_dwordx4 v[48:51], v26, s[4:7], s69 offen offset:320
    s_waitcnt vmcnt(0)
    v_mfma_f32_16x16x32_bf16 v[108:111], v[48:51], a[140:143], v[108:111]
    s_nop 7
    s_nop 15
    v_max3_f32 v14, v104, v105, v106
    v_max3_f32 v14, v14, v107, v108
    v_max3_f32 v14, v14, v109, v110
    v_max_f32 v14, v14, v111
    v_mov_b32 v15, v14
    s_nop 1
    v_permlane32_swap_b32 v15, v14
    v_max_f32 v14, v14, v15
    v_mov_b32 v15, v14
    s_nop 1
    v_permlane16_swap_b32 v15, v14
    v_max_f32 v14, v14, v15
    v_fma_f32 v14, v14, s28, v10
    v_max_f32 v20, 0, v14
    v_sub_f32 v10, v10, v20
    v_sub_f32 v21, 0, v20
    v_exp_f32 v21, v21
    s_nop 0
    v_mul_f32 v45, v45, v21
    v_mul_f32 v160, v160, v21
    v_mul_f32 v161, v161, v21
    v_mul_f32 v162, v162, v21
    v_mul_f32 v163, v163, v21
    v_mul_f32 v164, v164, v21
    v_mul_f32 v165, v165, v21
    v_mul_f32 v166, v166, v21
    v_mul_f32 v167, v167, v21
    v_mul_f32 v168, v168, v21
    v_mul_f32 v169, v169, v21
    v_mul_f32 v170, v170, v21
    v_mul_f32 v171, v171, v21
    v_mul_f32 v172, v172, v21
    v_mul_f32 v173, v173, v21
    v_mul_f32 v174, v174, v21
    v_mul_f32 v175, v175, v21
    v_mul_f32 v176, v176, v21
    v_mul_f32 v177, v177, v21
    v_mul_f32 v178, v178, v21
    v_mul_f32 v179, v179, v21
    v_mul_f32 v180, v180, v21
    v_mul_f32 v181, v181, v21
    v_mul_f32 v182, v182, v21
    v_mul_f32 v183, v183, v21
    v_mul_f32 v184, v184, v21
    v_mul_f32 v185, v185, v21
    v_mul_f32 v186, v186, v21
    v_mul_f32 v187, v187, v21
    v_mul_f32 v188, v188, v21
    v_mul_f32 v189, v189, v21
    v_mul_f32 v190, v190, v21
    v_mul_f32 v191, v191, v21
    v_mul_f32 v192, v192, v21
    v_mul_f32 v193, v193, v21
    v_mul_f32 v194, v194, v21
    v_mul_f32 v195, v195, v21
    v_mul_f32 v196, v196, v21
    v_mul_f32 v197, v197, v21
    v_mul_f32 v198, v198, v21
    v_mul_f32 v199, v199, v21
    v_mul_f32 v200, v200, v21
    v_mul_f32 v201, v201, v21
    v_mul_f32 v202, v202, v21
    v_mul_f32 v203, v203, v21
    v_mul_f32 v204, v204, v21
    v_mul_f32 v205, v205, v21
    v_mul_f32 v206, v206, v21
    v_mul_f32 v207, v207, v21
    v_fma_f32 v104, v104, s28, v10
    v_fma_f32 v105, v105, s28, v10
    v_exp_f32 v104, v104
    v_exp_f32 v105, v105
    s_nop 0
    v_cvt_pk_bf16_f32 v24, v104, v105
    v_fma_f32 v106, v106, s28, v10
    v_fma_f32 v107, v107, s28, v10
    v_exp_f32 v106, v106
    v_exp_f32 v107, v107
    s_nop 0
    v_cvt_pk_bf16_f32 v25, v106, v107
    v_fma_f32 v108, v108, s28, v10
    v_fma_f32 v109, v109, s28, v10
    v_exp_f32 v108, v108
    v_exp_f32 v109, v109
    s_nop 0
    v_cvt_pk_bf16_f32 v22, v108, v109
    v_fma_f32 v110, v110, s28, v10
    v_fma_f32 v111, v111, s28, v10
    v_exp_f32 v110, v110
    v_exp_f32 v111, v111
    s_nop 0
    v_cvt_pk_bf16_f32 v23, v110, v111
    s_add_u32 s69, s39, 0
    buffer_load_dwordx4 v[48:51], v26, s[4:7], s69 offen offset:0
    s_waitcnt vmcnt(0)
    v_mfma_f32_16x16x32_bf16 v[104:107], v[48:51], a[144:147], 0
    s_nop 7
    buffer_load_dwordx4 v[48:51], v26, s[4:7], s69 offen offset:64
    s_waitcnt vmcnt(0)
    v_mfma_f32_16x16x32_bf16 v[104:107], v[48:51], a[148:151], v[104:107]
    s_nop 7
    buffer_load_dwordx4 v[48:51], v26, s[4:7], s69 offen offset:128
    s_waitcnt vmcnt(0)
    v_mfma_f32_16x16x32_bf16 v[104:107], v[48:51], a[152:155], v[104:107]
    s_nop 7
    buffer_load_dwordx4 v[48:51], v26, s[4:7], s69 offen offset:192
    s_waitcnt vmcnt(0)
    v_mfma_f32_16x16x32_bf16 v[104:107], v[48:51], a[156:159], v[104:107]
    s_nop 7
    buffer_load_dwordx4 v[48:51], v26, s[4:7], s69 offen offset:256
    s_waitcnt vmcnt(0)
    v_mfma_f32_16x16x32_bf16 v[104:107], v[48:51], a[160:163], v[104:107]
    s_nop 7
    buffer_load_dwordx4 v[48:51], v26, s[4:7], s69 offen offset:320
    s_waitcnt vmcnt(0)
    v_mfma_f32_16x16x32_bf16 v[104:107], v[48:51], a[164:167], v[104:107]
    s_nop 7
    s_add_u32 s69, s39, 6144
    buffer_load_dwordx4 v[48:51], v26, s[4:7], s69 offen offset:0
    s_waitcnt vmcnt(0)
    v_mfma_f32_16x16x32_bf16 v[108:111], v[48:51], a[144:147], 0
    s_nop 7
    buffer_load_dwordx4 v[48:51], v26, s[4:7], s69 offen offset:64
    s_waitcnt vmcnt(0)
    v_mfma_f32_16x16x32_bf16 v[108:111], v[48:51], a[148:151], v[108:111]
    s_nop 7
    buffer_load_dwordx4 v[48:51], v26, s[4:7], s69 offen offset:128
    s_waitcnt vmcnt(0)
    v_mfma_f32_16x16x32_bf16 v[108:111], v[48:51], a[152:155], v[108:111]
    s_nop 7
    buffer_load_dwordx4 v[48:51], v26, s[4:7], s69 offen offset:192
    s_waitcnt vmcnt(0)
    v_mfma_f32_16x16x32_bf16 v[108:111], v[48:51], a[156:159], v[108:111]
    s_nop 7
    buffer_load_dwordx4 v[48:51], v26, s[4:7], s69 offen offset:256
    s_waitcnt vmcnt(0)
    v_mfma_f32_16x16x32_bf16 v[108:111], v[48:51], a[160:163], v[108:111]
    s_nop 7
    buffer_load_dwordx4 v[48:51], v26, s[4:7], s69 offen offset:320
    s_waitcnt vmcnt(0)
    v_mfma_f32_16x16x32_bf16 v[108:111], v[48:51], a[164:167], v[108:111]
    s_nop 7
    s_nop 15
    v_max3_f32 v14, v104, v105, v106
    v_max3_f32 v14, v14, v107, v108
    v_max3_f32 v14, v14, v109, v110
    v_max_f32 v14, v14, v111
    v_mov_b32 v15, v14
    s_nop 1
    v_permlane32_swap_b32 v15, v14
    v_max_f32 v14, v14, v15
    v_mov_b32 v15, v14
    s_nop 1
    v_permlane16_swap_b32 v15, v14
    v_max_f32 v14, v14, v15
    v_fma_f32 v14, v14, s28, v11
    v_max_f32 v20, 0, v14
    v_sub_f32 v11, v11, v20
    v_sub_f32 v21, 0, v20
    v_exp_f32 v21, v21
    s_nop 0
    v_mul_f32 v46, v46, v21
    v_mul_f32 v208, v208, v21
    v_mul_f32 v209, v209, v21
    v_mul_f32 v210, v210, v21
    v_mul_f32 v211, v211, v21
    v_mul_f32 v212, v212, v21
    v_mul_f32 v213, v213, v21
    v_mul_f32 v214, v214, v21
    v_mul_f32 v215, v215, v21
    v_mul_f32 v216, v216, v21
    v_mul_f32 v217, v217, v21
    v_mul_f32 v218, v218, v21
    v_mul_f32 v219, v219, v21
    v_mul_f32 v220, v220, v21
    v_mul_f32 v221, v221, v21
    v_mul_f32 v222, v222, v21
    v_mul_f32 v223, v223, v21
    v_mul_f32 v224, v224, v21
    v_mul_f32 v225, v225, v21
    v_mul_f32 v226, v226, v21
    v_mul_f32 v227, v227, v21
    v_mul_f32 v228, v228, v21
    v_mul_f32 v229, v229, v21
    v_mul_f32 v230, v230, v21
    v_mul_f32 v231, v231, v21
    v_mul_f32 v232, v232, v21
    v_mul_f32 v233, v233, v21
    v_mul_f32 v234, v234, v21
    v_mul_f32 v235, v235, v21
    v_mul_f32 v236, v236, v21
    v_mul_f32 v237, v237, v21
    v_mul_f32 v238, v238, v21
    v_mul_f32 v239, v239, v21
    v_mul_f32 v240, v240, v21
    v_mul_f32 v241, v241, v21
    v_mul_f32 v242, v242, v21
    v_mul_f32 v243, v243, v21
    v_mul_f32 v244, v244, v21
    v_mul_f32 v245, v245, v21
    v_mul_f32 v246, v246, v21
    v_mul_f32 v247, v247, v21
    v_mul_f32 v248, v248, v21
    v_mul_f32 v249, v249, v21
    v_mul_f32 v250, v250, v21
    v_mul_f32 v251, v251, v21
    v_mul_f32 v252, v252, v21
    v_mul_f32 v253, v253, v21
    v_mul_f32 v254, v254, v21
    v_mul_f32 v255, v255, v21
    v_fma_f32 v104, v104, s28, v11
    v_fma_f32 v105, v105, s28, v11
    v_exp_f32 v104, v104
    v_exp_f32 v105, v105
    s_nop 0
    v_cvt_pk_bf16_f32 v30, v104, v105
    v_fma_f32 v106, v106, s28, v11
    v_fma_f32 v107, v107, s28, v11
    v_exp_f32 v106, v106
    v_exp_f32 v107, v107
    s_nop 0
    v_cvt_pk_bf16_f32 v31, v106, v107
    v_fma_f32 v108, v108, s28, v11
    v_fma_f32 v109, v109, s28, v11
    v_exp_f32 v108, v108
    v_exp_f32 v109, v109
    s_nop 0
    v_cvt_pk_bf16_f32 v28, v108, v109
    v_fma_f32 v110, v110, s28, v11
    v_fma_f32 v111, v111, s28, v11
    v_exp_f32 v110, v110
    v_exp_f32 v111, v111
    s_nop 0
    v_cvt_pk_bf16_f32 v29, v110, v111
    s_add_u32 s69, s39, 0
    buffer_load_dwordx4 v[48:51], v26, s[4:7], s69 offen offset:0
    s_waitcnt vmcnt(0)
    v_mfma_f32_16x16x32_bf16 v[104:107], v[48:51], a[168:171], 0
    s_nop 7
    buffer_load_dwordx4 v[48:51], v26, s[4:7], s69 offen offset:64
    s_waitcnt vmcnt(0)
    v_mfma_f32_16x16x32_bf16 v[104:107], v[48:51], a[172:175], v[104:107]
    s_nop 7
    buffer_load_dwordx4 v[48:51], v26, s[4:7], s69 offen offset:128
    s_waitcnt vmcnt(0)
    v_mfma_f32_16x16x32_bf16 v[104:107], v[48:51], a[176:179], v[104:107]
    s_nop 7
    buffer_load_dwordx4 v[48:51], v26, s[4:7], s69 offen offset:192
    s_waitcnt vmcnt(0)
    v_mfma_f32_16x16x32_bf16 v[104:107], v[48:51], a[180:183], v[104:107]
    s_nop 7
    buffer_load_dwordx4 v[48:51], v26, s[4:7], s69 offen offset:256
    s_waitcnt vmcnt(0)
    v_mfma_f32_16x16x32_bf16 v[104:107], v[48:51], a[184:187], v[104:107]
    s_nop 7
    buffer_load_dwordx4 v[48:51], v26, s[4:7], s69 offen offset:320
    s_waitcnt vmcnt(0)
    v_mfma_f32_16x16x32_bf16 v[104:107], v[48:51], a[188:191], v[104:107]
    s_nop 7
    s_add_u32 s69, s39, 6144
    buffer_load_dwordx4 v[48:51], v26, s[4:7], s69 offen offset:0
    s_waitcnt vmcnt(0)
    v_mfma_f32_16x16x32_bf16 v[108:111], v[48:51], a[168:171], 0
    s_nop 7
    buffer_load_dwordx4 v[48:51], v26, s[4:7], s69 offen offset:64
    s_waitcnt vmcnt(0)
    v_mfma_f32_16x16x32_bf16 v[108:111], v[48:51], a[172:175], v[108:111]
    s_nop 7
    buffer_load_dwordx4 v[48:51], v26, s[4:7], s69 offen offset:128
    s_waitcnt vmcnt(0)
    v_mfma_f32_16x16x32_bf16 v[108:111], v[48:51], a[176:179], v[108:111]
    s_nop 7
    buffer_load_dwordx4 v[48:51], v26, s[4:7], s69 offen offset:192
    s_waitcnt vmcnt(0)
    v_mfma_f32_16x16x32_bf16 v[108:111], v[48:51], a[180:183], v[108:111]
    s_nop 7
    buffer_load_dwordx4 v[48:51], v26, s[4:7], s69 offen offset:256
    s_waitcnt vmcnt(0)
    v_mfma_f32_16x16x32_bf16 v[108:111], v[48:51], a[184:187], v[108:111]
    s_nop 7
    buffer_load_dwordx4 v[48:51], v26, s[4:7], s69 offen offset:320
    s_waitcnt vmcnt(0)
    v_mfma_f32_16x16x32_bf16 v[108:111], v[48:51], a[188:191], v[108:111]
    s_nop 7
    s_nop 15
    v_max3_f32 v14, v104, v105, v106
    v_max3_f32 v14, v14, v107, v108
    v_max3_f32 v14, v14, v109, v110
    v_max_f32 v14, v14, v111
    v_mov_b32 v15, v14
    s_nop 1
    v_permlane32_swap_b32 v15, v14
    v_max_f32 v14, v14, v15
    v_mov_b32 v15, v14
    s_nop 1
    v_permlane16_swap_b32 v15, v14
    v_max_f32 v14, v14, v15
    v_fma_f32 v14, v14, s28, v12
    v_max_f32 v20, 0, v14
    v_sub_f32 v12, v12, v20
    v_sub_f32 v21, 0, v20
    v_exp_f32 v21, v21
    s_nop 0
    v_mul_f32 v47, v47, v21
    v_accvgpr_read_b32 v15, a0
    v_mul_f32 v15, v15, v21
    v_accvgpr_write_b32 a0, v15
    v_accvgpr_read_b32 v15, a1
    v_mul_f32 v15, v15, v21
    v_accvgpr_write_b32 a1, v15
    v_accvgpr_read_b32 v15, a2
    v_mul_f32 v15, v15, v21
    v_accvgpr_write_b32 a2, v15
    v_accvgpr_read_b32 v15, a3
    v_mul_f32 v15, v15, v21
    v_accvgpr_write_b32 a3, v15
    v_accvgpr_read_b32 v15, a4
    v_mul_f32 v15, v15, v21
    v_accvgpr_write_b32 a4, v15
    v_accvgpr_read_b32 v15, a5
    v_mul_f32 v15, v15, v21
    v_accvgpr_write_b32 a5, v15
    v_accvgpr_read_b32 v15, a6
    v_mul_f32 v15, v15, v21
    v_accvgpr_write_b32 a6, v15
    v_accvgpr_read_b32 v15, a7
    v_mul_f32 v15, v15, v21
    v_accvgpr_write_b32 a7, v15
    v_accvgpr_read_b32 v15, a8
    v_mul_f32 v15, v15, v21
    v_accvgpr_write_b32 a8, v15
    v_accvgpr_read_b32 v15, a9
    v_mul_f32 v15, v15, v21
    v_accvgpr_write_b32 a9, v15
    v_accvgpr_read_b32 v15, a10
    v_mul_f32 v15, v15, v21
    v_accvgpr_write_b32 a10, v15
    v_accvgpr_read_b32 v15, a11
    v_mul_f32 v15, v15, v21
    v_accvgpr_write_b32 a11, v15
    v_accvgpr_read_b32 v15, a12
    v_mul_f32 v15, v15, v21
    v_accvgpr_write_b32 a12, v15
    v_accvgpr_read_b32 v15, a13
    v_mul_f32 v15, v15, v21
    v_accvgpr_write_b32 a13, v15
    v_accvgpr_read_b32 v15, a14
    v_mul_f32 v15, v15, v21
    v_accvgpr_write_b32 a14, v15
    v_accvgpr_read_b32 v15, a15
    v_mul_f32 v15, v15, v21
    v_accvgpr_write_b32 a15, v15
    v_accvgpr_read_b32 v15, a16
    v_mul_f32 v15, v15, v21
    v_accvgpr_write_b32 a16, v15
    v_accvgpr_read_b32 v15, a17
    v_mul_f32 v15, v15, v21
    v_accvgpr_write_b32 a17, v15
    v_accvgpr_read_b32 v15, a18
    v_mul_f32 v15, v15, v21
    v_accvgpr_write_b32 a18, v15
    v_accvgpr_read_b32 v15, a19
    v_mul_f32 v15, v15, v21
    v_accvgpr_write_b32 a19, v15
    v_accvgpr_read_b32 v15, a20
    v_mul_f32 v15, v15, v21
    v_accvgpr_write_b32 a20, v15
    v_accvgpr_read_b32 v15, a21
    v_mul_f32 v15, v15, v21
    v_accvgpr_write_b32 a21, v15
    v_accvgpr_read_b32 v15, a22
    v_mul_f32 v15, v15, v21
    v_accvgpr_write_b32 a22, v15
    v_accvgpr_read_b32 v15, a23
    v_mul_f32 v15, v15, v21
    v_accvgpr_write_b32 a23, v15
    v_accvgpr_read_b32 v15, a24
    v_mul_f32 v15, v15, v21
    v_accvgpr_write_b32 a24, v15
    v_accvgpr_read_b32 v15, a25
    v_mul_f32 v15, v15, v21
    v_accvgpr_write_b32 a25, v15
    v_accvgpr_read_b32 v15, a26
    v_mul_f32 v15, v15, v21
    v_accvgpr_write_b32 a26, v15
    v_accvgpr_read_b32 v15, a27
    v_mul_f32 v15, v15, v21
    v_accvgpr_write_b32 a27, v15
    v_accvgpr_read_b32 v15, a28
    v_mul_f32 v15, v15, v21
    v_accvgpr_write_b32 a28, v15
    v_accvgpr_read_b32 v15, a29
    v_mul_f32 v15, v15, v21
    v_accvgpr_write_b32 a29, v15
    v_accvgpr_read_b32 v15, a30
    v_mul_f32 v15, v15, v21
    v_accvgpr_write_b32 a30, v15
    v_accvgpr_read_b32 v15, a31
    v_mul_f32 v15, v15, v21
    v_accvgpr_write_b32 a31, v15
    v_accvgpr_read_b32 v15, a32
    v_mul_f32 v15, v15, v21
    v_accvgpr_write_b32 a32, v15
    v_accvgpr_read_b32 v15, a33
    v_mul_f32 v15, v15, v21
    v_accvgpr_write_b32 a33, v15
    v_accvgpr_read_b32 v15, a34
    v_mul_f32 v15, v15, v21
    v_accvgpr_write_b32 a34, v15
    v_accvgpr_read_b32 v15, a35
    v_mul_f32 v15, v15, v21
    v_accvgpr_write_b32 a35, v15
    v_accvgpr_read_b32 v15, a36
    v_mul_f32 v15, v15, v21
    v_accvgpr_write_b32 a36, v15
    v_accvgpr_read_b32 v15, a37
    v_mul_f32 v15, v15, v21
    v_accvgpr_write_b32 a37, v15
    v_accvgpr_read_b32 v15, a38
    v_mul_f32 v15, v15, v21
    v_accvgpr_write_b32 a38, v15
    v_accvgpr_read_b32 v15, a39
    v_mul_f32 v15, v15, v21
    v_accvgpr_write_b32 a39, v15
    v_accvgpr_read_b32 v15, a40
    v_mul_f32 v15, v15, v21
    v_accvgpr_write_b32 a40, v15
    v_accvgpr_read_b32 v15, a41
    v_mul_f32 v15, v15, v21
    v_accvgpr_write_b32 a41, v15
    v_accvgpr_read_b32 v15, a42
    v_mul_f32 v15, v15, v21
    v_accvgpr_write_b32 a42, v15
    v_accvgpr_read_b32 v15, a43
    v_mul_f32 v15, v15, v21
    v_accvgpr_write_b32 a43, v15
    v_accvgpr_read_b32 v15, a44
    v_mul_f32 v15, v15, v21
    v_accvgpr_write_b32 a44, v15
    v_accvgpr_read_b32 v15, a45
    v_mul_f32 v15, v15, v21
    v_accvgpr_write_b32 a45, v15
    v_accvgpr_read_b32 v15, a46
    v_mul_f32 v15, v15, v21
    v_accvgpr_write_b32 a46, v15
    v_accvgpr_read_b32 v15, a47
    v_mul_f32 v15, v15, v21
    v_accvgpr_write_b32 a47, v15
    v_fma_f32 v104, v104, s28, v12
    v_fma_f32 v105, v105, s28, v12
    v_exp_f32 v104, v104
    v_exp_f32 v105, v105
    s_nop 0
    v_cvt_pk_bf16_f32 v36, v104, v105
    v_fma_f32 v106, v106, s28, v12
    v_fma_f32 v107, v107, s28, v12
    v_exp_f32 v106, v106
    v_exp_f32 v107, v107
    s_nop 0
    v_cvt_pk_bf16_f32 v37, v106, v107
    v_fma_f32 v108, v108, s28, v12
    v_fma_f32 v109, v109, s28, v12
    v_exp_f32 v108, v108
    v_exp_f32 v109, v109
    s_nop 0
    v_cvt_pk_bf16_f32 v34, v108, v109
    v_fma_f32 v110, v110, s28, v12
    v_fma_f32 v111, v111, s28, v12
    v_exp_f32 v110, v110
    v_exp_f32 v111, v111
    s_nop 0
    v_cvt_pk_bf16_f32 v35, v110, v111
    v_mfma_f32_16x16x32_bf16 v[48:51], a[236:239], v[16:19], v[44:47]
    v_mfma_f32_16x16x32_bf16 v[48:51], a[240:243], v[22:25], v[48:51]
    v_mfma_f32_16x16x32_bf16 v[48:51], a[244:247], v[28:31], v[48:51]
    v_mfma_f32_16x16x32_bf16 v[48:51], a[248:251], v[34:37], v[48:51]
    s_nop 15
    s_setpc_b64 s[40:41]
L_rs_start5b:
    s_call_b64 s[40:41], L_rare5_1
    s_branch L_ret_start5b
L_rs_loop5w0a:
    s_call_b64 s[40:41], L_rare5_0
    s_branch L_ret_loop5w0a
L_rs_loop5w0b:
    s_call_b64 s[40:41], L_rare5_1
    s_branch L_ret_loop5w0b
L_rs_loop5w1a:
    s_call_b64 s[40:41], L_rare5_0
    s_branch L_ret_loop5w1a
L_rs_loop5w1b:
    s_call_b64 s[40:41], L_rare5_1
    s_branch L_ret_loop5w1b
L_rs_end5a:
    s_call_b64 s[40:41], L_rare5_0
    s_branch L_ret_end5a
L_rs_end5b:
    s_call_b64 s[40:41], L_rare5_1
    s_branch L_ret_end5b
L_rs_start4b:
    s_call_b64 s[40:41], L_rare4_1
    s_branch L_ret_start4b
L_rs_loop4w0a:
    s_call_b64 s[40:41], L_rare4_0
    s_branch L_ret_loop4w0a
L_rs_loop4w0b:
    s_call_b64 s[40:41], L_rare4_1
    s_branch L_ret_loop4w0b
L_rs_end4a:
    s_call_b64 s[40:41], L_rare4_0
    s_branch L_ret_end4a
L_rs_end4b:
    s_call_b64 s[40:41], L_rare4_1
    s_branch L_ret_end4b
L_rs_tr54a:
    s_call_b64 s[40:41], L_rare5_0
    s_branch L_ret_tr54a
L_rs_tr54b:
    s_nop 15
    s_waitcnt vmcnt(0) lgkmcnt(0)
    s_mov_b32 s68, s14
    s_mov_b32 s14, 166723584
    v_mbcnt_lo_u32_b32 v105, -1, 0
    v_mbcnt_hi_u32_b32 v105, -1, v105
    v_and_b32 v104, 15, v105
    v_mul_u32_u24 v104, 384, v104
    v_lshrrev_b32 v105, 4, v105
    v_lshl_add_u32 v104, v105, 4, v104
    s_add_u32 s69, s34, 0
    buffer_load_dwordx4 a[96:99], v104, s[12:15], s69 offen offset:0
    buffer_load_dwordx4 a[100:103], v104, s[12:15], s69 offen offset:64
    buffer_load_dwordx4 a[104:107], v104, s[12:15], s69 offen offset:128
    buffer_load_dwordx4 a[108:111], v104, s[12:15], s69 offen offset:192
    buffer_load_dwordx4 a[112:115], v104, s[12:15], s69 offen offset:256
    buffer_load_dwordx4 a[116:119], v104, s[12:15], s69 offen offset:320
    s_add_u32 s69, s34, 6144
    buffer_load_dwordx4 a[120:123], v104, s[12:15], s69 offen offset:0
    buffer_load_dwordx4 a[124:127], v104, s[12:15], s69 offen offset:64
    buffer_load_dwordx4 a[128:131], v104, s[12:15], s69 offen offset:128
    buffer_load_dwordx4 a[132:135], v104, s[12:15], s69 offen offset:192
    buffer_load_dwordx4 a[136:139], v104, s[12:15], s69 offen offset:256
    buffer_load_dwordx4 a[140:143], v104, s[12:15], s69 offen offset:320
    s_add_u32 s69, s34, 12288
    buffer_load_dwordx4 a[144:147], v104, s[12:15], s69 offen offset:0
    buffer_load_dwordx4 a[148:151], v104, s[12:15], s69 offen offset:64
    buffer_load_dwordx4 a[152:155], v104, s[12:15], s69 offen offset:128
    buffer_load_dwordx4 a[156:159], v104, s[12:15], s69 offen offset:192
    buffer_load_dwordx4 a[160:163], v104, s[12:15], s69 offen offset:256
    buffer_load_dwordx4 a[164:167], v104, s[12:15], s69 offen offset:320
    s_add_u32 s69, s34, 18432
    buffer_load_dwordx4 a[168:171], v104, s[12:15], s69 offen offset:0
    buffer_load_dwordx4 a[172:175], v104, s[12:15], s69 offen offset:64
    buffer_load_dwordx4 a[176:179], v104, s[12:15], s69 offen offset:128
    buffer_load_dwordx4 a[180:183], v104, s[12:15], s69 offen offset:192
    buffer_load_dwordx4 a[184:187], v104, s[12:15], s69 offen offset:256
    buffer_load_dwordx4 a[188:191], v104, s[12:15], s69 offen offset:320
    s_add_u32 s69, s34, 24576
    buffer_load_dwordx4 a[192:195], v104, s[12:15], s69 offen offset:0
    buffer_load_dwordx4 a[196:199], v104, s[12:15], s69 offen offset:64
    buffer_load_dwordx4 a[200:203], v104, s[12:15], s69 offen offset:128
    buffer_load_dwordx4 a[204:207], v104, s[12:15], s69 offen offset:192
    buffer_load_dwordx4 a[208:211], v104, s[12:15], s69 offen offset:256
    buffer_load_dwordx4 v[92:95], v104, s[12:15], s69 offen offset:320
    s_waitcnt vmcnt(0)
    s_call_b64 s[40:41], L_rare5_1
    v_mbcnt_lo_u32_b32 v105, -1, 0
    v_mbcnt_hi_u32_b32 v105, -1, v105
    v_and_b32 v104, 15, v105
    v_mul_u32_u24 v104, 384, v104
    v_lshrrev_b32 v105, 4, v105
    v_lshl_add_u32 v104, v105, 4, v104
    s_add_u32 s69, s33, 0
    buffer_load_dwordx4 a[96:99], v104, s[12:15], s69 offen offset:0
    buffer_load_dwordx4 a[100:103], v104, s[12:15], s69 offen offset:64
    buffer_load_dwordx4 a[104:107], v104, s[12:15], s69 offen offset:128
    buffer_load_dwordx4 a[108:111], v104, s[12:15], s69 offen offset:192
    buffer_load_dwordx4 a[112:115], v104, s[12:15], s69 offen offset:256
    buffer_load_dwordx4 a[116:119], v104, s[12:15], s69 offen offset:320
    s_add_u32 s69, s33, 6144
    buffer_load_dwordx4 a[120:123], v104, s[12:15], s69 offen offset:0
    buffer_load_dwordx4 a[124:127], v104, s[12:15], s69 offen offset:64
    buffer_load_dwordx4 a[128:131], v104, s[12:15], s69 offen offset:128
    buffer_load_dwordx4 a[132:135], v104, s[12:15], s69 offen offset:192
    buffer_load_dwordx4 a[136:139], v104, s[12:15], s69 offen offset:256
    buffer_load_dwordx4 a[140:143], v104, s[12:15], s69 offen offset:320
    s_add_u32 s69, s33, 12288
    buffer_load_dwordx4 a[144:147], v104, s[12:15], s69 offen offset:0
    buffer_load_dwordx4 a[148:151], v104, s[12:15], s69 offen offset:64
    buffer_load_dwordx4 a[152:155], v104, s[12:15], s69 offen offset:128
    buffer_load_dwordx4 a[156:159], v104, s[12:15], s69 offen offset:192
    buffer_load_dwordx4 a[160:163], v104, s[12:15], s69 offen offset:256
    buffer_load_dwordx4 a[164:167], v104, s[12:15], s69 offen offset:320
    s_add_u32 s69, s33, 18432
    buffer_load_dwordx4 a[168:171], v104, s[12:15], s69 offen offset:0
    buffer_load_dwordx4 a[172:175], v104, s[12:15], s69 offen offset:64
    buffer_load_dwordx4 a[176:179], v104, s[12:15], s69 offen offset:128
    buffer_load_dwordx4 a[180:183], v104, s[12:15], s69 offen offset:192
    buffer_load_dwordx4 a[184:187], v104, s[12:15], s69 offen offset:256
    buffer_load_dwordx4 a[188:191], v104, s[12:15], s69 offen offset:320
    s_waitcnt vmcnt(0)
    s_mov_b32 s14, s68
    s_branch L_ret_tr54b
L_rs_tr54d:
    s_call_b64 s[40:41], L_rare4_1
    s_branch L_ret_tr54d
L_rs_tr45a:
    s_call_b64 s[40:41], L_rare4_0
    s_branch L_ret_tr45a
L_rs_tr45b:
    s_nop 15
    s_waitcnt vmcnt(0) lgkmcnt(0)
    s_mov_b32 s68, s14
    s_mov_b32 s14, 166723584
    v_mbcnt_lo_u32_b32 v105, -1, 0
    v_mbcnt_hi_u32_b32 v105, -1, v105
    v_and_b32 v104, 15, v105
    v_mul_u32_u24 v104, 384, v104
    v_lshrrev_b32 v105, 4, v105
    v_lshl_add_u32 v104, v105, 4, v104
    s_add_u32 s69, s34, 0
    buffer_load_dwordx4 a[96:99], v104, s[12:15], s69 offen offset:0
    buffer_load_dwordx4 a[100:103], v104, s[12:15], s69 offen offset:64
    buffer_load_dwordx4 a[104:107], v104, s[12:15], s69 offen offset:128
    buffer_load_dwordx4 a[108:111], v104, s[12:15], s69 offen offset:192
    buffer_load_dwordx4 a[112:115], v104, s[12:15], s69 offen offset:256
    buffer_load_dwordx4 a[116:119], v104, s[12:15], s69 offen offset:320
    s_add_u32 s69, s34, 6144
    buffer_load_dwordx4 a[120:123], v104, s[12:15], s69 offen offset:0
    buffer_load_dwordx4 a[124:127], v104, s[12:15], s69 offen offset:64
    buffer_load_dwordx4 a[128:131], v104, s[12:15], s69 offen offset:128
    buffer_load_dwordx4 a[132:135], v104, s[12:15], s69 offen offset:192
    buffer_load_dwordx4 a[136:139], v104, s[12:15], s69 offen offset:256
    buffer_load_dwordx4 a[140:143], v104, s[12:15], s69 offen offset:320
    s_add_u32 s69, s34, 12288
    buffer_load_dwordx4 a[144:147], v104, s[12:15], s69 offen offset:0
    buffer_load_dwordx4 a[148:151], v104, s[12:15], s69 offen offset:64
    buffer_load_dwordx4 a[152:155], v104, s[12:15], s69 offen offset:128
    buffer_load_dwordx4 a[156:159], v104, s[12:15], s69 offen offset:192
    buffer_load_dwordx4 a[160:163], v104, s[12:15], s69 offen offset:256
    buffer_load_dwordx4 a[164:167], v104, s[12:15], s69 offen offset:320
    s_add_u32 s69, s34, 18432
    buffer_load_dwordx4 a[168:171], v104, s[12:15], s69 offen offset:0
    buffer_load_dwordx4 a[172:175], v104, s[12:15], s69 offen offset:64
    buffer_load_dwordx4 a[176:179], v104, s[12:15], s69 offen offset:128
    buffer_load_dwordx4 a[180:183], v104, s[12:15], s69 offen offset:192
    buffer_load_dwordx4 a[184:187], v104, s[12:15], s69 offen offset:256
    buffer_load_dwordx4 a[188:191], v104, s[12:15], s69 offen offset:320
    s_waitcnt vmcnt(0)
    s_call_b64 s[40:41], L_rare4_1
    v_mbcnt_lo_u32_b32 v105, -1, 0
    v_mbcnt_hi_u32_b32 v105, -1, v105
    v_and_b32 v104, 15, v105
    v_mul_u32_u24 v104, 384, v104
    v_lshrrev_b32 v105, 4, v105
    v_lshl_add_u32 v104, v105, 4, v104
    s_add_u32 s69, s33, 0
    buffer_load_dwordx4 a[96:99], v104, s[12:15], s69 offen offset:0
    buffer_load_dwordx4 a[100:103], v104, s[12:15], s69 offen offset:64
    buffer_load_dwordx4 a[104:107], v104, s[12:15], s69 offen offset:128
    buffer_load_dwordx4 a[108:111], v104, s[12:15], s69 offen offset:192
    buffer_load_dwordx4 a[112:115], v104, s[12:15], s69 offen offset:256
    buffer_load_dwordx4 a[116:119], v104, s[12:15], s69 offen offset:320
    s_add_u32 s69, s33, 6144
    buffer_load_dwordx4 a[120:123], v104, s[12:15], s69 offen offset:0
    buffer_load_dwordx4 a[124:127], v104, s[12:15], s69 offen offset:64
    buffer_load_dwordx4 a[128:131], v104, s[12:15], s69 offen offset:128
    buffer_load_dwordx4 a[132:135], v104, s[12:15], s69 offen offset:192
    buffer_load_dwordx4 a[136:139], v104, s[12:15], s69 offen offset:256
    buffer_load_dwordx4 a[140:143], v104, s[12:15], s69 offen offset:320
    s_add_u32 s69, s33, 12288
    buffer_load_dwordx4 a[144:147], v104, s[12:15], s69 offen offset:0
    buffer_load_dwordx4 a[148:151], v104, s[12:15], s69 offen offset:64
    buffer_load_dwordx4 a[152:155], v104, s[12:15], s69 offen offset:128
    buffer_load_dwordx4 a[156:159], v104, s[12:15], s69 offen offset:192
    buffer_load_dwordx4 a[160:163], v104, s[12:15], s69 offen offset:256
    buffer_load_dwordx4 a[164:167], v104, s[12:15], s69 offen offset:320
    s_add_u32 s69, s33, 18432
    buffer_load_dwordx4 a[168:171], v104, s[12:15], s69 offen offset:0
    buffer_load_dwordx4 a[172:175], v104, s[12:15], s69 offen offset:64
    buffer_load_dwordx4 a[176:179], v104, s[12:15], s69 offen offset:128
    buffer_load_dwordx4 a[180:183], v104, s[12:15], s69 offen offset:192
    buffer_load_dwordx4 a[184:187], v104, s[12:15], s69 offen offset:256
    buffer_load_dwordx4 a[188:191], v104, s[12:15], s69 offen offset:320
    s_add_u32 s69, s33, 24576
    buffer_load_dwordx4 a[192:195], v104, s[12:15], s69 offen offset:0
    buffer_load_dwordx4 a[196:199], v104, s[12:15], s69 offen offset:64
    buffer_load_dwordx4 a[200:203], v104, s[12:15], s69 offen offset:128
    buffer_load_dwordx4 a[204:207], v104, s[12:15], s69 offen offset:192
    buffer_load_dwordx4 a[208:211], v104, s[12:15], s69 offen offset:256
    buffer_load_dwordx4 v[92:95], v104, s[12:15], s69 offen offset:320
    s_waitcnt vmcnt(0)
    s_mov_b32 s14, s68
    s_branch L_ret_tr45b
L_rs_tr45d:
    s_call_b64 s[40:41], L_rare5_1
    s_branch L_ret_tr45d
L_rs_tr44a:
    s_call_b64 s[40:41], L_rare4_0
    s_branch L_ret_tr44a
L_rs_tr44b:
    s_nop 15
    s_waitcnt vmcnt(0) lgkmcnt(0)
    s_mov_b32 s68, s14
    s_mov_b32 s14, 166723584
    v_mbcnt_lo_u32_b32 v105, -1, 0
    v_mbcnt_hi_u32_b32 v105, -1, v105
    v_and_b32 v104, 15, v105
    v_mul_u32_u24 v104, 384, v104
    v_lshrrev_b32 v105, 4, v105
    v_lshl_add_u32 v104, v105, 4, v104
    s_add_u32 s69, s34, 0
    buffer_load_dwordx4 a[96:99], v104, s[12:15], s69 offen offset:0
    buffer_load_dwordx4 a[100:103], v104, s[12:15], s69 offen offset:64
    buffer_load_dwordx4 a[104:107], v104, s[12:15], s69 offen offset:128
    buffer_load_dwordx4 a[108:111], v104, s[12:15], s69 offen offset:192
    buffer_load_dwordx4 a[112:115], v104, s[12:15], s69 offen offset:256
    buffer_load_dwordx4 a[116:119], v104, s[12:15], s69 offen offset:320
    s_add_u32 s69, s34, 6144
    buffer_load_dwordx4 a[120:123], v104, s[12:15], s69 offen offset:0
    buffer_load_dwordx4 a[124:127], v104, s[12:15], s69 offen offset:64
    buffer_load_dwordx4 a[128:131], v104, s[12:15], s69 offen offset:128
    buffer_load_dwordx4 a[132:135], v104, s[12:15], s69 offen offset:192
    buffer_load_dwordx4 a[136:139], v104, s[12:15], s69 offen offset:256
    buffer_load_dwordx4 a[140:143], v104, s[12:15], s69 offen offset:320
    s_add_u32 s69, s34, 12288
    buffer_load_dwordx4 a[144:147], v104, s[12:15], s69 offen offset:0
    buffer_load_dwordx4 a[148:151], v104, s[12:15], s69 offen offset:64
    buffer_load_dwordx4 a[152:155], v104, s[12:15], s69 offen offset:128
    buffer_load_dwordx4 a[156:159], v104, s[12:15], s69 offen offset:192
    buffer_load_dwordx4 a[160:163], v104, s[12:15], s69 offen offset:256
    buffer_load_dwordx4 a[164:167], v104, s[12:15], s69 offen offset:320
    s_add_u32 s69, s34, 18432
    buffer_load_dwordx4 a[168:171], v104, s[12:15], s69 offen offset:0
    buffer_load_dwordx4 a[172:175], v104, s[12:15], s69 offen offset:64
    buffer_load_dwordx4 a[176:179], v104, s[12:15], s69 offen offset:128
    buffer_load_dwordx4 a[180:183], v104, s[12:15], s69 offen offset:192
    buffer_load_dwordx4 a[184:187], v104, s[12:15], s69 offen offset:256
    buffer_load_dwordx4 a[188:191], v104, s[12:15], s69 offen offset:320
    s_waitcnt vmcnt(0)
    s_call_b64 s[40:41], L_rare4_1
    v_mbcnt_lo_u32_b32 v105, -1, 0
    v_mbcnt_hi_u32_b32 v105, -1, v105
    v_and_b32 v104, 15, v105
    v_mul_u32_u24 v104, 384, v104
    v_lshrrev_b32 v105, 4, v105
    v_lshl_add_u32 v104, v105, 4, v104
    s_add_u32 s69, s33, 0
    buffer_load_dwordx4 a[96:99], v104, s[12:15], s69 offen offset:0
    buffer_load_dwordx4 a[100:103], v104, s[12:15], s69 offen offset:64
    buffer_load_dwordx4 a[104:107], v104, s[12:15], s69 offen offset:128
    buffer_load_dwordx4 a[108:111], v104, s[12:15], s69 offen offset:192
    buffer_load_dwordx4 a[112:115], v104, s[12:15], s69 offen offset:256
    buffer_load_dwordx4 a[116:119], v104, s[12:15], s69 offen offset:320
    s_add_u32 s69, s33, 6144
    buffer_load_dwordx4 a[120:123], v104, s[12:15], s69 offen offset:0
    buffer_load_dwordx4 a[124:127], v104, s[12:15], s69 offen offset:64
    buffer_load_dwordx4 a[128:131], v104, s[12:15], s69 offen offset:128
    buffer_load_dwordx4 a[132:135], v104, s[12:15], s69 offen offset:192
    buffer_load_dwordx4 a[136:139], v104, s[12:15], s69 offen offset:256
    buffer_load_dwordx4 a[140:143], v104, s[12:15], s69 offen offset:320
    s_add_u32 s69, s33, 12288
    buffer_load_dwordx4 a[144:147], v104, s[12:15], s69 offen offset:0
    buffer_load_dwordx4 a[148:151], v104, s[12:15], s69 offen offset:64
    buffer_load_dwordx4 a[152:155], v104, s[12:15], s69 offen offset:128
    buffer_load_dwordx4 a[156:159], v104, s[12:15], s69 offen offset:192
    buffer_load_dwordx4 a[160:163], v104, s[12:15], s69 offen offset:256
    buffer_load_dwordx4 a[164:167], v104, s[12:15], s69 offen offset:320
    s_add_u32 s69, s33, 18432
    buffer_load_dwordx4 a[168:171], v104, s[12:15], s69 offen offset:0
    buffer_load_dwordx4 a[172:175], v104, s[12:15], s69 offen offset:64
    buffer_load_dwordx4 a[176:179], v104, s[12:15], s69 offen offset:128
    buffer_load_dwordx4 a[180:183], v104, s[12:15], s69 offen offset:192
    buffer_load_dwordx4 a[184:187], v104, s[12:15], s69 offen offset:256
    buffer_load_dwordx4 a[188:191], v104, s[12:15], s69 offen offset:320
    s_waitcnt vmcnt(0)
    s_mov_b32 s14, s68
    s_branch L_ret_tr44b
L_rs_tr44d:
    s_call_b64 s[40:41], L_rare4_1
    s_branch L_ret_tr44d
L_rs_tr55a:
    s_call_b64 s[40:41], L_rare5_0
    s_branch L_ret_tr55a
L_rs_tr55b:
    s_nop 15
    s_waitcnt vmcnt(0) lgkmcnt(0)
    s_mov_b32 s68, s14
    s_mov_b32 s14, 166723584
    v_mbcnt_lo_u32_b32 v105, -1, 0
    v_mbcnt_hi_u32_b32 v105, -1, v105
    v_and_b32 v104, 15, v105
    v_mul_u32_u24 v104, 384, v104
    v_lshrrev_b32 v105, 4, v105
    v_lshl_add_u32 v104, v105, 4, v104
    s_add_u32 s69, s34, 0
    buffer_load_dwordx4 a[96:99], v104, s[12:15], s69 offen offset:0
    buffer_load_dwordx4 a[100:103], v104, s[12:15], s69 offen offset:64
    buffer_load_dwordx4 a[104:107], v104, s[12:15], s69 offen offset:128
    buffer_load_dwordx4 a[108:111], v104, s[12:15], s69 offen offset:192
    buffer_load_dwordx4 a[112:115], v104, s[12:15], s69 offen offset:256
    buffer_load_dwordx4 a[116:119], v104, s[12:15], s69 offen offset:320
    s_add_u32 s69, s34, 6144
    buffer_load_dwordx4 a[120:123], v104, s[12:15], s69 offen offset:0
    buffer_load_dwordx4 a[124:127], v104, s[12:15], s69 offen offset:64
    buffer_load_dwordx4 a[128:131], v104, s[12:15], s69 offen offset:128
    buffer_load_dwordx4 a[132:135], v104, s[12:15], s69 offen offset:192
    buffer_load_dwordx4 a[136:139], v104, s[12:15], s69 offen offset:256
    buffer_load_dwordx4 a[140:143], v104, s[12:15], s69 offen offset:320
    s_add_u32 s69, s34, 12288
    buffer_load_dwordx4 a[144:147], v104, s[12:15], s69 offen offset:0
    buffer_load_dwordx4 a[148:151], v104, s[12:15], s69 offen offset:64
    buffer_load_dwordx4 a[152:155], v104, s[12:15], s69 offen offset:128
    buffer_load_dwordx4 a[156:159], v104, s[12:15], s69 offen offset:192
    buffer_load_dwordx4 a[160:163], v104, s[12:15], s69 offen offset:256
    buffer_load_dwordx4 a[164:167], v104, s[12:15], s69 offen offset:320
    s_add_u32 s69, s34, 18432
    buffer_load_dwordx4 a[168:171], v104, s[12:15], s69 offen offset:0
    buffer_load_dwordx4 a[172:175], v104, s[12:15], s69 offen offset:64
    buffer_load_dwordx4 a[176:179], v104, s[12:15], s69 offen offset:128
    buffer_load_dwordx4 a[180:183], v104, s[12:15], s69 offen offset:192
    buffer_load_dwordx4 a[184:187], v104, s[12:15], s69 offen offset:256
    buffer_load_dwordx4 a[188:191], v104, s[12:15], s69 offen offset:320
    s_add_u32 s69, s34, 24576
    buffer_load_dwordx4 a[192:195], v104, s[12:15], s69 offen offset:0
    buffer_load_dwordx4 a[196:199], v104, s[12:15], s69 offen offset:64
    buffer_load_dwordx4 a[200:203], v104, s[12:15], s69 offen offset:128
    buffer_load_dwordx4 a[204:207], v104, s[12:15], s69 offen offset:192
    buffer_load_dwordx4 a[208:211], v104, s[12:15], s69 offen offset:256
    buffer_load_dwordx4 v[92:95], v104, s[12:15], s69 offen offset:320
    s_waitcnt vmcnt(0)
    s_call_b64 s[40:41], L_rare5_1
    v_mbcnt_lo_u32_b32 v105, -1, 0
    v_mbcnt_hi_u32_b32 v105, -1, v105
    v_and_b32 v104, 15, v105
    v_mul_u32_u24 v104, 384, v104
    v_lshrrev_b32 v105, 4, v105
    v_lshl_add_u32 v104, v105, 4, v104
    s_add_u32 s69, s33, 0
    buffer_load_dwordx4 a[96:99], v104, s[12:15], s69 offen offset:0
    buffer_load_dwordx4 a[100:103], v104, s[12:15], s69 offen offset:64
    buffer_load_dwordx4 a[104:107], v104, s[12:15], s69 offen offset:128
    buffer_load_dwordx4 a[108:111], v104, s[12:15], s69 offen offset:192
    buffer_load_dwordx4 a[112:115], v104, s[12:15], s69 offen offset:256
    buffer_load_dwordx4 a[116:119], v104, s[12:15], s69 offen offset:320
    s_add_u32 s69, s33, 6144
    buffer_load_dwordx4 a[120:123], v104, s[12:15], s69 offen offset:0
    buffer_load_dwordx4 a[124:127], v104, s[12:15], s69 offen offset:64
    buffer_load_dwordx4 a[128:131], v104, s[12:15], s69 offen offset:128
    buffer_load_dwordx4 a[132:135], v104, s[12:15], s69 offen offset:192
    buffer_load_dwordx4 a[136:139], v104, s[12:15], s69 offen offset:256
    buffer_load_dwordx4 a[140:143], v104, s[12:15], s69 offen offset:320
    s_add_u32 s69, s33, 12288
    buffer_load_dwordx4 a[144:147], v104, s[12:15], s69 offen offset:0
    buffer_load_dwordx4 a[148:151], v104, s[12:15], s69 offen offset:64
    buffer_load_dwordx4 a[152:155], v104, s[12:15], s69 offen offset:128
    buffer_load_dwordx4 a[156:159], v104, s[12:15], s69 offen offset:192
    buffer_load_dwordx4 a[160:163], v104, s[12:15], s69 offen offset:256
    buffer_load_dwordx4 a[164:167], v104, s[12:15], s69 offen offset:320
    s_add_u32 s69, s33, 18432
    buffer_load_dwordx4 a[168:171], v104, s[12:15], s69 offen offset:0
    buffer_load_dwordx4 a[172:175], v104, s[12:15], s69 offen offset:64
    buffer_load_dwordx4 a[176:179], v104, s[12:15], s69 offen offset:128
    buffer_load_dwordx4 a[180:183], v104, s[12:15], s69 offen offset:192
    buffer_load_dwordx4 a[184:187], v104, s[12:15], s69 offen offset:256
    buffer_load_dwordx4 a[188:191], v104, s[12:15], s69 offen offset:320
    s_add_u32 s69, s33, 24576
    buffer_load_dwordx4 a[192:195], v104, s[12:15], s69 offen offset:0
    buffer_load_dwordx4 a[196:199], v104, s[12:15], s69 offen offset:64
    buffer_load_dwordx4 a[200:203], v104, s[12:15], s69 offen offset:128
    buffer_load_dwordx4 a[204:207], v104, s[12:15], s69 offen offset:192
    buffer_load_dwordx4 a[208:211], v104, s[12:15], s69 offen offset:256
    buffer_load_dwordx4 v[92:95], v104, s[12:15], s69 offen offset:320
    s_waitcnt vmcnt(0)
    s_mov_b32 s14, s68
    s_branch L_ret_tr55b
L_rs_tr55d:
    s_call_b64 s[40:41], L_rare5_1
    s_branch L_ret_tr55d
.section .rodata,"a"
.p2align 6
.amdhsa_kernel standalone__gqa_softmax__near_ridge_kernel
  .amdhsa_next_free_vgpr 512
  .amdhsa_next_free_sgpr 102
  .amdhsa_accum_offset 256
  .amdhsa_group_segment_fixed_size 0
  .amdhsa_kernarg_size 48
  .amdhsa_user_sgpr_count 2
  .amdhsa_user_sgpr_kernarg_segment_ptr 1
  .amdhsa_system_sgpr_workgroup_id_x 1
.end_amdhsa_kernel
```

```asm
; @launch grid=(256,1,1) block=(256,1,1) lds=163840
.amdgcn_target "amdgcn-amd-amdhsa--gfx950"
.text
.globl standalone__gqa_softmax__near_ridge_kernel
.p2align 8
.type standalone__gqa_softmax__near_ridge_kernel,@function
standalone__gqa_softmax__near_ridge_kernel:
    s_cmp_ge_u32 s2, 256
    s_cbranch_scc1 L_end
    s_load_dwordx4 s[84:87], s[0:1], 0
    s_load_dwordx4 s[88:91], s[0:1], 16
    v_lshrrev_b32 v110, 6, v0
    v_and_b32 v111, 63, v0
    s_getpc_b64 s[60:61]
L_pc:
    s_lshr_b32 s62, s2, 3
    v_lshl_add_u32 v53, s62, 2, v110
    v_min_u32 v52, ((L_codeend-L_pc+16383)/16384)-1, v111
    v_mul_u32_u24 v53, ((L_codeend-L_pc+16383)/16384), v53
    v_add_lshl_u32 v52, v52, v53, 7
    v_min_u32 v52, L_codeend-L_pc-4, v52
    global_load_dword v53, v52, s[60:61]
    v_readfirstlane_b32 s3, v110
    v_lshrrev_b32 v96, 3, v111
    v_mul_u32_u24 v7, 384, v96
    v_lshrrev_b32 v97, 1, v96
    v_lshlrev_b32 v97, 1, v97
    v_and_b32 v98, 7, v111
    v_xor_b32 v97, v97, v98
    v_lshl_add_u32 v7, v97, 4, v7
    s_and_b32 s65, s3, 1
    s_mul_i32 s42, s65, 80
    s_mul_i32 s43, s65, 3072
    v_xor_b32 v6, s42, v7
    v_xor_b32 v7, 80, v6
    v_add_u32 v6, s43, v6
    s_sub_u32 s43, 3072, s43
    v_add_u32 v7, s43, v7
    s_mov_b32 s28, 0x3dd53b95
    s_mov_b32 s29, 0x4e800000
    s_mov_b32 s49, 5888
    s_mov_b32 s66, 0x28301800
    s_mov_b32 s46, 0
    s_mov_b32 s47, 0xffff0000
    s_and_b32 s42, s2, 7
    s_lshr_b32 s43, s2, 3
    s_mul_i32 s44, s43, 43
    s_lshr_b32 s44, s44, 7
    s_mov_b32 s39, s44
    s_mul_i32 s45, s44, 3
    s_sub_u32 s36, s43, s45
    s_lshl_b32 s42, s42, 6
    s_lshl_b32 s45, s45, 1
    s_add_u32 s42, s42, s45
    s_mul_i32 s64, s42, 196608
    s_mul_i32 s35, s42, 325632
    s_lshr_b32 s42, s44, 1
    s_mov_b32 s31, 0x6900924
    s_cmp_eq_u32 s42, 1
    s_cselect_b32 s31, 0x14a0489, s31
    s_cmp_eq_u32 s42, 2
    s_cselect_b32 s31, 0x8250258, s31
    s_cmp_eq_u32 s42, 3
    s_cselect_b32 s31, 0x8940912, s31
    s_cmp_eq_u32 s42, 4
    s_cselect_b32 s31, 0x1a10606, s31
    s_and_b32 s42, s44, 1
    s_lshl_b32 s42, s42, 4
    s_lshr_b32 s31, s31, s42
    s_and_b32 s31, s31, 0xffff
    s_cmp_eq_u32 s43, 30
    s_cselect_b32 s31, 0x120648, s31
    s_cmp_eq_u32 s43, 31
    s_cselect_b32 s31, 0x240219, s31
    s_lshr_b32 s63, s31, 16
    s_cmp_ge_u32 s43, 30
    s_cselect_b32 s36, 0, s36
    s_cselect_b32 s42, 4, 6
    s_mul_i32 s42, s42, 196608
    s_add_u32 s6, s64, s42
    s_mov_b32 s10, s6
    s_mul_i32 s22, s3, 3072
    s_mul_i32 s38, s3, 28672
    s_add_u32 s38, s38, 49152
    s_and_b32 s42, s3, 2
    s_mul_i32 s42, s42, 3072
    s_add_u32 s20, s64, s42
    s_mov_b32 s21, s20
    s_mov_b32 s14, 166723584
    s_mov_b32 s18, 0
    s_mov_b32 s67, 0
    s_mov_b32 s37, 0
    s_mov_b32 s60, 0
    s_mov_b32 s61, 0xffff
    s_lshl_b32 s42, s37, 1
    s_lshr_b32 s42, s31, s42
    s_and_b32 s42, s42, 3
    s_add_u32 s42, s42, s36
    s_sub_u32 s43, s42, 3
    s_cmp_ge_u32 s42, 3
    s_cselect_b32 s42, s43, s42
    s_mul_i32 s44, s3, 5
    s_mov_b32 s32, 1
    s_lshl_b32 s43, s3, 2
    s_add_u32 s45, s43, 21
    s_cmp_eq_u32 s3, 0
    s_cselect_b32 s45, 20, s45
    s_cselect_b32 s34, 1, 0
    s_cmp_eq_u32 s42, 1
    s_cselect_b32 s44, s45, s44
    s_cselect_b32 s32, s34, s32
    s_add_u32 s45, s43, 37
    s_cmp_eq_u32 s42, 2
    s_cselect_b32 s44, s45, s44
    s_cselect_b32 s32, 0, s32
    s_mul_i32 s44, s44, 6144
    s_add_u32 s34, s35, s44
    s_waitcnt lgkmcnt(0)
    s_mov_b32 s12, s84
    s_and_b32 s13, s85, 0xffff
    s_mov_b32 s15, 0x20000
    s_mov_b32 s4, s86
    s_and_b32 s5, s87, 0xffff
    s_mov_b32 s7, 0x20000
    s_mov_b32 s8, s88
    s_and_b32 s9, s89, 0xffff
    s_mov_b32 s11, 0x20000
    s_mov_b32 s16, s90
    s_and_b32 s17, s91, 0xffff
    s_mov_b32 s19, 0x20000
    s_cmp_eq_u32 s32, 0
    s_cbranch_scc1 L_start4
L_start5:
    s_add_u32 m0, s22, 0
    s_nop 0
    buffer_load_dwordx4 v6, s[4:7], s20 offen lds
    s_add_u32 s20, s20, 128
    s_add_u32 m0, s22, 1024
    s_nop 0
    buffer_load_dwordx4 v6, s[4:7], s20 offen lds
    s_add_u32 s20, s20, 128
    s_add_u32 m0, s22, 2048
    s_nop 0
    buffer_load_dwordx4 v6, s[4:7], s20 offen lds
    s_add_u32 s20, s20, 12032
    s_add_u32 m0, s22, 12288
    s_nop 0
    buffer_load_dwordx4 v6, s[4:7], s20 offen lds
    s_add_u32 s20, s20, 128
    s_add_u32 m0, s22, 13312
    s_nop 0
    buffer_load_dwordx4 v6, s[4:7], s20 offen lds
    s_add_u32 s20, s20, 128
    s_add_u32 m0, s22, 14336
    s_nop 0
    buffer_load_dwordx4 v6, s[4:7], s20 offen lds
    s_add_u32 s20, s20, 12032
    s_add_u32 s48, s34, 0
    s_add_u32 m0, s38, 0
    s_nop 0
    buffer_load_dwordx4 v6, s[12:15], s48 offen nt lds
    s_add_u32 m0, s38, 1024
    s_nop 0
    buffer_load_dwordx4 v7, s[12:15], s48 offen nt lds
    s_add_u32 s48, s34, 128
    s_add_u32 m0, s38, 2048
    s_nop 0
    buffer_load_dwordx4 v6, s[12:15], s48 offen nt lds
    s_add_u32 m0, s38, 3072
    s_nop 0
    buffer_load_dwordx4 v7, s[12:15], s48 offen nt lds
    s_add_u32 s48, s34, 256
    s_add_u32 m0, s38, 4096
    s_nop 0
    buffer_load_dwordx4 v6, s[12:15], s48 offen nt lds
    s_add_u32 m0, s38, 5120
    s_nop 0
    buffer_load_dwordx4 v7, s[12:15], s48 offen nt lds
    s_add_u32 s48, s34, 6144
    s_add_u32 m0, s38, 6144
    s_nop 0
    buffer_load_dwordx4 v6, s[12:15], s48 offen nt lds
    s_add_u32 m0, s38, 7168
    s_nop 0
    buffer_load_dwordx4 v7, s[12:15], s48 offen nt lds
    s_add_u32 s48, s34, 6272
    s_add_u32 m0, s38, 8192
    s_nop 0
    buffer_load_dwordx4 v6, s[12:15], s48 offen nt lds
    s_add_u32 m0, s38, 9216
    s_nop 0
    buffer_load_dwordx4 v7, s[12:15], s48 offen nt lds
    s_add_u32 s48, s34, 6400
    s_add_u32 m0, s38, 10240
    s_nop 0
    buffer_load_dwordx4 v6, s[12:15], s48 offen nt lds
    s_add_u32 m0, s38, 11264
    s_nop 0
    buffer_load_dwordx4 v7, s[12:15], s48 offen nt lds
    s_add_u32 s48, s34, 12288
    s_add_u32 m0, s38, 12288
    s_nop 0
    buffer_load_dwordx4 v6, s[12:15], s48 offen nt lds
    s_add_u32 m0, s38, 13312
    s_nop 0
    buffer_load_dwordx4 v7, s[12:15], s48 offen nt lds
    s_add_u32 s48, s34, 12416
    s_add_u32 m0, s38, 14336
    s_nop 0
    buffer_load_dwordx4 v6, s[12:15], s48 offen nt lds
    s_add_u32 m0, s38, 15360
    s_nop 0
    buffer_load_dwordx4 v7, s[12:15], s48 offen nt lds
    s_add_u32 s48, s34, 12544
    s_add_u32 m0, s38, 16384
    s_nop 0
    buffer_load_dwordx4 v6, s[12:15], s48 offen nt lds
    s_add_u32 m0, s38, 17408
    s_nop 0
    buffer_load_dwordx4 v7, s[12:15], s48 offen nt lds
    v_and_b32 v96, 15, v111
    v_lshrrev_b32 v97, 4, v111
    v_lshrrev_b32 v98, 3, v96
    v_and_b32 v99, 7, v96
    v_lshlrev_b32 v0, 7, v99
    v_bfe_u32 v99, v96, 1, 2
    v_lshlrev_b32 v99, 1, v99
    v_mul_u32_u24 v100, 5, v98
    v_xor_b32 v99, v99, v100
    v_xor_b32 v99, v99, v97
    v_lshl_add_u32 v0, v99, 4, v0
    v_mul_u32_u24 v100, 3072, v98
    v_add_u32 v0, v100, v0
    v_xor_b32 v1, 64, v0
    v_lshrrev_b32 v98, 1, v97
    v_mul_u32_u24 v2, 3072, v98
    v_and_b32 v99, 1, v97
    v_bfe_u32 v100, v111, 2, 2
    v_lshl_add_u32 v96, v99, 2, v100
    v_lshl_add_u32 v2, v96, 7, v2
    v_lshrrev_b32 v96, 1, v96
    v_lshlrev_b32 v96, 1, v96
    v_mul_u32_u24 v98, 5, v98
    v_xor_b32 v96, v96, v98
    v_bfe_u32 v99, v111, 1, 1
    v_xor_b32 v96, v96, v99
    v_lshl_add_u32 v2, v96, 4, v2
    v_and_b32 v99, 1, v111
    v_lshl_add_u32 v2, v99, 3, v2
    v_add_u32 v2, 24576, v2
    v_xor_b32 v3, 32, v2
    v_xor_b32 v4, 64, v2
    v_xor_b32 v5, 96, v2
    v_lshl_add_u32 v103, v111, 4, s38
    v_and_b32 v96, 15, v111
    s_mov_b32 s42, 0x1011
    v_bfe_i32 v97, s42, v96, 1
    v_and_b32 v97, 0x3f803f80, v97
    v_accvgpr_write_b32 a236, v97
    v_accvgpr_write_b32 a237, v97
    v_accvgpr_write_b32 a238, v97
    v_accvgpr_write_b32 a239, v97
    s_mov_b32 s42, 0x3222
    v_bfe_i32 v97, s42, v96, 1
    v_and_b32 v97, 0x3f803f80, v97
    v_accvgpr_write_b32 a240, v97
    v_accvgpr_write_b32 a241, v97
    v_accvgpr_write_b32 a242, v97
    v_accvgpr_write_b32 a243, v97
    s_mov_b32 s42, 0x5444
    v_bfe_i32 v97, s42, v96, 1
    v_and_b32 v97, 0x3f803f80, v97
    v_accvgpr_write_b32 a244, v97
    v_accvgpr_write_b32 a245, v97
    v_accvgpr_write_b32 a246, v97
    v_accvgpr_write_b32 a247, v97
    s_mov_b32 s42, 0x9888
    v_bfe_i32 v97, s42, v96, 1
    v_and_b32 v97, 0x3f803f80, v97
    v_accvgpr_write_b32 a248, v97
    v_accvgpr_write_b32 a249, v97
    v_accvgpr_write_b32 a250, v97
    v_accvgpr_write_b32 a251, v97
    s_mov_b32 s42, 0x1100
    v_bfe_i32 v97, s42, v96, 1
    v_and_b32 v97, 0x3f803f80, v97
    v_accvgpr_write_b32 a252, v97
    v_accvgpr_write_b32 a253, v97
    v_accvgpr_write_b32 a254, v97
    v_accvgpr_write_b32 a255, v97
    s_waitcnt vmcnt(18)
    s_barrier
    s_waitcnt vmcnt(12)
    s_add_u32 s48, s34, 18432
    s_add_u32 m0, s38, 18432
    s_nop 0
    buffer_load_dwordx4 v6, s[12:15], s48 offen nt lds
    v_lshrrev_b32 v105, 11, v0
    s_add_u32 m0, s38, 19456
    s_nop 0
    buffer_load_dwordx4 v7, s[12:15], s48 offen nt lds
    s_add_u32 s48, s34, 18560
    ds_read_b128 a[220:223], v0 offset:1024
    v_and_b32 v104, 0x3ff, v0
    s_add_u32 m0, s38, 20480
    v_xor_b32 v105, s65, v105
    buffer_load_dwordx4 v6, s[12:15], s48 offen nt lds
    ds_read_b128 a[212:215], v0 offset:0
    ds_read_b128 a[216:219], v1 offset:0
    v_lshl_add_u32 v104, v105, 10, v104
    v_add_u32 v104, s38, v104
    s_add_u32 m0, s38, 21504
    v_xor_b32 v105, 64, v104
    buffer_load_dwordx4 v7, s[12:15], s48 offen nt lds
    s_add_u32 s48, s34, 18688
    ds_read_b128 a[96:99], v104 offset:0
    s_add_u32 m0, s38, 22528
    v_mbcnt_lo_u32_b32 v107, -1, 0
    buffer_load_dwordx4 v6, s[12:15], s48 offen nt lds
    s_add_u32 m0, s38, 23552
    ds_read_b128 a[224:227], v1 offset:1024
    ds_read_b128 a[104:107], v104 offset:2048
    ds_read_b128 a[116:119], v105 offset:4096
    ds_read_b128 a[100:103], v105 offset:0
    buffer_load_dwordx4 v7, s[12:15], s48 offen nt lds
    ds_read_b128 a[232:235], v1 offset:2048
    s_waitcnt lgkmcnt(5)
    v_mfma_f32_16x16x32_bf16 v[52:55], a[212:215], a[96:99], 0
    ds_read_b128 a[228:231], v0 offset:2048
    s_waitcnt lgkmcnt(2)
    v_mfma_f32_16x16x32_bf16 v[52:55], a[216:219], a[100:103], v[52:55]
    v_mbcnt_hi_u32_b32 v107, -1, v107
    ds_read_b128 a[108:111], v105 offset:2048
    v_mfma_f32_16x16x32_bf16 v[52:55], a[220:223], a[104:107], v[52:55]
    ds_read_b128 a[112:115], v104 offset:4096
    s_waitcnt lgkmcnt(1)
    v_mfma_f32_16x16x32_bf16 v[52:55], a[224:227], a[108:111], v[52:55]
    ds_read_b128 a[220:223], v0 offset:7168
    s_waitcnt lgkmcnt(1)
    v_mfma_f32_16x16x32_bf16 v[52:55], a[228:231], a[112:115], v[52:55]
    v_and_b32 v106, 15, v107
    ds_read_b128 a[212:215], v0 offset:6144
    v_mfma_f32_16x16x32_bf16 v[52:55], a[232:235], a[116:119], v[52:55]
    ds_read_b128 a[216:219], v1 offset:6144
    s_waitcnt lgkmcnt(1)
    v_mfma_f32_16x16x32_bf16 v[56:59], a[212:215], a[96:99], 0
    ds_read_b128 a[224:227], v1 offset:7168
    s_waitcnt lgkmcnt(1)
    v_mfma_f32_16x16x32_bf16 v[56:59], a[216:219], a[100:103], v[56:59]
    ds_read_b128 a[232:235], v1 offset:8192
    s_nop 0
    v_max3_f32 v96, v52, v53, v54
    ds_read_b128 a[212:215], v0 offset:12288
    v_mfma_f32_16x16x32_bf16 v[56:59], a[220:223], a[104:107], v[56:59]
    ds_read_b128 a[220:223], v0 offset:13312
    s_waitcnt lgkmcnt(3)
    v_mfma_f32_16x16x32_bf16 v[56:59], a[224:227], a[108:111], v[56:59]
    ds_read_b128 a[228:231], v0 offset:8192
    s_waitcnt lgkmcnt(0)
    v_mfma_f32_16x16x32_bf16 v[56:59], a[228:231], a[112:115], v[56:59]
    ds_read_b128 a[228:231], v0 offset:14336
    v_mfma_f32_16x16x32_bf16 v[56:59], a[232:235], a[116:119], v[56:59]
    s_nop 7
    v_max3_f32 v96, v96, v55, v56
    v_max3_f32 v96, v96, v57, v58
    v_max_f32 v96, v96, v59
    v_mul_u32_u24 v106, 384, v106
    ds_read_b128 a[232:235], v1 offset:14336
    v_mov_b32 v97, v96
    s_nop 1
    v_permlane32_swap_b32 v97, v96
    v_lshrrev_b32 v107, 4, v107
    v_max_f32 v96, v96, v97
    v_mov_b32 v97, v96
    s_nop 1
    v_permlane16_swap_b32 v97, v96
    v_max_f32 v96, v96, v97
    v_mul_f32_e64 v9, -s28, v96
    v_fma_f32 v54, v54, s28, v9
    v_fma_f32 v59, v59, s28, v9
    v_fma_f32 v55, v55, s28, v9
    v_fma_f32 v52, v52, s28, v9
    v_exp_f32 v59, v59
    v_fma_f32 v58, v58, s28, v9
    v_exp_f32 v55, v55
    v_fma_f32 v53, v53, s28, v9
    v_exp_f32 v54, v54
    ds_read_b128 a[224:227], v1 offset:13312
    v_cvt_pk_bf16_f32 v15, v54, v55
    ds_read_b128 a[216:219], v1 offset:12288
    v_fma_f32 v56, v56, s28, v9
    v_exp_f32 v53, v53
    v_exp_f32 v52, v52
    v_exp_f32 v56, v56
    v_cvt_pk_bf16_f32 v14, v52, v53
    v_fma_f32 v57, v57, s28, v9
    v_exp_f32 v58, v58
    s_waitcnt vmcnt(12)
    s_add_u32 s48, s34, 24576
    s_add_u32 m0, s38, 24576
    s_nop 0
    buffer_load_dwordx4 v6, s[12:15], s48 offen nt lds
    s_add_u32 m0, s38, 25600
    v_mfma_f32_16x16x32_bf16 v[52:55], a[212:215], a[96:99], 0
    buffer_load_dwordx4 v7, s[12:15], s48 offen nt lds
    s_add_u32 s48, s34, 24704
    ds_read_b128 a[212:215], v0 offset:18432
    s_waitcnt lgkmcnt(1)
    v_mfma_f32_16x16x32_bf16 v[52:55], a[216:219], a[100:103], v[52:55]
    s_add_u32 m0, s38, 26624
    s_nop 0
    buffer_load_dwordx4 v6, s[12:15], s48 offen nt lds
    ds_read_b128 a[216:219], v1 offset:18432
    v_exp_f32 v57, v57
    s_add_u32 m0, s38, 27648
    v_mfma_f32_16x16x32_bf16 v[52:55], a[220:223], a[104:107], v[52:55]
    buffer_load_dwordx4 v7, s[12:15], s48 offen nt lds
    s_add_u32 s48, s34, 24576
    ds_read_b128 a[140:143], v105 offset:10240
    v_lshl_add_u32 v106, v107, 4, v106
    v_mfma_f32_16x16x32_bf16 v[52:55], a[224:227], a[108:111], v[52:55]
    ds_read_b128 a[132:135], v105 offset:8192
    buffer_load_dwordx4 a[208:211], v106, s[12:15], s48 offen offset:256 nt
    ds_read_b128 a[120:123], v104 offset:6144
    v_mfma_f32_16x16x32_bf16 v[52:55], a[228:231], a[112:115], v[52:55]
    ds_read_b128 a[224:227], v1 offset:19456
    v_cvt_pk_bf16_f32 v17, v58, v59
    ds_read_b128 a[228:231], v0 offset:20480
    v_cvt_pk_bf16_f32 v16, v56, v57
    v_mfma_f32_16x16x32_bf16 v[52:55], a[232:235], a[116:119], v[52:55]
    ds_read_b128 a[220:223], v0 offset:19456
    buffer_load_dwordx4 v[92:95], v106, s[12:15], s48 offen offset:320 nt
    s_waitcnt lgkmcnt(7)
    v_mfma_f32_16x16x32_bf16 v[56:59], a[212:215], a[96:99], 0
    ds_read_b128 a[232:235], v1 offset:20480
    s_waitcnt lgkmcnt(7)
    v_mfma_f32_16x16x32_bf16 v[56:59], a[216:219], a[100:103], v[56:59]
    ds_read_b128 a[216:219], v1 offset:0
    s_waitcnt lgkmcnt(2)
    v_mfma_f32_16x16x32_bf16 v[56:59], a[220:223], a[104:107], v[56:59]
    ds_read_b128 a[220:223], v0 offset:1024
    ds_read_b128 a[128:131], v104 offset:8192
    v_mfma_f32_16x16x32_bf16 v[56:59], a[224:227], a[108:111], v[56:59]
    ds_read_b128 a[136:139], v104 offset:10240
    v_mfma_f32_16x16x32_bf16 v[56:59], a[228:231], a[112:115], v[56:59]
    s_waitcnt lgkmcnt(4)
    ds_read_b128 a[228:231], v0 offset:2048
    ds_read_b128 a[212:215], v0 offset:0
    v_mfma_f32_16x16x32_bf16 v[56:59], a[232:235], a[116:119], v[56:59]
    ds_read_b128 a[124:127], v105 offset:6144
    s_waitcnt lgkmcnt(1)
    v_mfma_f32_16x16x32_bf16 v[60:63], a[212:215], a[120:123], 0
    ds_read_b128 a[232:235], v1 offset:2048
    s_waitcnt lgkmcnt(1)
    v_mfma_f32_16x16x32_bf16 v[60:63], a[216:219], a[124:127], v[60:63]
    ds_read_b128 a[212:215], v0 offset:6144
    v_mfma_f32_16x16x32_bf16 v[60:63], a[220:223], a[128:131], v[60:63]
    ds_read_b128 a[224:227], v1 offset:1024
    s_waitcnt lgkmcnt(0)
    v_mfma_f32_16x16x32_bf16 v[60:63], a[224:227], a[132:135], v[60:63]
    ds_read_b128 a[220:223], v0 offset:7168
    v_mfma_f32_16x16x32_bf16 v[60:63], a[228:231], a[136:139], v[60:63]
    ds_read_b128 a[228:231], v0 offset:8192
    v_mfma_f32_16x16x32_bf16 v[60:63], a[232:235], a[140:143], v[60:63]
    ds_read_b128 a[216:219], v1 offset:6144
    v_mfma_f32_16x16x32_bf16 v[64:67], a[212:215], a[120:123], 0
    s_nop 5
    v_max3_f32 v98, v60, v61, v62
    ds_read_b128 a[212:215], v0 offset:12288
    s_waitcnt lgkmcnt(1)
    v_mfma_f32_16x16x32_bf16 v[64:67], a[216:219], a[124:127], v[64:67]
    ds_read_b128 a[224:227], v1 offset:7168
    v_mfma_f32_16x16x32_bf16 v[64:67], a[220:223], a[128:131], v[64:67]
    ds_read_b128 a[220:223], v0 offset:13312
    s_waitcnt lgkmcnt(1)
    v_mfma_f32_16x16x32_bf16 v[64:67], a[224:227], a[132:135], v[64:67]
    ds_read_b128 a[232:235], v1 offset:8192
    v_mfma_f32_16x16x32_bf16 v[64:67], a[228:231], a[136:139], v[64:67]
    ds_read_b128 a[228:231], v0 offset:14336
    v_fma_f32 v52, v52, s28, v9
    s_waitcnt lgkmcnt(1)
    v_mfma_f32_16x16x32_bf16 v[64:67], a[232:235], a[140:143], v[64:67]
    s_nop 7
    v_max3_f32 v98, v98, v63, v64
    v_max3_f32 v98, v98, v65, v66
    v_max_f32 v98, v98, v67
    v_mov_b32 v99, v98
    s_nop 1
    v_permlane32_swap_b32 v99, v98
    v_max_f32 v98, v98, v99
    v_mov_b32 v99, v98
    s_nop 1
    v_permlane16_swap_b32 v99, v98
    v_max_f32 v98, v98, v99
    v_mul_f32_e64 v10, -s28, v98
    v_fma_f32 v54, v54, s28, v9
    v_fma_f32 v63, v63, s28, v10
    v_fma_f32 v60, v60, s28, v10
    ds_read_b128 a[232:235], v1 offset:14336
    v_fma_f32 v67, v67, s28, v10
    v_fma_f32 v66, v66, s28, v10
    v_fma_f32 v64, v64, s28, v10
    v_exp_f32 v63, v63
    v_fma_f32 v65, v65, s28, v10
    v_exp_f32 v65, v65
    v_exp_f32 v64, v64
    v_fma_f32 v61, v61, s28, v10
    v_exp_f32 v67, v67
    v_exp_f32 v61, v61
    v_exp_f32 v60, v60
    ds_read_b128 a[216:219], v1 offset:12288
    v_cvt_pk_bf16_f32 v20, v60, v61
    v_fma_f32 v62, v62, s28, v10
    v_exp_f32 v62, v62
    v_exp_f32 v66, v66
    s_nop 0
    v_cvt_pk_bf16_f32 v23, v66, v67
    v_cvt_pk_bf16_f32 v21, v62, v63
    s_waitcnt vmcnt(12)
    s_add_u32 m0, s22, 24576
    s_nop 0
    buffer_load_dwordx4 v6, s[8:11], s21 offen lds
    v_mfma_f32_16x16x32_bf16 v[44:47], a[236:239], v[14:17], 0
    s_add_u32 s21, s21, 128
    s_add_u32 m0, s22, 25600
    s_nop 0
    buffer_load_dwordx4 v6, s[8:11], s21 offen lds
    s_add_u32 s21, s21, 128
    ds_read_b128 a[152:155], v104 offset:14336
    s_add_u32 m0, s22, 26624
    ds_read_b128 a[224:227], v1 offset:13312
    v_mfma_f32_16x16x32_bf16 v[60:63], a[212:215], a[120:123], 0
    ds_read_b128 a[212:215], v0 offset:18432
    buffer_load_dwordx4 v6, s[8:11], s21 offen lds
    s_waitcnt lgkmcnt(3)
    v_mfma_f32_16x16x32_bf16 v[60:63], a[216:219], a[124:127], v[60:63]
    ds_read_b128 a[144:147], v104 offset:12288
    v_mfma_f32_16x16x32_bf16 v[60:63], a[220:223], a[128:131], v[60:63]
    ds_read_b128 a[216:219], v1 offset:18432
    s_waitcnt lgkmcnt(3)
    v_mfma_f32_16x16x32_bf16 v[60:63], a[224:227], a[132:135], v[60:63]
    ds_read_b128 a[220:223], v0 offset:19456
    ds_read_b128 a[156:159], v105 offset:14336
    v_cvt_pk_bf16_f32 v22, v64, v65
    v_mfma_f32_16x16x32_bf16 v[60:63], a[228:231], a[136:139], v[60:63]
    ds_read_b128 a[224:227], v1 offset:19456
    s_add_u32 s21, s21, 12032
    v_mfma_f32_16x16x32_bf16 v[60:63], a[232:235], a[140:143], v[60:63]
    s_waitcnt lgkmcnt(5)
    ds_read_b128 a[228:231], v0 offset:20480
    v_fma_f32 v55, v55, s28, v9
    v_mfma_f32_16x16x32_bf16 v[64:67], a[212:215], a[120:123], 0
    ds_read_b128 a[232:235], v1 offset:20480
    s_waitcnt lgkmcnt(5)
    v_mfma_f32_16x16x32_bf16 v[64:67], a[216:219], a[124:127], v[64:67]
    ds_read_b128 a[164:167], v105 offset:16384
    s_waitcnt lgkmcnt(5)
    v_mfma_f32_16x16x32_bf16 v[64:67], a[220:223], a[128:131], v[64:67]
    ds_read_b128 a[216:219], v1 offset:0
    s_waitcnt lgkmcnt(4)
    v_mfma_f32_16x16x32_bf16 v[64:67], a[224:227], a[132:135], v[64:67]
    ds_read_b128 a[148:151], v105 offset:12288
    s_waitcnt lgkmcnt(4)
    v_mfma_f32_16x16x32_bf16 v[64:67], a[228:231], a[136:139], v[64:67]
    ds_read_b128 a[212:215], v0 offset:0
    s_waitcnt lgkmcnt(4)
    v_mfma_f32_16x16x32_bf16 v[64:67], a[232:235], a[140:143], v[64:67]
    ds_read_b128 a[220:223], v0 offset:1024
    s_waitcnt lgkmcnt(1)
    v_mfma_f32_16x16x32_bf16 v[68:71], a[212:215], a[144:147], 0
    ds_read_b128 a[224:227], v1 offset:1024
    ds_read_b128 a[228:231], v0 offset:2048
    v_mfma_f32_16x16x32_bf16 v[68:71], a[216:219], a[148:151], v[68:71]
    s_waitcnt lgkmcnt(2)
    ds_read_b128 a[232:235], v1 offset:2048
    v_mfma_f32_16x16x32_bf16 v[68:71], a[220:223], a[152:155], v[68:71]
    ds_read_b128 a[160:163], v104 offset:16384
    ds_read_b128 a[216:219], v1 offset:6144
    s_waitcnt lgkmcnt(4)
    v_mfma_f32_16x16x32_bf16 v[68:71], a[224:227], a[156:159], v[68:71]
    ds_read_b128 a[212:215], v0 offset:6144
    s_waitcnt lgkmcnt(2)
    v_mfma_f32_16x16x32_bf16 v[68:71], a[228:231], a[160:163], v[68:71]
    ds_read_b128 a[220:223], v0 offset:7168
    v_mfma_f32_16x16x32_bf16 v[68:71], a[232:235], a[164:167], v[68:71]
    s_nop 7
    v_max3_f32 v96, v68, v69, v70
    ds_read_b128 a[232:235], v1 offset:8192
    s_waitcnt lgkmcnt(2)
    v_mfma_f32_16x16x32_bf16 v[72:75], a[212:215], a[144:147], 0
    ds_read_b128 a[228:231], v0 offset:8192
    v_mfma_f32_16x16x32_bf16 v[72:75], a[216:219], a[148:151], v[72:75]
    ds_read_b128 a[212:215], v0 offset:12288
    v_fma_f32 v53, v53, s28, v9
    s_waitcnt lgkmcnt(3)
    v_mfma_f32_16x16x32_bf16 v[72:75], a[220:223], a[152:155], v[72:75]
    ds_read_b128 a[224:227], v1 offset:7168
    ds_read_b128 a[220:223], v0 offset:13312
    v_fma_f32 v60, v60, s28, v10
    s_waitcnt lgkmcnt(1)
    v_mfma_f32_16x16x32_bf16 v[72:75], a[224:227], a[156:159], v[72:75]
    ds_read_b128 a[224:227], v1 offset:13312
    v_mfma_f32_16x16x32_bf16 v[72:75], a[228:231], a[160:163], v[72:75]
    v_exp_f32 v54, v54
    ds_read_b128 a[216:219], v1 offset:12288
    v_mfma_f32_16x16x32_bf16 v[72:75], a[232:235], a[164:167], v[72:75]
    s_nop 7
    v_max3_f32 v96, v96, v71, v72
    v_max3_f32 v96, v96, v73, v74
    v_max_f32 v96, v96, v75
    v_exp_f32 v53, v53
    ds_read_b128 a[228:231], v0 offset:14336
    v_mov_b32 v97, v96
    s_nop 1
    v_permlane32_swap_b32 v97, v96
    v_max_f32 v96, v96, v97
    v_mov_b32 v97, v96
    s_nop 1
    v_permlane16_swap_b32 v97, v96
    v_fma_f32 v63, v63, s28, v10
    v_max_f32 v96, v96, v97
    v_mul_f32_e64 v11, -s28, v96
    v_fma_f32 v69, v69, s28, v11
    v_fma_f32 v68, v68, s28, v11
    v_fma_f32 v72, v72, s28, v11
    v_fma_f32 v75, v75, s28, v11
    v_fma_f32 v74, v74, s28, v11
    v_exp_f32 v75, v75
    v_exp_f32 v63, v63
    v_fma_f32 v71, v71, s28, v11
    v_exp_f32 v69, v69
    v_fma_f32 v70, v70, s28, v11
    v_exp_f32 v70, v70
    v_exp_f32 v68, v68
    v_mfma_f32_16x16x32_bf16 v[44:47], a[240:243], v[20:23], v[44:47]
    v_exp_f32 v74, v74
    v_cvt_pk_bf16_f32 v26, v68, v69
    v_fma_f32 v73, v73, s28, v11
    v_exp_f32 v73, v73
    v_exp_f32 v71, v71
    s_waitcnt vmcnt(9)
    s_add_u32 m0, s22, 36864
    ds_read_b128 a[232:235], v1 offset:14336
    buffer_load_dwordx4 v6, s[8:11], s21 offen lds
    s_add_u32 s21, s21, 128
    s_add_u32 m0, s22, 37888
    v_cvt_pk_bf16_f32 v27, v70, v71
    v_mfma_f32_16x16x32_bf16 v[68:71], a[212:215], a[144:147], 0
    buffer_load_dwordx4 v6, s[8:11], s21 offen lds
    ds_read_b128 a[212:215], v0 offset:18432
    s_add_u32 s21, s21, 128
    s_waitcnt lgkmcnt(2)
    v_mfma_f32_16x16x32_bf16 v[68:71], a[216:219], a[148:151], v[68:71]
    s_add_u32 m0, s22, 38912
    s_nop 0
    buffer_load_dwordx4 v6, s[8:11], s21 offen lds
    ds_read_b128 a[184:187], v104 offset:22528
    v_mfma_f32_16x16x32_bf16 v[68:71], a[220:223], a[152:155], v[68:71]
    v_fma_f32 v61, v61, s28, v10
    ds_read_b128 a[172:175], v105 offset:18432
    v_exp_f32 v72, v72
    v_mfma_f32_16x16x32_bf16 v[68:71], a[224:227], a[156:159], v[68:71]
    v_cvt_pk_bf16_f32 v29, v74, v75
    ds_read_b128 a[176:179], v104 offset:20480
    s_add_u32 s21, s21, 12032
    v_mfma_f32_16x16x32_bf16 v[68:71], a[228:231], a[160:163], v[68:71]
    v_cvt_pk_bf16_f32 v28, v72, v73
    ds_read_b128 a[180:183], v105 offset:20480
    ds_read_b128 a[168:171], v104 offset:18432
    s_waitcnt lgkmcnt(6)
    v_mfma_f32_16x16x32_bf16 v[68:71], a[232:235], a[164:167], v[68:71]
    ds_read_b128 a[216:219], v1 offset:18432
    s_waitcnt lgkmcnt(6)
    v_mfma_f32_16x16x32_bf16 v[72:75], a[212:215], a[144:147], 0
    ds_read_b128 a[220:223], v0 offset:19456
    ds_read_b128 a[228:231], v0 offset:20480
    v_mfma_f32_16x16x32_bf16 v[44:47], a[244:247], v[26:29], v[44:47]
    ds_read_b128 a[224:227], v1 offset:19456
    ds_read_b128 a[232:235], v1 offset:20480
    s_waitcnt lgkmcnt(4)
    v_mfma_f32_16x16x32_bf16 v[72:75], a[216:219], a[148:151], v[72:75]
    ds_read_b128 a[216:219], v1 offset:0
    v_fma_f32 v62, v62, s28, v10
    s_waitcnt lgkmcnt(4)
    v_mfma_f32_16x16x32_bf16 v[72:75], a[220:223], a[152:155], v[72:75]
    ds_read_b128 a[212:215], v0 offset:0
    s_waitcnt lgkmcnt(3)
    v_mfma_f32_16x16x32_bf16 v[72:75], a[224:227], a[156:159], v[72:75]
    ds_read_b128 a[220:223], v0 offset:1024
    v_mfma_f32_16x16x32_bf16 v[72:75], a[228:231], a[160:163], v[72:75]
    s_waitcnt lgkmcnt(3)
    ds_read_b128 a[224:227], v1 offset:1024
    v_mfma_f32_16x16x32_bf16 v[72:75], a[232:235], a[164:167], v[72:75]
    ds_read_b128 a[188:191], v105 offset:22528
    s_waitcnt lgkmcnt(3)
    v_mfma_f32_16x16x32_bf16 v[76:79], a[212:215], a[168:171], 0
    ds_read_b128 a[228:231], v0 offset:2048
    v_mfma_f32_16x16x32_bf16 v[76:79], a[216:219], a[172:175], v[76:79]
    s_waitcnt lgkmcnt(3)
    ds_read_b128 a[232:235], v1 offset:2048
    v_mfma_f32_16x16x32_bf16 v[76:79], a[220:223], a[176:179], v[76:79]
    s_waitcnt lgkmcnt(3)
    ds_read_b128 a[216:219], v1 offset:6144
    v_exp_f32 v52, v52
    v_mfma_f32_16x16x32_bf16 v[76:79], a[224:227], a[180:183], v[76:79]
    ds_read_b128 a[212:215], v0 offset:6144
    s_waitcnt lgkmcnt(3)
    v_mfma_f32_16x16x32_bf16 v[76:79], a[228:231], a[184:187], v[76:79]
    ds_read_b128 a[220:223], v0 offset:7168
    v_exp_f32 v55, v55
    s_waitcnt lgkmcnt(3)
    v_mfma_f32_16x16x32_bf16 v[76:79], a[232:235], a[188:191], v[76:79]
    ds_read_b128 a[228:231], v0 offset:8192
    s_waitcnt lgkmcnt(2)
    v_mfma_f32_16x16x32_bf16 v[80:83], a[212:215], a[168:171], 0
    ds_read_b128 a[224:227], v1 offset:7168
    v_mfma_f32_16x16x32_bf16 v[80:83], a[216:219], a[172:175], v[80:83]
    ds_read_b128 a[232:235], v1 offset:8192
    s_waitcnt lgkmcnt(3)
    v_mfma_f32_16x16x32_bf16 v[80:83], a[220:223], a[176:179], v[80:83]
    ds_read_b128 a[220:223], v0 offset:13312
    v_max3_f32 v98, v76, v77, v78
    s_waitcnt lgkmcnt(2)
    v_mfma_f32_16x16x32_bf16 v[80:83], a[224:227], a[180:183], v[80:83]
    ds_read_b128 a[212:215], v0 offset:12288
    v_mfma_f32_16x16x32_bf16 v[80:83], a[228:231], a[184:187], v[80:83]
    s_waitcnt lgkmcnt(2)
    ds_read_b128 a[216:219], v1 offset:12288
    v_mfma_f32_16x16x32_bf16 v[80:83], a[232:235], a[188:191], v[80:83]
    s_nop 7
    v_max3_f32 v98, v98, v79, v80
    v_max3_f32 v98, v98, v81, v82
    v_max_f32 v98, v98, v83
    v_mov_b32 v99, v98
    s_nop 1
    v_permlane32_swap_b32 v99, v98
    v_max_f32 v98, v98, v99
    v_mov_b32 v99, v98
    s_nop 1
    v_permlane16_swap_b32 v99, v98
    ds_read_b128 a[224:227], v1 offset:13312
    v_max_f32 v98, v98, v99
    v_mul_f32_e64 v12, -s28, v98
    v_fma_f32 v78, v78, s28, v12
    ds_read_b128 a[232:235], v1 offset:14336
    v_fma_f32 v80, v80, s28, v12
    v_fma_f32 v76, v76, s28, v12
    v_exp_f32 v60, v60
    v_exp_f32 v62, v62
    v_fma_f32 v77, v77, s28, v12
    v_fma_f32 v79, v79, s28, v12
    v_exp_f32 v79, v79
    v_exp_f32 v78, v78
    v_fma_f32 v82, v82, s28, v12
    v_exp_f32 v77, v77
    v_fma_f32 v81, v81, s28, v12
    v_fma_f32 v83, v83, s28, v12
    v_exp_f32 v76, v76
    s_nop 0
    v_cvt_pk_bf16_f32 v32, v76, v77
    v_cvt_pk_bf16_f32 v33, v78, v79
    v_exp_f32 v80, v80
    s_waitcnt lgkmcnt(2)
    v_mfma_f32_16x16x32_bf16 v[76:79], a[212:215], a[168:171], 0
    ds_read_b128 a[228:231], v0 offset:14336
    v_exp_f32 v83, v83
    v_cvt_pk_bf16_f32 v19, v54, v55
    v_mfma_f32_16x16x32_bf16 v[76:79], a[216:219], a[172:175], v[76:79]
    ds_read_b128 a[212:215], v0 offset:18432
    v_mfma_f32_16x16x32_bf16 v[76:79], a[220:223], a[176:179], v[76:79]
    s_waitcnt lgkmcnt(3)
    v_exp_f32 v61, v61
    ds_read_b128 a[216:219], v1 offset:18432
    v_mfma_f32_16x16x32_bf16 v[76:79], a[224:227], a[180:183], v[76:79]
    ds_read_b128 a[220:223], v0 offset:19456
    v_exp_f32 v81, v81
    v_exp_f32 v82, v82
    s_waitcnt lgkmcnt(3)
    v_mfma_f32_16x16x32_bf16 v[76:79], a[228:231], a[184:187], v[76:79]
    v_cvt_pk_bf16_f32 v18, v52, v53
    v_cvt_pk_bf16_f32 v34, v80, v81
    v_cvt_pk_bf16_f32 v25, v62, v63
    ds_read_b128 a[224:227], v1 offset:19456
    v_mfma_f32_16x16x32_bf16 v[76:79], a[232:235], a[188:191], v[76:79]
    s_waitcnt lgkmcnt(3)
    ds_read_b128 a[228:231], v0 offset:20480
    v_cvt_pk_bf16_f32 v35, v82, v83
    v_mfma_f32_16x16x32_bf16 v[80:83], a[212:215], a[168:171], 0
    s_waitcnt lgkmcnt(3)
    ds_read_b128 a[232:235], v1 offset:20480
    v_mfma_f32_16x16x32_bf16 v[80:83], a[216:219], a[172:175], v[80:83]
    s_waitcnt lgkmcnt(3)
    ds_read_b128 a[216:219], v1 offset:0
    v_mfma_f32_16x16x32_bf16 v[80:83], a[220:223], a[176:179], v[80:83]
    ds_read_b128 a[212:215], v0 offset:0
    s_waitcnt vmcnt(6)
    ds_read_b128 a[192:195], v104 offset:24576
    ds_read_b128 a[200:203], v104 offset:26624
    ds_read_b128 a[196:199], v105 offset:24576
    s_waitcnt lgkmcnt(6)
    v_mfma_f32_16x16x32_bf16 v[80:83], a[224:227], a[180:183], v[80:83]
    ds_read_b128 a[220:223], v0 offset:1024
    v_mfma_f32_16x16x32_bf16 v[80:83], a[228:231], a[184:187], v[80:83]
    s_waitcnt lgkmcnt(6)
    ds_read_b128 a[204:207], v105 offset:26624
    ds_read_b128 a[224:227], v1 offset:1024
    v_mfma_f32_16x16x32_bf16 v[80:83], a[232:235], a[188:191], v[80:83]
    ds_read_b128 a[228:231], v0 offset:2048
    ds_read_b128 a[232:235], v1 offset:2048
    s_waitcnt lgkmcnt(7)
    v_mfma_f32_16x16x32_bf16 v[84:87], a[212:215], a[192:195], 0
    s_waitcnt lgkmcnt(5)
    ds_read_b128 a[212:215], v0 offset:6144
    v_mfma_f32_16x16x32_bf16 v[84:87], a[216:219], a[196:199], v[84:87]
    s_waitcnt lgkmcnt(5)
    ds_read_b128 a[216:219], v1 offset:6144
    v_mfma_f32_16x16x32_bf16 v[84:87], a[220:223], a[200:203], v[84:87]
    ds_read_b128 a[220:223], v0 offset:7168
    s_waitcnt lgkmcnt(5)
    v_mfma_f32_16x16x32_bf16 v[84:87], a[224:227], a[204:207], v[84:87]
    s_waitcnt lgkmcnt(4)
    ds_read_b128 a[224:227], v1 offset:7168
    v_mfma_f32_16x16x32_bf16 v[84:87], a[228:231], a[208:211], v[84:87]
    s_waitcnt lgkmcnt(4)
    ds_read_b128 a[228:231], v0 offset:8192
    v_mfma_f32_16x16x32_bf16 v[84:87], a[232:235], v[92:95], v[84:87]
    ds_read_b128 a[232:235], v1 offset:8192
    s_waitcnt lgkmcnt(5)
    v_mfma_f32_16x16x32_bf16 v[88:91], a[212:215], a[192:195], 0
    s_waitcnt lgkmcnt(4)
    v_mfma_f32_16x16x32_bf16 v[88:91], a[216:219], a[196:199], v[88:91]
    s_waitcnt lgkmcnt(3)
    v_mfma_f32_16x16x32_bf16 v[88:91], a[220:223], a[200:203], v[88:91]
    s_waitcnt lgkmcnt(2)
    v_mfma_f32_16x16x32_bf16 v[88:91], a[224:227], a[204:207], v[88:91]
    s_waitcnt lgkmcnt(1)
    v_mfma_f32_16x16x32_bf16 v[88:91], a[228:231], a[208:211], v[88:91]
    v_max3_f32 v96, v84, v85, v86
    s_waitcnt vmcnt(63) lgkmcnt(0)
    s_barrier
    s_add_u32 m0, s22, 0
    ds_read_b128 a[216:219], v1 offset:12288
    buffer_load_dwordx4 v6, s[4:7], s20 offen lds
    v_mfma_f32_16x16x32_bf16 v[88:91], a[232:235], v[92:95], v[88:91]
    s_add_u32 s20, s20, 128
    s_add_u32 m0, s22, 1024
    ds_read_b128 a[212:215], v0 offset:12288
    buffer_load_dwordx4 v6, s[4:7], s20 offen lds
    s_add_u32 s20, s20, 128
    v_mfma_f32_16x16x32_bf16 v[44:47], a[248:251], v[32:35], v[44:47]
    s_add_u32 m0, s22, 2048
    ds_read_b128 a[224:227], v1 offset:13312
    buffer_load_dwordx4 v6, s[4:7], s20 offen lds
    ds_read_b128 a[228:231], v0 offset:14336
    ds_read_b128 a[232:235], v1 offset:14336
    ds_read_b128 a[220:223], v0 offset:13312
    s_add_u32 s20, s20, 12032
    v_max3_f32 v96, v96, v87, v88
    v_max3_f32 v96, v96, v89, v90
    v_max_f32 v96, v96, v91
    v_mov_b32 v97, v96
    s_mov_b32 s39, s64
    s_add_u32 s37, s37, 1
    v_permlane32_swap_b32 v97, v96
    v_max_f32 v96, v96, v97
    v_mov_b32 v97, v96
    s_bitcmp1_b32 s63, s37
    s_cselect_b32 s62, 4294770688, 0
    v_permlane16_swap_b32 v97, v96
    v_max_f32 v96, v96, v97
    s_cselect_b32 s42, 0, 325632
    v_mul_f32_e64 v13, -s28, v96
    v_fma_f32 v85, v85, s28, v13
    v_fma_f32 v87, v87, s28, v13
    v_fma_f32 v84, v84, s28, v13
    s_add_u32 s35, s35, s42
    v_exp_f32 v87, v87
    v_exp_f32 v84, v84
    v_fma_f32 v86, v86, s28, v13
    v_exp_f32 v85, v85
    v_exp_f32 v86, v86
    v_cvt_pk_bf16_f32 v38, v84, v85
    v_cvt_pk_bf16_f32 v39, v86, v87
    s_waitcnt lgkmcnt(3)
    v_mfma_f32_16x16x32_bf16 v[84:87], a[212:215], a[192:195], 0
    s_lshl_b32 s42, s37, 1
    ds_read_b128 a[212:215], v0 offset:18432
    s_lshr_b32 s42, s31, s42
    v_mfma_f32_16x16x32_bf16 v[84:87], a[216:219], a[196:199], v[84:87]
    s_waitcnt lgkmcnt(1)
    ds_read_b128 a[216:219], v1 offset:18432
    s_and_b32 s42, s42, 3
    v_mfma_f32_16x16x32_bf16 v[84:87], a[220:223], a[200:203], v[84:87]
    s_add_u32 s42, s42, s36
    ds_read_b128 a[220:223], v0 offset:19456
    s_sub_u32 s43, s42, 3
    v_mfma_f32_16x16x32_bf16 v[84:87], a[224:227], a[204:207], v[84:87]
    s_cmp_ge_u32 s42, 3
    ds_read_b128 a[224:227], v1 offset:19456
    s_cselect_b32 s42, s43, s42
    v_mfma_f32_16x16x32_bf16 v[84:87], a[228:231], a[208:211], v[84:87]
    s_mul_i32 s44, s3, 5
    s_mov_b32 s32, 1
    ds_read_b128 a[228:231], v0 offset:20480
    v_mfma_f32_16x16x32_bf16 v[84:87], a[232:235], v[92:95], v[84:87]
    s_lshl_b32 s43, s3, 2
    ds_read_b128 a[232:235], v1 offset:20480
    s_add_u32 s45, s43, 21
    v_fma_f32 v91, v91, s28, v13
    s_cmp_eq_u32 s3, 0
    v_fma_f32 v88, v88, s28, v13
    s_cselect_b32 s45, 20, s45
    v_fma_f32 v90, v90, s28, v13
    s_cselect_b32 s33, 1, 0
    s_cmp_eq_u32 s42, 1
    s_cselect_b32 s44, s45, s44
    s_cselect_b32 s32, s33, s32
    v_fma_f32 v89, v89, s28, v13
    s_add_u32 s45, s43, 37
    v_exp_f32 v88, v88
    v_exp_f32 v90, v90
    s_cmp_eq_u32 s42, 2
    s_cselect_b32 s44, s45, s44
    s_cselect_b32 s32, 0, s32
    s_mul_i32 s44, s44, 6144
    s_add_u32 s33, s35, s44
    s_mul_i32 s42, s32, 6144
    s_add_u32 s42, s42, 24576
    v_exp_f32 v89, v89
    s_add_u32 s42, s42, s33
    v_exp_f32 v91, v91
    s_cmp_ge_u32 s37, 6
    s_cselect_b32 s14, 0, s42
    v_cvt_pk_bf16_f32 v40, v88, v89
    s_add_u32 s24, s67, 256
    v_cvt_pk_bf16_f32 v41, v90, v91
    s_add_u32 s25, s33, 256
    s_add_u32 s23, s38, 4096
    s_mov_b32 s27, 0x249
    s_mov_b32 s30, 0
    s_waitcnt vmcnt(6) lgkmcnt(0)
    v_mfma_f32_16x16x32_bf16 v[88:91], a[212:215], a[192:195], 0
    s_barrier
    ds_read_b64_tr_b16 a[212:213], v2 offset:0
    ds_read_b64_tr_b16 a[214:215], v2 offset:6144
    v_mfma_f32_16x16x32_bf16 v[88:91], a[216:219], a[196:199], v[88:91]
    ds_read_b64_tr_b16 a[216:217], v3 offset:0
    ds_read_b64_tr_b16 a[218:219], v3 offset:6144
    s_add_u32 m0, s22, 12288
    s_nop 0
    buffer_load_dwordx4 v6, s[4:7], s20 offen lds
    s_add_u32 s20, s20, 128
    v_mfma_f32_16x16x32_bf16 v[88:91], a[220:223], a[200:203], v[88:91]
    s_add_u32 m0, s22, 13312
    s_nop 0
    buffer_load_dwordx4 v6, s[4:7], s20 offen lds
    s_add_u32 s20, s20, 128
    ds_read_b64_tr_b16 a[220:221], v4 offset:0
    v_mfma_f32_16x16x32_bf16 v[88:91], a[224:227], a[204:207], v[88:91]
    ds_read_b64_tr_b16 a[222:223], v4 offset:6144
    s_add_u32 m0, s22, 14336
    s_nop 0
    buffer_load_dwordx4 v6, s[4:7], s20 offen lds
    v_mfma_f32_16x16x32_bf16 v[44:47], a[252:255], v[38:41], v[44:47]
    ds_read_b64_tr_b16 a[224:225], v5 offset:0
    v_cvt_pk_bf16_f32 v24, v60, v61
    v_mfma_f32_16x16x32_bf16 v[88:91], a[228:231], a[208:211], v[88:91]
    s_add_u32 s20, s20, 12032
    ds_read_b64_tr_b16 a[226:227], v5 offset:6144
    v_mfma_f32_16x16x32_bf16 v[88:91], a[232:235], v[92:95], v[88:91]
    s_waitcnt lgkmcnt(4)
    v_mfma_f32_16x16x32_bf16 v[112:115], a[212:215], v[14:17], 0
    v_fma_f32 v80, v80, s28, v12
    v_mfma_f32_16x16x32_bf16 v[116:119], a[216:219], v[14:17], 0
    v_fma_f32 v85, v85, s28, v13
    s_nop 2
    v_fma_f32 v89, v89, s28, v13
    v_mfma_f32_16x16x32_bf16 v[164:167], a[216:219], v[20:23], 0
    v_mfma_f32_16x16x32_bf16 v[160:163], a[212:215], v[20:23], 0
    v_mfma_f32_16x16x32_bf16 v[208:211], a[212:215], v[26:29], 0
    ds_read_b64_tr_b16 a[234:235], v3 offset:7168
    v_mfma_f32_16x16x32_bf16 v[212:215], a[216:219], v[26:29], 0
    ds_read_b64_tr_b16 a[230:231], v2 offset:7168
    v_fma_f32 v57, v57, s28, v9
    v_mfma_f32_16x16x32_bf16 a[4:7], a[216:219], v[32:35], 0
    v_fma_f32 v65, v65, s28, v10
    v_fma_f32 v67, v67, s28, v10
    v_mfma_f32_16x16x32_bf16 a[0:3], a[212:215], v[32:35], 0
    ds_read_b64_tr_b16 a[232:233], v3 offset:1024
    v_fma_f32 v59, v59, s28, v9
    v_mfma_f32_16x16x32_bf16 a[48:51], a[212:215], v[38:41], 0
    ds_read_b64_tr_b16 a[228:229], v2 offset:1024
    v_fma_f32 v58, v58, s28, v9
    v_mfma_f32_16x16x32_bf16 a[52:55], a[216:219], v[38:41], 0
    s_waitcnt lgkmcnt(4)
    v_exp_f32 v85, v85
    v_mfma_f32_16x16x32_bf16 a[56:59], a[220:223], v[38:41], 0
    v_fma_f32 v69, v69, s28, v11
    v_fma_f32 v74, v74, s28, v11
    v_mfma_f32_16x16x32_bf16 a[60:63], a[224:227], v[38:41], 0
    ds_read_b64_tr_b16 a[214:215], v4 offset:7168
    v_fma_f32 v73, v73, s28, v11
    v_mfma_f32_16x16x32_bf16 a[12:15], a[224:227], v[32:35], 0
    ds_read_b64_tr_b16 a[212:213], v4 offset:1024
    v_mfma_f32_16x16x32_bf16 a[8:11], a[220:223], v[32:35], 0
    ds_read_b64_tr_b16 a[216:217], v5 offset:1024
    v_fma_f32 v66, v66, s28, v10
    v_mfma_f32_16x16x32_bf16 v[216:219], a[220:223], v[26:29], 0
    v_fma_f32 v79, v79, s28, v12
    v_mfma_f32_16x16x32_bf16 v[220:223], a[224:227], v[26:29], 0
    v_fma_f32 v64, v64, s28, v10
    v_fma_f32 v83, v83, s28, v12
    v_mfma_f32_16x16x32_bf16 v[172:175], a[224:227], v[20:23], 0
    v_fma_f32 v81, v81, s28, v12
    v_fma_f32 v88, v88, s28, v13
    v_mfma_f32_16x16x32_bf16 v[168:171], a[220:223], v[20:23], 0
    v_fma_f32 v91, v91, s28, v13
    v_fma_f32 v84, v84, s28, v13
    v_mfma_f32_16x16x32_bf16 v[120:123], a[220:223], v[14:17], 0
    v_fma_f32 v87, v87, s28, v13
    v_mfma_f32_16x16x32_bf16 v[124:127], a[224:227], v[14:17], 0
    s_waitcnt lgkmcnt(3)
    ds_read_b64_tr_b16 a[218:219], v5 offset:7168
    v_mfma_f32_16x16x32_bf16 v[128:131], a[228:231], v[14:17], 0
    v_exp_f32 v69, v69
    v_mfma_f32_16x16x32_bf16 v[132:135], a[232:235], v[14:17], 0
    ds_read_b64_tr_b16 a[224:225], v3 offset:2048
    v_mfma_f32_16x16x32_bf16 v[180:183], a[232:235], v[20:23], 0
    ds_read_b64_tr_b16 a[226:227], v3 offset:8192
    v_fma_f32 v76, v76, s28, v12
    v_mfma_f32_16x16x32_bf16 v[176:179], a[228:231], v[20:23], 0
    ds_read_b64_tr_b16 a[222:223], v2 offset:8192
    v_fma_f32 v70, v70, s28, v11
    v_mfma_f32_16x16x32_bf16 v[224:227], a[228:231], v[26:29], 0
    v_exp_f32 v57, v57
    v_mfma_f32_16x16x32_bf16 v[228:231], a[232:235], v[26:29], 0
    v_exp_f32 v70, v70
    v_mfma_f32_16x16x32_bf16 a[20:23], a[232:235], v[32:35], 0
    ds_read_b64_tr_b16 a[220:221], v2 offset:2048
    v_fma_f32 v77, v77, s28, v12
    v_mfma_f32_16x16x32_bf16 a[16:19], a[228:231], v[32:35], 0
    v_exp_f32 v84, v84
    v_mfma_f32_16x16x32_bf16 a[64:67], a[228:231], v[38:41], 0
    v_exp_f32 v87, v87
    v_mfma_f32_16x16x32_bf16 a[68:71], a[232:235], v[38:41], 0
    s_waitcnt lgkmcnt(4)
    v_fma_f32 v82, v82, s28, v12
    v_fma_f32 v56, v56, s28, v9
    v_mfma_f32_16x16x32_bf16 a[72:75], a[212:215], v[38:41], 0
    ds_read_b64_tr_b16 a[228:229], v4 offset:2048
    v_fma_f32 v75, v75, s28, v11
    v_mfma_f32_16x16x32_bf16 a[76:79], a[216:219], v[38:41], 0
    ds_read_b64_tr_b16 a[234:235], v5 offset:8192
    v_mfma_f32_16x16x32_bf16 a[28:31], a[216:219], v[32:35], 0
    v_fma_f32 v71, v71, s28, v11
    v_mfma_f32_16x16x32_bf16 a[24:27], a[212:215], v[32:35], 0
    ds_read_b64_tr_b16 a[232:233], v5 offset:2048
    v_fma_f32 v68, v68, s28, v11
    v_mfma_f32_16x16x32_bf16 v[232:235], a[212:215], v[26:29], 0
    v_fma_f32 v86, v86, s28, v13
    s_add_u32 s39, s39, 12288
    v_mfma_f32_16x16x32_bf16 v[236:239], a[216:219], v[26:29], 0
    ds_read_b64_tr_b16 a[230:231], v4 offset:8192
    v_fma_f32 v90, v90, s28, v13
    v_mfma_f32_16x16x32_bf16 v[188:191], a[216:219], v[20:23], 0
    v_exp_f32 v89, v89
    v_mfma_f32_16x16x32_bf16 v[184:187], a[212:215], v[20:23], 0
    v_add_u32 v103, 4096, v103
    v_mfma_f32_16x16x32_bf16 v[136:139], a[212:215], v[14:17], 0
    v_exp_f32 v81, v81
    v_mfma_f32_16x16x32_bf16 v[140:143], a[216:219], v[14:17], 0
    s_waitcnt lgkmcnt(4)
    v_exp_f32 v59, v59
    v_mfma_f32_16x16x32_bf16 v[144:147], a[220:223], v[14:17], 0
    v_exp_f32 v91, v91
    v_mfma_f32_16x16x32_bf16 v[148:151], a[224:227], v[14:17], 0
    v_exp_f32 v68, v68
    v_mfma_f32_16x16x32_bf16 v[196:199], a[224:227], v[20:23], 0
    v_exp_f32 v77, v77
    v_mfma_f32_16x16x32_bf16 v[192:195], a[220:223], v[20:23], 0
    v_exp_f32 v71, v71
    v_mfma_f32_16x16x32_bf16 v[240:243], a[220:223], v[26:29], 0
    v_exp_f32 v79, v79
    v_mfma_f32_16x16x32_bf16 v[244:247], a[224:227], v[26:29], 0
    v_exp_f32 v58, v58
    v_mfma_f32_16x16x32_bf16 a[36:39], a[224:227], v[32:35], 0
    v_exp_f32 v64, v64
    v_mfma_f32_16x16x32_bf16 a[32:35], a[220:223], v[32:35], 0
    v_mfma_f32_16x16x32_bf16 a[80:83], a[220:223], v[38:41], 0
    s_waitcnt vmcnt(3) lgkmcnt(0)
    v_exp_f32 v76, v76
    v_mfma_f32_16x16x32_bf16 a[84:87], a[224:227], v[38:41], 0
    s_barrier
    ds_read_b128 a[212:215], v0 offset:0
    v_mfma_f32_16x16x32_bf16 a[88:91], a[228:231], v[38:41], 0
    ds_read_b128 a[216:219], v1 offset:0
    v_cvt_pk_bf16_f32 v30, v68, v69
    v_mfma_f32_16x16x32_bf16 a[92:95], a[232:235], v[38:41], 0
    s_add_u32 m0, s22, 24576
    ds_read_b128 a[220:223], v0 offset:1024
    v_fma_f32 v78, v78, s28, v12
    v_mfma_f32_16x16x32_bf16 a[44:47], a[232:235], v[32:35], 0
    v_fma_f32 v72, v72, s28, v11
    v_mfma_f32_16x16x32_bf16 a[40:43], a[228:231], v[32:35], 0
    buffer_load_dwordx4 v6, s[8:11], s21 offen lds
    v_mfma_f32_16x16x32_bf16 v[248:251], a[228:231], v[26:29], 0
    v_exp_f32 v86, v86
    v_mfma_f32_16x16x32_bf16 v[252:255], a[232:235], v[26:29], 0
    s_add_u32 s21, s21, 128
    s_add_u32 m0, s22, 25600
    v_mfma_f32_16x16x32_bf16 v[204:207], a[232:235], v[20:23], 0
    buffer_load_dwordx4 v6, s[8:11], s21 offen lds
    v_mfma_f32_16x16x32_bf16 v[200:203], a[228:231], v[20:23], 0
    s_add_u32 s21, s21, 128
    v_exp_f32 v78, v78
    v_mfma_f32_16x16x32_bf16 v[152:155], a[228:231], v[14:17], 0
    v_cvt_pk_bf16_f32 v36, v76, v77
    v_mfma_f32_16x16x32_bf16 v[156:159], a[232:235], v[14:17], 0
    s_waitcnt lgkmcnt(2)
    v_cvt_pk_bf16_f32 v31, v70, v71
    v_cvt_pk_bf16_f32 v37, v78, v79
    v_mfma_f32_16x16x32_bf16 v[52:55], a[212:215], a[96:99], 0
    s_waitcnt lgkmcnt(1)
    ds_read_b128 a[224:227], v1 offset:1024
    v_cvt_pk_bf16_f32 v42, v84, v85
    v_mfma_f32_16x16x32_bf16 v[52:55], a[216:219], a[100:103], v[52:55]
    s_add_u32 m0, s22, 26624
    ds_read_b128 a[228:231], v0 offset:2048
    s_waitcnt lgkmcnt(2)
    v_mfma_f32_16x16x32_bf16 v[52:55], a[220:223], a[104:107], v[52:55]
    buffer_load_dwordx4 v6, s[8:11], s21 offen lds
    v_mfma_f32_16x16x32_bf16 v[60:63], a[220:223], a[128:131], 0
    v_exp_f32 v56, v56
    v_mfma_f32_16x16x32_bf16 v[60:63], a[216:219], a[124:127], v[60:63]
    v_exp_f32 v66, v66
    v_mfma_f32_16x16x32_bf16 v[60:63], a[212:215], a[120:123], v[60:63]
    v_exp_f32 v80, v80
    v_mfma_f32_16x16x32_bf16 v[68:71], a[212:215], a[144:147], 0
    ds_read_b128 a[232:235], v1 offset:2048
    v_mfma_f32_16x16x32_bf16 v[68:71], a[216:219], a[148:151], v[68:71]
    v_mfma_f32_16x16x32_bf16 v[68:71], a[220:223], a[152:155], v[68:71]
    v_exp_f32 v88, v88
    v_mfma_f32_16x16x32_bf16 v[76:79], a[220:223], a[176:179], 0
    v_cvt_pk_bf16_f32 v43, v86, v87
    v_cvt_pk_bf16_f32 v40, v88, v89
    v_mfma_f32_16x16x32_bf16 v[76:79], a[216:219], a[172:175], v[76:79]
    v_exp_f32 v90, v90
    v_mfma_f32_16x16x32_bf16 v[76:79], a[212:215], a[168:171], v[76:79]
    v_exp_f32 v65, v65
    v_mfma_f32_16x16x32_bf16 v[84:87], a[212:215], a[192:195], 0
    v_exp_f32 v75, v75
    v_mfma_f32_16x16x32_bf16 v[84:87], a[216:219], a[196:199], v[84:87]
    v_exp_f32 v73, v73
    v_mfma_f32_16x16x32_bf16 v[84:87], a[220:223], a[200:203], v[84:87]
    s_waitcnt lgkmcnt(1)
    v_cvt_pk_bf16_f32 v16, v56, v57
    s_add_u32 s21, s21, 12032
    v_mfma_f32_16x16x32_bf16 v[84:87], a[224:227], a[204:207], v[84:87]
    v_exp_f32 v74, v74
    v_mfma_f32_16x16x32_bf16 v[84:87], a[228:231], a[208:211], v[84:87]
    s_waitcnt lgkmcnt(0)
    v_exp_f32 v67, v67
    v_mfma_f32_16x16x32_bf16 v[84:87], a[232:235], v[92:95], v[84:87]
    s_add_u32 m0, s38, 0
    ds_read_b128 a[220:223], v0 offset:7168
    v_mfma_f32_16x16x32_bf16 v[76:79], a[232:235], a[188:191], v[76:79]
    ds_read_b128 a[212:215], v0 offset:6144
    v_mfma_f32_16x16x32_bf16 v[76:79], a[228:231], a[184:187], v[76:79]
    buffer_load_dwordx4 v6, s[12:15], s33 offen nt lds
    v_mfma_f32_16x16x32_bf16 v[76:79], a[224:227], a[180:183], v[76:79]
    v_exp_f32 v72, v72
    v_mfma_f32_16x16x32_bf16 v[68:71], a[224:227], a[156:159], v[68:71]
    v_cvt_pk_bf16_f32 v34, v80, v81
    v_mfma_f32_16x16x32_bf16 v[68:71], a[228:231], a[160:163], v[68:71]
    v_cvt_pk_bf16_f32 v29, v74, v75
    v_cvt_pk_bf16_f32 v28, v72, v73
    v_mfma_f32_16x16x32_bf16 v[68:71], a[232:235], a[164:167], v[68:71]
    v_cvt_pk_bf16_f32 v23, v66, v67
    v_cvt_pk_bf16_f32 v22, v64, v65
    v_mfma_f32_16x16x32_bf16 v[60:63], a[232:235], a[140:143], v[60:63]
    ds_read_b128 a[216:219], v1 offset:6144
    v_mfma_f32_16x16x32_bf16 v[60:63], a[228:231], a[136:139], v[60:63]
    v_cvt_pk_bf16_f32 v17, v58, v59
    v_mfma_f32_16x16x32_bf16 v[60:63], a[224:227], a[132:135], v[60:63]
    v_cvt_pk_bf16_f32 v41, v90, v91
    v_mfma_f32_16x16x32_bf16 v[48:51], a[236:239], v[16:19], v[44:47]
    s_add_u32 m0, s38, 1024
    v_exp_f32 v83, v83
    v_mfma_f32_16x16x32_bf16 v[52:55], a[224:227], a[108:111], v[52:55]
    v_mfma_f32_16x16x32_bf16 v[48:51], a[240:243], v[22:25], v[48:51]
    buffer_load_dwordx4 v7, s[12:15], s33 offen nt lds
    v_mfma_f32_16x16x32_bf16 v[52:55], a[228:231], a[112:115], v[52:55]
    v_exp_f32 v82, v82
    v_mfma_f32_16x16x32_bf16 v[48:51], a[244:247], v[28:31], v[48:51]
    ds_read_b128 a[224:227], v1 offset:7168
    v_cvt_pk_bf16_f32 v35, v82, v83
    v_mfma_f32_16x16x32_bf16 v[52:55], a[232:235], a[116:119], v[52:55]
    ds_read_b128 a[232:235], v1 offset:8192
    v_mfma_f32_16x16x32_bf16 v[48:51], a[248:251], v[34:37], v[48:51]
    s_add_u32 s59, s33, 128
    s_add_u32 m0, s38, 2048
    ds_read_b128 a[228:231], v0 offset:8192
    v_mfma_f32_16x16x32_bf16 v[48:51], a[252:255], v[40:43], v[48:51]
    s_waitcnt lgkmcnt(3)
    v_mfma_f32_16x16x32_bf16 v[56:59], a[212:215], a[96:99], 0
    buffer_load_dwordx4 v6, s[12:15], s59 offen nt lds
    v_mfma_f32_16x16x32_bf16 v[56:59], a[216:219], a[100:103], v[56:59]
    v_mfma_f32_16x16x32_bf16 v[56:59], a[220:223], a[104:107], v[56:59]
    v_mfma_f32_16x16x32_bf16 v[64:67], a[220:223], a[128:131], 0
    s_nop 1
    v_cmp_lt_f32 vcc, s29, v48
    v_mfma_f32_16x16x32_bf16 v[64:67], a[216:219], a[124:127], v[64:67]
    s_add_u32 m0, s38, 3072
    v_mfma_f32_16x16x32_bf16 v[64:67], a[212:215], a[120:123], v[64:67]
    buffer_load_dwordx4 v7, s[12:15], s59 offen nt lds
    v_mfma_f32_16x16x32_bf16 v[72:75], a[212:215], a[144:147], 0
    s_cbranch_vccnz L_rs_start5b
L_ret_start5b:
    v_fma_f32 v60, v60, s28, v10
    v_mfma_f32_16x16x32_bf16 v[72:75], a[216:219], a[148:151], v[72:75]
    v_fma_f32 v61, v61, s28, v10
    v_fma_f32 v63, v63, s28, v10
    v_mfma_f32_16x16x32_bf16 v[72:75], a[220:223], a[152:155], v[72:75]
    s_waitcnt vmcnt(13) lgkmcnt(0)
    v_exp_f32 v63, v63
    v_mfma_f32_16x16x32_bf16 v[80:83], a[220:223], a[176:179], 0
    s_barrier
    v_mfma_f32_16x16x32_bf16 v[80:83], a[216:219], a[172:175], v[80:83]
    v_fma_f32 v54, v54, s28, v9
    v_mfma_f32_16x16x32_bf16 v[80:83], a[212:215], a[168:171], v[80:83]
    s_add_u32 m0, s22, 0
    v_exp_f32 v60, v60
    v_mfma_f32_16x16x32_bf16 v[88:91], a[212:215], a[192:195], 0
    buffer_load_dwordx4 v6, s[4:7], s20 offen lds
    v_mfma_f32_16x16x32_bf16 v[88:91], a[216:219], a[196:199], v[88:91]
    v_exp_f32 v61, v61
    v_mfma_f32_16x16x32_bf16 v[88:91], a[220:223], a[200:203], v[88:91]
    ds_read_b64_tr_b16 a[212:213], v2 offset:18432
    v_fma_f32 v53, v53, s28, v9
    v_mfma_f32_16x16x32_bf16 v[88:91], a[224:227], a[204:207], v[88:91]
    v_exp_f32 v53, v53
    v_mfma_f32_16x16x32_bf16 v[88:91], a[228:231], a[208:211], v[88:91]
    s_add_u32 s20, s20, 128
    ds_read_b64_tr_b16 a[214:215], v2 offset:12288
    s_add_u32 m0, s22, 1024
    v_mfma_f32_16x16x32_bf16 v[88:91], a[232:235], v[92:95], v[88:91]
    buffer_load_dwordx4 v6, s[4:7], s20 offen lds
    v_mfma_f32_16x16x32_bf16 v[80:83], a[232:235], a[188:191], v[80:83]
    s_add_u32 s20, s20, 128
    ds_read_b64_tr_b16 a[216:217], v3 offset:18432
    s_add_u32 m0, s22, 2048
    v_mfma_f32_16x16x32_bf16 v[80:83], a[228:231], a[184:187], v[80:83]
    ds_read_b64_tr_b16 a[218:219], v3 offset:12288
    v_fma_f32 v55, v55, s28, v9
    v_mfma_f32_16x16x32_bf16 v[80:83], a[224:227], a[180:183], v[80:83]
    buffer_load_dwordx4 v6, s[4:7], s20 offen lds
    v_mfma_f32_16x16x32_bf16 v[72:75], a[224:227], a[156:159], v[72:75]
    v_exp_f32 v55, v55
    v_mfma_f32_16x16x32_bf16 v[72:75], a[228:231], a[160:163], v[72:75]
    v_exp_f32 v54, v54
    v_mfma_f32_16x16x32_bf16 v[72:75], a[232:235], a[164:167], v[72:75]
    ds_read_b64_tr_b16 a[220:221], v4 offset:18432
    v_fma_f32 v52, v52, s28, v9
    v_mfma_f32_16x16x32_bf16 v[64:67], a[232:235], a[140:143], v[64:67]
    s_add_u32 s20, s20, 12032
    v_exp_f32 v52, v52
    v_mfma_f32_16x16x32_bf16 v[64:67], a[228:231], a[136:139], v[64:67]
    ds_read_b64_tr_b16 a[222:223], v4 offset:12288
    v_fma_f32 v62, v62, s28, v10
    v_mfma_f32_16x16x32_bf16 v[64:67], a[224:227], a[132:135], v[64:67]
    v_exp_f32 v62, v62
    v_mfma_f32_16x16x32_bf16 v[56:59], a[224:227], a[108:111], v[56:59]
    ds_read_b64_tr_b16 a[224:225], v5 offset:18432
    v_cvt_pk_bf16_f32 v20, v60, v61
    v_mfma_f32_16x16x32_bf16 v[56:59], a[228:231], a[112:115], v[56:59]
    ds_read_b64_tr_b16 a[226:227], v5 offset:12288
    v_cvt_pk_bf16_f32 v21, v62, v63
    v_mfma_f32_16x16x32_bf16 v[56:59], a[232:235], a[116:119], v[56:59]
    s_waitcnt lgkmcnt(4)
    v_cvt_pk_bf16_f32 v14, v52, v53
    v_cvt_pk_bf16_f32 v15, v54, v55
    s_branch L_loop5
L_start4:
    s_add_u32 m0, s22, 0
    s_nop 0
    buffer_load_dwordx4 v6, s[4:7], s20 offen lds
    s_add_u32 s20, s20, 128
    s_add_u32 m0, s22, 1024
    s_nop 0
    buffer_load_dwordx4 v6, s[4:7], s20 offen lds
    s_add_u32 s20, s20, 128
    s_add_u32 m0, s22, 2048
    s_nop 0
    buffer_load_dwordx4 v6, s[4:7], s20 offen lds
    s_add_u32 s20, s20, 12032
    s_add_u32 m0, s22, 12288
    s_nop 0
    buffer_load_dwordx4 v6, s[4:7], s20 offen lds
    s_add_u32 s20, s20, 128
    s_add_u32 m0, s22, 13312
    s_nop 0
    buffer_load_dwordx4 v6, s[4:7], s20 offen lds
    s_add_u32 s20, s20, 128
    s_add_u32 m0, s22, 14336
    s_nop 0
    buffer_load_dwordx4 v6, s[4:7], s20 offen lds
    s_add_u32 s20, s20, 12032
    s_add_u32 s48, s34, 0
    s_add_u32 m0, s38, 0
    s_nop 0
    buffer_load_dwordx4 v6, s[12:15], s48 offen nt lds
    s_add_u32 m0, s38, 1024
    s_nop 0
    buffer_load_dwordx4 v7, s[12:15], s48 offen nt lds
    s_add_u32 s48, s34, 128
    s_add_u32 m0, s38, 2048
    s_nop 0
    buffer_load_dwordx4 v6, s[12:15], s48 offen nt lds
    s_add_u32 m0, s38, 3072
    s_nop 0
    buffer_load_dwordx4 v7, s[12:15], s48 offen nt lds
    s_add_u32 s48, s34, 256
    s_add_u32 m0, s38, 4096
    s_nop 0
    buffer_load_dwordx4 v6, s[12:15], s48 offen nt lds
    s_add_u32 m0, s38, 5120
    s_nop 0
    buffer_load_dwordx4 v7, s[12:15], s48 offen nt lds
    s_add_u32 s48, s34, 6144
    s_add_u32 m0, s38, 6144
    s_nop 0
    buffer_load_dwordx4 v6, s[12:15], s48 offen nt lds
    s_add_u32 m0, s38, 7168
    s_nop 0
    buffer_load_dwordx4 v7, s[12:15], s48 offen nt lds
    s_add_u32 s48, s34, 6272
    s_add_u32 m0, s38, 8192
    s_nop 0
    buffer_load_dwordx4 v6, s[12:15], s48 offen nt lds
    s_add_u32 m0, s38, 9216
    s_nop 0
    buffer_load_dwordx4 v7, s[12:15], s48 offen nt lds
    s_add_u32 s48, s34, 6400
    s_add_u32 m0, s38, 10240
    s_nop 0
    buffer_load_dwordx4 v6, s[12:15], s48 offen nt lds
    s_add_u32 m0, s38, 11264
    s_nop 0
    buffer_load_dwordx4 v7, s[12:15], s48 offen nt lds
    s_add_u32 s48, s34, 12288
    s_add_u32 m0, s38, 12288
    s_nop 0
    buffer_load_dwordx4 v6, s[12:15], s48 offen nt lds
    s_add_u32 m0, s38, 13312
    s_nop 0
    buffer_load_dwordx4 v7, s[12:15], s48 offen nt lds
    s_add_u32 s48, s34, 12416
    s_add_u32 m0, s38, 14336
    s_nop 0
    buffer_load_dwordx4 v6, s[12:15], s48 offen nt lds
    s_add_u32 m0, s38, 15360
    s_nop 0
    buffer_load_dwordx4 v7, s[12:15], s48 offen nt lds
    s_add_u32 s48, s34, 12544
    s_add_u32 m0, s38, 16384
    s_nop 0
    buffer_load_dwordx4 v6, s[12:15], s48 offen nt lds
    s_add_u32 m0, s38, 17408
    s_nop 0
    buffer_load_dwordx4 v7, s[12:15], s48 offen nt lds
    v_and_b32 v96, 15, v111
    v_lshrrev_b32 v97, 4, v111
    v_lshrrev_b32 v98, 3, v96
    v_and_b32 v99, 7, v96
    v_lshlrev_b32 v0, 7, v99
    v_bfe_u32 v99, v96, 1, 2
    v_lshlrev_b32 v99, 1, v99
    v_mul_u32_u24 v100, 5, v98
    v_xor_b32 v99, v99, v100
    v_xor_b32 v99, v99, v97
    v_lshl_add_u32 v0, v99, 4, v0
    v_mul_u32_u24 v100, 3072, v98
    v_add_u32 v0, v100, v0
    v_xor_b32 v1, 64, v0
    v_lshrrev_b32 v98, 1, v97
    v_mul_u32_u24 v2, 3072, v98
    v_and_b32 v99, 1, v97
    v_bfe_u32 v100, v111, 2, 2
    v_lshl_add_u32 v96, v99, 2, v100
    v_lshl_add_u32 v2, v96, 7, v2
    v_lshrrev_b32 v96, 1, v96
    v_lshlrev_b32 v96, 1, v96
    v_mul_u32_u24 v98, 5, v98
    v_xor_b32 v96, v96, v98
    v_bfe_u32 v99, v111, 1, 1
    v_xor_b32 v96, v96, v99
    v_lshl_add_u32 v2, v96, 4, v2
    v_and_b32 v99, 1, v111
    v_lshl_add_u32 v2, v99, 3, v2
    v_add_u32 v2, 24576, v2
    v_xor_b32 v3, 32, v2
    v_xor_b32 v4, 64, v2
    v_xor_b32 v5, 96, v2
    v_lshl_add_u32 v103, v111, 4, s38
    v_and_b32 v96, 15, v111
    s_mov_b32 s42, 0x1011
    v_bfe_i32 v97, s42, v96, 1
    v_and_b32 v97, 0x3f803f80, v97
    v_accvgpr_write_b32 a236, v97
    v_accvgpr_write_b32 a237, v97
    v_accvgpr_write_b32 a238, v97
    v_accvgpr_write_b32 a239, v97
    s_mov_b32 s42, 0x3222
    v_bfe_i32 v97, s42, v96, 1
    v_and_b32 v97, 0x3f803f80, v97
    v_accvgpr_write_b32 a240, v97
    v_accvgpr_write_b32 a241, v97
    v_accvgpr_write_b32 a242, v97
    v_accvgpr_write_b32 a243, v97
    s_mov_b32 s42, 0x5444
    v_bfe_i32 v97, s42, v96, 1
    v_and_b32 v97, 0x3f803f80, v97
    v_accvgpr_write_b32 a244, v97
    v_accvgpr_write_b32 a245, v97
    v_accvgpr_write_b32 a246, v97
    v_accvgpr_write_b32 a247, v97
    s_mov_b32 s42, 0x9888
    v_bfe_i32 v97, s42, v96, 1
    v_and_b32 v97, 0x3f803f80, v97
    v_accvgpr_write_b32 a248, v97
    v_accvgpr_write_b32 a249, v97
    v_accvgpr_write_b32 a250, v97
    v_accvgpr_write_b32 a251, v97
    s_mov_b32 s42, 0x1100
    v_bfe_i32 v97, s42, v96, 1
    v_and_b32 v97, 0x3f803f80, v97
    v_accvgpr_write_b32 a252, v97
    v_accvgpr_write_b32 a253, v97
    v_accvgpr_write_b32 a254, v97
    v_accvgpr_write_b32 a255, v97
    s_waitcnt vmcnt(18)
    s_barrier
    s_waitcnt vmcnt(12)
    s_add_u32 s48, s34, 18432
    s_add_u32 m0, s38, 18432
    s_nop 0
    buffer_load_dwordx4 v6, s[12:15], s48 offen nt lds
    s_add_u32 m0, s38, 19456
    s_nop 0
    buffer_load_dwordx4 v7, s[12:15], s48 offen nt lds
    s_add_u32 s48, s34, 18560
    ds_read_b128 a[212:215], v0 offset:0
    s_add_u32 m0, s38, 20480
    s_nop 0
    buffer_load_dwordx4 v6, s[12:15], s48 offen nt lds
    v_lshrrev_b32 v105, 11, v0
    s_add_u32 m0, s38, 21504
    v_xor_b32 v105, s65, v105
    v_and_b32 v104, 0x3ff, v0
    v_lshl_add_u32 v104, v105, 10, v104
    v_add_u32 v104, s38, v104
    buffer_load_dwordx4 v7, s[12:15], s48 offen nt lds
    s_add_u32 s48, s34, 18688
    ds_read_b128 a[220:223], v0 offset:1024
    s_add_u32 m0, s38, 22528
    s_nop 0
    buffer_load_dwordx4 v6, s[12:15], s48 offen nt lds
    ds_read_b128 a[96:99], v104 offset:0
    s_add_u32 m0, s38, 23552
    s_nop 0
    buffer_load_dwordx4 v7, s[12:15], s48 offen nt lds
    ds_read_b128 a[228:231], v0 offset:2048
    s_waitcnt lgkmcnt(1)
    v_mfma_f32_16x16x32_bf16 v[52:55], a[212:215], a[96:99], 0
    v_xor_b32 v105, 64, v104
    ds_read_b128 a[104:107], v104 offset:2048
    ds_read_b128 a[216:219], v1 offset:0
    ds_read_b128 a[100:103], v105 offset:0
    ds_read_b128 a[224:227], v1 offset:1024
    s_waitcnt lgkmcnt(1)
    v_mfma_f32_16x16x32_bf16 v[52:55], a[216:219], a[100:103], v[52:55]
    ds_read_b128 a[108:111], v105 offset:2048
    ds_read_b128 a[232:235], v1 offset:2048
    ds_read_b128 a[112:115], v104 offset:4096
    v_mfma_f32_16x16x32_bf16 v[52:55], a[220:223], a[104:107], v[52:55]
    ds_read_b128 a[212:215], v0 offset:6144
    s_waitcnt lgkmcnt(3)
    v_mfma_f32_16x16x32_bf16 v[52:55], a[224:227], a[108:111], v[52:55]
    s_waitcnt lgkmcnt(1)
    ds_read_b128 a[216:219], v1 offset:6144
    v_mfma_f32_16x16x32_bf16 v[52:55], a[228:231], a[112:115], v[52:55]
    ds_read_b128 a[116:119], v105 offset:4096
    s_waitcnt lgkmcnt(0)
    v_mfma_f32_16x16x32_bf16 v[52:55], a[232:235], a[116:119], v[52:55]
    ds_read_b128 a[220:223], v0 offset:7168
    v_mfma_f32_16x16x32_bf16 v[56:59], a[212:215], a[96:99], 0
    ds_read_b128 a[224:227], v1 offset:7168
    v_mfma_f32_16x16x32_bf16 v[56:59], a[216:219], a[100:103], v[56:59]
    ds_read_b128 a[212:215], v0 offset:12288
    s_waitcnt lgkmcnt(2)
    v_mfma_f32_16x16x32_bf16 v[56:59], a[220:223], a[104:107], v[56:59]
    ds_read_b128 a[216:219], v1 offset:12288
    ds_read_b128 a[228:231], v0 offset:8192
    s_waitcnt lgkmcnt(3)
    v_mfma_f32_16x16x32_bf16 v[56:59], a[224:227], a[108:111], v[56:59]
    ds_read_b128 a[232:235], v1 offset:8192
    s_waitcnt lgkmcnt(1)
    v_mfma_f32_16x16x32_bf16 v[56:59], a[228:231], a[112:115], v[56:59]
    ds_read_b128 a[228:231], v0 offset:14336
    v_max3_f32 v96, v52, v53, v54
    s_waitcnt lgkmcnt(1)
    v_mfma_f32_16x16x32_bf16 v[56:59], a[232:235], a[116:119], v[56:59]
    s_nop 7
    v_max3_f32 v96, v96, v55, v56
    v_max3_f32 v96, v96, v57, v58
    ds_read_b128 a[220:223], v0 offset:13312
    ds_read_b128 a[224:227], v1 offset:13312
    v_max_f32 v96, v96, v59
    v_mov_b32 v97, v96
    s_nop 1
    v_permlane32_swap_b32 v97, v96
    v_max_f32 v96, v96, v97
    v_mov_b32 v97, v96
    s_nop 1
    v_permlane16_swap_b32 v97, v96
    v_max_f32 v96, v96, v97
    v_mul_f32_e64 v9, -s28, v96
    v_fma_f32 v58, v58, s28, v9
    ds_read_b128 a[232:235], v1 offset:14336
    v_fma_f32 v52, v52, s28, v9
    v_fma_f32 v59, v59, s28, v9
    v_fma_f32 v53, v53, s28, v9
    v_fma_f32 v55, v55, s28, v9
    v_exp_f32 v52, v52
    v_exp_f32 v55, v55
    v_exp_f32 v53, v53
    v_fma_f32 v54, v54, s28, v9
    v_exp_f32 v59, v59
    v_exp_f32 v54, v54
    s_nop 0
    v_cvt_pk_bf16_f32 v15, v54, v55
    s_waitcnt vmcnt(12)
    s_add_u32 m0, s22, 24576
    ds_read_b128 a[128:131], v104 offset:8192
    buffer_load_dwordx4 v6, s[8:11], s21 offen lds
    v_cvt_pk_bf16_f32 v14, v52, v53
    s_add_u32 s21, s21, 128
    v_mfma_f32_16x16x32_bf16 v[52:55], a[212:215], a[96:99], 0
    s_add_u32 m0, s22, 25600
    s_nop 0
    buffer_load_dwordx4 v6, s[8:11], s21 offen lds
    s_add_u32 s21, s21, 128
    ds_read_b128 a[140:143], v105 offset:10240
    v_mfma_f32_16x16x32_bf16 v[52:55], a[216:219], a[100:103], v[52:55]
    s_add_u32 m0, s22, 26624
    v_fma_f32 v56, v56, s28, v9
    buffer_load_dwordx4 v6, s[8:11], s21 offen lds
    v_exp_f32 v58, v58
    ds_read_b128 a[212:215], v0 offset:18432
    s_waitcnt lgkmcnt(3)
    v_mfma_f32_16x16x32_bf16 v[52:55], a[220:223], a[104:107], v[52:55]
    v_fma_f32 v57, v57, s28, v9
    ds_read_b128 a[220:223], v0 offset:19456
    v_mfma_f32_16x16x32_bf16 v[52:55], a[224:227], a[108:111], v[52:55]
    ds_read_b128 a[224:227], v1 offset:19456
    ds_read_b128 a[216:219], v1 offset:18432
    v_exp_f32 v56, v56
    v_mfma_f32_16x16x32_bf16 v[52:55], a[228:231], a[112:115], v[52:55]
    v_exp_f32 v57, v57
    ds_read_b128 a[124:127], v105 offset:6144
    v_cvt_pk_bf16_f32 v17, v58, v59
    v_mfma_f32_16x16x32_bf16 v[52:55], a[232:235], a[116:119], v[52:55]
    v_cvt_pk_bf16_f32 v16, v56, v57
    ds_read_b128 a[120:123], v104 offset:6144
    s_waitcnt lgkmcnt(5)
    v_mfma_f32_16x16x32_bf16 v[56:59], a[212:215], a[96:99], 0
    ds_read_b128 a[212:215], v0 offset:0
    s_waitcnt lgkmcnt(3)
    v_mfma_f32_16x16x32_bf16 v[56:59], a[216:219], a[100:103], v[56:59]
    ds_read_b128 a[228:231], v0 offset:20480
    v_mfma_f32_16x16x32_bf16 v[56:59], a[220:223], a[104:107], v[56:59]
    ds_read_b128 a[216:219], v1 offset:0
    ds_read_b128 a[232:235], v1 offset:20480
    v_mfma_f32_16x16x32_bf16 v[56:59], a[224:227], a[108:111], v[56:59]
    ds_read_b128 a[220:223], v0 offset:1024
    s_waitcnt lgkmcnt(3)
    v_mfma_f32_16x16x32_bf16 v[56:59], a[228:231], a[112:115], v[56:59]
    ds_read_b128 a[224:227], v1 offset:1024
    s_waitcnt lgkmcnt(2)
    v_mfma_f32_16x16x32_bf16 v[56:59], a[232:235], a[116:119], v[56:59]
    s_add_u32 s21, s21, 12032
    v_fma_f32 v52, v52, s28, v9
    ds_read_b128 a[136:139], v104 offset:10240
    v_mfma_f32_16x16x32_bf16 v[60:63], a[212:215], a[120:123], 0
    ds_read_b128 a[228:231], v0 offset:2048
    v_mfma_f32_16x16x32_bf16 v[60:63], a[216:219], a[124:127], v[60:63]
    s_waitcnt lgkmcnt(3)
    ds_read_b128 a[132:135], v105 offset:8192
    v_mfma_f32_16x16x32_bf16 v[60:63], a[220:223], a[128:131], v[60:63]
    ds_read_b128 a[216:219], v1 offset:6144
    s_waitcnt lgkmcnt(1)
    v_mfma_f32_16x16x32_bf16 v[60:63], a[224:227], a[132:135], v[60:63]
    ds_read_b128 a[232:235], v1 offset:2048
    v_mfma_f32_16x16x32_bf16 v[60:63], a[228:231], a[136:139], v[60:63]
    ds_read_b128 a[212:215], v0 offset:6144
    s_waitcnt lgkmcnt(1)
    v_mfma_f32_16x16x32_bf16 v[60:63], a[232:235], a[140:143], v[60:63]
    ds_read_b128 a[220:223], v0 offset:7168
    s_waitcnt lgkmcnt(1)
    v_mfma_f32_16x16x32_bf16 v[64:67], a[212:215], a[120:123], 0
    ds_read_b128 a[224:227], v1 offset:7168
    v_mfma_f32_16x16x32_bf16 v[64:67], a[216:219], a[124:127], v[64:67]
    ds_read_b128 a[228:231], v0 offset:8192
    s_waitcnt lgkmcnt(2)
    v_mfma_f32_16x16x32_bf16 v[64:67], a[220:223], a[128:131], v[64:67]
    ds_read_b128 a[212:215], v0 offset:12288
    v_max3_f32 v98, v60, v61, v62
    ds_read_b128 a[232:235], v1 offset:8192
    s_waitcnt lgkmcnt(2)
    v_mfma_f32_16x16x32_bf16 v[64:67], a[224:227], a[132:135], v[64:67]
    ds_read_b128 a[220:223], v0 offset:13312
    v_fma_f32 v55, v55, s28, v9
    v_mfma_f32_16x16x32_bf16 v[64:67], a[228:231], a[136:139], v[64:67]
    ds_read_b128 a[224:227], v1 offset:13312
    s_waitcnt lgkmcnt(2)
    v_mfma_f32_16x16x32_bf16 v[64:67], a[232:235], a[140:143], v[64:67]
    s_nop 7
    v_max3_f32 v98, v98, v63, v64
    v_max3_f32 v98, v98, v65, v66
    v_max_f32 v98, v98, v67
    ds_read_b128 a[228:231], v0 offset:14336
    v_mov_b32 v99, v98
    s_nop 1
    v_permlane32_swap_b32 v99, v98
    ds_read_b128 a[216:219], v1 offset:12288
    v_max_f32 v98, v98, v99
    v_mov_b32 v99, v98
    v_mfma_f32_16x16x32_bf16 v[44:47], a[236:239], v[14:17], 0
    s_nop 0
    v_permlane16_swap_b32 v99, v98
    v_max_f32 v98, v98, v99
    v_mul_f32_e64 v10, -s28, v98
    v_fma_f32 v61, v61, s28, v10
    v_fma_f32 v62, v62, s28, v10
    v_exp_f32 v62, v62
    v_fma_f32 v54, v54, s28, v9
    v_fma_f32 v63, v63, s28, v10
    v_fma_f32 v60, v60, s28, v10
    v_exp_f32 v60, v60
    v_fma_f32 v66, v66, s28, v10
    v_fma_f32 v65, v65, s28, v10
    v_exp_f32 v61, v61
    v_exp_f32 v63, v63
    v_cvt_pk_bf16_f32 v20, v60, v61
    v_exp_f32 v65, v65
    v_fma_f32 v67, v67, s28, v10
    v_exp_f32 v67, v67
    v_exp_f32 v66, v66
    v_cvt_pk_bf16_f32 v21, v62, v63
    s_waitcnt vmcnt(9)
    s_add_u32 m0, s22, 36864
    ds_read_b128 a[232:235], v1 offset:14336
    buffer_load_dwordx4 v6, s[8:11], s21 offen lds
    ds_read_b128 a[144:147], v104 offset:12288
    v_mfma_f32_16x16x32_bf16 v[60:63], a[212:215], a[120:123], 0
    s_add_u32 s21, s21, 128
    s_add_u32 m0, s22, 37888
    s_nop 0
    buffer_load_dwordx4 v6, s[8:11], s21 offen lds
    v_fma_f32 v64, v64, s28, v10
    s_add_u32 s21, s21, 128
    ds_read_b128 a[212:215], v0 offset:18432
    s_add_u32 m0, s22, 38912
    s_waitcnt lgkmcnt(3)
    v_mfma_f32_16x16x32_bf16 v[60:63], a[216:219], a[124:127], v[60:63]
    buffer_load_dwordx4 v6, s[8:11], s21 offen lds
    ds_read_b128 a[160:163], v104 offset:16384
    v_mfma_f32_16x16x32_bf16 v[60:63], a[220:223], a[128:131], v[60:63]
    ds_read_b128 a[220:223], v0 offset:19456
    v_mfma_f32_16x16x32_bf16 v[60:63], a[224:227], a[132:135], v[60:63]
    ds_read_b128 a[152:155], v104 offset:14336
    v_mfma_f32_16x16x32_bf16 v[60:63], a[228:231], a[136:139], v[60:63]
    ds_read_b128 a[164:167], v105 offset:16384
    v_exp_f32 v64, v64
    s_waitcnt lgkmcnt(6)
    v_mfma_f32_16x16x32_bf16 v[60:63], a[232:235], a[140:143], v[60:63]
    ds_read_b128 a[232:235], v1 offset:20480
    ds_read_b128 a[216:219], v1 offset:18432
    v_cvt_pk_bf16_f32 v23, v66, v67
    ds_read_b128 a[224:227], v1 offset:19456
    v_cvt_pk_bf16_f32 v22, v64, v65
    s_waitcnt lgkmcnt(7)
    v_mfma_f32_16x16x32_bf16 v[64:67], a[212:215], a[120:123], 0
    ds_read_b128 a[228:231], v0 offset:20480
    s_waitcnt lgkmcnt(2)
    v_mfma_f32_16x16x32_bf16 v[64:67], a[216:219], a[124:127], v[64:67]
    ds_read_b128 a[212:215], v0 offset:0
    v_mfma_f32_16x16x32_bf16 v[64:67], a[220:223], a[128:131], v[64:67]
    ds_read_b128 a[148:151], v105 offset:12288
    v_mfma_f32_16x16x32_bf16 v[44:47], a[240:243], v[20:23], v[44:47]
    s_waitcnt lgkmcnt(3)
    ds_read_b128 a[216:219], v1 offset:0
    v_fma_f32 v60, v60, s28, v10
    v_mfma_f32_16x16x32_bf16 v[64:67], a[224:227], a[132:135], v[64:67]
    s_waitcnt lgkmcnt(3)
    ds_read_b128 a[156:159], v105 offset:14336
    v_mfma_f32_16x16x32_bf16 v[64:67], a[228:231], a[136:139], v[64:67]
    ds_read_b128 a[224:227], v1 offset:1024
    v_mfma_f32_16x16x32_bf16 v[64:67], a[232:235], a[140:143], v[64:67]
    ds_read_b128 a[220:223], v0 offset:1024
    s_waitcnt lgkmcnt(5)
    v_mfma_f32_16x16x32_bf16 v[68:71], a[212:215], a[144:147], 0
    ds_read_b128 a[228:231], v0 offset:2048
    s_waitcnt lgkmcnt(4)
    v_mfma_f32_16x16x32_bf16 v[68:71], a[216:219], a[148:151], v[68:71]
    ds_read_b128 a[212:215], v0 offset:6144
    s_waitcnt lgkmcnt(2)
    v_mfma_f32_16x16x32_bf16 v[68:71], a[220:223], a[152:155], v[68:71]
    ds_read_b128 a[232:235], v1 offset:2048
    v_mfma_f32_16x16x32_bf16 v[68:71], a[224:227], a[156:159], v[68:71]
    ds_read_b128 a[216:219], v1 offset:6144
    v_fma_f32 v53, v53, s28, v9
    s_waitcnt lgkmcnt(3)
    v_mfma_f32_16x16x32_bf16 v[68:71], a[228:231], a[160:163], v[68:71]
    ds_read_b128 a[228:231], v0 offset:8192
    ds_read_b128 a[220:223], v0 offset:7168
    s_waitcnt lgkmcnt(3)
    v_mfma_f32_16x16x32_bf16 v[68:71], a[232:235], a[164:167], v[68:71]
    s_add_u32 s21, s21, 12032
    ds_read_b128 a[224:227], v1 offset:7168
    v_mfma_f32_16x16x32_bf16 v[72:75], a[212:215], a[144:147], 0
    s_waitcnt lgkmcnt(3)
    ds_read_b128 a[212:215], v0 offset:12288
    v_mfma_f32_16x16x32_bf16 v[72:75], a[216:219], a[148:151], v[72:75]
    ds_read_b128 a[232:235], v1 offset:8192
    s_waitcnt lgkmcnt(3)
    v_mfma_f32_16x16x32_bf16 v[72:75], a[220:223], a[152:155], v[72:75]
    v_exp_f32 v54, v54
    ds_read_b128 a[216:219], v1 offset:12288
    v_max3_f32 v96, v68, v69, v70
    s_waitcnt lgkmcnt(3)
    v_mfma_f32_16x16x32_bf16 v[72:75], a[224:227], a[156:159], v[72:75]
    ds_read_b128 a[224:227], v1 offset:13312
    v_mfma_f32_16x16x32_bf16 v[72:75], a[228:231], a[160:163], v[72:75]
    ds_read_b128 a[220:223], v0 offset:13312
    s_waitcnt lgkmcnt(3)
    v_mfma_f32_16x16x32_bf16 v[72:75], a[232:235], a[164:167], v[72:75]
    s_nop 7
    v_max3_f32 v96, v96, v71, v72
    v_max3_f32 v96, v96, v73, v74
    v_max_f32 v96, v96, v75
    ds_read_b128 a[228:231], v0 offset:14336
    v_mov_b32 v97, v96
    s_nop 1
    v_permlane32_swap_b32 v97, v96
    v_max_f32 v96, v96, v97
    v_mov_b32 v97, v96
    s_nop 1
    v_permlane16_swap_b32 v97, v96
    v_max_f32 v96, v96, v97
    v_mul_f32_e64 v11, -s28, v96
    v_fma_f32 v72, v72, s28, v11
    v_fma_f32 v71, v71, s28, v11
    v_fma_f32 v68, v68, s28, v11
    v_fma_f32 v70, v70, s28, v11
    v_exp_f32 v53, v53
    v_exp_f32 v70, v70
    v_exp_f32 v68, v68
    v_fma_f32 v69, v69, s28, v11
    v_exp_f32 v71, v71
    v_fma_f32 v75, v75, s28, v11
    v_cvt_pk_bf16_f32 v27, v70, v71
    v_fma_f32 v74, v74, s28, v11
    v_exp_f32 v69, v69
    s_nop 0
    v_cvt_pk_bf16_f32 v26, v68, v69
    v_mfma_f32_16x16x32_bf16 v[68:71], a[212:215], a[144:147], 0
    s_waitcnt lgkmcnt(1)
    ds_read_b128 a[232:235], v1 offset:14336
    v_fma_f32 v73, v73, s28, v11
    v_mfma_f32_16x16x32_bf16 v[68:71], a[216:219], a[148:151], v[68:71]
    v_exp_f32 v72, v72
    v_exp_f32 v74, v74
    ds_read_b128 a[212:215], v0 offset:18432
    v_mfma_f32_16x16x32_bf16 v[68:71], a[220:223], a[152:155], v[68:71]
    v_exp_f32 v73, v73
    ds_read_b128 a[216:219], v1 offset:18432
    v_mfma_f32_16x16x32_bf16 v[68:71], a[224:227], a[156:159], v[68:71]
    s_waitcnt lgkmcnt(3)
    v_fma_f32 v61, v61, s28, v10
    ds_read_b128 a[220:223], v0 offset:19456
    v_exp_f32 v75, v75
    v_mfma_f32_16x16x32_bf16 v[68:71], a[228:231], a[160:163], v[68:71]
    v_cvt_pk_bf16_f32 v28, v72, v73
    ds_read_b128 a[224:227], v1 offset:19456
    v_exp_f32 v60, v60
    v_cvt_pk_bf16_f32 v29, v74, v75
    s_waitcnt lgkmcnt(4)
    v_mfma_f32_16x16x32_bf16 v[68:71], a[232:235], a[164:167], v[68:71]
    ds_read_b128 a[232:235], v1 offset:20480
    s_waitcnt lgkmcnt(4)
    v_mfma_f32_16x16x32_bf16 v[72:75], a[212:215], a[144:147], 0
    ds_read_b128 a[228:231], v0 offset:20480
    s_waitcnt lgkmcnt(4)
    v_mfma_f32_16x16x32_bf16 v[72:75], a[216:219], a[148:151], v[72:75]
    v_exp_f32 v61, v61
    ds_read_b128 a[216:219], v1 offset:0
    s_waitcnt lgkmcnt(4)
    v_mfma_f32_16x16x32_bf16 v[72:75], a[220:223], a[152:155], v[72:75]
    ds_read_b128 a[220:223], v0 offset:1024
    s_waitcnt lgkmcnt(4)
    v_mfma_f32_16x16x32_bf16 v[72:75], a[224:227], a[156:159], v[72:75]
    ds_read_b128 a[212:215], v0 offset:0
    s_waitcnt lgkmcnt(3)
    v_mfma_f32_16x16x32_bf16 v[72:75], a[228:231], a[160:163], v[72:75]
    s_waitcnt vmcnt(6)
    ds_read_b128 a[168:171], v104 offset:18432
    v_mfma_f32_16x16x32_bf16 v[72:75], a[232:235], a[164:167], v[72:75]
    ds_read_b128 a[232:235], v1 offset:2048
    ds_read_b128 a[172:175], v105 offset:18432
    ds_read_b128 a[176:179], v104 offset:20480
    ds_read_b128 a[188:191], v105 offset:22528
    ds_read_b128 a[184:187], v104 offset:22528
    ds_read_b128 a[224:227], v1 offset:1024
    ds_read_b128 a[180:183], v105 offset:20480
    ds_read_b128 a[228:231], v0 offset:2048
    s_waitcnt lgkmcnt(8)
    v_mfma_f32_16x16x32_bf16 v[76:79], a[212:215], a[168:171], 0
    ds_read_b128 a[212:215], v0 offset:6144
    s_waitcnt lgkmcnt(7)
    v_mfma_f32_16x16x32_bf16 v[76:79], a[216:219], a[172:175], v[76:79]
    s_waitcnt lgkmcnt(5)
    ds_read_b128 a[216:219], v1 offset:6144
    v_mfma_f32_16x16x32_bf16 v[76:79], a[220:223], a[176:179], v[76:79]
    s_waitcnt lgkmcnt(2)
    ds_read_b128 a[220:223], v0 offset:7168
    v_mfma_f32_16x16x32_bf16 v[76:79], a[224:227], a[180:183], v[76:79]
    ds_read_b128 a[224:227], v1 offset:7168
    v_mfma_f32_16x16x32_bf16 v[76:79], a[228:231], a[184:187], v[76:79]
    ds_read_b128 a[228:231], v0 offset:8192
    v_mfma_f32_16x16x32_bf16 v[76:79], a[232:235], a[188:191], v[76:79]
    ds_read_b128 a[232:235], v1 offset:8192
    s_waitcnt lgkmcnt(5)
    v_mfma_f32_16x16x32_bf16 v[80:83], a[212:215], a[168:171], 0
    s_waitcnt lgkmcnt(4)
    v_mfma_f32_16x16x32_bf16 v[80:83], a[216:219], a[172:175], v[80:83]
    v_exp_f32 v52, v52
    s_nop 1
    v_max3_f32 v98, v76, v77, v78
    s_waitcnt lgkmcnt(2)
    v_mfma_f32_16x16x32_bf16 v[80:83], a[220:223], a[176:179], v[80:83]
    s_waitcnt vmcnt(63) lgkmcnt(0)
    s_barrier
    ds_read_b128 a[216:219], v1 offset:12288
    v_mfma_f32_16x16x32_bf16 v[80:83], a[224:227], a[180:183], v[80:83]
    s_add_u32 m0, s22, 0
    ds_read_b128 a[212:215], v0 offset:12288
    buffer_load_dwordx4 v6, s[4:7], s20 offen lds
    v_mfma_f32_16x16x32_bf16 v[80:83], a[228:231], a[184:187], v[80:83]
    s_add_u32 s20, s20, 128
    ds_read_b128 a[224:227], v1 offset:13312
    ds_read_b128 a[220:223], v0 offset:13312
    v_mfma_f32_16x16x32_bf16 v[80:83], a[232:235], a[188:191], v[80:83]
    s_add_u32 m0, s22, 1024
    ds_read_b128 a[232:235], v1 offset:14336
    buffer_load_dwordx4 v6, s[4:7], s20 offen lds
    v_mfma_f32_16x16x32_bf16 v[44:47], a[244:247], v[26:29], v[44:47]
    s_add_u32 s20, s20, 128
    s_add_u32 m0, s22, 2048
    ds_read_b128 a[228:231], v0 offset:14336
    buffer_load_dwordx4 v6, s[4:7], s20 offen lds
    v_max3_f32 v98, v98, v79, v80
    v_max3_f32 v98, v98, v81, v82
    v_max_f32 v98, v98, v83
    v_mov_b32 v99, v98
    s_add_u32 s20, s20, 12032
    s_mov_b32 s39, s64
    v_permlane32_swap_b32 v99, v98
    v_max_f32 v98, v98, v99
    v_mov_b32 v99, v98
    s_add_u32 s37, s37, 1
    s_bitcmp1_b32 s63, s37
    v_permlane16_swap_b32 v99, v98
    v_max_f32 v98, v98, v99
    v_mul_f32_e64 v12, -s28, v98
    v_fma_f32 v79, v79, s28, v12
    v_fma_f32 v78, v78, s28, v12
    v_exp_f32 v78, v78
    v_fma_f32 v77, v77, s28, v12
    v_fma_f32 v76, v76, s28, v12
    v_exp_f32 v77, v77
    v_exp_f32 v79, v79
    v_exp_f32 v76, v76
    v_cvt_pk_bf16_f32 v33, v78, v79
    v_cvt_pk_bf16_f32 v32, v76, v77
    s_cselect_b32 s62, 4294770688, 0
    s_waitcnt lgkmcnt(1)
    v_mfma_f32_16x16x32_bf16 v[76:79], a[212:215], a[168:171], 0
    s_cselect_b32 s42, 0, 325632
    s_add_u32 s35, s35, s42
    ds_read_b128 a[212:215], v0 offset:18432
    v_mfma_f32_16x16x32_bf16 v[76:79], a[216:219], a[172:175], v[76:79]
    s_lshl_b32 s42, s37, 1
    ds_read_b128 a[216:219], v1 offset:18432
    s_lshr_b32 s42, s31, s42
    s_and_b32 s42, s42, 3
    s_add_u32 s42, s42, s36
    v_mfma_f32_16x16x32_bf16 v[76:79], a[220:223], a[176:179], v[76:79]
    s_sub_u32 s43, s42, 3
    ds_read_b128 a[220:223], v0 offset:19456
    s_cmp_ge_u32 s42, 3
    v_mfma_f32_16x16x32_bf16 v[76:79], a[224:227], a[180:183], v[76:79]
    s_waitcnt lgkmcnt(3)
    ds_read_b128 a[224:227], v1 offset:19456
    s_cselect_b32 s42, s43, s42
    v_mfma_f32_16x16x32_bf16 v[76:79], a[228:231], a[184:187], v[76:79]
    s_mul_i32 s44, s3, 5
    ds_read_b128 a[228:231], v0 offset:20480
    s_mov_b32 s32, 1
    v_mfma_f32_16x16x32_bf16 v[76:79], a[232:235], a[188:191], v[76:79]
    s_lshl_b32 s43, s3, 2
    s_add_u32 s45, s43, 21
    ds_read_b128 a[232:235], v1 offset:20480
    s_cmp_eq_u32 s3, 0
    s_cselect_b32 s45, 20, s45
    v_fma_f32 v82, v82, s28, v12
    v_fma_f32 v80, v80, s28, v12
    v_fma_f32 v83, v83, s28, v12
    s_cselect_b32 s33, 1, 0
    s_cmp_eq_u32 s42, 1
    s_cselect_b32 s44, s45, s44
    s_cselect_b32 s32, s33, s32
    s_add_u32 s45, s43, 37
    v_fma_f32 v81, v81, s28, v12
    v_exp_f32 v83, v83
    s_cmp_eq_u32 s42, 2
    s_cselect_b32 s44, s45, s44
    s_cselect_b32 s32, 0, s32
    v_exp_f32 v82, v82
    s_mul_i32 s44, s44, 6144
    s_add_u32 s33, s35, s44
    v_exp_f32 v81, v81
    s_mul_i32 s42, s32, 6144
    s_add_u32 s42, s42, 24576
    s_add_u32 s42, s42, s33
    v_exp_f32 v80, v80
    s_cmp_ge_u32 s37, 6
    v_cvt_pk_bf16_f32 v35, v82, v83
    s_cselect_b32 s14, 0, s42
    v_cvt_pk_bf16_f32 v34, v80, v81
    s_add_u32 s24, s67, 6144
    s_add_u32 s25, s33, 6144
    s_add_u32 s23, s38, 6144
    s_mov_b32 s27, 0x30c30
    s_mov_b32 s89, 0xaaaaaaaa
    s_mov_b32 s30, 0
    s_waitcnt vmcnt(6) lgkmcnt(0)
    v_mfma_f32_16x16x32_bf16 v[80:83], a[212:215], a[168:171], 0
    s_barrier
    ds_read_b64_tr_b16 a[212:213], v2 offset:0
    ds_read_b64_tr_b16 a[214:215], v2 offset:6144
    v_mfma_f32_16x16x32_bf16 v[80:83], a[216:219], a[172:175], v[80:83]
    v_exp_f32 v55, v55
    s_add_u32 m0, s22, 12288
    ds_read_b64_tr_b16 a[216:217], v3 offset:0
    buffer_load_dwordx4 v6, s[4:7], s20 offen lds
    v_cvt_pk_bf16_f32 v18, v52, v53
    ds_read_b64_tr_b16 a[218:219], v3 offset:6144
    s_add_u32 s20, s20, 128
    v_mfma_f32_16x16x32_bf16 v[80:83], a[220:223], a[176:179], v[80:83]
    s_add_u32 m0, s22, 13312
    ds_read_b64_tr_b16 a[220:221], v4 offset:0
    buffer_load_dwordx4 v6, s[4:7], s20 offen lds
    v_cvt_pk_bf16_f32 v19, v54, v55
    v_mfma_f32_16x16x32_bf16 v[80:83], a[224:227], a[180:183], v[80:83]
    s_add_u32 s20, s20, 128
    ds_read_b64_tr_b16 a[222:223], v4 offset:6144
    v_mfma_f32_16x16x32_bf16 v[80:83], a[228:231], a[184:187], v[80:83]
    s_add_u32 m0, s22, 14336
    ds_read_b64_tr_b16 a[224:225], v5 offset:0
    v_cvt_pk_bf16_f32 v24, v60, v61
    v_mfma_f32_16x16x32_bf16 v[80:83], a[232:235], a[188:191], v[80:83]
    buffer_load_dwordx4 v6, s[4:7], s20 offen lds
    ds_read_b64_tr_b16 a[226:227], v5 offset:6144
    v_mfma_f32_16x16x32_bf16 v[44:47], a[248:251], v[32:35], v[44:47]
    s_add_u32 s20, s20, 12032
    s_waitcnt lgkmcnt(6)
    v_mfma_f32_16x16x32_bf16 v[112:115], a[212:215], v[14:17], 0
    ds_read_b64_tr_b16 a[230:231], v2 offset:7168
    v_fma_f32 v74, v74, s28, v11
    v_mfma_f32_16x16x32_bf16 v[160:163], a[212:215], v[20:23], 0
    ds_read_b64_tr_b16 a[228:229], v2 offset:1024
    v_fma_f32 v58, v58, s28, v9
    v_mfma_f32_16x16x32_bf16 v[208:211], a[212:215], v[26:29], 0
    v_fma_f32 v68, v68, s28, v11
    v_fma_f32 v75, v75, s28, v11
    v_fma_f32 v66, v66, s28, v10
    v_mfma_f32_16x16x32_bf16 a[0:3], a[212:215], v[32:35], 0
    v_fma_f32 v59, v59, s28, v9
    s_waitcnt lgkmcnt(6)
    v_mfma_f32_16x16x32_bf16 a[4:7], a[216:219], v[32:35], 0
    ds_read_b64_tr_b16 a[214:215], v4 offset:7168
    v_fma_f32 v77, v77, s28, v12
    v_mfma_f32_16x16x32_bf16 v[212:215], a[216:219], v[26:29], 0
    v_exp_f32 v58, v58
    v_mfma_f32_16x16x32_bf16 v[164:167], a[216:219], v[20:23], 0
    ds_read_b64_tr_b16 a[234:235], v3 offset:7168
    v_add_u32 v103, 6144, v103
    v_mfma_f32_16x16x32_bf16 v[116:119], a[216:219], v[14:17], 0
    ds_read_b64_tr_b16 a[212:213], v4 offset:1024
    s_waitcnt lgkmcnt(7)
    v_mfma_f32_16x16x32_bf16 v[120:123], a[220:223], v[14:17], 0
    ds_read_b64_tr_b16 a[232:233], v3 offset:1024
    v_fma_f32 v78, v78, s28, v12
    v_mfma_f32_16x16x32_bf16 v[168:171], a[220:223], v[20:23], 0
    v_fma_f32 v63, v63, s28, v10
    v_fma_f32 v69, v69, s28, v11
    v_mfma_f32_16x16x32_bf16 v[216:219], a[220:223], v[26:29], 0
    v_fma_f32 v76, v76, s28, v12
    v_fma_f32 v67, v67, s28, v10
    v_mfma_f32_16x16x32_bf16 a[8:11], a[220:223], v[32:35], 0
    s_waitcnt lgkmcnt(4)
    v_fma_f32 v72, v72, s28, v11
    v_fma_f32 v70, v70, s28, v11
    v_mfma_f32_16x16x32_bf16 a[12:15], a[224:227], v[32:35], 0
    v_fma_f32 v83, v83, s28, v12
    v_fma_f32 v62, v62, s28, v10
    v_mfma_f32_16x16x32_bf16 v[220:223], a[224:227], v[26:29], 0
    ds_read_b64_tr_b16 a[216:217], v5 offset:1024
    v_mfma_f32_16x16x32_bf16 v[172:175], a[224:227], v[20:23], 0
    ds_read_b64_tr_b16 a[220:221], v2 offset:2048
    v_fma_f32 v82, v82, s28, v12
    v_mfma_f32_16x16x32_bf16 v[124:127], a[224:227], v[14:17], 0
    ds_read_b64_tr_b16 a[222:223], v2 offset:8192
    v_fma_f32 v57, v57, s28, v9
    v_mfma_f32_16x16x32_bf16 v[128:131], a[228:231], v[14:17], 0
    v_exp_f32 v77, v77
    v_mfma_f32_16x16x32_bf16 v[176:179], a[228:231], v[20:23], 0
    ds_read_b64_tr_b16 a[218:219], v5 offset:7168
    v_mfma_f32_16x16x32_bf16 v[224:227], a[228:231], v[26:29], 0
    v_exp_f32 v75, v75
    v_mfma_f32_16x16x32_bf16 a[16:19], a[228:231], v[32:35], 0
    s_waitcnt lgkmcnt(4)
    ds_read_b64_tr_b16 a[228:229], v4 offset:2048
    v_fma_f32 v80, v80, s28, v12
    v_mfma_f32_16x16x32_bf16 a[20:23], a[232:235], v[32:35], 0
    ds_read_b64_tr_b16 a[226:227], v3 offset:8192
    v_fma_f32 v81, v81, s28, v12
    v_mfma_f32_16x16x32_bf16 v[228:231], a[232:235], v[26:29], 0
    ds_read_b64_tr_b16 a[224:225], v3 offset:2048
    v_fma_f32 v56, v56, s28, v9
    v_mfma_f32_16x16x32_bf16 v[180:183], a[232:235], v[20:23], 0
    ds_read_b64_tr_b16 a[230:231], v4 offset:8192
    v_fma_f32 v71, v71, s28, v11
    v_mfma_f32_16x16x32_bf16 v[132:135], a[232:235], v[14:17], 0
    ds_read_b64_tr_b16 a[232:233], v5 offset:2048
    v_mfma_f32_16x16x32_bf16 v[136:139], a[212:215], v[14:17], 0
    ds_read_b64_tr_b16 a[234:235], v5 offset:8192
    v_fma_f32 v79, v79, s28, v12
    v_mfma_f32_16x16x32_bf16 v[184:187], a[212:215], v[20:23], 0
    v_exp_f32 v67, v67
    v_mfma_f32_16x16x32_bf16 v[232:235], a[212:215], v[26:29], 0
    v_exp_f32 v70, v70
    v_mfma_f32_16x16x32_bf16 a[24:27], a[212:215], v[32:35], 0
    s_waitcnt lgkmcnt(6)
    v_exp_f32 v59, v59
    v_mfma_f32_16x16x32_bf16 a[28:31], a[216:219], v[32:35], 0
    v_exp_f32 v69, v69
    v_mfma_f32_16x16x32_bf16 v[236:239], a[216:219], v[26:29], 0
    s_add_u32 s39, s39, 12288
    v_exp_f32 v68, v68
    v_mfma_f32_16x16x32_bf16 v[188:191], a[216:219], v[20:23], 0
    v_exp_f32 v62, v62
    v_mfma_f32_16x16x32_bf16 v[140:143], a[216:219], v[14:17], 0
    v_exp_f32 v76, v76
    v_mfma_f32_16x16x32_bf16 v[144:147], a[220:223], v[14:17], 0
    v_exp_f32 v71, v71
    v_mfma_f32_16x16x32_bf16 v[192:195], a[220:223], v[20:23], 0
    v_exp_f32 v79, v79
    v_mfma_f32_16x16x32_bf16 v[240:243], a[220:223], v[26:29], 0
    s_waitcnt vmcnt(3) lgkmcnt(0)
    v_exp_f32 v66, v66
    v_mfma_f32_16x16x32_bf16 a[32:35], a[220:223], v[32:35], 0
    s_barrier
    v_mfma_f32_16x16x32_bf16 a[36:39], a[224:227], v[32:35], 0
    ds_read_b128 a[216:219], v1 offset:0
    v_mov_b32 v39, v7
    v_mfma_f32_16x16x32_bf16 v[244:247], a[224:227], v[26:29], 0
    ds_read_b128 a[212:215], v0 offset:0
    s_add_u32 m0, s22, 24576
    v_mfma_f32_16x16x32_bf16 v[196:199], a[224:227], v[20:23], 0
    buffer_load_dwordx4 v6, s[8:11], s21 offen lds
    v_mfma_f32_16x16x32_bf16 v[148:151], a[224:227], v[14:17], 0
    s_add_u32 s21, s21, 128
    s_add_u32 m0, s22, 25600
    ds_read_b128 a[220:223], v0 offset:1024
    v_mfma_f32_16x16x32_bf16 v[152:155], a[228:231], v[14:17], 0
    buffer_load_dwordx4 v6, s[8:11], s21 offen lds
    v_mfma_f32_16x16x32_bf16 v[200:203], a[228:231], v[20:23], 0
    v_fma_f32 v65, v65, s28, v10
    v_mfma_f32_16x16x32_bf16 v[248:251], a[228:231], v[26:29], 0
    s_add_u32 s21, s21, 128
    v_exp_f32 v63, v63
    v_mfma_f32_16x16x32_bf16 a[40:43], a[228:231], v[32:35], 0
    v_cvt_pk_bf16_f32 v30, v68, v69
    s_add_u32 m0, s22, 26624
    v_mfma_f32_16x16x32_bf16 a[44:47], a[232:235], v[32:35], 0
    ds_read_b128 a[228:231], v0 offset:2048
    v_cvt_pk_bf16_f32 v31, v70, v71
    v_mfma_f32_16x16x32_bf16 v[252:255], a[232:235], v[26:29], 0
    v_exp_f32 v56, v56
    v_mfma_f32_16x16x32_bf16 v[204:207], a[232:235], v[20:23], 0
    buffer_load_dwordx4 v6, s[8:11], s21 offen lds
    v_mfma_f32_16x16x32_bf16 v[156:159], a[232:235], v[14:17], 0
    s_waitcnt lgkmcnt(2)
    ds_read_b128 a[224:227], v1 offset:1024
    v_cvt_pk_bf16_f32 v36, v76, v77
    v_mfma_f32_16x16x32_bf16 v[52:55], a[212:215], a[96:99], 0
    v_fma_f32 v73, v73, s28, v11
    v_mfma_f32_16x16x32_bf16 v[52:55], a[216:219], a[100:103], v[52:55]
    s_waitcnt lgkmcnt(2)
    v_exp_f32 v78, v78
    v_mfma_f32_16x16x32_bf16 v[52:55], a[220:223], a[104:107], v[52:55]
    s_add_u32 s21, s21, 12032
    ds_read_b128 a[232:235], v1 offset:2048
    v_cvt_pk_bf16_f32 v25, v62, v63
    v_mfma_f32_16x16x32_bf16 v[60:63], a[220:223], a[128:131], 0
    s_add_u32 m0, s38, 0
    v_fma_f32 v64, v64, s28, v10
    v_cvt_pk_bf16_f32 v23, v66, v67
    v_mfma_f32_16x16x32_bf16 v[60:63], a[216:219], a[124:127], v[60:63]
    v_exp_f32 v64, v64
    v_mfma_f32_16x16x32_bf16 v[60:63], a[212:215], a[120:123], v[60:63]
    buffer_load_dwordx4 v6, s[12:15], s33 offen nt lds
    v_mfma_f32_16x16x32_bf16 v[68:71], a[212:215], a[144:147], 0
    s_add_u32 m0, s38, 1024
    v_exp_f32 v65, v65
    v_mfma_f32_16x16x32_bf16 v[68:71], a[216:219], a[148:151], v[68:71]
    buffer_load_dwordx4 v7, s[12:15], s33 offen nt lds
    v_mfma_f32_16x16x32_bf16 v[68:71], a[220:223], a[152:155], v[68:71]
    v_cvt_pk_bf16_f32 v37, v78, v79
    v_mfma_f32_16x16x32_bf16 v[76:79], a[220:223], a[176:179], 0
    v_exp_f32 v80, v80
    v_mfma_f32_16x16x32_bf16 v[76:79], a[216:219], a[172:175], v[76:79]
    v_exp_f32 v57, v57
    v_mfma_f32_16x16x32_bf16 v[76:79], a[212:215], a[168:171], v[76:79]
    s_waitcnt lgkmcnt(1)
    v_exp_f32 v72, v72
    v_mfma_f32_16x16x32_bf16 v[76:79], a[224:227], a[180:183], v[76:79]
    s_add_u32 s59, s33, 128
    ds_read_b128 a[220:223], v0 offset:7168
    v_cvt_pk_bf16_f32 v17, v58, v59
    v_mfma_f32_16x16x32_bf16 v[76:79], a[228:231], a[184:187], v[76:79]
    s_waitcnt lgkmcnt(1)
    v_exp_f32 v74, v74
    v_mfma_f32_16x16x32_bf16 v[76:79], a[232:235], a[188:191], v[76:79]
    s_add_u32 m0, s38, 2048
    ds_read_b128 a[216:219], v1 offset:6144
    v_mfma_f32_16x16x32_bf16 v[68:71], a[232:235], a[164:167], v[68:71]
    ds_read_b128 a[212:215], v0 offset:6144
    v_mfma_f32_16x16x32_bf16 v[68:71], a[228:231], a[160:163], v[68:71]
    buffer_load_dwordx4 v6, s[12:15], s59 offen nt lds
    v_mfma_f32_16x16x32_bf16 v[68:71], a[224:227], a[156:159], v[68:71]
    v_cvt_pk_bf16_f32 v22, v64, v65
    v_cvt_pk_bf16_f32 v16, v56, v57
    v_mfma_f32_16x16x32_bf16 v[60:63], a[224:227], a[132:135], v[60:63]
    v_exp_f32 v83, v83
    v_mfma_f32_16x16x32_bf16 v[60:63], a[228:231], a[136:139], v[60:63]
    v_exp_f32 v73, v73
    v_mfma_f32_16x16x32_bf16 v[60:63], a[232:235], a[140:143], v[60:63]
    v_exp_f32 v81, v81
    v_mfma_f32_16x16x32_bf16 v[52:55], a[232:235], a[116:119], v[52:55]
    ds_read_b128 a[232:235], v1 offset:8192
    v_mfma_f32_16x16x32_bf16 v[52:55], a[228:231], a[112:115], v[52:55]
    ds_read_b128 a[228:231], v0 offset:8192
    v_cvt_pk_bf16_f32 v29, v74, v75
    v_mfma_f32_16x16x32_bf16 v[52:55], a[224:227], a[108:111], v[52:55]
    ds_read_b128 a[224:227], v1 offset:7168
    v_cvt_pk_bf16_f32 v34, v80, v81
    v_mfma_f32_16x16x32_bf16 v[48:51], a[236:239], v[16:19], v[44:47]
    v_exp_f32 v82, v82
    v_mfma_f32_16x16x32_bf16 v[48:51], a[240:243], v[22:25], v[48:51]
    s_waitcnt lgkmcnt(3)
    v_cvt_pk_bf16_f32 v28, v72, v73
    v_mfma_f32_16x16x32_bf16 v[56:59], a[212:215], a[96:99], 0
    s_add_u32 m0, s38, 3072
    v_cvt_pk_bf16_f32 v35, v82, v83
    v_mfma_f32_16x16x32_bf16 v[48:51], a[244:247], v[28:31], v[48:51]
    buffer_load_dwordx4 v7, s[12:15], s59 offen nt lds
    v_mfma_f32_16x16x32_bf16 v[48:51], a[248:251], v[34:37], v[48:51]
    s_add_u32 s58, s33, 256
    s_add_u32 m0, s38, 4096
    v_mov_b32 v38, v6
    v_mfma_f32_16x16x32_bf16 v[56:59], a[216:219], a[100:103], v[56:59]
    buffer_load_dwordx4 v6, s[12:15], s58 offen nt lds
    v_mfma_f32_16x16x32_bf16 v[56:59], a[220:223], a[104:107], v[56:59]
    s_add_u32 m0, s38, 5120
    s_nop 0
    v_cmp_lt_f32 vcc, s29, v48
    v_mfma_f32_16x16x32_bf16 v[64:67], a[220:223], a[128:131], 0
    buffer_load_dwordx4 v7, s[12:15], s58 offen nt lds
    v_mfma_f32_16x16x32_bf16 v[64:67], a[216:219], a[124:127], v[64:67]
    v_mfma_f32_16x16x32_bf16 v[64:67], a[212:215], a[120:123], v[64:67]
    s_waitcnt vmcnt(15) lgkmcnt(0)
    s_cbranch_vccnz L_rs_start4b
L_ret_start4b:
    v_mfma_f32_16x16x32_bf16 v[72:75], a[212:215], a[144:147], 0
    s_barrier
    v_mfma_f32_16x16x32_bf16 v[72:75], a[216:219], a[148:151], v[72:75]
    v_fma_f32 v55, v55, s28, v9
    v_fma_f32 v54, v54, s28, v9
    v_mfma_f32_16x16x32_bf16 v[72:75], a[220:223], a[152:155], v[72:75]
    s_add_u32 m0, s22, 0
    v_fma_f32 v61, v61, s28, v10
    v_fma_f32 v60, v60, s28, v10
    v_mfma_f32_16x16x32_bf16 v[80:83], a[220:223], a[176:179], 0
    buffer_load_dwordx4 v6, s[4:7], s20 offen lds
    v_mfma_f32_16x16x32_bf16 v[80:83], a[216:219], a[172:175], v[80:83]
    s_add_u32 s20, s20, 128
    v_exp_f32 v55, v55
    v_mfma_f32_16x16x32_bf16 v[80:83], a[212:215], a[168:171], v[80:83]
    ds_read_b64_tr_b16 a[212:213], v2 offset:18432
    v_fma_f32 v53, v53, s28, v9
    v_mfma_f32_16x16x32_bf16 v[80:83], a[224:227], a[180:183], v[80:83]
    v_exp_f32 v54, v54
    v_mfma_f32_16x16x32_bf16 v[80:83], a[228:231], a[184:187], v[80:83]
    s_add_u32 m0, s22, 1024
    ds_read_b64_tr_b16 a[214:215], v2 offset:12288
    buffer_load_dwordx4 v6, s[4:7], s20 offen lds
    v_mfma_f32_16x16x32_bf16 v[80:83], a[232:235], a[188:191], v[80:83]
    s_add_u32 s20, s20, 128
    v_exp_f32 v60, v60
    v_mfma_f32_16x16x32_bf16 v[72:75], a[232:235], a[164:167], v[72:75]
    ds_read_b64_tr_b16 a[216:217], v3 offset:18432
    ds_read_b64_tr_b16 a[218:219], v3 offset:12288
    v_mfma_f32_16x16x32_bf16 v[72:75], a[228:231], a[160:163], v[72:75]
    s_add_u32 m0, s22, 2048
    ds_read_b64_tr_b16 a[220:221], v4 offset:18432
    v_fma_f32 v52, v52, s28, v9
    v_mfma_f32_16x16x32_bf16 v[72:75], a[224:227], a[156:159], v[72:75]
    buffer_load_dwordx4 v6, s[4:7], s20 offen lds
    v_mfma_f32_16x16x32_bf16 v[64:67], a[224:227], a[132:135], v[64:67]
    v_exp_f32 v61, v61
    v_mfma_f32_16x16x32_bf16 v[64:67], a[228:231], a[136:139], v[64:67]
    s_add_u32 s20, s20, 12032
    v_exp_f32 v52, v52
    v_mfma_f32_16x16x32_bf16 v[64:67], a[232:235], a[140:143], v[64:67]
    v_exp_f32 v53, v53
    v_mfma_f32_16x16x32_bf16 v[56:59], a[232:235], a[116:119], v[56:59]
    v_cvt_pk_bf16_f32 v15, v54, v55
    v_cvt_pk_bf16_f32 v14, v52, v53
    v_mfma_f32_16x16x32_bf16 v[56:59], a[228:231], a[112:115], v[56:59]
    ds_read_b64_tr_b16 a[222:223], v4 offset:12288
    v_cvt_pk_bf16_f32 v20, v60, v61
    v_mfma_f32_16x16x32_bf16 v[56:59], a[224:227], a[108:111], v[56:59]
    s_waitcnt lgkmcnt(4)
    ds_read_b64_tr_b16 a[224:225], v5 offset:18432
    ds_read_b64_tr_b16 a[226:227], v5 offset:12288
    s_branch L_loop4
L_loop5:
    s_bitcmp1_b32 s3, 1
    s_cbranch_scc1 L_loop5w1
    .p2align 6
L_loop5w0:
    v_mfma_f32_16x16x32_bf16 v[112:115], a[212:215], v[16:19], v[112:115]
    ds_read_b128 v[96:99], v103 offset:0
    v_mfma_f32_16x16x32_bf16 v[116:119], a[216:219], v[16:19], v[116:119]
    ds_read_b64_tr_b16 a[228:229], v2 offset:19456
    v_fma_f32 v73, v73, s28, v11
    v_mfma_f32_16x16x32_bf16 v[164:167], a[216:219], v[22:25], v[164:167]
    ds_read_b64_tr_b16 a[234:235], v3 offset:13312
    v_fma_f32 v84, v84, s28, v13
    v_mfma_f32_16x16x32_bf16 v[160:163], a[212:215], v[22:25], v[160:163]
    ds_read_b64_tr_b16 a[232:233], v3 offset:19456
    v_fma_f32 v85, v85, s28, v13
    v_mfma_f32_16x16x32_bf16 v[208:211], a[212:215], v[28:31], v[208:211]
    v_fma_f32 v65, v65, s28, v10
    v_fma_f32 v72, v72, s28, v11
    v_mfma_f32_16x16x32_bf16 v[212:215], a[216:219], v[28:31], v[212:215]
    v_fma_f32 v91, v91, s28, v13
    v_fma_f32 v59, v59, s28, v9
    v_mfma_f32_16x16x32_bf16 a[4:7], a[216:219], v[34:37], a[4:7]
    ds_read_b64_tr_b16 a[230:231], v2 offset:13312
    v_fma_f32 v71, v71, s28, v11
    v_mfma_f32_16x16x32_bf16 a[0:3], a[212:215], v[34:37], a[0:3]
    s_add_u32 s39, s39, 12288
    v_fma_f32 v86, v86, s28, v13
    v_mfma_f32_16x16x32_bf16 a[48:51], a[212:215], v[40:43], a[48:51]
    v_fma_f32 v69, v69, s28, v11
    v_fma_f32 v67, v67, s28, v10
    v_mfma_f32_16x16x32_bf16 a[52:55], a[216:219], v[40:43], a[52:55]
    s_add_u32 m0, s23, 0
    v_fma_f32 v87, v87, s28, v13
    v_fma_f32 v56, v56, s28, v9
    s_waitcnt lgkmcnt(4)
    v_mfma_f32_16x16x32_bf16 a[56:59], a[220:223], v[40:43], a[56:59]
    buffer_store_dwordx4 v[96:99], v6, s[16:19], s24 offen offset:0 nt
    ds_read_b64_tr_b16 a[214:215], v4 offset:13312
    v_exp_f32 v71, v71
    v_mfma_f32_16x16x32_bf16 a[60:63], a[224:227], v[40:43], a[60:63]
    v_exp_f32 v85, v85
    v_mfma_f32_16x16x32_bf16 a[12:15], a[224:227], v[34:37], a[12:15]
    v_fma_f32 v58, v58, s28, v9
    v_fma_f32 v83, v83, s28, v12
    v_mfma_f32_16x16x32_bf16 a[8:11], a[220:223], v[34:37], a[8:11]
    ds_read_b64_tr_b16 a[216:217], v5 offset:19456
    ds_read_b64_tr_b16 a[212:213], v4 offset:19456
    v_mfma_f32_16x16x32_bf16 v[216:219], a[220:223], v[28:31], v[216:219]
    v_fma_f32 v89, v89, s28, v13
    v_mfma_f32_16x16x32_bf16 v[220:223], a[224:227], v[28:31], v[220:223]
    v_fma_f32 v70, v70, s28, v11
    v_fma_f32 v57, v57, s28, v9
    v_mfma_f32_16x16x32_bf16 v[172:175], a[224:227], v[22:25], v[172:175]
    buffer_load_dwordx4 v6, s[12:15], s25 offen nt lds
    v_mfma_f32_16x16x32_bf16 v[168:171], a[220:223], v[22:25], v[168:171]
    v_fma_f32 v68, v68, s28, v11
    v_fma_f32 v79, v79, s28, v12
    v_mfma_f32_16x16x32_bf16 v[120:123], a[220:223], v[16:19], v[120:123]
    v_exp_f32 v70, v70
    v_mfma_f32_16x16x32_bf16 v[124:127], a[224:227], v[16:19], v[124:127]
    s_waitcnt lgkmcnt(3)
    ds_read_b64_tr_b16 a[218:219], v5 offset:13312
    ds_read_b64_tr_b16 a[220:221], v2 offset:20480
    v_mfma_f32_16x16x32_bf16 v[128:131], a[228:231], v[16:19], v[128:131]
    ds_read_b64_tr_b16 a[222:223], v2 offset:14336
    v_fma_f32 v66, v66, s28, v10
    v_mfma_f32_16x16x32_bf16 v[132:135], a[232:235], v[16:19], v[132:135]
    v_fma_f32 v82, v82, s28, v12
    v_fma_f32 v74, v74, s28, v11
    v_mfma_f32_16x16x32_bf16 v[180:183], a[232:235], v[22:25], v[180:183]
    ds_read_b64_tr_b16 a[226:227], v3 offset:14336
    ds_read_b64_tr_b16 a[224:225], v3 offset:20480
    v_mfma_f32_16x16x32_bf16 v[176:179], a[228:231], v[22:25], v[176:179]
    v_mfma_f32_16x16x32_bf16 v[224:227], a[228:231], v[28:31], v[224:227]
    v_exp_f32 v87, v87
    v_mfma_f32_16x16x32_bf16 v[228:231], a[232:235], v[28:31], v[228:231]
    v_mfma_f32_16x16x32_bf16 a[20:23], a[232:235], v[34:37], a[20:23]
    v_exp_f32 v89, v89
    v_mfma_f32_16x16x32_bf16 a[16:19], a[228:231], v[34:37], a[16:19]
    v_fma_f32 v81, v81, s28, v12
    v_fma_f32 v80, v80, s28, v12
    v_mfma_f32_16x16x32_bf16 a[64:67], a[228:231], v[40:43], a[64:67]
    v_exp_f32 v83, v83
    v_mfma_f32_16x16x32_bf16 a[68:71], a[232:235], v[40:43], a[68:71]
    s_waitcnt lgkmcnt(3)
    ds_read_b64_tr_b16 a[232:233], v5 offset:20480
    v_fma_f32 v77, v77, s28, v12
    v_mfma_f32_16x16x32_bf16 a[72:75], a[212:215], v[40:43], a[72:75]
    v_fma_f32 v64, v64, s28, v10
    v_mfma_f32_16x16x32_bf16 a[76:79], a[216:219], v[40:43], a[76:79]
    v_exp_f32 v57, v57
    v_mfma_f32_16x16x32_bf16 a[28:31], a[216:219], v[34:37], a[28:31]
    ds_read_b64_tr_b16 a[228:229], v4 offset:20480
    v_fma_f32 v76, v76, s28, v12
    v_mfma_f32_16x16x32_bf16 a[24:27], a[212:215], v[34:37], a[24:27]
    ds_read_b64_tr_b16 a[234:235], v5 offset:14336
    v_fma_f32 v78, v78, s28, v12
    v_mfma_f32_16x16x32_bf16 v[232:235], a[212:215], v[28:31], v[232:235]
    v_exp_f32 v67, v67
    v_mfma_f32_16x16x32_bf16 v[236:239], a[216:219], v[28:31], v[236:239]
    v_exp_f32 v84, v84
    v_mfma_f32_16x16x32_bf16 v[188:191], a[216:219], v[22:25], v[188:191]
    ds_read_b64_tr_b16 a[230:231], v4 offset:14336
    v_fma_f32 v88, v88, s28, v13
    v_mfma_f32_16x16x32_bf16 v[184:187], a[212:215], v[22:25], v[184:187]
    v_exp_f32 v66, v66
    v_mfma_f32_16x16x32_bf16 v[136:139], a[212:215], v[16:19], v[136:139]
    v_exp_f32 v86, v86
    v_mfma_f32_16x16x32_bf16 v[140:143], a[216:219], v[16:19], v[140:143]
    s_waitcnt lgkmcnt(3)
    ds_read_b128 v[96:99], v103 offset:1024
    v_mfma_f32_16x16x32_bf16 v[144:147], a[220:223], v[16:19], v[144:147]
    v_exp_f32 v69, v69
    v_mfma_f32_16x16x32_bf16 v[148:151], a[224:227], v[16:19], v[148:151]
    v_exp_f32 v77, v77
    v_mfma_f32_16x16x32_bf16 v[196:199], a[224:227], v[22:25], v[196:199]
    v_exp_f32 v73, v73
    v_mfma_f32_16x16x32_bf16 v[192:195], a[220:223], v[22:25], v[192:195]
    v_mfma_f32_16x16x32_bf16 v[240:243], a[220:223], v[28:31], v[240:243]
    v_exp_f32 v65, v65
    v_mfma_f32_16x16x32_bf16 v[244:247], a[224:227], v[28:31], v[244:247]
    v_exp_f32 v68, v68
    v_mfma_f32_16x16x32_bf16 a[36:39], a[224:227], v[34:37], a[36:39]
    v_exp_f32 v59, v59
    v_mfma_f32_16x16x32_bf16 a[32:35], a[220:223], v[34:37], a[32:35]
    s_waitcnt vmcnt(12) lgkmcnt(1)
    v_exp_f32 v72, v72
    v_mfma_f32_16x16x32_bf16 a[80:83], a[220:223], v[40:43], a[80:83]
    v_fma_f32 v75, v75, s28, v11
    v_cvt_pk_bf16_f32 v26, v68, v69
    v_mfma_f32_16x16x32_bf16 a[84:87], a[224:227], v[40:43], a[84:87]
    s_barrier
    ds_read_b128 a[212:215], v0 offset:12288
    v_mfma_f32_16x16x32_bf16 a[88:91], a[228:231], v[40:43], a[88:91]
    ds_read_b128 a[216:219], v1 offset:12288
    v_cvt_pk_bf16_f32 v27, v70, v71
    v_mfma_f32_16x16x32_bf16 a[92:95], a[232:235], v[40:43], a[92:95]
    ds_read_b128 a[220:223], v0 offset:13312
    s_add_u32 m0, s22, 36864
    v_mfma_f32_16x16x32_bf16 a[44:47], a[232:235], v[34:37], a[44:47]
    buffer_load_dwordx4 v6, s[8:11], s21 offen lds
    v_mfma_f32_16x16x32_bf16 a[40:43], a[228:231], v[34:37], a[40:43]
    s_add_u32 s21, s21, 128
    s_add_u32 m0, s22, 37888
    v_cvt_pk_bf16_f32 v38, v84, v85
    v_mfma_f32_16x16x32_bf16 v[248:251], a[228:231], v[28:31], v[248:251]
    buffer_load_dwordx4 v6, s[8:11], s21 offen lds
    v_mfma_f32_16x16x32_bf16 v[252:255], a[232:235], v[28:31], v[252:255]
    s_add_u32 s21, s21, 128
    v_exp_f32 v79, v79
    v_mfma_f32_16x16x32_bf16 v[204:207], a[232:235], v[22:25], v[204:207]
    ds_read_b128 a[224:227], v1 offset:13312
    v_cvt_pk_bf16_f32 v39, v86, v87
    v_mfma_f32_16x16x32_bf16 v[200:203], a[228:231], v[22:25], v[200:203]
    s_add_u32 m0, s22, 38912
    v_exp_f32 v58, v58
    v_mfma_f32_16x16x32_bf16 v[152:155], a[228:231], v[16:19], v[152:155]
    buffer_load_dwordx4 v6, s[8:11], s21 offen lds
    v_mfma_f32_16x16x32_bf16 v[156:159], a[232:235], v[16:19], v[156:159]
    s_waitcnt lgkmcnt(3)
    ds_read_b128 a[232:235], v1 offset:14336
    v_fma_f32 v90, v90, s28, v13
    v_mfma_f32_16x16x32_bf16 v[52:55], a[212:215], a[96:99], 0
    s_waitcnt lgkmcnt(3)
    v_exp_f32 v78, v78
    v_mfma_f32_16x16x32_bf16 v[52:55], a[216:219], a[100:103], v[52:55]
    s_waitcnt lgkmcnt(2)
    v_exp_f32 v76, v76
    v_mfma_f32_16x16x32_bf16 v[52:55], a[220:223], a[104:107], v[52:55]
    v_exp_f32 v91, v91
    v_mfma_f32_16x16x32_bf16 v[60:63], a[220:223], a[128:131], 0
    v_exp_f32 v64, v64
    v_mfma_f32_16x16x32_bf16 v[60:63], a[216:219], a[124:127], v[60:63]
    s_add_u32 s21, s21, 12032
    s_add_u32 m0, s23, 1024
    ds_read_b128 a[228:231], v0 offset:14336
    v_mfma_f32_16x16x32_bf16 v[60:63], a[212:215], a[120:123], v[60:63]
    v_exp_f32 v56, v56
    v_mfma_f32_16x16x32_bf16 v[68:71], a[212:215], a[144:147], 0
    v_exp_f32 v90, v90
    v_mfma_f32_16x16x32_bf16 v[68:71], a[216:219], a[148:151], v[68:71]
    buffer_store_dwordx4 v[96:99], v7, s[16:19], s24 offen offset:0 nt
    v_cvt_pk_bf16_f32 v32, v76, v77
    v_cvt_pk_bf16_f32 v33, v78, v79
    v_mfma_f32_16x16x32_bf16 v[68:71], a[220:223], a[152:155], v[68:71]
    v_exp_f32 v81, v81
    v_mfma_f32_16x16x32_bf16 v[76:79], a[220:223], a[176:179], 0
    v_exp_f32 v74, v74
    v_mfma_f32_16x16x32_bf16 v[76:79], a[216:219], a[172:175], v[76:79]
    v_exp_f32 v80, v80
    v_mfma_f32_16x16x32_bf16 v[76:79], a[212:215], a[168:171], v[76:79]
    v_cvt_pk_bf16_f32 v16, v56, v57
    v_cvt_pk_bf16_f32 v23, v66, v67
    v_mfma_f32_16x16x32_bf16 v[84:87], a[212:215], a[192:195], 0
    v_cvt_pk_bf16_f32 v22, v64, v65
    v_mfma_f32_16x16x32_bf16 v[84:87], a[216:219], a[196:199], v[84:87]
    v_mfma_f32_16x16x32_bf16 v[84:87], a[220:223], a[200:203], v[84:87]
    s_waitcnt lgkmcnt(0)
    ds_read_b128 a[212:215], v0 offset:18432
    v_mfma_f32_16x16x32_bf16 v[84:87], a[224:227], a[204:207], v[84:87]
    v_cvt_pk_bf16_f32 v17, v58, v59
    v_mfma_f32_16x16x32_bf16 v[84:87], a[228:231], a[208:211], v[84:87]
    v_cvt_pk_bf16_f32 v34, v80, v81
    v_mfma_f32_16x16x32_bf16 v[84:87], a[232:235], v[92:95], v[84:87]
    buffer_load_dwordx4 v7, s[12:15], s25 offen nt lds
    v_mfma_f32_16x16x32_bf16 v[76:79], a[232:235], a[188:191], v[76:79]
    v_exp_f32 v75, v75
    v_mfma_f32_16x16x32_bf16 v[76:79], a[228:231], a[184:187], v[76:79]
    v_exp_f32 v82, v82
    v_mfma_f32_16x16x32_bf16 v[76:79], a[224:227], a[180:183], v[76:79]
    ds_read_b128 a[216:219], v1 offset:18432
    s_bitcmp1_b32 s27, 0
    v_mfma_f32_16x16x32_bf16 v[68:71], a[224:227], a[156:159], v[68:71]
    v_exp_f32 v88, v88
    v_mfma_f32_16x16x32_bf16 v[68:71], a[228:231], a[160:163], v[68:71]
    v_cvt_pk_bf16_f32 v28, v72, v73
    v_mfma_f32_16x16x32_bf16 v[68:71], a[232:235], a[164:167], v[68:71]
    v_cvt_pk_bf16_f32 v29, v74, v75
    v_mfma_f32_16x16x32_bf16 v[44:47], a[236:239], v[14:17], v[48:51]
    ds_read_b128 a[220:223], v0 offset:19456
    v_mfma_f32_16x16x32_bf16 v[60:63], a[232:235], a[140:143], v[60:63]
    v_cvt_pk_bf16_f32 v41, v90, v91
    v_mfma_f32_16x16x32_bf16 v[60:63], a[228:231], a[136:139], v[60:63]
    s_cselect_b32 s26, s49, 128
    ds_read_b128 v[96:99], v103 offset:2048
    v_cvt_pk_bf16_f32 v40, v88, v89
    v_mfma_f32_16x16x32_bf16 v[60:63], a[224:227], a[132:135], v[60:63]
    v_mfma_f32_16x16x32_bf16 v[52:55], a[224:227], a[108:111], v[52:55]
    ds_read_b128 a[224:227], v1 offset:19456
    v_mfma_f32_16x16x32_bf16 v[52:55], a[228:231], a[112:115], v[52:55]
    v_mfma_f32_16x16x32_bf16 v[52:55], a[232:235], a[116:119], v[52:55]
    v_cvt_pk_bf16_f32 v35, v82, v83
    v_mfma_f32_16x16x32_bf16 v[44:47], a[240:243], v[20:23], v[44:47]
    ds_read_b128 a[232:235], v1 offset:20480
    v_mfma_f32_16x16x32_bf16 v[44:47], a[244:247], v[26:29], v[44:47]
    ds_read_b128 a[228:231], v0 offset:20480
    v_mfma_f32_16x16x32_bf16 v[44:47], a[248:251], v[32:35], v[44:47]
    v_mfma_f32_16x16x32_bf16 v[44:47], a[252:255], v[38:41], v[44:47]
    s_lshr_b32 s27, s27, 1
    s_waitcnt lgkmcnt(4)
    v_mfma_f32_16x16x32_bf16 v[56:59], a[212:215], a[96:99], 0
    s_add_u32 s24, s24, s26
    v_mfma_f32_16x16x32_bf16 v[56:59], a[216:219], a[100:103], v[56:59]
    v_mfma_f32_16x16x32_bf16 v[56:59], a[220:223], a[104:107], v[56:59]
    s_nop 1
    v_cmp_lt_f32 vcc, s29, v44
    v_mfma_f32_16x16x32_bf16 v[64:67], a[220:223], a[128:131], 0
    s_add_u32 s25, s25, s26
    v_mfma_f32_16x16x32_bf16 v[64:67], a[216:219], a[124:127], v[64:67]
    v_mfma_f32_16x16x32_bf16 v[64:67], a[212:215], a[120:123], v[64:67]
    s_nop 0
    s_cbranch_vccnz L_rs_loop5w0a
L_ret_loop5w0a:
    v_mfma_f32_16x16x32_bf16 v[72:75], a[212:215], a[144:147], 0
    v_mfma_f32_16x16x32_bf16 v[72:75], a[216:219], a[148:151], v[72:75]
    s_waitcnt vmcnt(12) lgkmcnt(0)
    v_mfma_f32_16x16x32_bf16 v[72:75], a[220:223], a[152:155], v[72:75]
    v_fma_f32 v87, v87, s28, v13
    s_add_u32 m0, s22, 12288
    v_mfma_f32_16x16x32_bf16 v[80:83], a[220:223], a[176:179], 0
    s_barrier
    v_mfma_f32_16x16x32_bf16 v[80:83], a[216:219], a[172:175], v[80:83]
    buffer_load_dwordx4 v6, s[4:7], s20 offen lds
    v_mfma_f32_16x16x32_bf16 v[80:83], a[212:215], a[168:171], v[80:83]
    s_add_u32 s20, s20, 128
    v_fma_f32 v84, v84, s28, v13
    s_add_u32 m0, s22, 13312
    v_mfma_f32_16x16x32_bf16 v[88:91], a[212:215], a[192:195], 0
    buffer_load_dwordx4 v6, s[4:7], s20 offen lds
    v_mfma_f32_16x16x32_bf16 v[88:91], a[216:219], a[196:199], v[88:91]
    ds_read_b64_tr_b16 a[212:213], v2 offset:0
    ds_read_b64_tr_b16 a[214:215], v2 offset:6144
    v_mfma_f32_16x16x32_bf16 v[88:91], a[220:223], a[200:203], v[88:91]
    s_add_u32 s20, s20, 128
    v_fma_f32 v76, v76, s28, v12
    v_fma_f32 v62, v62, s28, v10
    v_mfma_f32_16x16x32_bf16 v[88:91], a[224:227], a[204:207], v[88:91]
    v_fma_f32 v70, v70, s28, v11
    v_fma_f32 v52, v52, s28, v9
    v_mfma_f32_16x16x32_bf16 v[88:91], a[228:231], a[208:211], v[88:91]
    s_add_u32 m0, s22, 14336
    ds_read_b64_tr_b16 a[216:217], v3 offset:0
    v_fma_f32 v69, v69, s28, v11
    v_mfma_f32_16x16x32_bf16 v[88:91], a[232:235], v[92:95], v[88:91]
    buffer_load_dwordx4 v6, s[4:7], s20 offen lds
    v_mfma_f32_16x16x32_bf16 v[80:83], a[232:235], a[188:191], v[80:83]
    v_fma_f32 v63, v63, s28, v10
    v_mfma_f32_16x16x32_bf16 v[80:83], a[228:231], a[184:187], v[80:83]
    ds_read_b64_tr_b16 a[218:219], v3 offset:6144
    v_fma_f32 v55, v55, s28, v9
    v_mfma_f32_16x16x32_bf16 v[80:83], a[224:227], a[180:183], v[80:83]
    v_fma_f32 v79, v79, s28, v12
    v_fma_f32 v53, v53, s28, v9
    v_mfma_f32_16x16x32_bf16 v[72:75], a[224:227], a[156:159], v[72:75]
    v_exp_f32 v62, v62
    v_mfma_f32_16x16x32_bf16 v[72:75], a[228:231], a[160:163], v[72:75]
    ds_read_b64_tr_b16 a[220:221], v4 offset:0
    v_mfma_f32_16x16x32_bf16 v[72:75], a[232:235], a[164:167], v[72:75]
    v_fma_f32 v68, v68, s28, v11
    v_fma_f32 v83, v83, s28, v12
    v_mfma_f32_16x16x32_bf16 v[64:67], a[232:235], a[140:143], v[64:67]
    v_mfma_f32_16x16x32_bf16 v[64:67], a[228:231], a[136:139], v[64:67]
    s_add_u32 s20, s20, 12032
    v_exp_f32 v63, v63
    v_mfma_f32_16x16x32_bf16 v[64:67], a[224:227], a[132:135], v[64:67]
    ds_read_b64_tr_b16 a[222:223], v4 offset:6144
    v_mfma_f32_16x16x32_bf16 v[56:59], a[224:227], a[108:111], v[56:59]
    v_exp_f32 v52, v52
    v_mfma_f32_16x16x32_bf16 v[56:59], a[228:231], a[112:115], v[56:59]
    v_exp_f32 v76, v76
    v_mfma_f32_16x16x32_bf16 v[56:59], a[232:235], a[116:119], v[56:59]
    s_waitcnt lgkmcnt(2)
    ds_read_b64_tr_b16 a[232:233], v3 offset:1024
    ds_read_b64_tr_b16 a[230:231], v2 offset:7168
    v_mfma_f32_16x16x32_bf16 v[112:115], a[212:215], v[14:17], v[112:115]
    ds_read_b64_tr_b16 a[224:225], v5 offset:0
    v_fma_f32 v91, v91, s28, v13
    v_mfma_f32_16x16x32_bf16 v[116:119], a[216:219], v[14:17], v[116:119]
    ds_read_b64_tr_b16 a[226:227], v5 offset:6144
    v_fma_f32 v61, v61, s28, v10
    v_mfma_f32_16x16x32_bf16 v[164:167], a[216:219], v[20:23], v[164:167]
    buffer_store_dwordx4 v[96:99], v6, s[16:19], s24 offen offset:0 nt
    v_cvt_pk_bf16_f32 v25, v62, v63
    v_exp_f32 v55, v55
    v_mfma_f32_16x16x32_bf16 v[160:163], a[212:215], v[20:23], v[160:163]
    s_add_u32 s39, s39, 12288
    v_fma_f32 v64, v64, s28, v10
    v_mfma_f32_16x16x32_bf16 v[208:211], a[212:215], v[26:29], v[208:211]
    v_fma_f32 v75, v75, s28, v11
    s_add_u32 m0, s23, 2048
    v_mfma_f32_16x16x32_bf16 v[212:215], a[216:219], v[26:29], v[212:215]
    v_fma_f32 v54, v54, s28, v9
    v_fma_f32 v73, v73, s28, v11
    v_mfma_f32_16x16x32_bf16 a[4:7], a[216:219], v[32:35], a[4:7]
    v_exp_f32 v69, v69
    v_mfma_f32_16x16x32_bf16 a[0:3], a[212:215], v[32:35], a[0:3]
    v_fma_f32 v85, v85, s28, v13
    v_fma_f32 v60, v60, s28, v10
    v_mfma_f32_16x16x32_bf16 a[48:51], a[212:215], v[38:41], a[48:51]
    ds_read_b64_tr_b16 a[234:235], v3 offset:7168
    ds_read_b64_tr_b16 a[228:229], v2 offset:1024
    v_mfma_f32_16x16x32_bf16 a[52:55], a[216:219], v[38:41], a[52:55]
    s_waitcnt lgkmcnt(3)
    v_exp_f32 v68, v68
    v_mfma_f32_16x16x32_bf16 a[56:59], a[220:223], v[38:41], a[56:59]
    s_waitcnt lgkmcnt(2)
    ds_read_b64_tr_b16 a[212:213], v4 offset:1024
    ds_read_b64_tr_b16 a[218:219], v5 offset:7168
    v_mfma_f32_16x16x32_bf16 a[60:63], a[224:227], v[38:41], a[60:63]
    v_fma_f32 v78, v78, s28, v12
    v_fma_f32 v65, v65, s28, v10
    v_mfma_f32_16x16x32_bf16 a[12:15], a[224:227], v[32:35], a[12:15]
    v_fma_f32 v89, v89, s28, v13
    v_fma_f32 v56, v56, s28, v9
    v_mfma_f32_16x16x32_bf16 a[8:11], a[220:223], v[32:35], a[8:11]
    v_fma_f32 v67, v67, s28, v10
    v_fma_f32 v81, v81, s28, v12
    v_mfma_f32_16x16x32_bf16 v[216:219], a[220:223], v[26:29], v[216:219]
    v_exp_f32 v53, v53
    v_mfma_f32_16x16x32_bf16 v[220:223], a[224:227], v[26:29], v[220:223]
    buffer_load_dwordx4 v6, s[12:15], s25 offen nt lds
    v_mfma_f32_16x16x32_bf16 v[172:175], a[224:227], v[20:23], v[172:175]
    ds_read_b64_tr_b16 a[214:215], v4 offset:7168
    v_fma_f32 v77, v77, s28, v12
    v_mfma_f32_16x16x32_bf16 v[168:171], a[220:223], v[20:23], v[168:171]
    v_exp_f32 v79, v79
    v_mfma_f32_16x16x32_bf16 v[120:123], a[220:223], v[14:17], v[120:123]
    v_fma_f32 v58, v58, s28, v9
    v_fma_f32 v66, v66, s28, v10
    v_mfma_f32_16x16x32_bf16 v[124:127], a[224:227], v[14:17], v[124:127]
    s_waitcnt lgkmcnt(3)
    ds_read_b64_tr_b16 a[216:217], v5 offset:1024
    v_mfma_f32_16x16x32_bf16 v[128:131], a[228:231], v[14:17], v[128:131]
    ds_read_b64_tr_b16 a[224:225], v3 offset:2048
    ds_read_b64_tr_b16 a[220:221], v2 offset:2048
    v_mfma_f32_16x16x32_bf16 v[132:135], a[232:235], v[14:17], v[132:135]
    v_exp_f32 v85, v85
    v_mfma_f32_16x16x32_bf16 v[180:183], a[232:235], v[20:23], v[180:183]
    v_fma_f32 v71, v71, s28, v11
    v_mfma_f32_16x16x32_bf16 v[176:179], a[228:231], v[20:23], v[176:179]
    ds_read_b64_tr_b16 a[222:223], v2 offset:8192
    ds_read_b128 v[96:99], v103 offset:3072
    v_mfma_f32_16x16x32_bf16 v[224:227], a[228:231], v[26:29], v[224:227]
    ds_read_b64_tr_b16 a[226:227], v3 offset:8192
    v_fma_f32 v86, v86, s28, v13
    v_mfma_f32_16x16x32_bf16 v[228:231], a[232:235], v[26:29], v[228:231]
    v_exp_f32 v73, v73
    v_mfma_f32_16x16x32_bf16 a[20:23], a[232:235], v[32:35], a[20:23]
    v_cvt_pk_bf16_f32 v18, v52, v53
    v_fma_f32 v90, v90, s28, v13
    v_mfma_f32_16x16x32_bf16 a[16:19], a[228:231], v[32:35], a[16:19]
    v_exp_f32 v81, v81
    v_mfma_f32_16x16x32_bf16 a[64:67], a[228:231], v[38:41], a[64:67]
    v_exp_f32 v54, v54
    v_mfma_f32_16x16x32_bf16 a[68:71], a[232:235], v[38:41], a[68:71]
    s_waitcnt lgkmcnt(5)
    v_mfma_f32_16x16x32_bf16 a[72:75], a[212:215], v[38:41], a[72:75]
    v_exp_f32 v70, v70
    v_mfma_f32_16x16x32_bf16 a[76:79], a[216:219], v[38:41], a[76:79]
    ds_read_b64_tr_b16 a[228:229], v4 offset:2048
    v_mfma_f32_16x16x32_bf16 a[28:31], a[216:219], v[32:35], a[28:31]
    ds_read_b64_tr_b16 a[234:235], v5 offset:8192
    ds_read_b64_tr_b16 a[232:233], v5 offset:2048
    v_mfma_f32_16x16x32_bf16 a[24:27], a[212:215], v[32:35], a[24:27]
    ds_read_b64_tr_b16 a[230:231], v4 offset:8192
    v_cvt_pk_bf16_f32 v30, v68, v69
    v_mfma_f32_16x16x32_bf16 v[232:235], a[212:215], v[26:29], v[232:235]
    v_exp_f32 v61, v61
    v_mfma_f32_16x16x32_bf16 v[236:239], a[216:219], v[26:29], v[236:239]
    v_exp_f32 v84, v84
    v_mfma_f32_16x16x32_bf16 v[188:191], a[216:219], v[20:23], v[188:191]
    v_cvt_pk_bf16_f32 v42, v84, v85
    v_mfma_f32_16x16x32_bf16 v[184:187], a[212:215], v[20:23], v[184:187]
    v_fma_f32 v57, v57, s28, v9
    v_fma_f32 v80, v80, s28, v12
    v_mfma_f32_16x16x32_bf16 v[136:139], a[212:215], v[14:17], v[136:139]
    v_exp_f32 v80, v80
    v_mfma_f32_16x16x32_bf16 v[140:143], a[216:219], v[14:17], v[140:143]
    s_waitcnt lgkmcnt(4)
    v_exp_f32 v77, v77
    v_mfma_f32_16x16x32_bf16 v[144:147], a[220:223], v[14:17], v[144:147]
    v_exp_f32 v71, v71
    v_mfma_f32_16x16x32_bf16 v[148:151], a[224:227], v[14:17], v[148:151]
    v_exp_f32 v66, v66
    v_mfma_f32_16x16x32_bf16 v[196:199], a[224:227], v[20:23], v[196:199]
    v_exp_f32 v64, v64
    v_mfma_f32_16x16x32_bf16 v[192:195], a[220:223], v[20:23], v[192:195]
    s_waitcnt vmcnt(12) lgkmcnt(0)
    v_exp_f32 v65, v65
    v_mfma_f32_16x16x32_bf16 v[240:243], a[220:223], v[26:29], v[240:243]
    v_cvt_pk_bf16_f32 v31, v70, v71
    v_mfma_f32_16x16x32_bf16 v[244:247], a[224:227], v[26:29], v[244:247]
    s_add_u32 m0, s22, 24576
    v_exp_f32 v60, v60
    v_mfma_f32_16x16x32_bf16 a[36:39], a[224:227], v[32:35], a[36:39]
    v_exp_f32 v78, v78
    v_mfma_f32_16x16x32_bf16 a[32:35], a[220:223], v[32:35], a[32:35]
    v_exp_f32 v86, v86
    v_mfma_f32_16x16x32_bf16 a[80:83], a[220:223], v[38:41], a[80:83]
    v_exp_f32 v67, v67
    v_mfma_f32_16x16x32_bf16 a[84:87], a[224:227], v[38:41], a[84:87]
    s_barrier
    ds_read_b128 a[212:215], v0 offset:0
    v_mfma_f32_16x16x32_bf16 a[88:91], a[228:231], v[38:41], a[88:91]
    buffer_load_dwordx4 v6, s[8:11], s21 offen lds
    ds_read_b128 a[216:219], v1 offset:0
    v_mfma_f32_16x16x32_bf16 a[92:95], a[232:235], v[38:41], a[92:95]
    s_add_u32 s21, s21, 128
    ds_read_b128 a[220:223], v0 offset:1024
    s_add_u32 m0, s22, 25600
    v_mfma_f32_16x16x32_bf16 a[44:47], a[232:235], v[32:35], a[44:47]
    v_exp_f32 v87, v87
    v_mfma_f32_16x16x32_bf16 a[40:43], a[228:231], v[32:35], a[40:43]
    buffer_load_dwordx4 v6, s[8:11], s21 offen lds
    v_mfma_f32_16x16x32_bf16 v[248:251], a[228:231], v[26:29], v[248:251]
    s_add_u32 s21, s21, 128
    v_exp_f32 v56, v56
    v_mfma_f32_16x16x32_bf16 v[252:255], a[232:235], v[26:29], v[252:255]
    s_add_u32 m0, s22, 26624
    v_exp_f32 v83, v83
    v_mfma_f32_16x16x32_bf16 v[204:207], a[232:235], v[20:23], v[204:207]
    buffer_load_dwordx4 v6, s[8:11], s21 offen lds
    v_mfma_f32_16x16x32_bf16 v[200:203], a[228:231], v[20:23], v[200:203]
    s_add_u32 s21, s21, 12032
    ds_read_b128 a[224:227], v1 offset:1024
    v_fma_f32 v74, v74, s28, v11
    v_mfma_f32_16x16x32_bf16 v[152:155], a[228:231], v[14:17], v[152:155]
    v_cvt_pk_bf16_f32 v19, v54, v55
    v_cvt_pk_bf16_f32 v36, v76, v77
    v_mfma_f32_16x16x32_bf16 v[156:159], a[232:235], v[14:17], v[156:159]
    s_waitcnt lgkmcnt(3)
    v_fma_f32 v82, v82, s28, v12
    v_cvt_pk_bf16_f32 v43, v86, v87
    v_mfma_f32_16x16x32_bf16 v[52:55], a[212:215], a[96:99], 0
    s_waitcnt lgkmcnt(2)
    v_cvt_pk_bf16_f32 v24, v60, v61
    v_cvt_pk_bf16_f32 v37, v78, v79
    v_mfma_f32_16x16x32_bf16 v[52:55], a[216:219], a[100:103], v[52:55]
    s_waitcnt lgkmcnt(1)
    v_add_u32 v103, 4096, v103
    v_fma_f32 v72, v72, s28, v11
    v_mfma_f32_16x16x32_bf16 v[52:55], a[220:223], a[104:107], v[52:55]
    ds_read_b128 a[232:235], v1 offset:2048
    v_mfma_f32_16x16x32_bf16 v[60:63], a[220:223], a[128:131], 0
    v_exp_f32 v72, v72
    v_mfma_f32_16x16x32_bf16 v[60:63], a[216:219], a[124:127], v[60:63]
    ds_read_b128 a[228:231], v0 offset:2048
    v_mfma_f32_16x16x32_bf16 v[60:63], a[212:215], a[120:123], v[60:63]
    buffer_store_dwordx4 v[96:99], v7, s[16:19], s24 offen offset:0 nt
    v_cvt_pk_bf16_f32 v23, v66, v67
    v_fma_f32 v59, v59, s28, v9
    v_mfma_f32_16x16x32_bf16 v[68:71], a[212:215], a[144:147], 0
    v_exp_f32 v82, v82
    v_mfma_f32_16x16x32_bf16 v[68:71], a[216:219], a[148:151], v[68:71]
    v_cvt_pk_bf16_f32 v22, v64, v65
    v_mfma_f32_16x16x32_bf16 v[68:71], a[220:223], a[152:155], v[68:71]
    v_exp_f32 v57, v57
    v_mfma_f32_16x16x32_bf16 v[76:79], a[220:223], a[176:179], 0
    v_fma_f32 v88, v88, s28, v13
    v_cvt_pk_bf16_f32 v35, v82, v83
    v_mfma_f32_16x16x32_bf16 v[76:79], a[216:219], a[172:175], v[76:79]
    s_add_u32 m0, s23, 3072
    v_exp_f32 v91, v91
    v_mfma_f32_16x16x32_bf16 v[76:79], a[212:215], a[168:171], v[76:79]
    v_exp_f32 v90, v90
    v_mfma_f32_16x16x32_bf16 v[84:87], a[212:215], a[192:195], 0
    v_cvt_pk_bf16_f32 v28, v72, v73
    v_mfma_f32_16x16x32_bf16 v[84:87], a[216:219], a[196:199], v[84:87]
    v_exp_f32 v75, v75
    v_mfma_f32_16x16x32_bf16 v[84:87], a[220:223], a[200:203], v[84:87]
    s_waitcnt lgkmcnt(0)
    v_exp_f32 v58, v58
    v_mfma_f32_16x16x32_bf16 v[84:87], a[224:227], a[204:207], v[84:87]
    buffer_load_dwordx4 v7, s[12:15], s25 offen nt lds
    v_mfma_f32_16x16x32_bf16 v[84:87], a[228:231], a[208:211], v[84:87]
    v_exp_f32 v89, v89
    v_mfma_f32_16x16x32_bf16 v[84:87], a[232:235], v[92:95], v[84:87]
    v_exp_f32 v88, v88
    v_mfma_f32_16x16x32_bf16 v[76:79], a[232:235], a[188:191], v[76:79]
    v_mfma_f32_16x16x32_bf16 v[76:79], a[228:231], a[184:187], v[76:79]
    v_exp_f32 v74, v74
    v_mfma_f32_16x16x32_bf16 v[76:79], a[224:227], a[180:183], v[76:79]
    v_exp_f32 v59, v59
    v_mfma_f32_16x16x32_bf16 v[68:71], a[224:227], a[156:159], v[68:71]
    v_mfma_f32_16x16x32_bf16 v[68:71], a[228:231], a[160:163], v[68:71]
    ds_read_b128 a[212:215], v0 offset:6144
    v_cvt_pk_bf16_f32 v16, v56, v57
    v_mfma_f32_16x16x32_bf16 v[68:71], a[232:235], a[164:167], v[68:71]
    ds_read_b128 a[216:219], v1 offset:6144
    v_mfma_f32_16x16x32_bf16 v[60:63], a[232:235], a[140:143], v[60:63]
    ds_read_b128 a[220:223], v0 offset:7168
    v_cvt_pk_bf16_f32 v29, v74, v75
    v_mfma_f32_16x16x32_bf16 v[60:63], a[228:231], a[136:139], v[60:63]
    v_mfma_f32_16x16x32_bf16 v[60:63], a[224:227], a[132:135], v[60:63]
    v_cvt_pk_bf16_f32 v17, v58, v59
    v_cvt_pk_bf16_f32 v40, v88, v89
    v_mfma_f32_16x16x32_bf16 v[52:55], a[224:227], a[108:111], v[52:55]
    v_cvt_pk_bf16_f32 v41, v90, v91
    v_mfma_f32_16x16x32_bf16 v[52:55], a[228:231], a[112:115], v[52:55]
    ds_read_b128 a[228:231], v0 offset:8192
    v_cvt_pk_bf16_f32 v34, v80, v81
    v_mfma_f32_16x16x32_bf16 v[48:51], a[236:239], v[16:19], v[44:47]
    ds_read_b128 a[224:227], v1 offset:7168
    v_mfma_f32_16x16x32_bf16 v[52:55], a[232:235], a[116:119], v[52:55]
    ds_read_b128 a[232:235], v1 offset:8192
    v_mfma_f32_16x16x32_bf16 v[48:51], a[240:243], v[22:25], v[48:51]
    v_mfma_f32_16x16x32_bf16 v[48:51], a[244:247], v[28:31], v[48:51]
    v_mfma_f32_16x16x32_bf16 v[48:51], a[248:251], v[34:37], v[48:51]
    s_bitcmp1_b32 s27, 0
    v_mfma_f32_16x16x32_bf16 v[48:51], a[252:255], v[40:43], v[48:51]
    s_cselect_b32 s26, s49, 128
    s_waitcnt lgkmcnt(3)
    v_mfma_f32_16x16x32_bf16 v[56:59], a[212:215], a[96:99], 0
    s_lshr_b32 s27, s27, 1
    s_add_u32 s24, s24, s26
    v_mfma_f32_16x16x32_bf16 v[56:59], a[216:219], a[100:103], v[56:59]
    s_nop 1
    v_cmp_lt_f32 vcc, s29, v48
    v_mfma_f32_16x16x32_bf16 v[56:59], a[220:223], a[104:107], v[56:59]
    s_add_u32 s25, s25, s26
    s_add_u32 s23, s23, 4096
    v_mfma_f32_16x16x32_bf16 v[64:67], a[220:223], a[128:131], 0
    s_nop 0
    s_cbranch_vccnz L_rs_loop5w0b
L_ret_loop5w0b:
    v_mfma_f32_16x16x32_bf16 v[64:67], a[216:219], a[124:127], v[64:67]
    v_fma_f32 v53, v53, s28, v9
    v_fma_f32 v52, v52, s28, v9
    v_mfma_f32_16x16x32_bf16 v[64:67], a[212:215], a[120:123], v[64:67]
    v_exp_f32 v52, v52
    v_mfma_f32_16x16x32_bf16 v[72:75], a[212:215], a[144:147], 0
    s_waitcnt vmcnt(12) lgkmcnt(0)
    v_exp_f32 v53, v53
    v_mfma_f32_16x16x32_bf16 v[72:75], a[216:219], a[148:151], v[72:75]
    s_cmp_eq_u32 s30, 5
    s_cselect_b32 s26, s62, 0
    v_fma_f32 v62, v62, s28, v10
    v_mfma_f32_16x16x32_bf16 v[72:75], a[220:223], a[152:155], v[72:75]
    s_add_u32 s20, s20, s26
    v_fma_f32 v55, v55, s28, v9
    s_add_u32 m0, s22, 0
    v_mfma_f32_16x16x32_bf16 v[80:83], a[220:223], a[176:179], 0
    s_barrier
    v_mfma_f32_16x16x32_bf16 v[80:83], a[216:219], a[172:175], v[80:83]
    buffer_load_dwordx4 v6, s[4:7], s20 offen lds
    v_mfma_f32_16x16x32_bf16 v[80:83], a[212:215], a[168:171], v[80:83]
    s_add_u32 s20, s20, 128
    s_add_u32 m0, s22, 1024
    v_mfma_f32_16x16x32_bf16 v[88:91], a[212:215], a[192:195], 0
    buffer_load_dwordx4 v6, s[4:7], s20 offen lds
    v_mfma_f32_16x16x32_bf16 v[88:91], a[216:219], a[196:199], v[88:91]
    s_add_u32 s20, s20, 128
    ds_read_b64_tr_b16 a[212:213], v2 offset:18432
    ds_read_b64_tr_b16 a[214:215], v2 offset:12288
    v_mfma_f32_16x16x32_bf16 v[88:91], a[220:223], a[200:203], v[88:91]
    s_add_u32 m0, s22, 2048
    ds_read_b64_tr_b16 a[216:217], v3 offset:18432
    v_mfma_f32_16x16x32_bf16 v[88:91], a[224:227], a[204:207], v[88:91]
    buffer_load_dwordx4 v6, s[4:7], s20 offen lds
    v_mfma_f32_16x16x32_bf16 v[88:91], a[228:231], a[208:211], v[88:91]
    ds_read_b64_tr_b16 a[218:219], v3 offset:12288
    v_fma_f32 v54, v54, s28, v9
    v_mfma_f32_16x16x32_bf16 v[88:91], a[232:235], v[92:95], v[88:91]
    v_fma_f32 v63, v63, s28, v10
    v_cvt_pk_bf16_f32 v14, v52, v53
    v_mfma_f32_16x16x32_bf16 v[80:83], a[232:235], a[188:191], v[80:83]
    ds_read_b64_tr_b16 a[220:221], v4 offset:18432
    ds_read_b64_tr_b16 a[222:223], v4 offset:12288
    v_mfma_f32_16x16x32_bf16 v[80:83], a[228:231], a[184:187], v[80:83]
    v_exp_f32 v62, v62
    v_mfma_f32_16x16x32_bf16 v[80:83], a[224:227], a[180:183], v[80:83]
    v_exp_f32 v54, v54
    v_mfma_f32_16x16x32_bf16 v[72:75], a[224:227], a[156:159], v[72:75]
    s_add_u32 s20, s20, 12032
    v_fma_f32 v61, v61, s28, v10
    v_fma_f32 v60, v60, s28, v10
    v_mfma_f32_16x16x32_bf16 v[72:75], a[228:231], a[160:163], v[72:75]
    v_exp_f32 v55, v55
    v_mfma_f32_16x16x32_bf16 v[72:75], a[232:235], a[164:167], v[72:75]
    v_exp_f32 v61, v61
    v_mfma_f32_16x16x32_bf16 v[64:67], a[232:235], a[140:143], v[64:67]
    v_exp_f32 v63, v63
    v_mfma_f32_16x16x32_bf16 v[64:67], a[228:231], a[136:139], v[64:67]
    s_add_u32 s30, s30, 1
    v_cvt_pk_bf16_f32 v15, v54, v55
    s_cmp_lt_u32 s30, 6
    v_mfma_f32_16x16x32_bf16 v[64:67], a[224:227], a[132:135], v[64:67]
    v_exp_f32 v60, v60
    v_mfma_f32_16x16x32_bf16 v[56:59], a[224:227], a[108:111], v[56:59]
    s_waitcnt lgkmcnt(2)
    ds_read_b64_tr_b16 a[224:225], v5 offset:18432
    v_cvt_pk_bf16_f32 v20, v60, v61
    v_mfma_f32_16x16x32_bf16 v[56:59], a[228:231], a[112:115], v[56:59]
    ds_read_b64_tr_b16 a[226:227], v5 offset:12288
    v_cvt_pk_bf16_f32 v21, v62, v63
    v_mfma_f32_16x16x32_bf16 v[56:59], a[232:235], a[116:119], v[56:59]
    s_cbranch_scc1 L_loop5w0
    s_cmp_ge_u32 s37, 6
    s_cbranch_scc1 L_end5
    s_cmp_eq_u32 s32, 0
    s_cbranch_scc1 L_tr54
    s_branch L_tr55
    .p2align 6
L_loop5w1:
    v_mfma_f32_16x16x32_bf16 v[112:115], a[212:215], v[16:19], v[112:115]
    ds_read_b128 v[96:99], v103 offset:0
    ds_read_b64_tr_b16 a[234:235], v3 offset:13312
    v_mfma_f32_16x16x32_bf16 v[116:119], a[216:219], v[16:19], v[116:119]
    v_fma_f32 v71, v71, s28, v11
    v_fma_f32 v82, v82, s28, v12
    v_fma_f32 v57, v57, s28, v9
    v_mfma_f32_16x16x32_bf16 v[164:167], a[216:219], v[22:25], v[164:167]
    v_fma_f32 v87, v87, s28, v13
    v_fma_f32 v73, v73, s28, v11
    v_mfma_f32_16x16x32_bf16 v[160:163], a[212:215], v[22:25], v[160:163]
    ds_read_b64_tr_b16 a[230:231], v2 offset:13312
    v_mfma_f32_16x16x32_bf16 v[208:211], a[212:215], v[28:31], v[208:211]
    v_fma_f32 v76, v76, s28, v12
    v_fma_f32 v80, v80, s28, v12
    v_mfma_f32_16x16x32_bf16 v[212:215], a[216:219], v[28:31], v[212:215]
    v_exp_f32 v71, v71
    v_mfma_f32_16x16x32_bf16 a[4:7], a[216:219], v[34:37], a[4:7]
    v_fma_f32 v65, v65, s28, v10
    v_mfma_f32_16x16x32_bf16 a[0:3], a[212:215], v[34:37], a[0:3]
    v_fma_f32 v77, v77, s28, v12
    v_fma_f32 v66, v66, s28, v10
    v_mfma_f32_16x16x32_bf16 a[48:51], a[212:215], v[40:43], a[48:51]
    ds_read_b64_tr_b16 a[228:229], v2 offset:19456
    v_mfma_f32_16x16x32_bf16 a[52:55], a[216:219], v[40:43], a[52:55]
    s_add_u32 s39, s39, 12288
    v_fma_f32 v58, v58, s28, v9
    s_waitcnt lgkmcnt(3)
    v_mfma_f32_16x16x32_bf16 a[56:59], a[220:223], v[40:43], a[56:59]
    buffer_store_dwordx4 v[96:99], v6, s[16:19], s24 offen offset:0 nt
    ds_read_b64_tr_b16 a[214:215], v4 offset:13312
    ds_read_b64_tr_b16 a[212:213], v4 offset:19456
    ds_read_b64_tr_b16 a[232:233], v3 offset:19456
    v_mfma_f32_16x16x32_bf16 a[60:63], a[224:227], v[40:43], a[60:63]
    v_fma_f32 v83, v83, s28, v12
    v_fma_f32 v85, v85, s28, v13
    v_mfma_f32_16x16x32_bf16 a[12:15], a[224:227], v[34:37], a[12:15]
    v_exp_f32 v77, v77
    v_mfma_f32_16x16x32_bf16 a[8:11], a[220:223], v[34:37], a[8:11]
    ds_read_b64_tr_b16 a[216:217], v5 offset:19456
    v_mfma_f32_16x16x32_bf16 v[216:219], a[220:223], v[28:31], v[216:219]
    v_fma_f32 v59, v59, s28, v9
    v_mfma_f32_16x16x32_bf16 v[220:223], a[224:227], v[28:31], v[220:223]
    v_fma_f32 v70, v70, s28, v11
    v_mfma_f32_16x16x32_bf16 v[172:175], a[224:227], v[22:25], v[172:175]
    s_add_u32 m0, s23, 0
    v_fma_f32 v69, v69, s28, v11
    v_mfma_f32_16x16x32_bf16 v[168:171], a[220:223], v[22:25], v[168:171]
    ds_read_b64_tr_b16 a[218:219], v5 offset:13312
    v_mfma_f32_16x16x32_bf16 v[120:123], a[220:223], v[16:19], v[120:123]
    buffer_load_dwordx4 v6, s[12:15], s25 offen nt lds
    v_mfma_f32_16x16x32_bf16 v[124:127], a[224:227], v[16:19], v[124:127]
    s_waitcnt lgkmcnt(5)
    v_fma_f32 v81, v81, s28, v12
    v_fma_f32 v84, v84, s28, v13
    v_mfma_f32_16x16x32_bf16 v[128:131], a[228:231], v[16:19], v[128:131]
    s_waitcnt lgkmcnt(2)
    v_fma_f32 v67, v67, s28, v10
    v_fma_f32 v56, v56, s28, v9
    v_mfma_f32_16x16x32_bf16 v[132:135], a[232:235], v[16:19], v[132:135]
    v_mfma_f32_16x16x32_bf16 v[180:183], a[232:235], v[22:25], v[180:183]
    ds_read_b64_tr_b16 a[226:227], v3 offset:14336
    ds_read_b64_tr_b16 a[220:221], v2 offset:20480
    v_mfma_f32_16x16x32_bf16 v[176:179], a[228:231], v[22:25], v[176:179]
    v_exp_f32 v82, v82
    v_mfma_f32_16x16x32_bf16 v[224:227], a[228:231], v[28:31], v[224:227]
    v_exp_f32 v69, v69
    v_mfma_f32_16x16x32_bf16 v[228:231], a[232:235], v[28:31], v[228:231]
    v_exp_f32 v56, v56
    v_mfma_f32_16x16x32_bf16 a[20:23], a[232:235], v[34:37], a[20:23]
    v_fma_f32 v68, v68, s28, v11
    v_fma_f32 v86, v86, s28, v13
    v_mfma_f32_16x16x32_bf16 a[16:19], a[228:231], v[34:37], a[16:19]
    v_fma_f32 v79, v79, s28, v12
    v_fma_f32 v78, v78, s28, v12
    v_mfma_f32_16x16x32_bf16 a[64:67], a[228:231], v[40:43], a[64:67]
    ds_read_b64_tr_b16 a[224:225], v3 offset:20480
    ds_read_b64_tr_b16 a[222:223], v2 offset:14336
    v_mfma_f32_16x16x32_bf16 a[68:71], a[232:235], v[40:43], a[68:71]
    ds_read_b64_tr_b16 a[234:235], v5 offset:14336
    v_fma_f32 v89, v89, s28, v13
    v_mfma_f32_16x16x32_bf16 a[72:75], a[212:215], v[40:43], a[72:75]
    s_waitcnt lgkmcnt(5)
    ds_read_b128 v[96:99], v103 offset:1024
    v_fma_f32 v91, v91, s28, v13
    v_mfma_f32_16x16x32_bf16 a[76:79], a[216:219], v[40:43], a[76:79]
    ds_read_b64_tr_b16 a[232:233], v5 offset:20480
    ds_read_b64_tr_b16 a[228:229], v4 offset:20480
    v_mfma_f32_16x16x32_bf16 a[28:31], a[216:219], v[34:37], a[28:31]
    ds_read_b64_tr_b16 a[230:231], v4 offset:14336
    v_mfma_f32_16x16x32_bf16 a[24:27], a[212:215], v[34:37], a[24:27]
    v_fma_f32 v90, v90, s28, v13
    v_mfma_f32_16x16x32_bf16 v[232:235], a[212:215], v[28:31], v[232:235]
    v_exp_f32 v70, v70
    v_mfma_f32_16x16x32_bf16 v[236:239], a[216:219], v[28:31], v[236:239]
    v_exp_f32 v81, v81
    v_mfma_f32_16x16x32_bf16 v[188:191], a[216:219], v[22:25], v[188:191]
    v_exp_f32 v91, v91
    v_mfma_f32_16x16x32_bf16 v[184:187], a[212:215], v[22:25], v[184:187]
    v_exp_f32 v84, v84
    v_mfma_f32_16x16x32_bf16 v[136:139], a[212:215], v[16:19], v[136:139]
    v_fma_f32 v88, v88, s28, v13
    v_fma_f32 v75, v75, s28, v11
    v_mfma_f32_16x16x32_bf16 v[140:143], a[216:219], v[16:19], v[140:143]
    s_waitcnt lgkmcnt(4)
    v_exp_f32 v86, v86
    v_mfma_f32_16x16x32_bf16 v[144:147], a[220:223], v[16:19], v[144:147]
    v_exp_f32 v85, v85
    v_mfma_f32_16x16x32_bf16 v[148:151], a[224:227], v[16:19], v[148:151]
    v_exp_f32 v68, v68
    v_mfma_f32_16x16x32_bf16 v[196:199], a[224:227], v[22:25], v[196:199]
    s_waitcnt vmcnt(12) lgkmcnt(0)
    v_fma_f32 v74, v74, s28, v11
    v_mfma_f32_16x16x32_bf16 v[192:195], a[220:223], v[22:25], v[192:195]
    v_exp_f32 v87, v87
    v_mfma_f32_16x16x32_bf16 v[240:243], a[220:223], v[28:31], v[240:243]
    v_exp_f32 v79, v79
    v_mfma_f32_16x16x32_bf16 v[244:247], a[224:227], v[28:31], v[244:247]
    s_barrier
    v_mfma_f32_16x16x32_bf16 a[36:39], a[224:227], v[34:37], a[36:39]
    v_exp_f32 v78, v78
    v_mfma_f32_16x16x32_bf16 a[32:35], a[220:223], v[34:37], a[32:35]
    v_exp_f32 v88, v88
    v_mfma_f32_16x16x32_bf16 a[80:83], a[220:223], v[40:43], a[80:83]
    ds_read_b128 a[212:215], v0 offset:12288
    v_cvt_pk_bf16_f32 v27, v70, v71
    v_mfma_f32_16x16x32_bf16 a[84:87], a[224:227], v[40:43], a[84:87]
    ds_read_b128 a[216:219], v1 offset:12288
    v_cvt_pk_bf16_f32 v38, v84, v85
    v_mfma_f32_16x16x32_bf16 a[88:91], a[228:231], v[40:43], a[88:91]
    s_add_u32 m0, s22, 36864
    ds_read_b128 a[220:223], v0 offset:13312
    v_fma_f32 v64, v64, s28, v10
    v_mfma_f32_16x16x32_bf16 a[92:95], a[232:235], v[40:43], a[92:95]
    buffer_load_dwordx4 v6, s[8:11], s21 offen lds
    v_mfma_f32_16x16x32_bf16 a[44:47], a[232:235], v[34:37], a[44:47]
    s_add_u32 s21, s21, 128
    v_exp_f32 v74, v74
    v_mfma_f32_16x16x32_bf16 a[40:43], a[228:231], v[34:37], a[40:43]
    v_exp_f32 v75, v75
    v_mfma_f32_16x16x32_bf16 v[248:251], a[228:231], v[28:31], v[248:251]
    s_add_u32 m0, s22, 37888
    v_exp_f32 v67, v67
    v_mfma_f32_16x16x32_bf16 v[252:255], a[232:235], v[28:31], v[252:255]
    buffer_load_dwordx4 v6, s[8:11], s21 offen lds
    v_mfma_f32_16x16x32_bf16 v[204:207], a[232:235], v[22:25], v[204:207]
    s_add_u32 s21, s21, 128
    v_exp_f32 v80, v80
    v_mfma_f32_16x16x32_bf16 v[200:203], a[228:231], v[22:25], v[200:203]
    v_cvt_pk_bf16_f32 v33, v78, v79
    s_add_u32 m0, s22, 38912
    v_mfma_f32_16x16x32_bf16 v[152:155], a[228:231], v[16:19], v[152:155]
    buffer_load_dwordx4 v6, s[8:11], s21 offen lds
    v_mfma_f32_16x16x32_bf16 v[156:159], a[232:235], v[16:19], v[156:159]
    s_waitcnt lgkmcnt(1)
    v_exp_f32 v76, v76
    v_mfma_f32_16x16x32_bf16 v[52:55], a[212:215], a[96:99], 0
    v_mfma_f32_16x16x32_bf16 v[52:55], a[216:219], a[100:103], v[52:55]
    s_waitcnt lgkmcnt(0)
    ds_read_b128 a[228:231], v0 offset:14336
    v_cvt_pk_bf16_f32 v26, v68, v69
    v_mfma_f32_16x16x32_bf16 v[52:55], a[220:223], a[104:107], v[52:55]
    v_exp_f32 v73, v73
    v_mfma_f32_16x16x32_bf16 v[60:63], a[220:223], a[128:131], 0
    v_cvt_pk_bf16_f32 v32, v76, v77
    s_add_u32 s21, s21, 12032
    v_mfma_f32_16x16x32_bf16 v[60:63], a[216:219], a[124:127], v[60:63]
    ds_read_b128 a[224:227], v1 offset:13312
    v_fma_f32 v72, v72, s28, v11
    v_mfma_f32_16x16x32_bf16 v[60:63], a[212:215], a[120:123], v[60:63]
    v_exp_f32 v58, v58
    v_mfma_f32_16x16x32_bf16 v[68:71], a[212:215], a[144:147], 0
    ds_read_b128 a[232:235], v1 offset:14336
    v_mfma_f32_16x16x32_bf16 v[68:71], a[216:219], a[148:151], v[68:71]
    buffer_store_dwordx4 v[96:99], v7, s[16:19], s24 offen offset:0 nt
    v_exp_f32 v64, v64
    v_mfma_f32_16x16x32_bf16 v[68:71], a[220:223], a[152:155], v[68:71]
    v_cvt_pk_bf16_f32 v39, v86, v87
    v_mfma_f32_16x16x32_bf16 v[76:79], a[220:223], a[176:179], 0
    v_exp_f32 v72, v72
    v_mfma_f32_16x16x32_bf16 v[76:79], a[216:219], a[172:175], v[76:79]
    v_exp_f32 v65, v65
    v_mfma_f32_16x16x32_bf16 v[76:79], a[212:215], a[168:171], v[76:79]
    v_exp_f32 v57, v57
    v_mfma_f32_16x16x32_bf16 v[84:87], a[212:215], a[192:195], 0
    s_add_u32 m0, s23, 1024
    ds_read_b128 a[212:215], v0 offset:18432
    v_mfma_f32_16x16x32_bf16 v[84:87], a[216:219], a[196:199], v[84:87]
    ds_read_b128 a[216:219], v1 offset:18432
    v_cvt_pk_bf16_f32 v16, v56, v57
    v_mfma_f32_16x16x32_bf16 v[84:87], a[220:223], a[200:203], v[84:87]
    s_waitcnt lgkmcnt(3)
    v_exp_f32 v83, v83
    v_mfma_f32_16x16x32_bf16 v[84:87], a[224:227], a[204:207], v[84:87]
    v_mfma_f32_16x16x32_bf16 v[84:87], a[228:231], a[208:211], v[84:87]
    s_waitcnt lgkmcnt(2)
    v_exp_f32 v90, v90
    v_mfma_f32_16x16x32_bf16 v[84:87], a[232:235], v[92:95], v[84:87]
    buffer_load_dwordx4 v7, s[12:15], s25 offen nt lds
    v_mfma_f32_16x16x32_bf16 v[76:79], a[232:235], a[188:191], v[76:79]
    v_exp_f32 v66, v66
    v_mfma_f32_16x16x32_bf16 v[76:79], a[228:231], a[184:187], v[76:79]
    v_mfma_f32_16x16x32_bf16 v[76:79], a[224:227], a[180:183], v[76:79]
    v_cvt_pk_bf16_f32 v34, v80, v81
    v_mfma_f32_16x16x32_bf16 v[68:71], a[224:227], a[156:159], v[68:71]
    ds_read_b128 a[220:223], v0 offset:19456
    v_mfma_f32_16x16x32_bf16 v[68:71], a[228:231], a[160:163], v[68:71]
    v_mfma_f32_16x16x32_bf16 v[68:71], a[232:235], a[164:167], v[68:71]
    v_mfma_f32_16x16x32_bf16 v[60:63], a[232:235], a[140:143], v[60:63]
    s_bitcmp1_b32 s27, 0
    v_cvt_pk_bf16_f32 v23, v66, v67
    v_mfma_f32_16x16x32_bf16 v[60:63], a[228:231], a[136:139], v[60:63]
    v_exp_f32 v89, v89
    v_mfma_f32_16x16x32_bf16 v[60:63], a[224:227], a[132:135], v[60:63]
    v_exp_f32 v59, v59
    v_mfma_f32_16x16x32_bf16 v[52:55], a[224:227], a[108:111], v[52:55]
    v_cvt_pk_bf16_f32 v41, v90, v91
    v_cvt_pk_bf16_f32 v29, v74, v75
    v_mfma_f32_16x16x32_bf16 v[52:55], a[228:231], a[112:115], v[52:55]
    v_cvt_pk_bf16_f32 v22, v64, v65
    v_cvt_pk_bf16_f32 v17, v58, v59
    v_mfma_f32_16x16x32_bf16 v[52:55], a[232:235], a[116:119], v[52:55]
    s_cselect_b32 s26, s49, 128
    ds_read_b128 a[228:231], v0 offset:20480
    ds_read_b128 a[224:227], v1 offset:19456
    v_mfma_f32_16x16x32_bf16 v[44:47], a[236:239], v[14:17], v[48:51]
    s_waitcnt lgkmcnt(3)
    ds_read_b128 a[232:235], v1 offset:20480
    v_cvt_pk_bf16_f32 v28, v72, v73
    v_mfma_f32_16x16x32_bf16 v[56:59], a[212:215], a[96:99], 0
    v_cvt_pk_bf16_f32 v40, v88, v89
    s_lshr_b32 s27, s27, 1
    v_mfma_f32_16x16x32_bf16 v[44:47], a[240:243], v[20:23], v[44:47]
    v_cvt_pk_bf16_f32 v35, v82, v83
    v_mfma_f32_16x16x32_bf16 v[44:47], a[244:247], v[26:29], v[44:47]
    s_nop 0
    v_mfma_f32_16x16x32_bf16 v[44:47], a[248:251], v[32:35], v[44:47]
    v_mfma_f32_16x16x32_bf16 v[44:47], a[252:255], v[38:41], v[44:47]
    v_mfma_f32_16x16x32_bf16 v[56:59], a[216:219], a[100:103], v[56:59]
    s_add_u32 s24, s24, s26
    s_waitcnt lgkmcnt(3)
    v_mfma_f32_16x16x32_bf16 v[56:59], a[220:223], a[104:107], v[56:59]
    ds_read_b128 v[96:99], v103 offset:2048
    v_mfma_f32_16x16x32_bf16 v[64:67], a[220:223], a[128:131], 0
    s_nop 1
    v_cmp_lt_f32 vcc, s29, v44
    v_mfma_f32_16x16x32_bf16 v[64:67], a[216:219], a[124:127], v[64:67]
    s_add_u32 s25, s25, s26
    s_waitcnt vmcnt(12) lgkmcnt(1)
    v_mfma_f32_16x16x32_bf16 v[64:67], a[212:215], a[120:123], v[64:67]
    s_barrier
    v_mfma_f32_16x16x32_bf16 v[72:75], a[212:215], a[144:147], 0
    s_cbranch_vccnz L_rs_loop5w1a
L_ret_loop5w1a:
    v_fma_f32 v54, v54, s28, v9
    v_mfma_f32_16x16x32_bf16 v[72:75], a[216:219], a[148:151], v[72:75]
    v_fma_f32 v61, v61, s28, v10
    v_fma_f32 v84, v84, s28, v13
    v_mfma_f32_16x16x32_bf16 v[72:75], a[220:223], a[152:155], v[72:75]
    s_add_u32 m0, s22, 12288
    v_fma_f32 v71, v71, s28, v11
    v_fma_f32 v77, v77, s28, v12
    v_mfma_f32_16x16x32_bf16 v[80:83], a[220:223], a[176:179], 0
    buffer_load_dwordx4 v6, s[4:7], s20 offen lds
    v_mfma_f32_16x16x32_bf16 v[80:83], a[216:219], a[172:175], v[80:83]
    v_exp_f32 v54, v54
    v_mfma_f32_16x16x32_bf16 v[80:83], a[212:215], a[168:171], v[80:83]
    s_add_u32 s20, s20, 128
    v_fma_f32 v85, v85, s28, v13
    v_mfma_f32_16x16x32_bf16 v[88:91], a[212:215], a[192:195], 0
    v_fma_f32 v62, v62, s28, v10
    v_mfma_f32_16x16x32_bf16 v[88:91], a[216:219], a[196:199], v[88:91]
    s_add_u32 m0, s22, 13312
    ds_read_b64_tr_b16 a[212:213], v2 offset:0
    ds_read_b64_tr_b16 a[214:215], v2 offset:6144
    v_mfma_f32_16x16x32_bf16 v[88:91], a[220:223], a[200:203], v[88:91]
    buffer_load_dwordx4 v6, s[4:7], s20 offen lds
    v_mfma_f32_16x16x32_bf16 v[88:91], a[224:227], a[204:207], v[88:91]
    v_fma_f32 v63, v63, s28, v10
    v_mfma_f32_16x16x32_bf16 v[88:91], a[228:231], a[208:211], v[88:91]
    s_add_u32 s20, s20, 128
    ds_read_b64_tr_b16 a[216:217], v3 offset:0
    s_add_u32 m0, s22, 14336
    v_mfma_f32_16x16x32_bf16 v[88:91], a[232:235], v[92:95], v[88:91]
    buffer_load_dwordx4 v6, s[4:7], s20 offen lds
    v_mfma_f32_16x16x32_bf16 v[80:83], a[232:235], a[188:191], v[80:83]
    v_fma_f32 v69, v69, s28, v11
    v_mfma_f32_16x16x32_bf16 v[80:83], a[228:231], a[184:187], v[80:83]
    ds_read_b64_tr_b16 a[218:219], v3 offset:6144
    v_fma_f32 v86, v86, s28, v13
    v_mfma_f32_16x16x32_bf16 v[80:83], a[224:227], a[180:183], v[80:83]
    v_exp_f32 v62, v62
    v_mfma_f32_16x16x32_bf16 v[72:75], a[224:227], a[156:159], v[72:75]
    v_fma_f32 v87, v87, s28, v13
    v_fma_f32 v70, v70, s28, v11
    v_mfma_f32_16x16x32_bf16 v[72:75], a[228:231], a[160:163], v[72:75]
    v_fma_f32 v79, v79, s28, v12
    v_fma_f32 v53, v53, s28, v9
    v_mfma_f32_16x16x32_bf16 v[72:75], a[232:235], a[164:167], v[72:75]
    v_exp_f32 v84, v84
    v_mfma_f32_16x16x32_bf16 v[64:67], a[232:235], a[140:143], v[64:67]
    ds_read_b64_tr_b16 a[220:221], v4 offset:0
    v_fma_f32 v83, v83, s28, v12
    v_mfma_f32_16x16x32_bf16 v[64:67], a[228:231], a[136:139], v[64:67]
    v_exp_f32 v69, v69
    v_mfma_f32_16x16x32_bf16 v[64:67], a[224:227], a[132:135], v[64:67]
    v_fma_f32 v88, v88, s28, v13
    v_fma_f32 v75, v75, s28, v11
    v_mfma_f32_16x16x32_bf16 v[56:59], a[224:227], a[108:111], v[56:59]
    v_fma_f32 v80, v80, s28, v12
    v_fma_f32 v60, v60, s28, v10
    v_mfma_f32_16x16x32_bf16 v[56:59], a[228:231], a[112:115], v[56:59]
    ds_read_b64_tr_b16 a[230:231], v2 offset:7168
    ds_read_b64_tr_b16 a[222:223], v4 offset:6144
    v_mfma_f32_16x16x32_bf16 v[56:59], a[232:235], a[116:119], v[56:59]
    s_waitcnt lgkmcnt(3)
    v_exp_f32 v63, v63
    v_mfma_f32_16x16x32_bf16 v[112:115], a[212:215], v[14:17], v[112:115]
    ds_read_b64_tr_b16 a[224:225], v5 offset:0
    ds_read_b64_tr_b16 a[226:227], v5 offset:6144
    v_mfma_f32_16x16x32_bf16 v[116:119], a[216:219], v[14:17], v[116:119]
    v_exp_f32 v77, v77
    v_mfma_f32_16x16x32_bf16 v[164:167], a[216:219], v[20:23], v[164:167]
    s_add_u32 s20, s20, 12032
    v_fma_f32 v76, v76, s28, v12
    v_fma_f32 v74, v74, s28, v11
    v_mfma_f32_16x16x32_bf16 v[160:163], a[212:215], v[20:23], v[160:163]
    v_fma_f32 v56, v56, s28, v9
    v_mfma_f32_16x16x32_bf16 v[208:211], a[212:215], v[26:29], v[208:211]
    ds_read_b64_tr_b16 a[232:233], v3 offset:1024
    v_fma_f32 v55, v55, s28, v9
    v_mfma_f32_16x16x32_bf16 v[212:215], a[216:219], v[26:29], v[212:215]
    buffer_store_dwordx4 v[96:99], v6, s[16:19], s24 offen offset:0 nt
    s_add_u32 s39, s39, 12288
    v_fma_f32 v82, v82, s28, v12
    v_exp_f32 v87, v87
    v_mfma_f32_16x16x32_bf16 a[4:7], a[216:219], v[32:35], a[4:7]
    v_cvt_pk_bf16_f32 v25, v62, v63
    v_fma_f32 v78, v78, s28, v12
    v_mfma_f32_16x16x32_bf16 a[0:3], a[212:215], v[32:35], a[0:3]
    ds_read_b64_tr_b16 a[234:235], v3 offset:7168
    v_fma_f32 v89, v89, s28, v13
    v_mfma_f32_16x16x32_bf16 a[48:51], a[212:215], v[38:41], a[48:51]
    ds_read_b64_tr_b16 a[228:229], v2 offset:1024
    v_mfma_f32_16x16x32_bf16 a[52:55], a[216:219], v[38:41], a[52:55]
    s_waitcnt lgkmcnt(3)
    ds_read_b64_tr_b16 a[212:213], v4 offset:1024
    v_fma_f32 v91, v91, s28, v13
    v_mfma_f32_16x16x32_bf16 a[56:59], a[220:223], v[38:41], a[56:59]
    v_fma_f32 v68, v68, s28, v11
    v_fma_f32 v66, v66, s28, v10
    v_mfma_f32_16x16x32_bf16 a[60:63], a[224:227], v[38:41], a[60:63]
    v_exp_f32 v70, v70
    v_mfma_f32_16x16x32_bf16 a[12:15], a[224:227], v[32:35], a[12:15]
    v_fma_f32 v65, v65, s28, v10
    v_mfma_f32_16x16x32_bf16 a[8:11], a[220:223], v[32:35], a[8:11]
    v_exp_f32 v76, v76
    v_mfma_f32_16x16x32_bf16 v[216:219], a[220:223], v[26:29], v[216:219]
    v_exp_f32 v68, v68
    v_mfma_f32_16x16x32_bf16 v[220:223], a[224:227], v[26:29], v[220:223]
    s_add_u32 m0, s23, 2048
    v_exp_f32 v53, v53
    v_mfma_f32_16x16x32_bf16 v[172:175], a[224:227], v[20:23], v[172:175]
    buffer_load_dwordx4 v6, s[12:15], s25 offen nt lds
    v_mfma_f32_16x16x32_bf16 v[168:171], a[220:223], v[20:23], v[168:171]
    v_exp_f32 v55, v55
    v_mfma_f32_16x16x32_bf16 v[120:123], a[220:223], v[14:17], v[120:123]
    ds_read_b64_tr_b16 a[214:215], v4 offset:7168
    v_fma_f32 v81, v81, s28, v12
    v_mfma_f32_16x16x32_bf16 v[124:127], a[224:227], v[14:17], v[124:127]
    s_waitcnt lgkmcnt(1)
    v_fma_f32 v52, v52, s28, v9
    v_fma_f32 v64, v64, s28, v10
    v_mfma_f32_16x16x32_bf16 v[128:131], a[228:231], v[14:17], v[128:131]
    ds_read_b64_tr_b16 a[216:217], v5 offset:1024
    ds_read_b64_tr_b16 a[218:219], v5 offset:7168
    v_mfma_f32_16x16x32_bf16 v[132:135], a[232:235], v[14:17], v[132:135]
    v_exp_f32 v61, v61
    v_mfma_f32_16x16x32_bf16 v[180:183], a[232:235], v[20:23], v[180:183]
    v_fma_f32 v57, v57, s28, v9
    v_mfma_f32_16x16x32_bf16 v[176:179], a[228:231], v[20:23], v[176:179]
    v_exp_f32 v71, v71
    v_mfma_f32_16x16x32_bf16 v[224:227], a[228:231], v[26:29], v[224:227]
    ds_read_b64_tr_b16 a[224:225], v3 offset:2048
    v_fma_f32 v67, v67, s28, v10
    v_mfma_f32_16x16x32_bf16 v[228:231], a[232:235], v[26:29], v[228:231]
    v_fma_f32 v72, v72, s28, v11
    v_fma_f32 v90, v90, s28, v13
    v_mfma_f32_16x16x32_bf16 a[20:23], a[232:235], v[32:35], a[20:23]
    ds_read_b64_tr_b16 a[222:223], v2 offset:8192
    v_mfma_f32_16x16x32_bf16 a[16:19], a[228:231], v[32:35], a[16:19]
    v_exp_f32 v74, v74
    v_mfma_f32_16x16x32_bf16 a[64:67], a[228:231], v[38:41], a[64:67]
    v_cvt_pk_bf16_f32 v30, v68, v69
    v_mfma_f32_16x16x32_bf16 a[68:71], a[232:235], v[38:41], a[68:71]
    s_waitcnt lgkmcnt(4)
    ds_read_b64_tr_b16 a[220:221], v2 offset:2048
    ds_read_b64_tr_b16 a[226:227], v3 offset:8192
    v_mfma_f32_16x16x32_bf16 a[72:75], a[212:215], v[38:41], a[72:75]
    s_waitcnt lgkmcnt(4)
    v_exp_f32 v57, v57
    v_mfma_f32_16x16x32_bf16 a[76:79], a[216:219], v[38:41], a[76:79]
    ds_read_b64_tr_b16 a[234:235], v5 offset:8192
    ds_read_b64_tr_b16 a[228:229], v4 offset:2048
    v_mfma_f32_16x16x32_bf16 a[28:31], a[216:219], v[32:35], a[28:31]
    v_exp_f32 v79, v79
    v_mfma_f32_16x16x32_bf16 a[24:27], a[212:215], v[32:35], a[24:27]
    ds_read_b64_tr_b16 a[230:231], v4 offset:8192
    ds_read_b64_tr_b16 a[232:233], v5 offset:2048
    v_mfma_f32_16x16x32_bf16 v[232:235], a[212:215], v[26:29], v[232:235]
    v_exp_f32 v91, v91
    v_mfma_f32_16x16x32_bf16 v[236:239], a[216:219], v[26:29], v[236:239]
    v_exp_f32 v60, v60
    v_mfma_f32_16x16x32_bf16 v[188:191], a[216:219], v[20:23], v[188:191]
    v_exp_f32 v85, v85
    v_mfma_f32_16x16x32_bf16 v[184:187], a[212:215], v[20:23], v[184:187]
    v_exp_f32 v65, v65
    v_mfma_f32_16x16x32_bf16 v[136:139], a[212:215], v[14:17], v[136:139]
    v_exp_f32 v52, v52
    v_mfma_f32_16x16x32_bf16 v[140:143], a[216:219], v[14:17], v[140:143]
    s_waitcnt lgkmcnt(4)
    v_mfma_f32_16x16x32_bf16 v[144:147], a[220:223], v[14:17], v[144:147]
    v_mfma_f32_16x16x32_bf16 v[148:151], a[224:227], v[14:17], v[148:151]
    v_fma_f32 v73, v73, s28, v11
    v_mfma_f32_16x16x32_bf16 v[196:199], a[224:227], v[20:23], v[196:199]
    ds_read_b128 v[96:99], v103 offset:3072
    v_mfma_f32_16x16x32_bf16 v[192:195], a[220:223], v[20:23], v[192:195]
    s_waitcnt vmcnt(12) lgkmcnt(1)
    v_exp_f32 v88, v88
    v_mfma_f32_16x16x32_bf16 v[240:243], a[220:223], v[26:29], v[240:243]
    v_fma_f32 v58, v58, s28, v9
    v_cvt_pk_bf16_f32 v19, v54, v55
    v_mfma_f32_16x16x32_bf16 v[244:247], a[224:227], v[26:29], v[244:247]
    s_barrier
    v_mfma_f32_16x16x32_bf16 a[36:39], a[224:227], v[32:35], a[36:39]
    s_add_u32 m0, s22, 24576
    v_exp_f32 v78, v78
    v_mfma_f32_16x16x32_bf16 a[32:35], a[220:223], v[32:35], a[32:35]
    buffer_load_dwordx4 v6, s[8:11], s21 offen lds
    v_mfma_f32_16x16x32_bf16 a[80:83], a[220:223], v[38:41], a[80:83]
    s_add_u32 s21, s21, 128
    ds_read_b128 a[220:223], v0 offset:1024
    v_cvt_pk_bf16_f32 v31, v70, v71
    v_mfma_f32_16x16x32_bf16 a[84:87], a[224:227], v[38:41], a[84:87]
    ds_read_b128 a[212:215], v0 offset:0
    v_cvt_pk_bf16_f32 v36, v76, v77
    v_mfma_f32_16x16x32_bf16 a[88:91], a[228:231], v[38:41], a[88:91]
    s_add_u32 m0, s22, 25600
    ds_read_b128 a[216:219], v1 offset:0
    v_cvt_pk_bf16_f32 v24, v60, v61
    v_mfma_f32_16x16x32_bf16 a[92:95], a[232:235], v[38:41], a[92:95]
    buffer_load_dwordx4 v6, s[8:11], s21 offen lds
    v_mfma_f32_16x16x32_bf16 a[44:47], a[232:235], v[32:35], a[44:47]
    v_exp_f32 v67, v67
    v_mfma_f32_16x16x32_bf16 a[40:43], a[228:231], v[32:35], a[40:43]
    v_mfma_f32_16x16x32_bf16 v[248:251], a[228:231], v[26:29], v[248:251]
    s_add_u32 s21, s21, 128
    s_add_u32 m0, s22, 26624
    v_cvt_pk_bf16_f32 v18, v52, v53
    v_mfma_f32_16x16x32_bf16 v[252:255], a[232:235], v[26:29], v[252:255]
    v_exp_f32 v80, v80
    v_mfma_f32_16x16x32_bf16 v[204:207], a[232:235], v[20:23], v[204:207]
    buffer_load_dwordx4 v6, s[8:11], s21 offen lds
    v_mfma_f32_16x16x32_bf16 v[200:203], a[228:231], v[20:23], v[200:203]
    v_exp_f32 v66, v66
    v_mfma_f32_16x16x32_bf16 v[152:155], a[228:231], v[14:17], v[152:155]
    s_add_u32 s21, s21, 12032
    v_mfma_f32_16x16x32_bf16 v[156:159], a[232:235], v[14:17], v[156:159]
    s_waitcnt lgkmcnt(1)
    v_cvt_pk_bf16_f32 v37, v78, v79
    v_mfma_f32_16x16x32_bf16 v[52:55], a[212:215], a[96:99], 0
    s_waitcnt lgkmcnt(0)
    v_exp_f32 v73, v73
    v_mfma_f32_16x16x32_bf16 v[52:55], a[216:219], a[100:103], v[52:55]
    v_exp_f32 v86, v86
    v_mfma_f32_16x16x32_bf16 v[52:55], a[220:223], a[104:107], v[52:55]
    ds_read_b128 a[224:227], v1 offset:1024
    v_cvt_pk_bf16_f32 v43, v86, v87
    v_mfma_f32_16x16x32_bf16 v[60:63], a[220:223], a[128:131], 0
    ds_read_b128 a[228:231], v0 offset:2048
    v_mfma_f32_16x16x32_bf16 v[60:63], a[216:219], a[124:127], v[60:63]
    buffer_store_dwordx4 v[96:99], v7, s[16:19], s24 offen offset:0 nt
    ds_read_b128 a[232:235], v1 offset:2048
    v_exp_f32 v83, v83
    v_mfma_f32_16x16x32_bf16 v[60:63], a[212:215], a[120:123], v[60:63]
    v_exp_f32 v81, v81
    v_mfma_f32_16x16x32_bf16 v[68:71], a[212:215], a[144:147], 0
    v_exp_f32 v82, v82
    v_mfma_f32_16x16x32_bf16 v[68:71], a[216:219], a[148:151], v[68:71]
    v_exp_f32 v56, v56
    v_mfma_f32_16x16x32_bf16 v[68:71], a[220:223], a[152:155], v[68:71]
    v_exp_f32 v90, v90
    v_mfma_f32_16x16x32_bf16 v[76:79], a[220:223], a[176:179], 0
    v_exp_f32 v58, v58
    v_mfma_f32_16x16x32_bf16 v[76:79], a[216:219], a[172:175], v[76:79]
    v_exp_f32 v75, v75
    v_mfma_f32_16x16x32_bf16 v[76:79], a[212:215], a[168:171], v[76:79]
    v_cvt_pk_bf16_f32 v42, v84, v85
    v_cvt_pk_bf16_f32 v34, v80, v81
    v_mfma_f32_16x16x32_bf16 v[84:87], a[212:215], a[192:195], 0
    ds_read_b128 a[212:215], v0 offset:6144
    s_add_u32 m0, s23, 3072
    v_mfma_f32_16x16x32_bf16 v[84:87], a[216:219], a[196:199], v[84:87]
    v_cvt_pk_bf16_f32 v23, v66, v67
    v_mfma_f32_16x16x32_bf16 v[84:87], a[220:223], a[200:203], v[84:87]
    s_waitcnt lgkmcnt(1)
    v_exp_f32 v72, v72
    v_mfma_f32_16x16x32_bf16 v[84:87], a[224:227], a[204:207], v[84:87]
    ds_read_b128 a[220:223], v0 offset:7168
    v_mfma_f32_16x16x32_bf16 v[84:87], a[228:231], a[208:211], v[84:87]
    buffer_load_dwordx4 v7, s[12:15], s25 offen nt lds
    v_mfma_f32_16x16x32_bf16 v[84:87], a[232:235], v[92:95], v[84:87]
    v_fma_f32 v59, v59, s28, v9
    v_cvt_pk_bf16_f32 v29, v74, v75
    v_mfma_f32_16x16x32_bf16 v[76:79], a[232:235], a[188:191], v[76:79]
    v_cvt_pk_bf16_f32 v28, v72, v73
    v_mfma_f32_16x16x32_bf16 v[76:79], a[228:231], a[184:187], v[76:79]
    v_exp_f32 v59, v59
    v_mfma_f32_16x16x32_bf16 v[76:79], a[224:227], a[180:183], v[76:79]
    v_exp_f32 v89, v89
    v_mfma_f32_16x16x32_bf16 v[68:71], a[224:227], a[156:159], v[68:71]
    v_cvt_pk_bf16_f32 v16, v56, v57
    v_mfma_f32_16x16x32_bf16 v[68:71], a[228:231], a[160:163], v[68:71]
    v_exp_f32 v64, v64
    v_mfma_f32_16x16x32_bf16 v[68:71], a[232:235], a[164:167], v[68:71]
    ds_read_b128 a[216:219], v1 offset:6144
    v_mfma_f32_16x16x32_bf16 v[60:63], a[232:235], a[140:143], v[60:63]
    s_bitcmp1_b32 s27, 0
    v_mfma_f32_16x16x32_bf16 v[60:63], a[228:231], a[136:139], v[60:63]
    s_cselect_b32 s26, s49, 128
    v_cvt_pk_bf16_f32 v17, v58, v59
    s_lshr_b32 s27, s27, 1
    v_mfma_f32_16x16x32_bf16 v[60:63], a[224:227], a[132:135], v[60:63]
    v_cvt_pk_bf16_f32 v22, v64, v65
    v_mfma_f32_16x16x32_bf16 v[52:55], a[224:227], a[108:111], v[52:55]
    ds_read_b128 a[224:227], v1 offset:7168
    v_mfma_f32_16x16x32_bf16 v[52:55], a[228:231], a[112:115], v[52:55]
    ds_read_b128 a[228:231], v0 offset:8192
    v_mfma_f32_16x16x32_bf16 v[52:55], a[232:235], a[116:119], v[52:55]
    ds_read_b128 a[232:235], v1 offset:8192
    v_mfma_f32_16x16x32_bf16 v[48:51], a[236:239], v[16:19], v[44:47]
    s_add_u32 s24, s24, s26
    v_mfma_f32_16x16x32_bf16 v[48:51], a[240:243], v[22:25], v[48:51]
    s_waitcnt lgkmcnt(4)
    v_cvt_pk_bf16_f32 v41, v90, v91
    s_add_u32 s25, s25, s26
    v_mfma_f32_16x16x32_bf16 v[56:59], a[212:215], a[96:99], 0
    v_cvt_pk_bf16_f32 v35, v82, v83
    v_mfma_f32_16x16x32_bf16 v[48:51], a[244:247], v[28:31], v[48:51]
    v_cvt_pk_bf16_f32 v40, v88, v89
    v_mfma_f32_16x16x32_bf16 v[48:51], a[248:251], v[34:37], v[48:51]
    s_nop 0
    v_mfma_f32_16x16x32_bf16 v[48:51], a[252:255], v[40:43], v[48:51]
    s_waitcnt lgkmcnt(3)
    v_mfma_f32_16x16x32_bf16 v[56:59], a[216:219], a[100:103], v[56:59]
    s_add_u32 s23, s23, 4096
    v_add_u32 v103, 4096, v103
    v_mfma_f32_16x16x32_bf16 v[56:59], a[220:223], a[104:107], v[56:59]
    v_mfma_f32_16x16x32_bf16 v[64:67], a[220:223], a[128:131], 0
    s_nop 1
    v_cmp_lt_f32 vcc, s29, v48
    v_mfma_f32_16x16x32_bf16 v[64:67], a[216:219], a[124:127], v[64:67]
    s_waitcnt vmcnt(12) lgkmcnt(0)
    v_mfma_f32_16x16x32_bf16 v[64:67], a[212:215], a[120:123], v[64:67]
    s_barrier
    v_mfma_f32_16x16x32_bf16 v[72:75], a[212:215], a[144:147], 0
    s_cbranch_vccnz L_rs_loop5w1b
L_ret_loop5w1b:
    s_cmp_eq_u32 s30, 5
    v_mfma_f32_16x16x32_bf16 v[72:75], a[216:219], a[148:151], v[72:75]
    s_cselect_b32 s26, s62, 0
    v_fma_f32 v55, v55, s28, v9
    s_add_u32 s20, s20, s26
    v_mfma_f32_16x16x32_bf16 v[72:75], a[220:223], a[152:155], v[72:75]
    s_add_u32 m0, s22, 0
    v_fma_f32 v63, v63, s28, v10
    v_fma_f32 v62, v62, s28, v10
    v_mfma_f32_16x16x32_bf16 v[80:83], a[220:223], a[176:179], 0
    buffer_load_dwordx4 v6, s[4:7], s20 offen lds
    v_mfma_f32_16x16x32_bf16 v[80:83], a[216:219], a[172:175], v[80:83]
    s_add_u32 s20, s20, 128
    s_add_u32 m0, s22, 1024
    v_fma_f32 v53, v53, s28, v9
    v_mfma_f32_16x16x32_bf16 v[80:83], a[212:215], a[168:171], v[80:83]
    v_fma_f32 v52, v52, s28, v9
    v_fma_f32 v60, v60, s28, v10
    v_mfma_f32_16x16x32_bf16 v[88:91], a[212:215], a[192:195], 0
    buffer_load_dwordx4 v6, s[4:7], s20 offen lds
    v_mfma_f32_16x16x32_bf16 v[88:91], a[216:219], a[196:199], v[88:91]
    s_add_u32 s20, s20, 128
    ds_read_b64_tr_b16 a[212:213], v2 offset:18432
    v_fma_f32 v61, v61, s28, v10
    v_mfma_f32_16x16x32_bf16 v[88:91], a[220:223], a[200:203], v[88:91]
    s_add_u32 m0, s22, 2048
    v_exp_f32 v61, v61
    v_mfma_f32_16x16x32_bf16 v[88:91], a[224:227], a[204:207], v[88:91]
    buffer_load_dwordx4 v6, s[4:7], s20 offen lds
    v_mfma_f32_16x16x32_bf16 v[88:91], a[228:231], a[208:211], v[88:91]
    v_exp_f32 v60, v60
    v_mfma_f32_16x16x32_bf16 v[88:91], a[232:235], v[92:95], v[88:91]
    ds_read_b64_tr_b16 a[214:215], v2 offset:12288
    v_cvt_pk_bf16_f32 v20, v60, v61
    v_mfma_f32_16x16x32_bf16 v[80:83], a[232:235], a[188:191], v[80:83]
    ds_read_b64_tr_b16 a[216:217], v3 offset:18432
    ds_read_b64_tr_b16 a[218:219], v3 offset:12288
    v_mfma_f32_16x16x32_bf16 v[80:83], a[228:231], a[184:187], v[80:83]
    v_exp_f32 v52, v52
    v_mfma_f32_16x16x32_bf16 v[80:83], a[224:227], a[180:183], v[80:83]
    v_exp_f32 v55, v55
    v_mfma_f32_16x16x32_bf16 v[72:75], a[224:227], a[156:159], v[72:75]
    s_add_u32 s20, s20, 12032
    ds_read_b64_tr_b16 a[220:221], v4 offset:18432
    v_fma_f32 v54, v54, s28, v9
    v_mfma_f32_16x16x32_bf16 v[72:75], a[228:231], a[160:163], v[72:75]
    s_add_u32 s30, s30, 1
    v_exp_f32 v63, v63
    v_mfma_f32_16x16x32_bf16 v[72:75], a[232:235], a[164:167], v[72:75]
    s_cmp_lt_u32 s30, 6
    v_exp_f32 v62, v62
    v_mfma_f32_16x16x32_bf16 v[64:67], a[232:235], a[140:143], v[64:67]
    v_exp_f32 v54, v54
    v_mfma_f32_16x16x32_bf16 v[64:67], a[228:231], a[136:139], v[64:67]
    v_cvt_pk_bf16_f32 v15, v54, v55
    v_cvt_pk_bf16_f32 v21, v62, v63
    v_mfma_f32_16x16x32_bf16 v[64:67], a[224:227], a[132:135], v[64:67]
    v_exp_f32 v53, v53
    v_mfma_f32_16x16x32_bf16 v[56:59], a[224:227], a[108:111], v[56:59]
    ds_read_b64_tr_b16 a[222:223], v4 offset:12288
    v_cvt_pk_bf16_f32 v14, v52, v53
    v_mfma_f32_16x16x32_bf16 v[56:59], a[228:231], a[112:115], v[56:59]
    s_waitcnt lgkmcnt(2)
    ds_read_b64_tr_b16 a[224:225], v5 offset:18432
    ds_read_b64_tr_b16 a[226:227], v5 offset:12288
    v_mfma_f32_16x16x32_bf16 v[56:59], a[232:235], a[116:119], v[56:59]
    s_cbranch_scc1 L_loop5w1
    s_cmp_ge_u32 s37, 6
    s_cbranch_scc1 L_end5
    s_cmp_eq_u32 s32, 0
    s_cbranch_scc1 L_tr54
    s_branch L_tr55
L_tr54:
    v_mfma_f32_16x16x32_bf16 v[112:115], a[212:215], v[16:19], v[112:115]
    v_fma_f32 v73, v73, s28, v11
    v_mfma_f32_16x16x32_bf16 v[116:119], a[216:219], v[16:19], v[116:119]
    ds_read_b64_tr_b16 a[228:229], v2 offset:19456
    v_fma_f32 v88, v88, s28, v13
    v_mfma_f32_16x16x32_bf16 v[164:167], a[216:219], v[22:25], v[164:167]
    v_fma_f32 v78, v78, s28, v12
    v_fma_f32 v56, v56, s28, v9
    v_mfma_f32_16x16x32_bf16 v[160:163], a[212:215], v[22:25], v[160:163]
    v_mfma_f32_16x16x32_bf16 v[208:211], a[212:215], v[28:31], v[208:211]
    ds_read_b64_tr_b16 a[234:235], v3 offset:13312
    v_fma_f32 v83, v83, s28, v12
    v_mfma_f32_16x16x32_bf16 v[212:215], a[216:219], v[28:31], v[212:215]
    ds_read_b64_tr_b16 a[230:231], v2 offset:13312
    v_fma_f32 v79, v79, s28, v12
    v_mfma_f32_16x16x32_bf16 a[4:7], a[216:219], v[34:37], a[4:7]
    v_mfma_f32_16x16x32_bf16 a[0:3], a[212:215], v[34:37], a[0:3]
    ds_read_b64_tr_b16 a[232:233], v3 offset:19456
    v_fma_f32 v81, v81, s28, v12
    v_mfma_f32_16x16x32_bf16 a[48:51], a[212:215], v[40:43], a[48:51]
    v_fma_f32 v77, v77, s28, v12
    v_fma_f32 v80, v80, s28, v12
    v_mfma_f32_16x16x32_bf16 a[52:55], a[216:219], v[40:43], a[52:55]
    s_waitcnt lgkmcnt(4)
    v_exp_f32 v79, v79
    v_mfma_f32_16x16x32_bf16 a[56:59], a[220:223], v[40:43], a[56:59]
    ds_read_b64_tr_b16 a[214:215], v4 offset:13312
    v_fma_f32 v86, v86, s28, v13
    v_mfma_f32_16x16x32_bf16 a[60:63], a[224:227], v[40:43], a[60:63]
    v_fma_f32 v66, v66, s28, v10
    v_fma_f32 v67, v67, s28, v10
    v_mfma_f32_16x16x32_bf16 a[12:15], a[224:227], v[34:37], a[12:15]
    v_mfma_f32_16x16x32_bf16 a[8:11], a[220:223], v[34:37], a[8:11]
    v_fma_f32 v90, v90, s28, v13
    v_mfma_f32_16x16x32_bf16 v[216:219], a[220:223], v[28:31], v[216:219]
    ds_read_b64_tr_b16 a[212:213], v4 offset:19456
    v_fma_f32 v87, v87, s28, v13
    v_mfma_f32_16x16x32_bf16 v[220:223], a[224:227], v[28:31], v[220:223]
    v_exp_f32 v78, v78
    v_mfma_f32_16x16x32_bf16 v[172:175], a[224:227], v[22:25], v[172:175]
    v_fma_f32 v65, v65, s28, v10
    v_fma_f32 v70, v70, s28, v11
    v_mfma_f32_16x16x32_bf16 v[168:171], a[220:223], v[22:25], v[168:171]
    v_fma_f32 v91, v91, s28, v13
    v_mfma_f32_16x16x32_bf16 v[120:123], a[220:223], v[16:19], v[120:123]
    ds_read_b64_tr_b16 a[216:217], v5 offset:19456
    v_fma_f32 v82, v82, s28, v12
    v_mfma_f32_16x16x32_bf16 v[124:127], a[224:227], v[16:19], v[124:127]
    s_waitcnt lgkmcnt(3)
    ds_read_b64_tr_b16 a[218:219], v5 offset:13312
    v_mfma_f32_16x16x32_bf16 v[128:131], a[228:231], v[16:19], v[128:131]
    v_exp_f32 v70, v70
    v_mfma_f32_16x16x32_bf16 v[132:135], a[232:235], v[16:19], v[132:135]
    v_exp_f32 v77, v77
    v_mfma_f32_16x16x32_bf16 v[180:183], a[232:235], v[22:25], v[180:183]
    v_fma_f32 v84, v84, s28, v13
    v_fma_f32 v59, v59, s28, v9
    v_mfma_f32_16x16x32_bf16 v[176:179], a[228:231], v[22:25], v[176:179]
    ds_read_b64_tr_b16 a[222:223], v2 offset:14336
    v_cvt_pk_bf16_f32 v33, v78, v79
    v_mfma_f32_16x16x32_bf16 v[224:227], a[228:231], v[28:31], v[224:227]
    ds_read_b64_tr_b16 a[226:227], v3 offset:14336
    v_mfma_f32_16x16x32_bf16 v[228:231], a[232:235], v[28:31], v[228:231]
    ds_read_b64_tr_b16 a[220:221], v2 offset:20480
    v_fma_f32 v68, v68, s28, v11
    v_mfma_f32_16x16x32_bf16 a[20:23], a[232:235], v[34:37], a[20:23]
    v_fma_f32 v85, v85, s28, v13
    v_mfma_f32_16x16x32_bf16 a[16:19], a[228:231], v[34:37], a[16:19]
    v_mfma_f32_16x16x32_bf16 a[64:67], a[228:231], v[40:43], a[64:67]
    v_fma_f32 v57, v57, s28, v9
    v_fma_f32 v74, v74, s28, v11
    v_mfma_f32_16x16x32_bf16 a[68:71], a[232:235], v[40:43], a[68:71]
    s_waitcnt lgkmcnt(3)
    ds_read_b64_tr_b16 a[224:225], v3 offset:20480
    s_add_u32 s39, s39, 12288
    v_mfma_f32_16x16x32_bf16 a[72:75], a[212:215], v[40:43], a[72:75]
    v_exp_f32 v68, v68
    v_mfma_f32_16x16x32_bf16 a[76:79], a[216:219], v[40:43], a[76:79]
    v_exp_f32 v73, v73
    v_mfma_f32_16x16x32_bf16 a[28:31], a[216:219], v[34:37], a[28:31]
    v_fma_f32 v69, v69, s28, v11
    v_fma_f32 v58, v58, s28, v9
    v_mfma_f32_16x16x32_bf16 a[24:27], a[212:215], v[34:37], a[24:27]
    ds_read_b64_tr_b16 a[230:231], v4 offset:14336
    v_fma_f32 v76, v76, s28, v12
    v_mfma_f32_16x16x32_bf16 v[232:235], a[212:215], v[28:31], v[232:235]
    ds_read_b64_tr_b16 a[228:229], v4 offset:20480
    v_fma_f32 v71, v71, s28, v11
    v_mfma_f32_16x16x32_bf16 v[236:239], a[216:219], v[28:31], v[236:239]
    ds_read_b64_tr_b16 a[234:235], v5 offset:14336
    v_fma_f32 v89, v89, s28, v13
    v_mfma_f32_16x16x32_bf16 v[188:191], a[216:219], v[22:25], v[188:191]
    v_exp_f32 v84, v84
    v_mfma_f32_16x16x32_bf16 v[184:187], a[212:215], v[22:25], v[184:187]
    v_exp_f32 v67, v67
    v_mfma_f32_16x16x32_bf16 v[136:139], a[212:215], v[16:19], v[136:139]
    ds_read_b64_tr_b16 a[232:233], v5 offset:20480
    v_fma_f32 v75, v75, s28, v11
    v_mfma_f32_16x16x32_bf16 v[140:143], a[216:219], v[16:19], v[140:143]
    s_waitcnt lgkmcnt(4)
    v_exp_f32 v66, v66
    v_mfma_f32_16x16x32_bf16 v[144:147], a[220:223], v[16:19], v[144:147]
    v_exp_f32 v69, v69
    v_mfma_f32_16x16x32_bf16 v[148:151], a[224:227], v[16:19], v[148:151]
    v_exp_f32 v57, v57
    v_mfma_f32_16x16x32_bf16 v[196:199], a[224:227], v[22:25], v[196:199]
    v_exp_f32 v82, v82
    v_mfma_f32_16x16x32_bf16 v[192:195], a[220:223], v[22:25], v[192:195]
    v_exp_f32 v85, v85
    v_mfma_f32_16x16x32_bf16 v[240:243], a[220:223], v[28:31], v[240:243]
    v_exp_f32 v86, v86
    v_mfma_f32_16x16x32_bf16 v[244:247], a[224:227], v[28:31], v[244:247]
    v_exp_f32 v74, v74
    v_mfma_f32_16x16x32_bf16 a[36:39], a[224:227], v[34:37], a[36:39]
    v_exp_f32 v76, v76
    v_mfma_f32_16x16x32_bf16 a[32:35], a[220:223], v[34:37], a[32:35]
    v_exp_f32 v83, v83
    v_mfma_f32_16x16x32_bf16 a[80:83], a[220:223], v[40:43], a[80:83]
    s_waitcnt vmcnt(10) lgkmcnt(0)
    v_exp_f32 v87, v87
    v_mfma_f32_16x16x32_bf16 a[84:87], a[224:227], v[40:43], a[84:87]
    s_barrier
    ds_read_b128 a[212:215], v0 offset:12288
    v_mfma_f32_16x16x32_bf16 a[88:91], a[228:231], v[40:43], a[88:91]
    ds_read_b128 a[216:219], v1 offset:12288
    v_fma_f32 v72, v72, s28, v11
    v_mfma_f32_16x16x32_bf16 a[92:95], a[232:235], v[40:43], a[92:95]
    s_add_u32 m0, s22, 36864
    ds_read_b128 a[220:223], v0 offset:13312
    v_mfma_f32_16x16x32_bf16 a[44:47], a[232:235], v[34:37], a[44:47]
    buffer_load_dwordx4 v6, s[8:11], s21 offen lds
    v_mfma_f32_16x16x32_bf16 a[40:43], a[228:231], v[34:37], a[40:43]
    s_add_u32 s21, s21, 128
    ds_read_b128 a[224:227], v1 offset:13312
    s_add_u32 m0, s22, 37888
    v_mfma_f32_16x16x32_bf16 v[248:251], a[228:231], v[28:31], v[248:251]
    buffer_load_dwordx4 v6, s[8:11], s21 offen lds
    v_mfma_f32_16x16x32_bf16 v[252:255], a[232:235], v[28:31], v[252:255]
    v_cvt_pk_bf16_f32 v26, v68, v69
    s_add_u32 s21, s21, 128
    v_mfma_f32_16x16x32_bf16 v[204:207], a[232:235], v[22:25], v[204:207]
    v_exp_f32 v75, v75
    v_mfma_f32_16x16x32_bf16 v[200:203], a[228:231], v[22:25], v[200:203]
    s_add_u32 m0, s22, 38912
    v_exp_f32 v90, v90
    v_mfma_f32_16x16x32_bf16 v[152:155], a[228:231], v[16:19], v[152:155]
    buffer_load_dwordx4 v6, s[8:11], s21 offen lds
    v_mfma_f32_16x16x32_bf16 v[156:159], a[232:235], v[16:19], v[156:159]
    s_waitcnt lgkmcnt(3)
    ds_read_b128 a[228:231], v0 offset:14336
    v_mfma_f32_16x16x32_bf16 v[52:55], a[212:215], a[96:99], 0
    s_waitcnt lgkmcnt(3)
    v_exp_f32 v71, v71
    v_mfma_f32_16x16x32_bf16 v[52:55], a[216:219], a[100:103], v[52:55]
    s_waitcnt lgkmcnt(2)
    v_cvt_pk_bf16_f32 v32, v76, v77
    v_mfma_f32_16x16x32_bf16 v[52:55], a[220:223], a[104:107], v[52:55]
    v_mfma_f32_16x16x32_bf16 v[60:63], a[220:223], a[128:131], 0
    v_exp_f32 v91, v91
    v_mfma_f32_16x16x32_bf16 v[60:63], a[216:219], a[124:127], v[60:63]
    ds_read_b128 a[232:235], v1 offset:14336
    v_fma_f32 v64, v64, s28, v10
    v_mfma_f32_16x16x32_bf16 v[60:63], a[212:215], a[120:123], v[60:63]
    v_cvt_pk_bf16_f32 v27, v70, v71
    v_cvt_pk_bf16_f32 v38, v84, v85
    v_mfma_f32_16x16x32_bf16 v[68:71], a[212:215], a[144:147], 0
    v_cvt_pk_bf16_f32 v39, v86, v87
    v_mfma_f32_16x16x32_bf16 v[68:71], a[216:219], a[148:151], v[68:71]
    v_exp_f32 v58, v58
    v_mfma_f32_16x16x32_bf16 v[68:71], a[220:223], a[152:155], v[68:71]
    v_cvt_pk_bf16_f32 v41, v90, v91
    v_cvt_pk_bf16_f32 v23, v66, v67
    v_mfma_f32_16x16x32_bf16 v[76:79], a[220:223], a[176:179], 0
    v_exp_f32 v72, v72
    v_mfma_f32_16x16x32_bf16 v[76:79], a[216:219], a[172:175], v[76:79]
    v_cvt_pk_bf16_f32 v35, v82, v83
    v_cvt_pk_bf16_f32 v29, v74, v75
    v_mfma_f32_16x16x32_bf16 v[76:79], a[212:215], a[168:171], v[76:79]
    v_exp_f32 v59, v59
    v_mfma_f32_16x16x32_bf16 v[84:87], a[212:215], a[192:195], 0
    v_exp_f32 v81, v81
    v_mfma_f32_16x16x32_bf16 v[84:87], a[216:219], a[196:199], v[84:87]
    v_exp_f32 v89, v89
    v_mfma_f32_16x16x32_bf16 v[84:87], a[220:223], a[200:203], v[84:87]
    s_waitcnt lgkmcnt(0)
    v_cvt_pk_bf16_f32 v28, v72, v73
    v_mfma_f32_16x16x32_bf16 v[84:87], a[224:227], a[204:207], v[84:87]
    v_exp_f32 v65, v65
    v_mfma_f32_16x16x32_bf16 v[84:87], a[228:231], a[208:211], v[84:87]
    v_exp_f32 v80, v80
    v_mfma_f32_16x16x32_bf16 v[84:87], a[232:235], v[92:95], v[84:87]
    v_exp_f32 v64, v64
    v_mfma_f32_16x16x32_bf16 v[76:79], a[232:235], a[188:191], v[76:79]
    v_mfma_f32_16x16x32_bf16 v[76:79], a[228:231], a[184:187], v[76:79]
    ds_read_b128 a[212:215], v0 offset:18432
    v_cvt_pk_bf16_f32 v17, v58, v59
    v_mfma_f32_16x16x32_bf16 v[76:79], a[224:227], a[180:183], v[76:79]
    v_cvt_pk_bf16_f32 v34, v80, v81
    v_mfma_f32_16x16x32_bf16 v[68:71], a[224:227], a[156:159], v[68:71]
    v_exp_f32 v56, v56
    v_mfma_f32_16x16x32_bf16 v[68:71], a[228:231], a[160:163], v[68:71]
    v_mfma_f32_16x16x32_bf16 v[68:71], a[232:235], a[164:167], v[68:71]
    v_mfma_f32_16x16x32_bf16 v[60:63], a[232:235], a[140:143], v[60:63]
    v_cvt_pk_bf16_f32 v22, v64, v65
    v_mfma_f32_16x16x32_bf16 v[60:63], a[228:231], a[136:139], v[60:63]
    ds_read_b128 a[216:219], v1 offset:18432
    v_cvt_pk_bf16_f32 v16, v56, v57
    v_mfma_f32_16x16x32_bf16 v[60:63], a[224:227], a[132:135], v[60:63]
    ds_read_b128 a[220:223], v0 offset:19456
    v_mfma_f32_16x16x32_bf16 v[52:55], a[224:227], a[108:111], v[52:55]
    v_exp_f32 v88, v88
    v_mfma_f32_16x16x32_bf16 v[44:47], a[236:239], v[14:17], v[48:51]
    v_mfma_f32_16x16x32_bf16 v[44:47], a[240:243], v[20:23], v[44:47]
    ds_read_b128 a[224:227], v1 offset:19456
    v_cvt_pk_bf16_f32 v40, v88, v89
    v_mfma_f32_16x16x32_bf16 v[52:55], a[228:231], a[112:115], v[52:55]
    ds_read_b128 a[228:231], v0 offset:20480
    v_mfma_f32_16x16x32_bf16 v[52:55], a[232:235], a[116:119], v[52:55]
    v_mfma_f32_16x16x32_bf16 v[44:47], a[244:247], v[26:29], v[44:47]
    ds_read_b128 a[232:235], v1 offset:20480
    v_mfma_f32_16x16x32_bf16 v[44:47], a[248:251], v[32:35], v[44:47]
    v_mfma_f32_16x16x32_bf16 v[44:47], a[252:255], v[38:41], v[44:47]
    s_waitcnt lgkmcnt(5)
    v_mfma_f32_16x16x32_bf16 v[56:59], a[212:215], a[96:99], 0
    s_waitcnt lgkmcnt(4)
    v_mfma_f32_16x16x32_bf16 v[56:59], a[216:219], a[100:103], v[56:59]
    s_waitcnt lgkmcnt(3)
    v_mfma_f32_16x16x32_bf16 v[56:59], a[220:223], a[104:107], v[56:59]
    s_nop 1
    v_cmp_lt_f32 vcc, s29, v44
    v_mfma_f32_16x16x32_bf16 v[64:67], a[220:223], a[128:131], 0
    s_add_u32 s21, s21, 12032
    v_mfma_f32_16x16x32_bf16 v[64:67], a[216:219], a[124:127], v[64:67]
    v_mfma_f32_16x16x32_bf16 v[64:67], a[212:215], a[120:123], v[64:67]
    s_nop 0
    s_cbranch_vccnz L_rs_tr54a
L_ret_tr54a:
    v_mfma_f32_16x16x32_bf16 v[72:75], a[212:215], a[144:147], 0
    v_fma_f32 v62, v62, s28, v10
    v_fma_f32 v52, v52, s28, v9
    v_mfma_f32_16x16x32_bf16 v[72:75], a[216:219], a[148:151], v[72:75]
    s_waitcnt vmcnt(6) lgkmcnt(0)
    v_exp_f32 v52, v52
    v_mfma_f32_16x16x32_bf16 v[72:75], a[220:223], a[152:155], v[72:75]
    s_add_u32 m0, s22, 12288
    v_fma_f32 v60, v60, s28, v10
    v_fma_f32 v55, v55, s28, v9
    v_mfma_f32_16x16x32_bf16 v[80:83], a[220:223], a[176:179], 0
    s_barrier
    v_mfma_f32_16x16x32_bf16 v[80:83], a[216:219], a[172:175], v[80:83]
    buffer_load_dwordx4 v6, s[4:7], s20 offen lds
    v_mfma_f32_16x16x32_bf16 v[80:83], a[212:215], a[168:171], v[80:83]
    v_exp_f32 v55, v55
    v_mfma_f32_16x16x32_bf16 v[88:91], a[212:215], a[192:195], 0
    ds_read_b64_tr_b16 a[212:213], v2 offset:0
    v_fma_f32 v54, v54, s28, v9
    v_mfma_f32_16x16x32_bf16 v[88:91], a[216:219], a[196:199], v[88:91]
    v_exp_f32 v60, v60
    v_mfma_f32_16x16x32_bf16 v[88:91], a[220:223], a[200:203], v[88:91]
    s_add_u32 s20, s20, 128
    ds_read_b64_tr_b16 a[214:215], v2 offset:6144
    v_fma_f32 v53, v53, s28, v9
    v_mfma_f32_16x16x32_bf16 v[88:91], a[224:227], a[204:207], v[88:91]
    ds_read_b64_tr_b16 a[216:217], v3 offset:0
    s_add_u32 m0, s22, 13312
    v_mfma_f32_16x16x32_bf16 v[88:91], a[228:231], a[208:211], v[88:91]
    ds_read_b64_tr_b16 a[218:219], v3 offset:6144
    v_fma_f32 v61, v61, s28, v10
    v_mfma_f32_16x16x32_bf16 v[88:91], a[232:235], v[92:95], v[88:91]
    buffer_load_dwordx4 v6, s[4:7], s20 offen lds
    v_mfma_f32_16x16x32_bf16 v[80:83], a[232:235], a[188:191], v[80:83]
    v_exp_f32 v62, v62
    v_mfma_f32_16x16x32_bf16 v[80:83], a[228:231], a[184:187], v[80:83]
    s_add_u32 s20, s20, 128
    s_add_u32 m0, s22, 14336
    v_fma_f32 v63, v63, s28, v10
    v_mfma_f32_16x16x32_bf16 v[80:83], a[224:227], a[180:183], v[80:83]
    buffer_load_dwordx4 v6, s[4:7], s20 offen lds
    v_mfma_f32_16x16x32_bf16 v[72:75], a[224:227], a[156:159], v[72:75]
    v_exp_f32 v54, v54
    v_mfma_f32_16x16x32_bf16 v[72:75], a[228:231], a[160:163], v[72:75]
    ds_read_b64_tr_b16 a[220:221], v4 offset:0
    v_mfma_f32_16x16x32_bf16 v[72:75], a[232:235], a[164:167], v[72:75]
    v_exp_f32 v61, v61
    v_mfma_f32_16x16x32_bf16 v[64:67], a[232:235], a[140:143], v[64:67]
    v_exp_f32 v63, v63
    v_mfma_f32_16x16x32_bf16 v[64:67], a[228:231], a[136:139], v[64:67]
    v_exp_f32 v53, v53
    v_mfma_f32_16x16x32_bf16 v[64:67], a[224:227], a[132:135], v[64:67]
    ds_read_b64_tr_b16 a[222:223], v4 offset:6144
    v_cvt_pk_bf16_f32 v18, v52, v53
    v_mfma_f32_16x16x32_bf16 v[56:59], a[224:227], a[108:111], v[56:59]
    s_add_u32 s20, s20, 12032
    v_cvt_pk_bf16_f32 v25, v62, v63
    v_cvt_pk_bf16_f32 v24, v60, v61
    v_mfma_f32_16x16x32_bf16 v[56:59], a[228:231], a[112:115], v[56:59]
    ds_read_b64_tr_b16 a[224:225], v5 offset:0
    v_cvt_pk_bf16_f32 v19, v54, v55
    v_mfma_f32_16x16x32_bf16 v[56:59], a[232:235], a[116:119], v[56:59]
    s_waitcnt lgkmcnt(3)
    ds_read_b64_tr_b16 a[226:227], v5 offset:6144
    v_mfma_f32_16x16x32_bf16 v[112:115], a[212:215], v[14:17], v[112:115]
    ds_read_b64_tr_b16 a[230:231], v2 offset:7168
    v_fma_f32 v87, v87, s28, v13
    v_mfma_f32_16x16x32_bf16 v[116:119], a[216:219], v[14:17], v[116:119]
    v_fma_f32 v66, v66, s28, v10
    v_fma_f32 v73, v73, s28, v11
    v_mfma_f32_16x16x32_bf16 v[164:167], a[216:219], v[20:23], v[164:167]
    ds_read_b64_tr_b16 a[234:235], v3 offset:7168
    v_and_b32 v104, 0x3ff, v0
    v_mfma_f32_16x16x32_bf16 v[160:163], a[212:215], v[20:23], v[160:163]
    v_fma_f32 v72, v72, s28, v11
    v_fma_f32 v83, v83, s28, v12
    v_mfma_f32_16x16x32_bf16 v[208:211], a[212:215], v[26:29], v[208:211]
    ds_read_b64_tr_b16 a[228:229], v2 offset:1024
    v_fma_f32 v67, v67, s28, v10
    v_mfma_f32_16x16x32_bf16 v[212:215], a[216:219], v[26:29], v[212:215]
    ds_read_b64_tr_b16 a[232:233], v3 offset:1024
    v_lshrrev_b32 v105, 11, v0
    v_mfma_f32_16x16x32_bf16 a[4:7], a[216:219], v[32:35], a[4:7]
    v_fma_f32 v89, v89, s28, v13
    v_fma_f32 v56, v56, s28, v9
    v_mfma_f32_16x16x32_bf16 a[0:3], a[212:215], v[32:35], a[0:3]
    v_fma_f32 v70, v70, s28, v11
    v_fma_f32 v58, v58, s28, v9
    v_mfma_f32_16x16x32_bf16 a[48:51], a[212:215], v[38:41], a[48:51]
    ds_read_b64_tr_b16 a[212:213], v4 offset:1024
    v_fma_f32 v57, v57, s28, v9
    v_mfma_f32_16x16x32_bf16 a[52:55], a[216:219], v[38:41], a[52:55]
    s_waitcnt lgkmcnt(5)
    v_fma_f32 v78, v78, s28, v12
    v_fma_f32 v81, v81, s28, v12
    v_mfma_f32_16x16x32_bf16 a[56:59], a[220:223], v[38:41], a[56:59]
    v_xor_b32 v105, s65, v105
    v_lshl_add_u32 v104, v105, 10, v104
    v_mfma_f32_16x16x32_bf16 a[60:63], a[224:227], v[38:41], a[60:63]
    v_fma_f32 v65, v65, s28, v10
    v_add_u32 v104, s38, v104
    v_mfma_f32_16x16x32_bf16 a[12:15], a[224:227], v[32:35], a[12:15]
    ds_read_b64_tr_b16 a[214:215], v4 offset:7168
    v_fma_f32 v90, v90, s28, v13
    v_mfma_f32_16x16x32_bf16 a[8:11], a[220:223], v[32:35], a[8:11]
    ds_read_b64_tr_b16 a[218:219], v5 offset:7168
    v_fma_f32 v76, v76, s28, v12
    v_mfma_f32_16x16x32_bf16 v[216:219], a[220:223], v[26:29], v[216:219]
    ds_read_b64_tr_b16 a[216:217], v5 offset:1024
    v_fma_f32 v84, v84, s28, v13
    v_mfma_f32_16x16x32_bf16 v[220:223], a[224:227], v[26:29], v[220:223]
    v_exp_f32 v73, v73
    v_mfma_f32_16x16x32_bf16 v[172:175], a[224:227], v[20:23], v[172:175]
    v_exp_f32 v78, v78
    v_mfma_f32_16x16x32_bf16 v[168:171], a[220:223], v[20:23], v[168:171]
    v_exp_f32 v65, v65
    v_mfma_f32_16x16x32_bf16 v[120:123], a[220:223], v[14:17], v[120:123]
    ds_read_b64_tr_b16 a[220:221], v2 offset:2048
    v_fma_f32 v77, v77, s28, v12
    v_mfma_f32_16x16x32_bf16 v[124:127], a[224:227], v[14:17], v[124:127]
    s_waitcnt lgkmcnt(4)
    ds_read_b64_tr_b16 a[224:225], v3 offset:2048
    v_fma_f32 v91, v91, s28, v13
    v_mfma_f32_16x16x32_bf16 v[128:131], a[228:231], v[14:17], v[128:131]
    ds_read_b128 a[128:131], v104 offset:8192
    v_fma_f32 v71, v71, s28, v11
    v_mfma_f32_16x16x32_bf16 v[132:135], a[232:235], v[14:17], v[132:135]
    v_exp_f32 v58, v58
    v_mfma_f32_16x16x32_bf16 v[180:183], a[232:235], v[20:23], v[180:183]
    v_exp_f32 v84, v84
    v_mfma_f32_16x16x32_bf16 v[176:179], a[228:231], v[20:23], v[176:179]
    v_exp_f32 v67, v67
    v_mfma_f32_16x16x32_bf16 v[224:227], a[228:231], v[26:29], v[224:227]
    ds_read_b64_tr_b16 a[226:227], v3 offset:8192
    v_fma_f32 v68, v68, s28, v11
    v_mfma_f32_16x16x32_bf16 v[228:231], a[232:235], v[26:29], v[228:231]
    v_exp_f32 v91, v91
    v_mfma_f32_16x16x32_bf16 a[20:23], a[232:235], v[32:35], a[20:23]
    v_exp_f32 v81, v81
    v_mfma_f32_16x16x32_bf16 a[16:19], a[228:231], v[32:35], a[16:19]
    ds_read_b64_tr_b16 a[222:223], v2 offset:8192
    v_fma_f32 v69, v69, s28, v11
    v_mfma_f32_16x16x32_bf16 a[64:67], a[228:231], v[38:41], a[64:67]
    ds_read_b128 a[104:107], v104 offset:2048
    v_exp_f32 v87, v87
    v_mfma_f32_16x16x32_bf16 a[68:71], a[232:235], v[38:41], a[68:71]
    s_waitcnt lgkmcnt(4)
    ds_read_b128 a[176:179], v104 offset:20480
    v_fma_f32 v79, v79, s28, v12
    v_mfma_f32_16x16x32_bf16 a[72:75], a[212:215], v[38:41], a[72:75]
    v_exp_f32 v70, v70
    v_mfma_f32_16x16x32_bf16 a[76:79], a[216:219], v[38:41], a[76:79]
    ds_read_b64_tr_b16 a[228:229], v4 offset:2048
    v_fma_f32 v85, v85, s28, v13
    v_mfma_f32_16x16x32_bf16 a[28:31], a[216:219], v[32:35], a[28:31]
    v_exp_f32 v69, v69
    v_mfma_f32_16x16x32_bf16 a[24:27], a[212:215], v[32:35], a[24:27]
    ds_read_b64_tr_b16 a[230:231], v4 offset:8192
    v_fma_f32 v88, v88, s28, v13
    v_mfma_f32_16x16x32_bf16 v[232:235], a[212:215], v[26:29], v[232:235]
    ds_read_b64_tr_b16 a[234:235], v5 offset:8192
    v_xor_b32 v105, 64, v104
    v_mfma_f32_16x16x32_bf16 v[236:239], a[216:219], v[26:29], v[236:239]
    ds_read_b64_tr_b16 a[232:233], v5 offset:2048
    v_fma_f32 v75, v75, s28, v11
    v_mfma_f32_16x16x32_bf16 v[188:191], a[216:219], v[20:23], v[188:191]
    ds_read_b128 a[152:155], v104 offset:14336
    v_fma_f32 v74, v74, s28, v11
    v_mfma_f32_16x16x32_bf16 v[184:187], a[212:215], v[20:23], v[184:187]
    v_exp_f32 v88, v88
    v_mfma_f32_16x16x32_bf16 v[136:139], a[212:215], v[14:17], v[136:139]
    v_exp_f32 v77, v77
    v_mfma_f32_16x16x32_bf16 v[140:143], a[216:219], v[14:17], v[140:143]
    s_waitcnt lgkmcnt(5)
    ds_read_b128 a[96:99], v104 offset:0
    v_fma_f32 v86, v86, s28, v13
    v_mfma_f32_16x16x32_bf16 v[144:147], a[220:223], v[14:17], v[144:147]
    ds_read_b128 a[168:171], v104 offset:18432
    v_fma_f32 v82, v82, s28, v12
    v_mfma_f32_16x16x32_bf16 v[148:151], a[224:227], v[14:17], v[148:151]
    ds_read_b128 a[124:127], v105 offset:6144
    v_exp_f32 v79, v79
    v_mfma_f32_16x16x32_bf16 v[196:199], a[224:227], v[20:23], v[196:199]
    v_exp_f32 v85, v85
    v_mfma_f32_16x16x32_bf16 v[192:195], a[220:223], v[20:23], v[192:195]
    s_add_u32 s39, s39, 12288
    ds_read_b128 a[160:163], v104 offset:16384
    v_exp_f32 v90, v90
    v_mfma_f32_16x16x32_bf16 v[240:243], a[220:223], v[26:29], v[240:243]
    v_exp_f32 v71, v71
    v_mfma_f32_16x16x32_bf16 v[244:247], a[224:227], v[26:29], v[244:247]
    ds_read_b128 a[180:183], v105 offset:20480
    v_exp_f32 v68, v68
    v_mfma_f32_16x16x32_bf16 a[36:39], a[224:227], v[32:35], a[36:39]
    s_waitcnt vmcnt(6) lgkmcnt(5)
    v_exp_f32 v86, v86
    v_mfma_f32_16x16x32_bf16 a[32:35], a[220:223], v[32:35], a[32:35]
    v_exp_f32 v76, v76
    v_mfma_f32_16x16x32_bf16 a[80:83], a[220:223], v[38:41], a[80:83]
    s_add_u32 s21, s21, s62
    ds_read_b128 a[100:103], v105 offset:0
    v_fma_f32 v59, v59, s28, v9
    v_mfma_f32_16x16x32_bf16 a[84:87], a[224:227], v[38:41], a[84:87]
    s_barrier
    ds_read_b128 a[148:151], v105 offset:12288
    v_mfma_f32_16x16x32_bf16 a[88:91], a[228:231], v[38:41], a[88:91]
    ds_read_b128 a[212:215], v0 offset:0
    v_fma_f32 v64, v64, s28, v10
    v_mfma_f32_16x16x32_bf16 a[92:95], a[232:235], v[38:41], a[92:95]
    s_add_u32 m0, s22, 24576
    ds_read_b128 a[216:219], v1 offset:0
    buffer_load_dwordx4 v6, s[8:11], s21 offen lds
    v_mfma_f32_16x16x32_bf16 a[44:47], a[232:235], v[32:35], a[44:47]
    ds_read_b128 a[220:223], v0 offset:1024
    v_mfma_f32_16x16x32_bf16 a[40:43], a[228:231], v[32:35], a[40:43]
    ds_read_b128 a[144:147], v104 offset:12288
    v_exp_f32 v82, v82
    v_mfma_f32_16x16x32_bf16 v[248:251], a[228:231], v[26:29], v[248:251]
    s_add_u32 s21, s21, 128
    ds_read_b128 a[172:175], v105 offset:18432
    s_add_u32 m0, s22, 25600
    v_mfma_f32_16x16x32_bf16 v[252:255], a[232:235], v[26:29], v[252:255]
    ds_read_b128 a[120:123], v104 offset:6144
    buffer_load_dwordx4 v6, s[8:11], s21 offen lds
    v_mfma_f32_16x16x32_bf16 v[204:207], a[232:235], v[20:23], v[204:207]
    ds_read_b128 a[132:135], v105 offset:8192
    v_cvt_pk_bf16_f32 v36, v76, v77
    v_mfma_f32_16x16x32_bf16 v[200:203], a[228:231], v[20:23], v[200:203]
    s_add_u32 s21, s21, 128
    s_add_u32 m0, s22, 26624
    ds_read_b128 a[184:187], v104 offset:22528
    v_mfma_f32_16x16x32_bf16 v[152:155], a[228:231], v[14:17], v[152:155]
    ds_read_b128 a[164:167], v105 offset:16384
    buffer_load_dwordx4 v6, s[8:11], s21 offen lds
    v_mfma_f32_16x16x32_bf16 v[156:159], a[232:235], v[14:17], v[156:159]
    s_waitcnt lgkmcnt(8)
    ds_read_b128 a[224:227], v1 offset:1024
    v_cvt_pk_bf16_f32 v31, v70, v71
    v_mfma_f32_16x16x32_bf16 v[52:55], a[212:215], a[96:99], 0
    s_waitcnt lgkmcnt(8)
    v_exp_f32 v59, v59
    v_mfma_f32_16x16x32_bf16 v[52:55], a[216:219], a[100:103], v[52:55]
    s_waitcnt lgkmcnt(7)
    ds_read_b128 a[232:235], v1 offset:2048
    v_exp_f32 v83, v83
    v_mfma_f32_16x16x32_bf16 v[52:55], a[220:223], a[104:107], v[52:55]
    ds_read_b128 a[228:231], v0 offset:2048
    v_cvt_pk_bf16_f32 v37, v78, v79
    v_mfma_f32_16x16x32_bf16 v[60:63], a[220:223], a[128:131], 0
    ds_read_b128 a[188:191], v105 offset:22528
    v_cvt_pk_bf16_f32 v42, v84, v85
    v_mfma_f32_16x16x32_bf16 v[60:63], a[216:219], a[124:127], v[60:63]
    s_waitcnt lgkmcnt(7)
    ds_read_b128 a[136:139], v104 offset:10240
    v_cvt_pk_bf16_f32 v17, v58, v59
    v_mfma_f32_16x16x32_bf16 v[60:63], a[212:215], a[120:123], v[60:63]
    ds_read_b128 a[112:115], v104 offset:4096
    v_cvt_pk_bf16_f32 v30, v68, v69
    v_mfma_f32_16x16x32_bf16 v[68:71], a[212:215], a[144:147], 0
    ds_read_b128 a[156:159], v105 offset:14336
    v_cvt_pk_bf16_f32 v41, v90, v91
    v_mfma_f32_16x16x32_bf16 v[68:71], a[216:219], a[148:151], v[68:71]
    ds_read_b128 a[140:143], v105 offset:10240
    v_cvt_pk_bf16_f32 v43, v86, v87
    v_mfma_f32_16x16x32_bf16 v[68:71], a[220:223], a[152:155], v[68:71]
    v_exp_f32 v64, v64
    v_mfma_f32_16x16x32_bf16 v[76:79], a[220:223], a[176:179], 0
    v_exp_f32 v74, v74
    v_mfma_f32_16x16x32_bf16 v[76:79], a[216:219], a[172:175], v[76:79]
    ds_read_b128 a[116:119], v105 offset:4096
    v_fma_f32 v80, v80, s28, v12
    v_mfma_f32_16x16x32_bf16 v[76:79], a[212:215], a[168:171], v[76:79]
    s_waitcnt lgkmcnt(7)
    ds_read_b128 a[108:111], v105 offset:2048
    v_exp_f32 v57, v57
    v_mfma_f32_16x16x32_bf16 v[76:79], a[224:227], a[180:183], v[76:79]
    s_waitcnt lgkmcnt(7)
    v_exp_f32 v56, v56
    v_mfma_f32_16x16x32_bf16 v[76:79], a[228:231], a[184:187], v[76:79]
    s_waitcnt lgkmcnt(6)
    ds_read_b128 a[212:215], v0 offset:6144
    v_cvt_pk_bf16_f32 v22, v64, v65
    v_mfma_f32_16x16x32_bf16 v[76:79], a[232:235], a[188:191], v[76:79]
    v_exp_f32 v89, v89
    v_mfma_f32_16x16x32_bf16 v[68:71], a[232:235], a[164:167], v[68:71]
    v_exp_f32 v75, v75
    v_mfma_f32_16x16x32_bf16 v[68:71], a[228:231], a[160:163], v[68:71]
    s_waitcnt lgkmcnt(4)
    v_exp_f32 v80, v80
    v_mfma_f32_16x16x32_bf16 v[68:71], a[224:227], a[156:159], v[68:71]
    v_exp_f32 v72, v72
    v_mfma_f32_16x16x32_bf16 v[60:63], a[224:227], a[132:135], v[60:63]
    v_exp_f32 v66, v66
    v_mfma_f32_16x16x32_bf16 v[60:63], a[228:231], a[136:139], v[60:63]
    s_waitcnt lgkmcnt(3)
    ds_read_b128 a[216:219], v1 offset:6144
    v_cvt_pk_bf16_f32 v23, v66, v67
    v_mfma_f32_16x16x32_bf16 v[60:63], a[232:235], a[140:143], v[60:63]
    s_waitcnt lgkmcnt(3)
    ds_read_b128 a[220:223], v0 offset:7168
    v_cvt_pk_bf16_f32 v40, v88, v89
    v_mfma_f32_16x16x32_bf16 v[52:55], a[232:235], a[116:119], v[52:55]
    v_cvt_pk_bf16_f32 v29, v74, v75
    v_cvt_pk_bf16_f32 v16, v56, v57
    v_mfma_f32_16x16x32_bf16 v[52:55], a[228:231], a[112:115], v[52:55]
    s_waitcnt lgkmcnt(3)
    ds_read_b128 a[232:235], v1 offset:8192
    v_mfma_f32_16x16x32_bf16 v[52:55], a[224:227], a[108:111], v[52:55]
    ds_read_b128 a[228:231], v0 offset:8192
    v_cvt_pk_bf16_f32 v35, v82, v83
    v_mfma_f32_16x16x32_bf16 v[48:51], a[236:239], v[16:19], v[44:47]
    ds_read_b128 a[224:227], v1 offset:7168
    v_cvt_pk_bf16_f32 v28, v72, v73
    v_mfma_f32_16x16x32_bf16 v[48:51], a[240:243], v[22:25], v[48:51]
    v_cvt_pk_bf16_f32 v34, v80, v81
    v_mfma_f32_16x16x32_bf16 v[48:51], a[244:247], v[28:31], v[48:51]
    s_nop 0
    v_mfma_f32_16x16x32_bf16 v[48:51], a[248:251], v[34:37], v[48:51]
    v_mfma_f32_16x16x32_bf16 v[48:51], a[252:255], v[40:43], v[48:51]
    s_waitcnt lgkmcnt(5)
    v_mfma_f32_16x16x32_bf16 v[56:59], a[212:215], a[96:99], 0
    s_waitcnt lgkmcnt(4)
    v_mfma_f32_16x16x32_bf16 v[56:59], a[216:219], a[100:103], v[56:59]
    s_waitcnt lgkmcnt(3)
    v_mfma_f32_16x16x32_bf16 v[56:59], a[220:223], a[104:107], v[56:59]
    s_nop 1
    v_cmp_lt_f32 vcc, s29, v48
    v_mfma_f32_16x16x32_bf16 v[64:67], a[220:223], a[128:131], 0
    s_add_u32 s21, s21, 12032
    v_mfma_f32_16x16x32_bf16 v[64:67], a[216:219], a[124:127], v[64:67]
    v_mfma_f32_16x16x32_bf16 v[64:67], a[212:215], a[120:123], v[64:67]
    s_waitcnt vmcnt(6) lgkmcnt(0)
    s_cbranch_vccnz L_rs_tr54b
L_ret_tr54b:
    v_mfma_f32_16x16x32_bf16 v[72:75], a[212:215], a[144:147], 0
    s_barrier
    v_mfma_f32_16x16x32_bf16 v[72:75], a[216:219], a[148:151], v[72:75]
    s_add_u32 m0, s22, 0
    v_mov_b32 v100, v48
    v_lshrrev_b32 v108, 11, v0
    v_mfma_f32_16x16x32_bf16 v[72:75], a[220:223], a[152:155], v[72:75]
    buffer_load_dwordx4 v6, s[4:7], s20 offen lds
    v_mfma_f32_16x16x32_bf16 v[80:83], a[220:223], a[176:179], 0
    v_and_b32 v101, 0x3ff, v0
    v_xor_b32 v108, s65, v108
    v_mfma_f32_16x16x32_bf16 v[80:83], a[216:219], a[172:175], v[80:83]
    s_add_u32 s20, s20, 128
    v_rcp_f32 v8, v51
    v_mfma_f32_16x16x32_bf16 v[80:83], a[212:215], a[168:171], v[80:83]
    s_add_u32 m0, s22, 1024
    ds_read_b64_tr_b16 a[212:213], v2 offset:18432
    buffer_load_dwordx4 v6, s[4:7], s20 offen lds
    v_lshl_add_u32 v101, v108, 10, v101
    v_mfma_f32_16x16x32_bf16 v[80:83], a[224:227], a[180:183], v[80:83]
    s_add_u32 s20, s20, 128
    ds_read_b64_tr_b16 a[214:215], v2 offset:12288
    v_mbcnt_lo_u32_b32 v108, -1, 0
    v_mfma_f32_16x16x32_bf16 v[80:83], a[228:231], a[184:187], v[80:83]
    s_add_u32 m0, s22, 2048
    ds_read_b64_tr_b16 a[216:217], v3 offset:18432
    buffer_load_dwordx4 v6, s[4:7], s20 offen lds
    v_mfma_f32_16x16x32_bf16 v[80:83], a[232:235], a[188:191], v[80:83]
    ds_read_b64_tr_b16 a[218:219], v3 offset:12288
    v_mbcnt_hi_u32_b32 v108, -1, v108
    v_add_u32 v101, s38, v101
    v_mfma_f32_16x16x32_bf16 v[72:75], a[232:235], a[164:167], v[72:75]
    v_lshrrev_b32 v108, 1, v108
    v_rcp_f32 v50, v50
    v_mfma_f32_16x16x32_bf16 v[72:75], a[228:231], a[160:163], v[72:75]
    v_and_b32 v108, 24, v108
    v_permlane32_swap_b32 v48, v100
    v_mfma_f32_16x16x32_bf16 v[72:75], a[224:227], a[156:159], v[72:75]
    ds_read_b64_tr_b16 a[220:221], v4 offset:18432
    v_bfe_u32 v108, s66, v108, 8
    v_mfma_f32_16x16x32_bf16 v[64:67], a[224:227], a[132:135], v[64:67]
    v_xor_b32 v101, v101, v108
    v_mov_b32 v108, v100
    v_mfma_f32_16x16x32_bf16 v[64:67], a[228:231], a[136:139], v[64:67]
    ds_read_b64_tr_b16 a[222:223], v4 offset:12288
    v_rcp_f32 v102, v49
    v_mfma_f32_16x16x32_bf16 v[64:67], a[232:235], a[140:143], v[64:67]
    v_rcp_f32 v48, v48
    v_mfma_f32_16x16x32_bf16 v[56:59], a[232:235], a[116:119], v[56:59]
    s_add_u32 s20, s20, 12032
    v_permlane16_swap_b32 v100, v108
    v_mfma_f32_16x16x32_bf16 v[56:59], a[228:231], a[112:115], v[56:59]
    v_rcp_f32 v100, v100
    v_mfma_f32_16x16x32_bf16 v[56:59], a[224:227], a[108:111], v[56:59]
    s_waitcnt lgkmcnt(2)
    ds_read_b64_tr_b16 a[224:225], v5 offset:18432
    ds_read_b64_tr_b16 a[226:227], v5 offset:12288
    v_max3_f32 v96, v52, v53, v54
    s_nop 3
    v_max3_f32 v96, v96, v55, v56
    v_max3_f32 v98, v60, v61, v62
    v_max3_f32 v98, v98, v63, v64
    v_mfma_f32_16x16x32_bf16 v[112:115], a[212:215], v[16:19], v[112:115]
    v_max3_f32 v96, v96, v57, v58
    v_max3_f32 v98, v98, v65, v66
    v_mfma_f32_16x16x32_bf16 v[116:119], a[216:219], v[16:19], v[116:119]
    s_mov_b32 s67, s34
    v_max_f32 v98, v98, v67
    v_max_f32 v96, v96, v59
    v_mfma_f32_16x16x32_bf16 v[164:167], a[216:219], v[22:25], v[164:167]
    ds_read_b64_tr_b16 a[230:231], v2 offset:13312
    v_mov_b32 v99, v98
    v_mfma_f32_16x16x32_bf16 v[160:163], a[212:215], v[22:25], v[160:163]
    s_nop 0
    v_permlane32_swap_b32 v99, v98
    v_mfma_f32_16x16x32_bf16 v[208:211], a[212:215], v[28:31], v[208:211]
    ds_read_b64_tr_b16 a[228:229], v2 offset:19456
    v_max_f32 v98, v98, v99
    v_mfma_f32_16x16x32_bf16 v[212:215], a[216:219], v[28:31], v[212:215]
    s_add_u32 s18, s34, 30720
    v_mov_b32 v99, v98
    v_mov_b32 v97, v96
    v_mfma_f32_16x16x32_bf16 a[4:7], a[216:219], v[34:37], a[4:7]
    s_nop 0
    v_permlane32_swap_b32 v97, v96
    v_mfma_f32_16x16x32_bf16 a[0:3], a[212:215], v[34:37], a[0:3]
    v_permlane16_swap_b32 v99, v98
    v_mfma_f32_16x16x32_bf16 a[48:51], a[212:215], v[40:43], a[48:51]
    s_mov_b32 s34, s33
    v_max_f32 v98, v98, v99
    v_mul_f32_e64 v10, -s28, v98
    v_max3_f32 v98, v76, v77, v78
    v_mfma_f32_16x16x32_bf16 a[52:55], a[216:219], v[40:43], a[52:55]
    s_waitcnt lgkmcnt(2)
    ds_read_b64_tr_b16 a[234:235], v3 offset:13312
    v_max_f32 v96, v96, v97
    v_mfma_f32_16x16x32_bf16 a[56:59], a[220:223], v[40:43], a[56:59]
    s_add_u32 s64, s64, s62
    ds_read_b64_tr_b16 a[232:233], v3 offset:19456
    v_mov_b32 v97, v96
    v_fma_f32 v62, v62, s28, v10
    v_mfma_f32_16x16x32_bf16 a[60:63], a[224:227], v[40:43], a[60:63]
    v_permlane16_swap_b32 v97, v96
    v_mfma_f32_16x16x32_bf16 a[12:15], a[224:227], v[34:37], a[12:15]
    s_add_u32 s64, s64, 196608
    ds_read_b64_tr_b16 a[212:213], v4 offset:19456
    v_max3_f32 v98, v98, v79, v80
    v_mfma_f32_16x16x32_bf16 a[8:11], a[220:223], v[34:37], a[8:11]
    s_mov_b32 s39, s64
    ds_read_b64_tr_b16 a[216:217], v5 offset:19456
    v_max_f32 v96, v96, v97
    v_max3_f32 v98, v98, v81, v82
    v_mul_f32_e64 v9, -s28, v96
    v_mfma_f32_16x16x32_bf16 v[216:219], a[220:223], v[28:31], v[216:219]
    s_add_u32 s37, s37, 1
    v_fma_f32 v61, v61, s28, v10
    v_max_f32 v98, v98, v83
    v_mfma_f32_16x16x32_bf16 v[220:223], a[224:227], v[28:31], v[220:223]
    s_bitcmp1_b32 s63, s37
    v_max3_f32 v96, v68, v69, v70
    v_accvgpr_read_b32 v106, a2
    v_mfma_f32_16x16x32_bf16 v[172:175], a[224:227], v[22:25], v[172:175]
    s_cselect_b32 s62, 4294770688, 0
    v_max3_f32 v96, v96, v71, v72
    v_mov_b32 v99, v98
    v_mfma_f32_16x16x32_bf16 v[168:171], a[220:223], v[22:25], v[168:171]
    s_cselect_b32 s42, 0, 325632
    v_permlane32_swap_b32 v99, v98
    v_mfma_f32_16x16x32_bf16 v[120:123], a[220:223], v[16:19], v[120:123]
    s_add_u32 s35, s35, s42
    v_max3_f32 v96, v96, v73, v74
    v_fma_f32 v58, v58, s28, v9
    v_mfma_f32_16x16x32_bf16 v[124:127], a[224:227], v[16:19], v[124:127]
    s_waitcnt lgkmcnt(2)
    ds_read_b64_tr_b16 a[218:219], v5 offset:13312
    v_max_f32 v98, v98, v99
    v_mfma_f32_16x16x32_bf16 v[128:131], a[228:231], v[16:19], v[128:131]
    s_lshl_b32 s42, s37, 1
    ds_read_b64_tr_b16 a[220:221], v2 offset:20480
    v_mov_b32 v99, v98
    v_mfma_f32_16x16x32_bf16 v[132:135], a[232:235], v[16:19], v[132:135]
    s_lshr_b32 s42, s31, s42
    ds_read_b64_tr_b16 a[214:215], v4 offset:13312
    v_permlane16_swap_b32 v99, v98
    v_mfma_f32_16x16x32_bf16 v[180:183], a[232:235], v[22:25], v[180:183]
    s_and_b32 s42, s42, 3
    ds_read_b64_tr_b16 a[224:225], v3 offset:20480
    v_fma_f32 v52, v52, s28, v9
    v_fma_f32 v54, v54, s28, v9
    v_mfma_f32_16x16x32_bf16 v[176:179], a[228:231], v[22:25], v[176:179]
    s_add_u32 s42, s42, s36
    v_max_f32 v96, v96, v75
    v_max_f32 v98, v98, v99
    v_mfma_f32_16x16x32_bf16 v[224:227], a[228:231], v[28:31], v[224:227]
    s_sub_u32 s43, s42, 3
    v_mov_b32 v97, v96
    v_fma_f32 v60, v60, s28, v10
    v_mfma_f32_16x16x32_bf16 v[228:231], a[232:235], v[28:31], v[228:231]
    s_cmp_ge_u32 s42, 3
    ds_read_b64_tr_b16 a[222:223], v2 offset:14336
    v_fma_f32 v64, v64, s28, v10
    v_mfma_f32_16x16x32_bf16 a[20:23], a[232:235], v[34:37], a[20:23]
    s_cselect_b32 s42, s43, s42
    ds_read_b64_tr_b16 a[226:227], v3 offset:14336
    v_permlane32_swap_b32 v97, v96
    v_exp_f32 v62, v62
    v_pk_mul_f32 v[122:123], v[122:123], v[48:49] op_sel_hi:[1,0]
    v_pk_mul_f32 v[174:175], v[174:175], v[102:103] op_sel_hi:[1,0]
    v_fma_f32 v57, v57, s28, v9
    v_accvgpr_read_b32 v108, a48
    v_mfma_f32_16x16x32_bf16 a[16:19], a[228:231], v[34:37], a[16:19]
    s_mul_i32 s44, s3, 5
    v_mul_f32_e64 v12, -s28, v98
    v_exp_f32 v57, v57
    v_mfma_f32_16x16x32_bf16 a[64:67], a[228:231], v[40:43], a[64:67]
    s_mov_b32 s32, 1
    v_max_f32 v96, v96, v97
    v_accvgpr_read_b32 v104, a0
    v_mfma_f32_16x16x32_bf16 a[68:71], a[232:235], v[40:43], a[68:71]
    s_waitcnt lgkmcnt(3)
    ds_read_b64_tr_b16 a[232:233], v5 offset:20480
    v_fma_f32 v66, v66, s28, v10
    v_mov_b32 v97, v96
    v_mfma_f32_16x16x32_bf16 a[72:75], a[212:215], v[40:43], a[72:75]
    s_lshl_b32 s43, s3, 2
    v_permlane16_swap_b32 v97, v96
    v_mfma_f32_16x16x32_bf16 a[76:79], a[216:219], v[40:43], a[76:79]
    s_add_u32 s45, s43, 21
    v_exp_f32 v61, v61
    v_mfma_f32_16x16x32_bf16 a[28:31], a[216:219], v[34:37], a[28:31]
    s_cmp_eq_u32 s3, 0
    ds_read_b64_tr_b16 a[234:235], v5 offset:14336
    v_fma_f32 v55, v55, s28, v9
    v_mfma_f32_16x16x32_bf16 a[24:27], a[212:215], v[34:37], a[24:27]
    s_cselect_b32 s45, 20, s45
    v_fma_f32 v78, v78, s28, v12
    v_fma_f32 v67, v67, s28, v10
    v_mfma_f32_16x16x32_bf16 v[232:235], a[212:215], v[28:31], v[232:235]
    s_cselect_b32 s33, 1, 0
    ds_read_b64_tr_b16 a[228:229], v4 offset:20480
    v_accvgpr_read_b32 v110, a50
    v_mfma_f32_16x16x32_bf16 v[236:239], a[216:219], v[28:31], v[236:239]
    s_cmp_eq_u32 s42, 1
    v_exp_f32 v67, v67
    v_fma_f32 v53, v53, s28, v9
    v_mfma_f32_16x16x32_bf16 v[188:191], a[216:219], v[22:25], v[188:191]
    s_cselect_b32 s44, s45, s44
    v_max_f32 v96, v96, v97
    v_exp_f32 v54, v54
    v_mfma_f32_16x16x32_bf16 v[184:187], a[212:215], v[22:25], v[184:187]
    s_cselect_b32 s32, s33, s32
    s_add_u32 s45, s43, 37
    v_fma_f32 v79, v79, s28, v12
    v_mfma_f32_16x16x32_bf16 v[136:139], a[212:215], v[16:19], v[136:139]
    s_cmp_eq_u32 s42, 2
    s_cselect_b32 s44, s45, s44
    v_accvgpr_read_b32 v105, a1
    v_mfma_f32_16x16x32_bf16 v[140:143], a[216:219], v[16:19], v[140:143]
    s_waitcnt lgkmcnt(2)
    v_fma_f32 v59, v59, s28, v9
    v_mul_f32_e64 v11, -s28, v96
    v_mfma_f32_16x16x32_bf16 v[144:147], a[220:223], v[16:19], v[144:147]
    s_cselect_b32 s32, 0, s32
    s_mul_i32 s44, s44, 6144
    ds_read_b64_tr_b16 a[230:231], v4 offset:14336
    v_mfma_f32_16x16x32_bf16 v[148:151], a[224:227], v[16:19], v[148:151]
    s_add_u32 s33, s35, s44
    s_mul_i32 s42, s32, 6144
    v_fma_f32 v68, v68, s28, v11
    s_add_u32 s42, s42, 24576
    v_mfma_f32_16x16x32_bf16 v[196:199], a[224:227], v[22:25], v[196:199]
    s_add_u32 s42, s42, s33
    v_exp_f32 v52, v52
    v_fma_f32 v74, v74, s28, v11
    v_mfma_f32_16x16x32_bf16 v[192:195], a[220:223], v[22:25], v[192:195]
    s_cmp_ge_u32 s37, 6
    v_accvgpr_read_b32 v109, a49
    v_accvgpr_read_b32 v107, a3
    v_mfma_f32_16x16x32_bf16 v[240:243], a[220:223], v[28:31], v[240:243]
    s_cselect_b32 s14, 0, s42
    v_fma_f32 v69, v69, s28, v11
    v_exp_f32 v53, v53
    v_fma_f32 v63, v63, s28, v10
    v_fma_f32 v65, v65, s28, v10
    v_pk_mul_f32 v[120:121], v[120:121], v[48:49] op_sel_hi:[1,0]
    v_pk_mul_f32 v[112:113], v[112:113], v[48:49] op_sel_hi:[1,0]
    v_fma_f32 v70, v70, s28, v11
    s_add_u32 s24, s67, 6144
    v_mfma_f32_16x16x32_bf16 v[244:247], a[224:227], v[28:31], v[244:247]
    s_add_u32 s25, s33, 6144
    v_exp_f32 v64, v64
    v_mfma_f32_16x16x32_bf16 a[36:39], a[224:227], v[34:37], a[36:39]
    s_add_u32 s23, s38, 6144
    v_exp_f32 v70, v70
    s_mov_b32 s27, 0x30c30
    v_mfma_f32_16x16x32_bf16 a[32:35], a[220:223], v[34:37], a[32:35]
    s_mov_b32 s89, 0xaaaaaaaa
    v_exp_f32 v63, v63
    v_mfma_f32_16x16x32_bf16 a[80:83], a[220:223], v[40:43], a[80:83]
    s_mov_b32 s30, 0
    v_exp_f32 v55, v55
    v_mfma_f32_16x16x32_bf16 a[84:87], a[224:227], v[40:43], a[84:87]
    s_waitcnt vmcnt(6) lgkmcnt(0)
    v_exp_f32 v60, v60
    v_mfma_f32_16x16x32_bf16 a[88:91], a[228:231], v[40:43], a[88:91]
    s_barrier
    ds_read_b128 a[216:219], v1 offset:12288
    v_mfma_f32_16x16x32_bf16 a[92:95], a[232:235], v[40:43], a[92:95]
    ds_read_b128 a[212:215], v0 offset:12288
    v_fma_f32 v71, v71, s28, v11
    v_mfma_f32_16x16x32_bf16 a[44:47], a[232:235], v[34:37], a[44:47]
    ds_read_b128 a[220:223], v0 offset:13312
    v_fma_f32 v80, v80, s28, v12
    v_mfma_f32_16x16x32_bf16 a[40:43], a[228:231], v[34:37], a[40:43]
    v_exp_f32 v69, v69
    v_mfma_f32_16x16x32_bf16 v[248:251], a[228:231], v[28:31], v[248:251]
    v_fma_f32 v82, v82, s28, v12
    v_cvt_pk_bf16_f32 v20, v60, v61
    v_cvt_pk_bf16_f32 v14, v52, v53
    v_fma_f32 v75, v75, s28, v11
    v_mfma_f32_16x16x32_bf16 v[252:255], a[232:235], v[28:31], v[252:255]
    v_cvt_pk_bf16_f32 v21, v62, v63
    v_accvgpr_read_b32 v111, a51
    v_mfma_f32_16x16x32_bf16 v[204:207], a[232:235], v[22:25], v[204:207]
    v_exp_f32 v58, v58
    v_mfma_f32_16x16x32_bf16 v[200:203], a[228:231], v[22:25], v[200:203]
    v_fma_f32 v76, v76, s28, v12
    v_fma_f32 v72, v72, s28, v11
    v_fma_f32 v77, v77, s28, v12
    v_mfma_f32_16x16x32_bf16 v[152:155], a[228:231], v[16:19], v[152:155]
    v_exp_f32 v68, v68
    v_fma_f32 v73, v73, s28, v11
    v_exp_f32 v76, v76
    v_cvt_pk_bf16_f32 v15, v54, v55
    v_mfma_f32_16x16x32_bf16 v[156:159], a[232:235], v[16:19], v[156:159]
    s_waitcnt lgkmcnt(1)
    v_exp_f32 v77, v77
    v_fma_f32 v81, v81, s28, v12
    v_mfma_f32_16x16x32_bf16 v[52:55], a[212:215], a[96:99], 0
    ds_read_b128 a[224:227], v1 offset:13312
    v_cvt_pk_bf16_f32 v32, v76, v77
    v_mfma_f32_16x16x32_bf16 v[52:55], a[216:219], a[100:103], v[52:55]
    s_waitcnt lgkmcnt(1)
    ds_read_b128 a[228:231], v0 offset:14336
    v_fma_f32 v56, v56, s28, v9
    v_mfma_f32_16x16x32_bf16 v[52:55], a[220:223], a[104:107], v[52:55]
    v_exp_f32 v71, v71
    v_mfma_f32_16x16x32_bf16 v[60:63], a[220:223], a[128:131], 0
    v_exp_f32 v79, v79
    v_mfma_f32_16x16x32_bf16 v[60:63], a[216:219], a[124:127], v[60:63]
    ds_read_b128 a[232:235], v1 offset:14336
    v_cvt_pk_bf16_f32 v27, v70, v71
    v_cvt_pk_bf16_f32 v26, v68, v69
    v_mfma_f32_16x16x32_bf16 v[60:63], a[212:215], a[120:123], v[60:63]
    v_exp_f32 v75, v75
    v_mfma_f32_16x16x32_bf16 v[68:71], a[212:215], a[144:147], 0
    v_exp_f32 v81, v81
    v_mfma_f32_16x16x32_bf16 v[68:71], a[216:219], a[148:151], v[68:71]
    v_exp_f32 v78, v78
    v_mfma_f32_16x16x32_bf16 v[68:71], a[220:223], a[152:155], v[68:71]
    v_exp_f32 v59, v59
    v_cvt_pk_bf16_f32 v33, v78, v79
    v_mfma_f32_16x16x32_bf16 v[76:79], a[220:223], a[176:179], 0
    v_exp_f32 v66, v66
    v_exp_f32 v65, v65
    v_mfma_f32_16x16x32_bf16 v[76:79], a[216:219], a[172:175], v[76:79]
    s_add_u32 m0, s22, 36864
    v_cvt_pk_bf16_f32 v22, v64, v65
    v_exp_f32 v72, v72
    v_mfma_f32_16x16x32_bf16 v[76:79], a[212:215], a[168:171], v[76:79]
    s_waitcnt lgkmcnt(1)
    v_exp_f32 v56, v56
    v_mfma_f32_16x16x32_bf16 v[76:79], a[224:227], a[180:183], v[76:79]
    buffer_load_dwordx4 v6, s[8:11], s21 offen lds
    v_mfma_f32_16x16x32_bf16 v[76:79], a[228:231], a[184:187], v[76:79]
    s_waitcnt lgkmcnt(0)
    v_exp_f32 v74, v74
    v_mfma_f32_16x16x32_bf16 v[76:79], a[232:235], a[188:191], v[76:79]
    v_fma_f32 v83, v83, s28, v12
    v_cvt_pk_bf16_f32 v23, v66, v67
    v_mfma_f32_16x16x32_bf16 v[68:71], a[232:235], a[164:167], v[68:71]
    v_exp_f32 v80, v80
    v_mfma_f32_16x16x32_bf16 v[68:71], a[228:231], a[160:163], v[68:71]
    ds_read_b128 a[216:219], v1 offset:18432
    v_cvt_pk_bf16_f32 v34, v80, v81
    v_mfma_f32_16x16x32_bf16 v[68:71], a[224:227], a[156:159], v[68:71]
    v_exp_f32 v83, v83
    v_mfma_f32_16x16x32_bf16 v[60:63], a[224:227], a[132:135], v[60:63]
    s_add_u32 s21, s21, 128
    v_exp_f32 v73, v73
    v_mfma_f32_16x16x32_bf16 v[60:63], a[228:231], a[136:139], v[60:63]
    ds_read_b128 a[212:215], v0 offset:18432
    v_cvt_pk_bf16_f32 v16, v56, v57
    v_mfma_f32_16x16x32_bf16 v[60:63], a[232:235], a[140:143], v[60:63]
    s_add_u32 m0, s22, 37888
    ds_read_b128 a[220:223], v0 offset:19456
    v_fma_f32 v76, v76, s28, v12
    v_mfma_f32_16x16x32_bf16 v[52:55], a[232:235], a[116:119], v[52:55]
    buffer_load_dwordx4 v6, s[8:11], s21 offen lds
    v_mfma_f32_16x16x32_bf16 v[52:55], a[228:231], a[112:115], v[52:55]
    v_exp_f32 v76, v76
    v_mfma_f32_16x16x32_bf16 v[52:55], a[224:227], a[108:111], v[52:55]
    ds_read_b128 a[224:227], v1 offset:19456
    v_fma_f32 v70, v70, s28, v11
    v_cvt_pk_bf16_f32 v28, v72, v73
    v_exp_f32 v82, v82
    v_pk_mul_f32 v[178:179], v[178:179], v[102:103] op_sel_hi:[1,0]
    v_fma_f32 v60, v60, s28, v10
    v_pk_mul_f32 v[222:223], v[222:223], v[50:51] op_sel_hi:[1,0]
    v_pk_mul_f32 v[176:177], v[176:177], v[102:103] op_sel_hi:[1,0]
    v_pk_mul_f32 v[114:115], v[114:115], v[48:49] op_sel_hi:[1,0]
    v_pk_mul_f32 v[164:165], v[164:165], v[102:103] op_sel_hi:[1,0]
    v_pk_mul_f32 v[244:245], v[244:245], v[50:51] op_sel_hi:[1,0]
    v_pk_mul_f32 v[124:125], v[124:125], v[48:49] op_sel_hi:[1,0]
    v_pk_mul_f32 v[104:105], v[104:105], v[8:9] op_sel_hi:[1,0]
    v_pk_mul_f32 v[212:213], v[212:213], v[50:51] op_sel_hi:[1,0]
    v_pk_mul_f32 v[228:229], v[228:229], v[50:51] op_sel_hi:[1,0]
    v_pk_mul_f32 v[208:209], v[208:209], v[50:51] op_sel_hi:[1,0]
    v_cvt_pk_bf16_f32 v17, v58, v59
    v_pk_mul_f32 v[162:163], v[162:163], v[102:103] op_sel_hi:[1,0]
    v_pk_mul_f32 v[180:181], v[180:181], v[102:103] op_sel_hi:[1,0]
    v_pk_mul_f32 v[210:211], v[210:211], v[50:51] op_sel_hi:[1,0]
    v_pk_mul_f32 v[110:111], v[110:111], v[100:101] op_sel_hi:[1,0]
    v_pk_mul_f32 v[230:231], v[230:231], v[50:51] op_sel_hi:[1,0]
    v_pk_mul_f32 v[216:217], v[216:217], v[50:51] op_sel_hi:[1,0]
    v_pk_mul_f32 v[254:255], v[254:255], v[50:51] op_sel_hi:[1,0]
    v_pk_mul_f32 v[116:117], v[116:117], v[48:49] op_sel_hi:[1,0]
    v_pk_mul_f32 v[106:107], v[106:107], v[8:9] op_sel_hi:[1,0]
    v_pk_mul_f32 v[160:161], v[160:161], v[102:103] op_sel_hi:[1,0]
    v_pk_mul_f32 v[168:169], v[168:169], v[102:103] op_sel_hi:[1,0]
    v_pk_mul_f32 v[232:233], v[232:233], v[50:51] op_sel_hi:[1,0]
    v_pk_mul_f32 v[184:185], v[184:185], v[102:103] op_sel_hi:[1,0]
    v_pk_mul_f32 v[214:215], v[214:215], v[50:51] op_sel_hi:[1,0]
    v_cvt_pk_bf16_f32 v176, v176, v177
    v_pk_mul_f32 v[108:109], v[108:109], v[100:101] op_sel_hi:[1,0]
    v_cvt_pk_bf16_f32 v244, v244, v245
    s_waitcnt lgkmcnt(1)
    v_mfma_f32_16x16x32_bf16 v[56:59], a[212:215], a[96:99], 0
    ds_read_b128 a[232:235], v1 offset:20480
    v_cvt_pk_bf16_f32 v112, v112, v113
    v_mfma_f32_16x16x32_bf16 v[56:59], a[216:219], a[100:103], v[56:59]
    s_add_u32 s21, s21, 128
    ds_read_b128 a[228:231], v0 offset:20480
    v_fma_f32 v71, v71, s28, v11
    v_cvt_pk_bf16_f32 v35, v82, v83
    v_mfma_f32_16x16x32_bf16 v[56:59], a[220:223], a[104:107], v[56:59]
    s_add_u32 m0, s22, 38912
    v_cvt_pk_bf16_f32 v104, v104, v105
    v_cvt_pk_bf16_f32 v113, v114, v115
    v_mov_b32 v38, v6
    v_mfma_f32_16x16x32_bf16 v[64:67], a[220:223], a[128:131], 0
    v_fma_f32 v69, v69, s28, v11
    v_fma_f32 v55, v55, s28, v9
    v_mfma_f32_16x16x32_bf16 v[64:67], a[216:219], a[124:127], v[64:67]
    v_cvt_pk_bf16_f32 v160, v160, v161
    v_cvt_pk_bf16_f32 v120, v120, v121
    v_mfma_f32_16x16x32_bf16 v[64:67], a[212:215], a[120:123], v[64:67]
    v_cvt_pk_bf16_f32 v29, v74, v75
    v_cvt_pk_bf16_f32 v161, v162, v163
    v_mfma_f32_16x16x32_bf16 v[72:75], a[212:215], a[144:147], 0
    v_fma_f32 v53, v53, s28, v9
    v_cvt_pk_bf16_f32 v164, v164, v165
    v_mfma_f32_16x16x32_bf16 v[72:75], a[216:219], a[148:151], v[72:75]
    v_fma_f32 v78, v78, s28, v12
    v_exp_f32 v53, v53
    v_mfma_f32_16x16x32_bf16 v[72:75], a[220:223], a[152:155], v[72:75]
    buffer_load_dwordx4 v6, s[8:11], s21 offen lds
    v_mfma_f32_16x16x32_bf16 v[80:83], a[220:223], a[176:179], 0
    s_add_u32 s21, s21, 12032
    v_cvt_pk_bf16_f32 v116, v116, v117
    v_cvt_pk_bf16_f32 v108, v108, v109
    v_mfma_f32_16x16x32_bf16 v[80:83], a[216:219], a[172:175], v[80:83]
    s_waitcnt vmcnt(6) lgkmcnt(0)
    v_cvt_pk_bf16_f32 v216, v216, v217
    v_cvt_pk_bf16_f32 v105, v106, v107
    v_mfma_f32_16x16x32_bf16 v[80:83], a[212:215], a[168:171], v[80:83]
    s_barrier
    v_mfma_f32_16x16x32_bf16 v[80:83], a[224:227], a[180:183], v[80:83]
    v_cvt_pk_bf16_f32 v208, v208, v209
    v_cvt_pk_bf16_f32 v212, v212, v213
    v_mfma_f32_16x16x32_bf16 v[80:83], a[228:231], a[184:187], v[80:83]
    ds_read_b64_tr_b16 a[212:213], v2 offset:0
    v_cvt_pk_bf16_f32 v121, v122, v123
    v_mfma_f32_16x16x32_bf16 v[80:83], a[232:235], a[188:191], v[80:83]
    v_cvt_pk_bf16_f32 v109, v110, v111
    v_exp_f32 v70, v70
    v_mfma_f32_16x16x32_bf16 v[72:75], a[232:235], a[164:167], v[72:75]
    ds_read_b64_tr_b16 a[214:215], v2 offset:6144
    v_fma_f32 v68, v68, s28, v11
    v_cvt_pk_bf16_f32 v168, v168, v169
    v_mfma_f32_16x16x32_bf16 v[72:75], a[228:231], a[160:163], v[72:75]
    s_add_u32 m0, s22, 12288
    ds_write2st64_b64 v101, v[112:113], v[160:161] offset0:0 offset1:12
    v_pk_mul_f32 v[166:167], v[166:167], v[102:103] op_sel_hi:[1,0]
    v_pk_mul_f32 v[138:139], v[138:139], v[48:49] op_sel_hi:[1,0]
    v_pk_mul_f32 v[200:201], v[200:201], v[102:103] op_sel_hi:[1,0]
    v_pk_mul_f32 v[240:241], v[240:241], v[50:51] op_sel_hi:[1,0]
    v_accvgpr_read_b32 v107, a7
    v_fma_f32 v80, v80, s28, v12
    v_mfma_f32_16x16x32_bf16 v[72:75], a[224:227], a[156:159], v[72:75]
    v_fma_f32 v52, v52, s28, v9
    v_cvt_pk_bf16_f32 v209, v210, v211
    v_mfma_f32_16x16x32_bf16 v[64:67], a[224:227], a[132:135], v[64:67]
    ds_read_b64_tr_b16 a[216:217], v3 offset:0
    v_cvt_pk_bf16_f32 v124, v124, v125
    v_mfma_f32_16x16x32_bf16 v[64:67], a[228:231], a[136:139], v[64:67]
    v_exp_f32 v78, v78
    v_mfma_f32_16x16x32_bf16 v[64:67], a[232:235], a[140:143], v[64:67]
    ds_read_b64_tr_b16 a[218:219], v3 offset:6144
    v_exp_f32 v68, v68
    v_cvt_pk_bf16_f32 v228, v228, v229
    v_exp_f32 v60, v60
    v_mfma_f32_16x16x32_bf16 v[56:59], a[232:235], a[116:119], v[56:59]
    ds_write2st64_b64 v101, v[208:209], v[104:105] offset0:24 offset1:36
    v_mfma_f32_16x16x32_bf16 v[56:59], a[228:231], a[112:115], v[56:59]
    ds_read_b64_tr_b16 a[220:221], v4 offset:0
    v_accvgpr_read_b32 v111, a55
    v_accvgpr_read_b32 v104, a4
    v_accvgpr_read_b32 v106, a6
    v_mfma_f32_16x16x32_bf16 v[56:59], a[224:227], a[108:111], v[56:59]
    s_waitcnt lgkmcnt(4)
    ds_write_b64 v101, v[108:109] offset:24576
    v_mfma_f32_16x16x32_bf16 v[112:115], a[212:215], v[14:17], 0
    buffer_load_dwordx4 v6, s[4:7], s20 offen lds
    ds_read_b64_tr_b16 a[222:223], v4 offset:6144
    v_cvt_pk_bf16_f32 v177, v178, v179
    v_accvgpr_read_b32 v105, a5
    v_accvgpr_read_b32 v108, a52
    v_fma_f32 v73, v73, s28, v11
    v_pk_mul_f32 v[128:129], v[128:129], v[48:49] op_sel_hi:[1,0]
    v_pk_mul_f32 v[220:221], v[220:221], v[50:51] op_sel_hi:[1,0]
    v_pk_mul_f32 v[248:249], v[248:249], v[50:51] op_sel_hi:[1,0]
    v_pk_mul_f32 v[104:105], v[104:105], v[8:9] op_sel_hi:[1,0]
    v_pk_mul_f32 v[134:135], v[134:135], v[48:49] op_sel_hi:[1,0]
    v_pk_mul_f32 v[156:157], v[156:157], v[48:49] op_sel_hi:[1,0]
    v_cvt_pk_bf16_f32 v180, v180, v181
    v_pk_mul_f32 v[182:183], v[182:183], v[102:103] op_sel_hi:[1,0]
    v_pk_mul_f32 v[118:119], v[118:119], v[48:49] op_sel_hi:[1,0]
    v_accvgpr_read_b32 v110, a54
    v_cvt_pk_bf16_f32 v248, v248, v249
    v_pk_mul_f32 v[106:107], v[106:107], v[8:9] op_sel_hi:[1,0]
    v_accvgpr_read_b32 v109, a53
    v_cvt_pk_bf16_f32 v165, v166, v167
    v_exp_f32 v73, v73
    v_pk_mul_f32 v[218:219], v[218:219], v[50:51] op_sel_hi:[1,0]
    v_cvt_pk_bf16_f32 v104, v104, v105
    v_fma_f32 v81, v81, s28, v12
    v_pk_mul_f32 v[236:237], v[236:237], v[50:51] op_sel_hi:[1,0]
    v_pk_mul_f32 v[186:187], v[186:187], v[102:103] op_sel_hi:[1,0]
    v_pk_mul_f32 v[108:109], v[108:109], v[100:101] op_sel_hi:[1,0]
    v_fma_f32 v62, v62, s28, v10
    v_xor_b32 v101, 32, v101
    v_fma_f32 v79, v79, s28, v12
    v_pk_mul_f32 v[188:189], v[188:189], v[102:103] op_sel_hi:[1,0]
    v_cvt_pk_bf16_f32 v117, v118, v119
    v_pk_mul_f32 v[140:141], v[140:141], v[48:49] op_sel_hi:[1,0]
    v_pk_mul_f32 v[136:137], v[136:137], v[48:49] op_sel_hi:[1,0]
    v_pk_mul_f32 v[170:171], v[170:171], v[102:103] op_sel_hi:[1,0]
    v_pk_mul_f32 v[110:111], v[110:111], v[100:101] op_sel_hi:[1,0]
    v_pk_mul_f32 v[224:225], v[224:225], v[50:51] op_sel_hi:[1,0]
    v_pk_mul_f32 v[172:173], v[172:173], v[102:103] op_sel_hi:[1,0]
    v_cvt_pk_bf16_f32 v200, v200, v201
    v_fma_f32 v75, v75, s28, v11
    v_cvt_pk_bf16_f32 v213, v214, v215
    v_cvt_pk_bf16_f32 v105, v106, v107
    v_mfma_f32_16x16x32_bf16 v[44:47], a[236:239], v[14:17], 0
    ds_read_b64_tr_b16 a[228:229], v2 offset:1024
    v_cvt_pk_bf16_f32 v108, v108, v109
    v_mfma_f32_16x16x32_bf16 v[160:163], a[212:215], v[20:23], 0
    ds_read_b64_tr_b16 a[232:233], v3 offset:1024
    v_fma_f32 v63, v63, s28, v10
    v_mfma_f32_16x16x32_bf16 v[208:211], a[212:215], v[26:29], 0
    s_add_u32 s20, s20, 128
    ds_write2st64_b64 v101, v[116:117], v[164:165] offset0:0 offset1:12
    v_mfma_f32_16x16x32_bf16 a[0:3], a[212:215], v[32:35], 0
    ds_write2st64_b64 v101, v[212:213], v[104:105] offset0:24 offset1:36
    v_cvt_pk_bf16_f32 v172, v172, v173
    v_cvt_pk_bf16_f32 v220, v220, v221
    v_cvt_pk_bf16_f32 v109, v110, v111
    v_mfma_f32_16x16x32_bf16 v[44:47], a[240:243], v[20:23], v[44:47]
    s_waitcnt lgkmcnt(4)
    ds_read_b64_tr_b16 a[234:235], v3 offset:7168
    v_fma_f32 v61, v61, s28, v10
    v_accvgpr_read_b32 v107, a11
    v_mfma_f32_16x16x32_bf16 a[4:7], a[216:219], v[32:35], 0
    ds_write_b64 v101, v[108:109] offset:24576
    v_exp_f32 v55, v55
    v_pk_mul_f32 v[152:153], v[152:153], v[48:49] op_sel_hi:[1,0]
    v_pk_mul_f32 v[190:191], v[190:191], v[102:103] op_sel_hi:[1,0]
    v_pk_mul_f32 v[250:251], v[250:251], v[50:51] op_sel_hi:[1,0]
    v_cvt_pk_bf16_f32 v188, v188, v189
    v_accvgpr_read_b32 v104, a8
    v_accvgpr_read_b32 v110, a58
    v_exp_f32 v52, v52
    v_mfma_f32_16x16x32_bf16 v[212:215], a[216:219], v[26:29], 0
    ds_read_b64_tr_b16 a[224:225], v5 offset:0
    v_accvgpr_read_b32 v105, a9
    v_cvt_pk_bf16_f32 v136, v136, v137
    v_cvt_pk_bf16_f32 v169, v170, v171
    v_accvgpr_read_b32 v111, a59
    v_accvgpr_read_b32 v109, a57
    v_pk_mul_f32 v[110:111], v[110:111], v[100:101] op_sel_hi:[1,0]
    v_pk_mul_f32 v[104:105], v[104:105], v[8:9] op_sel_hi:[1,0]
    v_xor_b32 v101, 96, v101
    v_accvgpr_read_b32 v108, a56
    v_pk_mul_f32 v[226:227], v[226:227], v[50:51] op_sel_hi:[1,0]
    v_cvt_pk_bf16_f32 v217, v218, v219
    v_cvt_pk_bf16_f32 v128, v128, v129
    v_pk_mul_f32 v[132:133], v[132:133], v[48:49] op_sel_hi:[1,0]
    v_pk_mul_f32 v[158:159], v[158:159], v[48:49] op_sel_hi:[1,0]
    v_cvt_pk_bf16_f32 v221, v222, v223
    v_cvt_pk_bf16_f32 v104, v104, v105
    v_pk_mul_f32 v[126:127], v[126:127], v[48:49] op_sel_hi:[1,0]
    v_accvgpr_read_b32 v106, a10
    v_pk_mul_f32 v[204:205], v[204:205], v[102:103] op_sel_hi:[1,0]
    v_pk_mul_f32 v[108:109], v[108:109], v[100:101] op_sel_hi:[1,0]
    v_pk_mul_f32 v[106:107], v[106:107], v[8:9] op_sel_hi:[1,0]
    v_pk_mul_f32 v[148:149], v[148:149], v[48:49] op_sel_hi:[1,0]
    v_pk_mul_f32 v[246:247], v[246:247], v[50:51] op_sel_hi:[1,0]
    v_cvt_pk_bf16_f32 v108, v108, v109
    v_fma_f32 v67, v67, s28, v10
    v_pk_mul_f32 v[130:131], v[130:131], v[48:49] op_sel_hi:[1,0]
    v_cvt_pk_bf16_f32 v109, v110, v111
    v_cvt_pk_bf16_f32 v105, v106, v107
    v_mfma_f32_16x16x32_bf16 v[44:47], a[244:247], v[26:29], v[44:47]
    ds_read_b64_tr_b16 a[212:213], v4 offset:1024
    v_accvgpr_read_b32 v107, a15
    v_accvgpr_read_b32 v106, a14
    v_fma_f32 v83, v83, s28, v12
    v_mfma_f32_16x16x32_bf16 v[164:167], a[216:219], v[20:23], 0
    ds_read_b64_tr_b16 a[230:231], v2 offset:7168
    v_fma_f32 v77, v77, s28, v12
    v_mfma_f32_16x16x32_bf16 v[44:47], a[248:251], v[32:35], v[44:47]
    ds_write2st64_b64 v101, v[120:121], v[168:169] offset0:0 offset1:12
    v_fma_f32 v66, v66, s28, v10
    v_cvt_pk_bf16_f32 v240, v240, v241
    v_mfma_f32_16x16x32_bf16 v[116:119], a[216:219], v[14:17], 0
    ds_write2st64_b64 v101, v[216:217], v[104:105] offset0:24 offset1:36
    v_cvt_pk_bf16_f32 v236, v236, v237
    v_mfma_f32_16x16x32_bf16 v[120:123], a[220:223], v[14:17], 0
    ds_read_b64_tr_b16 a[226:227], v5 offset:6144
    v_cvt_pk_bf16_f32 v249, v250, v251
    v_mfma_f32_16x16x32_bf16 v[168:171], a[220:223], v[20:23], 0
    ds_write_b64 v101, v[108:109] offset:24576
    v_cvt_pk_bf16_f32 v132, v132, v133
    v_exp_f32 v61, v61
    v_pk_mul_f32 v[206:207], v[206:207], v[102:103] op_sel_hi:[1,0]
    v_accvgpr_read_b32 v104, a12
    v_accvgpr_read_b32 v111, a63
    v_cvt_pk_bf16_f32 v229, v230, v231
    v_pk_mul_f32 v[106:107], v[106:107], v[8:9] op_sel_hi:[1,0]
    v_cvt_pk_bf16_f32 v189, v190, v191
    v_accvgpr_read_b32 v108, a60
    v_accvgpr_read_b32 v105, a13
    v_fma_f32 v57, v57, s28, v9
    v_pk_mul_f32 v[252:253], v[252:253], v[50:51] op_sel_hi:[1,0]
    v_accvgpr_read_b32 v110, a62
    v_subrev_u32 v103, 28672, v103
    v_pk_mul_f32 v[234:235], v[234:235], v[50:51] op_sel_hi:[1,0]
    v_pk_mul_f32 v[242:243], v[242:243], v[50:51] op_sel_hi:[1,0]
    v_cvt_pk_bf16_f32 v129, v130, v131
    v_pk_mul_f32 v[110:111], v[110:111], v[100:101] op_sel_hi:[1,0]
    v_cvt_pk_bf16_f32 v173, v174, v175
    v_pk_mul_f32 v[196:197], v[196:197], v[102:103] op_sel_hi:[1,0]
    v_cvt_pk_bf16_f32 v125, v126, v127
    v_accvgpr_read_b32 v109, a61
    v_cvt_pk_bf16_f32 v224, v224, v225
    v_pk_mul_f32 v[108:109], v[108:109], v[100:101] op_sel_hi:[1,0]
    v_pk_mul_f32 v[104:105], v[104:105], v[8:9] op_sel_hi:[1,0]
    v_cvt_pk_bf16_f32 v24, v60, v61
    v_xor_b32 v101, 32, v101
    v_pk_mul_f32 v[192:193], v[192:193], v[102:103] op_sel_hi:[1,0]
    v_cvt_pk_bf16_f32 v104, v104, v105
    v_cvt_pk_bf16_f32 v105, v106, v107
    v_cvt_pk_bf16_f32 v108, v108, v109
    v_pk_mul_f32 v[142:143], v[142:143], v[48:49] op_sel_hi:[1,0]
    v_cvt_pk_bf16_f32 v196, v196, v197
    v_cvt_pk_bf16_f32 v109, v110, v111
    v_accvgpr_read_b32 v106, a18
    v_mfma_f32_16x16x32_bf16 v[216:219], a[220:223], v[26:29], 0
    ds_write2st64_b64 v101, v[124:125], v[172:173] offset0:0 offset1:12
    v_exp_f32 v62, v62
    v_accvgpr_read_b32 v110, a66
    v_mfma_f32_16x16x32_bf16 a[8:11], a[220:223], v[32:35], 0
    s_waitcnt lgkmcnt(1)
    ds_write2st64_b64 v101, v[220:221], v[104:105] offset0:24 offset1:36
    v_mfma_f32_16x16x32_bf16 a[12:15], a[224:227], v[32:35], 0
    ds_write_b64 v101, v[108:109] offset:24576
    v_mfma_f32_16x16x32_bf16 v[220:223], a[224:227], v[26:29], 0
    ds_read_b64_tr_b16 a[214:215], v4 offset:7168
    ds_read_b64_tr_b16 a[220:221], v2 offset:2048
    ds_read_b64_tr_b16 a[222:223], v2 offset:8192
    v_cvt_pk_bf16_f32 v133, v134, v135
    v_accvgpr_read_b32 v104, a16
    v_accvgpr_read_b32 v109, a65
    v_accvgpr_read_b32 v107, a19
    v_pk_mul_f32 v[144:145], v[144:145], v[48:49] op_sel_hi:[1,0]
    v_accvgpr_read_b32 v108, a64
    v_accvgpr_read_b32 v105, a17
    v_xor_b32 v101, 96, v101
    v_pk_mul_f32 v[108:109], v[108:109], v[100:101] op_sel_hi:[1,0]
    v_cvt_pk_bf16_f32 v232, v232, v233
    v_pk_mul_f32 v[106:107], v[106:107], v[8:9] op_sel_hi:[1,0]
    v_cvt_pk_bf16_f32 v225, v226, v227
    v_fma_f32 v54, v54, s28, v9
    v_pk_mul_f32 v[104:105], v[104:105], v[8:9] op_sel_hi:[1,0]
    v_accvgpr_read_b32 v111, a67
    v_cvt_pk_bf16_f32 v108, v108, v109
    v_cvt_pk_bf16_f32 v181, v182, v183
    v_cvt_pk_bf16_f32 v104, v104, v105
    v_cvt_pk_bf16_f32 v152, v152, v153
    v_cvt_pk_bf16_f32 v140, v140, v141
    v_cvt_pk_bf16_f32 v105, v106, v107
    v_pk_mul_f32 v[110:111], v[110:111], v[100:101] op_sel_hi:[1,0]
    v_cvt_pk_bf16_f32 v144, v144, v145
    v_fma_f32 v58, v58, s28, v9
    v_mov_b32 v39, v7
    v_pk_mul_f32 v[150:151], v[150:151], v[48:49] op_sel_hi:[1,0]
    v_cvt_pk_bf16_f32 v109, v110, v111
    v_accvgpr_read_b32 v110, a70
    v_mfma_f32_16x16x32_bf16 v[172:175], a[224:227], v[20:23], 0
    s_add_u32 m0, s22, 13312
    ds_write2st64_b64 v101, v[128:129], v[176:177] offset0:4 offset1:16
    v_mfma_f32_16x16x32_bf16 v[124:127], a[224:227], v[14:17], 0
    ds_write2st64_b64 v101, v[224:225], v[104:105] offset0:28 offset1:40
    v_mfma_f32_16x16x32_bf16 v[128:131], a[228:231], v[14:17], 0
    ds_read_b64_tr_b16 a[216:217], v5 offset:1024
    ds_read_b64_tr_b16 a[218:219], v5 offset:7168
    v_cvt_pk_bf16_f32 v204, v204, v205
    v_mfma_f32_16x16x32_bf16 v[176:179], a[228:231], v[20:23], 0
    buffer_load_dwordx4 v6, s[4:7], s20 offen lds
    ds_write_b64 v101, v[108:109] offset:26624
    v_accvgpr_read_b32 v108, a68
    v_accvgpr_read_b32 v104, a20
    v_accvgpr_read_b32 v105, a21
    v_cvt_pk_bf16_f32 v241, v242, v243
    v_accvgpr_read_b32 v109, a69
    v_cvt_pk_bf16_f32 v192, v192, v193
    v_fma_f32 v74, v74, s28, v11
    v_accvgpr_read_b32 v106, a22
    v_accvgpr_read_b32 v107, a23
    v_accvgpr_read_b32 v111, a71
    v_xor_b32 v101, 32, v101
    v_pk_mul_f32 v[104:105], v[104:105], v[8:9] op_sel_hi:[1,0]
    v_pk_mul_f32 v[108:109], v[108:109], v[100:101] op_sel_hi:[1,0]
    v_pk_mul_f32 v[110:111], v[110:111], v[100:101] op_sel_hi:[1,0]
    v_pk_mul_f32 v[194:195], v[194:195], v[102:103] op_sel_hi:[1,0]
    v_exp_f32 v58, v58
    v_cvt_pk_bf16_f32 v104, v104, v105
    v_cvt_pk_bf16_f32 v252, v252, v253
    v_pk_mul_f32 v[106:107], v[106:107], v[8:9] op_sel_hi:[1,0]
    v_pk_mul_f32 v[238:239], v[238:239], v[50:51] op_sel_hi:[1,0]
    v_cvt_pk_bf16_f32 v184, v184, v185
    v_cvt_pk_bf16_f32 v105, v106, v107
    v_mfma_f32_16x16x32_bf16 v[224:227], a[228:231], v[26:29], 0
    ds_write2st64_b64 v101, v[132:133], v[180:181] offset0:4 offset1:16
    v_pk_mul_f32 v[202:203], v[202:203], v[102:103] op_sel_hi:[1,0]
    v_cvt_pk_bf16_f32 v148, v148, v149
    v_cvt_pk_bf16_f32 v245, v246, v247
    v_cvt_pk_bf16_f32 v108, v108, v109
    v_cvt_pk_bf16_f32 v109, v110, v111
    v_accvgpr_read_b32 v107, a27
    v_mfma_f32_16x16x32_bf16 a[16:19], a[228:231], v[32:35], 0
    s_add_u32 s20, s20, 128
    ds_write2st64_b64 v101, v[228:229], v[104:105] offset0:28 offset1:40
    v_mfma_f32_16x16x32_bf16 a[20:23], a[232:235], v[32:35], 0
    s_add_u32 m0, s22, 14336
    ds_read_b64_tr_b16 a[230:231], v4 offset:8192
    ds_write_b64 v101, v[108:109] offset:26624
    v_accvgpr_read_b32 v108, a72
    v_cvt_pk_bf16_f32 v141, v142, v143
    v_accvgpr_read_b32 v111, a75
    v_pk_mul_f32 v[154:155], v[154:155], v[48:49] op_sel_hi:[1,0]
    v_accvgpr_read_b32 v109, a73
    v_exp_f32 v71, v71
    v_pk_mul_f32 v[108:109], v[108:109], v[100:101] op_sel_hi:[1,0]
    v_cvt_pk_bf16_f32 v185, v186, v187
    v_cvt_pk_bf16_f32 v108, v108, v109
    v_accvgpr_read_b32 v104, a24
    v_cvt_pk_bf16_f32 v193, v194, v195
    v_fma_f32 v64, v64, s28, v10
    v_accvgpr_read_b32 v106, a26
    v_accvgpr_read_b32 v105, a25
    v_cvt_pk_bf16_f32 v137, v138, v139
    v_accvgpr_read_b32 v110, a74
    v_pk_mul_f32 v[146:147], v[146:147], v[48:49] op_sel_hi:[1,0]
    v_exp_f32 v79, v79
    v_pk_mul_f32 v[104:105], v[104:105], v[8:9] op_sel_hi:[1,0]
    v_pk_mul_f32 v[110:111], v[110:111], v[100:101] op_sel_hi:[1,0]
    v_exp_f32 v54, v54
    v_fma_f32 v56, v56, s28, v9
    v_pk_mul_f32 v[106:107], v[106:107], v[8:9] op_sel_hi:[1,0]
    v_cvt_pk_bf16_f32 v156, v156, v157
    v_cvt_pk_bf16_f32 v104, v104, v105
    v_cvt_pk_bf16_f32 v109, v110, v111
    v_cvt_pk_bf16_f32 v37, v78, v79
    v_cvt_pk_bf16_f32 v105, v106, v107
    v_xor_b32 v101, 96, v101
    v_mfma_f32_16x16x32_bf16 v[228:231], a[232:235], v[26:29], 0
    ds_read_b64_tr_b16 a[224:225], v3 offset:2048
    ds_read_b64_tr_b16 a[228:229], v4 offset:2048
    v_cvt_pk_bf16_f32 v233, v234, v235
    v_mfma_f32_16x16x32_bf16 v[180:183], a[232:235], v[20:23], 0
    ds_write2st64_b64 v101, v[136:137], v[184:185] offset0:4 offset1:16
    v_mfma_f32_16x16x32_bf16 v[132:135], a[232:235], v[14:17], 0
    s_waitcnt lgkmcnt(3)
    ds_write2st64_b64 v101, v[232:233], v[104:105] offset0:28 offset1:40
    v_mfma_f32_16x16x32_bf16 v[136:139], a[212:215], v[14:17], 0
    buffer_load_dwordx4 v6, s[4:7], s20 offen lds
    ds_read_b128 v[84:87], v103 offset:1024
    v_mfma_f32_16x16x32_bf16 v[184:187], a[212:215], v[20:23], 0
    ds_read_b64_tr_b16 a[226:227], v3 offset:8192
    ds_write_b64 v101, v[108:109] offset:26624
    v_mfma_f32_16x16x32_bf16 v[232:235], a[212:215], v[26:29], 0
    s_add_u32 s20, s20, 12032
    ds_read_b64_tr_b16 a[232:233], v5 offset:2048
    ds_read_b64_tr_b16 a[234:235], v5 offset:8192
    ds_read_b128 v[96:99], v103 offset:0
    v_xor_b32 v101, 32, v101
    v_accvgpr_read_b32 v105, a29
    v_accvgpr_read_b32 v109, a77
    v_mfma_f32_16x16x32_bf16 a[24:27], a[212:215], v[32:35], 0
    s_add_u32 s39, s39, 12288
    ds_write2st64_b64 v101, v[140:141], v[188:189] offset0:4 offset1:16
    v_accvgpr_read_b32 v110, a78
    v_exp_f32 v69, v69
    v_accvgpr_read_b32 v104, a28
    v_cvt_pk_bf16_f32 v153, v154, v155
    v_cvt_pk_bf16_f32 v145, v146, v147
    v_accvgpr_read_b32 v106, a30
    v_accvgpr_read_b32 v111, a79
    v_fma_f32 v59, v59, s28, v9
    v_accvgpr_read_b32 v107, a31
    v_accvgpr_read_b32 v108, a76
    v_pk_mul_f32 v[108:109], v[108:109], v[100:101] op_sel_hi:[1,0]
    v_pk_mul_f32 v[110:111], v[110:111], v[100:101] op_sel_hi:[1,0]
    v_pk_mul_f32 v[104:105], v[104:105], v[8:9] op_sel_hi:[1,0]
    v_cvt_pk_bf16_f32 v108, v108, v109
    v_cvt_pk_bf16_f32 v18, v52, v53
    v_cvt_pk_bf16_f32 v104, v104, v105
    v_cvt_pk_bf16_f32 v237, v238, v239
    v_pk_mul_f32 v[106:107], v[106:107], v[8:9] op_sel_hi:[1,0]
    v_cvt_pk_bf16_f32 v109, v110, v111
    v_cvt_pk_bf16_f32 v105, v106, v107
    v_mfma_f32_16x16x32_bf16 a[28:31], a[216:219], v[32:35], 0
    ds_write2st64_b64 v101, v[236:237], v[104:105] offset0:28 offset1:40
    v_mfma_f32_16x16x32_bf16 v[236:239], a[216:219], v[26:29], 0
    s_waitcnt vmcnt(6) lgkmcnt(2)
    ds_write_b64 v101, v[108:109] offset:26624
    v_mfma_f32_16x16x32_bf16 v[188:191], a[216:219], v[20:23], 0
    buffer_store_dwordx4 v[96:99], v6, s[16:19], s67 offen offset:0 nt
    s_barrier
    ds_read_b128 v[88:91], v103 offset:2048
    v_accvgpr_read_b32 v111, a83
    v_accvgpr_read_b32 v105, a33
    v_accvgpr_read_b32 v108, a80
    v_pk_mul_f32 v[198:199], v[198:199], v[102:103] op_sel_hi:[1,0]
    v_accvgpr_read_b32 v104, a32
    v_fma_f32 v82, v82, s28, v12
    v_exp_f32 v63, v63
    v_pk_mul_f32 v[104:105], v[104:105], v[8:9] op_sel_hi:[1,0]
    v_accvgpr_read_b32 v110, a82
    v_cvt_pk_bf16_f32 v30, v68, v69
    v_cvt_pk_bf16_f32 v104, v104, v105
    v_accvgpr_read_b32 v107, a35
    v_xor_b32 v101, 96, v101
    v_accvgpr_read_b32 v106, a34
    v_mfma_f32_16x16x32_bf16 v[140:143], a[216:219], v[14:17], 0
    ds_write2st64_b64 v101, v[144:145], v[192:193] offset0:8 offset1:20
    v_cvt_pk_bf16_f32 v253, v254, v255
    v_cvt_pk_bf16_f32 v157, v158, v159
    v_exp_f32 v67, v67
    v_accvgpr_read_b32 v109, a81
    v_pk_mul_f32 v[108:109], v[108:109], v[100:101] op_sel_hi:[1,0]
    v_pk_mul_f32 v[106:107], v[106:107], v[8:9] op_sel_hi:[1,0]
    v_cvt_pk_bf16_f32 v197, v198, v199
    v_pk_mul_f32 v[110:111], v[110:111], v[100:101] op_sel_hi:[1,0]
    v_cvt_pk_bf16_f32 v105, v106, v107
    v_cvt_pk_bf16_f32 v205, v206, v207
    v_cvt_pk_bf16_f32 v108, v108, v109
    v_mfma_f32_16x16x32_bf16 v[144:147], a[220:223], v[14:17], 0
    s_add_u32 m0, s22, 24576
    ds_write2st64_b64 v101, v[240:241], v[104:105] offset0:32 offset1:44
    v_cvt_pk_bf16_f32 v149, v150, v151
    v_accvgpr_read_b32 v107, a39
    v_cvt_pk_bf16_f32 v25, v62, v63
    v_cvt_pk_bf16_f32 v109, v110, v111
    v_mfma_f32_16x16x32_bf16 v[192:195], a[220:223], v[20:23], 0
    ds_write_b64 v101, v[108:109] offset:0
    v_accvgpr_read_b32 v105, a37
    v_accvgpr_read_b32 v106, a38
    v_accvgpr_read_b32 v111, a87
    v_accvgpr_read_b32 v108, a84
    v_accvgpr_read_b32 v104, a36
    v_pk_mul_f32 v[104:105], v[104:105], v[8:9] op_sel_hi:[1,0]
    v_pk_mul_f32 v[106:107], v[106:107], v[8:9] op_sel_hi:[1,0]
    v_accvgpr_read_b32 v109, a85
    v_accvgpr_read_b32 v110, a86
    v_xor_b32 v101, 32, v101
    v_pk_mul_f32 v[108:109], v[108:109], v[100:101] op_sel_hi:[1,0]
    v_pk_mul_f32 v[110:111], v[110:111], v[100:101] op_sel_hi:[1,0]
    v_cvt_pk_bf16_f32 v104, v104, v105
    v_cvt_pk_bf16_f32 v108, v108, v109
    v_mfma_f32_16x16x32_bf16 v[240:243], a[220:223], v[26:29], 0
    buffer_load_dwordx4 v6, s[8:11], s21 offen lds
    ds_write2st64_b64 v101, v[148:149], v[196:197] offset0:8 offset1:20
    v_cvt_pk_bf16_f32 v105, v106, v107
    v_cvt_pk_bf16_f32 v109, v110, v111
    v_mfma_f32_16x16x32_bf16 a[32:35], a[220:223], v[32:35], 0
    ds_write2st64_b64 v101, v[244:245], v[104:105] offset0:32 offset1:44
    v_accvgpr_read_b32 v106, a42
    v_accvgpr_read_b32 v107, a43
    v_cvt_pk_bf16_f32 v201, v202, v203
    v_mfma_f32_16x16x32_bf16 a[36:39], a[224:227], v[32:35], 0
    ds_write_b64 v101, v[108:109] offset:0
    v_accvgpr_read_b32 v104, a40
    v_accvgpr_read_b32 v110, a90
    v_accvgpr_read_b32 v111, a91
    v_accvgpr_read_b32 v108, a88
    v_accvgpr_read_b32 v105, a41
    v_accvgpr_read_b32 v109, a89
    v_pk_mul_f32 v[104:105], v[104:105], v[8:9] op_sel_hi:[1,0]
    v_xor_b32 v101, 96, v101
    v_pk_mul_f32 v[106:107], v[106:107], v[8:9] op_sel_hi:[1,0]
    v_pk_mul_f32 v[108:109], v[108:109], v[100:101] op_sel_hi:[1,0]
    v_pk_mul_f32 v[110:111], v[110:111], v[100:101] op_sel_hi:[1,0]
    v_exp_f32 v66, v66
    v_exp_f32 v77, v77
    v_mfma_f32_16x16x32_bf16 v[244:247], a[224:227], v[26:29], 0
    ds_write2st64_b64 v101, v[152:153], v[200:201] offset0:8 offset1:20
    v_cvt_pk_bf16_f32 v108, v108, v109
    v_cvt_pk_bf16_f32 v104, v104, v105
    v_mfma_f32_16x16x32_bf16 v[196:199], a[224:227], v[20:23], 0
    ds_read_b128 a[212:215], v0 offset:0
    v_cvt_pk_bf16_f32 v105, v106, v107
    v_cvt_pk_bf16_f32 v109, v110, v111
    v_mfma_f32_16x16x32_bf16 v[148:151], a[224:227], v[14:17], 0
    ds_write2st64_b64 v101, v[248:249], v[104:105] offset0:32 offset1:44
    v_cvt_pk_bf16_f32 v19, v54, v55
    v_mfma_f32_16x16x32_bf16 v[152:155], a[228:231], v[14:17], 0
    s_add_u32 s21, s21, 128
    ds_write_b64 v101, v[108:109] offset:0
    v_accvgpr_read_b32 v105, a45
    v_accvgpr_read_b32 v108, a92
    v_accvgpr_read_b32 v106, a46
    v_mfma_f32_16x16x32_bf16 v[200:203], a[228:231], v[20:23], 0
    ds_read_b128 a[220:223], v0 offset:1024
    v_xor_b32 v101, 32, v101
    v_accvgpr_read_b32 v107, a47
    v_mfma_f32_16x16x32_bf16 v[248:251], a[228:231], v[26:29], 0
    ds_read_b128 a[216:219], v1 offset:0
    v_accvgpr_read_b32 v104, a44
    v_accvgpr_read_b32 v109, a93
    v_mfma_f32_16x16x32_bf16 a[40:43], a[228:231], v[32:35], 0
    s_add_u32 m0, s22, 25600
    ds_write2st64_b64 v101, v[156:157], v[204:205] offset0:8 offset1:20
    v_pk_mul_f32 v[108:109], v[108:109], v[100:101] op_sel_hi:[1,0]
    v_pk_mul_f32 v[104:105], v[104:105], v[8:9] op_sel_hi:[1,0]
    v_cvt_pk_bf16_f32 v31, v70, v71
    v_pk_mul_f32 v[106:107], v[106:107], v[8:9] op_sel_hi:[1,0]
    v_cvt_pk_bf16_f32 v104, v104, v105
    v_cvt_pk_bf16_f32 v105, v106, v107
    v_accvgpr_read_b32 v110, a94
    v_mfma_f32_16x16x32_bf16 a[44:47], a[232:235], v[32:35], 0
    buffer_store_dwordx4 v[84:87], v7, s[16:19], s67 offen offset:0 nt
    ds_write2st64_b64 v101, v[252:253], v[104:105] offset0:32 offset1:44
    v_mfma_f32_16x16x32_bf16 v[252:255], a[232:235], v[26:29], 0
    v_exp_f32 v74, v74
    v_mfma_f32_16x16x32_bf16 v[204:207], a[232:235], v[20:23], 0
    buffer_load_dwordx4 v6, s[8:11], s21 offen lds
    v_mfma_f32_16x16x32_bf16 v[156:159], a[232:235], v[14:17], 0
    s_waitcnt lgkmcnt(3)
    ds_read_b128 a[228:231], v0 offset:2048
    s_add_u32 s21, s21, 128
    v_mfma_f32_16x16x32_bf16 v[52:55], a[212:215], a[96:99], 0
    s_waitcnt lgkmcnt(3)
    ds_read_b128 a[224:227], v1 offset:1024
    v_accvgpr_read_b32 v111, a95
    v_mfma_f32_16x16x32_bf16 v[52:55], a[216:219], a[100:103], v[52:55]
    s_add_u32 m0, s22, 26624
    ds_read_b128 v[96:99], v103 offset:3072
    v_exp_f32 v56, v56
    v_mfma_f32_16x16x32_bf16 v[52:55], a[220:223], a[104:107], v[52:55]
    v_exp_f32 v80, v80
    v_mfma_f32_16x16x32_bf16 v[60:63], a[220:223], a[128:131], 0
    ds_read_b128 v[84:87], v103 offset:4096
    buffer_load_dwordx4 v6, s[8:11], s21 offen lds
    v_mfma_f32_16x16x32_bf16 v[60:63], a[216:219], a[124:127], v[60:63]
    s_add_u32 s21, s21, 12032
    ds_read_b128 a[232:235], v1 offset:2048
    v_cvt_pk_bf16_f32 v36, v76, v77
    v_mfma_f32_16x16x32_bf16 v[60:63], a[212:215], a[120:123], v[60:63]
    s_add_u32 s56, s67, 128
    v_exp_f32 v64, v64
    v_mfma_f32_16x16x32_bf16 v[68:71], a[212:215], a[144:147], 0
    buffer_store_dwordx4 v[88:91], v6, s[16:19], s56 offen offset:0 nt
    s_add_u32 s58, s33, 128
    s_add_u32 m0, s38, 2048
    v_exp_f32 v59, v59
    v_cvt_pk_bf16_f32 v108, v108, v109
    v_mfma_f32_16x16x32_bf16 v[68:71], a[216:219], a[148:151], v[68:71]
    v_exp_f32 v57, v57
    v_mfma_f32_16x16x32_bf16 v[68:71], a[220:223], a[152:155], v[68:71]
    buffer_load_dwordx4 v6, s[12:15], s58 offen nt lds
    v_mfma_f32_16x16x32_bf16 v[76:79], a[220:223], a[176:179], 0
    s_waitcnt lgkmcnt(2)
    buffer_store_dwordx4 v[96:99], v7, s[16:19], s56 offen offset:0 nt
    v_pk_mul_f32 v[110:111], v[110:111], v[100:101] op_sel_hi:[1,0]
    v_exp_f32 v83, v83
    v_cvt_pk_bf16_f32 v109, v110, v111
    v_mfma_f32_16x16x32_bf16 v[76:79], a[216:219], a[172:175], v[76:79]
    v_exp_f32 v81, v81
    v_mfma_f32_16x16x32_bf16 v[76:79], a[212:215], a[168:171], v[76:79]
    ds_read_b128 a[220:223], v0 offset:7168
    v_cvt_pk_bf16_f32 v23, v66, v67
    v_cvt_pk_bf16_f32 v16, v56, v57
    v_mfma_f32_16x16x32_bf16 v[76:79], a[224:227], a[180:183], v[76:79]
    ds_write_b64 v101, v[108:109] offset:0
    v_mfma_f32_16x16x32_bf16 v[76:79], a[228:231], a[184:187], v[76:79]
    s_waitcnt lgkmcnt(2)
    ds_read_b128 v[88:91], v103 offset:5120
    v_fma_f32 v65, v65, s28, v10
    v_mfma_f32_16x16x32_bf16 v[76:79], a[232:235], a[188:191], v[76:79]
    v_exp_f32 v75, v75
    v_mfma_f32_16x16x32_bf16 v[68:71], a[232:235], a[164:167], v[68:71]
    s_add_u32 m0, s38, 3072
    v_exp_f32 v82, v82
    v_mfma_f32_16x16x32_bf16 v[68:71], a[228:231], a[160:163], v[68:71]
    ds_read_b128 a[212:215], v0 offset:6144
    v_cvt_pk_bf16_f32 v29, v74, v75
    v_mfma_f32_16x16x32_bf16 v[68:71], a[224:227], a[156:159], v[68:71]
    v_exp_f32 v65, v65
    v_mfma_f32_16x16x32_bf16 v[60:63], a[224:227], a[132:135], v[60:63]
    buffer_load_dwordx4 v7, s[12:15], s58 offen nt lds
    v_mfma_f32_16x16x32_bf16 v[60:63], a[228:231], a[136:139], v[60:63]
    ds_read_b128 v[96:99], v103 offset:0
    v_cvt_pk_bf16_f32 v22, v64, v65
    v_mfma_f32_16x16x32_bf16 v[60:63], a[232:235], a[140:143], v[60:63]
    ds_read_b128 a[216:219], v1 offset:6144
    v_cvt_pk_bf16_f32 v17, v58, v59
    v_mfma_f32_16x16x32_bf16 v[52:55], a[232:235], a[116:119], v[52:55]
    s_add_u32 s57, s67, 256
    v_cvt_pk_bf16_f32 v35, v82, v83
    v_cvt_pk_bf16_f32 v34, v80, v81
    v_mfma_f32_16x16x32_bf16 v[52:55], a[228:231], a[112:115], v[52:55]
    buffer_store_dwordx4 v[84:87], v6, s[16:19], s57 offen offset:0 nt
    s_add_u32 s59, s33, 256
    s_add_u32 m0, s38, 4096
    v_fma_f32 v72, v72, s28, v11
    v_exp_f32 v72, v72
    v_mfma_f32_16x16x32_bf16 v[48:51], a[236:239], v[16:19], v[44:47]
    v_cvt_pk_bf16_f32 v28, v72, v73
    v_mfma_f32_16x16x32_bf16 v[48:51], a[240:243], v[22:25], v[48:51]
    buffer_load_dwordx4 v6, s[12:15], s59 offen nt lds
    v_mfma_f32_16x16x32_bf16 v[48:51], a[244:247], v[28:31], v[48:51]
    ds_read_b128 v[84:87], v103 offset:1024
    v_mfma_f32_16x16x32_bf16 v[52:55], a[224:227], a[108:111], v[52:55]
    s_waitcnt lgkmcnt(3)
    ds_read_b128 a[224:227], v1 offset:7168
    s_add_u32 m0, s38, 5120
    v_mfma_f32_16x16x32_bf16 v[56:59], a[212:215], a[96:99], 0
    buffer_load_dwordx4 v7, s[12:15], s59 offen nt lds
    v_mfma_f32_16x16x32_bf16 v[48:51], a[248:251], v[34:37], v[48:51]
    s_add_u32 s56, s67, 24832
    ds_read_b128 a[232:235], v1 offset:8192
    s_waitcnt lgkmcnt(3)
    v_mfma_f32_16x16x32_bf16 v[56:59], a[216:219], a[100:103], v[56:59]
    ds_read_b128 a[228:231], v0 offset:8192
    s_add_u32 m0, s38, 0
    v_mfma_f32_16x16x32_bf16 v[56:59], a[220:223], a[104:107], v[56:59]
    v_add_u32 v103, 6144, v103
    v_cmp_lt_f32 vcc, s29, v48
    v_mfma_f32_16x16x32_bf16 v[64:67], a[220:223], a[128:131], 0
    buffer_load_dwordx4 v6, s[12:15], s33 offen nt lds
    v_mfma_f32_16x16x32_bf16 v[64:67], a[216:219], a[124:127], v[64:67]
    buffer_store_dwordx4 v[88:91], v7, s[16:19], s57 offen offset:0 nt
    s_add_u32 m0, s38, 1024
    s_cbranch_vccnz L_rs_tr54d
L_ret_tr54d:
    v_fma_f32 v61, v61, s28, v10
    v_fma_f32 v52, v52, s28, v9
    v_mfma_f32_16x16x32_bf16 v[64:67], a[212:215], a[120:123], v[64:67]
    v_exp_f32 v52, v52
    v_mfma_f32_16x16x32_bf16 v[72:75], a[212:215], a[144:147], 0
    s_waitcnt lgkmcnt(3)
    buffer_load_dwordx4 v7, s[12:15], s33 offen nt lds
    v_mfma_f32_16x16x32_bf16 v[72:75], a[216:219], a[148:151], v[72:75]
    v_exp_f32 v61, v61
    v_mfma_f32_16x16x32_bf16 v[72:75], a[220:223], a[152:155], v[72:75]
    buffer_store_dwordx4 v[96:99], v6, s[16:19], s56 offen offset:0 nt
    v_fma_f32 v53, v53, s28, v9
    v_fma_f32 v55, v55, s28, v9
    s_waitcnt vmcnt(19) lgkmcnt(0)
    v_mfma_f32_16x16x32_bf16 v[80:83], a[220:223], a[176:179], 0
    s_barrier
    v_mfma_f32_16x16x32_bf16 v[80:83], a[216:219], a[172:175], v[80:83]
    v_exp_f32 v53, v53
    v_mfma_f32_16x16x32_bf16 v[80:83], a[212:215], a[168:171], v[80:83]
    s_add_u32 m0, s22, 0
    ds_read_b64_tr_b16 a[212:213], v2 offset:18432
    v_fma_f32 v60, v60, s28, v10
    v_mfma_f32_16x16x32_bf16 v[80:83], a[224:227], a[180:183], v[80:83]
    v_exp_f32 v55, v55
    v_mfma_f32_16x16x32_bf16 v[80:83], a[228:231], a[184:187], v[80:83]
    buffer_load_dwordx4 v6, s[4:7], s20 offen lds
    v_mfma_f32_16x16x32_bf16 v[80:83], a[232:235], a[188:191], v[80:83]
    s_add_u32 s20, s20, 128
    ds_read_b64_tr_b16 a[214:215], v2 offset:12288
    v_fma_f32 v54, v54, s28, v9
    v_mfma_f32_16x16x32_bf16 v[72:75], a[232:235], a[164:167], v[72:75]
    s_add_u32 m0, s22, 1024
    v_exp_f32 v54, v54
    v_mfma_f32_16x16x32_bf16 v[72:75], a[228:231], a[160:163], v[72:75]
    buffer_load_dwordx4 v6, s[4:7], s20 offen lds
    v_mfma_f32_16x16x32_bf16 v[72:75], a[224:227], a[156:159], v[72:75]
    ds_read_b64_tr_b16 a[216:217], v3 offset:18432
    v_mfma_f32_16x16x32_bf16 v[64:67], a[224:227], a[132:135], v[64:67]
    s_add_u32 s20, s20, 128
    ds_read_b64_tr_b16 a[218:219], v3 offset:12288
    s_add_u32 m0, s22, 2048
    v_mfma_f32_16x16x32_bf16 v[64:67], a[228:231], a[136:139], v[64:67]
    v_exp_f32 v60, v60
    v_mfma_f32_16x16x32_bf16 v[64:67], a[232:235], a[140:143], v[64:67]
    buffer_load_dwordx4 v6, s[4:7], s20 offen lds
    v_mfma_f32_16x16x32_bf16 v[56:59], a[232:235], a[116:119], v[56:59]
    buffer_store_dwordx4 v[84:87], v7, s[16:19], s56 offen offset:0 nt
    ds_read_b64_tr_b16 a[220:221], v4 offset:18432
    v_cvt_pk_bf16_f32 v15, v54, v55
    v_cvt_pk_bf16_f32 v20, v60, v61
    v_mfma_f32_16x16x32_bf16 v[56:59], a[228:231], a[112:115], v[56:59]
    s_add_u32 s20, s20, 12032
    ds_read_b64_tr_b16 a[222:223], v4 offset:12288
    v_cvt_pk_bf16_f32 v14, v52, v53
    v_mfma_f32_16x16x32_bf16 v[56:59], a[224:227], a[108:111], v[56:59]
    s_waitcnt lgkmcnt(4)
    ds_read_b64_tr_b16 a[224:225], v5 offset:18432
    ds_read_b64_tr_b16 a[226:227], v5 offset:12288
    s_branch L_loop4
L_tr55:
    v_mfma_f32_16x16x32_bf16 v[112:115], a[212:215], v[16:19], v[112:115]
    s_add_u32 s39, s39, 12288
    s_add_u32 s48, s33, 24576
    v_mfma_f32_16x16x32_bf16 v[116:119], a[216:219], v[16:19], v[116:119]
    ds_read_b64_tr_b16 a[230:231], v2 offset:13312
    v_fma_f32 v58, v58, s28, v9
    v_mfma_f32_16x16x32_bf16 v[164:167], a[216:219], v[22:25], v[164:167]
    ds_read_b64_tr_b16 a[232:233], v3 offset:19456
    v_mbcnt_lo_u32_b32 v97, -1, 0
    v_mfma_f32_16x16x32_bf16 v[160:163], a[212:215], v[22:25], v[160:163]
    ds_read_b64_tr_b16 a[228:229], v2 offset:19456
    v_fma_f32 v87, v87, s28, v13
    v_mfma_f32_16x16x32_bf16 v[208:211], a[212:215], v[28:31], v[208:211]
    v_fma_f32 v73, v73, s28, v11
    v_fma_f32 v81, v81, s28, v12
    v_mfma_f32_16x16x32_bf16 v[212:215], a[216:219], v[28:31], v[212:215]
    ds_read_b64_tr_b16 a[234:235], v3 offset:13312
    v_mbcnt_hi_u32_b32 v97, -1, v97
    v_mfma_f32_16x16x32_bf16 a[4:7], a[216:219], v[34:37], a[4:7]
    v_fma_f32 v66, v66, s28, v10
    v_and_b32 v96, 15, v97
    v_mfma_f32_16x16x32_bf16 a[0:3], a[212:215], v[34:37], a[0:3]
    v_mul_u32_u24 v96, 384, v96
    v_fma_f32 v82, v82, s28, v12
    v_mfma_f32_16x16x32_bf16 a[48:51], a[212:215], v[40:43], a[48:51]
    v_fma_f32 v86, v86, s28, v13
    v_fma_f32 v76, v76, s28, v12
    v_mfma_f32_16x16x32_bf16 a[52:55], a[216:219], v[40:43], a[52:55]
    s_waitcnt lgkmcnt(4)
    ds_read_b64_tr_b16 a[218:219], v5 offset:13312
    v_fma_f32 v59, v59, s28, v9
    v_mfma_f32_16x16x32_bf16 a[56:59], a[220:223], v[40:43], a[56:59]
    v_fma_f32 v88, v88, s28, v13
    v_fma_f32 v65, v65, s28, v10
    v_mfma_f32_16x16x32_bf16 a[60:63], a[224:227], v[40:43], a[60:63]
    v_lshrrev_b32 v97, 4, v97
    v_lshl_add_u32 v96, v97, 4, v96
    v_mfma_f32_16x16x32_bf16 a[12:15], a[224:227], v[34:37], a[12:15]
    ds_read_b64_tr_b16 a[212:213], v4 offset:19456
    v_fma_f32 v74, v74, s28, v11
    v_mfma_f32_16x16x32_bf16 a[8:11], a[220:223], v[34:37], a[8:11]
    buffer_load_dword v97, v96, s[12:15], s48 offen offset:256
    v_mfma_f32_16x16x32_bf16 v[216:219], a[220:223], v[28:31], v[216:219]
    v_fma_f32 v72, v72, s28, v11
    v_fma_f32 v78, v78, s28, v12
    v_mfma_f32_16x16x32_bf16 v[220:223], a[224:227], v[28:31], v[220:223]
    ds_read_b64_tr_b16 a[214:215], v4 offset:13312
    v_fma_f32 v85, v85, s28, v13
    v_mfma_f32_16x16x32_bf16 v[172:175], a[224:227], v[22:25], v[172:175]
    ds_read_b64_tr_b16 a[216:217], v5 offset:19456
    v_fma_f32 v84, v84, s28, v13
    v_mfma_f32_16x16x32_bf16 v[168:171], a[220:223], v[22:25], v[168:171]
    v_fma_f32 v68, v68, s28, v11
    v_fma_f32 v77, v77, s28, v12
    v_mfma_f32_16x16x32_bf16 v[120:123], a[220:223], v[16:19], v[120:123]
    v_exp_f32 v82, v82
    v_mfma_f32_16x16x32_bf16 v[124:127], a[224:227], v[16:19], v[124:127]
    s_waitcnt lgkmcnt(3)
    v_fma_f32 v57, v57, s28, v9
    v_mfma_f32_16x16x32_bf16 v[128:131], a[228:231], v[16:19], v[128:131]
    v_exp_f32 v78, v78
    v_mfma_f32_16x16x32_bf16 v[132:135], a[232:235], v[16:19], v[132:135]
    ds_read_b64_tr_b16 a[224:225], v3 offset:20480
    v_fma_f32 v71, v71, s28, v11
    v_mfma_f32_16x16x32_bf16 v[180:183], a[232:235], v[22:25], v[180:183]
    ds_read_b64_tr_b16 a[222:223], v2 offset:14336
    v_fma_f32 v79, v79, s28, v12
    v_mfma_f32_16x16x32_bf16 v[176:179], a[228:231], v[22:25], v[176:179]
    v_fma_f32 v67, v67, s28, v10
    v_fma_f32 v70, v70, s28, v11
    v_mfma_f32_16x16x32_bf16 v[224:227], a[228:231], v[28:31], v[224:227]
    v_fma_f32 v75, v75, s28, v11
    v_fma_f32 v90, v90, s28, v13
    v_mfma_f32_16x16x32_bf16 v[228:231], a[232:235], v[28:31], v[228:231]
    ds_read_b64_tr_b16 a[226:227], v3 offset:14336
    v_mfma_f32_16x16x32_bf16 a[20:23], a[232:235], v[34:37], a[20:23]
    v_exp_f32 v75, v75
    v_mfma_f32_16x16x32_bf16 a[16:19], a[228:231], v[34:37], a[16:19]
    v_exp_f32 v85, v85
    v_mfma_f32_16x16x32_bf16 a[64:67], a[228:231], v[40:43], a[64:67]
    v_exp_f32 v68, v68
    v_mfma_f32_16x16x32_bf16 a[68:71], a[232:235], v[40:43], a[68:71]
    s_waitcnt lgkmcnt(3)
    ds_read_b64_tr_b16 a[220:221], v2 offset:20480
    v_fma_f32 v83, v83, s28, v12
    v_mfma_f32_16x16x32_bf16 a[72:75], a[212:215], v[40:43], a[72:75]
    v_exp_f32 v84, v84
    v_mfma_f32_16x16x32_bf16 a[76:79], a[216:219], v[40:43], a[76:79]
    ds_read_b64_tr_b16 a[232:233], v5 offset:20480
    v_mfma_f32_16x16x32_bf16 a[28:31], a[216:219], v[34:37], a[28:31]
    v_exp_f32 v59, v59
    v_mfma_f32_16x16x32_bf16 a[24:27], a[212:215], v[34:37], a[24:27]
    v_exp_f32 v71, v71
    v_mfma_f32_16x16x32_bf16 v[232:235], a[212:215], v[28:31], v[232:235]
    v_exp_f32 v70, v70
    v_mfma_f32_16x16x32_bf16 v[236:239], a[216:219], v[28:31], v[236:239]
    ds_read_b64_tr_b16 a[228:229], v4 offset:20480
    v_mfma_f32_16x16x32_bf16 v[188:191], a[216:219], v[22:25], v[188:191]
    ds_read_b64_tr_b16 a[230:231], v4 offset:14336
    v_fma_f32 v56, v56, s28, v9
    v_mfma_f32_16x16x32_bf16 v[184:187], a[212:215], v[22:25], v[184:187]
    v_exp_f32 v56, v56
    v_mfma_f32_16x16x32_bf16 v[136:139], a[212:215], v[16:19], v[136:139]
    ds_read_b64_tr_b16 a[234:235], v5 offset:14336
    v_fma_f32 v89, v89, s28, v13
    v_mfma_f32_16x16x32_bf16 v[140:143], a[216:219], v[16:19], v[140:143]
    s_waitcnt lgkmcnt(4)
    v_exp_f32 v67, v67
    v_mfma_f32_16x16x32_bf16 v[144:147], a[220:223], v[16:19], v[144:147]
    v_exp_f32 v86, v86
    v_mfma_f32_16x16x32_bf16 v[148:151], a[224:227], v[16:19], v[148:151]
    v_exp_f32 v88, v88
    v_mfma_f32_16x16x32_bf16 v[196:199], a[224:227], v[22:25], v[196:199]
    v_exp_f32 v77, v77
    v_mfma_f32_16x16x32_bf16 v[192:195], a[220:223], v[22:25], v[192:195]
    v_exp_f32 v87, v87
    v_mfma_f32_16x16x32_bf16 v[240:243], a[220:223], v[28:31], v[240:243]
    v_exp_f32 v79, v79
    v_mfma_f32_16x16x32_bf16 v[244:247], a[224:227], v[28:31], v[244:247]
    v_fma_f32 v69, v69, s28, v11
    v_cvt_pk_bf16_f32 v39, v86, v87
    v_mfma_f32_16x16x32_bf16 a[36:39], a[224:227], v[34:37], a[36:39]
    v_exp_f32 v76, v76
    v_mfma_f32_16x16x32_bf16 a[32:35], a[220:223], v[34:37], a[32:35]
    v_exp_f32 v57, v57
    v_mfma_f32_16x16x32_bf16 a[80:83], a[220:223], v[40:43], a[80:83]
    s_waitcnt vmcnt(11) lgkmcnt(0)
    v_cvt_pk_bf16_f32 v33, v78, v79
    v_cvt_pk_bf16_f32 v32, v76, v77
    v_mfma_f32_16x16x32_bf16 a[84:87], a[224:227], v[40:43], a[84:87]
    s_barrier
    v_mfma_f32_16x16x32_bf16 a[88:91], a[228:231], v[40:43], a[88:91]
    ds_read_b128 a[212:215], v0 offset:12288
    s_add_u32 m0, s22, 36864
    v_mfma_f32_16x16x32_bf16 a[92:95], a[232:235], v[40:43], a[92:95]
    buffer_load_dwordx4 v6, s[8:11], s21 offen lds
    v_mfma_f32_16x16x32_bf16 a[44:47], a[232:235], v[34:37], a[44:47]
    ds_read_b128 a[220:223], v0 offset:13312
    v_fma_f32 v91, v91, s28, v13
    v_mfma_f32_16x16x32_bf16 a[40:43], a[228:231], v[34:37], a[40:43]
    s_add_u32 s21, s21, 128
    ds_read_b128 a[216:219], v1 offset:12288
    v_cvt_pk_bf16_f32 v38, v84, v85
    v_mfma_f32_16x16x32_bf16 v[248:251], a[228:231], v[28:31], v[248:251]
    s_add_u32 m0, s22, 37888
    v_exp_f32 v74, v74
    v_mfma_f32_16x16x32_bf16 v[252:255], a[232:235], v[28:31], v[252:255]
    buffer_load_dwordx4 v6, s[8:11], s21 offen lds
    v_mfma_f32_16x16x32_bf16 v[204:207], a[232:235], v[22:25], v[204:207]
    s_add_u32 s21, s21, 128
    v_exp_f32 v69, v69
    v_mfma_f32_16x16x32_bf16 v[200:203], a[228:231], v[22:25], v[200:203]
    v_cvt_pk_bf16_f32 v26, v68, v69
    s_add_u32 m0, s22, 38912
    v_mfma_f32_16x16x32_bf16 v[152:155], a[228:231], v[16:19], v[152:155]
    buffer_load_dwordx4 v6, s[8:11], s21 offen lds
    v_mfma_f32_16x16x32_bf16 v[156:159], a[232:235], v[16:19], v[156:159]
    s_waitcnt lgkmcnt(2)
    v_mfma_f32_16x16x32_bf16 v[52:55], a[212:215], a[96:99], 0
    v_cvt_pk_bf16_f32 v29, v74, v75
    v_mfma_f32_16x16x32_bf16 v[60:63], a[212:215], a[120:123], 0
    ds_read_b128 a[228:231], v0 offset:14336
    v_cvt_pk_bf16_f32 v27, v70, v71
    v_mfma_f32_16x16x32_bf16 v[68:71], a[212:215], a[144:147], 0
    ds_read_b128 a[224:227], v1 offset:13312
    v_mfma_f32_16x16x32_bf16 v[76:79], a[212:215], a[168:171], 0
    v_exp_f32 v90, v90
    v_mfma_f32_16x16x32_bf16 v[84:87], a[212:215], a[192:195], 0
    s_waitcnt lgkmcnt(2)
    v_exp_f32 v66, v66
    v_mfma_f32_16x16x32_bf16 v[52:55], a[216:219], a[100:103], v[52:55]
    v_mfma_f32_16x16x32_bf16 v[60:63], a[216:219], a[124:127], v[60:63]
    v_exp_f32 v89, v89
    v_mfma_f32_16x16x32_bf16 v[68:71], a[216:219], a[148:151], v[68:71]
    v_exp_f32 v65, v65
    v_mfma_f32_16x16x32_bf16 v[76:79], a[216:219], a[172:175], v[76:79]
    v_exp_f32 v91, v91
    v_mfma_f32_16x16x32_bf16 v[84:87], a[216:219], a[196:199], v[84:87]
    v_cvt_pk_bf16_f32 v23, v66, v67
    v_cvt_pk_bf16_f32 v40, v88, v89
    v_mfma_f32_16x16x32_bf16 v[52:55], a[220:223], a[104:107], v[52:55]
    v_exp_f32 v58, v58
    v_mfma_f32_16x16x32_bf16 v[60:63], a[220:223], a[128:131], v[60:63]
    v_exp_f32 v81, v81
    v_mfma_f32_16x16x32_bf16 v[68:71], a[220:223], a[152:155], v[68:71]
    s_add_u32 s21, s21, 12032
    ds_read_b128 a[232:235], v1 offset:14336
    v_cvt_pk_bf16_f32 v17, v58, v59
    v_mfma_f32_16x16x32_bf16 v[76:79], a[220:223], a[176:179], v[76:79]
    v_fma_f32 v80, v80, s28, v12
    v_mfma_f32_16x16x32_bf16 v[84:87], a[220:223], a[200:203], v[84:87]
    s_waitcnt lgkmcnt(1)
    v_exp_f32 v83, v83
    v_mfma_f32_16x16x32_bf16 v[52:55], a[224:227], a[108:111], v[52:55]
    v_exp_f32 v72, v72
    v_mfma_f32_16x16x32_bf16 v[60:63], a[224:227], a[132:135], v[60:63]
    v_cvt_pk_bf16_f32 v16, v56, v57
    v_fma_f32 v64, v64, s28, v10
    v_mfma_f32_16x16x32_bf16 v[68:71], a[224:227], a[156:159], v[68:71]
    v_exp_f32 v73, v73
    v_mfma_f32_16x16x32_bf16 v[76:79], a[224:227], a[180:183], v[76:79]
    v_exp_f32 v80, v80
    v_mfma_f32_16x16x32_bf16 v[84:87], a[224:227], a[204:207], v[84:87]
    v_exp_f32 v64, v64
    v_mfma_f32_16x16x32_bf16 v[52:55], a[228:231], a[112:115], v[52:55]
    v_cvt_pk_bf16_f32 v34, v80, v81
    v_cvt_pk_bf16_f32 v28, v72, v73
    v_mfma_f32_16x16x32_bf16 v[44:47], a[236:239], v[14:17], v[48:51]
    v_mfma_f32_16x16x32_bf16 v[60:63], a[228:231], a[136:139], v[60:63]
    v_cvt_pk_bf16_f32 v35, v82, v83
    v_cvt_pk_bf16_f32 v22, v64, v65
    v_mfma_f32_16x16x32_bf16 v[68:71], a[228:231], a[160:163], v[68:71]
    ds_read_b128 a[212:215], v0 offset:20480
    v_cvt_pk_bf16_f32 v41, v90, v91
    v_mfma_f32_16x16x32_bf16 v[44:47], a[240:243], v[20:23], v[44:47]
    v_mfma_f32_16x16x32_bf16 v[76:79], a[228:231], a[184:187], v[76:79]
    ds_read_b128 a[224:227], v1 offset:18432
    v_mfma_f32_16x16x32_bf16 v[84:87], a[228:231], a[208:211], v[84:87]
    ds_read_b128 a[216:219], v1 offset:20480
    v_mfma_f32_16x16x32_bf16 v[44:47], a[244:247], v[26:29], v[44:47]
    v_mfma_f32_16x16x32_bf16 v[44:47], a[248:251], v[32:35], v[44:47]
    v_mfma_f32_16x16x32_bf16 v[44:47], a[252:255], v[38:41], v[44:47]
    s_waitcnt lgkmcnt(3)
    v_mfma_f32_16x16x32_bf16 v[52:55], a[232:235], a[116:119], v[52:55]
    ds_read_b128 a[220:223], v0 offset:18432
    v_mfma_f32_16x16x32_bf16 v[60:63], a[232:235], a[140:143], v[60:63]
    ds_read_b128 a[228:231], v0 offset:19456
    v_mfma_f32_16x16x32_bf16 v[68:71], a[232:235], a[164:167], v[68:71]
    s_nop 1
    v_cmp_lt_f32 vcc, s29, v44
    v_mfma_f32_16x16x32_bf16 v[76:79], a[232:235], a[188:191], v[76:79]
    v_mfma_f32_16x16x32_bf16 v[84:87], a[232:235], v[92:95], v[84:87]
    s_waitcnt lgkmcnt(4)
    ds_read_b128 a[232:235], v1 offset:19456
    v_mfma_f32_16x16x32_bf16 v[56:59], a[212:215], a[112:115], 0
    s_cbranch_vccnz L_rs_tr55a
L_ret_tr55a:
    v_mfma_f32_16x16x32_bf16 v[64:67], a[212:215], a[136:139], 0
    v_fma_f32 v53, v53, s28, v9
    v_mfma_f32_16x16x32_bf16 v[72:75], a[212:215], a[160:163], 0
    v_fma_f32 v55, v55, s28, v9
    v_fma_f32 v61, v61, s28, v10
    v_mfma_f32_16x16x32_bf16 v[80:83], a[212:215], a[184:187], 0
    v_fma_f32 v62, v62, s28, v10
    v_fma_f32 v63, v63, s28, v10
    v_mfma_f32_16x16x32_bf16 v[88:91], a[212:215], a[208:211], 0
    s_waitcnt lgkmcnt(3)
    v_exp_f32 v53, v53
    v_mfma_f32_16x16x32_bf16 v[56:59], a[216:219], a[116:119], v[56:59]
    v_exp_f32 v63, v63
    v_mfma_f32_16x16x32_bf16 v[64:67], a[216:219], a[140:143], v[64:67]
    v_exp_f32 v55, v55
    v_mfma_f32_16x16x32_bf16 v[72:75], a[216:219], a[164:167], v[72:75]
    v_mfma_f32_16x16x32_bf16 v[80:83], a[216:219], a[188:191], v[80:83]
    s_waitcnt vmcnt(7) lgkmcnt(0)
    v_mfma_f32_16x16x32_bf16 v[88:91], a[216:219], v[92:95], v[88:91]
    s_barrier
    v_mfma_f32_16x16x32_bf16 v[56:59], a[220:223], a[96:99], v[56:59]
    s_add_u32 m0, s22, 12288
    v_exp_f32 v62, v62
    v_mfma_f32_16x16x32_bf16 v[64:67], a[220:223], a[120:123], v[64:67]
    buffer_load_dwordx4 v6, s[4:7], s20 offen lds
    v_mfma_f32_16x16x32_bf16 v[72:75], a[220:223], a[144:147], v[72:75]
    ds_read_b64_tr_b16 a[212:213], v2 offset:0
    v_fma_f32 v52, v52, s28, v9
    v_mfma_f32_16x16x32_bf16 v[80:83], a[220:223], a[168:171], v[80:83]
    s_add_u32 s20, s20, 128
    s_add_u32 m0, s22, 13312
    v_fma_f32 v54, v54, s28, v9
    v_mfma_f32_16x16x32_bf16 v[88:91], a[220:223], a[192:195], v[88:91]
    buffer_load_dwordx4 v6, s[4:7], s20 offen lds
    v_mfma_f32_16x16x32_bf16 v[56:59], a[224:227], a[100:103], v[56:59]
    s_add_u32 s20, s20, 128
    ds_read_b64_tr_b16 a[214:215], v2 offset:6144
    v_fma_f32 v60, v60, s28, v10
    v_mfma_f32_16x16x32_bf16 v[64:67], a[224:227], a[124:127], v[64:67]
    v_exp_f32 v61, v61
    v_mfma_f32_16x16x32_bf16 v[72:75], a[224:227], a[148:151], v[72:75]
    v_exp_f32 v54, v54
    v_mfma_f32_16x16x32_bf16 v[80:83], a[224:227], a[172:175], v[80:83]
    ds_read_b64_tr_b16 a[216:217], v3 offset:0
    s_add_u32 m0, s22, 14336
    v_mfma_f32_16x16x32_bf16 v[88:91], a[224:227], a[196:199], v[88:91]
    ds_read_b64_tr_b16 a[218:219], v3 offset:6144
    v_mfma_f32_16x16x32_bf16 v[56:59], a[228:231], a[104:107], v[56:59]
    buffer_load_dwordx4 v6, s[4:7], s20 offen lds
    v_mfma_f32_16x16x32_bf16 v[64:67], a[228:231], a[128:131], v[64:67]
    v_exp_f32 v52, v52
    v_mfma_f32_16x16x32_bf16 v[72:75], a[228:231], a[152:155], v[72:75]
    ds_read_b64_tr_b16 a[220:221], v4 offset:0
    v_cvt_pk_bf16_f32 v19, v54, v55
    v_mfma_f32_16x16x32_bf16 v[80:83], a[228:231], a[176:179], v[80:83]
    v_exp_f32 v60, v60
    v_mfma_f32_16x16x32_bf16 v[88:91], a[228:231], a[200:203], v[88:91]
    s_add_u32 s20, s20, 12032
    v_cvt_pk_bf16_f32 v25, v62, v63
    v_mfma_f32_16x16x32_bf16 v[56:59], a[232:235], a[108:111], v[56:59]
    ds_read_b64_tr_b16 a[222:223], v4 offset:6144
    v_cvt_pk_bf16_f32 v18, v52, v53
    v_mfma_f32_16x16x32_bf16 v[64:67], a[232:235], a[132:135], v[64:67]
    buffer_load_dwordx4 a[208:211], v96, s[12:15], s48 offen offset:256 nt
    v_mfma_f32_16x16x32_bf16 v[72:75], a[232:235], a[156:159], v[72:75]
    buffer_load_dwordx4 v[92:95], v96, s[12:15], s48 offen offset:320 nt
    v_mfma_f32_16x16x32_bf16 v[80:83], a[232:235], a[180:183], v[80:83]
    ds_read_b64_tr_b16 a[224:225], v5 offset:0
    v_mfma_f32_16x16x32_bf16 v[88:91], a[232:235], a[204:207], v[88:91]
    s_waitcnt lgkmcnt(3)
    ds_read_b64_tr_b16 a[226:227], v5 offset:6144
    v_cvt_pk_bf16_f32 v24, v60, v61
    v_mfma_f32_16x16x32_bf16 v[112:115], a[212:215], v[14:17], v[112:115]
    v_lshrrev_b32 v105, 11, v0
    v_fma_f32 v69, v69, s28, v11
    v_mfma_f32_16x16x32_bf16 v[116:119], a[216:219], v[14:17], v[116:119]
    ds_read_b64_tr_b16 a[234:235], v3 offset:7168
    v_fma_f32 v66, v66, s28, v10
    v_mfma_f32_16x16x32_bf16 v[164:167], a[216:219], v[20:23], v[164:167]
    ds_read_b64_tr_b16 a[230:231], v2 offset:7168
    v_xor_b32 v105, s65, v105
    v_mfma_f32_16x16x32_bf16 v[160:163], a[212:215], v[20:23], v[160:163]
    v_fma_f32 v77, v77, s28, v12
    v_and_b32 v104, 0x3ff, v0
    v_mfma_f32_16x16x32_bf16 v[208:211], a[212:215], v[26:29], v[208:211]
    ds_read_b64_tr_b16 a[232:233], v3 offset:1024
    v_fma_f32 v86, v86, s28, v13
    v_mfma_f32_16x16x32_bf16 v[212:215], a[216:219], v[26:29], v[212:215]
    ds_read_b64_tr_b16 a[228:229], v2 offset:1024
    v_fma_f32 v90, v90, s28, v13
    v_mfma_f32_16x16x32_bf16 a[4:7], a[216:219], v[32:35], a[4:7]
    v_lshl_add_u32 v104, v105, 10, v104
    v_fma_f32 v79, v79, s28, v12
    v_mfma_f32_16x16x32_bf16 a[0:3], a[212:215], v[32:35], a[0:3]
    v_fma_f32 v91, v91, s28, v13
    v_fma_f32 v83, v83, s28, v12
    v_mfma_f32_16x16x32_bf16 a[48:51], a[212:215], v[38:41], a[48:51]
    v_exp_f32 v86, v86
    v_mfma_f32_16x16x32_bf16 a[52:55], a[216:219], v[38:41], a[52:55]
    s_waitcnt lgkmcnt(4)
    ds_read_b64_tr_b16 a[214:215], v4 offset:7168
    v_add_u32 v104, s38, v104
    v_mfma_f32_16x16x32_bf16 a[56:59], a[220:223], v[38:41], a[56:59]
    v_fma_f32 v64, v64, s28, v10
    v_fma_f32 v68, v68, s28, v11
    v_mfma_f32_16x16x32_bf16 a[60:63], a[224:227], v[38:41], a[60:63]
    ds_read_b64_tr_b16 a[218:219], v5 offset:7168
    v_fma_f32 v87, v87, s28, v13
    v_mfma_f32_16x16x32_bf16 a[12:15], a[224:227], v[32:35], a[12:15]
    v_exp_f32 v91, v91
    v_mfma_f32_16x16x32_bf16 a[8:11], a[220:223], v[32:35], a[8:11]
    ds_read_b128 a[176:179], v104 offset:20480
    v_fma_f32 v57, v57, s28, v9
    v_mfma_f32_16x16x32_bf16 v[216:219], a[220:223], v[26:29], v[216:219]
    v_exp_f32 v83, v83
    v_mfma_f32_16x16x32_bf16 v[220:223], a[224:227], v[26:29], v[220:223]
    ds_read_b64_tr_b16 a[212:213], v4 offset:1024
    v_fma_f32 v89, v89, s28, v13
    v_mfma_f32_16x16x32_bf16 v[172:175], a[224:227], v[20:23], v[172:175]
    ds_read_b64_tr_b16 a[216:217], v5 offset:1024
    v_fma_f32 v84, v84, s28, v13
    v_mfma_f32_16x16x32_bf16 v[168:171], a[220:223], v[20:23], v[168:171]
    v_exp_f32 v68, v68
    v_mfma_f32_16x16x32_bf16 v[120:123], a[220:223], v[14:17], v[120:123]
    v_xor_b32 v105, 64, v104
    v_fma_f32 v78, v78, s28, v12
    v_mfma_f32_16x16x32_bf16 v[124:127], a[224:227], v[14:17], v[124:127]
    s_waitcnt lgkmcnt(4)
    ds_read_b64_tr_b16 a[220:221], v2 offset:2048
    v_fma_f32 v76, v76, s28, v12
    v_mfma_f32_16x16x32_bf16 v[128:131], a[228:231], v[14:17], v[128:131]
    v_exp_f32 v87, v87
    v_mfma_f32_16x16x32_bf16 v[132:135], a[232:235], v[14:17], v[132:135]
    v_fma_f32 v71, v71, s28, v11
    v_fma_f32 v67, v67, s28, v10
    v_mfma_f32_16x16x32_bf16 v[180:183], a[232:235], v[20:23], v[180:183]
    ds_read_b64_tr_b16 a[226:227], v3 offset:8192
    v_fma_f32 v56, v56, s28, v9
    v_mfma_f32_16x16x32_bf16 v[176:179], a[228:231], v[20:23], v[176:179]
    v_exp_f32 v71, v71
    v_mfma_f32_16x16x32_bf16 v[224:227], a[228:231], v[26:29], v[224:227]
    v_exp_f32 v79, v79
    v_mfma_f32_16x16x32_bf16 v[228:231], a[232:235], v[26:29], v[228:231]
    v_exp_f32 v69, v69
    v_mfma_f32_16x16x32_bf16 a[20:23], a[232:235], v[32:35], a[20:23]
    v_fma_f32 v88, v88, s28, v13
    v_fma_f32 v82, v82, s28, v12
    v_mfma_f32_16x16x32_bf16 a[16:19], a[228:231], v[32:35], a[16:19]
    ds_read_b64_tr_b16 a[222:223], v2 offset:8192
    v_fma_f32 v70, v70, s28, v11
    v_mfma_f32_16x16x32_bf16 a[64:67], a[228:231], v[38:41], a[64:67]
    ds_read_b64_tr_b16 a[228:229], v4 offset:2048
    v_fma_f32 v75, v75, s28, v11
    v_mfma_f32_16x16x32_bf16 a[68:71], a[232:235], v[38:41], a[68:71]
    s_waitcnt lgkmcnt(3)
    v_exp_f32 v76, v76
    v_mfma_f32_16x16x32_bf16 a[72:75], a[212:215], v[38:41], a[72:75]
    s_add_u32 s39, s39, 12288
    ds_read_b64_tr_b16 a[224:225], v3 offset:2048
    v_exp_f32 v64, v64
    v_mfma_f32_16x16x32_bf16 a[76:79], a[216:219], v[38:41], a[76:79]
    ds_read_b128 a[120:123], v104 offset:6144
    v_fma_f32 v65, v65, s28, v10
    v_mfma_f32_16x16x32_bf16 a[28:31], a[216:219], v[32:35], a[28:31]
    ds_read_b64_tr_b16 a[230:231], v4 offset:8192
    v_exp_f32 v77, v77
    v_mfma_f32_16x16x32_bf16 a[24:27], a[212:215], v[32:35], a[24:27]
    v_exp_f32 v84, v84
    v_mfma_f32_16x16x32_bf16 v[232:235], a[212:215], v[26:29], v[232:235]
    ds_read_b64_tr_b16 a[234:235], v5 offset:8192
    v_fma_f32 v80, v80, s28, v12
    v_mfma_f32_16x16x32_bf16 v[236:239], a[216:219], v[26:29], v[236:239]
    ds_read_b128 a[144:147], v104 offset:12288
    v_fma_f32 v85, v85, s28, v13
    v_mfma_f32_16x16x32_bf16 v[188:191], a[216:219], v[20:23], v[188:191]
    ds_read_b64_tr_b16 a[232:233], v5 offset:2048
    v_exp_f32 v80, v80
    v_exp_f32 v78, v78
    v_mfma_f32_16x16x32_bf16 v[184:187], a[212:215], v[20:23], v[184:187]
    ds_read_b128 a[148:151], v105 offset:12288
    v_cvt_pk_bf16_f32 v30, v68, v69
    v_mfma_f32_16x16x32_bf16 v[136:139], a[212:215], v[14:17], v[136:139]
    ds_read_b128 a[132:135], v105 offset:8192
    v_fma_f32 v58, v58, s28, v9
    v_mfma_f32_16x16x32_bf16 v[140:143], a[216:219], v[14:17], v[140:143]
    s_waitcnt lgkmcnt(7)
    v_exp_f32 v70, v70
    v_mfma_f32_16x16x32_bf16 v[144:147], a[220:223], v[14:17], v[144:147]
    ds_read_b128 a[168:171], v104 offset:18432
    v_exp_f32 v65, v65
    v_mfma_f32_16x16x32_bf16 v[148:151], a[224:227], v[14:17], v[148:151]
    v_exp_f32 v89, v89
    v_mfma_f32_16x16x32_bf16 v[196:199], a[224:227], v[20:23], v[196:199]
    v_exp_f32 v85, v85
    v_mfma_f32_16x16x32_bf16 v[192:195], a[220:223], v[20:23], v[192:195]
    ds_read_b128 a[124:127], v105 offset:6144
    v_cvt_pk_bf16_f32 v43, v86, v87
    v_mfma_f32_16x16x32_bf16 v[240:243], a[220:223], v[26:29], v[240:243]
    ds_read_b128 a[152:155], v104 offset:14336
    v_fma_f32 v74, v74, s28, v11
    v_mfma_f32_16x16x32_bf16 v[244:247], a[224:227], v[26:29], v[244:247]
    s_waitcnt vmcnt(9) lgkmcnt(5)
    ds_read_b128 a[96:99], v104 offset:0
    v_cvt_pk_bf16_f32 v36, v76, v77
    v_mfma_f32_16x16x32_bf16 a[36:39], a[224:227], v[32:35], a[36:39]
    ds_read_b128 a[192:195], v104 offset:24576
    v_cvt_pk_bf16_f32 v42, v84, v85
    v_mfma_f32_16x16x32_bf16 a[32:35], a[220:223], v[32:35], a[32:35]
    s_add_u32 s21, s21, s62
    ds_read_b128 a[196:199], v105 offset:24576
    v_fma_f32 v59, v59, s28, v9
    v_mfma_f32_16x16x32_bf16 a[80:83], a[220:223], v[38:41], a[80:83]
    ds_read_b128 a[128:131], v104 offset:8192
    v_fma_f32 v81, v81, s28, v12
    v_mfma_f32_16x16x32_bf16 a[84:87], a[224:227], v[38:41], a[84:87]
    s_barrier
    v_mfma_f32_16x16x32_bf16 a[88:91], a[228:231], v[38:41], a[88:91]
    s_add_u32 m0, s22, 24576
    ds_read_b128 a[212:215], v0 offset:0
    v_cvt_pk_bf16_f32 v37, v78, v79
    v_mfma_f32_16x16x32_bf16 a[92:95], a[232:235], v[38:41], a[92:95]
    ds_read_b128 a[216:219], v1 offset:0
    buffer_load_dwordx4 v6, s[8:11], s21 offen lds
    v_mfma_f32_16x16x32_bf16 a[44:47], a[232:235], v[32:35], a[44:47]
    s_add_u32 s21, s21, 128
    ds_read_b128 a[172:175], v105 offset:18432
    v_fma_f32 v73, v73, s28, v11
    v_mfma_f32_16x16x32_bf16 a[40:43], a[228:231], v[32:35], a[40:43]
    ds_read_b128 a[100:103], v105 offset:0
    v_mfma_f32_16x16x32_bf16 v[248:251], a[228:231], v[26:29], v[248:251]
    s_add_u32 m0, s22, 25600
    ds_read_b128 a[156:159], v105 offset:14336
    buffer_load_dwordx4 v6, s[8:11], s21 offen lds
    v_mfma_f32_16x16x32_bf16 v[252:255], a[232:235], v[26:29], v[252:255]
    ds_read_b128 a[200:203], v104 offset:26624
    s_add_u32 s21, s21, 128
    v_mfma_f32_16x16x32_bf16 v[204:207], a[232:235], v[20:23], v[204:207]
    s_add_u32 m0, s22, 26624
    ds_read_b128 a[180:183], v105 offset:20480
    v_cvt_pk_bf16_f32 v31, v70, v71
    v_mfma_f32_16x16x32_bf16 v[200:203], a[228:231], v[20:23], v[200:203]
    ds_read_b128 a[104:107], v104 offset:2048
    v_exp_f32 v56, v56
    v_mfma_f32_16x16x32_bf16 v[152:155], a[228:231], v[14:17], v[152:155]
    buffer_load_dwordx4 v6, s[8:11], s21 offen lds
    ds_read_b128 a[224:227], v1 offset:1024
    v_mfma_f32_16x16x32_bf16 v[156:159], a[232:235], v[14:17], v[156:159]
    s_waitcnt lgkmcnt(8)
    ds_read_b128 a[220:223], v0 offset:1024
    v_exp_f32 v58, v58
    v_mfma_f32_16x16x32_bf16 v[52:55], a[212:215], a[96:99], 0
    v_exp_f32 v59, v59
    v_mfma_f32_16x16x32_bf16 v[60:63], a[212:215], a[120:123], 0
    ds_read_b128 a[164:167], v105 offset:16384
    v_fma_f32 v72, v72, s28, v11
    v_mfma_f32_16x16x32_bf16 v[68:71], a[212:215], a[144:147], 0
    ds_read_b128 a[204:207], v105 offset:26624
    v_cvt_pk_bf16_f32 v22, v64, v65
    v_mfma_f32_16x16x32_bf16 v[76:79], a[212:215], a[168:171], 0
    ds_read_b128 a[108:111], v105 offset:2048
    v_mfma_f32_16x16x32_bf16 v[84:87], a[212:215], a[192:195], 0
    s_waitcnt lgkmcnt(7)
    v_exp_f32 v88, v88
    v_mfma_f32_16x16x32_bf16 v[52:55], a[216:219], a[100:103], v[52:55]
    v_exp_f32 v67, v67
    v_mfma_f32_16x16x32_bf16 v[60:63], a[216:219], a[124:127], v[60:63]
    v_exp_f32 v75, v75
    v_mfma_f32_16x16x32_bf16 v[68:71], a[216:219], a[148:151], v[68:71]
    ds_read_b128 a[228:231], v0 offset:6144
    v_cvt_pk_bf16_f32 v17, v58, v59
    v_mfma_f32_16x16x32_bf16 v[76:79], a[216:219], a[172:175], v[76:79]
    v_exp_f32 v82, v82
    v_mfma_f32_16x16x32_bf16 v[84:87], a[216:219], a[196:199], v[84:87]
    s_waitcnt lgkmcnt(4)
    v_exp_f32 v90, v90
    v_mfma_f32_16x16x32_bf16 v[52:55], a[220:223], a[104:107], v[52:55]
    v_exp_f32 v81, v81
    v_mfma_f32_16x16x32_bf16 v[60:63], a[220:223], a[128:131], v[60:63]
    v_exp_f32 v73, v73
    v_mfma_f32_16x16x32_bf16 v[68:71], a[220:223], a[152:155], v[68:71]
    v_exp_f32 v66, v66
    v_mfma_f32_16x16x32_bf16 v[76:79], a[220:223], a[176:179], v[76:79]
    v_exp_f32 v72, v72
    v_mfma_f32_16x16x32_bf16 v[84:87], a[220:223], a[200:203], v[84:87]
    s_waitcnt lgkmcnt(1)
    v_exp_f32 v57, v57
    v_mfma_f32_16x16x32_bf16 v[52:55], a[224:227], a[108:111], v[52:55]
    v_cvt_pk_bf16_f32 v23, v66, v67
    v_cvt_pk_bf16_f32 v16, v56, v57
    v_mfma_f32_16x16x32_bf16 v[60:63], a[224:227], a[132:135], v[60:63]
    ds_read_b128 a[140:143], v105 offset:10240
    v_cvt_pk_bf16_f32 v41, v90, v91
    v_mfma_f32_16x16x32_bf16 v[68:71], a[224:227], a[156:159], v[68:71]
    v_exp_f32 v74, v74
    v_mfma_f32_16x16x32_bf16 v[76:79], a[224:227], a[180:183], v[76:79]
    ds_read_b128 a[220:223], v0 offset:2048
    v_cvt_pk_bf16_f32 v34, v80, v81
    v_mfma_f32_16x16x32_bf16 v[84:87], a[224:227], a[204:207], v[84:87]
    s_waitcnt lgkmcnt(2)
    ds_read_b128 a[232:235], v1 offset:6144
    v_mfma_f32_16x16x32_bf16 v[56:59], a[228:231], a[96:99], 0
    v_mfma_f32_16x16x32_bf16 v[48:51], a[236:239], v[16:19], v[44:47]
    v_cvt_pk_bf16_f32 v40, v88, v89
    v_cvt_pk_bf16_f32 v35, v82, v83
    v_mfma_f32_16x16x32_bf16 v[48:51], a[240:243], v[22:25], v[48:51]
    v_cvt_pk_bf16_f32 v28, v72, v73
    v_cvt_pk_bf16_f32 v29, v74, v75
    v_mfma_f32_16x16x32_bf16 v[64:67], a[228:231], a[120:123], 0
    ds_read_b128 a[212:215], v0 offset:7168
    v_mfma_f32_16x16x32_bf16 v[48:51], a[244:247], v[28:31], v[48:51]
    ds_read_b128 a[184:187], v104 offset:22528
    v_mfma_f32_16x16x32_bf16 v[72:75], a[228:231], a[144:147], 0
    ds_read_b128 a[216:219], v1 offset:7168
    v_mfma_f32_16x16x32_bf16 v[48:51], a[248:251], v[34:37], v[48:51]
    v_mfma_f32_16x16x32_bf16 v[48:51], a[252:255], v[40:43], v[48:51]
    s_add_u32 s21, s21, 12032
    ds_read_b128 a[116:119], v105 offset:4096
    v_mfma_f32_16x16x32_bf16 v[80:83], a[228:231], a[168:171], 0
    ds_read_b128 a[188:191], v105 offset:22528
    v_mfma_f32_16x16x32_bf16 v[88:91], a[228:231], a[192:195], 0
    s_waitcnt lgkmcnt(5)
    ds_read_b128 a[160:163], v104 offset:16384
    v_mfma_f32_16x16x32_bf16 v[56:59], a[232:235], a[100:103], v[56:59]
    ds_read_b128 a[112:115], v104 offset:4096
    v_mfma_f32_16x16x32_bf16 v[64:67], a[232:235], a[124:127], v[64:67]
    ds_read_b128 a[136:139], v104 offset:10240
    v_cmp_lt_f32 vcc, s29, v48
    v_mfma_f32_16x16x32_bf16 v[72:75], a[232:235], a[148:151], v[72:75]
    ds_read_b128 a[224:227], v1 offset:2048
    v_mfma_f32_16x16x32_bf16 v[80:83], a[232:235], a[172:175], v[80:83]
    ds_read_b128 a[228:231], v0 offset:8192
    v_mfma_f32_16x16x32_bf16 v[88:91], a[232:235], a[196:199], v[88:91]
    s_waitcnt lgkmcnt(8)
    ds_read_b128 a[232:235], v1 offset:8192
    v_mfma_f32_16x16x32_bf16 v[56:59], a[212:215], a[104:107], v[56:59]
    s_cbranch_vccnz L_rs_tr55b
L_ret_tr55b:
    v_lshrrev_b32 v108, 11, v0
    v_mfma_f32_16x16x32_bf16 v[64:67], a[212:215], a[128:131], v[64:67]
    v_mov_b32 v100, v48
    v_and_b32 v101, 0x3ff, v0
    v_mfma_f32_16x16x32_bf16 v[72:75], a[212:215], a[152:155], v[72:75]
    v_rcp_f32 v102, v49
    v_mfma_f32_16x16x32_bf16 v[80:83], a[212:215], a[176:179], v[80:83]
    v_permlane32_swap_b32 v48, v100
    v_mfma_f32_16x16x32_bf16 v[88:91], a[212:215], a[200:203], v[88:91]
    s_waitcnt lgkmcnt(5)
    v_xor_b32 v108, s65, v108
    v_lshl_add_u32 v101, v108, 10, v101
    v_mfma_f32_16x16x32_bf16 v[56:59], a[216:219], a[108:111], v[56:59]
    s_waitcnt vmcnt(3)
    v_mbcnt_lo_u32_b32 v108, -1, 0
    v_mbcnt_hi_u32_b32 v108, -1, v108
    v_mfma_f32_16x16x32_bf16 v[64:67], a[216:219], a[132:135], v[64:67]
    v_mfma_f32_16x16x32_bf16 v[72:75], a[216:219], a[156:159], v[72:75]
    v_lshrrev_b32 v108, 1, v108
    v_add_u32 v101, s38, v101
    v_mfma_f32_16x16x32_bf16 v[80:83], a[216:219], a[180:183], v[80:83]
    s_waitcnt vmcnt(8) lgkmcnt(0)
    v_mfma_f32_16x16x32_bf16 v[88:91], a[216:219], a[204:207], v[88:91]
    s_barrier
    v_mfma_f32_16x16x32_bf16 v[52:55], a[220:223], a[112:115], v[52:55]
    ds_read_b64_tr_b16 a[212:213], v2 offset:18432
    s_add_u32 m0, s22, 0
    v_mfma_f32_16x16x32_bf16 v[60:63], a[220:223], a[136:139], v[60:63]
    buffer_load_dwordx4 v6, s[4:7], s20 offen lds
    v_mfma_f32_16x16x32_bf16 v[68:71], a[220:223], a[160:163], v[68:71]
    ds_read_b64_tr_b16 a[214:215], v2 offset:12288
    v_mfma_f32_16x16x32_bf16 v[76:79], a[220:223], a[184:187], v[76:79]
    s_add_u32 s20, s20, 128
    s_add_u32 m0, s22, 1024
    ds_read_b64_tr_b16 a[216:217], v3 offset:18432
    v_mfma_f32_16x16x32_bf16 v[84:87], a[220:223], a[208:211], v[84:87]
    buffer_load_dwordx4 v6, s[4:7], s20 offen lds
    v_mfma_f32_16x16x32_bf16 v[52:55], a[224:227], a[116:119], v[52:55]
    s_add_u32 s20, s20, 128
    s_add_u32 m0, s22, 2048
    v_and_b32 v108, 24, v108
    v_mfma_f32_16x16x32_bf16 v[60:63], a[224:227], a[140:143], v[60:63]
    buffer_load_dwordx4 v6, s[4:7], s20 offen lds
    v_mfma_f32_16x16x32_bf16 v[68:71], a[224:227], a[164:167], v[68:71]
    ds_read_b64_tr_b16 a[218:219], v3 offset:12288
    v_mfma_f32_16x16x32_bf16 v[76:79], a[224:227], a[188:191], v[76:79]
    ds_read_b64_tr_b16 a[220:221], v4 offset:18432
    v_bfe_u32 v108, s66, v108, 8
    v_mfma_f32_16x16x32_bf16 v[84:87], a[224:227], v[92:95], v[84:87]
    v_rcp_f32 v8, v51
    v_mfma_f32_16x16x32_bf16 v[56:59], a[228:231], a[112:115], v[56:59]
    v_rcp_f32 v50, v50
    v_mfma_f32_16x16x32_bf16 v[64:67], a[228:231], a[136:139], v[64:67]
    v_rcp_f32 v48, v48
    v_mfma_f32_16x16x32_bf16 v[72:75], a[228:231], a[160:163], v[72:75]
    v_xor_b32 v101, v101, v108
    v_mfma_f32_16x16x32_bf16 v[80:83], a[228:231], a[184:187], v[80:83]
    ds_read_b64_tr_b16 a[222:223], v4 offset:12288
    v_mov_b32 v108, v100
    v_mfma_f32_16x16x32_bf16 v[88:91], a[228:231], a[208:211], v[88:91]
    s_add_u32 s20, s20, 12032
    v_permlane16_swap_b32 v100, v108
    v_mfma_f32_16x16x32_bf16 v[56:59], a[232:235], a[116:119], v[56:59]
    ds_read_b64_tr_b16 a[224:225], v5 offset:18432
    v_mfma_f32_16x16x32_bf16 v[64:67], a[232:235], a[140:143], v[64:67]
    v_mfma_f32_16x16x32_bf16 v[72:75], a[232:235], a[164:167], v[72:75]
    v_rcp_f32 v100, v100
    v_mfma_f32_16x16x32_bf16 v[80:83], a[232:235], a[188:191], v[80:83]
    ds_read_b64_tr_b16 a[226:227], v5 offset:12288
    v_mfma_f32_16x16x32_bf16 v[88:91], a[232:235], v[92:95], v[88:91]
    s_waitcnt lgkmcnt(3)
    v_max3_f32 v96, v52, v53, v54
    v_mfma_f32_16x16x32_bf16 v[112:115], a[212:215], v[16:19], v[112:115]
    ds_read_b64_tr_b16 a[234:235], v3 offset:13312
    v_max3_f32 v96, v96, v55, v56
    v_mfma_f32_16x16x32_bf16 v[116:119], a[216:219], v[16:19], v[116:119]
    s_mov_b32 s67, s34
    v_max3_f32 v98, v60, v61, v62
    v_max3_f32 v96, v96, v57, v58
    v_max3_f32 v98, v98, v63, v64
    v_max3_f32 v98, v98, v65, v66
    v_max_f32 v98, v98, v67
    v_max_f32 v96, v96, v59
    v_mov_b32 v99, v98
    v_mfma_f32_16x16x32_bf16 v[164:167], a[216:219], v[22:25], v[164:167]
    s_nop 0
    v_permlane32_swap_b32 v99, v98
    v_mov_b32 v97, v96
    v_mfma_f32_16x16x32_bf16 v[160:163], a[212:215], v[22:25], v[160:163]
    v_max_f32 v98, v98, v99
    v_permlane32_swap_b32 v97, v96
    v_max_f32 v96, v96, v97
    v_mov_b32 v97, v96
    v_pk_mul_f32 v[166:167], v[166:167], v[102:103] op_sel_hi:[1,0]
    v_mov_b32 v99, v98
    v_permlane16_swap_b32 v97, v96
    v_max_f32 v96, v96, v97
    v_mfma_f32_16x16x32_bf16 v[208:211], a[212:215], v[28:31], v[208:211]
    s_add_u32 s18, s34, 30720
    ds_read_b64_tr_b16 a[230:231], v2 offset:13312
    v_mul_f32_e64 v9, -s28, v96
    v_permlane16_swap_b32 v99, v98
    v_max3_f32 v96, v68, v69, v70
    v_max3_f32 v96, v96, v71, v72
    v_mfma_f32_16x16x32_bf16 v[212:215], a[216:219], v[28:31], v[212:215]
    v_max_f32 v98, v98, v99
    v_max3_f32 v96, v96, v73, v74
    v_fma_f32 v55, v55, s28, v9
    v_mfma_f32_16x16x32_bf16 a[4:7], a[216:219], v[34:37], a[4:7]
    s_mov_b32 s34, s33
    v_max_f32 v96, v96, v75
    v_mul_f32_e64 v10, -s28, v98
    v_mfma_f32_16x16x32_bf16 a[0:3], a[212:215], v[34:37], a[0:3]
    ds_read_b64_tr_b16 a[232:233], v3 offset:19456
    v_mov_b32 v97, v96
    v_mfma_f32_16x16x32_bf16 a[48:51], a[212:215], v[40:43], a[48:51]
    s_nop 0
    v_permlane32_swap_b32 v97, v96
    v_mfma_f32_16x16x32_bf16 a[52:55], a[216:219], v[40:43], a[52:55]
    s_waitcnt lgkmcnt(2)
    v_max_f32 v96, v96, v97
    v_max3_f32 v98, v76, v77, v78
    v_mfma_f32_16x16x32_bf16 a[56:59], a[220:223], v[40:43], a[56:59]
    s_add_u32 s64, s64, s62
    ds_read_b64_tr_b16 a[228:229], v2 offset:19456
    v_mov_b32 v97, v96
    v_mfma_f32_16x16x32_bf16 a[60:63], a[224:227], v[40:43], a[60:63]
    s_nop 0
    v_permlane16_swap_b32 v97, v96
    v_fma_f32 v53, v53, s28, v9
    v_mfma_f32_16x16x32_bf16 a[12:15], a[224:227], v[34:37], a[12:15]
    s_add_u32 s64, s64, 196608
    v_max3_f32 v98, v98, v79, v80
    v_max3_f32 v98, v98, v81, v82
    v_max_f32 v96, v96, v97
    v_mfma_f32_16x16x32_bf16 a[8:11], a[220:223], v[34:37], a[8:11]
    s_mov_b32 s39, s64
    ds_read_b64_tr_b16 a[216:217], v5 offset:19456
    v_fma_f32 v54, v54, s28, v9
    v_mfma_f32_16x16x32_bf16 v[216:219], a[220:223], v[28:31], v[216:219]
    s_add_u32 s37, s37, 1
    ds_read_b64_tr_b16 a[214:215], v4 offset:13312
    v_mul_f32_e64 v11, -s28, v96
    v_max3_f32 v96, v84, v85, v86
    v_mfma_f32_16x16x32_bf16 v[220:223], a[224:227], v[28:31], v[220:223]
    v_fma_f32 v52, v52, s28, v9
    v_max3_f32 v96, v96, v87, v88
    v_max_f32 v98, v98, v83
    v_mfma_f32_16x16x32_bf16 v[172:175], a[224:227], v[22:25], v[172:175]
    s_bitcmp1_b32 s63, s37
    v_exp_f32 v52, v52
    v_mfma_f32_16x16x32_bf16 v[168:171], a[220:223], v[22:25], v[168:171]
    s_cselect_b32 s62, 4294770688, 0
    v_max3_f32 v96, v96, v89, v90
    v_fma_f32 v62, v62, s28, v10
    v_mfma_f32_16x16x32_bf16 v[120:123], a[220:223], v[16:19], v[120:123]
    s_cselect_b32 s42, 0, 325632
    ds_read_b64_tr_b16 a[218:219], v5 offset:13312
    v_max_f32 v96, v96, v91
    v_mfma_f32_16x16x32_bf16 v[124:127], a[224:227], v[16:19], v[124:127]
    s_waitcnt lgkmcnt(3)
    ds_read_b64_tr_b16 a[212:213], v4 offset:19456
    v_fma_f32 v66, v66, s28, v10
    v_exp_f32 v54, v54
    v_mfma_f32_16x16x32_bf16 v[128:131], a[228:231], v[16:19], v[128:131]
    s_add_u32 s35, s35, s42
    ds_read_b64_tr_b16 a[220:221], v2 offset:20480
    v_fma_f32 v74, v74, s28, v11
    v_mfma_f32_16x16x32_bf16 v[132:135], a[232:235], v[16:19], v[132:135]
    s_lshl_b32 s42, s37, 1
    v_fma_f32 v61, v61, s28, v10
    v_mov_b32 v97, v96
    v_mfma_f32_16x16x32_bf16 v[180:183], a[232:235], v[22:25], v[180:183]
    s_lshr_b32 s42, s31, s42
    ds_read_b64_tr_b16 a[222:223], v2 offset:14336
    v_mov_b32 v99, v98
    v_mfma_f32_16x16x32_bf16 v[176:179], a[228:231], v[22:25], v[176:179]
    s_and_b32 s42, s42, 3
    v_permlane32_swap_b32 v99, v98
    v_mfma_f32_16x16x32_bf16 v[224:227], a[228:231], v[28:31], v[224:227]
    s_add_u32 s42, s42, s36
    v_exp_f32 v53, v53
    v_mfma_f32_16x16x32_bf16 v[228:231], a[232:235], v[28:31], v[228:231]
    s_sub_u32 s43, s42, 3
    v_permlane32_swap_b32 v97, v96
    v_mfma_f32_16x16x32_bf16 a[20:23], a[232:235], v[34:37], a[20:23]
    s_cmp_ge_u32 s42, 3
    ds_read_b64_tr_b16 a[226:227], v3 offset:14336
    v_exp_f32 v55, v55
    v_max_f32 v96, v96, v97
    v_mfma_f32_16x16x32_bf16 a[16:19], a[228:231], v[34:37], a[16:19]
    s_cselect_b32 s42, s43, s42
    v_accvgpr_read_b32 v104, a0
    v_max_f32 v98, v98, v99
    v_mfma_f32_16x16x32_bf16 a[64:67], a[228:231], v[40:43], a[64:67]
    s_mul_i32 s44, s3, 5
    ds_read_b64_tr_b16 a[224:225], v3 offset:20480
    v_fma_f32 v68, v68, s28, v11
    v_fma_f32 v64, v64, s28, v10
    v_mov_b32 v99, v98
    v_mfma_f32_16x16x32_bf16 a[68:71], a[232:235], v[40:43], a[68:71]
    s_waitcnt lgkmcnt(3)
    v_fma_f32 v60, v60, s28, v10
    v_accvgpr_read_b32 v105, a1
    v_mfma_f32_16x16x32_bf16 a[72:75], a[212:215], v[40:43], a[72:75]
    s_mov_b32 s32, 1
    v_mov_b32 v97, v96
    v_fma_f32 v71, v71, s28, v11
    v_mfma_f32_16x16x32_bf16 a[76:79], a[216:219], v[40:43], a[76:79]
    s_lshl_b32 s43, s3, 2
    v_permlane16_swap_b32 v99, v98
    v_max_f32 v98, v98, v99
    v_fma_f32 v72, v72, s28, v11
    v_fma_f32 v57, v57, s28, v9
    v_mfma_f32_16x16x32_bf16 a[28:31], a[216:219], v[34:37], a[28:31]
    s_add_u32 s45, s43, 21
    v_permlane16_swap_b32 v97, v96
    v_mfma_f32_16x16x32_bf16 a[24:27], a[212:215], v[34:37], a[24:27]
    s_cmp_eq_u32 s3, 0
    ds_read_b64_tr_b16 a[230:231], v4 offset:14336
    v_fma_f32 v70, v70, s28, v11
    v_mul_f32_e64 v12, -s28, v98
    v_mfma_f32_16x16x32_bf16 v[232:235], a[212:215], v[28:31], v[232:235]
    s_cselect_b32 s45, 20, s45
    v_fma_f32 v76, v76, s28, v12
    v_accvgpr_read_b32 v106, a2
    s_cselect_b32 s33, 1, 0
    v_cvt_pk_bf16_f32 v14, v52, v53
    v_mfma_f32_16x16x32_bf16 v[236:239], a[216:219], v[28:31], v[236:239]
    s_cmp_eq_u32 s42, 1
    v_exp_f32 v71, v71
    v_mfma_f32_16x16x32_bf16 v[188:191], a[216:219], v[22:25], v[188:191]
    s_cselect_b32 s44, s45, s44
    ds_read_b64_tr_b16 a[232:233], v5 offset:20480
    v_fma_f32 v56, v56, s28, v9
    v_mfma_f32_16x16x32_bf16 v[184:187], a[212:215], v[22:25], v[184:187]
    s_cselect_b32 s32, s33, s32
    v_max_f32 v96, v96, v97
    v_fma_f32 v58, v58, s28, v9
    v_mfma_f32_16x16x32_bf16 v[136:139], a[212:215], v[16:19], v[136:139]
    s_add_u32 s45, s43, 37
    v_fma_f32 v79, v79, s28, v12
    v_exp_f32 v70, v70
    v_mfma_f32_16x16x32_bf16 v[140:143], a[216:219], v[16:19], v[140:143]
    s_waitcnt lgkmcnt(2)
    ds_read_b64_tr_b16 a[228:229], v4 offset:20480
    v_mul_f32_e64 v13, -s28, v96
    v_mfma_f32_16x16x32_bf16 v[144:147], a[220:223], v[16:19], v[144:147]
    s_cmp_eq_u32 s42, 2
    v_fma_f32 v83, v83, s28, v12
    v_fma_f32 v75, v75, s28, v11
    v_fma_f32 v73, v73, s28, v11
    v_mfma_f32_16x16x32_bf16 v[148:151], a[224:227], v[16:19], v[148:151]
    s_cselect_b32 s44, s45, s44
    v_fma_f32 v63, v63, s28, v10
    v_fma_f32 v67, v67, s28, v10
    v_mfma_f32_16x16x32_bf16 v[196:199], a[224:227], v[22:25], v[196:199]
    s_cselect_b32 s32, 0, s32
    ds_read_b64_tr_b16 a[234:235], v5 offset:14336
    v_fma_f32 v77, v77, s28, v12
    v_mfma_f32_16x16x32_bf16 v[192:195], a[220:223], v[22:25], v[192:195]
    s_mul_i32 s44, s44, 6144
    v_fma_f32 v78, v78, s28, v12
    v_cvt_pk_bf16_f32 v15, v54, v55
    v_mfma_f32_16x16x32_bf16 v[240:243], a[220:223], v[28:31], v[240:243]
    s_add_u32 s33, s35, s44
    s_mul_i32 s42, s32, 6144
    v_exp_f32 v60, v60
    v_mfma_f32_16x16x32_bf16 v[244:247], a[224:227], v[28:31], v[244:247]
    s_add_u32 s42, s42, 24576
    v_exp_f32 v61, v61
    v_mfma_f32_16x16x32_bf16 a[36:39], a[224:227], v[34:37], a[36:39]
    s_add_u32 s42, s42, s33
    v_fma_f32 v69, v69, s28, v11
    s_cmp_ge_u32 s37, 6
    v_mfma_f32_16x16x32_bf16 a[32:35], a[220:223], v[34:37], a[32:35]
    s_cselect_b32 s14, 0, s42
    v_exp_f32 v62, v62
    v_exp_f32 v76, v76
    v_mfma_f32_16x16x32_bf16 a[80:83], a[220:223], v[40:43], a[80:83]
    s_add_u32 s24, s67, 256
    v_exp_f32 v69, v69
    s_add_u32 s25, s33, 256
    v_exp_f32 v78, v78
    v_pk_mul_f32 v[228:229], v[228:229], v[50:51] op_sel_hi:[1,0]
    v_fma_f32 v84, v84, s28, v13
    s_add_u32 s23, s38, 4096
    v_mfma_f32_16x16x32_bf16 a[84:87], a[224:227], v[40:43], a[84:87]
    s_mov_b32 s27, 0x249
    v_exp_f32 v63, v63
    s_mov_b32 s30, 0
    s_waitcnt vmcnt(8) lgkmcnt(0)
    v_mfma_f32_16x16x32_bf16 a[88:91], a[228:231], v[40:43], a[88:91]
    s_barrier
    ds_read_b128 a[212:215], v0 offset:12288
    v_fma_f32 v87, v87, s28, v13
    v_fma_f32 v88, v88, s28, v13
    v_mfma_f32_16x16x32_bf16 a[92:95], a[232:235], v[40:43], a[92:95]
    ds_read_b128 a[216:219], v1 offset:12288
    v_cvt_pk_bf16_f32 v27, v70, v71
    v_mfma_f32_16x16x32_bf16 a[44:47], a[232:235], v[34:37], a[44:47]
    ds_read_b128 a[220:223], v0 offset:13312
    v_exp_f32 v77, v77
    v_mfma_f32_16x16x32_bf16 a[40:43], a[228:231], v[34:37], a[40:43]
    v_exp_f32 v57, v57
    v_fma_f32 v86, v86, s28, v13
    v_mfma_f32_16x16x32_bf16 v[248:251], a[228:231], v[28:31], v[248:251]
    v_exp_f32 v79, v79
    v_mfma_f32_16x16x32_bf16 v[252:255], a[232:235], v[28:31], v[252:255]
    v_exp_f32 v88, v88
    v_mfma_f32_16x16x32_bf16 v[204:207], a[232:235], v[22:25], v[204:207]
    v_fma_f32 v59, v59, s28, v9
    v_exp_f32 v74, v74
    v_mfma_f32_16x16x32_bf16 v[200:203], a[228:231], v[22:25], v[200:203]
    v_fma_f32 v89, v89, s28, v13
    v_fma_f32 v65, v65, s28, v10
    v_cvt_pk_bf16_f32 v32, v76, v77
    v_mfma_f32_16x16x32_bf16 v[152:155], a[228:231], v[16:19], v[152:155]
    v_exp_f32 v87, v87
    v_fma_f32 v91, v91, s28, v13
    v_exp_f32 v84, v84
    v_mfma_f32_16x16x32_bf16 v[156:159], a[232:235], v[16:19], v[156:159]
    s_waitcnt lgkmcnt(1)
    ds_read_b128 a[232:235], v1 offset:14336
    v_cvt_pk_bf16_f32 v21, v62, v63
    v_accvgpr_read_b32 v110, a50
    v_mfma_f32_16x16x32_bf16 v[52:55], a[212:215], a[96:99], 0
    v_subrev_u32 v103, 28672, v103
    v_cvt_pk_bf16_f32 v20, v60, v61
    v_mfma_f32_16x16x32_bf16 v[52:55], a[216:219], a[100:103], v[52:55]
    s_waitcnt lgkmcnt(1)
    v_exp_f32 v68, v68
    v_mfma_f32_16x16x32_bf16 v[52:55], a[220:223], a[104:107], v[52:55]
    v_fma_f32 v85, v85, s28, v13
    v_cvt_pk_bf16_f32 v33, v78, v79
    v_mfma_f32_16x16x32_bf16 v[60:63], a[220:223], a[128:131], 0
    ds_read_b128 a[228:231], v0 offset:14336
    v_cvt_pk_bf16_f32 v26, v68, v69
    v_exp_f32 v83, v83
    v_mfma_f32_16x16x32_bf16 v[60:63], a[216:219], a[124:127], v[60:63]
    ds_read_b128 a[224:227], v1 offset:13312
    v_accvgpr_read_b32 v111, a51
    v_mfma_f32_16x16x32_bf16 v[60:63], a[212:215], a[120:123], v[60:63]
    s_add_u32 m0, s22, 36864
    v_exp_f32 v86, v86
    v_mfma_f32_16x16x32_bf16 v[68:71], a[212:215], a[144:147], 0
    v_accvgpr_read_b32 v109, a49
    v_exp_f32 v85, v85
    v_mfma_f32_16x16x32_bf16 v[68:71], a[216:219], a[148:151], v[68:71]
    v_exp_f32 v67, v67
    v_mfma_f32_16x16x32_bf16 v[68:71], a[220:223], a[152:155], v[68:71]
    v_exp_f32 v64, v64
    v_mfma_f32_16x16x32_bf16 v[76:79], a[220:223], a[176:179], 0
    buffer_load_dwordx4 v6, s[8:11], s21 offen lds
    v_cvt_pk_bf16_f32 v39, v86, v87
    v_mfma_f32_16x16x32_bf16 v[76:79], a[216:219], a[172:175], v[76:79]
    v_exp_f32 v59, v59
    v_mfma_f32_16x16x32_bf16 v[76:79], a[212:215], a[168:171], v[76:79]
    v_cvt_pk_bf16_f32 v228, v228, v229
    v_cvt_pk_bf16_f32 v38, v84, v85
    v_mfma_f32_16x16x32_bf16 v[84:87], a[212:215], a[192:195], 0
    v_exp_f32 v89, v89
    v_mfma_f32_16x16x32_bf16 v[84:87], a[216:219], a[196:199], v[84:87]
    v_exp_f32 v91, v91
    v_exp_f32 v56, v56
    v_mfma_f32_16x16x32_bf16 v[84:87], a[220:223], a[200:203], v[84:87]
    s_waitcnt lgkmcnt(0)
    v_fma_f32 v82, v82, s28, v12
    v_fma_f32 v80, v80, s28, v12
    v_mfma_f32_16x16x32_bf16 v[84:87], a[224:227], a[204:207], v[84:87]
    v_exp_f32 v73, v73
    v_exp_f32 v82, v82
    v_mfma_f32_16x16x32_bf16 v[84:87], a[228:231], a[208:211], v[84:87]
    v_exp_f32 v65, v65
    v_mfma_f32_16x16x32_bf16 v[84:87], a[232:235], v[92:95], v[84:87]
    ds_read_b128 a[216:219], v1 offset:18432
    v_cvt_pk_bf16_f32 v16, v56, v57
    v_mfma_f32_16x16x32_bf16 v[76:79], a[232:235], a[188:191], v[76:79]
    ds_read_b128 a[212:215], v0 offset:18432
    v_accvgpr_read_b32 v107, a3
    v_mfma_f32_16x16x32_bf16 v[76:79], a[228:231], a[184:187], v[76:79]
    ds_read_b128 a[220:223], v0 offset:19456
    v_cvt_pk_bf16_f32 v22, v64, v65
    v_mfma_f32_16x16x32_bf16 v[76:79], a[224:227], a[180:183], v[76:79]
    v_fma_f32 v81, v81, s28, v12
    v_fma_f32 v84, v84, s28, v13
    v_fma_f32 v90, v90, s28, v13
    v_mfma_f32_16x16x32_bf16 v[68:71], a[224:227], a[156:159], v[68:71]
    v_exp_f32 v58, v58
    v_exp_f32 v75, v75
    v_mfma_f32_16x16x32_bf16 v[68:71], a[228:231], a[160:163], v[68:71]
    v_exp_f32 v72, v72
    v_mfma_f32_16x16x32_bf16 v[68:71], a[232:235], a[164:167], v[68:71]
    s_add_u32 s21, s21, 128
    v_fma_f32 v76, v76, s28, v12
    v_accvgpr_read_b32 v108, a48
    v_mfma_f32_16x16x32_bf16 v[60:63], a[232:235], a[140:143], v[60:63]
    s_add_u32 m0, s22, 37888
    v_exp_f32 v66, v66
    v_mfma_f32_16x16x32_bf16 v[60:63], a[228:231], a[136:139], v[60:63]
    buffer_load_dwordx4 v6, s[8:11], s21 offen lds
    v_mfma_f32_16x16x32_bf16 v[60:63], a[224:227], a[132:135], v[60:63]
    v_cvt_pk_bf16_f32 v17, v58, v59
    v_cvt_pk_bf16_f32 v23, v66, v67
    v_mfma_f32_16x16x32_bf16 v[52:55], a[224:227], a[108:111], v[52:55]
    v_exp_f32 v90, v90
    v_mfma_f32_16x16x32_bf16 v[52:55], a[228:231], a[112:115], v[52:55]
    v_exp_f32 v81, v81
    v_mfma_f32_16x16x32_bf16 v[52:55], a[232:235], a[116:119], v[52:55]
    s_add_u32 s21, s21, 128
    ds_read_b128 a[224:227], v1 offset:19456
    v_fma_f32 v71, v71, s28, v11
    v_mfma_f32_16x16x32_bf16 v[44:47], a[236:239], v[14:17], 0
    s_waitcnt lgkmcnt(1)
    ds_read_b128 a[232:235], v1 offset:20480
    v_cvt_pk_bf16_f32 v35, v82, v83
    v_mfma_f32_16x16x32_bf16 v[56:59], a[212:215], a[96:99], 0
    ds_read_b128 a[228:231], v0 offset:20480
    v_fma_f32 v78, v78, s28, v12
    v_mfma_f32_16x16x32_bf16 v[56:59], a[216:219], a[100:103], v[56:59]
    v_exp_f32 v80, v80
    v_fma_f32 v55, v55, s28, v9
    v_fma_f32 v63, v63, s28, v10
    v_exp_f32 v84, v84
    v_pk_mul_f32 v[114:115], v[114:115], v[48:49] op_sel_hi:[1,0]
    v_pk_mul_f32 v[128:129], v[128:129], v[48:49] op_sel_hi:[1,0]
    v_pk_mul_f32 v[124:125], v[124:125], v[48:49] op_sel_hi:[1,0]
    v_pk_mul_f32 v[162:163], v[162:163], v[102:103] op_sel_hi:[1,0]
    v_cvt_pk_bf16_f32 v34, v80, v81
    v_pk_mul_f32 v[218:219], v[218:219], v[50:51] op_sel_hi:[1,0]
    v_pk_mul_f32 v[208:209], v[208:209], v[50:51] op_sel_hi:[1,0]
    v_pk_mul_f32 v[112:113], v[112:113], v[48:49] op_sel_hi:[1,0]
    v_cvt_pk_bf16_f32 v29, v74, v75
    v_pk_mul_f32 v[116:117], v[116:117], v[48:49] op_sel_hi:[1,0]
    v_pk_mul_f32 v[168:169], v[168:169], v[102:103] op_sel_hi:[1,0]
    v_fma_f32 v69, v69, s28, v11
    v_pk_mul_f32 v[210:211], v[210:211], v[50:51] op_sel_hi:[1,0]
    v_pk_mul_f32 v[104:105], v[104:105], v[8:9] op_sel_hi:[1,0]
    v_pk_mul_f32 v[164:165], v[164:165], v[102:103] op_sel_hi:[1,0]
    v_pk_mul_f32 v[132:133], v[132:133], v[48:49] op_sel_hi:[1,0]
    v_pk_mul_f32 v[214:215], v[214:215], v[50:51] op_sel_hi:[1,0]
    v_pk_mul_f32 v[106:107], v[106:107], v[8:9] op_sel_hi:[1,0]
    v_pk_mul_f32 v[118:119], v[118:119], v[48:49] op_sel_hi:[1,0]
    v_pk_mul_f32 v[110:111], v[110:111], v[100:101] op_sel_hi:[1,0]
    v_pk_mul_f32 v[108:109], v[108:109], v[100:101] op_sel_hi:[1,0]
    v_pk_mul_f32 v[216:217], v[216:217], v[50:51] op_sel_hi:[1,0]
    v_pk_mul_f32 v[160:161], v[160:161], v[102:103] op_sel_hi:[1,0]
    v_fma_f32 v85, v85, s28, v13
    v_pk_mul_f32 v[212:213], v[212:213], v[50:51] op_sel_hi:[1,0]
    v_pk_mul_f32 v[230:231], v[230:231], v[50:51] op_sel_hi:[1,0]
    v_cvt_pk_bf16_f32 v104, v104, v105
    v_cvt_pk_bf16_f32 v216, v216, v217
    v_mfma_f32_16x16x32_bf16 v[56:59], a[220:223], a[104:107], v[56:59]
    v_cvt_pk_bf16_f32 v112, v112, v113
    v_cvt_pk_bf16_f32 v108, v108, v109
    v_mfma_f32_16x16x32_bf16 v[64:67], a[220:223], a[128:131], 0
    v_cvt_pk_bf16_f32 v105, v106, v107
    v_cvt_pk_bf16_f32 v28, v72, v73
    v_mfma_f32_16x16x32_bf16 v[64:67], a[216:219], a[124:127], v[64:67]
    s_add_u32 m0, s22, 38912
    v_fma_f32 v79, v79, s28, v12
    v_cvt_pk_bf16_f32 v41, v90, v91
    v_mfma_f32_16x16x32_bf16 v[64:67], a[212:215], a[120:123], v[64:67]
    v_fma_f32 v54, v54, s28, v9
    v_cvt_pk_bf16_f32 v40, v88, v89
    v_mfma_f32_16x16x32_bf16 v[72:75], a[212:215], a[144:147], 0
    buffer_load_dwordx4 v6, s[8:11], s21 offen lds
    v_mfma_f32_16x16x32_bf16 v[72:75], a[216:219], a[148:151], v[72:75]
    v_cvt_pk_bf16_f32 v212, v212, v213
    v_cvt_pk_bf16_f32 v208, v208, v209
    v_mfma_f32_16x16x32_bf16 v[72:75], a[220:223], a[152:155], v[72:75]
    v_cvt_pk_bf16_f32 v109, v110, v111
    v_cvt_pk_bf16_f32 v160, v160, v161
    v_mfma_f32_16x16x32_bf16 v[80:83], a[220:223], a[176:179], 0
    v_cvt_pk_bf16_f32 v161, v162, v163
    v_cvt_pk_bf16_f32 v113, v114, v115
    v_mfma_f32_16x16x32_bf16 v[80:83], a[216:219], a[172:175], v[80:83]
    s_add_u32 s21, s21, 12032
    v_fma_f32 v61, v61, s28, v10
    v_cvt_pk_bf16_f32 v209, v210, v211
    v_mfma_f32_16x16x32_bf16 v[80:83], a[212:215], a[168:171], v[80:83]
    ds_write2st64_b64 v101, v[112:113], v[160:161] offset0:0 offset1:12
    v_mfma_f32_16x16x32_bf16 v[88:91], a[212:215], a[192:195], 0
    ds_write2st64_b64 v101, v[208:209], v[104:105] offset0:24 offset1:36
    v_mfma_f32_16x16x32_bf16 v[88:91], a[216:219], a[196:199], v[88:91]
    s_waitcnt vmcnt(6) lgkmcnt(2)
    v_fma_f32 v87, v87, s28, v13
    v_fma_f32 v86, v86, s28, v13
    v_mfma_f32_16x16x32_bf16 v[88:91], a[220:223], a[200:203], v[88:91]
    v_fma_f32 v77, v77, s28, v12
    v_accvgpr_read_b32 v110, a54
    v_mfma_f32_16x16x32_bf16 v[44:47], a[240:243], v[20:23], v[44:47]
    s_barrier
    ds_read_b64_tr_b16 a[212:213], v2 offset:0
    v_mfma_f32_16x16x32_bf16 v[88:91], a[224:227], a[204:207], v[88:91]
    v_fma_f32 v62, v62, s28, v10
    v_exp_f32 v77, v77
    v_mfma_f32_16x16x32_bf16 v[88:91], a[228:231], a[208:211], v[88:91]
    ds_write_b64 v101, v[108:109] offset:24576
    v_mfma_f32_16x16x32_bf16 v[88:91], a[232:235], v[92:95], v[88:91]
    ds_read_b64_tr_b16 a[214:215], v2 offset:6144
    v_accvgpr_read_b32 v109, a53
    v_mfma_f32_16x16x32_bf16 v[80:83], a[232:235], a[188:191], v[80:83]
    v_exp_f32 v61, v61
    v_mfma_f32_16x16x32_bf16 v[80:83], a[228:231], a[184:187], v[80:83]
    ds_read_b64_tr_b16 a[216:217], v3 offset:0
    v_accvgpr_read_b32 v105, a5
    v_exp_f32 v85, v85
    v_mfma_f32_16x16x32_bf16 v[80:83], a[224:227], a[180:183], v[80:83]
    s_add_u32 m0, s22, 12288
    v_accvgpr_read_b32 v111, a55
    v_accvgpr_read_b32 v108, a52
    v_accvgpr_read_b32 v104, a4
    v_mfma_f32_16x16x32_bf16 v[72:75], a[224:227], a[156:159], v[72:75]
    v_exp_f32 v69, v69
    v_mfma_f32_16x16x32_bf16 v[44:47], a[244:247], v[26:29], v[44:47]
    v_exp_f32 v78, v78
    v_accvgpr_read_b32 v107, a7
    v_mfma_f32_16x16x32_bf16 v[72:75], a[228:231], a[160:163], v[72:75]
    ds_read_b64_tr_b16 a[218:219], v3 offset:6144
    buffer_load_dwordx4 v6, s[4:7], s20 offen lds
    v_exp_f32 v87, v87
    v_pk_mul_f32 v[252:253], v[252:253], v[50:51] op_sel_hi:[1,0]
    v_pk_mul_f32 v[134:135], v[134:135], v[48:49] op_sel_hi:[1,0]
    v_exp_f32 v54, v54
    v_pk_mul_f32 v[174:175], v[174:175], v[102:103] op_sel_hi:[1,0]
    v_pk_mul_f32 v[224:225], v[224:225], v[50:51] op_sel_hi:[1,0]
    v_pk_mul_f32 v[244:245], v[244:245], v[50:51] op_sel_hi:[1,0]
    v_pk_mul_f32 v[108:109], v[108:109], v[100:101] op_sel_hi:[1,0]
    v_pk_mul_f32 v[196:197], v[196:197], v[102:103] op_sel_hi:[1,0]
    v_pk_mul_f32 v[232:233], v[232:233], v[50:51] op_sel_hi:[1,0]
    v_pk_mul_f32 v[186:187], v[186:187], v[102:103] op_sel_hi:[1,0]
    v_cvt_pk_bf16_f32 v116, v116, v117
    v_cvt_pk_bf16_f32 v229, v230, v231
    v_pk_mul_f32 v[110:111], v[110:111], v[100:101] op_sel_hi:[1,0]
    v_xor_b32 v101, 32, v101
    v_cvt_pk_bf16_f32 v217, v218, v219
    v_fma_f32 v91, v91, s28, v13
    v_pk_mul_f32 v[120:121], v[120:121], v[48:49] op_sel_hi:[1,0]
    v_pk_mul_f32 v[104:105], v[104:105], v[8:9] op_sel_hi:[1,0]
    v_pk_mul_f32 v[222:223], v[222:223], v[50:51] op_sel_hi:[1,0]
    v_pk_mul_f32 v[140:141], v[140:141], v[48:49] op_sel_hi:[1,0]
    v_cvt_pk_bf16_f32 v42, v84, v85
    v_pk_mul_f32 v[246:247], v[246:247], v[50:51] op_sel_hi:[1,0]
    v_pk_mul_f32 v[148:149], v[148:149], v[48:49] op_sel_hi:[1,0]
    v_pk_mul_f32 v[136:137], v[136:137], v[48:49] op_sel_hi:[1,0]
    v_fma_f32 v52, v52, s28, v9
    v_pk_mul_f32 v[238:239], v[238:239], v[50:51] op_sel_hi:[1,0]
    v_cvt_pk_bf16_f32 v252, v252, v253
    v_accvgpr_read_b32 v106, a6
    v_cvt_pk_bf16_f32 v140, v140, v141
    v_fma_f32 v68, v68, s28, v11
    v_pk_mul_f32 v[184:185], v[184:185], v[102:103] op_sel_hi:[1,0]
    v_pk_mul_f32 v[178:179], v[178:179], v[102:103] op_sel_hi:[1,0]
    v_cvt_pk_bf16_f32 v168, v168, v169
    v_pk_mul_f32 v[176:177], v[176:177], v[102:103] op_sel_hi:[1,0]
    v_fma_f32 v90, v90, s28, v13
    v_pk_mul_f32 v[106:107], v[106:107], v[8:9] op_sel_hi:[1,0]
    v_pk_mul_f32 v[172:173], v[172:173], v[102:103] op_sel_hi:[1,0]
    v_cvt_pk_bf16_f32 v104, v104, v105
    v_fma_f32 v82, v82, s28, v12
    v_mfma_f32_16x16x32_bf16 v[72:75], a[232:235], a[164:167], v[72:75]
    ds_read_b64_tr_b16 a[220:221], v4 offset:0
    v_cvt_pk_bf16_f32 v184, v184, v185
    v_cvt_pk_bf16_f32 v117, v118, v119
    v_cvt_pk_bf16_f32 v108, v108, v109
    v_cvt_pk_bf16_f32 v164, v164, v165
    v_mfma_f32_16x16x32_bf16 v[44:47], a[248:251], v[32:35], v[44:47]
    v_cvt_pk_bf16_f32 v165, v166, v167
    v_cvt_pk_bf16_f32 v213, v214, v215
    v_cvt_pk_bf16_f32 v105, v106, v107
    v_mfma_f32_16x16x32_bf16 v[64:67], a[232:235], a[140:143], v[64:67]
    v_fma_f32 v74, v74, s28, v11
    v_cvt_pk_bf16_f32 v109, v110, v111
    v_fma_f32 v70, v70, s28, v11
    v_accvgpr_read_b32 v106, a10
    v_mfma_f32_16x16x32_bf16 v[64:67], a[228:231], a[136:139], v[64:67]
    ds_write2st64_b64 v101, v[116:117], v[164:165] offset0:0 offset1:12
    v_accvgpr_read_b32 v107, a11
    v_mfma_f32_16x16x32_bf16 v[64:67], a[224:227], a[132:135], v[64:67]
    s_add_u32 s20, s20, 128
    v_exp_f32 v71, v71
    v_mfma_f32_16x16x32_bf16 v[56:59], a[224:227], a[108:111], v[56:59]
    ds_read_b64_tr_b16 a[222:223], v4 offset:6144
    v_cvt_pk_bf16_f32 v172, v172, v173
    v_mfma_f32_16x16x32_bf16 v[56:59], a[228:231], a[112:115], v[56:59]
    ds_write2st64_b64 v101, v[212:213], v[104:105] offset0:24 offset1:36
    v_pk_mul_f32 v[170:171], v[170:171], v[102:103] op_sel_hi:[1,0]
    v_fma_f32 v60, v60, s28, v10
    v_cvt_pk_bf16_f32 v120, v120, v121
    v_mfma_f32_16x16x32_bf16 v[56:59], a[232:235], a[116:119], v[56:59]
    s_add_u32 m0, s22, 13312
    ds_write_b64 v101, v[108:109] offset:24576
    v_exp_f32 v62, v62
    v_mfma_f32_16x16x32_bf16 v[44:47], a[252:255], v[38:41], v[44:47]
    s_waitcnt lgkmcnt(4)
    ds_read_b64_tr_b16 a[224:225], v5 offset:0
    buffer_load_dwordx4 v6, s[4:7], s20 offen lds
    v_mfma_f32_16x16x32_bf16 v[112:115], a[212:215], v[14:17], 0
    v_cvt_pk_bf16_f32 v136, v136, v137
    v_accvgpr_read_b32 v104, a8
    v_mfma_f32_16x16x32_bf16 v[116:119], a[216:219], v[14:17], 0
    s_add_u32 s20, s20, 128
    ds_read_b64_tr_b16 a[228:229], v2 offset:1024
    v_fma_f32 v58, v58, s28, v9
    v_accvgpr_read_b32 v108, a56
    v_mfma_f32_16x16x32_bf16 v[164:167], a[216:219], v[20:23], 0
    s_add_u32 m0, s22, 14336
    v_accvgpr_read_b32 v109, a57
    v_cvt_pk_bf16_f32 v124, v124, v125
    v_cvt_pk_bf16_f32 v185, v186, v187
    v_exp_f32 v63, v63
    v_pk_mul_f32 v[142:143], v[142:143], v[48:49] op_sel_hi:[1,0]
    v_pk_mul_f32 v[240:241], v[240:241], v[50:51] op_sel_hi:[1,0]
    v_cvt_pk_bf16_f32 v132, v132, v133
    v_fma_f32 v83, v83, s28, v12
    v_pk_mul_f32 v[236:237], v[236:237], v[50:51] op_sel_hi:[1,0]
    v_pk_mul_f32 v[198:199], v[198:199], v[102:103] op_sel_hi:[1,0]
    v_xor_b32 v101, 96, v101
    v_pk_mul_f32 v[188:189], v[188:189], v[102:103] op_sel_hi:[1,0]
    v_cvt_pk_bf16_f32 v176, v176, v177
    v_fma_f32 v66, v66, s28, v10
    v_pk_mul_f32 v[106:107], v[106:107], v[8:9] op_sel_hi:[1,0]
    v_pk_mul_f32 v[122:123], v[122:123], v[48:49] op_sel_hi:[1,0]
    v_pk_mul_f32 v[242:243], v[242:243], v[50:51] op_sel_hi:[1,0]
    v_cvt_pk_bf16_f32 v121, v122, v123
    v_pk_mul_f32 v[138:139], v[138:139], v[48:49] op_sel_hi:[1,0]
    v_pk_mul_f32 v[220:221], v[220:221], v[50:51] op_sel_hi:[1,0]
    v_cvt_pk_bf16_f32 v196, v196, v197
    v_pk_mul_f32 v[180:181], v[180:181], v[102:103] op_sel_hi:[1,0]
    v_cvt_pk_bf16_f32 v197, v198, v199
    v_pk_mul_f32 v[234:235], v[234:235], v[50:51] op_sel_hi:[1,0]
    v_accvgpr_read_b32 v110, a58
    v_pk_mul_f32 v[254:255], v[254:255], v[50:51] op_sel_hi:[1,0]
    v_cvt_pk_bf16_f32 v169, v170, v171
    v_cvt_pk_bf16_f32 v220, v220, v221
    v_pk_mul_f32 v[126:127], v[126:127], v[48:49] op_sel_hi:[1,0]
    v_exp_f32 v58, v58
    v_pk_mul_f32 v[108:109], v[108:109], v[100:101] op_sel_hi:[1,0]
    v_accvgpr_read_b32 v111, a59
    v_pk_mul_f32 v[192:193], v[192:193], v[102:103] op_sel_hi:[1,0]
    v_accvgpr_read_b32 v105, a9
    v_pk_mul_f32 v[204:205], v[204:205], v[102:103] op_sel_hi:[1,0]
    v_pk_mul_f32 v[130:131], v[130:131], v[48:49] op_sel_hi:[1,0]
    v_pk_mul_f32 v[104:105], v[104:105], v[8:9] op_sel_hi:[1,0]
    v_pk_mul_f32 v[200:201], v[200:201], v[102:103] op_sel_hi:[1,0]
    v_pk_mul_f32 v[248:249], v[248:249], v[50:51] op_sel_hi:[1,0]
    v_pk_mul_f32 v[110:111], v[110:111], v[100:101] op_sel_hi:[1,0]
    v_pk_mul_f32 v[250:251], v[250:251], v[50:51] op_sel_hi:[1,0]
    v_cvt_pk_bf16_f32 v177, v178, v179
    v_pk_mul_f32 v[146:147], v[146:147], v[48:49] op_sel_hi:[1,0]
    v_pk_mul_f32 v[158:159], v[158:159], v[48:49] op_sel_hi:[1,0]
    v_cvt_pk_bf16_f32 v104, v104, v105
    v_fma_f32 v88, v88, s28, v13
    v_cvt_pk_bf16_f32 v173, v174, v175
    v_cvt_pk_bf16_f32 v105, v106, v107
    v_accvgpr_read_b32 v106, a14
    v_mfma_f32_16x16x32_bf16 v[160:163], a[212:215], v[20:23], 0
    ds_write2st64_b64 v101, v[120:121], v[168:169] offset0:0 offset1:12
    v_cvt_pk_bf16_f32 v133, v134, v135
    v_cvt_pk_bf16_f32 v125, v126, v127
    v_cvt_pk_bf16_f32 v180, v180, v181
    v_cvt_pk_bf16_f32 v108, v108, v109
    v_cvt_pk_bf16_f32 v109, v110, v111
    v_mfma_f32_16x16x32_bf16 v[208:211], a[212:215], v[26:29], 0
    ds_read_b64_tr_b16 a[232:233], v3 offset:1024
    v_accvgpr_read_b32 v111, a63
    v_cvt_pk_bf16_f32 v236, v236, v237
    v_mfma_f32_16x16x32_bf16 v[212:215], a[216:219], v[26:29], 0
    ds_write2st64_b64 v101, v[216:217], v[104:105] offset0:24 offset1:36
    v_accvgpr_read_b32 v104, a12
    v_pk_mul_f32 v[156:157], v[156:157], v[48:49] op_sel_hi:[1,0]
    v_accvgpr_read_b32 v105, a13
    v_cvt_pk_bf16_f32 v221, v222, v223
    v_accvgpr_read_b32 v110, a62
    v_exp_f32 v52, v52
    v_cvt_pk_bf16_f32 v128, v128, v129
    v_mfma_f32_16x16x32_bf16 a[4:7], a[216:219], v[32:35], 0
    ds_read_b64_tr_b16 a[226:227], v5 offset:6144
    v_cvt_pk_bf16_f32 v248, v248, v249
    v_mfma_f32_16x16x32_bf16 a[0:3], a[212:215], v[32:35], 0
    ds_write_b64 v101, v[108:109] offset:24576
    v_accvgpr_read_b32 v108, a60
    v_mfma_f32_16x16x32_bf16 a[48:51], a[212:215], v[38:41], 0
    buffer_load_dwordx4 v6, s[4:7], s20 offen lds
    ds_read_b64_tr_b16 a[214:215], v4 offset:7168
    v_accvgpr_read_b32 v109, a61
    v_cvt_pk_bf16_f32 v148, v148, v149
    v_cvt_pk_bf16_f32 v232, v232, v233
    v_pk_mul_f32 v[104:105], v[104:105], v[8:9] op_sel_hi:[1,0]
    v_pk_mul_f32 v[108:109], v[108:109], v[100:101] op_sel_hi:[1,0]
    v_pk_mul_f32 v[144:145], v[144:145], v[48:49] op_sel_hi:[1,0]
    v_exp_f32 v70, v70
    v_exp_f32 v79, v79
    v_mfma_f32_16x16x32_bf16 a[52:55], a[216:219], v[38:41], 0
    v_exp_f32 v76, v76
    v_accvgpr_read_b32 v107, a15
    v_cvt_pk_bf16_f32 v104, v104, v105
    v_cvt_pk_bf16_f32 v108, v108, v109
    v_pk_mul_f32 v[110:111], v[110:111], v[100:101] op_sel_hi:[1,0]
    v_xor_b32 v101, 32, v101
    v_cvt_pk_bf16_f32 v141, v142, v143
    v_pk_mul_f32 v[226:227], v[226:227], v[50:51] op_sel_hi:[1,0]
    v_pk_mul_f32 v[106:107], v[106:107], v[8:9] op_sel_hi:[1,0]
    v_cvt_pk_bf16_f32 v224, v224, v225
    v_cvt_pk_bf16_f32 v109, v110, v111
    v_cvt_pk_bf16_f32 v137, v138, v139
    s_waitcnt lgkmcnt(2)
    v_mfma_f32_16x16x32_bf16 a[56:59], a[220:223], v[38:41], 0
    ds_write2st64_b64 v101, v[124:125], v[172:173] offset0:0 offset1:12
    v_cvt_pk_bf16_f32 v105, v106, v107
    v_mfma_f32_16x16x32_bf16 a[60:63], a[224:227], v[38:41], 0
    ds_read_b64_tr_b16 a[212:213], v4 offset:1024
    v_accvgpr_read_b32 v110, a66
    v_mfma_f32_16x16x32_bf16 a[12:15], a[224:227], v[32:35], 0
    ds_write2st64_b64 v101, v[220:221], v[104:105] offset0:24 offset1:36
    v_accvgpr_read_b32 v107, a19
    v_accvgpr_read_b32 v104, a16
    v_mfma_f32_16x16x32_bf16 a[8:11], a[220:223], v[32:35], 0
    ds_write_b64 v101, v[108:109] offset:24576
    v_accvgpr_read_b32 v109, a65
    v_cvt_pk_bf16_f32 v144, v144, v145
    v_accvgpr_read_b32 v105, a17
    v_pk_mul_f32 v[104:105], v[104:105], v[8:9] op_sel_hi:[1,0]
    v_cvt_pk_bf16_f32 v233, v234, v235
    v_accvgpr_read_b32 v111, a67
    v_pk_mul_f32 v[182:183], v[182:183], v[102:103] op_sel_hi:[1,0]
    v_cvt_pk_bf16_f32 v36, v76, v77
    v_accvgpr_read_b32 v106, a18
    v_cvt_pk_bf16_f32 v104, v104, v105
    v_pk_mul_f32 v[202:203], v[202:203], v[102:103] op_sel_hi:[1,0]
    v_accvgpr_read_b32 v108, a64
    v_fma_f32 v56, v56, s28, v9
    v_pk_mul_f32 v[110:111], v[110:111], v[100:101] op_sel_hi:[1,0]
    v_pk_mul_f32 v[108:109], v[108:109], v[100:101] op_sel_hi:[1,0]
    v_xor_b32 v101, 96, v101
    v_pk_mul_f32 v[106:107], v[106:107], v[8:9] op_sel_hi:[1,0]
    v_cvt_pk_bf16_f32 v108, v108, v109
    v_cvt_pk_bf16_f32 v105, v106, v107
    v_cvt_pk_bf16_f32 v109, v110, v111
    v_mfma_f32_16x16x32_bf16 v[216:219], a[220:223], v[26:29], 0
    ds_read_b64_tr_b16 a[234:235], v3 offset:7168
    v_cvt_pk_bf16_f32 v129, v130, v131
    v_cvt_pk_bf16_f32 v225, v226, v227
    v_accvgpr_read_b32 v110, a70
    v_mfma_f32_16x16x32_bf16 v[220:223], a[224:227], v[26:29], 0
    ds_read_b64_tr_b16 a[218:219], v5 offset:7168
    ds_read_b64_tr_b16 a[230:231], v2 offset:7168
    v_mfma_f32_16x16x32_bf16 v[172:175], a[224:227], v[20:23], 0
    ds_write2st64_b64 v101, v[128:129], v[176:177] offset0:4 offset1:16
    v_mfma_f32_16x16x32_bf16 v[168:171], a[220:223], v[20:23], 0
    s_add_u32 s20, s20, 12032
    ds_write2st64_b64 v101, v[224:225], v[104:105] offset0:28 offset1:40
    v_mfma_f32_16x16x32_bf16 v[120:123], a[220:223], v[14:17], 0
    ds_write_b64 v101, v[108:109] offset:26624
    v_cvt_pk_bf16_f32 v145, v146, v147
    v_accvgpr_read_b32 v111, a71
    v_cvt_pk_bf16_f32 v249, v250, v251
    v_xor_b32 v101, 32, v101
    v_accvgpr_read_b32 v104, a20
    v_accvgpr_read_b32 v108, a68
    v_accvgpr_read_b32 v109, a69
    v_accvgpr_read_b32 v105, a21
    v_mfma_f32_16x16x32_bf16 v[124:127], a[224:227], v[14:17], 0
    s_add_u32 s39, s39, 12288
    ds_read_b128 v[96:99], v103 offset:0
    v_accvgpr_read_b32 v107, a23
    v_exp_f32 v55, v55
    v_accvgpr_read_b32 v106, a22
    v_pk_mul_f32 v[110:111], v[110:111], v[100:101] op_sel_hi:[1,0]
    v_cvt_pk_bf16_f32 v204, v204, v205
    v_cvt_pk_bf16_f32 v244, v244, v245
    v_pk_mul_f32 v[152:153], v[152:153], v[48:49] op_sel_hi:[1,0]
    v_pk_mul_f32 v[108:109], v[108:109], v[100:101] op_sel_hi:[1,0]
    v_cvt_pk_bf16_f32 v181, v182, v183
    v_pk_mul_f32 v[104:105], v[104:105], v[8:9] op_sel_hi:[1,0]
    v_cvt_pk_bf16_f32 v156, v156, v157
    s_waitcnt lgkmcnt(3)
    v_mfma_f32_16x16x32_bf16 v[128:131], a[228:231], v[14:17], 0
    ds_write2st64_b64 v101, v[132:133], v[180:181] offset0:4 offset1:16
    v_pk_mul_f32 v[106:107], v[106:107], v[8:9] op_sel_hi:[1,0]
    v_cvt_pk_bf16_f32 v31, v70, v71
    v_cvt_pk_bf16_f32 v253, v254, v255
    v_cvt_pk_bf16_f32 v152, v152, v153
    v_cvt_pk_bf16_f32 v104, v104, v105
    v_cvt_pk_bf16_f32 v105, v106, v107
    v_pk_mul_f32 v[206:207], v[206:207], v[102:103] op_sel_hi:[1,0]
    v_cvt_pk_bf16_f32 v237, v238, v239
    v_pk_mul_f32 v[190:191], v[190:191], v[102:103] op_sel_hi:[1,0]
    v_cvt_pk_bf16_f32 v108, v108, v109
    v_cvt_pk_bf16_f32 v188, v188, v189
    v_fma_f32 v53, v53, s28, v9
    v_cvt_pk_bf16_f32 v109, v110, v111
    v_pk_mul_f32 v[194:195], v[194:195], v[102:103] op_sel_hi:[1,0]
    v_cvt_pk_bf16_f32 v245, v246, v247
    v_fma_f32 v89, v89, s28, v13
    v_mfma_f32_16x16x32_bf16 v[132:135], a[232:235], v[14:17], 0
    ds_read_b64_tr_b16 a[216:217], v5 offset:1024
    v_accvgpr_read_b32 v110, a74
    v_mfma_f32_16x16x32_bf16 v[180:183], a[232:235], v[20:23], 0
    ds_write2st64_b64 v101, v[228:229], v[104:105] offset0:28 offset1:40
    v_mfma_f32_16x16x32_bf16 v[176:179], a[228:231], v[20:23], 0
    ds_write_b64 v101, v[108:109] offset:26624
    v_accvgpr_read_b32 v107, a27
    v_accvgpr_read_b32 v109, a73
    v_xor_b32 v101, 96, v101
    v_cvt_pk_bf16_f32 v192, v192, v193
    v_pk_mul_f32 v[154:155], v[154:155], v[48:49] op_sel_hi:[1,0]
    v_accvgpr_read_b32 v105, a25
    v_accvgpr_read_b32 v108, a72
    v_mfma_f32_16x16x32_bf16 v[224:227], a[228:231], v[26:29], 0
    ds_write2st64_b64 v101, v[136:137], v[184:185] offset0:4 offset1:16
    v_accvgpr_read_b32 v104, a24
    v_pk_mul_f32 v[150:151], v[150:151], v[48:49] op_sel_hi:[1,0]
    v_pk_mul_f32 v[104:105], v[104:105], v[8:9] op_sel_hi:[1,0]
    v_fma_f32 v81, v81, s28, v12
    v_accvgpr_read_b32 v111, a75
    v_cvt_pk_bf16_f32 v104, v104, v105
    v_cvt_pk_bf16_f32 v189, v190, v191
    v_cvt_pk_bf16_f32 v240, v240, v241
    v_accvgpr_read_b32 v106, a26
    v_cvt_pk_bf16_f32 v153, v154, v155
    v_pk_mul_f32 v[108:109], v[108:109], v[100:101] op_sel_hi:[1,0]
    v_cvt_pk_bf16_f32 v25, v62, v63
    v_cvt_pk_bf16_f32 v200, v200, v201
    v_pk_mul_f32 v[106:107], v[106:107], v[8:9] op_sel_hi:[1,0]
    v_cvt_pk_bf16_f32 v193, v194, v195
    v_cvt_pk_bf16_f32 v105, v106, v107
    v_cvt_pk_bf16_f32 v108, v108, v109
    v_accvgpr_read_b32 v107, a31
    v_pk_mul_f32 v[110:111], v[110:111], v[100:101] op_sel_hi:[1,0]
    v_fma_f32 v67, v67, s28, v10
    v_accvgpr_read_b32 v106, a30
    v_mfma_f32_16x16x32_bf16 v[228:231], a[232:235], v[26:29], 0
    ds_write2st64_b64 v101, v[232:233], v[104:105] offset0:28 offset1:40
    v_mfma_f32_16x16x32_bf16 a[20:23], a[232:235], v[32:35], 0
    ds_read_b64_tr_b16 a[222:223], v2 offset:8192
    v_cvt_pk_bf16_f32 v109, v110, v111
    v_mfma_f32_16x16x32_bf16 a[16:19], a[228:231], v[32:35], 0
    ds_read_b64_tr_b16 a[220:221], v2 offset:2048
    v_accvgpr_read_b32 v104, a28
    v_mfma_f32_16x16x32_bf16 a[64:67], a[228:231], v[38:41], 0
    ds_write_b64 v101, v[108:109] offset:26624
    v_xor_b32 v101, 32, v101
    v_accvgpr_read_b32 v105, a29
    v_pk_mul_f32 v[104:105], v[104:105], v[8:9] op_sel_hi:[1,0]
    v_accvgpr_read_b32 v109, a77
    v_accvgpr_read_b32 v108, a76
    v_pk_mul_f32 v[108:109], v[108:109], v[100:101] op_sel_hi:[1,0]
    v_accvgpr_read_b32 v110, a78
    v_cvt_pk_bf16_f32 v241, v242, v243
    v_accvgpr_read_b32 v111, a79
    v_mfma_f32_16x16x32_bf16 a[68:71], a[232:235], v[38:41], 0
    ds_read_b64_tr_b16 a[228:229], v4 offset:2048
    v_cvt_pk_bf16_f32 v108, v108, v109
    v_mfma_f32_16x16x32_bf16 a[72:75], a[212:215], v[38:41], 0
    s_waitcnt lgkmcnt(5)
    ds_read_b64_tr_b16 a[224:225], v3 offset:2048
    ds_read_b64_tr_b16 a[230:231], v4 offset:8192
    v_cvt_pk_bf16_f32 v104, v104, v105
    v_mfma_f32_16x16x32_bf16 a[76:79], a[216:219], v[38:41], 0
    buffer_store_dwordx4 v[96:99], v6, s[16:19], s67 offen offset:0 nt
    ds_read_b64_tr_b16 a[226:227], v3 offset:8192
    v_pk_mul_f32 v[110:111], v[110:111], v[100:101] op_sel_hi:[1,0]
    v_pk_mul_f32 v[106:107], v[106:107], v[8:9] op_sel_hi:[1,0]
    v_cvt_pk_bf16_f32 v109, v110, v111
    v_cvt_pk_bf16_f32 v105, v106, v107
    v_mfma_f32_16x16x32_bf16 a[28:31], a[216:219], v[32:35], 0
    ds_write2st64_b64 v101, v[140:141], v[188:189] offset0:4 offset1:16
    v_mfma_f32_16x16x32_bf16 a[24:27], a[212:215], v[32:35], 0
    ds_read_b64_tr_b16 a[234:235], v5 offset:8192
    ds_read_b64_tr_b16 a[232:233], v5 offset:2048
    v_mfma_f32_16x16x32_bf16 v[232:235], a[212:215], v[26:29], 0
    ds_write2st64_b64 v101, v[236:237], v[104:105] offset0:28 offset1:40
    v_accvgpr_read_b32 v106, a34
    v_mfma_f32_16x16x32_bf16 v[236:239], a[216:219], v[26:29], 0
    ds_read_b128 v[96:99], v103 offset:1024
    v_cvt_pk_bf16_f32 v201, v202, v203
    v_mfma_f32_16x16x32_bf16 v[188:191], a[216:219], v[20:23], 0
    ds_write_b64 v101, v[108:109] offset:26624
    v_accvgpr_read_b32 v109, a81
    v_accvgpr_read_b32 v105, a33
    v_accvgpr_read_b32 v104, a32
    v_accvgpr_read_b32 v111, a83
    v_exp_f32 v68, v68
    v_pk_mul_f32 v[104:105], v[104:105], v[8:9] op_sel_hi:[1,0]
    v_accvgpr_read_b32 v108, a80
    v_accvgpr_read_b32 v107, a35
    v_cvt_pk_bf16_f32 v104, v104, v105
    v_pk_mul_f32 v[108:109], v[108:109], v[100:101] op_sel_hi:[1,0]
    v_fma_f32 v65, v65, s28, v10
    v_fma_f32 v80, v80, s28, v12
    v_accvgpr_read_b32 v110, a82
    v_pk_mul_f32 v[106:107], v[106:107], v[8:9] op_sel_hi:[1,0]
    v_cvt_pk_bf16_f32 v19, v54, v55
    v_xor_b32 v101, 96, v101
    v_fma_f32 v72, v72, s28, v11
    v_cvt_pk_bf16_f32 v108, v108, v109
    v_cvt_pk_bf16_f32 v157, v158, v159
    v_mfma_f32_16x16x32_bf16 v[184:187], a[212:215], v[20:23], 0
    ds_write2st64_b64 v101, v[144:145], v[192:193] offset0:8 offset1:20
    v_cvt_pk_bf16_f32 v105, v106, v107
    v_pk_mul_f32 v[110:111], v[110:111], v[100:101] op_sel_hi:[1,0]
    v_cvt_pk_bf16_f32 v149, v150, v151
    v_cvt_pk_bf16_f32 v109, v110, v111
    v_mfma_f32_16x16x32_bf16 v[136:139], a[212:215], v[14:17], 0
    s_waitcnt vmcnt(7) lgkmcnt(2)
    ds_write2st64_b64 v101, v[240:241], v[104:105] offset0:32 offset1:44
    v_accvgpr_read_b32 v105, a37
    v_mfma_f32_16x16x32_bf16 v[140:143], a[216:219], v[14:17], 0
    buffer_store_dwordx4 v[96:99], v7, s[16:19], s67 offen offset:0 nt
    s_barrier
    ds_write_b64 v101, v[108:109] offset:0
    v_accvgpr_read_b32 v108, a84
    v_accvgpr_read_b32 v107, a39
    v_accvgpr_read_b32 v104, a36
    v_accvgpr_read_b32 v106, a38
    v_xor_b32 v101, 32, v101
    v_accvgpr_read_b32 v109, a85
    v_accvgpr_read_b32 v111, a87
    v_pk_mul_f32 v[106:107], v[106:107], v[8:9] op_sel_hi:[1,0]
    v_pk_mul_f32 v[108:109], v[108:109], v[100:101] op_sel_hi:[1,0]
    v_accvgpr_read_b32 v110, a86
    v_pk_mul_f32 v[110:111], v[110:111], v[100:101] op_sel_hi:[1,0]
    v_pk_mul_f32 v[104:105], v[104:105], v[8:9] op_sel_hi:[1,0]
    v_cvt_pk_bf16_f32 v108, v108, v109
    v_cvt_pk_bf16_f32 v104, v104, v105
    v_mfma_f32_16x16x32_bf16 v[144:147], a[220:223], v[14:17], 0
    s_add_u32 m0, s22, 24576
    ds_write2st64_b64 v101, v[148:149], v[196:197] offset0:8 offset1:20
    v_mfma_f32_16x16x32_bf16 v[148:151], a[224:227], v[14:17], 0
    ds_read_b128 a[216:219], v1 offset:0
    v_cvt_pk_bf16_f32 v105, v106, v107
    v_exp_f32 v53, v53
    v_mfma_f32_16x16x32_bf16 v[196:199], a[224:227], v[20:23], 0
    ds_write2st64_b64 v101, v[244:245], v[104:105] offset0:32 offset1:44
    v_mfma_f32_16x16x32_bf16 v[192:195], a[220:223], v[20:23], 0
    buffer_load_dwordx4 v6, s[8:11], s21 offen lds
    v_mfma_f32_16x16x32_bf16 v[240:243], a[220:223], v[26:29], 0
    v_cvt_pk_bf16_f32 v109, v110, v111
    v_accvgpr_read_b32 v105, a41
    v_accvgpr_read_b32 v106, a42
    v_accvgpr_read_b32 v107, a43
    v_accvgpr_read_b32 v104, a40
    v_mfma_f32_16x16x32_bf16 v[244:247], a[224:227], v[26:29], 0
    ds_write_b64 v101, v[108:109] offset:0
    v_accvgpr_read_b32 v111, a91
    v_cvt_pk_bf16_f32 v205, v206, v207
    v_xor_b32 v101, 96, v101
    v_accvgpr_read_b32 v108, a88
    v_accvgpr_read_b32 v109, a89
    v_accvgpr_read_b32 v110, a90
    v_mfma_f32_16x16x32_bf16 a[36:39], a[224:227], v[32:35], 0
    s_add_u32 s21, s21, 128
    ds_write2st64_b64 v101, v[152:153], v[200:201] offset0:8 offset1:20
    v_pk_mul_f32 v[104:105], v[104:105], v[8:9] op_sel_hi:[1,0]
    v_pk_mul_f32 v[110:111], v[110:111], v[100:101] op_sel_hi:[1,0]
    v_pk_mul_f32 v[106:107], v[106:107], v[8:9] op_sel_hi:[1,0]
    v_cvt_pk_bf16_f32 v104, v104, v105
    v_pk_mul_f32 v[108:109], v[108:109], v[100:101] op_sel_hi:[1,0]
    v_cvt_pk_bf16_f32 v105, v106, v107
    v_accvgpr_read_b32 v106, a46
    v_mfma_f32_16x16x32_bf16 a[32:35], a[220:223], v[32:35], 0
    ds_write2st64_b64 v101, v[248:249], v[104:105] offset0:32 offset1:44
    v_exp_f32 v67, v67
    v_cvt_pk_bf16_f32 v108, v108, v109
    v_cvt_pk_bf16_f32 v109, v110, v111
    v_mfma_f32_16x16x32_bf16 a[80:83], a[220:223], v[38:41], 0
    s_add_u32 m0, s22, 25600
    ds_read_b128 a[212:215], v0 offset:0
    v_accvgpr_read_b32 v110, a94
    v_fma_f32 v75, v75, s28, v11
    v_mfma_f32_16x16x32_bf16 a[84:87], a[224:227], v[38:41], 0
    ds_write_b64 v101, v[108:109] offset:0
    v_accvgpr_read_b32 v105, a45
    v_accvgpr_read_b32 v104, a44
    v_mfma_f32_16x16x32_bf16 a[88:91], a[228:231], v[38:41], 0
    buffer_load_dwordx4 v6, s[8:11], s21 offen lds
    ds_read_b128 v[96:99], v103 offset:2048
    v_accvgpr_read_b32 v111, a95
    v_accvgpr_read_b32 v109, a93
    v_accvgpr_read_b32 v108, a92
    v_pk_mul_f32 v[108:109], v[108:109], v[100:101] op_sel_hi:[1,0]
    v_accvgpr_read_b32 v107, a47
    v_pk_mul_f32 v[106:107], v[106:107], v[8:9] op_sel_hi:[1,0]
    v_pk_mul_f32 v[110:111], v[110:111], v[100:101] op_sel_hi:[1,0]
    v_pk_mul_f32 v[104:105], v[104:105], v[8:9] op_sel_hi:[1,0]
    v_exp_f32 v89, v89
    v_fma_f32 v59, v59, s28, v9
    v_mfma_f32_16x16x32_bf16 a[92:95], a[232:235], v[38:41], 0
    ds_read_b128 a[220:223], v0 offset:1024
    v_xor_b32 v101, 32, v101
    v_cvt_pk_bf16_f32 v18, v52, v53
    v_cvt_pk_bf16_f32 v104, v104, v105
    v_mfma_f32_16x16x32_bf16 a[44:47], a[232:235], v[32:35], 0
    ds_read_b128 a[224:227], v1 offset:1024
    v_cvt_pk_bf16_f32 v105, v106, v107
    v_mfma_f32_16x16x32_bf16 a[40:43], a[228:231], v[32:35], 0
    ds_write2st64_b64 v101, v[156:157], v[204:205] offset0:8 offset1:20
    v_mfma_f32_16x16x32_bf16 v[248:251], a[228:231], v[26:29], 0
    ds_write2st64_b64 v101, v[252:253], v[104:105] offset0:32 offset1:44
    v_fma_f32 v57, v57, s28, v9
    v_mfma_f32_16x16x32_bf16 v[252:255], a[232:235], v[26:29], 0
    s_add_u32 s21, s21, 128
    v_exp_f32 v56, v56
    v_mfma_f32_16x16x32_bf16 v[204:207], a[232:235], v[20:23], 0
    s_add_u32 m0, s22, 26624
    v_exp_f32 v81, v81
    v_mfma_f32_16x16x32_bf16 v[200:203], a[228:231], v[20:23], 0
    buffer_load_dwordx4 v6, s[8:11], s21 offen lds
    v_mfma_f32_16x16x32_bf16 v[152:155], a[228:231], v[14:17], 0
    v_exp_f32 v60, v60
    v_mfma_f32_16x16x32_bf16 v[156:159], a[232:235], v[14:17], 0
    s_waitcnt lgkmcnt(3)
    ds_read_b128 a[232:235], v1 offset:2048
    v_cvt_pk_bf16_f32 v30, v68, v69
    v_mfma_f32_16x16x32_bf16 v[52:55], a[212:215], a[96:99], 0
    s_add_u32 s21, s21, 12032
    v_exp_f32 v88, v88
    v_mfma_f32_16x16x32_bf16 v[52:55], a[216:219], a[100:103], v[52:55]
    s_add_u32 s56, s67, 128
    v_exp_f32 v66, v66
    v_mfma_f32_16x16x32_bf16 v[52:55], a[220:223], a[104:107], v[52:55]
    s_add_u32 s58, s33, 128
    ds_read_b128 a[228:231], v0 offset:2048
    v_cvt_pk_bf16_f32 v24, v60, v61
    v_mfma_f32_16x16x32_bf16 v[60:63], a[220:223], a[128:131], 0
    v_exp_f32 v86, v86
    v_mfma_f32_16x16x32_bf16 v[60:63], a[216:219], a[124:127], v[60:63]
    v_cvt_pk_bf16_f32 v23, v66, v67
    v_cvt_pk_bf16_f32 v37, v78, v79
    v_mfma_f32_16x16x32_bf16 v[60:63], a[212:215], a[120:123], v[60:63]
    s_add_u32 m0, s38, 2048
    v_exp_f32 v59, v59
    v_mfma_f32_16x16x32_bf16 v[68:71], a[212:215], a[144:147], 0
    buffer_load_dwordx4 v6, s[12:15], s58 offen nt lds
    v_mfma_f32_16x16x32_bf16 v[68:71], a[216:219], a[148:151], v[68:71]
    v_cvt_pk_bf16_f32 v40, v88, v89
    v_exp_f32 v72, v72
    v_mfma_f32_16x16x32_bf16 v[68:71], a[220:223], a[152:155], v[68:71]
    buffer_store_dwordx4 v[96:99], v6, s[16:19], s56 offen offset:0 nt
    s_nop 0
    ds_read_b128 v[96:99], v103 offset:3072
    v_exp_f32 v74, v74
    v_mfma_f32_16x16x32_bf16 v[76:79], a[220:223], a[176:179], 0
    v_exp_f32 v75, v75
    v_mfma_f32_16x16x32_bf16 v[76:79], a[216:219], a[172:175], v[76:79]
    v_exp_f32 v57, v57
    v_mfma_f32_16x16x32_bf16 v[76:79], a[212:215], a[168:171], v[76:79]
    v_exp_f32 v80, v80
    v_cvt_pk_bf16_f32 v43, v86, v87
    v_mfma_f32_16x16x32_bf16 v[84:87], a[212:215], a[192:195], 0
    s_add_u32 m0, s38, 3072
    v_cvt_pk_bf16_f32 v17, v58, v59
    v_fma_f32 v64, v64, s28, v10
    v_mfma_f32_16x16x32_bf16 v[84:87], a[216:219], a[196:199], v[84:87]
    v_exp_f32 v64, v64
    v_mfma_f32_16x16x32_bf16 v[84:87], a[220:223], a[200:203], v[84:87]
    s_waitcnt lgkmcnt(1)
    v_cvt_pk_bf16_f32 v108, v108, v109
    v_cvt_pk_bf16_f32 v16, v56, v57
    v_mfma_f32_16x16x32_bf16 v[84:87], a[224:227], a[204:207], v[84:87]
    v_exp_f32 v65, v65
    v_mfma_f32_16x16x32_bf16 v[84:87], a[228:231], a[208:211], v[84:87]
    v_exp_f32 v82, v82
    v_mfma_f32_16x16x32_bf16 v[48:51], a[236:239], v[16:19], v[44:47]
    v_cvt_pk_bf16_f32 v109, v110, v111
    v_cvt_pk_bf16_f32 v22, v64, v65
    v_mfma_f32_16x16x32_bf16 v[84:87], a[232:235], v[92:95], v[84:87]
    s_waitcnt lgkmcnt(0)
    buffer_load_dwordx4 v7, s[12:15], s58 offen nt lds
    v_mfma_f32_16x16x32_bf16 v[48:51], a[240:243], v[22:25], v[48:51]
    buffer_store_dwordx4 v[96:99], v7, s[16:19], s56 offen offset:0 nt
    ds_write_b64 v101, v[108:109] offset:0
    v_mfma_f32_16x16x32_bf16 v[76:79], a[232:235], a[188:191], v[76:79]
    s_add_u32 s57, s67, 24832
    ds_read_b128 v[96:99], v103 offset:0
    v_fma_f32 v73, v73, s28, v11
    v_mfma_f32_16x16x32_bf16 v[76:79], a[228:231], a[184:187], v[76:79]
    v_exp_f32 v83, v83
    v_mfma_f32_16x16x32_bf16 v[76:79], a[224:227], a[180:183], v[76:79]
    s_add_u32 m0, s38, 0
    v_mfma_f32_16x16x32_bf16 v[68:71], a[224:227], a[156:159], v[68:71]
    v_exp_f32 v73, v73
    v_mfma_f32_16x16x32_bf16 v[68:71], a[228:231], a[160:163], v[68:71]
    ds_read_b128 a[212:215], v0 offset:6144
    v_cvt_pk_bf16_f32 v28, v72, v73
    v_mfma_f32_16x16x32_bf16 v[68:71], a[232:235], a[164:167], v[68:71]
    v_cvt_pk_bf16_f32 v29, v74, v75
    v_mfma_f32_16x16x32_bf16 v[60:63], a[232:235], a[140:143], v[60:63]
    ds_read_b128 a[216:219], v1 offset:6144
    v_cvt_pk_bf16_f32 v35, v82, v83
    v_mfma_f32_16x16x32_bf16 v[60:63], a[228:231], a[136:139], v[60:63]
    ds_read_b128 a[220:223], v0 offset:7168
    v_cvt_pk_bf16_f32 v34, v80, v81
    v_mfma_f32_16x16x32_bf16 v[60:63], a[224:227], a[132:135], v[60:63]
    v_exp_f32 v90, v90
    v_mfma_f32_16x16x32_bf16 v[48:51], a[244:247], v[28:31], v[48:51]
    v_exp_f32 v91, v91
    v_mfma_f32_16x16x32_bf16 v[52:55], a[224:227], a[108:111], v[52:55]
    v_cvt_pk_bf16_f32 v41, v90, v91
    v_mfma_f32_16x16x32_bf16 v[48:51], a[248:251], v[34:37], v[48:51]
    s_waitcnt lgkmcnt(3)
    ds_read_b128 a[224:227], v1 offset:7168
    buffer_load_dwordx4 v6, s[12:15], s33 offen nt lds
    v_mfma_f32_16x16x32_bf16 v[48:51], a[252:255], v[40:43], v[48:51]
    buffer_store_dwordx4 v[96:99], v6, s[16:19], s57 offen offset:0 nt
    s_nop 0
    ds_read_b128 v[96:99], v103 offset:1024
    v_mfma_f32_16x16x32_bf16 v[52:55], a[228:231], a[112:115], v[52:55]
    s_add_u32 m0, s38, 1024
    v_mfma_f32_16x16x32_bf16 v[52:55], a[232:235], a[116:119], v[52:55]
    s_waitcnt lgkmcnt(4)
    ds_read_b128 a[228:231], v0 offset:8192
    v_mfma_f32_16x16x32_bf16 v[56:59], a[212:215], a[96:99], 0
    s_waitcnt lgkmcnt(4)
    v_add_u32 v103, 4096, v103
    v_cmp_lt_f32 vcc, s29, v48
    v_mfma_f32_16x16x32_bf16 v[56:59], a[216:219], a[100:103], v[56:59]
    s_waitcnt lgkmcnt(3)
    ds_read_b128 a[232:235], v1 offset:8192
    v_mfma_f32_16x16x32_bf16 v[56:59], a[220:223], a[104:107], v[56:59]
    s_nop 0
    s_cbranch_vccnz L_rs_tr55d
L_ret_tr55d:
    v_fma_f32 v53, v53, s28, v9
    v_mfma_f32_16x16x32_bf16 v[64:67], a[220:223], a[128:131], 0
    v_fma_f32 v62, v62, s28, v10
    v_fma_f32 v60, v60, s28, v10
    v_mfma_f32_16x16x32_bf16 v[64:67], a[216:219], a[124:127], v[64:67]
    v_fma_f32 v55, v55, s28, v9
    v_fma_f32 v63, v63, s28, v10
    v_mfma_f32_16x16x32_bf16 v[64:67], a[212:215], a[120:123], v[64:67]
    v_fma_f32 v52, v52, s28, v9
    v_mfma_f32_16x16x32_bf16 v[72:75], a[212:215], a[144:147], 0
    v_exp_f32 v62, v62
    v_mfma_f32_16x16x32_bf16 v[72:75], a[216:219], a[148:151], v[72:75]
    v_mfma_f32_16x16x32_bf16 v[72:75], a[220:223], a[152:155], v[72:75]
    v_exp_f32 v53, v53
    v_mfma_f32_16x16x32_bf16 v[80:83], a[220:223], a[176:179], 0
    v_exp_f32 v60, v60
    v_mfma_f32_16x16x32_bf16 v[80:83], a[216:219], a[172:175], v[80:83]
    s_waitcnt lgkmcnt(1)
    buffer_load_dwordx4 v7, s[12:15], s33 offen nt lds
    v_mfma_f32_16x16x32_bf16 v[80:83], a[212:215], a[168:171], v[80:83]
    s_waitcnt vmcnt(15) lgkmcnt(0)
    v_exp_f32 v52, v52
    v_mfma_f32_16x16x32_bf16 v[88:91], a[212:215], a[192:195], 0
    buffer_store_dwordx4 v[96:99], v7, s[16:19], s57 offen offset:0 nt
    s_barrier
    s_add_u32 m0, s22, 0
    ds_read_b64_tr_b16 a[212:213], v2 offset:18432
    v_mfma_f32_16x16x32_bf16 v[88:91], a[216:219], a[196:199], v[88:91]
    v_exp_f32 v55, v55
    v_mfma_f32_16x16x32_bf16 v[88:91], a[220:223], a[200:203], v[88:91]
    buffer_load_dwordx4 v6, s[4:7], s20 offen lds
    v_mfma_f32_16x16x32_bf16 v[88:91], a[224:227], a[204:207], v[88:91]
    v_mfma_f32_16x16x32_bf16 v[88:91], a[228:231], a[208:211], v[88:91]
    s_add_u32 s20, s20, 128
    ds_read_b64_tr_b16 a[214:215], v2 offset:12288
    s_add_u32 m0, s22, 1024
    v_mfma_f32_16x16x32_bf16 v[88:91], a[232:235], v[92:95], v[88:91]
    ds_read_b64_tr_b16 a[216:217], v3 offset:18432
    v_fma_f32 v61, v61, s28, v10
    v_mfma_f32_16x16x32_bf16 v[80:83], a[232:235], a[188:191], v[80:83]
    v_mfma_f32_16x16x32_bf16 v[80:83], a[228:231], a[184:187], v[80:83]
    ds_read_b64_tr_b16 a[218:219], v3 offset:12288
    v_fma_f32 v54, v54, s28, v9
    v_mfma_f32_16x16x32_bf16 v[80:83], a[224:227], a[180:183], v[80:83]
    v_exp_f32 v61, v61
    v_mfma_f32_16x16x32_bf16 v[72:75], a[224:227], a[156:159], v[72:75]
    v_exp_f32 v54, v54
    v_mfma_f32_16x16x32_bf16 v[72:75], a[228:231], a[160:163], v[72:75]
    v_cvt_pk_bf16_f32 v20, v60, v61
    v_cvt_pk_bf16_f32 v14, v52, v53
    v_mfma_f32_16x16x32_bf16 v[72:75], a[232:235], a[164:167], v[72:75]
    v_exp_f32 v63, v63
    v_mfma_f32_16x16x32_bf16 v[64:67], a[232:235], a[140:143], v[64:67]
    buffer_load_dwordx4 v6, s[4:7], s20 offen lds
    v_mfma_f32_16x16x32_bf16 v[64:67], a[228:231], a[136:139], v[64:67]
    s_add_u32 s20, s20, 128
    s_add_u32 m0, s22, 2048
    ds_read_b64_tr_b16 a[220:221], v4 offset:18432
    v_mfma_f32_16x16x32_bf16 v[64:67], a[224:227], a[132:135], v[64:67]
    buffer_load_dwordx4 v6, s[4:7], s20 offen lds
    v_mfma_f32_16x16x32_bf16 v[56:59], a[224:227], a[108:111], v[56:59]
    ds_read_b64_tr_b16 a[222:223], v4 offset:12288
    v_cvt_pk_bf16_f32 v15, v54, v55
    v_mfma_f32_16x16x32_bf16 v[56:59], a[228:231], a[112:115], v[56:59]
    s_add_u32 s20, s20, 12032
    ds_read_b64_tr_b16 a[224:225], v5 offset:18432
    v_mfma_f32_16x16x32_bf16 v[56:59], a[232:235], a[116:119], v[56:59]
    s_waitcnt lgkmcnt(3)
    ds_read_b64_tr_b16 a[226:227], v5 offset:12288
    v_cvt_pk_bf16_f32 v21, v62, v63
    s_branch L_loop5
L_loop4:
    .p2align 6
L_loop4w0:
    v_mfma_f32_16x16x32_bf16 v[112:115], a[212:215], v[16:19], v[112:115]
    v_fma_f32 v66, v66, s28, v10
    v_mfma_f32_16x16x32_bf16 v[160:163], a[212:215], v[22:25], v[160:163]
    ds_read_b64_tr_b16 a[228:229], v2 offset:19456
    v_fma_f32 v74, v74, s28, v11
    v_fma_f32 v68, v68, s28, v11
    v_mfma_f32_16x16x32_bf16 v[208:211], a[212:215], v[28:31], v[208:211]
    v_fma_f32 v58, v58, s28, v9
    v_mfma_f32_16x16x32_bf16 a[0:3], a[212:215], v[34:37], a[0:3]
    v_fma_f32 v63, v63, s28, v10
    s_waitcnt lgkmcnt(5)
    v_mfma_f32_16x16x32_bf16 a[4:7], a[216:219], v[34:37], a[4:7]
    ds_read_b64_tr_b16 a[230:231], v2 offset:13312
    v_mfma_f32_16x16x32_bf16 v[212:215], a[216:219], v[28:31], v[212:215]
    ds_read_b64_tr_b16 a[212:213], v4 offset:19456
    v_fma_f32 v64, v64, s28, v10
    v_mfma_f32_16x16x32_bf16 v[164:167], a[216:219], v[22:25], v[164:167]
    ds_read_b64_tr_b16 a[232:233], v3 offset:19456
    v_mfma_f32_16x16x32_bf16 v[116:119], a[216:219], v[16:19], v[116:119]
    ds_read_b64_tr_b16 a[234:235], v3 offset:13312
    s_waitcnt lgkmcnt(7)
    v_mfma_f32_16x16x32_bf16 v[120:123], a[220:223], v[16:19], v[120:123]
    v_exp_f32 v63, v63
    v_mfma_f32_16x16x32_bf16 v[168:171], a[220:223], v[22:25], v[168:171]
    ds_read_b64_tr_b16 a[216:217], v5 offset:19456
    v_fma_f32 v67, v67, s28, v10
    v_mfma_f32_16x16x32_bf16 v[216:219], a[220:223], v[28:31], v[216:219]
    v_exp_f32 v68, v68
    v_mfma_f32_16x16x32_bf16 a[8:11], a[220:223], v[34:37], a[8:11]
    s_waitcnt lgkmcnt(5)
    ds_read_b64_tr_b16 a[214:215], v4 offset:13312
    v_fma_f32 v69, v69, s28, v11
    v_mfma_f32_16x16x32_bf16 a[12:15], a[224:227], v[34:37], a[12:15]
    v_fma_f32 v79, v79, s28, v12
    v_fma_f32 v57, v57, s28, v9
    v_mfma_f32_16x16x32_bf16 v[220:223], a[224:227], v[28:31], v[220:223]
    v_fma_f32 v83, v83, s28, v12
    v_fma_f32 v71, v71, s28, v11
    v_mfma_f32_16x16x32_bf16 v[172:175], a[224:227], v[22:25], v[172:175]
    ds_read_b64_tr_b16 a[222:223], v2 offset:14336
    v_mfma_f32_16x16x32_bf16 v[124:127], a[224:227], v[16:19], v[124:127]
    s_waitcnt lgkmcnt(5)
    ds_read_b64_tr_b16 a[218:219], v5 offset:13312
    v_mfma_f32_16x16x32_bf16 v[128:131], a[228:231], v[16:19], v[128:131]
    v_exp_f32 v58, v58
    v_mfma_f32_16x16x32_bf16 v[176:179], a[228:231], v[22:25], v[176:179]
    ds_read_b64_tr_b16 a[220:221], v2 offset:20480
    v_fma_f32 v65, v65, s28, v10
    v_mfma_f32_16x16x32_bf16 v[224:227], a[228:231], v[28:31], v[224:227]
    s_add_u32 s39, s39, 12288
    ds_read_b64_tr_b16 a[224:225], v3 offset:20480
    v_fma_f32 v56, v56, s28, v9
    v_mfma_f32_16x16x32_bf16 a[16:19], a[228:231], v[34:37], a[16:19]
    s_waitcnt lgkmcnt(5)
    ds_read_b64_tr_b16 a[230:231], v4 offset:14336
    v_fma_f32 v70, v70, s28, v11
    v_mfma_f32_16x16x32_bf16 a[20:23], a[232:235], v[34:37], a[20:23]
    ds_read_b64_tr_b16 a[226:227], v3 offset:14336
    v_fma_f32 v62, v62, s28, v10
    v_mfma_f32_16x16x32_bf16 v[228:231], a[232:235], v[28:31], v[228:231]
    v_fma_f32 v73, v73, s28, v11
    v_fma_f32 v78, v78, s28, v12
    v_mfma_f32_16x16x32_bf16 v[180:183], a[232:235], v[22:25], v[180:183]
    ds_read_b64_tr_b16 a[228:229], v4 offset:20480
    v_fma_f32 v77, v77, s28, v12
    v_mfma_f32_16x16x32_bf16 v[132:135], a[232:235], v[16:19], v[132:135]
    s_waitcnt lgkmcnt(7)
    ds_read_b64_tr_b16 a[232:233], v5 offset:20480
    v_fma_f32 v72, v72, s28, v11
    v_mfma_f32_16x16x32_bf16 v[136:139], a[212:215], v[16:19], v[136:139]
    ds_read_b64_tr_b16 a[234:235], v5 offset:14336
    v_fma_f32 v81, v81, s28, v12
    v_mfma_f32_16x16x32_bf16 v[184:187], a[212:215], v[22:25], v[184:187]
    ds_read_b128 v[88:91], v103 offset:0
    v_mfma_f32_16x16x32_bf16 v[232:235], a[212:215], v[28:31], v[232:235]
    v_exp_f32 v62, v62
    v_mfma_f32_16x16x32_bf16 a[24:27], a[212:215], v[34:37], a[24:27]
    s_waitcnt lgkmcnt(7)
    v_exp_f32 v67, v67
    v_mfma_f32_16x16x32_bf16 a[28:31], a[216:219], v[34:37], a[28:31]
    v_exp_f32 v69, v69
    v_mfma_f32_16x16x32_bf16 v[236:239], a[216:219], v[28:31], v[236:239]
    v_fma_f32 v80, v80, s28, v12
    v_fma_f32 v76, v76, s28, v12
    v_mfma_f32_16x16x32_bf16 v[188:191], a[216:219], v[22:25], v[188:191]
    v_exp_f32 v70, v70
    v_mfma_f32_16x16x32_bf16 v[140:143], a[216:219], v[16:19], v[140:143]
    ds_read_b128 v[84:87], v103 offset:2048
    v_mfma_f32_16x16x32_bf16 v[144:147], a[220:223], v[16:19], v[144:147]
    v_exp_f32 v65, v65
    v_mfma_f32_16x16x32_bf16 v[192:195], a[220:223], v[22:25], v[192:195]
    v_exp_f32 v66, v66
    v_mfma_f32_16x16x32_bf16 v[240:243], a[220:223], v[28:31], v[240:243]
    s_waitcnt vmcnt(10) lgkmcnt(2)
    v_exp_f32 v77, v77
    v_mfma_f32_16x16x32_bf16 a[32:35], a[220:223], v[34:37], a[32:35]
    s_barrier
    v_mfma_f32_16x16x32_bf16 a[36:39], a[224:227], v[34:37], a[36:39]
    s_add_u32 m0, s22, 36864
    v_exp_f32 v72, v72
    v_mfma_f32_16x16x32_bf16 v[244:247], a[224:227], v[28:31], v[244:247]
    ds_read_b128 a[212:215], v0 offset:12288
    v_mfma_f32_16x16x32_bf16 v[196:199], a[224:227], v[22:25], v[196:199]
    ds_read_b128 a[216:219], v1 offset:12288
    v_fma_f32 v59, v59, s28, v9
    v_mfma_f32_16x16x32_bf16 v[148:151], a[224:227], v[16:19], v[148:151]
    ds_read_b128 a[220:223], v0 offset:13312
    v_mfma_f32_16x16x32_bf16 v[152:155], a[228:231], v[16:19], v[152:155]
    buffer_load_dwordx4 v6, s[8:11], s21 offen lds
    v_mfma_f32_16x16x32_bf16 v[200:203], a[228:231], v[22:25], v[200:203]
    s_add_u32 s21, s21, 128
    v_exp_f32 v78, v78
    v_mfma_f32_16x16x32_bf16 v[248:251], a[228:231], v[28:31], v[248:251]
    s_add_u32 m0, s22, 37888
    v_exp_f32 v79, v79
    v_mfma_f32_16x16x32_bf16 a[40:43], a[228:231], v[34:37], a[40:43]
    buffer_load_dwordx4 v6, s[8:11], s21 offen lds
    v_mfma_f32_16x16x32_bf16 a[44:47], a[232:235], v[34:37], a[44:47]
    s_add_u32 s21, s21, 128
    s_add_u32 m0, s22, 38912
    v_mfma_f32_16x16x32_bf16 v[252:255], a[232:235], v[28:31], v[252:255]
    v_exp_f32 v71, v71
    v_mfma_f32_16x16x32_bf16 v[204:207], a[232:235], v[22:25], v[204:207]
    buffer_load_dwordx4 v6, s[8:11], s21 offen lds
    v_mfma_f32_16x16x32_bf16 v[156:159], a[232:235], v[16:19], v[156:159]
    s_waitcnt lgkmcnt(2)
    ds_read_b128 a[224:227], v1 offset:13312
    v_fma_f32 v75, v75, s28, v11
    v_mfma_f32_16x16x32_bf16 v[52:55], a[212:215], a[96:99], 0
    s_waitcnt lgkmcnt(2)
    ds_read_b128 a[232:235], v1 offset:14336
    v_cvt_pk_bf16_f32 v26, v68, v69
    v_mfma_f32_16x16x32_bf16 v[52:55], a[216:219], a[100:103], v[52:55]
    s_waitcnt lgkmcnt(2)
    v_exp_f32 v76, v76
    v_mfma_f32_16x16x32_bf16 v[52:55], a[220:223], a[104:107], v[52:55]
    v_fma_f32 v82, v82, s28, v12
    v_cvt_pk_bf16_f32 v21, v62, v63
    v_mfma_f32_16x16x32_bf16 v[60:63], a[220:223], a[128:131], 0
    ds_read_b128 a[228:231], v0 offset:14336
    v_cvt_pk_bf16_f32 v23, v66, v67
    v_mfma_f32_16x16x32_bf16 v[60:63], a[216:219], a[124:127], v[60:63]
    v_mfma_f32_16x16x32_bf16 v[60:63], a[212:215], a[120:123], v[60:63]
    v_cvt_pk_bf16_f32 v32, v76, v77
    v_cvt_pk_bf16_f32 v27, v70, v71
    v_mfma_f32_16x16x32_bf16 v[68:71], a[212:215], a[144:147], 0
    s_add_u32 s21, s21, 12032
    v_exp_f32 v59, v59
    v_mfma_f32_16x16x32_bf16 v[68:71], a[216:219], a[148:151], v[68:71]
    s_add_u32 m0, s23, 0
    v_exp_f32 v74, v74
    v_mfma_f32_16x16x32_bf16 v[68:71], a[220:223], a[152:155], v[68:71]
    buffer_store_dwordx4 v[88:91], v38, s[16:19], s24 offen offset:0 nt
    v_exp_f32 v81, v81
    v_cvt_pk_bf16_f32 v33, v78, v79
    v_mfma_f32_16x16x32_bf16 v[76:79], a[220:223], a[176:179], 0
    v_cvt_pk_bf16_f32 v17, v58, v59
    v_mfma_f32_16x16x32_bf16 v[76:79], a[216:219], a[172:175], v[76:79]
    v_exp_f32 v82, v82
    v_mfma_f32_16x16x32_bf16 v[76:79], a[212:215], a[168:171], v[76:79]
    s_waitcnt lgkmcnt(1)
    v_exp_f32 v83, v83
    v_mfma_f32_16x16x32_bf16 v[76:79], a[224:227], a[180:183], v[76:79]
    s_waitcnt lgkmcnt(0)
    ds_read_b128 a[212:215], v0 offset:18432
    v_cvt_pk_bf16_f32 v35, v82, v83
    v_mfma_f32_16x16x32_bf16 v[76:79], a[228:231], a[184:187], v[76:79]
    ds_read_b128 a[220:223], v0 offset:19456
    v_mfma_f32_16x16x32_bf16 v[76:79], a[232:235], a[188:191], v[76:79]
    v_exp_f32 v75, v75
    v_mfma_f32_16x16x32_bf16 v[68:71], a[232:235], a[164:167], v[68:71]
    ds_read_b128 a[216:219], v1 offset:18432
    v_cvt_pk_bf16_f32 v29, v74, v75
    v_mfma_f32_16x16x32_bf16 v[68:71], a[228:231], a[160:163], v[68:71]
    v_exp_f32 v57, v57
    v_mfma_f32_16x16x32_bf16 v[68:71], a[224:227], a[156:159], v[68:71]
    buffer_load_dwordx4 v38, s[12:15], s25 offen nt lds
    v_mfma_f32_16x16x32_bf16 v[60:63], a[224:227], a[132:135], v[60:63]
    v_exp_f32 v56, v56
    v_mfma_f32_16x16x32_bf16 v[60:63], a[228:231], a[136:139], v[60:63]
    s_bitcmp1_b32 s27, 0
    v_exp_f32 v64, v64
    v_mfma_f32_16x16x32_bf16 v[60:63], a[232:235], a[140:143], v[60:63]
    v_exp_f32 v73, v73
    v_mfma_f32_16x16x32_bf16 v[52:55], a[232:235], a[116:119], v[52:55]
    ds_read_b128 a[232:235], v1 offset:20480
    v_cvt_pk_bf16_f32 v22, v64, v65
    v_mfma_f32_16x16x32_bf16 v[52:55], a[228:231], a[112:115], v[52:55]
    ds_read_b128 a[228:231], v0 offset:20480
    v_cvt_pk_bf16_f32 v28, v72, v73
    v_mfma_f32_16x16x32_bf16 v[52:55], a[224:227], a[108:111], v[52:55]
    s_waitcnt lgkmcnt(3)
    ds_read_b128 a[224:227], v1 offset:19456
    v_cvt_pk_bf16_f32 v16, v56, v57
    v_mfma_f32_16x16x32_bf16 v[56:59], a[212:215], a[96:99], 0
    s_cselect_b32 s26, s49, 128
    s_bitcmp1_b32 s89, 0
    s_cselect_b32 s26, s26, 0
    v_mfma_f32_16x16x32_bf16 v[44:47], a[236:239], v[14:17], v[48:51]
    v_exp_f32 v80, v80
    v_mfma_f32_16x16x32_bf16 v[44:47], a[240:243], v[20:23], v[44:47]
    v_cvt_pk_bf16_f32 v34, v80, v81
    s_lshr_b32 s89, s89, 1
    v_mfma_f32_16x16x32_bf16 v[44:47], a[244:247], v[26:29], v[44:47]
    s_waitcnt lgkmcnt(3)
    v_mfma_f32_16x16x32_bf16 v[56:59], a[216:219], a[100:103], v[56:59]
    v_mfma_f32_16x16x32_bf16 v[56:59], a[220:223], a[104:107], v[56:59]
    v_mfma_f32_16x16x32_bf16 v[44:47], a[248:251], v[32:35], v[44:47]
    s_lshr_b32 s27, s27, 1
    v_mfma_f32_16x16x32_bf16 v[64:67], a[220:223], a[128:131], 0
    s_add_u32 s24, s24, s26
    s_add_u32 s25, s25, s26
    ds_read_b128 v[96:99], v103 offset:1024
    v_mfma_f32_16x16x32_bf16 v[64:67], a[216:219], a[124:127], v[64:67]
    v_mfma_f32_16x16x32_bf16 v[64:67], a[212:215], a[120:123], v[64:67]
    s_nop 0
    v_cmp_lt_f32 vcc, s29, v44
    s_waitcnt vmcnt(10) lgkmcnt(1)
    v_mfma_f32_16x16x32_bf16 v[72:75], a[212:215], a[144:147], 0
    s_barrier
    v_mfma_f32_16x16x32_bf16 v[72:75], a[216:219], a[148:151], v[72:75]
    s_nop 0
    s_cbranch_vccnz L_rs_loop4w0a
L_ret_loop4w0a:
    v_mfma_f32_16x16x32_bf16 v[72:75], a[220:223], a[152:155], v[72:75]
    s_add_u32 m0, s22, 12288
    v_fma_f32 v78, v78, s28, v12
    v_fma_f32 v62, v62, s28, v10
    v_mfma_f32_16x16x32_bf16 v[80:83], a[220:223], a[176:179], 0
    buffer_load_dwordx4 v6, s[4:7], s20 offen lds
    v_mfma_f32_16x16x32_bf16 v[80:83], a[216:219], a[172:175], v[80:83]
    s_add_u32 s20, s20, 128
    v_exp_f32 v78, v78
    v_mfma_f32_16x16x32_bf16 v[80:83], a[212:215], a[168:171], v[80:83]
    s_add_u32 m0, s22, 13312
    ds_read_b64_tr_b16 a[212:213], v2 offset:0
    v_fma_f32 v53, v53, s28, v9
    v_mfma_f32_16x16x32_bf16 v[80:83], a[224:227], a[180:183], v[80:83]
    buffer_load_dwordx4 v6, s[4:7], s20 offen lds
    v_mfma_f32_16x16x32_bf16 v[80:83], a[228:231], a[184:187], v[80:83]
    s_add_u32 s20, s20, 128
    ds_read_b64_tr_b16 a[214:215], v2 offset:6144
    v_fma_f32 v68, v68, s28, v11
    v_mfma_f32_16x16x32_bf16 v[80:83], a[232:235], a[188:191], v[80:83]
    s_add_u32 m0, s22, 14336
    ds_read_b64_tr_b16 a[216:217], v3 offset:0
    v_mfma_f32_16x16x32_bf16 v[72:75], a[232:235], a[164:167], v[72:75]
    ds_read_b64_tr_b16 a[218:219], v3 offset:6144
    v_fma_f32 v71, v71, s28, v11
    v_mfma_f32_16x16x32_bf16 v[72:75], a[228:231], a[160:163], v[72:75]
    buffer_load_dwordx4 v6, s[4:7], s20 offen lds
    v_mfma_f32_16x16x32_bf16 v[72:75], a[224:227], a[156:159], v[72:75]
    s_add_u32 s20, s20, 12032
    ds_read_b64_tr_b16 a[220:221], v4 offset:0
    v_fma_f32 v69, v69, s28, v11
    v_mfma_f32_16x16x32_bf16 v[64:67], a[224:227], a[132:135], v[64:67]
    v_fma_f32 v61, v61, s28, v10
    v_fma_f32 v60, v60, s28, v10
    v_mfma_f32_16x16x32_bf16 v[64:67], a[228:231], a[136:139], v[64:67]
    ds_read_b64_tr_b16 a[222:223], v4 offset:6144
    v_fma_f32 v79, v79, s28, v12
    v_mfma_f32_16x16x32_bf16 v[64:67], a[232:235], a[140:143], v[64:67]
    v_exp_f32 v53, v53
    v_mfma_f32_16x16x32_bf16 v[56:59], a[232:235], a[116:119], v[56:59]
    s_add_u32 s39, s39, 12288
    v_exp_f32 v60, v60
    v_mfma_f32_16x16x32_bf16 v[56:59], a[228:231], a[112:115], v[56:59]
    s_add_u32 m0, s23, 1024
    v_fma_f32 v63, v63, s28, v10
    v_fma_f32 v54, v54, s28, v9
    v_mfma_f32_16x16x32_bf16 v[56:59], a[224:227], a[108:111], v[56:59]
    s_waitcnt lgkmcnt(4)
    v_exp_f32 v79, v79
    v_mfma_f32_16x16x32_bf16 v[112:115], a[212:215], v[14:17], v[112:115]
    ds_read_b64_tr_b16 a[228:229], v2 offset:1024
    v_fma_f32 v55, v55, s28, v9
    v_mfma_f32_16x16x32_bf16 v[160:163], a[212:215], v[20:23], v[160:163]
    ds_read_b64_tr_b16 a[224:225], v5 offset:0
    v_fma_f32 v70, v70, s28, v11
    v_mfma_f32_16x16x32_bf16 v[208:211], a[212:215], v[26:29], v[208:211]
    ds_read_b64_tr_b16 a[234:235], v3 offset:7168
    v_fma_f32 v77, v77, s28, v12
    v_mfma_f32_16x16x32_bf16 a[0:3], a[212:215], v[32:35], a[0:3]
    s_waitcnt lgkmcnt(4)
    ds_read_b64_tr_b16 a[226:227], v5 offset:6144
    v_fma_f32 v74, v74, s28, v11
    v_mfma_f32_16x16x32_bf16 a[4:7], a[216:219], v[32:35], a[4:7]
    ds_read_b64_tr_b16 a[230:231], v2 offset:7168
    v_mfma_f32_16x16x32_bf16 v[212:215], a[216:219], v[26:29], v[212:215]
    buffer_store_dwordx4 v[96:99], v39, s[16:19], s24 offen offset:0 nt
    ds_read_b64_tr_b16 a[212:213], v4 offset:1024
    v_exp_f32 v77, v77
    v_mfma_f32_16x16x32_bf16 v[164:167], a[216:219], v[20:23], v[164:167]
    v_exp_f32 v55, v55
    v_mfma_f32_16x16x32_bf16 v[116:119], a[216:219], v[14:17], v[116:119]
    s_waitcnt lgkmcnt(6)
    ds_read_b64_tr_b16 a[232:233], v3 offset:1024
    v_fma_f32 v75, v75, s28, v11
    v_mfma_f32_16x16x32_bf16 v[120:123], a[220:223], v[14:17], v[120:123]
    ds_read_b64_tr_b16 a[214:215], v4 offset:7168
    v_mfma_f32_16x16x32_bf16 v[168:171], a[220:223], v[20:23], v[168:171]
    ds_read_b64_tr_b16 a[218:219], v5 offset:7168
    v_mfma_f32_16x16x32_bf16 v[216:219], a[220:223], v[26:29], v[216:219]
    v_exp_f32 v61, v61
    v_mfma_f32_16x16x32_bf16 a[8:11], a[220:223], v[32:35], a[8:11]
    ds_read_b64_tr_b16 a[216:217], v5 offset:1024
    s_waitcnt lgkmcnt(6)
    v_mfma_f32_16x16x32_bf16 a[12:15], a[224:227], v[32:35], a[12:15]
    v_exp_f32 v54, v54
    v_mfma_f32_16x16x32_bf16 v[220:223], a[224:227], v[26:29], v[220:223]
    ds_read_b64_tr_b16 a[220:221], v2 offset:2048
    v_fma_f32 v73, v73, s28, v11
    v_mfma_f32_16x16x32_bf16 v[172:175], a[224:227], v[20:23], v[172:175]
    buffer_load_dwordx4 v39, s[12:15], s25 offen nt lds
    v_mfma_f32_16x16x32_bf16 v[124:127], a[224:227], v[14:17], v[124:127]
    s_waitcnt lgkmcnt(5)
    ds_read_b64_tr_b16 a[222:223], v2 offset:8192
    v_fma_f32 v57, v57, s28, v9
    v_mfma_f32_16x16x32_bf16 v[128:131], a[228:231], v[14:17], v[128:131]
    s_bitcmp1_b32 s27, 0
    ds_read_b64_tr_b16 a[224:225], v3 offset:2048
    v_fma_f32 v52, v52, s28, v9
    v_mfma_f32_16x16x32_bf16 v[176:179], a[228:231], v[20:23], v[176:179]
    v_exp_f32 v69, v69
    v_mfma_f32_16x16x32_bf16 v[224:227], a[228:231], v[26:29], v[224:227]
    v_exp_f32 v71, v71
    v_mfma_f32_16x16x32_bf16 a[16:19], a[228:231], v[32:35], a[16:19]
    s_waitcnt lgkmcnt(4)
    ds_read_b64_tr_b16 a[230:231], v4 offset:8192
    v_fma_f32 v58, v58, s28, v9
    v_mfma_f32_16x16x32_bf16 a[20:23], a[232:235], v[32:35], a[20:23]
    v_exp_f32 v52, v52
    v_mfma_f32_16x16x32_bf16 v[228:231], a[232:235], v[26:29], v[228:231]
    ds_read_b64_tr_b16 a[226:227], v3 offset:8192
    v_fma_f32 v76, v76, s28, v12
    v_mfma_f32_16x16x32_bf16 v[180:183], a[232:235], v[20:23], v[180:183]
    s_cselect_b32 s26, s49, 128
    s_bitcmp1_b32 s89, 0
    ds_read_b64_tr_b16 a[228:229], v4 offset:2048
    v_mfma_f32_16x16x32_bf16 v[132:135], a[232:235], v[14:17], v[132:135]
    ds_read_b64_tr_b16 a[232:233], v5 offset:2048
    v_fma_f32 v80, v80, s28, v12
    v_mfma_f32_16x16x32_bf16 v[136:139], a[212:215], v[14:17], v[136:139]
    s_cselect_b32 s26, s26, 0
    ds_read_b64_tr_b16 a[234:235], v5 offset:8192
    v_fma_f32 v82, v82, s28, v12
    v_mfma_f32_16x16x32_bf16 v[184:187], a[212:215], v[20:23], v[184:187]
    v_exp_f32 v68, v68
    v_mfma_f32_16x16x32_bf16 v[232:235], a[212:215], v[26:29], v[232:235]
    s_lshr_b32 s89, s89, 1
    v_exp_f32 v63, v63
    v_mfma_f32_16x16x32_bf16 a[24:27], a[212:215], v[32:35], a[24:27]
    s_waitcnt lgkmcnt(5)
    v_exp_f32 v70, v70
    v_mfma_f32_16x16x32_bf16 a[28:31], a[216:219], v[32:35], a[28:31]
    v_exp_f32 v80, v80
    v_mfma_f32_16x16x32_bf16 v[236:239], a[216:219], v[26:29], v[236:239]
    v_fma_f32 v72, v72, s28, v11
    s_lshr_b32 s27, s27, 1
    v_mfma_f32_16x16x32_bf16 v[188:191], a[216:219], v[20:23], v[188:191]
    s_add_u32 s24, s24, s26
    v_cvt_pk_bf16_f32 v19, v54, v55
    v_mfma_f32_16x16x32_bf16 v[140:143], a[216:219], v[14:17], v[140:143]
    v_cvt_pk_bf16_f32 v24, v60, v61
    v_mfma_f32_16x16x32_bf16 v[144:147], a[220:223], v[14:17], v[144:147]
    v_exp_f32 v73, v73
    v_mfma_f32_16x16x32_bf16 v[192:195], a[220:223], v[20:23], v[192:195]
    v_fma_f32 v81, v81, s28, v12
    s_add_u32 s25, s25, s26
    v_mfma_f32_16x16x32_bf16 v[240:243], a[220:223], v[26:29], v[240:243]
    s_waitcnt vmcnt(10) lgkmcnt(0)
    v_exp_f32 v62, v62
    v_mfma_f32_16x16x32_bf16 a[32:35], a[220:223], v[32:35], a[32:35]
    s_barrier
    v_mfma_f32_16x16x32_bf16 a[36:39], a[224:227], v[32:35], a[36:39]
    s_add_u32 m0, s22, 24576
    ds_read_b128 a[212:215], v0 offset:0
    v_cvt_pk_bf16_f32 v25, v62, v63
    v_mfma_f32_16x16x32_bf16 v[244:247], a[224:227], v[26:29], v[244:247]
    buffer_load_dwordx4 v6, s[8:11], s21 offen lds
    v_mfma_f32_16x16x32_bf16 v[196:199], a[224:227], v[20:23], v[196:199]
    s_add_u32 s21, s21, 128
    ds_read_b128 a[216:219], v1 offset:0
    v_cvt_pk_bf16_f32 v30, v68, v69
    v_mfma_f32_16x16x32_bf16 v[148:151], a[224:227], v[14:17], v[148:151]
    s_add_u32 m0, s22, 25600
    ds_read_b128 a[220:223], v0 offset:1024
    v_cvt_pk_bf16_f32 v18, v52, v53
    v_mfma_f32_16x16x32_bf16 v[152:155], a[228:231], v[14:17], v[152:155]
    buffer_load_dwordx4 v6, s[8:11], s21 offen lds
    v_mfma_f32_16x16x32_bf16 v[200:203], a[228:231], v[20:23], v[200:203]
    v_exp_f32 v76, v76
    v_mfma_f32_16x16x32_bf16 v[248:251], a[228:231], v[26:29], v[248:251]
    s_add_u32 s21, s21, 128
    ds_read_b128 a[224:227], v1 offset:1024
    v_mfma_f32_16x16x32_bf16 a[40:43], a[228:231], v[32:35], a[40:43]
    v_fma_f32 v65, v65, s28, v10
    v_fma_f32 v83, v83, s28, v12
    v_mfma_f32_16x16x32_bf16 a[44:47], a[232:235], v[32:35], a[44:47]
    s_add_u32 m0, s22, 26624
    v_exp_f32 v58, v58
    v_mfma_f32_16x16x32_bf16 v[252:255], a[232:235], v[26:29], v[252:255]
    buffer_load_dwordx4 v6, s[8:11], s21 offen lds
    v_mfma_f32_16x16x32_bf16 v[204:207], a[232:235], v[20:23], v[204:207]
    ds_read_b128 a[228:231], v0 offset:2048
    v_fma_f32 v59, v59, s28, v9
    v_mfma_f32_16x16x32_bf16 v[156:159], a[232:235], v[14:17], v[156:159]
    s_waitcnt lgkmcnt(4)
    v_fma_f32 v66, v66, s28, v10
    v_fma_f32 v64, v64, s28, v10
    v_mfma_f32_16x16x32_bf16 v[52:55], a[212:215], a[96:99], 0
    s_waitcnt lgkmcnt(3)
    v_exp_f32 v64, v64
    v_mfma_f32_16x16x32_bf16 v[52:55], a[216:219], a[100:103], v[52:55]
    s_waitcnt lgkmcnt(2)
    v_exp_f32 v83, v83
    v_mfma_f32_16x16x32_bf16 v[52:55], a[220:223], a[104:107], v[52:55]
    s_add_u32 s21, s21, 12032
    v_cvt_pk_bf16_f32 v31, v70, v71
    v_cvt_pk_bf16_f32 v37, v78, v79
    v_mfma_f32_16x16x32_bf16 v[60:63], a[220:223], a[128:131], 0
    ds_read_b128 a[232:235], v1 offset:2048
    v_fma_f32 v67, v67, s28, v10
    v_mfma_f32_16x16x32_bf16 v[60:63], a[216:219], a[124:127], v[60:63]
    buffer_store_dwordx4 v[84:87], v38, s[16:19], s24 offen offset:0 nt
    v_fma_f32 v56, v56, s28, v9
    v_exp_f32 v74, v74
    v_mfma_f32_16x16x32_bf16 v[60:63], a[212:215], a[120:123], v[60:63]
    v_exp_f32 v81, v81
    v_mfma_f32_16x16x32_bf16 v[68:71], a[212:215], a[144:147], 0
    v_exp_f32 v59, v59
    v_mfma_f32_16x16x32_bf16 v[68:71], a[216:219], a[148:151], v[68:71]
    v_exp_f32 v57, v57
    v_mfma_f32_16x16x32_bf16 v[68:71], a[220:223], a[152:155], v[68:71]
    v_cvt_pk_bf16_f32 v36, v76, v77
    v_cvt_pk_bf16_f32 v34, v80, v81
    v_mfma_f32_16x16x32_bf16 v[76:79], a[220:223], a[176:179], 0
    v_exp_f32 v67, v67
    v_mfma_f32_16x16x32_bf16 v[76:79], a[216:219], a[172:175], v[76:79]
    v_exp_f32 v75, v75
    v_mfma_f32_16x16x32_bf16 v[76:79], a[212:215], a[168:171], v[76:79]
    s_add_u32 m0, s23, 2048
    ds_read_b128 a[212:215], v0 offset:6144
    s_waitcnt lgkmcnt(1)
    v_mfma_f32_16x16x32_bf16 v[76:79], a[224:227], a[180:183], v[76:79]
    v_exp_f32 v82, v82
    v_mfma_f32_16x16x32_bf16 v[76:79], a[228:231], a[184:187], v[76:79]
    buffer_load_dwordx4 v38, s[12:15], s25 offen nt lds
    v_mfma_f32_16x16x32_bf16 v[76:79], a[232:235], a[188:191], v[76:79]
    v_exp_f32 v65, v65
    v_mfma_f32_16x16x32_bf16 v[68:71], a[232:235], a[164:167], v[68:71]
    v_exp_f32 v72, v72
    v_mfma_f32_16x16x32_bf16 v[68:71], a[228:231], a[160:163], v[68:71]
    v_exp_f32 v56, v56
    v_mfma_f32_16x16x32_bf16 v[68:71], a[224:227], a[156:159], v[68:71]
    s_bitcmp1_b32 s27, 0
    ds_read_b128 a[220:223], v0 offset:7168
    v_cvt_pk_bf16_f32 v16, v56, v57
    v_mfma_f32_16x16x32_bf16 v[60:63], a[224:227], a[132:135], v[60:63]
    ds_read_b128 a[216:219], v1 offset:6144
    v_cvt_pk_bf16_f32 v17, v58, v59
    v_mfma_f32_16x16x32_bf16 v[60:63], a[228:231], a[136:139], v[60:63]
    s_cselect_b32 s26, s49, 128
    v_cvt_pk_bf16_f32 v22, v64, v65
    v_cvt_pk_bf16_f32 v29, v74, v75
    v_mfma_f32_16x16x32_bf16 v[60:63], a[232:235], a[140:143], v[60:63]
    v_exp_f32 v66, v66
    v_mfma_f32_16x16x32_bf16 v[52:55], a[232:235], a[116:119], v[52:55]
    s_bitcmp1_b32 s89, 0
    ds_read_b128 a[232:235], v1 offset:8192
    v_mfma_f32_16x16x32_bf16 v[52:55], a[228:231], a[112:115], v[52:55]
    s_cselect_b32 s26, s26, 0
    ds_read_b128 a[228:231], v0 offset:8192
    v_cvt_pk_bf16_f32 v35, v82, v83
    v_mfma_f32_16x16x32_bf16 v[52:55], a[224:227], a[108:111], v[52:55]
    ds_read_b128 a[224:227], v1 offset:7168
    v_cvt_pk_bf16_f32 v23, v66, v67
    v_mfma_f32_16x16x32_bf16 v[48:51], a[236:239], v[16:19], v[44:47]
    v_cvt_pk_bf16_f32 v28, v72, v73
    v_mfma_f32_16x16x32_bf16 v[48:51], a[240:243], v[22:25], v[48:51]
    s_lshr_b32 s89, s89, 1
    v_mfma_f32_16x16x32_bf16 v[48:51], a[244:247], v[28:31], v[48:51]
    v_mfma_f32_16x16x32_bf16 v[48:51], a[248:251], v[34:37], v[48:51]
    s_waitcnt lgkmcnt(4)
    v_swap_b32 v38, v39
    v_mfma_f32_16x16x32_bf16 v[56:59], a[212:215], a[96:99], 0
    s_lshr_b32 s27, s27, 1
    v_add_u32 v103, 3072, v103
    s_waitcnt lgkmcnt(3)
    v_mfma_f32_16x16x32_bf16 v[56:59], a[216:219], a[100:103], v[56:59]
    s_nop 0
    v_cmp_lt_f32 vcc, s29, v48
    s_add_u32 s24, s24, s26
    v_mfma_f32_16x16x32_bf16 v[56:59], a[220:223], a[104:107], v[56:59]
    s_add_u32 s25, s25, s26
    s_add_u32 s23, s23, 3072
    v_mfma_f32_16x16x32_bf16 v[64:67], a[220:223], a[128:131], 0
    s_cbranch_vccnz L_rs_loop4w0b
L_ret_loop4w0b:
    v_fma_f32 v60, v60, s28, v10
    v_mfma_f32_16x16x32_bf16 v[64:67], a[216:219], a[124:127], v[64:67]
    v_fma_f32 v54, v54, s28, v9
    v_fma_f32 v52, v52, s28, v9
    v_mfma_f32_16x16x32_bf16 v[64:67], a[212:215], a[120:123], v[64:67]
    s_waitcnt vmcnt(12) lgkmcnt(0)
    s_cmp_eq_u32 s30, 5
    v_fma_f32 v53, v53, s28, v9
    v_mfma_f32_16x16x32_bf16 v[72:75], a[212:215], a[144:147], 0
    s_barrier
    v_mfma_f32_16x16x32_bf16 v[72:75], a[216:219], a[148:151], v[72:75]
    s_cselect_b32 s26, s62, 0
    s_add_u32 s20, s20, s26
    s_add_u32 m0, s22, 0
    v_mfma_f32_16x16x32_bf16 v[72:75], a[220:223], a[152:155], v[72:75]
    buffer_load_dwordx4 v6, s[4:7], s20 offen lds
    v_mfma_f32_16x16x32_bf16 v[80:83], a[220:223], a[176:179], 0
    s_add_u32 s20, s20, 128
    v_exp_f32 v53, v53
    v_mfma_f32_16x16x32_bf16 v[80:83], a[216:219], a[172:175], v[80:83]
    v_exp_f32 v52, v52
    v_mfma_f32_16x16x32_bf16 v[80:83], a[212:215], a[168:171], v[80:83]
    s_add_u32 m0, s22, 1024
    ds_read_b64_tr_b16 a[212:213], v2 offset:18432
    v_fma_f32 v61, v61, s28, v10
    v_mfma_f32_16x16x32_bf16 v[80:83], a[224:227], a[180:183], v[80:83]
    buffer_load_dwordx4 v6, s[4:7], s20 offen lds
    v_mfma_f32_16x16x32_bf16 v[80:83], a[228:231], a[184:187], v[80:83]
    s_add_u32 s20, s20, 128
    ds_read_b64_tr_b16 a[214:215], v2 offset:12288
    v_fma_f32 v55, v55, s28, v9
    v_mfma_f32_16x16x32_bf16 v[80:83], a[232:235], a[188:191], v[80:83]
    s_add_u32 m0, s22, 2048
    v_exp_f32 v55, v55
    v_mfma_f32_16x16x32_bf16 v[72:75], a[232:235], a[164:167], v[72:75]
    buffer_load_dwordx4 v6, s[4:7], s20 offen lds
    v_mfma_f32_16x16x32_bf16 v[72:75], a[228:231], a[160:163], v[72:75]
    v_exp_f32 v54, v54
    v_mfma_f32_16x16x32_bf16 v[72:75], a[224:227], a[156:159], v[72:75]
    v_exp_f32 v60, v60
    v_mfma_f32_16x16x32_bf16 v[64:67], a[224:227], a[132:135], v[64:67]
    ds_read_b64_tr_b16 a[216:217], v3 offset:18432
    v_mfma_f32_16x16x32_bf16 v[64:67], a[228:231], a[136:139], v[64:67]
    s_add_u32 s20, s20, 12032
    ds_read_b64_tr_b16 a[218:219], v3 offset:12288
    v_cvt_pk_bf16_f32 v14, v52, v53
    v_mfma_f32_16x16x32_bf16 v[64:67], a[232:235], a[140:143], v[64:67]
    ds_read_b64_tr_b16 a[220:221], v4 offset:18432
    v_cvt_pk_bf16_f32 v15, v54, v55
    v_mfma_f32_16x16x32_bf16 v[56:59], a[232:235], a[116:119], v[56:59]
    s_add_u32 s30, s30, 1
    v_exp_f32 v61, v61
    v_mfma_f32_16x16x32_bf16 v[56:59], a[228:231], a[112:115], v[56:59]
    s_cmp_lt_u32 s30, 6
    ds_read_b64_tr_b16 a[222:223], v4 offset:12288
    v_cvt_pk_bf16_f32 v20, v60, v61
    v_mfma_f32_16x16x32_bf16 v[56:59], a[224:227], a[108:111], v[56:59]
    s_waitcnt lgkmcnt(4)
    ds_read_b64_tr_b16 a[224:225], v5 offset:18432
    ds_read_b64_tr_b16 a[226:227], v5 offset:12288
    s_cbranch_scc1 L_loop4w0
    s_cmp_ge_u32 s37, 6
    s_cbranch_scc1 L_end4
    s_cmp_eq_u32 s32, 0
    s_cbranch_scc1 L_tr44
    s_branch L_tr45
L_tr45:
    v_mfma_f32_16x16x32_bf16 v[112:115], a[212:215], v[16:19], v[112:115]
    v_fma_f32 v58, v58, s28, v9
    v_mbcnt_lo_u32_b32 v107, -1, 0
    v_mfma_f32_16x16x32_bf16 v[160:163], a[212:215], v[22:25], v[160:163]
    v_mbcnt_hi_u32_b32 v107, -1, v107
    v_fma_f32 v64, v64, s28, v10
    v_mfma_f32_16x16x32_bf16 v[208:211], a[212:215], v[28:31], v[208:211]
    v_fma_f32 v67, v67, s28, v10
    v_fma_f32 v82, v82, s28, v12
    v_mfma_f32_16x16x32_bf16 a[0:3], a[212:215], v[34:37], a[0:3]
    ds_read_b64_tr_b16 a[234:235], v3 offset:13312
    v_fma_f32 v70, v70, s28, v11
    s_waitcnt lgkmcnt(5)
    v_mfma_f32_16x16x32_bf16 a[4:7], a[216:219], v[34:37], a[4:7]
    ds_read_b64_tr_b16 a[230:231], v2 offset:13312
    v_and_b32 v106, 15, v107
    v_mfma_f32_16x16x32_bf16 v[212:215], a[216:219], v[28:31], v[212:215]
    ds_read_b64_tr_b16 a[228:229], v2 offset:19456
    v_mul_u32_u24 v106, 384, v106
    v_mfma_f32_16x16x32_bf16 v[164:167], a[216:219], v[22:25], v[164:167]
    s_add_u32 s39, s39, 12288
    v_fma_f32 v65, v65, s28, v10
    v_lshrrev_b32 v107, 4, v107
    v_mfma_f32_16x16x32_bf16 v[116:119], a[216:219], v[16:19], v[116:119]
    ds_read_b64_tr_b16 a[214:215], v4 offset:13312
    s_waitcnt lgkmcnt(6)
    v_mfma_f32_16x16x32_bf16 v[120:123], a[220:223], v[16:19], v[120:123]
    ds_read_b64_tr_b16 a[232:233], v3 offset:19456
    v_lshl_add_u32 v106, v107, 4, v106
    v_mfma_f32_16x16x32_bf16 v[168:171], a[220:223], v[22:25], v[168:171]
    s_add_u32 s48, s33, 24576
    ds_read_b64_tr_b16 a[212:213], v4 offset:19456
    v_fma_f32 v56, v56, s28, v9
    v_mfma_f32_16x16x32_bf16 v[216:219], a[220:223], v[28:31], v[216:219]
    buffer_load_dwordx4 a[208:211], v106, s[12:15], s48 offen offset:256 nt
    v_mfma_f32_16x16x32_bf16 a[8:11], a[220:223], v[34:37], a[8:11]
    s_waitcnt lgkmcnt(6)
    ds_read_b64_tr_b16 a[216:217], v5 offset:19456
    v_fma_f32 v68, v68, s28, v11
    v_mfma_f32_16x16x32_bf16 a[12:15], a[224:227], v[34:37], a[12:15]
    buffer_load_dwordx4 v[92:95], v106, s[12:15], s48 offen offset:320 nt
    v_fma_f32 v77, v77, s28, v12
    v_mfma_f32_16x16x32_bf16 v[220:223], a[224:227], v[28:31], v[220:223]
    v_exp_f32 v64, v64
    v_mfma_f32_16x16x32_bf16 v[172:175], a[224:227], v[22:25], v[172:175]
    ds_read_b64_tr_b16 a[222:223], v2 offset:14336
    v_fma_f32 v69, v69, s28, v11
    v_mfma_f32_16x16x32_bf16 v[124:127], a[224:227], v[16:19], v[124:127]
    s_waitcnt lgkmcnt(5)
    ds_read_b64_tr_b16 a[218:219], v5 offset:13312
    v_fma_f32 v79, v79, s28, v12
    v_mfma_f32_16x16x32_bf16 v[128:131], a[228:231], v[16:19], v[128:131]
    ds_read_b64_tr_b16 a[224:225], v3 offset:20480
    v_fma_f32 v76, v76, s28, v12
    v_mfma_f32_16x16x32_bf16 v[176:179], a[228:231], v[22:25], v[176:179]
    v_exp_f32 v56, v56
    v_mfma_f32_16x16x32_bf16 v[224:227], a[228:231], v[28:31], v[224:227]
    ds_read_b128 v[88:91], v103 offset:0
    v_fma_f32 v63, v63, s28, v10
    v_mfma_f32_16x16x32_bf16 a[16:19], a[228:231], v[34:37], a[16:19]
    s_waitcnt lgkmcnt(5)
    ds_read_b64_tr_b16 a[226:227], v3 offset:14336
    v_fma_f32 v71, v71, s28, v11
    v_mfma_f32_16x16x32_bf16 a[20:23], a[232:235], v[34:37], a[20:23]
    ds_read_b64_tr_b16 a[220:221], v2 offset:20480
    v_fma_f32 v66, v66, s28, v10
    v_mfma_f32_16x16x32_bf16 v[228:231], a[232:235], v[28:31], v[228:231]
    ds_read_b64_tr_b16 a[230:231], v4 offset:14336
    v_fma_f32 v78, v78, s28, v12
    v_mfma_f32_16x16x32_bf16 v[180:183], a[232:235], v[22:25], v[180:183]
    ds_read_b64_tr_b16 a[228:229], v4 offset:20480
    v_fma_f32 v62, v62, s28, v10
    v_mfma_f32_16x16x32_bf16 v[132:135], a[232:235], v[16:19], v[132:135]
    ds_read_b64_tr_b16 a[232:233], v5 offset:20480
    v_fma_f32 v74, v74, s28, v11
    v_mfma_f32_16x16x32_bf16 v[136:139], a[212:215], v[16:19], v[136:139]
    ds_read_b64_tr_b16 a[234:235], v5 offset:14336
    v_fma_f32 v75, v75, s28, v11
    v_mfma_f32_16x16x32_bf16 v[184:187], a[212:215], v[22:25], v[184:187]
    v_exp_f32 v76, v76
    v_mfma_f32_16x16x32_bf16 v[232:235], a[212:215], v[28:31], v[232:235]
    v_exp_f32 v77, v77
    v_mfma_f32_16x16x32_bf16 a[24:27], a[212:215], v[34:37], a[24:27]
    s_waitcnt lgkmcnt(7)
    v_exp_f32 v63, v63
    v_mfma_f32_16x16x32_bf16 a[28:31], a[216:219], v[34:37], a[28:31]
    ds_read_b128 v[96:99], v103 offset:1024
    v_fma_f32 v59, v59, s28, v9
    v_mfma_f32_16x16x32_bf16 v[236:239], a[216:219], v[28:31], v[236:239]
    v_exp_f32 v75, v75
    v_mfma_f32_16x16x32_bf16 v[188:191], a[216:219], v[22:25], v[188:191]
    v_exp_f32 v68, v68
    v_mfma_f32_16x16x32_bf16 v[140:143], a[216:219], v[16:19], v[140:143]
    s_waitcnt lgkmcnt(4)
    v_exp_f32 v62, v62
    v_mfma_f32_16x16x32_bf16 v[144:147], a[220:223], v[16:19], v[144:147]
    v_exp_f32 v65, v65
    v_mfma_f32_16x16x32_bf16 v[192:195], a[220:223], v[22:25], v[192:195]
    v_exp_f32 v74, v74
    v_mfma_f32_16x16x32_bf16 v[240:243], a[220:223], v[28:31], v[240:243]
    s_waitcnt vmcnt(12) lgkmcnt(1)
    v_fma_f32 v80, v80, s28, v12
    s_add_u32 m0, s22, 36864
    v_mfma_f32_16x16x32_bf16 a[32:35], a[220:223], v[34:37], a[32:35]
    s_barrier
    v_mfma_f32_16x16x32_bf16 a[36:39], a[224:227], v[34:37], a[36:39]
    buffer_load_dwordx4 v6, s[8:11], s21 offen lds
    v_mfma_f32_16x16x32_bf16 v[244:247], a[224:227], v[28:31], v[244:247]
    s_add_u32 s21, s21, 128
    ds_read_b128 a[212:215], v0 offset:12288
    v_cvt_pk_bf16_f32 v21, v62, v63
    v_mfma_f32_16x16x32_bf16 v[196:199], a[224:227], v[22:25], v[196:199]
    ds_read_b128 a[216:219], v1 offset:12288
    v_fma_f32 v81, v81, s28, v12
    v_mfma_f32_16x16x32_bf16 v[148:151], a[224:227], v[16:19], v[148:151]
    s_add_u32 m0, s22, 37888
    v_exp_f32 v69, v69
    v_mfma_f32_16x16x32_bf16 v[152:155], a[228:231], v[16:19], v[152:155]
    buffer_load_dwordx4 v6, s[8:11], s21 offen lds
    v_mfma_f32_16x16x32_bf16 v[200:203], a[228:231], v[22:25], v[200:203]
    s_add_u32 s21, s21, 128
    ds_read_b128 a[220:223], v0 offset:13312
    v_cvt_pk_bf16_f32 v26, v68, v69
    v_mfma_f32_16x16x32_bf16 v[248:251], a[228:231], v[28:31], v[248:251]
    v_exp_f32 v71, v71
    v_mfma_f32_16x16x32_bf16 a[40:43], a[228:231], v[34:37], a[40:43]
    v_exp_f32 v67, v67
    v_mfma_f32_16x16x32_bf16 a[44:47], a[232:235], v[34:37], a[44:47]
    s_add_u32 m0, s22, 38912
    v_exp_f32 v70, v70
    v_mfma_f32_16x16x32_bf16 v[252:255], a[232:235], v[28:31], v[252:255]
    buffer_load_dwordx4 v6, s[8:11], s21 offen lds
    v_mfma_f32_16x16x32_bf16 v[204:207], a[232:235], v[22:25], v[204:207]
    buffer_store_dwordx4 v[88:91], v6, s[16:19], s24 offen offset:0 nt
    ds_read_b128 a[224:227], v1 offset:13312
    v_exp_f32 v66, v66
    v_mfma_f32_16x16x32_bf16 v[156:159], a[232:235], v[16:19], v[156:159]
    s_waitcnt lgkmcnt(2)
    ds_read_b128 a[228:231], v0 offset:14336
    v_fma_f32 v57, v57, s28, v9
    v_mfma_f32_16x16x32_bf16 v[52:55], a[212:215], a[96:99], 0
    buffer_store_dwordx4 v[96:99], v7, s[16:19], s24 offen offset:0 nt
    s_add_u32 s21, s21, 12032
    ds_read_b128 a[232:235], v1 offset:14336
    v_exp_f32 v57, v57
    v_mfma_f32_16x16x32_bf16 v[52:55], a[216:219], a[100:103], v[52:55]
    s_waitcnt lgkmcnt(3)
    v_exp_f32 v78, v78
    v_mfma_f32_16x16x32_bf16 v[52:55], a[220:223], a[104:107], v[52:55]
    v_cvt_pk_bf16_f32 v23, v66, v67
    v_cvt_pk_bf16_f32 v27, v70, v71
    v_mfma_f32_16x16x32_bf16 v[60:63], a[220:223], a[128:131], 0
    v_exp_f32 v79, v79
    v_mfma_f32_16x16x32_bf16 v[60:63], a[216:219], a[124:127], v[60:63]
    ds_read_b128 v[84:87], v103 offset:2048
    v_fma_f32 v83, v83, s28, v12
    v_mfma_f32_16x16x32_bf16 v[60:63], a[212:215], a[120:123], v[60:63]
    v_cvt_pk_bf16_f32 v33, v78, v79
    s_add_u32 m0, s38, 24576
    v_mfma_f32_16x16x32_bf16 v[68:71], a[212:215], a[144:147], 0
    v_cvt_pk_bf16_f32 v22, v64, v65
    v_cvt_pk_bf16_f32 v16, v56, v57
    v_mfma_f32_16x16x32_bf16 v[68:71], a[216:219], a[148:151], v[68:71]
    v_cvt_pk_bf16_f32 v32, v76, v77
    v_fma_f32 v72, v72, s28, v11
    v_mfma_f32_16x16x32_bf16 v[68:71], a[220:223], a[152:155], v[68:71]
    v_exp_f32 v59, v59
    v_mfma_f32_16x16x32_bf16 v[76:79], a[220:223], a[176:179], 0
    v_exp_f32 v82, v82
    v_mfma_f32_16x16x32_bf16 v[76:79], a[216:219], a[172:175], v[76:79]
    v_exp_f32 v58, v58
    v_mfma_f32_16x16x32_bf16 v[76:79], a[212:215], a[168:171], v[76:79]
    s_waitcnt lgkmcnt(1)
    v_exp_f32 v83, v83
    v_mfma_f32_16x16x32_bf16 v[76:79], a[224:227], a[180:183], v[76:79]
    v_exp_f32 v81, v81
    v_mfma_f32_16x16x32_bf16 v[76:79], a[228:231], a[184:187], v[76:79]
    ds_read_b128 a[216:219], v1 offset:18432
    v_fma_f32 v73, v73, s28, v11
    v_mfma_f32_16x16x32_bf16 v[76:79], a[232:235], a[188:191], v[76:79]
    buffer_load_dwordx4 v6, s[12:15], s25 offen nt lds
    v_mfma_f32_16x16x32_bf16 v[68:71], a[232:235], a[164:167], v[68:71]
    s_add_u32 m0, s38, 25600
    ds_read_b128 v[88:91], v103 offset:3072
    v_mfma_f32_16x16x32_bf16 v[68:71], a[228:231], a[160:163], v[68:71]
    v_exp_f32 v80, v80
    v_mfma_f32_16x16x32_bf16 v[68:71], a[224:227], a[156:159], v[68:71]
    ds_read_b128 a[212:215], v0 offset:18432
    v_cvt_pk_bf16_f32 v34, v80, v81
    v_mfma_f32_16x16x32_bf16 v[60:63], a[224:227], a[132:135], v[60:63]
    ds_read_b128 a[220:223], v0 offset:19456
    v_cvt_pk_bf16_f32 v29, v74, v75
    v_mfma_f32_16x16x32_bf16 v[60:63], a[228:231], a[136:139], v[60:63]
    v_exp_f32 v72, v72
    v_mfma_f32_16x16x32_bf16 v[60:63], a[232:235], a[140:143], v[60:63]
    buffer_load_dwordx4 v7, s[12:15], s25 offen nt lds
    v_mfma_f32_16x16x32_bf16 v[52:55], a[232:235], a[116:119], v[52:55]
    v_exp_f32 v73, v73
    v_mfma_f32_16x16x32_bf16 v[52:55], a[228:231], a[112:115], v[52:55]
    ds_read_b128 a[232:235], v1 offset:20480
    v_cvt_pk_bf16_f32 v17, v58, v59
    v_mfma_f32_16x16x32_bf16 v[52:55], a[224:227], a[108:111], v[52:55]
    s_add_u32 s57, s24, 128
    ds_read_b128 a[228:231], v0 offset:20480
    s_add_u32 s59, s25, 128
    v_mfma_f32_16x16x32_bf16 v[44:47], a[236:239], v[14:17], v[48:51]
    s_add_u32 m0, s38, 26624
    ds_read_b128 a[224:227], v1 offset:19456
    v_cvt_pk_bf16_f32 v28, v72, v73
    v_mfma_f32_16x16x32_bf16 v[44:47], a[240:243], v[20:23], v[44:47]
    v_cvt_pk_bf16_f32 v35, v82, v83
    v_mfma_f32_16x16x32_bf16 v[44:47], a[244:247], v[26:29], v[44:47]
    s_nop 0
    v_mfma_f32_16x16x32_bf16 v[44:47], a[248:251], v[32:35], v[44:47]
    s_waitcnt lgkmcnt(4)
    v_mfma_f32_16x16x32_bf16 v[56:59], a[212:215], a[96:99], 0
    buffer_load_dwordx4 v6, s[12:15], s59 offen nt lds
    v_mfma_f32_16x16x32_bf16 v[56:59], a[216:219], a[100:103], v[56:59]
    s_waitcnt lgkmcnt(3)
    v_mfma_f32_16x16x32_bf16 v[56:59], a[220:223], a[104:107], v[56:59]
    v_mfma_f32_16x16x32_bf16 v[64:67], a[220:223], a[128:131], 0
    s_nop 0
    v_cmp_lt_f32 vcc, s29, v44
    s_add_u32 m0, s38, 27648
    v_mfma_f32_16x16x32_bf16 v[64:67], a[216:219], a[124:127], v[64:67]
    buffer_load_dwordx4 v7, s[12:15], s59 offen nt lds
    v_mfma_f32_16x16x32_bf16 v[64:67], a[212:215], a[120:123], v[64:67]
    buffer_store_dwordx4 v[84:87], v6, s[16:19], s57 offen offset:0 nt
    s_waitcnt vmcnt(15) lgkmcnt(0)
    s_cbranch_vccnz L_rs_tr45a
L_ret_tr45a:
    v_fma_f32 v61, v61, s28, v10
    s_add_u32 m0, s22, 12288
    v_mfma_f32_16x16x32_bf16 v[72:75], a[212:215], a[144:147], 0
    s_barrier
    v_mfma_f32_16x16x32_bf16 v[72:75], a[216:219], a[148:151], v[72:75]
    buffer_load_dwordx4 v6, s[4:7], s20 offen lds
    v_mfma_f32_16x16x32_bf16 v[72:75], a[220:223], a[152:155], v[72:75]
    s_add_u32 s20, s20, 128
    v_fma_f32 v52, v52, s28, v9
    v_fma_f32 v53, v53, s28, v9
    v_mfma_f32_16x16x32_bf16 v[80:83], a[220:223], a[176:179], 0
    s_add_u32 m0, s22, 13312
    v_exp_f32 v52, v52
    v_mfma_f32_16x16x32_bf16 v[80:83], a[216:219], a[172:175], v[80:83]
    buffer_load_dwordx4 v6, s[4:7], s20 offen lds
    v_mfma_f32_16x16x32_bf16 v[80:83], a[212:215], a[168:171], v[80:83]
    s_add_u32 s20, s20, 128
    v_exp_f32 v61, v61
    v_mfma_f32_16x16x32_bf16 v[80:83], a[224:227], a[180:183], v[80:83]
    s_add_u32 m0, s22, 14336
    ds_read_b64_tr_b16 a[212:213], v2 offset:0
    v_fma_f32 v54, v54, s28, v9
    v_mfma_f32_16x16x32_bf16 v[80:83], a[228:231], a[184:187], v[80:83]
    buffer_load_dwordx4 v6, s[4:7], s20 offen lds
    v_mfma_f32_16x16x32_bf16 v[80:83], a[232:235], a[188:191], v[80:83]
    ds_read_b64_tr_b16 a[214:215], v2 offset:6144
    v_mfma_f32_16x16x32_bf16 v[72:75], a[232:235], a[164:167], v[72:75]
    ds_read_b64_tr_b16 a[216:217], v3 offset:0
    v_fma_f32 v55, v55, s28, v9
    v_mfma_f32_16x16x32_bf16 v[72:75], a[228:231], a[160:163], v[72:75]
    ds_read_b64_tr_b16 a[218:219], v3 offset:6144
    v_fma_f32 v60, v60, s28, v10
    v_mfma_f32_16x16x32_bf16 v[72:75], a[224:227], a[156:159], v[72:75]
    v_exp_f32 v60, v60
    v_mfma_f32_16x16x32_bf16 v[64:67], a[224:227], a[132:135], v[64:67]
    v_exp_f32 v55, v55
    v_mfma_f32_16x16x32_bf16 v[64:67], a[228:231], a[136:139], v[64:67]
    ds_read_b64_tr_b16 a[220:221], v4 offset:0
    v_cvt_pk_bf16_f32 v24, v60, v61
    v_mfma_f32_16x16x32_bf16 v[64:67], a[232:235], a[140:143], v[64:67]
    v_exp_f32 v54, v54
    v_mfma_f32_16x16x32_bf16 v[56:59], a[232:235], a[116:119], v[56:59]
    v_exp_f32 v53, v53
    v_mfma_f32_16x16x32_bf16 v[56:59], a[228:231], a[112:115], v[56:59]
    ds_read_b64_tr_b16 a[222:223], v4 offset:6144
    v_cvt_pk_bf16_f32 v19, v54, v55
    v_mfma_f32_16x16x32_bf16 v[56:59], a[224:227], a[108:111], v[56:59]
    buffer_store_dwordx4 v[88:91], v7, s[16:19], s57 offen offset:0 nt
    s_waitcnt lgkmcnt(4)
    s_add_u32 s20, s20, 12032
    ds_read_b64_tr_b16 a[224:225], v5 offset:0
    ds_read_b64_tr_b16 a[226:227], v5 offset:6144
    v_cvt_pk_bf16_f32 v18, v52, v53
    v_fma_f32 v81, v81, s28, v12
    v_mfma_f32_16x16x32_bf16 v[112:115], a[212:215], v[14:17], v[112:115]
    ds_read_b64_tr_b16 a[230:231], v2 offset:7168
    v_fma_f32 v65, v65, s28, v10
    v_mfma_f32_16x16x32_bf16 v[160:163], a[212:215], v[20:23], v[160:163]
    ds_read_b64_tr_b16 a[228:229], v2 offset:1024
    v_fma_f32 v57, v57, s28, v9
    v_mfma_f32_16x16x32_bf16 v[208:211], a[212:215], v[26:29], v[208:211]
    v_fma_f32 v77, v77, s28, v12
    v_fma_f32 v59, v59, s28, v9
    v_fma_f32 v72, v72, s28, v11
    v_fma_f32 v71, v71, s28, v11
    v_mfma_f32_16x16x32_bf16 a[0:3], a[212:215], v[32:35], a[0:3]
    s_waitcnt lgkmcnt(6)
    ds_read_b64_tr_b16 a[234:235], v3 offset:7168
    v_fma_f32 v82, v82, s28, v12
    v_mfma_f32_16x16x32_bf16 a[4:7], a[216:219], v[32:35], a[4:7]
    v_exp_f32 v59, v59
    v_mfma_f32_16x16x32_bf16 v[212:215], a[216:219], v[26:29], v[212:215]
    v_exp_f32 v77, v77
    v_mfma_f32_16x16x32_bf16 v[164:167], a[216:219], v[20:23], v[164:167]
    v_fma_f32 v78, v78, s28, v12
    v_fma_f32 v63, v63, s28, v10
    v_mfma_f32_16x16x32_bf16 v[116:119], a[216:219], v[14:17], v[116:119]
    s_waitcnt lgkmcnt(5)
    ds_read_b64_tr_b16 a[212:213], v4 offset:1024
    v_and_b32 v104, 0x3ff, v0
    v_mfma_f32_16x16x32_bf16 v[120:123], a[220:223], v[14:17], v[120:123]
    ds_read_b64_tr_b16 a[232:233], v3 offset:1024
    v_lshrrev_b32 v105, 11, v0
    v_mfma_f32_16x16x32_bf16 v[168:171], a[220:223], v[20:23], v[168:171]
    v_exp_f32 v71, v71
    v_mfma_f32_16x16x32_bf16 v[216:219], a[220:223], v[26:29], v[216:219]
    ds_read_b64_tr_b16 a[216:217], v5 offset:1024
    v_fma_f32 v76, v76, s28, v12
    v_mfma_f32_16x16x32_bf16 a[8:11], a[220:223], v[32:35], a[8:11]
    s_waitcnt lgkmcnt(4)
    ds_read_b64_tr_b16 a[214:215], v4 offset:7168
    v_fma_f32 v73, v73, s28, v11
    v_mfma_f32_16x16x32_bf16 a[12:15], a[224:227], v[32:35], a[12:15]
    v_exp_f32 v78, v78
    v_mfma_f32_16x16x32_bf16 v[220:223], a[224:227], v[26:29], v[220:223]
    v_exp_f32 v65, v65
    v_mfma_f32_16x16x32_bf16 v[172:175], a[224:227], v[20:23], v[172:175]
    ds_read_b64_tr_b16 a[218:219], v5 offset:7168
    v_xor_b32 v105, s65, v105
    v_mfma_f32_16x16x32_bf16 v[124:127], a[224:227], v[14:17], v[124:127]
    ds_read_b64_tr_b16 a[226:227], v3 offset:8192
    v_fma_f32 v56, v56, s28, v9
    v_mfma_f32_16x16x32_bf16 v[128:131], a[228:231], v[14:17], v[128:131]
    ds_read_b64_tr_b16 a[220:221], v2 offset:2048
    v_fma_f32 v69, v69, s28, v11
    v_mfma_f32_16x16x32_bf16 v[176:179], a[228:231], v[20:23], v[176:179]
    ds_read_b64_tr_b16 a[222:223], v2 offset:8192
    v_mfma_f32_16x16x32_bf16 v[224:227], a[228:231], v[26:29], v[224:227]
    v_exp_f32 v63, v63
    v_mfma_f32_16x16x32_bf16 a[16:19], a[228:231], v[32:35], a[16:19]
    s_waitcnt lgkmcnt(6)
    ds_read_b64_tr_b16 a[230:231], v4 offset:8192
    v_lshl_add_u32 v104, v105, 10, v104
    v_mfma_f32_16x16x32_bf16 a[20:23], a[232:235], v[32:35], a[20:23]
    v_fma_f32 v83, v83, s28, v12
    v_fma_f32 v64, v64, s28, v10
    v_mfma_f32_16x16x32_bf16 v[228:231], a[232:235], v[26:29], v[228:231]
    ds_read_b64_tr_b16 a[228:229], v4 offset:2048
    v_fma_f32 v79, v79, s28, v12
    v_mfma_f32_16x16x32_bf16 v[180:183], a[232:235], v[20:23], v[180:183]
    ds_read_b64_tr_b16 a[224:225], v3 offset:2048
    v_add_u32 v104, s38, v104
    v_mfma_f32_16x16x32_bf16 v[132:135], a[232:235], v[14:17], v[132:135]
    s_waitcnt lgkmcnt(7)
    ds_read_b64_tr_b16 a[234:235], v5 offset:8192
    v_fma_f32 v67, v67, s28, v10
    v_mfma_f32_16x16x32_bf16 v[136:139], a[212:215], v[14:17], v[136:139]
    ds_read_b64_tr_b16 a[232:233], v5 offset:2048
    v_xor_b32 v105, 64, v104
    v_mfma_f32_16x16x32_bf16 v[184:187], a[212:215], v[20:23], v[184:187]
    s_add_u32 s39, s39, 12288
    v_exp_f32 v79, v79
    v_mfma_f32_16x16x32_bf16 v[232:235], a[212:215], v[26:29], v[232:235]
    ds_read_b128 a[168:171], v104 offset:18432
    v_fma_f32 v62, v62, s28, v10
    v_mfma_f32_16x16x32_bf16 a[24:27], a[212:215], v[32:35], a[24:27]
    s_waitcnt lgkmcnt(6)
    ds_read_b128 a[100:103], v105 offset:0
    v_fma_f32 v80, v80, s28, v12
    v_mfma_f32_16x16x32_bf16 a[28:31], a[216:219], v[32:35], a[28:31]
    ds_read_b128 a[172:175], v105 offset:18432
    v_exp_f32 v57, v57
    v_mfma_f32_16x16x32_bf16 v[236:239], a[216:219], v[26:29], v[236:239]
    v_exp_f32 v62, v62
    v_mfma_f32_16x16x32_bf16 v[188:191], a[216:219], v[20:23], v[188:191]
    ds_read_b128 a[128:131], v104 offset:8192
    v_fma_f32 v68, v68, s28, v11
    v_mfma_f32_16x16x32_bf16 v[140:143], a[216:219], v[14:17], v[140:143]
    ds_read_b128 a[132:135], v105 offset:8192
    v_cvt_pk_bf16_f32 v37, v78, v79
    v_mfma_f32_16x16x32_bf16 v[144:147], a[220:223], v[14:17], v[144:147]
    ds_read_b128 a[152:155], v104 offset:14336
    v_fma_f32 v70, v70, s28, v11
    v_exp_f32 v70, v70
    v_mfma_f32_16x16x32_bf16 v[192:195], a[220:223], v[20:23], v[192:195]
    s_waitcnt vmcnt(16) lgkmcnt(6)
    ds_read_b128 a[148:151], v105 offset:12288
    v_cvt_pk_bf16_f32 v25, v62, v63
    v_mfma_f32_16x16x32_bf16 v[240:243], a[220:223], v[26:29], v[240:243]
    s_add_u32 s21, s21, s62
    v_exp_f32 v68, v68
    v_mfma_f32_16x16x32_bf16 a[32:35], a[220:223], v[32:35], a[32:35]
    s_barrier
    ds_read_b128 a[212:215], v0 offset:0
    v_mfma_f32_16x16x32_bf16 a[36:39], a[224:227], v[32:35], a[36:39]
    s_add_u32 m0, s22, 24576
    ds_read_b128 a[120:123], v104 offset:6144
    buffer_load_dwordx4 v6, s[8:11], s21 offen lds
    v_mfma_f32_16x16x32_bf16 v[244:247], a[224:227], v[26:29], v[244:247]
    s_add_u32 s21, s21, 128
    ds_read_b128 a[96:99], v104 offset:0
    v_fma_f32 v74, v74, s28, v11
    v_mfma_f32_16x16x32_bf16 v[196:199], a[224:227], v[20:23], v[196:199]
    s_add_u32 m0, s22, 25600
    ds_read_b128 a[144:147], v104 offset:12288
    buffer_load_dwordx4 v6, s[8:11], s21 offen lds
    v_mfma_f32_16x16x32_bf16 v[148:151], a[224:227], v[14:17], v[148:151]
    ds_read_b128 a[216:219], v1 offset:0
    s_add_u32 s21, s21, 128
    v_mfma_f32_16x16x32_bf16 v[152:155], a[228:231], v[14:17], v[152:155]
    s_add_u32 m0, s22, 26624
    ds_read_b128 a[176:179], v104 offset:20480
    buffer_load_dwordx4 v6, s[8:11], s21 offen lds
    v_mfma_f32_16x16x32_bf16 v[200:203], a[228:231], v[20:23], v[200:203]
    s_add_u32 s21, s21, 12032
    s_waitcnt vmcnt(10)
    ds_read_b128 a[192:195], v104 offset:24576
    v_mfma_f32_16x16x32_bf16 v[248:251], a[228:231], v[26:29], v[248:251]
    ds_read_b128 a[124:127], v105 offset:6144
    v_exp_f32 v76, v76
    v_mfma_f32_16x16x32_bf16 a[40:43], a[228:231], v[32:35], a[40:43]
    ds_read_b128 a[220:223], v0 offset:1024
    v_cvt_pk_bf16_f32 v36, v76, v77
    v_mfma_f32_16x16x32_bf16 a[44:47], a[232:235], v[32:35], a[44:47]
    s_waitcnt vmcnt(8)
    ds_read_b128 a[196:199], v105 offset:24576
    v_cvt_pk_bf16_f32 v31, v70, v71
    v_mfma_f32_16x16x32_bf16 v[252:255], a[232:235], v[26:29], v[252:255]
    ds_read_b128 a[160:163], v104 offset:16384
    v_exp_f32 v72, v72
    v_mfma_f32_16x16x32_bf16 v[204:207], a[232:235], v[20:23], v[204:207]
    ds_read_b128 a[204:207], v105 offset:26624
    v_exp_f32 v69, v69
    v_mfma_f32_16x16x32_bf16 v[156:159], a[232:235], v[14:17], v[156:159]
    s_waitcnt lgkmcnt(8)
    ds_read_b128 a[104:107], v104 offset:2048
    v_cvt_pk_bf16_f32 v30, v68, v69
    v_mfma_f32_16x16x32_bf16 v[52:55], a[212:215], a[96:99], 0
    ds_read_b128 a[180:183], v105 offset:20480
    v_fma_f32 v75, v75, s28, v11
    v_mfma_f32_16x16x32_bf16 v[60:63], a[212:215], a[120:123], 0
    ds_read_b128 a[108:111], v105 offset:2048
    v_fma_f32 v58, v58, s28, v9
    v_mfma_f32_16x16x32_bf16 v[68:71], a[212:215], a[144:147], 0
    ds_read_b128 a[200:203], v104 offset:26624
    v_mfma_f32_16x16x32_bf16 v[76:79], a[212:215], a[168:171], 0
    s_waitcnt lgkmcnt(8)
    ds_read_b128 a[224:227], v1 offset:1024
    v_mfma_f32_16x16x32_bf16 v[84:87], a[212:215], a[192:195], 0
    ds_read_b128 a[136:139], v104 offset:10240
    v_exp_f32 v58, v58
    v_mfma_f32_16x16x32_bf16 v[52:55], a[216:219], a[100:103], v[52:55]
    v_exp_f32 v73, v73
    v_mfma_f32_16x16x32_bf16 v[60:63], a[216:219], a[124:127], v[60:63]
    ds_read_b128 a[156:159], v105 offset:14336
    v_cvt_pk_bf16_f32 v17, v58, v59
    v_mfma_f32_16x16x32_bf16 v[68:71], a[216:219], a[148:151], v[68:71]
    v_exp_f32 v56, v56
    v_mfma_f32_16x16x32_bf16 v[76:79], a[216:219], a[172:175], v[76:79]
    s_waitcnt lgkmcnt(7)
    v_exp_f32 v64, v64
    v_mfma_f32_16x16x32_bf16 v[84:87], a[216:219], a[196:199], v[84:87]
    s_waitcnt lgkmcnt(6)
    ds_read_b128 a[228:231], v0 offset:6144
    v_cvt_pk_bf16_f32 v28, v72, v73
    v_mfma_f32_16x16x32_bf16 v[52:55], a[220:223], a[104:107], v[52:55]
    v_fma_f32 v66, v66, s28, v10
    v_cvt_pk_bf16_f32 v16, v56, v57
    v_mfma_f32_16x16x32_bf16 v[60:63], a[220:223], a[128:131], v[60:63]
    ds_read_b128 a[232:235], v1 offset:6144
    v_mfma_f32_16x16x32_bf16 v[68:71], a[220:223], a[152:155], v[68:71]
    v_exp_f32 v80, v80
    v_mfma_f32_16x16x32_bf16 v[76:79], a[220:223], a[176:179], v[76:79]
    v_exp_f32 v67, v67
    v_mfma_f32_16x16x32_bf16 v[48:51], a[236:239], v[16:19], v[44:47]
    s_waitcnt lgkmcnt(3)
    v_exp_f32 v75, v75
    v_mfma_f32_16x16x32_bf16 v[84:87], a[220:223], a[200:203], v[84:87]
    v_exp_f32 v82, v82
    v_mfma_f32_16x16x32_bf16 v[52:55], a[224:227], a[108:111], v[52:55]
    v_exp_f32 v81, v81
    v_mfma_f32_16x16x32_bf16 v[60:63], a[224:227], a[132:135], v[60:63]
    s_waitcnt lgkmcnt(2)
    v_exp_f32 v83, v83
    v_mfma_f32_16x16x32_bf16 v[68:71], a[224:227], a[156:159], v[68:71]
    ds_read_b128 a[220:223], v0 offset:2048
    v_cvt_pk_bf16_f32 v22, v64, v65
    v_mfma_f32_16x16x32_bf16 v[76:79], a[224:227], a[180:183], v[76:79]
    v_exp_f32 v66, v66
    v_mfma_f32_16x16x32_bf16 v[84:87], a[224:227], a[204:207], v[84:87]
    s_waitcnt lgkmcnt(2)
    v_exp_f32 v74, v74
    v_mfma_f32_16x16x32_bf16 v[56:59], a[228:231], a[96:99], 0
    v_cvt_pk_bf16_f32 v23, v66, v67
    v_cvt_pk_bf16_f32 v35, v82, v83
    v_mfma_f32_16x16x32_bf16 v[64:67], a[228:231], a[120:123], 0
    ds_read_b128 a[212:215], v0 offset:7168
    v_cvt_pk_bf16_f32 v29, v74, v75
    v_mfma_f32_16x16x32_bf16 v[48:51], a[240:243], v[22:25], v[48:51]
    ds_read_b128 a[116:119], v105 offset:4096
    v_mfma_f32_16x16x32_bf16 v[72:75], a[228:231], a[144:147], 0
    ds_read_b128 a[184:187], v104 offset:22528
    v_cvt_pk_bf16_f32 v34, v80, v81
    v_mfma_f32_16x16x32_bf16 v[80:83], a[228:231], a[168:171], 0
    v_mfma_f32_16x16x32_bf16 v[48:51], a[244:247], v[28:31], v[48:51]
    ds_read_b128 a[164:167], v105 offset:16384
    v_mfma_f32_16x16x32_bf16 v[48:51], a[248:251], v[34:37], v[48:51]
    ds_read_b128 a[216:219], v1 offset:7168
    v_mfma_f32_16x16x32_bf16 v[88:91], a[228:231], a[192:195], 0
    s_waitcnt lgkmcnt(5)
    ds_read_b128 a[112:115], v104 offset:4096
    v_mfma_f32_16x16x32_bf16 v[56:59], a[232:235], a[100:103], v[56:59]
    ds_read_b128 a[228:231], v0 offset:8192
    v_mfma_f32_16x16x32_bf16 v[64:67], a[232:235], a[124:127], v[64:67]
    ds_read_b128 a[224:227], v1 offset:2048
    v_mfma_f32_16x16x32_bf16 v[72:75], a[232:235], a[148:151], v[72:75]
    ds_read_b128 a[140:143], v105 offset:10240
    v_mfma_f32_16x16x32_bf16 v[80:83], a[232:235], a[172:175], v[80:83]
    ds_read_b128 a[188:191], v105 offset:22528
    v_mfma_f32_16x16x32_bf16 v[88:91], a[232:235], a[196:199], v[88:91]
    s_waitcnt lgkmcnt(8)
    ds_read_b128 a[232:235], v1 offset:8192
    v_cmp_lt_f32 vcc, s29, v48
    v_mfma_f32_16x16x32_bf16 v[56:59], a[212:215], a[104:107], v[56:59]
    v_mfma_f32_16x16x32_bf16 v[64:67], a[212:215], a[128:131], v[64:67]
    v_mfma_f32_16x16x32_bf16 v[72:75], a[212:215], a[152:155], v[72:75]
    s_waitcnt vmcnt(17)
    s_nop 0
    s_cbranch_vccnz L_rs_tr45b
L_ret_tr45b:
    v_mfma_f32_16x16x32_bf16 v[80:83], a[212:215], a[176:179], v[80:83]
    v_and_b32 v101, 0x3ff, v0
    v_lshrrev_b32 v108, 11, v0
    v_mfma_f32_16x16x32_bf16 v[88:91], a[212:215], a[200:203], v[88:91]
    s_waitcnt lgkmcnt(5)
    v_xor_b32 v108, s65, v108
    v_lshl_add_u32 v101, v108, 10, v101
    v_mfma_f32_16x16x32_bf16 v[56:59], a[216:219], a[108:111], v[56:59]
    v_mbcnt_lo_u32_b32 v108, -1, 0
    v_mfma_f32_16x16x32_bf16 v[64:67], a[216:219], a[132:135], v[64:67]
    v_rcp_f32 v102, v49
    v_mfma_f32_16x16x32_bf16 v[72:75], a[216:219], a[156:159], v[72:75]
    v_mbcnt_hi_u32_b32 v108, -1, v108
    v_mfma_f32_16x16x32_bf16 v[80:83], a[216:219], a[180:183], v[80:83]
    s_waitcnt vmcnt(14) lgkmcnt(0)
    v_mfma_f32_16x16x32_bf16 v[88:91], a[216:219], a[204:207], v[88:91]
    s_barrier
    v_mfma_f32_16x16x32_bf16 v[52:55], a[220:223], a[112:115], v[52:55]
    ds_read_b64_tr_b16 a[212:213], v2 offset:18432
    s_add_u32 m0, s22, 0
    v_mfma_f32_16x16x32_bf16 v[60:63], a[220:223], a[136:139], v[60:63]
    buffer_load_dwordx4 v6, s[4:7], s20 offen lds
    v_mfma_f32_16x16x32_bf16 v[68:71], a[220:223], a[160:163], v[68:71]
    s_add_u32 s20, s20, 128
    v_rcp_f32 v50, v50
    v_mfma_f32_16x16x32_bf16 v[76:79], a[220:223], a[184:187], v[76:79]
    v_lshrrev_b32 v108, 1, v108
    s_add_u32 m0, s22, 1024
    v_mfma_f32_16x16x32_bf16 v[84:87], a[220:223], a[208:211], v[84:87]
    buffer_load_dwordx4 v6, s[4:7], s20 offen lds
    v_mfma_f32_16x16x32_bf16 v[52:55], a[224:227], a[116:119], v[52:55]
    s_add_u32 s20, s20, 128
    s_add_u32 m0, s22, 2048
    v_and_b32 v108, 24, v108
    v_mfma_f32_16x16x32_bf16 v[60:63], a[224:227], a[140:143], v[60:63]
    buffer_load_dwordx4 v6, s[4:7], s20 offen lds
    v_mfma_f32_16x16x32_bf16 v[68:71], a[224:227], a[164:167], v[68:71]
    ds_read_b64_tr_b16 a[214:215], v2 offset:12288
    v_add_u32 v101, s38, v101
    v_mfma_f32_16x16x32_bf16 v[76:79], a[224:227], a[188:191], v[76:79]
    v_mov_b32 v100, v48
    v_bfe_u32 v108, s66, v108, 8
    v_mfma_f32_16x16x32_bf16 v[84:87], a[224:227], v[92:95], v[84:87]
    v_rcp_f32 v8, v51
    v_mfma_f32_16x16x32_bf16 v[56:59], a[228:231], a[112:115], v[56:59]
    s_add_u32 s20, s20, 12032
    ds_read_b64_tr_b16 a[216:217], v3 offset:18432
    v_mfma_f32_16x16x32_bf16 v[64:67], a[228:231], a[136:139], v[64:67]
    v_permlane32_swap_b32 v48, v100
    v_mfma_f32_16x16x32_bf16 v[72:75], a[228:231], a[160:163], v[72:75]
    v_mfma_f32_16x16x32_bf16 v[80:83], a[228:231], a[184:187], v[80:83]
    ds_read_b64_tr_b16 a[218:219], v3 offset:12288
    v_xor_b32 v101, v101, v108
    v_mfma_f32_16x16x32_bf16 v[88:91], a[228:231], a[208:211], v[88:91]
    ds_read_b64_tr_b16 a[220:221], v4 offset:18432
    v_mfma_f32_16x16x32_bf16 v[56:59], a[232:235], a[116:119], v[56:59]
    ds_read_b64_tr_b16 a[222:223], v4 offset:12288
    v_mfma_f32_16x16x32_bf16 v[64:67], a[232:235], a[140:143], v[64:67]
    ds_read_b64_tr_b16 a[224:225], v5 offset:18432
    v_mfma_f32_16x16x32_bf16 v[72:75], a[232:235], a[164:167], v[72:75]
    s_waitcnt lgkmcnt(5)
    v_mfma_f32_16x16x32_bf16 v[80:83], a[232:235], a[188:191], v[80:83]
    ds_read_b64_tr_b16 a[226:227], v5 offset:12288
    v_mfma_f32_16x16x32_bf16 v[88:91], a[232:235], v[92:95], v[88:91]
    v_rcp_f32 v48, v48
    v_max3_f32 v98, v60, v61, v62
    v_max3_f32 v96, v52, v53, v54
    v_max3_f32 v96, v96, v55, v56
    v_max3_f32 v98, v98, v63, v64
    v_max3_f32 v98, v98, v65, v66
    v_max3_f32 v96, v96, v57, v58
    v_max_f32 v96, v96, v59
    v_max_f32 v98, v98, v67
    v_mov_b32 v97, v96
    v_mfma_f32_16x16x32_bf16 v[112:115], a[212:215], v[16:19], v[112:115]
    s_nop 0
    v_permlane32_swap_b32 v97, v96
    v_max_f32 v96, v96, v97
    v_mov_b32 v99, v98
    v_mov_b32 v97, v96
    v_mfma_f32_16x16x32_bf16 v[160:163], a[212:215], v[22:25], v[160:163]
    s_mov_b32 s67, s34
    v_permlane32_swap_b32 v99, v98
    v_mfma_f32_16x16x32_bf16 v[208:211], a[212:215], v[28:31], v[208:211]
    s_add_u32 s18, s34, 24576
    ds_read_b64_tr_b16 a[230:231], v2 offset:13312
    v_permlane16_swap_b32 v97, v96
    v_max_f32 v98, v98, v99
    v_mov_b32 v99, v98
    v_max_f32 v96, v96, v97
    v_mul_f32_e64 v9, -s28, v96
    v_max3_f32 v96, v68, v69, v70
    v_mfma_f32_16x16x32_bf16 a[0:3], a[212:215], v[34:37], a[0:3]
    s_waitcnt lgkmcnt(5)
    ds_read_b64_tr_b16 a[234:235], v3 offset:13312
    v_max3_f32 v96, v96, v71, v72
    v_permlane16_swap_b32 v99, v98
    v_mfma_f32_16x16x32_bf16 a[4:7], a[216:219], v[34:37], a[4:7]
    s_mov_b32 s34, s33
    ds_read_b64_tr_b16 a[228:229], v2 offset:19456
    v_max3_f32 v96, v96, v73, v74
    v_mfma_f32_16x16x32_bf16 v[212:215], a[216:219], v[28:31], v[212:215]
    s_add_u32 s64, s64, s62
    v_max_f32 v98, v98, v99
    v_max_f32 v96, v96, v75
    v_mfma_f32_16x16x32_bf16 v[164:167], a[216:219], v[22:25], v[164:167]
    s_add_u32 s64, s64, 196608
    ds_read_b64_tr_b16 a[232:233], v3 offset:19456
    v_mul_f32_e64 v10, -s28, v98
    v_mfma_f32_16x16x32_bf16 v[116:119], a[216:219], v[16:19], v[116:119]
    s_waitcnt lgkmcnt(4)
    v_fma_f32 v63, v63, s28, v10
    v_fma_f32 v57, v57, s28, v9
    v_fma_f32 v53, v53, s28, v9
    v_mfma_f32_16x16x32_bf16 v[120:123], a[220:223], v[16:19], v[120:123]
    s_mov_b32 s39, s64
    v_mov_b32 v97, v96
    v_max3_f32 v98, v76, v77, v78
    v_mfma_f32_16x16x32_bf16 v[168:171], a[220:223], v[22:25], v[168:171]
    s_add_u32 s37, s37, 1
    ds_read_b64_tr_b16 a[218:219], v5 offset:13312
    v_max3_f32 v98, v98, v79, v80
    v_mfma_f32_16x16x32_bf16 v[216:219], a[220:223], v[28:31], v[216:219]
    s_bitcmp1_b32 s63, s37
    ds_read_b64_tr_b16 a[216:217], v5 offset:19456
    v_fma_f32 v60, v60, s28, v10
    v_fma_f32 v61, v61, s28, v10
    v_permlane32_swap_b32 v97, v96
    v_max_f32 v96, v96, v97
    v_mov_b32 v97, v96
    v_mfma_f32_16x16x32_bf16 a[8:11], a[220:223], v[34:37], a[8:11]
    s_cselect_b32 s62, 4294770688, 0
    v_max3_f32 v98, v98, v81, v82
    v_accvgpr_read_b32 v105, a1
    v_permlane16_swap_b32 v97, v96
    v_max_f32 v98, v98, v83
    v_mfma_f32_16x16x32_bf16 a[12:15], a[224:227], v[34:37], a[12:15]
    s_cselect_b32 s42, 0, 325632
    v_fma_f32 v59, v59, s28, v9
    v_max_f32 v96, v96, v97
    v_mfma_f32_16x16x32_bf16 v[220:223], a[224:227], v[28:31], v[220:223]
    s_add_u32 s35, s35, s42
    ds_read_b64_tr_b16 a[212:213], v4 offset:19456
    v_mul_f32_e64 v11, -s28, v96
    v_mfma_f32_16x16x32_bf16 v[172:175], a[224:227], v[22:25], v[172:175]
    s_lshl_b32 s42, s37, 1
    v_fma_f32 v64, v64, s28, v10
    v_max3_f32 v96, v84, v85, v86
    v_accvgpr_read_b32 v109, a5
    v_fma_f32 v68, v68, s28, v11
    v_mfma_f32_16x16x32_bf16 v[124:127], a[224:227], v[16:19], v[124:127]
    s_waitcnt lgkmcnt(3)
    ds_read_b64_tr_b16 a[214:215], v4 offset:13312
    v_mov_b32 v99, v98
    v_fma_f32 v55, v55, s28, v9
    v_mfma_f32_16x16x32_bf16 v[128:131], a[228:231], v[16:19], v[128:131]
    s_lshr_b32 s42, s31, s42
    v_max3_f32 v96, v96, v87, v88
    v_exp_f32 v57, v57
    v_mfma_f32_16x16x32_bf16 v[176:179], a[228:231], v[22:25], v[176:179]
    s_and_b32 s42, s42, 3
    ds_read_b64_tr_b16 a[220:221], v2 offset:20480
    v_fma_f32 v72, v72, s28, v11
    v_mfma_f32_16x16x32_bf16 v[224:227], a[228:231], v[28:31], v[224:227]
    s_add_u32 s42, s42, s36
    ds_read_b64_tr_b16 a[224:225], v3 offset:20480
    v_fma_f32 v54, v54, s28, v9
    v_mfma_f32_16x16x32_bf16 a[16:19], a[228:231], v[34:37], a[16:19]
    s_sub_u32 s43, s42, 3
    v_accvgpr_read_b32 v104, a0
    v_permlane32_swap_b32 v99, v98
    v_max3_f32 v96, v96, v89, v90
    v_mfma_f32_16x16x32_bf16 a[20:23], a[232:235], v[34:37], a[20:23]
    s_cmp_ge_u32 s42, 3
    v_max_f32 v96, v96, v91
    v_max_f32 v98, v98, v99
    v_mfma_f32_16x16x32_bf16 v[228:231], a[232:235], v[28:31], v[228:231]
    s_cselect_b32 s42, s43, s42
    ds_read_b64_tr_b16 a[226:227], v3 offset:14336
    v_subrev_u32 v103, 24576, v103
    v_mfma_f32_16x16x32_bf16 v[180:183], a[232:235], v[22:25], v[180:183]
    s_mul_i32 s44, s3, 5
    ds_read_b64_tr_b16 a[222:223], v2 offset:14336
    v_exp_f32 v68, v68
    v_mfma_f32_16x16x32_bf16 v[132:135], a[232:235], v[16:19], v[132:135]
    s_mov_b32 s32, 1
    ds_read_b64_tr_b16 a[234:235], v5 offset:14336
    s_waitcnt lgkmcnt(5)
    v_mfma_f32_16x16x32_bf16 v[136:139], a[212:215], v[16:19], v[136:139]
    s_lshl_b32 s43, s3, 2
    v_fma_f32 v65, v65, s28, v10
    v_fma_f32 v69, v69, s28, v11
    v_mov_b32 v97, v96
    v_mfma_f32_16x16x32_bf16 v[184:187], a[212:215], v[22:25], v[184:187]
    s_add_u32 s45, s43, 21
    v_exp_f32 v54, v54
    v_mfma_f32_16x16x32_bf16 v[232:235], a[212:215], v[28:31], v[232:235]
    s_cmp_eq_u32 s3, 0
    ds_read_b64_tr_b16 a[230:231], v4 offset:14336
    v_mov_b32 v99, v98
    v_mfma_f32_16x16x32_bf16 a[24:27], a[212:215], v[34:37], a[24:27]
    s_cselect_b32 s45, 20, s45
    v_fma_f32 v62, v62, s28, v10
    v_permlane32_swap_b32 v97, v96
    v_mfma_f32_16x16x32_bf16 a[28:31], a[216:219], v[34:37], a[28:31]
    s_cselect_b32 s33, 1, 0
    ds_read_b64_tr_b16 a[232:233], v5 offset:20480
    s_cmp_eq_u32 s42, 1
    v_mfma_f32_16x16x32_bf16 v[236:239], a[216:219], v[28:31], v[236:239]
    s_cselect_b32 s44, s45, s44
    v_exp_f32 v60, v60
    v_permlane16_swap_b32 v99, v98
    v_mfma_f32_16x16x32_bf16 v[188:191], a[216:219], v[22:25], v[188:191]
    s_cselect_b32 s32, s33, s32
    ds_read_b64_tr_b16 a[228:229], v4 offset:20480
    v_exp_f32 v62, v62
    v_mfma_f32_16x16x32_bf16 v[140:143], a[216:219], v[16:19], v[140:143]
    s_waitcnt lgkmcnt(4)
    v_exp_f32 v63, v63
    v_fma_f32 v66, v66, s28, v10
    v_mfma_f32_16x16x32_bf16 v[144:147], a[220:223], v[16:19], v[144:147]
    s_add_u32 s45, s43, 37
    v_max_f32 v98, v98, v99
    v_mul_f32_e64 v12, -s28, v98
    v_mfma_f32_16x16x32_bf16 v[192:195], a[220:223], v[22:25], v[192:195]
    s_cmp_eq_u32 s42, 2
    v_fma_f32 v77, v77, s28, v12
    s_cselect_b32 s44, s45, s44
    s_cselect_b32 s32, 0, s32
    v_fma_f32 v58, v58, s28, v9
    v_fma_f32 v76, v76, s28, v12
    v_fma_f32 v52, v52, s28, v9
    v_max_f32 v96, v96, v97
    v_mov_b32 v97, v96
    s_mul_i32 s44, s44, 6144
    v_exp_f32 v61, v61
    v_mfma_f32_16x16x32_bf16 v[240:243], a[220:223], v[28:31], v[240:243]
    s_add_u32 s33, s35, s44
    v_permlane16_swap_b32 v97, v96
    v_mfma_f32_16x16x32_bf16 a[32:35], a[220:223], v[34:37], a[32:35]
    s_mul_i32 s42, s32, 6144
    v_fma_f32 v70, v70, s28, v11
    v_exp_f32 v58, v58
    v_mfma_f32_16x16x32_bf16 a[36:39], a[224:227], v[34:37], a[36:39]
    s_add_u32 s42, s42, 24576
    v_max_f32 v96, v96, v97
    s_add_u32 s42, s42, s33
    s_cmp_ge_u32 s37, 6
    v_mfma_f32_16x16x32_bf16 v[244:247], a[224:227], v[28:31], v[244:247]
    s_cselect_b32 s14, 0, s42
    v_mul_f32_e64 v13, -s28, v96
    v_exp_f32 v55, v55
    s_add_u32 s24, s67, 256
    v_mfma_f32_16x16x32_bf16 v[196:199], a[224:227], v[22:25], v[196:199]
    s_add_u32 s25, s33, 256
    v_exp_f32 v69, v69
    v_mfma_f32_16x16x32_bf16 v[148:151], a[224:227], v[16:19], v[148:151]
    s_add_u32 s23, s38, 4096
    s_mov_b32 s27, 0x249
    s_mov_b32 s30, 0
    v_fma_f32 v71, v71, s28, v11
    s_waitcnt vmcnt(7) lgkmcnt(0)
    v_mfma_f32_16x16x32_bf16 v[152:155], a[228:231], v[16:19], v[152:155]
    s_barrier
    ds_read_b128 a[220:223], v0 offset:13312
    v_fma_f32 v86, v86, s28, v13
    v_mfma_f32_16x16x32_bf16 v[200:203], a[228:231], v[22:25], v[200:203]
    v_exp_f32 v76, v76
    v_fma_f32 v84, v84, s28, v13
    v_mfma_f32_16x16x32_bf16 v[248:251], a[228:231], v[28:31], v[248:251]
    ds_read_b128 a[212:215], v0 offset:12288
    v_exp_f32 v77, v77
    v_exp_f32 v71, v71
    v_exp_f32 v52, v52
    v_exp_f32 v72, v72
    v_exp_f32 v66, v66
    v_mfma_f32_16x16x32_bf16 a[40:43], a[228:231], v[34:37], a[40:43]
    ds_read_b128 a[216:219], v1 offset:12288
    v_exp_f32 v53, v53
    v_cvt_pk_bf16_f32 v21, v62, v63
    v_cvt_pk_bf16_f32 v26, v68, v69
    v_mfma_f32_16x16x32_bf16 a[44:47], a[232:235], v[34:37], a[44:47]
    v_fma_f32 v74, v74, s28, v11
    v_accvgpr_read_b32 v107, a3
    v_cvt_pk_bf16_f32 v32, v76, v77
    v_exp_f32 v70, v70
    v_exp_f32 v84, v84
    v_pk_mul_f32 v[122:123], v[122:123], v[48:49] op_sel_hi:[1,0]
    v_fma_f32 v82, v82, s28, v12
    v_fma_f32 v56, v56, s28, v9
    v_fma_f32 v79, v79, s28, v12
    v_fma_f32 v73, v73, s28, v11
    v_pk_mul_f32 v[114:115], v[114:115], v[48:49] op_sel_hi:[1,0]
    v_fma_f32 v87, v87, s28, v13
    v_cvt_pk_bf16_f32 v20, v60, v61
    v_fma_f32 v75, v75, s28, v11
    v_mfma_f32_16x16x32_bf16 v[252:255], a[232:235], v[28:31], v[252:255]
    v_fma_f32 v78, v78, s28, v12
    v_cvt_pk_bf16_f32 v15, v54, v55
    v_mfma_f32_16x16x32_bf16 v[204:207], a[232:235], v[22:25], v[204:207]
    v_cvt_pk_bf16_f32 v14, v52, v53
    v_exp_f32 v86, v86
    v_fma_f32 v91, v91, s28, v13
    v_fma_f32 v85, v85, s28, v13
    v_mfma_f32_16x16x32_bf16 v[156:159], a[232:235], v[16:19], v[156:159]
    s_waitcnt lgkmcnt(1)
    v_exp_f32 v87, v87
    v_mfma_f32_16x16x32_bf16 v[52:55], a[212:215], a[96:99], 0
    s_waitcnt lgkmcnt(0)
    ds_read_b128 a[232:235], v1 offset:14336
    v_fma_f32 v81, v81, s28, v12
    v_mfma_f32_16x16x32_bf16 v[52:55], a[216:219], a[100:103], v[52:55]
    v_exp_f32 v79, v79
    v_mfma_f32_16x16x32_bf16 v[52:55], a[220:223], a[104:107], v[52:55]
    ds_read_b128 a[224:227], v1 offset:13312
    v_exp_f32 v78, v78
    v_mfma_f32_16x16x32_bf16 v[60:63], a[220:223], a[128:131], 0
    ds_read_b128 a[228:231], v0 offset:14336
    v_cvt_pk_bf16_f32 v33, v78, v79
    v_mfma_f32_16x16x32_bf16 v[60:63], a[216:219], a[124:127], v[60:63]
    v_cvt_pk_bf16_f32 v27, v70, v71
    v_accvgpr_read_b32 v111, a7
    v_mfma_f32_16x16x32_bf16 v[60:63], a[212:215], a[120:123], v[60:63]
    s_add_u32 m0, s22, 36864
    v_exp_f32 v85, v85
    v_mfma_f32_16x16x32_bf16 v[68:71], a[212:215], a[144:147], 0
    v_fma_f32 v67, v67, s28, v10
    v_exp_f32 v73, v73
    v_mfma_f32_16x16x32_bf16 v[68:71], a[216:219], a[148:151], v[68:71]
    v_fma_f32 v88, v88, s28, v13
    v_fma_f32 v90, v90, s28, v13
    v_mfma_f32_16x16x32_bf16 v[68:71], a[220:223], a[152:155], v[68:71]
    buffer_load_dwordx4 v6, s[8:11], s21 offen lds
    v_mfma_f32_16x16x32_bf16 v[76:79], a[220:223], a[176:179], 0
    s_add_u32 s21, s21, 128
    v_cvt_pk_bf16_f32 v38, v84, v85
    v_cvt_pk_bf16_f32 v39, v86, v87
    v_mfma_f32_16x16x32_bf16 v[76:79], a[216:219], a[172:175], v[76:79]
    v_exp_f32 v59, v59
    v_mfma_f32_16x16x32_bf16 v[76:79], a[212:215], a[168:171], v[76:79]
    v_exp_f32 v82, v82
    v_mfma_f32_16x16x32_bf16 v[84:87], a[212:215], a[192:195], 0
    s_add_u32 m0, s22, 37888
    v_exp_f32 v91, v91
    v_mfma_f32_16x16x32_bf16 v[84:87], a[216:219], a[196:199], v[84:87]
    v_exp_f32 v56, v56
    v_mfma_f32_16x16x32_bf16 v[84:87], a[220:223], a[200:203], v[84:87]
    s_waitcnt lgkmcnt(0)
    v_exp_f32 v67, v67
    v_fma_f32 v83, v83, s28, v12
    v_mfma_f32_16x16x32_bf16 v[84:87], a[224:227], a[204:207], v[84:87]
    ds_read_b128 a[216:219], v1 offset:18432
    v_cvt_pk_bf16_f32 v17, v58, v59
    v_mfma_f32_16x16x32_bf16 v[84:87], a[228:231], a[208:211], v[84:87]
    buffer_load_dwordx4 v6, s[8:11], s21 offen lds
    v_mfma_f32_16x16x32_bf16 v[84:87], a[232:235], v[92:95], v[84:87]
    ds_read_b128 a[212:215], v0 offset:18432
    v_accvgpr_read_b32 v110, a6
    v_mfma_f32_16x16x32_bf16 v[76:79], a[232:235], a[188:191], v[76:79]
    v_cvt_pk_bf16_f32 v23, v66, v67
    v_fma_f32 v80, v80, s28, v12
    v_mfma_f32_16x16x32_bf16 v[76:79], a[228:231], a[184:187], v[76:79]
    v_exp_f32 v65, v65
    v_mfma_f32_16x16x32_bf16 v[76:79], a[224:227], a[180:183], v[76:79]
    v_fma_f32 v89, v89, s28, v13
    v_accvgpr_read_b32 v108, a4
    v_mfma_f32_16x16x32_bf16 v[68:71], a[224:227], a[156:159], v[68:71]
    v_exp_f32 v88, v88
    v_mfma_f32_16x16x32_bf16 v[68:71], a[228:231], a[160:163], v[68:71]
    v_exp_f32 v80, v80
    v_mfma_f32_16x16x32_bf16 v[68:71], a[232:235], a[164:167], v[68:71]
    v_accvgpr_read_b32 v106, a2
    v_cvt_pk_bf16_f32 v16, v56, v57
    v_mfma_f32_16x16x32_bf16 v[60:63], a[232:235], a[140:143], v[60:63]
    s_add_u32 s21, s21, 128
    v_exp_f32 v74, v74
    v_mfma_f32_16x16x32_bf16 v[60:63], a[228:231], a[136:139], v[60:63]
    v_exp_f32 v75, v75
    v_mfma_f32_16x16x32_bf16 v[60:63], a[224:227], a[132:135], v[60:63]
    v_cvt_pk_bf16_f32 v28, v72, v73
    v_fma_f32 v69, v69, s28, v11
    v_mfma_f32_16x16x32_bf16 v[52:55], a[224:227], a[108:111], v[52:55]
    s_add_u32 m0, s22, 38912
    v_exp_f32 v81, v81
    v_mfma_f32_16x16x32_bf16 v[52:55], a[228:231], a[112:115], v[52:55]
    buffer_load_dwordx4 v6, s[8:11], s21 offen lds
    v_mfma_f32_16x16x32_bf16 v[52:55], a[232:235], a[116:119], v[52:55]
    s_waitcnt lgkmcnt(0)
    v_exp_f32 v90, v90
    v_mfma_f32_16x16x32_bf16 v[56:59], a[212:215], a[96:99], 0
    ds_read_b128 a[220:223], v0 offset:19456
    v_fma_f32 v87, v87, s28, v13
    v_fma_f32 v70, v70, s28, v11
    v_exp_f32 v64, v64
    v_pk_mul_f32 v[168:169], v[168:169], v[102:103] op_sel_hi:[1,0]
    v_cvt_pk_bf16_f32 v22, v64, v65
    v_pk_mul_f32 v[212:213], v[212:213], v[50:51] op_sel_hi:[1,0]
    v_pk_mul_f32 v[104:105], v[104:105], v[8:9] op_sel_hi:[1,0]
    v_pk_mul_f32 v[108:109], v[108:109], v[8:9] op_sel_hi:[1,0]
    v_pk_mul_f32 v[216:217], v[216:217], v[50:51] op_sel_hi:[1,0]
    v_pk_mul_f32 v[152:153], v[152:153], v[48:49] op_sel_hi:[1,0]
    v_pk_mul_f32 v[140:141], v[140:141], v[48:49] op_sel_hi:[1,0]
    v_pk_mul_f32 v[218:219], v[218:219], v[50:51] op_sel_hi:[1,0]
    v_pk_mul_f32 v[160:161], v[160:161], v[102:103] op_sel_hi:[1,0]
    v_pk_mul_f32 v[164:165], v[164:165], v[102:103] op_sel_hi:[1,0]
    v_fma_f32 v53, v53, s28, v9
    v_pk_mul_f32 v[112:113], v[112:113], v[48:49] op_sel_hi:[1,0]
    v_pk_mul_f32 v[166:167], v[166:167], v[102:103] op_sel_hi:[1,0]
    v_pk_mul_f32 v[120:121], v[120:121], v[48:49] op_sel_hi:[1,0]
    v_pk_mul_f32 v[110:111], v[110:111], v[8:9] op_sel_hi:[1,0]
    v_pk_mul_f32 v[162:163], v[162:163], v[102:103] op_sel_hi:[1,0]
    v_pk_mul_f32 v[248:249], v[248:249], v[50:51] op_sel_hi:[1,0]
    v_pk_mul_f32 v[214:215], v[214:215], v[50:51] op_sel_hi:[1,0]
    v_pk_mul_f32 v[132:133], v[132:133], v[48:49] op_sel_hi:[1,0]
    v_pk_mul_f32 v[210:211], v[210:211], v[50:51] op_sel_hi:[1,0]
    v_pk_mul_f32 v[224:225], v[224:225], v[50:51] op_sel_hi:[1,0]
    v_pk_mul_f32 v[208:209], v[208:209], v[50:51] op_sel_hi:[1,0]
    v_pk_mul_f32 v[172:173], v[172:173], v[102:103] op_sel_hi:[1,0]
    v_pk_mul_f32 v[118:119], v[118:119], v[48:49] op_sel_hi:[1,0]
    v_pk_mul_f32 v[116:117], v[116:117], v[48:49] op_sel_hi:[1,0]
    v_pk_mul_f32 v[222:223], v[222:223], v[50:51] op_sel_hi:[1,0]
    v_pk_mul_f32 v[176:177], v[176:177], v[102:103] op_sel_hi:[1,0]
    v_fma_f32 v68, v68, s28, v11
    v_pk_mul_f32 v[244:245], v[244:245], v[50:51] op_sel_hi:[1,0]
    v_cvt_pk_bf16_f32 v29, v74, v75
    v_pk_mul_f32 v[190:191], v[190:191], v[102:103] op_sel_hi:[1,0]
    v_cvt_pk_bf16_f32 v160, v160, v161
    v_cvt_pk_bf16_f32 v132, v132, v133
    v_mfma_f32_16x16x32_bf16 v[56:59], a[216:219], a[100:103], v[56:59]
    s_waitcnt lgkmcnt(0)
    v_exp_f32 v68, v68
    v_mfma_f32_16x16x32_bf16 v[56:59], a[220:223], a[104:107], v[56:59]
    v_fma_f32 v79, v79, s28, v12
    v_cvt_pk_bf16_f32 v208, v208, v209
    v_mfma_f32_16x16x32_bf16 v[64:67], a[220:223], a[128:131], 0
    v_exp_f32 v83, v83
    v_mfma_f32_16x16x32_bf16 v[64:67], a[216:219], a[124:127], v[64:67]
    ds_read_b128 a[232:235], v1 offset:20480
    v_cvt_pk_bf16_f32 v112, v112, v113
    v_mfma_f32_16x16x32_bf16 v[64:67], a[212:215], a[120:123], v[64:67]
    ds_read_b128 a[224:227], v1 offset:19456
    v_cvt_pk_bf16_f32 v35, v82, v83
    v_mfma_f32_16x16x32_bf16 v[72:75], a[212:215], a[144:147], 0
    ds_read_b128 a[228:231], v0 offset:20480
    v_cvt_pk_bf16_f32 v108, v108, v109
    v_cvt_pk_bf16_f32 v41, v90, v91
    v_mfma_f32_16x16x32_bf16 v[72:75], a[216:219], a[148:151], v[72:75]
    s_add_u32 s21, s21, 12032
    v_cvt_pk_bf16_f32 v34, v80, v81
    v_fma_f32 v86, v86, s28, v13
    v_mfma_f32_16x16x32_bf16 v[72:75], a[220:223], a[152:155], v[72:75]
    v_fma_f32 v61, v61, s28, v10
    v_cvt_pk_bf16_f32 v161, v162, v163
    v_exp_f32 v70, v70
    v_fma_f32 v84, v84, s28, v13
    v_pk_mul_f32 v[240:241], v[240:241], v[50:51] op_sel_hi:[1,0]
    v_pk_mul_f32 v[198:199], v[198:199], v[102:103] op_sel_hi:[1,0]
    v_pk_mul_f32 v[192:193], v[192:193], v[102:103] op_sel_hi:[1,0]
    v_pk_mul_f32 v[130:131], v[130:131], v[48:49] op_sel_hi:[1,0]
    v_pk_mul_f32 v[220:221], v[220:221], v[50:51] op_sel_hi:[1,0]
    v_cvt_pk_bf16_f32 v172, v172, v173
    v_pk_mul_f32 v[106:107], v[106:107], v[8:9] op_sel_hi:[1,0]
    v_exp_f32 v89, v89
    v_fma_f32 v52, v52, s28, v9
    v_mfma_f32_16x16x32_bf16 v[80:83], a[220:223], a[176:179], 0
    v_exp_f32 v52, v52
    v_mfma_f32_16x16x32_bf16 v[80:83], a[216:219], a[172:175], v[80:83]
    v_cvt_pk_bf16_f32 v244, v244, v245
    v_cvt_pk_bf16_f32 v40, v88, v89
    v_mfma_f32_16x16x32_bf16 v[80:83], a[212:215], a[168:171], v[80:83]
    v_exp_f32 v69, v69
    v_cvt_pk_bf16_f32 v212, v212, v213
    v_mfma_f32_16x16x32_bf16 v[88:91], a[212:215], a[192:195], 0
    s_waitcnt vmcnt(6) lgkmcnt(0)
    v_fma_f32 v77, v77, s28, v12
    v_cvt_pk_bf16_f32 v104, v104, v105
    v_mfma_f32_16x16x32_bf16 v[88:91], a[216:219], a[196:199], v[88:91]
    s_barrier
    v_exp_f32 v86, v86
    v_mfma_f32_16x16x32_bf16 v[88:91], a[220:223], a[200:203], v[88:91]
    v_cvt_pk_bf16_f32 v116, v116, v117
    v_cvt_pk_bf16_f32 v105, v106, v107
    v_mfma_f32_16x16x32_bf16 v[44:47], a[236:239], v[14:17], 0
    v_fma_f32 v54, v54, s28, v9
    v_exp_f32 v53, v53
    v_mfma_f32_16x16x32_bf16 v[88:91], a[224:227], a[204:207], v[88:91]
    v_cvt_pk_bf16_f32 v224, v224, v225
    v_fma_f32 v71, v71, s28, v11
    v_cvt_pk_bf16_f32 v209, v210, v211
    v_cvt_pk_bf16_f32 v113, v114, v115
    v_mfma_f32_16x16x32_bf16 v[88:91], a[228:231], a[208:211], v[88:91]
    v_exp_f32 v71, v71
    v_mfma_f32_16x16x32_bf16 v[88:91], a[232:235], v[92:95], v[88:91]
    v_exp_f32 v61, v61
    v_fma_f32 v55, v55, s28, v9
    v_mfma_f32_16x16x32_bf16 v[80:83], a[232:235], a[188:191], v[80:83]
    s_add_u32 m0, s22, 12288
    v_cvt_pk_bf16_f32 v220, v220, v221
    v_fma_f32 v76, v76, s28, v12
    v_mfma_f32_16x16x32_bf16 v[80:83], a[228:231], a[184:187], v[80:83]
    ds_read_b64_tr_b16 a[212:213], v2 offset:0
    v_cvt_pk_bf16_f32 v164, v164, v165
    v_mfma_f32_16x16x32_bf16 v[80:83], a[224:227], a[180:183], v[80:83]
    ds_read_b64_tr_b16 a[214:215], v2 offset:6144
    v_fma_f32 v60, v60, s28, v10
    v_fma_f32 v63, v63, s28, v10
    v_mfma_f32_16x16x32_bf16 v[72:75], a[224:227], a[156:159], v[72:75]
    ds_write2st64_b64 v101, v[112:113], v[160:161] offset0:0 offset1:12
    v_pk_mul_f32 v[146:147], v[146:147], v[48:49] op_sel_hi:[1,0]
    v_exp_f32 v54, v54
    v_pk_mul_f32 v[178:179], v[178:179], v[102:103] op_sel_hi:[1,0]
    v_pk_mul_f32 v[184:185], v[184:185], v[102:103] op_sel_hi:[1,0]
    v_cvt_pk_bf16_f32 v192, v192, v193
    v_pk_mul_f32 v[188:189], v[188:189], v[102:103] op_sel_hi:[1,0]
    v_pk_mul_f32 v[194:195], v[194:195], v[102:103] op_sel_hi:[1,0]
    v_pk_mul_f32 v[232:233], v[232:233], v[50:51] op_sel_hi:[1,0]
    v_pk_mul_f32 v[200:201], v[200:201], v[102:103] op_sel_hi:[1,0]
    v_pk_mul_f32 v[204:205], v[204:205], v[102:103] op_sel_hi:[1,0]
    v_pk_mul_f32 v[128:129], v[128:129], v[48:49] op_sel_hi:[1,0]
    v_pk_mul_f32 v[182:183], v[182:183], v[102:103] op_sel_hi:[1,0]
    v_cvt_pk_bf16_f32 v188, v188, v189
    v_pk_mul_f32 v[134:135], v[134:135], v[48:49] op_sel_hi:[1,0]
    v_cvt_pk_bf16_f32 v213, v214, v215
    v_cvt_pk_bf16_f32 v176, v176, v177
    v_cvt_pk_bf16_f32 v193, v194, v195
    v_pk_mul_f32 v[174:175], v[174:175], v[102:103] op_sel_hi:[1,0]
    v_pk_mul_f32 v[196:197], v[196:197], v[102:103] op_sel_hi:[1,0]
    v_cvt_pk_bf16_f32 v117, v118, v119
    v_cvt_pk_bf16_f32 v109, v110, v111
    v_mfma_f32_16x16x32_bf16 v[44:47], a[240:243], v[20:23], v[44:47]
    buffer_load_dwordx4 v6, s[4:7], s20 offen lds
    v_cvt_pk_bf16_f32 v165, v166, v167
    v_mfma_f32_16x16x32_bf16 v[72:75], a[228:231], a[160:163], v[72:75]
    s_add_u32 s20, s20, 128
    ds_read_b64_tr_b16 a[216:217], v3 offset:0
    v_cvt_pk_bf16_f32 v152, v152, v153
    v_mfma_f32_16x16x32_bf16 v[72:75], a[232:235], a[164:167], v[72:75]
    ds_write2st64_b64 v101, v[208:209], v[104:105] offset0:24 offset1:36
    v_mfma_f32_16x16x32_bf16 v[64:67], a[232:235], a[140:143], v[64:67]
    v_cvt_pk_bf16_f32 v173, v174, v175
    v_cvt_pk_bf16_f32 v128, v128, v129
    v_mfma_f32_16x16x32_bf16 v[64:67], a[228:231], a[136:139], v[64:67]
    ds_read_b64_tr_b16 a[218:219], v3 offset:6144
    v_cvt_pk_bf16_f32 v189, v190, v191
    v_cvt_pk_bf16_f32 v129, v130, v131
    v_xor_b32 v101, 32, v101
    v_exp_f32 v77, v77
    v_exp_f32 v55, v55
    v_mfma_f32_16x16x32_bf16 v[64:67], a[224:227], a[132:135], v[64:67]
    v_fma_f32 v90, v90, s28, v13
    v_accvgpr_read_b32 v105, a9
    v_fma_f32 v73, v73, s28, v11
    v_cvt_pk_bf16_f32 v133, v134, v135
    v_mfma_f32_16x16x32_bf16 v[56:59], a[224:227], a[108:111], v[56:59]
    ds_write2st64_b64 v101, v[116:117], v[164:165] offset0:0 offset1:12
    v_accvgpr_read_b32 v107, a11
    v_exp_f32 v60, v60
    v_accvgpr_read_b32 v110, a14
    v_pk_mul_f32 v[228:229], v[228:229], v[50:51] op_sel_hi:[1,0]
    v_pk_mul_f32 v[242:243], v[242:243], v[50:51] op_sel_hi:[1,0]
    v_pk_mul_f32 v[144:145], v[144:145], v[48:49] op_sel_hi:[1,0]
    v_pk_mul_f32 v[142:143], v[142:143], v[48:49] op_sel_hi:[1,0]
    v_pk_mul_f32 v[124:125], v[124:125], v[48:49] op_sel_hi:[1,0]
    v_pk_mul_f32 v[180:181], v[180:181], v[102:103] op_sel_hi:[1,0]
    v_pk_mul_f32 v[170:171], v[170:171], v[102:103] op_sel_hi:[1,0]
    v_fma_f32 v88, v88, s28, v13
    v_cvt_pk_bf16_f32 v168, v168, v169
    v_cvt_pk_bf16_f32 v216, v216, v217
    v_cvt_pk_bf16_f32 v177, v178, v179
    v_mfma_f32_16x16x32_bf16 v[56:59], a[228:231], a[112:115], v[56:59]
    ds_read_b64_tr_b16 a[220:221], v4 offset:0
    v_cvt_pk_bf16_f32 v221, v222, v223
    v_mfma_f32_16x16x32_bf16 v[44:47], a[244:247], v[26:29], v[44:47]
    s_add_u32 m0, s22, 13312
    ds_read_b64_tr_b16 a[222:223], v4 offset:6144
    v_exp_f32 v79, v79
    v_mfma_f32_16x16x32_bf16 v[56:59], a[232:235], a[116:119], v[56:59]
    s_waitcnt lgkmcnt(3)
    v_cvt_pk_bf16_f32 v124, v124, v125
    v_cvt_pk_bf16_f32 v120, v120, v121
    v_cvt_pk_bf16_f32 v204, v204, v205
    v_mfma_f32_16x16x32_bf16 v[112:115], a[212:215], v[14:17], 0
    v_accvgpr_read_b32 v104, a8
    v_accvgpr_read_b32 v106, a10
    v_fma_f32 v74, v74, s28, v11
    v_mfma_f32_16x16x32_bf16 v[116:119], a[216:219], v[14:17], 0
    ds_write2st64_b64 v101, v[212:213], v[108:109] offset0:24 offset1:36
    v_pk_mul_f32 v[236:237], v[236:237], v[50:51] op_sel_hi:[1,0]
    v_pk_mul_f32 v[154:155], v[154:155], v[48:49] op_sel_hi:[1,0]
    v_cvt_pk_bf16_f32 v30, v68, v69
    v_pk_mul_f32 v[106:107], v[106:107], v[8:9] op_sel_hi:[1,0]
    v_cvt_pk_bf16_f32 v196, v196, v197
    v_pk_mul_f32 v[226:227], v[226:227], v[50:51] op_sel_hi:[1,0]
    v_pk_mul_f32 v[246:247], v[246:247], v[50:51] op_sel_hi:[1,0]
    v_pk_mul_f32 v[104:105], v[104:105], v[8:9] op_sel_hi:[1,0]
    v_cvt_pk_bf16_f32 v144, v144, v145
    v_fma_f32 v66, v66, s28, v10
    v_xor_b32 v101, 96, v101
    v_mfma_f32_16x16x32_bf16 v[164:167], a[216:219], v[20:23], 0
    v_cvt_pk_bf16_f32 v184, v184, v185
    v_cvt_pk_bf16_f32 v200, v200, v201
    v_cvt_pk_bf16_f32 v240, v240, v241
    v_cvt_pk_bf16_f32 v228, v228, v229
    v_exp_f32 v76, v76
    v_fma_f32 v82, v82, s28, v12
    v_fma_f32 v91, v91, s28, v13
    v_cvt_pk_bf16_f32 v169, v170, v171
    v_cvt_pk_bf16_f32 v217, v218, v219
    v_pk_mul_f32 v[126:127], v[126:127], v[48:49] op_sel_hi:[1,0]
    v_pk_mul_f32 v[148:149], v[148:149], v[48:49] op_sel_hi:[1,0]
    v_cvt_pk_bf16_f32 v125, v126, v127
    v_accvgpr_read_b32 v111, a15
    v_pk_mul_f32 v[136:137], v[136:137], v[48:49] op_sel_hi:[1,0]
    v_pk_mul_f32 v[238:239], v[238:239], v[50:51] op_sel_hi:[1,0]
    v_exp_f32 v66, v66
    v_cvt_pk_bf16_f32 v31, v70, v71
    v_cvt_pk_bf16_f32 v232, v232, v233
    v_pk_mul_f32 v[186:187], v[186:187], v[102:103] op_sel_hi:[1,0]
    v_pk_mul_f32 v[150:151], v[150:151], v[48:49] op_sel_hi:[1,0]
    v_cvt_pk_bf16_f32 v180, v180, v181
    v_pk_mul_f32 v[252:253], v[252:253], v[50:51] op_sel_hi:[1,0]
    v_exp_f32 v87, v87
    v_fma_f32 v67, v67, s28, v10
    v_pk_mul_f32 v[254:255], v[254:255], v[50:51] op_sel_hi:[1,0]
    v_cvt_pk_bf16_f32 v121, v122, v123
    v_accvgpr_read_b32 v109, a13
    v_mfma_f32_16x16x32_bf16 v[160:163], a[212:215], v[20:23], 0
    ds_read_b64_tr_b16 a[224:225], v5 offset:0
    v_cvt_pk_bf16_f32 v104, v104, v105
    v_mfma_f32_16x16x32_bf16 v[208:211], a[212:215], v[26:29], 0
    ds_read_b64_tr_b16 a[226:227], v5 offset:6144
    v_accvgpr_read_b32 v108, a12
    v_mfma_f32_16x16x32_bf16 v[212:215], a[216:219], v[26:29], 0
    v_fma_f32 v75, v75, s28, v11
    v_cvt_pk_bf16_f32 v153, v154, v155
    v_cvt_pk_bf16_f32 v105, v106, v107
    v_mfma_f32_16x16x32_bf16 a[4:7], a[216:219], v[32:35], 0
    ds_write2st64_b64 v101, v[120:121], v[168:169] offset0:0 offset1:12
    v_fma_f32 v62, v62, s28, v10
    v_pk_mul_f32 v[108:109], v[108:109], v[8:9] op_sel_hi:[1,0]
    v_pk_mul_f32 v[138:139], v[138:139], v[48:49] op_sel_hi:[1,0]
    v_pk_mul_f32 v[110:111], v[110:111], v[8:9] op_sel_hi:[1,0]
    v_cvt_pk_bf16_f32 v108, v108, v109
    v_cvt_pk_bf16_f32 v140, v140, v141
    v_mfma_f32_16x16x32_bf16 a[0:3], a[212:215], v[32:35], 0
    ds_write2st64_b64 v101, v[216:217], v[104:105] offset0:24 offset1:36
    v_pk_mul_f32 v[234:235], v[234:235], v[50:51] op_sel_hi:[1,0]
    v_pk_mul_f32 v[230:231], v[230:231], v[50:51] op_sel_hi:[1,0]
    v_accvgpr_read_b32 v104, a16
    v_cvt_pk_bf16_f32 v109, v110, v111
    v_exp_f32 v84, v84
    v_accvgpr_read_b32 v105, a17
    v_mfma_f32_16x16x32_bf16 a[48:51], a[212:215], v[38:41], 0
    buffer_load_dwordx4 v6, s[4:7], s20 offen lds
    ds_read_b64_tr_b16 a[212:213], v4 offset:1024
    v_accvgpr_read_b32 v110, a22
    v_fma_f32 v83, v83, s28, v12
    v_cvt_pk_bf16_f32 v148, v148, v149
    v_cvt_pk_bf16_f32 v248, v248, v249
    v_xor_b32 v101, 32, v101
    v_mfma_f32_16x16x32_bf16 a[52:55], a[216:219], v[38:41], 0
    s_waitcnt lgkmcnt(3)
    v_cvt_pk_bf16_f32 v225, v226, v227
    v_exp_f32 v83, v83
    v_mfma_f32_16x16x32_bf16 a[56:59], a[220:223], v[38:41], 0
    ds_read_b64_tr_b16 a[232:233], v3 offset:1024
    v_fma_f32 v56, v56, s28, v9
    v_mfma_f32_16x16x32_bf16 a[60:63], a[224:227], v[38:41], 0
    ds_write2st64_b64 v101, v[124:125], v[172:173] offset0:0 offset1:12
    v_cvt_pk_bf16_f32 v181, v182, v183
    v_cvt_pk_bf16_f32 v236, v236, v237
    v_fma_f32 v78, v78, s28, v12
    v_accvgpr_read_b32 v107, a19
    v_mfma_f32_16x16x32_bf16 a[12:15], a[224:227], v[32:35], 0
    s_add_u32 s20, s20, 128
    ds_write2st64_b64 v101, v[220:221], v[108:109] offset0:24 offset1:36
    v_cvt_pk_bf16_f32 v24, v60, v61
    v_pk_mul_f32 v[104:105], v[104:105], v[8:9] op_sel_hi:[1,0]
    v_cvt_pk_bf16_f32 v136, v136, v137
    v_xor_b32 v101, 96, v101
    v_cvt_pk_bf16_f32 v233, v234, v235
    v_accvgpr_read_b32 v106, a18
    v_mfma_f32_16x16x32_bf16 v[44:47], a[248:251], v[32:35], v[44:47]
    s_add_u32 m0, s22, 14336
    ds_read_b128 v[96:99], v103 offset:0
    v_accvgpr_read_b32 v109, a21
    v_mfma_f32_16x16x32_bf16 a[8:11], a[220:223], v[32:35], 0
    ds_read_b64_tr_b16 a[216:217], v5 offset:1024
    v_fma_f32 v85, v85, s28, v13
    v_mfma_f32_16x16x32_bf16 v[216:219], a[220:223], v[26:29], 0
    ds_read_b64_tr_b16 a[234:235], v3 offset:7168
    v_accvgpr_read_b32 v111, a23
    v_cvt_pk_bf16_f32 v104, v104, v105
    v_cvt_pk_bf16_f32 v18, v52, v53
    v_cvt_pk_bf16_f32 v229, v230, v231
    v_mfma_f32_16x16x32_bf16 v[44:47], a[252:255], v[38:41], v[44:47]
    ds_read_b64_tr_b16 a[230:231], v2 offset:7168
    buffer_load_dwordx4 v6, s[4:7], s20 offen lds
    v_mfma_f32_16x16x32_bf16 v[220:223], a[224:227], v[26:29], 0
    ds_read_b64_tr_b16 a[228:229], v2 offset:1024
    v_cvt_pk_bf16_f32 v241, v242, v243
    v_exp_f32 v56, v56
    v_mfma_f32_16x16x32_bf16 v[172:175], a[224:227], v[20:23], 0
    ds_write2st64_b64 v101, v[128:129], v[176:177] offset0:4 offset1:16
    v_pk_mul_f32 v[250:251], v[250:251], v[50:51] op_sel_hi:[1,0]
    v_pk_mul_f32 v[106:107], v[106:107], v[8:9] op_sel_hi:[1,0]
    v_pk_mul_f32 v[110:111], v[110:111], v[8:9] op_sel_hi:[1,0]
    v_accvgpr_read_b32 v108, a20
    v_cvt_pk_bf16_f32 v185, v186, v187
    v_cvt_pk_bf16_f32 v237, v238, v239
    v_pk_mul_f32 v[108:109], v[108:109], v[8:9] op_sel_hi:[1,0]
    v_cvt_pk_bf16_f32 v105, v106, v107
    v_cvt_pk_bf16_f32 v249, v250, v251
    v_pk_mul_f32 v[206:207], v[206:207], v[102:103] op_sel_hi:[1,0]
    v_accvgpr_read_b32 v106, a26
    v_fma_f32 v89, v89, s28, v13
    v_accvgpr_read_b32 v107, a27
    v_cvt_pk_bf16_f32 v108, v108, v109
    v_exp_f32 v78, v78
    v_cvt_pk_bf16_f32 v109, v110, v111
    v_cvt_pk_bf16_f32 v137, v138, v139
    v_mfma_f32_16x16x32_bf16 v[168:171], a[220:223], v[20:23], 0
    ds_write2st64_b64 v101, v[224:225], v[104:105] offset0:28 offset1:40
    v_fma_f32 v64, v64, s28, v10
    v_mfma_f32_16x16x32_bf16 v[120:123], a[220:223], v[14:17], 0
    ds_read_b64_tr_b16 a[218:219], v5 offset:7168
    v_cvt_pk_bf16_f32 v141, v142, v143
    v_xor_b32 v101, 32, v101
    v_mfma_f32_16x16x32_bf16 v[124:127], a[224:227], v[14:17], 0
    s_waitcnt lgkmcnt(3)
    ds_write2st64_b64 v101, v[132:133], v[180:181] offset0:4 offset1:16
    v_mfma_f32_16x16x32_bf16 v[128:131], a[228:231], v[14:17], 0
    v_exp_f32 v90, v90
    v_mfma_f32_16x16x32_bf16 v[132:135], a[232:235], v[14:17], 0
    s_add_u32 s20, s20, 12032
    ds_write2st64_b64 v101, v[228:229], v[108:109] offset0:28 offset1:40
    v_mfma_f32_16x16x32_bf16 v[180:183], a[232:235], v[20:23], 0
    buffer_store_dwordx4 v[96:99], v6, s[16:19], s67 offen offset:0 nt
    ds_read_b64_tr_b16 a[214:215], v4 offset:7168
    v_pk_mul_f32 v[158:159], v[158:159], v[48:49] op_sel_hi:[1,0]
    v_accvgpr_read_b32 v108, a28
    v_accvgpr_read_b32 v109, a29
    v_pk_mul_f32 v[108:109], v[108:109], v[8:9] op_sel_hi:[1,0]
    v_pk_mul_f32 v[202:203], v[202:203], v[102:103] op_sel_hi:[1,0]
    v_accvgpr_read_b32 v104, a24
    v_cvt_pk_bf16_f32 v252, v252, v253
    v_cvt_pk_bf16_f32 v108, v108, v109
    v_mfma_f32_16x16x32_bf16 v[176:179], a[228:231], v[20:23], 0
    ds_read_b64_tr_b16 a[222:223], v2 offset:8192
    v_accvgpr_read_b32 v105, a25
    v_mfma_f32_16x16x32_bf16 v[224:227], a[228:231], v[26:29], 0
    s_add_u32 m0, s38, 0
    ds_read_b64_tr_b16 a[220:221], v2 offset:2048
    v_xor_b32 v101, 96, v101
    v_cvt_pk_bf16_f32 v149, v150, v151
    v_mfma_f32_16x16x32_bf16 v[228:231], a[232:235], v[26:29], 0
    buffer_load_dwordx4 v6, s[12:15], s33 offen nt lds
    ds_read_b128 v[96:99], v103 offset:1024
    v_accvgpr_read_b32 v110, a30
    v_cvt_pk_bf16_f32 v245, v246, v247
    v_cvt_pk_bf16_f32 v145, v146, v147
    v_accvgpr_read_b32 v111, a31
    v_mfma_f32_16x16x32_bf16 a[20:23], a[232:235], v[32:35], 0
    ds_write2st64_b64 v101, v[136:137], v[184:185] offset0:4 offset1:16
    v_pk_mul_f32 v[106:107], v[106:107], v[8:9] op_sel_hi:[1,0]
    v_pk_mul_f32 v[110:111], v[110:111], v[8:9] op_sel_hi:[1,0]
    v_pk_mul_f32 v[104:105], v[104:105], v[8:9] op_sel_hi:[1,0]
    v_pk_mul_f32 v[156:157], v[156:157], v[48:49] op_sel_hi:[1,0]
    v_cvt_pk_bf16_f32 v104, v104, v105
    v_cvt_pk_bf16_f32 v105, v106, v107
    v_mfma_f32_16x16x32_bf16 a[16:19], a[228:231], v[32:35], 0
    s_add_u32 m0, s38, 1024
    v_cvt_pk_bf16_f32 v109, v110, v111
    v_accvgpr_read_b32 v111, a39
    v_mfma_f32_16x16x32_bf16 a[64:67], a[228:231], v[38:41], 0
    ds_write2st64_b64 v101, v[232:233], v[104:105] offset0:28 offset1:40
    v_mfma_f32_16x16x32_bf16 a[68:71], a[232:235], v[38:41], 0
    s_waitcnt lgkmcnt(4)
    ds_read_b64_tr_b16 a[224:225], v3 offset:2048
    v_fma_f32 v80, v80, s28, v12
    v_mfma_f32_16x16x32_bf16 a[72:75], a[212:215], v[38:41], 0
    ds_read_b64_tr_b16 a[226:227], v3 offset:8192
    v_exp_f32 v88, v88
    v_xor_b32 v101, 32, v101
    v_accvgpr_read_b32 v106, a34
    v_mfma_f32_16x16x32_bf16 a[76:79], a[216:219], v[38:41], 0
    ds_read_b64_tr_b16 a[230:231], v4 offset:8192
    v_cvt_pk_bf16_f32 v197, v198, v199
    v_mfma_f32_16x16x32_bf16 a[28:31], a[216:219], v[32:35], 0
    ds_write2st64_b64 v101, v[140:141], v[188:189] offset0:4 offset1:16
    v_mfma_f32_16x16x32_bf16 a[24:27], a[212:215], v[32:35], 0
    ds_read_b64_tr_b16 a[228:229], v4 offset:2048
    v_accvgpr_read_b32 v110, a38
    v_mfma_f32_16x16x32_bf16 v[232:235], a[212:215], v[26:29], 0
    ds_write2st64_b64 v101, v[236:237], v[108:109] offset0:28 offset1:40
    v_mfma_f32_16x16x32_bf16 v[236:239], a[216:219], v[26:29], 0
    s_waitcnt lgkmcnt(6)
    ds_read_b64_tr_b16 a[234:235], v5 offset:8192
    buffer_load_dwordx4 v7, s[12:15], s33 offen nt lds
    v_accvgpr_read_b32 v107, a35
    v_mfma_f32_16x16x32_bf16 v[188:191], a[216:219], v[20:23], 0
    s_add_u32 s39, s39, 12288
    ds_read_b64_tr_b16 a[232:233], v5 offset:2048
    v_accvgpr_read_b32 v109, a37
    v_accvgpr_read_b32 v105, a33
    v_accvgpr_read_b32 v108, a36
    v_accvgpr_read_b32 v104, a32
    v_pk_mul_f32 v[104:105], v[104:105], v[8:9] op_sel_hi:[1,0]
    v_pk_mul_f32 v[106:107], v[106:107], v[8:9] op_sel_hi:[1,0]
    v_xor_b32 v101, 96, v101
    v_cvt_pk_bf16_f32 v156, v156, v157
    v_pk_mul_f32 v[108:109], v[108:109], v[8:9] op_sel_hi:[1,0]
    v_pk_mul_f32 v[110:111], v[110:111], v[8:9] op_sel_hi:[1,0]
    v_cvt_pk_bf16_f32 v108, v108, v109
    v_cvt_pk_bf16_f32 v104, v104, v105
    v_mfma_f32_16x16x32_bf16 v[184:187], a[212:215], v[20:23], 0
    ds_write2st64_b64 v101, v[144:145], v[192:193] offset0:8 offset1:20
    v_cvt_pk_bf16_f32 v105, v106, v107
    v_cvt_pk_bf16_f32 v109, v110, v111
    v_mfma_f32_16x16x32_bf16 v[136:139], a[212:215], v[14:17], 0
    ds_write2st64_b64 v101, v[240:241], v[104:105] offset0:32 offset1:44
    v_xor_b32 v101, 32, v101
    v_mfma_f32_16x16x32_bf16 v[140:143], a[216:219], v[14:17], 0
    ds_write2st64_b64 v101, v[148:149], v[196:197] offset0:8 offset1:20
    v_mfma_f32_16x16x32_bf16 v[144:147], a[220:223], v[14:17], 0
    s_waitcnt vmcnt(9) lgkmcnt(3)
    ds_write2st64_b64 v101, v[244:245], v[108:109] offset0:32 offset1:44
    v_mfma_f32_16x16x32_bf16 v[148:151], a[224:227], v[14:17], 0
    v_accvgpr_read_b32 v104, a40
    v_accvgpr_read_b32 v110, a46
    v_mfma_f32_16x16x32_bf16 v[196:199], a[224:227], v[20:23], 0
    s_barrier
    v_mfma_f32_16x16x32_bf16 v[192:195], a[220:223], v[20:23], 0
    v_cvt_pk_bf16_f32 v205, v206, v207
    v_cvt_pk_bf16_f32 v201, v202, v203
    v_accvgpr_read_b32 v105, a41
    v_accvgpr_read_b32 v111, a47
    v_mfma_f32_16x16x32_bf16 v[240:243], a[220:223], v[26:29], 0
    ds_read_b128 a[216:219], v1 offset:0
    v_cvt_pk_bf16_f32 v19, v54, v55
    v_mfma_f32_16x16x32_bf16 v[244:247], a[224:227], v[26:29], 0
    v_cvt_pk_bf16_f32 v253, v254, v255
    v_accvgpr_read_b32 v106, a42
    v_mfma_f32_16x16x32_bf16 a[36:39], a[224:227], v[32:35], 0
    s_add_u32 m0, s22, 24576
    v_accvgpr_read_b32 v107, a43
    v_accvgpr_read_b32 v109, a45
    v_mfma_f32_16x16x32_bf16 a[32:35], a[220:223], v[32:35], 0
    ds_read_b128 a[212:215], v0 offset:0
    v_fma_f32 v72, v72, s28, v11
    v_mfma_f32_16x16x32_bf16 a[80:83], a[220:223], v[38:41], 0
    buffer_store_dwordx4 v[96:99], v7, s[16:19], s67 offen offset:0 nt
    ds_read_b128 a[220:223], v0 offset:1024
    v_accvgpr_read_b32 v108, a44
    v_pk_mul_f32 v[104:105], v[104:105], v[8:9] op_sel_hi:[1,0]
    v_pk_mul_f32 v[108:109], v[108:109], v[8:9] op_sel_hi:[1,0]
    v_pk_mul_f32 v[110:111], v[110:111], v[8:9] op_sel_hi:[1,0]
    v_exp_f32 v62, v62
    v_pk_mul_f32 v[106:107], v[106:107], v[8:9] op_sel_hi:[1,0]
    v_cvt_pk_bf16_f32 v104, v104, v105
    v_cvt_pk_bf16_f32 v108, v108, v109
    v_mfma_f32_16x16x32_bf16 a[84:87], a[224:227], v[38:41], 0
    v_xor_b32 v101, 96, v101
    v_cvt_pk_bf16_f32 v109, v110, v111
    v_cvt_pk_bf16_f32 v105, v106, v107
    v_mfma_f32_16x16x32_bf16 a[88:91], a[228:231], v[38:41], 0
    ds_write2st64_b64 v101, v[152:153], v[200:201] offset0:8 offset1:20
    v_mfma_f32_16x16x32_bf16 a[92:95], a[232:235], v[38:41], 0
    ds_write2st64_b64 v101, v[248:249], v[104:105] offset0:32 offset1:44
    v_mfma_f32_16x16x32_bf16 a[44:47], a[232:235], v[32:35], 0
    v_cvt_pk_bf16_f32 v157, v158, v159
    v_xor_b32 v101, 32, v101
    v_mfma_f32_16x16x32_bf16 a[40:43], a[228:231], v[32:35], 0
    ds_write2st64_b64 v101, v[156:157], v[204:205] offset0:8 offset1:20
    v_fma_f32 v58, v58, s28, v9
    v_mfma_f32_16x16x32_bf16 v[248:251], a[228:231], v[26:29], 0
    ds_write2st64_b64 v101, v[252:253], v[108:109] offset0:32 offset1:44
    v_mfma_f32_16x16x32_bf16 v[252:255], a[232:235], v[26:29], 0
    v_exp_f32 v85, v85
    v_mfma_f32_16x16x32_bf16 v[204:207], a[232:235], v[20:23], 0
    v_exp_f32 v63, v63
    v_mfma_f32_16x16x32_bf16 v[200:203], a[228:231], v[20:23], 0
    buffer_load_dwordx4 v6, s[8:11], s21 offen lds
    v_mfma_f32_16x16x32_bf16 v[152:155], a[228:231], v[14:17], 0
    v_cvt_pk_bf16_f32 v25, v62, v63
    v_fma_f32 v81, v81, s28, v12
    v_mfma_f32_16x16x32_bf16 v[156:159], a[232:235], v[14:17], 0
    s_waitcnt lgkmcnt(2)
    ds_read_b128 v[96:99], v103 offset:2048
    v_fma_f32 v65, v65, s28, v10
    v_mfma_f32_16x16x32_bf16 v[52:55], a[212:215], a[96:99], 0
    ds_read_b128 a[232:235], v1 offset:2048
    v_cvt_pk_bf16_f32 v36, v76, v77
    v_mfma_f32_16x16x32_bf16 v[52:55], a[216:219], a[100:103], v[52:55]
    s_add_u32 s21, s21, 128
    v_exp_f32 v80, v80
    v_mfma_f32_16x16x32_bf16 v[52:55], a[220:223], a[104:107], v[52:55]
    v_cvt_pk_bf16_f32 v43, v86, v87
    v_cvt_pk_bf16_f32 v42, v84, v85
    v_mfma_f32_16x16x32_bf16 v[60:63], a[220:223], a[128:131], 0
    ds_read_b128 a[224:227], v1 offset:1024
    v_fma_f32 v57, v57, s28, v9
    v_mfma_f32_16x16x32_bf16 v[60:63], a[216:219], a[124:127], v[60:63]
    v_exp_f32 v81, v81
    v_mfma_f32_16x16x32_bf16 v[60:63], a[212:215], a[120:123], v[60:63]
    s_add_u32 m0, s22, 25600
    ds_read_b128 a[228:231], v0 offset:2048
    v_cvt_pk_bf16_f32 v37, v78, v79
    v_mfma_f32_16x16x32_bf16 v[68:71], a[212:215], a[144:147], 0
    v_exp_f32 v65, v65
    v_mfma_f32_16x16x32_bf16 v[68:71], a[216:219], a[148:151], v[68:71]
    v_exp_f32 v64, v64
    v_mfma_f32_16x16x32_bf16 v[68:71], a[220:223], a[152:155], v[68:71]
    buffer_load_dwordx4 v6, s[8:11], s21 offen lds
    v_mfma_f32_16x16x32_bf16 v[76:79], a[220:223], a[176:179], 0
    v_exp_f32 v58, v58
    v_mfma_f32_16x16x32_bf16 v[76:79], a[216:219], a[172:175], v[76:79]
    s_add_u32 s21, s21, 128
    v_exp_f32 v74, v74
    v_mfma_f32_16x16x32_bf16 v[76:79], a[212:215], a[168:171], v[76:79]
    s_add_u32 m0, s22, 26624
    v_exp_f32 v72, v72
    v_mfma_f32_16x16x32_bf16 v[84:87], a[212:215], a[192:195], 0
    v_exp_f32 v91, v91
    v_mfma_f32_16x16x32_bf16 v[84:87], a[216:219], a[196:199], v[84:87]
    buffer_load_dwordx4 v6, s[8:11], s21 offen lds
    v_mfma_f32_16x16x32_bf16 v[84:87], a[220:223], a[200:203], v[84:87]
    s_waitcnt lgkmcnt(1)
    v_exp_f32 v82, v82
    v_mfma_f32_16x16x32_bf16 v[84:87], a[224:227], a[204:207], v[84:87]
    s_waitcnt lgkmcnt(0)
    v_exp_f32 v57, v57
    v_mfma_f32_16x16x32_bf16 v[84:87], a[228:231], a[208:211], v[84:87]
    s_add_u32 s21, s21, 12032
    v_exp_f32 v73, v73
    v_fma_f32 v59, v59, s28, v9
    v_mfma_f32_16x16x32_bf16 v[84:87], a[232:235], v[92:95], v[84:87]
    s_add_u32 s56, s67, 128
    v_cvt_pk_bf16_f32 v34, v80, v81
    v_mfma_f32_16x16x32_bf16 v[76:79], a[232:235], a[188:191], v[76:79]
    v_exp_f32 v75, v75
    v_cvt_pk_bf16_f32 v28, v72, v73
    v_mfma_f32_16x16x32_bf16 v[76:79], a[228:231], a[184:187], v[76:79]
    v_cvt_pk_bf16_f32 v22, v64, v65
    v_mfma_f32_16x16x32_bf16 v[76:79], a[224:227], a[180:183], v[76:79]
    s_add_u32 s58, s33, 128
    v_exp_f32 v67, v67
    v_mfma_f32_16x16x32_bf16 v[68:71], a[224:227], a[156:159], v[68:71]
    ds_read_b128 a[216:219], v1 offset:6144
    v_mfma_f32_16x16x32_bf16 v[68:71], a[228:231], a[160:163], v[68:71]
    v_exp_f32 v59, v59
    v_mfma_f32_16x16x32_bf16 v[68:71], a[232:235], a[164:167], v[68:71]
    ds_read_b128 a[212:215], v0 offset:6144
    v_cvt_pk_bf16_f32 v16, v56, v57
    v_mfma_f32_16x16x32_bf16 v[60:63], a[232:235], a[140:143], v[60:63]
    buffer_store_dwordx4 v[96:99], v6, s[16:19], s56 offen offset:0 nt
    v_exp_f32 v89, v89
    v_cvt_pk_bf16_f32 v17, v58, v59
    v_mfma_f32_16x16x32_bf16 v[60:63], a[228:231], a[136:139], v[60:63]
    s_nop 0
    v_mfma_f32_16x16x32_bf16 v[48:51], a[236:239], v[16:19], v[44:47]
    ds_read_b128 a[220:223], v0 offset:7168
    v_cvt_pk_bf16_f32 v35, v82, v83
    v_mfma_f32_16x16x32_bf16 v[60:63], a[224:227], a[132:135], v[60:63]
    v_cvt_pk_bf16_f32 v23, v66, v67
    s_add_u32 m0, s38, 2048
    v_mfma_f32_16x16x32_bf16 v[52:55], a[224:227], a[108:111], v[52:55]
    v_cvt_pk_bf16_f32 v29, v74, v75
    v_cvt_pk_bf16_f32 v40, v88, v89
    v_mfma_f32_16x16x32_bf16 v[48:51], a[240:243], v[22:25], v[48:51]
    v_cvt_pk_bf16_f32 v41, v90, v91
    v_mfma_f32_16x16x32_bf16 v[48:51], a[244:247], v[28:31], v[48:51]
    buffer_load_dwordx4 v6, s[12:15], s58 offen nt lds
    v_mfma_f32_16x16x32_bf16 v[52:55], a[228:231], a[112:115], v[52:55]
    ds_read_b128 v[96:99], v103 offset:3072
    v_mfma_f32_16x16x32_bf16 v[48:51], a[248:251], v[34:37], v[48:51]
    v_mfma_f32_16x16x32_bf16 v[48:51], a[252:255], v[40:43], v[48:51]
    s_add_u32 m0, s38, 3072
    ds_read_b128 a[228:231], v0 offset:8192
    v_mfma_f32_16x16x32_bf16 v[52:55], a[232:235], a[116:119], v[52:55]
    s_waitcnt lgkmcnt(3)
    ds_read_b128 a[224:227], v1 offset:7168
    v_mfma_f32_16x16x32_bf16 v[56:59], a[212:215], a[96:99], 0
    s_nop 1
    v_cmp_lt_f32 vcc, s29, v48
    v_mfma_f32_16x16x32_bf16 v[56:59], a[216:219], a[100:103], v[56:59]
    s_waitcnt lgkmcnt(3)
    ds_read_b128 a[232:235], v1 offset:8192
    v_mfma_f32_16x16x32_bf16 v[56:59], a[220:223], a[104:107], v[56:59]
    s_nop 0
    s_cbranch_vccnz L_rs_tr45d
L_ret_tr45d:
    v_mfma_f32_16x16x32_bf16 v[64:67], a[220:223], a[128:131], 0
    v_fma_f32 v53, v53, s28, v9
    v_add_u32 v103, 4096, v103
    v_mfma_f32_16x16x32_bf16 v[64:67], a[216:219], a[124:127], v[64:67]
    v_fma_f32 v54, v54, s28, v9
    v_fma_f32 v61, v61, s28, v10
    v_mfma_f32_16x16x32_bf16 v[64:67], a[212:215], a[120:123], v[64:67]
    v_fma_f32 v63, v63, s28, v10
    v_mfma_f32_16x16x32_bf16 v[72:75], a[212:215], a[144:147], 0
    v_exp_f32 v61, v61
    v_mfma_f32_16x16x32_bf16 v[72:75], a[216:219], a[148:151], v[72:75]
    v_exp_f32 v53, v53
    v_mfma_f32_16x16x32_bf16 v[72:75], a[220:223], a[152:155], v[72:75]
    v_fma_f32 v62, v62, s28, v10
    v_mfma_f32_16x16x32_bf16 v[80:83], a[220:223], a[176:179], 0
    s_waitcnt lgkmcnt(1)
    buffer_load_dwordx4 v7, s[12:15], s58 offen nt lds
    v_mfma_f32_16x16x32_bf16 v[80:83], a[216:219], a[172:175], v[80:83]
    v_exp_f32 v54, v54
    v_mfma_f32_16x16x32_bf16 v[80:83], a[212:215], a[168:171], v[80:83]
    s_waitcnt vmcnt(13) lgkmcnt(0)
    v_exp_f32 v63, v63
    v_mfma_f32_16x16x32_bf16 v[88:91], a[212:215], a[192:195], 0
    buffer_store_dwordx4 v[96:99], v7, s[16:19], s56 offen offset:0 nt
    s_barrier
    v_mfma_f32_16x16x32_bf16 v[88:91], a[216:219], a[196:199], v[88:91]
    s_add_u32 m0, s22, 0
    ds_read_b64_tr_b16 a[212:213], v2 offset:18432
    v_mfma_f32_16x16x32_bf16 v[88:91], a[220:223], a[200:203], v[88:91]
    ds_read_b64_tr_b16 a[214:215], v2 offset:12288
    v_fma_f32 v52, v52, s28, v9
    v_mfma_f32_16x16x32_bf16 v[88:91], a[224:227], a[204:207], v[88:91]
    v_exp_f32 v62, v62
    v_mfma_f32_16x16x32_bf16 v[88:91], a[228:231], a[208:211], v[88:91]
    buffer_load_dwordx4 v6, s[4:7], s20 offen lds
    v_mfma_f32_16x16x32_bf16 v[88:91], a[232:235], v[92:95], v[88:91]
    s_add_u32 s20, s20, 128
    ds_read_b64_tr_b16 a[216:217], v3 offset:18432
    v_mfma_f32_16x16x32_bf16 v[80:83], a[232:235], a[188:191], v[80:83]
    s_add_u32 m0, s22, 1024
    ds_read_b64_tr_b16 a[218:219], v3 offset:12288
    v_cvt_pk_bf16_f32 v21, v62, v63
    v_mfma_f32_16x16x32_bf16 v[80:83], a[228:231], a[184:187], v[80:83]
    v_exp_f32 v52, v52
    v_mfma_f32_16x16x32_bf16 v[80:83], a[224:227], a[180:183], v[80:83]
    buffer_load_dwordx4 v6, s[4:7], s20 offen lds
    v_mfma_f32_16x16x32_bf16 v[72:75], a[224:227], a[156:159], v[72:75]
    s_add_u32 s20, s20, 128
    ds_read_b64_tr_b16 a[220:221], v4 offset:18432
    v_mfma_f32_16x16x32_bf16 v[72:75], a[228:231], a[160:163], v[72:75]
    v_fma_f32 v55, v55, s28, v9
    v_mfma_f32_16x16x32_bf16 v[72:75], a[232:235], a[164:167], v[72:75]
    v_cvt_pk_bf16_f32 v14, v52, v53
    v_mfma_f32_16x16x32_bf16 v[64:67], a[232:235], a[140:143], v[64:67]
    s_add_u32 m0, s22, 2048
    ds_read_b64_tr_b16 a[222:223], v4 offset:12288
    v_fma_f32 v60, v60, s28, v10
    v_mfma_f32_16x16x32_bf16 v[64:67], a[228:231], a[136:139], v[64:67]
    buffer_load_dwordx4 v6, s[4:7], s20 offen lds
    v_mfma_f32_16x16x32_bf16 v[64:67], a[224:227], a[132:135], v[64:67]
    v_exp_f32 v55, v55
    v_mfma_f32_16x16x32_bf16 v[56:59], a[224:227], a[108:111], v[56:59]
    v_exp_f32 v60, v60
    v_mfma_f32_16x16x32_bf16 v[56:59], a[228:231], a[112:115], v[56:59]
    s_add_u32 s20, s20, 12032
    ds_read_b64_tr_b16 a[224:225], v5 offset:18432
    v_cvt_pk_bf16_f32 v15, v54, v55
    v_mfma_f32_16x16x32_bf16 v[56:59], a[232:235], a[116:119], v[56:59]
    s_waitcnt lgkmcnt(3)
    ds_read_b64_tr_b16 a[226:227], v5 offset:12288
    v_cvt_pk_bf16_f32 v20, v60, v61
    s_branch L_loop5
L_tr44:
    v_mfma_f32_16x16x32_bf16 v[112:115], a[212:215], v[16:19], v[112:115]
    ds_read_b64_tr_b16 a[234:235], v3 offset:13312
    v_mfma_f32_16x16x32_bf16 v[160:163], a[212:215], v[22:25], v[160:163]
    ds_read_b64_tr_b16 a[228:229], v2 offset:19456
    v_fma_f32 v78, v78, s28, v12
    v_fma_f32 v69, v69, s28, v11
    v_mfma_f32_16x16x32_bf16 v[208:211], a[212:215], v[28:31], v[208:211]
    ds_read_b64_tr_b16 a[232:233], v3 offset:19456
    v_fma_f32 v58, v58, s28, v9
    v_mfma_f32_16x16x32_bf16 a[0:3], a[212:215], v[34:37], a[0:3]
    s_waitcnt lgkmcnt(7)
    v_mfma_f32_16x16x32_bf16 a[4:7], a[216:219], v[34:37], a[4:7]
    ds_read_b64_tr_b16 a[230:231], v2 offset:13312
    v_fma_f32 v57, v57, s28, v9
    v_mfma_f32_16x16x32_bf16 v[212:215], a[216:219], v[28:31], v[212:215]
    v_fma_f32 v59, v59, s28, v9
    v_fma_f32 v73, v73, s28, v11
    v_mfma_f32_16x16x32_bf16 v[164:167], a[216:219], v[22:25], v[164:167]
    v_exp_f32 v57, v57
    v_mfma_f32_16x16x32_bf16 v[116:119], a[216:219], v[16:19], v[116:119]
    ds_read_b64_tr_b16 a[212:213], v4 offset:19456
    s_waitcnt lgkmcnt(7)
    v_mfma_f32_16x16x32_bf16 v[120:123], a[220:223], v[16:19], v[120:123]
    v_exp_f32 v59, v59
    v_mfma_f32_16x16x32_bf16 v[168:171], a[220:223], v[22:25], v[168:171]
    ds_read_b64_tr_b16 a[218:219], v5 offset:13312
    v_fma_f32 v82, v82, s28, v12
    v_mfma_f32_16x16x32_bf16 v[216:219], a[220:223], v[28:31], v[216:219]
    ds_read_b64_tr_b16 a[214:215], v4 offset:13312
    v_fma_f32 v70, v70, s28, v11
    v_mfma_f32_16x16x32_bf16 a[8:11], a[220:223], v[34:37], a[8:11]
    s_waitcnt lgkmcnt(5)
    v_exp_f32 v78, v78
    v_mfma_f32_16x16x32_bf16 a[12:15], a[224:227], v[34:37], a[12:15]
    ds_read_b64_tr_b16 a[216:217], v5 offset:19456
    s_add_u32 s39, s39, 12288
    v_mfma_f32_16x16x32_bf16 v[220:223], a[224:227], v[28:31], v[220:223]
    ds_read_b64_tr_b16 a[222:223], v2 offset:14336
    v_fma_f32 v79, v79, s28, v12
    v_mfma_f32_16x16x32_bf16 v[172:175], a[224:227], v[22:25], v[172:175]
    ds_read_b64_tr_b16 a[220:221], v2 offset:20480
    v_fma_f32 v66, v66, s28, v10
    v_mfma_f32_16x16x32_bf16 v[124:127], a[224:227], v[16:19], v[124:127]
    s_waitcnt lgkmcnt(6)
    v_fma_f32 v67, v67, s28, v10
    v_fma_f32 v63, v63, s28, v10
    v_mfma_f32_16x16x32_bf16 v[128:131], a[228:231], v[16:19], v[128:131]
    v_exp_f32 v69, v69
    v_mfma_f32_16x16x32_bf16 v[176:179], a[228:231], v[22:25], v[176:179]
    ds_read_b64_tr_b16 a[226:227], v3 offset:14336
    v_mfma_f32_16x16x32_bf16 v[224:227], a[228:231], v[28:31], v[224:227]
    ds_read_b64_tr_b16 a[224:225], v3 offset:20480
    v_fma_f32 v62, v62, s28, v10
    v_mfma_f32_16x16x32_bf16 a[16:19], a[228:231], v[34:37], a[16:19]
    ds_read_b64_tr_b16 a[230:231], v4 offset:14336
    v_fma_f32 v65, v65, s28, v10
    v_mfma_f32_16x16x32_bf16 a[20:23], a[232:235], v[34:37], a[20:23]
    v_fma_f32 v56, v56, s28, v9
    v_fma_f32 v77, v77, s28, v12
    v_mfma_f32_16x16x32_bf16 v[228:231], a[232:235], v[28:31], v[228:231]
    ds_read_b64_tr_b16 a[228:229], v4 offset:20480
    v_mfma_f32_16x16x32_bf16 v[180:183], a[232:235], v[22:25], v[180:183]
    v_exp_f32 v79, v79
    v_mfma_f32_16x16x32_bf16 v[132:135], a[232:235], v[16:19], v[132:135]
    s_waitcnt lgkmcnt(5)
    ds_read_b64_tr_b16 a[232:233], v5 offset:20480
    v_mfma_f32_16x16x32_bf16 v[136:139], a[212:215], v[16:19], v[136:139]
    ds_read_b64_tr_b16 a[234:235], v5 offset:14336
    v_fma_f32 v68, v68, s28, v11
    v_mfma_f32_16x16x32_bf16 v[184:187], a[212:215], v[22:25], v[184:187]
    v_exp_f32 v63, v63
    v_mfma_f32_16x16x32_bf16 v[232:235], a[212:215], v[28:31], v[232:235]
    v_fma_f32 v80, v80, s28, v12
    v_fma_f32 v76, v76, s28, v12
    v_mfma_f32_16x16x32_bf16 a[24:27], a[212:215], v[34:37], a[24:27]
    v_fma_f32 v75, v75, s28, v11
    v_mfma_f32_16x16x32_bf16 a[28:31], a[216:219], v[34:37], a[28:31]
    v_exp_f32 v77, v77
    v_mfma_f32_16x16x32_bf16 v[236:239], a[216:219], v[28:31], v[236:239]
    v_exp_f32 v76, v76
    v_mfma_f32_16x16x32_bf16 v[188:191], a[216:219], v[22:25], v[188:191]
    v_exp_f32 v58, v58
    v_mfma_f32_16x16x32_bf16 v[140:143], a[216:219], v[16:19], v[140:143]
    s_waitcnt lgkmcnt(2)
    v_exp_f32 v62, v62
    v_mfma_f32_16x16x32_bf16 v[144:147], a[220:223], v[16:19], v[144:147]
    v_cvt_pk_bf16_f32 v21, v62, v63
    v_mfma_f32_16x16x32_bf16 v[192:195], a[220:223], v[22:25], v[192:195]
    v_exp_f32 v68, v68
    v_mfma_f32_16x16x32_bf16 v[240:243], a[220:223], v[28:31], v[240:243]
    s_waitcnt vmcnt(10) lgkmcnt(0)
    v_exp_f32 v65, v65
    v_mfma_f32_16x16x32_bf16 a[32:35], a[220:223], v[34:37], a[32:35]
    s_barrier
    v_mfma_f32_16x16x32_bf16 a[36:39], a[224:227], v[34:37], a[36:39]
    s_add_u32 m0, s22, 36864
    ds_read_b128 a[216:219], v1 offset:12288
    v_fma_f32 v83, v83, s28, v12
    v_mfma_f32_16x16x32_bf16 v[244:247], a[224:227], v[28:31], v[244:247]
    ds_read_b128 a[212:215], v0 offset:12288
    v_fma_f32 v64, v64, s28, v10
    v_mfma_f32_16x16x32_bf16 v[196:199], a[224:227], v[22:25], v[196:199]
    buffer_load_dwordx4 v6, s[8:11], s21 offen lds
    v_mfma_f32_16x16x32_bf16 v[148:151], a[224:227], v[16:19], v[148:151]
    s_add_u32 s21, s21, 128
    ds_read_b128 a[220:223], v0 offset:13312
    v_fma_f32 v71, v71, s28, v11
    v_mfma_f32_16x16x32_bf16 v[152:155], a[228:231], v[16:19], v[152:155]
    s_add_u32 m0, s22, 37888
    ds_read_b128 v[84:87], v103 offset:0
    v_fma_f32 v81, v81, s28, v12
    v_mfma_f32_16x16x32_bf16 v[200:203], a[228:231], v[22:25], v[200:203]
    buffer_load_dwordx4 v6, s[8:11], s21 offen lds
    v_mfma_f32_16x16x32_bf16 v[248:251], a[228:231], v[28:31], v[248:251]
    ds_read_b128 a[224:227], v1 offset:13312
    v_mfma_f32_16x16x32_bf16 a[40:43], a[228:231], v[34:37], a[40:43]
    s_add_u32 s21, s21, 128
    v_fma_f32 v74, v74, s28, v11
    v_mfma_f32_16x16x32_bf16 a[44:47], a[232:235], v[34:37], a[44:47]
    v_exp_f32 v75, v75
    v_mfma_f32_16x16x32_bf16 v[252:255], a[232:235], v[28:31], v[252:255]
    s_add_u32 m0, s22, 38912
    v_exp_f32 v70, v70
    v_mfma_f32_16x16x32_bf16 v[204:207], a[232:235], v[22:25], v[204:207]
    buffer_load_dwordx4 v6, s[8:11], s21 offen lds
    v_mfma_f32_16x16x32_bf16 v[156:159], a[232:235], v[16:19], v[156:159]
    s_waitcnt lgkmcnt(3)
    v_exp_f32 v71, v71
    v_mfma_f32_16x16x32_bf16 v[52:55], a[212:215], a[96:99], 0
    ds_read_b128 a[228:231], v0 offset:14336
    v_cvt_pk_bf16_f32 v32, v76, v77
    v_mfma_f32_16x16x32_bf16 v[52:55], a[216:219], a[100:103], v[52:55]
    s_waitcnt lgkmcnt(3)
    v_exp_f32 v82, v82
    v_mfma_f32_16x16x32_bf16 v[52:55], a[220:223], a[104:107], v[52:55]
    ds_read_b128 a[232:235], v1 offset:14336
    v_fma_f32 v72, v72, s28, v11
    v_mfma_f32_16x16x32_bf16 v[60:63], a[220:223], a[128:131], 0
    s_add_u32 s21, s21, 12032
    v_cvt_pk_bf16_f32 v27, v70, v71
    v_cvt_pk_bf16_f32 v26, v68, v69
    v_mfma_f32_16x16x32_bf16 v[60:63], a[216:219], a[124:127], v[60:63]
    s_add_u32 s57, s24, 128
    ds_read_b128 v[96:99], v103 offset:2048
    v_cvt_pk_bf16_f32 v33, v78, v79
    v_mfma_f32_16x16x32_bf16 v[60:63], a[212:215], a[120:123], v[60:63]
    v_exp_f32 v64, v64
    v_mfma_f32_16x16x32_bf16 v[68:71], a[212:215], a[144:147], 0
    v_exp_f32 v80, v80
    v_mfma_f32_16x16x32_bf16 v[68:71], a[216:219], a[148:151], v[68:71]
    v_exp_f32 v83, v83
    v_mfma_f32_16x16x32_bf16 v[68:71], a[220:223], a[152:155], v[68:71]
    v_exp_f32 v67, v67
    v_mfma_f32_16x16x32_bf16 v[76:79], a[220:223], a[176:179], 0
    v_exp_f32 v66, v66
    v_mfma_f32_16x16x32_bf16 v[76:79], a[216:219], a[172:175], v[76:79]
    v_exp_f32 v74, v74
    v_mfma_f32_16x16x32_bf16 v[76:79], a[212:215], a[168:171], v[76:79]
    s_waitcnt lgkmcnt(2)
    v_exp_f32 v72, v72
    v_mfma_f32_16x16x32_bf16 v[76:79], a[224:227], a[180:183], v[76:79]
    v_mfma_f32_16x16x32_bf16 v[76:79], a[228:231], a[184:187], v[76:79]
    s_waitcnt lgkmcnt(1)
    ds_read_b128 a[220:223], v0 offset:19456
    v_mfma_f32_16x16x32_bf16 v[76:79], a[232:235], a[188:191], v[76:79]
    v_exp_f32 v73, v73
    v_mfma_f32_16x16x32_bf16 v[68:71], a[232:235], a[164:167], v[68:71]
    ds_read_b128 a[212:215], v0 offset:18432
    v_cvt_pk_bf16_f32 v22, v64, v65
    v_mfma_f32_16x16x32_bf16 v[68:71], a[228:231], a[160:163], v[68:71]
    v_exp_f32 v56, v56
    v_mfma_f32_16x16x32_bf16 v[68:71], a[224:227], a[156:159], v[68:71]
    ds_read_b128 a[216:219], v1 offset:18432
    v_cvt_pk_bf16_f32 v17, v58, v59
    v_mfma_f32_16x16x32_bf16 v[60:63], a[224:227], a[132:135], v[60:63]
    ds_read_b128 v[88:91], v103 offset:1024
    v_cvt_pk_bf16_f32 v16, v56, v57
    v_mfma_f32_16x16x32_bf16 v[60:63], a[228:231], a[136:139], v[60:63]
    v_cvt_pk_bf16_f32 v28, v72, v73
    v_mfma_f32_16x16x32_bf16 v[60:63], a[232:235], a[140:143], v[60:63]
    v_exp_f32 v81, v81
    v_mfma_f32_16x16x32_bf16 v[52:55], a[232:235], a[116:119], v[52:55]
    ds_read_b128 a[232:235], v1 offset:20480
    v_cvt_pk_bf16_f32 v23, v66, v67
    v_mfma_f32_16x16x32_bf16 v[44:47], a[236:239], v[14:17], v[48:51]
    v_mfma_f32_16x16x32_bf16 v[52:55], a[228:231], a[112:115], v[52:55]
    v_cvt_pk_bf16_f32 v29, v74, v75
    v_cvt_pk_bf16_f32 v35, v82, v83
    v_mfma_f32_16x16x32_bf16 v[44:47], a[240:243], v[20:23], v[44:47]
    v_cvt_pk_bf16_f32 v34, v80, v81
    v_mfma_f32_16x16x32_bf16 v[52:55], a[224:227], a[108:111], v[52:55]
    ds_read_b128 a[228:231], v0 offset:20480
    v_mfma_f32_16x16x32_bf16 v[44:47], a[244:247], v[26:29], v[44:47]
    ds_read_b128 a[224:227], v1 offset:19456
    v_mfma_f32_16x16x32_bf16 v[44:47], a[248:251], v[32:35], v[44:47]
    buffer_store_dwordx4 v[84:87], v6, s[16:19], s24 offen offset:0 nt
    s_nop 0
    ds_read_b128 v[84:87], v103 offset:3072
    s_waitcnt lgkmcnt(4)
    v_mfma_f32_16x16x32_bf16 v[56:59], a[212:215], a[96:99], 0
    v_mfma_f32_16x16x32_bf16 v[56:59], a[216:219], a[100:103], v[56:59]
    s_nop 1
    v_cmp_lt_f32 vcc, s29, v44
    v_mfma_f32_16x16x32_bf16 v[56:59], a[220:223], a[104:107], v[56:59]
    buffer_store_dwordx4 v[88:91], v7, s[16:19], s24 offen offset:0 nt
    s_nop 2
    s_cbranch_vccnz L_rs_tr44a
L_ret_tr44a:
    v_mfma_f32_16x16x32_bf16 v[64:67], a[220:223], a[128:131], 0
    v_fma_f32 v54, v54, s28, v9
    v_fma_f32 v53, v53, s28, v9
    v_mfma_f32_16x16x32_bf16 v[64:67], a[216:219], a[124:127], v[64:67]
    v_exp_f32 v53, v53
    v_mfma_f32_16x16x32_bf16 v[64:67], a[212:215], a[120:123], v[64:67]
    v_fma_f32 v55, v55, s28, v9
    s_waitcnt vmcnt(8) lgkmcnt(1)
    v_mfma_f32_16x16x32_bf16 v[72:75], a[212:215], a[144:147], 0
    s_barrier
    v_mfma_f32_16x16x32_bf16 v[72:75], a[216:219], a[148:151], v[72:75]
    s_add_u32 m0, s22, 12288
    v_fma_f32 v61, v61, s28, v10
    v_fma_f32 v52, v52, s28, v9
    v_mfma_f32_16x16x32_bf16 v[72:75], a[220:223], a[152:155], v[72:75]
    buffer_load_dwordx4 v6, s[4:7], s20 offen lds
    v_mfma_f32_16x16x32_bf16 v[80:83], a[220:223], a[176:179], 0
    s_add_u32 s20, s20, 128
    v_exp_f32 v55, v55
    v_mfma_f32_16x16x32_bf16 v[80:83], a[216:219], a[172:175], v[80:83]
    s_add_u32 m0, s22, 13312
    v_exp_f32 v54, v54
    v_mfma_f32_16x16x32_bf16 v[80:83], a[212:215], a[168:171], v[80:83]
    buffer_load_dwordx4 v6, s[4:7], s20 offen lds
    v_mfma_f32_16x16x32_bf16 v[80:83], a[224:227], a[180:183], v[80:83]
    s_add_u32 s20, s20, 128
    v_exp_f32 v61, v61
    v_mfma_f32_16x16x32_bf16 v[80:83], a[228:231], a[184:187], v[80:83]
    ds_read_b64_tr_b16 a[212:213], v2 offset:0
    v_cvt_pk_bf16_f32 v19, v54, v55
    v_mfma_f32_16x16x32_bf16 v[80:83], a[232:235], a[188:191], v[80:83]
    s_add_u32 m0, s22, 14336
    ds_read_b64_tr_b16 a[214:215], v2 offset:6144
    v_mfma_f32_16x16x32_bf16 v[72:75], a[232:235], a[164:167], v[72:75]
    buffer_load_dwordx4 v6, s[4:7], s20 offen lds
    v_mfma_f32_16x16x32_bf16 v[72:75], a[228:231], a[160:163], v[72:75]
    ds_read_b64_tr_b16 a[216:217], v3 offset:0
    v_mfma_f32_16x16x32_bf16 v[72:75], a[224:227], a[156:159], v[72:75]
    buffer_store_dwordx4 v[96:99], v6, s[16:19], s57 offen offset:0 nt
    ds_read_b64_tr_b16 a[218:219], v3 offset:6144
    v_exp_f32 v52, v52
    v_mfma_f32_16x16x32_bf16 v[64:67], a[224:227], a[132:135], v[64:67]
    ds_read_b64_tr_b16 a[220:221], v4 offset:0
    v_fma_f32 v60, v60, s28, v10
    v_mfma_f32_16x16x32_bf16 v[64:67], a[228:231], a[136:139], v[64:67]
    v_mfma_f32_16x16x32_bf16 v[64:67], a[232:235], a[140:143], v[64:67]
    v_exp_f32 v60, v60
    v_mfma_f32_16x16x32_bf16 v[56:59], a[232:235], a[116:119], v[56:59]
    ds_read_b64_tr_b16 a[222:223], v4 offset:6144
    v_cvt_pk_bf16_f32 v24, v60, v61
    v_mfma_f32_16x16x32_bf16 v[56:59], a[228:231], a[112:115], v[56:59]
    s_add_u32 s20, s20, 12032
    s_waitcnt lgkmcnt(4)
    v_mfma_f32_16x16x32_bf16 v[56:59], a[224:227], a[108:111], v[56:59]
    buffer_store_dwordx4 v[84:87], v7, s[16:19], s57 offen offset:0 nt
    ds_read_b64_tr_b16 a[224:225], v5 offset:0
    ds_read_b64_tr_b16 a[226:227], v5 offset:6144
    v_cvt_pk_bf16_f32 v18, v52, v53
    v_lshrrev_b32 v105, 11, v0
    v_mfma_f32_16x16x32_bf16 v[112:115], a[212:215], v[14:17], v[112:115]
    v_xor_b32 v105, s65, v105
    v_fma_f32 v70, v70, s28, v11
    v_fma_f32 v73, v73, s28, v11
    v_mfma_f32_16x16x32_bf16 v[160:163], a[212:215], v[20:23], v[160:163]
    s_add_u32 s39, s39, 12288
    ds_read_b64_tr_b16 a[234:235], v3 offset:7168
    v_fma_f32 v68, v68, s28, v11
    v_fma_f32 v77, v77, s28, v12
    v_mfma_f32_16x16x32_bf16 v[208:211], a[212:215], v[26:29], v[208:211]
    ds_read_b64_tr_b16 a[228:229], v2 offset:1024
    v_fma_f32 v72, v72, s28, v11
    v_mfma_f32_16x16x32_bf16 a[0:3], a[212:215], v[32:35], a[0:3]
    s_waitcnt lgkmcnt(6)
    ds_read_b64_tr_b16 a[232:233], v3 offset:1024
    v_and_b32 v104, 0x3ff, v0
    v_mfma_f32_16x16x32_bf16 a[4:7], a[216:219], v[32:35], a[4:7]
    ds_read_b64_tr_b16 a[230:231], v2 offset:7168
    v_fma_f32 v76, v76, s28, v12
    v_mfma_f32_16x16x32_bf16 v[212:215], a[216:219], v[26:29], v[212:215]
    v_lshl_add_u32 v104, v105, 10, v104
    v_fma_f32 v62, v62, s28, v10
    v_mfma_f32_16x16x32_bf16 v[164:167], a[216:219], v[20:23], v[164:167]
    ds_read_b64_tr_b16 a[212:213], v4 offset:1024
    v_fma_f32 v81, v81, s28, v12
    v_mfma_f32_16x16x32_bf16 v[116:119], a[216:219], v[14:17], v[116:119]
    s_waitcnt lgkmcnt(7)
    v_exp_f32 v77, v77
    v_mfma_f32_16x16x32_bf16 v[120:123], a[220:223], v[14:17], v[120:123]
    v_exp_f32 v68, v68
    v_mfma_f32_16x16x32_bf16 v[168:171], a[220:223], v[20:23], v[168:171]
    ds_read_b64_tr_b16 a[218:219], v5 offset:7168
    v_add_u32 v104, s38, v104
    v_mfma_f32_16x16x32_bf16 v[216:219], a[220:223], v[26:29], v[216:219]
    ds_read_b64_tr_b16 a[214:215], v4 offset:7168
    v_fma_f32 v71, v71, s28, v11
    v_mfma_f32_16x16x32_bf16 a[8:11], a[220:223], v[32:35], a[8:11]
    s_waitcnt lgkmcnt(6)
    ds_read_b64_tr_b16 a[220:221], v2 offset:2048
    v_xor_b32 v105, 64, v104
    v_mfma_f32_16x16x32_bf16 a[12:15], a[224:227], v[32:35], a[12:15]
    ds_read_b128 a[100:103], v105 offset:0
    v_exp_f32 v72, v72
    v_mfma_f32_16x16x32_bf16 v[220:223], a[224:227], v[26:29], v[220:223]
    ds_read_b64_tr_b16 a[216:217], v5 offset:1024
    v_fma_f32 v79, v79, s28, v12
    v_mfma_f32_16x16x32_bf16 v[172:175], a[224:227], v[20:23], v[172:175]
    v_exp_f32 v79, v79
    v_mfma_f32_16x16x32_bf16 v[124:127], a[224:227], v[14:17], v[124:127]
    s_waitcnt lgkmcnt(6)
    v_exp_f32 v70, v70
    v_mfma_f32_16x16x32_bf16 v[128:131], a[228:231], v[14:17], v[128:131]
    ds_read_b64_tr_b16 a[222:223], v2 offset:8192
    v_exp_f32 v62, v62
    v_mfma_f32_16x16x32_bf16 v[176:179], a[228:231], v[20:23], v[176:179]
    ds_read_b64_tr_b16 a[224:225], v3 offset:2048
    v_fma_f32 v58, v58, s28, v9
    v_mfma_f32_16x16x32_bf16 v[224:227], a[228:231], v[26:29], v[224:227]
    ds_read_b64_tr_b16 a[226:227], v3 offset:8192
    v_fma_f32 v67, v67, s28, v10
    v_mfma_f32_16x16x32_bf16 a[16:19], a[228:231], v[32:35], a[16:19]
    ds_read_b64_tr_b16 a[228:229], v4 offset:2048
    v_fma_f32 v69, v69, s28, v11
    v_mfma_f32_16x16x32_bf16 a[20:23], a[232:235], v[32:35], a[20:23]
    ds_read_b64_tr_b16 a[230:231], v4 offset:8192
    v_fma_f32 v74, v74, s28, v11
    v_mfma_f32_16x16x32_bf16 v[228:231], a[232:235], v[26:29], v[228:231]
    ds_read_b128 a[160:163], v104 offset:16384
    v_fma_f32 v65, v65, s28, v10
    v_mfma_f32_16x16x32_bf16 v[180:183], a[232:235], v[20:23], v[180:183]
    v_exp_f32 v76, v76
    v_mfma_f32_16x16x32_bf16 v[132:135], a[232:235], v[14:17], v[132:135]
    s_waitcnt lgkmcnt(6)
    ds_read_b128 a[152:155], v104 offset:14336
    v_exp_f32 v81, v81
    v_mfma_f32_16x16x32_bf16 v[136:139], a[212:215], v[14:17], v[136:139]
    ds_read_b64_tr_b16 a[234:235], v5 offset:8192
    v_fma_f32 v57, v57, s28, v9
    v_mfma_f32_16x16x32_bf16 v[184:187], a[212:215], v[20:23], v[184:187]
    ds_read_b64_tr_b16 a[232:233], v5 offset:2048
    v_fma_f32 v78, v78, s28, v12
    v_mfma_f32_16x16x32_bf16 v[232:235], a[212:215], v[26:29], v[232:235]
    ds_read_b128 a[148:151], v105 offset:12288
    v_cvt_pk_bf16_f32 v36, v76, v77
    v_mfma_f32_16x16x32_bf16 a[24:27], a[212:215], v[32:35], a[24:27]
    ds_read_b128 a[176:179], v104 offset:20480
    v_exp_f32 v57, v57
    v_mfma_f32_16x16x32_bf16 a[28:31], a[216:219], v[32:35], a[28:31]
    v_exp_f32 v71, v71
    v_mfma_f32_16x16x32_bf16 v[236:239], a[216:219], v[26:29], v[236:239]
    ds_read_b128 a[124:127], v105 offset:6144
    v_exp_f32 v73, v73
    v_mfma_f32_16x16x32_bf16 v[188:191], a[216:219], v[20:23], v[188:191]
    ds_read_b128 a[172:175], v105 offset:18432
    v_cvt_pk_bf16_f32 v31, v70, v71
    v_mfma_f32_16x16x32_bf16 v[140:143], a[216:219], v[14:17], v[140:143]
    s_waitcnt lgkmcnt(7)
    ds_read_b128 a[144:147], v104 offset:12288
    v_exp_f32 v78, v78
    v_mfma_f32_16x16x32_bf16 v[144:147], a[220:223], v[14:17], v[144:147]
    ds_read_b128 a[120:123], v104 offset:6144
    v_fma_f32 v80, v80, s28, v12
    v_mfma_f32_16x16x32_bf16 v[192:195], a[220:223], v[20:23], v[192:195]
    ds_read_b128 a[168:171], v104 offset:18432
    v_fma_f32 v63, v63, s28, v10
    v_mfma_f32_16x16x32_bf16 v[240:243], a[220:223], v[26:29], v[240:243]
    s_waitcnt vmcnt(10) lgkmcnt(7)
    v_exp_f32 v69, v69
    v_mfma_f32_16x16x32_bf16 a[32:35], a[220:223], v[32:35], a[32:35]
    s_barrier
    v_mfma_f32_16x16x32_bf16 a[36:39], a[224:227], v[32:35], a[36:39]
    s_add_u32 s21, s21, s62
    ds_read_b128 a[108:111], v105 offset:2048
    v_fma_f32 v56, v56, s28, v9
    v_mfma_f32_16x16x32_bf16 v[244:247], a[224:227], v[26:29], v[244:247]
    s_add_u32 m0, s22, 24576
    ds_read_b128 a[212:215], v0 offset:0
    buffer_load_dwordx4 v6, s[8:11], s21 offen lds
    v_mfma_f32_16x16x32_bf16 v[196:199], a[224:227], v[20:23], v[196:199]
    s_add_u32 s21, s21, 128
    ds_read_b128 a[96:99], v104 offset:0
    v_fma_f32 v82, v82, s28, v12
    v_mfma_f32_16x16x32_bf16 v[148:151], a[224:227], v[14:17], v[148:151]
    s_add_u32 m0, s22, 25600
    ds_read_b128 a[104:107], v104 offset:2048
    buffer_load_dwordx4 v6, s[8:11], s21 offen lds
    v_mfma_f32_16x16x32_bf16 v[152:155], a[228:231], v[14:17], v[152:155]
    ds_read_b128 a[216:219], v1 offset:0
    v_fma_f32 v66, v66, s28, v10
    v_mfma_f32_16x16x32_bf16 v[200:203], a[228:231], v[20:23], v[200:203]
    s_add_u32 s21, s21, 128
    ds_read_b128 a[224:227], v1 offset:1024
    v_fma_f32 v64, v64, s28, v10
    v_mfma_f32_16x16x32_bf16 v[248:251], a[228:231], v[26:29], v[248:251]
    s_add_u32 m0, s22, 26624
    ds_read_b128 a[128:131], v104 offset:8192
    buffer_load_dwordx4 v6, s[8:11], s21 offen lds
    v_mfma_f32_16x16x32_bf16 a[40:43], a[228:231], v[32:35], a[40:43]
    v_exp_f32 v58, v58
    v_mfma_f32_16x16x32_bf16 a[44:47], a[232:235], v[32:35], a[44:47]
    v_exp_f32 v56, v56
    v_mfma_f32_16x16x32_bf16 v[252:255], a[232:235], v[26:29], v[252:255]
    ds_read_b128 a[220:223], v0 offset:1024
    v_exp_f32 v63, v63
    v_mfma_f32_16x16x32_bf16 v[204:207], a[232:235], v[20:23], v[204:207]
    ds_read_b128 a[180:183], v105 offset:20480
    v_fma_f32 v75, v75, s28, v11
    v_mfma_f32_16x16x32_bf16 v[156:159], a[232:235], v[14:17], v[156:159]
    s_waitcnt lgkmcnt(6)
    ds_read_b128 a[164:167], v105 offset:16384
    v_cvt_pk_bf16_f32 v25, v62, v63
    v_mfma_f32_16x16x32_bf16 v[52:55], a[212:215], a[96:99], 0
    ds_read_b128 a[156:159], v105 offset:14336
    v_cvt_pk_bf16_f32 v37, v78, v79
    v_mfma_f32_16x16x32_bf16 v[60:63], a[212:215], a[120:123], 0
    ds_read_b128 a[132:135], v105 offset:8192
    v_cvt_pk_bf16_f32 v30, v68, v69
    v_mfma_f32_16x16x32_bf16 v[68:71], a[212:215], a[144:147], 0
    v_exp_f32 v67, v67
    v_mfma_f32_16x16x32_bf16 v[76:79], a[212:215], a[168:171], 0
    s_waitcnt lgkmcnt(6)
    v_exp_f32 v74, v74
    v_mfma_f32_16x16x32_bf16 v[52:55], a[216:219], a[100:103], v[52:55]
    ds_read_b128 a[228:231], v0 offset:6144
    v_fma_f32 v59, v59, s28, v9
    v_mfma_f32_16x16x32_bf16 v[60:63], a[216:219], a[124:127], v[60:63]
    v_exp_f32 v65, v65
    v_mfma_f32_16x16x32_bf16 v[68:71], a[216:219], a[148:151], v[68:71]
    v_exp_f32 v66, v66
    v_mfma_f32_16x16x32_bf16 v[76:79], a[216:219], a[172:175], v[76:79]
    s_waitcnt lgkmcnt(5)
    v_exp_f32 v75, v75
    v_mfma_f32_16x16x32_bf16 v[52:55], a[220:223], a[104:107], v[52:55]
    v_exp_f32 v64, v64
    v_mfma_f32_16x16x32_bf16 v[60:63], a[220:223], a[128:131], v[60:63]
    ds_read_b128 a[232:235], v1 offset:6144
    v_cvt_pk_bf16_f32 v23, v66, v67
    v_mfma_f32_16x16x32_bf16 v[68:71], a[220:223], a[152:155], v[68:71]
    v_exp_f32 v59, v59
    v_mfma_f32_16x16x32_bf16 v[76:79], a[220:223], a[176:179], v[76:79]
    ds_read_b128 a[212:215], v0 offset:7168
    v_cvt_pk_bf16_f32 v16, v56, v57
    v_mfma_f32_16x16x32_bf16 v[52:55], a[224:227], a[108:111], v[52:55]
    s_waitcnt lgkmcnt(3)
    v_exp_f32 v82, v82
    v_mfma_f32_16x16x32_bf16 v[60:63], a[224:227], a[132:135], v[60:63]
    v_cvt_pk_bf16_f32 v22, v64, v65
    v_cvt_pk_bf16_f32 v28, v72, v73
    v_mfma_f32_16x16x32_bf16 v[68:71], a[224:227], a[156:159], v[68:71]
    v_cvt_pk_bf16_f32 v17, v58, v59
    v_fma_f32 v83, v83, s28, v12
    v_mfma_f32_16x16x32_bf16 v[76:79], a[224:227], a[180:183], v[76:79]
    s_waitcnt lgkmcnt(2)
    v_exp_f32 v80, v80
    v_mfma_f32_16x16x32_bf16 v[56:59], a[228:231], a[96:99], 0
    v_exp_f32 v83, v83
    v_mfma_f32_16x16x32_bf16 v[64:67], a[228:231], a[120:123], 0
    ds_read_b128 a[224:227], v1 offset:2048
    v_cvt_pk_bf16_f32 v29, v74, v75
    v_mfma_f32_16x16x32_bf16 v[48:51], a[236:239], v[16:19], v[44:47]
    ds_read_b128 a[216:219], v1 offset:7168
    v_cvt_pk_bf16_f32 v34, v80, v81
    v_mfma_f32_16x16x32_bf16 v[72:75], a[228:231], a[144:147], 0
    ds_read_b128 a[220:223], v0 offset:2048
    v_cvt_pk_bf16_f32 v35, v82, v83
    v_mfma_f32_16x16x32_bf16 v[80:83], a[228:231], a[168:171], 0
    s_waitcnt lgkmcnt(4)
    ds_read_b128 a[112:115], v104 offset:4096
    v_mfma_f32_16x16x32_bf16 v[56:59], a[232:235], a[100:103], v[56:59]
    ds_read_b128 a[228:231], v0 offset:8192
    v_mfma_f32_16x16x32_bf16 v[64:67], a[232:235], a[124:127], v[64:67]
    ds_read_b128 a[136:139], v104 offset:10240
    v_mfma_f32_16x16x32_bf16 v[72:75], a[232:235], a[148:151], v[72:75]
    v_mfma_f32_16x16x32_bf16 v[80:83], a[232:235], a[172:175], v[80:83]
    ds_read_b128 a[232:235], v1 offset:8192
    v_mfma_f32_16x16x32_bf16 v[48:51], a[240:243], v[22:25], v[48:51]
    ds_read_b128 a[116:119], v105 offset:4096
    v_mfma_f32_16x16x32_bf16 v[48:51], a[244:247], v[28:31], v[48:51]
    ds_read_b128 a[140:143], v105 offset:10240
    v_mfma_f32_16x16x32_bf16 v[48:51], a[248:251], v[34:37], v[48:51]
    s_waitcnt lgkmcnt(8)
    ds_read_b128 a[184:187], v104 offset:22528
    v_mfma_f32_16x16x32_bf16 v[56:59], a[212:215], a[104:107], v[56:59]
    v_mfma_f32_16x16x32_bf16 v[64:67], a[212:215], a[128:131], v[64:67]
    ds_read_b128 a[188:191], v105 offset:22528
    v_mfma_f32_16x16x32_bf16 v[72:75], a[212:215], a[152:155], v[72:75]
    s_nop 1
    v_cmp_lt_f32 vcc, s29, v48
    v_mfma_f32_16x16x32_bf16 v[80:83], a[212:215], a[176:179], v[80:83]
    s_waitcnt lgkmcnt(6)
    v_mfma_f32_16x16x32_bf16 v[56:59], a[216:219], a[108:111], v[56:59]
    s_add_u32 s21, s21, 12032
    v_mfma_f32_16x16x32_bf16 v[64:67], a[216:219], a[132:135], v[64:67]
    s_cbranch_vccnz L_rs_tr44b
L_ret_tr44b:
    s_waitcnt vmcnt(10) lgkmcnt(4)
    v_mfma_f32_16x16x32_bf16 v[72:75], a[216:219], a[156:159], v[72:75]
    s_barrier
    v_mfma_f32_16x16x32_bf16 v[80:83], a[216:219], a[180:183], v[80:83]
    s_add_u32 m0, s22, 0
    ds_read_b64_tr_b16 a[212:213], v2 offset:18432
    buffer_load_dwordx4 v6, s[4:7], s20 offen lds
    v_mfma_f32_16x16x32_bf16 v[52:55], a[220:223], a[112:115], v[52:55]
    s_add_u32 s20, s20, 128
    ds_read_b64_tr_b16 a[214:215], v2 offset:12288
    v_lshrrev_b32 v108, 11, v0
    v_mfma_f32_16x16x32_bf16 v[60:63], a[220:223], a[136:139], v[60:63]
    s_add_u32 m0, s22, 1024
    ds_read_b64_tr_b16 a[216:217], v3 offset:18432
    buffer_load_dwordx4 v6, s[4:7], s20 offen lds
    v_mfma_f32_16x16x32_bf16 v[68:71], a[220:223], a[160:163], v[68:71]
    s_waitcnt lgkmcnt(3)
    v_rcp_f32 v50, v50
    v_mfma_f32_16x16x32_bf16 v[76:79], a[220:223], a[184:187], v[76:79]
    s_add_u32 s20, s20, 128
    v_mov_b32 v100, v48
    v_xor_b32 v108, s65, v108
    v_mfma_f32_16x16x32_bf16 v[52:55], a[224:227], a[116:119], v[52:55]
    s_add_u32 m0, s22, 2048
    v_rcp_f32 v8, v51
    v_mfma_f32_16x16x32_bf16 v[60:63], a[224:227], a[140:143], v[60:63]
    buffer_load_dwordx4 v6, s[4:7], s20 offen lds
    v_mfma_f32_16x16x32_bf16 v[68:71], a[224:227], a[164:167], v[68:71]
    v_and_b32 v101, 0x3ff, v0
    v_lshl_add_u32 v101, v108, 10, v101
    v_mfma_f32_16x16x32_bf16 v[76:79], a[224:227], a[188:191], v[76:79]
    s_add_u32 s20, s20, 12032
    ds_read_b64_tr_b16 a[218:219], v3 offset:12288
    v_mbcnt_lo_u32_b32 v108, -1, 0
    v_mfma_f32_16x16x32_bf16 v[56:59], a[228:231], a[112:115], v[56:59]
    v_rcp_f32 v102, v49
    v_mfma_f32_16x16x32_bf16 v[64:67], a[228:231], a[136:139], v[64:67]
    v_mbcnt_hi_u32_b32 v108, -1, v108
    v_lshrrev_b32 v108, 1, v108
    v_mfma_f32_16x16x32_bf16 v[72:75], a[228:231], a[160:163], v[72:75]
    ds_read_b64_tr_b16 a[220:221], v4 offset:18432
    v_and_b32 v108, 24, v108
    v_mfma_f32_16x16x32_bf16 v[80:83], a[228:231], a[184:187], v[80:83]
    v_permlane32_swap_b32 v48, v100
    v_mfma_f32_16x16x32_bf16 v[56:59], a[232:235], a[116:119], v[56:59]
    ds_read_b64_tr_b16 a[222:223], v4 offset:12288
    v_bfe_u32 v108, s66, v108, 8
    v_mfma_f32_16x16x32_bf16 v[64:67], a[232:235], a[140:143], v[64:67]
    s_waitcnt lgkmcnt(3)
    v_rcp_f32 v48, v48
    v_mfma_f32_16x16x32_bf16 v[72:75], a[232:235], a[164:167], v[72:75]
    ds_read_b64_tr_b16 a[224:225], v5 offset:18432
    v_add_u32 v101, s38, v101
    v_mfma_f32_16x16x32_bf16 v[80:83], a[232:235], a[188:191], v[80:83]
    ds_read_b64_tr_b16 a[226:227], v5 offset:12288
    v_xor_b32 v101, v101, v108
    v_max3_f32 v96, v52, v53, v54
    v_max3_f32 v98, v60, v61, v62
    v_mfma_f32_16x16x32_bf16 v[112:115], a[212:215], v[16:19], v[112:115]
    s_mov_b32 s67, s34
    v_max3_f32 v96, v96, v55, v56
    v_max3_f32 v98, v98, v63, v64
    v_mfma_f32_16x16x32_bf16 v[160:163], a[212:215], v[22:25], v[160:163]
    s_add_u32 s18, s34, 24576
    ds_read_b64_tr_b16 a[234:235], v3 offset:13312
    v_max3_f32 v98, v98, v65, v66
    v_max3_f32 v96, v96, v57, v58
    v_max_f32 v98, v98, v67
    v_max_f32 v96, v96, v59
    v_mfma_f32_16x16x32_bf16 v[208:211], a[212:215], v[28:31], v[208:211]
    s_mov_b32 s34, s33
    v_mov_b32 v99, v98
    v_mov_b32 v97, v96
    s_add_u32 s64, s64, s62
    v_mfma_f32_16x16x32_bf16 a[0:3], a[212:215], v[34:37], a[0:3]
    s_waitcnt lgkmcnt(5)
    v_permlane32_swap_b32 v97, v96
    v_max_f32 v96, v96, v97
    v_mfma_f32_16x16x32_bf16 a[4:7], a[216:219], v[34:37], a[4:7]
    s_add_u32 s64, s64, 196608
    ds_read_b64_tr_b16 a[214:215], v4 offset:13312
    v_mov_b32 v97, v96
    v_permlane32_swap_b32 v99, v98
    v_mfma_f32_16x16x32_bf16 v[212:215], a[216:219], v[28:31], v[212:215]
    s_mov_b32 s39, s64
    ds_read_b64_tr_b16 a[232:233], v3 offset:19456
    v_permlane16_swap_b32 v97, v96
    v_mfma_f32_16x16x32_bf16 v[164:167], a[216:219], v[22:25], v[164:167]
    s_add_u32 s37, s37, 1
    ds_read_b64_tr_b16 a[228:229], v2 offset:19456
    v_max_f32 v98, v98, v99
    v_mfma_f32_16x16x32_bf16 v[116:119], a[216:219], v[16:19], v[116:119]
    s_waitcnt lgkmcnt(4)
    ds_read_b64_tr_b16 a[212:213], v4 offset:19456
    v_max_f32 v96, v96, v97
    v_mfma_f32_16x16x32_bf16 v[120:123], a[220:223], v[16:19], v[120:123]
    s_bitcmp1_b32 s63, s37
    s_cselect_b32 s62, 4294770688, 0
    ds_read_b64_tr_b16 a[230:231], v2 offset:13312
    v_mul_f32_e64 v9, -s28, v96
    v_mfma_f32_16x16x32_bf16 v[168:171], a[220:223], v[22:25], v[168:171]
    s_cselect_b32 s42, 0, 325632
    v_max3_f32 v96, v68, v69, v70
    v_mov_b32 v99, v98
    v_mfma_f32_16x16x32_bf16 v[216:219], a[220:223], v[28:31], v[216:219]
    s_add_u32 s35, s35, s42
    s_lshl_b32 s42, s37, 1
    v_permlane16_swap_b32 v99, v98
    v_max3_f32 v96, v96, v71, v72
    v_max3_f32 v96, v96, v73, v74
    v_max_f32 v96, v96, v75
    v_mfma_f32_16x16x32_bf16 a[8:11], a[220:223], v[34:37], a[8:11]
    s_lshr_b32 s42, s31, s42
    v_mov_b32 v97, v96
    v_max_f32 v98, v98, v99
    v_mul_f32_e64 v10, -s28, v98
    v_permlane32_swap_b32 v97, v96
    v_pk_mul_f32 v[164:165], v[164:165], v[102:103] op_sel_hi:[1,0]
    s_and_b32 s42, s42, 3
    s_add_u32 s42, s42, s36
    v_fma_f32 v55, v55, s28, v9
    v_max3_f32 v98, v76, v77, v78
    v_mfma_f32_16x16x32_bf16 a[12:15], a[224:227], v[34:37], a[12:15]
    s_sub_u32 s43, s42, 3
    ds_read_b64_tr_b16 a[216:217], v5 offset:19456
    v_subrev_u32 v103, 24576, v103
    v_mfma_f32_16x16x32_bf16 v[220:223], a[224:227], v[28:31], v[220:223]
    s_cmp_ge_u32 s42, 3
    ds_read_b64_tr_b16 a[220:221], v2 offset:20480
    v_accvgpr_read_b32 v104, a0
    v_mfma_f32_16x16x32_bf16 v[172:175], a[224:227], v[22:25], v[172:175]
    s_cselect_b32 s42, s43, s42
    v_fma_f32 v58, v58, s28, v9
    v_fma_f32 v54, v54, s28, v9
    v_mfma_f32_16x16x32_bf16 v[124:127], a[224:227], v[16:19], v[124:127]
    s_waitcnt lgkmcnt(2)
    ds_read_b64_tr_b16 a[218:219], v5 offset:13312
    v_max_f32 v96, v96, v97
    v_fma_f32 v62, v62, s28, v10
    v_mfma_f32_16x16x32_bf16 v[128:131], a[228:231], v[16:19], v[128:131]
    s_mul_i32 s44, s3, 5
    ds_read_b64_tr_b16 a[226:227], v3 offset:14336
    v_fma_f32 v53, v53, s28, v9
    v_mfma_f32_16x16x32_bf16 v[176:179], a[228:231], v[22:25], v[176:179]
    s_mov_b32 s32, 1
    ds_read_b64_tr_b16 a[224:225], v3 offset:20480
    v_mov_b32 v97, v96
    v_mfma_f32_16x16x32_bf16 v[224:227], a[228:231], v[28:31], v[224:227]
    s_lshl_b32 s43, s3, 2
    v_max3_f32 v98, v98, v79, v80
    v_fma_f32 v64, v64, s28, v10
    v_mfma_f32_16x16x32_bf16 a[16:19], a[228:231], v[34:37], a[16:19]
    s_add_u32 s45, s43, 21
    ds_read_b64_tr_b16 a[222:223], v2 offset:14336
    v_fma_f32 v56, v56, s28, v9
    v_mfma_f32_16x16x32_bf16 a[20:23], a[232:235], v[34:37], a[20:23]
    s_cmp_eq_u32 s3, 0
    v_permlane16_swap_b32 v97, v96
    v_mfma_f32_16x16x32_bf16 v[228:231], a[232:235], v[28:31], v[228:231]
    s_cselect_b32 s45, 20, s45
    v_fma_f32 v61, v61, s28, v10
    v_max3_f32 v98, v98, v81, v82
    s_cselect_b32 s33, 1, 0
    v_mfma_f32_16x16x32_bf16 v[180:183], a[232:235], v[22:25], v[180:183]
    s_cmp_eq_u32 s42, 1
    ds_read_b64_tr_b16 a[228:229], v4 offset:20480
    v_fma_f32 v52, v52, s28, v9
    v_mfma_f32_16x16x32_bf16 v[132:135], a[232:235], v[16:19], v[132:135]
    s_cselect_b32 s44, s45, s44
    v_fma_f32 v57, v57, s28, v9
    v_max_f32 v98, v98, v83
    v_mfma_f32_16x16x32_bf16 v[136:139], a[212:215], v[16:19], v[136:139]
    s_cselect_b32 s32, s33, s32
    v_mov_b32 v99, v98
    v_fma_f32 v63, v63, s28, v10
    v_exp_f32 v61, v61
    v_max_f32 v96, v96, v97
    v_mfma_f32_16x16x32_bf16 v[184:187], a[212:215], v[22:25], v[184:187]
    s_add_u32 s45, s43, 37
    v_accvgpr_read_b32 v105, a1
    v_mul_f32_e64 v11, -s28, v96
    v_permlane32_swap_b32 v99, v98
    v_fma_f32 v67, v67, s28, v10
    v_fma_f32 v68, v68, s28, v11
    v_mfma_f32_16x16x32_bf16 v[232:235], a[212:215], v[28:31], v[232:235]
    s_cmp_eq_u32 s42, 2
    v_fma_f32 v60, v60, s28, v10
    v_max_f32 v98, v98, v99
    v_mfma_f32_16x16x32_bf16 a[24:27], a[212:215], v[34:37], a[24:27]
    s_waitcnt lgkmcnt(1)
    ds_read_b64_tr_b16 a[230:231], v4 offset:14336
    v_fma_f32 v70, v70, s28, v11
    v_mfma_f32_16x16x32_bf16 a[28:31], a[216:219], v[34:37], a[28:31]
    s_cselect_b32 s44, s45, s44
    s_cselect_b32 s32, 0, s32
    ds_read_b64_tr_b16 a[232:233], v5 offset:20480
    v_mfma_f32_16x16x32_bf16 v[236:239], a[216:219], v[28:31], v[236:239]
    s_mul_i32 s44, s44, 6144
    ds_read_b64_tr_b16 a[234:235], v5 offset:14336
    s_add_u32 s33, s35, s44
    v_mfma_f32_16x16x32_bf16 v[188:191], a[216:219], v[22:25], v[188:191]
    s_mul_i32 s42, s32, 6144
    v_exp_f32 v62, v62
    v_mfma_f32_16x16x32_bf16 v[140:143], a[216:219], v[16:19], v[140:143]
    s_add_u32 s42, s42, 24576
    v_exp_f32 v55, v55
    v_mfma_f32_16x16x32_bf16 v[144:147], a[220:223], v[16:19], v[144:147]
    s_add_u32 s42, s42, s33
    v_mov_b32 v99, v98
    v_accvgpr_read_b32 v109, a5
    v_mfma_f32_16x16x32_bf16 v[192:195], a[220:223], v[22:25], v[192:195]
    s_cmp_ge_u32 s37, 6
    v_fma_f32 v59, v59, s28, v9
    s_cselect_b32 s14, 0, s42
    v_exp_f32 v52, v52
    v_mfma_f32_16x16x32_bf16 v[240:243], a[220:223], v[28:31], v[240:243]
    s_add_u32 s24, s67, 6144
    v_exp_f32 v53, v53
    v_fma_f32 v71, v71, s28, v11
    v_mfma_f32_16x16x32_bf16 a[32:35], a[220:223], v[34:37], a[32:35]
    s_add_u32 s25, s33, 6144
    v_permlane16_swap_b32 v99, v98
    v_mfma_f32_16x16x32_bf16 a[36:39], a[224:227], v[34:37], a[36:39]
    s_add_u32 s23, s38, 6144
    v_exp_f32 v60, v60
    v_mfma_f32_16x16x32_bf16 v[244:247], a[224:227], v[28:31], v[244:247]
    s_mov_b32 s27, 0x30c30
    v_exp_f32 v68, v68
    v_mfma_f32_16x16x32_bf16 v[196:199], a[224:227], v[22:25], v[196:199]
    s_mov_b32 s89, 0xaaaaaaaa
    s_mov_b32 s30, 0
    v_max_f32 v98, v98, v99
    v_mfma_f32_16x16x32_bf16 v[148:151], a[224:227], v[16:19], v[148:151]
    s_waitcnt vmcnt(8) lgkmcnt(0)
    s_barrier
    ds_read_b128 a[212:215], v0 offset:12288
    v_fma_f32 v72, v72, s28, v11
    v_mul_f32_e64 v12, -s28, v98
    v_exp_f32 v70, v70
    v_mfma_f32_16x16x32_bf16 v[152:155], a[228:231], v[16:19], v[152:155]
    ds_read_b128 a[220:223], v0 offset:13312
    v_fma_f32 v75, v75, s28, v11
    v_mfma_f32_16x16x32_bf16 v[200:203], a[228:231], v[22:25], v[200:203]
    ds_read_b128 a[216:219], v1 offset:12288
    v_fma_f32 v77, v77, s28, v12
    v_fma_f32 v78, v78, s28, v12
    v_exp_f32 v78, v78
    v_mfma_f32_16x16x32_bf16 v[248:251], a[228:231], v[28:31], v[248:251]
    v_exp_f32 v71, v71
    v_fma_f32 v76, v76, s28, v12
    v_cvt_pk_bf16_f32 v14, v52, v53
    v_cvt_pk_bf16_f32 v27, v70, v71
    v_exp_f32 v59, v59
    v_fma_f32 v79, v79, s28, v12
    v_mfma_f32_16x16x32_bf16 a[40:43], a[228:231], v[34:37], a[40:43]
    s_add_u32 m0, s22, 36864
    v_cvt_pk_bf16_f32 v20, v60, v61
    v_exp_f32 v63, v63
    v_exp_f32 v54, v54
    v_exp_f32 v72, v72
    v_mfma_f32_16x16x32_bf16 a[44:47], a[232:235], v[34:37], a[44:47]
    v_exp_f32 v67, v67
    v_mfma_f32_16x16x32_bf16 v[252:255], a[232:235], v[28:31], v[252:255]
    v_fma_f32 v69, v69, s28, v11
    v_exp_f32 v77, v77
    v_mfma_f32_16x16x32_bf16 v[204:207], a[232:235], v[22:25], v[204:207]
    ds_read_b128 a[224:227], v1 offset:13312
    v_exp_f32 v69, v69
    v_mfma_f32_16x16x32_bf16 v[156:159], a[232:235], v[16:19], v[156:159]
    s_waitcnt lgkmcnt(1)
    v_fma_f32 v83, v83, s28, v12
    v_cvt_pk_bf16_f32 v15, v54, v55
    v_fma_f32 v65, v65, s28, v10
    v_mfma_f32_16x16x32_bf16 v[52:55], a[212:215], a[96:99], 0
    ds_read_b128 a[228:231], v0 offset:14336
    v_cvt_pk_bf16_f32 v26, v68, v69
    v_mfma_f32_16x16x32_bf16 v[52:55], a[216:219], a[100:103], v[52:55]
    v_cvt_pk_bf16_f32 v21, v62, v63
    v_exp_f32 v76, v76
    v_fma_f32 v66, v66, s28, v10
    v_fma_f32 v82, v82, s28, v12
    v_mfma_f32_16x16x32_bf16 v[52:55], a[220:223], a[104:107], v[52:55]
    v_exp_f32 v83, v83
    v_mfma_f32_16x16x32_bf16 v[60:63], a[220:223], a[128:131], 0
    ds_read_b128 a[232:235], v1 offset:14336
    v_cvt_pk_bf16_f32 v32, v76, v77
    v_mfma_f32_16x16x32_bf16 v[60:63], a[216:219], a[124:127], v[60:63]
    v_exp_f32 v79, v79
    v_mfma_f32_16x16x32_bf16 v[60:63], a[212:215], a[120:123], v[60:63]
    v_exp_f32 v65, v65
    v_mfma_f32_16x16x32_bf16 v[68:71], a[212:215], a[144:147], 0
    v_fma_f32 v74, v74, s28, v11
    v_cvt_pk_bf16_f32 v33, v78, v79
    v_mfma_f32_16x16x32_bf16 v[68:71], a[216:219], a[148:151], v[68:71]
    v_exp_f32 v64, v64
    v_mfma_f32_16x16x32_bf16 v[68:71], a[220:223], a[152:155], v[68:71]
    buffer_load_dwordx4 v6, s[8:11], s21 offen lds
    v_mfma_f32_16x16x32_bf16 v[76:79], a[220:223], a[176:179], 0
    v_exp_f32 v74, v74
    v_mfma_f32_16x16x32_bf16 v[76:79], a[216:219], a[172:175], v[76:79]
    v_exp_f32 v58, v58
    v_mfma_f32_16x16x32_bf16 v[76:79], a[212:215], a[168:171], v[76:79]
    s_waitcnt lgkmcnt(1)
    v_exp_f32 v82, v82
    v_mfma_f32_16x16x32_bf16 v[76:79], a[224:227], a[180:183], v[76:79]
    ds_read_b128 a[216:219], v1 offset:18432
    v_fma_f32 v80, v80, s28, v12
    v_mfma_f32_16x16x32_bf16 v[76:79], a[228:231], a[184:187], v[76:79]
    s_waitcnt lgkmcnt(1)
    ds_read_b128 a[220:223], v0 offset:19456
    v_exp_f32 v75, v75
    v_mfma_f32_16x16x32_bf16 v[76:79], a[232:235], a[188:191], v[76:79]
    ds_read_b128 a[212:215], v0 offset:18432
    v_accvgpr_read_b32 v110, a6
    v_mfma_f32_16x16x32_bf16 v[68:71], a[232:235], a[164:167], v[68:71]
    v_exp_f32 v57, v57
    v_mfma_f32_16x16x32_bf16 v[68:71], a[228:231], a[160:163], v[68:71]
    s_add_u32 s21, s21, 128
    v_cvt_pk_bf16_f32 v164, v164, v165
    v_cvt_pk_bf16_f32 v17, v58, v59
    v_mfma_f32_16x16x32_bf16 v[68:71], a[224:227], a[156:159], v[68:71]
    v_cvt_pk_bf16_f32 v29, v74, v75
    v_exp_f32 v66, v66
    v_mfma_f32_16x16x32_bf16 v[60:63], a[224:227], a[132:135], v[60:63]
    s_add_u32 m0, s22, 37888
    v_fma_f32 v73, v73, s28, v11
    v_exp_f32 v56, v56
    v_mfma_f32_16x16x32_bf16 v[60:63], a[228:231], a[136:139], v[60:63]
    buffer_load_dwordx4 v6, s[8:11], s21 offen lds
    v_mfma_f32_16x16x32_bf16 v[60:63], a[232:235], a[140:143], v[60:63]
    v_exp_f32 v80, v80
    v_cvt_pk_bf16_f32 v16, v56, v57
    v_mfma_f32_16x16x32_bf16 v[52:55], a[232:235], a[116:119], v[52:55]
    v_fma_f32 v68, v68, s28, v11
    v_fma_f32 v71, v71, s28, v11
    v_mfma_f32_16x16x32_bf16 v[52:55], a[228:231], a[112:115], v[52:55]
    s_add_u32 s21, s21, 128
    ds_read_b128 a[232:235], v1 offset:20480
    v_cvt_pk_bf16_f32 v22, v64, v65
    v_mfma_f32_16x16x32_bf16 v[52:55], a[224:227], a[108:111], v[52:55]
    s_waitcnt lgkmcnt(1)
    v_cvt_pk_bf16_f32 v23, v66, v67
    v_fma_f32 v78, v78, s28, v12
    v_mfma_f32_16x16x32_bf16 v[56:59], a[212:215], a[96:99], 0
    ds_read_b128 a[228:231], v0 offset:20480
    v_accvgpr_read_b32 v108, a4
    v_mfma_f32_16x16x32_bf16 v[56:59], a[216:219], a[100:103], v[56:59]
    ds_read_b128 a[224:227], v1 offset:19456
    v_fma_f32 v81, v81, s28, v12
    v_mfma_f32_16x16x32_bf16 v[56:59], a[220:223], a[104:107], v[56:59]
    v_exp_f32 v78, v78
    v_mfma_f32_16x16x32_bf16 v[44:47], a[236:239], v[14:17], 0
    v_exp_f32 v73, v73
    v_mfma_f32_16x16x32_bf16 v[64:67], a[220:223], a[128:131], 0
    v_cvt_pk_bf16_f32 v28, v72, v73
    v_fma_f32 v54, v54, s28, v9
    v_mfma_f32_16x16x32_bf16 v[64:67], a[216:219], a[124:127], v[64:67]
    s_add_u32 m0, s22, 38912
    v_exp_f32 v71, v71
    v_exp_f32 v81, v81
    v_fma_f32 v69, v69, s28, v11
    v_pk_mul_f32 v[136:137], v[136:137], v[48:49] op_sel_hi:[1,0]
    v_pk_mul_f32 v[132:133], v[132:133], v[48:49] op_sel_hi:[1,0]
    v_pk_mul_f32 v[234:235], v[234:235], v[50:51] op_sel_hi:[1,0]
    v_pk_mul_f32 v[124:125], v[124:125], v[48:49] op_sel_hi:[1,0]
    v_pk_mul_f32 v[160:161], v[160:161], v[102:103] op_sel_hi:[1,0]
    v_pk_mul_f32 v[216:217], v[216:217], v[50:51] op_sel_hi:[1,0]
    v_pk_mul_f32 v[104:105], v[104:105], v[8:9] op_sel_hi:[1,0]
    v_pk_mul_f32 v[114:115], v[114:115], v[48:49] op_sel_hi:[1,0]
    v_pk_mul_f32 v[176:177], v[176:177], v[102:103] op_sel_hi:[1,0]
    v_cvt_pk_bf16_f32 v34, v80, v81
    v_pk_mul_f32 v[130:131], v[130:131], v[48:49] op_sel_hi:[1,0]
    v_pk_mul_f32 v[152:153], v[152:153], v[48:49] op_sel_hi:[1,0]
    v_fma_f32 v63, v63, s28, v10
    v_fma_f32 v79, v79, s28, v12
    v_mfma_f32_16x16x32_bf16 v[64:67], a[212:215], a[120:123], v[64:67]
    v_accvgpr_read_b32 v111, a7
    v_cvt_pk_bf16_f32 v35, v82, v83
    v_mfma_f32_16x16x32_bf16 v[72:75], a[212:215], a[144:147], 0
    buffer_load_dwordx4 v6, s[8:11], s21 offen lds
    v_mfma_f32_16x16x32_bf16 v[72:75], a[216:219], a[148:151], v[72:75]
    v_fma_f32 v55, v55, s28, v9
    v_fma_f32 v77, v77, s28, v12
    v_mfma_f32_16x16x32_bf16 v[72:75], a[220:223], a[152:155], v[72:75]
    v_cvt_pk_bf16_f32 v176, v176, v177
    v_cvt_pk_bf16_f32 v104, v104, v105
    v_fma_f32 v52, v52, s28, v9
    v_mfma_f32_16x16x32_bf16 v[80:83], a[220:223], a[176:179], 0
    s_add_u32 s21, s21, 12032
    v_exp_f32 v55, v55
    v_mfma_f32_16x16x32_bf16 v[80:83], a[216:219], a[172:175], v[80:83]
    s_waitcnt vmcnt(6) lgkmcnt(0)
    v_fma_f32 v62, v62, s28, v10
    v_fma_f32 v70, v70, s28, v11
    v_mfma_f32_16x16x32_bf16 v[80:83], a[212:215], a[168:171], v[80:83]
    s_barrier
    v_mfma_f32_16x16x32_bf16 v[80:83], a[224:227], a[180:183], v[80:83]
    ds_read_b64_tr_b16 a[212:213], v2 offset:0
    v_accvgpr_read_b32 v107, a3
    v_mfma_f32_16x16x32_bf16 v[80:83], a[228:231], a[184:187], v[80:83]
    ds_read_b64_tr_b16 a[214:215], v2 offset:6144
    v_exp_f32 v79, v79
    v_mfma_f32_16x16x32_bf16 v[80:83], a[232:235], a[188:191], v[80:83]
    v_fma_f32 v60, v60, s28, v10
    v_mov_b32 v38, v6
    v_mfma_f32_16x16x32_bf16 v[72:75], a[232:235], a[164:167], v[72:75]
    v_exp_f32 v62, v62
    v_mfma_f32_16x16x32_bf16 v[72:75], a[228:231], a[160:163], v[72:75]
    v_fma_f32 v53, v53, s28, v9
    v_exp_f32 v52, v52
    v_mfma_f32_16x16x32_bf16 v[44:47], a[240:243], v[20:23], v[44:47]
    s_add_u32 m0, s22, 12288
    v_exp_f32 v63, v63
    v_mfma_f32_16x16x32_bf16 v[72:75], a[224:227], a[156:159], v[72:75]
    ds_read_b64_tr_b16 a[216:217], v3 offset:0
    v_fma_f32 v76, v76, s28, v12
    v_mfma_f32_16x16x32_bf16 v[64:67], a[224:227], a[132:135], v[64:67]
    v_accvgpr_read_b32 v106, a2
    v_fma_f32 v80, v80, s28, v12
    v_mfma_f32_16x16x32_bf16 v[64:67], a[228:231], a[136:139], v[64:67]
    ds_read_b64_tr_b16 a[218:219], v3 offset:6144
    buffer_load_dwordx4 v6, s[4:7], s20 offen lds
    v_exp_f32 v76, v76
    v_pk_mul_f32 v[170:171], v[170:171], v[102:103] op_sel_hi:[1,0]
    v_pk_mul_f32 v[120:121], v[120:121], v[48:49] op_sel_hi:[1,0]
    v_pk_mul_f32 v[196:197], v[196:197], v[102:103] op_sel_hi:[1,0]
    v_fma_f32 v61, v61, s28, v10
    v_pk_mul_f32 v[220:221], v[220:221], v[50:51] op_sel_hi:[1,0]
    v_pk_mul_f32 v[108:109], v[108:109], v[8:9] op_sel_hi:[1,0]
    v_pk_mul_f32 v[190:191], v[190:191], v[102:103] op_sel_hi:[1,0]
    v_pk_mul_f32 v[244:245], v[244:245], v[50:51] op_sel_hi:[1,0]
    v_pk_mul_f32 v[174:175], v[174:175], v[102:103] op_sel_hi:[1,0]
    v_pk_mul_f32 v[140:141], v[140:141], v[48:49] op_sel_hi:[1,0]
    v_pk_mul_f32 v[112:113], v[112:113], v[48:49] op_sel_hi:[1,0]
    v_pk_mul_f32 v[126:127], v[126:127], v[48:49] op_sel_hi:[1,0]
    v_pk_mul_f32 v[248:249], v[248:249], v[50:51] op_sel_hi:[1,0]
    v_pk_mul_f32 v[162:163], v[162:163], v[102:103] op_sel_hi:[1,0]
    v_pk_mul_f32 v[226:227], v[226:227], v[50:51] op_sel_hi:[1,0]
    v_cvt_pk_bf16_f32 v108, v108, v109
    v_pk_mul_f32 v[202:203], v[202:203], v[102:103] op_sel_hi:[1,0]
    v_pk_mul_f32 v[208:209], v[208:209], v[50:51] op_sel_hi:[1,0]
    v_pk_mul_f32 v[116:117], v[116:117], v[48:49] op_sel_hi:[1,0]
    v_pk_mul_f32 v[240:241], v[240:241], v[50:51] op_sel_hi:[1,0]
    v_pk_mul_f32 v[252:253], v[252:253], v[50:51] op_sel_hi:[1,0]
    v_pk_mul_f32 v[228:229], v[228:229], v[50:51] op_sel_hi:[1,0]
    v_cvt_pk_bf16_f32 v124, v124, v125
    v_cvt_pk_bf16_f32 v220, v220, v221
    v_pk_mul_f32 v[254:255], v[254:255], v[50:51] op_sel_hi:[1,0]
    v_cvt_pk_bf16_f32 v112, v112, v113
    v_pk_mul_f32 v[232:233], v[232:233], v[50:51] op_sel_hi:[1,0]
    v_cvt_pk_bf16_f32 v132, v132, v133
    v_cvt_pk_bf16_f32 v136, v136, v137
    v_pk_mul_f32 v[166:167], v[166:167], v[102:103] op_sel_hi:[1,0]
    v_cvt_pk_bf16_f32 v160, v160, v161
    v_cvt_pk_bf16_f32 v252, v252, v253
    v_pk_mul_f32 v[180:181], v[180:181], v[102:103] op_sel_hi:[1,0]
    v_pk_mul_f32 v[218:219], v[218:219], v[50:51] op_sel_hi:[1,0]
    v_pk_mul_f32 v[210:211], v[210:211], v[50:51] op_sel_hi:[1,0]
    v_pk_mul_f32 v[200:201], v[200:201], v[102:103] op_sel_hi:[1,0]
    v_pk_mul_f32 v[128:129], v[128:129], v[48:49] op_sel_hi:[1,0]
    v_pk_mul_f32 v[110:111], v[110:111], v[8:9] op_sel_hi:[1,0]
    v_pk_mul_f32 v[182:183], v[182:183], v[102:103] op_sel_hi:[1,0]
    v_pk_mul_f32 v[242:243], v[242:243], v[50:51] op_sel_hi:[1,0]
    v_pk_mul_f32 v[206:207], v[206:207], v[102:103] op_sel_hi:[1,0]
    v_pk_mul_f32 v[168:169], v[168:169], v[102:103] op_sel_hi:[1,0]
    v_pk_mul_f32 v[178:179], v[178:179], v[102:103] op_sel_hi:[1,0]
    v_pk_mul_f32 v[212:213], v[212:213], v[50:51] op_sel_hi:[1,0]
    v_pk_mul_f32 v[214:215], v[214:215], v[50:51] op_sel_hi:[1,0]
    v_pk_mul_f32 v[172:173], v[172:173], v[102:103] op_sel_hi:[1,0]
    v_pk_mul_f32 v[188:189], v[188:189], v[102:103] op_sel_hi:[1,0]
    v_pk_mul_f32 v[184:185], v[184:185], v[102:103] op_sel_hi:[1,0]
    v_cvt_pk_bf16_f32 v253, v254, v255
    v_cvt_pk_bf16_f32 v188, v188, v189
    v_cvt_pk_bf16_f32 v240, v240, v241
    v_pk_mul_f32 v[106:107], v[106:107], v[8:9] op_sel_hi:[1,0]
    v_pk_mul_f32 v[142:143], v[142:143], v[48:49] op_sel_hi:[1,0]
    v_fma_f32 v83, v83, s28, v12
    v_cvt_pk_bf16_f32 v208, v208, v209
    v_cvt_pk_bf16_f32 v161, v162, v163
    v_pk_mul_f32 v[236:237], v[236:237], v[50:51] op_sel_hi:[1,0]
    v_fma_f32 v82, v82, s28, v12
    v_cvt_pk_bf16_f32 v116, v116, v117
    v_cvt_pk_bf16_f32 v120, v120, v121
    v_cvt_pk_bf16_f32 v200, v200, v201
    v_cvt_pk_bf16_f32 v168, v168, v169
    v_pk_mul_f32 v[224:225], v[224:225], v[50:51] op_sel_hi:[1,0]
    v_cvt_pk_bf16_f32 v113, v114, v115
    v_cvt_pk_bf16_f32 v109, v110, v111
    v_cvt_pk_bf16_f32 v212, v212, v213
    v_pk_mul_f32 v[122:123], v[122:123], v[48:49] op_sel_hi:[1,0]
    v_exp_f32 v77, v77
    v_cvt_pk_bf16_f32 v184, v184, v185
    v_pk_mul_f32 v[138:139], v[138:139], v[48:49] op_sel_hi:[1,0]
    v_cvt_pk_bf16_f32 v105, v106, v107
    v_pk_mul_f32 v[198:199], v[198:199], v[102:103] op_sel_hi:[1,0]
    v_fma_f32 v75, v75, s28, v11
    v_cvt_pk_bf16_f32 v228, v228, v229
    v_cvt_pk_bf16_f32 v172, v172, v173
    v_pk_mul_f32 v[118:119], v[118:119], v[48:49] op_sel_hi:[1,0]
    v_cvt_pk_bf16_f32 v216, v216, v217
    v_pk_mul_f32 v[204:205], v[204:205], v[102:103] op_sel_hi:[1,0]
    v_cvt_pk_bf16_f32 v117, v118, v119
    v_exp_f32 v80, v80
    v_cvt_pk_bf16_f32 v137, v138, v139
    v_cvt_pk_bf16_f32 v209, v210, v211
    v_mfma_f32_16x16x32_bf16 v[64:67], a[232:235], a[140:143], v[64:67]
    ds_read_b64_tr_b16 a[220:221], v4 offset:0
    v_cvt_pk_bf16_f32 v213, v214, v215
    v_mfma_f32_16x16x32_bf16 v[56:59], a[232:235], a[116:119], v[56:59]
    s_add_u32 s20, s20, 128
    ds_write2st64_b64 v101, v[112:113], v[160:161] offset0:0 offset1:12
    v_pk_mul_f32 v[250:251], v[250:251], v[50:51] op_sel_hi:[1,0]
    v_accvgpr_read_b32 v106, a10
    v_fma_f32 v74, v74, s28, v11
    v_mfma_f32_16x16x32_bf16 v[44:47], a[244:247], v[26:29], v[44:47]
    s_add_u32 m0, s22, 13312
    ds_write2st64_b64 v101, v[208:209], v[104:105] offset0:24 offset1:36
    v_cvt_pk_bf16_f32 v165, v166, v167
    v_accvgpr_read_b32 v104, a8
    v_cvt_pk_bf16_f32 v121, v122, v123
    v_accvgpr_read_b32 v110, a14
    v_accvgpr_read_b32 v105, a9
    v_mfma_f32_16x16x32_bf16 v[56:59], a[228:231], a[112:115], v[56:59]
    v_cvt_pk_bf16_f32 v196, v196, v197
    v_cvt_pk_bf16_f32 v232, v232, v233
    v_fma_f32 v72, v72, s28, v11
    v_xor_b32 v101, 32, v101
    v_mfma_f32_16x16x32_bf16 v[56:59], a[224:227], a[108:111], v[56:59]
    s_waitcnt lgkmcnt(3)
    ds_write2st64_b64 v101, v[116:117], v[164:165] offset0:0 offset1:12
    v_mfma_f32_16x16x32_bf16 v[112:115], a[212:215], v[14:17], 0
    ds_read_b64_tr_b16 a[222:223], v4 offset:6144
    v_exp_f32 v72, v72
    v_cvt_pk_bf16_f32 v140, v140, v141
    v_exp_f32 v83, v83
    v_pk_mul_f32 v[194:195], v[194:195], v[102:103] op_sel_hi:[1,0]
    v_pk_mul_f32 v[146:147], v[146:147], v[48:49] op_sel_hi:[1,0]
    v_pk_mul_f32 v[222:223], v[222:223], v[50:51] op_sel_hi:[1,0]
    v_pk_mul_f32 v[134:135], v[134:135], v[48:49] op_sel_hi:[1,0]
    v_cvt_pk_bf16_f32 v221, v222, v223
    v_cvt_pk_bf16_f32 v224, v224, v225
    v_mfma_f32_16x16x32_bf16 v[160:163], a[212:215], v[20:23], 0
    ds_write2st64_b64 v101, v[212:213], v[108:109] offset0:24 offset1:36
    v_mfma_f32_16x16x32_bf16 v[208:211], a[212:215], v[26:29], 0
    v_accvgpr_read_b32 v109, a13
    v_xor_b32 v101, 96, v101
    v_accvgpr_read_b32 v107, a11
    v_cvt_pk_bf16_f32 v169, v170, v171
    v_exp_f32 v68, v68
    v_cvt_pk_bf16_f32 v217, v218, v219
    v_cvt_pk_bf16_f32 v197, v198, v199
    v_mfma_f32_16x16x32_bf16 a[0:3], a[212:215], v[32:35], 0
    ds_read_b64_tr_b16 a[234:235], v3 offset:7168
    buffer_load_dwordx4 v6, s[4:7], s20 offen lds
    v_exp_f32 v54, v54
    v_mfma_f32_16x16x32_bf16 a[4:7], a[216:219], v[32:35], 0
    ds_write2st64_b64 v101, v[120:121], v[168:169] offset0:0 offset1:12
    v_pk_mul_f32 v[238:239], v[238:239], v[50:51] op_sel_hi:[1,0]
    v_pk_mul_f32 v[106:107], v[106:107], v[8:9] op_sel_hi:[1,0]
    v_cvt_pk_bf16_f32 v173, v174, v175
    v_pk_mul_f32 v[186:187], v[186:187], v[102:103] op_sel_hi:[1,0]
    v_cvt_pk_bf16_f32 v177, v178, v179
    v_cvt_pk_bf16_f32 v248, v248, v249
    v_pk_mul_f32 v[104:105], v[104:105], v[8:9] op_sel_hi:[1,0]
    v_cvt_pk_bf16_f32 v141, v142, v143
    v_cvt_pk_bf16_f32 v180, v180, v181
    v_pk_mul_f32 v[144:145], v[144:145], v[48:49] op_sel_hi:[1,0]
    v_cvt_pk_bf16_f32 v236, v236, v237
    v_fma_f32 v64, v64, s28, v10
    v_cvt_pk_bf16_f32 v185, v186, v187
    v_pk_mul_f32 v[154:155], v[154:155], v[48:49] op_sel_hi:[1,0]
    v_cvt_pk_bf16_f32 v225, v226, v227
    v_cvt_pk_bf16_f32 v25, v62, v63
    v_mfma_f32_16x16x32_bf16 v[212:215], a[216:219], v[26:29], 0
    ds_read_b64_tr_b16 a[224:225], v5 offset:0
    ds_read_b64_tr_b16 a[214:215], v4 offset:7168
    v_accvgpr_read_b32 v111, a15
    v_mfma_f32_16x16x32_bf16 v[44:47], a[248:251], v[32:35], v[44:47]
    s_add_u32 s20, s20, 128
    ds_read_b64_tr_b16 a[230:231], v2 offset:7168
    v_fma_f32 v59, v59, s28, v9
    v_cvt_pk_bf16_f32 v104, v104, v105
    v_cvt_pk_bf16_f32 v105, v106, v107
    v_mfma_f32_16x16x32_bf16 v[164:167], a[216:219], v[20:23], 0
    s_add_u32 m0, s22, 14336
    ds_read_b64_tr_b16 a[212:213], v4 offset:1024
    v_fma_f32 v65, v65, s28, v10
    v_mfma_f32_16x16x32_bf16 v[116:119], a[216:219], v[14:17], 0
    s_waitcnt lgkmcnt(5)
    ds_read_b64_tr_b16 a[228:229], v2 offset:1024
    buffer_load_dwordx4 v6, s[4:7], s20 offen lds
    v_mfma_f32_16x16x32_bf16 v[120:123], a[220:223], v[14:17], 0
    ds_read_b64_tr_b16 a[226:227], v5 offset:6144
    v_cvt_pk_bf16_f32 v144, v144, v145
    v_cvt_pk_bf16_f32 v201, v202, v203
    v_accvgpr_read_b32 v106, a18
    v_accvgpr_read_b32 v108, a12
    v_mfma_f32_16x16x32_bf16 v[168:171], a[220:223], v[20:23], 0
    s_add_u32 s20, s20, 12032
    ds_write2st64_b64 v101, v[216:217], v[104:105] offset0:24 offset1:36
    v_fma_f32 v73, v73, s28, v11
    v_cvt_pk_bf16_f32 v204, v204, v205
    v_pk_mul_f32 v[192:193], v[192:193], v[102:103] op_sel_hi:[1,0]
    v_fma_f32 v81, v81, s28, v12
    v_pk_mul_f32 v[108:109], v[108:109], v[8:9] op_sel_hi:[1,0]
    v_fma_f32 v67, v67, s28, v10
    v_cvt_pk_bf16_f32 v128, v128, v129
    v_pk_mul_f32 v[110:111], v[110:111], v[8:9] op_sel_hi:[1,0]
    v_cvt_pk_bf16_f32 v125, v126, v127
    v_pk_mul_f32 v[230:231], v[230:231], v[50:51] op_sel_hi:[1,0]
    v_accvgpr_read_b32 v105, a17
    v_accvgpr_read_b32 v104, a16
    v_pk_mul_f32 v[156:157], v[156:157], v[48:49] op_sel_hi:[1,0]
    v_cvt_pk_bf16_f32 v244, v244, v245
    v_cvt_pk_bf16_f32 v129, v130, v131
    v_cvt_pk_bf16_f32 v145, v146, v147
    v_accvgpr_read_b32 v107, a19
    v_xor_b32 v101, 32, v101
    v_pk_mul_f32 v[104:105], v[104:105], v[8:9] op_sel_hi:[1,0]
    v_cvt_pk_bf16_f32 v108, v108, v109
    v_pk_mul_f32 v[246:247], v[246:247], v[50:51] op_sel_hi:[1,0]
    v_cvt_pk_bf16_f32 v104, v104, v105
    v_cvt_pk_bf16_f32 v189, v190, v191
    v_mfma_f32_16x16x32_bf16 v[216:219], a[220:223], v[26:29], 0
    ds_write2st64_b64 v101, v[124:125], v[172:173] offset0:0 offset1:12
    v_cvt_pk_bf16_f32 v192, v192, v193
    v_pk_mul_f32 v[106:107], v[106:107], v[8:9] op_sel_hi:[1,0]
    v_cvt_pk_bf16_f32 v181, v182, v183
    v_cvt_pk_bf16_f32 v109, v110, v111
    v_mfma_f32_16x16x32_bf16 a[8:11], a[220:223], v[32:35], 0
    s_waitcnt lgkmcnt(1)
    ds_write2st64_b64 v101, v[220:221], v[108:109] offset0:24 offset1:36
    v_pk_mul_f32 v[148:149], v[148:149], v[48:49] op_sel_hi:[1,0]
    v_accvgpr_read_b32 v108, a20
    s_nop 0
    v_mfma_f32_16x16x32_bf16 a[12:15], a[224:227], v[32:35], 0
    ds_read_b64_tr_b16 a[218:219], v5 offset:7168
    ds_read_b64_tr_b16 a[232:233], v3 offset:1024
    v_cvt_pk_bf16_f32 v233, v234, v235
    v_cvt_pk_bf16_f32 v105, v106, v107
    v_mfma_f32_16x16x32_bf16 v[220:223], a[224:227], v[26:29], 0
    ds_read_b128 v[88:91], v103 offset:0
    v_accvgpr_read_b32 v109, a21
    v_xor_b32 v101, 96, v101
    v_mfma_f32_16x16x32_bf16 v[172:175], a[224:227], v[20:23], 0
    ds_write2st64_b64 v101, v[128:129], v[176:177] offset0:4 offset1:16
    v_cvt_pk_bf16_f32 v36, v76, v77
    v_mfma_f32_16x16x32_bf16 v[124:127], a[224:227], v[14:17], 0
    s_add_u32 m0, s38, 0
    ds_write2st64_b64 v101, v[224:225], v[104:105] offset0:28 offset1:40
    v_cvt_pk_bf16_f32 v229, v230, v231
    v_pk_mul_f32 v[108:109], v[108:109], v[8:9] op_sel_hi:[1,0]
    v_accvgpr_read_b32 v110, a22
    v_accvgpr_read_b32 v111, a23
    v_xor_b32 v101, 32, v101
    v_accvgpr_read_b32 v106, a26
    v_fma_f32 v57, v57, s28, v9
    v_pk_mul_f32 v[158:159], v[158:159], v[48:49] op_sel_hi:[1,0]
    v_accvgpr_read_b32 v105, a25
    v_cvt_pk_bf16_f32 v133, v134, v135
    v_cvt_pk_bf16_f32 v148, v148, v149
    v_mfma_f32_16x16x32_bf16 v[128:131], a[228:231], v[14:17], 0
    ds_write2st64_b64 v101, v[132:133], v[180:181] offset0:4 offset1:16
    v_accvgpr_read_b32 v104, a24
    v_accvgpr_read_b32 v107, a27
    v_exp_f32 v73, v73
    v_pk_mul_f32 v[106:107], v[106:107], v[8:9] op_sel_hi:[1,0]
    v_pk_mul_f32 v[110:111], v[110:111], v[8:9] op_sel_hi:[1,0]
    v_pk_mul_f32 v[104:105], v[104:105], v[8:9] op_sel_hi:[1,0]
    v_cvt_pk_bf16_f32 v108, v108, v109
    v_cvt_pk_bf16_f32 v104, v104, v105
    v_cvt_pk_bf16_f32 v109, v110, v111
    v_exp_f32 v82, v82
    v_accvgpr_read_b32 v110, a30
    v_cvt_pk_bf16_f32 v245, v246, v247
    v_fma_f32 v58, v58, s28, v9
    v_mfma_f32_16x16x32_bf16 v[176:179], a[228:231], v[20:23], 0
    s_waitcnt lgkmcnt(1)
    ds_read_b128 v[96:99], v103 offset:1024
    buffer_load_dwordx4 v6, s[12:15], s33 offen nt lds
    v_mfma_f32_16x16x32_bf16 v[224:227], a[228:231], v[26:29], 0
    ds_read_b64_tr_b16 a[224:225], v3 offset:2048
    ds_read_b64_tr_b16 a[216:217], v5 offset:1024
    v_mfma_f32_16x16x32_bf16 a[16:19], a[228:231], v[32:35], 0
    ds_write2st64_b64 v101, v[228:229], v[108:109] offset0:28 offset1:40
    v_cvt_pk_bf16_f32 v105, v106, v107
    v_xor_b32 v101, 96, v101
    v_mfma_f32_16x16x32_bf16 a[20:23], a[232:235], v[32:35], 0
    ds_write2st64_b64 v101, v[136:137], v[184:185] offset0:4 offset1:16
    v_accvgpr_read_b32 v111, a31
    v_accvgpr_read_b32 v108, a28
    v_cvt_pk_bf16_f32 v156, v156, v157
    v_exp_f32 v53, v53
    v_mfma_f32_16x16x32_bf16 v[228:231], a[232:235], v[26:29], 0
    ds_write2st64_b64 v101, v[232:233], v[104:105] offset0:28 offset1:40
    v_cvt_pk_bf16_f32 v193, v194, v195
    v_accvgpr_read_b32 v109, a29
    v_cvt_pk_bf16_f32 v152, v152, v153
    v_mfma_f32_16x16x32_bf16 v[180:183], a[232:235], v[20:23], 0
    ds_read_b64_tr_b16 a[220:221], v2 offset:2048
    v_xor_b32 v101, 32, v101
    v_mfma_f32_16x16x32_bf16 v[132:135], a[232:235], v[14:17], 0
    buffer_store_dwordx4 v[88:91], v6, s[16:19], s67 offen offset:0 nt
    ds_read_b64_tr_b16 a[230:231], v4 offset:8192
    v_cvt_pk_bf16_f32 v241, v242, v243
    v_pk_mul_f32 v[108:109], v[108:109], v[8:9] op_sel_hi:[1,0]
    v_pk_mul_f32 v[150:151], v[150:151], v[48:49] op_sel_hi:[1,0]
    v_accvgpr_read_b32 v107, a35
    v_cvt_pk_bf16_f32 v108, v108, v109
    v_mfma_f32_16x16x32_bf16 v[136:139], a[212:215], v[14:17], 0
    ds_read_b64_tr_b16 a[232:233], v5 offset:2048
    v_accvgpr_read_b32 v106, a34
    v_cvt_pk_bf16_f32 v237, v238, v239
    v_mfma_f32_16x16x32_bf16 v[184:187], a[212:215], v[20:23], 0
    ds_write2st64_b64 v101, v[140:141], v[188:189] offset0:4 offset1:16
    v_pk_mul_f32 v[110:111], v[110:111], v[8:9] op_sel_hi:[1,0]
    v_cvt_pk_bf16_f32 v149, v150, v151
    v_accvgpr_read_b32 v105, a33
    v_mfma_f32_16x16x32_bf16 v[232:235], a[212:215], v[26:29], 0
    ds_read_b64_tr_b16 a[226:227], v3 offset:8192
    ds_read_b64_tr_b16 a[222:223], v2 offset:8192
    v_mfma_f32_16x16x32_bf16 a[24:27], a[212:215], v[32:35], 0
    s_waitcnt lgkmcnt(6)
    ds_read_b64_tr_b16 a[234:235], v5 offset:8192
    v_cvt_pk_bf16_f32 v109, v110, v111
    v_mfma_f32_16x16x32_bf16 a[28:31], a[216:219], v[32:35], 0
    s_add_u32 m0, s38, 1024
    ds_write2st64_b64 v101, v[236:237], v[108:109] offset0:28 offset1:40
    v_xor_b32 v101, 96, v101
    v_accvgpr_read_b32 v109, a37
    v_pk_mul_f32 v[106:107], v[106:107], v[8:9] op_sel_hi:[1,0]
    v_fma_f32 v66, v66, s28, v10
    v_accvgpr_read_b32 v111, a39
    v_mfma_f32_16x16x32_bf16 v[236:239], a[216:219], v[26:29], 0
    ds_read_b64_tr_b16 a[228:229], v4 offset:2048
    buffer_load_dwordx4 v7, s[12:15], s33 offen nt lds
    v_accvgpr_read_b32 v104, a32
    v_exp_f32 v60, v60
    v_pk_mul_f32 v[104:105], v[104:105], v[8:9] op_sel_hi:[1,0]
    v_accvgpr_read_b32 v108, a36
    v_pk_mul_f32 v[108:109], v[108:109], v[8:9] op_sel_hi:[1,0]
    v_cvt_pk_bf16_f32 v153, v154, v155
    v_exp_f32 v61, v61
    v_cvt_pk_bf16_f32 v108, v108, v109
    v_accvgpr_read_b32 v110, a38
    v_mfma_f32_16x16x32_bf16 v[188:191], a[216:219], v[20:23], 0
    s_add_u32 s39, s39, 12288
    ds_write2st64_b64 v101, v[144:145], v[192:193] offset0:8 offset1:20
    v_cvt_pk_bf16_f32 v104, v104, v105
    v_cvt_pk_bf16_f32 v105, v106, v107
    v_pk_mul_f32 v[110:111], v[110:111], v[8:9] op_sel_hi:[1,0]
    v_cvt_pk_bf16_f32 v249, v250, v251
    v_cvt_pk_bf16_f32 v37, v78, v79
    v_mfma_f32_16x16x32_bf16 v[140:143], a[216:219], v[14:17], 0
    s_waitcnt lgkmcnt(2)
    ds_write2st64_b64 v101, v[240:241], v[104:105] offset0:32 offset1:44
    v_mfma_f32_16x16x32_bf16 v[144:147], a[220:223], v[14:17], 0
    v_cvt_pk_bf16_f32 v109, v110, v111
    v_cvt_pk_bf16_f32 v205, v206, v207
    v_mfma_f32_16x16x32_bf16 v[192:195], a[220:223], v[20:23], 0
    s_waitcnt vmcnt(9) lgkmcnt(2)
    v_xor_b32 v101, 32, v101
    v_accvgpr_read_b32 v107, a43
    v_mfma_f32_16x16x32_bf16 v[240:243], a[220:223], v[26:29], 0
    buffer_store_dwordx4 v[96:99], v7, s[16:19], s67 offen offset:0 nt
    s_barrier
    ds_write2st64_b64 v101, v[148:149], v[196:197] offset0:8 offset1:20
    v_accvgpr_read_b32 v111, a47
    v_mfma_f32_16x16x32_bf16 a[32:35], a[220:223], v[32:35], 0
    ds_write2st64_b64 v101, v[244:245], v[108:109] offset0:32 offset1:44
    v_mfma_f32_16x16x32_bf16 a[36:39], a[224:227], v[32:35], 0
    ds_read_b128 a[216:219], v1 offset:0
    v_accvgpr_read_b32 v105, a41
    v_accvgpr_read_b32 v109, a45
    v_cvt_pk_bf16_f32 v19, v54, v55
    v_cvt_pk_bf16_f32 v24, v60, v61
    v_accvgpr_read_b32 v110, a46
    v_mfma_f32_16x16x32_bf16 v[244:247], a[224:227], v[26:29], 0
    v_accvgpr_read_b32 v108, a44
    v_xor_b32 v101, 96, v101
    v_mfma_f32_16x16x32_bf16 v[196:199], a[224:227], v[20:23], 0
    s_add_u32 m0, s22, 24576
    ds_read_b128 a[212:215], v0 offset:0
    v_accvgpr_read_b32 v104, a40
    v_accvgpr_read_b32 v106, a42
    v_exp_f32 v70, v70
    v_exp_f32 v58, v58
    v_pk_mul_f32 v[108:109], v[108:109], v[8:9] op_sel_hi:[1,0]
    v_pk_mul_f32 v[110:111], v[110:111], v[8:9] op_sel_hi:[1,0]
    v_pk_mul_f32 v[106:107], v[106:107], v[8:9] op_sel_hi:[1,0]
    v_pk_mul_f32 v[104:105], v[104:105], v[8:9] op_sel_hi:[1,0]
    v_cvt_pk_bf16_f32 v31, v70, v71
    v_cvt_pk_bf16_f32 v108, v108, v109
    v_cvt_pk_bf16_f32 v104, v104, v105
    v_mfma_f32_16x16x32_bf16 v[148:151], a[224:227], v[14:17], 0
    ds_write2st64_b64 v101, v[152:153], v[200:201] offset0:8 offset1:20
    v_cvt_pk_bf16_f32 v105, v106, v107
    v_mfma_f32_16x16x32_bf16 v[152:155], a[228:231], v[14:17], 0
    ds_read_b128 a[220:223], v0 offset:1024
    v_cvt_pk_bf16_f32 v157, v158, v159
    v_mfma_f32_16x16x32_bf16 v[200:203], a[228:231], v[20:23], 0
    ds_write2st64_b64 v101, v[248:249], v[104:105] offset0:32 offset1:44
    v_mfma_f32_16x16x32_bf16 v[248:251], a[228:231], v[26:29], 0
    v_cvt_pk_bf16_f32 v109, v110, v111
    v_xor_b32 v101, 32, v101
    v_mfma_f32_16x16x32_bf16 a[40:43], a[228:231], v[32:35], 0
    ds_write2st64_b64 v101, v[156:157], v[204:205] offset0:8 offset1:20
    v_mfma_f32_16x16x32_bf16 a[44:47], a[232:235], v[32:35], 0
    ds_write2st64_b64 v101, v[252:253], v[108:109] offset0:32 offset1:44
    v_mfma_f32_16x16x32_bf16 v[252:255], a[232:235], v[26:29], 0
    ds_read_b128 v[88:91], v103 offset:3072
    v_exp_f32 v65, v65
    v_mfma_f32_16x16x32_bf16 v[204:207], a[232:235], v[20:23], 0
    v_cvt_pk_bf16_f32 v18, v52, v53
    v_exp_f32 v69, v69
    v_mfma_f32_16x16x32_bf16 v[156:159], a[232:235], v[14:17], 0
    s_waitcnt lgkmcnt(4)
    ds_read_b128 a[228:231], v0 offset:2048
    v_fma_f32 v56, v56, s28, v9
    v_mfma_f32_16x16x32_bf16 v[52:55], a[212:215], a[96:99], 0
    ds_read_b128 a[224:227], v1 offset:1024
    v_exp_f32 v74, v74
    v_mfma_f32_16x16x32_bf16 v[52:55], a[216:219], a[100:103], v[52:55]
    v_exp_f32 v67, v67
    v_mfma_f32_16x16x32_bf16 v[52:55], a[220:223], a[104:107], v[52:55]
    ds_read_b128 v[84:87], v103 offset:2048
    v_exp_f32 v57, v57
    v_mfma_f32_16x16x32_bf16 v[60:63], a[220:223], a[128:131], 0
    ds_read_b128 a[232:235], v1 offset:2048
    v_exp_f32 v56, v56
    v_mfma_f32_16x16x32_bf16 v[60:63], a[216:219], a[124:127], v[60:63]
    buffer_load_dwordx4 v6, s[8:11], s21 offen lds
    v_mfma_f32_16x16x32_bf16 v[60:63], a[212:215], a[120:123], v[60:63]
    s_add_u32 s21, s21, 128
    v_cvt_pk_bf16_f32 v30, v68, v69
    v_cvt_pk_bf16_f32 v16, v56, v57
    v_mfma_f32_16x16x32_bf16 v[68:71], a[212:215], a[144:147], 0
    s_add_u32 m0, s22, 25600
    v_exp_f32 v64, v64
    v_mfma_f32_16x16x32_bf16 v[68:71], a[216:219], a[148:151], v[68:71]
    v_exp_f32 v81, v81
    v_mfma_f32_16x16x32_bf16 v[68:71], a[220:223], a[152:155], v[68:71]
    buffer_load_dwordx4 v6, s[8:11], s21 offen lds
    v_mfma_f32_16x16x32_bf16 v[76:79], a[220:223], a[176:179], 0
    s_add_u32 s21, s21, 128
    v_exp_f32 v59, v59
    v_mfma_f32_16x16x32_bf16 v[76:79], a[216:219], a[172:175], v[76:79]
    v_exp_f32 v66, v66
    v_mfma_f32_16x16x32_bf16 v[76:79], a[212:215], a[168:171], v[76:79]
    s_waitcnt lgkmcnt(2)
    v_cvt_pk_bf16_f32 v17, v58, v59
    s_add_u32 m0, s22, 26624
    v_mfma_f32_16x16x32_bf16 v[76:79], a[224:227], a[180:183], v[76:79]
    buffer_load_dwordx4 v6, s[8:11], s21 offen lds
    v_mfma_f32_16x16x32_bf16 v[48:51], a[236:239], v[16:19], v[44:47]
    ds_read_b128 v[96:99], v103 offset:4096
    v_mfma_f32_16x16x32_bf16 v[76:79], a[228:231], a[184:187], v[76:79]
    s_waitcnt lgkmcnt(1)
    v_mfma_f32_16x16x32_bf16 v[76:79], a[232:235], a[188:191], v[76:79]
    s_add_u32 s21, s21, 12032
    ds_read_b128 a[216:219], v1 offset:6144
    v_cvt_pk_bf16_f32 v23, v66, v67
    v_mfma_f32_16x16x32_bf16 v[68:71], a[232:235], a[164:167], v[68:71]
    s_add_u32 s56, s67, 128
    v_cvt_pk_bf16_f32 v35, v82, v83
    v_mfma_f32_16x16x32_bf16 v[68:71], a[228:231], a[160:163], v[68:71]
    ds_read_b128 a[212:215], v0 offset:6144
    v_cvt_pk_bf16_f32 v22, v64, v65
    v_mfma_f32_16x16x32_bf16 v[68:71], a[224:227], a[156:159], v[68:71]
    buffer_store_dwordx4 v[84:87], v6, s[16:19], s56 offen offset:0 nt
    ds_read_b128 a[220:223], v0 offset:7168
    v_exp_f32 v75, v75
    v_mfma_f32_16x16x32_bf16 v[48:51], a[240:243], v[22:25], v[48:51]
    s_add_u32 s58, s33, 128
    v_cvt_pk_bf16_f32 v34, v80, v81
    s_add_u32 m0, s38, 2048
    v_mfma_f32_16x16x32_bf16 v[60:63], a[224:227], a[132:135], v[60:63]
    buffer_load_dwordx4 v6, s[12:15], s58 offen nt lds
    v_mfma_f32_16x16x32_bf16 v[60:63], a[228:231], a[136:139], v[60:63]
    ds_read_b128 v[84:87], v103 offset:5120
    v_cvt_pk_bf16_f32 v28, v72, v73
    v_mfma_f32_16x16x32_bf16 v[60:63], a[232:235], a[140:143], v[60:63]
    v_cvt_pk_bf16_f32 v29, v74, v75
    s_add_u32 m0, s38, 3072
    v_mfma_f32_16x16x32_bf16 v[52:55], a[232:235], a[116:119], v[52:55]
    v_mfma_f32_16x16x32_bf16 v[48:51], a[244:247], v[28:31], v[48:51]
    buffer_load_dwordx4 v7, s[12:15], s58 offen nt lds
    v_mfma_f32_16x16x32_bf16 v[48:51], a[248:251], v[34:37], v[48:51]
    s_add_u32 s57, s67, 256
    ds_read_b128 a[232:235], v1 offset:8192
    v_mov_b32 v39, v7
    v_mfma_f32_16x16x32_bf16 v[52:55], a[228:231], a[112:115], v[52:55]
    s_add_u32 s59, s33, 256
    ds_read_b128 a[228:231], v0 offset:8192
    s_add_u32 m0, s38, 4096
    v_mfma_f32_16x16x32_bf16 v[52:55], a[224:227], a[108:111], v[52:55]
    s_waitcnt lgkmcnt(4)
    ds_read_b128 a[224:227], v1 offset:7168
    v_cmp_lt_f32 vcc, s29, v48
    v_mfma_f32_16x16x32_bf16 v[56:59], a[212:215], a[96:99], 0
    buffer_load_dwordx4 v6, s[12:15], s59 offen nt lds
    v_mfma_f32_16x16x32_bf16 v[56:59], a[216:219], a[100:103], v[56:59]
    buffer_store_dwordx4 v[88:91], v7, s[16:19], s56 offen offset:0 nt
    s_add_u32 m0, s38, 5120
    s_cbranch_vccnz L_rs_tr44d
L_ret_tr44d:
    v_fma_f32 v52, v52, s28, v9
    s_waitcnt lgkmcnt(3)
    v_mfma_f32_16x16x32_bf16 v[56:59], a[220:223], a[104:107], v[56:59]
    v_fma_f32 v53, v53, s28, v9
    v_mfma_f32_16x16x32_bf16 v[64:67], a[220:223], a[128:131], 0
    v_exp_f32 v53, v53
    v_mfma_f32_16x16x32_bf16 v[64:67], a[216:219], a[124:127], v[64:67]
    v_exp_f32 v52, v52
    v_mfma_f32_16x16x32_bf16 v[64:67], a[212:215], a[120:123], v[64:67]
    v_fma_f32 v54, v54, s28, v9
    v_fma_f32 v55, v55, s28, v9
    v_mfma_f32_16x16x32_bf16 v[72:75], a[212:215], a[144:147], 0
    v_exp_f32 v55, v55
    v_mfma_f32_16x16x32_bf16 v[72:75], a[216:219], a[148:151], v[72:75]
    buffer_load_dwordx4 v7, s[12:15], s59 offen nt lds
    v_mfma_f32_16x16x32_bf16 v[72:75], a[220:223], a[152:155], v[72:75]
    v_mfma_f32_16x16x32_bf16 v[80:83], a[220:223], a[176:179], 0
    s_waitcnt vmcnt(16) lgkmcnt(0)
    v_exp_f32 v54, v54
    v_mfma_f32_16x16x32_bf16 v[80:83], a[216:219], a[172:175], v[80:83]
    buffer_store_dwordx4 v[96:99], v6, s[16:19], s57 offen offset:0 nt
    s_barrier
    v_fma_f32 v60, v60, s28, v10
    v_mfma_f32_16x16x32_bf16 v[80:83], a[212:215], a[168:171], v[80:83]
    s_add_u32 m0, s22, 0
    ds_read_b64_tr_b16 a[212:213], v2 offset:18432
    v_add_u32 v103, 6144, v103
    v_mfma_f32_16x16x32_bf16 v[80:83], a[224:227], a[180:183], v[80:83]
    buffer_load_dwordx4 v6, s[4:7], s20 offen lds
    v_mfma_f32_16x16x32_bf16 v[80:83], a[228:231], a[184:187], v[80:83]
    s_add_u32 s20, s20, 128
    ds_read_b64_tr_b16 a[214:215], v2 offset:12288
    v_mfma_f32_16x16x32_bf16 v[80:83], a[232:235], a[188:191], v[80:83]
    v_exp_f32 v60, v60
    v_mfma_f32_16x16x32_bf16 v[72:75], a[232:235], a[164:167], v[72:75]
    s_add_u32 m0, s22, 1024
    ds_read_b64_tr_b16 a[216:217], v3 offset:18432
    v_mfma_f32_16x16x32_bf16 v[72:75], a[228:231], a[160:163], v[72:75]
    buffer_load_dwordx4 v6, s[4:7], s20 offen lds
    v_mfma_f32_16x16x32_bf16 v[72:75], a[224:227], a[156:159], v[72:75]
    s_add_u32 s20, s20, 128
    ds_read_b64_tr_b16 a[218:219], v3 offset:12288
    v_cvt_pk_bf16_f32 v15, v54, v55
    v_mfma_f32_16x16x32_bf16 v[64:67], a[224:227], a[132:135], v[64:67]
    s_add_u32 m0, s22, 2048
    v_mfma_f32_16x16x32_bf16 v[64:67], a[228:231], a[136:139], v[64:67]
    ds_read_b64_tr_b16 a[220:221], v4 offset:18432
    v_cvt_pk_bf16_f32 v14, v52, v53
    v_mfma_f32_16x16x32_bf16 v[64:67], a[232:235], a[140:143], v[64:67]
    ds_read_b64_tr_b16 a[222:223], v4 offset:12288
    v_fma_f32 v61, v61, s28, v10
    v_mfma_f32_16x16x32_bf16 v[56:59], a[232:235], a[116:119], v[56:59]
    buffer_load_dwordx4 v6, s[4:7], s20 offen lds
    v_mfma_f32_16x16x32_bf16 v[56:59], a[228:231], a[112:115], v[56:59]
    s_add_u32 s20, s20, 12032
    v_exp_f32 v61, v61
    v_mfma_f32_16x16x32_bf16 v[56:59], a[224:227], a[108:111], v[56:59]
    buffer_store_dwordx4 v[84:87], v7, s[16:19], s57 offen offset:0 nt
    s_waitcnt lgkmcnt(4)
    ds_read_b64_tr_b16 a[224:225], v5 offset:18432
    ds_read_b64_tr_b16 a[226:227], v5 offset:12288
    v_cvt_pk_bf16_f32 v20, v60, v61
    s_branch L_loop4
L_end5:
    v_mfma_f32_16x16x32_bf16 v[112:115], a[212:215], v[16:19], v[112:115]
    v_mfma_f32_16x16x32_bf16 v[116:119], a[216:219], v[16:19], v[116:119]
    ds_read_b64_tr_b16 a[230:231], v2 offset:13312
    v_mfma_f32_16x16x32_bf16 v[164:167], a[216:219], v[22:25], v[164:167]
    v_fma_f32 v73, v73, s28, v11
    v_mfma_f32_16x16x32_bf16 v[160:163], a[212:215], v[22:25], v[160:163]
    ds_read_b64_tr_b16 a[234:235], v3 offset:13312
    v_fma_f32 v69, v69, s28, v11
    v_mfma_f32_16x16x32_bf16 v[208:211], a[212:215], v[28:31], v[208:211]
    v_fma_f32 v64, v64, s28, v10
    v_mfma_f32_16x16x32_bf16 v[212:215], a[216:219], v[28:31], v[212:215]
    v_fma_f32 v77, v77, s28, v12
    v_mfma_f32_16x16x32_bf16 a[4:7], a[216:219], v[34:37], a[4:7]
    ds_read_b64_tr_b16 a[228:229], v2 offset:19456
    v_fma_f32 v57, v57, s28, v9
    v_mfma_f32_16x16x32_bf16 a[0:3], a[212:215], v[34:37], a[0:3]
    v_fma_f32 v71, v71, s28, v11
    v_fma_f32 v84, v84, s28, v13
    v_mfma_f32_16x16x32_bf16 a[48:51], a[212:215], v[40:43], a[48:51]
    ds_read_b64_tr_b16 a[232:233], v3 offset:19456
    v_fma_f32 v85, v85, s28, v13
    v_mfma_f32_16x16x32_bf16 a[52:55], a[216:219], v[40:43], a[52:55]
    s_waitcnt lgkmcnt(4)
    v_mfma_f32_16x16x32_bf16 a[56:59], a[220:223], v[40:43], a[56:59]
    ds_read_b64_tr_b16 a[218:219], v5 offset:13312
    v_fma_f32 v68, v68, s28, v11
    v_mfma_f32_16x16x32_bf16 a[60:63], a[224:227], v[40:43], a[60:63]
    ds_read_b64_tr_b16 a[212:213], v4 offset:19456
    v_fma_f32 v56, v56, s28, v9
    v_mfma_f32_16x16x32_bf16 a[12:15], a[224:227], v[34:37], a[12:15]
    ds_read_b64_tr_b16 a[216:217], v5 offset:19456
    v_fma_f32 v91, v91, s28, v13
    v_mfma_f32_16x16x32_bf16 a[8:11], a[220:223], v[34:37], a[8:11]
    v_fma_f32 v76, v76, s28, v12
    v_mfma_f32_16x16x32_bf16 v[216:219], a[220:223], v[28:31], v[216:219]
    v_fma_f32 v82, v82, s28, v12
    v_mfma_f32_16x16x32_bf16 v[220:223], a[224:227], v[28:31], v[220:223]
    v_fma_f32 v70, v70, s28, v11
    v_mfma_f32_16x16x32_bf16 v[172:175], a[224:227], v[22:25], v[172:175]
    v_exp_f32 v69, v69
    v_mfma_f32_16x16x32_bf16 v[168:171], a[220:223], v[22:25], v[168:171]
    v_exp_f32 v82, v82
    v_mfma_f32_16x16x32_bf16 v[120:123], a[220:223], v[16:19], v[120:123]
    ds_read_b64_tr_b16 a[214:215], v4 offset:13312
    v_mfma_f32_16x16x32_bf16 v[124:127], a[224:227], v[16:19], v[124:127]
    s_waitcnt lgkmcnt(4)
    v_exp_f32 v70, v70
    v_mfma_f32_16x16x32_bf16 v[128:131], a[228:231], v[16:19], v[128:131]
    ds_read_b64_tr_b16 a[224:225], v3 offset:20480
    v_fma_f32 v65, v65, s28, v10
    v_mfma_f32_16x16x32_bf16 v[132:135], a[232:235], v[16:19], v[132:135]
    v_exp_f32 v68, v68
    v_mfma_f32_16x16x32_bf16 v[180:183], a[232:235], v[22:25], v[180:183]
    v_fma_f32 v78, v78, s28, v12
    v_cvt_pk_bf16_f32 v26, v68, v69
    v_mfma_f32_16x16x32_bf16 v[176:179], a[228:231], v[22:25], v[176:179]
    ds_read_b64_tr_b16 a[220:221], v2 offset:20480
    v_fma_f32 v74, v74, s28, v11
    v_mfma_f32_16x16x32_bf16 v[224:227], a[228:231], v[28:31], v[224:227]
    v_fma_f32 v81, v81, s28, v12
    v_fma_f32 v86, v86, s28, v13
    v_mfma_f32_16x16x32_bf16 v[228:231], a[232:235], v[28:31], v[228:231]
    ds_read_b64_tr_b16 a[222:223], v2 offset:14336
    v_fma_f32 v59, v59, s28, v9
    v_mfma_f32_16x16x32_bf16 a[20:23], a[232:235], v[34:37], a[20:23]
    v_exp_f32 v74, v74
    v_mfma_f32_16x16x32_bf16 a[16:19], a[228:231], v[34:37], a[16:19]
    v_exp_f32 v78, v78
    v_mfma_f32_16x16x32_bf16 a[64:67], a[228:231], v[40:43], a[64:67]
    ds_read_b64_tr_b16 a[228:229], v4 offset:20480
    v_fma_f32 v83, v83, s28, v12
    v_mfma_f32_16x16x32_bf16 a[68:71], a[232:235], v[40:43], a[68:71]
    s_waitcnt lgkmcnt(4)
    ds_read_b64_tr_b16 a[226:227], v3 offset:14336
    v_fma_f32 v75, v75, s28, v11
    v_mfma_f32_16x16x32_bf16 a[72:75], a[212:215], v[40:43], a[72:75]
    v_exp_f32 v84, v84
    v_mfma_f32_16x16x32_bf16 a[76:79], a[216:219], v[40:43], a[76:79]
    v_fma_f32 v87, v87, s28, v13
    v_mfma_f32_16x16x32_bf16 a[28:31], a[216:219], v[34:37], a[28:31]
    v_exp_f32 v71, v71
    v_mfma_f32_16x16x32_bf16 a[24:27], a[212:215], v[34:37], a[24:27]
    v_exp_f32 v85, v85
    v_mfma_f32_16x16x32_bf16 v[232:235], a[212:215], v[28:31], v[232:235]
    ds_read_b64_tr_b16 a[232:233], v5 offset:20480
    v_fma_f32 v58, v58, s28, v9
    v_mfma_f32_16x16x32_bf16 v[236:239], a[216:219], v[28:31], v[236:239]
    ds_read_b64_tr_b16 a[230:231], v4 offset:14336
    v_fma_f32 v66, v66, s28, v10
    v_mfma_f32_16x16x32_bf16 v[188:191], a[216:219], v[22:25], v[188:191]
    ds_read_b64_tr_b16 a[234:235], v5 offset:14336
    v_mfma_f32_16x16x32_bf16 v[184:187], a[212:215], v[22:25], v[184:187]
    v_exp_f32 v73, v73
    v_mfma_f32_16x16x32_bf16 v[136:139], a[212:215], v[16:19], v[136:139]
    v_fma_f32 v79, v79, s28, v12
    v_mfma_f32_16x16x32_bf16 v[140:143], a[216:219], v[16:19], v[140:143]
    s_waitcnt lgkmcnt(3)
    v_exp_f32 v87, v87
    v_mfma_f32_16x16x32_bf16 v[144:147], a[220:223], v[16:19], v[144:147]
    v_exp_f32 v86, v86
    v_mfma_f32_16x16x32_bf16 v[148:151], a[224:227], v[16:19], v[148:151]
    s_add_u32 s39, s39, 12288
    v_exp_f32 v77, v77
    v_mfma_f32_16x16x32_bf16 v[196:199], a[224:227], v[22:25], v[196:199]
    v_fma_f32 v90, v90, s28, v13
    v_fma_f32 v72, v72, s28, v11
    v_mfma_f32_16x16x32_bf16 v[192:195], a[220:223], v[22:25], v[192:195]
    v_exp_f32 v59, v59
    v_mfma_f32_16x16x32_bf16 v[240:243], a[220:223], v[28:31], v[240:243]
    v_exp_f32 v66, v66
    v_mfma_f32_16x16x32_bf16 v[244:247], a[224:227], v[28:31], v[244:247]
    v_exp_f32 v57, v57
    v_mfma_f32_16x16x32_bf16 a[36:39], a[224:227], v[34:37], a[36:39]
    v_exp_f32 v58, v58
    v_mfma_f32_16x16x32_bf16 a[32:35], a[220:223], v[34:37], a[32:35]
    s_waitcnt vmcnt(10) lgkmcnt(0)
    v_exp_f32 v76, v76
    v_mfma_f32_16x16x32_bf16 a[80:83], a[220:223], v[40:43], a[80:83]
    v_exp_f32 v83, v83
    v_mfma_f32_16x16x32_bf16 a[84:87], a[224:227], v[40:43], a[84:87]
    s_barrier
    ds_read_b128 a[212:215], v0 offset:12288
    v_mfma_f32_16x16x32_bf16 a[88:91], a[228:231], v[40:43], a[88:91]
    ds_read_b128 a[216:219], v1 offset:12288
    s_add_u32 m0, s22, 36864
    v_mfma_f32_16x16x32_bf16 a[92:95], a[232:235], v[40:43], a[92:95]
    ds_read_b128 a[220:223], v0 offset:13312
    v_cvt_pk_bf16_f32 v38, v84, v85
    v_mfma_f32_16x16x32_bf16 a[44:47], a[232:235], v[34:37], a[44:47]
    v_exp_f32 v79, v79
    v_mfma_f32_16x16x32_bf16 a[40:43], a[228:231], v[34:37], a[40:43]
    v_fma_f32 v89, v89, s28, v13
    v_mfma_f32_16x16x32_bf16 v[248:251], a[228:231], v[28:31], v[248:251]
    buffer_load_dwordx4 v6, s[8:11], s21 offen lds
    v_mfma_f32_16x16x32_bf16 v[252:255], a[232:235], v[28:31], v[252:255]
    s_add_u32 s21, s21, 128
    s_add_u32 m0, s22, 37888
    v_fma_f32 v67, v67, s28, v10
    v_mfma_f32_16x16x32_bf16 v[204:207], a[232:235], v[22:25], v[204:207]
    buffer_load_dwordx4 v6, s[8:11], s21 offen lds
    v_mfma_f32_16x16x32_bf16 v[200:203], a[228:231], v[22:25], v[200:203]
    s_add_u32 s21, s21, 128
    v_cvt_pk_bf16_f32 v39, v86, v87
    s_add_u32 m0, s22, 38912
    v_mfma_f32_16x16x32_bf16 v[152:155], a[228:231], v[16:19], v[152:155]
    buffer_load_dwordx4 v6, s[8:11], s21 offen lds
    v_mfma_f32_16x16x32_bf16 v[156:159], a[232:235], v[16:19], v[156:159]
    s_waitcnt lgkmcnt(2)
    v_exp_f32 v90, v90
    v_mfma_f32_16x16x32_bf16 v[52:55], a[212:215], a[96:99], 0
    s_waitcnt lgkmcnt(1)
    v_cvt_pk_bf16_f32 v32, v76, v77
    v_mfma_f32_16x16x32_bf16 v[52:55], a[216:219], a[100:103], v[52:55]
    s_waitcnt lgkmcnt(0)
    ds_read_b128 a[224:227], v1 offset:13312
    v_fma_f32 v88, v88, s28, v13
    v_mfma_f32_16x16x32_bf16 v[52:55], a[220:223], a[104:107], v[52:55]
    ds_read_b128 a[228:231], v0 offset:14336
    v_mfma_f32_16x16x32_bf16 v[60:63], a[220:223], a[128:131], 0
    v_exp_f32 v91, v91
    v_mfma_f32_16x16x32_bf16 v[60:63], a[216:219], a[124:127], v[60:63]
    v_cvt_pk_bf16_f32 v33, v78, v79
    v_cvt_pk_bf16_f32 v27, v70, v71
    v_mfma_f32_16x16x32_bf16 v[60:63], a[212:215], a[120:123], v[60:63]
    ds_read_b128 a[232:235], v1 offset:14336
    v_mfma_f32_16x16x32_bf16 v[68:71], a[212:215], a[144:147], 0
    v_exp_f32 v56, v56
    v_mfma_f32_16x16x32_bf16 v[68:71], a[216:219], a[148:151], v[68:71]
    v_exp_f32 v75, v75
    v_mfma_f32_16x16x32_bf16 v[68:71], a[220:223], a[152:155], v[68:71]
    v_cvt_pk_bf16_f32 v29, v74, v75
    v_cvt_pk_bf16_f32 v41, v90, v91
    v_mfma_f32_16x16x32_bf16 v[76:79], a[220:223], a[176:179], 0
    v_exp_f32 v72, v72
    v_mfma_f32_16x16x32_bf16 v[76:79], a[216:219], a[172:175], v[76:79]
    v_exp_f32 v89, v89
    v_mfma_f32_16x16x32_bf16 v[76:79], a[212:215], a[168:171], v[76:79]
    v_exp_f32 v67, v67
    v_mfma_f32_16x16x32_bf16 v[84:87], a[212:215], a[192:195], 0
    v_exp_f32 v81, v81
    v_mfma_f32_16x16x32_bf16 v[84:87], a[216:219], a[196:199], v[84:87]
    v_mfma_f32_16x16x32_bf16 v[84:87], a[220:223], a[200:203], v[84:87]
    s_waitcnt lgkmcnt(1)
    v_mfma_f32_16x16x32_bf16 v[84:87], a[224:227], a[204:207], v[84:87]
    v_cvt_pk_bf16_f32 v16, v56, v57
    v_fma_f32 v80, v80, s28, v12
    v_mfma_f32_16x16x32_bf16 v[84:87], a[228:231], a[208:211], v[84:87]
    s_waitcnt lgkmcnt(0)
    v_exp_f32 v65, v65
    v_mfma_f32_16x16x32_bf16 v[84:87], a[232:235], v[92:95], v[84:87]
    v_cvt_pk_bf16_f32 v23, v66, v67
    v_mfma_f32_16x16x32_bf16 v[76:79], a[232:235], a[188:191], v[76:79]
    v_exp_f32 v64, v64
    v_mfma_f32_16x16x32_bf16 v[76:79], a[228:231], a[184:187], v[76:79]
    ds_read_b128 a[216:219], v1 offset:18432
    v_mfma_f32_16x16x32_bf16 v[76:79], a[224:227], a[180:183], v[76:79]
    s_add_u32 s21, s21, 12032
    v_mfma_f32_16x16x32_bf16 v[68:71], a[224:227], a[156:159], v[68:71]
    ds_read_b128 a[212:215], v0 offset:18432
    v_cvt_pk_bf16_f32 v22, v64, v65
    v_mfma_f32_16x16x32_bf16 v[68:71], a[228:231], a[160:163], v[68:71]
    v_exp_f32 v80, v80
    v_mfma_f32_16x16x32_bf16 v[68:71], a[232:235], a[164:167], v[68:71]
    v_cvt_pk_bf16_f32 v34, v80, v81
    v_cvt_pk_bf16_f32 v17, v58, v59
    v_mfma_f32_16x16x32_bf16 v[60:63], a[232:235], a[140:143], v[60:63]
    v_exp_f32 v88, v88
    v_mfma_f32_16x16x32_bf16 v[44:47], a[236:239], v[14:17], v[48:51]
    ds_read_b128 a[220:223], v0 offset:19456
    v_mfma_f32_16x16x32_bf16 v[60:63], a[228:231], a[136:139], v[60:63]
    v_mfma_f32_16x16x32_bf16 v[60:63], a[224:227], a[132:135], v[60:63]
    v_mfma_f32_16x16x32_bf16 v[44:47], a[240:243], v[20:23], v[44:47]
    v_cvt_pk_bf16_f32 v40, v88, v89
    v_cvt_pk_bf16_f32 v28, v72, v73
    v_mfma_f32_16x16x32_bf16 v[52:55], a[224:227], a[108:111], v[52:55]
    v_cvt_pk_bf16_f32 v35, v82, v83
    v_mfma_f32_16x16x32_bf16 v[52:55], a[228:231], a[112:115], v[52:55]
    ds_read_b128 a[224:227], v1 offset:19456
    v_mfma_f32_16x16x32_bf16 v[44:47], a[244:247], v[26:29], v[44:47]
    v_mfma_f32_16x16x32_bf16 v[52:55], a[232:235], a[116:119], v[52:55]
    ds_read_b128 a[232:235], v1 offset:20480
    v_mfma_f32_16x16x32_bf16 v[44:47], a[248:251], v[32:35], v[44:47]
    ds_read_b128 a[228:231], v0 offset:20480
    v_mfma_f32_16x16x32_bf16 v[44:47], a[252:255], v[38:41], v[44:47]
    s_waitcnt lgkmcnt(4)
    v_mfma_f32_16x16x32_bf16 v[56:59], a[212:215], a[96:99], 0
    v_mfma_f32_16x16x32_bf16 v[56:59], a[216:219], a[100:103], v[56:59]
    s_waitcnt lgkmcnt(3)
    v_mfma_f32_16x16x32_bf16 v[56:59], a[220:223], a[104:107], v[56:59]
    v_mfma_f32_16x16x32_bf16 v[64:67], a[220:223], a[128:131], 0
    s_nop 1
    v_cmp_lt_f32 vcc, s29, v44
    v_mfma_f32_16x16x32_bf16 v[64:67], a[216:219], a[124:127], v[64:67]
    v_mfma_f32_16x16x32_bf16 v[64:67], a[212:215], a[120:123], v[64:67]
    v_mfma_f32_16x16x32_bf16 v[72:75], a[212:215], a[144:147], 0
    v_mfma_f32_16x16x32_bf16 v[72:75], a[216:219], a[148:151], v[72:75]
    s_nop 0
    s_cbranch_vccnz L_rs_end5a
L_ret_end5a:
    v_mfma_f32_16x16x32_bf16 v[72:75], a[220:223], a[152:155], v[72:75]
    s_waitcnt vmcnt(6) lgkmcnt(0)
    v_mfma_f32_16x16x32_bf16 v[80:83], a[220:223], a[176:179], 0
    s_barrier
    v_mfma_f32_16x16x32_bf16 v[80:83], a[216:219], a[172:175], v[80:83]
    v_fma_f32 v60, v60, s28, v10
    v_fma_f32 v52, v52, s28, v9
    v_mfma_f32_16x16x32_bf16 v[80:83], a[212:215], a[168:171], v[80:83]
    v_exp_f32 v60, v60
    v_mfma_f32_16x16x32_bf16 v[88:91], a[212:215], a[192:195], 0
    ds_read_b64_tr_b16 a[212:213], v2 offset:0
    v_fma_f32 v55, v55, s28, v9
    v_mfma_f32_16x16x32_bf16 v[88:91], a[216:219], a[196:199], v[88:91]
    ds_read_b64_tr_b16 a[214:215], v2 offset:6144
    v_fma_f32 v53, v53, s28, v9
    v_mfma_f32_16x16x32_bf16 v[88:91], a[220:223], a[200:203], v[88:91]
    v_fma_f32 v54, v54, s28, v9
    v_fma_f32 v61, v61, s28, v10
    v_mfma_f32_16x16x32_bf16 v[88:91], a[224:227], a[204:207], v[88:91]
    ds_read_b64_tr_b16 a[216:217], v3 offset:0
    v_fma_f32 v63, v63, s28, v10
    v_mfma_f32_16x16x32_bf16 v[88:91], a[228:231], a[208:211], v[88:91]
    v_mfma_f32_16x16x32_bf16 v[88:91], a[232:235], v[92:95], v[88:91]
    ds_read_b64_tr_b16 a[218:219], v3 offset:6144
    v_fma_f32 v62, v62, s28, v10
    v_mfma_f32_16x16x32_bf16 v[80:83], a[232:235], a[188:191], v[80:83]
    v_exp_f32 v52, v52
    v_mfma_f32_16x16x32_bf16 v[80:83], a[228:231], a[184:187], v[80:83]
    v_exp_f32 v53, v53
    v_mfma_f32_16x16x32_bf16 v[80:83], a[224:227], a[180:183], v[80:83]
    v_cvt_pk_bf16_f32 v18, v52, v53
    v_mfma_f32_16x16x32_bf16 v[72:75], a[224:227], a[156:159], v[72:75]
    v_exp_f32 v54, v54
    v_mfma_f32_16x16x32_bf16 v[72:75], a[228:231], a[160:163], v[72:75]
    ds_read_b64_tr_b16 a[220:221], v4 offset:0
    v_mfma_f32_16x16x32_bf16 v[72:75], a[232:235], a[164:167], v[72:75]
    v_exp_f32 v62, v62
    v_mfma_f32_16x16x32_bf16 v[64:67], a[232:235], a[140:143], v[64:67]
    v_exp_f32 v55, v55
    v_mfma_f32_16x16x32_bf16 v[64:67], a[228:231], a[136:139], v[64:67]
    v_exp_f32 v61, v61
    v_mfma_f32_16x16x32_bf16 v[64:67], a[224:227], a[132:135], v[64:67]
    v_exp_f32 v63, v63
    v_mfma_f32_16x16x32_bf16 v[56:59], a[224:227], a[108:111], v[56:59]
    ds_read_b64_tr_b16 a[222:223], v4 offset:6144
    v_cvt_pk_bf16_f32 v24, v60, v61
    v_mfma_f32_16x16x32_bf16 v[56:59], a[228:231], a[112:115], v[56:59]
    ds_read_b64_tr_b16 a[224:225], v5 offset:0
    v_cvt_pk_bf16_f32 v19, v54, v55
    v_mfma_f32_16x16x32_bf16 v[56:59], a[232:235], a[116:119], v[56:59]
    s_waitcnt lgkmcnt(3)
    ds_read_b64_tr_b16 a[226:227], v5 offset:6144
    v_cvt_pk_bf16_f32 v25, v62, v63
    v_mfma_f32_16x16x32_bf16 v[112:115], a[212:215], v[14:17], v[112:115]
    v_fma_f32 v70, v70, s28, v11
    v_fma_f32 v64, v64, s28, v10
    v_mfma_f32_16x16x32_bf16 v[116:119], a[216:219], v[14:17], v[116:119]
    v_fma_f32 v66, v66, s28, v10
    v_fma_f32 v56, v56, s28, v9
    v_mfma_f32_16x16x32_bf16 v[164:167], a[216:219], v[20:23], v[164:167]
    ds_read_b64_tr_b16 a[230:231], v2 offset:7168
    v_fma_f32 v71, v71, s28, v11
    v_mfma_f32_16x16x32_bf16 v[160:163], a[212:215], v[20:23], v[160:163]
    v_fma_f32 v69, v69, s28, v11
    v_fma_f32 v77, v77, s28, v12
    v_mfma_f32_16x16x32_bf16 v[208:211], a[212:215], v[26:29], v[208:211]
    ds_read_b64_tr_b16 a[228:229], v2 offset:1024
    v_fma_f32 v68, v68, s28, v11
    v_mfma_f32_16x16x32_bf16 v[212:215], a[216:219], v[26:29], v[212:215]
    v_fma_f32 v76, v76, s28, v12
    v_fma_f32 v72, v72, s28, v11
    v_mfma_f32_16x16x32_bf16 a[4:7], a[216:219], v[32:35], a[4:7]
    v_exp_f32 v66, v66
    v_mfma_f32_16x16x32_bf16 a[0:3], a[212:215], v[32:35], a[0:3]
    v_fma_f32 v89, v89, s28, v13
    v_fma_f32 v82, v82, s28, v12
    v_mfma_f32_16x16x32_bf16 a[48:51], a[212:215], v[38:41], a[48:51]
    s_add_u32 s39, s39, 12288
    ds_read_b64_tr_b16 a[232:233], v3 offset:1024
    v_fma_f32 v83, v83, s28, v12
    v_mfma_f32_16x16x32_bf16 a[52:55], a[216:219], v[38:41], a[52:55]
    s_waitcnt lgkmcnt(3)
    ds_read_b64_tr_b16 a[234:235], v3 offset:7168
    v_fma_f32 v79, v79, s28, v12
    v_mfma_f32_16x16x32_bf16 a[56:59], a[220:223], v[38:41], a[56:59]
    s_waitcnt vmcnt(0)
    v_fma_f32 v74, v74, s28, v11
    v_fma_f32 v86, v86, s28, v13
    v_mfma_f32_16x16x32_bf16 a[60:63], a[224:227], v[38:41], a[60:63]
    ds_read_b64_tr_b16 a[214:215], v4 offset:7168
    v_fma_f32 v87, v87, s28, v13
    v_mfma_f32_16x16x32_bf16 a[12:15], a[224:227], v[32:35], a[12:15]
    s_barrier
    v_mfma_f32_16x16x32_bf16 a[8:11], a[220:223], v[32:35], a[8:11]
    v_exp_f32 v56, v56
    v_mfma_f32_16x16x32_bf16 v[216:219], a[220:223], v[26:29], v[216:219]
    ds_read_b64_tr_b16 a[216:217], v5 offset:1024
    v_fma_f32 v73, v73, s28, v11
    v_mfma_f32_16x16x32_bf16 v[220:223], a[224:227], v[26:29], v[220:223]
    v_exp_f32 v71, v71
    v_mfma_f32_16x16x32_bf16 v[172:175], a[224:227], v[20:23], v[172:175]
    v_fma_f32 v84, v84, s28, v13
    v_fma_f32 v81, v81, s28, v12
    v_mfma_f32_16x16x32_bf16 v[168:171], a[220:223], v[20:23], v[168:171]
    ds_read_b64_tr_b16 a[218:219], v5 offset:7168
    v_fma_f32 v91, v91, s28, v13
    v_mfma_f32_16x16x32_bf16 v[120:123], a[220:223], v[14:17], v[120:123]
    ds_read_b64_tr_b16 a[212:213], v4 offset:1024
    v_fma_f32 v58, v58, s28, v9
    v_mfma_f32_16x16x32_bf16 v[124:127], a[224:227], v[14:17], v[124:127]
    s_waitcnt lgkmcnt(4)
    v_exp_f32 v76, v76
    v_mfma_f32_16x16x32_bf16 v[128:131], a[228:231], v[14:17], v[128:131]
    v_exp_f32 v74, v74
    v_mfma_f32_16x16x32_bf16 v[132:135], a[232:235], v[14:17], v[132:135]
    ds_read_b64_tr_b16 a[224:225], v3 offset:2048
    v_fma_f32 v85, v85, s28, v13
    v_mfma_f32_16x16x32_bf16 v[180:183], a[232:235], v[20:23], v[180:183]
    ds_read_b64_tr_b16 a[222:223], v2 offset:8192
    v_fma_f32 v67, v67, s28, v10
    v_fma_f32 v90, v90, s28, v13
    v_mfma_f32_16x16x32_bf16 v[176:179], a[228:231], v[20:23], v[176:179]
    v_exp_f32 v91, v91
    v_mfma_f32_16x16x32_bf16 v[224:227], a[228:231], v[26:29], v[224:227]
    v_exp_f32 v70, v70
    v_mfma_f32_16x16x32_bf16 v[228:231], a[232:235], v[26:29], v[228:231]
    v_exp_f32 v82, v82
    v_mfma_f32_16x16x32_bf16 a[20:23], a[232:235], v[32:35], a[20:23]
    ds_read_b64_tr_b16 a[220:221], v2 offset:2048
    v_fma_f32 v65, v65, s28, v10
    v_mfma_f32_16x16x32_bf16 a[16:19], a[228:231], v[32:35], a[16:19]
    v_exp_f32 v64, v64
    v_mfma_f32_16x16x32_bf16 a[64:67], a[228:231], v[38:41], a[64:67]
    ds_read_b64_tr_b16 a[226:227], v3 offset:8192
    v_exp_f32 v65, v65
    v_mfma_f32_16x16x32_bf16 a[68:71], a[232:235], v[38:41], a[68:71]
    s_waitcnt lgkmcnt(4)
    v_fma_f32 v75, v75, s28, v11
    v_fma_f32 v59, v59, s28, v9
    v_mfma_f32_16x16x32_bf16 a[72:75], a[212:215], v[38:41], a[72:75]
    ds_read_b64_tr_b16 a[230:231], v4 offset:8192
    v_fma_f32 v88, v88, s28, v13
    v_mfma_f32_16x16x32_bf16 a[76:79], a[216:219], v[38:41], a[76:79]
    ds_read_b64_tr_b16 a[232:233], v5 offset:2048
    v_fma_f32 v80, v80, s28, v12
    v_mfma_f32_16x16x32_bf16 a[28:31], a[216:219], v[32:35], a[28:31]
    v_exp_f32 v79, v79
    v_mfma_f32_16x16x32_bf16 a[24:27], a[212:215], v[32:35], a[24:27]
    ds_read_b64_tr_b16 a[234:235], v5 offset:8192
    v_exp_f32 v84, v84
    v_mfma_f32_16x16x32_bf16 v[232:235], a[212:215], v[26:29], v[232:235]
    v_exp_f32 v83, v83
    v_mfma_f32_16x16x32_bf16 v[236:239], a[216:219], v[26:29], v[236:239]
    v_exp_f32 v77, v77
    v_mfma_f32_16x16x32_bf16 v[188:191], a[216:219], v[20:23], v[188:191]
    v_exp_f32 v81, v81
    v_mfma_f32_16x16x32_bf16 v[184:187], a[212:215], v[20:23], v[184:187]
    v_exp_f32 v89, v89
    v_mfma_f32_16x16x32_bf16 v[136:139], a[212:215], v[14:17], v[136:139]
    v_exp_f32 v73, v73
    v_mfma_f32_16x16x32_bf16 v[140:143], a[216:219], v[14:17], v[140:143]
    s_waitcnt lgkmcnt(3)
    ds_read_b64_tr_b16 a[228:229], v4 offset:2048
    v_fma_f32 v78, v78, s28, v12
    v_mfma_f32_16x16x32_bf16 v[144:147], a[220:223], v[14:17], v[144:147]
    v_exp_f32 v90, v90
    v_mfma_f32_16x16x32_bf16 v[148:151], a[224:227], v[14:17], v[148:151]
    v_exp_f32 v59, v59
    v_fma_f32 v57, v57, s28, v9
    v_mfma_f32_16x16x32_bf16 v[196:199], a[224:227], v[20:23], v[196:199]
    v_exp_f32 v85, v85
    v_mfma_f32_16x16x32_bf16 v[192:195], a[220:223], v[20:23], v[192:195]
    v_exp_f32 v57, v57
    v_mfma_f32_16x16x32_bf16 v[240:243], a[220:223], v[26:29], v[240:243]
    v_exp_f32 v80, v80
    v_mfma_f32_16x16x32_bf16 v[244:247], a[224:227], v[26:29], v[244:247]
    v_exp_f32 v75, v75
    v_mfma_f32_16x16x32_bf16 a[36:39], a[224:227], v[32:35], a[36:39]
    v_exp_f32 v78, v78
    v_mfma_f32_16x16x32_bf16 a[32:35], a[220:223], v[32:35], a[32:35]
    v_exp_f32 v88, v88
    v_mfma_f32_16x16x32_bf16 a[80:83], a[220:223], v[38:41], a[80:83]
    v_exp_f32 v72, v72
    v_mfma_f32_16x16x32_bf16 a[84:87], a[224:227], v[38:41], a[84:87]
    s_waitcnt lgkmcnt(0)
    ds_read_b64_tr_b16 a[212:213], v2 offset:18432
    v_exp_f32 v68, v68
    v_mfma_f32_16x16x32_bf16 a[88:91], a[228:231], v[38:41], a[88:91]
    v_exp_f32 v67, v67
    v_mfma_f32_16x16x32_bf16 a[92:95], a[232:235], v[38:41], a[92:95]
    ds_read_b64_tr_b16 a[214:215], v2 offset:12288
    v_cvt_pk_bf16_f32 v37, v78, v79
    v_mfma_f32_16x16x32_bf16 a[44:47], a[232:235], v[32:35], a[44:47]
    v_exp_f32 v58, v58
    v_mfma_f32_16x16x32_bf16 a[40:43], a[228:231], v[32:35], a[40:43]
    ds_read_b64_tr_b16 a[216:217], v3 offset:18432
    v_exp_f32 v69, v69
    v_mfma_f32_16x16x32_bf16 v[248:251], a[228:231], v[26:29], v[248:251]
    ds_read_b64_tr_b16 a[218:219], v3 offset:12288
    v_cvt_pk_bf16_f32 v42, v84, v85
    v_mfma_f32_16x16x32_bf16 v[252:255], a[232:235], v[26:29], v[252:255]
    v_exp_f32 v86, v86
    v_mfma_f32_16x16x32_bf16 v[204:207], a[232:235], v[20:23], v[204:207]
    ds_read_b64_tr_b16 a[220:221], v4 offset:18432
    v_cvt_pk_bf16_f32 v30, v68, v69
    v_mfma_f32_16x16x32_bf16 v[200:203], a[228:231], v[20:23], v[200:203]
    v_cvt_pk_bf16_f32 v23, v66, v67
    v_cvt_pk_bf16_f32 v36, v76, v77
    v_mfma_f32_16x16x32_bf16 v[152:155], a[228:231], v[14:17], v[152:155]
    v_cvt_pk_bf16_f32 v22, v64, v65
    v_cvt_pk_bf16_f32 v34, v80, v81
    v_mfma_f32_16x16x32_bf16 v[156:159], a[232:235], v[14:17], v[156:159]
    v_cvt_pk_bf16_f32 v29, v74, v75
    v_cvt_pk_bf16_f32 v17, v58, v59
    v_cvt_pk_bf16_f32 v35, v82, v83
    v_cvt_pk_bf16_f32 v16, v56, v57
    v_cvt_pk_bf16_f32 v31, v70, v71
    v_cvt_pk_bf16_f32 v28, v72, v73
    v_mfma_f32_16x16x32_bf16 v[48:51], a[236:239], v[16:19], v[44:47]
    ds_read_b64_tr_b16 a[222:223], v4 offset:12288
    v_cvt_pk_bf16_f32 v40, v88, v89
    v_mfma_f32_16x16x32_bf16 v[48:51], a[240:243], v[22:25], v[48:51]
    v_exp_f32 v87, v87
    v_mfma_f32_16x16x32_bf16 v[48:51], a[244:247], v[28:31], v[48:51]
    v_cvt_pk_bf16_f32 v41, v90, v91
    v_cvt_pk_bf16_f32 v43, v86, v87
    v_mfma_f32_16x16x32_bf16 v[48:51], a[248:251], v[34:37], v[48:51]
    ds_read_b64_tr_b16 a[224:225], v5 offset:18432
    v_mfma_f32_16x16x32_bf16 v[48:51], a[252:255], v[40:43], v[48:51]
    s_waitcnt lgkmcnt(3)
    ds_read_b64_tr_b16 a[226:227], v5 offset:12288
    s_nop 5
    v_cmp_lt_f32 vcc, s29, v48
    s_nop 4
    s_cbranch_vccnz L_rs_end5b
L_ret_end5b:
    v_lshrrev_b32 v108, 11, v0
    v_xor_b32 v108, s65, v108
    v_and_b32 v101, 0x3ff, v0
    v_lshl_add_u32 v101, v108, 10, v101
    v_add_u32 v101, s38, v101
    v_mbcnt_lo_u32_b32 v108, -1, 0
    v_mbcnt_hi_u32_b32 v108, -1, v108
    v_lshrrev_b32 v108, 1, v108
    v_mov_b32 v100, v48
    v_and_b32 v108, 24, v108
    v_bfe_u32 v108, s66, v108, 8
    v_xor_b32 v101, v101, v108
    v_permlane32_swap_b32 v48, v100
    v_mov_b32 v108, v100
    v_rcp_f32 v8, v51
    v_rcp_f32 v102, v49
    v_permlane16_swap_b32 v100, v108
    v_rcp_f32 v48, v48
    v_rcp_f32 v100, v100
    v_rcp_f32 v50, v50
    v_mfma_f32_16x16x32_bf16 v[112:115], a[212:215], v[16:19], v[112:115]
    v_xor_b32 v92, 32, v101
    v_mfma_f32_16x16x32_bf16 v[116:119], a[216:219], v[16:19], v[116:119]
    v_mfma_f32_16x16x32_bf16 v[164:167], a[216:219], v[22:25], v[164:167]
    v_mfma_f32_16x16x32_bf16 v[160:163], a[212:215], v[22:25], v[160:163]
    s_add_u32 s84, s34, 0
    ds_read_b64_tr_b16 a[228:229], v2 offset:19456
    v_mfma_f32_16x16x32_bf16 v[208:211], a[212:215], v[28:31], v[208:211]
    v_mfma_f32_16x16x32_bf16 v[212:215], a[216:219], v[28:31], v[212:215]
    ds_read_b64_tr_b16 a[230:231], v2 offset:13312
    v_mfma_f32_16x16x32_bf16 a[4:7], a[216:219], v[34:37], a[4:7]
    v_mfma_f32_16x16x32_bf16 a[0:3], a[212:215], v[34:37], a[0:3]
    v_subrev_u32 v103, 28672, v103
    s_add_u32 s85, s34, 6144
    v_mfma_f32_16x16x32_bf16 a[48:51], a[212:215], v[40:43], a[48:51]
    v_mfma_f32_16x16x32_bf16 a[52:55], a[216:219], v[40:43], a[52:55]
    s_waitcnt lgkmcnt(2)
    ds_read_b64_tr_b16 a[234:235], v3 offset:13312
    v_mfma_f32_16x16x32_bf16 a[56:59], a[220:223], v[40:43], a[56:59]
    ds_read_b64_tr_b16 a[232:233], v3 offset:19456
    v_mfma_f32_16x16x32_bf16 a[60:63], a[224:227], v[40:43], a[60:63]
    v_mfma_f32_16x16x32_bf16 a[12:15], a[224:227], v[34:37], a[12:15]
    ds_read_b64_tr_b16 a[218:219], v5 offset:13312
    v_mfma_f32_16x16x32_bf16 a[8:11], a[220:223], v[34:37], a[8:11]
    ds_read_b64_tr_b16 a[214:215], v4 offset:13312
    v_accvgpr_read_b32 v105, a1
    v_mfma_f32_16x16x32_bf16 v[216:219], a[220:223], v[28:31], v[216:219]
    ds_read_b64_tr_b16 a[216:217], v5 offset:19456
    v_mfma_f32_16x16x32_bf16 v[220:223], a[224:227], v[28:31], v[220:223]
    v_mfma_f32_16x16x32_bf16 v[172:175], a[224:227], v[22:25], v[172:175]
    v_mfma_f32_16x16x32_bf16 v[168:171], a[220:223], v[22:25], v[168:171]
    ds_read_b64_tr_b16 a[212:213], v4 offset:19456
    v_mfma_f32_16x16x32_bf16 v[120:123], a[220:223], v[16:19], v[120:123]
    ds_read_b64_tr_b16 a[220:221], v2 offset:20480
    v_mfma_f32_16x16x32_bf16 v[124:127], a[224:227], v[16:19], v[124:127]
    s_waitcnt lgkmcnt(6)
    ds_read_b64_tr_b16 a[222:223], v2 offset:14336
    v_mfma_f32_16x16x32_bf16 v[128:131], a[228:231], v[16:19], v[128:131]
    s_waitcnt lgkmcnt(6)
    v_accvgpr_read_b32 v107, a3
    v_mfma_f32_16x16x32_bf16 v[132:135], a[232:235], v[16:19], v[132:135]
    v_mfma_f32_16x16x32_bf16 v[180:183], a[232:235], v[22:25], v[180:183]
    s_add_u32 s86, s34, 12288
    v_accvgpr_read_b32 v52, a8
    v_accvgpr_read_b32 v56, a12
    v_mfma_f32_16x16x32_bf16 v[176:179], a[228:231], v[22:25], v[176:179]
    v_mfma_f32_16x16x32_bf16 v[224:227], a[228:231], v[28:31], v[224:227]
    v_mfma_f32_16x16x32_bf16 v[228:231], a[232:235], v[28:31], v[228:231]
    v_accvgpr_read_b32 v54, a10
    v_accvgpr_read_b32 v109, a5
    v_mfma_f32_16x16x32_bf16 a[20:23], a[232:235], v[34:37], a[20:23]
    v_mfma_f32_16x16x32_bf16 a[16:19], a[228:231], v[34:37], a[16:19]
    v_accvgpr_read_b32 v57, a13
    v_mfma_f32_16x16x32_bf16 a[64:67], a[228:231], v[40:43], a[64:67]
    v_mfma_f32_16x16x32_bf16 a[68:71], a[232:235], v[40:43], a[68:71]
    s_waitcnt lgkmcnt(0)
    v_mfma_f32_16x16x32_bf16 a[72:75], a[212:215], v[40:43], a[72:75]
    ds_read_b64_tr_b16 a[228:229], v4 offset:20480
    v_mfma_f32_16x16x32_bf16 a[76:79], a[216:219], v[40:43], a[76:79]
    s_add_u32 s87, s34, 18432
    v_mfma_f32_16x16x32_bf16 a[28:31], a[216:219], v[34:37], a[28:31]
    ds_read_b64_tr_b16 a[234:235], v5 offset:14336
    v_accvgpr_read_b32 v55, a11
    v_mfma_f32_16x16x32_bf16 a[24:27], a[212:215], v[34:37], a[24:27]
    ds_read_b64_tr_b16 a[224:225], v3 offset:20480
    v_xor_b32 v93, 64, v101
    v_mfma_f32_16x16x32_bf16 v[232:235], a[212:215], v[28:31], v[232:235]
    ds_read_b64_tr_b16 a[226:227], v3 offset:14336
    v_accvgpr_read_b32 v59, a15
    v_mfma_f32_16x16x32_bf16 v[236:239], a[216:219], v[28:31], v[236:239]
    ds_read_b64_tr_b16 a[232:233], v5 offset:20480
    v_mfma_f32_16x16x32_bf16 v[188:191], a[216:219], v[22:25], v[188:191]
    s_add_u32 s88, s34, 24576
    v_xor_b32 v94, 96, v101
    v_accvgpr_read_b32 v104, a0
    v_mfma_f32_16x16x32_bf16 v[184:187], a[212:215], v[22:25], v[184:187]
    v_mfma_f32_16x16x32_bf16 v[136:139], a[212:215], v[16:19], v[136:139]
    ds_read_b64_tr_b16 a[230:231], v4 offset:14336
    v_accvgpr_read_b32 v58, a14
    v_mfma_f32_16x16x32_bf16 v[140:143], a[216:219], v[16:19], v[140:143]
    v_accvgpr_read_b32 v106, a2
    v_accvgpr_read_b32 v53, a9
    v_accvgpr_read_b32 v110, a6
    v_pk_mul_f32 v[126:127], v[126:127], v[48:49] op_sel_hi:[1,0]
    v_pk_mul_f32 v[118:119], v[118:119], v[48:49] op_sel_hi:[1,0]
    v_pk_mul_f32 v[120:121], v[120:121], v[48:49] op_sel_hi:[1,0]
    v_pk_mul_f32 v[124:125], v[124:125], v[48:49] op_sel_hi:[1,0]
    v_pk_mul_f32 v[162:163], v[162:163], v[102:103] op_sel_hi:[1,0]
    v_pk_mul_f32 v[122:123], v[122:123], v[48:49] op_sel_hi:[1,0]
    v_pk_mul_f32 v[166:167], v[166:167], v[102:103] op_sel_hi:[1,0]
    v_pk_mul_f32 v[114:115], v[114:115], v[48:49] op_sel_hi:[1,0]
    v_pk_mul_f32 v[168:169], v[168:169], v[102:103] op_sel_hi:[1,0]
    v_pk_mul_f32 v[160:161], v[160:161], v[102:103] op_sel_hi:[1,0]
    v_pk_mul_f32 v[116:117], v[116:117], v[48:49] op_sel_hi:[1,0]
    v_pk_mul_f32 v[208:209], v[208:209], v[50:51] op_sel_hi:[1,0]
    v_pk_mul_f32 v[170:171], v[170:171], v[102:103] op_sel_hi:[1,0]
    v_pk_mul_f32 v[164:165], v[164:165], v[102:103] op_sel_hi:[1,0]
    v_pk_mul_f32 v[172:173], v[172:173], v[102:103] op_sel_hi:[1,0]
    v_pk_mul_f32 v[174:175], v[174:175], v[102:103] op_sel_hi:[1,0]
    v_pk_mul_f32 v[112:113], v[112:113], v[48:49] op_sel_hi:[1,0]
    v_cvt_pk_bf16_f32 v120, v120, v121
    v_cvt_pk_bf16_f32 v121, v122, v123
    v_mfma_f32_16x16x32_bf16 v[144:147], a[220:223], v[16:19], v[144:147]
    s_waitcnt lgkmcnt(1)
    v_cvt_pk_bf16_f32 v124, v124, v125
    v_cvt_pk_bf16_f32 v160, v160, v161
    v_mfma_f32_16x16x32_bf16 v[148:151], a[224:227], v[16:19], v[148:151]
    v_cvt_pk_bf16_f32 v164, v164, v165
    v_cvt_pk_bf16_f32 v172, v172, v173
    v_mfma_f32_16x16x32_bf16 v[196:199], a[224:227], v[22:25], v[196:199]
    v_cvt_pk_bf16_f32 v112, v112, v113
    v_cvt_pk_bf16_f32 v116, v116, v117
    v_mfma_f32_16x16x32_bf16 v[192:195], a[220:223], v[22:25], v[192:195]
    v_cvt_pk_bf16_f32 v113, v114, v115
    v_cvt_pk_bf16_f32 v117, v118, v119
    v_mfma_f32_16x16x32_bf16 v[240:243], a[220:223], v[28:31], v[240:243]
    v_cvt_pk_bf16_f32 v165, v166, v167
    v_cvt_pk_bf16_f32 v125, v126, v127
    v_mfma_f32_16x16x32_bf16 v[244:247], a[224:227], v[28:31], v[244:247]
    v_cvt_pk_bf16_f32 v173, v174, v175
    v_cvt_pk_bf16_f32 v168, v168, v169
    v_mfma_f32_16x16x32_bf16 a[36:39], a[224:227], v[34:37], a[36:39]
    s_add_u32 s18, s34, 30720
    v_cvt_pk_bf16_f32 v161, v162, v163
    v_cvt_pk_bf16_f32 v169, v170, v171
    v_mfma_f32_16x16x32_bf16 a[32:35], a[220:223], v[34:37], a[32:35]
    ds_write2st64_b64 v101, v[112:113], v[160:161] offset0:0 offset1:12
    v_mfma_f32_16x16x32_bf16 a[80:83], a[220:223], v[40:43], a[80:83]
    ds_write2st64_b64 v92, v[116:117], v[164:165] offset0:0 offset1:12
    v_mfma_f32_16x16x32_bf16 a[84:87], a[224:227], v[40:43], a[84:87]
    s_waitcnt lgkmcnt(2)
    ds_write2st64_b64 v93, v[120:121], v[168:169] offset0:0 offset1:12
    v_mfma_f32_16x16x32_bf16 a[88:91], a[228:231], v[40:43], a[88:91]
    ds_write2st64_b64 v94, v[124:125], v[172:173] offset0:0 offset1:12
    v_mfma_f32_16x16x32_bf16 a[92:95], a[232:235], v[40:43], a[92:95]
    ds_read_b128 v[60:63], v103 offset:0
    v_mfma_f32_16x16x32_bf16 a[44:47], a[232:235], v[34:37], a[44:47]
    ds_read_b128 v[64:67], v103 offset:1024
    v_pk_mul_f32 v[150:151], v[150:151], v[48:49] op_sel_hi:[1,0]
    v_pk_mul_f32 v[216:217], v[216:217], v[50:51] op_sel_hi:[1,0]
    v_pk_mul_f32 v[220:221], v[220:221], v[50:51] op_sel_hi:[1,0]
    v_pk_mul_f32 v[58:59], v[58:59], v[8:9] op_sel_hi:[1,0]
    v_pk_mul_f32 v[56:57], v[56:57], v[8:9] op_sel_hi:[1,0]
    v_pk_mul_f32 v[136:137], v[136:137], v[48:49] op_sel_hi:[1,0]
    v_pk_mul_f32 v[52:53], v[52:53], v[8:9] op_sel_hi:[1,0]
    v_pk_mul_f32 v[142:143], v[142:143], v[48:49] op_sel_hi:[1,0]
    v_pk_mul_f32 v[218:219], v[218:219], v[50:51] op_sel_hi:[1,0]
    v_pk_mul_f32 v[140:141], v[140:141], v[48:49] op_sel_hi:[1,0]
    v_cvt_pk_bf16_f32 v52, v52, v53
    v_pk_mul_f32 v[148:149], v[148:149], v[48:49] op_sel_hi:[1,0]
    v_accvgpr_read_b32 v108, a4
    v_pk_mul_f32 v[104:105], v[104:105], v[8:9] op_sel_hi:[1,0]
    v_pk_mul_f32 v[214:215], v[214:215], v[50:51] op_sel_hi:[1,0]
    v_pk_mul_f32 v[212:213], v[212:213], v[50:51] op_sel_hi:[1,0]
    v_pk_mul_f32 v[138:139], v[138:139], v[48:49] op_sel_hi:[1,0]
    v_pk_mul_f32 v[54:55], v[54:55], v[8:9] op_sel_hi:[1,0]
    v_pk_mul_f32 v[106:107], v[106:107], v[8:9] op_sel_hi:[1,0]
    v_pk_mul_f32 v[128:129], v[128:129], v[48:49] op_sel_hi:[1,0]
    v_pk_mul_f32 v[222:223], v[222:223], v[50:51] op_sel_hi:[1,0]
    s_nop 1
    v_mfma_f32_16x16x32_bf16 a[40:43], a[228:231], v[34:37], a[40:43]
    v_mfma_f32_16x16x32_bf16 v[248:251], a[228:231], v[28:31], v[248:251]
    s_waitcnt lgkmcnt(1)
    buffer_store_dwordx4 v[60:63], v6, s[16:19], s84 offen offset:0 nt
    ds_read_b128 v[68:71], v103 offset:6144
    v_cvt_pk_bf16_f32 v53, v54, v55
    v_pk_mul_f32 v[108:109], v[108:109], v[8:9] op_sel_hi:[1,0]
    v_cvt_pk_bf16_f32 v220, v220, v221
    v_pk_mul_f32 v[210:211], v[210:211], v[50:51] op_sel_hi:[1,0]
    v_pk_mul_f32 v[180:181], v[180:181], v[102:103] op_sel_hi:[1,0]
    v_pk_mul_f32 v[188:189], v[188:189], v[102:103] op_sel_hi:[1,0]
    v_cvt_pk_bf16_f32 v216, v216, v217
    s_nop 0
    v_mfma_f32_16x16x32_bf16 v[252:255], a[232:235], v[28:31], v[252:255]
    v_cvt_pk_bf16_f32 v56, v56, v57
    v_cvt_pk_bf16_f32 v108, v108, v109
    v_accvgpr_read_b32 v111, a7
    v_cvt_pk_bf16_f32 v104, v104, v105
    ds_read_b128 v[72:75], v103 offset:7168
    v_cvt_pk_bf16_f32 v221, v222, v223
    v_pk_mul_f32 v[110:111], v[110:111], v[8:9] op_sel_hi:[1,0]
    v_cvt_pk_bf16_f32 v212, v212, v213
    v_cvt_pk_bf16_f32 v213, v214, v215
    v_cvt_pk_bf16_f32 v208, v208, v209
    v_cvt_pk_bf16_f32 v105, v106, v107
    v_cvt_pk_bf16_f32 v209, v210, v211
    v_cvt_pk_bf16_f32 v57, v58, v59
    v_cvt_pk_bf16_f32 v188, v188, v189
    v_mfma_f32_16x16x32_bf16 v[204:207], a[232:235], v[22:25], v[204:207]
    s_waitcnt lgkmcnt(2)
    buffer_store_dwordx4 v[64:67], v7, s[16:19], s84 offen offset:0 nt
    v_cvt_pk_bf16_f32 v109, v110, v111
    v_cvt_pk_bf16_f32 v140, v140, v141
    ds_write2st64_b64 v101, v[208:209], v[104:105] offset0:24 offset1:36
    v_cvt_pk_bf16_f32 v136, v136, v137
    v_pk_mul_f32 v[236:237], v[236:237], v[50:51] op_sel_hi:[1,0]
    v_accvgpr_read_b32 v54, a58
    v_pk_mul_f32 v[130:131], v[130:131], v[48:49] op_sel_hi:[1,0]
    v_pk_mul_f32 v[240:241], v[240:241], v[50:51] op_sel_hi:[1,0]
    v_accvgpr_read_b32 v59, a63
    v_cvt_pk_bf16_f32 v217, v218, v219
    v_accvgpr_read_b32 v104, a48
    v_pk_mul_f32 v[226:227], v[226:227], v[50:51] op_sel_hi:[1,0]
    v_accvgpr_read_b32 v58, a62
    v_cvt_pk_bf16_f32 v128, v128, v129
    v_mfma_f32_16x16x32_bf16 v[200:203], a[228:231], v[22:25], v[200:203]
    s_waitcnt lgkmcnt(1)
    v_cvt_pk_bf16_f32 v137, v138, v139
    ds_write2st64_b64 v92, v[212:213], v[108:109] offset0:24 offset1:36
    buffer_store_dwordx4 v[68:71], v6, s[16:19], s85 offen offset:0 nt
    ds_write2st64_b64 v93, v[216:217], v[52:53] offset0:24 offset1:36
    v_pk_mul_f32 v[254:255], v[254:255], v[50:51] op_sel_hi:[1,0]
    v_pk_mul_f32 v[182:183], v[182:183], v[102:103] op_sel_hi:[1,0]
    v_pk_mul_f32 v[224:225], v[224:225], v[50:51] op_sel_hi:[1,0]
    v_accvgpr_read_b32 v53, a57
    v_accvgpr_read_b32 v108, a52
    v_mfma_f32_16x16x32_bf16 v[152:155], a[228:231], v[16:19], v[152:155]
    ds_write2st64_b64 v94, v[220:221], v[56:57] offset0:24 offset1:36
    v_cvt_pk_bf16_f32 v236, v236, v237
    v_accvgpr_read_b32 v55, a59
    v_accvgpr_read_b32 v52, a56
    v_pk_mul_f32 v[228:229], v[228:229], v[50:51] op_sel_hi:[1,0]
    v_cvt_pk_bf16_f32 v141, v142, v143
    ds_read_b128 v[76:79], v103 offset:12288
    v_accvgpr_read_b32 v57, a61
    v_pk_mul_f32 v[132:133], v[132:133], v[48:49] op_sel_hi:[1,0]
    buffer_store_dwordx4 v[72:75], v7, s[16:19], s85 offen offset:0 nt
    v_accvgpr_read_b32 v105, a49
    v_pk_mul_f32 v[244:245], v[244:245], v[50:51] op_sel_hi:[1,0]
    v_pk_mul_f32 v[238:239], v[238:239], v[50:51] op_sel_hi:[1,0]
    v_pk_mul_f32 v[234:235], v[234:235], v[50:51] op_sel_hi:[1,0]
    v_cvt_pk_bf16_f32 v224, v224, v225
    v_pk_mul_f32 v[58:59], v[58:59], v[100:101] op_sel_hi:[1,0]
    v_pk_mul_f32 v[198:199], v[198:199], v[102:103] op_sel_hi:[1,0]
    v_cvt_pk_bf16_f32 v180, v180, v181
    v_pk_mul_f32 v[230:231], v[230:231], v[50:51] op_sel_hi:[1,0]
    v_accvgpr_read_b32 v109, a53
    v_pk_mul_f32 v[52:53], v[52:53], v[100:101] op_sel_hi:[1,0]
    v_cvt_pk_bf16_f32 v129, v130, v131
    v_pk_mul_f32 v[190:191], v[190:191], v[102:103] op_sel_hi:[1,0]
    ds_read_b128 v[80:83], v103 offset:13312
    v_pk_mul_f32 v[108:109], v[108:109], v[100:101] op_sel_hi:[1,0]
    ds_read_b128 v[84:87], v103 offset:18432
    v_pk_mul_f32 v[232:233], v[232:233], v[50:51] op_sel_hi:[1,0]
    v_pk_mul_f32 v[104:105], v[104:105], v[100:101] op_sel_hi:[1,0]
    ds_read_b128 v[88:91], v103 offset:19456
    v_pk_mul_f32 v[54:55], v[54:55], v[100:101] op_sel_hi:[1,0]
    v_accvgpr_read_b32 v110, a54
    v_accvgpr_read_b32 v106, a50
    v_mfma_f32_16x16x32_bf16 v[156:159], a[232:235], v[16:19], v[156:159]
    s_waitcnt lgkmcnt(3)
    buffer_store_dwordx4 v[76:79], v6, s[16:19], s86 offen offset:0 nt
    v_pk_mul_f32 v[176:177], v[176:177], v[102:103] op_sel_hi:[1,0]
    v_accvgpr_read_b32 v111, a55
    v_accvgpr_read_b32 v107, a51
    v_cvt_pk_bf16_f32 v52, v52, v53
    v_cvt_pk_bf16_f32 v132, v132, v133
    v_pk_mul_f32 v[250:251], v[250:251], v[50:51] op_sel_hi:[1,0]
    v_cvt_pk_bf16_f32 v104, v104, v105
    v_cvt_pk_bf16_f32 v53, v54, v55
    v_accvgpr_read_b32 v56, a60
    v_pk_mul_f32 v[110:111], v[110:111], v[100:101] op_sel_hi:[1,0]
    v_pk_mul_f32 v[56:57], v[56:57], v[100:101] op_sel_hi:[1,0]
    v_cvt_pk_bf16_f32 v108, v108, v109
    v_pk_mul_f32 v[194:195], v[194:195], v[102:103] op_sel_hi:[1,0]
    v_cvt_pk_bf16_f32 v109, v110, v111
    v_cvt_pk_bf16_f32 v148, v148, v149
    v_pk_mul_f32 v[152:153], v[152:153], v[48:49] op_sel_hi:[1,0]
    v_cvt_pk_bf16_f32 v56, v56, v57
    v_cvt_pk_bf16_f32 v57, v58, v59
    v_pk_mul_f32 v[192:193], v[192:193], v[102:103] op_sel_hi:[1,0]
    v_pk_mul_f32 v[186:187], v[186:187], v[102:103] op_sel_hi:[1,0]
    v_pk_mul_f32 v[134:135], v[134:135], v[48:49] op_sel_hi:[1,0]
    v_pk_mul_f32 v[156:157], v[156:157], v[48:49] op_sel_hi:[1,0]
    v_pk_mul_f32 v[106:107], v[106:107], v[100:101] op_sel_hi:[1,0]
    v_pk_mul_f32 v[200:201], v[200:201], v[102:103] op_sel_hi:[1,0]
    s_waitcnt lgkmcnt(1)
    buffer_store_dwordx4 v[80:83], v7, s[16:19], s86 offen offset:0 nt
    v_cvt_pk_bf16_f32 v105, v106, v107
    v_pk_mul_f32 v[184:185], v[184:185], v[102:103] op_sel_hi:[1,0]
    v_cvt_pk_bf16_f32 v181, v182, v183
    v_accvgpr_read_b32 v59, a31
    v_pk_mul_f32 v[154:155], v[154:155], v[48:49] op_sel_hi:[1,0]
    ds_write_b64 v101, v[104:105] offset:24576
    v_cvt_pk_bf16_f32 v192, v192, v193
    v_accvgpr_read_b32 v107, a19
    ds_write_b64 v92, v[108:109] offset:24576
    v_cvt_pk_bf16_f32 v156, v156, v157
    v_pk_mul_f32 v[246:247], v[246:247], v[50:51] op_sel_hi:[1,0]
    v_accvgpr_read_b32 v54, a26
    v_pk_mul_f32 v[144:145], v[144:145], v[48:49] op_sel_hi:[1,0]
    v_cvt_pk_bf16_f32 v237, v238, v239
    v_accvgpr_read_b32 v106, a18
    v_cvt_pk_bf16_f32 v176, v176, v177
    v_pk_mul_f32 v[178:179], v[178:179], v[102:103] op_sel_hi:[1,0]
    v_accvgpr_read_b32 v109, a21
    v_cvt_pk_bf16_f32 v244, v244, v245
    v_cvt_pk_bf16_f32 v228, v228, v229
    buffer_store_dwordx4 v[84:87], v6, s[16:19], s87 offen offset:0 nt
    ds_write_b64 v93, v[52:53] offset:24576
    v_pk_mul_f32 v[204:205], v[204:205], v[102:103] op_sel_hi:[1,0]
    v_cvt_pk_bf16_f32 v177, v178, v179
    v_accvgpr_read_b32 v52, a24
    v_cvt_pk_bf16_f32 v232, v232, v233
    v_pk_mul_f32 v[248:249], v[248:249], v[50:51] op_sel_hi:[1,0]
    ds_write_b64 v94, v[56:57] offset:24576
    ds_read_b128 v[60:63], v103 offset:24576
    ds_read_b128 v[64:67], v103 offset:25600
    v_accvgpr_read_b32 v58, a30
    v_accvgpr_read_b32 v57, a29
    s_waitcnt lgkmcnt(4)
    buffer_store_dwordx4 v[88:91], v7, s[16:19], s87 offen offset:0 nt
    v_accvgpr_read_b32 v111, a23
    v_pk_mul_f32 v[252:253], v[252:253], v[50:51] op_sel_hi:[1,0]
    v_cvt_pk_bf16_f32 v152, v152, v153
    v_accvgpr_read_b32 v56, a28
    v_cvt_pk_bf16_f32 v189, v190, v191
    v_cvt_pk_bf16_f32 v184, v184, v185
    v_cvt_pk_bf16_f32 v133, v134, v135
    v_accvgpr_read_b32 v105, a17
    v_pk_mul_f32 v[106:107], v[106:107], v[8:9] op_sel_hi:[1,0]
    ds_write2st64_b64 v101, v[128:129], v[176:177] offset0:4 offset1:16
    v_pk_mul_f32 v[58:59], v[58:59], v[8:9] op_sel_hi:[1,0]
    v_cvt_pk_bf16_f32 v252, v252, v253
    v_cvt_pk_bf16_f32 v225, v226, v227
    v_cvt_pk_bf16_f32 v204, v204, v205
    ds_write2st64_b64 v92, v[132:133], v[180:181] offset0:4 offset1:16
    v_accvgpr_read_b32 v110, a22
    v_cvt_pk_bf16_f32 v185, v186, v187
    s_waitcnt lgkmcnt(2)
    buffer_store_dwordx4 v[60:63], v6, s[16:19], s88 offen offset:0 nt
    v_accvgpr_read_b32 v53, a25
    v_pk_mul_f32 v[56:57], v[56:57], v[8:9] op_sel_hi:[1,0]
    v_pk_mul_f32 v[196:197], v[196:197], v[102:103] op_sel_hi:[1,0]
    ds_write2st64_b64 v93, v[136:137], v[184:185] offset0:4 offset1:16
    v_pk_mul_f32 v[206:207], v[206:207], v[102:103] op_sel_hi:[1,0]
    ds_write2st64_b64 v94, v[140:141], v[188:189] offset0:4 offset1:16
    v_accvgpr_read_b32 v104, a16
    v_pk_mul_f32 v[104:105], v[104:105], v[8:9] op_sel_hi:[1,0]
    v_accvgpr_read_b32 v55, a27
    v_cvt_pk_bf16_f32 v104, v104, v105
    v_cvt_pk_bf16_f32 v233, v234, v235
    ds_read_b128 v[68:71], v103 offset:2048
    buffer_store_dwordx4 v[64:67], v7, s[16:19], s88 offen offset:0 nt
    ds_read_b128 v[72:75], v103 offset:3072
    v_cvt_pk_bf16_f32 v248, v248, v249
    v_cvt_pk_bf16_f32 v105, v106, v107
    v_cvt_pk_bf16_f32 v56, v56, v57
    v_pk_mul_f32 v[110:111], v[110:111], v[8:9] op_sel_hi:[1,0]
    v_cvt_pk_bf16_f32 v229, v230, v231
    v_pk_mul_f32 v[52:53], v[52:53], v[8:9] op_sel_hi:[1,0]
    ds_read_b128 v[76:79], v103 offset:8192
    v_cvt_pk_bf16_f32 v196, v196, v197
    v_accvgpr_read_b32 v106, a66
    ds_read_b128 v[80:83], v103 offset:9216
    v_accvgpr_read_b32 v108, a20
    v_pk_mul_f32 v[108:109], v[108:109], v[8:9] op_sel_hi:[1,0]
    ds_write2st64_b64 v101, v[224:225], v[104:105] offset0:28 offset1:40
    v_pk_mul_f32 v[54:55], v[54:55], v[8:9] op_sel_hi:[1,0]
    v_cvt_pk_bf16_f32 v108, v108, v109
    v_accvgpr_read_b32 v107, a67
    v_accvgpr_read_b32 v105, a65
    s_waitcnt lgkmcnt(4)
    buffer_store_dwordx4 v[68:71], v6, s[16:19], s84 offen offset:128 nt
    v_cvt_pk_bf16_f32 v52, v52, v53
    v_cvt_pk_bf16_f32 v144, v144, v145
    v_cvt_pk_bf16_f32 v57, v58, v59
    v_cvt_pk_bf16_f32 v53, v54, v55
    v_pk_mul_f32 v[242:243], v[242:243], v[50:51] op_sel_hi:[1,0]
    v_accvgpr_read_b32 v104, a64
    v_pk_mul_f32 v[104:105], v[104:105], v[100:101] op_sel_hi:[1,0]
    v_cvt_pk_bf16_f32 v109, v110, v111
    ds_write2st64_b64 v92, v[228:229], v[108:109] offset0:28 offset1:40
    v_accvgpr_read_b32 v108, a68
    s_waitcnt lgkmcnt(3)
    buffer_store_dwordx4 v[72:75], v7, s[16:19], s84 offen offset:128 nt
    v_accvgpr_read_b32 v109, a69
    ds_write2st64_b64 v93, v[232:233], v[52:53] offset0:28 offset1:40
    v_pk_mul_f32 v[202:203], v[202:203], v[102:103] op_sel_hi:[1,0]
    v_accvgpr_read_b32 v110, a70
    v_cvt_pk_bf16_f32 v193, v194, v195
    v_accvgpr_read_b32 v111, a71
    ds_write2st64_b64 v94, v[236:237], v[56:57] offset0:28 offset1:40
    v_pk_mul_f32 v[108:109], v[108:109], v[100:101] op_sel_hi:[1,0]
    ds_read_b128 v[84:87], v103 offset:14336
    v_accvgpr_read_b32 v53, a73
    v_accvgpr_read_b32 v59, a79
    v_pk_mul_f32 v[110:111], v[110:111], v[100:101] op_sel_hi:[1,0]
    v_accvgpr_read_b32 v57, a77
    v_accvgpr_read_b32 v54, a74
    buffer_store_dwordx4 v[76:79], v6, s[16:19], s85 offen offset:128 nt
    v_accvgpr_read_b32 v55, a75
    ds_read_b128 v[88:91], v103 offset:15360
    v_cvt_pk_bf16_f32 v108, v108, v109
    s_waitcnt lgkmcnt(4)
    buffer_store_dwordx4 v[80:83], v7, s[16:19], s85 offen offset:128 nt
    v_accvgpr_read_b32 v58, a78
    v_accvgpr_read_b32 v52, a72
    v_pk_mul_f32 v[58:59], v[58:59], v[100:101] op_sel_hi:[1,0]
    v_pk_mul_f32 v[54:55], v[54:55], v[100:101] op_sel_hi:[1,0]
    v_cvt_pk_bf16_f32 v109, v110, v111
    v_pk_mul_f32 v[146:147], v[146:147], v[48:49] op_sel_hi:[1,0]
    ds_read_b128 v[60:63], v103 offset:20480
    v_accvgpr_read_b32 v56, a76
    s_waitcnt lgkmcnt(1)
    buffer_store_dwordx4 v[84:87], v6, s[16:19], s86 offen offset:128 nt
    v_pk_mul_f32 v[52:53], v[52:53], v[100:101] op_sel_hi:[1,0]
    v_cvt_pk_bf16_f32 v249, v250, v251
    v_pk_mul_f32 v[106:107], v[106:107], v[100:101] op_sel_hi:[1,0]
    v_cvt_pk_bf16_f32 v200, v200, v201
    v_pk_mul_f32 v[56:57], v[56:57], v[100:101] op_sel_hi:[1,0]
    s_nop 0
    v_cvt_pk_bf16_f32 v56, v56, v57
    v_cvt_pk_bf16_f32 v52, v52, v53
    v_cvt_pk_bf16_f32 v104, v104, v105
    v_cvt_pk_bf16_f32 v197, v198, v199
    ds_read_b128 v[64:67], v103 offset:21504
    v_cvt_pk_bf16_f32 v205, v206, v207
    v_pk_mul_f32 v[158:159], v[158:159], v[48:49] op_sel_hi:[1,0]
    v_cvt_pk_bf16_f32 v105, v106, v107
    v_cvt_pk_bf16_f32 v149, v150, v151
    v_cvt_pk_bf16_f32 v240, v240, v241
    ds_write_b64 v101, v[104:105] offset:26624
    v_cvt_pk_bf16_f32 v53, v54, v55
    buffer_store_dwordx4 v[88:91], v7, s[16:19], s86 offen offset:128 nt
    v_accvgpr_read_b32 v111, a39
    ds_write_b64 v92, v[108:109] offset:26624
    v_accvgpr_read_b32 v105, a33
    ds_write_b64 v93, v[52:53] offset:26624
    v_accvgpr_read_b32 v106, a34
    v_cvt_pk_bf16_f32 v57, v58, v59
    v_cvt_pk_bf16_f32 v157, v158, v159
    v_accvgpr_read_b32 v52, a40
    v_cvt_pk_bf16_f32 v145, v146, v147
    v_cvt_pk_bf16_f32 v253, v254, v255
    v_accvgpr_read_b32 v59, a47
    v_cvt_pk_bf16_f32 v241, v242, v243
    v_accvgpr_read_b32 v110, a38
    v_accvgpr_read_b32 v104, a32
    ds_write_b64 v94, v[56:57] offset:26624
    s_waitcnt lgkmcnt(3)
    buffer_store_dwordx4 v[60:63], v6, s[16:19], s87 offen offset:128 nt
    v_accvgpr_read_b32 v109, a37
    v_accvgpr_read_b32 v55, a43
    v_accvgpr_read_b32 v107, a35
    v_accvgpr_read_b32 v54, a42
    v_accvgpr_read_b32 v57, a45
    v_accvgpr_read_b32 v108, a36
    ds_read_b128 v[68:71], v103 offset:26624
    v_pk_mul_f32 v[110:111], v[110:111], v[8:9] op_sel_hi:[1,0]
    v_cvt_pk_bf16_f32 v153, v154, v155
    ds_read_b128 v[72:75], v103 offset:27648
    v_accvgpr_read_b32 v58, a46
    ds_write2st64_b64 v101, v[144:145], v[192:193] offset0:8 offset1:20
    buffer_store_dwordx4 v[64:67], v7, s[16:19], s87 offen offset:128 nt
    v_accvgpr_read_b32 v53, a41
    v_pk_mul_f32 v[108:109], v[108:109], v[8:9] op_sel_hi:[1,0]
    v_pk_mul_f32 v[106:107], v[106:107], v[8:9] op_sel_hi:[1,0]
    v_cvt_pk_bf16_f32 v201, v202, v203
    ds_write2st64_b64 v92, v[148:149], v[196:197] offset0:8 offset1:20
    v_cvt_pk_bf16_f32 v108, v108, v109
    v_accvgpr_read_b32 v56, a44
    v_cvt_pk_bf16_f32 v245, v246, v247
    v_pk_mul_f32 v[104:105], v[104:105], v[8:9] op_sel_hi:[1,0]
    ds_write2st64_b64 v93, v[152:153], v[200:201] offset0:8 offset1:20
    ds_write2st64_b64 v94, v[156:157], v[204:205] offset0:8 offset1:20
    ds_read_b128 v[76:79], v103 offset:4096
    v_pk_mul_f32 v[56:57], v[56:57], v[8:9] op_sel_hi:[1,0]
    s_waitcnt lgkmcnt(4)
    buffer_store_dwordx4 v[68:71], v6, s[16:19], s88 offen offset:128 nt
    v_pk_mul_f32 v[52:53], v[52:53], v[8:9] op_sel_hi:[1,0]
    s_nop 0
    v_cvt_pk_bf16_f32 v52, v52, v53
    v_cvt_pk_bf16_f32 v104, v104, v105
    v_pk_mul_f32 v[54:55], v[54:55], v[8:9] op_sel_hi:[1,0]
    v_cvt_pk_bf16_f32 v56, v56, v57
    ds_read_b128 v[80:83], v103 offset:5120
    v_cvt_pk_bf16_f32 v105, v106, v107
    ds_read_b128 v[84:87], v103 offset:10240
    buffer_store_dwordx4 v[72:75], v7, s[16:19], s88 offen offset:128 nt
    v_cvt_pk_bf16_f32 v109, v110, v111
    ds_read_b128 v[88:91], v103 offset:11264
    ds_write2st64_b64 v101, v[240:241], v[104:105] offset0:32 offset1:44
    v_cvt_pk_bf16_f32 v53, v54, v55
    v_accvgpr_read_b32 v54, a90
    ds_write2st64_b64 v92, v[244:245], v[108:109] offset0:32 offset1:44
    v_pk_mul_f32 v[58:59], v[58:59], v[8:9] op_sel_hi:[1,0]
    v_accvgpr_read_b32 v111, a87
    ds_write2st64_b64 v93, v[248:249], v[52:53] offset0:32 offset1:44
    v_accvgpr_read_b32 v105, a81
    v_cvt_pk_bf16_f32 v57, v58, v59
    s_waitcnt lgkmcnt(4)
    buffer_store_dwordx4 v[76:79], v6, s[16:19], s84 offen offset:256 nt
    ds_write2st64_b64 v94, v[252:253], v[56:57] offset0:32 offset1:44
    buffer_store_dwordx4 v[80:83], v7, s[16:19], s84 offen offset:256 nt
    v_accvgpr_read_b32 v52, a88
    v_accvgpr_read_b32 v53, a89
    v_accvgpr_read_b32 v104, a80
    v_accvgpr_read_b32 v55, a91
    v_accvgpr_read_b32 v107, a83
    v_accvgpr_read_b32 v106, a82
    v_pk_mul_f32 v[52:53], v[52:53], v[100:101] op_sel_hi:[1,0]
    ds_read_b128 v[60:63], v103 offset:16384
    v_accvgpr_read_b32 v56, a92
    v_accvgpr_read_b32 v57, a93
    ds_read_b128 v[64:67], v103 offset:17408
    buffer_store_dwordx4 v[84:87], v6, s[16:19], s85 offen offset:256 nt
    ds_read_b128 v[68:71], v103 offset:22528
    v_pk_mul_f32 v[104:105], v[104:105], v[100:101] op_sel_hi:[1,0]
    v_accvgpr_read_b32 v109, a85
    v_pk_mul_f32 v[106:107], v[106:107], v[100:101] op_sel_hi:[1,0]
    v_accvgpr_read_b32 v108, a84
    s_waitcnt lgkmcnt(3)
    buffer_store_dwordx4 v[88:91], v7, s[16:19], s85 offen offset:256 nt
    v_pk_mul_f32 v[56:57], v[56:57], v[100:101] op_sel_hi:[1,0]
    v_accvgpr_read_b32 v110, a86
    v_cvt_pk_bf16_f32 v52, v52, v53
    v_cvt_pk_bf16_f32 v56, v56, v57
    v_pk_mul_f32 v[110:111], v[110:111], v[100:101] op_sel_hi:[1,0]
    s_waitcnt lgkmcnt(0)
    buffer_store_dwordx4 v[60:63], v6, s[16:19], s86 offen offset:256 nt
    v_cvt_pk_bf16_f32 v104, v104, v105
    v_pk_mul_f32 v[108:109], v[108:109], v[100:101] op_sel_hi:[1,0]
    v_accvgpr_read_b32 v59, a95
    v_accvgpr_read_b32 v58, a94
    v_cvt_pk_bf16_f32 v108, v108, v109
    v_pk_mul_f32 v[58:59], v[58:59], v[100:101] op_sel_hi:[1,0]
    v_cvt_pk_bf16_f32 v105, v106, v107
    ds_read_b128 v[72:75], v103 offset:23552
    ds_write_b64 v101, v[104:105] offset:0
    buffer_store_dwordx4 v[64:67], v7, s[16:19], s86 offen offset:256 nt
    v_cvt_pk_bf16_f32 v109, v110, v111
    v_pk_mul_f32 v[54:55], v[54:55], v[100:101] op_sel_hi:[1,0]
    buffer_store_dwordx4 v[68:71], v6, s[16:19], s87 offen offset:256 nt
    v_cvt_pk_bf16_f32 v53, v54, v55
    ds_write_b64 v92, v[108:109] offset:0
    ds_write_b64 v93, v[52:53] offset:0
    v_cvt_pk_bf16_f32 v57, v58, v59
    ds_write_b64 v94, v[56:57] offset:0
    ds_read_b128 v[76:79], v103 offset:0
    ds_read_b128 v[80:83], v103 offset:1024
    s_waitcnt lgkmcnt(5)
    buffer_store_dwordx4 v[72:75], v7, s[16:19], s87 offen offset:256 nt
    s_waitcnt lgkmcnt(1)
    buffer_store_dwordx4 v[76:79], v6, s[16:19], s88 offen offset:256 nt
    s_waitcnt lgkmcnt(0)
    buffer_store_dwordx4 v[80:83], v7, s[16:19], s88 offen offset:256 nt
    s_branch L_fin
L_end4:
    v_mfma_f32_16x16x32_bf16 v[112:115], a[212:215], v[16:19], v[112:115]
    v_fma_f32 v79, v79, s28, v12
    v_fma_f32 v71, v71, s28, v11
    v_fma_f32 v74, v74, s28, v11
    v_mfma_f32_16x16x32_bf16 v[160:163], a[212:215], v[22:25], v[160:163]
    v_exp_f32 v71, v71
    v_mfma_f32_16x16x32_bf16 v[208:211], a[212:215], v[28:31], v[208:211]
    ds_read_b64_tr_b16 a[228:229], v2 offset:19456
    v_fma_f32 v65, v65, s28, v10
    v_mfma_f32_16x16x32_bf16 a[0:3], a[212:215], v[34:37], a[0:3]
    ds_read_b64_tr_b16 a[230:231], v2 offset:13312
    s_waitcnt lgkmcnt(6)
    v_mfma_f32_16x16x32_bf16 a[4:7], a[216:219], v[34:37], a[4:7]
    ds_read_b64_tr_b16 a[234:235], v3 offset:13312
    v_mfma_f32_16x16x32_bf16 v[212:215], a[216:219], v[28:31], v[212:215]
    ds_read_b64_tr_b16 a[232:233], v3 offset:19456
    v_mfma_f32_16x16x32_bf16 v[164:167], a[216:219], v[22:25], v[164:167]
    ds_read_b128 v[88:91], v103 offset:0
    v_mfma_f32_16x16x32_bf16 v[116:119], a[216:219], v[16:19], v[116:119]
    v_fma_f32 v66, v66, s28, v10
    s_waitcnt lgkmcnt(7)
    v_mfma_f32_16x16x32_bf16 v[120:123], a[220:223], v[16:19], v[120:123]
    v_exp_f32 v79, v79
    v_mfma_f32_16x16x32_bf16 v[168:171], a[220:223], v[22:25], v[168:171]
    ds_read_b64_tr_b16 a[218:219], v5 offset:13312
    v_fma_f32 v57, v57, s28, v9
    v_mfma_f32_16x16x32_bf16 v[216:219], a[220:223], v[28:31], v[216:219]
    ds_read_b64_tr_b16 a[214:215], v4 offset:13312
    v_fma_f32 v69, v69, s28, v11
    v_mfma_f32_16x16x32_bf16 a[8:11], a[220:223], v[34:37], a[8:11]
    s_waitcnt lgkmcnt(7)
    ds_read_b64_tr_b16 a[212:213], v4 offset:19456
    v_fma_f32 v82, v82, s28, v12
    v_mfma_f32_16x16x32_bf16 a[12:15], a[224:227], v[34:37], a[12:15]
    ds_read_b64_tr_b16 a[222:223], v2 offset:14336
    v_fma_f32 v73, v73, s28, v11
    v_mfma_f32_16x16x32_bf16 v[220:223], a[224:227], v[28:31], v[220:223]
    v_fma_f32 v62, v62, s28, v10
    v_fma_f32 v77, v77, s28, v12
    v_mfma_f32_16x16x32_bf16 v[172:175], a[224:227], v[22:25], v[172:175]
    s_add_u32 s39, s39, 12288
    ds_read_b64_tr_b16 a[216:217], v5 offset:19456
    v_fma_f32 v75, v75, s28, v11
    v_mfma_f32_16x16x32_bf16 v[124:127], a[224:227], v[16:19], v[124:127]
    s_waitcnt lgkmcnt(6)
    ds_read_b64_tr_b16 a[224:225], v3 offset:20480
    v_fma_f32 v56, v56, s28, v9
    v_mfma_f32_16x16x32_bf16 v[128:131], a[228:231], v[16:19], v[128:131]
    ds_read_b64_tr_b16 a[220:221], v2 offset:20480
    v_fma_f32 v81, v81, s28, v12
    v_mfma_f32_16x16x32_bf16 v[176:179], a[228:231], v[22:25], v[176:179]
    v_fma_f32 v67, v67, s28, v10
    v_fma_f32 v76, v76, s28, v12
    v_mfma_f32_16x16x32_bf16 v[224:227], a[228:231], v[28:31], v[224:227]
    ds_read_b64_tr_b16 a[226:227], v3 offset:14336
    v_fma_f32 v63, v63, s28, v10
    v_mfma_f32_16x16x32_bf16 a[16:19], a[228:231], v[34:37], a[16:19]
    v_exp_f32 v77, v77
    v_mfma_f32_16x16x32_bf16 a[20:23], a[232:235], v[34:37], a[20:23]
    ds_read_b64_tr_b16 a[228:229], v4 offset:20480
    v_fma_f32 v70, v70, s28, v11
    v_mfma_f32_16x16x32_bf16 v[228:231], a[232:235], v[28:31], v[228:231]
    ds_read_b64_tr_b16 a[230:231], v4 offset:14336
    v_fma_f32 v83, v83, s28, v12
    v_mfma_f32_16x16x32_bf16 v[180:183], a[232:235], v[22:25], v[180:183]
    v_fma_f32 v80, v80, s28, v12
    v_fma_f32 v59, v59, s28, v9
    v_mfma_f32_16x16x32_bf16 v[132:135], a[232:235], v[16:19], v[132:135]
    s_waitcnt lgkmcnt(6)
    ds_read_b64_tr_b16 a[234:235], v5 offset:14336
    v_fma_f32 v58, v58, s28, v9
    v_mfma_f32_16x16x32_bf16 v[136:139], a[212:215], v[16:19], v[136:139]
    ds_read_b64_tr_b16 a[232:233], v5 offset:20480
    v_fma_f32 v68, v68, s28, v11
    v_mfma_f32_16x16x32_bf16 v[184:187], a[212:215], v[22:25], v[184:187]
    v_exp_f32 v69, v69
    v_mfma_f32_16x16x32_bf16 v[232:235], a[212:215], v[28:31], v[232:235]
    v_exp_f32 v65, v65
    v_mfma_f32_16x16x32_bf16 a[24:27], a[212:215], v[34:37], a[24:27]
    s_waitcnt lgkmcnt(5)
    v_exp_f32 v70, v70
    v_mfma_f32_16x16x32_bf16 a[28:31], a[216:219], v[34:37], a[28:31]
    v_exp_f32 v81, v81
    v_mfma_f32_16x16x32_bf16 v[236:239], a[216:219], v[28:31], v[236:239]
    v_exp_f32 v63, v63
    v_mfma_f32_16x16x32_bf16 v[188:191], a[216:219], v[22:25], v[188:191]
    v_fma_f32 v78, v78, s28, v12
    v_cvt_pk_bf16_f32 v27, v70, v71
    v_mfma_f32_16x16x32_bf16 v[140:143], a[216:219], v[16:19], v[140:143]
    v_exp_f32 v78, v78
    v_mfma_f32_16x16x32_bf16 v[144:147], a[220:223], v[16:19], v[144:147]
    v_exp_f32 v68, v68
    v_mfma_f32_16x16x32_bf16 v[192:195], a[220:223], v[22:25], v[192:195]
    v_exp_f32 v66, v66
    v_mfma_f32_16x16x32_bf16 v[240:243], a[220:223], v[28:31], v[240:243]
    s_waitcnt vmcnt(10) lgkmcnt(0)
    v_fma_f32 v64, v64, s28, v10
    s_add_u32 m0, s22, 36864
    v_mfma_f32_16x16x32_bf16 a[32:35], a[220:223], v[34:37], a[32:35]
    s_barrier
    v_mfma_f32_16x16x32_bf16 a[36:39], a[224:227], v[34:37], a[36:39]
    ds_read_b128 a[216:219], v1 offset:12288
    v_mfma_f32_16x16x32_bf16 v[244:247], a[224:227], v[28:31], v[244:247]
    buffer_load_dwordx4 v6, s[8:11], s21 offen lds
    v_mfma_f32_16x16x32_bf16 v[196:199], a[224:227], v[22:25], v[196:199]
    s_add_u32 s21, s21, 128
    ds_read_b128 a[220:223], v0 offset:13312
    v_mfma_f32_16x16x32_bf16 v[148:151], a[224:227], v[16:19], v[148:151]
    ds_read_b128 a[212:215], v0 offset:12288
    v_mfma_f32_16x16x32_bf16 v[152:155], a[228:231], v[16:19], v[152:155]
    s_add_u32 m0, s22, 37888
    v_exp_f32 v80, v80
    v_mfma_f32_16x16x32_bf16 v[200:203], a[228:231], v[22:25], v[200:203]
    ds_read_b128 v[96:99], v103 offset:1024
    v_fma_f32 v72, v72, s28, v11
    v_mfma_f32_16x16x32_bf16 v[248:251], a[228:231], v[28:31], v[248:251]
    v_exp_f32 v74, v74
    v_mfma_f32_16x16x32_bf16 a[40:43], a[228:231], v[34:37], a[40:43]
    buffer_load_dwordx4 v6, s[8:11], s21 offen lds
    v_mfma_f32_16x16x32_bf16 a[44:47], a[232:235], v[34:37], a[44:47]
    s_add_u32 s21, s21, 128
    s_add_u32 m0, s22, 38912
    ds_read_b128 a[224:227], v1 offset:13312
    v_mfma_f32_16x16x32_bf16 v[252:255], a[232:235], v[28:31], v[252:255]
    buffer_load_dwordx4 v6, s[8:11], s21 offen lds
    v_mfma_f32_16x16x32_bf16 v[204:207], a[232:235], v[22:25], v[204:207]
    v_exp_f32 v62, v62
    v_mfma_f32_16x16x32_bf16 v[156:159], a[232:235], v[16:19], v[156:159]
    buffer_store_dwordx4 v[88:91], v6, s[16:19], s24 offen offset:0 nt
    s_nop 0
    ds_read_b128 v[88:91], v103 offset:3072
    s_waitcnt lgkmcnt(3)
    v_mfma_f32_16x16x32_bf16 v[52:55], a[212:215], a[96:99], 0
    ds_read_b128 a[228:231], v0 offset:14336
    v_cvt_pk_bf16_f32 v21, v62, v63
    v_mfma_f32_16x16x32_bf16 v[52:55], a[216:219], a[100:103], v[52:55]
    ds_read_b128 a[232:235], v1 offset:14336
    v_cvt_pk_bf16_f32 v33, v78, v79
    v_mfma_f32_16x16x32_bf16 v[52:55], a[220:223], a[104:107], v[52:55]
    v_exp_f32 v76, v76
    v_mfma_f32_16x16x32_bf16 v[60:63], a[220:223], a[128:131], 0
    v_cvt_pk_bf16_f32 v26, v68, v69
    v_cvt_pk_bf16_f32 v32, v76, v77
    v_mfma_f32_16x16x32_bf16 v[60:63], a[216:219], a[124:127], v[60:63]
    v_exp_f32 v57, v57
    v_mfma_f32_16x16x32_bf16 v[60:63], a[212:215], a[120:123], v[60:63]
    v_exp_f32 v82, v82
    v_mfma_f32_16x16x32_bf16 v[68:71], a[212:215], a[144:147], 0
    v_exp_f32 v75, v75
    v_mfma_f32_16x16x32_bf16 v[68:71], a[216:219], a[148:151], v[68:71]
    v_exp_f32 v58, v58
    v_mfma_f32_16x16x32_bf16 v[68:71], a[220:223], a[152:155], v[68:71]
    v_cvt_pk_bf16_f32 v34, v80, v81
    v_cvt_pk_bf16_f32 v29, v74, v75
    v_mfma_f32_16x16x32_bf16 v[76:79], a[220:223], a[176:179], 0
    s_add_u32 s21, s21, 12032
    v_exp_f32 v64, v64
    v_mfma_f32_16x16x32_bf16 v[76:79], a[216:219], a[172:175], v[76:79]
    v_exp_f32 v56, v56
    v_mfma_f32_16x16x32_bf16 v[76:79], a[212:215], a[168:171], v[76:79]
    s_waitcnt lgkmcnt(0)
    v_exp_f32 v72, v72
    v_mfma_f32_16x16x32_bf16 v[76:79], a[224:227], a[180:183], v[76:79]
    v_exp_f32 v67, v67
    v_mfma_f32_16x16x32_bf16 v[76:79], a[228:231], a[184:187], v[76:79]
    v_cvt_pk_bf16_f32 v22, v64, v65
    v_mfma_f32_16x16x32_bf16 v[76:79], a[232:235], a[188:191], v[76:79]
    v_exp_f32 v59, v59
    v_mfma_f32_16x16x32_bf16 v[68:71], a[232:235], a[164:167], v[68:71]
    v_cvt_pk_bf16_f32 v23, v66, v67
    v_cvt_pk_bf16_f32 v17, v58, v59
    v_mfma_f32_16x16x32_bf16 v[68:71], a[228:231], a[160:163], v[68:71]
    ds_read_b128 a[212:215], v0 offset:18432
    v_cvt_pk_bf16_f32 v16, v56, v57
    v_mfma_f32_16x16x32_bf16 v[68:71], a[224:227], a[156:159], v[68:71]
    ds_read_b128 a[216:219], v1 offset:18432
    v_mfma_f32_16x16x32_bf16 v[60:63], a[224:227], a[132:135], v[60:63]
    ds_read_b128 a[220:223], v0 offset:19456
    v_mfma_f32_16x16x32_bf16 v[60:63], a[228:231], a[136:139], v[60:63]
    ds_read_b128 v[84:87], v103 offset:2048
    v_mfma_f32_16x16x32_bf16 v[44:47], a[236:239], v[14:17], v[48:51]
    s_add_u32 s57, s24, 128
    v_exp_f32 v73, v73
    v_mfma_f32_16x16x32_bf16 v[60:63], a[232:235], a[140:143], v[60:63]
    v_exp_f32 v83, v83
    v_mfma_f32_16x16x32_bf16 v[52:55], a[232:235], a[116:119], v[52:55]
    v_mfma_f32_16x16x32_bf16 v[44:47], a[240:243], v[20:23], v[44:47]
    v_mfma_f32_16x16x32_bf16 v[52:55], a[228:231], a[112:115], v[52:55]
    v_cvt_pk_bf16_f32 v28, v72, v73
    v_cvt_pk_bf16_f32 v35, v82, v83
    v_mfma_f32_16x16x32_bf16 v[52:55], a[224:227], a[108:111], v[52:55]
    ds_read_b128 a[224:227], v1 offset:19456
    v_mfma_f32_16x16x32_bf16 v[44:47], a[244:247], v[26:29], v[44:47]
    ds_read_b128 a[232:235], v1 offset:20480
    v_mfma_f32_16x16x32_bf16 v[44:47], a[248:251], v[32:35], v[44:47]
    s_waitcnt lgkmcnt(4)
    ds_read_b128 a[228:231], v0 offset:20480
    v_mfma_f32_16x16x32_bf16 v[56:59], a[212:215], a[96:99], 0
    buffer_store_dwordx4 v[96:99], v7, s[16:19], s24 offen offset:0 nt
    s_nop 3
    v_cmp_lt_f32 vcc, s29, v44
    v_mfma_f32_16x16x32_bf16 v[56:59], a[216:219], a[100:103], v[56:59]
    s_waitcnt lgkmcnt(3)
    v_mfma_f32_16x16x32_bf16 v[56:59], a[220:223], a[104:107], v[56:59]
    buffer_store_dwordx4 v[84:87], v6, s[16:19], s57 offen offset:0 nt
    s_nop 0
    s_cbranch_vccnz L_rs_end4a
L_ret_end4a:
    v_mfma_f32_16x16x32_bf16 v[64:67], a[220:223], a[128:131], 0
    v_fma_f32 v55, v55, s28, v9
    v_fma_f32 v60, v60, s28, v10
    v_mfma_f32_16x16x32_bf16 v[64:67], a[216:219], a[124:127], v[64:67]
    v_fma_f32 v52, v52, s28, v9
    v_mfma_f32_16x16x32_bf16 v[64:67], a[212:215], a[120:123], v[64:67]
    buffer_store_dwordx4 v[88:91], v7, s[16:19], s57 offen offset:0 nt
    s_waitcnt vmcnt(10) lgkmcnt(0)
    v_mfma_f32_16x16x32_bf16 v[72:75], a[212:215], a[144:147], 0
    s_barrier
    v_mfma_f32_16x16x32_bf16 v[72:75], a[216:219], a[148:151], v[72:75]
    v_fma_f32 v61, v61, s28, v10
    v_fma_f32 v54, v54, s28, v9
    v_mfma_f32_16x16x32_bf16 v[72:75], a[220:223], a[152:155], v[72:75]
    v_exp_f32 v61, v61
    v_mfma_f32_16x16x32_bf16 v[80:83], a[220:223], a[176:179], 0
    v_mfma_f32_16x16x32_bf16 v[80:83], a[216:219], a[172:175], v[80:83]
    v_exp_f32 v54, v54
    v_mfma_f32_16x16x32_bf16 v[80:83], a[212:215], a[168:171], v[80:83]
    ds_read_b64_tr_b16 a[212:213], v2 offset:0
    v_fma_f32 v53, v53, s28, v9
    v_mfma_f32_16x16x32_bf16 v[80:83], a[224:227], a[180:183], v[80:83]
    v_exp_f32 v53, v53
    v_mfma_f32_16x16x32_bf16 v[80:83], a[228:231], a[184:187], v[80:83]
    ds_read_b64_tr_b16 a[214:215], v2 offset:6144
    v_mfma_f32_16x16x32_bf16 v[80:83], a[232:235], a[188:191], v[80:83]
    ds_read_b64_tr_b16 a[216:217], v3 offset:0
    v_mfma_f32_16x16x32_bf16 v[72:75], a[232:235], a[164:167], v[72:75]
    v_exp_f32 v55, v55
    v_mfma_f32_16x16x32_bf16 v[72:75], a[228:231], a[160:163], v[72:75]
    ds_read_b64_tr_b16 a[218:219], v3 offset:6144
    v_mfma_f32_16x16x32_bf16 v[72:75], a[224:227], a[156:159], v[72:75]
    v_exp_f32 v60, v60
    v_mfma_f32_16x16x32_bf16 v[64:67], a[224:227], a[132:135], v[64:67]
    v_exp_f32 v52, v52
    v_mfma_f32_16x16x32_bf16 v[64:67], a[228:231], a[136:139], v[64:67]
    v_mfma_f32_16x16x32_bf16 v[64:67], a[232:235], a[140:143], v[64:67]
    v_cvt_pk_bf16_f32 v19, v54, v55
    v_cvt_pk_bf16_f32 v18, v52, v53
    v_mfma_f32_16x16x32_bf16 v[56:59], a[232:235], a[116:119], v[56:59]
    ds_read_b64_tr_b16 a[220:221], v4 offset:0
    v_cvt_pk_bf16_f32 v24, v60, v61
    v_mfma_f32_16x16x32_bf16 v[56:59], a[228:231], a[112:115], v[56:59]
    ds_read_b64_tr_b16 a[222:223], v4 offset:6144
    v_mfma_f32_16x16x32_bf16 v[56:59], a[224:227], a[108:111], v[56:59]
    s_waitcnt lgkmcnt(4)
    ds_read_b64_tr_b16 a[224:225], v5 offset:0
    ds_read_b64_tr_b16 a[226:227], v5 offset:6144
    v_mfma_f32_16x16x32_bf16 v[112:115], a[212:215], v[14:17], v[112:115]
    ds_read_b64_tr_b16 a[232:233], v3 offset:1024
    v_fma_f32 v66, v66, s28, v10
    v_mfma_f32_16x16x32_bf16 v[160:163], a[212:215], v[20:23], v[160:163]
    s_add_u32 s39, s39, 12288
    ds_read_b64_tr_b16 a[230:231], v2 offset:7168
    v_fma_f32 v57, v57, s28, v9
    v_fma_f32 v63, v63, s28, v10
    v_mfma_f32_16x16x32_bf16 v[208:211], a[212:215], v[26:29], v[208:211]
    v_fma_f32 v78, v78, s28, v12
    v_fma_f32 v69, v69, s28, v11
    v_exp_f32 v69, v69
    v_mfma_f32_16x16x32_bf16 a[0:3], a[212:215], v[32:35], a[0:3]
    s_waitcnt lgkmcnt(6)
    ds_read_b64_tr_b16 a[228:229], v2 offset:1024
    v_fma_f32 v67, v67, s28, v10
    v_mfma_f32_16x16x32_bf16 a[4:7], a[216:219], v[32:35], a[4:7]
    ds_read_b64_tr_b16 a[234:235], v3 offset:7168
    v_fma_f32 v83, v83, s28, v12
    v_mfma_f32_16x16x32_bf16 v[212:215], a[216:219], v[26:29], v[212:215]
    v_exp_f32 v78, v78
    v_mfma_f32_16x16x32_bf16 v[164:167], a[216:219], v[20:23], v[164:167]
    s_waitcnt vmcnt(4)
    ds_read_b64_tr_b16 a[212:213], v4 offset:1024
    v_fma_f32 v73, v73, s28, v11
    v_mfma_f32_16x16x32_bf16 v[116:119], a[216:219], v[14:17], v[116:119]
    s_waitcnt lgkmcnt(7)
    v_exp_f32 v73, v73
    v_mfma_f32_16x16x32_bf16 v[120:123], a[220:223], v[14:17], v[120:123]
    s_barrier
    v_fma_f32 v81, v81, s28, v12
    v_mfma_f32_16x16x32_bf16 v[168:171], a[220:223], v[20:23], v[168:171]
    ds_read_b64_tr_b16 a[214:215], v4 offset:7168
    v_fma_f32 v75, v75, s28, v11
    v_mfma_f32_16x16x32_bf16 v[216:219], a[220:223], v[26:29], v[216:219]
    ds_read_b64_tr_b16 a[216:217], v5 offset:1024
    v_fma_f32 v77, v77, s28, v12
    v_mfma_f32_16x16x32_bf16 a[8:11], a[220:223], v[32:35], a[8:11]
    s_waitcnt lgkmcnt(5)
    v_exp_f32 v57, v57
    v_mfma_f32_16x16x32_bf16 a[12:15], a[224:227], v[32:35], a[12:15]
    ds_read_b64_tr_b16 a[222:223], v2 offset:8192
    v_fma_f32 v64, v64, s28, v10
    v_fma_f32 v62, v62, s28, v10
    v_mfma_f32_16x16x32_bf16 v[220:223], a[224:227], v[26:29], v[220:223]
    v_exp_f32 v67, v67
    v_mfma_f32_16x16x32_bf16 v[172:175], a[224:227], v[20:23], v[172:175]
    ds_read_b64_tr_b16 a[220:221], v2 offset:2048
    v_fma_f32 v70, v70, s28, v11
    v_mfma_f32_16x16x32_bf16 v[124:127], a[224:227], v[14:17], v[124:127]
    s_waitcnt lgkmcnt(5)
    ds_read_b64_tr_b16 a[218:219], v5 offset:7168
    v_fma_f32 v68, v68, s28, v11
    v_mfma_f32_16x16x32_bf16 v[128:131], a[228:231], v[14:17], v[128:131]
    v_exp_f32 v81, v81
    v_mfma_f32_16x16x32_bf16 v[176:179], a[228:231], v[20:23], v[176:179]
    v_fma_f32 v59, v59, s28, v9
    v_fma_f32 v80, v80, s28, v12
    v_mfma_f32_16x16x32_bf16 v[224:227], a[228:231], v[26:29], v[224:227]
    v_fma_f32 v72, v72, s28, v11
    v_exp_f32 v63, v63
    v_mfma_f32_16x16x32_bf16 a[16:19], a[228:231], v[32:35], a[16:19]
    v_fma_f32 v71, v71, s28, v11
    v_fma_f32 v79, v79, s28, v12
    v_mfma_f32_16x16x32_bf16 a[20:23], a[232:235], v[32:35], a[20:23]
    v_exp_f32 v77, v77
    v_fma_f32 v76, v76, s28, v12
    v_mfma_f32_16x16x32_bf16 v[228:231], a[232:235], v[26:29], v[228:231]
    v_exp_f32 v71, v71
    v_mfma_f32_16x16x32_bf16 v[180:183], a[232:235], v[20:23], v[180:183]
    ds_read_b64_tr_b16 a[226:227], v3 offset:8192
    v_exp_f32 v68, v68
    v_mfma_f32_16x16x32_bf16 v[132:135], a[232:235], v[14:17], v[132:135]
    s_waitcnt lgkmcnt(2)
    v_exp_f32 v83, v83
    v_mfma_f32_16x16x32_bf16 v[136:139], a[212:215], v[14:17], v[136:139]
    ds_read_b64_tr_b16 a[228:229], v4 offset:2048
    v_fma_f32 v58, v58, s28, v9
    v_mfma_f32_16x16x32_bf16 v[184:187], a[212:215], v[20:23], v[184:187]
    ds_read_b64_tr_b16 a[224:225], v3 offset:2048
    v_exp_f32 v75, v75
    v_mfma_f32_16x16x32_bf16 v[232:235], a[212:215], v[26:29], v[232:235]
    v_exp_f32 v79, v79
    v_mfma_f32_16x16x32_bf16 a[24:27], a[212:215], v[32:35], a[24:27]
    s_waitcnt lgkmcnt(3)
    ds_read_b64_tr_b16 a[230:231], v4 offset:8192
    v_fma_f32 v56, v56, s28, v9
    v_mfma_f32_16x16x32_bf16 a[28:31], a[216:219], v[32:35], a[28:31]
    v_exp_f32 v58, v58
    v_mfma_f32_16x16x32_bf16 v[236:239], a[216:219], v[26:29], v[236:239]
    v_exp_f32 v64, v64
    v_mfma_f32_16x16x32_bf16 v[188:191], a[216:219], v[20:23], v[188:191]
    ds_read_b64_tr_b16 a[234:235], v5 offset:8192
    v_exp_f32 v56, v56
    v_mfma_f32_16x16x32_bf16 v[140:143], a[216:219], v[14:17], v[140:143]
    v_exp_f32 v66, v66
    v_mfma_f32_16x16x32_bf16 v[144:147], a[220:223], v[14:17], v[144:147]
    v_exp_f32 v76, v76
    v_mfma_f32_16x16x32_bf16 v[192:195], a[220:223], v[20:23], v[192:195]
    ds_read_b64_tr_b16 a[232:233], v5 offset:2048
    v_cvt_pk_bf16_f32 v30, v68, v69
    v_mfma_f32_16x16x32_bf16 v[240:243], a[220:223], v[26:29], v[240:243]
    ds_read_b64_tr_b16 a[212:213], v2 offset:18432
    v_fma_f32 v82, v82, s28, v12
    v_mfma_f32_16x16x32_bf16 a[32:35], a[220:223], v[32:35], a[32:35]
    s_waitcnt lgkmcnt(4)
    v_fma_f32 v74, v74, s28, v11
    v_exp_f32 v59, v59
    v_mfma_f32_16x16x32_bf16 a[36:39], a[224:227], v[32:35], a[36:39]
    v_exp_f32 v62, v62
    v_mfma_f32_16x16x32_bf16 v[244:247], a[224:227], v[26:29], v[244:247]
    ds_read_b64_tr_b16 a[214:215], v2 offset:12288
    v_fma_f32 v65, v65, s28, v10
    v_mfma_f32_16x16x32_bf16 v[196:199], a[224:227], v[20:23], v[196:199]
    v_exp_f32 v80, v80
    v_mfma_f32_16x16x32_bf16 v[148:151], a[224:227], v[14:17], v[148:151]
    s_waitcnt lgkmcnt(4)
    v_exp_f32 v72, v72
    v_mfma_f32_16x16x32_bf16 v[152:155], a[228:231], v[14:17], v[152:155]
    ds_read_b64_tr_b16 a[216:217], v3 offset:18432
    v_exp_f32 v74, v74
    v_mfma_f32_16x16x32_bf16 v[200:203], a[228:231], v[20:23], v[200:203]
    ds_read_b64_tr_b16 a[218:219], v3 offset:12288
    v_cvt_pk_bf16_f32 v25, v62, v63
    v_mfma_f32_16x16x32_bf16 v[248:251], a[228:231], v[26:29], v[248:251]
    v_exp_f32 v70, v70
    v_mfma_f32_16x16x32_bf16 a[40:43], a[228:231], v[32:35], a[40:43]
    s_waitcnt lgkmcnt(4)
    v_exp_f32 v65, v65
    v_mfma_f32_16x16x32_bf16 a[44:47], a[232:235], v[32:35], a[44:47]
    v_exp_f32 v82, v82
    v_mfma_f32_16x16x32_bf16 v[252:255], a[232:235], v[26:29], v[252:255]
    v_cvt_pk_bf16_f32 v31, v70, v71
    v_cvt_pk_bf16_f32 v28, v72, v73
    v_mfma_f32_16x16x32_bf16 v[204:207], a[232:235], v[20:23], v[204:207]
    v_cvt_pk_bf16_f32 v37, v78, v79
    v_cvt_pk_bf16_f32 v22, v64, v65
    v_mfma_f32_16x16x32_bf16 v[156:159], a[232:235], v[14:17], v[156:159]
    ds_read_b64_tr_b16 a[220:221], v4 offset:18432
    v_cvt_pk_bf16_f32 v16, v56, v57
    v_cvt_pk_bf16_f32 v17, v58, v59
    v_cvt_pk_bf16_f32 v23, v66, v67
    v_cvt_pk_bf16_f32 v34, v80, v81
    v_mfma_f32_16x16x32_bf16 v[48:51], a[236:239], v[16:19], v[44:47]
    v_cvt_pk_bf16_f32 v36, v76, v77
    v_cvt_pk_bf16_f32 v29, v74, v75
    v_mfma_f32_16x16x32_bf16 v[48:51], a[240:243], v[22:25], v[48:51]
    ds_read_b64_tr_b16 a[222:223], v4 offset:12288
    v_cvt_pk_bf16_f32 v35, v82, v83
    v_mfma_f32_16x16x32_bf16 v[48:51], a[244:247], v[28:31], v[48:51]
    ds_read_b64_tr_b16 a[224:225], v5 offset:18432
    v_mfma_f32_16x16x32_bf16 v[48:51], a[248:251], v[34:37], v[48:51]
    s_waitcnt lgkmcnt(3)
    ds_read_b64_tr_b16 a[226:227], v5 offset:12288
    s_nop 5
    v_cmp_lt_f32 vcc, s29, v48
    s_nop 4
    s_cbranch_vccnz L_rs_end4b
L_ret_end4b:
    v_lshrrev_b32 v108, 11, v0
    v_rcp_f32 v102, v49
    v_and_b32 v101, 0x3ff, v0
    v_xor_b32 v108, s65, v108
    v_lshl_add_u32 v101, v108, 10, v101
    v_mov_b32 v100, v48
    v_mbcnt_lo_u32_b32 v108, -1, 0
    v_rcp_f32 v50, v50
    v_permlane32_swap_b32 v48, v100
    v_add_u32 v101, s38, v101
    v_mbcnt_hi_u32_b32 v108, -1, v108
    v_lshrrev_b32 v108, 1, v108
    v_and_b32 v108, 24, v108
    v_rcp_f32 v48, v48
    v_rcp_f32 v8, v51
    v_bfe_u32 v108, s66, v108, 8
    v_xor_b32 v101, v101, v108
    v_mfma_f32_16x16x32_bf16 v[112:115], a[212:215], v[16:19], v[112:115]
    ds_read_b64_tr_b16 a[234:235], v3 offset:13312
    v_mfma_f32_16x16x32_bf16 v[160:163], a[212:215], v[22:25], v[160:163]
    v_mfma_f32_16x16x32_bf16 v[208:211], a[212:215], v[28:31], v[208:211]
    ds_read_b64_tr_b16 a[228:229], v2 offset:19456
    v_mfma_f32_16x16x32_bf16 a[0:3], a[212:215], v[34:37], a[0:3]
    s_waitcnt lgkmcnt(6)
    v_mfma_f32_16x16x32_bf16 a[4:7], a[216:219], v[34:37], a[4:7]
    ds_read_b64_tr_b16 a[230:231], v2 offset:13312
    v_xor_b32 v94, 96, v101
    v_mfma_f32_16x16x32_bf16 v[212:215], a[216:219], v[28:31], v[212:215]
    ds_read_b64_tr_b16 a[214:215], v4 offset:13312
    v_mfma_f32_16x16x32_bf16 v[164:167], a[216:219], v[22:25], v[164:167]
    v_mfma_f32_16x16x32_bf16 v[116:119], a[216:219], v[16:19], v[116:119]
    s_waitcnt lgkmcnt(6)
    v_mfma_f32_16x16x32_bf16 v[120:123], a[220:223], v[16:19], v[120:123]
    v_xor_b32 v93, 64, v101
    v_mfma_f32_16x16x32_bf16 v[168:171], a[220:223], v[22:25], v[168:171]
    ds_read_b64_tr_b16 a[232:233], v3 offset:19456
    v_accvgpr_read_b32 v107, a3
    v_mfma_f32_16x16x32_bf16 v[216:219], a[220:223], v[28:31], v[216:219]
    v_accvgpr_read_b32 v105, a1
    v_mfma_f32_16x16x32_bf16 a[8:11], a[220:223], v[34:37], a[8:11]
    s_waitcnt lgkmcnt(4)
    ds_read_b64_tr_b16 a[216:217], v5 offset:19456
    v_accvgpr_read_b32 v110, a6
    v_mfma_f32_16x16x32_bf16 a[12:15], a[224:227], v[34:37], a[12:15]
    s_add_u32 s84, s34, 0
    ds_read_b64_tr_b16 a[212:213], v4 offset:19456
    v_mfma_f32_16x16x32_bf16 v[220:223], a[224:227], v[28:31], v[220:223]
    ds_read_b64_tr_b16 a[222:223], v2 offset:14336
    s_add_u32 s85, s34, 6144
    v_mfma_f32_16x16x32_bf16 v[172:175], a[224:227], v[22:25], v[172:175]
    ds_read_b64_tr_b16 a[218:219], v5 offset:13312
    v_mfma_f32_16x16x32_bf16 v[124:127], a[224:227], v[16:19], v[124:127]
    s_waitcnt lgkmcnt(5)
    ds_read_b64_tr_b16 a[220:221], v2 offset:20480
    v_accvgpr_read_b32 v56, a12
    v_mfma_f32_16x16x32_bf16 v[128:131], a[228:231], v[16:19], v[128:131]
    v_accvgpr_read_b32 v109, a5
    v_mfma_f32_16x16x32_bf16 v[176:179], a[228:231], v[22:25], v[176:179]
    v_subrev_u32 v103, 24576, v103
    v_accvgpr_read_b32 v57, a13
    v_mfma_f32_16x16x32_bf16 v[224:227], a[228:231], v[28:31], v[224:227]
    v_mfma_f32_16x16x32_bf16 a[16:19], a[228:231], v[34:37], a[16:19]
    v_accvgpr_read_b32 v108, a4
    ds_read_b64_tr_b16 a[226:227], v3 offset:14336
    s_add_u32 s86, s34, 12288
    v_pk_mul_f32 v[160:161], v[160:161], v[102:103] op_sel_hi:[1,0]
    v_pk_mul_f32 v[220:221], v[220:221], v[50:51] op_sel_hi:[1,0]
    v_pk_mul_f32 v[120:121], v[120:121], v[48:49] op_sel_hi:[1,0]
    v_pk_mul_f32 v[116:117], v[116:117], v[48:49] op_sel_hi:[1,0]
    v_pk_mul_f32 v[164:165], v[164:165], v[102:103] op_sel_hi:[1,0]
    v_pk_mul_f32 v[168:169], v[168:169], v[102:103] op_sel_hi:[1,0]
    v_pk_mul_f32 v[172:173], v[172:173], v[102:103] op_sel_hi:[1,0]
    v_pk_mul_f32 v[114:115], v[114:115], v[48:49] op_sel_hi:[1,0]
    v_pk_mul_f32 v[130:131], v[130:131], v[48:49] op_sel_hi:[1,0]
    v_pk_mul_f32 v[112:113], v[112:113], v[48:49] op_sel_hi:[1,0]
    v_pk_mul_f32 v[170:171], v[170:171], v[102:103] op_sel_hi:[1,0]
    v_pk_mul_f32 v[162:163], v[162:163], v[102:103] op_sel_hi:[1,0]
    v_pk_mul_f32 v[174:175], v[174:175], v[102:103] op_sel_hi:[1,0]
    v_accvgpr_read_b32 v54, a10
    s_waitcnt lgkmcnt(2)
    v_mfma_f32_16x16x32_bf16 a[20:23], a[232:235], v[34:37], a[20:23]
    v_mfma_f32_16x16x32_bf16 v[228:231], a[232:235], v[28:31], v[228:231]
    ds_read_b64_tr_b16 a[224:225], v3 offset:20480
    v_mfma_f32_16x16x32_bf16 v[180:183], a[232:235], v[22:25], v[180:183]
    v_cvt_pk_bf16_f32 v120, v120, v121
    v_mfma_f32_16x16x32_bf16 v[132:135], a[232:235], v[16:19], v[132:135]
    v_xor_b32 v92, 32, v101
    v_accvgpr_read_b32 v104, a0
    v_mfma_f32_16x16x32_bf16 v[136:139], a[212:215], v[16:19], v[136:139]
    v_cvt_pk_bf16_f32 v112, v112, v113
    v_mfma_f32_16x16x32_bf16 v[184:187], a[212:215], v[22:25], v[184:187]
    v_cvt_pk_bf16_f32 v164, v164, v165
    v_mfma_f32_16x16x32_bf16 v[232:235], a[212:215], v[28:31], v[232:235]
    ds_read_b64_tr_b16 a[228:229], v4 offset:20480
    v_cvt_pk_bf16_f32 v220, v220, v221
    v_mfma_f32_16x16x32_bf16 a[24:27], a[212:215], v[34:37], a[24:27]
    ds_read_b64_tr_b16 a[234:235], v5 offset:14336
    v_cvt_pk_bf16_f32 v168, v168, v169
    v_mfma_f32_16x16x32_bf16 a[28:31], a[216:219], v[34:37], a[28:31]
    v_mfma_f32_16x16x32_bf16 v[236:239], a[216:219], v[28:31], v[236:239]
    ds_read_b64_tr_b16 a[230:231], v4 offset:14336
    v_mfma_f32_16x16x32_bf16 v[188:191], a[216:219], v[22:25], v[188:191]
    v_accvgpr_read_b32 v52, a8
    v_mfma_f32_16x16x32_bf16 v[140:143], a[216:219], v[16:19], v[140:143]
    s_waitcnt lgkmcnt(3)
    v_cvt_pk_bf16_f32 v116, v116, v117
    v_cvt_pk_bf16_f32 v113, v114, v115
    v_mfma_f32_16x16x32_bf16 v[144:147], a[220:223], v[16:19], v[144:147]
    v_cvt_pk_bf16_f32 v160, v160, v161
    v_mfma_f32_16x16x32_bf16 v[192:195], a[220:223], v[22:25], v[192:195]
    v_cvt_pk_bf16_f32 v161, v162, v163
    v_cvt_pk_bf16_f32 v172, v172, v173
    v_mfma_f32_16x16x32_bf16 v[240:243], a[220:223], v[28:31], v[240:243]
    s_add_u32 s87, s34, 18432
    v_cvt_pk_bf16_f32 v169, v170, v171
    v_mfma_f32_16x16x32_bf16 a[32:35], a[220:223], v[34:37], a[32:35]
    ds_write2st64_b64 v101, v[112:113], v[160:161] offset0:0 offset1:12
    v_pk_mul_f32 v[118:119], v[118:119], v[48:49] op_sel_hi:[1,0]
    v_pk_mul_f32 v[126:127], v[126:127], v[48:49] op_sel_hi:[1,0]
    v_pk_mul_f32 v[122:123], v[122:123], v[48:49] op_sel_hi:[1,0]
    v_pk_mul_f32 v[124:125], v[124:125], v[48:49] op_sel_hi:[1,0]
    v_pk_mul_f32 v[166:167], v[166:167], v[102:103] op_sel_hi:[1,0]
    v_cvt_pk_bf16_f32 v121, v122, v123
    v_cvt_pk_bf16_f32 v165, v166, v167
    v_mfma_f32_16x16x32_bf16 a[36:39], a[224:227], v[34:37], a[36:39]
    v_cvt_pk_bf16_f32 v117, v118, v119
    v_cvt_pk_bf16_f32 v124, v124, v125
    v_mfma_f32_16x16x32_bf16 v[244:247], a[224:227], v[28:31], v[244:247]
    v_accvgpr_read_b32 v53, a9
    v_cvt_pk_bf16_f32 v125, v126, v127
    v_mfma_f32_16x16x32_bf16 v[196:199], a[224:227], v[22:25], v[196:199]
    ds_read_b64_tr_b16 a[232:233], v5 offset:20480
    v_cvt_pk_bf16_f32 v173, v174, v175
    v_mfma_f32_16x16x32_bf16 v[148:151], a[224:227], v[16:19], v[148:151]
    s_waitcnt lgkmcnt(2)
    ds_write2st64_b64 v92, v[116:117], v[164:165] offset0:0 offset1:12
    v_mfma_f32_16x16x32_bf16 v[152:155], a[228:231], v[16:19], v[152:155]
    ds_write2st64_b64 v93, v[120:121], v[168:169] offset0:0 offset1:12
    v_mfma_f32_16x16x32_bf16 v[200:203], a[228:231], v[22:25], v[200:203]
    ds_write2st64_b64 v94, v[124:125], v[172:173] offset0:0 offset1:12
    v_mfma_f32_16x16x32_bf16 v[248:251], a[228:231], v[28:31], v[248:251]
    ds_read_b128 v[80:83], v103 offset:0
    v_pk_mul_f32 v[208:209], v[208:209], v[50:51] op_sel_hi:[1,0]
    v_pk_mul_f32 v[216:217], v[216:217], v[50:51] op_sel_hi:[1,0]
    v_accvgpr_read_b32 v59, a15
    v_cvt_pk_bf16_f32 v208, v208, v209
    v_accvgpr_read_b32 v111, a7
    v_pk_mul_f32 v[128:129], v[128:129], v[48:49] op_sel_hi:[1,0]
    s_add_u32 s18, s34, 24576
    v_pk_mul_f32 v[214:215], v[214:215], v[50:51] op_sel_hi:[1,0]
    v_pk_mul_f32 v[224:225], v[224:225], v[50:51] op_sel_hi:[1,0]
    v_accvgpr_read_b32 v55, a11
    v_accvgpr_read_b32 v106, a2
    v_pk_mul_f32 v[186:187], v[186:187], v[102:103] op_sel_hi:[1,0]
    v_pk_mul_f32 v[52:53], v[52:53], v[8:9] op_sel_hi:[1,0]
    v_pk_mul_f32 v[218:219], v[218:219], v[50:51] op_sel_hi:[1,0]
    v_pk_mul_f32 v[210:211], v[210:211], v[50:51] op_sel_hi:[1,0]
    s_nop 1
    v_mfma_f32_16x16x32_bf16 a[40:43], a[228:231], v[34:37], a[40:43]
    s_waitcnt lgkmcnt(3)
    ds_read_b128 v[84:87], v103 offset:1024
    v_mfma_f32_16x16x32_bf16 a[44:47], a[232:235], v[34:37], a[44:47]
    v_pk_mul_f32 v[228:229], v[228:229], v[50:51] op_sel_hi:[1,0]
    v_pk_mul_f32 v[212:213], v[212:213], v[50:51] op_sel_hi:[1,0]
    v_pk_mul_f32 v[230:231], v[230:231], v[50:51] op_sel_hi:[1,0]
    v_pk_mul_f32 v[136:137], v[136:137], v[48:49] op_sel_hi:[1,0]
    s_waitcnt lgkmcnt(1)
    buffer_store_dwordx4 v[80:83], v6, s[16:19], s84 offen offset:0 nt
    v_pk_mul_f32 v[106:107], v[106:107], v[8:9] op_sel_hi:[1,0]
    v_pk_mul_f32 v[132:133], v[132:133], v[48:49] op_sel_hi:[1,0]
    v_pk_mul_f32 v[56:57], v[56:57], v[8:9] op_sel_hi:[1,0]
    v_cvt_pk_bf16_f32 v52, v52, v53
    v_pk_mul_f32 v[196:197], v[196:197], v[102:103] op_sel_hi:[1,0]
    v_pk_mul_f32 v[110:111], v[110:111], v[8:9] op_sel_hi:[1,0]
    v_pk_mul_f32 v[104:105], v[104:105], v[8:9] op_sel_hi:[1,0]
    v_pk_mul_f32 v[140:141], v[140:141], v[48:49] op_sel_hi:[1,0]
    v_pk_mul_f32 v[192:193], v[192:193], v[102:103] op_sel_hi:[1,0]
    v_pk_mul_f32 v[178:179], v[178:179], v[102:103] op_sel_hi:[1,0]
    v_pk_mul_f32 v[108:109], v[108:109], v[8:9] op_sel_hi:[1,0]
    v_cvt_pk_bf16_f32 v56, v56, v57
    v_cvt_pk_bf16_f32 v212, v212, v213
    v_cvt_pk_bf16_f32 v216, v216, v217
    v_pk_mul_f32 v[54:55], v[54:55], v[8:9] op_sel_hi:[1,0]
    ds_read_b128 v[88:91], v103 offset:6144
    v_pk_mul_f32 v[234:235], v[234:235], v[50:51] op_sel_hi:[1,0]
    v_cvt_pk_bf16_f32 v108, v108, v109
    v_cvt_pk_bf16_f32 v53, v54, v55
    v_cvt_pk_bf16_f32 v104, v104, v105
    v_mfma_f32_16x16x32_bf16 v[252:255], a[232:235], v[28:31], v[252:255]
    v_cvt_pk_bf16_f32 v209, v210, v211
    ds_read_b128 v[60:63], v103 offset:7168
    v_mfma_f32_16x16x32_bf16 v[204:207], a[232:235], v[22:25], v[204:207]
    s_waitcnt lgkmcnt(2)
    buffer_store_dwordx4 v[84:87], v7, s[16:19], s84 offen offset:0 nt
    v_cvt_pk_bf16_f32 v109, v110, v111
    v_pk_mul_f32 v[248:249], v[248:249], v[50:51] op_sel_hi:[1,0]
    v_pk_mul_f32 v[200:201], v[200:201], v[102:103] op_sel_hi:[1,0]
    v_pk_mul_f32 v[222:223], v[222:223], v[50:51] op_sel_hi:[1,0]
    v_cvt_pk_bf16_f32 v128, v128, v129
    v_cvt_pk_bf16_f32 v228, v228, v229
    v_pk_mul_f32 v[144:145], v[144:145], v[48:49] op_sel_hi:[1,0]
    v_cvt_pk_bf16_f32 v213, v214, v215
    v_cvt_pk_bf16_f32 v229, v230, v231
    v_accvgpr_read_b32 v58, a14
    v_pk_mul_f32 v[190:191], v[190:191], v[102:103] op_sel_hi:[1,0]
    v_pk_mul_f32 v[58:59], v[58:59], v[8:9] op_sel_hi:[1,0]
    v_cvt_pk_bf16_f32 v105, v106, v107
    v_pk_mul_f32 v[188:189], v[188:189], v[102:103] op_sel_hi:[1,0]
    v_pk_mul_f32 v[138:139], v[138:139], v[48:49] op_sel_hi:[1,0]
    v_pk_mul_f32 v[252:253], v[252:253], v[50:51] op_sel_hi:[1,0]
    ds_write2st64_b64 v101, v[208:209], v[104:105] offset0:24 offset1:36
    s_nop 0
    v_mfma_f32_16x16x32_bf16 v[156:159], a[232:235], v[16:19], v[156:159]
    s_waitcnt lgkmcnt(2)
    v_cvt_pk_bf16_f32 v221, v222, v223
    v_cvt_pk_bf16_f32 v140, v140, v141
    v_cvt_pk_bf16_f32 v217, v218, v219
    buffer_store_dwordx4 v[88:91], v6, s[16:19], s85 offen offset:0 nt
    ds_write2st64_b64 v92, v[212:213], v[108:109] offset0:24 offset1:36
    v_pk_mul_f32 v[236:237], v[236:237], v[50:51] op_sel_hi:[1,0]
    v_pk_mul_f32 v[202:203], v[202:203], v[102:103] op_sel_hi:[1,0]
    v_pk_mul_f32 v[142:143], v[142:143], v[48:49] op_sel_hi:[1,0]
    v_pk_mul_f32 v[176:177], v[176:177], v[102:103] op_sel_hi:[1,0]
    v_accvgpr_read_b32 v109, a21
    v_cvt_pk_bf16_f32 v57, v58, v59
    v_pk_mul_f32 v[148:149], v[148:149], v[48:49] op_sel_hi:[1,0]
    v_accvgpr_read_b32 v111, a23
    ds_write2st64_b64 v93, v[216:217], v[52:53] offset0:24 offset1:36
    ds_write2st64_b64 v94, v[220:221], v[56:57] offset0:24 offset1:36
    ds_read_b128 v[64:67], v103 offset:12288
    v_cvt_pk_bf16_f32 v148, v148, v149
    s_waitcnt lgkmcnt(4)
    buffer_store_dwordx4 v[60:63], v7, s[16:19], s85 offen offset:0 nt
    v_pk_mul_f32 v[254:255], v[254:255], v[50:51] op_sel_hi:[1,0]
    v_cvt_pk_bf16_f32 v132, v132, v133
    ds_read_b128 v[68:71], v103 offset:13312
    v_accvgpr_read_b32 v110, a22
    v_cvt_pk_bf16_f32 v188, v188, v189
    v_pk_mul_f32 v[134:135], v[134:135], v[48:49] op_sel_hi:[1,0]
    v_accvgpr_read_b32 v104, a16
    v_accvgpr_read_b32 v59, a31
    v_accvgpr_read_b32 v105, a17
    v_cvt_pk_bf16_f32 v236, v236, v237
    v_accvgpr_read_b32 v108, a20
    v_pk_mul_f32 v[104:105], v[104:105], v[8:9] op_sel_hi:[1,0]
    v_accvgpr_read_b32 v56, a28
    v_cvt_pk_bf16_f32 v133, v134, v135
    v_pk_mul_f32 v[240:241], v[240:241], v[50:51] op_sel_hi:[1,0]
    v_pk_mul_f32 v[198:199], v[198:199], v[102:103] op_sel_hi:[1,0]
    v_pk_mul_f32 v[180:181], v[180:181], v[102:103] op_sel_hi:[1,0]
    v_cvt_pk_bf16_f32 v224, v224, v225
    v_cvt_pk_bf16_f32 v136, v136, v137
    v_cvt_pk_bf16_f32 v141, v142, v143
    v_cvt_pk_bf16_f32 v129, v130, v131
    s_waitcnt lgkmcnt(1)
    buffer_store_dwordx4 v[64:67], v6, s[16:19], s86 offen offset:0 nt
    v_cvt_pk_bf16_f32 v176, v176, v177
    v_pk_mul_f32 v[184:185], v[184:185], v[102:103] op_sel_hi:[1,0]
    v_cvt_pk_bf16_f32 v177, v178, v179
    v_accvgpr_read_b32 v55, a27
    v_pk_mul_f32 v[232:233], v[232:233], v[50:51] op_sel_hi:[1,0]
    v_pk_mul_f32 v[150:151], v[150:151], v[48:49] op_sel_hi:[1,0]
    v_pk_mul_f32 v[108:109], v[108:109], v[8:9] op_sel_hi:[1,0]
    v_cvt_pk_bf16_f32 v189, v190, v191
    v_pk_mul_f32 v[244:245], v[244:245], v[50:51] op_sel_hi:[1,0]
    ds_read_b128 v[72:75], v103 offset:18432
    v_cvt_pk_bf16_f32 v144, v144, v145
    v_cvt_pk_bf16_f32 v184, v184, v185
    v_accvgpr_read_b32 v54, a26
    v_accvgpr_read_b32 v107, a19
    v_cvt_pk_bf16_f32 v180, v180, v181
    v_cvt_pk_bf16_f32 v185, v186, v187
    v_pk_mul_f32 v[154:155], v[154:155], v[48:49] op_sel_hi:[1,0]
    v_accvgpr_read_b32 v53, a25
    v_cvt_pk_bf16_f32 v200, v200, v201
    v_accvgpr_read_b32 v57, a29
    v_pk_mul_f32 v[182:183], v[182:183], v[102:103] op_sel_hi:[1,0]
    v_pk_mul_f32 v[246:247], v[246:247], v[50:51] op_sel_hi:[1,0]
    v_pk_mul_f32 v[156:157], v[156:157], v[48:49] op_sel_hi:[1,0]
    v_cvt_pk_bf16_f32 v196, v196, v197
    v_cvt_pk_bf16_f32 v108, v108, v109
    v_pk_mul_f32 v[152:153], v[152:153], v[48:49] op_sel_hi:[1,0]
    s_waitcnt lgkmcnt(1)
    buffer_store_dwordx4 v[68:71], v7, s[16:19], s86 offen offset:0 nt
    ds_read_b128 v[76:79], v103 offset:19456
    v_pk_mul_f32 v[226:227], v[226:227], v[50:51] op_sel_hi:[1,0]
    v_cvt_pk_bf16_f32 v181, v182, v183
    v_cvt_pk_bf16_f32 v244, v244, v245
    v_pk_mul_f32 v[110:111], v[110:111], v[8:9] op_sel_hi:[1,0]
    v_pk_mul_f32 v[204:205], v[204:205], v[102:103] op_sel_hi:[1,0]
    v_cvt_pk_bf16_f32 v192, v192, v193
    v_cvt_pk_bf16_f32 v225, v226, v227
    v_cvt_pk_bf16_f32 v152, v152, v153
    v_cvt_pk_bf16_f32 v137, v138, v139
    ds_write2st64_b64 v101, v[128:129], v[176:177] offset0:4 offset1:16
    v_pk_mul_f32 v[158:159], v[158:159], v[48:49] op_sel_hi:[1,0]
    v_pk_mul_f32 v[238:239], v[238:239], v[50:51] op_sel_hi:[1,0]
    v_pk_mul_f32 v[250:251], v[250:251], v[50:51] op_sel_hi:[1,0]
    v_accvgpr_read_b32 v58, a30
    v_cvt_pk_bf16_f32 v204, v204, v205
    v_cvt_pk_bf16_f32 v109, v110, v111
    s_waitcnt lgkmcnt(2)
    buffer_store_dwordx4 v[72:75], v6, s[16:19], s87 offen offset:0 nt
    v_accvgpr_read_b32 v52, a24
    ds_write2st64_b64 v92, v[132:133], v[180:181] offset0:4 offset1:16
    ds_write2st64_b64 v93, v[136:137], v[184:185] offset0:4 offset1:16
    ds_write2st64_b64 v94, v[140:141], v[188:189] offset0:4 offset1:16
    v_pk_mul_f32 v[54:55], v[54:55], v[8:9] op_sel_hi:[1,0]
    ds_read_b128 v[80:83], v103 offset:2048
    v_pk_mul_f32 v[242:243], v[242:243], v[50:51] op_sel_hi:[1,0]
    ds_read_b128 v[84:87], v103 offset:3072
    v_pk_mul_f32 v[52:53], v[52:53], v[8:9] op_sel_hi:[1,0]
    v_pk_mul_f32 v[206:207], v[206:207], v[102:103] op_sel_hi:[1,0]
    s_waitcnt lgkmcnt(5)
    buffer_store_dwordx4 v[76:79], v7, s[16:19], s87 offen offset:0 nt
    v_cvt_pk_bf16_f32 v52, v52, v53
    v_accvgpr_read_b32 v110, a38
    v_pk_mul_f32 v[56:57], v[56:57], v[8:9] op_sel_hi:[1,0]
    v_cvt_pk_bf16_f32 v232, v232, v233
    v_cvt_pk_bf16_f32 v197, v198, v199
    v_cvt_pk_bf16_f32 v53, v54, v55
    v_accvgpr_read_b32 v106, a18
    ds_read_b128 v[88:91], v103 offset:8192
    v_cvt_pk_bf16_f32 v153, v154, v155
    v_cvt_pk_bf16_f32 v56, v56, v57
    v_pk_mul_f32 v[58:59], v[58:59], v[8:9] op_sel_hi:[1,0]
    v_cvt_pk_bf16_f32 v248, v248, v249
    s_waitcnt lgkmcnt(2)
    buffer_store_dwordx4 v[80:83], v6, s[16:19], s84 offen offset:128 nt
    v_pk_mul_f32 v[106:107], v[106:107], v[8:9] op_sel_hi:[1,0]
    ds_read_b128 v[60:63], v103 offset:9216
    v_cvt_pk_bf16_f32 v104, v104, v105
    v_cvt_pk_bf16_f32 v57, v58, v59
    v_cvt_pk_bf16_f32 v105, v106, v107
    v_cvt_pk_bf16_f32 v237, v238, v239
    ds_write2st64_b64 v101, v[224:225], v[104:105] offset0:28 offset1:40
    ds_write2st64_b64 v92, v[228:229], v[108:109] offset0:28 offset1:40
    v_cvt_pk_bf16_f32 v240, v240, v241
    s_waitcnt lgkmcnt(3)
    buffer_store_dwordx4 v[84:87], v7, s[16:19], s84 offen offset:128 nt
    v_cvt_pk_bf16_f32 v233, v234, v235
    ds_write2st64_b64 v93, v[232:233], v[52:53] offset0:28 offset1:40
    v_pk_mul_f32 v[194:195], v[194:195], v[102:103] op_sel_hi:[1,0]
    ds_write2st64_b64 v94, v[236:237], v[56:57] offset0:28 offset1:40
    v_pk_mul_f32 v[146:147], v[146:147], v[48:49] op_sel_hi:[1,0]
    ds_read_b128 v[64:67], v103 offset:14336
    v_accvgpr_read_b32 v107, a35
    v_accvgpr_read_b32 v52, a40
    buffer_store_dwordx4 v[88:91], v6, s[16:19], s85 offen offset:128 nt
    v_cvt_pk_bf16_f32 v193, v194, v195
    v_accvgpr_read_b32 v105, a33
    v_accvgpr_read_b32 v104, a32
    ds_read_b128 v[68:71], v103 offset:15360
    v_cvt_pk_bf16_f32 v145, v146, v147
    v_accvgpr_read_b32 v54, a42
    v_accvgpr_read_b32 v55, a43
    v_accvgpr_read_b32 v106, a34
    ds_read_b128 v[72:75], v103 offset:20480
    v_accvgpr_read_b32 v111, a39
    v_cvt_pk_bf16_f32 v149, v150, v151
    v_accvgpr_read_b32 v56, a44
    s_waitcnt lgkmcnt(3)
    buffer_store_dwordx4 v[60:63], v7, s[16:19], s85 offen offset:128 nt
    v_cvt_pk_bf16_f32 v249, v250, v251
    v_accvgpr_read_b32 v53, a41
    v_cvt_pk_bf16_f32 v201, v202, v203
    v_accvgpr_read_b32 v57, a45
    v_pk_mul_f32 v[104:105], v[104:105], v[8:9] op_sel_hi:[1,0]
    v_pk_mul_f32 v[110:111], v[110:111], v[8:9] op_sel_hi:[1,0]
    ds_read_b128 v[76:79], v103 offset:21504
    v_accvgpr_read_b32 v109, a37
    ds_write2st64_b64 v101, v[144:145], v[192:193] offset0:8 offset1:20
    v_accvgpr_read_b32 v108, a36
    v_accvgpr_read_b32 v58, a46
    v_pk_mul_f32 v[52:53], v[52:53], v[8:9] op_sel_hi:[1,0]
    v_cvt_pk_bf16_f32 v205, v206, v207
    v_cvt_pk_bf16_f32 v241, v242, v243
    s_waitcnt lgkmcnt(2)
    buffer_store_dwordx4 v[64:67], v6, s[16:19], s86 offen offset:128 nt
    ds_write2st64_b64 v92, v[148:149], v[196:197] offset0:8 offset1:20
    v_pk_mul_f32 v[108:109], v[108:109], v[8:9] op_sel_hi:[1,0]
    v_cvt_pk_bf16_f32 v156, v156, v157
    v_cvt_pk_bf16_f32 v157, v158, v159
    v_cvt_pk_bf16_f32 v245, v246, v247
    buffer_store_dwordx4 v[68:71], v7, s[16:19], s86 offen offset:128 nt
    ds_write2st64_b64 v93, v[152:153], v[200:201] offset0:8 offset1:20
    ds_write2st64_b64 v94, v[156:157], v[204:205] offset0:8 offset1:20
    v_cvt_pk_bf16_f32 v108, v108, v109
    v_cvt_pk_bf16_f32 v109, v110, v111
    buffer_store_dwordx4 v[72:75], v6, s[16:19], s87 offen offset:128 nt
    v_cvt_pk_bf16_f32 v104, v104, v105
    v_cvt_pk_bf16_f32 v252, v252, v253
    ds_read_b128 v[80:83], v103 offset:4096
    v_accvgpr_read_b32 v59, a47
    ds_read_b128 v[84:87], v103 offset:5120
    s_waitcnt lgkmcnt(2)
    buffer_store_dwordx4 v[76:79], v7, s[16:19], s87 offen offset:128 nt
    v_pk_mul_f32 v[58:59], v[58:59], v[8:9] op_sel_hi:[1,0]
    v_cvt_pk_bf16_f32 v52, v52, v53
    v_pk_mul_f32 v[106:107], v[106:107], v[8:9] op_sel_hi:[1,0]
    s_waitcnt lgkmcnt(1)
    buffer_store_dwordx4 v[80:83], v6, s[16:19], s84 offen offset:256 nt
    v_pk_mul_f32 v[56:57], v[56:57], v[8:9] op_sel_hi:[1,0]
    v_pk_mul_f32 v[54:55], v[54:55], v[8:9] op_sel_hi:[1,0]
    ds_read_b128 v[88:91], v103 offset:10240
    v_cvt_pk_bf16_f32 v105, v106, v107
    s_waitcnt lgkmcnt(1)
    buffer_store_dwordx4 v[84:87], v7, s[16:19], s84 offen offset:256 nt
    ds_read_b128 v[60:63], v103 offset:11264
    v_cvt_pk_bf16_f32 v56, v56, v57
    ds_write2st64_b64 v101, v[240:241], v[104:105] offset0:32 offset1:44
    v_cvt_pk_bf16_f32 v53, v54, v55
    s_waitcnt lgkmcnt(2)
    buffer_store_dwordx4 v[88:91], v6, s[16:19], s85 offen offset:256 nt
    v_cvt_pk_bf16_f32 v253, v254, v255
    v_cvt_pk_bf16_f32 v57, v58, v59
    ds_write2st64_b64 v92, v[244:245], v[108:109] offset0:32 offset1:44
    ds_write2st64_b64 v93, v[248:249], v[52:53] offset0:32 offset1:44
    ds_write2st64_b64 v94, v[252:253], v[56:57] offset0:32 offset1:44
    ds_read_b128 v[64:67], v103 offset:16384
    ds_read_b128 v[68:71], v103 offset:17408
    ds_read_b128 v[72:75], v103 offset:22528
    s_waitcnt lgkmcnt(6)
    buffer_store_dwordx4 v[60:63], v7, s[16:19], s85 offen offset:256 nt
    ds_read_b128 v[76:79], v103 offset:23552
    s_waitcnt lgkmcnt(3)
    buffer_store_dwordx4 v[64:67], v6, s[16:19], s86 offen offset:256 nt
    s_waitcnt lgkmcnt(1)
    buffer_store_dwordx4 v[68:71], v7, s[16:19], s86 offen offset:256 nt
    buffer_store_dwordx4 v[72:75], v6, s[16:19], s87 offen offset:256 nt
    s_waitcnt lgkmcnt(0)
    buffer_store_dwordx4 v[76:79], v7, s[16:19], s87 offen offset:256 nt
    s_branch L_fin
L_fin:
    s_waitcnt vmcnt(0)
L_end:
    s_endpgm
L_codeend:
L_rare5_0:
    s_nop 15
    v_mbcnt_lo_u32_b32 v31, -1, 0
    v_mbcnt_hi_u32_b32 v31, -1, v31
    v_and_b32 v30, 15, v31
    v_mul_u32_u24 v30, 384, v30
    v_lshrrev_b32 v31, 4, v31
    v_lshl_add_u32 v30, v31, 4, v30
    s_add_u32 s69, s39, 0
    buffer_load_dwordx4 v[44:47], v30, s[4:7], s69 offen offset:0
    s_waitcnt vmcnt(0)
    v_mfma_f32_16x16x32_bf16 v[104:107], v[44:47], a[96:99], 0
    s_nop 7
    buffer_load_dwordx4 v[44:47], v30, s[4:7], s69 offen offset:64
    s_waitcnt vmcnt(0)
    v_mfma_f32_16x16x32_bf16 v[104:107], v[44:47], a[100:103], v[104:107]
    s_nop 7
    buffer_load_dwordx4 v[44:47], v30, s[4:7], s69 offen offset:128
    s_waitcnt vmcnt(0)
    v_mfma_f32_16x16x32_bf16 v[104:107], v[44:47], a[104:107], v[104:107]
    s_nop 7
    buffer_load_dwordx4 v[44:47], v30, s[4:7], s69 offen offset:192
    s_waitcnt vmcnt(0)
    v_mfma_f32_16x16x32_bf16 v[104:107], v[44:47], a[108:111], v[104:107]
    s_nop 7
    buffer_load_dwordx4 v[44:47], v30, s[4:7], s69 offen offset:256
    s_waitcnt vmcnt(0)
    v_mfma_f32_16x16x32_bf16 v[104:107], v[44:47], a[112:115], v[104:107]
    s_nop 7
    buffer_load_dwordx4 v[44:47], v30, s[4:7], s69 offen offset:320
    s_waitcnt vmcnt(0)
    v_mfma_f32_16x16x32_bf16 v[104:107], v[44:47], a[116:119], v[104:107]
    s_nop 7
    s_add_u32 s69, s39, 6144
    buffer_load_dwordx4 v[44:47], v30, s[4:7], s69 offen offset:0
    s_waitcnt vmcnt(0)
    v_mfma_f32_16x16x32_bf16 v[108:111], v[44:47], a[96:99], 0
    s_nop 7
    buffer_load_dwordx4 v[44:47], v30, s[4:7], s69 offen offset:64
    s_waitcnt vmcnt(0)
    v_mfma_f32_16x16x32_bf16 v[108:111], v[44:47], a[100:103], v[108:111]
    s_nop 7
    buffer_load_dwordx4 v[44:47], v30, s[4:7], s69 offen offset:128
    s_waitcnt vmcnt(0)
    v_mfma_f32_16x16x32_bf16 v[108:111], v[44:47], a[104:107], v[108:111]
    s_nop 7
    buffer_load_dwordx4 v[44:47], v30, s[4:7], s69 offen offset:192
    s_waitcnt vmcnt(0)
    v_mfma_f32_16x16x32_bf16 v[108:111], v[44:47], a[108:111], v[108:111]
    s_nop 7
    buffer_load_dwordx4 v[44:47], v30, s[4:7], s69 offen offset:256
    s_waitcnt vmcnt(0)
    v_mfma_f32_16x16x32_bf16 v[108:111], v[44:47], a[112:115], v[108:111]
    s_nop 7
    buffer_load_dwordx4 v[44:47], v30, s[4:7], s69 offen offset:320
    s_waitcnt vmcnt(0)
    v_mfma_f32_16x16x32_bf16 v[108:111], v[44:47], a[116:119], v[108:111]
    s_nop 7
    s_nop 15
    v_max3_f32 v18, v104, v105, v106
    v_max3_f32 v18, v18, v107, v108
    v_max3_f32 v18, v18, v109, v110
    v_max_f32 v18, v18, v111
    v_mov_b32 v19, v18
    s_nop 1
    v_permlane32_swap_b32 v19, v18
    v_max_f32 v18, v18, v19
    v_mov_b32 v19, v18
    s_nop 1
    v_permlane16_swap_b32 v19, v18
    v_max_f32 v18, v18, v19
    v_fma_f32 v18, v18, s28, v9
    v_max_f32 v24, 0, v18
    v_sub_f32 v9, v9, v24
    v_sub_f32 v25, 0, v24
    v_exp_f32 v25, v25
    s_nop 0
    v_mul_f32 v19, v48, v25
    v_cndmask_b32_e64 v48, v19, v48, s[60:61]
    v_cndmask_b32_e64 v48, v48, 0, s[46:47]
    v_mul_f32 v112, v112, v25
    v_mul_f32 v113, v113, v25
    v_mul_f32 v114, v114, v25
    v_mul_f32 v115, v115, v25
    v_mul_f32 v116, v116, v25
    v_mul_f32 v117, v117, v25
    v_mul_f32 v118, v118, v25
    v_mul_f32 v119, v119, v25
    v_mul_f32 v120, v120, v25
    v_mul_f32 v121, v121, v25
    v_mul_f32 v122, v122, v25
    v_mul_f32 v123, v123, v25
    v_mul_f32 v124, v124, v25
    v_mul_f32 v125, v125, v25
    v_mul_f32 v126, v126, v25
    v_mul_f32 v127, v127, v25
    v_mul_f32 v128, v128, v25
    v_mul_f32 v129, v129, v25
    v_mul_f32 v130, v130, v25
    v_mul_f32 v131, v131, v25
    v_mul_f32 v132, v132, v25
    v_mul_f32 v133, v133, v25
    v_mul_f32 v134, v134, v25
    v_mul_f32 v135, v135, v25
    v_mul_f32 v136, v136, v25
    v_mul_f32 v137, v137, v25
    v_mul_f32 v138, v138, v25
    v_mul_f32 v139, v139, v25
    v_mul_f32 v140, v140, v25
    v_mul_f32 v141, v141, v25
    v_mul_f32 v142, v142, v25
    v_mul_f32 v143, v143, v25
    v_mul_f32 v144, v144, v25
    v_mul_f32 v145, v145, v25
    v_mul_f32 v146, v146, v25
    v_mul_f32 v147, v147, v25
    v_mul_f32 v148, v148, v25
    v_mul_f32 v149, v149, v25
    v_mul_f32 v150, v150, v25
    v_mul_f32 v151, v151, v25
    v_mul_f32 v152, v152, v25
    v_mul_f32 v153, v153, v25
    v_mul_f32 v154, v154, v25
    v_mul_f32 v155, v155, v25
    v_mul_f32 v156, v156, v25
    v_mul_f32 v157, v157, v25
    v_mul_f32 v158, v158, v25
    v_mul_f32 v159, v159, v25
    v_fma_f32 v104, v104, s28, v9
    v_fma_f32 v105, v105, s28, v9
    v_exp_f32 v104, v104
    v_exp_f32 v105, v105
    s_nop 0
    v_cvt_pk_bf16_f32 v14, v104, v105
    v_fma_f32 v106, v106, s28, v9
    v_fma_f32 v107, v107, s28, v9
    v_exp_f32 v106, v106
    v_exp_f32 v107, v107
    s_nop 0
    v_cvt_pk_bf16_f32 v15, v106, v107
    v_fma_f32 v108, v108, s28, v9
    v_fma_f32 v109, v109, s28, v9
    v_exp_f32 v108, v108
    v_exp_f32 v109, v109
    s_nop 0
    v_cvt_pk_bf16_f32 v16, v108, v109
    v_fma_f32 v110, v110, s28, v9
    v_fma_f32 v111, v111, s28, v9
    v_exp_f32 v110, v110
    v_exp_f32 v111, v111
    s_nop 0
    v_cvt_pk_bf16_f32 v17, v110, v111
    s_add_u32 s69, s39, 0
    buffer_load_dwordx4 v[44:47], v30, s[4:7], s69 offen offset:0
    s_waitcnt vmcnt(0)
    v_mfma_f32_16x16x32_bf16 v[104:107], v[44:47], a[120:123], 0
    s_nop 7
    buffer_load_dwordx4 v[44:47], v30, s[4:7], s69 offen offset:64
    s_waitcnt vmcnt(0)
    v_mfma_f32_16x16x32_bf16 v[104:107], v[44:47], a[124:127], v[104:107]
    s_nop 7
    buffer_load_dwordx4 v[44:47], v30, s[4:7], s69 offen offset:128
    s_waitcnt vmcnt(0)
    v_mfma_f32_16x16x32_bf16 v[104:107], v[44:47], a[128:131], v[104:107]
    s_nop 7
    buffer_load_dwordx4 v[44:47], v30, s[4:7], s69 offen offset:192
    s_waitcnt vmcnt(0)
    v_mfma_f32_16x16x32_bf16 v[104:107], v[44:47], a[132:135], v[104:107]
    s_nop 7
    buffer_load_dwordx4 v[44:47], v30, s[4:7], s69 offen offset:256
    s_waitcnt vmcnt(0)
    v_mfma_f32_16x16x32_bf16 v[104:107], v[44:47], a[136:139], v[104:107]
    s_nop 7
    buffer_load_dwordx4 v[44:47], v30, s[4:7], s69 offen offset:320
    s_waitcnt vmcnt(0)
    v_mfma_f32_16x16x32_bf16 v[104:107], v[44:47], a[140:143], v[104:107]
    s_nop 7
    s_add_u32 s69, s39, 6144
    buffer_load_dwordx4 v[44:47], v30, s[4:7], s69 offen offset:0
    s_waitcnt vmcnt(0)
    v_mfma_f32_16x16x32_bf16 v[108:111], v[44:47], a[120:123], 0
    s_nop 7
    buffer_load_dwordx4 v[44:47], v30, s[4:7], s69 offen offset:64
    s_waitcnt vmcnt(0)
    v_mfma_f32_16x16x32_bf16 v[108:111], v[44:47], a[124:127], v[108:111]
    s_nop 7
    buffer_load_dwordx4 v[44:47], v30, s[4:7], s69 offen offset:128
    s_waitcnt vmcnt(0)
    v_mfma_f32_16x16x32_bf16 v[108:111], v[44:47], a[128:131], v[108:111]
    s_nop 7
    buffer_load_dwordx4 v[44:47], v30, s[4:7], s69 offen offset:192
    s_waitcnt vmcnt(0)
    v_mfma_f32_16x16x32_bf16 v[108:111], v[44:47], a[132:135], v[108:111]
    s_nop 7
    buffer_load_dwordx4 v[44:47], v30, s[4:7], s69 offen offset:256
    s_waitcnt vmcnt(0)
    v_mfma_f32_16x16x32_bf16 v[108:111], v[44:47], a[136:139], v[108:111]
    s_nop 7
    buffer_load_dwordx4 v[44:47], v30, s[4:7], s69 offen offset:320
    s_waitcnt vmcnt(0)
    v_mfma_f32_16x16x32_bf16 v[108:111], v[44:47], a[140:143], v[108:111]
    s_nop 7
    s_nop 15
    v_max3_f32 v18, v104, v105, v106
    v_max3_f32 v18, v18, v107, v108
    v_max3_f32 v18, v18, v109, v110
    v_max_f32 v18, v18, v111
    v_mov_b32 v19, v18
    s_nop 1
    v_permlane32_swap_b32 v19, v18
    v_max_f32 v18, v18, v19
    v_mov_b32 v19, v18
    s_nop 1
    v_permlane16_swap_b32 v19, v18
    v_max_f32 v18, v18, v19
    v_fma_f32 v18, v18, s28, v10
    v_max_f32 v24, 0, v18
    v_sub_f32 v10, v10, v24
    v_sub_f32 v25, 0, v24
    v_exp_f32 v25, v25
    s_nop 0
    v_mul_f32 v49, v49, v25
    v_mul_f32 v160, v160, v25
    v_mul_f32 v161, v161, v25
    v_mul_f32 v162, v162, v25
    v_mul_f32 v163, v163, v25
    v_mul_f32 v164, v164, v25
    v_mul_f32 v165, v165, v25
    v_mul_f32 v166, v166, v25
    v_mul_f32 v167, v167, v25
    v_mul_f32 v168, v168, v25
    v_mul_f32 v169, v169, v25
    v_mul_f32 v170, v170, v25
    v_mul_f32 v171, v171, v25
    v_mul_f32 v172, v172, v25
    v_mul_f32 v173, v173, v25
    v_mul_f32 v174, v174, v25
    v_mul_f32 v175, v175, v25
    v_mul_f32 v176, v176, v25
    v_mul_f32 v177, v177, v25
    v_mul_f32 v178, v178, v25
    v_mul_f32 v179, v179, v25
    v_mul_f32 v180, v180, v25
    v_mul_f32 v181, v181, v25
    v_mul_f32 v182, v182, v25
    v_mul_f32 v183, v183, v25
    v_mul_f32 v184, v184, v25
    v_mul_f32 v185, v185, v25
    v_mul_f32 v186, v186, v25
    v_mul_f32 v187, v187, v25
    v_mul_f32 v188, v188, v25
    v_mul_f32 v189, v189, v25
    v_mul_f32 v190, v190, v25
    v_mul_f32 v191, v191, v25
    v_mul_f32 v192, v192, v25
    v_mul_f32 v193, v193, v25
    v_mul_f32 v194, v194, v25
    v_mul_f32 v195, v195, v25
    v_mul_f32 v196, v196, v25
    v_mul_f32 v197, v197, v25
    v_mul_f32 v198, v198, v25
    v_mul_f32 v199, v199, v25
    v_mul_f32 v200, v200, v25
    v_mul_f32 v201, v201, v25
    v_mul_f32 v202, v202, v25
    v_mul_f32 v203, v203, v25
    v_mul_f32 v204, v204, v25
    v_mul_f32 v205, v205, v25
    v_mul_f32 v206, v206, v25
    v_mul_f32 v207, v207, v25
    v_fma_f32 v104, v104, s28, v10
    v_fma_f32 v105, v105, s28, v10
    v_exp_f32 v104, v104
    v_exp_f32 v105, v105
    s_nop 0
    v_cvt_pk_bf16_f32 v20, v104, v105
    v_fma_f32 v106, v106, s28, v10
    v_fma_f32 v107, v107, s28, v10
    v_exp_f32 v106, v106
    v_exp_f32 v107, v107
    s_nop 0
    v_cvt_pk_bf16_f32 v21, v106, v107
    v_fma_f32 v108, v108, s28, v10
    v_fma_f32 v109, v109, s28, v10
    v_exp_f32 v108, v108
    v_exp_f32 v109, v109
    s_nop 0
    v_cvt_pk_bf16_f32 v22, v108, v109
    v_fma_f32 v110, v110, s28, v10
    v_fma_f32 v111, v111, s28, v10
    v_exp_f32 v110, v110
    v_exp_f32 v111, v111
    s_nop 0
    v_cvt_pk_bf16_f32 v23, v110, v111
    s_add_u32 s69, s39, 0
    buffer_load_dwordx4 v[44:47], v30, s[4:7], s69 offen offset:0
    s_waitcnt vmcnt(0)
    v_mfma_f32_16x16x32_bf16 v[104:107], v[44:47], a[144:147], 0
    s_nop 7
    buffer_load_dwordx4 v[44:47], v30, s[4:7], s69 offen offset:64
    s_waitcnt vmcnt(0)
    v_mfma_f32_16x16x32_bf16 v[104:107], v[44:47], a[148:151], v[104:107]
    s_nop 7
    buffer_load_dwordx4 v[44:47], v30, s[4:7], s69 offen offset:128
    s_waitcnt vmcnt(0)
    v_mfma_f32_16x16x32_bf16 v[104:107], v[44:47], a[152:155], v[104:107]
    s_nop 7
    buffer_load_dwordx4 v[44:47], v30, s[4:7], s69 offen offset:192
    s_waitcnt vmcnt(0)
    v_mfma_f32_16x16x32_bf16 v[104:107], v[44:47], a[156:159], v[104:107]
    s_nop 7
    buffer_load_dwordx4 v[44:47], v30, s[4:7], s69 offen offset:256
    s_waitcnt vmcnt(0)
    v_mfma_f32_16x16x32_bf16 v[104:107], v[44:47], a[160:163], v[104:107]
    s_nop 7
    buffer_load_dwordx4 v[44:47], v30, s[4:7], s69 offen offset:320
    s_waitcnt vmcnt(0)
    v_mfma_f32_16x16x32_bf16 v[104:107], v[44:47], a[164:167], v[104:107]
    s_nop 7
    s_add_u32 s69, s39, 6144
    buffer_load_dwordx4 v[44:47], v30, s[4:7], s69 offen offset:0
    s_waitcnt vmcnt(0)
    v_mfma_f32_16x16x32_bf16 v[108:111], v[44:47], a[144:147], 0
    s_nop 7
    buffer_load_dwordx4 v[44:47], v30, s[4:7], s69 offen offset:64
    s_waitcnt vmcnt(0)
    v_mfma_f32_16x16x32_bf16 v[108:111], v[44:47], a[148:151], v[108:111]
    s_nop 7
    buffer_load_dwordx4 v[44:47], v30, s[4:7], s69 offen offset:128
    s_waitcnt vmcnt(0)
    v_mfma_f32_16x16x32_bf16 v[108:111], v[44:47], a[152:155], v[108:111]
    s_nop 7
    buffer_load_dwordx4 v[44:47], v30, s[4:7], s69 offen offset:192
    s_waitcnt vmcnt(0)
    v_mfma_f32_16x16x32_bf16 v[108:111], v[44:47], a[156:159], v[108:111]
    s_nop 7
    buffer_load_dwordx4 v[44:47], v30, s[4:7], s69 offen offset:256
    s_waitcnt vmcnt(0)
    v_mfma_f32_16x16x32_bf16 v[108:111], v[44:47], a[160:163], v[108:111]
    s_nop 7
    buffer_load_dwordx4 v[44:47], v30, s[4:7], s69 offen offset:320
    s_waitcnt vmcnt(0)
    v_mfma_f32_16x16x32_bf16 v[108:111], v[44:47], a[164:167], v[108:111]
    s_nop 7
    s_nop 15
    v_max3_f32 v18, v104, v105, v106
    v_max3_f32 v18, v18, v107, v108
    v_max3_f32 v18, v18, v109, v110
    v_max_f32 v18, v18, v111
    v_mov_b32 v19, v18
    s_nop 1
    v_permlane32_swap_b32 v19, v18
    v_max_f32 v18, v18, v19
    v_mov_b32 v19, v18
    s_nop 1
    v_permlane16_swap_b32 v19, v18
    v_max_f32 v18, v18, v19
    v_fma_f32 v18, v18, s28, v11
    v_max_f32 v24, 0, v18
    v_sub_f32 v11, v11, v24
    v_sub_f32 v25, 0, v24
    v_exp_f32 v25, v25
    s_nop 0
    v_mul_f32 v50, v50, v25
    v_mul_f32 v208, v208, v25
    v_mul_f32 v209, v209, v25
    v_mul_f32 v210, v210, v25
    v_mul_f32 v211, v211, v25
    v_mul_f32 v212, v212, v25
    v_mul_f32 v213, v213, v25
    v_mul_f32 v214, v214, v25
    v_mul_f32 v215, v215, v25
    v_mul_f32 v216, v216, v25
    v_mul_f32 v217, v217, v25
    v_mul_f32 v218, v218, v25
    v_mul_f32 v219, v219, v25
    v_mul_f32 v220, v220, v25
    v_mul_f32 v221, v221, v25
    v_mul_f32 v222, v222, v25
    v_mul_f32 v223, v223, v25
    v_mul_f32 v224, v224, v25
    v_mul_f32 v225, v225, v25
    v_mul_f32 v226, v226, v25
    v_mul_f32 v227, v227, v25
    v_mul_f32 v228, v228, v25
    v_mul_f32 v229, v229, v25
    v_mul_f32 v230, v230, v25
    v_mul_f32 v231, v231, v25
    v_mul_f32 v232, v232, v25
    v_mul_f32 v233, v233, v25
    v_mul_f32 v234, v234, v25
    v_mul_f32 v235, v235, v25
    v_mul_f32 v236, v236, v25
    v_mul_f32 v237, v237, v25
    v_mul_f32 v238, v238, v25
    v_mul_f32 v239, v239, v25
    v_mul_f32 v240, v240, v25
    v_mul_f32 v241, v241, v25
    v_mul_f32 v242, v242, v25
    v_mul_f32 v243, v243, v25
    v_mul_f32 v244, v244, v25
    v_mul_f32 v245, v245, v25
    v_mul_f32 v246, v246, v25
    v_mul_f32 v247, v247, v25
    v_mul_f32 v248, v248, v25
    v_mul_f32 v249, v249, v25
    v_mul_f32 v250, v250, v25
    v_mul_f32 v251, v251, v25
    v_mul_f32 v252, v252, v25
    v_mul_f32 v253, v253, v25
    v_mul_f32 v254, v254, v25
    v_mul_f32 v255, v255, v25
    v_fma_f32 v104, v104, s28, v11
    v_fma_f32 v105, v105, s28, v11
    v_exp_f32 v104, v104
    v_exp_f32 v105, v105
    s_nop 0
    v_cvt_pk_bf16_f32 v26, v104, v105
    v_fma_f32 v106, v106, s28, v11
    v_fma_f32 v107, v107, s28, v11
    v_exp_f32 v106, v106
    v_exp_f32 v107, v107
    s_nop 0
    v_cvt_pk_bf16_f32 v27, v106, v107
    v_fma_f32 v108, v108, s28, v11
    v_fma_f32 v109, v109, s28, v11
    v_exp_f32 v108, v108
    v_exp_f32 v109, v109
    s_nop 0
    v_cvt_pk_bf16_f32 v28, v108, v109
    v_fma_f32 v110, v110, s28, v11
    v_fma_f32 v111, v111, s28, v11
    v_exp_f32 v110, v110
    v_exp_f32 v111, v111
    s_nop 0
    v_cvt_pk_bf16_f32 v29, v110, v111
    s_add_u32 s69, s39, 0
    buffer_load_dwordx4 v[44:47], v30, s[4:7], s69 offen offset:0
    s_waitcnt vmcnt(0)
    v_mfma_f32_16x16x32_bf16 v[104:107], v[44:47], a[168:171], 0
    s_nop 7
    buffer_load_dwordx4 v[44:47], v30, s[4:7], s69 offen offset:64
    s_waitcnt vmcnt(0)
    v_mfma_f32_16x16x32_bf16 v[104:107], v[44:47], a[172:175], v[104:107]
    s_nop 7
    buffer_load_dwordx4 v[44:47], v30, s[4:7], s69 offen offset:128
    s_waitcnt vmcnt(0)
    v_mfma_f32_16x16x32_bf16 v[104:107], v[44:47], a[176:179], v[104:107]
    s_nop 7
    buffer_load_dwordx4 v[44:47], v30, s[4:7], s69 offen offset:192
    s_waitcnt vmcnt(0)
    v_mfma_f32_16x16x32_bf16 v[104:107], v[44:47], a[180:183], v[104:107]
    s_nop 7
    buffer_load_dwordx4 v[44:47], v30, s[4:7], s69 offen offset:256
    s_waitcnt vmcnt(0)
    v_mfma_f32_16x16x32_bf16 v[104:107], v[44:47], a[184:187], v[104:107]
    s_nop 7
    buffer_load_dwordx4 v[44:47], v30, s[4:7], s69 offen offset:320
    s_waitcnt vmcnt(0)
    v_mfma_f32_16x16x32_bf16 v[104:107], v[44:47], a[188:191], v[104:107]
    s_nop 7
    s_add_u32 s69, s39, 6144
    buffer_load_dwordx4 v[44:47], v30, s[4:7], s69 offen offset:0
    s_waitcnt vmcnt(0)
    v_mfma_f32_16x16x32_bf16 v[108:111], v[44:47], a[168:171], 0
    s_nop 7
    buffer_load_dwordx4 v[44:47], v30, s[4:7], s69 offen offset:64
    s_waitcnt vmcnt(0)
    v_mfma_f32_16x16x32_bf16 v[108:111], v[44:47], a[172:175], v[108:111]
    s_nop 7
    buffer_load_dwordx4 v[44:47], v30, s[4:7], s69 offen offset:128
    s_waitcnt vmcnt(0)
    v_mfma_f32_16x16x32_bf16 v[108:111], v[44:47], a[176:179], v[108:111]
    s_nop 7
    buffer_load_dwordx4 v[44:47], v30, s[4:7], s69 offen offset:192
    s_waitcnt vmcnt(0)
    v_mfma_f32_16x16x32_bf16 v[108:111], v[44:47], a[180:183], v[108:111]
    s_nop 7
    buffer_load_dwordx4 v[44:47], v30, s[4:7], s69 offen offset:256
    s_waitcnt vmcnt(0)
    v_mfma_f32_16x16x32_bf16 v[108:111], v[44:47], a[184:187], v[108:111]
    s_nop 7
    buffer_load_dwordx4 v[44:47], v30, s[4:7], s69 offen offset:320
    s_waitcnt vmcnt(0)
    v_mfma_f32_16x16x32_bf16 v[108:111], v[44:47], a[188:191], v[108:111]
    s_nop 7
    s_nop 15
    v_max3_f32 v18, v104, v105, v106
    v_max3_f32 v18, v18, v107, v108
    v_max3_f32 v18, v18, v109, v110
    v_max_f32 v18, v18, v111
    v_mov_b32 v19, v18
    s_nop 1
    v_permlane32_swap_b32 v19, v18
    v_max_f32 v18, v18, v19
    v_mov_b32 v19, v18
    s_nop 1
    v_permlane16_swap_b32 v19, v18
    v_max_f32 v18, v18, v19
    v_fma_f32 v18, v18, s28, v12
    v_max_f32 v24, 0, v18
    v_sub_f32 v12, v12, v24
    v_sub_f32 v25, 0, v24
    v_exp_f32 v25, v25
    s_nop 0
    v_mul_f32 v51, v51, v25
    v_accvgpr_read_b32 v19, a0
    v_mul_f32 v19, v19, v25
    v_accvgpr_write_b32 a0, v19
    v_accvgpr_read_b32 v19, a1
    v_mul_f32 v19, v19, v25
    v_accvgpr_write_b32 a1, v19
    v_accvgpr_read_b32 v19, a2
    v_mul_f32 v19, v19, v25
    v_accvgpr_write_b32 a2, v19
    v_accvgpr_read_b32 v19, a3
    v_mul_f32 v19, v19, v25
    v_accvgpr_write_b32 a3, v19
    v_accvgpr_read_b32 v19, a4
    v_mul_f32 v19, v19, v25
    v_accvgpr_write_b32 a4, v19
    v_accvgpr_read_b32 v19, a5
    v_mul_f32 v19, v19, v25
    v_accvgpr_write_b32 a5, v19
    v_accvgpr_read_b32 v19, a6
    v_mul_f32 v19, v19, v25
    v_accvgpr_write_b32 a6, v19
    v_accvgpr_read_b32 v19, a7
    v_mul_f32 v19, v19, v25
    v_accvgpr_write_b32 a7, v19
    v_accvgpr_read_b32 v19, a8
    v_mul_f32 v19, v19, v25
    v_accvgpr_write_b32 a8, v19
    v_accvgpr_read_b32 v19, a9
    v_mul_f32 v19, v19, v25
    v_accvgpr_write_b32 a9, v19
    v_accvgpr_read_b32 v19, a10
    v_mul_f32 v19, v19, v25
    v_accvgpr_write_b32 a10, v19
    v_accvgpr_read_b32 v19, a11
    v_mul_f32 v19, v19, v25
    v_accvgpr_write_b32 a11, v19
    v_accvgpr_read_b32 v19, a12
    v_mul_f32 v19, v19, v25
    v_accvgpr_write_b32 a12, v19
    v_accvgpr_read_b32 v19, a13
    v_mul_f32 v19, v19, v25
    v_accvgpr_write_b32 a13, v19
    v_accvgpr_read_b32 v19, a14
    v_mul_f32 v19, v19, v25
    v_accvgpr_write_b32 a14, v19
    v_accvgpr_read_b32 v19, a15
    v_mul_f32 v19, v19, v25
    v_accvgpr_write_b32 a15, v19
    v_accvgpr_read_b32 v19, a16
    v_mul_f32 v19, v19, v25
    v_accvgpr_write_b32 a16, v19
    v_accvgpr_read_b32 v19, a17
    v_mul_f32 v19, v19, v25
    v_accvgpr_write_b32 a17, v19
    v_accvgpr_read_b32 v19, a18
    v_mul_f32 v19, v19, v25
    v_accvgpr_write_b32 a18, v19
    v_accvgpr_read_b32 v19, a19
    v_mul_f32 v19, v19, v25
    v_accvgpr_write_b32 a19, v19
    v_accvgpr_read_b32 v19, a20
    v_mul_f32 v19, v19, v25
    v_accvgpr_write_b32 a20, v19
    v_accvgpr_read_b32 v19, a21
    v_mul_f32 v19, v19, v25
    v_accvgpr_write_b32 a21, v19
    v_accvgpr_read_b32 v19, a22
    v_mul_f32 v19, v19, v25
    v_accvgpr_write_b32 a22, v19
    v_accvgpr_read_b32 v19, a23
    v_mul_f32 v19, v19, v25
    v_accvgpr_write_b32 a23, v19
    v_accvgpr_read_b32 v19, a24
    v_mul_f32 v19, v19, v25
    v_accvgpr_write_b32 a24, v19
    v_accvgpr_read_b32 v19, a25
    v_mul_f32 v19, v19, v25
    v_accvgpr_write_b32 a25, v19
    v_accvgpr_read_b32 v19, a26
    v_mul_f32 v19, v19, v25
    v_accvgpr_write_b32 a26, v19
    v_accvgpr_read_b32 v19, a27
    v_mul_f32 v19, v19, v25
    v_accvgpr_write_b32 a27, v19
    v_accvgpr_read_b32 v19, a28
    v_mul_f32 v19, v19, v25
    v_accvgpr_write_b32 a28, v19
    v_accvgpr_read_b32 v19, a29
    v_mul_f32 v19, v19, v25
    v_accvgpr_write_b32 a29, v19
    v_accvgpr_read_b32 v19, a30
    v_mul_f32 v19, v19, v25
    v_accvgpr_write_b32 a30, v19
    v_accvgpr_read_b32 v19, a31
    v_mul_f32 v19, v19, v25
    v_accvgpr_write_b32 a31, v19
    v_accvgpr_read_b32 v19, a32
    v_mul_f32 v19, v19, v25
    v_accvgpr_write_b32 a32, v19
    v_accvgpr_read_b32 v19, a33
    v_mul_f32 v19, v19, v25
    v_accvgpr_write_b32 a33, v19
    v_accvgpr_read_b32 v19, a34
    v_mul_f32 v19, v19, v25
    v_accvgpr_write_b32 a34, v19
    v_accvgpr_read_b32 v19, a35
    v_mul_f32 v19, v19, v25
    v_accvgpr_write_b32 a35, v19
    v_accvgpr_read_b32 v19, a36
    v_mul_f32 v19, v19, v25
    v_accvgpr_write_b32 a36, v19
    v_accvgpr_read_b32 v19, a37
    v_mul_f32 v19, v19, v25
    v_accvgpr_write_b32 a37, v19
    v_accvgpr_read_b32 v19, a38
    v_mul_f32 v19, v19, v25
    v_accvgpr_write_b32 a38, v19
    v_accvgpr_read_b32 v19, a39
    v_mul_f32 v19, v19, v25
    v_accvgpr_write_b32 a39, v19
    v_accvgpr_read_b32 v19, a40
    v_mul_f32 v19, v19, v25
    v_accvgpr_write_b32 a40, v19
    v_accvgpr_read_b32 v19, a41
    v_mul_f32 v19, v19, v25
    v_accvgpr_write_b32 a41, v19
    v_accvgpr_read_b32 v19, a42
    v_mul_f32 v19, v19, v25
    v_accvgpr_write_b32 a42, v19
    v_accvgpr_read_b32 v19, a43
    v_mul_f32 v19, v19, v25
    v_accvgpr_write_b32 a43, v19
    v_accvgpr_read_b32 v19, a44
    v_mul_f32 v19, v19, v25
    v_accvgpr_write_b32 a44, v19
    v_accvgpr_read_b32 v19, a45
    v_mul_f32 v19, v19, v25
    v_accvgpr_write_b32 a45, v19
    v_accvgpr_read_b32 v19, a46
    v_mul_f32 v19, v19, v25
    v_accvgpr_write_b32 a46, v19
    v_accvgpr_read_b32 v19, a47
    v_mul_f32 v19, v19, v25
    v_accvgpr_write_b32 a47, v19
    v_fma_f32 v104, v104, s28, v12
    v_fma_f32 v105, v105, s28, v12
    v_exp_f32 v104, v104
    v_exp_f32 v105, v105
    s_nop 0
    v_cvt_pk_bf16_f32 v32, v104, v105
    v_fma_f32 v106, v106, s28, v12
    v_fma_f32 v107, v107, s28, v12
    v_exp_f32 v106, v106
    v_exp_f32 v107, v107
    s_nop 0
    v_cvt_pk_bf16_f32 v33, v106, v107
    v_fma_f32 v108, v108, s28, v12
    v_fma_f32 v109, v109, s28, v12
    v_exp_f32 v108, v108
    v_exp_f32 v109, v109
    s_nop 0
    v_cvt_pk_bf16_f32 v34, v108, v109
    v_fma_f32 v110, v110, s28, v12
    v_fma_f32 v111, v111, s28, v12
    v_exp_f32 v110, v110
    v_exp_f32 v111, v111
    s_nop 0
    v_cvt_pk_bf16_f32 v35, v110, v111
    s_add_u32 s69, s39, 0
    buffer_load_dwordx4 v[44:47], v30, s[4:7], s69 offen offset:0
    s_waitcnt vmcnt(0)
    v_mfma_f32_16x16x32_bf16 v[104:107], v[44:47], a[192:195], 0
    s_nop 7
    buffer_load_dwordx4 v[44:47], v30, s[4:7], s69 offen offset:64
    s_waitcnt vmcnt(0)
    v_mfma_f32_16x16x32_bf16 v[104:107], v[44:47], a[196:199], v[104:107]
    s_nop 7
    buffer_load_dwordx4 v[44:47], v30, s[4:7], s69 offen offset:128
    s_waitcnt vmcnt(0)
    v_mfma_f32_16x16x32_bf16 v[104:107], v[44:47], a[200:203], v[104:107]
    s_nop 7
    buffer_load_dwordx4 v[44:47], v30, s[4:7], s69 offen offset:192
    s_waitcnt vmcnt(0)
    v_mfma_f32_16x16x32_bf16 v[104:107], v[44:47], a[204:207], v[104:107]
    s_nop 7
    buffer_load_dwordx4 v[44:47], v30, s[4:7], s69 offen offset:256
    s_waitcnt vmcnt(0)
    v_mfma_f32_16x16x32_bf16 v[104:107], v[44:47], a[208:211], v[104:107]
    s_nop 7
    buffer_load_dwordx4 v[44:47], v30, s[4:7], s69 offen offset:320
    s_waitcnt vmcnt(0)
    v_mfma_f32_16x16x32_bf16 v[104:107], v[44:47], v[92:95], v[104:107]
    s_nop 7
    s_add_u32 s69, s39, 6144
    buffer_load_dwordx4 v[44:47], v30, s[4:7], s69 offen offset:0
    s_waitcnt vmcnt(0)
    v_mfma_f32_16x16x32_bf16 v[108:111], v[44:47], a[192:195], 0
    s_nop 7
    buffer_load_dwordx4 v[44:47], v30, s[4:7], s69 offen offset:64
    s_waitcnt vmcnt(0)
    v_mfma_f32_16x16x32_bf16 v[108:111], v[44:47], a[196:199], v[108:111]
    s_nop 7
    buffer_load_dwordx4 v[44:47], v30, s[4:7], s69 offen offset:128
    s_waitcnt vmcnt(0)
    v_mfma_f32_16x16x32_bf16 v[108:111], v[44:47], a[200:203], v[108:111]
    s_nop 7
    buffer_load_dwordx4 v[44:47], v30, s[4:7], s69 offen offset:192
    s_waitcnt vmcnt(0)
    v_mfma_f32_16x16x32_bf16 v[108:111], v[44:47], a[204:207], v[108:111]
    s_nop 7
    buffer_load_dwordx4 v[44:47], v30, s[4:7], s69 offen offset:256
    s_waitcnt vmcnt(0)
    v_mfma_f32_16x16x32_bf16 v[108:111], v[44:47], a[208:211], v[108:111]
    s_nop 7
    buffer_load_dwordx4 v[44:47], v30, s[4:7], s69 offen offset:320
    s_waitcnt vmcnt(0)
    v_mfma_f32_16x16x32_bf16 v[108:111], v[44:47], v[92:95], v[108:111]
    s_nop 7
    s_nop 15
    v_max3_f32 v18, v104, v105, v106
    v_max3_f32 v18, v18, v107, v108
    v_max3_f32 v18, v18, v109, v110
    v_max_f32 v18, v18, v111
    v_mov_b32 v19, v18
    s_nop 1
    v_permlane32_swap_b32 v19, v18
    v_max_f32 v18, v18, v19
    v_mov_b32 v19, v18
    s_nop 1
    v_permlane16_swap_b32 v19, v18
    v_max_f32 v18, v18, v19
    v_fma_f32 v18, v18, s28, v13
    v_max_f32 v24, 0, v18
    v_sub_f32 v13, v13, v24
    v_sub_f32 v25, 0, v24
    v_exp_f32 v25, v25
    s_nop 0
    v_mul_f32 v19, v48, v25
    v_cndmask_b32_e64 v48, v48, v19, s[60:61]
    v_accvgpr_read_b32 v19, a48
    v_mul_f32 v19, v19, v25
    v_accvgpr_write_b32 a48, v19
    v_accvgpr_read_b32 v19, a49
    v_mul_f32 v19, v19, v25
    v_accvgpr_write_b32 a49, v19
    v_accvgpr_read_b32 v19, a50
    v_mul_f32 v19, v19, v25
    v_accvgpr_write_b32 a50, v19
    v_accvgpr_read_b32 v19, a51
    v_mul_f32 v19, v19, v25
    v_accvgpr_write_b32 a51, v19
    v_accvgpr_read_b32 v19, a52
    v_mul_f32 v19, v19, v25
    v_accvgpr_write_b32 a52, v19
    v_accvgpr_read_b32 v19, a53
    v_mul_f32 v19, v19, v25
    v_accvgpr_write_b32 a53, v19
    v_accvgpr_read_b32 v19, a54
    v_mul_f32 v19, v19, v25
    v_accvgpr_write_b32 a54, v19
    v_accvgpr_read_b32 v19, a55
    v_mul_f32 v19, v19, v25
    v_accvgpr_write_b32 a55, v19
    v_accvgpr_read_b32 v19, a56
    v_mul_f32 v19, v19, v25
    v_accvgpr_write_b32 a56, v19
    v_accvgpr_read_b32 v19, a57
    v_mul_f32 v19, v19, v25
    v_accvgpr_write_b32 a57, v19
    v_accvgpr_read_b32 v19, a58
    v_mul_f32 v19, v19, v25
    v_accvgpr_write_b32 a58, v19
    v_accvgpr_read_b32 v19, a59
    v_mul_f32 v19, v19, v25
    v_accvgpr_write_b32 a59, v19
    v_accvgpr_read_b32 v19, a60
    v_mul_f32 v19, v19, v25
    v_accvgpr_write_b32 a60, v19
    v_accvgpr_read_b32 v19, a61
    v_mul_f32 v19, v19, v25
    v_accvgpr_write_b32 a61, v19
    v_accvgpr_read_b32 v19, a62
    v_mul_f32 v19, v19, v25
    v_accvgpr_write_b32 a62, v19
    v_accvgpr_read_b32 v19, a63
    v_mul_f32 v19, v19, v25
    v_accvgpr_write_b32 a63, v19
    v_accvgpr_read_b32 v19, a64
    v_mul_f32 v19, v19, v25
    v_accvgpr_write_b32 a64, v19
    v_accvgpr_read_b32 v19, a65
    v_mul_f32 v19, v19, v25
    v_accvgpr_write_b32 a65, v19
    v_accvgpr_read_b32 v19, a66
    v_mul_f32 v19, v19, v25
    v_accvgpr_write_b32 a66, v19
    v_accvgpr_read_b32 v19, a67
    v_mul_f32 v19, v19, v25
    v_accvgpr_write_b32 a67, v19
    v_accvgpr_read_b32 v19, a68
    v_mul_f32 v19, v19, v25
    v_accvgpr_write_b32 a68, v19
    v_accvgpr_read_b32 v19, a69
    v_mul_f32 v19, v19, v25
    v_accvgpr_write_b32 a69, v19
    v_accvgpr_read_b32 v19, a70
    v_mul_f32 v19, v19, v25
    v_accvgpr_write_b32 a70, v19
    v_accvgpr_read_b32 v19, a71
    v_mul_f32 v19, v19, v25
    v_accvgpr_write_b32 a71, v19
    v_accvgpr_read_b32 v19, a72
    v_mul_f32 v19, v19, v25
    v_accvgpr_write_b32 a72, v19
    v_accvgpr_read_b32 v19, a73
    v_mul_f32 v19, v19, v25
    v_accvgpr_write_b32 a73, v19
    v_accvgpr_read_b32 v19, a74
    v_mul_f32 v19, v19, v25
    v_accvgpr_write_b32 a74, v19
    v_accvgpr_read_b32 v19, a75
    v_mul_f32 v19, v19, v25
    v_accvgpr_write_b32 a75, v19
    v_accvgpr_read_b32 v19, a76
    v_mul_f32 v19, v19, v25
    v_accvgpr_write_b32 a76, v19
    v_accvgpr_read_b32 v19, a77
    v_mul_f32 v19, v19, v25
    v_accvgpr_write_b32 a77, v19
    v_accvgpr_read_b32 v19, a78
    v_mul_f32 v19, v19, v25
    v_accvgpr_write_b32 a78, v19
    v_accvgpr_read_b32 v19, a79
    v_mul_f32 v19, v19, v25
    v_accvgpr_write_b32 a79, v19
    v_accvgpr_read_b32 v19, a80
    v_mul_f32 v19, v19, v25
    v_accvgpr_write_b32 a80, v19
    v_accvgpr_read_b32 v19, a81
    v_mul_f32 v19, v19, v25
    v_accvgpr_write_b32 a81, v19
    v_accvgpr_read_b32 v19, a82
    v_mul_f32 v19, v19, v25
    v_accvgpr_write_b32 a82, v19
    v_accvgpr_read_b32 v19, a83
    v_mul_f32 v19, v19, v25
    v_accvgpr_write_b32 a83, v19
    v_accvgpr_read_b32 v19, a84
    v_mul_f32 v19, v19, v25
    v_accvgpr_write_b32 a84, v19
    v_accvgpr_read_b32 v19, a85
    v_mul_f32 v19, v19, v25
    v_accvgpr_write_b32 a85, v19
    v_accvgpr_read_b32 v19, a86
    v_mul_f32 v19, v19, v25
    v_accvgpr_write_b32 a86, v19
    v_accvgpr_read_b32 v19, a87
    v_mul_f32 v19, v19, v25
    v_accvgpr_write_b32 a87, v19
    v_accvgpr_read_b32 v19, a88
    v_mul_f32 v19, v19, v25
    v_accvgpr_write_b32 a88, v19
    v_accvgpr_read_b32 v19, a89
    v_mul_f32 v19, v19, v25
    v_accvgpr_write_b32 a89, v19
    v_accvgpr_read_b32 v19, a90
    v_mul_f32 v19, v19, v25
    v_accvgpr_write_b32 a90, v19
    v_accvgpr_read_b32 v19, a91
    v_mul_f32 v19, v19, v25
    v_accvgpr_write_b32 a91, v19
    v_accvgpr_read_b32 v19, a92
    v_mul_f32 v19, v19, v25
    v_accvgpr_write_b32 a92, v19
    v_accvgpr_read_b32 v19, a93
    v_mul_f32 v19, v19, v25
    v_accvgpr_write_b32 a93, v19
    v_accvgpr_read_b32 v19, a94
    v_mul_f32 v19, v19, v25
    v_accvgpr_write_b32 a94, v19
    v_accvgpr_read_b32 v19, a95
    v_mul_f32 v19, v19, v25
    v_accvgpr_write_b32 a95, v19
    v_fma_f32 v104, v104, s28, v13
    v_fma_f32 v105, v105, s28, v13
    v_exp_f32 v104, v104
    v_exp_f32 v105, v105
    s_nop 0
    v_cvt_pk_bf16_f32 v38, v104, v105
    v_fma_f32 v106, v106, s28, v13
    v_fma_f32 v107, v107, s28, v13
    v_exp_f32 v106, v106
    v_exp_f32 v107, v107
    s_nop 0
    v_cvt_pk_bf16_f32 v39, v106, v107
    v_fma_f32 v108, v108, s28, v13
    v_fma_f32 v109, v109, s28, v13
    v_exp_f32 v108, v108
    v_exp_f32 v109, v109
    s_nop 0
    v_cvt_pk_bf16_f32 v40, v108, v109
    v_fma_f32 v110, v110, s28, v13
    v_fma_f32 v111, v111, s28, v13
    v_exp_f32 v110, v110
    v_exp_f32 v111, v111
    s_nop 0
    v_cvt_pk_bf16_f32 v41, v110, v111
    v_mfma_f32_16x16x32_bf16 v[44:47], a[236:239], v[14:17], v[48:51]
    v_mfma_f32_16x16x32_bf16 v[44:47], a[240:243], v[20:23], v[44:47]
    v_mfma_f32_16x16x32_bf16 v[44:47], a[244:247], v[26:29], v[44:47]
    v_mfma_f32_16x16x32_bf16 v[44:47], a[248:251], v[32:35], v[44:47]
    v_mfma_f32_16x16x32_bf16 v[44:47], a[252:255], v[38:41], v[44:47]
    s_nop 15
    s_setpc_b64 s[40:41]
L_rare5_1:
    s_nop 15
    v_mbcnt_lo_u32_b32 v27, -1, 0
    v_mbcnt_hi_u32_b32 v27, -1, v27
    v_and_b32 v26, 15, v27
    v_mul_u32_u24 v26, 384, v26
    v_lshrrev_b32 v27, 4, v27
    v_lshl_add_u32 v26, v27, 4, v26
    s_add_u32 s69, s39, 0
    buffer_load_dwordx4 v[48:51], v26, s[4:7], s69 offen offset:0
    s_waitcnt vmcnt(0)
    v_mfma_f32_16x16x32_bf16 v[104:107], v[48:51], a[96:99], 0
    s_nop 7
    buffer_load_dwordx4 v[48:51], v26, s[4:7], s69 offen offset:64
    s_waitcnt vmcnt(0)
    v_mfma_f32_16x16x32_bf16 v[104:107], v[48:51], a[100:103], v[104:107]
    s_nop 7
    buffer_load_dwordx4 v[48:51], v26, s[4:7], s69 offen offset:128
    s_waitcnt vmcnt(0)
    v_mfma_f32_16x16x32_bf16 v[104:107], v[48:51], a[104:107], v[104:107]
    s_nop 7
    buffer_load_dwordx4 v[48:51], v26, s[4:7], s69 offen offset:192
    s_waitcnt vmcnt(0)
    v_mfma_f32_16x16x32_bf16 v[104:107], v[48:51], a[108:111], v[104:107]
    s_nop 7
    buffer_load_dwordx4 v[48:51], v26, s[4:7], s69 offen offset:256
    s_waitcnt vmcnt(0)
    v_mfma_f32_16x16x32_bf16 v[104:107], v[48:51], a[112:115], v[104:107]
    s_nop 7
    buffer_load_dwordx4 v[48:51], v26, s[4:7], s69 offen offset:320
    s_waitcnt vmcnt(0)
    v_mfma_f32_16x16x32_bf16 v[104:107], v[48:51], a[116:119], v[104:107]
    s_nop 7
    s_add_u32 s69, s39, 6144
    buffer_load_dwordx4 v[48:51], v26, s[4:7], s69 offen offset:0
    s_waitcnt vmcnt(0)
    v_mfma_f32_16x16x32_bf16 v[108:111], v[48:51], a[96:99], 0
    s_nop 7
    buffer_load_dwordx4 v[48:51], v26, s[4:7], s69 offen offset:64
    s_waitcnt vmcnt(0)
    v_mfma_f32_16x16x32_bf16 v[108:111], v[48:51], a[100:103], v[108:111]
    s_nop 7
    buffer_load_dwordx4 v[48:51], v26, s[4:7], s69 offen offset:128
    s_waitcnt vmcnt(0)
    v_mfma_f32_16x16x32_bf16 v[108:111], v[48:51], a[104:107], v[108:111]
    s_nop 7
    buffer_load_dwordx4 v[48:51], v26, s[4:7], s69 offen offset:192
    s_waitcnt vmcnt(0)
    v_mfma_f32_16x16x32_bf16 v[108:111], v[48:51], a[108:111], v[108:111]
    s_nop 7
    buffer_load_dwordx4 v[48:51], v26, s[4:7], s69 offen offset:256
    s_waitcnt vmcnt(0)
    v_mfma_f32_16x16x32_bf16 v[108:111], v[48:51], a[112:115], v[108:111]
    s_nop 7
    buffer_load_dwordx4 v[48:51], v26, s[4:7], s69 offen offset:320
    s_waitcnt vmcnt(0)
    v_mfma_f32_16x16x32_bf16 v[108:111], v[48:51], a[116:119], v[108:111]
    s_nop 7
    s_nop 15
    v_max3_f32 v14, v104, v105, v106
    v_max3_f32 v14, v14, v107, v108
    v_max3_f32 v14, v14, v109, v110
    v_max_f32 v14, v14, v111
    v_mov_b32 v15, v14
    s_nop 1
    v_permlane32_swap_b32 v15, v14
    v_max_f32 v14, v14, v15
    v_mov_b32 v15, v14
    s_nop 1
    v_permlane16_swap_b32 v15, v14
    v_max_f32 v14, v14, v15
    v_fma_f32 v14, v14, s28, v9
    v_max_f32 v20, 0, v14
    v_sub_f32 v9, v9, v20
    v_sub_f32 v21, 0, v20
    v_exp_f32 v21, v21
    s_nop 0
    v_mul_f32 v15, v44, v21
    v_cndmask_b32_e64 v44, v15, v44, s[60:61]
    v_cndmask_b32_e64 v44, v44, 0, s[46:47]
    v_mul_f32 v112, v112, v21
    v_mul_f32 v113, v113, v21
    v_mul_f32 v114, v114, v21
    v_mul_f32 v115, v115, v21
    v_mul_f32 v116, v116, v21
    v_mul_f32 v117, v117, v21
    v_mul_f32 v118, v118, v21
    v_mul_f32 v119, v119, v21
    v_mul_f32 v120, v120, v21
    v_mul_f32 v121, v121, v21
    v_mul_f32 v122, v122, v21
    v_mul_f32 v123, v123, v21
    v_mul_f32 v124, v124, v21
    v_mul_f32 v125, v125, v21
    v_mul_f32 v126, v126, v21
    v_mul_f32 v127, v127, v21
    v_mul_f32 v128, v128, v21
    v_mul_f32 v129, v129, v21
    v_mul_f32 v130, v130, v21
    v_mul_f32 v131, v131, v21
    v_mul_f32 v132, v132, v21
    v_mul_f32 v133, v133, v21
    v_mul_f32 v134, v134, v21
    v_mul_f32 v135, v135, v21
    v_mul_f32 v136, v136, v21
    v_mul_f32 v137, v137, v21
    v_mul_f32 v138, v138, v21
    v_mul_f32 v139, v139, v21
    v_mul_f32 v140, v140, v21
    v_mul_f32 v141, v141, v21
    v_mul_f32 v142, v142, v21
    v_mul_f32 v143, v143, v21
    v_mul_f32 v144, v144, v21
    v_mul_f32 v145, v145, v21
    v_mul_f32 v146, v146, v21
    v_mul_f32 v147, v147, v21
    v_mul_f32 v148, v148, v21
    v_mul_f32 v149, v149, v21
    v_mul_f32 v150, v150, v21
    v_mul_f32 v151, v151, v21
    v_mul_f32 v152, v152, v21
    v_mul_f32 v153, v153, v21
    v_mul_f32 v154, v154, v21
    v_mul_f32 v155, v155, v21
    v_mul_f32 v156, v156, v21
    v_mul_f32 v157, v157, v21
    v_mul_f32 v158, v158, v21
    v_mul_f32 v159, v159, v21
    v_fma_f32 v104, v104, s28, v9
    v_fma_f32 v105, v105, s28, v9
    v_exp_f32 v104, v104
    v_exp_f32 v105, v105
    s_nop 0
    v_cvt_pk_bf16_f32 v18, v104, v105
    v_fma_f32 v106, v106, s28, v9
    v_fma_f32 v107, v107, s28, v9
    v_exp_f32 v106, v106
    v_exp_f32 v107, v107
    s_nop 0
    v_cvt_pk_bf16_f32 v19, v106, v107
    v_fma_f32 v108, v108, s28, v9
    v_fma_f32 v109, v109, s28, v9
    v_exp_f32 v108, v108
    v_exp_f32 v109, v109
    s_nop 0
    v_cvt_pk_bf16_f32 v16, v108, v109
    v_fma_f32 v110, v110, s28, v9
    v_fma_f32 v111, v111, s28, v9
    v_exp_f32 v110, v110
    v_exp_f32 v111, v111
    s_nop 0
    v_cvt_pk_bf16_f32 v17, v110, v111
    s_add_u32 s69, s39, 0
    buffer_load_dwordx4 v[48:51], v26, s[4:7], s69 offen offset:0
    s_waitcnt vmcnt(0)
    v_mfma_f32_16x16x32_bf16 v[104:107], v[48:51], a[120:123], 0
    s_nop 7
    buffer_load_dwordx4 v[48:51], v26, s[4:7], s69 offen offset:64
    s_waitcnt vmcnt(0)
    v_mfma_f32_16x16x32_bf16 v[104:107], v[48:51], a[124:127], v[104:107]
    s_nop 7
    buffer_load_dwordx4 v[48:51], v26, s[4:7], s69 offen offset:128
    s_waitcnt vmcnt(0)
    v_mfma_f32_16x16x32_bf16 v[104:107], v[48:51], a[128:131], v[104:107]
    s_nop 7
    buffer_load_dwordx4 v[48:51], v26, s[4:7], s69 offen offset:192
    s_waitcnt vmcnt(0)
    v_mfma_f32_16x16x32_bf16 v[104:107], v[48:51], a[132:135], v[104:107]
    s_nop 7
    buffer_load_dwordx4 v[48:51], v26, s[4:7], s69 offen offset:256
    s_waitcnt vmcnt(0)
    v_mfma_f32_16x16x32_bf16 v[104:107], v[48:51], a[136:139], v[104:107]
    s_nop 7
    buffer_load_dwordx4 v[48:51], v26, s[4:7], s69 offen offset:320
    s_waitcnt vmcnt(0)
    v_mfma_f32_16x16x32_bf16 v[104:107], v[48:51], a[140:143], v[104:107]
    s_nop 7
    s_add_u32 s69, s39, 6144
    buffer_load_dwordx4 v[48:51], v26, s[4:7], s69 offen offset:0
    s_waitcnt vmcnt(0)
    v_mfma_f32_16x16x32_bf16 v[108:111], v[48:51], a[120:123], 0
    s_nop 7
    buffer_load_dwordx4 v[48:51], v26, s[4:7], s69 offen offset:64
    s_waitcnt vmcnt(0)
    v_mfma_f32_16x16x32_bf16 v[108:111], v[48:51], a[124:127], v[108:111]
    s_nop 7
    buffer_load_dwordx4 v[48:51], v26, s[4:7], s69 offen offset:128
    s_waitcnt vmcnt(0)
    v_mfma_f32_16x16x32_bf16 v[108:111], v[48:51], a[128:131], v[108:111]
    s_nop 7
    buffer_load_dwordx4 v[48:51], v26, s[4:7], s69 offen offset:192
    s_waitcnt vmcnt(0)
    v_mfma_f32_16x16x32_bf16 v[108:111], v[48:51], a[132:135], v[108:111]
    s_nop 7
    buffer_load_dwordx4 v[48:51], v26, s[4:7], s69 offen offset:256
    s_waitcnt vmcnt(0)
    v_mfma_f32_16x16x32_bf16 v[108:111], v[48:51], a[136:139], v[108:111]
    s_nop 7
    buffer_load_dwordx4 v[48:51], v26, s[4:7], s69 offen offset:320
    s_waitcnt vmcnt(0)
    v_mfma_f32_16x16x32_bf16 v[108:111], v[48:51], a[140:143], v[108:111]
    s_nop 7
    s_nop 15
    v_max3_f32 v14, v104, v105, v106
    v_max3_f32 v14, v14, v107, v108
    v_max3_f32 v14, v14, v109, v110
    v_max_f32 v14, v14, v111
    v_mov_b32 v15, v14
    s_nop 1
    v_permlane32_swap_b32 v15, v14
    v_max_f32 v14, v14, v15
    v_mov_b32 v15, v14
    s_nop 1
    v_permlane16_swap_b32 v15, v14
    v_max_f32 v14, v14, v15
    v_fma_f32 v14, v14, s28, v10
    v_max_f32 v20, 0, v14
    v_sub_f32 v10, v10, v20
    v_sub_f32 v21, 0, v20
    v_exp_f32 v21, v21
    s_nop 0
    v_mul_f32 v45, v45, v21
    v_mul_f32 v160, v160, v21
    v_mul_f32 v161, v161, v21
    v_mul_f32 v162, v162, v21
    v_mul_f32 v163, v163, v21
    v_mul_f32 v164, v164, v21
    v_mul_f32 v165, v165, v21
    v_mul_f32 v166, v166, v21
    v_mul_f32 v167, v167, v21
    v_mul_f32 v168, v168, v21
    v_mul_f32 v169, v169, v21
    v_mul_f32 v170, v170, v21
    v_mul_f32 v171, v171, v21
    v_mul_f32 v172, v172, v21
    v_mul_f32 v173, v173, v21
    v_mul_f32 v174, v174, v21
    v_mul_f32 v175, v175, v21
    v_mul_f32 v176, v176, v21
    v_mul_f32 v177, v177, v21
    v_mul_f32 v178, v178, v21
    v_mul_f32 v179, v179, v21
    v_mul_f32 v180, v180, v21
    v_mul_f32 v181, v181, v21
    v_mul_f32 v182, v182, v21
    v_mul_f32 v183, v183, v21
    v_mul_f32 v184, v184, v21
    v_mul_f32 v185, v185, v21
    v_mul_f32 v186, v186, v21
    v_mul_f32 v187, v187, v21
    v_mul_f32 v188, v188, v21
    v_mul_f32 v189, v189, v21
    v_mul_f32 v190, v190, v21
    v_mul_f32 v191, v191, v21
    v_mul_f32 v192, v192, v21
    v_mul_f32 v193, v193, v21
    v_mul_f32 v194, v194, v21
    v_mul_f32 v195, v195, v21
    v_mul_f32 v196, v196, v21
    v_mul_f32 v197, v197, v21
    v_mul_f32 v198, v198, v21
    v_mul_f32 v199, v199, v21
    v_mul_f32 v200, v200, v21
    v_mul_f32 v201, v201, v21
    v_mul_f32 v202, v202, v21
    v_mul_f32 v203, v203, v21
    v_mul_f32 v204, v204, v21
    v_mul_f32 v205, v205, v21
    v_mul_f32 v206, v206, v21
    v_mul_f32 v207, v207, v21
    v_fma_f32 v104, v104, s28, v10
    v_fma_f32 v105, v105, s28, v10
    v_exp_f32 v104, v104
    v_exp_f32 v105, v105
    s_nop 0
    v_cvt_pk_bf16_f32 v24, v104, v105
    v_fma_f32 v106, v106, s28, v10
    v_fma_f32 v107, v107, s28, v10
    v_exp_f32 v106, v106
    v_exp_f32 v107, v107
    s_nop 0
    v_cvt_pk_bf16_f32 v25, v106, v107
    v_fma_f32 v108, v108, s28, v10
    v_fma_f32 v109, v109, s28, v10
    v_exp_f32 v108, v108
    v_exp_f32 v109, v109
    s_nop 0
    v_cvt_pk_bf16_f32 v22, v108, v109
    v_fma_f32 v110, v110, s28, v10
    v_fma_f32 v111, v111, s28, v10
    v_exp_f32 v110, v110
    v_exp_f32 v111, v111
    s_nop 0
    v_cvt_pk_bf16_f32 v23, v110, v111
    s_add_u32 s69, s39, 0
    buffer_load_dwordx4 v[48:51], v26, s[4:7], s69 offen offset:0
    s_waitcnt vmcnt(0)
    v_mfma_f32_16x16x32_bf16 v[104:107], v[48:51], a[144:147], 0
    s_nop 7
    buffer_load_dwordx4 v[48:51], v26, s[4:7], s69 offen offset:64
    s_waitcnt vmcnt(0)
    v_mfma_f32_16x16x32_bf16 v[104:107], v[48:51], a[148:151], v[104:107]
    s_nop 7
    buffer_load_dwordx4 v[48:51], v26, s[4:7], s69 offen offset:128
    s_waitcnt vmcnt(0)
    v_mfma_f32_16x16x32_bf16 v[104:107], v[48:51], a[152:155], v[104:107]
    s_nop 7
    buffer_load_dwordx4 v[48:51], v26, s[4:7], s69 offen offset:192
    s_waitcnt vmcnt(0)
    v_mfma_f32_16x16x32_bf16 v[104:107], v[48:51], a[156:159], v[104:107]
    s_nop 7
    buffer_load_dwordx4 v[48:51], v26, s[4:7], s69 offen offset:256
    s_waitcnt vmcnt(0)
    v_mfma_f32_16x16x32_bf16 v[104:107], v[48:51], a[160:163], v[104:107]
    s_nop 7
    buffer_load_dwordx4 v[48:51], v26, s[4:7], s69 offen offset:320
    s_waitcnt vmcnt(0)
    v_mfma_f32_16x16x32_bf16 v[104:107], v[48:51], a[164:167], v[104:107]
    s_nop 7
    s_add_u32 s69, s39, 6144
    buffer_load_dwordx4 v[48:51], v26, s[4:7], s69 offen offset:0
    s_waitcnt vmcnt(0)
    v_mfma_f32_16x16x32_bf16 v[108:111], v[48:51], a[144:147], 0
    s_nop 7
    buffer_load_dwordx4 v[48:51], v26, s[4:7], s69 offen offset:64
    s_waitcnt vmcnt(0)
    v_mfma_f32_16x16x32_bf16 v[108:111], v[48:51], a[148:151], v[108:111]
    s_nop 7
    buffer_load_dwordx4 v[48:51], v26, s[4:7], s69 offen offset:128
    s_waitcnt vmcnt(0)
    v_mfma_f32_16x16x32_bf16 v[108:111], v[48:51], a[152:155], v[108:111]
    s_nop 7
    buffer_load_dwordx4 v[48:51], v26, s[4:7], s69 offen offset:192
    s_waitcnt vmcnt(0)
    v_mfma_f32_16x16x32_bf16 v[108:111], v[48:51], a[156:159], v[108:111]
    s_nop 7
    buffer_load_dwordx4 v[48:51], v26, s[4:7], s69 offen offset:256
    s_waitcnt vmcnt(0)
    v_mfma_f32_16x16x32_bf16 v[108:111], v[48:51], a[160:163], v[108:111]
    s_nop 7
    buffer_load_dwordx4 v[48:51], v26, s[4:7], s69 offen offset:320
    s_waitcnt vmcnt(0)
    v_mfma_f32_16x16x32_bf16 v[108:111], v[48:51], a[164:167], v[108:111]
    s_nop 7
    s_nop 15
    v_max3_f32 v14, v104, v105, v106
    v_max3_f32 v14, v14, v107, v108
    v_max3_f32 v14, v14, v109, v110
    v_max_f32 v14, v14, v111
    v_mov_b32 v15, v14
    s_nop 1
    v_permlane32_swap_b32 v15, v14
    v_max_f32 v14, v14, v15
    v_mov_b32 v15, v14
    s_nop 1
    v_permlane16_swap_b32 v15, v14
    v_max_f32 v14, v14, v15
    v_fma_f32 v14, v14, s28, v11
    v_max_f32 v20, 0, v14
    v_sub_f32 v11, v11, v20
    v_sub_f32 v21, 0, v20
    v_exp_f32 v21, v21
    s_nop 0
    v_mul_f32 v46, v46, v21
    v_mul_f32 v208, v208, v21
    v_mul_f32 v209, v209, v21
    v_mul_f32 v210, v210, v21
    v_mul_f32 v211, v211, v21
    v_mul_f32 v212, v212, v21
    v_mul_f32 v213, v213, v21
    v_mul_f32 v214, v214, v21
    v_mul_f32 v215, v215, v21
    v_mul_f32 v216, v216, v21
    v_mul_f32 v217, v217, v21
    v_mul_f32 v218, v218, v21
    v_mul_f32 v219, v219, v21
    v_mul_f32 v220, v220, v21
    v_mul_f32 v221, v221, v21
    v_mul_f32 v222, v222, v21
    v_mul_f32 v223, v223, v21
    v_mul_f32 v224, v224, v21
    v_mul_f32 v225, v225, v21
    v_mul_f32 v226, v226, v21
    v_mul_f32 v227, v227, v21
    v_mul_f32 v228, v228, v21
    v_mul_f32 v229, v229, v21
    v_mul_f32 v230, v230, v21
    v_mul_f32 v231, v231, v21
    v_mul_f32 v232, v232, v21
    v_mul_f32 v233, v233, v21
    v_mul_f32 v234, v234, v21
    v_mul_f32 v235, v235, v21
    v_mul_f32 v236, v236, v21
    v_mul_f32 v237, v237, v21
    v_mul_f32 v238, v238, v21
    v_mul_f32 v239, v239, v21
    v_mul_f32 v240, v240, v21
    v_mul_f32 v241, v241, v21
    v_mul_f32 v242, v242, v21
    v_mul_f32 v243, v243, v21
    v_mul_f32 v244, v244, v21
    v_mul_f32 v245, v245, v21
    v_mul_f32 v246, v246, v21
    v_mul_f32 v247, v247, v21
    v_mul_f32 v248, v248, v21
    v_mul_f32 v249, v249, v21
    v_mul_f32 v250, v250, v21
    v_mul_f32 v251, v251, v21
    v_mul_f32 v252, v252, v21
    v_mul_f32 v253, v253, v21
    v_mul_f32 v254, v254, v21
    v_mul_f32 v255, v255, v21
    v_fma_f32 v104, v104, s28, v11
    v_fma_f32 v105, v105, s28, v11
    v_exp_f32 v104, v104
    v_exp_f32 v105, v105
    s_nop 0
    v_cvt_pk_bf16_f32 v30, v104, v105
    v_fma_f32 v106, v106, s28, v11
    v_fma_f32 v107, v107, s28, v11
    v_exp_f32 v106, v106
    v_exp_f32 v107, v107
    s_nop 0
    v_cvt_pk_bf16_f32 v31, v106, v107
    v_fma_f32 v108, v108, s28, v11
    v_fma_f32 v109, v109, s28, v11
    v_exp_f32 v108, v108
    v_exp_f32 v109, v109
    s_nop 0
    v_cvt_pk_bf16_f32 v28, v108, v109
    v_fma_f32 v110, v110, s28, v11
    v_fma_f32 v111, v111, s28, v11
    v_exp_f32 v110, v110
    v_exp_f32 v111, v111
    s_nop 0
    v_cvt_pk_bf16_f32 v29, v110, v111
    s_add_u32 s69, s39, 0
    buffer_load_dwordx4 v[48:51], v26, s[4:7], s69 offen offset:0
    s_waitcnt vmcnt(0)
    v_mfma_f32_16x16x32_bf16 v[104:107], v[48:51], a[168:171], 0
    s_nop 7
    buffer_load_dwordx4 v[48:51], v26, s[4:7], s69 offen offset:64
    s_waitcnt vmcnt(0)
    v_mfma_f32_16x16x32_bf16 v[104:107], v[48:51], a[172:175], v[104:107]
    s_nop 7
    buffer_load_dwordx4 v[48:51], v26, s[4:7], s69 offen offset:128
    s_waitcnt vmcnt(0)
    v_mfma_f32_16x16x32_bf16 v[104:107], v[48:51], a[176:179], v[104:107]
    s_nop 7
    buffer_load_dwordx4 v[48:51], v26, s[4:7], s69 offen offset:192
    s_waitcnt vmcnt(0)
    v_mfma_f32_16x16x32_bf16 v[104:107], v[48:51], a[180:183], v[104:107]
    s_nop 7
    buffer_load_dwordx4 v[48:51], v26, s[4:7], s69 offen offset:256
    s_waitcnt vmcnt(0)
    v_mfma_f32_16x16x32_bf16 v[104:107], v[48:51], a[184:187], v[104:107]
    s_nop 7
    buffer_load_dwordx4 v[48:51], v26, s[4:7], s69 offen offset:320
    s_waitcnt vmcnt(0)
    v_mfma_f32_16x16x32_bf16 v[104:107], v[48:51], a[188:191], v[104:107]
    s_nop 7
    s_add_u32 s69, s39, 6144
    buffer_load_dwordx4 v[48:51], v26, s[4:7], s69 offen offset:0
    s_waitcnt vmcnt(0)
    v_mfma_f32_16x16x32_bf16 v[108:111], v[48:51], a[168:171], 0
    s_nop 7
    buffer_load_dwordx4 v[48:51], v26, s[4:7], s69 offen offset:64
    s_waitcnt vmcnt(0)
    v_mfma_f32_16x16x32_bf16 v[108:111], v[48:51], a[172:175], v[108:111]
    s_nop 7
    buffer_load_dwordx4 v[48:51], v26, s[4:7], s69 offen offset:128
    s_waitcnt vmcnt(0)
    v_mfma_f32_16x16x32_bf16 v[108:111], v[48:51], a[176:179], v[108:111]
    s_nop 7
    buffer_load_dwordx4 v[48:51], v26, s[4:7], s69 offen offset:192
    s_waitcnt vmcnt(0)
    v_mfma_f32_16x16x32_bf16 v[108:111], v[48:51], a[180:183], v[108:111]
    s_nop 7
    buffer_load_dwordx4 v[48:51], v26, s[4:7], s69 offen offset:256
    s_waitcnt vmcnt(0)
    v_mfma_f32_16x16x32_bf16 v[108:111], v[48:51], a[184:187], v[108:111]
    s_nop 7
    buffer_load_dwordx4 v[48:51], v26, s[4:7], s69 offen offset:320
    s_waitcnt vmcnt(0)
    v_mfma_f32_16x16x32_bf16 v[108:111], v[48:51], a[188:191], v[108:111]
    s_nop 7
    s_nop 15
    v_max3_f32 v14, v104, v105, v106
    v_max3_f32 v14, v14, v107, v108
    v_max3_f32 v14, v14, v109, v110
    v_max_f32 v14, v14, v111
    v_mov_b32 v15, v14
    s_nop 1
    v_permlane32_swap_b32 v15, v14
    v_max_f32 v14, v14, v15
    v_mov_b32 v15, v14
    s_nop 1
    v_permlane16_swap_b32 v15, v14
    v_max_f32 v14, v14, v15
    v_fma_f32 v14, v14, s28, v12
    v_max_f32 v20, 0, v14
    v_sub_f32 v12, v12, v20
    v_sub_f32 v21, 0, v20
    v_exp_f32 v21, v21
    s_nop 0
    v_mul_f32 v47, v47, v21
    v_accvgpr_read_b32 v15, a0
    v_mul_f32 v15, v15, v21
    v_accvgpr_write_b32 a0, v15
    v_accvgpr_read_b32 v15, a1
    v_mul_f32 v15, v15, v21
    v_accvgpr_write_b32 a1, v15
    v_accvgpr_read_b32 v15, a2
    v_mul_f32 v15, v15, v21
    v_accvgpr_write_b32 a2, v15
    v_accvgpr_read_b32 v15, a3
    v_mul_f32 v15, v15, v21
    v_accvgpr_write_b32 a3, v15
    v_accvgpr_read_b32 v15, a4
    v_mul_f32 v15, v15, v21
    v_accvgpr_write_b32 a4, v15
    v_accvgpr_read_b32 v15, a5
    v_mul_f32 v15, v15, v21
    v_accvgpr_write_b32 a5, v15
    v_accvgpr_read_b32 v15, a6
    v_mul_f32 v15, v15, v21
    v_accvgpr_write_b32 a6, v15
    v_accvgpr_read_b32 v15, a7
    v_mul_f32 v15, v15, v21
    v_accvgpr_write_b32 a7, v15
    v_accvgpr_read_b32 v15, a8
    v_mul_f32 v15, v15, v21
    v_accvgpr_write_b32 a8, v15
    v_accvgpr_read_b32 v15, a9
    v_mul_f32 v15, v15, v21
    v_accvgpr_write_b32 a9, v15
    v_accvgpr_read_b32 v15, a10
    v_mul_f32 v15, v15, v21
    v_accvgpr_write_b32 a10, v15
    v_accvgpr_read_b32 v15, a11
    v_mul_f32 v15, v15, v21
    v_accvgpr_write_b32 a11, v15
    v_accvgpr_read_b32 v15, a12
    v_mul_f32 v15, v15, v21
    v_accvgpr_write_b32 a12, v15
    v_accvgpr_read_b32 v15, a13
    v_mul_f32 v15, v15, v21
    v_accvgpr_write_b32 a13, v15
    v_accvgpr_read_b32 v15, a14
    v_mul_f32 v15, v15, v21
    v_accvgpr_write_b32 a14, v15
    v_accvgpr_read_b32 v15, a15
    v_mul_f32 v15, v15, v21
    v_accvgpr_write_b32 a15, v15
    v_accvgpr_read_b32 v15, a16
    v_mul_f32 v15, v15, v21
    v_accvgpr_write_b32 a16, v15
    v_accvgpr_read_b32 v15, a17
    v_mul_f32 v15, v15, v21
    v_accvgpr_write_b32 a17, v15
    v_accvgpr_read_b32 v15, a18
    v_mul_f32 v15, v15, v21
    v_accvgpr_write_b32 a18, v15
    v_accvgpr_read_b32 v15, a19
    v_mul_f32 v15, v15, v21
    v_accvgpr_write_b32 a19, v15
    v_accvgpr_read_b32 v15, a20
    v_mul_f32 v15, v15, v21
    v_accvgpr_write_b32 a20, v15
    v_accvgpr_read_b32 v15, a21
    v_mul_f32 v15, v15, v21
    v_accvgpr_write_b32 a21, v15
    v_accvgpr_read_b32 v15, a22
    v_mul_f32 v15, v15, v21
    v_accvgpr_write_b32 a22, v15
    v_accvgpr_read_b32 v15, a23
    v_mul_f32 v15, v15, v21
    v_accvgpr_write_b32 a23, v15
    v_accvgpr_read_b32 v15, a24
    v_mul_f32 v15, v15, v21
    v_accvgpr_write_b32 a24, v15
    v_accvgpr_read_b32 v15, a25
    v_mul_f32 v15, v15, v21
    v_accvgpr_write_b32 a25, v15
    v_accvgpr_read_b32 v15, a26
    v_mul_f32 v15, v15, v21
    v_accvgpr_write_b32 a26, v15
    v_accvgpr_read_b32 v15, a27
    v_mul_f32 v15, v15, v21
    v_accvgpr_write_b32 a27, v15
    v_accvgpr_read_b32 v15, a28
    v_mul_f32 v15, v15, v21
    v_accvgpr_write_b32 a28, v15
    v_accvgpr_read_b32 v15, a29
    v_mul_f32 v15, v15, v21
    v_accvgpr_write_b32 a29, v15
    v_accvgpr_read_b32 v15, a30
    v_mul_f32 v15, v15, v21
    v_accvgpr_write_b32 a30, v15
    v_accvgpr_read_b32 v15, a31
    v_mul_f32 v15, v15, v21
    v_accvgpr_write_b32 a31, v15
    v_accvgpr_read_b32 v15, a32
    v_mul_f32 v15, v15, v21
    v_accvgpr_write_b32 a32, v15
    v_accvgpr_read_b32 v15, a33
    v_mul_f32 v15, v15, v21
    v_accvgpr_write_b32 a33, v15
    v_accvgpr_read_b32 v15, a34
    v_mul_f32 v15, v15, v21
    v_accvgpr_write_b32 a34, v15
    v_accvgpr_read_b32 v15, a35
    v_mul_f32 v15, v15, v21
    v_accvgpr_write_b32 a35, v15
    v_accvgpr_read_b32 v15, a36
    v_mul_f32 v15, v15, v21
    v_accvgpr_write_b32 a36, v15
    v_accvgpr_read_b32 v15, a37
    v_mul_f32 v15, v15, v21
    v_accvgpr_write_b32 a37, v15
    v_accvgpr_read_b32 v15, a38
    v_mul_f32 v15, v15, v21
    v_accvgpr_write_b32 a38, v15
    v_accvgpr_read_b32 v15, a39
    v_mul_f32 v15, v15, v21
    v_accvgpr_write_b32 a39, v15
    v_accvgpr_read_b32 v15, a40
    v_mul_f32 v15, v15, v21
    v_accvgpr_write_b32 a40, v15
    v_accvgpr_read_b32 v15, a41
    v_mul_f32 v15, v15, v21
    v_accvgpr_write_b32 a41, v15
    v_accvgpr_read_b32 v15, a42
    v_mul_f32 v15, v15, v21
    v_accvgpr_write_b32 a42, v15
    v_accvgpr_read_b32 v15, a43
    v_mul_f32 v15, v15, v21
    v_accvgpr_write_b32 a43, v15
    v_accvgpr_read_b32 v15, a44
    v_mul_f32 v15, v15, v21
    v_accvgpr_write_b32 a44, v15
    v_accvgpr_read_b32 v15, a45
    v_mul_f32 v15, v15, v21
    v_accvgpr_write_b32 a45, v15
    v_accvgpr_read_b32 v15, a46
    v_mul_f32 v15, v15, v21
    v_accvgpr_write_b32 a46, v15
    v_accvgpr_read_b32 v15, a47
    v_mul_f32 v15, v15, v21
    v_accvgpr_write_b32 a47, v15
    v_fma_f32 v104, v104, s28, v12
    v_fma_f32 v105, v105, s28, v12
    v_exp_f32 v104, v104
    v_exp_f32 v105, v105
    s_nop 0
    v_cvt_pk_bf16_f32 v36, v104, v105
    v_fma_f32 v106, v106, s28, v12
    v_fma_f32 v107, v107, s28, v12
    v_exp_f32 v106, v106
    v_exp_f32 v107, v107
    s_nop 0
    v_cvt_pk_bf16_f32 v37, v106, v107
    v_fma_f32 v108, v108, s28, v12
    v_fma_f32 v109, v109, s28, v12
    v_exp_f32 v108, v108
    v_exp_f32 v109, v109
    s_nop 0
    v_cvt_pk_bf16_f32 v34, v108, v109
    v_fma_f32 v110, v110, s28, v12
    v_fma_f32 v111, v111, s28, v12
    v_exp_f32 v110, v110
    v_exp_f32 v111, v111
    s_nop 0
    v_cvt_pk_bf16_f32 v35, v110, v111
    s_add_u32 s69, s39, 0
    buffer_load_dwordx4 v[48:51], v26, s[4:7], s69 offen offset:0
    s_waitcnt vmcnt(0)
    v_mfma_f32_16x16x32_bf16 v[104:107], v[48:51], a[192:195], 0
    s_nop 7
    buffer_load_dwordx4 v[48:51], v26, s[4:7], s69 offen offset:64
    s_waitcnt vmcnt(0)
    v_mfma_f32_16x16x32_bf16 v[104:107], v[48:51], a[196:199], v[104:107]
    s_nop 7
    buffer_load_dwordx4 v[48:51], v26, s[4:7], s69 offen offset:128
    s_waitcnt vmcnt(0)
    v_mfma_f32_16x16x32_bf16 v[104:107], v[48:51], a[200:203], v[104:107]
    s_nop 7
    buffer_load_dwordx4 v[48:51], v26, s[4:7], s69 offen offset:192
    s_waitcnt vmcnt(0)
    v_mfma_f32_16x16x32_bf16 v[104:107], v[48:51], a[204:207], v[104:107]
    s_nop 7
    buffer_load_dwordx4 v[48:51], v26, s[4:7], s69 offen offset:256
    s_waitcnt vmcnt(0)
    v_mfma_f32_16x16x32_bf16 v[104:107], v[48:51], a[208:211], v[104:107]
    s_nop 7
    buffer_load_dwordx4 v[48:51], v26, s[4:7], s69 offen offset:320
    s_waitcnt vmcnt(0)
    v_mfma_f32_16x16x32_bf16 v[104:107], v[48:51], v[92:95], v[104:107]
    s_nop 7
    s_add_u32 s69, s39, 6144
    buffer_load_dwordx4 v[48:51], v26, s[4:7], s69 offen offset:0
    s_waitcnt vmcnt(0)
    v_mfma_f32_16x16x32_bf16 v[108:111], v[48:51], a[192:195], 0
    s_nop 7
    buffer_load_dwordx4 v[48:51], v26, s[4:7], s69 offen offset:64
    s_waitcnt vmcnt(0)
    v_mfma_f32_16x16x32_bf16 v[108:111], v[48:51], a[196:199], v[108:111]
    s_nop 7
    buffer_load_dwordx4 v[48:51], v26, s[4:7], s69 offen offset:128
    s_waitcnt vmcnt(0)
    v_mfma_f32_16x16x32_bf16 v[108:111], v[48:51], a[200:203], v[108:111]
    s_nop 7
    buffer_load_dwordx4 v[48:51], v26, s[4:7], s69 offen offset:192
    s_waitcnt vmcnt(0)
    v_mfma_f32_16x16x32_bf16 v[108:111], v[48:51], a[204:207], v[108:111]
    s_nop 7
    buffer_load_dwordx4 v[48:51], v26, s[4:7], s69 offen offset:256
    s_waitcnt vmcnt(0)
    v_mfma_f32_16x16x32_bf16 v[108:111], v[48:51], a[208:211], v[108:111]
    s_nop 7
    buffer_load_dwordx4 v[48:51], v26, s[4:7], s69 offen offset:320
    s_waitcnt vmcnt(0)
    v_mfma_f32_16x16x32_bf16 v[108:111], v[48:51], v[92:95], v[108:111]
    s_nop 7
    s_nop 15
    v_max3_f32 v14, v104, v105, v106
    v_max3_f32 v14, v14, v107, v108
    v_max3_f32 v14, v14, v109, v110
    v_max_f32 v14, v14, v111
    v_mov_b32 v15, v14
    s_nop 1
    v_permlane32_swap_b32 v15, v14
    v_max_f32 v14, v14, v15
    v_mov_b32 v15, v14
    s_nop 1
    v_permlane16_swap_b32 v15, v14
    v_max_f32 v14, v14, v15
    v_fma_f32 v14, v14, s28, v13
    v_max_f32 v20, 0, v14
    v_sub_f32 v13, v13, v20
    v_sub_f32 v21, 0, v20
    v_exp_f32 v21, v21
    s_nop 0
    v_mul_f32 v15, v44, v21
    v_cndmask_b32_e64 v44, v44, v15, s[60:61]
    v_accvgpr_read_b32 v15, a48
    v_mul_f32 v15, v15, v21
    v_accvgpr_write_b32 a48, v15
    v_accvgpr_read_b32 v15, a49
    v_mul_f32 v15, v15, v21
    v_accvgpr_write_b32 a49, v15
    v_accvgpr_read_b32 v15, a50
    v_mul_f32 v15, v15, v21
    v_accvgpr_write_b32 a50, v15
    v_accvgpr_read_b32 v15, a51
    v_mul_f32 v15, v15, v21
    v_accvgpr_write_b32 a51, v15
    v_accvgpr_read_b32 v15, a52
    v_mul_f32 v15, v15, v21
    v_accvgpr_write_b32 a52, v15
    v_accvgpr_read_b32 v15, a53
    v_mul_f32 v15, v15, v21
    v_accvgpr_write_b32 a53, v15
    v_accvgpr_read_b32 v15, a54
    v_mul_f32 v15, v15, v21
    v_accvgpr_write_b32 a54, v15
    v_accvgpr_read_b32 v15, a55
    v_mul_f32 v15, v15, v21
    v_accvgpr_write_b32 a55, v15
    v_accvgpr_read_b32 v15, a56
    v_mul_f32 v15, v15, v21
    v_accvgpr_write_b32 a56, v15
    v_accvgpr_read_b32 v15, a57
    v_mul_f32 v15, v15, v21
    v_accvgpr_write_b32 a57, v15
    v_accvgpr_read_b32 v15, a58
    v_mul_f32 v15, v15, v21
    v_accvgpr_write_b32 a58, v15
    v_accvgpr_read_b32 v15, a59
    v_mul_f32 v15, v15, v21
    v_accvgpr_write_b32 a59, v15
    v_accvgpr_read_b32 v15, a60
    v_mul_f32 v15, v15, v21
    v_accvgpr_write_b32 a60, v15
    v_accvgpr_read_b32 v15, a61
    v_mul_f32 v15, v15, v21
    v_accvgpr_write_b32 a61, v15
    v_accvgpr_read_b32 v15, a62
    v_mul_f32 v15, v15, v21
    v_accvgpr_write_b32 a62, v15
    v_accvgpr_read_b32 v15, a63
    v_mul_f32 v15, v15, v21
    v_accvgpr_write_b32 a63, v15
    v_accvgpr_read_b32 v15, a64
    v_mul_f32 v15, v15, v21
    v_accvgpr_write_b32 a64, v15
    v_accvgpr_read_b32 v15, a65
    v_mul_f32 v15, v15, v21
    v_accvgpr_write_b32 a65, v15
    v_accvgpr_read_b32 v15, a66
    v_mul_f32 v15, v15, v21
    v_accvgpr_write_b32 a66, v15
    v_accvgpr_read_b32 v15, a67
    v_mul_f32 v15, v15, v21
    v_accvgpr_write_b32 a67, v15
    v_accvgpr_read_b32 v15, a68
    v_mul_f32 v15, v15, v21
    v_accvgpr_write_b32 a68, v15
    v_accvgpr_read_b32 v15, a69
    v_mul_f32 v15, v15, v21
    v_accvgpr_write_b32 a69, v15
    v_accvgpr_read_b32 v15, a70
    v_mul_f32 v15, v15, v21
    v_accvgpr_write_b32 a70, v15
    v_accvgpr_read_b32 v15, a71
    v_mul_f32 v15, v15, v21
    v_accvgpr_write_b32 a71, v15
    v_accvgpr_read_b32 v15, a72
    v_mul_f32 v15, v15, v21
    v_accvgpr_write_b32 a72, v15
    v_accvgpr_read_b32 v15, a73
    v_mul_f32 v15, v15, v21
    v_accvgpr_write_b32 a73, v15
    v_accvgpr_read_b32 v15, a74
    v_mul_f32 v15, v15, v21
    v_accvgpr_write_b32 a74, v15
    v_accvgpr_read_b32 v15, a75
    v_mul_f32 v15, v15, v21
    v_accvgpr_write_b32 a75, v15
    v_accvgpr_read_b32 v15, a76
    v_mul_f32 v15, v15, v21
    v_accvgpr_write_b32 a76, v15
    v_accvgpr_read_b32 v15, a77
    v_mul_f32 v15, v15, v21
    v_accvgpr_write_b32 a77, v15
    v_accvgpr_read_b32 v15, a78
    v_mul_f32 v15, v15, v21
    v_accvgpr_write_b32 a78, v15
    v_accvgpr_read_b32 v15, a79
    v_mul_f32 v15, v15, v21
    v_accvgpr_write_b32 a79, v15
    v_accvgpr_read_b32 v15, a80
    v_mul_f32 v15, v15, v21
    v_accvgpr_write_b32 a80, v15
    v_accvgpr_read_b32 v15, a81
    v_mul_f32 v15, v15, v21
    v_accvgpr_write_b32 a81, v15
    v_accvgpr_read_b32 v15, a82
    v_mul_f32 v15, v15, v21
    v_accvgpr_write_b32 a82, v15
    v_accvgpr_read_b32 v15, a83
    v_mul_f32 v15, v15, v21
    v_accvgpr_write_b32 a83, v15
    v_accvgpr_read_b32 v15, a84
    v_mul_f32 v15, v15, v21
    v_accvgpr_write_b32 a84, v15
    v_accvgpr_read_b32 v15, a85
    v_mul_f32 v15, v15, v21
    v_accvgpr_write_b32 a85, v15
    v_accvgpr_read_b32 v15, a86
    v_mul_f32 v15, v15, v21
    v_accvgpr_write_b32 a86, v15
    v_accvgpr_read_b32 v15, a87
    v_mul_f32 v15, v15, v21
    v_accvgpr_write_b32 a87, v15
    v_accvgpr_read_b32 v15, a88
    v_mul_f32 v15, v15, v21
    v_accvgpr_write_b32 a88, v15
    v_accvgpr_read_b32 v15, a89
    v_mul_f32 v15, v15, v21
    v_accvgpr_write_b32 a89, v15
    v_accvgpr_read_b32 v15, a90
    v_mul_f32 v15, v15, v21
    v_accvgpr_write_b32 a90, v15
    v_accvgpr_read_b32 v15, a91
    v_mul_f32 v15, v15, v21
    v_accvgpr_write_b32 a91, v15
    v_accvgpr_read_b32 v15, a92
    v_mul_f32 v15, v15, v21
    v_accvgpr_write_b32 a92, v15
    v_accvgpr_read_b32 v15, a93
    v_mul_f32 v15, v15, v21
    v_accvgpr_write_b32 a93, v15
    v_accvgpr_read_b32 v15, a94
    v_mul_f32 v15, v15, v21
    v_accvgpr_write_b32 a94, v15
    v_accvgpr_read_b32 v15, a95
    v_mul_f32 v15, v15, v21
    v_accvgpr_write_b32 a95, v15
    v_fma_f32 v104, v104, s28, v13
    v_fma_f32 v105, v105, s28, v13
    v_exp_f32 v104, v104
    v_exp_f32 v105, v105
    s_nop 0
    v_cvt_pk_bf16_f32 v42, v104, v105
    v_fma_f32 v106, v106, s28, v13
    v_fma_f32 v107, v107, s28, v13
    v_exp_f32 v106, v106
    v_exp_f32 v107, v107
    s_nop 0
    v_cvt_pk_bf16_f32 v43, v106, v107
    v_fma_f32 v108, v108, s28, v13
    v_fma_f32 v109, v109, s28, v13
    v_exp_f32 v108, v108
    v_exp_f32 v109, v109
    s_nop 0
    v_cvt_pk_bf16_f32 v40, v108, v109
    v_fma_f32 v110, v110, s28, v13
    v_fma_f32 v111, v111, s28, v13
    v_exp_f32 v110, v110
    v_exp_f32 v111, v111
    s_nop 0
    v_cvt_pk_bf16_f32 v41, v110, v111
    v_mfma_f32_16x16x32_bf16 v[48:51], a[236:239], v[16:19], v[44:47]
    v_mfma_f32_16x16x32_bf16 v[48:51], a[240:243], v[22:25], v[48:51]
    v_mfma_f32_16x16x32_bf16 v[48:51], a[244:247], v[28:31], v[48:51]
    v_mfma_f32_16x16x32_bf16 v[48:51], a[248:251], v[34:37], v[48:51]
    v_mfma_f32_16x16x32_bf16 v[48:51], a[252:255], v[40:43], v[48:51]
    s_nop 15
    s_setpc_b64 s[40:41]
L_rare4_0:
    s_nop 15
    v_mbcnt_lo_u32_b32 v31, -1, 0
    v_mbcnt_hi_u32_b32 v31, -1, v31
    v_and_b32 v30, 15, v31
    v_mul_u32_u24 v30, 384, v30
    v_lshrrev_b32 v31, 4, v31
    v_lshl_add_u32 v30, v31, 4, v30
    s_add_u32 s69, s39, 0
    buffer_load_dwordx4 v[44:47], v30, s[4:7], s69 offen offset:0
    s_waitcnt vmcnt(0)
    v_mfma_f32_16x16x32_bf16 v[104:107], v[44:47], a[96:99], 0
    s_nop 7
    buffer_load_dwordx4 v[44:47], v30, s[4:7], s69 offen offset:64
    s_waitcnt vmcnt(0)
    v_mfma_f32_16x16x32_bf16 v[104:107], v[44:47], a[100:103], v[104:107]
    s_nop 7
    buffer_load_dwordx4 v[44:47], v30, s[4:7], s69 offen offset:128
    s_waitcnt vmcnt(0)
    v_mfma_f32_16x16x32_bf16 v[104:107], v[44:47], a[104:107], v[104:107]
    s_nop 7
    buffer_load_dwordx4 v[44:47], v30, s[4:7], s69 offen offset:192
    s_waitcnt vmcnt(0)
    v_mfma_f32_16x16x32_bf16 v[104:107], v[44:47], a[108:111], v[104:107]
    s_nop 7
    buffer_load_dwordx4 v[44:47], v30, s[4:7], s69 offen offset:256
    s_waitcnt vmcnt(0)
    v_mfma_f32_16x16x32_bf16 v[104:107], v[44:47], a[112:115], v[104:107]
    s_nop 7
    buffer_load_dwordx4 v[44:47], v30, s[4:7], s69 offen offset:320
    s_waitcnt vmcnt(0)
    v_mfma_f32_16x16x32_bf16 v[104:107], v[44:47], a[116:119], v[104:107]
    s_nop 7
    s_add_u32 s69, s39, 6144
    buffer_load_dwordx4 v[44:47], v30, s[4:7], s69 offen offset:0
    s_waitcnt vmcnt(0)
    v_mfma_f32_16x16x32_bf16 v[108:111], v[44:47], a[96:99], 0
    s_nop 7
    buffer_load_dwordx4 v[44:47], v30, s[4:7], s69 offen offset:64
    s_waitcnt vmcnt(0)
    v_mfma_f32_16x16x32_bf16 v[108:111], v[44:47], a[100:103], v[108:111]
    s_nop 7
    buffer_load_dwordx4 v[44:47], v30, s[4:7], s69 offen offset:128
    s_waitcnt vmcnt(0)
    v_mfma_f32_16x16x32_bf16 v[108:111], v[44:47], a[104:107], v[108:111]
    s_nop 7
    buffer_load_dwordx4 v[44:47], v30, s[4:7], s69 offen offset:192
    s_waitcnt vmcnt(0)
    v_mfma_f32_16x16x32_bf16 v[108:111], v[44:47], a[108:111], v[108:111]
    s_nop 7
    buffer_load_dwordx4 v[44:47], v30, s[4:7], s69 offen offset:256
    s_waitcnt vmcnt(0)
    v_mfma_f32_16x16x32_bf16 v[108:111], v[44:47], a[112:115], v[108:111]
    s_nop 7
    buffer_load_dwordx4 v[44:47], v30, s[4:7], s69 offen offset:320
    s_waitcnt vmcnt(0)
    v_mfma_f32_16x16x32_bf16 v[108:111], v[44:47], a[116:119], v[108:111]
    s_nop 7
    s_nop 15
    v_max3_f32 v18, v104, v105, v106
    v_max3_f32 v18, v18, v107, v108
    v_max3_f32 v18, v18, v109, v110
    v_max_f32 v18, v18, v111
    v_mov_b32 v19, v18
    s_nop 1
    v_permlane32_swap_b32 v19, v18
    v_max_f32 v18, v18, v19
    v_mov_b32 v19, v18
    s_nop 1
    v_permlane16_swap_b32 v19, v18
    v_max_f32 v18, v18, v19
    v_fma_f32 v18, v18, s28, v9
    v_max_f32 v24, 0, v18
    v_sub_f32 v9, v9, v24
    v_sub_f32 v25, 0, v24
    v_exp_f32 v25, v25
    s_nop 0
    v_mul_f32 v19, v48, v25
    v_cndmask_b32_e64 v48, v19, v48, s[60:61]
    v_cndmask_b32_e64 v48, v48, 0, s[46:47]
    v_mul_f32 v112, v112, v25
    v_mul_f32 v113, v113, v25
    v_mul_f32 v114, v114, v25
    v_mul_f32 v115, v115, v25
    v_mul_f32 v116, v116, v25
    v_mul_f32 v117, v117, v25
    v_mul_f32 v118, v118, v25
    v_mul_f32 v119, v119, v25
    v_mul_f32 v120, v120, v25
    v_mul_f32 v121, v121, v25
    v_mul_f32 v122, v122, v25
    v_mul_f32 v123, v123, v25
    v_mul_f32 v124, v124, v25
    v_mul_f32 v125, v125, v25
    v_mul_f32 v126, v126, v25
    v_mul_f32 v127, v127, v25
    v_mul_f32 v128, v128, v25
    v_mul_f32 v129, v129, v25
    v_mul_f32 v130, v130, v25
    v_mul_f32 v131, v131, v25
    v_mul_f32 v132, v132, v25
    v_mul_f32 v133, v133, v25
    v_mul_f32 v134, v134, v25
    v_mul_f32 v135, v135, v25
    v_mul_f32 v136, v136, v25
    v_mul_f32 v137, v137, v25
    v_mul_f32 v138, v138, v25
    v_mul_f32 v139, v139, v25
    v_mul_f32 v140, v140, v25
    v_mul_f32 v141, v141, v25
    v_mul_f32 v142, v142, v25
    v_mul_f32 v143, v143, v25
    v_mul_f32 v144, v144, v25
    v_mul_f32 v145, v145, v25
    v_mul_f32 v146, v146, v25
    v_mul_f32 v147, v147, v25
    v_mul_f32 v148, v148, v25
    v_mul_f32 v149, v149, v25
    v_mul_f32 v150, v150, v25
    v_mul_f32 v151, v151, v25
    v_mul_f32 v152, v152, v25
    v_mul_f32 v153, v153, v25
    v_mul_f32 v154, v154, v25
    v_mul_f32 v155, v155, v25
    v_mul_f32 v156, v156, v25
    v_mul_f32 v157, v157, v25
    v_mul_f32 v158, v158, v25
    v_mul_f32 v159, v159, v25
    v_fma_f32 v104, v104, s28, v9
    v_fma_f32 v105, v105, s28, v9
    v_exp_f32 v104, v104
    v_exp_f32 v105, v105
    s_nop 0
    v_cvt_pk_bf16_f32 v14, v104, v105
    v_fma_f32 v106, v106, s28, v9
    v_fma_f32 v107, v107, s28, v9
    v_exp_f32 v106, v106
    v_exp_f32 v107, v107
    s_nop 0
    v_cvt_pk_bf16_f32 v15, v106, v107
    v_fma_f32 v108, v108, s28, v9
    v_fma_f32 v109, v109, s28, v9
    v_exp_f32 v108, v108
    v_exp_f32 v109, v109
    s_nop 0
    v_cvt_pk_bf16_f32 v16, v108, v109
    v_fma_f32 v110, v110, s28, v9
    v_fma_f32 v111, v111, s28, v9
    v_exp_f32 v110, v110
    v_exp_f32 v111, v111
    s_nop 0
    v_cvt_pk_bf16_f32 v17, v110, v111
    s_add_u32 s69, s39, 0
    buffer_load_dwordx4 v[44:47], v30, s[4:7], s69 offen offset:0
    s_waitcnt vmcnt(0)
    v_mfma_f32_16x16x32_bf16 v[104:107], v[44:47], a[120:123], 0
    s_nop 7
    buffer_load_dwordx4 v[44:47], v30, s[4:7], s69 offen offset:64
    s_waitcnt vmcnt(0)
    v_mfma_f32_16x16x32_bf16 v[104:107], v[44:47], a[124:127], v[104:107]
    s_nop 7
    buffer_load_dwordx4 v[44:47], v30, s[4:7], s69 offen offset:128
    s_waitcnt vmcnt(0)
    v_mfma_f32_16x16x32_bf16 v[104:107], v[44:47], a[128:131], v[104:107]
    s_nop 7
    buffer_load_dwordx4 v[44:47], v30, s[4:7], s69 offen offset:192
    s_waitcnt vmcnt(0)
    v_mfma_f32_16x16x32_bf16 v[104:107], v[44:47], a[132:135], v[104:107]
    s_nop 7
    buffer_load_dwordx4 v[44:47], v30, s[4:7], s69 offen offset:256
    s_waitcnt vmcnt(0)
    v_mfma_f32_16x16x32_bf16 v[104:107], v[44:47], a[136:139], v[104:107]
    s_nop 7
    buffer_load_dwordx4 v[44:47], v30, s[4:7], s69 offen offset:320
    s_waitcnt vmcnt(0)
    v_mfma_f32_16x16x32_bf16 v[104:107], v[44:47], a[140:143], v[104:107]
    s_nop 7
    s_add_u32 s69, s39, 6144
    buffer_load_dwordx4 v[44:47], v30, s[4:7], s69 offen offset:0
    s_waitcnt vmcnt(0)
    v_mfma_f32_16x16x32_bf16 v[108:111], v[44:47], a[120:123], 0
    s_nop 7
    buffer_load_dwordx4 v[44:47], v30, s[4:7], s69 offen offset:64
    s_waitcnt vmcnt(0)
    v_mfma_f32_16x16x32_bf16 v[108:111], v[44:47], a[124:127], v[108:111]
    s_nop 7
    buffer_load_dwordx4 v[44:47], v30, s[4:7], s69 offen offset:128
    s_waitcnt vmcnt(0)
    v_mfma_f32_16x16x32_bf16 v[108:111], v[44:47], a[128:131], v[108:111]
    s_nop 7
    buffer_load_dwordx4 v[44:47], v30, s[4:7], s69 offen offset:192
    s_waitcnt vmcnt(0)
    v_mfma_f32_16x16x32_bf16 v[108:111], v[44:47], a[132:135], v[108:111]
    s_nop 7
    buffer_load_dwordx4 v[44:47], v30, s[4:7], s69 offen offset:256
    s_waitcnt vmcnt(0)
    v_mfma_f32_16x16x32_bf16 v[108:111], v[44:47], a[136:139], v[108:111]
    s_nop 7
    buffer_load_dwordx4 v[44:47], v30, s[4:7], s69 offen offset:320
    s_waitcnt vmcnt(0)
    v_mfma_f32_16x16x32_bf16 v[108:111], v[44:47], a[140:143], v[108:111]
    s_nop 7
    s_nop 15
    v_max3_f32 v18, v104, v105, v106
    v_max3_f32 v18, v18, v107, v108
    v_max3_f32 v18, v18, v109, v110
    v_max_f32 v18, v18, v111
    v_mov_b32 v19, v18
    s_nop 1
    v_permlane32_swap_b32 v19, v18
    v_max_f32 v18, v18, v19
    v_mov_b32 v19, v18
    s_nop 1
    v_permlane16_swap_b32 v19, v18
    v_max_f32 v18, v18, v19
    v_fma_f32 v18, v18, s28, v10
    v_max_f32 v24, 0, v18
    v_sub_f32 v10, v10, v24
    v_sub_f32 v25, 0, v24
    v_exp_f32 v25, v25
    s_nop 0
    v_mul_f32 v49, v49, v25
    v_mul_f32 v160, v160, v25
    v_mul_f32 v161, v161, v25
    v_mul_f32 v162, v162, v25
    v_mul_f32 v163, v163, v25
    v_mul_f32 v164, v164, v25
    v_mul_f32 v165, v165, v25
    v_mul_f32 v166, v166, v25
    v_mul_f32 v167, v167, v25
    v_mul_f32 v168, v168, v25
    v_mul_f32 v169, v169, v25
    v_mul_f32 v170, v170, v25
    v_mul_f32 v171, v171, v25
    v_mul_f32 v172, v172, v25
    v_mul_f32 v173, v173, v25
    v_mul_f32 v174, v174, v25
    v_mul_f32 v175, v175, v25
    v_mul_f32 v176, v176, v25
    v_mul_f32 v177, v177, v25
    v_mul_f32 v178, v178, v25
    v_mul_f32 v179, v179, v25
    v_mul_f32 v180, v180, v25
    v_mul_f32 v181, v181, v25
    v_mul_f32 v182, v182, v25
    v_mul_f32 v183, v183, v25
    v_mul_f32 v184, v184, v25
    v_mul_f32 v185, v185, v25
    v_mul_f32 v186, v186, v25
    v_mul_f32 v187, v187, v25
    v_mul_f32 v188, v188, v25
    v_mul_f32 v189, v189, v25
    v_mul_f32 v190, v190, v25
    v_mul_f32 v191, v191, v25
    v_mul_f32 v192, v192, v25
    v_mul_f32 v193, v193, v25
    v_mul_f32 v194, v194, v25
    v_mul_f32 v195, v195, v25
    v_mul_f32 v196, v196, v25
    v_mul_f32 v197, v197, v25
    v_mul_f32 v198, v198, v25
    v_mul_f32 v199, v199, v25
    v_mul_f32 v200, v200, v25
    v_mul_f32 v201, v201, v25
    v_mul_f32 v202, v202, v25
    v_mul_f32 v203, v203, v25
    v_mul_f32 v204, v204, v25
    v_mul_f32 v205, v205, v25
    v_mul_f32 v206, v206, v25
    v_mul_f32 v207, v207, v25
    v_fma_f32 v104, v104, s28, v10
    v_fma_f32 v105, v105, s28, v10
    v_exp_f32 v104, v104
    v_exp_f32 v105, v105
    s_nop 0
    v_cvt_pk_bf16_f32 v20, v104, v105
    v_fma_f32 v106, v106, s28, v10
    v_fma_f32 v107, v107, s28, v10
    v_exp_f32 v106, v106
    v_exp_f32 v107, v107
    s_nop 0
    v_cvt_pk_bf16_f32 v21, v106, v107
    v_fma_f32 v108, v108, s28, v10
    v_fma_f32 v109, v109, s28, v10
    v_exp_f32 v108, v108
    v_exp_f32 v109, v109
    s_nop 0
    v_cvt_pk_bf16_f32 v22, v108, v109
    v_fma_f32 v110, v110, s28, v10
    v_fma_f32 v111, v111, s28, v10
    v_exp_f32 v110, v110
    v_exp_f32 v111, v111
    s_nop 0
    v_cvt_pk_bf16_f32 v23, v110, v111
    s_add_u32 s69, s39, 0
    buffer_load_dwordx4 v[44:47], v30, s[4:7], s69 offen offset:0
    s_waitcnt vmcnt(0)
    v_mfma_f32_16x16x32_bf16 v[104:107], v[44:47], a[144:147], 0
    s_nop 7
    buffer_load_dwordx4 v[44:47], v30, s[4:7], s69 offen offset:64
    s_waitcnt vmcnt(0)
    v_mfma_f32_16x16x32_bf16 v[104:107], v[44:47], a[148:151], v[104:107]
    s_nop 7
    buffer_load_dwordx4 v[44:47], v30, s[4:7], s69 offen offset:128
    s_waitcnt vmcnt(0)
    v_mfma_f32_16x16x32_bf16 v[104:107], v[44:47], a[152:155], v[104:107]
    s_nop 7
    buffer_load_dwordx4 v[44:47], v30, s[4:7], s69 offen offset:192
    s_waitcnt vmcnt(0)
    v_mfma_f32_16x16x32_bf16 v[104:107], v[44:47], a[156:159], v[104:107]
    s_nop 7
    buffer_load_dwordx4 v[44:47], v30, s[4:7], s69 offen offset:256
    s_waitcnt vmcnt(0)
    v_mfma_f32_16x16x32_bf16 v[104:107], v[44:47], a[160:163], v[104:107]
    s_nop 7
    buffer_load_dwordx4 v[44:47], v30, s[4:7], s69 offen offset:320
    s_waitcnt vmcnt(0)
    v_mfma_f32_16x16x32_bf16 v[104:107], v[44:47], a[164:167], v[104:107]
    s_nop 7
    s_add_u32 s69, s39, 6144
    buffer_load_dwordx4 v[44:47], v30, s[4:7], s69 offen offset:0
    s_waitcnt vmcnt(0)
    v_mfma_f32_16x16x32_bf16 v[108:111], v[44:47], a[144:147], 0
    s_nop 7
    buffer_load_dwordx4 v[44:47], v30, s[4:7], s69 offen offset:64
    s_waitcnt vmcnt(0)
    v_mfma_f32_16x16x32_bf16 v[108:111], v[44:47], a[148:151], v[108:111]
    s_nop 7
    buffer_load_dwordx4 v[44:47], v30, s[4:7], s69 offen offset:128
    s_waitcnt vmcnt(0)
    v_mfma_f32_16x16x32_bf16 v[108:111], v[44:47], a[152:155], v[108:111]
    s_nop 7
    buffer_load_dwordx4 v[44:47], v30, s[4:7], s69 offen offset:192
    s_waitcnt vmcnt(0)
    v_mfma_f32_16x16x32_bf16 v[108:111], v[44:47], a[156:159], v[108:111]
    s_nop 7
    buffer_load_dwordx4 v[44:47], v30, s[4:7], s69 offen offset:256
    s_waitcnt vmcnt(0)
    v_mfma_f32_16x16x32_bf16 v[108:111], v[44:47], a[160:163], v[108:111]
    s_nop 7
    buffer_load_dwordx4 v[44:47], v30, s[4:7], s69 offen offset:320
    s_waitcnt vmcnt(0)
    v_mfma_f32_16x16x32_bf16 v[108:111], v[44:47], a[164:167], v[108:111]
    s_nop 7
    s_nop 15
    v_max3_f32 v18, v104, v105, v106
    v_max3_f32 v18, v18, v107, v108
    v_max3_f32 v18, v18, v109, v110
    v_max_f32 v18, v18, v111
    v_mov_b32 v19, v18
    s_nop 1
    v_permlane32_swap_b32 v19, v18
    v_max_f32 v18, v18, v19
    v_mov_b32 v19, v18
    s_nop 1
    v_permlane16_swap_b32 v19, v18
    v_max_f32 v18, v18, v19
    v_fma_f32 v18, v18, s28, v11
    v_max_f32 v24, 0, v18
    v_sub_f32 v11, v11, v24
    v_sub_f32 v25, 0, v24
    v_exp_f32 v25, v25
    s_nop 0
    v_mul_f32 v50, v50, v25
    v_mul_f32 v208, v208, v25
    v_mul_f32 v209, v209, v25
    v_mul_f32 v210, v210, v25
    v_mul_f32 v211, v211, v25
    v_mul_f32 v212, v212, v25
    v_mul_f32 v213, v213, v25
    v_mul_f32 v214, v214, v25
    v_mul_f32 v215, v215, v25
    v_mul_f32 v216, v216, v25
    v_mul_f32 v217, v217, v25
    v_mul_f32 v218, v218, v25
    v_mul_f32 v219, v219, v25
    v_mul_f32 v220, v220, v25
    v_mul_f32 v221, v221, v25
    v_mul_f32 v222, v222, v25
    v_mul_f32 v223, v223, v25
    v_mul_f32 v224, v224, v25
    v_mul_f32 v225, v225, v25
    v_mul_f32 v226, v226, v25
    v_mul_f32 v227, v227, v25
    v_mul_f32 v228, v228, v25
    v_mul_f32 v229, v229, v25
    v_mul_f32 v230, v230, v25
    v_mul_f32 v231, v231, v25
    v_mul_f32 v232, v232, v25
    v_mul_f32 v233, v233, v25
    v_mul_f32 v234, v234, v25
    v_mul_f32 v235, v235, v25
    v_mul_f32 v236, v236, v25
    v_mul_f32 v237, v237, v25
    v_mul_f32 v238, v238, v25
    v_mul_f32 v239, v239, v25
    v_mul_f32 v240, v240, v25
    v_mul_f32 v241, v241, v25
    v_mul_f32 v242, v242, v25
    v_mul_f32 v243, v243, v25
    v_mul_f32 v244, v244, v25
    v_mul_f32 v245, v245, v25
    v_mul_f32 v246, v246, v25
    v_mul_f32 v247, v247, v25
    v_mul_f32 v248, v248, v25
    v_mul_f32 v249, v249, v25
    v_mul_f32 v250, v250, v25
    v_mul_f32 v251, v251, v25
    v_mul_f32 v252, v252, v25
    v_mul_f32 v253, v253, v25
    v_mul_f32 v254, v254, v25
    v_mul_f32 v255, v255, v25
    v_fma_f32 v104, v104, s28, v11
    v_fma_f32 v105, v105, s28, v11
    v_exp_f32 v104, v104
    v_exp_f32 v105, v105
    s_nop 0
    v_cvt_pk_bf16_f32 v26, v104, v105
    v_fma_f32 v106, v106, s28, v11
    v_fma_f32 v107, v107, s28, v11
    v_exp_f32 v106, v106
    v_exp_f32 v107, v107
    s_nop 0
    v_cvt_pk_bf16_f32 v27, v106, v107
    v_fma_f32 v108, v108, s28, v11
    v_fma_f32 v109, v109, s28, v11
    v_exp_f32 v108, v108
    v_exp_f32 v109, v109
    s_nop 0
    v_cvt_pk_bf16_f32 v28, v108, v109
    v_fma_f32 v110, v110, s28, v11
    v_fma_f32 v111, v111, s28, v11
    v_exp_f32 v110, v110
    v_exp_f32 v111, v111
    s_nop 0
    v_cvt_pk_bf16_f32 v29, v110, v111
    s_add_u32 s69, s39, 0
    buffer_load_dwordx4 v[44:47], v30, s[4:7], s69 offen offset:0
    s_waitcnt vmcnt(0)
    v_mfma_f32_16x16x32_bf16 v[104:107], v[44:47], a[168:171], 0
    s_nop 7
    buffer_load_dwordx4 v[44:47], v30, s[4:7], s69 offen offset:64
    s_waitcnt vmcnt(0)
    v_mfma_f32_16x16x32_bf16 v[104:107], v[44:47], a[172:175], v[104:107]
    s_nop 7
    buffer_load_dwordx4 v[44:47], v30, s[4:7], s69 offen offset:128
    s_waitcnt vmcnt(0)
    v_mfma_f32_16x16x32_bf16 v[104:107], v[44:47], a[176:179], v[104:107]
    s_nop 7
    buffer_load_dwordx4 v[44:47], v30, s[4:7], s69 offen offset:192
    s_waitcnt vmcnt(0)
    v_mfma_f32_16x16x32_bf16 v[104:107], v[44:47], a[180:183], v[104:107]
    s_nop 7
    buffer_load_dwordx4 v[44:47], v30, s[4:7], s69 offen offset:256
    s_waitcnt vmcnt(0)
    v_mfma_f32_16x16x32_bf16 v[104:107], v[44:47], a[184:187], v[104:107]
    s_nop 7
    buffer_load_dwordx4 v[44:47], v30, s[4:7], s69 offen offset:320
    s_waitcnt vmcnt(0)
    v_mfma_f32_16x16x32_bf16 v[104:107], v[44:47], a[188:191], v[104:107]
    s_nop 7
    s_add_u32 s69, s39, 6144
    buffer_load_dwordx4 v[44:47], v30, s[4:7], s69 offen offset:0
    s_waitcnt vmcnt(0)
    v_mfma_f32_16x16x32_bf16 v[108:111], v[44:47], a[168:171], 0
    s_nop 7
    buffer_load_dwordx4 v[44:47], v30, s[4:7], s69 offen offset:64
    s_waitcnt vmcnt(0)
    v_mfma_f32_16x16x32_bf16 v[108:111], v[44:47], a[172:175], v[108:111]
    s_nop 7
    buffer_load_dwordx4 v[44:47], v30, s[4:7], s69 offen offset:128
    s_waitcnt vmcnt(0)
    v_mfma_f32_16x16x32_bf16 v[108:111], v[44:47], a[176:179], v[108:111]
    s_nop 7
    buffer_load_dwordx4 v[44:47], v30, s[4:7], s69 offen offset:192
    s_waitcnt vmcnt(0)
    v_mfma_f32_16x16x32_bf16 v[108:111], v[44:47], a[180:183], v[108:111]
    s_nop 7
    buffer_load_dwordx4 v[44:47], v30, s[4:7], s69 offen offset:256
    s_waitcnt vmcnt(0)
    v_mfma_f32_16x16x32_bf16 v[108:111], v[44:47], a[184:187], v[108:111]
    s_nop 7
    buffer_load_dwordx4 v[44:47], v30, s[4:7], s69 offen offset:320
    s_waitcnt vmcnt(0)
    v_mfma_f32_16x16x32_bf16 v[108:111], v[44:47], a[188:191], v[108:111]
    s_nop 7
    s_nop 15
    v_max3_f32 v18, v104, v105, v106
    v_max3_f32 v18, v18, v107, v108
    v_max3_f32 v18, v18, v109, v110
    v_max_f32 v18, v18, v111
    v_mov_b32 v19, v18
    s_nop 1
    v_permlane32_swap_b32 v19, v18
    v_max_f32 v18, v18, v19
    v_mov_b32 v19, v18
    s_nop 1
    v_permlane16_swap_b32 v19, v18
    v_max_f32 v18, v18, v19
    v_fma_f32 v18, v18, s28, v12
    v_max_f32 v24, 0, v18
    v_sub_f32 v12, v12, v24
    v_sub_f32 v25, 0, v24
    v_exp_f32 v25, v25
    s_nop 0
    v_mul_f32 v51, v51, v25
    v_accvgpr_read_b32 v19, a0
    v_mul_f32 v19, v19, v25
    v_accvgpr_write_b32 a0, v19
    v_accvgpr_read_b32 v19, a1
    v_mul_f32 v19, v19, v25
    v_accvgpr_write_b32 a1, v19
    v_accvgpr_read_b32 v19, a2
    v_mul_f32 v19, v19, v25
    v_accvgpr_write_b32 a2, v19
    v_accvgpr_read_b32 v19, a3
    v_mul_f32 v19, v19, v25
    v_accvgpr_write_b32 a3, v19
    v_accvgpr_read_b32 v19, a4
    v_mul_f32 v19, v19, v25
    v_accvgpr_write_b32 a4, v19
    v_accvgpr_read_b32 v19, a5
    v_mul_f32 v19, v19, v25
    v_accvgpr_write_b32 a5, v19
    v_accvgpr_read_b32 v19, a6
    v_mul_f32 v19, v19, v25
    v_accvgpr_write_b32 a6, v19
    v_accvgpr_read_b32 v19, a7
    v_mul_f32 v19, v19, v25
    v_accvgpr_write_b32 a7, v19
    v_accvgpr_read_b32 v19, a8
    v_mul_f32 v19, v19, v25
    v_accvgpr_write_b32 a8, v19
    v_accvgpr_read_b32 v19, a9
    v_mul_f32 v19, v19, v25
    v_accvgpr_write_b32 a9, v19
    v_accvgpr_read_b32 v19, a10
    v_mul_f32 v19, v19, v25
    v_accvgpr_write_b32 a10, v19
    v_accvgpr_read_b32 v19, a11
    v_mul_f32 v19, v19, v25
    v_accvgpr_write_b32 a11, v19
    v_accvgpr_read_b32 v19, a12
    v_mul_f32 v19, v19, v25
    v_accvgpr_write_b32 a12, v19
    v_accvgpr_read_b32 v19, a13
    v_mul_f32 v19, v19, v25
    v_accvgpr_write_b32 a13, v19
    v_accvgpr_read_b32 v19, a14
    v_mul_f32 v19, v19, v25
    v_accvgpr_write_b32 a14, v19
    v_accvgpr_read_b32 v19, a15
    v_mul_f32 v19, v19, v25
    v_accvgpr_write_b32 a15, v19
    v_accvgpr_read_b32 v19, a16
    v_mul_f32 v19, v19, v25
    v_accvgpr_write_b32 a16, v19
    v_accvgpr_read_b32 v19, a17
    v_mul_f32 v19, v19, v25
    v_accvgpr_write_b32 a17, v19
    v_accvgpr_read_b32 v19, a18
    v_mul_f32 v19, v19, v25
    v_accvgpr_write_b32 a18, v19
    v_accvgpr_read_b32 v19, a19
    v_mul_f32 v19, v19, v25
    v_accvgpr_write_b32 a19, v19
    v_accvgpr_read_b32 v19, a20
    v_mul_f32 v19, v19, v25
    v_accvgpr_write_b32 a20, v19
    v_accvgpr_read_b32 v19, a21
    v_mul_f32 v19, v19, v25
    v_accvgpr_write_b32 a21, v19
    v_accvgpr_read_b32 v19, a22
    v_mul_f32 v19, v19, v25
    v_accvgpr_write_b32 a22, v19
    v_accvgpr_read_b32 v19, a23
    v_mul_f32 v19, v19, v25
    v_accvgpr_write_b32 a23, v19
    v_accvgpr_read_b32 v19, a24
    v_mul_f32 v19, v19, v25
    v_accvgpr_write_b32 a24, v19
    v_accvgpr_read_b32 v19, a25
    v_mul_f32 v19, v19, v25
    v_accvgpr_write_b32 a25, v19
    v_accvgpr_read_b32 v19, a26
    v_mul_f32 v19, v19, v25
    v_accvgpr_write_b32 a26, v19
    v_accvgpr_read_b32 v19, a27
    v_mul_f32 v19, v19, v25
    v_accvgpr_write_b32 a27, v19
    v_accvgpr_read_b32 v19, a28
    v_mul_f32 v19, v19, v25
    v_accvgpr_write_b32 a28, v19
    v_accvgpr_read_b32 v19, a29
    v_mul_f32 v19, v19, v25
    v_accvgpr_write_b32 a29, v19
    v_accvgpr_read_b32 v19, a30
    v_mul_f32 v19, v19, v25
    v_accvgpr_write_b32 a30, v19
    v_accvgpr_read_b32 v19, a31
    v_mul_f32 v19, v19, v25
    v_accvgpr_write_b32 a31, v19
    v_accvgpr_read_b32 v19, a32
    v_mul_f32 v19, v19, v25
    v_accvgpr_write_b32 a32, v19
    v_accvgpr_read_b32 v19, a33
    v_mul_f32 v19, v19, v25
    v_accvgpr_write_b32 a33, v19
    v_accvgpr_read_b32 v19, a34
    v_mul_f32 v19, v19, v25
    v_accvgpr_write_b32 a34, v19
    v_accvgpr_read_b32 v19, a35
    v_mul_f32 v19, v19, v25
    v_accvgpr_write_b32 a35, v19
    v_accvgpr_read_b32 v19, a36
    v_mul_f32 v19, v19, v25
    v_accvgpr_write_b32 a36, v19
    v_accvgpr_read_b32 v19, a37
    v_mul_f32 v19, v19, v25
    v_accvgpr_write_b32 a37, v19
    v_accvgpr_read_b32 v19, a38
    v_mul_f32 v19, v19, v25
    v_accvgpr_write_b32 a38, v19
    v_accvgpr_read_b32 v19, a39
    v_mul_f32 v19, v19, v25
    v_accvgpr_write_b32 a39, v19
    v_accvgpr_read_b32 v19, a40
    v_mul_f32 v19, v19, v25
    v_accvgpr_write_b32 a40, v19
    v_accvgpr_read_b32 v19, a41
    v_mul_f32 v19, v19, v25
    v_accvgpr_write_b32 a41, v19
    v_accvgpr_read_b32 v19, a42
    v_mul_f32 v19, v19, v25
    v_accvgpr_write_b32 a42, v19
    v_accvgpr_read_b32 v19, a43
    v_mul_f32 v19, v19, v25
    v_accvgpr_write_b32 a43, v19
    v_accvgpr_read_b32 v19, a44
    v_mul_f32 v19, v19, v25
    v_accvgpr_write_b32 a44, v19
    v_accvgpr_read_b32 v19, a45
    v_mul_f32 v19, v19, v25
    v_accvgpr_write_b32 a45, v19
    v_accvgpr_read_b32 v19, a46
    v_mul_f32 v19, v19, v25
    v_accvgpr_write_b32 a46, v19
    v_accvgpr_read_b32 v19, a47
    v_mul_f32 v19, v19, v25
    v_accvgpr_write_b32 a47, v19
    v_fma_f32 v104, v104, s28, v12
    v_fma_f32 v105, v105, s28, v12
    v_exp_f32 v104, v104
    v_exp_f32 v105, v105
    s_nop 0
    v_cvt_pk_bf16_f32 v32, v104, v105
    v_fma_f32 v106, v106, s28, v12
    v_fma_f32 v107, v107, s28, v12
    v_exp_f32 v106, v106
    v_exp_f32 v107, v107
    s_nop 0
    v_cvt_pk_bf16_f32 v33, v106, v107
    v_fma_f32 v108, v108, s28, v12
    v_fma_f32 v109, v109, s28, v12
    v_exp_f32 v108, v108
    v_exp_f32 v109, v109
    s_nop 0
    v_cvt_pk_bf16_f32 v34, v108, v109
    v_fma_f32 v110, v110, s28, v12
    v_fma_f32 v111, v111, s28, v12
    v_exp_f32 v110, v110
    v_exp_f32 v111, v111
    s_nop 0
    v_cvt_pk_bf16_f32 v35, v110, v111
    v_mfma_f32_16x16x32_bf16 v[44:47], a[236:239], v[14:17], v[48:51]
    v_mfma_f32_16x16x32_bf16 v[44:47], a[240:243], v[20:23], v[44:47]
    v_mfma_f32_16x16x32_bf16 v[44:47], a[244:247], v[26:29], v[44:47]
    v_mfma_f32_16x16x32_bf16 v[44:47], a[248:251], v[32:35], v[44:47]
    s_nop 15
    s_setpc_b64 s[40:41]
L_rare4_1:
    s_nop 15
    v_mbcnt_lo_u32_b32 v27, -1, 0
    v_mbcnt_hi_u32_b32 v27, -1, v27
    v_and_b32 v26, 15, v27
    v_mul_u32_u24 v26, 384, v26
    v_lshrrev_b32 v27, 4, v27
    v_lshl_add_u32 v26, v27, 4, v26
    s_add_u32 s69, s39, 0
    buffer_load_dwordx4 v[48:51], v26, s[4:7], s69 offen offset:0
    s_waitcnt vmcnt(0)
    v_mfma_f32_16x16x32_bf16 v[104:107], v[48:51], a[96:99], 0
    s_nop 7
    buffer_load_dwordx4 v[48:51], v26, s[4:7], s69 offen offset:64
    s_waitcnt vmcnt(0)
    v_mfma_f32_16x16x32_bf16 v[104:107], v[48:51], a[100:103], v[104:107]
    s_nop 7
    buffer_load_dwordx4 v[48:51], v26, s[4:7], s69 offen offset:128
    s_waitcnt vmcnt(0)
    v_mfma_f32_16x16x32_bf16 v[104:107], v[48:51], a[104:107], v[104:107]
    s_nop 7
    buffer_load_dwordx4 v[48:51], v26, s[4:7], s69 offen offset:192
    s_waitcnt vmcnt(0)
    v_mfma_f32_16x16x32_bf16 v[104:107], v[48:51], a[108:111], v[104:107]
    s_nop 7
    buffer_load_dwordx4 v[48:51], v26, s[4:7], s69 offen offset:256
    s_waitcnt vmcnt(0)
    v_mfma_f32_16x16x32_bf16 v[104:107], v[48:51], a[112:115], v[104:107]
    s_nop 7
    buffer_load_dwordx4 v[48:51], v26, s[4:7], s69 offen offset:320
    s_waitcnt vmcnt(0)
    v_mfma_f32_16x16x32_bf16 v[104:107], v[48:51], a[116:119], v[104:107]
    s_nop 7
    s_add_u32 s69, s39, 6144
    buffer_load_dwordx4 v[48:51], v26, s[4:7], s69 offen offset:0
    s_waitcnt vmcnt(0)
    v_mfma_f32_16x16x32_bf16 v[108:111], v[48:51], a[96:99], 0
    s_nop 7
    buffer_load_dwordx4 v[48:51], v26, s[4:7], s69 offen offset:64
    s_waitcnt vmcnt(0)
    v_mfma_f32_16x16x32_bf16 v[108:111], v[48:51], a[100:103], v[108:111]
    s_nop 7
    buffer_load_dwordx4 v[48:51], v26, s[4:7], s69 offen offset:128
    s_waitcnt vmcnt(0)
    v_mfma_f32_16x16x32_bf16 v[108:111], v[48:51], a[104:107], v[108:111]
    s_nop 7
    buffer_load_dwordx4 v[48:51], v26, s[4:7], s69 offen offset:192
    s_waitcnt vmcnt(0)
    v_mfma_f32_16x16x32_bf16 v[108:111], v[48:51], a[108:111], v[108:111]
    s_nop 7
    buffer_load_dwordx4 v[48:51], v26, s[4:7], s69 offen offset:256
    s_waitcnt vmcnt(0)
    v_mfma_f32_16x16x32_bf16 v[108:111], v[48:51], a[112:115], v[108:111]
    s_nop 7
    buffer_load_dwordx4 v[48:51], v26, s[4:7], s69 offen offset:320
    s_waitcnt vmcnt(0)
    v_mfma_f32_16x16x32_bf16 v[108:111], v[48:51], a[116:119], v[108:111]
    s_nop 7
    s_nop 15
    v_max3_f32 v14, v104, v105, v106
    v_max3_f32 v14, v14, v107, v108
    v_max3_f32 v14, v14, v109, v110
    v_max_f32 v14, v14, v111
    v_mov_b32 v15, v14
    s_nop 1
    v_permlane32_swap_b32 v15, v14
    v_max_f32 v14, v14, v15
    v_mov_b32 v15, v14
    s_nop 1
    v_permlane16_swap_b32 v15, v14
    v_max_f32 v14, v14, v15
    v_fma_f32 v14, v14, s28, v9
    v_max_f32 v20, 0, v14
    v_sub_f32 v9, v9, v20
    v_sub_f32 v21, 0, v20
    v_exp_f32 v21, v21
    s_nop 0
    v_mul_f32 v15, v44, v21
    v_cndmask_b32_e64 v44, v15, v44, s[60:61]
    v_cndmask_b32_e64 v44, v44, 0, s[46:47]
    v_mul_f32 v112, v112, v21
    v_mul_f32 v113, v113, v21
    v_mul_f32 v114, v114, v21
    v_mul_f32 v115, v115, v21
    v_mul_f32 v116, v116, v21
    v_mul_f32 v117, v117, v21
    v_mul_f32 v118, v118, v21
    v_mul_f32 v119, v119, v21
    v_mul_f32 v120, v120, v21
    v_mul_f32 v121, v121, v21
    v_mul_f32 v122, v122, v21
    v_mul_f32 v123, v123, v21
    v_mul_f32 v124, v124, v21
    v_mul_f32 v125, v125, v21
    v_mul_f32 v126, v126, v21
    v_mul_f32 v127, v127, v21
    v_mul_f32 v128, v128, v21
    v_mul_f32 v129, v129, v21
    v_mul_f32 v130, v130, v21
    v_mul_f32 v131, v131, v21
    v_mul_f32 v132, v132, v21
    v_mul_f32 v133, v133, v21
    v_mul_f32 v134, v134, v21
    v_mul_f32 v135, v135, v21
    v_mul_f32 v136, v136, v21
    v_mul_f32 v137, v137, v21
    v_mul_f32 v138, v138, v21
    v_mul_f32 v139, v139, v21
    v_mul_f32 v140, v140, v21
    v_mul_f32 v141, v141, v21
    v_mul_f32 v142, v142, v21
    v_mul_f32 v143, v143, v21
    v_mul_f32 v144, v144, v21
    v_mul_f32 v145, v145, v21
    v_mul_f32 v146, v146, v21
    v_mul_f32 v147, v147, v21
    v_mul_f32 v148, v148, v21
    v_mul_f32 v149, v149, v21
    v_mul_f32 v150, v150, v21
    v_mul_f32 v151, v151, v21
    v_mul_f32 v152, v152, v21
    v_mul_f32 v153, v153, v21
    v_mul_f32 v154, v154, v21
    v_mul_f32 v155, v155, v21
    v_mul_f32 v156, v156, v21
    v_mul_f32 v157, v157, v21
    v_mul_f32 v158, v158, v21
    v_mul_f32 v159, v159, v21
    v_fma_f32 v104, v104, s28, v9
    v_fma_f32 v105, v105, s28, v9
    v_exp_f32 v104, v104
    v_exp_f32 v105, v105
    s_nop 0
    v_cvt_pk_bf16_f32 v18, v104, v105
    v_fma_f32 v106, v106, s28, v9
    v_fma_f32 v107, v107, s28, v9
    v_exp_f32 v106, v106
    v_exp_f32 v107, v107
    s_nop 0
    v_cvt_pk_bf16_f32 v19, v106, v107
    v_fma_f32 v108, v108, s28, v9
    v_fma_f32 v109, v109, s28, v9
    v_exp_f32 v108, v108
    v_exp_f32 v109, v109
    s_nop 0
    v_cvt_pk_bf16_f32 v16, v108, v109
    v_fma_f32 v110, v110, s28, v9
    v_fma_f32 v111, v111, s28, v9
    v_exp_f32 v110, v110
    v_exp_f32 v111, v111
    s_nop 0
    v_cvt_pk_bf16_f32 v17, v110, v111
    s_add_u32 s69, s39, 0
    buffer_load_dwordx4 v[48:51], v26, s[4:7], s69 offen offset:0
    s_waitcnt vmcnt(0)
    v_mfma_f32_16x16x32_bf16 v[104:107], v[48:51], a[120:123], 0
    s_nop 7
    buffer_load_dwordx4 v[48:51], v26, s[4:7], s69 offen offset:64
    s_waitcnt vmcnt(0)
    v_mfma_f32_16x16x32_bf16 v[104:107], v[48:51], a[124:127], v[104:107]
    s_nop 7
    buffer_load_dwordx4 v[48:51], v26, s[4:7], s69 offen offset:128
    s_waitcnt vmcnt(0)
    v_mfma_f32_16x16x32_bf16 v[104:107], v[48:51], a[128:131], v[104:107]
    s_nop 7
    buffer_load_dwordx4 v[48:51], v26, s[4:7], s69 offen offset:192
    s_waitcnt vmcnt(0)
    v_mfma_f32_16x16x32_bf16 v[104:107], v[48:51], a[132:135], v[104:107]
    s_nop 7
    buffer_load_dwordx4 v[48:51], v26, s[4:7], s69 offen offset:256
    s_waitcnt vmcnt(0)
    v_mfma_f32_16x16x32_bf16 v[104:107], v[48:51], a[136:139], v[104:107]
    s_nop 7
    buffer_load_dwordx4 v[48:51], v26, s[4:7], s69 offen offset:320
    s_waitcnt vmcnt(0)
    v_mfma_f32_16x16x32_bf16 v[104:107], v[48:51], a[140:143], v[104:107]
    s_nop 7
    s_add_u32 s69, s39, 6144
    buffer_load_dwordx4 v[48:51], v26, s[4:7], s69 offen offset:0
    s_waitcnt vmcnt(0)
    v_mfma_f32_16x16x32_bf16 v[108:111], v[48:51], a[120:123], 0
    s_nop 7
    buffer_load_dwordx4 v[48:51], v26, s[4:7], s69 offen offset:64
    s_waitcnt vmcnt(0)
    v_mfma_f32_16x16x32_bf16 v[108:111], v[48:51], a[124:127], v[108:111]
    s_nop 7
    buffer_load_dwordx4 v[48:51], v26, s[4:7], s69 offen offset:128
    s_waitcnt vmcnt(0)
    v_mfma_f32_16x16x32_bf16 v[108:111], v[48:51], a[128:131], v[108:111]
    s_nop 7
    buffer_load_dwordx4 v[48:51], v26, s[4:7], s69 offen offset:192
    s_waitcnt vmcnt(0)
    v_mfma_f32_16x16x32_bf16 v[108:111], v[48:51], a[132:135], v[108:111]
    s_nop 7
    buffer_load_dwordx4 v[48:51], v26, s[4:7], s69 offen offset:256
    s_waitcnt vmcnt(0)
    v_mfma_f32_16x16x32_bf16 v[108:111], v[48:51], a[136:139], v[108:111]
    s_nop 7
    buffer_load_dwordx4 v[48:51], v26, s[4:7], s69 offen offset:320
    s_waitcnt vmcnt(0)
    v_mfma_f32_16x16x32_bf16 v[108:111], v[48:51], a[140:143], v[108:111]
    s_nop 7
    s_nop 15
    v_max3_f32 v14, v104, v105, v106
    v_max3_f32 v14, v14, v107, v108
    v_max3_f32 v14, v14, v109, v110
    v_max_f32 v14, v14, v111
    v_mov_b32 v15, v14
    s_nop 1
    v_permlane32_swap_b32 v15, v14
    v_max_f32 v14, v14, v15
    v_mov_b32 v15, v14
    s_nop 1
    v_permlane16_swap_b32 v15, v14
    v_max_f32 v14, v14, v15
    v_fma_f32 v14, v14, s28, v10
    v_max_f32 v20, 0, v14
    v_sub_f32 v10, v10, v20
    v_sub_f32 v21, 0, v20
    v_exp_f32 v21, v21
    s_nop 0
    v_mul_f32 v45, v45, v21
    v_mul_f32 v160, v160, v21
    v_mul_f32 v161, v161, v21
    v_mul_f32 v162, v162, v21
    v_mul_f32 v163, v163, v21
    v_mul_f32 v164, v164, v21
    v_mul_f32 v165, v165, v21
    v_mul_f32 v166, v166, v21
    v_mul_f32 v167, v167, v21
    v_mul_f32 v168, v168, v21
    v_mul_f32 v169, v169, v21
    v_mul_f32 v170, v170, v21
    v_mul_f32 v171, v171, v21
    v_mul_f32 v172, v172, v21
    v_mul_f32 v173, v173, v21
    v_mul_f32 v174, v174, v21
    v_mul_f32 v175, v175, v21
    v_mul_f32 v176, v176, v21
    v_mul_f32 v177, v177, v21
    v_mul_f32 v178, v178, v21
    v_mul_f32 v179, v179, v21
    v_mul_f32 v180, v180, v21
    v_mul_f32 v181, v181, v21
    v_mul_f32 v182, v182, v21
    v_mul_f32 v183, v183, v21
    v_mul_f32 v184, v184, v21
    v_mul_f32 v185, v185, v21
    v_mul_f32 v186, v186, v21
    v_mul_f32 v187, v187, v21
    v_mul_f32 v188, v188, v21
    v_mul_f32 v189, v189, v21
    v_mul_f32 v190, v190, v21
    v_mul_f32 v191, v191, v21
    v_mul_f32 v192, v192, v21
    v_mul_f32 v193, v193, v21
    v_mul_f32 v194, v194, v21
    v_mul_f32 v195, v195, v21
    v_mul_f32 v196, v196, v21
    v_mul_f32 v197, v197, v21
    v_mul_f32 v198, v198, v21
    v_mul_f32 v199, v199, v21
    v_mul_f32 v200, v200, v21
    v_mul_f32 v201, v201, v21
    v_mul_f32 v202, v202, v21
    v_mul_f32 v203, v203, v21
    v_mul_f32 v204, v204, v21
    v_mul_f32 v205, v205, v21
    v_mul_f32 v206, v206, v21
    v_mul_f32 v207, v207, v21
    v_fma_f32 v104, v104, s28, v10
    v_fma_f32 v105, v105, s28, v10
    v_exp_f32 v104, v104
    v_exp_f32 v105, v105
    s_nop 0
    v_cvt_pk_bf16_f32 v24, v104, v105
    v_fma_f32 v106, v106, s28, v10
    v_fma_f32 v107, v107, s28, v10
    v_exp_f32 v106, v106
    v_exp_f32 v107, v107
    s_nop 0
    v_cvt_pk_bf16_f32 v25, v106, v107
    v_fma_f32 v108, v108, s28, v10
    v_fma_f32 v109, v109, s28, v10
    v_exp_f32 v108, v108
    v_exp_f32 v109, v109
    s_nop 0
    v_cvt_pk_bf16_f32 v22, v108, v109
    v_fma_f32 v110, v110, s28, v10
    v_fma_f32 v111, v111, s28, v10
    v_exp_f32 v110, v110
    v_exp_f32 v111, v111
    s_nop 0
    v_cvt_pk_bf16_f32 v23, v110, v111
    s_add_u32 s69, s39, 0
    buffer_load_dwordx4 v[48:51], v26, s[4:7], s69 offen offset:0
    s_waitcnt vmcnt(0)
    v_mfma_f32_16x16x32_bf16 v[104:107], v[48:51], a[144:147], 0
    s_nop 7
    buffer_load_dwordx4 v[48:51], v26, s[4:7], s69 offen offset:64
    s_waitcnt vmcnt(0)
    v_mfma_f32_16x16x32_bf16 v[104:107], v[48:51], a[148:151], v[104:107]
    s_nop 7
    buffer_load_dwordx4 v[48:51], v26, s[4:7], s69 offen offset:128
    s_waitcnt vmcnt(0)
    v_mfma_f32_16x16x32_bf16 v[104:107], v[48:51], a[152:155], v[104:107]
    s_nop 7
    buffer_load_dwordx4 v[48:51], v26, s[4:7], s69 offen offset:192
    s_waitcnt vmcnt(0)
    v_mfma_f32_16x16x32_bf16 v[104:107], v[48:51], a[156:159], v[104:107]
    s_nop 7
    buffer_load_dwordx4 v[48:51], v26, s[4:7], s69 offen offset:256
    s_waitcnt vmcnt(0)
    v_mfma_f32_16x16x32_bf16 v[104:107], v[48:51], a[160:163], v[104:107]
    s_nop 7
    buffer_load_dwordx4 v[48:51], v26, s[4:7], s69 offen offset:320
    s_waitcnt vmcnt(0)
    v_mfma_f32_16x16x32_bf16 v[104:107], v[48:51], a[164:167], v[104:107]
    s_nop 7
    s_add_u32 s69, s39, 6144
    buffer_load_dwordx4 v[48:51], v26, s[4:7], s69 offen offset:0
    s_waitcnt vmcnt(0)
    v_mfma_f32_16x16x32_bf16 v[108:111], v[48:51], a[144:147], 0
    s_nop 7
    buffer_load_dwordx4 v[48:51], v26, s[4:7], s69 offen offset:64
    s_waitcnt vmcnt(0)
    v_mfma_f32_16x16x32_bf16 v[108:111], v[48:51], a[148:151], v[108:111]
    s_nop 7
    buffer_load_dwordx4 v[48:51], v26, s[4:7], s69 offen offset:128
    s_waitcnt vmcnt(0)
    v_mfma_f32_16x16x32_bf16 v[108:111], v[48:51], a[152:155], v[108:111]
    s_nop 7
    buffer_load_dwordx4 v[48:51], v26, s[4:7], s69 offen offset:192
    s_waitcnt vmcnt(0)
    v_mfma_f32_16x16x32_bf16 v[108:111], v[48:51], a[156:159], v[108:111]
    s_nop 7
    buffer_load_dwordx4 v[48:51], v26, s[4:7], s69 offen offset:256
    s_waitcnt vmcnt(0)
    v_mfma_f32_16x16x32_bf16 v[108:111], v[48:51], a[160:163], v[108:111]
    s_nop 7
    buffer_load_dwordx4 v[48:51], v26, s[4:7], s69 offen offset:320
    s_waitcnt vmcnt(0)
    v_mfma_f32_16x16x32_bf16 v[108:111], v[48:51], a[164:167], v[108:111]
    s_nop 7
    s_nop 15
    v_max3_f32 v14, v104, v105, v106
    v_max3_f32 v14, v14, v107, v108
    v_max3_f32 v14, v14, v109, v110
    v_max_f32 v14, v14, v111
    v_mov_b32 v15, v14
    s_nop 1
    v_permlane32_swap_b32 v15, v14
    v_max_f32 v14, v14, v15
    v_mov_b32 v15, v14
    s_nop 1
    v_permlane16_swap_b32 v15, v14
    v_max_f32 v14, v14, v15
    v_fma_f32 v14, v14, s28, v11
    v_max_f32 v20, 0, v14
    v_sub_f32 v11, v11, v20
    v_sub_f32 v21, 0, v20
    v_exp_f32 v21, v21
    s_nop 0
    v_mul_f32 v46, v46, v21
    v_mul_f32 v208, v208, v21
    v_mul_f32 v209, v209, v21
    v_mul_f32 v210, v210, v21
    v_mul_f32 v211, v211, v21
    v_mul_f32 v212, v212, v21
    v_mul_f32 v213, v213, v21
    v_mul_f32 v214, v214, v21
    v_mul_f32 v215, v215, v21
    v_mul_f32 v216, v216, v21
    v_mul_f32 v217, v217, v21
    v_mul_f32 v218, v218, v21
    v_mul_f32 v219, v219, v21
    v_mul_f32 v220, v220, v21
    v_mul_f32 v221, v221, v21
    v_mul_f32 v222, v222, v21
    v_mul_f32 v223, v223, v21
    v_mul_f32 v224, v224, v21
    v_mul_f32 v225, v225, v21
    v_mul_f32 v226, v226, v21
    v_mul_f32 v227, v227, v21
    v_mul_f32 v228, v228, v21
    v_mul_f32 v229, v229, v21
    v_mul_f32 v230, v230, v21
    v_mul_f32 v231, v231, v21
    v_mul_f32 v232, v232, v21
    v_mul_f32 v233, v233, v21
    v_mul_f32 v234, v234, v21
    v_mul_f32 v235, v235, v21
    v_mul_f32 v236, v236, v21
    v_mul_f32 v237, v237, v21
    v_mul_f32 v238, v238, v21
    v_mul_f32 v239, v239, v21
    v_mul_f32 v240, v240, v21
    v_mul_f32 v241, v241, v21
    v_mul_f32 v242, v242, v21
    v_mul_f32 v243, v243, v21
    v_mul_f32 v244, v244, v21
    v_mul_f32 v245, v245, v21
    v_mul_f32 v246, v246, v21
    v_mul_f32 v247, v247, v21
    v_mul_f32 v248, v248, v21
    v_mul_f32 v249, v249, v21
    v_mul_f32 v250, v250, v21
    v_mul_f32 v251, v251, v21
    v_mul_f32 v252, v252, v21
    v_mul_f32 v253, v253, v21
    v_mul_f32 v254, v254, v21
    v_mul_f32 v255, v255, v21
    v_fma_f32 v104, v104, s28, v11
    v_fma_f32 v105, v105, s28, v11
    v_exp_f32 v104, v104
    v_exp_f32 v105, v105
    s_nop 0
    v_cvt_pk_bf16_f32 v30, v104, v105
    v_fma_f32 v106, v106, s28, v11
    v_fma_f32 v107, v107, s28, v11
    v_exp_f32 v106, v106
    v_exp_f32 v107, v107
    s_nop 0
    v_cvt_pk_bf16_f32 v31, v106, v107
    v_fma_f32 v108, v108, s28, v11
    v_fma_f32 v109, v109, s28, v11
    v_exp_f32 v108, v108
    v_exp_f32 v109, v109
    s_nop 0
    v_cvt_pk_bf16_f32 v28, v108, v109
    v_fma_f32 v110, v110, s28, v11
    v_fma_f32 v111, v111, s28, v11
    v_exp_f32 v110, v110
    v_exp_f32 v111, v111
    s_nop 0
    v_cvt_pk_bf16_f32 v29, v110, v111
    s_add_u32 s69, s39, 0
    buffer_load_dwordx4 v[48:51], v26, s[4:7], s69 offen offset:0
    s_waitcnt vmcnt(0)
    v_mfma_f32_16x16x32_bf16 v[104:107], v[48:51], a[168:171], 0
    s_nop 7
    buffer_load_dwordx4 v[48:51], v26, s[4:7], s69 offen offset:64
    s_waitcnt vmcnt(0)
    v_mfma_f32_16x16x32_bf16 v[104:107], v[48:51], a[172:175], v[104:107]
    s_nop 7
    buffer_load_dwordx4 v[48:51], v26, s[4:7], s69 offen offset:128
    s_waitcnt vmcnt(0)
    v_mfma_f32_16x16x32_bf16 v[104:107], v[48:51], a[176:179], v[104:107]
    s_nop 7
    buffer_load_dwordx4 v[48:51], v26, s[4:7], s69 offen offset:192
    s_waitcnt vmcnt(0)
    v_mfma_f32_16x16x32_bf16 v[104:107], v[48:51], a[180:183], v[104:107]
    s_nop 7
    buffer_load_dwordx4 v[48:51], v26, s[4:7], s69 offen offset:256
    s_waitcnt vmcnt(0)
    v_mfma_f32_16x16x32_bf16 v[104:107], v[48:51], a[184:187], v[104:107]
    s_nop 7
    buffer_load_dwordx4 v[48:51], v26, s[4:7], s69 offen offset:320
    s_waitcnt vmcnt(0)
    v_mfma_f32_16x16x32_bf16 v[104:107], v[48:51], a[188:191], v[104:107]
    s_nop 7
    s_add_u32 s69, s39, 6144
    buffer_load_dwordx4 v[48:51], v26, s[4:7], s69 offen offset:0
    s_waitcnt vmcnt(0)
    v_mfma_f32_16x16x32_bf16 v[108:111], v[48:51], a[168:171], 0
    s_nop 7
    buffer_load_dwordx4 v[48:51], v26, s[4:7], s69 offen offset:64
    s_waitcnt vmcnt(0)
    v_mfma_f32_16x16x32_bf16 v[108:111], v[48:51], a[172:175], v[108:111]
    s_nop 7
    buffer_load_dwordx4 v[48:51], v26, s[4:7], s69 offen offset:128
    s_waitcnt vmcnt(0)
    v_mfma_f32_16x16x32_bf16 v[108:111], v[48:51], a[176:179], v[108:111]
    s_nop 7
    buffer_load_dwordx4 v[48:51], v26, s[4:7], s69 offen offset:192
    s_waitcnt vmcnt(0)
    v_mfma_f32_16x16x32_bf16 v[108:111], v[48:51], a[180:183], v[108:111]
    s_nop 7
    buffer_load_dwordx4 v[48:51], v26, s[4:7], s69 offen offset:256
    s_waitcnt vmcnt(0)
    v_mfma_f32_16x16x32_bf16 v[108:111], v[48:51], a[184:187], v[108:111]
    s_nop 7
    buffer_load_dwordx4 v[48:51], v26, s[4:7], s69 offen offset:320
    s_waitcnt vmcnt(0)
    v_mfma_f32_16x16x32_bf16 v[108:111], v[48:51], a[188:191], v[108:111]
    s_nop 7
    s_nop 15
    v_max3_f32 v14, v104, v105, v106
    v_max3_f32 v14, v14, v107, v108
    v_max3_f32 v14, v14, v109, v110
    v_max_f32 v14, v14, v111
    v_mov_b32 v15, v14
    s_nop 1
    v_permlane32_swap_b32 v15, v14
    v_max_f32 v14, v14, v15
    v_mov_b32 v15, v14
    s_nop 1
    v_permlane16_swap_b32 v15, v14
    v_max_f32 v14, v14, v15
    v_fma_f32 v14, v14, s28, v12
    v_max_f32 v20, 0, v14
    v_sub_f32 v12, v12, v20
    v_sub_f32 v21, 0, v20
    v_exp_f32 v21, v21
    s_nop 0
    v_mul_f32 v47, v47, v21
    v_accvgpr_read_b32 v15, a0
    v_mul_f32 v15, v15, v21
    v_accvgpr_write_b32 a0, v15
    v_accvgpr_read_b32 v15, a1
    v_mul_f32 v15, v15, v21
    v_accvgpr_write_b32 a1, v15
    v_accvgpr_read_b32 v15, a2
    v_mul_f32 v15, v15, v21
    v_accvgpr_write_b32 a2, v15
    v_accvgpr_read_b32 v15, a3
    v_mul_f32 v15, v15, v21
    v_accvgpr_write_b32 a3, v15
    v_accvgpr_read_b32 v15, a4
    v_mul_f32 v15, v15, v21
    v_accvgpr_write_b32 a4, v15
    v_accvgpr_read_b32 v15, a5
    v_mul_f32 v15, v15, v21
    v_accvgpr_write_b32 a5, v15
    v_accvgpr_read_b32 v15, a6
    v_mul_f32 v15, v15, v21
    v_accvgpr_write_b32 a6, v15
    v_accvgpr_read_b32 v15, a7
    v_mul_f32 v15, v15, v21
    v_accvgpr_write_b32 a7, v15
    v_accvgpr_read_b32 v15, a8
    v_mul_f32 v15, v15, v21
    v_accvgpr_write_b32 a8, v15
    v_accvgpr_read_b32 v15, a9
    v_mul_f32 v15, v15, v21
    v_accvgpr_write_b32 a9, v15
    v_accvgpr_read_b32 v15, a10
    v_mul_f32 v15, v15, v21
    v_accvgpr_write_b32 a10, v15
    v_accvgpr_read_b32 v15, a11
    v_mul_f32 v15, v15, v21
    v_accvgpr_write_b32 a11, v15
    v_accvgpr_read_b32 v15, a12
    v_mul_f32 v15, v15, v21
    v_accvgpr_write_b32 a12, v15
    v_accvgpr_read_b32 v15, a13
    v_mul_f32 v15, v15, v21
    v_accvgpr_write_b32 a13, v15
    v_accvgpr_read_b32 v15, a14
    v_mul_f32 v15, v15, v21
    v_accvgpr_write_b32 a14, v15
    v_accvgpr_read_b32 v15, a15
    v_mul_f32 v15, v15, v21
    v_accvgpr_write_b32 a15, v15
    v_accvgpr_read_b32 v15, a16
    v_mul_f32 v15, v15, v21
    v_accvgpr_write_b32 a16, v15
    v_accvgpr_read_b32 v15, a17
    v_mul_f32 v15, v15, v21
    v_accvgpr_write_b32 a17, v15
    v_accvgpr_read_b32 v15, a18
    v_mul_f32 v15, v15, v21
    v_accvgpr_write_b32 a18, v15
    v_accvgpr_read_b32 v15, a19
    v_mul_f32 v15, v15, v21
    v_accvgpr_write_b32 a19, v15
    v_accvgpr_read_b32 v15, a20
    v_mul_f32 v15, v15, v21
    v_accvgpr_write_b32 a20, v15
    v_accvgpr_read_b32 v15, a21
    v_mul_f32 v15, v15, v21
    v_accvgpr_write_b32 a21, v15
    v_accvgpr_read_b32 v15, a22
    v_mul_f32 v15, v15, v21
    v_accvgpr_write_b32 a22, v15
    v_accvgpr_read_b32 v15, a23
    v_mul_f32 v15, v15, v21
    v_accvgpr_write_b32 a23, v15
    v_accvgpr_read_b32 v15, a24
    v_mul_f32 v15, v15, v21
    v_accvgpr_write_b32 a24, v15
    v_accvgpr_read_b32 v15, a25
    v_mul_f32 v15, v15, v21
    v_accvgpr_write_b32 a25, v15
    v_accvgpr_read_b32 v15, a26
    v_mul_f32 v15, v15, v21
    v_accvgpr_write_b32 a26, v15
    v_accvgpr_read_b32 v15, a27
    v_mul_f32 v15, v15, v21
    v_accvgpr_write_b32 a27, v15
    v_accvgpr_read_b32 v15, a28
    v_mul_f32 v15, v15, v21
    v_accvgpr_write_b32 a28, v15
    v_accvgpr_read_b32 v15, a29
    v_mul_f32 v15, v15, v21
    v_accvgpr_write_b32 a29, v15
    v_accvgpr_read_b32 v15, a30
    v_mul_f32 v15, v15, v21
    v_accvgpr_write_b32 a30, v15
    v_accvgpr_read_b32 v15, a31
    v_mul_f32 v15, v15, v21
    v_accvgpr_write_b32 a31, v15
    v_accvgpr_read_b32 v15, a32
    v_mul_f32 v15, v15, v21
    v_accvgpr_write_b32 a32, v15
    v_accvgpr_read_b32 v15, a33
    v_mul_f32 v15, v15, v21
    v_accvgpr_write_b32 a33, v15
    v_accvgpr_read_b32 v15, a34
    v_mul_f32 v15, v15, v21
    v_accvgpr_write_b32 a34, v15
    v_accvgpr_read_b32 v15, a35
    v_mul_f32 v15, v15, v21
    v_accvgpr_write_b32 a35, v15
    v_accvgpr_read_b32 v15, a36
    v_mul_f32 v15, v15, v21
    v_accvgpr_write_b32 a36, v15
    v_accvgpr_read_b32 v15, a37
    v_mul_f32 v15, v15, v21
    v_accvgpr_write_b32 a37, v15
    v_accvgpr_read_b32 v15, a38
    v_mul_f32 v15, v15, v21
    v_accvgpr_write_b32 a38, v15
    v_accvgpr_read_b32 v15, a39
    v_mul_f32 v15, v15, v21
    v_accvgpr_write_b32 a39, v15
    v_accvgpr_read_b32 v15, a40
    v_mul_f32 v15, v15, v21
    v_accvgpr_write_b32 a40, v15
    v_accvgpr_read_b32 v15, a41
    v_mul_f32 v15, v15, v21
    v_accvgpr_write_b32 a41, v15
    v_accvgpr_read_b32 v15, a42
    v_mul_f32 v15, v15, v21
    v_accvgpr_write_b32 a42, v15
    v_accvgpr_read_b32 v15, a43
    v_mul_f32 v15, v15, v21
    v_accvgpr_write_b32 a43, v15
    v_accvgpr_read_b32 v15, a44
    v_mul_f32 v15, v15, v21
    v_accvgpr_write_b32 a44, v15
    v_accvgpr_read_b32 v15, a45
    v_mul_f32 v15, v15, v21
    v_accvgpr_write_b32 a45, v15
    v_accvgpr_read_b32 v15, a46
    v_mul_f32 v15, v15, v21
    v_accvgpr_write_b32 a46, v15
    v_accvgpr_read_b32 v15, a47
    v_mul_f32 v15, v15, v21
    v_accvgpr_write_b32 a47, v15
    v_fma_f32 v104, v104, s28, v12
    v_fma_f32 v105, v105, s28, v12
    v_exp_f32 v104, v104
    v_exp_f32 v105, v105
    s_nop 0
    v_cvt_pk_bf16_f32 v36, v104, v105
    v_fma_f32 v106, v106, s28, v12
    v_fma_f32 v107, v107, s28, v12
    v_exp_f32 v106, v106
    v_exp_f32 v107, v107
    s_nop 0
    v_cvt_pk_bf16_f32 v37, v106, v107
    v_fma_f32 v108, v108, s28, v12
    v_fma_f32 v109, v109, s28, v12
    v_exp_f32 v108, v108
    v_exp_f32 v109, v109
    s_nop 0
    v_cvt_pk_bf16_f32 v34, v108, v109
    v_fma_f32 v110, v110, s28, v12
    v_fma_f32 v111, v111, s28, v12
    v_exp_f32 v110, v110
    v_exp_f32 v111, v111
    s_nop 0
    v_cvt_pk_bf16_f32 v35, v110, v111
    v_mfma_f32_16x16x32_bf16 v[48:51], a[236:239], v[16:19], v[44:47]
    v_mfma_f32_16x16x32_bf16 v[48:51], a[240:243], v[22:25], v[48:51]
    v_mfma_f32_16x16x32_bf16 v[48:51], a[244:247], v[28:31], v[48:51]
    v_mfma_f32_16x16x32_bf16 v[48:51], a[248:251], v[34:37], v[48:51]
    s_nop 15
    s_setpc_b64 s[40:41]
L_rs_start5b:
    s_call_b64 s[40:41], L_rare5_1
    s_branch L_ret_start5b
L_rs_loop5w0a:
    s_call_b64 s[40:41], L_rare5_0
    s_branch L_ret_loop5w0a
L_rs_loop5w0b:
    s_call_b64 s[40:41], L_rare5_1
    s_branch L_ret_loop5w0b
L_rs_loop5w1a:
    s_call_b64 s[40:41], L_rare5_0
    s_branch L_ret_loop5w1a
L_rs_loop5w1b:
    s_call_b64 s[40:41], L_rare5_1
    s_branch L_ret_loop5w1b
L_rs_end5a:
    s_call_b64 s[40:41], L_rare5_0
    s_branch L_ret_end5a
L_rs_end5b:
    s_call_b64 s[40:41], L_rare5_1
    s_branch L_ret_end5b
L_rs_start4b:
    s_call_b64 s[40:41], L_rare4_1
    s_branch L_ret_start4b
L_rs_loop4w0a:
    s_call_b64 s[40:41], L_rare4_0
    s_branch L_ret_loop4w0a
L_rs_loop4w0b:
    s_call_b64 s[40:41], L_rare4_1
    s_branch L_ret_loop4w0b
L_rs_end4a:
    s_call_b64 s[40:41], L_rare4_0
    s_branch L_ret_end4a
L_rs_end4b:
    s_call_b64 s[40:41], L_rare4_1
    s_branch L_ret_end4b
L_rs_tr54a:
    s_call_b64 s[40:41], L_rare5_0
    s_branch L_ret_tr54a
L_rs_tr54b:
    s_nop 15
    s_waitcnt vmcnt(0) lgkmcnt(0)
    s_mov_b32 s68, s14
    s_mov_b32 s14, 166723584
    v_mbcnt_lo_u32_b32 v105, -1, 0
    v_mbcnt_hi_u32_b32 v105, -1, v105
    v_and_b32 v104, 15, v105
    v_mul_u32_u24 v104, 384, v104
    v_lshrrev_b32 v105, 4, v105
    v_lshl_add_u32 v104, v105, 4, v104
    s_add_u32 s69, s34, 0
    buffer_load_dwordx4 a[96:99], v104, s[12:15], s69 offen offset:0
    buffer_load_dwordx4 a[100:103], v104, s[12:15], s69 offen offset:64
    buffer_load_dwordx4 a[104:107], v104, s[12:15], s69 offen offset:128
    buffer_load_dwordx4 a[108:111], v104, s[12:15], s69 offen offset:192
    buffer_load_dwordx4 a[112:115], v104, s[12:15], s69 offen offset:256
    buffer_load_dwordx4 a[116:119], v104, s[12:15], s69 offen offset:320
    s_add_u32 s69, s34, 6144
    buffer_load_dwordx4 a[120:123], v104, s[12:15], s69 offen offset:0
    buffer_load_dwordx4 a[124:127], v104, s[12:15], s69 offen offset:64
    buffer_load_dwordx4 a[128:131], v104, s[12:15], s69 offen offset:128
    buffer_load_dwordx4 a[132:135], v104, s[12:15], s69 offen offset:192
    buffer_load_dwordx4 a[136:139], v104, s[12:15], s69 offen offset:256
    buffer_load_dwordx4 a[140:143], v104, s[12:15], s69 offen offset:320
    s_add_u32 s69, s34, 12288
    buffer_load_dwordx4 a[144:147], v104, s[12:15], s69 offen offset:0
    buffer_load_dwordx4 a[148:151], v104, s[12:15], s69 offen offset:64
    buffer_load_dwordx4 a[152:155], v104, s[12:15], s69 offen offset:128
    buffer_load_dwordx4 a[156:159], v104, s[12:15], s69 offen offset:192
    buffer_load_dwordx4 a[160:163], v104, s[12:15], s69 offen offset:256
    buffer_load_dwordx4 a[164:167], v104, s[12:15], s69 offen offset:320
    s_add_u32 s69, s34, 18432
    buffer_load_dwordx4 a[168:171], v104, s[12:15], s69 offen offset:0
    buffer_load_dwordx4 a[172:175], v104, s[12:15], s69 offen offset:64
    buffer_load_dwordx4 a[176:179], v104, s[12:15], s69 offen offset:128
    buffer_load_dwordx4 a[180:183], v104, s[12:15], s69 offen offset:192
    buffer_load_dwordx4 a[184:187], v104, s[12:15], s69 offen offset:256
    buffer_load_dwordx4 a[188:191], v104, s[12:15], s69 offen offset:320
    s_add_u32 s69, s34, 24576
    buffer_load_dwordx4 a[192:195], v104, s[12:15], s69 offen offset:0
    buffer_load_dwordx4 a[196:199], v104, s[12:15], s69 offen offset:64
    buffer_load_dwordx4 a[200:203], v104, s[12:15], s69 offen offset:128
    buffer_load_dwordx4 a[204:207], v104, s[12:15], s69 offen offset:192
    buffer_load_dwordx4 a[208:211], v104, s[12:15], s69 offen offset:256
    buffer_load_dwordx4 v[92:95], v104, s[12:15], s69 offen offset:320
    s_waitcnt vmcnt(0)
    s_call_b64 s[40:41], L_rare5_1
    v_mbcnt_lo_u32_b32 v105, -1, 0
    v_mbcnt_hi_u32_b32 v105, -1, v105
    v_and_b32 v104, 15, v105
    v_mul_u32_u24 v104, 384, v104
    v_lshrrev_b32 v105, 4, v105
    v_lshl_add_u32 v104, v105, 4, v104
    s_add_u32 s69, s33, 0
    buffer_load_dwordx4 a[96:99], v104, s[12:15], s69 offen offset:0
    buffer_load_dwordx4 a[100:103], v104, s[12:15], s69 offen offset:64
    buffer_load_dwordx4 a[104:107], v104, s[12:15], s69 offen offset:128
    buffer_load_dwordx4 a[108:111], v104, s[12:15], s69 offen offset:192
    buffer_load_dwordx4 a[112:115], v104, s[12:15], s69 offen offset:256
    buffer_load_dwordx4 a[116:119], v104, s[12:15], s69 offen offset:320
    s_add_u32 s69, s33, 6144
    buffer_load_dwordx4 a[120:123], v104, s[12:15], s69 offen offset:0
    buffer_load_dwordx4 a[124:127], v104, s[12:15], s69 offen offset:64
    buffer_load_dwordx4 a[128:131], v104, s[12:15], s69 offen offset:128
    buffer_load_dwordx4 a[132:135], v104, s[12:15], s69 offen offset:192
    buffer_load_dwordx4 a[136:139], v104, s[12:15], s69 offen offset:256
    buffer_load_dwordx4 a[140:143], v104, s[12:15], s69 offen offset:320
    s_add_u32 s69, s33, 12288
    buffer_load_dwordx4 a[144:147], v104, s[12:15], s69 offen offset:0
    buffer_load_dwordx4 a[148:151], v104, s[12:15], s69 offen offset:64
    buffer_load_dwordx4 a[152:155], v104, s[12:15], s69 offen offset:128
    buffer_load_dwordx4 a[156:159], v104, s[12:15], s69 offen offset:192
    buffer_load_dwordx4 a[160:163], v104, s[12:15], s69 offen offset:256
    buffer_load_dwordx4 a[164:167], v104, s[12:15], s69 offen offset:320
    s_add_u32 s69, s33, 18432
    buffer_load_dwordx4 a[168:171], v104, s[12:15], s69 offen offset:0
    buffer_load_dwordx4 a[172:175], v104, s[12:15], s69 offen offset:64
    buffer_load_dwordx4 a[176:179], v104, s[12:15], s69 offen offset:128
    buffer_load_dwordx4 a[180:183], v104, s[12:15], s69 offen offset:192
    buffer_load_dwordx4 a[184:187], v104, s[12:15], s69 offen offset:256
    buffer_load_dwordx4 a[188:191], v104, s[12:15], s69 offen offset:320
    s_waitcnt vmcnt(0)
    s_mov_b32 s14, s68
    s_branch L_ret_tr54b
L_rs_tr54d:
    s_call_b64 s[40:41], L_rare4_1
    s_branch L_ret_tr54d
L_rs_tr45a:
    s_call_b64 s[40:41], L_rare4_0
    s_branch L_ret_tr45a
L_rs_tr45b:
    s_nop 15
    s_waitcnt vmcnt(0) lgkmcnt(0)
    s_mov_b32 s68, s14
    s_mov_b32 s14, 166723584
    v_mbcnt_lo_u32_b32 v105, -1, 0
    v_mbcnt_hi_u32_b32 v105, -1, v105
    v_and_b32 v104, 15, v105
    v_mul_u32_u24 v104, 384, v104
    v_lshrrev_b32 v105, 4, v105
    v_lshl_add_u32 v104, v105, 4, v104
    s_add_u32 s69, s34, 0
    buffer_load_dwordx4 a[96:99], v104, s[12:15], s69 offen offset:0
    buffer_load_dwordx4 a[100:103], v104, s[12:15], s69 offen offset:64
    buffer_load_dwordx4 a[104:107], v104, s[12:15], s69 offen offset:128
    buffer_load_dwordx4 a[108:111], v104, s[12:15], s69 offen offset:192
    buffer_load_dwordx4 a[112:115], v104, s[12:15], s69 offen offset:256
    buffer_load_dwordx4 a[116:119], v104, s[12:15], s69 offen offset:320
    s_add_u32 s69, s34, 6144
    buffer_load_dwordx4 a[120:123], v104, s[12:15], s69 offen offset:0
    buffer_load_dwordx4 a[124:127], v104, s[12:15], s69 offen offset:64
    buffer_load_dwordx4 a[128:131], v104, s[12:15], s69 offen offset:128
    buffer_load_dwordx4 a[132:135], v104, s[12:15], s69 offen offset:192
    buffer_load_dwordx4 a[136:139], v104, s[12:15], s69 offen offset:256
    buffer_load_dwordx4 a[140:143], v104, s[12:15], s69 offen offset:320
    s_add_u32 s69, s34, 12288
    buffer_load_dwordx4 a[144:147], v104, s[12:15], s69 offen offset:0
    buffer_load_dwordx4 a[148:151], v104, s[12:15], s69 offen offset:64
    buffer_load_dwordx4 a[152:155], v104, s[12:15], s69 offen offset:128
    buffer_load_dwordx4 a[156:159], v104, s[12:15], s69 offen offset:192
    buffer_load_dwordx4 a[160:163], v104, s[12:15], s69 offen offset:256
    buffer_load_dwordx4 a[164:167], v104, s[12:15], s69 offen offset:320
    s_add_u32 s69, s34, 18432
    buffer_load_dwordx4 a[168:171], v104, s[12:15], s69 offen offset:0
    buffer_load_dwordx4 a[172:175], v104, s[12:15], s69 offen offset:64
    buffer_load_dwordx4 a[176:179], v104, s[12:15], s69 offen offset:128
    buffer_load_dwordx4 a[180:183], v104, s[12:15], s69 offen offset:192
    buffer_load_dwordx4 a[184:187], v104, s[12:15], s69 offen offset:256
    buffer_load_dwordx4 a[188:191], v104, s[12:15], s69 offen offset:320
    s_waitcnt vmcnt(0)
    s_call_b64 s[40:41], L_rare4_1
    v_mbcnt_lo_u32_b32 v105, -1, 0
    v_mbcnt_hi_u32_b32 v105, -1, v105
    v_and_b32 v104, 15, v105
    v_mul_u32_u24 v104, 384, v104
    v_lshrrev_b32 v105, 4, v105
    v_lshl_add_u32 v104, v105, 4, v104
    s_add_u32 s69, s33, 0
    buffer_load_dwordx4 a[96:99], v104, s[12:15], s69 offen offset:0
    buffer_load_dwordx4 a[100:103], v104, s[12:15], s69 offen offset:64
    buffer_load_dwordx4 a[104:107], v104, s[12:15], s69 offen offset:128
    buffer_load_dwordx4 a[108:111], v104, s[12:15], s69 offen offset:192
    buffer_load_dwordx4 a[112:115], v104, s[12:15], s69 offen offset:256
    buffer_load_dwordx4 a[116:119], v104, s[12:15], s69 offen offset:320
    s_add_u32 s69, s33, 6144
    buffer_load_dwordx4 a[120:123], v104, s[12:15], s69 offen offset:0
    buffer_load_dwordx4 a[124:127], v104, s[12:15], s69 offen offset:64
    buffer_load_dwordx4 a[128:131], v104, s[12:15], s69 offen offset:128
    buffer_load_dwordx4 a[132:135], v104, s[12:15], s69 offen offset:192
    buffer_load_dwordx4 a[136:139], v104, s[12:15], s69 offen offset:256
    buffer_load_dwordx4 a[140:143], v104, s[12:15], s69 offen offset:320
    s_add_u32 s69, s33, 12288
    buffer_load_dwordx4 a[144:147], v104, s[12:15], s69 offen offset:0
    buffer_load_dwordx4 a[148:151], v104, s[12:15], s69 offen offset:64
    buffer_load_dwordx4 a[152:155], v104, s[12:15], s69 offen offset:128
    buffer_load_dwordx4 a[156:159], v104, s[12:15], s69 offen offset:192
    buffer_load_dwordx4 a[160:163], v104, s[12:15], s69 offen offset:256
    buffer_load_dwordx4 a[164:167], v104, s[12:15], s69 offen offset:320
    s_add_u32 s69, s33, 18432
    buffer_load_dwordx4 a[168:171], v104, s[12:15], s69 offen offset:0
    buffer_load_dwordx4 a[172:175], v104, s[12:15], s69 offen offset:64
    buffer_load_dwordx4 a[176:179], v104, s[12:15], s69 offen offset:128
    buffer_load_dwordx4 a[180:183], v104, s[12:15], s69 offen offset:192
    buffer_load_dwordx4 a[184:187], v104, s[12:15], s69 offen offset:256
    buffer_load_dwordx4 a[188:191], v104, s[12:15], s69 offen offset:320
    s_add_u32 s69, s33, 24576
    buffer_load_dwordx4 a[192:195], v104, s[12:15], s69 offen offset:0
    buffer_load_dwordx4 a[196:199], v104, s[12:15], s69 offen offset:64
    buffer_load_dwordx4 a[200:203], v104, s[12:15], s69 offen offset:128
    buffer_load_dwordx4 a[204:207], v104, s[12:15], s69 offen offset:192
    buffer_load_dwordx4 a[208:211], v104, s[12:15], s69 offen offset:256
    buffer_load_dwordx4 v[92:95], v104, s[12:15], s69 offen offset:320
    s_waitcnt vmcnt(0)
    s_mov_b32 s14, s68
    s_branch L_ret_tr45b
L_rs_tr45d:
    s_call_b64 s[40:41], L_rare5_1
    s_branch L_ret_tr45d
L_rs_tr44a:
    s_call_b64 s[40:41], L_rare4_0
    s_branch L_ret_tr44a
L_rs_tr44b:
    s_nop 15
    s_waitcnt vmcnt(0) lgkmcnt(0)
    s_mov_b32 s68, s14
    s_mov_b32 s14, 166723584
    v_mbcnt_lo_u32_b32 v105, -1, 0
    v_mbcnt_hi_u32_b32 v105, -1, v105
    v_and_b32 v104, 15, v105
    v_mul_u32_u24 v104, 384, v104
    v_lshrrev_b32 v105, 4, v105
    v_lshl_add_u32 v104, v105, 4, v104
    s_add_u32 s69, s34, 0
    buffer_load_dwordx4 a[96:99], v104, s[12:15], s69 offen offset:0
    buffer_load_dwordx4 a[100:103], v104, s[12:15], s69 offen offset:64
    buffer_load_dwordx4 a[104:107], v104, s[12:15], s69 offen offset:128
    buffer_load_dwordx4 a[108:111], v104, s[12:15], s69 offen offset:192
    buffer_load_dwordx4 a[112:115], v104, s[12:15], s69 offen offset:256
    buffer_load_dwordx4 a[116:119], v104, s[12:15], s69 offen offset:320
    s_add_u32 s69, s34, 6144
    buffer_load_dwordx4 a[120:123], v104, s[12:15], s69 offen offset:0
    buffer_load_dwordx4 a[124:127], v104, s[12:15], s69 offen offset:64
    buffer_load_dwordx4 a[128:131], v104, s[12:15], s69 offen offset:128
    buffer_load_dwordx4 a[132:135], v104, s[12:15], s69 offen offset:192
    buffer_load_dwordx4 a[136:139], v104, s[12:15], s69 offen offset:256
    buffer_load_dwordx4 a[140:143], v104, s[12:15], s69 offen offset:320
    s_add_u32 s69, s34, 12288
    buffer_load_dwordx4 a[144:147], v104, s[12:15], s69 offen offset:0
    buffer_load_dwordx4 a[148:151], v104, s[12:15], s69 offen offset:64
    buffer_load_dwordx4 a[152:155], v104, s[12:15], s69 offen offset:128
    buffer_load_dwordx4 a[156:159], v104, s[12:15], s69 offen offset:192
    buffer_load_dwordx4 a[160:163], v104, s[12:15], s69 offen offset:256
    buffer_load_dwordx4 a[164:167], v104, s[12:15], s69 offen offset:320
    s_add_u32 s69, s34, 18432
    buffer_load_dwordx4 a[168:171], v104, s[12:15], s69 offen offset:0
    buffer_load_dwordx4 a[172:175], v104, s[12:15], s69 offen offset:64
    buffer_load_dwordx4 a[176:179], v104, s[12:15], s69 offen offset:128
    buffer_load_dwordx4 a[180:183], v104, s[12:15], s69 offen offset:192
    buffer_load_dwordx4 a[184:187], v104, s[12:15], s69 offen offset:256
    buffer_load_dwordx4 a[188:191], v104, s[12:15], s69 offen offset:320
    s_waitcnt vmcnt(0)
    s_call_b64 s[40:41], L_rare4_1
    v_mbcnt_lo_u32_b32 v105, -1, 0
    v_mbcnt_hi_u32_b32 v105, -1, v105
    v_and_b32 v104, 15, v105
    v_mul_u32_u24 v104, 384, v104
    v_lshrrev_b32 v105, 4, v105
    v_lshl_add_u32 v104, v105, 4, v104
    s_add_u32 s69, s33, 0
    buffer_load_dwordx4 a[96:99], v104, s[12:15], s69 offen offset:0
    buffer_load_dwordx4 a[100:103], v104, s[12:15], s69 offen offset:64
    buffer_load_dwordx4 a[104:107], v104, s[12:15], s69 offen offset:128
    buffer_load_dwordx4 a[108:111], v104, s[12:15], s69 offen offset:192
    buffer_load_dwordx4 a[112:115], v104, s[12:15], s69 offen offset:256
    buffer_load_dwordx4 a[116:119], v104, s[12:15], s69 offen offset:320
    s_add_u32 s69, s33, 6144
    buffer_load_dwordx4 a[120:123], v104, s[12:15], s69 offen offset:0
    buffer_load_dwordx4 a[124:127], v104, s[12:15], s69 offen offset:64
    buffer_load_dwordx4 a[128:131], v104, s[12:15], s69 offen offset:128
    buffer_load_dwordx4 a[132:135], v104, s[12:15], s69 offen offset:192
    buffer_load_dwordx4 a[136:139], v104, s[12:15], s69 offen offset:256
    buffer_load_dwordx4 a[140:143], v104, s[12:15], s69 offen offset:320
    s_add_u32 s69, s33, 12288
    buffer_load_dwordx4 a[144:147], v104, s[12:15], s69 offen offset:0
    buffer_load_dwordx4 a[148:151], v104, s[12:15], s69 offen offset:64
    buffer_load_dwordx4 a[152:155], v104, s[12:15], s69 offen offset:128
    buffer_load_dwordx4 a[156:159], v104, s[12:15], s69 offen offset:192
    buffer_load_dwordx4 a[160:163], v104, s[12:15], s69 offen offset:256
    buffer_load_dwordx4 a[164:167], v104, s[12:15], s69 offen offset:320
    s_add_u32 s69, s33, 18432
    buffer_load_dwordx4 a[168:171], v104, s[12:15], s69 offen offset:0
    buffer_load_dwordx4 a[172:175], v104, s[12:15], s69 offen offset:64
    buffer_load_dwordx4 a[176:179], v104, s[12:15], s69 offen offset:128
    buffer_load_dwordx4 a[180:183], v104, s[12:15], s69 offen offset:192
    buffer_load_dwordx4 a[184:187], v104, s[12:15], s69 offen offset:256
    buffer_load_dwordx4 a[188:191], v104, s[12:15], s69 offen offset:320
    s_waitcnt vmcnt(0)
    s_mov_b32 s14, s68
    s_branch L_ret_tr44b
L_rs_tr44d:
    s_call_b64 s[40:41], L_rare4_1
    s_branch L_ret_tr44d
L_rs_tr55a:
    s_call_b64 s[40:41], L_rare5_0
    s_branch L_ret_tr55a
L_rs_tr55b:
    s_nop 15
    s_waitcnt vmcnt(0) lgkmcnt(0)
    s_mov_b32 s68, s14
    s_mov_b32 s14, 166723584
    v_mbcnt_lo_u32_b32 v105, -1, 0
    v_mbcnt_hi_u32_b32 v105, -1, v105
    v_and_b32 v104, 15, v105
    v_mul_u32_u24 v104, 384, v104
    v_lshrrev_b32 v105, 4, v105
    v_lshl_add_u32 v104, v105, 4, v104
    s_add_u32 s69, s34, 0
    buffer_load_dwordx4 a[96:99], v104, s[12:15], s69 offen offset:0
    buffer_load_dwordx4 a[100:103], v104, s[12:15], s69 offen offset:64
    buffer_load_dwordx4 a[104:107], v104, s[12:15], s69 offen offset:128
    buffer_load_dwordx4 a[108:111], v104, s[12:15], s69 offen offset:192
    buffer_load_dwordx4 a[112:115], v104, s[12:15], s69 offen offset:256
    buffer_load_dwordx4 a[116:119], v104, s[12:15], s69 offen offset:320
    s_add_u32 s69, s34, 6144
    buffer_load_dwordx4 a[120:123], v104, s[12:15], s69 offen offset:0
    buffer_load_dwordx4 a[124:127], v104, s[12:15], s69 offen offset:64
    buffer_load_dwordx4 a[128:131], v104, s[12:15], s69 offen offset:128
    buffer_load_dwordx4 a[132:135], v104, s[12:15], s69 offen offset:192
    buffer_load_dwordx4 a[136:139], v104, s[12:15], s69 offen offset:256
    buffer_load_dwordx4 a[140:143], v104, s[12:15], s69 offen offset:320
    s_add_u32 s69, s34, 12288
    buffer_load_dwordx4 a[144:147], v104, s[12:15], s69 offen offset:0
    buffer_load_dwordx4 a[148:151], v104, s[12:15], s69 offen offset:64
    buffer_load_dwordx4 a[152:155], v104, s[12:15], s69 offen offset:128
    buffer_load_dwordx4 a[156:159], v104, s[12:15], s69 offen offset:192
    buffer_load_dwordx4 a[160:163], v104, s[12:15], s69 offen offset:256
    buffer_load_dwordx4 a[164:167], v104, s[12:15], s69 offen offset:320
    s_add_u32 s69, s34, 18432
    buffer_load_dwordx4 a[168:171], v104, s[12:15], s69 offen offset:0
    buffer_load_dwordx4 a[172:175], v104, s[12:15], s69 offen offset:64
    buffer_load_dwordx4 a[176:179], v104, s[12:15], s69 offen offset:128
    buffer_load_dwordx4 a[180:183], v104, s[12:15], s69 offen offset:192
    buffer_load_dwordx4 a[184:187], v104, s[12:15], s69 offen offset:256
    buffer_load_dwordx4 a[188:191], v104, s[12:15], s69 offen offset:320
    s_add_u32 s69, s34, 24576
    buffer_load_dwordx4 a[192:195], v104, s[12:15], s69 offen offset:0
    buffer_load_dwordx4 a[196:199], v104, s[12:15], s69 offen offset:64
    buffer_load_dwordx4 a[200:203], v104, s[12:15], s69 offen offset:128
    buffer_load_dwordx4 a[204:207], v104, s[12:15], s69 offen offset:192
    buffer_load_dwordx4 a[208:211], v104, s[12:15], s69 offen offset:256
    buffer_load_dwordx4 v[92:95], v104, s[12:15], s69 offen offset:320
    s_waitcnt vmcnt(0)
    s_call_b64 s[40:41], L_rare5_1
    v_mbcnt_lo_u32_b32 v105, -1, 0
    v_mbcnt_hi_u32_b32 v105, -1, v105
    v_and_b32 v104, 15, v105
    v_mul_u32_u24 v104, 384, v104
    v_lshrrev_b32 v105, 4, v105
    v_lshl_add_u32 v104, v105, 4, v104
    s_add_u32 s69, s33, 0
    buffer_load_dwordx4 a[96:99], v104, s[12:15], s69 offen offset:0
    buffer_load_dwordx4 a[100:103], v104, s[12:15], s69 offen offset:64
    buffer_load_dwordx4 a[104:107], v104, s[12:15], s69 offen offset:128
    buffer_load_dwordx4 a[108:111], v104, s[12:15], s69 offen offset:192
    buffer_load_dwordx4 a[112:115], v104, s[12:15], s69 offen offset:256
    buffer_load_dwordx4 a[116:119], v104, s[12:15], s69 offen offset:320
    s_add_u32 s69, s33, 6144
    buffer_load_dwordx4 a[120:123], v104, s[12:15], s69 offen offset:0
    buffer_load_dwordx4 a[124:127], v104, s[12:15], s69 offen offset:64
    buffer_load_dwordx4 a[128:131], v104, s[12:15], s69 offen offset:128
    buffer_load_dwordx4 a[132:135], v104, s[12:15], s69 offen offset:192
    buffer_load_dwordx4 a[136:139], v104, s[12:15], s69 offen offset:256
    buffer_load_dwordx4 a[140:143], v104, s[12:15], s69 offen offset:320
    s_add_u32 s69, s33, 12288
    buffer_load_dwordx4 a[144:147], v104, s[12:15], s69 offen offset:0
    buffer_load_dwordx4 a[148:151], v104, s[12:15], s69 offen offset:64
    buffer_load_dwordx4 a[152:155], v104, s[12:15], s69 offen offset:128
    buffer_load_dwordx4 a[156:159], v104, s[12:15], s69 offen offset:192
    buffer_load_dwordx4 a[160:163], v104, s[12:15], s69 offen offset:256
    buffer_load_dwordx4 a[164:167], v104, s[12:15], s69 offen offset:320
    s_add_u32 s69, s33, 18432
    buffer_load_dwordx4 a[168:171], v104, s[12:15], s69 offen offset:0
    buffer_load_dwordx4 a[172:175], v104, s[12:15], s69 offen offset:64
    buffer_load_dwordx4 a[176:179], v104, s[12:15], s69 offen offset:128
    buffer_load_dwordx4 a[180:183], v104, s[12:15], s69 offen offset:192
    buffer_load_dwordx4 a[184:187], v104, s[12:15], s69 offen offset:256
    buffer_load_dwordx4 a[188:191], v104, s[12:15], s69 offen offset:320
    s_add_u32 s69, s33, 24576
    buffer_load_dwordx4 a[192:195], v104, s[12:15], s69 offen offset:0
    buffer_load_dwordx4 a[196:199], v104, s[12:15], s69 offen offset:64
    buffer_load_dwordx4 a[200:203], v104, s[12:15], s69 offen offset:128
    buffer_load_dwordx4 a[204:207], v104, s[12:15], s69 offen offset:192
    buffer_load_dwordx4 a[208:211], v104, s[12:15], s69 offen offset:256
    buffer_load_dwordx4 v[92:95], v104, s[12:15], s69 offen offset:320
    s_waitcnt vmcnt(0)
    s_mov_b32 s14, s68
    s_branch L_ret_tr55b
L_rs_tr55d:
    s_call_b64 s[40:41], L_rare5_1
    s_branch L_ret_tr55d
.section .rodata,"a"
.p2align 6
.amdhsa_kernel standalone__gqa_softmax__near_ridge_kernel
  .amdhsa_next_free_vgpr 512
  .amdhsa_next_free_sgpr 102
  .amdhsa_accum_offset 256
  .amdhsa_group_segment_fixed_size 0
  .amdhsa_kernarg_size 48
  .amdhsa_user_sgpr_count 2
  .amdhsa_user_sgpr_kernarg_segment_ptr 1
  .amdhsa_system_sgpr_workgroup_id_x 1
.end_amdhsa_kernel
```

```asm
; @launch grid=(256,1,1) block=(256,1,1) lds=163840
.amdgcn_target "amdgcn-amd-amdhsa--gfx950"
.text
.globl standalone__gqa_softmax__near_ridge_kernel
.p2align 8
.type standalone__gqa_softmax__near_ridge_kernel,@function
standalone__gqa_softmax__near_ridge_kernel:
    s_cmp_ge_u32 s2, 256
    s_cbranch_scc1 L_end
    s_load_dwordx4 s[84:87], s[0:1], 0
    s_load_dwordx4 s[88:91], s[0:1], 16
    v_lshrrev_b32 v110, 6, v0
    v_and_b32 v111, 63, v0
    s_getpc_b64 s[60:61]
L_pc:
    s_lshr_b32 s62, s2, 3
    v_lshl_add_u32 v53, s62, 2, v110
    v_min_u32 v52, ((L_codeend-L_pc+16383)/16384)-1, v111
    v_mul_u32_u24 v53, ((L_codeend-L_pc+16383)/16384), v53
    v_add_lshl_u32 v52, v52, v53, 7
    v_min_u32 v52, L_codeend-L_pc-4, v52
    global_load_dword v53, v52, s[60:61]
    v_readfirstlane_b32 s3, v110
    v_lshrrev_b32 v96, 3, v111
    v_mul_u32_u24 v7, 384, v96
    v_lshrrev_b32 v97, 1, v96
    v_lshlrev_b32 v97, 1, v97
    v_and_b32 v98, 7, v111
    v_xor_b32 v97, v97, v98
    v_lshl_add_u32 v7, v97, 4, v7
    s_and_b32 s65, s3, 1
    s_mul_i32 s42, s65, 80
    s_mul_i32 s43, s65, 3072
    v_xor_b32 v6, s42, v7
    v_xor_b32 v7, 80, v6
    v_add_u32 v6, s43, v6
    s_sub_u32 s43, 3072, s43
    v_add_u32 v7, s43, v7
    s_mov_b32 s28, 0x3dd53b95
    s_mov_b32 s29, 0x4e800000
    s_mov_b32 s49, 5888
    s_mov_b32 s66, 0x28301800
    s_mov_b32 s46, 0
    s_mov_b32 s47, 0xffff0000
    s_and_b32 s42, s2, 7
    s_lshr_b32 s43, s2, 3
    s_mul_i32 s44, s43, 43
    s_lshr_b32 s44, s44, 7
    s_mov_b32 s39, s44
    s_mul_i32 s45, s44, 3
    s_sub_u32 s36, s43, s45
    s_lshl_b32 s42, s42, 6
    s_lshl_b32 s45, s45, 1
    s_add_u32 s42, s42, s45
    s_mul_i32 s64, s42, 196608
    s_mul_i32 s35, s42, 325632
    s_lshr_b32 s42, s44, 1
    s_mov_b32 s31, 0x6900924
    s_cmp_eq_u32 s42, 1
    s_cselect_b32 s31, 0x14a0489, s31
    s_cmp_eq_u32 s42, 2
    s_cselect_b32 s31, 0x8250258, s31
    s_cmp_eq_u32 s42, 3
    s_cselect_b32 s31, 0x8940912, s31
    s_cmp_eq_u32 s42, 4
    s_cselect_b32 s31, 0x1a10606, s31
    s_and_b32 s42, s44, 1
    s_lshl_b32 s42, s42, 4
    s_lshr_b32 s31, s31, s42
    s_and_b32 s31, s31, 0xffff
    s_cmp_eq_u32 s43, 30
    s_cselect_b32 s31, 0x120648, s31
    s_cmp_eq_u32 s43, 31
    s_cselect_b32 s31, 0x240219, s31
    s_lshr_b32 s63, s31, 16
    s_cmp_ge_u32 s43, 30
    s_cselect_b32 s36, 0, s36
    s_cselect_b32 s42, 4, 6
    s_mul_i32 s42, s42, 196608
    s_add_u32 s6, s64, s42
    s_mov_b32 s10, s6
    s_mul_i32 s22, s3, 3072
    s_mul_i32 s38, s3, 28672
    s_add_u32 s38, s38, 49152
    s_and_b32 s42, s3, 2
    s_mul_i32 s42, s42, 3072
    s_add_u32 s20, s64, s42
    s_mov_b32 s21, s20
    s_mov_b32 s14, 166723584
    s_mov_b32 s18, 0
    s_mov_b32 s67, 0
    s_mov_b32 s37, 0
    s_mov_b32 s60, 0
    s_mov_b32 s61, 0xffff
    s_lshl_b32 s42, s37, 1
    s_lshr_b32 s42, s31, s42
    s_and_b32 s42, s42, 3
    s_add_u32 s42, s42, s36
    s_sub_u32 s43, s42, 3
    s_cmp_ge_u32 s42, 3
    s_cselect_b32 s42, s43, s42
    s_mul_i32 s44, s3, 5
    s_mov_b32 s32, 1
    s_lshl_b32 s43, s3, 2
    s_add_u32 s45, s43, 21
    s_cmp_eq_u32 s3, 0
    s_cselect_b32 s45, 20, s45
    s_cselect_b32 s34, 1, 0
    s_cmp_eq_u32 s42, 1
    s_cselect_b32 s44, s45, s44
    s_cselect_b32 s32, s34, s32
    s_add_u32 s45, s43, 37
    s_cmp_eq_u32 s42, 2
    s_cselect_b32 s44, s45, s44
    s_cselect_b32 s32, 0, s32
    s_mul_i32 s44, s44, 6144
    s_add_u32 s34, s35, s44
    s_waitcnt lgkmcnt(0)
    s_mov_b32 s12, s84
    s_and_b32 s13, s85, 0xffff
    s_mov_b32 s15, 0x20000
    s_mov_b32 s4, s86
    s_and_b32 s5, s87, 0xffff
    s_mov_b32 s7, 0x20000
    s_mov_b32 s8, s88
    s_and_b32 s9, s89, 0xffff
    s_mov_b32 s11, 0x20000
    s_mov_b32 s16, s90
    s_and_b32 s17, s91, 0xffff
    s_mov_b32 s19, 0x20000
    s_cmp_eq_u32 s32, 0
    s_cbranch_scc1 L_start4
L_start5:
    s_add_u32 m0, s22, 0
    s_nop 0
    buffer_load_dwordx4 v6, s[4:7], s20 offen lds
    s_add_u32 s20, s20, 128
    s_add_u32 m0, s22, 1024
    s_nop 0
    buffer_load_dwordx4 v6, s[4:7], s20 offen lds
    s_add_u32 s20, s20, 128
    s_add_u32 m0, s22, 2048
    s_nop 0
    buffer_load_dwordx4 v6, s[4:7], s20 offen lds
    s_add_u32 s20, s20, 12032
    s_add_u32 m0, s22, 12288
    s_nop 0
    buffer_load_dwordx4 v6, s[4:7], s20 offen lds
    s_add_u32 s20, s20, 128
    s_add_u32 m0, s22, 13312
    s_nop 0
    buffer_load_dwordx4 v6, s[4:7], s20 offen lds
    s_add_u32 s20, s20, 128
    s_add_u32 m0, s22, 14336
    s_nop 0
    buffer_load_dwordx4 v6, s[4:7], s20 offen lds
    s_add_u32 s20, s20, 12032
    s_add_u32 s48, s34, 0
    s_add_u32 m0, s38, 0
    s_nop 0
    buffer_load_dwordx4 v6, s[12:15], s48 offen nt lds
    s_add_u32 m0, s38, 1024
    s_nop 0
    buffer_load_dwordx4 v7, s[12:15], s48 offen nt lds
    s_add_u32 s48, s34, 128
    s_add_u32 m0, s38, 2048
    s_nop 0
    buffer_load_dwordx4 v6, s[12:15], s48 offen nt lds
    s_add_u32 m0, s38, 3072
    s_nop 0
    buffer_load_dwordx4 v7, s[12:15], s48 offen nt lds
    s_add_u32 s48, s34, 256
    s_add_u32 m0, s38, 4096
    s_nop 0
    buffer_load_dwordx4 v6, s[12:15], s48 offen nt lds
    s_add_u32 m0, s38, 5120
    s_nop 0
    buffer_load_dwordx4 v7, s[12:15], s48 offen nt lds
    s_add_u32 s48, s34, 6144
    s_add_u32 m0, s38, 6144
    s_nop 0
    buffer_load_dwordx4 v6, s[12:15], s48 offen nt lds
    s_add_u32 m0, s38, 7168
    s_nop 0
    buffer_load_dwordx4 v7, s[12:15], s48 offen nt lds
    s_add_u32 s48, s34, 6272
    s_add_u32 m0, s38, 8192
    s_nop 0
    buffer_load_dwordx4 v6, s[12:15], s48 offen nt lds
    s_add_u32 m0, s38, 9216
    s_nop 0
    buffer_load_dwordx4 v7, s[12:15], s48 offen nt lds
    s_add_u32 s48, s34, 6400
    s_add_u32 m0, s38, 10240
    s_nop 0
    buffer_load_dwordx4 v6, s[12:15], s48 offen nt lds
    s_add_u32 m0, s38, 11264
    s_nop 0
    buffer_load_dwordx4 v7, s[12:15], s48 offen nt lds
    s_add_u32 s48, s34, 12288
    s_add_u32 m0, s38, 12288
    s_nop 0
    buffer_load_dwordx4 v6, s[12:15], s48 offen nt lds
    s_add_u32 m0, s38, 13312
    s_nop 0
    buffer_load_dwordx4 v7, s[12:15], s48 offen nt lds
    s_add_u32 s48, s34, 12416
    s_add_u32 m0, s38, 14336
    s_nop 0
    buffer_load_dwordx4 v6, s[12:15], s48 offen nt lds
    s_add_u32 m0, s38, 15360
    s_nop 0
    buffer_load_dwordx4 v7, s[12:15], s48 offen nt lds
    s_add_u32 s48, s34, 12544
    s_add_u32 m0, s38, 16384
    s_nop 0
    buffer_load_dwordx4 v6, s[12:15], s48 offen nt lds
    s_add_u32 m0, s38, 17408
    s_nop 0
    buffer_load_dwordx4 v7, s[12:15], s48 offen nt lds
    v_and_b32 v96, 15, v111
    v_lshrrev_b32 v97, 4, v111
    v_lshrrev_b32 v98, 3, v96
    v_and_b32 v99, 7, v96
    v_lshlrev_b32 v0, 7, v99
    v_bfe_u32 v99, v96, 1, 2
    v_lshlrev_b32 v99, 1, v99
    v_mul_u32_u24 v100, 5, v98
    v_xor_b32 v99, v99, v100
    v_xor_b32 v99, v99, v97
    v_lshl_add_u32 v0, v99, 4, v0
    v_mul_u32_u24 v100, 3072, v98
    v_add_u32 v0, v100, v0
    v_xor_b32 v1, 64, v0
    v_lshrrev_b32 v98, 1, v97
    v_mul_u32_u24 v2, 3072, v98
    v_and_b32 v99, 1, v97
    v_bfe_u32 v100, v111, 2, 2
    v_lshl_add_u32 v96, v99, 2, v100
    v_lshl_add_u32 v2, v96, 7, v2
    v_lshrrev_b32 v96, 1, v96
    v_lshlrev_b32 v96, 1, v96
    v_mul_u32_u24 v98, 5, v98
    v_xor_b32 v96, v96, v98
    v_bfe_u32 v99, v111, 1, 1
    v_xor_b32 v96, v96, v99
    v_lshl_add_u32 v2, v96, 4, v2
    v_and_b32 v99, 1, v111
    v_lshl_add_u32 v2, v99, 3, v2
    v_add_u32 v2, 24576, v2
    v_xor_b32 v3, 32, v2
    v_xor_b32 v4, 64, v2
    v_xor_b32 v5, 96, v2
    v_lshl_add_u32 v103, v111, 4, s38
    v_and_b32 v96, 15, v111
    s_mov_b32 s42, 0x1011
    v_bfe_i32 v97, s42, v96, 1
    v_and_b32 v97, 0x3f803f80, v97
    v_accvgpr_write_b32 a236, v97
    v_accvgpr_write_b32 a237, v97
    v_accvgpr_write_b32 a238, v97
    v_accvgpr_write_b32 a239, v97
    s_mov_b32 s42, 0x3222
    v_bfe_i32 v97, s42, v96, 1
    v_and_b32 v97, 0x3f803f80, v97
    v_accvgpr_write_b32 a240, v97
    v_accvgpr_write_b32 a241, v97
    v_accvgpr_write_b32 a242, v97
    v_accvgpr_write_b32 a243, v97
    s_mov_b32 s42, 0x5444
    v_bfe_i32 v97, s42, v96, 1
    v_and_b32 v97, 0x3f803f80, v97
    v_accvgpr_write_b32 a244, v97
    v_accvgpr_write_b32 a245, v97
    v_accvgpr_write_b32 a246, v97
    v_accvgpr_write_b32 a247, v97
    s_mov_b32 s42, 0x9888
    v_bfe_i32 v97, s42, v96, 1
    v_and_b32 v97, 0x3f803f80, v97
    v_accvgpr_write_b32 a248, v97
    v_accvgpr_write_b32 a249, v97
    v_accvgpr_write_b32 a250, v97
    v_accvgpr_write_b32 a251, v97
    s_mov_b32 s42, 0x1100
    v_bfe_i32 v97, s42, v96, 1
    v_and_b32 v97, 0x3f803f80, v97
    v_accvgpr_write_b32 a252, v97
    v_accvgpr_write_b32 a253, v97
    v_accvgpr_write_b32 a254, v97
    v_accvgpr_write_b32 a255, v97
    s_waitcnt vmcnt(18)
    s_barrier
    s_waitcnt vmcnt(12)
    s_add_u32 s48, s34, 18432
    s_add_u32 m0, s38, 18432
    s_nop 0
    buffer_load_dwordx4 v6, s[12:15], s48 offen nt lds
    v_lshrrev_b32 v105, 11, v0
    s_add_u32 m0, s38, 19456
    s_nop 0
    buffer_load_dwordx4 v7, s[12:15], s48 offen nt lds
    s_add_u32 s48, s34, 18560
    ds_read_b128 a[220:223], v0 offset:1024
    v_and_b32 v104, 0x3ff, v0
    s_add_u32 m0, s38, 20480
    v_xor_b32 v105, s65, v105
    buffer_load_dwordx4 v6, s[12:15], s48 offen nt lds
    ds_read_b128 a[212:215], v0 offset:0
    ds_read_b128 a[216:219], v1 offset:0
    v_lshl_add_u32 v104, v105, 10, v104
    v_add_u32 v104, s38, v104
    s_add_u32 m0, s38, 21504
    v_xor_b32 v105, 64, v104
    buffer_load_dwordx4 v7, s[12:15], s48 offen nt lds
    s_add_u32 s48, s34, 18688
    ds_read_b128 a[96:99], v104 offset:0
    s_add_u32 m0, s38, 22528
    v_mbcnt_lo_u32_b32 v107, -1, 0
    buffer_load_dwordx4 v6, s[12:15], s48 offen nt lds
    s_add_u32 m0, s38, 23552
    ds_read_b128 a[224:227], v1 offset:1024
    ds_read_b128 a[104:107], v104 offset:2048
    ds_read_b128 a[116:119], v105 offset:4096
    ds_read_b128 a[100:103], v105 offset:0
    buffer_load_dwordx4 v7, s[12:15], s48 offen nt lds
    ds_read_b128 a[232:235], v1 offset:2048
    s_waitcnt lgkmcnt(5)
    v_mfma_f32_16x16x32_bf16 v[52:55], a[212:215], a[96:99], 0
    ds_read_b128 a[228:231], v0 offset:2048
    s_waitcnt lgkmcnt(2)
    v_mfma_f32_16x16x32_bf16 v[52:55], a[216:219], a[100:103], v[52:55]
    v_mbcnt_hi_u32_b32 v107, -1, v107
    ds_read_b128 a[108:111], v105 offset:2048
    v_mfma_f32_16x16x32_bf16 v[52:55], a[220:223], a[104:107], v[52:55]
    ds_read_b128 a[112:115], v104 offset:4096
    s_waitcnt lgkmcnt(1)
    v_mfma_f32_16x16x32_bf16 v[52:55], a[224:227], a[108:111], v[52:55]
    ds_read_b128 a[220:223], v0 offset:7168
    s_waitcnt lgkmcnt(1)
    v_mfma_f32_16x16x32_bf16 v[52:55], a[228:231], a[112:115], v[52:55]
    v_and_b32 v106, 15, v107
    ds_read_b128 a[212:215], v0 offset:6144
    v_mfma_f32_16x16x32_bf16 v[52:55], a[232:235], a[116:119], v[52:55]
    ds_read_b128 a[216:219], v1 offset:6144
    s_waitcnt lgkmcnt(1)
    v_mfma_f32_16x16x32_bf16 v[56:59], a[212:215], a[96:99], 0
    ds_read_b128 a[224:227], v1 offset:7168
    s_waitcnt lgkmcnt(1)
    v_mfma_f32_16x16x32_bf16 v[56:59], a[216:219], a[100:103], v[56:59]
    ds_read_b128 a[232:235], v1 offset:8192
    s_nop 0
    v_max3_f32 v96, v52, v53, v54
    ds_read_b128 a[212:215], v0 offset:12288
    v_mfma_f32_16x16x32_bf16 v[56:59], a[220:223], a[104:107], v[56:59]
    ds_read_b128 a[220:223], v0 offset:13312
    s_waitcnt lgkmcnt(3)
    v_mfma_f32_16x16x32_bf16 v[56:59], a[224:227], a[108:111], v[56:59]
    ds_read_b128 a[228:231], v0 offset:8192
    s_waitcnt lgkmcnt(0)
    v_mfma_f32_16x16x32_bf16 v[56:59], a[228:231], a[112:115], v[56:59]
    ds_read_b128 a[228:231], v0 offset:14336
    v_mfma_f32_16x16x32_bf16 v[56:59], a[232:235], a[116:119], v[56:59]
    s_nop 7
    v_max3_f32 v96, v96, v55, v56
    v_max3_f32 v96, v96, v57, v58
    v_max_f32 v96, v96, v59
    v_mul_u32_u24 v106, 384, v106
    ds_read_b128 a[232:235], v1 offset:14336
    v_mov_b32 v97, v96
    s_nop 1
    v_permlane32_swap_b32 v97, v96
    v_lshrrev_b32 v107, 4, v107
    v_max_f32 v96, v96, v97
    v_mov_b32 v97, v96
    s_nop 1
    v_permlane16_swap_b32 v97, v96
    v_max_f32 v96, v96, v97
    v_mul_f32_e64 v9, -s28, v96
    v_fma_f32 v54, v54, s28, v9
    v_fma_f32 v59, v59, s28, v9
    v_fma_f32 v55, v55, s28, v9
    v_fma_f32 v52, v52, s28, v9
    v_exp_f32 v59, v59
    v_fma_f32 v58, v58, s28, v9
    v_exp_f32 v55, v55
    v_fma_f32 v53, v53, s28, v9
    v_exp_f32 v54, v54
    ds_read_b128 a[224:227], v1 offset:13312
    v_cvt_pk_bf16_f32 v15, v54, v55
    ds_read_b128 a[216:219], v1 offset:12288
    v_fma_f32 v56, v56, s28, v9
    v_exp_f32 v53, v53
    v_exp_f32 v52, v52
    v_exp_f32 v56, v56
    v_cvt_pk_bf16_f32 v14, v52, v53
    v_fma_f32 v57, v57, s28, v9
    v_exp_f32 v58, v58
    s_waitcnt vmcnt(12)
    s_add_u32 s48, s34, 24576
    s_add_u32 m0, s38, 24576
    s_nop 0
    buffer_load_dwordx4 v6, s[12:15], s48 offen nt lds
    s_add_u32 m0, s38, 25600
    v_mfma_f32_16x16x32_bf16 v[52:55], a[212:215], a[96:99], 0
    buffer_load_dwordx4 v7, s[12:15], s48 offen nt lds
    s_add_u32 s48, s34, 24704
    ds_read_b128 a[212:215], v0 offset:18432
    s_waitcnt lgkmcnt(1)
    v_mfma_f32_16x16x32_bf16 v[52:55], a[216:219], a[100:103], v[52:55]
    s_add_u32 m0, s38, 26624
    s_nop 0
    buffer_load_dwordx4 v6, s[12:15], s48 offen nt lds
    ds_read_b128 a[216:219], v1 offset:18432
    v_exp_f32 v57, v57
    s_add_u32 m0, s38, 27648
    v_mfma_f32_16x16x32_bf16 v[52:55], a[220:223], a[104:107], v[52:55]
    buffer_load_dwordx4 v7, s[12:15], s48 offen nt lds
    s_add_u32 s48, s34, 24576
    ds_read_b128 a[140:143], v105 offset:10240
    v_lshl_add_u32 v106, v107, 4, v106
    v_mfma_f32_16x16x32_bf16 v[52:55], a[224:227], a[108:111], v[52:55]
    ds_read_b128 a[132:135], v105 offset:8192
    buffer_load_dwordx4 a[208:211], v106, s[12:15], s48 offen offset:256 nt
    ds_read_b128 a[120:123], v104 offset:6144
    v_mfma_f32_16x16x32_bf16 v[52:55], a[228:231], a[112:115], v[52:55]
    ds_read_b128 a[224:227], v1 offset:19456
    v_cvt_pk_bf16_f32 v17, v58, v59
    ds_read_b128 a[228:231], v0 offset:20480
    v_cvt_pk_bf16_f32 v16, v56, v57
    v_mfma_f32_16x16x32_bf16 v[52:55], a[232:235], a[116:119], v[52:55]
    ds_read_b128 a[220:223], v0 offset:19456
    buffer_load_dwordx4 v[92:95], v106, s[12:15], s48 offen offset:320 nt
    s_waitcnt lgkmcnt(7)
    v_mfma_f32_16x16x32_bf16 v[56:59], a[212:215], a[96:99], 0
    ds_read_b128 a[232:235], v1 offset:20480
    s_waitcnt lgkmcnt(7)
    v_mfma_f32_16x16x32_bf16 v[56:59], a[216:219], a[100:103], v[56:59]
    ds_read_b128 a[216:219], v1 offset:0
    s_waitcnt lgkmcnt(2)
    v_mfma_f32_16x16x32_bf16 v[56:59], a[220:223], a[104:107], v[56:59]
    ds_read_b128 a[220:223], v0 offset:1024
    ds_read_b128 a[128:131], v104 offset:8192
    v_mfma_f32_16x16x32_bf16 v[56:59], a[224:227], a[108:111], v[56:59]
    ds_read_b128 a[136:139], v104 offset:10240
    v_mfma_f32_16x16x32_bf16 v[56:59], a[228:231], a[112:115], v[56:59]
    s_waitcnt lgkmcnt(4)
    ds_read_b128 a[228:231], v0 offset:2048
    ds_read_b128 a[212:215], v0 offset:0
    v_mfma_f32_16x16x32_bf16 v[56:59], a[232:235], a[116:119], v[56:59]
    ds_read_b128 a[124:127], v105 offset:6144
    s_waitcnt lgkmcnt(1)
    v_mfma_f32_16x16x32_bf16 v[60:63], a[212:215], a[120:123], 0
    ds_read_b128 a[232:235], v1 offset:2048
    s_waitcnt lgkmcnt(1)
    v_mfma_f32_16x16x32_bf16 v[60:63], a[216:219], a[124:127], v[60:63]
    ds_read_b128 a[212:215], v0 offset:6144
    v_mfma_f32_16x16x32_bf16 v[60:63], a[220:223], a[128:131], v[60:63]
    ds_read_b128 a[224:227], v1 offset:1024
    s_waitcnt lgkmcnt(0)
    v_mfma_f32_16x16x32_bf16 v[60:63], a[224:227], a[132:135], v[60:63]
    ds_read_b128 a[220:223], v0 offset:7168
    v_mfma_f32_16x16x32_bf16 v[60:63], a[228:231], a[136:139], v[60:63]
    ds_read_b128 a[228:231], v0 offset:8192
    v_mfma_f32_16x16x32_bf16 v[60:63], a[232:235], a[140:143], v[60:63]
    ds_read_b128 a[216:219], v1 offset:6144
    v_mfma_f32_16x16x32_bf16 v[64:67], a[212:215], a[120:123], 0
    s_nop 5
    v_max3_f32 v98, v60, v61, v62
    ds_read_b128 a[212:215], v0 offset:12288
    s_waitcnt lgkmcnt(1)
    v_mfma_f32_16x16x32_bf16 v[64:67], a[216:219], a[124:127], v[64:67]
    ds_read_b128 a[224:227], v1 offset:7168
    v_mfma_f32_16x16x32_bf16 v[64:67], a[220:223], a[128:131], v[64:67]
    ds_read_b128 a[220:223], v0 offset:13312
    s_waitcnt lgkmcnt(1)
    v_mfma_f32_16x16x32_bf16 v[64:67], a[224:227], a[132:135], v[64:67]
    ds_read_b128 a[232:235], v1 offset:8192
    v_mfma_f32_16x16x32_bf16 v[64:67], a[228:231], a[136:139], v[64:67]
    ds_read_b128 a[228:231], v0 offset:14336
    v_fma_f32 v52, v52, s28, v9
    s_waitcnt lgkmcnt(1)
    v_mfma_f32_16x16x32_bf16 v[64:67], a[232:235], a[140:143], v[64:67]
    s_nop 7
    v_max3_f32 v98, v98, v63, v64
    v_max3_f32 v98, v98, v65, v66
    v_max_f32 v98, v98, v67
    v_mov_b32 v99, v98
    s_nop 1
    v_permlane32_swap_b32 v99, v98
    v_max_f32 v98, v98, v99
    v_mov_b32 v99, v98
    s_nop 1
    v_permlane16_swap_b32 v99, v98
    v_max_f32 v98, v98, v99
    v_mul_f32_e64 v10, -s28, v98
    v_fma_f32 v54, v54, s28, v9
    v_fma_f32 v63, v63, s28, v10
    v_fma_f32 v60, v60, s28, v10
    ds_read_b128 a[232:235], v1 offset:14336
    v_fma_f32 v67, v67, s28, v10
    v_fma_f32 v66, v66, s28, v10
    v_fma_f32 v64, v64, s28, v10
    v_exp_f32 v63, v63
    v_fma_f32 v65, v65, s28, v10
    v_exp_f32 v65, v65
    v_exp_f32 v64, v64
    v_fma_f32 v61, v61, s28, v10
    v_exp_f32 v67, v67
    v_exp_f32 v61, v61
    v_exp_f32 v60, v60
    ds_read_b128 a[216:219], v1 offset:12288
    v_cvt_pk_bf16_f32 v20, v60, v61
    v_fma_f32 v62, v62, s28, v10
    v_exp_f32 v62, v62
    v_exp_f32 v66, v66
    s_nop 0
    v_cvt_pk_bf16_f32 v23, v66, v67
    v_cvt_pk_bf16_f32 v21, v62, v63
    s_waitcnt vmcnt(12)
    s_add_u32 m0, s22, 24576
    s_nop 0
    buffer_load_dwordx4 v6, s[8:11], s21 offen lds
    v_mfma_f32_16x16x32_bf16 v[44:47], a[236:239], v[14:17], 0
    s_add_u32 s21, s21, 128
    s_add_u32 m0, s22, 25600
    s_nop 0
    buffer_load_dwordx4 v6, s[8:11], s21 offen lds
    s_add_u32 s21, s21, 128
    ds_read_b128 a[152:155], v104 offset:14336
    s_add_u32 m0, s22, 26624
    ds_read_b128 a[224:227], v1 offset:13312
    v_mfma_f32_16x16x32_bf16 v[60:63], a[212:215], a[120:123], 0
    ds_read_b128 a[212:215], v0 offset:18432
    buffer_load_dwordx4 v6, s[8:11], s21 offen lds
    s_waitcnt lgkmcnt(3)
    v_mfma_f32_16x16x32_bf16 v[60:63], a[216:219], a[124:127], v[60:63]
    ds_read_b128 a[144:147], v104 offset:12288
    v_mfma_f32_16x16x32_bf16 v[60:63], a[220:223], a[128:131], v[60:63]
    ds_read_b128 a[216:219], v1 offset:18432
    s_waitcnt lgkmcnt(3)
    v_mfma_f32_16x16x32_bf16 v[60:63], a[224:227], a[132:135], v[60:63]
    ds_read_b128 a[220:223], v0 offset:19456
    ds_read_b128 a[156:159], v105 offset:14336
    v_cvt_pk_bf16_f32 v22, v64, v65
    v_mfma_f32_16x16x32_bf16 v[60:63], a[228:231], a[136:139], v[60:63]
    ds_read_b128 a[224:227], v1 offset:19456
    s_add_u32 s21, s21, 12032
    v_mfma_f32_16x16x32_bf16 v[60:63], a[232:235], a[140:143], v[60:63]
    s_waitcnt lgkmcnt(5)
    ds_read_b128 a[228:231], v0 offset:20480
    v_fma_f32 v55, v55, s28, v9
    v_mfma_f32_16x16x32_bf16 v[64:67], a[212:215], a[120:123], 0
    ds_read_b128 a[232:235], v1 offset:20480
    s_waitcnt lgkmcnt(5)
    v_mfma_f32_16x16x32_bf16 v[64:67], a[216:219], a[124:127], v[64:67]
    ds_read_b128 a[164:167], v105 offset:16384
    s_waitcnt lgkmcnt(5)
    v_mfma_f32_16x16x32_bf16 v[64:67], a[220:223], a[128:131], v[64:67]
    ds_read_b128 a[216:219], v1 offset:0
    s_waitcnt lgkmcnt(4)
    v_mfma_f32_16x16x32_bf16 v[64:67], a[224:227], a[132:135], v[64:67]
    ds_read_b128 a[148:151], v105 offset:12288
    s_waitcnt lgkmcnt(4)
    v_mfma_f32_16x16x32_bf16 v[64:67], a[228:231], a[136:139], v[64:67]
    ds_read_b128 a[212:215], v0 offset:0
    s_waitcnt lgkmcnt(4)
    v_mfma_f32_16x16x32_bf16 v[64:67], a[232:235], a[140:143], v[64:67]
    ds_read_b128 a[220:223], v0 offset:1024
    s_waitcnt lgkmcnt(1)
    v_mfma_f32_16x16x32_bf16 v[68:71], a[212:215], a[144:147], 0
    ds_read_b128 a[224:227], v1 offset:1024
    ds_read_b128 a[228:231], v0 offset:2048
    v_mfma_f32_16x16x32_bf16 v[68:71], a[216:219], a[148:151], v[68:71]
    s_waitcnt lgkmcnt(2)
    ds_read_b128 a[232:235], v1 offset:2048
    v_mfma_f32_16x16x32_bf16 v[68:71], a[220:223], a[152:155], v[68:71]
    ds_read_b128 a[160:163], v104 offset:16384
    ds_read_b128 a[216:219], v1 offset:6144
    s_waitcnt lgkmcnt(4)
    v_mfma_f32_16x16x32_bf16 v[68:71], a[224:227], a[156:159], v[68:71]
    ds_read_b128 a[212:215], v0 offset:6144
    s_waitcnt lgkmcnt(2)
    v_mfma_f32_16x16x32_bf16 v[68:71], a[228:231], a[160:163], v[68:71]
    ds_read_b128 a[220:223], v0 offset:7168
    v_mfma_f32_16x16x32_bf16 v[68:71], a[232:235], a[164:167], v[68:71]
    s_nop 7
    v_max3_f32 v96, v68, v69, v70
    ds_read_b128 a[232:235], v1 offset:8192
    s_waitcnt lgkmcnt(2)
    v_mfma_f32_16x16x32_bf16 v[72:75], a[212:215], a[144:147], 0
    ds_read_b128 a[228:231], v0 offset:8192
    v_mfma_f32_16x16x32_bf16 v[72:75], a[216:219], a[148:151], v[72:75]
    ds_read_b128 a[212:215], v0 offset:12288
    v_fma_f32 v53, v53, s28, v9
    s_waitcnt lgkmcnt(3)
    v_mfma_f32_16x16x32_bf16 v[72:75], a[220:223], a[152:155], v[72:75]
    ds_read_b128 a[224:227], v1 offset:7168
    ds_read_b128 a[220:223], v0 offset:13312
    v_fma_f32 v60, v60, s28, v10
    s_waitcnt lgkmcnt(1)
    v_mfma_f32_16x16x32_bf16 v[72:75], a[224:227], a[156:159], v[72:75]
    ds_read_b128 a[224:227], v1 offset:13312
    v_mfma_f32_16x16x32_bf16 v[72:75], a[228:231], a[160:163], v[72:75]
    v_exp_f32 v54, v54
    ds_read_b128 a[216:219], v1 offset:12288
    v_mfma_f32_16x16x32_bf16 v[72:75], a[232:235], a[164:167], v[72:75]
    s_nop 7
    v_max3_f32 v96, v96, v71, v72
    v_max3_f32 v96, v96, v73, v74
    v_max_f32 v96, v96, v75
    v_exp_f32 v53, v53
    ds_read_b128 a[228:231], v0 offset:14336
    v_mov_b32 v97, v96
    s_nop 1
    v_permlane32_swap_b32 v97, v96
    v_max_f32 v96, v96, v97
    v_mov_b32 v97, v96
    s_nop 1
    v_permlane16_swap_b32 v97, v96
    v_fma_f32 v63, v63, s28, v10
    v_max_f32 v96, v96, v97
    v_mul_f32_e64 v11, -s28, v96
    v_fma_f32 v69, v69, s28, v11
    v_fma_f32 v68, v68, s28, v11
    v_fma_f32 v72, v72, s28, v11
    v_fma_f32 v75, v75, s28, v11
    v_fma_f32 v74, v74, s28, v11
    v_exp_f32 v75, v75
    v_exp_f32 v63, v63
    v_fma_f32 v71, v71, s28, v11
    v_exp_f32 v69, v69
    v_fma_f32 v70, v70, s28, v11
    v_exp_f32 v70, v70
    v_exp_f32 v68, v68
    v_mfma_f32_16x16x32_bf16 v[44:47], a[240:243], v[20:23], v[44:47]
    v_exp_f32 v74, v74
    v_cvt_pk_bf16_f32 v26, v68, v69
    v_fma_f32 v73, v73, s28, v11
    v_exp_f32 v73, v73
    v_exp_f32 v71, v71
    s_waitcnt vmcnt(9)
    s_add_u32 m0, s22, 36864
    ds_read_b128 a[232:235], v1 offset:14336
    buffer_load_dwordx4 v6, s[8:11], s21 offen lds
    s_add_u32 s21, s21, 128
    s_add_u32 m0, s22, 37888
    v_cvt_pk_bf16_f32 v27, v70, v71
    v_mfma_f32_16x16x32_bf16 v[68:71], a[212:215], a[144:147], 0
    buffer_load_dwordx4 v6, s[8:11], s21 offen lds
    ds_read_b128 a[212:215], v0 offset:18432
    s_add_u32 s21, s21, 128
    s_waitcnt lgkmcnt(2)
    v_mfma_f32_16x16x32_bf16 v[68:71], a[216:219], a[148:151], v[68:71]
    s_add_u32 m0, s22, 38912
    s_nop 0
    buffer_load_dwordx4 v6, s[8:11], s21 offen lds
    ds_read_b128 a[184:187], v104 offset:22528
    v_mfma_f32_16x16x32_bf16 v[68:71], a[220:223], a[152:155], v[68:71]
    v_fma_f32 v61, v61, s28, v10
    ds_read_b128 a[172:175], v105 offset:18432
    v_exp_f32 v72, v72
    v_mfma_f32_16x16x32_bf16 v[68:71], a[224:227], a[156:159], v[68:71]
    v_cvt_pk_bf16_f32 v29, v74, v75
    ds_read_b128 a[176:179], v104 offset:20480
    s_add_u32 s21, s21, 12032
    v_mfma_f32_16x16x32_bf16 v[68:71], a[228:231], a[160:163], v[68:71]
    v_cvt_pk_bf16_f32 v28, v72, v73
    ds_read_b128 a[180:183], v105 offset:20480
    ds_read_b128 a[168:171], v104 offset:18432
    s_waitcnt lgkmcnt(6)
    v_mfma_f32_16x16x32_bf16 v[68:71], a[232:235], a[164:167], v[68:71]
    ds_read_b128 a[216:219], v1 offset:18432
    s_waitcnt lgkmcnt(6)
    v_mfma_f32_16x16x32_bf16 v[72:75], a[212:215], a[144:147], 0
    ds_read_b128 a[220:223], v0 offset:19456
    ds_read_b128 a[228:231], v0 offset:20480
    v_mfma_f32_16x16x32_bf16 v[44:47], a[244:247], v[26:29], v[44:47]
    ds_read_b128 a[224:227], v1 offset:19456
    ds_read_b128 a[232:235], v1 offset:20480
    s_waitcnt lgkmcnt(4)
    v_mfma_f32_16x16x32_bf16 v[72:75], a[216:219], a[148:151], v[72:75]
    ds_read_b128 a[216:219], v1 offset:0
    v_fma_f32 v62, v62, s28, v10
    s_waitcnt lgkmcnt(4)
    v_mfma_f32_16x16x32_bf16 v[72:75], a[220:223], a[152:155], v[72:75]
    ds_read_b128 a[212:215], v0 offset:0
    s_waitcnt lgkmcnt(3)
    v_mfma_f32_16x16x32_bf16 v[72:75], a[224:227], a[156:159], v[72:75]
    ds_read_b128 a[220:223], v0 offset:1024
    v_mfma_f32_16x16x32_bf16 v[72:75], a[228:231], a[160:163], v[72:75]
    s_waitcnt lgkmcnt(3)
    ds_read_b128 a[224:227], v1 offset:1024
    v_mfma_f32_16x16x32_bf16 v[72:75], a[232:235], a[164:167], v[72:75]
    ds_read_b128 a[188:191], v105 offset:22528
    s_waitcnt lgkmcnt(3)
    v_mfma_f32_16x16x32_bf16 v[76:79], a[212:215], a[168:171], 0
    ds_read_b128 a[228:231], v0 offset:2048
    v_mfma_f32_16x16x32_bf16 v[76:79], a[216:219], a[172:175], v[76:79]
    s_waitcnt lgkmcnt(3)
    ds_read_b128 a[232:235], v1 offset:2048
    v_mfma_f32_16x16x32_bf16 v[76:79], a[220:223], a[176:179], v[76:79]
    s_waitcnt lgkmcnt(3)
    ds_read_b128 a[216:219], v1 offset:6144
    v_exp_f32 v52, v52
    v_mfma_f32_16x16x32_bf16 v[76:79], a[224:227], a[180:183], v[76:79]
    ds_read_b128 a[212:215], v0 offset:6144
    s_waitcnt lgkmcnt(3)
    v_mfma_f32_16x16x32_bf16 v[76:79], a[228:231], a[184:187], v[76:79]
    ds_read_b128 a[220:223], v0 offset:7168
    v_exp_f32 v55, v55
    s_waitcnt lgkmcnt(3)
    v_mfma_f32_16x16x32_bf16 v[76:79], a[232:235], a[188:191], v[76:79]
    ds_read_b128 a[228:231], v0 offset:8192
    s_waitcnt lgkmcnt(2)
    v_mfma_f32_16x16x32_bf16 v[80:83], a[212:215], a[168:171], 0
    ds_read_b128 a[224:227], v1 offset:7168
    v_mfma_f32_16x16x32_bf16 v[80:83], a[216:219], a[172:175], v[80:83]
    ds_read_b128 a[232:235], v1 offset:8192
    s_waitcnt lgkmcnt(3)
    v_mfma_f32_16x16x32_bf16 v[80:83], a[220:223], a[176:179], v[80:83]
    ds_read_b128 a[220:223], v0 offset:13312
    v_max3_f32 v98, v76, v77, v78
    s_waitcnt lgkmcnt(2)
    v_mfma_f32_16x16x32_bf16 v[80:83], a[224:227], a[180:183], v[80:83]
    ds_read_b128 a[212:215], v0 offset:12288
    v_mfma_f32_16x16x32_bf16 v[80:83], a[228:231], a[184:187], v[80:83]
    s_waitcnt lgkmcnt(2)
    ds_read_b128 a[216:219], v1 offset:12288
    v_mfma_f32_16x16x32_bf16 v[80:83], a[232:235], a[188:191], v[80:83]
    s_nop 7
    v_max3_f32 v98, v98, v79, v80
    v_max3_f32 v98, v98, v81, v82
    v_max_f32 v98, v98, v83
    v_mov_b32 v99, v98
    s_nop 1
    v_permlane32_swap_b32 v99, v98
    v_max_f32 v98, v98, v99
    v_mov_b32 v99, v98
    s_nop 1
    v_permlane16_swap_b32 v99, v98
    ds_read_b128 a[224:227], v1 offset:13312
    v_max_f32 v98, v98, v99
    v_mul_f32_e64 v12, -s28, v98
    v_fma_f32 v78, v78, s28, v12
    ds_read_b128 a[232:235], v1 offset:14336
    v_fma_f32 v80, v80, s28, v12
    v_fma_f32 v76, v76, s28, v12
    v_exp_f32 v60, v60
    v_exp_f32 v62, v62
    v_fma_f32 v77, v77, s28, v12
    v_fma_f32 v79, v79, s28, v12
    v_exp_f32 v79, v79
    v_exp_f32 v78, v78
    v_fma_f32 v82, v82, s28, v12
    v_exp_f32 v77, v77
    v_fma_f32 v81, v81, s28, v12
    v_fma_f32 v83, v83, s28, v12
    v_exp_f32 v76, v76
    s_nop 0
    v_cvt_pk_bf16_f32 v32, v76, v77
    v_cvt_pk_bf16_f32 v33, v78, v79
    v_exp_f32 v80, v80
    s_waitcnt lgkmcnt(2)
    v_mfma_f32_16x16x32_bf16 v[76:79], a[212:215], a[168:171], 0
    ds_read_b128 a[228:231], v0 offset:14336
    v_exp_f32 v83, v83
    v_cvt_pk_bf16_f32 v19, v54, v55
    v_mfma_f32_16x16x32_bf16 v[76:79], a[216:219], a[172:175], v[76:79]
    ds_read_b128 a[212:215], v0 offset:18432
    v_mfma_f32_16x16x32_bf16 v[76:79], a[220:223], a[176:179], v[76:79]
    s_waitcnt lgkmcnt(3)
    v_exp_f32 v61, v61
    ds_read_b128 a[216:219], v1 offset:18432
    v_mfma_f32_16x16x32_bf16 v[76:79], a[224:227], a[180:183], v[76:79]
    ds_read_b128 a[220:223], v0 offset:19456
    v_exp_f32 v81, v81
    v_exp_f32 v82, v82
    s_waitcnt lgkmcnt(3)
    v_mfma_f32_16x16x32_bf16 v[76:79], a[228:231], a[184:187], v[76:79]
    v_cvt_pk_bf16_f32 v18, v52, v53
    v_cvt_pk_bf16_f32 v34, v80, v81
    v_cvt_pk_bf16_f32 v25, v62, v63
    ds_read_b128 a[224:227], v1 offset:19456
    v_mfma_f32_16x16x32_bf16 v[76:79], a[232:235], a[188:191], v[76:79]
    s_waitcnt lgkmcnt(3)
    ds_read_b128 a[228:231], v0 offset:20480
    v_cvt_pk_bf16_f32 v35, v82, v83
    v_mfma_f32_16x16x32_bf16 v[80:83], a[212:215], a[168:171], 0
    s_waitcnt lgkmcnt(3)
    ds_read_b128 a[232:235], v1 offset:20480
    v_mfma_f32_16x16x32_bf16 v[80:83], a[216:219], a[172:175], v[80:83]
    s_waitcnt lgkmcnt(3)
    ds_read_b128 a[216:219], v1 offset:0
    v_mfma_f32_16x16x32_bf16 v[80:83], a[220:223], a[176:179], v[80:83]
    ds_read_b128 a[212:215], v0 offset:0
    s_waitcnt vmcnt(6)
    ds_read_b128 a[192:195], v104 offset:24576
    ds_read_b128 a[200:203], v104 offset:26624
    ds_read_b128 a[196:199], v105 offset:24576
    s_waitcnt lgkmcnt(6)
    v_mfma_f32_16x16x32_bf16 v[80:83], a[224:227], a[180:183], v[80:83]
    ds_read_b128 a[220:223], v0 offset:1024
    v_mfma_f32_16x16x32_bf16 v[80:83], a[228:231], a[184:187], v[80:83]
    s_waitcnt lgkmcnt(6)
    ds_read_b128 a[204:207], v105 offset:26624
    ds_read_b128 a[224:227], v1 offset:1024
    v_mfma_f32_16x16x32_bf16 v[80:83], a[232:235], a[188:191], v[80:83]
    ds_read_b128 a[228:231], v0 offset:2048
    ds_read_b128 a[232:235], v1 offset:2048
    s_waitcnt lgkmcnt(7)
    v_mfma_f32_16x16x32_bf16 v[84:87], a[212:215], a[192:195], 0
    s_waitcnt lgkmcnt(5)
    ds_read_b128 a[212:215], v0 offset:6144
    v_mfma_f32_16x16x32_bf16 v[84:87], a[216:219], a[196:199], v[84:87]
    s_waitcnt lgkmcnt(5)
    ds_read_b128 a[216:219], v1 offset:6144
    v_mfma_f32_16x16x32_bf16 v[84:87], a[220:223], a[200:203], v[84:87]
    ds_read_b128 a[220:223], v0 offset:7168
    s_waitcnt lgkmcnt(5)
    v_mfma_f32_16x16x32_bf16 v[84:87], a[224:227], a[204:207], v[84:87]
    s_waitcnt lgkmcnt(4)
    ds_read_b128 a[224:227], v1 offset:7168
    v_mfma_f32_16x16x32_bf16 v[84:87], a[228:231], a[208:211], v[84:87]
    s_waitcnt lgkmcnt(4)
    ds_read_b128 a[228:231], v0 offset:8192
    v_mfma_f32_16x16x32_bf16 v[84:87], a[232:235], v[92:95], v[84:87]
    ds_read_b128 a[232:235], v1 offset:8192
    s_waitcnt lgkmcnt(5)
    v_mfma_f32_16x16x32_bf16 v[88:91], a[212:215], a[192:195], 0
    s_waitcnt lgkmcnt(4)
    v_mfma_f32_16x16x32_bf16 v[88:91], a[216:219], a[196:199], v[88:91]
    s_waitcnt lgkmcnt(3)
    v_mfma_f32_16x16x32_bf16 v[88:91], a[220:223], a[200:203], v[88:91]
    s_waitcnt lgkmcnt(2)
    v_mfma_f32_16x16x32_bf16 v[88:91], a[224:227], a[204:207], v[88:91]
    s_waitcnt lgkmcnt(1)
    v_mfma_f32_16x16x32_bf16 v[88:91], a[228:231], a[208:211], v[88:91]
    v_max3_f32 v96, v84, v85, v86
    s_waitcnt vmcnt(63) lgkmcnt(0)
    s_barrier
    s_add_u32 m0, s22, 0
    ds_read_b128 a[216:219], v1 offset:12288
    buffer_load_dwordx4 v6, s[4:7], s20 offen lds
    v_mfma_f32_16x16x32_bf16 v[88:91], a[232:235], v[92:95], v[88:91]
    s_add_u32 s20, s20, 128
    s_add_u32 m0, s22, 1024
    ds_read_b128 a[212:215], v0 offset:12288
    buffer_load_dwordx4 v6, s[4:7], s20 offen lds
    s_add_u32 s20, s20, 128
    v_mfma_f32_16x16x32_bf16 v[44:47], a[248:251], v[32:35], v[44:47]
    s_add_u32 m0, s22, 2048
    ds_read_b128 a[224:227], v1 offset:13312
    buffer_load_dwordx4 v6, s[4:7], s20 offen lds
    ds_read_b128 a[228:231], v0 offset:14336
    ds_read_b128 a[232:235], v1 offset:14336
    ds_read_b128 a[220:223], v0 offset:13312
    s_add_u32 s20, s20, 12032
    v_max3_f32 v96, v96, v87, v88
    v_max3_f32 v96, v96, v89, v90
    v_max_f32 v96, v96, v91
    v_mov_b32 v97, v96
    s_mov_b32 s39, s64
    s_add_u32 s37, s37, 1
    v_permlane32_swap_b32 v97, v96
    v_max_f32 v96, v96, v97
    v_mov_b32 v97, v96
    s_bitcmp1_b32 s63, s37
    s_cselect_b32 s62, 4294770688, 0
    v_permlane16_swap_b32 v97, v96
    v_max_f32 v96, v96, v97
    s_cselect_b32 s42, 0, 325632
    v_mul_f32_e64 v13, -s28, v96
    v_fma_f32 v85, v85, s28, v13
    v_fma_f32 v87, v87, s28, v13
    v_fma_f32 v84, v84, s28, v13
    s_add_u32 s35, s35, s42
    v_exp_f32 v87, v87
    v_exp_f32 v84, v84
    v_fma_f32 v86, v86, s28, v13
    v_exp_f32 v85, v85
    v_exp_f32 v86, v86
    v_cvt_pk_bf16_f32 v38, v84, v85
    v_cvt_pk_bf16_f32 v39, v86, v87
    s_waitcnt lgkmcnt(3)
    v_mfma_f32_16x16x32_bf16 v[84:87], a[212:215], a[192:195], 0
    s_lshl_b32 s42, s37, 1
    ds_read_b128 a[212:215], v0 offset:18432
    s_lshr_b32 s42, s31, s42
    v_mfma_f32_16x16x32_bf16 v[84:87], a[216:219], a[196:199], v[84:87]
    s_waitcnt lgkmcnt(1)
    ds_read_b128 a[216:219], v1 offset:18432
    s_and_b32 s42, s42, 3
    v_mfma_f32_16x16x32_bf16 v[84:87], a[220:223], a[200:203], v[84:87]
    s_add_u32 s42, s42, s36
    ds_read_b128 a[220:223], v0 offset:19456
    s_sub_u32 s43, s42, 3
    v_mfma_f32_16x16x32_bf16 v[84:87], a[224:227], a[204:207], v[84:87]
    s_cmp_ge_u32 s42, 3
    ds_read_b128 a[224:227], v1 offset:19456
    s_cselect_b32 s42, s43, s42
    v_mfma_f32_16x16x32_bf16 v[84:87], a[228:231], a[208:211], v[84:87]
    s_mul_i32 s44, s3, 5
    s_mov_b32 s32, 1
    ds_read_b128 a[228:231], v0 offset:20480
    v_mfma_f32_16x16x32_bf16 v[84:87], a[232:235], v[92:95], v[84:87]
    s_lshl_b32 s43, s3, 2
    ds_read_b128 a[232:235], v1 offset:20480
    s_add_u32 s45, s43, 21
    v_fma_f32 v91, v91, s28, v13
    s_cmp_eq_u32 s3, 0
    v_fma_f32 v88, v88, s28, v13
    s_cselect_b32 s45, 20, s45
    v_fma_f32 v90, v90, s28, v13
    s_cselect_b32 s33, 1, 0
    s_cmp_eq_u32 s42, 1
    s_cselect_b32 s44, s45, s44
    s_cselect_b32 s32, s33, s32
    v_fma_f32 v89, v89, s28, v13
    s_add_u32 s45, s43, 37
    v_exp_f32 v88, v88
    v_exp_f32 v90, v90
    s_cmp_eq_u32 s42, 2
    s_cselect_b32 s44, s45, s44
    s_cselect_b32 s32, 0, s32
    s_mul_i32 s44, s44, 6144
    s_add_u32 s33, s35, s44
    s_mul_i32 s42, s32, 6144
    s_add_u32 s42, s42, 24576
    v_exp_f32 v89, v89
    s_add_u32 s42, s42, s33
    v_exp_f32 v91, v91
    s_cmp_ge_u32 s37, 6
    s_cselect_b32 s14, 0, s42
    v_cvt_pk_bf16_f32 v40, v88, v89
    s_add_u32 s24, s67, 256
    v_cvt_pk_bf16_f32 v41, v90, v91
    s_add_u32 s25, s33, 256
    s_add_u32 s23, s38, 4096
    s_mov_b32 s27, 0x249
    s_mov_b32 s30, 0
    s_waitcnt vmcnt(6) lgkmcnt(0)
    v_mfma_f32_16x16x32_bf16 v[88:91], a[212:215], a[192:195], 0
    s_barrier
    ds_read_b64_tr_b16 a[212:213], v2 offset:0
    ds_read_b64_tr_b16 a[214:215], v2 offset:6144
    v_mfma_f32_16x16x32_bf16 v[88:91], a[216:219], a[196:199], v[88:91]
    ds_read_b64_tr_b16 a[216:217], v3 offset:0
    ds_read_b64_tr_b16 a[218:219], v3 offset:6144
    s_add_u32 m0, s22, 12288
    s_nop 0
    buffer_load_dwordx4 v6, s[4:7], s20 offen lds
    s_add_u32 s20, s20, 128
    v_mfma_f32_16x16x32_bf16 v[88:91], a[220:223], a[200:203], v[88:91]
    s_add_u32 m0, s22, 13312
    s_nop 0
    buffer_load_dwordx4 v6, s[4:7], s20 offen lds
    s_add_u32 s20, s20, 128
    ds_read_b64_tr_b16 a[220:221], v4 offset:0
    v_mfma_f32_16x16x32_bf16 v[88:91], a[224:227], a[204:207], v[88:91]
    ds_read_b64_tr_b16 a[222:223], v4 offset:6144
    s_add_u32 m0, s22, 14336
    s_nop 0
    buffer_load_dwordx4 v6, s[4:7], s20 offen lds
    v_mfma_f32_16x16x32_bf16 v[44:47], a[252:255], v[38:41], v[44:47]
    ds_read_b64_tr_b16 a[224:225], v5 offset:0
    v_cvt_pk_bf16_f32 v24, v60, v61
    v_mfma_f32_16x16x32_bf16 v[88:91], a[228:231], a[208:211], v[88:91]
    s_add_u32 s20, s20, 12032
    ds_read_b64_tr_b16 a[226:227], v5 offset:6144
    v_mfma_f32_16x16x32_bf16 v[88:91], a[232:235], v[92:95], v[88:91]
    s_waitcnt lgkmcnt(4)
    v_mfma_f32_16x16x32_bf16 v[112:115], a[212:215], v[14:17], 0
    ds_read_b64_tr_b16 a[228:229], v2 offset:1024
    v_fma_f32 v70, v70, s28, v11
    v_mfma_f32_16x16x32_bf16 v[116:119], a[216:219], v[14:17], 0
    v_fma_f32 v59, v59, s28, v9
    v_fma_f32 v69, v69, s28, v11
    v_mfma_f32_16x16x32_bf16 v[164:167], a[216:219], v[20:23], 0
    v_fma_f32 v78, v78, s28, v12
    v_mfma_f32_16x16x32_bf16 v[160:163], a[212:215], v[20:23], 0
    v_exp_f32 v78, v78
    v_mfma_f32_16x16x32_bf16 v[208:211], a[212:215], v[26:29], 0
    ds_read_b64_tr_b16 a[232:233], v3 offset:1024
    v_mfma_f32_16x16x32_bf16 v[212:215], a[216:219], v[26:29], 0
    ds_read_b64_tr_b16 a[230:231], v2 offset:7168
    v_fma_f32 v79, v79, s28, v12
    v_mfma_f32_16x16x32_bf16 a[4:7], a[216:219], v[32:35], 0
    ds_read_b64_tr_b16 a[234:235], v3 offset:7168
    v_fma_f32 v56, v56, s28, v9
    v_mfma_f32_16x16x32_bf16 a[0:3], a[212:215], v[32:35], 0
    v_fma_f32 v67, v67, s28, v10
    v_fma_f32 v58, v58, s28, v9
    v_mfma_f32_16x16x32_bf16 a[48:51], a[212:215], v[38:41], 0
    v_fma_f32 v80, v80, s28, v12
    v_fma_f32 v81, v81, s28, v12
    v_mfma_f32_16x16x32_bf16 a[52:55], a[216:219], v[38:41], 0
    s_waitcnt lgkmcnt(4)
    v_fma_f32 v65, v65, s28, v10
    v_mfma_f32_16x16x32_bf16 a[56:59], a[220:223], v[38:41], 0
    v_fma_f32 v77, v77, s28, v12
    v_fma_f32 v68, v68, s28, v11
    v_mfma_f32_16x16x32_bf16 a[60:63], a[224:227], v[38:41], 0
    ds_read_b64_tr_b16 a[214:215], v4 offset:7168
    v_fma_f32 v89, v89, s28, v13
    v_mfma_f32_16x16x32_bf16 a[12:15], a[224:227], v[32:35], 0
    ds_read_b64_tr_b16 a[216:217], v5 offset:1024
    v_mfma_f32_16x16x32_bf16 a[8:11], a[220:223], v[32:35], 0
    v_exp_f32 v69, v69
    v_mfma_f32_16x16x32_bf16 v[216:219], a[220:223], v[26:29], 0
    v_fma_f32 v87, v87, s28, v13
    v_fma_f32 v86, v86, s28, v13
    v_mfma_f32_16x16x32_bf16 v[220:223], a[224:227], v[26:29], 0
    v_fma_f32 v84, v84, s28, v13
    v_fma_f32 v90, v90, s28, v13
    v_mfma_f32_16x16x32_bf16 v[172:175], a[224:227], v[20:23], 0
    v_mfma_f32_16x16x32_bf16 v[168:171], a[220:223], v[20:23], 0
    ds_read_b64_tr_b16 a[218:219], v5 offset:7168
    v_mfma_f32_16x16x32_bf16 v[120:123], a[220:223], v[14:17], 0
    v_exp_f32 v86, v86
    v_mfma_f32_16x16x32_bf16 v[124:127], a[224:227], v[14:17], 0
    s_waitcnt lgkmcnt(3)
    ds_read_b64_tr_b16 a[212:213], v4 offset:1024
    v_fma_f32 v71, v71, s28, v11
    v_mfma_f32_16x16x32_bf16 v[128:131], a[228:231], v[14:17], 0
    ds_read_b64_tr_b16 a[224:225], v3 offset:2048
    v_mfma_f32_16x16x32_bf16 v[132:135], a[232:235], v[14:17], 0
    v_fma_f32 v88, v88, s28, v13
    v_fma_f32 v73, v73, s28, v11
    v_mfma_f32_16x16x32_bf16 v[180:183], a[232:235], v[20:23], 0
    ds_read_b64_tr_b16 a[222:223], v2 offset:8192
    v_fma_f32 v74, v74, s28, v11
    v_mfma_f32_16x16x32_bf16 v[176:179], a[228:231], v[20:23], 0
    v_exp_f32 v77, v77
    v_mfma_f32_16x16x32_bf16 v[224:227], a[228:231], v[26:29], 0
    v_exp_f32 v89, v89
    v_mfma_f32_16x16x32_bf16 v[228:231], a[232:235], v[26:29], 0
    v_exp_f32 v84, v84
    v_mfma_f32_16x16x32_bf16 a[20:23], a[232:235], v[32:35], 0
    v_exp_f32 v67, v67
    v_mfma_f32_16x16x32_bf16 a[16:19], a[228:231], v[32:35], 0
    ds_read_b64_tr_b16 a[220:221], v2 offset:2048
    v_mfma_f32_16x16x32_bf16 a[64:67], a[228:231], v[38:41], 0
    s_add_u32 s39, s39, 12288
    v_exp_f32 v88, v88
    v_mfma_f32_16x16x32_bf16 a[68:71], a[232:235], v[38:41], 0
    s_waitcnt lgkmcnt(3)
    ds_read_b64_tr_b16 a[232:233], v5 offset:2048
    v_fma_f32 v72, v72, s28, v11
    v_mfma_f32_16x16x32_bf16 a[72:75], a[212:215], v[38:41], 0
    ds_read_b64_tr_b16 a[226:227], v3 offset:8192
    v_fma_f32 v75, v75, s28, v11
    v_mfma_f32_16x16x32_bf16 a[76:79], a[216:219], v[38:41], 0
    v_fma_f32 v83, v83, s28, v12
    v_mfma_f32_16x16x32_bf16 a[28:31], a[216:219], v[32:35], 0
    ds_read_b64_tr_b16 a[228:229], v4 offset:2048
    v_fma_f32 v76, v76, s28, v12
    v_mfma_f32_16x16x32_bf16 a[24:27], a[212:215], v[32:35], 0
    v_exp_f32 v76, v76
    v_mfma_f32_16x16x32_bf16 v[232:235], a[212:215], v[26:29], 0
    ds_read_b64_tr_b16 a[230:231], v4 offset:8192
    v_mfma_f32_16x16x32_bf16 v[236:239], a[216:219], v[26:29], 0
    ds_read_b64_tr_b16 a[234:235], v5 offset:8192
    v_add_u32 v103, 4096, v103
    v_mfma_f32_16x16x32_bf16 v[188:191], a[216:219], v[20:23], 0
    v_exp_f32 v79, v79
    v_mfma_f32_16x16x32_bf16 v[184:187], a[212:215], v[20:23], 0
    v_fma_f32 v57, v57, s28, v9
    v_mfma_f32_16x16x32_bf16 v[136:139], a[212:215], v[14:17], 0
    v_exp_f32 v73, v73
    v_mfma_f32_16x16x32_bf16 v[140:143], a[216:219], v[14:17], 0
    s_waitcnt lgkmcnt(4)
    v_exp_f32 v72, v72
    v_mfma_f32_16x16x32_bf16 v[144:147], a[220:223], v[14:17], 0
    s_waitcnt lgkmcnt(3)
    v_exp_f32 v83, v83
    v_mfma_f32_16x16x32_bf16 v[148:151], a[224:227], v[14:17], 0
    v_exp_f32 v57, v57
    v_mfma_f32_16x16x32_bf16 v[196:199], a[224:227], v[20:23], 0
    v_exp_f32 v68, v68
    v_mfma_f32_16x16x32_bf16 v[192:195], a[220:223], v[20:23], 0
    v_exp_f32 v70, v70
    v_mfma_f32_16x16x32_bf16 v[240:243], a[220:223], v[26:29], 0
    v_exp_f32 v58, v58
    v_mfma_f32_16x16x32_bf16 v[244:247], a[224:227], v[26:29], 0
    v_exp_f32 v71, v71
    v_mfma_f32_16x16x32_bf16 a[36:39], a[224:227], v[32:35], 0
    v_cvt_pk_bf16_f32 v30, v68, v69
    v_fma_f32 v85, v85, s28, v13
    v_mfma_f32_16x16x32_bf16 a[32:35], a[220:223], v[32:35], 0
    v_exp_f32 v56, v56
    v_mfma_f32_16x16x32_bf16 a[80:83], a[220:223], v[38:41], 0
    s_waitcnt vmcnt(3) lgkmcnt(0)
    v_exp_f32 v74, v74
    v_mfma_f32_16x16x32_bf16 a[84:87], a[224:227], v[38:41], 0
    s_barrier
    ds_read_b128 a[212:215], v0 offset:0
    v_mfma_f32_16x16x32_bf16 a[88:91], a[228:231], v[38:41], 0
    ds_read_b128 a[216:219], v1 offset:0
    v_cvt_pk_bf16_f32 v31, v70, v71
    v_mfma_f32_16x16x32_bf16 a[92:95], a[232:235], v[38:41], 0
    ds_read_b128 a[220:223], v0 offset:1024
    s_add_u32 m0, s22, 24576
    v_mfma_f32_16x16x32_bf16 a[44:47], a[232:235], v[32:35], 0
    buffer_load_dwordx4 v6, s[8:11], s21 offen lds
    v_mfma_f32_16x16x32_bf16 a[40:43], a[228:231], v[32:35], 0
    v_exp_f32 v59, v59
    v_mfma_f32_16x16x32_bf16 v[248:251], a[228:231], v[26:29], 0
    s_add_u32 s21, s21, 128
    s_add_u32 m0, s22, 25600
    ds_read_b128 a[224:227], v1 offset:1024
    v_mfma_f32_16x16x32_bf16 v[252:255], a[232:235], v[26:29], 0
    buffer_load_dwordx4 v6, s[8:11], s21 offen lds
    v_mfma_f32_16x16x32_bf16 v[204:207], a[232:235], v[20:23], 0
    s_add_u32 s21, s21, 128
    v_fma_f32 v82, v82, s28, v12
    s_add_u32 m0, s22, 26624
    v_mfma_f32_16x16x32_bf16 v[200:203], a[228:231], v[20:23], 0
    v_exp_f32 v87, v87
    v_mfma_f32_16x16x32_bf16 v[152:155], a[228:231], v[14:17], 0
    buffer_load_dwordx4 v6, s[8:11], s21 offen lds
    v_mfma_f32_16x16x32_bf16 v[156:159], a[232:235], v[14:17], 0
    s_waitcnt lgkmcnt(3)
    ds_read_b128 a[232:235], v1 offset:2048
    v_mfma_f32_16x16x32_bf16 v[52:55], a[212:215], a[96:99], 0
    s_waitcnt lgkmcnt(3)
    v_fma_f32 v64, v64, s28, v10
    v_fma_f32 v91, v91, s28, v13
    v_mfma_f32_16x16x32_bf16 v[52:55], a[216:219], a[100:103], v[52:55]
    s_waitcnt lgkmcnt(2)
    v_cvt_pk_bf16_f32 v16, v56, v57
    v_cvt_pk_bf16_f32 v36, v76, v77
    v_mfma_f32_16x16x32_bf16 v[52:55], a[220:223], a[104:107], v[52:55]
    ds_read_b128 a[228:231], v0 offset:2048
    v_mfma_f32_16x16x32_bf16 v[60:63], a[220:223], a[128:131], 0
    v_cvt_pk_bf16_f32 v37, v78, v79
    v_cvt_pk_bf16_f32 v43, v86, v87
    v_mfma_f32_16x16x32_bf16 v[60:63], a[216:219], a[124:127], v[60:63]
    v_exp_f32 v85, v85
    v_mfma_f32_16x16x32_bf16 v[60:63], a[212:215], a[120:123], v[60:63]
    v_exp_f32 v81, v81
    v_mfma_f32_16x16x32_bf16 v[68:71], a[212:215], a[144:147], 0
    v_mfma_f32_16x16x32_bf16 v[68:71], a[216:219], a[148:151], v[68:71]
    v_cvt_pk_bf16_f32 v42, v84, v85
    v_mfma_f32_16x16x32_bf16 v[68:71], a[220:223], a[152:155], v[68:71]
    s_add_u32 s21, s21, 12032
    v_exp_f32 v91, v91
    v_mfma_f32_16x16x32_bf16 v[76:79], a[220:223], a[176:179], 0
    v_exp_f32 v80, v80
    v_mfma_f32_16x16x32_bf16 v[76:79], a[216:219], a[172:175], v[76:79]
    v_cvt_pk_bf16_f32 v28, v72, v73
    v_mfma_f32_16x16x32_bf16 v[76:79], a[212:215], a[168:171], v[76:79]
    v_exp_f32 v82, v82
    v_mfma_f32_16x16x32_bf16 v[84:87], a[212:215], a[192:195], 0
    v_cvt_pk_bf16_f32 v17, v58, v59
    v_mfma_f32_16x16x32_bf16 v[84:87], a[216:219], a[196:199], v[84:87]
    s_add_u32 m0, s38, 0
    ds_read_b128 a[212:215], v0 offset:6144
    v_mfma_f32_16x16x32_bf16 v[84:87], a[220:223], a[200:203], v[84:87]
    s_waitcnt lgkmcnt(1)
    v_mfma_f32_16x16x32_bf16 v[84:87], a[224:227], a[204:207], v[84:87]
    v_exp_f32 v90, v90
    v_mfma_f32_16x16x32_bf16 v[48:51], a[236:239], v[16:19], v[44:47]
    buffer_load_dwordx4 v6, s[12:15], s33 offen nt lds
    v_mfma_f32_16x16x32_bf16 v[84:87], a[228:231], a[208:211], v[84:87]
    v_exp_f32 v65, v65
    v_mfma_f32_16x16x32_bf16 v[84:87], a[232:235], v[92:95], v[84:87]
    v_mfma_f32_16x16x32_bf16 v[76:79], a[232:235], a[188:191], v[76:79]
    v_exp_f32 v75, v75
    v_mfma_f32_16x16x32_bf16 v[76:79], a[228:231], a[184:187], v[76:79]
    ds_read_b128 a[220:223], v0 offset:7168
    v_cvt_pk_bf16_f32 v41, v90, v91
    v_mfma_f32_16x16x32_bf16 v[76:79], a[224:227], a[180:183], v[76:79]
    ds_read_b128 a[216:219], v1 offset:6144
    v_fma_f32 v66, v66, s28, v10
    v_mfma_f32_16x16x32_bf16 v[68:71], a[224:227], a[156:159], v[68:71]
    v_exp_f32 v64, v64
    v_mfma_f32_16x16x32_bf16 v[68:71], a[228:231], a[160:163], v[68:71]
    v_mfma_f32_16x16x32_bf16 v[68:71], a[232:235], a[164:167], v[68:71]
    v_exp_f32 v66, v66
    v_mfma_f32_16x16x32_bf16 v[60:63], a[232:235], a[140:143], v[60:63]
    v_mfma_f32_16x16x32_bf16 v[60:63], a[228:231], a[136:139], v[60:63]
    v_cvt_pk_bf16_f32 v35, v82, v83
    v_cvt_pk_bf16_f32 v34, v80, v81
    v_mfma_f32_16x16x32_bf16 v[60:63], a[224:227], a[132:135], v[60:63]
    v_cvt_pk_bf16_f32 v29, v74, v75
    v_mfma_f32_16x16x32_bf16 v[52:55], a[224:227], a[108:111], v[52:55]
    v_cvt_pk_bf16_f32 v22, v64, v65
    v_mfma_f32_16x16x32_bf16 v[52:55], a[228:231], a[112:115], v[52:55]
    ds_read_b128 a[228:231], v0 offset:8192
    v_cvt_pk_bf16_f32 v23, v66, v67
    v_mfma_f32_16x16x32_bf16 v[52:55], a[232:235], a[116:119], v[52:55]
    ds_read_b128 a[232:235], v1 offset:8192
    v_cvt_pk_bf16_f32 v40, v88, v89
    v_mfma_f32_16x16x32_bf16 v[48:51], a[240:243], v[22:25], v[48:51]
    s_add_u32 m0, s38, 1024
    ds_read_b128 a[224:227], v1 offset:7168
    v_mfma_f32_16x16x32_bf16 v[48:51], a[244:247], v[28:31], v[48:51]
    buffer_load_dwordx4 v7, s[12:15], s33 offen nt lds
    v_mfma_f32_16x16x32_bf16 v[48:51], a[248:251], v[34:37], v[48:51]
    v_mfma_f32_16x16x32_bf16 v[48:51], a[252:255], v[40:43], v[48:51]
    s_add_u32 s59, s33, 128
    s_add_u32 m0, s38, 2048
    s_waitcnt lgkmcnt(3)
    v_mfma_f32_16x16x32_bf16 v[56:59], a[212:215], a[96:99], 0
    buffer_load_dwordx4 v6, s[12:15], s59 offen nt lds
    v_mfma_f32_16x16x32_bf16 v[56:59], a[216:219], a[100:103], v[56:59]
    s_add_u32 m0, s38, 3072
    s_nop 0
    v_cmp_lt_f32 vcc, s29, v48
    v_mfma_f32_16x16x32_bf16 v[56:59], a[220:223], a[104:107], v[56:59]
    v_mfma_f32_16x16x32_bf16 v[64:67], a[220:223], a[128:131], 0
    v_mfma_f32_16x16x32_bf16 v[64:67], a[216:219], a[124:127], v[64:67]
    buffer_load_dwordx4 v7, s[12:15], s59 offen nt lds
    v_mfma_f32_16x16x32_bf16 v[64:67], a[212:215], a[120:123], v[64:67]
    s_cbranch_vccnz L_rs_start5b
L_ret_start5b:
    v_fma_f32 v61, v61, s28, v10
    v_mfma_f32_16x16x32_bf16 v[72:75], a[212:215], a[144:147], 0
    v_fma_f32 v52, v52, s28, v9
    v_fma_f32 v54, v54, s28, v9
    v_mfma_f32_16x16x32_bf16 v[72:75], a[216:219], a[148:151], v[72:75]
    v_exp_f32 v54, v54
    v_mfma_f32_16x16x32_bf16 v[72:75], a[220:223], a[152:155], v[72:75]
    s_waitcnt vmcnt(13) lgkmcnt(0)
    s_add_u32 m0, s22, 0
    v_fma_f32 v55, v55, s28, v9
    v_mfma_f32_16x16x32_bf16 v[80:83], a[220:223], a[176:179], 0
    s_barrier
    v_mfma_f32_16x16x32_bf16 v[80:83], a[216:219], a[172:175], v[80:83]
    buffer_load_dwordx4 v6, s[4:7], s20 offen lds
    v_mfma_f32_16x16x32_bf16 v[80:83], a[212:215], a[168:171], v[80:83]
    s_add_u32 s20, s20, 128
    v_exp_f32 v61, v61
    v_mfma_f32_16x16x32_bf16 v[88:91], a[212:215], a[192:195], 0
    s_add_u32 m0, s22, 1024
    ds_read_b64_tr_b16 a[212:213], v2 offset:18432
    v_fma_f32 v60, v60, s28, v10
    v_mfma_f32_16x16x32_bf16 v[88:91], a[216:219], a[196:199], v[88:91]
    ds_read_b64_tr_b16 a[214:215], v2 offset:12288
    v_mfma_f32_16x16x32_bf16 v[88:91], a[220:223], a[200:203], v[88:91]
    buffer_load_dwordx4 v6, s[4:7], s20 offen lds
    v_mfma_f32_16x16x32_bf16 v[88:91], a[224:227], a[204:207], v[88:91]
    ds_read_b64_tr_b16 a[216:217], v3 offset:18432
    v_fma_f32 v53, v53, s28, v9
    v_mfma_f32_16x16x32_bf16 v[88:91], a[228:231], a[208:211], v[88:91]
    s_add_u32 s20, s20, 128
    ds_read_b64_tr_b16 a[218:219], v3 offset:12288
    v_fma_f32 v63, v63, s28, v10
    v_mfma_f32_16x16x32_bf16 v[88:91], a[232:235], v[92:95], v[88:91]
    s_add_u32 m0, s22, 2048
    v_exp_f32 v53, v53
    v_mfma_f32_16x16x32_bf16 v[80:83], a[232:235], a[188:191], v[80:83]
    buffer_load_dwordx4 v6, s[4:7], s20 offen lds
    v_mfma_f32_16x16x32_bf16 v[80:83], a[228:231], a[184:187], v[80:83]
    v_exp_f32 v63, v63
    v_mfma_f32_16x16x32_bf16 v[80:83], a[224:227], a[180:183], v[80:83]
    v_exp_f32 v55, v55
    v_mfma_f32_16x16x32_bf16 v[72:75], a[224:227], a[156:159], v[72:75]
    s_add_u32 s20, s20, 12032
    v_exp_f32 v60, v60
    v_mfma_f32_16x16x32_bf16 v[72:75], a[228:231], a[160:163], v[72:75]
    v_cvt_pk_bf16_f32 v20, v60, v61
    v_fma_f32 v62, v62, s28, v10
    v_mfma_f32_16x16x32_bf16 v[72:75], a[232:235], a[164:167], v[72:75]
    v_exp_f32 v62, v62
    v_mfma_f32_16x16x32_bf16 v[64:67], a[232:235], a[140:143], v[64:67]
    v_exp_f32 v52, v52
    v_mfma_f32_16x16x32_bf16 v[64:67], a[228:231], a[136:139], v[64:67]
    ds_read_b64_tr_b16 a[220:221], v4 offset:18432
    v_cvt_pk_bf16_f32 v21, v62, v63
    v_mfma_f32_16x16x32_bf16 v[64:67], a[224:227], a[132:135], v[64:67]
    s_waitcnt lgkmcnt(1)
    s_bitcmp1_b32 s3, 1
    ds_read_b64_tr_b16 a[222:223], v4 offset:12288
    v_mfma_f32_16x16x32_bf16 v[56:59], a[224:227], a[108:111], v[56:59]
    ds_read_b64_tr_b16 a[224:225], v5 offset:18432
    v_cvt_pk_bf16_f32 v15, v54, v55
    v_mfma_f32_16x16x32_bf16 v[56:59], a[228:231], a[112:115], v[56:59]
    ds_read_b64_tr_b16 a[226:227], v5 offset:12288
    v_cvt_pk_bf16_f32 v14, v52, v53
    v_mfma_f32_16x16x32_bf16 v[56:59], a[232:235], a[116:119], v[56:59]
    s_cbranch_scc1 L_loop5w1
    s_branch L_loop5w0
L_start4:
    s_add_u32 m0, s22, 0
    s_nop 0
    buffer_load_dwordx4 v6, s[4:7], s20 offen lds
    s_add_u32 s20, s20, 128
    s_add_u32 m0, s22, 1024
    s_nop 0
    buffer_load_dwordx4 v6, s[4:7], s20 offen lds
    s_add_u32 s20, s20, 128
    s_add_u32 m0, s22, 2048
    s_nop 0
    buffer_load_dwordx4 v6, s[4:7], s20 offen lds
    s_add_u32 s20, s20, 12032
    s_add_u32 m0, s22, 12288
    s_nop 0
    buffer_load_dwordx4 v6, s[4:7], s20 offen lds
    s_add_u32 s20, s20, 128
    s_add_u32 m0, s22, 13312
    s_nop 0
    buffer_load_dwordx4 v6, s[4:7], s20 offen lds
    s_add_u32 s20, s20, 128
    s_add_u32 m0, s22, 14336
    s_nop 0
    buffer_load_dwordx4 v6, s[4:7], s20 offen lds
    s_add_u32 s20, s20, 12032
    s_add_u32 s48, s34, 0
    s_add_u32 m0, s38, 0
    s_nop 0
    buffer_load_dwordx4 v6, s[12:15], s48 offen nt lds
    s_add_u32 m0, s38, 1024
    s_nop 0
    buffer_load_dwordx4 v7, s[12:15], s48 offen nt lds
    s_add_u32 s48, s34, 128
    s_add_u32 m0, s38, 2048
    s_nop 0
    buffer_load_dwordx4 v6, s[12:15], s48 offen nt lds
    s_add_u32 m0, s38, 3072
    s_nop 0
    buffer_load_dwordx4 v7, s[12:15], s48 offen nt lds
    s_add_u32 s48, s34, 256
    s_add_u32 m0, s38, 4096
    s_nop 0
    buffer_load_dwordx4 v6, s[12:15], s48 offen nt lds
    s_add_u32 m0, s38, 5120
    s_nop 0
    buffer_load_dwordx4 v7, s[12:15], s48 offen nt lds
    s_add_u32 s48, s34, 6144
    s_add_u32 m0, s38, 6144
    s_nop 0
    buffer_load_dwordx4 v6, s[12:15], s48 offen nt lds
    s_add_u32 m0, s38, 7168
    s_nop 0
    buffer_load_dwordx4 v7, s[12:15], s48 offen nt lds
    s_add_u32 s48, s34, 6272
    s_add_u32 m0, s38, 8192
    s_nop 0
    buffer_load_dwordx4 v6, s[12:15], s48 offen nt lds
    s_add_u32 m0, s38, 9216
    s_nop 0
    buffer_load_dwordx4 v7, s[12:15], s48 offen nt lds
    s_add_u32 s48, s34, 6400
    s_add_u32 m0, s38, 10240
    s_nop 0
    buffer_load_dwordx4 v6, s[12:15], s48 offen nt lds
    s_add_u32 m0, s38, 11264
    s_nop 0
    buffer_load_dwordx4 v7, s[12:15], s48 offen nt lds
    s_add_u32 s48, s34, 12288
    s_add_u32 m0, s38, 12288
    s_nop 0
    buffer_load_dwordx4 v6, s[12:15], s48 offen nt lds
    s_add_u32 m0, s38, 13312
    s_nop 0
    buffer_load_dwordx4 v7, s[12:15], s48 offen nt lds
    s_add_u32 s48, s34, 12416
    s_add_u32 m0, s38, 14336
    s_nop 0
    buffer_load_dwordx4 v6, s[12:15], s48 offen nt lds
    s_add_u32 m0, s38, 15360
    s_nop 0
    buffer_load_dwordx4 v7, s[12:15], s48 offen nt lds
    s_add_u32 s48, s34, 12544
    s_add_u32 m0, s38, 16384
    s_nop 0
    buffer_load_dwordx4 v6, s[12:15], s48 offen nt lds
    s_add_u32 m0, s38, 17408
    s_nop 0
    buffer_load_dwordx4 v7, s[12:15], s48 offen nt lds
    v_and_b32 v96, 15, v111
    v_lshrrev_b32 v97, 4, v111
    v_lshrrev_b32 v98, 3, v96
    v_and_b32 v99, 7, v96
    v_lshlrev_b32 v0, 7, v99
    v_bfe_u32 v99, v96, 1, 2
    v_lshlrev_b32 v99, 1, v99
    v_mul_u32_u24 v100, 5, v98
    v_xor_b32 v99, v99, v100
    v_xor_b32 v99, v99, v97
    v_lshl_add_u32 v0, v99, 4, v0
    v_mul_u32_u24 v100, 3072, v98
    v_add_u32 v0, v100, v0
    v_xor_b32 v1, 64, v0
    v_lshrrev_b32 v98, 1, v97
    v_mul_u32_u24 v2, 3072, v98
    v_and_b32 v99, 1, v97
    v_bfe_u32 v100, v111, 2, 2
    v_lshl_add_u32 v96, v99, 2, v100
    v_lshl_add_u32 v2, v96, 7, v2
    v_lshrrev_b32 v96, 1, v96
    v_lshlrev_b32 v96, 1, v96
    v_mul_u32_u24 v98, 5, v98
    v_xor_b32 v96, v96, v98
    v_bfe_u32 v99, v111, 1, 1
    v_xor_b32 v96, v96, v99
    v_lshl_add_u32 v2, v96, 4, v2
    v_and_b32 v99, 1, v111
    v_lshl_add_u32 v2, v99, 3, v2
    v_add_u32 v2, 24576, v2
    v_xor_b32 v3, 32, v2
    v_xor_b32 v4, 64, v2
    v_xor_b32 v5, 96, v2
    v_lshl_add_u32 v103, v111, 4, s38
    v_and_b32 v96, 15, v111
    s_mov_b32 s42, 0x1011
    v_bfe_i32 v97, s42, v96, 1
    v_and_b32 v97, 0x3f803f80, v97
    v_accvgpr_write_b32 a236, v97
    v_accvgpr_write_b32 a237, v97
    v_accvgpr_write_b32 a238, v97
    v_accvgpr_write_b32 a239, v97
    s_mov_b32 s42, 0x3222
    v_bfe_i32 v97, s42, v96, 1
    v_and_b32 v97, 0x3f803f80, v97
    v_accvgpr_write_b32 a240, v97
    v_accvgpr_write_b32 a241, v97
    v_accvgpr_write_b32 a242, v97
    v_accvgpr_write_b32 a243, v97
    s_mov_b32 s42, 0x5444
    v_bfe_i32 v97, s42, v96, 1
    v_and_b32 v97, 0x3f803f80, v97
    v_accvgpr_write_b32 a244, v97
    v_accvgpr_write_b32 a245, v97
    v_accvgpr_write_b32 a246, v97
    v_accvgpr_write_b32 a247, v97
    s_mov_b32 s42, 0x9888
    v_bfe_i32 v97, s42, v96, 1
    v_and_b32 v97, 0x3f803f80, v97
    v_accvgpr_write_b32 a248, v97
    v_accvgpr_write_b32 a249, v97
    v_accvgpr_write_b32 a250, v97
    v_accvgpr_write_b32 a251, v97
    s_mov_b32 s42, 0x1100
    v_bfe_i32 v97, s42, v96, 1
    v_and_b32 v97, 0x3f803f80, v97
    v_accvgpr_write_b32 a252, v97
    v_accvgpr_write_b32 a253, v97
    v_accvgpr_write_b32 a254, v97
    v_accvgpr_write_b32 a255, v97
    s_waitcnt vmcnt(18)
    s_barrier
    s_waitcnt vmcnt(12)
    s_add_u32 s48, s34, 18432
    s_add_u32 m0, s38, 18432
    s_nop 0
    buffer_load_dwordx4 v6, s[12:15], s48 offen nt lds
    s_add_u32 m0, s38, 19456
    s_nop 0
    buffer_load_dwordx4 v7, s[12:15], s48 offen nt lds
    s_add_u32 s48, s34, 18560
    ds_read_b128 a[212:215], v0 offset:0
    s_add_u32 m0, s38, 20480
    s_nop 0
    buffer_load_dwordx4 v6, s[12:15], s48 offen nt lds
    v_lshrrev_b32 v105, 11, v0
    s_add_u32 m0, s38, 21504
    v_xor_b32 v105, s65, v105
    v_and_b32 v104, 0x3ff, v0
    v_lshl_add_u32 v104, v105, 10, v104
    v_add_u32 v104, s38, v104
    buffer_load_dwordx4 v7, s[12:15], s48 offen nt lds
    s_add_u32 s48, s34, 18688
    ds_read_b128 a[220:223], v0 offset:1024
    s_add_u32 m0, s38, 22528
    s_nop 0
    buffer_load_dwordx4 v6, s[12:15], s48 offen nt lds
    ds_read_b128 a[96:99], v104 offset:0
    s_add_u32 m0, s38, 23552
    s_nop 0
    buffer_load_dwordx4 v7, s[12:15], s48 offen nt lds
    ds_read_b128 a[228:231], v0 offset:2048
    s_waitcnt lgkmcnt(1)
    v_mfma_f32_16x16x32_bf16 v[52:55], a[212:215], a[96:99], 0
    v_xor_b32 v105, 64, v104
    ds_read_b128 a[104:107], v104 offset:2048
    ds_read_b128 a[216:219], v1 offset:0
    ds_read_b128 a[100:103], v105 offset:0
    ds_read_b128 a[224:227], v1 offset:1024
    s_waitcnt lgkmcnt(1)
    v_mfma_f32_16x16x32_bf16 v[52:55], a[216:219], a[100:103], v[52:55]
    ds_read_b128 a[108:111], v105 offset:2048
    ds_read_b128 a[232:235], v1 offset:2048
    ds_read_b128 a[112:115], v104 offset:4096
    v_mfma_f32_16x16x32_bf16 v[52:55], a[220:223], a[104:107], v[52:55]
    ds_read_b128 a[212:215], v0 offset:6144
    s_waitcnt lgkmcnt(3)
    v_mfma_f32_16x16x32_bf16 v[52:55], a[224:227], a[108:111], v[52:55]
    s_waitcnt lgkmcnt(1)
    ds_read_b128 a[216:219], v1 offset:6144
    v_mfma_f32_16x16x32_bf16 v[52:55], a[228:231], a[112:115], v[52:55]
    ds_read_b128 a[116:119], v105 offset:4096
    s_waitcnt lgkmcnt(0)
    v_mfma_f32_16x16x32_bf16 v[52:55], a[232:235], a[116:119], v[52:55]
    ds_read_b128 a[220:223], v0 offset:7168
    v_mfma_f32_16x16x32_bf16 v[56:59], a[212:215], a[96:99], 0
    ds_read_b128 a[224:227], v1 offset:7168
    v_mfma_f32_16x16x32_bf16 v[56:59], a[216:219], a[100:103], v[56:59]
    ds_read_b128 a[212:215], v0 offset:12288
    s_waitcnt lgkmcnt(2)
    v_mfma_f32_16x16x32_bf16 v[56:59], a[220:223], a[104:107], v[56:59]
    ds_read_b128 a[216:219], v1 offset:12288
    ds_read_b128 a[228:231], v0 offset:8192
    s_waitcnt lgkmcnt(3)
    v_mfma_f32_16x16x32_bf16 v[56:59], a[224:227], a[108:111], v[56:59]
    ds_read_b128 a[232:235], v1 offset:8192
    s_waitcnt lgkmcnt(1)
    v_mfma_f32_16x16x32_bf16 v[56:59], a[228:231], a[112:115], v[56:59]
    ds_read_b128 a[228:231], v0 offset:14336
    v_max3_f32 v96, v52, v53, v54
    s_waitcnt lgkmcnt(1)
    v_mfma_f32_16x16x32_bf16 v[56:59], a[232:235], a[116:119], v[56:59]
    s_nop 7
    v_max3_f32 v96, v96, v55, v56
    v_max3_f32 v96, v96, v57, v58
    ds_read_b128 a[220:223], v0 offset:13312
    ds_read_b128 a[224:227], v1 offset:13312
    v_max_f32 v96, v96, v59
    v_mov_b32 v97, v96
    s_nop 1
    v_permlane32_swap_b32 v97, v96
    v_max_f32 v96, v96, v97
    v_mov_b32 v97, v96
    s_nop 1
    v_permlane16_swap_b32 v97, v96
    v_max_f32 v96, v96, v97
    v_mul_f32_e64 v9, -s28, v96
    v_fma_f32 v58, v58, s28, v9
    ds_read_b128 a[232:235], v1 offset:14336
    v_fma_f32 v52, v52, s28, v9
    v_fma_f32 v59, v59, s28, v9
    v_fma_f32 v53, v53, s28, v9
    v_fma_f32 v55, v55, s28, v9
    v_exp_f32 v52, v52
    v_exp_f32 v55, v55
    v_exp_f32 v53, v53
    v_fma_f32 v54, v54, s28, v9
    v_exp_f32 v59, v59
    v_exp_f32 v54, v54
    s_nop 0
    v_cvt_pk_bf16_f32 v15, v54, v55
    s_waitcnt vmcnt(12)
    s_add_u32 m0, s22, 24576
    ds_read_b128 a[128:131], v104 offset:8192
    buffer_load_dwordx4 v6, s[8:11], s21 offen lds
    v_cvt_pk_bf16_f32 v14, v52, v53
    s_add_u32 s21, s21, 128
    v_mfma_f32_16x16x32_bf16 v[52:55], a[212:215], a[96:99], 0
    s_add_u32 m0, s22, 25600
    s_nop 0
    buffer_load_dwordx4 v6, s[8:11], s21 offen lds
    s_add_u32 s21, s21, 128
    ds_read_b128 a[140:143], v105 offset:10240
    v_mfma_f32_16x16x32_bf16 v[52:55], a[216:219], a[100:103], v[52:55]
    s_add_u32 m0, s22, 26624
    v_fma_f32 v56, v56, s28, v9
    buffer_load_dwordx4 v6, s[8:11], s21 offen lds
    v_exp_f32 v58, v58
    ds_read_b128 a[212:215], v0 offset:18432
    s_waitcnt lgkmcnt(3)
    v_mfma_f32_16x16x32_bf16 v[52:55], a[220:223], a[104:107], v[52:55]
    v_fma_f32 v57, v57, s28, v9
    ds_read_b128 a[220:223], v0 offset:19456
    v_mfma_f32_16x16x32_bf16 v[52:55], a[224:227], a[108:111], v[52:55]
    ds_read_b128 a[224:227], v1 offset:19456
    ds_read_b128 a[216:219], v1 offset:18432
    v_exp_f32 v56, v56
    v_mfma_f32_16x16x32_bf16 v[52:55], a[228:231], a[112:115], v[52:55]
    v_exp_f32 v57, v57
    ds_read_b128 a[124:127], v105 offset:6144
    v_cvt_pk_bf16_f32 v17, v58, v59
    v_mfma_f32_16x16x32_bf16 v[52:55], a[232:235], a[116:119], v[52:55]
    v_cvt_pk_bf16_f32 v16, v56, v57
    ds_read_b128 a[120:123], v104 offset:6144
    s_waitcnt lgkmcnt(5)
    v_mfma_f32_16x16x32_bf16 v[56:59], a[212:215], a[96:99], 0
    ds_read_b128 a[212:215], v0 offset:0
    s_waitcnt lgkmcnt(3)
    v_mfma_f32_16x16x32_bf16 v[56:59], a[216:219], a[100:103], v[56:59]
    ds_read_b128 a[228:231], v0 offset:20480
    v_mfma_f32_16x16x32_bf16 v[56:59], a[220:223], a[104:107], v[56:59]
    ds_read_b128 a[216:219], v1 offset:0
    ds_read_b128 a[232:235], v1 offset:20480
    v_mfma_f32_16x16x32_bf16 v[56:59], a[224:227], a[108:111], v[56:59]
    ds_read_b128 a[220:223], v0 offset:1024
    s_waitcnt lgkmcnt(3)
    v_mfma_f32_16x16x32_bf16 v[56:59], a[228:231], a[112:115], v[56:59]
    ds_read_b128 a[224:227], v1 offset:1024
    s_waitcnt lgkmcnt(2)
    v_mfma_f32_16x16x32_bf16 v[56:59], a[232:235], a[116:119], v[56:59]
    s_add_u32 s21, s21, 12032
    v_fma_f32 v52, v52, s28, v9
    ds_read_b128 a[136:139], v104 offset:10240
    v_mfma_f32_16x16x32_bf16 v[60:63], a[212:215], a[120:123], 0
    ds_read_b128 a[228:231], v0 offset:2048
    v_mfma_f32_16x16x32_bf16 v[60:63], a[216:219], a[124:127], v[60:63]
    s_waitcnt lgkmcnt(3)
    ds_read_b128 a[132:135], v105 offset:8192
    v_mfma_f32_16x16x32_bf16 v[60:63], a[220:223], a[128:131], v[60:63]
    ds_read_b128 a[216:219], v1 offset:6144
    s_waitcnt lgkmcnt(1)
    v_mfma_f32_16x16x32_bf16 v[60:63], a[224:227], a[132:135], v[60:63]
    ds_read_b128 a[232:235], v1 offset:2048
    v_mfma_f32_16x16x32_bf16 v[60:63], a[228:231], a[136:139], v[60:63]
    ds_read_b128 a[212:215], v0 offset:6144
    s_waitcnt lgkmcnt(1)
    v_mfma_f32_16x16x32_bf16 v[60:63], a[232:235], a[140:143], v[60:63]
    ds_read_b128 a[220:223], v0 offset:7168
    s_waitcnt lgkmcnt(1)
    v_mfma_f32_16x16x32_bf16 v[64:67], a[212:215], a[120:123], 0
    ds_read_b128 a[224:227], v1 offset:7168
    v_mfma_f32_16x16x32_bf16 v[64:67], a[216:219], a[124:127], v[64:67]
    ds_read_b128 a[228:231], v0 offset:8192
    s_waitcnt lgkmcnt(2)
    v_mfma_f32_16x16x32_bf16 v[64:67], a[220:223], a[128:131], v[64:67]
    ds_read_b128 a[212:215], v0 offset:12288
    v_max3_f32 v98, v60, v61, v62
    ds_read_b128 a[232:235], v1 offset:8192
    s_waitcnt lgkmcnt(2)
    v_mfma_f32_16x16x32_bf16 v[64:67], a[224:227], a[132:135], v[64:67]
    ds_read_b128 a[220:223], v0 offset:13312
    v_fma_f32 v55, v55, s28, v9
    v_mfma_f32_16x16x32_bf16 v[64:67], a[228:231], a[136:139], v[64:67]
    ds_read_b128 a[224:227], v1 offset:13312
    s_waitcnt lgkmcnt(2)
    v_mfma_f32_16x16x32_bf16 v[64:67], a[232:235], a[140:143], v[64:67]
    s_nop 7
    v_max3_f32 v98, v98, v63, v64
    v_max3_f32 v98, v98, v65, v66
    v_max_f32 v98, v98, v67
    ds_read_b128 a[228:231], v0 offset:14336
    v_mov_b32 v99, v98
    s_nop 1
    v_permlane32_swap_b32 v99, v98
    ds_read_b128 a[216:219], v1 offset:12288
    v_max_f32 v98, v98, v99
    v_mov_b32 v99, v98
    v_mfma_f32_16x16x32_bf16 v[44:47], a[236:239], v[14:17], 0
    s_nop 0
    v_permlane16_swap_b32 v99, v98
    v_max_f32 v98, v98, v99
    v_mul_f32_e64 v10, -s28, v98
    v_fma_f32 v61, v61, s28, v10
    v_fma_f32 v62, v62, s28, v10
    v_exp_f32 v62, v62
    v_fma_f32 v54, v54, s28, v9
    v_fma_f32 v63, v63, s28, v10
    v_fma_f32 v60, v60, s28, v10
    v_exp_f32 v60, v60
    v_fma_f32 v66, v66, s28, v10
    v_fma_f32 v65, v65, s28, v10
    v_exp_f32 v61, v61
    v_exp_f32 v63, v63
    v_cvt_pk_bf16_f32 v20, v60, v61
    v_exp_f32 v65, v65
    v_fma_f32 v67, v67, s28, v10
    v_exp_f32 v67, v67
    v_exp_f32 v66, v66
    v_cvt_pk_bf16_f32 v21, v62, v63
    s_waitcnt vmcnt(9)
    s_add_u32 m0, s22, 36864
    ds_read_b128 a[232:235], v1 offset:14336
    buffer_load_dwordx4 v6, s[8:11], s21 offen lds
    ds_read_b128 a[144:147], v104 offset:12288
    v_mfma_f32_16x16x32_bf16 v[60:63], a[212:215], a[120:123], 0
    s_add_u32 s21, s21, 128
    s_add_u32 m0, s22, 37888
    s_nop 0
    buffer_load_dwordx4 v6, s[8:11], s21 offen lds
    v_fma_f32 v64, v64, s28, v10
    s_add_u32 s21, s21, 128
    ds_read_b128 a[212:215], v0 offset:18432
    s_add_u32 m0, s22, 38912
    s_waitcnt lgkmcnt(3)
    v_mfma_f32_16x16x32_bf16 v[60:63], a[216:219], a[124:127], v[60:63]
    buffer_load_dwordx4 v6, s[8:11], s21 offen lds
    ds_read_b128 a[160:163], v104 offset:16384
    v_mfma_f32_16x16x32_bf16 v[60:63], a[220:223], a[128:131], v[60:63]
    ds_read_b128 a[220:223], v0 offset:19456
    v_mfma_f32_16x16x32_bf16 v[60:63], a[224:227], a[132:135], v[60:63]
    ds_read_b128 a[152:155], v104 offset:14336
    v_mfma_f32_16x16x32_bf16 v[60:63], a[228:231], a[136:139], v[60:63]
    ds_read_b128 a[164:167], v105 offset:16384
    v_exp_f32 v64, v64
    s_waitcnt lgkmcnt(6)
    v_mfma_f32_16x16x32_bf16 v[60:63], a[232:235], a[140:143], v[60:63]
    ds_read_b128 a[232:235], v1 offset:20480
    ds_read_b128 a[216:219], v1 offset:18432
    v_cvt_pk_bf16_f32 v23, v66, v67
    ds_read_b128 a[224:227], v1 offset:19456
    v_cvt_pk_bf16_f32 v22, v64, v65
    s_waitcnt lgkmcnt(7)
    v_mfma_f32_16x16x32_bf16 v[64:67], a[212:215], a[120:123], 0
    ds_read_b128 a[228:231], v0 offset:20480
    s_waitcnt lgkmcnt(2)
    v_mfma_f32_16x16x32_bf16 v[64:67], a[216:219], a[124:127], v[64:67]
    ds_read_b128 a[212:215], v0 offset:0
    v_mfma_f32_16x16x32_bf16 v[64:67], a[220:223], a[128:131], v[64:67]
    ds_read_b128 a[148:151], v105 offset:12288
    v_mfma_f32_16x16x32_bf16 v[44:47], a[240:243], v[20:23], v[44:47]
    s_waitcnt lgkmcnt(3)
    ds_read_b128 a[216:219], v1 offset:0
    v_fma_f32 v60, v60, s28, v10
    v_mfma_f32_16x16x32_bf16 v[64:67], a[224:227], a[132:135], v[64:67]
    s_waitcnt lgkmcnt(3)
    ds_read_b128 a[156:159], v105 offset:14336
    v_mfma_f32_16x16x32_bf16 v[64:67], a[228:231], a[136:139], v[64:67]
    ds_read_b128 a[224:227], v1 offset:1024
    v_mfma_f32_16x16x32_bf16 v[64:67], a[232:235], a[140:143], v[64:67]
    ds_read_b128 a[220:223], v0 offset:1024
    s_waitcnt lgkmcnt(5)
    v_mfma_f32_16x16x32_bf16 v[68:71], a[212:215], a[144:147], 0
    ds_read_b128 a[228:231], v0 offset:2048
    s_waitcnt lgkmcnt(4)
    v_mfma_f32_16x16x32_bf16 v[68:71], a[216:219], a[148:151], v[68:71]
    ds_read_b128 a[212:215], v0 offset:6144
    s_waitcnt lgkmcnt(2)
    v_mfma_f32_16x16x32_bf16 v[68:71], a[220:223], a[152:155], v[68:71]
    ds_read_b128 a[232:235], v1 offset:2048
    v_mfma_f32_16x16x32_bf16 v[68:71], a[224:227], a[156:159], v[68:71]
    ds_read_b128 a[216:219], v1 offset:6144
    v_fma_f32 v53, v53, s28, v9
    s_waitcnt lgkmcnt(3)
    v_mfma_f32_16x16x32_bf16 v[68:71], a[228:231], a[160:163], v[68:71]
    ds_read_b128 a[228:231], v0 offset:8192
    ds_read_b128 a[220:223], v0 offset:7168
    s_waitcnt lgkmcnt(3)
    v_mfma_f32_16x16x32_bf16 v[68:71], a[232:235], a[164:167], v[68:71]
    s_add_u32 s21, s21, 12032
    ds_read_b128 a[224:227], v1 offset:7168
    v_mfma_f32_16x16x32_bf16 v[72:75], a[212:215], a[144:147], 0
    s_waitcnt lgkmcnt(3)
    ds_read_b128 a[212:215], v0 offset:12288
    v_mfma_f32_16x16x32_bf16 v[72:75], a[216:219], a[148:151], v[72:75]
    ds_read_b128 a[232:235], v1 offset:8192
    s_waitcnt lgkmcnt(3)
    v_mfma_f32_16x16x32_bf16 v[72:75], a[220:223], a[152:155], v[72:75]
    v_exp_f32 v54, v54
    ds_read_b128 a[216:219], v1 offset:12288
    v_max3_f32 v96, v68, v69, v70
    s_waitcnt lgkmcnt(3)
    v_mfma_f32_16x16x32_bf16 v[72:75], a[224:227], a[156:159], v[72:75]
    ds_read_b128 a[224:227], v1 offset:13312
    v_mfma_f32_16x16x32_bf16 v[72:75], a[228:231], a[160:163], v[72:75]
    ds_read_b128 a[220:223], v0 offset:13312
    s_waitcnt lgkmcnt(3)
    v_mfma_f32_16x16x32_bf16 v[72:75], a[232:235], a[164:167], v[72:75]
    s_nop 7
    v_max3_f32 v96, v96, v71, v72
    v_max3_f32 v96, v96, v73, v74
    v_max_f32 v96, v96, v75
    ds_read_b128 a[228:231], v0 offset:14336
    v_mov_b32 v97, v96
    s_nop 1
    v_permlane32_swap_b32 v97, v96
    v_max_f32 v96, v96, v97
    v_mov_b32 v97, v96
    s_nop 1
    v_permlane16_swap_b32 v97, v96
    v_max_f32 v96, v96, v97
    v_mul_f32_e64 v11, -s28, v96
    v_fma_f32 v72, v72, s28, v11
    v_fma_f32 v71, v71, s28, v11
    v_fma_f32 v68, v68, s28, v11
    v_fma_f32 v70, v70, s28, v11
    v_exp_f32 v53, v53
    v_exp_f32 v70, v70
    v_exp_f32 v68, v68
    v_fma_f32 v69, v69, s28, v11
    v_exp_f32 v71, v71
    v_fma_f32 v75, v75, s28, v11
    v_cvt_pk_bf16_f32 v27, v70, v71
    v_fma_f32 v74, v74, s28, v11
    v_exp_f32 v69, v69
    s_nop 0
    v_cvt_pk_bf16_f32 v26, v68, v69
    v_mfma_f32_16x16x32_bf16 v[68:71], a[212:215], a[144:147], 0
    s_waitcnt lgkmcnt(1)
    ds_read_b128 a[232:235], v1 offset:14336
    v_fma_f32 v73, v73, s28, v11
    v_mfma_f32_16x16x32_bf16 v[68:71], a[216:219], a[148:151], v[68:71]
    v_exp_f32 v72, v72
    v_exp_f32 v74, v74
    ds_read_b128 a[212:215], v0 offset:18432
    v_mfma_f32_16x16x32_bf16 v[68:71], a[220:223], a[152:155], v[68:71]
    v_exp_f32 v73, v73
    ds_read_b128 a[216:219], v1 offset:18432
    v_mfma_f32_16x16x32_bf16 v[68:71], a[224:227], a[156:159], v[68:71]
    s_waitcnt lgkmcnt(3)
    v_fma_f32 v61, v61, s28, v10
    ds_read_b128 a[220:223], v0 offset:19456
    v_exp_f32 v75, v75
    v_mfma_f32_16x16x32_bf16 v[68:71], a[228:231], a[160:163], v[68:71]
    v_cvt_pk_bf16_f32 v28, v72, v73
    ds_read_b128 a[224:227], v1 offset:19456
    v_exp_f32 v60, v60
    v_cvt_pk_bf16_f32 v29, v74, v75
    s_waitcnt lgkmcnt(4)
    v_mfma_f32_16x16x32_bf16 v[68:71], a[232:235], a[164:167], v[68:71]
    ds_read_b128 a[232:235], v1 offset:20480
    s_waitcnt lgkmcnt(4)
    v_mfma_f32_16x16x32_bf16 v[72:75], a[212:215], a[144:147], 0
    ds_read_b128 a[228:231], v0 offset:20480
    s_waitcnt lgkmcnt(4)
    v_mfma_f32_16x16x32_bf16 v[72:75], a[216:219], a[148:151], v[72:75]
    v_exp_f32 v61, v61
    ds_read_b128 a[216:219], v1 offset:0
    s_waitcnt lgkmcnt(4)
    v_mfma_f32_16x16x32_bf16 v[72:75], a[220:223], a[152:155], v[72:75]
    ds_read_b128 a[220:223], v0 offset:1024
    s_waitcnt lgkmcnt(4)
    v_mfma_f32_16x16x32_bf16 v[72:75], a[224:227], a[156:159], v[72:75]
    ds_read_b128 a[212:215], v0 offset:0
    s_waitcnt lgkmcnt(3)
    v_mfma_f32_16x16x32_bf16 v[72:75], a[228:231], a[160:163], v[72:75]
    s_waitcnt vmcnt(6)
    ds_read_b128 a[168:171], v104 offset:18432
    v_mfma_f32_16x16x32_bf16 v[72:75], a[232:235], a[164:167], v[72:75]
    ds_read_b128 a[232:235], v1 offset:2048
    ds_read_b128 a[172:175], v105 offset:18432
    ds_read_b128 a[176:179], v104 offset:20480
    ds_read_b128 a[188:191], v105 offset:22528
    ds_read_b128 a[184:187], v104 offset:22528
    ds_read_b128 a[224:227], v1 offset:1024
    ds_read_b128 a[180:183], v105 offset:20480
    ds_read_b128 a[228:231], v0 offset:2048
    s_waitcnt lgkmcnt(8)
    v_mfma_f32_16x16x32_bf16 v[76:79], a[212:215], a[168:171], 0
    ds_read_b128 a[212:215], v0 offset:6144
    s_waitcnt lgkmcnt(7)
    v_mfma_f32_16x16x32_bf16 v[76:79], a[216:219], a[172:175], v[76:79]
    s_waitcnt lgkmcnt(5)
    ds_read_b128 a[216:219], v1 offset:6144
    v_mfma_f32_16x16x32_bf16 v[76:79], a[220:223], a[176:179], v[76:79]
    s_waitcnt lgkmcnt(2)
    ds_read_b128 a[220:223], v0 offset:7168
    v_mfma_f32_16x16x32_bf16 v[76:79], a[224:227], a[180:183], v[76:79]
    ds_read_b128 a[224:227], v1 offset:7168
    v_mfma_f32_16x16x32_bf16 v[76:79], a[228:231], a[184:187], v[76:79]
    ds_read_b128 a[228:231], v0 offset:8192
    v_mfma_f32_16x16x32_bf16 v[76:79], a[232:235], a[188:191], v[76:79]
    ds_read_b128 a[232:235], v1 offset:8192
    s_waitcnt lgkmcnt(5)
    v_mfma_f32_16x16x32_bf16 v[80:83], a[212:215], a[168:171], 0
    s_waitcnt lgkmcnt(4)
    v_mfma_f32_16x16x32_bf16 v[80:83], a[216:219], a[172:175], v[80:83]
    v_exp_f32 v52, v52
    s_nop 1
    v_max3_f32 v98, v76, v77, v78
    s_waitcnt lgkmcnt(2)
    v_mfma_f32_16x16x32_bf16 v[80:83], a[220:223], a[176:179], v[80:83]
    s_waitcnt vmcnt(63) lgkmcnt(0)
    s_barrier
    ds_read_b128 a[216:219], v1 offset:12288
    v_mfma_f32_16x16x32_bf16 v[80:83], a[224:227], a[180:183], v[80:83]
    s_add_u32 m0, s22, 0
    ds_read_b128 a[212:215], v0 offset:12288
    buffer_load_dwordx4 v6, s[4:7], s20 offen lds
    v_mfma_f32_16x16x32_bf16 v[80:83], a[228:231], a[184:187], v[80:83]
    s_add_u32 s20, s20, 128
    ds_read_b128 a[224:227], v1 offset:13312
    ds_read_b128 a[220:223], v0 offset:13312
    v_mfma_f32_16x16x32_bf16 v[80:83], a[232:235], a[188:191], v[80:83]
    s_add_u32 m0, s22, 1024
    ds_read_b128 a[232:235], v1 offset:14336
    buffer_load_dwordx4 v6, s[4:7], s20 offen lds
    v_mfma_f32_16x16x32_bf16 v[44:47], a[244:247], v[26:29], v[44:47]
    s_add_u32 s20, s20, 128
    s_add_u32 m0, s22, 2048
    ds_read_b128 a[228:231], v0 offset:14336
    buffer_load_dwordx4 v6, s[4:7], s20 offen lds
    v_max3_f32 v98, v98, v79, v80
    v_max3_f32 v98, v98, v81, v82
    v_max_f32 v98, v98, v83
    v_mov_b32 v99, v98
    s_add_u32 s20, s20, 12032
    s_mov_b32 s39, s64
    v_permlane32_swap_b32 v99, v98
    v_max_f32 v98, v98, v99
    v_mov_b32 v99, v98
    s_add_u32 s37, s37, 1
    s_bitcmp1_b32 s63, s37
    v_permlane16_swap_b32 v99, v98
    v_max_f32 v98, v98, v99
    v_mul_f32_e64 v12, -s28, v98
    v_fma_f32 v79, v79, s28, v12
    v_fma_f32 v78, v78, s28, v12
    v_exp_f32 v78, v78
    v_fma_f32 v77, v77, s28, v12
    v_fma_f32 v76, v76, s28, v12
    v_exp_f32 v77, v77
    v_exp_f32 v79, v79
    v_exp_f32 v76, v76
    v_cvt_pk_bf16_f32 v33, v78, v79
    v_cvt_pk_bf16_f32 v32, v76, v77
    s_cselect_b32 s62, 4294770688, 0
    s_waitcnt lgkmcnt(1)
    v_mfma_f32_16x16x32_bf16 v[76:79], a[212:215], a[168:171], 0
    s_cselect_b32 s42, 0, 325632
    s_add_u32 s35, s35, s42
    ds_read_b128 a[212:215], v0 offset:18432
    v_mfma_f32_16x16x32_bf16 v[76:79], a[216:219], a[172:175], v[76:79]
    s_lshl_b32 s42, s37, 1
    ds_read_b128 a[216:219], v1 offset:18432
    s_lshr_b32 s42, s31, s42
    s_and_b32 s42, s42, 3
    s_add_u32 s42, s42, s36
    v_mfma_f32_16x16x32_bf16 v[76:79], a[220:223], a[176:179], v[76:79]
    s_sub_u32 s43, s42, 3
    ds_read_b128 a[220:223], v0 offset:19456
    s_cmp_ge_u32 s42, 3
    v_mfma_f32_16x16x32_bf16 v[76:79], a[224:227], a[180:183], v[76:79]
    s_waitcnt lgkmcnt(3)
    ds_read_b128 a[224:227], v1 offset:19456
    s_cselect_b32 s42, s43, s42
    v_mfma_f32_16x16x32_bf16 v[76:79], a[228:231], a[184:187], v[76:79]
    s_mul_i32 s44, s3, 5
    ds_read_b128 a[228:231], v0 offset:20480
    s_mov_b32 s32, 1
    v_mfma_f32_16x16x32_bf16 v[76:79], a[232:235], a[188:191], v[76:79]
    s_lshl_b32 s43, s3, 2
    s_add_u32 s45, s43, 21
    ds_read_b128 a[232:235], v1 offset:20480
    s_cmp_eq_u32 s3, 0
    s_cselect_b32 s45, 20, s45
    v_fma_f32 v82, v82, s28, v12
    v_fma_f32 v80, v80, s28, v12
    v_fma_f32 v83, v83, s28, v12
    s_cselect_b32 s33, 1, 0
    s_cmp_eq_u32 s42, 1
    s_cselect_b32 s44, s45, s44
    s_cselect_b32 s32, s33, s32
    s_add_u32 s45, s43, 37
    v_fma_f32 v81, v81, s28, v12
    v_exp_f32 v83, v83
    s_cmp_eq_u32 s42, 2
    s_cselect_b32 s44, s45, s44
    s_cselect_b32 s32, 0, s32
    v_exp_f32 v82, v82
    s_mul_i32 s44, s44, 6144
    s_add_u32 s33, s35, s44
    v_exp_f32 v81, v81
    s_mul_i32 s42, s32, 6144
    s_add_u32 s42, s42, 24576
    s_add_u32 s42, s42, s33
    v_exp_f32 v80, v80
    s_cmp_ge_u32 s37, 6
    v_cvt_pk_bf16_f32 v35, v82, v83
    s_cselect_b32 s14, 0, s42
    v_cvt_pk_bf16_f32 v34, v80, v81
    s_add_u32 s24, s67, 6144
    s_add_u32 s25, s33, 6144
    s_add_u32 s23, s38, 6144
    s_mov_b32 s27, 0x30c30
    s_mov_b32 s89, 0xaaaaaaaa
    s_mov_b32 s30, 0
    s_waitcnt vmcnt(6) lgkmcnt(0)
    v_mfma_f32_16x16x32_bf16 v[80:83], a[212:215], a[168:171], 0
    s_barrier
    ds_read_b64_tr_b16 a[212:213], v2 offset:0
    ds_read_b64_tr_b16 a[214:215], v2 offset:6144
    v_mfma_f32_16x16x32_bf16 v[80:83], a[216:219], a[172:175], v[80:83]
    v_exp_f32 v55, v55
    s_add_u32 m0, s22, 12288
    ds_read_b64_tr_b16 a[216:217], v3 offset:0
    buffer_load_dwordx4 v6, s[4:7], s20 offen lds
    v_cvt_pk_bf16_f32 v18, v52, v53
    ds_read_b64_tr_b16 a[218:219], v3 offset:6144
    s_add_u32 s20, s20, 128
    v_mfma_f32_16x16x32_bf16 v[80:83], a[220:223], a[176:179], v[80:83]
    s_add_u32 m0, s22, 13312
    ds_read_b64_tr_b16 a[220:221], v4 offset:0
    buffer_load_dwordx4 v6, s[4:7], s20 offen lds
    v_cvt_pk_bf16_f32 v19, v54, v55
    v_mfma_f32_16x16x32_bf16 v[80:83], a[224:227], a[180:183], v[80:83]
    s_add_u32 s20, s20, 128
    ds_read_b64_tr_b16 a[222:223], v4 offset:6144
    v_mfma_f32_16x16x32_bf16 v[80:83], a[228:231], a[184:187], v[80:83]
    s_add_u32 m0, s22, 14336
    ds_read_b64_tr_b16 a[224:225], v5 offset:0
    v_cvt_pk_bf16_f32 v24, v60, v61
    v_mfma_f32_16x16x32_bf16 v[80:83], a[232:235], a[188:191], v[80:83]
    buffer_load_dwordx4 v6, s[4:7], s20 offen lds
    ds_read_b64_tr_b16 a[226:227], v5 offset:6144
    v_mfma_f32_16x16x32_bf16 v[44:47], a[248:251], v[32:35], v[44:47]
    s_add_u32 s20, s20, 12032
    s_waitcnt lgkmcnt(6)
    v_fma_f32 v65, v65, s28, v10
    v_mfma_f32_16x16x32_bf16 v[112:115], a[212:215], v[14:17], 0
    v_fma_f32 v79, v79, s28, v12
    v_mfma_f32_16x16x32_bf16 v[160:163], a[212:215], v[20:23], 0
    ds_read_b64_tr_b16 a[230:231], v2 offset:7168
    v_fma_f32 v68, v68, s28, v11
    v_mfma_f32_16x16x32_bf16 v[208:211], a[212:215], v[26:29], 0
    ds_read_b64_tr_b16 a[228:229], v2 offset:1024
    v_fma_f32 v69, v69, s28, v11
    v_mfma_f32_16x16x32_bf16 a[0:3], a[212:215], v[32:35], 0
    ds_read_b64_tr_b16 a[232:233], v3 offset:1024
    s_waitcnt lgkmcnt(7)
    v_mfma_f32_16x16x32_bf16 a[4:7], a[216:219], v[32:35], 0
    v_fma_f32 v70, v70, s28, v11
    v_fma_f32 v57, v57, s28, v9
    v_mfma_f32_16x16x32_bf16 v[212:215], a[216:219], v[26:29], 0
    ds_read_b64_tr_b16 a[214:215], v4 offset:7168
    v_mfma_f32_16x16x32_bf16 v[164:167], a[216:219], v[20:23], 0
    s_add_u32 s39, s39, 12288
    v_exp_f32 v79, v79
    v_mfma_f32_16x16x32_bf16 v[116:119], a[216:219], v[14:17], 0
    v_fma_f32 v71, v71, s28, v11
    s_waitcnt lgkmcnt(6)
    v_mfma_f32_16x16x32_bf16 v[120:123], a[220:223], v[14:17], 0
    v_fma_f32 v63, v63, s28, v10
    v_fma_f32 v62, v62, s28, v10
    v_mfma_f32_16x16x32_bf16 v[168:171], a[220:223], v[20:23], 0
    ds_read_b64_tr_b16 a[234:235], v3 offset:7168
    v_mfma_f32_16x16x32_bf16 v[216:219], a[220:223], v[26:29], 0
    ds_read_b64_tr_b16 a[212:213], v4 offset:1024
    v_fma_f32 v59, v59, s28, v9
    v_mfma_f32_16x16x32_bf16 a[8:11], a[220:223], v[32:35], 0
    s_waitcnt lgkmcnt(5)
    v_exp_f32 v70, v70
    v_mfma_f32_16x16x32_bf16 a[12:15], a[224:227], v[32:35], 0
    ds_read_b64_tr_b16 a[222:223], v2 offset:8192
    v_fma_f32 v75, v75, s28, v11
    v_mfma_f32_16x16x32_bf16 v[220:223], a[224:227], v[26:29], 0
    ds_read_b64_tr_b16 a[216:217], v5 offset:1024
    v_fma_f32 v77, v77, s28, v12
    v_mfma_f32_16x16x32_bf16 v[172:175], a[224:227], v[20:23], 0
    ds_read_b64_tr_b16 a[218:219], v5 offset:7168
    v_mfma_f32_16x16x32_bf16 v[124:127], a[224:227], v[14:17], 0
    s_waitcnt lgkmcnt(5)
    ds_read_b64_tr_b16 a[220:221], v2 offset:2048
    v_fma_f32 v81, v81, s28, v12
    v_mfma_f32_16x16x32_bf16 v[128:131], a[228:231], v[14:17], 0
    ds_read_b64_tr_b16 a[224:225], v3 offset:2048
    v_fma_f32 v82, v82, s28, v12
    v_mfma_f32_16x16x32_bf16 v[176:179], a[228:231], v[20:23], 0
    v_fma_f32 v58, v58, s28, v9
    v_fma_f32 v66, v66, s28, v10
    v_mfma_f32_16x16x32_bf16 v[224:227], a[228:231], v[26:29], 0
    v_exp_f32 v81, v81
    v_mfma_f32_16x16x32_bf16 a[16:19], a[228:231], v[32:35], 0
    s_waitcnt lgkmcnt(6)
    v_exp_f32 v62, v62
    v_mfma_f32_16x16x32_bf16 a[20:23], a[232:235], v[32:35], 0
    ds_read_b64_tr_b16 a[230:231], v4 offset:8192
    v_fma_f32 v78, v78, s28, v12
    v_mfma_f32_16x16x32_bf16 v[228:231], a[232:235], v[26:29], 0
    ds_read_b64_tr_b16 a[226:227], v3 offset:8192
    v_fma_f32 v76, v76, s28, v12
    v_mfma_f32_16x16x32_bf16 v[180:183], a[232:235], v[20:23], 0
    ds_read_b64_tr_b16 a[228:229], v4 offset:2048
    v_fma_f32 v67, v67, s28, v10
    v_mfma_f32_16x16x32_bf16 v[132:135], a[232:235], v[14:17], 0
    s_waitcnt lgkmcnt(6)
    ds_read_b64_tr_b16 a[232:233], v5 offset:2048
    v_fma_f32 v64, v64, s28, v10
    v_mfma_f32_16x16x32_bf16 v[136:139], a[212:215], v[14:17], 0
    ds_read_b64_tr_b16 a[234:235], v5 offset:8192
    v_fma_f32 v80, v80, s28, v12
    v_mfma_f32_16x16x32_bf16 v[184:187], a[212:215], v[20:23], 0
    v_fma_f32 v56, v56, s28, v9
    v_fma_f32 v73, v73, s28, v11
    v_mfma_f32_16x16x32_bf16 v[232:235], a[212:215], v[26:29], 0
    v_exp_f32 v82, v82
    v_mfma_f32_16x16x32_bf16 a[24:27], a[212:215], v[32:35], 0
    s_waitcnt lgkmcnt(5)
    v_mfma_f32_16x16x32_bf16 a[28:31], a[216:219], v[32:35], 0
    v_exp_f32 v78, v78
    v_mfma_f32_16x16x32_bf16 v[236:239], a[216:219], v[26:29], 0
    v_exp_f32 v76, v76
    v_mfma_f32_16x16x32_bf16 v[188:191], a[216:219], v[20:23], 0
    v_exp_f32 v68, v68
    v_mfma_f32_16x16x32_bf16 v[140:143], a[216:219], v[14:17], 0
    v_exp_f32 v69, v69
    v_mfma_f32_16x16x32_bf16 v[144:147], a[220:223], v[14:17], 0
    v_exp_f32 v65, v65
    v_mfma_f32_16x16x32_bf16 v[192:195], a[220:223], v[20:23], 0
    v_exp_f32 v63, v63
    v_mfma_f32_16x16x32_bf16 v[240:243], a[220:223], v[26:29], 0
    s_waitcnt vmcnt(3) lgkmcnt(0)
    v_cvt_pk_bf16_f32 v25, v62, v63
    v_fma_f32 v83, v83, s28, v12
    v_mfma_f32_16x16x32_bf16 a[32:35], a[220:223], v[32:35], 0
    s_barrier
    v_mfma_f32_16x16x32_bf16 a[36:39], a[224:227], v[32:35], 0
    ds_read_b128 a[212:215], v0 offset:0
    v_mov_b32 v39, v7
    v_mfma_f32_16x16x32_bf16 v[244:247], a[224:227], v[26:29], 0
    ds_read_b128 a[216:219], v1 offset:0
    v_cvt_pk_bf16_f32 v30, v68, v69
    v_mfma_f32_16x16x32_bf16 v[196:199], a[224:227], v[20:23], 0
    ds_read_b128 a[220:223], v0 offset:1024
    s_add_u32 m0, s22, 24576
    v_mfma_f32_16x16x32_bf16 v[148:151], a[224:227], v[14:17], 0
    buffer_load_dwordx4 v6, s[8:11], s21 offen lds
    v_mfma_f32_16x16x32_bf16 v[152:155], a[228:231], v[14:17], 0
    s_add_u32 s21, s21, 128
    v_exp_f32 v73, v73
    v_mfma_f32_16x16x32_bf16 v[200:203], a[228:231], v[20:23], 0
    s_add_u32 m0, s22, 25600
    v_exp_f32 v57, v57
    v_mfma_f32_16x16x32_bf16 v[248:251], a[228:231], v[26:29], 0
    buffer_load_dwordx4 v6, s[8:11], s21 offen lds
    v_mfma_f32_16x16x32_bf16 a[40:43], a[228:231], v[32:35], 0
    s_add_u32 s21, s21, 128
    v_exp_f32 v71, v71
    v_mfma_f32_16x16x32_bf16 a[44:47], a[232:235], v[32:35], 0
    v_cvt_pk_bf16_f32 v31, v70, v71
    v_cvt_pk_bf16_f32 v37, v78, v79
    v_mfma_f32_16x16x32_bf16 v[252:255], a[232:235], v[26:29], 0
    s_add_u32 m0, s22, 26624
    v_exp_f32 v77, v77
    v_mfma_f32_16x16x32_bf16 v[204:207], a[232:235], v[20:23], 0
    buffer_load_dwordx4 v6, s[8:11], s21 offen lds
    v_mfma_f32_16x16x32_bf16 v[156:159], a[232:235], v[14:17], 0
    s_waitcnt lgkmcnt(1)
    ds_read_b128 a[224:227], v1 offset:1024
    v_fma_f32 v72, v72, s28, v11
    v_mfma_f32_16x16x32_bf16 v[52:55], a[212:215], a[96:99], 0
    ds_read_b128 a[232:235], v1 offset:2048
    v_cvt_pk_bf16_f32 v36, v76, v77
    v_mfma_f32_16x16x32_bf16 v[52:55], a[216:219], a[100:103], v[52:55]
    s_waitcnt lgkmcnt(2)
    ds_read_b128 a[228:231], v0 offset:2048
    v_fma_f32 v74, v74, s28, v11
    v_mfma_f32_16x16x32_bf16 v[52:55], a[220:223], a[104:107], v[52:55]
    v_exp_f32 v66, v66
    v_mfma_f32_16x16x32_bf16 v[60:63], a[220:223], a[128:131], 0
    v_exp_f32 v67, v67
    v_mfma_f32_16x16x32_bf16 v[60:63], a[216:219], a[124:127], v[60:63]
    s_add_u32 s21, s21, 12032
    v_exp_f32 v59, v59
    v_mfma_f32_16x16x32_bf16 v[60:63], a[212:215], a[120:123], v[60:63]
    v_exp_f32 v83, v83
    v_mfma_f32_16x16x32_bf16 v[68:71], a[212:215], a[144:147], 0
    v_exp_f32 v74, v74
    v_mfma_f32_16x16x32_bf16 v[68:71], a[216:219], a[148:151], v[68:71]
    v_exp_f32 v64, v64
    v_mfma_f32_16x16x32_bf16 v[68:71], a[220:223], a[152:155], v[68:71]
    v_mov_b32 v38, v6
    s_add_u32 m0, s38, 0
    v_mfma_f32_16x16x32_bf16 v[76:79], a[220:223], a[176:179], 0
    v_exp_f32 v58, v58
    v_mfma_f32_16x16x32_bf16 v[76:79], a[216:219], a[172:175], v[76:79]
    buffer_load_dwordx4 v6, s[12:15], s33 offen nt lds
    v_mfma_f32_16x16x32_bf16 v[76:79], a[212:215], a[168:171], v[76:79]
    s_waitcnt lgkmcnt(0)
    v_exp_f32 v56, v56
    v_mfma_f32_16x16x32_bf16 v[76:79], a[224:227], a[180:183], v[76:79]
    ds_read_b128 a[212:215], v0 offset:6144
    s_add_u32 m0, s38, 1024
    v_mfma_f32_16x16x32_bf16 v[76:79], a[228:231], a[184:187], v[76:79]
    v_exp_f32 v75, v75
    v_mfma_f32_16x16x32_bf16 v[76:79], a[232:235], a[188:191], v[76:79]
    v_exp_f32 v72, v72
    v_mfma_f32_16x16x32_bf16 v[68:71], a[232:235], a[164:167], v[68:71]
    buffer_load_dwordx4 v7, s[12:15], s33 offen nt lds
    v_mfma_f32_16x16x32_bf16 v[68:71], a[228:231], a[160:163], v[68:71]
    ds_read_b128 a[220:223], v0 offset:7168
    v_cvt_pk_bf16_f32 v22, v64, v65
    v_mfma_f32_16x16x32_bf16 v[68:71], a[224:227], a[156:159], v[68:71]
    ds_read_b128 a[216:219], v1 offset:6144
    v_cvt_pk_bf16_f32 v35, v82, v83
    v_mfma_f32_16x16x32_bf16 v[60:63], a[224:227], a[132:135], v[60:63]
    v_cvt_pk_bf16_f32 v17, v58, v59
    v_cvt_pk_bf16_f32 v16, v56, v57
    v_mfma_f32_16x16x32_bf16 v[60:63], a[228:231], a[136:139], v[60:63]
    v_exp_f32 v80, v80
    v_mfma_f32_16x16x32_bf16 v[60:63], a[232:235], a[140:143], v[60:63]
    v_cvt_pk_bf16_f32 v29, v74, v75
    v_mfma_f32_16x16x32_bf16 v[52:55], a[232:235], a[116:119], v[52:55]
    s_add_u32 s59, s33, 128
    ds_read_b128 a[232:235], v1 offset:8192
    v_mfma_f32_16x16x32_bf16 v[52:55], a[228:231], a[112:115], v[52:55]
    s_add_u32 m0, s38, 2048
    ds_read_b128 a[228:231], v0 offset:8192
    v_cvt_pk_bf16_f32 v23, v66, v67
    v_mfma_f32_16x16x32_bf16 v[52:55], a[224:227], a[108:111], v[52:55]
    ds_read_b128 a[224:227], v1 offset:7168
    v_cvt_pk_bf16_f32 v28, v72, v73
    v_mfma_f32_16x16x32_bf16 v[48:51], a[236:239], v[16:19], v[44:47]
    buffer_load_dwordx4 v6, s[12:15], s59 offen nt lds
    v_mfma_f32_16x16x32_bf16 v[48:51], a[240:243], v[22:25], v[48:51]
    s_add_u32 m0, s38, 3072
    v_add_u32 v103, 6144, v103
    v_cvt_pk_bf16_f32 v34, v80, v81
    v_mfma_f32_16x16x32_bf16 v[48:51], a[244:247], v[28:31], v[48:51]
    buffer_load_dwordx4 v7, s[12:15], s59 offen nt lds
    v_mfma_f32_16x16x32_bf16 v[48:51], a[248:251], v[34:37], v[48:51]
    s_add_u32 s58, s33, 256
    s_add_u32 m0, s38, 4096
    s_waitcnt lgkmcnt(3)
    v_mfma_f32_16x16x32_bf16 v[56:59], a[212:215], a[96:99], 0
    buffer_load_dwordx4 v6, s[12:15], s58 offen nt lds
    v_mfma_f32_16x16x32_bf16 v[56:59], a[216:219], a[100:103], v[56:59]
    s_nop 1
    v_cmp_lt_f32 vcc, s29, v48
    v_mfma_f32_16x16x32_bf16 v[56:59], a[220:223], a[104:107], v[56:59]
    s_add_u32 m0, s38, 5120
    v_mfma_f32_16x16x32_bf16 v[64:67], a[220:223], a[128:131], 0
    buffer_load_dwordx4 v7, s[12:15], s58 offen nt lds
    v_mfma_f32_16x16x32_bf16 v[64:67], a[216:219], a[124:127], v[64:67]
    s_cbranch_vccnz L_rs_start4b
L_ret_start4b:
    v_fma_f32 v60, v60, s28, v10
    v_mfma_f32_16x16x32_bf16 v[64:67], a[212:215], a[120:123], v[64:67]
    s_waitcnt vmcnt(15) lgkmcnt(0)
    s_add_u32 m0, s22, 0
    v_fma_f32 v61, v61, s28, v10
    v_mfma_f32_16x16x32_bf16 v[72:75], a[212:215], a[144:147], 0
    s_barrier
    v_mfma_f32_16x16x32_bf16 v[72:75], a[216:219], a[148:151], v[72:75]
    buffer_load_dwordx4 v6, s[4:7], s20 offen lds
    v_mfma_f32_16x16x32_bf16 v[72:75], a[220:223], a[152:155], v[72:75]
    v_fma_f32 v52, v52, s28, v9
    v_mfma_f32_16x16x32_bf16 v[80:83], a[220:223], a[176:179], 0
    s_add_u32 s20, s20, 128
    v_exp_f32 v61, v61
    v_mfma_f32_16x16x32_bf16 v[80:83], a[216:219], a[172:175], v[80:83]
    s_add_u32 m0, s22, 1024
    v_exp_f32 v52, v52
    v_mfma_f32_16x16x32_bf16 v[80:83], a[212:215], a[168:171], v[80:83]
    buffer_load_dwordx4 v6, s[4:7], s20 offen lds
    v_mfma_f32_16x16x32_bf16 v[80:83], a[224:227], a[180:183], v[80:83]
    ds_read_b64_tr_b16 a[212:213], v2 offset:18432
    v_fma_f32 v55, v55, s28, v9
    v_mfma_f32_16x16x32_bf16 v[80:83], a[228:231], a[184:187], v[80:83]
    s_add_u32 s20, s20, 128
    ds_read_b64_tr_b16 a[214:215], v2 offset:12288
    v_fma_f32 v54, v54, s28, v9
    v_mfma_f32_16x16x32_bf16 v[80:83], a[232:235], a[188:191], v[80:83]
    ds_read_b64_tr_b16 a[216:217], v3 offset:18432
    v_fma_f32 v53, v53, s28, v9
    v_mfma_f32_16x16x32_bf16 v[72:75], a[232:235], a[164:167], v[72:75]
    s_add_u32 m0, s22, 2048
    v_exp_f32 v53, v53
    v_mfma_f32_16x16x32_bf16 v[72:75], a[228:231], a[160:163], v[72:75]
    buffer_load_dwordx4 v6, s[4:7], s20 offen lds
    v_mfma_f32_16x16x32_bf16 v[72:75], a[224:227], a[156:159], v[72:75]
    v_exp_f32 v60, v60
    v_mfma_f32_16x16x32_bf16 v[64:67], a[224:227], a[132:135], v[64:67]
    v_exp_f32 v54, v54
    v_mfma_f32_16x16x32_bf16 v[64:67], a[228:231], a[136:139], v[64:67]
    ds_read_b64_tr_b16 a[218:219], v3 offset:12288
    v_cvt_pk_bf16_f32 v20, v60, v61
    v_mfma_f32_16x16x32_bf16 v[64:67], a[232:235], a[140:143], v[64:67]
    v_exp_f32 v55, v55
    v_mfma_f32_16x16x32_bf16 v[56:59], a[232:235], a[116:119], v[56:59]
    ds_read_b64_tr_b16 a[220:221], v4 offset:18432
    v_cvt_pk_bf16_f32 v14, v52, v53
    v_mfma_f32_16x16x32_bf16 v[56:59], a[228:231], a[112:115], v[56:59]
    s_add_u32 s20, s20, 12032
    ds_read_b64_tr_b16 a[222:223], v4 offset:12288
    v_cvt_pk_bf16_f32 v15, v54, v55
    v_mfma_f32_16x16x32_bf16 v[56:59], a[224:227], a[108:111], v[56:59]
    s_waitcnt lgkmcnt(4)
    ds_read_b64_tr_b16 a[224:225], v5 offset:18432
    ds_read_b64_tr_b16 a[226:227], v5 offset:12288
    s_branch L_loop4w0
    .p2align 6
L_loop5w0:
    v_mfma_f32_16x16x32_bf16 v[112:115], a[212:215], v[16:19], v[112:115]
    ds_read_b128 v[96:99], v103 offset:0
    v_mfma_f32_16x16x32_bf16 v[116:119], a[216:219], v[16:19], v[116:119]
    ds_read_b64_tr_b16 a[228:229], v2 offset:19456
    v_fma_f32 v73, v73, s28, v11
    v_mfma_f32_16x16x32_bf16 v[164:167], a[216:219], v[22:25], v[164:167]
    ds_read_b64_tr_b16 a[234:235], v3 offset:13312
    v_fma_f32 v84, v84, s28, v13
    v_mfma_f32_16x16x32_bf16 v[160:163], a[212:215], v[22:25], v[160:163]
    ds_read_b64_tr_b16 a[232:233], v3 offset:19456
    v_fma_f32 v85, v85, s28, v13
    v_mfma_f32_16x16x32_bf16 v[208:211], a[212:215], v[28:31], v[208:211]
    v_fma_f32 v65, v65, s28, v10
    v_fma_f32 v72, v72, s28, v11
    v_mfma_f32_16x16x32_bf16 v[212:215], a[216:219], v[28:31], v[212:215]
    v_fma_f32 v91, v91, s28, v13
    v_fma_f32 v59, v59, s28, v9
    v_mfma_f32_16x16x32_bf16 a[4:7], a[216:219], v[34:37], a[4:7]
    ds_read_b64_tr_b16 a[230:231], v2 offset:13312
    v_fma_f32 v71, v71, s28, v11
    v_mfma_f32_16x16x32_bf16 a[0:3], a[212:215], v[34:37], a[0:3]
    s_add_u32 s39, s39, 12288
    v_fma_f32 v86, v86, s28, v13
    v_mfma_f32_16x16x32_bf16 a[48:51], a[212:215], v[40:43], a[48:51]
    v_fma_f32 v69, v69, s28, v11
    v_fma_f32 v67, v67, s28, v10
    v_mfma_f32_16x16x32_bf16 a[52:55], a[216:219], v[40:43], a[52:55]
    s_add_u32 m0, s23, 0
    v_fma_f32 v87, v87, s28, v13
    v_fma_f32 v56, v56, s28, v9
    s_waitcnt lgkmcnt(4)
    v_mfma_f32_16x16x32_bf16 a[56:59], a[220:223], v[40:43], a[56:59]
    buffer_store_dwordx4 v[96:99], v6, s[16:19], s24 offen offset:0 nt
    ds_read_b64_tr_b16 a[214:215], v4 offset:13312
    v_exp_f32 v71, v71
    v_mfma_f32_16x16x32_bf16 a[60:63], a[224:227], v[40:43], a[60:63]
    v_exp_f32 v85, v85
    v_mfma_f32_16x16x32_bf16 a[12:15], a[224:227], v[34:37], a[12:15]
    v_fma_f32 v58, v58, s28, v9
    v_fma_f32 v83, v83, s28, v12
    v_mfma_f32_16x16x32_bf16 a[8:11], a[220:223], v[34:37], a[8:11]
    ds_read_b64_tr_b16 a[216:217], v5 offset:19456
    ds_read_b64_tr_b16 a[212:213], v4 offset:19456
    v_mfma_f32_16x16x32_bf16 v[216:219], a[220:223], v[28:31], v[216:219]
    v_fma_f32 v89, v89, s28, v13
    v_mfma_f32_16x16x32_bf16 v[220:223], a[224:227], v[28:31], v[220:223]
    v_fma_f32 v70, v70, s28, v11
    v_fma_f32 v57, v57, s28, v9
    v_mfma_f32_16x16x32_bf16 v[172:175], a[224:227], v[22:25], v[172:175]
    buffer_load_dwordx4 v6, s[12:15], s25 offen nt lds
    v_mfma_f32_16x16x32_bf16 v[168:171], a[220:223], v[22:25], v[168:171]
    v_fma_f32 v68, v68, s28, v11
    v_fma_f32 v79, v79, s28, v12
    v_mfma_f32_16x16x32_bf16 v[120:123], a[220:223], v[16:19], v[120:123]
    v_exp_f32 v70, v70
    v_mfma_f32_16x16x32_bf16 v[124:127], a[224:227], v[16:19], v[124:127]
    s_waitcnt lgkmcnt(3)
    ds_read_b64_tr_b16 a[218:219], v5 offset:13312
    ds_read_b64_tr_b16 a[220:221], v2 offset:20480
    v_mfma_f32_16x16x32_bf16 v[128:131], a[228:231], v[16:19], v[128:131]
    ds_read_b64_tr_b16 a[222:223], v2 offset:14336
    v_fma_f32 v66, v66, s28, v10
    v_mfma_f32_16x16x32_bf16 v[132:135], a[232:235], v[16:19], v[132:135]
    v_fma_f32 v82, v82, s28, v12
    v_fma_f32 v74, v74, s28, v11
    v_mfma_f32_16x16x32_bf16 v[180:183], a[232:235], v[22:25], v[180:183]
    ds_read_b64_tr_b16 a[226:227], v3 offset:14336
    ds_read_b64_tr_b16 a[224:225], v3 offset:20480
    v_mfma_f32_16x16x32_bf16 v[176:179], a[228:231], v[22:25], v[176:179]
    v_mfma_f32_16x16x32_bf16 v[224:227], a[228:231], v[28:31], v[224:227]
    v_exp_f32 v87, v87
    v_mfma_f32_16x16x32_bf16 v[228:231], a[232:235], v[28:31], v[228:231]
    v_mfma_f32_16x16x32_bf16 a[20:23], a[232:235], v[34:37], a[20:23]
    v_exp_f32 v89, v89
    v_mfma_f32_16x16x32_bf16 a[16:19], a[228:231], v[34:37], a[16:19]
    v_fma_f32 v81, v81, s28, v12
    v_fma_f32 v80, v80, s28, v12
    v_mfma_f32_16x16x32_bf16 a[64:67], a[228:231], v[40:43], a[64:67]
    v_exp_f32 v83, v83
    v_mfma_f32_16x16x32_bf16 a[68:71], a[232:235], v[40:43], a[68:71]
    s_waitcnt lgkmcnt(3)
    ds_read_b64_tr_b16 a[232:233], v5 offset:20480
    v_fma_f32 v77, v77, s28, v12
    v_mfma_f32_16x16x32_bf16 a[72:75], a[212:215], v[40:43], a[72:75]
    v_fma_f32 v64, v64, s28, v10
    v_mfma_f32_16x16x32_bf16 a[76:79], a[216:219], v[40:43], a[76:79]
    v_exp_f32 v57, v57
    v_mfma_f32_16x16x32_bf16 a[28:31], a[216:219], v[34:37], a[28:31]
    ds_read_b64_tr_b16 a[228:229], v4 offset:20480
    v_fma_f32 v76, v76, s28, v12
    v_mfma_f32_16x16x32_bf16 a[24:27], a[212:215], v[34:37], a[24:27]
    ds_read_b64_tr_b16 a[234:235], v5 offset:14336
    v_fma_f32 v78, v78, s28, v12
    v_mfma_f32_16x16x32_bf16 v[232:235], a[212:215], v[28:31], v[232:235]
    v_exp_f32 v67, v67
    v_mfma_f32_16x16x32_bf16 v[236:239], a[216:219], v[28:31], v[236:239]
    v_exp_f32 v84, v84
    v_mfma_f32_16x16x32_bf16 v[188:191], a[216:219], v[22:25], v[188:191]
    ds_read_b64_tr_b16 a[230:231], v4 offset:14336
    v_fma_f32 v88, v88, s28, v13
    v_mfma_f32_16x16x32_bf16 v[184:187], a[212:215], v[22:25], v[184:187]
    v_exp_f32 v66, v66
    v_mfma_f32_16x16x32_bf16 v[136:139], a[212:215], v[16:19], v[136:139]
    v_exp_f32 v86, v86
    v_mfma_f32_16x16x32_bf16 v[140:143], a[216:219], v[16:19], v[140:143]
    s_waitcnt lgkmcnt(3)
    ds_read_b128 v[96:99], v103 offset:1024
    v_mfma_f32_16x16x32_bf16 v[144:147], a[220:223], v[16:19], v[144:147]
    v_exp_f32 v69, v69
    v_mfma_f32_16x16x32_bf16 v[148:151], a[224:227], v[16:19], v[148:151]
    v_exp_f32 v77, v77
    v_mfma_f32_16x16x32_bf16 v[196:199], a[224:227], v[22:25], v[196:199]
    v_exp_f32 v73, v73
    v_mfma_f32_16x16x32_bf16 v[192:195], a[220:223], v[22:25], v[192:195]
    v_mfma_f32_16x16x32_bf16 v[240:243], a[220:223], v[28:31], v[240:243]
    v_exp_f32 v65, v65
    v_mfma_f32_16x16x32_bf16 v[244:247], a[224:227], v[28:31], v[244:247]
    v_exp_f32 v68, v68
    v_mfma_f32_16x16x32_bf16 a[36:39], a[224:227], v[34:37], a[36:39]
    v_exp_f32 v59, v59
    v_mfma_f32_16x16x32_bf16 a[32:35], a[220:223], v[34:37], a[32:35]
    s_waitcnt vmcnt(12) lgkmcnt(1)
    v_exp_f32 v72, v72
    v_mfma_f32_16x16x32_bf16 a[80:83], a[220:223], v[40:43], a[80:83]
    v_fma_f32 v75, v75, s28, v11
    v_cvt_pk_bf16_f32 v26, v68, v69
    v_mfma_f32_16x16x32_bf16 a[84:87], a[224:227], v[40:43], a[84:87]
    s_barrier
    ds_read_b128 a[212:215], v0 offset:12288
    v_mfma_f32_16x16x32_bf16 a[88:91], a[228:231], v[40:43], a[88:91]
    ds_read_b128 a[216:219], v1 offset:12288
    v_cvt_pk_bf16_f32 v27, v70, v71
    v_mfma_f32_16x16x32_bf16 a[92:95], a[232:235], v[40:43], a[92:95]
    ds_read_b128 a[220:223], v0 offset:13312
    s_add_u32 m0, s22, 36864
    v_mfma_f32_16x16x32_bf16 a[44:47], a[232:235], v[34:37], a[44:47]
    buffer_load_dwordx4 v6, s[8:11], s21 offen lds
    v_mfma_f32_16x16x32_bf16 a[40:43], a[228:231], v[34:37], a[40:43]
    s_add_u32 s21, s21, 128
    s_add_u32 m0, s22, 37888
    v_cvt_pk_bf16_f32 v38, v84, v85
    v_mfma_f32_16x16x32_bf16 v[248:251], a[228:231], v[28:31], v[248:251]
    buffer_load_dwordx4 v6, s[8:11], s21 offen lds
    v_mfma_f32_16x16x32_bf16 v[252:255], a[232:235], v[28:31], v[252:255]
    s_add_u32 s21, s21, 128
    v_exp_f32 v79, v79
    v_mfma_f32_16x16x32_bf16 v[204:207], a[232:235], v[22:25], v[204:207]
    ds_read_b128 a[224:227], v1 offset:13312
    v_cvt_pk_bf16_f32 v39, v86, v87
    v_mfma_f32_16x16x32_bf16 v[200:203], a[228:231], v[22:25], v[200:203]
    s_add_u32 m0, s22, 38912
    v_exp_f32 v58, v58
    v_mfma_f32_16x16x32_bf16 v[152:155], a[228:231], v[16:19], v[152:155]
    buffer_load_dwordx4 v6, s[8:11], s21 offen lds
    v_mfma_f32_16x16x32_bf16 v[156:159], a[232:235], v[16:19], v[156:159]
    s_waitcnt lgkmcnt(3)
    ds_read_b128 a[232:235], v1 offset:14336
    v_fma_f32 v90, v90, s28, v13
    v_mfma_f32_16x16x32_bf16 v[52:55], a[212:215], a[96:99], 0
    s_waitcnt lgkmcnt(3)
    v_exp_f32 v78, v78
    v_mfma_f32_16x16x32_bf16 v[52:55], a[216:219], a[100:103], v[52:55]
    s_waitcnt lgkmcnt(2)
    v_exp_f32 v76, v76
    v_mfma_f32_16x16x32_bf16 v[52:55], a[220:223], a[104:107], v[52:55]
    v_exp_f32 v91, v91
    v_mfma_f32_16x16x32_bf16 v[60:63], a[220:223], a[128:131], 0
    v_exp_f32 v64, v64
    v_mfma_f32_16x16x32_bf16 v[60:63], a[216:219], a[124:127], v[60:63]
    s_add_u32 s21, s21, 12032
    s_add_u32 m0, s23, 1024
    ds_read_b128 a[228:231], v0 offset:14336
    v_mfma_f32_16x16x32_bf16 v[60:63], a[212:215], a[120:123], v[60:63]
    v_exp_f32 v56, v56
    v_mfma_f32_16x16x32_bf16 v[68:71], a[212:215], a[144:147], 0
    v_exp_f32 v90, v90
    v_mfma_f32_16x16x32_bf16 v[68:71], a[216:219], a[148:151], v[68:71]
    buffer_store_dwordx4 v[96:99], v7, s[16:19], s24 offen offset:0 nt
    v_cvt_pk_bf16_f32 v32, v76, v77
    v_cvt_pk_bf16_f32 v33, v78, v79
    v_mfma_f32_16x16x32_bf16 v[68:71], a[220:223], a[152:155], v[68:71]
    v_exp_f32 v81, v81
    v_mfma_f32_16x16x32_bf16 v[76:79], a[220:223], a[176:179], 0
    v_exp_f32 v74, v74
    v_mfma_f32_16x16x32_bf16 v[76:79], a[216:219], a[172:175], v[76:79]
    v_exp_f32 v80, v80
    v_mfma_f32_16x16x32_bf16 v[76:79], a[212:215], a[168:171], v[76:79]
    v_cvt_pk_bf16_f32 v16, v56, v57
    v_cvt_pk_bf16_f32 v23, v66, v67
    v_mfma_f32_16x16x32_bf16 v[84:87], a[212:215], a[192:195], 0
    v_cvt_pk_bf16_f32 v22, v64, v65
    v_mfma_f32_16x16x32_bf16 v[84:87], a[216:219], a[196:199], v[84:87]
    v_mfma_f32_16x16x32_bf16 v[84:87], a[220:223], a[200:203], v[84:87]
    s_waitcnt lgkmcnt(0)
    ds_read_b128 a[212:215], v0 offset:18432
    v_mfma_f32_16x16x32_bf16 v[84:87], a[224:227], a[204:207], v[84:87]
    v_cvt_pk_bf16_f32 v17, v58, v59
    v_mfma_f32_16x16x32_bf16 v[84:87], a[228:231], a[208:211], v[84:87]
    v_cvt_pk_bf16_f32 v34, v80, v81
    v_mfma_f32_16x16x32_bf16 v[84:87], a[232:235], v[92:95], v[84:87]
    buffer_load_dwordx4 v7, s[12:15], s25 offen nt lds
    v_mfma_f32_16x16x32_bf16 v[76:79], a[232:235], a[188:191], v[76:79]
    v_exp_f32 v75, v75
    v_mfma_f32_16x16x32_bf16 v[76:79], a[228:231], a[184:187], v[76:79]
    v_exp_f32 v82, v82
    v_mfma_f32_16x16x32_bf16 v[76:79], a[224:227], a[180:183], v[76:79]
    ds_read_b128 a[216:219], v1 offset:18432
    s_bitcmp1_b32 s27, 0
    v_mfma_f32_16x16x32_bf16 v[68:71], a[224:227], a[156:159], v[68:71]
    v_exp_f32 v88, v88
    v_mfma_f32_16x16x32_bf16 v[68:71], a[228:231], a[160:163], v[68:71]
    v_cvt_pk_bf16_f32 v28, v72, v73
    v_mfma_f32_16x16x32_bf16 v[68:71], a[232:235], a[164:167], v[68:71]
    v_cvt_pk_bf16_f32 v29, v74, v75
    v_mfma_f32_16x16x32_bf16 v[44:47], a[236:239], v[14:17], v[48:51]
    ds_read_b128 a[220:223], v0 offset:19456
    v_mfma_f32_16x16x32_bf16 v[60:63], a[232:235], a[140:143], v[60:63]
    v_cvt_pk_bf16_f32 v41, v90, v91
    v_mfma_f32_16x16x32_bf16 v[60:63], a[228:231], a[136:139], v[60:63]
    s_cselect_b32 s26, s49, 128
    ds_read_b128 v[96:99], v103 offset:2048
    v_cvt_pk_bf16_f32 v40, v88, v89
    v_mfma_f32_16x16x32_bf16 v[60:63], a[224:227], a[132:135], v[60:63]
    v_mfma_f32_16x16x32_bf16 v[52:55], a[224:227], a[108:111], v[52:55]
    ds_read_b128 a[224:227], v1 offset:19456
    v_mfma_f32_16x16x32_bf16 v[52:55], a[228:231], a[112:115], v[52:55]
    v_mfma_f32_16x16x32_bf16 v[52:55], a[232:235], a[116:119], v[52:55]
    v_cvt_pk_bf16_f32 v35, v82, v83
    v_mfma_f32_16x16x32_bf16 v[44:47], a[240:243], v[20:23], v[44:47]
    ds_read_b128 a[232:235], v1 offset:20480
    v_mfma_f32_16x16x32_bf16 v[44:47], a[244:247], v[26:29], v[44:47]
    ds_read_b128 a[228:231], v0 offset:20480
    v_mfma_f32_16x16x32_bf16 v[44:47], a[248:251], v[32:35], v[44:47]
    v_mfma_f32_16x16x32_bf16 v[44:47], a[252:255], v[38:41], v[44:47]
    s_lshr_b32 s27, s27, 1
    s_waitcnt lgkmcnt(4)
    v_mfma_f32_16x16x32_bf16 v[56:59], a[212:215], a[96:99], 0
    s_add_u32 s24, s24, s26
    v_mfma_f32_16x16x32_bf16 v[56:59], a[216:219], a[100:103], v[56:59]
    v_mfma_f32_16x16x32_bf16 v[56:59], a[220:223], a[104:107], v[56:59]
    s_nop 1
    v_cmp_lt_f32 vcc, s29, v44
    v_mfma_f32_16x16x32_bf16 v[64:67], a[220:223], a[128:131], 0
    s_add_u32 s25, s25, s26
    v_mfma_f32_16x16x32_bf16 v[64:67], a[216:219], a[124:127], v[64:67]
    v_mfma_f32_16x16x32_bf16 v[64:67], a[212:215], a[120:123], v[64:67]
    s_nop 0
    s_cbranch_vccnz L_rs_loop5w0a
L_ret_loop5w0a:
    v_mfma_f32_16x16x32_bf16 v[72:75], a[212:215], a[144:147], 0
    v_mfma_f32_16x16x32_bf16 v[72:75], a[216:219], a[148:151], v[72:75]
    s_waitcnt vmcnt(12) lgkmcnt(0)
    v_mfma_f32_16x16x32_bf16 v[72:75], a[220:223], a[152:155], v[72:75]
    v_fma_f32 v87, v87, s28, v13
    s_add_u32 m0, s22, 12288
    v_mfma_f32_16x16x32_bf16 v[80:83], a[220:223], a[176:179], 0
    s_barrier
    v_mfma_f32_16x16x32_bf16 v[80:83], a[216:219], a[172:175], v[80:83]
    buffer_load_dwordx4 v6, s[4:7], s20 offen lds
    v_mfma_f32_16x16x32_bf16 v[80:83], a[212:215], a[168:171], v[80:83]
    s_add_u32 s20, s20, 128
    v_fma_f32 v84, v84, s28, v13
    s_add_u32 m0, s22, 13312
    v_mfma_f32_16x16x32_bf16 v[88:91], a[212:215], a[192:195], 0
    buffer_load_dwordx4 v6, s[4:7], s20 offen lds
    v_mfma_f32_16x16x32_bf16 v[88:91], a[216:219], a[196:199], v[88:91]
    ds_read_b64_tr_b16 a[212:213], v2 offset:0
    ds_read_b64_tr_b16 a[214:215], v2 offset:6144
    v_mfma_f32_16x16x32_bf16 v[88:91], a[220:223], a[200:203], v[88:91]
    s_add_u32 s20, s20, 128
    v_fma_f32 v76, v76, s28, v12
    v_fma_f32 v62, v62, s28, v10
    v_mfma_f32_16x16x32_bf16 v[88:91], a[224:227], a[204:207], v[88:91]
    v_fma_f32 v70, v70, s28, v11
    v_fma_f32 v52, v52, s28, v9
    v_mfma_f32_16x16x32_bf16 v[88:91], a[228:231], a[208:211], v[88:91]
    s_add_u32 m0, s22, 14336
    ds_read_b64_tr_b16 a[216:217], v3 offset:0
    v_fma_f32 v69, v69, s28, v11
    v_mfma_f32_16x16x32_bf16 v[88:91], a[232:235], v[92:95], v[88:91]
    buffer_load_dwordx4 v6, s[4:7], s20 offen lds
    v_mfma_f32_16x16x32_bf16 v[80:83], a[232:235], a[188:191], v[80:83]
    v_fma_f32 v63, v63, s28, v10
    v_mfma_f32_16x16x32_bf16 v[80:83], a[228:231], a[184:187], v[80:83]
    ds_read_b64_tr_b16 a[218:219], v3 offset:6144
    v_fma_f32 v55, v55, s28, v9
    v_mfma_f32_16x16x32_bf16 v[80:83], a[224:227], a[180:183], v[80:83]
    v_fma_f32 v79, v79, s28, v12
    v_fma_f32 v53, v53, s28, v9
    v_mfma_f32_16x16x32_bf16 v[72:75], a[224:227], a[156:159], v[72:75]
    v_exp_f32 v62, v62
    v_mfma_f32_16x16x32_bf16 v[72:75], a[228:231], a[160:163], v[72:75]
    ds_read_b64_tr_b16 a[220:221], v4 offset:0
    v_mfma_f32_16x16x32_bf16 v[72:75], a[232:235], a[164:167], v[72:75]
    v_fma_f32 v68, v68, s28, v11
    v_fma_f32 v83, v83, s28, v12
    v_mfma_f32_16x16x32_bf16 v[64:67], a[232:235], a[140:143], v[64:67]
    v_mfma_f32_16x16x32_bf16 v[64:67], a[228:231], a[136:139], v[64:67]
    s_add_u32 s20, s20, 12032
    v_exp_f32 v63, v63
    v_mfma_f32_16x16x32_bf16 v[64:67], a[224:227], a[132:135], v[64:67]
    ds_read_b64_tr_b16 a[222:223], v4 offset:6144
    v_mfma_f32_16x16x32_bf16 v[56:59], a[224:227], a[108:111], v[56:59]
    v_exp_f32 v52, v52
    v_mfma_f32_16x16x32_bf16 v[56:59], a[228:231], a[112:115], v[56:59]
    v_exp_f32 v76, v76
    v_mfma_f32_16x16x32_bf16 v[56:59], a[232:235], a[116:119], v[56:59]
    s_waitcnt lgkmcnt(2)
    ds_read_b64_tr_b16 a[232:233], v3 offset:1024
    ds_read_b64_tr_b16 a[230:231], v2 offset:7168
    v_mfma_f32_16x16x32_bf16 v[112:115], a[212:215], v[14:17], v[112:115]
    ds_read_b64_tr_b16 a[224:225], v5 offset:0
    v_fma_f32 v91, v91, s28, v13
    v_mfma_f32_16x16x32_bf16 v[116:119], a[216:219], v[14:17], v[116:119]
    ds_read_b64_tr_b16 a[226:227], v5 offset:6144
    v_fma_f32 v61, v61, s28, v10
    v_mfma_f32_16x16x32_bf16 v[164:167], a[216:219], v[20:23], v[164:167]
    buffer_store_dwordx4 v[96:99], v6, s[16:19], s24 offen offset:0 nt
    v_cvt_pk_bf16_f32 v25, v62, v63
    v_exp_f32 v55, v55
    v_mfma_f32_16x16x32_bf16 v[160:163], a[212:215], v[20:23], v[160:163]
    s_add_u32 s39, s39, 12288
    v_fma_f32 v64, v64, s28, v10
    v_mfma_f32_16x16x32_bf16 v[208:211], a[212:215], v[26:29], v[208:211]
    v_fma_f32 v75, v75, s28, v11
    s_add_u32 m0, s23, 2048
    v_mfma_f32_16x16x32_bf16 v[212:215], a[216:219], v[26:29], v[212:215]
    v_fma_f32 v54, v54, s28, v9
    v_fma_f32 v73, v73, s28, v11
    v_mfma_f32_16x16x32_bf16 a[4:7], a[216:219], v[32:35], a[4:7]
    v_exp_f32 v69, v69
    v_mfma_f32_16x16x32_bf16 a[0:3], a[212:215], v[32:35], a[0:3]
    v_fma_f32 v85, v85, s28, v13
    v_fma_f32 v60, v60, s28, v10
    v_mfma_f32_16x16x32_bf16 a[48:51], a[212:215], v[38:41], a[48:51]
    ds_read_b64_tr_b16 a[234:235], v3 offset:7168
    ds_read_b64_tr_b16 a[228:229], v2 offset:1024
    v_mfma_f32_16x16x32_bf16 a[52:55], a[216:219], v[38:41], a[52:55]
    s_waitcnt lgkmcnt(3)
    v_exp_f32 v68, v68
    v_mfma_f32_16x16x32_bf16 a[56:59], a[220:223], v[38:41], a[56:59]
    s_waitcnt lgkmcnt(2)
    ds_read_b64_tr_b16 a[212:213], v4 offset:1024
    ds_read_b64_tr_b16 a[218:219], v5 offset:7168
    v_mfma_f32_16x16x32_bf16 a[60:63], a[224:227], v[38:41], a[60:63]
    v_fma_f32 v78, v78, s28, v12
    v_fma_f32 v65, v65, s28, v10
    v_mfma_f32_16x16x32_bf16 a[12:15], a[224:227], v[32:35], a[12:15]
    v_fma_f32 v89, v89, s28, v13
    v_fma_f32 v56, v56, s28, v9
    v_mfma_f32_16x16x32_bf16 a[8:11], a[220:223], v[32:35], a[8:11]
    v_fma_f32 v67, v67, s28, v10
    v_fma_f32 v81, v81, s28, v12
    v_mfma_f32_16x16x32_bf16 v[216:219], a[220:223], v[26:29], v[216:219]
    v_exp_f32 v53, v53
    v_mfma_f32_16x16x32_bf16 v[220:223], a[224:227], v[26:29], v[220:223]
    buffer_load_dwordx4 v6, s[12:15], s25 offen nt lds
    v_mfma_f32_16x16x32_bf16 v[172:175], a[224:227], v[20:23], v[172:175]
    ds_read_b64_tr_b16 a[214:215], v4 offset:7168
    v_fma_f32 v77, v77, s28, v12
    v_mfma_f32_16x16x32_bf16 v[168:171], a[220:223], v[20:23], v[168:171]
    v_exp_f32 v79, v79
    v_mfma_f32_16x16x32_bf16 v[120:123], a[220:223], v[14:17], v[120:123]
    v_fma_f32 v58, v58, s28, v9
    v_fma_f32 v66, v66, s28, v10
    v_mfma_f32_16x16x32_bf16 v[124:127], a[224:227], v[14:17], v[124:127]
    s_waitcnt lgkmcnt(3)
    ds_read_b64_tr_b16 a[216:217], v5 offset:1024
    v_mfma_f32_16x16x32_bf16 v[128:131], a[228:231], v[14:17], v[128:131]
    ds_read_b64_tr_b16 a[224:225], v3 offset:2048
    ds_read_b64_tr_b16 a[220:221], v2 offset:2048
    v_mfma_f32_16x16x32_bf16 v[132:135], a[232:235], v[14:17], v[132:135]
    v_exp_f32 v85, v85
    v_mfma_f32_16x16x32_bf16 v[180:183], a[232:235], v[20:23], v[180:183]
    v_fma_f32 v71, v71, s28, v11
    v_mfma_f32_16x16x32_bf16 v[176:179], a[228:231], v[20:23], v[176:179]
    ds_read_b64_tr_b16 a[222:223], v2 offset:8192
    ds_read_b128 v[96:99], v103 offset:3072
    v_mfma_f32_16x16x32_bf16 v[224:227], a[228:231], v[26:29], v[224:227]
    ds_read_b64_tr_b16 a[226:227], v3 offset:8192
    v_fma_f32 v86, v86, s28, v13
    v_mfma_f32_16x16x32_bf16 v[228:231], a[232:235], v[26:29], v[228:231]
    v_exp_f32 v73, v73
    v_mfma_f32_16x16x32_bf16 a[20:23], a[232:235], v[32:35], a[20:23]
    v_cvt_pk_bf16_f32 v18, v52, v53
    v_fma_f32 v90, v90, s28, v13
    v_mfma_f32_16x16x32_bf16 a[16:19], a[228:231], v[32:35], a[16:19]
    v_exp_f32 v81, v81
    v_mfma_f32_16x16x32_bf16 a[64:67], a[228:231], v[38:41], a[64:67]
    v_exp_f32 v54, v54
    v_mfma_f32_16x16x32_bf16 a[68:71], a[232:235], v[38:41], a[68:71]
    s_waitcnt lgkmcnt(5)
    v_mfma_f32_16x16x32_bf16 a[72:75], a[212:215], v[38:41], a[72:75]
    v_exp_f32 v70, v70
    v_mfma_f32_16x16x32_bf16 a[76:79], a[216:219], v[38:41], a[76:79]
    ds_read_b64_tr_b16 a[228:229], v4 offset:2048
    v_mfma_f32_16x16x32_bf16 a[28:31], a[216:219], v[32:35], a[28:31]
    ds_read_b64_tr_b16 a[234:235], v5 offset:8192
    ds_read_b64_tr_b16 a[232:233], v5 offset:2048
    v_mfma_f32_16x16x32_bf16 a[24:27], a[212:215], v[32:35], a[24:27]
    ds_read_b64_tr_b16 a[230:231], v4 offset:8192
    v_cvt_pk_bf16_f32 v30, v68, v69
    v_mfma_f32_16x16x32_bf16 v[232:235], a[212:215], v[26:29], v[232:235]
    v_exp_f32 v61, v61
    v_mfma_f32_16x16x32_bf16 v[236:239], a[216:219], v[26:29], v[236:239]
    v_exp_f32 v84, v84
    v_mfma_f32_16x16x32_bf16 v[188:191], a[216:219], v[20:23], v[188:191]
    v_cvt_pk_bf16_f32 v42, v84, v85
    v_mfma_f32_16x16x32_bf16 v[184:187], a[212:215], v[20:23], v[184:187]
    v_fma_f32 v57, v57, s28, v9
    v_fma_f32 v80, v80, s28, v12
    v_mfma_f32_16x16x32_bf16 v[136:139], a[212:215], v[14:17], v[136:139]
    v_exp_f32 v80, v80
    v_mfma_f32_16x16x32_bf16 v[140:143], a[216:219], v[14:17], v[140:143]
    s_waitcnt lgkmcnt(4)
    v_exp_f32 v77, v77
    v_mfma_f32_16x16x32_bf16 v[144:147], a[220:223], v[14:17], v[144:147]
    v_exp_f32 v71, v71
    v_mfma_f32_16x16x32_bf16 v[148:151], a[224:227], v[14:17], v[148:151]
    v_exp_f32 v66, v66
    v_mfma_f32_16x16x32_bf16 v[196:199], a[224:227], v[20:23], v[196:199]
    v_exp_f32 v64, v64
    v_mfma_f32_16x16x32_bf16 v[192:195], a[220:223], v[20:23], v[192:195]
    s_waitcnt vmcnt(12) lgkmcnt(0)
    v_exp_f32 v65, v65
    v_mfma_f32_16x16x32_bf16 v[240:243], a[220:223], v[26:29], v[240:243]
    v_cvt_pk_bf16_f32 v31, v70, v71
    v_mfma_f32_16x16x32_bf16 v[244:247], a[224:227], v[26:29], v[244:247]
    s_add_u32 m0, s22, 24576
    v_exp_f32 v60, v60
    v_mfma_f32_16x16x32_bf16 a[36:39], a[224:227], v[32:35], a[36:39]
    v_exp_f32 v78, v78
    v_mfma_f32_16x16x32_bf16 a[32:35], a[220:223], v[32:35], a[32:35]
    v_exp_f32 v86, v86
    v_mfma_f32_16x16x32_bf16 a[80:83], a[220:223], v[38:41], a[80:83]
    v_exp_f32 v67, v67
    v_mfma_f32_16x16x32_bf16 a[84:87], a[224:227], v[38:41], a[84:87]
    s_barrier
    ds_read_b128 a[212:215], v0 offset:0
    v_mfma_f32_16x16x32_bf16 a[88:91], a[228:231], v[38:41], a[88:91]
    buffer_load_dwordx4 v6, s[8:11], s21 offen lds
    ds_read_b128 a[216:219], v1 offset:0
    v_mfma_f32_16x16x32_bf16 a[92:95], a[232:235], v[38:41], a[92:95]
    s_add_u32 s21, s21, 128
    ds_read_b128 a[220:223], v0 offset:1024
    s_add_u32 m0, s22, 25600
    v_mfma_f32_16x16x32_bf16 a[44:47], a[232:235], v[32:35], a[44:47]
    v_exp_f32 v87, v87
    v_mfma_f32_16x16x32_bf16 a[40:43], a[228:231], v[32:35], a[40:43]
    buffer_load_dwordx4 v6, s[8:11], s21 offen lds
    v_mfma_f32_16x16x32_bf16 v[248:251], a[228:231], v[26:29], v[248:251]
    s_add_u32 s21, s21, 128
    v_exp_f32 v56, v56
    v_mfma_f32_16x16x32_bf16 v[252:255], a[232:235], v[26:29], v[252:255]
    s_add_u32 m0, s22, 26624
    v_exp_f32 v83, v83
    v_mfma_f32_16x16x32_bf16 v[204:207], a[232:235], v[20:23], v[204:207]
    buffer_load_dwordx4 v6, s[8:11], s21 offen lds
    v_mfma_f32_16x16x32_bf16 v[200:203], a[228:231], v[20:23], v[200:203]
    s_add_u32 s21, s21, 12032
    ds_read_b128 a[224:227], v1 offset:1024
    v_fma_f32 v74, v74, s28, v11
    v_mfma_f32_16x16x32_bf16 v[152:155], a[228:231], v[14:17], v[152:155]
    v_cvt_pk_bf16_f32 v19, v54, v55
    v_cvt_pk_bf16_f32 v36, v76, v77
    v_mfma_f32_16x16x32_bf16 v[156:159], a[232:235], v[14:17], v[156:159]
    s_waitcnt lgkmcnt(3)
    v_fma_f32 v82, v82, s28, v12
    v_cvt_pk_bf16_f32 v43, v86, v87
    v_mfma_f32_16x16x32_bf16 v[52:55], a[212:215], a[96:99], 0
    s_waitcnt lgkmcnt(2)
    v_cvt_pk_bf16_f32 v24, v60, v61
    v_cvt_pk_bf16_f32 v37, v78, v79
    v_mfma_f32_16x16x32_bf16 v[52:55], a[216:219], a[100:103], v[52:55]
    s_waitcnt lgkmcnt(1)
    v_add_u32 v103, 4096, v103
    v_fma_f32 v72, v72, s28, v11
    v_mfma_f32_16x16x32_bf16 v[52:55], a[220:223], a[104:107], v[52:55]
    ds_read_b128 a[232:235], v1 offset:2048
    v_mfma_f32_16x16x32_bf16 v[60:63], a[220:223], a[128:131], 0
    v_exp_f32 v72, v72
    v_mfma_f32_16x16x32_bf16 v[60:63], a[216:219], a[124:127], v[60:63]
    ds_read_b128 a[228:231], v0 offset:2048
    v_mfma_f32_16x16x32_bf16 v[60:63], a[212:215], a[120:123], v[60:63]
    buffer_store_dwordx4 v[96:99], v7, s[16:19], s24 offen offset:0 nt
    v_cvt_pk_bf16_f32 v23, v66, v67
    v_fma_f32 v59, v59, s28, v9
    v_mfma_f32_16x16x32_bf16 v[68:71], a[212:215], a[144:147], 0
    v_exp_f32 v82, v82
    v_mfma_f32_16x16x32_bf16 v[68:71], a[216:219], a[148:151], v[68:71]
    v_cvt_pk_bf16_f32 v22, v64, v65
    v_mfma_f32_16x16x32_bf16 v[68:71], a[220:223], a[152:155], v[68:71]
    v_exp_f32 v57, v57
    v_mfma_f32_16x16x32_bf16 v[76:79], a[220:223], a[176:179], 0
    v_fma_f32 v88, v88, s28, v13
    v_cvt_pk_bf16_f32 v35, v82, v83
    v_mfma_f32_16x16x32_bf16 v[76:79], a[216:219], a[172:175], v[76:79]
    s_add_u32 m0, s23, 3072
    v_exp_f32 v91, v91
    v_mfma_f32_16x16x32_bf16 v[76:79], a[212:215], a[168:171], v[76:79]
    v_exp_f32 v90, v90
    v_mfma_f32_16x16x32_bf16 v[84:87], a[212:215], a[192:195], 0
    v_cvt_pk_bf16_f32 v28, v72, v73
    v_mfma_f32_16x16x32_bf16 v[84:87], a[216:219], a[196:199], v[84:87]
    v_exp_f32 v75, v75
    v_mfma_f32_16x16x32_bf16 v[84:87], a[220:223], a[200:203], v[84:87]
    s_waitcnt lgkmcnt(0)
    v_exp_f32 v58, v58
    v_mfma_f32_16x16x32_bf16 v[84:87], a[224:227], a[204:207], v[84:87]
    buffer_load_dwordx4 v7, s[12:15], s25 offen nt lds
    v_mfma_f32_16x16x32_bf16 v[84:87], a[228:231], a[208:211], v[84:87]
    v_exp_f32 v89, v89
    v_mfma_f32_16x16x32_bf16 v[84:87], a[232:235], v[92:95], v[84:87]
    v_exp_f32 v88, v88
    v_mfma_f32_16x16x32_bf16 v[76:79], a[232:235], a[188:191], v[76:79]
    v_mfma_f32_16x16x32_bf16 v[76:79], a[228:231], a[184:187], v[76:79]
    v_exp_f32 v74, v74
    v_mfma_f32_16x16x32_bf16 v[76:79], a[224:227], a[180:183], v[76:79]
    v_exp_f32 v59, v59
    v_mfma_f32_16x16x32_bf16 v[68:71], a[224:227], a[156:159], v[68:71]
    v_mfma_f32_16x16x32_bf16 v[68:71], a[228:231], a[160:163], v[68:71]
    ds_read_b128 a[212:215], v0 offset:6144
    v_cvt_pk_bf16_f32 v16, v56, v57
    v_mfma_f32_16x16x32_bf16 v[68:71], a[232:235], a[164:167], v[68:71]
    ds_read_b128 a[216:219], v1 offset:6144
    v_mfma_f32_16x16x32_bf16 v[60:63], a[232:235], a[140:143], v[60:63]
    ds_read_b128 a[220:223], v0 offset:7168
    v_cvt_pk_bf16_f32 v29, v74, v75
    v_mfma_f32_16x16x32_bf16 v[60:63], a[228:231], a[136:139], v[60:63]
    v_mfma_f32_16x16x32_bf16 v[60:63], a[224:227], a[132:135], v[60:63]
    v_cvt_pk_bf16_f32 v17, v58, v59
    v_cvt_pk_bf16_f32 v40, v88, v89
    v_mfma_f32_16x16x32_bf16 v[52:55], a[224:227], a[108:111], v[52:55]
    v_cvt_pk_bf16_f32 v41, v90, v91
    v_mfma_f32_16x16x32_bf16 v[52:55], a[228:231], a[112:115], v[52:55]
    ds_read_b128 a[228:231], v0 offset:8192
    v_cvt_pk_bf16_f32 v34, v80, v81
    v_mfma_f32_16x16x32_bf16 v[48:51], a[236:239], v[16:19], v[44:47]
    ds_read_b128 a[224:227], v1 offset:7168
    v_mfma_f32_16x16x32_bf16 v[52:55], a[232:235], a[116:119], v[52:55]
    ds_read_b128 a[232:235], v1 offset:8192
    v_mfma_f32_16x16x32_bf16 v[48:51], a[240:243], v[22:25], v[48:51]
    v_mfma_f32_16x16x32_bf16 v[48:51], a[244:247], v[28:31], v[48:51]
    v_mfma_f32_16x16x32_bf16 v[48:51], a[248:251], v[34:37], v[48:51]
    s_bitcmp1_b32 s27, 0
    v_mfma_f32_16x16x32_bf16 v[48:51], a[252:255], v[40:43], v[48:51]
    s_cselect_b32 s26, s49, 128
    s_waitcnt lgkmcnt(3)
    v_mfma_f32_16x16x32_bf16 v[56:59], a[212:215], a[96:99], 0
    s_lshr_b32 s27, s27, 1
    s_add_u32 s24, s24, s26
    v_mfma_f32_16x16x32_bf16 v[56:59], a[216:219], a[100:103], v[56:59]
    s_nop 1
    v_cmp_lt_f32 vcc, s29, v48
    v_mfma_f32_16x16x32_bf16 v[56:59], a[220:223], a[104:107], v[56:59]
    s_add_u32 s25, s25, s26
    s_add_u32 s23, s23, 4096
    v_mfma_f32_16x16x32_bf16 v[64:67], a[220:223], a[128:131], 0
    s_nop 0
    s_cbranch_vccnz L_rs_loop5w0b
L_ret_loop5w0b:
    v_mfma_f32_16x16x32_bf16 v[64:67], a[216:219], a[124:127], v[64:67]
    v_fma_f32 v53, v53, s28, v9
    v_fma_f32 v52, v52, s28, v9
    v_mfma_f32_16x16x32_bf16 v[64:67], a[212:215], a[120:123], v[64:67]
    v_exp_f32 v52, v52
    v_mfma_f32_16x16x32_bf16 v[72:75], a[212:215], a[144:147], 0
    s_waitcnt vmcnt(12) lgkmcnt(0)
    v_exp_f32 v53, v53
    v_mfma_f32_16x16x32_bf16 v[72:75], a[216:219], a[148:151], v[72:75]
    s_cmp_eq_u32 s30, 5
    s_cselect_b32 s26, s62, 0
    v_fma_f32 v62, v62, s28, v10
    v_mfma_f32_16x16x32_bf16 v[72:75], a[220:223], a[152:155], v[72:75]
    s_add_u32 s20, s20, s26
    v_fma_f32 v55, v55, s28, v9
    s_add_u32 m0, s22, 0
    v_mfma_f32_16x16x32_bf16 v[80:83], a[220:223], a[176:179], 0
    s_barrier
    v_mfma_f32_16x16x32_bf16 v[80:83], a[216:219], a[172:175], v[80:83]
    buffer_load_dwordx4 v6, s[4:7], s20 offen lds
    v_mfma_f32_16x16x32_bf16 v[80:83], a[212:215], a[168:171], v[80:83]
    s_add_u32 s20, s20, 128
    s_add_u32 m0, s22, 1024
    v_mfma_f32_16x16x32_bf16 v[88:91], a[212:215], a[192:195], 0
    buffer_load_dwordx4 v6, s[4:7], s20 offen lds
    v_mfma_f32_16x16x32_bf16 v[88:91], a[216:219], a[196:199], v[88:91]
    s_add_u32 s20, s20, 128
    ds_read_b64_tr_b16 a[212:213], v2 offset:18432
    ds_read_b64_tr_b16 a[214:215], v2 offset:12288
    v_mfma_f32_16x16x32_bf16 v[88:91], a[220:223], a[200:203], v[88:91]
    s_add_u32 m0, s22, 2048
    ds_read_b64_tr_b16 a[216:217], v3 offset:18432
    v_mfma_f32_16x16x32_bf16 v[88:91], a[224:227], a[204:207], v[88:91]
    buffer_load_dwordx4 v6, s[4:7], s20 offen lds
    v_mfma_f32_16x16x32_bf16 v[88:91], a[228:231], a[208:211], v[88:91]
    ds_read_b64_tr_b16 a[218:219], v3 offset:12288
    v_fma_f32 v54, v54, s28, v9
    v_mfma_f32_16x16x32_bf16 v[88:91], a[232:235], v[92:95], v[88:91]
    v_fma_f32 v63, v63, s28, v10
    v_cvt_pk_bf16_f32 v14, v52, v53
    v_mfma_f32_16x16x32_bf16 v[80:83], a[232:235], a[188:191], v[80:83]
    ds_read_b64_tr_b16 a[220:221], v4 offset:18432
    ds_read_b64_tr_b16 a[222:223], v4 offset:12288
    v_mfma_f32_16x16x32_bf16 v[80:83], a[228:231], a[184:187], v[80:83]
    v_exp_f32 v62, v62
    v_mfma_f32_16x16x32_bf16 v[80:83], a[224:227], a[180:183], v[80:83]
    v_exp_f32 v54, v54
    v_mfma_f32_16x16x32_bf16 v[72:75], a[224:227], a[156:159], v[72:75]
    s_add_u32 s20, s20, 12032
    v_fma_f32 v61, v61, s28, v10
    v_fma_f32 v60, v60, s28, v10
    v_mfma_f32_16x16x32_bf16 v[72:75], a[228:231], a[160:163], v[72:75]
    v_exp_f32 v55, v55
    v_mfma_f32_16x16x32_bf16 v[72:75], a[232:235], a[164:167], v[72:75]
    v_exp_f32 v61, v61
    v_mfma_f32_16x16x32_bf16 v[64:67], a[232:235], a[140:143], v[64:67]
    v_exp_f32 v63, v63
    v_mfma_f32_16x16x32_bf16 v[64:67], a[228:231], a[136:139], v[64:67]
    s_add_u32 s30, s30, 1
    v_cvt_pk_bf16_f32 v15, v54, v55
    s_cmp_lt_u32 s30, 6
    v_mfma_f32_16x16x32_bf16 v[64:67], a[224:227], a[132:135], v[64:67]
    v_exp_f32 v60, v60
    v_mfma_f32_16x16x32_bf16 v[56:59], a[224:227], a[108:111], v[56:59]
    s_waitcnt lgkmcnt(2)
    ds_read_b64_tr_b16 a[224:225], v5 offset:18432
    v_cvt_pk_bf16_f32 v20, v60, v61
    v_mfma_f32_16x16x32_bf16 v[56:59], a[228:231], a[112:115], v[56:59]
    ds_read_b64_tr_b16 a[226:227], v5 offset:12288
    v_cvt_pk_bf16_f32 v21, v62, v63
    v_mfma_f32_16x16x32_bf16 v[56:59], a[232:235], a[116:119], v[56:59]
    s_cbranch_scc1 L_loop5w0
    s_cmp_ge_u32 s37, 6
    s_cbranch_scc1 L_end5
    s_cmp_eq_u32 s32, 0
    s_cbranch_scc1 L_tr54
    s_branch L_tr55
    .p2align 6
L_loop5w1:
    v_mfma_f32_16x16x32_bf16 v[112:115], a[212:215], v[16:19], v[112:115]
    ds_read_b128 v[96:99], v103 offset:0
    ds_read_b64_tr_b16 a[234:235], v3 offset:13312
    v_mfma_f32_16x16x32_bf16 v[116:119], a[216:219], v[16:19], v[116:119]
    v_fma_f32 v71, v71, s28, v11
    v_fma_f32 v82, v82, s28, v12
    v_fma_f32 v57, v57, s28, v9
    v_mfma_f32_16x16x32_bf16 v[164:167], a[216:219], v[22:25], v[164:167]
    v_fma_f32 v87, v87, s28, v13
    v_fma_f32 v73, v73, s28, v11
    v_mfma_f32_16x16x32_bf16 v[160:163], a[212:215], v[22:25], v[160:163]
    ds_read_b64_tr_b16 a[230:231], v2 offset:13312
    v_mfma_f32_16x16x32_bf16 v[208:211], a[212:215], v[28:31], v[208:211]
    v_fma_f32 v76, v76, s28, v12
    v_fma_f32 v80, v80, s28, v12
    v_mfma_f32_16x16x32_bf16 v[212:215], a[216:219], v[28:31], v[212:215]
    v_exp_f32 v71, v71
    v_mfma_f32_16x16x32_bf16 a[4:7], a[216:219], v[34:37], a[4:7]
    v_fma_f32 v65, v65, s28, v10
    v_mfma_f32_16x16x32_bf16 a[0:3], a[212:215], v[34:37], a[0:3]
    v_fma_f32 v77, v77, s28, v12
    v_fma_f32 v66, v66, s28, v10
    v_mfma_f32_16x16x32_bf16 a[48:51], a[212:215], v[40:43], a[48:51]
    ds_read_b64_tr_b16 a[228:229], v2 offset:19456
    v_mfma_f32_16x16x32_bf16 a[52:55], a[216:219], v[40:43], a[52:55]
    s_add_u32 s39, s39, 12288
    v_fma_f32 v58, v58, s28, v9
    s_waitcnt lgkmcnt(3)
    v_mfma_f32_16x16x32_bf16 a[56:59], a[220:223], v[40:43], a[56:59]
    buffer_store_dwordx4 v[96:99], v6, s[16:19], s24 offen offset:0 nt
    ds_read_b64_tr_b16 a[214:215], v4 offset:13312
    ds_read_b64_tr_b16 a[212:213], v4 offset:19456
    ds_read_b64_tr_b16 a[232:233], v3 offset:19456
    v_mfma_f32_16x16x32_bf16 a[60:63], a[224:227], v[40:43], a[60:63]
    v_fma_f32 v83, v83, s28, v12
    v_fma_f32 v85, v85, s28, v13
    v_mfma_f32_16x16x32_bf16 a[12:15], a[224:227], v[34:37], a[12:15]
    v_exp_f32 v77, v77
    v_mfma_f32_16x16x32_bf16 a[8:11], a[220:223], v[34:37], a[8:11]
    ds_read_b64_tr_b16 a[216:217], v5 offset:19456
    v_mfma_f32_16x16x32_bf16 v[216:219], a[220:223], v[28:31], v[216:219]
    v_fma_f32 v59, v59, s28, v9
    v_mfma_f32_16x16x32_bf16 v[220:223], a[224:227], v[28:31], v[220:223]
    v_fma_f32 v70, v70, s28, v11
    v_mfma_f32_16x16x32_bf16 v[172:175], a[224:227], v[22:25], v[172:175]
    s_add_u32 m0, s23, 0
    v_fma_f32 v69, v69, s28, v11
    v_mfma_f32_16x16x32_bf16 v[168:171], a[220:223], v[22:25], v[168:171]
    ds_read_b64_tr_b16 a[218:219], v5 offset:13312
    v_mfma_f32_16x16x32_bf16 v[120:123], a[220:223], v[16:19], v[120:123]
    buffer_load_dwordx4 v6, s[12:15], s25 offen nt lds
    v_mfma_f32_16x16x32_bf16 v[124:127], a[224:227], v[16:19], v[124:127]
    s_waitcnt lgkmcnt(5)
    v_fma_f32 v81, v81, s28, v12
    v_fma_f32 v84, v84, s28, v13
    v_mfma_f32_16x16x32_bf16 v[128:131], a[228:231], v[16:19], v[128:131]
    s_waitcnt lgkmcnt(2)
    v_fma_f32 v67, v67, s28, v10
    v_fma_f32 v56, v56, s28, v9
    v_mfma_f32_16x16x32_bf16 v[132:135], a[232:235], v[16:19], v[132:135]
    v_mfma_f32_16x16x32_bf16 v[180:183], a[232:235], v[22:25], v[180:183]
    ds_read_b64_tr_b16 a[226:227], v3 offset:14336
    ds_read_b64_tr_b16 a[220:221], v2 offset:20480
    v_mfma_f32_16x16x32_bf16 v[176:179], a[228:231], v[22:25], v[176:179]
    v_exp_f32 v82, v82
    v_mfma_f32_16x16x32_bf16 v[224:227], a[228:231], v[28:31], v[224:227]
    v_exp_f32 v69, v69
    v_mfma_f32_16x16x32_bf16 v[228:231], a[232:235], v[28:31], v[228:231]
    v_exp_f32 v56, v56
    v_mfma_f32_16x16x32_bf16 a[20:23], a[232:235], v[34:37], a[20:23]
    v_fma_f32 v68, v68, s28, v11
    v_fma_f32 v86, v86, s28, v13
    v_mfma_f32_16x16x32_bf16 a[16:19], a[228:231], v[34:37], a[16:19]
    v_fma_f32 v79, v79, s28, v12
    v_fma_f32 v78, v78, s28, v12
    v_mfma_f32_16x16x32_bf16 a[64:67], a[228:231], v[40:43], a[64:67]
    ds_read_b64_tr_b16 a[224:225], v3 offset:20480
    ds_read_b64_tr_b16 a[222:223], v2 offset:14336
    v_mfma_f32_16x16x32_bf16 a[68:71], a[232:235], v[40:43], a[68:71]
    ds_read_b64_tr_b16 a[234:235], v5 offset:14336
    v_fma_f32 v89, v89, s28, v13
    v_mfma_f32_16x16x32_bf16 a[72:75], a[212:215], v[40:43], a[72:75]
    s_waitcnt lgkmcnt(5)
    ds_read_b128 v[96:99], v103 offset:1024
    v_fma_f32 v91, v91, s28, v13
    v_mfma_f32_16x16x32_bf16 a[76:79], a[216:219], v[40:43], a[76:79]
    ds_read_b64_tr_b16 a[232:233], v5 offset:20480
    ds_read_b64_tr_b16 a[228:229], v4 offset:20480
    v_mfma_f32_16x16x32_bf16 a[28:31], a[216:219], v[34:37], a[28:31]
    ds_read_b64_tr_b16 a[230:231], v4 offset:14336
    v_mfma_f32_16x16x32_bf16 a[24:27], a[212:215], v[34:37], a[24:27]
    v_fma_f32 v90, v90, s28, v13
    v_mfma_f32_16x16x32_bf16 v[232:235], a[212:215], v[28:31], v[232:235]
    v_exp_f32 v70, v70
    v_mfma_f32_16x16x32_bf16 v[236:239], a[216:219], v[28:31], v[236:239]
    v_exp_f32 v81, v81
    v_mfma_f32_16x16x32_bf16 v[188:191], a[216:219], v[22:25], v[188:191]
    v_exp_f32 v91, v91
    v_mfma_f32_16x16x32_bf16 v[184:187], a[212:215], v[22:25], v[184:187]
    v_exp_f32 v84, v84
    v_mfma_f32_16x16x32_bf16 v[136:139], a[212:215], v[16:19], v[136:139]
    v_fma_f32 v88, v88, s28, v13
    v_fma_f32 v75, v75, s28, v11
    v_mfma_f32_16x16x32_bf16 v[140:143], a[216:219], v[16:19], v[140:143]
    s_waitcnt lgkmcnt(4)
    v_exp_f32 v86, v86
    v_mfma_f32_16x16x32_bf16 v[144:147], a[220:223], v[16:19], v[144:147]
    v_exp_f32 v85, v85
    v_mfma_f32_16x16x32_bf16 v[148:151], a[224:227], v[16:19], v[148:151]
    v_exp_f32 v68, v68
    v_mfma_f32_16x16x32_bf16 v[196:199], a[224:227], v[22:25], v[196:199]
    s_waitcnt vmcnt(12) lgkmcnt(0)
    v_fma_f32 v74, v74, s28, v11
    v_mfma_f32_16x16x32_bf16 v[192:195], a[220:223], v[22:25], v[192:195]
    v_exp_f32 v87, v87
    v_mfma_f32_16x16x32_bf16 v[240:243], a[220:223], v[28:31], v[240:243]
    v_exp_f32 v79, v79
    v_mfma_f32_16x16x32_bf16 v[244:247], a[224:227], v[28:31], v[244:247]
    s_barrier
    v_mfma_f32_16x16x32_bf16 a[36:39], a[224:227], v[34:37], a[36:39]
    v_exp_f32 v78, v78
    v_mfma_f32_16x16x32_bf16 a[32:35], a[220:223], v[34:37], a[32:35]
    v_exp_f32 v88, v88
    v_mfma_f32_16x16x32_bf16 a[80:83], a[220:223], v[40:43], a[80:83]
    ds_read_b128 a[212:215], v0 offset:12288
    v_cvt_pk_bf16_f32 v27, v70, v71
    v_mfma_f32_16x16x32_bf16 a[84:87], a[224:227], v[40:43], a[84:87]
    ds_read_b128 a[216:219], v1 offset:12288
    v_cvt_pk_bf16_f32 v38, v84, v85
    v_mfma_f32_16x16x32_bf16 a[88:91], a[228:231], v[40:43], a[88:91]
    s_add_u32 m0, s22, 36864
    ds_read_b128 a[220:223], v0 offset:13312
    v_fma_f32 v64, v64, s28, v10
    v_mfma_f32_16x16x32_bf16 a[92:95], a[232:235], v[40:43], a[92:95]
    buffer_load_dwordx4 v6, s[8:11], s21 offen lds
    v_mfma_f32_16x16x32_bf16 a[44:47], a[232:235], v[34:37], a[44:47]
    s_add_u32 s21, s21, 128
    v_exp_f32 v74, v74
    v_mfma_f32_16x16x32_bf16 a[40:43], a[228:231], v[34:37], a[40:43]
    v_exp_f32 v75, v75
    v_mfma_f32_16x16x32_bf16 v[248:251], a[228:231], v[28:31], v[248:251]
    s_add_u32 m0, s22, 37888
    v_exp_f32 v67, v67
    v_mfma_f32_16x16x32_bf16 v[252:255], a[232:235], v[28:31], v[252:255]
    buffer_load_dwordx4 v6, s[8:11], s21 offen lds
    v_mfma_f32_16x16x32_bf16 v[204:207], a[232:235], v[22:25], v[204:207]
    s_add_u32 s21, s21, 128
    v_exp_f32 v80, v80
    v_mfma_f32_16x16x32_bf16 v[200:203], a[228:231], v[22:25], v[200:203]
    v_cvt_pk_bf16_f32 v33, v78, v79
    s_add_u32 m0, s22, 38912
    v_mfma_f32_16x16x32_bf16 v[152:155], a[228:231], v[16:19], v[152:155]
    buffer_load_dwordx4 v6, s[8:11], s21 offen lds
    v_mfma_f32_16x16x32_bf16 v[156:159], a[232:235], v[16:19], v[156:159]
    s_waitcnt lgkmcnt(1)
    v_exp_f32 v76, v76
    v_mfma_f32_16x16x32_bf16 v[52:55], a[212:215], a[96:99], 0
    v_mfma_f32_16x16x32_bf16 v[52:55], a[216:219], a[100:103], v[52:55]
    s_waitcnt lgkmcnt(0)
    ds_read_b128 a[228:231], v0 offset:14336
    v_cvt_pk_bf16_f32 v26, v68, v69
    v_mfma_f32_16x16x32_bf16 v[52:55], a[220:223], a[104:107], v[52:55]
    v_exp_f32 v73, v73
    v_mfma_f32_16x16x32_bf16 v[60:63], a[220:223], a[128:131], 0
    v_cvt_pk_bf16_f32 v32, v76, v77
    s_add_u32 s21, s21, 12032
    v_mfma_f32_16x16x32_bf16 v[60:63], a[216:219], a[124:127], v[60:63]
    ds_read_b128 a[224:227], v1 offset:13312
    v_fma_f32 v72, v72, s28, v11
    v_mfma_f32_16x16x32_bf16 v[60:63], a[212:215], a[120:123], v[60:63]
    v_exp_f32 v58, v58
    v_mfma_f32_16x16x32_bf16 v[68:71], a[212:215], a[144:147], 0
    ds_read_b128 a[232:235], v1 offset:14336
    v_mfma_f32_16x16x32_bf16 v[68:71], a[216:219], a[148:151], v[68:71]
    buffer_store_dwordx4 v[96:99], v7, s[16:19], s24 offen offset:0 nt
    v_exp_f32 v64, v64
    v_mfma_f32_16x16x32_bf16 v[68:71], a[220:223], a[152:155], v[68:71]
    v_cvt_pk_bf16_f32 v39, v86, v87
    v_mfma_f32_16x16x32_bf16 v[76:79], a[220:223], a[176:179], 0
    v_exp_f32 v72, v72
    v_mfma_f32_16x16x32_bf16 v[76:79], a[216:219], a[172:175], v[76:79]
    v_exp_f32 v65, v65
    v_mfma_f32_16x16x32_bf16 v[76:79], a[212:215], a[168:171], v[76:79]
    v_exp_f32 v57, v57
    v_mfma_f32_16x16x32_bf16 v[84:87], a[212:215], a[192:195], 0
    s_add_u32 m0, s23, 1024
    ds_read_b128 a[212:215], v0 offset:18432
    v_mfma_f32_16x16x32_bf16 v[84:87], a[216:219], a[196:199], v[84:87]
    ds_read_b128 a[216:219], v1 offset:18432
    v_cvt_pk_bf16_f32 v16, v56, v57
    v_mfma_f32_16x16x32_bf16 v[84:87], a[220:223], a[200:203], v[84:87]
    s_waitcnt lgkmcnt(3)
    v_exp_f32 v83, v83
    v_mfma_f32_16x16x32_bf16 v[84:87], a[224:227], a[204:207], v[84:87]
    v_mfma_f32_16x16x32_bf16 v[84:87], a[228:231], a[208:211], v[84:87]
    s_waitcnt lgkmcnt(2)
    v_exp_f32 v90, v90
    v_mfma_f32_16x16x32_bf16 v[84:87], a[232:235], v[92:95], v[84:87]
    buffer_load_dwordx4 v7, s[12:15], s25 offen nt lds
    v_mfma_f32_16x16x32_bf16 v[76:79], a[232:235], a[188:191], v[76:79]
    v_exp_f32 v66, v66
    v_mfma_f32_16x16x32_bf16 v[76:79], a[228:231], a[184:187], v[76:79]
    v_mfma_f32_16x16x32_bf16 v[76:79], a[224:227], a[180:183], v[76:79]
    v_cvt_pk_bf16_f32 v34, v80, v81
    v_mfma_f32_16x16x32_bf16 v[68:71], a[224:227], a[156:159], v[68:71]
    ds_read_b128 a[220:223], v0 offset:19456
    v_mfma_f32_16x16x32_bf16 v[68:71], a[228:231], a[160:163], v[68:71]
    v_mfma_f32_16x16x32_bf16 v[68:71], a[232:235], a[164:167], v[68:71]
    v_mfma_f32_16x16x32_bf16 v[60:63], a[232:235], a[140:143], v[60:63]
    s_bitcmp1_b32 s27, 0
    v_cvt_pk_bf16_f32 v23, v66, v67
    v_mfma_f32_16x16x32_bf16 v[60:63], a[228:231], a[136:139], v[60:63]
    v_exp_f32 v89, v89
    v_mfma_f32_16x16x32_bf16 v[60:63], a[224:227], a[132:135], v[60:63]
    v_exp_f32 v59, v59
    v_mfma_f32_16x16x32_bf16 v[52:55], a[224:227], a[108:111], v[52:55]
    v_cvt_pk_bf16_f32 v41, v90, v91
    v_cvt_pk_bf16_f32 v29, v74, v75
    v_mfma_f32_16x16x32_bf16 v[52:55], a[228:231], a[112:115], v[52:55]
    v_cvt_pk_bf16_f32 v22, v64, v65
    v_cvt_pk_bf16_f32 v17, v58, v59
    v_mfma_f32_16x16x32_bf16 v[52:55], a[232:235], a[116:119], v[52:55]
    s_cselect_b32 s26, s49, 128
    ds_read_b128 a[228:231], v0 offset:20480
    ds_read_b128 a[224:227], v1 offset:19456
    v_mfma_f32_16x16x32_bf16 v[44:47], a[236:239], v[14:17], v[48:51]
    s_waitcnt lgkmcnt(3)
    ds_read_b128 a[232:235], v1 offset:20480
    v_cvt_pk_bf16_f32 v28, v72, v73
    v_mfma_f32_16x16x32_bf16 v[56:59], a[212:215], a[96:99], 0
    v_cvt_pk_bf16_f32 v40, v88, v89
    s_lshr_b32 s27, s27, 1
    v_mfma_f32_16x16x32_bf16 v[44:47], a[240:243], v[20:23], v[44:47]
    v_cvt_pk_bf16_f32 v35, v82, v83
    v_mfma_f32_16x16x32_bf16 v[44:47], a[244:247], v[26:29], v[44:47]
    s_nop 0
    v_mfma_f32_16x16x32_bf16 v[44:47], a[248:251], v[32:35], v[44:47]
    v_mfma_f32_16x16x32_bf16 v[44:47], a[252:255], v[38:41], v[44:47]
    v_mfma_f32_16x16x32_bf16 v[56:59], a[216:219], a[100:103], v[56:59]
    s_add_u32 s24, s24, s26
    s_waitcnt lgkmcnt(3)
    v_mfma_f32_16x16x32_bf16 v[56:59], a[220:223], a[104:107], v[56:59]
    ds_read_b128 v[96:99], v103 offset:2048
    v_mfma_f32_16x16x32_bf16 v[64:67], a[220:223], a[128:131], 0
    s_nop 1
    v_cmp_lt_f32 vcc, s29, v44
    v_mfma_f32_16x16x32_bf16 v[64:67], a[216:219], a[124:127], v[64:67]
    s_add_u32 s25, s25, s26
    s_waitcnt vmcnt(12) lgkmcnt(1)
    v_mfma_f32_16x16x32_bf16 v[64:67], a[212:215], a[120:123], v[64:67]
    s_barrier
    v_mfma_f32_16x16x32_bf16 v[72:75], a[212:215], a[144:147], 0
    s_cbranch_vccnz L_rs_loop5w1a
L_ret_loop5w1a:
    v_fma_f32 v54, v54, s28, v9
    v_mfma_f32_16x16x32_bf16 v[72:75], a[216:219], a[148:151], v[72:75]
    v_fma_f32 v61, v61, s28, v10
    v_fma_f32 v84, v84, s28, v13
    v_mfma_f32_16x16x32_bf16 v[72:75], a[220:223], a[152:155], v[72:75]
    s_add_u32 m0, s22, 12288
    v_fma_f32 v71, v71, s28, v11
    v_fma_f32 v77, v77, s28, v12
    v_mfma_f32_16x16x32_bf16 v[80:83], a[220:223], a[176:179], 0
    buffer_load_dwordx4 v6, s[4:7], s20 offen lds
    v_mfma_f32_16x16x32_bf16 v[80:83], a[216:219], a[172:175], v[80:83]
    v_exp_f32 v54, v54
    v_mfma_f32_16x16x32_bf16 v[80:83], a[212:215], a[168:171], v[80:83]
    s_add_u32 s20, s20, 128
    v_fma_f32 v85, v85, s28, v13
    v_mfma_f32_16x16x32_bf16 v[88:91], a[212:215], a[192:195], 0
    v_fma_f32 v62, v62, s28, v10
    v_mfma_f32_16x16x32_bf16 v[88:91], a[216:219], a[196:199], v[88:91]
    s_add_u32 m0, s22, 13312
    ds_read_b64_tr_b16 a[212:213], v2 offset:0
    ds_read_b64_tr_b16 a[214:215], v2 offset:6144
    v_mfma_f32_16x16x32_bf16 v[88:91], a[220:223], a[200:203], v[88:91]
    buffer_load_dwordx4 v6, s[4:7], s20 offen lds
    v_mfma_f32_16x16x32_bf16 v[88:91], a[224:227], a[204:207], v[88:91]
    v_fma_f32 v63, v63, s28, v10
    v_mfma_f32_16x16x32_bf16 v[88:91], a[228:231], a[208:211], v[88:91]
    s_add_u32 s20, s20, 128
    ds_read_b64_tr_b16 a[216:217], v3 offset:0
    s_add_u32 m0, s22, 14336
    v_mfma_f32_16x16x32_bf16 v[88:91], a[232:235], v[92:95], v[88:91]
    buffer_load_dwordx4 v6, s[4:7], s20 offen lds
    v_mfma_f32_16x16x32_bf16 v[80:83], a[232:235], a[188:191], v[80:83]
    v_fma_f32 v69, v69, s28, v11
    v_mfma_f32_16x16x32_bf16 v[80:83], a[228:231], a[184:187], v[80:83]
    ds_read_b64_tr_b16 a[218:219], v3 offset:6144
    v_fma_f32 v86, v86, s28, v13
    v_mfma_f32_16x16x32_bf16 v[80:83], a[224:227], a[180:183], v[80:83]
    v_exp_f32 v62, v62
    v_mfma_f32_16x16x32_bf16 v[72:75], a[224:227], a[156:159], v[72:75]
    v_fma_f32 v87, v87, s28, v13
    v_fma_f32 v70, v70, s28, v11
    v_mfma_f32_16x16x32_bf16 v[72:75], a[228:231], a[160:163], v[72:75]
    v_fma_f32 v79, v79, s28, v12
    v_fma_f32 v53, v53, s28, v9
    v_mfma_f32_16x16x32_bf16 v[72:75], a[232:235], a[164:167], v[72:75]
    v_exp_f32 v84, v84
    v_mfma_f32_16x16x32_bf16 v[64:67], a[232:235], a[140:143], v[64:67]
    ds_read_b64_tr_b16 a[220:221], v4 offset:0
    v_fma_f32 v83, v83, s28, v12
    v_mfma_f32_16x16x32_bf16 v[64:67], a[228:231], a[136:139], v[64:67]
    v_exp_f32 v69, v69
    v_mfma_f32_16x16x32_bf16 v[64:67], a[224:227], a[132:135], v[64:67]
    v_fma_f32 v88, v88, s28, v13
    v_fma_f32 v75, v75, s28, v11
    v_mfma_f32_16x16x32_bf16 v[56:59], a[224:227], a[108:111], v[56:59]
    v_fma_f32 v80, v80, s28, v12
    v_fma_f32 v60, v60, s28, v10
    v_mfma_f32_16x16x32_bf16 v[56:59], a[228:231], a[112:115], v[56:59]
    ds_read_b64_tr_b16 a[230:231], v2 offset:7168
    ds_read_b64_tr_b16 a[222:223], v4 offset:6144
    v_mfma_f32_16x16x32_bf16 v[56:59], a[232:235], a[116:119], v[56:59]
    s_waitcnt lgkmcnt(3)
    v_exp_f32 v63, v63
    v_mfma_f32_16x16x32_bf16 v[112:115], a[212:215], v[14:17], v[112:115]
    ds_read_b64_tr_b16 a[224:225], v5 offset:0
    ds_read_b64_tr_b16 a[226:227], v5 offset:6144
    v_mfma_f32_16x16x32_bf16 v[116:119], a[216:219], v[14:17], v[116:119]
    v_exp_f32 v77, v77
    v_mfma_f32_16x16x32_bf16 v[164:167], a[216:219], v[20:23], v[164:167]
    s_add_u32 s20, s20, 12032
    v_fma_f32 v76, v76, s28, v12
    v_fma_f32 v74, v74, s28, v11
    v_mfma_f32_16x16x32_bf16 v[160:163], a[212:215], v[20:23], v[160:163]
    v_fma_f32 v56, v56, s28, v9
    v_mfma_f32_16x16x32_bf16 v[208:211], a[212:215], v[26:29], v[208:211]
    ds_read_b64_tr_b16 a[232:233], v3 offset:1024
    v_fma_f32 v55, v55, s28, v9
    v_mfma_f32_16x16x32_bf16 v[212:215], a[216:219], v[26:29], v[212:215]
    buffer_store_dwordx4 v[96:99], v6, s[16:19], s24 offen offset:0 nt
    s_add_u32 s39, s39, 12288
    v_fma_f32 v82, v82, s28, v12
    v_exp_f32 v87, v87
    v_mfma_f32_16x16x32_bf16 a[4:7], a[216:219], v[32:35], a[4:7]
    v_cvt_pk_bf16_f32 v25, v62, v63
    v_fma_f32 v78, v78, s28, v12
    v_mfma_f32_16x16x32_bf16 a[0:3], a[212:215], v[32:35], a[0:3]
    ds_read_b64_tr_b16 a[234:235], v3 offset:7168
    v_fma_f32 v89, v89, s28, v13
    v_mfma_f32_16x16x32_bf16 a[48:51], a[212:215], v[38:41], a[48:51]
    ds_read_b64_tr_b16 a[228:229], v2 offset:1024
    v_mfma_f32_16x16x32_bf16 a[52:55], a[216:219], v[38:41], a[52:55]
    s_waitcnt lgkmcnt(3)
    ds_read_b64_tr_b16 a[212:213], v4 offset:1024
    v_fma_f32 v91, v91, s28, v13
    v_mfma_f32_16x16x32_bf16 a[56:59], a[220:223], v[38:41], a[56:59]
    v_fma_f32 v68, v68, s28, v11
    v_fma_f32 v66, v66, s28, v10
    v_mfma_f32_16x16x32_bf16 a[60:63], a[224:227], v[38:41], a[60:63]
    v_exp_f32 v70, v70
    v_mfma_f32_16x16x32_bf16 a[12:15], a[224:227], v[32:35], a[12:15]
    v_fma_f32 v65, v65, s28, v10
    v_mfma_f32_16x16x32_bf16 a[8:11], a[220:223], v[32:35], a[8:11]
    v_exp_f32 v76, v76
    v_mfma_f32_16x16x32_bf16 v[216:219], a[220:223], v[26:29], v[216:219]
    v_exp_f32 v68, v68
    v_mfma_f32_16x16x32_bf16 v[220:223], a[224:227], v[26:29], v[220:223]
    s_add_u32 m0, s23, 2048
    v_exp_f32 v53, v53
    v_mfma_f32_16x16x32_bf16 v[172:175], a[224:227], v[20:23], v[172:175]
    buffer_load_dwordx4 v6, s[12:15], s25 offen nt lds
    v_mfma_f32_16x16x32_bf16 v[168:171], a[220:223], v[20:23], v[168:171]
    v_exp_f32 v55, v55
    v_mfma_f32_16x16x32_bf16 v[120:123], a[220:223], v[14:17], v[120:123]
    ds_read_b64_tr_b16 a[214:215], v4 offset:7168
    v_fma_f32 v81, v81, s28, v12
    v_mfma_f32_16x16x32_bf16 v[124:127], a[224:227], v[14:17], v[124:127]
    s_waitcnt lgkmcnt(1)
    v_fma_f32 v52, v52, s28, v9
    v_fma_f32 v64, v64, s28, v10
    v_mfma_f32_16x16x32_bf16 v[128:131], a[228:231], v[14:17], v[128:131]
    ds_read_b64_tr_b16 a[216:217], v5 offset:1024
    ds_read_b64_tr_b16 a[218:219], v5 offset:7168
    v_mfma_f32_16x16x32_bf16 v[132:135], a[232:235], v[14:17], v[132:135]
    v_exp_f32 v61, v61
    v_mfma_f32_16x16x32_bf16 v[180:183], a[232:235], v[20:23], v[180:183]
    v_fma_f32 v57, v57, s28, v9
    v_mfma_f32_16x16x32_bf16 v[176:179], a[228:231], v[20:23], v[176:179]
    v_exp_f32 v71, v71
    v_mfma_f32_16x16x32_bf16 v[224:227], a[228:231], v[26:29], v[224:227]
    ds_read_b64_tr_b16 a[224:225], v3 offset:2048
    v_fma_f32 v67, v67, s28, v10
    v_mfma_f32_16x16x32_bf16 v[228:231], a[232:235], v[26:29], v[228:231]
    v_fma_f32 v72, v72, s28, v11
    v_fma_f32 v90, v90, s28, v13
    v_mfma_f32_16x16x32_bf16 a[20:23], a[232:235], v[32:35], a[20:23]
    ds_read_b64_tr_b16 a[222:223], v2 offset:8192
    v_mfma_f32_16x16x32_bf16 a[16:19], a[228:231], v[32:35], a[16:19]
    v_exp_f32 v74, v74
    v_mfma_f32_16x16x32_bf16 a[64:67], a[228:231], v[38:41], a[64:67]
    v_cvt_pk_bf16_f32 v30, v68, v69
    v_mfma_f32_16x16x32_bf16 a[68:71], a[232:235], v[38:41], a[68:71]
    s_waitcnt lgkmcnt(4)
    ds_read_b64_tr_b16 a[220:221], v2 offset:2048
    ds_read_b64_tr_b16 a[226:227], v3 offset:8192
    v_mfma_f32_16x16x32_bf16 a[72:75], a[212:215], v[38:41], a[72:75]
    s_waitcnt lgkmcnt(4)
    v_exp_f32 v57, v57
    v_mfma_f32_16x16x32_bf16 a[76:79], a[216:219], v[38:41], a[76:79]
    ds_read_b64_tr_b16 a[234:235], v5 offset:8192
    ds_read_b64_tr_b16 a[228:229], v4 offset:2048
    v_mfma_f32_16x16x32_bf16 a[28:31], a[216:219], v[32:35], a[28:31]
    v_exp_f32 v79, v79
    v_mfma_f32_16x16x32_bf16 a[24:27], a[212:215], v[32:35], a[24:27]
    ds_read_b64_tr_b16 a[230:231], v4 offset:8192
    ds_read_b64_tr_b16 a[232:233], v5 offset:2048
    v_mfma_f32_16x16x32_bf16 v[232:235], a[212:215], v[26:29], v[232:235]
    v_exp_f32 v91, v91
    v_mfma_f32_16x16x32_bf16 v[236:239], a[216:219], v[26:29], v[236:239]
    v_exp_f32 v60, v60
    v_mfma_f32_16x16x32_bf16 v[188:191], a[216:219], v[20:23], v[188:191]
    v_exp_f32 v85, v85
    v_mfma_f32_16x16x32_bf16 v[184:187], a[212:215], v[20:23], v[184:187]
    v_exp_f32 v65, v65
    v_mfma_f32_16x16x32_bf16 v[136:139], a[212:215], v[14:17], v[136:139]
    v_exp_f32 v52, v52
    v_mfma_f32_16x16x32_bf16 v[140:143], a[216:219], v[14:17], v[140:143]
    s_waitcnt lgkmcnt(4)
    v_mfma_f32_16x16x32_bf16 v[144:147], a[220:223], v[14:17], v[144:147]
    v_mfma_f32_16x16x32_bf16 v[148:151], a[224:227], v[14:17], v[148:151]
    v_fma_f32 v73, v73, s28, v11
    v_mfma_f32_16x16x32_bf16 v[196:199], a[224:227], v[20:23], v[196:199]
    ds_read_b128 v[96:99], v103 offset:3072
    v_mfma_f32_16x16x32_bf16 v[192:195], a[220:223], v[20:23], v[192:195]
    s_waitcnt vmcnt(12) lgkmcnt(1)
    v_exp_f32 v88, v88
    v_mfma_f32_16x16x32_bf16 v[240:243], a[220:223], v[26:29], v[240:243]
    v_fma_f32 v58, v58, s28, v9
    v_cvt_pk_bf16_f32 v19, v54, v55
    v_mfma_f32_16x16x32_bf16 v[244:247], a[224:227], v[26:29], v[244:247]
    s_barrier
    v_mfma_f32_16x16x32_bf16 a[36:39], a[224:227], v[32:35], a[36:39]
    s_add_u32 m0, s22, 24576
    v_exp_f32 v78, v78
    v_mfma_f32_16x16x32_bf16 a[32:35], a[220:223], v[32:35], a[32:35]
    buffer_load_dwordx4 v6, s[8:11], s21 offen lds
    v_mfma_f32_16x16x32_bf16 a[80:83], a[220:223], v[38:41], a[80:83]
    s_add_u32 s21, s21, 128
    ds_read_b128 a[220:223], v0 offset:1024
    v_cvt_pk_bf16_f32 v31, v70, v71
    v_mfma_f32_16x16x32_bf16 a[84:87], a[224:227], v[38:41], a[84:87]
    ds_read_b128 a[212:215], v0 offset:0
    v_cvt_pk_bf16_f32 v36, v76, v77
    v_mfma_f32_16x16x32_bf16 a[88:91], a[228:231], v[38:41], a[88:91]
    s_add_u32 m0, s22, 25600
    ds_read_b128 a[216:219], v1 offset:0
    v_cvt_pk_bf16_f32 v24, v60, v61
    v_mfma_f32_16x16x32_bf16 a[92:95], a[232:235], v[38:41], a[92:95]
    buffer_load_dwordx4 v6, s[8:11], s21 offen lds
    v_mfma_f32_16x16x32_bf16 a[44:47], a[232:235], v[32:35], a[44:47]
    v_exp_f32 v67, v67
    v_mfma_f32_16x16x32_bf16 a[40:43], a[228:231], v[32:35], a[40:43]
    v_mfma_f32_16x16x32_bf16 v[248:251], a[228:231], v[26:29], v[248:251]
    s_add_u32 s21, s21, 128
    s_add_u32 m0, s22, 26624
    v_cvt_pk_bf16_f32 v18, v52, v53
    v_mfma_f32_16x16x32_bf16 v[252:255], a[232:235], v[26:29], v[252:255]
    v_exp_f32 v80, v80
    v_mfma_f32_16x16x32_bf16 v[204:207], a[232:235], v[20:23], v[204:207]
    buffer_load_dwordx4 v6, s[8:11], s21 offen lds
    v_mfma_f32_16x16x32_bf16 v[200:203], a[228:231], v[20:23], v[200:203]
    v_exp_f32 v66, v66
    v_mfma_f32_16x16x32_bf16 v[152:155], a[228:231], v[14:17], v[152:155]
    s_add_u32 s21, s21, 12032
    v_mfma_f32_16x16x32_bf16 v[156:159], a[232:235], v[14:17], v[156:159]
    s_waitcnt lgkmcnt(1)
    v_cvt_pk_bf16_f32 v37, v78, v79
    v_mfma_f32_16x16x32_bf16 v[52:55], a[212:215], a[96:99], 0
    s_waitcnt lgkmcnt(0)
    v_exp_f32 v73, v73
    v_mfma_f32_16x16x32_bf16 v[52:55], a[216:219], a[100:103], v[52:55]
    v_exp_f32 v86, v86
    v_mfma_f32_16x16x32_bf16 v[52:55], a[220:223], a[104:107], v[52:55]
    ds_read_b128 a[224:227], v1 offset:1024
    v_cvt_pk_bf16_f32 v43, v86, v87
    v_mfma_f32_16x16x32_bf16 v[60:63], a[220:223], a[128:131], 0
    ds_read_b128 a[228:231], v0 offset:2048
    v_mfma_f32_16x16x32_bf16 v[60:63], a[216:219], a[124:127], v[60:63]
    buffer_store_dwordx4 v[96:99], v7, s[16:19], s24 offen offset:0 nt
    ds_read_b128 a[232:235], v1 offset:2048
    v_exp_f32 v83, v83
    v_mfma_f32_16x16x32_bf16 v[60:63], a[212:215], a[120:123], v[60:63]
    v_exp_f32 v81, v81
    v_mfma_f32_16x16x32_bf16 v[68:71], a[212:215], a[144:147], 0
    v_exp_f32 v82, v82
    v_mfma_f32_16x16x32_bf16 v[68:71], a[216:219], a[148:151], v[68:71]
    v_exp_f32 v56, v56
    v_mfma_f32_16x16x32_bf16 v[68:71], a[220:223], a[152:155], v[68:71]
    v_exp_f32 v90, v90
    v_mfma_f32_16x16x32_bf16 v[76:79], a[220:223], a[176:179], 0
    v_exp_f32 v58, v58
    v_mfma_f32_16x16x32_bf16 v[76:79], a[216:219], a[172:175], v[76:79]
    v_exp_f32 v75, v75
    v_mfma_f32_16x16x32_bf16 v[76:79], a[212:215], a[168:171], v[76:79]
    v_cvt_pk_bf16_f32 v42, v84, v85
    v_cvt_pk_bf16_f32 v34, v80, v81
    v_mfma_f32_16x16x32_bf16 v[84:87], a[212:215], a[192:195], 0
    ds_read_b128 a[212:215], v0 offset:6144
    s_add_u32 m0, s23, 3072
    v_mfma_f32_16x16x32_bf16 v[84:87], a[216:219], a[196:199], v[84:87]
    v_cvt_pk_bf16_f32 v23, v66, v67
    v_mfma_f32_16x16x32_bf16 v[84:87], a[220:223], a[200:203], v[84:87]
    s_waitcnt lgkmcnt(1)
    v_exp_f32 v72, v72
    v_mfma_f32_16x16x32_bf16 v[84:87], a[224:227], a[204:207], v[84:87]
    ds_read_b128 a[220:223], v0 offset:7168
    v_mfma_f32_16x16x32_bf16 v[84:87], a[228:231], a[208:211], v[84:87]
    buffer_load_dwordx4 v7, s[12:15], s25 offen nt lds
    v_mfma_f32_16x16x32_bf16 v[84:87], a[232:235], v[92:95], v[84:87]
    v_fma_f32 v59, v59, s28, v9
    v_cvt_pk_bf16_f32 v29, v74, v75
    v_mfma_f32_16x16x32_bf16 v[76:79], a[232:235], a[188:191], v[76:79]
    v_cvt_pk_bf16_f32 v28, v72, v73
    v_mfma_f32_16x16x32_bf16 v[76:79], a[228:231], a[184:187], v[76:79]
    v_exp_f32 v59, v59
    v_mfma_f32_16x16x32_bf16 v[76:79], a[224:227], a[180:183], v[76:79]
    v_exp_f32 v89, v89
    v_mfma_f32_16x16x32_bf16 v[68:71], a[224:227], a[156:159], v[68:71]
    v_cvt_pk_bf16_f32 v16, v56, v57
    v_mfma_f32_16x16x32_bf16 v[68:71], a[228:231], a[160:163], v[68:71]
    v_exp_f32 v64, v64
    v_mfma_f32_16x16x32_bf16 v[68:71], a[232:235], a[164:167], v[68:71]
    ds_read_b128 a[216:219], v1 offset:6144
    v_mfma_f32_16x16x32_bf16 v[60:63], a[232:235], a[140:143], v[60:63]
    s_bitcmp1_b32 s27, 0
    v_mfma_f32_16x16x32_bf16 v[60:63], a[228:231], a[136:139], v[60:63]
    s_cselect_b32 s26, s49, 128
    v_cvt_pk_bf16_f32 v17, v58, v59
    s_lshr_b32 s27, s27, 1
    v_mfma_f32_16x16x32_bf16 v[60:63], a[224:227], a[132:135], v[60:63]
    v_cvt_pk_bf16_f32 v22, v64, v65
    v_mfma_f32_16x16x32_bf16 v[52:55], a[224:227], a[108:111], v[52:55]
    ds_read_b128 a[224:227], v1 offset:7168
    v_mfma_f32_16x16x32_bf16 v[52:55], a[228:231], a[112:115], v[52:55]
    ds_read_b128 a[228:231], v0 offset:8192
    v_mfma_f32_16x16x32_bf16 v[52:55], a[232:235], a[116:119], v[52:55]
    ds_read_b128 a[232:235], v1 offset:8192
    v_mfma_f32_16x16x32_bf16 v[48:51], a[236:239], v[16:19], v[44:47]
    s_add_u32 s24, s24, s26
    v_mfma_f32_16x16x32_bf16 v[48:51], a[240:243], v[22:25], v[48:51]
    s_waitcnt lgkmcnt(4)
    v_cvt_pk_bf16_f32 v41, v90, v91
    s_add_u32 s25, s25, s26
    v_mfma_f32_16x16x32_bf16 v[56:59], a[212:215], a[96:99], 0
    v_cvt_pk_bf16_f32 v35, v82, v83
    v_mfma_f32_16x16x32_bf16 v[48:51], a[244:247], v[28:31], v[48:51]
    v_cvt_pk_bf16_f32 v40, v88, v89
    v_mfma_f32_16x16x32_bf16 v[48:51], a[248:251], v[34:37], v[48:51]
    s_nop 0
    v_mfma_f32_16x16x32_bf16 v[48:51], a[252:255], v[40:43], v[48:51]
    s_waitcnt lgkmcnt(3)
    v_mfma_f32_16x16x32_bf16 v[56:59], a[216:219], a[100:103], v[56:59]
    s_add_u32 s23, s23, 4096
    v_add_u32 v103, 4096, v103
    v_mfma_f32_16x16x32_bf16 v[56:59], a[220:223], a[104:107], v[56:59]
    v_mfma_f32_16x16x32_bf16 v[64:67], a[220:223], a[128:131], 0
    s_nop 1
    v_cmp_lt_f32 vcc, s29, v48
    v_mfma_f32_16x16x32_bf16 v[64:67], a[216:219], a[124:127], v[64:67]
    s_waitcnt vmcnt(12) lgkmcnt(0)
    v_mfma_f32_16x16x32_bf16 v[64:67], a[212:215], a[120:123], v[64:67]
    s_barrier
    v_mfma_f32_16x16x32_bf16 v[72:75], a[212:215], a[144:147], 0
    s_cbranch_vccnz L_rs_loop5w1b
L_ret_loop5w1b:
    s_cmp_eq_u32 s30, 5
    v_mfma_f32_16x16x32_bf16 v[72:75], a[216:219], a[148:151], v[72:75]
    s_cselect_b32 s26, s62, 0
    v_fma_f32 v55, v55, s28, v9
    s_add_u32 s20, s20, s26
    v_mfma_f32_16x16x32_bf16 v[72:75], a[220:223], a[152:155], v[72:75]
    s_add_u32 m0, s22, 0
    v_fma_f32 v63, v63, s28, v10
    v_fma_f32 v62, v62, s28, v10
    v_mfma_f32_16x16x32_bf16 v[80:83], a[220:223], a[176:179], 0
    buffer_load_dwordx4 v6, s[4:7], s20 offen lds
    v_mfma_f32_16x16x32_bf16 v[80:83], a[216:219], a[172:175], v[80:83]
    s_add_u32 s20, s20, 128
    s_add_u32 m0, s22, 1024
    v_fma_f32 v53, v53, s28, v9
    v_mfma_f32_16x16x32_bf16 v[80:83], a[212:215], a[168:171], v[80:83]
    v_fma_f32 v52, v52, s28, v9
    v_fma_f32 v60, v60, s28, v10
    v_mfma_f32_16x16x32_bf16 v[88:91], a[212:215], a[192:195], 0
    buffer_load_dwordx4 v6, s[4:7], s20 offen lds
    v_mfma_f32_16x16x32_bf16 v[88:91], a[216:219], a[196:199], v[88:91]
    s_add_u32 s20, s20, 128
    ds_read_b64_tr_b16 a[212:213], v2 offset:18432
    v_fma_f32 v61, v61, s28, v10
    v_mfma_f32_16x16x32_bf16 v[88:91], a[220:223], a[200:203], v[88:91]
    s_add_u32 m0, s22, 2048
    v_exp_f32 v61, v61
    v_mfma_f32_16x16x32_bf16 v[88:91], a[224:227], a[204:207], v[88:91]
    buffer_load_dwordx4 v6, s[4:7], s20 offen lds
    v_mfma_f32_16x16x32_bf16 v[88:91], a[228:231], a[208:211], v[88:91]
    v_exp_f32 v60, v60
    v_mfma_f32_16x16x32_bf16 v[88:91], a[232:235], v[92:95], v[88:91]
    ds_read_b64_tr_b16 a[214:215], v2 offset:12288
    v_cvt_pk_bf16_f32 v20, v60, v61
    v_mfma_f32_16x16x32_bf16 v[80:83], a[232:235], a[188:191], v[80:83]
    ds_read_b64_tr_b16 a[216:217], v3 offset:18432
    ds_read_b64_tr_b16 a[218:219], v3 offset:12288
    v_mfma_f32_16x16x32_bf16 v[80:83], a[228:231], a[184:187], v[80:83]
    v_exp_f32 v52, v52
    v_mfma_f32_16x16x32_bf16 v[80:83], a[224:227], a[180:183], v[80:83]
    v_exp_f32 v55, v55
    v_mfma_f32_16x16x32_bf16 v[72:75], a[224:227], a[156:159], v[72:75]
    s_add_u32 s20, s20, 12032
    ds_read_b64_tr_b16 a[220:221], v4 offset:18432
    v_fma_f32 v54, v54, s28, v9
    v_mfma_f32_16x16x32_bf16 v[72:75], a[228:231], a[160:163], v[72:75]
    s_add_u32 s30, s30, 1
    v_exp_f32 v63, v63
    v_mfma_f32_16x16x32_bf16 v[72:75], a[232:235], a[164:167], v[72:75]
    s_cmp_lt_u32 s30, 6
    v_exp_f32 v62, v62
    v_mfma_f32_16x16x32_bf16 v[64:67], a[232:235], a[140:143], v[64:67]
    v_exp_f32 v54, v54
    v_mfma_f32_16x16x32_bf16 v[64:67], a[228:231], a[136:139], v[64:67]
    v_cvt_pk_bf16_f32 v15, v54, v55
    v_cvt_pk_bf16_f32 v21, v62, v63
    v_mfma_f32_16x16x32_bf16 v[64:67], a[224:227], a[132:135], v[64:67]
    v_exp_f32 v53, v53
    v_mfma_f32_16x16x32_bf16 v[56:59], a[224:227], a[108:111], v[56:59]
    ds_read_b64_tr_b16 a[222:223], v4 offset:12288
    v_cvt_pk_bf16_f32 v14, v52, v53
    v_mfma_f32_16x16x32_bf16 v[56:59], a[228:231], a[112:115], v[56:59]
    s_waitcnt lgkmcnt(2)
    ds_read_b64_tr_b16 a[224:225], v5 offset:18432
    ds_read_b64_tr_b16 a[226:227], v5 offset:12288
    v_mfma_f32_16x16x32_bf16 v[56:59], a[232:235], a[116:119], v[56:59]
    s_cbranch_scc1 L_loop5w1
    s_cmp_ge_u32 s37, 6
    s_cbranch_scc1 L_end5
    s_cmp_eq_u32 s32, 0
    s_cbranch_scc1 L_tr54
    s_branch L_tr55
L_tr54:
    v_mfma_f32_16x16x32_bf16 v[112:115], a[212:215], v[16:19], v[112:115]
    v_fma_f32 v73, v73, s28, v11
    v_mfma_f32_16x16x32_bf16 v[116:119], a[216:219], v[16:19], v[116:119]
    ds_read_b64_tr_b16 a[228:229], v2 offset:19456
    v_fma_f32 v88, v88, s28, v13
    v_mfma_f32_16x16x32_bf16 v[164:167], a[216:219], v[22:25], v[164:167]
    v_fma_f32 v78, v78, s28, v12
    v_fma_f32 v56, v56, s28, v9
    v_mfma_f32_16x16x32_bf16 v[160:163], a[212:215], v[22:25], v[160:163]
    v_mfma_f32_16x16x32_bf16 v[208:211], a[212:215], v[28:31], v[208:211]
    ds_read_b64_tr_b16 a[234:235], v3 offset:13312
    v_fma_f32 v83, v83, s28, v12
    v_mfma_f32_16x16x32_bf16 v[212:215], a[216:219], v[28:31], v[212:215]
    ds_read_b64_tr_b16 a[230:231], v2 offset:13312
    v_fma_f32 v79, v79, s28, v12
    v_mfma_f32_16x16x32_bf16 a[4:7], a[216:219], v[34:37], a[4:7]
    v_mfma_f32_16x16x32_bf16 a[0:3], a[212:215], v[34:37], a[0:3]
    ds_read_b64_tr_b16 a[232:233], v3 offset:19456
    v_fma_f32 v81, v81, s28, v12
    v_mfma_f32_16x16x32_bf16 a[48:51], a[212:215], v[40:43], a[48:51]
    v_fma_f32 v77, v77, s28, v12
    v_fma_f32 v80, v80, s28, v12
    v_mfma_f32_16x16x32_bf16 a[52:55], a[216:219], v[40:43], a[52:55]
    s_waitcnt lgkmcnt(4)
    v_exp_f32 v79, v79
    v_mfma_f32_16x16x32_bf16 a[56:59], a[220:223], v[40:43], a[56:59]
    ds_read_b64_tr_b16 a[214:215], v4 offset:13312
    v_fma_f32 v86, v86, s28, v13
    v_mfma_f32_16x16x32_bf16 a[60:63], a[224:227], v[40:43], a[60:63]
    v_fma_f32 v66, v66, s28, v10
    v_fma_f32 v67, v67, s28, v10
    v_mfma_f32_16x16x32_bf16 a[12:15], a[224:227], v[34:37], a[12:15]
    v_mfma_f32_16x16x32_bf16 a[8:11], a[220:223], v[34:37], a[8:11]
    v_fma_f32 v90, v90, s28, v13
    v_mfma_f32_16x16x32_bf16 v[216:219], a[220:223], v[28:31], v[216:219]
    ds_read_b64_tr_b16 a[212:213], v4 offset:19456
    v_fma_f32 v87, v87, s28, v13
    v_mfma_f32_16x16x32_bf16 v[220:223], a[224:227], v[28:31], v[220:223]
    v_exp_f32 v78, v78
    v_mfma_f32_16x16x32_bf16 v[172:175], a[224:227], v[22:25], v[172:175]
    v_fma_f32 v65, v65, s28, v10
    v_fma_f32 v70, v70, s28, v11
    v_mfma_f32_16x16x32_bf16 v[168:171], a[220:223], v[22:25], v[168:171]
    v_fma_f32 v91, v91, s28, v13
    v_mfma_f32_16x16x32_bf16 v[120:123], a[220:223], v[16:19], v[120:123]
    ds_read_b64_tr_b16 a[216:217], v5 offset:19456
    v_fma_f32 v82, v82, s28, v12
    v_mfma_f32_16x16x32_bf16 v[124:127], a[224:227], v[16:19], v[124:127]
    s_waitcnt lgkmcnt(3)
    ds_read_b64_tr_b16 a[218:219], v5 offset:13312
    v_mfma_f32_16x16x32_bf16 v[128:131], a[228:231], v[16:19], v[128:131]
    v_exp_f32 v70, v70
    v_mfma_f32_16x16x32_bf16 v[132:135], a[232:235], v[16:19], v[132:135]
    v_exp_f32 v77, v77
    v_mfma_f32_16x16x32_bf16 v[180:183], a[232:235], v[22:25], v[180:183]
    v_fma_f32 v84, v84, s28, v13
    v_fma_f32 v59, v59, s28, v9
    v_mfma_f32_16x16x32_bf16 v[176:179], a[228:231], v[22:25], v[176:179]
    ds_read_b64_tr_b16 a[222:223], v2 offset:14336
    v_cvt_pk_bf16_f32 v33, v78, v79
    v_mfma_f32_16x16x32_bf16 v[224:227], a[228:231], v[28:31], v[224:227]
    ds_read_b64_tr_b16 a[226:227], v3 offset:14336
    v_mfma_f32_16x16x32_bf16 v[228:231], a[232:235], v[28:31], v[228:231]
    ds_read_b64_tr_b16 a[220:221], v2 offset:20480
    v_fma_f32 v68, v68, s28, v11
    v_mfma_f32_16x16x32_bf16 a[20:23], a[232:235], v[34:37], a[20:23]
    v_fma_f32 v85, v85, s28, v13
    v_mfma_f32_16x16x32_bf16 a[16:19], a[228:231], v[34:37], a[16:19]
    v_mfma_f32_16x16x32_bf16 a[64:67], a[228:231], v[40:43], a[64:67]
    v_fma_f32 v57, v57, s28, v9
    v_fma_f32 v74, v74, s28, v11
    v_mfma_f32_16x16x32_bf16 a[68:71], a[232:235], v[40:43], a[68:71]
    s_waitcnt lgkmcnt(3)
    ds_read_b64_tr_b16 a[224:225], v3 offset:20480
    s_add_u32 s39, s39, 12288
    v_mfma_f32_16x16x32_bf16 a[72:75], a[212:215], v[40:43], a[72:75]
    v_exp_f32 v68, v68
    v_mfma_f32_16x16x32_bf16 a[76:79], a[216:219], v[40:43], a[76:79]
    v_exp_f32 v73, v73
    v_mfma_f32_16x16x32_bf16 a[28:31], a[216:219], v[34:37], a[28:31]
    v_fma_f32 v69, v69, s28, v11
    v_fma_f32 v58, v58, s28, v9
    v_mfma_f32_16x16x32_bf16 a[24:27], a[212:215], v[34:37], a[24:27]
    ds_read_b64_tr_b16 a[230:231], v4 offset:14336
    v_fma_f32 v76, v76, s28, v12
    v_mfma_f32_16x16x32_bf16 v[232:235], a[212:215], v[28:31], v[232:235]
    ds_read_b64_tr_b16 a[228:229], v4 offset:20480
    v_fma_f32 v71, v71, s28, v11
    v_mfma_f32_16x16x32_bf16 v[236:239], a[216:219], v[28:31], v[236:239]
    ds_read_b64_tr_b16 a[234:235], v5 offset:14336
    v_fma_f32 v89, v89, s28, v13
    v_mfma_f32_16x16x32_bf16 v[188:191], a[216:219], v[22:25], v[188:191]
    v_exp_f32 v84, v84
    v_mfma_f32_16x16x32_bf16 v[184:187], a[212:215], v[22:25], v[184:187]
    v_exp_f32 v67, v67
    v_mfma_f32_16x16x32_bf16 v[136:139], a[212:215], v[16:19], v[136:139]
    ds_read_b64_tr_b16 a[232:233], v5 offset:20480
    v_fma_f32 v75, v75, s28, v11
    v_mfma_f32_16x16x32_bf16 v[140:143], a[216:219], v[16:19], v[140:143]
    s_waitcnt lgkmcnt(4)
    v_exp_f32 v66, v66
    v_mfma_f32_16x16x32_bf16 v[144:147], a[220:223], v[16:19], v[144:147]
    v_exp_f32 v69, v69
    v_mfma_f32_16x16x32_bf16 v[148:151], a[224:227], v[16:19], v[148:151]
    v_exp_f32 v57, v57
    v_mfma_f32_16x16x32_bf16 v[196:199], a[224:227], v[22:25], v[196:199]
    v_exp_f32 v82, v82
    v_mfma_f32_16x16x32_bf16 v[192:195], a[220:223], v[22:25], v[192:195]
    v_exp_f32 v85, v85
    v_mfma_f32_16x16x32_bf16 v[240:243], a[220:223], v[28:31], v[240:243]
    v_exp_f32 v86, v86
    v_mfma_f32_16x16x32_bf16 v[244:247], a[224:227], v[28:31], v[244:247]
    v_exp_f32 v74, v74
    v_mfma_f32_16x16x32_bf16 a[36:39], a[224:227], v[34:37], a[36:39]
    v_exp_f32 v76, v76
    v_mfma_f32_16x16x32_bf16 a[32:35], a[220:223], v[34:37], a[32:35]
    v_exp_f32 v83, v83
    v_mfma_f32_16x16x32_bf16 a[80:83], a[220:223], v[40:43], a[80:83]
    s_waitcnt vmcnt(10) lgkmcnt(0)
    v_exp_f32 v87, v87
    v_mfma_f32_16x16x32_bf16 a[84:87], a[224:227], v[40:43], a[84:87]
    s_barrier
    ds_read_b128 a[212:215], v0 offset:12288
    v_mfma_f32_16x16x32_bf16 a[88:91], a[228:231], v[40:43], a[88:91]
    ds_read_b128 a[216:219], v1 offset:12288
    v_fma_f32 v72, v72, s28, v11
    v_mfma_f32_16x16x32_bf16 a[92:95], a[232:235], v[40:43], a[92:95]
    s_add_u32 m0, s22, 36864
    ds_read_b128 a[220:223], v0 offset:13312
    v_mfma_f32_16x16x32_bf16 a[44:47], a[232:235], v[34:37], a[44:47]
    buffer_load_dwordx4 v6, s[8:11], s21 offen lds
    v_mfma_f32_16x16x32_bf16 a[40:43], a[228:231], v[34:37], a[40:43]
    s_add_u32 s21, s21, 128
    ds_read_b128 a[224:227], v1 offset:13312
    s_add_u32 m0, s22, 37888
    v_mfma_f32_16x16x32_bf16 v[248:251], a[228:231], v[28:31], v[248:251]
    buffer_load_dwordx4 v6, s[8:11], s21 offen lds
    v_mfma_f32_16x16x32_bf16 v[252:255], a[232:235], v[28:31], v[252:255]
    v_cvt_pk_bf16_f32 v26, v68, v69
    s_add_u32 s21, s21, 128
    v_mfma_f32_16x16x32_bf16 v[204:207], a[232:235], v[22:25], v[204:207]
    v_exp_f32 v75, v75
    v_mfma_f32_16x16x32_bf16 v[200:203], a[228:231], v[22:25], v[200:203]
    s_add_u32 m0, s22, 38912
    v_exp_f32 v90, v90
    v_mfma_f32_16x16x32_bf16 v[152:155], a[228:231], v[16:19], v[152:155]
    buffer_load_dwordx4 v6, s[8:11], s21 offen lds
    v_mfma_f32_16x16x32_bf16 v[156:159], a[232:235], v[16:19], v[156:159]
    s_waitcnt lgkmcnt(3)
    ds_read_b128 a[228:231], v0 offset:14336
    v_mfma_f32_16x16x32_bf16 v[52:55], a[212:215], a[96:99], 0
    s_waitcnt lgkmcnt(3)
    v_exp_f32 v71, v71
    v_mfma_f32_16x16x32_bf16 v[52:55], a[216:219], a[100:103], v[52:55]
    s_waitcnt lgkmcnt(2)
    v_cvt_pk_bf16_f32 v32, v76, v77
    v_mfma_f32_16x16x32_bf16 v[52:55], a[220:223], a[104:107], v[52:55]
    v_mfma_f32_16x16x32_bf16 v[60:63], a[220:223], a[128:131], 0
    v_exp_f32 v91, v91
    v_mfma_f32_16x16x32_bf16 v[60:63], a[216:219], a[124:127], v[60:63]
    ds_read_b128 a[232:235], v1 offset:14336
    v_fma_f32 v64, v64, s28, v10
    v_mfma_f32_16x16x32_bf16 v[60:63], a[212:215], a[120:123], v[60:63]
    v_cvt_pk_bf16_f32 v27, v70, v71
    v_cvt_pk_bf16_f32 v38, v84, v85
    v_mfma_f32_16x16x32_bf16 v[68:71], a[212:215], a[144:147], 0
    v_cvt_pk_bf16_f32 v39, v86, v87
    v_mfma_f32_16x16x32_bf16 v[68:71], a[216:219], a[148:151], v[68:71]
    v_exp_f32 v58, v58
    v_mfma_f32_16x16x32_bf16 v[68:71], a[220:223], a[152:155], v[68:71]
    v_cvt_pk_bf16_f32 v41, v90, v91
    v_cvt_pk_bf16_f32 v23, v66, v67
    v_mfma_f32_16x16x32_bf16 v[76:79], a[220:223], a[176:179], 0
    v_exp_f32 v72, v72
    v_mfma_f32_16x16x32_bf16 v[76:79], a[216:219], a[172:175], v[76:79]
    v_cvt_pk_bf16_f32 v35, v82, v83
    v_cvt_pk_bf16_f32 v29, v74, v75
    v_mfma_f32_16x16x32_bf16 v[76:79], a[212:215], a[168:171], v[76:79]
    v_exp_f32 v59, v59
    v_mfma_f32_16x16x32_bf16 v[84:87], a[212:215], a[192:195], 0
    v_exp_f32 v81, v81
    v_mfma_f32_16x16x32_bf16 v[84:87], a[216:219], a[196:199], v[84:87]
    v_exp_f32 v89, v89
    v_mfma_f32_16x16x32_bf16 v[84:87], a[220:223], a[200:203], v[84:87]
    s_waitcnt lgkmcnt(0)
    v_cvt_pk_bf16_f32 v28, v72, v73
    v_mfma_f32_16x16x32_bf16 v[84:87], a[224:227], a[204:207], v[84:87]
    v_exp_f32 v65, v65
    v_mfma_f32_16x16x32_bf16 v[84:87], a[228:231], a[208:211], v[84:87]
    v_exp_f32 v80, v80
    v_mfma_f32_16x16x32_bf16 v[84:87], a[232:235], v[92:95], v[84:87]
    v_exp_f32 v64, v64
    v_mfma_f32_16x16x32_bf16 v[76:79], a[232:235], a[188:191], v[76:79]
    v_mfma_f32_16x16x32_bf16 v[76:79], a[228:231], a[184:187], v[76:79]
    ds_read_b128 a[212:215], v0 offset:18432
    v_cvt_pk_bf16_f32 v17, v58, v59
    v_mfma_f32_16x16x32_bf16 v[76:79], a[224:227], a[180:183], v[76:79]
    v_cvt_pk_bf16_f32 v34, v80, v81
    v_mfma_f32_16x16x32_bf16 v[68:71], a[224:227], a[156:159], v[68:71]
    v_exp_f32 v56, v56
    v_mfma_f32_16x16x32_bf16 v[68:71], a[228:231], a[160:163], v[68:71]
    v_mfma_f32_16x16x32_bf16 v[68:71], a[232:235], a[164:167], v[68:71]
    v_mfma_f32_16x16x32_bf16 v[60:63], a[232:235], a[140:143], v[60:63]
    v_cvt_pk_bf16_f32 v22, v64, v65
    v_mfma_f32_16x16x32_bf16 v[60:63], a[228:231], a[136:139], v[60:63]
    ds_read_b128 a[216:219], v1 offset:18432
    v_cvt_pk_bf16_f32 v16, v56, v57
    v_mfma_f32_16x16x32_bf16 v[60:63], a[224:227], a[132:135], v[60:63]
    ds_read_b128 a[220:223], v0 offset:19456
    v_mfma_f32_16x16x32_bf16 v[52:55], a[224:227], a[108:111], v[52:55]
    v_exp_f32 v88, v88
    v_mfma_f32_16x16x32_bf16 v[44:47], a[236:239], v[14:17], v[48:51]
    v_mfma_f32_16x16x32_bf16 v[44:47], a[240:243], v[20:23], v[44:47]
    ds_read_b128 a[224:227], v1 offset:19456
    v_cvt_pk_bf16_f32 v40, v88, v89
    v_mfma_f32_16x16x32_bf16 v[52:55], a[228:231], a[112:115], v[52:55]
    ds_read_b128 a[228:231], v0 offset:20480
    v_mfma_f32_16x16x32_bf16 v[52:55], a[232:235], a[116:119], v[52:55]
    v_mfma_f32_16x16x32_bf16 v[44:47], a[244:247], v[26:29], v[44:47]
    ds_read_b128 a[232:235], v1 offset:20480
    v_mfma_f32_16x16x32_bf16 v[44:47], a[248:251], v[32:35], v[44:47]
    v_mfma_f32_16x16x32_bf16 v[44:47], a[252:255], v[38:41], v[44:47]
    s_waitcnt lgkmcnt(5)
    v_mfma_f32_16x16x32_bf16 v[56:59], a[212:215], a[96:99], 0
    s_waitcnt lgkmcnt(4)
    v_mfma_f32_16x16x32_bf16 v[56:59], a[216:219], a[100:103], v[56:59]
    s_waitcnt lgkmcnt(3)
    v_mfma_f32_16x16x32_bf16 v[56:59], a[220:223], a[104:107], v[56:59]
    s_nop 1
    v_cmp_lt_f32 vcc, s29, v44
    v_mfma_f32_16x16x32_bf16 v[64:67], a[220:223], a[128:131], 0
    s_add_u32 s21, s21, 12032
    v_mfma_f32_16x16x32_bf16 v[64:67], a[216:219], a[124:127], v[64:67]
    v_mfma_f32_16x16x32_bf16 v[64:67], a[212:215], a[120:123], v[64:67]
    s_nop 0
    s_cbranch_vccnz L_rs_tr54a
L_ret_tr54a:
    v_mfma_f32_16x16x32_bf16 v[72:75], a[212:215], a[144:147], 0
    v_fma_f32 v62, v62, s28, v10
    v_fma_f32 v52, v52, s28, v9
    v_mfma_f32_16x16x32_bf16 v[72:75], a[216:219], a[148:151], v[72:75]
    s_waitcnt vmcnt(6) lgkmcnt(0)
    v_exp_f32 v52, v52
    v_mfma_f32_16x16x32_bf16 v[72:75], a[220:223], a[152:155], v[72:75]
    s_add_u32 m0, s22, 12288
    v_fma_f32 v60, v60, s28, v10
    v_fma_f32 v55, v55, s28, v9
    v_mfma_f32_16x16x32_bf16 v[80:83], a[220:223], a[176:179], 0
    s_barrier
    v_mfma_f32_16x16x32_bf16 v[80:83], a[216:219], a[172:175], v[80:83]
    buffer_load_dwordx4 v6, s[4:7], s20 offen lds
    v_mfma_f32_16x16x32_bf16 v[80:83], a[212:215], a[168:171], v[80:83]
    v_exp_f32 v55, v55
    v_mfma_f32_16x16x32_bf16 v[88:91], a[212:215], a[192:195], 0
    ds_read_b64_tr_b16 a[212:213], v2 offset:0
    v_fma_f32 v54, v54, s28, v9
    v_mfma_f32_16x16x32_bf16 v[88:91], a[216:219], a[196:199], v[88:91]
    v_exp_f32 v60, v60
    v_mfma_f32_16x16x32_bf16 v[88:91], a[220:223], a[200:203], v[88:91]
    s_add_u32 s20, s20, 128
    ds_read_b64_tr_b16 a[214:215], v2 offset:6144
    v_fma_f32 v53, v53, s28, v9
    v_mfma_f32_16x16x32_bf16 v[88:91], a[224:227], a[204:207], v[88:91]
    ds_read_b64_tr_b16 a[216:217], v3 offset:0
    s_add_u32 m0, s22, 13312
    v_mfma_f32_16x16x32_bf16 v[88:91], a[228:231], a[208:211], v[88:91]
    ds_read_b64_tr_b16 a[218:219], v3 offset:6144
    v_fma_f32 v61, v61, s28, v10
    v_mfma_f32_16x16x32_bf16 v[88:91], a[232:235], v[92:95], v[88:91]
    buffer_load_dwordx4 v6, s[4:7], s20 offen lds
    v_mfma_f32_16x16x32_bf16 v[80:83], a[232:235], a[188:191], v[80:83]
    v_exp_f32 v62, v62
    v_mfma_f32_16x16x32_bf16 v[80:83], a[228:231], a[184:187], v[80:83]
    s_add_u32 s20, s20, 128
    s_add_u32 m0, s22, 14336
    v_fma_f32 v63, v63, s28, v10
    v_mfma_f32_16x16x32_bf16 v[80:83], a[224:227], a[180:183], v[80:83]
    buffer_load_dwordx4 v6, s[4:7], s20 offen lds
    v_mfma_f32_16x16x32_bf16 v[72:75], a[224:227], a[156:159], v[72:75]
    v_exp_f32 v54, v54
    v_mfma_f32_16x16x32_bf16 v[72:75], a[228:231], a[160:163], v[72:75]
    ds_read_b64_tr_b16 a[220:221], v4 offset:0
    v_mfma_f32_16x16x32_bf16 v[72:75], a[232:235], a[164:167], v[72:75]
    v_exp_f32 v61, v61
    v_mfma_f32_16x16x32_bf16 v[64:67], a[232:235], a[140:143], v[64:67]
    v_exp_f32 v63, v63
    v_mfma_f32_16x16x32_bf16 v[64:67], a[228:231], a[136:139], v[64:67]
    v_exp_f32 v53, v53
    v_mfma_f32_16x16x32_bf16 v[64:67], a[224:227], a[132:135], v[64:67]
    ds_read_b64_tr_b16 a[222:223], v4 offset:6144
    v_cvt_pk_bf16_f32 v18, v52, v53
    v_mfma_f32_16x16x32_bf16 v[56:59], a[224:227], a[108:111], v[56:59]
    s_add_u32 s20, s20, 12032
    v_cvt_pk_bf16_f32 v25, v62, v63
    v_cvt_pk_bf16_f32 v24, v60, v61
    v_mfma_f32_16x16x32_bf16 v[56:59], a[228:231], a[112:115], v[56:59]
    ds_read_b64_tr_b16 a[224:225], v5 offset:0
    v_cvt_pk_bf16_f32 v19, v54, v55
    v_mfma_f32_16x16x32_bf16 v[56:59], a[232:235], a[116:119], v[56:59]
    s_waitcnt lgkmcnt(3)
    ds_read_b64_tr_b16 a[226:227], v5 offset:6144
    v_mfma_f32_16x16x32_bf16 v[112:115], a[212:215], v[14:17], v[112:115]
    ds_read_b64_tr_b16 a[230:231], v2 offset:7168
    v_fma_f32 v87, v87, s28, v13
    v_mfma_f32_16x16x32_bf16 v[116:119], a[216:219], v[14:17], v[116:119]
    v_fma_f32 v66, v66, s28, v10
    v_fma_f32 v73, v73, s28, v11
    v_mfma_f32_16x16x32_bf16 v[164:167], a[216:219], v[20:23], v[164:167]
    ds_read_b64_tr_b16 a[234:235], v3 offset:7168
    v_and_b32 v104, 0x3ff, v0
    v_mfma_f32_16x16x32_bf16 v[160:163], a[212:215], v[20:23], v[160:163]
    v_fma_f32 v72, v72, s28, v11
    v_fma_f32 v83, v83, s28, v12
    v_mfma_f32_16x16x32_bf16 v[208:211], a[212:215], v[26:29], v[208:211]
    ds_read_b64_tr_b16 a[228:229], v2 offset:1024
    v_fma_f32 v67, v67, s28, v10
    v_mfma_f32_16x16x32_bf16 v[212:215], a[216:219], v[26:29], v[212:215]
    ds_read_b64_tr_b16 a[232:233], v3 offset:1024
    v_lshrrev_b32 v105, 11, v0
    v_mfma_f32_16x16x32_bf16 a[4:7], a[216:219], v[32:35], a[4:7]
    v_fma_f32 v89, v89, s28, v13
    v_fma_f32 v56, v56, s28, v9
    v_mfma_f32_16x16x32_bf16 a[0:3], a[212:215], v[32:35], a[0:3]
    v_fma_f32 v70, v70, s28, v11
    v_fma_f32 v58, v58, s28, v9
    v_mfma_f32_16x16x32_bf16 a[48:51], a[212:215], v[38:41], a[48:51]
    ds_read_b64_tr_b16 a[212:213], v4 offset:1024
    v_fma_f32 v57, v57, s28, v9
    v_mfma_f32_16x16x32_bf16 a[52:55], a[216:219], v[38:41], a[52:55]
    s_waitcnt lgkmcnt(5)
    v_fma_f32 v78, v78, s28, v12
    v_fma_f32 v81, v81, s28, v12
    v_mfma_f32_16x16x32_bf16 a[56:59], a[220:223], v[38:41], a[56:59]
    v_xor_b32 v105, s65, v105
    v_lshl_add_u32 v104, v105, 10, v104
    v_mfma_f32_16x16x32_bf16 a[60:63], a[224:227], v[38:41], a[60:63]
    v_fma_f32 v65, v65, s28, v10
    v_add_u32 v104, s38, v104
    v_mfma_f32_16x16x32_bf16 a[12:15], a[224:227], v[32:35], a[12:15]
    ds_read_b64_tr_b16 a[214:215], v4 offset:7168
    v_fma_f32 v90, v90, s28, v13
    v_mfma_f32_16x16x32_bf16 a[8:11], a[220:223], v[32:35], a[8:11]
    ds_read_b64_tr_b16 a[218:219], v5 offset:7168
    v_fma_f32 v76, v76, s28, v12
    v_mfma_f32_16x16x32_bf16 v[216:219], a[220:223], v[26:29], v[216:219]
    ds_read_b64_tr_b16 a[216:217], v5 offset:1024
    v_fma_f32 v84, v84, s28, v13
    v_mfma_f32_16x16x32_bf16 v[220:223], a[224:227], v[26:29], v[220:223]
    v_exp_f32 v73, v73
    v_mfma_f32_16x16x32_bf16 v[172:175], a[224:227], v[20:23], v[172:175]
    v_exp_f32 v78, v78
    v_mfma_f32_16x16x32_bf16 v[168:171], a[220:223], v[20:23], v[168:171]
    v_exp_f32 v65, v65
    v_mfma_f32_16x16x32_bf16 v[120:123], a[220:223], v[14:17], v[120:123]
    ds_read_b64_tr_b16 a[220:221], v2 offset:2048
    v_fma_f32 v77, v77, s28, v12
    v_mfma_f32_16x16x32_bf16 v[124:127], a[224:227], v[14:17], v[124:127]
    s_waitcnt lgkmcnt(4)
    ds_read_b64_tr_b16 a[224:225], v3 offset:2048
    v_fma_f32 v91, v91, s28, v13
    v_mfma_f32_16x16x32_bf16 v[128:131], a[228:231], v[14:17], v[128:131]
    ds_read_b128 a[128:131], v104 offset:8192
    v_fma_f32 v71, v71, s28, v11
    v_mfma_f32_16x16x32_bf16 v[132:135], a[232:235], v[14:17], v[132:135]
    v_exp_f32 v58, v58
    v_mfma_f32_16x16x32_bf16 v[180:183], a[232:235], v[20:23], v[180:183]
    v_exp_f32 v84, v84
    v_mfma_f32_16x16x32_bf16 v[176:179], a[228:231], v[20:23], v[176:179]
    v_exp_f32 v67, v67
    v_mfma_f32_16x16x32_bf16 v[224:227], a[228:231], v[26:29], v[224:227]
    ds_read_b64_tr_b16 a[226:227], v3 offset:8192
    v_fma_f32 v68, v68, s28, v11
    v_mfma_f32_16x16x32_bf16 v[228:231], a[232:235], v[26:29], v[228:231]
    v_exp_f32 v91, v91
    v_mfma_f32_16x16x32_bf16 a[20:23], a[232:235], v[32:35], a[20:23]
    v_exp_f32 v81, v81
    v_mfma_f32_16x16x32_bf16 a[16:19], a[228:231], v[32:35], a[16:19]
    ds_read_b64_tr_b16 a[222:223], v2 offset:8192
    v_fma_f32 v69, v69, s28, v11
    v_mfma_f32_16x16x32_bf16 a[64:67], a[228:231], v[38:41], a[64:67]
    ds_read_b128 a[104:107], v104 offset:2048
    v_exp_f32 v87, v87
    v_mfma_f32_16x16x32_bf16 a[68:71], a[232:235], v[38:41], a[68:71]
    s_waitcnt lgkmcnt(4)
    ds_read_b128 a[176:179], v104 offset:20480
    v_fma_f32 v79, v79, s28, v12
    v_mfma_f32_16x16x32_bf16 a[72:75], a[212:215], v[38:41], a[72:75]
    v_exp_f32 v70, v70
    v_mfma_f32_16x16x32_bf16 a[76:79], a[216:219], v[38:41], a[76:79]
    ds_read_b64_tr_b16 a[228:229], v4 offset:2048
    v_fma_f32 v85, v85, s28, v13
    v_mfma_f32_16x16x32_bf16 a[28:31], a[216:219], v[32:35], a[28:31]
    v_exp_f32 v69, v69
    v_mfma_f32_16x16x32_bf16 a[24:27], a[212:215], v[32:35], a[24:27]
    ds_read_b64_tr_b16 a[230:231], v4 offset:8192
    v_fma_f32 v88, v88, s28, v13
    v_mfma_f32_16x16x32_bf16 v[232:235], a[212:215], v[26:29], v[232:235]
    ds_read_b64_tr_b16 a[234:235], v5 offset:8192
    v_xor_b32 v105, 64, v104
    v_mfma_f32_16x16x32_bf16 v[236:239], a[216:219], v[26:29], v[236:239]
    ds_read_b64_tr_b16 a[232:233], v5 offset:2048
    v_fma_f32 v75, v75, s28, v11
    v_mfma_f32_16x16x32_bf16 v[188:191], a[216:219], v[20:23], v[188:191]
    ds_read_b128 a[152:155], v104 offset:14336
    v_fma_f32 v74, v74, s28, v11
    v_mfma_f32_16x16x32_bf16 v[184:187], a[212:215], v[20:23], v[184:187]
    v_exp_f32 v88, v88
    v_mfma_f32_16x16x32_bf16 v[136:139], a[212:215], v[14:17], v[136:139]
    v_exp_f32 v77, v77
    v_mfma_f32_16x16x32_bf16 v[140:143], a[216:219], v[14:17], v[140:143]
    s_waitcnt lgkmcnt(5)
    ds_read_b128 a[96:99], v104 offset:0
    v_fma_f32 v86, v86, s28, v13
    v_mfma_f32_16x16x32_bf16 v[144:147], a[220:223], v[14:17], v[144:147]
    ds_read_b128 a[168:171], v104 offset:18432
    v_fma_f32 v82, v82, s28, v12
    v_mfma_f32_16x16x32_bf16 v[148:151], a[224:227], v[14:17], v[148:151]
    ds_read_b128 a[124:127], v105 offset:6144
    v_exp_f32 v79, v79
    v_mfma_f32_16x16x32_bf16 v[196:199], a[224:227], v[20:23], v[196:199]
    v_exp_f32 v85, v85
    v_mfma_f32_16x16x32_bf16 v[192:195], a[220:223], v[20:23], v[192:195]
    s_add_u32 s39, s39, 12288
    ds_read_b128 a[160:163], v104 offset:16384
    v_exp_f32 v90, v90
    v_mfma_f32_16x16x32_bf16 v[240:243], a[220:223], v[26:29], v[240:243]
    v_exp_f32 v71, v71
    v_mfma_f32_16x16x32_bf16 v[244:247], a[224:227], v[26:29], v[244:247]
    ds_read_b128 a[180:183], v105 offset:20480
    v_exp_f32 v68, v68
    v_mfma_f32_16x16x32_bf16 a[36:39], a[224:227], v[32:35], a[36:39]
    s_waitcnt vmcnt(6) lgkmcnt(5)
    v_exp_f32 v86, v86
    v_mfma_f32_16x16x32_bf16 a[32:35], a[220:223], v[32:35], a[32:35]
    v_exp_f32 v76, v76
    v_mfma_f32_16x16x32_bf16 a[80:83], a[220:223], v[38:41], a[80:83]
    s_add_u32 s21, s21, s62
    ds_read_b128 a[100:103], v105 offset:0
    v_fma_f32 v59, v59, s28, v9
    v_mfma_f32_16x16x32_bf16 a[84:87], a[224:227], v[38:41], a[84:87]
    s_barrier
    ds_read_b128 a[148:151], v105 offset:12288
    v_mfma_f32_16x16x32_bf16 a[88:91], a[228:231], v[38:41], a[88:91]
    ds_read_b128 a[212:215], v0 offset:0
    v_fma_f32 v64, v64, s28, v10
    v_mfma_f32_16x16x32_bf16 a[92:95], a[232:235], v[38:41], a[92:95]
    s_add_u32 m0, s22, 24576
    ds_read_b128 a[216:219], v1 offset:0
    buffer_load_dwordx4 v6, s[8:11], s21 offen lds
    v_mfma_f32_16x16x32_bf16 a[44:47], a[232:235], v[32:35], a[44:47]
    ds_read_b128 a[220:223], v0 offset:1024
    v_mfma_f32_16x16x32_bf16 a[40:43], a[228:231], v[32:35], a[40:43]
    ds_read_b128 a[144:147], v104 offset:12288
    v_exp_f32 v82, v82
    v_mfma_f32_16x16x32_bf16 v[248:251], a[228:231], v[26:29], v[248:251]
    s_add_u32 s21, s21, 128
    ds_read_b128 a[172:175], v105 offset:18432
    s_add_u32 m0, s22, 25600
    v_mfma_f32_16x16x32_bf16 v[252:255], a[232:235], v[26:29], v[252:255]
    ds_read_b128 a[120:123], v104 offset:6144
    buffer_load_dwordx4 v6, s[8:11], s21 offen lds
    v_mfma_f32_16x16x32_bf16 v[204:207], a[232:235], v[20:23], v[204:207]
    ds_read_b128 a[132:135], v105 offset:8192
    v_cvt_pk_bf16_f32 v36, v76, v77
    v_mfma_f32_16x16x32_bf16 v[200:203], a[228:231], v[20:23], v[200:203]
    s_add_u32 s21, s21, 128
    s_add_u32 m0, s22, 26624
    ds_read_b128 a[184:187], v104 offset:22528
    v_mfma_f32_16x16x32_bf16 v[152:155], a[228:231], v[14:17], v[152:155]
    ds_read_b128 a[164:167], v105 offset:16384
    buffer_load_dwordx4 v6, s[8:11], s21 offen lds
    v_mfma_f32_16x16x32_bf16 v[156:159], a[232:235], v[14:17], v[156:159]
    s_waitcnt lgkmcnt(8)
    ds_read_b128 a[224:227], v1 offset:1024
    v_cvt_pk_bf16_f32 v31, v70, v71
    v_mfma_f32_16x16x32_bf16 v[52:55], a[212:215], a[96:99], 0
    s_waitcnt lgkmcnt(8)
    v_exp_f32 v59, v59
    v_mfma_f32_16x16x32_bf16 v[52:55], a[216:219], a[100:103], v[52:55]
    s_waitcnt lgkmcnt(7)
    ds_read_b128 a[232:235], v1 offset:2048
    v_exp_f32 v83, v83
    v_mfma_f32_16x16x32_bf16 v[52:55], a[220:223], a[104:107], v[52:55]
    ds_read_b128 a[228:231], v0 offset:2048
    v_cvt_pk_bf16_f32 v37, v78, v79
    v_mfma_f32_16x16x32_bf16 v[60:63], a[220:223], a[128:131], 0
    ds_read_b128 a[188:191], v105 offset:22528
    v_cvt_pk_bf16_f32 v42, v84, v85
    v_mfma_f32_16x16x32_bf16 v[60:63], a[216:219], a[124:127], v[60:63]
    s_waitcnt lgkmcnt(7)
    ds_read_b128 a[136:139], v104 offset:10240
    v_cvt_pk_bf16_f32 v17, v58, v59
    v_mfma_f32_16x16x32_bf16 v[60:63], a[212:215], a[120:123], v[60:63]
    ds_read_b128 a[112:115], v104 offset:4096
    v_cvt_pk_bf16_f32 v30, v68, v69
    v_mfma_f32_16x16x32_bf16 v[68:71], a[212:215], a[144:147], 0
    ds_read_b128 a[156:159], v105 offset:14336
    v_cvt_pk_bf16_f32 v41, v90, v91
    v_mfma_f32_16x16x32_bf16 v[68:71], a[216:219], a[148:151], v[68:71]
    ds_read_b128 a[140:143], v105 offset:10240
    v_cvt_pk_bf16_f32 v43, v86, v87
    v_mfma_f32_16x16x32_bf16 v[68:71], a[220:223], a[152:155], v[68:71]
    v_exp_f32 v64, v64
    v_mfma_f32_16x16x32_bf16 v[76:79], a[220:223], a[176:179], 0
    v_exp_f32 v74, v74
    v_mfma_f32_16x16x32_bf16 v[76:79], a[216:219], a[172:175], v[76:79]
    ds_read_b128 a[116:119], v105 offset:4096
    v_fma_f32 v80, v80, s28, v12
    v_mfma_f32_16x16x32_bf16 v[76:79], a[212:215], a[168:171], v[76:79]
    s_waitcnt lgkmcnt(7)
    ds_read_b128 a[108:111], v105 offset:2048
    v_exp_f32 v57, v57
    v_mfma_f32_16x16x32_bf16 v[76:79], a[224:227], a[180:183], v[76:79]
    s_waitcnt lgkmcnt(7)
    v_exp_f32 v56, v56
    v_mfma_f32_16x16x32_bf16 v[76:79], a[228:231], a[184:187], v[76:79]
    s_waitcnt lgkmcnt(6)
    ds_read_b128 a[212:215], v0 offset:6144
    v_cvt_pk_bf16_f32 v22, v64, v65
    v_mfma_f32_16x16x32_bf16 v[76:79], a[232:235], a[188:191], v[76:79]
    v_exp_f32 v89, v89
    v_mfma_f32_16x16x32_bf16 v[68:71], a[232:235], a[164:167], v[68:71]
    v_exp_f32 v75, v75
    v_mfma_f32_16x16x32_bf16 v[68:71], a[228:231], a[160:163], v[68:71]
    s_waitcnt lgkmcnt(4)
    v_exp_f32 v80, v80
    v_mfma_f32_16x16x32_bf16 v[68:71], a[224:227], a[156:159], v[68:71]
    v_exp_f32 v72, v72
    v_mfma_f32_16x16x32_bf16 v[60:63], a[224:227], a[132:135], v[60:63]
    v_exp_f32 v66, v66
    v_mfma_f32_16x16x32_bf16 v[60:63], a[228:231], a[136:139], v[60:63]
    s_waitcnt lgkmcnt(3)
    ds_read_b128 a[216:219], v1 offset:6144
    v_cvt_pk_bf16_f32 v23, v66, v67
    v_mfma_f32_16x16x32_bf16 v[60:63], a[232:235], a[140:143], v[60:63]
    s_waitcnt lgkmcnt(3)
    ds_read_b128 a[220:223], v0 offset:7168
    v_cvt_pk_bf16_f32 v40, v88, v89
    v_mfma_f32_16x16x32_bf16 v[52:55], a[232:235], a[116:119], v[52:55]
    v_cvt_pk_bf16_f32 v29, v74, v75
    v_cvt_pk_bf16_f32 v16, v56, v57
    v_mfma_f32_16x16x32_bf16 v[52:55], a[228:231], a[112:115], v[52:55]
    s_waitcnt lgkmcnt(3)
    ds_read_b128 a[232:235], v1 offset:8192
    v_mfma_f32_16x16x32_bf16 v[52:55], a[224:227], a[108:111], v[52:55]
    ds_read_b128 a[228:231], v0 offset:8192
    v_cvt_pk_bf16_f32 v35, v82, v83
    v_mfma_f32_16x16x32_bf16 v[48:51], a[236:239], v[16:19], v[44:47]
    ds_read_b128 a[224:227], v1 offset:7168
    v_cvt_pk_bf16_f32 v28, v72, v73
    v_mfma_f32_16x16x32_bf16 v[48:51], a[240:243], v[22:25], v[48:51]
    v_cvt_pk_bf16_f32 v34, v80, v81
    v_mfma_f32_16x16x32_bf16 v[48:51], a[244:247], v[28:31], v[48:51]
    s_nop 0
    v_mfma_f32_16x16x32_bf16 v[48:51], a[248:251], v[34:37], v[48:51]
    v_mfma_f32_16x16x32_bf16 v[48:51], a[252:255], v[40:43], v[48:51]
    s_waitcnt lgkmcnt(5)
    v_mfma_f32_16x16x32_bf16 v[56:59], a[212:215], a[96:99], 0
    s_waitcnt lgkmcnt(4)
    v_mfma_f32_16x16x32_bf16 v[56:59], a[216:219], a[100:103], v[56:59]
    s_waitcnt lgkmcnt(3)
    v_mfma_f32_16x16x32_bf16 v[56:59], a[220:223], a[104:107], v[56:59]
    s_nop 1
    v_cmp_lt_f32 vcc, s29, v48
    v_mfma_f32_16x16x32_bf16 v[64:67], a[220:223], a[128:131], 0
    s_add_u32 s21, s21, 12032
    v_mfma_f32_16x16x32_bf16 v[64:67], a[216:219], a[124:127], v[64:67]
    v_mfma_f32_16x16x32_bf16 v[64:67], a[212:215], a[120:123], v[64:67]
    s_waitcnt vmcnt(6) lgkmcnt(0)
    s_cbranch_vccnz L_rs_tr54b
L_ret_tr54b:
    v_mfma_f32_16x16x32_bf16 v[72:75], a[212:215], a[144:147], 0
    s_barrier
    v_mfma_f32_16x16x32_bf16 v[72:75], a[216:219], a[148:151], v[72:75]
    s_add_u32 m0, s22, 0
    v_mov_b32 v100, v48
    v_lshrrev_b32 v108, 11, v0
    v_mfma_f32_16x16x32_bf16 v[72:75], a[220:223], a[152:155], v[72:75]
    buffer_load_dwordx4 v6, s[4:7], s20 offen lds
    v_mfma_f32_16x16x32_bf16 v[80:83], a[220:223], a[176:179], 0
    v_and_b32 v101, 0x3ff, v0
    v_xor_b32 v108, s65, v108
    v_mfma_f32_16x16x32_bf16 v[80:83], a[216:219], a[172:175], v[80:83]
    s_add_u32 s20, s20, 128
    v_rcp_f32 v8, v51
    v_mfma_f32_16x16x32_bf16 v[80:83], a[212:215], a[168:171], v[80:83]
    s_add_u32 m0, s22, 1024
    ds_read_b64_tr_b16 a[212:213], v2 offset:18432
    buffer_load_dwordx4 v6, s[4:7], s20 offen lds
    v_lshl_add_u32 v101, v108, 10, v101
    v_mfma_f32_16x16x32_bf16 v[80:83], a[224:227], a[180:183], v[80:83]
    s_add_u32 s20, s20, 128
    ds_read_b64_tr_b16 a[214:215], v2 offset:12288
    v_mbcnt_lo_u32_b32 v108, -1, 0
    v_mfma_f32_16x16x32_bf16 v[80:83], a[228:231], a[184:187], v[80:83]
    s_add_u32 m0, s22, 2048
    ds_read_b64_tr_b16 a[216:217], v3 offset:18432
    buffer_load_dwordx4 v6, s[4:7], s20 offen lds
    v_mfma_f32_16x16x32_bf16 v[80:83], a[232:235], a[188:191], v[80:83]
    ds_read_b64_tr_b16 a[218:219], v3 offset:12288
    v_mbcnt_hi_u32_b32 v108, -1, v108
    v_add_u32 v101, s38, v101
    v_mfma_f32_16x16x32_bf16 v[72:75], a[232:235], a[164:167], v[72:75]
    v_lshrrev_b32 v108, 1, v108
    v_rcp_f32 v50, v50
    v_mfma_f32_16x16x32_bf16 v[72:75], a[228:231], a[160:163], v[72:75]
    v_and_b32 v108, 24, v108
    v_permlane32_swap_b32 v48, v100
    v_mfma_f32_16x16x32_bf16 v[72:75], a[224:227], a[156:159], v[72:75]
    ds_read_b64_tr_b16 a[220:221], v4 offset:18432
    v_bfe_u32 v108, s66, v108, 8
    v_mfma_f32_16x16x32_bf16 v[64:67], a[224:227], a[132:135], v[64:67]
    v_xor_b32 v101, v101, v108
    v_mov_b32 v108, v100
    v_mfma_f32_16x16x32_bf16 v[64:67], a[228:231], a[136:139], v[64:67]
    ds_read_b64_tr_b16 a[222:223], v4 offset:12288
    v_rcp_f32 v102, v49
    v_mfma_f32_16x16x32_bf16 v[64:67], a[232:235], a[140:143], v[64:67]
    v_rcp_f32 v48, v48
    v_mfma_f32_16x16x32_bf16 v[56:59], a[232:235], a[116:119], v[56:59]
    s_add_u32 s20, s20, 12032
    v_permlane16_swap_b32 v100, v108
    v_mfma_f32_16x16x32_bf16 v[56:59], a[228:231], a[112:115], v[56:59]
    v_rcp_f32 v100, v100
    v_mfma_f32_16x16x32_bf16 v[56:59], a[224:227], a[108:111], v[56:59]
    s_waitcnt lgkmcnt(2)
    ds_read_b64_tr_b16 a[224:225], v5 offset:18432
    ds_read_b64_tr_b16 a[226:227], v5 offset:12288
    v_mfma_f32_16x16x32_bf16 v[112:115], a[212:215], v[16:19], v[112:115]
    v_max3_f32 v98, v68, v69, v70
    v_max3_f32 v97, v60, v61, v62
    v_mfma_f32_16x16x32_bf16 v[116:119], a[216:219], v[16:19], v[116:119]
    s_mov_b32 s67, s34
    v_max3_f32 v96, v52, v53, v54
    v_max3_f32 v97, v97, v63, v64
    v_max3_f32 v96, v96, v55, v56
    v_mfma_f32_16x16x32_bf16 v[164:167], a[216:219], v[22:25], v[164:167]
    ds_read_b64_tr_b16 a[234:235], v3 offset:13312
    v_max3_f32 v96, v96, v57, v58
    v_max3_f32 v99, v76, v77, v78
    v_mfma_f32_16x16x32_bf16 v[160:163], a[212:215], v[22:25], v[160:163]
    s_add_u32 s18, s34, 30720
    v_max3_f32 v98, v98, v71, v72
    v_max_f32 v96, v96, v59
    v_mfma_f32_16x16x32_bf16 v[208:211], a[212:215], v[28:31], v[208:211]
    s_mov_b32 s34, s33
    v_max3_f32 v97, v97, v65, v66
    v_max3_f32 v98, v98, v73, v74
    v_max3_f32 v99, v99, v79, v80
    v_max3_f32 v99, v99, v81, v82
    v_mfma_f32_16x16x32_bf16 v[212:215], a[216:219], v[28:31], v[212:215]
    s_add_u32 s64, s64, s62
    ds_read_b64_tr_b16 a[232:233], v3 offset:19456
    v_max_f32 v99, v99, v83
    v_mfma_f32_16x16x32_bf16 a[4:7], a[216:219], v[34:37], a[4:7]
    ds_read_b64_tr_b16 a[230:231], v2 offset:13312
    v_max_f32 v97, v97, v67
    v_mfma_f32_16x16x32_bf16 a[0:3], a[212:215], v[34:37], a[0:3]
    s_add_u32 s64, s64, 196608
    ds_read_b64_tr_b16 a[228:229], v2 offset:19456
    v_max_f32 v98, v98, v75
    v_mfma_f32_16x16x32_bf16 a[48:51], a[212:215], v[40:43], a[48:51]
    v_permlane32_swap_b32 v96, v97
    v_permlane32_swap_b32 v98, v99
    v_mfma_f32_16x16x32_bf16 a[52:55], a[216:219], v[40:43], a[52:55]
    s_waitcnt lgkmcnt(4)
    v_max_f32 v98, v98, v99
    v_max_f32 v96, v96, v97
    v_mfma_f32_16x16x32_bf16 a[56:59], a[220:223], v[40:43], a[56:59]
    s_mov_b32 s39, s64
    v_permlane16_swap_b32 v96, v98
    v_mfma_f32_16x16x32_bf16 a[60:63], a[224:227], v[40:43], a[60:63]
    s_add_u32 s37, s37, 1
    ds_read_b64_tr_b16 a[212:213], v4 offset:19456
    v_max_f32 v96, v96, v98
    v_mfma_f32_16x16x32_bf16 a[12:15], a[224:227], v[34:37], a[12:15]
    s_bitcmp1_b32 s63, s37
    v_mul_f32_e64 v9, -s28, v96
    v_mov_b32 v11, v9
    v_mfma_f32_16x16x32_bf16 a[8:11], a[220:223], v[34:37], a[8:11]
    s_cselect_b32 s62, 4294770688, 0
    v_permlane16_swap_b32 v9, v11
    v_mfma_f32_16x16x32_bf16 v[216:219], a[220:223], v[28:31], v[216:219]
    s_cselect_b32 s42, 0, 325632
    v_mov_b32 v12, v11
    s_add_u32 s35, s35, s42
    v_mfma_f32_16x16x32_bf16 v[220:223], a[224:227], v[28:31], v[220:223]
    s_lshl_b32 s42, s37, 1
    ds_read_b64_tr_b16 a[216:217], v5 offset:19456
    v_mov_b32 v10, v9
    v_mfma_f32_16x16x32_bf16 v[172:175], a[224:227], v[22:25], v[172:175]
    s_lshr_b32 s42, s31, s42
    ds_read_b64_tr_b16 a[218:219], v5 offset:13312
    v_permlane32_swap_b32 v9, v10
    v_mfma_f32_16x16x32_bf16 v[168:171], a[220:223], v[22:25], v[168:171]
    s_and_b32 s42, s42, 3
    v_permlane32_swap_b32 v11, v12
    v_fma_f32 v65, v65, s28, v10
    v_mfma_f32_16x16x32_bf16 v[120:123], a[220:223], v[16:19], v[120:123]
    s_add_u32 s42, s42, s36
    v_fma_f32 v64, v64, s28, v10
    v_fma_f32 v66, v66, s28, v10
    v_mfma_f32_16x16x32_bf16 v[124:127], a[224:227], v[16:19], v[124:127]
    s_waitcnt lgkmcnt(3)
    ds_read_b64_tr_b16 a[222:223], v2 offset:14336
    v_subrev_u32 v103, 28672, v103
    v_mfma_f32_16x16x32_bf16 v[128:131], a[228:231], v[16:19], v[128:131]
    s_sub_u32 s43, s42, 3
    v_fma_f32 v68, v68, s28, v11
    v_fma_f32 v63, v63, s28, v10
    v_fma_f32 v72, v72, s28, v11
    v_fma_f32 v61, v61, s28, v10
    v_mfma_f32_16x16x32_bf16 v[132:135], a[232:235], v[16:19], v[132:135]
    s_cmp_ge_u32 s42, 3
    ds_read_b64_tr_b16 a[214:215], v4 offset:13312
    v_fma_f32 v80, v80, s28, v12
    v_mfma_f32_16x16x32_bf16 v[180:183], a[232:235], v[22:25], v[180:183]
    s_cselect_b32 s42, s43, s42
    v_fma_f32 v79, v79, s28, v12
    v_fma_f32 v53, v53, s28, v9
    v_mfma_f32_16x16x32_bf16 v[176:179], a[228:231], v[22:25], v[176:179]
    s_mul_i32 s44, s3, 5
    v_exp_f32 v79, v79
    v_mfma_f32_16x16x32_bf16 v[224:227], a[228:231], v[28:31], v[224:227]
    s_mov_b32 s32, 1
    ds_read_b64_tr_b16 a[226:227], v3 offset:14336
    v_mov_b32 v39, v7
    v_fma_f32 v55, v55, s28, v9
    v_fma_f32 v62, v62, s28, v10
    v_fma_f32 v75, v75, s28, v11
    v_pk_mul_f32 v[116:117], v[116:117], v[48:49] op_sel_hi:[1,0]
    v_pk_mul_f32 v[208:209], v[208:209], v[50:51] op_sel_hi:[1,0]
    v_fma_f32 v67, v67, s28, v10
    v_fma_f32 v54, v54, s28, v9
    v_mfma_f32_16x16x32_bf16 v[228:231], a[232:235], v[28:31], v[228:231]
    s_lshl_b32 s43, s3, 2
    ds_read_b64_tr_b16 a[224:225], v3 offset:20480
    v_fma_f32 v81, v81, s28, v12
    v_cvt_pk_bf16_f32 v208, v208, v209
    v_mfma_f32_16x16x32_bf16 a[20:23], a[232:235], v[34:37], a[20:23]
    s_add_u32 s45, s43, 21
    v_exp_f32 v54, v54
    v_mfma_f32_16x16x32_bf16 a[16:19], a[228:231], v[34:37], a[16:19]
    s_cmp_eq_u32 s3, 0
    v_exp_f32 v53, v53
    v_mfma_f32_16x16x32_bf16 a[64:67], a[228:231], v[40:43], a[64:67]
    s_cselect_b32 s45, 20, s45
    ds_read_b64_tr_b16 a[220:221], v2 offset:20480
    v_accvgpr_read_b32 v107, a3
    v_mfma_f32_16x16x32_bf16 a[68:71], a[232:235], v[40:43], a[68:71]
    s_waitcnt lgkmcnt(3)
    ds_read_b64_tr_b16 a[234:235], v5 offset:14336
    v_fma_f32 v52, v52, s28, v9
    v_mfma_f32_16x16x32_bf16 a[72:75], a[212:215], v[40:43], a[72:75]
    s_cselect_b32 s33, 1, 0
    v_fma_f32 v74, v74, s28, v11
    v_fma_f32 v57, v57, s28, v9
    v_mfma_f32_16x16x32_bf16 a[76:79], a[216:219], v[40:43], a[76:79]
    s_cmp_eq_u32 s42, 1
    v_fma_f32 v69, v69, s28, v11
    v_fma_f32 v71, v71, s28, v11
    v_fma_f32 v58, v58, s28, v9
    v_mfma_f32_16x16x32_bf16 a[28:31], a[216:219], v[34:37], a[28:31]
    s_cselect_b32 s44, s45, s44
    v_exp_f32 v62, v62
    v_mfma_f32_16x16x32_bf16 a[24:27], a[212:215], v[34:37], a[24:27]
    s_cselect_b32 s32, s33, s32
    ds_read_b64_tr_b16 a[228:229], v4 offset:20480
    v_fma_f32 v56, v56, s28, v9
    v_mfma_f32_16x16x32_bf16 v[232:235], a[212:215], v[28:31], v[232:235]
    s_add_u32 s45, s43, 37
    ds_read_b64_tr_b16 a[232:233], v5 offset:20480
    s_cmp_eq_u32 s42, 2
    v_mfma_f32_16x16x32_bf16 v[236:239], a[216:219], v[28:31], v[236:239]
    s_cselect_b32 s44, s45, s44
    v_exp_f32 v52, v52
    v_mfma_f32_16x16x32_bf16 v[188:191], a[216:219], v[22:25], v[188:191]
    s_cselect_b32 s32, 0, s32
    v_exp_f32 v67, v67
    v_mfma_f32_16x16x32_bf16 v[184:187], a[212:215], v[22:25], v[184:187]
    s_mul_i32 s44, s44, 6144
    v_exp_f32 v63, v63
    v_mfma_f32_16x16x32_bf16 v[136:139], a[212:215], v[16:19], v[136:139]
    s_add_u32 s33, s35, s44
    ds_read_b64_tr_b16 a[230:231], v4 offset:14336
    v_accvgpr_read_b32 v104, a0
    v_mfma_f32_16x16x32_bf16 v[140:143], a[216:219], v[16:19], v[140:143]
    s_waitcnt lgkmcnt(3)
    v_fma_f32 v78, v78, s28, v12
    v_fma_f32 v83, v83, s28, v12
    v_mfma_f32_16x16x32_bf16 v[144:147], a[220:223], v[16:19], v[144:147]
    s_mul_i32 s42, s32, 6144
    v_cvt_pk_bf16_f32 v21, v62, v63
    v_fma_f32 v76, v76, s28, v12
    v_mfma_f32_16x16x32_bf16 v[148:151], a[224:227], v[16:19], v[148:151]
    s_add_u32 s42, s42, 24576
    s_add_u32 s42, s42, s33
    v_fma_f32 v70, v70, s28, v11
    v_mfma_f32_16x16x32_bf16 v[196:199], a[224:227], v[22:25], v[196:199]
    s_cmp_ge_u32 s37, 6
    v_exp_f32 v78, v78
    v_mfma_f32_16x16x32_bf16 v[192:195], a[220:223], v[22:25], v[192:195]
    s_cselect_b32 s14, 0, s42
    v_exp_f32 v55, v55
    v_mfma_f32_16x16x32_bf16 v[240:243], a[220:223], v[28:31], v[240:243]
    s_add_u32 s24, s67, 6144
    v_exp_f32 v76, v76
    v_mfma_f32_16x16x32_bf16 v[244:247], a[224:227], v[28:31], v[244:247]
    s_add_u32 s25, s33, 6144
    s_add_u32 s23, s38, 6144
    v_mov_b32 v38, v6
    v_mfma_f32_16x16x32_bf16 a[36:39], a[224:227], v[34:37], a[36:39]
    s_mov_b32 s27, 0x30c30
    v_fma_f32 v60, v60, s28, v10
    v_fma_f32 v77, v77, s28, v12
    v_cvt_pk_bf16_f32 v14, v52, v53
    v_mfma_f32_16x16x32_bf16 a[32:35], a[220:223], v[34:37], a[32:35]
    s_mov_b32 s89, 0xaaaaaaaa
    v_exp_f32 v71, v71
    v_mfma_f32_16x16x32_bf16 a[80:83], a[220:223], v[40:43], a[80:83]
    s_mov_b32 s30, 0
    v_exp_f32 v61, v61
    v_mfma_f32_16x16x32_bf16 a[84:87], a[224:227], v[40:43], a[84:87]
    s_waitcnt vmcnt(6) lgkmcnt(0)
    v_exp_f32 v69, v69
    v_mfma_f32_16x16x32_bf16 a[88:91], a[228:231], v[40:43], a[88:91]
    s_barrier
    ds_read_b128 a[212:215], v0 offset:12288
    v_mfma_f32_16x16x32_bf16 a[92:95], a[232:235], v[40:43], a[92:95]
    ds_read_b128 a[216:219], v1 offset:12288
    v_fma_f32 v73, v73, s28, v11
    v_mfma_f32_16x16x32_bf16 a[44:47], a[232:235], v[34:37], a[44:47]
    ds_read_b128 a[220:223], v0 offset:13312
    v_exp_f32 v77, v77
    v_mfma_f32_16x16x32_bf16 a[40:43], a[228:231], v[34:37], a[40:43]
    v_accvgpr_read_b32 v106, a2
    v_fma_f32 v82, v82, s28, v12
    v_mfma_f32_16x16x32_bf16 v[248:251], a[228:231], v[28:31], v[248:251]
    v_fma_f32 v59, v59, s28, v9
    v_exp_f32 v68, v68
    v_mfma_f32_16x16x32_bf16 v[252:255], a[232:235], v[28:31], v[252:255]
    v_exp_f32 v60, v60
    v_cvt_pk_bf16_f32 v15, v54, v55
    v_mfma_f32_16x16x32_bf16 v[204:207], a[232:235], v[22:25], v[204:207]
    ds_read_b128 a[224:227], v1 offset:13312
    v_exp_f32 v70, v70
    v_mfma_f32_16x16x32_bf16 v[200:203], a[228:231], v[22:25], v[200:203]
    s_add_u32 m0, s22, 36864
    v_cvt_pk_bf16_f32 v33, v78, v79
    v_accvgpr_read_b32 v110, a50
    v_mfma_f32_16x16x32_bf16 v[152:155], a[228:231], v[16:19], v[152:155]
    v_exp_f32 v73, v73
    v_mfma_f32_16x16x32_bf16 v[156:159], a[232:235], v[16:19], v[156:159]
    s_waitcnt lgkmcnt(3)
    ds_read_b128 a[228:231], v0 offset:14336
    v_accvgpr_read_b32 v108, a48
    v_mfma_f32_16x16x32_bf16 v[52:55], a[212:215], a[96:99], 0
    s_waitcnt lgkmcnt(3)
    v_exp_f32 v82, v82
    v_mfma_f32_16x16x32_bf16 v[52:55], a[216:219], a[100:103], v[52:55]
    s_waitcnt lgkmcnt(2)
    v_exp_f32 v66, v66
    v_exp_f32 v81, v81
    v_mfma_f32_16x16x32_bf16 v[52:55], a[220:223], a[104:107], v[52:55]
    v_cvt_pk_bf16_f32 v32, v76, v77
    v_cvt_pk_bf16_f32 v20, v60, v61
    v_mfma_f32_16x16x32_bf16 v[60:63], a[220:223], a[128:131], 0
    ds_read_b128 a[232:235], v1 offset:14336
    v_cvt_pk_bf16_f32 v26, v68, v69
    v_mfma_f32_16x16x32_bf16 v[60:63], a[216:219], a[124:127], v[60:63]
    v_cvt_pk_bf16_f32 v27, v70, v71
    v_exp_f32 v65, v65
    v_mfma_f32_16x16x32_bf16 v[60:63], a[212:215], a[120:123], v[60:63]
    v_exp_f32 v58, v58
    v_mfma_f32_16x16x32_bf16 v[68:71], a[212:215], a[144:147], 0
    v_accvgpr_read_b32 v105, a1
    v_accvgpr_read_b32 v109, a49
    v_mfma_f32_16x16x32_bf16 v[68:71], a[216:219], a[148:151], v[68:71]
    buffer_load_dwordx4 v6, s[8:11], s21 offen lds
    v_mfma_f32_16x16x32_bf16 v[68:71], a[220:223], a[152:155], v[68:71]
    v_exp_f32 v83, v83
    v_mfma_f32_16x16x32_bf16 v[76:79], a[220:223], a[176:179], 0
    v_exp_f32 v80, v80
    v_mfma_f32_16x16x32_bf16 v[76:79], a[216:219], a[172:175], v[76:79]
    v_exp_f32 v59, v59
    v_mfma_f32_16x16x32_bf16 v[76:79], a[212:215], a[168:171], v[76:79]
    s_waitcnt lgkmcnt(1)
    v_exp_f32 v72, v72
    v_mfma_f32_16x16x32_bf16 v[76:79], a[224:227], a[180:183], v[76:79]
    v_exp_f32 v75, v75
    v_mfma_f32_16x16x32_bf16 v[76:79], a[228:231], a[184:187], v[76:79]
    s_waitcnt lgkmcnt(0)
    v_exp_f32 v74, v74
    v_exp_f32 v57, v57
    v_mfma_f32_16x16x32_bf16 v[76:79], a[232:235], a[188:191], v[76:79]
    v_cvt_pk_bf16_f32 v116, v116, v117
    v_cvt_pk_bf16_f32 v35, v82, v83
    v_mfma_f32_16x16x32_bf16 v[68:71], a[232:235], a[164:167], v[68:71]
    ds_read_b128 a[212:215], v0 offset:18432
    v_exp_f32 v56, v56
    v_mfma_f32_16x16x32_bf16 v[68:71], a[228:231], a[160:163], v[68:71]
    s_add_u32 s21, s21, 128
    v_exp_f32 v64, v64
    v_mfma_f32_16x16x32_bf16 v[68:71], a[224:227], a[156:159], v[68:71]
    ds_read_b128 a[216:219], v1 offset:18432
    v_fma_f32 v78, v78, s28, v12
    v_mfma_f32_16x16x32_bf16 v[60:63], a[224:227], a[132:135], v[60:63]
    v_fma_f32 v79, v79, s28, v12
    v_accvgpr_read_b32 v111, a51
    v_mfma_f32_16x16x32_bf16 v[60:63], a[228:231], a[136:139], v[60:63]
    v_exp_f32 v79, v79
    v_mfma_f32_16x16x32_bf16 v[60:63], a[232:235], a[140:143], v[60:63]
    s_add_u32 m0, s22, 37888
    ds_read_b128 a[220:223], v0 offset:19456
    buffer_load_dwordx4 v6, s[8:11], s21 offen lds
    v_exp_f32 v78, v78
    v_pk_mul_f32 v[216:217], v[216:217], v[50:51] op_sel_hi:[1,0]
    v_pk_mul_f32 v[108:109], v[108:109], v[100:101] op_sel_hi:[1,0]
    v_pk_mul_f32 v[218:219], v[218:219], v[50:51] op_sel_hi:[1,0]
    v_pk_mul_f32 v[210:211], v[210:211], v[50:51] op_sel_hi:[1,0]
    v_pk_mul_f32 v[112:113], v[112:113], v[48:49] op_sel_hi:[1,0]
    v_pk_mul_f32 v[220:221], v[220:221], v[50:51] op_sel_hi:[1,0]
    v_pk_mul_f32 v[224:225], v[224:225], v[50:51] op_sel_hi:[1,0]
    v_pk_mul_f32 v[180:181], v[180:181], v[102:103] op_sel_hi:[1,0]
    v_pk_mul_f32 v[152:153], v[152:153], v[48:49] op_sel_hi:[1,0]
    v_pk_mul_f32 v[136:137], v[136:137], v[48:49] op_sel_hi:[1,0]
    v_pk_mul_f32 v[212:213], v[212:213], v[50:51] op_sel_hi:[1,0]
    v_pk_mul_f32 v[130:131], v[130:131], v[48:49] op_sel_hi:[1,0]
    v_pk_mul_f32 v[114:115], v[114:115], v[48:49] op_sel_hi:[1,0]
    v_pk_mul_f32 v[110:111], v[110:111], v[100:101] op_sel_hi:[1,0]
    v_pk_mul_f32 v[162:163], v[162:163], v[102:103] op_sel_hi:[1,0]
    v_pk_mul_f32 v[214:215], v[214:215], v[50:51] op_sel_hi:[1,0]
    v_pk_mul_f32 v[160:161], v[160:161], v[102:103] op_sel_hi:[1,0]
    v_pk_mul_f32 v[226:227], v[226:227], v[50:51] op_sel_hi:[1,0]
    v_cvt_pk_bf16_f32 v22, v64, v65
    v_pk_mul_f32 v[168:169], v[168:169], v[102:103] op_sel_hi:[1,0]
    v_pk_mul_f32 v[104:105], v[104:105], v[8:9] op_sel_hi:[1,0]
    v_pk_mul_f32 v[120:121], v[120:121], v[48:49] op_sel_hi:[1,0]
    v_pk_mul_f32 v[192:193], v[192:193], v[102:103] op_sel_hi:[1,0]
    v_pk_mul_f32 v[200:201], v[200:201], v[102:103] op_sel_hi:[1,0]
    v_cvt_pk_bf16_f32 v209, v210, v211
    v_pk_mul_f32 v[252:253], v[252:253], v[50:51] op_sel_hi:[1,0]
    v_pk_mul_f32 v[128:129], v[128:129], v[48:49] op_sel_hi:[1,0]
    v_cvt_pk_bf16_f32 v104, v104, v105
    v_cvt_pk_bf16_f32 v108, v108, v109
    v_pk_mul_f32 v[106:107], v[106:107], v[8:9] op_sel_hi:[1,0]
    v_cvt_pk_bf16_f32 v16, v56, v57
    v_pk_mul_f32 v[166:167], v[166:167], v[102:103] op_sel_hi:[1,0]
    v_pk_mul_f32 v[164:165], v[164:165], v[102:103] op_sel_hi:[1,0]
    v_cvt_pk_bf16_f32 v109, v110, v111
    v_cvt_pk_bf16_f32 v17, v58, v59
    v_mfma_f32_16x16x32_bf16 v[52:55], a[232:235], a[116:119], v[52:55]
    v_cvt_pk_bf16_f32 v220, v220, v221
    v_accvgpr_read_b32 v111, a55
    v_cvt_pk_bf16_f32 v216, v216, v217
    v_cvt_pk_bf16_f32 v105, v106, v107
    v_mfma_f32_16x16x32_bf16 v[52:55], a[228:231], a[112:115], v[52:55]
    v_cvt_pk_bf16_f32 v29, v74, v75
    v_fma_f32 v69, v69, s28, v11
    v_mfma_f32_16x16x32_bf16 v[52:55], a[224:227], a[108:111], v[52:55]
    s_waitcnt lgkmcnt(0)
    ds_read_b128 a[232:235], v1 offset:20480
    v_cvt_pk_bf16_f32 v34, v80, v81
    v_cvt_pk_bf16_f32 v252, v252, v253
    v_mfma_f32_16x16x32_bf16 v[56:59], a[212:215], a[96:99], 0
    ds_read_b128 a[228:231], v0 offset:20480
    v_fma_f32 v76, v76, s28, v12
    v_mfma_f32_16x16x32_bf16 v[56:59], a[216:219], a[100:103], v[56:59]
    s_add_u32 s21, s21, 128
    v_fma_f32 v63, v63, s28, v10
    v_cvt_pk_bf16_f32 v23, v66, v67
    v_mfma_f32_16x16x32_bf16 v[56:59], a[220:223], a[104:107], v[56:59]
    ds_read_b128 a[224:227], v1 offset:19456
    v_cvt_pk_bf16_f32 v28, v72, v73
    v_mfma_f32_16x16x32_bf16 v[64:67], a[220:223], a[128:131], 0
    v_cvt_pk_bf16_f32 v160, v160, v161
    v_cvt_pk_bf16_f32 v112, v112, v113
    v_mfma_f32_16x16x32_bf16 v[64:67], a[216:219], a[124:127], v[64:67]
    v_cvt_pk_bf16_f32 v161, v162, v163
    v_fma_f32 v53, v53, s28, v9
    v_mfma_f32_16x16x32_bf16 v[64:67], a[212:215], a[120:123], v[64:67]
    s_add_u32 m0, s22, 38912
    v_cvt_pk_bf16_f32 v224, v224, v225
    v_cvt_pk_bf16_f32 v164, v164, v165
    v_mfma_f32_16x16x32_bf16 v[72:75], a[212:215], a[144:147], 0
    v_cvt_pk_bf16_f32 v113, v114, v115
    v_cvt_pk_bf16_f32 v128, v128, v129
    v_mfma_f32_16x16x32_bf16 v[72:75], a[216:219], a[148:151], v[72:75]
    ds_write2st64_b64 v101, v[112:113], v[160:161] offset0:0 offset1:12
    v_fma_f32 v71, v71, s28, v11
    v_cvt_pk_bf16_f32 v152, v152, v153
    v_mfma_f32_16x16x32_bf16 v[72:75], a[220:223], a[152:155], v[72:75]
    buffer_load_dwordx4 v6, s[8:11], s21 offen lds
    v_mfma_f32_16x16x32_bf16 v[80:83], a[220:223], a[176:179], 0
    ds_write2st64_b64 v101, v[208:209], v[104:105] offset0:24 offset1:36
    v_cvt_pk_bf16_f32 v120, v120, v121
    v_mfma_f32_16x16x32_bf16 v[80:83], a[216:219], a[172:175], v[80:83]
    s_add_u32 s21, s21, 12032
    ds_write_b64 v101, v[108:109] offset:24576
    v_mfma_f32_16x16x32_bf16 v[80:83], a[212:215], a[168:171], v[80:83]
    s_waitcnt vmcnt(6) lgkmcnt(3)
    v_fma_f32 v61, v61, s28, v10
    v_cvt_pk_bf16_f32 v225, v226, v227
    v_mfma_f32_16x16x32_bf16 v[80:83], a[224:227], a[180:183], v[80:83]
    s_barrier
    ds_read_b64_tr_b16 a[212:213], v2 offset:0
    v_mfma_f32_16x16x32_bf16 v[80:83], a[228:231], a[184:187], v[80:83]
    v_accvgpr_read_b32 v109, a53
    v_cvt_pk_bf16_f32 v168, v168, v169
    v_mfma_f32_16x16x32_bf16 v[80:83], a[232:235], a[188:191], v[80:83]
    s_add_u32 m0, s22, 12288
    v_fma_f32 v68, v68, s28, v11
    v_accvgpr_read_b32 v105, a5
    v_accvgpr_read_b32 v106, a6
    v_mfma_f32_16x16x32_bf16 v[72:75], a[232:235], a[164:167], v[72:75]
    buffer_load_dwordx4 v6, s[4:7], s20 offen lds
    v_mfma_f32_16x16x32_bf16 v[44:47], a[236:239], v[14:17], 0
    s_add_u32 s20, s20, 128
    v_exp_f32 v69, v69
    v_mfma_f32_16x16x32_bf16 v[72:75], a[228:231], a[160:163], v[72:75]
    v_exp_f32 v53, v53
    v_mfma_f32_16x16x32_bf16 v[72:75], a[224:227], a[156:159], v[72:75]
    v_cvt_pk_bf16_f32 v212, v212, v213
    v_accvgpr_read_b32 v110, a54
    v_mfma_f32_16x16x32_bf16 v[64:67], a[224:227], a[132:135], v[64:67]
    ds_read_b64_tr_b16 a[214:215], v2 offset:6144
    v_fma_f32 v55, v55, s28, v9
    v_mfma_f32_16x16x32_bf16 v[64:67], a[228:231], a[136:139], v[64:67]
    v_fma_f32 v52, v52, s28, v9
    v_accvgpr_read_b32 v107, a7
    v_fma_f32 v81, v81, s28, v12
    v_mfma_f32_16x16x32_bf16 v[64:67], a[232:235], a[140:143], v[64:67]
    ds_read_b64_tr_b16 a[216:217], v3 offset:0
    v_fma_f32 v54, v54, s28, v9
    v_accvgpr_read_b32 v104, a4
    v_exp_f32 v55, v55
    v_fma_f32 v82, v82, s28, v12
    v_pk_mul_f32 v[242:243], v[242:243], v[50:51] op_sel_hi:[1,0]
    v_pk_mul_f32 v[238:239], v[238:239], v[50:51] op_sel_hi:[1,0]
    v_pk_mul_f32 v[182:183], v[182:183], v[102:103] op_sel_hi:[1,0]
    v_pk_mul_f32 v[142:143], v[142:143], v[48:49] op_sel_hi:[1,0]
    v_pk_mul_f32 v[236:237], v[236:237], v[50:51] op_sel_hi:[1,0]
    v_pk_mul_f32 v[176:177], v[176:177], v[102:103] op_sel_hi:[1,0]
    v_cvt_pk_bf16_f32 v165, v166, v167
    v_pk_mul_f32 v[148:149], v[148:149], v[48:49] op_sel_hi:[1,0]
    v_accvgpr_read_b32 v108, a52
    v_pk_mul_f32 v[118:119], v[118:119], v[48:49] op_sel_hi:[1,0]
    v_pk_mul_f32 v[108:109], v[108:109], v[100:101] op_sel_hi:[1,0]
    v_pk_mul_f32 v[178:179], v[178:179], v[102:103] op_sel_hi:[1,0]
    v_pk_mul_f32 v[124:125], v[124:125], v[48:49] op_sel_hi:[1,0]
    v_pk_mul_f32 v[222:223], v[222:223], v[50:51] op_sel_hi:[1,0]
    v_pk_mul_f32 v[110:111], v[110:111], v[100:101] op_sel_hi:[1,0]
    v_cvt_pk_bf16_f32 v108, v108, v109
    v_pk_mul_f32 v[232:233], v[232:233], v[50:51] op_sel_hi:[1,0]
    v_fma_f32 v75, v75, s28, v11
    v_pk_mul_f32 v[196:197], v[196:197], v[102:103] op_sel_hi:[1,0]
    v_pk_mul_f32 v[126:127], v[126:127], v[48:49] op_sel_hi:[1,0]
    v_pk_mul_f32 v[250:251], v[250:251], v[50:51] op_sel_hi:[1,0]
    v_fma_f32 v77, v77, s28, v12
    v_pk_mul_f32 v[194:195], v[194:195], v[102:103] op_sel_hi:[1,0]
    v_cvt_pk_bf16_f32 v124, v124, v125
    v_pk_mul_f32 v[132:133], v[132:133], v[48:49] op_sel_hi:[1,0]
    v_pk_mul_f32 v[104:105], v[104:105], v[8:9] op_sel_hi:[1,0]
    v_pk_mul_f32 v[174:175], v[174:175], v[102:103] op_sel_hi:[1,0]
    v_cvt_pk_bf16_f32 v104, v104, v105
    v_pk_mul_f32 v[190:191], v[190:191], v[102:103] op_sel_hi:[1,0]
    v_fma_f32 v80, v80, s28, v12
    v_exp_f32 v77, v77
    v_pk_mul_f32 v[172:173], v[172:173], v[102:103] op_sel_hi:[1,0]
    v_pk_mul_f32 v[228:229], v[228:229], v[50:51] op_sel_hi:[1,0]
    v_fma_f32 v60, v60, s28, v10
    v_cvt_pk_bf16_f32 v109, v110, v111
    v_pk_mul_f32 v[170:171], v[170:171], v[102:103] op_sel_hi:[1,0]
    v_pk_mul_f32 v[154:155], v[154:155], v[48:49] op_sel_hi:[1,0]
    v_pk_mul_f32 v[106:107], v[106:107], v[8:9] op_sel_hi:[1,0]
    v_cvt_pk_bf16_f32 v213, v214, v215
    v_pk_mul_f32 v[244:245], v[244:245], v[50:51] op_sel_hi:[1,0]
    v_xor_b32 v101, 32, v101
    v_cvt_pk_bf16_f32 v244, v244, v245
    v_mfma_f32_16x16x32_bf16 v[56:59], a[232:235], a[116:119], v[56:59]
    ds_read_b64_tr_b16 a[218:219], v3 offset:6144
    v_cvt_pk_bf16_f32 v117, v118, v119
    v_fma_f32 v66, v66, s28, v10
    v_mfma_f32_16x16x32_bf16 v[56:59], a[228:231], a[112:115], v[56:59]
    ds_read_b64_tr_b16 a[234:235], v3 offset:7168
    v_fma_f32 v70, v70, s28, v11
    v_cvt_pk_bf16_f32 v129, v130, v131
    v_mfma_f32_16x16x32_bf16 v[56:59], a[224:227], a[108:111], v[56:59]
    s_waitcnt lgkmcnt(2)
    ds_read_b64_tr_b16 a[220:221], v4 offset:0
    v_cvt_pk_bf16_f32 v105, v106, v107
    v_mfma_f32_16x16x32_bf16 v[112:115], a[212:215], v[14:17], 0
    ds_read_b64_tr_b16 a[222:223], v4 offset:6144
    v_accvgpr_read_b32 v110, a58
    v_cvt_pk_bf16_f32 v125, v126, v127
    v_fma_f32 v83, v83, s28, v12
    v_cvt_pk_bf16_f32 v217, v218, v219
    v_fma_f32 v58, v58, s28, v9
    v_accvgpr_read_b32 v106, a10
    v_accvgpr_read_b32 v111, a59
    v_fma_f32 v64, v64, s28, v10
    v_cvt_pk_bf16_f32 v236, v236, v237
    v_mfma_f32_16x16x32_bf16 v[160:163], a[212:215], v[20:23], 0
    s_add_u32 m0, s22, 13312
    ds_read_b64_tr_b16 a[224:225], v5 offset:0
    v_exp_f32 v60, v60
    v_cvt_pk_bf16_f32 v221, v222, v223
    v_mfma_f32_16x16x32_bf16 v[208:211], a[212:215], v[26:29], 0
    ds_write2st64_b64 v101, v[116:117], v[164:165] offset0:0 offset1:12
    v_pk_mul_f32 v[140:141], v[140:141], v[48:49] op_sel_hi:[1,0]
    v_pk_mul_f32 v[248:249], v[248:249], v[50:51] op_sel_hi:[1,0]
    v_cvt_pk_bf16_f32 v172, v172, v173
    v_pk_mul_f32 v[188:189], v[188:189], v[102:103] op_sel_hi:[1,0]
    v_pk_mul_f32 v[230:231], v[230:231], v[50:51] op_sel_hi:[1,0]
    v_exp_f32 v76, v76
    v_cvt_pk_bf16_f32 v169, v170, v171
    v_mfma_f32_16x16x32_bf16 a[0:3], a[212:215], v[32:35], 0
    buffer_load_dwordx4 v6, s[4:7], s20 offen lds
    ds_write2st64_b64 v101, v[212:213], v[104:105] offset0:24 offset1:36
    v_mfma_f32_16x16x32_bf16 v[44:47], a[240:243], v[20:23], v[44:47]
    s_waitcnt lgkmcnt(3)
    ds_read_b64_tr_b16 a[228:229], v2 offset:1024
    v_cvt_pk_bf16_f32 v136, v136, v137
    v_mfma_f32_16x16x32_bf16 a[4:7], a[216:219], v[32:35], 0
    s_add_u32 s20, s20, 128
    ds_read_b64_tr_b16 a[232:233], v3 offset:1024
    v_exp_f32 v71, v71
    v_accvgpr_read_b32 v107, a11
    v_mfma_f32_16x16x32_bf16 v[44:47], a[244:247], v[26:29], v[44:47]
    ds_write_b64 v101, v[108:109] offset:24576
    v_accvgpr_read_b32 v108, a56
    v_cvt_pk_bf16_f32 v200, v200, v201
    v_pk_mul_f32 v[186:187], v[186:187], v[102:103] op_sel_hi:[1,0]
    v_accvgpr_read_b32 v109, a57
    v_cvt_pk_bf16_f32 v153, v154, v155
    v_pk_mul_f32 v[108:109], v[108:109], v[100:101] op_sel_hi:[1,0]
    v_fma_f32 v56, v56, s28, v9
    v_pk_mul_f32 v[184:185], v[184:185], v[102:103] op_sel_hi:[1,0]
    v_fma_f32 v73, v73, s28, v11
    v_cvt_pk_bf16_f32 v108, v108, v109
    v_exp_f32 v80, v80
    v_pk_mul_f32 v[156:157], v[156:157], v[48:49] op_sel_hi:[1,0]
    v_accvgpr_read_b32 v105, a9
    v_accvgpr_read_b32 v104, a8
    v_pk_mul_f32 v[146:147], v[146:147], v[48:49] op_sel_hi:[1,0]
    v_pk_mul_f32 v[144:145], v[144:145], v[48:49] op_sel_hi:[1,0]
    v_fma_f32 v65, v65, s28, v10
    v_pk_mul_f32 v[106:107], v[106:107], v[8:9] op_sel_hi:[1,0]
    v_pk_mul_f32 v[110:111], v[110:111], v[100:101] op_sel_hi:[1,0]
    v_pk_mul_f32 v[122:123], v[122:123], v[48:49] op_sel_hi:[1,0]
    v_cvt_pk_bf16_f32 v140, v140, v141
    v_pk_mul_f32 v[134:135], v[134:135], v[48:49] op_sel_hi:[1,0]
    v_exp_f32 v73, v73
    v_pk_mul_f32 v[234:235], v[234:235], v[50:51] op_sel_hi:[1,0]
    v_xor_b32 v101, 96, v101
    v_pk_mul_f32 v[138:139], v[138:139], v[48:49] op_sel_hi:[1,0]
    v_fma_f32 v74, v74, s28, v11
    v_pk_mul_f32 v[104:105], v[104:105], v[8:9] op_sel_hi:[1,0]
    v_cvt_pk_bf16_f32 v121, v122, v123
    v_cvt_pk_bf16_f32 v184, v184, v185
    v_cvt_pk_bf16_f32 v104, v104, v105
    v_mfma_f32_16x16x32_bf16 v[212:215], a[216:219], v[26:29], 0
    ds_write2st64_b64 v101, v[120:121], v[168:169] offset0:0 offset1:12
    v_cvt_pk_bf16_f32 v109, v110, v111
    v_cvt_pk_bf16_f32 v105, v106, v107
    v_cvt_pk_bf16_f32 v176, v176, v177
    v_cvt_pk_bf16_f32 v228, v228, v229
    v_mfma_f32_16x16x32_bf16 v[164:167], a[216:219], v[20:23], 0
    ds_read_b64_tr_b16 a[212:213], v4 offset:1024
    ds_read_b64_tr_b16 a[230:231], v2 offset:7168
    v_mfma_f32_16x16x32_bf16 v[116:119], a[216:219], v[14:17], 0
    s_add_u32 m0, s22, 14336
    ds_write2st64_b64 v101, v[216:217], v[104:105] offset0:24 offset1:36
    v_accvgpr_read_b32 v111, a63
    v_fma_f32 v59, v59, s28, v9
    v_cvt_pk_bf16_f32 v196, v196, v197
    v_mfma_f32_16x16x32_bf16 v[120:123], a[220:223], v[14:17], 0
    ds_read_b64_tr_b16 a[226:227], v5 offset:6144
    v_accvgpr_read_b32 v107, a15
    v_accvgpr_read_b32 v105, a13
    v_mfma_f32_16x16x32_bf16 v[168:171], a[220:223], v[20:23], 0
    buffer_load_dwordx4 v6, s[4:7], s20 offen lds
    ds_write_b64 v101, v[108:109] offset:24576
    v_pk_mul_f32 v[240:241], v[240:241], v[50:51] op_sel_hi:[1,0]
    v_cvt_pk_bf16_f32 v177, v178, v179
    v_accvgpr_read_b32 v108, a60
    v_accvgpr_read_b32 v104, a12
    v_cvt_pk_bf16_f32 v144, v144, v145
    v_accvgpr_read_b32 v110, a62
    v_cvt_pk_bf16_f32 v248, v248, v249
    v_accvgpr_read_b32 v109, a61
    v_pk_mul_f32 v[108:109], v[108:109], v[100:101] op_sel_hi:[1,0]
    v_cvt_pk_bf16_f32 v132, v132, v133
    v_pk_mul_f32 v[202:203], v[202:203], v[102:103] op_sel_hi:[1,0]
    v_pk_mul_f32 v[198:199], v[198:199], v[102:103] op_sel_hi:[1,0]
    v_accvgpr_read_b32 v106, a14
    v_pk_mul_f32 v[150:151], v[150:151], v[48:49] op_sel_hi:[1,0]
    v_pk_mul_f32 v[106:107], v[106:107], v[8:9] op_sel_hi:[1,0]
    v_pk_mul_f32 v[104:105], v[104:105], v[8:9] op_sel_hi:[1,0]
    v_pk_mul_f32 v[110:111], v[110:111], v[100:101] op_sel_hi:[1,0]
    v_cvt_pk_bf16_f32 v104, v104, v105
    v_cvt_pk_bf16_f32 v133, v134, v135
    v_cvt_pk_bf16_f32 v108, v108, v109
    v_cvt_pk_bf16_f32 v173, v174, v175
    v_xor_b32 v101, 32, v101
    v_cvt_pk_bf16_f32 v180, v180, v181
    v_cvt_pk_bf16_f32 v105, v106, v107
    v_accvgpr_read_b32 v107, a19
    v_mfma_f32_16x16x32_bf16 v[44:47], a[248:251], v[32:35], v[44:47]
    ds_write2st64_b64 v101, v[124:125], v[172:173] offset0:0 offset1:12
    v_fma_f32 v57, v57, s28, v9
    v_cvt_pk_bf16_f32 v240, v240, v241
    v_mfma_f32_16x16x32_bf16 v[216:219], a[220:223], v[26:29], 0
    ds_read_b64_tr_b16 a[216:217], v5 offset:1024
    v_cvt_pk_bf16_f32 v109, v110, v111
    v_mfma_f32_16x16x32_bf16 a[8:11], a[220:223], v[32:35], 0
    s_waitcnt lgkmcnt(2)
    ds_write2st64_b64 v101, v[220:221], v[104:105] offset0:24 offset1:36
    v_mfma_f32_16x16x32_bf16 a[12:15], a[224:227], v[32:35], 0
    ds_write_b64 v101, v[108:109] offset:24576
    ds_read_b64_tr_b16 a[222:223], v2 offset:8192
    v_accvgpr_read_b32 v110, a66
    v_accvgpr_read_b32 v109, a65
    v_accvgpr_read_b32 v104, a16
    v_accvgpr_read_b32 v106, a18
    v_accvgpr_read_b32 v108, a64
    v_pk_mul_f32 v[106:107], v[106:107], v[8:9] op_sel_hi:[1,0]
    v_cvt_pk_bf16_f32 v137, v138, v139
    v_pk_mul_f32 v[158:159], v[158:159], v[48:49] op_sel_hi:[1,0]
    v_xor_b32 v101, 96, v101
    v_pk_mul_f32 v[108:109], v[108:109], v[100:101] op_sel_hi:[1,0]
    v_pk_mul_f32 v[246:247], v[246:247], v[50:51] op_sel_hi:[1,0]
    v_accvgpr_read_b32 v111, a67
    v_pk_mul_f32 v[110:111], v[110:111], v[100:101] op_sel_hi:[1,0]
    v_cvt_pk_bf16_f32 v108, v108, v109
    v_accvgpr_read_b32 v105, a17
    v_fma_f32 v62, v62, s28, v10
    v_pk_mul_f32 v[104:105], v[104:105], v[8:9] op_sel_hi:[1,0]
    v_exp_f32 v68, v68
    v_cvt_pk_bf16_f32 v104, v104, v105
    v_cvt_pk_bf16_f32 v105, v106, v107
    v_mfma_f32_16x16x32_bf16 v[220:223], a[224:227], v[26:29], 0
    ds_write2st64_b64 v101, v[128:129], v[176:177] offset0:4 offset1:16
    v_cvt_pk_bf16_f32 v109, v110, v111
    v_cvt_pk_bf16_f32 v237, v238, v239
    v_cvt_pk_bf16_f32 v181, v182, v183
    v_cvt_pk_bf16_f32 v188, v188, v189
    v_mfma_f32_16x16x32_bf16 v[172:175], a[224:227], v[20:23], 0
    ds_write2st64_b64 v101, v[224:225], v[104:105] offset0:28 offset1:40
    v_mfma_f32_16x16x32_bf16 v[124:127], a[224:227], v[14:17], 0
    ds_write_b64 v101, v[108:109] offset:26624
    v_accvgpr_read_b32 v110, a70
    v_accvgpr_read_b32 v104, a20
    v_cvt_pk_bf16_f32 v232, v232, v233
    v_accvgpr_read_b32 v106, a22
    v_cvt_pk_bf16_f32 v145, v146, v147
    v_mfma_f32_16x16x32_bf16 v[128:131], a[228:231], v[14:17], 0
    ds_read_b128 v[96:99], v103 offset:0
    v_cvt_pk_bf16_f32 v229, v230, v231
    v_cvt_pk_bf16_f32 v192, v192, v193
    v_mfma_f32_16x16x32_bf16 v[176:179], a[228:231], v[20:23], 0
    ds_read_b64_tr_b16 a[214:215], v4 offset:7168
    ds_read_b64_tr_b16 a[218:219], v5 offset:7168
    v_accvgpr_read_b32 v111, a71
    v_accvgpr_read_b32 v109, a69
    v_accvgpr_read_b32 v108, a68
    v_accvgpr_read_b32 v105, a21
    v_cvt_pk_bf16_f32 v156, v156, v157
    v_pk_mul_f32 v[104:105], v[104:105], v[8:9] op_sel_hi:[1,0]
    v_pk_mul_f32 v[110:111], v[110:111], v[100:101] op_sel_hi:[1,0]
    v_pk_mul_f32 v[108:109], v[108:109], v[100:101] op_sel_hi:[1,0]
    v_accvgpr_read_b32 v107, a23
    v_exp_f32 v57, v57
    v_xor_b32 v101, 32, v101
    v_cvt_pk_bf16_f32 v141, v142, v143
    v_pk_mul_f32 v[106:107], v[106:107], v[8:9] op_sel_hi:[1,0]
    v_fma_f32 v67, v67, s28, v10
    v_cvt_pk_bf16_f32 v108, v108, v109
    v_cvt_pk_bf16_f32 v104, v104, v105
    v_exp_f32 v63, v63
    v_mfma_f32_16x16x32_bf16 v[224:227], a[228:231], v[26:29], 0
    ds_write2st64_b64 v101, v[132:133], v[180:181] offset0:4 offset1:16
    v_cvt_pk_bf16_f32 v109, v110, v111
    v_cvt_pk_bf16_f32 v148, v148, v149
    v_cvt_pk_bf16_f32 v185, v186, v187
    v_cvt_pk_bf16_f32 v105, v106, v107
    v_mfma_f32_16x16x32_bf16 a[16:19], a[228:231], v[32:35], 0
    ds_write2st64_b64 v101, v[228:229], v[104:105] offset0:28 offset1:40
    v_mfma_f32_16x16x32_bf16 a[20:23], a[232:235], v[32:35], 0
    ds_read_b64_tr_b16 a[224:225], v3 offset:2048
    ds_write_b64 v101, v[108:109] offset:26624
    v_mfma_f32_16x16x32_bf16 v[228:231], a[232:235], v[26:29], 0
    ds_read_b128 v[84:87], v103 offset:1024
    v_accvgpr_read_b32 v110, a74
    v_accvgpr_read_b32 v111, a75
    v_exp_f32 v59, v59
    v_cvt_pk_bf16_f32 v189, v190, v191
    v_accvgpr_read_b32 v105, a25
    v_cvt_pk_bf16_f32 v157, v158, v159
    v_accvgpr_read_b32 v107, a27
    v_accvgpr_read_b32 v104, a24
    v_accvgpr_read_b32 v108, a72
    v_accvgpr_read_b32 v109, a73
    v_accvgpr_read_b32 v106, a26
    v_pk_mul_f32 v[108:109], v[108:109], v[100:101] op_sel_hi:[1,0]
    v_cvt_pk_bf16_f32 v201, v202, v203
    v_pk_mul_f32 v[254:255], v[254:255], v[50:51] op_sel_hi:[1,0]
    v_pk_mul_f32 v[104:105], v[104:105], v[8:9] op_sel_hi:[1,0]
    v_cvt_pk_bf16_f32 v193, v194, v195
    v_pk_mul_f32 v[106:107], v[106:107], v[8:9] op_sel_hi:[1,0]
    v_cvt_pk_bf16_f32 v104, v104, v105
    v_xor_b32 v101, 96, v101
    v_cvt_pk_bf16_f32 v105, v106, v107
    v_accvgpr_read_b32 v106, a30
    v_cvt_pk_bf16_f32 v233, v234, v235
    v_pk_mul_f32 v[110:111], v[110:111], v[100:101] op_sel_hi:[1,0]
    v_accvgpr_read_b32 v107, a31
    v_cvt_pk_bf16_f32 v108, v108, v109
    v_mfma_f32_16x16x32_bf16 v[180:183], a[232:235], v[20:23], 0
    s_add_u32 s20, s20, 12032
    ds_write2st64_b64 v101, v[136:137], v[184:185] offset0:4 offset1:16
    v_mfma_f32_16x16x32_bf16 v[132:135], a[232:235], v[14:17], 0
    s_waitcnt lgkmcnt(2)
    ds_write2st64_b64 v101, v[232:233], v[104:105] offset0:28 offset1:40
    v_cvt_pk_bf16_f32 v109, v110, v111
    v_mfma_f32_16x16x32_bf16 v[136:139], a[212:215], v[14:17], 0
    ds_write_b64 v101, v[108:109] offset:26624
    v_accvgpr_read_b32 v104, a28
    v_accvgpr_read_b32 v108, a76
    v_mfma_f32_16x16x32_bf16 v[184:187], a[212:215], v[20:23], 0
    ds_read_b64_tr_b16 a[232:233], v5 offset:2048
    ds_read_b64_tr_b16 a[230:231], v4 offset:8192
    v_xor_b32 v101, 32, v101
    v_exp_f32 v54, v54
    v_accvgpr_read_b32 v105, a29
    v_exp_f32 v70, v70
    v_cvt_pk_bf16_f32 v197, v198, v199
    v_exp_f32 v52, v52
    v_pk_mul_f32 v[106:107], v[106:107], v[8:9] op_sel_hi:[1,0]
    v_pk_mul_f32 v[104:105], v[104:105], v[8:9] op_sel_hi:[1,0]
    v_accvgpr_read_b32 v110, a78
    v_accvgpr_read_b32 v111, a79
    v_pk_mul_f32 v[204:205], v[204:205], v[102:103] op_sel_hi:[1,0]
    v_cvt_pk_bf16_f32 v245, v246, v247
    v_cvt_pk_bf16_f32 v104, v104, v105
    v_cvt_pk_bf16_f32 v105, v106, v107
    v_mfma_f32_16x16x32_bf16 v[232:235], a[212:215], v[26:29], 0
    ds_read_b64_tr_b16 a[228:229], v4 offset:2048
    ds_read_b64_tr_b16 a[226:227], v3 offset:8192
    v_accvgpr_read_b32 v109, a77
    v_mfma_f32_16x16x32_bf16 a[24:27], a[212:215], v[32:35], 0
    ds_write2st64_b64 v101, v[140:141], v[188:189] offset0:4 offset1:16
    ds_read_b64_tr_b16 a[220:221], v2 offset:2048
    v_mfma_f32_16x16x32_bf16 a[28:31], a[216:219], v[32:35], 0
    s_add_u32 s39, s39, 12288
    ds_read_b64_tr_b16 a[234:235], v5 offset:8192
    ds_write2st64_b64 v101, v[236:237], v[104:105] offset0:28 offset1:40
    v_accvgpr_read_b32 v104, a32
    v_pk_mul_f32 v[108:109], v[108:109], v[100:101] op_sel_hi:[1,0]
    v_pk_mul_f32 v[110:111], v[110:111], v[100:101] op_sel_hi:[1,0]
    v_cvt_pk_bf16_f32 v108, v108, v109
    v_cvt_pk_bf16_f32 v204, v204, v205
    v_accvgpr_read_b32 v105, a33
    v_accvgpr_read_b32 v107, a35
    v_cvt_pk_bf16_f32 v109, v110, v111
    v_mfma_f32_16x16x32_bf16 v[236:239], a[216:219], v[26:29], 0
    buffer_store_dwordx4 v[96:99], v6, s[16:19], s67 offen offset:0 nt
    ds_write_b64 v101, v[108:109] offset:26624
    v_cvt_pk_bf16_f32 v241, v242, v243
    v_accvgpr_read_b32 v106, a34
    v_xor_b32 v101, 96, v101
    v_pk_mul_f32 v[104:105], v[104:105], v[8:9] op_sel_hi:[1,0]
    v_cvt_pk_bf16_f32 v149, v150, v151
    v_accvgpr_read_b32 v110, a82
    v_cvt_pk_bf16_f32 v104, v104, v105
    v_fma_f32 v72, v72, s28, v11
    v_accvgpr_read_b32 v108, a80
    v_pk_mul_f32 v[106:107], v[106:107], v[8:9] op_sel_hi:[1,0]
    v_pk_mul_f32 v[206:207], v[206:207], v[102:103] op_sel_hi:[1,0]
    v_cvt_pk_bf16_f32 v105, v106, v107
    v_accvgpr_read_b32 v109, a81
    v_accvgpr_read_b32 v107, a39
    v_mfma_f32_16x16x32_bf16 v[188:191], a[216:219], v[20:23], 0
    s_waitcnt vmcnt(7) lgkmcnt(2)
    ds_write2st64_b64 v101, v[144:145], v[192:193] offset0:8 offset1:20
    v_mfma_f32_16x16x32_bf16 v[140:143], a[216:219], v[14:17], 0
    buffer_store_dwordx4 v[84:87], v7, s[16:19], s67 offen offset:0 nt
    s_barrier
    ds_write2st64_b64 v101, v[240:241], v[104:105] offset0:32 offset1:44
    v_cvt_pk_bf16_f32 v249, v250, v251
    v_accvgpr_read_b32 v111, a83
    v_pk_mul_f32 v[108:109], v[108:109], v[100:101] op_sel_hi:[1,0]
    v_accvgpr_read_b32 v104, a36
    v_pk_mul_f32 v[110:111], v[110:111], v[100:101] op_sel_hi:[1,0]
    v_cvt_pk_bf16_f32 v108, v108, v109
    v_cvt_pk_bf16_f32 v109, v110, v111
    v_accvgpr_read_b32 v111, a87
    v_exp_f32 v61, v61
    v_accvgpr_read_b32 v105, a37
    v_mfma_f32_16x16x32_bf16 v[144:147], a[220:223], v[14:17], 0
    ds_write_b64 v101, v[108:109] offset:0
    v_accvgpr_read_b32 v109, a85
    v_exp_f32 v72, v72
    v_accvgpr_read_b32 v110, a86
    v_pk_mul_f32 v[104:105], v[104:105], v[8:9] op_sel_hi:[1,0]
    v_accvgpr_read_b32 v108, a84
    v_accvgpr_read_b32 v106, a38
    v_pk_mul_f32 v[106:107], v[106:107], v[8:9] op_sel_hi:[1,0]
    v_xor_b32 v101, 32, v101
    v_cvt_pk_bf16_f32 v104, v104, v105
    v_exp_f32 v58, v58
    v_pk_mul_f32 v[110:111], v[110:111], v[100:101] op_sel_hi:[1,0]
    v_exp_f32 v62, v62
    v_cvt_pk_bf16_f32 v105, v106, v107
    v_cvt_pk_bf16_f32 v19, v54, v55
    v_accvgpr_read_b32 v106, a42
    v_mfma_f32_16x16x32_bf16 v[192:195], a[220:223], v[20:23], 0
    s_add_u32 m0, s22, 24576
    ds_write2st64_b64 v101, v[148:149], v[196:197] offset0:8 offset1:20
    v_mfma_f32_16x16x32_bf16 v[240:243], a[220:223], v[26:29], 0
    ds_write2st64_b64 v101, v[244:245], v[104:105] offset0:32 offset1:44
    v_pk_mul_f32 v[108:109], v[108:109], v[100:101] op_sel_hi:[1,0]
    v_accvgpr_read_b32 v107, a43
    v_cvt_pk_bf16_f32 v108, v108, v109
    v_mfma_f32_16x16x32_bf16 a[32:35], a[220:223], v[32:35], 0
    ds_read_b128 a[220:223], v0 offset:1024
    v_accvgpr_read_b32 v105, a41
    v_accvgpr_read_b32 v104, a40
    v_mfma_f32_16x16x32_bf16 a[36:39], a[224:227], v[32:35], 0
    ds_read_b128 a[212:215], v0 offset:0
    v_cvt_pk_bf16_f32 v37, v78, v79
    v_cvt_pk_bf16_f32 v109, v110, v111
    v_mfma_f32_16x16x32_bf16 v[244:247], a[224:227], v[26:29], 0
    ds_write_b64 v101, v[108:109] offset:0
    v_accvgpr_read_b32 v111, a91
    v_accvgpr_read_b32 v109, a89
    v_accvgpr_read_b32 v108, a88
    v_pk_mul_f32 v[108:109], v[108:109], v[100:101] op_sel_hi:[1,0]
    v_accvgpr_read_b32 v110, a90
    v_pk_mul_f32 v[110:111], v[110:111], v[100:101] op_sel_hi:[1,0]
    v_pk_mul_f32 v[106:107], v[106:107], v[8:9] op_sel_hi:[1,0]
    v_pk_mul_f32 v[104:105], v[104:105], v[8:9] op_sel_hi:[1,0]
    v_cvt_pk_bf16_f32 v253, v254, v255
    v_xor_b32 v101, 96, v101
    v_cvt_pk_bf16_f32 v104, v104, v105
    v_cvt_pk_bf16_f32 v18, v52, v53
    v_cvt_pk_bf16_f32 v108, v108, v109
    v_cvt_pk_bf16_f32 v105, v106, v107
    v_mfma_f32_16x16x32_bf16 v[196:199], a[224:227], v[20:23], 0
    ds_write2st64_b64 v101, v[152:153], v[200:201] offset0:8 offset1:20
    v_accvgpr_read_b32 v107, a47
    v_mfma_f32_16x16x32_bf16 v[148:151], a[224:227], v[14:17], 0
    ds_read_b128 a[216:219], v1 offset:0
    buffer_load_dwordx4 v6, s[8:11], s21 offen lds
    v_cvt_pk_bf16_f32 v109, v110, v111
    v_mfma_f32_16x16x32_bf16 v[152:155], a[228:231], v[14:17], 0
    s_add_u32 s21, s21, 128
    ds_write2st64_b64 v101, v[248:249], v[104:105] offset0:32 offset1:44
    v_mfma_f32_16x16x32_bf16 v[200:203], a[228:231], v[20:23], 0
    s_add_u32 m0, s22, 25600
    ds_read_b128 v[88:91], v103 offset:2048
    buffer_load_dwordx4 v6, s[8:11], s21 offen lds
    v_mfma_f32_16x16x32_bf16 v[248:251], a[228:231], v[26:29], 0
    s_add_u32 s21, s21, 128
    ds_write_b64 v101, v[108:109] offset:0
    v_xor_b32 v101, 32, v101
    v_cvt_pk_bf16_f32 v205, v206, v207
    v_accvgpr_read_b32 v105, a45
    v_accvgpr_read_b32 v106, a46
    v_mfma_f32_16x16x32_bf16 a[40:43], a[228:231], v[32:35], 0
    ds_write2st64_b64 v101, v[156:157], v[204:205] offset0:8 offset1:20
    v_accvgpr_read_b32 v104, a44
    v_pk_mul_f32 v[104:105], v[104:105], v[8:9] op_sel_hi:[1,0]
    v_pk_mul_f32 v[106:107], v[106:107], v[8:9] op_sel_hi:[1,0]
    v_cvt_pk_bf16_f32 v104, v104, v105
    v_cvt_pk_bf16_f32 v105, v106, v107
    v_mfma_f32_16x16x32_bf16 a[44:47], a[232:235], v[32:35], 0
    s_add_u32 m0, s22, 26624
    ds_write2st64_b64 v101, v[252:253], v[104:105] offset0:32 offset1:44
    v_mfma_f32_16x16x32_bf16 v[252:255], a[232:235], v[26:29], 0
    ds_read_b128 a[224:227], v1 offset:1024
    buffer_load_dwordx4 v6, s[8:11], s21 offen lds
    v_mfma_f32_16x16x32_bf16 v[204:207], a[232:235], v[20:23], 0
    s_add_u32 s21, s21, 12032
    ds_read_b128 v[96:99], v103 offset:3072
    v_accvgpr_read_b32 v108, a92
    v_accvgpr_read_b32 v109, a93
    v_mfma_f32_16x16x32_bf16 v[156:159], a[232:235], v[14:17], 0
    s_waitcnt lgkmcnt(5)
    ds_read_b128 a[228:231], v0 offset:2048
    v_cvt_pk_bf16_f32 v30, v68, v69
    v_mfma_f32_16x16x32_bf16 v[52:55], a[212:215], a[96:99], 0
    s_add_u32 s56, s67, 128
    v_exp_f32 v67, v67
    v_mfma_f32_16x16x32_bf16 v[52:55], a[216:219], a[100:103], v[52:55]
    buffer_store_dwordx4 v[88:91], v6, s[16:19], s56 offen offset:0 nt
    v_cvt_pk_bf16_f32 v28, v72, v73
    v_pk_mul_f32 v[108:109], v[108:109], v[100:101] op_sel_hi:[1,0]
    v_cvt_pk_bf16_f32 v24, v60, v61
    v_cvt_pk_bf16_f32 v31, v70, v71
    v_cvt_pk_bf16_f32 v25, v62, v63
    v_mfma_f32_16x16x32_bf16 v[52:55], a[220:223], a[104:107], v[52:55]
    s_add_u32 s58, s33, 128
    ds_read_b128 a[232:235], v1 offset:2048
    v_cvt_pk_bf16_f32 v36, v76, v77
    v_mfma_f32_16x16x32_bf16 v[60:63], a[220:223], a[128:131], 0
    ds_read_b128 v[84:87], v103 offset:4096
    v_mfma_f32_16x16x32_bf16 v[60:63], a[216:219], a[124:127], v[60:63]
    v_exp_f32 v74, v74
    v_mfma_f32_16x16x32_bf16 v[60:63], a[212:215], a[120:123], v[60:63]
    v_exp_f32 v65, v65
    v_mfma_f32_16x16x32_bf16 v[68:71], a[212:215], a[144:147], 0
    v_exp_f32 v75, v75
    v_mfma_f32_16x16x32_bf16 v[68:71], a[216:219], a[148:151], v[68:71]
    v_exp_f32 v56, v56
    v_mfma_f32_16x16x32_bf16 v[68:71], a[220:223], a[152:155], v[68:71]
    s_add_u32 m0, s38, 2048
    v_exp_f32 v81, v81
    v_mfma_f32_16x16x32_bf16 v[76:79], a[220:223], a[176:179], 0
    buffer_load_dwordx4 v6, s[12:15], s58 offen nt lds
    v_mfma_f32_16x16x32_bf16 v[76:79], a[216:219], a[172:175], v[76:79]
    v_cvt_pk_bf16_f32 v17, v58, v59
    v_accvgpr_read_b32 v111, a95
    v_mfma_f32_16x16x32_bf16 v[76:79], a[212:215], a[168:171], v[76:79]
    s_waitcnt lgkmcnt(2)
    v_exp_f32 v64, v64
    v_mfma_f32_16x16x32_bf16 v[76:79], a[224:227], a[180:183], v[76:79]
    s_add_u32 m0, s38, 3072
    v_exp_f32 v66, v66
    v_mfma_f32_16x16x32_bf16 v[76:79], a[228:231], a[184:187], v[76:79]
    s_waitcnt lgkmcnt(0)
    ds_read_b128 a[220:223], v0 offset:7168
    v_cvt_pk_bf16_f32 v108, v108, v109
    v_mfma_f32_16x16x32_bf16 v[76:79], a[232:235], a[188:191], v[76:79]
    buffer_load_dwordx4 v7, s[12:15], s58 offen nt lds
    v_mfma_f32_16x16x32_bf16 v[68:71], a[232:235], a[164:167], v[68:71]
    ds_read_b128 v[88:91], v103 offset:5120
    v_cvt_pk_bf16_f32 v29, v74, v75
    v_mfma_f32_16x16x32_bf16 v[68:71], a[228:231], a[160:163], v[68:71]
    v_accvgpr_read_b32 v110, a94
    v_cvt_pk_bf16_f32 v23, v66, v67
    v_mfma_f32_16x16x32_bf16 v[68:71], a[224:227], a[156:159], v[68:71]
    buffer_store_dwordx4 v[96:99], v7, s[16:19], s56 offen offset:0 nt
    s_add_u32 s57, s67, 256
    ds_read_b128 a[216:219], v1 offset:6144
    v_pk_mul_f32 v[110:111], v[110:111], v[100:101] op_sel_hi:[1,0]
    v_cvt_pk_bf16_f32 v22, v64, v65
    v_cvt_pk_bf16_f32 v109, v110, v111
    v_mfma_f32_16x16x32_bf16 v[60:63], a[224:227], a[132:135], v[60:63]
    s_add_u32 s59, s33, 256
    ds_read_b128 a[212:215], v0 offset:6144
    v_cvt_pk_bf16_f32 v16, v56, v57
    v_mfma_f32_16x16x32_bf16 v[60:63], a[228:231], a[136:139], v[60:63]
    v_exp_f32 v82, v82
    v_mfma_f32_16x16x32_bf16 v[60:63], a[232:235], a[140:143], v[60:63]
    buffer_store_dwordx4 v[84:87], v6, s[16:19], s57 offen offset:0 nt
    s_add_u32 m0, s38, 4096
    ds_write_b64 v101, v[108:109] offset:0
    v_mfma_f32_16x16x32_bf16 v[52:55], a[232:235], a[116:119], v[52:55]
    v_exp_f32 v83, v83
    v_mfma_f32_16x16x32_bf16 v[48:51], a[236:239], v[16:19], v[44:47]
    buffer_load_dwordx4 v6, s[12:15], s59 offen nt lds
    v_mfma_f32_16x16x32_bf16 v[48:51], a[240:243], v[22:25], v[48:51]
    ds_read_b128 v[96:99], v103 offset:0
    v_mfma_f32_16x16x32_bf16 v[52:55], a[228:231], a[112:115], v[52:55]
    ds_read_b128 v[84:87], v103 offset:1024
    v_cvt_pk_bf16_f32 v34, v80, v81
    v_mfma_f32_16x16x32_bf16 v[48:51], a[244:247], v[28:31], v[48:51]
    ds_read_b128 a[228:231], v0 offset:8192
    v_cvt_pk_bf16_f32 v35, v82, v83
    v_mfma_f32_16x16x32_bf16 v[52:55], a[224:227], a[108:111], v[52:55]
    ds_read_b128 a[224:227], v1 offset:7168
    s_waitcnt lgkmcnt(5)
    v_mfma_f32_16x16x32_bf16 v[56:59], a[212:215], a[96:99], 0
    ds_read_b128 a[232:235], v1 offset:8192
    v_mfma_f32_16x16x32_bf16 v[48:51], a[248:251], v[34:37], v[48:51]
    buffer_store_dwordx4 v[88:91], v7, s[16:19], s57 offen offset:0 nt
    v_add_u32 v103, 6144, v103
    s_add_u32 m0, s38, 5120
    v_mfma_f32_16x16x32_bf16 v[56:59], a[216:219], a[100:103], v[56:59]
    v_mfma_f32_16x16x32_bf16 v[56:59], a[220:223], a[104:107], v[56:59]
    buffer_load_dwordx4 v7, s[12:15], s59 offen nt lds
    v_mfma_f32_16x16x32_bf16 v[64:67], a[220:223], a[128:131], 0
    s_add_u32 s56, s67, 24832
    s_add_u32 m0, s38, 0
    v_cmp_lt_f32 vcc, s29, v48
    v_mfma_f32_16x16x32_bf16 v[64:67], a[216:219], a[124:127], v[64:67]
    v_mfma_f32_16x16x32_bf16 v[64:67], a[212:215], a[120:123], v[64:67]
    s_waitcnt lgkmcnt(3)
    buffer_load_dwordx4 v6, s[12:15], s33 offen nt lds
    v_mfma_f32_16x16x32_bf16 v[72:75], a[212:215], a[144:147], 0
    s_add_u32 m0, s38, 1024
    s_cbranch_vccnz L_rs_tr54d
L_ret_tr54d:
    v_mfma_f32_16x16x32_bf16 v[72:75], a[216:219], a[148:151], v[72:75]
    buffer_load_dwordx4 v7, s[12:15], s33 offen nt lds
    v_mfma_f32_16x16x32_bf16 v[72:75], a[220:223], a[152:155], v[72:75]
    s_waitcnt vmcnt(18) lgkmcnt(0)
    v_fma_f32 v53, v53, s28, v9
    v_fma_f32 v61, v61, s28, v10
    v_mfma_f32_16x16x32_bf16 v[80:83], a[220:223], a[176:179], 0
    buffer_store_dwordx4 v[96:99], v6, s[16:19], s56 offen offset:0 nt
    s_barrier
    v_fma_f32 v52, v52, s28, v9
    v_fma_f32 v55, v55, s28, v9
    v_mfma_f32_16x16x32_bf16 v[80:83], a[216:219], a[172:175], v[80:83]
    v_exp_f32 v61, v61
    v_fma_f32 v60, v60, s28, v10
    v_mfma_f32_16x16x32_bf16 v[80:83], a[212:215], a[168:171], v[80:83]
    s_add_u32 m0, s22, 0
    ds_read_b64_tr_b16 a[212:213], v2 offset:18432
    v_fma_f32 v54, v54, s28, v9
    v_mfma_f32_16x16x32_bf16 v[80:83], a[224:227], a[180:183], v[80:83]
    v_exp_f32 v55, v55
    v_mfma_f32_16x16x32_bf16 v[80:83], a[228:231], a[184:187], v[80:83]
    ds_read_b64_tr_b16 a[214:215], v2 offset:12288
    buffer_load_dwordx4 v6, s[4:7], s20 offen lds
    v_mfma_f32_16x16x32_bf16 v[80:83], a[232:235], a[188:191], v[80:83]
    s_add_u32 s20, s20, 128
    v_exp_f32 v54, v54
    v_mfma_f32_16x16x32_bf16 v[72:75], a[232:235], a[164:167], v[72:75]
    s_add_u32 m0, s22, 1024
    ds_read_b64_tr_b16 a[216:217], v3 offset:18432
    v_cvt_pk_bf16_f32 v15, v54, v55
    v_mfma_f32_16x16x32_bf16 v[72:75], a[228:231], a[160:163], v[72:75]
    v_exp_f32 v53, v53
    v_mfma_f32_16x16x32_bf16 v[72:75], a[224:227], a[156:159], v[72:75]
    buffer_load_dwordx4 v6, s[4:7], s20 offen lds
    v_mfma_f32_16x16x32_bf16 v[64:67], a[224:227], a[132:135], v[64:67]
    s_add_u32 s20, s20, 128
    v_exp_f32 v60, v60
    v_mfma_f32_16x16x32_bf16 v[64:67], a[228:231], a[136:139], v[64:67]
    s_add_u32 m0, s22, 2048
    v_exp_f32 v52, v52
    v_mfma_f32_16x16x32_bf16 v[64:67], a[232:235], a[140:143], v[64:67]
    ds_read_b64_tr_b16 a[218:219], v3 offset:12288
    v_cvt_pk_bf16_f32 v14, v52, v53
    v_mfma_f32_16x16x32_bf16 v[56:59], a[232:235], a[116:119], v[56:59]
    buffer_load_dwordx4 v6, s[4:7], s20 offen lds
    ds_read_b64_tr_b16 a[220:221], v4 offset:18432
    v_mfma_f32_16x16x32_bf16 v[56:59], a[228:231], a[112:115], v[56:59]
    s_add_u32 s20, s20, 12032
    ds_read_b64_tr_b16 a[222:223], v4 offset:12288
    v_cvt_pk_bf16_f32 v20, v60, v61
    v_mfma_f32_16x16x32_bf16 v[56:59], a[224:227], a[108:111], v[56:59]
    s_waitcnt lgkmcnt(4)
    ds_read_b64_tr_b16 a[224:225], v5 offset:18432
    ds_read_b64_tr_b16 a[226:227], v5 offset:12288
    buffer_store_dwordx4 v[84:87], v7, s[16:19], s56 offen offset:0 nt
    s_branch L_loop4w0
L_tr55:
    v_mfma_f32_16x16x32_bf16 v[112:115], a[212:215], v[16:19], v[112:115]
    s_add_u32 s39, s39, 12288
    s_add_u32 s48, s33, 24576
    v_mfma_f32_16x16x32_bf16 v[116:119], a[216:219], v[16:19], v[116:119]
    ds_read_b64_tr_b16 a[230:231], v2 offset:13312
    v_fma_f32 v58, v58, s28, v9
    v_mfma_f32_16x16x32_bf16 v[164:167], a[216:219], v[22:25], v[164:167]
    ds_read_b64_tr_b16 a[232:233], v3 offset:19456
    v_mbcnt_lo_u32_b32 v97, -1, 0
    v_mfma_f32_16x16x32_bf16 v[160:163], a[212:215], v[22:25], v[160:163]
    ds_read_b64_tr_b16 a[228:229], v2 offset:19456
    v_fma_f32 v87, v87, s28, v13
    v_mfma_f32_16x16x32_bf16 v[208:211], a[212:215], v[28:31], v[208:211]
    v_fma_f32 v73, v73, s28, v11
    v_fma_f32 v81, v81, s28, v12
    v_mfma_f32_16x16x32_bf16 v[212:215], a[216:219], v[28:31], v[212:215]
    ds_read_b64_tr_b16 a[234:235], v3 offset:13312
    v_mbcnt_hi_u32_b32 v97, -1, v97
    v_mfma_f32_16x16x32_bf16 a[4:7], a[216:219], v[34:37], a[4:7]
    v_fma_f32 v66, v66, s28, v10
    v_and_b32 v96, 15, v97
    v_mfma_f32_16x16x32_bf16 a[0:3], a[212:215], v[34:37], a[0:3]
    v_mul_u32_u24 v96, 384, v96
    v_fma_f32 v82, v82, s28, v12
    v_mfma_f32_16x16x32_bf16 a[48:51], a[212:215], v[40:43], a[48:51]
    v_fma_f32 v86, v86, s28, v13
    v_fma_f32 v76, v76, s28, v12
    v_mfma_f32_16x16x32_bf16 a[52:55], a[216:219], v[40:43], a[52:55]
    s_waitcnt lgkmcnt(4)
    ds_read_b64_tr_b16 a[218:219], v5 offset:13312
    v_fma_f32 v59, v59, s28, v9
    v_mfma_f32_16x16x32_bf16 a[56:59], a[220:223], v[40:43], a[56:59]
    v_fma_f32 v88, v88, s28, v13
    v_fma_f32 v65, v65, s28, v10
    v_mfma_f32_16x16x32_bf16 a[60:63], a[224:227], v[40:43], a[60:63]
    v_lshrrev_b32 v97, 4, v97
    v_lshl_add_u32 v96, v97, 4, v96
    v_mfma_f32_16x16x32_bf16 a[12:15], a[224:227], v[34:37], a[12:15]
    ds_read_b64_tr_b16 a[212:213], v4 offset:19456
    v_fma_f32 v74, v74, s28, v11
    v_mfma_f32_16x16x32_bf16 a[8:11], a[220:223], v[34:37], a[8:11]
    buffer_load_dword v97, v96, s[12:15], s48 offen offset:256
    v_mfma_f32_16x16x32_bf16 v[216:219], a[220:223], v[28:31], v[216:219]
    v_fma_f32 v72, v72, s28, v11
    v_fma_f32 v78, v78, s28, v12
    v_mfma_f32_16x16x32_bf16 v[220:223], a[224:227], v[28:31], v[220:223]
    ds_read_b64_tr_b16 a[214:215], v4 offset:13312
    v_fma_f32 v85, v85, s28, v13
    v_mfma_f32_16x16x32_bf16 v[172:175], a[224:227], v[22:25], v[172:175]
    ds_read_b64_tr_b16 a[216:217], v5 offset:19456
    v_fma_f32 v84, v84, s28, v13
    v_mfma_f32_16x16x32_bf16 v[168:171], a[220:223], v[22:25], v[168:171]
    v_fma_f32 v68, v68, s28, v11
    v_fma_f32 v77, v77, s28, v12
    v_mfma_f32_16x16x32_bf16 v[120:123], a[220:223], v[16:19], v[120:123]
    v_exp_f32 v82, v82
    v_mfma_f32_16x16x32_bf16 v[124:127], a[224:227], v[16:19], v[124:127]
    s_waitcnt lgkmcnt(3)
    v_fma_f32 v57, v57, s28, v9
    v_mfma_f32_16x16x32_bf16 v[128:131], a[228:231], v[16:19], v[128:131]
    v_exp_f32 v78, v78
    v_mfma_f32_16x16x32_bf16 v[132:135], a[232:235], v[16:19], v[132:135]
    ds_read_b64_tr_b16 a[224:225], v3 offset:20480
    v_fma_f32 v71, v71, s28, v11
    v_mfma_f32_16x16x32_bf16 v[180:183], a[232:235], v[22:25], v[180:183]
    ds_read_b64_tr_b16 a[222:223], v2 offset:14336
    v_fma_f32 v79, v79, s28, v12
    v_mfma_f32_16x16x32_bf16 v[176:179], a[228:231], v[22:25], v[176:179]
    v_fma_f32 v67, v67, s28, v10
    v_fma_f32 v70, v70, s28, v11
    v_mfma_f32_16x16x32_bf16 v[224:227], a[228:231], v[28:31], v[224:227]
    v_fma_f32 v75, v75, s28, v11
    v_fma_f32 v90, v90, s28, v13
    v_mfma_f32_16x16x32_bf16 v[228:231], a[232:235], v[28:31], v[228:231]
    ds_read_b64_tr_b16 a[226:227], v3 offset:14336
    v_mfma_f32_16x16x32_bf16 a[20:23], a[232:235], v[34:37], a[20:23]
    v_exp_f32 v75, v75
    v_mfma_f32_16x16x32_bf16 a[16:19], a[228:231], v[34:37], a[16:19]
    v_exp_f32 v85, v85
    v_mfma_f32_16x16x32_bf16 a[64:67], a[228:231], v[40:43], a[64:67]
    v_exp_f32 v68, v68
    v_mfma_f32_16x16x32_bf16 a[68:71], a[232:235], v[40:43], a[68:71]
    s_waitcnt lgkmcnt(3)
    ds_read_b64_tr_b16 a[220:221], v2 offset:20480
    v_fma_f32 v83, v83, s28, v12
    v_mfma_f32_16x16x32_bf16 a[72:75], a[212:215], v[40:43], a[72:75]
    v_exp_f32 v84, v84
    v_mfma_f32_16x16x32_bf16 a[76:79], a[216:219], v[40:43], a[76:79]
    ds_read_b64_tr_b16 a[232:233], v5 offset:20480
    v_mfma_f32_16x16x32_bf16 a[28:31], a[216:219], v[34:37], a[28:31]
    v_exp_f32 v59, v59
    v_mfma_f32_16x16x32_bf16 a[24:27], a[212:215], v[34:37], a[24:27]
    v_exp_f32 v71, v71
    v_mfma_f32_16x16x32_bf16 v[232:235], a[212:215], v[28:31], v[232:235]
    v_exp_f32 v70, v70
    v_mfma_f32_16x16x32_bf16 v[236:239], a[216:219], v[28:31], v[236:239]
    ds_read_b64_tr_b16 a[228:229], v4 offset:20480
    v_mfma_f32_16x16x32_bf16 v[188:191], a[216:219], v[22:25], v[188:191]
    ds_read_b64_tr_b16 a[230:231], v4 offset:14336
    v_fma_f32 v56, v56, s28, v9
    v_mfma_f32_16x16x32_bf16 v[184:187], a[212:215], v[22:25], v[184:187]
    v_exp_f32 v56, v56
    v_mfma_f32_16x16x32_bf16 v[136:139], a[212:215], v[16:19], v[136:139]
    ds_read_b64_tr_b16 a[234:235], v5 offset:14336
    v_fma_f32 v89, v89, s28, v13
    v_mfma_f32_16x16x32_bf16 v[140:143], a[216:219], v[16:19], v[140:143]
    s_waitcnt lgkmcnt(4)
    v_exp_f32 v67, v67
    v_mfma_f32_16x16x32_bf16 v[144:147], a[220:223], v[16:19], v[144:147]
    v_exp_f32 v86, v86
    v_mfma_f32_16x16x32_bf16 v[148:151], a[224:227], v[16:19], v[148:151]
    v_exp_f32 v88, v88
    v_mfma_f32_16x16x32_bf16 v[196:199], a[224:227], v[22:25], v[196:199]
    v_exp_f32 v77, v77
    v_mfma_f32_16x16x32_bf16 v[192:195], a[220:223], v[22:25], v[192:195]
    v_exp_f32 v87, v87
    v_mfma_f32_16x16x32_bf16 v[240:243], a[220:223], v[28:31], v[240:243]
    v_exp_f32 v79, v79
    v_mfma_f32_16x16x32_bf16 v[244:247], a[224:227], v[28:31], v[244:247]
    v_fma_f32 v69, v69, s28, v11
    v_cvt_pk_bf16_f32 v39, v86, v87
    v_mfma_f32_16x16x32_bf16 a[36:39], a[224:227], v[34:37], a[36:39]
    v_exp_f32 v76, v76
    v_mfma_f32_16x16x32_bf16 a[32:35], a[220:223], v[34:37], a[32:35]
    v_exp_f32 v57, v57
    v_mfma_f32_16x16x32_bf16 a[80:83], a[220:223], v[40:43], a[80:83]
    s_waitcnt vmcnt(11) lgkmcnt(0)
    v_cvt_pk_bf16_f32 v33, v78, v79
    v_cvt_pk_bf16_f32 v32, v76, v77
    v_mfma_f32_16x16x32_bf16 a[84:87], a[224:227], v[40:43], a[84:87]
    s_barrier
    v_mfma_f32_16x16x32_bf16 a[88:91], a[228:231], v[40:43], a[88:91]
    ds_read_b128 a[212:215], v0 offset:12288
    s_add_u32 m0, s22, 36864
    v_mfma_f32_16x16x32_bf16 a[92:95], a[232:235], v[40:43], a[92:95]
    buffer_load_dwordx4 v6, s[8:11], s21 offen lds
    v_mfma_f32_16x16x32_bf16 a[44:47], a[232:235], v[34:37], a[44:47]
    ds_read_b128 a[220:223], v0 offset:13312
    v_fma_f32 v91, v91, s28, v13
    v_mfma_f32_16x16x32_bf16 a[40:43], a[228:231], v[34:37], a[40:43]
    s_add_u32 s21, s21, 128
    ds_read_b128 a[216:219], v1 offset:12288
    v_cvt_pk_bf16_f32 v38, v84, v85
    v_mfma_f32_16x16x32_bf16 v[248:251], a[228:231], v[28:31], v[248:251]
    s_add_u32 m0, s22, 37888
    v_exp_f32 v74, v74
    v_mfma_f32_16x16x32_bf16 v[252:255], a[232:235], v[28:31], v[252:255]
    buffer_load_dwordx4 v6, s[8:11], s21 offen lds
    v_mfma_f32_16x16x32_bf16 v[204:207], a[232:235], v[22:25], v[204:207]
    s_add_u32 s21, s21, 128
    v_exp_f32 v69, v69
    v_mfma_f32_16x16x32_bf16 v[200:203], a[228:231], v[22:25], v[200:203]
    v_cvt_pk_bf16_f32 v26, v68, v69
    s_add_u32 m0, s22, 38912
    v_mfma_f32_16x16x32_bf16 v[152:155], a[228:231], v[16:19], v[152:155]
    buffer_load_dwordx4 v6, s[8:11], s21 offen lds
    v_mfma_f32_16x16x32_bf16 v[156:159], a[232:235], v[16:19], v[156:159]
    s_waitcnt lgkmcnt(2)
    v_mfma_f32_16x16x32_bf16 v[52:55], a[212:215], a[96:99], 0
    v_cvt_pk_bf16_f32 v29, v74, v75
    v_mfma_f32_16x16x32_bf16 v[60:63], a[212:215], a[120:123], 0
    ds_read_b128 a[228:231], v0 offset:14336
    v_cvt_pk_bf16_f32 v27, v70, v71
    v_mfma_f32_16x16x32_bf16 v[68:71], a[212:215], a[144:147], 0
    ds_read_b128 a[224:227], v1 offset:13312
    v_mfma_f32_16x16x32_bf16 v[76:79], a[212:215], a[168:171], 0
    v_exp_f32 v90, v90
    v_mfma_f32_16x16x32_bf16 v[84:87], a[212:215], a[192:195], 0
    s_waitcnt lgkmcnt(2)
    v_exp_f32 v66, v66
    v_mfma_f32_16x16x32_bf16 v[52:55], a[216:219], a[100:103], v[52:55]
    v_mfma_f32_16x16x32_bf16 v[60:63], a[216:219], a[124:127], v[60:63]
    v_exp_f32 v89, v89
    v_mfma_f32_16x16x32_bf16 v[68:71], a[216:219], a[148:151], v[68:71]
    v_exp_f32 v65, v65
    v_mfma_f32_16x16x32_bf16 v[76:79], a[216:219], a[172:175], v[76:79]
    v_exp_f32 v91, v91
    v_mfma_f32_16x16x32_bf16 v[84:87], a[216:219], a[196:199], v[84:87]
    v_cvt_pk_bf16_f32 v23, v66, v67
    v_cvt_pk_bf16_f32 v40, v88, v89
    v_mfma_f32_16x16x32_bf16 v[52:55], a[220:223], a[104:107], v[52:55]
    v_exp_f32 v58, v58
    v_mfma_f32_16x16x32_bf16 v[60:63], a[220:223], a[128:131], v[60:63]
    v_exp_f32 v81, v81
    v_mfma_f32_16x16x32_bf16 v[68:71], a[220:223], a[152:155], v[68:71]
    s_add_u32 s21, s21, 12032
    ds_read_b128 a[232:235], v1 offset:14336
    v_cvt_pk_bf16_f32 v17, v58, v59
    v_mfma_f32_16x16x32_bf16 v[76:79], a[220:223], a[176:179], v[76:79]
    v_fma_f32 v80, v80, s28, v12
    v_mfma_f32_16x16x32_bf16 v[84:87], a[220:223], a[200:203], v[84:87]
    s_waitcnt lgkmcnt(1)
    v_exp_f32 v83, v83
    v_mfma_f32_16x16x32_bf16 v[52:55], a[224:227], a[108:111], v[52:55]
    v_exp_f32 v72, v72
    v_mfma_f32_16x16x32_bf16 v[60:63], a[224:227], a[132:135], v[60:63]
    v_cvt_pk_bf16_f32 v16, v56, v57
    v_fma_f32 v64, v64, s28, v10
    v_mfma_f32_16x16x32_bf16 v[68:71], a[224:227], a[156:159], v[68:71]
    v_exp_f32 v73, v73
    v_mfma_f32_16x16x32_bf16 v[76:79], a[224:227], a[180:183], v[76:79]
    v_exp_f32 v80, v80
    v_mfma_f32_16x16x32_bf16 v[84:87], a[224:227], a[204:207], v[84:87]
    v_exp_f32 v64, v64
    v_mfma_f32_16x16x32_bf16 v[52:55], a[228:231], a[112:115], v[52:55]
    v_cvt_pk_bf16_f32 v34, v80, v81
    v_cvt_pk_bf16_f32 v28, v72, v73
    v_mfma_f32_16x16x32_bf16 v[44:47], a[236:239], v[14:17], v[48:51]
    v_mfma_f32_16x16x32_bf16 v[60:63], a[228:231], a[136:139], v[60:63]
    v_cvt_pk_bf16_f32 v35, v82, v83
    v_cvt_pk_bf16_f32 v22, v64, v65
    v_mfma_f32_16x16x32_bf16 v[68:71], a[228:231], a[160:163], v[68:71]
    ds_read_b128 a[212:215], v0 offset:20480
    v_cvt_pk_bf16_f32 v41, v90, v91
    v_mfma_f32_16x16x32_bf16 v[44:47], a[240:243], v[20:23], v[44:47]
    v_mfma_f32_16x16x32_bf16 v[76:79], a[228:231], a[184:187], v[76:79]
    ds_read_b128 a[224:227], v1 offset:18432
    v_mfma_f32_16x16x32_bf16 v[84:87], a[228:231], a[208:211], v[84:87]
    ds_read_b128 a[216:219], v1 offset:20480
    v_mfma_f32_16x16x32_bf16 v[44:47], a[244:247], v[26:29], v[44:47]
    v_mfma_f32_16x16x32_bf16 v[44:47], a[248:251], v[32:35], v[44:47]
    v_mfma_f32_16x16x32_bf16 v[44:47], a[252:255], v[38:41], v[44:47]
    s_waitcnt lgkmcnt(3)
    v_mfma_f32_16x16x32_bf16 v[52:55], a[232:235], a[116:119], v[52:55]
    ds_read_b128 a[220:223], v0 offset:18432
    v_mfma_f32_16x16x32_bf16 v[60:63], a[232:235], a[140:143], v[60:63]
    ds_read_b128 a[228:231], v0 offset:19456
    v_mfma_f32_16x16x32_bf16 v[68:71], a[232:235], a[164:167], v[68:71]
    s_nop 1
    v_cmp_lt_f32 vcc, s29, v44
    v_mfma_f32_16x16x32_bf16 v[76:79], a[232:235], a[188:191], v[76:79]
    v_mfma_f32_16x16x32_bf16 v[84:87], a[232:235], v[92:95], v[84:87]
    s_waitcnt lgkmcnt(4)
    ds_read_b128 a[232:235], v1 offset:19456
    v_mfma_f32_16x16x32_bf16 v[56:59], a[212:215], a[112:115], 0
    s_cbranch_vccnz L_rs_tr55a
L_ret_tr55a:
    v_mfma_f32_16x16x32_bf16 v[64:67], a[212:215], a[136:139], 0
    v_fma_f32 v53, v53, s28, v9
    v_mfma_f32_16x16x32_bf16 v[72:75], a[212:215], a[160:163], 0
    v_fma_f32 v55, v55, s28, v9
    v_fma_f32 v61, v61, s28, v10
    v_mfma_f32_16x16x32_bf16 v[80:83], a[212:215], a[184:187], 0
    v_fma_f32 v62, v62, s28, v10
    v_fma_f32 v63, v63, s28, v10
    v_mfma_f32_16x16x32_bf16 v[88:91], a[212:215], a[208:211], 0
    s_waitcnt lgkmcnt(3)
    v_exp_f32 v53, v53
    v_mfma_f32_16x16x32_bf16 v[56:59], a[216:219], a[116:119], v[56:59]
    v_exp_f32 v63, v63
    v_mfma_f32_16x16x32_bf16 v[64:67], a[216:219], a[140:143], v[64:67]
    v_exp_f32 v55, v55
    v_mfma_f32_16x16x32_bf16 v[72:75], a[216:219], a[164:167], v[72:75]
    v_mfma_f32_16x16x32_bf16 v[80:83], a[216:219], a[188:191], v[80:83]
    s_waitcnt vmcnt(7) lgkmcnt(0)
    v_mfma_f32_16x16x32_bf16 v[88:91], a[216:219], v[92:95], v[88:91]
    s_barrier
    v_mfma_f32_16x16x32_bf16 v[56:59], a[220:223], a[96:99], v[56:59]
    s_add_u32 m0, s22, 12288
    v_exp_f32 v62, v62
    v_mfma_f32_16x16x32_bf16 v[64:67], a[220:223], a[120:123], v[64:67]
    buffer_load_dwordx4 v6, s[4:7], s20 offen lds
    v_mfma_f32_16x16x32_bf16 v[72:75], a[220:223], a[144:147], v[72:75]
    ds_read_b64_tr_b16 a[212:213], v2 offset:0
    v_fma_f32 v52, v52, s28, v9
    v_mfma_f32_16x16x32_bf16 v[80:83], a[220:223], a[168:171], v[80:83]
    s_add_u32 s20, s20, 128
    s_add_u32 m0, s22, 13312
    v_fma_f32 v54, v54, s28, v9
    v_mfma_f32_16x16x32_bf16 v[88:91], a[220:223], a[192:195], v[88:91]
    buffer_load_dwordx4 v6, s[4:7], s20 offen lds
    v_mfma_f32_16x16x32_bf16 v[56:59], a[224:227], a[100:103], v[56:59]
    s_add_u32 s20, s20, 128
    ds_read_b64_tr_b16 a[214:215], v2 offset:6144
    v_fma_f32 v60, v60, s28, v10
    v_mfma_f32_16x16x32_bf16 v[64:67], a[224:227], a[124:127], v[64:67]
    v_exp_f32 v61, v61
    v_mfma_f32_16x16x32_bf16 v[72:75], a[224:227], a[148:151], v[72:75]
    v_exp_f32 v54, v54
    v_mfma_f32_16x16x32_bf16 v[80:83], a[224:227], a[172:175], v[80:83]
    ds_read_b64_tr_b16 a[216:217], v3 offset:0
    s_add_u32 m0, s22, 14336
    v_mfma_f32_16x16x32_bf16 v[88:91], a[224:227], a[196:199], v[88:91]
    ds_read_b64_tr_b16 a[218:219], v3 offset:6144
    v_mfma_f32_16x16x32_bf16 v[56:59], a[228:231], a[104:107], v[56:59]
    buffer_load_dwordx4 v6, s[4:7], s20 offen lds
    v_mfma_f32_16x16x32_bf16 v[64:67], a[228:231], a[128:131], v[64:67]
    v_exp_f32 v52, v52
    v_mfma_f32_16x16x32_bf16 v[72:75], a[228:231], a[152:155], v[72:75]
    ds_read_b64_tr_b16 a[220:221], v4 offset:0
    v_cvt_pk_bf16_f32 v19, v54, v55
    v_mfma_f32_16x16x32_bf16 v[80:83], a[228:231], a[176:179], v[80:83]
    v_exp_f32 v60, v60
    v_mfma_f32_16x16x32_bf16 v[88:91], a[228:231], a[200:203], v[88:91]
    s_add_u32 s20, s20, 12032
    v_cvt_pk_bf16_f32 v25, v62, v63
    v_mfma_f32_16x16x32_bf16 v[56:59], a[232:235], a[108:111], v[56:59]
    ds_read_b64_tr_b16 a[222:223], v4 offset:6144
    v_cvt_pk_bf16_f32 v18, v52, v53
    v_mfma_f32_16x16x32_bf16 v[64:67], a[232:235], a[132:135], v[64:67]
    buffer_load_dwordx4 a[208:211], v96, s[12:15], s48 offen offset:256 nt
    v_mfma_f32_16x16x32_bf16 v[72:75], a[232:235], a[156:159], v[72:75]
    buffer_load_dwordx4 v[92:95], v96, s[12:15], s48 offen offset:320 nt
    v_mfma_f32_16x16x32_bf16 v[80:83], a[232:235], a[180:183], v[80:83]
    ds_read_b64_tr_b16 a[224:225], v5 offset:0
    v_mfma_f32_16x16x32_bf16 v[88:91], a[232:235], a[204:207], v[88:91]
    s_waitcnt lgkmcnt(3)
    ds_read_b64_tr_b16 a[226:227], v5 offset:6144
    v_cvt_pk_bf16_f32 v24, v60, v61
    v_mfma_f32_16x16x32_bf16 v[112:115], a[212:215], v[14:17], v[112:115]
    v_lshrrev_b32 v105, 11, v0
    v_fma_f32 v69, v69, s28, v11
    v_mfma_f32_16x16x32_bf16 v[116:119], a[216:219], v[14:17], v[116:119]
    ds_read_b64_tr_b16 a[234:235], v3 offset:7168
    v_fma_f32 v66, v66, s28, v10
    v_mfma_f32_16x16x32_bf16 v[164:167], a[216:219], v[20:23], v[164:167]
    ds_read_b64_tr_b16 a[230:231], v2 offset:7168
    v_xor_b32 v105, s65, v105
    v_mfma_f32_16x16x32_bf16 v[160:163], a[212:215], v[20:23], v[160:163]
    v_fma_f32 v77, v77, s28, v12
    v_and_b32 v104, 0x3ff, v0
    v_mfma_f32_16x16x32_bf16 v[208:211], a[212:215], v[26:29], v[208:211]
    ds_read_b64_tr_b16 a[232:233], v3 offset:1024
    v_fma_f32 v86, v86, s28, v13
    v_mfma_f32_16x16x32_bf16 v[212:215], a[216:219], v[26:29], v[212:215]
    ds_read_b64_tr_b16 a[228:229], v2 offset:1024
    v_fma_f32 v90, v90, s28, v13
    v_mfma_f32_16x16x32_bf16 a[4:7], a[216:219], v[32:35], a[4:7]
    v_lshl_add_u32 v104, v105, 10, v104
    v_fma_f32 v79, v79, s28, v12
    v_mfma_f32_16x16x32_bf16 a[0:3], a[212:215], v[32:35], a[0:3]
    v_fma_f32 v91, v91, s28, v13
    v_fma_f32 v83, v83, s28, v12
    v_mfma_f32_16x16x32_bf16 a[48:51], a[212:215], v[38:41], a[48:51]
    v_exp_f32 v86, v86
    v_mfma_f32_16x16x32_bf16 a[52:55], a[216:219], v[38:41], a[52:55]
    s_waitcnt lgkmcnt(4)
    ds_read_b64_tr_b16 a[214:215], v4 offset:7168
    v_add_u32 v104, s38, v104
    v_mfma_f32_16x16x32_bf16 a[56:59], a[220:223], v[38:41], a[56:59]
    v_fma_f32 v64, v64, s28, v10
    v_fma_f32 v68, v68, s28, v11
    v_mfma_f32_16x16x32_bf16 a[60:63], a[224:227], v[38:41], a[60:63]
    ds_read_b64_tr_b16 a[218:219], v5 offset:7168
    v_fma_f32 v87, v87, s28, v13
    v_mfma_f32_16x16x32_bf16 a[12:15], a[224:227], v[32:35], a[12:15]
    v_exp_f32 v91, v91
    v_mfma_f32_16x16x32_bf16 a[8:11], a[220:223], v[32:35], a[8:11]
    ds_read_b128 a[176:179], v104 offset:20480
    v_fma_f32 v57, v57, s28, v9
    v_mfma_f32_16x16x32_bf16 v[216:219], a[220:223], v[26:29], v[216:219]
    v_exp_f32 v83, v83
    v_mfma_f32_16x16x32_bf16 v[220:223], a[224:227], v[26:29], v[220:223]
    ds_read_b64_tr_b16 a[212:213], v4 offset:1024
    v_fma_f32 v89, v89, s28, v13
    v_mfma_f32_16x16x32_bf16 v[172:175], a[224:227], v[20:23], v[172:175]
    ds_read_b64_tr_b16 a[216:217], v5 offset:1024
    v_fma_f32 v84, v84, s28, v13
    v_mfma_f32_16x16x32_bf16 v[168:171], a[220:223], v[20:23], v[168:171]
    v_exp_f32 v68, v68
    v_mfma_f32_16x16x32_bf16 v[120:123], a[220:223], v[14:17], v[120:123]
    v_xor_b32 v105, 64, v104
    v_fma_f32 v78, v78, s28, v12
    v_mfma_f32_16x16x32_bf16 v[124:127], a[224:227], v[14:17], v[124:127]
    s_waitcnt lgkmcnt(4)
    ds_read_b64_tr_b16 a[220:221], v2 offset:2048
    v_fma_f32 v76, v76, s28, v12
    v_mfma_f32_16x16x32_bf16 v[128:131], a[228:231], v[14:17], v[128:131]
    v_exp_f32 v87, v87
    v_mfma_f32_16x16x32_bf16 v[132:135], a[232:235], v[14:17], v[132:135]
    v_fma_f32 v71, v71, s28, v11
    v_fma_f32 v67, v67, s28, v10
    v_mfma_f32_16x16x32_bf16 v[180:183], a[232:235], v[20:23], v[180:183]
    ds_read_b64_tr_b16 a[226:227], v3 offset:8192
    v_fma_f32 v56, v56, s28, v9
    v_mfma_f32_16x16x32_bf16 v[176:179], a[228:231], v[20:23], v[176:179]
    v_exp_f32 v71, v71
    v_mfma_f32_16x16x32_bf16 v[224:227], a[228:231], v[26:29], v[224:227]
    v_exp_f32 v79, v79
    v_mfma_f32_16x16x32_bf16 v[228:231], a[232:235], v[26:29], v[228:231]
    v_exp_f32 v69, v69
    v_mfma_f32_16x16x32_bf16 a[20:23], a[232:235], v[32:35], a[20:23]
    v_fma_f32 v88, v88, s28, v13
    v_fma_f32 v82, v82, s28, v12
    v_mfma_f32_16x16x32_bf16 a[16:19], a[228:231], v[32:35], a[16:19]
    ds_read_b64_tr_b16 a[222:223], v2 offset:8192
    v_fma_f32 v70, v70, s28, v11
    v_mfma_f32_16x16x32_bf16 a[64:67], a[228:231], v[38:41], a[64:67]
    ds_read_b64_tr_b16 a[228:229], v4 offset:2048
    v_fma_f32 v75, v75, s28, v11
    v_mfma_f32_16x16x32_bf16 a[68:71], a[232:235], v[38:41], a[68:71]
    s_waitcnt lgkmcnt(3)
    v_exp_f32 v76, v76
    v_mfma_f32_16x16x32_bf16 a[72:75], a[212:215], v[38:41], a[72:75]
    s_add_u32 s39, s39, 12288
    ds_read_b64_tr_b16 a[224:225], v3 offset:2048
    v_exp_f32 v64, v64
    v_mfma_f32_16x16x32_bf16 a[76:79], a[216:219], v[38:41], a[76:79]
    ds_read_b128 a[120:123], v104 offset:6144
    v_fma_f32 v65, v65, s28, v10
    v_mfma_f32_16x16x32_bf16 a[28:31], a[216:219], v[32:35], a[28:31]
    ds_read_b64_tr_b16 a[230:231], v4 offset:8192
    v_exp_f32 v77, v77
    v_mfma_f32_16x16x32_bf16 a[24:27], a[212:215], v[32:35], a[24:27]
    v_exp_f32 v84, v84
    v_mfma_f32_16x16x32_bf16 v[232:235], a[212:215], v[26:29], v[232:235]
    ds_read_b64_tr_b16 a[234:235], v5 offset:8192
    v_fma_f32 v80, v80, s28, v12
    v_mfma_f32_16x16x32_bf16 v[236:239], a[216:219], v[26:29], v[236:239]
    ds_read_b128 a[144:147], v104 offset:12288
    v_fma_f32 v85, v85, s28, v13
    v_mfma_f32_16x16x32_bf16 v[188:191], a[216:219], v[20:23], v[188:191]
    ds_read_b64_tr_b16 a[232:233], v5 offset:2048
    v_exp_f32 v80, v80
    v_exp_f32 v78, v78
    v_mfma_f32_16x16x32_bf16 v[184:187], a[212:215], v[20:23], v[184:187]
    ds_read_b128 a[148:151], v105 offset:12288
    v_cvt_pk_bf16_f32 v30, v68, v69
    v_mfma_f32_16x16x32_bf16 v[136:139], a[212:215], v[14:17], v[136:139]
    ds_read_b128 a[132:135], v105 offset:8192
    v_fma_f32 v58, v58, s28, v9
    v_mfma_f32_16x16x32_bf16 v[140:143], a[216:219], v[14:17], v[140:143]
    s_waitcnt lgkmcnt(7)
    v_exp_f32 v70, v70
    v_mfma_f32_16x16x32_bf16 v[144:147], a[220:223], v[14:17], v[144:147]
    ds_read_b128 a[168:171], v104 offset:18432
    v_exp_f32 v65, v65
    v_mfma_f32_16x16x32_bf16 v[148:151], a[224:227], v[14:17], v[148:151]
    v_exp_f32 v89, v89
    v_mfma_f32_16x16x32_bf16 v[196:199], a[224:227], v[20:23], v[196:199]
    v_exp_f32 v85, v85
    v_mfma_f32_16x16x32_bf16 v[192:195], a[220:223], v[20:23], v[192:195]
    ds_read_b128 a[124:127], v105 offset:6144
    v_cvt_pk_bf16_f32 v43, v86, v87
    v_mfma_f32_16x16x32_bf16 v[240:243], a[220:223], v[26:29], v[240:243]
    ds_read_b128 a[152:155], v104 offset:14336
    v_fma_f32 v74, v74, s28, v11
    v_mfma_f32_16x16x32_bf16 v[244:247], a[224:227], v[26:29], v[244:247]
    s_waitcnt vmcnt(9) lgkmcnt(5)
    ds_read_b128 a[96:99], v104 offset:0
    v_cvt_pk_bf16_f32 v36, v76, v77
    v_mfma_f32_16x16x32_bf16 a[36:39], a[224:227], v[32:35], a[36:39]
    ds_read_b128 a[192:195], v104 offset:24576
    v_cvt_pk_bf16_f32 v42, v84, v85
    v_mfma_f32_16x16x32_bf16 a[32:35], a[220:223], v[32:35], a[32:35]
    s_add_u32 s21, s21, s62
    ds_read_b128 a[196:199], v105 offset:24576
    v_fma_f32 v59, v59, s28, v9
    v_mfma_f32_16x16x32_bf16 a[80:83], a[220:223], v[38:41], a[80:83]
    ds_read_b128 a[128:131], v104 offset:8192
    v_fma_f32 v81, v81, s28, v12
    v_mfma_f32_16x16x32_bf16 a[84:87], a[224:227], v[38:41], a[84:87]
    s_barrier
    v_mfma_f32_16x16x32_bf16 a[88:91], a[228:231], v[38:41], a[88:91]
    s_add_u32 m0, s22, 24576
    ds_read_b128 a[212:215], v0 offset:0
    v_cvt_pk_bf16_f32 v37, v78, v79
    v_mfma_f32_16x16x32_bf16 a[92:95], a[232:235], v[38:41], a[92:95]
    ds_read_b128 a[216:219], v1 offset:0
    buffer_load_dwordx4 v6, s[8:11], s21 offen lds
    v_mfma_f32_16x16x32_bf16 a[44:47], a[232:235], v[32:35], a[44:47]
    s_add_u32 s21, s21, 128
    ds_read_b128 a[172:175], v105 offset:18432
    v_fma_f32 v73, v73, s28, v11
    v_mfma_f32_16x16x32_bf16 a[40:43], a[228:231], v[32:35], a[40:43]
    ds_read_b128 a[100:103], v105 offset:0
    v_mfma_f32_16x16x32_bf16 v[248:251], a[228:231], v[26:29], v[248:251]
    s_add_u32 m0, s22, 25600
    ds_read_b128 a[156:159], v105 offset:14336
    buffer_load_dwordx4 v6, s[8:11], s21 offen lds
    v_mfma_f32_16x16x32_bf16 v[252:255], a[232:235], v[26:29], v[252:255]
    ds_read_b128 a[200:203], v104 offset:26624
    s_add_u32 s21, s21, 128
    v_mfma_f32_16x16x32_bf16 v[204:207], a[232:235], v[20:23], v[204:207]
    s_add_u32 m0, s22, 26624
    ds_read_b128 a[180:183], v105 offset:20480
    v_cvt_pk_bf16_f32 v31, v70, v71
    v_mfma_f32_16x16x32_bf16 v[200:203], a[228:231], v[20:23], v[200:203]
    ds_read_b128 a[104:107], v104 offset:2048
    v_exp_f32 v56, v56
    v_mfma_f32_16x16x32_bf16 v[152:155], a[228:231], v[14:17], v[152:155]
    buffer_load_dwordx4 v6, s[8:11], s21 offen lds
    ds_read_b128 a[224:227], v1 offset:1024
    v_mfma_f32_16x16x32_bf16 v[156:159], a[232:235], v[14:17], v[156:159]
    s_waitcnt lgkmcnt(8)
    ds_read_b128 a[220:223], v0 offset:1024
    v_exp_f32 v58, v58
    v_mfma_f32_16x16x32_bf16 v[52:55], a[212:215], a[96:99], 0
    v_exp_f32 v59, v59
    v_mfma_f32_16x16x32_bf16 v[60:63], a[212:215], a[120:123], 0
    ds_read_b128 a[164:167], v105 offset:16384
    v_fma_f32 v72, v72, s28, v11
    v_mfma_f32_16x16x32_bf16 v[68:71], a[212:215], a[144:147], 0
    ds_read_b128 a[204:207], v105 offset:26624
    v_cvt_pk_bf16_f32 v22, v64, v65
    v_mfma_f32_16x16x32_bf16 v[76:79], a[212:215], a[168:171], 0
    ds_read_b128 a[108:111], v105 offset:2048
    v_mfma_f32_16x16x32_bf16 v[84:87], a[212:215], a[192:195], 0
    s_waitcnt lgkmcnt(7)
    v_exp_f32 v88, v88
    v_mfma_f32_16x16x32_bf16 v[52:55], a[216:219], a[100:103], v[52:55]
    v_exp_f32 v67, v67
    v_mfma_f32_16x16x32_bf16 v[60:63], a[216:219], a[124:127], v[60:63]
    v_exp_f32 v75, v75
    v_mfma_f32_16x16x32_bf16 v[68:71], a[216:219], a[148:151], v[68:71]
    ds_read_b128 a[228:231], v0 offset:6144
    v_cvt_pk_bf16_f32 v17, v58, v59
    v_mfma_f32_16x16x32_bf16 v[76:79], a[216:219], a[172:175], v[76:79]
    v_exp_f32 v82, v82
    v_mfma_f32_16x16x32_bf16 v[84:87], a[216:219], a[196:199], v[84:87]
    s_waitcnt lgkmcnt(4)
    v_exp_f32 v90, v90
    v_mfma_f32_16x16x32_bf16 v[52:55], a[220:223], a[104:107], v[52:55]
    v_exp_f32 v81, v81
    v_mfma_f32_16x16x32_bf16 v[60:63], a[220:223], a[128:131], v[60:63]
    v_exp_f32 v73, v73
    v_mfma_f32_16x16x32_bf16 v[68:71], a[220:223], a[152:155], v[68:71]
    v_exp_f32 v66, v66
    v_mfma_f32_16x16x32_bf16 v[76:79], a[220:223], a[176:179], v[76:79]
    v_exp_f32 v72, v72
    v_mfma_f32_16x16x32_bf16 v[84:87], a[220:223], a[200:203], v[84:87]
    s_waitcnt lgkmcnt(1)
    v_exp_f32 v57, v57
    v_mfma_f32_16x16x32_bf16 v[52:55], a[224:227], a[108:111], v[52:55]
    v_cvt_pk_bf16_f32 v23, v66, v67
    v_cvt_pk_bf16_f32 v16, v56, v57
    v_mfma_f32_16x16x32_bf16 v[60:63], a[224:227], a[132:135], v[60:63]
    ds_read_b128 a[140:143], v105 offset:10240
    v_cvt_pk_bf16_f32 v41, v90, v91
    v_mfma_f32_16x16x32_bf16 v[68:71], a[224:227], a[156:159], v[68:71]
    v_exp_f32 v74, v74
    v_mfma_f32_16x16x32_bf16 v[76:79], a[224:227], a[180:183], v[76:79]
    ds_read_b128 a[220:223], v0 offset:2048
    v_cvt_pk_bf16_f32 v34, v80, v81
    v_mfma_f32_16x16x32_bf16 v[84:87], a[224:227], a[204:207], v[84:87]
    s_waitcnt lgkmcnt(2)
    ds_read_b128 a[232:235], v1 offset:6144
    v_mfma_f32_16x16x32_bf16 v[56:59], a[228:231], a[96:99], 0
    v_mfma_f32_16x16x32_bf16 v[48:51], a[236:239], v[16:19], v[44:47]
    v_cvt_pk_bf16_f32 v40, v88, v89
    v_cvt_pk_bf16_f32 v35, v82, v83
    v_mfma_f32_16x16x32_bf16 v[48:51], a[240:243], v[22:25], v[48:51]
    v_cvt_pk_bf16_f32 v28, v72, v73
    v_cvt_pk_bf16_f32 v29, v74, v75
    v_mfma_f32_16x16x32_bf16 v[64:67], a[228:231], a[120:123], 0
    ds_read_b128 a[212:215], v0 offset:7168
    v_mfma_f32_16x16x32_bf16 v[48:51], a[244:247], v[28:31], v[48:51]
    ds_read_b128 a[184:187], v104 offset:22528
    v_mfma_f32_16x16x32_bf16 v[72:75], a[228:231], a[144:147], 0
    ds_read_b128 a[216:219], v1 offset:7168
    v_mfma_f32_16x16x32_bf16 v[48:51], a[248:251], v[34:37], v[48:51]
    v_mfma_f32_16x16x32_bf16 v[48:51], a[252:255], v[40:43], v[48:51]
    s_add_u32 s21, s21, 12032
    ds_read_b128 a[116:119], v105 offset:4096
    v_mfma_f32_16x16x32_bf16 v[80:83], a[228:231], a[168:171], 0
    ds_read_b128 a[188:191], v105 offset:22528
    v_mfma_f32_16x16x32_bf16 v[88:91], a[228:231], a[192:195], 0
    s_waitcnt lgkmcnt(5)
    ds_read_b128 a[160:163], v104 offset:16384
    v_mfma_f32_16x16x32_bf16 v[56:59], a[232:235], a[100:103], v[56:59]
    ds_read_b128 a[112:115], v104 offset:4096
    v_mfma_f32_16x16x32_bf16 v[64:67], a[232:235], a[124:127], v[64:67]
    ds_read_b128 a[136:139], v104 offset:10240
    v_cmp_lt_f32 vcc, s29, v48
    v_mfma_f32_16x16x32_bf16 v[72:75], a[232:235], a[148:151], v[72:75]
    ds_read_b128 a[224:227], v1 offset:2048
    v_mfma_f32_16x16x32_bf16 v[80:83], a[232:235], a[172:175], v[80:83]
    ds_read_b128 a[228:231], v0 offset:8192
    v_mfma_f32_16x16x32_bf16 v[88:91], a[232:235], a[196:199], v[88:91]
    s_waitcnt lgkmcnt(8)
    ds_read_b128 a[232:235], v1 offset:8192
    v_mfma_f32_16x16x32_bf16 v[56:59], a[212:215], a[104:107], v[56:59]
    s_cbranch_vccnz L_rs_tr55b
L_ret_tr55b:
    v_lshrrev_b32 v108, 11, v0
    v_mfma_f32_16x16x32_bf16 v[64:67], a[212:215], a[128:131], v[64:67]
    v_mov_b32 v100, v48
    v_and_b32 v101, 0x3ff, v0
    v_mfma_f32_16x16x32_bf16 v[72:75], a[212:215], a[152:155], v[72:75]
    v_rcp_f32 v102, v49
    v_mfma_f32_16x16x32_bf16 v[80:83], a[212:215], a[176:179], v[80:83]
    v_permlane32_swap_b32 v48, v100
    v_mfma_f32_16x16x32_bf16 v[88:91], a[212:215], a[200:203], v[88:91]
    s_waitcnt lgkmcnt(5)
    v_xor_b32 v108, s65, v108
    v_lshl_add_u32 v101, v108, 10, v101
    v_mfma_f32_16x16x32_bf16 v[56:59], a[216:219], a[108:111], v[56:59]
    s_waitcnt vmcnt(3)
    v_mbcnt_lo_u32_b32 v108, -1, 0
    v_mbcnt_hi_u32_b32 v108, -1, v108
    v_mfma_f32_16x16x32_bf16 v[64:67], a[216:219], a[132:135], v[64:67]
    v_mfma_f32_16x16x32_bf16 v[72:75], a[216:219], a[156:159], v[72:75]
    v_lshrrev_b32 v108, 1, v108
    v_add_u32 v101, s38, v101
    v_mfma_f32_16x16x32_bf16 v[80:83], a[216:219], a[180:183], v[80:83]
    s_waitcnt vmcnt(8) lgkmcnt(0)
    v_mfma_f32_16x16x32_bf16 v[88:91], a[216:219], a[204:207], v[88:91]
    s_barrier
    v_mfma_f32_16x16x32_bf16 v[52:55], a[220:223], a[112:115], v[52:55]
    ds_read_b64_tr_b16 a[212:213], v2 offset:18432
    s_add_u32 m0, s22, 0
    v_mfma_f32_16x16x32_bf16 v[60:63], a[220:223], a[136:139], v[60:63]
    buffer_load_dwordx4 v6, s[4:7], s20 offen lds
    v_mfma_f32_16x16x32_bf16 v[68:71], a[220:223], a[160:163], v[68:71]
    ds_read_b64_tr_b16 a[214:215], v2 offset:12288
    v_mfma_f32_16x16x32_bf16 v[76:79], a[220:223], a[184:187], v[76:79]
    s_add_u32 s20, s20, 128
    s_add_u32 m0, s22, 1024
    ds_read_b64_tr_b16 a[216:217], v3 offset:18432
    v_mfma_f32_16x16x32_bf16 v[84:87], a[220:223], a[208:211], v[84:87]
    buffer_load_dwordx4 v6, s[4:7], s20 offen lds
    v_mfma_f32_16x16x32_bf16 v[52:55], a[224:227], a[116:119], v[52:55]
    s_add_u32 s20, s20, 128
    s_add_u32 m0, s22, 2048
    v_and_b32 v108, 24, v108
    v_mfma_f32_16x16x32_bf16 v[60:63], a[224:227], a[140:143], v[60:63]
    buffer_load_dwordx4 v6, s[4:7], s20 offen lds
    v_mfma_f32_16x16x32_bf16 v[68:71], a[224:227], a[164:167], v[68:71]
    ds_read_b64_tr_b16 a[218:219], v3 offset:12288
    v_mfma_f32_16x16x32_bf16 v[76:79], a[224:227], a[188:191], v[76:79]
    ds_read_b64_tr_b16 a[220:221], v4 offset:18432
    v_bfe_u32 v108, s66, v108, 8
    v_mfma_f32_16x16x32_bf16 v[84:87], a[224:227], v[92:95], v[84:87]
    v_rcp_f32 v8, v51
    v_mfma_f32_16x16x32_bf16 v[56:59], a[228:231], a[112:115], v[56:59]
    v_rcp_f32 v50, v50
    v_mfma_f32_16x16x32_bf16 v[64:67], a[228:231], a[136:139], v[64:67]
    v_rcp_f32 v48, v48
    v_mfma_f32_16x16x32_bf16 v[72:75], a[228:231], a[160:163], v[72:75]
    v_xor_b32 v101, v101, v108
    v_mfma_f32_16x16x32_bf16 v[80:83], a[228:231], a[184:187], v[80:83]
    ds_read_b64_tr_b16 a[222:223], v4 offset:12288
    v_mov_b32 v108, v100
    v_mfma_f32_16x16x32_bf16 v[88:91], a[228:231], a[208:211], v[88:91]
    s_add_u32 s20, s20, 12032
    v_permlane16_swap_b32 v100, v108
    v_mfma_f32_16x16x32_bf16 v[56:59], a[232:235], a[116:119], v[56:59]
    ds_read_b64_tr_b16 a[224:225], v5 offset:18432
    v_mfma_f32_16x16x32_bf16 v[64:67], a[232:235], a[140:143], v[64:67]
    v_mfma_f32_16x16x32_bf16 v[72:75], a[232:235], a[164:167], v[72:75]
    v_rcp_f32 v100, v100
    v_mfma_f32_16x16x32_bf16 v[80:83], a[232:235], a[188:191], v[80:83]
    ds_read_b64_tr_b16 a[226:227], v5 offset:12288
    v_mfma_f32_16x16x32_bf16 v[88:91], a[232:235], v[92:95], v[88:91]
    s_waitcnt lgkmcnt(3)
    v_mfma_f32_16x16x32_bf16 v[112:115], a[212:215], v[16:19], v[112:115]
    s_mov_b32 s67, s34
    v_max3_f32 v97, v60, v61, v62
    v_max3_f32 v96, v52, v53, v54
    v_max3_f32 v96, v96, v55, v56
    v_max3_f32 v99, v76, v77, v78
    v_mfma_f32_16x16x32_bf16 v[116:119], a[216:219], v[16:19], v[116:119]
    s_add_u32 s18, s34, 30720
    v_max3_f32 v98, v68, v69, v70
    v_max3_f32 v99, v99, v79, v80
    v_max3_f32 v98, v98, v71, v72
    v_mfma_f32_16x16x32_bf16 v[164:167], a[216:219], v[22:25], v[164:167]
    v_max3_f32 v98, v98, v73, v74
    v_max3_f32 v96, v96, v57, v58
    v_max3_f32 v97, v97, v63, v64
    v_max3_f32 v97, v97, v65, v66
    v_mfma_f32_16x16x32_bf16 v[160:163], a[212:215], v[22:25], v[160:163]
    ds_read_b64_tr_b16 a[228:229], v2 offset:19456
    v_max3_f32 v99, v99, v81, v82
    v_mfma_f32_16x16x32_bf16 v[208:211], a[212:215], v[28:31], v[208:211]
    v_max_f32 v99, v99, v83
    v_max_f32 v96, v96, v59
    v_mfma_f32_16x16x32_bf16 v[212:215], a[216:219], v[28:31], v[212:215]
    s_mov_b32 s34, s33
    v_max_f32 v97, v97, v67
    v_max_f32 v98, v98, v75
    v_mfma_f32_16x16x32_bf16 a[4:7], a[216:219], v[34:37], a[4:7]
    s_add_u32 s64, s64, s62
    v_permlane32_swap_b32 v96, v97
    v_mfma_f32_16x16x32_bf16 a[0:3], a[212:215], v[34:37], a[0:3]
    s_add_u32 s64, s64, 196608
    ds_read_b64_tr_b16 a[230:231], v2 offset:13312
    v_max_f32 v96, v96, v97
    v_mfma_f32_16x16x32_bf16 a[48:51], a[212:215], v[40:43], a[48:51]
    s_mov_b32 s39, s64
    v_permlane32_swap_b32 v98, v99
    v_mfma_f32_16x16x32_bf16 a[52:55], a[216:219], v[40:43], a[52:55]
    s_waitcnt lgkmcnt(2)
    ds_read_b64_tr_b16 a[234:235], v3 offset:13312
    v_max_f32 v98, v98, v99
    v_mfma_f32_16x16x32_bf16 a[56:59], a[220:223], v[40:43], a[56:59]
    ds_read_b64_tr_b16 a[218:219], v5 offset:13312
    v_permlane16_swap_b32 v96, v98
    v_mfma_f32_16x16x32_bf16 a[60:63], a[224:227], v[40:43], a[60:63]
    s_add_u32 s37, s37, 1
    ds_read_b64_tr_b16 a[232:233], v3 offset:19456
    v_max_f32 v96, v96, v98
    v_mfma_f32_16x16x32_bf16 a[12:15], a[224:227], v[34:37], a[12:15]
    s_bitcmp1_b32 s63, s37
    v_mul_f32_e64 v9, -s28, v96
    v_mov_b32 v11, v9
    v_max3_f32 v96, v84, v85, v86
    v_mfma_f32_16x16x32_bf16 a[8:11], a[220:223], v[34:37], a[8:11]
    s_cselect_b32 s62, 4294770688, 0
    ds_read_b64_tr_b16 a[216:217], v5 offset:19456
    v_permlane16_swap_b32 v9, v11
    v_max3_f32 v96, v96, v87, v88
    v_mfma_f32_16x16x32_bf16 v[216:219], a[220:223], v[28:31], v[216:219]
    s_cselect_b32 s42, 0, 325632
    v_mov_b32 v12, v11
    v_max3_f32 v96, v96, v89, v90
    v_mfma_f32_16x16x32_bf16 v[220:223], a[224:227], v[28:31], v[220:223]
    s_add_u32 s35, s35, s42
    ds_read_b64_tr_b16 a[214:215], v4 offset:13312
    v_mov_b32 v10, v9
    v_mfma_f32_16x16x32_bf16 v[172:175], a[224:227], v[22:25], v[172:175]
    ds_read_b64_tr_b16 a[212:213], v4 offset:19456
    v_max_f32 v96, v96, v91
    v_accvgpr_read_b32 v109, a49
    v_permlane32_swap_b32 v9, v10
    v_fma_f32 v56, v56, s28, v9
    v_mfma_f32_16x16x32_bf16 v[168:171], a[220:223], v[22:25], v[168:171]
    s_lshl_b32 s42, s37, 1
    v_permlane32_swap_b32 v11, v12
    v_mfma_f32_16x16x32_bf16 v[120:123], a[220:223], v[16:19], v[120:123]
    s_lshr_b32 s42, s31, s42
    v_fma_f32 v59, v59, s28, v9
    v_accvgpr_read_b32 v108, a48
    v_accvgpr_read_b32 v110, a50
    v_mfma_f32_16x16x32_bf16 v[124:127], a[224:227], v[16:19], v[124:127]
    s_waitcnt lgkmcnt(3)
    v_fma_f32 v71, v71, s28, v11
    v_fma_f32 v61, v61, s28, v10
    v_mfma_f32_16x16x32_bf16 v[128:131], a[228:231], v[16:19], v[128:131]
    s_and_b32 s42, s42, 3
    ds_read_b64_tr_b16 a[222:223], v2 offset:14336
    v_mov_b32 v97, v96
    v_mfma_f32_16x16x32_bf16 v[132:135], a[232:235], v[16:19], v[132:135]
    ds_read_b64_tr_b16 a[226:227], v3 offset:14336
    v_fma_f32 v57, v57, s28, v9
    v_fma_f32 v58, v58, s28, v9
    v_mfma_f32_16x16x32_bf16 v[180:183], a[232:235], v[22:25], v[180:183]
    s_add_u32 s42, s42, s36
    v_exp_f32 v57, v57
    v_mfma_f32_16x16x32_bf16 v[176:179], a[228:231], v[22:25], v[176:179]
    s_sub_u32 s43, s42, 3
    v_permlane32_swap_b32 v97, v96
    v_mfma_f32_16x16x32_bf16 v[224:227], a[228:231], v[28:31], v[224:227]
    s_cmp_ge_u32 s42, 3
    ds_read_b64_tr_b16 a[224:225], v3 offset:20480
    v_fma_f32 v77, v77, s28, v12
    v_mfma_f32_16x16x32_bf16 v[228:231], a[232:235], v[28:31], v[228:231]
    s_cselect_b32 s42, s43, s42
    ds_read_b64_tr_b16 a[220:221], v2 offset:20480
    v_fma_f32 v53, v53, s28, v9
    v_mfma_f32_16x16x32_bf16 a[20:23], a[232:235], v[34:37], a[20:23]
    s_mul_i32 s44, s3, 5
    v_exp_f32 v61, v61
    v_mfma_f32_16x16x32_bf16 a[16:19], a[228:231], v[34:37], a[16:19]
    s_mov_b32 s32, 1
    v_fma_f32 v74, v74, s28, v11
    v_accvgpr_read_b32 v111, a51
    v_mfma_f32_16x16x32_bf16 a[64:67], a[228:231], v[40:43], a[64:67]
    s_lshl_b32 s43, s3, 2
    ds_read_b64_tr_b16 a[230:231], v4 offset:14336
    v_fma_f32 v75, v75, s28, v11
    v_fma_f32 v54, v54, s28, v9
    v_mfma_f32_16x16x32_bf16 a[68:71], a[232:235], v[40:43], a[68:71]
    s_waitcnt lgkmcnt(5)
    v_exp_f32 v53, v53
    v_fma_f32 v68, v68, s28, v11
    v_max_f32 v96, v96, v97
    v_mfma_f32_16x16x32_bf16 a[72:75], a[212:215], v[40:43], a[72:75]
    s_add_u32 s45, s43, 21
    ds_read_b64_tr_b16 a[232:233], v5 offset:20480
    v_fma_f32 v79, v79, s28, v12
    v_mfma_f32_16x16x32_bf16 a[76:79], a[216:219], v[40:43], a[76:79]
    s_cmp_eq_u32 s3, 0
    v_fma_f32 v64, v64, s28, v10
    v_mov_b32 v97, v96
    v_mfma_f32_16x16x32_bf16 a[28:31], a[216:219], v[34:37], a[28:31]
    s_cselect_b32 s45, 20, s45
    v_permlane16_swap_b32 v97, v96
    v_mfma_f32_16x16x32_bf16 a[24:27], a[212:215], v[34:37], a[24:27]
    s_cselect_b32 s33, 1, 0
    v_accvgpr_read_b32 v105, a1
    v_fma_f32 v76, v76, s28, v12
    v_mfma_f32_16x16x32_bf16 v[232:235], a[212:215], v[28:31], v[232:235]
    s_cmp_eq_u32 s42, 1
    v_fma_f32 v52, v52, s28, v9
    v_max_f32 v96, v96, v97
    v_mfma_f32_16x16x32_bf16 v[236:239], a[216:219], v[28:31], v[236:239]
    s_cselect_b32 s44, s45, s44
    v_fma_f32 v55, v55, s28, v9
    v_fma_f32 v60, v60, s28, v10
    v_mfma_f32_16x16x32_bf16 v[188:191], a[216:219], v[22:25], v[188:191]
    s_cselect_b32 s32, s33, s32
    v_exp_f32 v54, v54
    v_mfma_f32_16x16x32_bf16 v[184:187], a[212:215], v[22:25], v[184:187]
    s_add_u32 s45, s43, 37
    ds_read_b64_tr_b16 a[234:235], v5 offset:14336
    v_exp_f32 v77, v77
    v_mfma_f32_16x16x32_bf16 v[136:139], a[212:215], v[16:19], v[136:139]
    s_cmp_eq_u32 s42, 2
    v_exp_f32 v76, v76
    v_mul_f32_e64 v13, -s28, v96
    v_exp_f32 v52, v52
    v_pk_mul_f32 v[216:217], v[216:217], v[50:51] op_sel_hi:[1,0]
    v_exp_f32 v68, v68
    s_cselect_b32 s44, s45, s44
    v_accvgpr_read_b32 v104, a0
    v_mfma_f32_16x16x32_bf16 v[140:143], a[216:219], v[16:19], v[140:143]
    s_waitcnt lgkmcnt(1)
    v_fma_f32 v62, v62, s28, v10
    v_fma_f32 v72, v72, s28, v11
    v_mfma_f32_16x16x32_bf16 v[144:147], a[220:223], v[16:19], v[144:147]
    s_cselect_b32 s32, 0, s32
    ds_read_b64_tr_b16 a[228:229], v4 offset:20480
    v_exp_f32 v79, v79
    v_mfma_f32_16x16x32_bf16 v[148:151], a[224:227], v[16:19], v[148:151]
    s_mul_i32 s44, s44, 6144
    v_fma_f32 v81, v81, s28, v12
    s_add_u32 s33, s35, s44
    v_mfma_f32_16x16x32_bf16 v[196:199], a[224:227], v[22:25], v[196:199]
    s_mul_i32 s42, s32, 6144
    v_fma_f32 v63, v63, s28, v10
    v_fma_f32 v78, v78, s28, v12
    v_mfma_f32_16x16x32_bf16 v[192:195], a[220:223], v[22:25], v[192:195]
    s_add_u32 s42, s42, 24576
    v_exp_f32 v60, v60
    v_mfma_f32_16x16x32_bf16 v[240:243], a[220:223], v[28:31], v[240:243]
    s_add_u32 s42, s42, s33
    v_fma_f32 v86, v86, s28, v13
    v_fma_f32 v87, v87, s28, v13
    v_exp_f32 v63, v63
    v_mfma_f32_16x16x32_bf16 v[244:247], a[224:227], v[28:31], v[244:247]
    s_cmp_ge_u32 s37, 6
    v_exp_f32 v81, v81
    v_cvt_pk_bf16_f32 v14, v52, v53
    v_mfma_f32_16x16x32_bf16 a[36:39], a[224:227], v[34:37], a[36:39]
    s_cselect_b32 s14, 0, s42
    v_exp_f32 v62, v62
    v_mfma_f32_16x16x32_bf16 a[32:35], a[220:223], v[34:37], a[32:35]
    s_add_u32 s24, s67, 256
    s_add_u32 s25, s33, 256
    v_fma_f32 v80, v80, s28, v12
    s_add_u32 s23, s38, 4096
    v_mfma_f32_16x16x32_bf16 a[80:83], a[220:223], v[40:43], a[80:83]
    s_mov_b32 s27, 0x249
    v_exp_f32 v64, v64
    v_mfma_f32_16x16x32_bf16 a[84:87], a[224:227], v[40:43], a[84:87]
    s_mov_b32 s30, 0
    s_waitcnt vmcnt(8) lgkmcnt(0)
    v_fma_f32 v84, v84, s28, v13
    v_mfma_f32_16x16x32_bf16 a[88:91], a[228:231], v[40:43], a[88:91]
    s_barrier
    v_mfma_f32_16x16x32_bf16 a[92:95], a[232:235], v[40:43], a[92:95]
    v_cvt_pk_bf16_f32 v20, v60, v61
    v_cvt_pk_bf16_f32 v21, v62, v63
    v_fma_f32 v69, v69, s28, v11
    v_exp_f32 v69, v69
    v_mfma_f32_16x16x32_bf16 a[44:47], a[232:235], v[34:37], a[44:47]
    ds_read_b128 a[212:215], v0 offset:12288
    v_fma_f32 v85, v85, s28, v13
    v_fma_f32 v65, v65, s28, v10
    v_fma_f32 v88, v88, s28, v13
    v_mfma_f32_16x16x32_bf16 a[40:43], a[228:231], v[34:37], a[40:43]
    ds_read_b128 a[216:219], v1 offset:12288
    v_exp_f32 v85, v85
    v_mfma_f32_16x16x32_bf16 v[248:251], a[228:231], v[28:31], v[248:251]
    ds_read_b128 a[220:223], v0 offset:13312
    v_exp_f32 v55, v55
    v_exp_f32 v84, v84
    v_exp_f32 v71, v71
    v_cvt_pk_bf16_f32 v15, v54, v55
    v_mfma_f32_16x16x32_bf16 v[252:255], a[232:235], v[28:31], v[252:255]
    v_exp_f32 v59, v59
    v_mfma_f32_16x16x32_bf16 v[204:207], a[232:235], v[22:25], v[204:207]
    v_exp_f32 v65, v65
    v_fma_f32 v67, v67, s28, v10
    v_mfma_f32_16x16x32_bf16 v[200:203], a[228:231], v[22:25], v[200:203]
    v_cvt_pk_bf16_f32 v38, v84, v85
    v_fma_f32 v91, v91, s28, v13
    v_exp_f32 v87, v87
    v_mfma_f32_16x16x32_bf16 v[152:155], a[228:231], v[16:19], v[152:155]
    v_exp_f32 v86, v86
    v_cvt_pk_bf16_f32 v32, v76, v77
    v_mfma_f32_16x16x32_bf16 v[156:159], a[232:235], v[16:19], v[156:159]
    s_waitcnt lgkmcnt(2)
    ds_read_b128 a[224:227], v1 offset:13312
    v_fma_f32 v70, v70, s28, v11
    v_cvt_pk_bf16_f32 v39, v86, v87
    v_mfma_f32_16x16x32_bf16 v[52:55], a[212:215], a[96:99], 0
    s_waitcnt lgkmcnt(2)
    v_fma_f32 v66, v66, s28, v10
    v_exp_f32 v70, v70
    v_mfma_f32_16x16x32_bf16 v[52:55], a[216:219], a[100:103], v[52:55]
    s_waitcnt lgkmcnt(1)
    ds_read_b128 a[228:231], v0 offset:14336
    v_fma_f32 v82, v82, s28, v12
    v_mfma_f32_16x16x32_bf16 v[52:55], a[220:223], a[104:107], v[52:55]
    ds_read_b128 a[232:235], v1 offset:14336
    v_cvt_pk_bf16_f32 v22, v64, v65
    v_mfma_f32_16x16x32_bf16 v[60:63], a[220:223], a[128:131], 0
    v_cvt_pk_bf16_f32 v26, v68, v69
    v_cvt_pk_bf16_f32 v27, v70, v71
    v_mfma_f32_16x16x32_bf16 v[60:63], a[216:219], a[124:127], v[60:63]
    v_exp_f32 v74, v74
    v_mfma_f32_16x16x32_bf16 v[60:63], a[212:215], a[120:123], v[60:63]
    s_add_u32 m0, s22, 36864
    v_exp_f32 v91, v91
    v_mfma_f32_16x16x32_bf16 v[68:71], a[212:215], a[144:147], 0
    v_exp_f32 v72, v72
    v_exp_f32 v67, v67
    v_mfma_f32_16x16x32_bf16 v[68:71], a[216:219], a[148:151], v[68:71]
    buffer_load_dwordx4 v6, s[8:11], s21 offen lds
    v_exp_f32 v78, v78
    v_mfma_f32_16x16x32_bf16 v[68:71], a[220:223], a[152:155], v[68:71]
    v_cvt_pk_bf16_f32 v33, v78, v79
    v_exp_f32 v88, v88
    v_mfma_f32_16x16x32_bf16 v[76:79], a[220:223], a[176:179], 0
    v_fma_f32 v73, v73, s28, v11
    v_fma_f32 v90, v90, s28, v13
    v_mfma_f32_16x16x32_bf16 v[76:79], a[216:219], a[172:175], v[76:79]
    v_exp_f32 v66, v66
    v_mfma_f32_16x16x32_bf16 v[76:79], a[212:215], a[168:171], v[76:79]
    v_cvt_pk_bf16_f32 v23, v66, v67
    v_fma_f32 v83, v83, s28, v12
    v_mfma_f32_16x16x32_bf16 v[84:87], a[212:215], a[192:195], 0
    v_exp_f32 v82, v82
    v_mfma_f32_16x16x32_bf16 v[84:87], a[216:219], a[196:199], v[84:87]
    v_exp_f32 v75, v75
    v_mfma_f32_16x16x32_bf16 v[84:87], a[220:223], a[200:203], v[84:87]
    s_waitcnt lgkmcnt(0)
    v_exp_f32 v83, v83
    v_mfma_f32_16x16x32_bf16 v[84:87], a[224:227], a[204:207], v[84:87]
    v_exp_f32 v58, v58
    v_mfma_f32_16x16x32_bf16 v[84:87], a[228:231], a[208:211], v[84:87]
    s_add_u32 s21, s21, 128
    v_exp_f32 v80, v80
    v_mfma_f32_16x16x32_bf16 v[84:87], a[232:235], v[92:95], v[84:87]
    v_accvgpr_read_b32 v107, a3
    v_subrev_u32 v103, 28672, v103
    v_mfma_f32_16x16x32_bf16 v[76:79], a[232:235], a[188:191], v[76:79]
    v_cvt_pk_bf16_f32 v29, v74, v75
    v_exp_f32 v56, v56
    v_mfma_f32_16x16x32_bf16 v[76:79], a[228:231], a[184:187], v[76:79]
    v_cvt_pk_bf16_f32 v17, v58, v59
    v_accvgpr_read_b32 v106, a2
    v_mfma_f32_16x16x32_bf16 v[76:79], a[224:227], a[180:183], v[76:79]
    v_cvt_pk_bf16_f32 v34, v80, v81
    v_cvt_pk_bf16_f32 v216, v216, v217
    v_mfma_f32_16x16x32_bf16 v[68:71], a[224:227], a[156:159], v[68:71]
    v_exp_f32 v73, v73
    v_mfma_f32_16x16x32_bf16 v[68:71], a[228:231], a[160:163], v[68:71]
    ds_read_b128 a[216:219], v1 offset:18432
    v_fma_f32 v85, v85, s28, v13
    v_mfma_f32_16x16x32_bf16 v[68:71], a[232:235], a[164:167], v[68:71]
    v_fma_f32 v84, v84, s28, v13
    v_cvt_pk_bf16_f32 v16, v56, v57
    v_mfma_f32_16x16x32_bf16 v[60:63], a[232:235], a[140:143], v[60:63]
    s_add_u32 m0, s22, 37888
    ds_read_b128 a[220:223], v0 offset:19456
    v_fma_f32 v86, v86, s28, v13
    v_mfma_f32_16x16x32_bf16 v[60:63], a[228:231], a[136:139], v[60:63]
    ds_read_b128 a[212:215], v0 offset:18432
    v_cvt_pk_bf16_f32 v35, v82, v83
    v_mfma_f32_16x16x32_bf16 v[60:63], a[224:227], a[132:135], v[60:63]
    buffer_load_dwordx4 v6, s[8:11], s21 offen lds
    v_mfma_f32_16x16x32_bf16 v[52:55], a[224:227], a[108:111], v[52:55]
    ds_read_b128 a[224:227], v1 offset:19456
    v_fma_f32 v76, v76, s28, v12
    v_mfma_f32_16x16x32_bf16 v[52:55], a[228:231], a[112:115], v[52:55]
    ds_read_b128 a[228:231], v0 offset:20480
    v_exp_f32 v90, v90
    v_exp_f32 v76, v76
    v_pk_mul_f32 v[164:165], v[164:165], v[102:103] op_sel_hi:[1,0]
    v_pk_mul_f32 v[166:167], v[166:167], v[102:103] op_sel_hi:[1,0]
    v_pk_mul_f32 v[120:121], v[120:121], v[48:49] op_sel_hi:[1,0]
    v_pk_mul_f32 v[160:161], v[160:161], v[102:103] op_sel_hi:[1,0]
    v_pk_mul_f32 v[214:215], v[214:215], v[50:51] op_sel_hi:[1,0]
    v_pk_mul_f32 v[162:163], v[162:163], v[102:103] op_sel_hi:[1,0]
    v_pk_mul_f32 v[110:111], v[110:111], v[100:101] op_sel_hi:[1,0]
    v_pk_mul_f32 v[152:153], v[152:153], v[48:49] op_sel_hi:[1,0]
    v_pk_mul_f32 v[122:123], v[122:123], v[48:49] op_sel_hi:[1,0]
    v_pk_mul_f32 v[128:129], v[128:129], v[48:49] op_sel_hi:[1,0]
    v_pk_mul_f32 v[148:149], v[148:149], v[48:49] op_sel_hi:[1,0]
    v_pk_mul_f32 v[106:107], v[106:107], v[8:9] op_sel_hi:[1,0]
    v_pk_mul_f32 v[114:115], v[114:115], v[48:49] op_sel_hi:[1,0]
    v_fma_f32 v77, v77, s28, v12
    v_pk_mul_f32 v[108:109], v[108:109], v[100:101] op_sel_hi:[1,0]
    v_fma_f32 v71, v71, s28, v11
    v_pk_mul_f32 v[118:119], v[118:119], v[48:49] op_sel_hi:[1,0]
    v_fma_f32 v89, v89, s28, v13
    v_pk_mul_f32 v[116:117], v[116:117], v[48:49] op_sel_hi:[1,0]
    v_pk_mul_f32 v[174:175], v[174:175], v[102:103] op_sel_hi:[1,0]
    v_pk_mul_f32 v[228:229], v[228:229], v[50:51] op_sel_hi:[1,0]
    v_pk_mul_f32 v[208:209], v[208:209], v[50:51] op_sel_hi:[1,0]
    v_pk_mul_f32 v[112:113], v[112:113], v[48:49] op_sel_hi:[1,0]
    v_pk_mul_f32 v[104:105], v[104:105], v[8:9] op_sel_hi:[1,0]
    v_pk_mul_f32 v[168:169], v[168:169], v[102:103] op_sel_hi:[1,0]
    v_cvt_pk_bf16_f32 v104, v104, v105
    v_fma_f32 v60, v60, s28, v10
    v_mfma_f32_16x16x32_bf16 v[52:55], a[232:235], a[116:119], v[52:55]
    s_waitcnt lgkmcnt(2)
    v_exp_f32 v71, v71
    v_mfma_f32_16x16x32_bf16 v[56:59], a[212:215], a[96:99], 0
    s_add_u32 s21, s21, 128
    v_fma_f32 v78, v78, s28, v12
    v_fma_f32 v87, v87, s28, v13
    v_mfma_f32_16x16x32_bf16 v[56:59], a[216:219], a[100:103], v[56:59]
    ds_read_b128 a[232:235], v1 offset:20480
    v_cvt_pk_bf16_f32 v41, v90, v91
    v_mfma_f32_16x16x32_bf16 v[56:59], a[220:223], a[104:107], v[56:59]
    s_add_u32 m0, s22, 38912
    v_cvt_pk_bf16_f32 v160, v160, v161
    v_cvt_pk_bf16_f32 v108, v108, v109
    v_mfma_f32_16x16x32_bf16 v[64:67], a[220:223], a[128:131], 0
    v_exp_f32 v89, v89
    v_mfma_f32_16x16x32_bf16 v[44:47], a[236:239], v[14:17], 0
    v_cvt_pk_bf16_f32 v105, v106, v107
    v_cvt_pk_bf16_f32 v112, v112, v113
    v_mfma_f32_16x16x32_bf16 v[64:67], a[216:219], a[124:127], v[64:67]
    v_cvt_pk_bf16_f32 v164, v164, v165
    v_cvt_pk_bf16_f32 v40, v88, v89
    v_mfma_f32_16x16x32_bf16 v[64:67], a[212:215], a[120:123], v[64:67]
    v_cvt_pk_bf16_f32 v28, v72, v73
    v_exp_f32 v78, v78
    v_mfma_f32_16x16x32_bf16 v[72:75], a[212:215], a[144:147], 0
    v_exp_f32 v60, v60
    v_exp_f32 v87, v87
    v_mfma_f32_16x16x32_bf16 v[72:75], a[216:219], a[148:151], v[72:75]
    buffer_load_dwordx4 v6, s[8:11], s21 offen lds
    v_cvt_pk_bf16_f32 v120, v120, v121
    v_mfma_f32_16x16x32_bf16 v[72:75], a[220:223], a[152:155], v[72:75]
    s_add_u32 s21, s21, 12032
    v_fma_f32 v54, v54, s28, v9
    v_accvgpr_read_b32 v107, a7
    v_mfma_f32_16x16x32_bf16 v[80:83], a[220:223], a[176:179], 0
    s_waitcnt vmcnt(6) lgkmcnt(0)
    v_cvt_pk_bf16_f32 v113, v114, v115
    v_cvt_pk_bf16_f32 v208, v208, v209
    v_mfma_f32_16x16x32_bf16 v[80:83], a[216:219], a[172:175], v[80:83]
    s_barrier
    v_mfma_f32_16x16x32_bf16 v[44:47], a[240:243], v[20:23], v[44:47]
    s_add_u32 m0, s22, 12288
    v_cvt_pk_bf16_f32 v109, v110, v111
    v_fma_f32 v53, v53, s28, v9
    v_mfma_f32_16x16x32_bf16 v[80:83], a[212:215], a[168:171], v[80:83]
    v_cvt_pk_bf16_f32 v116, v116, v117
    v_fma_f32 v69, v69, s28, v11
    v_mfma_f32_16x16x32_bf16 v[88:91], a[212:215], a[192:195], 0
    v_cvt_pk_bf16_f32 v168, v168, v169
    v_accvgpr_read_b32 v106, a6
    v_mfma_f32_16x16x32_bf16 v[88:91], a[216:219], a[196:199], v[88:91]
    v_cvt_pk_bf16_f32 v152, v152, v153
    v_cvt_pk_bf16_f32 v165, v166, v167
    v_mfma_f32_16x16x32_bf16 v[88:91], a[220:223], a[200:203], v[88:91]
    ds_read_b64_tr_b16 a[212:213], v2 offset:0
    v_cvt_pk_bf16_f32 v117, v118, v119
    v_fma_f32 v52, v52, s28, v9
    v_mfma_f32_16x16x32_bf16 v[88:91], a[224:227], a[204:207], v[88:91]
    ds_read_b64_tr_b16 a[214:215], v2 offset:6144
    v_cvt_pk_bf16_f32 v161, v162, v163
    v_fma_f32 v68, v68, s28, v11
    v_mfma_f32_16x16x32_bf16 v[88:91], a[228:231], a[208:211], v[88:91]
    v_exp_f32 v69, v69
    v_mfma_f32_16x16x32_bf16 v[88:91], a[232:235], v[92:95], v[88:91]
    ds_write2st64_b64 v101, v[112:113], v[160:161] offset0:0 offset1:12
    v_pk_mul_f32 v[210:211], v[210:211], v[50:51] op_sel_hi:[1,0]
    v_pk_mul_f32 v[212:213], v[212:213], v[50:51] op_sel_hi:[1,0]
    v_pk_mul_f32 v[220:221], v[220:221], v[50:51] op_sel_hi:[1,0]
    v_pk_mul_f32 v[124:125], v[124:125], v[48:49] op_sel_hi:[1,0]
    v_pk_mul_f32 v[236:237], v[236:237], v[50:51] op_sel_hi:[1,0]
    v_cvt_pk_bf16_f32 v212, v212, v213
    v_fma_f32 v55, v55, s28, v9
    v_pk_mul_f32 v[224:225], v[224:225], v[50:51] op_sel_hi:[1,0]
    v_exp_f32 v85, v85
    v_pk_mul_f32 v[106:107], v[106:107], v[8:9] op_sel_hi:[1,0]
    v_pk_mul_f32 v[150:151], v[150:151], v[48:49] op_sel_hi:[1,0]
    v_pk_mul_f32 v[192:193], v[192:193], v[102:103] op_sel_hi:[1,0]
    v_pk_mul_f32 v[170:171], v[170:171], v[102:103] op_sel_hi:[1,0]
    v_cvt_pk_bf16_f32 v209, v210, v211
    v_cvt_pk_bf16_f32 v220, v220, v221
    v_pk_mul_f32 v[138:139], v[138:139], v[48:49] op_sel_hi:[1,0]
    v_pk_mul_f32 v[172:173], v[172:173], v[102:103] op_sel_hi:[1,0]
    v_cvt_pk_bf16_f32 v128, v128, v129
    v_fma_f32 v79, v79, s28, v12
    v_mfma_f32_16x16x32_bf16 v[80:83], a[232:235], a[188:191], v[80:83]
    v_fma_f32 v70, v70, s28, v11
    v_fma_f32 v62, v62, s28, v10
    v_mfma_f32_16x16x32_bf16 v[80:83], a[228:231], a[184:187], v[80:83]
    v_exp_f32 v68, v68
    v_mfma_f32_16x16x32_bf16 v[80:83], a[224:227], a[180:183], v[80:83]
    buffer_load_dwordx4 v6, s[4:7], s20 offen lds
    v_mfma_f32_16x16x32_bf16 v[72:75], a[224:227], a[156:159], v[72:75]
    ds_write2st64_b64 v101, v[208:209], v[104:105] offset0:24 offset1:36
    v_accvgpr_read_b32 v110, a54
    v_mfma_f32_16x16x32_bf16 v[72:75], a[228:231], a[160:163], v[72:75]
    v_cvt_pk_bf16_f32 v30, v68, v69
    v_fma_f32 v63, v63, s28, v10
    v_mfma_f32_16x16x32_bf16 v[72:75], a[232:235], a[164:167], v[72:75]
    ds_read_b64_tr_b16 a[216:217], v3 offset:0
    v_accvgpr_read_b32 v104, a4
    v_mfma_f32_16x16x32_bf16 v[64:67], a[232:235], a[140:143], v[64:67]
    v_exp_f32 v77, v77
    v_mfma_f32_16x16x32_bf16 v[44:47], a[244:247], v[26:29], v[44:47]
    v_fma_f32 v61, v61, s28, v10
    v_cvt_pk_bf16_f32 v224, v224, v225
    v_mfma_f32_16x16x32_bf16 v[64:67], a[228:231], a[136:139], v[64:67]
    ds_read_b64_tr_b16 a[218:219], v3 offset:6144
    v_cvt_pk_bf16_f32 v148, v148, v149
    v_mfma_f32_16x16x32_bf16 v[64:67], a[224:227], a[132:135], v[64:67]
    ds_read_b64_tr_b16 a[220:221], v4 offset:0
    v_fma_f32 v90, v90, s28, v13
    v_exp_f32 v79, v79
    v_mfma_f32_16x16x32_bf16 v[44:47], a[248:251], v[32:35], v[44:47]
    ds_write_b64 v101, v[108:109] offset:24576
    v_mfma_f32_16x16x32_bf16 v[56:59], a[224:227], a[108:111], v[56:59]
    ds_read_b64_tr_b16 a[222:223], v4 offset:6144
    v_accvgpr_read_b32 v111, a55
    v_mfma_f32_16x16x32_bf16 v[56:59], a[228:231], a[112:115], v[56:59]
    v_accvgpr_read_b32 v109, a53
    v_accvgpr_read_b32 v108, a52
    v_cvt_pk_bf16_f32 v228, v228, v229
    v_exp_f32 v61, v61
    v_pk_mul_f32 v[110:111], v[110:111], v[100:101] op_sel_hi:[1,0]
    v_cvt_pk_bf16_f32 v169, v170, v171
    v_accvgpr_read_b32 v105, a5
    v_fma_f32 v80, v80, s28, v12
    v_pk_mul_f32 v[108:109], v[108:109], v[100:101] op_sel_hi:[1,0]
    v_pk_mul_f32 v[176:177], v[176:177], v[102:103] op_sel_hi:[1,0]
    v_pk_mul_f32 v[254:255], v[254:255], v[50:51] op_sel_hi:[1,0]
    v_pk_mul_f32 v[130:131], v[130:131], v[48:49] op_sel_hi:[1,0]
    v_cvt_pk_bf16_f32 v108, v108, v109
    v_pk_mul_f32 v[240:241], v[240:241], v[50:51] op_sel_hi:[1,0]
    v_pk_mul_f32 v[180:181], v[180:181], v[102:103] op_sel_hi:[1,0]
    v_pk_mul_f32 v[198:199], v[198:199], v[102:103] op_sel_hi:[1,0]
    v_cvt_pk_bf16_f32 v109, v110, v111
    v_pk_mul_f32 v[104:105], v[104:105], v[8:9] op_sel_hi:[1,0]
    v_xor_b32 v101, 32, v101
    v_pk_mul_f32 v[196:197], v[196:197], v[102:103] op_sel_hi:[1,0]
    v_fma_f32 v82, v82, s28, v12
    v_pk_mul_f32 v[136:137], v[136:137], v[48:49] op_sel_hi:[1,0]
    v_pk_mul_f32 v[242:243], v[242:243], v[50:51] op_sel_hi:[1,0]
    v_pk_mul_f32 v[218:219], v[218:219], v[50:51] op_sel_hi:[1,0]
    v_cvt_pk_bf16_f32 v104, v104, v105
    v_pk_mul_f32 v[222:223], v[222:223], v[50:51] op_sel_hi:[1,0]
    v_pk_mul_f32 v[182:183], v[182:183], v[102:103] op_sel_hi:[1,0]
    v_fma_f32 v65, v65, s28, v10
    v_accvgpr_read_b32 v111, a59
    v_cvt_pk_bf16_f32 v172, v172, v173
    v_cvt_pk_bf16_f32 v192, v192, v193
    v_mfma_f32_16x16x32_bf16 v[56:59], a[232:235], a[116:119], v[56:59]
    s_waitcnt lgkmcnt(1)
    ds_read_b64_tr_b16 a[232:233], v3 offset:1024
    v_cvt_pk_bf16_f32 v105, v106, v107
    v_mfma_f32_16x16x32_bf16 v[112:115], a[212:215], v[14:17], 0
    s_add_u32 s20, s20, 128
    ds_write2st64_b64 v101, v[116:117], v[164:165] offset0:0 offset1:12
    v_pk_mul_f32 v[252:253], v[252:253], v[50:51] op_sel_hi:[1,0]
    v_pk_mul_f32 v[126:127], v[126:127], v[48:49] op_sel_hi:[1,0]
    v_cvt_pk_bf16_f32 v213, v214, v215
    v_cvt_pk_bf16_f32 v180, v180, v181
    v_mfma_f32_16x16x32_bf16 v[116:119], a[216:219], v[14:17], 0
    ds_write2st64_b64 v101, v[212:213], v[104:105] offset0:24 offset1:36
    v_pk_mul_f32 v[132:133], v[132:133], v[48:49] op_sel_hi:[1,0]
    v_fma_f32 v89, v89, s28, v13
    v_accvgpr_read_b32 v107, a11
    v_fma_f32 v83, v83, s28, v12
    v_fma_f32 v73, v73, s28, v11
    v_mfma_f32_16x16x32_bf16 v[164:167], a[216:219], v[20:23], 0
    ds_read_b64_tr_b16 a[224:225], v5 offset:0
    v_accvgpr_read_b32 v110, a58
    v_cvt_pk_bf16_f32 v129, v130, v131
    v_mfma_f32_16x16x32_bf16 v[160:163], a[212:215], v[20:23], 0
    ds_write_b64 v101, v[108:109] offset:24576
    v_exp_f32 v90, v90
    v_cvt_pk_bf16_f32 v252, v252, v253
    v_pk_mul_f32 v[232:233], v[232:233], v[50:51] op_sel_hi:[1,0]
    v_cvt_pk_bf16_f32 v217, v218, v219
    v_cvt_pk_bf16_f32 v196, v196, v197
    v_xor_b32 v101, 96, v101
    v_pk_mul_f32 v[204:205], v[204:205], v[102:103] op_sel_hi:[1,0]
    v_cvt_pk_bf16_f32 v236, v236, v237
    v_pk_mul_f32 v[184:185], v[184:185], v[102:103] op_sel_hi:[1,0]
    v_cvt_pk_bf16_f32 v124, v124, v125
    v_accvgpr_read_b32 v106, a10
    v_mfma_f32_16x16x32_bf16 v[208:211], a[212:215], v[26:29], 0
    ds_read_b64_tr_b16 a[230:231], v2 offset:7168
    v_accvgpr_read_b32 v109, a57
    v_accvgpr_read_b32 v108, a56
    v_accvgpr_read_b32 v105, a9
    v_cvt_pk_bf16_f32 v121, v122, v123
    v_pk_mul_f32 v[110:111], v[110:111], v[100:101] op_sel_hi:[1,0]
    v_pk_mul_f32 v[108:109], v[108:109], v[100:101] op_sel_hi:[1,0]
    v_cvt_pk_bf16_f32 v221, v222, v223
    v_fma_f32 v57, v57, s28, v9
    v_pk_mul_f32 v[140:141], v[140:141], v[48:49] op_sel_hi:[1,0]
    v_cvt_pk_bf16_f32 v184, v184, v185
    v_accvgpr_read_b32 v104, a8
    v_pk_mul_f32 v[226:227], v[226:227], v[50:51] op_sel_hi:[1,0]
    v_pk_mul_f32 v[200:201], v[200:201], v[102:103] op_sel_hi:[1,0]
    v_pk_mul_f32 v[146:147], v[146:147], v[48:49] op_sel_hi:[1,0]
    v_pk_mul_f32 v[106:107], v[106:107], v[8:9] op_sel_hi:[1,0]
    v_pk_mul_f32 v[230:231], v[230:231], v[50:51] op_sel_hi:[1,0]
    v_cvt_pk_bf16_f32 v232, v232, v233
    v_pk_mul_f32 v[104:105], v[104:105], v[8:9] op_sel_hi:[1,0]
    v_fma_f32 v81, v81, s28, v12
    v_cvt_pk_bf16_f32 v108, v108, v109
    v_pk_mul_f32 v[142:143], v[142:143], v[48:49] op_sel_hi:[1,0]
    v_cvt_pk_bf16_f32 v104, v104, v105
    v_exp_f32 v53, v53
    v_cvt_pk_bf16_f32 v225, v226, v227
    v_mfma_f32_16x16x32_bf16 v[212:215], a[216:219], v[26:29], 0
    s_add_u32 m0, s22, 13312
    v_cvt_pk_bf16_f32 v176, v176, v177
    v_cvt_pk_bf16_f32 v105, v106, v107
    v_mfma_f32_16x16x32_bf16 a[4:7], a[216:219], v[32:35], 0
    ds_read_b64_tr_b16 a[228:229], v2 offset:1024
    v_cvt_pk_bf16_f32 v125, v126, v127
    v_cvt_pk_bf16_f32 v173, v174, v175
    v_mfma_f32_16x16x32_bf16 a[0:3], a[212:215], v[32:35], 0
    ds_write2st64_b64 v101, v[120:121], v[168:169] offset0:0 offset1:12
    v_mfma_f32_16x16x32_bf16 a[48:51], a[212:215], v[38:41], 0
    ds_read_b64_tr_b16 a[234:235], v3 offset:7168
    v_cvt_pk_bf16_f32 v109, v110, v111
    v_mfma_f32_16x16x32_bf16 v[44:47], a[252:255], v[38:41], v[44:47]
    ds_write2st64_b64 v101, v[216:217], v[104:105] offset0:24 offset1:36
    v_mfma_f32_16x16x32_bf16 a[52:55], a[216:219], v[38:41], 0
    s_waitcnt lgkmcnt(4)
    ds_read_b64_tr_b16 a[226:227], v5 offset:6144
    v_accvgpr_read_b32 v104, a12
    v_accvgpr_read_b32 v111, a63
    v_mfma_f32_16x16x32_bf16 a[56:59], a[220:223], v[38:41], 0
    buffer_load_dwordx4 v6, s[4:7], s20 offen lds
    ds_write_b64 v101, v[108:109] offset:24576
    v_accvgpr_read_b32 v105, a13
    v_pk_mul_f32 v[144:145], v[144:145], v[48:49] op_sel_hi:[1,0]
    v_accvgpr_read_b32 v108, a60
    v_pk_mul_f32 v[104:105], v[104:105], v[8:9] op_sel_hi:[1,0]
    v_pk_mul_f32 v[178:179], v[178:179], v[102:103] op_sel_hi:[1,0]
    v_exp_f32 v70, v70
    v_exp_f32 v52, v52
    v_accvgpr_read_b32 v107, a15
    v_accvgpr_read_b32 v109, a61
    v_pk_mul_f32 v[134:135], v[134:135], v[48:49] op_sel_hi:[1,0]
    v_pk_mul_f32 v[158:159], v[158:159], v[48:49] op_sel_hi:[1,0]
    v_xor_b32 v101, 32, v101
    v_cvt_pk_bf16_f32 v177, v178, v179
    v_pk_mul_f32 v[244:245], v[244:245], v[50:51] op_sel_hi:[1,0]
    v_cvt_pk_bf16_f32 v104, v104, v105
    v_cvt_pk_bf16_f32 v132, v132, v133
    v_accvgpr_read_b32 v110, a62
    v_exp_f32 v84, v84
    v_accvgpr_read_b32 v106, a14
    v_cvt_pk_bf16_f32 v136, v136, v137
    v_cvt_pk_bf16_f32 v240, v240, v241
    v_pk_mul_f32 v[108:109], v[108:109], v[100:101] op_sel_hi:[1,0]
    v_pk_mul_f32 v[106:107], v[106:107], v[8:9] op_sel_hi:[1,0]
    v_fma_f32 v66, v66, s28, v10
    v_cvt_pk_bf16_f32 v105, v106, v107
    v_cvt_pk_bf16_f32 v181, v182, v183
    s_waitcnt lgkmcnt(1)
    v_mfma_f32_16x16x32_bf16 a[60:63], a[224:227], v[38:41], 0
    ds_write2st64_b64 v101, v[124:125], v[172:173] offset0:0 offset1:12
    v_cvt_pk_bf16_f32 v108, v108, v109
    v_mfma_f32_16x16x32_bf16 a[12:15], a[224:227], v[32:35], 0
    s_add_u32 s20, s20, 128
    ds_write2st64_b64 v101, v[220:221], v[104:105] offset0:24 offset1:36
    v_fma_f32 v72, v72, s28, v11
    v_pk_mul_f32 v[186:187], v[186:187], v[102:103] op_sel_hi:[1,0]
    v_accvgpr_read_b32 v105, a17
    v_accvgpr_read_b32 v106, a18
    v_pk_mul_f32 v[110:111], v[110:111], v[100:101] op_sel_hi:[1,0]
    v_fma_f32 v88, v88, s28, v13
    v_accvgpr_read_b32 v107, a19
    v_exp_f32 v62, v62
    v_cvt_pk_bf16_f32 v109, v110, v111
    v_mfma_f32_16x16x32_bf16 a[8:11], a[220:223], v[32:35], 0
    ds_write_b64 v101, v[108:109] offset:24576
    v_accvgpr_read_b32 v110, a66
    v_accvgpr_read_b32 v104, a16
    v_cvt_pk_bf16_f32 v140, v140, v141
    v_pk_mul_f32 v[104:105], v[104:105], v[8:9] op_sel_hi:[1,0]
    v_accvgpr_read_b32 v111, a67
    v_accvgpr_read_b32 v109, a65
    v_pk_mul_f32 v[190:191], v[190:191], v[102:103] op_sel_hi:[1,0]
    v_fma_f32 v64, v64, s28, v10
    v_accvgpr_read_b32 v108, a64
    v_cvt_pk_bf16_f32 v133, v134, v135
    v_pk_mul_f32 v[110:111], v[110:111], v[100:101] op_sel_hi:[1,0]
    v_pk_mul_f32 v[154:155], v[154:155], v[48:49] op_sel_hi:[1,0]
    v_pk_mul_f32 v[106:107], v[106:107], v[8:9] op_sel_hi:[1,0]
    v_pk_mul_f32 v[108:109], v[108:109], v[100:101] op_sel_hi:[1,0]
    v_pk_mul_f32 v[234:235], v[234:235], v[50:51] op_sel_hi:[1,0]
    v_cvt_pk_bf16_f32 v229, v230, v231
    v_pk_mul_f32 v[248:249], v[248:249], v[50:51] op_sel_hi:[1,0]
    v_cvt_pk_bf16_f32 v108, v108, v109
    v_cvt_pk_bf16_f32 v104, v104, v105
    v_xor_b32 v101, 96, v101
    v_mfma_f32_16x16x32_bf16 v[216:219], a[220:223], v[26:29], 0
    ds_read_b128 v[96:99], v103 offset:0
    v_fma_f32 v59, v59, s28, v9
    v_cvt_pk_bf16_f32 v137, v138, v139
    v_mfma_f32_16x16x32_bf16 v[220:223], a[224:227], v[26:29], 0
    ds_read_b64_tr_b16 a[218:219], v5 offset:7168
    ds_read_b64_tr_b16 a[216:217], v5 offset:1024
    v_cvt_pk_bf16_f32 v105, v106, v107
    v_mfma_f32_16x16x32_bf16 v[172:175], a[224:227], v[20:23], 0
    ds_write2st64_b64 v101, v[128:129], v[176:177] offset0:4 offset1:16
    v_mfma_f32_16x16x32_bf16 v[168:171], a[220:223], v[20:23], 0
    ds_write2st64_b64 v101, v[224:225], v[104:105] offset0:28 offset1:40
    v_cvt_pk_bf16_f32 v109, v110, v111
    v_mfma_f32_16x16x32_bf16 v[120:123], a[220:223], v[14:17], 0
    ds_write_b64 v101, v[108:109] offset:26624
    v_accvgpr_read_b32 v111, a71
    v_mfma_f32_16x16x32_bf16 v[124:127], a[224:227], v[14:17], 0
    s_add_u32 m0, s22, 14336
    ds_read_b64_tr_b16 a[214:215], v4 offset:7168
    v_accvgpr_read_b32 v107, a23
    v_xor_b32 v101, 32, v101
    v_accvgpr_read_b32 v104, a20
    v_mfma_f32_16x16x32_bf16 v[128:131], a[228:231], v[14:17], 0
    ds_write2st64_b64 v101, v[132:133], v[180:181] offset0:4 offset1:16
    v_accvgpr_read_b32 v105, a21
    v_mfma_f32_16x16x32_bf16 v[132:135], a[232:235], v[14:17], 0
    ds_read_b64_tr_b16 a[212:213], v4 offset:1024
    v_accvgpr_read_b32 v109, a69
    v_accvgpr_read_b32 v106, a22
    v_accvgpr_read_b32 v108, a68
    v_mfma_f32_16x16x32_bf16 v[180:183], a[232:235], v[20:23], 0
    ds_read_b64_tr_b16 a[222:223], v2 offset:8192
    buffer_load_dwordx4 v6, s[4:7], s20 offen lds
    ds_read_b64_tr_b16 a[224:225], v3 offset:2048
    v_cvt_pk_bf16_f32 v18, v52, v53
    v_pk_mul_f32 v[106:107], v[106:107], v[8:9] op_sel_hi:[1,0]
    v_pk_mul_f32 v[104:105], v[104:105], v[8:9] op_sel_hi:[1,0]
    v_pk_mul_f32 v[108:109], v[108:109], v[100:101] op_sel_hi:[1,0]
    v_cvt_pk_bf16_f32 v31, v70, v71
    v_cvt_pk_bf16_f32 v241, v242, v243
    v_cvt_pk_bf16_f32 v233, v234, v235
    v_exp_f32 v63, v63
    v_pk_mul_f32 v[188:189], v[188:189], v[102:103] op_sel_hi:[1,0]
    v_cvt_pk_bf16_f32 v104, v104, v105
    v_cvt_pk_bf16_f32 v108, v108, v109
    v_exp_f32 v73, v73
    v_cvt_pk_bf16_f32 v105, v106, v107
    v_mfma_f32_16x16x32_bf16 v[176:179], a[228:231], v[20:23], 0
    ds_write2st64_b64 v101, v[228:229], v[104:105] offset0:28 offset1:40
    v_accvgpr_read_b32 v110, a70
    v_pk_mul_f32 v[110:111], v[110:111], v[100:101] op_sel_hi:[1,0]
    v_pk_mul_f32 v[194:195], v[194:195], v[102:103] op_sel_hi:[1,0]
    v_accvgpr_read_b32 v107, a27
    v_pk_mul_f32 v[238:239], v[238:239], v[50:51] op_sel_hi:[1,0]
    v_accvgpr_read_b32 v105, a25
    v_cvt_pk_bf16_f32 v185, v186, v187
    v_cvt_pk_bf16_f32 v193, v194, v195
    v_pk_mul_f32 v[246:247], v[246:247], v[50:51] op_sel_hi:[1,0]
    v_cvt_pk_bf16_f32 v109, v110, v111
    v_accvgpr_read_b32 v104, a24
    v_mfma_f32_16x16x32_bf16 v[224:227], a[228:231], v[26:29], 0
    s_add_u32 s20, s20, 12032
    ds_read_b64_tr_b16 a[226:227], v3 offset:8192
    v_accvgpr_read_b32 v106, a26
    v_mfma_f32_16x16x32_bf16 v[228:231], a[232:235], v[26:29], 0
    s_waitcnt lgkmcnt(2)
    buffer_store_dwordx4 v[96:99], v6, s[16:19], s67 offen offset:0 nt
    ds_write_b64 v101, v[108:109] offset:26624
    v_pk_mul_f32 v[156:157], v[156:157], v[48:49] op_sel_hi:[1,0]
    v_xor_b32 v101, 96, v101
    v_pk_mul_f32 v[206:207], v[206:207], v[102:103] op_sel_hi:[1,0]
    v_pk_mul_f32 v[106:107], v[106:107], v[8:9] op_sel_hi:[1,0]
    v_pk_mul_f32 v[250:251], v[250:251], v[50:51] op_sel_hi:[1,0]
    v_accvgpr_read_b32 v110, a74
    v_accvgpr_read_b32 v109, a73
    v_pk_mul_f32 v[104:105], v[104:105], v[8:9] op_sel_hi:[1,0]
    v_accvgpr_read_b32 v108, a72
    v_pk_mul_f32 v[108:109], v[108:109], v[100:101] op_sel_hi:[1,0]
    v_cvt_pk_bf16_f32 v248, v248, v249
    v_cvt_pk_bf16_f32 v108, v108, v109
    v_accvgpr_read_b32 v111, a75
    v_cvt_pk_bf16_f32 v144, v144, v145
    v_mfma_f32_16x16x32_bf16 a[20:23], a[232:235], v[32:35], 0
    ds_read_b128 v[96:99], v103 offset:1024
    v_cvt_pk_bf16_f32 v141, v142, v143
    v_cvt_pk_bf16_f32 v104, v104, v105
    v_fma_f32 v74, v74, s28, v11
    v_cvt_pk_bf16_f32 v105, v106, v107
    v_cvt_pk_bf16_f32 v145, v146, v147
    v_mfma_f32_16x16x32_bf16 a[16:19], a[228:231], v[32:35], 0
    ds_write2st64_b64 v101, v[136:137], v[184:185] offset0:4 offset1:16
    v_exp_f32 v55, v55
    v_pk_mul_f32 v[110:111], v[110:111], v[100:101] op_sel_hi:[1,0]
    v_cvt_pk_bf16_f32 v188, v188, v189
    v_cvt_pk_bf16_f32 v109, v110, v111
    v_cvt_pk_bf16_f32 v149, v150, v151
    v_mfma_f32_16x16x32_bf16 a[64:67], a[228:231], v[38:41], 0
    ds_write2st64_b64 v101, v[232:233], v[104:105] offset0:28 offset1:40
    v_mfma_f32_16x16x32_bf16 a[68:71], a[232:235], v[38:41], 0
    ds_write_b64 v101, v[108:109] offset:26624
    v_accvgpr_read_b32 v110, a78
    v_exp_f32 v86, v86
    v_mfma_f32_16x16x32_bf16 a[72:75], a[212:215], v[38:41], 0
    ds_read_b64_tr_b16 a[220:221], v2 offset:2048
    v_accvgpr_read_b32 v109, a77
    v_accvgpr_read_b32 v106, a30
    v_accvgpr_read_b32 v105, a29
    v_xor_b32 v101, 32, v101
    v_pk_mul_f32 v[202:203], v[202:203], v[102:103] op_sel_hi:[1,0]
    v_cvt_pk_bf16_f32 v237, v238, v239
    v_accvgpr_read_b32 v107, a31
    v_accvgpr_read_b32 v104, a28
    v_accvgpr_read_b32 v111, a79
    v_pk_mul_f32 v[106:107], v[106:107], v[8:9] op_sel_hi:[1,0]
    v_cvt_pk_bf16_f32 v189, v190, v191
    v_accvgpr_read_b32 v108, a76
    v_mfma_f32_16x16x32_bf16 a[76:79], a[216:219], v[38:41], 0
    s_add_u32 s39, s39, 12288
    ds_read_b64_tr_b16 a[232:233], v5 offset:2048
    ds_read_b64_tr_b16 a[234:235], v5 offset:8192
    v_cvt_pk_bf16_f32 v156, v156, v157
    v_mfma_f32_16x16x32_bf16 a[28:31], a[216:219], v[32:35], 0
    ds_read_b64_tr_b16 a[228:229], v4 offset:2048
    ds_read_b64_tr_b16 a[230:231], v4 offset:8192
    v_mfma_f32_16x16x32_bf16 a[24:27], a[212:215], v[32:35], 0
    ds_write2st64_b64 v101, v[140:141], v[188:189] offset0:4 offset1:16
    v_pk_mul_f32 v[104:105], v[104:105], v[8:9] op_sel_hi:[1,0]
    v_pk_mul_f32 v[108:109], v[108:109], v[100:101] op_sel_hi:[1,0]
    v_pk_mul_f32 v[110:111], v[110:111], v[100:101] op_sel_hi:[1,0]
    v_cvt_pk_bf16_f32 v197, v198, v199
    v_cvt_pk_bf16_f32 v104, v104, v105
    v_cvt_pk_bf16_f32 v105, v106, v107
    v_cvt_pk_bf16_f32 v153, v154, v155
    v_cvt_pk_bf16_f32 v108, v108, v109
    v_cvt_pk_bf16_f32 v25, v62, v63
    v_mfma_f32_16x16x32_bf16 v[232:235], a[212:215], v[26:29], 0
    ds_write2st64_b64 v101, v[236:237], v[104:105] offset0:28 offset1:40
    v_cvt_pk_bf16_f32 v109, v110, v111
    v_accvgpr_read_b32 v105, a33
    v_mfma_f32_16x16x32_bf16 v[236:239], a[216:219], v[26:29], 0
    ds_write_b64 v101, v[108:109] offset:26624
    v_accvgpr_read_b32 v109, a81
    v_accvgpr_read_b32 v108, a80
    v_accvgpr_read_b32 v104, a32
    v_accvgpr_read_b32 v110, a82
    v_accvgpr_read_b32 v107, a35
    v_cvt_pk_bf16_f32 v244, v244, v245
    v_accvgpr_read_b32 v111, a83
    s_waitcnt vmcnt(7) lgkmcnt(3)
    v_accvgpr_read_b32 v106, a34
    v_pk_mul_f32 v[104:105], v[104:105], v[8:9] op_sel_hi:[1,0]
    v_xor_b32 v101, 96, v101
    v_pk_mul_f32 v[110:111], v[110:111], v[100:101] op_sel_hi:[1,0]
    v_cvt_pk_bf16_f32 v36, v76, v77
    v_pk_mul_f32 v[108:109], v[108:109], v[100:101] op_sel_hi:[1,0]
    v_pk_mul_f32 v[106:107], v[106:107], v[8:9] op_sel_hi:[1,0]
    v_fma_f32 v56, v56, s28, v9
    v_cvt_pk_bf16_f32 v108, v108, v109
    v_cvt_pk_bf16_f32 v104, v104, v105
    v_mfma_f32_16x16x32_bf16 v[188:191], a[216:219], v[20:23], 0
    buffer_store_dwordx4 v[96:99], v7, s[16:19], s67 offen offset:0 nt
    s_barrier
    ds_write2st64_b64 v101, v[144:145], v[192:193] offset0:8 offset1:20
    v_cvt_pk_bf16_f32 v204, v204, v205
    v_cvt_pk_bf16_f32 v105, v106, v107
    v_mfma_f32_16x16x32_bf16 v[184:187], a[212:215], v[20:23], 0
    s_add_u32 m0, s22, 24576
    ds_write2st64_b64 v101, v[240:241], v[104:105] offset0:32 offset1:44
    v_fma_f32 v75, v75, s28, v11
    v_cvt_pk_bf16_f32 v109, v110, v111
    v_mfma_f32_16x16x32_bf16 v[136:139], a[212:215], v[14:17], 0
    ds_write_b64 v101, v[108:109] offset:0
    v_cvt_pk_bf16_f32 v249, v250, v251
    v_accvgpr_read_b32 v108, a84
    v_mfma_f32_16x16x32_bf16 v[140:143], a[216:219], v[14:17], 0
    v_accvgpr_read_b32 v105, a37
    v_accvgpr_read_b32 v106, a38
    v_xor_b32 v101, 32, v101
    v_accvgpr_read_b32 v109, a85
    v_accvgpr_read_b32 v110, a86
    v_accvgpr_read_b32 v107, a39
    v_fma_f32 v58, v58, s28, v9
    v_accvgpr_read_b32 v104, a36
    v_pk_mul_f32 v[108:109], v[108:109], v[100:101] op_sel_hi:[1,0]
    v_accvgpr_read_b32 v111, a87
    v_pk_mul_f32 v[104:105], v[104:105], v[8:9] op_sel_hi:[1,0]
    v_pk_mul_f32 v[106:107], v[106:107], v[8:9] op_sel_hi:[1,0]
    v_cvt_pk_bf16_f32 v108, v108, v109
    v_cvt_pk_bf16_f32 v104, v104, v105
    v_cvt_pk_bf16_f32 v253, v254, v255
    v_pk_mul_f32 v[110:111], v[110:111], v[100:101] op_sel_hi:[1,0]
    v_cvt_pk_bf16_f32 v105, v106, v107
    v_cvt_pk_bf16_f32 v245, v246, v247
    v_cvt_pk_bf16_f32 v200, v200, v201
    v_mfma_f32_16x16x32_bf16 v[144:147], a[220:223], v[14:17], 0
    ds_write2st64_b64 v101, v[148:149], v[196:197] offset0:8 offset1:20
    v_mfma_f32_16x16x32_bf16 v[148:151], a[224:227], v[14:17], 0
    buffer_load_dwordx4 v6, s[8:11], s21 offen lds
    v_mfma_f32_16x16x32_bf16 v[196:199], a[224:227], v[20:23], 0
    ds_read_b128 a[216:219], v1 offset:0
    v_cvt_pk_bf16_f32 v109, v110, v111
    v_mfma_f32_16x16x32_bf16 v[192:195], a[220:223], v[20:23], 0
    ds_write2st64_b64 v101, v[244:245], v[104:105] offset0:32 offset1:44
    v_accvgpr_read_b32 v111, a91
    v_accvgpr_read_b32 v104, a40
    v_mfma_f32_16x16x32_bf16 v[240:243], a[220:223], v[26:29], 0
    ds_read_b128 v[96:99], v103 offset:2048
    v_cvt_pk_bf16_f32 v201, v202, v203
    v_accvgpr_read_b32 v107, a43
    v_mfma_f32_16x16x32_bf16 v[244:247], a[224:227], v[26:29], 0
    s_add_u32 s21, s21, 128
    ds_write_b64 v101, v[108:109] offset:0
    v_accvgpr_read_b32 v105, a41
    v_accvgpr_read_b32 v110, a90
    v_pk_mul_f32 v[110:111], v[110:111], v[100:101] op_sel_hi:[1,0]
    v_pk_mul_f32 v[104:105], v[104:105], v[8:9] op_sel_hi:[1,0]
    v_accvgpr_read_b32 v106, a42
    v_cvt_pk_bf16_f32 v104, v104, v105
    v_pk_mul_f32 v[106:107], v[106:107], v[8:9] op_sel_hi:[1,0]
    v_xor_b32 v101, 96, v101
    v_accvgpr_read_b32 v108, a88
    v_cvt_pk_bf16_f32 v105, v106, v107
    v_accvgpr_read_b32 v109, a89
    v_mfma_f32_16x16x32_bf16 a[36:39], a[224:227], v[32:35], 0
    s_add_u32 m0, s22, 25600
    ds_write2st64_b64 v101, v[152:153], v[200:201] offset0:8 offset1:20
    v_pk_mul_f32 v[108:109], v[108:109], v[100:101] op_sel_hi:[1,0]
    v_accvgpr_read_b32 v106, a46
    v_cvt_pk_bf16_f32 v108, v108, v109
    v_accvgpr_read_b32 v107, a47
    v_mfma_f32_16x16x32_bf16 a[32:35], a[220:223], v[32:35], 0
    ds_write2st64_b64 v101, v[248:249], v[104:105] offset0:32 offset1:44
    v_cvt_pk_bf16_f32 v109, v110, v111
    v_mfma_f32_16x16x32_bf16 a[80:83], a[220:223], v[38:41], 0
    ds_read_b128 a[212:215], v0 offset:0
    buffer_load_dwordx4 v6, s[8:11], s21 offen lds
    v_mfma_f32_16x16x32_bf16 a[84:87], a[224:227], v[38:41], 0
    s_add_u32 s21, s21, 128
    ds_write_b64 v101, v[108:109] offset:0
    v_accvgpr_read_b32 v111, a95
    v_accvgpr_read_b32 v108, a92
    v_pk_mul_f32 v[106:107], v[106:107], v[8:9] op_sel_hi:[1,0]
    v_cvt_pk_bf16_f32 v42, v84, v85
    v_accvgpr_read_b32 v109, a93
    v_mfma_f32_16x16x32_bf16 a[88:91], a[228:231], v[38:41], 0
    v_cvt_pk_bf16_f32 v24, v60, v61
    v_accvgpr_read_b32 v110, a94
    v_accvgpr_read_b32 v104, a44
    v_cvt_pk_bf16_f32 v205, v206, v207
    v_accvgpr_read_b32 v105, a45
    v_pk_mul_f32 v[104:105], v[104:105], v[8:9] op_sel_hi:[1,0]
    v_pk_mul_f32 v[108:109], v[108:109], v[100:101] op_sel_hi:[1,0]
    v_pk_mul_f32 v[110:111], v[110:111], v[100:101] op_sel_hi:[1,0]
    v_cvt_pk_bf16_f32 v104, v104, v105
    v_cvt_pk_bf16_f32 v105, v106, v107
    v_cvt_pk_bf16_f32 v157, v158, v159
    v_mfma_f32_16x16x32_bf16 a[92:95], a[232:235], v[38:41], 0
    ds_read_b128 a[220:223], v0 offset:1024
    v_cvt_pk_bf16_f32 v37, v78, v79
    v_mfma_f32_16x16x32_bf16 a[44:47], a[232:235], v[32:35], 0
    v_exp_f32 v57, v57
    v_xor_b32 v101, 32, v101
    v_mfma_f32_16x16x32_bf16 a[40:43], a[228:231], v[32:35], 0
    s_add_u32 m0, s22, 26624
    ds_write2st64_b64 v101, v[156:157], v[204:205] offset0:8 offset1:20
    v_mfma_f32_16x16x32_bf16 v[248:251], a[228:231], v[26:29], 0
    ds_write2st64_b64 v101, v[252:253], v[104:105] offset0:32 offset1:44
    v_mfma_f32_16x16x32_bf16 v[252:255], a[232:235], v[26:29], 0
    buffer_load_dwordx4 v6, s[8:11], s21 offen lds
    v_mfma_f32_16x16x32_bf16 v[204:207], a[232:235], v[20:23], 0
    s_add_u32 s21, s21, 12032
    v_exp_f32 v56, v56
    v_mfma_f32_16x16x32_bf16 v[200:203], a[228:231], v[20:23], 0
    s_add_u32 s56, s67, 128
    v_exp_f32 v54, v54
    v_mfma_f32_16x16x32_bf16 v[152:155], a[228:231], v[14:17], 0
    v_cvt_pk_bf16_f32 v19, v54, v55
    v_exp_f32 v58, v58
    v_mfma_f32_16x16x32_bf16 v[156:159], a[232:235], v[14:17], 0
    s_waitcnt lgkmcnt(2)
    ds_read_b128 a[224:227], v1 offset:1024
    v_cvt_pk_bf16_f32 v43, v86, v87
    v_mfma_f32_16x16x32_bf16 v[52:55], a[212:215], a[96:99], 0
    s_add_u32 s58, s33, 128
    v_exp_f32 v72, v72
    v_mfma_f32_16x16x32_bf16 v[52:55], a[216:219], a[100:103], v[52:55]
    s_add_u32 m0, s38, 2048
    ds_read_b128 a[228:231], v0 offset:2048
    buffer_load_dwordx4 v6, s[12:15], s58 offen nt lds
    v_mfma_f32_16x16x32_bf16 v[52:55], a[220:223], a[104:107], v[52:55]
    buffer_store_dwordx4 v[96:99], v6, s[16:19], s56 offen offset:0 nt
    s_nop 0
    ds_read_b128 v[96:99], v103 offset:3072
    v_fma_f32 v91, v91, s28, v13
    v_cvt_pk_bf16_f32 v16, v56, v57
    v_mfma_f32_16x16x32_bf16 v[60:63], a[220:223], a[128:131], 0
    ds_read_b128 a[232:235], v1 offset:2048
    v_fma_f32 v67, v67, s28, v10
    v_mfma_f32_16x16x32_bf16 v[60:63], a[216:219], a[124:127], v[60:63]
    v_exp_f32 v89, v89
    v_mfma_f32_16x16x32_bf16 v[60:63], a[212:215], a[120:123], v[60:63]
    v_exp_f32 v59, v59
    v_mfma_f32_16x16x32_bf16 v[68:71], a[212:215], a[144:147], 0
    s_add_u32 m0, s38, 3072
    v_exp_f32 v65, v65
    v_mfma_f32_16x16x32_bf16 v[68:71], a[216:219], a[148:151], v[68:71]
    v_exp_f32 v83, v83
    v_mfma_f32_16x16x32_bf16 v[68:71], a[220:223], a[152:155], v[68:71]
    v_exp_f32 v64, v64
    v_mfma_f32_16x16x32_bf16 v[76:79], a[220:223], a[176:179], 0
    v_cvt_pk_bf16_f32 v108, v108, v109
    v_mfma_f32_16x16x32_bf16 v[76:79], a[216:219], a[172:175], v[76:79]
    v_exp_f32 v75, v75
    v_mfma_f32_16x16x32_bf16 v[76:79], a[212:215], a[168:171], v[76:79]
    v_exp_f32 v74, v74
    v_mfma_f32_16x16x32_bf16 v[84:87], a[212:215], a[192:195], 0
    v_mfma_f32_16x16x32_bf16 v[84:87], a[216:219], a[196:199], v[84:87]
    v_exp_f32 v67, v67
    v_mfma_f32_16x16x32_bf16 v[84:87], a[220:223], a[200:203], v[84:87]
    s_waitcnt lgkmcnt(0)
    v_exp_f32 v91, v91
    v_mfma_f32_16x16x32_bf16 v[84:87], a[224:227], a[204:207], v[84:87]
    buffer_load_dwordx4 v7, s[12:15], s58 offen nt lds
    v_mfma_f32_16x16x32_bf16 v[84:87], a[228:231], a[208:211], v[84:87]
    v_cvt_pk_bf16_f32 v17, v58, v59
    v_cvt_pk_bf16_f32 v109, v110, v111
    v_mfma_f32_16x16x32_bf16 v[84:87], a[232:235], v[92:95], v[84:87]
    buffer_store_dwordx4 v[96:99], v7, s[16:19], s56 offen offset:0 nt
    ds_write_b64 v101, v[108:109] offset:0
    v_mfma_f32_16x16x32_bf16 v[76:79], a[232:235], a[188:191], v[76:79]
    v_cvt_pk_bf16_f32 v22, v64, v65
    v_cvt_pk_bf16_f32 v29, v74, v75
    v_mfma_f32_16x16x32_bf16 v[76:79], a[228:231], a[184:187], v[76:79]
    v_exp_f32 v80, v80
    v_mfma_f32_16x16x32_bf16 v[76:79], a[224:227], a[180:183], v[76:79]
    ds_read_b128 a[212:215], v0 offset:6144
    v_mfma_f32_16x16x32_bf16 v[48:51], a[236:239], v[16:19], v[44:47]
    ds_read_b128 a[216:219], v1 offset:6144
    v_cvt_pk_bf16_f32 v41, v90, v91
    v_mfma_f32_16x16x32_bf16 v[68:71], a[224:227], a[156:159], v[68:71]
    ds_read_b128 v[96:99], v103 offset:0
    v_cvt_pk_bf16_f32 v28, v72, v73
    v_mfma_f32_16x16x32_bf16 v[68:71], a[228:231], a[160:163], v[68:71]
    v_exp_f32 v88, v88
    v_mfma_f32_16x16x32_bf16 v[68:71], a[232:235], a[164:167], v[68:71]
    v_exp_f32 v66, v66
    v_mfma_f32_16x16x32_bf16 v[60:63], a[232:235], a[140:143], v[60:63]
    s_add_u32 s57, s67, 24832
    ds_read_b128 a[220:223], v0 offset:7168
    v_cvt_pk_bf16_f32 v23, v66, v67
    v_mfma_f32_16x16x32_bf16 v[60:63], a[228:231], a[136:139], v[60:63]
    v_exp_f32 v81, v81
    v_mfma_f32_16x16x32_bf16 v[48:51], a[240:243], v[22:25], v[48:51]
    s_add_u32 m0, s38, 0
    v_exp_f32 v82, v82
    v_mfma_f32_16x16x32_bf16 v[60:63], a[224:227], a[132:135], v[60:63]
    v_cvt_pk_bf16_f32 v35, v82, v83
    v_cvt_pk_bf16_f32 v34, v80, v81
    v_mfma_f32_16x16x32_bf16 v[52:55], a[224:227], a[108:111], v[52:55]
    v_mfma_f32_16x16x32_bf16 v[48:51], a[244:247], v[28:31], v[48:51]
    v_cvt_pk_bf16_f32 v40, v88, v89
    v_mfma_f32_16x16x32_bf16 v[48:51], a[248:251], v[34:37], v[48:51]
    ds_read_b128 a[224:227], v1 offset:7168
    v_mfma_f32_16x16x32_bf16 v[48:51], a[252:255], v[40:43], v[48:51]
    s_waitcnt lgkmcnt(2)
    buffer_load_dwordx4 v6, s[12:15], s33 offen nt lds
    v_mfma_f32_16x16x32_bf16 v[52:55], a[228:231], a[112:115], v[52:55]
    buffer_store_dwordx4 v[96:99], v6, s[16:19], s57 offen offset:0 nt
    s_nop 3
    v_cmp_lt_f32 vcc, s29, v48
    v_mfma_f32_16x16x32_bf16 v[52:55], a[232:235], a[116:119], v[52:55]
    ds_read_b128 a[232:235], v1 offset:8192
    v_mfma_f32_16x16x32_bf16 v[56:59], a[212:215], a[96:99], 0
    ds_read_b128 v[96:99], v103 offset:1024
    s_add_u32 m0, s38, 1024
    v_mfma_f32_16x16x32_bf16 v[56:59], a[216:219], a[100:103], v[56:59]
    s_cbranch_vccnz L_rs_tr55d
L_ret_tr55d:
    s_waitcnt lgkmcnt(3)
    v_mfma_f32_16x16x32_bf16 v[56:59], a[220:223], a[104:107], v[56:59]
    ds_read_b128 a[228:231], v0 offset:8192
    v_fma_f32 v62, v62, s28, v10
    v_mfma_f32_16x16x32_bf16 v[64:67], a[220:223], a[128:131], 0
    v_fma_f32 v55, v55, s28, v9
    v_fma_f32 v60, v60, s28, v10
    v_mfma_f32_16x16x32_bf16 v[64:67], a[216:219], a[124:127], v[64:67]
    v_fma_f32 v52, v52, s28, v9
    v_fma_f32 v54, v54, s28, v9
    v_mfma_f32_16x16x32_bf16 v[64:67], a[212:215], a[120:123], v[64:67]
    v_mfma_f32_16x16x32_bf16 v[72:75], a[212:215], a[144:147], 0
    v_exp_f32 v54, v54
    v_mfma_f32_16x16x32_bf16 v[72:75], a[216:219], a[148:151], v[72:75]
    v_exp_f32 v52, v52
    v_mfma_f32_16x16x32_bf16 v[72:75], a[220:223], a[152:155], v[72:75]
    v_exp_f32 v55, v55
    v_mfma_f32_16x16x32_bf16 v[80:83], a[220:223], a[176:179], 0
    v_fma_f32 v63, v63, s28, v10
    v_fma_f32 v53, v53, s28, v9
    v_mfma_f32_16x16x32_bf16 v[80:83], a[216:219], a[172:175], v[80:83]
    v_exp_f32 v60, v60
    v_mfma_f32_16x16x32_bf16 v[80:83], a[212:215], a[168:171], v[80:83]
    s_waitcnt lgkmcnt(1)
    buffer_load_dwordx4 v7, s[12:15], s33 offen nt lds
    v_mfma_f32_16x16x32_bf16 v[88:91], a[212:215], a[192:195], 0
    s_waitcnt vmcnt(15) lgkmcnt(0)
    v_exp_f32 v53, v53
    v_mfma_f32_16x16x32_bf16 v[88:91], a[216:219], a[196:199], v[88:91]
    s_barrier
    v_mfma_f32_16x16x32_bf16 v[88:91], a[220:223], a[200:203], v[88:91]
    s_add_u32 m0, s22, 0
    ds_read_b64_tr_b16 a[212:213], v2 offset:18432
    v_add_u32 v103, 4096, v103
    v_mfma_f32_16x16x32_bf16 v[88:91], a[224:227], a[204:207], v[88:91]
    ds_read_b64_tr_b16 a[214:215], v2 offset:12288
    v_fma_f32 v61, v61, s28, v10
    v_mfma_f32_16x16x32_bf16 v[88:91], a[228:231], a[208:211], v[88:91]
    buffer_load_dwordx4 v6, s[4:7], s20 offen lds
    v_mfma_f32_16x16x32_bf16 v[88:91], a[232:235], v[92:95], v[88:91]
    ds_read_b64_tr_b16 a[216:217], v3 offset:18432
    v_cvt_pk_bf16_f32 v14, v52, v53
    v_mfma_f32_16x16x32_bf16 v[80:83], a[232:235], a[188:191], v[80:83]
    s_add_u32 s20, s20, 128
    ds_read_b64_tr_b16 a[218:219], v3 offset:12288
    s_add_u32 m0, s22, 1024
    v_mfma_f32_16x16x32_bf16 v[80:83], a[228:231], a[184:187], v[80:83]
    v_exp_f32 v62, v62
    v_mfma_f32_16x16x32_bf16 v[80:83], a[224:227], a[180:183], v[80:83]
    buffer_load_dwordx4 v6, s[4:7], s20 offen lds
    v_mfma_f32_16x16x32_bf16 v[72:75], a[224:227], a[156:159], v[72:75]
    v_exp_f32 v63, v63
    v_mfma_f32_16x16x32_bf16 v[72:75], a[228:231], a[160:163], v[72:75]
    s_add_u32 s20, s20, 128
    v_exp_f32 v61, v61
    v_mfma_f32_16x16x32_bf16 v[72:75], a[232:235], a[164:167], v[72:75]
    ds_read_b64_tr_b16 a[220:221], v4 offset:18432
    s_add_u32 m0, s22, 2048
    v_mfma_f32_16x16x32_bf16 v[64:67], a[232:235], a[140:143], v[64:67]
    buffer_load_dwordx4 v6, s[4:7], s20 offen lds
    v_mfma_f32_16x16x32_bf16 v[64:67], a[228:231], a[136:139], v[64:67]
    ds_read_b64_tr_b16 a[222:223], v4 offset:12288
    v_cvt_pk_bf16_f32 v21, v62, v63
    v_mfma_f32_16x16x32_bf16 v[64:67], a[224:227], a[132:135], v[64:67]
    v_cvt_pk_bf16_f32 v15, v54, v55
    v_cvt_pk_bf16_f32 v20, v60, v61
    v_mfma_f32_16x16x32_bf16 v[56:59], a[224:227], a[108:111], v[56:59]
    ds_read_b64_tr_b16 a[224:225], v5 offset:18432
    s_add_u32 s20, s20, 12032
    v_mfma_f32_16x16x32_bf16 v[56:59], a[228:231], a[112:115], v[56:59]
    s_waitcnt lgkmcnt(3)
    s_bitcmp1_b32 s3, 1
    ds_read_b64_tr_b16 a[226:227], v5 offset:12288
    v_mfma_f32_16x16x32_bf16 v[56:59], a[232:235], a[116:119], v[56:59]
    buffer_store_dwordx4 v[96:99], v7, s[16:19], s57 offen offset:0 nt
    s_cbranch_scc1 L_loop5w1
    s_branch L_loop5w0
    .p2align 6
L_loop4w0:
    v_mfma_f32_16x16x32_bf16 v[112:115], a[212:215], v[16:19], v[112:115]
    v_fma_f32 v66, v66, s28, v10
    v_mfma_f32_16x16x32_bf16 v[160:163], a[212:215], v[22:25], v[160:163]
    ds_read_b64_tr_b16 a[228:229], v2 offset:19456
    v_fma_f32 v74, v74, s28, v11
    v_fma_f32 v68, v68, s28, v11
    v_mfma_f32_16x16x32_bf16 v[208:211], a[212:215], v[28:31], v[208:211]
    v_fma_f32 v58, v58, s28, v9
    v_mfma_f32_16x16x32_bf16 a[0:3], a[212:215], v[34:37], a[0:3]
    v_fma_f32 v63, v63, s28, v10
    s_waitcnt lgkmcnt(5)
    v_mfma_f32_16x16x32_bf16 a[4:7], a[216:219], v[34:37], a[4:7]
    ds_read_b64_tr_b16 a[230:231], v2 offset:13312
    v_mfma_f32_16x16x32_bf16 v[212:215], a[216:219], v[28:31], v[212:215]
    ds_read_b64_tr_b16 a[212:213], v4 offset:19456
    v_fma_f32 v64, v64, s28, v10
    v_mfma_f32_16x16x32_bf16 v[164:167], a[216:219], v[22:25], v[164:167]
    ds_read_b64_tr_b16 a[232:233], v3 offset:19456
    v_mfma_f32_16x16x32_bf16 v[116:119], a[216:219], v[16:19], v[116:119]
    ds_read_b64_tr_b16 a[234:235], v3 offset:13312
    s_waitcnt lgkmcnt(7)
    v_mfma_f32_16x16x32_bf16 v[120:123], a[220:223], v[16:19], v[120:123]
    v_exp_f32 v63, v63
    v_mfma_f32_16x16x32_bf16 v[168:171], a[220:223], v[22:25], v[168:171]
    ds_read_b64_tr_b16 a[216:217], v5 offset:19456
    v_fma_f32 v67, v67, s28, v10
    v_mfma_f32_16x16x32_bf16 v[216:219], a[220:223], v[28:31], v[216:219]
    v_exp_f32 v68, v68
    v_mfma_f32_16x16x32_bf16 a[8:11], a[220:223], v[34:37], a[8:11]
    s_waitcnt lgkmcnt(5)
    ds_read_b64_tr_b16 a[214:215], v4 offset:13312
    v_fma_f32 v69, v69, s28, v11
    v_mfma_f32_16x16x32_bf16 a[12:15], a[224:227], v[34:37], a[12:15]
    v_fma_f32 v79, v79, s28, v12
    v_fma_f32 v57, v57, s28, v9
    v_mfma_f32_16x16x32_bf16 v[220:223], a[224:227], v[28:31], v[220:223]
    v_fma_f32 v83, v83, s28, v12
    v_fma_f32 v71, v71, s28, v11
    v_mfma_f32_16x16x32_bf16 v[172:175], a[224:227], v[22:25], v[172:175]
    ds_read_b64_tr_b16 a[222:223], v2 offset:14336
    v_mfma_f32_16x16x32_bf16 v[124:127], a[224:227], v[16:19], v[124:127]
    s_waitcnt lgkmcnt(5)
    ds_read_b64_tr_b16 a[218:219], v5 offset:13312
    v_mfma_f32_16x16x32_bf16 v[128:131], a[228:231], v[16:19], v[128:131]
    v_exp_f32 v58, v58
    v_mfma_f32_16x16x32_bf16 v[176:179], a[228:231], v[22:25], v[176:179]
    ds_read_b64_tr_b16 a[220:221], v2 offset:20480
    v_fma_f32 v65, v65, s28, v10
    v_mfma_f32_16x16x32_bf16 v[224:227], a[228:231], v[28:31], v[224:227]
    s_add_u32 s39, s39, 12288
    ds_read_b64_tr_b16 a[224:225], v3 offset:20480
    v_fma_f32 v56, v56, s28, v9
    v_mfma_f32_16x16x32_bf16 a[16:19], a[228:231], v[34:37], a[16:19]
    s_waitcnt lgkmcnt(5)
    ds_read_b64_tr_b16 a[230:231], v4 offset:14336
    v_fma_f32 v70, v70, s28, v11
    v_mfma_f32_16x16x32_bf16 a[20:23], a[232:235], v[34:37], a[20:23]
    ds_read_b64_tr_b16 a[226:227], v3 offset:14336
    v_fma_f32 v62, v62, s28, v10
    v_mfma_f32_16x16x32_bf16 v[228:231], a[232:235], v[28:31], v[228:231]
    v_fma_f32 v73, v73, s28, v11
    v_fma_f32 v78, v78, s28, v12
    v_mfma_f32_16x16x32_bf16 v[180:183], a[232:235], v[22:25], v[180:183]
    ds_read_b64_tr_b16 a[228:229], v4 offset:20480
    v_fma_f32 v77, v77, s28, v12
    v_mfma_f32_16x16x32_bf16 v[132:135], a[232:235], v[16:19], v[132:135]
    s_waitcnt lgkmcnt(7)
    ds_read_b64_tr_b16 a[232:233], v5 offset:20480
    v_fma_f32 v72, v72, s28, v11
    v_mfma_f32_16x16x32_bf16 v[136:139], a[212:215], v[16:19], v[136:139]
    ds_read_b64_tr_b16 a[234:235], v5 offset:14336
    v_fma_f32 v81, v81, s28, v12
    v_mfma_f32_16x16x32_bf16 v[184:187], a[212:215], v[22:25], v[184:187]
    ds_read_b128 v[88:91], v103 offset:0
    v_mfma_f32_16x16x32_bf16 v[232:235], a[212:215], v[28:31], v[232:235]
    v_exp_f32 v62, v62
    v_mfma_f32_16x16x32_bf16 a[24:27], a[212:215], v[34:37], a[24:27]
    s_waitcnt lgkmcnt(7)
    v_exp_f32 v67, v67
    v_mfma_f32_16x16x32_bf16 a[28:31], a[216:219], v[34:37], a[28:31]
    v_exp_f32 v69, v69
    v_mfma_f32_16x16x32_bf16 v[236:239], a[216:219], v[28:31], v[236:239]
    v_fma_f32 v80, v80, s28, v12
    v_fma_f32 v76, v76, s28, v12
    v_mfma_f32_16x16x32_bf16 v[188:191], a[216:219], v[22:25], v[188:191]
    v_exp_f32 v70, v70
    v_mfma_f32_16x16x32_bf16 v[140:143], a[216:219], v[16:19], v[140:143]
    ds_read_b128 v[84:87], v103 offset:2048
    v_mfma_f32_16x16x32_bf16 v[144:147], a[220:223], v[16:19], v[144:147]
    v_exp_f32 v65, v65
    v_mfma_f32_16x16x32_bf16 v[192:195], a[220:223], v[22:25], v[192:195]
    v_exp_f32 v66, v66
    v_mfma_f32_16x16x32_bf16 v[240:243], a[220:223], v[28:31], v[240:243]
    s_waitcnt vmcnt(10) lgkmcnt(2)
    v_exp_f32 v77, v77
    v_mfma_f32_16x16x32_bf16 a[32:35], a[220:223], v[34:37], a[32:35]
    s_barrier
    v_mfma_f32_16x16x32_bf16 a[36:39], a[224:227], v[34:37], a[36:39]
    s_add_u32 m0, s22, 36864
    v_exp_f32 v72, v72
    v_mfma_f32_16x16x32_bf16 v[244:247], a[224:227], v[28:31], v[244:247]
    ds_read_b128 a[212:215], v0 offset:12288
    v_mfma_f32_16x16x32_bf16 v[196:199], a[224:227], v[22:25], v[196:199]
    ds_read_b128 a[216:219], v1 offset:12288
    v_fma_f32 v59, v59, s28, v9
    v_mfma_f32_16x16x32_bf16 v[148:151], a[224:227], v[16:19], v[148:151]
    ds_read_b128 a[220:223], v0 offset:13312
    v_mfma_f32_16x16x32_bf16 v[152:155], a[228:231], v[16:19], v[152:155]
    buffer_load_dwordx4 v6, s[8:11], s21 offen lds
    v_mfma_f32_16x16x32_bf16 v[200:203], a[228:231], v[22:25], v[200:203]
    s_add_u32 s21, s21, 128
    v_exp_f32 v78, v78
    v_mfma_f32_16x16x32_bf16 v[248:251], a[228:231], v[28:31], v[248:251]
    s_add_u32 m0, s22, 37888
    v_exp_f32 v79, v79
    v_mfma_f32_16x16x32_bf16 a[40:43], a[228:231], v[34:37], a[40:43]
    buffer_load_dwordx4 v6, s[8:11], s21 offen lds
    v_mfma_f32_16x16x32_bf16 a[44:47], a[232:235], v[34:37], a[44:47]
    s_add_u32 s21, s21, 128
    s_add_u32 m0, s22, 38912
    v_mfma_f32_16x16x32_bf16 v[252:255], a[232:235], v[28:31], v[252:255]
    v_exp_f32 v71, v71
    v_mfma_f32_16x16x32_bf16 v[204:207], a[232:235], v[22:25], v[204:207]
    buffer_load_dwordx4 v6, s[8:11], s21 offen lds
    v_mfma_f32_16x16x32_bf16 v[156:159], a[232:235], v[16:19], v[156:159]
    s_waitcnt lgkmcnt(2)
    ds_read_b128 a[224:227], v1 offset:13312
    v_fma_f32 v75, v75, s28, v11
    v_mfma_f32_16x16x32_bf16 v[52:55], a[212:215], a[96:99], 0
    s_waitcnt lgkmcnt(2)
    ds_read_b128 a[232:235], v1 offset:14336
    v_cvt_pk_bf16_f32 v26, v68, v69
    v_mfma_f32_16x16x32_bf16 v[52:55], a[216:219], a[100:103], v[52:55]
    s_waitcnt lgkmcnt(2)
    v_exp_f32 v76, v76
    v_mfma_f32_16x16x32_bf16 v[52:55], a[220:223], a[104:107], v[52:55]
    v_fma_f32 v82, v82, s28, v12
    v_cvt_pk_bf16_f32 v21, v62, v63
    v_mfma_f32_16x16x32_bf16 v[60:63], a[220:223], a[128:131], 0
    ds_read_b128 a[228:231], v0 offset:14336
    v_cvt_pk_bf16_f32 v23, v66, v67
    v_mfma_f32_16x16x32_bf16 v[60:63], a[216:219], a[124:127], v[60:63]
    v_mfma_f32_16x16x32_bf16 v[60:63], a[212:215], a[120:123], v[60:63]
    v_cvt_pk_bf16_f32 v32, v76, v77
    v_cvt_pk_bf16_f32 v27, v70, v71
    v_mfma_f32_16x16x32_bf16 v[68:71], a[212:215], a[144:147], 0
    s_add_u32 s21, s21, 12032
    v_exp_f32 v59, v59
    v_mfma_f32_16x16x32_bf16 v[68:71], a[216:219], a[148:151], v[68:71]
    s_add_u32 m0, s23, 0
    v_exp_f32 v74, v74
    v_mfma_f32_16x16x32_bf16 v[68:71], a[220:223], a[152:155], v[68:71]
    buffer_store_dwordx4 v[88:91], v38, s[16:19], s24 offen offset:0 nt
    v_exp_f32 v81, v81
    v_cvt_pk_bf16_f32 v33, v78, v79
    v_mfma_f32_16x16x32_bf16 v[76:79], a[220:223], a[176:179], 0
    v_cvt_pk_bf16_f32 v17, v58, v59
    v_mfma_f32_16x16x32_bf16 v[76:79], a[216:219], a[172:175], v[76:79]
    v_exp_f32 v82, v82
    v_mfma_f32_16x16x32_bf16 v[76:79], a[212:215], a[168:171], v[76:79]
    s_waitcnt lgkmcnt(1)
    v_exp_f32 v83, v83
    v_mfma_f32_16x16x32_bf16 v[76:79], a[224:227], a[180:183], v[76:79]
    s_waitcnt lgkmcnt(0)
    ds_read_b128 a[212:215], v0 offset:18432
    v_cvt_pk_bf16_f32 v35, v82, v83
    v_mfma_f32_16x16x32_bf16 v[76:79], a[228:231], a[184:187], v[76:79]
    ds_read_b128 a[220:223], v0 offset:19456
    v_mfma_f32_16x16x32_bf16 v[76:79], a[232:235], a[188:191], v[76:79]
    v_exp_f32 v75, v75
    v_mfma_f32_16x16x32_bf16 v[68:71], a[232:235], a[164:167], v[68:71]
    ds_read_b128 a[216:219], v1 offset:18432
    v_cvt_pk_bf16_f32 v29, v74, v75
    v_mfma_f32_16x16x32_bf16 v[68:71], a[228:231], a[160:163], v[68:71]
    v_exp_f32 v57, v57
    v_mfma_f32_16x16x32_bf16 v[68:71], a[224:227], a[156:159], v[68:71]
    buffer_load_dwordx4 v38, s[12:15], s25 offen nt lds
    v_mfma_f32_16x16x32_bf16 v[60:63], a[224:227], a[132:135], v[60:63]
    v_exp_f32 v56, v56
    v_mfma_f32_16x16x32_bf16 v[60:63], a[228:231], a[136:139], v[60:63]
    s_bitcmp1_b32 s27, 0
    v_exp_f32 v64, v64
    v_mfma_f32_16x16x32_bf16 v[60:63], a[232:235], a[140:143], v[60:63]
    v_exp_f32 v73, v73
    v_mfma_f32_16x16x32_bf16 v[52:55], a[232:235], a[116:119], v[52:55]
    ds_read_b128 a[232:235], v1 offset:20480
    v_cvt_pk_bf16_f32 v22, v64, v65
    v_mfma_f32_16x16x32_bf16 v[52:55], a[228:231], a[112:115], v[52:55]
    ds_read_b128 a[228:231], v0 offset:20480
    v_cvt_pk_bf16_f32 v28, v72, v73
    v_mfma_f32_16x16x32_bf16 v[52:55], a[224:227], a[108:111], v[52:55]
    s_waitcnt lgkmcnt(3)
    ds_read_b128 a[224:227], v1 offset:19456
    v_cvt_pk_bf16_f32 v16, v56, v57
    v_mfma_f32_16x16x32_bf16 v[56:59], a[212:215], a[96:99], 0
    s_cselect_b32 s26, s49, 128
    s_bitcmp1_b32 s89, 0
    s_cselect_b32 s26, s26, 0
    v_mfma_f32_16x16x32_bf16 v[44:47], a[236:239], v[14:17], v[48:51]
    v_exp_f32 v80, v80
    v_mfma_f32_16x16x32_bf16 v[44:47], a[240:243], v[20:23], v[44:47]
    v_cvt_pk_bf16_f32 v34, v80, v81
    s_lshr_b32 s89, s89, 1
    v_mfma_f32_16x16x32_bf16 v[44:47], a[244:247], v[26:29], v[44:47]
    s_waitcnt lgkmcnt(3)
    v_mfma_f32_16x16x32_bf16 v[56:59], a[216:219], a[100:103], v[56:59]
    v_mfma_f32_16x16x32_bf16 v[56:59], a[220:223], a[104:107], v[56:59]
    v_mfma_f32_16x16x32_bf16 v[44:47], a[248:251], v[32:35], v[44:47]
    s_lshr_b32 s27, s27, 1
    v_mfma_f32_16x16x32_bf16 v[64:67], a[220:223], a[128:131], 0
    s_add_u32 s24, s24, s26
    s_add_u32 s25, s25, s26
    ds_read_b128 v[96:99], v103 offset:1024
    v_mfma_f32_16x16x32_bf16 v[64:67], a[216:219], a[124:127], v[64:67]
    v_mfma_f32_16x16x32_bf16 v[64:67], a[212:215], a[120:123], v[64:67]
    s_nop 0
    v_cmp_lt_f32 vcc, s29, v44
    s_waitcnt vmcnt(10) lgkmcnt(1)
    v_mfma_f32_16x16x32_bf16 v[72:75], a[212:215], a[144:147], 0
    s_barrier
    v_mfma_f32_16x16x32_bf16 v[72:75], a[216:219], a[148:151], v[72:75]
    s_nop 0
    s_cbranch_vccnz L_rs_loop4w0a
L_ret_loop4w0a:
    v_mfma_f32_16x16x32_bf16 v[72:75], a[220:223], a[152:155], v[72:75]
    s_add_u32 m0, s22, 12288
    v_fma_f32 v78, v78, s28, v12
    v_fma_f32 v62, v62, s28, v10
    v_mfma_f32_16x16x32_bf16 v[80:83], a[220:223], a[176:179], 0
    buffer_load_dwordx4 v6, s[4:7], s20 offen lds
    v_mfma_f32_16x16x32_bf16 v[80:83], a[216:219], a[172:175], v[80:83]
    s_add_u32 s20, s20, 128
    v_exp_f32 v78, v78
    v_mfma_f32_16x16x32_bf16 v[80:83], a[212:215], a[168:171], v[80:83]
    s_add_u32 m0, s22, 13312
    ds_read_b64_tr_b16 a[212:213], v2 offset:0
    v_fma_f32 v53, v53, s28, v9
    v_mfma_f32_16x16x32_bf16 v[80:83], a[224:227], a[180:183], v[80:83]
    buffer_load_dwordx4 v6, s[4:7], s20 offen lds
    v_mfma_f32_16x16x32_bf16 v[80:83], a[228:231], a[184:187], v[80:83]
    s_add_u32 s20, s20, 128
    ds_read_b64_tr_b16 a[214:215], v2 offset:6144
    v_fma_f32 v68, v68, s28, v11
    v_mfma_f32_16x16x32_bf16 v[80:83], a[232:235], a[188:191], v[80:83]
    s_add_u32 m0, s22, 14336
    ds_read_b64_tr_b16 a[216:217], v3 offset:0
    v_mfma_f32_16x16x32_bf16 v[72:75], a[232:235], a[164:167], v[72:75]
    ds_read_b64_tr_b16 a[218:219], v3 offset:6144
    v_fma_f32 v71, v71, s28, v11
    v_mfma_f32_16x16x32_bf16 v[72:75], a[228:231], a[160:163], v[72:75]
    buffer_load_dwordx4 v6, s[4:7], s20 offen lds
    v_mfma_f32_16x16x32_bf16 v[72:75], a[224:227], a[156:159], v[72:75]
    s_add_u32 s20, s20, 12032
    ds_read_b64_tr_b16 a[220:221], v4 offset:0
    v_fma_f32 v69, v69, s28, v11
    v_mfma_f32_16x16x32_bf16 v[64:67], a[224:227], a[132:135], v[64:67]
    v_fma_f32 v61, v61, s28, v10
    v_fma_f32 v60, v60, s28, v10
    v_mfma_f32_16x16x32_bf16 v[64:67], a[228:231], a[136:139], v[64:67]
    ds_read_b64_tr_b16 a[222:223], v4 offset:6144
    v_fma_f32 v79, v79, s28, v12
    v_mfma_f32_16x16x32_bf16 v[64:67], a[232:235], a[140:143], v[64:67]
    v_exp_f32 v53, v53
    v_mfma_f32_16x16x32_bf16 v[56:59], a[232:235], a[116:119], v[56:59]
    s_add_u32 s39, s39, 12288
    v_exp_f32 v60, v60
    v_mfma_f32_16x16x32_bf16 v[56:59], a[228:231], a[112:115], v[56:59]
    s_add_u32 m0, s23, 1024
    v_fma_f32 v63, v63, s28, v10
    v_fma_f32 v54, v54, s28, v9
    v_mfma_f32_16x16x32_bf16 v[56:59], a[224:227], a[108:111], v[56:59]
    s_waitcnt lgkmcnt(4)
    v_exp_f32 v79, v79
    v_mfma_f32_16x16x32_bf16 v[112:115], a[212:215], v[14:17], v[112:115]
    ds_read_b64_tr_b16 a[228:229], v2 offset:1024
    v_fma_f32 v55, v55, s28, v9
    v_mfma_f32_16x16x32_bf16 v[160:163], a[212:215], v[20:23], v[160:163]
    ds_read_b64_tr_b16 a[224:225], v5 offset:0
    v_fma_f32 v70, v70, s28, v11
    v_mfma_f32_16x16x32_bf16 v[208:211], a[212:215], v[26:29], v[208:211]
    ds_read_b64_tr_b16 a[234:235], v3 offset:7168
    v_fma_f32 v77, v77, s28, v12
    v_mfma_f32_16x16x32_bf16 a[0:3], a[212:215], v[32:35], a[0:3]
    s_waitcnt lgkmcnt(4)
    ds_read_b64_tr_b16 a[226:227], v5 offset:6144
    v_fma_f32 v74, v74, s28, v11
    v_mfma_f32_16x16x32_bf16 a[4:7], a[216:219], v[32:35], a[4:7]
    ds_read_b64_tr_b16 a[230:231], v2 offset:7168
    v_mfma_f32_16x16x32_bf16 v[212:215], a[216:219], v[26:29], v[212:215]
    buffer_store_dwordx4 v[96:99], v39, s[16:19], s24 offen offset:0 nt
    ds_read_b64_tr_b16 a[212:213], v4 offset:1024
    v_exp_f32 v77, v77
    v_mfma_f32_16x16x32_bf16 v[164:167], a[216:219], v[20:23], v[164:167]
    v_exp_f32 v55, v55
    v_mfma_f32_16x16x32_bf16 v[116:119], a[216:219], v[14:17], v[116:119]
    s_waitcnt lgkmcnt(6)
    ds_read_b64_tr_b16 a[232:233], v3 offset:1024
    v_fma_f32 v75, v75, s28, v11
    v_mfma_f32_16x16x32_bf16 v[120:123], a[220:223], v[14:17], v[120:123]
    ds_read_b64_tr_b16 a[214:215], v4 offset:7168
    v_mfma_f32_16x16x32_bf16 v[168:171], a[220:223], v[20:23], v[168:171]
    ds_read_b64_tr_b16 a[218:219], v5 offset:7168
    v_mfma_f32_16x16x32_bf16 v[216:219], a[220:223], v[26:29], v[216:219]
    v_exp_f32 v61, v61
    v_mfma_f32_16x16x32_bf16 a[8:11], a[220:223], v[32:35], a[8:11]
    ds_read_b64_tr_b16 a[216:217], v5 offset:1024
    s_waitcnt lgkmcnt(6)
    v_mfma_f32_16x16x32_bf16 a[12:15], a[224:227], v[32:35], a[12:15]
    v_exp_f32 v54, v54
    v_mfma_f32_16x16x32_bf16 v[220:223], a[224:227], v[26:29], v[220:223]
    ds_read_b64_tr_b16 a[220:221], v2 offset:2048
    v_fma_f32 v73, v73, s28, v11
    v_mfma_f32_16x16x32_bf16 v[172:175], a[224:227], v[20:23], v[172:175]
    buffer_load_dwordx4 v39, s[12:15], s25 offen nt lds
    v_mfma_f32_16x16x32_bf16 v[124:127], a[224:227], v[14:17], v[124:127]
    s_waitcnt lgkmcnt(5)
    ds_read_b64_tr_b16 a[222:223], v2 offset:8192
    v_fma_f32 v57, v57, s28, v9
    v_mfma_f32_16x16x32_bf16 v[128:131], a[228:231], v[14:17], v[128:131]
    s_bitcmp1_b32 s27, 0
    ds_read_b64_tr_b16 a[224:225], v3 offset:2048
    v_fma_f32 v52, v52, s28, v9
    v_mfma_f32_16x16x32_bf16 v[176:179], a[228:231], v[20:23], v[176:179]
    v_exp_f32 v69, v69
    v_mfma_f32_16x16x32_bf16 v[224:227], a[228:231], v[26:29], v[224:227]
    v_exp_f32 v71, v71
    v_mfma_f32_16x16x32_bf16 a[16:19], a[228:231], v[32:35], a[16:19]
    s_waitcnt lgkmcnt(4)
    ds_read_b64_tr_b16 a[230:231], v4 offset:8192
    v_fma_f32 v58, v58, s28, v9
    v_mfma_f32_16x16x32_bf16 a[20:23], a[232:235], v[32:35], a[20:23]
    v_exp_f32 v52, v52
    v_mfma_f32_16x16x32_bf16 v[228:231], a[232:235], v[26:29], v[228:231]
    ds_read_b64_tr_b16 a[226:227], v3 offset:8192
    v_fma_f32 v76, v76, s28, v12
    v_mfma_f32_16x16x32_bf16 v[180:183], a[232:235], v[20:23], v[180:183]
    s_cselect_b32 s26, s49, 128
    s_bitcmp1_b32 s89, 0
    ds_read_b64_tr_b16 a[228:229], v4 offset:2048
    v_mfma_f32_16x16x32_bf16 v[132:135], a[232:235], v[14:17], v[132:135]
    ds_read_b64_tr_b16 a[232:233], v5 offset:2048
    v_fma_f32 v80, v80, s28, v12
    v_mfma_f32_16x16x32_bf16 v[136:139], a[212:215], v[14:17], v[136:139]
    s_cselect_b32 s26, s26, 0
    ds_read_b64_tr_b16 a[234:235], v5 offset:8192
    v_fma_f32 v82, v82, s28, v12
    v_mfma_f32_16x16x32_bf16 v[184:187], a[212:215], v[20:23], v[184:187]
    v_exp_f32 v68, v68
    v_mfma_f32_16x16x32_bf16 v[232:235], a[212:215], v[26:29], v[232:235]
    s_lshr_b32 s89, s89, 1
    v_exp_f32 v63, v63
    v_mfma_f32_16x16x32_bf16 a[24:27], a[212:215], v[32:35], a[24:27]
    s_waitcnt lgkmcnt(5)
    v_exp_f32 v70, v70
    v_mfma_f32_16x16x32_bf16 a[28:31], a[216:219], v[32:35], a[28:31]
    v_exp_f32 v80, v80
    v_mfma_f32_16x16x32_bf16 v[236:239], a[216:219], v[26:29], v[236:239]
    v_fma_f32 v72, v72, s28, v11
    s_lshr_b32 s27, s27, 1
    v_mfma_f32_16x16x32_bf16 v[188:191], a[216:219], v[20:23], v[188:191]
    s_add_u32 s24, s24, s26
    v_cvt_pk_bf16_f32 v19, v54, v55
    v_mfma_f32_16x16x32_bf16 v[140:143], a[216:219], v[14:17], v[140:143]
    v_cvt_pk_bf16_f32 v24, v60, v61
    v_mfma_f32_16x16x32_bf16 v[144:147], a[220:223], v[14:17], v[144:147]
    v_exp_f32 v73, v73
    v_mfma_f32_16x16x32_bf16 v[192:195], a[220:223], v[20:23], v[192:195]
    v_fma_f32 v81, v81, s28, v12
    s_add_u32 s25, s25, s26
    v_mfma_f32_16x16x32_bf16 v[240:243], a[220:223], v[26:29], v[240:243]
    s_waitcnt vmcnt(10) lgkmcnt(0)
    v_exp_f32 v62, v62
    v_mfma_f32_16x16x32_bf16 a[32:35], a[220:223], v[32:35], a[32:35]
    s_barrier
    v_mfma_f32_16x16x32_bf16 a[36:39], a[224:227], v[32:35], a[36:39]
    s_add_u32 m0, s22, 24576
    ds_read_b128 a[212:215], v0 offset:0
    v_cvt_pk_bf16_f32 v25, v62, v63
    v_mfma_f32_16x16x32_bf16 v[244:247], a[224:227], v[26:29], v[244:247]
    buffer_load_dwordx4 v6, s[8:11], s21 offen lds
    v_mfma_f32_16x16x32_bf16 v[196:199], a[224:227], v[20:23], v[196:199]
    s_add_u32 s21, s21, 128
    ds_read_b128 a[216:219], v1 offset:0
    v_cvt_pk_bf16_f32 v30, v68, v69
    v_mfma_f32_16x16x32_bf16 v[148:151], a[224:227], v[14:17], v[148:151]
    s_add_u32 m0, s22, 25600
    ds_read_b128 a[220:223], v0 offset:1024
    v_cvt_pk_bf16_f32 v18, v52, v53
    v_mfma_f32_16x16x32_bf16 v[152:155], a[228:231], v[14:17], v[152:155]
    buffer_load_dwordx4 v6, s[8:11], s21 offen lds
    v_mfma_f32_16x16x32_bf16 v[200:203], a[228:231], v[20:23], v[200:203]
    v_exp_f32 v76, v76
    v_mfma_f32_16x16x32_bf16 v[248:251], a[228:231], v[26:29], v[248:251]
    s_add_u32 s21, s21, 128
    ds_read_b128 a[224:227], v1 offset:1024
    v_mfma_f32_16x16x32_bf16 a[40:43], a[228:231], v[32:35], a[40:43]
    v_fma_f32 v65, v65, s28, v10
    v_fma_f32 v83, v83, s28, v12
    v_mfma_f32_16x16x32_bf16 a[44:47], a[232:235], v[32:35], a[44:47]
    s_add_u32 m0, s22, 26624
    v_exp_f32 v58, v58
    v_mfma_f32_16x16x32_bf16 v[252:255], a[232:235], v[26:29], v[252:255]
    buffer_load_dwordx4 v6, s[8:11], s21 offen lds
    v_mfma_f32_16x16x32_bf16 v[204:207], a[232:235], v[20:23], v[204:207]
    ds_read_b128 a[228:231], v0 offset:2048
    v_fma_f32 v59, v59, s28, v9
    v_mfma_f32_16x16x32_bf16 v[156:159], a[232:235], v[14:17], v[156:159]
    s_waitcnt lgkmcnt(4)
    v_fma_f32 v66, v66, s28, v10
    v_fma_f32 v64, v64, s28, v10
    v_mfma_f32_16x16x32_bf16 v[52:55], a[212:215], a[96:99], 0
    s_waitcnt lgkmcnt(3)
    v_exp_f32 v64, v64
    v_mfma_f32_16x16x32_bf16 v[52:55], a[216:219], a[100:103], v[52:55]
    s_waitcnt lgkmcnt(2)
    v_exp_f32 v83, v83
    v_mfma_f32_16x16x32_bf16 v[52:55], a[220:223], a[104:107], v[52:55]
    s_add_u32 s21, s21, 12032
    v_cvt_pk_bf16_f32 v31, v70, v71
    v_cvt_pk_bf16_f32 v37, v78, v79
    v_mfma_f32_16x16x32_bf16 v[60:63], a[220:223], a[128:131], 0
    ds_read_b128 a[232:235], v1 offset:2048
    v_fma_f32 v67, v67, s28, v10
    v_mfma_f32_16x16x32_bf16 v[60:63], a[216:219], a[124:127], v[60:63]
    buffer_store_dwordx4 v[84:87], v38, s[16:19], s24 offen offset:0 nt
    v_fma_f32 v56, v56, s28, v9
    v_exp_f32 v74, v74
    v_mfma_f32_16x16x32_bf16 v[60:63], a[212:215], a[120:123], v[60:63]
    v_exp_f32 v81, v81
    v_mfma_f32_16x16x32_bf16 v[68:71], a[212:215], a[144:147], 0
    v_exp_f32 v59, v59
    v_mfma_f32_16x16x32_bf16 v[68:71], a[216:219], a[148:151], v[68:71]
    v_exp_f32 v57, v57
    v_mfma_f32_16x16x32_bf16 v[68:71], a[220:223], a[152:155], v[68:71]
    v_cvt_pk_bf16_f32 v36, v76, v77
    v_cvt_pk_bf16_f32 v34, v80, v81
    v_mfma_f32_16x16x32_bf16 v[76:79], a[220:223], a[176:179], 0
    v_exp_f32 v67, v67
    v_mfma_f32_16x16x32_bf16 v[76:79], a[216:219], a[172:175], v[76:79]
    v_exp_f32 v75, v75
    v_mfma_f32_16x16x32_bf16 v[76:79], a[212:215], a[168:171], v[76:79]
    s_add_u32 m0, s23, 2048
    ds_read_b128 a[212:215], v0 offset:6144
    s_waitcnt lgkmcnt(1)
    v_mfma_f32_16x16x32_bf16 v[76:79], a[224:227], a[180:183], v[76:79]
    v_exp_f32 v82, v82
    v_mfma_f32_16x16x32_bf16 v[76:79], a[228:231], a[184:187], v[76:79]
    buffer_load_dwordx4 v38, s[12:15], s25 offen nt lds
    v_mfma_f32_16x16x32_bf16 v[76:79], a[232:235], a[188:191], v[76:79]
    v_exp_f32 v65, v65
    v_mfma_f32_16x16x32_bf16 v[68:71], a[232:235], a[164:167], v[68:71]
    v_exp_f32 v72, v72
    v_mfma_f32_16x16x32_bf16 v[68:71], a[228:231], a[160:163], v[68:71]
    v_exp_f32 v56, v56
    v_mfma_f32_16x16x32_bf16 v[68:71], a[224:227], a[156:159], v[68:71]
    s_bitcmp1_b32 s27, 0
    ds_read_b128 a[220:223], v0 offset:7168
    v_cvt_pk_bf16_f32 v16, v56, v57
    v_mfma_f32_16x16x32_bf16 v[60:63], a[224:227], a[132:135], v[60:63]
    ds_read_b128 a[216:219], v1 offset:6144
    v_cvt_pk_bf16_f32 v17, v58, v59
    v_mfma_f32_16x16x32_bf16 v[60:63], a[228:231], a[136:139], v[60:63]
    s_cselect_b32 s26, s49, 128
    v_cvt_pk_bf16_f32 v22, v64, v65
    v_cvt_pk_bf16_f32 v29, v74, v75
    v_mfma_f32_16x16x32_bf16 v[60:63], a[232:235], a[140:143], v[60:63]
    v_exp_f32 v66, v66
    v_mfma_f32_16x16x32_bf16 v[52:55], a[232:235], a[116:119], v[52:55]
    s_bitcmp1_b32 s89, 0
    ds_read_b128 a[232:235], v1 offset:8192
    v_mfma_f32_16x16x32_bf16 v[52:55], a[228:231], a[112:115], v[52:55]
    s_cselect_b32 s26, s26, 0
    ds_read_b128 a[228:231], v0 offset:8192
    v_cvt_pk_bf16_f32 v35, v82, v83
    v_mfma_f32_16x16x32_bf16 v[52:55], a[224:227], a[108:111], v[52:55]
    ds_read_b128 a[224:227], v1 offset:7168
    v_cvt_pk_bf16_f32 v23, v66, v67
    v_mfma_f32_16x16x32_bf16 v[48:51], a[236:239], v[16:19], v[44:47]
    v_cvt_pk_bf16_f32 v28, v72, v73
    v_mfma_f32_16x16x32_bf16 v[48:51], a[240:243], v[22:25], v[48:51]
    s_lshr_b32 s89, s89, 1
    v_mfma_f32_16x16x32_bf16 v[48:51], a[244:247], v[28:31], v[48:51]
    v_mfma_f32_16x16x32_bf16 v[48:51], a[248:251], v[34:37], v[48:51]
    s_waitcnt lgkmcnt(4)
    v_swap_b32 v38, v39
    v_mfma_f32_16x16x32_bf16 v[56:59], a[212:215], a[96:99], 0
    s_lshr_b32 s27, s27, 1
    v_add_u32 v103, 3072, v103
    s_waitcnt lgkmcnt(3)
    v_mfma_f32_16x16x32_bf16 v[56:59], a[216:219], a[100:103], v[56:59]
    s_nop 0
    v_cmp_lt_f32 vcc, s29, v48
    s_add_u32 s24, s24, s26
    v_mfma_f32_16x16x32_bf16 v[56:59], a[220:223], a[104:107], v[56:59]
    s_add_u32 s25, s25, s26
    s_add_u32 s23, s23, 3072
    v_mfma_f32_16x16x32_bf16 v[64:67], a[220:223], a[128:131], 0
    s_cbranch_vccnz L_rs_loop4w0b
L_ret_loop4w0b:
    v_fma_f32 v60, v60, s28, v10
    v_mfma_f32_16x16x32_bf16 v[64:67], a[216:219], a[124:127], v[64:67]
    v_fma_f32 v54, v54, s28, v9
    v_fma_f32 v52, v52, s28, v9
    v_mfma_f32_16x16x32_bf16 v[64:67], a[212:215], a[120:123], v[64:67]
    s_waitcnt vmcnt(12) lgkmcnt(0)
    s_cmp_eq_u32 s30, 5
    v_fma_f32 v53, v53, s28, v9
    v_mfma_f32_16x16x32_bf16 v[72:75], a[212:215], a[144:147], 0
    s_barrier
    v_mfma_f32_16x16x32_bf16 v[72:75], a[216:219], a[148:151], v[72:75]
    s_cselect_b32 s26, s62, 0
    s_add_u32 s20, s20, s26
    s_add_u32 m0, s22, 0
    v_mfma_f32_16x16x32_bf16 v[72:75], a[220:223], a[152:155], v[72:75]
    buffer_load_dwordx4 v6, s[4:7], s20 offen lds
    v_mfma_f32_16x16x32_bf16 v[80:83], a[220:223], a[176:179], 0
    s_add_u32 s20, s20, 128
    v_exp_f32 v53, v53
    v_mfma_f32_16x16x32_bf16 v[80:83], a[216:219], a[172:175], v[80:83]
    v_exp_f32 v52, v52
    v_mfma_f32_16x16x32_bf16 v[80:83], a[212:215], a[168:171], v[80:83]
    s_add_u32 m0, s22, 1024
    ds_read_b64_tr_b16 a[212:213], v2 offset:18432
    v_fma_f32 v61, v61, s28, v10
    v_mfma_f32_16x16x32_bf16 v[80:83], a[224:227], a[180:183], v[80:83]
    buffer_load_dwordx4 v6, s[4:7], s20 offen lds
    v_mfma_f32_16x16x32_bf16 v[80:83], a[228:231], a[184:187], v[80:83]
    s_add_u32 s20, s20, 128
    ds_read_b64_tr_b16 a[214:215], v2 offset:12288
    v_fma_f32 v55, v55, s28, v9
    v_mfma_f32_16x16x32_bf16 v[80:83], a[232:235], a[188:191], v[80:83]
    s_add_u32 m0, s22, 2048
    v_exp_f32 v55, v55
    v_mfma_f32_16x16x32_bf16 v[72:75], a[232:235], a[164:167], v[72:75]
    buffer_load_dwordx4 v6, s[4:7], s20 offen lds
    v_mfma_f32_16x16x32_bf16 v[72:75], a[228:231], a[160:163], v[72:75]
    v_exp_f32 v54, v54
    v_mfma_f32_16x16x32_bf16 v[72:75], a[224:227], a[156:159], v[72:75]
    v_exp_f32 v60, v60
    v_mfma_f32_16x16x32_bf16 v[64:67], a[224:227], a[132:135], v[64:67]
    ds_read_b64_tr_b16 a[216:217], v3 offset:18432
    v_mfma_f32_16x16x32_bf16 v[64:67], a[228:231], a[136:139], v[64:67]
    s_add_u32 s20, s20, 12032
    ds_read_b64_tr_b16 a[218:219], v3 offset:12288
    v_cvt_pk_bf16_f32 v14, v52, v53
    v_mfma_f32_16x16x32_bf16 v[64:67], a[232:235], a[140:143], v[64:67]
    ds_read_b64_tr_b16 a[220:221], v4 offset:18432
    v_cvt_pk_bf16_f32 v15, v54, v55
    v_mfma_f32_16x16x32_bf16 v[56:59], a[232:235], a[116:119], v[56:59]
    s_add_u32 s30, s30, 1
    v_exp_f32 v61, v61
    v_mfma_f32_16x16x32_bf16 v[56:59], a[228:231], a[112:115], v[56:59]
    s_cmp_lt_u32 s30, 6
    ds_read_b64_tr_b16 a[222:223], v4 offset:12288
    v_cvt_pk_bf16_f32 v20, v60, v61
    v_mfma_f32_16x16x32_bf16 v[56:59], a[224:227], a[108:111], v[56:59]
    s_waitcnt lgkmcnt(4)
    ds_read_b64_tr_b16 a[224:225], v5 offset:18432
    ds_read_b64_tr_b16 a[226:227], v5 offset:12288
    s_cbranch_scc1 L_loop4w0
    s_cmp_ge_u32 s37, 6
    s_cbranch_scc1 L_end4
    s_cmp_eq_u32 s32, 0
    s_cbranch_scc1 L_tr44
    s_branch L_tr45
L_tr45:
    v_mfma_f32_16x16x32_bf16 v[112:115], a[212:215], v[16:19], v[112:115]
    v_fma_f32 v58, v58, s28, v9
    v_mbcnt_lo_u32_b32 v107, -1, 0
    v_mfma_f32_16x16x32_bf16 v[160:163], a[212:215], v[22:25], v[160:163]
    v_mbcnt_hi_u32_b32 v107, -1, v107
    v_fma_f32 v64, v64, s28, v10
    v_mfma_f32_16x16x32_bf16 v[208:211], a[212:215], v[28:31], v[208:211]
    v_fma_f32 v67, v67, s28, v10
    v_fma_f32 v82, v82, s28, v12
    v_mfma_f32_16x16x32_bf16 a[0:3], a[212:215], v[34:37], a[0:3]
    ds_read_b64_tr_b16 a[234:235], v3 offset:13312
    v_fma_f32 v70, v70, s28, v11
    s_waitcnt lgkmcnt(5)
    v_mfma_f32_16x16x32_bf16 a[4:7], a[216:219], v[34:37], a[4:7]
    ds_read_b64_tr_b16 a[230:231], v2 offset:13312
    v_and_b32 v106, 15, v107
    v_mfma_f32_16x16x32_bf16 v[212:215], a[216:219], v[28:31], v[212:215]
    ds_read_b64_tr_b16 a[228:229], v2 offset:19456
    v_mul_u32_u24 v106, 384, v106
    v_mfma_f32_16x16x32_bf16 v[164:167], a[216:219], v[22:25], v[164:167]
    s_add_u32 s39, s39, 12288
    v_fma_f32 v65, v65, s28, v10
    v_lshrrev_b32 v107, 4, v107
    v_mfma_f32_16x16x32_bf16 v[116:119], a[216:219], v[16:19], v[116:119]
    ds_read_b64_tr_b16 a[214:215], v4 offset:13312
    s_waitcnt lgkmcnt(6)
    v_mfma_f32_16x16x32_bf16 v[120:123], a[220:223], v[16:19], v[120:123]
    ds_read_b64_tr_b16 a[232:233], v3 offset:19456
    v_lshl_add_u32 v106, v107, 4, v106
    v_mfma_f32_16x16x32_bf16 v[168:171], a[220:223], v[22:25], v[168:171]
    s_add_u32 s48, s33, 24576
    ds_read_b64_tr_b16 a[212:213], v4 offset:19456
    v_fma_f32 v56, v56, s28, v9
    v_mfma_f32_16x16x32_bf16 v[216:219], a[220:223], v[28:31], v[216:219]
    buffer_load_dwordx4 a[208:211], v106, s[12:15], s48 offen offset:256 nt
    v_mfma_f32_16x16x32_bf16 a[8:11], a[220:223], v[34:37], a[8:11]
    s_waitcnt lgkmcnt(6)
    ds_read_b64_tr_b16 a[216:217], v5 offset:19456
    v_fma_f32 v68, v68, s28, v11
    v_mfma_f32_16x16x32_bf16 a[12:15], a[224:227], v[34:37], a[12:15]
    buffer_load_dwordx4 v[92:95], v106, s[12:15], s48 offen offset:320 nt
    v_fma_f32 v77, v77, s28, v12
    v_mfma_f32_16x16x32_bf16 v[220:223], a[224:227], v[28:31], v[220:223]
    v_exp_f32 v64, v64
    v_mfma_f32_16x16x32_bf16 v[172:175], a[224:227], v[22:25], v[172:175]
    ds_read_b64_tr_b16 a[222:223], v2 offset:14336
    v_fma_f32 v69, v69, s28, v11
    v_mfma_f32_16x16x32_bf16 v[124:127], a[224:227], v[16:19], v[124:127]
    s_waitcnt lgkmcnt(5)
    ds_read_b64_tr_b16 a[218:219], v5 offset:13312
    v_fma_f32 v79, v79, s28, v12
    v_mfma_f32_16x16x32_bf16 v[128:131], a[228:231], v[16:19], v[128:131]
    ds_read_b64_tr_b16 a[224:225], v3 offset:20480
    v_fma_f32 v76, v76, s28, v12
    v_mfma_f32_16x16x32_bf16 v[176:179], a[228:231], v[22:25], v[176:179]
    v_exp_f32 v56, v56
    v_mfma_f32_16x16x32_bf16 v[224:227], a[228:231], v[28:31], v[224:227]
    ds_read_b128 v[88:91], v103 offset:0
    v_fma_f32 v63, v63, s28, v10
    v_mfma_f32_16x16x32_bf16 a[16:19], a[228:231], v[34:37], a[16:19]
    s_waitcnt lgkmcnt(5)
    ds_read_b64_tr_b16 a[226:227], v3 offset:14336
    v_fma_f32 v71, v71, s28, v11
    v_mfma_f32_16x16x32_bf16 a[20:23], a[232:235], v[34:37], a[20:23]
    ds_read_b64_tr_b16 a[220:221], v2 offset:20480
    v_fma_f32 v66, v66, s28, v10
    v_mfma_f32_16x16x32_bf16 v[228:231], a[232:235], v[28:31], v[228:231]
    ds_read_b64_tr_b16 a[230:231], v4 offset:14336
    v_fma_f32 v78, v78, s28, v12
    v_mfma_f32_16x16x32_bf16 v[180:183], a[232:235], v[22:25], v[180:183]
    ds_read_b64_tr_b16 a[228:229], v4 offset:20480
    v_fma_f32 v62, v62, s28, v10
    v_mfma_f32_16x16x32_bf16 v[132:135], a[232:235], v[16:19], v[132:135]
    ds_read_b64_tr_b16 a[232:233], v5 offset:20480
    v_fma_f32 v74, v74, s28, v11
    v_mfma_f32_16x16x32_bf16 v[136:139], a[212:215], v[16:19], v[136:139]
    ds_read_b64_tr_b16 a[234:235], v5 offset:14336
    v_fma_f32 v75, v75, s28, v11
    v_mfma_f32_16x16x32_bf16 v[184:187], a[212:215], v[22:25], v[184:187]
    v_exp_f32 v76, v76
    v_mfma_f32_16x16x32_bf16 v[232:235], a[212:215], v[28:31], v[232:235]
    v_exp_f32 v77, v77
    v_mfma_f32_16x16x32_bf16 a[24:27], a[212:215], v[34:37], a[24:27]
    s_waitcnt lgkmcnt(7)
    v_exp_f32 v63, v63
    v_mfma_f32_16x16x32_bf16 a[28:31], a[216:219], v[34:37], a[28:31]
    ds_read_b128 v[96:99], v103 offset:1024
    v_fma_f32 v59, v59, s28, v9
    v_mfma_f32_16x16x32_bf16 v[236:239], a[216:219], v[28:31], v[236:239]
    v_exp_f32 v75, v75
    v_mfma_f32_16x16x32_bf16 v[188:191], a[216:219], v[22:25], v[188:191]
    v_exp_f32 v68, v68
    v_mfma_f32_16x16x32_bf16 v[140:143], a[216:219], v[16:19], v[140:143]
    s_waitcnt lgkmcnt(4)
    v_exp_f32 v62, v62
    v_mfma_f32_16x16x32_bf16 v[144:147], a[220:223], v[16:19], v[144:147]
    v_exp_f32 v65, v65
    v_mfma_f32_16x16x32_bf16 v[192:195], a[220:223], v[22:25], v[192:195]
    v_exp_f32 v74, v74
    v_mfma_f32_16x16x32_bf16 v[240:243], a[220:223], v[28:31], v[240:243]
    s_waitcnt vmcnt(12) lgkmcnt(1)
    v_fma_f32 v80, v80, s28, v12
    s_add_u32 m0, s22, 36864
    v_mfma_f32_16x16x32_bf16 a[32:35], a[220:223], v[34:37], a[32:35]
    s_barrier
    v_mfma_f32_16x16x32_bf16 a[36:39], a[224:227], v[34:37], a[36:39]
    buffer_load_dwordx4 v6, s[8:11], s21 offen lds
    v_mfma_f32_16x16x32_bf16 v[244:247], a[224:227], v[28:31], v[244:247]
    s_add_u32 s21, s21, 128
    ds_read_b128 a[212:215], v0 offset:12288
    v_cvt_pk_bf16_f32 v21, v62, v63
    v_mfma_f32_16x16x32_bf16 v[196:199], a[224:227], v[22:25], v[196:199]
    ds_read_b128 a[216:219], v1 offset:12288
    v_fma_f32 v81, v81, s28, v12
    v_mfma_f32_16x16x32_bf16 v[148:151], a[224:227], v[16:19], v[148:151]
    s_add_u32 m0, s22, 37888
    v_exp_f32 v69, v69
    v_mfma_f32_16x16x32_bf16 v[152:155], a[228:231], v[16:19], v[152:155]
    buffer_load_dwordx4 v6, s[8:11], s21 offen lds
    v_mfma_f32_16x16x32_bf16 v[200:203], a[228:231], v[22:25], v[200:203]
    s_add_u32 s21, s21, 128
    ds_read_b128 a[220:223], v0 offset:13312
    v_cvt_pk_bf16_f32 v26, v68, v69
    v_mfma_f32_16x16x32_bf16 v[248:251], a[228:231], v[28:31], v[248:251]
    v_exp_f32 v71, v71
    v_mfma_f32_16x16x32_bf16 a[40:43], a[228:231], v[34:37], a[40:43]
    v_exp_f32 v67, v67
    v_mfma_f32_16x16x32_bf16 a[44:47], a[232:235], v[34:37], a[44:47]
    s_add_u32 m0, s22, 38912
    v_exp_f32 v70, v70
    v_mfma_f32_16x16x32_bf16 v[252:255], a[232:235], v[28:31], v[252:255]
    buffer_load_dwordx4 v6, s[8:11], s21 offen lds
    v_mfma_f32_16x16x32_bf16 v[204:207], a[232:235], v[22:25], v[204:207]
    buffer_store_dwordx4 v[88:91], v6, s[16:19], s24 offen offset:0 nt
    ds_read_b128 a[224:227], v1 offset:13312
    v_exp_f32 v66, v66
    v_mfma_f32_16x16x32_bf16 v[156:159], a[232:235], v[16:19], v[156:159]
    s_waitcnt lgkmcnt(2)
    ds_read_b128 a[228:231], v0 offset:14336
    v_fma_f32 v57, v57, s28, v9
    v_mfma_f32_16x16x32_bf16 v[52:55], a[212:215], a[96:99], 0
    buffer_store_dwordx4 v[96:99], v7, s[16:19], s24 offen offset:0 nt
    s_add_u32 s21, s21, 12032
    ds_read_b128 a[232:235], v1 offset:14336
    v_exp_f32 v57, v57
    v_mfma_f32_16x16x32_bf16 v[52:55], a[216:219], a[100:103], v[52:55]
    s_waitcnt lgkmcnt(3)
    v_exp_f32 v78, v78
    v_mfma_f32_16x16x32_bf16 v[52:55], a[220:223], a[104:107], v[52:55]
    v_cvt_pk_bf16_f32 v23, v66, v67
    v_cvt_pk_bf16_f32 v27, v70, v71
    v_mfma_f32_16x16x32_bf16 v[60:63], a[220:223], a[128:131], 0
    v_exp_f32 v79, v79
    v_mfma_f32_16x16x32_bf16 v[60:63], a[216:219], a[124:127], v[60:63]
    ds_read_b128 v[84:87], v103 offset:2048
    v_fma_f32 v83, v83, s28, v12
    v_mfma_f32_16x16x32_bf16 v[60:63], a[212:215], a[120:123], v[60:63]
    v_cvt_pk_bf16_f32 v33, v78, v79
    s_add_u32 m0, s38, 24576
    v_mfma_f32_16x16x32_bf16 v[68:71], a[212:215], a[144:147], 0
    v_cvt_pk_bf16_f32 v22, v64, v65
    v_cvt_pk_bf16_f32 v16, v56, v57
    v_mfma_f32_16x16x32_bf16 v[68:71], a[216:219], a[148:151], v[68:71]
    v_cvt_pk_bf16_f32 v32, v76, v77
    v_fma_f32 v72, v72, s28, v11
    v_mfma_f32_16x16x32_bf16 v[68:71], a[220:223], a[152:155], v[68:71]
    v_exp_f32 v59, v59
    v_mfma_f32_16x16x32_bf16 v[76:79], a[220:223], a[176:179], 0
    v_exp_f32 v82, v82
    v_mfma_f32_16x16x32_bf16 v[76:79], a[216:219], a[172:175], v[76:79]
    v_exp_f32 v58, v58
    v_mfma_f32_16x16x32_bf16 v[76:79], a[212:215], a[168:171], v[76:79]
    s_waitcnt lgkmcnt(1)
    v_exp_f32 v83, v83
    v_mfma_f32_16x16x32_bf16 v[76:79], a[224:227], a[180:183], v[76:79]
    v_exp_f32 v81, v81
    v_mfma_f32_16x16x32_bf16 v[76:79], a[228:231], a[184:187], v[76:79]
    ds_read_b128 a[216:219], v1 offset:18432
    v_fma_f32 v73, v73, s28, v11
    v_mfma_f32_16x16x32_bf16 v[76:79], a[232:235], a[188:191], v[76:79]
    buffer_load_dwordx4 v6, s[12:15], s25 offen nt lds
    v_mfma_f32_16x16x32_bf16 v[68:71], a[232:235], a[164:167], v[68:71]
    s_add_u32 m0, s38, 25600
    ds_read_b128 v[88:91], v103 offset:3072
    v_mfma_f32_16x16x32_bf16 v[68:71], a[228:231], a[160:163], v[68:71]
    v_exp_f32 v80, v80
    v_mfma_f32_16x16x32_bf16 v[68:71], a[224:227], a[156:159], v[68:71]
    ds_read_b128 a[212:215], v0 offset:18432
    v_cvt_pk_bf16_f32 v34, v80, v81
    v_mfma_f32_16x16x32_bf16 v[60:63], a[224:227], a[132:135], v[60:63]
    ds_read_b128 a[220:223], v0 offset:19456
    v_cvt_pk_bf16_f32 v29, v74, v75
    v_mfma_f32_16x16x32_bf16 v[60:63], a[228:231], a[136:139], v[60:63]
    v_exp_f32 v72, v72
    v_mfma_f32_16x16x32_bf16 v[60:63], a[232:235], a[140:143], v[60:63]
    buffer_load_dwordx4 v7, s[12:15], s25 offen nt lds
    v_mfma_f32_16x16x32_bf16 v[52:55], a[232:235], a[116:119], v[52:55]
    v_exp_f32 v73, v73
    v_mfma_f32_16x16x32_bf16 v[52:55], a[228:231], a[112:115], v[52:55]
    ds_read_b128 a[232:235], v1 offset:20480
    v_cvt_pk_bf16_f32 v17, v58, v59
    v_mfma_f32_16x16x32_bf16 v[52:55], a[224:227], a[108:111], v[52:55]
    s_add_u32 s57, s24, 128
    ds_read_b128 a[228:231], v0 offset:20480
    s_add_u32 s59, s25, 128
    v_mfma_f32_16x16x32_bf16 v[44:47], a[236:239], v[14:17], v[48:51]
    s_add_u32 m0, s38, 26624
    ds_read_b128 a[224:227], v1 offset:19456
    v_cvt_pk_bf16_f32 v28, v72, v73
    v_mfma_f32_16x16x32_bf16 v[44:47], a[240:243], v[20:23], v[44:47]
    v_cvt_pk_bf16_f32 v35, v82, v83
    v_mfma_f32_16x16x32_bf16 v[44:47], a[244:247], v[26:29], v[44:47]
    s_nop 0
    v_mfma_f32_16x16x32_bf16 v[44:47], a[248:251], v[32:35], v[44:47]
    s_waitcnt lgkmcnt(4)
    v_mfma_f32_16x16x32_bf16 v[56:59], a[212:215], a[96:99], 0
    buffer_load_dwordx4 v6, s[12:15], s59 offen nt lds
    v_mfma_f32_16x16x32_bf16 v[56:59], a[216:219], a[100:103], v[56:59]
    s_waitcnt lgkmcnt(3)
    v_mfma_f32_16x16x32_bf16 v[56:59], a[220:223], a[104:107], v[56:59]
    v_mfma_f32_16x16x32_bf16 v[64:67], a[220:223], a[128:131], 0
    s_nop 0
    v_cmp_lt_f32 vcc, s29, v44
    s_add_u32 m0, s38, 27648
    v_mfma_f32_16x16x32_bf16 v[64:67], a[216:219], a[124:127], v[64:67]
    buffer_load_dwordx4 v7, s[12:15], s59 offen nt lds
    v_mfma_f32_16x16x32_bf16 v[64:67], a[212:215], a[120:123], v[64:67]
    buffer_store_dwordx4 v[84:87], v6, s[16:19], s57 offen offset:0 nt
    s_waitcnt vmcnt(15) lgkmcnt(0)
    s_cbranch_vccnz L_rs_tr45a
L_ret_tr45a:
    v_fma_f32 v61, v61, s28, v10
    s_add_u32 m0, s22, 12288
    v_mfma_f32_16x16x32_bf16 v[72:75], a[212:215], a[144:147], 0
    s_barrier
    v_mfma_f32_16x16x32_bf16 v[72:75], a[216:219], a[148:151], v[72:75]
    buffer_load_dwordx4 v6, s[4:7], s20 offen lds
    v_mfma_f32_16x16x32_bf16 v[72:75], a[220:223], a[152:155], v[72:75]
    s_add_u32 s20, s20, 128
    v_fma_f32 v52, v52, s28, v9
    v_fma_f32 v53, v53, s28, v9
    v_mfma_f32_16x16x32_bf16 v[80:83], a[220:223], a[176:179], 0
    s_add_u32 m0, s22, 13312
    v_exp_f32 v52, v52
    v_mfma_f32_16x16x32_bf16 v[80:83], a[216:219], a[172:175], v[80:83]
    buffer_load_dwordx4 v6, s[4:7], s20 offen lds
    v_mfma_f32_16x16x32_bf16 v[80:83], a[212:215], a[168:171], v[80:83]
    s_add_u32 s20, s20, 128
    v_exp_f32 v61, v61
    v_mfma_f32_16x16x32_bf16 v[80:83], a[224:227], a[180:183], v[80:83]
    s_add_u32 m0, s22, 14336
    ds_read_b64_tr_b16 a[212:213], v2 offset:0
    v_fma_f32 v54, v54, s28, v9
    v_mfma_f32_16x16x32_bf16 v[80:83], a[228:231], a[184:187], v[80:83]
    buffer_load_dwordx4 v6, s[4:7], s20 offen lds
    v_mfma_f32_16x16x32_bf16 v[80:83], a[232:235], a[188:191], v[80:83]
    ds_read_b64_tr_b16 a[214:215], v2 offset:6144
    v_mfma_f32_16x16x32_bf16 v[72:75], a[232:235], a[164:167], v[72:75]
    ds_read_b64_tr_b16 a[216:217], v3 offset:0
    v_fma_f32 v55, v55, s28, v9
    v_mfma_f32_16x16x32_bf16 v[72:75], a[228:231], a[160:163], v[72:75]
    ds_read_b64_tr_b16 a[218:219], v3 offset:6144
    v_fma_f32 v60, v60, s28, v10
    v_mfma_f32_16x16x32_bf16 v[72:75], a[224:227], a[156:159], v[72:75]
    v_exp_f32 v60, v60
    v_mfma_f32_16x16x32_bf16 v[64:67], a[224:227], a[132:135], v[64:67]
    v_exp_f32 v55, v55
    v_mfma_f32_16x16x32_bf16 v[64:67], a[228:231], a[136:139], v[64:67]
    ds_read_b64_tr_b16 a[220:221], v4 offset:0
    v_cvt_pk_bf16_f32 v24, v60, v61
    v_mfma_f32_16x16x32_bf16 v[64:67], a[232:235], a[140:143], v[64:67]
    v_exp_f32 v54, v54
    v_mfma_f32_16x16x32_bf16 v[56:59], a[232:235], a[116:119], v[56:59]
    v_exp_f32 v53, v53
    v_mfma_f32_16x16x32_bf16 v[56:59], a[228:231], a[112:115], v[56:59]
    ds_read_b64_tr_b16 a[222:223], v4 offset:6144
    v_cvt_pk_bf16_f32 v19, v54, v55
    v_mfma_f32_16x16x32_bf16 v[56:59], a[224:227], a[108:111], v[56:59]
    buffer_store_dwordx4 v[88:91], v7, s[16:19], s57 offen offset:0 nt
    s_waitcnt lgkmcnt(4)
    s_add_u32 s20, s20, 12032
    ds_read_b64_tr_b16 a[224:225], v5 offset:0
    ds_read_b64_tr_b16 a[226:227], v5 offset:6144
    v_cvt_pk_bf16_f32 v18, v52, v53
    v_fma_f32 v81, v81, s28, v12
    v_mfma_f32_16x16x32_bf16 v[112:115], a[212:215], v[14:17], v[112:115]
    ds_read_b64_tr_b16 a[230:231], v2 offset:7168
    v_fma_f32 v65, v65, s28, v10
    v_mfma_f32_16x16x32_bf16 v[160:163], a[212:215], v[20:23], v[160:163]
    ds_read_b64_tr_b16 a[228:229], v2 offset:1024
    v_fma_f32 v57, v57, s28, v9
    v_mfma_f32_16x16x32_bf16 v[208:211], a[212:215], v[26:29], v[208:211]
    v_fma_f32 v77, v77, s28, v12
    v_fma_f32 v59, v59, s28, v9
    v_fma_f32 v72, v72, s28, v11
    v_fma_f32 v71, v71, s28, v11
    v_mfma_f32_16x16x32_bf16 a[0:3], a[212:215], v[32:35], a[0:3]
    s_waitcnt lgkmcnt(6)
    ds_read_b64_tr_b16 a[234:235], v3 offset:7168
    v_fma_f32 v82, v82, s28, v12
    v_mfma_f32_16x16x32_bf16 a[4:7], a[216:219], v[32:35], a[4:7]
    v_exp_f32 v59, v59
    v_mfma_f32_16x16x32_bf16 v[212:215], a[216:219], v[26:29], v[212:215]
    v_exp_f32 v77, v77
    v_mfma_f32_16x16x32_bf16 v[164:167], a[216:219], v[20:23], v[164:167]
    v_fma_f32 v78, v78, s28, v12
    v_fma_f32 v63, v63, s28, v10
    v_mfma_f32_16x16x32_bf16 v[116:119], a[216:219], v[14:17], v[116:119]
    s_waitcnt lgkmcnt(5)
    ds_read_b64_tr_b16 a[212:213], v4 offset:1024
    v_and_b32 v104, 0x3ff, v0
    v_mfma_f32_16x16x32_bf16 v[120:123], a[220:223], v[14:17], v[120:123]
    ds_read_b64_tr_b16 a[232:233], v3 offset:1024
    v_lshrrev_b32 v105, 11, v0
    v_mfma_f32_16x16x32_bf16 v[168:171], a[220:223], v[20:23], v[168:171]
    v_exp_f32 v71, v71
    v_mfma_f32_16x16x32_bf16 v[216:219], a[220:223], v[26:29], v[216:219]
    ds_read_b64_tr_b16 a[216:217], v5 offset:1024
    v_fma_f32 v76, v76, s28, v12
    v_mfma_f32_16x16x32_bf16 a[8:11], a[220:223], v[32:35], a[8:11]
    s_waitcnt lgkmcnt(4)
    ds_read_b64_tr_b16 a[214:215], v4 offset:7168
    v_fma_f32 v73, v73, s28, v11
    v_mfma_f32_16x16x32_bf16 a[12:15], a[224:227], v[32:35], a[12:15]
    v_exp_f32 v78, v78
    v_mfma_f32_16x16x32_bf16 v[220:223], a[224:227], v[26:29], v[220:223]
    v_exp_f32 v65, v65
    v_mfma_f32_16x16x32_bf16 v[172:175], a[224:227], v[20:23], v[172:175]
    ds_read_b64_tr_b16 a[218:219], v5 offset:7168
    v_xor_b32 v105, s65, v105
    v_mfma_f32_16x16x32_bf16 v[124:127], a[224:227], v[14:17], v[124:127]
    ds_read_b64_tr_b16 a[226:227], v3 offset:8192
    v_fma_f32 v56, v56, s28, v9
    v_mfma_f32_16x16x32_bf16 v[128:131], a[228:231], v[14:17], v[128:131]
    ds_read_b64_tr_b16 a[220:221], v2 offset:2048
    v_fma_f32 v69, v69, s28, v11
    v_mfma_f32_16x16x32_bf16 v[176:179], a[228:231], v[20:23], v[176:179]
    ds_read_b64_tr_b16 a[222:223], v2 offset:8192
    v_mfma_f32_16x16x32_bf16 v[224:227], a[228:231], v[26:29], v[224:227]
    v_exp_f32 v63, v63
    v_mfma_f32_16x16x32_bf16 a[16:19], a[228:231], v[32:35], a[16:19]
    s_waitcnt lgkmcnt(6)
    ds_read_b64_tr_b16 a[230:231], v4 offset:8192
    v_lshl_add_u32 v104, v105, 10, v104
    v_mfma_f32_16x16x32_bf16 a[20:23], a[232:235], v[32:35], a[20:23]
    v_fma_f32 v83, v83, s28, v12
    v_fma_f32 v64, v64, s28, v10
    v_mfma_f32_16x16x32_bf16 v[228:231], a[232:235], v[26:29], v[228:231]
    ds_read_b64_tr_b16 a[228:229], v4 offset:2048
    v_fma_f32 v79, v79, s28, v12
    v_mfma_f32_16x16x32_bf16 v[180:183], a[232:235], v[20:23], v[180:183]
    ds_read_b64_tr_b16 a[224:225], v3 offset:2048
    v_add_u32 v104, s38, v104
    v_mfma_f32_16x16x32_bf16 v[132:135], a[232:235], v[14:17], v[132:135]
    s_waitcnt lgkmcnt(7)
    ds_read_b64_tr_b16 a[234:235], v5 offset:8192
    v_fma_f32 v67, v67, s28, v10
    v_mfma_f32_16x16x32_bf16 v[136:139], a[212:215], v[14:17], v[136:139]
    ds_read_b64_tr_b16 a[232:233], v5 offset:2048
    v_xor_b32 v105, 64, v104
    v_mfma_f32_16x16x32_bf16 v[184:187], a[212:215], v[20:23], v[184:187]
    s_add_u32 s39, s39, 12288
    v_exp_f32 v79, v79
    v_mfma_f32_16x16x32_bf16 v[232:235], a[212:215], v[26:29], v[232:235]
    ds_read_b128 a[168:171], v104 offset:18432
    v_fma_f32 v62, v62, s28, v10
    v_mfma_f32_16x16x32_bf16 a[24:27], a[212:215], v[32:35], a[24:27]
    s_waitcnt lgkmcnt(6)
    ds_read_b128 a[100:103], v105 offset:0
    v_fma_f32 v80, v80, s28, v12
    v_mfma_f32_16x16x32_bf16 a[28:31], a[216:219], v[32:35], a[28:31]
    ds_read_b128 a[172:175], v105 offset:18432
    v_exp_f32 v57, v57
    v_mfma_f32_16x16x32_bf16 v[236:239], a[216:219], v[26:29], v[236:239]
    v_exp_f32 v62, v62
    v_mfma_f32_16x16x32_bf16 v[188:191], a[216:219], v[20:23], v[188:191]
    ds_read_b128 a[128:131], v104 offset:8192
    v_fma_f32 v68, v68, s28, v11
    v_mfma_f32_16x16x32_bf16 v[140:143], a[216:219], v[14:17], v[140:143]
    ds_read_b128 a[132:135], v105 offset:8192
    v_cvt_pk_bf16_f32 v37, v78, v79
    v_mfma_f32_16x16x32_bf16 v[144:147], a[220:223], v[14:17], v[144:147]
    ds_read_b128 a[152:155], v104 offset:14336
    v_fma_f32 v70, v70, s28, v11
    v_exp_f32 v70, v70
    v_mfma_f32_16x16x32_bf16 v[192:195], a[220:223], v[20:23], v[192:195]
    s_waitcnt vmcnt(16) lgkmcnt(6)
    ds_read_b128 a[148:151], v105 offset:12288
    v_cvt_pk_bf16_f32 v25, v62, v63
    v_mfma_f32_16x16x32_bf16 v[240:243], a[220:223], v[26:29], v[240:243]
    s_add_u32 s21, s21, s62
    v_exp_f32 v68, v68
    v_mfma_f32_16x16x32_bf16 a[32:35], a[220:223], v[32:35], a[32:35]
    s_barrier
    ds_read_b128 a[212:215], v0 offset:0
    v_mfma_f32_16x16x32_bf16 a[36:39], a[224:227], v[32:35], a[36:39]
    s_add_u32 m0, s22, 24576
    ds_read_b128 a[120:123], v104 offset:6144
    buffer_load_dwordx4 v6, s[8:11], s21 offen lds
    v_mfma_f32_16x16x32_bf16 v[244:247], a[224:227], v[26:29], v[244:247]
    s_add_u32 s21, s21, 128
    ds_read_b128 a[96:99], v104 offset:0
    v_fma_f32 v74, v74, s28, v11
    v_mfma_f32_16x16x32_bf16 v[196:199], a[224:227], v[20:23], v[196:199]
    s_add_u32 m0, s22, 25600
    ds_read_b128 a[144:147], v104 offset:12288
    buffer_load_dwordx4 v6, s[8:11], s21 offen lds
    v_mfma_f32_16x16x32_bf16 v[148:151], a[224:227], v[14:17], v[148:151]
    ds_read_b128 a[216:219], v1 offset:0
    s_add_u32 s21, s21, 128
    v_mfma_f32_16x16x32_bf16 v[152:155], a[228:231], v[14:17], v[152:155]
    s_add_u32 m0, s22, 26624
    ds_read_b128 a[176:179], v104 offset:20480
    buffer_load_dwordx4 v6, s[8:11], s21 offen lds
    v_mfma_f32_16x16x32_bf16 v[200:203], a[228:231], v[20:23], v[200:203]
    s_add_u32 s21, s21, 12032
    s_waitcnt vmcnt(10)
    ds_read_b128 a[192:195], v104 offset:24576
    v_mfma_f32_16x16x32_bf16 v[248:251], a[228:231], v[26:29], v[248:251]
    ds_read_b128 a[124:127], v105 offset:6144
    v_exp_f32 v76, v76
    v_mfma_f32_16x16x32_bf16 a[40:43], a[228:231], v[32:35], a[40:43]
    ds_read_b128 a[220:223], v0 offset:1024
    v_cvt_pk_bf16_f32 v36, v76, v77
    v_mfma_f32_16x16x32_bf16 a[44:47], a[232:235], v[32:35], a[44:47]
    s_waitcnt vmcnt(8)
    ds_read_b128 a[196:199], v105 offset:24576
    v_cvt_pk_bf16_f32 v31, v70, v71
    v_mfma_f32_16x16x32_bf16 v[252:255], a[232:235], v[26:29], v[252:255]
    ds_read_b128 a[160:163], v104 offset:16384
    v_exp_f32 v72, v72
    v_mfma_f32_16x16x32_bf16 v[204:207], a[232:235], v[20:23], v[204:207]
    ds_read_b128 a[204:207], v105 offset:26624
    v_exp_f32 v69, v69
    v_mfma_f32_16x16x32_bf16 v[156:159], a[232:235], v[14:17], v[156:159]
    s_waitcnt lgkmcnt(8)
    ds_read_b128 a[104:107], v104 offset:2048
    v_cvt_pk_bf16_f32 v30, v68, v69
    v_mfma_f32_16x16x32_bf16 v[52:55], a[212:215], a[96:99], 0
    ds_read_b128 a[180:183], v105 offset:20480
    v_fma_f32 v75, v75, s28, v11
    v_mfma_f32_16x16x32_bf16 v[60:63], a[212:215], a[120:123], 0
    ds_read_b128 a[108:111], v105 offset:2048
    v_fma_f32 v58, v58, s28, v9
    v_mfma_f32_16x16x32_bf16 v[68:71], a[212:215], a[144:147], 0
    ds_read_b128 a[200:203], v104 offset:26624
    v_mfma_f32_16x16x32_bf16 v[76:79], a[212:215], a[168:171], 0
    s_waitcnt lgkmcnt(8)
    ds_read_b128 a[224:227], v1 offset:1024
    v_mfma_f32_16x16x32_bf16 v[84:87], a[212:215], a[192:195], 0
    ds_read_b128 a[136:139], v104 offset:10240
    v_exp_f32 v58, v58
    v_mfma_f32_16x16x32_bf16 v[52:55], a[216:219], a[100:103], v[52:55]
    v_exp_f32 v73, v73
    v_mfma_f32_16x16x32_bf16 v[60:63], a[216:219], a[124:127], v[60:63]
    ds_read_b128 a[156:159], v105 offset:14336
    v_cvt_pk_bf16_f32 v17, v58, v59
    v_mfma_f32_16x16x32_bf16 v[68:71], a[216:219], a[148:151], v[68:71]
    v_exp_f32 v56, v56
    v_mfma_f32_16x16x32_bf16 v[76:79], a[216:219], a[172:175], v[76:79]
    s_waitcnt lgkmcnt(7)
    v_exp_f32 v64, v64
    v_mfma_f32_16x16x32_bf16 v[84:87], a[216:219], a[196:199], v[84:87]
    s_waitcnt lgkmcnt(6)
    ds_read_b128 a[228:231], v0 offset:6144
    v_cvt_pk_bf16_f32 v28, v72, v73
    v_mfma_f32_16x16x32_bf16 v[52:55], a[220:223], a[104:107], v[52:55]
    v_fma_f32 v66, v66, s28, v10
    v_cvt_pk_bf16_f32 v16, v56, v57
    v_mfma_f32_16x16x32_bf16 v[60:63], a[220:223], a[128:131], v[60:63]
    ds_read_b128 a[232:235], v1 offset:6144
    v_mfma_f32_16x16x32_bf16 v[68:71], a[220:223], a[152:155], v[68:71]
    v_exp_f32 v80, v80
    v_mfma_f32_16x16x32_bf16 v[76:79], a[220:223], a[176:179], v[76:79]
    v_exp_f32 v67, v67
    v_mfma_f32_16x16x32_bf16 v[48:51], a[236:239], v[16:19], v[44:47]
    s_waitcnt lgkmcnt(3)
    v_exp_f32 v75, v75
    v_mfma_f32_16x16x32_bf16 v[84:87], a[220:223], a[200:203], v[84:87]
    v_exp_f32 v82, v82
    v_mfma_f32_16x16x32_bf16 v[52:55], a[224:227], a[108:111], v[52:55]
    v_exp_f32 v81, v81
    v_mfma_f32_16x16x32_bf16 v[60:63], a[224:227], a[132:135], v[60:63]
    s_waitcnt lgkmcnt(2)
    v_exp_f32 v83, v83
    v_mfma_f32_16x16x32_bf16 v[68:71], a[224:227], a[156:159], v[68:71]
    ds_read_b128 a[220:223], v0 offset:2048
    v_cvt_pk_bf16_f32 v22, v64, v65
    v_mfma_f32_16x16x32_bf16 v[76:79], a[224:227], a[180:183], v[76:79]
    v_exp_f32 v66, v66
    v_mfma_f32_16x16x32_bf16 v[84:87], a[224:227], a[204:207], v[84:87]
    s_waitcnt lgkmcnt(2)
    v_exp_f32 v74, v74
    v_mfma_f32_16x16x32_bf16 v[56:59], a[228:231], a[96:99], 0
    v_cvt_pk_bf16_f32 v23, v66, v67
    v_cvt_pk_bf16_f32 v35, v82, v83
    v_mfma_f32_16x16x32_bf16 v[64:67], a[228:231], a[120:123], 0
    ds_read_b128 a[212:215], v0 offset:7168
    v_cvt_pk_bf16_f32 v29, v74, v75
    v_mfma_f32_16x16x32_bf16 v[48:51], a[240:243], v[22:25], v[48:51]
    ds_read_b128 a[116:119], v105 offset:4096
    v_mfma_f32_16x16x32_bf16 v[72:75], a[228:231], a[144:147], 0
    ds_read_b128 a[184:187], v104 offset:22528
    v_cvt_pk_bf16_f32 v34, v80, v81
    v_mfma_f32_16x16x32_bf16 v[80:83], a[228:231], a[168:171], 0
    v_mfma_f32_16x16x32_bf16 v[48:51], a[244:247], v[28:31], v[48:51]
    ds_read_b128 a[164:167], v105 offset:16384
    v_mfma_f32_16x16x32_bf16 v[48:51], a[248:251], v[34:37], v[48:51]
    ds_read_b128 a[216:219], v1 offset:7168
    v_mfma_f32_16x16x32_bf16 v[88:91], a[228:231], a[192:195], 0
    s_waitcnt lgkmcnt(5)
    ds_read_b128 a[112:115], v104 offset:4096
    v_mfma_f32_16x16x32_bf16 v[56:59], a[232:235], a[100:103], v[56:59]
    ds_read_b128 a[228:231], v0 offset:8192
    v_mfma_f32_16x16x32_bf16 v[64:67], a[232:235], a[124:127], v[64:67]
    ds_read_b128 a[224:227], v1 offset:2048
    v_mfma_f32_16x16x32_bf16 v[72:75], a[232:235], a[148:151], v[72:75]
    ds_read_b128 a[140:143], v105 offset:10240
    v_mfma_f32_16x16x32_bf16 v[80:83], a[232:235], a[172:175], v[80:83]
    ds_read_b128 a[188:191], v105 offset:22528
    v_mfma_f32_16x16x32_bf16 v[88:91], a[232:235], a[196:199], v[88:91]
    s_waitcnt lgkmcnt(8)
    ds_read_b128 a[232:235], v1 offset:8192
    v_cmp_lt_f32 vcc, s29, v48
    v_mfma_f32_16x16x32_bf16 v[56:59], a[212:215], a[104:107], v[56:59]
    v_mfma_f32_16x16x32_bf16 v[64:67], a[212:215], a[128:131], v[64:67]
    v_mfma_f32_16x16x32_bf16 v[72:75], a[212:215], a[152:155], v[72:75]
    s_waitcnt vmcnt(17)
    s_nop 0
    s_cbranch_vccnz L_rs_tr45b
L_ret_tr45b:
    v_mfma_f32_16x16x32_bf16 v[80:83], a[212:215], a[176:179], v[80:83]
    v_and_b32 v101, 0x3ff, v0
    v_lshrrev_b32 v108, 11, v0
    v_mfma_f32_16x16x32_bf16 v[88:91], a[212:215], a[200:203], v[88:91]
    s_waitcnt lgkmcnt(5)
    v_xor_b32 v108, s65, v108
    v_lshl_add_u32 v101, v108, 10, v101
    v_mfma_f32_16x16x32_bf16 v[56:59], a[216:219], a[108:111], v[56:59]
    v_mbcnt_lo_u32_b32 v108, -1, 0
    v_mfma_f32_16x16x32_bf16 v[64:67], a[216:219], a[132:135], v[64:67]
    v_rcp_f32 v102, v49
    v_mfma_f32_16x16x32_bf16 v[72:75], a[216:219], a[156:159], v[72:75]
    v_mbcnt_hi_u32_b32 v108, -1, v108
    v_mfma_f32_16x16x32_bf16 v[80:83], a[216:219], a[180:183], v[80:83]
    s_waitcnt vmcnt(14) lgkmcnt(0)
    v_mfma_f32_16x16x32_bf16 v[88:91], a[216:219], a[204:207], v[88:91]
    s_barrier
    v_mfma_f32_16x16x32_bf16 v[52:55], a[220:223], a[112:115], v[52:55]
    ds_read_b64_tr_b16 a[212:213], v2 offset:18432
    s_add_u32 m0, s22, 0
    v_mfma_f32_16x16x32_bf16 v[60:63], a[220:223], a[136:139], v[60:63]
    buffer_load_dwordx4 v6, s[4:7], s20 offen lds
    v_mfma_f32_16x16x32_bf16 v[68:71], a[220:223], a[160:163], v[68:71]
    s_add_u32 s20, s20, 128
    v_rcp_f32 v50, v50
    v_mfma_f32_16x16x32_bf16 v[76:79], a[220:223], a[184:187], v[76:79]
    v_lshrrev_b32 v108, 1, v108
    s_add_u32 m0, s22, 1024
    v_mfma_f32_16x16x32_bf16 v[84:87], a[220:223], a[208:211], v[84:87]
    buffer_load_dwordx4 v6, s[4:7], s20 offen lds
    v_mfma_f32_16x16x32_bf16 v[52:55], a[224:227], a[116:119], v[52:55]
    s_add_u32 s20, s20, 128
    s_add_u32 m0, s22, 2048
    v_and_b32 v108, 24, v108
    v_mfma_f32_16x16x32_bf16 v[60:63], a[224:227], a[140:143], v[60:63]
    buffer_load_dwordx4 v6, s[4:7], s20 offen lds
    v_mfma_f32_16x16x32_bf16 v[68:71], a[224:227], a[164:167], v[68:71]
    ds_read_b64_tr_b16 a[214:215], v2 offset:12288
    v_add_u32 v101, s38, v101
    v_mfma_f32_16x16x32_bf16 v[76:79], a[224:227], a[188:191], v[76:79]
    v_mov_b32 v100, v48
    v_bfe_u32 v108, s66, v108, 8
    v_mfma_f32_16x16x32_bf16 v[84:87], a[224:227], v[92:95], v[84:87]
    v_rcp_f32 v8, v51
    v_mfma_f32_16x16x32_bf16 v[56:59], a[228:231], a[112:115], v[56:59]
    s_add_u32 s20, s20, 12032
    ds_read_b64_tr_b16 a[216:217], v3 offset:18432
    v_mfma_f32_16x16x32_bf16 v[64:67], a[228:231], a[136:139], v[64:67]
    v_permlane32_swap_b32 v48, v100
    v_mfma_f32_16x16x32_bf16 v[72:75], a[228:231], a[160:163], v[72:75]
    v_mfma_f32_16x16x32_bf16 v[80:83], a[228:231], a[184:187], v[80:83]
    ds_read_b64_tr_b16 a[218:219], v3 offset:12288
    v_xor_b32 v101, v101, v108
    v_mfma_f32_16x16x32_bf16 v[88:91], a[228:231], a[208:211], v[88:91]
    ds_read_b64_tr_b16 a[220:221], v4 offset:18432
    v_mfma_f32_16x16x32_bf16 v[56:59], a[232:235], a[116:119], v[56:59]
    ds_read_b64_tr_b16 a[222:223], v4 offset:12288
    v_mfma_f32_16x16x32_bf16 v[64:67], a[232:235], a[140:143], v[64:67]
    ds_read_b64_tr_b16 a[224:225], v5 offset:18432
    v_mfma_f32_16x16x32_bf16 v[72:75], a[232:235], a[164:167], v[72:75]
    s_waitcnt lgkmcnt(5)
    v_mfma_f32_16x16x32_bf16 v[80:83], a[232:235], a[188:191], v[80:83]
    ds_read_b64_tr_b16 a[226:227], v5 offset:12288
    v_mfma_f32_16x16x32_bf16 v[88:91], a[232:235], v[92:95], v[88:91]
    v_rcp_f32 v48, v48
    v_mfma_f32_16x16x32_bf16 v[112:115], a[212:215], v[16:19], v[112:115]
    ds_read_b64_tr_b16 a[230:231], v2 offset:13312
    v_max3_f32 v98, v68, v69, v70
    v_max3_f32 v99, v76, v77, v78
    v_mfma_f32_16x16x32_bf16 v[160:163], a[212:215], v[22:25], v[160:163]
    s_mov_b32 s67, s34
    v_max3_f32 v97, v60, v61, v62
    v_max3_f32 v96, v52, v53, v54
    v_max3_f32 v98, v98, v71, v72
    v_max3_f32 v97, v97, v63, v64
    v_max3_f32 v99, v99, v79, v80
    v_max3_f32 v96, v96, v55, v56
    v_max3_f32 v99, v99, v81, v82
    v_max3_f32 v97, v97, v65, v66
    v_max_f32 v99, v99, v83
    v_mfma_f32_16x16x32_bf16 v[208:211], a[212:215], v[28:31], v[208:211]
    ds_read_b64_tr_b16 a[232:233], v3 offset:19456
    v_max3_f32 v98, v98, v73, v74
    v_mfma_f32_16x16x32_bf16 a[0:3], a[212:215], v[34:37], a[0:3]
    s_waitcnt lgkmcnt(6)
    ds_read_b64_tr_b16 a[214:215], v4 offset:13312
    v_max_f32 v97, v97, v67
    v_max3_f32 v96, v96, v57, v58
    v_mfma_f32_16x16x32_bf16 a[4:7], a[216:219], v[34:37], a[4:7]
    s_add_u32 s18, s34, 24576
    v_max_f32 v96, v96, v59
    v_max_f32 v98, v98, v75
    v_mfma_f32_16x16x32_bf16 v[212:215], a[216:219], v[28:31], v[212:215]
    s_mov_b32 s34, s33
    ds_read_b64_tr_b16 a[234:235], v3 offset:13312
    v_permlane32_swap_b32 v96, v97
    v_mfma_f32_16x16x32_bf16 v[164:167], a[216:219], v[22:25], v[164:167]
    s_add_u32 s64, s64, s62
    ds_read_b64_tr_b16 a[212:213], v4 offset:19456
    v_max_f32 v96, v96, v97
    v_permlane32_swap_b32 v98, v99
    v_mfma_f32_16x16x32_bf16 v[116:119], a[216:219], v[16:19], v[116:119]
    s_waitcnt lgkmcnt(4)
    ds_read_b64_tr_b16 a[228:229], v2 offset:19456
    v_accvgpr_read_b32 v107, a3
    v_max_f32 v98, v98, v99
    v_mfma_f32_16x16x32_bf16 v[120:123], a[220:223], v[16:19], v[120:123]
    s_add_u32 s64, s64, 196608
    v_permlane16_swap_b32 v96, v98
    v_mfma_f32_16x16x32_bf16 v[168:171], a[220:223], v[22:25], v[168:171]
    s_mov_b32 s39, s64
    v_max_f32 v96, v96, v98
    v_mul_f32_e64 v9, -s28, v96
    v_mfma_f32_16x16x32_bf16 v[216:219], a[220:223], v[28:31], v[216:219]
    s_add_u32 s37, s37, 1
    ds_read_b64_tr_b16 a[218:219], v5 offset:13312
    v_mov_b32 v11, v9
    v_max3_f32 v96, v84, v85, v86
    v_mfma_f32_16x16x32_bf16 a[8:11], a[220:223], v[34:37], a[8:11]
    s_bitcmp1_b32 s63, s37
    v_max3_f32 v96, v96, v87, v88
    v_max3_f32 v96, v96, v89, v90
    v_max_f32 v96, v96, v91
    v_mfma_f32_16x16x32_bf16 a[12:15], a[224:227], v[34:37], a[12:15]
    s_cselect_b32 s62, 4294770688, 0
    v_permlane16_swap_b32 v9, v11
    v_mov_b32 v12, v11
    v_mfma_f32_16x16x32_bf16 v[220:223], a[224:227], v[28:31], v[220:223]
    s_cselect_b32 s42, 0, 325632
    v_mov_b32 v10, v9
    v_mov_b32 v97, v96
    v_mfma_f32_16x16x32_bf16 v[172:175], a[224:227], v[22:25], v[172:175]
    s_add_u32 s35, s35, s42
    ds_read_b64_tr_b16 a[222:223], v2 offset:14336
    v_accvgpr_read_b32 v110, a6
    v_permlane32_swap_b32 v97, v96
    v_max_f32 v96, v96, v97
    v_pk_mul_f32 v[212:213], v[212:213], v[50:51] op_sel_hi:[1,0]
    v_permlane32_swap_b32 v9, v10
    v_mov_b32 v97, v96
    v_mfma_f32_16x16x32_bf16 v[124:127], a[224:227], v[16:19], v[124:127]
    s_waitcnt lgkmcnt(2)
    v_permlane32_swap_b32 v11, v12
    v_mfma_f32_16x16x32_bf16 v[128:131], a[228:231], v[16:19], v[128:131]
    s_lshl_b32 s42, s37, 1
    ds_read_b64_tr_b16 a[216:217], v5 offset:19456
    v_fma_f32 v55, v55, s28, v9
    v_mfma_f32_16x16x32_bf16 v[176:179], a[228:231], v[22:25], v[176:179]
    s_lshr_b32 s42, s31, s42
    ds_read_b64_tr_b16 a[220:221], v2 offset:20480
    v_fma_f32 v67, v67, s28, v10
    v_mfma_f32_16x16x32_bf16 v[224:227], a[228:231], v[28:31], v[224:227]
    s_and_b32 s42, s42, 3
    v_fma_f32 v62, v62, s28, v10
    v_fma_f32 v71, v71, s28, v11
    v_mfma_f32_16x16x32_bf16 a[16:19], a[228:231], v[34:37], a[16:19]
    s_add_u32 s42, s42, s36
    v_permlane16_swap_b32 v97, v96
    v_mfma_f32_16x16x32_bf16 a[20:23], a[232:235], v[34:37], a[20:23]
    s_sub_u32 s43, s42, 3
    v_fma_f32 v61, v61, s28, v10
    s_cmp_ge_u32 s42, 3
    v_mfma_f32_16x16x32_bf16 v[228:231], a[232:235], v[28:31], v[228:231]
    s_cselect_b32 s42, s43, s42
    ds_read_b64_tr_b16 a[228:229], v4 offset:20480
    v_exp_f32 v71, v71
    v_mfma_f32_16x16x32_bf16 v[180:183], a[232:235], v[22:25], v[180:183]
    s_mul_i32 s44, s3, 5
    ds_read_b64_tr_b16 a[230:231], v4 offset:14336
    v_fma_f32 v69, v69, s28, v11
    v_mfma_f32_16x16x32_bf16 v[132:135], a[232:235], v[16:19], v[132:135]
    s_mov_b32 s32, 1
    ds_read_b64_tr_b16 a[224:225], v3 offset:20480
    v_fma_f32 v60, v60, s28, v10
    v_mfma_f32_16x16x32_bf16 v[136:139], a[212:215], v[16:19], v[136:139]
    s_lshl_b32 s43, s3, 2
    v_fma_f32 v76, v76, s28, v12
    v_fma_f32 v56, v56, s28, v9
    v_mfma_f32_16x16x32_bf16 v[184:187], a[212:215], v[22:25], v[184:187]
    s_add_u32 s45, s43, 21
    ds_read_b64_tr_b16 a[226:227], v3 offset:14336
    v_fma_f32 v63, v63, s28, v10
    v_mfma_f32_16x16x32_bf16 v[232:235], a[212:215], v[28:31], v[232:235]
    s_cmp_eq_u32 s3, 0
    ds_read_b64_tr_b16 a[232:233], v5 offset:20480
    v_fma_f32 v75, v75, s28, v11
    v_mfma_f32_16x16x32_bf16 a[24:27], a[212:215], v[34:37], a[24:27]
    s_waitcnt lgkmcnt(5)
    ds_read_b64_tr_b16 a[234:235], v5 offset:14336
    v_exp_f32 v61, v61
    v_mfma_f32_16x16x32_bf16 a[28:31], a[216:219], v[34:37], a[28:31]
    s_cselect_b32 s45, 20, s45
    v_exp_f32 v62, v62
    v_mfma_f32_16x16x32_bf16 v[236:239], a[216:219], v[28:31], v[236:239]
    s_cselect_b32 s33, 1, 0
    v_exp_f32 v60, v60
    v_fma_f32 v59, v59, s28, v9
    v_fma_f32 v52, v52, s28, v9
    v_mfma_f32_16x16x32_bf16 v[188:191], a[216:219], v[22:25], v[188:191]
    s_cmp_eq_u32 s42, 1
    v_max_f32 v96, v96, v97
    v_fma_f32 v68, v68, s28, v11
    v_mfma_f32_16x16x32_bf16 v[140:143], a[216:219], v[16:19], v[140:143]
    s_cselect_b32 s44, s45, s44
    v_fma_f32 v57, v57, s28, v9
    v_fma_f32 v54, v54, s28, v9
    v_mfma_f32_16x16x32_bf16 v[144:147], a[220:223], v[16:19], v[144:147]
    s_cselect_b32 s32, s33, s32
    v_exp_f32 v68, v68
    v_mfma_f32_16x16x32_bf16 v[192:195], a[220:223], v[22:25], v[192:195]
    s_add_u32 s45, s43, 37
    s_cmp_eq_u32 s42, 2
    v_exp_f32 v59, v59
    v_mfma_f32_16x16x32_bf16 v[240:243], a[220:223], v[28:31], v[240:243]
    s_cselect_b32 s44, s45, s44
    v_fma_f32 v65, v65, s28, v10
    v_mul_f32_e64 v13, -s28, v96
    v_mfma_f32_16x16x32_bf16 a[32:35], a[220:223], v[34:37], a[32:35]
    s_waitcnt lgkmcnt(1)
    v_exp_f32 v76, v76
    v_fma_f32 v78, v78, s28, v12
    v_mfma_f32_16x16x32_bf16 a[36:39], a[224:227], v[34:37], a[36:39]
    s_cselect_b32 s32, 0, s32
    v_fma_f32 v70, v70, s28, v11
    v_fma_f32 v53, v53, s28, v9
    v_fma_f32 v90, v90, s28, v13
    s_mul_i32 s44, s44, 6144
    v_fma_f32 v87, v87, s28, v13
    s_add_u32 s33, s35, s44
    v_mfma_f32_16x16x32_bf16 v[244:247], a[224:227], v[28:31], v[244:247]
    s_mul_i32 s42, s32, 6144
    v_exp_f32 v53, v53
    v_mfma_f32_16x16x32_bf16 v[196:199], a[224:227], v[22:25], v[196:199]
    s_add_u32 s42, s42, 24576
    v_exp_f32 v63, v63
    v_mfma_f32_16x16x32_bf16 v[148:151], a[224:227], v[16:19], v[148:151]
    s_add_u32 s42, s42, s33
    v_fma_f32 v86, v86, s28, v13
    v_fma_f32 v79, v79, s28, v12
    s_cmp_ge_u32 s37, 6
    v_fma_f32 v83, v83, s28, v12
    v_mfma_f32_16x16x32_bf16 v[152:155], a[228:231], v[16:19], v[152:155]
    s_cselect_b32 s14, 0, s42
    v_cvt_pk_bf16_f32 v20, v60, v61
    s_add_u32 s24, s67, 256
    s_add_u32 s25, s33, 256
    v_mfma_f32_16x16x32_bf16 v[200:203], a[228:231], v[22:25], v[200:203]
    s_add_u32 s23, s38, 4096
    s_mov_b32 s27, 0x249
    s_mov_b32 s30, 0
    s_waitcnt vmcnt(7) lgkmcnt(0)
    v_exp_f32 v54, v54
    v_mfma_f32_16x16x32_bf16 v[248:251], a[228:231], v[28:31], v[248:251]
    s_barrier
    ds_read_b128 a[212:215], v0 offset:12288
    v_exp_f32 v69, v69
    v_fma_f32 v85, v85, s28, v13
    v_mfma_f32_16x16x32_bf16 a[40:43], a[228:231], v[34:37], a[40:43]
    ds_read_b128 a[216:219], v1 offset:12288
    v_exp_f32 v55, v55
    v_fma_f32 v91, v91, s28, v13
    v_fma_f32 v64, v64, s28, v10
    v_mfma_f32_16x16x32_bf16 a[44:47], a[232:235], v[34:37], a[44:47]
    ds_read_b128 a[220:223], v0 offset:13312
    v_fma_f32 v88, v88, s28, v13
    v_accvgpr_read_b32 v104, a0
    v_fma_f32 v84, v84, s28, v13
    v_exp_f32 v86, v86
    v_exp_f32 v52, v52
    v_mfma_f32_16x16x32_bf16 v[252:255], a[232:235], v[28:31], v[252:255]
    ds_read_b128 a[228:231], v0 offset:14336
    v_fma_f32 v80, v80, s28, v12
    v_cvt_pk_bf16_f32 v21, v62, v63
    v_exp_f32 v79, v79
    v_mfma_f32_16x16x32_bf16 v[204:207], a[232:235], v[22:25], v[204:207]
    s_add_u32 m0, s22, 36864
    v_fma_f32 v77, v77, s28, v12
    v_cvt_pk_bf16_f32 v26, v68, v69
    v_fma_f32 v82, v82, s28, v12
    v_fma_f32 v74, v74, s28, v11
    v_exp_f32 v85, v85
    v_exp_f32 v87, v87
    v_accvgpr_read_b32 v111, a7
    v_fma_f32 v72, v72, s28, v11
    v_cvt_pk_bf16_f32 v14, v52, v53
    v_mfma_f32_16x16x32_bf16 v[156:159], a[232:235], v[16:19], v[156:159]
    s_waitcnt lgkmcnt(3)
    ds_read_b128 a[224:227], v1 offset:13312
    v_cvt_pk_bf16_f32 v15, v54, v55
    v_mfma_f32_16x16x32_bf16 v[52:55], a[212:215], a[96:99], 0
    s_waitcnt lgkmcnt(3)
    v_exp_f32 v77, v77
    v_fma_f32 v66, v66, s28, v10
    v_exp_f32 v84, v84
    v_mfma_f32_16x16x32_bf16 v[52:55], a[216:219], a[100:103], v[52:55]
    s_waitcnt lgkmcnt(2)
    v_exp_f32 v70, v70
    v_mfma_f32_16x16x32_bf16 v[52:55], a[220:223], a[104:107], v[52:55]
    v_exp_f32 v90, v90
    v_cvt_pk_bf16_f32 v27, v70, v71
    v_fma_f32 v58, v58, s28, v9
    v_accvgpr_read_b32 v109, a5
    v_cvt_pk_bf16_f32 v32, v76, v77
    v_cvt_pk_bf16_f32 v39, v86, v87
    v_cvt_pk_bf16_f32 v38, v84, v85
    v_fma_f32 v73, v73, s28, v11
    v_mfma_f32_16x16x32_bf16 v[60:63], a[220:223], a[128:131], 0
    ds_read_b128 a[232:235], v1 offset:14336
    v_accvgpr_read_b32 v105, a1
    v_mfma_f32_16x16x32_bf16 v[60:63], a[216:219], a[124:127], v[60:63]
    v_exp_f32 v82, v82
    v_mfma_f32_16x16x32_bf16 v[60:63], a[212:215], a[120:123], v[60:63]
    buffer_load_dwordx4 v6, s[8:11], s21 offen lds
    v_mfma_f32_16x16x32_bf16 v[68:71], a[212:215], a[144:147], 0
    v_exp_f32 v78, v78
    v_mfma_f32_16x16x32_bf16 v[68:71], a[216:219], a[148:151], v[68:71]
    v_exp_f32 v65, v65
    v_mfma_f32_16x16x32_bf16 v[68:71], a[220:223], a[152:155], v[68:71]
    v_cvt_pk_bf16_f32 v33, v78, v79
    v_fma_f32 v89, v89, s28, v13
    v_mfma_f32_16x16x32_bf16 v[76:79], a[220:223], a[176:179], 0
    v_exp_f32 v64, v64
    v_mfma_f32_16x16x32_bf16 v[76:79], a[216:219], a[172:175], v[76:79]
    s_add_u32 s21, s21, 128
    v_exp_f32 v58, v58
    v_mfma_f32_16x16x32_bf16 v[76:79], a[212:215], a[168:171], v[76:79]
    v_exp_f32 v57, v57
    v_mfma_f32_16x16x32_bf16 v[84:87], a[212:215], a[192:195], 0
    v_subrev_u32 v103, 24576, v103
    v_cvt_pk_bf16_f32 v17, v58, v59
    v_mfma_f32_16x16x32_bf16 v[84:87], a[216:219], a[196:199], v[84:87]
    v_exp_f32 v88, v88
    v_mfma_f32_16x16x32_bf16 v[84:87], a[220:223], a[200:203], v[84:87]
    s_waitcnt lgkmcnt(0)
    v_exp_f32 v91, v91
    v_mfma_f32_16x16x32_bf16 v[84:87], a[224:227], a[204:207], v[84:87]
    v_exp_f32 v66, v66
    v_mfma_f32_16x16x32_bf16 v[84:87], a[228:231], a[208:211], v[84:87]
    v_exp_f32 v80, v80
    v_mfma_f32_16x16x32_bf16 v[84:87], a[232:235], v[92:95], v[84:87]
    v_exp_f32 v73, v73
    v_mfma_f32_16x16x32_bf16 v[76:79], a[232:235], a[188:191], v[76:79]
    v_exp_f32 v67, v67
    v_mfma_f32_16x16x32_bf16 v[76:79], a[228:231], a[184:187], v[76:79]
    ds_read_b128 a[212:215], v0 offset:18432
    v_fma_f32 v81, v81, s28, v12
    v_mfma_f32_16x16x32_bf16 v[76:79], a[224:227], a[180:183], v[76:79]
    ds_read_b128 a[216:219], v1 offset:18432
    v_exp_f32 v72, v72
    v_mfma_f32_16x16x32_bf16 v[68:71], a[224:227], a[156:159], v[68:71]
    v_cvt_pk_bf16_f32 v22, v64, v65
    v_accvgpr_read_b32 v106, a2
    v_mfma_f32_16x16x32_bf16 v[68:71], a[228:231], a[160:163], v[68:71]
    s_add_u32 m0, s22, 37888
    v_exp_f32 v89, v89
    v_mfma_f32_16x16x32_bf16 v[68:71], a[232:235], a[164:167], v[68:71]
    v_exp_f32 v75, v75
    v_mfma_f32_16x16x32_bf16 v[60:63], a[232:235], a[140:143], v[60:63]
    v_exp_f32 v74, v74
    v_mfma_f32_16x16x32_bf16 v[60:63], a[228:231], a[136:139], v[60:63]
    buffer_load_dwordx4 v6, s[8:11], s21 offen lds
    v_mfma_f32_16x16x32_bf16 v[60:63], a[224:227], a[132:135], v[60:63]
    v_exp_f32 v56, v56
    v_mfma_f32_16x16x32_bf16 v[52:55], a[224:227], a[108:111], v[52:55]
    v_exp_f32 v81, v81
    v_mfma_f32_16x16x32_bf16 v[52:55], a[228:231], a[112:115], v[52:55]
    s_add_u32 s21, s21, 128
    ds_read_b128 a[228:231], v0 offset:20480
    v_cvt_pk_bf16_f32 v16, v56, v57
    v_mfma_f32_16x16x32_bf16 v[52:55], a[232:235], a[116:119], v[52:55]
    ds_read_b128 a[220:223], v0 offset:19456
    v_fma_f32 v87, v87, s28, v13
    v_mfma_f32_16x16x32_bf16 v[44:47], a[236:239], v[14:17], 0
    s_waitcnt lgkmcnt(2)
    v_fma_f32 v78, v78, s28, v12
    v_cvt_pk_bf16_f32 v41, v90, v91
    v_mfma_f32_16x16x32_bf16 v[56:59], a[212:215], a[96:99], 0
    v_cvt_pk_bf16_f32 v40, v88, v89
    v_exp_f32 v83, v83
    v_fma_f32 v77, v77, s28, v12
    v_accvgpr_read_b32 v108, a4
    v_pk_mul_f32 v[114:115], v[114:115], v[48:49] op_sel_hi:[1,0]
    v_cvt_pk_bf16_f32 v212, v212, v213
    v_pk_mul_f32 v[216:217], v[216:217], v[50:51] op_sel_hi:[1,0]
    v_pk_mul_f32 v[164:165], v[164:165], v[102:103] op_sel_hi:[1,0]
    v_pk_mul_f32 v[180:181], v[180:181], v[102:103] op_sel_hi:[1,0]
    v_pk_mul_f32 v[220:221], v[220:221], v[50:51] op_sel_hi:[1,0]
    v_pk_mul_f32 v[176:177], v[176:177], v[102:103] op_sel_hi:[1,0]
    v_pk_mul_f32 v[146:147], v[146:147], v[48:49] op_sel_hi:[1,0]
    v_pk_mul_f32 v[128:129], v[128:129], v[48:49] op_sel_hi:[1,0]
    v_pk_mul_f32 v[104:105], v[104:105], v[8:9] op_sel_hi:[1,0]
    v_pk_mul_f32 v[194:195], v[194:195], v[102:103] op_sel_hi:[1,0]
    v_pk_mul_f32 v[214:215], v[214:215], v[50:51] op_sel_hi:[1,0]
    v_pk_mul_f32 v[210:211], v[210:211], v[50:51] op_sel_hi:[1,0]
    v_pk_mul_f32 v[132:133], v[132:133], v[48:49] op_sel_hi:[1,0]
    v_pk_mul_f32 v[162:163], v[162:163], v[102:103] op_sel_hi:[1,0]
    v_pk_mul_f32 v[236:237], v[236:237], v[50:51] op_sel_hi:[1,0]
    v_pk_mul_f32 v[106:107], v[106:107], v[8:9] op_sel_hi:[1,0]
    v_pk_mul_f32 v[218:219], v[218:219], v[50:51] op_sel_hi:[1,0]
    v_pk_mul_f32 v[160:161], v[160:161], v[102:103] op_sel_hi:[1,0]
    v_pk_mul_f32 v[222:223], v[222:223], v[50:51] op_sel_hi:[1,0]
    v_pk_mul_f32 v[198:199], v[198:199], v[102:103] op_sel_hi:[1,0]
    v_pk_mul_f32 v[240:241], v[240:241], v[50:51] op_sel_hi:[1,0]
    v_pk_mul_f32 v[140:141], v[140:141], v[48:49] op_sel_hi:[1,0]
    v_pk_mul_f32 v[166:167], v[166:167], v[102:103] op_sel_hi:[1,0]
    v_pk_mul_f32 v[224:225], v[224:225], v[50:51] op_sel_hi:[1,0]
    v_cvt_pk_bf16_f32 v29, v74, v75
    v_pk_mul_f32 v[112:113], v[112:113], v[48:49] op_sel_hi:[1,0]
    v_pk_mul_f32 v[168:169], v[168:169], v[102:103] op_sel_hi:[1,0]
    v_pk_mul_f32 v[134:135], v[134:135], v[48:49] op_sel_hi:[1,0]
    v_pk_mul_f32 v[144:145], v[144:145], v[48:49] op_sel_hi:[1,0]
    v_cvt_pk_bf16_f32 v180, v180, v181
    v_pk_mul_f32 v[138:139], v[138:139], v[48:49] op_sel_hi:[1,0]
    v_pk_mul_f32 v[186:187], v[186:187], v[102:103] op_sel_hi:[1,0]
    v_pk_mul_f32 v[108:109], v[108:109], v[8:9] op_sel_hi:[1,0]
    v_pk_mul_f32 v[110:111], v[110:111], v[8:9] op_sel_hi:[1,0]
    v_pk_mul_f32 v[188:189], v[188:189], v[102:103] op_sel_hi:[1,0]
    v_cvt_pk_bf16_f32 v28, v72, v73
    v_pk_mul_f32 v[208:209], v[208:209], v[50:51] op_sel_hi:[1,0]
    v_cvt_pk_bf16_f32 v23, v66, v67
    v_cvt_pk_bf16_f32 v240, v240, v241
    v_mfma_f32_16x16x32_bf16 v[56:59], a[216:219], a[100:103], v[56:59]
    s_waitcnt lgkmcnt(0)
    ds_read_b128 a[232:235], v1 offset:20480
    v_fma_f32 v79, v79, s28, v12
    v_mfma_f32_16x16x32_bf16 v[56:59], a[220:223], a[104:107], v[56:59]
    s_add_u32 m0, s22, 38912
    v_cvt_pk_bf16_f32 v104, v104, v105
    v_fma_f32 v55, v55, s28, v9
    v_cvt_pk_bf16_f32 v34, v80, v81
    v_mfma_f32_16x16x32_bf16 v[64:67], a[220:223], a[128:131], 0
    ds_read_b128 a[224:227], v1 offset:19456
    v_cvt_pk_bf16_f32 v108, v108, v109
    v_mfma_f32_16x16x32_bf16 v[64:67], a[216:219], a[124:127], v[64:67]
    v_cvt_pk_bf16_f32 v140, v140, v141
    v_fma_f32 v76, v76, s28, v12
    v_cvt_pk_bf16_f32 v112, v112, v113
    v_mfma_f32_16x16x32_bf16 v[64:67], a[212:215], a[120:123], v[64:67]
    v_cvt_pk_bf16_f32 v35, v82, v83
    v_cvt_pk_bf16_f32 v105, v106, v107
    v_mfma_f32_16x16x32_bf16 v[72:75], a[212:215], a[144:147], 0
    v_fma_f32 v54, v54, s28, v9
    v_accvgpr_read_b32 v106, a10
    v_mfma_f32_16x16x32_bf16 v[72:75], a[216:219], a[148:151], v[72:75]
    v_fma_f32 v52, v52, s28, v9
    v_cvt_pk_bf16_f32 v160, v160, v161
    v_mfma_f32_16x16x32_bf16 v[72:75], a[220:223], a[152:155], v[72:75]
    v_cvt_pk_bf16_f32 v144, v144, v145
    v_fma_f32 v84, v84, s28, v13
    v_fma_f32 v86, v86, s28, v13
    v_mfma_f32_16x16x32_bf16 v[80:83], a[220:223], a[176:179], 0
    v_cvt_pk_bf16_f32 v176, v176, v177
    v_cvt_pk_bf16_f32 v113, v114, v115
    v_mfma_f32_16x16x32_bf16 v[80:83], a[216:219], a[172:175], v[80:83]
    buffer_load_dwordx4 v6, s[8:11], s21 offen lds
    v_mfma_f32_16x16x32_bf16 v[80:83], a[212:215], a[168:171], v[80:83]
    s_add_u32 s21, s21, 12032
    v_cvt_pk_bf16_f32 v164, v164, v165
    v_cvt_pk_bf16_f32 v216, v216, v217
    v_fma_f32 v60, v60, s28, v10
    v_exp_f32 v52, v52
    v_cvt_pk_bf16_f32 v220, v220, v221
    v_pk_mul_f32 v[226:227], v[226:227], v[50:51] op_sel_hi:[1,0]
    v_pk_mul_f32 v[254:255], v[254:255], v[50:51] op_sel_hi:[1,0]
    v_pk_mul_f32 v[116:117], v[116:117], v[48:49] op_sel_hi:[1,0]
    v_pk_mul_f32 v[172:173], v[172:173], v[102:103] op_sel_hi:[1,0]
    v_pk_mul_f32 v[184:185], v[184:185], v[102:103] op_sel_hi:[1,0]
    v_fma_f32 v85, v85, s28, v13
    v_pk_mul_f32 v[252:253], v[252:253], v[50:51] op_sel_hi:[1,0]
    v_pk_mul_f32 v[118:119], v[118:119], v[48:49] op_sel_hi:[1,0]
    v_fma_f32 v63, v63, s28, v10
    v_pk_mul_f32 v[230:231], v[230:231], v[50:51] op_sel_hi:[1,0]
    v_cvt_pk_bf16_f32 v224, v224, v225
    v_pk_mul_f32 v[228:229], v[228:229], v[50:51] op_sel_hi:[1,0]
    v_pk_mul_f32 v[120:121], v[120:121], v[48:49] op_sel_hi:[1,0]
    v_cvt_pk_bf16_f32 v252, v252, v253
    v_cvt_pk_bf16_f32 v161, v162, v163
    v_mfma_f32_16x16x32_bf16 v[88:91], a[212:215], a[192:195], 0
    s_waitcnt vmcnt(6) lgkmcnt(0)
    v_exp_f32 v76, v76
    v_mfma_f32_16x16x32_bf16 v[88:91], a[216:219], a[196:199], v[88:91]
    s_barrier
    v_mfma_f32_16x16x32_bf16 v[88:91], a[220:223], a[200:203], v[88:91]
    ds_read_b64_tr_b16 a[212:213], v2 offset:0
    v_cvt_pk_bf16_f32 v208, v208, v209
    v_exp_f32 v55, v55
    v_mfma_f32_16x16x32_bf16 v[88:91], a[224:227], a[204:207], v[88:91]
    ds_write2st64_b64 v101, v[112:113], v[160:161] offset0:0 offset1:12
    v_mfma_f32_16x16x32_bf16 v[88:91], a[228:231], a[208:211], v[88:91]
    v_exp_f32 v79, v79
    v_mfma_f32_16x16x32_bf16 v[88:91], a[232:235], v[92:95], v[88:91]
    ds_read_b64_tr_b16 a[214:215], v2 offset:6144
    v_fma_f32 v71, v71, s28, v11
    v_cvt_pk_bf16_f32 v188, v188, v189
    v_mfma_f32_16x16x32_bf16 v[80:83], a[232:235], a[188:191], v[80:83]
    s_add_u32 m0, s22, 12288
    v_cvt_pk_bf16_f32 v109, v110, v111
    v_cvt_pk_bf16_f32 v132, v132, v133
    v_cvt_pk_bf16_f32 v165, v166, v167
    v_mfma_f32_16x16x32_bf16 v[80:83], a[228:231], a[184:187], v[80:83]
    buffer_load_dwordx4 v6, s[4:7], s20 offen lds
    v_mfma_f32_16x16x32_bf16 v[80:83], a[224:227], a[180:183], v[80:83]
    v_exp_f32 v87, v87
    v_mfma_f32_16x16x32_bf16 v[72:75], a[224:227], a[156:159], v[72:75]
    v_cvt_pk_bf16_f32 v209, v210, v211
    v_cvt_pk_bf16_f32 v236, v236, v237
    v_exp_f32 v86, v86
    v_mfma_f32_16x16x32_bf16 v[72:75], a[228:231], a[160:163], v[72:75]
    ds_read_b64_tr_b16 a[216:217], v3 offset:0
    v_accvgpr_read_b32 v107, a11
    v_mfma_f32_16x16x32_bf16 v[72:75], a[232:235], a[164:167], v[72:75]
    ds_read_b64_tr_b16 a[218:219], v3 offset:6144
    v_cvt_pk_bf16_f32 v184, v184, v185
    v_mfma_f32_16x16x32_bf16 v[64:67], a[232:235], a[140:143], v[64:67]
    v_exp_f32 v85, v85
    v_mfma_f32_16x16x32_bf16 v[64:67], a[228:231], a[136:139], v[64:67]
    ds_read_b64_tr_b16 a[220:221], v4 offset:0
    v_cvt_pk_bf16_f32 v168, v168, v169
    v_mfma_f32_16x16x32_bf16 v[64:67], a[224:227], a[132:135], v[64:67]
    ds_write2st64_b64 v101, v[208:209], v[104:105] offset0:24 offset1:36
    v_pk_mul_f32 v[122:123], v[122:123], v[48:49] op_sel_hi:[1,0]
    v_pk_mul_f32 v[130:131], v[130:131], v[48:49] op_sel_hi:[1,0]
    v_pk_mul_f32 v[170:171], v[170:171], v[102:103] op_sel_hi:[1,0]
    v_cvt_pk_bf16_f32 v116, v116, v117
    v_accvgpr_read_b32 v104, a8
    v_pk_mul_f32 v[192:193], v[192:193], v[102:103] op_sel_hi:[1,0]
    v_accvgpr_read_b32 v105, a9
    v_accvgpr_read_b32 v110, a14
    v_fma_f32 v62, v62, s28, v10
    v_pk_mul_f32 v[136:137], v[136:137], v[48:49] op_sel_hi:[1,0]
    v_xor_b32 v101, 32, v101
    v_pk_mul_f32 v[104:105], v[104:105], v[8:9] op_sel_hi:[1,0]
    v_fma_f32 v70, v70, s28, v11
    v_pk_mul_f32 v[242:243], v[242:243], v[50:51] op_sel_hi:[1,0]
    v_cvt_pk_bf16_f32 v120, v120, v121
    v_pk_mul_f32 v[190:191], v[190:191], v[102:103] op_sel_hi:[1,0]
    v_cvt_pk_bf16_f32 v104, v104, v105
    v_cvt_pk_bf16_f32 v169, v170, v171
    v_pk_mul_f32 v[148:149], v[148:149], v[48:49] op_sel_hi:[1,0]
    v_exp_f32 v60, v60
    v_pk_mul_f32 v[142:143], v[142:143], v[48:49] op_sel_hi:[1,0]
    v_pk_mul_f32 v[206:207], v[206:207], v[102:103] op_sel_hi:[1,0]
    v_pk_mul_f32 v[182:183], v[182:183], v[102:103] op_sel_hi:[1,0]
    v_cvt_pk_bf16_f32 v192, v192, v193
    v_pk_mul_f32 v[196:197], v[196:197], v[102:103] op_sel_hi:[1,0]
    v_cvt_pk_bf16_f32 v213, v214, v215
    v_pk_mul_f32 v[174:175], v[174:175], v[102:103] op_sel_hi:[1,0]
    v_pk_mul_f32 v[106:107], v[106:107], v[8:9] op_sel_hi:[1,0]
    v_pk_mul_f32 v[232:233], v[232:233], v[50:51] op_sel_hi:[1,0]
    v_accvgpr_read_b32 v111, a15
    v_pk_mul_f32 v[126:127], v[126:127], v[48:49] op_sel_hi:[1,0]
    v_pk_mul_f32 v[124:125], v[124:125], v[48:49] op_sel_hi:[1,0]
    v_fma_f32 v72, v72, s28, v11
    v_pk_mul_f32 v[248:249], v[248:249], v[50:51] op_sel_hi:[1,0]
    v_pk_mul_f32 v[204:205], v[204:205], v[102:103] op_sel_hi:[1,0]
    v_cvt_pk_bf16_f32 v105, v106, v107
    v_cvt_pk_bf16_f32 v128, v128, v129
    v_mfma_f32_16x16x32_bf16 v[56:59], a[224:227], a[108:111], v[56:59]
    v_cvt_pk_bf16_f32 v121, v122, v123
    v_cvt_pk_bf16_f32 v204, v204, v205
    v_mfma_f32_16x16x32_bf16 v[56:59], a[228:231], a[112:115], v[56:59]
    v_cvt_pk_bf16_f32 v172, v172, v173
    v_cvt_pk_bf16_f32 v117, v118, v119
    v_mfma_f32_16x16x32_bf16 v[44:47], a[240:243], v[20:23], v[44:47]
    ds_write2st64_b64 v101, v[116:117], v[164:165] offset0:0 offset1:12
    v_mfma_f32_16x16x32_bf16 v[56:59], a[232:235], a[116:119], v[56:59]
    s_waitcnt lgkmcnt(1)
    ds_read_b64_tr_b16 a[222:223], v4 offset:6144
    v_fma_f32 v69, v69, s28, v11
    v_mfma_f32_16x16x32_bf16 v[112:115], a[212:215], v[14:17], 0
    ds_write2st64_b64 v101, v[212:213], v[108:109] offset0:24 offset1:36
    v_mfma_f32_16x16x32_bf16 v[44:47], a[244:247], v[26:29], v[44:47]
    ds_read_b64_tr_b16 a[228:229], v2 offset:1024
    v_cvt_pk_bf16_f32 v185, v186, v187
    v_mfma_f32_16x16x32_bf16 v[116:119], a[216:219], v[14:17], 0
    s_add_u32 s20, s20, 128
    v_fma_f32 v64, v64, s28, v10
    v_exp_f32 v77, v77
    v_cvt_pk_bf16_f32 v205, v206, v207
    v_cvt_pk_bf16_f32 v196, v196, v197
    v_exp_f32 v62, v62
    v_accvgpr_read_b32 v108, a12
    v_pk_mul_f32 v[156:157], v[156:157], v[48:49] op_sel_hi:[1,0]
    v_accvgpr_read_b32 v109, a13
    v_pk_mul_f32 v[234:235], v[234:235], v[50:51] op_sel_hi:[1,0]
    v_pk_mul_f32 v[152:153], v[152:153], v[48:49] op_sel_hi:[1,0]
    v_fma_f32 v53, v53, s28, v9
    v_pk_mul_f32 v[110:111], v[110:111], v[8:9] op_sel_hi:[1,0]
    v_fma_f32 v56, v56, s28, v9
    v_pk_mul_f32 v[108:109], v[108:109], v[8:9] op_sel_hi:[1,0]
    v_cvt_pk_bf16_f32 v228, v228, v229
    v_pk_mul_f32 v[150:151], v[150:151], v[48:49] op_sel_hi:[1,0]
    v_pk_mul_f32 v[178:179], v[178:179], v[102:103] op_sel_hi:[1,0]
    v_cvt_pk_bf16_f32 v136, v136, v137
    v_pk_mul_f32 v[202:203], v[202:203], v[102:103] op_sel_hi:[1,0]
    v_xor_b32 v101, 96, v101
    v_cvt_pk_bf16_f32 v108, v108, v109
    v_mfma_f32_16x16x32_bf16 v[44:47], a[248:251], v[32:35], v[44:47]
    ds_write2st64_b64 v101, v[120:121], v[168:169] offset0:0 offset1:12
    v_cvt_pk_bf16_f32 v173, v174, v175
    v_pk_mul_f32 v[244:245], v[244:245], v[50:51] op_sel_hi:[1,0]
    v_fma_f32 v83, v83, s28, v12
    v_cvt_pk_bf16_f32 v217, v218, v219
    v_mfma_f32_16x16x32_bf16 v[164:167], a[216:219], v[20:23], 0
    s_add_u32 m0, s22, 13312
    ds_read_b64_tr_b16 a[224:225], v5 offset:0
    v_cvt_pk_bf16_f32 v145, v146, v147
    v_mfma_f32_16x16x32_bf16 v[160:163], a[212:215], v[20:23], 0
    buffer_load_dwordx4 v6, s[4:7], s20 offen lds
    ds_read_b64_tr_b16 a[226:227], v5 offset:6144
    v_accvgpr_read_b32 v107, a19
    v_cvt_pk_bf16_f32 v109, v110, v111
    v_cvt_pk_bf16_f32 v129, v130, v131
    v_accvgpr_read_b32 v106, a18
    v_exp_f32 v70, v70
    v_mfma_f32_16x16x32_bf16 v[208:211], a[212:215], v[26:29], 0
    s_add_u32 s20, s20, 128
    ds_read_b64_tr_b16 a[230:231], v2 offset:7168
    v_cvt_pk_bf16_f32 v225, v226, v227
    v_cvt_pk_bf16_f32 v197, v198, v199
    v_exp_f32 v78, v78
    v_cvt_pk_bf16_f32 v148, v148, v149
    v_mfma_f32_16x16x32_bf16 v[212:215], a[216:219], v[26:29], 0
    v_cvt_pk_bf16_f32 v133, v134, v135
    v_exp_f32 v54, v54
    v_mfma_f32_16x16x32_bf16 a[4:7], a[216:219], v[32:35], 0
    ds_write2st64_b64 v101, v[216:217], v[104:105] offset0:24 offset1:36
    v_accvgpr_read_b32 v110, a22
    v_cvt_pk_bf16_f32 v177, v178, v179
    v_cvt_pk_bf16_f32 v221, v222, v223
    v_xor_b32 v101, 32, v101
    v_pk_mul_f32 v[250:251], v[250:251], v[50:51] op_sel_hi:[1,0]
    v_pk_mul_f32 v[154:155], v[154:155], v[48:49] op_sel_hi:[1,0]
    v_pk_mul_f32 v[200:201], v[200:201], v[102:103] op_sel_hi:[1,0]
    v_cvt_pk_bf16_f32 v37, v78, v79
    v_pk_mul_f32 v[106:107], v[106:107], v[8:9] op_sel_hi:[1,0]
    v_cvt_pk_bf16_f32 v193, v194, v195
    v_fma_f32 v68, v68, s28, v11
    v_cvt_pk_bf16_f32 v124, v124, v125
    v_accvgpr_read_b32 v104, a16
    v_cvt_pk_bf16_f32 v232, v232, v233
    v_mfma_f32_16x16x32_bf16 a[0:3], a[212:215], v[32:35], 0
    ds_read_b64_tr_b16 a[234:235], v3 offset:7168
    v_exp_f32 v71, v71
    v_cvt_pk_bf16_f32 v125, v126, v127
    v_cvt_pk_bf16_f32 v156, v156, v157
    v_mfma_f32_16x16x32_bf16 a[48:51], a[212:215], v[38:41], 0
    ds_write2st64_b64 v101, v[124:125], v[172:173] offset0:0 offset1:12
    v_fma_f32 v59, v59, s28, v9
    v_cvt_pk_bf16_f32 v244, v244, v245
    v_mfma_f32_16x16x32_bf16 a[52:55], a[216:219], v[38:41], 0
    s_waitcnt lgkmcnt(3)
    v_cvt_pk_bf16_f32 v181, v182, v183
    v_fma_f32 v67, v67, s28, v10
    v_mfma_f32_16x16x32_bf16 a[56:59], a[220:223], v[38:41], 0
    v_cvt_pk_bf16_f32 v149, v150, v151
    v_cvt_pk_bf16_f32 v200, v200, v201
    v_mfma_f32_16x16x32_bf16 a[60:63], a[224:227], v[38:41], 0
    s_add_u32 m0, s22, 14336
    ds_read_b64_tr_b16 a[232:233], v3 offset:1024
    buffer_load_dwordx4 v6, s[4:7], s20 offen lds
    v_fma_f32 v88, v88, s28, v13
    v_cvt_pk_bf16_f32 v229, v230, v231
    v_accvgpr_read_b32 v105, a17
    v_pk_mul_f32 v[246:247], v[246:247], v[50:51] op_sel_hi:[1,0]
    v_pk_mul_f32 v[104:105], v[104:105], v[8:9] op_sel_hi:[1,0]
    v_accvgpr_read_b32 v111, a23
    v_fma_f32 v61, v61, s28, v10
    v_mfma_f32_16x16x32_bf16 a[12:15], a[224:227], v[32:35], 0
    ds_write2st64_b64 v101, v[220:221], v[108:109] offset0:24 offset1:36
    v_cvt_pk_bf16_f32 v248, v248, v249
    v_exp_f32 v53, v53
    v_cvt_pk_bf16_f32 v104, v104, v105
    v_exp_f32 v68, v68
    v_pk_mul_f32 v[110:111], v[110:111], v[8:9] op_sel_hi:[1,0]
    v_cvt_pk_bf16_f32 v105, v106, v107
    v_xor_b32 v101, 96, v101
    v_cvt_pk_bf16_f32 v141, v142, v143
    v_mfma_f32_16x16x32_bf16 a[8:11], a[220:223], v[32:35], 0
    ds_read_b128 v[96:99], v103 offset:0
    v_exp_f32 v83, v83
    v_cvt_pk_bf16_f32 v189, v190, v191
    v_mfma_f32_16x16x32_bf16 v[216:219], a[220:223], v[26:29], 0
    v_accvgpr_read_b32 v108, a20
    v_fma_f32 v80, v80, s28, v12
    v_mfma_f32_16x16x32_bf16 v[220:223], a[224:227], v[26:29], 0
    ds_write2st64_b64 v101, v[128:129], v[176:177] offset0:4 offset1:16
    v_mfma_f32_16x16x32_bf16 v[172:175], a[224:227], v[20:23], 0
    ds_read_b64_tr_b16 a[218:219], v5 offset:7168
    v_fma_f32 v89, v89, s28, v13
    v_cvt_pk_bf16_f32 v137, v138, v139
    v_mfma_f32_16x16x32_bf16 v[168:171], a[220:223], v[20:23], 0
    ds_write2st64_b64 v101, v[224:225], v[104:105] offset0:28 offset1:40
    v_accvgpr_read_b32 v104, a24
    v_xor_b32 v101, 32, v101
    v_fma_f32 v65, v65, s28, v10
    v_accvgpr_read_b32 v109, a21
    v_pk_mul_f32 v[108:109], v[108:109], v[8:9] op_sel_hi:[1,0]
    v_pk_mul_f32 v[158:159], v[158:159], v[48:49] op_sel_hi:[1,0]
    v_cvt_pk_bf16_f32 v108, v108, v109
    v_cvt_pk_bf16_f32 v109, v110, v111
    v_mfma_f32_16x16x32_bf16 v[120:123], a[220:223], v[14:17], 0
    v_accvgpr_read_b32 v107, a27
    v_cvt_pk_bf16_f32 v152, v152, v153
    v_exp_f32 v84, v84
    v_fma_f32 v81, v81, s28, v12
    v_mfma_f32_16x16x32_bf16 v[124:127], a[224:227], v[14:17], 0
    s_add_u32 s20, s20, 12032
    ds_write2st64_b64 v101, v[132:133], v[180:181] offset0:4 offset1:16
    v_mfma_f32_16x16x32_bf16 v[128:131], a[228:231], v[14:17], 0
    s_waitcnt lgkmcnt(3)
    ds_write2st64_b64 v101, v[228:229], v[108:109] offset0:28 offset1:40
    v_mfma_f32_16x16x32_bf16 v[132:135], a[232:235], v[14:17], 0
    ds_read_b64_tr_b16 a[216:217], v5 offset:1024
    v_accvgpr_read_b32 v105, a25
    v_mfma_f32_16x16x32_bf16 v[180:183], a[232:235], v[20:23], 0
    s_add_u32 m0, s38, 0
    ds_read_b64_tr_b16 a[214:215], v4 offset:7168
    v_cvt_pk_bf16_f32 v233, v234, v235
    v_accvgpr_read_b32 v106, a26
    v_mfma_f32_16x16x32_bf16 v[44:47], a[252:255], v[38:41], v[44:47]
    buffer_store_dwordx4 v[96:99], v6, s[16:19], s67 offen offset:0 nt
    ds_read_b64_tr_b16 a[212:213], v4 offset:1024
    v_accvgpr_read_b32 v111, a31
    v_accvgpr_read_b32 v109, a29
    v_accvgpr_read_b32 v108, a28
    v_pk_mul_f32 v[108:109], v[108:109], v[8:9] op_sel_hi:[1,0]
    v_pk_mul_f32 v[106:107], v[106:107], v[8:9] op_sel_hi:[1,0]
    v_pk_mul_f32 v[238:239], v[238:239], v[50:51] op_sel_hi:[1,0]
    v_fma_f32 v58, v58, s28, v9
    v_pk_mul_f32 v[104:105], v[104:105], v[8:9] op_sel_hi:[1,0]
    v_exp_f32 v69, v69
    v_accvgpr_read_b32 v110, a30
    v_mfma_f32_16x16x32_bf16 v[176:179], a[228:231], v[20:23], 0
    ds_read_b64_tr_b16 a[224:225], v3 offset:2048
    v_fma_f32 v66, v66, s28, v10
    v_cvt_pk_bf16_f32 v104, v104, v105
    v_cvt_pk_bf16_f32 v105, v106, v107
    v_xor_b32 v101, 96, v101
    v_mfma_f32_16x16x32_bf16 v[224:227], a[228:231], v[26:29], 0
    ds_write2st64_b64 v101, v[136:137], v[184:185] offset0:4 offset1:16
    v_mfma_f32_16x16x32_bf16 v[228:231], a[232:235], v[26:29], 0
    ds_read_b64_tr_b16 a[220:221], v2 offset:2048
    v_cvt_pk_bf16_f32 v108, v108, v109
    v_mfma_f32_16x16x32_bf16 a[20:23], a[232:235], v[32:35], 0
    buffer_load_dwordx4 v6, s[12:15], s33 offen nt lds
    v_mfma_f32_16x16x32_bf16 a[16:19], a[228:231], v[32:35], 0
    ds_write2st64_b64 v101, v[232:233], v[104:105] offset0:28 offset1:40
    v_xor_b32 v101, 32, v101
    v_cvt_pk_bf16_f32 v36, v76, v77
    v_pk_mul_f32 v[110:111], v[110:111], v[8:9] op_sel_hi:[1,0]
    v_cvt_pk_bf16_f32 v18, v52, v53
    v_cvt_pk_bf16_f32 v237, v238, v239
    v_fma_f32 v75, v75, s28, v11
    v_mfma_f32_16x16x32_bf16 a[64:67], a[228:231], v[38:41], 0
    ds_read_b128 v[96:99], v103 offset:1024
    v_accvgpr_read_b32 v107, a35
    v_mfma_f32_16x16x32_bf16 a[68:71], a[232:235], v[38:41], 0
    s_waitcnt lgkmcnt(4)
    v_exp_f32 v63, v63
    v_cvt_pk_bf16_f32 v109, v110, v111
    v_mfma_f32_16x16x32_bf16 a[72:75], a[212:215], v[38:41], 0
    ds_write2st64_b64 v101, v[140:141], v[188:189] offset0:4 offset1:16
    v_mfma_f32_16x16x32_bf16 a[76:79], a[216:219], v[38:41], 0
    ds_write2st64_b64 v101, v[236:237], v[108:109] offset0:28 offset1:40
    v_accvgpr_read_b32 v110, a38
    v_accvgpr_read_b32 v106, a34
    v_accvgpr_read_b32 v109, a37
    v_mfma_f32_16x16x32_bf16 a[28:31], a[216:219], v[32:35], 0
    ds_read_b64_tr_b16 a[230:231], v4 offset:8192
    v_accvgpr_read_b32 v111, a39
    v_cvt_pk_bf16_f32 v31, v70, v71
    v_xor_b32 v101, 96, v101
    v_accvgpr_read_b32 v104, a32
    v_mfma_f32_16x16x32_bf16 a[24:27], a[212:215], v[32:35], 0
    ds_read_b64_tr_b16 a[222:223], v2 offset:8192
    v_accvgpr_read_b32 v108, a36
    v_mfma_f32_16x16x32_bf16 v[232:235], a[212:215], v[26:29], 0
    s_add_u32 m0, s38, 1024
    ds_read_b64_tr_b16 a[226:227], v3 offset:8192
    v_cvt_pk_bf16_f32 v241, v242, v243
    v_cvt_pk_bf16_f32 v25, v62, v63
    v_accvgpr_read_b32 v105, a33
    v_fma_f32 v73, v73, s28, v11
    v_pk_mul_f32 v[108:109], v[108:109], v[8:9] op_sel_hi:[1,0]
    v_pk_mul_f32 v[106:107], v[106:107], v[8:9] op_sel_hi:[1,0]
    v_pk_mul_f32 v[104:105], v[104:105], v[8:9] op_sel_hi:[1,0]
    v_pk_mul_f32 v[110:111], v[110:111], v[8:9] op_sel_hi:[1,0]
    v_fma_f32 v90, v90, s28, v13
    v_cvt_pk_bf16_f32 v104, v104, v105
    v_cvt_pk_bf16_f32 v105, v106, v107
    v_cvt_pk_bf16_f32 v42, v84, v85
    v_mfma_f32_16x16x32_bf16 v[236:239], a[216:219], v[26:29], 0
    ds_write2st64_b64 v101, v[144:145], v[192:193] offset0:8 offset1:20
    v_mfma_f32_16x16x32_bf16 v[188:191], a[216:219], v[20:23], 0
    ds_read_b64_tr_b16 a[232:233], v5 offset:2048
    v_cvt_pk_bf16_f32 v108, v108, v109
    v_cvt_pk_bf16_f32 v157, v158, v159
    v_cvt_pk_bf16_f32 v245, v246, v247
    v_mfma_f32_16x16x32_bf16 v[184:187], a[212:215], v[20:23], 0
    ds_write2st64_b64 v101, v[240:241], v[104:105] offset0:32 offset1:44
    v_mfma_f32_16x16x32_bf16 v[136:139], a[212:215], v[14:17], 0
    ds_read_b64_tr_b16 a[228:229], v4 offset:2048
    v_xor_b32 v101, 32, v101
    v_mfma_f32_16x16x32_bf16 v[140:143], a[216:219], v[14:17], 0
    s_waitcnt lgkmcnt(4)
    ds_read_b64_tr_b16 a[234:235], v5 offset:8192
    v_cvt_pk_bf16_f32 v201, v202, v203
    v_mfma_f32_16x16x32_bf16 v[144:147], a[220:223], v[14:17], 0
    ds_write2st64_b64 v101, v[148:149], v[196:197] offset0:8 offset1:20
    v_mfma_f32_16x16x32_bf16 v[148:151], a[224:227], v[14:17], 0
    buffer_load_dwordx4 v7, s[12:15], s33 offen nt lds
    v_mfma_f32_16x16x32_bf16 v[196:199], a[224:227], v[20:23], 0
    v_cvt_pk_bf16_f32 v109, v110, v111
    v_accvgpr_read_b32 v106, a42
    v_accvgpr_read_b32 v107, a43
    v_cvt_pk_bf16_f32 v153, v154, v155
    v_mfma_f32_16x16x32_bf16 v[192:195], a[220:223], v[20:23], 0
    ds_write2st64_b64 v101, v[244:245], v[108:109] offset0:32 offset1:44
    v_mfma_f32_16x16x32_bf16 v[240:243], a[220:223], v[26:29], 0
    v_accvgpr_read_b32 v105, a41
    v_accvgpr_read_b32 v111, a47
    v_accvgpr_read_b32 v108, a44
    v_mfma_f32_16x16x32_bf16 v[244:247], a[224:227], v[26:29], 0
    s_add_u32 s39, s39, 12288
    v_cvt_pk_bf16_f32 v249, v250, v251
    v_fma_f32 v91, v91, s28, v13
    v_cvt_pk_bf16_f32 v19, v54, v55
    v_accvgpr_read_b32 v109, a45
    v_mfma_f32_16x16x32_bf16 a[36:39], a[224:227], v[32:35], 0
    s_waitcnt vmcnt(9) lgkmcnt(2)
    v_accvgpr_read_b32 v104, a40
    v_xor_b32 v101, 96, v101
    v_mfma_f32_16x16x32_bf16 a[32:35], a[220:223], v[32:35], 0
    buffer_store_dwordx4 v[96:99], v7, s[16:19], s67 offen offset:0 nt
    s_barrier
    v_pk_mul_f32 v[108:109], v[108:109], v[8:9] op_sel_hi:[1,0]
    v_pk_mul_f32 v[106:107], v[106:107], v[8:9] op_sel_hi:[1,0]
    v_accvgpr_read_b32 v110, a46
    v_pk_mul_f32 v[104:105], v[104:105], v[8:9] op_sel_hi:[1,0]
    v_pk_mul_f32 v[110:111], v[110:111], v[8:9] op_sel_hi:[1,0]
    v_cvt_pk_bf16_f32 v108, v108, v109
    v_fma_f32 v57, v57, s28, v9
    v_mfma_f32_16x16x32_bf16 a[80:83], a[220:223], v[38:41], 0
    ds_read_b128 a[220:223], v0 offset:1024
    v_cvt_pk_bf16_f32 v253, v254, v255
    v_mfma_f32_16x16x32_bf16 a[84:87], a[224:227], v[38:41], 0
    ds_write2st64_b64 v101, v[152:153], v[200:201] offset0:8 offset1:20
    v_cvt_pk_bf16_f32 v43, v86, v87
    v_mfma_f32_16x16x32_bf16 a[88:91], a[228:231], v[38:41], 0
    ds_read_b128 a[216:219], v1 offset:0
    v_cvt_pk_bf16_f32 v104, v104, v105
    v_mfma_f32_16x16x32_bf16 a[92:95], a[232:235], v[38:41], 0
    ds_read_b128 a[212:215], v0 offset:0
    v_cvt_pk_bf16_f32 v105, v106, v107
    v_cvt_pk_bf16_f32 v109, v110, v111
    v_mfma_f32_16x16x32_bf16 a[44:47], a[232:235], v[32:35], 0
    ds_write2st64_b64 v101, v[248:249], v[104:105] offset0:32 offset1:44
    v_xor_b32 v101, 32, v101
    v_mfma_f32_16x16x32_bf16 a[40:43], a[228:231], v[32:35], 0
    ds_write2st64_b64 v101, v[156:157], v[204:205] offset0:8 offset1:20
    v_mfma_f32_16x16x32_bf16 v[248:251], a[228:231], v[26:29], 0
    ds_write2st64_b64 v101, v[252:253], v[108:109] offset0:32 offset1:44
    v_mfma_f32_16x16x32_bf16 v[252:255], a[232:235], v[26:29], 0
    v_exp_f32 v59, v59
    v_mfma_f32_16x16x32_bf16 v[204:207], a[232:235], v[20:23], 0
    v_exp_f32 v65, v65
    v_mfma_f32_16x16x32_bf16 v[200:203], a[228:231], v[20:23], 0
    v_fma_f32 v82, v82, s28, v12
    v_fma_f32 v74, v74, s28, v11
    v_mfma_f32_16x16x32_bf16 v[152:155], a[228:231], v[14:17], 0
    v_exp_f32 v58, v58
    v_mfma_f32_16x16x32_bf16 v[156:159], a[232:235], v[14:17], 0
    s_waitcnt lgkmcnt(3)
    v_exp_f32 v61, v61
    v_mfma_f32_16x16x32_bf16 v[52:55], a[212:215], a[96:99], 0
    ds_read_b128 a[224:227], v1 offset:1024
    v_cvt_pk_bf16_f32 v30, v68, v69
    v_mfma_f32_16x16x32_bf16 v[52:55], a[216:219], a[100:103], v[52:55]
    v_exp_f32 v56, v56
    v_mfma_f32_16x16x32_bf16 v[52:55], a[220:223], a[104:107], v[52:55]
    v_exp_f32 v57, v57
    v_cvt_pk_bf16_f32 v24, v60, v61
    v_mfma_f32_16x16x32_bf16 v[60:63], a[220:223], a[128:131], 0
    s_add_u32 m0, s22, 24576
    v_exp_f32 v64, v64
    v_mfma_f32_16x16x32_bf16 v[60:63], a[216:219], a[124:127], v[60:63]
    buffer_load_dwordx4 v6, s[8:11], s21 offen lds
    v_mfma_f32_16x16x32_bf16 v[60:63], a[212:215], a[120:123], v[60:63]
    ds_read_b128 a[228:231], v0 offset:2048
    v_cvt_pk_bf16_f32 v17, v58, v59
    v_mfma_f32_16x16x32_bf16 v[68:71], a[212:215], a[144:147], 0
    ds_read_b128 v[96:99], v103 offset:2048
    v_cvt_pk_bf16_f32 v22, v64, v65
    v_mfma_f32_16x16x32_bf16 v[68:71], a[216:219], a[148:151], v[68:71]
    s_add_u32 s21, s21, 128
    ds_read_b128 a[232:235], v1 offset:2048
    v_cvt_pk_bf16_f32 v16, v56, v57
    v_mfma_f32_16x16x32_bf16 v[68:71], a[220:223], a[152:155], v[68:71]
    s_add_u32 m0, s22, 25600
    v_exp_f32 v90, v90
    v_mfma_f32_16x16x32_bf16 v[76:79], a[220:223], a[176:179], 0
    v_exp_f32 v67, v67
    v_mfma_f32_16x16x32_bf16 v[48:51], a[236:239], v[16:19], v[44:47]
    v_exp_f32 v89, v89
    v_mfma_f32_16x16x32_bf16 v[76:79], a[216:219], a[172:175], v[76:79]
    v_exp_f32 v66, v66
    v_mfma_f32_16x16x32_bf16 v[76:79], a[212:215], a[168:171], v[76:79]
    v_exp_f32 v72, v72
    v_mfma_f32_16x16x32_bf16 v[84:87], a[212:215], a[192:195], 0
    buffer_load_dwordx4 v6, s[8:11], s21 offen lds
    v_mfma_f32_16x16x32_bf16 v[84:87], a[216:219], a[196:199], v[84:87]
    s_add_u32 s21, s21, 128
    v_exp_f32 v88, v88
    v_mfma_f32_16x16x32_bf16 v[84:87], a[220:223], a[200:203], v[84:87]
    s_waitcnt lgkmcnt(2)
    v_exp_f32 v82, v82
    v_mfma_f32_16x16x32_bf16 v[84:87], a[224:227], a[204:207], v[84:87]
    s_add_u32 m0, s22, 26624
    v_exp_f32 v73, v73
    v_mfma_f32_16x16x32_bf16 v[84:87], a[228:231], a[208:211], v[84:87]
    s_waitcnt lgkmcnt(0)
    v_exp_f32 v74, v74
    v_mfma_f32_16x16x32_bf16 v[84:87], a[232:235], v[92:95], v[84:87]
    v_exp_f32 v91, v91
    v_mfma_f32_16x16x32_bf16 v[76:79], a[232:235], a[188:191], v[76:79]
    v_exp_f32 v80, v80
    v_mfma_f32_16x16x32_bf16 v[76:79], a[228:231], a[184:187], v[76:79]
    buffer_load_dwordx4 v6, s[8:11], s21 offen lds
    v_mfma_f32_16x16x32_bf16 v[76:79], a[224:227], a[180:183], v[76:79]
    s_add_u32 s21, s21, 12032
    v_exp_f32 v75, v75
    v_mfma_f32_16x16x32_bf16 v[68:71], a[224:227], a[156:159], v[68:71]
    v_exp_f32 v81, v81
    v_mfma_f32_16x16x32_bf16 v[68:71], a[228:231], a[160:163], v[68:71]
    s_add_u32 s56, s67, 128
    v_cvt_pk_bf16_f32 v34, v80, v81
    v_cvt_pk_bf16_f32 v23, v66, v67
    v_mfma_f32_16x16x32_bf16 v[68:71], a[232:235], a[164:167], v[68:71]
    ds_read_b128 a[220:223], v0 offset:7168
    v_cvt_pk_bf16_f32 v35, v82, v83
    v_mfma_f32_16x16x32_bf16 v[48:51], a[240:243], v[22:25], v[48:51]
    ds_read_b128 a[212:215], v0 offset:6144
    v_cvt_pk_bf16_f32 v29, v74, v75
    v_mfma_f32_16x16x32_bf16 v[60:63], a[232:235], a[140:143], v[60:63]
    ds_read_b128 a[216:219], v1 offset:6144
    v_cvt_pk_bf16_f32 v41, v90, v91
    v_mfma_f32_16x16x32_bf16 v[60:63], a[228:231], a[136:139], v[60:63]
    buffer_store_dwordx4 v[96:99], v6, s[16:19], s56 offen offset:0 nt
    s_add_u32 s58, s33, 128
    s_add_u32 m0, s38, 2048
    v_cvt_pk_bf16_f32 v28, v72, v73
    v_cvt_pk_bf16_f32 v40, v88, v89
    s_nop 0
    v_mfma_f32_16x16x32_bf16 v[48:51], a[244:247], v[28:31], v[48:51]
    v_mfma_f32_16x16x32_bf16 v[48:51], a[248:251], v[34:37], v[48:51]
    v_mfma_f32_16x16x32_bf16 v[48:51], a[252:255], v[40:43], v[48:51]
    buffer_load_dwordx4 v6, s[12:15], s58 offen nt lds
    v_mfma_f32_16x16x32_bf16 v[60:63], a[224:227], a[132:135], v[60:63]
    s_add_u32 m0, s38, 3072
    v_mfma_f32_16x16x32_bf16 v[52:55], a[224:227], a[108:111], v[52:55]
    ds_read_b128 v[96:99], v103 offset:3072
    v_mfma_f32_16x16x32_bf16 v[52:55], a[228:231], a[112:115], v[52:55]
    ds_read_b128 a[224:227], v1 offset:7168
    v_mfma_f32_16x16x32_bf16 v[52:55], a[232:235], a[116:119], v[52:55]
    s_waitcnt lgkmcnt(3)
    ds_read_b128 a[232:235], v1 offset:8192
    v_cmp_lt_f32 vcc, s29, v48
    v_mfma_f32_16x16x32_bf16 v[56:59], a[212:215], a[96:99], 0
    s_waitcnt lgkmcnt(3)
    ds_read_b128 a[228:231], v0 offset:8192
    v_mfma_f32_16x16x32_bf16 v[56:59], a[216:219], a[100:103], v[56:59]
    s_nop 0
    s_cbranch_vccnz L_rs_tr45d
L_ret_tr45d:
    v_fma_f32 v53, v53, s28, v9
    v_mfma_f32_16x16x32_bf16 v[56:59], a[220:223], a[104:107], v[56:59]
    v_fma_f32 v54, v54, s28, v9
    v_fma_f32 v61, v61, s28, v10
    v_mfma_f32_16x16x32_bf16 v[64:67], a[220:223], a[128:131], 0
    v_fma_f32 v62, v62, s28, v10
    v_mfma_f32_16x16x32_bf16 v[64:67], a[216:219], a[124:127], v[64:67]
    v_exp_f32 v62, v62
    v_mfma_f32_16x16x32_bf16 v[64:67], a[212:215], a[120:123], v[64:67]
    v_exp_f32 v53, v53
    v_mfma_f32_16x16x32_bf16 v[72:75], a[212:215], a[144:147], 0
    v_exp_f32 v61, v61
    v_mfma_f32_16x16x32_bf16 v[72:75], a[216:219], a[148:151], v[72:75]
    s_waitcnt lgkmcnt(3)
    buffer_load_dwordx4 v7, s[12:15], s58 offen nt lds
    v_mfma_f32_16x16x32_bf16 v[72:75], a[220:223], a[152:155], v[72:75]
    v_exp_f32 v54, v54
    v_mfma_f32_16x16x32_bf16 v[80:83], a[220:223], a[176:179], 0
    v_fma_f32 v60, v60, s28, v10
    s_waitcnt vmcnt(13) lgkmcnt(0)
    v_mfma_f32_16x16x32_bf16 v[80:83], a[216:219], a[172:175], v[80:83]
    s_barrier
    v_mfma_f32_16x16x32_bf16 v[80:83], a[212:215], a[168:171], v[80:83]
    s_add_u32 m0, s22, 0
    v_fma_f32 v63, v63, s28, v10
    v_fma_f32 v55, v55, s28, v9
    v_mfma_f32_16x16x32_bf16 v[88:91], a[212:215], a[192:195], 0
    v_exp_f32 v60, v60
    v_mfma_f32_16x16x32_bf16 v[88:91], a[216:219], a[196:199], v[88:91]
    ds_read_b64_tr_b16 a[212:213], v2 offset:18432
    v_mfma_f32_16x16x32_bf16 v[88:91], a[220:223], a[200:203], v[88:91]
    ds_read_b64_tr_b16 a[214:215], v2 offset:12288
    v_mfma_f32_16x16x32_bf16 v[88:91], a[224:227], a[204:207], v[88:91]
    v_exp_f32 v55, v55
    v_mfma_f32_16x16x32_bf16 v[88:91], a[228:231], a[208:211], v[88:91]
    ds_read_b64_tr_b16 a[216:217], v3 offset:18432
    v_add_u32 v103, 4096, v103
    v_mfma_f32_16x16x32_bf16 v[88:91], a[232:235], v[92:95], v[88:91]
    v_exp_f32 v63, v63
    v_mfma_f32_16x16x32_bf16 v[80:83], a[232:235], a[188:191], v[80:83]
    ds_read_b64_tr_b16 a[218:219], v3 offset:12288
    v_fma_f32 v52, v52, s28, v9
    v_mfma_f32_16x16x32_bf16 v[80:83], a[228:231], a[184:187], v[80:83]
    buffer_load_dwordx4 v6, s[4:7], s20 offen lds
    v_mfma_f32_16x16x32_bf16 v[80:83], a[224:227], a[180:183], v[80:83]
    s_add_u32 s20, s20, 128
    s_add_u32 m0, s22, 1024
    v_cvt_pk_bf16_f32 v15, v54, v55
    v_mfma_f32_16x16x32_bf16 v[72:75], a[224:227], a[156:159], v[72:75]
    buffer_load_dwordx4 v6, s[4:7], s20 offen lds
    v_mfma_f32_16x16x32_bf16 v[72:75], a[228:231], a[160:163], v[72:75]
    s_add_u32 s20, s20, 128
    s_add_u32 m0, s22, 2048
    v_cvt_pk_bf16_f32 v21, v62, v63
    v_mfma_f32_16x16x32_bf16 v[72:75], a[232:235], a[164:167], v[72:75]
    ds_read_b64_tr_b16 a[220:221], v4 offset:18432
    v_mfma_f32_16x16x32_bf16 v[64:67], a[232:235], a[140:143], v[64:67]
    buffer_load_dwordx4 v6, s[4:7], s20 offen lds
    v_mfma_f32_16x16x32_bf16 v[64:67], a[228:231], a[136:139], v[64:67]
    v_exp_f32 v52, v52
    v_mfma_f32_16x16x32_bf16 v[64:67], a[224:227], a[132:135], v[64:67]
    s_add_u32 s20, s20, 12032
    ds_read_b64_tr_b16 a[222:223], v4 offset:12288
    v_cvt_pk_bf16_f32 v20, v60, v61
    v_mfma_f32_16x16x32_bf16 v[56:59], a[224:227], a[108:111], v[56:59]
    ds_read_b64_tr_b16 a[224:225], v5 offset:18432
    v_cvt_pk_bf16_f32 v14, v52, v53
    v_mfma_f32_16x16x32_bf16 v[56:59], a[228:231], a[112:115], v[56:59]
    s_waitcnt lgkmcnt(3)
    ds_read_b64_tr_b16 a[226:227], v5 offset:12288
    s_bitcmp1_b32 s3, 1
    v_mfma_f32_16x16x32_bf16 v[56:59], a[232:235], a[116:119], v[56:59]
    buffer_store_dwordx4 v[96:99], v7, s[16:19], s56 offen offset:0 nt
    s_cbranch_scc1 L_loop5w1
    s_branch L_loop5w0
L_tr44:
    v_mfma_f32_16x16x32_bf16 v[112:115], a[212:215], v[16:19], v[112:115]
    ds_read_b64_tr_b16 a[234:235], v3 offset:13312
    v_mfma_f32_16x16x32_bf16 v[160:163], a[212:215], v[22:25], v[160:163]
    ds_read_b64_tr_b16 a[228:229], v2 offset:19456
    v_fma_f32 v78, v78, s28, v12
    v_fma_f32 v69, v69, s28, v11
    v_mfma_f32_16x16x32_bf16 v[208:211], a[212:215], v[28:31], v[208:211]
    ds_read_b64_tr_b16 a[232:233], v3 offset:19456
    v_fma_f32 v58, v58, s28, v9
    v_mfma_f32_16x16x32_bf16 a[0:3], a[212:215], v[34:37], a[0:3]
    s_waitcnt lgkmcnt(7)
    v_mfma_f32_16x16x32_bf16 a[4:7], a[216:219], v[34:37], a[4:7]
    ds_read_b64_tr_b16 a[230:231], v2 offset:13312
    v_fma_f32 v57, v57, s28, v9
    v_mfma_f32_16x16x32_bf16 v[212:215], a[216:219], v[28:31], v[212:215]
    v_fma_f32 v59, v59, s28, v9
    v_fma_f32 v73, v73, s28, v11
    v_mfma_f32_16x16x32_bf16 v[164:167], a[216:219], v[22:25], v[164:167]
    v_exp_f32 v57, v57
    v_mfma_f32_16x16x32_bf16 v[116:119], a[216:219], v[16:19], v[116:119]
    ds_read_b64_tr_b16 a[212:213], v4 offset:19456
    s_waitcnt lgkmcnt(7)
    v_mfma_f32_16x16x32_bf16 v[120:123], a[220:223], v[16:19], v[120:123]
    v_exp_f32 v59, v59
    v_mfma_f32_16x16x32_bf16 v[168:171], a[220:223], v[22:25], v[168:171]
    ds_read_b64_tr_b16 a[218:219], v5 offset:13312
    v_fma_f32 v82, v82, s28, v12
    v_mfma_f32_16x16x32_bf16 v[216:219], a[220:223], v[28:31], v[216:219]
    ds_read_b64_tr_b16 a[214:215], v4 offset:13312
    v_fma_f32 v70, v70, s28, v11
    v_mfma_f32_16x16x32_bf16 a[8:11], a[220:223], v[34:37], a[8:11]
    s_waitcnt lgkmcnt(5)
    v_exp_f32 v78, v78
    v_mfma_f32_16x16x32_bf16 a[12:15], a[224:227], v[34:37], a[12:15]
    ds_read_b64_tr_b16 a[216:217], v5 offset:19456
    s_add_u32 s39, s39, 12288
    v_mfma_f32_16x16x32_bf16 v[220:223], a[224:227], v[28:31], v[220:223]
    ds_read_b64_tr_b16 a[222:223], v2 offset:14336
    v_fma_f32 v79, v79, s28, v12
    v_mfma_f32_16x16x32_bf16 v[172:175], a[224:227], v[22:25], v[172:175]
    ds_read_b64_tr_b16 a[220:221], v2 offset:20480
    v_fma_f32 v66, v66, s28, v10
    v_mfma_f32_16x16x32_bf16 v[124:127], a[224:227], v[16:19], v[124:127]
    s_waitcnt lgkmcnt(6)
    v_fma_f32 v67, v67, s28, v10
    v_fma_f32 v63, v63, s28, v10
    v_mfma_f32_16x16x32_bf16 v[128:131], a[228:231], v[16:19], v[128:131]
    v_exp_f32 v69, v69
    v_mfma_f32_16x16x32_bf16 v[176:179], a[228:231], v[22:25], v[176:179]
    ds_read_b64_tr_b16 a[226:227], v3 offset:14336
    v_mfma_f32_16x16x32_bf16 v[224:227], a[228:231], v[28:31], v[224:227]
    ds_read_b64_tr_b16 a[224:225], v3 offset:20480
    v_fma_f32 v62, v62, s28, v10
    v_mfma_f32_16x16x32_bf16 a[16:19], a[228:231], v[34:37], a[16:19]
    ds_read_b64_tr_b16 a[230:231], v4 offset:14336
    v_fma_f32 v65, v65, s28, v10
    v_mfma_f32_16x16x32_bf16 a[20:23], a[232:235], v[34:37], a[20:23]
    v_fma_f32 v56, v56, s28, v9
    v_fma_f32 v77, v77, s28, v12
    v_mfma_f32_16x16x32_bf16 v[228:231], a[232:235], v[28:31], v[228:231]
    ds_read_b64_tr_b16 a[228:229], v4 offset:20480
    v_mfma_f32_16x16x32_bf16 v[180:183], a[232:235], v[22:25], v[180:183]
    v_exp_f32 v79, v79
    v_mfma_f32_16x16x32_bf16 v[132:135], a[232:235], v[16:19], v[132:135]
    s_waitcnt lgkmcnt(5)
    ds_read_b64_tr_b16 a[232:233], v5 offset:20480
    v_mfma_f32_16x16x32_bf16 v[136:139], a[212:215], v[16:19], v[136:139]
    ds_read_b64_tr_b16 a[234:235], v5 offset:14336
    v_fma_f32 v68, v68, s28, v11
    v_mfma_f32_16x16x32_bf16 v[184:187], a[212:215], v[22:25], v[184:187]
    v_exp_f32 v63, v63
    v_mfma_f32_16x16x32_bf16 v[232:235], a[212:215], v[28:31], v[232:235]
    v_fma_f32 v80, v80, s28, v12
    v_fma_f32 v76, v76, s28, v12
    v_mfma_f32_16x16x32_bf16 a[24:27], a[212:215], v[34:37], a[24:27]
    v_fma_f32 v75, v75, s28, v11
    v_mfma_f32_16x16x32_bf16 a[28:31], a[216:219], v[34:37], a[28:31]
    v_exp_f32 v77, v77
    v_mfma_f32_16x16x32_bf16 v[236:239], a[216:219], v[28:31], v[236:239]
    v_exp_f32 v76, v76
    v_mfma_f32_16x16x32_bf16 v[188:191], a[216:219], v[22:25], v[188:191]
    v_exp_f32 v58, v58
    v_mfma_f32_16x16x32_bf16 v[140:143], a[216:219], v[16:19], v[140:143]
    s_waitcnt lgkmcnt(2)
    v_exp_f32 v62, v62
    v_mfma_f32_16x16x32_bf16 v[144:147], a[220:223], v[16:19], v[144:147]
    v_cvt_pk_bf16_f32 v21, v62, v63
    v_mfma_f32_16x16x32_bf16 v[192:195], a[220:223], v[22:25], v[192:195]
    v_exp_f32 v68, v68
    v_mfma_f32_16x16x32_bf16 v[240:243], a[220:223], v[28:31], v[240:243]
    s_waitcnt vmcnt(10) lgkmcnt(0)
    v_exp_f32 v65, v65
    v_mfma_f32_16x16x32_bf16 a[32:35], a[220:223], v[34:37], a[32:35]
    s_barrier
    v_mfma_f32_16x16x32_bf16 a[36:39], a[224:227], v[34:37], a[36:39]
    s_add_u32 m0, s22, 36864
    ds_read_b128 a[216:219], v1 offset:12288
    v_fma_f32 v83, v83, s28, v12
    v_mfma_f32_16x16x32_bf16 v[244:247], a[224:227], v[28:31], v[244:247]
    ds_read_b128 a[212:215], v0 offset:12288
    v_fma_f32 v64, v64, s28, v10
    v_mfma_f32_16x16x32_bf16 v[196:199], a[224:227], v[22:25], v[196:199]
    buffer_load_dwordx4 v6, s[8:11], s21 offen lds
    v_mfma_f32_16x16x32_bf16 v[148:151], a[224:227], v[16:19], v[148:151]
    s_add_u32 s21, s21, 128
    ds_read_b128 a[220:223], v0 offset:13312
    v_fma_f32 v71, v71, s28, v11
    v_mfma_f32_16x16x32_bf16 v[152:155], a[228:231], v[16:19], v[152:155]
    s_add_u32 m0, s22, 37888
    ds_read_b128 v[84:87], v103 offset:0
    v_fma_f32 v81, v81, s28, v12
    v_mfma_f32_16x16x32_bf16 v[200:203], a[228:231], v[22:25], v[200:203]
    buffer_load_dwordx4 v6, s[8:11], s21 offen lds
    v_mfma_f32_16x16x32_bf16 v[248:251], a[228:231], v[28:31], v[248:251]
    ds_read_b128 a[224:227], v1 offset:13312
    v_mfma_f32_16x16x32_bf16 a[40:43], a[228:231], v[34:37], a[40:43]
    s_add_u32 s21, s21, 128
    v_fma_f32 v74, v74, s28, v11
    v_mfma_f32_16x16x32_bf16 a[44:47], a[232:235], v[34:37], a[44:47]
    v_exp_f32 v75, v75
    v_mfma_f32_16x16x32_bf16 v[252:255], a[232:235], v[28:31], v[252:255]
    s_add_u32 m0, s22, 38912
    v_exp_f32 v70, v70
    v_mfma_f32_16x16x32_bf16 v[204:207], a[232:235], v[22:25], v[204:207]
    buffer_load_dwordx4 v6, s[8:11], s21 offen lds
    v_mfma_f32_16x16x32_bf16 v[156:159], a[232:235], v[16:19], v[156:159]
    s_waitcnt lgkmcnt(3)
    v_exp_f32 v71, v71
    v_mfma_f32_16x16x32_bf16 v[52:55], a[212:215], a[96:99], 0
    ds_read_b128 a[228:231], v0 offset:14336
    v_cvt_pk_bf16_f32 v32, v76, v77
    v_mfma_f32_16x16x32_bf16 v[52:55], a[216:219], a[100:103], v[52:55]
    s_waitcnt lgkmcnt(3)
    v_exp_f32 v82, v82
    v_mfma_f32_16x16x32_bf16 v[52:55], a[220:223], a[104:107], v[52:55]
    ds_read_b128 a[232:235], v1 offset:14336
    v_fma_f32 v72, v72, s28, v11
    v_mfma_f32_16x16x32_bf16 v[60:63], a[220:223], a[128:131], 0
    s_add_u32 s21, s21, 12032
    v_cvt_pk_bf16_f32 v27, v70, v71
    v_cvt_pk_bf16_f32 v26, v68, v69
    v_mfma_f32_16x16x32_bf16 v[60:63], a[216:219], a[124:127], v[60:63]
    s_add_u32 s57, s24, 128
    ds_read_b128 v[96:99], v103 offset:2048
    v_cvt_pk_bf16_f32 v33, v78, v79
    v_mfma_f32_16x16x32_bf16 v[60:63], a[212:215], a[120:123], v[60:63]
    v_exp_f32 v64, v64
    v_mfma_f32_16x16x32_bf16 v[68:71], a[212:215], a[144:147], 0
    v_exp_f32 v80, v80
    v_mfma_f32_16x16x32_bf16 v[68:71], a[216:219], a[148:151], v[68:71]
    v_exp_f32 v83, v83
    v_mfma_f32_16x16x32_bf16 v[68:71], a[220:223], a[152:155], v[68:71]
    v_exp_f32 v67, v67
    v_mfma_f32_16x16x32_bf16 v[76:79], a[220:223], a[176:179], 0
    v_exp_f32 v66, v66
    v_mfma_f32_16x16x32_bf16 v[76:79], a[216:219], a[172:175], v[76:79]
    v_exp_f32 v74, v74
    v_mfma_f32_16x16x32_bf16 v[76:79], a[212:215], a[168:171], v[76:79]
    s_waitcnt lgkmcnt(2)
    v_exp_f32 v72, v72
    v_mfma_f32_16x16x32_bf16 v[76:79], a[224:227], a[180:183], v[76:79]
    v_mfma_f32_16x16x32_bf16 v[76:79], a[228:231], a[184:187], v[76:79]
    s_waitcnt lgkmcnt(1)
    ds_read_b128 a[220:223], v0 offset:19456
    v_mfma_f32_16x16x32_bf16 v[76:79], a[232:235], a[188:191], v[76:79]
    v_exp_f32 v73, v73
    v_mfma_f32_16x16x32_bf16 v[68:71], a[232:235], a[164:167], v[68:71]
    ds_read_b128 a[212:215], v0 offset:18432
    v_cvt_pk_bf16_f32 v22, v64, v65
    v_mfma_f32_16x16x32_bf16 v[68:71], a[228:231], a[160:163], v[68:71]
    v_exp_f32 v56, v56
    v_mfma_f32_16x16x32_bf16 v[68:71], a[224:227], a[156:159], v[68:71]
    ds_read_b128 a[216:219], v1 offset:18432
    v_cvt_pk_bf16_f32 v17, v58, v59
    v_mfma_f32_16x16x32_bf16 v[60:63], a[224:227], a[132:135], v[60:63]
    ds_read_b128 v[88:91], v103 offset:1024
    v_cvt_pk_bf16_f32 v16, v56, v57
    v_mfma_f32_16x16x32_bf16 v[60:63], a[228:231], a[136:139], v[60:63]
    v_cvt_pk_bf16_f32 v28, v72, v73
    v_mfma_f32_16x16x32_bf16 v[60:63], a[232:235], a[140:143], v[60:63]
    v_exp_f32 v81, v81
    v_mfma_f32_16x16x32_bf16 v[52:55], a[232:235], a[116:119], v[52:55]
    ds_read_b128 a[232:235], v1 offset:20480
    v_cvt_pk_bf16_f32 v23, v66, v67
    v_mfma_f32_16x16x32_bf16 v[44:47], a[236:239], v[14:17], v[48:51]
    v_mfma_f32_16x16x32_bf16 v[52:55], a[228:231], a[112:115], v[52:55]
    v_cvt_pk_bf16_f32 v29, v74, v75
    v_cvt_pk_bf16_f32 v35, v82, v83
    v_mfma_f32_16x16x32_bf16 v[44:47], a[240:243], v[20:23], v[44:47]
    v_cvt_pk_bf16_f32 v34, v80, v81
    v_mfma_f32_16x16x32_bf16 v[52:55], a[224:227], a[108:111], v[52:55]
    ds_read_b128 a[228:231], v0 offset:20480
    v_mfma_f32_16x16x32_bf16 v[44:47], a[244:247], v[26:29], v[44:47]
    ds_read_b128 a[224:227], v1 offset:19456
    v_mfma_f32_16x16x32_bf16 v[44:47], a[248:251], v[32:35], v[44:47]
    buffer_store_dwordx4 v[84:87], v6, s[16:19], s24 offen offset:0 nt
    s_nop 0
    ds_read_b128 v[84:87], v103 offset:3072
    s_waitcnt lgkmcnt(4)
    v_mfma_f32_16x16x32_bf16 v[56:59], a[212:215], a[96:99], 0
    v_mfma_f32_16x16x32_bf16 v[56:59], a[216:219], a[100:103], v[56:59]
    s_nop 1
    v_cmp_lt_f32 vcc, s29, v44
    v_mfma_f32_16x16x32_bf16 v[56:59], a[220:223], a[104:107], v[56:59]
    buffer_store_dwordx4 v[88:91], v7, s[16:19], s24 offen offset:0 nt
    s_nop 2
    s_cbranch_vccnz L_rs_tr44a
L_ret_tr44a:
    v_mfma_f32_16x16x32_bf16 v[64:67], a[220:223], a[128:131], 0
    v_fma_f32 v54, v54, s28, v9
    v_fma_f32 v53, v53, s28, v9
    v_mfma_f32_16x16x32_bf16 v[64:67], a[216:219], a[124:127], v[64:67]
    v_exp_f32 v53, v53
    v_mfma_f32_16x16x32_bf16 v[64:67], a[212:215], a[120:123], v[64:67]
    v_fma_f32 v55, v55, s28, v9
    s_waitcnt vmcnt(8) lgkmcnt(1)
    v_mfma_f32_16x16x32_bf16 v[72:75], a[212:215], a[144:147], 0
    s_barrier
    v_mfma_f32_16x16x32_bf16 v[72:75], a[216:219], a[148:151], v[72:75]
    s_add_u32 m0, s22, 12288
    v_fma_f32 v61, v61, s28, v10
    v_fma_f32 v52, v52, s28, v9
    v_mfma_f32_16x16x32_bf16 v[72:75], a[220:223], a[152:155], v[72:75]
    buffer_load_dwordx4 v6, s[4:7], s20 offen lds
    v_mfma_f32_16x16x32_bf16 v[80:83], a[220:223], a[176:179], 0
    s_add_u32 s20, s20, 128
    v_exp_f32 v55, v55
    v_mfma_f32_16x16x32_bf16 v[80:83], a[216:219], a[172:175], v[80:83]
    s_add_u32 m0, s22, 13312
    v_exp_f32 v54, v54
    v_mfma_f32_16x16x32_bf16 v[80:83], a[212:215], a[168:171], v[80:83]
    buffer_load_dwordx4 v6, s[4:7], s20 offen lds
    v_mfma_f32_16x16x32_bf16 v[80:83], a[224:227], a[180:183], v[80:83]
    s_add_u32 s20, s20, 128
    v_exp_f32 v61, v61
    v_mfma_f32_16x16x32_bf16 v[80:83], a[228:231], a[184:187], v[80:83]
    ds_read_b64_tr_b16 a[212:213], v2 offset:0
    v_cvt_pk_bf16_f32 v19, v54, v55
    v_mfma_f32_16x16x32_bf16 v[80:83], a[232:235], a[188:191], v[80:83]
    s_add_u32 m0, s22, 14336
    ds_read_b64_tr_b16 a[214:215], v2 offset:6144
    v_mfma_f32_16x16x32_bf16 v[72:75], a[232:235], a[164:167], v[72:75]
    buffer_load_dwordx4 v6, s[4:7], s20 offen lds
    v_mfma_f32_16x16x32_bf16 v[72:75], a[228:231], a[160:163], v[72:75]
    ds_read_b64_tr_b16 a[216:217], v3 offset:0
    v_mfma_f32_16x16x32_bf16 v[72:75], a[224:227], a[156:159], v[72:75]
    buffer_store_dwordx4 v[96:99], v6, s[16:19], s57 offen offset:0 nt
    ds_read_b64_tr_b16 a[218:219], v3 offset:6144
    v_exp_f32 v52, v52
    v_mfma_f32_16x16x32_bf16 v[64:67], a[224:227], a[132:135], v[64:67]
    ds_read_b64_tr_b16 a[220:221], v4 offset:0
    v_fma_f32 v60, v60, s28, v10
    v_mfma_f32_16x16x32_bf16 v[64:67], a[228:231], a[136:139], v[64:67]
    v_mfma_f32_16x16x32_bf16 v[64:67], a[232:235], a[140:143], v[64:67]
    v_exp_f32 v60, v60
    v_mfma_f32_16x16x32_bf16 v[56:59], a[232:235], a[116:119], v[56:59]
    ds_read_b64_tr_b16 a[222:223], v4 offset:6144
    v_cvt_pk_bf16_f32 v24, v60, v61
    v_mfma_f32_16x16x32_bf16 v[56:59], a[228:231], a[112:115], v[56:59]
    s_add_u32 s20, s20, 12032
    s_waitcnt lgkmcnt(4)
    v_mfma_f32_16x16x32_bf16 v[56:59], a[224:227], a[108:111], v[56:59]
    buffer_store_dwordx4 v[84:87], v7, s[16:19], s57 offen offset:0 nt
    ds_read_b64_tr_b16 a[224:225], v5 offset:0
    ds_read_b64_tr_b16 a[226:227], v5 offset:6144
    v_cvt_pk_bf16_f32 v18, v52, v53
    v_lshrrev_b32 v105, 11, v0
    v_mfma_f32_16x16x32_bf16 v[112:115], a[212:215], v[14:17], v[112:115]
    v_xor_b32 v105, s65, v105
    v_fma_f32 v70, v70, s28, v11
    v_fma_f32 v73, v73, s28, v11
    v_mfma_f32_16x16x32_bf16 v[160:163], a[212:215], v[20:23], v[160:163]
    s_add_u32 s39, s39, 12288
    ds_read_b64_tr_b16 a[234:235], v3 offset:7168
    v_fma_f32 v68, v68, s28, v11
    v_fma_f32 v77, v77, s28, v12
    v_mfma_f32_16x16x32_bf16 v[208:211], a[212:215], v[26:29], v[208:211]
    ds_read_b64_tr_b16 a[228:229], v2 offset:1024
    v_fma_f32 v72, v72, s28, v11
    v_mfma_f32_16x16x32_bf16 a[0:3], a[212:215], v[32:35], a[0:3]
    s_waitcnt lgkmcnt(6)
    ds_read_b64_tr_b16 a[232:233], v3 offset:1024
    v_and_b32 v104, 0x3ff, v0
    v_mfma_f32_16x16x32_bf16 a[4:7], a[216:219], v[32:35], a[4:7]
    ds_read_b64_tr_b16 a[230:231], v2 offset:7168
    v_fma_f32 v76, v76, s28, v12
    v_mfma_f32_16x16x32_bf16 v[212:215], a[216:219], v[26:29], v[212:215]
    v_lshl_add_u32 v104, v105, 10, v104
    v_fma_f32 v62, v62, s28, v10
    v_mfma_f32_16x16x32_bf16 v[164:167], a[216:219], v[20:23], v[164:167]
    ds_read_b64_tr_b16 a[212:213], v4 offset:1024
    v_fma_f32 v81, v81, s28, v12
    v_mfma_f32_16x16x32_bf16 v[116:119], a[216:219], v[14:17], v[116:119]
    s_waitcnt lgkmcnt(7)
    v_exp_f32 v77, v77
    v_mfma_f32_16x16x32_bf16 v[120:123], a[220:223], v[14:17], v[120:123]
    v_exp_f32 v68, v68
    v_mfma_f32_16x16x32_bf16 v[168:171], a[220:223], v[20:23], v[168:171]
    ds_read_b64_tr_b16 a[218:219], v5 offset:7168
    v_add_u32 v104, s38, v104
    v_mfma_f32_16x16x32_bf16 v[216:219], a[220:223], v[26:29], v[216:219]
    ds_read_b64_tr_b16 a[214:215], v4 offset:7168
    v_fma_f32 v71, v71, s28, v11
    v_mfma_f32_16x16x32_bf16 a[8:11], a[220:223], v[32:35], a[8:11]
    s_waitcnt lgkmcnt(6)
    ds_read_b64_tr_b16 a[220:221], v2 offset:2048
    v_xor_b32 v105, 64, v104
    v_mfma_f32_16x16x32_bf16 a[12:15], a[224:227], v[32:35], a[12:15]
    ds_read_b128 a[100:103], v105 offset:0
    v_exp_f32 v72, v72
    v_mfma_f32_16x16x32_bf16 v[220:223], a[224:227], v[26:29], v[220:223]
    ds_read_b64_tr_b16 a[216:217], v5 offset:1024
    v_fma_f32 v79, v79, s28, v12
    v_mfma_f32_16x16x32_bf16 v[172:175], a[224:227], v[20:23], v[172:175]
    v_exp_f32 v79, v79
    v_mfma_f32_16x16x32_bf16 v[124:127], a[224:227], v[14:17], v[124:127]
    s_waitcnt lgkmcnt(6)
    v_exp_f32 v70, v70
    v_mfma_f32_16x16x32_bf16 v[128:131], a[228:231], v[14:17], v[128:131]
    ds_read_b64_tr_b16 a[222:223], v2 offset:8192
    v_exp_f32 v62, v62
    v_mfma_f32_16x16x32_bf16 v[176:179], a[228:231], v[20:23], v[176:179]
    ds_read_b64_tr_b16 a[224:225], v3 offset:2048
    v_fma_f32 v58, v58, s28, v9
    v_mfma_f32_16x16x32_bf16 v[224:227], a[228:231], v[26:29], v[224:227]
    ds_read_b64_tr_b16 a[226:227], v3 offset:8192
    v_fma_f32 v67, v67, s28, v10
    v_mfma_f32_16x16x32_bf16 a[16:19], a[228:231], v[32:35], a[16:19]
    ds_read_b64_tr_b16 a[228:229], v4 offset:2048
    v_fma_f32 v69, v69, s28, v11
    v_mfma_f32_16x16x32_bf16 a[20:23], a[232:235], v[32:35], a[20:23]
    ds_read_b64_tr_b16 a[230:231], v4 offset:8192
    v_fma_f32 v74, v74, s28, v11
    v_mfma_f32_16x16x32_bf16 v[228:231], a[232:235], v[26:29], v[228:231]
    ds_read_b128 a[160:163], v104 offset:16384
    v_fma_f32 v65, v65, s28, v10
    v_mfma_f32_16x16x32_bf16 v[180:183], a[232:235], v[20:23], v[180:183]
    v_exp_f32 v76, v76
    v_mfma_f32_16x16x32_bf16 v[132:135], a[232:235], v[14:17], v[132:135]
    s_waitcnt lgkmcnt(6)
    ds_read_b128 a[152:155], v104 offset:14336
    v_exp_f32 v81, v81
    v_mfma_f32_16x16x32_bf16 v[136:139], a[212:215], v[14:17], v[136:139]
    ds_read_b64_tr_b16 a[234:235], v5 offset:8192
    v_fma_f32 v57, v57, s28, v9
    v_mfma_f32_16x16x32_bf16 v[184:187], a[212:215], v[20:23], v[184:187]
    ds_read_b64_tr_b16 a[232:233], v5 offset:2048
    v_fma_f32 v78, v78, s28, v12
    v_mfma_f32_16x16x32_bf16 v[232:235], a[212:215], v[26:29], v[232:235]
    ds_read_b128 a[148:151], v105 offset:12288
    v_cvt_pk_bf16_f32 v36, v76, v77
    v_mfma_f32_16x16x32_bf16 a[24:27], a[212:215], v[32:35], a[24:27]
    ds_read_b128 a[176:179], v104 offset:20480
    v_exp_f32 v57, v57
    v_mfma_f32_16x16x32_bf16 a[28:31], a[216:219], v[32:35], a[28:31]
    v_exp_f32 v71, v71
    v_mfma_f32_16x16x32_bf16 v[236:239], a[216:219], v[26:29], v[236:239]
    ds_read_b128 a[124:127], v105 offset:6144
    v_exp_f32 v73, v73
    v_mfma_f32_16x16x32_bf16 v[188:191], a[216:219], v[20:23], v[188:191]
    ds_read_b128 a[172:175], v105 offset:18432
    v_cvt_pk_bf16_f32 v31, v70, v71
    v_mfma_f32_16x16x32_bf16 v[140:143], a[216:219], v[14:17], v[140:143]
    s_waitcnt lgkmcnt(7)
    ds_read_b128 a[144:147], v104 offset:12288
    v_exp_f32 v78, v78
    v_mfma_f32_16x16x32_bf16 v[144:147], a[220:223], v[14:17], v[144:147]
    ds_read_b128 a[120:123], v104 offset:6144
    v_fma_f32 v80, v80, s28, v12
    v_mfma_f32_16x16x32_bf16 v[192:195], a[220:223], v[20:23], v[192:195]
    ds_read_b128 a[168:171], v104 offset:18432
    v_fma_f32 v63, v63, s28, v10
    v_mfma_f32_16x16x32_bf16 v[240:243], a[220:223], v[26:29], v[240:243]
    s_waitcnt vmcnt(10) lgkmcnt(7)
    v_exp_f32 v69, v69
    v_mfma_f32_16x16x32_bf16 a[32:35], a[220:223], v[32:35], a[32:35]
    s_barrier
    v_mfma_f32_16x16x32_bf16 a[36:39], a[224:227], v[32:35], a[36:39]
    s_add_u32 s21, s21, s62
    ds_read_b128 a[108:111], v105 offset:2048
    v_fma_f32 v56, v56, s28, v9
    v_mfma_f32_16x16x32_bf16 v[244:247], a[224:227], v[26:29], v[244:247]
    s_add_u32 m0, s22, 24576
    ds_read_b128 a[212:215], v0 offset:0
    buffer_load_dwordx4 v6, s[8:11], s21 offen lds
    v_mfma_f32_16x16x32_bf16 v[196:199], a[224:227], v[20:23], v[196:199]
    s_add_u32 s21, s21, 128
    ds_read_b128 a[96:99], v104 offset:0
    v_fma_f32 v82, v82, s28, v12
    v_mfma_f32_16x16x32_bf16 v[148:151], a[224:227], v[14:17], v[148:151]
    s_add_u32 m0, s22, 25600
    ds_read_b128 a[104:107], v104 offset:2048
    buffer_load_dwordx4 v6, s[8:11], s21 offen lds
    v_mfma_f32_16x16x32_bf16 v[152:155], a[228:231], v[14:17], v[152:155]
    ds_read_b128 a[216:219], v1 offset:0
    v_fma_f32 v66, v66, s28, v10
    v_mfma_f32_16x16x32_bf16 v[200:203], a[228:231], v[20:23], v[200:203]
    s_add_u32 s21, s21, 128
    ds_read_b128 a[224:227], v1 offset:1024
    v_fma_f32 v64, v64, s28, v10
    v_mfma_f32_16x16x32_bf16 v[248:251], a[228:231], v[26:29], v[248:251]
    s_add_u32 m0, s22, 26624
    ds_read_b128 a[128:131], v104 offset:8192
    buffer_load_dwordx4 v6, s[8:11], s21 offen lds
    v_mfma_f32_16x16x32_bf16 a[40:43], a[228:231], v[32:35], a[40:43]
    v_exp_f32 v58, v58
    v_mfma_f32_16x16x32_bf16 a[44:47], a[232:235], v[32:35], a[44:47]
    v_exp_f32 v56, v56
    v_mfma_f32_16x16x32_bf16 v[252:255], a[232:235], v[26:29], v[252:255]
    ds_read_b128 a[220:223], v0 offset:1024
    v_exp_f32 v63, v63
    v_mfma_f32_16x16x32_bf16 v[204:207], a[232:235], v[20:23], v[204:207]
    ds_read_b128 a[180:183], v105 offset:20480
    v_fma_f32 v75, v75, s28, v11
    v_mfma_f32_16x16x32_bf16 v[156:159], a[232:235], v[14:17], v[156:159]
    s_waitcnt lgkmcnt(6)
    ds_read_b128 a[164:167], v105 offset:16384
    v_cvt_pk_bf16_f32 v25, v62, v63
    v_mfma_f32_16x16x32_bf16 v[52:55], a[212:215], a[96:99], 0
    ds_read_b128 a[156:159], v105 offset:14336
    v_cvt_pk_bf16_f32 v37, v78, v79
    v_mfma_f32_16x16x32_bf16 v[60:63], a[212:215], a[120:123], 0
    ds_read_b128 a[132:135], v105 offset:8192
    v_cvt_pk_bf16_f32 v30, v68, v69
    v_mfma_f32_16x16x32_bf16 v[68:71], a[212:215], a[144:147], 0
    v_exp_f32 v67, v67
    v_mfma_f32_16x16x32_bf16 v[76:79], a[212:215], a[168:171], 0
    s_waitcnt lgkmcnt(6)
    v_exp_f32 v74, v74
    v_mfma_f32_16x16x32_bf16 v[52:55], a[216:219], a[100:103], v[52:55]
    ds_read_b128 a[228:231], v0 offset:6144
    v_fma_f32 v59, v59, s28, v9
    v_mfma_f32_16x16x32_bf16 v[60:63], a[216:219], a[124:127], v[60:63]
    v_exp_f32 v65, v65
    v_mfma_f32_16x16x32_bf16 v[68:71], a[216:219], a[148:151], v[68:71]
    v_exp_f32 v66, v66
    v_mfma_f32_16x16x32_bf16 v[76:79], a[216:219], a[172:175], v[76:79]
    s_waitcnt lgkmcnt(5)
    v_exp_f32 v75, v75
    v_mfma_f32_16x16x32_bf16 v[52:55], a[220:223], a[104:107], v[52:55]
    v_exp_f32 v64, v64
    v_mfma_f32_16x16x32_bf16 v[60:63], a[220:223], a[128:131], v[60:63]
    ds_read_b128 a[232:235], v1 offset:6144
    v_cvt_pk_bf16_f32 v23, v66, v67
    v_mfma_f32_16x16x32_bf16 v[68:71], a[220:223], a[152:155], v[68:71]
    v_exp_f32 v59, v59
    v_mfma_f32_16x16x32_bf16 v[76:79], a[220:223], a[176:179], v[76:79]
    ds_read_b128 a[212:215], v0 offset:7168
    v_cvt_pk_bf16_f32 v16, v56, v57
    v_mfma_f32_16x16x32_bf16 v[52:55], a[224:227], a[108:111], v[52:55]
    s_waitcnt lgkmcnt(3)
    v_exp_f32 v82, v82
    v_mfma_f32_16x16x32_bf16 v[60:63], a[224:227], a[132:135], v[60:63]
    v_cvt_pk_bf16_f32 v22, v64, v65
    v_cvt_pk_bf16_f32 v28, v72, v73
    v_mfma_f32_16x16x32_bf16 v[68:71], a[224:227], a[156:159], v[68:71]
    v_cvt_pk_bf16_f32 v17, v58, v59
    v_fma_f32 v83, v83, s28, v12
    v_mfma_f32_16x16x32_bf16 v[76:79], a[224:227], a[180:183], v[76:79]
    s_waitcnt lgkmcnt(2)
    v_exp_f32 v80, v80
    v_mfma_f32_16x16x32_bf16 v[56:59], a[228:231], a[96:99], 0
    v_exp_f32 v83, v83
    v_mfma_f32_16x16x32_bf16 v[64:67], a[228:231], a[120:123], 0
    ds_read_b128 a[224:227], v1 offset:2048
    v_cvt_pk_bf16_f32 v29, v74, v75
    v_mfma_f32_16x16x32_bf16 v[48:51], a[236:239], v[16:19], v[44:47]
    ds_read_b128 a[216:219], v1 offset:7168
    v_cvt_pk_bf16_f32 v34, v80, v81
    v_mfma_f32_16x16x32_bf16 v[72:75], a[228:231], a[144:147], 0
    ds_read_b128 a[220:223], v0 offset:2048
    v_cvt_pk_bf16_f32 v35, v82, v83
    v_mfma_f32_16x16x32_bf16 v[80:83], a[228:231], a[168:171], 0
    s_waitcnt lgkmcnt(4)
    ds_read_b128 a[112:115], v104 offset:4096
    v_mfma_f32_16x16x32_bf16 v[56:59], a[232:235], a[100:103], v[56:59]
    ds_read_b128 a[228:231], v0 offset:8192
    v_mfma_f32_16x16x32_bf16 v[64:67], a[232:235], a[124:127], v[64:67]
    ds_read_b128 a[136:139], v104 offset:10240
    v_mfma_f32_16x16x32_bf16 v[72:75], a[232:235], a[148:151], v[72:75]
    v_mfma_f32_16x16x32_bf16 v[80:83], a[232:235], a[172:175], v[80:83]
    ds_read_b128 a[232:235], v1 offset:8192
    v_mfma_f32_16x16x32_bf16 v[48:51], a[240:243], v[22:25], v[48:51]
    ds_read_b128 a[116:119], v105 offset:4096
    v_mfma_f32_16x16x32_bf16 v[48:51], a[244:247], v[28:31], v[48:51]
    ds_read_b128 a[140:143], v105 offset:10240
    v_mfma_f32_16x16x32_bf16 v[48:51], a[248:251], v[34:37], v[48:51]
    s_waitcnt lgkmcnt(8)
    ds_read_b128 a[184:187], v104 offset:22528
    v_mfma_f32_16x16x32_bf16 v[56:59], a[212:215], a[104:107], v[56:59]
    v_mfma_f32_16x16x32_bf16 v[64:67], a[212:215], a[128:131], v[64:67]
    ds_read_b128 a[188:191], v105 offset:22528
    v_mfma_f32_16x16x32_bf16 v[72:75], a[212:215], a[152:155], v[72:75]
    s_nop 1
    v_cmp_lt_f32 vcc, s29, v48
    v_mfma_f32_16x16x32_bf16 v[80:83], a[212:215], a[176:179], v[80:83]
    s_waitcnt lgkmcnt(6)
    v_mfma_f32_16x16x32_bf16 v[56:59], a[216:219], a[108:111], v[56:59]
    s_add_u32 s21, s21, 12032
    v_mfma_f32_16x16x32_bf16 v[64:67], a[216:219], a[132:135], v[64:67]
    s_cbranch_vccnz L_rs_tr44b
L_ret_tr44b:
    s_waitcnt vmcnt(10) lgkmcnt(4)
    v_mfma_f32_16x16x32_bf16 v[72:75], a[216:219], a[156:159], v[72:75]
    s_barrier
    v_mfma_f32_16x16x32_bf16 v[80:83], a[216:219], a[180:183], v[80:83]
    s_add_u32 m0, s22, 0
    ds_read_b64_tr_b16 a[212:213], v2 offset:18432
    buffer_load_dwordx4 v6, s[4:7], s20 offen lds
    v_mfma_f32_16x16x32_bf16 v[52:55], a[220:223], a[112:115], v[52:55]
    s_add_u32 s20, s20, 128
    ds_read_b64_tr_b16 a[214:215], v2 offset:12288
    v_lshrrev_b32 v108, 11, v0
    v_mfma_f32_16x16x32_bf16 v[60:63], a[220:223], a[136:139], v[60:63]
    s_add_u32 m0, s22, 1024
    ds_read_b64_tr_b16 a[216:217], v3 offset:18432
    buffer_load_dwordx4 v6, s[4:7], s20 offen lds
    v_mfma_f32_16x16x32_bf16 v[68:71], a[220:223], a[160:163], v[68:71]
    s_waitcnt lgkmcnt(3)
    v_rcp_f32 v50, v50
    v_mfma_f32_16x16x32_bf16 v[76:79], a[220:223], a[184:187], v[76:79]
    s_add_u32 s20, s20, 128
    v_mov_b32 v100, v48
    v_xor_b32 v108, s65, v108
    v_mfma_f32_16x16x32_bf16 v[52:55], a[224:227], a[116:119], v[52:55]
    s_add_u32 m0, s22, 2048
    v_rcp_f32 v8, v51
    v_mfma_f32_16x16x32_bf16 v[60:63], a[224:227], a[140:143], v[60:63]
    buffer_load_dwordx4 v6, s[4:7], s20 offen lds
    v_mfma_f32_16x16x32_bf16 v[68:71], a[224:227], a[164:167], v[68:71]
    v_and_b32 v101, 0x3ff, v0
    v_lshl_add_u32 v101, v108, 10, v101
    v_mfma_f32_16x16x32_bf16 v[76:79], a[224:227], a[188:191], v[76:79]
    s_add_u32 s20, s20, 12032
    ds_read_b64_tr_b16 a[218:219], v3 offset:12288
    v_mbcnt_lo_u32_b32 v108, -1, 0
    v_mfma_f32_16x16x32_bf16 v[56:59], a[228:231], a[112:115], v[56:59]
    v_rcp_f32 v102, v49
    v_mfma_f32_16x16x32_bf16 v[64:67], a[228:231], a[136:139], v[64:67]
    v_mbcnt_hi_u32_b32 v108, -1, v108
    v_lshrrev_b32 v108, 1, v108
    v_mfma_f32_16x16x32_bf16 v[72:75], a[228:231], a[160:163], v[72:75]
    ds_read_b64_tr_b16 a[220:221], v4 offset:18432
    v_and_b32 v108, 24, v108
    v_mfma_f32_16x16x32_bf16 v[80:83], a[228:231], a[184:187], v[80:83]
    v_permlane32_swap_b32 v48, v100
    v_mfma_f32_16x16x32_bf16 v[56:59], a[232:235], a[116:119], v[56:59]
    ds_read_b64_tr_b16 a[222:223], v4 offset:12288
    v_bfe_u32 v108, s66, v108, 8
    v_mfma_f32_16x16x32_bf16 v[64:67], a[232:235], a[140:143], v[64:67]
    s_waitcnt lgkmcnt(3)
    v_rcp_f32 v48, v48
    v_mfma_f32_16x16x32_bf16 v[72:75], a[232:235], a[164:167], v[72:75]
    ds_read_b64_tr_b16 a[224:225], v5 offset:18432
    v_add_u32 v101, s38, v101
    v_mfma_f32_16x16x32_bf16 v[80:83], a[232:235], a[188:191], v[80:83]
    ds_read_b64_tr_b16 a[226:227], v5 offset:12288
    v_xor_b32 v101, v101, v108
    v_max3_f32 v99, v76, v77, v78
    v_mfma_f32_16x16x32_bf16 v[112:115], a[212:215], v[16:19], v[112:115]
    s_mov_b32 s67, s34
    ds_read_b64_tr_b16 a[234:235], v3 offset:13312
    v_max3_f32 v97, v60, v61, v62
    v_max3_f32 v96, v52, v53, v54
    v_max3_f32 v99, v99, v79, v80
    v_max3_f32 v96, v96, v55, v56
    v_max3_f32 v98, v68, v69, v70
    v_max3_f32 v97, v97, v63, v64
    v_max3_f32 v96, v96, v57, v58
    v_mfma_f32_16x16x32_bf16 v[160:163], a[212:215], v[22:25], v[160:163]
    ds_read_b64_tr_b16 a[230:231], v2 offset:13312
    v_max3_f32 v97, v97, v65, v66
    v_max3_f32 v99, v99, v81, v82
    v_max3_f32 v98, v98, v71, v72
    v_mfma_f32_16x16x32_bf16 v[208:211], a[212:215], v[28:31], v[208:211]
    v_mov_b32 v38, v6
    v_max3_f32 v98, v98, v73, v74
    v_mfma_f32_16x16x32_bf16 a[0:3], a[212:215], v[34:37], a[0:3]
    s_waitcnt lgkmcnt(6)
    v_max_f32 v96, v96, v59
    v_max_f32 v98, v98, v75
    v_max_f32 v99, v99, v83
    v_mfma_f32_16x16x32_bf16 a[4:7], a[216:219], v[34:37], a[4:7]
    ds_read_b64_tr_b16 a[232:233], v3 offset:19456
    v_max_f32 v97, v97, v67
    v_mfma_f32_16x16x32_bf16 v[212:215], a[216:219], v[28:31], v[212:215]
    s_add_u32 s18, s34, 24576
    ds_read_b64_tr_b16 a[214:215], v4 offset:13312
    v_permlane32_swap_b32 v98, v99
    v_mfma_f32_16x16x32_bf16 v[164:167], a[216:219], v[22:25], v[164:167]
    v_permlane32_swap_b32 v96, v97
    v_mfma_f32_16x16x32_bf16 v[116:119], a[216:219], v[16:19], v[116:119]
    s_waitcnt lgkmcnt(4)
    ds_read_b64_tr_b16 a[228:229], v2 offset:19456
    v_max_f32 v98, v98, v99
    v_max_f32 v96, v96, v97
    v_mfma_f32_16x16x32_bf16 v[120:123], a[220:223], v[16:19], v[120:123]
    s_nop 0
    v_permlane16_swap_b32 v96, v98
    v_max_f32 v96, v96, v98
    v_mfma_f32_16x16x32_bf16 v[168:171], a[220:223], v[22:25], v[168:171]
    s_mov_b32 s34, s33
    v_mul_f32_e64 v9, -s28, v96
    v_mov_b32 v11, v9
    v_mfma_f32_16x16x32_bf16 v[216:219], a[220:223], v[28:31], v[216:219]
    s_add_u32 s64, s64, s62
    ds_read_b64_tr_b16 a[216:217], v5 offset:19456
    v_permlane16_swap_b32 v9, v11
    v_mov_b32 v10, v9
    v_mfma_f32_16x16x32_bf16 a[8:11], a[220:223], v[34:37], a[8:11]
    s_add_u32 s64, s64, 196608
    ds_read_b64_tr_b16 a[212:213], v4 offset:19456
    v_mov_b32 v12, v11
    v_permlane32_swap_b32 v9, v10
    v_fma_f32 v62, v62, s28, v10
    v_mfma_f32_16x16x32_bf16 a[12:15], a[224:227], v[34:37], a[12:15]
    s_mov_b32 s39, s64
    v_fma_f32 v66, v66, s28, v10
    v_accvgpr_read_b32 v106, a2
    v_mfma_f32_16x16x32_bf16 v[220:223], a[224:227], v[28:31], v[220:223]
    s_add_u32 s37, s37, 1
    ds_read_b64_tr_b16 a[218:219], v5 offset:13312
    v_fma_f32 v54, v54, s28, v9
    v_mfma_f32_16x16x32_bf16 v[172:175], a[224:227], v[22:25], v[172:175]
    s_bitcmp1_b32 s63, s37
    ds_read_b64_tr_b16 a[222:223], v2 offset:14336
    v_exp_f32 v54, v54
    v_mfma_f32_16x16x32_bf16 v[124:127], a[224:227], v[16:19], v[124:127]
    s_waitcnt lgkmcnt(4)
    v_fma_f32 v56, v56, s28, v9
    v_accvgpr_read_b32 v111, a7
    s_cselect_b32 s62, 4294770688, 0
    v_mfma_f32_16x16x32_bf16 v[128:131], a[228:231], v[16:19], v[128:131]
    s_cselect_b32 s42, 0, 325632
    v_permlane32_swap_b32 v11, v12
    v_mfma_f32_16x16x32_bf16 v[176:179], a[228:231], v[22:25], v[176:179]
    s_add_u32 s35, s35, s42
    ds_read_b64_tr_b16 a[226:227], v3 offset:14336
    v_fma_f32 v69, v69, s28, v11
    v_mfma_f32_16x16x32_bf16 v[224:227], a[228:231], v[28:31], v[224:227]
    s_lshl_b32 s42, s37, 1
    ds_read_b64_tr_b16 a[220:221], v2 offset:20480
    s_lshr_b32 s42, s31, s42
    v_mfma_f32_16x16x32_bf16 a[16:19], a[228:231], v[34:37], a[16:19]
    s_and_b32 s42, s42, 3
    ds_read_b64_tr_b16 a[224:225], v3 offset:20480
    v_exp_f32 v69, v69
    v_mfma_f32_16x16x32_bf16 a[20:23], a[232:235], v[34:37], a[20:23]
    s_add_u32 s42, s42, s36
    v_fma_f32 v81, v81, s28, v12
    v_fma_f32 v65, v65, s28, v10
    v_mfma_f32_16x16x32_bf16 v[228:231], a[232:235], v[28:31], v[228:231]
    s_sub_u32 s43, s42, 3
    ds_read_b64_tr_b16 a[230:231], v4 offset:14336
    v_fma_f32 v60, v60, s28, v10
    v_mfma_f32_16x16x32_bf16 v[180:183], a[232:235], v[22:25], v[180:183]
    s_cmp_ge_u32 s42, 3
    v_fma_f32 v58, v58, s28, v9
    v_fma_f32 v72, v72, s28, v11
    v_mfma_f32_16x16x32_bf16 v[132:135], a[232:235], v[16:19], v[132:135]
    s_waitcnt lgkmcnt(4)
    ds_read_b64_tr_b16 a[234:235], v5 offset:14336
    v_fma_f32 v79, v79, s28, v12
    v_mfma_f32_16x16x32_bf16 v[136:139], a[212:215], v[16:19], v[136:139]
    s_cselect_b32 s42, s43, s42
    v_fma_f32 v67, v67, s28, v10
    v_fma_f32 v78, v78, s28, v12
    v_fma_f32 v83, v83, s28, v12
    v_mfma_f32_16x16x32_bf16 v[184:187], a[212:215], v[22:25], v[184:187]
    s_mul_i32 s44, s3, 5
    ds_read_b64_tr_b16 a[228:229], v4 offset:20480
    v_fma_f32 v70, v70, s28, v11
    v_fma_f32 v52, v52, s28, v9
    v_mfma_f32_16x16x32_bf16 v[232:235], a[212:215], v[28:31], v[232:235]
    s_mov_b32 s32, 1
    v_fma_f32 v73, v73, s28, v11
    v_fma_f32 v53, v53, s28, v9
    v_mfma_f32_16x16x32_bf16 a[24:27], a[212:215], v[34:37], a[24:27]
    s_lshl_b32 s43, s3, 2
    v_exp_f32 v70, v70
    v_mfma_f32_16x16x32_bf16 a[28:31], a[216:219], v[34:37], a[28:31]
    s_add_u32 s45, s43, 21
    v_fma_f32 v71, v71, s28, v11
    v_fma_f32 v77, v77, s28, v12
    v_mfma_f32_16x16x32_bf16 v[236:239], a[216:219], v[28:31], v[236:239]
    s_cmp_eq_u32 s3, 0
    s_cselect_b32 s45, 20, s45
    v_fma_f32 v55, v55, s28, v9
    v_mfma_f32_16x16x32_bf16 v[188:191], a[216:219], v[22:25], v[188:191]
    s_cselect_b32 s33, 1, 0
    ds_read_b64_tr_b16 a[232:233], v5 offset:20480
    v_fma_f32 v68, v68, s28, v11
    v_exp_f32 v60, v60
    s_cmp_eq_u32 s42, 1
    v_mfma_f32_16x16x32_bf16 v[140:143], a[216:219], v[16:19], v[140:143]
    s_cselect_b32 s44, s45, s44
    v_exp_f32 v55, v55
    s_waitcnt lgkmcnt(2)
    v_mfma_f32_16x16x32_bf16 v[144:147], a[220:223], v[16:19], v[144:147]
    s_cselect_b32 s32, s33, s32
    v_exp_f32 v52, v52
    v_mfma_f32_16x16x32_bf16 v[192:195], a[220:223], v[22:25], v[192:195]
    s_add_u32 s45, s43, 37
    v_exp_f32 v79, v79
    v_mfma_f32_16x16x32_bf16 v[240:243], a[220:223], v[28:31], v[240:243]
    s_cmp_eq_u32 s42, 2
    v_exp_f32 v53, v53
    v_mfma_f32_16x16x32_bf16 a[32:35], a[220:223], v[34:37], a[32:35]
    s_cselect_b32 s44, s45, s44
    v_fma_f32 v76, v76, s28, v12
    s_cselect_b32 s32, 0, s32
    s_mul_i32 s44, s44, 6144
    v_mfma_f32_16x16x32_bf16 a[36:39], a[224:227], v[34:37], a[36:39]
    s_add_u32 s33, s35, s44
    s_mul_i32 s42, s32, 6144
    v_cvt_pk_bf16_f32 v15, v54, v55
    v_exp_f32 v78, v78
    s_add_u32 s42, s42, 24576
    v_pk_mul_f32 v[212:213], v[212:213], v[50:51] op_sel_hi:[1,0]
    s_add_u32 s42, s42, s33
    s_cmp_ge_u32 s37, 6
    v_mfma_f32_16x16x32_bf16 v[244:247], a[224:227], v[28:31], v[244:247]
    s_cselect_b32 s14, 0, s42
    s_add_u32 s24, s67, 6144
    s_add_u32 s25, s33, 6144
    v_fma_f32 v61, v61, s28, v10
    v_mfma_f32_16x16x32_bf16 v[196:199], a[224:227], v[22:25], v[196:199]
    s_add_u32 s23, s38, 6144
    v_exp_f32 v61, v61
    s_mov_b32 s27, 0x30c30
    v_mfma_f32_16x16x32_bf16 v[148:151], a[224:227], v[16:19], v[148:151]
    s_mov_b32 s89, 0xaaaaaaaa
    s_mov_b32 s30, 0
    s_waitcnt vmcnt(8) lgkmcnt(0)
    v_mfma_f32_16x16x32_bf16 v[152:155], a[228:231], v[16:19], v[152:155]
    s_barrier
    ds_read_b128 a[212:215], v0 offset:12288
    v_cvt_pk_bf16_f32 v20, v60, v61
    v_mfma_f32_16x16x32_bf16 v[200:203], a[228:231], v[22:25], v[200:203]
    ds_read_b128 a[216:219], v1 offset:12288
    v_fma_f32 v80, v80, s28, v12
    v_mfma_f32_16x16x32_bf16 v[248:251], a[228:231], v[28:31], v[248:251]
    ds_read_b128 a[220:223], v0 offset:13312
    v_accvgpr_read_b32 v109, a5
    v_exp_f32 v71, v71
    v_fma_f32 v64, v64, s28, v10
    v_mfma_f32_16x16x32_bf16 a[40:43], a[228:231], v[34:37], a[40:43]
    ds_read_b128 a[224:227], v1 offset:13312
    v_accvgpr_read_b32 v107, a3
    v_fma_f32 v57, v57, s28, v9
    v_fma_f32 v59, v59, s28, v9
    v_exp_f32 v68, v68
    v_fma_f32 v82, v82, s28, v12
    v_cvt_pk_bf16_f32 v14, v52, v53
    v_cvt_pk_bf16_f32 v26, v68, v69
    v_mfma_f32_16x16x32_bf16 a[44:47], a[232:235], v[34:37], a[44:47]
    v_exp_f32 v77, v77
    v_fma_f32 v63, v63, s28, v10
    v_mfma_f32_16x16x32_bf16 v[252:255], a[232:235], v[28:31], v[252:255]
    v_exp_f32 v67, v67
    v_mfma_f32_16x16x32_bf16 v[204:207], a[232:235], v[22:25], v[204:207]
    ds_read_b128 a[228:231], v0 offset:14336
    v_exp_f32 v76, v76
    v_mfma_f32_16x16x32_bf16 v[156:159], a[232:235], v[16:19], v[156:159]
    s_waitcnt lgkmcnt(4)
    v_exp_f32 v62, v62
    v_fma_f32 v75, v75, s28, v11
    v_exp_f32 v63, v63
    v_mfma_f32_16x16x32_bf16 v[52:55], a[212:215], a[96:99], 0
    s_waitcnt lgkmcnt(2)
    v_cvt_pk_bf16_f32 v21, v62, v63
    v_exp_f32 v82, v82
    v_cvt_pk_bf16_f32 v32, v76, v77
    v_mfma_f32_16x16x32_bf16 v[52:55], a[216:219], a[100:103], v[52:55]
    v_cvt_pk_bf16_f32 v33, v78, v79
    v_cvt_pk_bf16_f32 v27, v70, v71
    v_mfma_f32_16x16x32_bf16 v[52:55], a[220:223], a[104:107], v[52:55]
    ds_read_b128 a[232:235], v1 offset:14336
    v_subrev_u32 v103, 24576, v103
    v_mfma_f32_16x16x32_bf16 v[60:63], a[220:223], a[128:131], 0
    v_exp_f32 v81, v81
    v_mfma_f32_16x16x32_bf16 v[60:63], a[216:219], a[124:127], v[60:63]
    s_add_u32 m0, s22, 36864
    v_exp_f32 v56, v56
    v_mfma_f32_16x16x32_bf16 v[60:63], a[212:215], a[120:123], v[60:63]
    v_fma_f32 v74, v74, s28, v11
    v_cvt_pk_bf16_f32 v212, v212, v213
    v_mfma_f32_16x16x32_bf16 v[68:71], a[212:215], a[144:147], 0
    v_exp_f32 v74, v74
    v_mfma_f32_16x16x32_bf16 v[68:71], a[216:219], a[148:151], v[68:71]
    v_exp_f32 v65, v65
    v_mfma_f32_16x16x32_bf16 v[68:71], a[220:223], a[152:155], v[68:71]
    v_exp_f32 v73, v73
    v_exp_f32 v83, v83
    v_mfma_f32_16x16x32_bf16 v[76:79], a[220:223], a[176:179], 0
    buffer_load_dwordx4 v6, s[8:11], s21 offen lds
    v_mfma_f32_16x16x32_bf16 v[76:79], a[216:219], a[172:175], v[76:79]
    v_exp_f32 v57, v57
    v_mfma_f32_16x16x32_bf16 v[76:79], a[212:215], a[168:171], v[76:79]
    s_waitcnt lgkmcnt(1)
    v_exp_f32 v72, v72
    v_mfma_f32_16x16x32_bf16 v[76:79], a[224:227], a[180:183], v[76:79]
    v_cvt_pk_bf16_f32 v16, v56, v57
    v_accvgpr_read_b32 v104, a0
    v_mfma_f32_16x16x32_bf16 v[76:79], a[228:231], a[184:187], v[76:79]
    s_waitcnt lgkmcnt(0)
    v_exp_f32 v75, v75
    v_mfma_f32_16x16x32_bf16 v[76:79], a[232:235], a[188:191], v[76:79]
    v_exp_f32 v66, v66
    v_mfma_f32_16x16x32_bf16 v[68:71], a[232:235], a[164:167], v[68:71]
    v_accvgpr_read_b32 v105, a1
    v_cvt_pk_bf16_f32 v23, v66, v67
    v_mfma_f32_16x16x32_bf16 v[68:71], a[228:231], a[160:163], v[68:71]
    v_exp_f32 v59, v59
    v_mfma_f32_16x16x32_bf16 v[68:71], a[224:227], a[156:159], v[68:71]
    ds_read_b128 a[216:219], v1 offset:18432
    v_exp_f32 v80, v80
    v_mfma_f32_16x16x32_bf16 v[60:63], a[224:227], a[132:135], v[60:63]
    s_add_u32 s21, s21, 128
    v_fma_f32 v78, v78, s28, v12
    v_fma_f32 v77, v77, s28, v12
    v_mfma_f32_16x16x32_bf16 v[60:63], a[228:231], a[136:139], v[60:63]
    ds_read_b128 a[212:215], v0 offset:18432
    v_cvt_pk_bf16_f32 v34, v80, v81
    v_mfma_f32_16x16x32_bf16 v[60:63], a[232:235], a[140:143], v[60:63]
    v_exp_f32 v58, v58
    v_mfma_f32_16x16x32_bf16 v[52:55], a[232:235], a[116:119], v[52:55]
    v_cvt_pk_bf16_f32 v17, v58, v59
    v_accvgpr_read_b32 v110, a6
    v_mfma_f32_16x16x32_bf16 v[52:55], a[228:231], a[112:115], v[52:55]
    v_accvgpr_read_b32 v108, a4
    v_exp_f32 v64, v64
    v_mfma_f32_16x16x32_bf16 v[52:55], a[224:227], a[108:111], v[52:55]
    s_add_u32 m0, s22, 37888
    ds_read_b128 a[224:227], v1 offset:19456
    v_fma_f32 v70, v70, s28, v11
    v_mfma_f32_16x16x32_bf16 v[44:47], a[236:239], v[14:17], 0
    ds_read_b128 a[220:223], v0 offset:19456
    v_exp_f32 v77, v77
    v_exp_f32 v70, v70
    v_pk_mul_f32 v[226:227], v[226:227], v[50:51] op_sel_hi:[1,0]
    v_pk_mul_f32 v[114:115], v[114:115], v[48:49] op_sel_hi:[1,0]
    v_pk_mul_f32 v[216:217], v[216:217], v[50:51] op_sel_hi:[1,0]
    v_pk_mul_f32 v[124:125], v[124:125], v[48:49] op_sel_hi:[1,0]
    v_pk_mul_f32 v[128:129], v[128:129], v[48:49] op_sel_hi:[1,0]
    v_pk_mul_f32 v[122:123], v[122:123], v[48:49] op_sel_hi:[1,0]
    v_pk_mul_f32 v[220:221], v[220:221], v[50:51] op_sel_hi:[1,0]
    v_pk_mul_f32 v[166:167], v[166:167], v[102:103] op_sel_hi:[1,0]
    v_pk_mul_f32 v[160:161], v[160:161], v[102:103] op_sel_hi:[1,0]
    v_cvt_pk_bf16_f32 v216, v216, v217
    v_pk_mul_f32 v[120:121], v[120:121], v[48:49] op_sel_hi:[1,0]
    v_pk_mul_f32 v[112:113], v[112:113], v[48:49] op_sel_hi:[1,0]
    v_pk_mul_f32 v[168:169], v[168:169], v[102:103] op_sel_hi:[1,0]
    v_pk_mul_f32 v[150:151], v[150:151], v[48:49] op_sel_hi:[1,0]
    v_pk_mul_f32 v[108:109], v[108:109], v[8:9] op_sel_hi:[1,0]
    v_pk_mul_f32 v[232:233], v[232:233], v[50:51] op_sel_hi:[1,0]
    v_cvt_pk_bf16_f32 v29, v74, v75
    v_cvt_pk_bf16_f32 v28, v72, v73
    v_pk_mul_f32 v[224:225], v[224:225], v[50:51] op_sel_hi:[1,0]
    v_pk_mul_f32 v[236:237], v[236:237], v[50:51] op_sel_hi:[1,0]
    v_pk_mul_f32 v[208:209], v[208:209], v[50:51] op_sel_hi:[1,0]
    v_pk_mul_f32 v[176:177], v[176:177], v[102:103] op_sel_hi:[1,0]
    v_pk_mul_f32 v[118:119], v[118:119], v[48:49] op_sel_hi:[1,0]
    v_pk_mul_f32 v[162:163], v[162:163], v[102:103] op_sel_hi:[1,0]
    v_pk_mul_f32 v[192:193], v[192:193], v[102:103] op_sel_hi:[1,0]
    v_pk_mul_f32 v[186:187], v[186:187], v[102:103] op_sel_hi:[1,0]
    v_pk_mul_f32 v[172:173], v[172:173], v[102:103] op_sel_hi:[1,0]
    v_fma_f32 v62, v62, s28, v10
    v_cvt_pk_bf16_f32 v208, v208, v209
    v_pk_mul_f32 v[110:111], v[110:111], v[8:9] op_sel_hi:[1,0]
    v_pk_mul_f32 v[210:211], v[210:211], v[50:51] op_sel_hi:[1,0]
    v_pk_mul_f32 v[164:165], v[164:165], v[102:103] op_sel_hi:[1,0]
    v_pk_mul_f32 v[106:107], v[106:107], v[8:9] op_sel_hi:[1,0]
    v_fma_f32 v76, v76, s28, v12
    v_pk_mul_f32 v[104:105], v[104:105], v[8:9] op_sel_hi:[1,0]
    v_pk_mul_f32 v[116:117], v[116:117], v[48:49] op_sel_hi:[1,0]
    v_pk_mul_f32 v[144:145], v[144:145], v[48:49] op_sel_hi:[1,0]
    v_pk_mul_f32 v[222:223], v[222:223], v[50:51] op_sel_hi:[1,0]
    v_fma_f32 v60, v60, s28, v10
    v_cvt_pk_bf16_f32 v120, v120, v121
    s_waitcnt lgkmcnt(0)
    v_mfma_f32_16x16x32_bf16 v[56:59], a[212:215], a[96:99], 0
    buffer_load_dwordx4 v6, s[8:11], s21 offen lds
    v_fma_f32 v63, v63, s28, v10
    v_fma_f32 v79, v79, s28, v12
    v_cvt_pk_bf16_f32 v22, v64, v65
    v_cvt_pk_bf16_f32 v116, v116, v117
    v_mfma_f32_16x16x32_bf16 v[56:59], a[216:219], a[100:103], v[56:59]
    v_cvt_pk_bf16_f32 v160, v160, v161
    v_fma_f32 v68, v68, s28, v11
    v_mfma_f32_16x16x32_bf16 v[56:59], a[220:223], a[104:107], v[56:59]
    s_add_u32 s21, s21, 128
    ds_read_b128 a[228:231], v0 offset:20480
    v_cvt_pk_bf16_f32 v35, v82, v83
    v_mfma_f32_16x16x32_bf16 v[64:67], a[220:223], a[128:131], 0
    ds_read_b128 a[232:235], v1 offset:20480
    v_cvt_pk_bf16_f32 v112, v112, v113
    v_fma_f32 v52, v52, s28, v9
    v_mfma_f32_16x16x32_bf16 v[64:67], a[216:219], a[124:127], v[64:67]
    v_cvt_pk_bf16_f32 v108, v108, v109
    v_cvt_pk_bf16_f32 v224, v224, v225
    v_fma_f32 v54, v54, s28, v9
    v_mfma_f32_16x16x32_bf16 v[64:67], a[212:215], a[120:123], v[64:67]
    v_cvt_pk_bf16_f32 v164, v164, v165
    v_cvt_pk_bf16_f32 v176, v176, v177
    v_mfma_f32_16x16x32_bf16 v[72:75], a[212:215], a[144:147], 0
    v_cvt_pk_bf16_f32 v104, v104, v105
    v_cvt_pk_bf16_f32 v113, v114, v115
    v_mfma_f32_16x16x32_bf16 v[72:75], a[216:219], a[148:151], v[72:75]
    v_cvt_pk_bf16_f32 v105, v106, v107
    v_cvt_pk_bf16_f32 v225, v226, v227
    v_mfma_f32_16x16x32_bf16 v[72:75], a[220:223], a[152:155], v[72:75]
    s_add_u32 m0, s22, 38912
    v_exp_f32 v68, v68
    v_mfma_f32_16x16x32_bf16 v[80:83], a[220:223], a[176:179], 0
    buffer_load_dwordx4 v6, s[8:11], s21 offen lds
    v_mfma_f32_16x16x32_bf16 v[80:83], a[216:219], a[172:175], v[80:83]
    s_add_u32 s21, s21, 12032
    v_cvt_pk_bf16_f32 v161, v162, v163
    v_cvt_pk_bf16_f32 v168, v168, v169
    v_mfma_f32_16x16x32_bf16 v[80:83], a[212:215], a[168:171], v[80:83]
    v_exp_f32 v60, v60
    v_fma_f32 v69, v69, s28, v11
    v_mfma_f32_16x16x32_bf16 v[80:83], a[224:227], a[180:183], v[80:83]
    s_waitcnt vmcnt(6) lgkmcnt(0)
    v_cvt_pk_bf16_f32 v121, v122, v123
    v_cvt_pk_bf16_f32 v220, v220, v221
    v_mfma_f32_16x16x32_bf16 v[80:83], a[228:231], a[184:187], v[80:83]
    s_barrier
    v_cvt_pk_bf16_f32 v209, v210, v211
    v_mfma_f32_16x16x32_bf16 v[80:83], a[232:235], a[188:191], v[80:83]
    ds_read_b64_tr_b16 a[212:213], v2 offset:0
    v_cvt_pk_bf16_f32 v109, v110, v111
    v_exp_f32 v62, v62
    v_mfma_f32_16x16x32_bf16 v[72:75], a[232:235], a[164:167], v[72:75]
    ds_write2st64_b64 v101, v[112:113], v[160:161] offset0:0 offset1:12
    v_pk_mul_f32 v[244:245], v[244:245], v[50:51] op_sel_hi:[1,0]
    v_fma_f32 v61, v61, s28, v10
    v_cvt_pk_bf16_f32 v117, v118, v119
    v_accvgpr_read_b32 v107, a11
    v_mfma_f32_16x16x32_bf16 v[72:75], a[228:231], a[160:163], v[72:75]
    ds_read_b64_tr_b16 a[214:215], v2 offset:6144
    v_accvgpr_read_b32 v106, a10
    v_mfma_f32_16x16x32_bf16 v[72:75], a[224:227], a[156:159], v[72:75]
    ds_write2st64_b64 v101, v[208:209], v[104:105] offset0:24 offset1:36
    v_pk_mul_f32 v[174:175], v[174:175], v[102:103] op_sel_hi:[1,0]
    v_accvgpr_read_b32 v105, a9
    v_pk_mul_f32 v[126:127], v[126:127], v[48:49] op_sel_hi:[1,0]
    v_pk_mul_f32 v[228:229], v[228:229], v[50:51] op_sel_hi:[1,0]
    v_pk_mul_f32 v[132:133], v[132:133], v[48:49] op_sel_hi:[1,0]
    v_pk_mul_f32 v[180:181], v[180:181], v[102:103] op_sel_hi:[1,0]
    v_pk_mul_f32 v[184:185], v[184:185], v[102:103] op_sel_hi:[1,0]
    v_pk_mul_f32 v[214:215], v[214:215], v[50:51] op_sel_hi:[1,0]
    v_accvgpr_read_b32 v104, a8
    v_cvt_pk_bf16_f32 v213, v214, v215
    v_cvt_pk_bf16_f32 v124, v124, v125
    v_pk_mul_f32 v[148:149], v[148:149], v[48:49] op_sel_hi:[1,0]
    v_pk_mul_f32 v[196:197], v[196:197], v[102:103] op_sel_hi:[1,0]
    v_pk_mul_f32 v[234:235], v[234:235], v[50:51] op_sel_hi:[1,0]
    v_accvgpr_read_b32 v111, a15
    v_cvt_pk_bf16_f32 v132, v132, v133
    v_pk_mul_f32 v[242:243], v[242:243], v[50:51] op_sel_hi:[1,0]
    v_cvt_pk_bf16_f32 v165, v166, v167
    v_pk_mul_f32 v[152:153], v[152:153], v[48:49] op_sel_hi:[1,0]
    v_pk_mul_f32 v[248:249], v[248:249], v[50:51] op_sel_hi:[1,0]
    v_pk_mul_f32 v[156:157], v[156:157], v[48:49] op_sel_hi:[1,0]
    v_exp_f32 v69, v69
    v_pk_mul_f32 v[252:253], v[252:253], v[50:51] op_sel_hi:[1,0]
    v_pk_mul_f32 v[130:131], v[130:131], v[48:49] op_sel_hi:[1,0]
    v_exp_f32 v61, v61
    v_cvt_pk_bf16_f32 v244, v244, v245
    v_fma_f32 v73, v73, s28, v11
    v_pk_mul_f32 v[138:139], v[138:139], v[48:49] op_sel_hi:[1,0]
    v_pk_mul_f32 v[170:171], v[170:171], v[102:103] op_sel_hi:[1,0]
    v_pk_mul_f32 v[218:219], v[218:219], v[50:51] op_sel_hi:[1,0]
    v_pk_mul_f32 v[246:247], v[246:247], v[50:51] op_sel_hi:[1,0]
    v_pk_mul_f32 v[188:189], v[188:189], v[102:103] op_sel_hi:[1,0]
    v_pk_mul_f32 v[200:201], v[200:201], v[102:103] op_sel_hi:[1,0]
    v_pk_mul_f32 v[106:107], v[106:107], v[8:9] op_sel_hi:[1,0]
    v_pk_mul_f32 v[104:105], v[104:105], v[8:9] op_sel_hi:[1,0]
    v_cvt_pk_bf16_f32 v128, v128, v129
    v_xor_b32 v101, 32, v101
    v_pk_mul_f32 v[146:147], v[146:147], v[48:49] op_sel_hi:[1,0]
    v_pk_mul_f32 v[230:231], v[230:231], v[50:51] op_sel_hi:[1,0]
    v_pk_mul_f32 v[198:199], v[198:199], v[102:103] op_sel_hi:[1,0]
    v_pk_mul_f32 v[142:143], v[142:143], v[48:49] op_sel_hi:[1,0]
    v_cvt_pk_bf16_f32 v156, v156, v157
    v_pk_mul_f32 v[190:191], v[190:191], v[102:103] op_sel_hi:[1,0]
    v_exp_f32 v52, v52
    v_exp_f32 v54, v54
    v_mfma_f32_16x16x32_bf16 v[64:67], a[224:227], a[132:135], v[64:67]
    s_add_u32 m0, s22, 12288
    ds_read_b64_tr_b16 a[216:217], v3 offset:0
    buffer_load_dwordx4 v6, s[4:7], s20 offen lds
    v_mfma_f32_16x16x32_bf16 v[64:67], a[228:231], a[136:139], v[64:67]
    ds_read_b64_tr_b16 a[218:219], v3 offset:6144
    v_cvt_pk_bf16_f32 v192, v192, v193
    v_mfma_f32_16x16x32_bf16 v[64:67], a[232:235], a[140:143], v[64:67]
    ds_read_b64_tr_b16 a[220:221], v4 offset:0
    v_cvt_pk_bf16_f32 v236, v236, v237
    v_exp_f32 v79, v79
    v_mfma_f32_16x16x32_bf16 v[56:59], a[232:235], a[116:119], v[56:59]
    ds_write2st64_b64 v101, v[116:117], v[164:165] offset0:0 offset1:12
    v_mfma_f32_16x16x32_bf16 v[44:47], a[240:243], v[20:23], v[44:47]
    ds_read_b64_tr_b16 a[222:223], v4 offset:6144
    v_cvt_pk_bf16_f32 v184, v184, v185
    v_mfma_f32_16x16x32_bf16 v[56:59], a[228:231], a[112:115], v[56:59]
    s_add_u32 s20, s20, 128
    ds_read_b64_tr_b16 a[230:231], v2 offset:7168
    v_fma_f32 v71, v71, s28, v11
    v_cvt_pk_bf16_f32 v221, v222, v223
    v_mfma_f32_16x16x32_bf16 v[56:59], a[224:227], a[108:111], v[56:59]
    ds_read_b64_tr_b16 a[224:225], v5 offset:0
    v_cvt_pk_bf16_f32 v104, v104, v105
    v_mfma_f32_16x16x32_bf16 v[44:47], a[244:247], v[26:29], v[44:47]
    s_waitcnt lgkmcnt(7)
    ds_read_b64_tr_b16 a[226:227], v5 offset:6144
    v_cvt_pk_bf16_f32 v172, v172, v173
    v_mfma_f32_16x16x32_bf16 v[112:115], a[212:215], v[14:17], 0
    ds_write2st64_b64 v101, v[212:213], v[108:109] offset0:24 offset1:36
    v_fma_f32 v56, v56, s28, v9
    v_mfma_f32_16x16x32_bf16 v[160:163], a[212:215], v[20:23], 0
    ds_read_b64_tr_b16 a[234:235], v3 offset:7168
    v_cvt_pk_bf16_f32 v129, v130, v131
    v_cvt_pk_bf16_f32 v200, v200, v201
    v_cvt_pk_bf16_f32 v217, v218, v219
    v_mfma_f32_16x16x32_bf16 v[208:211], a[212:215], v[26:29], 0
    v_cvt_pk_bf16_f32 v125, v126, v127
    v_accvgpr_read_b32 v110, a14
    v_mfma_f32_16x16x32_bf16 a[0:3], a[212:215], v[32:35], 0
    ds_read_b64_tr_b16 a[228:229], v2 offset:1024
    v_xor_b32 v101, 96, v101
    v_cvt_pk_bf16_f32 v188, v188, v189
    v_fma_f32 v55, v55, s28, v9
    v_accvgpr_read_b32 v109, a13
    v_pk_mul_f32 v[238:239], v[238:239], v[50:51] op_sel_hi:[1,0]
    v_pk_mul_f32 v[136:137], v[136:137], v[48:49] op_sel_hi:[1,0]
    v_pk_mul_f32 v[178:179], v[178:179], v[102:103] op_sel_hi:[1,0]
    v_pk_mul_f32 v[110:111], v[110:111], v[8:9] op_sel_hi:[1,0]
    v_cvt_pk_bf16_f32 v105, v106, v107
    v_pk_mul_f32 v[194:195], v[194:195], v[102:103] op_sel_hi:[1,0]
    v_pk_mul_f32 v[240:241], v[240:241], v[50:51] op_sel_hi:[1,0]
    v_cvt_pk_bf16_f32 v232, v232, v233
    v_accvgpr_read_b32 v107, a19
    v_cvt_pk_bf16_f32 v185, v186, v187
    v_pk_mul_f32 v[158:159], v[158:159], v[48:49] op_sel_hi:[1,0]
    v_fma_f32 v80, v80, s28, v12
    v_cvt_pk_bf16_f32 v169, v170, v171
    v_mfma_f32_16x16x32_bf16 v[44:47], a[248:251], v[32:35], v[44:47]
    s_waitcnt lgkmcnt(3)
    ds_write2st64_b64 v101, v[120:121], v[168:169] offset0:0 offset1:12
    v_accvgpr_read_b32 v108, a12
    v_mfma_f32_16x16x32_bf16 a[4:7], a[216:219], v[32:35], 0
    ds_write2st64_b64 v101, v[216:217], v[104:105] offset0:24 offset1:36
    v_pk_mul_f32 v[108:109], v[108:109], v[8:9] op_sel_hi:[1,0]
    v_fma_f32 v53, v53, s28, v9
    v_pk_mul_f32 v[206:207], v[206:207], v[102:103] op_sel_hi:[1,0]
    v_pk_mul_f32 v[154:155], v[154:155], v[48:49] op_sel_hi:[1,0]
    v_pk_mul_f32 v[250:251], v[250:251], v[50:51] op_sel_hi:[1,0]
    v_pk_mul_f32 v[202:203], v[202:203], v[102:103] op_sel_hi:[1,0]
    v_cvt_pk_bf16_f32 v108, v108, v109
    v_fma_f32 v75, v75, s28, v11
    v_xor_b32 v101, 32, v101
    v_accvgpr_read_b32 v106, a18
    v_accvgpr_read_b32 v104, a16
    v_mfma_f32_16x16x32_bf16 v[212:215], a[216:219], v[26:29], 0
    ds_read_b64_tr_b16 a[214:215], v4 offset:7168
    v_cvt_pk_bf16_f32 v144, v144, v145
    v_cvt_pk_bf16_f32 v109, v110, v111
    v_cvt_pk_bf16_f32 v196, v196, v197
    v_cvt_pk_bf16_f32 v173, v174, v175
    v_exp_f32 v80, v80
    v_cvt_pk_bf16_f32 v152, v152, v153
    v_cvt_pk_bf16_f32 v252, v252, v253
    v_pk_mul_f32 v[182:183], v[182:183], v[102:103] op_sel_hi:[1,0]
    v_cvt_pk_bf16_f32 v228, v228, v229
    v_fma_f32 v67, v67, s28, v10
    v_mfma_f32_16x16x32_bf16 v[164:167], a[216:219], v[20:23], 0
    ds_write2st64_b64 v101, v[124:125], v[172:173] offset0:0 offset1:12
    v_cvt_pk_bf16_f32 v153, v154, v155
    v_exp_f32 v53, v53
    v_mfma_f32_16x16x32_bf16 v[116:119], a[216:219], v[14:17], 0
    v_cvt_pk_bf16_f32 v136, v136, v137
    v_cvt_pk_bf16_f32 v248, v248, v249
    v_mfma_f32_16x16x32_bf16 v[120:123], a[220:223], v[14:17], 0
    ds_write2st64_b64 v101, v[220:221], v[108:109] offset0:24 offset1:36
    v_fma_f32 v64, v64, s28, v10
    v_pk_mul_f32 v[106:107], v[106:107], v[8:9] op_sel_hi:[1,0]
    v_exp_f32 v76, v76
    v_cvt_pk_bf16_f32 v137, v138, v139
    v_accvgpr_read_b32 v109, a21
    v_fma_f32 v58, v58, s28, v9
    v_cvt_pk_bf16_f32 v177, v178, v179
    v_cvt_pk_bf16_f32 v180, v180, v181
    v_cvt_pk_bf16_f32 v237, v238, v239
    v_accvgpr_read_b32 v111, a23
    v_fma_f32 v82, v82, s28, v12
    v_mfma_f32_16x16x32_bf16 v[168:171], a[220:223], v[20:23], 0
    ds_read_b64_tr_b16 a[232:233], v3 offset:1024
    v_xor_b32 v101, 96, v101
    v_mfma_f32_16x16x32_bf16 v[216:219], a[220:223], v[26:29], 0
    s_add_u32 m0, s22, 13312
    ds_read_b128 v[96:99], v103 offset:1024
    buffer_load_dwordx4 v6, s[4:7], s20 offen lds
    v_accvgpr_read_b32 v105, a17
    v_accvgpr_read_b32 v110, a22
    v_accvgpr_read_b32 v108, a20
    v_cvt_pk_bf16_f32 v145, v146, v147
    v_pk_mul_f32 v[134:135], v[134:135], v[48:49] op_sel_hi:[1,0]
    v_exp_f32 v82, v82
    v_cvt_pk_bf16_f32 v229, v230, v231
    v_pk_mul_f32 v[104:105], v[104:105], v[8:9] op_sel_hi:[1,0]
    v_cvt_pk_bf16_f32 v189, v190, v191
    v_fma_f32 v59, v59, s28, v9
    v_cvt_pk_bf16_f32 v181, v182, v183
    v_pk_mul_f32 v[110:111], v[110:111], v[8:9] op_sel_hi:[1,0]
    v_pk_mul_f32 v[140:141], v[140:141], v[48:49] op_sel_hi:[1,0]
    v_fma_f32 v83, v83, s28, v12
    v_cvt_pk_bf16_f32 v104, v104, v105
    v_mfma_f32_16x16x32_bf16 a[8:11], a[220:223], v[32:35], 0
    ds_read_b64_tr_b16 a[222:223], v2 offset:8192
    v_cvt_pk_bf16_f32 v193, v194, v195
    v_exp_f32 v71, v71
    v_mfma_f32_16x16x32_bf16 a[12:15], a[224:227], v[32:35], 0
    s_add_u32 s20, s20, 128
    ds_write2st64_b64 v101, v[128:129], v[176:177] offset0:4 offset1:16
    v_pk_mul_f32 v[108:109], v[108:109], v[8:9] op_sel_hi:[1,0]
    v_exp_f32 v64, v64
    v_pk_mul_f32 v[204:205], v[204:205], v[102:103] op_sel_hi:[1,0]
    v_exp_f32 v63, v63
    v_cvt_pk_bf16_f32 v133, v134, v135
    v_cvt_pk_bf16_f32 v108, v108, v109
    v_cvt_pk_bf16_f32 v105, v106, v107
    v_mfma_f32_16x16x32_bf16 v[220:223], a[224:227], v[26:29], 0
    s_add_u32 m0, s22, 14336
    ds_read_b64_tr_b16 a[218:219], v5 offset:7168
    v_cvt_pk_bf16_f32 v109, v110, v111
    v_mfma_f32_16x16x32_bf16 v[172:175], a[224:227], v[20:23], 0
    ds_read_b64_tr_b16 a[212:213], v4 offset:1024
    v_fma_f32 v57, v57, s28, v9
    v_mfma_f32_16x16x32_bf16 v[124:127], a[224:227], v[14:17], 0
    s_waitcnt lgkmcnt(4)
    ds_write2st64_b64 v101, v[224:225], v[104:105] offset0:28 offset1:40
    v_accvgpr_read_b32 v104, a24
    v_cvt_pk_bf16_f32 v36, v76, v77
    v_mfma_f32_16x16x32_bf16 v[128:131], a[228:231], v[14:17], 0
    ds_read_b64_tr_b16 a[216:217], v5 offset:1024
    v_xor_b32 v101, 32, v101
    v_accvgpr_read_b32 v111, a31
    v_mfma_f32_16x16x32_bf16 v[176:179], a[228:231], v[20:23], 0
    ds_read_b128 v[88:91], v103 offset:0
    v_accvgpr_read_b32 v105, a25
    v_accvgpr_read_b32 v107, a27
    v_mfma_f32_16x16x32_bf16 v[224:227], a[228:231], v[26:29], 0
    buffer_load_dwordx4 v6, s[4:7], s20 offen lds
    ds_write2st64_b64 v101, v[132:133], v[180:181] offset0:4 offset1:16
    v_exp_f32 v55, v55
    v_cvt_pk_bf16_f32 v140, v140, v141
    v_accvgpr_read_b32 v110, a30
    v_accvgpr_read_b32 v106, a26
    v_mfma_f32_16x16x32_bf16 a[16:19], a[228:231], v[32:35], 0
    ds_write2st64_b64 v101, v[228:229], v[108:109] offset0:28 offset1:40
    v_pk_mul_f32 v[104:105], v[104:105], v[8:9] op_sel_hi:[1,0]
    v_cvt_pk_bf16_f32 v141, v142, v143
    v_pk_mul_f32 v[106:107], v[106:107], v[8:9] op_sel_hi:[1,0]
    v_pk_mul_f32 v[110:111], v[110:111], v[8:9] op_sel_hi:[1,0]
    v_cvt_pk_bf16_f32 v148, v148, v149
    v_cvt_pk_bf16_f32 v233, v234, v235
    v_fma_f32 v72, v72, s28, v11
    v_xor_b32 v101, 96, v101
    v_accvgpr_read_b32 v108, a28
    v_cvt_pk_bf16_f32 v245, v246, v247
    v_cvt_pk_bf16_f32 v104, v104, v105
    v_cvt_pk_bf16_f32 v105, v106, v107
    v_mfma_f32_16x16x32_bf16 a[20:23], a[232:235], v[32:35], 0
    s_add_u32 s20, s20, 12032
    ds_write2st64_b64 v101, v[136:137], v[184:185] offset0:4 offset1:16
    v_mfma_f32_16x16x32_bf16 v[228:231], a[232:235], v[26:29], 0
    s_add_u32 m0, s38, 0
    ds_write2st64_b64 v101, v[232:233], v[104:105] offset0:28 offset1:40
    v_mfma_f32_16x16x32_bf16 v[180:183], a[232:235], v[20:23], 0
    ds_read_b64_tr_b16 a[228:229], v4 offset:2048
    v_accvgpr_read_b32 v109, a29
    v_mfma_f32_16x16x32_bf16 v[132:135], a[232:235], v[14:17], 0
    s_waitcnt lgkmcnt(4)
    ds_read_b64_tr_b16 a[220:221], v2 offset:2048
    v_xor_b32 v101, 32, v101
    v_cvt_pk_bf16_f32 v240, v240, v241
    v_mfma_f32_16x16x32_bf16 v[136:139], a[212:215], v[14:17], 0
    ds_write2st64_b64 v101, v[140:141], v[188:189] offset0:4 offset1:16
    v_pk_mul_f32 v[108:109], v[108:109], v[8:9] op_sel_hi:[1,0]
    v_cvt_pk_bf16_f32 v157, v158, v159
    v_cvt_pk_bf16_f32 v108, v108, v109
    v_mfma_f32_16x16x32_bf16 v[184:187], a[212:215], v[20:23], 0
    ds_read_b64_tr_b16 a[230:231], v4 offset:8192
    ds_read_b64_tr_b16 a[232:233], v5 offset:2048
    v_cvt_pk_bf16_f32 v109, v110, v111
    v_mfma_f32_16x16x32_bf16 v[232:235], a[212:215], v[26:29], 0
    ds_read_b64_tr_b16 a[226:227], v3 offset:8192
    buffer_load_dwordx4 v6, s[12:15], s33 offen nt lds
    ds_read_b64_tr_b16 a[234:235], v5 offset:8192
    v_mfma_f32_16x16x32_bf16 a[24:27], a[212:215], v[32:35], 0
    ds_read_b64_tr_b16 a[224:225], v3 offset:2048
    v_cvt_pk_bf16_f32 v197, v198, v199
    v_accvgpr_read_b32 v110, a38
    v_accvgpr_read_b32 v104, a32
    v_accvgpr_read_b32 v106, a34
    v_mfma_f32_16x16x32_bf16 a[28:31], a[216:219], v[32:35], 0
    s_add_u32 m0, s38, 1024
    ds_write2st64_b64 v101, v[236:237], v[108:109] offset0:28 offset1:40
    v_accvgpr_read_b32 v109, a37
    v_accvgpr_read_b32 v111, a39
    v_cvt_pk_bf16_f32 v204, v204, v205
    v_accvgpr_read_b32 v108, a36
    v_cvt_pk_bf16_f32 v149, v150, v151
    v_pk_mul_f32 v[110:111], v[110:111], v[8:9] op_sel_hi:[1,0]
    v_accvgpr_read_b32 v105, a33
    v_pk_mul_f32 v[108:109], v[108:109], v[8:9] op_sel_hi:[1,0]
    v_cvt_pk_bf16_f32 v19, v54, v55
    v_pk_mul_f32 v[104:105], v[104:105], v[8:9] op_sel_hi:[1,0]
    v_xor_b32 v101, 96, v101
    v_cvt_pk_bf16_f32 v241, v242, v243
    v_cvt_pk_bf16_f32 v108, v108, v109
    v_accvgpr_read_b32 v107, a35
    v_cvt_pk_bf16_f32 v109, v110, v111
    v_pk_mul_f32 v[106:107], v[106:107], v[8:9] op_sel_hi:[1,0]
    v_cvt_pk_bf16_f32 v104, v104, v105
    v_cvt_pk_bf16_f32 v105, v106, v107
    v_mfma_f32_16x16x32_bf16 v[236:239], a[216:219], v[26:29], 0
    buffer_load_dwordx4 v7, s[12:15], s33 offen nt lds
    v_mfma_f32_16x16x32_bf16 v[188:191], a[216:219], v[20:23], 0
    s_add_u32 s39, s39, 12288
    ds_write2st64_b64 v101, v[144:145], v[192:193] offset0:8 offset1:20
    v_mfma_f32_16x16x32_bf16 v[140:143], a[216:219], v[14:17], 0
    s_waitcnt vmcnt(8) lgkmcnt(2)
    ds_write2st64_b64 v101, v[240:241], v[104:105] offset0:32 offset1:44
    v_xor_b32 v101, 32, v101
    v_mfma_f32_16x16x32_bf16 v[144:147], a[220:223], v[14:17], 0
    buffer_store_dwordx4 v[88:91], v6, s[16:19], s67 offen offset:0 nt
    s_barrier
    ds_write2st64_b64 v101, v[148:149], v[196:197] offset0:8 offset1:20
    v_accvgpr_read_b32 v106, a42
    v_accvgpr_read_b32 v107, a43
    v_accvgpr_read_b32 v105, a41
    v_accvgpr_read_b32 v111, a47
    v_cvt_pk_bf16_f32 v249, v250, v251
    v_cvt_pk_bf16_f32 v201, v202, v203
    v_mfma_f32_16x16x32_bf16 v[192:195], a[220:223], v[20:23], 0
    ds_write2st64_b64 v101, v[244:245], v[108:109] offset0:32 offset1:44
    v_accvgpr_read_b32 v104, a40
    v_accvgpr_read_b32 v108, a44
    v_accvgpr_read_b32 v109, a45
    v_pk_mul_f32 v[106:107], v[106:107], v[8:9] op_sel_hi:[1,0]
    v_accvgpr_read_b32 v110, a46
    v_cvt_pk_bf16_f32 v205, v206, v207
    v_pk_mul_f32 v[104:105], v[104:105], v[8:9] op_sel_hi:[1,0]
    v_pk_mul_f32 v[110:111], v[110:111], v[8:9] op_sel_hi:[1,0]
    v_pk_mul_f32 v[108:109], v[108:109], v[8:9] op_sel_hi:[1,0]
    v_cvt_pk_bf16_f32 v25, v62, v63
    v_pk_mul_f32 v[254:255], v[254:255], v[50:51] op_sel_hi:[1,0]
    v_cvt_pk_bf16_f32 v104, v104, v105
    v_cvt_pk_bf16_f32 v24, v60, v61
    v_fma_f32 v66, v66, s28, v10
    v_mfma_f32_16x16x32_bf16 v[240:243], a[220:223], v[26:29], 0
    v_cvt_pk_bf16_f32 v108, v108, v109
    v_xor_b32 v101, 96, v101
    v_mfma_f32_16x16x32_bf16 a[32:35], a[220:223], v[32:35], 0
    ds_read_b128 a[220:223], v0 offset:1024
    v_cvt_pk_bf16_f32 v105, v106, v107
    v_mfma_f32_16x16x32_bf16 a[36:39], a[224:227], v[32:35], 0
    ds_write2st64_b64 v101, v[152:153], v[200:201] offset0:8 offset1:20
    v_mfma_f32_16x16x32_bf16 v[244:247], a[224:227], v[26:29], 0
    v_cvt_pk_bf16_f32 v31, v70, v71
    v_cvt_pk_bf16_f32 v253, v254, v255
    v_mfma_f32_16x16x32_bf16 v[196:199], a[224:227], v[20:23], 0
    ds_write2st64_b64 v101, v[248:249], v[104:105] offset0:32 offset1:44
    v_mfma_f32_16x16x32_bf16 v[148:151], a[224:227], v[14:17], 0
    s_add_u32 m0, s22, 24576
    ds_read_b128 a[212:215], v0 offset:0
    v_cvt_pk_bf16_f32 v109, v110, v111
    v_mfma_f32_16x16x32_bf16 v[152:155], a[228:231], v[14:17], 0
    ds_read_b128 a[216:219], v1 offset:0
    v_xor_b32 v101, 32, v101
    v_mfma_f32_16x16x32_bf16 v[200:203], a[228:231], v[20:23], 0
    buffer_load_dwordx4 v6, s[8:11], s21 offen lds
    v_mfma_f32_16x16x32_bf16 v[248:251], a[228:231], v[26:29], 0
    buffer_store_dwordx4 v[96:99], v7, s[16:19], s67 offen offset:0 nt
    ds_write2st64_b64 v101, v[156:157], v[204:205] offset0:8 offset1:20
    v_cvt_pk_bf16_f32 v18, v52, v53
    v_mfma_f32_16x16x32_bf16 a[40:43], a[228:231], v[32:35], 0
    s_add_u32 s21, s21, 128
    ds_write2st64_b64 v101, v[252:253], v[108:109] offset0:32 offset1:44
    v_mfma_f32_16x16x32_bf16 a[44:47], a[232:235], v[32:35], 0
    v_exp_f32 v66, v66
    v_mfma_f32_16x16x32_bf16 v[252:255], a[232:235], v[26:29], 0
    s_add_u32 m0, s22, 25600
    v_exp_f32 v78, v78
    v_mfma_f32_16x16x32_bf16 v[204:207], a[232:235], v[20:23], 0
    ds_read_b128 a[228:231], v0 offset:2048
    buffer_load_dwordx4 v6, s[8:11], s21 offen lds
    v_mfma_f32_16x16x32_bf16 v[156:159], a[232:235], v[14:17], 0
    s_waitcnt lgkmcnt(3)
    v_exp_f32 v72, v72
    v_mfma_f32_16x16x32_bf16 v[52:55], a[212:215], a[96:99], 0
    ds_read_b128 a[224:227], v1 offset:1024
    v_cvt_pk_bf16_f32 v30, v68, v69
    v_mfma_f32_16x16x32_bf16 v[52:55], a[216:219], a[100:103], v[52:55]
    s_add_u32 s21, s21, 128
    ds_read_b128 v[84:87], v103 offset:2048
    v_fma_f32 v81, v81, s28, v12
    v_mfma_f32_16x16x32_bf16 v[52:55], a[220:223], a[104:107], v[52:55]
    ds_read_b128 a[232:235], v1 offset:2048
    v_cvt_pk_bf16_f32 v37, v78, v79
    v_mfma_f32_16x16x32_bf16 v[60:63], a[220:223], a[128:131], 0
    v_exp_f32 v58, v58
    v_mfma_f32_16x16x32_bf16 v[60:63], a[216:219], a[124:127], v[60:63]
    v_exp_f32 v59, v59
    v_mfma_f32_16x16x32_bf16 v[60:63], a[212:215], a[120:123], v[60:63]
    v_exp_f32 v73, v73
    v_mfma_f32_16x16x32_bf16 v[68:71], a[212:215], a[144:147], 0
    s_add_u32 m0, s22, 26624
    v_exp_f32 v67, v67
    v_mfma_f32_16x16x32_bf16 v[68:71], a[216:219], a[148:151], v[68:71]
    buffer_load_dwordx4 v6, s[8:11], s21 offen lds
    v_mfma_f32_16x16x32_bf16 v[68:71], a[220:223], a[152:155], v[68:71]
    v_fma_f32 v74, v74, s28, v11
    v_cvt_pk_bf16_f32 v17, v58, v59
    v_mfma_f32_16x16x32_bf16 v[76:79], a[220:223], a[176:179], 0
    v_exp_f32 v56, v56
    v_mfma_f32_16x16x32_bf16 v[76:79], a[216:219], a[172:175], v[76:79]
    s_add_u32 s21, s21, 12032
    v_exp_f32 v81, v81
    v_mfma_f32_16x16x32_bf16 v[76:79], a[212:215], a[168:171], v[76:79]
    s_waitcnt lgkmcnt(1)
    v_exp_f32 v57, v57
    v_mfma_f32_16x16x32_bf16 v[76:79], a[224:227], a[180:183], v[76:79]
    ds_read_b128 a[220:223], v0 offset:7168
    v_cvt_pk_bf16_f32 v16, v56, v57
    v_mfma_f32_16x16x32_bf16 v[76:79], a[228:231], a[184:187], v[76:79]
    s_waitcnt lgkmcnt(1)
    v_exp_f32 v83, v83
    v_mfma_f32_16x16x32_bf16 v[76:79], a[232:235], a[188:191], v[76:79]
    s_add_u32 s56, s67, 128
    ds_read_b128 v[88:91], v103 offset:3072
    v_fma_f32 v65, v65, s28, v10
    v_mfma_f32_16x16x32_bf16 v[68:71], a[232:235], a[164:167], v[68:71]
    ds_read_b128 a[212:215], v0 offset:6144
    v_mfma_f32_16x16x32_bf16 v[48:51], a[236:239], v[16:19], v[44:47]
    v_exp_f32 v74, v74
    v_mfma_f32_16x16x32_bf16 v[68:71], a[228:231], a[160:163], v[68:71]
    s_add_u32 s58, s33, 128
    ds_read_b128 a[216:219], v1 offset:6144
    s_add_u32 m0, s38, 2048
    v_mfma_f32_16x16x32_bf16 v[68:71], a[224:227], a[156:159], v[68:71]
    ds_read_b128 v[96:99], v103 offset:4096
    v_cvt_pk_bf16_f32 v34, v80, v81
    v_mfma_f32_16x16x32_bf16 v[60:63], a[224:227], a[132:135], v[60:63]
    v_exp_f32 v65, v65
    v_mfma_f32_16x16x32_bf16 v[60:63], a[228:231], a[136:139], v[60:63]
    v_exp_f32 v75, v75
    v_mfma_f32_16x16x32_bf16 v[60:63], a[232:235], a[140:143], v[60:63]
    buffer_load_dwordx4 v6, s[12:15], s58 offen nt lds
    v_mfma_f32_16x16x32_bf16 v[52:55], a[232:235], a[116:119], v[52:55]
    buffer_store_dwordx4 v[84:87], v6, s[16:19], s56 offen offset:0 nt
    s_nop 0
    ds_read_b128 v[84:87], v103 offset:5120
    v_cvt_pk_bf16_f32 v22, v64, v65
    v_cvt_pk_bf16_f32 v23, v66, v67
    v_mfma_f32_16x16x32_bf16 v[52:55], a[228:231], a[112:115], v[52:55]
    v_cvt_pk_bf16_f32 v28, v72, v73
    v_mov_b32 v39, v7
    v_mfma_f32_16x16x32_bf16 v[52:55], a[224:227], a[108:111], v[52:55]
    s_add_u32 m0, s38, 3072
    v_cvt_pk_bf16_f32 v29, v74, v75
    s_waitcnt lgkmcnt(3)
    v_mfma_f32_16x16x32_bf16 v[56:59], a[212:215], a[96:99], 0
    buffer_load_dwordx4 v7, s[12:15], s58 offen nt lds
    v_mfma_f32_16x16x32_bf16 v[48:51], a[240:243], v[22:25], v[48:51]
    ds_read_b128 a[228:231], v0 offset:8192
    v_cvt_pk_bf16_f32 v35, v82, v83
    v_mfma_f32_16x16x32_bf16 v[48:51], a[244:247], v[28:31], v[48:51]
    s_add_u32 s57, s67, 256
    ds_read_b128 a[232:235], v1 offset:8192
    v_mfma_f32_16x16x32_bf16 v[48:51], a[248:251], v[34:37], v[48:51]
    buffer_store_dwordx4 v[88:91], v7, s[16:19], s56 offen offset:0 nt
    ds_read_b128 a[224:227], v1 offset:7168
    s_waitcnt lgkmcnt(4)
    v_mfma_f32_16x16x32_bf16 v[56:59], a[216:219], a[100:103], v[56:59]
    s_add_u32 s59, s33, 256
    s_add_u32 m0, s38, 4096
    v_mfma_f32_16x16x32_bf16 v[56:59], a[220:223], a[104:107], v[56:59]
    buffer_load_dwordx4 v6, s[12:15], s59 offen nt lds
    v_mfma_f32_16x16x32_bf16 v[64:67], a[220:223], a[128:131], 0
    v_cmp_lt_f32 vcc, s29, v48
    s_add_u32 m0, s38, 5120
    v_mfma_f32_16x16x32_bf16 v[64:67], a[216:219], a[124:127], v[64:67]
    s_waitcnt lgkmcnt(3)
    buffer_load_dwordx4 v7, s[12:15], s59 offen nt lds
    v_mfma_f32_16x16x32_bf16 v[64:67], a[212:215], a[120:123], v[64:67]
    buffer_store_dwordx4 v[96:99], v6, s[16:19], s57 offen offset:0 nt
    s_cbranch_vccnz L_rs_tr44d
L_ret_tr44d:
    v_fma_f32 v54, v54, s28, v9
    v_fma_f32 v61, v61, s28, v10
    v_fma_f32 v60, v60, s28, v10
    v_mfma_f32_16x16x32_bf16 v[72:75], a[212:215], a[144:147], 0
    v_fma_f32 v55, v55, s28, v9
    v_mfma_f32_16x16x32_bf16 v[72:75], a[216:219], a[148:151], v[72:75]
    v_fma_f32 v52, v52, s28, v9
    v_mfma_f32_16x16x32_bf16 v[72:75], a[220:223], a[152:155], v[72:75]
    s_waitcnt vmcnt(17) lgkmcnt(0)
    v_exp_f32 v55, v55
    v_mfma_f32_16x16x32_bf16 v[80:83], a[220:223], a[176:179], 0
    s_barrier
    v_mfma_f32_16x16x32_bf16 v[80:83], a[216:219], a[172:175], v[80:83]
    v_exp_f32 v52, v52
    v_mfma_f32_16x16x32_bf16 v[80:83], a[212:215], a[168:171], v[80:83]
    s_add_u32 m0, s22, 0
    ds_read_b64_tr_b16 a[212:213], v2 offset:18432
    v_fma_f32 v53, v53, s28, v9
    v_mfma_f32_16x16x32_bf16 v[80:83], a[224:227], a[180:183], v[80:83]
    ds_read_b64_tr_b16 a[214:215], v2 offset:12288
    v_exp_f32 v61, v61
    v_mfma_f32_16x16x32_bf16 v[80:83], a[228:231], a[184:187], v[80:83]
    buffer_load_dwordx4 v6, s[4:7], s20 offen lds
    v_mfma_f32_16x16x32_bf16 v[80:83], a[232:235], a[188:191], v[80:83]
    v_exp_f32 v60, v60
    v_mfma_f32_16x16x32_bf16 v[72:75], a[232:235], a[164:167], v[72:75]
    s_add_u32 s20, s20, 128
    ds_read_b64_tr_b16 a[216:217], v3 offset:18432
    v_cvt_pk_bf16_f32 v20, v60, v61
    v_mfma_f32_16x16x32_bf16 v[72:75], a[228:231], a[160:163], v[72:75]
    s_add_u32 m0, s22, 1024
    v_exp_f32 v53, v53
    v_mfma_f32_16x16x32_bf16 v[72:75], a[224:227], a[156:159], v[72:75]
    buffer_load_dwordx4 v6, s[4:7], s20 offen lds
    v_mfma_f32_16x16x32_bf16 v[64:67], a[224:227], a[132:135], v[64:67]
    s_add_u32 s20, s20, 128
    v_exp_f32 v54, v54
    v_mfma_f32_16x16x32_bf16 v[64:67], a[228:231], a[136:139], v[64:67]
    ds_read_b64_tr_b16 a[218:219], v3 offset:12288
    v_cvt_pk_bf16_f32 v15, v54, v55
    v_mfma_f32_16x16x32_bf16 v[64:67], a[232:235], a[140:143], v[64:67]
    s_add_u32 m0, s22, 2048
    ds_read_b64_tr_b16 a[220:221], v4 offset:18432
    v_cvt_pk_bf16_f32 v14, v52, v53
    v_mfma_f32_16x16x32_bf16 v[56:59], a[232:235], a[116:119], v[56:59]
    buffer_load_dwordx4 v6, s[4:7], s20 offen lds
    v_mfma_f32_16x16x32_bf16 v[56:59], a[228:231], a[112:115], v[56:59]
    s_add_u32 s20, s20, 12032
    ds_read_b64_tr_b16 a[222:223], v4 offset:12288
    v_add_u32 v103, 6144, v103
    v_mfma_f32_16x16x32_bf16 v[56:59], a[224:227], a[108:111], v[56:59]
    s_waitcnt lgkmcnt(4)
    ds_read_b64_tr_b16 a[224:225], v5 offset:18432
    ds_read_b64_tr_b16 a[226:227], v5 offset:12288
    buffer_store_dwordx4 v[84:87], v7, s[16:19], s57 offen offset:0 nt
    s_branch L_loop4w0
L_end5:
    v_mfma_f32_16x16x32_bf16 v[112:115], a[212:215], v[16:19], v[112:115]
    v_mfma_f32_16x16x32_bf16 v[116:119], a[216:219], v[16:19], v[116:119]
    ds_read_b64_tr_b16 a[230:231], v2 offset:13312
    v_mfma_f32_16x16x32_bf16 v[164:167], a[216:219], v[22:25], v[164:167]
    v_fma_f32 v73, v73, s28, v11
    v_mfma_f32_16x16x32_bf16 v[160:163], a[212:215], v[22:25], v[160:163]
    ds_read_b64_tr_b16 a[234:235], v3 offset:13312
    v_fma_f32 v69, v69, s28, v11
    v_mfma_f32_16x16x32_bf16 v[208:211], a[212:215], v[28:31], v[208:211]
    v_fma_f32 v64, v64, s28, v10
    v_mfma_f32_16x16x32_bf16 v[212:215], a[216:219], v[28:31], v[212:215]
    v_fma_f32 v77, v77, s28, v12
    v_mfma_f32_16x16x32_bf16 a[4:7], a[216:219], v[34:37], a[4:7]
    ds_read_b64_tr_b16 a[228:229], v2 offset:19456
    v_fma_f32 v57, v57, s28, v9
    v_mfma_f32_16x16x32_bf16 a[0:3], a[212:215], v[34:37], a[0:3]
    v_fma_f32 v71, v71, s28, v11
    v_fma_f32 v84, v84, s28, v13
    v_mfma_f32_16x16x32_bf16 a[48:51], a[212:215], v[40:43], a[48:51]
    ds_read_b64_tr_b16 a[232:233], v3 offset:19456
    v_fma_f32 v85, v85, s28, v13
    v_mfma_f32_16x16x32_bf16 a[52:55], a[216:219], v[40:43], a[52:55]
    s_waitcnt lgkmcnt(4)
    v_mfma_f32_16x16x32_bf16 a[56:59], a[220:223], v[40:43], a[56:59]
    ds_read_b64_tr_b16 a[218:219], v5 offset:13312
    v_fma_f32 v68, v68, s28, v11
    v_mfma_f32_16x16x32_bf16 a[60:63], a[224:227], v[40:43], a[60:63]
    ds_read_b64_tr_b16 a[212:213], v4 offset:19456
    v_fma_f32 v56, v56, s28, v9
    v_mfma_f32_16x16x32_bf16 a[12:15], a[224:227], v[34:37], a[12:15]
    ds_read_b64_tr_b16 a[216:217], v5 offset:19456
    v_fma_f32 v91, v91, s28, v13
    v_mfma_f32_16x16x32_bf16 a[8:11], a[220:223], v[34:37], a[8:11]
    v_fma_f32 v76, v76, s28, v12
    v_mfma_f32_16x16x32_bf16 v[216:219], a[220:223], v[28:31], v[216:219]
    v_fma_f32 v82, v82, s28, v12
    v_mfma_f32_16x16x32_bf16 v[220:223], a[224:227], v[28:31], v[220:223]
    v_fma_f32 v70, v70, s28, v11
    v_mfma_f32_16x16x32_bf16 v[172:175], a[224:227], v[22:25], v[172:175]
    v_exp_f32 v69, v69
    v_mfma_f32_16x16x32_bf16 v[168:171], a[220:223], v[22:25], v[168:171]
    v_exp_f32 v82, v82
    v_mfma_f32_16x16x32_bf16 v[120:123], a[220:223], v[16:19], v[120:123]
    ds_read_b64_tr_b16 a[214:215], v4 offset:13312
    v_mfma_f32_16x16x32_bf16 v[124:127], a[224:227], v[16:19], v[124:127]
    s_waitcnt lgkmcnt(4)
    v_exp_f32 v70, v70
    v_mfma_f32_16x16x32_bf16 v[128:131], a[228:231], v[16:19], v[128:131]
    ds_read_b64_tr_b16 a[224:225], v3 offset:20480
    v_fma_f32 v65, v65, s28, v10
    v_mfma_f32_16x16x32_bf16 v[132:135], a[232:235], v[16:19], v[132:135]
    v_exp_f32 v68, v68
    v_mfma_f32_16x16x32_bf16 v[180:183], a[232:235], v[22:25], v[180:183]
    v_fma_f32 v78, v78, s28, v12
    v_cvt_pk_bf16_f32 v26, v68, v69
    v_mfma_f32_16x16x32_bf16 v[176:179], a[228:231], v[22:25], v[176:179]
    ds_read_b64_tr_b16 a[220:221], v2 offset:20480
    v_fma_f32 v74, v74, s28, v11
    v_mfma_f32_16x16x32_bf16 v[224:227], a[228:231], v[28:31], v[224:227]
    v_fma_f32 v81, v81, s28, v12
    v_fma_f32 v86, v86, s28, v13
    v_mfma_f32_16x16x32_bf16 v[228:231], a[232:235], v[28:31], v[228:231]
    ds_read_b64_tr_b16 a[222:223], v2 offset:14336
    v_fma_f32 v59, v59, s28, v9
    v_mfma_f32_16x16x32_bf16 a[20:23], a[232:235], v[34:37], a[20:23]
    v_exp_f32 v74, v74
    v_mfma_f32_16x16x32_bf16 a[16:19], a[228:231], v[34:37], a[16:19]
    v_exp_f32 v78, v78
    v_mfma_f32_16x16x32_bf16 a[64:67], a[228:231], v[40:43], a[64:67]
    ds_read_b64_tr_b16 a[228:229], v4 offset:20480
    v_fma_f32 v83, v83, s28, v12
    v_mfma_f32_16x16x32_bf16 a[68:71], a[232:235], v[40:43], a[68:71]
    s_waitcnt lgkmcnt(4)
    ds_read_b64_tr_b16 a[226:227], v3 offset:14336
    v_fma_f32 v75, v75, s28, v11
    v_mfma_f32_16x16x32_bf16 a[72:75], a[212:215], v[40:43], a[72:75]
    v_exp_f32 v84, v84
    v_mfma_f32_16x16x32_bf16 a[76:79], a[216:219], v[40:43], a[76:79]
    v_fma_f32 v87, v87, s28, v13
    v_mfma_f32_16x16x32_bf16 a[28:31], a[216:219], v[34:37], a[28:31]
    v_exp_f32 v71, v71
    v_mfma_f32_16x16x32_bf16 a[24:27], a[212:215], v[34:37], a[24:27]
    v_exp_f32 v85, v85
    v_mfma_f32_16x16x32_bf16 v[232:235], a[212:215], v[28:31], v[232:235]
    ds_read_b64_tr_b16 a[232:233], v5 offset:20480
    v_fma_f32 v58, v58, s28, v9
    v_mfma_f32_16x16x32_bf16 v[236:239], a[216:219], v[28:31], v[236:239]
    ds_read_b64_tr_b16 a[230:231], v4 offset:14336
    v_fma_f32 v66, v66, s28, v10
    v_mfma_f32_16x16x32_bf16 v[188:191], a[216:219], v[22:25], v[188:191]
    ds_read_b64_tr_b16 a[234:235], v5 offset:14336
    v_mfma_f32_16x16x32_bf16 v[184:187], a[212:215], v[22:25], v[184:187]
    v_exp_f32 v73, v73
    v_mfma_f32_16x16x32_bf16 v[136:139], a[212:215], v[16:19], v[136:139]
    v_fma_f32 v79, v79, s28, v12
    v_mfma_f32_16x16x32_bf16 v[140:143], a[216:219], v[16:19], v[140:143]
    s_waitcnt lgkmcnt(3)
    v_exp_f32 v87, v87
    v_mfma_f32_16x16x32_bf16 v[144:147], a[220:223], v[16:19], v[144:147]
    v_exp_f32 v86, v86
    v_mfma_f32_16x16x32_bf16 v[148:151], a[224:227], v[16:19], v[148:151]
    s_add_u32 s39, s39, 12288
    v_exp_f32 v77, v77
    v_mfma_f32_16x16x32_bf16 v[196:199], a[224:227], v[22:25], v[196:199]
    v_fma_f32 v90, v90, s28, v13
    v_fma_f32 v72, v72, s28, v11
    v_mfma_f32_16x16x32_bf16 v[192:195], a[220:223], v[22:25], v[192:195]
    v_exp_f32 v59, v59
    v_mfma_f32_16x16x32_bf16 v[240:243], a[220:223], v[28:31], v[240:243]
    v_exp_f32 v66, v66
    v_mfma_f32_16x16x32_bf16 v[244:247], a[224:227], v[28:31], v[244:247]
    v_exp_f32 v57, v57
    v_mfma_f32_16x16x32_bf16 a[36:39], a[224:227], v[34:37], a[36:39]
    v_exp_f32 v58, v58
    v_mfma_f32_16x16x32_bf16 a[32:35], a[220:223], v[34:37], a[32:35]
    s_waitcnt vmcnt(10) lgkmcnt(0)
    v_exp_f32 v76, v76
    v_mfma_f32_16x16x32_bf16 a[80:83], a[220:223], v[40:43], a[80:83]
    v_exp_f32 v83, v83
    v_mfma_f32_16x16x32_bf16 a[84:87], a[224:227], v[40:43], a[84:87]
    s_barrier
    ds_read_b128 a[212:215], v0 offset:12288
    v_mfma_f32_16x16x32_bf16 a[88:91], a[228:231], v[40:43], a[88:91]
    ds_read_b128 a[216:219], v1 offset:12288
    s_add_u32 m0, s22, 36864
    v_mfma_f32_16x16x32_bf16 a[92:95], a[232:235], v[40:43], a[92:95]
    ds_read_b128 a[220:223], v0 offset:13312
    v_cvt_pk_bf16_f32 v38, v84, v85
    v_mfma_f32_16x16x32_bf16 a[44:47], a[232:235], v[34:37], a[44:47]
    v_exp_f32 v79, v79
    v_mfma_f32_16x16x32_bf16 a[40:43], a[228:231], v[34:37], a[40:43]
    v_fma_f32 v89, v89, s28, v13
    v_mfma_f32_16x16x32_bf16 v[248:251], a[228:231], v[28:31], v[248:251]
    buffer_load_dwordx4 v6, s[8:11], s21 offen lds
    v_mfma_f32_16x16x32_bf16 v[252:255], a[232:235], v[28:31], v[252:255]
    s_add_u32 s21, s21, 128
    s_add_u32 m0, s22, 37888
    v_fma_f32 v67, v67, s28, v10
    v_mfma_f32_16x16x32_bf16 v[204:207], a[232:235], v[22:25], v[204:207]
    buffer_load_dwordx4 v6, s[8:11], s21 offen lds
    v_mfma_f32_16x16x32_bf16 v[200:203], a[228:231], v[22:25], v[200:203]
    s_add_u32 s21, s21, 128
    v_cvt_pk_bf16_f32 v39, v86, v87
    s_add_u32 m0, s22, 38912
    v_mfma_f32_16x16x32_bf16 v[152:155], a[228:231], v[16:19], v[152:155]
    buffer_load_dwordx4 v6, s[8:11], s21 offen lds
    v_mfma_f32_16x16x32_bf16 v[156:159], a[232:235], v[16:19], v[156:159]
    s_waitcnt lgkmcnt(2)
    v_exp_f32 v90, v90
    v_mfma_f32_16x16x32_bf16 v[52:55], a[212:215], a[96:99], 0
    s_waitcnt lgkmcnt(1)
    v_cvt_pk_bf16_f32 v32, v76, v77
    v_mfma_f32_16x16x32_bf16 v[52:55], a[216:219], a[100:103], v[52:55]
    s_waitcnt lgkmcnt(0)
    ds_read_b128 a[224:227], v1 offset:13312
    v_fma_f32 v88, v88, s28, v13
    v_mfma_f32_16x16x32_bf16 v[52:55], a[220:223], a[104:107], v[52:55]
    ds_read_b128 a[228:231], v0 offset:14336
    v_mfma_f32_16x16x32_bf16 v[60:63], a[220:223], a[128:131], 0
    v_exp_f32 v91, v91
    v_mfma_f32_16x16x32_bf16 v[60:63], a[216:219], a[124:127], v[60:63]
    v_cvt_pk_bf16_f32 v33, v78, v79
    v_cvt_pk_bf16_f32 v27, v70, v71
    v_mfma_f32_16x16x32_bf16 v[60:63], a[212:215], a[120:123], v[60:63]
    ds_read_b128 a[232:235], v1 offset:14336
    v_mfma_f32_16x16x32_bf16 v[68:71], a[212:215], a[144:147], 0
    v_exp_f32 v56, v56
    v_mfma_f32_16x16x32_bf16 v[68:71], a[216:219], a[148:151], v[68:71]
    v_exp_f32 v75, v75
    v_mfma_f32_16x16x32_bf16 v[68:71], a[220:223], a[152:155], v[68:71]
    v_cvt_pk_bf16_f32 v29, v74, v75
    v_cvt_pk_bf16_f32 v41, v90, v91
    v_mfma_f32_16x16x32_bf16 v[76:79], a[220:223], a[176:179], 0
    v_exp_f32 v72, v72
    v_mfma_f32_16x16x32_bf16 v[76:79], a[216:219], a[172:175], v[76:79]
    v_exp_f32 v89, v89
    v_mfma_f32_16x16x32_bf16 v[76:79], a[212:215], a[168:171], v[76:79]
    v_exp_f32 v67, v67
    v_mfma_f32_16x16x32_bf16 v[84:87], a[212:215], a[192:195], 0
    v_exp_f32 v81, v81
    v_mfma_f32_16x16x32_bf16 v[84:87], a[216:219], a[196:199], v[84:87]
    v_mfma_f32_16x16x32_bf16 v[84:87], a[220:223], a[200:203], v[84:87]
    s_waitcnt lgkmcnt(1)
    v_mfma_f32_16x16x32_bf16 v[84:87], a[224:227], a[204:207], v[84:87]
    v_cvt_pk_bf16_f32 v16, v56, v57
    v_fma_f32 v80, v80, s28, v12
    v_mfma_f32_16x16x32_bf16 v[84:87], a[228:231], a[208:211], v[84:87]
    s_waitcnt lgkmcnt(0)
    v_exp_f32 v65, v65
    v_mfma_f32_16x16x32_bf16 v[84:87], a[232:235], v[92:95], v[84:87]
    v_cvt_pk_bf16_f32 v23, v66, v67
    v_mfma_f32_16x16x32_bf16 v[76:79], a[232:235], a[188:191], v[76:79]
    v_exp_f32 v64, v64
    v_mfma_f32_16x16x32_bf16 v[76:79], a[228:231], a[184:187], v[76:79]
    ds_read_b128 a[216:219], v1 offset:18432
    v_mfma_f32_16x16x32_bf16 v[76:79], a[224:227], a[180:183], v[76:79]
    s_add_u32 s21, s21, 12032
    v_mfma_f32_16x16x32_bf16 v[68:71], a[224:227], a[156:159], v[68:71]
    ds_read_b128 a[212:215], v0 offset:18432
    v_cvt_pk_bf16_f32 v22, v64, v65
    v_mfma_f32_16x16x32_bf16 v[68:71], a[228:231], a[160:163], v[68:71]
    v_exp_f32 v80, v80
    v_mfma_f32_16x16x32_bf16 v[68:71], a[232:235], a[164:167], v[68:71]
    v_cvt_pk_bf16_f32 v34, v80, v81
    v_cvt_pk_bf16_f32 v17, v58, v59
    v_mfma_f32_16x16x32_bf16 v[60:63], a[232:235], a[140:143], v[60:63]
    v_exp_f32 v88, v88
    v_mfma_f32_16x16x32_bf16 v[44:47], a[236:239], v[14:17], v[48:51]
    ds_read_b128 a[220:223], v0 offset:19456
    v_mfma_f32_16x16x32_bf16 v[60:63], a[228:231], a[136:139], v[60:63]
    v_mfma_f32_16x16x32_bf16 v[60:63], a[224:227], a[132:135], v[60:63]
    v_mfma_f32_16x16x32_bf16 v[44:47], a[240:243], v[20:23], v[44:47]
    v_cvt_pk_bf16_f32 v40, v88, v89
    v_cvt_pk_bf16_f32 v28, v72, v73
    v_mfma_f32_16x16x32_bf16 v[52:55], a[224:227], a[108:111], v[52:55]
    v_cvt_pk_bf16_f32 v35, v82, v83
    v_mfma_f32_16x16x32_bf16 v[52:55], a[228:231], a[112:115], v[52:55]
    ds_read_b128 a[224:227], v1 offset:19456
    v_mfma_f32_16x16x32_bf16 v[44:47], a[244:247], v[26:29], v[44:47]
    v_mfma_f32_16x16x32_bf16 v[52:55], a[232:235], a[116:119], v[52:55]
    ds_read_b128 a[232:235], v1 offset:20480
    v_mfma_f32_16x16x32_bf16 v[44:47], a[248:251], v[32:35], v[44:47]
    ds_read_b128 a[228:231], v0 offset:20480
    v_mfma_f32_16x16x32_bf16 v[44:47], a[252:255], v[38:41], v[44:47]
    s_waitcnt lgkmcnt(4)
    v_mfma_f32_16x16x32_bf16 v[56:59], a[212:215], a[96:99], 0
    v_mfma_f32_16x16x32_bf16 v[56:59], a[216:219], a[100:103], v[56:59]
    s_waitcnt lgkmcnt(3)
    v_mfma_f32_16x16x32_bf16 v[56:59], a[220:223], a[104:107], v[56:59]
    v_mfma_f32_16x16x32_bf16 v[64:67], a[220:223], a[128:131], 0
    s_nop 1
    v_cmp_lt_f32 vcc, s29, v44
    v_mfma_f32_16x16x32_bf16 v[64:67], a[216:219], a[124:127], v[64:67]
    v_mfma_f32_16x16x32_bf16 v[64:67], a[212:215], a[120:123], v[64:67]
    v_mfma_f32_16x16x32_bf16 v[72:75], a[212:215], a[144:147], 0
    v_mfma_f32_16x16x32_bf16 v[72:75], a[216:219], a[148:151], v[72:75]
    s_nop 0
    s_cbranch_vccnz L_rs_end5a
L_ret_end5a:
    v_mfma_f32_16x16x32_bf16 v[72:75], a[220:223], a[152:155], v[72:75]
    s_waitcnt vmcnt(6) lgkmcnt(0)
    v_mfma_f32_16x16x32_bf16 v[80:83], a[220:223], a[176:179], 0
    s_barrier
    v_mfma_f32_16x16x32_bf16 v[80:83], a[216:219], a[172:175], v[80:83]
    v_fma_f32 v60, v60, s28, v10
    v_fma_f32 v52, v52, s28, v9
    v_mfma_f32_16x16x32_bf16 v[80:83], a[212:215], a[168:171], v[80:83]
    v_exp_f32 v60, v60
    v_mfma_f32_16x16x32_bf16 v[88:91], a[212:215], a[192:195], 0
    ds_read_b64_tr_b16 a[212:213], v2 offset:0
    v_fma_f32 v55, v55, s28, v9
    v_mfma_f32_16x16x32_bf16 v[88:91], a[216:219], a[196:199], v[88:91]
    ds_read_b64_tr_b16 a[214:215], v2 offset:6144
    v_fma_f32 v53, v53, s28, v9
    v_mfma_f32_16x16x32_bf16 v[88:91], a[220:223], a[200:203], v[88:91]
    v_fma_f32 v54, v54, s28, v9
    v_fma_f32 v61, v61, s28, v10
    v_mfma_f32_16x16x32_bf16 v[88:91], a[224:227], a[204:207], v[88:91]
    ds_read_b64_tr_b16 a[216:217], v3 offset:0
    v_fma_f32 v63, v63, s28, v10
    v_mfma_f32_16x16x32_bf16 v[88:91], a[228:231], a[208:211], v[88:91]
    v_mfma_f32_16x16x32_bf16 v[88:91], a[232:235], v[92:95], v[88:91]
    ds_read_b64_tr_b16 a[218:219], v3 offset:6144
    v_fma_f32 v62, v62, s28, v10
    v_mfma_f32_16x16x32_bf16 v[80:83], a[232:235], a[188:191], v[80:83]
    v_exp_f32 v52, v52
    v_mfma_f32_16x16x32_bf16 v[80:83], a[228:231], a[184:187], v[80:83]
    v_exp_f32 v53, v53
    v_mfma_f32_16x16x32_bf16 v[80:83], a[224:227], a[180:183], v[80:83]
    v_cvt_pk_bf16_f32 v18, v52, v53
    v_mfma_f32_16x16x32_bf16 v[72:75], a[224:227], a[156:159], v[72:75]
    v_exp_f32 v54, v54
    v_mfma_f32_16x16x32_bf16 v[72:75], a[228:231], a[160:163], v[72:75]
    ds_read_b64_tr_b16 a[220:221], v4 offset:0
    v_mfma_f32_16x16x32_bf16 v[72:75], a[232:235], a[164:167], v[72:75]
    v_exp_f32 v62, v62
    v_mfma_f32_16x16x32_bf16 v[64:67], a[232:235], a[140:143], v[64:67]
    v_exp_f32 v55, v55
    v_mfma_f32_16x16x32_bf16 v[64:67], a[228:231], a[136:139], v[64:67]
    v_exp_f32 v61, v61
    v_mfma_f32_16x16x32_bf16 v[64:67], a[224:227], a[132:135], v[64:67]
    v_exp_f32 v63, v63
    v_mfma_f32_16x16x32_bf16 v[56:59], a[224:227], a[108:111], v[56:59]
    ds_read_b64_tr_b16 a[222:223], v4 offset:6144
    v_cvt_pk_bf16_f32 v24, v60, v61
    v_mfma_f32_16x16x32_bf16 v[56:59], a[228:231], a[112:115], v[56:59]
    ds_read_b64_tr_b16 a[224:225], v5 offset:0
    v_cvt_pk_bf16_f32 v19, v54, v55
    v_mfma_f32_16x16x32_bf16 v[56:59], a[232:235], a[116:119], v[56:59]
    s_waitcnt lgkmcnt(3)
    ds_read_b64_tr_b16 a[226:227], v5 offset:6144
    v_cvt_pk_bf16_f32 v25, v62, v63
    v_mfma_f32_16x16x32_bf16 v[112:115], a[212:215], v[14:17], v[112:115]
    v_fma_f32 v70, v70, s28, v11
    v_fma_f32 v64, v64, s28, v10
    v_mfma_f32_16x16x32_bf16 v[116:119], a[216:219], v[14:17], v[116:119]
    v_fma_f32 v66, v66, s28, v10
    v_fma_f32 v56, v56, s28, v9
    v_mfma_f32_16x16x32_bf16 v[164:167], a[216:219], v[20:23], v[164:167]
    ds_read_b64_tr_b16 a[230:231], v2 offset:7168
    v_fma_f32 v71, v71, s28, v11
    v_mfma_f32_16x16x32_bf16 v[160:163], a[212:215], v[20:23], v[160:163]
    v_fma_f32 v69, v69, s28, v11
    v_fma_f32 v77, v77, s28, v12
    v_mfma_f32_16x16x32_bf16 v[208:211], a[212:215], v[26:29], v[208:211]
    ds_read_b64_tr_b16 a[228:229], v2 offset:1024
    v_fma_f32 v68, v68, s28, v11
    v_mfma_f32_16x16x32_bf16 v[212:215], a[216:219], v[26:29], v[212:215]
    v_fma_f32 v76, v76, s28, v12
    v_fma_f32 v72, v72, s28, v11
    v_mfma_f32_16x16x32_bf16 a[4:7], a[216:219], v[32:35], a[4:7]
    v_exp_f32 v66, v66
    v_mfma_f32_16x16x32_bf16 a[0:3], a[212:215], v[32:35], a[0:3]
    v_fma_f32 v89, v89, s28, v13
    v_fma_f32 v82, v82, s28, v12
    v_mfma_f32_16x16x32_bf16 a[48:51], a[212:215], v[38:41], a[48:51]
    s_add_u32 s39, s39, 12288
    ds_read_b64_tr_b16 a[232:233], v3 offset:1024
    v_fma_f32 v83, v83, s28, v12
    v_mfma_f32_16x16x32_bf16 a[52:55], a[216:219], v[38:41], a[52:55]
    s_waitcnt lgkmcnt(3)
    ds_read_b64_tr_b16 a[234:235], v3 offset:7168
    v_fma_f32 v79, v79, s28, v12
    v_mfma_f32_16x16x32_bf16 a[56:59], a[220:223], v[38:41], a[56:59]
    s_waitcnt vmcnt(0)
    v_fma_f32 v74, v74, s28, v11
    v_fma_f32 v86, v86, s28, v13
    v_mfma_f32_16x16x32_bf16 a[60:63], a[224:227], v[38:41], a[60:63]
    ds_read_b64_tr_b16 a[214:215], v4 offset:7168
    v_fma_f32 v87, v87, s28, v13
    v_mfma_f32_16x16x32_bf16 a[12:15], a[224:227], v[32:35], a[12:15]
    s_barrier
    v_mfma_f32_16x16x32_bf16 a[8:11], a[220:223], v[32:35], a[8:11]
    v_exp_f32 v56, v56
    v_mfma_f32_16x16x32_bf16 v[216:219], a[220:223], v[26:29], v[216:219]
    ds_read_b64_tr_b16 a[216:217], v5 offset:1024
    v_fma_f32 v73, v73, s28, v11
    v_mfma_f32_16x16x32_bf16 v[220:223], a[224:227], v[26:29], v[220:223]
    v_exp_f32 v71, v71
    v_mfma_f32_16x16x32_bf16 v[172:175], a[224:227], v[20:23], v[172:175]
    v_fma_f32 v84, v84, s28, v13
    v_fma_f32 v81, v81, s28, v12
    v_mfma_f32_16x16x32_bf16 v[168:171], a[220:223], v[20:23], v[168:171]
    ds_read_b64_tr_b16 a[218:219], v5 offset:7168
    v_fma_f32 v91, v91, s28, v13
    v_mfma_f32_16x16x32_bf16 v[120:123], a[220:223], v[14:17], v[120:123]
    ds_read_b64_tr_b16 a[212:213], v4 offset:1024
    v_fma_f32 v58, v58, s28, v9
    v_mfma_f32_16x16x32_bf16 v[124:127], a[224:227], v[14:17], v[124:127]
    s_waitcnt lgkmcnt(4)
    v_exp_f32 v76, v76
    v_mfma_f32_16x16x32_bf16 v[128:131], a[228:231], v[14:17], v[128:131]
    v_exp_f32 v74, v74
    v_mfma_f32_16x16x32_bf16 v[132:135], a[232:235], v[14:17], v[132:135]
    ds_read_b64_tr_b16 a[224:225], v3 offset:2048
    v_fma_f32 v85, v85, s28, v13
    v_mfma_f32_16x16x32_bf16 v[180:183], a[232:235], v[20:23], v[180:183]
    ds_read_b64_tr_b16 a[222:223], v2 offset:8192
    v_fma_f32 v67, v67, s28, v10
    v_fma_f32 v90, v90, s28, v13
    v_mfma_f32_16x16x32_bf16 v[176:179], a[228:231], v[20:23], v[176:179]
    v_exp_f32 v91, v91
    v_mfma_f32_16x16x32_bf16 v[224:227], a[228:231], v[26:29], v[224:227]
    v_exp_f32 v70, v70
    v_mfma_f32_16x16x32_bf16 v[228:231], a[232:235], v[26:29], v[228:231]
    v_exp_f32 v82, v82
    v_mfma_f32_16x16x32_bf16 a[20:23], a[232:235], v[32:35], a[20:23]
    ds_read_b64_tr_b16 a[220:221], v2 offset:2048
    v_fma_f32 v65, v65, s28, v10
    v_mfma_f32_16x16x32_bf16 a[16:19], a[228:231], v[32:35], a[16:19]
    v_exp_f32 v64, v64
    v_mfma_f32_16x16x32_bf16 a[64:67], a[228:231], v[38:41], a[64:67]
    ds_read_b64_tr_b16 a[226:227], v3 offset:8192
    v_exp_f32 v65, v65
    v_mfma_f32_16x16x32_bf16 a[68:71], a[232:235], v[38:41], a[68:71]
    s_waitcnt lgkmcnt(4)
    v_fma_f32 v75, v75, s28, v11
    v_fma_f32 v59, v59, s28, v9
    v_mfma_f32_16x16x32_bf16 a[72:75], a[212:215], v[38:41], a[72:75]
    ds_read_b64_tr_b16 a[230:231], v4 offset:8192
    v_fma_f32 v88, v88, s28, v13
    v_mfma_f32_16x16x32_bf16 a[76:79], a[216:219], v[38:41], a[76:79]
    ds_read_b64_tr_b16 a[232:233], v5 offset:2048
    v_fma_f32 v80, v80, s28, v12
    v_mfma_f32_16x16x32_bf16 a[28:31], a[216:219], v[32:35], a[28:31]
    v_exp_f32 v79, v79
    v_mfma_f32_16x16x32_bf16 a[24:27], a[212:215], v[32:35], a[24:27]
    ds_read_b64_tr_b16 a[234:235], v5 offset:8192
    v_exp_f32 v84, v84
    v_mfma_f32_16x16x32_bf16 v[232:235], a[212:215], v[26:29], v[232:235]
    v_exp_f32 v83, v83
    v_mfma_f32_16x16x32_bf16 v[236:239], a[216:219], v[26:29], v[236:239]
    v_exp_f32 v77, v77
    v_mfma_f32_16x16x32_bf16 v[188:191], a[216:219], v[20:23], v[188:191]
    v_exp_f32 v81, v81
    v_mfma_f32_16x16x32_bf16 v[184:187], a[212:215], v[20:23], v[184:187]
    v_exp_f32 v89, v89
    v_mfma_f32_16x16x32_bf16 v[136:139], a[212:215], v[14:17], v[136:139]
    v_exp_f32 v73, v73
    v_mfma_f32_16x16x32_bf16 v[140:143], a[216:219], v[14:17], v[140:143]
    s_waitcnt lgkmcnt(3)
    ds_read_b64_tr_b16 a[228:229], v4 offset:2048
    v_fma_f32 v78, v78, s28, v12
    v_mfma_f32_16x16x32_bf16 v[144:147], a[220:223], v[14:17], v[144:147]
    v_exp_f32 v90, v90
    v_mfma_f32_16x16x32_bf16 v[148:151], a[224:227], v[14:17], v[148:151]
    v_exp_f32 v59, v59
    v_fma_f32 v57, v57, s28, v9
    v_mfma_f32_16x16x32_bf16 v[196:199], a[224:227], v[20:23], v[196:199]
    v_exp_f32 v85, v85
    v_mfma_f32_16x16x32_bf16 v[192:195], a[220:223], v[20:23], v[192:195]
    v_exp_f32 v57, v57
    v_mfma_f32_16x16x32_bf16 v[240:243], a[220:223], v[26:29], v[240:243]
    v_exp_f32 v80, v80
    v_mfma_f32_16x16x32_bf16 v[244:247], a[224:227], v[26:29], v[244:247]
    v_exp_f32 v75, v75
    v_mfma_f32_16x16x32_bf16 a[36:39], a[224:227], v[32:35], a[36:39]
    v_exp_f32 v78, v78
    v_mfma_f32_16x16x32_bf16 a[32:35], a[220:223], v[32:35], a[32:35]
    v_exp_f32 v88, v88
    v_mfma_f32_16x16x32_bf16 a[80:83], a[220:223], v[38:41], a[80:83]
    v_exp_f32 v72, v72
    v_mfma_f32_16x16x32_bf16 a[84:87], a[224:227], v[38:41], a[84:87]
    s_waitcnt lgkmcnt(0)
    ds_read_b64_tr_b16 a[212:213], v2 offset:18432
    v_exp_f32 v68, v68
    v_mfma_f32_16x16x32_bf16 a[88:91], a[228:231], v[38:41], a[88:91]
    v_exp_f32 v67, v67
    v_mfma_f32_16x16x32_bf16 a[92:95], a[232:235], v[38:41], a[92:95]
    ds_read_b64_tr_b16 a[214:215], v2 offset:12288
    v_cvt_pk_bf16_f32 v37, v78, v79
    v_mfma_f32_16x16x32_bf16 a[44:47], a[232:235], v[32:35], a[44:47]
    v_exp_f32 v58, v58
    v_mfma_f32_16x16x32_bf16 a[40:43], a[228:231], v[32:35], a[40:43]
    ds_read_b64_tr_b16 a[216:217], v3 offset:18432
    v_exp_f32 v69, v69
    v_mfma_f32_16x16x32_bf16 v[248:251], a[228:231], v[26:29], v[248:251]
    ds_read_b64_tr_b16 a[218:219], v3 offset:12288
    v_cvt_pk_bf16_f32 v42, v84, v85
    v_mfma_f32_16x16x32_bf16 v[252:255], a[232:235], v[26:29], v[252:255]
    v_exp_f32 v86, v86
    v_mfma_f32_16x16x32_bf16 v[204:207], a[232:235], v[20:23], v[204:207]
    ds_read_b64_tr_b16 a[220:221], v4 offset:18432
    v_cvt_pk_bf16_f32 v30, v68, v69
    v_mfma_f32_16x16x32_bf16 v[200:203], a[228:231], v[20:23], v[200:203]
    v_cvt_pk_bf16_f32 v23, v66, v67
    v_cvt_pk_bf16_f32 v36, v76, v77
    v_mfma_f32_16x16x32_bf16 v[152:155], a[228:231], v[14:17], v[152:155]
    v_cvt_pk_bf16_f32 v22, v64, v65
    v_cvt_pk_bf16_f32 v34, v80, v81
    v_mfma_f32_16x16x32_bf16 v[156:159], a[232:235], v[14:17], v[156:159]
    v_cvt_pk_bf16_f32 v29, v74, v75
    v_cvt_pk_bf16_f32 v17, v58, v59
    v_cvt_pk_bf16_f32 v35, v82, v83
    v_cvt_pk_bf16_f32 v16, v56, v57
    v_cvt_pk_bf16_f32 v31, v70, v71
    v_cvt_pk_bf16_f32 v28, v72, v73
    v_mfma_f32_16x16x32_bf16 v[48:51], a[236:239], v[16:19], v[44:47]
    ds_read_b64_tr_b16 a[222:223], v4 offset:12288
    v_cvt_pk_bf16_f32 v40, v88, v89
    v_mfma_f32_16x16x32_bf16 v[48:51], a[240:243], v[22:25], v[48:51]
    v_exp_f32 v87, v87
    v_mfma_f32_16x16x32_bf16 v[48:51], a[244:247], v[28:31], v[48:51]
    v_cvt_pk_bf16_f32 v41, v90, v91
    v_cvt_pk_bf16_f32 v43, v86, v87
    v_mfma_f32_16x16x32_bf16 v[48:51], a[248:251], v[34:37], v[48:51]
    ds_read_b64_tr_b16 a[224:225], v5 offset:18432
    v_mfma_f32_16x16x32_bf16 v[48:51], a[252:255], v[40:43], v[48:51]
    s_waitcnt lgkmcnt(3)
    ds_read_b64_tr_b16 a[226:227], v5 offset:12288
    s_nop 5
    v_cmp_lt_f32 vcc, s29, v48
    s_nop 4
    s_cbranch_vccnz L_rs_end5b
L_ret_end5b:
    v_lshrrev_b32 v108, 11, v0
    v_xor_b32 v108, s65, v108
    v_and_b32 v101, 0x3ff, v0
    v_lshl_add_u32 v101, v108, 10, v101
    v_add_u32 v101, s38, v101
    v_mbcnt_lo_u32_b32 v108, -1, 0
    v_mbcnt_hi_u32_b32 v108, -1, v108
    v_lshrrev_b32 v108, 1, v108
    v_mov_b32 v100, v48
    v_and_b32 v108, 24, v108
    v_bfe_u32 v108, s66, v108, 8
    v_xor_b32 v101, v101, v108
    v_permlane32_swap_b32 v48, v100
    v_mov_b32 v108, v100
    v_rcp_f32 v8, v51
    v_rcp_f32 v102, v49
    v_permlane16_swap_b32 v100, v108
    v_rcp_f32 v48, v48
    v_rcp_f32 v100, v100
    v_rcp_f32 v50, v50
    v_mfma_f32_16x16x32_bf16 v[112:115], a[212:215], v[16:19], v[112:115]
    v_xor_b32 v92, 32, v101
    v_mfma_f32_16x16x32_bf16 v[116:119], a[216:219], v[16:19], v[116:119]
    v_mfma_f32_16x16x32_bf16 v[164:167], a[216:219], v[22:25], v[164:167]
    v_mfma_f32_16x16x32_bf16 v[160:163], a[212:215], v[22:25], v[160:163]
    s_add_u32 s84, s34, 0
    ds_read_b64_tr_b16 a[228:229], v2 offset:19456
    v_mfma_f32_16x16x32_bf16 v[208:211], a[212:215], v[28:31], v[208:211]
    v_mfma_f32_16x16x32_bf16 v[212:215], a[216:219], v[28:31], v[212:215]
    ds_read_b64_tr_b16 a[230:231], v2 offset:13312
    v_mfma_f32_16x16x32_bf16 a[4:7], a[216:219], v[34:37], a[4:7]
    v_mfma_f32_16x16x32_bf16 a[0:3], a[212:215], v[34:37], a[0:3]
    v_subrev_u32 v103, 28672, v103
    s_add_u32 s85, s34, 6144
    v_mfma_f32_16x16x32_bf16 a[48:51], a[212:215], v[40:43], a[48:51]
    v_mfma_f32_16x16x32_bf16 a[52:55], a[216:219], v[40:43], a[52:55]
    s_waitcnt lgkmcnt(2)
    ds_read_b64_tr_b16 a[234:235], v3 offset:13312
    v_mfma_f32_16x16x32_bf16 a[56:59], a[220:223], v[40:43], a[56:59]
    ds_read_b64_tr_b16 a[232:233], v3 offset:19456
    v_mfma_f32_16x16x32_bf16 a[60:63], a[224:227], v[40:43], a[60:63]
    v_mfma_f32_16x16x32_bf16 a[12:15], a[224:227], v[34:37], a[12:15]
    ds_read_b64_tr_b16 a[218:219], v5 offset:13312
    v_mfma_f32_16x16x32_bf16 a[8:11], a[220:223], v[34:37], a[8:11]
    ds_read_b64_tr_b16 a[214:215], v4 offset:13312
    v_accvgpr_read_b32 v105, a1
    v_mfma_f32_16x16x32_bf16 v[216:219], a[220:223], v[28:31], v[216:219]
    ds_read_b64_tr_b16 a[216:217], v5 offset:19456
    v_mfma_f32_16x16x32_bf16 v[220:223], a[224:227], v[28:31], v[220:223]
    v_mfma_f32_16x16x32_bf16 v[172:175], a[224:227], v[22:25], v[172:175]
    v_mfma_f32_16x16x32_bf16 v[168:171], a[220:223], v[22:25], v[168:171]
    ds_read_b64_tr_b16 a[212:213], v4 offset:19456
    v_mfma_f32_16x16x32_bf16 v[120:123], a[220:223], v[16:19], v[120:123]
    ds_read_b64_tr_b16 a[220:221], v2 offset:20480
    v_mfma_f32_16x16x32_bf16 v[124:127], a[224:227], v[16:19], v[124:127]
    s_waitcnt lgkmcnt(6)
    ds_read_b64_tr_b16 a[222:223], v2 offset:14336
    v_mfma_f32_16x16x32_bf16 v[128:131], a[228:231], v[16:19], v[128:131]
    s_waitcnt lgkmcnt(6)
    v_accvgpr_read_b32 v107, a3
    v_mfma_f32_16x16x32_bf16 v[132:135], a[232:235], v[16:19], v[132:135]
    v_mfma_f32_16x16x32_bf16 v[180:183], a[232:235], v[22:25], v[180:183]
    s_add_u32 s86, s34, 12288
    v_accvgpr_read_b32 v52, a8
    v_accvgpr_read_b32 v56, a12
    v_mfma_f32_16x16x32_bf16 v[176:179], a[228:231], v[22:25], v[176:179]
    v_mfma_f32_16x16x32_bf16 v[224:227], a[228:231], v[28:31], v[224:227]
    v_mfma_f32_16x16x32_bf16 v[228:231], a[232:235], v[28:31], v[228:231]
    v_accvgpr_read_b32 v54, a10
    v_accvgpr_read_b32 v109, a5
    v_mfma_f32_16x16x32_bf16 a[20:23], a[232:235], v[34:37], a[20:23]
    v_mfma_f32_16x16x32_bf16 a[16:19], a[228:231], v[34:37], a[16:19]
    v_accvgpr_read_b32 v57, a13
    v_mfma_f32_16x16x32_bf16 a[64:67], a[228:231], v[40:43], a[64:67]
    v_mfma_f32_16x16x32_bf16 a[68:71], a[232:235], v[40:43], a[68:71]
    s_waitcnt lgkmcnt(0)
    v_mfma_f32_16x16x32_bf16 a[72:75], a[212:215], v[40:43], a[72:75]
    ds_read_b64_tr_b16 a[228:229], v4 offset:20480
    v_mfma_f32_16x16x32_bf16 a[76:79], a[216:219], v[40:43], a[76:79]
    s_add_u32 s87, s34, 18432
    v_mfma_f32_16x16x32_bf16 a[28:31], a[216:219], v[34:37], a[28:31]
    ds_read_b64_tr_b16 a[234:235], v5 offset:14336
    v_accvgpr_read_b32 v55, a11
    v_mfma_f32_16x16x32_bf16 a[24:27], a[212:215], v[34:37], a[24:27]
    ds_read_b64_tr_b16 a[224:225], v3 offset:20480
    v_xor_b32 v93, 64, v101
    v_mfma_f32_16x16x32_bf16 v[232:235], a[212:215], v[28:31], v[232:235]
    ds_read_b64_tr_b16 a[226:227], v3 offset:14336
    v_accvgpr_read_b32 v59, a15
    v_mfma_f32_16x16x32_bf16 v[236:239], a[216:219], v[28:31], v[236:239]
    ds_read_b64_tr_b16 a[232:233], v5 offset:20480
    v_mfma_f32_16x16x32_bf16 v[188:191], a[216:219], v[22:25], v[188:191]
    s_add_u32 s88, s34, 24576
    v_xor_b32 v94, 96, v101
    v_accvgpr_read_b32 v104, a0
    v_mfma_f32_16x16x32_bf16 v[184:187], a[212:215], v[22:25], v[184:187]
    v_mfma_f32_16x16x32_bf16 v[136:139], a[212:215], v[16:19], v[136:139]
    ds_read_b64_tr_b16 a[230:231], v4 offset:14336
    v_accvgpr_read_b32 v58, a14
    v_mfma_f32_16x16x32_bf16 v[140:143], a[216:219], v[16:19], v[140:143]
    v_accvgpr_read_b32 v106, a2
    v_accvgpr_read_b32 v53, a9
    v_accvgpr_read_b32 v110, a6
    v_pk_mul_f32 v[126:127], v[126:127], v[48:49] op_sel_hi:[1,0]
    v_pk_mul_f32 v[118:119], v[118:119], v[48:49] op_sel_hi:[1,0]
    v_pk_mul_f32 v[120:121], v[120:121], v[48:49] op_sel_hi:[1,0]
    v_pk_mul_f32 v[124:125], v[124:125], v[48:49] op_sel_hi:[1,0]
    v_pk_mul_f32 v[162:163], v[162:163], v[102:103] op_sel_hi:[1,0]
    v_pk_mul_f32 v[122:123], v[122:123], v[48:49] op_sel_hi:[1,0]
    v_pk_mul_f32 v[166:167], v[166:167], v[102:103] op_sel_hi:[1,0]
    v_pk_mul_f32 v[114:115], v[114:115], v[48:49] op_sel_hi:[1,0]
    v_pk_mul_f32 v[168:169], v[168:169], v[102:103] op_sel_hi:[1,0]
    v_pk_mul_f32 v[160:161], v[160:161], v[102:103] op_sel_hi:[1,0]
    v_pk_mul_f32 v[116:117], v[116:117], v[48:49] op_sel_hi:[1,0]
    v_pk_mul_f32 v[208:209], v[208:209], v[50:51] op_sel_hi:[1,0]
    v_pk_mul_f32 v[170:171], v[170:171], v[102:103] op_sel_hi:[1,0]
    v_pk_mul_f32 v[164:165], v[164:165], v[102:103] op_sel_hi:[1,0]
    v_pk_mul_f32 v[172:173], v[172:173], v[102:103] op_sel_hi:[1,0]
    v_pk_mul_f32 v[174:175], v[174:175], v[102:103] op_sel_hi:[1,0]
    v_pk_mul_f32 v[112:113], v[112:113], v[48:49] op_sel_hi:[1,0]
    v_cvt_pk_bf16_f32 v120, v120, v121
    v_cvt_pk_bf16_f32 v121, v122, v123
    v_mfma_f32_16x16x32_bf16 v[144:147], a[220:223], v[16:19], v[144:147]
    s_waitcnt lgkmcnt(1)
    v_cvt_pk_bf16_f32 v124, v124, v125
    v_cvt_pk_bf16_f32 v160, v160, v161
    v_mfma_f32_16x16x32_bf16 v[148:151], a[224:227], v[16:19], v[148:151]
    v_cvt_pk_bf16_f32 v164, v164, v165
    v_cvt_pk_bf16_f32 v172, v172, v173
    v_mfma_f32_16x16x32_bf16 v[196:199], a[224:227], v[22:25], v[196:199]
    v_cvt_pk_bf16_f32 v112, v112, v113
    v_cvt_pk_bf16_f32 v116, v116, v117
    v_mfma_f32_16x16x32_bf16 v[192:195], a[220:223], v[22:25], v[192:195]
    v_cvt_pk_bf16_f32 v113, v114, v115
    v_cvt_pk_bf16_f32 v117, v118, v119
    v_mfma_f32_16x16x32_bf16 v[240:243], a[220:223], v[28:31], v[240:243]
    v_cvt_pk_bf16_f32 v165, v166, v167
    v_cvt_pk_bf16_f32 v125, v126, v127
    v_mfma_f32_16x16x32_bf16 v[244:247], a[224:227], v[28:31], v[244:247]
    v_cvt_pk_bf16_f32 v173, v174, v175
    v_cvt_pk_bf16_f32 v168, v168, v169
    v_mfma_f32_16x16x32_bf16 a[36:39], a[224:227], v[34:37], a[36:39]
    s_add_u32 s18, s34, 30720
    v_cvt_pk_bf16_f32 v161, v162, v163
    v_cvt_pk_bf16_f32 v169, v170, v171
    v_mfma_f32_16x16x32_bf16 a[32:35], a[220:223], v[34:37], a[32:35]
    ds_write2st64_b64 v101, v[112:113], v[160:161] offset0:0 offset1:12
    v_mfma_f32_16x16x32_bf16 a[80:83], a[220:223], v[40:43], a[80:83]
    ds_write2st64_b64 v92, v[116:117], v[164:165] offset0:0 offset1:12
    v_mfma_f32_16x16x32_bf16 a[84:87], a[224:227], v[40:43], a[84:87]
    s_waitcnt lgkmcnt(2)
    ds_write2st64_b64 v93, v[120:121], v[168:169] offset0:0 offset1:12
    v_mfma_f32_16x16x32_bf16 a[88:91], a[228:231], v[40:43], a[88:91]
    ds_write2st64_b64 v94, v[124:125], v[172:173] offset0:0 offset1:12
    v_mfma_f32_16x16x32_bf16 a[92:95], a[232:235], v[40:43], a[92:95]
    ds_read_b128 v[60:63], v103 offset:0
    v_mfma_f32_16x16x32_bf16 a[44:47], a[232:235], v[34:37], a[44:47]
    ds_read_b128 v[64:67], v103 offset:1024
    v_pk_mul_f32 v[150:151], v[150:151], v[48:49] op_sel_hi:[1,0]
    v_pk_mul_f32 v[216:217], v[216:217], v[50:51] op_sel_hi:[1,0]
    v_pk_mul_f32 v[220:221], v[220:221], v[50:51] op_sel_hi:[1,0]
    v_pk_mul_f32 v[58:59], v[58:59], v[8:9] op_sel_hi:[1,0]
    v_pk_mul_f32 v[56:57], v[56:57], v[8:9] op_sel_hi:[1,0]
    v_pk_mul_f32 v[136:137], v[136:137], v[48:49] op_sel_hi:[1,0]
    v_pk_mul_f32 v[52:53], v[52:53], v[8:9] op_sel_hi:[1,0]
    v_pk_mul_f32 v[142:143], v[142:143], v[48:49] op_sel_hi:[1,0]
    v_pk_mul_f32 v[218:219], v[218:219], v[50:51] op_sel_hi:[1,0]
    v_pk_mul_f32 v[140:141], v[140:141], v[48:49] op_sel_hi:[1,0]
    v_cvt_pk_bf16_f32 v52, v52, v53
    v_pk_mul_f32 v[148:149], v[148:149], v[48:49] op_sel_hi:[1,0]
    v_accvgpr_read_b32 v108, a4
    v_pk_mul_f32 v[104:105], v[104:105], v[8:9] op_sel_hi:[1,0]
    v_pk_mul_f32 v[214:215], v[214:215], v[50:51] op_sel_hi:[1,0]
    v_pk_mul_f32 v[212:213], v[212:213], v[50:51] op_sel_hi:[1,0]
    v_pk_mul_f32 v[138:139], v[138:139], v[48:49] op_sel_hi:[1,0]
    v_pk_mul_f32 v[54:55], v[54:55], v[8:9] op_sel_hi:[1,0]
    v_pk_mul_f32 v[106:107], v[106:107], v[8:9] op_sel_hi:[1,0]
    v_pk_mul_f32 v[128:129], v[128:129], v[48:49] op_sel_hi:[1,0]
    v_pk_mul_f32 v[222:223], v[222:223], v[50:51] op_sel_hi:[1,0]
    s_nop 1
    v_mfma_f32_16x16x32_bf16 a[40:43], a[228:231], v[34:37], a[40:43]
    v_mfma_f32_16x16x32_bf16 v[248:251], a[228:231], v[28:31], v[248:251]
    s_waitcnt lgkmcnt(1)
    buffer_store_dwordx4 v[60:63], v6, s[16:19], s84 offen offset:0 nt
    ds_read_b128 v[68:71], v103 offset:6144
    v_cvt_pk_bf16_f32 v53, v54, v55
    v_pk_mul_f32 v[108:109], v[108:109], v[8:9] op_sel_hi:[1,0]
    v_cvt_pk_bf16_f32 v220, v220, v221
    v_pk_mul_f32 v[210:211], v[210:211], v[50:51] op_sel_hi:[1,0]
    v_pk_mul_f32 v[180:181], v[180:181], v[102:103] op_sel_hi:[1,0]
    v_pk_mul_f32 v[188:189], v[188:189], v[102:103] op_sel_hi:[1,0]
    v_cvt_pk_bf16_f32 v216, v216, v217
    s_nop 0
    v_mfma_f32_16x16x32_bf16 v[252:255], a[232:235], v[28:31], v[252:255]
    v_cvt_pk_bf16_f32 v56, v56, v57
    v_cvt_pk_bf16_f32 v108, v108, v109
    v_accvgpr_read_b32 v111, a7
    v_cvt_pk_bf16_f32 v104, v104, v105
    ds_read_b128 v[72:75], v103 offset:7168
    v_cvt_pk_bf16_f32 v221, v222, v223
    v_pk_mul_f32 v[110:111], v[110:111], v[8:9] op_sel_hi:[1,0]
    v_cvt_pk_bf16_f32 v212, v212, v213
    v_cvt_pk_bf16_f32 v213, v214, v215
    v_cvt_pk_bf16_f32 v208, v208, v209
    v_cvt_pk_bf16_f32 v105, v106, v107
    v_cvt_pk_bf16_f32 v209, v210, v211
    v_cvt_pk_bf16_f32 v57, v58, v59
    v_cvt_pk_bf16_f32 v188, v188, v189
    v_mfma_f32_16x16x32_bf16 v[204:207], a[232:235], v[22:25], v[204:207]
    s_waitcnt lgkmcnt(2)
    buffer_store_dwordx4 v[64:67], v7, s[16:19], s84 offen offset:0 nt
    v_cvt_pk_bf16_f32 v109, v110, v111
    v_cvt_pk_bf16_f32 v140, v140, v141
    ds_write2st64_b64 v101, v[208:209], v[104:105] offset0:24 offset1:36
    v_cvt_pk_bf16_f32 v136, v136, v137
    v_pk_mul_f32 v[236:237], v[236:237], v[50:51] op_sel_hi:[1,0]
    v_accvgpr_read_b32 v54, a58
    v_pk_mul_f32 v[130:131], v[130:131], v[48:49] op_sel_hi:[1,0]
    v_pk_mul_f32 v[240:241], v[240:241], v[50:51] op_sel_hi:[1,0]
    v_accvgpr_read_b32 v59, a63
    v_cvt_pk_bf16_f32 v217, v218, v219
    v_accvgpr_read_b32 v104, a48
    v_pk_mul_f32 v[226:227], v[226:227], v[50:51] op_sel_hi:[1,0]
    v_accvgpr_read_b32 v58, a62
    v_cvt_pk_bf16_f32 v128, v128, v129
    v_mfma_f32_16x16x32_bf16 v[200:203], a[228:231], v[22:25], v[200:203]
    s_waitcnt lgkmcnt(1)
    v_cvt_pk_bf16_f32 v137, v138, v139
    ds_write2st64_b64 v92, v[212:213], v[108:109] offset0:24 offset1:36
    buffer_store_dwordx4 v[68:71], v6, s[16:19], s85 offen offset:0 nt
    ds_write2st64_b64 v93, v[216:217], v[52:53] offset0:24 offset1:36
    v_pk_mul_f32 v[254:255], v[254:255], v[50:51] op_sel_hi:[1,0]
    v_pk_mul_f32 v[182:183], v[182:183], v[102:103] op_sel_hi:[1,0]
    v_pk_mul_f32 v[224:225], v[224:225], v[50:51] op_sel_hi:[1,0]
    v_accvgpr_read_b32 v53, a57
    v_accvgpr_read_b32 v108, a52
    v_mfma_f32_16x16x32_bf16 v[152:155], a[228:231], v[16:19], v[152:155]
    ds_write2st64_b64 v94, v[220:221], v[56:57] offset0:24 offset1:36
    v_cvt_pk_bf16_f32 v236, v236, v237
    v_accvgpr_read_b32 v55, a59
    v_accvgpr_read_b32 v52, a56
    v_pk_mul_f32 v[228:229], v[228:229], v[50:51] op_sel_hi:[1,0]
    v_cvt_pk_bf16_f32 v141, v142, v143
    ds_read_b128 v[76:79], v103 offset:12288
    v_accvgpr_read_b32 v57, a61
    v_pk_mul_f32 v[132:133], v[132:133], v[48:49] op_sel_hi:[1,0]
    buffer_store_dwordx4 v[72:75], v7, s[16:19], s85 offen offset:0 nt
    v_accvgpr_read_b32 v105, a49
    v_pk_mul_f32 v[244:245], v[244:245], v[50:51] op_sel_hi:[1,0]
    v_pk_mul_f32 v[238:239], v[238:239], v[50:51] op_sel_hi:[1,0]
    v_pk_mul_f32 v[234:235], v[234:235], v[50:51] op_sel_hi:[1,0]
    v_cvt_pk_bf16_f32 v224, v224, v225
    v_pk_mul_f32 v[58:59], v[58:59], v[100:101] op_sel_hi:[1,0]
    v_pk_mul_f32 v[198:199], v[198:199], v[102:103] op_sel_hi:[1,0]
    v_cvt_pk_bf16_f32 v180, v180, v181
    v_pk_mul_f32 v[230:231], v[230:231], v[50:51] op_sel_hi:[1,0]
    v_accvgpr_read_b32 v109, a53
    v_pk_mul_f32 v[52:53], v[52:53], v[100:101] op_sel_hi:[1,0]
    v_cvt_pk_bf16_f32 v129, v130, v131
    v_pk_mul_f32 v[190:191], v[190:191], v[102:103] op_sel_hi:[1,0]
    ds_read_b128 v[80:83], v103 offset:13312
    v_pk_mul_f32 v[108:109], v[108:109], v[100:101] op_sel_hi:[1,0]
    ds_read_b128 v[84:87], v103 offset:18432
    v_pk_mul_f32 v[232:233], v[232:233], v[50:51] op_sel_hi:[1,0]
    v_pk_mul_f32 v[104:105], v[104:105], v[100:101] op_sel_hi:[1,0]
    ds_read_b128 v[88:91], v103 offset:19456
    v_pk_mul_f32 v[54:55], v[54:55], v[100:101] op_sel_hi:[1,0]
    v_accvgpr_read_b32 v110, a54
    v_accvgpr_read_b32 v106, a50
    v_mfma_f32_16x16x32_bf16 v[156:159], a[232:235], v[16:19], v[156:159]
    s_waitcnt lgkmcnt(3)
    buffer_store_dwordx4 v[76:79], v6, s[16:19], s86 offen offset:0 nt
    v_pk_mul_f32 v[176:177], v[176:177], v[102:103] op_sel_hi:[1,0]
    v_accvgpr_read_b32 v111, a55
    v_accvgpr_read_b32 v107, a51
    v_cvt_pk_bf16_f32 v52, v52, v53
    v_cvt_pk_bf16_f32 v132, v132, v133
    v_pk_mul_f32 v[250:251], v[250:251], v[50:51] op_sel_hi:[1,0]
    v_cvt_pk_bf16_f32 v104, v104, v105
    v_cvt_pk_bf16_f32 v53, v54, v55
    v_accvgpr_read_b32 v56, a60
    v_pk_mul_f32 v[110:111], v[110:111], v[100:101] op_sel_hi:[1,0]
    v_pk_mul_f32 v[56:57], v[56:57], v[100:101] op_sel_hi:[1,0]
    v_cvt_pk_bf16_f32 v108, v108, v109
    v_pk_mul_f32 v[194:195], v[194:195], v[102:103] op_sel_hi:[1,0]
    v_cvt_pk_bf16_f32 v109, v110, v111
    v_cvt_pk_bf16_f32 v148, v148, v149
    v_pk_mul_f32 v[152:153], v[152:153], v[48:49] op_sel_hi:[1,0]
    v_cvt_pk_bf16_f32 v56, v56, v57
    v_cvt_pk_bf16_f32 v57, v58, v59
    v_pk_mul_f32 v[192:193], v[192:193], v[102:103] op_sel_hi:[1,0]
    v_pk_mul_f32 v[186:187], v[186:187], v[102:103] op_sel_hi:[1,0]
    v_pk_mul_f32 v[134:135], v[134:135], v[48:49] op_sel_hi:[1,0]
    v_pk_mul_f32 v[156:157], v[156:157], v[48:49] op_sel_hi:[1,0]
    v_pk_mul_f32 v[106:107], v[106:107], v[100:101] op_sel_hi:[1,0]
    v_pk_mul_f32 v[200:201], v[200:201], v[102:103] op_sel_hi:[1,0]
    s_waitcnt lgkmcnt(1)
    buffer_store_dwordx4 v[80:83], v7, s[16:19], s86 offen offset:0 nt
    v_cvt_pk_bf16_f32 v105, v106, v107
    v_pk_mul_f32 v[184:185], v[184:185], v[102:103] op_sel_hi:[1,0]
    v_cvt_pk_bf16_f32 v181, v182, v183
    v_accvgpr_read_b32 v59, a31
    v_pk_mul_f32 v[154:155], v[154:155], v[48:49] op_sel_hi:[1,0]
    ds_write_b64 v101, v[104:105] offset:24576
    v_cvt_pk_bf16_f32 v192, v192, v193
    v_accvgpr_read_b32 v107, a19
    ds_write_b64 v92, v[108:109] offset:24576
    v_cvt_pk_bf16_f32 v156, v156, v157
    v_pk_mul_f32 v[246:247], v[246:247], v[50:51] op_sel_hi:[1,0]
    v_accvgpr_read_b32 v54, a26
    v_pk_mul_f32 v[144:145], v[144:145], v[48:49] op_sel_hi:[1,0]
    v_cvt_pk_bf16_f32 v237, v238, v239
    v_accvgpr_read_b32 v106, a18
    v_cvt_pk_bf16_f32 v176, v176, v177
    v_pk_mul_f32 v[178:179], v[178:179], v[102:103] op_sel_hi:[1,0]
    v_accvgpr_read_b32 v109, a21
    v_cvt_pk_bf16_f32 v244, v244, v245
    v_cvt_pk_bf16_f32 v228, v228, v229
    buffer_store_dwordx4 v[84:87], v6, s[16:19], s87 offen offset:0 nt
    ds_write_b64 v93, v[52:53] offset:24576
    v_pk_mul_f32 v[204:205], v[204:205], v[102:103] op_sel_hi:[1,0]
    v_cvt_pk_bf16_f32 v177, v178, v179
    v_accvgpr_read_b32 v52, a24
    v_cvt_pk_bf16_f32 v232, v232, v233
    v_pk_mul_f32 v[248:249], v[248:249], v[50:51] op_sel_hi:[1,0]
    ds_write_b64 v94, v[56:57] offset:24576
    ds_read_b128 v[60:63], v103 offset:24576
    ds_read_b128 v[64:67], v103 offset:25600
    v_accvgpr_read_b32 v58, a30
    v_accvgpr_read_b32 v57, a29
    s_waitcnt lgkmcnt(4)
    buffer_store_dwordx4 v[88:91], v7, s[16:19], s87 offen offset:0 nt
    v_accvgpr_read_b32 v111, a23
    v_pk_mul_f32 v[252:253], v[252:253], v[50:51] op_sel_hi:[1,0]
    v_cvt_pk_bf16_f32 v152, v152, v153
    v_accvgpr_read_b32 v56, a28
    v_cvt_pk_bf16_f32 v189, v190, v191
    v_cvt_pk_bf16_f32 v184, v184, v185
    v_cvt_pk_bf16_f32 v133, v134, v135
    v_accvgpr_read_b32 v105, a17
    v_pk_mul_f32 v[106:107], v[106:107], v[8:9] op_sel_hi:[1,0]
    ds_write2st64_b64 v101, v[128:129], v[176:177] offset0:4 offset1:16
    v_pk_mul_f32 v[58:59], v[58:59], v[8:9] op_sel_hi:[1,0]
    v_cvt_pk_bf16_f32 v252, v252, v253
    v_cvt_pk_bf16_f32 v225, v226, v227
    v_cvt_pk_bf16_f32 v204, v204, v205
    ds_write2st64_b64 v92, v[132:133], v[180:181] offset0:4 offset1:16
    v_accvgpr_read_b32 v110, a22
    v_cvt_pk_bf16_f32 v185, v186, v187
    s_waitcnt lgkmcnt(2)
    buffer_store_dwordx4 v[60:63], v6, s[16:19], s88 offen offset:0 nt
    v_accvgpr_read_b32 v53, a25
    v_pk_mul_f32 v[56:57], v[56:57], v[8:9] op_sel_hi:[1,0]
    v_pk_mul_f32 v[196:197], v[196:197], v[102:103] op_sel_hi:[1,0]
    ds_write2st64_b64 v93, v[136:137], v[184:185] offset0:4 offset1:16
    v_pk_mul_f32 v[206:207], v[206:207], v[102:103] op_sel_hi:[1,0]
    ds_write2st64_b64 v94, v[140:141], v[188:189] offset0:4 offset1:16
    v_accvgpr_read_b32 v104, a16
    v_pk_mul_f32 v[104:105], v[104:105], v[8:9] op_sel_hi:[1,0]
    v_accvgpr_read_b32 v55, a27
    v_cvt_pk_bf16_f32 v104, v104, v105
    v_cvt_pk_bf16_f32 v233, v234, v235
    ds_read_b128 v[68:71], v103 offset:2048
    buffer_store_dwordx4 v[64:67], v7, s[16:19], s88 offen offset:0 nt
    ds_read_b128 v[72:75], v103 offset:3072
    v_cvt_pk_bf16_f32 v248, v248, v249
    v_cvt_pk_bf16_f32 v105, v106, v107
    v_cvt_pk_bf16_f32 v56, v56, v57
    v_pk_mul_f32 v[110:111], v[110:111], v[8:9] op_sel_hi:[1,0]
    v_cvt_pk_bf16_f32 v229, v230, v231
    v_pk_mul_f32 v[52:53], v[52:53], v[8:9] op_sel_hi:[1,0]
    ds_read_b128 v[76:79], v103 offset:8192
    v_cvt_pk_bf16_f32 v196, v196, v197
    v_accvgpr_read_b32 v106, a66
    ds_read_b128 v[80:83], v103 offset:9216
    v_accvgpr_read_b32 v108, a20
    v_pk_mul_f32 v[108:109], v[108:109], v[8:9] op_sel_hi:[1,0]
    ds_write2st64_b64 v101, v[224:225], v[104:105] offset0:28 offset1:40
    v_pk_mul_f32 v[54:55], v[54:55], v[8:9] op_sel_hi:[1,0]
    v_cvt_pk_bf16_f32 v108, v108, v109
    v_accvgpr_read_b32 v107, a67
    v_accvgpr_read_b32 v105, a65
    s_waitcnt lgkmcnt(4)
    buffer_store_dwordx4 v[68:71], v6, s[16:19], s84 offen offset:128 nt
    v_cvt_pk_bf16_f32 v52, v52, v53
    v_cvt_pk_bf16_f32 v144, v144, v145
    v_cvt_pk_bf16_f32 v57, v58, v59
    v_cvt_pk_bf16_f32 v53, v54, v55
    v_pk_mul_f32 v[242:243], v[242:243], v[50:51] op_sel_hi:[1,0]
    v_accvgpr_read_b32 v104, a64
    v_pk_mul_f32 v[104:105], v[104:105], v[100:101] op_sel_hi:[1,0]
    v_cvt_pk_bf16_f32 v109, v110, v111
    ds_write2st64_b64 v92, v[228:229], v[108:109] offset0:28 offset1:40
    v_accvgpr_read_b32 v108, a68
    s_waitcnt lgkmcnt(3)
    buffer_store_dwordx4 v[72:75], v7, s[16:19], s84 offen offset:128 nt
    v_accvgpr_read_b32 v109, a69
    ds_write2st64_b64 v93, v[232:233], v[52:53] offset0:28 offset1:40
    v_pk_mul_f32 v[202:203], v[202:203], v[102:103] op_sel_hi:[1,0]
    v_accvgpr_read_b32 v110, a70
    v_cvt_pk_bf16_f32 v193, v194, v195
    v_accvgpr_read_b32 v111, a71
    ds_write2st64_b64 v94, v[236:237], v[56:57] offset0:28 offset1:40
    v_pk_mul_f32 v[108:109], v[108:109], v[100:101] op_sel_hi:[1,0]
    ds_read_b128 v[84:87], v103 offset:14336
    v_accvgpr_read_b32 v53, a73
    v_accvgpr_read_b32 v59, a79
    v_pk_mul_f32 v[110:111], v[110:111], v[100:101] op_sel_hi:[1,0]
    v_accvgpr_read_b32 v57, a77
    v_accvgpr_read_b32 v54, a74
    buffer_store_dwordx4 v[76:79], v6, s[16:19], s85 offen offset:128 nt
    v_accvgpr_read_b32 v55, a75
    ds_read_b128 v[88:91], v103 offset:15360
    v_cvt_pk_bf16_f32 v108, v108, v109
    s_waitcnt lgkmcnt(4)
    buffer_store_dwordx4 v[80:83], v7, s[16:19], s85 offen offset:128 nt
    v_accvgpr_read_b32 v58, a78
    v_accvgpr_read_b32 v52, a72
    v_pk_mul_f32 v[58:59], v[58:59], v[100:101] op_sel_hi:[1,0]
    v_pk_mul_f32 v[54:55], v[54:55], v[100:101] op_sel_hi:[1,0]
    v_cvt_pk_bf16_f32 v109, v110, v111
    v_pk_mul_f32 v[146:147], v[146:147], v[48:49] op_sel_hi:[1,0]
    ds_read_b128 v[60:63], v103 offset:20480
    v_accvgpr_read_b32 v56, a76
    s_waitcnt lgkmcnt(1)
    buffer_store_dwordx4 v[84:87], v6, s[16:19], s86 offen offset:128 nt
    v_pk_mul_f32 v[52:53], v[52:53], v[100:101] op_sel_hi:[1,0]
    v_cvt_pk_bf16_f32 v249, v250, v251
    v_pk_mul_f32 v[106:107], v[106:107], v[100:101] op_sel_hi:[1,0]
    v_cvt_pk_bf16_f32 v200, v200, v201
    v_pk_mul_f32 v[56:57], v[56:57], v[100:101] op_sel_hi:[1,0]
    s_nop 0
    v_cvt_pk_bf16_f32 v56, v56, v57
    v_cvt_pk_bf16_f32 v52, v52, v53
    v_cvt_pk_bf16_f32 v104, v104, v105
    v_cvt_pk_bf16_f32 v197, v198, v199
    ds_read_b128 v[64:67], v103 offset:21504
    v_cvt_pk_bf16_f32 v205, v206, v207
    v_pk_mul_f32 v[158:159], v[158:159], v[48:49] op_sel_hi:[1,0]
    v_cvt_pk_bf16_f32 v105, v106, v107
    v_cvt_pk_bf16_f32 v149, v150, v151
    v_cvt_pk_bf16_f32 v240, v240, v241
    ds_write_b64 v101, v[104:105] offset:26624
    v_cvt_pk_bf16_f32 v53, v54, v55
    buffer_store_dwordx4 v[88:91], v7, s[16:19], s86 offen offset:128 nt
    v_accvgpr_read_b32 v111, a39
    ds_write_b64 v92, v[108:109] offset:26624
    v_accvgpr_read_b32 v105, a33
    ds_write_b64 v93, v[52:53] offset:26624
    v_accvgpr_read_b32 v106, a34
    v_cvt_pk_bf16_f32 v57, v58, v59
    v_cvt_pk_bf16_f32 v157, v158, v159
    v_accvgpr_read_b32 v52, a40
    v_cvt_pk_bf16_f32 v145, v146, v147
    v_cvt_pk_bf16_f32 v253, v254, v255
    v_accvgpr_read_b32 v59, a47
    v_cvt_pk_bf16_f32 v241, v242, v243
    v_accvgpr_read_b32 v110, a38
    v_accvgpr_read_b32 v104, a32
    ds_write_b64 v94, v[56:57] offset:26624
    s_waitcnt lgkmcnt(3)
    buffer_store_dwordx4 v[60:63], v6, s[16:19], s87 offen offset:128 nt
    v_accvgpr_read_b32 v109, a37
    v_accvgpr_read_b32 v55, a43
    v_accvgpr_read_b32 v107, a35
    v_accvgpr_read_b32 v54, a42
    v_accvgpr_read_b32 v57, a45
    v_accvgpr_read_b32 v108, a36
    ds_read_b128 v[68:71], v103 offset:26624
    v_pk_mul_f32 v[110:111], v[110:111], v[8:9] op_sel_hi:[1,0]
    v_cvt_pk_bf16_f32 v153, v154, v155
    ds_read_b128 v[72:75], v103 offset:27648
    v_accvgpr_read_b32 v58, a46
    ds_write2st64_b64 v101, v[144:145], v[192:193] offset0:8 offset1:20
    buffer_store_dwordx4 v[64:67], v7, s[16:19], s87 offen offset:128 nt
    v_accvgpr_read_b32 v53, a41
    v_pk_mul_f32 v[108:109], v[108:109], v[8:9] op_sel_hi:[1,0]
    v_pk_mul_f32 v[106:107], v[106:107], v[8:9] op_sel_hi:[1,0]
    v_cvt_pk_bf16_f32 v201, v202, v203
    ds_write2st64_b64 v92, v[148:149], v[196:197] offset0:8 offset1:20
    v_cvt_pk_bf16_f32 v108, v108, v109
    v_accvgpr_read_b32 v56, a44
    v_cvt_pk_bf16_f32 v245, v246, v247
    v_pk_mul_f32 v[104:105], v[104:105], v[8:9] op_sel_hi:[1,0]
    ds_write2st64_b64 v93, v[152:153], v[200:201] offset0:8 offset1:20
    ds_write2st64_b64 v94, v[156:157], v[204:205] offset0:8 offset1:20
    ds_read_b128 v[76:79], v103 offset:4096
    v_pk_mul_f32 v[56:57], v[56:57], v[8:9] op_sel_hi:[1,0]
    s_waitcnt lgkmcnt(4)
    buffer_store_dwordx4 v[68:71], v6, s[16:19], s88 offen offset:128 nt
    v_pk_mul_f32 v[52:53], v[52:53], v[8:9] op_sel_hi:[1,0]
    s_nop 0
    v_cvt_pk_bf16_f32 v52, v52, v53
    v_cvt_pk_bf16_f32 v104, v104, v105
    v_pk_mul_f32 v[54:55], v[54:55], v[8:9] op_sel_hi:[1,0]
    v_cvt_pk_bf16_f32 v56, v56, v57
    ds_read_b128 v[80:83], v103 offset:5120
    v_cvt_pk_bf16_f32 v105, v106, v107
    ds_read_b128 v[84:87], v103 offset:10240
    buffer_store_dwordx4 v[72:75], v7, s[16:19], s88 offen offset:128 nt
    v_cvt_pk_bf16_f32 v109, v110, v111
    ds_read_b128 v[88:91], v103 offset:11264
    ds_write2st64_b64 v101, v[240:241], v[104:105] offset0:32 offset1:44
    v_cvt_pk_bf16_f32 v53, v54, v55
    v_accvgpr_read_b32 v54, a90
    ds_write2st64_b64 v92, v[244:245], v[108:109] offset0:32 offset1:44
    v_pk_mul_f32 v[58:59], v[58:59], v[8:9] op_sel_hi:[1,0]
    v_accvgpr_read_b32 v111, a87
    ds_write2st64_b64 v93, v[248:249], v[52:53] offset0:32 offset1:44
    v_accvgpr_read_b32 v105, a81
    v_cvt_pk_bf16_f32 v57, v58, v59
    s_waitcnt lgkmcnt(4)
    buffer_store_dwordx4 v[76:79], v6, s[16:19], s84 offen offset:256 nt
    ds_write2st64_b64 v94, v[252:253], v[56:57] offset0:32 offset1:44
    buffer_store_dwordx4 v[80:83], v7, s[16:19], s84 offen offset:256 nt
    v_accvgpr_read_b32 v52, a88
    v_accvgpr_read_b32 v53, a89
    v_accvgpr_read_b32 v104, a80
    v_accvgpr_read_b32 v55, a91
    v_accvgpr_read_b32 v107, a83
    v_accvgpr_read_b32 v106, a82
    v_pk_mul_f32 v[52:53], v[52:53], v[100:101] op_sel_hi:[1,0]
    ds_read_b128 v[60:63], v103 offset:16384
    v_accvgpr_read_b32 v56, a92
    v_accvgpr_read_b32 v57, a93
    ds_read_b128 v[64:67], v103 offset:17408
    buffer_store_dwordx4 v[84:87], v6, s[16:19], s85 offen offset:256 nt
    ds_read_b128 v[68:71], v103 offset:22528
    v_pk_mul_f32 v[104:105], v[104:105], v[100:101] op_sel_hi:[1,0]
    v_accvgpr_read_b32 v109, a85
    v_pk_mul_f32 v[106:107], v[106:107], v[100:101] op_sel_hi:[1,0]
    v_accvgpr_read_b32 v108, a84
    s_waitcnt lgkmcnt(3)
    buffer_store_dwordx4 v[88:91], v7, s[16:19], s85 offen offset:256 nt
    v_pk_mul_f32 v[56:57], v[56:57], v[100:101] op_sel_hi:[1,0]
    v_accvgpr_read_b32 v110, a86
    v_cvt_pk_bf16_f32 v52, v52, v53
    v_cvt_pk_bf16_f32 v56, v56, v57
    v_pk_mul_f32 v[110:111], v[110:111], v[100:101] op_sel_hi:[1,0]
    s_waitcnt lgkmcnt(0)
    buffer_store_dwordx4 v[60:63], v6, s[16:19], s86 offen offset:256 nt
    v_cvt_pk_bf16_f32 v104, v104, v105
    v_pk_mul_f32 v[108:109], v[108:109], v[100:101] op_sel_hi:[1,0]
    v_accvgpr_read_b32 v59, a95
    v_accvgpr_read_b32 v58, a94
    v_cvt_pk_bf16_f32 v108, v108, v109
    v_pk_mul_f32 v[58:59], v[58:59], v[100:101] op_sel_hi:[1,0]
    v_cvt_pk_bf16_f32 v105, v106, v107
    ds_read_b128 v[72:75], v103 offset:23552
    ds_write_b64 v101, v[104:105] offset:0
    buffer_store_dwordx4 v[64:67], v7, s[16:19], s86 offen offset:256 nt
    v_cvt_pk_bf16_f32 v109, v110, v111
    v_pk_mul_f32 v[54:55], v[54:55], v[100:101] op_sel_hi:[1,0]
    buffer_store_dwordx4 v[68:71], v6, s[16:19], s87 offen offset:256 nt
    v_cvt_pk_bf16_f32 v53, v54, v55
    ds_write_b64 v92, v[108:109] offset:0
    ds_write_b64 v93, v[52:53] offset:0
    v_cvt_pk_bf16_f32 v57, v58, v59
    ds_write_b64 v94, v[56:57] offset:0
    ds_read_b128 v[76:79], v103 offset:0
    ds_read_b128 v[80:83], v103 offset:1024
    s_waitcnt lgkmcnt(5)
    buffer_store_dwordx4 v[72:75], v7, s[16:19], s87 offen offset:256 nt
    s_waitcnt lgkmcnt(1)
    buffer_store_dwordx4 v[76:79], v6, s[16:19], s88 offen offset:256 nt
    s_waitcnt lgkmcnt(0)
    buffer_store_dwordx4 v[80:83], v7, s[16:19], s88 offen offset:256 nt
    s_branch L_fin
L_end4:
    v_mfma_f32_16x16x32_bf16 v[112:115], a[212:215], v[16:19], v[112:115]
    v_fma_f32 v79, v79, s28, v12
    v_fma_f32 v71, v71, s28, v11
    v_fma_f32 v74, v74, s28, v11
    v_mfma_f32_16x16x32_bf16 v[160:163], a[212:215], v[22:25], v[160:163]
    v_exp_f32 v71, v71
    v_mfma_f32_16x16x32_bf16 v[208:211], a[212:215], v[28:31], v[208:211]
    ds_read_b64_tr_b16 a[228:229], v2 offset:19456
    v_fma_f32 v65, v65, s28, v10
    v_mfma_f32_16x16x32_bf16 a[0:3], a[212:215], v[34:37], a[0:3]
    ds_read_b64_tr_b16 a[230:231], v2 offset:13312
    s_waitcnt lgkmcnt(6)
    v_mfma_f32_16x16x32_bf16 a[4:7], a[216:219], v[34:37], a[4:7]
    ds_read_b64_tr_b16 a[234:235], v3 offset:13312
    v_mfma_f32_16x16x32_bf16 v[212:215], a[216:219], v[28:31], v[212:215]
    ds_read_b64_tr_b16 a[232:233], v3 offset:19456
    v_mfma_f32_16x16x32_bf16 v[164:167], a[216:219], v[22:25], v[164:167]
    ds_read_b128 v[88:91], v103 offset:0
    v_mfma_f32_16x16x32_bf16 v[116:119], a[216:219], v[16:19], v[116:119]
    v_fma_f32 v66, v66, s28, v10
    s_waitcnt lgkmcnt(7)
    v_mfma_f32_16x16x32_bf16 v[120:123], a[220:223], v[16:19], v[120:123]
    v_exp_f32 v79, v79
    v_mfma_f32_16x16x32_bf16 v[168:171], a[220:223], v[22:25], v[168:171]
    ds_read_b64_tr_b16 a[218:219], v5 offset:13312
    v_fma_f32 v57, v57, s28, v9
    v_mfma_f32_16x16x32_bf16 v[216:219], a[220:223], v[28:31], v[216:219]
    ds_read_b64_tr_b16 a[214:215], v4 offset:13312
    v_fma_f32 v69, v69, s28, v11
    v_mfma_f32_16x16x32_bf16 a[8:11], a[220:223], v[34:37], a[8:11]
    s_waitcnt lgkmcnt(7)
    ds_read_b64_tr_b16 a[212:213], v4 offset:19456
    v_fma_f32 v82, v82, s28, v12
    v_mfma_f32_16x16x32_bf16 a[12:15], a[224:227], v[34:37], a[12:15]
    ds_read_b64_tr_b16 a[222:223], v2 offset:14336
    v_fma_f32 v73, v73, s28, v11
    v_mfma_f32_16x16x32_bf16 v[220:223], a[224:227], v[28:31], v[220:223]
    v_fma_f32 v62, v62, s28, v10
    v_fma_f32 v77, v77, s28, v12
    v_mfma_f32_16x16x32_bf16 v[172:175], a[224:227], v[22:25], v[172:175]
    s_add_u32 s39, s39, 12288
    ds_read_b64_tr_b16 a[216:217], v5 offset:19456
    v_fma_f32 v75, v75, s28, v11
    v_mfma_f32_16x16x32_bf16 v[124:127], a[224:227], v[16:19], v[124:127]
    s_waitcnt lgkmcnt(6)
    ds_read_b64_tr_b16 a[224:225], v3 offset:20480
    v_fma_f32 v56, v56, s28, v9
    v_mfma_f32_16x16x32_bf16 v[128:131], a[228:231], v[16:19], v[128:131]
    ds_read_b64_tr_b16 a[220:221], v2 offset:20480
    v_fma_f32 v81, v81, s28, v12
    v_mfma_f32_16x16x32_bf16 v[176:179], a[228:231], v[22:25], v[176:179]
    v_fma_f32 v67, v67, s28, v10
    v_fma_f32 v76, v76, s28, v12
    v_mfma_f32_16x16x32_bf16 v[224:227], a[228:231], v[28:31], v[224:227]
    ds_read_b64_tr_b16 a[226:227], v3 offset:14336
    v_fma_f32 v63, v63, s28, v10
    v_mfma_f32_16x16x32_bf16 a[16:19], a[228:231], v[34:37], a[16:19]
    v_exp_f32 v77, v77
    v_mfma_f32_16x16x32_bf16 a[20:23], a[232:235], v[34:37], a[20:23]
    ds_read_b64_tr_b16 a[228:229], v4 offset:20480
    v_fma_f32 v70, v70, s28, v11
    v_mfma_f32_16x16x32_bf16 v[228:231], a[232:235], v[28:31], v[228:231]
    ds_read_b64_tr_b16 a[230:231], v4 offset:14336
    v_fma_f32 v83, v83, s28, v12
    v_mfma_f32_16x16x32_bf16 v[180:183], a[232:235], v[22:25], v[180:183]
    v_fma_f32 v80, v80, s28, v12
    v_fma_f32 v59, v59, s28, v9
    v_mfma_f32_16x16x32_bf16 v[132:135], a[232:235], v[16:19], v[132:135]
    s_waitcnt lgkmcnt(6)
    ds_read_b64_tr_b16 a[234:235], v5 offset:14336
    v_fma_f32 v58, v58, s28, v9
    v_mfma_f32_16x16x32_bf16 v[136:139], a[212:215], v[16:19], v[136:139]
    ds_read_b64_tr_b16 a[232:233], v5 offset:20480
    v_fma_f32 v68, v68, s28, v11
    v_mfma_f32_16x16x32_bf16 v[184:187], a[212:215], v[22:25], v[184:187]
    v_exp_f32 v69, v69
    v_mfma_f32_16x16x32_bf16 v[232:235], a[212:215], v[28:31], v[232:235]
    v_exp_f32 v65, v65
    v_mfma_f32_16x16x32_bf16 a[24:27], a[212:215], v[34:37], a[24:27]
    s_waitcnt lgkmcnt(5)
    v_exp_f32 v70, v70
    v_mfma_f32_16x16x32_bf16 a[28:31], a[216:219], v[34:37], a[28:31]
    v_exp_f32 v81, v81
    v_mfma_f32_16x16x32_bf16 v[236:239], a[216:219], v[28:31], v[236:239]
    v_exp_f32 v63, v63
    v_mfma_f32_16x16x32_bf16 v[188:191], a[216:219], v[22:25], v[188:191]
    v_fma_f32 v78, v78, s28, v12
    v_cvt_pk_bf16_f32 v27, v70, v71
    v_mfma_f32_16x16x32_bf16 v[140:143], a[216:219], v[16:19], v[140:143]
    v_exp_f32 v78, v78
    v_mfma_f32_16x16x32_bf16 v[144:147], a[220:223], v[16:19], v[144:147]
    v_exp_f32 v68, v68
    v_mfma_f32_16x16x32_bf16 v[192:195], a[220:223], v[22:25], v[192:195]
    v_exp_f32 v66, v66
    v_mfma_f32_16x16x32_bf16 v[240:243], a[220:223], v[28:31], v[240:243]
    s_waitcnt vmcnt(10) lgkmcnt(0)
    v_fma_f32 v64, v64, s28, v10
    s_add_u32 m0, s22, 36864
    v_mfma_f32_16x16x32_bf16 a[32:35], a[220:223], v[34:37], a[32:35]
    s_barrier
    v_mfma_f32_16x16x32_bf16 a[36:39], a[224:227], v[34:37], a[36:39]
    ds_read_b128 a[216:219], v1 offset:12288
    v_mfma_f32_16x16x32_bf16 v[244:247], a[224:227], v[28:31], v[244:247]
    buffer_load_dwordx4 v6, s[8:11], s21 offen lds
    v_mfma_f32_16x16x32_bf16 v[196:199], a[224:227], v[22:25], v[196:199]
    s_add_u32 s21, s21, 128
    ds_read_b128 a[220:223], v0 offset:13312
    v_mfma_f32_16x16x32_bf16 v[148:151], a[224:227], v[16:19], v[148:151]
    ds_read_b128 a[212:215], v0 offset:12288
    v_mfma_f32_16x16x32_bf16 v[152:155], a[228:231], v[16:19], v[152:155]
    s_add_u32 m0, s22, 37888
    v_exp_f32 v80, v80
    v_mfma_f32_16x16x32_bf16 v[200:203], a[228:231], v[22:25], v[200:203]
    ds_read_b128 v[96:99], v103 offset:1024
    v_fma_f32 v72, v72, s28, v11
    v_mfma_f32_16x16x32_bf16 v[248:251], a[228:231], v[28:31], v[248:251]
    v_exp_f32 v74, v74
    v_mfma_f32_16x16x32_bf16 a[40:43], a[228:231], v[34:37], a[40:43]
    buffer_load_dwordx4 v6, s[8:11], s21 offen lds
    v_mfma_f32_16x16x32_bf16 a[44:47], a[232:235], v[34:37], a[44:47]
    s_add_u32 s21, s21, 128
    s_add_u32 m0, s22, 38912
    ds_read_b128 a[224:227], v1 offset:13312
    v_mfma_f32_16x16x32_bf16 v[252:255], a[232:235], v[28:31], v[252:255]
    buffer_load_dwordx4 v6, s[8:11], s21 offen lds
    v_mfma_f32_16x16x32_bf16 v[204:207], a[232:235], v[22:25], v[204:207]
    v_exp_f32 v62, v62
    v_mfma_f32_16x16x32_bf16 v[156:159], a[232:235], v[16:19], v[156:159]
    buffer_store_dwordx4 v[88:91], v6, s[16:19], s24 offen offset:0 nt
    s_nop 0
    ds_read_b128 v[88:91], v103 offset:3072
    s_waitcnt lgkmcnt(3)
    v_mfma_f32_16x16x32_bf16 v[52:55], a[212:215], a[96:99], 0
    ds_read_b128 a[228:231], v0 offset:14336
    v_cvt_pk_bf16_f32 v21, v62, v63
    v_mfma_f32_16x16x32_bf16 v[52:55], a[216:219], a[100:103], v[52:55]
    ds_read_b128 a[232:235], v1 offset:14336
    v_cvt_pk_bf16_f32 v33, v78, v79
    v_mfma_f32_16x16x32_bf16 v[52:55], a[220:223], a[104:107], v[52:55]
    v_exp_f32 v76, v76
    v_mfma_f32_16x16x32_bf16 v[60:63], a[220:223], a[128:131], 0
    v_cvt_pk_bf16_f32 v26, v68, v69
    v_cvt_pk_bf16_f32 v32, v76, v77
    v_mfma_f32_16x16x32_bf16 v[60:63], a[216:219], a[124:127], v[60:63]
    v_exp_f32 v57, v57
    v_mfma_f32_16x16x32_bf16 v[60:63], a[212:215], a[120:123], v[60:63]
    v_exp_f32 v82, v82
    v_mfma_f32_16x16x32_bf16 v[68:71], a[212:215], a[144:147], 0
    v_exp_f32 v75, v75
    v_mfma_f32_16x16x32_bf16 v[68:71], a[216:219], a[148:151], v[68:71]
    v_exp_f32 v58, v58
    v_mfma_f32_16x16x32_bf16 v[68:71], a[220:223], a[152:155], v[68:71]
    v_cvt_pk_bf16_f32 v34, v80, v81
    v_cvt_pk_bf16_f32 v29, v74, v75
    v_mfma_f32_16x16x32_bf16 v[76:79], a[220:223], a[176:179], 0
    s_add_u32 s21, s21, 12032
    v_exp_f32 v64, v64
    v_mfma_f32_16x16x32_bf16 v[76:79], a[216:219], a[172:175], v[76:79]
    v_exp_f32 v56, v56
    v_mfma_f32_16x16x32_bf16 v[76:79], a[212:215], a[168:171], v[76:79]
    s_waitcnt lgkmcnt(0)
    v_exp_f32 v72, v72
    v_mfma_f32_16x16x32_bf16 v[76:79], a[224:227], a[180:183], v[76:79]
    v_exp_f32 v67, v67
    v_mfma_f32_16x16x32_bf16 v[76:79], a[228:231], a[184:187], v[76:79]
    v_cvt_pk_bf16_f32 v22, v64, v65
    v_mfma_f32_16x16x32_bf16 v[76:79], a[232:235], a[188:191], v[76:79]
    v_exp_f32 v59, v59
    v_mfma_f32_16x16x32_bf16 v[68:71], a[232:235], a[164:167], v[68:71]
    v_cvt_pk_bf16_f32 v23, v66, v67
    v_cvt_pk_bf16_f32 v17, v58, v59
    v_mfma_f32_16x16x32_bf16 v[68:71], a[228:231], a[160:163], v[68:71]
    ds_read_b128 a[212:215], v0 offset:18432
    v_cvt_pk_bf16_f32 v16, v56, v57
    v_mfma_f32_16x16x32_bf16 v[68:71], a[224:227], a[156:159], v[68:71]
    ds_read_b128 a[216:219], v1 offset:18432
    v_mfma_f32_16x16x32_bf16 v[60:63], a[224:227], a[132:135], v[60:63]
    ds_read_b128 a[220:223], v0 offset:19456
    v_mfma_f32_16x16x32_bf16 v[60:63], a[228:231], a[136:139], v[60:63]
    ds_read_b128 v[84:87], v103 offset:2048
    v_mfma_f32_16x16x32_bf16 v[44:47], a[236:239], v[14:17], v[48:51]
    s_add_u32 s57, s24, 128
    v_exp_f32 v73, v73
    v_mfma_f32_16x16x32_bf16 v[60:63], a[232:235], a[140:143], v[60:63]
    v_exp_f32 v83, v83
    v_mfma_f32_16x16x32_bf16 v[52:55], a[232:235], a[116:119], v[52:55]
    v_mfma_f32_16x16x32_bf16 v[44:47], a[240:243], v[20:23], v[44:47]
    v_mfma_f32_16x16x32_bf16 v[52:55], a[228:231], a[112:115], v[52:55]
    v_cvt_pk_bf16_f32 v28, v72, v73
    v_cvt_pk_bf16_f32 v35, v82, v83
    v_mfma_f32_16x16x32_bf16 v[52:55], a[224:227], a[108:111], v[52:55]
    ds_read_b128 a[224:227], v1 offset:19456
    v_mfma_f32_16x16x32_bf16 v[44:47], a[244:247], v[26:29], v[44:47]
    ds_read_b128 a[232:235], v1 offset:20480
    v_mfma_f32_16x16x32_bf16 v[44:47], a[248:251], v[32:35], v[44:47]
    s_waitcnt lgkmcnt(4)
    ds_read_b128 a[228:231], v0 offset:20480
    v_mfma_f32_16x16x32_bf16 v[56:59], a[212:215], a[96:99], 0
    buffer_store_dwordx4 v[96:99], v7, s[16:19], s24 offen offset:0 nt
    s_nop 3
    v_cmp_lt_f32 vcc, s29, v44
    v_mfma_f32_16x16x32_bf16 v[56:59], a[216:219], a[100:103], v[56:59]
    s_waitcnt lgkmcnt(3)
    v_mfma_f32_16x16x32_bf16 v[56:59], a[220:223], a[104:107], v[56:59]
    buffer_store_dwordx4 v[84:87], v6, s[16:19], s57 offen offset:0 nt
    s_nop 0
    s_cbranch_vccnz L_rs_end4a
L_ret_end4a:
    v_mfma_f32_16x16x32_bf16 v[64:67], a[220:223], a[128:131], 0
    v_fma_f32 v55, v55, s28, v9
    v_fma_f32 v60, v60, s28, v10
    v_mfma_f32_16x16x32_bf16 v[64:67], a[216:219], a[124:127], v[64:67]
    v_fma_f32 v52, v52, s28, v9
    v_mfma_f32_16x16x32_bf16 v[64:67], a[212:215], a[120:123], v[64:67]
    buffer_store_dwordx4 v[88:91], v7, s[16:19], s57 offen offset:0 nt
    s_waitcnt vmcnt(10) lgkmcnt(0)
    v_mfma_f32_16x16x32_bf16 v[72:75], a[212:215], a[144:147], 0
    s_barrier
    v_mfma_f32_16x16x32_bf16 v[72:75], a[216:219], a[148:151], v[72:75]
    v_fma_f32 v61, v61, s28, v10
    v_fma_f32 v54, v54, s28, v9
    v_mfma_f32_16x16x32_bf16 v[72:75], a[220:223], a[152:155], v[72:75]
    v_exp_f32 v61, v61
    v_mfma_f32_16x16x32_bf16 v[80:83], a[220:223], a[176:179], 0
    v_mfma_f32_16x16x32_bf16 v[80:83], a[216:219], a[172:175], v[80:83]
    v_exp_f32 v54, v54
    v_mfma_f32_16x16x32_bf16 v[80:83], a[212:215], a[168:171], v[80:83]
    ds_read_b64_tr_b16 a[212:213], v2 offset:0
    v_fma_f32 v53, v53, s28, v9
    v_mfma_f32_16x16x32_bf16 v[80:83], a[224:227], a[180:183], v[80:83]
    v_exp_f32 v53, v53
    v_mfma_f32_16x16x32_bf16 v[80:83], a[228:231], a[184:187], v[80:83]
    ds_read_b64_tr_b16 a[214:215], v2 offset:6144
    v_mfma_f32_16x16x32_bf16 v[80:83], a[232:235], a[188:191], v[80:83]
    ds_read_b64_tr_b16 a[216:217], v3 offset:0
    v_mfma_f32_16x16x32_bf16 v[72:75], a[232:235], a[164:167], v[72:75]
    v_exp_f32 v55, v55
    v_mfma_f32_16x16x32_bf16 v[72:75], a[228:231], a[160:163], v[72:75]
    ds_read_b64_tr_b16 a[218:219], v3 offset:6144
    v_mfma_f32_16x16x32_bf16 v[72:75], a[224:227], a[156:159], v[72:75]
    v_exp_f32 v60, v60
    v_mfma_f32_16x16x32_bf16 v[64:67], a[224:227], a[132:135], v[64:67]
    v_exp_f32 v52, v52
    v_mfma_f32_16x16x32_bf16 v[64:67], a[228:231], a[136:139], v[64:67]
    v_mfma_f32_16x16x32_bf16 v[64:67], a[232:235], a[140:143], v[64:67]
    v_cvt_pk_bf16_f32 v19, v54, v55
    v_cvt_pk_bf16_f32 v18, v52, v53
    v_mfma_f32_16x16x32_bf16 v[56:59], a[232:235], a[116:119], v[56:59]
    ds_read_b64_tr_b16 a[220:221], v4 offset:0
    v_cvt_pk_bf16_f32 v24, v60, v61
    v_mfma_f32_16x16x32_bf16 v[56:59], a[228:231], a[112:115], v[56:59]
    ds_read_b64_tr_b16 a[222:223], v4 offset:6144
    v_mfma_f32_16x16x32_bf16 v[56:59], a[224:227], a[108:111], v[56:59]
    s_waitcnt lgkmcnt(4)
    ds_read_b64_tr_b16 a[224:225], v5 offset:0
    ds_read_b64_tr_b16 a[226:227], v5 offset:6144
    v_mfma_f32_16x16x32_bf16 v[112:115], a[212:215], v[14:17], v[112:115]
    ds_read_b64_tr_b16 a[232:233], v3 offset:1024
    v_fma_f32 v66, v66, s28, v10
    v_mfma_f32_16x16x32_bf16 v[160:163], a[212:215], v[20:23], v[160:163]
    s_add_u32 s39, s39, 12288
    ds_read_b64_tr_b16 a[230:231], v2 offset:7168
    v_fma_f32 v57, v57, s28, v9
    v_fma_f32 v63, v63, s28, v10
    v_mfma_f32_16x16x32_bf16 v[208:211], a[212:215], v[26:29], v[208:211]
    v_fma_f32 v78, v78, s28, v12
    v_fma_f32 v69, v69, s28, v11
    v_exp_f32 v69, v69
    v_mfma_f32_16x16x32_bf16 a[0:3], a[212:215], v[32:35], a[0:3]
    s_waitcnt lgkmcnt(6)
    ds_read_b64_tr_b16 a[228:229], v2 offset:1024
    v_fma_f32 v67, v67, s28, v10
    v_mfma_f32_16x16x32_bf16 a[4:7], a[216:219], v[32:35], a[4:7]
    ds_read_b64_tr_b16 a[234:235], v3 offset:7168
    v_fma_f32 v83, v83, s28, v12
    v_mfma_f32_16x16x32_bf16 v[212:215], a[216:219], v[26:29], v[212:215]
    v_exp_f32 v78, v78
    v_mfma_f32_16x16x32_bf16 v[164:167], a[216:219], v[20:23], v[164:167]
    s_waitcnt vmcnt(4)
    ds_read_b64_tr_b16 a[212:213], v4 offset:1024
    v_fma_f32 v73, v73, s28, v11
    v_mfma_f32_16x16x32_bf16 v[116:119], a[216:219], v[14:17], v[116:119]
    s_waitcnt lgkmcnt(7)
    v_exp_f32 v73, v73
    v_mfma_f32_16x16x32_bf16 v[120:123], a[220:223], v[14:17], v[120:123]
    s_barrier
    v_fma_f32 v81, v81, s28, v12
    v_mfma_f32_16x16x32_bf16 v[168:171], a[220:223], v[20:23], v[168:171]
    ds_read_b64_tr_b16 a[214:215], v4 offset:7168
    v_fma_f32 v75, v75, s28, v11
    v_mfma_f32_16x16x32_bf16 v[216:219], a[220:223], v[26:29], v[216:219]
    ds_read_b64_tr_b16 a[216:217], v5 offset:1024
    v_fma_f32 v77, v77, s28, v12
    v_mfma_f32_16x16x32_bf16 a[8:11], a[220:223], v[32:35], a[8:11]
    s_waitcnt lgkmcnt(5)
    v_exp_f32 v57, v57
    v_mfma_f32_16x16x32_bf16 a[12:15], a[224:227], v[32:35], a[12:15]
    ds_read_b64_tr_b16 a[222:223], v2 offset:8192
    v_fma_f32 v64, v64, s28, v10
    v_fma_f32 v62, v62, s28, v10
    v_mfma_f32_16x16x32_bf16 v[220:223], a[224:227], v[26:29], v[220:223]
    v_exp_f32 v67, v67
    v_mfma_f32_16x16x32_bf16 v[172:175], a[224:227], v[20:23], v[172:175]
    ds_read_b64_tr_b16 a[220:221], v2 offset:2048
    v_fma_f32 v70, v70, s28, v11
    v_mfma_f32_16x16x32_bf16 v[124:127], a[224:227], v[14:17], v[124:127]
    s_waitcnt lgkmcnt(5)
    ds_read_b64_tr_b16 a[218:219], v5 offset:7168
    v_fma_f32 v68, v68, s28, v11
    v_mfma_f32_16x16x32_bf16 v[128:131], a[228:231], v[14:17], v[128:131]
    v_exp_f32 v81, v81
    v_mfma_f32_16x16x32_bf16 v[176:179], a[228:231], v[20:23], v[176:179]
    v_fma_f32 v59, v59, s28, v9
    v_fma_f32 v80, v80, s28, v12
    v_mfma_f32_16x16x32_bf16 v[224:227], a[228:231], v[26:29], v[224:227]
    v_fma_f32 v72, v72, s28, v11
    v_exp_f32 v63, v63
    v_mfma_f32_16x16x32_bf16 a[16:19], a[228:231], v[32:35], a[16:19]
    v_fma_f32 v71, v71, s28, v11
    v_fma_f32 v79, v79, s28, v12
    v_mfma_f32_16x16x32_bf16 a[20:23], a[232:235], v[32:35], a[20:23]
    v_exp_f32 v77, v77
    v_fma_f32 v76, v76, s28, v12
    v_mfma_f32_16x16x32_bf16 v[228:231], a[232:235], v[26:29], v[228:231]
    v_exp_f32 v71, v71
    v_mfma_f32_16x16x32_bf16 v[180:183], a[232:235], v[20:23], v[180:183]
    ds_read_b64_tr_b16 a[226:227], v3 offset:8192
    v_exp_f32 v68, v68
    v_mfma_f32_16x16x32_bf16 v[132:135], a[232:235], v[14:17], v[132:135]
    s_waitcnt lgkmcnt(2)
    v_exp_f32 v83, v83
    v_mfma_f32_16x16x32_bf16 v[136:139], a[212:215], v[14:17], v[136:139]
    ds_read_b64_tr_b16 a[228:229], v4 offset:2048
    v_fma_f32 v58, v58, s28, v9
    v_mfma_f32_16x16x32_bf16 v[184:187], a[212:215], v[20:23], v[184:187]
    ds_read_b64_tr_b16 a[224:225], v3 offset:2048
    v_exp_f32 v75, v75
    v_mfma_f32_16x16x32_bf16 v[232:235], a[212:215], v[26:29], v[232:235]
    v_exp_f32 v79, v79
    v_mfma_f32_16x16x32_bf16 a[24:27], a[212:215], v[32:35], a[24:27]
    s_waitcnt lgkmcnt(3)
    ds_read_b64_tr_b16 a[230:231], v4 offset:8192
    v_fma_f32 v56, v56, s28, v9
    v_mfma_f32_16x16x32_bf16 a[28:31], a[216:219], v[32:35], a[28:31]
    v_exp_f32 v58, v58
    v_mfma_f32_16x16x32_bf16 v[236:239], a[216:219], v[26:29], v[236:239]
    v_exp_f32 v64, v64
    v_mfma_f32_16x16x32_bf16 v[188:191], a[216:219], v[20:23], v[188:191]
    ds_read_b64_tr_b16 a[234:235], v5 offset:8192
    v_exp_f32 v56, v56
    v_mfma_f32_16x16x32_bf16 v[140:143], a[216:219], v[14:17], v[140:143]
    v_exp_f32 v66, v66
    v_mfma_f32_16x16x32_bf16 v[144:147], a[220:223], v[14:17], v[144:147]
    v_exp_f32 v76, v76
    v_mfma_f32_16x16x32_bf16 v[192:195], a[220:223], v[20:23], v[192:195]
    ds_read_b64_tr_b16 a[232:233], v5 offset:2048
    v_cvt_pk_bf16_f32 v30, v68, v69
    v_mfma_f32_16x16x32_bf16 v[240:243], a[220:223], v[26:29], v[240:243]
    ds_read_b64_tr_b16 a[212:213], v2 offset:18432
    v_fma_f32 v82, v82, s28, v12
    v_mfma_f32_16x16x32_bf16 a[32:35], a[220:223], v[32:35], a[32:35]
    s_waitcnt lgkmcnt(4)
    v_fma_f32 v74, v74, s28, v11
    v_exp_f32 v59, v59
    v_mfma_f32_16x16x32_bf16 a[36:39], a[224:227], v[32:35], a[36:39]
    v_exp_f32 v62, v62
    v_mfma_f32_16x16x32_bf16 v[244:247], a[224:227], v[26:29], v[244:247]
    ds_read_b64_tr_b16 a[214:215], v2 offset:12288
    v_fma_f32 v65, v65, s28, v10
    v_mfma_f32_16x16x32_bf16 v[196:199], a[224:227], v[20:23], v[196:199]
    v_exp_f32 v80, v80
    v_mfma_f32_16x16x32_bf16 v[148:151], a[224:227], v[14:17], v[148:151]
    s_waitcnt lgkmcnt(4)
    v_exp_f32 v72, v72
    v_mfma_f32_16x16x32_bf16 v[152:155], a[228:231], v[14:17], v[152:155]
    ds_read_b64_tr_b16 a[216:217], v3 offset:18432
    v_exp_f32 v74, v74
    v_mfma_f32_16x16x32_bf16 v[200:203], a[228:231], v[20:23], v[200:203]
    ds_read_b64_tr_b16 a[218:219], v3 offset:12288
    v_cvt_pk_bf16_f32 v25, v62, v63
    v_mfma_f32_16x16x32_bf16 v[248:251], a[228:231], v[26:29], v[248:251]
    v_exp_f32 v70, v70
    v_mfma_f32_16x16x32_bf16 a[40:43], a[228:231], v[32:35], a[40:43]
    s_waitcnt lgkmcnt(4)
    v_exp_f32 v65, v65
    v_mfma_f32_16x16x32_bf16 a[44:47], a[232:235], v[32:35], a[44:47]
    v_exp_f32 v82, v82
    v_mfma_f32_16x16x32_bf16 v[252:255], a[232:235], v[26:29], v[252:255]
    v_cvt_pk_bf16_f32 v31, v70, v71
    v_cvt_pk_bf16_f32 v28, v72, v73
    v_mfma_f32_16x16x32_bf16 v[204:207], a[232:235], v[20:23], v[204:207]
    v_cvt_pk_bf16_f32 v37, v78, v79
    v_cvt_pk_bf16_f32 v22, v64, v65
    v_mfma_f32_16x16x32_bf16 v[156:159], a[232:235], v[14:17], v[156:159]
    ds_read_b64_tr_b16 a[220:221], v4 offset:18432
    v_cvt_pk_bf16_f32 v16, v56, v57
    v_cvt_pk_bf16_f32 v17, v58, v59
    v_cvt_pk_bf16_f32 v23, v66, v67
    v_cvt_pk_bf16_f32 v34, v80, v81
    v_mfma_f32_16x16x32_bf16 v[48:51], a[236:239], v[16:19], v[44:47]
    v_cvt_pk_bf16_f32 v36, v76, v77
    v_cvt_pk_bf16_f32 v29, v74, v75
    v_mfma_f32_16x16x32_bf16 v[48:51], a[240:243], v[22:25], v[48:51]
    ds_read_b64_tr_b16 a[222:223], v4 offset:12288
    v_cvt_pk_bf16_f32 v35, v82, v83
    v_mfma_f32_16x16x32_bf16 v[48:51], a[244:247], v[28:31], v[48:51]
    ds_read_b64_tr_b16 a[224:225], v5 offset:18432
    v_mfma_f32_16x16x32_bf16 v[48:51], a[248:251], v[34:37], v[48:51]
    s_waitcnt lgkmcnt(3)
    ds_read_b64_tr_b16 a[226:227], v5 offset:12288
    s_nop 5
    v_cmp_lt_f32 vcc, s29, v48
    s_nop 4
    s_cbranch_vccnz L_rs_end4b
L_ret_end4b:
    v_lshrrev_b32 v108, 11, v0
    v_rcp_f32 v102, v49
    v_and_b32 v101, 0x3ff, v0
    v_xor_b32 v108, s65, v108
    v_lshl_add_u32 v101, v108, 10, v101
    v_mov_b32 v100, v48
    v_mbcnt_lo_u32_b32 v108, -1, 0
    v_rcp_f32 v50, v50
    v_permlane32_swap_b32 v48, v100
    v_add_u32 v101, s38, v101
    v_mbcnt_hi_u32_b32 v108, -1, v108
    v_lshrrev_b32 v108, 1, v108
    v_and_b32 v108, 24, v108
    v_rcp_f32 v48, v48
    v_rcp_f32 v8, v51
    v_bfe_u32 v108, s66, v108, 8
    v_xor_b32 v101, v101, v108
    v_mfma_f32_16x16x32_bf16 v[112:115], a[212:215], v[16:19], v[112:115]
    ds_read_b64_tr_b16 a[234:235], v3 offset:13312
    v_mfma_f32_16x16x32_bf16 v[160:163], a[212:215], v[22:25], v[160:163]
    v_mfma_f32_16x16x32_bf16 v[208:211], a[212:215], v[28:31], v[208:211]
    ds_read_b64_tr_b16 a[228:229], v2 offset:19456
    v_mfma_f32_16x16x32_bf16 a[0:3], a[212:215], v[34:37], a[0:3]
    s_waitcnt lgkmcnt(6)
    v_mfma_f32_16x16x32_bf16 a[4:7], a[216:219], v[34:37], a[4:7]
    ds_read_b64_tr_b16 a[230:231], v2 offset:13312
    v_xor_b32 v94, 96, v101
    v_mfma_f32_16x16x32_bf16 v[212:215], a[216:219], v[28:31], v[212:215]
    ds_read_b64_tr_b16 a[214:215], v4 offset:13312
    v_mfma_f32_16x16x32_bf16 v[164:167], a[216:219], v[22:25], v[164:167]
    v_mfma_f32_16x16x32_bf16 v[116:119], a[216:219], v[16:19], v[116:119]
    s_waitcnt lgkmcnt(6)
    v_mfma_f32_16x16x32_bf16 v[120:123], a[220:223], v[16:19], v[120:123]
    v_xor_b32 v93, 64, v101
    v_mfma_f32_16x16x32_bf16 v[168:171], a[220:223], v[22:25], v[168:171]
    ds_read_b64_tr_b16 a[232:233], v3 offset:19456
    v_accvgpr_read_b32 v107, a3
    v_mfma_f32_16x16x32_bf16 v[216:219], a[220:223], v[28:31], v[216:219]
    v_accvgpr_read_b32 v105, a1
    v_mfma_f32_16x16x32_bf16 a[8:11], a[220:223], v[34:37], a[8:11]
    s_waitcnt lgkmcnt(4)
    ds_read_b64_tr_b16 a[216:217], v5 offset:19456
    v_accvgpr_read_b32 v110, a6
    v_mfma_f32_16x16x32_bf16 a[12:15], a[224:227], v[34:37], a[12:15]
    s_add_u32 s84, s34, 0
    ds_read_b64_tr_b16 a[212:213], v4 offset:19456
    v_mfma_f32_16x16x32_bf16 v[220:223], a[224:227], v[28:31], v[220:223]
    ds_read_b64_tr_b16 a[222:223], v2 offset:14336
    s_add_u32 s85, s34, 6144
    v_mfma_f32_16x16x32_bf16 v[172:175], a[224:227], v[22:25], v[172:175]
    ds_read_b64_tr_b16 a[218:219], v5 offset:13312
    v_mfma_f32_16x16x32_bf16 v[124:127], a[224:227], v[16:19], v[124:127]
    s_waitcnt lgkmcnt(5)
    ds_read_b64_tr_b16 a[220:221], v2 offset:20480
    v_accvgpr_read_b32 v56, a12
    v_mfma_f32_16x16x32_bf16 v[128:131], a[228:231], v[16:19], v[128:131]
    v_accvgpr_read_b32 v109, a5
    v_mfma_f32_16x16x32_bf16 v[176:179], a[228:231], v[22:25], v[176:179]
    v_subrev_u32 v103, 24576, v103
    v_accvgpr_read_b32 v57, a13
    v_mfma_f32_16x16x32_bf16 v[224:227], a[228:231], v[28:31], v[224:227]
    v_mfma_f32_16x16x32_bf16 a[16:19], a[228:231], v[34:37], a[16:19]
    v_accvgpr_read_b32 v108, a4
    ds_read_b64_tr_b16 a[226:227], v3 offset:14336
    s_add_u32 s86, s34, 12288
    v_pk_mul_f32 v[160:161], v[160:161], v[102:103] op_sel_hi:[1,0]
    v_pk_mul_f32 v[220:221], v[220:221], v[50:51] op_sel_hi:[1,0]
    v_pk_mul_f32 v[120:121], v[120:121], v[48:49] op_sel_hi:[1,0]
    v_pk_mul_f32 v[116:117], v[116:117], v[48:49] op_sel_hi:[1,0]
    v_pk_mul_f32 v[164:165], v[164:165], v[102:103] op_sel_hi:[1,0]
    v_pk_mul_f32 v[168:169], v[168:169], v[102:103] op_sel_hi:[1,0]
    v_pk_mul_f32 v[172:173], v[172:173], v[102:103] op_sel_hi:[1,0]
    v_pk_mul_f32 v[114:115], v[114:115], v[48:49] op_sel_hi:[1,0]
    v_pk_mul_f32 v[130:131], v[130:131], v[48:49] op_sel_hi:[1,0]
    v_pk_mul_f32 v[112:113], v[112:113], v[48:49] op_sel_hi:[1,0]
    v_pk_mul_f32 v[170:171], v[170:171], v[102:103] op_sel_hi:[1,0]
    v_pk_mul_f32 v[162:163], v[162:163], v[102:103] op_sel_hi:[1,0]
    v_pk_mul_f32 v[174:175], v[174:175], v[102:103] op_sel_hi:[1,0]
    v_accvgpr_read_b32 v54, a10
    s_waitcnt lgkmcnt(2)
    v_mfma_f32_16x16x32_bf16 a[20:23], a[232:235], v[34:37], a[20:23]
    v_mfma_f32_16x16x32_bf16 v[228:231], a[232:235], v[28:31], v[228:231]
    ds_read_b64_tr_b16 a[224:225], v3 offset:20480
    v_mfma_f32_16x16x32_bf16 v[180:183], a[232:235], v[22:25], v[180:183]
    v_cvt_pk_bf16_f32 v120, v120, v121
    v_mfma_f32_16x16x32_bf16 v[132:135], a[232:235], v[16:19], v[132:135]
    v_xor_b32 v92, 32, v101
    v_accvgpr_read_b32 v104, a0
    v_mfma_f32_16x16x32_bf16 v[136:139], a[212:215], v[16:19], v[136:139]
    v_cvt_pk_bf16_f32 v112, v112, v113
    v_mfma_f32_16x16x32_bf16 v[184:187], a[212:215], v[22:25], v[184:187]
    v_cvt_pk_bf16_f32 v164, v164, v165
    v_mfma_f32_16x16x32_bf16 v[232:235], a[212:215], v[28:31], v[232:235]
    ds_read_b64_tr_b16 a[228:229], v4 offset:20480
    v_cvt_pk_bf16_f32 v220, v220, v221
    v_mfma_f32_16x16x32_bf16 a[24:27], a[212:215], v[34:37], a[24:27]
    ds_read_b64_tr_b16 a[234:235], v5 offset:14336
    v_cvt_pk_bf16_f32 v168, v168, v169
    v_mfma_f32_16x16x32_bf16 a[28:31], a[216:219], v[34:37], a[28:31]
    v_mfma_f32_16x16x32_bf16 v[236:239], a[216:219], v[28:31], v[236:239]
    ds_read_b64_tr_b16 a[230:231], v4 offset:14336
    v_mfma_f32_16x16x32_bf16 v[188:191], a[216:219], v[22:25], v[188:191]
    v_accvgpr_read_b32 v52, a8
    v_mfma_f32_16x16x32_bf16 v[140:143], a[216:219], v[16:19], v[140:143]
    s_waitcnt lgkmcnt(3)
    v_cvt_pk_bf16_f32 v116, v116, v117
    v_cvt_pk_bf16_f32 v113, v114, v115
    v_mfma_f32_16x16x32_bf16 v[144:147], a[220:223], v[16:19], v[144:147]
    v_cvt_pk_bf16_f32 v160, v160, v161
    v_mfma_f32_16x16x32_bf16 v[192:195], a[220:223], v[22:25], v[192:195]
    v_cvt_pk_bf16_f32 v161, v162, v163
    v_cvt_pk_bf16_f32 v172, v172, v173
    v_mfma_f32_16x16x32_bf16 v[240:243], a[220:223], v[28:31], v[240:243]
    s_add_u32 s87, s34, 18432
    v_cvt_pk_bf16_f32 v169, v170, v171
    v_mfma_f32_16x16x32_bf16 a[32:35], a[220:223], v[34:37], a[32:35]
    ds_write2st64_b64 v101, v[112:113], v[160:161] offset0:0 offset1:12
    v_pk_mul_f32 v[118:119], v[118:119], v[48:49] op_sel_hi:[1,0]
    v_pk_mul_f32 v[126:127], v[126:127], v[48:49] op_sel_hi:[1,0]
    v_pk_mul_f32 v[122:123], v[122:123], v[48:49] op_sel_hi:[1,0]
    v_pk_mul_f32 v[124:125], v[124:125], v[48:49] op_sel_hi:[1,0]
    v_pk_mul_f32 v[166:167], v[166:167], v[102:103] op_sel_hi:[1,0]
    v_cvt_pk_bf16_f32 v121, v122, v123
    v_cvt_pk_bf16_f32 v165, v166, v167
    v_mfma_f32_16x16x32_bf16 a[36:39], a[224:227], v[34:37], a[36:39]
    v_cvt_pk_bf16_f32 v117, v118, v119
    v_cvt_pk_bf16_f32 v124, v124, v125
    v_mfma_f32_16x16x32_bf16 v[244:247], a[224:227], v[28:31], v[244:247]
    v_accvgpr_read_b32 v53, a9
    v_cvt_pk_bf16_f32 v125, v126, v127
    v_mfma_f32_16x16x32_bf16 v[196:199], a[224:227], v[22:25], v[196:199]
    ds_read_b64_tr_b16 a[232:233], v5 offset:20480
    v_cvt_pk_bf16_f32 v173, v174, v175
    v_mfma_f32_16x16x32_bf16 v[148:151], a[224:227], v[16:19], v[148:151]
    s_waitcnt lgkmcnt(2)
    ds_write2st64_b64 v92, v[116:117], v[164:165] offset0:0 offset1:12
    v_mfma_f32_16x16x32_bf16 v[152:155], a[228:231], v[16:19], v[152:155]
    ds_write2st64_b64 v93, v[120:121], v[168:169] offset0:0 offset1:12
    v_mfma_f32_16x16x32_bf16 v[200:203], a[228:231], v[22:25], v[200:203]
    ds_write2st64_b64 v94, v[124:125], v[172:173] offset0:0 offset1:12
    v_mfma_f32_16x16x32_bf16 v[248:251], a[228:231], v[28:31], v[248:251]
    ds_read_b128 v[80:83], v103 offset:0
    v_pk_mul_f32 v[208:209], v[208:209], v[50:51] op_sel_hi:[1,0]
    v_pk_mul_f32 v[216:217], v[216:217], v[50:51] op_sel_hi:[1,0]
    v_accvgpr_read_b32 v59, a15
    v_cvt_pk_bf16_f32 v208, v208, v209
    v_accvgpr_read_b32 v111, a7
    v_pk_mul_f32 v[128:129], v[128:129], v[48:49] op_sel_hi:[1,0]
    s_add_u32 s18, s34, 24576
    v_pk_mul_f32 v[214:215], v[214:215], v[50:51] op_sel_hi:[1,0]
    v_pk_mul_f32 v[224:225], v[224:225], v[50:51] op_sel_hi:[1,0]
    v_accvgpr_read_b32 v55, a11
    v_accvgpr_read_b32 v106, a2
    v_pk_mul_f32 v[186:187], v[186:187], v[102:103] op_sel_hi:[1,0]
    v_pk_mul_f32 v[52:53], v[52:53], v[8:9] op_sel_hi:[1,0]
    v_pk_mul_f32 v[218:219], v[218:219], v[50:51] op_sel_hi:[1,0]
    v_pk_mul_f32 v[210:211], v[210:211], v[50:51] op_sel_hi:[1,0]
    s_nop 1
    v_mfma_f32_16x16x32_bf16 a[40:43], a[228:231], v[34:37], a[40:43]
    s_waitcnt lgkmcnt(3)
    ds_read_b128 v[84:87], v103 offset:1024
    v_mfma_f32_16x16x32_bf16 a[44:47], a[232:235], v[34:37], a[44:47]
    v_pk_mul_f32 v[228:229], v[228:229], v[50:51] op_sel_hi:[1,0]
    v_pk_mul_f32 v[212:213], v[212:213], v[50:51] op_sel_hi:[1,0]
    v_pk_mul_f32 v[230:231], v[230:231], v[50:51] op_sel_hi:[1,0]
    v_pk_mul_f32 v[136:137], v[136:137], v[48:49] op_sel_hi:[1,0]
    s_waitcnt lgkmcnt(1)
    buffer_store_dwordx4 v[80:83], v6, s[16:19], s84 offen offset:0 nt
    v_pk_mul_f32 v[106:107], v[106:107], v[8:9] op_sel_hi:[1,0]
    v_pk_mul_f32 v[132:133], v[132:133], v[48:49] op_sel_hi:[1,0]
    v_pk_mul_f32 v[56:57], v[56:57], v[8:9] op_sel_hi:[1,0]
    v_cvt_pk_bf16_f32 v52, v52, v53
    v_pk_mul_f32 v[196:197], v[196:197], v[102:103] op_sel_hi:[1,0]
    v_pk_mul_f32 v[110:111], v[110:111], v[8:9] op_sel_hi:[1,0]
    v_pk_mul_f32 v[104:105], v[104:105], v[8:9] op_sel_hi:[1,0]
    v_pk_mul_f32 v[140:141], v[140:141], v[48:49] op_sel_hi:[1,0]
    v_pk_mul_f32 v[192:193], v[192:193], v[102:103] op_sel_hi:[1,0]
    v_pk_mul_f32 v[178:179], v[178:179], v[102:103] op_sel_hi:[1,0]
    v_pk_mul_f32 v[108:109], v[108:109], v[8:9] op_sel_hi:[1,0]
    v_cvt_pk_bf16_f32 v56, v56, v57
    v_cvt_pk_bf16_f32 v212, v212, v213
    v_cvt_pk_bf16_f32 v216, v216, v217
    v_pk_mul_f32 v[54:55], v[54:55], v[8:9] op_sel_hi:[1,0]
    ds_read_b128 v[88:91], v103 offset:6144
    v_pk_mul_f32 v[234:235], v[234:235], v[50:51] op_sel_hi:[1,0]
    v_cvt_pk_bf16_f32 v108, v108, v109
    v_cvt_pk_bf16_f32 v53, v54, v55
    v_cvt_pk_bf16_f32 v104, v104, v105
    v_mfma_f32_16x16x32_bf16 v[252:255], a[232:235], v[28:31], v[252:255]
    v_cvt_pk_bf16_f32 v209, v210, v211
    ds_read_b128 v[60:63], v103 offset:7168
    v_mfma_f32_16x16x32_bf16 v[204:207], a[232:235], v[22:25], v[204:207]
    s_waitcnt lgkmcnt(2)
    buffer_store_dwordx4 v[84:87], v7, s[16:19], s84 offen offset:0 nt
    v_cvt_pk_bf16_f32 v109, v110, v111
    v_pk_mul_f32 v[248:249], v[248:249], v[50:51] op_sel_hi:[1,0]
    v_pk_mul_f32 v[200:201], v[200:201], v[102:103] op_sel_hi:[1,0]
    v_pk_mul_f32 v[222:223], v[222:223], v[50:51] op_sel_hi:[1,0]
    v_cvt_pk_bf16_f32 v128, v128, v129
    v_cvt_pk_bf16_f32 v228, v228, v229
    v_pk_mul_f32 v[144:145], v[144:145], v[48:49] op_sel_hi:[1,0]
    v_cvt_pk_bf16_f32 v213, v214, v215
    v_cvt_pk_bf16_f32 v229, v230, v231
    v_accvgpr_read_b32 v58, a14
    v_pk_mul_f32 v[190:191], v[190:191], v[102:103] op_sel_hi:[1,0]
    v_pk_mul_f32 v[58:59], v[58:59], v[8:9] op_sel_hi:[1,0]
    v_cvt_pk_bf16_f32 v105, v106, v107
    v_pk_mul_f32 v[188:189], v[188:189], v[102:103] op_sel_hi:[1,0]
    v_pk_mul_f32 v[138:139], v[138:139], v[48:49] op_sel_hi:[1,0]
    v_pk_mul_f32 v[252:253], v[252:253], v[50:51] op_sel_hi:[1,0]
    ds_write2st64_b64 v101, v[208:209], v[104:105] offset0:24 offset1:36
    s_nop 0
    v_mfma_f32_16x16x32_bf16 v[156:159], a[232:235], v[16:19], v[156:159]
    s_waitcnt lgkmcnt(2)
    v_cvt_pk_bf16_f32 v221, v222, v223
    v_cvt_pk_bf16_f32 v140, v140, v141
    v_cvt_pk_bf16_f32 v217, v218, v219
    buffer_store_dwordx4 v[88:91], v6, s[16:19], s85 offen offset:0 nt
    ds_write2st64_b64 v92, v[212:213], v[108:109] offset0:24 offset1:36
    v_pk_mul_f32 v[236:237], v[236:237], v[50:51] op_sel_hi:[1,0]
    v_pk_mul_f32 v[202:203], v[202:203], v[102:103] op_sel_hi:[1,0]
    v_pk_mul_f32 v[142:143], v[142:143], v[48:49] op_sel_hi:[1,0]
    v_pk_mul_f32 v[176:177], v[176:177], v[102:103] op_sel_hi:[1,0]
    v_accvgpr_read_b32 v109, a21
    v_cvt_pk_bf16_f32 v57, v58, v59
    v_pk_mul_f32 v[148:149], v[148:149], v[48:49] op_sel_hi:[1,0]
    v_accvgpr_read_b32 v111, a23
    ds_write2st64_b64 v93, v[216:217], v[52:53] offset0:24 offset1:36
    ds_write2st64_b64 v94, v[220:221], v[56:57] offset0:24 offset1:36
    ds_read_b128 v[64:67], v103 offset:12288
    v_cvt_pk_bf16_f32 v148, v148, v149
    s_waitcnt lgkmcnt(4)
    buffer_store_dwordx4 v[60:63], v7, s[16:19], s85 offen offset:0 nt
    v_pk_mul_f32 v[254:255], v[254:255], v[50:51] op_sel_hi:[1,0]
    v_cvt_pk_bf16_f32 v132, v132, v133
    ds_read_b128 v[68:71], v103 offset:13312
    v_accvgpr_read_b32 v110, a22
    v_cvt_pk_bf16_f32 v188, v188, v189
    v_pk_mul_f32 v[134:135], v[134:135], v[48:49] op_sel_hi:[1,0]
    v_accvgpr_read_b32 v104, a16
    v_accvgpr_read_b32 v59, a31
    v_accvgpr_read_b32 v105, a17
    v_cvt_pk_bf16_f32 v236, v236, v237
    v_accvgpr_read_b32 v108, a20
    v_pk_mul_f32 v[104:105], v[104:105], v[8:9] op_sel_hi:[1,0]
    v_accvgpr_read_b32 v56, a28
    v_cvt_pk_bf16_f32 v133, v134, v135
    v_pk_mul_f32 v[240:241], v[240:241], v[50:51] op_sel_hi:[1,0]
    v_pk_mul_f32 v[198:199], v[198:199], v[102:103] op_sel_hi:[1,0]
    v_pk_mul_f32 v[180:181], v[180:181], v[102:103] op_sel_hi:[1,0]
    v_cvt_pk_bf16_f32 v224, v224, v225
    v_cvt_pk_bf16_f32 v136, v136, v137
    v_cvt_pk_bf16_f32 v141, v142, v143
    v_cvt_pk_bf16_f32 v129, v130, v131
    s_waitcnt lgkmcnt(1)
    buffer_store_dwordx4 v[64:67], v6, s[16:19], s86 offen offset:0 nt
    v_cvt_pk_bf16_f32 v176, v176, v177
    v_pk_mul_f32 v[184:185], v[184:185], v[102:103] op_sel_hi:[1,0]
    v_cvt_pk_bf16_f32 v177, v178, v179
    v_accvgpr_read_b32 v55, a27
    v_pk_mul_f32 v[232:233], v[232:233], v[50:51] op_sel_hi:[1,0]
    v_pk_mul_f32 v[150:151], v[150:151], v[48:49] op_sel_hi:[1,0]
    v_pk_mul_f32 v[108:109], v[108:109], v[8:9] op_sel_hi:[1,0]
    v_cvt_pk_bf16_f32 v189, v190, v191
    v_pk_mul_f32 v[244:245], v[244:245], v[50:51] op_sel_hi:[1,0]
    ds_read_b128 v[72:75], v103 offset:18432
    v_cvt_pk_bf16_f32 v144, v144, v145
    v_cvt_pk_bf16_f32 v184, v184, v185
    v_accvgpr_read_b32 v54, a26
    v_accvgpr_read_b32 v107, a19
    v_cvt_pk_bf16_f32 v180, v180, v181
    v_cvt_pk_bf16_f32 v185, v186, v187
    v_pk_mul_f32 v[154:155], v[154:155], v[48:49] op_sel_hi:[1,0]
    v_accvgpr_read_b32 v53, a25
    v_cvt_pk_bf16_f32 v200, v200, v201
    v_accvgpr_read_b32 v57, a29
    v_pk_mul_f32 v[182:183], v[182:183], v[102:103] op_sel_hi:[1,0]
    v_pk_mul_f32 v[246:247], v[246:247], v[50:51] op_sel_hi:[1,0]
    v_pk_mul_f32 v[156:157], v[156:157], v[48:49] op_sel_hi:[1,0]
    v_cvt_pk_bf16_f32 v196, v196, v197
    v_cvt_pk_bf16_f32 v108, v108, v109
    v_pk_mul_f32 v[152:153], v[152:153], v[48:49] op_sel_hi:[1,0]
    s_waitcnt lgkmcnt(1)
    buffer_store_dwordx4 v[68:71], v7, s[16:19], s86 offen offset:0 nt
    ds_read_b128 v[76:79], v103 offset:19456
    v_pk_mul_f32 v[226:227], v[226:227], v[50:51] op_sel_hi:[1,0]
    v_cvt_pk_bf16_f32 v181, v182, v183
    v_cvt_pk_bf16_f32 v244, v244, v245
    v_pk_mul_f32 v[110:111], v[110:111], v[8:9] op_sel_hi:[1,0]
    v_pk_mul_f32 v[204:205], v[204:205], v[102:103] op_sel_hi:[1,0]
    v_cvt_pk_bf16_f32 v192, v192, v193
    v_cvt_pk_bf16_f32 v225, v226, v227
    v_cvt_pk_bf16_f32 v152, v152, v153
    v_cvt_pk_bf16_f32 v137, v138, v139
    ds_write2st64_b64 v101, v[128:129], v[176:177] offset0:4 offset1:16
    v_pk_mul_f32 v[158:159], v[158:159], v[48:49] op_sel_hi:[1,0]
    v_pk_mul_f32 v[238:239], v[238:239], v[50:51] op_sel_hi:[1,0]
    v_pk_mul_f32 v[250:251], v[250:251], v[50:51] op_sel_hi:[1,0]
    v_accvgpr_read_b32 v58, a30
    v_cvt_pk_bf16_f32 v204, v204, v205
    v_cvt_pk_bf16_f32 v109, v110, v111
    s_waitcnt lgkmcnt(2)
    buffer_store_dwordx4 v[72:75], v6, s[16:19], s87 offen offset:0 nt
    v_accvgpr_read_b32 v52, a24
    ds_write2st64_b64 v92, v[132:133], v[180:181] offset0:4 offset1:16
    ds_write2st64_b64 v93, v[136:137], v[184:185] offset0:4 offset1:16
    ds_write2st64_b64 v94, v[140:141], v[188:189] offset0:4 offset1:16
    v_pk_mul_f32 v[54:55], v[54:55], v[8:9] op_sel_hi:[1,0]
    ds_read_b128 v[80:83], v103 offset:2048
    v_pk_mul_f32 v[242:243], v[242:243], v[50:51] op_sel_hi:[1,0]
    ds_read_b128 v[84:87], v103 offset:3072
    v_pk_mul_f32 v[52:53], v[52:53], v[8:9] op_sel_hi:[1,0]
    v_pk_mul_f32 v[206:207], v[206:207], v[102:103] op_sel_hi:[1,0]
    s_waitcnt lgkmcnt(5)
    buffer_store_dwordx4 v[76:79], v7, s[16:19], s87 offen offset:0 nt
    v_cvt_pk_bf16_f32 v52, v52, v53
    v_accvgpr_read_b32 v110, a38
    v_pk_mul_f32 v[56:57], v[56:57], v[8:9] op_sel_hi:[1,0]
    v_cvt_pk_bf16_f32 v232, v232, v233
    v_cvt_pk_bf16_f32 v197, v198, v199
    v_cvt_pk_bf16_f32 v53, v54, v55
    v_accvgpr_read_b32 v106, a18
    ds_read_b128 v[88:91], v103 offset:8192
    v_cvt_pk_bf16_f32 v153, v154, v155
    v_cvt_pk_bf16_f32 v56, v56, v57
    v_pk_mul_f32 v[58:59], v[58:59], v[8:9] op_sel_hi:[1,0]
    v_cvt_pk_bf16_f32 v248, v248, v249
    s_waitcnt lgkmcnt(2)
    buffer_store_dwordx4 v[80:83], v6, s[16:19], s84 offen offset:128 nt
    v_pk_mul_f32 v[106:107], v[106:107], v[8:9] op_sel_hi:[1,0]
    ds_read_b128 v[60:63], v103 offset:9216
    v_cvt_pk_bf16_f32 v104, v104, v105
    v_cvt_pk_bf16_f32 v57, v58, v59
    v_cvt_pk_bf16_f32 v105, v106, v107
    v_cvt_pk_bf16_f32 v237, v238, v239
    ds_write2st64_b64 v101, v[224:225], v[104:105] offset0:28 offset1:40
    ds_write2st64_b64 v92, v[228:229], v[108:109] offset0:28 offset1:40
    v_cvt_pk_bf16_f32 v240, v240, v241
    s_waitcnt lgkmcnt(3)
    buffer_store_dwordx4 v[84:87], v7, s[16:19], s84 offen offset:128 nt
    v_cvt_pk_bf16_f32 v233, v234, v235
    ds_write2st64_b64 v93, v[232:233], v[52:53] offset0:28 offset1:40
    v_pk_mul_f32 v[194:195], v[194:195], v[102:103] op_sel_hi:[1,0]
    ds_write2st64_b64 v94, v[236:237], v[56:57] offset0:28 offset1:40
    v_pk_mul_f32 v[146:147], v[146:147], v[48:49] op_sel_hi:[1,0]
    ds_read_b128 v[64:67], v103 offset:14336
    v_accvgpr_read_b32 v107, a35
    v_accvgpr_read_b32 v52, a40
    buffer_store_dwordx4 v[88:91], v6, s[16:19], s85 offen offset:128 nt
    v_cvt_pk_bf16_f32 v193, v194, v195
    v_accvgpr_read_b32 v105, a33
    v_accvgpr_read_b32 v104, a32
    ds_read_b128 v[68:71], v103 offset:15360
    v_cvt_pk_bf16_f32 v145, v146, v147
    v_accvgpr_read_b32 v54, a42
    v_accvgpr_read_b32 v55, a43
    v_accvgpr_read_b32 v106, a34
    ds_read_b128 v[72:75], v103 offset:20480
    v_accvgpr_read_b32 v111, a39
    v_cvt_pk_bf16_f32 v149, v150, v151
    v_accvgpr_read_b32 v56, a44
    s_waitcnt lgkmcnt(3)
    buffer_store_dwordx4 v[60:63], v7, s[16:19], s85 offen offset:128 nt
    v_cvt_pk_bf16_f32 v249, v250, v251
    v_accvgpr_read_b32 v53, a41
    v_cvt_pk_bf16_f32 v201, v202, v203
    v_accvgpr_read_b32 v57, a45
    v_pk_mul_f32 v[104:105], v[104:105], v[8:9] op_sel_hi:[1,0]
    v_pk_mul_f32 v[110:111], v[110:111], v[8:9] op_sel_hi:[1,0]
    ds_read_b128 v[76:79], v103 offset:21504
    v_accvgpr_read_b32 v109, a37
    ds_write2st64_b64 v101, v[144:145], v[192:193] offset0:8 offset1:20
    v_accvgpr_read_b32 v108, a36
    v_accvgpr_read_b32 v58, a46
    v_pk_mul_f32 v[52:53], v[52:53], v[8:9] op_sel_hi:[1,0]
    v_cvt_pk_bf16_f32 v205, v206, v207
    v_cvt_pk_bf16_f32 v241, v242, v243
    s_waitcnt lgkmcnt(2)
    buffer_store_dwordx4 v[64:67], v6, s[16:19], s86 offen offset:128 nt
    ds_write2st64_b64 v92, v[148:149], v[196:197] offset0:8 offset1:20
    v_pk_mul_f32 v[108:109], v[108:109], v[8:9] op_sel_hi:[1,0]
    v_cvt_pk_bf16_f32 v156, v156, v157
    v_cvt_pk_bf16_f32 v157, v158, v159
    v_cvt_pk_bf16_f32 v245, v246, v247
    buffer_store_dwordx4 v[68:71], v7, s[16:19], s86 offen offset:128 nt
    ds_write2st64_b64 v93, v[152:153], v[200:201] offset0:8 offset1:20
    ds_write2st64_b64 v94, v[156:157], v[204:205] offset0:8 offset1:20
    v_cvt_pk_bf16_f32 v108, v108, v109
    v_cvt_pk_bf16_f32 v109, v110, v111
    buffer_store_dwordx4 v[72:75], v6, s[16:19], s87 offen offset:128 nt
    v_cvt_pk_bf16_f32 v104, v104, v105
    v_cvt_pk_bf16_f32 v252, v252, v253
    ds_read_b128 v[80:83], v103 offset:4096
    v_accvgpr_read_b32 v59, a47
    ds_read_b128 v[84:87], v103 offset:5120
    s_waitcnt lgkmcnt(2)
    buffer_store_dwordx4 v[76:79], v7, s[16:19], s87 offen offset:128 nt
    v_pk_mul_f32 v[58:59], v[58:59], v[8:9] op_sel_hi:[1,0]
    v_cvt_pk_bf16_f32 v52, v52, v53
    v_pk_mul_f32 v[106:107], v[106:107], v[8:9] op_sel_hi:[1,0]
    s_waitcnt lgkmcnt(1)
    buffer_store_dwordx4 v[80:83], v6, s[16:19], s84 offen offset:256 nt
    v_pk_mul_f32 v[56:57], v[56:57], v[8:9] op_sel_hi:[1,0]
    v_pk_mul_f32 v[54:55], v[54:55], v[8:9] op_sel_hi:[1,0]
    ds_read_b128 v[88:91], v103 offset:10240
    v_cvt_pk_bf16_f32 v105, v106, v107
    s_waitcnt lgkmcnt(1)
    buffer_store_dwordx4 v[84:87], v7, s[16:19], s84 offen offset:256 nt
    ds_read_b128 v[60:63], v103 offset:11264
    v_cvt_pk_bf16_f32 v56, v56, v57
    ds_write2st64_b64 v101, v[240:241], v[104:105] offset0:32 offset1:44
    v_cvt_pk_bf16_f32 v53, v54, v55
    s_waitcnt lgkmcnt(2)
    buffer_store_dwordx4 v[88:91], v6, s[16:19], s85 offen offset:256 nt
    v_cvt_pk_bf16_f32 v253, v254, v255
    v_cvt_pk_bf16_f32 v57, v58, v59
    ds_write2st64_b64 v92, v[244:245], v[108:109] offset0:32 offset1:44
    ds_write2st64_b64 v93, v[248:249], v[52:53] offset0:32 offset1:44
    ds_write2st64_b64 v94, v[252:253], v[56:57] offset0:32 offset1:44
    ds_read_b128 v[64:67], v103 offset:16384
    ds_read_b128 v[68:71], v103 offset:17408
    ds_read_b128 v[72:75], v103 offset:22528
    s_waitcnt lgkmcnt(6)
    buffer_store_dwordx4 v[60:63], v7, s[16:19], s85 offen offset:256 nt
    ds_read_b128 v[76:79], v103 offset:23552
    s_waitcnt lgkmcnt(3)
    buffer_store_dwordx4 v[64:67], v6, s[16:19], s86 offen offset:256 nt
    s_waitcnt lgkmcnt(1)
    buffer_store_dwordx4 v[68:71], v7, s[16:19], s86 offen offset:256 nt
    buffer_store_dwordx4 v[72:75], v6, s[16:19], s87 offen offset:256 nt
    s_waitcnt lgkmcnt(0)
    buffer_store_dwordx4 v[76:79], v7, s[16:19], s87 offen offset:256 nt
    s_branch L_fin
L_fin:
    s_waitcnt vmcnt(0)
L_end:
    s_endpgm
L_codeend:
L_rare5_0:
    s_nop 15
    v_mbcnt_lo_u32_b32 v31, -1, 0
    v_mbcnt_hi_u32_b32 v31, -1, v31
    v_and_b32 v30, 15, v31
    v_mul_u32_u24 v30, 384, v30
    v_lshrrev_b32 v31, 4, v31
    v_lshl_add_u32 v30, v31, 4, v30
    s_add_u32 s69, s39, 0
    buffer_load_dwordx4 v[44:47], v30, s[4:7], s69 offen offset:0
    s_waitcnt vmcnt(0)
    v_mfma_f32_16x16x32_bf16 v[104:107], v[44:47], a[96:99], 0
    s_nop 7
    buffer_load_dwordx4 v[44:47], v30, s[4:7], s69 offen offset:64
    s_waitcnt vmcnt(0)
    v_mfma_f32_16x16x32_bf16 v[104:107], v[44:47], a[100:103], v[104:107]
    s_nop 7
    buffer_load_dwordx4 v[44:47], v30, s[4:7], s69 offen offset:128
    s_waitcnt vmcnt(0)
    v_mfma_f32_16x16x32_bf16 v[104:107], v[44:47], a[104:107], v[104:107]
    s_nop 7
    buffer_load_dwordx4 v[44:47], v30, s[4:7], s69 offen offset:192
    s_waitcnt vmcnt(0)
    v_mfma_f32_16x16x32_bf16 v[104:107], v[44:47], a[108:111], v[104:107]
    s_nop 7
    buffer_load_dwordx4 v[44:47], v30, s[4:7], s69 offen offset:256
    s_waitcnt vmcnt(0)
    v_mfma_f32_16x16x32_bf16 v[104:107], v[44:47], a[112:115], v[104:107]
    s_nop 7
    buffer_load_dwordx4 v[44:47], v30, s[4:7], s69 offen offset:320
    s_waitcnt vmcnt(0)
    v_mfma_f32_16x16x32_bf16 v[104:107], v[44:47], a[116:119], v[104:107]
    s_nop 7
    s_add_u32 s69, s39, 6144
    buffer_load_dwordx4 v[44:47], v30, s[4:7], s69 offen offset:0
    s_waitcnt vmcnt(0)
    v_mfma_f32_16x16x32_bf16 v[108:111], v[44:47], a[96:99], 0
    s_nop 7
    buffer_load_dwordx4 v[44:47], v30, s[4:7], s69 offen offset:64
    s_waitcnt vmcnt(0)
    v_mfma_f32_16x16x32_bf16 v[108:111], v[44:47], a[100:103], v[108:111]
    s_nop 7
    buffer_load_dwordx4 v[44:47], v30, s[4:7], s69 offen offset:128
    s_waitcnt vmcnt(0)
    v_mfma_f32_16x16x32_bf16 v[108:111], v[44:47], a[104:107], v[108:111]
    s_nop 7
    buffer_load_dwordx4 v[44:47], v30, s[4:7], s69 offen offset:192
    s_waitcnt vmcnt(0)
    v_mfma_f32_16x16x32_bf16 v[108:111], v[44:47], a[108:111], v[108:111]
    s_nop 7
    buffer_load_dwordx4 v[44:47], v30, s[4:7], s69 offen offset:256
    s_waitcnt vmcnt(0)
    v_mfma_f32_16x16x32_bf16 v[108:111], v[44:47], a[112:115], v[108:111]
    s_nop 7
    buffer_load_dwordx4 v[44:47], v30, s[4:7], s69 offen offset:320
    s_waitcnt vmcnt(0)
    v_mfma_f32_16x16x32_bf16 v[108:111], v[44:47], a[116:119], v[108:111]
    s_nop 7
    s_nop 15
    v_max3_f32 v18, v104, v105, v106
    v_max3_f32 v18, v18, v107, v108
    v_max3_f32 v18, v18, v109, v110
    v_max_f32 v18, v18, v111
    v_mov_b32 v19, v18
    s_nop 1
    v_permlane32_swap_b32 v19, v18
    v_max_f32 v18, v18, v19
    v_mov_b32 v19, v18
    s_nop 1
    v_permlane16_swap_b32 v19, v18
    v_max_f32 v18, v18, v19
    v_fma_f32 v18, v18, s28, v9
    v_max_f32 v24, 0, v18
    v_sub_f32 v9, v9, v24
    v_sub_f32 v25, 0, v24
    v_exp_f32 v25, v25
    s_nop 0
    v_mul_f32 v19, v48, v25
    v_cndmask_b32_e64 v48, v19, v48, s[60:61]
    v_cndmask_b32_e64 v48, v48, 0, s[46:47]
    v_mul_f32 v112, v112, v25
    v_mul_f32 v113, v113, v25
    v_mul_f32 v114, v114, v25
    v_mul_f32 v115, v115, v25
    v_mul_f32 v116, v116, v25
    v_mul_f32 v117, v117, v25
    v_mul_f32 v118, v118, v25
    v_mul_f32 v119, v119, v25
    v_mul_f32 v120, v120, v25
    v_mul_f32 v121, v121, v25
    v_mul_f32 v122, v122, v25
    v_mul_f32 v123, v123, v25
    v_mul_f32 v124, v124, v25
    v_mul_f32 v125, v125, v25
    v_mul_f32 v126, v126, v25
    v_mul_f32 v127, v127, v25
    v_mul_f32 v128, v128, v25
    v_mul_f32 v129, v129, v25
    v_mul_f32 v130, v130, v25
    v_mul_f32 v131, v131, v25
    v_mul_f32 v132, v132, v25
    v_mul_f32 v133, v133, v25
    v_mul_f32 v134, v134, v25
    v_mul_f32 v135, v135, v25
    v_mul_f32 v136, v136, v25
    v_mul_f32 v137, v137, v25
    v_mul_f32 v138, v138, v25
    v_mul_f32 v139, v139, v25
    v_mul_f32 v140, v140, v25
    v_mul_f32 v141, v141, v25
    v_mul_f32 v142, v142, v25
    v_mul_f32 v143, v143, v25
    v_mul_f32 v144, v144, v25
    v_mul_f32 v145, v145, v25
    v_mul_f32 v146, v146, v25
    v_mul_f32 v147, v147, v25
    v_mul_f32 v148, v148, v25
    v_mul_f32 v149, v149, v25
    v_mul_f32 v150, v150, v25
    v_mul_f32 v151, v151, v25
    v_mul_f32 v152, v152, v25
    v_mul_f32 v153, v153, v25
    v_mul_f32 v154, v154, v25
    v_mul_f32 v155, v155, v25
    v_mul_f32 v156, v156, v25
    v_mul_f32 v157, v157, v25
    v_mul_f32 v158, v158, v25
    v_mul_f32 v159, v159, v25
    v_fma_f32 v104, v104, s28, v9
    v_fma_f32 v105, v105, s28, v9
    v_exp_f32 v104, v104
    v_exp_f32 v105, v105
    s_nop 0
    v_cvt_pk_bf16_f32 v14, v104, v105
    v_fma_f32 v106, v106, s28, v9
    v_fma_f32 v107, v107, s28, v9
    v_exp_f32 v106, v106
    v_exp_f32 v107, v107
    s_nop 0
    v_cvt_pk_bf16_f32 v15, v106, v107
    v_fma_f32 v108, v108, s28, v9
    v_fma_f32 v109, v109, s28, v9
    v_exp_f32 v108, v108
    v_exp_f32 v109, v109
    s_nop 0
    v_cvt_pk_bf16_f32 v16, v108, v109
    v_fma_f32 v110, v110, s28, v9
    v_fma_f32 v111, v111, s28, v9
    v_exp_f32 v110, v110
    v_exp_f32 v111, v111
    s_nop 0
    v_cvt_pk_bf16_f32 v17, v110, v111
    s_add_u32 s69, s39, 0
    buffer_load_dwordx4 v[44:47], v30, s[4:7], s69 offen offset:0
    s_waitcnt vmcnt(0)
    v_mfma_f32_16x16x32_bf16 v[104:107], v[44:47], a[120:123], 0
    s_nop 7
    buffer_load_dwordx4 v[44:47], v30, s[4:7], s69 offen offset:64
    s_waitcnt vmcnt(0)
    v_mfma_f32_16x16x32_bf16 v[104:107], v[44:47], a[124:127], v[104:107]
    s_nop 7
    buffer_load_dwordx4 v[44:47], v30, s[4:7], s69 offen offset:128
    s_waitcnt vmcnt(0)
    v_mfma_f32_16x16x32_bf16 v[104:107], v[44:47], a[128:131], v[104:107]
    s_nop 7
    buffer_load_dwordx4 v[44:47], v30, s[4:7], s69 offen offset:192
    s_waitcnt vmcnt(0)
    v_mfma_f32_16x16x32_bf16 v[104:107], v[44:47], a[132:135], v[104:107]
    s_nop 7
    buffer_load_dwordx4 v[44:47], v30, s[4:7], s69 offen offset:256
    s_waitcnt vmcnt(0)
    v_mfma_f32_16x16x32_bf16 v[104:107], v[44:47], a[136:139], v[104:107]
    s_nop 7
    buffer_load_dwordx4 v[44:47], v30, s[4:7], s69 offen offset:320
    s_waitcnt vmcnt(0)
    v_mfma_f32_16x16x32_bf16 v[104:107], v[44:47], a[140:143], v[104:107]
    s_nop 7
    s_add_u32 s69, s39, 6144
    buffer_load_dwordx4 v[44:47], v30, s[4:7], s69 offen offset:0
    s_waitcnt vmcnt(0)
    v_mfma_f32_16x16x32_bf16 v[108:111], v[44:47], a[120:123], 0
    s_nop 7
    buffer_load_dwordx4 v[44:47], v30, s[4:7], s69 offen offset:64
    s_waitcnt vmcnt(0)
    v_mfma_f32_16x16x32_bf16 v[108:111], v[44:47], a[124:127], v[108:111]
    s_nop 7
    buffer_load_dwordx4 v[44:47], v30, s[4:7], s69 offen offset:128
    s_waitcnt vmcnt(0)
    v_mfma_f32_16x16x32_bf16 v[108:111], v[44:47], a[128:131], v[108:111]
    s_nop 7
    buffer_load_dwordx4 v[44:47], v30, s[4:7], s69 offen offset:192
    s_waitcnt vmcnt(0)
    v_mfma_f32_16x16x32_bf16 v[108:111], v[44:47], a[132:135], v[108:111]
    s_nop 7
    buffer_load_dwordx4 v[44:47], v30, s[4:7], s69 offen offset:256
    s_waitcnt vmcnt(0)
    v_mfma_f32_16x16x32_bf16 v[108:111], v[44:47], a[136:139], v[108:111]
    s_nop 7
    buffer_load_dwordx4 v[44:47], v30, s[4:7], s69 offen offset:320
    s_waitcnt vmcnt(0)
    v_mfma_f32_16x16x32_bf16 v[108:111], v[44:47], a[140:143], v[108:111]
    s_nop 7
    s_nop 15
    v_max3_f32 v18, v104, v105, v106
    v_max3_f32 v18, v18, v107, v108
    v_max3_f32 v18, v18, v109, v110
    v_max_f32 v18, v18, v111
    v_mov_b32 v19, v18
    s_nop 1
    v_permlane32_swap_b32 v19, v18
    v_max_f32 v18, v18, v19
    v_mov_b32 v19, v18
    s_nop 1
    v_permlane16_swap_b32 v19, v18
    v_max_f32 v18, v18, v19
    v_fma_f32 v18, v18, s28, v10
    v_max_f32 v24, 0, v18
    v_sub_f32 v10, v10, v24
    v_sub_f32 v25, 0, v24
    v_exp_f32 v25, v25
    s_nop 0
    v_mul_f32 v49, v49, v25
    v_mul_f32 v160, v160, v25
    v_mul_f32 v161, v161, v25
    v_mul_f32 v162, v162, v25
    v_mul_f32 v163, v163, v25
    v_mul_f32 v164, v164, v25
    v_mul_f32 v165, v165, v25
    v_mul_f32 v166, v166, v25
    v_mul_f32 v167, v167, v25
    v_mul_f32 v168, v168, v25
    v_mul_f32 v169, v169, v25
    v_mul_f32 v170, v170, v25
    v_mul_f32 v171, v171, v25
    v_mul_f32 v172, v172, v25
    v_mul_f32 v173, v173, v25
    v_mul_f32 v174, v174, v25
    v_mul_f32 v175, v175, v25
    v_mul_f32 v176, v176, v25
    v_mul_f32 v177, v177, v25
    v_mul_f32 v178, v178, v25
    v_mul_f32 v179, v179, v25
    v_mul_f32 v180, v180, v25
    v_mul_f32 v181, v181, v25
    v_mul_f32 v182, v182, v25
    v_mul_f32 v183, v183, v25
    v_mul_f32 v184, v184, v25
    v_mul_f32 v185, v185, v25
    v_mul_f32 v186, v186, v25
    v_mul_f32 v187, v187, v25
    v_mul_f32 v188, v188, v25
    v_mul_f32 v189, v189, v25
    v_mul_f32 v190, v190, v25
    v_mul_f32 v191, v191, v25
    v_mul_f32 v192, v192, v25
    v_mul_f32 v193, v193, v25
    v_mul_f32 v194, v194, v25
    v_mul_f32 v195, v195, v25
    v_mul_f32 v196, v196, v25
    v_mul_f32 v197, v197, v25
    v_mul_f32 v198, v198, v25
    v_mul_f32 v199, v199, v25
    v_mul_f32 v200, v200, v25
    v_mul_f32 v201, v201, v25
    v_mul_f32 v202, v202, v25
    v_mul_f32 v203, v203, v25
    v_mul_f32 v204, v204, v25
    v_mul_f32 v205, v205, v25
    v_mul_f32 v206, v206, v25
    v_mul_f32 v207, v207, v25
    v_fma_f32 v104, v104, s28, v10
    v_fma_f32 v105, v105, s28, v10
    v_exp_f32 v104, v104
    v_exp_f32 v105, v105
    s_nop 0
    v_cvt_pk_bf16_f32 v20, v104, v105
    v_fma_f32 v106, v106, s28, v10
    v_fma_f32 v107, v107, s28, v10
    v_exp_f32 v106, v106
    v_exp_f32 v107, v107
    s_nop 0
    v_cvt_pk_bf16_f32 v21, v106, v107
    v_fma_f32 v108, v108, s28, v10
    v_fma_f32 v109, v109, s28, v10
    v_exp_f32 v108, v108
    v_exp_f32 v109, v109
    s_nop 0
    v_cvt_pk_bf16_f32 v22, v108, v109
    v_fma_f32 v110, v110, s28, v10
    v_fma_f32 v111, v111, s28, v10
    v_exp_f32 v110, v110
    v_exp_f32 v111, v111
    s_nop 0
    v_cvt_pk_bf16_f32 v23, v110, v111
    s_add_u32 s69, s39, 0
    buffer_load_dwordx4 v[44:47], v30, s[4:7], s69 offen offset:0
    s_waitcnt vmcnt(0)
    v_mfma_f32_16x16x32_bf16 v[104:107], v[44:47], a[144:147], 0
    s_nop 7
    buffer_load_dwordx4 v[44:47], v30, s[4:7], s69 offen offset:64
    s_waitcnt vmcnt(0)
    v_mfma_f32_16x16x32_bf16 v[104:107], v[44:47], a[148:151], v[104:107]
    s_nop 7
    buffer_load_dwordx4 v[44:47], v30, s[4:7], s69 offen offset:128
    s_waitcnt vmcnt(0)
    v_mfma_f32_16x16x32_bf16 v[104:107], v[44:47], a[152:155], v[104:107]
    s_nop 7
    buffer_load_dwordx4 v[44:47], v30, s[4:7], s69 offen offset:192
    s_waitcnt vmcnt(0)
    v_mfma_f32_16x16x32_bf16 v[104:107], v[44:47], a[156:159], v[104:107]
    s_nop 7
    buffer_load_dwordx4 v[44:47], v30, s[4:7], s69 offen offset:256
    s_waitcnt vmcnt(0)
    v_mfma_f32_16x16x32_bf16 v[104:107], v[44:47], a[160:163], v[104:107]
    s_nop 7
    buffer_load_dwordx4 v[44:47], v30, s[4:7], s69 offen offset:320
    s_waitcnt vmcnt(0)
    v_mfma_f32_16x16x32_bf16 v[104:107], v[44:47], a[164:167], v[104:107]
    s_nop 7
    s_add_u32 s69, s39, 6144
    buffer_load_dwordx4 v[44:47], v30, s[4:7], s69 offen offset:0
    s_waitcnt vmcnt(0)
    v_mfma_f32_16x16x32_bf16 v[108:111], v[44:47], a[144:147], 0
    s_nop 7
    buffer_load_dwordx4 v[44:47], v30, s[4:7], s69 offen offset:64
    s_waitcnt vmcnt(0)
    v_mfma_f32_16x16x32_bf16 v[108:111], v[44:47], a[148:151], v[108:111]
    s_nop 7
    buffer_load_dwordx4 v[44:47], v30, s[4:7], s69 offen offset:128
    s_waitcnt vmcnt(0)
    v_mfma_f32_16x16x32_bf16 v[108:111], v[44:47], a[152:155], v[108:111]
    s_nop 7
    buffer_load_dwordx4 v[44:47], v30, s[4:7], s69 offen offset:192
    s_waitcnt vmcnt(0)
    v_mfma_f32_16x16x32_bf16 v[108:111], v[44:47], a[156:159], v[108:111]
    s_nop 7
    buffer_load_dwordx4 v[44:47], v30, s[4:7], s69 offen offset:256
    s_waitcnt vmcnt(0)
    v_mfma_f32_16x16x32_bf16 v[108:111], v[44:47], a[160:163], v[108:111]
    s_nop 7
    buffer_load_dwordx4 v[44:47], v30, s[4:7], s69 offen offset:320
    s_waitcnt vmcnt(0)
    v_mfma_f32_16x16x32_bf16 v[108:111], v[44:47], a[164:167], v[108:111]
    s_nop 7
    s_nop 15
    v_max3_f32 v18, v104, v105, v106
    v_max3_f32 v18, v18, v107, v108
    v_max3_f32 v18, v18, v109, v110
    v_max_f32 v18, v18, v111
    v_mov_b32 v19, v18
    s_nop 1
    v_permlane32_swap_b32 v19, v18
    v_max_f32 v18, v18, v19
    v_mov_b32 v19, v18
    s_nop 1
    v_permlane16_swap_b32 v19, v18
    v_max_f32 v18, v18, v19
    v_fma_f32 v18, v18, s28, v11
    v_max_f32 v24, 0, v18
    v_sub_f32 v11, v11, v24
    v_sub_f32 v25, 0, v24
    v_exp_f32 v25, v25
    s_nop 0
    v_mul_f32 v50, v50, v25
    v_mul_f32 v208, v208, v25
    v_mul_f32 v209, v209, v25
    v_mul_f32 v210, v210, v25
    v_mul_f32 v211, v211, v25
    v_mul_f32 v212, v212, v25
    v_mul_f32 v213, v213, v25
    v_mul_f32 v214, v214, v25
    v_mul_f32 v215, v215, v25
    v_mul_f32 v216, v216, v25
    v_mul_f32 v217, v217, v25
    v_mul_f32 v218, v218, v25
    v_mul_f32 v219, v219, v25
    v_mul_f32 v220, v220, v25
    v_mul_f32 v221, v221, v25
    v_mul_f32 v222, v222, v25
    v_mul_f32 v223, v223, v25
    v_mul_f32 v224, v224, v25
    v_mul_f32 v225, v225, v25
    v_mul_f32 v226, v226, v25
    v_mul_f32 v227, v227, v25
    v_mul_f32 v228, v228, v25
    v_mul_f32 v229, v229, v25
    v_mul_f32 v230, v230, v25
    v_mul_f32 v231, v231, v25
    v_mul_f32 v232, v232, v25
    v_mul_f32 v233, v233, v25
    v_mul_f32 v234, v234, v25
    v_mul_f32 v235, v235, v25
    v_mul_f32 v236, v236, v25
    v_mul_f32 v237, v237, v25
    v_mul_f32 v238, v238, v25
    v_mul_f32 v239, v239, v25
    v_mul_f32 v240, v240, v25
    v_mul_f32 v241, v241, v25
    v_mul_f32 v242, v242, v25
    v_mul_f32 v243, v243, v25
    v_mul_f32 v244, v244, v25
    v_mul_f32 v245, v245, v25
    v_mul_f32 v246, v246, v25
    v_mul_f32 v247, v247, v25
    v_mul_f32 v248, v248, v25
    v_mul_f32 v249, v249, v25
    v_mul_f32 v250, v250, v25
    v_mul_f32 v251, v251, v25
    v_mul_f32 v252, v252, v25
    v_mul_f32 v253, v253, v25
    v_mul_f32 v254, v254, v25
    v_mul_f32 v255, v255, v25
    v_fma_f32 v104, v104, s28, v11
    v_fma_f32 v105, v105, s28, v11
    v_exp_f32 v104, v104
    v_exp_f32 v105, v105
    s_nop 0
    v_cvt_pk_bf16_f32 v26, v104, v105
    v_fma_f32 v106, v106, s28, v11
    v_fma_f32 v107, v107, s28, v11
    v_exp_f32 v106, v106
    v_exp_f32 v107, v107
    s_nop 0
    v_cvt_pk_bf16_f32 v27, v106, v107
    v_fma_f32 v108, v108, s28, v11
    v_fma_f32 v109, v109, s28, v11
    v_exp_f32 v108, v108
    v_exp_f32 v109, v109
    s_nop 0
    v_cvt_pk_bf16_f32 v28, v108, v109
    v_fma_f32 v110, v110, s28, v11
    v_fma_f32 v111, v111, s28, v11
    v_exp_f32 v110, v110
    v_exp_f32 v111, v111
    s_nop 0
    v_cvt_pk_bf16_f32 v29, v110, v111
    s_add_u32 s69, s39, 0
    buffer_load_dwordx4 v[44:47], v30, s[4:7], s69 offen offset:0
    s_waitcnt vmcnt(0)
    v_mfma_f32_16x16x32_bf16 v[104:107], v[44:47], a[168:171], 0
    s_nop 7
    buffer_load_dwordx4 v[44:47], v30, s[4:7], s69 offen offset:64
    s_waitcnt vmcnt(0)
    v_mfma_f32_16x16x32_bf16 v[104:107], v[44:47], a[172:175], v[104:107]
    s_nop 7
    buffer_load_dwordx4 v[44:47], v30, s[4:7], s69 offen offset:128
    s_waitcnt vmcnt(0)
    v_mfma_f32_16x16x32_bf16 v[104:107], v[44:47], a[176:179], v[104:107]
    s_nop 7
    buffer_load_dwordx4 v[44:47], v30, s[4:7], s69 offen offset:192
    s_waitcnt vmcnt(0)
    v_mfma_f32_16x16x32_bf16 v[104:107], v[44:47], a[180:183], v[104:107]
    s_nop 7
    buffer_load_dwordx4 v[44:47], v30, s[4:7], s69 offen offset:256
    s_waitcnt vmcnt(0)
    v_mfma_f32_16x16x32_bf16 v[104:107], v[44:47], a[184:187], v[104:107]
    s_nop 7
    buffer_load_dwordx4 v[44:47], v30, s[4:7], s69 offen offset:320
    s_waitcnt vmcnt(0)
    v_mfma_f32_16x16x32_bf16 v[104:107], v[44:47], a[188:191], v[104:107]
    s_nop 7
    s_add_u32 s69, s39, 6144
    buffer_load_dwordx4 v[44:47], v30, s[4:7], s69 offen offset:0
    s_waitcnt vmcnt(0)
    v_mfma_f32_16x16x32_bf16 v[108:111], v[44:47], a[168:171], 0
    s_nop 7
    buffer_load_dwordx4 v[44:47], v30, s[4:7], s69 offen offset:64
    s_waitcnt vmcnt(0)
    v_mfma_f32_16x16x32_bf16 v[108:111], v[44:47], a[172:175], v[108:111]
    s_nop 7
    buffer_load_dwordx4 v[44:47], v30, s[4:7], s69 offen offset:128
    s_waitcnt vmcnt(0)
    v_mfma_f32_16x16x32_bf16 v[108:111], v[44:47], a[176:179], v[108:111]
    s_nop 7
    buffer_load_dwordx4 v[44:47], v30, s[4:7], s69 offen offset:192
    s_waitcnt vmcnt(0)
    v_mfma_f32_16x16x32_bf16 v[108:111], v[44:47], a[180:183], v[108:111]
    s_nop 7
    buffer_load_dwordx4 v[44:47], v30, s[4:7], s69 offen offset:256
    s_waitcnt vmcnt(0)
    v_mfma_f32_16x16x32_bf16 v[108:111], v[44:47], a[184:187], v[108:111]
    s_nop 7
    buffer_load_dwordx4 v[44:47], v30, s[4:7], s69 offen offset:320
    s_waitcnt vmcnt(0)
    v_mfma_f32_16x16x32_bf16 v[108:111], v[44:47], a[188:191], v[108:111]
    s_nop 7
    s_nop 15
    v_max3_f32 v18, v104, v105, v106
    v_max3_f32 v18, v18, v107, v108
    v_max3_f32 v18, v18, v109, v110
    v_max_f32 v18, v18, v111
    v_mov_b32 v19, v18
    s_nop 1
    v_permlane32_swap_b32 v19, v18
    v_max_f32 v18, v18, v19
    v_mov_b32 v19, v18
    s_nop 1
    v_permlane16_swap_b32 v19, v18
    v_max_f32 v18, v18, v19
    v_fma_f32 v18, v18, s28, v12
    v_max_f32 v24, 0, v18
    v_sub_f32 v12, v12, v24
    v_sub_f32 v25, 0, v24
    v_exp_f32 v25, v25
    s_nop 0
    v_mul_f32 v51, v51, v25
    v_accvgpr_read_b32 v19, a0
    v_mul_f32 v19, v19, v25
    v_accvgpr_write_b32 a0, v19
    v_accvgpr_read_b32 v19, a1
    v_mul_f32 v19, v19, v25
    v_accvgpr_write_b32 a1, v19
    v_accvgpr_read_b32 v19, a2
    v_mul_f32 v19, v19, v25
    v_accvgpr_write_b32 a2, v19
    v_accvgpr_read_b32 v19, a3
    v_mul_f32 v19, v19, v25
    v_accvgpr_write_b32 a3, v19
    v_accvgpr_read_b32 v19, a4
    v_mul_f32 v19, v19, v25
    v_accvgpr_write_b32 a4, v19
    v_accvgpr_read_b32 v19, a5
    v_mul_f32 v19, v19, v25
    v_accvgpr_write_b32 a5, v19
    v_accvgpr_read_b32 v19, a6
    v_mul_f32 v19, v19, v25
    v_accvgpr_write_b32 a6, v19
    v_accvgpr_read_b32 v19, a7
    v_mul_f32 v19, v19, v25
    v_accvgpr_write_b32 a7, v19
    v_accvgpr_read_b32 v19, a8
    v_mul_f32 v19, v19, v25
    v_accvgpr_write_b32 a8, v19
    v_accvgpr_read_b32 v19, a9
    v_mul_f32 v19, v19, v25
    v_accvgpr_write_b32 a9, v19
    v_accvgpr_read_b32 v19, a10
    v_mul_f32 v19, v19, v25
    v_accvgpr_write_b32 a10, v19
    v_accvgpr_read_b32 v19, a11
    v_mul_f32 v19, v19, v25
    v_accvgpr_write_b32 a11, v19
    v_accvgpr_read_b32 v19, a12
    v_mul_f32 v19, v19, v25
    v_accvgpr_write_b32 a12, v19
    v_accvgpr_read_b32 v19, a13
    v_mul_f32 v19, v19, v25
    v_accvgpr_write_b32 a13, v19
    v_accvgpr_read_b32 v19, a14
    v_mul_f32 v19, v19, v25
    v_accvgpr_write_b32 a14, v19
    v_accvgpr_read_b32 v19, a15
    v_mul_f32 v19, v19, v25
    v_accvgpr_write_b32 a15, v19
    v_accvgpr_read_b32 v19, a16
    v_mul_f32 v19, v19, v25
    v_accvgpr_write_b32 a16, v19
    v_accvgpr_read_b32 v19, a17
    v_mul_f32 v19, v19, v25
    v_accvgpr_write_b32 a17, v19
    v_accvgpr_read_b32 v19, a18
    v_mul_f32 v19, v19, v25
    v_accvgpr_write_b32 a18, v19
    v_accvgpr_read_b32 v19, a19
    v_mul_f32 v19, v19, v25
    v_accvgpr_write_b32 a19, v19
    v_accvgpr_read_b32 v19, a20
    v_mul_f32 v19, v19, v25
    v_accvgpr_write_b32 a20, v19
    v_accvgpr_read_b32 v19, a21
    v_mul_f32 v19, v19, v25
    v_accvgpr_write_b32 a21, v19
    v_accvgpr_read_b32 v19, a22
    v_mul_f32 v19, v19, v25
    v_accvgpr_write_b32 a22, v19
    v_accvgpr_read_b32 v19, a23
    v_mul_f32 v19, v19, v25
    v_accvgpr_write_b32 a23, v19
    v_accvgpr_read_b32 v19, a24
    v_mul_f32 v19, v19, v25
    v_accvgpr_write_b32 a24, v19
    v_accvgpr_read_b32 v19, a25
    v_mul_f32 v19, v19, v25
    v_accvgpr_write_b32 a25, v19
    v_accvgpr_read_b32 v19, a26
    v_mul_f32 v19, v19, v25
    v_accvgpr_write_b32 a26, v19
    v_accvgpr_read_b32 v19, a27
    v_mul_f32 v19, v19, v25
    v_accvgpr_write_b32 a27, v19
    v_accvgpr_read_b32 v19, a28
    v_mul_f32 v19, v19, v25
    v_accvgpr_write_b32 a28, v19
    v_accvgpr_read_b32 v19, a29
    v_mul_f32 v19, v19, v25
    v_accvgpr_write_b32 a29, v19
    v_accvgpr_read_b32 v19, a30
    v_mul_f32 v19, v19, v25
    v_accvgpr_write_b32 a30, v19
    v_accvgpr_read_b32 v19, a31
    v_mul_f32 v19, v19, v25
    v_accvgpr_write_b32 a31, v19
    v_accvgpr_read_b32 v19, a32
    v_mul_f32 v19, v19, v25
    v_accvgpr_write_b32 a32, v19
    v_accvgpr_read_b32 v19, a33
    v_mul_f32 v19, v19, v25
    v_accvgpr_write_b32 a33, v19
    v_accvgpr_read_b32 v19, a34
    v_mul_f32 v19, v19, v25
    v_accvgpr_write_b32 a34, v19
    v_accvgpr_read_b32 v19, a35
    v_mul_f32 v19, v19, v25
    v_accvgpr_write_b32 a35, v19
    v_accvgpr_read_b32 v19, a36
    v_mul_f32 v19, v19, v25
    v_accvgpr_write_b32 a36, v19
    v_accvgpr_read_b32 v19, a37
    v_mul_f32 v19, v19, v25
    v_accvgpr_write_b32 a37, v19
    v_accvgpr_read_b32 v19, a38
    v_mul_f32 v19, v19, v25
    v_accvgpr_write_b32 a38, v19
    v_accvgpr_read_b32 v19, a39
    v_mul_f32 v19, v19, v25
    v_accvgpr_write_b32 a39, v19
    v_accvgpr_read_b32 v19, a40
    v_mul_f32 v19, v19, v25
    v_accvgpr_write_b32 a40, v19
    v_accvgpr_read_b32 v19, a41
    v_mul_f32 v19, v19, v25
    v_accvgpr_write_b32 a41, v19
    v_accvgpr_read_b32 v19, a42
    v_mul_f32 v19, v19, v25
    v_accvgpr_write_b32 a42, v19
    v_accvgpr_read_b32 v19, a43
    v_mul_f32 v19, v19, v25
    v_accvgpr_write_b32 a43, v19
    v_accvgpr_read_b32 v19, a44
    v_mul_f32 v19, v19, v25
    v_accvgpr_write_b32 a44, v19
    v_accvgpr_read_b32 v19, a45
    v_mul_f32 v19, v19, v25
    v_accvgpr_write_b32 a45, v19
    v_accvgpr_read_b32 v19, a46
    v_mul_f32 v19, v19, v25
    v_accvgpr_write_b32 a46, v19
    v_accvgpr_read_b32 v19, a47
    v_mul_f32 v19, v19, v25
    v_accvgpr_write_b32 a47, v19
    v_fma_f32 v104, v104, s28, v12
    v_fma_f32 v105, v105, s28, v12
    v_exp_f32 v104, v104
    v_exp_f32 v105, v105
    s_nop 0
    v_cvt_pk_bf16_f32 v32, v104, v105
    v_fma_f32 v106, v106, s28, v12
    v_fma_f32 v107, v107, s28, v12
    v_exp_f32 v106, v106
    v_exp_f32 v107, v107
    s_nop 0
    v_cvt_pk_bf16_f32 v33, v106, v107
    v_fma_f32 v108, v108, s28, v12
    v_fma_f32 v109, v109, s28, v12
    v_exp_f32 v108, v108
    v_exp_f32 v109, v109
    s_nop 0
    v_cvt_pk_bf16_f32 v34, v108, v109
    v_fma_f32 v110, v110, s28, v12
    v_fma_f32 v111, v111, s28, v12
    v_exp_f32 v110, v110
    v_exp_f32 v111, v111
    s_nop 0
    v_cvt_pk_bf16_f32 v35, v110, v111
    s_add_u32 s69, s39, 0
    buffer_load_dwordx4 v[44:47], v30, s[4:7], s69 offen offset:0
    s_waitcnt vmcnt(0)
    v_mfma_f32_16x16x32_bf16 v[104:107], v[44:47], a[192:195], 0
    s_nop 7
    buffer_load_dwordx4 v[44:47], v30, s[4:7], s69 offen offset:64
    s_waitcnt vmcnt(0)
    v_mfma_f32_16x16x32_bf16 v[104:107], v[44:47], a[196:199], v[104:107]
    s_nop 7
    buffer_load_dwordx4 v[44:47], v30, s[4:7], s69 offen offset:128
    s_waitcnt vmcnt(0)
    v_mfma_f32_16x16x32_bf16 v[104:107], v[44:47], a[200:203], v[104:107]
    s_nop 7
    buffer_load_dwordx4 v[44:47], v30, s[4:7], s69 offen offset:192
    s_waitcnt vmcnt(0)
    v_mfma_f32_16x16x32_bf16 v[104:107], v[44:47], a[204:207], v[104:107]
    s_nop 7
    buffer_load_dwordx4 v[44:47], v30, s[4:7], s69 offen offset:256
    s_waitcnt vmcnt(0)
    v_mfma_f32_16x16x32_bf16 v[104:107], v[44:47], a[208:211], v[104:107]
    s_nop 7
    buffer_load_dwordx4 v[44:47], v30, s[4:7], s69 offen offset:320
    s_waitcnt vmcnt(0)
    v_mfma_f32_16x16x32_bf16 v[104:107], v[44:47], v[92:95], v[104:107]
    s_nop 7
    s_add_u32 s69, s39, 6144
    buffer_load_dwordx4 v[44:47], v30, s[4:7], s69 offen offset:0
    s_waitcnt vmcnt(0)
    v_mfma_f32_16x16x32_bf16 v[108:111], v[44:47], a[192:195], 0
    s_nop 7
    buffer_load_dwordx4 v[44:47], v30, s[4:7], s69 offen offset:64
    s_waitcnt vmcnt(0)
    v_mfma_f32_16x16x32_bf16 v[108:111], v[44:47], a[196:199], v[108:111]
    s_nop 7
    buffer_load_dwordx4 v[44:47], v30, s[4:7], s69 offen offset:128
    s_waitcnt vmcnt(0)
    v_mfma_f32_16x16x32_bf16 v[108:111], v[44:47], a[200:203], v[108:111]
    s_nop 7
    buffer_load_dwordx4 v[44:47], v30, s[4:7], s69 offen offset:192
    s_waitcnt vmcnt(0)
    v_mfma_f32_16x16x32_bf16 v[108:111], v[44:47], a[204:207], v[108:111]
    s_nop 7
    buffer_load_dwordx4 v[44:47], v30, s[4:7], s69 offen offset:256
    s_waitcnt vmcnt(0)
    v_mfma_f32_16x16x32_bf16 v[108:111], v[44:47], a[208:211], v[108:111]
    s_nop 7
    buffer_load_dwordx4 v[44:47], v30, s[4:7], s69 offen offset:320
    s_waitcnt vmcnt(0)
    v_mfma_f32_16x16x32_bf16 v[108:111], v[44:47], v[92:95], v[108:111]
    s_nop 7
    s_nop 15
    v_max3_f32 v18, v104, v105, v106
    v_max3_f32 v18, v18, v107, v108
    v_max3_f32 v18, v18, v109, v110
    v_max_f32 v18, v18, v111
    v_mov_b32 v19, v18
    s_nop 1
    v_permlane32_swap_b32 v19, v18
    v_max_f32 v18, v18, v19
    v_mov_b32 v19, v18
    s_nop 1
    v_permlane16_swap_b32 v19, v18
    v_max_f32 v18, v18, v19
    v_fma_f32 v18, v18, s28, v13
    v_max_f32 v24, 0, v18
    v_sub_f32 v13, v13, v24
    v_sub_f32 v25, 0, v24
    v_exp_f32 v25, v25
    s_nop 0
    v_mul_f32 v19, v48, v25
    v_cndmask_b32_e64 v48, v48, v19, s[60:61]
    v_accvgpr_read_b32 v19, a48
    v_mul_f32 v19, v19, v25
    v_accvgpr_write_b32 a48, v19
    v_accvgpr_read_b32 v19, a49
    v_mul_f32 v19, v19, v25
    v_accvgpr_write_b32 a49, v19
    v_accvgpr_read_b32 v19, a50
    v_mul_f32 v19, v19, v25
    v_accvgpr_write_b32 a50, v19
    v_accvgpr_read_b32 v19, a51
    v_mul_f32 v19, v19, v25
    v_accvgpr_write_b32 a51, v19
    v_accvgpr_read_b32 v19, a52
    v_mul_f32 v19, v19, v25
    v_accvgpr_write_b32 a52, v19
    v_accvgpr_read_b32 v19, a53
    v_mul_f32 v19, v19, v25
    v_accvgpr_write_b32 a53, v19
    v_accvgpr_read_b32 v19, a54
    v_mul_f32 v19, v19, v25
    v_accvgpr_write_b32 a54, v19
    v_accvgpr_read_b32 v19, a55
    v_mul_f32 v19, v19, v25
    v_accvgpr_write_b32 a55, v19
    v_accvgpr_read_b32 v19, a56
    v_mul_f32 v19, v19, v25
    v_accvgpr_write_b32 a56, v19
    v_accvgpr_read_b32 v19, a57
    v_mul_f32 v19, v19, v25
    v_accvgpr_write_b32 a57, v19
    v_accvgpr_read_b32 v19, a58
    v_mul_f32 v19, v19, v25
    v_accvgpr_write_b32 a58, v19
    v_accvgpr_read_b32 v19, a59
    v_mul_f32 v19, v19, v25
    v_accvgpr_write_b32 a59, v19
    v_accvgpr_read_b32 v19, a60
    v_mul_f32 v19, v19, v25
    v_accvgpr_write_b32 a60, v19
    v_accvgpr_read_b32 v19, a61
    v_mul_f32 v19, v19, v25
    v_accvgpr_write_b32 a61, v19
    v_accvgpr_read_b32 v19, a62
    v_mul_f32 v19, v19, v25
    v_accvgpr_write_b32 a62, v19
    v_accvgpr_read_b32 v19, a63
    v_mul_f32 v19, v19, v25
    v_accvgpr_write_b32 a63, v19
    v_accvgpr_read_b32 v19, a64
    v_mul_f32 v19, v19, v25
    v_accvgpr_write_b32 a64, v19
    v_accvgpr_read_b32 v19, a65
    v_mul_f32 v19, v19, v25
    v_accvgpr_write_b32 a65, v19
    v_accvgpr_read_b32 v19, a66
    v_mul_f32 v19, v19, v25
    v_accvgpr_write_b32 a66, v19
    v_accvgpr_read_b32 v19, a67
    v_mul_f32 v19, v19, v25
    v_accvgpr_write_b32 a67, v19
    v_accvgpr_read_b32 v19, a68
    v_mul_f32 v19, v19, v25
    v_accvgpr_write_b32 a68, v19
    v_accvgpr_read_b32 v19, a69
    v_mul_f32 v19, v19, v25
    v_accvgpr_write_b32 a69, v19
    v_accvgpr_read_b32 v19, a70
    v_mul_f32 v19, v19, v25
    v_accvgpr_write_b32 a70, v19
    v_accvgpr_read_b32 v19, a71
    v_mul_f32 v19, v19, v25
    v_accvgpr_write_b32 a71, v19
    v_accvgpr_read_b32 v19, a72
    v_mul_f32 v19, v19, v25
    v_accvgpr_write_b32 a72, v19
    v_accvgpr_read_b32 v19, a73
    v_mul_f32 v19, v19, v25
    v_accvgpr_write_b32 a73, v19
    v_accvgpr_read_b32 v19, a74
    v_mul_f32 v19, v19, v25
    v_accvgpr_write_b32 a74, v19
    v_accvgpr_read_b32 v19, a75
    v_mul_f32 v19, v19, v25
    v_accvgpr_write_b32 a75, v19
    v_accvgpr_read_b32 v19, a76
    v_mul_f32 v19, v19, v25
    v_accvgpr_write_b32 a76, v19
    v_accvgpr_read_b32 v19, a77
    v_mul_f32 v19, v19, v25
    v_accvgpr_write_b32 a77, v19
    v_accvgpr_read_b32 v19, a78
    v_mul_f32 v19, v19, v25
    v_accvgpr_write_b32 a78, v19
    v_accvgpr_read_b32 v19, a79
    v_mul_f32 v19, v19, v25
    v_accvgpr_write_b32 a79, v19
    v_accvgpr_read_b32 v19, a80
    v_mul_f32 v19, v19, v25
    v_accvgpr_write_b32 a80, v19
    v_accvgpr_read_b32 v19, a81
    v_mul_f32 v19, v19, v25
    v_accvgpr_write_b32 a81, v19
    v_accvgpr_read_b32 v19, a82
    v_mul_f32 v19, v19, v25
    v_accvgpr_write_b32 a82, v19
    v_accvgpr_read_b32 v19, a83
    v_mul_f32 v19, v19, v25
    v_accvgpr_write_b32 a83, v19
    v_accvgpr_read_b32 v19, a84
    v_mul_f32 v19, v19, v25
    v_accvgpr_write_b32 a84, v19
    v_accvgpr_read_b32 v19, a85
    v_mul_f32 v19, v19, v25
    v_accvgpr_write_b32 a85, v19
    v_accvgpr_read_b32 v19, a86
    v_mul_f32 v19, v19, v25
    v_accvgpr_write_b32 a86, v19
    v_accvgpr_read_b32 v19, a87
    v_mul_f32 v19, v19, v25
    v_accvgpr_write_b32 a87, v19
    v_accvgpr_read_b32 v19, a88
    v_mul_f32 v19, v19, v25
    v_accvgpr_write_b32 a88, v19
    v_accvgpr_read_b32 v19, a89
    v_mul_f32 v19, v19, v25
    v_accvgpr_write_b32 a89, v19
    v_accvgpr_read_b32 v19, a90
    v_mul_f32 v19, v19, v25
    v_accvgpr_write_b32 a90, v19
    v_accvgpr_read_b32 v19, a91
    v_mul_f32 v19, v19, v25
    v_accvgpr_write_b32 a91, v19
    v_accvgpr_read_b32 v19, a92
    v_mul_f32 v19, v19, v25
    v_accvgpr_write_b32 a92, v19
    v_accvgpr_read_b32 v19, a93
    v_mul_f32 v19, v19, v25
    v_accvgpr_write_b32 a93, v19
    v_accvgpr_read_b32 v19, a94
    v_mul_f32 v19, v19, v25
    v_accvgpr_write_b32 a94, v19
    v_accvgpr_read_b32 v19, a95
    v_mul_f32 v19, v19, v25
    v_accvgpr_write_b32 a95, v19
    v_fma_f32 v104, v104, s28, v13
    v_fma_f32 v105, v105, s28, v13
    v_exp_f32 v104, v104
    v_exp_f32 v105, v105
    s_nop 0
    v_cvt_pk_bf16_f32 v38, v104, v105
    v_fma_f32 v106, v106, s28, v13
    v_fma_f32 v107, v107, s28, v13
    v_exp_f32 v106, v106
    v_exp_f32 v107, v107
    s_nop 0
    v_cvt_pk_bf16_f32 v39, v106, v107
    v_fma_f32 v108, v108, s28, v13
    v_fma_f32 v109, v109, s28, v13
    v_exp_f32 v108, v108
    v_exp_f32 v109, v109
    s_nop 0
    v_cvt_pk_bf16_f32 v40, v108, v109
    v_fma_f32 v110, v110, s28, v13
    v_fma_f32 v111, v111, s28, v13
    v_exp_f32 v110, v110
    v_exp_f32 v111, v111
    s_nop 0
    v_cvt_pk_bf16_f32 v41, v110, v111
    v_mfma_f32_16x16x32_bf16 v[44:47], a[236:239], v[14:17], v[48:51]
    v_mfma_f32_16x16x32_bf16 v[44:47], a[240:243], v[20:23], v[44:47]
    v_mfma_f32_16x16x32_bf16 v[44:47], a[244:247], v[26:29], v[44:47]
    v_mfma_f32_16x16x32_bf16 v[44:47], a[248:251], v[32:35], v[44:47]
    v_mfma_f32_16x16x32_bf16 v[44:47], a[252:255], v[38:41], v[44:47]
    s_nop 15
    s_setpc_b64 s[40:41]
L_rare5_1:
    s_nop 15
    v_mbcnt_lo_u32_b32 v27, -1, 0
    v_mbcnt_hi_u32_b32 v27, -1, v27
    v_and_b32 v26, 15, v27
    v_mul_u32_u24 v26, 384, v26
    v_lshrrev_b32 v27, 4, v27
    v_lshl_add_u32 v26, v27, 4, v26
    s_add_u32 s69, s39, 0
    buffer_load_dwordx4 v[48:51], v26, s[4:7], s69 offen offset:0
    s_waitcnt vmcnt(0)
    v_mfma_f32_16x16x32_bf16 v[104:107], v[48:51], a[96:99], 0
    s_nop 7
    buffer_load_dwordx4 v[48:51], v26, s[4:7], s69 offen offset:64
    s_waitcnt vmcnt(0)
    v_mfma_f32_16x16x32_bf16 v[104:107], v[48:51], a[100:103], v[104:107]
    s_nop 7
    buffer_load_dwordx4 v[48:51], v26, s[4:7], s69 offen offset:128
    s_waitcnt vmcnt(0)
    v_mfma_f32_16x16x32_bf16 v[104:107], v[48:51], a[104:107], v[104:107]
    s_nop 7
    buffer_load_dwordx4 v[48:51], v26, s[4:7], s69 offen offset:192
    s_waitcnt vmcnt(0)
    v_mfma_f32_16x16x32_bf16 v[104:107], v[48:51], a[108:111], v[104:107]
    s_nop 7
    buffer_load_dwordx4 v[48:51], v26, s[4:7], s69 offen offset:256
    s_waitcnt vmcnt(0)
    v_mfma_f32_16x16x32_bf16 v[104:107], v[48:51], a[112:115], v[104:107]
    s_nop 7
    buffer_load_dwordx4 v[48:51], v26, s[4:7], s69 offen offset:320
    s_waitcnt vmcnt(0)
    v_mfma_f32_16x16x32_bf16 v[104:107], v[48:51], a[116:119], v[104:107]
    s_nop 7
    s_add_u32 s69, s39, 6144
    buffer_load_dwordx4 v[48:51], v26, s[4:7], s69 offen offset:0
    s_waitcnt vmcnt(0)
    v_mfma_f32_16x16x32_bf16 v[108:111], v[48:51], a[96:99], 0
    s_nop 7
    buffer_load_dwordx4 v[48:51], v26, s[4:7], s69 offen offset:64
    s_waitcnt vmcnt(0)
    v_mfma_f32_16x16x32_bf16 v[108:111], v[48:51], a[100:103], v[108:111]
    s_nop 7
    buffer_load_dwordx4 v[48:51], v26, s[4:7], s69 offen offset:128
    s_waitcnt vmcnt(0)
    v_mfma_f32_16x16x32_bf16 v[108:111], v[48:51], a[104:107], v[108:111]
    s_nop 7
    buffer_load_dwordx4 v[48:51], v26, s[4:7], s69 offen offset:192
    s_waitcnt vmcnt(0)
    v_mfma_f32_16x16x32_bf16 v[108:111], v[48:51], a[108:111], v[108:111]
    s_nop 7
    buffer_load_dwordx4 v[48:51], v26, s[4:7], s69 offen offset:256
    s_waitcnt vmcnt(0)
    v_mfma_f32_16x16x32_bf16 v[108:111], v[48:51], a[112:115], v[108:111]
    s_nop 7
    buffer_load_dwordx4 v[48:51], v26, s[4:7], s69 offen offset:320
    s_waitcnt vmcnt(0)
    v_mfma_f32_16x16x32_bf16 v[108:111], v[48:51], a[116:119], v[108:111]
    s_nop 7
    s_nop 15
    v_max3_f32 v14, v104, v105, v106
    v_max3_f32 v14, v14, v107, v108
    v_max3_f32 v14, v14, v109, v110
    v_max_f32 v14, v14, v111
    v_mov_b32 v15, v14
    s_nop 1
    v_permlane32_swap_b32 v15, v14
    v_max_f32 v14, v14, v15
    v_mov_b32 v15, v14
    s_nop 1
    v_permlane16_swap_b32 v15, v14
    v_max_f32 v14, v14, v15
    v_fma_f32 v14, v14, s28, v9
    v_max_f32 v20, 0, v14
    v_sub_f32 v9, v9, v20
    v_sub_f32 v21, 0, v20
    v_exp_f32 v21, v21
    s_nop 0
    v_mul_f32 v15, v44, v21
    v_cndmask_b32_e64 v44, v15, v44, s[60:61]
    v_cndmask_b32_e64 v44, v44, 0, s[46:47]
    v_mul_f32 v112, v112, v21
    v_mul_f32 v113, v113, v21
    v_mul_f32 v114, v114, v21
    v_mul_f32 v115, v115, v21
    v_mul_f32 v116, v116, v21
    v_mul_f32 v117, v117, v21
    v_mul_f32 v118, v118, v21
    v_mul_f32 v119, v119, v21
    v_mul_f32 v120, v120, v21
    v_mul_f32 v121, v121, v21
    v_mul_f32 v122, v122, v21
    v_mul_f32 v123, v123, v21
    v_mul_f32 v124, v124, v21
    v_mul_f32 v125, v125, v21
    v_mul_f32 v126, v126, v21
    v_mul_f32 v127, v127, v21
    v_mul_f32 v128, v128, v21
    v_mul_f32 v129, v129, v21
    v_mul_f32 v130, v130, v21
    v_mul_f32 v131, v131, v21
    v_mul_f32 v132, v132, v21
    v_mul_f32 v133, v133, v21
    v_mul_f32 v134, v134, v21
    v_mul_f32 v135, v135, v21
    v_mul_f32 v136, v136, v21
    v_mul_f32 v137, v137, v21
    v_mul_f32 v138, v138, v21
    v_mul_f32 v139, v139, v21
    v_mul_f32 v140, v140, v21
    v_mul_f32 v141, v141, v21
    v_mul_f32 v142, v142, v21
    v_mul_f32 v143, v143, v21
    v_mul_f32 v144, v144, v21
    v_mul_f32 v145, v145, v21
    v_mul_f32 v146, v146, v21
    v_mul_f32 v147, v147, v21
    v_mul_f32 v148, v148, v21
    v_mul_f32 v149, v149, v21
    v_mul_f32 v150, v150, v21
    v_mul_f32 v151, v151, v21
    v_mul_f32 v152, v152, v21
    v_mul_f32 v153, v153, v21
    v_mul_f32 v154, v154, v21
    v_mul_f32 v155, v155, v21
    v_mul_f32 v156, v156, v21
    v_mul_f32 v157, v157, v21
    v_mul_f32 v158, v158, v21
    v_mul_f32 v159, v159, v21
    v_fma_f32 v104, v104, s28, v9
    v_fma_f32 v105, v105, s28, v9
    v_exp_f32 v104, v104
    v_exp_f32 v105, v105
    s_nop 0
    v_cvt_pk_bf16_f32 v18, v104, v105
    v_fma_f32 v106, v106, s28, v9
    v_fma_f32 v107, v107, s28, v9
    v_exp_f32 v106, v106
    v_exp_f32 v107, v107
    s_nop 0
    v_cvt_pk_bf16_f32 v19, v106, v107
    v_fma_f32 v108, v108, s28, v9
    v_fma_f32 v109, v109, s28, v9
    v_exp_f32 v108, v108
    v_exp_f32 v109, v109
    s_nop 0
    v_cvt_pk_bf16_f32 v16, v108, v109
    v_fma_f32 v110, v110, s28, v9
    v_fma_f32 v111, v111, s28, v9
    v_exp_f32 v110, v110
    v_exp_f32 v111, v111
    s_nop 0
    v_cvt_pk_bf16_f32 v17, v110, v111
    s_add_u32 s69, s39, 0
    buffer_load_dwordx4 v[48:51], v26, s[4:7], s69 offen offset:0
    s_waitcnt vmcnt(0)
    v_mfma_f32_16x16x32_bf16 v[104:107], v[48:51], a[120:123], 0
    s_nop 7
    buffer_load_dwordx4 v[48:51], v26, s[4:7], s69 offen offset:64
    s_waitcnt vmcnt(0)
    v_mfma_f32_16x16x32_bf16 v[104:107], v[48:51], a[124:127], v[104:107]
    s_nop 7
    buffer_load_dwordx4 v[48:51], v26, s[4:7], s69 offen offset:128
    s_waitcnt vmcnt(0)
    v_mfma_f32_16x16x32_bf16 v[104:107], v[48:51], a[128:131], v[104:107]
    s_nop 7
    buffer_load_dwordx4 v[48:51], v26, s[4:7], s69 offen offset:192
    s_waitcnt vmcnt(0)
    v_mfma_f32_16x16x32_bf16 v[104:107], v[48:51], a[132:135], v[104:107]
    s_nop 7
    buffer_load_dwordx4 v[48:51], v26, s[4:7], s69 offen offset:256
    s_waitcnt vmcnt(0)
    v_mfma_f32_16x16x32_bf16 v[104:107], v[48:51], a[136:139], v[104:107]
    s_nop 7
    buffer_load_dwordx4 v[48:51], v26, s[4:7], s69 offen offset:320
    s_waitcnt vmcnt(0)
    v_mfma_f32_16x16x32_bf16 v[104:107], v[48:51], a[140:143], v[104:107]
    s_nop 7
    s_add_u32 s69, s39, 6144
    buffer_load_dwordx4 v[48:51], v26, s[4:7], s69 offen offset:0
    s_waitcnt vmcnt(0)
    v_mfma_f32_16x16x32_bf16 v[108:111], v[48:51], a[120:123], 0
    s_nop 7
    buffer_load_dwordx4 v[48:51], v26, s[4:7], s69 offen offset:64
    s_waitcnt vmcnt(0)
    v_mfma_f32_16x16x32_bf16 v[108:111], v[48:51], a[124:127], v[108:111]
    s_nop 7
    buffer_load_dwordx4 v[48:51], v26, s[4:7], s69 offen offset:128
    s_waitcnt vmcnt(0)
    v_mfma_f32_16x16x32_bf16 v[108:111], v[48:51], a[128:131], v[108:111]
    s_nop 7
    buffer_load_dwordx4 v[48:51], v26, s[4:7], s69 offen offset:192
    s_waitcnt vmcnt(0)
    v_mfma_f32_16x16x32_bf16 v[108:111], v[48:51], a[132:135], v[108:111]
    s_nop 7
    buffer_load_dwordx4 v[48:51], v26, s[4:7], s69 offen offset:256
    s_waitcnt vmcnt(0)
    v_mfma_f32_16x16x32_bf16 v[108:111], v[48:51], a[136:139], v[108:111]
    s_nop 7
    buffer_load_dwordx4 v[48:51], v26, s[4:7], s69 offen offset:320
    s_waitcnt vmcnt(0)
    v_mfma_f32_16x16x32_bf16 v[108:111], v[48:51], a[140:143], v[108:111]
    s_nop 7
    s_nop 15
    v_max3_f32 v14, v104, v105, v106
    v_max3_f32 v14, v14, v107, v108
    v_max3_f32 v14, v14, v109, v110
    v_max_f32 v14, v14, v111
    v_mov_b32 v15, v14
    s_nop 1
    v_permlane32_swap_b32 v15, v14
    v_max_f32 v14, v14, v15
    v_mov_b32 v15, v14
    s_nop 1
    v_permlane16_swap_b32 v15, v14
    v_max_f32 v14, v14, v15
    v_fma_f32 v14, v14, s28, v10
    v_max_f32 v20, 0, v14
    v_sub_f32 v10, v10, v20
    v_sub_f32 v21, 0, v20
    v_exp_f32 v21, v21
    s_nop 0
    v_mul_f32 v45, v45, v21
    v_mul_f32 v160, v160, v21
    v_mul_f32 v161, v161, v21
    v_mul_f32 v162, v162, v21
    v_mul_f32 v163, v163, v21
    v_mul_f32 v164, v164, v21
    v_mul_f32 v165, v165, v21
    v_mul_f32 v166, v166, v21
    v_mul_f32 v167, v167, v21
    v_mul_f32 v168, v168, v21
    v_mul_f32 v169, v169, v21
    v_mul_f32 v170, v170, v21
    v_mul_f32 v171, v171, v21
    v_mul_f32 v172, v172, v21
    v_mul_f32 v173, v173, v21
    v_mul_f32 v174, v174, v21
    v_mul_f32 v175, v175, v21
    v_mul_f32 v176, v176, v21
    v_mul_f32 v177, v177, v21
    v_mul_f32 v178, v178, v21
    v_mul_f32 v179, v179, v21
    v_mul_f32 v180, v180, v21
    v_mul_f32 v181, v181, v21
    v_mul_f32 v182, v182, v21
    v_mul_f32 v183, v183, v21
    v_mul_f32 v184, v184, v21
    v_mul_f32 v185, v185, v21
    v_mul_f32 v186, v186, v21
    v_mul_f32 v187, v187, v21
    v_mul_f32 v188, v188, v21
    v_mul_f32 v189, v189, v21
    v_mul_f32 v190, v190, v21
    v_mul_f32 v191, v191, v21
    v_mul_f32 v192, v192, v21
    v_mul_f32 v193, v193, v21
    v_mul_f32 v194, v194, v21
    v_mul_f32 v195, v195, v21
    v_mul_f32 v196, v196, v21
    v_mul_f32 v197, v197, v21
    v_mul_f32 v198, v198, v21
    v_mul_f32 v199, v199, v21
    v_mul_f32 v200, v200, v21
    v_mul_f32 v201, v201, v21
    v_mul_f32 v202, v202, v21
    v_mul_f32 v203, v203, v21
    v_mul_f32 v204, v204, v21
    v_mul_f32 v205, v205, v21
    v_mul_f32 v206, v206, v21
    v_mul_f32 v207, v207, v21
    v_fma_f32 v104, v104, s28, v10
    v_fma_f32 v105, v105, s28, v10
    v_exp_f32 v104, v104
    v_exp_f32 v105, v105
    s_nop 0
    v_cvt_pk_bf16_f32 v24, v104, v105
    v_fma_f32 v106, v106, s28, v10
    v_fma_f32 v107, v107, s28, v10
    v_exp_f32 v106, v106
    v_exp_f32 v107, v107
    s_nop 0
    v_cvt_pk_bf16_f32 v25, v106, v107
    v_fma_f32 v108, v108, s28, v10
    v_fma_f32 v109, v109, s28, v10
    v_exp_f32 v108, v108
    v_exp_f32 v109, v109
    s_nop 0
    v_cvt_pk_bf16_f32 v22, v108, v109
    v_fma_f32 v110, v110, s28, v10
    v_fma_f32 v111, v111, s28, v10
    v_exp_f32 v110, v110
    v_exp_f32 v111, v111
    s_nop 0
    v_cvt_pk_bf16_f32 v23, v110, v111
    s_add_u32 s69, s39, 0
    buffer_load_dwordx4 v[48:51], v26, s[4:7], s69 offen offset:0
    s_waitcnt vmcnt(0)
    v_mfma_f32_16x16x32_bf16 v[104:107], v[48:51], a[144:147], 0
    s_nop 7
    buffer_load_dwordx4 v[48:51], v26, s[4:7], s69 offen offset:64
    s_waitcnt vmcnt(0)
    v_mfma_f32_16x16x32_bf16 v[104:107], v[48:51], a[148:151], v[104:107]
    s_nop 7
    buffer_load_dwordx4 v[48:51], v26, s[4:7], s69 offen offset:128
    s_waitcnt vmcnt(0)
    v_mfma_f32_16x16x32_bf16 v[104:107], v[48:51], a[152:155], v[104:107]
    s_nop 7
    buffer_load_dwordx4 v[48:51], v26, s[4:7], s69 offen offset:192
    s_waitcnt vmcnt(0)
    v_mfma_f32_16x16x32_bf16 v[104:107], v[48:51], a[156:159], v[104:107]
    s_nop 7
    buffer_load_dwordx4 v[48:51], v26, s[4:7], s69 offen offset:256
    s_waitcnt vmcnt(0)
    v_mfma_f32_16x16x32_bf16 v[104:107], v[48:51], a[160:163], v[104:107]
    s_nop 7
    buffer_load_dwordx4 v[48:51], v26, s[4:7], s69 offen offset:320
    s_waitcnt vmcnt(0)
    v_mfma_f32_16x16x32_bf16 v[104:107], v[48:51], a[164:167], v[104:107]
    s_nop 7
    s_add_u32 s69, s39, 6144
    buffer_load_dwordx4 v[48:51], v26, s[4:7], s69 offen offset:0
    s_waitcnt vmcnt(0)
    v_mfma_f32_16x16x32_bf16 v[108:111], v[48:51], a[144:147], 0
    s_nop 7
    buffer_load_dwordx4 v[48:51], v26, s[4:7], s69 offen offset:64
    s_waitcnt vmcnt(0)
    v_mfma_f32_16x16x32_bf16 v[108:111], v[48:51], a[148:151], v[108:111]
    s_nop 7
    buffer_load_dwordx4 v[48:51], v26, s[4:7], s69 offen offset:128
    s_waitcnt vmcnt(0)
    v_mfma_f32_16x16x32_bf16 v[108:111], v[48:51], a[152:155], v[108:111]
    s_nop 7
    buffer_load_dwordx4 v[48:51], v26, s[4:7], s69 offen offset:192
    s_waitcnt vmcnt(0)
    v_mfma_f32_16x16x32_bf16 v[108:111], v[48:51], a[156:159], v[108:111]
    s_nop 7
    buffer_load_dwordx4 v[48:51], v26, s[4:7], s69 offen offset:256
    s_waitcnt vmcnt(0)
    v_mfma_f32_16x16x32_bf16 v[108:111], v[48:51], a[160:163], v[108:111]
    s_nop 7
    buffer_load_dwordx4 v[48:51], v26, s[4:7], s69 offen offset:320
    s_waitcnt vmcnt(0)
    v_mfma_f32_16x16x32_bf16 v[108:111], v[48:51], a[164:167], v[108:111]
    s_nop 7
    s_nop 15
    v_max3_f32 v14, v104, v105, v106
    v_max3_f32 v14, v14, v107, v108
    v_max3_f32 v14, v14, v109, v110
    v_max_f32 v14, v14, v111
    v_mov_b32 v15, v14
    s_nop 1
    v_permlane32_swap_b32 v15, v14
    v_max_f32 v14, v14, v15
    v_mov_b32 v15, v14
    s_nop 1
    v_permlane16_swap_b32 v15, v14
    v_max_f32 v14, v14, v15
    v_fma_f32 v14, v14, s28, v11
    v_max_f32 v20, 0, v14
    v_sub_f32 v11, v11, v20
    v_sub_f32 v21, 0, v20
    v_exp_f32 v21, v21
    s_nop 0
    v_mul_f32 v46, v46, v21
    v_mul_f32 v208, v208, v21
    v_mul_f32 v209, v209, v21
    v_mul_f32 v210, v210, v21
    v_mul_f32 v211, v211, v21
    v_mul_f32 v212, v212, v21
    v_mul_f32 v213, v213, v21
    v_mul_f32 v214, v214, v21
    v_mul_f32 v215, v215, v21
    v_mul_f32 v216, v216, v21
    v_mul_f32 v217, v217, v21
    v_mul_f32 v218, v218, v21
    v_mul_f32 v219, v219, v21
    v_mul_f32 v220, v220, v21
    v_mul_f32 v221, v221, v21
    v_mul_f32 v222, v222, v21
    v_mul_f32 v223, v223, v21
    v_mul_f32 v224, v224, v21
    v_mul_f32 v225, v225, v21
    v_mul_f32 v226, v226, v21
    v_mul_f32 v227, v227, v21
    v_mul_f32 v228, v228, v21
    v_mul_f32 v229, v229, v21
    v_mul_f32 v230, v230, v21
    v_mul_f32 v231, v231, v21
    v_mul_f32 v232, v232, v21
    v_mul_f32 v233, v233, v21
    v_mul_f32 v234, v234, v21
    v_mul_f32 v235, v235, v21
    v_mul_f32 v236, v236, v21
    v_mul_f32 v237, v237, v21
    v_mul_f32 v238, v238, v21
    v_mul_f32 v239, v239, v21
    v_mul_f32 v240, v240, v21
    v_mul_f32 v241, v241, v21
    v_mul_f32 v242, v242, v21
    v_mul_f32 v243, v243, v21
    v_mul_f32 v244, v244, v21
    v_mul_f32 v245, v245, v21
    v_mul_f32 v246, v246, v21
    v_mul_f32 v247, v247, v21
    v_mul_f32 v248, v248, v21
    v_mul_f32 v249, v249, v21
    v_mul_f32 v250, v250, v21
    v_mul_f32 v251, v251, v21
    v_mul_f32 v252, v252, v21
    v_mul_f32 v253, v253, v21
    v_mul_f32 v254, v254, v21
    v_mul_f32 v255, v255, v21
    v_fma_f32 v104, v104, s28, v11
    v_fma_f32 v105, v105, s28, v11
    v_exp_f32 v104, v104
    v_exp_f32 v105, v105
    s_nop 0
    v_cvt_pk_bf16_f32 v30, v104, v105
    v_fma_f32 v106, v106, s28, v11
    v_fma_f32 v107, v107, s28, v11
    v_exp_f32 v106, v106
    v_exp_f32 v107, v107
    s_nop 0
    v_cvt_pk_bf16_f32 v31, v106, v107
    v_fma_f32 v108, v108, s28, v11
    v_fma_f32 v109, v109, s28, v11
    v_exp_f32 v108, v108
    v_exp_f32 v109, v109
    s_nop 0
    v_cvt_pk_bf16_f32 v28, v108, v109
    v_fma_f32 v110, v110, s28, v11
    v_fma_f32 v111, v111, s28, v11
    v_exp_f32 v110, v110
    v_exp_f32 v111, v111
    s_nop 0
    v_cvt_pk_bf16_f32 v29, v110, v111
    s_add_u32 s69, s39, 0
    buffer_load_dwordx4 v[48:51], v26, s[4:7], s69 offen offset:0
    s_waitcnt vmcnt(0)
    v_mfma_f32_16x16x32_bf16 v[104:107], v[48:51], a[168:171], 0
    s_nop 7
    buffer_load_dwordx4 v[48:51], v26, s[4:7], s69 offen offset:64
    s_waitcnt vmcnt(0)
    v_mfma_f32_16x16x32_bf16 v[104:107], v[48:51], a[172:175], v[104:107]
    s_nop 7
    buffer_load_dwordx4 v[48:51], v26, s[4:7], s69 offen offset:128
    s_waitcnt vmcnt(0)
    v_mfma_f32_16x16x32_bf16 v[104:107], v[48:51], a[176:179], v[104:107]
    s_nop 7
    buffer_load_dwordx4 v[48:51], v26, s[4:7], s69 offen offset:192
    s_waitcnt vmcnt(0)
    v_mfma_f32_16x16x32_bf16 v[104:107], v[48:51], a[180:183], v[104:107]
    s_nop 7
    buffer_load_dwordx4 v[48:51], v26, s[4:7], s69 offen offset:256
    s_waitcnt vmcnt(0)
    v_mfma_f32_16x16x32_bf16 v[104:107], v[48:51], a[184:187], v[104:107]
    s_nop 7
    buffer_load_dwordx4 v[48:51], v26, s[4:7], s69 offen offset:320
    s_waitcnt vmcnt(0)
    v_mfma_f32_16x16x32_bf16 v[104:107], v[48:51], a[188:191], v[104:107]
    s_nop 7
    s_add_u32 s69, s39, 6144
    buffer_load_dwordx4 v[48:51], v26, s[4:7], s69 offen offset:0
    s_waitcnt vmcnt(0)
    v_mfma_f32_16x16x32_bf16 v[108:111], v[48:51], a[168:171], 0
    s_nop 7
    buffer_load_dwordx4 v[48:51], v26, s[4:7], s69 offen offset:64
    s_waitcnt vmcnt(0)
    v_mfma_f32_16x16x32_bf16 v[108:111], v[48:51], a[172:175], v[108:111]
    s_nop 7
    buffer_load_dwordx4 v[48:51], v26, s[4:7], s69 offen offset:128
    s_waitcnt vmcnt(0)
    v_mfma_f32_16x16x32_bf16 v[108:111], v[48:51], a[176:179], v[108:111]
    s_nop 7
    buffer_load_dwordx4 v[48:51], v26, s[4:7], s69 offen offset:192
    s_waitcnt vmcnt(0)
    v_mfma_f32_16x16x32_bf16 v[108:111], v[48:51], a[180:183], v[108:111]
    s_nop 7
    buffer_load_dwordx4 v[48:51], v26, s[4:7], s69 offen offset:256
    s_waitcnt vmcnt(0)
    v_mfma_f32_16x16x32_bf16 v[108:111], v[48:51], a[184:187], v[108:111]
    s_nop 7
    buffer_load_dwordx4 v[48:51], v26, s[4:7], s69 offen offset:320
    s_waitcnt vmcnt(0)
    v_mfma_f32_16x16x32_bf16 v[108:111], v[48:51], a[188:191], v[108:111]
    s_nop 7
    s_nop 15
    v_max3_f32 v14, v104, v105, v106
    v_max3_f32 v14, v14, v107, v108
    v_max3_f32 v14, v14, v109, v110
    v_max_f32 v14, v14, v111
    v_mov_b32 v15, v14
    s_nop 1
    v_permlane32_swap_b32 v15, v14
    v_max_f32 v14, v14, v15
    v_mov_b32 v15, v14
    s_nop 1
    v_permlane16_swap_b32 v15, v14
    v_max_f32 v14, v14, v15
    v_fma_f32 v14, v14, s28, v12
    v_max_f32 v20, 0, v14
    v_sub_f32 v12, v12, v20
    v_sub_f32 v21, 0, v20
    v_exp_f32 v21, v21
    s_nop 0
    v_mul_f32 v47, v47, v21
    v_accvgpr_read_b32 v15, a0
    v_mul_f32 v15, v15, v21
    v_accvgpr_write_b32 a0, v15
    v_accvgpr_read_b32 v15, a1
    v_mul_f32 v15, v15, v21
    v_accvgpr_write_b32 a1, v15
    v_accvgpr_read_b32 v15, a2
    v_mul_f32 v15, v15, v21
    v_accvgpr_write_b32 a2, v15
    v_accvgpr_read_b32 v15, a3
    v_mul_f32 v15, v15, v21
    v_accvgpr_write_b32 a3, v15
    v_accvgpr_read_b32 v15, a4
    v_mul_f32 v15, v15, v21
    v_accvgpr_write_b32 a4, v15
    v_accvgpr_read_b32 v15, a5
    v_mul_f32 v15, v15, v21
    v_accvgpr_write_b32 a5, v15
    v_accvgpr_read_b32 v15, a6
    v_mul_f32 v15, v15, v21
    v_accvgpr_write_b32 a6, v15
    v_accvgpr_read_b32 v15, a7
    v_mul_f32 v15, v15, v21
    v_accvgpr_write_b32 a7, v15
    v_accvgpr_read_b32 v15, a8
    v_mul_f32 v15, v15, v21
    v_accvgpr_write_b32 a8, v15
    v_accvgpr_read_b32 v15, a9
    v_mul_f32 v15, v15, v21
    v_accvgpr_write_b32 a9, v15
    v_accvgpr_read_b32 v15, a10
    v_mul_f32 v15, v15, v21
    v_accvgpr_write_b32 a10, v15
    v_accvgpr_read_b32 v15, a11
    v_mul_f32 v15, v15, v21
    v_accvgpr_write_b32 a11, v15
    v_accvgpr_read_b32 v15, a12
    v_mul_f32 v15, v15, v21
    v_accvgpr_write_b32 a12, v15
    v_accvgpr_read_b32 v15, a13
    v_mul_f32 v15, v15, v21
    v_accvgpr_write_b32 a13, v15
    v_accvgpr_read_b32 v15, a14
    v_mul_f32 v15, v15, v21
    v_accvgpr_write_b32 a14, v15
    v_accvgpr_read_b32 v15, a15
    v_mul_f32 v15, v15, v21
    v_accvgpr_write_b32 a15, v15
    v_accvgpr_read_b32 v15, a16
    v_mul_f32 v15, v15, v21
    v_accvgpr_write_b32 a16, v15
    v_accvgpr_read_b32 v15, a17
    v_mul_f32 v15, v15, v21
    v_accvgpr_write_b32 a17, v15
    v_accvgpr_read_b32 v15, a18
    v_mul_f32 v15, v15, v21
    v_accvgpr_write_b32 a18, v15
    v_accvgpr_read_b32 v15, a19
    v_mul_f32 v15, v15, v21
    v_accvgpr_write_b32 a19, v15
    v_accvgpr_read_b32 v15, a20
    v_mul_f32 v15, v15, v21
    v_accvgpr_write_b32 a20, v15
    v_accvgpr_read_b32 v15, a21
    v_mul_f32 v15, v15, v21
    v_accvgpr_write_b32 a21, v15
    v_accvgpr_read_b32 v15, a22
    v_mul_f32 v15, v15, v21
    v_accvgpr_write_b32 a22, v15
    v_accvgpr_read_b32 v15, a23
    v_mul_f32 v15, v15, v21
    v_accvgpr_write_b32 a23, v15
    v_accvgpr_read_b32 v15, a24
    v_mul_f32 v15, v15, v21
    v_accvgpr_write_b32 a24, v15
    v_accvgpr_read_b32 v15, a25
    v_mul_f32 v15, v15, v21
    v_accvgpr_write_b32 a25, v15
    v_accvgpr_read_b32 v15, a26
    v_mul_f32 v15, v15, v21
    v_accvgpr_write_b32 a26, v15
    v_accvgpr_read_b32 v15, a27
    v_mul_f32 v15, v15, v21
    v_accvgpr_write_b32 a27, v15
    v_accvgpr_read_b32 v15, a28
    v_mul_f32 v15, v15, v21
    v_accvgpr_write_b32 a28, v15
    v_accvgpr_read_b32 v15, a29
    v_mul_f32 v15, v15, v21
    v_accvgpr_write_b32 a29, v15
    v_accvgpr_read_b32 v15, a30
    v_mul_f32 v15, v15, v21
    v_accvgpr_write_b32 a30, v15
    v_accvgpr_read_b32 v15, a31
    v_mul_f32 v15, v15, v21
    v_accvgpr_write_b32 a31, v15
    v_accvgpr_read_b32 v15, a32
    v_mul_f32 v15, v15, v21
    v_accvgpr_write_b32 a32, v15
    v_accvgpr_read_b32 v15, a33
    v_mul_f32 v15, v15, v21
    v_accvgpr_write_b32 a33, v15
    v_accvgpr_read_b32 v15, a34
    v_mul_f32 v15, v15, v21
    v_accvgpr_write_b32 a34, v15
    v_accvgpr_read_b32 v15, a35
    v_mul_f32 v15, v15, v21
    v_accvgpr_write_b32 a35, v15
    v_accvgpr_read_b32 v15, a36
    v_mul_f32 v15, v15, v21
    v_accvgpr_write_b32 a36, v15
    v_accvgpr_read_b32 v15, a37
    v_mul_f32 v15, v15, v21
    v_accvgpr_write_b32 a37, v15
    v_accvgpr_read_b32 v15, a38
    v_mul_f32 v15, v15, v21
    v_accvgpr_write_b32 a38, v15
    v_accvgpr_read_b32 v15, a39
    v_mul_f32 v15, v15, v21
    v_accvgpr_write_b32 a39, v15
    v_accvgpr_read_b32 v15, a40
    v_mul_f32 v15, v15, v21
    v_accvgpr_write_b32 a40, v15
    v_accvgpr_read_b32 v15, a41
    v_mul_f32 v15, v15, v21
    v_accvgpr_write_b32 a41, v15
    v_accvgpr_read_b32 v15, a42
    v_mul_f32 v15, v15, v21
    v_accvgpr_write_b32 a42, v15
    v_accvgpr_read_b32 v15, a43
    v_mul_f32 v15, v15, v21
    v_accvgpr_write_b32 a43, v15
    v_accvgpr_read_b32 v15, a44
    v_mul_f32 v15, v15, v21
    v_accvgpr_write_b32 a44, v15
    v_accvgpr_read_b32 v15, a45
    v_mul_f32 v15, v15, v21
    v_accvgpr_write_b32 a45, v15
    v_accvgpr_read_b32 v15, a46
    v_mul_f32 v15, v15, v21
    v_accvgpr_write_b32 a46, v15
    v_accvgpr_read_b32 v15, a47
    v_mul_f32 v15, v15, v21
    v_accvgpr_write_b32 a47, v15
    v_fma_f32 v104, v104, s28, v12
    v_fma_f32 v105, v105, s28, v12
    v_exp_f32 v104, v104
    v_exp_f32 v105, v105
    s_nop 0
    v_cvt_pk_bf16_f32 v36, v104, v105
    v_fma_f32 v106, v106, s28, v12
    v_fma_f32 v107, v107, s28, v12
    v_exp_f32 v106, v106
    v_exp_f32 v107, v107
    s_nop 0
    v_cvt_pk_bf16_f32 v37, v106, v107
    v_fma_f32 v108, v108, s28, v12
    v_fma_f32 v109, v109, s28, v12
    v_exp_f32 v108, v108
    v_exp_f32 v109, v109
    s_nop 0
    v_cvt_pk_bf16_f32 v34, v108, v109
    v_fma_f32 v110, v110, s28, v12
    v_fma_f32 v111, v111, s28, v12
    v_exp_f32 v110, v110
    v_exp_f32 v111, v111
    s_nop 0
    v_cvt_pk_bf16_f32 v35, v110, v111
    s_add_u32 s69, s39, 0
    buffer_load_dwordx4 v[48:51], v26, s[4:7], s69 offen offset:0
    s_waitcnt vmcnt(0)
    v_mfma_f32_16x16x32_bf16 v[104:107], v[48:51], a[192:195], 0
    s_nop 7
    buffer_load_dwordx4 v[48:51], v26, s[4:7], s69 offen offset:64
    s_waitcnt vmcnt(0)
    v_mfma_f32_16x16x32_bf16 v[104:107], v[48:51], a[196:199], v[104:107]
    s_nop 7
    buffer_load_dwordx4 v[48:51], v26, s[4:7], s69 offen offset:128
    s_waitcnt vmcnt(0)
    v_mfma_f32_16x16x32_bf16 v[104:107], v[48:51], a[200:203], v[104:107]
    s_nop 7
    buffer_load_dwordx4 v[48:51], v26, s[4:7], s69 offen offset:192
    s_waitcnt vmcnt(0)
    v_mfma_f32_16x16x32_bf16 v[104:107], v[48:51], a[204:207], v[104:107]
    s_nop 7
    buffer_load_dwordx4 v[48:51], v26, s[4:7], s69 offen offset:256
    s_waitcnt vmcnt(0)
    v_mfma_f32_16x16x32_bf16 v[104:107], v[48:51], a[208:211], v[104:107]
    s_nop 7
    buffer_load_dwordx4 v[48:51], v26, s[4:7], s69 offen offset:320
    s_waitcnt vmcnt(0)
    v_mfma_f32_16x16x32_bf16 v[104:107], v[48:51], v[92:95], v[104:107]
    s_nop 7
    s_add_u32 s69, s39, 6144
    buffer_load_dwordx4 v[48:51], v26, s[4:7], s69 offen offset:0
    s_waitcnt vmcnt(0)
    v_mfma_f32_16x16x32_bf16 v[108:111], v[48:51], a[192:195], 0
    s_nop 7
    buffer_load_dwordx4 v[48:51], v26, s[4:7], s69 offen offset:64
    s_waitcnt vmcnt(0)
    v_mfma_f32_16x16x32_bf16 v[108:111], v[48:51], a[196:199], v[108:111]
    s_nop 7
    buffer_load_dwordx4 v[48:51], v26, s[4:7], s69 offen offset:128
    s_waitcnt vmcnt(0)
    v_mfma_f32_16x16x32_bf16 v[108:111], v[48:51], a[200:203], v[108:111]
    s_nop 7
    buffer_load_dwordx4 v[48:51], v26, s[4:7], s69 offen offset:192
    s_waitcnt vmcnt(0)
    v_mfma_f32_16x16x32_bf16 v[108:111], v[48:51], a[204:207], v[108:111]
    s_nop 7
    buffer_load_dwordx4 v[48:51], v26, s[4:7], s69 offen offset:256
    s_waitcnt vmcnt(0)
    v_mfma_f32_16x16x32_bf16 v[108:111], v[48:51], a[208:211], v[108:111]
    s_nop 7
    buffer_load_dwordx4 v[48:51], v26, s[4:7], s69 offen offset:320
    s_waitcnt vmcnt(0)
    v_mfma_f32_16x16x32_bf16 v[108:111], v[48:51], v[92:95], v[108:111]
    s_nop 7
    s_nop 15
    v_max3_f32 v14, v104, v105, v106
    v_max3_f32 v14, v14, v107, v108
    v_max3_f32 v14, v14, v109, v110
    v_max_f32 v14, v14, v111
    v_mov_b32 v15, v14
    s_nop 1
    v_permlane32_swap_b32 v15, v14
    v_max_f32 v14, v14, v15
    v_mov_b32 v15, v14
    s_nop 1
    v_permlane16_swap_b32 v15, v14
    v_max_f32 v14, v14, v15
    v_fma_f32 v14, v14, s28, v13
    v_max_f32 v20, 0, v14
    v_sub_f32 v13, v13, v20
    v_sub_f32 v21, 0, v20
    v_exp_f32 v21, v21
    s_nop 0
    v_mul_f32 v15, v44, v21
    v_cndmask_b32_e64 v44, v44, v15, s[60:61]
    v_accvgpr_read_b32 v15, a48
    v_mul_f32 v15, v15, v21
    v_accvgpr_write_b32 a48, v15
    v_accvgpr_read_b32 v15, a49
    v_mul_f32 v15, v15, v21
    v_accvgpr_write_b32 a49, v15
    v_accvgpr_read_b32 v15, a50
    v_mul_f32 v15, v15, v21
    v_accvgpr_write_b32 a50, v15
    v_accvgpr_read_b32 v15, a51
    v_mul_f32 v15, v15, v21
    v_accvgpr_write_b32 a51, v15
    v_accvgpr_read_b32 v15, a52
    v_mul_f32 v15, v15, v21
    v_accvgpr_write_b32 a52, v15
    v_accvgpr_read_b32 v15, a53
    v_mul_f32 v15, v15, v21
    v_accvgpr_write_b32 a53, v15
    v_accvgpr_read_b32 v15, a54
    v_mul_f32 v15, v15, v21
    v_accvgpr_write_b32 a54, v15
    v_accvgpr_read_b32 v15, a55
    v_mul_f32 v15, v15, v21
    v_accvgpr_write_b32 a55, v15
    v_accvgpr_read_b32 v15, a56
    v_mul_f32 v15, v15, v21
    v_accvgpr_write_b32 a56, v15
    v_accvgpr_read_b32 v15, a57
    v_mul_f32 v15, v15, v21
    v_accvgpr_write_b32 a57, v15
    v_accvgpr_read_b32 v15, a58
    v_mul_f32 v15, v15, v21
    v_accvgpr_write_b32 a58, v15
    v_accvgpr_read_b32 v15, a59
    v_mul_f32 v15, v15, v21
    v_accvgpr_write_b32 a59, v15
    v_accvgpr_read_b32 v15, a60
    v_mul_f32 v15, v15, v21
    v_accvgpr_write_b32 a60, v15
    v_accvgpr_read_b32 v15, a61
    v_mul_f32 v15, v15, v21
    v_accvgpr_write_b32 a61, v15
    v_accvgpr_read_b32 v15, a62
    v_mul_f32 v15, v15, v21
    v_accvgpr_write_b32 a62, v15
    v_accvgpr_read_b32 v15, a63
    v_mul_f32 v15, v15, v21
    v_accvgpr_write_b32 a63, v15
    v_accvgpr_read_b32 v15, a64
    v_mul_f32 v15, v15, v21
    v_accvgpr_write_b32 a64, v15
    v_accvgpr_read_b32 v15, a65
    v_mul_f32 v15, v15, v21
    v_accvgpr_write_b32 a65, v15
    v_accvgpr_read_b32 v15, a66
    v_mul_f32 v15, v15, v21
    v_accvgpr_write_b32 a66, v15
    v_accvgpr_read_b32 v15, a67
    v_mul_f32 v15, v15, v21
    v_accvgpr_write_b32 a67, v15
    v_accvgpr_read_b32 v15, a68
    v_mul_f32 v15, v15, v21
    v_accvgpr_write_b32 a68, v15
    v_accvgpr_read_b32 v15, a69
    v_mul_f32 v15, v15, v21
    v_accvgpr_write_b32 a69, v15
    v_accvgpr_read_b32 v15, a70
    v_mul_f32 v15, v15, v21
    v_accvgpr_write_b32 a70, v15
    v_accvgpr_read_b32 v15, a71
    v_mul_f32 v15, v15, v21
    v_accvgpr_write_b32 a71, v15
    v_accvgpr_read_b32 v15, a72
    v_mul_f32 v15, v15, v21
    v_accvgpr_write_b32 a72, v15
    v_accvgpr_read_b32 v15, a73
    v_mul_f32 v15, v15, v21
    v_accvgpr_write_b32 a73, v15
    v_accvgpr_read_b32 v15, a74
    v_mul_f32 v15, v15, v21
    v_accvgpr_write_b32 a74, v15
    v_accvgpr_read_b32 v15, a75
    v_mul_f32 v15, v15, v21
    v_accvgpr_write_b32 a75, v15
    v_accvgpr_read_b32 v15, a76
    v_mul_f32 v15, v15, v21
    v_accvgpr_write_b32 a76, v15
    v_accvgpr_read_b32 v15, a77
    v_mul_f32 v15, v15, v21
    v_accvgpr_write_b32 a77, v15
    v_accvgpr_read_b32 v15, a78
    v_mul_f32 v15, v15, v21
    v_accvgpr_write_b32 a78, v15
    v_accvgpr_read_b32 v15, a79
    v_mul_f32 v15, v15, v21
    v_accvgpr_write_b32 a79, v15
    v_accvgpr_read_b32 v15, a80
    v_mul_f32 v15, v15, v21
    v_accvgpr_write_b32 a80, v15
    v_accvgpr_read_b32 v15, a81
    v_mul_f32 v15, v15, v21
    v_accvgpr_write_b32 a81, v15
    v_accvgpr_read_b32 v15, a82
    v_mul_f32 v15, v15, v21
    v_accvgpr_write_b32 a82, v15
    v_accvgpr_read_b32 v15, a83
    v_mul_f32 v15, v15, v21
    v_accvgpr_write_b32 a83, v15
    v_accvgpr_read_b32 v15, a84
    v_mul_f32 v15, v15, v21
    v_accvgpr_write_b32 a84, v15
    v_accvgpr_read_b32 v15, a85
    v_mul_f32 v15, v15, v21
    v_accvgpr_write_b32 a85, v15
    v_accvgpr_read_b32 v15, a86
    v_mul_f32 v15, v15, v21
    v_accvgpr_write_b32 a86, v15
    v_accvgpr_read_b32 v15, a87
    v_mul_f32 v15, v15, v21
    v_accvgpr_write_b32 a87, v15
    v_accvgpr_read_b32 v15, a88
    v_mul_f32 v15, v15, v21
    v_accvgpr_write_b32 a88, v15
    v_accvgpr_read_b32 v15, a89
    v_mul_f32 v15, v15, v21
    v_accvgpr_write_b32 a89, v15
    v_accvgpr_read_b32 v15, a90
    v_mul_f32 v15, v15, v21
    v_accvgpr_write_b32 a90, v15
    v_accvgpr_read_b32 v15, a91
    v_mul_f32 v15, v15, v21
    v_accvgpr_write_b32 a91, v15
    v_accvgpr_read_b32 v15, a92
    v_mul_f32 v15, v15, v21
    v_accvgpr_write_b32 a92, v15
    v_accvgpr_read_b32 v15, a93
    v_mul_f32 v15, v15, v21
    v_accvgpr_write_b32 a93, v15
    v_accvgpr_read_b32 v15, a94
    v_mul_f32 v15, v15, v21
    v_accvgpr_write_b32 a94, v15
    v_accvgpr_read_b32 v15, a95
    v_mul_f32 v15, v15, v21
    v_accvgpr_write_b32 a95, v15
    v_fma_f32 v104, v104, s28, v13
    v_fma_f32 v105, v105, s28, v13
    v_exp_f32 v104, v104
    v_exp_f32 v105, v105
    s_nop 0
    v_cvt_pk_bf16_f32 v42, v104, v105
    v_fma_f32 v106, v106, s28, v13
    v_fma_f32 v107, v107, s28, v13
    v_exp_f32 v106, v106
    v_exp_f32 v107, v107
    s_nop 0
    v_cvt_pk_bf16_f32 v43, v106, v107
    v_fma_f32 v108, v108, s28, v13
    v_fma_f32 v109, v109, s28, v13
    v_exp_f32 v108, v108
    v_exp_f32 v109, v109
    s_nop 0
    v_cvt_pk_bf16_f32 v40, v108, v109
    v_fma_f32 v110, v110, s28, v13
    v_fma_f32 v111, v111, s28, v13
    v_exp_f32 v110, v110
    v_exp_f32 v111, v111
    s_nop 0
    v_cvt_pk_bf16_f32 v41, v110, v111
    v_mfma_f32_16x16x32_bf16 v[48:51], a[236:239], v[16:19], v[44:47]
    v_mfma_f32_16x16x32_bf16 v[48:51], a[240:243], v[22:25], v[48:51]
    v_mfma_f32_16x16x32_bf16 v[48:51], a[244:247], v[28:31], v[48:51]
    v_mfma_f32_16x16x32_bf16 v[48:51], a[248:251], v[34:37], v[48:51]
    v_mfma_f32_16x16x32_bf16 v[48:51], a[252:255], v[40:43], v[48:51]
    s_nop 15
    s_setpc_b64 s[40:41]
L_rare4_0:
    s_nop 15
    v_mbcnt_lo_u32_b32 v31, -1, 0
    v_mbcnt_hi_u32_b32 v31, -1, v31
    v_and_b32 v30, 15, v31
    v_mul_u32_u24 v30, 384, v30
    v_lshrrev_b32 v31, 4, v31
    v_lshl_add_u32 v30, v31, 4, v30
    s_add_u32 s69, s39, 0
    buffer_load_dwordx4 v[44:47], v30, s[4:7], s69 offen offset:0
    s_waitcnt vmcnt(0)
    v_mfma_f32_16x16x32_bf16 v[104:107], v[44:47], a[96:99], 0
    s_nop 7
    buffer_load_dwordx4 v[44:47], v30, s[4:7], s69 offen offset:64
    s_waitcnt vmcnt(0)
    v_mfma_f32_16x16x32_bf16 v[104:107], v[44:47], a[100:103], v[104:107]
    s_nop 7
    buffer_load_dwordx4 v[44:47], v30, s[4:7], s69 offen offset:128
    s_waitcnt vmcnt(0)
    v_mfma_f32_16x16x32_bf16 v[104:107], v[44:47], a[104:107], v[104:107]
    s_nop 7
    buffer_load_dwordx4 v[44:47], v30, s[4:7], s69 offen offset:192
    s_waitcnt vmcnt(0)
    v_mfma_f32_16x16x32_bf16 v[104:107], v[44:47], a[108:111], v[104:107]
    s_nop 7
    buffer_load_dwordx4 v[44:47], v30, s[4:7], s69 offen offset:256
    s_waitcnt vmcnt(0)
    v_mfma_f32_16x16x32_bf16 v[104:107], v[44:47], a[112:115], v[104:107]
    s_nop 7
    buffer_load_dwordx4 v[44:47], v30, s[4:7], s69 offen offset:320
    s_waitcnt vmcnt(0)
    v_mfma_f32_16x16x32_bf16 v[104:107], v[44:47], a[116:119], v[104:107]
    s_nop 7
    s_add_u32 s69, s39, 6144
    buffer_load_dwordx4 v[44:47], v30, s[4:7], s69 offen offset:0
    s_waitcnt vmcnt(0)
    v_mfma_f32_16x16x32_bf16 v[108:111], v[44:47], a[96:99], 0
    s_nop 7
    buffer_load_dwordx4 v[44:47], v30, s[4:7], s69 offen offset:64
    s_waitcnt vmcnt(0)
    v_mfma_f32_16x16x32_bf16 v[108:111], v[44:47], a[100:103], v[108:111]
    s_nop 7
    buffer_load_dwordx4 v[44:47], v30, s[4:7], s69 offen offset:128
    s_waitcnt vmcnt(0)
    v_mfma_f32_16x16x32_bf16 v[108:111], v[44:47], a[104:107], v[108:111]
    s_nop 7
    buffer_load_dwordx4 v[44:47], v30, s[4:7], s69 offen offset:192
    s_waitcnt vmcnt(0)
    v_mfma_f32_16x16x32_bf16 v[108:111], v[44:47], a[108:111], v[108:111]
    s_nop 7
    buffer_load_dwordx4 v[44:47], v30, s[4:7], s69 offen offset:256
    s_waitcnt vmcnt(0)
    v_mfma_f32_16x16x32_bf16 v[108:111], v[44:47], a[112:115], v[108:111]
    s_nop 7
    buffer_load_dwordx4 v[44:47], v30, s[4:7], s69 offen offset:320
    s_waitcnt vmcnt(0)
    v_mfma_f32_16x16x32_bf16 v[108:111], v[44:47], a[116:119], v[108:111]
    s_nop 7
    s_nop 15
    v_max3_f32 v18, v104, v105, v106
    v_max3_f32 v18, v18, v107, v108
    v_max3_f32 v18, v18, v109, v110
    v_max_f32 v18, v18, v111
    v_mov_b32 v19, v18
    s_nop 1
    v_permlane32_swap_b32 v19, v18
    v_max_f32 v18, v18, v19
    v_mov_b32 v19, v18
    s_nop 1
    v_permlane16_swap_b32 v19, v18
    v_max_f32 v18, v18, v19
    v_fma_f32 v18, v18, s28, v9
    v_max_f32 v24, 0, v18
    v_sub_f32 v9, v9, v24
    v_sub_f32 v25, 0, v24
    v_exp_f32 v25, v25
    s_nop 0
    v_mul_f32 v19, v48, v25
    v_cndmask_b32_e64 v48, v19, v48, s[60:61]
    v_cndmask_b32_e64 v48, v48, 0, s[46:47]
    v_mul_f32 v112, v112, v25
    v_mul_f32 v113, v113, v25
    v_mul_f32 v114, v114, v25
    v_mul_f32 v115, v115, v25
    v_mul_f32 v116, v116, v25
    v_mul_f32 v117, v117, v25
    v_mul_f32 v118, v118, v25
    v_mul_f32 v119, v119, v25
    v_mul_f32 v120, v120, v25
    v_mul_f32 v121, v121, v25
    v_mul_f32 v122, v122, v25
    v_mul_f32 v123, v123, v25
    v_mul_f32 v124, v124, v25
    v_mul_f32 v125, v125, v25
    v_mul_f32 v126, v126, v25
    v_mul_f32 v127, v127, v25
    v_mul_f32 v128, v128, v25
    v_mul_f32 v129, v129, v25
    v_mul_f32 v130, v130, v25
    v_mul_f32 v131, v131, v25
    v_mul_f32 v132, v132, v25
    v_mul_f32 v133, v133, v25
    v_mul_f32 v134, v134, v25
    v_mul_f32 v135, v135, v25
    v_mul_f32 v136, v136, v25
    v_mul_f32 v137, v137, v25
    v_mul_f32 v138, v138, v25
    v_mul_f32 v139, v139, v25
    v_mul_f32 v140, v140, v25
    v_mul_f32 v141, v141, v25
    v_mul_f32 v142, v142, v25
    v_mul_f32 v143, v143, v25
    v_mul_f32 v144, v144, v25
    v_mul_f32 v145, v145, v25
    v_mul_f32 v146, v146, v25
    v_mul_f32 v147, v147, v25
    v_mul_f32 v148, v148, v25
    v_mul_f32 v149, v149, v25
    v_mul_f32 v150, v150, v25
    v_mul_f32 v151, v151, v25
    v_mul_f32 v152, v152, v25
    v_mul_f32 v153, v153, v25
    v_mul_f32 v154, v154, v25
    v_mul_f32 v155, v155, v25
    v_mul_f32 v156, v156, v25
    v_mul_f32 v157, v157, v25
    v_mul_f32 v158, v158, v25
    v_mul_f32 v159, v159, v25
    v_fma_f32 v104, v104, s28, v9
    v_fma_f32 v105, v105, s28, v9
    v_exp_f32 v104, v104
    v_exp_f32 v105, v105
    s_nop 0
    v_cvt_pk_bf16_f32 v14, v104, v105
    v_fma_f32 v106, v106, s28, v9
    v_fma_f32 v107, v107, s28, v9
    v_exp_f32 v106, v106
    v_exp_f32 v107, v107
    s_nop 0
    v_cvt_pk_bf16_f32 v15, v106, v107
    v_fma_f32 v108, v108, s28, v9
    v_fma_f32 v109, v109, s28, v9
    v_exp_f32 v108, v108
    v_exp_f32 v109, v109
    s_nop 0
    v_cvt_pk_bf16_f32 v16, v108, v109
    v_fma_f32 v110, v110, s28, v9
    v_fma_f32 v111, v111, s28, v9
    v_exp_f32 v110, v110
    v_exp_f32 v111, v111
    s_nop 0
    v_cvt_pk_bf16_f32 v17, v110, v111
    s_add_u32 s69, s39, 0
    buffer_load_dwordx4 v[44:47], v30, s[4:7], s69 offen offset:0
    s_waitcnt vmcnt(0)
    v_mfma_f32_16x16x32_bf16 v[104:107], v[44:47], a[120:123], 0
    s_nop 7
    buffer_load_dwordx4 v[44:47], v30, s[4:7], s69 offen offset:64
    s_waitcnt vmcnt(0)
    v_mfma_f32_16x16x32_bf16 v[104:107], v[44:47], a[124:127], v[104:107]
    s_nop 7
    buffer_load_dwordx4 v[44:47], v30, s[4:7], s69 offen offset:128
    s_waitcnt vmcnt(0)
    v_mfma_f32_16x16x32_bf16 v[104:107], v[44:47], a[128:131], v[104:107]
    s_nop 7
    buffer_load_dwordx4 v[44:47], v30, s[4:7], s69 offen offset:192
    s_waitcnt vmcnt(0)
    v_mfma_f32_16x16x32_bf16 v[104:107], v[44:47], a[132:135], v[104:107]
    s_nop 7
    buffer_load_dwordx4 v[44:47], v30, s[4:7], s69 offen offset:256
    s_waitcnt vmcnt(0)
    v_mfma_f32_16x16x32_bf16 v[104:107], v[44:47], a[136:139], v[104:107]
    s_nop 7
    buffer_load_dwordx4 v[44:47], v30, s[4:7], s69 offen offset:320
    s_waitcnt vmcnt(0)
    v_mfma_f32_16x16x32_bf16 v[104:107], v[44:47], a[140:143], v[104:107]
    s_nop 7
    s_add_u32 s69, s39, 6144
    buffer_load_dwordx4 v[44:47], v30, s[4:7], s69 offen offset:0
    s_waitcnt vmcnt(0)
    v_mfma_f32_16x16x32_bf16 v[108:111], v[44:47], a[120:123], 0
    s_nop 7
    buffer_load_dwordx4 v[44:47], v30, s[4:7], s69 offen offset:64
    s_waitcnt vmcnt(0)
    v_mfma_f32_16x16x32_bf16 v[108:111], v[44:47], a[124:127], v[108:111]
    s_nop 7
    buffer_load_dwordx4 v[44:47], v30, s[4:7], s69 offen offset:128
    s_waitcnt vmcnt(0)
    v_mfma_f32_16x16x32_bf16 v[108:111], v[44:47], a[128:131], v[108:111]
    s_nop 7
    buffer_load_dwordx4 v[44:47], v30, s[4:7], s69 offen offset:192
    s_waitcnt vmcnt(0)
    v_mfma_f32_16x16x32_bf16 v[108:111], v[44:47], a[132:135], v[108:111]
    s_nop 7
    buffer_load_dwordx4 v[44:47], v30, s[4:7], s69 offen offset:256
    s_waitcnt vmcnt(0)
    v_mfma_f32_16x16x32_bf16 v[108:111], v[44:47], a[136:139], v[108:111]
    s_nop 7
    buffer_load_dwordx4 v[44:47], v30, s[4:7], s69 offen offset:320
    s_waitcnt vmcnt(0)
    v_mfma_f32_16x16x32_bf16 v[108:111], v[44:47], a[140:143], v[108:111]
    s_nop 7
    s_nop 15
    v_max3_f32 v18, v104, v105, v106
    v_max3_f32 v18, v18, v107, v108
    v_max3_f32 v18, v18, v109, v110
    v_max_f32 v18, v18, v111
    v_mov_b32 v19, v18
    s_nop 1
    v_permlane32_swap_b32 v19, v18
    v_max_f32 v18, v18, v19
    v_mov_b32 v19, v18
    s_nop 1
    v_permlane16_swap_b32 v19, v18
    v_max_f32 v18, v18, v19
    v_fma_f32 v18, v18, s28, v10
    v_max_f32 v24, 0, v18
    v_sub_f32 v10, v10, v24
    v_sub_f32 v25, 0, v24
    v_exp_f32 v25, v25
    s_nop 0
    v_mul_f32 v49, v49, v25
    v_mul_f32 v160, v160, v25
    v_mul_f32 v161, v161, v25
    v_mul_f32 v162, v162, v25
    v_mul_f32 v163, v163, v25
    v_mul_f32 v164, v164, v25
    v_mul_f32 v165, v165, v25
    v_mul_f32 v166, v166, v25
    v_mul_f32 v167, v167, v25
    v_mul_f32 v168, v168, v25
    v_mul_f32 v169, v169, v25
    v_mul_f32 v170, v170, v25
    v_mul_f32 v171, v171, v25
    v_mul_f32 v172, v172, v25
    v_mul_f32 v173, v173, v25
    v_mul_f32 v174, v174, v25
    v_mul_f32 v175, v175, v25
    v_mul_f32 v176, v176, v25
    v_mul_f32 v177, v177, v25
    v_mul_f32 v178, v178, v25
    v_mul_f32 v179, v179, v25
    v_mul_f32 v180, v180, v25
    v_mul_f32 v181, v181, v25
    v_mul_f32 v182, v182, v25
    v_mul_f32 v183, v183, v25
    v_mul_f32 v184, v184, v25
    v_mul_f32 v185, v185, v25
    v_mul_f32 v186, v186, v25
    v_mul_f32 v187, v187, v25
    v_mul_f32 v188, v188, v25
    v_mul_f32 v189, v189, v25
    v_mul_f32 v190, v190, v25
    v_mul_f32 v191, v191, v25
    v_mul_f32 v192, v192, v25
    v_mul_f32 v193, v193, v25
    v_mul_f32 v194, v194, v25
    v_mul_f32 v195, v195, v25
    v_mul_f32 v196, v196, v25
    v_mul_f32 v197, v197, v25
    v_mul_f32 v198, v198, v25
    v_mul_f32 v199, v199, v25
    v_mul_f32 v200, v200, v25
    v_mul_f32 v201, v201, v25
    v_mul_f32 v202, v202, v25
    v_mul_f32 v203, v203, v25
    v_mul_f32 v204, v204, v25
    v_mul_f32 v205, v205, v25
    v_mul_f32 v206, v206, v25
    v_mul_f32 v207, v207, v25
    v_fma_f32 v104, v104, s28, v10
    v_fma_f32 v105, v105, s28, v10
    v_exp_f32 v104, v104
    v_exp_f32 v105, v105
    s_nop 0
    v_cvt_pk_bf16_f32 v20, v104, v105
    v_fma_f32 v106, v106, s28, v10
    v_fma_f32 v107, v107, s28, v10
    v_exp_f32 v106, v106
    v_exp_f32 v107, v107
    s_nop 0
    v_cvt_pk_bf16_f32 v21, v106, v107
    v_fma_f32 v108, v108, s28, v10
    v_fma_f32 v109, v109, s28, v10
    v_exp_f32 v108, v108
    v_exp_f32 v109, v109
    s_nop 0
    v_cvt_pk_bf16_f32 v22, v108, v109
    v_fma_f32 v110, v110, s28, v10
    v_fma_f32 v111, v111, s28, v10
    v_exp_f32 v110, v110
    v_exp_f32 v111, v111
    s_nop 0
    v_cvt_pk_bf16_f32 v23, v110, v111
    s_add_u32 s69, s39, 0
    buffer_load_dwordx4 v[44:47], v30, s[4:7], s69 offen offset:0
    s_waitcnt vmcnt(0)
    v_mfma_f32_16x16x32_bf16 v[104:107], v[44:47], a[144:147], 0
    s_nop 7
    buffer_load_dwordx4 v[44:47], v30, s[4:7], s69 offen offset:64
    s_waitcnt vmcnt(0)
    v_mfma_f32_16x16x32_bf16 v[104:107], v[44:47], a[148:151], v[104:107]
    s_nop 7
    buffer_load_dwordx4 v[44:47], v30, s[4:7], s69 offen offset:128
    s_waitcnt vmcnt(0)
    v_mfma_f32_16x16x32_bf16 v[104:107], v[44:47], a[152:155], v[104:107]
    s_nop 7
    buffer_load_dwordx4 v[44:47], v30, s[4:7], s69 offen offset:192
    s_waitcnt vmcnt(0)
    v_mfma_f32_16x16x32_bf16 v[104:107], v[44:47], a[156:159], v[104:107]
    s_nop 7
    buffer_load_dwordx4 v[44:47], v30, s[4:7], s69 offen offset:256
    s_waitcnt vmcnt(0)
    v_mfma_f32_16x16x32_bf16 v[104:107], v[44:47], a[160:163], v[104:107]
    s_nop 7
    buffer_load_dwordx4 v[44:47], v30, s[4:7], s69 offen offset:320
    s_waitcnt vmcnt(0)
    v_mfma_f32_16x16x32_bf16 v[104:107], v[44:47], a[164:167], v[104:107]
    s_nop 7
    s_add_u32 s69, s39, 6144
    buffer_load_dwordx4 v[44:47], v30, s[4:7], s69 offen offset:0
    s_waitcnt vmcnt(0)
    v_mfma_f32_16x16x32_bf16 v[108:111], v[44:47], a[144:147], 0
    s_nop 7
    buffer_load_dwordx4 v[44:47], v30, s[4:7], s69 offen offset:64
    s_waitcnt vmcnt(0)
    v_mfma_f32_16x16x32_bf16 v[108:111], v[44:47], a[148:151], v[108:111]
    s_nop 7
    buffer_load_dwordx4 v[44:47], v30, s[4:7], s69 offen offset:128
    s_waitcnt vmcnt(0)
    v_mfma_f32_16x16x32_bf16 v[108:111], v[44:47], a[152:155], v[108:111]
    s_nop 7
    buffer_load_dwordx4 v[44:47], v30, s[4:7], s69 offen offset:192
    s_waitcnt vmcnt(0)
    v_mfma_f32_16x16x32_bf16 v[108:111], v[44:47], a[156:159], v[108:111]
    s_nop 7
    buffer_load_dwordx4 v[44:47], v30, s[4:7], s69 offen offset:256
    s_waitcnt vmcnt(0)
    v_mfma_f32_16x16x32_bf16 v[108:111], v[44:47], a[160:163], v[108:111]
    s_nop 7
    buffer_load_dwordx4 v[44:47], v30, s[4:7], s69 offen offset:320
    s_waitcnt vmcnt(0)
    v_mfma_f32_16x16x32_bf16 v[108:111], v[44:47], a[164:167], v[108:111]
    s_nop 7
    s_nop 15
    v_max3_f32 v18, v104, v105, v106
    v_max3_f32 v18, v18, v107, v108
    v_max3_f32 v18, v18, v109, v110
    v_max_f32 v18, v18, v111
    v_mov_b32 v19, v18
    s_nop 1
    v_permlane32_swap_b32 v19, v18
    v_max_f32 v18, v18, v19
    v_mov_b32 v19, v18
    s_nop 1
    v_permlane16_swap_b32 v19, v18
    v_max_f32 v18, v18, v19
    v_fma_f32 v18, v18, s28, v11
    v_max_f32 v24, 0, v18
    v_sub_f32 v11, v11, v24
    v_sub_f32 v25, 0, v24
    v_exp_f32 v25, v25
    s_nop 0
    v_mul_f32 v50, v50, v25
    v_mul_f32 v208, v208, v25
    v_mul_f32 v209, v209, v25
    v_mul_f32 v210, v210, v25
    v_mul_f32 v211, v211, v25
    v_mul_f32 v212, v212, v25
    v_mul_f32 v213, v213, v25
    v_mul_f32 v214, v214, v25
    v_mul_f32 v215, v215, v25
    v_mul_f32 v216, v216, v25
    v_mul_f32 v217, v217, v25
    v_mul_f32 v218, v218, v25
    v_mul_f32 v219, v219, v25
    v_mul_f32 v220, v220, v25
    v_mul_f32 v221, v221, v25
    v_mul_f32 v222, v222, v25
    v_mul_f32 v223, v223, v25
    v_mul_f32 v224, v224, v25
    v_mul_f32 v225, v225, v25
    v_mul_f32 v226, v226, v25
    v_mul_f32 v227, v227, v25
    v_mul_f32 v228, v228, v25
    v_mul_f32 v229, v229, v25
    v_mul_f32 v230, v230, v25
    v_mul_f32 v231, v231, v25
    v_mul_f32 v232, v232, v25
    v_mul_f32 v233, v233, v25
    v_mul_f32 v234, v234, v25
    v_mul_f32 v235, v235, v25
    v_mul_f32 v236, v236, v25
    v_mul_f32 v237, v237, v25
    v_mul_f32 v238, v238, v25
    v_mul_f32 v239, v239, v25
    v_mul_f32 v240, v240, v25
    v_mul_f32 v241, v241, v25
    v_mul_f32 v242, v242, v25
    v_mul_f32 v243, v243, v25
    v_mul_f32 v244, v244, v25
    v_mul_f32 v245, v245, v25
    v_mul_f32 v246, v246, v25
    v_mul_f32 v247, v247, v25
    v_mul_f32 v248, v248, v25
    v_mul_f32 v249, v249, v25
    v_mul_f32 v250, v250, v25
    v_mul_f32 v251, v251, v25
    v_mul_f32 v252, v252, v25
    v_mul_f32 v253, v253, v25
    v_mul_f32 v254, v254, v25
    v_mul_f32 v255, v255, v25
    v_fma_f32 v104, v104, s28, v11
    v_fma_f32 v105, v105, s28, v11
    v_exp_f32 v104, v104
    v_exp_f32 v105, v105
    s_nop 0
    v_cvt_pk_bf16_f32 v26, v104, v105
    v_fma_f32 v106, v106, s28, v11
    v_fma_f32 v107, v107, s28, v11
    v_exp_f32 v106, v106
    v_exp_f32 v107, v107
    s_nop 0
    v_cvt_pk_bf16_f32 v27, v106, v107
    v_fma_f32 v108, v108, s28, v11
    v_fma_f32 v109, v109, s28, v11
    v_exp_f32 v108, v108
    v_exp_f32 v109, v109
    s_nop 0
    v_cvt_pk_bf16_f32 v28, v108, v109
    v_fma_f32 v110, v110, s28, v11
    v_fma_f32 v111, v111, s28, v11
    v_exp_f32 v110, v110
    v_exp_f32 v111, v111
    s_nop 0
    v_cvt_pk_bf16_f32 v29, v110, v111
    s_add_u32 s69, s39, 0
    buffer_load_dwordx4 v[44:47], v30, s[4:7], s69 offen offset:0
    s_waitcnt vmcnt(0)
    v_mfma_f32_16x16x32_bf16 v[104:107], v[44:47], a[168:171], 0
    s_nop 7
    buffer_load_dwordx4 v[44:47], v30, s[4:7], s69 offen offset:64
    s_waitcnt vmcnt(0)
    v_mfma_f32_16x16x32_bf16 v[104:107], v[44:47], a[172:175], v[104:107]
    s_nop 7
    buffer_load_dwordx4 v[44:47], v30, s[4:7], s69 offen offset:128
    s_waitcnt vmcnt(0)
    v_mfma_f32_16x16x32_bf16 v[104:107], v[44:47], a[176:179], v[104:107]
    s_nop 7
    buffer_load_dwordx4 v[44:47], v30, s[4:7], s69 offen offset:192
    s_waitcnt vmcnt(0)
    v_mfma_f32_16x16x32_bf16 v[104:107], v[44:47], a[180:183], v[104:107]
    s_nop 7
    buffer_load_dwordx4 v[44:47], v30, s[4:7], s69 offen offset:256
    s_waitcnt vmcnt(0)
    v_mfma_f32_16x16x32_bf16 v[104:107], v[44:47], a[184:187], v[104:107]
    s_nop 7
    buffer_load_dwordx4 v[44:47], v30, s[4:7], s69 offen offset:320
    s_waitcnt vmcnt(0)
    v_mfma_f32_16x16x32_bf16 v[104:107], v[44:47], a[188:191], v[104:107]
    s_nop 7
    s_add_u32 s69, s39, 6144
    buffer_load_dwordx4 v[44:47], v30, s[4:7], s69 offen offset:0
    s_waitcnt vmcnt(0)
    v_mfma_f32_16x16x32_bf16 v[108:111], v[44:47], a[168:171], 0
    s_nop 7
    buffer_load_dwordx4 v[44:47], v30, s[4:7], s69 offen offset:64
    s_waitcnt vmcnt(0)
    v_mfma_f32_16x16x32_bf16 v[108:111], v[44:47], a[172:175], v[108:111]
    s_nop 7
    buffer_load_dwordx4 v[44:47], v30, s[4:7], s69 offen offset:128
    s_waitcnt vmcnt(0)
    v_mfma_f32_16x16x32_bf16 v[108:111], v[44:47], a[176:179], v[108:111]
    s_nop 7
    buffer_load_dwordx4 v[44:47], v30, s[4:7], s69 offen offset:192
    s_waitcnt vmcnt(0)
    v_mfma_f32_16x16x32_bf16 v[108:111], v[44:47], a[180:183], v[108:111]
    s_nop 7
    buffer_load_dwordx4 v[44:47], v30, s[4:7], s69 offen offset:256
    s_waitcnt vmcnt(0)
    v_mfma_f32_16x16x32_bf16 v[108:111], v[44:47], a[184:187], v[108:111]
    s_nop 7
    buffer_load_dwordx4 v[44:47], v30, s[4:7], s69 offen offset:320
    s_waitcnt vmcnt(0)
    v_mfma_f32_16x16x32_bf16 v[108:111], v[44:47], a[188:191], v[108:111]
    s_nop 7
    s_nop 15
    v_max3_f32 v18, v104, v105, v106
    v_max3_f32 v18, v18, v107, v108
    v_max3_f32 v18, v18, v109, v110
    v_max_f32 v18, v18, v111
    v_mov_b32 v19, v18
    s_nop 1
    v_permlane32_swap_b32 v19, v18
    v_max_f32 v18, v18, v19
    v_mov_b32 v19, v18
    s_nop 1
    v_permlane16_swap_b32 v19, v18
    v_max_f32 v18, v18, v19
    v_fma_f32 v18, v18, s28, v12
    v_max_f32 v24, 0, v18
    v_sub_f32 v12, v12, v24
    v_sub_f32 v25, 0, v24
    v_exp_f32 v25, v25
    s_nop 0
    v_mul_f32 v51, v51, v25
    v_accvgpr_read_b32 v19, a0
    v_mul_f32 v19, v19, v25
    v_accvgpr_write_b32 a0, v19
    v_accvgpr_read_b32 v19, a1
    v_mul_f32 v19, v19, v25
    v_accvgpr_write_b32 a1, v19
    v_accvgpr_read_b32 v19, a2
    v_mul_f32 v19, v19, v25
    v_accvgpr_write_b32 a2, v19
    v_accvgpr_read_b32 v19, a3
    v_mul_f32 v19, v19, v25
    v_accvgpr_write_b32 a3, v19
    v_accvgpr_read_b32 v19, a4
    v_mul_f32 v19, v19, v25
    v_accvgpr_write_b32 a4, v19
    v_accvgpr_read_b32 v19, a5
    v_mul_f32 v19, v19, v25
    v_accvgpr_write_b32 a5, v19
    v_accvgpr_read_b32 v19, a6
    v_mul_f32 v19, v19, v25
    v_accvgpr_write_b32 a6, v19
    v_accvgpr_read_b32 v19, a7
    v_mul_f32 v19, v19, v25
    v_accvgpr_write_b32 a7, v19
    v_accvgpr_read_b32 v19, a8
    v_mul_f32 v19, v19, v25
    v_accvgpr_write_b32 a8, v19
    v_accvgpr_read_b32 v19, a9
    v_mul_f32 v19, v19, v25
    v_accvgpr_write_b32 a9, v19
    v_accvgpr_read_b32 v19, a10
    v_mul_f32 v19, v19, v25
    v_accvgpr_write_b32 a10, v19
    v_accvgpr_read_b32 v19, a11
    v_mul_f32 v19, v19, v25
    v_accvgpr_write_b32 a11, v19
    v_accvgpr_read_b32 v19, a12
    v_mul_f32 v19, v19, v25
    v_accvgpr_write_b32 a12, v19
    v_accvgpr_read_b32 v19, a13
    v_mul_f32 v19, v19, v25
    v_accvgpr_write_b32 a13, v19
    v_accvgpr_read_b32 v19, a14
    v_mul_f32 v19, v19, v25
    v_accvgpr_write_b32 a14, v19
    v_accvgpr_read_b32 v19, a15
    v_mul_f32 v19, v19, v25
    v_accvgpr_write_b32 a15, v19
    v_accvgpr_read_b32 v19, a16
    v_mul_f32 v19, v19, v25
    v_accvgpr_write_b32 a16, v19
    v_accvgpr_read_b32 v19, a17
    v_mul_f32 v19, v19, v25
    v_accvgpr_write_b32 a17, v19
    v_accvgpr_read_b32 v19, a18
    v_mul_f32 v19, v19, v25
    v_accvgpr_write_b32 a18, v19
    v_accvgpr_read_b32 v19, a19
    v_mul_f32 v19, v19, v25
    v_accvgpr_write_b32 a19, v19
    v_accvgpr_read_b32 v19, a20
    v_mul_f32 v19, v19, v25
    v_accvgpr_write_b32 a20, v19
    v_accvgpr_read_b32 v19, a21
    v_mul_f32 v19, v19, v25
    v_accvgpr_write_b32 a21, v19
    v_accvgpr_read_b32 v19, a22
    v_mul_f32 v19, v19, v25
    v_accvgpr_write_b32 a22, v19
    v_accvgpr_read_b32 v19, a23
    v_mul_f32 v19, v19, v25
    v_accvgpr_write_b32 a23, v19
    v_accvgpr_read_b32 v19, a24
    v_mul_f32 v19, v19, v25
    v_accvgpr_write_b32 a24, v19
    v_accvgpr_read_b32 v19, a25
    v_mul_f32 v19, v19, v25
    v_accvgpr_write_b32 a25, v19
    v_accvgpr_read_b32 v19, a26
    v_mul_f32 v19, v19, v25
    v_accvgpr_write_b32 a26, v19
    v_accvgpr_read_b32 v19, a27
    v_mul_f32 v19, v19, v25
    v_accvgpr_write_b32 a27, v19
    v_accvgpr_read_b32 v19, a28
    v_mul_f32 v19, v19, v25
    v_accvgpr_write_b32 a28, v19
    v_accvgpr_read_b32 v19, a29
    v_mul_f32 v19, v19, v25
    v_accvgpr_write_b32 a29, v19
    v_accvgpr_read_b32 v19, a30
    v_mul_f32 v19, v19, v25
    v_accvgpr_write_b32 a30, v19
    v_accvgpr_read_b32 v19, a31
    v_mul_f32 v19, v19, v25
    v_accvgpr_write_b32 a31, v19
    v_accvgpr_read_b32 v19, a32
    v_mul_f32 v19, v19, v25
    v_accvgpr_write_b32 a32, v19
    v_accvgpr_read_b32 v19, a33
    v_mul_f32 v19, v19, v25
    v_accvgpr_write_b32 a33, v19
    v_accvgpr_read_b32 v19, a34
    v_mul_f32 v19, v19, v25
    v_accvgpr_write_b32 a34, v19
    v_accvgpr_read_b32 v19, a35
    v_mul_f32 v19, v19, v25
    v_accvgpr_write_b32 a35, v19
    v_accvgpr_read_b32 v19, a36
    v_mul_f32 v19, v19, v25
    v_accvgpr_write_b32 a36, v19
    v_accvgpr_read_b32 v19, a37
    v_mul_f32 v19, v19, v25
    v_accvgpr_write_b32 a37, v19
    v_accvgpr_read_b32 v19, a38
    v_mul_f32 v19, v19, v25
    v_accvgpr_write_b32 a38, v19
    v_accvgpr_read_b32 v19, a39
    v_mul_f32 v19, v19, v25
    v_accvgpr_write_b32 a39, v19
    v_accvgpr_read_b32 v19, a40
    v_mul_f32 v19, v19, v25
    v_accvgpr_write_b32 a40, v19
    v_accvgpr_read_b32 v19, a41
    v_mul_f32 v19, v19, v25
    v_accvgpr_write_b32 a41, v19
    v_accvgpr_read_b32 v19, a42
    v_mul_f32 v19, v19, v25
    v_accvgpr_write_b32 a42, v19
    v_accvgpr_read_b32 v19, a43
    v_mul_f32 v19, v19, v25
    v_accvgpr_write_b32 a43, v19
    v_accvgpr_read_b32 v19, a44
    v_mul_f32 v19, v19, v25
    v_accvgpr_write_b32 a44, v19
    v_accvgpr_read_b32 v19, a45
    v_mul_f32 v19, v19, v25
    v_accvgpr_write_b32 a45, v19
    v_accvgpr_read_b32 v19, a46
    v_mul_f32 v19, v19, v25
    v_accvgpr_write_b32 a46, v19
    v_accvgpr_read_b32 v19, a47
    v_mul_f32 v19, v19, v25
    v_accvgpr_write_b32 a47, v19
    v_fma_f32 v104, v104, s28, v12
    v_fma_f32 v105, v105, s28, v12
    v_exp_f32 v104, v104
    v_exp_f32 v105, v105
    s_nop 0
    v_cvt_pk_bf16_f32 v32, v104, v105
    v_fma_f32 v106, v106, s28, v12
    v_fma_f32 v107, v107, s28, v12
    v_exp_f32 v106, v106
    v_exp_f32 v107, v107
    s_nop 0
    v_cvt_pk_bf16_f32 v33, v106, v107
    v_fma_f32 v108, v108, s28, v12
    v_fma_f32 v109, v109, s28, v12
    v_exp_f32 v108, v108
    v_exp_f32 v109, v109
    s_nop 0
    v_cvt_pk_bf16_f32 v34, v108, v109
    v_fma_f32 v110, v110, s28, v12
    v_fma_f32 v111, v111, s28, v12
    v_exp_f32 v110, v110
    v_exp_f32 v111, v111
    s_nop 0
    v_cvt_pk_bf16_f32 v35, v110, v111
    v_mfma_f32_16x16x32_bf16 v[44:47], a[236:239], v[14:17], v[48:51]
    v_mfma_f32_16x16x32_bf16 v[44:47], a[240:243], v[20:23], v[44:47]
    v_mfma_f32_16x16x32_bf16 v[44:47], a[244:247], v[26:29], v[44:47]
    v_mfma_f32_16x16x32_bf16 v[44:47], a[248:251], v[32:35], v[44:47]
    s_nop 15
    s_setpc_b64 s[40:41]
L_rare4_1:
    s_nop 15
    v_mbcnt_lo_u32_b32 v27, -1, 0
    v_mbcnt_hi_u32_b32 v27, -1, v27
    v_and_b32 v26, 15, v27
    v_mul_u32_u24 v26, 384, v26
    v_lshrrev_b32 v27, 4, v27
    v_lshl_add_u32 v26, v27, 4, v26
    s_add_u32 s69, s39, 0
    buffer_load_dwordx4 v[48:51], v26, s[4:7], s69 offen offset:0
    s_waitcnt vmcnt(0)
    v_mfma_f32_16x16x32_bf16 v[104:107], v[48:51], a[96:99], 0
    s_nop 7
    buffer_load_dwordx4 v[48:51], v26, s[4:7], s69 offen offset:64
    s_waitcnt vmcnt(0)
    v_mfma_f32_16x16x32_bf16 v[104:107], v[48:51], a[100:103], v[104:107]
    s_nop 7
    buffer_load_dwordx4 v[48:51], v26, s[4:7], s69 offen offset:128
    s_waitcnt vmcnt(0)
    v_mfma_f32_16x16x32_bf16 v[104:107], v[48:51], a[104:107], v[104:107]
    s_nop 7
    buffer_load_dwordx4 v[48:51], v26, s[4:7], s69 offen offset:192
    s_waitcnt vmcnt(0)
    v_mfma_f32_16x16x32_bf16 v[104:107], v[48:51], a[108:111], v[104:107]
    s_nop 7
    buffer_load_dwordx4 v[48:51], v26, s[4:7], s69 offen offset:256
    s_waitcnt vmcnt(0)
    v_mfma_f32_16x16x32_bf16 v[104:107], v[48:51], a[112:115], v[104:107]
    s_nop 7
    buffer_load_dwordx4 v[48:51], v26, s[4:7], s69 offen offset:320
    s_waitcnt vmcnt(0)
    v_mfma_f32_16x16x32_bf16 v[104:107], v[48:51], a[116:119], v[104:107]
    s_nop 7
    s_add_u32 s69, s39, 6144
    buffer_load_dwordx4 v[48:51], v26, s[4:7], s69 offen offset:0
    s_waitcnt vmcnt(0)
    v_mfma_f32_16x16x32_bf16 v[108:111], v[48:51], a[96:99], 0
    s_nop 7
    buffer_load_dwordx4 v[48:51], v26, s[4:7], s69 offen offset:64
    s_waitcnt vmcnt(0)
    v_mfma_f32_16x16x32_bf16 v[108:111], v[48:51], a[100:103], v[108:111]
    s_nop 7
    buffer_load_dwordx4 v[48:51], v26, s[4:7], s69 offen offset:128
    s_waitcnt vmcnt(0)
    v_mfma_f32_16x16x32_bf16 v[108:111], v[48:51], a[104:107], v[108:111]
    s_nop 7
    buffer_load_dwordx4 v[48:51], v26, s[4:7], s69 offen offset:192
    s_waitcnt vmcnt(0)
    v_mfma_f32_16x16x32_bf16 v[108:111], v[48:51], a[108:111], v[108:111]
    s_nop 7
    buffer_load_dwordx4 v[48:51], v26, s[4:7], s69 offen offset:256
    s_waitcnt vmcnt(0)
    v_mfma_f32_16x16x32_bf16 v[108:111], v[48:51], a[112:115], v[108:111]
    s_nop 7
    buffer_load_dwordx4 v[48:51], v26, s[4:7], s69 offen offset:320
    s_waitcnt vmcnt(0)
    v_mfma_f32_16x16x32_bf16 v[108:111], v[48:51], a[116:119], v[108:111]
    s_nop 7
    s_nop 15
    v_max3_f32 v14, v104, v105, v106
    v_max3_f32 v14, v14, v107, v108
    v_max3_f32 v14, v14, v109, v110
    v_max_f32 v14, v14, v111
    v_mov_b32 v15, v14
    s_nop 1
    v_permlane32_swap_b32 v15, v14
    v_max_f32 v14, v14, v15
    v_mov_b32 v15, v14
    s_nop 1
    v_permlane16_swap_b32 v15, v14
    v_max_f32 v14, v14, v15
    v_fma_f32 v14, v14, s28, v9
    v_max_f32 v20, 0, v14
    v_sub_f32 v9, v9, v20
    v_sub_f32 v21, 0, v20
    v_exp_f32 v21, v21
    s_nop 0
    v_mul_f32 v15, v44, v21
    v_cndmask_b32_e64 v44, v15, v44, s[60:61]
    v_cndmask_b32_e64 v44, v44, 0, s[46:47]
    v_mul_f32 v112, v112, v21
    v_mul_f32 v113, v113, v21
    v_mul_f32 v114, v114, v21
    v_mul_f32 v115, v115, v21
    v_mul_f32 v116, v116, v21
    v_mul_f32 v117, v117, v21
    v_mul_f32 v118, v118, v21
    v_mul_f32 v119, v119, v21
    v_mul_f32 v120, v120, v21
    v_mul_f32 v121, v121, v21
    v_mul_f32 v122, v122, v21
    v_mul_f32 v123, v123, v21
    v_mul_f32 v124, v124, v21
    v_mul_f32 v125, v125, v21
    v_mul_f32 v126, v126, v21
    v_mul_f32 v127, v127, v21
    v_mul_f32 v128, v128, v21
    v_mul_f32 v129, v129, v21
    v_mul_f32 v130, v130, v21
    v_mul_f32 v131, v131, v21
    v_mul_f32 v132, v132, v21
    v_mul_f32 v133, v133, v21
    v_mul_f32 v134, v134, v21
    v_mul_f32 v135, v135, v21
    v_mul_f32 v136, v136, v21
    v_mul_f32 v137, v137, v21
    v_mul_f32 v138, v138, v21
    v_mul_f32 v139, v139, v21
    v_mul_f32 v140, v140, v21
    v_mul_f32 v141, v141, v21
    v_mul_f32 v142, v142, v21
    v_mul_f32 v143, v143, v21
    v_mul_f32 v144, v144, v21
    v_mul_f32 v145, v145, v21
    v_mul_f32 v146, v146, v21
    v_mul_f32 v147, v147, v21
    v_mul_f32 v148, v148, v21
    v_mul_f32 v149, v149, v21
    v_mul_f32 v150, v150, v21
    v_mul_f32 v151, v151, v21
    v_mul_f32 v152, v152, v21
    v_mul_f32 v153, v153, v21
    v_mul_f32 v154, v154, v21
    v_mul_f32 v155, v155, v21
    v_mul_f32 v156, v156, v21
    v_mul_f32 v157, v157, v21
    v_mul_f32 v158, v158, v21
    v_mul_f32 v159, v159, v21
    v_fma_f32 v104, v104, s28, v9
    v_fma_f32 v105, v105, s28, v9
    v_exp_f32 v104, v104
    v_exp_f32 v105, v105
    s_nop 0
    v_cvt_pk_bf16_f32 v18, v104, v105
    v_fma_f32 v106, v106, s28, v9
    v_fma_f32 v107, v107, s28, v9
    v_exp_f32 v106, v106
    v_exp_f32 v107, v107
    s_nop 0
    v_cvt_pk_bf16_f32 v19, v106, v107
    v_fma_f32 v108, v108, s28, v9
    v_fma_f32 v109, v109, s28, v9
    v_exp_f32 v108, v108
    v_exp_f32 v109, v109
    s_nop 0
    v_cvt_pk_bf16_f32 v16, v108, v109
    v_fma_f32 v110, v110, s28, v9
    v_fma_f32 v111, v111, s28, v9
    v_exp_f32 v110, v110
    v_exp_f32 v111, v111
    s_nop 0
    v_cvt_pk_bf16_f32 v17, v110, v111
    s_add_u32 s69, s39, 0
    buffer_load_dwordx4 v[48:51], v26, s[4:7], s69 offen offset:0
    s_waitcnt vmcnt(0)
    v_mfma_f32_16x16x32_bf16 v[104:107], v[48:51], a[120:123], 0
    s_nop 7
    buffer_load_dwordx4 v[48:51], v26, s[4:7], s69 offen offset:64
    s_waitcnt vmcnt(0)
    v_mfma_f32_16x16x32_bf16 v[104:107], v[48:51], a[124:127], v[104:107]
    s_nop 7
    buffer_load_dwordx4 v[48:51], v26, s[4:7], s69 offen offset:128
    s_waitcnt vmcnt(0)
    v_mfma_f32_16x16x32_bf16 v[104:107], v[48:51], a[128:131], v[104:107]
    s_nop 7
    buffer_load_dwordx4 v[48:51], v26, s[4:7], s69 offen offset:192
    s_waitcnt vmcnt(0)
    v_mfma_f32_16x16x32_bf16 v[104:107], v[48:51], a[132:135], v[104:107]
    s_nop 7
    buffer_load_dwordx4 v[48:51], v26, s[4:7], s69 offen offset:256
    s_waitcnt vmcnt(0)
    v_mfma_f32_16x16x32_bf16 v[104:107], v[48:51], a[136:139], v[104:107]
    s_nop 7
    buffer_load_dwordx4 v[48:51], v26, s[4:7], s69 offen offset:320
    s_waitcnt vmcnt(0)
    v_mfma_f32_16x16x32_bf16 v[104:107], v[48:51], a[140:143], v[104:107]
    s_nop 7
    s_add_u32 s69, s39, 6144
    buffer_load_dwordx4 v[48:51], v26, s[4:7], s69 offen offset:0
    s_waitcnt vmcnt(0)
    v_mfma_f32_16x16x32_bf16 v[108:111], v[48:51], a[120:123], 0
    s_nop 7
    buffer_load_dwordx4 v[48:51], v26, s[4:7], s69 offen offset:64
    s_waitcnt vmcnt(0)
    v_mfma_f32_16x16x32_bf16 v[108:111], v[48:51], a[124:127], v[108:111]
    s_nop 7
    buffer_load_dwordx4 v[48:51], v26, s[4:7], s69 offen offset:128
    s_waitcnt vmcnt(0)
    v_mfma_f32_16x16x32_bf16 v[108:111], v[48:51], a[128:131], v[108:111]
    s_nop 7
    buffer_load_dwordx4 v[48:51], v26, s[4:7], s69 offen offset:192
    s_waitcnt vmcnt(0)
    v_mfma_f32_16x16x32_bf16 v[108:111], v[48:51], a[132:135], v[108:111]
    s_nop 7
    buffer_load_dwordx4 v[48:51], v26, s[4:7], s69 offen offset:256
    s_waitcnt vmcnt(0)
    v_mfma_f32_16x16x32_bf16 v[108:111], v[48:51], a[136:139], v[108:111]
    s_nop 7
    buffer_load_dwordx4 v[48:51], v26, s[4:7], s69 offen offset:320
    s_waitcnt vmcnt(0)
    v_mfma_f32_16x16x32_bf16 v[108:111], v[48:51], a[140:143], v[108:111]
    s_nop 7
    s_nop 15
    v_max3_f32 v14, v104, v105, v106
    v_max3_f32 v14, v14, v107, v108
    v_max3_f32 v14, v14, v109, v110
    v_max_f32 v14, v14, v111
    v_mov_b32 v15, v14
    s_nop 1
    v_permlane32_swap_b32 v15, v14
    v_max_f32 v14, v14, v15
    v_mov_b32 v15, v14
    s_nop 1
    v_permlane16_swap_b32 v15, v14
    v_max_f32 v14, v14, v15
    v_fma_f32 v14, v14, s28, v10
    v_max_f32 v20, 0, v14
    v_sub_f32 v10, v10, v20
    v_sub_f32 v21, 0, v20
    v_exp_f32 v21, v21
    s_nop 0
    v_mul_f32 v45, v45, v21
    v_mul_f32 v160, v160, v21
    v_mul_f32 v161, v161, v21
    v_mul_f32 v162, v162, v21
    v_mul_f32 v163, v163, v21
    v_mul_f32 v164, v164, v21
    v_mul_f32 v165, v165, v21
    v_mul_f32 v166, v166, v21
    v_mul_f32 v167, v167, v21
    v_mul_f32 v168, v168, v21
    v_mul_f32 v169, v169, v21
    v_mul_f32 v170, v170, v21
    v_mul_f32 v171, v171, v21
    v_mul_f32 v172, v172, v21
    v_mul_f32 v173, v173, v21
    v_mul_f32 v174, v174, v21
    v_mul_f32 v175, v175, v21
    v_mul_f32 v176, v176, v21
    v_mul_f32 v177, v177, v21
    v_mul_f32 v178, v178, v21
    v_mul_f32 v179, v179, v21
    v_mul_f32 v180, v180, v21
    v_mul_f32 v181, v181, v21
    v_mul_f32 v182, v182, v21
    v_mul_f32 v183, v183, v21
    v_mul_f32 v184, v184, v21
    v_mul_f32 v185, v185, v21
    v_mul_f32 v186, v186, v21
    v_mul_f32 v187, v187, v21
    v_mul_f32 v188, v188, v21
    v_mul_f32 v189, v189, v21
    v_mul_f32 v190, v190, v21
    v_mul_f32 v191, v191, v21
    v_mul_f32 v192, v192, v21
    v_mul_f32 v193, v193, v21
    v_mul_f32 v194, v194, v21
    v_mul_f32 v195, v195, v21
    v_mul_f32 v196, v196, v21
    v_mul_f32 v197, v197, v21
    v_mul_f32 v198, v198, v21
    v_mul_f32 v199, v199, v21
    v_mul_f32 v200, v200, v21
    v_mul_f32 v201, v201, v21
    v_mul_f32 v202, v202, v21
    v_mul_f32 v203, v203, v21
    v_mul_f32 v204, v204, v21
    v_mul_f32 v205, v205, v21
    v_mul_f32 v206, v206, v21
    v_mul_f32 v207, v207, v21
    v_fma_f32 v104, v104, s28, v10
    v_fma_f32 v105, v105, s28, v10
    v_exp_f32 v104, v104
    v_exp_f32 v105, v105
    s_nop 0
    v_cvt_pk_bf16_f32 v24, v104, v105
    v_fma_f32 v106, v106, s28, v10
    v_fma_f32 v107, v107, s28, v10
    v_exp_f32 v106, v106
    v_exp_f32 v107, v107
    s_nop 0
    v_cvt_pk_bf16_f32 v25, v106, v107
    v_fma_f32 v108, v108, s28, v10
    v_fma_f32 v109, v109, s28, v10
    v_exp_f32 v108, v108
    v_exp_f32 v109, v109
    s_nop 0
    v_cvt_pk_bf16_f32 v22, v108, v109
    v_fma_f32 v110, v110, s28, v10
    v_fma_f32 v111, v111, s28, v10
    v_exp_f32 v110, v110
    v_exp_f32 v111, v111
    s_nop 0
    v_cvt_pk_bf16_f32 v23, v110, v111
    s_add_u32 s69, s39, 0
    buffer_load_dwordx4 v[48:51], v26, s[4:7], s69 offen offset:0
    s_waitcnt vmcnt(0)
    v_mfma_f32_16x16x32_bf16 v[104:107], v[48:51], a[144:147], 0
    s_nop 7
    buffer_load_dwordx4 v[48:51], v26, s[4:7], s69 offen offset:64
    s_waitcnt vmcnt(0)
    v_mfma_f32_16x16x32_bf16 v[104:107], v[48:51], a[148:151], v[104:107]
    s_nop 7
    buffer_load_dwordx4 v[48:51], v26, s[4:7], s69 offen offset:128
    s_waitcnt vmcnt(0)
    v_mfma_f32_16x16x32_bf16 v[104:107], v[48:51], a[152:155], v[104:107]
    s_nop 7
    buffer_load_dwordx4 v[48:51], v26, s[4:7], s69 offen offset:192
    s_waitcnt vmcnt(0)
    v_mfma_f32_16x16x32_bf16 v[104:107], v[48:51], a[156:159], v[104:107]
    s_nop 7
    buffer_load_dwordx4 v[48:51], v26, s[4:7], s69 offen offset:256
    s_waitcnt vmcnt(0)
    v_mfma_f32_16x16x32_bf16 v[104:107], v[48:51], a[160:163], v[104:107]
    s_nop 7
    buffer_load_dwordx4 v[48:51], v26, s[4:7], s69 offen offset:320
    s_waitcnt vmcnt(0)
    v_mfma_f32_16x16x32_bf16 v[104:107], v[48:51], a[164:167], v[104:107]
    s_nop 7
    s_add_u32 s69, s39, 6144
    buffer_load_dwordx4 v[48:51], v26, s[4:7], s69 offen offset:0
    s_waitcnt vmcnt(0)
    v_mfma_f32_16x16x32_bf16 v[108:111], v[48:51], a[144:147], 0
    s_nop 7
    buffer_load_dwordx4 v[48:51], v26, s[4:7], s69 offen offset:64
    s_waitcnt vmcnt(0)
    v_mfma_f32_16x16x32_bf16 v[108:111], v[48:51], a[148:151], v[108:111]
    s_nop 7
    buffer_load_dwordx4 v[48:51], v26, s[4:7], s69 offen offset:128
    s_waitcnt vmcnt(0)
    v_mfma_f32_16x16x32_bf16 v[108:111], v[48:51], a[152:155], v[108:111]
    s_nop 7
    buffer_load_dwordx4 v[48:51], v26, s[4:7], s69 offen offset:192
    s_waitcnt vmcnt(0)
    v_mfma_f32_16x16x32_bf16 v[108:111], v[48:51], a[156:159], v[108:111]
    s_nop 7
    buffer_load_dwordx4 v[48:51], v26, s[4:7], s69 offen offset:256
    s_waitcnt vmcnt(0)
    v_mfma_f32_16x16x32_bf16 v[108:111], v[48:51], a[160:163], v[108:111]
    s_nop 7
    buffer_load_dwordx4 v[48:51], v26, s[4:7], s69 offen offset:320
    s_waitcnt vmcnt(0)
    v_mfma_f32_16x16x32_bf16 v[108:111], v[48:51], a[164:167], v[108:111]
    s_nop 7
    s_nop 15
    v_max3_f32 v14, v104, v105, v106
    v_max3_f32 v14, v14, v107, v108
    v_max3_f32 v14, v14, v109, v110
    v_max_f32 v14, v14, v111
    v_mov_b32 v15, v14
    s_nop 1
    v_permlane32_swap_b32 v15, v14
    v_max_f32 v14, v14, v15
    v_mov_b32 v15, v14
    s_nop 1
    v_permlane16_swap_b32 v15, v14
    v_max_f32 v14, v14, v15
    v_fma_f32 v14, v14, s28, v11
    v_max_f32 v20, 0, v14
    v_sub_f32 v11, v11, v20
    v_sub_f32 v21, 0, v20
    v_exp_f32 v21, v21
    s_nop 0
    v_mul_f32 v46, v46, v21
    v_mul_f32 v208, v208, v21
    v_mul_f32 v209, v209, v21
    v_mul_f32 v210, v210, v21
    v_mul_f32 v211, v211, v21
    v_mul_f32 v212, v212, v21
    v_mul_f32 v213, v213, v21
    v_mul_f32 v214, v214, v21
    v_mul_f32 v215, v215, v21
    v_mul_f32 v216, v216, v21
    v_mul_f32 v217, v217, v21
    v_mul_f32 v218, v218, v21
    v_mul_f32 v219, v219, v21
    v_mul_f32 v220, v220, v21
    v_mul_f32 v221, v221, v21
    v_mul_f32 v222, v222, v21
    v_mul_f32 v223, v223, v21
    v_mul_f32 v224, v224, v21
    v_mul_f32 v225, v225, v21
    v_mul_f32 v226, v226, v21
    v_mul_f32 v227, v227, v21
    v_mul_f32 v228, v228, v21
    v_mul_f32 v229, v229, v21
    v_mul_f32 v230, v230, v21
    v_mul_f32 v231, v231, v21
    v_mul_f32 v232, v232, v21
    v_mul_f32 v233, v233, v21
    v_mul_f32 v234, v234, v21
    v_mul_f32 v235, v235, v21
    v_mul_f32 v236, v236, v21
    v_mul_f32 v237, v237, v21
    v_mul_f32 v238, v238, v21
    v_mul_f32 v239, v239, v21
    v_mul_f32 v240, v240, v21
    v_mul_f32 v241, v241, v21
    v_mul_f32 v242, v242, v21
    v_mul_f32 v243, v243, v21
    v_mul_f32 v244, v244, v21
    v_mul_f32 v245, v245, v21
    v_mul_f32 v246, v246, v21
    v_mul_f32 v247, v247, v21
    v_mul_f32 v248, v248, v21
    v_mul_f32 v249, v249, v21
    v_mul_f32 v250, v250, v21
    v_mul_f32 v251, v251, v21
    v_mul_f32 v252, v252, v21
    v_mul_f32 v253, v253, v21
    v_mul_f32 v254, v254, v21
    v_mul_f32 v255, v255, v21
    v_fma_f32 v104, v104, s28, v11
    v_fma_f32 v105, v105, s28, v11
    v_exp_f32 v104, v104
    v_exp_f32 v105, v105
    s_nop 0
    v_cvt_pk_bf16_f32 v30, v104, v105
    v_fma_f32 v106, v106, s28, v11
    v_fma_f32 v107, v107, s28, v11
    v_exp_f32 v106, v106
    v_exp_f32 v107, v107
    s_nop 0
    v_cvt_pk_bf16_f32 v31, v106, v107
    v_fma_f32 v108, v108, s28, v11
    v_fma_f32 v109, v109, s28, v11
    v_exp_f32 v108, v108
    v_exp_f32 v109, v109
    s_nop 0
    v_cvt_pk_bf16_f32 v28, v108, v109
    v_fma_f32 v110, v110, s28, v11
    v_fma_f32 v111, v111, s28, v11
    v_exp_f32 v110, v110
    v_exp_f32 v111, v111
    s_nop 0
    v_cvt_pk_bf16_f32 v29, v110, v111
    s_add_u32 s69, s39, 0
    buffer_load_dwordx4 v[48:51], v26, s[4:7], s69 offen offset:0
    s_waitcnt vmcnt(0)
    v_mfma_f32_16x16x32_bf16 v[104:107], v[48:51], a[168:171], 0
    s_nop 7
    buffer_load_dwordx4 v[48:51], v26, s[4:7], s69 offen offset:64
    s_waitcnt vmcnt(0)
    v_mfma_f32_16x16x32_bf16 v[104:107], v[48:51], a[172:175], v[104:107]
    s_nop 7
    buffer_load_dwordx4 v[48:51], v26, s[4:7], s69 offen offset:128
    s_waitcnt vmcnt(0)
    v_mfma_f32_16x16x32_bf16 v[104:107], v[48:51], a[176:179], v[104:107]
    s_nop 7
    buffer_load_dwordx4 v[48:51], v26, s[4:7], s69 offen offset:192
    s_waitcnt vmcnt(0)
    v_mfma_f32_16x16x32_bf16 v[104:107], v[48:51], a[180:183], v[104:107]
    s_nop 7
    buffer_load_dwordx4 v[48:51], v26, s[4:7], s69 offen offset:256
    s_waitcnt vmcnt(0)
    v_mfma_f32_16x16x32_bf16 v[104:107], v[48:51], a[184:187], v[104:107]
    s_nop 7
    buffer_load_dwordx4 v[48:51], v26, s[4:7], s69 offen offset:320
    s_waitcnt vmcnt(0)
    v_mfma_f32_16x16x32_bf16 v[104:107], v[48:51], a[188:191], v[104:107]
    s_nop 7
    s_add_u32 s69, s39, 6144
    buffer_load_dwordx4 v[48:51], v26, s[4:7], s69 offen offset:0
    s_waitcnt vmcnt(0)
    v_mfma_f32_16x16x32_bf16 v[108:111], v[48:51], a[168:171], 0
    s_nop 7
    buffer_load_dwordx4 v[48:51], v26, s[4:7], s69 offen offset:64
    s_waitcnt vmcnt(0)
    v_mfma_f32_16x16x32_bf16 v[108:111], v[48:51], a[172:175], v[108:111]
    s_nop 7
    buffer_load_dwordx4 v[48:51], v26, s[4:7], s69 offen offset:128
    s_waitcnt vmcnt(0)
    v_mfma_f32_16x16x32_bf16 v[108:111], v[48:51], a[176:179], v[108:111]
    s_nop 7
    buffer_load_dwordx4 v[48:51], v26, s[4:7], s69 offen offset:192
    s_waitcnt vmcnt(0)
    v_mfma_f32_16x16x32_bf16 v[108:111], v[48:51], a[180:183], v[108:111]
    s_nop 7
    buffer_load_dwordx4 v[48:51], v26, s[4:7], s69 offen offset:256
    s_waitcnt vmcnt(0)
    v_mfma_f32_16x16x32_bf16 v[108:111], v[48:51], a[184:187], v[108:111]
    s_nop 7
    buffer_load_dwordx4 v[48:51], v26, s[4:7], s69 offen offset:320
    s_waitcnt vmcnt(0)
    v_mfma_f32_16x16x32_bf16 v[108:111], v[48:51], a[188:191], v[108:111]
    s_nop 7
    s_nop 15
    v_max3_f32 v14, v104, v105, v106
    v_max3_f32 v14, v14, v107, v108
    v_max3_f32 v14, v14, v109, v110
    v_max_f32 v14, v14, v111
    v_mov_b32 v15, v14
    s_nop 1
    v_permlane32_swap_b32 v15, v14
    v_max_f32 v14, v14, v15
    v_mov_b32 v15, v14
    s_nop 1
    v_permlane16_swap_b32 v15, v14
    v_max_f32 v14, v14, v15
    v_fma_f32 v14, v14, s28, v12
    v_max_f32 v20, 0, v14
    v_sub_f32 v12, v12, v20
    v_sub_f32 v21, 0, v20
    v_exp_f32 v21, v21
    s_nop 0
    v_mul_f32 v47, v47, v21
    v_accvgpr_read_b32 v15, a0
    v_mul_f32 v15, v15, v21
    v_accvgpr_write_b32 a0, v15
    v_accvgpr_read_b32 v15, a1
    v_mul_f32 v15, v15, v21
    v_accvgpr_write_b32 a1, v15
    v_accvgpr_read_b32 v15, a2
    v_mul_f32 v15, v15, v21
    v_accvgpr_write_b32 a2, v15
    v_accvgpr_read_b32 v15, a3
    v_mul_f32 v15, v15, v21
    v_accvgpr_write_b32 a3, v15
    v_accvgpr_read_b32 v15, a4
    v_mul_f32 v15, v15, v21
    v_accvgpr_write_b32 a4, v15
    v_accvgpr_read_b32 v15, a5
    v_mul_f32 v15, v15, v21
    v_accvgpr_write_b32 a5, v15
    v_accvgpr_read_b32 v15, a6
    v_mul_f32 v15, v15, v21
    v_accvgpr_write_b32 a6, v15
    v_accvgpr_read_b32 v15, a7
    v_mul_f32 v15, v15, v21
    v_accvgpr_write_b32 a7, v15
    v_accvgpr_read_b32 v15, a8
    v_mul_f32 v15, v15, v21
    v_accvgpr_write_b32 a8, v15
    v_accvgpr_read_b32 v15, a9
    v_mul_f32 v15, v15, v21
    v_accvgpr_write_b32 a9, v15
    v_accvgpr_read_b32 v15, a10
    v_mul_f32 v15, v15, v21
    v_accvgpr_write_b32 a10, v15
    v_accvgpr_read_b32 v15, a11
    v_mul_f32 v15, v15, v21
    v_accvgpr_write_b32 a11, v15
    v_accvgpr_read_b32 v15, a12
    v_mul_f32 v15, v15, v21
    v_accvgpr_write_b32 a12, v15
    v_accvgpr_read_b32 v15, a13
    v_mul_f32 v15, v15, v21
    v_accvgpr_write_b32 a13, v15
    v_accvgpr_read_b32 v15, a14
    v_mul_f32 v15, v15, v21
    v_accvgpr_write_b32 a14, v15
    v_accvgpr_read_b32 v15, a15
    v_mul_f32 v15, v15, v21
    v_accvgpr_write_b32 a15, v15
    v_accvgpr_read_b32 v15, a16
    v_mul_f32 v15, v15, v21
    v_accvgpr_write_b32 a16, v15
    v_accvgpr_read_b32 v15, a17
    v_mul_f32 v15, v15, v21
    v_accvgpr_write_b32 a17, v15
    v_accvgpr_read_b32 v15, a18
    v_mul_f32 v15, v15, v21
    v_accvgpr_write_b32 a18, v15
    v_accvgpr_read_b32 v15, a19
    v_mul_f32 v15, v15, v21
    v_accvgpr_write_b32 a19, v15
    v_accvgpr_read_b32 v15, a20
    v_mul_f32 v15, v15, v21
    v_accvgpr_write_b32 a20, v15
    v_accvgpr_read_b32 v15, a21
    v_mul_f32 v15, v15, v21
    v_accvgpr_write_b32 a21, v15
    v_accvgpr_read_b32 v15, a22
    v_mul_f32 v15, v15, v21
    v_accvgpr_write_b32 a22, v15
    v_accvgpr_read_b32 v15, a23
    v_mul_f32 v15, v15, v21
    v_accvgpr_write_b32 a23, v15
    v_accvgpr_read_b32 v15, a24
    v_mul_f32 v15, v15, v21
    v_accvgpr_write_b32 a24, v15
    v_accvgpr_read_b32 v15, a25
    v_mul_f32 v15, v15, v21
    v_accvgpr_write_b32 a25, v15
    v_accvgpr_read_b32 v15, a26
    v_mul_f32 v15, v15, v21
    v_accvgpr_write_b32 a26, v15
    v_accvgpr_read_b32 v15, a27
    v_mul_f32 v15, v15, v21
    v_accvgpr_write_b32 a27, v15
    v_accvgpr_read_b32 v15, a28
    v_mul_f32 v15, v15, v21
    v_accvgpr_write_b32 a28, v15
    v_accvgpr_read_b32 v15, a29
    v_mul_f32 v15, v15, v21
    v_accvgpr_write_b32 a29, v15
    v_accvgpr_read_b32 v15, a30
    v_mul_f32 v15, v15, v21
    v_accvgpr_write_b32 a30, v15
    v_accvgpr_read_b32 v15, a31
    v_mul_f32 v15, v15, v21
    v_accvgpr_write_b32 a31, v15
    v_accvgpr_read_b32 v15, a32
    v_mul_f32 v15, v15, v21
    v_accvgpr_write_b32 a32, v15
    v_accvgpr_read_b32 v15, a33
    v_mul_f32 v15, v15, v21
    v_accvgpr_write_b32 a33, v15
    v_accvgpr_read_b32 v15, a34
    v_mul_f32 v15, v15, v21
    v_accvgpr_write_b32 a34, v15
    v_accvgpr_read_b32 v15, a35
    v_mul_f32 v15, v15, v21
    v_accvgpr_write_b32 a35, v15
    v_accvgpr_read_b32 v15, a36
    v_mul_f32 v15, v15, v21
    v_accvgpr_write_b32 a36, v15
    v_accvgpr_read_b32 v15, a37
    v_mul_f32 v15, v15, v21
    v_accvgpr_write_b32 a37, v15
    v_accvgpr_read_b32 v15, a38
    v_mul_f32 v15, v15, v21
    v_accvgpr_write_b32 a38, v15
    v_accvgpr_read_b32 v15, a39
    v_mul_f32 v15, v15, v21
    v_accvgpr_write_b32 a39, v15
    v_accvgpr_read_b32 v15, a40
    v_mul_f32 v15, v15, v21
    v_accvgpr_write_b32 a40, v15
    v_accvgpr_read_b32 v15, a41
    v_mul_f32 v15, v15, v21
    v_accvgpr_write_b32 a41, v15
    v_accvgpr_read_b32 v15, a42
    v_mul_f32 v15, v15, v21
    v_accvgpr_write_b32 a42, v15
    v_accvgpr_read_b32 v15, a43
    v_mul_f32 v15, v15, v21
    v_accvgpr_write_b32 a43, v15
    v_accvgpr_read_b32 v15, a44
    v_mul_f32 v15, v15, v21
    v_accvgpr_write_b32 a44, v15
    v_accvgpr_read_b32 v15, a45
    v_mul_f32 v15, v15, v21
    v_accvgpr_write_b32 a45, v15
    v_accvgpr_read_b32 v15, a46
    v_mul_f32 v15, v15, v21
    v_accvgpr_write_b32 a46, v15
    v_accvgpr_read_b32 v15, a47
    v_mul_f32 v15, v15, v21
    v_accvgpr_write_b32 a47, v15
    v_fma_f32 v104, v104, s28, v12
    v_fma_f32 v105, v105, s28, v12
    v_exp_f32 v104, v104
    v_exp_f32 v105, v105
    s_nop 0
    v_cvt_pk_bf16_f32 v36, v104, v105
    v_fma_f32 v106, v106, s28, v12
    v_fma_f32 v107, v107, s28, v12
    v_exp_f32 v106, v106
    v_exp_f32 v107, v107
    s_nop 0
    v_cvt_pk_bf16_f32 v37, v106, v107
    v_fma_f32 v108, v108, s28, v12
    v_fma_f32 v109, v109, s28, v12
    v_exp_f32 v108, v108
    v_exp_f32 v109, v109
    s_nop 0
    v_cvt_pk_bf16_f32 v34, v108, v109
    v_fma_f32 v110, v110, s28, v12
    v_fma_f32 v111, v111, s28, v12
    v_exp_f32 v110, v110
    v_exp_f32 v111, v111
    s_nop 0
    v_cvt_pk_bf16_f32 v35, v110, v111
    v_mfma_f32_16x16x32_bf16 v[48:51], a[236:239], v[16:19], v[44:47]
    v_mfma_f32_16x16x32_bf16 v[48:51], a[240:243], v[22:25], v[48:51]
    v_mfma_f32_16x16x32_bf16 v[48:51], a[244:247], v[28:31], v[48:51]
    v_mfma_f32_16x16x32_bf16 v[48:51], a[248:251], v[34:37], v[48:51]
    s_nop 15
    s_setpc_b64 s[40:41]
L_rs_start5b:
    s_call_b64 s[40:41], L_rare5_1
    s_branch L_ret_start5b
L_rs_loop5w0a:
    s_call_b64 s[40:41], L_rare5_0
    s_branch L_ret_loop5w0a
L_rs_loop5w0b:
    s_call_b64 s[40:41], L_rare5_1
    s_branch L_ret_loop5w0b
L_rs_loop5w1a:
    s_call_b64 s[40:41], L_rare5_0
    s_branch L_ret_loop5w1a
L_rs_loop5w1b:
    s_call_b64 s[40:41], L_rare5_1
    s_branch L_ret_loop5w1b
L_rs_end5a:
    s_call_b64 s[40:41], L_rare5_0
    s_branch L_ret_end5a
L_rs_end5b:
    s_call_b64 s[40:41], L_rare5_1
    s_branch L_ret_end5b
L_rs_start4b:
    s_call_b64 s[40:41], L_rare4_1
    s_branch L_ret_start4b
L_rs_loop4w0a:
    s_call_b64 s[40:41], L_rare4_0
    s_branch L_ret_loop4w0a
L_rs_loop4w0b:
    s_call_b64 s[40:41], L_rare4_1
    s_branch L_ret_loop4w0b
L_rs_end4a:
    s_call_b64 s[40:41], L_rare4_0
    s_branch L_ret_end4a
L_rs_end4b:
    s_call_b64 s[40:41], L_rare4_1
    s_branch L_ret_end4b
L_rs_tr54a:
    s_call_b64 s[40:41], L_rare5_0
    s_branch L_ret_tr54a
L_rs_tr54b:
    s_nop 15
    s_waitcnt vmcnt(0) lgkmcnt(0)
    s_mov_b32 s68, s14
    s_mov_b32 s14, 166723584
    v_mbcnt_lo_u32_b32 v105, -1, 0
    v_mbcnt_hi_u32_b32 v105, -1, v105
    v_and_b32 v104, 15, v105
    v_mul_u32_u24 v104, 384, v104
    v_lshrrev_b32 v105, 4, v105
    v_lshl_add_u32 v104, v105, 4, v104
    s_add_u32 s69, s34, 0
    buffer_load_dwordx4 a[96:99], v104, s[12:15], s69 offen offset:0
    buffer_load_dwordx4 a[100:103], v104, s[12:15], s69 offen offset:64
    buffer_load_dwordx4 a[104:107], v104, s[12:15], s69 offen offset:128
    buffer_load_dwordx4 a[108:111], v104, s[12:15], s69 offen offset:192
    buffer_load_dwordx4 a[112:115], v104, s[12:15], s69 offen offset:256
    buffer_load_dwordx4 a[116:119], v104, s[12:15], s69 offen offset:320
    s_add_u32 s69, s34, 6144
    buffer_load_dwordx4 a[120:123], v104, s[12:15], s69 offen offset:0
    buffer_load_dwordx4 a[124:127], v104, s[12:15], s69 offen offset:64
    buffer_load_dwordx4 a[128:131], v104, s[12:15], s69 offen offset:128
    buffer_load_dwordx4 a[132:135], v104, s[12:15], s69 offen offset:192
    buffer_load_dwordx4 a[136:139], v104, s[12:15], s69 offen offset:256
    buffer_load_dwordx4 a[140:143], v104, s[12:15], s69 offen offset:320
    s_add_u32 s69, s34, 12288
    buffer_load_dwordx4 a[144:147], v104, s[12:15], s69 offen offset:0
    buffer_load_dwordx4 a[148:151], v104, s[12:15], s69 offen offset:64
    buffer_load_dwordx4 a[152:155], v104, s[12:15], s69 offen offset:128
    buffer_load_dwordx4 a[156:159], v104, s[12:15], s69 offen offset:192
    buffer_load_dwordx4 a[160:163], v104, s[12:15], s69 offen offset:256
    buffer_load_dwordx4 a[164:167], v104, s[12:15], s69 offen offset:320
    s_add_u32 s69, s34, 18432
    buffer_load_dwordx4 a[168:171], v104, s[12:15], s69 offen offset:0
    buffer_load_dwordx4 a[172:175], v104, s[12:15], s69 offen offset:64
    buffer_load_dwordx4 a[176:179], v104, s[12:15], s69 offen offset:128
    buffer_load_dwordx4 a[180:183], v104, s[12:15], s69 offen offset:192
    buffer_load_dwordx4 a[184:187], v104, s[12:15], s69 offen offset:256
    buffer_load_dwordx4 a[188:191], v104, s[12:15], s69 offen offset:320
    s_add_u32 s69, s34, 24576
    buffer_load_dwordx4 a[192:195], v104, s[12:15], s69 offen offset:0
    buffer_load_dwordx4 a[196:199], v104, s[12:15], s69 offen offset:64
    buffer_load_dwordx4 a[200:203], v104, s[12:15], s69 offen offset:128
    buffer_load_dwordx4 a[204:207], v104, s[12:15], s69 offen offset:192
    buffer_load_dwordx4 a[208:211], v104, s[12:15], s69 offen offset:256
    buffer_load_dwordx4 v[92:95], v104, s[12:15], s69 offen offset:320
    s_waitcnt vmcnt(0)
    s_call_b64 s[40:41], L_rare5_1
    v_mbcnt_lo_u32_b32 v105, -1, 0
    v_mbcnt_hi_u32_b32 v105, -1, v105
    v_and_b32 v104, 15, v105
    v_mul_u32_u24 v104, 384, v104
    v_lshrrev_b32 v105, 4, v105
    v_lshl_add_u32 v104, v105, 4, v104
    s_add_u32 s69, s33, 0
    buffer_load_dwordx4 a[96:99], v104, s[12:15], s69 offen offset:0
    buffer_load_dwordx4 a[100:103], v104, s[12:15], s69 offen offset:64
    buffer_load_dwordx4 a[104:107], v104, s[12:15], s69 offen offset:128
    buffer_load_dwordx4 a[108:111], v104, s[12:15], s69 offen offset:192
    buffer_load_dwordx4 a[112:115], v104, s[12:15], s69 offen offset:256
    buffer_load_dwordx4 a[116:119], v104, s[12:15], s69 offen offset:320
    s_add_u32 s69, s33, 6144
    buffer_load_dwordx4 a[120:123], v104, s[12:15], s69 offen offset:0
    buffer_load_dwordx4 a[124:127], v104, s[12:15], s69 offen offset:64
    buffer_load_dwordx4 a[128:131], v104, s[12:15], s69 offen offset:128
    buffer_load_dwordx4 a[132:135], v104, s[12:15], s69 offen offset:192
    buffer_load_dwordx4 a[136:139], v104, s[12:15], s69 offen offset:256
    buffer_load_dwordx4 a[140:143], v104, s[12:15], s69 offen offset:320
    s_add_u32 s69, s33, 12288
    buffer_load_dwordx4 a[144:147], v104, s[12:15], s69 offen offset:0
    buffer_load_dwordx4 a[148:151], v104, s[12:15], s69 offen offset:64
    buffer_load_dwordx4 a[152:155], v104, s[12:15], s69 offen offset:128
    buffer_load_dwordx4 a[156:159], v104, s[12:15], s69 offen offset:192
    buffer_load_dwordx4 a[160:163], v104, s[12:15], s69 offen offset:256
    buffer_load_dwordx4 a[164:167], v104, s[12:15], s69 offen offset:320
    s_add_u32 s69, s33, 18432
    buffer_load_dwordx4 a[168:171], v104, s[12:15], s69 offen offset:0
    buffer_load_dwordx4 a[172:175], v104, s[12:15], s69 offen offset:64
    buffer_load_dwordx4 a[176:179], v104, s[12:15], s69 offen offset:128
    buffer_load_dwordx4 a[180:183], v104, s[12:15], s69 offen offset:192
    buffer_load_dwordx4 a[184:187], v104, s[12:15], s69 offen offset:256
    buffer_load_dwordx4 a[188:191], v104, s[12:15], s69 offen offset:320
    s_waitcnt vmcnt(0)
    s_mov_b32 s14, s68
    s_branch L_ret_tr54b
L_rs_tr54d:
    s_call_b64 s[40:41], L_rare4_1
    s_branch L_ret_tr54d
L_rs_tr45a:
    s_call_b64 s[40:41], L_rare4_0
    s_branch L_ret_tr45a
L_rs_tr45b:
    s_nop 15
    s_waitcnt vmcnt(0) lgkmcnt(0)
    s_mov_b32 s68, s14
    s_mov_b32 s14, 166723584
    v_mbcnt_lo_u32_b32 v105, -1, 0
    v_mbcnt_hi_u32_b32 v105, -1, v105
    v_and_b32 v104, 15, v105
    v_mul_u32_u24 v104, 384, v104
    v_lshrrev_b32 v105, 4, v105
    v_lshl_add_u32 v104, v105, 4, v104
    s_add_u32 s69, s34, 0
    buffer_load_dwordx4 a[96:99], v104, s[12:15], s69 offen offset:0
    buffer_load_dwordx4 a[100:103], v104, s[12:15], s69 offen offset:64
    buffer_load_dwordx4 a[104:107], v104, s[12:15], s69 offen offset:128
    buffer_load_dwordx4 a[108:111], v104, s[12:15], s69 offen offset:192
    buffer_load_dwordx4 a[112:115], v104, s[12:15], s69 offen offset:256
    buffer_load_dwordx4 a[116:119], v104, s[12:15], s69 offen offset:320
    s_add_u32 s69, s34, 6144
    buffer_load_dwordx4 a[120:123], v104, s[12:15], s69 offen offset:0
    buffer_load_dwordx4 a[124:127], v104, s[12:15], s69 offen offset:64
    buffer_load_dwordx4 a[128:131], v104, s[12:15], s69 offen offset:128
    buffer_load_dwordx4 a[132:135], v104, s[12:15], s69 offen offset:192
    buffer_load_dwordx4 a[136:139], v104, s[12:15], s69 offen offset:256
    buffer_load_dwordx4 a[140:143], v104, s[12:15], s69 offen offset:320
    s_add_u32 s69, s34, 12288
    buffer_load_dwordx4 a[144:147], v104, s[12:15], s69 offen offset:0
    buffer_load_dwordx4 a[148:151], v104, s[12:15], s69 offen offset:64
    buffer_load_dwordx4 a[152:155], v104, s[12:15], s69 offen offset:128
    buffer_load_dwordx4 a[156:159], v104, s[12:15], s69 offen offset:192
    buffer_load_dwordx4 a[160:163], v104, s[12:15], s69 offen offset:256
    buffer_load_dwordx4 a[164:167], v104, s[12:15], s69 offen offset:320
    s_add_u32 s69, s34, 18432
    buffer_load_dwordx4 a[168:171], v104, s[12:15], s69 offen offset:0
    buffer_load_dwordx4 a[172:175], v104, s[12:15], s69 offen offset:64
    buffer_load_dwordx4 a[176:179], v104, s[12:15], s69 offen offset:128
    buffer_load_dwordx4 a[180:183], v104, s[12:15], s69 offen offset:192
    buffer_load_dwordx4 a[184:187], v104, s[12:15], s69 offen offset:256
    buffer_load_dwordx4 a[188:191], v104, s[12:15], s69 offen offset:320
    s_waitcnt vmcnt(0)
    s_call_b64 s[40:41], L_rare4_1
    v_mbcnt_lo_u32_b32 v105, -1, 0
    v_mbcnt_hi_u32_b32 v105, -1, v105
    v_and_b32 v104, 15, v105
    v_mul_u32_u24 v104, 384, v104
    v_lshrrev_b32 v105, 4, v105
    v_lshl_add_u32 v104, v105, 4, v104
    s_add_u32 s69, s33, 0
    buffer_load_dwordx4 a[96:99], v104, s[12:15], s69 offen offset:0
    buffer_load_dwordx4 a[100:103], v104, s[12:15], s69 offen offset:64
    buffer_load_dwordx4 a[104:107], v104, s[12:15], s69 offen offset:128
    buffer_load_dwordx4 a[108:111], v104, s[12:15], s69 offen offset:192
    buffer_load_dwordx4 a[112:115], v104, s[12:15], s69 offen offset:256
    buffer_load_dwordx4 a[116:119], v104, s[12:15], s69 offen offset:320
    s_add_u32 s69, s33, 6144
    buffer_load_dwordx4 a[120:123], v104, s[12:15], s69 offen offset:0
    buffer_load_dwordx4 a[124:127], v104, s[12:15], s69 offen offset:64
    buffer_load_dwordx4 a[128:131], v104, s[12:15], s69 offen offset:128
    buffer_load_dwordx4 a[132:135], v104, s[12:15], s69 offen offset:192
    buffer_load_dwordx4 a[136:139], v104, s[12:15], s69 offen offset:256
    buffer_load_dwordx4 a[140:143], v104, s[12:15], s69 offen offset:320
    s_add_u32 s69, s33, 12288
    buffer_load_dwordx4 a[144:147], v104, s[12:15], s69 offen offset:0
    buffer_load_dwordx4 a[148:151], v104, s[12:15], s69 offen offset:64
    buffer_load_dwordx4 a[152:155], v104, s[12:15], s69 offen offset:128
    buffer_load_dwordx4 a[156:159], v104, s[12:15], s69 offen offset:192
    buffer_load_dwordx4 a[160:163], v104, s[12:15], s69 offen offset:256
    buffer_load_dwordx4 a[164:167], v104, s[12:15], s69 offen offset:320
    s_add_u32 s69, s33, 18432
    buffer_load_dwordx4 a[168:171], v104, s[12:15], s69 offen offset:0
    buffer_load_dwordx4 a[172:175], v104, s[12:15], s69 offen offset:64
    buffer_load_dwordx4 a[176:179], v104, s[12:15], s69 offen offset:128
    buffer_load_dwordx4 a[180:183], v104, s[12:15], s69 offen offset:192
    buffer_load_dwordx4 a[184:187], v104, s[12:15], s69 offen offset:256
    buffer_load_dwordx4 a[188:191], v104, s[12:15], s69 offen offset:320
    s_add_u32 s69, s33, 24576
    buffer_load_dwordx4 a[192:195], v104, s[12:15], s69 offen offset:0
    buffer_load_dwordx4 a[196:199], v104, s[12:15], s69 offen offset:64
    buffer_load_dwordx4 a[200:203], v104, s[12:15], s69 offen offset:128
    buffer_load_dwordx4 a[204:207], v104, s[12:15], s69 offen offset:192
    buffer_load_dwordx4 a[208:211], v104, s[12:15], s69 offen offset:256
    buffer_load_dwordx4 v[92:95], v104, s[12:15], s69 offen offset:320
    s_waitcnt vmcnt(0)
    s_mov_b32 s14, s68
    s_branch L_ret_tr45b
L_rs_tr45d:
    s_call_b64 s[40:41], L_rare5_1
    s_branch L_ret_tr45d
L_rs_tr44a:
    s_call_b64 s[40:41], L_rare4_0
    s_branch L_ret_tr44a
L_rs_tr44b:
    s_nop 15
    s_waitcnt vmcnt(0) lgkmcnt(0)
    s_mov_b32 s68, s14
    s_mov_b32 s14, 166723584
    v_mbcnt_lo_u32_b32 v105, -1, 0
    v_mbcnt_hi_u32_b32 v105, -1, v105
    v_and_b32 v104, 15, v105
    v_mul_u32_u24 v104, 384, v104
    v_lshrrev_b32 v105, 4, v105
    v_lshl_add_u32 v104, v105, 4, v104
    s_add_u32 s69, s34, 0
    buffer_load_dwordx4 a[96:99], v104, s[12:15], s69 offen offset:0
    buffer_load_dwordx4 a[100:103], v104, s[12:15], s69 offen offset:64
    buffer_load_dwordx4 a[104:107], v104, s[12:15], s69 offen offset:128
    buffer_load_dwordx4 a[108:111], v104, s[12:15], s69 offen offset:192
    buffer_load_dwordx4 a[112:115], v104, s[12:15], s69 offen offset:256
    buffer_load_dwordx4 a[116:119], v104, s[12:15], s69 offen offset:320
    s_add_u32 s69, s34, 6144
    buffer_load_dwordx4 a[120:123], v104, s[12:15], s69 offen offset:0
    buffer_load_dwordx4 a[124:127], v104, s[12:15], s69 offen offset:64
    buffer_load_dwordx4 a[128:131], v104, s[12:15], s69 offen offset:128
    buffer_load_dwordx4 a[132:135], v104, s[12:15], s69 offen offset:192
    buffer_load_dwordx4 a[136:139], v104, s[12:15], s69 offen offset:256
    buffer_load_dwordx4 a[140:143], v104, s[12:15], s69 offen offset:320
    s_add_u32 s69, s34, 12288
    buffer_load_dwordx4 a[144:147], v104, s[12:15], s69 offen offset:0
    buffer_load_dwordx4 a[148:151], v104, s[12:15], s69 offen offset:64
    buffer_load_dwordx4 a[152:155], v104, s[12:15], s69 offen offset:128
    buffer_load_dwordx4 a[156:159], v104, s[12:15], s69 offen offset:192
    buffer_load_dwordx4 a[160:163], v104, s[12:15], s69 offen offset:256
    buffer_load_dwordx4 a[164:167], v104, s[12:15], s69 offen offset:320
    s_add_u32 s69, s34, 18432
    buffer_load_dwordx4 a[168:171], v104, s[12:15], s69 offen offset:0
    buffer_load_dwordx4 a[172:175], v104, s[12:15], s69 offen offset:64
    buffer_load_dwordx4 a[176:179], v104, s[12:15], s69 offen offset:128
    buffer_load_dwordx4 a[180:183], v104, s[12:15], s69 offen offset:192
    buffer_load_dwordx4 a[184:187], v104, s[12:15], s69 offen offset:256
    buffer_load_dwordx4 a[188:191], v104, s[12:15], s69 offen offset:320
    s_waitcnt vmcnt(0)
    s_call_b64 s[40:41], L_rare4_1
    v_mbcnt_lo_u32_b32 v105, -1, 0
    v_mbcnt_hi_u32_b32 v105, -1, v105
    v_and_b32 v104, 15, v105
    v_mul_u32_u24 v104, 384, v104
    v_lshrrev_b32 v105, 4, v105
    v_lshl_add_u32 v104, v105, 4, v104
    s_add_u32 s69, s33, 0
    buffer_load_dwordx4 a[96:99], v104, s[12:15], s69 offen offset:0
    buffer_load_dwordx4 a[100:103], v104, s[12:15], s69 offen offset:64
    buffer_load_dwordx4 a[104:107], v104, s[12:15], s69 offen offset:128
    buffer_load_dwordx4 a[108:111], v104, s[12:15], s69 offen offset:192
    buffer_load_dwordx4 a[112:115], v104, s[12:15], s69 offen offset:256
    buffer_load_dwordx4 a[116:119], v104, s[12:15], s69 offen offset:320
    s_add_u32 s69, s33, 6144
    buffer_load_dwordx4 a[120:123], v104, s[12:15], s69 offen offset:0
    buffer_load_dwordx4 a[124:127], v104, s[12:15], s69 offen offset:64
    buffer_load_dwordx4 a[128:131], v104, s[12:15], s69 offen offset:128
    buffer_load_dwordx4 a[132:135], v104, s[12:15], s69 offen offset:192
    buffer_load_dwordx4 a[136:139], v104, s[12:15], s69 offen offset:256
    buffer_load_dwordx4 a[140:143], v104, s[12:15], s69 offen offset:320
    s_add_u32 s69, s33, 12288
    buffer_load_dwordx4 a[144:147], v104, s[12:15], s69 offen offset:0
    buffer_load_dwordx4 a[148:151], v104, s[12:15], s69 offen offset:64
    buffer_load_dwordx4 a[152:155], v104, s[12:15], s69 offen offset:128
    buffer_load_dwordx4 a[156:159], v104, s[12:15], s69 offen offset:192
    buffer_load_dwordx4 a[160:163], v104, s[12:15], s69 offen offset:256
    buffer_load_dwordx4 a[164:167], v104, s[12:15], s69 offen offset:320
    s_add_u32 s69, s33, 18432
    buffer_load_dwordx4 a[168:171], v104, s[12:15], s69 offen offset:0
    buffer_load_dwordx4 a[172:175], v104, s[12:15], s69 offen offset:64
    buffer_load_dwordx4 a[176:179], v104, s[12:15], s69 offen offset:128
    buffer_load_dwordx4 a[180:183], v104, s[12:15], s69 offen offset:192
    buffer_load_dwordx4 a[184:187], v104, s[12:15], s69 offen offset:256
    buffer_load_dwordx4 a[188:191], v104, s[12:15], s69 offen offset:320
    s_waitcnt vmcnt(0)
    s_mov_b32 s14, s68
    s_branch L_ret_tr44b
L_rs_tr44d:
    s_call_b64 s[40:41], L_rare4_1
    s_branch L_ret_tr44d
L_rs_tr55a:
    s_call_b64 s[40:41], L_rare5_0
    s_branch L_ret_tr55a
L_rs_tr55b:
    s_nop 15
    s_waitcnt vmcnt(0) lgkmcnt(0)
    s_mov_b32 s68, s14
    s_mov_b32 s14, 166723584
    v_mbcnt_lo_u32_b32 v105, -1, 0
    v_mbcnt_hi_u32_b32 v105, -1, v105
    v_and_b32 v104, 15, v105
    v_mul_u32_u24 v104, 384, v104
    v_lshrrev_b32 v105, 4, v105
    v_lshl_add_u32 v104, v105, 4, v104
    s_add_u32 s69, s34, 0
    buffer_load_dwordx4 a[96:99], v104, s[12:15], s69 offen offset:0
    buffer_load_dwordx4 a[100:103], v104, s[12:15], s69 offen offset:64
    buffer_load_dwordx4 a[104:107], v104, s[12:15], s69 offen offset:128
    buffer_load_dwordx4 a[108:111], v104, s[12:15], s69 offen offset:192
    buffer_load_dwordx4 a[112:115], v104, s[12:15], s69 offen offset:256
    buffer_load_dwordx4 a[116:119], v104, s[12:15], s69 offen offset:320
    s_add_u32 s69, s34, 6144
    buffer_load_dwordx4 a[120:123], v104, s[12:15], s69 offen offset:0
    buffer_load_dwordx4 a[124:127], v104, s[12:15], s69 offen offset:64
    buffer_load_dwordx4 a[128:131], v104, s[12:15], s69 offen offset:128
    buffer_load_dwordx4 a[132:135], v104, s[12:15], s69 offen offset:192
    buffer_load_dwordx4 a[136:139], v104, s[12:15], s69 offen offset:256
    buffer_load_dwordx4 a[140:143], v104, s[12:15], s69 offen offset:320
    s_add_u32 s69, s34, 12288
    buffer_load_dwordx4 a[144:147], v104, s[12:15], s69 offen offset:0
    buffer_load_dwordx4 a[148:151], v104, s[12:15], s69 offen offset:64
    buffer_load_dwordx4 a[152:155], v104, s[12:15], s69 offen offset:128
    buffer_load_dwordx4 a[156:159], v104, s[12:15], s69 offen offset:192
    buffer_load_dwordx4 a[160:163], v104, s[12:15], s69 offen offset:256
    buffer_load_dwordx4 a[164:167], v104, s[12:15], s69 offen offset:320
    s_add_u32 s69, s34, 18432
    buffer_load_dwordx4 a[168:171], v104, s[12:15], s69 offen offset:0
    buffer_load_dwordx4 a[172:175], v104, s[12:15], s69 offen offset:64
    buffer_load_dwordx4 a[176:179], v104, s[12:15], s69 offen offset:128
    buffer_load_dwordx4 a[180:183], v104, s[12:15], s69 offen offset:192
    buffer_load_dwordx4 a[184:187], v104, s[12:15], s69 offen offset:256
    buffer_load_dwordx4 a[188:191], v104, s[12:15], s69 offen offset:320
    s_add_u32 s69, s34, 24576
    buffer_load_dwordx4 a[192:195], v104, s[12:15], s69 offen offset:0
    buffer_load_dwordx4 a[196:199], v104, s[12:15], s69 offen offset:64
    buffer_load_dwordx4 a[200:203], v104, s[12:15], s69 offen offset:128
    buffer_load_dwordx4 a[204:207], v104, s[12:15], s69 offen offset:192
    buffer_load_dwordx4 a[208:211], v104, s[12:15], s69 offen offset:256
    buffer_load_dwordx4 v[92:95], v104, s[12:15], s69 offen offset:320
    s_waitcnt vmcnt(0)
    s_call_b64 s[40:41], L_rare5_1
    v_mbcnt_lo_u32_b32 v105, -1, 0
    v_mbcnt_hi_u32_b32 v105, -1, v105
    v_and_b32 v104, 15, v105
    v_mul_u32_u24 v104, 384, v104
    v_lshrrev_b32 v105, 4, v105
    v_lshl_add_u32 v104, v105, 4, v104
    s_add_u32 s69, s33, 0
    buffer_load_dwordx4 a[96:99], v104, s[12:15], s69 offen offset:0
    buffer_load_dwordx4 a[100:103], v104, s[12:15], s69 offen offset:64
    buffer_load_dwordx4 a[104:107], v104, s[12:15], s69 offen offset:128
    buffer_load_dwordx4 a[108:111], v104, s[12:15], s69 offen offset:192
    buffer_load_dwordx4 a[112:115], v104, s[12:15], s69 offen offset:256
    buffer_load_dwordx4 a[116:119], v104, s[12:15], s69 offen offset:320
    s_add_u32 s69, s33, 6144
    buffer_load_dwordx4 a[120:123], v104, s[12:15], s69 offen offset:0
    buffer_load_dwordx4 a[124:127], v104, s[12:15], s69 offen offset:64
    buffer_load_dwordx4 a[128:131], v104, s[12:15], s69 offen offset:128
    buffer_load_dwordx4 a[132:135], v104, s[12:15], s69 offen offset:192
    buffer_load_dwordx4 a[136:139], v104, s[12:15], s69 offen offset:256
    buffer_load_dwordx4 a[140:143], v104, s[12:15], s69 offen offset:320
    s_add_u32 s69, s33, 12288
    buffer_load_dwordx4 a[144:147], v104, s[12:15], s69 offen offset:0
    buffer_load_dwordx4 a[148:151], v104, s[12:15], s69 offen offset:64
    buffer_load_dwordx4 a[152:155], v104, s[12:15], s69 offen offset:128
    buffer_load_dwordx4 a[156:159], v104, s[12:15], s69 offen offset:192
    buffer_load_dwordx4 a[160:163], v104, s[12:15], s69 offen offset:256
    buffer_load_dwordx4 a[164:167], v104, s[12:15], s69 offen offset:320
    s_add_u32 s69, s33, 18432
    buffer_load_dwordx4 a[168:171], v104, s[12:15], s69 offen offset:0
    buffer_load_dwordx4 a[172:175], v104, s[12:15], s69 offen offset:64
    buffer_load_dwordx4 a[176:179], v104, s[12:15], s69 offen offset:128
    buffer_load_dwordx4 a[180:183], v104, s[12:15], s69 offen offset:192
    buffer_load_dwordx4 a[184:187], v104, s[12:15], s69 offen offset:256
    buffer_load_dwordx4 a[188:191], v104, s[12:15], s69 offen offset:320
    s_add_u32 s69, s33, 24576
    buffer_load_dwordx4 a[192:195], v104, s[12:15], s69 offen offset:0
    buffer_load_dwordx4 a[196:199], v104, s[12:15], s69 offen offset:64
    buffer_load_dwordx4 a[200:203], v104, s[12:15], s69 offen offset:128
    buffer_load_dwordx4 a[204:207], v104, s[12:15], s69 offen offset:192
    buffer_load_dwordx4 a[208:211], v104, s[12:15], s69 offen offset:256
    buffer_load_dwordx4 v[92:95], v104, s[12:15], s69 offen offset:320
    s_waitcnt vmcnt(0)
    s_mov_b32 s14, s68
    s_branch L_ret_tr55b
L_rs_tr55d:
    s_call_b64 s[40:41], L_rare5_1
    s_branch L_ret_tr55d
.section .rodata,"a"
.p2align 6
.amdhsa_kernel standalone__gqa_softmax__near_ridge_kernel
  .amdhsa_next_free_vgpr 512
  .amdhsa_next_free_sgpr 102
  .amdhsa_accum_offset 256
  .amdhsa_group_segment_fixed_size 0
  .amdhsa_kernarg_size 48
  .amdhsa_user_sgpr_count 2
  .amdhsa_user_sgpr_kernarg_segment_ptr 1
  .amdhsa_system_sgpr_workgroup_id_x 1
.end_amdhsa_kernel
```

```asm
; @launch grid=(256,1,1) block=(256,1,1) lds=163840
.amdgcn_target "amdgcn-amd-amdhsa--gfx950"
.text
.globl standalone__gqa_softmax__near_ridge_kernel
.p2align 8
.type standalone__gqa_softmax__near_ridge_kernel,@function
standalone__gqa_softmax__near_ridge_kernel:
    s_cmp_ge_u32 s2, 256
    s_cbranch_scc1 L_end
    s_load_dwordx4 s[84:87], s[0:1], 0
    s_load_dwordx4 s[88:91], s[0:1], 16
    v_lshrrev_b32 v110, 6, v0
    v_and_b32 v111, 63, v0
    s_getpc_b64 s[60:61]
L_pc:
    s_lshr_b32 s62, s2, 3
    v_lshl_add_u32 v53, s62, 2, v110
    v_min_u32 v52, ((L_codeend-L_pc+16383)/16384)-1, v111
    v_mul_u32_u24 v53, ((L_codeend-L_pc+16383)/16384), v53
    v_add_lshl_u32 v52, v52, v53, 7
    v_min_u32 v52, L_codeend-L_pc-4, v52
    global_load_dword v53, v52, s[60:61]
    v_readfirstlane_b32 s3, v110
    v_lshrrev_b32 v96, 3, v111
    v_mul_u32_u24 v7, 384, v96
    v_lshrrev_b32 v97, 1, v96
    v_lshlrev_b32 v97, 1, v97
    v_and_b32 v98, 7, v111
    v_xor_b32 v97, v97, v98
    v_lshl_add_u32 v7, v97, 4, v7
    s_and_b32 s65, s3, 1
    s_mul_i32 s42, s65, 80
    s_mul_i32 s43, s65, 3072
    v_xor_b32 v6, s42, v7
    v_xor_b32 v7, 80, v6
    v_add_u32 v6, s43, v6
    s_sub_u32 s43, 3072, s43
    v_add_u32 v7, s43, v7
    s_mov_b32 s28, 0x3dd53b95
    s_mov_b32 s29, 0x4e800000
    s_mov_b32 s49, 5888
    s_mov_b32 s66, 0x28301800
    s_mov_b32 s46, 0
    s_mov_b32 s47, 0xffff0000
    s_and_b32 s42, s2, 7
    s_lshr_b32 s43, s2, 3
    s_mul_i32 s44, s43, 43
    s_lshr_b32 s44, s44, 7
    s_mov_b32 s39, s44
    s_mul_i32 s45, s44, 3
    s_sub_u32 s36, s43, s45
    s_lshl_b32 s42, s42, 6
    s_lshl_b32 s45, s45, 1
    s_add_u32 s42, s42, s45
    s_mul_i32 s64, s42, 196608
    s_mul_i32 s35, s42, 325632
    s_lshr_b32 s42, s44, 1
    s_mov_b32 s31, 0x5a005a0
    s_cmp_eq_u32 s42, 1
    s_cselect_b32 s31, 0x5a005a0, s31
    s_cmp_eq_u32 s42, 2
    s_cselect_b32 s31, 0x5a005a0, s31
    s_cmp_eq_u32 s42, 3
    s_cselect_b32 s31, 0x5a005a0, s31
    s_cmp_eq_u32 s42, 4
    s_cselect_b32 s31, 0x5a005a0, s31
    s_and_b32 s42, s44, 1
    s_lshl_b32 s42, s42, 4
    s_lshr_b32 s31, s31, s42
    s_and_b32 s31, s31, 0xffff
    s_cmp_eq_u32 s43, 30
    s_cselect_b32 s31, 0x120648, s31
    s_cmp_eq_u32 s43, 31
    s_cselect_b32 s31, 0x240219, s31
    s_lshr_b32 s63, s31, 16
    s_cmp_ge_u32 s43, 30
    s_cselect_b32 s36, 0, s36
    s_cselect_b32 s42, 4, 6
    s_mul_i32 s42, s42, 196608
    s_add_u32 s6, s64, s42
    s_mov_b32 s10, s6
    s_mul_i32 s22, s3, 3072
    s_mul_i32 s38, s3, 28672
    s_add_u32 s38, s38, 49152
    s_and_b32 s42, s3, 2
    s_mul_i32 s42, s42, 3072
    s_add_u32 s20, s64, s42
    s_mov_b32 s21, s20
    s_mov_b32 s14, 166723584
    s_mov_b32 s18, 0
    s_mov_b32 s67, 0
    s_mov_b32 s37, 0
    s_mov_b32 s60, 0
    s_mov_b32 s61, 0xffff
    s_lshl_b32 s42, s37, 1
    s_lshr_b32 s42, s31, s42
    s_and_b32 s42, s42, 3
    s_add_u32 s42, s42, s36
    s_sub_u32 s43, s42, 3
    s_cmp_ge_u32 s42, 3
    s_cselect_b32 s42, s43, s42
    s_mul_i32 s44, s3, 5
    s_mov_b32 s32, 1
    s_lshl_b32 s43, s3, 2
    s_add_u32 s45, s43, 21
    s_cmp_eq_u32 s3, 0
    s_cselect_b32 s45, 20, s45
    s_cselect_b32 s34, 1, 0
    s_cmp_eq_u32 s42, 1
    s_cselect_b32 s44, s45, s44
    s_cselect_b32 s32, s34, s32
    s_add_u32 s45, s43, 37
    s_cmp_eq_u32 s42, 2
    s_cselect_b32 s44, s45, s44
    s_cselect_b32 s32, 0, s32
    s_mul_i32 s44, s44, 6144
    s_add_u32 s34, s35, s44
    s_waitcnt lgkmcnt(0)
    s_mov_b32 s12, s84
    s_and_b32 s13, s85, 0xffff
    s_mov_b32 s15, 0x20000
    s_mov_b32 s4, s86
    s_and_b32 s5, s87, 0xffff
    s_mov_b32 s7, 0x20000
    s_mov_b32 s8, s88
    s_and_b32 s9, s89, 0xffff
    s_mov_b32 s11, 0x20000
    s_mov_b32 s16, s90
    s_and_b32 s17, s91, 0xffff
    s_mov_b32 s19, 0x20000
    s_cmp_eq_u32 s32, 0
    s_cbranch_scc1 L_start4
L_start5:
    s_add_u32 m0, s22, 0
    s_nop 0
    buffer_load_dwordx4 v6, s[4:7], s20 offen lds
    s_add_u32 s20, s20, 128
    s_add_u32 m0, s22, 1024
    s_nop 0
    buffer_load_dwordx4 v6, s[4:7], s20 offen lds
    s_add_u32 s20, s20, 128
    s_add_u32 m0, s22, 2048
    s_nop 0
    buffer_load_dwordx4 v6, s[4:7], s20 offen lds
    s_add_u32 s20, s20, 12032
    s_add_u32 m0, s22, 12288
    s_nop 0
    buffer_load_dwordx4 v6, s[4:7], s20 offen lds
    s_add_u32 s20, s20, 128
    s_add_u32 m0, s22, 13312
    s_nop 0
    buffer_load_dwordx4 v6, s[4:7], s20 offen lds
    s_add_u32 s20, s20, 128
    s_add_u32 m0, s22, 14336
    s_nop 0
    buffer_load_dwordx4 v6, s[4:7], s20 offen lds
    s_add_u32 s20, s20, 12032
    s_add_u32 s48, s34, 0
    s_add_u32 m0, s38, 0
    s_nop 0
    buffer_load_dwordx4 v6, s[12:15], s48 offen nt lds
    s_add_u32 m0, s38, 1024
    s_nop 0
    buffer_load_dwordx4 v7, s[12:15], s48 offen nt lds
    s_add_u32 s48, s34, 128
    s_add_u32 m0, s38, 2048
    s_nop 0
    buffer_load_dwordx4 v6, s[12:15], s48 offen nt lds
    s_add_u32 m0, s38, 3072
    s_nop 0
    buffer_load_dwordx4 v7, s[12:15], s48 offen nt lds
    s_add_u32 s48, s34, 256
    s_add_u32 m0, s38, 4096
    s_nop 0
    buffer_load_dwordx4 v6, s[12:15], s48 offen nt lds
    s_add_u32 m0, s38, 5120
    s_nop 0
    buffer_load_dwordx4 v7, s[12:15], s48 offen nt lds
    s_add_u32 s48, s34, 6144
    s_add_u32 m0, s38, 6144
    s_nop 0
    buffer_load_dwordx4 v6, s[12:15], s48 offen nt lds
    s_add_u32 m0, s38, 7168
    s_nop 0
    buffer_load_dwordx4 v7, s[12:15], s48 offen nt lds
    s_add_u32 s48, s34, 6272
    s_add_u32 m0, s38, 8192
    s_nop 0
    buffer_load_dwordx4 v6, s[12:15], s48 offen nt lds
    s_add_u32 m0, s38, 9216
    s_nop 0
    buffer_load_dwordx4 v7, s[12:15], s48 offen nt lds
    s_add_u32 s48, s34, 6400
    s_add_u32 m0, s38, 10240
    s_nop 0
    buffer_load_dwordx4 v6, s[12:15], s48 offen nt lds
    s_add_u32 m0, s38, 11264
    s_nop 0
    buffer_load_dwordx4 v7, s[12:15], s48 offen nt lds
    s_add_u32 s48, s34, 12288
    s_add_u32 m0, s38, 12288
    s_nop 0
    buffer_load_dwordx4 v6, s[12:15], s48 offen nt lds
    s_add_u32 m0, s38, 13312
    s_nop 0
    buffer_load_dwordx4 v7, s[12:15], s48 offen nt lds
    s_add_u32 s48, s34, 12416
    s_add_u32 m0, s38, 14336
    s_nop 0
    buffer_load_dwordx4 v6, s[12:15], s48 offen nt lds
    s_add_u32 m0, s38, 15360
    s_nop 0
    buffer_load_dwordx4 v7, s[12:15], s48 offen nt lds
    s_add_u32 s48, s34, 12544
    s_add_u32 m0, s38, 16384
    s_nop 0
    buffer_load_dwordx4 v6, s[12:15], s48 offen nt lds
    s_add_u32 m0, s38, 17408
    s_nop 0
    buffer_load_dwordx4 v7, s[12:15], s48 offen nt lds
    v_and_b32 v96, 15, v111
    v_lshrrev_b32 v97, 4, v111
    v_lshrrev_b32 v98, 3, v96
    v_and_b32 v99, 7, v96
    v_lshlrev_b32 v0, 7, v99
    v_bfe_u32 v99, v96, 1, 2
    v_lshlrev_b32 v99, 1, v99
    v_mul_u32_u24 v100, 5, v98
    v_xor_b32 v99, v99, v100
    v_xor_b32 v99, v99, v97
    v_lshl_add_u32 v0, v99, 4, v0
    v_mul_u32_u24 v100, 3072, v98
    v_add_u32 v0, v100, v0
    v_xor_b32 v1, 64, v0
    v_lshrrev_b32 v98, 1, v97
    v_mul_u32_u24 v2, 3072, v98
    v_and_b32 v99, 1, v97
    v_bfe_u32 v100, v111, 2, 2
    v_lshl_add_u32 v96, v99, 2, v100
    v_lshl_add_u32 v2, v96, 7, v2
    v_lshrrev_b32 v96, 1, v96
    v_lshlrev_b32 v96, 1, v96
    v_mul_u32_u24 v98, 5, v98
    v_xor_b32 v96, v96, v98
    v_bfe_u32 v99, v111, 1, 1
    v_xor_b32 v96, v96, v99
    v_lshl_add_u32 v2, v96, 4, v2
    v_and_b32 v99, 1, v111
    v_lshl_add_u32 v2, v99, 3, v2
    v_add_u32 v2, 24576, v2
    v_xor_b32 v3, 32, v2
    v_xor_b32 v4, 64, v2
    v_xor_b32 v5, 96, v2
    v_lshl_add_u32 v103, v111, 4, s38
    v_and_b32 v96, 15, v111
    s_mov_b32 s42, 0x1011
    v_bfe_i32 v97, s42, v96, 1
    v_and_b32 v97, 0x3f803f80, v97
    v_accvgpr_write_b32 a236, v97
    v_accvgpr_write_b32 a237, v97
    v_accvgpr_write_b32 a238, v97
    v_accvgpr_write_b32 a239, v97
    s_mov_b32 s42, 0x3222
    v_bfe_i32 v97, s42, v96, 1
    v_and_b32 v97, 0x3f803f80, v97
    v_accvgpr_write_b32 a240, v97
    v_accvgpr_write_b32 a241, v97
    v_accvgpr_write_b32 a242, v97
    v_accvgpr_write_b32 a243, v97
    s_mov_b32 s42, 0x5444
    v_bfe_i32 v97, s42, v96, 1
    v_and_b32 v97, 0x3f803f80, v97
    v_accvgpr_write_b32 a244, v97
    v_accvgpr_write_b32 a245, v97
    v_accvgpr_write_b32 a246, v97
    v_accvgpr_write_b32 a247, v97
    s_mov_b32 s42, 0x9888
    v_bfe_i32 v97, s42, v96, 1
    v_and_b32 v97, 0x3f803f80, v97
    v_accvgpr_write_b32 a248, v97
    v_accvgpr_write_b32 a249, v97
    v_accvgpr_write_b32 a250, v97
    v_accvgpr_write_b32 a251, v97
    s_mov_b32 s42, 0x1100
    v_bfe_i32 v97, s42, v96, 1
    v_and_b32 v97, 0x3f803f80, v97
    v_accvgpr_write_b32 a252, v97
    v_accvgpr_write_b32 a253, v97
    v_accvgpr_write_b32 a254, v97
    v_accvgpr_write_b32 a255, v97
    s_waitcnt vmcnt(18)
    s_barrier
    s_waitcnt vmcnt(12)
    s_add_u32 s48, s34, 18432
    s_add_u32 m0, s38, 18432
    s_nop 0
    buffer_load_dwordx4 v6, s[12:15], s48 offen nt lds
    v_lshrrev_b32 v105, 11, v0
    s_add_u32 m0, s38, 19456
    s_nop 0
    buffer_load_dwordx4 v7, s[12:15], s48 offen nt lds
    s_add_u32 s48, s34, 18560
    ds_read_b128 a[220:223], v0 offset:1024
    v_and_b32 v104, 0x3ff, v0
    s_add_u32 m0, s38, 20480
    v_xor_b32 v105, s65, v105
    buffer_load_dwordx4 v6, s[12:15], s48 offen nt lds
    ds_read_b128 a[212:215], v0 offset:0
    ds_read_b128 a[216:219], v1 offset:0
    v_lshl_add_u32 v104, v105, 10, v104
    v_add_u32 v104, s38, v104
    s_add_u32 m0, s38, 21504
    v_xor_b32 v105, 64, v104
    buffer_load_dwordx4 v7, s[12:15], s48 offen nt lds
    s_add_u32 s48, s34, 18688
    ds_read_b128 a[96:99], v104 offset:0
    s_add_u32 m0, s38, 22528
    v_mbcnt_lo_u32_b32 v107, -1, 0
    buffer_load_dwordx4 v6, s[12:15], s48 offen nt lds
    s_add_u32 m0, s38, 23552
    ds_read_b128 a[224:227], v1 offset:1024
    ds_read_b128 a[104:107], v104 offset:2048
    ds_read_b128 a[116:119], v105 offset:4096
    ds_read_b128 a[100:103], v105 offset:0
    buffer_load_dwordx4 v7, s[12:15], s48 offen nt lds
    ds_read_b128 a[232:235], v1 offset:2048
    s_waitcnt lgkmcnt(5)
    v_mfma_f32_16x16x32_bf16 v[52:55], a[212:215], a[96:99], 0
    ds_read_b128 a[228:231], v0 offset:2048
    s_waitcnt lgkmcnt(2)
    v_mfma_f32_16x16x32_bf16 v[52:55], a[216:219], a[100:103], v[52:55]
    v_mbcnt_hi_u32_b32 v107, -1, v107
    ds_read_b128 a[108:111], v105 offset:2048
    v_mfma_f32_16x16x32_bf16 v[52:55], a[220:223], a[104:107], v[52:55]
    ds_read_b128 a[112:115], v104 offset:4096
    s_waitcnt lgkmcnt(1)
    v_mfma_f32_16x16x32_bf16 v[52:55], a[224:227], a[108:111], v[52:55]
    ds_read_b128 a[220:223], v0 offset:7168
    s_waitcnt lgkmcnt(1)
    v_mfma_f32_16x16x32_bf16 v[52:55], a[228:231], a[112:115], v[52:55]
    v_and_b32 v106, 15, v107
    ds_read_b128 a[212:215], v0 offset:6144
    v_mfma_f32_16x16x32_bf16 v[52:55], a[232:235], a[116:119], v[52:55]
    ds_read_b128 a[216:219], v1 offset:6144
    s_waitcnt lgkmcnt(1)
    v_mfma_f32_16x16x32_bf16 v[56:59], a[212:215], a[96:99], 0
    ds_read_b128 a[224:227], v1 offset:7168
    s_waitcnt lgkmcnt(1)
    v_mfma_f32_16x16x32_bf16 v[56:59], a[216:219], a[100:103], v[56:59]
    ds_read_b128 a[232:235], v1 offset:8192
    s_nop 0
    v_max3_f32 v96, v52, v53, v54
    ds_read_b128 a[212:215], v0 offset:12288
    v_mfma_f32_16x16x32_bf16 v[56:59], a[220:223], a[104:107], v[56:59]
    ds_read_b128 a[220:223], v0 offset:13312
    s_waitcnt lgkmcnt(3)
    v_mfma_f32_16x16x32_bf16 v[56:59], a[224:227], a[108:111], v[56:59]
    ds_read_b128 a[228:231], v0 offset:8192
    s_waitcnt lgkmcnt(0)
    v_mfma_f32_16x16x32_bf16 v[56:59], a[228:231], a[112:115], v[56:59]
    ds_read_b128 a[228:231], v0 offset:14336
    v_mfma_f32_16x16x32_bf16 v[56:59], a[232:235], a[116:119], v[56:59]
    s_nop 7
    v_max3_f32 v96, v96, v55, v56
    v_max3_f32 v96, v96, v57, v58
    v_max_f32 v96, v96, v59
    v_mul_u32_u24 v106, 384, v106
    ds_read_b128 a[232:235], v1 offset:14336
    v_mov_b32 v97, v96
    s_nop 1
    v_permlane32_swap_b32 v97, v96
    v_lshrrev_b32 v107, 4, v107
    v_max_f32 v96, v96, v97
    v_mov_b32 v97, v96
    s_nop 1
    v_permlane16_swap_b32 v97, v96
    v_max_f32 v96, v96, v97
    v_mul_f32_e64 v9, -s28, v96
    v_fma_f32 v54, v54, s28, v9
    v_fma_f32 v59, v59, s28, v9
    v_fma_f32 v55, v55, s28, v9
    v_fma_f32 v52, v52, s28, v9
    v_exp_f32 v59, v59
    v_fma_f32 v58, v58, s28, v9
    v_exp_f32 v55, v55
    v_fma_f32 v53, v53, s28, v9
    v_exp_f32 v54, v54
    ds_read_b128 a[224:227], v1 offset:13312
    v_cvt_pk_bf16_f32 v15, v54, v55
    ds_read_b128 a[216:219], v1 offset:12288
    v_fma_f32 v56, v56, s28, v9
    v_exp_f32 v53, v53
    v_exp_f32 v52, v52
    v_exp_f32 v56, v56
    v_cvt_pk_bf16_f32 v14, v52, v53
    v_fma_f32 v57, v57, s28, v9
    v_exp_f32 v58, v58
    s_waitcnt vmcnt(12)
    s_add_u32 s48, s34, 24576
    s_add_u32 m0, s38, 24576
    s_nop 0
    buffer_load_dwordx4 v6, s[12:15], s48 offen nt lds
    s_add_u32 m0, s38, 25600
    v_mfma_f32_16x16x32_bf16 v[52:55], a[212:215], a[96:99], 0
    buffer_load_dwordx4 v7, s[12:15], s48 offen nt lds
    s_add_u32 s48, s34, 24704
    ds_read_b128 a[212:215], v0 offset:18432
    s_waitcnt lgkmcnt(1)
    v_mfma_f32_16x16x32_bf16 v[52:55], a[216:219], a[100:103], v[52:55]
    s_add_u32 m0, s38, 26624
    s_nop 0
    buffer_load_dwordx4 v6, s[12:15], s48 offen nt lds
    ds_read_b128 a[216:219], v1 offset:18432
    v_exp_f32 v57, v57
    s_add_u32 m0, s38, 27648
    v_mfma_f32_16x16x32_bf16 v[52:55], a[220:223], a[104:107], v[52:55]
    buffer_load_dwordx4 v7, s[12:15], s48 offen nt lds
    s_add_u32 s48, s34, 24576
    ds_read_b128 a[140:143], v105 offset:10240
    v_lshl_add_u32 v106, v107, 4, v106
    v_mfma_f32_16x16x32_bf16 v[52:55], a[224:227], a[108:111], v[52:55]
    ds_read_b128 a[132:135], v105 offset:8192
    buffer_load_dwordx4 a[208:211], v106, s[12:15], s48 offen offset:256 nt
    ds_read_b128 a[120:123], v104 offset:6144
    v_mfma_f32_16x16x32_bf16 v[52:55], a[228:231], a[112:115], v[52:55]
    ds_read_b128 a[224:227], v1 offset:19456
    v_cvt_pk_bf16_f32 v17, v58, v59
    ds_read_b128 a[228:231], v0 offset:20480
    v_cvt_pk_bf16_f32 v16, v56, v57
    v_mfma_f32_16x16x32_bf16 v[52:55], a[232:235], a[116:119], v[52:55]
    ds_read_b128 a[220:223], v0 offset:19456
    buffer_load_dwordx4 v[92:95], v106, s[12:15], s48 offen offset:320 nt
    s_waitcnt lgkmcnt(7)
    v_mfma_f32_16x16x32_bf16 v[56:59], a[212:215], a[96:99], 0
    ds_read_b128 a[232:235], v1 offset:20480
    s_waitcnt lgkmcnt(7)
    v_mfma_f32_16x16x32_bf16 v[56:59], a[216:219], a[100:103], v[56:59]
    ds_read_b128 a[216:219], v1 offset:0
    s_waitcnt lgkmcnt(2)
    v_mfma_f32_16x16x32_bf16 v[56:59], a[220:223], a[104:107], v[56:59]
    ds_read_b128 a[220:223], v0 offset:1024
    ds_read_b128 a[128:131], v104 offset:8192
    v_mfma_f32_16x16x32_bf16 v[56:59], a[224:227], a[108:111], v[56:59]
    ds_read_b128 a[136:139], v104 offset:10240
    v_mfma_f32_16x16x32_bf16 v[56:59], a[228:231], a[112:115], v[56:59]
    s_waitcnt lgkmcnt(4)
    ds_read_b128 a[228:231], v0 offset:2048
    ds_read_b128 a[212:215], v0 offset:0
    v_mfma_f32_16x16x32_bf16 v[56:59], a[232:235], a[116:119], v[56:59]
    ds_read_b128 a[124:127], v105 offset:6144
    s_waitcnt lgkmcnt(1)
    v_mfma_f32_16x16x32_bf16 v[60:63], a[212:215], a[120:123], 0
    ds_read_b128 a[232:235], v1 offset:2048
    s_waitcnt lgkmcnt(1)
    v_mfma_f32_16x16x32_bf16 v[60:63], a[216:219], a[124:127], v[60:63]
    ds_read_b128 a[212:215], v0 offset:6144
    v_mfma_f32_16x16x32_bf16 v[60:63], a[220:223], a[128:131], v[60:63]
    ds_read_b128 a[224:227], v1 offset:1024
    s_waitcnt lgkmcnt(0)
    v_mfma_f32_16x16x32_bf16 v[60:63], a[224:227], a[132:135], v[60:63]
    ds_read_b128 a[220:223], v0 offset:7168
    v_mfma_f32_16x16x32_bf16 v[60:63], a[228:231], a[136:139], v[60:63]
    ds_read_b128 a[228:231], v0 offset:8192
    v_mfma_f32_16x16x32_bf16 v[60:63], a[232:235], a[140:143], v[60:63]
    ds_read_b128 a[216:219], v1 offset:6144
    v_mfma_f32_16x16x32_bf16 v[64:67], a[212:215], a[120:123], 0
    s_nop 5
    v_max3_f32 v98, v60, v61, v62
    ds_read_b128 a[212:215], v0 offset:12288
    s_waitcnt lgkmcnt(1)
    v_mfma_f32_16x16x32_bf16 v[64:67], a[216:219], a[124:127], v[64:67]
    ds_read_b128 a[224:227], v1 offset:7168
    v_mfma_f32_16x16x32_bf16 v[64:67], a[220:223], a[128:131], v[64:67]
    ds_read_b128 a[220:223], v0 offset:13312
    s_waitcnt lgkmcnt(1)
    v_mfma_f32_16x16x32_bf16 v[64:67], a[224:227], a[132:135], v[64:67]
    ds_read_b128 a[232:235], v1 offset:8192
    v_mfma_f32_16x16x32_bf16 v[64:67], a[228:231], a[136:139], v[64:67]
    ds_read_b128 a[228:231], v0 offset:14336
    v_fma_f32 v52, v52, s28, v9
    s_waitcnt lgkmcnt(1)
    v_mfma_f32_16x16x32_bf16 v[64:67], a[232:235], a[140:143], v[64:67]
    s_nop 7
    v_max3_f32 v98, v98, v63, v64
    v_max3_f32 v98, v98, v65, v66
    v_max_f32 v98, v98, v67
    v_mov_b32 v99, v98
    s_nop 1
    v_permlane32_swap_b32 v99, v98
    v_max_f32 v98, v98, v99
    v_mov_b32 v99, v98
    s_nop 1
    v_permlane16_swap_b32 v99, v98
    v_max_f32 v98, v98, v99
    v_mul_f32_e64 v10, -s28, v98
    v_fma_f32 v54, v54, s28, v9
    v_fma_f32 v63, v63, s28, v10
    v_fma_f32 v60, v60, s28, v10
    ds_read_b128 a[232:235], v1 offset:14336
    v_fma_f32 v67, v67, s28, v10
    v_fma_f32 v66, v66, s28, v10
    v_fma_f32 v64, v64, s28, v10
    v_exp_f32 v63, v63
    v_fma_f32 v65, v65, s28, v10
    v_exp_f32 v65, v65
    v_exp_f32 v64, v64
    v_fma_f32 v61, v61, s28, v10
    v_exp_f32 v67, v67
    v_exp_f32 v61, v61
    v_exp_f32 v60, v60
    ds_read_b128 a[216:219], v1 offset:12288
    v_cvt_pk_bf16_f32 v20, v60, v61
    v_fma_f32 v62, v62, s28, v10
    v_exp_f32 v62, v62
    v_exp_f32 v66, v66
    s_nop 0
    v_cvt_pk_bf16_f32 v23, v66, v67
    v_cvt_pk_bf16_f32 v21, v62, v63
    s_waitcnt vmcnt(12)
    s_add_u32 m0, s22, 24576
    s_nop 0
    buffer_load_dwordx4 v6, s[8:11], s21 offen lds
    v_mfma_f32_16x16x32_bf16 v[44:47], a[236:239], v[14:17], 0
    s_add_u32 s21, s21, 128
    s_add_u32 m0, s22, 25600
    s_nop 0
    buffer_load_dwordx4 v6, s[8:11], s21 offen lds
    s_add_u32 s21, s21, 128
    ds_read_b128 a[152:155], v104 offset:14336
    s_add_u32 m0, s22, 26624
    ds_read_b128 a[224:227], v1 offset:13312
    v_mfma_f32_16x16x32_bf16 v[60:63], a[212:215], a[120:123], 0
    ds_read_b128 a[212:215], v0 offset:18432
    buffer_load_dwordx4 v6, s[8:11], s21 offen lds
    s_waitcnt lgkmcnt(3)
    v_mfma_f32_16x16x32_bf16 v[60:63], a[216:219], a[124:127], v[60:63]
    ds_read_b128 a[144:147], v104 offset:12288
    v_mfma_f32_16x16x32_bf16 v[60:63], a[220:223], a[128:131], v[60:63]
    ds_read_b128 a[216:219], v1 offset:18432
    s_waitcnt lgkmcnt(3)
    v_mfma_f32_16x16x32_bf16 v[60:63], a[224:227], a[132:135], v[60:63]
    ds_read_b128 a[220:223], v0 offset:19456
    ds_read_b128 a[156:159], v105 offset:14336
    v_cvt_pk_bf16_f32 v22, v64, v65
    v_mfma_f32_16x16x32_bf16 v[60:63], a[228:231], a[136:139], v[60:63]
    ds_read_b128 a[224:227], v1 offset:19456
    s_add_u32 s21, s21, 12032
    v_mfma_f32_16x16x32_bf16 v[60:63], a[232:235], a[140:143], v[60:63]
    s_waitcnt lgkmcnt(5)
    ds_read_b128 a[228:231], v0 offset:20480
    v_fma_f32 v55, v55, s28, v9
    v_mfma_f32_16x16x32_bf16 v[64:67], a[212:215], a[120:123], 0
    ds_read_b128 a[232:235], v1 offset:20480
    s_waitcnt lgkmcnt(5)
    v_mfma_f32_16x16x32_bf16 v[64:67], a[216:219], a[124:127], v[64:67]
    ds_read_b128 a[164:167], v105 offset:16384
    s_waitcnt lgkmcnt(5)
    v_mfma_f32_16x16x32_bf16 v[64:67], a[220:223], a[128:131], v[64:67]
    ds_read_b128 a[216:219], v1 offset:0
    s_waitcnt lgkmcnt(4)
    v_mfma_f32_16x16x32_bf16 v[64:67], a[224:227], a[132:135], v[64:67]
    ds_read_b128 a[148:151], v105 offset:12288
    s_waitcnt lgkmcnt(4)
    v_mfma_f32_16x16x32_bf16 v[64:67], a[228:231], a[136:139], v[64:67]
    ds_read_b128 a[212:215], v0 offset:0
    s_waitcnt lgkmcnt(4)
    v_mfma_f32_16x16x32_bf16 v[64:67], a[232:235], a[140:143], v[64:67]
    ds_read_b128 a[220:223], v0 offset:1024
    s_waitcnt lgkmcnt(1)
    v_mfma_f32_16x16x32_bf16 v[68:71], a[212:215], a[144:147], 0
    ds_read_b128 a[224:227], v1 offset:1024
    ds_read_b128 a[228:231], v0 offset:2048
    v_mfma_f32_16x16x32_bf16 v[68:71], a[216:219], a[148:151], v[68:71]
    s_waitcnt lgkmcnt(2)
    ds_read_b128 a[232:235], v1 offset:2048
    v_mfma_f32_16x16x32_bf16 v[68:71], a[220:223], a[152:155], v[68:71]
    ds_read_b128 a[160:163], v104 offset:16384
    ds_read_b128 a[216:219], v1 offset:6144
    s_waitcnt lgkmcnt(4)
    v_mfma_f32_16x16x32_bf16 v[68:71], a[224:227], a[156:159], v[68:71]
    ds_read_b128 a[212:215], v0 offset:6144
    s_waitcnt lgkmcnt(2)
    v_mfma_f32_16x16x32_bf16 v[68:71], a[228:231], a[160:163], v[68:71]
    ds_read_b128 a[220:223], v0 offset:7168
    v_mfma_f32_16x16x32_bf16 v[68:71], a[232:235], a[164:167], v[68:71]
    s_nop 7
    v_max3_f32 v96, v68, v69, v70
    ds_read_b128 a[232:235], v1 offset:8192
    s_waitcnt lgkmcnt(2)
    v_mfma_f32_16x16x32_bf16 v[72:75], a[212:215], a[144:147], 0
    ds_read_b128 a[228:231], v0 offset:8192
    v_mfma_f32_16x16x32_bf16 v[72:75], a[216:219], a[148:151], v[72:75]
    ds_read_b128 a[212:215], v0 offset:12288
    v_fma_f32 v53, v53, s28, v9
    s_waitcnt lgkmcnt(3)
    v_mfma_f32_16x16x32_bf16 v[72:75], a[220:223], a[152:155], v[72:75]
    ds_read_b128 a[224:227], v1 offset:7168
    ds_read_b128 a[220:223], v0 offset:13312
    v_fma_f32 v60, v60, s28, v10
    s_waitcnt lgkmcnt(1)
    v_mfma_f32_16x16x32_bf16 v[72:75], a[224:227], a[156:159], v[72:75]
    ds_read_b128 a[224:227], v1 offset:13312
    v_mfma_f32_16x16x32_bf16 v[72:75], a[228:231], a[160:163], v[72:75]
    v_exp_f32 v54, v54
    ds_read_b128 a[216:219], v1 offset:12288
    v_mfma_f32_16x16x32_bf16 v[72:75], a[232:235], a[164:167], v[72:75]
    s_nop 7
    v_max3_f32 v96, v96, v71, v72
    v_max3_f32 v96, v96, v73, v74
    v_max_f32 v96, v96, v75
    v_exp_f32 v53, v53
    ds_read_b128 a[228:231], v0 offset:14336
    v_mov_b32 v97, v96
    s_nop 1
    v_permlane32_swap_b32 v97, v96
    v_max_f32 v96, v96, v97
    v_mov_b32 v97, v96
    s_nop 1
    v_permlane16_swap_b32 v97, v96
    v_fma_f32 v63, v63, s28, v10
    v_max_f32 v96, v96, v97
    v_mul_f32_e64 v11, -s28, v96
    v_fma_f32 v69, v69, s28, v11
    v_fma_f32 v68, v68, s28, v11
    v_fma_f32 v72, v72, s28, v11
    v_fma_f32 v75, v75, s28, v11
    v_fma_f32 v74, v74, s28, v11
    v_exp_f32 v75, v75
    v_exp_f32 v63, v63
    v_fma_f32 v71, v71, s28, v11
    v_exp_f32 v69, v69
    v_fma_f32 v70, v70, s28, v11
    v_exp_f32 v70, v70
    v_exp_f32 v68, v68
    v_mfma_f32_16x16x32_bf16 v[44:47], a[240:243], v[20:23], v[44:47]
    v_exp_f32 v74, v74
    v_cvt_pk_bf16_f32 v26, v68, v69
    v_fma_f32 v73, v73, s28, v11
    v_exp_f32 v73, v73
    v_exp_f32 v71, v71
    s_waitcnt vmcnt(9)
    s_add_u32 m0, s22, 36864
    ds_read_b128 a[232:235], v1 offset:14336
    buffer_load_dwordx4 v6, s[8:11], s21 offen lds
    s_add_u32 s21, s21, 128
    s_add_u32 m0, s22, 37888
    v_cvt_pk_bf16_f32 v27, v70, v71
    v_mfma_f32_16x16x32_bf16 v[68:71], a[212:215], a[144:147], 0
    buffer_load_dwordx4 v6, s[8:11], s21 offen lds
    ds_read_b128 a[212:215], v0 offset:18432
    s_add_u32 s21, s21, 128
    s_waitcnt lgkmcnt(2)
    v_mfma_f32_16x16x32_bf16 v[68:71], a[216:219], a[148:151], v[68:71]
    s_add_u32 m0, s22, 38912
    s_nop 0
    buffer_load_dwordx4 v6, s[8:11], s21 offen lds
    ds_read_b128 a[184:187], v104 offset:22528
    v_mfma_f32_16x16x32_bf16 v[68:71], a[220:223], a[152:155], v[68:71]
    v_fma_f32 v61, v61, s28, v10
    ds_read_b128 a[172:175], v105 offset:18432
    v_exp_f32 v72, v72
    v_mfma_f32_16x16x32_bf16 v[68:71], a[224:227], a[156:159], v[68:71]
    v_cvt_pk_bf16_f32 v29, v74, v75
    ds_read_b128 a[176:179], v104 offset:20480
    s_add_u32 s21, s21, 12032
    v_mfma_f32_16x16x32_bf16 v[68:71], a[228:231], a[160:163], v[68:71]
    v_cvt_pk_bf16_f32 v28, v72, v73
    ds_read_b128 a[180:183], v105 offset:20480
    ds_read_b128 a[168:171], v104 offset:18432
    s_waitcnt lgkmcnt(6)
    v_mfma_f32_16x16x32_bf16 v[68:71], a[232:235], a[164:167], v[68:71]
    ds_read_b128 a[216:219], v1 offset:18432
    s_waitcnt lgkmcnt(6)
    v_mfma_f32_16x16x32_bf16 v[72:75], a[212:215], a[144:147], 0
    ds_read_b128 a[220:223], v0 offset:19456
    ds_read_b128 a[228:231], v0 offset:20480
    v_mfma_f32_16x16x32_bf16 v[44:47], a[244:247], v[26:29], v[44:47]
    ds_read_b128 a[224:227], v1 offset:19456
    ds_read_b128 a[232:235], v1 offset:20480
    s_waitcnt lgkmcnt(4)
    v_mfma_f32_16x16x32_bf16 v[72:75], a[216:219], a[148:151], v[72:75]
    ds_read_b128 a[216:219], v1 offset:0
    v_fma_f32 v62, v62, s28, v10
    s_waitcnt lgkmcnt(4)
    v_mfma_f32_16x16x32_bf16 v[72:75], a[220:223], a[152:155], v[72:75]
    ds_read_b128 a[212:215], v0 offset:0
    s_waitcnt lgkmcnt(3)
    v_mfma_f32_16x16x32_bf16 v[72:75], a[224:227], a[156:159], v[72:75]
    ds_read_b128 a[220:223], v0 offset:1024
    v_mfma_f32_16x16x32_bf16 v[72:75], a[228:231], a[160:163], v[72:75]
    s_waitcnt lgkmcnt(3)
    ds_read_b128 a[224:227], v1 offset:1024
    v_mfma_f32_16x16x32_bf16 v[72:75], a[232:235], a[164:167], v[72:75]
    ds_read_b128 a[188:191], v105 offset:22528
    s_waitcnt lgkmcnt(3)
    v_mfma_f32_16x16x32_bf16 v[76:79], a[212:215], a[168:171], 0
    ds_read_b128 a[228:231], v0 offset:2048
    v_mfma_f32_16x16x32_bf16 v[76:79], a[216:219], a[172:175], v[76:79]
    s_waitcnt lgkmcnt(3)
    ds_read_b128 a[232:235], v1 offset:2048
    v_mfma_f32_16x16x32_bf16 v[76:79], a[220:223], a[176:179], v[76:79]
    s_waitcnt lgkmcnt(3)
    ds_read_b128 a[216:219], v1 offset:6144
    v_exp_f32 v52, v52
    v_mfma_f32_16x16x32_bf16 v[76:79], a[224:227], a[180:183], v[76:79]
    ds_read_b128 a[212:215], v0 offset:6144
    s_waitcnt lgkmcnt(3)
    v_mfma_f32_16x16x32_bf16 v[76:79], a[228:231], a[184:187], v[76:79]
    ds_read_b128 a[220:223], v0 offset:7168
    v_exp_f32 v55, v55
    s_waitcnt lgkmcnt(3)
    v_mfma_f32_16x16x32_bf16 v[76:79], a[232:235], a[188:191], v[76:79]
    ds_read_b128 a[228:231], v0 offset:8192
    s_waitcnt lgkmcnt(2)
    v_mfma_f32_16x16x32_bf16 v[80:83], a[212:215], a[168:171], 0
    ds_read_b128 a[224:227], v1 offset:7168
    v_mfma_f32_16x16x32_bf16 v[80:83], a[216:219], a[172:175], v[80:83]
    ds_read_b128 a[232:235], v1 offset:8192
    s_waitcnt lgkmcnt(3)
    v_mfma_f32_16x16x32_bf16 v[80:83], a[220:223], a[176:179], v[80:83]
    ds_read_b128 a[220:223], v0 offset:13312
    v_max3_f32 v98, v76, v77, v78
    s_waitcnt lgkmcnt(2)
    v_mfma_f32_16x16x32_bf16 v[80:83], a[224:227], a[180:183], v[80:83]
    ds_read_b128 a[212:215], v0 offset:12288
    v_mfma_f32_16x16x32_bf16 v[80:83], a[228:231], a[184:187], v[80:83]
    s_waitcnt lgkmcnt(2)
    ds_read_b128 a[216:219], v1 offset:12288
    v_mfma_f32_16x16x32_bf16 v[80:83], a[232:235], a[188:191], v[80:83]
    s_nop 7
    v_max3_f32 v98, v98, v79, v80
    v_max3_f32 v98, v98, v81, v82
    v_max_f32 v98, v98, v83
    v_mov_b32 v99, v98
    s_nop 1
    v_permlane32_swap_b32 v99, v98
    v_max_f32 v98, v98, v99
    v_mov_b32 v99, v98
    s_nop 1
    v_permlane16_swap_b32 v99, v98
    ds_read_b128 a[224:227], v1 offset:13312
    v_max_f32 v98, v98, v99
    v_mul_f32_e64 v12, -s28, v98
    v_fma_f32 v78, v78, s28, v12
    ds_read_b128 a[232:235], v1 offset:14336
    v_fma_f32 v80, v80, s28, v12
    v_fma_f32 v76, v76, s28, v12
    v_exp_f32 v60, v60
    v_exp_f32 v62, v62
    v_fma_f32 v77, v77, s28, v12
    v_fma_f32 v79, v79, s28, v12
    v_exp_f32 v79, v79
    v_exp_f32 v78, v78
    v_fma_f32 v82, v82, s28, v12
    v_exp_f32 v77, v77
    v_fma_f32 v81, v81, s28, v12
    v_fma_f32 v83, v83, s28, v12
    v_exp_f32 v76, v76
    s_nop 0
    v_cvt_pk_bf16_f32 v32, v76, v77
    v_cvt_pk_bf16_f32 v33, v78, v79
    v_exp_f32 v80, v80
    s_waitcnt lgkmcnt(2)
    v_mfma_f32_16x16x32_bf16 v[76:79], a[212:215], a[168:171], 0
    ds_read_b128 a[228:231], v0 offset:14336
    v_exp_f32 v83, v83
    v_cvt_pk_bf16_f32 v19, v54, v55
    v_mfma_f32_16x16x32_bf16 v[76:79], a[216:219], a[172:175], v[76:79]
    ds_read_b128 a[212:215], v0 offset:18432
    v_mfma_f32_16x16x32_bf16 v[76:79], a[220:223], a[176:179], v[76:79]
    s_waitcnt lgkmcnt(3)
    v_exp_f32 v61, v61
    ds_read_b128 a[216:219], v1 offset:18432
    v_mfma_f32_16x16x32_bf16 v[76:79], a[224:227], a[180:183], v[76:79]
    ds_read_b128 a[220:223], v0 offset:19456
    v_exp_f32 v81, v81
    v_exp_f32 v82, v82
    s_waitcnt lgkmcnt(3)
    v_mfma_f32_16x16x32_bf16 v[76:79], a[228:231], a[184:187], v[76:79]
    v_cvt_pk_bf16_f32 v18, v52, v53
    v_cvt_pk_bf16_f32 v34, v80, v81
    v_cvt_pk_bf16_f32 v25, v62, v63
    ds_read_b128 a[224:227], v1 offset:19456
    v_mfma_f32_16x16x32_bf16 v[76:79], a[232:235], a[188:191], v[76:79]
    s_waitcnt lgkmcnt(3)
    ds_read_b128 a[228:231], v0 offset:20480
    v_cvt_pk_bf16_f32 v35, v82, v83
    v_mfma_f32_16x16x32_bf16 v[80:83], a[212:215], a[168:171], 0
    s_waitcnt lgkmcnt(3)
    ds_read_b128 a[232:235], v1 offset:20480
    v_mfma_f32_16x16x32_bf16 v[80:83], a[216:219], a[172:175], v[80:83]
    s_waitcnt lgkmcnt(3)
    ds_read_b128 a[216:219], v1 offset:0
    v_mfma_f32_16x16x32_bf16 v[80:83], a[220:223], a[176:179], v[80:83]
    ds_read_b128 a[212:215], v0 offset:0
    s_waitcnt vmcnt(6)
    ds_read_b128 a[192:195], v104 offset:24576
    ds_read_b128 a[200:203], v104 offset:26624
    ds_read_b128 a[196:199], v105 offset:24576
    s_waitcnt lgkmcnt(6)
    v_mfma_f32_16x16x32_bf16 v[80:83], a[224:227], a[180:183], v[80:83]
    ds_read_b128 a[220:223], v0 offset:1024
    v_mfma_f32_16x16x32_bf16 v[80:83], a[228:231], a[184:187], v[80:83]
    s_waitcnt lgkmcnt(6)
    ds_read_b128 a[204:207], v105 offset:26624
    ds_read_b128 a[224:227], v1 offset:1024
    v_mfma_f32_16x16x32_bf16 v[80:83], a[232:235], a[188:191], v[80:83]
    ds_read_b128 a[228:231], v0 offset:2048
    ds_read_b128 a[232:235], v1 offset:2048
    s_waitcnt lgkmcnt(7)
    v_mfma_f32_16x16x32_bf16 v[84:87], a[212:215], a[192:195], 0
    s_waitcnt lgkmcnt(5)
    ds_read_b128 a[212:215], v0 offset:6144
    v_mfma_f32_16x16x32_bf16 v[84:87], a[216:219], a[196:199], v[84:87]
    s_waitcnt lgkmcnt(5)
    ds_read_b128 a[216:219], v1 offset:6144
    v_mfma_f32_16x16x32_bf16 v[84:87], a[220:223], a[200:203], v[84:87]
    ds_read_b128 a[220:223], v0 offset:7168
    s_waitcnt lgkmcnt(5)
    v_mfma_f32_16x16x32_bf16 v[84:87], a[224:227], a[204:207], v[84:87]
    s_waitcnt lgkmcnt(4)
    ds_read_b128 a[224:227], v1 offset:7168
    v_mfma_f32_16x16x32_bf16 v[84:87], a[228:231], a[208:211], v[84:87]
    s_waitcnt lgkmcnt(4)
    ds_read_b128 a[228:231], v0 offset:8192
    v_mfma_f32_16x16x32_bf16 v[84:87], a[232:235], v[92:95], v[84:87]
    ds_read_b128 a[232:235], v1 offset:8192
    s_waitcnt lgkmcnt(5)
    v_mfma_f32_16x16x32_bf16 v[88:91], a[212:215], a[192:195], 0
    s_waitcnt lgkmcnt(4)
    v_mfma_f32_16x16x32_bf16 v[88:91], a[216:219], a[196:199], v[88:91]
    s_waitcnt lgkmcnt(3)
    v_mfma_f32_16x16x32_bf16 v[88:91], a[220:223], a[200:203], v[88:91]
    s_waitcnt lgkmcnt(2)
    v_mfma_f32_16x16x32_bf16 v[88:91], a[224:227], a[204:207], v[88:91]
    s_waitcnt lgkmcnt(1)
    v_mfma_f32_16x16x32_bf16 v[88:91], a[228:231], a[208:211], v[88:91]
    v_max3_f32 v96, v84, v85, v86
    s_waitcnt vmcnt(63) lgkmcnt(0)
    s_barrier
    s_add_u32 m0, s22, 0
    ds_read_b128 a[216:219], v1 offset:12288
    buffer_load_dwordx4 v6, s[4:7], s20 offen lds
    v_mfma_f32_16x16x32_bf16 v[88:91], a[232:235], v[92:95], v[88:91]
    s_add_u32 s20, s20, 128
    s_add_u32 m0, s22, 1024
    ds_read_b128 a[212:215], v0 offset:12288
    buffer_load_dwordx4 v6, s[4:7], s20 offen lds
    s_add_u32 s20, s20, 128
    v_mfma_f32_16x16x32_bf16 v[44:47], a[248:251], v[32:35], v[44:47]
    s_add_u32 m0, s22, 2048
    ds_read_b128 a[224:227], v1 offset:13312
    buffer_load_dwordx4 v6, s[4:7], s20 offen lds
    ds_read_b128 a[228:231], v0 offset:14336
    ds_read_b128 a[232:235], v1 offset:14336
    ds_read_b128 a[220:223], v0 offset:13312
    s_add_u32 s20, s20, 12032
    v_max3_f32 v96, v96, v87, v88
    v_max3_f32 v96, v96, v89, v90
    v_max_f32 v96, v96, v91
    v_mov_b32 v97, v96
    s_mov_b32 s39, s64
    s_add_u32 s37, s37, 1
    v_permlane32_swap_b32 v97, v96
    v_max_f32 v96, v96, v97
    v_mov_b32 v97, v96
    s_bitcmp1_b32 s63, s37
    s_cselect_b32 s62, 4294770688, 0
    v_permlane16_swap_b32 v97, v96
    v_max_f32 v96, v96, v97
    s_cselect_b32 s42, 0, 325632
    v_mul_f32_e64 v13, -s28, v96
    v_fma_f32 v85, v85, s28, v13
    v_fma_f32 v87, v87, s28, v13
    v_fma_f32 v84, v84, s28, v13
    s_add_u32 s35, s35, s42
    v_exp_f32 v87, v87
    v_exp_f32 v84, v84
    v_fma_f32 v86, v86, s28, v13
    v_exp_f32 v85, v85
    v_exp_f32 v86, v86
    v_cvt_pk_bf16_f32 v38, v84, v85
    v_cvt_pk_bf16_f32 v39, v86, v87
    s_waitcnt lgkmcnt(3)
    v_mfma_f32_16x16x32_bf16 v[84:87], a[212:215], a[192:195], 0
    s_lshl_b32 s42, s37, 1
    ds_read_b128 a[212:215], v0 offset:18432
    s_lshr_b32 s42, s31, s42
    v_mfma_f32_16x16x32_bf16 v[84:87], a[216:219], a[196:199], v[84:87]
    s_waitcnt lgkmcnt(1)
    ds_read_b128 a[216:219], v1 offset:18432
    s_and_b32 s42, s42, 3
    v_mfma_f32_16x16x32_bf16 v[84:87], a[220:223], a[200:203], v[84:87]
    s_add_u32 s42, s42, s36
    ds_read_b128 a[220:223], v0 offset:19456
    s_sub_u32 s43, s42, 3
    v_mfma_f32_16x16x32_bf16 v[84:87], a[224:227], a[204:207], v[84:87]
    s_cmp_ge_u32 s42, 3
    ds_read_b128 a[224:227], v1 offset:19456
    s_cselect_b32 s42, s43, s42
    v_mfma_f32_16x16x32_bf16 v[84:87], a[228:231], a[208:211], v[84:87]
    s_mul_i32 s44, s3, 5
    s_mov_b32 s32, 1
    ds_read_b128 a[228:231], v0 offset:20480
    v_mfma_f32_16x16x32_bf16 v[84:87], a[232:235], v[92:95], v[84:87]
    s_lshl_b32 s43, s3, 2
    ds_read_b128 a[232:235], v1 offset:20480
    s_add_u32 s45, s43, 21
    v_fma_f32 v91, v91, s28, v13
    s_cmp_eq_u32 s3, 0
    v_fma_f32 v88, v88, s28, v13
    s_cselect_b32 s45, 20, s45
    v_fma_f32 v90, v90, s28, v13
    s_cselect_b32 s33, 1, 0
    s_cmp_eq_u32 s42, 1
    s_cselect_b32 s44, s45, s44
    s_cselect_b32 s32, s33, s32
    v_fma_f32 v89, v89, s28, v13
    s_add_u32 s45, s43, 37
    v_exp_f32 v88, v88
    v_exp_f32 v90, v90
    s_cmp_eq_u32 s42, 2
    s_cselect_b32 s44, s45, s44
    s_cselect_b32 s32, 0, s32
    s_mul_i32 s44, s44, 6144
    s_add_u32 s33, s35, s44
    s_mul_i32 s42, s32, 6144
    s_add_u32 s42, s42, 24576
    v_exp_f32 v89, v89
    s_add_u32 s42, s42, s33
    v_exp_f32 v91, v91
    s_cmp_ge_u32 s37, 6
    s_cselect_b32 s14, 0, s42
    v_cvt_pk_bf16_f32 v40, v88, v89
    s_add_u32 s24, s67, 256
    v_cvt_pk_bf16_f32 v41, v90, v91
    s_add_u32 s25, s33, 256
    s_add_u32 s23, s38, 4096
    s_mov_b32 s27, 0x249
    s_mov_b32 s30, 0
    s_waitcnt vmcnt(6) lgkmcnt(0)
    v_mfma_f32_16x16x32_bf16 v[88:91], a[212:215], a[192:195], 0
    s_barrier
    ds_read_b64_tr_b16 a[212:213], v2 offset:0
    ds_read_b64_tr_b16 a[214:215], v2 offset:6144
    v_mfma_f32_16x16x32_bf16 v[88:91], a[216:219], a[196:199], v[88:91]
    ds_read_b64_tr_b16 a[216:217], v3 offset:0
    ds_read_b64_tr_b16 a[218:219], v3 offset:6144
    s_add_u32 m0, s22, 12288
    s_nop 0
    buffer_load_dwordx4 v6, s[4:7], s20 offen lds
    s_add_u32 s20, s20, 128
    v_mfma_f32_16x16x32_bf16 v[88:91], a[220:223], a[200:203], v[88:91]
    s_add_u32 m0, s22, 13312
    s_nop 0
    buffer_load_dwordx4 v6, s[4:7], s20 offen lds
    s_add_u32 s20, s20, 128
    ds_read_b64_tr_b16 a[220:221], v4 offset:0
    v_mfma_f32_16x16x32_bf16 v[88:91], a[224:227], a[204:207], v[88:91]
    ds_read_b64_tr_b16 a[222:223], v4 offset:6144
    s_add_u32 m0, s22, 14336
    s_nop 0
    buffer_load_dwordx4 v6, s[4:7], s20 offen lds
    v_mfma_f32_16x16x32_bf16 v[44:47], a[252:255], v[38:41], v[44:47]
    ds_read_b64_tr_b16 a[224:225], v5 offset:0
    v_cvt_pk_bf16_f32 v24, v60, v61
    v_mfma_f32_16x16x32_bf16 v[88:91], a[228:231], a[208:211], v[88:91]
    s_add_u32 s20, s20, 12032
    ds_read_b64_tr_b16 a[226:227], v5 offset:6144
    v_mfma_f32_16x16x32_bf16 v[88:91], a[232:235], v[92:95], v[88:91]
    s_waitcnt lgkmcnt(4)
    v_mfma_f32_16x16x32_bf16 v[112:115], a[212:215], v[14:17], 0
    ds_read_b64_tr_b16 a[228:229], v2 offset:1024
    v_fma_f32 v70, v70, s28, v11
    v_mfma_f32_16x16x32_bf16 v[116:119], a[216:219], v[14:17], 0
    v_fma_f32 v59, v59, s28, v9
    v_fma_f32 v69, v69, s28, v11
    v_mfma_f32_16x16x32_bf16 v[164:167], a[216:219], v[20:23], 0
    v_fma_f32 v78, v78, s28, v12
    v_mfma_f32_16x16x32_bf16 v[160:163], a[212:215], v[20:23], 0
    v_exp_f32 v78, v78
    v_mfma_f32_16x16x32_bf16 v[208:211], a[212:215], v[26:29], 0
    ds_read_b64_tr_b16 a[232:233], v3 offset:1024
    v_mfma_f32_16x16x32_bf16 v[212:215], a[216:219], v[26:29], 0
    ds_read_b64_tr_b16 a[230:231], v2 offset:7168
    v_fma_f32 v79, v79, s28, v12
    v_mfma_f32_16x16x32_bf16 a[4:7], a[216:219], v[32:35], 0
    ds_read_b64_tr_b16 a[234:235], v3 offset:7168
    v_fma_f32 v56, v56, s28, v9
    v_mfma_f32_16x16x32_bf16 a[0:3], a[212:215], v[32:35], 0
    v_fma_f32 v67, v67, s28, v10
    v_fma_f32 v58, v58, s28, v9
    v_mfma_f32_16x16x32_bf16 a[48:51], a[212:215], v[38:41], 0
    v_fma_f32 v80, v80, s28, v12
    v_fma_f32 v81, v81, s28, v12
    v_mfma_f32_16x16x32_bf16 a[52:55], a[216:219], v[38:41], 0
    s_waitcnt lgkmcnt(4)
    v_fma_f32 v65, v65, s28, v10
    v_mfma_f32_16x16x32_bf16 a[56:59], a[220:223], v[38:41], 0
    v_fma_f32 v77, v77, s28, v12
    v_fma_f32 v68, v68, s28, v11
    v_mfma_f32_16x16x32_bf16 a[60:63], a[224:227], v[38:41], 0
    ds_read_b64_tr_b16 a[214:215], v4 offset:7168
    v_fma_f32 v89, v89, s28, v13
    v_mfma_f32_16x16x32_bf16 a[12:15], a[224:227], v[32:35], 0
    ds_read_b64_tr_b16 a[216:217], v5 offset:1024
    v_mfma_f32_16x16x32_bf16 a[8:11], a[220:223], v[32:35], 0
    v_exp_f32 v69, v69
    v_mfma_f32_16x16x32_bf16 v[216:219], a[220:223], v[26:29], 0
    v_fma_f32 v87, v87, s28, v13
    v_fma_f32 v86, v86, s28, v13
    v_mfma_f32_16x16x32_bf16 v[220:223], a[224:227], v[26:29], 0
    v_fma_f32 v84, v84, s28, v13
    v_fma_f32 v90, v90, s28, v13
    v_mfma_f32_16x16x32_bf16 v[172:175], a[224:227], v[20:23], 0
    v_mfma_f32_16x16x32_bf16 v[168:171], a[220:223], v[20:23], 0
    ds_read_b64_tr_b16 a[218:219], v5 offset:7168
    v_mfma_f32_16x16x32_bf16 v[120:123], a[220:223], v[14:17], 0
    v_exp_f32 v86, v86
    v_mfma_f32_16x16x32_bf16 v[124:127], a[224:227], v[14:17], 0
    s_waitcnt lgkmcnt(3)
    ds_read_b64_tr_b16 a[212:213], v4 offset:1024
    v_fma_f32 v71, v71, s28, v11
    v_mfma_f32_16x16x32_bf16 v[128:131], a[228:231], v[14:17], 0
    ds_read_b64_tr_b16 a[224:225], v3 offset:2048
    v_mfma_f32_16x16x32_bf16 v[132:135], a[232:235], v[14:17], 0
    v_fma_f32 v88, v88, s28, v13
    v_fma_f32 v73, v73, s28, v11
    v_mfma_f32_16x16x32_bf16 v[180:183], a[232:235], v[20:23], 0
    ds_read_b64_tr_b16 a[222:223], v2 offset:8192
    v_fma_f32 v74, v74, s28, v11
    v_mfma_f32_16x16x32_bf16 v[176:179], a[228:231], v[20:23], 0
    v_exp_f32 v77, v77
    v_mfma_f32_16x16x32_bf16 v[224:227], a[228:231], v[26:29], 0
    v_exp_f32 v89, v89
    v_mfma_f32_16x16x32_bf16 v[228:231], a[232:235], v[26:29], 0
    v_exp_f32 v84, v84
    v_mfma_f32_16x16x32_bf16 a[20:23], a[232:235], v[32:35], 0
    v_exp_f32 v67, v67
    v_mfma_f32_16x16x32_bf16 a[16:19], a[228:231], v[32:35], 0
    ds_read_b64_tr_b16 a[220:221], v2 offset:2048
    v_mfma_f32_16x16x32_bf16 a[64:67], a[228:231], v[38:41], 0
    s_add_u32 s39, s39, 12288
    v_exp_f32 v88, v88
    v_mfma_f32_16x16x32_bf16 a[68:71], a[232:235], v[38:41], 0
    s_waitcnt lgkmcnt(3)
    ds_read_b64_tr_b16 a[232:233], v5 offset:2048
    v_fma_f32 v72, v72, s28, v11
    v_mfma_f32_16x16x32_bf16 a[72:75], a[212:215], v[38:41], 0
    ds_read_b64_tr_b16 a[226:227], v3 offset:8192
    v_fma_f32 v75, v75, s28, v11
    v_mfma_f32_16x16x32_bf16 a[76:79], a[216:219], v[38:41], 0
    v_fma_f32 v83, v83, s28, v12
    v_mfma_f32_16x16x32_bf16 a[28:31], a[216:219], v[32:35], 0
    ds_read_b64_tr_b16 a[228:229], v4 offset:2048
    v_fma_f32 v76, v76, s28, v12
    v_mfma_f32_16x16x32_bf16 a[24:27], a[212:215], v[32:35], 0
    v_exp_f32 v76, v76
    v_mfma_f32_16x16x32_bf16 v[232:235], a[212:215], v[26:29], 0
    ds_read_b64_tr_b16 a[230:231], v4 offset:8192
    v_mfma_f32_16x16x32_bf16 v[236:239], a[216:219], v[26:29], 0
    ds_read_b64_tr_b16 a[234:235], v5 offset:8192
    v_add_u32 v103, 4096, v103
    v_mfma_f32_16x16x32_bf16 v[188:191], a[216:219], v[20:23], 0
    v_exp_f32 v79, v79
    v_mfma_f32_16x16x32_bf16 v[184:187], a[212:215], v[20:23], 0
    v_fma_f32 v57, v57, s28, v9
    v_mfma_f32_16x16x32_bf16 v[136:139], a[212:215], v[14:17], 0
    v_exp_f32 v73, v73
    v_mfma_f32_16x16x32_bf16 v[140:143], a[216:219], v[14:17], 0
    s_waitcnt lgkmcnt(4)
    v_exp_f32 v72, v72
    v_mfma_f32_16x16x32_bf16 v[144:147], a[220:223], v[14:17], 0
    s_waitcnt lgkmcnt(3)
    v_exp_f32 v83, v83
    v_mfma_f32_16x16x32_bf16 v[148:151], a[224:227], v[14:17], 0
    v_exp_f32 v57, v57
    v_mfma_f32_16x16x32_bf16 v[196:199], a[224:227], v[20:23], 0
    v_exp_f32 v68, v68
    v_mfma_f32_16x16x32_bf16 v[192:195], a[220:223], v[20:23], 0
    v_exp_f32 v70, v70
    v_mfma_f32_16x16x32_bf16 v[240:243], a[220:223], v[26:29], 0
    v_exp_f32 v58, v58
    v_mfma_f32_16x16x32_bf16 v[244:247], a[224:227], v[26:29], 0
    v_exp_f32 v71, v71
    v_mfma_f32_16x16x32_bf16 a[36:39], a[224:227], v[32:35], 0
    v_cvt_pk_bf16_f32 v30, v68, v69
    v_fma_f32 v85, v85, s28, v13
    v_mfma_f32_16x16x32_bf16 a[32:35], a[220:223], v[32:35], 0
    v_exp_f32 v56, v56
    v_mfma_f32_16x16x32_bf16 a[80:83], a[220:223], v[38:41], 0
    s_waitcnt vmcnt(3) lgkmcnt(0)
    v_exp_f32 v74, v74
    v_mfma_f32_16x16x32_bf16 a[84:87], a[224:227], v[38:41], 0
    s_barrier
    ds_read_b128 a[212:215], v0 offset:0
    v_mfma_f32_16x16x32_bf16 a[88:91], a[228:231], v[38:41], 0
    ds_read_b128 a[216:219], v1 offset:0
    v_cvt_pk_bf16_f32 v31, v70, v71
    v_mfma_f32_16x16x32_bf16 a[92:95], a[232:235], v[38:41], 0
    ds_read_b128 a[220:223], v0 offset:1024
    s_add_u32 m0, s22, 24576
    v_mfma_f32_16x16x32_bf16 a[44:47], a[232:235], v[32:35], 0
    buffer_load_dwordx4 v6, s[8:11], s21 offen lds
    v_mfma_f32_16x16x32_bf16 a[40:43], a[228:231], v[32:35], 0
    v_exp_f32 v59, v59
    v_mfma_f32_16x16x32_bf16 v[248:251], a[228:231], v[26:29], 0
    s_add_u32 s21, s21, 128
    s_add_u32 m0, s22, 25600
    ds_read_b128 a[224:227], v1 offset:1024
    v_mfma_f32_16x16x32_bf16 v[252:255], a[232:235], v[26:29], 0
    buffer_load_dwordx4 v6, s[8:11], s21 offen lds
    v_mfma_f32_16x16x32_bf16 v[204:207], a[232:235], v[20:23], 0
    s_add_u32 s21, s21, 128
    v_fma_f32 v82, v82, s28, v12
    s_add_u32 m0, s22, 26624
    v_mfma_f32_16x16x32_bf16 v[200:203], a[228:231], v[20:23], 0
    v_exp_f32 v87, v87
    v_mfma_f32_16x16x32_bf16 v[152:155], a[228:231], v[14:17], 0
    buffer_load_dwordx4 v6, s[8:11], s21 offen lds
    v_mfma_f32_16x16x32_bf16 v[156:159], a[232:235], v[14:17], 0
    s_waitcnt lgkmcnt(3)
    ds_read_b128 a[232:235], v1 offset:2048
    v_mfma_f32_16x16x32_bf16 v[52:55], a[212:215], a[96:99], 0
    s_waitcnt lgkmcnt(3)
    v_fma_f32 v64, v64, s28, v10
    v_fma_f32 v91, v91, s28, v13
    v_mfma_f32_16x16x32_bf16 v[52:55], a[216:219], a[100:103], v[52:55]
    s_waitcnt lgkmcnt(2)
    v_cvt_pk_bf16_f32 v16, v56, v57
    v_cvt_pk_bf16_f32 v36, v76, v77
    v_mfma_f32_16x16x32_bf16 v[52:55], a[220:223], a[104:107], v[52:55]
    ds_read_b128 a[228:231], v0 offset:2048
    v_mfma_f32_16x16x32_bf16 v[60:63], a[220:223], a[128:131], 0
    v_cvt_pk_bf16_f32 v37, v78, v79
    v_cvt_pk_bf16_f32 v43, v86, v87
    v_mfma_f32_16x16x32_bf16 v[60:63], a[216:219], a[124:127], v[60:63]
    v_exp_f32 v85, v85
    v_mfma_f32_16x16x32_bf16 v[60:63], a[212:215], a[120:123], v[60:63]
    v_exp_f32 v81, v81
    v_mfma_f32_16x16x32_bf16 v[68:71], a[212:215], a[144:147], 0
    v_mfma_f32_16x16x32_bf16 v[68:71], a[216:219], a[148:151], v[68:71]
    v_cvt_pk_bf16_f32 v42, v84, v85
    v_mfma_f32_16x16x32_bf16 v[68:71], a[220:223], a[152:155], v[68:71]
    s_add_u32 s21, s21, 12032
    v_exp_f32 v91, v91
    v_mfma_f32_16x16x32_bf16 v[76:79], a[220:223], a[176:179], 0
    v_exp_f32 v80, v80
    v_mfma_f32_16x16x32_bf16 v[76:79], a[216:219], a[172:175], v[76:79]
    v_cvt_pk_bf16_f32 v28, v72, v73
    v_mfma_f32_16x16x32_bf16 v[76:79], a[212:215], a[168:171], v[76:79]
    v_exp_f32 v82, v82
    v_mfma_f32_16x16x32_bf16 v[84:87], a[212:215], a[192:195], 0
    v_cvt_pk_bf16_f32 v17, v58, v59
    v_mfma_f32_16x16x32_bf16 v[84:87], a[216:219], a[196:199], v[84:87]
    s_add_u32 m0, s38, 0
    ds_read_b128 a[212:215], v0 offset:6144
    v_mfma_f32_16x16x32_bf16 v[84:87], a[220:223], a[200:203], v[84:87]
    s_waitcnt lgkmcnt(1)
    v_mfma_f32_16x16x32_bf16 v[84:87], a[224:227], a[204:207], v[84:87]
    v_exp_f32 v90, v90
    v_mfma_f32_16x16x32_bf16 v[48:51], a[236:239], v[16:19], v[44:47]
    buffer_load_dwordx4 v6, s[12:15], s33 offen nt lds
    v_mfma_f32_16x16x32_bf16 v[84:87], a[228:231], a[208:211], v[84:87]
    v_exp_f32 v65, v65
    v_mfma_f32_16x16x32_bf16 v[84:87], a[232:235], v[92:95], v[84:87]
    v_mfma_f32_16x16x32_bf16 v[76:79], a[232:235], a[188:191], v[76:79]
    v_exp_f32 v75, v75
    v_mfma_f32_16x16x32_bf16 v[76:79], a[228:231], a[184:187], v[76:79]
    ds_read_b128 a[220:223], v0 offset:7168
    v_cvt_pk_bf16_f32 v41, v90, v91
    v_mfma_f32_16x16x32_bf16 v[76:79], a[224:227], a[180:183], v[76:79]
    ds_read_b128 a[216:219], v1 offset:6144
    v_fma_f32 v66, v66, s28, v10
    v_mfma_f32_16x16x32_bf16 v[68:71], a[224:227], a[156:159], v[68:71]
    v_exp_f32 v64, v64
    v_mfma_f32_16x16x32_bf16 v[68:71], a[228:231], a[160:163], v[68:71]
    v_mfma_f32_16x16x32_bf16 v[68:71], a[232:235], a[164:167], v[68:71]
    v_exp_f32 v66, v66
    v_mfma_f32_16x16x32_bf16 v[60:63], a[232:235], a[140:143], v[60:63]
    v_mfma_f32_16x16x32_bf16 v[60:63], a[228:231], a[136:139], v[60:63]
    v_cvt_pk_bf16_f32 v35, v82, v83
    v_cvt_pk_bf16_f32 v34, v80, v81
    v_mfma_f32_16x16x32_bf16 v[60:63], a[224:227], a[132:135], v[60:63]
    v_cvt_pk_bf16_f32 v29, v74, v75
    v_mfma_f32_16x16x32_bf16 v[52:55], a[224:227], a[108:111], v[52:55]
    v_cvt_pk_bf16_f32 v22, v64, v65
    v_mfma_f32_16x16x32_bf16 v[52:55], a[228:231], a[112:115], v[52:55]
    ds_read_b128 a[228:231], v0 offset:8192
    v_cvt_pk_bf16_f32 v23, v66, v67
    v_mfma_f32_16x16x32_bf16 v[52:55], a[232:235], a[116:119], v[52:55]
    ds_read_b128 a[232:235], v1 offset:8192
    v_cvt_pk_bf16_f32 v40, v88, v89
    v_mfma_f32_16x16x32_bf16 v[48:51], a[240:243], v[22:25], v[48:51]
    s_add_u32 m0, s38, 1024
    ds_read_b128 a[224:227], v1 offset:7168
    v_mfma_f32_16x16x32_bf16 v[48:51], a[244:247], v[28:31], v[48:51]
    buffer_load_dwordx4 v7, s[12:15], s33 offen nt lds
    v_mfma_f32_16x16x32_bf16 v[48:51], a[248:251], v[34:37], v[48:51]
    v_mfma_f32_16x16x32_bf16 v[48:51], a[252:255], v[40:43], v[48:51]
    s_add_u32 s59, s33, 128
    s_add_u32 m0, s38, 2048
    s_waitcnt lgkmcnt(3)
    v_mfma_f32_16x16x32_bf16 v[56:59], a[212:215], a[96:99], 0
    buffer_load_dwordx4 v6, s[12:15], s59 offen nt lds
    v_mfma_f32_16x16x32_bf16 v[56:59], a[216:219], a[100:103], v[56:59]
    s_add_u32 m0, s38, 3072
    s_nop 0
    v_cmp_lt_f32 vcc, s29, v48
    v_mfma_f32_16x16x32_bf16 v[56:59], a[220:223], a[104:107], v[56:59]
    v_mfma_f32_16x16x32_bf16 v[64:67], a[220:223], a[128:131], 0
    v_mfma_f32_16x16x32_bf16 v[64:67], a[216:219], a[124:127], v[64:67]
    buffer_load_dwordx4 v7, s[12:15], s59 offen nt lds
    v_mfma_f32_16x16x32_bf16 v[64:67], a[212:215], a[120:123], v[64:67]
    s_cbranch_vccnz L_rs_start5b
L_ret_start5b:
    v_fma_f32 v61, v61, s28, v10
    v_mfma_f32_16x16x32_bf16 v[72:75], a[212:215], a[144:147], 0
    v_fma_f32 v52, v52, s28, v9
    v_fma_f32 v54, v54, s28, v9
    v_mfma_f32_16x16x32_bf16 v[72:75], a[216:219], a[148:151], v[72:75]
    v_exp_f32 v54, v54
    v_mfma_f32_16x16x32_bf16 v[72:75], a[220:223], a[152:155], v[72:75]
    s_waitcnt vmcnt(13) lgkmcnt(0)
    s_add_u32 m0, s22, 0
    v_fma_f32 v55, v55, s28, v9
    v_mfma_f32_16x16x32_bf16 v[80:83], a[220:223], a[176:179], 0
    s_barrier
    v_mfma_f32_16x16x32_bf16 v[80:83], a[216:219], a[172:175], v[80:83]
    buffer_load_dwordx4 v6, s[4:7], s20 offen lds
    v_mfma_f32_16x16x32_bf16 v[80:83], a[212:215], a[168:171], v[80:83]
    s_add_u32 s20, s20, 128
    v_exp_f32 v61, v61
    v_mfma_f32_16x16x32_bf16 v[88:91], a[212:215], a[192:195], 0
    s_add_u32 m0, s22, 1024
    ds_read_b64_tr_b16 a[212:213], v2 offset:18432
    v_fma_f32 v60, v60, s28, v10
    v_mfma_f32_16x16x32_bf16 v[88:91], a[216:219], a[196:199], v[88:91]
    ds_read_b64_tr_b16 a[214:215], v2 offset:12288
    v_mfma_f32_16x16x32_bf16 v[88:91], a[220:223], a[200:203], v[88:91]
    buffer_load_dwordx4 v6, s[4:7], s20 offen lds
    v_mfma_f32_16x16x32_bf16 v[88:91], a[224:227], a[204:207], v[88:91]
    ds_read_b64_tr_b16 a[216:217], v3 offset:18432
    v_fma_f32 v53, v53, s28, v9
    v_mfma_f32_16x16x32_bf16 v[88:91], a[228:231], a[208:211], v[88:91]
    s_add_u32 s20, s20, 128
    ds_read_b64_tr_b16 a[218:219], v3 offset:12288
    v_fma_f32 v63, v63, s28, v10
    v_mfma_f32_16x16x32_bf16 v[88:91], a[232:235], v[92:95], v[88:91]
    s_add_u32 m0, s22, 2048
    v_exp_f32 v53, v53
    v_mfma_f32_16x16x32_bf16 v[80:83], a[232:235], a[188:191], v[80:83]
    buffer_load_dwordx4 v6, s[4:7], s20 offen lds
    v_mfma_f32_16x16x32_bf16 v[80:83], a[228:231], a[184:187], v[80:83]
    v_exp_f32 v63, v63
    v_mfma_f32_16x16x32_bf16 v[80:83], a[224:227], a[180:183], v[80:83]
    v_exp_f32 v55, v55
    v_mfma_f32_16x16x32_bf16 v[72:75], a[224:227], a[156:159], v[72:75]
    s_add_u32 s20, s20, 12032
    v_exp_f32 v60, v60
    v_mfma_f32_16x16x32_bf16 v[72:75], a[228:231], a[160:163], v[72:75]
    v_cvt_pk_bf16_f32 v20, v60, v61
    v_fma_f32 v62, v62, s28, v10
    v_mfma_f32_16x16x32_bf16 v[72:75], a[232:235], a[164:167], v[72:75]
    v_exp_f32 v62, v62
    v_mfma_f32_16x16x32_bf16 v[64:67], a[232:235], a[140:143], v[64:67]
    v_exp_f32 v52, v52
    v_mfma_f32_16x16x32_bf16 v[64:67], a[228:231], a[136:139], v[64:67]
    ds_read_b64_tr_b16 a[220:221], v4 offset:18432
    v_cvt_pk_bf16_f32 v21, v62, v63
    v_mfma_f32_16x16x32_bf16 v[64:67], a[224:227], a[132:135], v[64:67]
    s_waitcnt lgkmcnt(1)
    s_bitcmp1_b32 s3, 1
    ds_read_b64_tr_b16 a[222:223], v4 offset:12288
    v_mfma_f32_16x16x32_bf16 v[56:59], a[224:227], a[108:111], v[56:59]
    ds_read_b64_tr_b16 a[224:225], v5 offset:18432
    v_cvt_pk_bf16_f32 v15, v54, v55
    v_mfma_f32_16x16x32_bf16 v[56:59], a[228:231], a[112:115], v[56:59]
    ds_read_b64_tr_b16 a[226:227], v5 offset:12288
    v_cvt_pk_bf16_f32 v14, v52, v53
    v_mfma_f32_16x16x32_bf16 v[56:59], a[232:235], a[116:119], v[56:59]
    s_cbranch_scc1 L_loop5w1
    s_branch L_loop5w0
L_start4:
    s_add_u32 m0, s22, 0
    s_nop 0
    buffer_load_dwordx4 v6, s[4:7], s20 offen lds
    s_add_u32 s20, s20, 128
    s_add_u32 m0, s22, 1024
    s_nop 0
    buffer_load_dwordx4 v6, s[4:7], s20 offen lds
    s_add_u32 s20, s20, 128
    s_add_u32 m0, s22, 2048
    s_nop 0
    buffer_load_dwordx4 v6, s[4:7], s20 offen lds
    s_add_u32 s20, s20, 12032
    s_add_u32 m0, s22, 12288
    s_nop 0
    buffer_load_dwordx4 v6, s[4:7], s20 offen lds
    s_add_u32 s20, s20, 128
    s_add_u32 m0, s22, 13312
    s_nop 0
    buffer_load_dwordx4 v6, s[4:7], s20 offen lds
    s_add_u32 s20, s20, 128
    s_add_u32 m0, s22, 14336
    s_nop 0
    buffer_load_dwordx4 v6, s[4:7], s20 offen lds
    s_add_u32 s20, s20, 12032
    s_add_u32 s48, s34, 0
    s_add_u32 m0, s38, 0
    s_nop 0
    buffer_load_dwordx4 v6, s[12:15], s48 offen nt lds
    s_add_u32 m0, s38, 1024
    s_nop 0
    buffer_load_dwordx4 v7, s[12:15], s48 offen nt lds
    s_add_u32 s48, s34, 128
    s_add_u32 m0, s38, 2048
    s_nop 0
    buffer_load_dwordx4 v6, s[12:15], s48 offen nt lds
    s_add_u32 m0, s38, 3072
    s_nop 0
    buffer_load_dwordx4 v7, s[12:15], s48 offen nt lds
    s_add_u32 s48, s34, 256
    s_add_u32 m0, s38, 4096
    s_nop 0
    buffer_load_dwordx4 v6, s[12:15], s48 offen nt lds
    s_add_u32 m0, s38, 5120
    s_nop 0
    buffer_load_dwordx4 v7, s[12:15], s48 offen nt lds
    s_add_u32 s48, s34, 6144
    s_add_u32 m0, s38, 6144
    s_nop 0
    buffer_load_dwordx4 v6, s[12:15], s48 offen nt lds
    s_add_u32 m0, s38, 7168
    s_nop 0
    buffer_load_dwordx4 v7, s[12:15], s48 offen nt lds
    s_add_u32 s48, s34, 6272
    s_add_u32 m0, s38, 8192
    s_nop 0
    buffer_load_dwordx4 v6, s[12:15], s48 offen nt lds
    s_add_u32 m0, s38, 9216
    s_nop 0
    buffer_load_dwordx4 v7, s[12:15], s48 offen nt lds
    s_add_u32 s48, s34, 6400
    s_add_u32 m0, s38, 10240
    s_nop 0
    buffer_load_dwordx4 v6, s[12:15], s48 offen nt lds
    s_add_u32 m0, s38, 11264
    s_nop 0
    buffer_load_dwordx4 v7, s[12:15], s48 offen nt lds
    s_add_u32 s48, s34, 12288
    s_add_u32 m0, s38, 12288
    s_nop 0
    buffer_load_dwordx4 v6, s[12:15], s48 offen nt lds
    s_add_u32 m0, s38, 13312
    s_nop 0
    buffer_load_dwordx4 v7, s[12:15], s48 offen nt lds
    s_add_u32 s48, s34, 12416
    s_add_u32 m0, s38, 14336
    s_nop 0
    buffer_load_dwordx4 v6, s[12:15], s48 offen nt lds
    s_add_u32 m0, s38, 15360
    s_nop 0
    buffer_load_dwordx4 v7, s[12:15], s48 offen nt lds
    s_add_u32 s48, s34, 12544
    s_add_u32 m0, s38, 16384
    s_nop 0
    buffer_load_dwordx4 v6, s[12:15], s48 offen nt lds
    s_add_u32 m0, s38, 17408
    s_nop 0
    buffer_load_dwordx4 v7, s[12:15], s48 offen nt lds
    v_and_b32 v96, 15, v111
    v_lshrrev_b32 v97, 4, v111
    v_lshrrev_b32 v98, 3, v96
    v_and_b32 v99, 7, v96
    v_lshlrev_b32 v0, 7, v99
    v_bfe_u32 v99, v96, 1, 2
    v_lshlrev_b32 v99, 1, v99
    v_mul_u32_u24 v100, 5, v98
    v_xor_b32 v99, v99, v100
    v_xor_b32 v99, v99, v97
    v_lshl_add_u32 v0, v99, 4, v0
    v_mul_u32_u24 v100, 3072, v98
    v_add_u32 v0, v100, v0
    v_xor_b32 v1, 64, v0
    v_lshrrev_b32 v98, 1, v97
    v_mul_u32_u24 v2, 3072, v98
    v_and_b32 v99, 1, v97
    v_bfe_u32 v100, v111, 2, 2
    v_lshl_add_u32 v96, v99, 2, v100
    v_lshl_add_u32 v2, v96, 7, v2
    v_lshrrev_b32 v96, 1, v96
    v_lshlrev_b32 v96, 1, v96
    v_mul_u32_u24 v98, 5, v98
    v_xor_b32 v96, v96, v98
    v_bfe_u32 v99, v111, 1, 1
    v_xor_b32 v96, v96, v99
    v_lshl_add_u32 v2, v96, 4, v2
    v_and_b32 v99, 1, v111
    v_lshl_add_u32 v2, v99, 3, v2
    v_add_u32 v2, 24576, v2
    v_xor_b32 v3, 32, v2
    v_xor_b32 v4, 64, v2
    v_xor_b32 v5, 96, v2
    v_lshl_add_u32 v103, v111, 4, s38
    v_and_b32 v96, 15, v111
    s_mov_b32 s42, 0x1011
    v_bfe_i32 v97, s42, v96, 1
    v_and_b32 v97, 0x3f803f80, v97
    v_accvgpr_write_b32 a236, v97
    v_accvgpr_write_b32 a237, v97
    v_accvgpr_write_b32 a238, v97
    v_accvgpr_write_b32 a239, v97
    s_mov_b32 s42, 0x3222
    v_bfe_i32 v97, s42, v96, 1
    v_and_b32 v97, 0x3f803f80, v97
    v_accvgpr_write_b32 a240, v97
    v_accvgpr_write_b32 a241, v97
    v_accvgpr_write_b32 a242, v97
    v_accvgpr_write_b32 a243, v97
    s_mov_b32 s42, 0x5444
    v_bfe_i32 v97, s42, v96, 1
    v_and_b32 v97, 0x3f803f80, v97
    v_accvgpr_write_b32 a244, v97
    v_accvgpr_write_b32 a245, v97
    v_accvgpr_write_b32 a246, v97
    v_accvgpr_write_b32 a247, v97
    s_mov_b32 s42, 0x9888
    v_bfe_i32 v97, s42, v96, 1
    v_and_b32 v97, 0x3f803f80, v97
    v_accvgpr_write_b32 a248, v97
    v_accvgpr_write_b32 a249, v97
    v_accvgpr_write_b32 a250, v97
    v_accvgpr_write_b32 a251, v97
    s_mov_b32 s42, 0x1100
    v_bfe_i32 v97, s42, v96, 1
    v_and_b32 v97, 0x3f803f80, v97
    v_accvgpr_write_b32 a252, v97
    v_accvgpr_write_b32 a253, v97
    v_accvgpr_write_b32 a254, v97
    v_accvgpr_write_b32 a255, v97
    s_waitcnt vmcnt(18)
    s_barrier
    s_waitcnt vmcnt(12)
    s_add_u32 s48, s34, 18432
    s_add_u32 m0, s38, 18432
    s_nop 0
    buffer_load_dwordx4 v6, s[12:15], s48 offen nt lds
    s_add_u32 m0, s38, 19456
    s_nop 0
    buffer_load_dwordx4 v7, s[12:15], s48 offen nt lds
    s_add_u32 s48, s34, 18560
    ds_read_b128 a[212:215], v0 offset:0
    s_add_u32 m0, s38, 20480
    s_nop 0
    buffer_load_dwordx4 v6, s[12:15], s48 offen nt lds
    v_lshrrev_b32 v105, 11, v0
    s_add_u32 m0, s38, 21504
    v_xor_b32 v105, s65, v105
    v_and_b32 v104, 0x3ff, v0
    v_lshl_add_u32 v104, v105, 10, v104
    v_add_u32 v104, s38, v104
    buffer_load_dwordx4 v7, s[12:15], s48 offen nt lds
    s_add_u32 s48, s34, 18688
    ds_read_b128 a[220:223], v0 offset:1024
    s_add_u32 m0, s38, 22528
    s_nop 0
    buffer_load_dwordx4 v6, s[12:15], s48 offen nt lds
    ds_read_b128 a[96:99], v104 offset:0
    s_add_u32 m0, s38, 23552
    s_nop 0
    buffer_load_dwordx4 v7, s[12:15], s48 offen nt lds
    ds_read_b128 a[228:231], v0 offset:2048
    s_waitcnt lgkmcnt(1)
    v_mfma_f32_16x16x32_bf16 v[52:55], a[212:215], a[96:99], 0
    v_xor_b32 v105, 64, v104
    ds_read_b128 a[104:107], v104 offset:2048
    ds_read_b128 a[216:219], v1 offset:0
    ds_read_b128 a[100:103], v105 offset:0
    ds_read_b128 a[224:227], v1 offset:1024
    s_waitcnt lgkmcnt(1)
    v_mfma_f32_16x16x32_bf16 v[52:55], a[216:219], a[100:103], v[52:55]
    ds_read_b128 a[108:111], v105 offset:2048
    ds_read_b128 a[232:235], v1 offset:2048
    ds_read_b128 a[112:115], v104 offset:4096
    v_mfma_f32_16x16x32_bf16 v[52:55], a[220:223], a[104:107], v[52:55]
    ds_read_b128 a[212:215], v0 offset:6144
    s_waitcnt lgkmcnt(3)
    v_mfma_f32_16x16x32_bf16 v[52:55], a[224:227], a[108:111], v[52:55]
    s_waitcnt lgkmcnt(1)
    ds_read_b128 a[216:219], v1 offset:6144
    v_mfma_f32_16x16x32_bf16 v[52:55], a[228:231], a[112:115], v[52:55]
    ds_read_b128 a[116:119], v105 offset:4096
    s_waitcnt lgkmcnt(0)
    v_mfma_f32_16x16x32_bf16 v[52:55], a[232:235], a[116:119], v[52:55]
    ds_read_b128 a[220:223], v0 offset:7168
    v_mfma_f32_16x16x32_bf16 v[56:59], a[212:215], a[96:99], 0
    ds_read_b128 a[224:227], v1 offset:7168
    v_mfma_f32_16x16x32_bf16 v[56:59], a[216:219], a[100:103], v[56:59]
    ds_read_b128 a[212:215], v0 offset:12288
    s_waitcnt lgkmcnt(2)
    v_mfma_f32_16x16x32_bf16 v[56:59], a[220:223], a[104:107], v[56:59]
    ds_read_b128 a[216:219], v1 offset:12288
    ds_read_b128 a[228:231], v0 offset:8192
    s_waitcnt lgkmcnt(3)
    v_mfma_f32_16x16x32_bf16 v[56:59], a[224:227], a[108:111], v[56:59]
    ds_read_b128 a[232:235], v1 offset:8192
    s_waitcnt lgkmcnt(1)
    v_mfma_f32_16x16x32_bf16 v[56:59], a[228:231], a[112:115], v[56:59]
    ds_read_b128 a[228:231], v0 offset:14336
    v_max3_f32 v96, v52, v53, v54
    s_waitcnt lgkmcnt(1)
    v_mfma_f32_16x16x32_bf16 v[56:59], a[232:235], a[116:119], v[56:59]
    s_nop 7
    v_max3_f32 v96, v96, v55, v56
    v_max3_f32 v96, v96, v57, v58
    ds_read_b128 a[220:223], v0 offset:13312
    ds_read_b128 a[224:227], v1 offset:13312
    v_max_f32 v96, v96, v59
    v_mov_b32 v97, v96
    s_nop 1
    v_permlane32_swap_b32 v97, v96
    v_max_f32 v96, v96, v97
    v_mov_b32 v97, v96
    s_nop 1
    v_permlane16_swap_b32 v97, v96
    v_max_f32 v96, v96, v97
    v_mul_f32_e64 v9, -s28, v96
    v_fma_f32 v58, v58, s28, v9
    ds_read_b128 a[232:235], v1 offset:14336
    v_fma_f32 v52, v52, s28, v9
    v_fma_f32 v59, v59, s28, v9
    v_fma_f32 v53, v53, s28, v9
    v_fma_f32 v55, v55, s28, v9
    v_exp_f32 v52, v52
    v_exp_f32 v55, v55
    v_exp_f32 v53, v53
    v_fma_f32 v54, v54, s28, v9
    v_exp_f32 v59, v59
    v_exp_f32 v54, v54
    s_nop 0
    v_cvt_pk_bf16_f32 v15, v54, v55
    s_waitcnt vmcnt(12)
    s_add_u32 m0, s22, 24576
    ds_read_b128 a[128:131], v104 offset:8192
    buffer_load_dwordx4 v6, s[8:11], s21 offen lds
    v_cvt_pk_bf16_f32 v14, v52, v53
    s_add_u32 s21, s21, 128
    v_mfma_f32_16x16x32_bf16 v[52:55], a[212:215], a[96:99], 0
    s_add_u32 m0, s22, 25600
    s_nop 0
    buffer_load_dwordx4 v6, s[8:11], s21 offen lds
    s_add_u32 s21, s21, 128
    ds_read_b128 a[140:143], v105 offset:10240
    v_mfma_f32_16x16x32_bf16 v[52:55], a[216:219], a[100:103], v[52:55]
    s_add_u32 m0, s22, 26624
    v_fma_f32 v56, v56, s28, v9
    buffer_load_dwordx4 v6, s[8:11], s21 offen lds
    v_exp_f32 v58, v58
    ds_read_b128 a[212:215], v0 offset:18432
    s_waitcnt lgkmcnt(3)
    v_mfma_f32_16x16x32_bf16 v[52:55], a[220:223], a[104:107], v[52:55]
    v_fma_f32 v57, v57, s28, v9
    ds_read_b128 a[220:223], v0 offset:19456
    v_mfma_f32_16x16x32_bf16 v[52:55], a[224:227], a[108:111], v[52:55]
    ds_read_b128 a[224:227], v1 offset:19456
    ds_read_b128 a[216:219], v1 offset:18432
    v_exp_f32 v56, v56
    v_mfma_f32_16x16x32_bf16 v[52:55], a[228:231], a[112:115], v[52:55]
    v_exp_f32 v57, v57
    ds_read_b128 a[124:127], v105 offset:6144
    v_cvt_pk_bf16_f32 v17, v58, v59
    v_mfma_f32_16x16x32_bf16 v[52:55], a[232:235], a[116:119], v[52:55]
    v_cvt_pk_bf16_f32 v16, v56, v57
    ds_read_b128 a[120:123], v104 offset:6144
    s_waitcnt lgkmcnt(5)
    v_mfma_f32_16x16x32_bf16 v[56:59], a[212:215], a[96:99], 0
    ds_read_b128 a[212:215], v0 offset:0
    s_waitcnt lgkmcnt(3)
    v_mfma_f32_16x16x32_bf16 v[56:59], a[216:219], a[100:103], v[56:59]
    ds_read_b128 a[228:231], v0 offset:20480
    v_mfma_f32_16x16x32_bf16 v[56:59], a[220:223], a[104:107], v[56:59]
    ds_read_b128 a[216:219], v1 offset:0
    ds_read_b128 a[232:235], v1 offset:20480
    v_mfma_f32_16x16x32_bf16 v[56:59], a[224:227], a[108:111], v[56:59]
    ds_read_b128 a[220:223], v0 offset:1024
    s_waitcnt lgkmcnt(3)
    v_mfma_f32_16x16x32_bf16 v[56:59], a[228:231], a[112:115], v[56:59]
    ds_read_b128 a[224:227], v1 offset:1024
    s_waitcnt lgkmcnt(2)
    v_mfma_f32_16x16x32_bf16 v[56:59], a[232:235], a[116:119], v[56:59]
    s_add_u32 s21, s21, 12032
    v_fma_f32 v52, v52, s28, v9
    ds_read_b128 a[136:139], v104 offset:10240
    v_mfma_f32_16x16x32_bf16 v[60:63], a[212:215], a[120:123], 0
    ds_read_b128 a[228:231], v0 offset:2048
    v_mfma_f32_16x16x32_bf16 v[60:63], a[216:219], a[124:127], v[60:63]
    s_waitcnt lgkmcnt(3)
    ds_read_b128 a[132:135], v105 offset:8192
    v_mfma_f32_16x16x32_bf16 v[60:63], a[220:223], a[128:131], v[60:63]
    ds_read_b128 a[216:219], v1 offset:6144
    s_waitcnt lgkmcnt(1)
    v_mfma_f32_16x16x32_bf16 v[60:63], a[224:227], a[132:135], v[60:63]
    ds_read_b128 a[232:235], v1 offset:2048
    v_mfma_f32_16x16x32_bf16 v[60:63], a[228:231], a[136:139], v[60:63]
    ds_read_b128 a[212:215], v0 offset:6144
    s_waitcnt lgkmcnt(1)
    v_mfma_f32_16x16x32_bf16 v[60:63], a[232:235], a[140:143], v[60:63]
    ds_read_b128 a[220:223], v0 offset:7168
    s_waitcnt lgkmcnt(1)
    v_mfma_f32_16x16x32_bf16 v[64:67], a[212:215], a[120:123], 0
    ds_read_b128 a[224:227], v1 offset:7168
    v_mfma_f32_16x16x32_bf16 v[64:67], a[216:219], a[124:127], v[64:67]
    ds_read_b128 a[228:231], v0 offset:8192
    s_waitcnt lgkmcnt(2)
    v_mfma_f32_16x16x32_bf16 v[64:67], a[220:223], a[128:131], v[64:67]
    ds_read_b128 a[212:215], v0 offset:12288
    v_max3_f32 v98, v60, v61, v62
    ds_read_b128 a[232:235], v1 offset:8192
    s_waitcnt lgkmcnt(2)
    v_mfma_f32_16x16x32_bf16 v[64:67], a[224:227], a[132:135], v[64:67]
    ds_read_b128 a[220:223], v0 offset:13312
    v_fma_f32 v55, v55, s28, v9
    v_mfma_f32_16x16x32_bf16 v[64:67], a[228:231], a[136:139], v[64:67]
    ds_read_b128 a[224:227], v1 offset:13312
    s_waitcnt lgkmcnt(2)
    v_mfma_f32_16x16x32_bf16 v[64:67], a[232:235], a[140:143], v[64:67]
    s_nop 7
    v_max3_f32 v98, v98, v63, v64
    v_max3_f32 v98, v98, v65, v66
    v_max_f32 v98, v98, v67
    ds_read_b128 a[228:231], v0 offset:14336
    v_mov_b32 v99, v98
    s_nop 1
    v_permlane32_swap_b32 v99, v98
    ds_read_b128 a[216:219], v1 offset:12288
    v_max_f32 v98, v98, v99
    v_mov_b32 v99, v98
    v_mfma_f32_16x16x32_bf16 v[44:47], a[236:239], v[14:17], 0
    s_nop 0
    v_permlane16_swap_b32 v99, v98
    v_max_f32 v98, v98, v99
    v_mul_f32_e64 v10, -s28, v98
    v_fma_f32 v61, v61, s28, v10
    v_fma_f32 v62, v62, s28, v10
    v_exp_f32 v62, v62
    v_fma_f32 v54, v54, s28, v9
    v_fma_f32 v63, v63, s28, v10
    v_fma_f32 v60, v60, s28, v10
    v_exp_f32 v60, v60
    v_fma_f32 v66, v66, s28, v10
    v_fma_f32 v65, v65, s28, v10
    v_exp_f32 v61, v61
    v_exp_f32 v63, v63
    v_cvt_pk_bf16_f32 v20, v60, v61
    v_exp_f32 v65, v65
    v_fma_f32 v67, v67, s28, v10
    v_exp_f32 v67, v67
    v_exp_f32 v66, v66
    v_cvt_pk_bf16_f32 v21, v62, v63
    s_waitcnt vmcnt(9)
    s_add_u32 m0, s22, 36864
    ds_read_b128 a[232:235], v1 offset:14336
    buffer_load_dwordx4 v6, s[8:11], s21 offen lds
    ds_read_b128 a[144:147], v104 offset:12288
    v_mfma_f32_16x16x32_bf16 v[60:63], a[212:215], a[120:123], 0
    s_add_u32 s21, s21, 128
    s_add_u32 m0, s22, 37888
    s_nop 0
    buffer_load_dwordx4 v6, s[8:11], s21 offen lds
    v_fma_f32 v64, v64, s28, v10
    s_add_u32 s21, s21, 128
    ds_read_b128 a[212:215], v0 offset:18432
    s_add_u32 m0, s22, 38912
    s_waitcnt lgkmcnt(3)
    v_mfma_f32_16x16x32_bf16 v[60:63], a[216:219], a[124:127], v[60:63]
    buffer_load_dwordx4 v6, s[8:11], s21 offen lds
    ds_read_b128 a[160:163], v104 offset:16384
    v_mfma_f32_16x16x32_bf16 v[60:63], a[220:223], a[128:131], v[60:63]
    ds_read_b128 a[220:223], v0 offset:19456
    v_mfma_f32_16x16x32_bf16 v[60:63], a[224:227], a[132:135], v[60:63]
    ds_read_b128 a[152:155], v104 offset:14336
    v_mfma_f32_16x16x32_bf16 v[60:63], a[228:231], a[136:139], v[60:63]
    ds_read_b128 a[164:167], v105 offset:16384
    v_exp_f32 v64, v64
    s_waitcnt lgkmcnt(6)
    v_mfma_f32_16x16x32_bf16 v[60:63], a[232:235], a[140:143], v[60:63]
    ds_read_b128 a[232:235], v1 offset:20480
    ds_read_b128 a[216:219], v1 offset:18432
    v_cvt_pk_bf16_f32 v23, v66, v67
    ds_read_b128 a[224:227], v1 offset:19456
    v_cvt_pk_bf16_f32 v22, v64, v65
    s_waitcnt lgkmcnt(7)
    v_mfma_f32_16x16x32_bf16 v[64:67], a[212:215], a[120:123], 0
    ds_read_b128 a[228:231], v0 offset:20480
    s_waitcnt lgkmcnt(2)
    v_mfma_f32_16x16x32_bf16 v[64:67], a[216:219], a[124:127], v[64:67]
    ds_read_b128 a[212:215], v0 offset:0
    v_mfma_f32_16x16x32_bf16 v[64:67], a[220:223], a[128:131], v[64:67]
    ds_read_b128 a[148:151], v105 offset:12288
    v_mfma_f32_16x16x32_bf16 v[44:47], a[240:243], v[20:23], v[44:47]
    s_waitcnt lgkmcnt(3)
    ds_read_b128 a[216:219], v1 offset:0
    v_fma_f32 v60, v60, s28, v10
    v_mfma_f32_16x16x32_bf16 v[64:67], a[224:227], a[132:135], v[64:67]
    s_waitcnt lgkmcnt(3)
    ds_read_b128 a[156:159], v105 offset:14336
    v_mfma_f32_16x16x32_bf16 v[64:67], a[228:231], a[136:139], v[64:67]
    ds_read_b128 a[224:227], v1 offset:1024
    v_mfma_f32_16x16x32_bf16 v[64:67], a[232:235], a[140:143], v[64:67]
    ds_read_b128 a[220:223], v0 offset:1024
    s_waitcnt lgkmcnt(5)
    v_mfma_f32_16x16x32_bf16 v[68:71], a[212:215], a[144:147], 0
    ds_read_b128 a[228:231], v0 offset:2048
    s_waitcnt lgkmcnt(4)
    v_mfma_f32_16x16x32_bf16 v[68:71], a[216:219], a[148:151], v[68:71]
    ds_read_b128 a[212:215], v0 offset:6144
    s_waitcnt lgkmcnt(2)
    v_mfma_f32_16x16x32_bf16 v[68:71], a[220:223], a[152:155], v[68:71]
    ds_read_b128 a[232:235], v1 offset:2048
    v_mfma_f32_16x16x32_bf16 v[68:71], a[224:227], a[156:159], v[68:71]
    ds_read_b128 a[216:219], v1 offset:6144
    v_fma_f32 v53, v53, s28, v9
    s_waitcnt lgkmcnt(3)
    v_mfma_f32_16x16x32_bf16 v[68:71], a[228:231], a[160:163], v[68:71]
    ds_read_b128 a[228:231], v0 offset:8192
    ds_read_b128 a[220:223], v0 offset:7168
    s_waitcnt lgkmcnt(3)
    v_mfma_f32_16x16x32_bf16 v[68:71], a[232:235], a[164:167], v[68:71]
    s_add_u32 s21, s21, 12032
    ds_read_b128 a[224:227], v1 offset:7168
    v_mfma_f32_16x16x32_bf16 v[72:75], a[212:215], a[144:147], 0
    s_waitcnt lgkmcnt(3)
    ds_read_b128 a[212:215], v0 offset:12288
    v_mfma_f32_16x16x32_bf16 v[72:75], a[216:219], a[148:151], v[72:75]
    ds_read_b128 a[232:235], v1 offset:8192
    s_waitcnt lgkmcnt(3)
    v_mfma_f32_16x16x32_bf16 v[72:75], a[220:223], a[152:155], v[72:75]
    v_exp_f32 v54, v54
    ds_read_b128 a[216:219], v1 offset:12288
    v_max3_f32 v96, v68, v69, v70
    s_waitcnt lgkmcnt(3)
    v_mfma_f32_16x16x32_bf16 v[72:75], a[224:227], a[156:159], v[72:75]
    ds_read_b128 a[224:227], v1 offset:13312
    v_mfma_f32_16x16x32_bf16 v[72:75], a[228:231], a[160:163], v[72:75]
    ds_read_b128 a[220:223], v0 offset:13312
    s_waitcnt lgkmcnt(3)
    v_mfma_f32_16x16x32_bf16 v[72:75], a[232:235], a[164:167], v[72:75]
    s_nop 7
    v_max3_f32 v96, v96, v71, v72
    v_max3_f32 v96, v96, v73, v74
    v_max_f32 v96, v96, v75
    ds_read_b128 a[228:231], v0 offset:14336
    v_mov_b32 v97, v96
    s_nop 1
    v_permlane32_swap_b32 v97, v96
    v_max_f32 v96, v96, v97
    v_mov_b32 v97, v96
    s_nop 1
    v_permlane16_swap_b32 v97, v96
    v_max_f32 v96, v96, v97
    v_mul_f32_e64 v11, -s28, v96
    v_fma_f32 v72, v72, s28, v11
    v_fma_f32 v71, v71, s28, v11
    v_fma_f32 v68, v68, s28, v11
    v_fma_f32 v70, v70, s28, v11
    v_exp_f32 v53, v53
    v_exp_f32 v70, v70
    v_exp_f32 v68, v68
    v_fma_f32 v69, v69, s28, v11
    v_exp_f32 v71, v71
    v_fma_f32 v75, v75, s28, v11
    v_cvt_pk_bf16_f32 v27, v70, v71
    v_fma_f32 v74, v74, s28, v11
    v_exp_f32 v69, v69
    s_nop 0
    v_cvt_pk_bf16_f32 v26, v68, v69
    v_mfma_f32_16x16x32_bf16 v[68:71], a[212:215], a[144:147], 0
    s_waitcnt lgkmcnt(1)
    ds_read_b128 a[232:235], v1 offset:14336
    v_fma_f32 v73, v73, s28, v11
    v_mfma_f32_16x16x32_bf16 v[68:71], a[216:219], a[148:151], v[68:71]
    v_exp_f32 v72, v72
    v_exp_f32 v74, v74
    ds_read_b128 a[212:215], v0 offset:18432
    v_mfma_f32_16x16x32_bf16 v[68:71], a[220:223], a[152:155], v[68:71]
    v_exp_f32 v73, v73
    ds_read_b128 a[216:219], v1 offset:18432
    v_mfma_f32_16x16x32_bf16 v[68:71], a[224:227], a[156:159], v[68:71]
    s_waitcnt lgkmcnt(3)
    v_fma_f32 v61, v61, s28, v10
    ds_read_b128 a[220:223], v0 offset:19456
    v_exp_f32 v75, v75
    v_mfma_f32_16x16x32_bf16 v[68:71], a[228:231], a[160:163], v[68:71]
    v_cvt_pk_bf16_f32 v28, v72, v73
    ds_read_b128 a[224:227], v1 offset:19456
    v_exp_f32 v60, v60
    v_cvt_pk_bf16_f32 v29, v74, v75
    s_waitcnt lgkmcnt(4)
    v_mfma_f32_16x16x32_bf16 v[68:71], a[232:235], a[164:167], v[68:71]
    ds_read_b128 a[232:235], v1 offset:20480
    s_waitcnt lgkmcnt(4)
    v_mfma_f32_16x16x32_bf16 v[72:75], a[212:215], a[144:147], 0
    ds_read_b128 a[228:231], v0 offset:20480
    s_waitcnt lgkmcnt(4)
    v_mfma_f32_16x16x32_bf16 v[72:75], a[216:219], a[148:151], v[72:75]
    v_exp_f32 v61, v61
    ds_read_b128 a[216:219], v1 offset:0
    s_waitcnt lgkmcnt(4)
    v_mfma_f32_16x16x32_bf16 v[72:75], a[220:223], a[152:155], v[72:75]
    ds_read_b128 a[220:223], v0 offset:1024
    s_waitcnt lgkmcnt(4)
    v_mfma_f32_16x16x32_bf16 v[72:75], a[224:227], a[156:159], v[72:75]
    ds_read_b128 a[212:215], v0 offset:0
    s_waitcnt lgkmcnt(3)
    v_mfma_f32_16x16x32_bf16 v[72:75], a[228:231], a[160:163], v[72:75]
    s_waitcnt vmcnt(6)
    ds_read_b128 a[168:171], v104 offset:18432
    v_mfma_f32_16x16x32_bf16 v[72:75], a[232:235], a[164:167], v[72:75]
    ds_read_b128 a[232:235], v1 offset:2048
    ds_read_b128 a[172:175], v105 offset:18432
    ds_read_b128 a[176:179], v104 offset:20480
    ds_read_b128 a[188:191], v105 offset:22528
    ds_read_b128 a[184:187], v104 offset:22528
    ds_read_b128 a[224:227], v1 offset:1024
    ds_read_b128 a[180:183], v105 offset:20480
    ds_read_b128 a[228:231], v0 offset:2048
    s_waitcnt lgkmcnt(8)
    v_mfma_f32_16x16x32_bf16 v[76:79], a[212:215], a[168:171], 0
    ds_read_b128 a[212:215], v0 offset:6144
    s_waitcnt lgkmcnt(7)
    v_mfma_f32_16x16x32_bf16 v[76:79], a[216:219], a[172:175], v[76:79]
    s_waitcnt lgkmcnt(5)
    ds_read_b128 a[216:219], v1 offset:6144
    v_mfma_f32_16x16x32_bf16 v[76:79], a[220:223], a[176:179], v[76:79]
    s_waitcnt lgkmcnt(2)
    ds_read_b128 a[220:223], v0 offset:7168
    v_mfma_f32_16x16x32_bf16 v[76:79], a[224:227], a[180:183], v[76:79]
    ds_read_b128 a[224:227], v1 offset:7168
    v_mfma_f32_16x16x32_bf16 v[76:79], a[228:231], a[184:187], v[76:79]
    ds_read_b128 a[228:231], v0 offset:8192
    v_mfma_f32_16x16x32_bf16 v[76:79], a[232:235], a[188:191], v[76:79]
    ds_read_b128 a[232:235], v1 offset:8192
    s_waitcnt lgkmcnt(5)
    v_mfma_f32_16x16x32_bf16 v[80:83], a[212:215], a[168:171], 0
    s_waitcnt lgkmcnt(4)
    v_mfma_f32_16x16x32_bf16 v[80:83], a[216:219], a[172:175], v[80:83]
    v_exp_f32 v52, v52
    s_nop 1
    v_max3_f32 v98, v76, v77, v78
    s_waitcnt lgkmcnt(2)
    v_mfma_f32_16x16x32_bf16 v[80:83], a[220:223], a[176:179], v[80:83]
    s_waitcnt vmcnt(63) lgkmcnt(0)
    s_barrier
    ds_read_b128 a[216:219], v1 offset:12288
    v_mfma_f32_16x16x32_bf16 v[80:83], a[224:227], a[180:183], v[80:83]
    s_add_u32 m0, s22, 0
    ds_read_b128 a[212:215], v0 offset:12288
    buffer_load_dwordx4 v6, s[4:7], s20 offen lds
    v_mfma_f32_16x16x32_bf16 v[80:83], a[228:231], a[184:187], v[80:83]
    s_add_u32 s20, s20, 128
    ds_read_b128 a[224:227], v1 offset:13312
    ds_read_b128 a[220:223], v0 offset:13312
    v_mfma_f32_16x16x32_bf16 v[80:83], a[232:235], a[188:191], v[80:83]
    s_add_u32 m0, s22, 1024
    ds_read_b128 a[232:235], v1 offset:14336
    buffer_load_dwordx4 v6, s[4:7], s20 offen lds
    v_mfma_f32_16x16x32_bf16 v[44:47], a[244:247], v[26:29], v[44:47]
    s_add_u32 s20, s20, 128
    s_add_u32 m0, s22, 2048
    ds_read_b128 a[228:231], v0 offset:14336
    buffer_load_dwordx4 v6, s[4:7], s20 offen lds
    v_max3_f32 v98, v98, v79, v80
    v_max3_f32 v98, v98, v81, v82
    v_max_f32 v98, v98, v83
    v_mov_b32 v99, v98
    s_add_u32 s20, s20, 12032
    s_mov_b32 s39, s64
    v_permlane32_swap_b32 v99, v98
    v_max_f32 v98, v98, v99
    v_mov_b32 v99, v98
    s_add_u32 s37, s37, 1
    s_bitcmp1_b32 s63, s37
    v_permlane16_swap_b32 v99, v98
    v_max_f32 v98, v98, v99
    v_mul_f32_e64 v12, -s28, v98
    v_fma_f32 v79, v79, s28, v12
    v_fma_f32 v78, v78, s28, v12
    v_exp_f32 v78, v78
    v_fma_f32 v77, v77, s28, v12
    v_fma_f32 v76, v76, s28, v12
    v_exp_f32 v77, v77
    v_exp_f32 v79, v79
    v_exp_f32 v76, v76
    v_cvt_pk_bf16_f32 v33, v78, v79
    v_cvt_pk_bf16_f32 v32, v76, v77
    s_cselect_b32 s62, 4294770688, 0
    s_waitcnt lgkmcnt(1)
    v_mfma_f32_16x16x32_bf16 v[76:79], a[212:215], a[168:171], 0
    s_cselect_b32 s42, 0, 325632
    s_add_u32 s35, s35, s42
    ds_read_b128 a[212:215], v0 offset:18432
    v_mfma_f32_16x16x32_bf16 v[76:79], a[216:219], a[172:175], v[76:79]
    s_lshl_b32 s42, s37, 1
    ds_read_b128 a[216:219], v1 offset:18432
    s_lshr_b32 s42, s31, s42
    s_and_b32 s42, s42, 3
    s_add_u32 s42, s42, s36
    v_mfma_f32_16x16x32_bf16 v[76:79], a[220:223], a[176:179], v[76:79]
    s_sub_u32 s43, s42, 3
    ds_read_b128 a[220:223], v0 offset:19456
    s_cmp_ge_u32 s42, 3
    v_mfma_f32_16x16x32_bf16 v[76:79], a[224:227], a[180:183], v[76:79]
    s_waitcnt lgkmcnt(3)
    ds_read_b128 a[224:227], v1 offset:19456
    s_cselect_b32 s42, s43, s42
    v_mfma_f32_16x16x32_bf16 v[76:79], a[228:231], a[184:187], v[76:79]
    s_mul_i32 s44, s3, 5
    ds_read_b128 a[228:231], v0 offset:20480
    s_mov_b32 s32, 1
    v_mfma_f32_16x16x32_bf16 v[76:79], a[232:235], a[188:191], v[76:79]
    s_lshl_b32 s43, s3, 2
    s_add_u32 s45, s43, 21
    ds_read_b128 a[232:235], v1 offset:20480
    s_cmp_eq_u32 s3, 0
    s_cselect_b32 s45, 20, s45
    v_fma_f32 v82, v82, s28, v12
    v_fma_f32 v80, v80, s28, v12
    v_fma_f32 v83, v83, s28, v12
    s_cselect_b32 s33, 1, 0
    s_cmp_eq_u32 s42, 1
    s_cselect_b32 s44, s45, s44
    s_cselect_b32 s32, s33, s32
    s_add_u32 s45, s43, 37
    v_fma_f32 v81, v81, s28, v12
    v_exp_f32 v83, v83
    s_cmp_eq_u32 s42, 2
    s_cselect_b32 s44, s45, s44
    s_cselect_b32 s32, 0, s32
    v_exp_f32 v82, v82
    s_mul_i32 s44, s44, 6144
    s_add_u32 s33, s35, s44
    v_exp_f32 v81, v81
    s_mul_i32 s42, s32, 6144
    s_add_u32 s42, s42, 24576
    s_add_u32 s42, s42, s33
    v_exp_f32 v80, v80
    s_cmp_ge_u32 s37, 6
    v_cvt_pk_bf16_f32 v35, v82, v83
    s_cselect_b32 s14, 0, s42
    v_cvt_pk_bf16_f32 v34, v80, v81
    s_add_u32 s24, s67, 6144
    s_add_u32 s25, s33, 6144
    s_add_u32 s23, s38, 6144
    s_mov_b32 s27, 0x30c30
    s_mov_b32 s89, 0xaaaaaaaa
    s_mov_b32 s30, 0
    s_waitcnt vmcnt(6) lgkmcnt(0)
    v_mfma_f32_16x16x32_bf16 v[80:83], a[212:215], a[168:171], 0
    s_barrier
    ds_read_b64_tr_b16 a[212:213], v2 offset:0
    ds_read_b64_tr_b16 a[214:215], v2 offset:6144
    v_mfma_f32_16x16x32_bf16 v[80:83], a[216:219], a[172:175], v[80:83]
    v_exp_f32 v55, v55
    s_add_u32 m0, s22, 12288
    ds_read_b64_tr_b16 a[216:217], v3 offset:0
    buffer_load_dwordx4 v6, s[4:7], s20 offen lds
    v_cvt_pk_bf16_f32 v18, v52, v53
    ds_read_b64_tr_b16 a[218:219], v3 offset:6144
    s_add_u32 s20, s20, 128
    v_mfma_f32_16x16x32_bf16 v[80:83], a[220:223], a[176:179], v[80:83]
    s_add_u32 m0, s22, 13312
    ds_read_b64_tr_b16 a[220:221], v4 offset:0
    buffer_load_dwordx4 v6, s[4:7], s20 offen lds
    v_cvt_pk_bf16_f32 v19, v54, v55
    v_mfma_f32_16x16x32_bf16 v[80:83], a[224:227], a[180:183], v[80:83]
    s_add_u32 s20, s20, 128
    ds_read_b64_tr_b16 a[222:223], v4 offset:6144
    v_mfma_f32_16x16x32_bf16 v[80:83], a[228:231], a[184:187], v[80:83]
    s_add_u32 m0, s22, 14336
    ds_read_b64_tr_b16 a[224:225], v5 offset:0
    v_cvt_pk_bf16_f32 v24, v60, v61
    v_mfma_f32_16x16x32_bf16 v[80:83], a[232:235], a[188:191], v[80:83]
    buffer_load_dwordx4 v6, s[4:7], s20 offen lds
    ds_read_b64_tr_b16 a[226:227], v5 offset:6144
    v_mfma_f32_16x16x32_bf16 v[44:47], a[248:251], v[32:35], v[44:47]
    s_add_u32 s20, s20, 12032
    s_waitcnt lgkmcnt(6)
    v_fma_f32 v65, v65, s28, v10
    v_mfma_f32_16x16x32_bf16 v[112:115], a[212:215], v[14:17], 0
    v_fma_f32 v79, v79, s28, v12
    v_mfma_f32_16x16x32_bf16 v[160:163], a[212:215], v[20:23], 0
    ds_read_b64_tr_b16 a[230:231], v2 offset:7168
    v_fma_f32 v68, v68, s28, v11
    v_mfma_f32_16x16x32_bf16 v[208:211], a[212:215], v[26:29], 0
    ds_read_b64_tr_b16 a[228:229], v2 offset:1024
    v_fma_f32 v69, v69, s28, v11
    v_mfma_f32_16x16x32_bf16 a[0:3], a[212:215], v[32:35], 0
    ds_read_b64_tr_b16 a[232:233], v3 offset:1024
    s_waitcnt lgkmcnt(7)
    v_mfma_f32_16x16x32_bf16 a[4:7], a[216:219], v[32:35], 0
    v_fma_f32 v70, v70, s28, v11
    v_fma_f32 v57, v57, s28, v9
    v_mfma_f32_16x16x32_bf16 v[212:215], a[216:219], v[26:29], 0
    ds_read_b64_tr_b16 a[214:215], v4 offset:7168
    v_mfma_f32_16x16x32_bf16 v[164:167], a[216:219], v[20:23], 0
    s_add_u32 s39, s39, 12288
    v_exp_f32 v79, v79
    v_mfma_f32_16x16x32_bf16 v[116:119], a[216:219], v[14:17], 0
    v_fma_f32 v71, v71, s28, v11
    s_waitcnt lgkmcnt(6)
    v_mfma_f32_16x16x32_bf16 v[120:123], a[220:223], v[14:17], 0
    v_fma_f32 v63, v63, s28, v10
    v_fma_f32 v62, v62, s28, v10
    v_mfma_f32_16x16x32_bf16 v[168:171], a[220:223], v[20:23], 0
    ds_read_b64_tr_b16 a[234:235], v3 offset:7168
    v_mfma_f32_16x16x32_bf16 v[216:219], a[220:223], v[26:29], 0
    ds_read_b64_tr_b16 a[212:213], v4 offset:1024
    v_fma_f32 v59, v59, s28, v9
    v_mfma_f32_16x16x32_bf16 a[8:11], a[220:223], v[32:35], 0
    s_waitcnt lgkmcnt(5)
    v_exp_f32 v70, v70
    v_mfma_f32_16x16x32_bf16 a[12:15], a[224:227], v[32:35], 0
    ds_read_b64_tr_b16 a[222:223], v2 offset:8192
    v_fma_f32 v75, v75, s28, v11
    v_mfma_f32_16x16x32_bf16 v[220:223], a[224:227], v[26:29], 0
    ds_read_b64_tr_b16 a[216:217], v5 offset:1024
    v_fma_f32 v77, v77, s28, v12
    v_mfma_f32_16x16x32_bf16 v[172:175], a[224:227], v[20:23], 0
    ds_read_b64_tr_b16 a[218:219], v5 offset:7168
    v_mfma_f32_16x16x32_bf16 v[124:127], a[224:227], v[14:17], 0
    s_waitcnt lgkmcnt(5)
    ds_read_b64_tr_b16 a[220:221], v2 offset:2048
    v_fma_f32 v81, v81, s28, v12
    v_mfma_f32_16x16x32_bf16 v[128:131], a[228:231], v[14:17], 0
    ds_read_b64_tr_b16 a[224:225], v3 offset:2048
    v_fma_f32 v82, v82, s28, v12
    v_mfma_f32_16x16x32_bf16 v[176:179], a[228:231], v[20:23], 0
    v_fma_f32 v58, v58, s28, v9
    v_fma_f32 v66, v66, s28, v10
    v_mfma_f32_16x16x32_bf16 v[224:227], a[228:231], v[26:29], 0
    v_exp_f32 v81, v81
    v_mfma_f32_16x16x32_bf16 a[16:19], a[228:231], v[32:35], 0
    s_waitcnt lgkmcnt(6)
    v_exp_f32 v62, v62
    v_mfma_f32_16x16x32_bf16 a[20:23], a[232:235], v[32:35], 0
    ds_read_b64_tr_b16 a[230:231], v4 offset:8192
    v_fma_f32 v78, v78, s28, v12
    v_mfma_f32_16x16x32_bf16 v[228:231], a[232:235], v[26:29], 0
    ds_read_b64_tr_b16 a[226:227], v3 offset:8192
    v_fma_f32 v76, v76, s28, v12
    v_mfma_f32_16x16x32_bf16 v[180:183], a[232:235], v[20:23], 0
    ds_read_b64_tr_b16 a[228:229], v4 offset:2048
    v_fma_f32 v67, v67, s28, v10
    v_mfma_f32_16x16x32_bf16 v[132:135], a[232:235], v[14:17], 0
    s_waitcnt lgkmcnt(6)
    ds_read_b64_tr_b16 a[232:233], v5 offset:2048
    v_fma_f32 v64, v64, s28, v10
    v_mfma_f32_16x16x32_bf16 v[136:139], a[212:215], v[14:17], 0
    ds_read_b64_tr_b16 a[234:235], v5 offset:8192
    v_fma_f32 v80, v80, s28, v12
    v_mfma_f32_16x16x32_bf16 v[184:187], a[212:215], v[20:23], 0
    v_fma_f32 v56, v56, s28, v9
    v_fma_f32 v73, v73, s28, v11
    v_mfma_f32_16x16x32_bf16 v[232:235], a[212:215], v[26:29], 0
    v_exp_f32 v82, v82
    v_mfma_f32_16x16x32_bf16 a[24:27], a[212:215], v[32:35], 0
    s_waitcnt lgkmcnt(5)
    v_mfma_f32_16x16x32_bf16 a[28:31], a[216:219], v[32:35], 0
    v_exp_f32 v78, v78
    v_mfma_f32_16x16x32_bf16 v[236:239], a[216:219], v[26:29], 0
    v_exp_f32 v76, v76
    v_mfma_f32_16x16x32_bf16 v[188:191], a[216:219], v[20:23], 0
    v_exp_f32 v68, v68
    v_mfma_f32_16x16x32_bf16 v[140:143], a[216:219], v[14:17], 0
    v_exp_f32 v69, v69
    v_mfma_f32_16x16x32_bf16 v[144:147], a[220:223], v[14:17], 0
    v_exp_f32 v65, v65
    v_mfma_f32_16x16x32_bf16 v[192:195], a[220:223], v[20:23], 0
    v_exp_f32 v63, v63
    v_mfma_f32_16x16x32_bf16 v[240:243], a[220:223], v[26:29], 0
    s_waitcnt vmcnt(3) lgkmcnt(0)
    v_cvt_pk_bf16_f32 v25, v62, v63
    v_fma_f32 v83, v83, s28, v12
    v_mfma_f32_16x16x32_bf16 a[32:35], a[220:223], v[32:35], 0
    s_barrier
    v_mfma_f32_16x16x32_bf16 a[36:39], a[224:227], v[32:35], 0
    ds_read_b128 a[212:215], v0 offset:0
    v_mov_b32 v39, v7
    v_mfma_f32_16x16x32_bf16 v[244:247], a[224:227], v[26:29], 0
    ds_read_b128 a[216:219], v1 offset:0
    v_cvt_pk_bf16_f32 v30, v68, v69
    v_mfma_f32_16x16x32_bf16 v[196:199], a[224:227], v[20:23], 0
    ds_read_b128 a[220:223], v0 offset:1024
    s_add_u32 m0, s22, 24576
    v_mfma_f32_16x16x32_bf16 v[148:151], a[224:227], v[14:17], 0
    buffer_load_dwordx4 v6, s[8:11], s21 offen lds
    v_mfma_f32_16x16x32_bf16 v[152:155], a[228:231], v[14:17], 0
    s_add_u32 s21, s21, 128
    v_exp_f32 v73, v73
    v_mfma_f32_16x16x32_bf16 v[200:203], a[228:231], v[20:23], 0
    s_add_u32 m0, s22, 25600
    v_exp_f32 v57, v57
    v_mfma_f32_16x16x32_bf16 v[248:251], a[228:231], v[26:29], 0
    buffer_load_dwordx4 v6, s[8:11], s21 offen lds
    v_mfma_f32_16x16x32_bf16 a[40:43], a[228:231], v[32:35], 0
    s_add_u32 s21, s21, 128
    v_exp_f32 v71, v71
    v_mfma_f32_16x16x32_bf16 a[44:47], a[232:235], v[32:35], 0
    v_cvt_pk_bf16_f32 v31, v70, v71
    v_cvt_pk_bf16_f32 v37, v78, v79
    v_mfma_f32_16x16x32_bf16 v[252:255], a[232:235], v[26:29], 0
    s_add_u32 m0, s22, 26624
    v_exp_f32 v77, v77
    v_mfma_f32_16x16x32_bf16 v[204:207], a[232:235], v[20:23], 0
    buffer_load_dwordx4 v6, s[8:11], s21 offen lds
    v_mfma_f32_16x16x32_bf16 v[156:159], a[232:235], v[14:17], 0
    s_waitcnt lgkmcnt(1)
    ds_read_b128 a[224:227], v1 offset:1024
    v_fma_f32 v72, v72, s28, v11
    v_mfma_f32_16x16x32_bf16 v[52:55], a[212:215], a[96:99], 0
    ds_read_b128 a[232:235], v1 offset:2048
    v_cvt_pk_bf16_f32 v36, v76, v77
    v_mfma_f32_16x16x32_bf16 v[52:55], a[216:219], a[100:103], v[52:55]
    s_waitcnt lgkmcnt(2)
    ds_read_b128 a[228:231], v0 offset:2048
    v_fma_f32 v74, v74, s28, v11
    v_mfma_f32_16x16x32_bf16 v[52:55], a[220:223], a[104:107], v[52:55]
    v_exp_f32 v66, v66
    v_mfma_f32_16x16x32_bf16 v[60:63], a[220:223], a[128:131], 0
    v_exp_f32 v67, v67
    v_mfma_f32_16x16x32_bf16 v[60:63], a[216:219], a[124:127], v[60:63]
    s_add_u32 s21, s21, 12032
    v_exp_f32 v59, v59
    v_mfma_f32_16x16x32_bf16 v[60:63], a[212:215], a[120:123], v[60:63]
    v_exp_f32 v83, v83
    v_mfma_f32_16x16x32_bf16 v[68:71], a[212:215], a[144:147], 0
    v_exp_f32 v74, v74
    v_mfma_f32_16x16x32_bf16 v[68:71], a[216:219], a[148:151], v[68:71]
    v_exp_f32 v64, v64
    v_mfma_f32_16x16x32_bf16 v[68:71], a[220:223], a[152:155], v[68:71]
    v_mov_b32 v38, v6
    s_add_u32 m0, s38, 0
    v_mfma_f32_16x16x32_bf16 v[76:79], a[220:223], a[176:179], 0
    v_exp_f32 v58, v58
    v_mfma_f32_16x16x32_bf16 v[76:79], a[216:219], a[172:175], v[76:79]
    buffer_load_dwordx4 v6, s[12:15], s33 offen nt lds
    v_mfma_f32_16x16x32_bf16 v[76:79], a[212:215], a[168:171], v[76:79]
    s_waitcnt lgkmcnt(0)
    v_exp_f32 v56, v56
    v_mfma_f32_16x16x32_bf16 v[76:79], a[224:227], a[180:183], v[76:79]
    ds_read_b128 a[212:215], v0 offset:6144
    s_add_u32 m0, s38, 1024
    v_mfma_f32_16x16x32_bf16 v[76:79], a[228:231], a[184:187], v[76:79]
    v_exp_f32 v75, v75
    v_mfma_f32_16x16x32_bf16 v[76:79], a[232:235], a[188:191], v[76:79]
    v_exp_f32 v72, v72
    v_mfma_f32_16x16x32_bf16 v[68:71], a[232:235], a[164:167], v[68:71]
    buffer_load_dwordx4 v7, s[12:15], s33 offen nt lds
    v_mfma_f32_16x16x32_bf16 v[68:71], a[228:231], a[160:163], v[68:71]
    ds_read_b128 a[220:223], v0 offset:7168
    v_cvt_pk_bf16_f32 v22, v64, v65
    v_mfma_f32_16x16x32_bf16 v[68:71], a[224:227], a[156:159], v[68:71]
    ds_read_b128 a[216:219], v1 offset:6144
    v_cvt_pk_bf16_f32 v35, v82, v83
    v_mfma_f32_16x16x32_bf16 v[60:63], a[224:227], a[132:135], v[60:63]
    v_cvt_pk_bf16_f32 v17, v58, v59
    v_cvt_pk_bf16_f32 v16, v56, v57
    v_mfma_f32_16x16x32_bf16 v[60:63], a[228:231], a[136:139], v[60:63]
    v_exp_f32 v80, v80
    v_mfma_f32_16x16x32_bf16 v[60:63], a[232:235], a[140:143], v[60:63]
    v_cvt_pk_bf16_f32 v29, v74, v75
    v_mfma_f32_16x16x32_bf16 v[52:55], a[232:235], a[116:119], v[52:55]
    s_add_u32 s59, s33, 128
    ds_read_b128 a[232:235], v1 offset:8192
    v_mfma_f32_16x16x32_bf16 v[52:55], a[228:231], a[112:115], v[52:55]
    s_add_u32 m0, s38, 2048
    ds_read_b128 a[228:231], v0 offset:8192
    v_cvt_pk_bf16_f32 v23, v66, v67
    v_mfma_f32_16x16x32_bf16 v[52:55], a[224:227], a[108:111], v[52:55]
    ds_read_b128 a[224:227], v1 offset:7168
    v_cvt_pk_bf16_f32 v28, v72, v73
    v_mfma_f32_16x16x32_bf16 v[48:51], a[236:239], v[16:19], v[44:47]
    buffer_load_dwordx4 v6, s[12:15], s59 offen nt lds
    v_mfma_f32_16x16x32_bf16 v[48:51], a[240:243], v[22:25], v[48:51]
    s_add_u32 m0, s38, 3072
    v_add_u32 v103, 6144, v103
    v_cvt_pk_bf16_f32 v34, v80, v81
    v_mfma_f32_16x16x32_bf16 v[48:51], a[244:247], v[28:31], v[48:51]
    buffer_load_dwordx4 v7, s[12:15], s59 offen nt lds
    v_mfma_f32_16x16x32_bf16 v[48:51], a[248:251], v[34:37], v[48:51]
    s_add_u32 s58, s33, 256
    s_add_u32 m0, s38, 4096
    s_waitcnt lgkmcnt(3)
    v_mfma_f32_16x16x32_bf16 v[56:59], a[212:215], a[96:99], 0
    buffer_load_dwordx4 v6, s[12:15], s58 offen nt lds
    v_mfma_f32_16x16x32_bf16 v[56:59], a[216:219], a[100:103], v[56:59]
    s_nop 1
    v_cmp_lt_f32 vcc, s29, v48
    v_mfma_f32_16x16x32_bf16 v[56:59], a[220:223], a[104:107], v[56:59]
    s_add_u32 m0, s38, 5120
    v_mfma_f32_16x16x32_bf16 v[64:67], a[220:223], a[128:131], 0
    buffer_load_dwordx4 v7, s[12:15], s58 offen nt lds
    v_mfma_f32_16x16x32_bf16 v[64:67], a[216:219], a[124:127], v[64:67]
    s_cbranch_vccnz L_rs_start4b
L_ret_start4b:
    v_fma_f32 v60, v60, s28, v10
    v_mfma_f32_16x16x32_bf16 v[64:67], a[212:215], a[120:123], v[64:67]
    s_waitcnt vmcnt(15) lgkmcnt(0)
    s_add_u32 m0, s22, 0
    v_fma_f32 v61, v61, s28, v10
    v_mfma_f32_16x16x32_bf16 v[72:75], a[212:215], a[144:147], 0
    s_barrier
    v_mfma_f32_16x16x32_bf16 v[72:75], a[216:219], a[148:151], v[72:75]
    buffer_load_dwordx4 v6, s[4:7], s20 offen lds
    v_mfma_f32_16x16x32_bf16 v[72:75], a[220:223], a[152:155], v[72:75]
    v_fma_f32 v52, v52, s28, v9
    v_mfma_f32_16x16x32_bf16 v[80:83], a[220:223], a[176:179], 0
    s_add_u32 s20, s20, 128
    v_exp_f32 v61, v61
    v_mfma_f32_16x16x32_bf16 v[80:83], a[216:219], a[172:175], v[80:83]
    s_add_u32 m0, s22, 1024
    v_exp_f32 v52, v52
    v_mfma_f32_16x16x32_bf16 v[80:83], a[212:215], a[168:171], v[80:83]
    buffer_load_dwordx4 v6, s[4:7], s20 offen lds
    v_mfma_f32_16x16x32_bf16 v[80:83], a[224:227], a[180:183], v[80:83]
    ds_read_b64_tr_b16 a[212:213], v2 offset:18432
    v_fma_f32 v55, v55, s28, v9
    v_mfma_f32_16x16x32_bf16 v[80:83], a[228:231], a[184:187], v[80:83]
    s_add_u32 s20, s20, 128
    ds_read_b64_tr_b16 a[214:215], v2 offset:12288
    v_fma_f32 v54, v54, s28, v9
    v_mfma_f32_16x16x32_bf16 v[80:83], a[232:235], a[188:191], v[80:83]
    ds_read_b64_tr_b16 a[216:217], v3 offset:18432
    v_fma_f32 v53, v53, s28, v9
    v_mfma_f32_16x16x32_bf16 v[72:75], a[232:235], a[164:167], v[72:75]
    s_add_u32 m0, s22, 2048
    v_exp_f32 v53, v53
    v_mfma_f32_16x16x32_bf16 v[72:75], a[228:231], a[160:163], v[72:75]
    buffer_load_dwordx4 v6, s[4:7], s20 offen lds
    v_mfma_f32_16x16x32_bf16 v[72:75], a[224:227], a[156:159], v[72:75]
    v_exp_f32 v60, v60
    v_mfma_f32_16x16x32_bf16 v[64:67], a[224:227], a[132:135], v[64:67]
    v_exp_f32 v54, v54
    v_mfma_f32_16x16x32_bf16 v[64:67], a[228:231], a[136:139], v[64:67]
    ds_read_b64_tr_b16 a[218:219], v3 offset:12288
    v_cvt_pk_bf16_f32 v20, v60, v61
    v_mfma_f32_16x16x32_bf16 v[64:67], a[232:235], a[140:143], v[64:67]
    v_exp_f32 v55, v55
    v_mfma_f32_16x16x32_bf16 v[56:59], a[232:235], a[116:119], v[56:59]
    ds_read_b64_tr_b16 a[220:221], v4 offset:18432
    v_cvt_pk_bf16_f32 v14, v52, v53
    v_mfma_f32_16x16x32_bf16 v[56:59], a[228:231], a[112:115], v[56:59]
    s_add_u32 s20, s20, 12032
    ds_read_b64_tr_b16 a[222:223], v4 offset:12288
    v_cvt_pk_bf16_f32 v15, v54, v55
    v_mfma_f32_16x16x32_bf16 v[56:59], a[224:227], a[108:111], v[56:59]
    s_waitcnt lgkmcnt(4)
    ds_read_b64_tr_b16 a[224:225], v5 offset:18432
    ds_read_b64_tr_b16 a[226:227], v5 offset:12288
    s_branch L_loop4w0
    .p2align 6
L_loop5w0:
    v_mfma_f32_16x16x32_bf16 v[112:115], a[212:215], v[16:19], v[112:115]
    ds_read_b128 v[96:99], v103 offset:0
    v_mfma_f32_16x16x32_bf16 v[116:119], a[216:219], v[16:19], v[116:119]
    ds_read_b64_tr_b16 a[228:229], v2 offset:19456
    v_fma_f32 v73, v73, s28, v11
    v_mfma_f32_16x16x32_bf16 v[164:167], a[216:219], v[22:25], v[164:167]
    ds_read_b64_tr_b16 a[234:235], v3 offset:13312
    v_fma_f32 v84, v84, s28, v13
    v_mfma_f32_16x16x32_bf16 v[160:163], a[212:215], v[22:25], v[160:163]
    ds_read_b64_tr_b16 a[232:233], v3 offset:19456
    v_fma_f32 v85, v85, s28, v13
    v_mfma_f32_16x16x32_bf16 v[208:211], a[212:215], v[28:31], v[208:211]
    v_fma_f32 v65, v65, s28, v10
    v_fma_f32 v72, v72, s28, v11
    v_mfma_f32_16x16x32_bf16 v[212:215], a[216:219], v[28:31], v[212:215]
    v_fma_f32 v91, v91, s28, v13
    v_fma_f32 v59, v59, s28, v9
    v_mfma_f32_16x16x32_bf16 a[4:7], a[216:219], v[34:37], a[4:7]
    ds_read_b64_tr_b16 a[230:231], v2 offset:13312
    v_fma_f32 v71, v71, s28, v11
    v_mfma_f32_16x16x32_bf16 a[0:3], a[212:215], v[34:37], a[0:3]
    s_add_u32 s39, s39, 12288
    v_fma_f32 v86, v86, s28, v13
    v_mfma_f32_16x16x32_bf16 a[48:51], a[212:215], v[40:43], a[48:51]
    v_fma_f32 v69, v69, s28, v11
    v_fma_f32 v67, v67, s28, v10
    v_mfma_f32_16x16x32_bf16 a[52:55], a[216:219], v[40:43], a[52:55]
    s_add_u32 m0, s23, 0
    v_fma_f32 v87, v87, s28, v13
    v_fma_f32 v56, v56, s28, v9
    s_waitcnt lgkmcnt(4)
    v_mfma_f32_16x16x32_bf16 a[56:59], a[220:223], v[40:43], a[56:59]
    buffer_store_dwordx4 v[96:99], v6, s[16:19], s24 offen offset:0 nt
    ds_read_b64_tr_b16 a[214:215], v4 offset:13312
    v_exp_f32 v71, v71
    v_mfma_f32_16x16x32_bf16 a[60:63], a[224:227], v[40:43], a[60:63]
    v_exp_f32 v85, v85
    v_mfma_f32_16x16x32_bf16 a[12:15], a[224:227], v[34:37], a[12:15]
    v_fma_f32 v58, v58, s28, v9
    v_fma_f32 v83, v83, s28, v12
    v_mfma_f32_16x16x32_bf16 a[8:11], a[220:223], v[34:37], a[8:11]
    ds_read_b64_tr_b16 a[216:217], v5 offset:19456
    ds_read_b64_tr_b16 a[212:213], v4 offset:19456
    v_mfma_f32_16x16x32_bf16 v[216:219], a[220:223], v[28:31], v[216:219]
    v_fma_f32 v89, v89, s28, v13
    v_mfma_f32_16x16x32_bf16 v[220:223], a[224:227], v[28:31], v[220:223]
    v_fma_f32 v70, v70, s28, v11
    v_fma_f32 v57, v57, s28, v9
    v_mfma_f32_16x16x32_bf16 v[172:175], a[224:227], v[22:25], v[172:175]
    buffer_load_dwordx4 v6, s[12:15], s25 offen nt lds
    v_mfma_f32_16x16x32_bf16 v[168:171], a[220:223], v[22:25], v[168:171]
    v_fma_f32 v68, v68, s28, v11
    v_fma_f32 v79, v79, s28, v12
    v_mfma_f32_16x16x32_bf16 v[120:123], a[220:223], v[16:19], v[120:123]
    v_exp_f32 v70, v70
    v_mfma_f32_16x16x32_bf16 v[124:127], a[224:227], v[16:19], v[124:127]
    s_waitcnt lgkmcnt(3)
    ds_read_b64_tr_b16 a[218:219], v5 offset:13312
    ds_read_b64_tr_b16 a[220:221], v2 offset:20480
    v_mfma_f32_16x16x32_bf16 v[128:131], a[228:231], v[16:19], v[128:131]
    ds_read_b64_tr_b16 a[222:223], v2 offset:14336
    v_fma_f32 v66, v66, s28, v10
    v_mfma_f32_16x16x32_bf16 v[132:135], a[232:235], v[16:19], v[132:135]
    v_fma_f32 v82, v82, s28, v12
    v_fma_f32 v74, v74, s28, v11
    v_mfma_f32_16x16x32_bf16 v[180:183], a[232:235], v[22:25], v[180:183]
    ds_read_b64_tr_b16 a[226:227], v3 offset:14336
    ds_read_b64_tr_b16 a[224:225], v3 offset:20480
    v_mfma_f32_16x16x32_bf16 v[176:179], a[228:231], v[22:25], v[176:179]
    v_mfma_f32_16x16x32_bf16 v[224:227], a[228:231], v[28:31], v[224:227]
    v_exp_f32 v87, v87
    v_mfma_f32_16x16x32_bf16 v[228:231], a[232:235], v[28:31], v[228:231]
    v_mfma_f32_16x16x32_bf16 a[20:23], a[232:235], v[34:37], a[20:23]
    v_exp_f32 v89, v89
    v_mfma_f32_16x16x32_bf16 a[16:19], a[228:231], v[34:37], a[16:19]
    v_fma_f32 v81, v81, s28, v12
    v_fma_f32 v80, v80, s28, v12
    v_mfma_f32_16x16x32_bf16 a[64:67], a[228:231], v[40:43], a[64:67]
    v_exp_f32 v83, v83
    v_mfma_f32_16x16x32_bf16 a[68:71], a[232:235], v[40:43], a[68:71]
    s_waitcnt lgkmcnt(3)
    ds_read_b64_tr_b16 a[232:233], v5 offset:20480
    v_fma_f32 v77, v77, s28, v12
    v_mfma_f32_16x16x32_bf16 a[72:75], a[212:215], v[40:43], a[72:75]
    v_fma_f32 v64, v64, s28, v10
    v_mfma_f32_16x16x32_bf16 a[76:79], a[216:219], v[40:43], a[76:79]
    v_exp_f32 v57, v57
    v_mfma_f32_16x16x32_bf16 a[28:31], a[216:219], v[34:37], a[28:31]
    ds_read_b64_tr_b16 a[228:229], v4 offset:20480
    v_fma_f32 v76, v76, s28, v12
    v_mfma_f32_16x16x32_bf16 a[24:27], a[212:215], v[34:37], a[24:27]
    ds_read_b64_tr_b16 a[234:235], v5 offset:14336
    v_fma_f32 v78, v78, s28, v12
    v_mfma_f32_16x16x32_bf16 v[232:235], a[212:215], v[28:31], v[232:235]
    v_exp_f32 v67, v67
    v_mfma_f32_16x16x32_bf16 v[236:239], a[216:219], v[28:31], v[236:239]
    v_exp_f32 v84, v84
    v_mfma_f32_16x16x32_bf16 v[188:191], a[216:219], v[22:25], v[188:191]
    ds_read_b64_tr_b16 a[230:231], v4 offset:14336
    v_fma_f32 v88, v88, s28, v13
    v_mfma_f32_16x16x32_bf16 v[184:187], a[212:215], v[22:25], v[184:187]
    v_exp_f32 v66, v66
    v_mfma_f32_16x16x32_bf16 v[136:139], a[212:215], v[16:19], v[136:139]
    v_exp_f32 v86, v86
    v_mfma_f32_16x16x32_bf16 v[140:143], a[216:219], v[16:19], v[140:143]
    s_waitcnt lgkmcnt(3)
    ds_read_b128 v[96:99], v103 offset:1024
    v_mfma_f32_16x16x32_bf16 v[144:147], a[220:223], v[16:19], v[144:147]
    v_exp_f32 v69, v69
    v_mfma_f32_16x16x32_bf16 v[148:151], a[224:227], v[16:19], v[148:151]
    v_exp_f32 v77, v77
    v_mfma_f32_16x16x32_bf16 v[196:199], a[224:227], v[22:25], v[196:199]
    v_exp_f32 v73, v73
    v_mfma_f32_16x16x32_bf16 v[192:195], a[220:223], v[22:25], v[192:195]
    v_mfma_f32_16x16x32_bf16 v[240:243], a[220:223], v[28:31], v[240:243]
    v_exp_f32 v65, v65
    v_mfma_f32_16x16x32_bf16 v[244:247], a[224:227], v[28:31], v[244:247]
    v_exp_f32 v68, v68
    v_mfma_f32_16x16x32_bf16 a[36:39], a[224:227], v[34:37], a[36:39]
    v_exp_f32 v59, v59
    v_mfma_f32_16x16x32_bf16 a[32:35], a[220:223], v[34:37], a[32:35]
    s_waitcnt vmcnt(12) lgkmcnt(1)
    v_exp_f32 v72, v72
    v_mfma_f32_16x16x32_bf16 a[80:83], a[220:223], v[40:43], a[80:83]
    v_fma_f32 v75, v75, s28, v11
    v_cvt_pk_bf16_f32 v26, v68, v69
    v_mfma_f32_16x16x32_bf16 a[84:87], a[224:227], v[40:43], a[84:87]
    s_barrier
    ds_read_b128 a[212:215], v0 offset:12288
    v_mfma_f32_16x16x32_bf16 a[88:91], a[228:231], v[40:43], a[88:91]
    ds_read_b128 a[216:219], v1 offset:12288
    v_cvt_pk_bf16_f32 v27, v70, v71
    v_mfma_f32_16x16x32_bf16 a[92:95], a[232:235], v[40:43], a[92:95]
    ds_read_b128 a[220:223], v0 offset:13312
    s_add_u32 m0, s22, 36864
    v_mfma_f32_16x16x32_bf16 a[44:47], a[232:235], v[34:37], a[44:47]
    buffer_load_dwordx4 v6, s[8:11], s21 offen lds
    v_mfma_f32_16x16x32_bf16 a[40:43], a[228:231], v[34:37], a[40:43]
    s_add_u32 s21, s21, 128
    s_add_u32 m0, s22, 37888
    v_cvt_pk_bf16_f32 v38, v84, v85
    v_mfma_f32_16x16x32_bf16 v[248:251], a[228:231], v[28:31], v[248:251]
    buffer_load_dwordx4 v6, s[8:11], s21 offen lds
    v_mfma_f32_16x16x32_bf16 v[252:255], a[232:235], v[28:31], v[252:255]
    s_add_u32 s21, s21, 128
    v_exp_f32 v79, v79
    v_mfma_f32_16x16x32_bf16 v[204:207], a[232:235], v[22:25], v[204:207]
    ds_read_b128 a[224:227], v1 offset:13312
    v_cvt_pk_bf16_f32 v39, v86, v87
    v_mfma_f32_16x16x32_bf16 v[200:203], a[228:231], v[22:25], v[200:203]
    s_add_u32 m0, s22, 38912
    v_exp_f32 v58, v58
    v_mfma_f32_16x16x32_bf16 v[152:155], a[228:231], v[16:19], v[152:155]
    buffer_load_dwordx4 v6, s[8:11], s21 offen lds
    v_mfma_f32_16x16x32_bf16 v[156:159], a[232:235], v[16:19], v[156:159]
    s_waitcnt lgkmcnt(3)
    ds_read_b128 a[232:235], v1 offset:14336
    v_fma_f32 v90, v90, s28, v13
    v_mfma_f32_16x16x32_bf16 v[52:55], a[212:215], a[96:99], 0
    s_waitcnt lgkmcnt(3)
    v_exp_f32 v78, v78
    v_mfma_f32_16x16x32_bf16 v[52:55], a[216:219], a[100:103], v[52:55]
    s_waitcnt lgkmcnt(2)
    v_exp_f32 v76, v76
    v_mfma_f32_16x16x32_bf16 v[52:55], a[220:223], a[104:107], v[52:55]
    v_exp_f32 v91, v91
    v_mfma_f32_16x16x32_bf16 v[60:63], a[220:223], a[128:131], 0
    v_exp_f32 v64, v64
    v_mfma_f32_16x16x32_bf16 v[60:63], a[216:219], a[124:127], v[60:63]
    s_add_u32 s21, s21, 12032
    s_add_u32 m0, s23, 1024
    ds_read_b128 a[228:231], v0 offset:14336
    v_mfma_f32_16x16x32_bf16 v[60:63], a[212:215], a[120:123], v[60:63]
    v_exp_f32 v56, v56
    v_mfma_f32_16x16x32_bf16 v[68:71], a[212:215], a[144:147], 0
    v_exp_f32 v90, v90
    v_mfma_f32_16x16x32_bf16 v[68:71], a[216:219], a[148:151], v[68:71]
    buffer_store_dwordx4 v[96:99], v7, s[16:19], s24 offen offset:0 nt
    v_cvt_pk_bf16_f32 v32, v76, v77
    v_cvt_pk_bf16_f32 v33, v78, v79
    v_mfma_f32_16x16x32_bf16 v[68:71], a[220:223], a[152:155], v[68:71]
    v_exp_f32 v81, v81
    v_mfma_f32_16x16x32_bf16 v[76:79], a[220:223], a[176:179], 0
    v_exp_f32 v74, v74
    v_mfma_f32_16x16x32_bf16 v[76:79], a[216:219], a[172:175], v[76:79]
    v_exp_f32 v80, v80
    v_mfma_f32_16x16x32_bf16 v[76:79], a[212:215], a[168:171], v[76:79]
    v_cvt_pk_bf16_f32 v16, v56, v57
    v_cvt_pk_bf16_f32 v23, v66, v67
    v_mfma_f32_16x16x32_bf16 v[84:87], a[212:215], a[192:195], 0
    v_cvt_pk_bf16_f32 v22, v64, v65
    v_mfma_f32_16x16x32_bf16 v[84:87], a[216:219], a[196:199], v[84:87]
    v_mfma_f32_16x16x32_bf16 v[84:87], a[220:223], a[200:203], v[84:87]
    s_waitcnt lgkmcnt(0)
    ds_read_b128 a[212:215], v0 offset:18432
    v_mfma_f32_16x16x32_bf16 v[84:87], a[224:227], a[204:207], v[84:87]
    v_cvt_pk_bf16_f32 v17, v58, v59
    v_mfma_f32_16x16x32_bf16 v[84:87], a[228:231], a[208:211], v[84:87]
    v_cvt_pk_bf16_f32 v34, v80, v81
    v_mfma_f32_16x16x32_bf16 v[84:87], a[232:235], v[92:95], v[84:87]
    buffer_load_dwordx4 v7, s[12:15], s25 offen nt lds
    v_mfma_f32_16x16x32_bf16 v[76:79], a[232:235], a[188:191], v[76:79]
    v_exp_f32 v75, v75
    v_mfma_f32_16x16x32_bf16 v[76:79], a[228:231], a[184:187], v[76:79]
    v_exp_f32 v82, v82
    v_mfma_f32_16x16x32_bf16 v[76:79], a[224:227], a[180:183], v[76:79]
    ds_read_b128 a[216:219], v1 offset:18432
    s_bitcmp1_b32 s27, 0
    v_mfma_f32_16x16x32_bf16 v[68:71], a[224:227], a[156:159], v[68:71]
    v_exp_f32 v88, v88
    v_mfma_f32_16x16x32_bf16 v[68:71], a[228:231], a[160:163], v[68:71]
    v_cvt_pk_bf16_f32 v28, v72, v73
    v_mfma_f32_16x16x32_bf16 v[68:71], a[232:235], a[164:167], v[68:71]
    v_cvt_pk_bf16_f32 v29, v74, v75
    v_mfma_f32_16x16x32_bf16 v[44:47], a[236:239], v[14:17], v[48:51]
    ds_read_b128 a[220:223], v0 offset:19456
    v_mfma_f32_16x16x32_bf16 v[60:63], a[232:235], a[140:143], v[60:63]
    v_cvt_pk_bf16_f32 v41, v90, v91
    v_mfma_f32_16x16x32_bf16 v[60:63], a[228:231], a[136:139], v[60:63]
    s_cselect_b32 s26, s49, 128
    ds_read_b128 v[96:99], v103 offset:2048
    v_cvt_pk_bf16_f32 v40, v88, v89
    v_mfma_f32_16x16x32_bf16 v[60:63], a[224:227], a[132:135], v[60:63]
    v_mfma_f32_16x16x32_bf16 v[52:55], a[224:227], a[108:111], v[52:55]
    ds_read_b128 a[224:227], v1 offset:19456
    v_mfma_f32_16x16x32_bf16 v[52:55], a[228:231], a[112:115], v[52:55]
    v_mfma_f32_16x16x32_bf16 v[52:55], a[232:235], a[116:119], v[52:55]
    v_cvt_pk_bf16_f32 v35, v82, v83
    v_mfma_f32_16x16x32_bf16 v[44:47], a[240:243], v[20:23], v[44:47]
    ds_read_b128 a[232:235], v1 offset:20480
    v_mfma_f32_16x16x32_bf16 v[44:47], a[244:247], v[26:29], v[44:47]
    ds_read_b128 a[228:231], v0 offset:20480
    v_mfma_f32_16x16x32_bf16 v[44:47], a[248:251], v[32:35], v[44:47]
    v_mfma_f32_16x16x32_bf16 v[44:47], a[252:255], v[38:41], v[44:47]
    s_lshr_b32 s27, s27, 1
    s_waitcnt lgkmcnt(4)
    v_mfma_f32_16x16x32_bf16 v[56:59], a[212:215], a[96:99], 0
    s_add_u32 s24, s24, s26
    v_mfma_f32_16x16x32_bf16 v[56:59], a[216:219], a[100:103], v[56:59]
    v_mfma_f32_16x16x32_bf16 v[56:59], a[220:223], a[104:107], v[56:59]
    s_nop 1
    v_cmp_lt_f32 vcc, s29, v44
    v_mfma_f32_16x16x32_bf16 v[64:67], a[220:223], a[128:131], 0
    s_add_u32 s25, s25, s26
    v_mfma_f32_16x16x32_bf16 v[64:67], a[216:219], a[124:127], v[64:67]
    v_mfma_f32_16x16x32_bf16 v[64:67], a[212:215], a[120:123], v[64:67]
    s_nop 0
    s_cbranch_vccnz L_rs_loop5w0a
L_ret_loop5w0a:
    v_mfma_f32_16x16x32_bf16 v[72:75], a[212:215], a[144:147], 0
    v_mfma_f32_16x16x32_bf16 v[72:75], a[216:219], a[148:151], v[72:75]
    s_waitcnt vmcnt(12) lgkmcnt(0)
    v_mfma_f32_16x16x32_bf16 v[72:75], a[220:223], a[152:155], v[72:75]
    v_fma_f32 v87, v87, s28, v13
    s_add_u32 m0, s22, 12288
    v_mfma_f32_16x16x32_bf16 v[80:83], a[220:223], a[176:179], 0
    s_barrier
    v_mfma_f32_16x16x32_bf16 v[80:83], a[216:219], a[172:175], v[80:83]
    buffer_load_dwordx4 v6, s[4:7], s20 offen lds
    v_mfma_f32_16x16x32_bf16 v[80:83], a[212:215], a[168:171], v[80:83]
    s_add_u32 s20, s20, 128
    v_fma_f32 v84, v84, s28, v13
    s_add_u32 m0, s22, 13312
    v_mfma_f32_16x16x32_bf16 v[88:91], a[212:215], a[192:195], 0
    buffer_load_dwordx4 v6, s[4:7], s20 offen lds
    v_mfma_f32_16x16x32_bf16 v[88:91], a[216:219], a[196:199], v[88:91]
    ds_read_b64_tr_b16 a[212:213], v2 offset:0
    ds_read_b64_tr_b16 a[214:215], v2 offset:6144
    v_mfma_f32_16x16x32_bf16 v[88:91], a[220:223], a[200:203], v[88:91]
    s_add_u32 s20, s20, 128
    v_fma_f32 v76, v76, s28, v12
    v_fma_f32 v62, v62, s28, v10
    v_mfma_f32_16x16x32_bf16 v[88:91], a[224:227], a[204:207], v[88:91]
    v_fma_f32 v70, v70, s28, v11
    v_fma_f32 v52, v52, s28, v9
    v_mfma_f32_16x16x32_bf16 v[88:91], a[228:231], a[208:211], v[88:91]
    s_add_u32 m0, s22, 14336
    ds_read_b64_tr_b16 a[216:217], v3 offset:0
    v_fma_f32 v69, v69, s28, v11
    v_mfma_f32_16x16x32_bf16 v[88:91], a[232:235], v[92:95], v[88:91]
    buffer_load_dwordx4 v6, s[4:7], s20 offen lds
    v_mfma_f32_16x16x32_bf16 v[80:83], a[232:235], a[188:191], v[80:83]
    v_fma_f32 v63, v63, s28, v10
    v_mfma_f32_16x16x32_bf16 v[80:83], a[228:231], a[184:187], v[80:83]
    ds_read_b64_tr_b16 a[218:219], v3 offset:6144
    v_fma_f32 v55, v55, s28, v9
    v_mfma_f32_16x16x32_bf16 v[80:83], a[224:227], a[180:183], v[80:83]
    v_fma_f32 v79, v79, s28, v12
    v_fma_f32 v53, v53, s28, v9
    v_mfma_f32_16x16x32_bf16 v[72:75], a[224:227], a[156:159], v[72:75]
    v_exp_f32 v62, v62
    v_mfma_f32_16x16x32_bf16 v[72:75], a[228:231], a[160:163], v[72:75]
    ds_read_b64_tr_b16 a[220:221], v4 offset:0
    v_mfma_f32_16x16x32_bf16 v[72:75], a[232:235], a[164:167], v[72:75]
    v_fma_f32 v68, v68, s28, v11
    v_fma_f32 v83, v83, s28, v12
    v_mfma_f32_16x16x32_bf16 v[64:67], a[232:235], a[140:143], v[64:67]
    v_mfma_f32_16x16x32_bf16 v[64:67], a[228:231], a[136:139], v[64:67]
    s_add_u32 s20, s20, 12032
    v_exp_f32 v63, v63
    v_mfma_f32_16x16x32_bf16 v[64:67], a[224:227], a[132:135], v[64:67]
    ds_read_b64_tr_b16 a[222:223], v4 offset:6144
    v_mfma_f32_16x16x32_bf16 v[56:59], a[224:227], a[108:111], v[56:59]
    v_exp_f32 v52, v52
    v_mfma_f32_16x16x32_bf16 v[56:59], a[228:231], a[112:115], v[56:59]
    v_exp_f32 v76, v76
    v_mfma_f32_16x16x32_bf16 v[56:59], a[232:235], a[116:119], v[56:59]
    s_waitcnt lgkmcnt(2)
    ds_read_b64_tr_b16 a[232:233], v3 offset:1024
    ds_read_b64_tr_b16 a[230:231], v2 offset:7168
    v_mfma_f32_16x16x32_bf16 v[112:115], a[212:215], v[14:17], v[112:115]
    ds_read_b64_tr_b16 a[224:225], v5 offset:0
    v_fma_f32 v91, v91, s28, v13
    v_mfma_f32_16x16x32_bf16 v[116:119], a[216:219], v[14:17], v[116:119]
    ds_read_b64_tr_b16 a[226:227], v5 offset:6144
    v_fma_f32 v61, v61, s28, v10
    v_mfma_f32_16x16x32_bf16 v[164:167], a[216:219], v[20:23], v[164:167]
    buffer_store_dwordx4 v[96:99], v6, s[16:19], s24 offen offset:0 nt
    v_cvt_pk_bf16_f32 v25, v62, v63
    v_exp_f32 v55, v55
    v_mfma_f32_16x16x32_bf16 v[160:163], a[212:215], v[20:23], v[160:163]
    s_add_u32 s39, s39, 12288
    v_fma_f32 v64, v64, s28, v10
    v_mfma_f32_16x16x32_bf16 v[208:211], a[212:215], v[26:29], v[208:211]
    v_fma_f32 v75, v75, s28, v11
    s_add_u32 m0, s23, 2048
    v_mfma_f32_16x16x32_bf16 v[212:215], a[216:219], v[26:29], v[212:215]
    v_fma_f32 v54, v54, s28, v9
    v_fma_f32 v73, v73, s28, v11
    v_mfma_f32_16x16x32_bf16 a[4:7], a[216:219], v[32:35], a[4:7]
    v_exp_f32 v69, v69
    v_mfma_f32_16x16x32_bf16 a[0:3], a[212:215], v[32:35], a[0:3]
    v_fma_f32 v85, v85, s28, v13
    v_fma_f32 v60, v60, s28, v10
    v_mfma_f32_16x16x32_bf16 a[48:51], a[212:215], v[38:41], a[48:51]
    ds_read_b64_tr_b16 a[234:235], v3 offset:7168
    ds_read_b64_tr_b16 a[228:229], v2 offset:1024
    v_mfma_f32_16x16x32_bf16 a[52:55], a[216:219], v[38:41], a[52:55]
    s_waitcnt lgkmcnt(3)
    v_exp_f32 v68, v68
    v_mfma_f32_16x16x32_bf16 a[56:59], a[220:223], v[38:41], a[56:59]
    s_waitcnt lgkmcnt(2)
    ds_read_b64_tr_b16 a[212:213], v4 offset:1024
    ds_read_b64_tr_b16 a[218:219], v5 offset:7168
    v_mfma_f32_16x16x32_bf16 a[60:63], a[224:227], v[38:41], a[60:63]
    v_fma_f32 v78, v78, s28, v12
    v_fma_f32 v65, v65, s28, v10
    v_mfma_f32_16x16x32_bf16 a[12:15], a[224:227], v[32:35], a[12:15]
    v_fma_f32 v89, v89, s28, v13
    v_fma_f32 v56, v56, s28, v9
    v_mfma_f32_16x16x32_bf16 a[8:11], a[220:223], v[32:35], a[8:11]
    v_fma_f32 v67, v67, s28, v10
    v_fma_f32 v81, v81, s28, v12
    v_mfma_f32_16x16x32_bf16 v[216:219], a[220:223], v[26:29], v[216:219]
    v_exp_f32 v53, v53
    v_mfma_f32_16x16x32_bf16 v[220:223], a[224:227], v[26:29], v[220:223]
    buffer_load_dwordx4 v6, s[12:15], s25 offen nt lds
    v_mfma_f32_16x16x32_bf16 v[172:175], a[224:227], v[20:23], v[172:175]
    ds_read_b64_tr_b16 a[214:215], v4 offset:7168
    v_fma_f32 v77, v77, s28, v12
    v_mfma_f32_16x16x32_bf16 v[168:171], a[220:223], v[20:23], v[168:171]
    v_exp_f32 v79, v79
    v_mfma_f32_16x16x32_bf16 v[120:123], a[220:223], v[14:17], v[120:123]
    v_fma_f32 v58, v58, s28, v9
    v_fma_f32 v66, v66, s28, v10
    v_mfma_f32_16x16x32_bf16 v[124:127], a[224:227], v[14:17], v[124:127]
    s_waitcnt lgkmcnt(3)
    ds_read_b64_tr_b16 a[216:217], v5 offset:1024
    v_mfma_f32_16x16x32_bf16 v[128:131], a[228:231], v[14:17], v[128:131]
    ds_read_b64_tr_b16 a[224:225], v3 offset:2048
    ds_read_b64_tr_b16 a[220:221], v2 offset:2048
    v_mfma_f32_16x16x32_bf16 v[132:135], a[232:235], v[14:17], v[132:135]
    v_exp_f32 v85, v85
    v_mfma_f32_16x16x32_bf16 v[180:183], a[232:235], v[20:23], v[180:183]
    v_fma_f32 v71, v71, s28, v11
    v_mfma_f32_16x16x32_bf16 v[176:179], a[228:231], v[20:23], v[176:179]
    ds_read_b64_tr_b16 a[222:223], v2 offset:8192
    ds_read_b128 v[96:99], v103 offset:3072
    v_mfma_f32_16x16x32_bf16 v[224:227], a[228:231], v[26:29], v[224:227]
    ds_read_b64_tr_b16 a[226:227], v3 offset:8192
    v_fma_f32 v86, v86, s28, v13
    v_mfma_f32_16x16x32_bf16 v[228:231], a[232:235], v[26:29], v[228:231]
    v_exp_f32 v73, v73
    v_mfma_f32_16x16x32_bf16 a[20:23], a[232:235], v[32:35], a[20:23]
    v_cvt_pk_bf16_f32 v18, v52, v53
    v_fma_f32 v90, v90, s28, v13
    v_mfma_f32_16x16x32_bf16 a[16:19], a[228:231], v[32:35], a[16:19]
    v_exp_f32 v81, v81
    v_mfma_f32_16x16x32_bf16 a[64:67], a[228:231], v[38:41], a[64:67]
    v_exp_f32 v54, v54
    v_mfma_f32_16x16x32_bf16 a[68:71], a[232:235], v[38:41], a[68:71]
    s_waitcnt lgkmcnt(5)
    v_mfma_f32_16x16x32_bf16 a[72:75], a[212:215], v[38:41], a[72:75]
    v_exp_f32 v70, v70
    v_mfma_f32_16x16x32_bf16 a[76:79], a[216:219], v[38:41], a[76:79]
    ds_read_b64_tr_b16 a[228:229], v4 offset:2048
    v_mfma_f32_16x16x32_bf16 a[28:31], a[216:219], v[32:35], a[28:31]
    ds_read_b64_tr_b16 a[234:235], v5 offset:8192
    ds_read_b64_tr_b16 a[232:233], v5 offset:2048
    v_mfma_f32_16x16x32_bf16 a[24:27], a[212:215], v[32:35], a[24:27]
    ds_read_b64_tr_b16 a[230:231], v4 offset:8192
    v_cvt_pk_bf16_f32 v30, v68, v69
    v_mfma_f32_16x16x32_bf16 v[232:235], a[212:215], v[26:29], v[232:235]
    v_exp_f32 v61, v61
    v_mfma_f32_16x16x32_bf16 v[236:239], a[216:219], v[26:29], v[236:239]
    v_exp_f32 v84, v84
    v_mfma_f32_16x16x32_bf16 v[188:191], a[216:219], v[20:23], v[188:191]
    v_cvt_pk_bf16_f32 v42, v84, v85
    v_mfma_f32_16x16x32_bf16 v[184:187], a[212:215], v[20:23], v[184:187]
    v_fma_f32 v57, v57, s28, v9
    v_fma_f32 v80, v80, s28, v12
    v_mfma_f32_16x16x32_bf16 v[136:139], a[212:215], v[14:17], v[136:139]
    v_exp_f32 v80, v80
    v_mfma_f32_16x16x32_bf16 v[140:143], a[216:219], v[14:17], v[140:143]
    s_waitcnt lgkmcnt(4)
    v_exp_f32 v77, v77
    v_mfma_f32_16x16x32_bf16 v[144:147], a[220:223], v[14:17], v[144:147]
    v_exp_f32 v71, v71
    v_mfma_f32_16x16x32_bf16 v[148:151], a[224:227], v[14:17], v[148:151]
    v_exp_f32 v66, v66
    v_mfma_f32_16x16x32_bf16 v[196:199], a[224:227], v[20:23], v[196:199]
    v_exp_f32 v64, v64
    v_mfma_f32_16x16x32_bf16 v[192:195], a[220:223], v[20:23], v[192:195]
    s_waitcnt vmcnt(12) lgkmcnt(0)
    v_exp_f32 v65, v65
    v_mfma_f32_16x16x32_bf16 v[240:243], a[220:223], v[26:29], v[240:243]
    v_cvt_pk_bf16_f32 v31, v70, v71
    v_mfma_f32_16x16x32_bf16 v[244:247], a[224:227], v[26:29], v[244:247]
    s_add_u32 m0, s22, 24576
    v_exp_f32 v60, v60
    v_mfma_f32_16x16x32_bf16 a[36:39], a[224:227], v[32:35], a[36:39]
    v_exp_f32 v78, v78
    v_mfma_f32_16x16x32_bf16 a[32:35], a[220:223], v[32:35], a[32:35]
    v_exp_f32 v86, v86
    v_mfma_f32_16x16x32_bf16 a[80:83], a[220:223], v[38:41], a[80:83]
    v_exp_f32 v67, v67
    v_mfma_f32_16x16x32_bf16 a[84:87], a[224:227], v[38:41], a[84:87]
    s_barrier
    ds_read_b128 a[212:215], v0 offset:0
    v_mfma_f32_16x16x32_bf16 a[88:91], a[228:231], v[38:41], a[88:91]
    buffer_load_dwordx4 v6, s[8:11], s21 offen lds
    ds_read_b128 a[216:219], v1 offset:0
    v_mfma_f32_16x16x32_bf16 a[92:95], a[232:235], v[38:41], a[92:95]
    s_add_u32 s21, s21, 128
    ds_read_b128 a[220:223], v0 offset:1024
    s_add_u32 m0, s22, 25600
    v_mfma_f32_16x16x32_bf16 a[44:47], a[232:235], v[32:35], a[44:47]
    v_exp_f32 v87, v87
    v_mfma_f32_16x16x32_bf16 a[40:43], a[228:231], v[32:35], a[40:43]
    buffer_load_dwordx4 v6, s[8:11], s21 offen lds
    v_mfma_f32_16x16x32_bf16 v[248:251], a[228:231], v[26:29], v[248:251]
    s_add_u32 s21, s21, 128
    v_exp_f32 v56, v56
    v_mfma_f32_16x16x32_bf16 v[252:255], a[232:235], v[26:29], v[252:255]
    s_add_u32 m0, s22, 26624
    v_exp_f32 v83, v83
    v_mfma_f32_16x16x32_bf16 v[204:207], a[232:235], v[20:23], v[204:207]
    buffer_load_dwordx4 v6, s[8:11], s21 offen lds
    v_mfma_f32_16x16x32_bf16 v[200:203], a[228:231], v[20:23], v[200:203]
    s_add_u32 s21, s21, 12032
    ds_read_b128 a[224:227], v1 offset:1024
    v_fma_f32 v74, v74, s28, v11
    v_mfma_f32_16x16x32_bf16 v[152:155], a[228:231], v[14:17], v[152:155]
    v_cvt_pk_bf16_f32 v19, v54, v55
    v_cvt_pk_bf16_f32 v36, v76, v77
    v_mfma_f32_16x16x32_bf16 v[156:159], a[232:235], v[14:17], v[156:159]
    s_waitcnt lgkmcnt(3)
    v_fma_f32 v82, v82, s28, v12
    v_cvt_pk_bf16_f32 v43, v86, v87
    v_mfma_f32_16x16x32_bf16 v[52:55], a[212:215], a[96:99], 0
    s_waitcnt lgkmcnt(2)
    v_cvt_pk_bf16_f32 v24, v60, v61
    v_cvt_pk_bf16_f32 v37, v78, v79
    v_mfma_f32_16x16x32_bf16 v[52:55], a[216:219], a[100:103], v[52:55]
    s_waitcnt lgkmcnt(1)
    v_add_u32 v103, 4096, v103
    v_fma_f32 v72, v72, s28, v11
    v_mfma_f32_16x16x32_bf16 v[52:55], a[220:223], a[104:107], v[52:55]
    ds_read_b128 a[232:235], v1 offset:2048
    v_mfma_f32_16x16x32_bf16 v[60:63], a[220:223], a[128:131], 0
    v_exp_f32 v72, v72
    v_mfma_f32_16x16x32_bf16 v[60:63], a[216:219], a[124:127], v[60:63]
    ds_read_b128 a[228:231], v0 offset:2048
    v_mfma_f32_16x16x32_bf16 v[60:63], a[212:215], a[120:123], v[60:63]
    buffer_store_dwordx4 v[96:99], v7, s[16:19], s24 offen offset:0 nt
    v_cvt_pk_bf16_f32 v23, v66, v67
    v_fma_f32 v59, v59, s28, v9
    v_mfma_f32_16x16x32_bf16 v[68:71], a[212:215], a[144:147], 0
    v_exp_f32 v82, v82
    v_mfma_f32_16x16x32_bf16 v[68:71], a[216:219], a[148:151], v[68:71]
    v_cvt_pk_bf16_f32 v22, v64, v65
    v_mfma_f32_16x16x32_bf16 v[68:71], a[220:223], a[152:155], v[68:71]
    v_exp_f32 v57, v57
    v_mfma_f32_16x16x32_bf16 v[76:79], a[220:223], a[176:179], 0
    v_fma_f32 v88, v88, s28, v13
    v_cvt_pk_bf16_f32 v35, v82, v83
    v_mfma_f32_16x16x32_bf16 v[76:79], a[216:219], a[172:175], v[76:79]
    s_add_u32 m0, s23, 3072
    v_exp_f32 v91, v91
    v_mfma_f32_16x16x32_bf16 v[76:79], a[212:215], a[168:171], v[76:79]
    v_exp_f32 v90, v90
    v_mfma_f32_16x16x32_bf16 v[84:87], a[212:215], a[192:195], 0
    v_cvt_pk_bf16_f32 v28, v72, v73
    v_mfma_f32_16x16x32_bf16 v[84:87], a[216:219], a[196:199], v[84:87]
    v_exp_f32 v75, v75
    v_mfma_f32_16x16x32_bf16 v[84:87], a[220:223], a[200:203], v[84:87]
    s_waitcnt lgkmcnt(0)
    v_exp_f32 v58, v58
    v_mfma_f32_16x16x32_bf16 v[84:87], a[224:227], a[204:207], v[84:87]
    buffer_load_dwordx4 v7, s[12:15], s25 offen nt lds
    v_mfma_f32_16x16x32_bf16 v[84:87], a[228:231], a[208:211], v[84:87]
    v_exp_f32 v89, v89
    v_mfma_f32_16x16x32_bf16 v[84:87], a[232:235], v[92:95], v[84:87]
    v_exp_f32 v88, v88
    v_mfma_f32_16x16x32_bf16 v[76:79], a[232:235], a[188:191], v[76:79]
    v_mfma_f32_16x16x32_bf16 v[76:79], a[228:231], a[184:187], v[76:79]
    v_exp_f32 v74, v74
    v_mfma_f32_16x16x32_bf16 v[76:79], a[224:227], a[180:183], v[76:79]
    v_exp_f32 v59, v59
    v_mfma_f32_16x16x32_bf16 v[68:71], a[224:227], a[156:159], v[68:71]
    v_mfma_f32_16x16x32_bf16 v[68:71], a[228:231], a[160:163], v[68:71]
    ds_read_b128 a[212:215], v0 offset:6144
    v_cvt_pk_bf16_f32 v16, v56, v57
    v_mfma_f32_16x16x32_bf16 v[68:71], a[232:235], a[164:167], v[68:71]
    ds_read_b128 a[216:219], v1 offset:6144
    v_mfma_f32_16x16x32_bf16 v[60:63], a[232:235], a[140:143], v[60:63]
    ds_read_b128 a[220:223], v0 offset:7168
    v_cvt_pk_bf16_f32 v29, v74, v75
    v_mfma_f32_16x16x32_bf16 v[60:63], a[228:231], a[136:139], v[60:63]
    v_mfma_f32_16x16x32_bf16 v[60:63], a[224:227], a[132:135], v[60:63]
    v_cvt_pk_bf16_f32 v17, v58, v59
    v_cvt_pk_bf16_f32 v40, v88, v89
    v_mfma_f32_16x16x32_bf16 v[52:55], a[224:227], a[108:111], v[52:55]
    v_cvt_pk_bf16_f32 v41, v90, v91
    v_mfma_f32_16x16x32_bf16 v[52:55], a[228:231], a[112:115], v[52:55]
    ds_read_b128 a[228:231], v0 offset:8192
    v_cvt_pk_bf16_f32 v34, v80, v81
    v_mfma_f32_16x16x32_bf16 v[48:51], a[236:239], v[16:19], v[44:47]
    ds_read_b128 a[224:227], v1 offset:7168
    v_mfma_f32_16x16x32_bf16 v[52:55], a[232:235], a[116:119], v[52:55]
    ds_read_b128 a[232:235], v1 offset:8192
    v_mfma_f32_16x16x32_bf16 v[48:51], a[240:243], v[22:25], v[48:51]
    v_mfma_f32_16x16x32_bf16 v[48:51], a[244:247], v[28:31], v[48:51]
    v_mfma_f32_16x16x32_bf16 v[48:51], a[248:251], v[34:37], v[48:51]
    s_bitcmp1_b32 s27, 0
    v_mfma_f32_16x16x32_bf16 v[48:51], a[252:255], v[40:43], v[48:51]
    s_cselect_b32 s26, s49, 128
    s_waitcnt lgkmcnt(3)
    v_mfma_f32_16x16x32_bf16 v[56:59], a[212:215], a[96:99], 0
    s_lshr_b32 s27, s27, 1
    s_add_u32 s24, s24, s26
    v_mfma_f32_16x16x32_bf16 v[56:59], a[216:219], a[100:103], v[56:59]
    s_nop 1
    v_cmp_lt_f32 vcc, s29, v48
    v_mfma_f32_16x16x32_bf16 v[56:59], a[220:223], a[104:107], v[56:59]
    s_add_u32 s25, s25, s26
    s_add_u32 s23, s23, 4096
    v_mfma_f32_16x16x32_bf16 v[64:67], a[220:223], a[128:131], 0
    s_nop 0
    s_cbranch_vccnz L_rs_loop5w0b
L_ret_loop5w0b:
    v_mfma_f32_16x16x32_bf16 v[64:67], a[216:219], a[124:127], v[64:67]
    v_fma_f32 v53, v53, s28, v9
    v_fma_f32 v52, v52, s28, v9
    v_mfma_f32_16x16x32_bf16 v[64:67], a[212:215], a[120:123], v[64:67]
    v_exp_f32 v52, v52
    v_mfma_f32_16x16x32_bf16 v[72:75], a[212:215], a[144:147], 0
    s_waitcnt vmcnt(12) lgkmcnt(0)
    v_exp_f32 v53, v53
    v_mfma_f32_16x16x32_bf16 v[72:75], a[216:219], a[148:151], v[72:75]
    s_cmp_eq_u32 s30, 5
    s_cselect_b32 s26, s62, 0
    v_fma_f32 v62, v62, s28, v10
    v_mfma_f32_16x16x32_bf16 v[72:75], a[220:223], a[152:155], v[72:75]
    s_add_u32 s20, s20, s26
    v_fma_f32 v55, v55, s28, v9
    s_add_u32 m0, s22, 0
    v_mfma_f32_16x16x32_bf16 v[80:83], a[220:223], a[176:179], 0
    s_barrier
    v_mfma_f32_16x16x32_bf16 v[80:83], a[216:219], a[172:175], v[80:83]
    buffer_load_dwordx4 v6, s[4:7], s20 offen lds
    v_mfma_f32_16x16x32_bf16 v[80:83], a[212:215], a[168:171], v[80:83]
    s_add_u32 s20, s20, 128
    s_add_u32 m0, s22, 1024
    v_mfma_f32_16x16x32_bf16 v[88:91], a[212:215], a[192:195], 0
    buffer_load_dwordx4 v6, s[4:7], s20 offen lds
    v_mfma_f32_16x16x32_bf16 v[88:91], a[216:219], a[196:199], v[88:91]
    s_add_u32 s20, s20, 128
    ds_read_b64_tr_b16 a[212:213], v2 offset:18432
    ds_read_b64_tr_b16 a[214:215], v2 offset:12288
    v_mfma_f32_16x16x32_bf16 v[88:91], a[220:223], a[200:203], v[88:91]
    s_add_u32 m0, s22, 2048
    ds_read_b64_tr_b16 a[216:217], v3 offset:18432
    v_mfma_f32_16x16x32_bf16 v[88:91], a[224:227], a[204:207], v[88:91]
    buffer_load_dwordx4 v6, s[4:7], s20 offen lds
    v_mfma_f32_16x16x32_bf16 v[88:91], a[228:231], a[208:211], v[88:91]
    ds_read_b64_tr_b16 a[218:219], v3 offset:12288
    v_fma_f32 v54, v54, s28, v9
    v_mfma_f32_16x16x32_bf16 v[88:91], a[232:235], v[92:95], v[88:91]
    v_fma_f32 v63, v63, s28, v10
    v_cvt_pk_bf16_f32 v14, v52, v53
    v_mfma_f32_16x16x32_bf16 v[80:83], a[232:235], a[188:191], v[80:83]
    ds_read_b64_tr_b16 a[220:221], v4 offset:18432
    ds_read_b64_tr_b16 a[222:223], v4 offset:12288
    v_mfma_f32_16x16x32_bf16 v[80:83], a[228:231], a[184:187], v[80:83]
    v_exp_f32 v62, v62
    v_mfma_f32_16x16x32_bf16 v[80:83], a[224:227], a[180:183], v[80:83]
    v_exp_f32 v54, v54
    v_mfma_f32_16x16x32_bf16 v[72:75], a[224:227], a[156:159], v[72:75]
    s_add_u32 s20, s20, 12032
    v_fma_f32 v61, v61, s28, v10
    v_fma_f32 v60, v60, s28, v10
    v_mfma_f32_16x16x32_bf16 v[72:75], a[228:231], a[160:163], v[72:75]
    v_exp_f32 v55, v55
    v_mfma_f32_16x16x32_bf16 v[72:75], a[232:235], a[164:167], v[72:75]
    v_exp_f32 v61, v61
    v_mfma_f32_16x16x32_bf16 v[64:67], a[232:235], a[140:143], v[64:67]
    v_exp_f32 v63, v63
    v_mfma_f32_16x16x32_bf16 v[64:67], a[228:231], a[136:139], v[64:67]
    s_add_u32 s30, s30, 1
    v_cvt_pk_bf16_f32 v15, v54, v55
    s_cmp_lt_u32 s30, 6
    v_mfma_f32_16x16x32_bf16 v[64:67], a[224:227], a[132:135], v[64:67]
    v_exp_f32 v60, v60
    v_mfma_f32_16x16x32_bf16 v[56:59], a[224:227], a[108:111], v[56:59]
    s_waitcnt lgkmcnt(2)
    ds_read_b64_tr_b16 a[224:225], v5 offset:18432
    v_cvt_pk_bf16_f32 v20, v60, v61
    v_mfma_f32_16x16x32_bf16 v[56:59], a[228:231], a[112:115], v[56:59]
    ds_read_b64_tr_b16 a[226:227], v5 offset:12288
    v_cvt_pk_bf16_f32 v21, v62, v63
    v_mfma_f32_16x16x32_bf16 v[56:59], a[232:235], a[116:119], v[56:59]
    s_cbranch_scc1 L_loop5w0
    s_cmp_ge_u32 s37, 6
    s_cbranch_scc1 L_end5
    s_cmp_eq_u32 s32, 0
    s_cbranch_scc1 L_tr54
    s_branch L_tr55
    .p2align 6
L_loop5w1:
    v_mfma_f32_16x16x32_bf16 v[112:115], a[212:215], v[16:19], v[112:115]
    ds_read_b128 v[96:99], v103 offset:0
    ds_read_b64_tr_b16 a[234:235], v3 offset:13312
    v_mfma_f32_16x16x32_bf16 v[116:119], a[216:219], v[16:19], v[116:119]
    v_fma_f32 v71, v71, s28, v11
    v_fma_f32 v82, v82, s28, v12
    v_fma_f32 v57, v57, s28, v9
    v_mfma_f32_16x16x32_bf16 v[164:167], a[216:219], v[22:25], v[164:167]
    v_fma_f32 v87, v87, s28, v13
    v_fma_f32 v73, v73, s28, v11
    v_mfma_f32_16x16x32_bf16 v[160:163], a[212:215], v[22:25], v[160:163]
    ds_read_b64_tr_b16 a[230:231], v2 offset:13312
    v_mfma_f32_16x16x32_bf16 v[208:211], a[212:215], v[28:31], v[208:211]
    v_fma_f32 v76, v76, s28, v12
    v_fma_f32 v80, v80, s28, v12
    v_mfma_f32_16x16x32_bf16 v[212:215], a[216:219], v[28:31], v[212:215]
    v_exp_f32 v71, v71
    v_mfma_f32_16x16x32_bf16 a[4:7], a[216:219], v[34:37], a[4:7]
    v_fma_f32 v65, v65, s28, v10
    v_mfma_f32_16x16x32_bf16 a[0:3], a[212:215], v[34:37], a[0:3]
    v_fma_f32 v77, v77, s28, v12
    v_fma_f32 v66, v66, s28, v10
    v_mfma_f32_16x16x32_bf16 a[48:51], a[212:215], v[40:43], a[48:51]
    ds_read_b64_tr_b16 a[228:229], v2 offset:19456
    v_mfma_f32_16x16x32_bf16 a[52:55], a[216:219], v[40:43], a[52:55]
    s_add_u32 s39, s39, 12288
    v_fma_f32 v58, v58, s28, v9
    s_waitcnt lgkmcnt(3)
    v_mfma_f32_16x16x32_bf16 a[56:59], a[220:223], v[40:43], a[56:59]
    buffer_store_dwordx4 v[96:99], v6, s[16:19], s24 offen offset:0 nt
    ds_read_b64_tr_b16 a[214:215], v4 offset:13312
    ds_read_b64_tr_b16 a[212:213], v4 offset:19456
    ds_read_b64_tr_b16 a[232:233], v3 offset:19456
    v_mfma_f32_16x16x32_bf16 a[60:63], a[224:227], v[40:43], a[60:63]
    v_fma_f32 v83, v83, s28, v12
    v_fma_f32 v85, v85, s28, v13
    v_mfma_f32_16x16x32_bf16 a[12:15], a[224:227], v[34:37], a[12:15]
    v_exp_f32 v77, v77
    v_mfma_f32_16x16x32_bf16 a[8:11], a[220:223], v[34:37], a[8:11]
    ds_read_b64_tr_b16 a[216:217], v5 offset:19456
    v_mfma_f32_16x16x32_bf16 v[216:219], a[220:223], v[28:31], v[216:219]
    v_fma_f32 v59, v59, s28, v9
    v_mfma_f32_16x16x32_bf16 v[220:223], a[224:227], v[28:31], v[220:223]
    v_fma_f32 v70, v70, s28, v11
    v_mfma_f32_16x16x32_bf16 v[172:175], a[224:227], v[22:25], v[172:175]
    s_add_u32 m0, s23, 0
    v_fma_f32 v69, v69, s28, v11
    v_mfma_f32_16x16x32_bf16 v[168:171], a[220:223], v[22:25], v[168:171]
    ds_read_b64_tr_b16 a[218:219], v5 offset:13312
    v_mfma_f32_16x16x32_bf16 v[120:123], a[220:223], v[16:19], v[120:123]
    buffer_load_dwordx4 v6, s[12:15], s25 offen nt lds
    v_mfma_f32_16x16x32_bf16 v[124:127], a[224:227], v[16:19], v[124:127]
    s_waitcnt lgkmcnt(5)
    v_fma_f32 v81, v81, s28, v12
    v_fma_f32 v84, v84, s28, v13
    v_mfma_f32_16x16x32_bf16 v[128:131], a[228:231], v[16:19], v[128:131]
    s_waitcnt lgkmcnt(2)
    v_fma_f32 v67, v67, s28, v10
    v_fma_f32 v56, v56, s28, v9
    v_mfma_f32_16x16x32_bf16 v[132:135], a[232:235], v[16:19], v[132:135]
    v_mfma_f32_16x16x32_bf16 v[180:183], a[232:235], v[22:25], v[180:183]
    ds_read_b64_tr_b16 a[226:227], v3 offset:14336
    ds_read_b64_tr_b16 a[220:221], v2 offset:20480
    v_mfma_f32_16x16x32_bf16 v[176:179], a[228:231], v[22:25], v[176:179]
    v_exp_f32 v82, v82
    v_mfma_f32_16x16x32_bf16 v[224:227], a[228:231], v[28:31], v[224:227]
    v_exp_f32 v69, v69
    v_mfma_f32_16x16x32_bf16 v[228:231], a[232:235], v[28:31], v[228:231]
    v_exp_f32 v56, v56
    v_mfma_f32_16x16x32_bf16 a[20:23], a[232:235], v[34:37], a[20:23]
    v_fma_f32 v68, v68, s28, v11
    v_fma_f32 v86, v86, s28, v13
    v_mfma_f32_16x16x32_bf16 a[16:19], a[228:231], v[34:37], a[16:19]
    v_fma_f32 v79, v79, s28, v12
    v_fma_f32 v78, v78, s28, v12
    v_mfma_f32_16x16x32_bf16 a[64:67], a[228:231], v[40:43], a[64:67]
    ds_read_b64_tr_b16 a[224:225], v3 offset:20480
    ds_read_b64_tr_b16 a[222:223], v2 offset:14336
    v_mfma_f32_16x16x32_bf16 a[68:71], a[232:235], v[40:43], a[68:71]
    ds_read_b64_tr_b16 a[234:235], v5 offset:14336
    v_fma_f32 v89, v89, s28, v13
    v_mfma_f32_16x16x32_bf16 a[72:75], a[212:215], v[40:43], a[72:75]
    s_waitcnt lgkmcnt(5)
    ds_read_b128 v[96:99], v103 offset:1024
    v_fma_f32 v91, v91, s28, v13
    v_mfma_f32_16x16x32_bf16 a[76:79], a[216:219], v[40:43], a[76:79]
    ds_read_b64_tr_b16 a[232:233], v5 offset:20480
    ds_read_b64_tr_b16 a[228:229], v4 offset:20480
    v_mfma_f32_16x16x32_bf16 a[28:31], a[216:219], v[34:37], a[28:31]
    ds_read_b64_tr_b16 a[230:231], v4 offset:14336
    v_mfma_f32_16x16x32_bf16 a[24:27], a[212:215], v[34:37], a[24:27]
    v_fma_f32 v90, v90, s28, v13
    v_mfma_f32_16x16x32_bf16 v[232:235], a[212:215], v[28:31], v[232:235]
    v_exp_f32 v70, v70
    v_mfma_f32_16x16x32_bf16 v[236:239], a[216:219], v[28:31], v[236:239]
    v_exp_f32 v81, v81
    v_mfma_f32_16x16x32_bf16 v[188:191], a[216:219], v[22:25], v[188:191]
    v_exp_f32 v91, v91
    v_mfma_f32_16x16x32_bf16 v[184:187], a[212:215], v[22:25], v[184:187]
    v_exp_f32 v84, v84
    v_mfma_f32_16x16x32_bf16 v[136:139], a[212:215], v[16:19], v[136:139]
    v_fma_f32 v88, v88, s28, v13
    v_fma_f32 v75, v75, s28, v11
    v_mfma_f32_16x16x32_bf16 v[140:143], a[216:219], v[16:19], v[140:143]
    s_waitcnt lgkmcnt(4)
    v_exp_f32 v86, v86
    v_mfma_f32_16x16x32_bf16 v[144:147], a[220:223], v[16:19], v[144:147]
    v_exp_f32 v85, v85
    v_mfma_f32_16x16x32_bf16 v[148:151], a[224:227], v[16:19], v[148:151]
    v_exp_f32 v68, v68
    v_mfma_f32_16x16x32_bf16 v[196:199], a[224:227], v[22:25], v[196:199]
    s_waitcnt vmcnt(12) lgkmcnt(0)
    v_fma_f32 v74, v74, s28, v11
    v_mfma_f32_16x16x32_bf16 v[192:195], a[220:223], v[22:25], v[192:195]
    v_exp_f32 v87, v87
    v_mfma_f32_16x16x32_bf16 v[240:243], a[220:223], v[28:31], v[240:243]
    v_exp_f32 v79, v79
    v_mfma_f32_16x16x32_bf16 v[244:247], a[224:227], v[28:31], v[244:247]
    s_barrier
    v_mfma_f32_16x16x32_bf16 a[36:39], a[224:227], v[34:37], a[36:39]
    v_exp_f32 v78, v78
    v_mfma_f32_16x16x32_bf16 a[32:35], a[220:223], v[34:37], a[32:35]
    v_exp_f32 v88, v88
    v_mfma_f32_16x16x32_bf16 a[80:83], a[220:223], v[40:43], a[80:83]
    ds_read_b128 a[212:215], v0 offset:12288
    v_cvt_pk_bf16_f32 v27, v70, v71
    v_mfma_f32_16x16x32_bf16 a[84:87], a[224:227], v[40:43], a[84:87]
    ds_read_b128 a[216:219], v1 offset:12288
    v_cvt_pk_bf16_f32 v38, v84, v85
    v_mfma_f32_16x16x32_bf16 a[88:91], a[228:231], v[40:43], a[88:91]
    s_add_u32 m0, s22, 36864
    ds_read_b128 a[220:223], v0 offset:13312
    v_fma_f32 v64, v64, s28, v10
    v_mfma_f32_16x16x32_bf16 a[92:95], a[232:235], v[40:43], a[92:95]
    buffer_load_dwordx4 v6, s[8:11], s21 offen lds
    v_mfma_f32_16x16x32_bf16 a[44:47], a[232:235], v[34:37], a[44:47]
    s_add_u32 s21, s21, 128
    v_exp_f32 v74, v74
    v_mfma_f32_16x16x32_bf16 a[40:43], a[228:231], v[34:37], a[40:43]
    v_exp_f32 v75, v75
    v_mfma_f32_16x16x32_bf16 v[248:251], a[228:231], v[28:31], v[248:251]
    s_add_u32 m0, s22, 37888
    v_exp_f32 v67, v67
    v_mfma_f32_16x16x32_bf16 v[252:255], a[232:235], v[28:31], v[252:255]
    buffer_load_dwordx4 v6, s[8:11], s21 offen lds
    v_mfma_f32_16x16x32_bf16 v[204:207], a[232:235], v[22:25], v[204:207]
    s_add_u32 s21, s21, 128
    v_exp_f32 v80, v80
    v_mfma_f32_16x16x32_bf16 v[200:203], a[228:231], v[22:25], v[200:203]
    v_cvt_pk_bf16_f32 v33, v78, v79
    s_add_u32 m0, s22, 38912
    v_mfma_f32_16x16x32_bf16 v[152:155], a[228:231], v[16:19], v[152:155]
    buffer_load_dwordx4 v6, s[8:11], s21 offen lds
    v_mfma_f32_16x16x32_bf16 v[156:159], a[232:235], v[16:19], v[156:159]
    s_waitcnt lgkmcnt(1)
    v_exp_f32 v76, v76
    v_mfma_f32_16x16x32_bf16 v[52:55], a[212:215], a[96:99], 0
    v_mfma_f32_16x16x32_bf16 v[52:55], a[216:219], a[100:103], v[52:55]
    s_waitcnt lgkmcnt(0)
    ds_read_b128 a[228:231], v0 offset:14336
    v_cvt_pk_bf16_f32 v26, v68, v69
    v_mfma_f32_16x16x32_bf16 v[52:55], a[220:223], a[104:107], v[52:55]
    v_exp_f32 v73, v73
    v_mfma_f32_16x16x32_bf16 v[60:63], a[220:223], a[128:131], 0
    v_cvt_pk_bf16_f32 v32, v76, v77
    s_add_u32 s21, s21, 12032
    v_mfma_f32_16x16x32_bf16 v[60:63], a[216:219], a[124:127], v[60:63]
    ds_read_b128 a[224:227], v1 offset:13312
    v_fma_f32 v72, v72, s28, v11
    v_mfma_f32_16x16x32_bf16 v[60:63], a[212:215], a[120:123], v[60:63]
    v_exp_f32 v58, v58
    v_mfma_f32_16x16x32_bf16 v[68:71], a[212:215], a[144:147], 0
    ds_read_b128 a[232:235], v1 offset:14336
    v_mfma_f32_16x16x32_bf16 v[68:71], a[216:219], a[148:151], v[68:71]
    buffer_store_dwordx4 v[96:99], v7, s[16:19], s24 offen offset:0 nt
    v_exp_f32 v64, v64
    v_mfma_f32_16x16x32_bf16 v[68:71], a[220:223], a[152:155], v[68:71]
    v_cvt_pk_bf16_f32 v39, v86, v87
    v_mfma_f32_16x16x32_bf16 v[76:79], a[220:223], a[176:179], 0
    v_exp_f32 v72, v72
    v_mfma_f32_16x16x32_bf16 v[76:79], a[216:219], a[172:175], v[76:79]
    v_exp_f32 v65, v65
    v_mfma_f32_16x16x32_bf16 v[76:79], a[212:215], a[168:171], v[76:79]
    v_exp_f32 v57, v57
    v_mfma_f32_16x16x32_bf16 v[84:87], a[212:215], a[192:195], 0
    s_add_u32 m0, s23, 1024
    ds_read_b128 a[212:215], v0 offset:18432
    v_mfma_f32_16x16x32_bf16 v[84:87], a[216:219], a[196:199], v[84:87]
    ds_read_b128 a[216:219], v1 offset:18432
    v_cvt_pk_bf16_f32 v16, v56, v57
    v_mfma_f32_16x16x32_bf16 v[84:87], a[220:223], a[200:203], v[84:87]
    s_waitcnt lgkmcnt(3)
    v_exp_f32 v83, v83
    v_mfma_f32_16x16x32_bf16 v[84:87], a[224:227], a[204:207], v[84:87]
    v_mfma_f32_16x16x32_bf16 v[84:87], a[228:231], a[208:211], v[84:87]
    s_waitcnt lgkmcnt(2)
    v_exp_f32 v90, v90
    v_mfma_f32_16x16x32_bf16 v[84:87], a[232:235], v[92:95], v[84:87]
    buffer_load_dwordx4 v7, s[12:15], s25 offen nt lds
    v_mfma_f32_16x16x32_bf16 v[76:79], a[232:235], a[188:191], v[76:79]
    v_exp_f32 v66, v66
    v_mfma_f32_16x16x32_bf16 v[76:79], a[228:231], a[184:187], v[76:79]
    v_mfma_f32_16x16x32_bf16 v[76:79], a[224:227], a[180:183], v[76:79]
    v_cvt_pk_bf16_f32 v34, v80, v81
    v_mfma_f32_16x16x32_bf16 v[68:71], a[224:227], a[156:159], v[68:71]
    ds_read_b128 a[220:223], v0 offset:19456
    v_mfma_f32_16x16x32_bf16 v[68:71], a[228:231], a[160:163], v[68:71]
    v_mfma_f32_16x16x32_bf16 v[68:71], a[232:235], a[164:167], v[68:71]
    v_mfma_f32_16x16x32_bf16 v[60:63], a[232:235], a[140:143], v[60:63]
    s_bitcmp1_b32 s27, 0
    v_cvt_pk_bf16_f32 v23, v66, v67
    v_mfma_f32_16x16x32_bf16 v[60:63], a[228:231], a[136:139], v[60:63]
    v_exp_f32 v89, v89
    v_mfma_f32_16x16x32_bf16 v[60:63], a[224:227], a[132:135], v[60:63]
    v_exp_f32 v59, v59
    v_mfma_f32_16x16x32_bf16 v[52:55], a[224:227], a[108:111], v[52:55]
    v_cvt_pk_bf16_f32 v41, v90, v91
    v_cvt_pk_bf16_f32 v29, v74, v75
    v_mfma_f32_16x16x32_bf16 v[52:55], a[228:231], a[112:115], v[52:55]
    v_cvt_pk_bf16_f32 v22, v64, v65
    v_cvt_pk_bf16_f32 v17, v58, v59
    v_mfma_f32_16x16x32_bf16 v[52:55], a[232:235], a[116:119], v[52:55]
    s_cselect_b32 s26, s49, 128
    ds_read_b128 a[228:231], v0 offset:20480
    ds_read_b128 a[224:227], v1 offset:19456
    v_mfma_f32_16x16x32_bf16 v[44:47], a[236:239], v[14:17], v[48:51]
    s_waitcnt lgkmcnt(3)
    ds_read_b128 a[232:235], v1 offset:20480
    v_cvt_pk_bf16_f32 v28, v72, v73
    v_mfma_f32_16x16x32_bf16 v[56:59], a[212:215], a[96:99], 0
    v_cvt_pk_bf16_f32 v40, v88, v89
    s_lshr_b32 s27, s27, 1
    v_mfma_f32_16x16x32_bf16 v[44:47], a[240:243], v[20:23], v[44:47]
    v_cvt_pk_bf16_f32 v35, v82, v83
    v_mfma_f32_16x16x32_bf16 v[44:47], a[244:247], v[26:29], v[44:47]
    s_nop 0
    v_mfma_f32_16x16x32_bf16 v[44:47], a[248:251], v[32:35], v[44:47]
    v_mfma_f32_16x16x32_bf16 v[44:47], a[252:255], v[38:41], v[44:47]
    v_mfma_f32_16x16x32_bf16 v[56:59], a[216:219], a[100:103], v[56:59]
    s_add_u32 s24, s24, s26
    s_waitcnt lgkmcnt(3)
    v_mfma_f32_16x16x32_bf16 v[56:59], a[220:223], a[104:107], v[56:59]
    ds_read_b128 v[96:99], v103 offset:2048
    v_mfma_f32_16x16x32_bf16 v[64:67], a[220:223], a[128:131], 0
    s_nop 1
    v_cmp_lt_f32 vcc, s29, v44
    v_mfma_f32_16x16x32_bf16 v[64:67], a[216:219], a[124:127], v[64:67]
    s_add_u32 s25, s25, s26
    s_waitcnt vmcnt(12) lgkmcnt(1)
    v_mfma_f32_16x16x32_bf16 v[64:67], a[212:215], a[120:123], v[64:67]
    s_barrier
    v_mfma_f32_16x16x32_bf16 v[72:75], a[212:215], a[144:147], 0
    s_cbranch_vccnz L_rs_loop5w1a
L_ret_loop5w1a:
    v_fma_f32 v54, v54, s28, v9
    v_mfma_f32_16x16x32_bf16 v[72:75], a[216:219], a[148:151], v[72:75]
    v_fma_f32 v61, v61, s28, v10
    v_fma_f32 v84, v84, s28, v13
    v_mfma_f32_16x16x32_bf16 v[72:75], a[220:223], a[152:155], v[72:75]
    s_add_u32 m0, s22, 12288
    v_fma_f32 v71, v71, s28, v11
    v_fma_f32 v77, v77, s28, v12
    v_mfma_f32_16x16x32_bf16 v[80:83], a[220:223], a[176:179], 0
    buffer_load_dwordx4 v6, s[4:7], s20 offen lds
    v_mfma_f32_16x16x32_bf16 v[80:83], a[216:219], a[172:175], v[80:83]
    v_exp_f32 v54, v54
    v_mfma_f32_16x16x32_bf16 v[80:83], a[212:215], a[168:171], v[80:83]
    s_add_u32 s20, s20, 128
    v_fma_f32 v85, v85, s28, v13
    v_mfma_f32_16x16x32_bf16 v[88:91], a[212:215], a[192:195], 0
    v_fma_f32 v62, v62, s28, v10
    v_mfma_f32_16x16x32_bf16 v[88:91], a[216:219], a[196:199], v[88:91]
    s_add_u32 m0, s22, 13312
    ds_read_b64_tr_b16 a[212:213], v2 offset:0
    ds_read_b64_tr_b16 a[214:215], v2 offset:6144
    v_mfma_f32_16x16x32_bf16 v[88:91], a[220:223], a[200:203], v[88:91]
    buffer_load_dwordx4 v6, s[4:7], s20 offen lds
    v_mfma_f32_16x16x32_bf16 v[88:91], a[224:227], a[204:207], v[88:91]
    v_fma_f32 v63, v63, s28, v10
    v_mfma_f32_16x16x32_bf16 v[88:91], a[228:231], a[208:211], v[88:91]
    s_add_u32 s20, s20, 128
    ds_read_b64_tr_b16 a[216:217], v3 offset:0
    s_add_u32 m0, s22, 14336
    v_mfma_f32_16x16x32_bf16 v[88:91], a[232:235], v[92:95], v[88:91]
    buffer_load_dwordx4 v6, s[4:7], s20 offen lds
    v_mfma_f32_16x16x32_bf16 v[80:83], a[232:235], a[188:191], v[80:83]
    v_fma_f32 v69, v69, s28, v11
    v_mfma_f32_16x16x32_bf16 v[80:83], a[228:231], a[184:187], v[80:83]
    ds_read_b64_tr_b16 a[218:219], v3 offset:6144
    v_fma_f32 v86, v86, s28, v13
    v_mfma_f32_16x16x32_bf16 v[80:83], a[224:227], a[180:183], v[80:83]
    v_exp_f32 v62, v62
    v_mfma_f32_16x16x32_bf16 v[72:75], a[224:227], a[156:159], v[72:75]
    v_fma_f32 v87, v87, s28, v13
    v_fma_f32 v70, v70, s28, v11
    v_mfma_f32_16x16x32_bf16 v[72:75], a[228:231], a[160:163], v[72:75]
    v_fma_f32 v79, v79, s28, v12
    v_fma_f32 v53, v53, s28, v9
    v_mfma_f32_16x16x32_bf16 v[72:75], a[232:235], a[164:167], v[72:75]
    v_exp_f32 v84, v84
    v_mfma_f32_16x16x32_bf16 v[64:67], a[232:235], a[140:143], v[64:67]
    ds_read_b64_tr_b16 a[220:221], v4 offset:0
    v_fma_f32 v83, v83, s28, v12
    v_mfma_f32_16x16x32_bf16 v[64:67], a[228:231], a[136:139], v[64:67]
    v_exp_f32 v69, v69
    v_mfma_f32_16x16x32_bf16 v[64:67], a[224:227], a[132:135], v[64:67]
    v_fma_f32 v88, v88, s28, v13
    v_fma_f32 v75, v75, s28, v11
    v_mfma_f32_16x16x32_bf16 v[56:59], a[224:227], a[108:111], v[56:59]
    v_fma_f32 v80, v80, s28, v12
    v_fma_f32 v60, v60, s28, v10
    v_mfma_f32_16x16x32_bf16 v[56:59], a[228:231], a[112:115], v[56:59]
    ds_read_b64_tr_b16 a[230:231], v2 offset:7168
    ds_read_b64_tr_b16 a[222:223], v4 offset:6144
    v_mfma_f32_16x16x32_bf16 v[56:59], a[232:235], a[116:119], v[56:59]
    s_waitcnt lgkmcnt(3)
    v_exp_f32 v63, v63
    v_mfma_f32_16x16x32_bf16 v[112:115], a[212:215], v[14:17], v[112:115]
    ds_read_b64_tr_b16 a[224:225], v5 offset:0
    ds_read_b64_tr_b16 a[226:227], v5 offset:6144
    v_mfma_f32_16x16x32_bf16 v[116:119], a[216:219], v[14:17], v[116:119]
    v_exp_f32 v77, v77
    v_mfma_f32_16x16x32_bf16 v[164:167], a[216:219], v[20:23], v[164:167]
    s_add_u32 s20, s20, 12032
    v_fma_f32 v76, v76, s28, v12
    v_fma_f32 v74, v74, s28, v11
    v_mfma_f32_16x16x32_bf16 v[160:163], a[212:215], v[20:23], v[160:163]
    v_fma_f32 v56, v56, s28, v9
    v_mfma_f32_16x16x32_bf16 v[208:211], a[212:215], v[26:29], v[208:211]
    ds_read_b64_tr_b16 a[232:233], v3 offset:1024
    v_fma_f32 v55, v55, s28, v9
    v_mfma_f32_16x16x32_bf16 v[212:215], a[216:219], v[26:29], v[212:215]
    buffer_store_dwordx4 v[96:99], v6, s[16:19], s24 offen offset:0 nt
    s_add_u32 s39, s39, 12288
    v_fma_f32 v82, v82, s28, v12
    v_exp_f32 v87, v87
    v_mfma_f32_16x16x32_bf16 a[4:7], a[216:219], v[32:35], a[4:7]
    v_cvt_pk_bf16_f32 v25, v62, v63
    v_fma_f32 v78, v78, s28, v12
    v_mfma_f32_16x16x32_bf16 a[0:3], a[212:215], v[32:35], a[0:3]
    ds_read_b64_tr_b16 a[234:235], v3 offset:7168
    v_fma_f32 v89, v89, s28, v13
    v_mfma_f32_16x16x32_bf16 a[48:51], a[212:215], v[38:41], a[48:51]
    ds_read_b64_tr_b16 a[228:229], v2 offset:1024
    v_mfma_f32_16x16x32_bf16 a[52:55], a[216:219], v[38:41], a[52:55]
    s_waitcnt lgkmcnt(3)
    ds_read_b64_tr_b16 a[212:213], v4 offset:1024
    v_fma_f32 v91, v91, s28, v13
    v_mfma_f32_16x16x32_bf16 a[56:59], a[220:223], v[38:41], a[56:59]
    v_fma_f32 v68, v68, s28, v11
    v_fma_f32 v66, v66, s28, v10
    v_mfma_f32_16x16x32_bf16 a[60:63], a[224:227], v[38:41], a[60:63]
    v_exp_f32 v70, v70
    v_mfma_f32_16x16x32_bf16 a[12:15], a[224:227], v[32:35], a[12:15]
    v_fma_f32 v65, v65, s28, v10
    v_mfma_f32_16x16x32_bf16 a[8:11], a[220:223], v[32:35], a[8:11]
    v_exp_f32 v76, v76
    v_mfma_f32_16x16x32_bf16 v[216:219], a[220:223], v[26:29], v[216:219]
    v_exp_f32 v68, v68
    v_mfma_f32_16x16x32_bf16 v[220:223], a[224:227], v[26:29], v[220:223]
    s_add_u32 m0, s23, 2048
    v_exp_f32 v53, v53
    v_mfma_f32_16x16x32_bf16 v[172:175], a[224:227], v[20:23], v[172:175]
    buffer_load_dwordx4 v6, s[12:15], s25 offen nt lds
    v_mfma_f32_16x16x32_bf16 v[168:171], a[220:223], v[20:23], v[168:171]
    v_exp_f32 v55, v55
    v_mfma_f32_16x16x32_bf16 v[120:123], a[220:223], v[14:17], v[120:123]
    ds_read_b64_tr_b16 a[214:215], v4 offset:7168
    v_fma_f32 v81, v81, s28, v12
    v_mfma_f32_16x16x32_bf16 v[124:127], a[224:227], v[14:17], v[124:127]
    s_waitcnt lgkmcnt(1)
    v_fma_f32 v52, v52, s28, v9
    v_fma_f32 v64, v64, s28, v10
    v_mfma_f32_16x16x32_bf16 v[128:131], a[228:231], v[14:17], v[128:131]
    ds_read_b64_tr_b16 a[216:217], v5 offset:1024
    ds_read_b64_tr_b16 a[218:219], v5 offset:7168
    v_mfma_f32_16x16x32_bf16 v[132:135], a[232:235], v[14:17], v[132:135]
    v_exp_f32 v61, v61
    v_mfma_f32_16x16x32_bf16 v[180:183], a[232:235], v[20:23], v[180:183]
    v_fma_f32 v57, v57, s28, v9
    v_mfma_f32_16x16x32_bf16 v[176:179], a[228:231], v[20:23], v[176:179]
    v_exp_f32 v71, v71
    v_mfma_f32_16x16x32_bf16 v[224:227], a[228:231], v[26:29], v[224:227]
    ds_read_b64_tr_b16 a[224:225], v3 offset:2048
    v_fma_f32 v67, v67, s28, v10
    v_mfma_f32_16x16x32_bf16 v[228:231], a[232:235], v[26:29], v[228:231]
    v_fma_f32 v72, v72, s28, v11
    v_fma_f32 v90, v90, s28, v13
    v_mfma_f32_16x16x32_bf16 a[20:23], a[232:235], v[32:35], a[20:23]
    ds_read_b64_tr_b16 a[222:223], v2 offset:8192
    v_mfma_f32_16x16x32_bf16 a[16:19], a[228:231], v[32:35], a[16:19]
    v_exp_f32 v74, v74
    v_mfma_f32_16x16x32_bf16 a[64:67], a[228:231], v[38:41], a[64:67]
    v_cvt_pk_bf16_f32 v30, v68, v69
    v_mfma_f32_16x16x32_bf16 a[68:71], a[232:235], v[38:41], a[68:71]
    s_waitcnt lgkmcnt(4)
    ds_read_b64_tr_b16 a[220:221], v2 offset:2048
    ds_read_b64_tr_b16 a[226:227], v3 offset:8192
    v_mfma_f32_16x16x32_bf16 a[72:75], a[212:215], v[38:41], a[72:75]
    s_waitcnt lgkmcnt(4)
    v_exp_f32 v57, v57
    v_mfma_f32_16x16x32_bf16 a[76:79], a[216:219], v[38:41], a[76:79]
    ds_read_b64_tr_b16 a[234:235], v5 offset:8192
    ds_read_b64_tr_b16 a[228:229], v4 offset:2048
    v_mfma_f32_16x16x32_bf16 a[28:31], a[216:219], v[32:35], a[28:31]
    v_exp_f32 v79, v79
    v_mfma_f32_16x16x32_bf16 a[24:27], a[212:215], v[32:35], a[24:27]
    ds_read_b64_tr_b16 a[230:231], v4 offset:8192
    ds_read_b64_tr_b16 a[232:233], v5 offset:2048
    v_mfma_f32_16x16x32_bf16 v[232:235], a[212:215], v[26:29], v[232:235]
    v_exp_f32 v91, v91
    v_mfma_f32_16x16x32_bf16 v[236:239], a[216:219], v[26:29], v[236:239]
    v_exp_f32 v60, v60
    v_mfma_f32_16x16x32_bf16 v[188:191], a[216:219], v[20:23], v[188:191]
    v_exp_f32 v85, v85
    v_mfma_f32_16x16x32_bf16 v[184:187], a[212:215], v[20:23], v[184:187]
    v_exp_f32 v65, v65
    v_mfma_f32_16x16x32_bf16 v[136:139], a[212:215], v[14:17], v[136:139]
    v_exp_f32 v52, v52
    v_mfma_f32_16x16x32_bf16 v[140:143], a[216:219], v[14:17], v[140:143]
    s_waitcnt lgkmcnt(4)
    v_mfma_f32_16x16x32_bf16 v[144:147], a[220:223], v[14:17], v[144:147]
    v_mfma_f32_16x16x32_bf16 v[148:151], a[224:227], v[14:17], v[148:151]
    v_fma_f32 v73, v73, s28, v11
    v_mfma_f32_16x16x32_bf16 v[196:199], a[224:227], v[20:23], v[196:199]
    ds_read_b128 v[96:99], v103 offset:3072
    v_mfma_f32_16x16x32_bf16 v[192:195], a[220:223], v[20:23], v[192:195]
    s_waitcnt vmcnt(12) lgkmcnt(1)
    v_exp_f32 v88, v88
    v_mfma_f32_16x16x32_bf16 v[240:243], a[220:223], v[26:29], v[240:243]
    v_fma_f32 v58, v58, s28, v9
    v_cvt_pk_bf16_f32 v19, v54, v55
    v_mfma_f32_16x16x32_bf16 v[244:247], a[224:227], v[26:29], v[244:247]
    s_barrier
    v_mfma_f32_16x16x32_bf16 a[36:39], a[224:227], v[32:35], a[36:39]
    s_add_u32 m0, s22, 24576
    v_exp_f32 v78, v78
    v_mfma_f32_16x16x32_bf16 a[32:35], a[220:223], v[32:35], a[32:35]
    buffer_load_dwordx4 v6, s[8:11], s21 offen lds
    v_mfma_f32_16x16x32_bf16 a[80:83], a[220:223], v[38:41], a[80:83]
    s_add_u32 s21, s21, 128
    ds_read_b128 a[220:223], v0 offset:1024
    v_cvt_pk_bf16_f32 v31, v70, v71
    v_mfma_f32_16x16x32_bf16 a[84:87], a[224:227], v[38:41], a[84:87]
    ds_read_b128 a[212:215], v0 offset:0
    v_cvt_pk_bf16_f32 v36, v76, v77
    v_mfma_f32_16x16x32_bf16 a[88:91], a[228:231], v[38:41], a[88:91]
    s_add_u32 m0, s22, 25600
    ds_read_b128 a[216:219], v1 offset:0
    v_cvt_pk_bf16_f32 v24, v60, v61
    v_mfma_f32_16x16x32_bf16 a[92:95], a[232:235], v[38:41], a[92:95]
    buffer_load_dwordx4 v6, s[8:11], s21 offen lds
    v_mfma_f32_16x16x32_bf16 a[44:47], a[232:235], v[32:35], a[44:47]
    v_exp_f32 v67, v67
    v_mfma_f32_16x16x32_bf16 a[40:43], a[228:231], v[32:35], a[40:43]
    v_mfma_f32_16x16x32_bf16 v[248:251], a[228:231], v[26:29], v[248:251]
    s_add_u32 s21, s21, 128
    s_add_u32 m0, s22, 26624
    v_cvt_pk_bf16_f32 v18, v52, v53
    v_mfma_f32_16x16x32_bf16 v[252:255], a[232:235], v[26:29], v[252:255]
    v_exp_f32 v80, v80
    v_mfma_f32_16x16x32_bf16 v[204:207], a[232:235], v[20:23], v[204:207]
    buffer_load_dwordx4 v6, s[8:11], s21 offen lds
    v_mfma_f32_16x16x32_bf16 v[200:203], a[228:231], v[20:23], v[200:203]
    v_exp_f32 v66, v66
    v_mfma_f32_16x16x32_bf16 v[152:155], a[228:231], v[14:17], v[152:155]
    s_add_u32 s21, s21, 12032
    v_mfma_f32_16x16x32_bf16 v[156:159], a[232:235], v[14:17], v[156:159]
    s_waitcnt lgkmcnt(1)
    v_cvt_pk_bf16_f32 v37, v78, v79
    v_mfma_f32_16x16x32_bf16 v[52:55], a[212:215], a[96:99], 0
    s_waitcnt lgkmcnt(0)
    v_exp_f32 v73, v73
    v_mfma_f32_16x16x32_bf16 v[52:55], a[216:219], a[100:103], v[52:55]
    v_exp_f32 v86, v86
    v_mfma_f32_16x16x32_bf16 v[52:55], a[220:223], a[104:107], v[52:55]
    ds_read_b128 a[224:227], v1 offset:1024
    v_cvt_pk_bf16_f32 v43, v86, v87
    v_mfma_f32_16x16x32_bf16 v[60:63], a[220:223], a[128:131], 0
    ds_read_b128 a[228:231], v0 offset:2048
    v_mfma_f32_16x16x32_bf16 v[60:63], a[216:219], a[124:127], v[60:63]
    buffer_store_dwordx4 v[96:99], v7, s[16:19], s24 offen offset:0 nt
    ds_read_b128 a[232:235], v1 offset:2048
    v_exp_f32 v83, v83
    v_mfma_f32_16x16x32_bf16 v[60:63], a[212:215], a[120:123], v[60:63]
    v_exp_f32 v81, v81
    v_mfma_f32_16x16x32_bf16 v[68:71], a[212:215], a[144:147], 0
    v_exp_f32 v82, v82
    v_mfma_f32_16x16x32_bf16 v[68:71], a[216:219], a[148:151], v[68:71]
    v_exp_f32 v56, v56
    v_mfma_f32_16x16x32_bf16 v[68:71], a[220:223], a[152:155], v[68:71]
    v_exp_f32 v90, v90
    v_mfma_f32_16x16x32_bf16 v[76:79], a[220:223], a[176:179], 0
    v_exp_f32 v58, v58
    v_mfma_f32_16x16x32_bf16 v[76:79], a[216:219], a[172:175], v[76:79]
    v_exp_f32 v75, v75
    v_mfma_f32_16x16x32_bf16 v[76:79], a[212:215], a[168:171], v[76:79]
    v_cvt_pk_bf16_f32 v42, v84, v85
    v_cvt_pk_bf16_f32 v34, v80, v81
    v_mfma_f32_16x16x32_bf16 v[84:87], a[212:215], a[192:195], 0
    ds_read_b128 a[212:215], v0 offset:6144
    s_add_u32 m0, s23, 3072
    v_mfma_f32_16x16x32_bf16 v[84:87], a[216:219], a[196:199], v[84:87]
    v_cvt_pk_bf16_f32 v23, v66, v67
    v_mfma_f32_16x16x32_bf16 v[84:87], a[220:223], a[200:203], v[84:87]
    s_waitcnt lgkmcnt(1)
    v_exp_f32 v72, v72
    v_mfma_f32_16x16x32_bf16 v[84:87], a[224:227], a[204:207], v[84:87]
    ds_read_b128 a[220:223], v0 offset:7168
    v_mfma_f32_16x16x32_bf16 v[84:87], a[228:231], a[208:211], v[84:87]
    buffer_load_dwordx4 v7, s[12:15], s25 offen nt lds
    v_mfma_f32_16x16x32_bf16 v[84:87], a[232:235], v[92:95], v[84:87]
    v_fma_f32 v59, v59, s28, v9
    v_cvt_pk_bf16_f32 v29, v74, v75
    v_mfma_f32_16x16x32_bf16 v[76:79], a[232:235], a[188:191], v[76:79]
    v_cvt_pk_bf16_f32 v28, v72, v73
    v_mfma_f32_16x16x32_bf16 v[76:79], a[228:231], a[184:187], v[76:79]
    v_exp_f32 v59, v59
    v_mfma_f32_16x16x32_bf16 v[76:79], a[224:227], a[180:183], v[76:79]
    v_exp_f32 v89, v89
    v_mfma_f32_16x16x32_bf16 v[68:71], a[224:227], a[156:159], v[68:71]
    v_cvt_pk_bf16_f32 v16, v56, v57
    v_mfma_f32_16x16x32_bf16 v[68:71], a[228:231], a[160:163], v[68:71]
    v_exp_f32 v64, v64
    v_mfma_f32_16x16x32_bf16 v[68:71], a[232:235], a[164:167], v[68:71]
    ds_read_b128 a[216:219], v1 offset:6144
    v_mfma_f32_16x16x32_bf16 v[60:63], a[232:235], a[140:143], v[60:63]
    s_bitcmp1_b32 s27, 0
    v_mfma_f32_16x16x32_bf16 v[60:63], a[228:231], a[136:139], v[60:63]
    s_cselect_b32 s26, s49, 128
    v_cvt_pk_bf16_f32 v17, v58, v59
    s_lshr_b32 s27, s27, 1
    v_mfma_f32_16x16x32_bf16 v[60:63], a[224:227], a[132:135], v[60:63]
    v_cvt_pk_bf16_f32 v22, v64, v65
    v_mfma_f32_16x16x32_bf16 v[52:55], a[224:227], a[108:111], v[52:55]
    ds_read_b128 a[224:227], v1 offset:7168
    v_mfma_f32_16x16x32_bf16 v[52:55], a[228:231], a[112:115], v[52:55]
    ds_read_b128 a[228:231], v0 offset:8192
    v_mfma_f32_16x16x32_bf16 v[52:55], a[232:235], a[116:119], v[52:55]
    ds_read_b128 a[232:235], v1 offset:8192
    v_mfma_f32_16x16x32_bf16 v[48:51], a[236:239], v[16:19], v[44:47]
    s_add_u32 s24, s24, s26
    v_mfma_f32_16x16x32_bf16 v[48:51], a[240:243], v[22:25], v[48:51]
    s_waitcnt lgkmcnt(4)
    v_cvt_pk_bf16_f32 v41, v90, v91
    s_add_u32 s25, s25, s26
    v_mfma_f32_16x16x32_bf16 v[56:59], a[212:215], a[96:99], 0
    v_cvt_pk_bf16_f32 v35, v82, v83
    v_mfma_f32_16x16x32_bf16 v[48:51], a[244:247], v[28:31], v[48:51]
    v_cvt_pk_bf16_f32 v40, v88, v89
    v_mfma_f32_16x16x32_bf16 v[48:51], a[248:251], v[34:37], v[48:51]
    s_nop 0
    v_mfma_f32_16x16x32_bf16 v[48:51], a[252:255], v[40:43], v[48:51]
    s_waitcnt lgkmcnt(3)
    v_mfma_f32_16x16x32_bf16 v[56:59], a[216:219], a[100:103], v[56:59]
    s_add_u32 s23, s23, 4096
    v_add_u32 v103, 4096, v103
    v_mfma_f32_16x16x32_bf16 v[56:59], a[220:223], a[104:107], v[56:59]
    v_mfma_f32_16x16x32_bf16 v[64:67], a[220:223], a[128:131], 0
    s_nop 1
    v_cmp_lt_f32 vcc, s29, v48
    v_mfma_f32_16x16x32_bf16 v[64:67], a[216:219], a[124:127], v[64:67]
    s_waitcnt vmcnt(12) lgkmcnt(0)
    v_mfma_f32_16x16x32_bf16 v[64:67], a[212:215], a[120:123], v[64:67]
    s_barrier
    v_mfma_f32_16x16x32_bf16 v[72:75], a[212:215], a[144:147], 0
    s_cbranch_vccnz L_rs_loop5w1b
L_ret_loop5w1b:
    s_cmp_eq_u32 s30, 5
    v_mfma_f32_16x16x32_bf16 v[72:75], a[216:219], a[148:151], v[72:75]
    s_cselect_b32 s26, s62, 0
    v_fma_f32 v55, v55, s28, v9
    s_add_u32 s20, s20, s26
    v_mfma_f32_16x16x32_bf16 v[72:75], a[220:223], a[152:155], v[72:75]
    s_add_u32 m0, s22, 0
    v_fma_f32 v63, v63, s28, v10
    v_fma_f32 v62, v62, s28, v10
    v_mfma_f32_16x16x32_bf16 v[80:83], a[220:223], a[176:179], 0
    buffer_load_dwordx4 v6, s[4:7], s20 offen lds
    v_mfma_f32_16x16x32_bf16 v[80:83], a[216:219], a[172:175], v[80:83]
    s_add_u32 s20, s20, 128
    s_add_u32 m0, s22, 1024
    v_fma_f32 v53, v53, s28, v9
    v_mfma_f32_16x16x32_bf16 v[80:83], a[212:215], a[168:171], v[80:83]
    v_fma_f32 v52, v52, s28, v9
    v_fma_f32 v60, v60, s28, v10
    v_mfma_f32_16x16x32_bf16 v[88:91], a[212:215], a[192:195], 0
    buffer_load_dwordx4 v6, s[4:7], s20 offen lds
    v_mfma_f32_16x16x32_bf16 v[88:91], a[216:219], a[196:199], v[88:91]
    s_add_u32 s20, s20, 128
    ds_read_b64_tr_b16 a[212:213], v2 offset:18432
    v_fma_f32 v61, v61, s28, v10
    v_mfma_f32_16x16x32_bf16 v[88:91], a[220:223], a[200:203], v[88:91]
    s_add_u32 m0, s22, 2048
    v_exp_f32 v61, v61
    v_mfma_f32_16x16x32_bf16 v[88:91], a[224:227], a[204:207], v[88:91]
    buffer_load_dwordx4 v6, s[4:7], s20 offen lds
    v_mfma_f32_16x16x32_bf16 v[88:91], a[228:231], a[208:211], v[88:91]
    v_exp_f32 v60, v60
    v_mfma_f32_16x16x32_bf16 v[88:91], a[232:235], v[92:95], v[88:91]
    ds_read_b64_tr_b16 a[214:215], v2 offset:12288
    v_cvt_pk_bf16_f32 v20, v60, v61
    v_mfma_f32_16x16x32_bf16 v[80:83], a[232:235], a[188:191], v[80:83]
    ds_read_b64_tr_b16 a[216:217], v3 offset:18432
    ds_read_b64_tr_b16 a[218:219], v3 offset:12288
    v_mfma_f32_16x16x32_bf16 v[80:83], a[228:231], a[184:187], v[80:83]
    v_exp_f32 v52, v52
    v_mfma_f32_16x16x32_bf16 v[80:83], a[224:227], a[180:183], v[80:83]
    v_exp_f32 v55, v55
    v_mfma_f32_16x16x32_bf16 v[72:75], a[224:227], a[156:159], v[72:75]
    s_add_u32 s20, s20, 12032
    ds_read_b64_tr_b16 a[220:221], v4 offset:18432
    v_fma_f32 v54, v54, s28, v9
    v_mfma_f32_16x16x32_bf16 v[72:75], a[228:231], a[160:163], v[72:75]
    s_add_u32 s30, s30, 1
    v_exp_f32 v63, v63
    v_mfma_f32_16x16x32_bf16 v[72:75], a[232:235], a[164:167], v[72:75]
    s_cmp_lt_u32 s30, 6
    v_exp_f32 v62, v62
    v_mfma_f32_16x16x32_bf16 v[64:67], a[232:235], a[140:143], v[64:67]
    v_exp_f32 v54, v54
    v_mfma_f32_16x16x32_bf16 v[64:67], a[228:231], a[136:139], v[64:67]
    v_cvt_pk_bf16_f32 v15, v54, v55
    v_cvt_pk_bf16_f32 v21, v62, v63
    v_mfma_f32_16x16x32_bf16 v[64:67], a[224:227], a[132:135], v[64:67]
    v_exp_f32 v53, v53
    v_mfma_f32_16x16x32_bf16 v[56:59], a[224:227], a[108:111], v[56:59]
    ds_read_b64_tr_b16 a[222:223], v4 offset:12288
    v_cvt_pk_bf16_f32 v14, v52, v53
    v_mfma_f32_16x16x32_bf16 v[56:59], a[228:231], a[112:115], v[56:59]
    s_waitcnt lgkmcnt(2)
    ds_read_b64_tr_b16 a[224:225], v5 offset:18432
    ds_read_b64_tr_b16 a[226:227], v5 offset:12288
    v_mfma_f32_16x16x32_bf16 v[56:59], a[232:235], a[116:119], v[56:59]
    s_cbranch_scc1 L_loop5w1
    s_cmp_ge_u32 s37, 6
    s_cbranch_scc1 L_end5
    s_cmp_eq_u32 s32, 0
    s_cbranch_scc1 L_tr54
    s_branch L_tr55
L_tr54:
    v_mfma_f32_16x16x32_bf16 v[112:115], a[212:215], v[16:19], v[112:115]
    v_fma_f32 v73, v73, s28, v11
    v_mfma_f32_16x16x32_bf16 v[116:119], a[216:219], v[16:19], v[116:119]
    ds_read_b64_tr_b16 a[228:229], v2 offset:19456
    v_fma_f32 v88, v88, s28, v13
    v_mfma_f32_16x16x32_bf16 v[164:167], a[216:219], v[22:25], v[164:167]
    v_fma_f32 v78, v78, s28, v12
    v_fma_f32 v56, v56, s28, v9
    v_mfma_f32_16x16x32_bf16 v[160:163], a[212:215], v[22:25], v[160:163]
    v_mfma_f32_16x16x32_bf16 v[208:211], a[212:215], v[28:31], v[208:211]
    ds_read_b64_tr_b16 a[234:235], v3 offset:13312
    v_fma_f32 v83, v83, s28, v12
    v_mfma_f32_16x16x32_bf16 v[212:215], a[216:219], v[28:31], v[212:215]
    ds_read_b64_tr_b16 a[230:231], v2 offset:13312
    v_fma_f32 v79, v79, s28, v12
    v_mfma_f32_16x16x32_bf16 a[4:7], a[216:219], v[34:37], a[4:7]
    v_mfma_f32_16x16x32_bf16 a[0:3], a[212:215], v[34:37], a[0:3]
    ds_read_b64_tr_b16 a[232:233], v3 offset:19456
    v_fma_f32 v81, v81, s28, v12
    v_mfma_f32_16x16x32_bf16 a[48:51], a[212:215], v[40:43], a[48:51]
    v_fma_f32 v77, v77, s28, v12
    v_fma_f32 v80, v80, s28, v12
    v_mfma_f32_16x16x32_bf16 a[52:55], a[216:219], v[40:43], a[52:55]
    s_waitcnt lgkmcnt(4)
    v_exp_f32 v79, v79
    v_mfma_f32_16x16x32_bf16 a[56:59], a[220:223], v[40:43], a[56:59]
    ds_read_b64_tr_b16 a[214:215], v4 offset:13312
    v_fma_f32 v86, v86, s28, v13
    v_mfma_f32_16x16x32_bf16 a[60:63], a[224:227], v[40:43], a[60:63]
    v_fma_f32 v66, v66, s28, v10
    v_fma_f32 v67, v67, s28, v10
    v_mfma_f32_16x16x32_bf16 a[12:15], a[224:227], v[34:37], a[12:15]
    v_mfma_f32_16x16x32_bf16 a[8:11], a[220:223], v[34:37], a[8:11]
    v_fma_f32 v90, v90, s28, v13
    v_mfma_f32_16x16x32_bf16 v[216:219], a[220:223], v[28:31], v[216:219]
    ds_read_b64_tr_b16 a[212:213], v4 offset:19456
    v_fma_f32 v87, v87, s28, v13
    v_mfma_f32_16x16x32_bf16 v[220:223], a[224:227], v[28:31], v[220:223]
    v_exp_f32 v78, v78
    v_mfma_f32_16x16x32_bf16 v[172:175], a[224:227], v[22:25], v[172:175]
    v_fma_f32 v65, v65, s28, v10
    v_fma_f32 v70, v70, s28, v11
    v_mfma_f32_16x16x32_bf16 v[168:171], a[220:223], v[22:25], v[168:171]
    v_fma_f32 v91, v91, s28, v13
    v_mfma_f32_16x16x32_bf16 v[120:123], a[220:223], v[16:19], v[120:123]
    ds_read_b64_tr_b16 a[216:217], v5 offset:19456
    v_fma_f32 v82, v82, s28, v12
    v_mfma_f32_16x16x32_bf16 v[124:127], a[224:227], v[16:19], v[124:127]
    s_waitcnt lgkmcnt(3)
    ds_read_b64_tr_b16 a[218:219], v5 offset:13312
    v_mfma_f32_16x16x32_bf16 v[128:131], a[228:231], v[16:19], v[128:131]
    v_exp_f32 v70, v70
    v_mfma_f32_16x16x32_bf16 v[132:135], a[232:235], v[16:19], v[132:135]
    v_exp_f32 v77, v77
    v_mfma_f32_16x16x32_bf16 v[180:183], a[232:235], v[22:25], v[180:183]
    v_fma_f32 v84, v84, s28, v13
    v_fma_f32 v59, v59, s28, v9
    v_mfma_f32_16x16x32_bf16 v[176:179], a[228:231], v[22:25], v[176:179]
    ds_read_b64_tr_b16 a[222:223], v2 offset:14336
    v_cvt_pk_bf16_f32 v33, v78, v79
    v_mfma_f32_16x16x32_bf16 v[224:227], a[228:231], v[28:31], v[224:227]
    ds_read_b64_tr_b16 a[226:227], v3 offset:14336
    v_mfma_f32_16x16x32_bf16 v[228:231], a[232:235], v[28:31], v[228:231]
    ds_read_b64_tr_b16 a[220:221], v2 offset:20480
    v_fma_f32 v68, v68, s28, v11
    v_mfma_f32_16x16x32_bf16 a[20:23], a[232:235], v[34:37], a[20:23]
    v_fma_f32 v85, v85, s28, v13
    v_mfma_f32_16x16x32_bf16 a[16:19], a[228:231], v[34:37], a[16:19]
    v_mfma_f32_16x16x32_bf16 a[64:67], a[228:231], v[40:43], a[64:67]
    v_fma_f32 v57, v57, s28, v9
    v_fma_f32 v74, v74, s28, v11
    v_mfma_f32_16x16x32_bf16 a[68:71], a[232:235], v[40:43], a[68:71]
    s_waitcnt lgkmcnt(3)
    ds_read_b64_tr_b16 a[224:225], v3 offset:20480
    s_add_u32 s39, s39, 12288
    v_mfma_f32_16x16x32_bf16 a[72:75], a[212:215], v[40:43], a[72:75]
    v_exp_f32 v68, v68
    v_mfma_f32_16x16x32_bf16 a[76:79], a[216:219], v[40:43], a[76:79]
    v_exp_f32 v73, v73
    v_mfma_f32_16x16x32_bf16 a[28:31], a[216:219], v[34:37], a[28:31]
    v_fma_f32 v69, v69, s28, v11
    v_fma_f32 v58, v58, s28, v9
    v_mfma_f32_16x16x32_bf16 a[24:27], a[212:215], v[34:37], a[24:27]
    ds_read_b64_tr_b16 a[230:231], v4 offset:14336
    v_fma_f32 v76, v76, s28, v12
    v_mfma_f32_16x16x32_bf16 v[232:235], a[212:215], v[28:31], v[232:235]
    ds_read_b64_tr_b16 a[228:229], v4 offset:20480
    v_fma_f32 v71, v71, s28, v11
    v_mfma_f32_16x16x32_bf16 v[236:239], a[216:219], v[28:31], v[236:239]
    ds_read_b64_tr_b16 a[234:235], v5 offset:14336
    v_fma_f32 v89, v89, s28, v13
    v_mfma_f32_16x16x32_bf16 v[188:191], a[216:219], v[22:25], v[188:191]
    v_exp_f32 v84, v84
    v_mfma_f32_16x16x32_bf16 v[184:187], a[212:215], v[22:25], v[184:187]
    v_exp_f32 v67, v67
    v_mfma_f32_16x16x32_bf16 v[136:139], a[212:215], v[16:19], v[136:139]
    ds_read_b64_tr_b16 a[232:233], v5 offset:20480
    v_fma_f32 v75, v75, s28, v11
    v_mfma_f32_16x16x32_bf16 v[140:143], a[216:219], v[16:19], v[140:143]
    s_waitcnt lgkmcnt(4)
    v_exp_f32 v66, v66
    v_mfma_f32_16x16x32_bf16 v[144:147], a[220:223], v[16:19], v[144:147]
    v_exp_f32 v69, v69
    v_mfma_f32_16x16x32_bf16 v[148:151], a[224:227], v[16:19], v[148:151]
    v_exp_f32 v57, v57
    v_mfma_f32_16x16x32_bf16 v[196:199], a[224:227], v[22:25], v[196:199]
    v_exp_f32 v82, v82
    v_mfma_f32_16x16x32_bf16 v[192:195], a[220:223], v[22:25], v[192:195]
    v_exp_f32 v85, v85
    v_mfma_f32_16x16x32_bf16 v[240:243], a[220:223], v[28:31], v[240:243]
    v_exp_f32 v86, v86
    v_mfma_f32_16x16x32_bf16 v[244:247], a[224:227], v[28:31], v[244:247]
    v_exp_f32 v74, v74
    v_mfma_f32_16x16x32_bf16 a[36:39], a[224:227], v[34:37], a[36:39]
    v_exp_f32 v76, v76
    v_mfma_f32_16x16x32_bf16 a[32:35], a[220:223], v[34:37], a[32:35]
    v_exp_f32 v83, v83
    v_mfma_f32_16x16x32_bf16 a[80:83], a[220:223], v[40:43], a[80:83]
    s_waitcnt vmcnt(10) lgkmcnt(0)
    v_exp_f32 v87, v87
    v_mfma_f32_16x16x32_bf16 a[84:87], a[224:227], v[40:43], a[84:87]
    s_barrier
    ds_read_b128 a[212:215], v0 offset:12288
    v_mfma_f32_16x16x32_bf16 a[88:91], a[228:231], v[40:43], a[88:91]
    ds_read_b128 a[216:219], v1 offset:12288
    v_fma_f32 v72, v72, s28, v11
    v_mfma_f32_16x16x32_bf16 a[92:95], a[232:235], v[40:43], a[92:95]
    s_add_u32 m0, s22, 36864
    ds_read_b128 a[220:223], v0 offset:13312
    v_mfma_f32_16x16x32_bf16 a[44:47], a[232:235], v[34:37], a[44:47]
    buffer_load_dwordx4 v6, s[8:11], s21 offen lds
    v_mfma_f32_16x16x32_bf16 a[40:43], a[228:231], v[34:37], a[40:43]
    s_add_u32 s21, s21, 128
    ds_read_b128 a[224:227], v1 offset:13312
    s_add_u32 m0, s22, 37888
    v_mfma_f32_16x16x32_bf16 v[248:251], a[228:231], v[28:31], v[248:251]
    buffer_load_dwordx4 v6, s[8:11], s21 offen lds
    v_mfma_f32_16x16x32_bf16 v[252:255], a[232:235], v[28:31], v[252:255]
    v_cvt_pk_bf16_f32 v26, v68, v69
    s_add_u32 s21, s21, 128
    v_mfma_f32_16x16x32_bf16 v[204:207], a[232:235], v[22:25], v[204:207]
    v_exp_f32 v75, v75
    v_mfma_f32_16x16x32_bf16 v[200:203], a[228:231], v[22:25], v[200:203]
    s_add_u32 m0, s22, 38912
    v_exp_f32 v90, v90
    v_mfma_f32_16x16x32_bf16 v[152:155], a[228:231], v[16:19], v[152:155]
    buffer_load_dwordx4 v6, s[8:11], s21 offen lds
    v_mfma_f32_16x16x32_bf16 v[156:159], a[232:235], v[16:19], v[156:159]
    s_waitcnt lgkmcnt(3)
    ds_read_b128 a[228:231], v0 offset:14336
    v_mfma_f32_16x16x32_bf16 v[52:55], a[212:215], a[96:99], 0
    s_waitcnt lgkmcnt(3)
    v_exp_f32 v71, v71
    v_mfma_f32_16x16x32_bf16 v[52:55], a[216:219], a[100:103], v[52:55]
    s_waitcnt lgkmcnt(2)
    v_cvt_pk_bf16_f32 v32, v76, v77
    v_mfma_f32_16x16x32_bf16 v[52:55], a[220:223], a[104:107], v[52:55]
    v_mfma_f32_16x16x32_bf16 v[60:63], a[220:223], a[128:131], 0
    v_exp_f32 v91, v91
    v_mfma_f32_16x16x32_bf16 v[60:63], a[216:219], a[124:127], v[60:63]
    ds_read_b128 a[232:235], v1 offset:14336
    v_fma_f32 v64, v64, s28, v10
    v_mfma_f32_16x16x32_bf16 v[60:63], a[212:215], a[120:123], v[60:63]
    v_cvt_pk_bf16_f32 v27, v70, v71
    v_cvt_pk_bf16_f32 v38, v84, v85
    v_mfma_f32_16x16x32_bf16 v[68:71], a[212:215], a[144:147], 0
    v_cvt_pk_bf16_f32 v39, v86, v87
    v_mfma_f32_16x16x32_bf16 v[68:71], a[216:219], a[148:151], v[68:71]
    v_exp_f32 v58, v58
    v_mfma_f32_16x16x32_bf16 v[68:71], a[220:223], a[152:155], v[68:71]
    v_cvt_pk_bf16_f32 v41, v90, v91
    v_cvt_pk_bf16_f32 v23, v66, v67
    v_mfma_f32_16x16x32_bf16 v[76:79], a[220:223], a[176:179], 0
    v_exp_f32 v72, v72
    v_mfma_f32_16x16x32_bf16 v[76:79], a[216:219], a[172:175], v[76:79]
    v_cvt_pk_bf16_f32 v35, v82, v83
    v_cvt_pk_bf16_f32 v29, v74, v75
    v_mfma_f32_16x16x32_bf16 v[76:79], a[212:215], a[168:171], v[76:79]
    v_exp_f32 v59, v59
    v_mfma_f32_16x16x32_bf16 v[84:87], a[212:215], a[192:195], 0
    v_exp_f32 v81, v81
    v_mfma_f32_16x16x32_bf16 v[84:87], a[216:219], a[196:199], v[84:87]
    v_exp_f32 v89, v89
    v_mfma_f32_16x16x32_bf16 v[84:87], a[220:223], a[200:203], v[84:87]
    s_waitcnt lgkmcnt(0)
    v_cvt_pk_bf16_f32 v28, v72, v73
    v_mfma_f32_16x16x32_bf16 v[84:87], a[224:227], a[204:207], v[84:87]
    v_exp_f32 v65, v65
    v_mfma_f32_16x16x32_bf16 v[84:87], a[228:231], a[208:211], v[84:87]
    v_exp_f32 v80, v80
    v_mfma_f32_16x16x32_bf16 v[84:87], a[232:235], v[92:95], v[84:87]
    v_exp_f32 v64, v64
    v_mfma_f32_16x16x32_bf16 v[76:79], a[232:235], a[188:191], v[76:79]
    v_mfma_f32_16x16x32_bf16 v[76:79], a[228:231], a[184:187], v[76:79]
    ds_read_b128 a[212:215], v0 offset:18432
    v_cvt_pk_bf16_f32 v17, v58, v59
    v_mfma_f32_16x16x32_bf16 v[76:79], a[224:227], a[180:183], v[76:79]
    v_cvt_pk_bf16_f32 v34, v80, v81
    v_mfma_f32_16x16x32_bf16 v[68:71], a[224:227], a[156:159], v[68:71]
    v_exp_f32 v56, v56
    v_mfma_f32_16x16x32_bf16 v[68:71], a[228:231], a[160:163], v[68:71]
    v_mfma_f32_16x16x32_bf16 v[68:71], a[232:235], a[164:167], v[68:71]
    v_mfma_f32_16x16x32_bf16 v[60:63], a[232:235], a[140:143], v[60:63]
    v_cvt_pk_bf16_f32 v22, v64, v65
    v_mfma_f32_16x16x32_bf16 v[60:63], a[228:231], a[136:139], v[60:63]
    ds_read_b128 a[216:219], v1 offset:18432
    v_cvt_pk_bf16_f32 v16, v56, v57
    v_mfma_f32_16x16x32_bf16 v[60:63], a[224:227], a[132:135], v[60:63]
    ds_read_b128 a[220:223], v0 offset:19456
    v_mfma_f32_16x16x32_bf16 v[52:55], a[224:227], a[108:111], v[52:55]
    v_exp_f32 v88, v88
    v_mfma_f32_16x16x32_bf16 v[44:47], a[236:239], v[14:17], v[48:51]
    v_mfma_f32_16x16x32_bf16 v[44:47], a[240:243], v[20:23], v[44:47]
    ds_read_b128 a[224:227], v1 offset:19456
    v_cvt_pk_bf16_f32 v40, v88, v89
    v_mfma_f32_16x16x32_bf16 v[52:55], a[228:231], a[112:115], v[52:55]
    ds_read_b128 a[228:231], v0 offset:20480
    v_mfma_f32_16x16x32_bf16 v[52:55], a[232:235], a[116:119], v[52:55]
    v_mfma_f32_16x16x32_bf16 v[44:47], a[244:247], v[26:29], v[44:47]
    ds_read_b128 a[232:235], v1 offset:20480
    v_mfma_f32_16x16x32_bf16 v[44:47], a[248:251], v[32:35], v[44:47]
    v_mfma_f32_16x16x32_bf16 v[44:47], a[252:255], v[38:41], v[44:47]
    s_waitcnt lgkmcnt(5)
    v_mfma_f32_16x16x32_bf16 v[56:59], a[212:215], a[96:99], 0
    s_waitcnt lgkmcnt(4)
    v_mfma_f32_16x16x32_bf16 v[56:59], a[216:219], a[100:103], v[56:59]
    s_waitcnt lgkmcnt(3)
    v_mfma_f32_16x16x32_bf16 v[56:59], a[220:223], a[104:107], v[56:59]
    s_nop 1
    v_cmp_lt_f32 vcc, s29, v44
    v_mfma_f32_16x16x32_bf16 v[64:67], a[220:223], a[128:131], 0
    s_add_u32 s21, s21, 12032
    v_mfma_f32_16x16x32_bf16 v[64:67], a[216:219], a[124:127], v[64:67]
    v_mfma_f32_16x16x32_bf16 v[64:67], a[212:215], a[120:123], v[64:67]
    s_nop 0
    s_cbranch_vccnz L_rs_tr54a
L_ret_tr54a:
    v_mfma_f32_16x16x32_bf16 v[72:75], a[212:215], a[144:147], 0
    v_fma_f32 v62, v62, s28, v10
    v_fma_f32 v52, v52, s28, v9
    v_mfma_f32_16x16x32_bf16 v[72:75], a[216:219], a[148:151], v[72:75]
    s_waitcnt vmcnt(6) lgkmcnt(0)
    v_exp_f32 v52, v52
    v_mfma_f32_16x16x32_bf16 v[72:75], a[220:223], a[152:155], v[72:75]
    s_add_u32 m0, s22, 12288
    v_fma_f32 v60, v60, s28, v10
    v_fma_f32 v55, v55, s28, v9
    v_mfma_f32_16x16x32_bf16 v[80:83], a[220:223], a[176:179], 0
    s_barrier
    v_mfma_f32_16x16x32_bf16 v[80:83], a[216:219], a[172:175], v[80:83]
    buffer_load_dwordx4 v6, s[4:7], s20 offen lds
    v_mfma_f32_16x16x32_bf16 v[80:83], a[212:215], a[168:171], v[80:83]
    v_exp_f32 v55, v55
    v_mfma_f32_16x16x32_bf16 v[88:91], a[212:215], a[192:195], 0
    ds_read_b64_tr_b16 a[212:213], v2 offset:0
    v_fma_f32 v54, v54, s28, v9
    v_mfma_f32_16x16x32_bf16 v[88:91], a[216:219], a[196:199], v[88:91]
    v_exp_f32 v60, v60
    v_mfma_f32_16x16x32_bf16 v[88:91], a[220:223], a[200:203], v[88:91]
    s_add_u32 s20, s20, 128
    ds_read_b64_tr_b16 a[214:215], v2 offset:6144
    v_fma_f32 v53, v53, s28, v9
    v_mfma_f32_16x16x32_bf16 v[88:91], a[224:227], a[204:207], v[88:91]
    ds_read_b64_tr_b16 a[216:217], v3 offset:0
    s_add_u32 m0, s22, 13312
    v_mfma_f32_16x16x32_bf16 v[88:91], a[228:231], a[208:211], v[88:91]
    ds_read_b64_tr_b16 a[218:219], v3 offset:6144
    v_fma_f32 v61, v61, s28, v10
    v_mfma_f32_16x16x32_bf16 v[88:91], a[232:235], v[92:95], v[88:91]
    buffer_load_dwordx4 v6, s[4:7], s20 offen lds
    v_mfma_f32_16x16x32_bf16 v[80:83], a[232:235], a[188:191], v[80:83]
    v_exp_f32 v62, v62
    v_mfma_f32_16x16x32_bf16 v[80:83], a[228:231], a[184:187], v[80:83]
    s_add_u32 s20, s20, 128
    s_add_u32 m0, s22, 14336
    v_fma_f32 v63, v63, s28, v10
    v_mfma_f32_16x16x32_bf16 v[80:83], a[224:227], a[180:183], v[80:83]
    buffer_load_dwordx4 v6, s[4:7], s20 offen lds
    v_mfma_f32_16x16x32_bf16 v[72:75], a[224:227], a[156:159], v[72:75]
    v_exp_f32 v54, v54
    v_mfma_f32_16x16x32_bf16 v[72:75], a[228:231], a[160:163], v[72:75]
    ds_read_b64_tr_b16 a[220:221], v4 offset:0
    v_mfma_f32_16x16x32_bf16 v[72:75], a[232:235], a[164:167], v[72:75]
    v_exp_f32 v61, v61
    v_mfma_f32_16x16x32_bf16 v[64:67], a[232:235], a[140:143], v[64:67]
    v_exp_f32 v63, v63
    v_mfma_f32_16x16x32_bf16 v[64:67], a[228:231], a[136:139], v[64:67]
    v_exp_f32 v53, v53
    v_mfma_f32_16x16x32_bf16 v[64:67], a[224:227], a[132:135], v[64:67]
    ds_read_b64_tr_b16 a[222:223], v4 offset:6144
    v_cvt_pk_bf16_f32 v18, v52, v53
    v_mfma_f32_16x16x32_bf16 v[56:59], a[224:227], a[108:111], v[56:59]
    s_add_u32 s20, s20, 12032
    v_cvt_pk_bf16_f32 v25, v62, v63
    v_cvt_pk_bf16_f32 v24, v60, v61
    v_mfma_f32_16x16x32_bf16 v[56:59], a[228:231], a[112:115], v[56:59]
    ds_read_b64_tr_b16 a[224:225], v5 offset:0
    v_cvt_pk_bf16_f32 v19, v54, v55
    v_mfma_f32_16x16x32_bf16 v[56:59], a[232:235], a[116:119], v[56:59]
    s_waitcnt lgkmcnt(3)
    ds_read_b64_tr_b16 a[226:227], v5 offset:6144
    v_mfma_f32_16x16x32_bf16 v[112:115], a[212:215], v[14:17], v[112:115]
    ds_read_b64_tr_b16 a[230:231], v2 offset:7168
    v_fma_f32 v87, v87, s28, v13
    v_mfma_f32_16x16x32_bf16 v[116:119], a[216:219], v[14:17], v[116:119]
    v_fma_f32 v66, v66, s28, v10
    v_fma_f32 v73, v73, s28, v11
    v_mfma_f32_16x16x32_bf16 v[164:167], a[216:219], v[20:23], v[164:167]
    ds_read_b64_tr_b16 a[234:235], v3 offset:7168
    v_and_b32 v104, 0x3ff, v0
    v_mfma_f32_16x16x32_bf16 v[160:163], a[212:215], v[20:23], v[160:163]
    v_fma_f32 v72, v72, s28, v11
    v_fma_f32 v83, v83, s28, v12
    v_mfma_f32_16x16x32_bf16 v[208:211], a[212:215], v[26:29], v[208:211]
    ds_read_b64_tr_b16 a[228:229], v2 offset:1024
    v_fma_f32 v67, v67, s28, v10
    v_mfma_f32_16x16x32_bf16 v[212:215], a[216:219], v[26:29], v[212:215]
    ds_read_b64_tr_b16 a[232:233], v3 offset:1024
    v_lshrrev_b32 v105, 11, v0
    v_mfma_f32_16x16x32_bf16 a[4:7], a[216:219], v[32:35], a[4:7]
    v_fma_f32 v89, v89, s28, v13
    v_fma_f32 v56, v56, s28, v9
    v_mfma_f32_16x16x32_bf16 a[0:3], a[212:215], v[32:35], a[0:3]
    v_fma_f32 v70, v70, s28, v11
    v_fma_f32 v58, v58, s28, v9
    v_mfma_f32_16x16x32_bf16 a[48:51], a[212:215], v[38:41], a[48:51]
    ds_read_b64_tr_b16 a[212:213], v4 offset:1024
    v_fma_f32 v57, v57, s28, v9
    v_mfma_f32_16x16x32_bf16 a[52:55], a[216:219], v[38:41], a[52:55]
    s_waitcnt lgkmcnt(5)
    v_fma_f32 v78, v78, s28, v12
    v_fma_f32 v81, v81, s28, v12
    v_mfma_f32_16x16x32_bf16 a[56:59], a[220:223], v[38:41], a[56:59]
    v_xor_b32 v105, s65, v105
    v_lshl_add_u32 v104, v105, 10, v104
    v_mfma_f32_16x16x32_bf16 a[60:63], a[224:227], v[38:41], a[60:63]
    v_fma_f32 v65, v65, s28, v10
    v_add_u32 v104, s38, v104
    v_mfma_f32_16x16x32_bf16 a[12:15], a[224:227], v[32:35], a[12:15]
    ds_read_b64_tr_b16 a[214:215], v4 offset:7168
    v_fma_f32 v90, v90, s28, v13
    v_mfma_f32_16x16x32_bf16 a[8:11], a[220:223], v[32:35], a[8:11]
    ds_read_b64_tr_b16 a[218:219], v5 offset:7168
    v_fma_f32 v76, v76, s28, v12
    v_mfma_f32_16x16x32_bf16 v[216:219], a[220:223], v[26:29], v[216:219]
    ds_read_b64_tr_b16 a[216:217], v5 offset:1024
    v_fma_f32 v84, v84, s28, v13
    v_mfma_f32_16x16x32_bf16 v[220:223], a[224:227], v[26:29], v[220:223]
    v_exp_f32 v73, v73
    v_mfma_f32_16x16x32_bf16 v[172:175], a[224:227], v[20:23], v[172:175]
    v_exp_f32 v78, v78
    v_mfma_f32_16x16x32_bf16 v[168:171], a[220:223], v[20:23], v[168:171]
    v_exp_f32 v65, v65
    v_mfma_f32_16x16x32_bf16 v[120:123], a[220:223], v[14:17], v[120:123]
    ds_read_b64_tr_b16 a[220:221], v2 offset:2048
    v_fma_f32 v77, v77, s28, v12
    v_mfma_f32_16x16x32_bf16 v[124:127], a[224:227], v[14:17], v[124:127]
    s_waitcnt lgkmcnt(4)
    ds_read_b64_tr_b16 a[224:225], v3 offset:2048
    v_fma_f32 v91, v91, s28, v13
    v_mfma_f32_16x16x32_bf16 v[128:131], a[228:231], v[14:17], v[128:131]
    ds_read_b128 a[128:131], v104 offset:8192
    v_fma_f32 v71, v71, s28, v11
    v_mfma_f32_16x16x32_bf16 v[132:135], a[232:235], v[14:17], v[132:135]
    v_exp_f32 v58, v58
    v_mfma_f32_16x16x32_bf16 v[180:183], a[232:235], v[20:23], v[180:183]
    v_exp_f32 v84, v84
    v_mfma_f32_16x16x32_bf16 v[176:179], a[228:231], v[20:23], v[176:179]
    v_exp_f32 v67, v67
    v_mfma_f32_16x16x32_bf16 v[224:227], a[228:231], v[26:29], v[224:227]
    ds_read_b64_tr_b16 a[226:227], v3 offset:8192
    v_fma_f32 v68, v68, s28, v11
    v_mfma_f32_16x16x32_bf16 v[228:231], a[232:235], v[26:29], v[228:231]
    v_exp_f32 v91, v91
    v_mfma_f32_16x16x32_bf16 a[20:23], a[232:235], v[32:35], a[20:23]
    v_exp_f32 v81, v81
    v_mfma_f32_16x16x32_bf16 a[16:19], a[228:231], v[32:35], a[16:19]
    ds_read_b64_tr_b16 a[222:223], v2 offset:8192
    v_fma_f32 v69, v69, s28, v11
    v_mfma_f32_16x16x32_bf16 a[64:67], a[228:231], v[38:41], a[64:67]
    ds_read_b128 a[104:107], v104 offset:2048
    v_exp_f32 v87, v87
    v_mfma_f32_16x16x32_bf16 a[68:71], a[232:235], v[38:41], a[68:71]
    s_waitcnt lgkmcnt(4)
    ds_read_b128 a[176:179], v104 offset:20480
    v_fma_f32 v79, v79, s28, v12
    v_mfma_f32_16x16x32_bf16 a[72:75], a[212:215], v[38:41], a[72:75]
    v_exp_f32 v70, v70
    v_mfma_f32_16x16x32_bf16 a[76:79], a[216:219], v[38:41], a[76:79]
    ds_read_b64_tr_b16 a[228:229], v4 offset:2048
    v_fma_f32 v85, v85, s28, v13
    v_mfma_f32_16x16x32_bf16 a[28:31], a[216:219], v[32:35], a[28:31]
    v_exp_f32 v69, v69
    v_mfma_f32_16x16x32_bf16 a[24:27], a[212:215], v[32:35], a[24:27]
    ds_read_b64_tr_b16 a[230:231], v4 offset:8192
    v_fma_f32 v88, v88, s28, v13
    v_mfma_f32_16x16x32_bf16 v[232:235], a[212:215], v[26:29], v[232:235]
    ds_read_b64_tr_b16 a[234:235], v5 offset:8192
    v_xor_b32 v105, 64, v104
    v_mfma_f32_16x16x32_bf16 v[236:239], a[216:219], v[26:29], v[236:239]
    ds_read_b64_tr_b16 a[232:233], v5 offset:2048
    v_fma_f32 v75, v75, s28, v11
    v_mfma_f32_16x16x32_bf16 v[188:191], a[216:219], v[20:23], v[188:191]
    ds_read_b128 a[152:155], v104 offset:14336
    v_fma_f32 v74, v74, s28, v11
    v_mfma_f32_16x16x32_bf16 v[184:187], a[212:215], v[20:23], v[184:187]
    v_exp_f32 v88, v88
    v_mfma_f32_16x16x32_bf16 v[136:139], a[212:215], v[14:17], v[136:139]
    v_exp_f32 v77, v77
    v_mfma_f32_16x16x32_bf16 v[140:143], a[216:219], v[14:17], v[140:143]
    s_waitcnt lgkmcnt(5)
    ds_read_b128 a[96:99], v104 offset:0
    v_fma_f32 v86, v86, s28, v13
    v_mfma_f32_16x16x32_bf16 v[144:147], a[220:223], v[14:17], v[144:147]
    ds_read_b128 a[168:171], v104 offset:18432
    v_fma_f32 v82, v82, s28, v12
    v_mfma_f32_16x16x32_bf16 v[148:151], a[224:227], v[14:17], v[148:151]
    ds_read_b128 a[124:127], v105 offset:6144
    v_exp_f32 v79, v79
    v_mfma_f32_16x16x32_bf16 v[196:199], a[224:227], v[20:23], v[196:199]
    v_exp_f32 v85, v85
    v_mfma_f32_16x16x32_bf16 v[192:195], a[220:223], v[20:23], v[192:195]
    s_add_u32 s39, s39, 12288
    ds_read_b128 a[160:163], v104 offset:16384
    v_exp_f32 v90, v90
    v_mfma_f32_16x16x32_bf16 v[240:243], a[220:223], v[26:29], v[240:243]
    v_exp_f32 v71, v71
    v_mfma_f32_16x16x32_bf16 v[244:247], a[224:227], v[26:29], v[244:247]
    ds_read_b128 a[180:183], v105 offset:20480
    v_exp_f32 v68, v68
    v_mfma_f32_16x16x32_bf16 a[36:39], a[224:227], v[32:35], a[36:39]
    s_waitcnt vmcnt(6) lgkmcnt(5)
    v_exp_f32 v86, v86
    v_mfma_f32_16x16x32_bf16 a[32:35], a[220:223], v[32:35], a[32:35]
    v_exp_f32 v76, v76
    v_mfma_f32_16x16x32_bf16 a[80:83], a[220:223], v[38:41], a[80:83]
    s_add_u32 s21, s21, s62
    ds_read_b128 a[100:103], v105 offset:0
    v_fma_f32 v59, v59, s28, v9
    v_mfma_f32_16x16x32_bf16 a[84:87], a[224:227], v[38:41], a[84:87]
    s_barrier
    ds_read_b128 a[148:151], v105 offset:12288
    v_mfma_f32_16x16x32_bf16 a[88:91], a[228:231], v[38:41], a[88:91]
    ds_read_b128 a[212:215], v0 offset:0
    v_fma_f32 v64, v64, s28, v10
    v_mfma_f32_16x16x32_bf16 a[92:95], a[232:235], v[38:41], a[92:95]
    s_add_u32 m0, s22, 24576
    ds_read_b128 a[216:219], v1 offset:0
    buffer_load_dwordx4 v6, s[8:11], s21 offen lds
    v_mfma_f32_16x16x32_bf16 a[44:47], a[232:235], v[32:35], a[44:47]
    ds_read_b128 a[220:223], v0 offset:1024
    v_mfma_f32_16x16x32_bf16 a[40:43], a[228:231], v[32:35], a[40:43]
    ds_read_b128 a[144:147], v104 offset:12288
    v_exp_f32 v82, v82
    v_mfma_f32_16x16x32_bf16 v[248:251], a[228:231], v[26:29], v[248:251]
    s_add_u32 s21, s21, 128
    ds_read_b128 a[172:175], v105 offset:18432
    s_add_u32 m0, s22, 25600
    v_mfma_f32_16x16x32_bf16 v[252:255], a[232:235], v[26:29], v[252:255]
    ds_read_b128 a[120:123], v104 offset:6144
    buffer_load_dwordx4 v6, s[8:11], s21 offen lds
    v_mfma_f32_16x16x32_bf16 v[204:207], a[232:235], v[20:23], v[204:207]
    ds_read_b128 a[132:135], v105 offset:8192
    v_cvt_pk_bf16_f32 v36, v76, v77
    v_mfma_f32_16x16x32_bf16 v[200:203], a[228:231], v[20:23], v[200:203]
    s_add_u32 s21, s21, 128
    s_add_u32 m0, s22, 26624
    ds_read_b128 a[184:187], v104 offset:22528
    v_mfma_f32_16x16x32_bf16 v[152:155], a[228:231], v[14:17], v[152:155]
    ds_read_b128 a[164:167], v105 offset:16384
    buffer_load_dwordx4 v6, s[8:11], s21 offen lds
    v_mfma_f32_16x16x32_bf16 v[156:159], a[232:235], v[14:17], v[156:159]
    s_waitcnt lgkmcnt(8)
    ds_read_b128 a[224:227], v1 offset:1024
    v_cvt_pk_bf16_f32 v31, v70, v71
    v_mfma_f32_16x16x32_bf16 v[52:55], a[212:215], a[96:99], 0
    s_waitcnt lgkmcnt(8)
    v_exp_f32 v59, v59
    v_mfma_f32_16x16x32_bf16 v[52:55], a[216:219], a[100:103], v[52:55]
    s_waitcnt lgkmcnt(7)
    ds_read_b128 a[232:235], v1 offset:2048
    v_exp_f32 v83, v83
    v_mfma_f32_16x16x32_bf16 v[52:55], a[220:223], a[104:107], v[52:55]
    ds_read_b128 a[228:231], v0 offset:2048
    v_cvt_pk_bf16_f32 v37, v78, v79
    v_mfma_f32_16x16x32_bf16 v[60:63], a[220:223], a[128:131], 0
    ds_read_b128 a[188:191], v105 offset:22528
    v_cvt_pk_bf16_f32 v42, v84, v85
    v_mfma_f32_16x16x32_bf16 v[60:63], a[216:219], a[124:127], v[60:63]
    s_waitcnt lgkmcnt(7)
    ds_read_b128 a[136:139], v104 offset:10240
    v_cvt_pk_bf16_f32 v17, v58, v59
    v_mfma_f32_16x16x32_bf16 v[60:63], a[212:215], a[120:123], v[60:63]
    ds_read_b128 a[112:115], v104 offset:4096
    v_cvt_pk_bf16_f32 v30, v68, v69
    v_mfma_f32_16x16x32_bf16 v[68:71], a[212:215], a[144:147], 0
    ds_read_b128 a[156:159], v105 offset:14336
    v_cvt_pk_bf16_f32 v41, v90, v91
    v_mfma_f32_16x16x32_bf16 v[68:71], a[216:219], a[148:151], v[68:71]
    ds_read_b128 a[140:143], v105 offset:10240
    v_cvt_pk_bf16_f32 v43, v86, v87
    v_mfma_f32_16x16x32_bf16 v[68:71], a[220:223], a[152:155], v[68:71]
    v_exp_f32 v64, v64
    v_mfma_f32_16x16x32_bf16 v[76:79], a[220:223], a[176:179], 0
    v_exp_f32 v74, v74
    v_mfma_f32_16x16x32_bf16 v[76:79], a[216:219], a[172:175], v[76:79]
    ds_read_b128 a[116:119], v105 offset:4096
    v_fma_f32 v80, v80, s28, v12
    v_mfma_f32_16x16x32_bf16 v[76:79], a[212:215], a[168:171], v[76:79]
    s_waitcnt lgkmcnt(7)
    ds_read_b128 a[108:111], v105 offset:2048
    v_exp_f32 v57, v57
    v_mfma_f32_16x16x32_bf16 v[76:79], a[224:227], a[180:183], v[76:79]
    s_waitcnt lgkmcnt(7)
    v_exp_f32 v56, v56
    v_mfma_f32_16x16x32_bf16 v[76:79], a[228:231], a[184:187], v[76:79]
    s_waitcnt lgkmcnt(6)
    ds_read_b128 a[212:215], v0 offset:6144
    v_cvt_pk_bf16_f32 v22, v64, v65
    v_mfma_f32_16x16x32_bf16 v[76:79], a[232:235], a[188:191], v[76:79]
    v_exp_f32 v89, v89
    v_mfma_f32_16x16x32_bf16 v[68:71], a[232:235], a[164:167], v[68:71]
    v_exp_f32 v75, v75
    v_mfma_f32_16x16x32_bf16 v[68:71], a[228:231], a[160:163], v[68:71]
    s_waitcnt lgkmcnt(4)
    v_exp_f32 v80, v80
    v_mfma_f32_16x16x32_bf16 v[68:71], a[224:227], a[156:159], v[68:71]
    v_exp_f32 v72, v72
    v_mfma_f32_16x16x32_bf16 v[60:63], a[224:227], a[132:135], v[60:63]
    v_exp_f32 v66, v66
    v_mfma_f32_16x16x32_bf16 v[60:63], a[228:231], a[136:139], v[60:63]
    s_waitcnt lgkmcnt(3)
    ds_read_b128 a[216:219], v1 offset:6144
    v_cvt_pk_bf16_f32 v23, v66, v67
    v_mfma_f32_16x16x32_bf16 v[60:63], a[232:235], a[140:143], v[60:63]
    s_waitcnt lgkmcnt(3)
    ds_read_b128 a[220:223], v0 offset:7168
    v_cvt_pk_bf16_f32 v40, v88, v89
    v_mfma_f32_16x16x32_bf16 v[52:55], a[232:235], a[116:119], v[52:55]
    v_cvt_pk_bf16_f32 v29, v74, v75
    v_cvt_pk_bf16_f32 v16, v56, v57
    v_mfma_f32_16x16x32_bf16 v[52:55], a[228:231], a[112:115], v[52:55]
    s_waitcnt lgkmcnt(3)
    ds_read_b128 a[232:235], v1 offset:8192
    v_mfma_f32_16x16x32_bf16 v[52:55], a[224:227], a[108:111], v[52:55]
    ds_read_b128 a[228:231], v0 offset:8192
    v_cvt_pk_bf16_f32 v35, v82, v83
    v_mfma_f32_16x16x32_bf16 v[48:51], a[236:239], v[16:19], v[44:47]
    ds_read_b128 a[224:227], v1 offset:7168
    v_cvt_pk_bf16_f32 v28, v72, v73
    v_mfma_f32_16x16x32_bf16 v[48:51], a[240:243], v[22:25], v[48:51]
    v_cvt_pk_bf16_f32 v34, v80, v81
    v_mfma_f32_16x16x32_bf16 v[48:51], a[244:247], v[28:31], v[48:51]
    s_nop 0
    v_mfma_f32_16x16x32_bf16 v[48:51], a[248:251], v[34:37], v[48:51]
    v_mfma_f32_16x16x32_bf16 v[48:51], a[252:255], v[40:43], v[48:51]
    s_waitcnt lgkmcnt(5)
    v_mfma_f32_16x16x32_bf16 v[56:59], a[212:215], a[96:99], 0
    s_waitcnt lgkmcnt(4)
    v_mfma_f32_16x16x32_bf16 v[56:59], a[216:219], a[100:103], v[56:59]
    s_waitcnt lgkmcnt(3)
    v_mfma_f32_16x16x32_bf16 v[56:59], a[220:223], a[104:107], v[56:59]
    s_nop 1
    v_cmp_lt_f32 vcc, s29, v48
    v_mfma_f32_16x16x32_bf16 v[64:67], a[220:223], a[128:131], 0
    s_add_u32 s21, s21, 12032
    v_mfma_f32_16x16x32_bf16 v[64:67], a[216:219], a[124:127], v[64:67]
    v_mfma_f32_16x16x32_bf16 v[64:67], a[212:215], a[120:123], v[64:67]
    s_waitcnt vmcnt(6) lgkmcnt(0)
    s_cbranch_vccnz L_rs_tr54b
L_ret_tr54b:
    v_mfma_f32_16x16x32_bf16 v[72:75], a[212:215], a[144:147], 0
    s_barrier
    v_mfma_f32_16x16x32_bf16 v[72:75], a[216:219], a[148:151], v[72:75]
    s_add_u32 m0, s22, 0
    v_mov_b32 v100, v48
    v_lshrrev_b32 v108, 11, v0
    v_mfma_f32_16x16x32_bf16 v[72:75], a[220:223], a[152:155], v[72:75]
    buffer_load_dwordx4 v6, s[4:7], s20 offen lds
    v_mfma_f32_16x16x32_bf16 v[80:83], a[220:223], a[176:179], 0
    v_and_b32 v101, 0x3ff, v0
    v_xor_b32 v108, s65, v108
    v_mfma_f32_16x16x32_bf16 v[80:83], a[216:219], a[172:175], v[80:83]
    s_add_u32 s20, s20, 128
    v_rcp_f32 v8, v51
    v_mfma_f32_16x16x32_bf16 v[80:83], a[212:215], a[168:171], v[80:83]
    s_add_u32 m0, s22, 1024
    ds_read_b64_tr_b16 a[212:213], v2 offset:18432
    buffer_load_dwordx4 v6, s[4:7], s20 offen lds
    v_lshl_add_u32 v101, v108, 10, v101
    v_mfma_f32_16x16x32_bf16 v[80:83], a[224:227], a[180:183], v[80:83]
    s_add_u32 s20, s20, 128
    ds_read_b64_tr_b16 a[214:215], v2 offset:12288
    v_mbcnt_lo_u32_b32 v108, -1, 0
    v_mfma_f32_16x16x32_bf16 v[80:83], a[228:231], a[184:187], v[80:83]
    s_add_u32 m0, s22, 2048
    ds_read_b64_tr_b16 a[216:217], v3 offset:18432
    buffer_load_dwordx4 v6, s[4:7], s20 offen lds
    v_mfma_f32_16x16x32_bf16 v[80:83], a[232:235], a[188:191], v[80:83]
    ds_read_b64_tr_b16 a[218:219], v3 offset:12288
    v_mbcnt_hi_u32_b32 v108, -1, v108
    v_add_u32 v101, s38, v101
    v_mfma_f32_16x16x32_bf16 v[72:75], a[232:235], a[164:167], v[72:75]
    v_lshrrev_b32 v108, 1, v108
    v_rcp_f32 v50, v50
    v_mfma_f32_16x16x32_bf16 v[72:75], a[228:231], a[160:163], v[72:75]
    v_and_b32 v108, 24, v108
    v_permlane32_swap_b32 v48, v100
    v_mfma_f32_16x16x32_bf16 v[72:75], a[224:227], a[156:159], v[72:75]
    ds_read_b64_tr_b16 a[220:221], v4 offset:18432
    v_bfe_u32 v108, s66, v108, 8
    v_mfma_f32_16x16x32_bf16 v[64:67], a[224:227], a[132:135], v[64:67]
    v_xor_b32 v101, v101, v108
    v_mov_b32 v108, v100
    v_mfma_f32_16x16x32_bf16 v[64:67], a[228:231], a[136:139], v[64:67]
    ds_read_b64_tr_b16 a[222:223], v4 offset:12288
    v_rcp_f32 v102, v49
    v_mfma_f32_16x16x32_bf16 v[64:67], a[232:235], a[140:143], v[64:67]
    v_rcp_f32 v48, v48
    v_mfma_f32_16x16x32_bf16 v[56:59], a[232:235], a[116:119], v[56:59]
    s_add_u32 s20, s20, 12032
    v_permlane16_swap_b32 v100, v108
    v_mfma_f32_16x16x32_bf16 v[56:59], a[228:231], a[112:115], v[56:59]
    v_rcp_f32 v100, v100
    v_mfma_f32_16x16x32_bf16 v[56:59], a[224:227], a[108:111], v[56:59]
    s_waitcnt lgkmcnt(2)
    ds_read_b64_tr_b16 a[224:225], v5 offset:18432
    ds_read_b64_tr_b16 a[226:227], v5 offset:12288
    v_mfma_f32_16x16x32_bf16 v[112:115], a[212:215], v[16:19], v[112:115]
    v_max3_f32 v98, v68, v69, v70
    v_max3_f32 v97, v60, v61, v62
    v_mfma_f32_16x16x32_bf16 v[116:119], a[216:219], v[16:19], v[116:119]
    s_mov_b32 s67, s34
    v_max3_f32 v96, v52, v53, v54
    v_max3_f32 v97, v97, v63, v64
    v_max3_f32 v96, v96, v55, v56
    v_mfma_f32_16x16x32_bf16 v[164:167], a[216:219], v[22:25], v[164:167]
    ds_read_b64_tr_b16 a[234:235], v3 offset:13312
    v_max3_f32 v96, v96, v57, v58
    v_max3_f32 v99, v76, v77, v78
    v_mfma_f32_16x16x32_bf16 v[160:163], a[212:215], v[22:25], v[160:163]
    s_add_u32 s18, s34, 30720
    v_max3_f32 v98, v98, v71, v72
    v_max_f32 v96, v96, v59
    v_mfma_f32_16x16x32_bf16 v[208:211], a[212:215], v[28:31], v[208:211]
    s_mov_b32 s34, s33
    v_max3_f32 v97, v97, v65, v66
    v_max3_f32 v98, v98, v73, v74
    v_max3_f32 v99, v99, v79, v80
    v_max3_f32 v99, v99, v81, v82
    v_mfma_f32_16x16x32_bf16 v[212:215], a[216:219], v[28:31], v[212:215]
    s_add_u32 s64, s64, s62
    ds_read_b64_tr_b16 a[232:233], v3 offset:19456
    v_max_f32 v99, v99, v83
    v_mfma_f32_16x16x32_bf16 a[4:7], a[216:219], v[34:37], a[4:7]
    ds_read_b64_tr_b16 a[230:231], v2 offset:13312
    v_max_f32 v97, v97, v67
    v_mfma_f32_16x16x32_bf16 a[0:3], a[212:215], v[34:37], a[0:3]
    s_add_u32 s64, s64, 196608
    ds_read_b64_tr_b16 a[228:229], v2 offset:19456
    v_max_f32 v98, v98, v75
    v_mfma_f32_16x16x32_bf16 a[48:51], a[212:215], v[40:43], a[48:51]
    v_permlane32_swap_b32 v96, v97
    v_permlane32_swap_b32 v98, v99
    v_mfma_f32_16x16x32_bf16 a[52:55], a[216:219], v[40:43], a[52:55]
    s_waitcnt lgkmcnt(4)
    v_max_f32 v98, v98, v99
    v_max_f32 v96, v96, v97
    v_mfma_f32_16x16x32_bf16 a[56:59], a[220:223], v[40:43], a[56:59]
    s_mov_b32 s39, s64
    v_permlane16_swap_b32 v96, v98
    v_mfma_f32_16x16x32_bf16 a[60:63], a[224:227], v[40:43], a[60:63]
    s_add_u32 s37, s37, 1
    ds_read_b64_tr_b16 a[212:213], v4 offset:19456
    v_max_f32 v96, v96, v98
    v_mfma_f32_16x16x32_bf16 a[12:15], a[224:227], v[34:37], a[12:15]
    s_bitcmp1_b32 s63, s37
    v_mul_f32_e64 v9, -s28, v96
    v_mov_b32 v11, v9
    v_mfma_f32_16x16x32_bf16 a[8:11], a[220:223], v[34:37], a[8:11]
    s_cselect_b32 s62, 4294770688, 0
    v_permlane16_swap_b32 v9, v11
    v_mfma_f32_16x16x32_bf16 v[216:219], a[220:223], v[28:31], v[216:219]
    s_cselect_b32 s42, 0, 325632
    v_mov_b32 v12, v11
    s_add_u32 s35, s35, s42
    v_mfma_f32_16x16x32_bf16 v[220:223], a[224:227], v[28:31], v[220:223]
    s_lshl_b32 s42, s37, 1
    ds_read_b64_tr_b16 a[216:217], v5 offset:19456
    v_mov_b32 v10, v9
    v_mfma_f32_16x16x32_bf16 v[172:175], a[224:227], v[22:25], v[172:175]
    s_lshr_b32 s42, s31, s42
    ds_read_b64_tr_b16 a[218:219], v5 offset:13312
    v_permlane32_swap_b32 v9, v10
    v_mfma_f32_16x16x32_bf16 v[168:171], a[220:223], v[22:25], v[168:171]
    s_and_b32 s42, s42, 3
    v_permlane32_swap_b32 v11, v12
    v_fma_f32 v65, v65, s28, v10
    v_mfma_f32_16x16x32_bf16 v[120:123], a[220:223], v[16:19], v[120:123]
    s_add_u32 s42, s42, s36
    v_fma_f32 v64, v64, s28, v10
    v_fma_f32 v66, v66, s28, v10
    v_mfma_f32_16x16x32_bf16 v[124:127], a[224:227], v[16:19], v[124:127]
    s_waitcnt lgkmcnt(3)
    ds_read_b64_tr_b16 a[222:223], v2 offset:14336
    v_subrev_u32 v103, 28672, v103
    v_mfma_f32_16x16x32_bf16 v[128:131], a[228:231], v[16:19], v[128:131]
    s_sub_u32 s43, s42, 3
    v_fma_f32 v68, v68, s28, v11
    v_fma_f32 v63, v63, s28, v10
    v_fma_f32 v72, v72, s28, v11
    v_fma_f32 v61, v61, s28, v10
    v_mfma_f32_16x16x32_bf16 v[132:135], a[232:235], v[16:19], v[132:135]
    s_cmp_ge_u32 s42, 3
    ds_read_b64_tr_b16 a[214:215], v4 offset:13312
    v_fma_f32 v80, v80, s28, v12
    v_mfma_f32_16x16x32_bf16 v[180:183], a[232:235], v[22:25], v[180:183]
    s_cselect_b32 s42, s43, s42
    v_fma_f32 v79, v79, s28, v12
    v_fma_f32 v53, v53, s28, v9
    v_mfma_f32_16x16x32_bf16 v[176:179], a[228:231], v[22:25], v[176:179]
    s_mul_i32 s44, s3, 5
    v_exp_f32 v79, v79
    v_mfma_f32_16x16x32_bf16 v[224:227], a[228:231], v[28:31], v[224:227]
    s_mov_b32 s32, 1
    ds_read_b64_tr_b16 a[226:227], v3 offset:14336
    v_mov_b32 v39, v7
    v_fma_f32 v55, v55, s28, v9
    v_fma_f32 v62, v62, s28, v10
    v_fma_f32 v75, v75, s28, v11
    v_pk_mul_f32 v[116:117], v[116:117], v[48:49] op_sel_hi:[1,0]
    v_pk_mul_f32 v[208:209], v[208:209], v[50:51] op_sel_hi:[1,0]
    v_fma_f32 v67, v67, s28, v10
    v_fma_f32 v54, v54, s28, v9
    v_mfma_f32_16x16x32_bf16 v[228:231], a[232:235], v[28:31], v[228:231]
    s_lshl_b32 s43, s3, 2
    ds_read_b64_tr_b16 a[224:225], v3 offset:20480
    v_fma_f32 v81, v81, s28, v12
    v_cvt_pk_bf16_f32 v208, v208, v209
    v_mfma_f32_16x16x32_bf16 a[20:23], a[232:235], v[34:37], a[20:23]
    s_add_u32 s45, s43, 21
    v_exp_f32 v54, v54
    v_mfma_f32_16x16x32_bf16 a[16:19], a[228:231], v[34:37], a[16:19]
    s_cmp_eq_u32 s3, 0
    v_exp_f32 v53, v53
    v_mfma_f32_16x16x32_bf16 a[64:67], a[228:231], v[40:43], a[64:67]
    s_cselect_b32 s45, 20, s45
    ds_read_b64_tr_b16 a[220:221], v2 offset:20480
    v_accvgpr_read_b32 v107, a3
    v_mfma_f32_16x16x32_bf16 a[68:71], a[232:235], v[40:43], a[68:71]
    s_waitcnt lgkmcnt(3)
    ds_read_b64_tr_b16 a[234:235], v5 offset:14336
    v_fma_f32 v52, v52, s28, v9
    v_mfma_f32_16x16x32_bf16 a[72:75], a[212:215], v[40:43], a[72:75]
    s_cselect_b32 s33, 1, 0
    v_fma_f32 v74, v74, s28, v11
    v_fma_f32 v57, v57, s28, v9
    v_mfma_f32_16x16x32_bf16 a[76:79], a[216:219], v[40:43], a[76:79]
    s_cmp_eq_u32 s42, 1
    v_fma_f32 v69, v69, s28, v11
    v_fma_f32 v71, v71, s28, v11
    v_fma_f32 v58, v58, s28, v9
    v_mfma_f32_16x16x32_bf16 a[28:31], a[216:219], v[34:37], a[28:31]
    s_cselect_b32 s44, s45, s44
    v_exp_f32 v62, v62
    v_mfma_f32_16x16x32_bf16 a[24:27], a[212:215], v[34:37], a[24:27]
    s_cselect_b32 s32, s33, s32
    ds_read_b64_tr_b16 a[228:229], v4 offset:20480
    v_fma_f32 v56, v56, s28, v9
    v_mfma_f32_16x16x32_bf16 v[232:235], a[212:215], v[28:31], v[232:235]
    s_add_u32 s45, s43, 37
    ds_read_b64_tr_b16 a[232:233], v5 offset:20480
    s_cmp_eq_u32 s42, 2
    v_mfma_f32_16x16x32_bf16 v[236:239], a[216:219], v[28:31], v[236:239]
    s_cselect_b32 s44, s45, s44
    v_exp_f32 v52, v52
    v_mfma_f32_16x16x32_bf16 v[188:191], a[216:219], v[22:25], v[188:191]
    s_cselect_b32 s32, 0, s32
    v_exp_f32 v67, v67
    v_mfma_f32_16x16x32_bf16 v[184:187], a[212:215], v[22:25], v[184:187]
    s_mul_i32 s44, s44, 6144
    v_exp_f32 v63, v63
    v_mfma_f32_16x16x32_bf16 v[136:139], a[212:215], v[16:19], v[136:139]
    s_add_u32 s33, s35, s44
    ds_read_b64_tr_b16 a[230:231], v4 offset:14336
    v_accvgpr_read_b32 v104, a0
    v_mfma_f32_16x16x32_bf16 v[140:143], a[216:219], v[16:19], v[140:143]
    s_waitcnt lgkmcnt(3)
    v_fma_f32 v78, v78, s28, v12
    v_fma_f32 v83, v83, s28, v12
    v_mfma_f32_16x16x32_bf16 v[144:147], a[220:223], v[16:19], v[144:147]
    s_mul_i32 s42, s32, 6144
    v_cvt_pk_bf16_f32 v21, v62, v63
    v_fma_f32 v76, v76, s28, v12
    v_mfma_f32_16x16x32_bf16 v[148:151], a[224:227], v[16:19], v[148:151]
    s_add_u32 s42, s42, 24576
    s_add_u32 s42, s42, s33
    v_fma_f32 v70, v70, s28, v11
    v_mfma_f32_16x16x32_bf16 v[196:199], a[224:227], v[22:25], v[196:199]
    s_cmp_ge_u32 s37, 6
    v_exp_f32 v78, v78
    v_mfma_f32_16x16x32_bf16 v[192:195], a[220:223], v[22:25], v[192:195]
    s_cselect_b32 s14, 0, s42
    v_exp_f32 v55, v55
    v_mfma_f32_16x16x32_bf16 v[240:243], a[220:223], v[28:31], v[240:243]
    s_add_u32 s24, s67, 6144
    v_exp_f32 v76, v76
    v_mfma_f32_16x16x32_bf16 v[244:247], a[224:227], v[28:31], v[244:247]
    s_add_u32 s25, s33, 6144
    s_add_u32 s23, s38, 6144
    v_mov_b32 v38, v6
    v_mfma_f32_16x16x32_bf16 a[36:39], a[224:227], v[34:37], a[36:39]
    s_mov_b32 s27, 0x30c30
    v_fma_f32 v60, v60, s28, v10
    v_fma_f32 v77, v77, s28, v12
    v_cvt_pk_bf16_f32 v14, v52, v53
    v_mfma_f32_16x16x32_bf16 a[32:35], a[220:223], v[34:37], a[32:35]
    s_mov_b32 s89, 0xaaaaaaaa
    v_exp_f32 v71, v71
    v_mfma_f32_16x16x32_bf16 a[80:83], a[220:223], v[40:43], a[80:83]
    s_mov_b32 s30, 0
    v_exp_f32 v61, v61
    v_mfma_f32_16x16x32_bf16 a[84:87], a[224:227], v[40:43], a[84:87]
    s_waitcnt vmcnt(6) lgkmcnt(0)
    v_exp_f32 v69, v69
    v_mfma_f32_16x16x32_bf16 a[88:91], a[228:231], v[40:43], a[88:91]
    s_barrier
    ds_read_b128 a[212:215], v0 offset:12288
    v_mfma_f32_16x16x32_bf16 a[92:95], a[232:235], v[40:43], a[92:95]
    ds_read_b128 a[216:219], v1 offset:12288
    v_fma_f32 v73, v73, s28, v11
    v_mfma_f32_16x16x32_bf16 a[44:47], a[232:235], v[34:37], a[44:47]
    ds_read_b128 a[220:223], v0 offset:13312
    v_exp_f32 v77, v77
    v_mfma_f32_16x16x32_bf16 a[40:43], a[228:231], v[34:37], a[40:43]
    v_accvgpr_read_b32 v106, a2
    v_fma_f32 v82, v82, s28, v12
    v_mfma_f32_16x16x32_bf16 v[248:251], a[228:231], v[28:31], v[248:251]
    v_fma_f32 v59, v59, s28, v9
    v_exp_f32 v68, v68
    v_mfma_f32_16x16x32_bf16 v[252:255], a[232:235], v[28:31], v[252:255]
    v_exp_f32 v60, v60
    v_cvt_pk_bf16_f32 v15, v54, v55
    v_mfma_f32_16x16x32_bf16 v[204:207], a[232:235], v[22:25], v[204:207]
    ds_read_b128 a[224:227], v1 offset:13312
    v_exp_f32 v70, v70
    v_mfma_f32_16x16x32_bf16 v[200:203], a[228:231], v[22:25], v[200:203]
    s_add_u32 m0, s22, 36864
    v_cvt_pk_bf16_f32 v33, v78, v79
    v_accvgpr_read_b32 v110, a50
    v_mfma_f32_16x16x32_bf16 v[152:155], a[228:231], v[16:19], v[152:155]
    v_exp_f32 v73, v73
    v_mfma_f32_16x16x32_bf16 v[156:159], a[232:235], v[16:19], v[156:159]
    s_waitcnt lgkmcnt(3)
    ds_read_b128 a[228:231], v0 offset:14336
    v_accvgpr_read_b32 v108, a48
    v_mfma_f32_16x16x32_bf16 v[52:55], a[212:215], a[96:99], 0
    s_waitcnt lgkmcnt(3)
    v_exp_f32 v82, v82
    v_mfma_f32_16x16x32_bf16 v[52:55], a[216:219], a[100:103], v[52:55]
    s_waitcnt lgkmcnt(2)
    v_exp_f32 v66, v66
    v_exp_f32 v81, v81
    v_mfma_f32_16x16x32_bf16 v[52:55], a[220:223], a[104:107], v[52:55]
    v_cvt_pk_bf16_f32 v32, v76, v77
    v_cvt_pk_bf16_f32 v20, v60, v61
    v_mfma_f32_16x16x32_bf16 v[60:63], a[220:223], a[128:131], 0
    ds_read_b128 a[232:235], v1 offset:14336
    v_cvt_pk_bf16_f32 v26, v68, v69
    v_mfma_f32_16x16x32_bf16 v[60:63], a[216:219], a[124:127], v[60:63]
    v_cvt_pk_bf16_f32 v27, v70, v71
    v_exp_f32 v65, v65
    v_mfma_f32_16x16x32_bf16 v[60:63], a[212:215], a[120:123], v[60:63]
    v_exp_f32 v58, v58
    v_mfma_f32_16x16x32_bf16 v[68:71], a[212:215], a[144:147], 0
    v_accvgpr_read_b32 v105, a1
    v_accvgpr_read_b32 v109, a49
    v_mfma_f32_16x16x32_bf16 v[68:71], a[216:219], a[148:151], v[68:71]
    buffer_load_dwordx4 v6, s[8:11], s21 offen lds
    v_mfma_f32_16x16x32_bf16 v[68:71], a[220:223], a[152:155], v[68:71]
    v_exp_f32 v83, v83
    v_mfma_f32_16x16x32_bf16 v[76:79], a[220:223], a[176:179], 0
    v_exp_f32 v80, v80
    v_mfma_f32_16x16x32_bf16 v[76:79], a[216:219], a[172:175], v[76:79]
    v_exp_f32 v59, v59
    v_mfma_f32_16x16x32_bf16 v[76:79], a[212:215], a[168:171], v[76:79]
    s_waitcnt lgkmcnt(1)
    v_exp_f32 v72, v72
    v_mfma_f32_16x16x32_bf16 v[76:79], a[224:227], a[180:183], v[76:79]
    v_exp_f32 v75, v75
    v_mfma_f32_16x16x32_bf16 v[76:79], a[228:231], a[184:187], v[76:79]
    s_waitcnt lgkmcnt(0)
    v_exp_f32 v74, v74
    v_exp_f32 v57, v57
    v_mfma_f32_16x16x32_bf16 v[76:79], a[232:235], a[188:191], v[76:79]
    v_cvt_pk_bf16_f32 v116, v116, v117
    v_cvt_pk_bf16_f32 v35, v82, v83
    v_mfma_f32_16x16x32_bf16 v[68:71], a[232:235], a[164:167], v[68:71]
    ds_read_b128 a[212:215], v0 offset:18432
    v_exp_f32 v56, v56
    v_mfma_f32_16x16x32_bf16 v[68:71], a[228:231], a[160:163], v[68:71]
    s_add_u32 s21, s21, 128
    v_exp_f32 v64, v64
    v_mfma_f32_16x16x32_bf16 v[68:71], a[224:227], a[156:159], v[68:71]
    ds_read_b128 a[216:219], v1 offset:18432
    v_fma_f32 v78, v78, s28, v12
    v_mfma_f32_16x16x32_bf16 v[60:63], a[224:227], a[132:135], v[60:63]
    v_fma_f32 v79, v79, s28, v12
    v_accvgpr_read_b32 v111, a51
    v_mfma_f32_16x16x32_bf16 v[60:63], a[228:231], a[136:139], v[60:63]
    v_exp_f32 v79, v79
    v_mfma_f32_16x16x32_bf16 v[60:63], a[232:235], a[140:143], v[60:63]
    s_add_u32 m0, s22, 37888
    ds_read_b128 a[220:223], v0 offset:19456
    buffer_load_dwordx4 v6, s[8:11], s21 offen lds
    v_exp_f32 v78, v78
    v_pk_mul_f32 v[216:217], v[216:217], v[50:51] op_sel_hi:[1,0]
    v_pk_mul_f32 v[108:109], v[108:109], v[100:101] op_sel_hi:[1,0]
    v_pk_mul_f32 v[218:219], v[218:219], v[50:51] op_sel_hi:[1,0]
    v_pk_mul_f32 v[210:211], v[210:211], v[50:51] op_sel_hi:[1,0]
    v_pk_mul_f32 v[112:113], v[112:113], v[48:49] op_sel_hi:[1,0]
    v_pk_mul_f32 v[220:221], v[220:221], v[50:51] op_sel_hi:[1,0]
    v_pk_mul_f32 v[224:225], v[224:225], v[50:51] op_sel_hi:[1,0]
    v_pk_mul_f32 v[180:181], v[180:181], v[102:103] op_sel_hi:[1,0]
    v_pk_mul_f32 v[152:153], v[152:153], v[48:49] op_sel_hi:[1,0]
    v_pk_mul_f32 v[136:137], v[136:137], v[48:49] op_sel_hi:[1,0]
    v_pk_mul_f32 v[212:213], v[212:213], v[50:51] op_sel_hi:[1,0]
    v_pk_mul_f32 v[130:131], v[130:131], v[48:49] op_sel_hi:[1,0]
    v_pk_mul_f32 v[114:115], v[114:115], v[48:49] op_sel_hi:[1,0]
    v_pk_mul_f32 v[110:111], v[110:111], v[100:101] op_sel_hi:[1,0]
    v_pk_mul_f32 v[162:163], v[162:163], v[102:103] op_sel_hi:[1,0]
    v_pk_mul_f32 v[214:215], v[214:215], v[50:51] op_sel_hi:[1,0]
    v_pk_mul_f32 v[160:161], v[160:161], v[102:103] op_sel_hi:[1,0]
    v_pk_mul_f32 v[226:227], v[226:227], v[50:51] op_sel_hi:[1,0]
    v_cvt_pk_bf16_f32 v22, v64, v65
    v_pk_mul_f32 v[168:169], v[168:169], v[102:103] op_sel_hi:[1,0]
    v_pk_mul_f32 v[104:105], v[104:105], v[8:9] op_sel_hi:[1,0]
    v_pk_mul_f32 v[120:121], v[120:121], v[48:49] op_sel_hi:[1,0]
    v_pk_mul_f32 v[192:193], v[192:193], v[102:103] op_sel_hi:[1,0]
    v_pk_mul_f32 v[200:201], v[200:201], v[102:103] op_sel_hi:[1,0]
    v_cvt_pk_bf16_f32 v209, v210, v211
    v_pk_mul_f32 v[252:253], v[252:253], v[50:51] op_sel_hi:[1,0]
    v_pk_mul_f32 v[128:129], v[128:129], v[48:49] op_sel_hi:[1,0]
    v_cvt_pk_bf16_f32 v104, v104, v105
    v_cvt_pk_bf16_f32 v108, v108, v109
    v_pk_mul_f32 v[106:107], v[106:107], v[8:9] op_sel_hi:[1,0]
    v_cvt_pk_bf16_f32 v16, v56, v57
    v_pk_mul_f32 v[166:167], v[166:167], v[102:103] op_sel_hi:[1,0]
    v_pk_mul_f32 v[164:165], v[164:165], v[102:103] op_sel_hi:[1,0]
    v_cvt_pk_bf16_f32 v109, v110, v111
    v_cvt_pk_bf16_f32 v17, v58, v59
    v_mfma_f32_16x16x32_bf16 v[52:55], a[232:235], a[116:119], v[52:55]
    v_cvt_pk_bf16_f32 v220, v220, v221
    v_accvgpr_read_b32 v111, a55
    v_cvt_pk_bf16_f32 v216, v216, v217
    v_cvt_pk_bf16_f32 v105, v106, v107
    v_mfma_f32_16x16x32_bf16 v[52:55], a[228:231], a[112:115], v[52:55]
    v_cvt_pk_bf16_f32 v29, v74, v75
    v_fma_f32 v69, v69, s28, v11
    v_mfma_f32_16x16x32_bf16 v[52:55], a[224:227], a[108:111], v[52:55]
    s_waitcnt lgkmcnt(0)
    ds_read_b128 a[232:235], v1 offset:20480
    v_cvt_pk_bf16_f32 v34, v80, v81
    v_cvt_pk_bf16_f32 v252, v252, v253
    v_mfma_f32_16x16x32_bf16 v[56:59], a[212:215], a[96:99], 0
    ds_read_b128 a[228:231], v0 offset:20480
    v_fma_f32 v76, v76, s28, v12
    v_mfma_f32_16x16x32_bf16 v[56:59], a[216:219], a[100:103], v[56:59]
    s_add_u32 s21, s21, 128
    v_fma_f32 v63, v63, s28, v10
    v_cvt_pk_bf16_f32 v23, v66, v67
    v_mfma_f32_16x16x32_bf16 v[56:59], a[220:223], a[104:107], v[56:59]
    ds_read_b128 a[224:227], v1 offset:19456
    v_cvt_pk_bf16_f32 v28, v72, v73
    v_mfma_f32_16x16x32_bf16 v[64:67], a[220:223], a[128:131], 0
    v_cvt_pk_bf16_f32 v160, v160, v161
    v_cvt_pk_bf16_f32 v112, v112, v113
    v_mfma_f32_16x16x32_bf16 v[64:67], a[216:219], a[124:127], v[64:67]
    v_cvt_pk_bf16_f32 v161, v162, v163
    v_fma_f32 v53, v53, s28, v9
    v_mfma_f32_16x16x32_bf16 v[64:67], a[212:215], a[120:123], v[64:67]
    s_add_u32 m0, s22, 38912
    v_cvt_pk_bf16_f32 v224, v224, v225
    v_cvt_pk_bf16_f32 v164, v164, v165
    v_mfma_f32_16x16x32_bf16 v[72:75], a[212:215], a[144:147], 0
    v_cvt_pk_bf16_f32 v113, v114, v115
    v_cvt_pk_bf16_f32 v128, v128, v129
    v_mfma_f32_16x16x32_bf16 v[72:75], a[216:219], a[148:151], v[72:75]
    ds_write2st64_b64 v101, v[112:113], v[160:161] offset0:0 offset1:12
    v_fma_f32 v71, v71, s28, v11
    v_cvt_pk_bf16_f32 v152, v152, v153
    v_mfma_f32_16x16x32_bf16 v[72:75], a[220:223], a[152:155], v[72:75]
    buffer_load_dwordx4 v6, s[8:11], s21 offen lds
    v_mfma_f32_16x16x32_bf16 v[80:83], a[220:223], a[176:179], 0
    ds_write2st64_b64 v101, v[208:209], v[104:105] offset0:24 offset1:36
    v_cvt_pk_bf16_f32 v120, v120, v121
    v_mfma_f32_16x16x32_bf16 v[80:83], a[216:219], a[172:175], v[80:83]
    s_add_u32 s21, s21, 12032
    ds_write_b64 v101, v[108:109] offset:24576
    v_mfma_f32_16x16x32_bf16 v[80:83], a[212:215], a[168:171], v[80:83]
    s_waitcnt vmcnt(6) lgkmcnt(3)
    v_fma_f32 v61, v61, s28, v10
    v_cvt_pk_bf16_f32 v225, v226, v227
    v_mfma_f32_16x16x32_bf16 v[80:83], a[224:227], a[180:183], v[80:83]
    s_barrier
    ds_read_b64_tr_b16 a[212:213], v2 offset:0
    v_mfma_f32_16x16x32_bf16 v[80:83], a[228:231], a[184:187], v[80:83]
    v_accvgpr_read_b32 v109, a53
    v_cvt_pk_bf16_f32 v168, v168, v169
    v_mfma_f32_16x16x32_bf16 v[80:83], a[232:235], a[188:191], v[80:83]
    s_add_u32 m0, s22, 12288
    v_fma_f32 v68, v68, s28, v11
    v_accvgpr_read_b32 v105, a5
    v_accvgpr_read_b32 v106, a6
    v_mfma_f32_16x16x32_bf16 v[72:75], a[232:235], a[164:167], v[72:75]
    buffer_load_dwordx4 v6, s[4:7], s20 offen lds
    v_mfma_f32_16x16x32_bf16 v[44:47], a[236:239], v[14:17], 0
    s_add_u32 s20, s20, 128
    v_exp_f32 v69, v69
    v_mfma_f32_16x16x32_bf16 v[72:75], a[228:231], a[160:163], v[72:75]
    v_exp_f32 v53, v53
    v_mfma_f32_16x16x32_bf16 v[72:75], a[224:227], a[156:159], v[72:75]
    v_cvt_pk_bf16_f32 v212, v212, v213
    v_accvgpr_read_b32 v110, a54
    v_mfma_f32_16x16x32_bf16 v[64:67], a[224:227], a[132:135], v[64:67]
    ds_read_b64_tr_b16 a[214:215], v2 offset:6144
    v_fma_f32 v55, v55, s28, v9
    v_mfma_f32_16x16x32_bf16 v[64:67], a[228:231], a[136:139], v[64:67]
    v_fma_f32 v52, v52, s28, v9
    v_accvgpr_read_b32 v107, a7
    v_fma_f32 v81, v81, s28, v12
    v_mfma_f32_16x16x32_bf16 v[64:67], a[232:235], a[140:143], v[64:67]
    ds_read_b64_tr_b16 a[216:217], v3 offset:0
    v_fma_f32 v54, v54, s28, v9
    v_accvgpr_read_b32 v104, a4
    v_exp_f32 v55, v55
    v_fma_f32 v82, v82, s28, v12
    v_pk_mul_f32 v[242:243], v[242:243], v[50:51] op_sel_hi:[1,0]
    v_pk_mul_f32 v[238:239], v[238:239], v[50:51] op_sel_hi:[1,0]
    v_pk_mul_f32 v[182:183], v[182:183], v[102:103] op_sel_hi:[1,0]
    v_pk_mul_f32 v[142:143], v[142:143], v[48:49] op_sel_hi:[1,0]
    v_pk_mul_f32 v[236:237], v[236:237], v[50:51] op_sel_hi:[1,0]
    v_pk_mul_f32 v[176:177], v[176:177], v[102:103] op_sel_hi:[1,0]
    v_cvt_pk_bf16_f32 v165, v166, v167
    v_pk_mul_f32 v[148:149], v[148:149], v[48:49] op_sel_hi:[1,0]
    v_accvgpr_read_b32 v108, a52
    v_pk_mul_f32 v[118:119], v[118:119], v[48:49] op_sel_hi:[1,0]
    v_pk_mul_f32 v[108:109], v[108:109], v[100:101] op_sel_hi:[1,0]
    v_pk_mul_f32 v[178:179], v[178:179], v[102:103] op_sel_hi:[1,0]
    v_pk_mul_f32 v[124:125], v[124:125], v[48:49] op_sel_hi:[1,0]
    v_pk_mul_f32 v[222:223], v[222:223], v[50:51] op_sel_hi:[1,0]
    v_pk_mul_f32 v[110:111], v[110:111], v[100:101] op_sel_hi:[1,0]
    v_cvt_pk_bf16_f32 v108, v108, v109
    v_pk_mul_f32 v[232:233], v[232:233], v[50:51] op_sel_hi:[1,0]
    v_fma_f32 v75, v75, s28, v11
    v_pk_mul_f32 v[196:197], v[196:197], v[102:103] op_sel_hi:[1,0]
    v_pk_mul_f32 v[126:127], v[126:127], v[48:49] op_sel_hi:[1,0]
    v_pk_mul_f32 v[250:251], v[250:251], v[50:51] op_sel_hi:[1,0]
    v_fma_f32 v77, v77, s28, v12
    v_pk_mul_f32 v[194:195], v[194:195], v[102:103] op_sel_hi:[1,0]
    v_cvt_pk_bf16_f32 v124, v124, v125
    v_pk_mul_f32 v[132:133], v[132:133], v[48:49] op_sel_hi:[1,0]
    v_pk_mul_f32 v[104:105], v[104:105], v[8:9] op_sel_hi:[1,0]
    v_pk_mul_f32 v[174:175], v[174:175], v[102:103] op_sel_hi:[1,0]
    v_cvt_pk_bf16_f32 v104, v104, v105
    v_pk_mul_f32 v[190:191], v[190:191], v[102:103] op_sel_hi:[1,0]
    v_fma_f32 v80, v80, s28, v12
    v_exp_f32 v77, v77
    v_pk_mul_f32 v[172:173], v[172:173], v[102:103] op_sel_hi:[1,0]
    v_pk_mul_f32 v[228:229], v[228:229], v[50:51] op_sel_hi:[1,0]
    v_fma_f32 v60, v60, s28, v10
    v_cvt_pk_bf16_f32 v109, v110, v111
    v_pk_mul_f32 v[170:171], v[170:171], v[102:103] op_sel_hi:[1,0]
    v_pk_mul_f32 v[154:155], v[154:155], v[48:49] op_sel_hi:[1,0]
    v_pk_mul_f32 v[106:107], v[106:107], v[8:9] op_sel_hi:[1,0]
    v_cvt_pk_bf16_f32 v213, v214, v215
    v_pk_mul_f32 v[244:245], v[244:245], v[50:51] op_sel_hi:[1,0]
    v_xor_b32 v101, 32, v101
    v_cvt_pk_bf16_f32 v244, v244, v245
    v_mfma_f32_16x16x32_bf16 v[56:59], a[232:235], a[116:119], v[56:59]
    ds_read_b64_tr_b16 a[218:219], v3 offset:6144
    v_cvt_pk_bf16_f32 v117, v118, v119
    v_fma_f32 v66, v66, s28, v10
    v_mfma_f32_16x16x32_bf16 v[56:59], a[228:231], a[112:115], v[56:59]
    ds_read_b64_tr_b16 a[234:235], v3 offset:7168
    v_fma_f32 v70, v70, s28, v11
    v_cvt_pk_bf16_f32 v129, v130, v131
    v_mfma_f32_16x16x32_bf16 v[56:59], a[224:227], a[108:111], v[56:59]
    s_waitcnt lgkmcnt(2)
    ds_read_b64_tr_b16 a[220:221], v4 offset:0
    v_cvt_pk_bf16_f32 v105, v106, v107
    v_mfma_f32_16x16x32_bf16 v[112:115], a[212:215], v[14:17], 0
    ds_read_b64_tr_b16 a[222:223], v4 offset:6144
    v_accvgpr_read_b32 v110, a58
    v_cvt_pk_bf16_f32 v125, v126, v127
    v_fma_f32 v83, v83, s28, v12
    v_cvt_pk_bf16_f32 v217, v218, v219
    v_fma_f32 v58, v58, s28, v9
    v_accvgpr_read_b32 v106, a10
    v_accvgpr_read_b32 v111, a59
    v_fma_f32 v64, v64, s28, v10
    v_cvt_pk_bf16_f32 v236, v236, v237
    v_mfma_f32_16x16x32_bf16 v[160:163], a[212:215], v[20:23], 0
    s_add_u32 m0, s22, 13312
    ds_read_b64_tr_b16 a[224:225], v5 offset:0
    v_exp_f32 v60, v60
    v_cvt_pk_bf16_f32 v221, v222, v223
    v_mfma_f32_16x16x32_bf16 v[208:211], a[212:215], v[26:29], 0
    ds_write2st64_b64 v101, v[116:117], v[164:165] offset0:0 offset1:12
    v_pk_mul_f32 v[140:141], v[140:141], v[48:49] op_sel_hi:[1,0]
    v_pk_mul_f32 v[248:249], v[248:249], v[50:51] op_sel_hi:[1,0]
    v_cvt_pk_bf16_f32 v172, v172, v173
    v_pk_mul_f32 v[188:189], v[188:189], v[102:103] op_sel_hi:[1,0]
    v_pk_mul_f32 v[230:231], v[230:231], v[50:51] op_sel_hi:[1,0]
    v_exp_f32 v76, v76
    v_cvt_pk_bf16_f32 v169, v170, v171
    v_mfma_f32_16x16x32_bf16 a[0:3], a[212:215], v[32:35], 0
    buffer_load_dwordx4 v6, s[4:7], s20 offen lds
    ds_write2st64_b64 v101, v[212:213], v[104:105] offset0:24 offset1:36
    v_mfma_f32_16x16x32_bf16 v[44:47], a[240:243], v[20:23], v[44:47]
    s_waitcnt lgkmcnt(3)
    ds_read_b64_tr_b16 a[228:229], v2 offset:1024
    v_cvt_pk_bf16_f32 v136, v136, v137
    v_mfma_f32_16x16x32_bf16 a[4:7], a[216:219], v[32:35], 0
    s_add_u32 s20, s20, 128
    ds_read_b64_tr_b16 a[232:233], v3 offset:1024
    v_exp_f32 v71, v71
    v_accvgpr_read_b32 v107, a11
    v_mfma_f32_16x16x32_bf16 v[44:47], a[244:247], v[26:29], v[44:47]
    ds_write_b64 v101, v[108:109] offset:24576
    v_accvgpr_read_b32 v108, a56
    v_cvt_pk_bf16_f32 v200, v200, v201
    v_pk_mul_f32 v[186:187], v[186:187], v[102:103] op_sel_hi:[1,0]
    v_accvgpr_read_b32 v109, a57
    v_cvt_pk_bf16_f32 v153, v154, v155
    v_pk_mul_f32 v[108:109], v[108:109], v[100:101] op_sel_hi:[1,0]
    v_fma_f32 v56, v56, s28, v9
    v_pk_mul_f32 v[184:185], v[184:185], v[102:103] op_sel_hi:[1,0]
    v_fma_f32 v73, v73, s28, v11
    v_cvt_pk_bf16_f32 v108, v108, v109
    v_exp_f32 v80, v80
    v_pk_mul_f32 v[156:157], v[156:157], v[48:49] op_sel_hi:[1,0]
    v_accvgpr_read_b32 v105, a9
    v_accvgpr_read_b32 v104, a8
    v_pk_mul_f32 v[146:147], v[146:147], v[48:49] op_sel_hi:[1,0]
    v_pk_mul_f32 v[144:145], v[144:145], v[48:49] op_sel_hi:[1,0]
    v_fma_f32 v65, v65, s28, v10
    v_pk_mul_f32 v[106:107], v[106:107], v[8:9] op_sel_hi:[1,0]
    v_pk_mul_f32 v[110:111], v[110:111], v[100:101] op_sel_hi:[1,0]
    v_pk_mul_f32 v[122:123], v[122:123], v[48:49] op_sel_hi:[1,0]
    v_cvt_pk_bf16_f32 v140, v140, v141
    v_pk_mul_f32 v[134:135], v[134:135], v[48:49] op_sel_hi:[1,0]
    v_exp_f32 v73, v73
    v_pk_mul_f32 v[234:235], v[234:235], v[50:51] op_sel_hi:[1,0]
    v_xor_b32 v101, 96, v101
    v_pk_mul_f32 v[138:139], v[138:139], v[48:49] op_sel_hi:[1,0]
    v_fma_f32 v74, v74, s28, v11
    v_pk_mul_f32 v[104:105], v[104:105], v[8:9] op_sel_hi:[1,0]
    v_cvt_pk_bf16_f32 v121, v122, v123
    v_cvt_pk_bf16_f32 v184, v184, v185
    v_cvt_pk_bf16_f32 v104, v104, v105
    v_mfma_f32_16x16x32_bf16 v[212:215], a[216:219], v[26:29], 0
    ds_write2st64_b64 v101, v[120:121], v[168:169] offset0:0 offset1:12
    v_cvt_pk_bf16_f32 v109, v110, v111
    v_cvt_pk_bf16_f32 v105, v106, v107
    v_cvt_pk_bf16_f32 v176, v176, v177
    v_cvt_pk_bf16_f32 v228, v228, v229
    v_mfma_f32_16x16x32_bf16 v[164:167], a[216:219], v[20:23], 0
    ds_read_b64_tr_b16 a[212:213], v4 offset:1024
    ds_read_b64_tr_b16 a[230:231], v2 offset:7168
    v_mfma_f32_16x16x32_bf16 v[116:119], a[216:219], v[14:17], 0
    s_add_u32 m0, s22, 14336
    ds_write2st64_b64 v101, v[216:217], v[104:105] offset0:24 offset1:36
    v_accvgpr_read_b32 v111, a63
    v_fma_f32 v59, v59, s28, v9
    v_cvt_pk_bf16_f32 v196, v196, v197
    v_mfma_f32_16x16x32_bf16 v[120:123], a[220:223], v[14:17], 0
    ds_read_b64_tr_b16 a[226:227], v5 offset:6144
    v_accvgpr_read_b32 v107, a15
    v_accvgpr_read_b32 v105, a13
    v_mfma_f32_16x16x32_bf16 v[168:171], a[220:223], v[20:23], 0
    buffer_load_dwordx4 v6, s[4:7], s20 offen lds
    ds_write_b64 v101, v[108:109] offset:24576
    v_pk_mul_f32 v[240:241], v[240:241], v[50:51] op_sel_hi:[1,0]
    v_cvt_pk_bf16_f32 v177, v178, v179
    v_accvgpr_read_b32 v108, a60
    v_accvgpr_read_b32 v104, a12
    v_cvt_pk_bf16_f32 v144, v144, v145
    v_accvgpr_read_b32 v110, a62
    v_cvt_pk_bf16_f32 v248, v248, v249
    v_accvgpr_read_b32 v109, a61
    v_pk_mul_f32 v[108:109], v[108:109], v[100:101] op_sel_hi:[1,0]
    v_cvt_pk_bf16_f32 v132, v132, v133
    v_pk_mul_f32 v[202:203], v[202:203], v[102:103] op_sel_hi:[1,0]
    v_pk_mul_f32 v[198:199], v[198:199], v[102:103] op_sel_hi:[1,0]
    v_accvgpr_read_b32 v106, a14
    v_pk_mul_f32 v[150:151], v[150:151], v[48:49] op_sel_hi:[1,0]
    v_pk_mul_f32 v[106:107], v[106:107], v[8:9] op_sel_hi:[1,0]
    v_pk_mul_f32 v[104:105], v[104:105], v[8:9] op_sel_hi:[1,0]
    v_pk_mul_f32 v[110:111], v[110:111], v[100:101] op_sel_hi:[1,0]
    v_cvt_pk_bf16_f32 v104, v104, v105
    v_cvt_pk_bf16_f32 v133, v134, v135
    v_cvt_pk_bf16_f32 v108, v108, v109
    v_cvt_pk_bf16_f32 v173, v174, v175
    v_xor_b32 v101, 32, v101
    v_cvt_pk_bf16_f32 v180, v180, v181
    v_cvt_pk_bf16_f32 v105, v106, v107
    v_accvgpr_read_b32 v107, a19
    v_mfma_f32_16x16x32_bf16 v[44:47], a[248:251], v[32:35], v[44:47]
    ds_write2st64_b64 v101, v[124:125], v[172:173] offset0:0 offset1:12
    v_fma_f32 v57, v57, s28, v9
    v_cvt_pk_bf16_f32 v240, v240, v241
    v_mfma_f32_16x16x32_bf16 v[216:219], a[220:223], v[26:29], 0
    ds_read_b64_tr_b16 a[216:217], v5 offset:1024
    v_cvt_pk_bf16_f32 v109, v110, v111
    v_mfma_f32_16x16x32_bf16 a[8:11], a[220:223], v[32:35], 0
    s_waitcnt lgkmcnt(2)
    ds_write2st64_b64 v101, v[220:221], v[104:105] offset0:24 offset1:36
    v_mfma_f32_16x16x32_bf16 a[12:15], a[224:227], v[32:35], 0
    ds_write_b64 v101, v[108:109] offset:24576
    ds_read_b64_tr_b16 a[222:223], v2 offset:8192
    v_accvgpr_read_b32 v110, a66
    v_accvgpr_read_b32 v109, a65
    v_accvgpr_read_b32 v104, a16
    v_accvgpr_read_b32 v106, a18
    v_accvgpr_read_b32 v108, a64
    v_pk_mul_f32 v[106:107], v[106:107], v[8:9] op_sel_hi:[1,0]
    v_cvt_pk_bf16_f32 v137, v138, v139
    v_pk_mul_f32 v[158:159], v[158:159], v[48:49] op_sel_hi:[1,0]
    v_xor_b32 v101, 96, v101
    v_pk_mul_f32 v[108:109], v[108:109], v[100:101] op_sel_hi:[1,0]
    v_pk_mul_f32 v[246:247], v[246:247], v[50:51] op_sel_hi:[1,0]
    v_accvgpr_read_b32 v111, a67
    v_pk_mul_f32 v[110:111], v[110:111], v[100:101] op_sel_hi:[1,0]
    v_cvt_pk_bf16_f32 v108, v108, v109
    v_accvgpr_read_b32 v105, a17
    v_fma_f32 v62, v62, s28, v10
    v_pk_mul_f32 v[104:105], v[104:105], v[8:9] op_sel_hi:[1,0]
    v_exp_f32 v68, v68
    v_cvt_pk_bf16_f32 v104, v104, v105
    v_cvt_pk_bf16_f32 v105, v106, v107
    v_mfma_f32_16x16x32_bf16 v[220:223], a[224:227], v[26:29], 0
    ds_write2st64_b64 v101, v[128:129], v[176:177] offset0:4 offset1:16
    v_cvt_pk_bf16_f32 v109, v110, v111
    v_cvt_pk_bf16_f32 v237, v238, v239
    v_cvt_pk_bf16_f32 v181, v182, v183
    v_cvt_pk_bf16_f32 v188, v188, v189
    v_mfma_f32_16x16x32_bf16 v[172:175], a[224:227], v[20:23], 0
    ds_write2st64_b64 v101, v[224:225], v[104:105] offset0:28 offset1:40
    v_mfma_f32_16x16x32_bf16 v[124:127], a[224:227], v[14:17], 0
    ds_write_b64 v101, v[108:109] offset:26624
    v_accvgpr_read_b32 v110, a70
    v_accvgpr_read_b32 v104, a20
    v_cvt_pk_bf16_f32 v232, v232, v233
    v_accvgpr_read_b32 v106, a22
    v_cvt_pk_bf16_f32 v145, v146, v147
    v_mfma_f32_16x16x32_bf16 v[128:131], a[228:231], v[14:17], 0
    ds_read_b128 v[96:99], v103 offset:0
    v_cvt_pk_bf16_f32 v229, v230, v231
    v_cvt_pk_bf16_f32 v192, v192, v193
    v_mfma_f32_16x16x32_bf16 v[176:179], a[228:231], v[20:23], 0
    ds_read_b64_tr_b16 a[214:215], v4 offset:7168
    ds_read_b64_tr_b16 a[218:219], v5 offset:7168
    v_accvgpr_read_b32 v111, a71
    v_accvgpr_read_b32 v109, a69
    v_accvgpr_read_b32 v108, a68
    v_accvgpr_read_b32 v105, a21
    v_cvt_pk_bf16_f32 v156, v156, v157
    v_pk_mul_f32 v[104:105], v[104:105], v[8:9] op_sel_hi:[1,0]
    v_pk_mul_f32 v[110:111], v[110:111], v[100:101] op_sel_hi:[1,0]
    v_pk_mul_f32 v[108:109], v[108:109], v[100:101] op_sel_hi:[1,0]
    v_accvgpr_read_b32 v107, a23
    v_exp_f32 v57, v57
    v_xor_b32 v101, 32, v101
    v_cvt_pk_bf16_f32 v141, v142, v143
    v_pk_mul_f32 v[106:107], v[106:107], v[8:9] op_sel_hi:[1,0]
    v_fma_f32 v67, v67, s28, v10
    v_cvt_pk_bf16_f32 v108, v108, v109
    v_cvt_pk_bf16_f32 v104, v104, v105
    v_exp_f32 v63, v63
    v_mfma_f32_16x16x32_bf16 v[224:227], a[228:231], v[26:29], 0
    ds_write2st64_b64 v101, v[132:133], v[180:181] offset0:4 offset1:16
    v_cvt_pk_bf16_f32 v109, v110, v111
    v_cvt_pk_bf16_f32 v148, v148, v149
    v_cvt_pk_bf16_f32 v185, v186, v187
    v_cvt_pk_bf16_f32 v105, v106, v107
    v_mfma_f32_16x16x32_bf16 a[16:19], a[228:231], v[32:35], 0
    ds_write2st64_b64 v101, v[228:229], v[104:105] offset0:28 offset1:40
    v_mfma_f32_16x16x32_bf16 a[20:23], a[232:235], v[32:35], 0
    ds_read_b64_tr_b16 a[224:225], v3 offset:2048
    ds_write_b64 v101, v[108:109] offset:26624
    v_mfma_f32_16x16x32_bf16 v[228:231], a[232:235], v[26:29], 0
    ds_read_b128 v[84:87], v103 offset:1024
    v_accvgpr_read_b32 v110, a74
    v_accvgpr_read_b32 v111, a75
    v_exp_f32 v59, v59
    v_cvt_pk_bf16_f32 v189, v190, v191
    v_accvgpr_read_b32 v105, a25
    v_cvt_pk_bf16_f32 v157, v158, v159
    v_accvgpr_read_b32 v107, a27
    v_accvgpr_read_b32 v104, a24
    v_accvgpr_read_b32 v108, a72
    v_accvgpr_read_b32 v109, a73
    v_accvgpr_read_b32 v106, a26
    v_pk_mul_f32 v[108:109], v[108:109], v[100:101] op_sel_hi:[1,0]
    v_cvt_pk_bf16_f32 v201, v202, v203
    v_pk_mul_f32 v[254:255], v[254:255], v[50:51] op_sel_hi:[1,0]
    v_pk_mul_f32 v[104:105], v[104:105], v[8:9] op_sel_hi:[1,0]
    v_cvt_pk_bf16_f32 v193, v194, v195
    v_pk_mul_f32 v[106:107], v[106:107], v[8:9] op_sel_hi:[1,0]
    v_cvt_pk_bf16_f32 v104, v104, v105
    v_xor_b32 v101, 96, v101
    v_cvt_pk_bf16_f32 v105, v106, v107
    v_accvgpr_read_b32 v106, a30
    v_cvt_pk_bf16_f32 v233, v234, v235
    v_pk_mul_f32 v[110:111], v[110:111], v[100:101] op_sel_hi:[1,0]
    v_accvgpr_read_b32 v107, a31
    v_cvt_pk_bf16_f32 v108, v108, v109
    v_mfma_f32_16x16x32_bf16 v[180:183], a[232:235], v[20:23], 0
    s_add_u32 s20, s20, 12032
    ds_write2st64_b64 v101, v[136:137], v[184:185] offset0:4 offset1:16
    v_mfma_f32_16x16x32_bf16 v[132:135], a[232:235], v[14:17], 0
    s_waitcnt lgkmcnt(2)
    ds_write2st64_b64 v101, v[232:233], v[104:105] offset0:28 offset1:40
    v_cvt_pk_bf16_f32 v109, v110, v111
    v_mfma_f32_16x16x32_bf16 v[136:139], a[212:215], v[14:17], 0
    ds_write_b64 v101, v[108:109] offset:26624
    v_accvgpr_read_b32 v104, a28
    v_accvgpr_read_b32 v108, a76
    v_mfma_f32_16x16x32_bf16 v[184:187], a[212:215], v[20:23], 0
    ds_read_b64_tr_b16 a[232:233], v5 offset:2048
    ds_read_b64_tr_b16 a[230:231], v4 offset:8192
    v_xor_b32 v101, 32, v101
    v_exp_f32 v54, v54
    v_accvgpr_read_b32 v105, a29
    v_exp_f32 v70, v70
    v_cvt_pk_bf16_f32 v197, v198, v199
    v_exp_f32 v52, v52
    v_pk_mul_f32 v[106:107], v[106:107], v[8:9] op_sel_hi:[1,0]
    v_pk_mul_f32 v[104:105], v[104:105], v[8:9] op_sel_hi:[1,0]
    v_accvgpr_read_b32 v110, a78
    v_accvgpr_read_b32 v111, a79
    v_pk_mul_f32 v[204:205], v[204:205], v[102:103] op_sel_hi:[1,0]
    v_cvt_pk_bf16_f32 v245, v246, v247
    v_cvt_pk_bf16_f32 v104, v104, v105
    v_cvt_pk_bf16_f32 v105, v106, v107
    v_mfma_f32_16x16x32_bf16 v[232:235], a[212:215], v[26:29], 0
    ds_read_b64_tr_b16 a[228:229], v4 offset:2048
    ds_read_b64_tr_b16 a[226:227], v3 offset:8192
    v_accvgpr_read_b32 v109, a77
    v_mfma_f32_16x16x32_bf16 a[24:27], a[212:215], v[32:35], 0
    ds_write2st64_b64 v101, v[140:141], v[188:189] offset0:4 offset1:16
    ds_read_b64_tr_b16 a[220:221], v2 offset:2048
    v_mfma_f32_16x16x32_bf16 a[28:31], a[216:219], v[32:35], 0
    s_add_u32 s39, s39, 12288
    ds_read_b64_tr_b16 a[234:235], v5 offset:8192
    ds_write2st64_b64 v101, v[236:237], v[104:105] offset0:28 offset1:40
    v_accvgpr_read_b32 v104, a32
    v_pk_mul_f32 v[108:109], v[108:109], v[100:101] op_sel_hi:[1,0]
    v_pk_mul_f32 v[110:111], v[110:111], v[100:101] op_sel_hi:[1,0]
    v_cvt_pk_bf16_f32 v108, v108, v109
    v_cvt_pk_bf16_f32 v204, v204, v205
    v_accvgpr_read_b32 v105, a33
    v_accvgpr_read_b32 v107, a35
    v_cvt_pk_bf16_f32 v109, v110, v111
    v_mfma_f32_16x16x32_bf16 v[236:239], a[216:219], v[26:29], 0
    buffer_store_dwordx4 v[96:99], v6, s[16:19], s67 offen offset:0 nt
    ds_write_b64 v101, v[108:109] offset:26624
    v_cvt_pk_bf16_f32 v241, v242, v243
    v_accvgpr_read_b32 v106, a34
    v_xor_b32 v101, 96, v101
    v_pk_mul_f32 v[104:105], v[104:105], v[8:9] op_sel_hi:[1,0]
    v_cvt_pk_bf16_f32 v149, v150, v151
    v_accvgpr_read_b32 v110, a82
    v_cvt_pk_bf16_f32 v104, v104, v105
    v_fma_f32 v72, v72, s28, v11
    v_accvgpr_read_b32 v108, a80
    v_pk_mul_f32 v[106:107], v[106:107], v[8:9] op_sel_hi:[1,0]
    v_pk_mul_f32 v[206:207], v[206:207], v[102:103] op_sel_hi:[1,0]
    v_cvt_pk_bf16_f32 v105, v106, v107
    v_accvgpr_read_b32 v109, a81
    v_accvgpr_read_b32 v107, a39
    v_mfma_f32_16x16x32_bf16 v[188:191], a[216:219], v[20:23], 0
    s_waitcnt vmcnt(7) lgkmcnt(2)
    ds_write2st64_b64 v101, v[144:145], v[192:193] offset0:8 offset1:20
    v_mfma_f32_16x16x32_bf16 v[140:143], a[216:219], v[14:17], 0
    buffer_store_dwordx4 v[84:87], v7, s[16:19], s67 offen offset:0 nt
    s_barrier
    ds_write2st64_b64 v101, v[240:241], v[104:105] offset0:32 offset1:44
    v_cvt_pk_bf16_f32 v249, v250, v251
    v_accvgpr_read_b32 v111, a83
    v_pk_mul_f32 v[108:109], v[108:109], v[100:101] op_sel_hi:[1,0]
    v_accvgpr_read_b32 v104, a36
    v_pk_mul_f32 v[110:111], v[110:111], v[100:101] op_sel_hi:[1,0]
    v_cvt_pk_bf16_f32 v108, v108, v109
    v_cvt_pk_bf16_f32 v109, v110, v111
    v_accvgpr_read_b32 v111, a87
    v_exp_f32 v61, v61
    v_accvgpr_read_b32 v105, a37
    v_mfma_f32_16x16x32_bf16 v[144:147], a[220:223], v[14:17], 0
    ds_write_b64 v101, v[108:109] offset:0
    v_accvgpr_read_b32 v109, a85
    v_exp_f32 v72, v72
    v_accvgpr_read_b32 v110, a86
    v_pk_mul_f32 v[104:105], v[104:105], v[8:9] op_sel_hi:[1,0]
    v_accvgpr_read_b32 v108, a84
    v_accvgpr_read_b32 v106, a38
    v_pk_mul_f32 v[106:107], v[106:107], v[8:9] op_sel_hi:[1,0]
    v_xor_b32 v101, 32, v101
    v_cvt_pk_bf16_f32 v104, v104, v105
    v_exp_f32 v58, v58
    v_pk_mul_f32 v[110:111], v[110:111], v[100:101] op_sel_hi:[1,0]
    v_exp_f32 v62, v62
    v_cvt_pk_bf16_f32 v105, v106, v107
    v_cvt_pk_bf16_f32 v19, v54, v55
    v_accvgpr_read_b32 v106, a42
    v_mfma_f32_16x16x32_bf16 v[192:195], a[220:223], v[20:23], 0
    s_add_u32 m0, s22, 24576
    ds_write2st64_b64 v101, v[148:149], v[196:197] offset0:8 offset1:20
    v_mfma_f32_16x16x32_bf16 v[240:243], a[220:223], v[26:29], 0
    ds_write2st64_b64 v101, v[244:245], v[104:105] offset0:32 offset1:44
    v_pk_mul_f32 v[108:109], v[108:109], v[100:101] op_sel_hi:[1,0]
    v_accvgpr_read_b32 v107, a43
    v_cvt_pk_bf16_f32 v108, v108, v109
    v_mfma_f32_16x16x32_bf16 a[32:35], a[220:223], v[32:35], 0
    ds_read_b128 a[220:223], v0 offset:1024
    v_accvgpr_read_b32 v105, a41
    v_accvgpr_read_b32 v104, a40
    v_mfma_f32_16x16x32_bf16 a[36:39], a[224:227], v[32:35], 0
    ds_read_b128 a[212:215], v0 offset:0
    v_cvt_pk_bf16_f32 v37, v78, v79
    v_cvt_pk_bf16_f32 v109, v110, v111
    v_mfma_f32_16x16x32_bf16 v[244:247], a[224:227], v[26:29], 0
    ds_write_b64 v101, v[108:109] offset:0
    v_accvgpr_read_b32 v111, a91
    v_accvgpr_read_b32 v109, a89
    v_accvgpr_read_b32 v108, a88
    v_pk_mul_f32 v[108:109], v[108:109], v[100:101] op_sel_hi:[1,0]
    v_accvgpr_read_b32 v110, a90
    v_pk_mul_f32 v[110:111], v[110:111], v[100:101] op_sel_hi:[1,0]
    v_pk_mul_f32 v[106:107], v[106:107], v[8:9] op_sel_hi:[1,0]
    v_pk_mul_f32 v[104:105], v[104:105], v[8:9] op_sel_hi:[1,0]
    v_cvt_pk_bf16_f32 v253, v254, v255
    v_xor_b32 v101, 96, v101
    v_cvt_pk_bf16_f32 v104, v104, v105
    v_cvt_pk_bf16_f32 v18, v52, v53
    v_cvt_pk_bf16_f32 v108, v108, v109
    v_cvt_pk_bf16_f32 v105, v106, v107
    v_mfma_f32_16x16x32_bf16 v[196:199], a[224:227], v[20:23], 0
    ds_write2st64_b64 v101, v[152:153], v[200:201] offset0:8 offset1:20
    v_accvgpr_read_b32 v107, a47
    v_mfma_f32_16x16x32_bf16 v[148:151], a[224:227], v[14:17], 0
    ds_read_b128 a[216:219], v1 offset:0
    buffer_load_dwordx4 v6, s[8:11], s21 offen lds
    v_cvt_pk_bf16_f32 v109, v110, v111
    v_mfma_f32_16x16x32_bf16 v[152:155], a[228:231], v[14:17], 0
    s_add_u32 s21, s21, 128
    ds_write2st64_b64 v101, v[248:249], v[104:105] offset0:32 offset1:44
    v_mfma_f32_16x16x32_bf16 v[200:203], a[228:231], v[20:23], 0
    s_add_u32 m0, s22, 25600
    ds_read_b128 v[88:91], v103 offset:2048
    buffer_load_dwordx4 v6, s[8:11], s21 offen lds
    v_mfma_f32_16x16x32_bf16 v[248:251], a[228:231], v[26:29], 0
    s_add_u32 s21, s21, 128
    ds_write_b64 v101, v[108:109] offset:0
    v_xor_b32 v101, 32, v101
    v_cvt_pk_bf16_f32 v205, v206, v207
    v_accvgpr_read_b32 v105, a45
    v_accvgpr_read_b32 v106, a46
    v_mfma_f32_16x16x32_bf16 a[40:43], a[228:231], v[32:35], 0
    ds_write2st64_b64 v101, v[156:157], v[204:205] offset0:8 offset1:20
    v_accvgpr_read_b32 v104, a44
    v_pk_mul_f32 v[104:105], v[104:105], v[8:9] op_sel_hi:[1,0]
    v_pk_mul_f32 v[106:107], v[106:107], v[8:9] op_sel_hi:[1,0]
    v_cvt_pk_bf16_f32 v104, v104, v105
    v_cvt_pk_bf16_f32 v105, v106, v107
    v_mfma_f32_16x16x32_bf16 a[44:47], a[232:235], v[32:35], 0
    s_add_u32 m0, s22, 26624
    ds_write2st64_b64 v101, v[252:253], v[104:105] offset0:32 offset1:44
    v_mfma_f32_16x16x32_bf16 v[252:255], a[232:235], v[26:29], 0
    ds_read_b128 a[224:227], v1 offset:1024
    buffer_load_dwordx4 v6, s[8:11], s21 offen lds
    v_mfma_f32_16x16x32_bf16 v[204:207], a[232:235], v[20:23], 0
    s_add_u32 s21, s21, 12032
    ds_read_b128 v[96:99], v103 offset:3072
    v_accvgpr_read_b32 v108, a92
    v_accvgpr_read_b32 v109, a93
    v_mfma_f32_16x16x32_bf16 v[156:159], a[232:235], v[14:17], 0
    s_waitcnt lgkmcnt(5)
    ds_read_b128 a[228:231], v0 offset:2048
    v_cvt_pk_bf16_f32 v30, v68, v69
    v_mfma_f32_16x16x32_bf16 v[52:55], a[212:215], a[96:99], 0
    s_add_u32 s56, s67, 128
    v_exp_f32 v67, v67
    v_mfma_f32_16x16x32_bf16 v[52:55], a[216:219], a[100:103], v[52:55]
    buffer_store_dwordx4 v[88:91], v6, s[16:19], s56 offen offset:0 nt
    v_cvt_pk_bf16_f32 v28, v72, v73
    v_pk_mul_f32 v[108:109], v[108:109], v[100:101] op_sel_hi:[1,0]
    v_cvt_pk_bf16_f32 v24, v60, v61
    v_cvt_pk_bf16_f32 v31, v70, v71
    v_cvt_pk_bf16_f32 v25, v62, v63
    v_mfma_f32_16x16x32_bf16 v[52:55], a[220:223], a[104:107], v[52:55]
    s_add_u32 s58, s33, 128
    ds_read_b128 a[232:235], v1 offset:2048
    v_cvt_pk_bf16_f32 v36, v76, v77
    v_mfma_f32_16x16x32_bf16 v[60:63], a[220:223], a[128:131], 0
    ds_read_b128 v[84:87], v103 offset:4096
    v_mfma_f32_16x16x32_bf16 v[60:63], a[216:219], a[124:127], v[60:63]
    v_exp_f32 v74, v74
    v_mfma_f32_16x16x32_bf16 v[60:63], a[212:215], a[120:123], v[60:63]
    v_exp_f32 v65, v65
    v_mfma_f32_16x16x32_bf16 v[68:71], a[212:215], a[144:147], 0
    v_exp_f32 v75, v75
    v_mfma_f32_16x16x32_bf16 v[68:71], a[216:219], a[148:151], v[68:71]
    v_exp_f32 v56, v56
    v_mfma_f32_16x16x32_bf16 v[68:71], a[220:223], a[152:155], v[68:71]
    s_add_u32 m0, s38, 2048
    v_exp_f32 v81, v81
    v_mfma_f32_16x16x32_bf16 v[76:79], a[220:223], a[176:179], 0
    buffer_load_dwordx4 v6, s[12:15], s58 offen nt lds
    v_mfma_f32_16x16x32_bf16 v[76:79], a[216:219], a[172:175], v[76:79]
    v_cvt_pk_bf16_f32 v17, v58, v59
    v_accvgpr_read_b32 v111, a95
    v_mfma_f32_16x16x32_bf16 v[76:79], a[212:215], a[168:171], v[76:79]
    s_waitcnt lgkmcnt(2)
    v_exp_f32 v64, v64
    v_mfma_f32_16x16x32_bf16 v[76:79], a[224:227], a[180:183], v[76:79]
    s_add_u32 m0, s38, 3072
    v_exp_f32 v66, v66
    v_mfma_f32_16x16x32_bf16 v[76:79], a[228:231], a[184:187], v[76:79]
    s_waitcnt lgkmcnt(0)
    ds_read_b128 a[220:223], v0 offset:7168
    v_cvt_pk_bf16_f32 v108, v108, v109
    v_mfma_f32_16x16x32_bf16 v[76:79], a[232:235], a[188:191], v[76:79]
    buffer_load_dwordx4 v7, s[12:15], s58 offen nt lds
    v_mfma_f32_16x16x32_bf16 v[68:71], a[232:235], a[164:167], v[68:71]
    ds_read_b128 v[88:91], v103 offset:5120
    v_cvt_pk_bf16_f32 v29, v74, v75
    v_mfma_f32_16x16x32_bf16 v[68:71], a[228:231], a[160:163], v[68:71]
    v_accvgpr_read_b32 v110, a94
    v_cvt_pk_bf16_f32 v23, v66, v67
    v_mfma_f32_16x16x32_bf16 v[68:71], a[224:227], a[156:159], v[68:71]
    buffer_store_dwordx4 v[96:99], v7, s[16:19], s56 offen offset:0 nt
    s_add_u32 s57, s67, 256
    ds_read_b128 a[216:219], v1 offset:6144
    v_pk_mul_f32 v[110:111], v[110:111], v[100:101] op_sel_hi:[1,0]
    v_cvt_pk_bf16_f32 v22, v64, v65
    v_cvt_pk_bf16_f32 v109, v110, v111
    v_mfma_f32_16x16x32_bf16 v[60:63], a[224:227], a[132:135], v[60:63]
    s_add_u32 s59, s33, 256
    ds_read_b128 a[212:215], v0 offset:6144
    v_cvt_pk_bf16_f32 v16, v56, v57
    v_mfma_f32_16x16x32_bf16 v[60:63], a[228:231], a[136:139], v[60:63]
    v_exp_f32 v82, v82
    v_mfma_f32_16x16x32_bf16 v[60:63], a[232:235], a[140:143], v[60:63]
    buffer_store_dwordx4 v[84:87], v6, s[16:19], s57 offen offset:0 nt
    s_add_u32 m0, s38, 4096
    ds_write_b64 v101, v[108:109] offset:0
    v_mfma_f32_16x16x32_bf16 v[52:55], a[232:235], a[116:119], v[52:55]
    v_exp_f32 v83, v83
    v_mfma_f32_16x16x32_bf16 v[48:51], a[236:239], v[16:19], v[44:47]
    buffer_load_dwordx4 v6, s[12:15], s59 offen nt lds
    v_mfma_f32_16x16x32_bf16 v[48:51], a[240:243], v[22:25], v[48:51]
    ds_read_b128 v[96:99], v103 offset:0
    v_mfma_f32_16x16x32_bf16 v[52:55], a[228:231], a[112:115], v[52:55]
    ds_read_b128 v[84:87], v103 offset:1024
    v_cvt_pk_bf16_f32 v34, v80, v81
    v_mfma_f32_16x16x32_bf16 v[48:51], a[244:247], v[28:31], v[48:51]
    ds_read_b128 a[228:231], v0 offset:8192
    v_cvt_pk_bf16_f32 v35, v82, v83
    v_mfma_f32_16x16x32_bf16 v[52:55], a[224:227], a[108:111], v[52:55]
    ds_read_b128 a[224:227], v1 offset:7168
    s_waitcnt lgkmcnt(5)
    v_mfma_f32_16x16x32_bf16 v[56:59], a[212:215], a[96:99], 0
    ds_read_b128 a[232:235], v1 offset:8192
    v_mfma_f32_16x16x32_bf16 v[48:51], a[248:251], v[34:37], v[48:51]
    buffer_store_dwordx4 v[88:91], v7, s[16:19], s57 offen offset:0 nt
    v_add_u32 v103, 6144, v103
    s_add_u32 m0, s38, 5120
    v_mfma_f32_16x16x32_bf16 v[56:59], a[216:219], a[100:103], v[56:59]
    v_mfma_f32_16x16x32_bf16 v[56:59], a[220:223], a[104:107], v[56:59]
    buffer_load_dwordx4 v7, s[12:15], s59 offen nt lds
    v_mfma_f32_16x16x32_bf16 v[64:67], a[220:223], a[128:131], 0
    s_add_u32 s56, s67, 24832
    s_add_u32 m0, s38, 0
    v_cmp_lt_f32 vcc, s29, v48
    v_mfma_f32_16x16x32_bf16 v[64:67], a[216:219], a[124:127], v[64:67]
    v_mfma_f32_16x16x32_bf16 v[64:67], a[212:215], a[120:123], v[64:67]
    s_waitcnt lgkmcnt(3)
    buffer_load_dwordx4 v6, s[12:15], s33 offen nt lds
    v_mfma_f32_16x16x32_bf16 v[72:75], a[212:215], a[144:147], 0
    s_add_u32 m0, s38, 1024
    s_cbranch_vccnz L_rs_tr54d
L_ret_tr54d:
    v_mfma_f32_16x16x32_bf16 v[72:75], a[216:219], a[148:151], v[72:75]
    buffer_load_dwordx4 v7, s[12:15], s33 offen nt lds
    v_mfma_f32_16x16x32_bf16 v[72:75], a[220:223], a[152:155], v[72:75]
    s_waitcnt vmcnt(18) lgkmcnt(0)
    v_fma_f32 v53, v53, s28, v9
    v_fma_f32 v61, v61, s28, v10
    v_mfma_f32_16x16x32_bf16 v[80:83], a[220:223], a[176:179], 0
    buffer_store_dwordx4 v[96:99], v6, s[16:19], s56 offen offset:0 nt
    s_barrier
    v_fma_f32 v52, v52, s28, v9
    v_fma_f32 v55, v55, s28, v9
    v_mfma_f32_16x16x32_bf16 v[80:83], a[216:219], a[172:175], v[80:83]
    v_exp_f32 v61, v61
    v_fma_f32 v60, v60, s28, v10
    v_mfma_f32_16x16x32_bf16 v[80:83], a[212:215], a[168:171], v[80:83]
    s_add_u32 m0, s22, 0
    ds_read_b64_tr_b16 a[212:213], v2 offset:18432
    v_fma_f32 v54, v54, s28, v9
    v_mfma_f32_16x16x32_bf16 v[80:83], a[224:227], a[180:183], v[80:83]
    v_exp_f32 v55, v55
    v_mfma_f32_16x16x32_bf16 v[80:83], a[228:231], a[184:187], v[80:83]
    ds_read_b64_tr_b16 a[214:215], v2 offset:12288
    buffer_load_dwordx4 v6, s[4:7], s20 offen lds
    v_mfma_f32_16x16x32_bf16 v[80:83], a[232:235], a[188:191], v[80:83]
    s_add_u32 s20, s20, 128
    v_exp_f32 v54, v54
    v_mfma_f32_16x16x32_bf16 v[72:75], a[232:235], a[164:167], v[72:75]
    s_add_u32 m0, s22, 1024
    ds_read_b64_tr_b16 a[216:217], v3 offset:18432
    v_cvt_pk_bf16_f32 v15, v54, v55
    v_mfma_f32_16x16x32_bf16 v[72:75], a[228:231], a[160:163], v[72:75]
    v_exp_f32 v53, v53
    v_mfma_f32_16x16x32_bf16 v[72:75], a[224:227], a[156:159], v[72:75]
    buffer_load_dwordx4 v6, s[4:7], s20 offen lds
    v_mfma_f32_16x16x32_bf16 v[64:67], a[224:227], a[132:135], v[64:67]
    s_add_u32 s20, s20, 128
    v_exp_f32 v60, v60
    v_mfma_f32_16x16x32_bf16 v[64:67], a[228:231], a[136:139], v[64:67]
    s_add_u32 m0, s22, 2048
    v_exp_f32 v52, v52
    v_mfma_f32_16x16x32_bf16 v[64:67], a[232:235], a[140:143], v[64:67]
    ds_read_b64_tr_b16 a[218:219], v3 offset:12288
    v_cvt_pk_bf16_f32 v14, v52, v53
    v_mfma_f32_16x16x32_bf16 v[56:59], a[232:235], a[116:119], v[56:59]
    buffer_load_dwordx4 v6, s[4:7], s20 offen lds
    ds_read_b64_tr_b16 a[220:221], v4 offset:18432
    v_mfma_f32_16x16x32_bf16 v[56:59], a[228:231], a[112:115], v[56:59]
    s_add_u32 s20, s20, 12032
    ds_read_b64_tr_b16 a[222:223], v4 offset:12288
    v_cvt_pk_bf16_f32 v20, v60, v61
    v_mfma_f32_16x16x32_bf16 v[56:59], a[224:227], a[108:111], v[56:59]
    s_waitcnt lgkmcnt(4)
    ds_read_b64_tr_b16 a[224:225], v5 offset:18432
    ds_read_b64_tr_b16 a[226:227], v5 offset:12288
    buffer_store_dwordx4 v[84:87], v7, s[16:19], s56 offen offset:0 nt
    s_branch L_loop4w0
L_tr55:
    v_mfma_f32_16x16x32_bf16 v[112:115], a[212:215], v[16:19], v[112:115]
    s_add_u32 s39, s39, 12288
    s_add_u32 s48, s33, 24576
    v_mfma_f32_16x16x32_bf16 v[116:119], a[216:219], v[16:19], v[116:119]
    ds_read_b64_tr_b16 a[230:231], v2 offset:13312
    v_fma_f32 v58, v58, s28, v9
    v_mfma_f32_16x16x32_bf16 v[164:167], a[216:219], v[22:25], v[164:167]
    ds_read_b64_tr_b16 a[232:233], v3 offset:19456
    v_mbcnt_lo_u32_b32 v97, -1, 0
    v_mfma_f32_16x16x32_bf16 v[160:163], a[212:215], v[22:25], v[160:163]
    ds_read_b64_tr_b16 a[228:229], v2 offset:19456
    v_fma_f32 v87, v87, s28, v13
    v_mfma_f32_16x16x32_bf16 v[208:211], a[212:215], v[28:31], v[208:211]
    v_fma_f32 v73, v73, s28, v11
    v_fma_f32 v81, v81, s28, v12
    v_mfma_f32_16x16x32_bf16 v[212:215], a[216:219], v[28:31], v[212:215]
    ds_read_b64_tr_b16 a[234:235], v3 offset:13312
    v_mbcnt_hi_u32_b32 v97, -1, v97
    v_mfma_f32_16x16x32_bf16 a[4:7], a[216:219], v[34:37], a[4:7]
    v_fma_f32 v66, v66, s28, v10
    v_and_b32 v96, 15, v97
    v_mfma_f32_16x16x32_bf16 a[0:3], a[212:215], v[34:37], a[0:3]
    v_mul_u32_u24 v96, 384, v96
    v_fma_f32 v82, v82, s28, v12
    v_mfma_f32_16x16x32_bf16 a[48:51], a[212:215], v[40:43], a[48:51]
    v_fma_f32 v86, v86, s28, v13
    v_fma_f32 v76, v76, s28, v12
    v_mfma_f32_16x16x32_bf16 a[52:55], a[216:219], v[40:43], a[52:55]
    s_waitcnt lgkmcnt(4)
    ds_read_b64_tr_b16 a[218:219], v5 offset:13312
    v_fma_f32 v59, v59, s28, v9
    v_mfma_f32_16x16x32_bf16 a[56:59], a[220:223], v[40:43], a[56:59]
    v_fma_f32 v88, v88, s28, v13
    v_fma_f32 v65, v65, s28, v10
    v_mfma_f32_16x16x32_bf16 a[60:63], a[224:227], v[40:43], a[60:63]
    v_lshrrev_b32 v97, 4, v97
    v_lshl_add_u32 v96, v97, 4, v96
    v_mfma_f32_16x16x32_bf16 a[12:15], a[224:227], v[34:37], a[12:15]
    ds_read_b64_tr_b16 a[212:213], v4 offset:19456
    v_fma_f32 v74, v74, s28, v11
    v_mfma_f32_16x16x32_bf16 a[8:11], a[220:223], v[34:37], a[8:11]
    buffer_load_dword v97, v96, s[12:15], s48 offen offset:256
    v_mfma_f32_16x16x32_bf16 v[216:219], a[220:223], v[28:31], v[216:219]
    v_fma_f32 v72, v72, s28, v11
    v_fma_f32 v78, v78, s28, v12
    v_mfma_f32_16x16x32_bf16 v[220:223], a[224:227], v[28:31], v[220:223]
    ds_read_b64_tr_b16 a[214:215], v4 offset:13312
    v_fma_f32 v85, v85, s28, v13
    v_mfma_f32_16x16x32_bf16 v[172:175], a[224:227], v[22:25], v[172:175]
    ds_read_b64_tr_b16 a[216:217], v5 offset:19456
    v_fma_f32 v84, v84, s28, v13
    v_mfma_f32_16x16x32_bf16 v[168:171], a[220:223], v[22:25], v[168:171]
    v_fma_f32 v68, v68, s28, v11
    v_fma_f32 v77, v77, s28, v12
    v_mfma_f32_16x16x32_bf16 v[120:123], a[220:223], v[16:19], v[120:123]
    v_exp_f32 v82, v82
    v_mfma_f32_16x16x32_bf16 v[124:127], a[224:227], v[16:19], v[124:127]
    s_waitcnt lgkmcnt(3)
    v_fma_f32 v57, v57, s28, v9
    v_mfma_f32_16x16x32_bf16 v[128:131], a[228:231], v[16:19], v[128:131]
    v_exp_f32 v78, v78
    v_mfma_f32_16x16x32_bf16 v[132:135], a[232:235], v[16:19], v[132:135]
    ds_read_b64_tr_b16 a[224:225], v3 offset:20480
    v_fma_f32 v71, v71, s28, v11
    v_mfma_f32_16x16x32_bf16 v[180:183], a[232:235], v[22:25], v[180:183]
    ds_read_b64_tr_b16 a[222:223], v2 offset:14336
    v_fma_f32 v79, v79, s28, v12
    v_mfma_f32_16x16x32_bf16 v[176:179], a[228:231], v[22:25], v[176:179]
    v_fma_f32 v67, v67, s28, v10
    v_fma_f32 v70, v70, s28, v11
    v_mfma_f32_16x16x32_bf16 v[224:227], a[228:231], v[28:31], v[224:227]
    v_fma_f32 v75, v75, s28, v11
    v_fma_f32 v90, v90, s28, v13
    v_mfma_f32_16x16x32_bf16 v[228:231], a[232:235], v[28:31], v[228:231]
    ds_read_b64_tr_b16 a[226:227], v3 offset:14336
    v_mfma_f32_16x16x32_bf16 a[20:23], a[232:235], v[34:37], a[20:23]
    v_exp_f32 v75, v75
    v_mfma_f32_16x16x32_bf16 a[16:19], a[228:231], v[34:37], a[16:19]
    v_exp_f32 v85, v85
    v_mfma_f32_16x16x32_bf16 a[64:67], a[228:231], v[40:43], a[64:67]
    v_exp_f32 v68, v68
    v_mfma_f32_16x16x32_bf16 a[68:71], a[232:235], v[40:43], a[68:71]
    s_waitcnt lgkmcnt(3)
    ds_read_b64_tr_b16 a[220:221], v2 offset:20480
    v_fma_f32 v83, v83, s28, v12
    v_mfma_f32_16x16x32_bf16 a[72:75], a[212:215], v[40:43], a[72:75]
    v_exp_f32 v84, v84
    v_mfma_f32_16x16x32_bf16 a[76:79], a[216:219], v[40:43], a[76:79]
    ds_read_b64_tr_b16 a[232:233], v5 offset:20480
    v_mfma_f32_16x16x32_bf16 a[28:31], a[216:219], v[34:37], a[28:31]
    v_exp_f32 v59, v59
    v_mfma_f32_16x16x32_bf16 a[24:27], a[212:215], v[34:37], a[24:27]
    v_exp_f32 v71, v71
    v_mfma_f32_16x16x32_bf16 v[232:235], a[212:215], v[28:31], v[232:235]
    v_exp_f32 v70, v70
    v_mfma_f32_16x16x32_bf16 v[236:239], a[216:219], v[28:31], v[236:239]
    ds_read_b64_tr_b16 a[228:229], v4 offset:20480
    v_mfma_f32_16x16x32_bf16 v[188:191], a[216:219], v[22:25], v[188:191]
    ds_read_b64_tr_b16 a[230:231], v4 offset:14336
    v_fma_f32 v56, v56, s28, v9
    v_mfma_f32_16x16x32_bf16 v[184:187], a[212:215], v[22:25], v[184:187]
    v_exp_f32 v56, v56
    v_mfma_f32_16x16x32_bf16 v[136:139], a[212:215], v[16:19], v[136:139]
    ds_read_b64_tr_b16 a[234:235], v5 offset:14336
    v_fma_f32 v89, v89, s28, v13
    v_mfma_f32_16x16x32_bf16 v[140:143], a[216:219], v[16:19], v[140:143]
    s_waitcnt lgkmcnt(4)
    v_exp_f32 v67, v67
    v_mfma_f32_16x16x32_bf16 v[144:147], a[220:223], v[16:19], v[144:147]
    v_exp_f32 v86, v86
    v_mfma_f32_16x16x32_bf16 v[148:151], a[224:227], v[16:19], v[148:151]
    v_exp_f32 v88, v88
    v_mfma_f32_16x16x32_bf16 v[196:199], a[224:227], v[22:25], v[196:199]
    v_exp_f32 v77, v77
    v_mfma_f32_16x16x32_bf16 v[192:195], a[220:223], v[22:25], v[192:195]
    v_exp_f32 v87, v87
    v_mfma_f32_16x16x32_bf16 v[240:243], a[220:223], v[28:31], v[240:243]
    v_exp_f32 v79, v79
    v_mfma_f32_16x16x32_bf16 v[244:247], a[224:227], v[28:31], v[244:247]
    v_fma_f32 v69, v69, s28, v11
    v_cvt_pk_bf16_f32 v39, v86, v87
    v_mfma_f32_16x16x32_bf16 a[36:39], a[224:227], v[34:37], a[36:39]
    v_exp_f32 v76, v76
    v_mfma_f32_16x16x32_bf16 a[32:35], a[220:223], v[34:37], a[32:35]
    v_exp_f32 v57, v57
    v_mfma_f32_16x16x32_bf16 a[80:83], a[220:223], v[40:43], a[80:83]
    s_waitcnt vmcnt(11) lgkmcnt(0)
    v_cvt_pk_bf16_f32 v33, v78, v79
    v_cvt_pk_bf16_f32 v32, v76, v77
    v_mfma_f32_16x16x32_bf16 a[84:87], a[224:227], v[40:43], a[84:87]
    s_barrier
    v_mfma_f32_16x16x32_bf16 a[88:91], a[228:231], v[40:43], a[88:91]
    ds_read_b128 a[212:215], v0 offset:12288
    s_add_u32 m0, s22, 36864
    v_mfma_f32_16x16x32_bf16 a[92:95], a[232:235], v[40:43], a[92:95]
    buffer_load_dwordx4 v6, s[8:11], s21 offen lds
    v_mfma_f32_16x16x32_bf16 a[44:47], a[232:235], v[34:37], a[44:47]
    ds_read_b128 a[220:223], v0 offset:13312
    v_fma_f32 v91, v91, s28, v13
    v_mfma_f32_16x16x32_bf16 a[40:43], a[228:231], v[34:37], a[40:43]
    s_add_u32 s21, s21, 128
    ds_read_b128 a[216:219], v1 offset:12288
    v_cvt_pk_bf16_f32 v38, v84, v85
    v_mfma_f32_16x16x32_bf16 v[248:251], a[228:231], v[28:31], v[248:251]
    s_add_u32 m0, s22, 37888
    v_exp_f32 v74, v74
    v_mfma_f32_16x16x32_bf16 v[252:255], a[232:235], v[28:31], v[252:255]
    buffer_load_dwordx4 v6, s[8:11], s21 offen lds
    v_mfma_f32_16x16x32_bf16 v[204:207], a[232:235], v[22:25], v[204:207]
    s_add_u32 s21, s21, 128
    v_exp_f32 v69, v69
    v_mfma_f32_16x16x32_bf16 v[200:203], a[228:231], v[22:25], v[200:203]
    v_cvt_pk_bf16_f32 v26, v68, v69
    s_add_u32 m0, s22, 38912
    v_mfma_f32_16x16x32_bf16 v[152:155], a[228:231], v[16:19], v[152:155]
    buffer_load_dwordx4 v6, s[8:11], s21 offen lds
    v_mfma_f32_16x16x32_bf16 v[156:159], a[232:235], v[16:19], v[156:159]
    s_waitcnt lgkmcnt(2)
    v_mfma_f32_16x16x32_bf16 v[52:55], a[212:215], a[96:99], 0
    v_cvt_pk_bf16_f32 v29, v74, v75
    v_mfma_f32_16x16x32_bf16 v[60:63], a[212:215], a[120:123], 0
    ds_read_b128 a[228:231], v0 offset:14336
    v_cvt_pk_bf16_f32 v27, v70, v71
    v_mfma_f32_16x16x32_bf16 v[68:71], a[212:215], a[144:147], 0
    ds_read_b128 a[224:227], v1 offset:13312
    v_mfma_f32_16x16x32_bf16 v[76:79], a[212:215], a[168:171], 0
    v_exp_f32 v90, v90
    v_mfma_f32_16x16x32_bf16 v[84:87], a[212:215], a[192:195], 0
    s_waitcnt lgkmcnt(2)
    v_exp_f32 v66, v66
    v_mfma_f32_16x16x32_bf16 v[52:55], a[216:219], a[100:103], v[52:55]
    v_mfma_f32_16x16x32_bf16 v[60:63], a[216:219], a[124:127], v[60:63]
    v_exp_f32 v89, v89
    v_mfma_f32_16x16x32_bf16 v[68:71], a[216:219], a[148:151], v[68:71]
    v_exp_f32 v65, v65
    v_mfma_f32_16x16x32_bf16 v[76:79], a[216:219], a[172:175], v[76:79]
    v_exp_f32 v91, v91
    v_mfma_f32_16x16x32_bf16 v[84:87], a[216:219], a[196:199], v[84:87]
    v_cvt_pk_bf16_f32 v23, v66, v67
    v_cvt_pk_bf16_f32 v40, v88, v89
    v_mfma_f32_16x16x32_bf16 v[52:55], a[220:223], a[104:107], v[52:55]
    v_exp_f32 v58, v58
    v_mfma_f32_16x16x32_bf16 v[60:63], a[220:223], a[128:131], v[60:63]
    v_exp_f32 v81, v81
    v_mfma_f32_16x16x32_bf16 v[68:71], a[220:223], a[152:155], v[68:71]
    s_add_u32 s21, s21, 12032
    ds_read_b128 a[232:235], v1 offset:14336
    v_cvt_pk_bf16_f32 v17, v58, v59
    v_mfma_f32_16x16x32_bf16 v[76:79], a[220:223], a[176:179], v[76:79]
    v_fma_f32 v80, v80, s28, v12
    v_mfma_f32_16x16x32_bf16 v[84:87], a[220:223], a[200:203], v[84:87]
    s_waitcnt lgkmcnt(1)
    v_exp_f32 v83, v83
    v_mfma_f32_16x16x32_bf16 v[52:55], a[224:227], a[108:111], v[52:55]
    v_exp_f32 v72, v72
    v_mfma_f32_16x16x32_bf16 v[60:63], a[224:227], a[132:135], v[60:63]
    v_cvt_pk_bf16_f32 v16, v56, v57
    v_fma_f32 v64, v64, s28, v10
    v_mfma_f32_16x16x32_bf16 v[68:71], a[224:227], a[156:159], v[68:71]
    v_exp_f32 v73, v73
    v_mfma_f32_16x16x32_bf16 v[76:79], a[224:227], a[180:183], v[76:79]
    v_exp_f32 v80, v80
    v_mfma_f32_16x16x32_bf16 v[84:87], a[224:227], a[204:207], v[84:87]
    v_exp_f32 v64, v64
    v_mfma_f32_16x16x32_bf16 v[52:55], a[228:231], a[112:115], v[52:55]
    v_cvt_pk_bf16_f32 v34, v80, v81
    v_cvt_pk_bf16_f32 v28, v72, v73
    v_mfma_f32_16x16x32_bf16 v[44:47], a[236:239], v[14:17], v[48:51]
    v_mfma_f32_16x16x32_bf16 v[60:63], a[228:231], a[136:139], v[60:63]
    v_cvt_pk_bf16_f32 v35, v82, v83
    v_cvt_pk_bf16_f32 v22, v64, v65
    v_mfma_f32_16x16x32_bf16 v[68:71], a[228:231], a[160:163], v[68:71]
    ds_read_b128 a[212:215], v0 offset:20480
    v_cvt_pk_bf16_f32 v41, v90, v91
    v_mfma_f32_16x16x32_bf16 v[44:47], a[240:243], v[20:23], v[44:47]
    v_mfma_f32_16x16x32_bf16 v[76:79], a[228:231], a[184:187], v[76:79]
    ds_read_b128 a[224:227], v1 offset:18432
    v_mfma_f32_16x16x32_bf16 v[84:87], a[228:231], a[208:211], v[84:87]
    ds_read_b128 a[216:219], v1 offset:20480
    v_mfma_f32_16x16x32_bf16 v[44:47], a[244:247], v[26:29], v[44:47]
    v_mfma_f32_16x16x32_bf16 v[44:47], a[248:251], v[32:35], v[44:47]
    v_mfma_f32_16x16x32_bf16 v[44:47], a[252:255], v[38:41], v[44:47]
    s_waitcnt lgkmcnt(3)
    v_mfma_f32_16x16x32_bf16 v[52:55], a[232:235], a[116:119], v[52:55]
    ds_read_b128 a[220:223], v0 offset:18432
    v_mfma_f32_16x16x32_bf16 v[60:63], a[232:235], a[140:143], v[60:63]
    ds_read_b128 a[228:231], v0 offset:19456
    v_mfma_f32_16x16x32_bf16 v[68:71], a[232:235], a[164:167], v[68:71]
    s_nop 1
    v_cmp_lt_f32 vcc, s29, v44
    v_mfma_f32_16x16x32_bf16 v[76:79], a[232:235], a[188:191], v[76:79]
    v_mfma_f32_16x16x32_bf16 v[84:87], a[232:235], v[92:95], v[84:87]
    s_waitcnt lgkmcnt(4)
    ds_read_b128 a[232:235], v1 offset:19456
    v_mfma_f32_16x16x32_bf16 v[56:59], a[212:215], a[112:115], 0
    s_cbranch_vccnz L_rs_tr55a
L_ret_tr55a:
    v_mfma_f32_16x16x32_bf16 v[64:67], a[212:215], a[136:139], 0
    v_fma_f32 v53, v53, s28, v9
    v_mfma_f32_16x16x32_bf16 v[72:75], a[212:215], a[160:163], 0
    v_fma_f32 v55, v55, s28, v9
    v_fma_f32 v61, v61, s28, v10
    v_mfma_f32_16x16x32_bf16 v[80:83], a[212:215], a[184:187], 0
    v_fma_f32 v62, v62, s28, v10
    v_fma_f32 v63, v63, s28, v10
    v_mfma_f32_16x16x32_bf16 v[88:91], a[212:215], a[208:211], 0
    s_waitcnt lgkmcnt(3)
    v_exp_f32 v53, v53
    v_mfma_f32_16x16x32_bf16 v[56:59], a[216:219], a[116:119], v[56:59]
    v_exp_f32 v63, v63
    v_mfma_f32_16x16x32_bf16 v[64:67], a[216:219], a[140:143], v[64:67]
    v_exp_f32 v55, v55
    v_mfma_f32_16x16x32_bf16 v[72:75], a[216:219], a[164:167], v[72:75]
    v_mfma_f32_16x16x32_bf16 v[80:83], a[216:219], a[188:191], v[80:83]
    s_waitcnt vmcnt(7) lgkmcnt(0)
    v_mfma_f32_16x16x32_bf16 v[88:91], a[216:219], v[92:95], v[88:91]
    s_barrier
    v_mfma_f32_16x16x32_bf16 v[56:59], a[220:223], a[96:99], v[56:59]
    s_add_u32 m0, s22, 12288
    v_exp_f32 v62, v62
    v_mfma_f32_16x16x32_bf16 v[64:67], a[220:223], a[120:123], v[64:67]
    buffer_load_dwordx4 v6, s[4:7], s20 offen lds
    v_mfma_f32_16x16x32_bf16 v[72:75], a[220:223], a[144:147], v[72:75]
    ds_read_b64_tr_b16 a[212:213], v2 offset:0
    v_fma_f32 v52, v52, s28, v9
    v_mfma_f32_16x16x32_bf16 v[80:83], a[220:223], a[168:171], v[80:83]
    s_add_u32 s20, s20, 128
    s_add_u32 m0, s22, 13312
    v_fma_f32 v54, v54, s28, v9
    v_mfma_f32_16x16x32_bf16 v[88:91], a[220:223], a[192:195], v[88:91]
    buffer_load_dwordx4 v6, s[4:7], s20 offen lds
    v_mfma_f32_16x16x32_bf16 v[56:59], a[224:227], a[100:103], v[56:59]
    s_add_u32 s20, s20, 128
    ds_read_b64_tr_b16 a[214:215], v2 offset:6144
    v_fma_f32 v60, v60, s28, v10
    v_mfma_f32_16x16x32_bf16 v[64:67], a[224:227], a[124:127], v[64:67]
    v_exp_f32 v61, v61
    v_mfma_f32_16x16x32_bf16 v[72:75], a[224:227], a[148:151], v[72:75]
    v_exp_f32 v54, v54
    v_mfma_f32_16x16x32_bf16 v[80:83], a[224:227], a[172:175], v[80:83]
    ds_read_b64_tr_b16 a[216:217], v3 offset:0
    s_add_u32 m0, s22, 14336
    v_mfma_f32_16x16x32_bf16 v[88:91], a[224:227], a[196:199], v[88:91]
    ds_read_b64_tr_b16 a[218:219], v3 offset:6144
    v_mfma_f32_16x16x32_bf16 v[56:59], a[228:231], a[104:107], v[56:59]
    buffer_load_dwordx4 v6, s[4:7], s20 offen lds
    v_mfma_f32_16x16x32_bf16 v[64:67], a[228:231], a[128:131], v[64:67]
    v_exp_f32 v52, v52
    v_mfma_f32_16x16x32_bf16 v[72:75], a[228:231], a[152:155], v[72:75]
    ds_read_b64_tr_b16 a[220:221], v4 offset:0
    v_cvt_pk_bf16_f32 v19, v54, v55
    v_mfma_f32_16x16x32_bf16 v[80:83], a[228:231], a[176:179], v[80:83]
    v_exp_f32 v60, v60
    v_mfma_f32_16x16x32_bf16 v[88:91], a[228:231], a[200:203], v[88:91]
    s_add_u32 s20, s20, 12032
    v_cvt_pk_bf16_f32 v25, v62, v63
    v_mfma_f32_16x16x32_bf16 v[56:59], a[232:235], a[108:111], v[56:59]
    ds_read_b64_tr_b16 a[222:223], v4 offset:6144
    v_cvt_pk_bf16_f32 v18, v52, v53
    v_mfma_f32_16x16x32_bf16 v[64:67], a[232:235], a[132:135], v[64:67]
    buffer_load_dwordx4 a[208:211], v96, s[12:15], s48 offen offset:256 nt
    v_mfma_f32_16x16x32_bf16 v[72:75], a[232:235], a[156:159], v[72:75]
    buffer_load_dwordx4 v[92:95], v96, s[12:15], s48 offen offset:320 nt
    v_mfma_f32_16x16x32_bf16 v[80:83], a[232:235], a[180:183], v[80:83]
    ds_read_b64_tr_b16 a[224:225], v5 offset:0
    v_mfma_f32_16x16x32_bf16 v[88:91], a[232:235], a[204:207], v[88:91]
    s_waitcnt lgkmcnt(3)
    ds_read_b64_tr_b16 a[226:227], v5 offset:6144
    v_cvt_pk_bf16_f32 v24, v60, v61
    v_mfma_f32_16x16x32_bf16 v[112:115], a[212:215], v[14:17], v[112:115]
    v_lshrrev_b32 v105, 11, v0
    v_fma_f32 v69, v69, s28, v11
    v_mfma_f32_16x16x32_bf16 v[116:119], a[216:219], v[14:17], v[116:119]
    ds_read_b64_tr_b16 a[234:235], v3 offset:7168
    v_fma_f32 v66, v66, s28, v10
    v_mfma_f32_16x16x32_bf16 v[164:167], a[216:219], v[20:23], v[164:167]
    ds_read_b64_tr_b16 a[230:231], v2 offset:7168
    v_xor_b32 v105, s65, v105
    v_mfma_f32_16x16x32_bf16 v[160:163], a[212:215], v[20:23], v[160:163]
    v_fma_f32 v77, v77, s28, v12
    v_and_b32 v104, 0x3ff, v0
    v_mfma_f32_16x16x32_bf16 v[208:211], a[212:215], v[26:29], v[208:211]
    ds_read_b64_tr_b16 a[232:233], v3 offset:1024
    v_fma_f32 v86, v86, s28, v13
    v_mfma_f32_16x16x32_bf16 v[212:215], a[216:219], v[26:29], v[212:215]
    ds_read_b64_tr_b16 a[228:229], v2 offset:1024
    v_fma_f32 v90, v90, s28, v13
    v_mfma_f32_16x16x32_bf16 a[4:7], a[216:219], v[32:35], a[4:7]
    v_lshl_add_u32 v104, v105, 10, v104
    v_fma_f32 v79, v79, s28, v12
    v_mfma_f32_16x16x32_bf16 a[0:3], a[212:215], v[32:35], a[0:3]
    v_fma_f32 v91, v91, s28, v13
    v_fma_f32 v83, v83, s28, v12
    v_mfma_f32_16x16x32_bf16 a[48:51], a[212:215], v[38:41], a[48:51]
    v_exp_f32 v86, v86
    v_mfma_f32_16x16x32_bf16 a[52:55], a[216:219], v[38:41], a[52:55]
    s_waitcnt lgkmcnt(4)
    ds_read_b64_tr_b16 a[214:215], v4 offset:7168
    v_add_u32 v104, s38, v104
    v_mfma_f32_16x16x32_bf16 a[56:59], a[220:223], v[38:41], a[56:59]
    v_fma_f32 v64, v64, s28, v10
    v_fma_f32 v68, v68, s28, v11
    v_mfma_f32_16x16x32_bf16 a[60:63], a[224:227], v[38:41], a[60:63]
    ds_read_b64_tr_b16 a[218:219], v5 offset:7168
    v_fma_f32 v87, v87, s28, v13
    v_mfma_f32_16x16x32_bf16 a[12:15], a[224:227], v[32:35], a[12:15]
    v_exp_f32 v91, v91
    v_mfma_f32_16x16x32_bf16 a[8:11], a[220:223], v[32:35], a[8:11]
    ds_read_b128 a[176:179], v104 offset:20480
    v_fma_f32 v57, v57, s28, v9
    v_mfma_f32_16x16x32_bf16 v[216:219], a[220:223], v[26:29], v[216:219]
    v_exp_f32 v83, v83
    v_mfma_f32_16x16x32_bf16 v[220:223], a[224:227], v[26:29], v[220:223]
    ds_read_b64_tr_b16 a[212:213], v4 offset:1024
    v_fma_f32 v89, v89, s28, v13
    v_mfma_f32_16x16x32_bf16 v[172:175], a[224:227], v[20:23], v[172:175]
    ds_read_b64_tr_b16 a[216:217], v5 offset:1024
    v_fma_f32 v84, v84, s28, v13
    v_mfma_f32_16x16x32_bf16 v[168:171], a[220:223], v[20:23], v[168:171]
    v_exp_f32 v68, v68
    v_mfma_f32_16x16x32_bf16 v[120:123], a[220:223], v[14:17], v[120:123]
    v_xor_b32 v105, 64, v104
    v_fma_f32 v78, v78, s28, v12
    v_mfma_f32_16x16x32_bf16 v[124:127], a[224:227], v[14:17], v[124:127]
    s_waitcnt lgkmcnt(4)
    ds_read_b64_tr_b16 a[220:221], v2 offset:2048
    v_fma_f32 v76, v76, s28, v12
    v_mfma_f32_16x16x32_bf16 v[128:131], a[228:231], v[14:17], v[128:131]
    v_exp_f32 v87, v87
    v_mfma_f32_16x16x32_bf16 v[132:135], a[232:235], v[14:17], v[132:135]
    v_fma_f32 v71, v71, s28, v11
    v_fma_f32 v67, v67, s28, v10
    v_mfma_f32_16x16x32_bf16 v[180:183], a[232:235], v[20:23], v[180:183]
    ds_read_b64_tr_b16 a[226:227], v3 offset:8192
    v_fma_f32 v56, v56, s28, v9
    v_mfma_f32_16x16x32_bf16 v[176:179], a[228:231], v[20:23], v[176:179]
    v_exp_f32 v71, v71
    v_mfma_f32_16x16x32_bf16 v[224:227], a[228:231], v[26:29], v[224:227]
    v_exp_f32 v79, v79
    v_mfma_f32_16x16x32_bf16 v[228:231], a[232:235], v[26:29], v[228:231]
    v_exp_f32 v69, v69
    v_mfma_f32_16x16x32_bf16 a[20:23], a[232:235], v[32:35], a[20:23]
    v_fma_f32 v88, v88, s28, v13
    v_fma_f32 v82, v82, s28, v12
    v_mfma_f32_16x16x32_bf16 a[16:19], a[228:231], v[32:35], a[16:19]
    ds_read_b64_tr_b16 a[222:223], v2 offset:8192
    v_fma_f32 v70, v70, s28, v11
    v_mfma_f32_16x16x32_bf16 a[64:67], a[228:231], v[38:41], a[64:67]
    ds_read_b64_tr_b16 a[228:229], v4 offset:2048
    v_fma_f32 v75, v75, s28, v11
    v_mfma_f32_16x16x32_bf16 a[68:71], a[232:235], v[38:41], a[68:71]
    s_waitcnt lgkmcnt(3)
    v_exp_f32 v76, v76
    v_mfma_f32_16x16x32_bf16 a[72:75], a[212:215], v[38:41], a[72:75]
    s_add_u32 s39, s39, 12288
    ds_read_b64_tr_b16 a[224:225], v3 offset:2048
    v_exp_f32 v64, v64
    v_mfma_f32_16x16x32_bf16 a[76:79], a[216:219], v[38:41], a[76:79]
    ds_read_b128 a[120:123], v104 offset:6144
    v_fma_f32 v65, v65, s28, v10
    v_mfma_f32_16x16x32_bf16 a[28:31], a[216:219], v[32:35], a[28:31]
    ds_read_b64_tr_b16 a[230:231], v4 offset:8192
    v_exp_f32 v77, v77
    v_mfma_f32_16x16x32_bf16 a[24:27], a[212:215], v[32:35], a[24:27]
    v_exp_f32 v84, v84
    v_mfma_f32_16x16x32_bf16 v[232:235], a[212:215], v[26:29], v[232:235]
    ds_read_b64_tr_b16 a[234:235], v5 offset:8192
    v_fma_f32 v80, v80, s28, v12
    v_mfma_f32_16x16x32_bf16 v[236:239], a[216:219], v[26:29], v[236:239]
    ds_read_b128 a[144:147], v104 offset:12288
    v_fma_f32 v85, v85, s28, v13
    v_mfma_f32_16x16x32_bf16 v[188:191], a[216:219], v[20:23], v[188:191]
    ds_read_b64_tr_b16 a[232:233], v5 offset:2048
    v_exp_f32 v80, v80
    v_exp_f32 v78, v78
    v_mfma_f32_16x16x32_bf16 v[184:187], a[212:215], v[20:23], v[184:187]
    ds_read_b128 a[148:151], v105 offset:12288
    v_cvt_pk_bf16_f32 v30, v68, v69
    v_mfma_f32_16x16x32_bf16 v[136:139], a[212:215], v[14:17], v[136:139]
    ds_read_b128 a[132:135], v105 offset:8192
    v_fma_f32 v58, v58, s28, v9
    v_mfma_f32_16x16x32_bf16 v[140:143], a[216:219], v[14:17], v[140:143]
    s_waitcnt lgkmcnt(7)
    v_exp_f32 v70, v70
    v_mfma_f32_16x16x32_bf16 v[144:147], a[220:223], v[14:17], v[144:147]
    ds_read_b128 a[168:171], v104 offset:18432
    v_exp_f32 v65, v65
    v_mfma_f32_16x16x32_bf16 v[148:151], a[224:227], v[14:17], v[148:151]
    v_exp_f32 v89, v89
    v_mfma_f32_16x16x32_bf16 v[196:199], a[224:227], v[20:23], v[196:199]
    v_exp_f32 v85, v85
    v_mfma_f32_16x16x32_bf16 v[192:195], a[220:223], v[20:23], v[192:195]
    ds_read_b128 a[124:127], v105 offset:6144
    v_cvt_pk_bf16_f32 v43, v86, v87
    v_mfma_f32_16x16x32_bf16 v[240:243], a[220:223], v[26:29], v[240:243]
    ds_read_b128 a[152:155], v104 offset:14336
    v_fma_f32 v74, v74, s28, v11
    v_mfma_f32_16x16x32_bf16 v[244:247], a[224:227], v[26:29], v[244:247]
    s_waitcnt vmcnt(9) lgkmcnt(5)
    ds_read_b128 a[96:99], v104 offset:0
    v_cvt_pk_bf16_f32 v36, v76, v77
    v_mfma_f32_16x16x32_bf16 a[36:39], a[224:227], v[32:35], a[36:39]
    ds_read_b128 a[192:195], v104 offset:24576
    v_cvt_pk_bf16_f32 v42, v84, v85
    v_mfma_f32_16x16x32_bf16 a[32:35], a[220:223], v[32:35], a[32:35]
    s_add_u32 s21, s21, s62
    ds_read_b128 a[196:199], v105 offset:24576
    v_fma_f32 v59, v59, s28, v9
    v_mfma_f32_16x16x32_bf16 a[80:83], a[220:223], v[38:41], a[80:83]
    ds_read_b128 a[128:131], v104 offset:8192
    v_fma_f32 v81, v81, s28, v12
    v_mfma_f32_16x16x32_bf16 a[84:87], a[224:227], v[38:41], a[84:87]
    s_barrier
    v_mfma_f32_16x16x32_bf16 a[88:91], a[228:231], v[38:41], a[88:91]
    s_add_u32 m0, s22, 24576
    ds_read_b128 a[212:215], v0 offset:0
    v_cvt_pk_bf16_f32 v37, v78, v79
    v_mfma_f32_16x16x32_bf16 a[92:95], a[232:235], v[38:41], a[92:95]
    ds_read_b128 a[216:219], v1 offset:0
    buffer_load_dwordx4 v6, s[8:11], s21 offen lds
    v_mfma_f32_16x16x32_bf16 a[44:47], a[232:235], v[32:35], a[44:47]
    s_add_u32 s21, s21, 128
    ds_read_b128 a[172:175], v105 offset:18432
    v_fma_f32 v73, v73, s28, v11
    v_mfma_f32_16x16x32_bf16 a[40:43], a[228:231], v[32:35], a[40:43]
    ds_read_b128 a[100:103], v105 offset:0
    v_mfma_f32_16x16x32_bf16 v[248:251], a[228:231], v[26:29], v[248:251]
    s_add_u32 m0, s22, 25600
    ds_read_b128 a[156:159], v105 offset:14336
    buffer_load_dwordx4 v6, s[8:11], s21 offen lds
    v_mfma_f32_16x16x32_bf16 v[252:255], a[232:235], v[26:29], v[252:255]
    ds_read_b128 a[200:203], v104 offset:26624
    s_add_u32 s21, s21, 128
    v_mfma_f32_16x16x32_bf16 v[204:207], a[232:235], v[20:23], v[204:207]
    s_add_u32 m0, s22, 26624
    ds_read_b128 a[180:183], v105 offset:20480
    v_cvt_pk_bf16_f32 v31, v70, v71
    v_mfma_f32_16x16x32_bf16 v[200:203], a[228:231], v[20:23], v[200:203]
    ds_read_b128 a[104:107], v104 offset:2048
    v_exp_f32 v56, v56
    v_mfma_f32_16x16x32_bf16 v[152:155], a[228:231], v[14:17], v[152:155]
    buffer_load_dwordx4 v6, s[8:11], s21 offen lds
    ds_read_b128 a[224:227], v1 offset:1024
    v_mfma_f32_16x16x32_bf16 v[156:159], a[232:235], v[14:17], v[156:159]
    s_waitcnt lgkmcnt(8)
    ds_read_b128 a[220:223], v0 offset:1024
    v_exp_f32 v58, v58
    v_mfma_f32_16x16x32_bf16 v[52:55], a[212:215], a[96:99], 0
    v_exp_f32 v59, v59
    v_mfma_f32_16x16x32_bf16 v[60:63], a[212:215], a[120:123], 0
    ds_read_b128 a[164:167], v105 offset:16384
    v_fma_f32 v72, v72, s28, v11
    v_mfma_f32_16x16x32_bf16 v[68:71], a[212:215], a[144:147], 0
    ds_read_b128 a[204:207], v105 offset:26624
    v_cvt_pk_bf16_f32 v22, v64, v65
    v_mfma_f32_16x16x32_bf16 v[76:79], a[212:215], a[168:171], 0
    ds_read_b128 a[108:111], v105 offset:2048
    v_mfma_f32_16x16x32_bf16 v[84:87], a[212:215], a[192:195], 0
    s_waitcnt lgkmcnt(7)
    v_exp_f32 v88, v88
    v_mfma_f32_16x16x32_bf16 v[52:55], a[216:219], a[100:103], v[52:55]
    v_exp_f32 v67, v67
    v_mfma_f32_16x16x32_bf16 v[60:63], a[216:219], a[124:127], v[60:63]
    v_exp_f32 v75, v75
    v_mfma_f32_16x16x32_bf16 v[68:71], a[216:219], a[148:151], v[68:71]
    ds_read_b128 a[228:231], v0 offset:6144
    v_cvt_pk_bf16_f32 v17, v58, v59
    v_mfma_f32_16x16x32_bf16 v[76:79], a[216:219], a[172:175], v[76:79]
    v_exp_f32 v82, v82
    v_mfma_f32_16x16x32_bf16 v[84:87], a[216:219], a[196:199], v[84:87]
    s_waitcnt lgkmcnt(4)
    v_exp_f32 v90, v90
    v_mfma_f32_16x16x32_bf16 v[52:55], a[220:223], a[104:107], v[52:55]
    v_exp_f32 v81, v81
    v_mfma_f32_16x16x32_bf16 v[60:63], a[220:223], a[128:131], v[60:63]
    v_exp_f32 v73, v73
    v_mfma_f32_16x16x32_bf16 v[68:71], a[220:223], a[152:155], v[68:71]
    v_exp_f32 v66, v66
    v_mfma_f32_16x16x32_bf16 v[76:79], a[220:223], a[176:179], v[76:79]
    v_exp_f32 v72, v72
    v_mfma_f32_16x16x32_bf16 v[84:87], a[220:223], a[200:203], v[84:87]
    s_waitcnt lgkmcnt(1)
    v_exp_f32 v57, v57
    v_mfma_f32_16x16x32_bf16 v[52:55], a[224:227], a[108:111], v[52:55]
    v_cvt_pk_bf16_f32 v23, v66, v67
    v_cvt_pk_bf16_f32 v16, v56, v57
    v_mfma_f32_16x16x32_bf16 v[60:63], a[224:227], a[132:135], v[60:63]
    ds_read_b128 a[140:143], v105 offset:10240
    v_cvt_pk_bf16_f32 v41, v90, v91
    v_mfma_f32_16x16x32_bf16 v[68:71], a[224:227], a[156:159], v[68:71]
    v_exp_f32 v74, v74
    v_mfma_f32_16x16x32_bf16 v[76:79], a[224:227], a[180:183], v[76:79]
    ds_read_b128 a[220:223], v0 offset:2048
    v_cvt_pk_bf16_f32 v34, v80, v81
    v_mfma_f32_16x16x32_bf16 v[84:87], a[224:227], a[204:207], v[84:87]
    s_waitcnt lgkmcnt(2)
    ds_read_b128 a[232:235], v1 offset:6144
    v_mfma_f32_16x16x32_bf16 v[56:59], a[228:231], a[96:99], 0
    v_mfma_f32_16x16x32_bf16 v[48:51], a[236:239], v[16:19], v[44:47]
    v_cvt_pk_bf16_f32 v40, v88, v89
    v_cvt_pk_bf16_f32 v35, v82, v83
    v_mfma_f32_16x16x32_bf16 v[48:51], a[240:243], v[22:25], v[48:51]
    v_cvt_pk_bf16_f32 v28, v72, v73
    v_cvt_pk_bf16_f32 v29, v74, v75
    v_mfma_f32_16x16x32_bf16 v[64:67], a[228:231], a[120:123], 0
    ds_read_b128 a[212:215], v0 offset:7168
    v_mfma_f32_16x16x32_bf16 v[48:51], a[244:247], v[28:31], v[48:51]
    ds_read_b128 a[184:187], v104 offset:22528
    v_mfma_f32_16x16x32_bf16 v[72:75], a[228:231], a[144:147], 0
    ds_read_b128 a[216:219], v1 offset:7168
    v_mfma_f32_16x16x32_bf16 v[48:51], a[248:251], v[34:37], v[48:51]
    v_mfma_f32_16x16x32_bf16 v[48:51], a[252:255], v[40:43], v[48:51]
    s_add_u32 s21, s21, 12032
    ds_read_b128 a[116:119], v105 offset:4096
    v_mfma_f32_16x16x32_bf16 v[80:83], a[228:231], a[168:171], 0
    ds_read_b128 a[188:191], v105 offset:22528
    v_mfma_f32_16x16x32_bf16 v[88:91], a[228:231], a[192:195], 0
    s_waitcnt lgkmcnt(5)
    ds_read_b128 a[160:163], v104 offset:16384
    v_mfma_f32_16x16x32_bf16 v[56:59], a[232:235], a[100:103], v[56:59]
    ds_read_b128 a[112:115], v104 offset:4096
    v_mfma_f32_16x16x32_bf16 v[64:67], a[232:235], a[124:127], v[64:67]
    ds_read_b128 a[136:139], v104 offset:10240
    v_cmp_lt_f32 vcc, s29, v48
    v_mfma_f32_16x16x32_bf16 v[72:75], a[232:235], a[148:151], v[72:75]
    ds_read_b128 a[224:227], v1 offset:2048
    v_mfma_f32_16x16x32_bf16 v[80:83], a[232:235], a[172:175], v[80:83]
    ds_read_b128 a[228:231], v0 offset:8192
    v_mfma_f32_16x16x32_bf16 v[88:91], a[232:235], a[196:199], v[88:91]
    s_waitcnt lgkmcnt(8)
    ds_read_b128 a[232:235], v1 offset:8192
    v_mfma_f32_16x16x32_bf16 v[56:59], a[212:215], a[104:107], v[56:59]
    s_cbranch_vccnz L_rs_tr55b
L_ret_tr55b:
    v_lshrrev_b32 v108, 11, v0
    v_mfma_f32_16x16x32_bf16 v[64:67], a[212:215], a[128:131], v[64:67]
    v_mov_b32 v100, v48
    v_and_b32 v101, 0x3ff, v0
    v_mfma_f32_16x16x32_bf16 v[72:75], a[212:215], a[152:155], v[72:75]
    v_rcp_f32 v102, v49
    v_mfma_f32_16x16x32_bf16 v[80:83], a[212:215], a[176:179], v[80:83]
    v_permlane32_swap_b32 v48, v100
    v_mfma_f32_16x16x32_bf16 v[88:91], a[212:215], a[200:203], v[88:91]
    s_waitcnt lgkmcnt(5)
    v_xor_b32 v108, s65, v108
    v_lshl_add_u32 v101, v108, 10, v101
    v_mfma_f32_16x16x32_bf16 v[56:59], a[216:219], a[108:111], v[56:59]
    s_waitcnt vmcnt(3)
    v_mbcnt_lo_u32_b32 v108, -1, 0
    v_mbcnt_hi_u32_b32 v108, -1, v108
    v_mfma_f32_16x16x32_bf16 v[64:67], a[216:219], a[132:135], v[64:67]
    v_mfma_f32_16x16x32_bf16 v[72:75], a[216:219], a[156:159], v[72:75]
    v_lshrrev_b32 v108, 1, v108
    v_add_u32 v101, s38, v101
    v_mfma_f32_16x16x32_bf16 v[80:83], a[216:219], a[180:183], v[80:83]
    s_waitcnt vmcnt(8) lgkmcnt(0)
    v_mfma_f32_16x16x32_bf16 v[88:91], a[216:219], a[204:207], v[88:91]
    s_barrier
    v_mfma_f32_16x16x32_bf16 v[52:55], a[220:223], a[112:115], v[52:55]
    ds_read_b64_tr_b16 a[212:213], v2 offset:18432
    s_add_u32 m0, s22, 0
    v_mfma_f32_16x16x32_bf16 v[60:63], a[220:223], a[136:139], v[60:63]
    buffer_load_dwordx4 v6, s[4:7], s20 offen lds
    v_mfma_f32_16x16x32_bf16 v[68:71], a[220:223], a[160:163], v[68:71]
    ds_read_b64_tr_b16 a[214:215], v2 offset:12288
    v_mfma_f32_16x16x32_bf16 v[76:79], a[220:223], a[184:187], v[76:79]
    s_add_u32 s20, s20, 128
    s_add_u32 m0, s22, 1024
    ds_read_b64_tr_b16 a[216:217], v3 offset:18432
    v_mfma_f32_16x16x32_bf16 v[84:87], a[220:223], a[208:211], v[84:87]
    buffer_load_dwordx4 v6, s[4:7], s20 offen lds
    v_mfma_f32_16x16x32_bf16 v[52:55], a[224:227], a[116:119], v[52:55]
    s_add_u32 s20, s20, 128
    s_add_u32 m0, s22, 2048
    v_and_b32 v108, 24, v108
    v_mfma_f32_16x16x32_bf16 v[60:63], a[224:227], a[140:143], v[60:63]
    buffer_load_dwordx4 v6, s[4:7], s20 offen lds
    v_mfma_f32_16x16x32_bf16 v[68:71], a[224:227], a[164:167], v[68:71]
    ds_read_b64_tr_b16 a[218:219], v3 offset:12288
    v_mfma_f32_16x16x32_bf16 v[76:79], a[224:227], a[188:191], v[76:79]
    ds_read_b64_tr_b16 a[220:221], v4 offset:18432
    v_bfe_u32 v108, s66, v108, 8
    v_mfma_f32_16x16x32_bf16 v[84:87], a[224:227], v[92:95], v[84:87]
    v_rcp_f32 v8, v51
    v_mfma_f32_16x16x32_bf16 v[56:59], a[228:231], a[112:115], v[56:59]
    v_rcp_f32 v50, v50
    v_mfma_f32_16x16x32_bf16 v[64:67], a[228:231], a[136:139], v[64:67]
    v_rcp_f32 v48, v48
    v_mfma_f32_16x16x32_bf16 v[72:75], a[228:231], a[160:163], v[72:75]
    v_xor_b32 v101, v101, v108
    v_mfma_f32_16x16x32_bf16 v[80:83], a[228:231], a[184:187], v[80:83]
    ds_read_b64_tr_b16 a[222:223], v4 offset:12288
    v_mov_b32 v108, v100
    v_mfma_f32_16x16x32_bf16 v[88:91], a[228:231], a[208:211], v[88:91]
    s_add_u32 s20, s20, 12032
    v_permlane16_swap_b32 v100, v108
    v_mfma_f32_16x16x32_bf16 v[56:59], a[232:235], a[116:119], v[56:59]
    ds_read_b64_tr_b16 a[224:225], v5 offset:18432
    v_mfma_f32_16x16x32_bf16 v[64:67], a[232:235], a[140:143], v[64:67]
    v_mfma_f32_16x16x32_bf16 v[72:75], a[232:235], a[164:167], v[72:75]
    v_rcp_f32 v100, v100
    v_mfma_f32_16x16x32_bf16 v[80:83], a[232:235], a[188:191], v[80:83]
    ds_read_b64_tr_b16 a[226:227], v5 offset:12288
    v_mfma_f32_16x16x32_bf16 v[88:91], a[232:235], v[92:95], v[88:91]
    s_waitcnt lgkmcnt(3)
    v_mfma_f32_16x16x32_bf16 v[112:115], a[212:215], v[16:19], v[112:115]
    s_mov_b32 s67, s34
    v_max3_f32 v97, v60, v61, v62
    v_max3_f32 v96, v52, v53, v54
    v_max3_f32 v96, v96, v55, v56
    v_max3_f32 v99, v76, v77, v78
    v_mfma_f32_16x16x32_bf16 v[116:119], a[216:219], v[16:19], v[116:119]
    s_add_u32 s18, s34, 30720
    v_max3_f32 v98, v68, v69, v70
    v_max3_f32 v99, v99, v79, v80
    v_max3_f32 v98, v98, v71, v72
    v_mfma_f32_16x16x32_bf16 v[164:167], a[216:219], v[22:25], v[164:167]
    v_max3_f32 v98, v98, v73, v74
    v_max3_f32 v96, v96, v57, v58
    v_max3_f32 v97, v97, v63, v64
    v_max3_f32 v97, v97, v65, v66
    v_mfma_f32_16x16x32_bf16 v[160:163], a[212:215], v[22:25], v[160:163]
    ds_read_b64_tr_b16 a[228:229], v2 offset:19456
    v_max3_f32 v99, v99, v81, v82
    v_mfma_f32_16x16x32_bf16 v[208:211], a[212:215], v[28:31], v[208:211]
    v_max_f32 v99, v99, v83
    v_max_f32 v96, v96, v59
    v_mfma_f32_16x16x32_bf16 v[212:215], a[216:219], v[28:31], v[212:215]
    s_mov_b32 s34, s33
    v_max_f32 v97, v97, v67
    v_max_f32 v98, v98, v75
    v_mfma_f32_16x16x32_bf16 a[4:7], a[216:219], v[34:37], a[4:7]
    s_add_u32 s64, s64, s62
    v_permlane32_swap_b32 v96, v97
    v_mfma_f32_16x16x32_bf16 a[0:3], a[212:215], v[34:37], a[0:3]
    s_add_u32 s64, s64, 196608
    ds_read_b64_tr_b16 a[230:231], v2 offset:13312
    v_max_f32 v96, v96, v97
    v_mfma_f32_16x16x32_bf16 a[48:51], a[212:215], v[40:43], a[48:51]
    s_mov_b32 s39, s64
    v_permlane32_swap_b32 v98, v99
    v_mfma_f32_16x16x32_bf16 a[52:55], a[216:219], v[40:43], a[52:55]
    s_waitcnt lgkmcnt(2)
    ds_read_b64_tr_b16 a[234:235], v3 offset:13312
    v_max_f32 v98, v98, v99
    v_mfma_f32_16x16x32_bf16 a[56:59], a[220:223], v[40:43], a[56:59]
    ds_read_b64_tr_b16 a[218:219], v5 offset:13312
    v_permlane16_swap_b32 v96, v98
    v_mfma_f32_16x16x32_bf16 a[60:63], a[224:227], v[40:43], a[60:63]
    s_add_u32 s37, s37, 1
    ds_read_b64_tr_b16 a[232:233], v3 offset:19456
    v_max_f32 v96, v96, v98
    v_mfma_f32_16x16x32_bf16 a[12:15], a[224:227], v[34:37], a[12:15]
    s_bitcmp1_b32 s63, s37
    v_mul_f32_e64 v9, -s28, v96
    v_mov_b32 v11, v9
    v_max3_f32 v96, v84, v85, v86
    v_mfma_f32_16x16x32_bf16 a[8:11], a[220:223], v[34:37], a[8:11]
    s_cselect_b32 s62, 4294770688, 0
    ds_read_b64_tr_b16 a[216:217], v5 offset:19456
    v_permlane16_swap_b32 v9, v11
    v_max3_f32 v96, v96, v87, v88
    v_mfma_f32_16x16x32_bf16 v[216:219], a[220:223], v[28:31], v[216:219]
    s_cselect_b32 s42, 0, 325632
    v_mov_b32 v12, v11
    v_max3_f32 v96, v96, v89, v90
    v_mfma_f32_16x16x32_bf16 v[220:223], a[224:227], v[28:31], v[220:223]
    s_add_u32 s35, s35, s42
    ds_read_b64_tr_b16 a[214:215], v4 offset:13312
    v_mov_b32 v10, v9
    v_mfma_f32_16x16x32_bf16 v[172:175], a[224:227], v[22:25], v[172:175]
    ds_read_b64_tr_b16 a[212:213], v4 offset:19456
    v_max_f32 v96, v96, v91
    v_accvgpr_read_b32 v109, a49
    v_permlane32_swap_b32 v9, v10
    v_fma_f32 v56, v56, s28, v9
    v_mfma_f32_16x16x32_bf16 v[168:171], a[220:223], v[22:25], v[168:171]
    s_lshl_b32 s42, s37, 1
    v_permlane32_swap_b32 v11, v12
    v_mfma_f32_16x16x32_bf16 v[120:123], a[220:223], v[16:19], v[120:123]
    s_lshr_b32 s42, s31, s42
    v_fma_f32 v59, v59, s28, v9
    v_accvgpr_read_b32 v108, a48
    v_accvgpr_read_b32 v110, a50
    v_mfma_f32_16x16x32_bf16 v[124:127], a[224:227], v[16:19], v[124:127]
    s_waitcnt lgkmcnt(3)
    v_fma_f32 v71, v71, s28, v11
    v_fma_f32 v61, v61, s28, v10
    v_mfma_f32_16x16x32_bf16 v[128:131], a[228:231], v[16:19], v[128:131]
    s_and_b32 s42, s42, 3
    ds_read_b64_tr_b16 a[222:223], v2 offset:14336
    v_mov_b32 v97, v96
    v_mfma_f32_16x16x32_bf16 v[132:135], a[232:235], v[16:19], v[132:135]
    ds_read_b64_tr_b16 a[226:227], v3 offset:14336
    v_fma_f32 v57, v57, s28, v9
    v_fma_f32 v58, v58, s28, v9
    v_mfma_f32_16x16x32_bf16 v[180:183], a[232:235], v[22:25], v[180:183]
    s_add_u32 s42, s42, s36
    v_exp_f32 v57, v57
    v_mfma_f32_16x16x32_bf16 v[176:179], a[228:231], v[22:25], v[176:179]
    s_sub_u32 s43, s42, 3
    v_permlane32_swap_b32 v97, v96
    v_mfma_f32_16x16x32_bf16 v[224:227], a[228:231], v[28:31], v[224:227]
    s_cmp_ge_u32 s42, 3
    ds_read_b64_tr_b16 a[224:225], v3 offset:20480
    v_fma_f32 v77, v77, s28, v12
    v_mfma_f32_16x16x32_bf16 v[228:231], a[232:235], v[28:31], v[228:231]
    s_cselect_b32 s42, s43, s42
    ds_read_b64_tr_b16 a[220:221], v2 offset:20480
    v_fma_f32 v53, v53, s28, v9
    v_mfma_f32_16x16x32_bf16 a[20:23], a[232:235], v[34:37], a[20:23]
    s_mul_i32 s44, s3, 5
    v_exp_f32 v61, v61
    v_mfma_f32_16x16x32_bf16 a[16:19], a[228:231], v[34:37], a[16:19]
    s_mov_b32 s32, 1
    v_fma_f32 v74, v74, s28, v11
    v_accvgpr_read_b32 v111, a51
    v_mfma_f32_16x16x32_bf16 a[64:67], a[228:231], v[40:43], a[64:67]
    s_lshl_b32 s43, s3, 2
    ds_read_b64_tr_b16 a[230:231], v4 offset:14336
    v_fma_f32 v75, v75, s28, v11
    v_fma_f32 v54, v54, s28, v9
    v_mfma_f32_16x16x32_bf16 a[68:71], a[232:235], v[40:43], a[68:71]
    s_waitcnt lgkmcnt(5)
    v_exp_f32 v53, v53
    v_fma_f32 v68, v68, s28, v11
    v_max_f32 v96, v96, v97
    v_mfma_f32_16x16x32_bf16 a[72:75], a[212:215], v[40:43], a[72:75]
    s_add_u32 s45, s43, 21
    ds_read_b64_tr_b16 a[232:233], v5 offset:20480
    v_fma_f32 v79, v79, s28, v12
    v_mfma_f32_16x16x32_bf16 a[76:79], a[216:219], v[40:43], a[76:79]
    s_cmp_eq_u32 s3, 0
    v_fma_f32 v64, v64, s28, v10
    v_mov_b32 v97, v96
    v_mfma_f32_16x16x32_bf16 a[28:31], a[216:219], v[34:37], a[28:31]
    s_cselect_b32 s45, 20, s45
    v_permlane16_swap_b32 v97, v96
    v_mfma_f32_16x16x32_bf16 a[24:27], a[212:215], v[34:37], a[24:27]
    s_cselect_b32 s33, 1, 0
    v_accvgpr_read_b32 v105, a1
    v_fma_f32 v76, v76, s28, v12
    v_mfma_f32_16x16x32_bf16 v[232:235], a[212:215], v[28:31], v[232:235]
    s_cmp_eq_u32 s42, 1
    v_fma_f32 v52, v52, s28, v9
    v_max_f32 v96, v96, v97
    v_mfma_f32_16x16x32_bf16 v[236:239], a[216:219], v[28:31], v[236:239]
    s_cselect_b32 s44, s45, s44
    v_fma_f32 v55, v55, s28, v9
    v_fma_f32 v60, v60, s28, v10
    v_mfma_f32_16x16x32_bf16 v[188:191], a[216:219], v[22:25], v[188:191]
    s_cselect_b32 s32, s33, s32
    v_exp_f32 v54, v54
    v_mfma_f32_16x16x32_bf16 v[184:187], a[212:215], v[22:25], v[184:187]
    s_add_u32 s45, s43, 37
    ds_read_b64_tr_b16 a[234:235], v5 offset:14336
    v_exp_f32 v77, v77
    v_mfma_f32_16x16x32_bf16 v[136:139], a[212:215], v[16:19], v[136:139]
    s_cmp_eq_u32 s42, 2
    v_exp_f32 v76, v76
    v_mul_f32_e64 v13, -s28, v96
    v_exp_f32 v52, v52
    v_pk_mul_f32 v[216:217], v[216:217], v[50:51] op_sel_hi:[1,0]
    v_exp_f32 v68, v68
    s_cselect_b32 s44, s45, s44
    v_accvgpr_read_b32 v104, a0
    v_mfma_f32_16x16x32_bf16 v[140:143], a[216:219], v[16:19], v[140:143]
    s_waitcnt lgkmcnt(1)
    v_fma_f32 v62, v62, s28, v10
    v_fma_f32 v72, v72, s28, v11
    v_mfma_f32_16x16x32_bf16 v[144:147], a[220:223], v[16:19], v[144:147]
    s_cselect_b32 s32, 0, s32
    ds_read_b64_tr_b16 a[228:229], v4 offset:20480
    v_exp_f32 v79, v79
    v_mfma_f32_16x16x32_bf16 v[148:151], a[224:227], v[16:19], v[148:151]
    s_mul_i32 s44, s44, 6144
    v_fma_f32 v81, v81, s28, v12
    s_add_u32 s33, s35, s44
    v_mfma_f32_16x16x32_bf16 v[196:199], a[224:227], v[22:25], v[196:199]
    s_mul_i32 s42, s32, 6144
    v_fma_f32 v63, v63, s28, v10
    v_fma_f32 v78, v78, s28, v12
    v_mfma_f32_16x16x32_bf16 v[192:195], a[220:223], v[22:25], v[192:195]
    s_add_u32 s42, s42, 24576
    v_exp_f32 v60, v60
    v_mfma_f32_16x16x32_bf16 v[240:243], a[220:223], v[28:31], v[240:243]
    s_add_u32 s42, s42, s33
    v_fma_f32 v86, v86, s28, v13
    v_fma_f32 v87, v87, s28, v13
    v_exp_f32 v63, v63
    v_mfma_f32_16x16x32_bf16 v[244:247], a[224:227], v[28:31], v[244:247]
    s_cmp_ge_u32 s37, 6
    v_exp_f32 v81, v81
    v_cvt_pk_bf16_f32 v14, v52, v53
    v_mfma_f32_16x16x32_bf16 a[36:39], a[224:227], v[34:37], a[36:39]
    s_cselect_b32 s14, 0, s42
    v_exp_f32 v62, v62
    v_mfma_f32_16x16x32_bf16 a[32:35], a[220:223], v[34:37], a[32:35]
    s_add_u32 s24, s67, 256
    s_add_u32 s25, s33, 256
    v_fma_f32 v80, v80, s28, v12
    s_add_u32 s23, s38, 4096
    v_mfma_f32_16x16x32_bf16 a[80:83], a[220:223], v[40:43], a[80:83]
    s_mov_b32 s27, 0x249
    v_exp_f32 v64, v64
    v_mfma_f32_16x16x32_bf16 a[84:87], a[224:227], v[40:43], a[84:87]
    s_mov_b32 s30, 0
    s_waitcnt vmcnt(8) lgkmcnt(0)
    v_fma_f32 v84, v84, s28, v13
    v_mfma_f32_16x16x32_bf16 a[88:91], a[228:231], v[40:43], a[88:91]
    s_barrier
    v_mfma_f32_16x16x32_bf16 a[92:95], a[232:235], v[40:43], a[92:95]
    v_cvt_pk_bf16_f32 v20, v60, v61
    v_cvt_pk_bf16_f32 v21, v62, v63
    v_fma_f32 v69, v69, s28, v11
    v_exp_f32 v69, v69
    v_mfma_f32_16x16x32_bf16 a[44:47], a[232:235], v[34:37], a[44:47]
    ds_read_b128 a[212:215], v0 offset:12288
    v_fma_f32 v85, v85, s28, v13
    v_fma_f32 v65, v65, s28, v10
    v_fma_f32 v88, v88, s28, v13
    v_mfma_f32_16x16x32_bf16 a[40:43], a[228:231], v[34:37], a[40:43]
    ds_read_b128 a[216:219], v1 offset:12288
    v_exp_f32 v85, v85
    v_mfma_f32_16x16x32_bf16 v[248:251], a[228:231], v[28:31], v[248:251]
    ds_read_b128 a[220:223], v0 offset:13312
    v_exp_f32 v55, v55
    v_exp_f32 v84, v84
    v_exp_f32 v71, v71
    v_cvt_pk_bf16_f32 v15, v54, v55
    v_mfma_f32_16x16x32_bf16 v[252:255], a[232:235], v[28:31], v[252:255]
    v_exp_f32 v59, v59
    v_mfma_f32_16x16x32_bf16 v[204:207], a[232:235], v[22:25], v[204:207]
    v_exp_f32 v65, v65
    v_fma_f32 v67, v67, s28, v10
    v_mfma_f32_16x16x32_bf16 v[200:203], a[228:231], v[22:25], v[200:203]
    v_cvt_pk_bf16_f32 v38, v84, v85
    v_fma_f32 v91, v91, s28, v13
    v_exp_f32 v87, v87
    v_mfma_f32_16x16x32_bf16 v[152:155], a[228:231], v[16:19], v[152:155]
    v_exp_f32 v86, v86
    v_cvt_pk_bf16_f32 v32, v76, v77
    v_mfma_f32_16x16x32_bf16 v[156:159], a[232:235], v[16:19], v[156:159]
    s_waitcnt lgkmcnt(2)
    ds_read_b128 a[224:227], v1 offset:13312
    v_fma_f32 v70, v70, s28, v11
    v_cvt_pk_bf16_f32 v39, v86, v87
    v_mfma_f32_16x16x32_bf16 v[52:55], a[212:215], a[96:99], 0
    s_waitcnt lgkmcnt(2)
    v_fma_f32 v66, v66, s28, v10
    v_exp_f32 v70, v70
    v_mfma_f32_16x16x32_bf16 v[52:55], a[216:219], a[100:103], v[52:55]
    s_waitcnt lgkmcnt(1)
    ds_read_b128 a[228:231], v0 offset:14336
    v_fma_f32 v82, v82, s28, v12
    v_mfma_f32_16x16x32_bf16 v[52:55], a[220:223], a[104:107], v[52:55]
    ds_read_b128 a[232:235], v1 offset:14336
    v_cvt_pk_bf16_f32 v22, v64, v65
    v_mfma_f32_16x16x32_bf16 v[60:63], a[220:223], a[128:131], 0
    v_cvt_pk_bf16_f32 v26, v68, v69
    v_cvt_pk_bf16_f32 v27, v70, v71
    v_mfma_f32_16x16x32_bf16 v[60:63], a[216:219], a[124:127], v[60:63]
    v_exp_f32 v74, v74
    v_mfma_f32_16x16x32_bf16 v[60:63], a[212:215], a[120:123], v[60:63]
    s_add_u32 m0, s22, 36864
    v_exp_f32 v91, v91
    v_mfma_f32_16x16x32_bf16 v[68:71], a[212:215], a[144:147], 0
    v_exp_f32 v72, v72
    v_exp_f32 v67, v67
    v_mfma_f32_16x16x32_bf16 v[68:71], a[216:219], a[148:151], v[68:71]
    buffer_load_dwordx4 v6, s[8:11], s21 offen lds
    v_exp_f32 v78, v78
    v_mfma_f32_16x16x32_bf16 v[68:71], a[220:223], a[152:155], v[68:71]
    v_cvt_pk_bf16_f32 v33, v78, v79
    v_exp_f32 v88, v88
    v_mfma_f32_16x16x32_bf16 v[76:79], a[220:223], a[176:179], 0
    v_fma_f32 v73, v73, s28, v11
    v_fma_f32 v90, v90, s28, v13
    v_mfma_f32_16x16x32_bf16 v[76:79], a[216:219], a[172:175], v[76:79]
    v_exp_f32 v66, v66
    v_mfma_f32_16x16x32_bf16 v[76:79], a[212:215], a[168:171], v[76:79]
    v_cvt_pk_bf16_f32 v23, v66, v67
    v_fma_f32 v83, v83, s28, v12
    v_mfma_f32_16x16x32_bf16 v[84:87], a[212:215], a[192:195], 0
    v_exp_f32 v82, v82
    v_mfma_f32_16x16x32_bf16 v[84:87], a[216:219], a[196:199], v[84:87]
    v_exp_f32 v75, v75
    v_mfma_f32_16x16x32_bf16 v[84:87], a[220:223], a[200:203], v[84:87]
    s_waitcnt lgkmcnt(0)
    v_exp_f32 v83, v83
    v_mfma_f32_16x16x32_bf16 v[84:87], a[224:227], a[204:207], v[84:87]
    v_exp_f32 v58, v58
    v_mfma_f32_16x16x32_bf16 v[84:87], a[228:231], a[208:211], v[84:87]
    s_add_u32 s21, s21, 128
    v_exp_f32 v80, v80
    v_mfma_f32_16x16x32_bf16 v[84:87], a[232:235], v[92:95], v[84:87]
    v_accvgpr_read_b32 v107, a3
    v_subrev_u32 v103, 28672, v103
    v_mfma_f32_16x16x32_bf16 v[76:79], a[232:235], a[188:191], v[76:79]
    v_cvt_pk_bf16_f32 v29, v74, v75
    v_exp_f32 v56, v56
    v_mfma_f32_16x16x32_bf16 v[76:79], a[228:231], a[184:187], v[76:79]
    v_cvt_pk_bf16_f32 v17, v58, v59
    v_accvgpr_read_b32 v106, a2
    v_mfma_f32_16x16x32_bf16 v[76:79], a[224:227], a[180:183], v[76:79]
    v_cvt_pk_bf16_f32 v34, v80, v81
    v_cvt_pk_bf16_f32 v216, v216, v217
    v_mfma_f32_16x16x32_bf16 v[68:71], a[224:227], a[156:159], v[68:71]
    v_exp_f32 v73, v73
    v_mfma_f32_16x16x32_bf16 v[68:71], a[228:231], a[160:163], v[68:71]
    ds_read_b128 a[216:219], v1 offset:18432
    v_fma_f32 v85, v85, s28, v13
    v_mfma_f32_16x16x32_bf16 v[68:71], a[232:235], a[164:167], v[68:71]
    v_fma_f32 v84, v84, s28, v13
    v_cvt_pk_bf16_f32 v16, v56, v57
    v_mfma_f32_16x16x32_bf16 v[60:63], a[232:235], a[140:143], v[60:63]
    s_add_u32 m0, s22, 37888
    ds_read_b128 a[220:223], v0 offset:19456
    v_fma_f32 v86, v86, s28, v13
    v_mfma_f32_16x16x32_bf16 v[60:63], a[228:231], a[136:139], v[60:63]
    ds_read_b128 a[212:215], v0 offset:18432
    v_cvt_pk_bf16_f32 v35, v82, v83
    v_mfma_f32_16x16x32_bf16 v[60:63], a[224:227], a[132:135], v[60:63]
    buffer_load_dwordx4 v6, s[8:11], s21 offen lds
    v_mfma_f32_16x16x32_bf16 v[52:55], a[224:227], a[108:111], v[52:55]
    ds_read_b128 a[224:227], v1 offset:19456
    v_fma_f32 v76, v76, s28, v12
    v_mfma_f32_16x16x32_bf16 v[52:55], a[228:231], a[112:115], v[52:55]
    ds_read_b128 a[228:231], v0 offset:20480
    v_exp_f32 v90, v90
    v_exp_f32 v76, v76
    v_pk_mul_f32 v[164:165], v[164:165], v[102:103] op_sel_hi:[1,0]
    v_pk_mul_f32 v[166:167], v[166:167], v[102:103] op_sel_hi:[1,0]
    v_pk_mul_f32 v[120:121], v[120:121], v[48:49] op_sel_hi:[1,0]
    v_pk_mul_f32 v[160:161], v[160:161], v[102:103] op_sel_hi:[1,0]
    v_pk_mul_f32 v[214:215], v[214:215], v[50:51] op_sel_hi:[1,0]
    v_pk_mul_f32 v[162:163], v[162:163], v[102:103] op_sel_hi:[1,0]
    v_pk_mul_f32 v[110:111], v[110:111], v[100:101] op_sel_hi:[1,0]
    v_pk_mul_f32 v[152:153], v[152:153], v[48:49] op_sel_hi:[1,0]
    v_pk_mul_f32 v[122:123], v[122:123], v[48:49] op_sel_hi:[1,0]
    v_pk_mul_f32 v[128:129], v[128:129], v[48:49] op_sel_hi:[1,0]
    v_pk_mul_f32 v[148:149], v[148:149], v[48:49] op_sel_hi:[1,0]
    v_pk_mul_f32 v[106:107], v[106:107], v[8:9] op_sel_hi:[1,0]
    v_pk_mul_f32 v[114:115], v[114:115], v[48:49] op_sel_hi:[1,0]
    v_fma_f32 v77, v77, s28, v12
    v_pk_mul_f32 v[108:109], v[108:109], v[100:101] op_sel_hi:[1,0]
    v_fma_f32 v71, v71, s28, v11
    v_pk_mul_f32 v[118:119], v[118:119], v[48:49] op_sel_hi:[1,0]
    v_fma_f32 v89, v89, s28, v13
    v_pk_mul_f32 v[116:117], v[116:117], v[48:49] op_sel_hi:[1,0]
    v_pk_mul_f32 v[174:175], v[174:175], v[102:103] op_sel_hi:[1,0]
    v_pk_mul_f32 v[228:229], v[228:229], v[50:51] op_sel_hi:[1,0]
    v_pk_mul_f32 v[208:209], v[208:209], v[50:51] op_sel_hi:[1,0]
    v_pk_mul_f32 v[112:113], v[112:113], v[48:49] op_sel_hi:[1,0]
    v_pk_mul_f32 v[104:105], v[104:105], v[8:9] op_sel_hi:[1,0]
    v_pk_mul_f32 v[168:169], v[168:169], v[102:103] op_sel_hi:[1,0]
    v_cvt_pk_bf16_f32 v104, v104, v105
    v_fma_f32 v60, v60, s28, v10
    v_mfma_f32_16x16x32_bf16 v[52:55], a[232:235], a[116:119], v[52:55]
    s_waitcnt lgkmcnt(2)
    v_exp_f32 v71, v71
    v_mfma_f32_16x16x32_bf16 v[56:59], a[212:215], a[96:99], 0
    s_add_u32 s21, s21, 128
    v_fma_f32 v78, v78, s28, v12
    v_fma_f32 v87, v87, s28, v13
    v_mfma_f32_16x16x32_bf16 v[56:59], a[216:219], a[100:103], v[56:59]
    ds_read_b128 a[232:235], v1 offset:20480
    v_cvt_pk_bf16_f32 v41, v90, v91
    v_mfma_f32_16x16x32_bf16 v[56:59], a[220:223], a[104:107], v[56:59]
    s_add_u32 m0, s22, 38912
    v_cvt_pk_bf16_f32 v160, v160, v161
    v_cvt_pk_bf16_f32 v108, v108, v109
    v_mfma_f32_16x16x32_bf16 v[64:67], a[220:223], a[128:131], 0
    v_exp_f32 v89, v89
    v_mfma_f32_16x16x32_bf16 v[44:47], a[236:239], v[14:17], 0
    v_cvt_pk_bf16_f32 v105, v106, v107
    v_cvt_pk_bf16_f32 v112, v112, v113
    v_mfma_f32_16x16x32_bf16 v[64:67], a[216:219], a[124:127], v[64:67]
    v_cvt_pk_bf16_f32 v164, v164, v165
    v_cvt_pk_bf16_f32 v40, v88, v89
    v_mfma_f32_16x16x32_bf16 v[64:67], a[212:215], a[120:123], v[64:67]
    v_cvt_pk_bf16_f32 v28, v72, v73
    v_exp_f32 v78, v78
    v_mfma_f32_16x16x32_bf16 v[72:75], a[212:215], a[144:147], 0
    v_exp_f32 v60, v60
    v_exp_f32 v87, v87
    v_mfma_f32_16x16x32_bf16 v[72:75], a[216:219], a[148:151], v[72:75]
    buffer_load_dwordx4 v6, s[8:11], s21 offen lds
    v_cvt_pk_bf16_f32 v120, v120, v121
    v_mfma_f32_16x16x32_bf16 v[72:75], a[220:223], a[152:155], v[72:75]
    s_add_u32 s21, s21, 12032
    v_fma_f32 v54, v54, s28, v9
    v_accvgpr_read_b32 v107, a7
    v_mfma_f32_16x16x32_bf16 v[80:83], a[220:223], a[176:179], 0
    s_waitcnt vmcnt(6) lgkmcnt(0)
    v_cvt_pk_bf16_f32 v113, v114, v115
    v_cvt_pk_bf16_f32 v208, v208, v209
    v_mfma_f32_16x16x32_bf16 v[80:83], a[216:219], a[172:175], v[80:83]
    s_barrier
    v_mfma_f32_16x16x32_bf16 v[44:47], a[240:243], v[20:23], v[44:47]
    s_add_u32 m0, s22, 12288
    v_cvt_pk_bf16_f32 v109, v110, v111
    v_fma_f32 v53, v53, s28, v9
    v_mfma_f32_16x16x32_bf16 v[80:83], a[212:215], a[168:171], v[80:83]
    v_cvt_pk_bf16_f32 v116, v116, v117
    v_fma_f32 v69, v69, s28, v11
    v_mfma_f32_16x16x32_bf16 v[88:91], a[212:215], a[192:195], 0
    v_cvt_pk_bf16_f32 v168, v168, v169
    v_accvgpr_read_b32 v106, a6
    v_mfma_f32_16x16x32_bf16 v[88:91], a[216:219], a[196:199], v[88:91]
    v_cvt_pk_bf16_f32 v152, v152, v153
    v_cvt_pk_bf16_f32 v165, v166, v167
    v_mfma_f32_16x16x32_bf16 v[88:91], a[220:223], a[200:203], v[88:91]
    ds_read_b64_tr_b16 a[212:213], v2 offset:0
    v_cvt_pk_bf16_f32 v117, v118, v119
    v_fma_f32 v52, v52, s28, v9
    v_mfma_f32_16x16x32_bf16 v[88:91], a[224:227], a[204:207], v[88:91]
    ds_read_b64_tr_b16 a[214:215], v2 offset:6144
    v_cvt_pk_bf16_f32 v161, v162, v163
    v_fma_f32 v68, v68, s28, v11
    v_mfma_f32_16x16x32_bf16 v[88:91], a[228:231], a[208:211], v[88:91]
    v_exp_f32 v69, v69
    v_mfma_f32_16x16x32_bf16 v[88:91], a[232:235], v[92:95], v[88:91]
    ds_write2st64_b64 v101, v[112:113], v[160:161] offset0:0 offset1:12
    v_pk_mul_f32 v[210:211], v[210:211], v[50:51] op_sel_hi:[1,0]
    v_pk_mul_f32 v[212:213], v[212:213], v[50:51] op_sel_hi:[1,0]
    v_pk_mul_f32 v[220:221], v[220:221], v[50:51] op_sel_hi:[1,0]
    v_pk_mul_f32 v[124:125], v[124:125], v[48:49] op_sel_hi:[1,0]
    v_pk_mul_f32 v[236:237], v[236:237], v[50:51] op_sel_hi:[1,0]
    v_cvt_pk_bf16_f32 v212, v212, v213
    v_fma_f32 v55, v55, s28, v9
    v_pk_mul_f32 v[224:225], v[224:225], v[50:51] op_sel_hi:[1,0]
    v_exp_f32 v85, v85
    v_pk_mul_f32 v[106:107], v[106:107], v[8:9] op_sel_hi:[1,0]
    v_pk_mul_f32 v[150:151], v[150:151], v[48:49] op_sel_hi:[1,0]
    v_pk_mul_f32 v[192:193], v[192:193], v[102:103] op_sel_hi:[1,0]
    v_pk_mul_f32 v[170:171], v[170:171], v[102:103] op_sel_hi:[1,0]
    v_cvt_pk_bf16_f32 v209, v210, v211
    v_cvt_pk_bf16_f32 v220, v220, v221
    v_pk_mul_f32 v[138:139], v[138:139], v[48:49] op_sel_hi:[1,0]
    v_pk_mul_f32 v[172:173], v[172:173], v[102:103] op_sel_hi:[1,0]
    v_cvt_pk_bf16_f32 v128, v128, v129
    v_fma_f32 v79, v79, s28, v12
    v_mfma_f32_16x16x32_bf16 v[80:83], a[232:235], a[188:191], v[80:83]
    v_fma_f32 v70, v70, s28, v11
    v_fma_f32 v62, v62, s28, v10
    v_mfma_f32_16x16x32_bf16 v[80:83], a[228:231], a[184:187], v[80:83]
    v_exp_f32 v68, v68
    v_mfma_f32_16x16x32_bf16 v[80:83], a[224:227], a[180:183], v[80:83]
    buffer_load_dwordx4 v6, s[4:7], s20 offen lds
    v_mfma_f32_16x16x32_bf16 v[72:75], a[224:227], a[156:159], v[72:75]
    ds_write2st64_b64 v101, v[208:209], v[104:105] offset0:24 offset1:36
    v_accvgpr_read_b32 v110, a54
    v_mfma_f32_16x16x32_bf16 v[72:75], a[228:231], a[160:163], v[72:75]
    v_cvt_pk_bf16_f32 v30, v68, v69
    v_fma_f32 v63, v63, s28, v10
    v_mfma_f32_16x16x32_bf16 v[72:75], a[232:235], a[164:167], v[72:75]
    ds_read_b64_tr_b16 a[216:217], v3 offset:0
    v_accvgpr_read_b32 v104, a4
    v_mfma_f32_16x16x32_bf16 v[64:67], a[232:235], a[140:143], v[64:67]
    v_exp_f32 v77, v77
    v_mfma_f32_16x16x32_bf16 v[44:47], a[244:247], v[26:29], v[44:47]
    v_fma_f32 v61, v61, s28, v10
    v_cvt_pk_bf16_f32 v224, v224, v225
    v_mfma_f32_16x16x32_bf16 v[64:67], a[228:231], a[136:139], v[64:67]
    ds_read_b64_tr_b16 a[218:219], v3 offset:6144
    v_cvt_pk_bf16_f32 v148, v148, v149
    v_mfma_f32_16x16x32_bf16 v[64:67], a[224:227], a[132:135], v[64:67]
    ds_read_b64_tr_b16 a[220:221], v4 offset:0
    v_fma_f32 v90, v90, s28, v13
    v_exp_f32 v79, v79
    v_mfma_f32_16x16x32_bf16 v[44:47], a[248:251], v[32:35], v[44:47]
    ds_write_b64 v101, v[108:109] offset:24576
    v_mfma_f32_16x16x32_bf16 v[56:59], a[224:227], a[108:111], v[56:59]
    ds_read_b64_tr_b16 a[222:223], v4 offset:6144
    v_accvgpr_read_b32 v111, a55
    v_mfma_f32_16x16x32_bf16 v[56:59], a[228:231], a[112:115], v[56:59]
    v_accvgpr_read_b32 v109, a53
    v_accvgpr_read_b32 v108, a52
    v_cvt_pk_bf16_f32 v228, v228, v229
    v_exp_f32 v61, v61
    v_pk_mul_f32 v[110:111], v[110:111], v[100:101] op_sel_hi:[1,0]
    v_cvt_pk_bf16_f32 v169, v170, v171
    v_accvgpr_read_b32 v105, a5
    v_fma_f32 v80, v80, s28, v12
    v_pk_mul_f32 v[108:109], v[108:109], v[100:101] op_sel_hi:[1,0]
    v_pk_mul_f32 v[176:177], v[176:177], v[102:103] op_sel_hi:[1,0]
    v_pk_mul_f32 v[254:255], v[254:255], v[50:51] op_sel_hi:[1,0]
    v_pk_mul_f32 v[130:131], v[130:131], v[48:49] op_sel_hi:[1,0]
    v_cvt_pk_bf16_f32 v108, v108, v109
    v_pk_mul_f32 v[240:241], v[240:241], v[50:51] op_sel_hi:[1,0]
    v_pk_mul_f32 v[180:181], v[180:181], v[102:103] op_sel_hi:[1,0]
    v_pk_mul_f32 v[198:199], v[198:199], v[102:103] op_sel_hi:[1,0]
    v_cvt_pk_bf16_f32 v109, v110, v111
    v_pk_mul_f32 v[104:105], v[104:105], v[8:9] op_sel_hi:[1,0]
    v_xor_b32 v101, 32, v101
    v_pk_mul_f32 v[196:197], v[196:197], v[102:103] op_sel_hi:[1,0]
    v_fma_f32 v82, v82, s28, v12
    v_pk_mul_f32 v[136:137], v[136:137], v[48:49] op_sel_hi:[1,0]
    v_pk_mul_f32 v[242:243], v[242:243], v[50:51] op_sel_hi:[1,0]
    v_pk_mul_f32 v[218:219], v[218:219], v[50:51] op_sel_hi:[1,0]
    v_cvt_pk_bf16_f32 v104, v104, v105
    v_pk_mul_f32 v[222:223], v[222:223], v[50:51] op_sel_hi:[1,0]
    v_pk_mul_f32 v[182:183], v[182:183], v[102:103] op_sel_hi:[1,0]
    v_fma_f32 v65, v65, s28, v10
    v_accvgpr_read_b32 v111, a59
    v_cvt_pk_bf16_f32 v172, v172, v173
    v_cvt_pk_bf16_f32 v192, v192, v193
    v_mfma_f32_16x16x32_bf16 v[56:59], a[232:235], a[116:119], v[56:59]
    s_waitcnt lgkmcnt(1)
    ds_read_b64_tr_b16 a[232:233], v3 offset:1024
    v_cvt_pk_bf16_f32 v105, v106, v107
    v_mfma_f32_16x16x32_bf16 v[112:115], a[212:215], v[14:17], 0
    s_add_u32 s20, s20, 128
    ds_write2st64_b64 v101, v[116:117], v[164:165] offset0:0 offset1:12
    v_pk_mul_f32 v[252:253], v[252:253], v[50:51] op_sel_hi:[1,0]
    v_pk_mul_f32 v[126:127], v[126:127], v[48:49] op_sel_hi:[1,0]
    v_cvt_pk_bf16_f32 v213, v214, v215
    v_cvt_pk_bf16_f32 v180, v180, v181
    v_mfma_f32_16x16x32_bf16 v[116:119], a[216:219], v[14:17], 0
    ds_write2st64_b64 v101, v[212:213], v[104:105] offset0:24 offset1:36
    v_pk_mul_f32 v[132:133], v[132:133], v[48:49] op_sel_hi:[1,0]
    v_fma_f32 v89, v89, s28, v13
    v_accvgpr_read_b32 v107, a11
    v_fma_f32 v83, v83, s28, v12
    v_fma_f32 v73, v73, s28, v11
    v_mfma_f32_16x16x32_bf16 v[164:167], a[216:219], v[20:23], 0
    ds_read_b64_tr_b16 a[224:225], v5 offset:0
    v_accvgpr_read_b32 v110, a58
    v_cvt_pk_bf16_f32 v129, v130, v131
    v_mfma_f32_16x16x32_bf16 v[160:163], a[212:215], v[20:23], 0
    ds_write_b64 v101, v[108:109] offset:24576
    v_exp_f32 v90, v90
    v_cvt_pk_bf16_f32 v252, v252, v253
    v_pk_mul_f32 v[232:233], v[232:233], v[50:51] op_sel_hi:[1,0]
    v_cvt_pk_bf16_f32 v217, v218, v219
    v_cvt_pk_bf16_f32 v196, v196, v197
    v_xor_b32 v101, 96, v101
    v_pk_mul_f32 v[204:205], v[204:205], v[102:103] op_sel_hi:[1,0]
    v_cvt_pk_bf16_f32 v236, v236, v237
    v_pk_mul_f32 v[184:185], v[184:185], v[102:103] op_sel_hi:[1,0]
    v_cvt_pk_bf16_f32 v124, v124, v125
    v_accvgpr_read_b32 v106, a10
    v_mfma_f32_16x16x32_bf16 v[208:211], a[212:215], v[26:29], 0
    ds_read_b64_tr_b16 a[230:231], v2 offset:7168
    v_accvgpr_read_b32 v109, a57
    v_accvgpr_read_b32 v108, a56
    v_accvgpr_read_b32 v105, a9
    v_cvt_pk_bf16_f32 v121, v122, v123
    v_pk_mul_f32 v[110:111], v[110:111], v[100:101] op_sel_hi:[1,0]
    v_pk_mul_f32 v[108:109], v[108:109], v[100:101] op_sel_hi:[1,0]
    v_cvt_pk_bf16_f32 v221, v222, v223
    v_fma_f32 v57, v57, s28, v9
    v_pk_mul_f32 v[140:141], v[140:141], v[48:49] op_sel_hi:[1,0]
    v_cvt_pk_bf16_f32 v184, v184, v185
    v_accvgpr_read_b32 v104, a8
    v_pk_mul_f32 v[226:227], v[226:227], v[50:51] op_sel_hi:[1,0]
    v_pk_mul_f32 v[200:201], v[200:201], v[102:103] op_sel_hi:[1,0]
    v_pk_mul_f32 v[146:147], v[146:147], v[48:49] op_sel_hi:[1,0]
    v_pk_mul_f32 v[106:107], v[106:107], v[8:9] op_sel_hi:[1,0]
    v_pk_mul_f32 v[230:231], v[230:231], v[50:51] op_sel_hi:[1,0]
    v_cvt_pk_bf16_f32 v232, v232, v233
    v_pk_mul_f32 v[104:105], v[104:105], v[8:9] op_sel_hi:[1,0]
    v_fma_f32 v81, v81, s28, v12
    v_cvt_pk_bf16_f32 v108, v108, v109
    v_pk_mul_f32 v[142:143], v[142:143], v[48:49] op_sel_hi:[1,0]
    v_cvt_pk_bf16_f32 v104, v104, v105
    v_exp_f32 v53, v53
    v_cvt_pk_bf16_f32 v225, v226, v227
    v_mfma_f32_16x16x32_bf16 v[212:215], a[216:219], v[26:29], 0
    s_add_u32 m0, s22, 13312
    v_cvt_pk_bf16_f32 v176, v176, v177
    v_cvt_pk_bf16_f32 v105, v106, v107
    v_mfma_f32_16x16x32_bf16 a[4:7], a[216:219], v[32:35], 0
    ds_read_b64_tr_b16 a[228:229], v2 offset:1024
    v_cvt_pk_bf16_f32 v125, v126, v127
    v_cvt_pk_bf16_f32 v173, v174, v175
    v_mfma_f32_16x16x32_bf16 a[0:3], a[212:215], v[32:35], 0
    ds_write2st64_b64 v101, v[120:121], v[168:169] offset0:0 offset1:12
    v_mfma_f32_16x16x32_bf16 a[48:51], a[212:215], v[38:41], 0
    ds_read_b64_tr_b16 a[234:235], v3 offset:7168
    v_cvt_pk_bf16_f32 v109, v110, v111
    v_mfma_f32_16x16x32_bf16 v[44:47], a[252:255], v[38:41], v[44:47]
    ds_write2st64_b64 v101, v[216:217], v[104:105] offset0:24 offset1:36
    v_mfma_f32_16x16x32_bf16 a[52:55], a[216:219], v[38:41], 0
    s_waitcnt lgkmcnt(4)
    ds_read_b64_tr_b16 a[226:227], v5 offset:6144
    v_accvgpr_read_b32 v104, a12
    v_accvgpr_read_b32 v111, a63
    v_mfma_f32_16x16x32_bf16 a[56:59], a[220:223], v[38:41], 0
    buffer_load_dwordx4 v6, s[4:7], s20 offen lds
    ds_write_b64 v101, v[108:109] offset:24576
    v_accvgpr_read_b32 v105, a13
    v_pk_mul_f32 v[144:145], v[144:145], v[48:49] op_sel_hi:[1,0]
    v_accvgpr_read_b32 v108, a60
    v_pk_mul_f32 v[104:105], v[104:105], v[8:9] op_sel_hi:[1,0]
    v_pk_mul_f32 v[178:179], v[178:179], v[102:103] op_sel_hi:[1,0]
    v_exp_f32 v70, v70
    v_exp_f32 v52, v52
    v_accvgpr_read_b32 v107, a15
    v_accvgpr_read_b32 v109, a61
    v_pk_mul_f32 v[134:135], v[134:135], v[48:49] op_sel_hi:[1,0]
    v_pk_mul_f32 v[158:159], v[158:159], v[48:49] op_sel_hi:[1,0]
    v_xor_b32 v101, 32, v101
    v_cvt_pk_bf16_f32 v177, v178, v179
    v_pk_mul_f32 v[244:245], v[244:245], v[50:51] op_sel_hi:[1,0]
    v_cvt_pk_bf16_f32 v104, v104, v105
    v_cvt_pk_bf16_f32 v132, v132, v133
    v_accvgpr_read_b32 v110, a62
    v_exp_f32 v84, v84
    v_accvgpr_read_b32 v106, a14
    v_cvt_pk_bf16_f32 v136, v136, v137
    v_cvt_pk_bf16_f32 v240, v240, v241
    v_pk_mul_f32 v[108:109], v[108:109], v[100:101] op_sel_hi:[1,0]
    v_pk_mul_f32 v[106:107], v[106:107], v[8:9] op_sel_hi:[1,0]
    v_fma_f32 v66, v66, s28, v10
    v_cvt_pk_bf16_f32 v105, v106, v107
    v_cvt_pk_bf16_f32 v181, v182, v183
    s_waitcnt lgkmcnt(1)
    v_mfma_f32_16x16x32_bf16 a[60:63], a[224:227], v[38:41], 0
    ds_write2st64_b64 v101, v[124:125], v[172:173] offset0:0 offset1:12
    v_cvt_pk_bf16_f32 v108, v108, v109
    v_mfma_f32_16x16x32_bf16 a[12:15], a[224:227], v[32:35], 0
    s_add_u32 s20, s20, 128
    ds_write2st64_b64 v101, v[220:221], v[104:105] offset0:24 offset1:36
    v_fma_f32 v72, v72, s28, v11
    v_pk_mul_f32 v[186:187], v[186:187], v[102:103] op_sel_hi:[1,0]
    v_accvgpr_read_b32 v105, a17
    v_accvgpr_read_b32 v106, a18
    v_pk_mul_f32 v[110:111], v[110:111], v[100:101] op_sel_hi:[1,0]
    v_fma_f32 v88, v88, s28, v13
    v_accvgpr_read_b32 v107, a19
    v_exp_f32 v62, v62
    v_cvt_pk_bf16_f32 v109, v110, v111
    v_mfma_f32_16x16x32_bf16 a[8:11], a[220:223], v[32:35], 0
    ds_write_b64 v101, v[108:109] offset:24576
    v_accvgpr_read_b32 v110, a66
    v_accvgpr_read_b32 v104, a16
    v_cvt_pk_bf16_f32 v140, v140, v141
    v_pk_mul_f32 v[104:105], v[104:105], v[8:9] op_sel_hi:[1,0]
    v_accvgpr_read_b32 v111, a67
    v_accvgpr_read_b32 v109, a65
    v_pk_mul_f32 v[190:191], v[190:191], v[102:103] op_sel_hi:[1,0]
    v_fma_f32 v64, v64, s28, v10
    v_accvgpr_read_b32 v108, a64
    v_cvt_pk_bf16_f32 v133, v134, v135
    v_pk_mul_f32 v[110:111], v[110:111], v[100:101] op_sel_hi:[1,0]
    v_pk_mul_f32 v[154:155], v[154:155], v[48:49] op_sel_hi:[1,0]
    v_pk_mul_f32 v[106:107], v[106:107], v[8:9] op_sel_hi:[1,0]
    v_pk_mul_f32 v[108:109], v[108:109], v[100:101] op_sel_hi:[1,0]
    v_pk_mul_f32 v[234:235], v[234:235], v[50:51] op_sel_hi:[1,0]
    v_cvt_pk_bf16_f32 v229, v230, v231
    v_pk_mul_f32 v[248:249], v[248:249], v[50:51] op_sel_hi:[1,0]
    v_cvt_pk_bf16_f32 v108, v108, v109
    v_cvt_pk_bf16_f32 v104, v104, v105
    v_xor_b32 v101, 96, v101
    v_mfma_f32_16x16x32_bf16 v[216:219], a[220:223], v[26:29], 0
    ds_read_b128 v[96:99], v103 offset:0
    v_fma_f32 v59, v59, s28, v9
    v_cvt_pk_bf16_f32 v137, v138, v139
    v_mfma_f32_16x16x32_bf16 v[220:223], a[224:227], v[26:29], 0
    ds_read_b64_tr_b16 a[218:219], v5 offset:7168
    ds_read_b64_tr_b16 a[216:217], v5 offset:1024
    v_cvt_pk_bf16_f32 v105, v106, v107
    v_mfma_f32_16x16x32_bf16 v[172:175], a[224:227], v[20:23], 0
    ds_write2st64_b64 v101, v[128:129], v[176:177] offset0:4 offset1:16
    v_mfma_f32_16x16x32_bf16 v[168:171], a[220:223], v[20:23], 0
    ds_write2st64_b64 v101, v[224:225], v[104:105] offset0:28 offset1:40
    v_cvt_pk_bf16_f32 v109, v110, v111
    v_mfma_f32_16x16x32_bf16 v[120:123], a[220:223], v[14:17], 0
    ds_write_b64 v101, v[108:109] offset:26624
    v_accvgpr_read_b32 v111, a71
    v_mfma_f32_16x16x32_bf16 v[124:127], a[224:227], v[14:17], 0
    s_add_u32 m0, s22, 14336
    ds_read_b64_tr_b16 a[214:215], v4 offset:7168
    v_accvgpr_read_b32 v107, a23
    v_xor_b32 v101, 32, v101
    v_accvgpr_read_b32 v104, a20
    v_mfma_f32_16x16x32_bf16 v[128:131], a[228:231], v[14:17], 0
    ds_write2st64_b64 v101, v[132:133], v[180:181] offset0:4 offset1:16
    v_accvgpr_read_b32 v105, a21
    v_mfma_f32_16x16x32_bf16 v[132:135], a[232:235], v[14:17], 0
    ds_read_b64_tr_b16 a[212:213], v4 offset:1024
    v_accvgpr_read_b32 v109, a69
    v_accvgpr_read_b32 v106, a22
    v_accvgpr_read_b32 v108, a68
    v_mfma_f32_16x16x32_bf16 v[180:183], a[232:235], v[20:23], 0
    ds_read_b64_tr_b16 a[222:223], v2 offset:8192
    buffer_load_dwordx4 v6, s[4:7], s20 offen lds
    ds_read_b64_tr_b16 a[224:225], v3 offset:2048
    v_cvt_pk_bf16_f32 v18, v52, v53
    v_pk_mul_f32 v[106:107], v[106:107], v[8:9] op_sel_hi:[1,0]
    v_pk_mul_f32 v[104:105], v[104:105], v[8:9] op_sel_hi:[1,0]
    v_pk_mul_f32 v[108:109], v[108:109], v[100:101] op_sel_hi:[1,0]
    v_cvt_pk_bf16_f32 v31, v70, v71
    v_cvt_pk_bf16_f32 v241, v242, v243
    v_cvt_pk_bf16_f32 v233, v234, v235
    v_exp_f32 v63, v63
    v_pk_mul_f32 v[188:189], v[188:189], v[102:103] op_sel_hi:[1,0]
    v_cvt_pk_bf16_f32 v104, v104, v105
    v_cvt_pk_bf16_f32 v108, v108, v109
    v_exp_f32 v73, v73
    v_cvt_pk_bf16_f32 v105, v106, v107
    v_mfma_f32_16x16x32_bf16 v[176:179], a[228:231], v[20:23], 0
    ds_write2st64_b64 v101, v[228:229], v[104:105] offset0:28 offset1:40
    v_accvgpr_read_b32 v110, a70
    v_pk_mul_f32 v[110:111], v[110:111], v[100:101] op_sel_hi:[1,0]
    v_pk_mul_f32 v[194:195], v[194:195], v[102:103] op_sel_hi:[1,0]
    v_accvgpr_read_b32 v107, a27
    v_pk_mul_f32 v[238:239], v[238:239], v[50:51] op_sel_hi:[1,0]
    v_accvgpr_read_b32 v105, a25
    v_cvt_pk_bf16_f32 v185, v186, v187
    v_cvt_pk_bf16_f32 v193, v194, v195
    v_pk_mul_f32 v[246:247], v[246:247], v[50:51] op_sel_hi:[1,0]
    v_cvt_pk_bf16_f32 v109, v110, v111
    v_accvgpr_read_b32 v104, a24
    v_mfma_f32_16x16x32_bf16 v[224:227], a[228:231], v[26:29], 0
    s_add_u32 s20, s20, 12032
    ds_read_b64_tr_b16 a[226:227], v3 offset:8192
    v_accvgpr_read_b32 v106, a26
    v_mfma_f32_16x16x32_bf16 v[228:231], a[232:235], v[26:29], 0
    s_waitcnt lgkmcnt(2)
    buffer_store_dwordx4 v[96:99], v6, s[16:19], s67 offen offset:0 nt
    ds_write_b64 v101, v[108:109] offset:26624
    v_pk_mul_f32 v[156:157], v[156:157], v[48:49] op_sel_hi:[1,0]
    v_xor_b32 v101, 96, v101
    v_pk_mul_f32 v[206:207], v[206:207], v[102:103] op_sel_hi:[1,0]
    v_pk_mul_f32 v[106:107], v[106:107], v[8:9] op_sel_hi:[1,0]
    v_pk_mul_f32 v[250:251], v[250:251], v[50:51] op_sel_hi:[1,0]
    v_accvgpr_read_b32 v110, a74
    v_accvgpr_read_b32 v109, a73
    v_pk_mul_f32 v[104:105], v[104:105], v[8:9] op_sel_hi:[1,0]
    v_accvgpr_read_b32 v108, a72
    v_pk_mul_f32 v[108:109], v[108:109], v[100:101] op_sel_hi:[1,0]
    v_cvt_pk_bf16_f32 v248, v248, v249
    v_cvt_pk_bf16_f32 v108, v108, v109
    v_accvgpr_read_b32 v111, a75
    v_cvt_pk_bf16_f32 v144, v144, v145
    v_mfma_f32_16x16x32_bf16 a[20:23], a[232:235], v[32:35], 0
    ds_read_b128 v[96:99], v103 offset:1024
    v_cvt_pk_bf16_f32 v141, v142, v143
    v_cvt_pk_bf16_f32 v104, v104, v105
    v_fma_f32 v74, v74, s28, v11
    v_cvt_pk_bf16_f32 v105, v106, v107
    v_cvt_pk_bf16_f32 v145, v146, v147
    v_mfma_f32_16x16x32_bf16 a[16:19], a[228:231], v[32:35], 0
    ds_write2st64_b64 v101, v[136:137], v[184:185] offset0:4 offset1:16
    v_exp_f32 v55, v55
    v_pk_mul_f32 v[110:111], v[110:111], v[100:101] op_sel_hi:[1,0]
    v_cvt_pk_bf16_f32 v188, v188, v189
    v_cvt_pk_bf16_f32 v109, v110, v111
    v_cvt_pk_bf16_f32 v149, v150, v151
    v_mfma_f32_16x16x32_bf16 a[64:67], a[228:231], v[38:41], 0
    ds_write2st64_b64 v101, v[232:233], v[104:105] offset0:28 offset1:40
    v_mfma_f32_16x16x32_bf16 a[68:71], a[232:235], v[38:41], 0
    ds_write_b64 v101, v[108:109] offset:26624
    v_accvgpr_read_b32 v110, a78
    v_exp_f32 v86, v86
    v_mfma_f32_16x16x32_bf16 a[72:75], a[212:215], v[38:41], 0
    ds_read_b64_tr_b16 a[220:221], v2 offset:2048
    v_accvgpr_read_b32 v109, a77
    v_accvgpr_read_b32 v106, a30
    v_accvgpr_read_b32 v105, a29
    v_xor_b32 v101, 32, v101
    v_pk_mul_f32 v[202:203], v[202:203], v[102:103] op_sel_hi:[1,0]
    v_cvt_pk_bf16_f32 v237, v238, v239
    v_accvgpr_read_b32 v107, a31
    v_accvgpr_read_b32 v104, a28
    v_accvgpr_read_b32 v111, a79
    v_pk_mul_f32 v[106:107], v[106:107], v[8:9] op_sel_hi:[1,0]
    v_cvt_pk_bf16_f32 v189, v190, v191
    v_accvgpr_read_b32 v108, a76
    v_mfma_f32_16x16x32_bf16 a[76:79], a[216:219], v[38:41], 0
    s_add_u32 s39, s39, 12288
    ds_read_b64_tr_b16 a[232:233], v5 offset:2048
    ds_read_b64_tr_b16 a[234:235], v5 offset:8192
    v_cvt_pk_bf16_f32 v156, v156, v157
    v_mfma_f32_16x16x32_bf16 a[28:31], a[216:219], v[32:35], 0
    ds_read_b64_tr_b16 a[228:229], v4 offset:2048
    ds_read_b64_tr_b16 a[230:231], v4 offset:8192
    v_mfma_f32_16x16x32_bf16 a[24:27], a[212:215], v[32:35], 0
    ds_write2st64_b64 v101, v[140:141], v[188:189] offset0:4 offset1:16
    v_pk_mul_f32 v[104:105], v[104:105], v[8:9] op_sel_hi:[1,0]
    v_pk_mul_f32 v[108:109], v[108:109], v[100:101] op_sel_hi:[1,0]
    v_pk_mul_f32 v[110:111], v[110:111], v[100:101] op_sel_hi:[1,0]
    v_cvt_pk_bf16_f32 v197, v198, v199
    v_cvt_pk_bf16_f32 v104, v104, v105
    v_cvt_pk_bf16_f32 v105, v106, v107
    v_cvt_pk_bf16_f32 v153, v154, v155
    v_cvt_pk_bf16_f32 v108, v108, v109
    v_cvt_pk_bf16_f32 v25, v62, v63
    v_mfma_f32_16x16x32_bf16 v[232:235], a[212:215], v[26:29], 0
    ds_write2st64_b64 v101, v[236:237], v[104:105] offset0:28 offset1:40
    v_cvt_pk_bf16_f32 v109, v110, v111
    v_accvgpr_read_b32 v105, a33
    v_mfma_f32_16x16x32_bf16 v[236:239], a[216:219], v[26:29], 0
    ds_write_b64 v101, v[108:109] offset:26624
    v_accvgpr_read_b32 v109, a81
    v_accvgpr_read_b32 v108, a80
    v_accvgpr_read_b32 v104, a32
    v_accvgpr_read_b32 v110, a82
    v_accvgpr_read_b32 v107, a35
    v_cvt_pk_bf16_f32 v244, v244, v245
    v_accvgpr_read_b32 v111, a83
    s_waitcnt vmcnt(7) lgkmcnt(3)
    v_accvgpr_read_b32 v106, a34
    v_pk_mul_f32 v[104:105], v[104:105], v[8:9] op_sel_hi:[1,0]
    v_xor_b32 v101, 96, v101
    v_pk_mul_f32 v[110:111], v[110:111], v[100:101] op_sel_hi:[1,0]
    v_cvt_pk_bf16_f32 v36, v76, v77
    v_pk_mul_f32 v[108:109], v[108:109], v[100:101] op_sel_hi:[1,0]
    v_pk_mul_f32 v[106:107], v[106:107], v[8:9] op_sel_hi:[1,0]
    v_fma_f32 v56, v56, s28, v9
    v_cvt_pk_bf16_f32 v108, v108, v109
    v_cvt_pk_bf16_f32 v104, v104, v105
    v_mfma_f32_16x16x32_bf16 v[188:191], a[216:219], v[20:23], 0
    buffer_store_dwordx4 v[96:99], v7, s[16:19], s67 offen offset:0 nt
    s_barrier
    ds_write2st64_b64 v101, v[144:145], v[192:193] offset0:8 offset1:20
    v_cvt_pk_bf16_f32 v204, v204, v205
    v_cvt_pk_bf16_f32 v105, v106, v107
    v_mfma_f32_16x16x32_bf16 v[184:187], a[212:215], v[20:23], 0
    s_add_u32 m0, s22, 24576
    ds_write2st64_b64 v101, v[240:241], v[104:105] offset0:32 offset1:44
    v_fma_f32 v75, v75, s28, v11
    v_cvt_pk_bf16_f32 v109, v110, v111
    v_mfma_f32_16x16x32_bf16 v[136:139], a[212:215], v[14:17], 0
    ds_write_b64 v101, v[108:109] offset:0
    v_cvt_pk_bf16_f32 v249, v250, v251
    v_accvgpr_read_b32 v108, a84
    v_mfma_f32_16x16x32_bf16 v[140:143], a[216:219], v[14:17], 0
    v_accvgpr_read_b32 v105, a37
    v_accvgpr_read_b32 v106, a38
    v_xor_b32 v101, 32, v101
    v_accvgpr_read_b32 v109, a85
    v_accvgpr_read_b32 v110, a86
    v_accvgpr_read_b32 v107, a39
    v_fma_f32 v58, v58, s28, v9
    v_accvgpr_read_b32 v104, a36
    v_pk_mul_f32 v[108:109], v[108:109], v[100:101] op_sel_hi:[1,0]
    v_accvgpr_read_b32 v111, a87
    v_pk_mul_f32 v[104:105], v[104:105], v[8:9] op_sel_hi:[1,0]
    v_pk_mul_f32 v[106:107], v[106:107], v[8:9] op_sel_hi:[1,0]
    v_cvt_pk_bf16_f32 v108, v108, v109
    v_cvt_pk_bf16_f32 v104, v104, v105
    v_cvt_pk_bf16_f32 v253, v254, v255
    v_pk_mul_f32 v[110:111], v[110:111], v[100:101] op_sel_hi:[1,0]
    v_cvt_pk_bf16_f32 v105, v106, v107
    v_cvt_pk_bf16_f32 v245, v246, v247
    v_cvt_pk_bf16_f32 v200, v200, v201
    v_mfma_f32_16x16x32_bf16 v[144:147], a[220:223], v[14:17], 0
    ds_write2st64_b64 v101, v[148:149], v[196:197] offset0:8 offset1:20
    v_mfma_f32_16x16x32_bf16 v[148:151], a[224:227], v[14:17], 0
    buffer_load_dwordx4 v6, s[8:11], s21 offen lds
    v_mfma_f32_16x16x32_bf16 v[196:199], a[224:227], v[20:23], 0
    ds_read_b128 a[216:219], v1 offset:0
    v_cvt_pk_bf16_f32 v109, v110, v111
    v_mfma_f32_16x16x32_bf16 v[192:195], a[220:223], v[20:23], 0
    ds_write2st64_b64 v101, v[244:245], v[104:105] offset0:32 offset1:44
    v_accvgpr_read_b32 v111, a91
    v_accvgpr_read_b32 v104, a40
    v_mfma_f32_16x16x32_bf16 v[240:243], a[220:223], v[26:29], 0
    ds_read_b128 v[96:99], v103 offset:2048
    v_cvt_pk_bf16_f32 v201, v202, v203
    v_accvgpr_read_b32 v107, a43
    v_mfma_f32_16x16x32_bf16 v[244:247], a[224:227], v[26:29], 0
    s_add_u32 s21, s21, 128
    ds_write_b64 v101, v[108:109] offset:0
    v_accvgpr_read_b32 v105, a41
    v_accvgpr_read_b32 v110, a90
    v_pk_mul_f32 v[110:111], v[110:111], v[100:101] op_sel_hi:[1,0]
    v_pk_mul_f32 v[104:105], v[104:105], v[8:9] op_sel_hi:[1,0]
    v_accvgpr_read_b32 v106, a42
    v_cvt_pk_bf16_f32 v104, v104, v105
    v_pk_mul_f32 v[106:107], v[106:107], v[8:9] op_sel_hi:[1,0]
    v_xor_b32 v101, 96, v101
    v_accvgpr_read_b32 v108, a88
    v_cvt_pk_bf16_f32 v105, v106, v107
    v_accvgpr_read_b32 v109, a89
    v_mfma_f32_16x16x32_bf16 a[36:39], a[224:227], v[32:35], 0
    s_add_u32 m0, s22, 25600
    ds_write2st64_b64 v101, v[152:153], v[200:201] offset0:8 offset1:20
    v_pk_mul_f32 v[108:109], v[108:109], v[100:101] op_sel_hi:[1,0]
    v_accvgpr_read_b32 v106, a46
    v_cvt_pk_bf16_f32 v108, v108, v109
    v_accvgpr_read_b32 v107, a47
    v_mfma_f32_16x16x32_bf16 a[32:35], a[220:223], v[32:35], 0
    ds_write2st64_b64 v101, v[248:249], v[104:105] offset0:32 offset1:44
    v_cvt_pk_bf16_f32 v109, v110, v111
    v_mfma_f32_16x16x32_bf16 a[80:83], a[220:223], v[38:41], 0
    ds_read_b128 a[212:215], v0 offset:0
    buffer_load_dwordx4 v6, s[8:11], s21 offen lds
    v_mfma_f32_16x16x32_bf16 a[84:87], a[224:227], v[38:41], 0
    s_add_u32 s21, s21, 128
    ds_write_b64 v101, v[108:109] offset:0
    v_accvgpr_read_b32 v111, a95
    v_accvgpr_read_b32 v108, a92
    v_pk_mul_f32 v[106:107], v[106:107], v[8:9] op_sel_hi:[1,0]
    v_cvt_pk_bf16_f32 v42, v84, v85
    v_accvgpr_read_b32 v109, a93
    v_mfma_f32_16x16x32_bf16 a[88:91], a[228:231], v[38:41], 0
    v_cvt_pk_bf16_f32 v24, v60, v61
    v_accvgpr_read_b32 v110, a94
    v_accvgpr_read_b32 v104, a44
    v_cvt_pk_bf16_f32 v205, v206, v207
    v_accvgpr_read_b32 v105, a45
    v_pk_mul_f32 v[104:105], v[104:105], v[8:9] op_sel_hi:[1,0]
    v_pk_mul_f32 v[108:109], v[108:109], v[100:101] op_sel_hi:[1,0]
    v_pk_mul_f32 v[110:111], v[110:111], v[100:101] op_sel_hi:[1,0]
    v_cvt_pk_bf16_f32 v104, v104, v105
    v_cvt_pk_bf16_f32 v105, v106, v107
    v_cvt_pk_bf16_f32 v157, v158, v159
    v_mfma_f32_16x16x32_bf16 a[92:95], a[232:235], v[38:41], 0
    ds_read_b128 a[220:223], v0 offset:1024
    v_cvt_pk_bf16_f32 v37, v78, v79
    v_mfma_f32_16x16x32_bf16 a[44:47], a[232:235], v[32:35], 0
    v_exp_f32 v57, v57
    v_xor_b32 v101, 32, v101
    v_mfma_f32_16x16x32_bf16 a[40:43], a[228:231], v[32:35], 0
    s_add_u32 m0, s22, 26624
    ds_write2st64_b64 v101, v[156:157], v[204:205] offset0:8 offset1:20
    v_mfma_f32_16x16x32_bf16 v[248:251], a[228:231], v[26:29], 0
    ds_write2st64_b64 v101, v[252:253], v[104:105] offset0:32 offset1:44
    v_mfma_f32_16x16x32_bf16 v[252:255], a[232:235], v[26:29], 0
    buffer_load_dwordx4 v6, s[8:11], s21 offen lds
    v_mfma_f32_16x16x32_bf16 v[204:207], a[232:235], v[20:23], 0
    s_add_u32 s21, s21, 12032
    v_exp_f32 v56, v56
    v_mfma_f32_16x16x32_bf16 v[200:203], a[228:231], v[20:23], 0
    s_add_u32 s56, s67, 128
    v_exp_f32 v54, v54
    v_mfma_f32_16x16x32_bf16 v[152:155], a[228:231], v[14:17], 0
    v_cvt_pk_bf16_f32 v19, v54, v55
    v_exp_f32 v58, v58
    v_mfma_f32_16x16x32_bf16 v[156:159], a[232:235], v[14:17], 0
    s_waitcnt lgkmcnt(2)
    ds_read_b128 a[224:227], v1 offset:1024
    v_cvt_pk_bf16_f32 v43, v86, v87
    v_mfma_f32_16x16x32_bf16 v[52:55], a[212:215], a[96:99], 0
    s_add_u32 s58, s33, 128
    v_exp_f32 v72, v72
    v_mfma_f32_16x16x32_bf16 v[52:55], a[216:219], a[100:103], v[52:55]
    s_add_u32 m0, s38, 2048
    ds_read_b128 a[228:231], v0 offset:2048
    buffer_load_dwordx4 v6, s[12:15], s58 offen nt lds
    v_mfma_f32_16x16x32_bf16 v[52:55], a[220:223], a[104:107], v[52:55]
    buffer_store_dwordx4 v[96:99], v6, s[16:19], s56 offen offset:0 nt
    s_nop 0
    ds_read_b128 v[96:99], v103 offset:3072
    v_fma_f32 v91, v91, s28, v13
    v_cvt_pk_bf16_f32 v16, v56, v57
    v_mfma_f32_16x16x32_bf16 v[60:63], a[220:223], a[128:131], 0
    ds_read_b128 a[232:235], v1 offset:2048
    v_fma_f32 v67, v67, s28, v10
    v_mfma_f32_16x16x32_bf16 v[60:63], a[216:219], a[124:127], v[60:63]
    v_exp_f32 v89, v89
    v_mfma_f32_16x16x32_bf16 v[60:63], a[212:215], a[120:123], v[60:63]
    v_exp_f32 v59, v59
    v_mfma_f32_16x16x32_bf16 v[68:71], a[212:215], a[144:147], 0
    s_add_u32 m0, s38, 3072
    v_exp_f32 v65, v65
    v_mfma_f32_16x16x32_bf16 v[68:71], a[216:219], a[148:151], v[68:71]
    v_exp_f32 v83, v83
    v_mfma_f32_16x16x32_bf16 v[68:71], a[220:223], a[152:155], v[68:71]
    v_exp_f32 v64, v64
    v_mfma_f32_16x16x32_bf16 v[76:79], a[220:223], a[176:179], 0
    v_cvt_pk_bf16_f32 v108, v108, v109
    v_mfma_f32_16x16x32_bf16 v[76:79], a[216:219], a[172:175], v[76:79]
    v_exp_f32 v75, v75
    v_mfma_f32_16x16x32_bf16 v[76:79], a[212:215], a[168:171], v[76:79]
    v_exp_f32 v74, v74
    v_mfma_f32_16x16x32_bf16 v[84:87], a[212:215], a[192:195], 0
    v_mfma_f32_16x16x32_bf16 v[84:87], a[216:219], a[196:199], v[84:87]
    v_exp_f32 v67, v67
    v_mfma_f32_16x16x32_bf16 v[84:87], a[220:223], a[200:203], v[84:87]
    s_waitcnt lgkmcnt(0)
    v_exp_f32 v91, v91
    v_mfma_f32_16x16x32_bf16 v[84:87], a[224:227], a[204:207], v[84:87]
    buffer_load_dwordx4 v7, s[12:15], s58 offen nt lds
    v_mfma_f32_16x16x32_bf16 v[84:87], a[228:231], a[208:211], v[84:87]
    v_cvt_pk_bf16_f32 v17, v58, v59
    v_cvt_pk_bf16_f32 v109, v110, v111
    v_mfma_f32_16x16x32_bf16 v[84:87], a[232:235], v[92:95], v[84:87]
    buffer_store_dwordx4 v[96:99], v7, s[16:19], s56 offen offset:0 nt
    ds_write_b64 v101, v[108:109] offset:0
    v_mfma_f32_16x16x32_bf16 v[76:79], a[232:235], a[188:191], v[76:79]
    v_cvt_pk_bf16_f32 v22, v64, v65
    v_cvt_pk_bf16_f32 v29, v74, v75
    v_mfma_f32_16x16x32_bf16 v[76:79], a[228:231], a[184:187], v[76:79]
    v_exp_f32 v80, v80
    v_mfma_f32_16x16x32_bf16 v[76:79], a[224:227], a[180:183], v[76:79]
    ds_read_b128 a[212:215], v0 offset:6144
    v_mfma_f32_16x16x32_bf16 v[48:51], a[236:239], v[16:19], v[44:47]
    ds_read_b128 a[216:219], v1 offset:6144
    v_cvt_pk_bf16_f32 v41, v90, v91
    v_mfma_f32_16x16x32_bf16 v[68:71], a[224:227], a[156:159], v[68:71]
    ds_read_b128 v[96:99], v103 offset:0
    v_cvt_pk_bf16_f32 v28, v72, v73
    v_mfma_f32_16x16x32_bf16 v[68:71], a[228:231], a[160:163], v[68:71]
    v_exp_f32 v88, v88
    v_mfma_f32_16x16x32_bf16 v[68:71], a[232:235], a[164:167], v[68:71]
    v_exp_f32 v66, v66
    v_mfma_f32_16x16x32_bf16 v[60:63], a[232:235], a[140:143], v[60:63]
    s_add_u32 s57, s67, 24832
    ds_read_b128 a[220:223], v0 offset:7168
    v_cvt_pk_bf16_f32 v23, v66, v67
    v_mfma_f32_16x16x32_bf16 v[60:63], a[228:231], a[136:139], v[60:63]
    v_exp_f32 v81, v81
    v_mfma_f32_16x16x32_bf16 v[48:51], a[240:243], v[22:25], v[48:51]
    s_add_u32 m0, s38, 0
    v_exp_f32 v82, v82
    v_mfma_f32_16x16x32_bf16 v[60:63], a[224:227], a[132:135], v[60:63]
    v_cvt_pk_bf16_f32 v35, v82, v83
    v_cvt_pk_bf16_f32 v34, v80, v81
    v_mfma_f32_16x16x32_bf16 v[52:55], a[224:227], a[108:111], v[52:55]
    v_mfma_f32_16x16x32_bf16 v[48:51], a[244:247], v[28:31], v[48:51]
    v_cvt_pk_bf16_f32 v40, v88, v89
    v_mfma_f32_16x16x32_bf16 v[48:51], a[248:251], v[34:37], v[48:51]
    ds_read_b128 a[224:227], v1 offset:7168
    v_mfma_f32_16x16x32_bf16 v[48:51], a[252:255], v[40:43], v[48:51]
    s_waitcnt lgkmcnt(2)
    buffer_load_dwordx4 v6, s[12:15], s33 offen nt lds
    v_mfma_f32_16x16x32_bf16 v[52:55], a[228:231], a[112:115], v[52:55]
    buffer_store_dwordx4 v[96:99], v6, s[16:19], s57 offen offset:0 nt
    s_nop 3
    v_cmp_lt_f32 vcc, s29, v48
    v_mfma_f32_16x16x32_bf16 v[52:55], a[232:235], a[116:119], v[52:55]
    ds_read_b128 a[232:235], v1 offset:8192
    v_mfma_f32_16x16x32_bf16 v[56:59], a[212:215], a[96:99], 0
    ds_read_b128 v[96:99], v103 offset:1024
    s_add_u32 m0, s38, 1024
    v_mfma_f32_16x16x32_bf16 v[56:59], a[216:219], a[100:103], v[56:59]
    s_cbranch_vccnz L_rs_tr55d
L_ret_tr55d:
    s_waitcnt lgkmcnt(3)
    v_mfma_f32_16x16x32_bf16 v[56:59], a[220:223], a[104:107], v[56:59]
    ds_read_b128 a[228:231], v0 offset:8192
    v_fma_f32 v62, v62, s28, v10
    v_mfma_f32_16x16x32_bf16 v[64:67], a[220:223], a[128:131], 0
    v_fma_f32 v55, v55, s28, v9
    v_fma_f32 v60, v60, s28, v10
    v_mfma_f32_16x16x32_bf16 v[64:67], a[216:219], a[124:127], v[64:67]
    v_fma_f32 v52, v52, s28, v9
    v_fma_f32 v54, v54, s28, v9
    v_mfma_f32_16x16x32_bf16 v[64:67], a[212:215], a[120:123], v[64:67]
    v_mfma_f32_16x16x32_bf16 v[72:75], a[212:215], a[144:147], 0
    v_exp_f32 v54, v54
    v_mfma_f32_16x16x32_bf16 v[72:75], a[216:219], a[148:151], v[72:75]
    v_exp_f32 v52, v52
    v_mfma_f32_16x16x32_bf16 v[72:75], a[220:223], a[152:155], v[72:75]
    v_exp_f32 v55, v55
    v_mfma_f32_16x16x32_bf16 v[80:83], a[220:223], a[176:179], 0
    v_fma_f32 v63, v63, s28, v10
    v_fma_f32 v53, v53, s28, v9
    v_mfma_f32_16x16x32_bf16 v[80:83], a[216:219], a[172:175], v[80:83]
    v_exp_f32 v60, v60
    v_mfma_f32_16x16x32_bf16 v[80:83], a[212:215], a[168:171], v[80:83]
    s_waitcnt lgkmcnt(1)
    buffer_load_dwordx4 v7, s[12:15], s33 offen nt lds
    v_mfma_f32_16x16x32_bf16 v[88:91], a[212:215], a[192:195], 0
    s_waitcnt vmcnt(15) lgkmcnt(0)
    v_exp_f32 v53, v53
    v_mfma_f32_16x16x32_bf16 v[88:91], a[216:219], a[196:199], v[88:91]
    s_barrier
    v_mfma_f32_16x16x32_bf16 v[88:91], a[220:223], a[200:203], v[88:91]
    s_add_u32 m0, s22, 0
    ds_read_b64_tr_b16 a[212:213], v2 offset:18432
    v_add_u32 v103, 4096, v103
    v_mfma_f32_16x16x32_bf16 v[88:91], a[224:227], a[204:207], v[88:91]
    ds_read_b64_tr_b16 a[214:215], v2 offset:12288
    v_fma_f32 v61, v61, s28, v10
    v_mfma_f32_16x16x32_bf16 v[88:91], a[228:231], a[208:211], v[88:91]
    buffer_load_dwordx4 v6, s[4:7], s20 offen lds
    v_mfma_f32_16x16x32_bf16 v[88:91], a[232:235], v[92:95], v[88:91]
    ds_read_b64_tr_b16 a[216:217], v3 offset:18432
    v_cvt_pk_bf16_f32 v14, v52, v53
    v_mfma_f32_16x16x32_bf16 v[80:83], a[232:235], a[188:191], v[80:83]
    s_add_u32 s20, s20, 128
    ds_read_b64_tr_b16 a[218:219], v3 offset:12288
    s_add_u32 m0, s22, 1024
    v_mfma_f32_16x16x32_bf16 v[80:83], a[228:231], a[184:187], v[80:83]
    v_exp_f32 v62, v62
    v_mfma_f32_16x16x32_bf16 v[80:83], a[224:227], a[180:183], v[80:83]
    buffer_load_dwordx4 v6, s[4:7], s20 offen lds
    v_mfma_f32_16x16x32_bf16 v[72:75], a[224:227], a[156:159], v[72:75]
    v_exp_f32 v63, v63
    v_mfma_f32_16x16x32_bf16 v[72:75], a[228:231], a[160:163], v[72:75]
    s_add_u32 s20, s20, 128
    v_exp_f32 v61, v61
    v_mfma_f32_16x16x32_bf16 v[72:75], a[232:235], a[164:167], v[72:75]
    ds_read_b64_tr_b16 a[220:221], v4 offset:18432
    s_add_u32 m0, s22, 2048
    v_mfma_f32_16x16x32_bf16 v[64:67], a[232:235], a[140:143], v[64:67]
    buffer_load_dwordx4 v6, s[4:7], s20 offen lds
    v_mfma_f32_16x16x32_bf16 v[64:67], a[228:231], a[136:139], v[64:67]
    ds_read_b64_tr_b16 a[222:223], v4 offset:12288
    v_cvt_pk_bf16_f32 v21, v62, v63
    v_mfma_f32_16x16x32_bf16 v[64:67], a[224:227], a[132:135], v[64:67]
    v_cvt_pk_bf16_f32 v15, v54, v55
    v_cvt_pk_bf16_f32 v20, v60, v61
    v_mfma_f32_16x16x32_bf16 v[56:59], a[224:227], a[108:111], v[56:59]
    ds_read_b64_tr_b16 a[224:225], v5 offset:18432
    s_add_u32 s20, s20, 12032
    v_mfma_f32_16x16x32_bf16 v[56:59], a[228:231], a[112:115], v[56:59]
    s_waitcnt lgkmcnt(3)
    s_bitcmp1_b32 s3, 1
    ds_read_b64_tr_b16 a[226:227], v5 offset:12288
    v_mfma_f32_16x16x32_bf16 v[56:59], a[232:235], a[116:119], v[56:59]
    buffer_store_dwordx4 v[96:99], v7, s[16:19], s57 offen offset:0 nt
    s_cbranch_scc1 L_loop5w1
    s_branch L_loop5w0
    .p2align 6
L_loop4w0:
    v_mfma_f32_16x16x32_bf16 v[112:115], a[212:215], v[16:19], v[112:115]
    v_fma_f32 v66, v66, s28, v10
    v_mfma_f32_16x16x32_bf16 v[160:163], a[212:215], v[22:25], v[160:163]
    ds_read_b64_tr_b16 a[228:229], v2 offset:19456
    v_fma_f32 v74, v74, s28, v11
    v_fma_f32 v68, v68, s28, v11
    v_mfma_f32_16x16x32_bf16 v[208:211], a[212:215], v[28:31], v[208:211]
    v_fma_f32 v58, v58, s28, v9
    v_mfma_f32_16x16x32_bf16 a[0:3], a[212:215], v[34:37], a[0:3]
    v_fma_f32 v63, v63, s28, v10
    s_waitcnt lgkmcnt(5)
    v_mfma_f32_16x16x32_bf16 a[4:7], a[216:219], v[34:37], a[4:7]
    ds_read_b64_tr_b16 a[230:231], v2 offset:13312
    v_mfma_f32_16x16x32_bf16 v[212:215], a[216:219], v[28:31], v[212:215]
    ds_read_b64_tr_b16 a[212:213], v4 offset:19456
    v_fma_f32 v64, v64, s28, v10
    v_mfma_f32_16x16x32_bf16 v[164:167], a[216:219], v[22:25], v[164:167]
    ds_read_b64_tr_b16 a[232:233], v3 offset:19456
    v_mfma_f32_16x16x32_bf16 v[116:119], a[216:219], v[16:19], v[116:119]
    ds_read_b64_tr_b16 a[234:235], v3 offset:13312
    s_waitcnt lgkmcnt(7)
    v_mfma_f32_16x16x32_bf16 v[120:123], a[220:223], v[16:19], v[120:123]
    v_exp_f32 v63, v63
    v_mfma_f32_16x16x32_bf16 v[168:171], a[220:223], v[22:25], v[168:171]
    ds_read_b64_tr_b16 a[216:217], v5 offset:19456
    v_fma_f32 v67, v67, s28, v10
    v_mfma_f32_16x16x32_bf16 v[216:219], a[220:223], v[28:31], v[216:219]
    v_exp_f32 v68, v68
    v_mfma_f32_16x16x32_bf16 a[8:11], a[220:223], v[34:37], a[8:11]
    s_waitcnt lgkmcnt(5)
    ds_read_b64_tr_b16 a[214:215], v4 offset:13312
    v_fma_f32 v69, v69, s28, v11
    v_mfma_f32_16x16x32_bf16 a[12:15], a[224:227], v[34:37], a[12:15]
    v_fma_f32 v79, v79, s28, v12
    v_fma_f32 v57, v57, s28, v9
    v_mfma_f32_16x16x32_bf16 v[220:223], a[224:227], v[28:31], v[220:223]
    v_fma_f32 v83, v83, s28, v12
    v_fma_f32 v71, v71, s28, v11
    v_mfma_f32_16x16x32_bf16 v[172:175], a[224:227], v[22:25], v[172:175]
    ds_read_b64_tr_b16 a[222:223], v2 offset:14336
    v_mfma_f32_16x16x32_bf16 v[124:127], a[224:227], v[16:19], v[124:127]
    s_waitcnt lgkmcnt(5)
    ds_read_b64_tr_b16 a[218:219], v5 offset:13312
    v_mfma_f32_16x16x32_bf16 v[128:131], a[228:231], v[16:19], v[128:131]
    v_exp_f32 v58, v58
    v_mfma_f32_16x16x32_bf16 v[176:179], a[228:231], v[22:25], v[176:179]
    ds_read_b64_tr_b16 a[220:221], v2 offset:20480
    v_fma_f32 v65, v65, s28, v10
    v_mfma_f32_16x16x32_bf16 v[224:227], a[228:231], v[28:31], v[224:227]
    s_add_u32 s39, s39, 12288
    ds_read_b64_tr_b16 a[224:225], v3 offset:20480
    v_fma_f32 v56, v56, s28, v9
    v_mfma_f32_16x16x32_bf16 a[16:19], a[228:231], v[34:37], a[16:19]
    s_waitcnt lgkmcnt(5)
    ds_read_b64_tr_b16 a[230:231], v4 offset:14336
    v_fma_f32 v70, v70, s28, v11
    v_mfma_f32_16x16x32_bf16 a[20:23], a[232:235], v[34:37], a[20:23]
    ds_read_b64_tr_b16 a[226:227], v3 offset:14336
    v_fma_f32 v62, v62, s28, v10
    v_mfma_f32_16x16x32_bf16 v[228:231], a[232:235], v[28:31], v[228:231]
    v_fma_f32 v73, v73, s28, v11
    v_fma_f32 v78, v78, s28, v12
    v_mfma_f32_16x16x32_bf16 v[180:183], a[232:235], v[22:25], v[180:183]
    ds_read_b64_tr_b16 a[228:229], v4 offset:20480
    v_fma_f32 v77, v77, s28, v12
    v_mfma_f32_16x16x32_bf16 v[132:135], a[232:235], v[16:19], v[132:135]
    s_waitcnt lgkmcnt(7)
    ds_read_b64_tr_b16 a[232:233], v5 offset:20480
    v_fma_f32 v72, v72, s28, v11
    v_mfma_f32_16x16x32_bf16 v[136:139], a[212:215], v[16:19], v[136:139]
    ds_read_b64_tr_b16 a[234:235], v5 offset:14336
    v_fma_f32 v81, v81, s28, v12
    v_mfma_f32_16x16x32_bf16 v[184:187], a[212:215], v[22:25], v[184:187]
    ds_read_b128 v[88:91], v103 offset:0
    v_mfma_f32_16x16x32_bf16 v[232:235], a[212:215], v[28:31], v[232:235]
    v_exp_f32 v62, v62
    v_mfma_f32_16x16x32_bf16 a[24:27], a[212:215], v[34:37], a[24:27]
    s_waitcnt lgkmcnt(7)
    v_exp_f32 v67, v67
    v_mfma_f32_16x16x32_bf16 a[28:31], a[216:219], v[34:37], a[28:31]
    v_exp_f32 v69, v69
    v_mfma_f32_16x16x32_bf16 v[236:239], a[216:219], v[28:31], v[236:239]
    v_fma_f32 v80, v80, s28, v12
    v_fma_f32 v76, v76, s28, v12
    v_mfma_f32_16x16x32_bf16 v[188:191], a[216:219], v[22:25], v[188:191]
    v_exp_f32 v70, v70
    v_mfma_f32_16x16x32_bf16 v[140:143], a[216:219], v[16:19], v[140:143]
    ds_read_b128 v[84:87], v103 offset:2048
    v_mfma_f32_16x16x32_bf16 v[144:147], a[220:223], v[16:19], v[144:147]
    v_exp_f32 v65, v65
    v_mfma_f32_16x16x32_bf16 v[192:195], a[220:223], v[22:25], v[192:195]
    v_exp_f32 v66, v66
    v_mfma_f32_16x16x32_bf16 v[240:243], a[220:223], v[28:31], v[240:243]
    s_waitcnt vmcnt(10) lgkmcnt(2)
    v_exp_f32 v77, v77
    v_mfma_f32_16x16x32_bf16 a[32:35], a[220:223], v[34:37], a[32:35]
    s_barrier
    v_mfma_f32_16x16x32_bf16 a[36:39], a[224:227], v[34:37], a[36:39]
    s_add_u32 m0, s22, 36864
    v_exp_f32 v72, v72
    v_mfma_f32_16x16x32_bf16 v[244:247], a[224:227], v[28:31], v[244:247]
    ds_read_b128 a[212:215], v0 offset:12288
    v_mfma_f32_16x16x32_bf16 v[196:199], a[224:227], v[22:25], v[196:199]
    ds_read_b128 a[216:219], v1 offset:12288
    v_fma_f32 v59, v59, s28, v9
    v_mfma_f32_16x16x32_bf16 v[148:151], a[224:227], v[16:19], v[148:151]
    ds_read_b128 a[220:223], v0 offset:13312
    v_mfma_f32_16x16x32_bf16 v[152:155], a[228:231], v[16:19], v[152:155]
    buffer_load_dwordx4 v6, s[8:11], s21 offen lds
    v_mfma_f32_16x16x32_bf16 v[200:203], a[228:231], v[22:25], v[200:203]
    s_add_u32 s21, s21, 128
    v_exp_f32 v78, v78
    v_mfma_f32_16x16x32_bf16 v[248:251], a[228:231], v[28:31], v[248:251]
    s_add_u32 m0, s22, 37888
    v_exp_f32 v79, v79
    v_mfma_f32_16x16x32_bf16 a[40:43], a[228:231], v[34:37], a[40:43]
    buffer_load_dwordx4 v6, s[8:11], s21 offen lds
    v_mfma_f32_16x16x32_bf16 a[44:47], a[232:235], v[34:37], a[44:47]
    s_add_u32 s21, s21, 128
    s_add_u32 m0, s22, 38912
    v_mfma_f32_16x16x32_bf16 v[252:255], a[232:235], v[28:31], v[252:255]
    v_exp_f32 v71, v71
    v_mfma_f32_16x16x32_bf16 v[204:207], a[232:235], v[22:25], v[204:207]
    buffer_load_dwordx4 v6, s[8:11], s21 offen lds
    v_mfma_f32_16x16x32_bf16 v[156:159], a[232:235], v[16:19], v[156:159]
    s_waitcnt lgkmcnt(2)
    ds_read_b128 a[224:227], v1 offset:13312
    v_fma_f32 v75, v75, s28, v11
    v_mfma_f32_16x16x32_bf16 v[52:55], a[212:215], a[96:99], 0
    s_waitcnt lgkmcnt(2)
    ds_read_b128 a[232:235], v1 offset:14336
    v_cvt_pk_bf16_f32 v26, v68, v69
    v_mfma_f32_16x16x32_bf16 v[52:55], a[216:219], a[100:103], v[52:55]
    s_waitcnt lgkmcnt(2)
    v_exp_f32 v76, v76
    v_mfma_f32_16x16x32_bf16 v[52:55], a[220:223], a[104:107], v[52:55]
    v_fma_f32 v82, v82, s28, v12
    v_cvt_pk_bf16_f32 v21, v62, v63
    v_mfma_f32_16x16x32_bf16 v[60:63], a[220:223], a[128:131], 0
    ds_read_b128 a[228:231], v0 offset:14336
    v_cvt_pk_bf16_f32 v23, v66, v67
    v_mfma_f32_16x16x32_bf16 v[60:63], a[216:219], a[124:127], v[60:63]
    v_mfma_f32_16x16x32_bf16 v[60:63], a[212:215], a[120:123], v[60:63]
    v_cvt_pk_bf16_f32 v32, v76, v77
    v_cvt_pk_bf16_f32 v27, v70, v71
    v_mfma_f32_16x16x32_bf16 v[68:71], a[212:215], a[144:147], 0
    s_add_u32 s21, s21, 12032
    v_exp_f32 v59, v59
    v_mfma_f32_16x16x32_bf16 v[68:71], a[216:219], a[148:151], v[68:71]
    s_add_u32 m0, s23, 0
    v_exp_f32 v74, v74
    v_mfma_f32_16x16x32_bf16 v[68:71], a[220:223], a[152:155], v[68:71]
    buffer_store_dwordx4 v[88:91], v38, s[16:19], s24 offen offset:0 nt
    v_exp_f32 v81, v81
    v_cvt_pk_bf16_f32 v33, v78, v79
    v_mfma_f32_16x16x32_bf16 v[76:79], a[220:223], a[176:179], 0
    v_cvt_pk_bf16_f32 v17, v58, v59
    v_mfma_f32_16x16x32_bf16 v[76:79], a[216:219], a[172:175], v[76:79]
    v_exp_f32 v82, v82
    v_mfma_f32_16x16x32_bf16 v[76:79], a[212:215], a[168:171], v[76:79]
    s_waitcnt lgkmcnt(1)
    v_exp_f32 v83, v83
    v_mfma_f32_16x16x32_bf16 v[76:79], a[224:227], a[180:183], v[76:79]
    s_waitcnt lgkmcnt(0)
    ds_read_b128 a[212:215], v0 offset:18432
    v_cvt_pk_bf16_f32 v35, v82, v83
    v_mfma_f32_16x16x32_bf16 v[76:79], a[228:231], a[184:187], v[76:79]
    ds_read_b128 a[220:223], v0 offset:19456
    v_mfma_f32_16x16x32_bf16 v[76:79], a[232:235], a[188:191], v[76:79]
    v_exp_f32 v75, v75
    v_mfma_f32_16x16x32_bf16 v[68:71], a[232:235], a[164:167], v[68:71]
    ds_read_b128 a[216:219], v1 offset:18432
    v_cvt_pk_bf16_f32 v29, v74, v75
    v_mfma_f32_16x16x32_bf16 v[68:71], a[228:231], a[160:163], v[68:71]
    v_exp_f32 v57, v57
    v_mfma_f32_16x16x32_bf16 v[68:71], a[224:227], a[156:159], v[68:71]
    buffer_load_dwordx4 v38, s[12:15], s25 offen nt lds
    v_mfma_f32_16x16x32_bf16 v[60:63], a[224:227], a[132:135], v[60:63]
    v_exp_f32 v56, v56
    v_mfma_f32_16x16x32_bf16 v[60:63], a[228:231], a[136:139], v[60:63]
    s_bitcmp1_b32 s27, 0
    v_exp_f32 v64, v64
    v_mfma_f32_16x16x32_bf16 v[60:63], a[232:235], a[140:143], v[60:63]
    v_exp_f32 v73, v73
    v_mfma_f32_16x16x32_bf16 v[52:55], a[232:235], a[116:119], v[52:55]
    ds_read_b128 a[232:235], v1 offset:20480
    v_cvt_pk_bf16_f32 v22, v64, v65
    v_mfma_f32_16x16x32_bf16 v[52:55], a[228:231], a[112:115], v[52:55]
    ds_read_b128 a[228:231], v0 offset:20480
    v_cvt_pk_bf16_f32 v28, v72, v73
    v_mfma_f32_16x16x32_bf16 v[52:55], a[224:227], a[108:111], v[52:55]
    s_waitcnt lgkmcnt(3)
    ds_read_b128 a[224:227], v1 offset:19456
    v_cvt_pk_bf16_f32 v16, v56, v57
    v_mfma_f32_16x16x32_bf16 v[56:59], a[212:215], a[96:99], 0
    s_cselect_b32 s26, s49, 128
    s_bitcmp1_b32 s89, 0
    s_cselect_b32 s26, s26, 0
    v_mfma_f32_16x16x32_bf16 v[44:47], a[236:239], v[14:17], v[48:51]
    v_exp_f32 v80, v80
    v_mfma_f32_16x16x32_bf16 v[44:47], a[240:243], v[20:23], v[44:47]
    v_cvt_pk_bf16_f32 v34, v80, v81
    s_lshr_b32 s89, s89, 1
    v_mfma_f32_16x16x32_bf16 v[44:47], a[244:247], v[26:29], v[44:47]
    s_waitcnt lgkmcnt(3)
    v_mfma_f32_16x16x32_bf16 v[56:59], a[216:219], a[100:103], v[56:59]
    v_mfma_f32_16x16x32_bf16 v[56:59], a[220:223], a[104:107], v[56:59]
    v_mfma_f32_16x16x32_bf16 v[44:47], a[248:251], v[32:35], v[44:47]
    s_lshr_b32 s27, s27, 1
    v_mfma_f32_16x16x32_bf16 v[64:67], a[220:223], a[128:131], 0
    s_add_u32 s24, s24, s26
    s_add_u32 s25, s25, s26
    ds_read_b128 v[96:99], v103 offset:1024
    v_mfma_f32_16x16x32_bf16 v[64:67], a[216:219], a[124:127], v[64:67]
    v_mfma_f32_16x16x32_bf16 v[64:67], a[212:215], a[120:123], v[64:67]
    s_nop 0
    v_cmp_lt_f32 vcc, s29, v44
    s_waitcnt vmcnt(10) lgkmcnt(1)
    v_mfma_f32_16x16x32_bf16 v[72:75], a[212:215], a[144:147], 0
    s_barrier
    v_mfma_f32_16x16x32_bf16 v[72:75], a[216:219], a[148:151], v[72:75]
    s_nop 0
    s_cbranch_vccnz L_rs_loop4w0a
L_ret_loop4w0a:
    v_mfma_f32_16x16x32_bf16 v[72:75], a[220:223], a[152:155], v[72:75]
    s_add_u32 m0, s22, 12288
    v_fma_f32 v78, v78, s28, v12
    v_fma_f32 v62, v62, s28, v10
    v_mfma_f32_16x16x32_bf16 v[80:83], a[220:223], a[176:179], 0
    buffer_load_dwordx4 v6, s[4:7], s20 offen lds
    v_mfma_f32_16x16x32_bf16 v[80:83], a[216:219], a[172:175], v[80:83]
    s_add_u32 s20, s20, 128
    v_exp_f32 v78, v78
    v_mfma_f32_16x16x32_bf16 v[80:83], a[212:215], a[168:171], v[80:83]
    s_add_u32 m0, s22, 13312
    ds_read_b64_tr_b16 a[212:213], v2 offset:0
    v_fma_f32 v53, v53, s28, v9
    v_mfma_f32_16x16x32_bf16 v[80:83], a[224:227], a[180:183], v[80:83]
    buffer_load_dwordx4 v6, s[4:7], s20 offen lds
    v_mfma_f32_16x16x32_bf16 v[80:83], a[228:231], a[184:187], v[80:83]
    s_add_u32 s20, s20, 128
    ds_read_b64_tr_b16 a[214:215], v2 offset:6144
    v_fma_f32 v68, v68, s28, v11
    v_mfma_f32_16x16x32_bf16 v[80:83], a[232:235], a[188:191], v[80:83]
    s_add_u32 m0, s22, 14336
    ds_read_b64_tr_b16 a[216:217], v3 offset:0
    v_mfma_f32_16x16x32_bf16 v[72:75], a[232:235], a[164:167], v[72:75]
    ds_read_b64_tr_b16 a[218:219], v3 offset:6144
    v_fma_f32 v71, v71, s28, v11
    v_mfma_f32_16x16x32_bf16 v[72:75], a[228:231], a[160:163], v[72:75]
    buffer_load_dwordx4 v6, s[4:7], s20 offen lds
    v_mfma_f32_16x16x32_bf16 v[72:75], a[224:227], a[156:159], v[72:75]
    s_add_u32 s20, s20, 12032
    ds_read_b64_tr_b16 a[220:221], v4 offset:0
    v_fma_f32 v69, v69, s28, v11
    v_mfma_f32_16x16x32_bf16 v[64:67], a[224:227], a[132:135], v[64:67]
    v_fma_f32 v61, v61, s28, v10
    v_fma_f32 v60, v60, s28, v10
    v_mfma_f32_16x16x32_bf16 v[64:67], a[228:231], a[136:139], v[64:67]
    ds_read_b64_tr_b16 a[222:223], v4 offset:6144
    v_fma_f32 v79, v79, s28, v12
    v_mfma_f32_16x16x32_bf16 v[64:67], a[232:235], a[140:143], v[64:67]
    v_exp_f32 v53, v53
    v_mfma_f32_16x16x32_bf16 v[56:59], a[232:235], a[116:119], v[56:59]
    s_add_u32 s39, s39, 12288
    v_exp_f32 v60, v60
    v_mfma_f32_16x16x32_bf16 v[56:59], a[228:231], a[112:115], v[56:59]
    s_add_u32 m0, s23, 1024
    v_fma_f32 v63, v63, s28, v10
    v_fma_f32 v54, v54, s28, v9
    v_mfma_f32_16x16x32_bf16 v[56:59], a[224:227], a[108:111], v[56:59]
    s_waitcnt lgkmcnt(4)
    v_exp_f32 v79, v79
    v_mfma_f32_16x16x32_bf16 v[112:115], a[212:215], v[14:17], v[112:115]
    ds_read_b64_tr_b16 a[228:229], v2 offset:1024
    v_fma_f32 v55, v55, s28, v9
    v_mfma_f32_16x16x32_bf16 v[160:163], a[212:215], v[20:23], v[160:163]
    ds_read_b64_tr_b16 a[224:225], v5 offset:0
    v_fma_f32 v70, v70, s28, v11
    v_mfma_f32_16x16x32_bf16 v[208:211], a[212:215], v[26:29], v[208:211]
    ds_read_b64_tr_b16 a[234:235], v3 offset:7168
    v_fma_f32 v77, v77, s28, v12
    v_mfma_f32_16x16x32_bf16 a[0:3], a[212:215], v[32:35], a[0:3]
    s_waitcnt lgkmcnt(4)
    ds_read_b64_tr_b16 a[226:227], v5 offset:6144
    v_fma_f32 v74, v74, s28, v11
    v_mfma_f32_16x16x32_bf16 a[4:7], a[216:219], v[32:35], a[4:7]
    ds_read_b64_tr_b16 a[230:231], v2 offset:7168
    v_mfma_f32_16x16x32_bf16 v[212:215], a[216:219], v[26:29], v[212:215]
    buffer_store_dwordx4 v[96:99], v39, s[16:19], s24 offen offset:0 nt
    ds_read_b64_tr_b16 a[212:213], v4 offset:1024
    v_exp_f32 v77, v77
    v_mfma_f32_16x16x32_bf16 v[164:167], a[216:219], v[20:23], v[164:167]
    v_exp_f32 v55, v55
    v_mfma_f32_16x16x32_bf16 v[116:119], a[216:219], v[14:17], v[116:119]
    s_waitcnt lgkmcnt(6)
    ds_read_b64_tr_b16 a[232:233], v3 offset:1024
    v_fma_f32 v75, v75, s28, v11
    v_mfma_f32_16x16x32_bf16 v[120:123], a[220:223], v[14:17], v[120:123]
    ds_read_b64_tr_b16 a[214:215], v4 offset:7168
    v_mfma_f32_16x16x32_bf16 v[168:171], a[220:223], v[20:23], v[168:171]
    ds_read_b64_tr_b16 a[218:219], v5 offset:7168
    v_mfma_f32_16x16x32_bf16 v[216:219], a[220:223], v[26:29], v[216:219]
    v_exp_f32 v61, v61
    v_mfma_f32_16x16x32_bf16 a[8:11], a[220:223], v[32:35], a[8:11]
    ds_read_b64_tr_b16 a[216:217], v5 offset:1024
    s_waitcnt lgkmcnt(6)
    v_mfma_f32_16x16x32_bf16 a[12:15], a[224:227], v[32:35], a[12:15]
    v_exp_f32 v54, v54
    v_mfma_f32_16x16x32_bf16 v[220:223], a[224:227], v[26:29], v[220:223]
    ds_read_b64_tr_b16 a[220:221], v2 offset:2048
    v_fma_f32 v73, v73, s28, v11
    v_mfma_f32_16x16x32_bf16 v[172:175], a[224:227], v[20:23], v[172:175]
    buffer_load_dwordx4 v39, s[12:15], s25 offen nt lds
    v_mfma_f32_16x16x32_bf16 v[124:127], a[224:227], v[14:17], v[124:127]
    s_waitcnt lgkmcnt(5)
    ds_read_b64_tr_b16 a[222:223], v2 offset:8192
    v_fma_f32 v57, v57, s28, v9
    v_mfma_f32_16x16x32_bf16 v[128:131], a[228:231], v[14:17], v[128:131]
    s_bitcmp1_b32 s27, 0
    ds_read_b64_tr_b16 a[224:225], v3 offset:2048
    v_fma_f32 v52, v52, s28, v9
    v_mfma_f32_16x16x32_bf16 v[176:179], a[228:231], v[20:23], v[176:179]
    v_exp_f32 v69, v69
    v_mfma_f32_16x16x32_bf16 v[224:227], a[228:231], v[26:29], v[224:227]
    v_exp_f32 v71, v71
    v_mfma_f32_16x16x32_bf16 a[16:19], a[228:231], v[32:35], a[16:19]
    s_waitcnt lgkmcnt(4)
    ds_read_b64_tr_b16 a[230:231], v4 offset:8192
    v_fma_f32 v58, v58, s28, v9
    v_mfma_f32_16x16x32_bf16 a[20:23], a[232:235], v[32:35], a[20:23]
    v_exp_f32 v52, v52
    v_mfma_f32_16x16x32_bf16 v[228:231], a[232:235], v[26:29], v[228:231]
    ds_read_b64_tr_b16 a[226:227], v3 offset:8192
    v_fma_f32 v76, v76, s28, v12
    v_mfma_f32_16x16x32_bf16 v[180:183], a[232:235], v[20:23], v[180:183]
    s_cselect_b32 s26, s49, 128
    s_bitcmp1_b32 s89, 0
    ds_read_b64_tr_b16 a[228:229], v4 offset:2048
    v_mfma_f32_16x16x32_bf16 v[132:135], a[232:235], v[14:17], v[132:135]
    ds_read_b64_tr_b16 a[232:233], v5 offset:2048
    v_fma_f32 v80, v80, s28, v12
    v_mfma_f32_16x16x32_bf16 v[136:139], a[212:215], v[14:17], v[136:139]
    s_cselect_b32 s26, s26, 0
    ds_read_b64_tr_b16 a[234:235], v5 offset:8192
    v_fma_f32 v82, v82, s28, v12
    v_mfma_f32_16x16x32_bf16 v[184:187], a[212:215], v[20:23], v[184:187]
    v_exp_f32 v68, v68
    v_mfma_f32_16x16x32_bf16 v[232:235], a[212:215], v[26:29], v[232:235]
    s_lshr_b32 s89, s89, 1
    v_exp_f32 v63, v63
    v_mfma_f32_16x16x32_bf16 a[24:27], a[212:215], v[32:35], a[24:27]
    s_waitcnt lgkmcnt(5)
    v_exp_f32 v70, v70
    v_mfma_f32_16x16x32_bf16 a[28:31], a[216:219], v[32:35], a[28:31]
    v_exp_f32 v80, v80
    v_mfma_f32_16x16x32_bf16 v[236:239], a[216:219], v[26:29], v[236:239]
    v_fma_f32 v72, v72, s28, v11
    s_lshr_b32 s27, s27, 1
    v_mfma_f32_16x16x32_bf16 v[188:191], a[216:219], v[20:23], v[188:191]
    s_add_u32 s24, s24, s26
    v_cvt_pk_bf16_f32 v19, v54, v55
    v_mfma_f32_16x16x32_bf16 v[140:143], a[216:219], v[14:17], v[140:143]
    v_cvt_pk_bf16_f32 v24, v60, v61
    v_mfma_f32_16x16x32_bf16 v[144:147], a[220:223], v[14:17], v[144:147]
    v_exp_f32 v73, v73
    v_mfma_f32_16x16x32_bf16 v[192:195], a[220:223], v[20:23], v[192:195]
    v_fma_f32 v81, v81, s28, v12
    s_add_u32 s25, s25, s26
    v_mfma_f32_16x16x32_bf16 v[240:243], a[220:223], v[26:29], v[240:243]
    s_waitcnt vmcnt(10) lgkmcnt(0)
    v_exp_f32 v62, v62
    v_mfma_f32_16x16x32_bf16 a[32:35], a[220:223], v[32:35], a[32:35]
    s_barrier
    v_mfma_f32_16x16x32_bf16 a[36:39], a[224:227], v[32:35], a[36:39]
    s_add_u32 m0, s22, 24576
    ds_read_b128 a[212:215], v0 offset:0
    v_cvt_pk_bf16_f32 v25, v62, v63
    v_mfma_f32_16x16x32_bf16 v[244:247], a[224:227], v[26:29], v[244:247]
    buffer_load_dwordx4 v6, s[8:11], s21 offen lds
    v_mfma_f32_16x16x32_bf16 v[196:199], a[224:227], v[20:23], v[196:199]
    s_add_u32 s21, s21, 128
    ds_read_b128 a[216:219], v1 offset:0
    v_cvt_pk_bf16_f32 v30, v68, v69
    v_mfma_f32_16x16x32_bf16 v[148:151], a[224:227], v[14:17], v[148:151]
    s_add_u32 m0, s22, 25600
    ds_read_b128 a[220:223], v0 offset:1024
    v_cvt_pk_bf16_f32 v18, v52, v53
    v_mfma_f32_16x16x32_bf16 v[152:155], a[228:231], v[14:17], v[152:155]
    buffer_load_dwordx4 v6, s[8:11], s21 offen lds
    v_mfma_f32_16x16x32_bf16 v[200:203], a[228:231], v[20:23], v[200:203]
    v_exp_f32 v76, v76
    v_mfma_f32_16x16x32_bf16 v[248:251], a[228:231], v[26:29], v[248:251]
    s_add_u32 s21, s21, 128
    ds_read_b128 a[224:227], v1 offset:1024
    v_mfma_f32_16x16x32_bf16 a[40:43], a[228:231], v[32:35], a[40:43]
    v_fma_f32 v65, v65, s28, v10
    v_fma_f32 v83, v83, s28, v12
    v_mfma_f32_16x16x32_bf16 a[44:47], a[232:235], v[32:35], a[44:47]
    s_add_u32 m0, s22, 26624
    v_exp_f32 v58, v58
    v_mfma_f32_16x16x32_bf16 v[252:255], a[232:235], v[26:29], v[252:255]
    buffer_load_dwordx4 v6, s[8:11], s21 offen lds
    v_mfma_f32_16x16x32_bf16 v[204:207], a[232:235], v[20:23], v[204:207]
    ds_read_b128 a[228:231], v0 offset:2048
    v_fma_f32 v59, v59, s28, v9
    v_mfma_f32_16x16x32_bf16 v[156:159], a[232:235], v[14:17], v[156:159]
    s_waitcnt lgkmcnt(4)
    v_fma_f32 v66, v66, s28, v10
    v_fma_f32 v64, v64, s28, v10
    v_mfma_f32_16x16x32_bf16 v[52:55], a[212:215], a[96:99], 0
    s_waitcnt lgkmcnt(3)
    v_exp_f32 v64, v64
    v_mfma_f32_16x16x32_bf16 v[52:55], a[216:219], a[100:103], v[52:55]
    s_waitcnt lgkmcnt(2)
    v_exp_f32 v83, v83
    v_mfma_f32_16x16x32_bf16 v[52:55], a[220:223], a[104:107], v[52:55]
    s_add_u32 s21, s21, 12032
    v_cvt_pk_bf16_f32 v31, v70, v71
    v_cvt_pk_bf16_f32 v37, v78, v79
    v_mfma_f32_16x16x32_bf16 v[60:63], a[220:223], a[128:131], 0
    ds_read_b128 a[232:235], v1 offset:2048
    v_fma_f32 v67, v67, s28, v10
    v_mfma_f32_16x16x32_bf16 v[60:63], a[216:219], a[124:127], v[60:63]
    buffer_store_dwordx4 v[84:87], v38, s[16:19], s24 offen offset:0 nt
    v_fma_f32 v56, v56, s28, v9
    v_exp_f32 v74, v74
    v_mfma_f32_16x16x32_bf16 v[60:63], a[212:215], a[120:123], v[60:63]
    v_exp_f32 v81, v81
    v_mfma_f32_16x16x32_bf16 v[68:71], a[212:215], a[144:147], 0
    v_exp_f32 v59, v59
    v_mfma_f32_16x16x32_bf16 v[68:71], a[216:219], a[148:151], v[68:71]
    v_exp_f32 v57, v57
    v_mfma_f32_16x16x32_bf16 v[68:71], a[220:223], a[152:155], v[68:71]
    v_cvt_pk_bf16_f32 v36, v76, v77
    v_cvt_pk_bf16_f32 v34, v80, v81
    v_mfma_f32_16x16x32_bf16 v[76:79], a[220:223], a[176:179], 0
    v_exp_f32 v67, v67
    v_mfma_f32_16x16x32_bf16 v[76:79], a[216:219], a[172:175], v[76:79]
    v_exp_f32 v75, v75
    v_mfma_f32_16x16x32_bf16 v[76:79], a[212:215], a[168:171], v[76:79]
    s_add_u32 m0, s23, 2048
    ds_read_b128 a[212:215], v0 offset:6144
    s_waitcnt lgkmcnt(1)
    v_mfma_f32_16x16x32_bf16 v[76:79], a[224:227], a[180:183], v[76:79]
    v_exp_f32 v82, v82
    v_mfma_f32_16x16x32_bf16 v[76:79], a[228:231], a[184:187], v[76:79]
    buffer_load_dwordx4 v38, s[12:15], s25 offen nt lds
    v_mfma_f32_16x16x32_bf16 v[76:79], a[232:235], a[188:191], v[76:79]
    v_exp_f32 v65, v65
    v_mfma_f32_16x16x32_bf16 v[68:71], a[232:235], a[164:167], v[68:71]
    v_exp_f32 v72, v72
    v_mfma_f32_16x16x32_bf16 v[68:71], a[228:231], a[160:163], v[68:71]
    v_exp_f32 v56, v56
    v_mfma_f32_16x16x32_bf16 v[68:71], a[224:227], a[156:159], v[68:71]
    s_bitcmp1_b32 s27, 0
    ds_read_b128 a[220:223], v0 offset:7168
    v_cvt_pk_bf16_f32 v16, v56, v57
    v_mfma_f32_16x16x32_bf16 v[60:63], a[224:227], a[132:135], v[60:63]
    ds_read_b128 a[216:219], v1 offset:6144
    v_cvt_pk_bf16_f32 v17, v58, v59
    v_mfma_f32_16x16x32_bf16 v[60:63], a[228:231], a[136:139], v[60:63]
    s_cselect_b32 s26, s49, 128
    v_cvt_pk_bf16_f32 v22, v64, v65
    v_cvt_pk_bf16_f32 v29, v74, v75
    v_mfma_f32_16x16x32_bf16 v[60:63], a[232:235], a[140:143], v[60:63]
    v_exp_f32 v66, v66
    v_mfma_f32_16x16x32_bf16 v[52:55], a[232:235], a[116:119], v[52:55]
    s_bitcmp1_b32 s89, 0
    ds_read_b128 a[232:235], v1 offset:8192
    v_mfma_f32_16x16x32_bf16 v[52:55], a[228:231], a[112:115], v[52:55]
    s_cselect_b32 s26, s26, 0
    ds_read_b128 a[228:231], v0 offset:8192
    v_cvt_pk_bf16_f32 v35, v82, v83
    v_mfma_f32_16x16x32_bf16 v[52:55], a[224:227], a[108:111], v[52:55]
    ds_read_b128 a[224:227], v1 offset:7168
    v_cvt_pk_bf16_f32 v23, v66, v67
    v_mfma_f32_16x16x32_bf16 v[48:51], a[236:239], v[16:19], v[44:47]
    v_cvt_pk_bf16_f32 v28, v72, v73
    v_mfma_f32_16x16x32_bf16 v[48:51], a[240:243], v[22:25], v[48:51]
    s_lshr_b32 s89, s89, 1
    v_mfma_f32_16x16x32_bf16 v[48:51], a[244:247], v[28:31], v[48:51]
    v_mfma_f32_16x16x32_bf16 v[48:51], a[248:251], v[34:37], v[48:51]
    s_waitcnt lgkmcnt(4)
    v_swap_b32 v38, v39
    v_mfma_f32_16x16x32_bf16 v[56:59], a[212:215], a[96:99], 0
    s_lshr_b32 s27, s27, 1
    v_add_u32 v103, 3072, v103
    s_waitcnt lgkmcnt(3)
    v_mfma_f32_16x16x32_bf16 v[56:59], a[216:219], a[100:103], v[56:59]
    s_nop 0
    v_cmp_lt_f32 vcc, s29, v48
    s_add_u32 s24, s24, s26
    v_mfma_f32_16x16x32_bf16 v[56:59], a[220:223], a[104:107], v[56:59]
    s_add_u32 s25, s25, s26
    s_add_u32 s23, s23, 3072
    v_mfma_f32_16x16x32_bf16 v[64:67], a[220:223], a[128:131], 0
    s_cbranch_vccnz L_rs_loop4w0b
L_ret_loop4w0b:
    v_fma_f32 v60, v60, s28, v10
    v_mfma_f32_16x16x32_bf16 v[64:67], a[216:219], a[124:127], v[64:67]
    v_fma_f32 v54, v54, s28, v9
    v_fma_f32 v52, v52, s28, v9
    v_mfma_f32_16x16x32_bf16 v[64:67], a[212:215], a[120:123], v[64:67]
    s_waitcnt vmcnt(12) lgkmcnt(0)
    s_cmp_eq_u32 s30, 5
    v_fma_f32 v53, v53, s28, v9
    v_mfma_f32_16x16x32_bf16 v[72:75], a[212:215], a[144:147], 0
    s_barrier
    v_mfma_f32_16x16x32_bf16 v[72:75], a[216:219], a[148:151], v[72:75]
    s_cselect_b32 s26, s62, 0
    s_add_u32 s20, s20, s26
    s_add_u32 m0, s22, 0
    v_mfma_f32_16x16x32_bf16 v[72:75], a[220:223], a[152:155], v[72:75]
    buffer_load_dwordx4 v6, s[4:7], s20 offen lds
    v_mfma_f32_16x16x32_bf16 v[80:83], a[220:223], a[176:179], 0
    s_add_u32 s20, s20, 128
    v_exp_f32 v53, v53
    v_mfma_f32_16x16x32_bf16 v[80:83], a[216:219], a[172:175], v[80:83]
    v_exp_f32 v52, v52
    v_mfma_f32_16x16x32_bf16 v[80:83], a[212:215], a[168:171], v[80:83]
    s_add_u32 m0, s22, 1024
    ds_read_b64_tr_b16 a[212:213], v2 offset:18432
    v_fma_f32 v61, v61, s28, v10
    v_mfma_f32_16x16x32_bf16 v[80:83], a[224:227], a[180:183], v[80:83]
    buffer_load_dwordx4 v6, s[4:7], s20 offen lds
    v_mfma_f32_16x16x32_bf16 v[80:83], a[228:231], a[184:187], v[80:83]
    s_add_u32 s20, s20, 128
    ds_read_b64_tr_b16 a[214:215], v2 offset:12288
    v_fma_f32 v55, v55, s28, v9
    v_mfma_f32_16x16x32_bf16 v[80:83], a[232:235], a[188:191], v[80:83]
    s_add_u32 m0, s22, 2048
    v_exp_f32 v55, v55
    v_mfma_f32_16x16x32_bf16 v[72:75], a[232:235], a[164:167], v[72:75]
    buffer_load_dwordx4 v6, s[4:7], s20 offen lds
    v_mfma_f32_16x16x32_bf16 v[72:75], a[228:231], a[160:163], v[72:75]
    v_exp_f32 v54, v54
    v_mfma_f32_16x16x32_bf16 v[72:75], a[224:227], a[156:159], v[72:75]
    v_exp_f32 v60, v60
    v_mfma_f32_16x16x32_bf16 v[64:67], a[224:227], a[132:135], v[64:67]
    ds_read_b64_tr_b16 a[216:217], v3 offset:18432
    v_mfma_f32_16x16x32_bf16 v[64:67], a[228:231], a[136:139], v[64:67]
    s_add_u32 s20, s20, 12032
    ds_read_b64_tr_b16 a[218:219], v3 offset:12288
    v_cvt_pk_bf16_f32 v14, v52, v53
    v_mfma_f32_16x16x32_bf16 v[64:67], a[232:235], a[140:143], v[64:67]
    ds_read_b64_tr_b16 a[220:221], v4 offset:18432
    v_cvt_pk_bf16_f32 v15, v54, v55
    v_mfma_f32_16x16x32_bf16 v[56:59], a[232:235], a[116:119], v[56:59]
    s_add_u32 s30, s30, 1
    v_exp_f32 v61, v61
    v_mfma_f32_16x16x32_bf16 v[56:59], a[228:231], a[112:115], v[56:59]
    s_cmp_lt_u32 s30, 6
    ds_read_b64_tr_b16 a[222:223], v4 offset:12288
    v_cvt_pk_bf16_f32 v20, v60, v61
    v_mfma_f32_16x16x32_bf16 v[56:59], a[224:227], a[108:111], v[56:59]
    s_waitcnt lgkmcnt(4)
    ds_read_b64_tr_b16 a[224:225], v5 offset:18432
    ds_read_b64_tr_b16 a[226:227], v5 offset:12288
    s_cbranch_scc1 L_loop4w0
    s_cmp_ge_u32 s37, 6
    s_cbranch_scc1 L_end4
    s_cmp_eq_u32 s32, 0
    s_cbranch_scc1 L_tr44
    s_branch L_tr45
L_tr45:
    v_mfma_f32_16x16x32_bf16 v[112:115], a[212:215], v[16:19], v[112:115]
    v_fma_f32 v58, v58, s28, v9
    v_mbcnt_lo_u32_b32 v107, -1, 0
    v_mfma_f32_16x16x32_bf16 v[160:163], a[212:215], v[22:25], v[160:163]
    v_mbcnt_hi_u32_b32 v107, -1, v107
    v_fma_f32 v64, v64, s28, v10
    v_mfma_f32_16x16x32_bf16 v[208:211], a[212:215], v[28:31], v[208:211]
    v_fma_f32 v67, v67, s28, v10
    v_fma_f32 v82, v82, s28, v12
    v_mfma_f32_16x16x32_bf16 a[0:3], a[212:215], v[34:37], a[0:3]
    ds_read_b64_tr_b16 a[234:235], v3 offset:13312
    v_fma_f32 v70, v70, s28, v11
    s_waitcnt lgkmcnt(5)
    v_mfma_f32_16x16x32_bf16 a[4:7], a[216:219], v[34:37], a[4:7]
    ds_read_b64_tr_b16 a[230:231], v2 offset:13312
    v_and_b32 v106, 15, v107
    v_mfma_f32_16x16x32_bf16 v[212:215], a[216:219], v[28:31], v[212:215]
    ds_read_b64_tr_b16 a[228:229], v2 offset:19456
    v_mul_u32_u24 v106, 384, v106
    v_mfma_f32_16x16x32_bf16 v[164:167], a[216:219], v[22:25], v[164:167]
    s_add_u32 s39, s39, 12288
    v_fma_f32 v65, v65, s28, v10
    v_lshrrev_b32 v107, 4, v107
    v_mfma_f32_16x16x32_bf16 v[116:119], a[216:219], v[16:19], v[116:119]
    ds_read_b64_tr_b16 a[214:215], v4 offset:13312
    s_waitcnt lgkmcnt(6)
    v_mfma_f32_16x16x32_bf16 v[120:123], a[220:223], v[16:19], v[120:123]
    ds_read_b64_tr_b16 a[232:233], v3 offset:19456
    v_lshl_add_u32 v106, v107, 4, v106
    v_mfma_f32_16x16x32_bf16 v[168:171], a[220:223], v[22:25], v[168:171]
    s_add_u32 s48, s33, 24576
    ds_read_b64_tr_b16 a[212:213], v4 offset:19456
    v_fma_f32 v56, v56, s28, v9
    v_mfma_f32_16x16x32_bf16 v[216:219], a[220:223], v[28:31], v[216:219]
    buffer_load_dwordx4 a[208:211], v106, s[12:15], s48 offen offset:256 nt
    v_mfma_f32_16x16x32_bf16 a[8:11], a[220:223], v[34:37], a[8:11]
    s_waitcnt lgkmcnt(6)
    ds_read_b64_tr_b16 a[216:217], v5 offset:19456
    v_fma_f32 v68, v68, s28, v11
    v_mfma_f32_16x16x32_bf16 a[12:15], a[224:227], v[34:37], a[12:15]
    buffer_load_dwordx4 v[92:95], v106, s[12:15], s48 offen offset:320 nt
    v_fma_f32 v77, v77, s28, v12
    v_mfma_f32_16x16x32_bf16 v[220:223], a[224:227], v[28:31], v[220:223]
    v_exp_f32 v64, v64
    v_mfma_f32_16x16x32_bf16 v[172:175], a[224:227], v[22:25], v[172:175]
    ds_read_b64_tr_b16 a[222:223], v2 offset:14336
    v_fma_f32 v69, v69, s28, v11
    v_mfma_f32_16x16x32_bf16 v[124:127], a[224:227], v[16:19], v[124:127]
    s_waitcnt lgkmcnt(5)
    ds_read_b64_tr_b16 a[218:219], v5 offset:13312
    v_fma_f32 v79, v79, s28, v12
    v_mfma_f32_16x16x32_bf16 v[128:131], a[228:231], v[16:19], v[128:131]
    ds_read_b64_tr_b16 a[224:225], v3 offset:20480
    v_fma_f32 v76, v76, s28, v12
    v_mfma_f32_16x16x32_bf16 v[176:179], a[228:231], v[22:25], v[176:179]
    v_exp_f32 v56, v56
    v_mfma_f32_16x16x32_bf16 v[224:227], a[228:231], v[28:31], v[224:227]
    ds_read_b128 v[88:91], v103 offset:0
    v_fma_f32 v63, v63, s28, v10
    v_mfma_f32_16x16x32_bf16 a[16:19], a[228:231], v[34:37], a[16:19]
    s_waitcnt lgkmcnt(5)
    ds_read_b64_tr_b16 a[226:227], v3 offset:14336
    v_fma_f32 v71, v71, s28, v11
    v_mfma_f32_16x16x32_bf16 a[20:23], a[232:235], v[34:37], a[20:23]
    ds_read_b64_tr_b16 a[220:221], v2 offset:20480
    v_fma_f32 v66, v66, s28, v10
    v_mfma_f32_16x16x32_bf16 v[228:231], a[232:235], v[28:31], v[228:231]
    ds_read_b64_tr_b16 a[230:231], v4 offset:14336
    v_fma_f32 v78, v78, s28, v12
    v_mfma_f32_16x16x32_bf16 v[180:183], a[232:235], v[22:25], v[180:183]
    ds_read_b64_tr_b16 a[228:229], v4 offset:20480
    v_fma_f32 v62, v62, s28, v10
    v_mfma_f32_16x16x32_bf16 v[132:135], a[232:235], v[16:19], v[132:135]
    ds_read_b64_tr_b16 a[232:233], v5 offset:20480
    v_fma_f32 v74, v74, s28, v11
    v_mfma_f32_16x16x32_bf16 v[136:139], a[212:215], v[16:19], v[136:139]
    ds_read_b64_tr_b16 a[234:235], v5 offset:14336
    v_fma_f32 v75, v75, s28, v11
    v_mfma_f32_16x16x32_bf16 v[184:187], a[212:215], v[22:25], v[184:187]
    v_exp_f32 v76, v76
    v_mfma_f32_16x16x32_bf16 v[232:235], a[212:215], v[28:31], v[232:235]
    v_exp_f32 v77, v77
    v_mfma_f32_16x16x32_bf16 a[24:27], a[212:215], v[34:37], a[24:27]
    s_waitcnt lgkmcnt(7)
    v_exp_f32 v63, v63
    v_mfma_f32_16x16x32_bf16 a[28:31], a[216:219], v[34:37], a[28:31]
    ds_read_b128 v[96:99], v103 offset:1024
    v_fma_f32 v59, v59, s28, v9
    v_mfma_f32_16x16x32_bf16 v[236:239], a[216:219], v[28:31], v[236:239]
    v_exp_f32 v75, v75
    v_mfma_f32_16x16x32_bf16 v[188:191], a[216:219], v[22:25], v[188:191]
    v_exp_f32 v68, v68
    v_mfma_f32_16x16x32_bf16 v[140:143], a[216:219], v[16:19], v[140:143]
    s_waitcnt lgkmcnt(4)
    v_exp_f32 v62, v62
    v_mfma_f32_16x16x32_bf16 v[144:147], a[220:223], v[16:19], v[144:147]
    v_exp_f32 v65, v65
    v_mfma_f32_16x16x32_bf16 v[192:195], a[220:223], v[22:25], v[192:195]
    v_exp_f32 v74, v74
    v_mfma_f32_16x16x32_bf16 v[240:243], a[220:223], v[28:31], v[240:243]
    s_waitcnt vmcnt(12) lgkmcnt(1)
    v_fma_f32 v80, v80, s28, v12
    s_add_u32 m0, s22, 36864
    v_mfma_f32_16x16x32_bf16 a[32:35], a[220:223], v[34:37], a[32:35]
    s_barrier
    v_mfma_f32_16x16x32_bf16 a[36:39], a[224:227], v[34:37], a[36:39]
    buffer_load_dwordx4 v6, s[8:11], s21 offen lds
    v_mfma_f32_16x16x32_bf16 v[244:247], a[224:227], v[28:31], v[244:247]
    s_add_u32 s21, s21, 128
    ds_read_b128 a[212:215], v0 offset:12288
    v_cvt_pk_bf16_f32 v21, v62, v63
    v_mfma_f32_16x16x32_bf16 v[196:199], a[224:227], v[22:25], v[196:199]
    ds_read_b128 a[216:219], v1 offset:12288
    v_fma_f32 v81, v81, s28, v12
    v_mfma_f32_16x16x32_bf16 v[148:151], a[224:227], v[16:19], v[148:151]
    s_add_u32 m0, s22, 37888
    v_exp_f32 v69, v69
    v_mfma_f32_16x16x32_bf16 v[152:155], a[228:231], v[16:19], v[152:155]
    buffer_load_dwordx4 v6, s[8:11], s21 offen lds
    v_mfma_f32_16x16x32_bf16 v[200:203], a[228:231], v[22:25], v[200:203]
    s_add_u32 s21, s21, 128
    ds_read_b128 a[220:223], v0 offset:13312
    v_cvt_pk_bf16_f32 v26, v68, v69
    v_mfma_f32_16x16x32_bf16 v[248:251], a[228:231], v[28:31], v[248:251]
    v_exp_f32 v71, v71
    v_mfma_f32_16x16x32_bf16 a[40:43], a[228:231], v[34:37], a[40:43]
    v_exp_f32 v67, v67
    v_mfma_f32_16x16x32_bf16 a[44:47], a[232:235], v[34:37], a[44:47]
    s_add_u32 m0, s22, 38912
    v_exp_f32 v70, v70
    v_mfma_f32_16x16x32_bf16 v[252:255], a[232:235], v[28:31], v[252:255]
    buffer_load_dwordx4 v6, s[8:11], s21 offen lds
    v_mfma_f32_16x16x32_bf16 v[204:207], a[232:235], v[22:25], v[204:207]
    buffer_store_dwordx4 v[88:91], v6, s[16:19], s24 offen offset:0 nt
    ds_read_b128 a[224:227], v1 offset:13312
    v_exp_f32 v66, v66
    v_mfma_f32_16x16x32_bf16 v[156:159], a[232:235], v[16:19], v[156:159]
    s_waitcnt lgkmcnt(2)
    ds_read_b128 a[228:231], v0 offset:14336
    v_fma_f32 v57, v57, s28, v9
    v_mfma_f32_16x16x32_bf16 v[52:55], a[212:215], a[96:99], 0
    buffer_store_dwordx4 v[96:99], v7, s[16:19], s24 offen offset:0 nt
    s_add_u32 s21, s21, 12032
    ds_read_b128 a[232:235], v1 offset:14336
    v_exp_f32 v57, v57
    v_mfma_f32_16x16x32_bf16 v[52:55], a[216:219], a[100:103], v[52:55]
    s_waitcnt lgkmcnt(3)
    v_exp_f32 v78, v78
    v_mfma_f32_16x16x32_bf16 v[52:55], a[220:223], a[104:107], v[52:55]
    v_cvt_pk_bf16_f32 v23, v66, v67
    v_cvt_pk_bf16_f32 v27, v70, v71
    v_mfma_f32_16x16x32_bf16 v[60:63], a[220:223], a[128:131], 0
    v_exp_f32 v79, v79
    v_mfma_f32_16x16x32_bf16 v[60:63], a[216:219], a[124:127], v[60:63]
    ds_read_b128 v[84:87], v103 offset:2048
    v_fma_f32 v83, v83, s28, v12
    v_mfma_f32_16x16x32_bf16 v[60:63], a[212:215], a[120:123], v[60:63]
    v_cvt_pk_bf16_f32 v33, v78, v79
    s_add_u32 m0, s38, 24576
    v_mfma_f32_16x16x32_bf16 v[68:71], a[212:215], a[144:147], 0
    v_cvt_pk_bf16_f32 v22, v64, v65
    v_cvt_pk_bf16_f32 v16, v56, v57
    v_mfma_f32_16x16x32_bf16 v[68:71], a[216:219], a[148:151], v[68:71]
    v_cvt_pk_bf16_f32 v32, v76, v77
    v_fma_f32 v72, v72, s28, v11
    v_mfma_f32_16x16x32_bf16 v[68:71], a[220:223], a[152:155], v[68:71]
    v_exp_f32 v59, v59
    v_mfma_f32_16x16x32_bf16 v[76:79], a[220:223], a[176:179], 0
    v_exp_f32 v82, v82
    v_mfma_f32_16x16x32_bf16 v[76:79], a[216:219], a[172:175], v[76:79]
    v_exp_f32 v58, v58
    v_mfma_f32_16x16x32_bf16 v[76:79], a[212:215], a[168:171], v[76:79]
    s_waitcnt lgkmcnt(1)
    v_exp_f32 v83, v83
    v_mfma_f32_16x16x32_bf16 v[76:79], a[224:227], a[180:183], v[76:79]
    v_exp_f32 v81, v81
    v_mfma_f32_16x16x32_bf16 v[76:79], a[228:231], a[184:187], v[76:79]
    ds_read_b128 a[216:219], v1 offset:18432
    v_fma_f32 v73, v73, s28, v11
    v_mfma_f32_16x16x32_bf16 v[76:79], a[232:235], a[188:191], v[76:79]
    buffer_load_dwordx4 v6, s[12:15], s25 offen nt lds
    v_mfma_f32_16x16x32_bf16 v[68:71], a[232:235], a[164:167], v[68:71]
    s_add_u32 m0, s38, 25600
    ds_read_b128 v[88:91], v103 offset:3072
    v_mfma_f32_16x16x32_bf16 v[68:71], a[228:231], a[160:163], v[68:71]
    v_exp_f32 v80, v80
    v_mfma_f32_16x16x32_bf16 v[68:71], a[224:227], a[156:159], v[68:71]
    ds_read_b128 a[212:215], v0 offset:18432
    v_cvt_pk_bf16_f32 v34, v80, v81
    v_mfma_f32_16x16x32_bf16 v[60:63], a[224:227], a[132:135], v[60:63]
    ds_read_b128 a[220:223], v0 offset:19456
    v_cvt_pk_bf16_f32 v29, v74, v75
    v_mfma_f32_16x16x32_bf16 v[60:63], a[228:231], a[136:139], v[60:63]
    v_exp_f32 v72, v72
    v_mfma_f32_16x16x32_bf16 v[60:63], a[232:235], a[140:143], v[60:63]
    buffer_load_dwordx4 v7, s[12:15], s25 offen nt lds
    v_mfma_f32_16x16x32_bf16 v[52:55], a[232:235], a[116:119], v[52:55]
    v_exp_f32 v73, v73
    v_mfma_f32_16x16x32_bf16 v[52:55], a[228:231], a[112:115], v[52:55]
    ds_read_b128 a[232:235], v1 offset:20480
    v_cvt_pk_bf16_f32 v17, v58, v59
    v_mfma_f32_16x16x32_bf16 v[52:55], a[224:227], a[108:111], v[52:55]
    s_add_u32 s57, s24, 128
    ds_read_b128 a[228:231], v0 offset:20480
    s_add_u32 s59, s25, 128
    v_mfma_f32_16x16x32_bf16 v[44:47], a[236:239], v[14:17], v[48:51]
    s_add_u32 m0, s38, 26624
    ds_read_b128 a[224:227], v1 offset:19456
    v_cvt_pk_bf16_f32 v28, v72, v73
    v_mfma_f32_16x16x32_bf16 v[44:47], a[240:243], v[20:23], v[44:47]
    v_cvt_pk_bf16_f32 v35, v82, v83
    v_mfma_f32_16x16x32_bf16 v[44:47], a[244:247], v[26:29], v[44:47]
    s_nop 0
    v_mfma_f32_16x16x32_bf16 v[44:47], a[248:251], v[32:35], v[44:47]
    s_waitcnt lgkmcnt(4)
    v_mfma_f32_16x16x32_bf16 v[56:59], a[212:215], a[96:99], 0
    buffer_load_dwordx4 v6, s[12:15], s59 offen nt lds
    v_mfma_f32_16x16x32_bf16 v[56:59], a[216:219], a[100:103], v[56:59]
    s_waitcnt lgkmcnt(3)
    v_mfma_f32_16x16x32_bf16 v[56:59], a[220:223], a[104:107], v[56:59]
    v_mfma_f32_16x16x32_bf16 v[64:67], a[220:223], a[128:131], 0
    s_nop 0
    v_cmp_lt_f32 vcc, s29, v44
    s_add_u32 m0, s38, 27648
    v_mfma_f32_16x16x32_bf16 v[64:67], a[216:219], a[124:127], v[64:67]
    buffer_load_dwordx4 v7, s[12:15], s59 offen nt lds
    v_mfma_f32_16x16x32_bf16 v[64:67], a[212:215], a[120:123], v[64:67]
    buffer_store_dwordx4 v[84:87], v6, s[16:19], s57 offen offset:0 nt
    s_waitcnt vmcnt(15) lgkmcnt(0)
    s_cbranch_vccnz L_rs_tr45a
L_ret_tr45a:
    v_fma_f32 v61, v61, s28, v10
    s_add_u32 m0, s22, 12288
    v_mfma_f32_16x16x32_bf16 v[72:75], a[212:215], a[144:147], 0
    s_barrier
    v_mfma_f32_16x16x32_bf16 v[72:75], a[216:219], a[148:151], v[72:75]
    buffer_load_dwordx4 v6, s[4:7], s20 offen lds
    v_mfma_f32_16x16x32_bf16 v[72:75], a[220:223], a[152:155], v[72:75]
    s_add_u32 s20, s20, 128
    v_fma_f32 v52, v52, s28, v9
    v_fma_f32 v53, v53, s28, v9
    v_mfma_f32_16x16x32_bf16 v[80:83], a[220:223], a[176:179], 0
    s_add_u32 m0, s22, 13312
    v_exp_f32 v52, v52
    v_mfma_f32_16x16x32_bf16 v[80:83], a[216:219], a[172:175], v[80:83]
    buffer_load_dwordx4 v6, s[4:7], s20 offen lds
    v_mfma_f32_16x16x32_bf16 v[80:83], a[212:215], a[168:171], v[80:83]
    s_add_u32 s20, s20, 128
    v_exp_f32 v61, v61
    v_mfma_f32_16x16x32_bf16 v[80:83], a[224:227], a[180:183], v[80:83]
    s_add_u32 m0, s22, 14336
    ds_read_b64_tr_b16 a[212:213], v2 offset:0
    v_fma_f32 v54, v54, s28, v9
    v_mfma_f32_16x16x32_bf16 v[80:83], a[228:231], a[184:187], v[80:83]
    buffer_load_dwordx4 v6, s[4:7], s20 offen lds
    v_mfma_f32_16x16x32_bf16 v[80:83], a[232:235], a[188:191], v[80:83]
    ds_read_b64_tr_b16 a[214:215], v2 offset:6144
    v_mfma_f32_16x16x32_bf16 v[72:75], a[232:235], a[164:167], v[72:75]
    ds_read_b64_tr_b16 a[216:217], v3 offset:0
    v_fma_f32 v55, v55, s28, v9
    v_mfma_f32_16x16x32_bf16 v[72:75], a[228:231], a[160:163], v[72:75]
    ds_read_b64_tr_b16 a[218:219], v3 offset:6144
    v_fma_f32 v60, v60, s28, v10
    v_mfma_f32_16x16x32_bf16 v[72:75], a[224:227], a[156:159], v[72:75]
    v_exp_f32 v60, v60
    v_mfma_f32_16x16x32_bf16 v[64:67], a[224:227], a[132:135], v[64:67]
    v_exp_f32 v55, v55
    v_mfma_f32_16x16x32_bf16 v[64:67], a[228:231], a[136:139], v[64:67]
    ds_read_b64_tr_b16 a[220:221], v4 offset:0
    v_cvt_pk_bf16_f32 v24, v60, v61
    v_mfma_f32_16x16x32_bf16 v[64:67], a[232:235], a[140:143], v[64:67]
    v_exp_f32 v54, v54
    v_mfma_f32_16x16x32_bf16 v[56:59], a[232:235], a[116:119], v[56:59]
    v_exp_f32 v53, v53
    v_mfma_f32_16x16x32_bf16 v[56:59], a[228:231], a[112:115], v[56:59]
    ds_read_b64_tr_b16 a[222:223], v4 offset:6144
    v_cvt_pk_bf16_f32 v19, v54, v55
    v_mfma_f32_16x16x32_bf16 v[56:59], a[224:227], a[108:111], v[56:59]
    buffer_store_dwordx4 v[88:91], v7, s[16:19], s57 offen offset:0 nt
    s_waitcnt lgkmcnt(4)
    s_add_u32 s20, s20, 12032
    ds_read_b64_tr_b16 a[224:225], v5 offset:0
    ds_read_b64_tr_b16 a[226:227], v5 offset:6144
    v_cvt_pk_bf16_f32 v18, v52, v53
    v_fma_f32 v81, v81, s28, v12
    v_mfma_f32_16x16x32_bf16 v[112:115], a[212:215], v[14:17], v[112:115]
    ds_read_b64_tr_b16 a[230:231], v2 offset:7168
    v_fma_f32 v65, v65, s28, v10
    v_mfma_f32_16x16x32_bf16 v[160:163], a[212:215], v[20:23], v[160:163]
    ds_read_b64_tr_b16 a[228:229], v2 offset:1024
    v_fma_f32 v57, v57, s28, v9
    v_mfma_f32_16x16x32_bf16 v[208:211], a[212:215], v[26:29], v[208:211]
    v_fma_f32 v77, v77, s28, v12
    v_fma_f32 v59, v59, s28, v9
    v_fma_f32 v72, v72, s28, v11
    v_fma_f32 v71, v71, s28, v11
    v_mfma_f32_16x16x32_bf16 a[0:3], a[212:215], v[32:35], a[0:3]
    s_waitcnt lgkmcnt(6)
    ds_read_b64_tr_b16 a[234:235], v3 offset:7168
    v_fma_f32 v82, v82, s28, v12
    v_mfma_f32_16x16x32_bf16 a[4:7], a[216:219], v[32:35], a[4:7]
    v_exp_f32 v59, v59
    v_mfma_f32_16x16x32_bf16 v[212:215], a[216:219], v[26:29], v[212:215]
    v_exp_f32 v77, v77
    v_mfma_f32_16x16x32_bf16 v[164:167], a[216:219], v[20:23], v[164:167]
    v_fma_f32 v78, v78, s28, v12
    v_fma_f32 v63, v63, s28, v10
    v_mfma_f32_16x16x32_bf16 v[116:119], a[216:219], v[14:17], v[116:119]
    s_waitcnt lgkmcnt(5)
    ds_read_b64_tr_b16 a[212:213], v4 offset:1024
    v_and_b32 v104, 0x3ff, v0
    v_mfma_f32_16x16x32_bf16 v[120:123], a[220:223], v[14:17], v[120:123]
    ds_read_b64_tr_b16 a[232:233], v3 offset:1024
    v_lshrrev_b32 v105, 11, v0
    v_mfma_f32_16x16x32_bf16 v[168:171], a[220:223], v[20:23], v[168:171]
    v_exp_f32 v71, v71
    v_mfma_f32_16x16x32_bf16 v[216:219], a[220:223], v[26:29], v[216:219]
    ds_read_b64_tr_b16 a[216:217], v5 offset:1024
    v_fma_f32 v76, v76, s28, v12
    v_mfma_f32_16x16x32_bf16 a[8:11], a[220:223], v[32:35], a[8:11]
    s_waitcnt lgkmcnt(4)
    ds_read_b64_tr_b16 a[214:215], v4 offset:7168
    v_fma_f32 v73, v73, s28, v11
    v_mfma_f32_16x16x32_bf16 a[12:15], a[224:227], v[32:35], a[12:15]
    v_exp_f32 v78, v78
    v_mfma_f32_16x16x32_bf16 v[220:223], a[224:227], v[26:29], v[220:223]
    v_exp_f32 v65, v65
    v_mfma_f32_16x16x32_bf16 v[172:175], a[224:227], v[20:23], v[172:175]
    ds_read_b64_tr_b16 a[218:219], v5 offset:7168
    v_xor_b32 v105, s65, v105
    v_mfma_f32_16x16x32_bf16 v[124:127], a[224:227], v[14:17], v[124:127]
    ds_read_b64_tr_b16 a[226:227], v3 offset:8192
    v_fma_f32 v56, v56, s28, v9
    v_mfma_f32_16x16x32_bf16 v[128:131], a[228:231], v[14:17], v[128:131]
    ds_read_b64_tr_b16 a[220:221], v2 offset:2048
    v_fma_f32 v69, v69, s28, v11
    v_mfma_f32_16x16x32_bf16 v[176:179], a[228:231], v[20:23], v[176:179]
    ds_read_b64_tr_b16 a[222:223], v2 offset:8192
    v_mfma_f32_16x16x32_bf16 v[224:227], a[228:231], v[26:29], v[224:227]
    v_exp_f32 v63, v63
    v_mfma_f32_16x16x32_bf16 a[16:19], a[228:231], v[32:35], a[16:19]
    s_waitcnt lgkmcnt(6)
    ds_read_b64_tr_b16 a[230:231], v4 offset:8192
    v_lshl_add_u32 v104, v105, 10, v104
    v_mfma_f32_16x16x32_bf16 a[20:23], a[232:235], v[32:35], a[20:23]
    v_fma_f32 v83, v83, s28, v12
    v_fma_f32 v64, v64, s28, v10
    v_mfma_f32_16x16x32_bf16 v[228:231], a[232:235], v[26:29], v[228:231]
    ds_read_b64_tr_b16 a[228:229], v4 offset:2048
    v_fma_f32 v79, v79, s28, v12
    v_mfma_f32_16x16x32_bf16 v[180:183], a[232:235], v[20:23], v[180:183]
    ds_read_b64_tr_b16 a[224:225], v3 offset:2048
    v_add_u32 v104, s38, v104
    v_mfma_f32_16x16x32_bf16 v[132:135], a[232:235], v[14:17], v[132:135]
    s_waitcnt lgkmcnt(7)
    ds_read_b64_tr_b16 a[234:235], v5 offset:8192
    v_fma_f32 v67, v67, s28, v10
    v_mfma_f32_16x16x32_bf16 v[136:139], a[212:215], v[14:17], v[136:139]
    ds_read_b64_tr_b16 a[232:233], v5 offset:2048
    v_xor_b32 v105, 64, v104
    v_mfma_f32_16x16x32_bf16 v[184:187], a[212:215], v[20:23], v[184:187]
    s_add_u32 s39, s39, 12288
    v_exp_f32 v79, v79
    v_mfma_f32_16x16x32_bf16 v[232:235], a[212:215], v[26:29], v[232:235]
    ds_read_b128 a[168:171], v104 offset:18432
    v_fma_f32 v62, v62, s28, v10
    v_mfma_f32_16x16x32_bf16 a[24:27], a[212:215], v[32:35], a[24:27]
    s_waitcnt lgkmcnt(6)
    ds_read_b128 a[100:103], v105 offset:0
    v_fma_f32 v80, v80, s28, v12
    v_mfma_f32_16x16x32_bf16 a[28:31], a[216:219], v[32:35], a[28:31]
    ds_read_b128 a[172:175], v105 offset:18432
    v_exp_f32 v57, v57
    v_mfma_f32_16x16x32_bf16 v[236:239], a[216:219], v[26:29], v[236:239]
    v_exp_f32 v62, v62
    v_mfma_f32_16x16x32_bf16 v[188:191], a[216:219], v[20:23], v[188:191]
    ds_read_b128 a[128:131], v104 offset:8192
    v_fma_f32 v68, v68, s28, v11
    v_mfma_f32_16x16x32_bf16 v[140:143], a[216:219], v[14:17], v[140:143]
    ds_read_b128 a[132:135], v105 offset:8192
    v_cvt_pk_bf16_f32 v37, v78, v79
    v_mfma_f32_16x16x32_bf16 v[144:147], a[220:223], v[14:17], v[144:147]
    ds_read_b128 a[152:155], v104 offset:14336
    v_fma_f32 v70, v70, s28, v11
    v_exp_f32 v70, v70
    v_mfma_f32_16x16x32_bf16 v[192:195], a[220:223], v[20:23], v[192:195]
    s_waitcnt vmcnt(16) lgkmcnt(6)
    ds_read_b128 a[148:151], v105 offset:12288
    v_cvt_pk_bf16_f32 v25, v62, v63
    v_mfma_f32_16x16x32_bf16 v[240:243], a[220:223], v[26:29], v[240:243]
    s_add_u32 s21, s21, s62
    v_exp_f32 v68, v68
    v_mfma_f32_16x16x32_bf16 a[32:35], a[220:223], v[32:35], a[32:35]
    s_barrier
    ds_read_b128 a[212:215], v0 offset:0
    v_mfma_f32_16x16x32_bf16 a[36:39], a[224:227], v[32:35], a[36:39]
    s_add_u32 m0, s22, 24576
    ds_read_b128 a[120:123], v104 offset:6144
    buffer_load_dwordx4 v6, s[8:11], s21 offen lds
    v_mfma_f32_16x16x32_bf16 v[244:247], a[224:227], v[26:29], v[244:247]
    s_add_u32 s21, s21, 128
    ds_read_b128 a[96:99], v104 offset:0
    v_fma_f32 v74, v74, s28, v11
    v_mfma_f32_16x16x32_bf16 v[196:199], a[224:227], v[20:23], v[196:199]
    s_add_u32 m0, s22, 25600
    ds_read_b128 a[144:147], v104 offset:12288
    buffer_load_dwordx4 v6, s[8:11], s21 offen lds
    v_mfma_f32_16x16x32_bf16 v[148:151], a[224:227], v[14:17], v[148:151]
    ds_read_b128 a[216:219], v1 offset:0
    s_add_u32 s21, s21, 128
    v_mfma_f32_16x16x32_bf16 v[152:155], a[228:231], v[14:17], v[152:155]
    s_add_u32 m0, s22, 26624
    ds_read_b128 a[176:179], v104 offset:20480
    buffer_load_dwordx4 v6, s[8:11], s21 offen lds
    v_mfma_f32_16x16x32_bf16 v[200:203], a[228:231], v[20:23], v[200:203]
    s_add_u32 s21, s21, 12032
    s_waitcnt vmcnt(10)
    ds_read_b128 a[192:195], v104 offset:24576
    v_mfma_f32_16x16x32_bf16 v[248:251], a[228:231], v[26:29], v[248:251]
    ds_read_b128 a[124:127], v105 offset:6144
    v_exp_f32 v76, v76
    v_mfma_f32_16x16x32_bf16 a[40:43], a[228:231], v[32:35], a[40:43]
    ds_read_b128 a[220:223], v0 offset:1024
    v_cvt_pk_bf16_f32 v36, v76, v77
    v_mfma_f32_16x16x32_bf16 a[44:47], a[232:235], v[32:35], a[44:47]
    s_waitcnt vmcnt(8)
    ds_read_b128 a[196:199], v105 offset:24576
    v_cvt_pk_bf16_f32 v31, v70, v71
    v_mfma_f32_16x16x32_bf16 v[252:255], a[232:235], v[26:29], v[252:255]
    ds_read_b128 a[160:163], v104 offset:16384
    v_exp_f32 v72, v72
    v_mfma_f32_16x16x32_bf16 v[204:207], a[232:235], v[20:23], v[204:207]
    ds_read_b128 a[204:207], v105 offset:26624
    v_exp_f32 v69, v69
    v_mfma_f32_16x16x32_bf16 v[156:159], a[232:235], v[14:17], v[156:159]
    s_waitcnt lgkmcnt(8)
    ds_read_b128 a[104:107], v104 offset:2048
    v_cvt_pk_bf16_f32 v30, v68, v69
    v_mfma_f32_16x16x32_bf16 v[52:55], a[212:215], a[96:99], 0
    ds_read_b128 a[180:183], v105 offset:20480
    v_fma_f32 v75, v75, s28, v11
    v_mfma_f32_16x16x32_bf16 v[60:63], a[212:215], a[120:123], 0
    ds_read_b128 a[108:111], v105 offset:2048
    v_fma_f32 v58, v58, s28, v9
    v_mfma_f32_16x16x32_bf16 v[68:71], a[212:215], a[144:147], 0
    ds_read_b128 a[200:203], v104 offset:26624
    v_mfma_f32_16x16x32_bf16 v[76:79], a[212:215], a[168:171], 0
    s_waitcnt lgkmcnt(8)
    ds_read_b128 a[224:227], v1 offset:1024
    v_mfma_f32_16x16x32_bf16 v[84:87], a[212:215], a[192:195], 0
    ds_read_b128 a[136:139], v104 offset:10240
    v_exp_f32 v58, v58
    v_mfma_f32_16x16x32_bf16 v[52:55], a[216:219], a[100:103], v[52:55]
    v_exp_f32 v73, v73
    v_mfma_f32_16x16x32_bf16 v[60:63], a[216:219], a[124:127], v[60:63]
    ds_read_b128 a[156:159], v105 offset:14336
    v_cvt_pk_bf16_f32 v17, v58, v59
    v_mfma_f32_16x16x32_bf16 v[68:71], a[216:219], a[148:151], v[68:71]
    v_exp_f32 v56, v56
    v_mfma_f32_16x16x32_bf16 v[76:79], a[216:219], a[172:175], v[76:79]
    s_waitcnt lgkmcnt(7)
    v_exp_f32 v64, v64
    v_mfma_f32_16x16x32_bf16 v[84:87], a[216:219], a[196:199], v[84:87]
    s_waitcnt lgkmcnt(6)
    ds_read_b128 a[228:231], v0 offset:6144
    v_cvt_pk_bf16_f32 v28, v72, v73
    v_mfma_f32_16x16x32_bf16 v[52:55], a[220:223], a[104:107], v[52:55]
    v_fma_f32 v66, v66, s28, v10
    v_cvt_pk_bf16_f32 v16, v56, v57
    v_mfma_f32_16x16x32_bf16 v[60:63], a[220:223], a[128:131], v[60:63]
    ds_read_b128 a[232:235], v1 offset:6144
    v_mfma_f32_16x16x32_bf16 v[68:71], a[220:223], a[152:155], v[68:71]
    v_exp_f32 v80, v80
    v_mfma_f32_16x16x32_bf16 v[76:79], a[220:223], a[176:179], v[76:79]
    v_exp_f32 v67, v67
    v_mfma_f32_16x16x32_bf16 v[48:51], a[236:239], v[16:19], v[44:47]
    s_waitcnt lgkmcnt(3)
    v_exp_f32 v75, v75
    v_mfma_f32_16x16x32_bf16 v[84:87], a[220:223], a[200:203], v[84:87]
    v_exp_f32 v82, v82
    v_mfma_f32_16x16x32_bf16 v[52:55], a[224:227], a[108:111], v[52:55]
    v_exp_f32 v81, v81
    v_mfma_f32_16x16x32_bf16 v[60:63], a[224:227], a[132:135], v[60:63]
    s_waitcnt lgkmcnt(2)
    v_exp_f32 v83, v83
    v_mfma_f32_16x16x32_bf16 v[68:71], a[224:227], a[156:159], v[68:71]
    ds_read_b128 a[220:223], v0 offset:2048
    v_cvt_pk_bf16_f32 v22, v64, v65
    v_mfma_f32_16x16x32_bf16 v[76:79], a[224:227], a[180:183], v[76:79]
    v_exp_f32 v66, v66
    v_mfma_f32_16x16x32_bf16 v[84:87], a[224:227], a[204:207], v[84:87]
    s_waitcnt lgkmcnt(2)
    v_exp_f32 v74, v74
    v_mfma_f32_16x16x32_bf16 v[56:59], a[228:231], a[96:99], 0
    v_cvt_pk_bf16_f32 v23, v66, v67
    v_cvt_pk_bf16_f32 v35, v82, v83
    v_mfma_f32_16x16x32_bf16 v[64:67], a[228:231], a[120:123], 0
    ds_read_b128 a[212:215], v0 offset:7168
    v_cvt_pk_bf16_f32 v29, v74, v75
    v_mfma_f32_16x16x32_bf16 v[48:51], a[240:243], v[22:25], v[48:51]
    ds_read_b128 a[116:119], v105 offset:4096
    v_mfma_f32_16x16x32_bf16 v[72:75], a[228:231], a[144:147], 0
    ds_read_b128 a[184:187], v104 offset:22528
    v_cvt_pk_bf16_f32 v34, v80, v81
    v_mfma_f32_16x16x32_bf16 v[80:83], a[228:231], a[168:171], 0
    v_mfma_f32_16x16x32_bf16 v[48:51], a[244:247], v[28:31], v[48:51]
    ds_read_b128 a[164:167], v105 offset:16384
    v_mfma_f32_16x16x32_bf16 v[48:51], a[248:251], v[34:37], v[48:51]
    ds_read_b128 a[216:219], v1 offset:7168
    v_mfma_f32_16x16x32_bf16 v[88:91], a[228:231], a[192:195], 0
    s_waitcnt lgkmcnt(5)
    ds_read_b128 a[112:115], v104 offset:4096
    v_mfma_f32_16x16x32_bf16 v[56:59], a[232:235], a[100:103], v[56:59]
    ds_read_b128 a[228:231], v0 offset:8192
    v_mfma_f32_16x16x32_bf16 v[64:67], a[232:235], a[124:127], v[64:67]
    ds_read_b128 a[224:227], v1 offset:2048
    v_mfma_f32_16x16x32_bf16 v[72:75], a[232:235], a[148:151], v[72:75]
    ds_read_b128 a[140:143], v105 offset:10240
    v_mfma_f32_16x16x32_bf16 v[80:83], a[232:235], a[172:175], v[80:83]
    ds_read_b128 a[188:191], v105 offset:22528
    v_mfma_f32_16x16x32_bf16 v[88:91], a[232:235], a[196:199], v[88:91]
    s_waitcnt lgkmcnt(8)
    ds_read_b128 a[232:235], v1 offset:8192
    v_cmp_lt_f32 vcc, s29, v48
    v_mfma_f32_16x16x32_bf16 v[56:59], a[212:215], a[104:107], v[56:59]
    v_mfma_f32_16x16x32_bf16 v[64:67], a[212:215], a[128:131], v[64:67]
    v_mfma_f32_16x16x32_bf16 v[72:75], a[212:215], a[152:155], v[72:75]
    s_waitcnt vmcnt(17)
    s_nop 0
    s_cbranch_vccnz L_rs_tr45b
L_ret_tr45b:
    v_mfma_f32_16x16x32_bf16 v[80:83], a[212:215], a[176:179], v[80:83]
    v_and_b32 v101, 0x3ff, v0
    v_lshrrev_b32 v108, 11, v0
    v_mfma_f32_16x16x32_bf16 v[88:91], a[212:215], a[200:203], v[88:91]
    s_waitcnt lgkmcnt(5)
    v_xor_b32 v108, s65, v108
    v_lshl_add_u32 v101, v108, 10, v101
    v_mfma_f32_16x16x32_bf16 v[56:59], a[216:219], a[108:111], v[56:59]
    v_mbcnt_lo_u32_b32 v108, -1, 0
    v_mfma_f32_16x16x32_bf16 v[64:67], a[216:219], a[132:135], v[64:67]
    v_rcp_f32 v102, v49
    v_mfma_f32_16x16x32_bf16 v[72:75], a[216:219], a[156:159], v[72:75]
    v_mbcnt_hi_u32_b32 v108, -1, v108
    v_mfma_f32_16x16x32_bf16 v[80:83], a[216:219], a[180:183], v[80:83]
    s_waitcnt vmcnt(14) lgkmcnt(0)
    v_mfma_f32_16x16x32_bf16 v[88:91], a[216:219], a[204:207], v[88:91]
    s_barrier
    v_mfma_f32_16x16x32_bf16 v[52:55], a[220:223], a[112:115], v[52:55]
    ds_read_b64_tr_b16 a[212:213], v2 offset:18432
    s_add_u32 m0, s22, 0
    v_mfma_f32_16x16x32_bf16 v[60:63], a[220:223], a[136:139], v[60:63]
    buffer_load_dwordx4 v6, s[4:7], s20 offen lds
    v_mfma_f32_16x16x32_bf16 v[68:71], a[220:223], a[160:163], v[68:71]
    s_add_u32 s20, s20, 128
    v_rcp_f32 v50, v50
    v_mfma_f32_16x16x32_bf16 v[76:79], a[220:223], a[184:187], v[76:79]
    v_lshrrev_b32 v108, 1, v108
    s_add_u32 m0, s22, 1024
    v_mfma_f32_16x16x32_bf16 v[84:87], a[220:223], a[208:211], v[84:87]
    buffer_load_dwordx4 v6, s[4:7], s20 offen lds
    v_mfma_f32_16x16x32_bf16 v[52:55], a[224:227], a[116:119], v[52:55]
    s_add_u32 s20, s20, 128
    s_add_u32 m0, s22, 2048
    v_and_b32 v108, 24, v108
    v_mfma_f32_16x16x32_bf16 v[60:63], a[224:227], a[140:143], v[60:63]
    buffer_load_dwordx4 v6, s[4:7], s20 offen lds
    v_mfma_f32_16x16x32_bf16 v[68:71], a[224:227], a[164:167], v[68:71]
    ds_read_b64_tr_b16 a[214:215], v2 offset:12288
    v_add_u32 v101, s38, v101
    v_mfma_f32_16x16x32_bf16 v[76:79], a[224:227], a[188:191], v[76:79]
    v_mov_b32 v100, v48
    v_bfe_u32 v108, s66, v108, 8
    v_mfma_f32_16x16x32_bf16 v[84:87], a[224:227], v[92:95], v[84:87]
    v_rcp_f32 v8, v51
    v_mfma_f32_16x16x32_bf16 v[56:59], a[228:231], a[112:115], v[56:59]
    s_add_u32 s20, s20, 12032
    ds_read_b64_tr_b16 a[216:217], v3 offset:18432
    v_mfma_f32_16x16x32_bf16 v[64:67], a[228:231], a[136:139], v[64:67]
    v_permlane32_swap_b32 v48, v100
    v_mfma_f32_16x16x32_bf16 v[72:75], a[228:231], a[160:163], v[72:75]
    v_mfma_f32_16x16x32_bf16 v[80:83], a[228:231], a[184:187], v[80:83]
    ds_read_b64_tr_b16 a[218:219], v3 offset:12288
    v_xor_b32 v101, v101, v108
    v_mfma_f32_16x16x32_bf16 v[88:91], a[228:231], a[208:211], v[88:91]
    ds_read_b64_tr_b16 a[220:221], v4 offset:18432
    v_mfma_f32_16x16x32_bf16 v[56:59], a[232:235], a[116:119], v[56:59]
    ds_read_b64_tr_b16 a[222:223], v4 offset:12288
    v_mfma_f32_16x16x32_bf16 v[64:67], a[232:235], a[140:143], v[64:67]
    ds_read_b64_tr_b16 a[224:225], v5 offset:18432
    v_mfma_f32_16x16x32_bf16 v[72:75], a[232:235], a[164:167], v[72:75]
    s_waitcnt lgkmcnt(5)
    v_mfma_f32_16x16x32_bf16 v[80:83], a[232:235], a[188:191], v[80:83]
    ds_read_b64_tr_b16 a[226:227], v5 offset:12288
    v_mfma_f32_16x16x32_bf16 v[88:91], a[232:235], v[92:95], v[88:91]
    v_rcp_f32 v48, v48
    v_mfma_f32_16x16x32_bf16 v[112:115], a[212:215], v[16:19], v[112:115]
    ds_read_b64_tr_b16 a[230:231], v2 offset:13312
    v_max3_f32 v98, v68, v69, v70
    v_max3_f32 v99, v76, v77, v78
    v_mfma_f32_16x16x32_bf16 v[160:163], a[212:215], v[22:25], v[160:163]
    s_mov_b32 s67, s34
    v_max3_f32 v97, v60, v61, v62
    v_max3_f32 v96, v52, v53, v54
    v_max3_f32 v98, v98, v71, v72
    v_max3_f32 v97, v97, v63, v64
    v_max3_f32 v99, v99, v79, v80
    v_max3_f32 v96, v96, v55, v56
    v_max3_f32 v99, v99, v81, v82
    v_max3_f32 v97, v97, v65, v66
    v_max_f32 v99, v99, v83
    v_mfma_f32_16x16x32_bf16 v[208:211], a[212:215], v[28:31], v[208:211]
    ds_read_b64_tr_b16 a[232:233], v3 offset:19456
    v_max3_f32 v98, v98, v73, v74
    v_mfma_f32_16x16x32_bf16 a[0:3], a[212:215], v[34:37], a[0:3]
    s_waitcnt lgkmcnt(6)
    ds_read_b64_tr_b16 a[214:215], v4 offset:13312
    v_max_f32 v97, v97, v67
    v_max3_f32 v96, v96, v57, v58
    v_mfma_f32_16x16x32_bf16 a[4:7], a[216:219], v[34:37], a[4:7]
    s_add_u32 s18, s34, 24576
    v_max_f32 v96, v96, v59
    v_max_f32 v98, v98, v75
    v_mfma_f32_16x16x32_bf16 v[212:215], a[216:219], v[28:31], v[212:215]
    s_mov_b32 s34, s33
    ds_read_b64_tr_b16 a[234:235], v3 offset:13312
    v_permlane32_swap_b32 v96, v97
    v_mfma_f32_16x16x32_bf16 v[164:167], a[216:219], v[22:25], v[164:167]
    s_add_u32 s64, s64, s62
    ds_read_b64_tr_b16 a[212:213], v4 offset:19456
    v_max_f32 v96, v96, v97
    v_permlane32_swap_b32 v98, v99
    v_mfma_f32_16x16x32_bf16 v[116:119], a[216:219], v[16:19], v[116:119]
    s_waitcnt lgkmcnt(4)
    ds_read_b64_tr_b16 a[228:229], v2 offset:19456
    v_accvgpr_read_b32 v107, a3
    v_max_f32 v98, v98, v99
    v_mfma_f32_16x16x32_bf16 v[120:123], a[220:223], v[16:19], v[120:123]
    s_add_u32 s64, s64, 196608
    v_permlane16_swap_b32 v96, v98
    v_mfma_f32_16x16x32_bf16 v[168:171], a[220:223], v[22:25], v[168:171]
    s_mov_b32 s39, s64
    v_max_f32 v96, v96, v98
    v_mul_f32_e64 v9, -s28, v96
    v_mfma_f32_16x16x32_bf16 v[216:219], a[220:223], v[28:31], v[216:219]
    s_add_u32 s37, s37, 1
    ds_read_b64_tr_b16 a[218:219], v5 offset:13312
    v_mov_b32 v11, v9
    v_max3_f32 v96, v84, v85, v86
    v_mfma_f32_16x16x32_bf16 a[8:11], a[220:223], v[34:37], a[8:11]
    s_bitcmp1_b32 s63, s37
    v_max3_f32 v96, v96, v87, v88
    v_max3_f32 v96, v96, v89, v90
    v_max_f32 v96, v96, v91
    v_mfma_f32_16x16x32_bf16 a[12:15], a[224:227], v[34:37], a[12:15]
    s_cselect_b32 s62, 4294770688, 0
    v_permlane16_swap_b32 v9, v11
    v_mov_b32 v12, v11
    v_mfma_f32_16x16x32_bf16 v[220:223], a[224:227], v[28:31], v[220:223]
    s_cselect_b32 s42, 0, 325632
    v_mov_b32 v10, v9
    v_mov_b32 v97, v96
    v_mfma_f32_16x16x32_bf16 v[172:175], a[224:227], v[22:25], v[172:175]
    s_add_u32 s35, s35, s42
    ds_read_b64_tr_b16 a[222:223], v2 offset:14336
    v_accvgpr_read_b32 v110, a6
    v_permlane32_swap_b32 v97, v96
    v_max_f32 v96, v96, v97
    v_pk_mul_f32 v[212:213], v[212:213], v[50:51] op_sel_hi:[1,0]
    v_permlane32_swap_b32 v9, v10
    v_mov_b32 v97, v96
    v_mfma_f32_16x16x32_bf16 v[124:127], a[224:227], v[16:19], v[124:127]
    s_waitcnt lgkmcnt(2)
    v_permlane32_swap_b32 v11, v12
    v_mfma_f32_16x16x32_bf16 v[128:131], a[228:231], v[16:19], v[128:131]
    s_lshl_b32 s42, s37, 1
    ds_read_b64_tr_b16 a[216:217], v5 offset:19456
    v_fma_f32 v55, v55, s28, v9
    v_mfma_f32_16x16x32_bf16 v[176:179], a[228:231], v[22:25], v[176:179]
    s_lshr_b32 s42, s31, s42
    ds_read_b64_tr_b16 a[220:221], v2 offset:20480
    v_fma_f32 v67, v67, s28, v10
    v_mfma_f32_16x16x32_bf16 v[224:227], a[228:231], v[28:31], v[224:227]
    s_and_b32 s42, s42, 3
    v_fma_f32 v62, v62, s28, v10
    v_fma_f32 v71, v71, s28, v11
    v_mfma_f32_16x16x32_bf16 a[16:19], a[228:231], v[34:37], a[16:19]
    s_add_u32 s42, s42, s36
    v_permlane16_swap_b32 v97, v96
    v_mfma_f32_16x16x32_bf16 a[20:23], a[232:235], v[34:37], a[20:23]
    s_sub_u32 s43, s42, 3
    v_fma_f32 v61, v61, s28, v10
    s_cmp_ge_u32 s42, 3
    v_mfma_f32_16x16x32_bf16 v[228:231], a[232:235], v[28:31], v[228:231]
    s_cselect_b32 s42, s43, s42
    ds_read_b64_tr_b16 a[228:229], v4 offset:20480
    v_exp_f32 v71, v71
    v_mfma_f32_16x16x32_bf16 v[180:183], a[232:235], v[22:25], v[180:183]
    s_mul_i32 s44, s3, 5
    ds_read_b64_tr_b16 a[230:231], v4 offset:14336
    v_fma_f32 v69, v69, s28, v11
    v_mfma_f32_16x16x32_bf16 v[132:135], a[232:235], v[16:19], v[132:135]
    s_mov_b32 s32, 1
    ds_read_b64_tr_b16 a[224:225], v3 offset:20480
    v_fma_f32 v60, v60, s28, v10
    v_mfma_f32_16x16x32_bf16 v[136:139], a[212:215], v[16:19], v[136:139]
    s_lshl_b32 s43, s3, 2
    v_fma_f32 v76, v76, s28, v12
    v_fma_f32 v56, v56, s28, v9
    v_mfma_f32_16x16x32_bf16 v[184:187], a[212:215], v[22:25], v[184:187]
    s_add_u32 s45, s43, 21
    ds_read_b64_tr_b16 a[226:227], v3 offset:14336
    v_fma_f32 v63, v63, s28, v10
    v_mfma_f32_16x16x32_bf16 v[232:235], a[212:215], v[28:31], v[232:235]
    s_cmp_eq_u32 s3, 0
    ds_read_b64_tr_b16 a[232:233], v5 offset:20480
    v_fma_f32 v75, v75, s28, v11
    v_mfma_f32_16x16x32_bf16 a[24:27], a[212:215], v[34:37], a[24:27]
    s_waitcnt lgkmcnt(5)
    ds_read_b64_tr_b16 a[234:235], v5 offset:14336
    v_exp_f32 v61, v61
    v_mfma_f32_16x16x32_bf16 a[28:31], a[216:219], v[34:37], a[28:31]
    s_cselect_b32 s45, 20, s45
    v_exp_f32 v62, v62
    v_mfma_f32_16x16x32_bf16 v[236:239], a[216:219], v[28:31], v[236:239]
    s_cselect_b32 s33, 1, 0
    v_exp_f32 v60, v60
    v_fma_f32 v59, v59, s28, v9
    v_fma_f32 v52, v52, s28, v9
    v_mfma_f32_16x16x32_bf16 v[188:191], a[216:219], v[22:25], v[188:191]
    s_cmp_eq_u32 s42, 1
    v_max_f32 v96, v96, v97
    v_fma_f32 v68, v68, s28, v11
    v_mfma_f32_16x16x32_bf16 v[140:143], a[216:219], v[16:19], v[140:143]
    s_cselect_b32 s44, s45, s44
    v_fma_f32 v57, v57, s28, v9
    v_fma_f32 v54, v54, s28, v9
    v_mfma_f32_16x16x32_bf16 v[144:147], a[220:223], v[16:19], v[144:147]
    s_cselect_b32 s32, s33, s32
    v_exp_f32 v68, v68
    v_mfma_f32_16x16x32_bf16 v[192:195], a[220:223], v[22:25], v[192:195]
    s_add_u32 s45, s43, 37
    s_cmp_eq_u32 s42, 2
    v_exp_f32 v59, v59
    v_mfma_f32_16x16x32_bf16 v[240:243], a[220:223], v[28:31], v[240:243]
    s_cselect_b32 s44, s45, s44
    v_fma_f32 v65, v65, s28, v10
    v_mul_f32_e64 v13, -s28, v96
    v_mfma_f32_16x16x32_bf16 a[32:35], a[220:223], v[34:37], a[32:35]
    s_waitcnt lgkmcnt(1)
    v_exp_f32 v76, v76
    v_fma_f32 v78, v78, s28, v12
    v_mfma_f32_16x16x32_bf16 a[36:39], a[224:227], v[34:37], a[36:39]
    s_cselect_b32 s32, 0, s32
    v_fma_f32 v70, v70, s28, v11
    v_fma_f32 v53, v53, s28, v9
    v_fma_f32 v90, v90, s28, v13
    s_mul_i32 s44, s44, 6144
    v_fma_f32 v87, v87, s28, v13
    s_add_u32 s33, s35, s44
    v_mfma_f32_16x16x32_bf16 v[244:247], a[224:227], v[28:31], v[244:247]
    s_mul_i32 s42, s32, 6144
    v_exp_f32 v53, v53
    v_mfma_f32_16x16x32_bf16 v[196:199], a[224:227], v[22:25], v[196:199]
    s_add_u32 s42, s42, 24576
    v_exp_f32 v63, v63
    v_mfma_f32_16x16x32_bf16 v[148:151], a[224:227], v[16:19], v[148:151]
    s_add_u32 s42, s42, s33
    v_fma_f32 v86, v86, s28, v13
    v_fma_f32 v79, v79, s28, v12
    s_cmp_ge_u32 s37, 6
    v_fma_f32 v83, v83, s28, v12
    v_mfma_f32_16x16x32_bf16 v[152:155], a[228:231], v[16:19], v[152:155]
    s_cselect_b32 s14, 0, s42
    v_cvt_pk_bf16_f32 v20, v60, v61
    s_add_u32 s24, s67, 256
    s_add_u32 s25, s33, 256
    v_mfma_f32_16x16x32_bf16 v[200:203], a[228:231], v[22:25], v[200:203]
    s_add_u32 s23, s38, 4096
    s_mov_b32 s27, 0x249
    s_mov_b32 s30, 0
    s_waitcnt vmcnt(7) lgkmcnt(0)
    v_exp_f32 v54, v54
    v_mfma_f32_16x16x32_bf16 v[248:251], a[228:231], v[28:31], v[248:251]
    s_barrier
    ds_read_b128 a[212:215], v0 offset:12288
    v_exp_f32 v69, v69
    v_fma_f32 v85, v85, s28, v13
    v_mfma_f32_16x16x32_bf16 a[40:43], a[228:231], v[34:37], a[40:43]
    ds_read_b128 a[216:219], v1 offset:12288
    v_exp_f32 v55, v55
    v_fma_f32 v91, v91, s28, v13
    v_fma_f32 v64, v64, s28, v10
    v_mfma_f32_16x16x32_bf16 a[44:47], a[232:235], v[34:37], a[44:47]
    ds_read_b128 a[220:223], v0 offset:13312
    v_fma_f32 v88, v88, s28, v13
    v_accvgpr_read_b32 v104, a0
    v_fma_f32 v84, v84, s28, v13
    v_exp_f32 v86, v86
    v_exp_f32 v52, v52
    v_mfma_f32_16x16x32_bf16 v[252:255], a[232:235], v[28:31], v[252:255]
    ds_read_b128 a[228:231], v0 offset:14336
    v_fma_f32 v80, v80, s28, v12
    v_cvt_pk_bf16_f32 v21, v62, v63
    v_exp_f32 v79, v79
    v_mfma_f32_16x16x32_bf16 v[204:207], a[232:235], v[22:25], v[204:207]
    s_add_u32 m0, s22, 36864
    v_fma_f32 v77, v77, s28, v12
    v_cvt_pk_bf16_f32 v26, v68, v69
    v_fma_f32 v82, v82, s28, v12
    v_fma_f32 v74, v74, s28, v11
    v_exp_f32 v85, v85
    v_exp_f32 v87, v87
    v_accvgpr_read_b32 v111, a7
    v_fma_f32 v72, v72, s28, v11
    v_cvt_pk_bf16_f32 v14, v52, v53
    v_mfma_f32_16x16x32_bf16 v[156:159], a[232:235], v[16:19], v[156:159]
    s_waitcnt lgkmcnt(3)
    ds_read_b128 a[224:227], v1 offset:13312
    v_cvt_pk_bf16_f32 v15, v54, v55
    v_mfma_f32_16x16x32_bf16 v[52:55], a[212:215], a[96:99], 0
    s_waitcnt lgkmcnt(3)
    v_exp_f32 v77, v77
    v_fma_f32 v66, v66, s28, v10
    v_exp_f32 v84, v84
    v_mfma_f32_16x16x32_bf16 v[52:55], a[216:219], a[100:103], v[52:55]
    s_waitcnt lgkmcnt(2)
    v_exp_f32 v70, v70
    v_mfma_f32_16x16x32_bf16 v[52:55], a[220:223], a[104:107], v[52:55]
    v_exp_f32 v90, v90
    v_cvt_pk_bf16_f32 v27, v70, v71
    v_fma_f32 v58, v58, s28, v9
    v_accvgpr_read_b32 v109, a5
    v_cvt_pk_bf16_f32 v32, v76, v77
    v_cvt_pk_bf16_f32 v39, v86, v87
    v_cvt_pk_bf16_f32 v38, v84, v85
    v_fma_f32 v73, v73, s28, v11
    v_mfma_f32_16x16x32_bf16 v[60:63], a[220:223], a[128:131], 0
    ds_read_b128 a[232:235], v1 offset:14336
    v_accvgpr_read_b32 v105, a1
    v_mfma_f32_16x16x32_bf16 v[60:63], a[216:219], a[124:127], v[60:63]
    v_exp_f32 v82, v82
    v_mfma_f32_16x16x32_bf16 v[60:63], a[212:215], a[120:123], v[60:63]
    buffer_load_dwordx4 v6, s[8:11], s21 offen lds
    v_mfma_f32_16x16x32_bf16 v[68:71], a[212:215], a[144:147], 0
    v_exp_f32 v78, v78
    v_mfma_f32_16x16x32_bf16 v[68:71], a[216:219], a[148:151], v[68:71]
    v_exp_f32 v65, v65
    v_mfma_f32_16x16x32_bf16 v[68:71], a[220:223], a[152:155], v[68:71]
    v_cvt_pk_bf16_f32 v33, v78, v79
    v_fma_f32 v89, v89, s28, v13
    v_mfma_f32_16x16x32_bf16 v[76:79], a[220:223], a[176:179], 0
    v_exp_f32 v64, v64
    v_mfma_f32_16x16x32_bf16 v[76:79], a[216:219], a[172:175], v[76:79]
    s_add_u32 s21, s21, 128
    v_exp_f32 v58, v58
    v_mfma_f32_16x16x32_bf16 v[76:79], a[212:215], a[168:171], v[76:79]
    v_exp_f32 v57, v57
    v_mfma_f32_16x16x32_bf16 v[84:87], a[212:215], a[192:195], 0
    v_subrev_u32 v103, 24576, v103
    v_cvt_pk_bf16_f32 v17, v58, v59
    v_mfma_f32_16x16x32_bf16 v[84:87], a[216:219], a[196:199], v[84:87]
    v_exp_f32 v88, v88
    v_mfma_f32_16x16x32_bf16 v[84:87], a[220:223], a[200:203], v[84:87]
    s_waitcnt lgkmcnt(0)
    v_exp_f32 v91, v91
    v_mfma_f32_16x16x32_bf16 v[84:87], a[224:227], a[204:207], v[84:87]
    v_exp_f32 v66, v66
    v_mfma_f32_16x16x32_bf16 v[84:87], a[228:231], a[208:211], v[84:87]
    v_exp_f32 v80, v80
    v_mfma_f32_16x16x32_bf16 v[84:87], a[232:235], v[92:95], v[84:87]
    v_exp_f32 v73, v73
    v_mfma_f32_16x16x32_bf16 v[76:79], a[232:235], a[188:191], v[76:79]
    v_exp_f32 v67, v67
    v_mfma_f32_16x16x32_bf16 v[76:79], a[228:231], a[184:187], v[76:79]
    ds_read_b128 a[212:215], v0 offset:18432
    v_fma_f32 v81, v81, s28, v12
    v_mfma_f32_16x16x32_bf16 v[76:79], a[224:227], a[180:183], v[76:79]
    ds_read_b128 a[216:219], v1 offset:18432
    v_exp_f32 v72, v72
    v_mfma_f32_16x16x32_bf16 v[68:71], a[224:227], a[156:159], v[68:71]
    v_cvt_pk_bf16_f32 v22, v64, v65
    v_accvgpr_read_b32 v106, a2
    v_mfma_f32_16x16x32_bf16 v[68:71], a[228:231], a[160:163], v[68:71]
    s_add_u32 m0, s22, 37888
    v_exp_f32 v89, v89
    v_mfma_f32_16x16x32_bf16 v[68:71], a[232:235], a[164:167], v[68:71]
    v_exp_f32 v75, v75
    v_mfma_f32_16x16x32_bf16 v[60:63], a[232:235], a[140:143], v[60:63]
    v_exp_f32 v74, v74
    v_mfma_f32_16x16x32_bf16 v[60:63], a[228:231], a[136:139], v[60:63]
    buffer_load_dwordx4 v6, s[8:11], s21 offen lds
    v_mfma_f32_16x16x32_bf16 v[60:63], a[224:227], a[132:135], v[60:63]
    v_exp_f32 v56, v56
    v_mfma_f32_16x16x32_bf16 v[52:55], a[224:227], a[108:111], v[52:55]
    v_exp_f32 v81, v81
    v_mfma_f32_16x16x32_bf16 v[52:55], a[228:231], a[112:115], v[52:55]
    s_add_u32 s21, s21, 128
    ds_read_b128 a[228:231], v0 offset:20480
    v_cvt_pk_bf16_f32 v16, v56, v57
    v_mfma_f32_16x16x32_bf16 v[52:55], a[232:235], a[116:119], v[52:55]
    ds_read_b128 a[220:223], v0 offset:19456
    v_fma_f32 v87, v87, s28, v13
    v_mfma_f32_16x16x32_bf16 v[44:47], a[236:239], v[14:17], 0
    s_waitcnt lgkmcnt(2)
    v_fma_f32 v78, v78, s28, v12
    v_cvt_pk_bf16_f32 v41, v90, v91
    v_mfma_f32_16x16x32_bf16 v[56:59], a[212:215], a[96:99], 0
    v_cvt_pk_bf16_f32 v40, v88, v89
    v_exp_f32 v83, v83
    v_fma_f32 v77, v77, s28, v12
    v_accvgpr_read_b32 v108, a4
    v_pk_mul_f32 v[114:115], v[114:115], v[48:49] op_sel_hi:[1,0]
    v_cvt_pk_bf16_f32 v212, v212, v213
    v_pk_mul_f32 v[216:217], v[216:217], v[50:51] op_sel_hi:[1,0]
    v_pk_mul_f32 v[164:165], v[164:165], v[102:103] op_sel_hi:[1,0]
    v_pk_mul_f32 v[180:181], v[180:181], v[102:103] op_sel_hi:[1,0]
    v_pk_mul_f32 v[220:221], v[220:221], v[50:51] op_sel_hi:[1,0]
    v_pk_mul_f32 v[176:177], v[176:177], v[102:103] op_sel_hi:[1,0]
    v_pk_mul_f32 v[146:147], v[146:147], v[48:49] op_sel_hi:[1,0]
    v_pk_mul_f32 v[128:129], v[128:129], v[48:49] op_sel_hi:[1,0]
    v_pk_mul_f32 v[104:105], v[104:105], v[8:9] op_sel_hi:[1,0]
    v_pk_mul_f32 v[194:195], v[194:195], v[102:103] op_sel_hi:[1,0]
    v_pk_mul_f32 v[214:215], v[214:215], v[50:51] op_sel_hi:[1,0]
    v_pk_mul_f32 v[210:211], v[210:211], v[50:51] op_sel_hi:[1,0]
    v_pk_mul_f32 v[132:133], v[132:133], v[48:49] op_sel_hi:[1,0]
    v_pk_mul_f32 v[162:163], v[162:163], v[102:103] op_sel_hi:[1,0]
    v_pk_mul_f32 v[236:237], v[236:237], v[50:51] op_sel_hi:[1,0]
    v_pk_mul_f32 v[106:107], v[106:107], v[8:9] op_sel_hi:[1,0]
    v_pk_mul_f32 v[218:219], v[218:219], v[50:51] op_sel_hi:[1,0]
    v_pk_mul_f32 v[160:161], v[160:161], v[102:103] op_sel_hi:[1,0]
    v_pk_mul_f32 v[222:223], v[222:223], v[50:51] op_sel_hi:[1,0]
    v_pk_mul_f32 v[198:199], v[198:199], v[102:103] op_sel_hi:[1,0]
    v_pk_mul_f32 v[240:241], v[240:241], v[50:51] op_sel_hi:[1,0]
    v_pk_mul_f32 v[140:141], v[140:141], v[48:49] op_sel_hi:[1,0]
    v_pk_mul_f32 v[166:167], v[166:167], v[102:103] op_sel_hi:[1,0]
    v_pk_mul_f32 v[224:225], v[224:225], v[50:51] op_sel_hi:[1,0]
    v_cvt_pk_bf16_f32 v29, v74, v75
    v_pk_mul_f32 v[112:113], v[112:113], v[48:49] op_sel_hi:[1,0]
    v_pk_mul_f32 v[168:169], v[168:169], v[102:103] op_sel_hi:[1,0]
    v_pk_mul_f32 v[134:135], v[134:135], v[48:49] op_sel_hi:[1,0]
    v_pk_mul_f32 v[144:145], v[144:145], v[48:49] op_sel_hi:[1,0]
    v_cvt_pk_bf16_f32 v180, v180, v181
    v_pk_mul_f32 v[138:139], v[138:139], v[48:49] op_sel_hi:[1,0]
    v_pk_mul_f32 v[186:187], v[186:187], v[102:103] op_sel_hi:[1,0]
    v_pk_mul_f32 v[108:109], v[108:109], v[8:9] op_sel_hi:[1,0]
    v_pk_mul_f32 v[110:111], v[110:111], v[8:9] op_sel_hi:[1,0]
    v_pk_mul_f32 v[188:189], v[188:189], v[102:103] op_sel_hi:[1,0]
    v_cvt_pk_bf16_f32 v28, v72, v73
    v_pk_mul_f32 v[208:209], v[208:209], v[50:51] op_sel_hi:[1,0]
    v_cvt_pk_bf16_f32 v23, v66, v67
    v_cvt_pk_bf16_f32 v240, v240, v241
    v_mfma_f32_16x16x32_bf16 v[56:59], a[216:219], a[100:103], v[56:59]
    s_waitcnt lgkmcnt(0)
    ds_read_b128 a[232:235], v1 offset:20480
    v_fma_f32 v79, v79, s28, v12
    v_mfma_f32_16x16x32_bf16 v[56:59], a[220:223], a[104:107], v[56:59]
    s_add_u32 m0, s22, 38912
    v_cvt_pk_bf16_f32 v104, v104, v105
    v_fma_f32 v55, v55, s28, v9
    v_cvt_pk_bf16_f32 v34, v80, v81
    v_mfma_f32_16x16x32_bf16 v[64:67], a[220:223], a[128:131], 0
    ds_read_b128 a[224:227], v1 offset:19456
    v_cvt_pk_bf16_f32 v108, v108, v109
    v_mfma_f32_16x16x32_bf16 v[64:67], a[216:219], a[124:127], v[64:67]
    v_cvt_pk_bf16_f32 v140, v140, v141
    v_fma_f32 v76, v76, s28, v12
    v_cvt_pk_bf16_f32 v112, v112, v113
    v_mfma_f32_16x16x32_bf16 v[64:67], a[212:215], a[120:123], v[64:67]
    v_cvt_pk_bf16_f32 v35, v82, v83
    v_cvt_pk_bf16_f32 v105, v106, v107
    v_mfma_f32_16x16x32_bf16 v[72:75], a[212:215], a[144:147], 0
    v_fma_f32 v54, v54, s28, v9
    v_accvgpr_read_b32 v106, a10
    v_mfma_f32_16x16x32_bf16 v[72:75], a[216:219], a[148:151], v[72:75]
    v_fma_f32 v52, v52, s28, v9
    v_cvt_pk_bf16_f32 v160, v160, v161
    v_mfma_f32_16x16x32_bf16 v[72:75], a[220:223], a[152:155], v[72:75]
    v_cvt_pk_bf16_f32 v144, v144, v145
    v_fma_f32 v84, v84, s28, v13
    v_fma_f32 v86, v86, s28, v13
    v_mfma_f32_16x16x32_bf16 v[80:83], a[220:223], a[176:179], 0
    v_cvt_pk_bf16_f32 v176, v176, v177
    v_cvt_pk_bf16_f32 v113, v114, v115
    v_mfma_f32_16x16x32_bf16 v[80:83], a[216:219], a[172:175], v[80:83]
    buffer_load_dwordx4 v6, s[8:11], s21 offen lds
    v_mfma_f32_16x16x32_bf16 v[80:83], a[212:215], a[168:171], v[80:83]
    s_add_u32 s21, s21, 12032
    v_cvt_pk_bf16_f32 v164, v164, v165
    v_cvt_pk_bf16_f32 v216, v216, v217
    v_fma_f32 v60, v60, s28, v10
    v_exp_f32 v52, v52
    v_cvt_pk_bf16_f32 v220, v220, v221
    v_pk_mul_f32 v[226:227], v[226:227], v[50:51] op_sel_hi:[1,0]
    v_pk_mul_f32 v[254:255], v[254:255], v[50:51] op_sel_hi:[1,0]
    v_pk_mul_f32 v[116:117], v[116:117], v[48:49] op_sel_hi:[1,0]
    v_pk_mul_f32 v[172:173], v[172:173], v[102:103] op_sel_hi:[1,0]
    v_pk_mul_f32 v[184:185], v[184:185], v[102:103] op_sel_hi:[1,0]
    v_fma_f32 v85, v85, s28, v13
    v_pk_mul_f32 v[252:253], v[252:253], v[50:51] op_sel_hi:[1,0]
    v_pk_mul_f32 v[118:119], v[118:119], v[48:49] op_sel_hi:[1,0]
    v_fma_f32 v63, v63, s28, v10
    v_pk_mul_f32 v[230:231], v[230:231], v[50:51] op_sel_hi:[1,0]
    v_cvt_pk_bf16_f32 v224, v224, v225
    v_pk_mul_f32 v[228:229], v[228:229], v[50:51] op_sel_hi:[1,0]
    v_pk_mul_f32 v[120:121], v[120:121], v[48:49] op_sel_hi:[1,0]
    v_cvt_pk_bf16_f32 v252, v252, v253
    v_cvt_pk_bf16_f32 v161, v162, v163
    v_mfma_f32_16x16x32_bf16 v[88:91], a[212:215], a[192:195], 0
    s_waitcnt vmcnt(6) lgkmcnt(0)
    v_exp_f32 v76, v76
    v_mfma_f32_16x16x32_bf16 v[88:91], a[216:219], a[196:199], v[88:91]
    s_barrier
    v_mfma_f32_16x16x32_bf16 v[88:91], a[220:223], a[200:203], v[88:91]
    ds_read_b64_tr_b16 a[212:213], v2 offset:0
    v_cvt_pk_bf16_f32 v208, v208, v209
    v_exp_f32 v55, v55
    v_mfma_f32_16x16x32_bf16 v[88:91], a[224:227], a[204:207], v[88:91]
    ds_write2st64_b64 v101, v[112:113], v[160:161] offset0:0 offset1:12
    v_mfma_f32_16x16x32_bf16 v[88:91], a[228:231], a[208:211], v[88:91]
    v_exp_f32 v79, v79
    v_mfma_f32_16x16x32_bf16 v[88:91], a[232:235], v[92:95], v[88:91]
    ds_read_b64_tr_b16 a[214:215], v2 offset:6144
    v_fma_f32 v71, v71, s28, v11
    v_cvt_pk_bf16_f32 v188, v188, v189
    v_mfma_f32_16x16x32_bf16 v[80:83], a[232:235], a[188:191], v[80:83]
    s_add_u32 m0, s22, 12288
    v_cvt_pk_bf16_f32 v109, v110, v111
    v_cvt_pk_bf16_f32 v132, v132, v133
    v_cvt_pk_bf16_f32 v165, v166, v167
    v_mfma_f32_16x16x32_bf16 v[80:83], a[228:231], a[184:187], v[80:83]
    buffer_load_dwordx4 v6, s[4:7], s20 offen lds
    v_mfma_f32_16x16x32_bf16 v[80:83], a[224:227], a[180:183], v[80:83]
    v_exp_f32 v87, v87
    v_mfma_f32_16x16x32_bf16 v[72:75], a[224:227], a[156:159], v[72:75]
    v_cvt_pk_bf16_f32 v209, v210, v211
    v_cvt_pk_bf16_f32 v236, v236, v237
    v_exp_f32 v86, v86
    v_mfma_f32_16x16x32_bf16 v[72:75], a[228:231], a[160:163], v[72:75]
    ds_read_b64_tr_b16 a[216:217], v3 offset:0
    v_accvgpr_read_b32 v107, a11
    v_mfma_f32_16x16x32_bf16 v[72:75], a[232:235], a[164:167], v[72:75]
    ds_read_b64_tr_b16 a[218:219], v3 offset:6144
    v_cvt_pk_bf16_f32 v184, v184, v185
    v_mfma_f32_16x16x32_bf16 v[64:67], a[232:235], a[140:143], v[64:67]
    v_exp_f32 v85, v85
    v_mfma_f32_16x16x32_bf16 v[64:67], a[228:231], a[136:139], v[64:67]
    ds_read_b64_tr_b16 a[220:221], v4 offset:0
    v_cvt_pk_bf16_f32 v168, v168, v169
    v_mfma_f32_16x16x32_bf16 v[64:67], a[224:227], a[132:135], v[64:67]
    ds_write2st64_b64 v101, v[208:209], v[104:105] offset0:24 offset1:36
    v_pk_mul_f32 v[122:123], v[122:123], v[48:49] op_sel_hi:[1,0]
    v_pk_mul_f32 v[130:131], v[130:131], v[48:49] op_sel_hi:[1,0]
    v_pk_mul_f32 v[170:171], v[170:171], v[102:103] op_sel_hi:[1,0]
    v_cvt_pk_bf16_f32 v116, v116, v117
    v_accvgpr_read_b32 v104, a8
    v_pk_mul_f32 v[192:193], v[192:193], v[102:103] op_sel_hi:[1,0]
    v_accvgpr_read_b32 v105, a9
    v_accvgpr_read_b32 v110, a14
    v_fma_f32 v62, v62, s28, v10
    v_pk_mul_f32 v[136:137], v[136:137], v[48:49] op_sel_hi:[1,0]
    v_xor_b32 v101, 32, v101
    v_pk_mul_f32 v[104:105], v[104:105], v[8:9] op_sel_hi:[1,0]
    v_fma_f32 v70, v70, s28, v11
    v_pk_mul_f32 v[242:243], v[242:243], v[50:51] op_sel_hi:[1,0]
    v_cvt_pk_bf16_f32 v120, v120, v121
    v_pk_mul_f32 v[190:191], v[190:191], v[102:103] op_sel_hi:[1,0]
    v_cvt_pk_bf16_f32 v104, v104, v105
    v_cvt_pk_bf16_f32 v169, v170, v171
    v_pk_mul_f32 v[148:149], v[148:149], v[48:49] op_sel_hi:[1,0]
    v_exp_f32 v60, v60
    v_pk_mul_f32 v[142:143], v[142:143], v[48:49] op_sel_hi:[1,0]
    v_pk_mul_f32 v[206:207], v[206:207], v[102:103] op_sel_hi:[1,0]
    v_pk_mul_f32 v[182:183], v[182:183], v[102:103] op_sel_hi:[1,0]
    v_cvt_pk_bf16_f32 v192, v192, v193
    v_pk_mul_f32 v[196:197], v[196:197], v[102:103] op_sel_hi:[1,0]
    v_cvt_pk_bf16_f32 v213, v214, v215
    v_pk_mul_f32 v[174:175], v[174:175], v[102:103] op_sel_hi:[1,0]
    v_pk_mul_f32 v[106:107], v[106:107], v[8:9] op_sel_hi:[1,0]
    v_pk_mul_f32 v[232:233], v[232:233], v[50:51] op_sel_hi:[1,0]
    v_accvgpr_read_b32 v111, a15
    v_pk_mul_f32 v[126:127], v[126:127], v[48:49] op_sel_hi:[1,0]
    v_pk_mul_f32 v[124:125], v[124:125], v[48:49] op_sel_hi:[1,0]
    v_fma_f32 v72, v72, s28, v11
    v_pk_mul_f32 v[248:249], v[248:249], v[50:51] op_sel_hi:[1,0]
    v_pk_mul_f32 v[204:205], v[204:205], v[102:103] op_sel_hi:[1,0]
    v_cvt_pk_bf16_f32 v105, v106, v107
    v_cvt_pk_bf16_f32 v128, v128, v129
    v_mfma_f32_16x16x32_bf16 v[56:59], a[224:227], a[108:111], v[56:59]
    v_cvt_pk_bf16_f32 v121, v122, v123
    v_cvt_pk_bf16_f32 v204, v204, v205
    v_mfma_f32_16x16x32_bf16 v[56:59], a[228:231], a[112:115], v[56:59]
    v_cvt_pk_bf16_f32 v172, v172, v173
    v_cvt_pk_bf16_f32 v117, v118, v119
    v_mfma_f32_16x16x32_bf16 v[44:47], a[240:243], v[20:23], v[44:47]
    ds_write2st64_b64 v101, v[116:117], v[164:165] offset0:0 offset1:12
    v_mfma_f32_16x16x32_bf16 v[56:59], a[232:235], a[116:119], v[56:59]
    s_waitcnt lgkmcnt(1)
    ds_read_b64_tr_b16 a[222:223], v4 offset:6144
    v_fma_f32 v69, v69, s28, v11
    v_mfma_f32_16x16x32_bf16 v[112:115], a[212:215], v[14:17], 0
    ds_write2st64_b64 v101, v[212:213], v[108:109] offset0:24 offset1:36
    v_mfma_f32_16x16x32_bf16 v[44:47], a[244:247], v[26:29], v[44:47]
    ds_read_b64_tr_b16 a[228:229], v2 offset:1024
    v_cvt_pk_bf16_f32 v185, v186, v187
    v_mfma_f32_16x16x32_bf16 v[116:119], a[216:219], v[14:17], 0
    s_add_u32 s20, s20, 128
    v_fma_f32 v64, v64, s28, v10
    v_exp_f32 v77, v77
    v_cvt_pk_bf16_f32 v205, v206, v207
    v_cvt_pk_bf16_f32 v196, v196, v197
    v_exp_f32 v62, v62
    v_accvgpr_read_b32 v108, a12
    v_pk_mul_f32 v[156:157], v[156:157], v[48:49] op_sel_hi:[1,0]
    v_accvgpr_read_b32 v109, a13
    v_pk_mul_f32 v[234:235], v[234:235], v[50:51] op_sel_hi:[1,0]
    v_pk_mul_f32 v[152:153], v[152:153], v[48:49] op_sel_hi:[1,0]
    v_fma_f32 v53, v53, s28, v9
    v_pk_mul_f32 v[110:111], v[110:111], v[8:9] op_sel_hi:[1,0]
    v_fma_f32 v56, v56, s28, v9
    v_pk_mul_f32 v[108:109], v[108:109], v[8:9] op_sel_hi:[1,0]
    v_cvt_pk_bf16_f32 v228, v228, v229
    v_pk_mul_f32 v[150:151], v[150:151], v[48:49] op_sel_hi:[1,0]
    v_pk_mul_f32 v[178:179], v[178:179], v[102:103] op_sel_hi:[1,0]
    v_cvt_pk_bf16_f32 v136, v136, v137
    v_pk_mul_f32 v[202:203], v[202:203], v[102:103] op_sel_hi:[1,0]
    v_xor_b32 v101, 96, v101
    v_cvt_pk_bf16_f32 v108, v108, v109
    v_mfma_f32_16x16x32_bf16 v[44:47], a[248:251], v[32:35], v[44:47]
    ds_write2st64_b64 v101, v[120:121], v[168:169] offset0:0 offset1:12
    v_cvt_pk_bf16_f32 v173, v174, v175
    v_pk_mul_f32 v[244:245], v[244:245], v[50:51] op_sel_hi:[1,0]
    v_fma_f32 v83, v83, s28, v12
    v_cvt_pk_bf16_f32 v217, v218, v219
    v_mfma_f32_16x16x32_bf16 v[164:167], a[216:219], v[20:23], 0
    s_add_u32 m0, s22, 13312
    ds_read_b64_tr_b16 a[224:225], v5 offset:0
    v_cvt_pk_bf16_f32 v145, v146, v147
    v_mfma_f32_16x16x32_bf16 v[160:163], a[212:215], v[20:23], 0
    buffer_load_dwordx4 v6, s[4:7], s20 offen lds
    ds_read_b64_tr_b16 a[226:227], v5 offset:6144
    v_accvgpr_read_b32 v107, a19
    v_cvt_pk_bf16_f32 v109, v110, v111
    v_cvt_pk_bf16_f32 v129, v130, v131
    v_accvgpr_read_b32 v106, a18
    v_exp_f32 v70, v70
    v_mfma_f32_16x16x32_bf16 v[208:211], a[212:215], v[26:29], 0
    s_add_u32 s20, s20, 128
    ds_read_b64_tr_b16 a[230:231], v2 offset:7168
    v_cvt_pk_bf16_f32 v225, v226, v227
    v_cvt_pk_bf16_f32 v197, v198, v199
    v_exp_f32 v78, v78
    v_cvt_pk_bf16_f32 v148, v148, v149
    v_mfma_f32_16x16x32_bf16 v[212:215], a[216:219], v[26:29], 0
    v_cvt_pk_bf16_f32 v133, v134, v135
    v_exp_f32 v54, v54
    v_mfma_f32_16x16x32_bf16 a[4:7], a[216:219], v[32:35], 0
    ds_write2st64_b64 v101, v[216:217], v[104:105] offset0:24 offset1:36
    v_accvgpr_read_b32 v110, a22
    v_cvt_pk_bf16_f32 v177, v178, v179
    v_cvt_pk_bf16_f32 v221, v222, v223
    v_xor_b32 v101, 32, v101
    v_pk_mul_f32 v[250:251], v[250:251], v[50:51] op_sel_hi:[1,0]
    v_pk_mul_f32 v[154:155], v[154:155], v[48:49] op_sel_hi:[1,0]
    v_pk_mul_f32 v[200:201], v[200:201], v[102:103] op_sel_hi:[1,0]
    v_cvt_pk_bf16_f32 v37, v78, v79
    v_pk_mul_f32 v[106:107], v[106:107], v[8:9] op_sel_hi:[1,0]
    v_cvt_pk_bf16_f32 v193, v194, v195
    v_fma_f32 v68, v68, s28, v11
    v_cvt_pk_bf16_f32 v124, v124, v125
    v_accvgpr_read_b32 v104, a16
    v_cvt_pk_bf16_f32 v232, v232, v233
    v_mfma_f32_16x16x32_bf16 a[0:3], a[212:215], v[32:35], 0
    ds_read_b64_tr_b16 a[234:235], v3 offset:7168
    v_exp_f32 v71, v71
    v_cvt_pk_bf16_f32 v125, v126, v127
    v_cvt_pk_bf16_f32 v156, v156, v157
    v_mfma_f32_16x16x32_bf16 a[48:51], a[212:215], v[38:41], 0
    ds_write2st64_b64 v101, v[124:125], v[172:173] offset0:0 offset1:12
    v_fma_f32 v59, v59, s28, v9
    v_cvt_pk_bf16_f32 v244, v244, v245
    v_mfma_f32_16x16x32_bf16 a[52:55], a[216:219], v[38:41], 0
    s_waitcnt lgkmcnt(3)
    v_cvt_pk_bf16_f32 v181, v182, v183
    v_fma_f32 v67, v67, s28, v10
    v_mfma_f32_16x16x32_bf16 a[56:59], a[220:223], v[38:41], 0
    v_cvt_pk_bf16_f32 v149, v150, v151
    v_cvt_pk_bf16_f32 v200, v200, v201
    v_mfma_f32_16x16x32_bf16 a[60:63], a[224:227], v[38:41], 0
    s_add_u32 m0, s22, 14336
    ds_read_b64_tr_b16 a[232:233], v3 offset:1024
    buffer_load_dwordx4 v6, s[4:7], s20 offen lds
    v_fma_f32 v88, v88, s28, v13
    v_cvt_pk_bf16_f32 v229, v230, v231
    v_accvgpr_read_b32 v105, a17
    v_pk_mul_f32 v[246:247], v[246:247], v[50:51] op_sel_hi:[1,0]
    v_pk_mul_f32 v[104:105], v[104:105], v[8:9] op_sel_hi:[1,0]
    v_accvgpr_read_b32 v111, a23
    v_fma_f32 v61, v61, s28, v10
    v_mfma_f32_16x16x32_bf16 a[12:15], a[224:227], v[32:35], 0
    ds_write2st64_b64 v101, v[220:221], v[108:109] offset0:24 offset1:36
    v_cvt_pk_bf16_f32 v248, v248, v249
    v_exp_f32 v53, v53
    v_cvt_pk_bf16_f32 v104, v104, v105
    v_exp_f32 v68, v68
    v_pk_mul_f32 v[110:111], v[110:111], v[8:9] op_sel_hi:[1,0]
    v_cvt_pk_bf16_f32 v105, v106, v107
    v_xor_b32 v101, 96, v101
    v_cvt_pk_bf16_f32 v141, v142, v143
    v_mfma_f32_16x16x32_bf16 a[8:11], a[220:223], v[32:35], 0
    ds_read_b128 v[96:99], v103 offset:0
    v_exp_f32 v83, v83
    v_cvt_pk_bf16_f32 v189, v190, v191
    v_mfma_f32_16x16x32_bf16 v[216:219], a[220:223], v[26:29], 0
    v_accvgpr_read_b32 v108, a20
    v_fma_f32 v80, v80, s28, v12
    v_mfma_f32_16x16x32_bf16 v[220:223], a[224:227], v[26:29], 0
    ds_write2st64_b64 v101, v[128:129], v[176:177] offset0:4 offset1:16
    v_mfma_f32_16x16x32_bf16 v[172:175], a[224:227], v[20:23], 0
    ds_read_b64_tr_b16 a[218:219], v5 offset:7168
    v_fma_f32 v89, v89, s28, v13
    v_cvt_pk_bf16_f32 v137, v138, v139
    v_mfma_f32_16x16x32_bf16 v[168:171], a[220:223], v[20:23], 0
    ds_write2st64_b64 v101, v[224:225], v[104:105] offset0:28 offset1:40
    v_accvgpr_read_b32 v104, a24
    v_xor_b32 v101, 32, v101
    v_fma_f32 v65, v65, s28, v10
    v_accvgpr_read_b32 v109, a21
    v_pk_mul_f32 v[108:109], v[108:109], v[8:9] op_sel_hi:[1,0]
    v_pk_mul_f32 v[158:159], v[158:159], v[48:49] op_sel_hi:[1,0]
    v_cvt_pk_bf16_f32 v108, v108, v109
    v_cvt_pk_bf16_f32 v109, v110, v111
    v_mfma_f32_16x16x32_bf16 v[120:123], a[220:223], v[14:17], 0
    v_accvgpr_read_b32 v107, a27
    v_cvt_pk_bf16_f32 v152, v152, v153
    v_exp_f32 v84, v84
    v_fma_f32 v81, v81, s28, v12
    v_mfma_f32_16x16x32_bf16 v[124:127], a[224:227], v[14:17], 0
    s_add_u32 s20, s20, 12032
    ds_write2st64_b64 v101, v[132:133], v[180:181] offset0:4 offset1:16
    v_mfma_f32_16x16x32_bf16 v[128:131], a[228:231], v[14:17], 0
    s_waitcnt lgkmcnt(3)
    ds_write2st64_b64 v101, v[228:229], v[108:109] offset0:28 offset1:40
    v_mfma_f32_16x16x32_bf16 v[132:135], a[232:235], v[14:17], 0
    ds_read_b64_tr_b16 a[216:217], v5 offset:1024
    v_accvgpr_read_b32 v105, a25
    v_mfma_f32_16x16x32_bf16 v[180:183], a[232:235], v[20:23], 0
    s_add_u32 m0, s38, 0
    ds_read_b64_tr_b16 a[214:215], v4 offset:7168
    v_cvt_pk_bf16_f32 v233, v234, v235
    v_accvgpr_read_b32 v106, a26
    v_mfma_f32_16x16x32_bf16 v[44:47], a[252:255], v[38:41], v[44:47]
    buffer_store_dwordx4 v[96:99], v6, s[16:19], s67 offen offset:0 nt
    ds_read_b64_tr_b16 a[212:213], v4 offset:1024
    v_accvgpr_read_b32 v111, a31
    v_accvgpr_read_b32 v109, a29
    v_accvgpr_read_b32 v108, a28
    v_pk_mul_f32 v[108:109], v[108:109], v[8:9] op_sel_hi:[1,0]
    v_pk_mul_f32 v[106:107], v[106:107], v[8:9] op_sel_hi:[1,0]
    v_pk_mul_f32 v[238:239], v[238:239], v[50:51] op_sel_hi:[1,0]
    v_fma_f32 v58, v58, s28, v9
    v_pk_mul_f32 v[104:105], v[104:105], v[8:9] op_sel_hi:[1,0]
    v_exp_f32 v69, v69
    v_accvgpr_read_b32 v110, a30
    v_mfma_f32_16x16x32_bf16 v[176:179], a[228:231], v[20:23], 0
    ds_read_b64_tr_b16 a[224:225], v3 offset:2048
    v_fma_f32 v66, v66, s28, v10
    v_cvt_pk_bf16_f32 v104, v104, v105
    v_cvt_pk_bf16_f32 v105, v106, v107
    v_xor_b32 v101, 96, v101
    v_mfma_f32_16x16x32_bf16 v[224:227], a[228:231], v[26:29], 0
    ds_write2st64_b64 v101, v[136:137], v[184:185] offset0:4 offset1:16
    v_mfma_f32_16x16x32_bf16 v[228:231], a[232:235], v[26:29], 0
    ds_read_b64_tr_b16 a[220:221], v2 offset:2048
    v_cvt_pk_bf16_f32 v108, v108, v109
    v_mfma_f32_16x16x32_bf16 a[20:23], a[232:235], v[32:35], 0
    buffer_load_dwordx4 v6, s[12:15], s33 offen nt lds
    v_mfma_f32_16x16x32_bf16 a[16:19], a[228:231], v[32:35], 0
    ds_write2st64_b64 v101, v[232:233], v[104:105] offset0:28 offset1:40
    v_xor_b32 v101, 32, v101
    v_cvt_pk_bf16_f32 v36, v76, v77
    v_pk_mul_f32 v[110:111], v[110:111], v[8:9] op_sel_hi:[1,0]
    v_cvt_pk_bf16_f32 v18, v52, v53
    v_cvt_pk_bf16_f32 v237, v238, v239
    v_fma_f32 v75, v75, s28, v11
    v_mfma_f32_16x16x32_bf16 a[64:67], a[228:231], v[38:41], 0
    ds_read_b128 v[96:99], v103 offset:1024
    v_accvgpr_read_b32 v107, a35
    v_mfma_f32_16x16x32_bf16 a[68:71], a[232:235], v[38:41], 0
    s_waitcnt lgkmcnt(4)
    v_exp_f32 v63, v63
    v_cvt_pk_bf16_f32 v109, v110, v111
    v_mfma_f32_16x16x32_bf16 a[72:75], a[212:215], v[38:41], 0
    ds_write2st64_b64 v101, v[140:141], v[188:189] offset0:4 offset1:16
    v_mfma_f32_16x16x32_bf16 a[76:79], a[216:219], v[38:41], 0
    ds_write2st64_b64 v101, v[236:237], v[108:109] offset0:28 offset1:40
    v_accvgpr_read_b32 v110, a38
    v_accvgpr_read_b32 v106, a34
    v_accvgpr_read_b32 v109, a37
    v_mfma_f32_16x16x32_bf16 a[28:31], a[216:219], v[32:35], 0
    ds_read_b64_tr_b16 a[230:231], v4 offset:8192
    v_accvgpr_read_b32 v111, a39
    v_cvt_pk_bf16_f32 v31, v70, v71
    v_xor_b32 v101, 96, v101
    v_accvgpr_read_b32 v104, a32
    v_mfma_f32_16x16x32_bf16 a[24:27], a[212:215], v[32:35], 0
    ds_read_b64_tr_b16 a[222:223], v2 offset:8192
    v_accvgpr_read_b32 v108, a36
    v_mfma_f32_16x16x32_bf16 v[232:235], a[212:215], v[26:29], 0
    s_add_u32 m0, s38, 1024
    ds_read_b64_tr_b16 a[226:227], v3 offset:8192
    v_cvt_pk_bf16_f32 v241, v242, v243
    v_cvt_pk_bf16_f32 v25, v62, v63
    v_accvgpr_read_b32 v105, a33
    v_fma_f32 v73, v73, s28, v11
    v_pk_mul_f32 v[108:109], v[108:109], v[8:9] op_sel_hi:[1,0]
    v_pk_mul_f32 v[106:107], v[106:107], v[8:9] op_sel_hi:[1,0]
    v_pk_mul_f32 v[104:105], v[104:105], v[8:9] op_sel_hi:[1,0]
    v_pk_mul_f32 v[110:111], v[110:111], v[8:9] op_sel_hi:[1,0]
    v_fma_f32 v90, v90, s28, v13
    v_cvt_pk_bf16_f32 v104, v104, v105
    v_cvt_pk_bf16_f32 v105, v106, v107
    v_cvt_pk_bf16_f32 v42, v84, v85
    v_mfma_f32_16x16x32_bf16 v[236:239], a[216:219], v[26:29], 0
    ds_write2st64_b64 v101, v[144:145], v[192:193] offset0:8 offset1:20
    v_mfma_f32_16x16x32_bf16 v[188:191], a[216:219], v[20:23], 0
    ds_read_b64_tr_b16 a[232:233], v5 offset:2048
    v_cvt_pk_bf16_f32 v108, v108, v109
    v_cvt_pk_bf16_f32 v157, v158, v159
    v_cvt_pk_bf16_f32 v245, v246, v247
    v_mfma_f32_16x16x32_bf16 v[184:187], a[212:215], v[20:23], 0
    ds_write2st64_b64 v101, v[240:241], v[104:105] offset0:32 offset1:44
    v_mfma_f32_16x16x32_bf16 v[136:139], a[212:215], v[14:17], 0
    ds_read_b64_tr_b16 a[228:229], v4 offset:2048
    v_xor_b32 v101, 32, v101
    v_mfma_f32_16x16x32_bf16 v[140:143], a[216:219], v[14:17], 0
    s_waitcnt lgkmcnt(4)
    ds_read_b64_tr_b16 a[234:235], v5 offset:8192
    v_cvt_pk_bf16_f32 v201, v202, v203
    v_mfma_f32_16x16x32_bf16 v[144:147], a[220:223], v[14:17], 0
    ds_write2st64_b64 v101, v[148:149], v[196:197] offset0:8 offset1:20
    v_mfma_f32_16x16x32_bf16 v[148:151], a[224:227], v[14:17], 0
    buffer_load_dwordx4 v7, s[12:15], s33 offen nt lds
    v_mfma_f32_16x16x32_bf16 v[196:199], a[224:227], v[20:23], 0
    v_cvt_pk_bf16_f32 v109, v110, v111
    v_accvgpr_read_b32 v106, a42
    v_accvgpr_read_b32 v107, a43
    v_cvt_pk_bf16_f32 v153, v154, v155
    v_mfma_f32_16x16x32_bf16 v[192:195], a[220:223], v[20:23], 0
    ds_write2st64_b64 v101, v[244:245], v[108:109] offset0:32 offset1:44
    v_mfma_f32_16x16x32_bf16 v[240:243], a[220:223], v[26:29], 0
    v_accvgpr_read_b32 v105, a41
    v_accvgpr_read_b32 v111, a47
    v_accvgpr_read_b32 v108, a44
    v_mfma_f32_16x16x32_bf16 v[244:247], a[224:227], v[26:29], 0
    s_add_u32 s39, s39, 12288
    v_cvt_pk_bf16_f32 v249, v250, v251
    v_fma_f32 v91, v91, s28, v13
    v_cvt_pk_bf16_f32 v19, v54, v55
    v_accvgpr_read_b32 v109, a45
    v_mfma_f32_16x16x32_bf16 a[36:39], a[224:227], v[32:35], 0
    s_waitcnt vmcnt(9) lgkmcnt(2)
    v_accvgpr_read_b32 v104, a40
    v_xor_b32 v101, 96, v101
    v_mfma_f32_16x16x32_bf16 a[32:35], a[220:223], v[32:35], 0
    buffer_store_dwordx4 v[96:99], v7, s[16:19], s67 offen offset:0 nt
    s_barrier
    v_pk_mul_f32 v[108:109], v[108:109], v[8:9] op_sel_hi:[1,0]
    v_pk_mul_f32 v[106:107], v[106:107], v[8:9] op_sel_hi:[1,0]
    v_accvgpr_read_b32 v110, a46
    v_pk_mul_f32 v[104:105], v[104:105], v[8:9] op_sel_hi:[1,0]
    v_pk_mul_f32 v[110:111], v[110:111], v[8:9] op_sel_hi:[1,0]
    v_cvt_pk_bf16_f32 v108, v108, v109
    v_fma_f32 v57, v57, s28, v9
    v_mfma_f32_16x16x32_bf16 a[80:83], a[220:223], v[38:41], 0
    ds_read_b128 a[220:223], v0 offset:1024
    v_cvt_pk_bf16_f32 v253, v254, v255
    v_mfma_f32_16x16x32_bf16 a[84:87], a[224:227], v[38:41], 0
    ds_write2st64_b64 v101, v[152:153], v[200:201] offset0:8 offset1:20
    v_cvt_pk_bf16_f32 v43, v86, v87
    v_mfma_f32_16x16x32_bf16 a[88:91], a[228:231], v[38:41], 0
    ds_read_b128 a[216:219], v1 offset:0
    v_cvt_pk_bf16_f32 v104, v104, v105
    v_mfma_f32_16x16x32_bf16 a[92:95], a[232:235], v[38:41], 0
    ds_read_b128 a[212:215], v0 offset:0
    v_cvt_pk_bf16_f32 v105, v106, v107
    v_cvt_pk_bf16_f32 v109, v110, v111
    v_mfma_f32_16x16x32_bf16 a[44:47], a[232:235], v[32:35], 0
    ds_write2st64_b64 v101, v[248:249], v[104:105] offset0:32 offset1:44
    v_xor_b32 v101, 32, v101
    v_mfma_f32_16x16x32_bf16 a[40:43], a[228:231], v[32:35], 0
    ds_write2st64_b64 v101, v[156:157], v[204:205] offset0:8 offset1:20
    v_mfma_f32_16x16x32_bf16 v[248:251], a[228:231], v[26:29], 0
    ds_write2st64_b64 v101, v[252:253], v[108:109] offset0:32 offset1:44
    v_mfma_f32_16x16x32_bf16 v[252:255], a[232:235], v[26:29], 0
    v_exp_f32 v59, v59
    v_mfma_f32_16x16x32_bf16 v[204:207], a[232:235], v[20:23], 0
    v_exp_f32 v65, v65
    v_mfma_f32_16x16x32_bf16 v[200:203], a[228:231], v[20:23], 0
    v_fma_f32 v82, v82, s28, v12
    v_fma_f32 v74, v74, s28, v11
    v_mfma_f32_16x16x32_bf16 v[152:155], a[228:231], v[14:17], 0
    v_exp_f32 v58, v58
    v_mfma_f32_16x16x32_bf16 v[156:159], a[232:235], v[14:17], 0
    s_waitcnt lgkmcnt(3)
    v_exp_f32 v61, v61
    v_mfma_f32_16x16x32_bf16 v[52:55], a[212:215], a[96:99], 0
    ds_read_b128 a[224:227], v1 offset:1024
    v_cvt_pk_bf16_f32 v30, v68, v69
    v_mfma_f32_16x16x32_bf16 v[52:55], a[216:219], a[100:103], v[52:55]
    v_exp_f32 v56, v56
    v_mfma_f32_16x16x32_bf16 v[52:55], a[220:223], a[104:107], v[52:55]
    v_exp_f32 v57, v57
    v_cvt_pk_bf16_f32 v24, v60, v61
    v_mfma_f32_16x16x32_bf16 v[60:63], a[220:223], a[128:131], 0
    s_add_u32 m0, s22, 24576
    v_exp_f32 v64, v64
    v_mfma_f32_16x16x32_bf16 v[60:63], a[216:219], a[124:127], v[60:63]
    buffer_load_dwordx4 v6, s[8:11], s21 offen lds
    v_mfma_f32_16x16x32_bf16 v[60:63], a[212:215], a[120:123], v[60:63]
    ds_read_b128 a[228:231], v0 offset:2048
    v_cvt_pk_bf16_f32 v17, v58, v59
    v_mfma_f32_16x16x32_bf16 v[68:71], a[212:215], a[144:147], 0
    ds_read_b128 v[96:99], v103 offset:2048
    v_cvt_pk_bf16_f32 v22, v64, v65
    v_mfma_f32_16x16x32_bf16 v[68:71], a[216:219], a[148:151], v[68:71]
    s_add_u32 s21, s21, 128
    ds_read_b128 a[232:235], v1 offset:2048
    v_cvt_pk_bf16_f32 v16, v56, v57
    v_mfma_f32_16x16x32_bf16 v[68:71], a[220:223], a[152:155], v[68:71]
    s_add_u32 m0, s22, 25600
    v_exp_f32 v90, v90
    v_mfma_f32_16x16x32_bf16 v[76:79], a[220:223], a[176:179], 0
    v_exp_f32 v67, v67
    v_mfma_f32_16x16x32_bf16 v[48:51], a[236:239], v[16:19], v[44:47]
    v_exp_f32 v89, v89
    v_mfma_f32_16x16x32_bf16 v[76:79], a[216:219], a[172:175], v[76:79]
    v_exp_f32 v66, v66
    v_mfma_f32_16x16x32_bf16 v[76:79], a[212:215], a[168:171], v[76:79]
    v_exp_f32 v72, v72
    v_mfma_f32_16x16x32_bf16 v[84:87], a[212:215], a[192:195], 0
    buffer_load_dwordx4 v6, s[8:11], s21 offen lds
    v_mfma_f32_16x16x32_bf16 v[84:87], a[216:219], a[196:199], v[84:87]
    s_add_u32 s21, s21, 128
    v_exp_f32 v88, v88
    v_mfma_f32_16x16x32_bf16 v[84:87], a[220:223], a[200:203], v[84:87]
    s_waitcnt lgkmcnt(2)
    v_exp_f32 v82, v82
    v_mfma_f32_16x16x32_bf16 v[84:87], a[224:227], a[204:207], v[84:87]
    s_add_u32 m0, s22, 26624
    v_exp_f32 v73, v73
    v_mfma_f32_16x16x32_bf16 v[84:87], a[228:231], a[208:211], v[84:87]
    s_waitcnt lgkmcnt(0)
    v_exp_f32 v74, v74
    v_mfma_f32_16x16x32_bf16 v[84:87], a[232:235], v[92:95], v[84:87]
    v_exp_f32 v91, v91
    v_mfma_f32_16x16x32_bf16 v[76:79], a[232:235], a[188:191], v[76:79]
    v_exp_f32 v80, v80
    v_mfma_f32_16x16x32_bf16 v[76:79], a[228:231], a[184:187], v[76:79]
    buffer_load_dwordx4 v6, s[8:11], s21 offen lds
    v_mfma_f32_16x16x32_bf16 v[76:79], a[224:227], a[180:183], v[76:79]
    s_add_u32 s21, s21, 12032
    v_exp_f32 v75, v75
    v_mfma_f32_16x16x32_bf16 v[68:71], a[224:227], a[156:159], v[68:71]
    v_exp_f32 v81, v81
    v_mfma_f32_16x16x32_bf16 v[68:71], a[228:231], a[160:163], v[68:71]
    s_add_u32 s56, s67, 128
    v_cvt_pk_bf16_f32 v34, v80, v81
    v_cvt_pk_bf16_f32 v23, v66, v67
    v_mfma_f32_16x16x32_bf16 v[68:71], a[232:235], a[164:167], v[68:71]
    ds_read_b128 a[220:223], v0 offset:7168
    v_cvt_pk_bf16_f32 v35, v82, v83
    v_mfma_f32_16x16x32_bf16 v[48:51], a[240:243], v[22:25], v[48:51]
    ds_read_b128 a[212:215], v0 offset:6144
    v_cvt_pk_bf16_f32 v29, v74, v75
    v_mfma_f32_16x16x32_bf16 v[60:63], a[232:235], a[140:143], v[60:63]
    ds_read_b128 a[216:219], v1 offset:6144
    v_cvt_pk_bf16_f32 v41, v90, v91
    v_mfma_f32_16x16x32_bf16 v[60:63], a[228:231], a[136:139], v[60:63]
    buffer_store_dwordx4 v[96:99], v6, s[16:19], s56 offen offset:0 nt
    s_add_u32 s58, s33, 128
    s_add_u32 m0, s38, 2048
    v_cvt_pk_bf16_f32 v28, v72, v73
    v_cvt_pk_bf16_f32 v40, v88, v89
    s_nop 0
    v_mfma_f32_16x16x32_bf16 v[48:51], a[244:247], v[28:31], v[48:51]
    v_mfma_f32_16x16x32_bf16 v[48:51], a[248:251], v[34:37], v[48:51]
    v_mfma_f32_16x16x32_bf16 v[48:51], a[252:255], v[40:43], v[48:51]
    buffer_load_dwordx4 v6, s[12:15], s58 offen nt lds
    v_mfma_f32_16x16x32_bf16 v[60:63], a[224:227], a[132:135], v[60:63]
    s_add_u32 m0, s38, 3072
    v_mfma_f32_16x16x32_bf16 v[52:55], a[224:227], a[108:111], v[52:55]
    ds_read_b128 v[96:99], v103 offset:3072
    v_mfma_f32_16x16x32_bf16 v[52:55], a[228:231], a[112:115], v[52:55]
    ds_read_b128 a[224:227], v1 offset:7168
    v_mfma_f32_16x16x32_bf16 v[52:55], a[232:235], a[116:119], v[52:55]
    s_waitcnt lgkmcnt(3)
    ds_read_b128 a[232:235], v1 offset:8192
    v_cmp_lt_f32 vcc, s29, v48
    v_mfma_f32_16x16x32_bf16 v[56:59], a[212:215], a[96:99], 0
    s_waitcnt lgkmcnt(3)
    ds_read_b128 a[228:231], v0 offset:8192
    v_mfma_f32_16x16x32_bf16 v[56:59], a[216:219], a[100:103], v[56:59]
    s_nop 0
    s_cbranch_vccnz L_rs_tr45d
L_ret_tr45d:
    v_fma_f32 v53, v53, s28, v9
    v_mfma_f32_16x16x32_bf16 v[56:59], a[220:223], a[104:107], v[56:59]
    v_fma_f32 v54, v54, s28, v9
    v_fma_f32 v61, v61, s28, v10
    v_mfma_f32_16x16x32_bf16 v[64:67], a[220:223], a[128:131], 0
    v_fma_f32 v62, v62, s28, v10
    v_mfma_f32_16x16x32_bf16 v[64:67], a[216:219], a[124:127], v[64:67]
    v_exp_f32 v62, v62
    v_mfma_f32_16x16x32_bf16 v[64:67], a[212:215], a[120:123], v[64:67]
    v_exp_f32 v53, v53
    v_mfma_f32_16x16x32_bf16 v[72:75], a[212:215], a[144:147], 0
    v_exp_f32 v61, v61
    v_mfma_f32_16x16x32_bf16 v[72:75], a[216:219], a[148:151], v[72:75]
    s_waitcnt lgkmcnt(3)
    buffer_load_dwordx4 v7, s[12:15], s58 offen nt lds
    v_mfma_f32_16x16x32_bf16 v[72:75], a[220:223], a[152:155], v[72:75]
    v_exp_f32 v54, v54
    v_mfma_f32_16x16x32_bf16 v[80:83], a[220:223], a[176:179], 0
    v_fma_f32 v60, v60, s28, v10
    s_waitcnt vmcnt(13) lgkmcnt(0)
    v_mfma_f32_16x16x32_bf16 v[80:83], a[216:219], a[172:175], v[80:83]
    s_barrier
    v_mfma_f32_16x16x32_bf16 v[80:83], a[212:215], a[168:171], v[80:83]
    s_add_u32 m0, s22, 0
    v_fma_f32 v63, v63, s28, v10
    v_fma_f32 v55, v55, s28, v9
    v_mfma_f32_16x16x32_bf16 v[88:91], a[212:215], a[192:195], 0
    v_exp_f32 v60, v60
    v_mfma_f32_16x16x32_bf16 v[88:91], a[216:219], a[196:199], v[88:91]
    ds_read_b64_tr_b16 a[212:213], v2 offset:18432
    v_mfma_f32_16x16x32_bf16 v[88:91], a[220:223], a[200:203], v[88:91]
    ds_read_b64_tr_b16 a[214:215], v2 offset:12288
    v_mfma_f32_16x16x32_bf16 v[88:91], a[224:227], a[204:207], v[88:91]
    v_exp_f32 v55, v55
    v_mfma_f32_16x16x32_bf16 v[88:91], a[228:231], a[208:211], v[88:91]
    ds_read_b64_tr_b16 a[216:217], v3 offset:18432
    v_add_u32 v103, 4096, v103
    v_mfma_f32_16x16x32_bf16 v[88:91], a[232:235], v[92:95], v[88:91]
    v_exp_f32 v63, v63
    v_mfma_f32_16x16x32_bf16 v[80:83], a[232:235], a[188:191], v[80:83]
    ds_read_b64_tr_b16 a[218:219], v3 offset:12288
    v_fma_f32 v52, v52, s28, v9
    v_mfma_f32_16x16x32_bf16 v[80:83], a[228:231], a[184:187], v[80:83]
    buffer_load_dwordx4 v6, s[4:7], s20 offen lds
    v_mfma_f32_16x16x32_bf16 v[80:83], a[224:227], a[180:183], v[80:83]
    s_add_u32 s20, s20, 128
    s_add_u32 m0, s22, 1024
    v_cvt_pk_bf16_f32 v15, v54, v55
    v_mfma_f32_16x16x32_bf16 v[72:75], a[224:227], a[156:159], v[72:75]
    buffer_load_dwordx4 v6, s[4:7], s20 offen lds
    v_mfma_f32_16x16x32_bf16 v[72:75], a[228:231], a[160:163], v[72:75]
    s_add_u32 s20, s20, 128
    s_add_u32 m0, s22, 2048
    v_cvt_pk_bf16_f32 v21, v62, v63
    v_mfma_f32_16x16x32_bf16 v[72:75], a[232:235], a[164:167], v[72:75]
    ds_read_b64_tr_b16 a[220:221], v4 offset:18432
    v_mfma_f32_16x16x32_bf16 v[64:67], a[232:235], a[140:143], v[64:67]
    buffer_load_dwordx4 v6, s[4:7], s20 offen lds
    v_mfma_f32_16x16x32_bf16 v[64:67], a[228:231], a[136:139], v[64:67]
    v_exp_f32 v52, v52
    v_mfma_f32_16x16x32_bf16 v[64:67], a[224:227], a[132:135], v[64:67]
    s_add_u32 s20, s20, 12032
    ds_read_b64_tr_b16 a[222:223], v4 offset:12288
    v_cvt_pk_bf16_f32 v20, v60, v61
    v_mfma_f32_16x16x32_bf16 v[56:59], a[224:227], a[108:111], v[56:59]
    ds_read_b64_tr_b16 a[224:225], v5 offset:18432
    v_cvt_pk_bf16_f32 v14, v52, v53
    v_mfma_f32_16x16x32_bf16 v[56:59], a[228:231], a[112:115], v[56:59]
    s_waitcnt lgkmcnt(3)
    ds_read_b64_tr_b16 a[226:227], v5 offset:12288
    s_bitcmp1_b32 s3, 1
    v_mfma_f32_16x16x32_bf16 v[56:59], a[232:235], a[116:119], v[56:59]
    buffer_store_dwordx4 v[96:99], v7, s[16:19], s56 offen offset:0 nt
    s_cbranch_scc1 L_loop5w1
    s_branch L_loop5w0
L_tr44:
    v_mfma_f32_16x16x32_bf16 v[112:115], a[212:215], v[16:19], v[112:115]
    ds_read_b64_tr_b16 a[234:235], v3 offset:13312
    v_mfma_f32_16x16x32_bf16 v[160:163], a[212:215], v[22:25], v[160:163]
    ds_read_b64_tr_b16 a[228:229], v2 offset:19456
    v_fma_f32 v78, v78, s28, v12
    v_fma_f32 v69, v69, s28, v11
    v_mfma_f32_16x16x32_bf16 v[208:211], a[212:215], v[28:31], v[208:211]
    ds_read_b64_tr_b16 a[232:233], v3 offset:19456
    v_fma_f32 v58, v58, s28, v9
    v_mfma_f32_16x16x32_bf16 a[0:3], a[212:215], v[34:37], a[0:3]
    s_waitcnt lgkmcnt(7)
    v_mfma_f32_16x16x32_bf16 a[4:7], a[216:219], v[34:37], a[4:7]
    ds_read_b64_tr_b16 a[230:231], v2 offset:13312
    v_fma_f32 v57, v57, s28, v9
    v_mfma_f32_16x16x32_bf16 v[212:215], a[216:219], v[28:31], v[212:215]
    v_fma_f32 v59, v59, s28, v9
    v_fma_f32 v73, v73, s28, v11
    v_mfma_f32_16x16x32_bf16 v[164:167], a[216:219], v[22:25], v[164:167]
    v_exp_f32 v57, v57
    v_mfma_f32_16x16x32_bf16 v[116:119], a[216:219], v[16:19], v[116:119]
    ds_read_b64_tr_b16 a[212:213], v4 offset:19456
    s_waitcnt lgkmcnt(7)
    v_mfma_f32_16x16x32_bf16 v[120:123], a[220:223], v[16:19], v[120:123]
    v_exp_f32 v59, v59
    v_mfma_f32_16x16x32_bf16 v[168:171], a[220:223], v[22:25], v[168:171]
    ds_read_b64_tr_b16 a[218:219], v5 offset:13312
    v_fma_f32 v82, v82, s28, v12
    v_mfma_f32_16x16x32_bf16 v[216:219], a[220:223], v[28:31], v[216:219]
    ds_read_b64_tr_b16 a[214:215], v4 offset:13312
    v_fma_f32 v70, v70, s28, v11
    v_mfma_f32_16x16x32_bf16 a[8:11], a[220:223], v[34:37], a[8:11]
    s_waitcnt lgkmcnt(5)
    v_exp_f32 v78, v78
    v_mfma_f32_16x16x32_bf16 a[12:15], a[224:227], v[34:37], a[12:15]
    ds_read_b64_tr_b16 a[216:217], v5 offset:19456
    s_add_u32 s39, s39, 12288
    v_mfma_f32_16x16x32_bf16 v[220:223], a[224:227], v[28:31], v[220:223]
    ds_read_b64_tr_b16 a[222:223], v2 offset:14336
    v_fma_f32 v79, v79, s28, v12
    v_mfma_f32_16x16x32_bf16 v[172:175], a[224:227], v[22:25], v[172:175]
    ds_read_b64_tr_b16 a[220:221], v2 offset:20480
    v_fma_f32 v66, v66, s28, v10
    v_mfma_f32_16x16x32_bf16 v[124:127], a[224:227], v[16:19], v[124:127]
    s_waitcnt lgkmcnt(6)
    v_fma_f32 v67, v67, s28, v10
    v_fma_f32 v63, v63, s28, v10
    v_mfma_f32_16x16x32_bf16 v[128:131], a[228:231], v[16:19], v[128:131]
    v_exp_f32 v69, v69
    v_mfma_f32_16x16x32_bf16 v[176:179], a[228:231], v[22:25], v[176:179]
    ds_read_b64_tr_b16 a[226:227], v3 offset:14336
    v_mfma_f32_16x16x32_bf16 v[224:227], a[228:231], v[28:31], v[224:227]
    ds_read_b64_tr_b16 a[224:225], v3 offset:20480
    v_fma_f32 v62, v62, s28, v10
    v_mfma_f32_16x16x32_bf16 a[16:19], a[228:231], v[34:37], a[16:19]
    ds_read_b64_tr_b16 a[230:231], v4 offset:14336
    v_fma_f32 v65, v65, s28, v10
    v_mfma_f32_16x16x32_bf16 a[20:23], a[232:235], v[34:37], a[20:23]
    v_fma_f32 v56, v56, s28, v9
    v_fma_f32 v77, v77, s28, v12
    v_mfma_f32_16x16x32_bf16 v[228:231], a[232:235], v[28:31], v[228:231]
    ds_read_b64_tr_b16 a[228:229], v4 offset:20480
    v_mfma_f32_16x16x32_bf16 v[180:183], a[232:235], v[22:25], v[180:183]
    v_exp_f32 v79, v79
    v_mfma_f32_16x16x32_bf16 v[132:135], a[232:235], v[16:19], v[132:135]
    s_waitcnt lgkmcnt(5)
    ds_read_b64_tr_b16 a[232:233], v5 offset:20480
    v_mfma_f32_16x16x32_bf16 v[136:139], a[212:215], v[16:19], v[136:139]
    ds_read_b64_tr_b16 a[234:235], v5 offset:14336
    v_fma_f32 v68, v68, s28, v11
    v_mfma_f32_16x16x32_bf16 v[184:187], a[212:215], v[22:25], v[184:187]
    v_exp_f32 v63, v63
    v_mfma_f32_16x16x32_bf16 v[232:235], a[212:215], v[28:31], v[232:235]
    v_fma_f32 v80, v80, s28, v12
    v_fma_f32 v76, v76, s28, v12
    v_mfma_f32_16x16x32_bf16 a[24:27], a[212:215], v[34:37], a[24:27]
    v_fma_f32 v75, v75, s28, v11
    v_mfma_f32_16x16x32_bf16 a[28:31], a[216:219], v[34:37], a[28:31]
    v_exp_f32 v77, v77
    v_mfma_f32_16x16x32_bf16 v[236:239], a[216:219], v[28:31], v[236:239]
    v_exp_f32 v76, v76
    v_mfma_f32_16x16x32_bf16 v[188:191], a[216:219], v[22:25], v[188:191]
    v_exp_f32 v58, v58
    v_mfma_f32_16x16x32_bf16 v[140:143], a[216:219], v[16:19], v[140:143]
    s_waitcnt lgkmcnt(2)
    v_exp_f32 v62, v62
    v_mfma_f32_16x16x32_bf16 v[144:147], a[220:223], v[16:19], v[144:147]
    v_cvt_pk_bf16_f32 v21, v62, v63
    v_mfma_f32_16x16x32_bf16 v[192:195], a[220:223], v[22:25], v[192:195]
    v_exp_f32 v68, v68
    v_mfma_f32_16x16x32_bf16 v[240:243], a[220:223], v[28:31], v[240:243]
    s_waitcnt vmcnt(10) lgkmcnt(0)
    v_exp_f32 v65, v65
    v_mfma_f32_16x16x32_bf16 a[32:35], a[220:223], v[34:37], a[32:35]
    s_barrier
    v_mfma_f32_16x16x32_bf16 a[36:39], a[224:227], v[34:37], a[36:39]
    s_add_u32 m0, s22, 36864
    ds_read_b128 a[216:219], v1 offset:12288
    v_fma_f32 v83, v83, s28, v12
    v_mfma_f32_16x16x32_bf16 v[244:247], a[224:227], v[28:31], v[244:247]
    ds_read_b128 a[212:215], v0 offset:12288
    v_fma_f32 v64, v64, s28, v10
    v_mfma_f32_16x16x32_bf16 v[196:199], a[224:227], v[22:25], v[196:199]
    buffer_load_dwordx4 v6, s[8:11], s21 offen lds
    v_mfma_f32_16x16x32_bf16 v[148:151], a[224:227], v[16:19], v[148:151]
    s_add_u32 s21, s21, 128
    ds_read_b128 a[220:223], v0 offset:13312
    v_fma_f32 v71, v71, s28, v11
    v_mfma_f32_16x16x32_bf16 v[152:155], a[228:231], v[16:19], v[152:155]
    s_add_u32 m0, s22, 37888
    ds_read_b128 v[84:87], v103 offset:0
    v_fma_f32 v81, v81, s28, v12
    v_mfma_f32_16x16x32_bf16 v[200:203], a[228:231], v[22:25], v[200:203]
    buffer_load_dwordx4 v6, s[8:11], s21 offen lds
    v_mfma_f32_16x16x32_bf16 v[248:251], a[228:231], v[28:31], v[248:251]
    ds_read_b128 a[224:227], v1 offset:13312
    v_mfma_f32_16x16x32_bf16 a[40:43], a[228:231], v[34:37], a[40:43]
    s_add_u32 s21, s21, 128
    v_fma_f32 v74, v74, s28, v11
    v_mfma_f32_16x16x32_bf16 a[44:47], a[232:235], v[34:37], a[44:47]
    v_exp_f32 v75, v75
    v_mfma_f32_16x16x32_bf16 v[252:255], a[232:235], v[28:31], v[252:255]
    s_add_u32 m0, s22, 38912
    v_exp_f32 v70, v70
    v_mfma_f32_16x16x32_bf16 v[204:207], a[232:235], v[22:25], v[204:207]
    buffer_load_dwordx4 v6, s[8:11], s21 offen lds
    v_mfma_f32_16x16x32_bf16 v[156:159], a[232:235], v[16:19], v[156:159]
    s_waitcnt lgkmcnt(3)
    v_exp_f32 v71, v71
    v_mfma_f32_16x16x32_bf16 v[52:55], a[212:215], a[96:99], 0
    ds_read_b128 a[228:231], v0 offset:14336
    v_cvt_pk_bf16_f32 v32, v76, v77
    v_mfma_f32_16x16x32_bf16 v[52:55], a[216:219], a[100:103], v[52:55]
    s_waitcnt lgkmcnt(3)
    v_exp_f32 v82, v82
    v_mfma_f32_16x16x32_bf16 v[52:55], a[220:223], a[104:107], v[52:55]
    ds_read_b128 a[232:235], v1 offset:14336
    v_fma_f32 v72, v72, s28, v11
    v_mfma_f32_16x16x32_bf16 v[60:63], a[220:223], a[128:131], 0
    s_add_u32 s21, s21, 12032
    v_cvt_pk_bf16_f32 v27, v70, v71
    v_cvt_pk_bf16_f32 v26, v68, v69
    v_mfma_f32_16x16x32_bf16 v[60:63], a[216:219], a[124:127], v[60:63]
    s_add_u32 s57, s24, 128
    ds_read_b128 v[96:99], v103 offset:2048
    v_cvt_pk_bf16_f32 v33, v78, v79
    v_mfma_f32_16x16x32_bf16 v[60:63], a[212:215], a[120:123], v[60:63]
    v_exp_f32 v64, v64
    v_mfma_f32_16x16x32_bf16 v[68:71], a[212:215], a[144:147], 0
    v_exp_f32 v80, v80
    v_mfma_f32_16x16x32_bf16 v[68:71], a[216:219], a[148:151], v[68:71]
    v_exp_f32 v83, v83
    v_mfma_f32_16x16x32_bf16 v[68:71], a[220:223], a[152:155], v[68:71]
    v_exp_f32 v67, v67
    v_mfma_f32_16x16x32_bf16 v[76:79], a[220:223], a[176:179], 0
    v_exp_f32 v66, v66
    v_mfma_f32_16x16x32_bf16 v[76:79], a[216:219], a[172:175], v[76:79]
    v_exp_f32 v74, v74
    v_mfma_f32_16x16x32_bf16 v[76:79], a[212:215], a[168:171], v[76:79]
    s_waitcnt lgkmcnt(2)
    v_exp_f32 v72, v72
    v_mfma_f32_16x16x32_bf16 v[76:79], a[224:227], a[180:183], v[76:79]
    v_mfma_f32_16x16x32_bf16 v[76:79], a[228:231], a[184:187], v[76:79]
    s_waitcnt lgkmcnt(1)
    ds_read_b128 a[220:223], v0 offset:19456
    v_mfma_f32_16x16x32_bf16 v[76:79], a[232:235], a[188:191], v[76:79]
    v_exp_f32 v73, v73
    v_mfma_f32_16x16x32_bf16 v[68:71], a[232:235], a[164:167], v[68:71]
    ds_read_b128 a[212:215], v0 offset:18432
    v_cvt_pk_bf16_f32 v22, v64, v65
    v_mfma_f32_16x16x32_bf16 v[68:71], a[228:231], a[160:163], v[68:71]
    v_exp_f32 v56, v56
    v_mfma_f32_16x16x32_bf16 v[68:71], a[224:227], a[156:159], v[68:71]
    ds_read_b128 a[216:219], v1 offset:18432
    v_cvt_pk_bf16_f32 v17, v58, v59
    v_mfma_f32_16x16x32_bf16 v[60:63], a[224:227], a[132:135], v[60:63]
    ds_read_b128 v[88:91], v103 offset:1024
    v_cvt_pk_bf16_f32 v16, v56, v57
    v_mfma_f32_16x16x32_bf16 v[60:63], a[228:231], a[136:139], v[60:63]
    v_cvt_pk_bf16_f32 v28, v72, v73
    v_mfma_f32_16x16x32_bf16 v[60:63], a[232:235], a[140:143], v[60:63]
    v_exp_f32 v81, v81
    v_mfma_f32_16x16x32_bf16 v[52:55], a[232:235], a[116:119], v[52:55]
    ds_read_b128 a[232:235], v1 offset:20480
    v_cvt_pk_bf16_f32 v23, v66, v67
    v_mfma_f32_16x16x32_bf16 v[44:47], a[236:239], v[14:17], v[48:51]
    v_mfma_f32_16x16x32_bf16 v[52:55], a[228:231], a[112:115], v[52:55]
    v_cvt_pk_bf16_f32 v29, v74, v75
    v_cvt_pk_bf16_f32 v35, v82, v83
    v_mfma_f32_16x16x32_bf16 v[44:47], a[240:243], v[20:23], v[44:47]
    v_cvt_pk_bf16_f32 v34, v80, v81
    v_mfma_f32_16x16x32_bf16 v[52:55], a[224:227], a[108:111], v[52:55]
    ds_read_b128 a[228:231], v0 offset:20480
    v_mfma_f32_16x16x32_bf16 v[44:47], a[244:247], v[26:29], v[44:47]
    ds_read_b128 a[224:227], v1 offset:19456
    v_mfma_f32_16x16x32_bf16 v[44:47], a[248:251], v[32:35], v[44:47]
    buffer_store_dwordx4 v[84:87], v6, s[16:19], s24 offen offset:0 nt
    s_nop 0
    ds_read_b128 v[84:87], v103 offset:3072
    s_waitcnt lgkmcnt(4)
    v_mfma_f32_16x16x32_bf16 v[56:59], a[212:215], a[96:99], 0
    v_mfma_f32_16x16x32_bf16 v[56:59], a[216:219], a[100:103], v[56:59]
    s_nop 1
    v_cmp_lt_f32 vcc, s29, v44
    v_mfma_f32_16x16x32_bf16 v[56:59], a[220:223], a[104:107], v[56:59]
    buffer_store_dwordx4 v[88:91], v7, s[16:19], s24 offen offset:0 nt
    s_nop 2
    s_cbranch_vccnz L_rs_tr44a
L_ret_tr44a:
    v_mfma_f32_16x16x32_bf16 v[64:67], a[220:223], a[128:131], 0
    v_fma_f32 v54, v54, s28, v9
    v_fma_f32 v53, v53, s28, v9
    v_mfma_f32_16x16x32_bf16 v[64:67], a[216:219], a[124:127], v[64:67]
    v_exp_f32 v53, v53
    v_mfma_f32_16x16x32_bf16 v[64:67], a[212:215], a[120:123], v[64:67]
    v_fma_f32 v55, v55, s28, v9
    s_waitcnt vmcnt(8) lgkmcnt(1)
    v_mfma_f32_16x16x32_bf16 v[72:75], a[212:215], a[144:147], 0
    s_barrier
    v_mfma_f32_16x16x32_bf16 v[72:75], a[216:219], a[148:151], v[72:75]
    s_add_u32 m0, s22, 12288
    v_fma_f32 v61, v61, s28, v10
    v_fma_f32 v52, v52, s28, v9
    v_mfma_f32_16x16x32_bf16 v[72:75], a[220:223], a[152:155], v[72:75]
    buffer_load_dwordx4 v6, s[4:7], s20 offen lds
    v_mfma_f32_16x16x32_bf16 v[80:83], a[220:223], a[176:179], 0
    s_add_u32 s20, s20, 128
    v_exp_f32 v55, v55
    v_mfma_f32_16x16x32_bf16 v[80:83], a[216:219], a[172:175], v[80:83]
    s_add_u32 m0, s22, 13312
    v_exp_f32 v54, v54
    v_mfma_f32_16x16x32_bf16 v[80:83], a[212:215], a[168:171], v[80:83]
    buffer_load_dwordx4 v6, s[4:7], s20 offen lds
    v_mfma_f32_16x16x32_bf16 v[80:83], a[224:227], a[180:183], v[80:83]
    s_add_u32 s20, s20, 128
    v_exp_f32 v61, v61
    v_mfma_f32_16x16x32_bf16 v[80:83], a[228:231], a[184:187], v[80:83]
    ds_read_b64_tr_b16 a[212:213], v2 offset:0
    v_cvt_pk_bf16_f32 v19, v54, v55
    v_mfma_f32_16x16x32_bf16 v[80:83], a[232:235], a[188:191], v[80:83]
    s_add_u32 m0, s22, 14336
    ds_read_b64_tr_b16 a[214:215], v2 offset:6144
    v_mfma_f32_16x16x32_bf16 v[72:75], a[232:235], a[164:167], v[72:75]
    buffer_load_dwordx4 v6, s[4:7], s20 offen lds
    v_mfma_f32_16x16x32_bf16 v[72:75], a[228:231], a[160:163], v[72:75]
    ds_read_b64_tr_b16 a[216:217], v3 offset:0
    v_mfma_f32_16x16x32_bf16 v[72:75], a[224:227], a[156:159], v[72:75]
    buffer_store_dwordx4 v[96:99], v6, s[16:19], s57 offen offset:0 nt
    ds_read_b64_tr_b16 a[218:219], v3 offset:6144
    v_exp_f32 v52, v52
    v_mfma_f32_16x16x32_bf16 v[64:67], a[224:227], a[132:135], v[64:67]
    ds_read_b64_tr_b16 a[220:221], v4 offset:0
    v_fma_f32 v60, v60, s28, v10
    v_mfma_f32_16x16x32_bf16 v[64:67], a[228:231], a[136:139], v[64:67]
    v_mfma_f32_16x16x32_bf16 v[64:67], a[232:235], a[140:143], v[64:67]
    v_exp_f32 v60, v60
    v_mfma_f32_16x16x32_bf16 v[56:59], a[232:235], a[116:119], v[56:59]
    ds_read_b64_tr_b16 a[222:223], v4 offset:6144
    v_cvt_pk_bf16_f32 v24, v60, v61
    v_mfma_f32_16x16x32_bf16 v[56:59], a[228:231], a[112:115], v[56:59]
    s_add_u32 s20, s20, 12032
    s_waitcnt lgkmcnt(4)
    v_mfma_f32_16x16x32_bf16 v[56:59], a[224:227], a[108:111], v[56:59]
    buffer_store_dwordx4 v[84:87], v7, s[16:19], s57 offen offset:0 nt
    ds_read_b64_tr_b16 a[224:225], v5 offset:0
    ds_read_b64_tr_b16 a[226:227], v5 offset:6144
    v_cvt_pk_bf16_f32 v18, v52, v53
    v_lshrrev_b32 v105, 11, v0
    v_mfma_f32_16x16x32_bf16 v[112:115], a[212:215], v[14:17], v[112:115]
    v_xor_b32 v105, s65, v105
    v_fma_f32 v70, v70, s28, v11
    v_fma_f32 v73, v73, s28, v11
    v_mfma_f32_16x16x32_bf16 v[160:163], a[212:215], v[20:23], v[160:163]
    s_add_u32 s39, s39, 12288
    ds_read_b64_tr_b16 a[234:235], v3 offset:7168
    v_fma_f32 v68, v68, s28, v11
    v_fma_f32 v77, v77, s28, v12
    v_mfma_f32_16x16x32_bf16 v[208:211], a[212:215], v[26:29], v[208:211]
    ds_read_b64_tr_b16 a[228:229], v2 offset:1024
    v_fma_f32 v72, v72, s28, v11
    v_mfma_f32_16x16x32_bf16 a[0:3], a[212:215], v[32:35], a[0:3]
    s_waitcnt lgkmcnt(6)
    ds_read_b64_tr_b16 a[232:233], v3 offset:1024
    v_and_b32 v104, 0x3ff, v0
    v_mfma_f32_16x16x32_bf16 a[4:7], a[216:219], v[32:35], a[4:7]
    ds_read_b64_tr_b16 a[230:231], v2 offset:7168
    v_fma_f32 v76, v76, s28, v12
    v_mfma_f32_16x16x32_bf16 v[212:215], a[216:219], v[26:29], v[212:215]
    v_lshl_add_u32 v104, v105, 10, v104
    v_fma_f32 v62, v62, s28, v10
    v_mfma_f32_16x16x32_bf16 v[164:167], a[216:219], v[20:23], v[164:167]
    ds_read_b64_tr_b16 a[212:213], v4 offset:1024
    v_fma_f32 v81, v81, s28, v12
    v_mfma_f32_16x16x32_bf16 v[116:119], a[216:219], v[14:17], v[116:119]
    s_waitcnt lgkmcnt(7)
    v_exp_f32 v77, v77
    v_mfma_f32_16x16x32_bf16 v[120:123], a[220:223], v[14:17], v[120:123]
    v_exp_f32 v68, v68
    v_mfma_f32_16x16x32_bf16 v[168:171], a[220:223], v[20:23], v[168:171]
    ds_read_b64_tr_b16 a[218:219], v5 offset:7168
    v_add_u32 v104, s38, v104
    v_mfma_f32_16x16x32_bf16 v[216:219], a[220:223], v[26:29], v[216:219]
    ds_read_b64_tr_b16 a[214:215], v4 offset:7168
    v_fma_f32 v71, v71, s28, v11
    v_mfma_f32_16x16x32_bf16 a[8:11], a[220:223], v[32:35], a[8:11]
    s_waitcnt lgkmcnt(6)
    ds_read_b64_tr_b16 a[220:221], v2 offset:2048
    v_xor_b32 v105, 64, v104
    v_mfma_f32_16x16x32_bf16 a[12:15], a[224:227], v[32:35], a[12:15]
    ds_read_b128 a[100:103], v105 offset:0
    v_exp_f32 v72, v72
    v_mfma_f32_16x16x32_bf16 v[220:223], a[224:227], v[26:29], v[220:223]
    ds_read_b64_tr_b16 a[216:217], v5 offset:1024
    v_fma_f32 v79, v79, s28, v12
    v_mfma_f32_16x16x32_bf16 v[172:175], a[224:227], v[20:23], v[172:175]
    v_exp_f32 v79, v79
    v_mfma_f32_16x16x32_bf16 v[124:127], a[224:227], v[14:17], v[124:127]
    s_waitcnt lgkmcnt(6)
    v_exp_f32 v70, v70
    v_mfma_f32_16x16x32_bf16 v[128:131], a[228:231], v[14:17], v[128:131]
    ds_read_b64_tr_b16 a[222:223], v2 offset:8192
    v_exp_f32 v62, v62
    v_mfma_f32_16x16x32_bf16 v[176:179], a[228:231], v[20:23], v[176:179]
    ds_read_b64_tr_b16 a[224:225], v3 offset:2048
    v_fma_f32 v58, v58, s28, v9
    v_mfma_f32_16x16x32_bf16 v[224:227], a[228:231], v[26:29], v[224:227]
    ds_read_b64_tr_b16 a[226:227], v3 offset:8192
    v_fma_f32 v67, v67, s28, v10
    v_mfma_f32_16x16x32_bf16 a[16:19], a[228:231], v[32:35], a[16:19]
    ds_read_b64_tr_b16 a[228:229], v4 offset:2048
    v_fma_f32 v69, v69, s28, v11
    v_mfma_f32_16x16x32_bf16 a[20:23], a[232:235], v[32:35], a[20:23]
    ds_read_b64_tr_b16 a[230:231], v4 offset:8192
    v_fma_f32 v74, v74, s28, v11
    v_mfma_f32_16x16x32_bf16 v[228:231], a[232:235], v[26:29], v[228:231]
    ds_read_b128 a[160:163], v104 offset:16384
    v_fma_f32 v65, v65, s28, v10
    v_mfma_f32_16x16x32_bf16 v[180:183], a[232:235], v[20:23], v[180:183]
    v_exp_f32 v76, v76
    v_mfma_f32_16x16x32_bf16 v[132:135], a[232:235], v[14:17], v[132:135]
    s_waitcnt lgkmcnt(6)
    ds_read_b128 a[152:155], v104 offset:14336
    v_exp_f32 v81, v81
    v_mfma_f32_16x16x32_bf16 v[136:139], a[212:215], v[14:17], v[136:139]
    ds_read_b64_tr_b16 a[234:235], v5 offset:8192
    v_fma_f32 v57, v57, s28, v9
    v_mfma_f32_16x16x32_bf16 v[184:187], a[212:215], v[20:23], v[184:187]
    ds_read_b64_tr_b16 a[232:233], v5 offset:2048
    v_fma_f32 v78, v78, s28, v12
    v_mfma_f32_16x16x32_bf16 v[232:235], a[212:215], v[26:29], v[232:235]
    ds_read_b128 a[148:151], v105 offset:12288
    v_cvt_pk_bf16_f32 v36, v76, v77
    v_mfma_f32_16x16x32_bf16 a[24:27], a[212:215], v[32:35], a[24:27]
    ds_read_b128 a[176:179], v104 offset:20480
    v_exp_f32 v57, v57
    v_mfma_f32_16x16x32_bf16 a[28:31], a[216:219], v[32:35], a[28:31]
    v_exp_f32 v71, v71
    v_mfma_f32_16x16x32_bf16 v[236:239], a[216:219], v[26:29], v[236:239]
    ds_read_b128 a[124:127], v105 offset:6144
    v_exp_f32 v73, v73
    v_mfma_f32_16x16x32_bf16 v[188:191], a[216:219], v[20:23], v[188:191]
    ds_read_b128 a[172:175], v105 offset:18432
    v_cvt_pk_bf16_f32 v31, v70, v71
    v_mfma_f32_16x16x32_bf16 v[140:143], a[216:219], v[14:17], v[140:143]
    s_waitcnt lgkmcnt(7)
    ds_read_b128 a[144:147], v104 offset:12288
    v_exp_f32 v78, v78
    v_mfma_f32_16x16x32_bf16 v[144:147], a[220:223], v[14:17], v[144:147]
    ds_read_b128 a[120:123], v104 offset:6144
    v_fma_f32 v80, v80, s28, v12
    v_mfma_f32_16x16x32_bf16 v[192:195], a[220:223], v[20:23], v[192:195]
    ds_read_b128 a[168:171], v104 offset:18432
    v_fma_f32 v63, v63, s28, v10
    v_mfma_f32_16x16x32_bf16 v[240:243], a[220:223], v[26:29], v[240:243]
    s_waitcnt vmcnt(10) lgkmcnt(7)
    v_exp_f32 v69, v69
    v_mfma_f32_16x16x32_bf16 a[32:35], a[220:223], v[32:35], a[32:35]
    s_barrier
    v_mfma_f32_16x16x32_bf16 a[36:39], a[224:227], v[32:35], a[36:39]
    s_add_u32 s21, s21, s62
    ds_read_b128 a[108:111], v105 offset:2048
    v_fma_f32 v56, v56, s28, v9
    v_mfma_f32_16x16x32_bf16 v[244:247], a[224:227], v[26:29], v[244:247]
    s_add_u32 m0, s22, 24576
    ds_read_b128 a[212:215], v0 offset:0
    buffer_load_dwordx4 v6, s[8:11], s21 offen lds
    v_mfma_f32_16x16x32_bf16 v[196:199], a[224:227], v[20:23], v[196:199]
    s_add_u32 s21, s21, 128
    ds_read_b128 a[96:99], v104 offset:0
    v_fma_f32 v82, v82, s28, v12
    v_mfma_f32_16x16x32_bf16 v[148:151], a[224:227], v[14:17], v[148:151]
    s_add_u32 m0, s22, 25600
    ds_read_b128 a[104:107], v104 offset:2048
    buffer_load_dwordx4 v6, s[8:11], s21 offen lds
    v_mfma_f32_16x16x32_bf16 v[152:155], a[228:231], v[14:17], v[152:155]
    ds_read_b128 a[216:219], v1 offset:0
    v_fma_f32 v66, v66, s28, v10
    v_mfma_f32_16x16x32_bf16 v[200:203], a[228:231], v[20:23], v[200:203]
    s_add_u32 s21, s21, 128
    ds_read_b128 a[224:227], v1 offset:1024
    v_fma_f32 v64, v64, s28, v10
    v_mfma_f32_16x16x32_bf16 v[248:251], a[228:231], v[26:29], v[248:251]
    s_add_u32 m0, s22, 26624
    ds_read_b128 a[128:131], v104 offset:8192
    buffer_load_dwordx4 v6, s[8:11], s21 offen lds
    v_mfma_f32_16x16x32_bf16 a[40:43], a[228:231], v[32:35], a[40:43]
    v_exp_f32 v58, v58
    v_mfma_f32_16x16x32_bf16 a[44:47], a[232:235], v[32:35], a[44:47]
    v_exp_f32 v56, v56
    v_mfma_f32_16x16x32_bf16 v[252:255], a[232:235], v[26:29], v[252:255]
    ds_read_b128 a[220:223], v0 offset:1024
    v_exp_f32 v63, v63
    v_mfma_f32_16x16x32_bf16 v[204:207], a[232:235], v[20:23], v[204:207]
    ds_read_b128 a[180:183], v105 offset:20480
    v_fma_f32 v75, v75, s28, v11
    v_mfma_f32_16x16x32_bf16 v[156:159], a[232:235], v[14:17], v[156:159]
    s_waitcnt lgkmcnt(6)
    ds_read_b128 a[164:167], v105 offset:16384
    v_cvt_pk_bf16_f32 v25, v62, v63
    v_mfma_f32_16x16x32_bf16 v[52:55], a[212:215], a[96:99], 0
    ds_read_b128 a[156:159], v105 offset:14336
    v_cvt_pk_bf16_f32 v37, v78, v79
    v_mfma_f32_16x16x32_bf16 v[60:63], a[212:215], a[120:123], 0
    ds_read_b128 a[132:135], v105 offset:8192
    v_cvt_pk_bf16_f32 v30, v68, v69
    v_mfma_f32_16x16x32_bf16 v[68:71], a[212:215], a[144:147], 0
    v_exp_f32 v67, v67
    v_mfma_f32_16x16x32_bf16 v[76:79], a[212:215], a[168:171], 0
    s_waitcnt lgkmcnt(6)
    v_exp_f32 v74, v74
    v_mfma_f32_16x16x32_bf16 v[52:55], a[216:219], a[100:103], v[52:55]
    ds_read_b128 a[228:231], v0 offset:6144
    v_fma_f32 v59, v59, s28, v9
    v_mfma_f32_16x16x32_bf16 v[60:63], a[216:219], a[124:127], v[60:63]
    v_exp_f32 v65, v65
    v_mfma_f32_16x16x32_bf16 v[68:71], a[216:219], a[148:151], v[68:71]
    v_exp_f32 v66, v66
    v_mfma_f32_16x16x32_bf16 v[76:79], a[216:219], a[172:175], v[76:79]
    s_waitcnt lgkmcnt(5)
    v_exp_f32 v75, v75
    v_mfma_f32_16x16x32_bf16 v[52:55], a[220:223], a[104:107], v[52:55]
    v_exp_f32 v64, v64
    v_mfma_f32_16x16x32_bf16 v[60:63], a[220:223], a[128:131], v[60:63]
    ds_read_b128 a[232:235], v1 offset:6144
    v_cvt_pk_bf16_f32 v23, v66, v67
    v_mfma_f32_16x16x32_bf16 v[68:71], a[220:223], a[152:155], v[68:71]
    v_exp_f32 v59, v59
    v_mfma_f32_16x16x32_bf16 v[76:79], a[220:223], a[176:179], v[76:79]
    ds_read_b128 a[212:215], v0 offset:7168
    v_cvt_pk_bf16_f32 v16, v56, v57
    v_mfma_f32_16x16x32_bf16 v[52:55], a[224:227], a[108:111], v[52:55]
    s_waitcnt lgkmcnt(3)
    v_exp_f32 v82, v82
    v_mfma_f32_16x16x32_bf16 v[60:63], a[224:227], a[132:135], v[60:63]
    v_cvt_pk_bf16_f32 v22, v64, v65
    v_cvt_pk_bf16_f32 v28, v72, v73
    v_mfma_f32_16x16x32_bf16 v[68:71], a[224:227], a[156:159], v[68:71]
    v_cvt_pk_bf16_f32 v17, v58, v59
    v_fma_f32 v83, v83, s28, v12
    v_mfma_f32_16x16x32_bf16 v[76:79], a[224:227], a[180:183], v[76:79]
    s_waitcnt lgkmcnt(2)
    v_exp_f32 v80, v80
    v_mfma_f32_16x16x32_bf16 v[56:59], a[228:231], a[96:99], 0
    v_exp_f32 v83, v83
    v_mfma_f32_16x16x32_bf16 v[64:67], a[228:231], a[120:123], 0
    ds_read_b128 a[224:227], v1 offset:2048
    v_cvt_pk_bf16_f32 v29, v74, v75
    v_mfma_f32_16x16x32_bf16 v[48:51], a[236:239], v[16:19], v[44:47]
    ds_read_b128 a[216:219], v1 offset:7168
    v_cvt_pk_bf16_f32 v34, v80, v81
    v_mfma_f32_16x16x32_bf16 v[72:75], a[228:231], a[144:147], 0
    ds_read_b128 a[220:223], v0 offset:2048
    v_cvt_pk_bf16_f32 v35, v82, v83
    v_mfma_f32_16x16x32_bf16 v[80:83], a[228:231], a[168:171], 0
    s_waitcnt lgkmcnt(4)
    ds_read_b128 a[112:115], v104 offset:4096
    v_mfma_f32_16x16x32_bf16 v[56:59], a[232:235], a[100:103], v[56:59]
    ds_read_b128 a[228:231], v0 offset:8192
    v_mfma_f32_16x16x32_bf16 v[64:67], a[232:235], a[124:127], v[64:67]
    ds_read_b128 a[136:139], v104 offset:10240
    v_mfma_f32_16x16x32_bf16 v[72:75], a[232:235], a[148:151], v[72:75]
    v_mfma_f32_16x16x32_bf16 v[80:83], a[232:235], a[172:175], v[80:83]
    ds_read_b128 a[232:235], v1 offset:8192
    v_mfma_f32_16x16x32_bf16 v[48:51], a[240:243], v[22:25], v[48:51]
    ds_read_b128 a[116:119], v105 offset:4096
    v_mfma_f32_16x16x32_bf16 v[48:51], a[244:247], v[28:31], v[48:51]
    ds_read_b128 a[140:143], v105 offset:10240
    v_mfma_f32_16x16x32_bf16 v[48:51], a[248:251], v[34:37], v[48:51]
    s_waitcnt lgkmcnt(8)
    ds_read_b128 a[184:187], v104 offset:22528
    v_mfma_f32_16x16x32_bf16 v[56:59], a[212:215], a[104:107], v[56:59]
    v_mfma_f32_16x16x32_bf16 v[64:67], a[212:215], a[128:131], v[64:67]
    ds_read_b128 a[188:191], v105 offset:22528
    v_mfma_f32_16x16x32_bf16 v[72:75], a[212:215], a[152:155], v[72:75]
    s_nop 1
    v_cmp_lt_f32 vcc, s29, v48
    v_mfma_f32_16x16x32_bf16 v[80:83], a[212:215], a[176:179], v[80:83]
    s_waitcnt lgkmcnt(6)
    v_mfma_f32_16x16x32_bf16 v[56:59], a[216:219], a[108:111], v[56:59]
    s_add_u32 s21, s21, 12032
    v_mfma_f32_16x16x32_bf16 v[64:67], a[216:219], a[132:135], v[64:67]
    s_cbranch_vccnz L_rs_tr44b
L_ret_tr44b:
    s_waitcnt vmcnt(10) lgkmcnt(4)
    v_mfma_f32_16x16x32_bf16 v[72:75], a[216:219], a[156:159], v[72:75]
    s_barrier
    v_mfma_f32_16x16x32_bf16 v[80:83], a[216:219], a[180:183], v[80:83]
    s_add_u32 m0, s22, 0
    ds_read_b64_tr_b16 a[212:213], v2 offset:18432
    buffer_load_dwordx4 v6, s[4:7], s20 offen lds
    v_mfma_f32_16x16x32_bf16 v[52:55], a[220:223], a[112:115], v[52:55]
    s_add_u32 s20, s20, 128
    ds_read_b64_tr_b16 a[214:215], v2 offset:12288
    v_lshrrev_b32 v108, 11, v0
    v_mfma_f32_16x16x32_bf16 v[60:63], a[220:223], a[136:139], v[60:63]
    s_add_u32 m0, s22, 1024
    ds_read_b64_tr_b16 a[216:217], v3 offset:18432
    buffer_load_dwordx4 v6, s[4:7], s20 offen lds
    v_mfma_f32_16x16x32_bf16 v[68:71], a[220:223], a[160:163], v[68:71]
    s_waitcnt lgkmcnt(3)
    v_rcp_f32 v50, v50
    v_mfma_f32_16x16x32_bf16 v[76:79], a[220:223], a[184:187], v[76:79]
    s_add_u32 s20, s20, 128
    v_mov_b32 v100, v48
    v_xor_b32 v108, s65, v108
    v_mfma_f32_16x16x32_bf16 v[52:55], a[224:227], a[116:119], v[52:55]
    s_add_u32 m0, s22, 2048
    v_rcp_f32 v8, v51
    v_mfma_f32_16x16x32_bf16 v[60:63], a[224:227], a[140:143], v[60:63]
    buffer_load_dwordx4 v6, s[4:7], s20 offen lds
    v_mfma_f32_16x16x32_bf16 v[68:71], a[224:227], a[164:167], v[68:71]
    v_and_b32 v101, 0x3ff, v0
    v_lshl_add_u32 v101, v108, 10, v101
    v_mfma_f32_16x16x32_bf16 v[76:79], a[224:227], a[188:191], v[76:79]
    s_add_u32 s20, s20, 12032
    ds_read_b64_tr_b16 a[218:219], v3 offset:12288
    v_mbcnt_lo_u32_b32 v108, -1, 0
    v_mfma_f32_16x16x32_bf16 v[56:59], a[228:231], a[112:115], v[56:59]
    v_rcp_f32 v102, v49
    v_mfma_f32_16x16x32_bf16 v[64:67], a[228:231], a[136:139], v[64:67]
    v_mbcnt_hi_u32_b32 v108, -1, v108
    v_lshrrev_b32 v108, 1, v108
    v_mfma_f32_16x16x32_bf16 v[72:75], a[228:231], a[160:163], v[72:75]
    ds_read_b64_tr_b16 a[220:221], v4 offset:18432
    v_and_b32 v108, 24, v108
    v_mfma_f32_16x16x32_bf16 v[80:83], a[228:231], a[184:187], v[80:83]
    v_permlane32_swap_b32 v48, v100
    v_mfma_f32_16x16x32_bf16 v[56:59], a[232:235], a[116:119], v[56:59]
    ds_read_b64_tr_b16 a[222:223], v4 offset:12288
    v_bfe_u32 v108, s66, v108, 8
    v_mfma_f32_16x16x32_bf16 v[64:67], a[232:235], a[140:143], v[64:67]
    s_waitcnt lgkmcnt(3)
    v_rcp_f32 v48, v48
    v_mfma_f32_16x16x32_bf16 v[72:75], a[232:235], a[164:167], v[72:75]
    ds_read_b64_tr_b16 a[224:225], v5 offset:18432
    v_add_u32 v101, s38, v101
    v_mfma_f32_16x16x32_bf16 v[80:83], a[232:235], a[188:191], v[80:83]
    ds_read_b64_tr_b16 a[226:227], v5 offset:12288
    v_xor_b32 v101, v101, v108
    v_max3_f32 v99, v76, v77, v78
    v_mfma_f32_16x16x32_bf16 v[112:115], a[212:215], v[16:19], v[112:115]
    s_mov_b32 s67, s34
    ds_read_b64_tr_b16 a[234:235], v3 offset:13312
    v_max3_f32 v97, v60, v61, v62
    v_max3_f32 v96, v52, v53, v54
    v_max3_f32 v99, v99, v79, v80
    v_max3_f32 v96, v96, v55, v56
    v_max3_f32 v98, v68, v69, v70
    v_max3_f32 v97, v97, v63, v64
    v_max3_f32 v96, v96, v57, v58
    v_mfma_f32_16x16x32_bf16 v[160:163], a[212:215], v[22:25], v[160:163]
    ds_read_b64_tr_b16 a[230:231], v2 offset:13312
    v_max3_f32 v97, v97, v65, v66
    v_max3_f32 v99, v99, v81, v82
    v_max3_f32 v98, v98, v71, v72
    v_mfma_f32_16x16x32_bf16 v[208:211], a[212:215], v[28:31], v[208:211]
    v_mov_b32 v38, v6
    v_max3_f32 v98, v98, v73, v74
    v_mfma_f32_16x16x32_bf16 a[0:3], a[212:215], v[34:37], a[0:3]
    s_waitcnt lgkmcnt(6)
    v_max_f32 v96, v96, v59
    v_max_f32 v98, v98, v75
    v_max_f32 v99, v99, v83
    v_mfma_f32_16x16x32_bf16 a[4:7], a[216:219], v[34:37], a[4:7]
    ds_read_b64_tr_b16 a[232:233], v3 offset:19456
    v_max_f32 v97, v97, v67
    v_mfma_f32_16x16x32_bf16 v[212:215], a[216:219], v[28:31], v[212:215]
    s_add_u32 s18, s34, 24576
    ds_read_b64_tr_b16 a[214:215], v4 offset:13312
    v_permlane32_swap_b32 v98, v99
    v_mfma_f32_16x16x32_bf16 v[164:167], a[216:219], v[22:25], v[164:167]
    v_permlane32_swap_b32 v96, v97
    v_mfma_f32_16x16x32_bf16 v[116:119], a[216:219], v[16:19], v[116:119]
    s_waitcnt lgkmcnt(4)
    ds_read_b64_tr_b16 a[228:229], v2 offset:19456
    v_max_f32 v98, v98, v99
    v_max_f32 v96, v96, v97
    v_mfma_f32_16x16x32_bf16 v[120:123], a[220:223], v[16:19], v[120:123]
    s_nop 0
    v_permlane16_swap_b32 v96, v98
    v_max_f32 v96, v96, v98
    v_mfma_f32_16x16x32_bf16 v[168:171], a[220:223], v[22:25], v[168:171]
    s_mov_b32 s34, s33
    v_mul_f32_e64 v9, -s28, v96
    v_mov_b32 v11, v9
    v_mfma_f32_16x16x32_bf16 v[216:219], a[220:223], v[28:31], v[216:219]
    s_add_u32 s64, s64, s62
    ds_read_b64_tr_b16 a[216:217], v5 offset:19456
    v_permlane16_swap_b32 v9, v11
    v_mov_b32 v10, v9
    v_mfma_f32_16x16x32_bf16 a[8:11], a[220:223], v[34:37], a[8:11]
    s_add_u32 s64, s64, 196608
    ds_read_b64_tr_b16 a[212:213], v4 offset:19456
    v_mov_b32 v12, v11
    v_permlane32_swap_b32 v9, v10
    v_fma_f32 v62, v62, s28, v10
    v_mfma_f32_16x16x32_bf16 a[12:15], a[224:227], v[34:37], a[12:15]
    s_mov_b32 s39, s64
    v_fma_f32 v66, v66, s28, v10
    v_accvgpr_read_b32 v106, a2
    v_mfma_f32_16x16x32_bf16 v[220:223], a[224:227], v[28:31], v[220:223]
    s_add_u32 s37, s37, 1
    ds_read_b64_tr_b16 a[218:219], v5 offset:13312
    v_fma_f32 v54, v54, s28, v9
    v_mfma_f32_16x16x32_bf16 v[172:175], a[224:227], v[22:25], v[172:175]
    s_bitcmp1_b32 s63, s37
    ds_read_b64_tr_b16 a[222:223], v2 offset:14336
    v_exp_f32 v54, v54
    v_mfma_f32_16x16x32_bf16 v[124:127], a[224:227], v[16:19], v[124:127]
    s_waitcnt lgkmcnt(4)
    v_fma_f32 v56, v56, s28, v9
    v_accvgpr_read_b32 v111, a7
    s_cselect_b32 s62, 4294770688, 0
    v_mfma_f32_16x16x32_bf16 v[128:131], a[228:231], v[16:19], v[128:131]
    s_cselect_b32 s42, 0, 325632
    v_permlane32_swap_b32 v11, v12
    v_mfma_f32_16x16x32_bf16 v[176:179], a[228:231], v[22:25], v[176:179]
    s_add_u32 s35, s35, s42
    ds_read_b64_tr_b16 a[226:227], v3 offset:14336
    v_fma_f32 v69, v69, s28, v11
    v_mfma_f32_16x16x32_bf16 v[224:227], a[228:231], v[28:31], v[224:227]
    s_lshl_b32 s42, s37, 1
    ds_read_b64_tr_b16 a[220:221], v2 offset:20480
    s_lshr_b32 s42, s31, s42
    v_mfma_f32_16x16x32_bf16 a[16:19], a[228:231], v[34:37], a[16:19]
    s_and_b32 s42, s42, 3
    ds_read_b64_tr_b16 a[224:225], v3 offset:20480
    v_exp_f32 v69, v69
    v_mfma_f32_16x16x32_bf16 a[20:23], a[232:235], v[34:37], a[20:23]
    s_add_u32 s42, s42, s36
    v_fma_f32 v81, v81, s28, v12
    v_fma_f32 v65, v65, s28, v10
    v_mfma_f32_16x16x32_bf16 v[228:231], a[232:235], v[28:31], v[228:231]
    s_sub_u32 s43, s42, 3
    ds_read_b64_tr_b16 a[230:231], v4 offset:14336
    v_fma_f32 v60, v60, s28, v10
    v_mfma_f32_16x16x32_bf16 v[180:183], a[232:235], v[22:25], v[180:183]
    s_cmp_ge_u32 s42, 3
    v_fma_f32 v58, v58, s28, v9
    v_fma_f32 v72, v72, s28, v11
    v_mfma_f32_16x16x32_bf16 v[132:135], a[232:235], v[16:19], v[132:135]
    s_waitcnt lgkmcnt(4)
    ds_read_b64_tr_b16 a[234:235], v5 offset:14336
    v_fma_f32 v79, v79, s28, v12
    v_mfma_f32_16x16x32_bf16 v[136:139], a[212:215], v[16:19], v[136:139]
    s_cselect_b32 s42, s43, s42
    v_fma_f32 v67, v67, s28, v10
    v_fma_f32 v78, v78, s28, v12
    v_fma_f32 v83, v83, s28, v12
    v_mfma_f32_16x16x32_bf16 v[184:187], a[212:215], v[22:25], v[184:187]
    s_mul_i32 s44, s3, 5
    ds_read_b64_tr_b16 a[228:229], v4 offset:20480
    v_fma_f32 v70, v70, s28, v11
    v_fma_f32 v52, v52, s28, v9
    v_mfma_f32_16x16x32_bf16 v[232:235], a[212:215], v[28:31], v[232:235]
    s_mov_b32 s32, 1
    v_fma_f32 v73, v73, s28, v11
    v_fma_f32 v53, v53, s28, v9
    v_mfma_f32_16x16x32_bf16 a[24:27], a[212:215], v[34:37], a[24:27]
    s_lshl_b32 s43, s3, 2
    v_exp_f32 v70, v70
    v_mfma_f32_16x16x32_bf16 a[28:31], a[216:219], v[34:37], a[28:31]
    s_add_u32 s45, s43, 21
    v_fma_f32 v71, v71, s28, v11
    v_fma_f32 v77, v77, s28, v12
    v_mfma_f32_16x16x32_bf16 v[236:239], a[216:219], v[28:31], v[236:239]
    s_cmp_eq_u32 s3, 0
    s_cselect_b32 s45, 20, s45
    v_fma_f32 v55, v55, s28, v9
    v_mfma_f32_16x16x32_bf16 v[188:191], a[216:219], v[22:25], v[188:191]
    s_cselect_b32 s33, 1, 0
    ds_read_b64_tr_b16 a[232:233], v5 offset:20480
    v_fma_f32 v68, v68, s28, v11
    v_exp_f32 v60, v60
    s_cmp_eq_u32 s42, 1
    v_mfma_f32_16x16x32_bf16 v[140:143], a[216:219], v[16:19], v[140:143]
    s_cselect_b32 s44, s45, s44
    v_exp_f32 v55, v55
    s_waitcnt lgkmcnt(2)
    v_mfma_f32_16x16x32_bf16 v[144:147], a[220:223], v[16:19], v[144:147]
    s_cselect_b32 s32, s33, s32
    v_exp_f32 v52, v52
    v_mfma_f32_16x16x32_bf16 v[192:195], a[220:223], v[22:25], v[192:195]
    s_add_u32 s45, s43, 37
    v_exp_f32 v79, v79
    v_mfma_f32_16x16x32_bf16 v[240:243], a[220:223], v[28:31], v[240:243]
    s_cmp_eq_u32 s42, 2
    v_exp_f32 v53, v53
    v_mfma_f32_16x16x32_bf16 a[32:35], a[220:223], v[34:37], a[32:35]
    s_cselect_b32 s44, s45, s44
    v_fma_f32 v76, v76, s28, v12
    s_cselect_b32 s32, 0, s32
    s_mul_i32 s44, s44, 6144
    v_mfma_f32_16x16x32_bf16 a[36:39], a[224:227], v[34:37], a[36:39]
    s_add_u32 s33, s35, s44
    s_mul_i32 s42, s32, 6144
    v_cvt_pk_bf16_f32 v15, v54, v55
    v_exp_f32 v78, v78
    s_add_u32 s42, s42, 24576
    v_pk_mul_f32 v[212:213], v[212:213], v[50:51] op_sel_hi:[1,0]
    s_add_u32 s42, s42, s33
    s_cmp_ge_u32 s37, 6
    v_mfma_f32_16x16x32_bf16 v[244:247], a[224:227], v[28:31], v[244:247]
    s_cselect_b32 s14, 0, s42
    s_add_u32 s24, s67, 6144
    s_add_u32 s25, s33, 6144
    v_fma_f32 v61, v61, s28, v10
    v_mfma_f32_16x16x32_bf16 v[196:199], a[224:227], v[22:25], v[196:199]
    s_add_u32 s23, s38, 6144
    v_exp_f32 v61, v61
    s_mov_b32 s27, 0x30c30
    v_mfma_f32_16x16x32_bf16 v[148:151], a[224:227], v[16:19], v[148:151]
    s_mov_b32 s89, 0xaaaaaaaa
    s_mov_b32 s30, 0
    s_waitcnt vmcnt(8) lgkmcnt(0)
    v_mfma_f32_16x16x32_bf16 v[152:155], a[228:231], v[16:19], v[152:155]
    s_barrier
    ds_read_b128 a[212:215], v0 offset:12288
    v_cvt_pk_bf16_f32 v20, v60, v61
    v_mfma_f32_16x16x32_bf16 v[200:203], a[228:231], v[22:25], v[200:203]
    ds_read_b128 a[216:219], v1 offset:12288
    v_fma_f32 v80, v80, s28, v12
    v_mfma_f32_16x16x32_bf16 v[248:251], a[228:231], v[28:31], v[248:251]
    ds_read_b128 a[220:223], v0 offset:13312
    v_accvgpr_read_b32 v109, a5
    v_exp_f32 v71, v71
    v_fma_f32 v64, v64, s28, v10
    v_mfma_f32_16x16x32_bf16 a[40:43], a[228:231], v[34:37], a[40:43]
    ds_read_b128 a[224:227], v1 offset:13312
    v_accvgpr_read_b32 v107, a3
    v_fma_f32 v57, v57, s28, v9
    v_fma_f32 v59, v59, s28, v9
    v_exp_f32 v68, v68
    v_fma_f32 v82, v82, s28, v12
    v_cvt_pk_bf16_f32 v14, v52, v53
    v_cvt_pk_bf16_f32 v26, v68, v69
    v_mfma_f32_16x16x32_bf16 a[44:47], a[232:235], v[34:37], a[44:47]
    v_exp_f32 v77, v77
    v_fma_f32 v63, v63, s28, v10
    v_mfma_f32_16x16x32_bf16 v[252:255], a[232:235], v[28:31], v[252:255]
    v_exp_f32 v67, v67
    v_mfma_f32_16x16x32_bf16 v[204:207], a[232:235], v[22:25], v[204:207]
    ds_read_b128 a[228:231], v0 offset:14336
    v_exp_f32 v76, v76
    v_mfma_f32_16x16x32_bf16 v[156:159], a[232:235], v[16:19], v[156:159]
    s_waitcnt lgkmcnt(4)
    v_exp_f32 v62, v62
    v_fma_f32 v75, v75, s28, v11
    v_exp_f32 v63, v63
    v_mfma_f32_16x16x32_bf16 v[52:55], a[212:215], a[96:99], 0
    s_waitcnt lgkmcnt(2)
    v_cvt_pk_bf16_f32 v21, v62, v63
    v_exp_f32 v82, v82
    v_cvt_pk_bf16_f32 v32, v76, v77
    v_mfma_f32_16x16x32_bf16 v[52:55], a[216:219], a[100:103], v[52:55]
    v_cvt_pk_bf16_f32 v33, v78, v79
    v_cvt_pk_bf16_f32 v27, v70, v71
    v_mfma_f32_16x16x32_bf16 v[52:55], a[220:223], a[104:107], v[52:55]
    ds_read_b128 a[232:235], v1 offset:14336
    v_subrev_u32 v103, 24576, v103
    v_mfma_f32_16x16x32_bf16 v[60:63], a[220:223], a[128:131], 0
    v_exp_f32 v81, v81
    v_mfma_f32_16x16x32_bf16 v[60:63], a[216:219], a[124:127], v[60:63]
    s_add_u32 m0, s22, 36864
    v_exp_f32 v56, v56
    v_mfma_f32_16x16x32_bf16 v[60:63], a[212:215], a[120:123], v[60:63]
    v_fma_f32 v74, v74, s28, v11
    v_cvt_pk_bf16_f32 v212, v212, v213
    v_mfma_f32_16x16x32_bf16 v[68:71], a[212:215], a[144:147], 0
    v_exp_f32 v74, v74
    v_mfma_f32_16x16x32_bf16 v[68:71], a[216:219], a[148:151], v[68:71]
    v_exp_f32 v65, v65
    v_mfma_f32_16x16x32_bf16 v[68:71], a[220:223], a[152:155], v[68:71]
    v_exp_f32 v73, v73
    v_exp_f32 v83, v83
    v_mfma_f32_16x16x32_bf16 v[76:79], a[220:223], a[176:179], 0
    buffer_load_dwordx4 v6, s[8:11], s21 offen lds
    v_mfma_f32_16x16x32_bf16 v[76:79], a[216:219], a[172:175], v[76:79]
    v_exp_f32 v57, v57
    v_mfma_f32_16x16x32_bf16 v[76:79], a[212:215], a[168:171], v[76:79]
    s_waitcnt lgkmcnt(1)
    v_exp_f32 v72, v72
    v_mfma_f32_16x16x32_bf16 v[76:79], a[224:227], a[180:183], v[76:79]
    v_cvt_pk_bf16_f32 v16, v56, v57
    v_accvgpr_read_b32 v104, a0
    v_mfma_f32_16x16x32_bf16 v[76:79], a[228:231], a[184:187], v[76:79]
    s_waitcnt lgkmcnt(0)
    v_exp_f32 v75, v75
    v_mfma_f32_16x16x32_bf16 v[76:79], a[232:235], a[188:191], v[76:79]
    v_exp_f32 v66, v66
    v_mfma_f32_16x16x32_bf16 v[68:71], a[232:235], a[164:167], v[68:71]
    v_accvgpr_read_b32 v105, a1
    v_cvt_pk_bf16_f32 v23, v66, v67
    v_mfma_f32_16x16x32_bf16 v[68:71], a[228:231], a[160:163], v[68:71]
    v_exp_f32 v59, v59
    v_mfma_f32_16x16x32_bf16 v[68:71], a[224:227], a[156:159], v[68:71]
    ds_read_b128 a[216:219], v1 offset:18432
    v_exp_f32 v80, v80
    v_mfma_f32_16x16x32_bf16 v[60:63], a[224:227], a[132:135], v[60:63]
    s_add_u32 s21, s21, 128
    v_fma_f32 v78, v78, s28, v12
    v_fma_f32 v77, v77, s28, v12
    v_mfma_f32_16x16x32_bf16 v[60:63], a[228:231], a[136:139], v[60:63]
    ds_read_b128 a[212:215], v0 offset:18432
    v_cvt_pk_bf16_f32 v34, v80, v81
    v_mfma_f32_16x16x32_bf16 v[60:63], a[232:235], a[140:143], v[60:63]
    v_exp_f32 v58, v58
    v_mfma_f32_16x16x32_bf16 v[52:55], a[232:235], a[116:119], v[52:55]
    v_cvt_pk_bf16_f32 v17, v58, v59
    v_accvgpr_read_b32 v110, a6
    v_mfma_f32_16x16x32_bf16 v[52:55], a[228:231], a[112:115], v[52:55]
    v_accvgpr_read_b32 v108, a4
    v_exp_f32 v64, v64
    v_mfma_f32_16x16x32_bf16 v[52:55], a[224:227], a[108:111], v[52:55]
    s_add_u32 m0, s22, 37888
    ds_read_b128 a[224:227], v1 offset:19456
    v_fma_f32 v70, v70, s28, v11
    v_mfma_f32_16x16x32_bf16 v[44:47], a[236:239], v[14:17], 0
    ds_read_b128 a[220:223], v0 offset:19456
    v_exp_f32 v77, v77
    v_exp_f32 v70, v70
    v_pk_mul_f32 v[226:227], v[226:227], v[50:51] op_sel_hi:[1,0]
    v_pk_mul_f32 v[114:115], v[114:115], v[48:49] op_sel_hi:[1,0]
    v_pk_mul_f32 v[216:217], v[216:217], v[50:51] op_sel_hi:[1,0]
    v_pk_mul_f32 v[124:125], v[124:125], v[48:49] op_sel_hi:[1,0]
    v_pk_mul_f32 v[128:129], v[128:129], v[48:49] op_sel_hi:[1,0]
    v_pk_mul_f32 v[122:123], v[122:123], v[48:49] op_sel_hi:[1,0]
    v_pk_mul_f32 v[220:221], v[220:221], v[50:51] op_sel_hi:[1,0]
    v_pk_mul_f32 v[166:167], v[166:167], v[102:103] op_sel_hi:[1,0]
    v_pk_mul_f32 v[160:161], v[160:161], v[102:103] op_sel_hi:[1,0]
    v_cvt_pk_bf16_f32 v216, v216, v217
    v_pk_mul_f32 v[120:121], v[120:121], v[48:49] op_sel_hi:[1,0]
    v_pk_mul_f32 v[112:113], v[112:113], v[48:49] op_sel_hi:[1,0]
    v_pk_mul_f32 v[168:169], v[168:169], v[102:103] op_sel_hi:[1,0]
    v_pk_mul_f32 v[150:151], v[150:151], v[48:49] op_sel_hi:[1,0]
    v_pk_mul_f32 v[108:109], v[108:109], v[8:9] op_sel_hi:[1,0]
    v_pk_mul_f32 v[232:233], v[232:233], v[50:51] op_sel_hi:[1,0]
    v_cvt_pk_bf16_f32 v29, v74, v75
    v_cvt_pk_bf16_f32 v28, v72, v73
    v_pk_mul_f32 v[224:225], v[224:225], v[50:51] op_sel_hi:[1,0]
    v_pk_mul_f32 v[236:237], v[236:237], v[50:51] op_sel_hi:[1,0]
    v_pk_mul_f32 v[208:209], v[208:209], v[50:51] op_sel_hi:[1,0]
    v_pk_mul_f32 v[176:177], v[176:177], v[102:103] op_sel_hi:[1,0]
    v_pk_mul_f32 v[118:119], v[118:119], v[48:49] op_sel_hi:[1,0]
    v_pk_mul_f32 v[162:163], v[162:163], v[102:103] op_sel_hi:[1,0]
    v_pk_mul_f32 v[192:193], v[192:193], v[102:103] op_sel_hi:[1,0]
    v_pk_mul_f32 v[186:187], v[186:187], v[102:103] op_sel_hi:[1,0]
    v_pk_mul_f32 v[172:173], v[172:173], v[102:103] op_sel_hi:[1,0]
    v_fma_f32 v62, v62, s28, v10
    v_cvt_pk_bf16_f32 v208, v208, v209
    v_pk_mul_f32 v[110:111], v[110:111], v[8:9] op_sel_hi:[1,0]
    v_pk_mul_f32 v[210:211], v[210:211], v[50:51] op_sel_hi:[1,0]
    v_pk_mul_f32 v[164:165], v[164:165], v[102:103] op_sel_hi:[1,0]
    v_pk_mul_f32 v[106:107], v[106:107], v[8:9] op_sel_hi:[1,0]
    v_fma_f32 v76, v76, s28, v12
    v_pk_mul_f32 v[104:105], v[104:105], v[8:9] op_sel_hi:[1,0]
    v_pk_mul_f32 v[116:117], v[116:117], v[48:49] op_sel_hi:[1,0]
    v_pk_mul_f32 v[144:145], v[144:145], v[48:49] op_sel_hi:[1,0]
    v_pk_mul_f32 v[222:223], v[222:223], v[50:51] op_sel_hi:[1,0]
    v_fma_f32 v60, v60, s28, v10
    v_cvt_pk_bf16_f32 v120, v120, v121
    s_waitcnt lgkmcnt(0)
    v_mfma_f32_16x16x32_bf16 v[56:59], a[212:215], a[96:99], 0
    buffer_load_dwordx4 v6, s[8:11], s21 offen lds
    v_fma_f32 v63, v63, s28, v10
    v_fma_f32 v79, v79, s28, v12
    v_cvt_pk_bf16_f32 v22, v64, v65
    v_cvt_pk_bf16_f32 v116, v116, v117
    v_mfma_f32_16x16x32_bf16 v[56:59], a[216:219], a[100:103], v[56:59]
    v_cvt_pk_bf16_f32 v160, v160, v161
    v_fma_f32 v68, v68, s28, v11
    v_mfma_f32_16x16x32_bf16 v[56:59], a[220:223], a[104:107], v[56:59]
    s_add_u32 s21, s21, 128
    ds_read_b128 a[228:231], v0 offset:20480
    v_cvt_pk_bf16_f32 v35, v82, v83
    v_mfma_f32_16x16x32_bf16 v[64:67], a[220:223], a[128:131], 0
    ds_read_b128 a[232:235], v1 offset:20480
    v_cvt_pk_bf16_f32 v112, v112, v113
    v_fma_f32 v52, v52, s28, v9
    v_mfma_f32_16x16x32_bf16 v[64:67], a[216:219], a[124:127], v[64:67]
    v_cvt_pk_bf16_f32 v108, v108, v109
    v_cvt_pk_bf16_f32 v224, v224, v225
    v_fma_f32 v54, v54, s28, v9
    v_mfma_f32_16x16x32_bf16 v[64:67], a[212:215], a[120:123], v[64:67]
    v_cvt_pk_bf16_f32 v164, v164, v165
    v_cvt_pk_bf16_f32 v176, v176, v177
    v_mfma_f32_16x16x32_bf16 v[72:75], a[212:215], a[144:147], 0
    v_cvt_pk_bf16_f32 v104, v104, v105
    v_cvt_pk_bf16_f32 v113, v114, v115
    v_mfma_f32_16x16x32_bf16 v[72:75], a[216:219], a[148:151], v[72:75]
    v_cvt_pk_bf16_f32 v105, v106, v107
    v_cvt_pk_bf16_f32 v225, v226, v227
    v_mfma_f32_16x16x32_bf16 v[72:75], a[220:223], a[152:155], v[72:75]
    s_add_u32 m0, s22, 38912
    v_exp_f32 v68, v68
    v_mfma_f32_16x16x32_bf16 v[80:83], a[220:223], a[176:179], 0
    buffer_load_dwordx4 v6, s[8:11], s21 offen lds
    v_mfma_f32_16x16x32_bf16 v[80:83], a[216:219], a[172:175], v[80:83]
    s_add_u32 s21, s21, 12032
    v_cvt_pk_bf16_f32 v161, v162, v163
    v_cvt_pk_bf16_f32 v168, v168, v169
    v_mfma_f32_16x16x32_bf16 v[80:83], a[212:215], a[168:171], v[80:83]
    v_exp_f32 v60, v60
    v_fma_f32 v69, v69, s28, v11
    v_mfma_f32_16x16x32_bf16 v[80:83], a[224:227], a[180:183], v[80:83]
    s_waitcnt vmcnt(6) lgkmcnt(0)
    v_cvt_pk_bf16_f32 v121, v122, v123
    v_cvt_pk_bf16_f32 v220, v220, v221
    v_mfma_f32_16x16x32_bf16 v[80:83], a[228:231], a[184:187], v[80:83]
    s_barrier
    v_cvt_pk_bf16_f32 v209, v210, v211
    v_mfma_f32_16x16x32_bf16 v[80:83], a[232:235], a[188:191], v[80:83]
    ds_read_b64_tr_b16 a[212:213], v2 offset:0
    v_cvt_pk_bf16_f32 v109, v110, v111
    v_exp_f32 v62, v62
    v_mfma_f32_16x16x32_bf16 v[72:75], a[232:235], a[164:167], v[72:75]
    ds_write2st64_b64 v101, v[112:113], v[160:161] offset0:0 offset1:12
    v_pk_mul_f32 v[244:245], v[244:245], v[50:51] op_sel_hi:[1,0]
    v_fma_f32 v61, v61, s28, v10
    v_cvt_pk_bf16_f32 v117, v118, v119
    v_accvgpr_read_b32 v107, a11
    v_mfma_f32_16x16x32_bf16 v[72:75], a[228:231], a[160:163], v[72:75]
    ds_read_b64_tr_b16 a[214:215], v2 offset:6144
    v_accvgpr_read_b32 v106, a10
    v_mfma_f32_16x16x32_bf16 v[72:75], a[224:227], a[156:159], v[72:75]
    ds_write2st64_b64 v101, v[208:209], v[104:105] offset0:24 offset1:36
    v_pk_mul_f32 v[174:175], v[174:175], v[102:103] op_sel_hi:[1,0]
    v_accvgpr_read_b32 v105, a9
    v_pk_mul_f32 v[126:127], v[126:127], v[48:49] op_sel_hi:[1,0]
    v_pk_mul_f32 v[228:229], v[228:229], v[50:51] op_sel_hi:[1,0]
    v_pk_mul_f32 v[132:133], v[132:133], v[48:49] op_sel_hi:[1,0]
    v_pk_mul_f32 v[180:181], v[180:181], v[102:103] op_sel_hi:[1,0]
    v_pk_mul_f32 v[184:185], v[184:185], v[102:103] op_sel_hi:[1,0]
    v_pk_mul_f32 v[214:215], v[214:215], v[50:51] op_sel_hi:[1,0]
    v_accvgpr_read_b32 v104, a8
    v_cvt_pk_bf16_f32 v213, v214, v215
    v_cvt_pk_bf16_f32 v124, v124, v125
    v_pk_mul_f32 v[148:149], v[148:149], v[48:49] op_sel_hi:[1,0]
    v_pk_mul_f32 v[196:197], v[196:197], v[102:103] op_sel_hi:[1,0]
    v_pk_mul_f32 v[234:235], v[234:235], v[50:51] op_sel_hi:[1,0]
    v_accvgpr_read_b32 v111, a15
    v_cvt_pk_bf16_f32 v132, v132, v133
    v_pk_mul_f32 v[242:243], v[242:243], v[50:51] op_sel_hi:[1,0]
    v_cvt_pk_bf16_f32 v165, v166, v167
    v_pk_mul_f32 v[152:153], v[152:153], v[48:49] op_sel_hi:[1,0]
    v_pk_mul_f32 v[248:249], v[248:249], v[50:51] op_sel_hi:[1,0]
    v_pk_mul_f32 v[156:157], v[156:157], v[48:49] op_sel_hi:[1,0]
    v_exp_f32 v69, v69
    v_pk_mul_f32 v[252:253], v[252:253], v[50:51] op_sel_hi:[1,0]
    v_pk_mul_f32 v[130:131], v[130:131], v[48:49] op_sel_hi:[1,0]
    v_exp_f32 v61, v61
    v_cvt_pk_bf16_f32 v244, v244, v245
    v_fma_f32 v73, v73, s28, v11
    v_pk_mul_f32 v[138:139], v[138:139], v[48:49] op_sel_hi:[1,0]
    v_pk_mul_f32 v[170:171], v[170:171], v[102:103] op_sel_hi:[1,0]
    v_pk_mul_f32 v[218:219], v[218:219], v[50:51] op_sel_hi:[1,0]
    v_pk_mul_f32 v[246:247], v[246:247], v[50:51] op_sel_hi:[1,0]
    v_pk_mul_f32 v[188:189], v[188:189], v[102:103] op_sel_hi:[1,0]
    v_pk_mul_f32 v[200:201], v[200:201], v[102:103] op_sel_hi:[1,0]
    v_pk_mul_f32 v[106:107], v[106:107], v[8:9] op_sel_hi:[1,0]
    v_pk_mul_f32 v[104:105], v[104:105], v[8:9] op_sel_hi:[1,0]
    v_cvt_pk_bf16_f32 v128, v128, v129
    v_xor_b32 v101, 32, v101
    v_pk_mul_f32 v[146:147], v[146:147], v[48:49] op_sel_hi:[1,0]
    v_pk_mul_f32 v[230:231], v[230:231], v[50:51] op_sel_hi:[1,0]
    v_pk_mul_f32 v[198:199], v[198:199], v[102:103] op_sel_hi:[1,0]
    v_pk_mul_f32 v[142:143], v[142:143], v[48:49] op_sel_hi:[1,0]
    v_cvt_pk_bf16_f32 v156, v156, v157
    v_pk_mul_f32 v[190:191], v[190:191], v[102:103] op_sel_hi:[1,0]
    v_exp_f32 v52, v52
    v_exp_f32 v54, v54
    v_mfma_f32_16x16x32_bf16 v[64:67], a[224:227], a[132:135], v[64:67]
    s_add_u32 m0, s22, 12288
    ds_read_b64_tr_b16 a[216:217], v3 offset:0
    buffer_load_dwordx4 v6, s[4:7], s20 offen lds
    v_mfma_f32_16x16x32_bf16 v[64:67], a[228:231], a[136:139], v[64:67]
    ds_read_b64_tr_b16 a[218:219], v3 offset:6144
    v_cvt_pk_bf16_f32 v192, v192, v193
    v_mfma_f32_16x16x32_bf16 v[64:67], a[232:235], a[140:143], v[64:67]
    ds_read_b64_tr_b16 a[220:221], v4 offset:0
    v_cvt_pk_bf16_f32 v236, v236, v237
    v_exp_f32 v79, v79
    v_mfma_f32_16x16x32_bf16 v[56:59], a[232:235], a[116:119], v[56:59]
    ds_write2st64_b64 v101, v[116:117], v[164:165] offset0:0 offset1:12
    v_mfma_f32_16x16x32_bf16 v[44:47], a[240:243], v[20:23], v[44:47]
    ds_read_b64_tr_b16 a[222:223], v4 offset:6144
    v_cvt_pk_bf16_f32 v184, v184, v185
    v_mfma_f32_16x16x32_bf16 v[56:59], a[228:231], a[112:115], v[56:59]
    s_add_u32 s20, s20, 128
    ds_read_b64_tr_b16 a[230:231], v2 offset:7168
    v_fma_f32 v71, v71, s28, v11
    v_cvt_pk_bf16_f32 v221, v222, v223
    v_mfma_f32_16x16x32_bf16 v[56:59], a[224:227], a[108:111], v[56:59]
    ds_read_b64_tr_b16 a[224:225], v5 offset:0
    v_cvt_pk_bf16_f32 v104, v104, v105
    v_mfma_f32_16x16x32_bf16 v[44:47], a[244:247], v[26:29], v[44:47]
    s_waitcnt lgkmcnt(7)
    ds_read_b64_tr_b16 a[226:227], v5 offset:6144
    v_cvt_pk_bf16_f32 v172, v172, v173
    v_mfma_f32_16x16x32_bf16 v[112:115], a[212:215], v[14:17], 0
    ds_write2st64_b64 v101, v[212:213], v[108:109] offset0:24 offset1:36
    v_fma_f32 v56, v56, s28, v9
    v_mfma_f32_16x16x32_bf16 v[160:163], a[212:215], v[20:23], 0
    ds_read_b64_tr_b16 a[234:235], v3 offset:7168
    v_cvt_pk_bf16_f32 v129, v130, v131
    v_cvt_pk_bf16_f32 v200, v200, v201
    v_cvt_pk_bf16_f32 v217, v218, v219
    v_mfma_f32_16x16x32_bf16 v[208:211], a[212:215], v[26:29], 0
    v_cvt_pk_bf16_f32 v125, v126, v127
    v_accvgpr_read_b32 v110, a14
    v_mfma_f32_16x16x32_bf16 a[0:3], a[212:215], v[32:35], 0
    ds_read_b64_tr_b16 a[228:229], v2 offset:1024
    v_xor_b32 v101, 96, v101
    v_cvt_pk_bf16_f32 v188, v188, v189
    v_fma_f32 v55, v55, s28, v9
    v_accvgpr_read_b32 v109, a13
    v_pk_mul_f32 v[238:239], v[238:239], v[50:51] op_sel_hi:[1,0]
    v_pk_mul_f32 v[136:137], v[136:137], v[48:49] op_sel_hi:[1,0]
    v_pk_mul_f32 v[178:179], v[178:179], v[102:103] op_sel_hi:[1,0]
    v_pk_mul_f32 v[110:111], v[110:111], v[8:9] op_sel_hi:[1,0]
    v_cvt_pk_bf16_f32 v105, v106, v107
    v_pk_mul_f32 v[194:195], v[194:195], v[102:103] op_sel_hi:[1,0]
    v_pk_mul_f32 v[240:241], v[240:241], v[50:51] op_sel_hi:[1,0]
    v_cvt_pk_bf16_f32 v232, v232, v233
    v_accvgpr_read_b32 v107, a19
    v_cvt_pk_bf16_f32 v185, v186, v187
    v_pk_mul_f32 v[158:159], v[158:159], v[48:49] op_sel_hi:[1,0]
    v_fma_f32 v80, v80, s28, v12
    v_cvt_pk_bf16_f32 v169, v170, v171
    v_mfma_f32_16x16x32_bf16 v[44:47], a[248:251], v[32:35], v[44:47]
    s_waitcnt lgkmcnt(3)
    ds_write2st64_b64 v101, v[120:121], v[168:169] offset0:0 offset1:12
    v_accvgpr_read_b32 v108, a12
    v_mfma_f32_16x16x32_bf16 a[4:7], a[216:219], v[32:35], 0
    ds_write2st64_b64 v101, v[216:217], v[104:105] offset0:24 offset1:36
    v_pk_mul_f32 v[108:109], v[108:109], v[8:9] op_sel_hi:[1,0]
    v_fma_f32 v53, v53, s28, v9
    v_pk_mul_f32 v[206:207], v[206:207], v[102:103] op_sel_hi:[1,0]
    v_pk_mul_f32 v[154:155], v[154:155], v[48:49] op_sel_hi:[1,0]
    v_pk_mul_f32 v[250:251], v[250:251], v[50:51] op_sel_hi:[1,0]
    v_pk_mul_f32 v[202:203], v[202:203], v[102:103] op_sel_hi:[1,0]
    v_cvt_pk_bf16_f32 v108, v108, v109
    v_fma_f32 v75, v75, s28, v11
    v_xor_b32 v101, 32, v101
    v_accvgpr_read_b32 v106, a18
    v_accvgpr_read_b32 v104, a16
    v_mfma_f32_16x16x32_bf16 v[212:215], a[216:219], v[26:29], 0
    ds_read_b64_tr_b16 a[214:215], v4 offset:7168
    v_cvt_pk_bf16_f32 v144, v144, v145
    v_cvt_pk_bf16_f32 v109, v110, v111
    v_cvt_pk_bf16_f32 v196, v196, v197
    v_cvt_pk_bf16_f32 v173, v174, v175
    v_exp_f32 v80, v80
    v_cvt_pk_bf16_f32 v152, v152, v153
    v_cvt_pk_bf16_f32 v252, v252, v253
    v_pk_mul_f32 v[182:183], v[182:183], v[102:103] op_sel_hi:[1,0]
    v_cvt_pk_bf16_f32 v228, v228, v229
    v_fma_f32 v67, v67, s28, v10
    v_mfma_f32_16x16x32_bf16 v[164:167], a[216:219], v[20:23], 0
    ds_write2st64_b64 v101, v[124:125], v[172:173] offset0:0 offset1:12
    v_cvt_pk_bf16_f32 v153, v154, v155
    v_exp_f32 v53, v53
    v_mfma_f32_16x16x32_bf16 v[116:119], a[216:219], v[14:17], 0
    v_cvt_pk_bf16_f32 v136, v136, v137
    v_cvt_pk_bf16_f32 v248, v248, v249
    v_mfma_f32_16x16x32_bf16 v[120:123], a[220:223], v[14:17], 0
    ds_write2st64_b64 v101, v[220:221], v[108:109] offset0:24 offset1:36
    v_fma_f32 v64, v64, s28, v10
    v_pk_mul_f32 v[106:107], v[106:107], v[8:9] op_sel_hi:[1,0]
    v_exp_f32 v76, v76
    v_cvt_pk_bf16_f32 v137, v138, v139
    v_accvgpr_read_b32 v109, a21
    v_fma_f32 v58, v58, s28, v9
    v_cvt_pk_bf16_f32 v177, v178, v179
    v_cvt_pk_bf16_f32 v180, v180, v181
    v_cvt_pk_bf16_f32 v237, v238, v239
    v_accvgpr_read_b32 v111, a23
    v_fma_f32 v82, v82, s28, v12
    v_mfma_f32_16x16x32_bf16 v[168:171], a[220:223], v[20:23], 0
    ds_read_b64_tr_b16 a[232:233], v3 offset:1024
    v_xor_b32 v101, 96, v101
    v_mfma_f32_16x16x32_bf16 v[216:219], a[220:223], v[26:29], 0
    s_add_u32 m0, s22, 13312
    ds_read_b128 v[96:99], v103 offset:1024
    buffer_load_dwordx4 v6, s[4:7], s20 offen lds
    v_accvgpr_read_b32 v105, a17
    v_accvgpr_read_b32 v110, a22
    v_accvgpr_read_b32 v108, a20
    v_cvt_pk_bf16_f32 v145, v146, v147
    v_pk_mul_f32 v[134:135], v[134:135], v[48:49] op_sel_hi:[1,0]
    v_exp_f32 v82, v82
    v_cvt_pk_bf16_f32 v229, v230, v231
    v_pk_mul_f32 v[104:105], v[104:105], v[8:9] op_sel_hi:[1,0]
    v_cvt_pk_bf16_f32 v189, v190, v191
    v_fma_f32 v59, v59, s28, v9
    v_cvt_pk_bf16_f32 v181, v182, v183
    v_pk_mul_f32 v[110:111], v[110:111], v[8:9] op_sel_hi:[1,0]
    v_pk_mul_f32 v[140:141], v[140:141], v[48:49] op_sel_hi:[1,0]
    v_fma_f32 v83, v83, s28, v12
    v_cvt_pk_bf16_f32 v104, v104, v105
    v_mfma_f32_16x16x32_bf16 a[8:11], a[220:223], v[32:35], 0
    ds_read_b64_tr_b16 a[222:223], v2 offset:8192
    v_cvt_pk_bf16_f32 v193, v194, v195
    v_exp_f32 v71, v71
    v_mfma_f32_16x16x32_bf16 a[12:15], a[224:227], v[32:35], 0
    s_add_u32 s20, s20, 128
    ds_write2st64_b64 v101, v[128:129], v[176:177] offset0:4 offset1:16
    v_pk_mul_f32 v[108:109], v[108:109], v[8:9] op_sel_hi:[1,0]
    v_exp_f32 v64, v64
    v_pk_mul_f32 v[204:205], v[204:205], v[102:103] op_sel_hi:[1,0]
    v_exp_f32 v63, v63
    v_cvt_pk_bf16_f32 v133, v134, v135
    v_cvt_pk_bf16_f32 v108, v108, v109
    v_cvt_pk_bf16_f32 v105, v106, v107
    v_mfma_f32_16x16x32_bf16 v[220:223], a[224:227], v[26:29], 0
    s_add_u32 m0, s22, 14336
    ds_read_b64_tr_b16 a[218:219], v5 offset:7168
    v_cvt_pk_bf16_f32 v109, v110, v111
    v_mfma_f32_16x16x32_bf16 v[172:175], a[224:227], v[20:23], 0
    ds_read_b64_tr_b16 a[212:213], v4 offset:1024
    v_fma_f32 v57, v57, s28, v9
    v_mfma_f32_16x16x32_bf16 v[124:127], a[224:227], v[14:17], 0
    s_waitcnt lgkmcnt(4)
    ds_write2st64_b64 v101, v[224:225], v[104:105] offset0:28 offset1:40
    v_accvgpr_read_b32 v104, a24
    v_cvt_pk_bf16_f32 v36, v76, v77
    v_mfma_f32_16x16x32_bf16 v[128:131], a[228:231], v[14:17], 0
    ds_read_b64_tr_b16 a[216:217], v5 offset:1024
    v_xor_b32 v101, 32, v101
    v_accvgpr_read_b32 v111, a31
    v_mfma_f32_16x16x32_bf16 v[176:179], a[228:231], v[20:23], 0
    ds_read_b128 v[88:91], v103 offset:0
    v_accvgpr_read_b32 v105, a25
    v_accvgpr_read_b32 v107, a27
    v_mfma_f32_16x16x32_bf16 v[224:227], a[228:231], v[26:29], 0
    buffer_load_dwordx4 v6, s[4:7], s20 offen lds
    ds_write2st64_b64 v101, v[132:133], v[180:181] offset0:4 offset1:16
    v_exp_f32 v55, v55
    v_cvt_pk_bf16_f32 v140, v140, v141
    v_accvgpr_read_b32 v110, a30
    v_accvgpr_read_b32 v106, a26
    v_mfma_f32_16x16x32_bf16 a[16:19], a[228:231], v[32:35], 0
    ds_write2st64_b64 v101, v[228:229], v[108:109] offset0:28 offset1:40
    v_pk_mul_f32 v[104:105], v[104:105], v[8:9] op_sel_hi:[1,0]
    v_cvt_pk_bf16_f32 v141, v142, v143
    v_pk_mul_f32 v[106:107], v[106:107], v[8:9] op_sel_hi:[1,0]
    v_pk_mul_f32 v[110:111], v[110:111], v[8:9] op_sel_hi:[1,0]
    v_cvt_pk_bf16_f32 v148, v148, v149
    v_cvt_pk_bf16_f32 v233, v234, v235
    v_fma_f32 v72, v72, s28, v11
    v_xor_b32 v101, 96, v101
    v_accvgpr_read_b32 v108, a28
    v_cvt_pk_bf16_f32 v245, v246, v247
    v_cvt_pk_bf16_f32 v104, v104, v105
    v_cvt_pk_bf16_f32 v105, v106, v107
    v_mfma_f32_16x16x32_bf16 a[20:23], a[232:235], v[32:35], 0
    s_add_u32 s20, s20, 12032
    ds_write2st64_b64 v101, v[136:137], v[184:185] offset0:4 offset1:16
    v_mfma_f32_16x16x32_bf16 v[228:231], a[232:235], v[26:29], 0
    s_add_u32 m0, s38, 0
    ds_write2st64_b64 v101, v[232:233], v[104:105] offset0:28 offset1:40
    v_mfma_f32_16x16x32_bf16 v[180:183], a[232:235], v[20:23], 0
    ds_read_b64_tr_b16 a[228:229], v4 offset:2048
    v_accvgpr_read_b32 v109, a29
    v_mfma_f32_16x16x32_bf16 v[132:135], a[232:235], v[14:17], 0
    s_waitcnt lgkmcnt(4)
    ds_read_b64_tr_b16 a[220:221], v2 offset:2048
    v_xor_b32 v101, 32, v101
    v_cvt_pk_bf16_f32 v240, v240, v241
    v_mfma_f32_16x16x32_bf16 v[136:139], a[212:215], v[14:17], 0
    ds_write2st64_b64 v101, v[140:141], v[188:189] offset0:4 offset1:16
    v_pk_mul_f32 v[108:109], v[108:109], v[8:9] op_sel_hi:[1,0]
    v_cvt_pk_bf16_f32 v157, v158, v159
    v_cvt_pk_bf16_f32 v108, v108, v109
    v_mfma_f32_16x16x32_bf16 v[184:187], a[212:215], v[20:23], 0
    ds_read_b64_tr_b16 a[230:231], v4 offset:8192
    ds_read_b64_tr_b16 a[232:233], v5 offset:2048
    v_cvt_pk_bf16_f32 v109, v110, v111
    v_mfma_f32_16x16x32_bf16 v[232:235], a[212:215], v[26:29], 0
    ds_read_b64_tr_b16 a[226:227], v3 offset:8192
    buffer_load_dwordx4 v6, s[12:15], s33 offen nt lds
    ds_read_b64_tr_b16 a[234:235], v5 offset:8192
    v_mfma_f32_16x16x32_bf16 a[24:27], a[212:215], v[32:35], 0
    ds_read_b64_tr_b16 a[224:225], v3 offset:2048
    v_cvt_pk_bf16_f32 v197, v198, v199
    v_accvgpr_read_b32 v110, a38
    v_accvgpr_read_b32 v104, a32
    v_accvgpr_read_b32 v106, a34
    v_mfma_f32_16x16x32_bf16 a[28:31], a[216:219], v[32:35], 0
    s_add_u32 m0, s38, 1024
    ds_write2st64_b64 v101, v[236:237], v[108:109] offset0:28 offset1:40
    v_accvgpr_read_b32 v109, a37
    v_accvgpr_read_b32 v111, a39
    v_cvt_pk_bf16_f32 v204, v204, v205
    v_accvgpr_read_b32 v108, a36
    v_cvt_pk_bf16_f32 v149, v150, v151
    v_pk_mul_f32 v[110:111], v[110:111], v[8:9] op_sel_hi:[1,0]
    v_accvgpr_read_b32 v105, a33
    v_pk_mul_f32 v[108:109], v[108:109], v[8:9] op_sel_hi:[1,0]
    v_cvt_pk_bf16_f32 v19, v54, v55
    v_pk_mul_f32 v[104:105], v[104:105], v[8:9] op_sel_hi:[1,0]
    v_xor_b32 v101, 96, v101
    v_cvt_pk_bf16_f32 v241, v242, v243
    v_cvt_pk_bf16_f32 v108, v108, v109
    v_accvgpr_read_b32 v107, a35
    v_cvt_pk_bf16_f32 v109, v110, v111
    v_pk_mul_f32 v[106:107], v[106:107], v[8:9] op_sel_hi:[1,0]
    v_cvt_pk_bf16_f32 v104, v104, v105
    v_cvt_pk_bf16_f32 v105, v106, v107
    v_mfma_f32_16x16x32_bf16 v[236:239], a[216:219], v[26:29], 0
    buffer_load_dwordx4 v7, s[12:15], s33 offen nt lds
    v_mfma_f32_16x16x32_bf16 v[188:191], a[216:219], v[20:23], 0
    s_add_u32 s39, s39, 12288
    ds_write2st64_b64 v101, v[144:145], v[192:193] offset0:8 offset1:20
    v_mfma_f32_16x16x32_bf16 v[140:143], a[216:219], v[14:17], 0
    s_waitcnt vmcnt(8) lgkmcnt(2)
    ds_write2st64_b64 v101, v[240:241], v[104:105] offset0:32 offset1:44
    v_xor_b32 v101, 32, v101
    v_mfma_f32_16x16x32_bf16 v[144:147], a[220:223], v[14:17], 0
    buffer_store_dwordx4 v[88:91], v6, s[16:19], s67 offen offset:0 nt
    s_barrier
    ds_write2st64_b64 v101, v[148:149], v[196:197] offset0:8 offset1:20
    v_accvgpr_read_b32 v106, a42
    v_accvgpr_read_b32 v107, a43
    v_accvgpr_read_b32 v105, a41
    v_accvgpr_read_b32 v111, a47
    v_cvt_pk_bf16_f32 v249, v250, v251
    v_cvt_pk_bf16_f32 v201, v202, v203
    v_mfma_f32_16x16x32_bf16 v[192:195], a[220:223], v[20:23], 0
    ds_write2st64_b64 v101, v[244:245], v[108:109] offset0:32 offset1:44
    v_accvgpr_read_b32 v104, a40
    v_accvgpr_read_b32 v108, a44
    v_accvgpr_read_b32 v109, a45
    v_pk_mul_f32 v[106:107], v[106:107], v[8:9] op_sel_hi:[1,0]
    v_accvgpr_read_b32 v110, a46
    v_cvt_pk_bf16_f32 v205, v206, v207
    v_pk_mul_f32 v[104:105], v[104:105], v[8:9] op_sel_hi:[1,0]
    v_pk_mul_f32 v[110:111], v[110:111], v[8:9] op_sel_hi:[1,0]
    v_pk_mul_f32 v[108:109], v[108:109], v[8:9] op_sel_hi:[1,0]
    v_cvt_pk_bf16_f32 v25, v62, v63
    v_pk_mul_f32 v[254:255], v[254:255], v[50:51] op_sel_hi:[1,0]
    v_cvt_pk_bf16_f32 v104, v104, v105
    v_cvt_pk_bf16_f32 v24, v60, v61
    v_fma_f32 v66, v66, s28, v10
    v_mfma_f32_16x16x32_bf16 v[240:243], a[220:223], v[26:29], 0
    v_cvt_pk_bf16_f32 v108, v108, v109
    v_xor_b32 v101, 96, v101
    v_mfma_f32_16x16x32_bf16 a[32:35], a[220:223], v[32:35], 0
    ds_read_b128 a[220:223], v0 offset:1024
    v_cvt_pk_bf16_f32 v105, v106, v107
    v_mfma_f32_16x16x32_bf16 a[36:39], a[224:227], v[32:35], 0
    ds_write2st64_b64 v101, v[152:153], v[200:201] offset0:8 offset1:20
    v_mfma_f32_16x16x32_bf16 v[244:247], a[224:227], v[26:29], 0
    v_cvt_pk_bf16_f32 v31, v70, v71
    v_cvt_pk_bf16_f32 v253, v254, v255
    v_mfma_f32_16x16x32_bf16 v[196:199], a[224:227], v[20:23], 0
    ds_write2st64_b64 v101, v[248:249], v[104:105] offset0:32 offset1:44
    v_mfma_f32_16x16x32_bf16 v[148:151], a[224:227], v[14:17], 0
    s_add_u32 m0, s22, 24576
    ds_read_b128 a[212:215], v0 offset:0
    v_cvt_pk_bf16_f32 v109, v110, v111
    v_mfma_f32_16x16x32_bf16 v[152:155], a[228:231], v[14:17], 0
    ds_read_b128 a[216:219], v1 offset:0
    v_xor_b32 v101, 32, v101
    v_mfma_f32_16x16x32_bf16 v[200:203], a[228:231], v[20:23], 0
    buffer_load_dwordx4 v6, s[8:11], s21 offen lds
    v_mfma_f32_16x16x32_bf16 v[248:251], a[228:231], v[26:29], 0
    buffer_store_dwordx4 v[96:99], v7, s[16:19], s67 offen offset:0 nt
    ds_write2st64_b64 v101, v[156:157], v[204:205] offset0:8 offset1:20
    v_cvt_pk_bf16_f32 v18, v52, v53
    v_mfma_f32_16x16x32_bf16 a[40:43], a[228:231], v[32:35], 0
    s_add_u32 s21, s21, 128
    ds_write2st64_b64 v101, v[252:253], v[108:109] offset0:32 offset1:44
    v_mfma_f32_16x16x32_bf16 a[44:47], a[232:235], v[32:35], 0
    v_exp_f32 v66, v66
    v_mfma_f32_16x16x32_bf16 v[252:255], a[232:235], v[26:29], 0
    s_add_u32 m0, s22, 25600
    v_exp_f32 v78, v78
    v_mfma_f32_16x16x32_bf16 v[204:207], a[232:235], v[20:23], 0
    ds_read_b128 a[228:231], v0 offset:2048
    buffer_load_dwordx4 v6, s[8:11], s21 offen lds
    v_mfma_f32_16x16x32_bf16 v[156:159], a[232:235], v[14:17], 0
    s_waitcnt lgkmcnt(3)
    v_exp_f32 v72, v72
    v_mfma_f32_16x16x32_bf16 v[52:55], a[212:215], a[96:99], 0
    ds_read_b128 a[224:227], v1 offset:1024
    v_cvt_pk_bf16_f32 v30, v68, v69
    v_mfma_f32_16x16x32_bf16 v[52:55], a[216:219], a[100:103], v[52:55]
    s_add_u32 s21, s21, 128
    ds_read_b128 v[84:87], v103 offset:2048
    v_fma_f32 v81, v81, s28, v12
    v_mfma_f32_16x16x32_bf16 v[52:55], a[220:223], a[104:107], v[52:55]
    ds_read_b128 a[232:235], v1 offset:2048
    v_cvt_pk_bf16_f32 v37, v78, v79
    v_mfma_f32_16x16x32_bf16 v[60:63], a[220:223], a[128:131], 0
    v_exp_f32 v58, v58
    v_mfma_f32_16x16x32_bf16 v[60:63], a[216:219], a[124:127], v[60:63]
    v_exp_f32 v59, v59
    v_mfma_f32_16x16x32_bf16 v[60:63], a[212:215], a[120:123], v[60:63]
    v_exp_f32 v73, v73
    v_mfma_f32_16x16x32_bf16 v[68:71], a[212:215], a[144:147], 0
    s_add_u32 m0, s22, 26624
    v_exp_f32 v67, v67
    v_mfma_f32_16x16x32_bf16 v[68:71], a[216:219], a[148:151], v[68:71]
    buffer_load_dwordx4 v6, s[8:11], s21 offen lds
    v_mfma_f32_16x16x32_bf16 v[68:71], a[220:223], a[152:155], v[68:71]
    v_fma_f32 v74, v74, s28, v11
    v_cvt_pk_bf16_f32 v17, v58, v59
    v_mfma_f32_16x16x32_bf16 v[76:79], a[220:223], a[176:179], 0
    v_exp_f32 v56, v56
    v_mfma_f32_16x16x32_bf16 v[76:79], a[216:219], a[172:175], v[76:79]
    s_add_u32 s21, s21, 12032
    v_exp_f32 v81, v81
    v_mfma_f32_16x16x32_bf16 v[76:79], a[212:215], a[168:171], v[76:79]
    s_waitcnt lgkmcnt(1)
    v_exp_f32 v57, v57
    v_mfma_f32_16x16x32_bf16 v[76:79], a[224:227], a[180:183], v[76:79]
    ds_read_b128 a[220:223], v0 offset:7168
    v_cvt_pk_bf16_f32 v16, v56, v57
    v_mfma_f32_16x16x32_bf16 v[76:79], a[228:231], a[184:187], v[76:79]
    s_waitcnt lgkmcnt(1)
    v_exp_f32 v83, v83
    v_mfma_f32_16x16x32_bf16 v[76:79], a[232:235], a[188:191], v[76:79]
    s_add_u32 s56, s67, 128
    ds_read_b128 v[88:91], v103 offset:3072
    v_fma_f32 v65, v65, s28, v10
    v_mfma_f32_16x16x32_bf16 v[68:71], a[232:235], a[164:167], v[68:71]
    ds_read_b128 a[212:215], v0 offset:6144
    v_mfma_f32_16x16x32_bf16 v[48:51], a[236:239], v[16:19], v[44:47]
    v_exp_f32 v74, v74
    v_mfma_f32_16x16x32_bf16 v[68:71], a[228:231], a[160:163], v[68:71]
    s_add_u32 s58, s33, 128
    ds_read_b128 a[216:219], v1 offset:6144
    s_add_u32 m0, s38, 2048
    v_mfma_f32_16x16x32_bf16 v[68:71], a[224:227], a[156:159], v[68:71]
    ds_read_b128 v[96:99], v103 offset:4096
    v_cvt_pk_bf16_f32 v34, v80, v81
    v_mfma_f32_16x16x32_bf16 v[60:63], a[224:227], a[132:135], v[60:63]
    v_exp_f32 v65, v65
    v_mfma_f32_16x16x32_bf16 v[60:63], a[228:231], a[136:139], v[60:63]
    v_exp_f32 v75, v75
    v_mfma_f32_16x16x32_bf16 v[60:63], a[232:235], a[140:143], v[60:63]
    buffer_load_dwordx4 v6, s[12:15], s58 offen nt lds
    v_mfma_f32_16x16x32_bf16 v[52:55], a[232:235], a[116:119], v[52:55]
    buffer_store_dwordx4 v[84:87], v6, s[16:19], s56 offen offset:0 nt
    s_nop 0
    ds_read_b128 v[84:87], v103 offset:5120
    v_cvt_pk_bf16_f32 v22, v64, v65
    v_cvt_pk_bf16_f32 v23, v66, v67
    v_mfma_f32_16x16x32_bf16 v[52:55], a[228:231], a[112:115], v[52:55]
    v_cvt_pk_bf16_f32 v28, v72, v73
    v_mov_b32 v39, v7
    v_mfma_f32_16x16x32_bf16 v[52:55], a[224:227], a[108:111], v[52:55]
    s_add_u32 m0, s38, 3072
    v_cvt_pk_bf16_f32 v29, v74, v75
    s_waitcnt lgkmcnt(3)
    v_mfma_f32_16x16x32_bf16 v[56:59], a[212:215], a[96:99], 0
    buffer_load_dwordx4 v7, s[12:15], s58 offen nt lds
    v_mfma_f32_16x16x32_bf16 v[48:51], a[240:243], v[22:25], v[48:51]
    ds_read_b128 a[228:231], v0 offset:8192
    v_cvt_pk_bf16_f32 v35, v82, v83
    v_mfma_f32_16x16x32_bf16 v[48:51], a[244:247], v[28:31], v[48:51]
    s_add_u32 s57, s67, 256
    ds_read_b128 a[232:235], v1 offset:8192
    v_mfma_f32_16x16x32_bf16 v[48:51], a[248:251], v[34:37], v[48:51]
    buffer_store_dwordx4 v[88:91], v7, s[16:19], s56 offen offset:0 nt
    ds_read_b128 a[224:227], v1 offset:7168
    s_waitcnt lgkmcnt(4)
    v_mfma_f32_16x16x32_bf16 v[56:59], a[216:219], a[100:103], v[56:59]
    s_add_u32 s59, s33, 256
    s_add_u32 m0, s38, 4096
    v_mfma_f32_16x16x32_bf16 v[56:59], a[220:223], a[104:107], v[56:59]
    buffer_load_dwordx4 v6, s[12:15], s59 offen nt lds
    v_mfma_f32_16x16x32_bf16 v[64:67], a[220:223], a[128:131], 0
    v_cmp_lt_f32 vcc, s29, v48
    s_add_u32 m0, s38, 5120
    v_mfma_f32_16x16x32_bf16 v[64:67], a[216:219], a[124:127], v[64:67]
    s_waitcnt lgkmcnt(3)
    buffer_load_dwordx4 v7, s[12:15], s59 offen nt lds
    v_mfma_f32_16x16x32_bf16 v[64:67], a[212:215], a[120:123], v[64:67]
    buffer_store_dwordx4 v[96:99], v6, s[16:19], s57 offen offset:0 nt
    s_cbranch_vccnz L_rs_tr44d
L_ret_tr44d:
    v_fma_f32 v54, v54, s28, v9
    v_fma_f32 v61, v61, s28, v10
    v_fma_f32 v60, v60, s28, v10
    v_mfma_f32_16x16x32_bf16 v[72:75], a[212:215], a[144:147], 0
    v_fma_f32 v55, v55, s28, v9
    v_mfma_f32_16x16x32_bf16 v[72:75], a[216:219], a[148:151], v[72:75]
    v_fma_f32 v52, v52, s28, v9
    v_mfma_f32_16x16x32_bf16 v[72:75], a[220:223], a[152:155], v[72:75]
    s_waitcnt vmcnt(17) lgkmcnt(0)
    v_exp_f32 v55, v55
    v_mfma_f32_16x16x32_bf16 v[80:83], a[220:223], a[176:179], 0
    s_barrier
    v_mfma_f32_16x16x32_bf16 v[80:83], a[216:219], a[172:175], v[80:83]
    v_exp_f32 v52, v52
    v_mfma_f32_16x16x32_bf16 v[80:83], a[212:215], a[168:171], v[80:83]
    s_add_u32 m0, s22, 0
    ds_read_b64_tr_b16 a[212:213], v2 offset:18432
    v_fma_f32 v53, v53, s28, v9
    v_mfma_f32_16x16x32_bf16 v[80:83], a[224:227], a[180:183], v[80:83]
    ds_read_b64_tr_b16 a[214:215], v2 offset:12288
    v_exp_f32 v61, v61
    v_mfma_f32_16x16x32_bf16 v[80:83], a[228:231], a[184:187], v[80:83]
    buffer_load_dwordx4 v6, s[4:7], s20 offen lds
    v_mfma_f32_16x16x32_bf16 v[80:83], a[232:235], a[188:191], v[80:83]
    v_exp_f32 v60, v60
    v_mfma_f32_16x16x32_bf16 v[72:75], a[232:235], a[164:167], v[72:75]
    s_add_u32 s20, s20, 128
    ds_read_b64_tr_b16 a[216:217], v3 offset:18432
    v_cvt_pk_bf16_f32 v20, v60, v61
    v_mfma_f32_16x16x32_bf16 v[72:75], a[228:231], a[160:163], v[72:75]
    s_add_u32 m0, s22, 1024
    v_exp_f32 v53, v53
    v_mfma_f32_16x16x32_bf16 v[72:75], a[224:227], a[156:159], v[72:75]
    buffer_load_dwordx4 v6, s[4:7], s20 offen lds
    v_mfma_f32_16x16x32_bf16 v[64:67], a[224:227], a[132:135], v[64:67]
    s_add_u32 s20, s20, 128
    v_exp_f32 v54, v54
    v_mfma_f32_16x16x32_bf16 v[64:67], a[228:231], a[136:139], v[64:67]
    ds_read_b64_tr_b16 a[218:219], v3 offset:12288
    v_cvt_pk_bf16_f32 v15, v54, v55
    v_mfma_f32_16x16x32_bf16 v[64:67], a[232:235], a[140:143], v[64:67]
    s_add_u32 m0, s22, 2048
    ds_read_b64_tr_b16 a[220:221], v4 offset:18432
    v_cvt_pk_bf16_f32 v14, v52, v53
    v_mfma_f32_16x16x32_bf16 v[56:59], a[232:235], a[116:119], v[56:59]
    buffer_load_dwordx4 v6, s[4:7], s20 offen lds
    v_mfma_f32_16x16x32_bf16 v[56:59], a[228:231], a[112:115], v[56:59]
    s_add_u32 s20, s20, 12032
    ds_read_b64_tr_b16 a[222:223], v4 offset:12288
    v_add_u32 v103, 6144, v103
    v_mfma_f32_16x16x32_bf16 v[56:59], a[224:227], a[108:111], v[56:59]
    s_waitcnt lgkmcnt(4)
    ds_read_b64_tr_b16 a[224:225], v5 offset:18432
    ds_read_b64_tr_b16 a[226:227], v5 offset:12288
    buffer_store_dwordx4 v[84:87], v7, s[16:19], s57 offen offset:0 nt
    s_branch L_loop4w0
L_end5:
    v_mfma_f32_16x16x32_bf16 v[112:115], a[212:215], v[16:19], v[112:115]
    v_mfma_f32_16x16x32_bf16 v[116:119], a[216:219], v[16:19], v[116:119]
    ds_read_b64_tr_b16 a[230:231], v2 offset:13312
    v_mfma_f32_16x16x32_bf16 v[164:167], a[216:219], v[22:25], v[164:167]
    v_fma_f32 v73, v73, s28, v11
    v_mfma_f32_16x16x32_bf16 v[160:163], a[212:215], v[22:25], v[160:163]
    ds_read_b64_tr_b16 a[234:235], v3 offset:13312
    v_fma_f32 v69, v69, s28, v11
    v_mfma_f32_16x16x32_bf16 v[208:211], a[212:215], v[28:31], v[208:211]
    v_fma_f32 v64, v64, s28, v10
    v_mfma_f32_16x16x32_bf16 v[212:215], a[216:219], v[28:31], v[212:215]
    v_fma_f32 v77, v77, s28, v12
    v_mfma_f32_16x16x32_bf16 a[4:7], a[216:219], v[34:37], a[4:7]
    ds_read_b64_tr_b16 a[228:229], v2 offset:19456
    v_fma_f32 v57, v57, s28, v9
    v_mfma_f32_16x16x32_bf16 a[0:3], a[212:215], v[34:37], a[0:3]
    v_fma_f32 v71, v71, s28, v11
    v_fma_f32 v84, v84, s28, v13
    v_mfma_f32_16x16x32_bf16 a[48:51], a[212:215], v[40:43], a[48:51]
    ds_read_b64_tr_b16 a[232:233], v3 offset:19456
    v_fma_f32 v85, v85, s28, v13
    v_mfma_f32_16x16x32_bf16 a[52:55], a[216:219], v[40:43], a[52:55]
    s_waitcnt lgkmcnt(4)
    v_mfma_f32_16x16x32_bf16 a[56:59], a[220:223], v[40:43], a[56:59]
    ds_read_b64_tr_b16 a[218:219], v5 offset:13312
    v_fma_f32 v68, v68, s28, v11
    v_mfma_f32_16x16x32_bf16 a[60:63], a[224:227], v[40:43], a[60:63]
    ds_read_b64_tr_b16 a[212:213], v4 offset:19456
    v_fma_f32 v56, v56, s28, v9
    v_mfma_f32_16x16x32_bf16 a[12:15], a[224:227], v[34:37], a[12:15]
    ds_read_b64_tr_b16 a[216:217], v5 offset:19456
    v_fma_f32 v91, v91, s28, v13
    v_mfma_f32_16x16x32_bf16 a[8:11], a[220:223], v[34:37], a[8:11]
    v_fma_f32 v76, v76, s28, v12
    v_mfma_f32_16x16x32_bf16 v[216:219], a[220:223], v[28:31], v[216:219]
    v_fma_f32 v82, v82, s28, v12
    v_mfma_f32_16x16x32_bf16 v[220:223], a[224:227], v[28:31], v[220:223]
    v_fma_f32 v70, v70, s28, v11
    v_mfma_f32_16x16x32_bf16 v[172:175], a[224:227], v[22:25], v[172:175]
    v_exp_f32 v69, v69
    v_mfma_f32_16x16x32_bf16 v[168:171], a[220:223], v[22:25], v[168:171]
    v_exp_f32 v82, v82
    v_mfma_f32_16x16x32_bf16 v[120:123], a[220:223], v[16:19], v[120:123]
    ds_read_b64_tr_b16 a[214:215], v4 offset:13312
    v_mfma_f32_16x16x32_bf16 v[124:127], a[224:227], v[16:19], v[124:127]
    s_waitcnt lgkmcnt(4)
    v_exp_f32 v70, v70
    v_mfma_f32_16x16x32_bf16 v[128:131], a[228:231], v[16:19], v[128:131]
    ds_read_b64_tr_b16 a[224:225], v3 offset:20480
    v_fma_f32 v65, v65, s28, v10
    v_mfma_f32_16x16x32_bf16 v[132:135], a[232:235], v[16:19], v[132:135]
    v_exp_f32 v68, v68
    v_mfma_f32_16x16x32_bf16 v[180:183], a[232:235], v[22:25], v[180:183]
    v_fma_f32 v78, v78, s28, v12
    v_cvt_pk_bf16_f32 v26, v68, v69
    v_mfma_f32_16x16x32_bf16 v[176:179], a[228:231], v[22:25], v[176:179]
    ds_read_b64_tr_b16 a[220:221], v2 offset:20480
    v_fma_f32 v74, v74, s28, v11
    v_mfma_f32_16x16x32_bf16 v[224:227], a[228:231], v[28:31], v[224:227]
    v_fma_f32 v81, v81, s28, v12
    v_fma_f32 v86, v86, s28, v13
    v_mfma_f32_16x16x32_bf16 v[228:231], a[232:235], v[28:31], v[228:231]
    ds_read_b64_tr_b16 a[222:223], v2 offset:14336
    v_fma_f32 v59, v59, s28, v9
    v_mfma_f32_16x16x32_bf16 a[20:23], a[232:235], v[34:37], a[20:23]
    v_exp_f32 v74, v74
    v_mfma_f32_16x16x32_bf16 a[16:19], a[228:231], v[34:37], a[16:19]
    v_exp_f32 v78, v78
    v_mfma_f32_16x16x32_bf16 a[64:67], a[228:231], v[40:43], a[64:67]
    ds_read_b64_tr_b16 a[228:229], v4 offset:20480
    v_fma_f32 v83, v83, s28, v12
    v_mfma_f32_16x16x32_bf16 a[68:71], a[232:235], v[40:43], a[68:71]
    s_waitcnt lgkmcnt(4)
    ds_read_b64_tr_b16 a[226:227], v3 offset:14336
    v_fma_f32 v75, v75, s28, v11
    v_mfma_f32_16x16x32_bf16 a[72:75], a[212:215], v[40:43], a[72:75]
    v_exp_f32 v84, v84
    v_mfma_f32_16x16x32_bf16 a[76:79], a[216:219], v[40:43], a[76:79]
    v_fma_f32 v87, v87, s28, v13
    v_mfma_f32_16x16x32_bf16 a[28:31], a[216:219], v[34:37], a[28:31]
    v_exp_f32 v71, v71
    v_mfma_f32_16x16x32_bf16 a[24:27], a[212:215], v[34:37], a[24:27]
    v_exp_f32 v85, v85
    v_mfma_f32_16x16x32_bf16 v[232:235], a[212:215], v[28:31], v[232:235]
    ds_read_b64_tr_b16 a[232:233], v5 offset:20480
    v_fma_f32 v58, v58, s28, v9
    v_mfma_f32_16x16x32_bf16 v[236:239], a[216:219], v[28:31], v[236:239]
    ds_read_b64_tr_b16 a[230:231], v4 offset:14336
    v_fma_f32 v66, v66, s28, v10
    v_mfma_f32_16x16x32_bf16 v[188:191], a[216:219], v[22:25], v[188:191]
    ds_read_b64_tr_b16 a[234:235], v5 offset:14336
    v_mfma_f32_16x16x32_bf16 v[184:187], a[212:215], v[22:25], v[184:187]
    v_exp_f32 v73, v73
    v_mfma_f32_16x16x32_bf16 v[136:139], a[212:215], v[16:19], v[136:139]
    v_fma_f32 v79, v79, s28, v12
    v_mfma_f32_16x16x32_bf16 v[140:143], a[216:219], v[16:19], v[140:143]
    s_waitcnt lgkmcnt(3)
    v_exp_f32 v87, v87
    v_mfma_f32_16x16x32_bf16 v[144:147], a[220:223], v[16:19], v[144:147]
    v_exp_f32 v86, v86
    v_mfma_f32_16x16x32_bf16 v[148:151], a[224:227], v[16:19], v[148:151]
    s_add_u32 s39, s39, 12288
    v_exp_f32 v77, v77
    v_mfma_f32_16x16x32_bf16 v[196:199], a[224:227], v[22:25], v[196:199]
    v_fma_f32 v90, v90, s28, v13
    v_fma_f32 v72, v72, s28, v11
    v_mfma_f32_16x16x32_bf16 v[192:195], a[220:223], v[22:25], v[192:195]
    v_exp_f32 v59, v59
    v_mfma_f32_16x16x32_bf16 v[240:243], a[220:223], v[28:31], v[240:243]
    v_exp_f32 v66, v66
    v_mfma_f32_16x16x32_bf16 v[244:247], a[224:227], v[28:31], v[244:247]
    v_exp_f32 v57, v57
    v_mfma_f32_16x16x32_bf16 a[36:39], a[224:227], v[34:37], a[36:39]
    v_exp_f32 v58, v58
    v_mfma_f32_16x16x32_bf16 a[32:35], a[220:223], v[34:37], a[32:35]
    s_waitcnt vmcnt(10) lgkmcnt(0)
    v_exp_f32 v76, v76
    v_mfma_f32_16x16x32_bf16 a[80:83], a[220:223], v[40:43], a[80:83]
    v_exp_f32 v83, v83
    v_mfma_f32_16x16x32_bf16 a[84:87], a[224:227], v[40:43], a[84:87]
    s_barrier
    ds_read_b128 a[212:215], v0 offset:12288
    v_mfma_f32_16x16x32_bf16 a[88:91], a[228:231], v[40:43], a[88:91]
    ds_read_b128 a[216:219], v1 offset:12288
    s_add_u32 m0, s22, 36864
    v_mfma_f32_16x16x32_bf16 a[92:95], a[232:235], v[40:43], a[92:95]
    ds_read_b128 a[220:223], v0 offset:13312
    v_cvt_pk_bf16_f32 v38, v84, v85
    v_mfma_f32_16x16x32_bf16 a[44:47], a[232:235], v[34:37], a[44:47]
    v_exp_f32 v79, v79
    v_mfma_f32_16x16x32_bf16 a[40:43], a[228:231], v[34:37], a[40:43]
    v_fma_f32 v89, v89, s28, v13
    v_mfma_f32_16x16x32_bf16 v[248:251], a[228:231], v[28:31], v[248:251]
    buffer_load_dwordx4 v6, s[8:11], s21 offen lds
    v_mfma_f32_16x16x32_bf16 v[252:255], a[232:235], v[28:31], v[252:255]
    s_add_u32 s21, s21, 128
    s_add_u32 m0, s22, 37888
    v_fma_f32 v67, v67, s28, v10
    v_mfma_f32_16x16x32_bf16 v[204:207], a[232:235], v[22:25], v[204:207]
    buffer_load_dwordx4 v6, s[8:11], s21 offen lds
    v_mfma_f32_16x16x32_bf16 v[200:203], a[228:231], v[22:25], v[200:203]
    s_add_u32 s21, s21, 128
    v_cvt_pk_bf16_f32 v39, v86, v87
    s_add_u32 m0, s22, 38912
    v_mfma_f32_16x16x32_bf16 v[152:155], a[228:231], v[16:19], v[152:155]
    buffer_load_dwordx4 v6, s[8:11], s21 offen lds
    v_mfma_f32_16x16x32_bf16 v[156:159], a[232:235], v[16:19], v[156:159]
    s_waitcnt lgkmcnt(2)
    v_exp_f32 v90, v90
    v_mfma_f32_16x16x32_bf16 v[52:55], a[212:215], a[96:99], 0
    s_waitcnt lgkmcnt(1)
    v_cvt_pk_bf16_f32 v32, v76, v77
    v_mfma_f32_16x16x32_bf16 v[52:55], a[216:219], a[100:103], v[52:55]
    s_waitcnt lgkmcnt(0)
    ds_read_b128 a[224:227], v1 offset:13312
    v_fma_f32 v88, v88, s28, v13
    v_mfma_f32_16x16x32_bf16 v[52:55], a[220:223], a[104:107], v[52:55]
    ds_read_b128 a[228:231], v0 offset:14336
    v_mfma_f32_16x16x32_bf16 v[60:63], a[220:223], a[128:131], 0
    v_exp_f32 v91, v91
    v_mfma_f32_16x16x32_bf16 v[60:63], a[216:219], a[124:127], v[60:63]
    v_cvt_pk_bf16_f32 v33, v78, v79
    v_cvt_pk_bf16_f32 v27, v70, v71
    v_mfma_f32_16x16x32_bf16 v[60:63], a[212:215], a[120:123], v[60:63]
    ds_read_b128 a[232:235], v1 offset:14336
    v_mfma_f32_16x16x32_bf16 v[68:71], a[212:215], a[144:147], 0
    v_exp_f32 v56, v56
    v_mfma_f32_16x16x32_bf16 v[68:71], a[216:219], a[148:151], v[68:71]
    v_exp_f32 v75, v75
    v_mfma_f32_16x16x32_bf16 v[68:71], a[220:223], a[152:155], v[68:71]
    v_cvt_pk_bf16_f32 v29, v74, v75
    v_cvt_pk_bf16_f32 v41, v90, v91
    v_mfma_f32_16x16x32_bf16 v[76:79], a[220:223], a[176:179], 0
    v_exp_f32 v72, v72
    v_mfma_f32_16x16x32_bf16 v[76:79], a[216:219], a[172:175], v[76:79]
    v_exp_f32 v89, v89
    v_mfma_f32_16x16x32_bf16 v[76:79], a[212:215], a[168:171], v[76:79]
    v_exp_f32 v67, v67
    v_mfma_f32_16x16x32_bf16 v[84:87], a[212:215], a[192:195], 0
    v_exp_f32 v81, v81
    v_mfma_f32_16x16x32_bf16 v[84:87], a[216:219], a[196:199], v[84:87]
    v_mfma_f32_16x16x32_bf16 v[84:87], a[220:223], a[200:203], v[84:87]
    s_waitcnt lgkmcnt(1)
    v_mfma_f32_16x16x32_bf16 v[84:87], a[224:227], a[204:207], v[84:87]
    v_cvt_pk_bf16_f32 v16, v56, v57
    v_fma_f32 v80, v80, s28, v12
    v_mfma_f32_16x16x32_bf16 v[84:87], a[228:231], a[208:211], v[84:87]
    s_waitcnt lgkmcnt(0)
    v_exp_f32 v65, v65
    v_mfma_f32_16x16x32_bf16 v[84:87], a[232:235], v[92:95], v[84:87]
    v_cvt_pk_bf16_f32 v23, v66, v67
    v_mfma_f32_16x16x32_bf16 v[76:79], a[232:235], a[188:191], v[76:79]
    v_exp_f32 v64, v64
    v_mfma_f32_16x16x32_bf16 v[76:79], a[228:231], a[184:187], v[76:79]
    ds_read_b128 a[216:219], v1 offset:18432
    v_mfma_f32_16x16x32_bf16 v[76:79], a[224:227], a[180:183], v[76:79]
    s_add_u32 s21, s21, 12032
    v_mfma_f32_16x16x32_bf16 v[68:71], a[224:227], a[156:159], v[68:71]
    ds_read_b128 a[212:215], v0 offset:18432
    v_cvt_pk_bf16_f32 v22, v64, v65
    v_mfma_f32_16x16x32_bf16 v[68:71], a[228:231], a[160:163], v[68:71]
    v_exp_f32 v80, v80
    v_mfma_f32_16x16x32_bf16 v[68:71], a[232:235], a[164:167], v[68:71]
    v_cvt_pk_bf16_f32 v34, v80, v81
    v_cvt_pk_bf16_f32 v17, v58, v59
    v_mfma_f32_16x16x32_bf16 v[60:63], a[232:235], a[140:143], v[60:63]
    v_exp_f32 v88, v88
    v_mfma_f32_16x16x32_bf16 v[44:47], a[236:239], v[14:17], v[48:51]
    ds_read_b128 a[220:223], v0 offset:19456
    v_mfma_f32_16x16x32_bf16 v[60:63], a[228:231], a[136:139], v[60:63]
    v_mfma_f32_16x16x32_bf16 v[60:63], a[224:227], a[132:135], v[60:63]
    v_mfma_f32_16x16x32_bf16 v[44:47], a[240:243], v[20:23], v[44:47]
    v_cvt_pk_bf16_f32 v40, v88, v89
    v_cvt_pk_bf16_f32 v28, v72, v73
    v_mfma_f32_16x16x32_bf16 v[52:55], a[224:227], a[108:111], v[52:55]
    v_cvt_pk_bf16_f32 v35, v82, v83
    v_mfma_f32_16x16x32_bf16 v[52:55], a[228:231], a[112:115], v[52:55]
    ds_read_b128 a[224:227], v1 offset:19456
    v_mfma_f32_16x16x32_bf16 v[44:47], a[244:247], v[26:29], v[44:47]
    v_mfma_f32_16x16x32_bf16 v[52:55], a[232:235], a[116:119], v[52:55]
    ds_read_b128 a[232:235], v1 offset:20480
    v_mfma_f32_16x16x32_bf16 v[44:47], a[248:251], v[32:35], v[44:47]
    ds_read_b128 a[228:231], v0 offset:20480
    v_mfma_f32_16x16x32_bf16 v[44:47], a[252:255], v[38:41], v[44:47]
    s_waitcnt lgkmcnt(4)
    v_mfma_f32_16x16x32_bf16 v[56:59], a[212:215], a[96:99], 0
    v_mfma_f32_16x16x32_bf16 v[56:59], a[216:219], a[100:103], v[56:59]
    s_waitcnt lgkmcnt(3)
    v_mfma_f32_16x16x32_bf16 v[56:59], a[220:223], a[104:107], v[56:59]
    v_mfma_f32_16x16x32_bf16 v[64:67], a[220:223], a[128:131], 0
    s_nop 1
    v_cmp_lt_f32 vcc, s29, v44
    v_mfma_f32_16x16x32_bf16 v[64:67], a[216:219], a[124:127], v[64:67]
    v_mfma_f32_16x16x32_bf16 v[64:67], a[212:215], a[120:123], v[64:67]
    v_mfma_f32_16x16x32_bf16 v[72:75], a[212:215], a[144:147], 0
    v_mfma_f32_16x16x32_bf16 v[72:75], a[216:219], a[148:151], v[72:75]
    s_nop 0
    s_cbranch_vccnz L_rs_end5a
L_ret_end5a:
    v_mfma_f32_16x16x32_bf16 v[72:75], a[220:223], a[152:155], v[72:75]
    s_waitcnt vmcnt(6) lgkmcnt(0)
    v_mfma_f32_16x16x32_bf16 v[80:83], a[220:223], a[176:179], 0
    s_barrier
    v_mfma_f32_16x16x32_bf16 v[80:83], a[216:219], a[172:175], v[80:83]
    v_fma_f32 v60, v60, s28, v10
    v_fma_f32 v52, v52, s28, v9
    v_mfma_f32_16x16x32_bf16 v[80:83], a[212:215], a[168:171], v[80:83]
    v_exp_f32 v60, v60
    v_mfma_f32_16x16x32_bf16 v[88:91], a[212:215], a[192:195], 0
    ds_read_b64_tr_b16 a[212:213], v2 offset:0
    v_fma_f32 v55, v55, s28, v9
    v_mfma_f32_16x16x32_bf16 v[88:91], a[216:219], a[196:199], v[88:91]
    ds_read_b64_tr_b16 a[214:215], v2 offset:6144
    v_fma_f32 v53, v53, s28, v9
    v_mfma_f32_16x16x32_bf16 v[88:91], a[220:223], a[200:203], v[88:91]
    v_fma_f32 v54, v54, s28, v9
    v_fma_f32 v61, v61, s28, v10
    v_mfma_f32_16x16x32_bf16 v[88:91], a[224:227], a[204:207], v[88:91]
    ds_read_b64_tr_b16 a[216:217], v3 offset:0
    v_fma_f32 v63, v63, s28, v10
    v_mfma_f32_16x16x32_bf16 v[88:91], a[228:231], a[208:211], v[88:91]
    v_mfma_f32_16x16x32_bf16 v[88:91], a[232:235], v[92:95], v[88:91]
    ds_read_b64_tr_b16 a[218:219], v3 offset:6144
    v_fma_f32 v62, v62, s28, v10
    v_mfma_f32_16x16x32_bf16 v[80:83], a[232:235], a[188:191], v[80:83]
    v_exp_f32 v52, v52
    v_mfma_f32_16x16x32_bf16 v[80:83], a[228:231], a[184:187], v[80:83]
    v_exp_f32 v53, v53
    v_mfma_f32_16x16x32_bf16 v[80:83], a[224:227], a[180:183], v[80:83]
    v_cvt_pk_bf16_f32 v18, v52, v53
    v_mfma_f32_16x16x32_bf16 v[72:75], a[224:227], a[156:159], v[72:75]
    v_exp_f32 v54, v54
    v_mfma_f32_16x16x32_bf16 v[72:75], a[228:231], a[160:163], v[72:75]
    ds_read_b64_tr_b16 a[220:221], v4 offset:0
    v_mfma_f32_16x16x32_bf16 v[72:75], a[232:235], a[164:167], v[72:75]
    v_exp_f32 v62, v62
    v_mfma_f32_16x16x32_bf16 v[64:67], a[232:235], a[140:143], v[64:67]
    v_exp_f32 v55, v55
    v_mfma_f32_16x16x32_bf16 v[64:67], a[228:231], a[136:139], v[64:67]
    v_exp_f32 v61, v61
    v_mfma_f32_16x16x32_bf16 v[64:67], a[224:227], a[132:135], v[64:67]
    v_exp_f32 v63, v63
    v_mfma_f32_16x16x32_bf16 v[56:59], a[224:227], a[108:111], v[56:59]
    ds_read_b64_tr_b16 a[222:223], v4 offset:6144
    v_cvt_pk_bf16_f32 v24, v60, v61
    v_mfma_f32_16x16x32_bf16 v[56:59], a[228:231], a[112:115], v[56:59]
    ds_read_b64_tr_b16 a[224:225], v5 offset:0
    v_cvt_pk_bf16_f32 v19, v54, v55
    v_mfma_f32_16x16x32_bf16 v[56:59], a[232:235], a[116:119], v[56:59]
    s_waitcnt lgkmcnt(3)
    ds_read_b64_tr_b16 a[226:227], v5 offset:6144
    v_cvt_pk_bf16_f32 v25, v62, v63
    v_mfma_f32_16x16x32_bf16 v[112:115], a[212:215], v[14:17], v[112:115]
    v_fma_f32 v70, v70, s28, v11
    v_fma_f32 v64, v64, s28, v10
    v_mfma_f32_16x16x32_bf16 v[116:119], a[216:219], v[14:17], v[116:119]
    v_fma_f32 v66, v66, s28, v10
    v_fma_f32 v56, v56, s28, v9
    v_mfma_f32_16x16x32_bf16 v[164:167], a[216:219], v[20:23], v[164:167]
    ds_read_b64_tr_b16 a[230:231], v2 offset:7168
    v_fma_f32 v71, v71, s28, v11
    v_mfma_f32_16x16x32_bf16 v[160:163], a[212:215], v[20:23], v[160:163]
    v_fma_f32 v69, v69, s28, v11
    v_fma_f32 v77, v77, s28, v12
    v_mfma_f32_16x16x32_bf16 v[208:211], a[212:215], v[26:29], v[208:211]
    ds_read_b64_tr_b16 a[228:229], v2 offset:1024
    v_fma_f32 v68, v68, s28, v11
    v_mfma_f32_16x16x32_bf16 v[212:215], a[216:219], v[26:29], v[212:215]
    v_fma_f32 v76, v76, s28, v12
    v_fma_f32 v72, v72, s28, v11
    v_mfma_f32_16x16x32_bf16 a[4:7], a[216:219], v[32:35], a[4:7]
    v_exp_f32 v66, v66
    v_mfma_f32_16x16x32_bf16 a[0:3], a[212:215], v[32:35], a[0:3]
    v_fma_f32 v89, v89, s28, v13
    v_fma_f32 v82, v82, s28, v12
    v_mfma_f32_16x16x32_bf16 a[48:51], a[212:215], v[38:41], a[48:51]
    s_add_u32 s39, s39, 12288
    ds_read_b64_tr_b16 a[232:233], v3 offset:1024
    v_fma_f32 v83, v83, s28, v12
    v_mfma_f32_16x16x32_bf16 a[52:55], a[216:219], v[38:41], a[52:55]
    s_waitcnt lgkmcnt(3)
    ds_read_b64_tr_b16 a[234:235], v3 offset:7168
    v_fma_f32 v79, v79, s28, v12
    v_mfma_f32_16x16x32_bf16 a[56:59], a[220:223], v[38:41], a[56:59]
    s_waitcnt vmcnt(0)
    v_fma_f32 v74, v74, s28, v11
    v_fma_f32 v86, v86, s28, v13
    v_mfma_f32_16x16x32_bf16 a[60:63], a[224:227], v[38:41], a[60:63]
    ds_read_b64_tr_b16 a[214:215], v4 offset:7168
    v_fma_f32 v87, v87, s28, v13
    v_mfma_f32_16x16x32_bf16 a[12:15], a[224:227], v[32:35], a[12:15]
    s_barrier
    v_mfma_f32_16x16x32_bf16 a[8:11], a[220:223], v[32:35], a[8:11]
    v_exp_f32 v56, v56
    v_mfma_f32_16x16x32_bf16 v[216:219], a[220:223], v[26:29], v[216:219]
    ds_read_b64_tr_b16 a[216:217], v5 offset:1024
    v_fma_f32 v73, v73, s28, v11
    v_mfma_f32_16x16x32_bf16 v[220:223], a[224:227], v[26:29], v[220:223]
    v_exp_f32 v71, v71
    v_mfma_f32_16x16x32_bf16 v[172:175], a[224:227], v[20:23], v[172:175]
    v_fma_f32 v84, v84, s28, v13
    v_fma_f32 v81, v81, s28, v12
    v_mfma_f32_16x16x32_bf16 v[168:171], a[220:223], v[20:23], v[168:171]
    ds_read_b64_tr_b16 a[218:219], v5 offset:7168
    v_fma_f32 v91, v91, s28, v13
    v_mfma_f32_16x16x32_bf16 v[120:123], a[220:223], v[14:17], v[120:123]
    ds_read_b64_tr_b16 a[212:213], v4 offset:1024
    v_fma_f32 v58, v58, s28, v9
    v_mfma_f32_16x16x32_bf16 v[124:127], a[224:227], v[14:17], v[124:127]
    s_waitcnt lgkmcnt(4)
    v_exp_f32 v76, v76
    v_mfma_f32_16x16x32_bf16 v[128:131], a[228:231], v[14:17], v[128:131]
    v_exp_f32 v74, v74
    v_mfma_f32_16x16x32_bf16 v[132:135], a[232:235], v[14:17], v[132:135]
    ds_read_b64_tr_b16 a[224:225], v3 offset:2048
    v_fma_f32 v85, v85, s28, v13
    v_mfma_f32_16x16x32_bf16 v[180:183], a[232:235], v[20:23], v[180:183]
    ds_read_b64_tr_b16 a[222:223], v2 offset:8192
    v_fma_f32 v67, v67, s28, v10
    v_fma_f32 v90, v90, s28, v13
    v_mfma_f32_16x16x32_bf16 v[176:179], a[228:231], v[20:23], v[176:179]
    v_exp_f32 v91, v91
    v_mfma_f32_16x16x32_bf16 v[224:227], a[228:231], v[26:29], v[224:227]
    v_exp_f32 v70, v70
    v_mfma_f32_16x16x32_bf16 v[228:231], a[232:235], v[26:29], v[228:231]
    v_exp_f32 v82, v82
    v_mfma_f32_16x16x32_bf16 a[20:23], a[232:235], v[32:35], a[20:23]
    ds_read_b64_tr_b16 a[220:221], v2 offset:2048
    v_fma_f32 v65, v65, s28, v10
    v_mfma_f32_16x16x32_bf16 a[16:19], a[228:231], v[32:35], a[16:19]
    v_exp_f32 v64, v64
    v_mfma_f32_16x16x32_bf16 a[64:67], a[228:231], v[38:41], a[64:67]
    ds_read_b64_tr_b16 a[226:227], v3 offset:8192
    v_exp_f32 v65, v65
    v_mfma_f32_16x16x32_bf16 a[68:71], a[232:235], v[38:41], a[68:71]
    s_waitcnt lgkmcnt(4)
    v_fma_f32 v75, v75, s28, v11
    v_fma_f32 v59, v59, s28, v9
    v_mfma_f32_16x16x32_bf16 a[72:75], a[212:215], v[38:41], a[72:75]
    ds_read_b64_tr_b16 a[230:231], v4 offset:8192
    v_fma_f32 v88, v88, s28, v13
    v_mfma_f32_16x16x32_bf16 a[76:79], a[216:219], v[38:41], a[76:79]
    ds_read_b64_tr_b16 a[232:233], v5 offset:2048
    v_fma_f32 v80, v80, s28, v12
    v_mfma_f32_16x16x32_bf16 a[28:31], a[216:219], v[32:35], a[28:31]
    v_exp_f32 v79, v79
    v_mfma_f32_16x16x32_bf16 a[24:27], a[212:215], v[32:35], a[24:27]
    ds_read_b64_tr_b16 a[234:235], v5 offset:8192
    v_exp_f32 v84, v84
    v_mfma_f32_16x16x32_bf16 v[232:235], a[212:215], v[26:29], v[232:235]
    v_exp_f32 v83, v83
    v_mfma_f32_16x16x32_bf16 v[236:239], a[216:219], v[26:29], v[236:239]
    v_exp_f32 v77, v77
    v_mfma_f32_16x16x32_bf16 v[188:191], a[216:219], v[20:23], v[188:191]
    v_exp_f32 v81, v81
    v_mfma_f32_16x16x32_bf16 v[184:187], a[212:215], v[20:23], v[184:187]
    v_exp_f32 v89, v89
    v_mfma_f32_16x16x32_bf16 v[136:139], a[212:215], v[14:17], v[136:139]
    v_exp_f32 v73, v73
    v_mfma_f32_16x16x32_bf16 v[140:143], a[216:219], v[14:17], v[140:143]
    s_waitcnt lgkmcnt(3)
    ds_read_b64_tr_b16 a[228:229], v4 offset:2048
    v_fma_f32 v78, v78, s28, v12
    v_mfma_f32_16x16x32_bf16 v[144:147], a[220:223], v[14:17], v[144:147]
    v_exp_f32 v90, v90
    v_mfma_f32_16x16x32_bf16 v[148:151], a[224:227], v[14:17], v[148:151]
    v_exp_f32 v59, v59
    v_fma_f32 v57, v57, s28, v9
    v_mfma_f32_16x16x32_bf16 v[196:199], a[224:227], v[20:23], v[196:199]
    v_exp_f32 v85, v85
    v_mfma_f32_16x16x32_bf16 v[192:195], a[220:223], v[20:23], v[192:195]
    v_exp_f32 v57, v57
    v_mfma_f32_16x16x32_bf16 v[240:243], a[220:223], v[26:29], v[240:243]
    v_exp_f32 v80, v80
    v_mfma_f32_16x16x32_bf16 v[244:247], a[224:227], v[26:29], v[244:247]
    v_exp_f32 v75, v75
    v_mfma_f32_16x16x32_bf16 a[36:39], a[224:227], v[32:35], a[36:39]
    v_exp_f32 v78, v78
    v_mfma_f32_16x16x32_bf16 a[32:35], a[220:223], v[32:35], a[32:35]
    v_exp_f32 v88, v88
    v_mfma_f32_16x16x32_bf16 a[80:83], a[220:223], v[38:41], a[80:83]
    v_exp_f32 v72, v72
    v_mfma_f32_16x16x32_bf16 a[84:87], a[224:227], v[38:41], a[84:87]
    s_waitcnt lgkmcnt(0)
    ds_read_b64_tr_b16 a[212:213], v2 offset:18432
    v_exp_f32 v68, v68
    v_mfma_f32_16x16x32_bf16 a[88:91], a[228:231], v[38:41], a[88:91]
    v_exp_f32 v67, v67
    v_mfma_f32_16x16x32_bf16 a[92:95], a[232:235], v[38:41], a[92:95]
    ds_read_b64_tr_b16 a[214:215], v2 offset:12288
    v_cvt_pk_bf16_f32 v37, v78, v79
    v_mfma_f32_16x16x32_bf16 a[44:47], a[232:235], v[32:35], a[44:47]
    v_exp_f32 v58, v58
    v_mfma_f32_16x16x32_bf16 a[40:43], a[228:231], v[32:35], a[40:43]
    ds_read_b64_tr_b16 a[216:217], v3 offset:18432
    v_exp_f32 v69, v69
    v_mfma_f32_16x16x32_bf16 v[248:251], a[228:231], v[26:29], v[248:251]
    ds_read_b64_tr_b16 a[218:219], v3 offset:12288
    v_cvt_pk_bf16_f32 v42, v84, v85
    v_mfma_f32_16x16x32_bf16 v[252:255], a[232:235], v[26:29], v[252:255]
    v_exp_f32 v86, v86
    v_mfma_f32_16x16x32_bf16 v[204:207], a[232:235], v[20:23], v[204:207]
    ds_read_b64_tr_b16 a[220:221], v4 offset:18432
    v_cvt_pk_bf16_f32 v30, v68, v69
    v_mfma_f32_16x16x32_bf16 v[200:203], a[228:231], v[20:23], v[200:203]
    v_cvt_pk_bf16_f32 v23, v66, v67
    v_cvt_pk_bf16_f32 v36, v76, v77
    v_mfma_f32_16x16x32_bf16 v[152:155], a[228:231], v[14:17], v[152:155]
    v_cvt_pk_bf16_f32 v22, v64, v65
    v_cvt_pk_bf16_f32 v34, v80, v81
    v_mfma_f32_16x16x32_bf16 v[156:159], a[232:235], v[14:17], v[156:159]
    v_cvt_pk_bf16_f32 v29, v74, v75
    v_cvt_pk_bf16_f32 v17, v58, v59
    v_cvt_pk_bf16_f32 v35, v82, v83
    v_cvt_pk_bf16_f32 v16, v56, v57
    v_cvt_pk_bf16_f32 v31, v70, v71
    v_cvt_pk_bf16_f32 v28, v72, v73
    v_mfma_f32_16x16x32_bf16 v[48:51], a[236:239], v[16:19], v[44:47]
    ds_read_b64_tr_b16 a[222:223], v4 offset:12288
    v_cvt_pk_bf16_f32 v40, v88, v89
    v_mfma_f32_16x16x32_bf16 v[48:51], a[240:243], v[22:25], v[48:51]
    v_exp_f32 v87, v87
    v_mfma_f32_16x16x32_bf16 v[48:51], a[244:247], v[28:31], v[48:51]
    v_cvt_pk_bf16_f32 v41, v90, v91
    v_cvt_pk_bf16_f32 v43, v86, v87
    v_mfma_f32_16x16x32_bf16 v[48:51], a[248:251], v[34:37], v[48:51]
    ds_read_b64_tr_b16 a[224:225], v5 offset:18432
    v_mfma_f32_16x16x32_bf16 v[48:51], a[252:255], v[40:43], v[48:51]
    s_waitcnt lgkmcnt(3)
    ds_read_b64_tr_b16 a[226:227], v5 offset:12288
    s_nop 5
    v_cmp_lt_f32 vcc, s29, v48
    s_nop 4
    s_cbranch_vccnz L_rs_end5b
L_ret_end5b:
    v_lshrrev_b32 v108, 11, v0
    v_xor_b32 v108, s65, v108
    v_and_b32 v101, 0x3ff, v0
    v_lshl_add_u32 v101, v108, 10, v101
    v_add_u32 v101, s38, v101
    v_mbcnt_lo_u32_b32 v108, -1, 0
    v_mbcnt_hi_u32_b32 v108, -1, v108
    v_lshrrev_b32 v108, 1, v108
    v_mov_b32 v100, v48
    v_and_b32 v108, 24, v108
    v_bfe_u32 v108, s66, v108, 8
    v_xor_b32 v101, v101, v108
    v_permlane32_swap_b32 v48, v100
    v_mov_b32 v108, v100
    v_rcp_f32 v8, v51
    v_rcp_f32 v102, v49
    v_permlane16_swap_b32 v100, v108
    v_rcp_f32 v48, v48
    v_rcp_f32 v100, v100
    v_rcp_f32 v50, v50
    v_mfma_f32_16x16x32_bf16 v[112:115], a[212:215], v[16:19], v[112:115]
    v_xor_b32 v92, 32, v101
    v_mfma_f32_16x16x32_bf16 v[116:119], a[216:219], v[16:19], v[116:119]
    v_mfma_f32_16x16x32_bf16 v[164:167], a[216:219], v[22:25], v[164:167]
    v_mfma_f32_16x16x32_bf16 v[160:163], a[212:215], v[22:25], v[160:163]
    s_add_u32 s84, s34, 0
    ds_read_b64_tr_b16 a[228:229], v2 offset:19456
    v_mfma_f32_16x16x32_bf16 v[208:211], a[212:215], v[28:31], v[208:211]
    v_mfma_f32_16x16x32_bf16 v[212:215], a[216:219], v[28:31], v[212:215]
    ds_read_b64_tr_b16 a[230:231], v2 offset:13312
    v_mfma_f32_16x16x32_bf16 a[4:7], a[216:219], v[34:37], a[4:7]
    v_mfma_f32_16x16x32_bf16 a[0:3], a[212:215], v[34:37], a[0:3]
    v_subrev_u32 v103, 28672, v103
    s_add_u32 s85, s34, 6144
    v_mfma_f32_16x16x32_bf16 a[48:51], a[212:215], v[40:43], a[48:51]
    v_mfma_f32_16x16x32_bf16 a[52:55], a[216:219], v[40:43], a[52:55]
    s_waitcnt lgkmcnt(2)
    ds_read_b64_tr_b16 a[234:235], v3 offset:13312
    v_mfma_f32_16x16x32_bf16 a[56:59], a[220:223], v[40:43], a[56:59]
    ds_read_b64_tr_b16 a[232:233], v3 offset:19456
    v_mfma_f32_16x16x32_bf16 a[60:63], a[224:227], v[40:43], a[60:63]
    v_mfma_f32_16x16x32_bf16 a[12:15], a[224:227], v[34:37], a[12:15]
    ds_read_b64_tr_b16 a[218:219], v5 offset:13312
    v_mfma_f32_16x16x32_bf16 a[8:11], a[220:223], v[34:37], a[8:11]
    ds_read_b64_tr_b16 a[214:215], v4 offset:13312
    v_accvgpr_read_b32 v105, a1
    v_mfma_f32_16x16x32_bf16 v[216:219], a[220:223], v[28:31], v[216:219]
    ds_read_b64_tr_b16 a[216:217], v5 offset:19456
    v_mfma_f32_16x16x32_bf16 v[220:223], a[224:227], v[28:31], v[220:223]
    v_mfma_f32_16x16x32_bf16 v[172:175], a[224:227], v[22:25], v[172:175]
    v_mfma_f32_16x16x32_bf16 v[168:171], a[220:223], v[22:25], v[168:171]
    ds_read_b64_tr_b16 a[212:213], v4 offset:19456
    v_mfma_f32_16x16x32_bf16 v[120:123], a[220:223], v[16:19], v[120:123]
    ds_read_b64_tr_b16 a[220:221], v2 offset:20480
    v_mfma_f32_16x16x32_bf16 v[124:127], a[224:227], v[16:19], v[124:127]
    s_waitcnt lgkmcnt(6)
    ds_read_b64_tr_b16 a[222:223], v2 offset:14336
    v_mfma_f32_16x16x32_bf16 v[128:131], a[228:231], v[16:19], v[128:131]
    s_waitcnt lgkmcnt(6)
    v_accvgpr_read_b32 v107, a3
    v_mfma_f32_16x16x32_bf16 v[132:135], a[232:235], v[16:19], v[132:135]
    v_mfma_f32_16x16x32_bf16 v[180:183], a[232:235], v[22:25], v[180:183]
    s_add_u32 s86, s34, 12288
    v_accvgpr_read_b32 v52, a8
    v_accvgpr_read_b32 v56, a12
    v_mfma_f32_16x16x32_bf16 v[176:179], a[228:231], v[22:25], v[176:179]
    v_mfma_f32_16x16x32_bf16 v[224:227], a[228:231], v[28:31], v[224:227]
    v_mfma_f32_16x16x32_bf16 v[228:231], a[232:235], v[28:31], v[228:231]
    v_accvgpr_read_b32 v54, a10
    v_accvgpr_read_b32 v109, a5
    v_mfma_f32_16x16x32_bf16 a[20:23], a[232:235], v[34:37], a[20:23]
    v_mfma_f32_16x16x32_bf16 a[16:19], a[228:231], v[34:37], a[16:19]
    v_accvgpr_read_b32 v57, a13
    v_mfma_f32_16x16x32_bf16 a[64:67], a[228:231], v[40:43], a[64:67]
    v_mfma_f32_16x16x32_bf16 a[68:71], a[232:235], v[40:43], a[68:71]
    s_waitcnt lgkmcnt(0)
    v_mfma_f32_16x16x32_bf16 a[72:75], a[212:215], v[40:43], a[72:75]
    ds_read_b64_tr_b16 a[228:229], v4 offset:20480
    v_mfma_f32_16x16x32_bf16 a[76:79], a[216:219], v[40:43], a[76:79]
    s_add_u32 s87, s34, 18432
    v_mfma_f32_16x16x32_bf16 a[28:31], a[216:219], v[34:37], a[28:31]
    ds_read_b64_tr_b16 a[234:235], v5 offset:14336
    v_accvgpr_read_b32 v55, a11
    v_mfma_f32_16x16x32_bf16 a[24:27], a[212:215], v[34:37], a[24:27]
    ds_read_b64_tr_b16 a[224:225], v3 offset:20480
    v_xor_b32 v93, 64, v101
    v_mfma_f32_16x16x32_bf16 v[232:235], a[212:215], v[28:31], v[232:235]
    ds_read_b64_tr_b16 a[226:227], v3 offset:14336
    v_accvgpr_read_b32 v59, a15
    v_mfma_f32_16x16x32_bf16 v[236:239], a[216:219], v[28:31], v[236:239]
    ds_read_b64_tr_b16 a[232:233], v5 offset:20480
    v_mfma_f32_16x16x32_bf16 v[188:191], a[216:219], v[22:25], v[188:191]
    s_add_u32 s88, s34, 24576
    v_xor_b32 v94, 96, v101
    v_accvgpr_read_b32 v104, a0
    v_mfma_f32_16x16x32_bf16 v[184:187], a[212:215], v[22:25], v[184:187]
    v_mfma_f32_16x16x32_bf16 v[136:139], a[212:215], v[16:19], v[136:139]
    ds_read_b64_tr_b16 a[230:231], v4 offset:14336
    v_accvgpr_read_b32 v58, a14
    v_mfma_f32_16x16x32_bf16 v[140:143], a[216:219], v[16:19], v[140:143]
    v_accvgpr_read_b32 v106, a2
    v_accvgpr_read_b32 v53, a9
    v_accvgpr_read_b32 v110, a6
    v_pk_mul_f32 v[126:127], v[126:127], v[48:49] op_sel_hi:[1,0]
    v_pk_mul_f32 v[118:119], v[118:119], v[48:49] op_sel_hi:[1,0]
    v_pk_mul_f32 v[120:121], v[120:121], v[48:49] op_sel_hi:[1,0]
    v_pk_mul_f32 v[124:125], v[124:125], v[48:49] op_sel_hi:[1,0]
    v_pk_mul_f32 v[162:163], v[162:163], v[102:103] op_sel_hi:[1,0]
    v_pk_mul_f32 v[122:123], v[122:123], v[48:49] op_sel_hi:[1,0]
    v_pk_mul_f32 v[166:167], v[166:167], v[102:103] op_sel_hi:[1,0]
    v_pk_mul_f32 v[114:115], v[114:115], v[48:49] op_sel_hi:[1,0]
    v_pk_mul_f32 v[168:169], v[168:169], v[102:103] op_sel_hi:[1,0]
    v_pk_mul_f32 v[160:161], v[160:161], v[102:103] op_sel_hi:[1,0]
    v_pk_mul_f32 v[116:117], v[116:117], v[48:49] op_sel_hi:[1,0]
    v_pk_mul_f32 v[208:209], v[208:209], v[50:51] op_sel_hi:[1,0]
    v_pk_mul_f32 v[170:171], v[170:171], v[102:103] op_sel_hi:[1,0]
    v_pk_mul_f32 v[164:165], v[164:165], v[102:103] op_sel_hi:[1,0]
    v_pk_mul_f32 v[172:173], v[172:173], v[102:103] op_sel_hi:[1,0]
    v_pk_mul_f32 v[174:175], v[174:175], v[102:103] op_sel_hi:[1,0]
    v_pk_mul_f32 v[112:113], v[112:113], v[48:49] op_sel_hi:[1,0]
    v_cvt_pk_bf16_f32 v120, v120, v121
    v_cvt_pk_bf16_f32 v121, v122, v123
    v_mfma_f32_16x16x32_bf16 v[144:147], a[220:223], v[16:19], v[144:147]
    s_waitcnt lgkmcnt(1)
    v_cvt_pk_bf16_f32 v124, v124, v125
    v_cvt_pk_bf16_f32 v160, v160, v161
    v_mfma_f32_16x16x32_bf16 v[148:151], a[224:227], v[16:19], v[148:151]
    v_cvt_pk_bf16_f32 v164, v164, v165
    v_cvt_pk_bf16_f32 v172, v172, v173
    v_mfma_f32_16x16x32_bf16 v[196:199], a[224:227], v[22:25], v[196:199]
    v_cvt_pk_bf16_f32 v112, v112, v113
    v_cvt_pk_bf16_f32 v116, v116, v117
    v_mfma_f32_16x16x32_bf16 v[192:195], a[220:223], v[22:25], v[192:195]
    v_cvt_pk_bf16_f32 v113, v114, v115
    v_cvt_pk_bf16_f32 v117, v118, v119
    v_mfma_f32_16x16x32_bf16 v[240:243], a[220:223], v[28:31], v[240:243]
    v_cvt_pk_bf16_f32 v165, v166, v167
    v_cvt_pk_bf16_f32 v125, v126, v127
    v_mfma_f32_16x16x32_bf16 v[244:247], a[224:227], v[28:31], v[244:247]
    v_cvt_pk_bf16_f32 v173, v174, v175
    v_cvt_pk_bf16_f32 v168, v168, v169
    v_mfma_f32_16x16x32_bf16 a[36:39], a[224:227], v[34:37], a[36:39]
    s_add_u32 s18, s34, 30720
    v_cvt_pk_bf16_f32 v161, v162, v163
    v_cvt_pk_bf16_f32 v169, v170, v171
    v_mfma_f32_16x16x32_bf16 a[32:35], a[220:223], v[34:37], a[32:35]
    ds_write2st64_b64 v101, v[112:113], v[160:161] offset0:0 offset1:12
    v_mfma_f32_16x16x32_bf16 a[80:83], a[220:223], v[40:43], a[80:83]
    ds_write2st64_b64 v92, v[116:117], v[164:165] offset0:0 offset1:12
    v_mfma_f32_16x16x32_bf16 a[84:87], a[224:227], v[40:43], a[84:87]
    s_waitcnt lgkmcnt(2)
    ds_write2st64_b64 v93, v[120:121], v[168:169] offset0:0 offset1:12
    v_mfma_f32_16x16x32_bf16 a[88:91], a[228:231], v[40:43], a[88:91]
    ds_write2st64_b64 v94, v[124:125], v[172:173] offset0:0 offset1:12
    v_mfma_f32_16x16x32_bf16 a[92:95], a[232:235], v[40:43], a[92:95]
    ds_read_b128 v[60:63], v103 offset:0
    v_mfma_f32_16x16x32_bf16 a[44:47], a[232:235], v[34:37], a[44:47]
    ds_read_b128 v[64:67], v103 offset:1024
    v_pk_mul_f32 v[150:151], v[150:151], v[48:49] op_sel_hi:[1,0]
    v_pk_mul_f32 v[216:217], v[216:217], v[50:51] op_sel_hi:[1,0]
    v_pk_mul_f32 v[220:221], v[220:221], v[50:51] op_sel_hi:[1,0]
    v_pk_mul_f32 v[58:59], v[58:59], v[8:9] op_sel_hi:[1,0]
    v_pk_mul_f32 v[56:57], v[56:57], v[8:9] op_sel_hi:[1,0]
    v_pk_mul_f32 v[136:137], v[136:137], v[48:49] op_sel_hi:[1,0]
    v_pk_mul_f32 v[52:53], v[52:53], v[8:9] op_sel_hi:[1,0]
    v_pk_mul_f32 v[142:143], v[142:143], v[48:49] op_sel_hi:[1,0]
    v_pk_mul_f32 v[218:219], v[218:219], v[50:51] op_sel_hi:[1,0]
    v_pk_mul_f32 v[140:141], v[140:141], v[48:49] op_sel_hi:[1,0]
    v_cvt_pk_bf16_f32 v52, v52, v53
    v_pk_mul_f32 v[148:149], v[148:149], v[48:49] op_sel_hi:[1,0]
    v_accvgpr_read_b32 v108, a4
    v_pk_mul_f32 v[104:105], v[104:105], v[8:9] op_sel_hi:[1,0]
    v_pk_mul_f32 v[214:215], v[214:215], v[50:51] op_sel_hi:[1,0]
    v_pk_mul_f32 v[212:213], v[212:213], v[50:51] op_sel_hi:[1,0]
    v_pk_mul_f32 v[138:139], v[138:139], v[48:49] op_sel_hi:[1,0]
    v_pk_mul_f32 v[54:55], v[54:55], v[8:9] op_sel_hi:[1,0]
    v_pk_mul_f32 v[106:107], v[106:107], v[8:9] op_sel_hi:[1,0]
    v_pk_mul_f32 v[128:129], v[128:129], v[48:49] op_sel_hi:[1,0]
    v_pk_mul_f32 v[222:223], v[222:223], v[50:51] op_sel_hi:[1,0]
    s_nop 1
    v_mfma_f32_16x16x32_bf16 a[40:43], a[228:231], v[34:37], a[40:43]
    v_mfma_f32_16x16x32_bf16 v[248:251], a[228:231], v[28:31], v[248:251]
    s_waitcnt lgkmcnt(1)
    buffer_store_dwordx4 v[60:63], v6, s[16:19], s84 offen offset:0 nt
    ds_read_b128 v[68:71], v103 offset:6144
    v_cvt_pk_bf16_f32 v53, v54, v55
    v_pk_mul_f32 v[108:109], v[108:109], v[8:9] op_sel_hi:[1,0]
    v_cvt_pk_bf16_f32 v220, v220, v221
    v_pk_mul_f32 v[210:211], v[210:211], v[50:51] op_sel_hi:[1,0]
    v_pk_mul_f32 v[180:181], v[180:181], v[102:103] op_sel_hi:[1,0]
    v_pk_mul_f32 v[188:189], v[188:189], v[102:103] op_sel_hi:[1,0]
    v_cvt_pk_bf16_f32 v216, v216, v217
    s_nop 0
    v_mfma_f32_16x16x32_bf16 v[252:255], a[232:235], v[28:31], v[252:255]
    v_cvt_pk_bf16_f32 v56, v56, v57
    v_cvt_pk_bf16_f32 v108, v108, v109
    v_accvgpr_read_b32 v111, a7
    v_cvt_pk_bf16_f32 v104, v104, v105
    ds_read_b128 v[72:75], v103 offset:7168
    v_cvt_pk_bf16_f32 v221, v222, v223
    v_pk_mul_f32 v[110:111], v[110:111], v[8:9] op_sel_hi:[1,0]
    v_cvt_pk_bf16_f32 v212, v212, v213
    v_cvt_pk_bf16_f32 v213, v214, v215
    v_cvt_pk_bf16_f32 v208, v208, v209
    v_cvt_pk_bf16_f32 v105, v106, v107
    v_cvt_pk_bf16_f32 v209, v210, v211
    v_cvt_pk_bf16_f32 v57, v58, v59
    v_cvt_pk_bf16_f32 v188, v188, v189
    v_mfma_f32_16x16x32_bf16 v[204:207], a[232:235], v[22:25], v[204:207]
    s_waitcnt lgkmcnt(2)
    buffer_store_dwordx4 v[64:67], v7, s[16:19], s84 offen offset:0 nt
    v_cvt_pk_bf16_f32 v109, v110, v111
    v_cvt_pk_bf16_f32 v140, v140, v141
    ds_write2st64_b64 v101, v[208:209], v[104:105] offset0:24 offset1:36
    v_cvt_pk_bf16_f32 v136, v136, v137
    v_pk_mul_f32 v[236:237], v[236:237], v[50:51] op_sel_hi:[1,0]
    v_accvgpr_read_b32 v54, a58
    v_pk_mul_f32 v[130:131], v[130:131], v[48:49] op_sel_hi:[1,0]
    v_pk_mul_f32 v[240:241], v[240:241], v[50:51] op_sel_hi:[1,0]
    v_accvgpr_read_b32 v59, a63
    v_cvt_pk_bf16_f32 v217, v218, v219
    v_accvgpr_read_b32 v104, a48
    v_pk_mul_f32 v[226:227], v[226:227], v[50:51] op_sel_hi:[1,0]
    v_accvgpr_read_b32 v58, a62
    v_cvt_pk_bf16_f32 v128, v128, v129
    v_mfma_f32_16x16x32_bf16 v[200:203], a[228:231], v[22:25], v[200:203]
    s_waitcnt lgkmcnt(1)
    v_cvt_pk_bf16_f32 v137, v138, v139
    ds_write2st64_b64 v92, v[212:213], v[108:109] offset0:24 offset1:36
    buffer_store_dwordx4 v[68:71], v6, s[16:19], s85 offen offset:0 nt
    ds_write2st64_b64 v93, v[216:217], v[52:53] offset0:24 offset1:36
    v_pk_mul_f32 v[254:255], v[254:255], v[50:51] op_sel_hi:[1,0]
    v_pk_mul_f32 v[182:183], v[182:183], v[102:103] op_sel_hi:[1,0]
    v_pk_mul_f32 v[224:225], v[224:225], v[50:51] op_sel_hi:[1,0]
    v_accvgpr_read_b32 v53, a57
    v_accvgpr_read_b32 v108, a52
    v_mfma_f32_16x16x32_bf16 v[152:155], a[228:231], v[16:19], v[152:155]
    ds_write2st64_b64 v94, v[220:221], v[56:57] offset0:24 offset1:36
    v_cvt_pk_bf16_f32 v236, v236, v237
    v_accvgpr_read_b32 v55, a59
    v_accvgpr_read_b32 v52, a56
    v_pk_mul_f32 v[228:229], v[228:229], v[50:51] op_sel_hi:[1,0]
    v_cvt_pk_bf16_f32 v141, v142, v143
    ds_read_b128 v[76:79], v103 offset:12288
    v_accvgpr_read_b32 v57, a61
    v_pk_mul_f32 v[132:133], v[132:133], v[48:49] op_sel_hi:[1,0]
    buffer_store_dwordx4 v[72:75], v7, s[16:19], s85 offen offset:0 nt
    v_accvgpr_read_b32 v105, a49
    v_pk_mul_f32 v[244:245], v[244:245], v[50:51] op_sel_hi:[1,0]
    v_pk_mul_f32 v[238:239], v[238:239], v[50:51] op_sel_hi:[1,0]
    v_pk_mul_f32 v[234:235], v[234:235], v[50:51] op_sel_hi:[1,0]
    v_cvt_pk_bf16_f32 v224, v224, v225
    v_pk_mul_f32 v[58:59], v[58:59], v[100:101] op_sel_hi:[1,0]
    v_pk_mul_f32 v[198:199], v[198:199], v[102:103] op_sel_hi:[1,0]
    v_cvt_pk_bf16_f32 v180, v180, v181
    v_pk_mul_f32 v[230:231], v[230:231], v[50:51] op_sel_hi:[1,0]
    v_accvgpr_read_b32 v109, a53
    v_pk_mul_f32 v[52:53], v[52:53], v[100:101] op_sel_hi:[1,0]
    v_cvt_pk_bf16_f32 v129, v130, v131
    v_pk_mul_f32 v[190:191], v[190:191], v[102:103] op_sel_hi:[1,0]
    ds_read_b128 v[80:83], v103 offset:13312
    v_pk_mul_f32 v[108:109], v[108:109], v[100:101] op_sel_hi:[1,0]
    ds_read_b128 v[84:87], v103 offset:18432
    v_pk_mul_f32 v[232:233], v[232:233], v[50:51] op_sel_hi:[1,0]
    v_pk_mul_f32 v[104:105], v[104:105], v[100:101] op_sel_hi:[1,0]
    ds_read_b128 v[88:91], v103 offset:19456
    v_pk_mul_f32 v[54:55], v[54:55], v[100:101] op_sel_hi:[1,0]
    v_accvgpr_read_b32 v110, a54
    v_accvgpr_read_b32 v106, a50
    v_mfma_f32_16x16x32_bf16 v[156:159], a[232:235], v[16:19], v[156:159]
    s_waitcnt lgkmcnt(3)
    buffer_store_dwordx4 v[76:79], v6, s[16:19], s86 offen offset:0 nt
    v_pk_mul_f32 v[176:177], v[176:177], v[102:103] op_sel_hi:[1,0]
    v_accvgpr_read_b32 v111, a55
    v_accvgpr_read_b32 v107, a51
    v_cvt_pk_bf16_f32 v52, v52, v53
    v_cvt_pk_bf16_f32 v132, v132, v133
    v_pk_mul_f32 v[250:251], v[250:251], v[50:51] op_sel_hi:[1,0]
    v_cvt_pk_bf16_f32 v104, v104, v105
    v_cvt_pk_bf16_f32 v53, v54, v55
    v_accvgpr_read_b32 v56, a60
    v_pk_mul_f32 v[110:111], v[110:111], v[100:101] op_sel_hi:[1,0]
    v_pk_mul_f32 v[56:57], v[56:57], v[100:101] op_sel_hi:[1,0]
    v_cvt_pk_bf16_f32 v108, v108, v109
    v_pk_mul_f32 v[194:195], v[194:195], v[102:103] op_sel_hi:[1,0]
    v_cvt_pk_bf16_f32 v109, v110, v111
    v_cvt_pk_bf16_f32 v148, v148, v149
    v_pk_mul_f32 v[152:153], v[152:153], v[48:49] op_sel_hi:[1,0]
    v_cvt_pk_bf16_f32 v56, v56, v57
    v_cvt_pk_bf16_f32 v57, v58, v59
    v_pk_mul_f32 v[192:193], v[192:193], v[102:103] op_sel_hi:[1,0]
    v_pk_mul_f32 v[186:187], v[186:187], v[102:103] op_sel_hi:[1,0]
    v_pk_mul_f32 v[134:135], v[134:135], v[48:49] op_sel_hi:[1,0]
    v_pk_mul_f32 v[156:157], v[156:157], v[48:49] op_sel_hi:[1,0]
    v_pk_mul_f32 v[106:107], v[106:107], v[100:101] op_sel_hi:[1,0]
    v_pk_mul_f32 v[200:201], v[200:201], v[102:103] op_sel_hi:[1,0]
    s_waitcnt lgkmcnt(1)
    buffer_store_dwordx4 v[80:83], v7, s[16:19], s86 offen offset:0 nt
    v_cvt_pk_bf16_f32 v105, v106, v107
    v_pk_mul_f32 v[184:185], v[184:185], v[102:103] op_sel_hi:[1,0]
    v_cvt_pk_bf16_f32 v181, v182, v183
    v_accvgpr_read_b32 v59, a31
    v_pk_mul_f32 v[154:155], v[154:155], v[48:49] op_sel_hi:[1,0]
    ds_write_b64 v101, v[104:105] offset:24576
    v_cvt_pk_bf16_f32 v192, v192, v193
    v_accvgpr_read_b32 v107, a19
    ds_write_b64 v92, v[108:109] offset:24576
    v_cvt_pk_bf16_f32 v156, v156, v157
    v_pk_mul_f32 v[246:247], v[246:247], v[50:51] op_sel_hi:[1,0]
    v_accvgpr_read_b32 v54, a26
    v_pk_mul_f32 v[144:145], v[144:145], v[48:49] op_sel_hi:[1,0]
    v_cvt_pk_bf16_f32 v237, v238, v239
    v_accvgpr_read_b32 v106, a18
    v_cvt_pk_bf16_f32 v176, v176, v177
    v_pk_mul_f32 v[178:179], v[178:179], v[102:103] op_sel_hi:[1,0]
    v_accvgpr_read_b32 v109, a21
    v_cvt_pk_bf16_f32 v244, v244, v245
    v_cvt_pk_bf16_f32 v228, v228, v229
    buffer_store_dwordx4 v[84:87], v6, s[16:19], s87 offen offset:0 nt
    ds_write_b64 v93, v[52:53] offset:24576
    v_pk_mul_f32 v[204:205], v[204:205], v[102:103] op_sel_hi:[1,0]
    v_cvt_pk_bf16_f32 v177, v178, v179
    v_accvgpr_read_b32 v52, a24
    v_cvt_pk_bf16_f32 v232, v232, v233
    v_pk_mul_f32 v[248:249], v[248:249], v[50:51] op_sel_hi:[1,0]
    ds_write_b64 v94, v[56:57] offset:24576
    ds_read_b128 v[60:63], v103 offset:24576
    ds_read_b128 v[64:67], v103 offset:25600
    v_accvgpr_read_b32 v58, a30
    v_accvgpr_read_b32 v57, a29
    s_waitcnt lgkmcnt(4)
    buffer_store_dwordx4 v[88:91], v7, s[16:19], s87 offen offset:0 nt
    v_accvgpr_read_b32 v111, a23
    v_pk_mul_f32 v[252:253], v[252:253], v[50:51] op_sel_hi:[1,0]
    v_cvt_pk_bf16_f32 v152, v152, v153
    v_accvgpr_read_b32 v56, a28
    v_cvt_pk_bf16_f32 v189, v190, v191
    v_cvt_pk_bf16_f32 v184, v184, v185
    v_cvt_pk_bf16_f32 v133, v134, v135
    v_accvgpr_read_b32 v105, a17
    v_pk_mul_f32 v[106:107], v[106:107], v[8:9] op_sel_hi:[1,0]
    ds_write2st64_b64 v101, v[128:129], v[176:177] offset0:4 offset1:16
    v_pk_mul_f32 v[58:59], v[58:59], v[8:9] op_sel_hi:[1,0]
    v_cvt_pk_bf16_f32 v252, v252, v253
    v_cvt_pk_bf16_f32 v225, v226, v227
    v_cvt_pk_bf16_f32 v204, v204, v205
    ds_write2st64_b64 v92, v[132:133], v[180:181] offset0:4 offset1:16
    v_accvgpr_read_b32 v110, a22
    v_cvt_pk_bf16_f32 v185, v186, v187
    s_waitcnt lgkmcnt(2)
    buffer_store_dwordx4 v[60:63], v6, s[16:19], s88 offen offset:0 nt
    v_accvgpr_read_b32 v53, a25
    v_pk_mul_f32 v[56:57], v[56:57], v[8:9] op_sel_hi:[1,0]
    v_pk_mul_f32 v[196:197], v[196:197], v[102:103] op_sel_hi:[1,0]
    ds_write2st64_b64 v93, v[136:137], v[184:185] offset0:4 offset1:16
    v_pk_mul_f32 v[206:207], v[206:207], v[102:103] op_sel_hi:[1,0]
    ds_write2st64_b64 v94, v[140:141], v[188:189] offset0:4 offset1:16
    v_accvgpr_read_b32 v104, a16
    v_pk_mul_f32 v[104:105], v[104:105], v[8:9] op_sel_hi:[1,0]
    v_accvgpr_read_b32 v55, a27
    v_cvt_pk_bf16_f32 v104, v104, v105
    v_cvt_pk_bf16_f32 v233, v234, v235
    ds_read_b128 v[68:71], v103 offset:2048
    buffer_store_dwordx4 v[64:67], v7, s[16:19], s88 offen offset:0 nt
    ds_read_b128 v[72:75], v103 offset:3072
    v_cvt_pk_bf16_f32 v248, v248, v249
    v_cvt_pk_bf16_f32 v105, v106, v107
    v_cvt_pk_bf16_f32 v56, v56, v57
    v_pk_mul_f32 v[110:111], v[110:111], v[8:9] op_sel_hi:[1,0]
    v_cvt_pk_bf16_f32 v229, v230, v231
    v_pk_mul_f32 v[52:53], v[52:53], v[8:9] op_sel_hi:[1,0]
    ds_read_b128 v[76:79], v103 offset:8192
    v_cvt_pk_bf16_f32 v196, v196, v197
    v_accvgpr_read_b32 v106, a66
    ds_read_b128 v[80:83], v103 offset:9216
    v_accvgpr_read_b32 v108, a20
    v_pk_mul_f32 v[108:109], v[108:109], v[8:9] op_sel_hi:[1,0]
    ds_write2st64_b64 v101, v[224:225], v[104:105] offset0:28 offset1:40
    v_pk_mul_f32 v[54:55], v[54:55], v[8:9] op_sel_hi:[1,0]
    v_cvt_pk_bf16_f32 v108, v108, v109
    v_accvgpr_read_b32 v107, a67
    v_accvgpr_read_b32 v105, a65
    s_waitcnt lgkmcnt(4)
    buffer_store_dwordx4 v[68:71], v6, s[16:19], s84 offen offset:128 nt
    v_cvt_pk_bf16_f32 v52, v52, v53
    v_cvt_pk_bf16_f32 v144, v144, v145
    v_cvt_pk_bf16_f32 v57, v58, v59
    v_cvt_pk_bf16_f32 v53, v54, v55
    v_pk_mul_f32 v[242:243], v[242:243], v[50:51] op_sel_hi:[1,0]
    v_accvgpr_read_b32 v104, a64
    v_pk_mul_f32 v[104:105], v[104:105], v[100:101] op_sel_hi:[1,0]
    v_cvt_pk_bf16_f32 v109, v110, v111
    ds_write2st64_b64 v92, v[228:229], v[108:109] offset0:28 offset1:40
    v_accvgpr_read_b32 v108, a68
    s_waitcnt lgkmcnt(3)
    buffer_store_dwordx4 v[72:75], v7, s[16:19], s84 offen offset:128 nt
    v_accvgpr_read_b32 v109, a69
    ds_write2st64_b64 v93, v[232:233], v[52:53] offset0:28 offset1:40
    v_pk_mul_f32 v[202:203], v[202:203], v[102:103] op_sel_hi:[1,0]
    v_accvgpr_read_b32 v110, a70
    v_cvt_pk_bf16_f32 v193, v194, v195
    v_accvgpr_read_b32 v111, a71
    ds_write2st64_b64 v94, v[236:237], v[56:57] offset0:28 offset1:40
    v_pk_mul_f32 v[108:109], v[108:109], v[100:101] op_sel_hi:[1,0]
    ds_read_b128 v[84:87], v103 offset:14336
    v_accvgpr_read_b32 v53, a73
    v_accvgpr_read_b32 v59, a79
    v_pk_mul_f32 v[110:111], v[110:111], v[100:101] op_sel_hi:[1,0]
    v_accvgpr_read_b32 v57, a77
    v_accvgpr_read_b32 v54, a74
    buffer_store_dwordx4 v[76:79], v6, s[16:19], s85 offen offset:128 nt
    v_accvgpr_read_b32 v55, a75
    ds_read_b128 v[88:91], v103 offset:15360
    v_cvt_pk_bf16_f32 v108, v108, v109
    s_waitcnt lgkmcnt(4)
    buffer_store_dwordx4 v[80:83], v7, s[16:19], s85 offen offset:128 nt
    v_accvgpr_read_b32 v58, a78
    v_accvgpr_read_b32 v52, a72
    v_pk_mul_f32 v[58:59], v[58:59], v[100:101] op_sel_hi:[1,0]
    v_pk_mul_f32 v[54:55], v[54:55], v[100:101] op_sel_hi:[1,0]
    v_cvt_pk_bf16_f32 v109, v110, v111
    v_pk_mul_f32 v[146:147], v[146:147], v[48:49] op_sel_hi:[1,0]
    ds_read_b128 v[60:63], v103 offset:20480
    v_accvgpr_read_b32 v56, a76
    s_waitcnt lgkmcnt(1)
    buffer_store_dwordx4 v[84:87], v6, s[16:19], s86 offen offset:128 nt
    v_pk_mul_f32 v[52:53], v[52:53], v[100:101] op_sel_hi:[1,0]
    v_cvt_pk_bf16_f32 v249, v250, v251
    v_pk_mul_f32 v[106:107], v[106:107], v[100:101] op_sel_hi:[1,0]
    v_cvt_pk_bf16_f32 v200, v200, v201
    v_pk_mul_f32 v[56:57], v[56:57], v[100:101] op_sel_hi:[1,0]
    s_nop 0
    v_cvt_pk_bf16_f32 v56, v56, v57
    v_cvt_pk_bf16_f32 v52, v52, v53
    v_cvt_pk_bf16_f32 v104, v104, v105
    v_cvt_pk_bf16_f32 v197, v198, v199
    ds_read_b128 v[64:67], v103 offset:21504
    v_cvt_pk_bf16_f32 v205, v206, v207
    v_pk_mul_f32 v[158:159], v[158:159], v[48:49] op_sel_hi:[1,0]
    v_cvt_pk_bf16_f32 v105, v106, v107
    v_cvt_pk_bf16_f32 v149, v150, v151
    v_cvt_pk_bf16_f32 v240, v240, v241
    ds_write_b64 v101, v[104:105] offset:26624
    v_cvt_pk_bf16_f32 v53, v54, v55
    buffer_store_dwordx4 v[88:91], v7, s[16:19], s86 offen offset:128 nt
    v_accvgpr_read_b32 v111, a39
    ds_write_b64 v92, v[108:109] offset:26624
    v_accvgpr_read_b32 v105, a33
    ds_write_b64 v93, v[52:53] offset:26624
    v_accvgpr_read_b32 v106, a34
    v_cvt_pk_bf16_f32 v57, v58, v59
    v_cvt_pk_bf16_f32 v157, v158, v159
    v_accvgpr_read_b32 v52, a40
    v_cvt_pk_bf16_f32 v145, v146, v147
    v_cvt_pk_bf16_f32 v253, v254, v255
    v_accvgpr_read_b32 v59, a47
    v_cvt_pk_bf16_f32 v241, v242, v243
    v_accvgpr_read_b32 v110, a38
    v_accvgpr_read_b32 v104, a32
    ds_write_b64 v94, v[56:57] offset:26624
    s_waitcnt lgkmcnt(3)
    buffer_store_dwordx4 v[60:63], v6, s[16:19], s87 offen offset:128 nt
    v_accvgpr_read_b32 v109, a37
    v_accvgpr_read_b32 v55, a43
    v_accvgpr_read_b32 v107, a35
    v_accvgpr_read_b32 v54, a42
    v_accvgpr_read_b32 v57, a45
    v_accvgpr_read_b32 v108, a36
    ds_read_b128 v[68:71], v103 offset:26624
    v_pk_mul_f32 v[110:111], v[110:111], v[8:9] op_sel_hi:[1,0]
    v_cvt_pk_bf16_f32 v153, v154, v155
    ds_read_b128 v[72:75], v103 offset:27648
    v_accvgpr_read_b32 v58, a46
    ds_write2st64_b64 v101, v[144:145], v[192:193] offset0:8 offset1:20
    buffer_store_dwordx4 v[64:67], v7, s[16:19], s87 offen offset:128 nt
    v_accvgpr_read_b32 v53, a41
    v_pk_mul_f32 v[108:109], v[108:109], v[8:9] op_sel_hi:[1,0]
    v_pk_mul_f32 v[106:107], v[106:107], v[8:9] op_sel_hi:[1,0]
    v_cvt_pk_bf16_f32 v201, v202, v203
    ds_write2st64_b64 v92, v[148:149], v[196:197] offset0:8 offset1:20
    v_cvt_pk_bf16_f32 v108, v108, v109
    v_accvgpr_read_b32 v56, a44
    v_cvt_pk_bf16_f32 v245, v246, v247
    v_pk_mul_f32 v[104:105], v[104:105], v[8:9] op_sel_hi:[1,0]
    ds_write2st64_b64 v93, v[152:153], v[200:201] offset0:8 offset1:20
    ds_write2st64_b64 v94, v[156:157], v[204:205] offset0:8 offset1:20
    ds_read_b128 v[76:79], v103 offset:4096
    v_pk_mul_f32 v[56:57], v[56:57], v[8:9] op_sel_hi:[1,0]
    s_waitcnt lgkmcnt(4)
    buffer_store_dwordx4 v[68:71], v6, s[16:19], s88 offen offset:128 nt
    v_pk_mul_f32 v[52:53], v[52:53], v[8:9] op_sel_hi:[1,0]
    s_nop 0
    v_cvt_pk_bf16_f32 v52, v52, v53
    v_cvt_pk_bf16_f32 v104, v104, v105
    v_pk_mul_f32 v[54:55], v[54:55], v[8:9] op_sel_hi:[1,0]
    v_cvt_pk_bf16_f32 v56, v56, v57
    ds_read_b128 v[80:83], v103 offset:5120
    v_cvt_pk_bf16_f32 v105, v106, v107
    ds_read_b128 v[84:87], v103 offset:10240
    buffer_store_dwordx4 v[72:75], v7, s[16:19], s88 offen offset:128 nt
    v_cvt_pk_bf16_f32 v109, v110, v111
    ds_read_b128 v[88:91], v103 offset:11264
    ds_write2st64_b64 v101, v[240:241], v[104:105] offset0:32 offset1:44
    v_cvt_pk_bf16_f32 v53, v54, v55
    v_accvgpr_read_b32 v54, a90
    ds_write2st64_b64 v92, v[244:245], v[108:109] offset0:32 offset1:44
    v_pk_mul_f32 v[58:59], v[58:59], v[8:9] op_sel_hi:[1,0]
    v_accvgpr_read_b32 v111, a87
    ds_write2st64_b64 v93, v[248:249], v[52:53] offset0:32 offset1:44
    v_accvgpr_read_b32 v105, a81
    v_cvt_pk_bf16_f32 v57, v58, v59
    s_waitcnt lgkmcnt(4)
    buffer_store_dwordx4 v[76:79], v6, s[16:19], s84 offen offset:256 nt
    ds_write2st64_b64 v94, v[252:253], v[56:57] offset0:32 offset1:44
    buffer_store_dwordx4 v[80:83], v7, s[16:19], s84 offen offset:256 nt
    v_accvgpr_read_b32 v52, a88
    v_accvgpr_read_b32 v53, a89
    v_accvgpr_read_b32 v104, a80
    v_accvgpr_read_b32 v55, a91
    v_accvgpr_read_b32 v107, a83
    v_accvgpr_read_b32 v106, a82
    v_pk_mul_f32 v[52:53], v[52:53], v[100:101] op_sel_hi:[1,0]
    ds_read_b128 v[60:63], v103 offset:16384
    v_accvgpr_read_b32 v56, a92
    v_accvgpr_read_b32 v57, a93
    ds_read_b128 v[64:67], v103 offset:17408
    buffer_store_dwordx4 v[84:87], v6, s[16:19], s85 offen offset:256 nt
    ds_read_b128 v[68:71], v103 offset:22528
    v_pk_mul_f32 v[104:105], v[104:105], v[100:101] op_sel_hi:[1,0]
    v_accvgpr_read_b32 v109, a85
    v_pk_mul_f32 v[106:107], v[106:107], v[100:101] op_sel_hi:[1,0]
    v_accvgpr_read_b32 v108, a84
    s_waitcnt lgkmcnt(3)
    buffer_store_dwordx4 v[88:91], v7, s[16:19], s85 offen offset:256 nt
    v_pk_mul_f32 v[56:57], v[56:57], v[100:101] op_sel_hi:[1,0]
    v_accvgpr_read_b32 v110, a86
    v_cvt_pk_bf16_f32 v52, v52, v53
    v_cvt_pk_bf16_f32 v56, v56, v57
    v_pk_mul_f32 v[110:111], v[110:111], v[100:101] op_sel_hi:[1,0]
    s_waitcnt lgkmcnt(0)
    buffer_store_dwordx4 v[60:63], v6, s[16:19], s86 offen offset:256 nt
    v_cvt_pk_bf16_f32 v104, v104, v105
    v_pk_mul_f32 v[108:109], v[108:109], v[100:101] op_sel_hi:[1,0]
    v_accvgpr_read_b32 v59, a95
    v_accvgpr_read_b32 v58, a94
    v_cvt_pk_bf16_f32 v108, v108, v109
    v_pk_mul_f32 v[58:59], v[58:59], v[100:101] op_sel_hi:[1,0]
    v_cvt_pk_bf16_f32 v105, v106, v107
    ds_read_b128 v[72:75], v103 offset:23552
    ds_write_b64 v101, v[104:105] offset:0
    buffer_store_dwordx4 v[64:67], v7, s[16:19], s86 offen offset:256 nt
    v_cvt_pk_bf16_f32 v109, v110, v111
    v_pk_mul_f32 v[54:55], v[54:55], v[100:101] op_sel_hi:[1,0]
    buffer_store_dwordx4 v[68:71], v6, s[16:19], s87 offen offset:256 nt
    v_cvt_pk_bf16_f32 v53, v54, v55
    ds_write_b64 v92, v[108:109] offset:0
    ds_write_b64 v93, v[52:53] offset:0
    v_cvt_pk_bf16_f32 v57, v58, v59
    ds_write_b64 v94, v[56:57] offset:0
    ds_read_b128 v[76:79], v103 offset:0
    ds_read_b128 v[80:83], v103 offset:1024
    s_waitcnt lgkmcnt(5)
    buffer_store_dwordx4 v[72:75], v7, s[16:19], s87 offen offset:256 nt
    s_waitcnt lgkmcnt(1)
    buffer_store_dwordx4 v[76:79], v6, s[16:19], s88 offen offset:256 nt
    s_waitcnt lgkmcnt(0)
    buffer_store_dwordx4 v[80:83], v7, s[16:19], s88 offen offset:256 nt
    s_branch L_fin
L_end4:
    v_mfma_f32_16x16x32_bf16 v[112:115], a[212:215], v[16:19], v[112:115]
    v_fma_f32 v79, v79, s28, v12
    v_fma_f32 v71, v71, s28, v11
    v_fma_f32 v74, v74, s28, v11
    v_mfma_f32_16x16x32_bf16 v[160:163], a[212:215], v[22:25], v[160:163]
    v_exp_f32 v71, v71
    v_mfma_f32_16x16x32_bf16 v[208:211], a[212:215], v[28:31], v[208:211]
    ds_read_b64_tr_b16 a[228:229], v2 offset:19456
    v_fma_f32 v65, v65, s28, v10
    v_mfma_f32_16x16x32_bf16 a[0:3], a[212:215], v[34:37], a[0:3]
    ds_read_b64_tr_b16 a[230:231], v2 offset:13312
    s_waitcnt lgkmcnt(6)
    v_mfma_f32_16x16x32_bf16 a[4:7], a[216:219], v[34:37], a[4:7]
    ds_read_b64_tr_b16 a[234:235], v3 offset:13312
    v_mfma_f32_16x16x32_bf16 v[212:215], a[216:219], v[28:31], v[212:215]
    ds_read_b64_tr_b16 a[232:233], v3 offset:19456
    v_mfma_f32_16x16x32_bf16 v[164:167], a[216:219], v[22:25], v[164:167]
    ds_read_b128 v[88:91], v103 offset:0
    v_mfma_f32_16x16x32_bf16 v[116:119], a[216:219], v[16:19], v[116:119]
    v_fma_f32 v66, v66, s28, v10
    s_waitcnt lgkmcnt(7)
    v_mfma_f32_16x16x32_bf16 v[120:123], a[220:223], v[16:19], v[120:123]
    v_exp_f32 v79, v79
    v_mfma_f32_16x16x32_bf16 v[168:171], a[220:223], v[22:25], v[168:171]
    ds_read_b64_tr_b16 a[218:219], v5 offset:13312
    v_fma_f32 v57, v57, s28, v9
    v_mfma_f32_16x16x32_bf16 v[216:219], a[220:223], v[28:31], v[216:219]
    ds_read_b64_tr_b16 a[214:215], v4 offset:13312
    v_fma_f32 v69, v69, s28, v11
    v_mfma_f32_16x16x32_bf16 a[8:11], a[220:223], v[34:37], a[8:11]
    s_waitcnt lgkmcnt(7)
    ds_read_b64_tr_b16 a[212:213], v4 offset:19456
    v_fma_f32 v82, v82, s28, v12
    v_mfma_f32_16x16x32_bf16 a[12:15], a[224:227], v[34:37], a[12:15]
    ds_read_b64_tr_b16 a[222:223], v2 offset:14336
    v_fma_f32 v73, v73, s28, v11
    v_mfma_f32_16x16x32_bf16 v[220:223], a[224:227], v[28:31], v[220:223]
    v_fma_f32 v62, v62, s28, v10
    v_fma_f32 v77, v77, s28, v12
    v_mfma_f32_16x16x32_bf16 v[172:175], a[224:227], v[22:25], v[172:175]
    s_add_u32 s39, s39, 12288
    ds_read_b64_tr_b16 a[216:217], v5 offset:19456
    v_fma_f32 v75, v75, s28, v11
    v_mfma_f32_16x16x32_bf16 v[124:127], a[224:227], v[16:19], v[124:127]
    s_waitcnt lgkmcnt(6)
    ds_read_b64_tr_b16 a[224:225], v3 offset:20480
    v_fma_f32 v56, v56, s28, v9
    v_mfma_f32_16x16x32_bf16 v[128:131], a[228:231], v[16:19], v[128:131]
    ds_read_b64_tr_b16 a[220:221], v2 offset:20480
    v_fma_f32 v81, v81, s28, v12
    v_mfma_f32_16x16x32_bf16 v[176:179], a[228:231], v[22:25], v[176:179]
    v_fma_f32 v67, v67, s28, v10
    v_fma_f32 v76, v76, s28, v12
    v_mfma_f32_16x16x32_bf16 v[224:227], a[228:231], v[28:31], v[224:227]
    ds_read_b64_tr_b16 a[226:227], v3 offset:14336
    v_fma_f32 v63, v63, s28, v10
    v_mfma_f32_16x16x32_bf16 a[16:19], a[228:231], v[34:37], a[16:19]
    v_exp_f32 v77, v77
    v_mfma_f32_16x16x32_bf16 a[20:23], a[232:235], v[34:37], a[20:23]
    ds_read_b64_tr_b16 a[228:229], v4 offset:20480
    v_fma_f32 v70, v70, s28, v11
    v_mfma_f32_16x16x32_bf16 v[228:231], a[232:235], v[28:31], v[228:231]
    ds_read_b64_tr_b16 a[230:231], v4 offset:14336
    v_fma_f32 v83, v83, s28, v12
    v_mfma_f32_16x16x32_bf16 v[180:183], a[232:235], v[22:25], v[180:183]
    v_fma_f32 v80, v80, s28, v12
    v_fma_f32 v59, v59, s28, v9
    v_mfma_f32_16x16x32_bf16 v[132:135], a[232:235], v[16:19], v[132:135]
    s_waitcnt lgkmcnt(6)
    ds_read_b64_tr_b16 a[234:235], v5 offset:14336
    v_fma_f32 v58, v58, s28, v9
    v_mfma_f32_16x16x32_bf16 v[136:139], a[212:215], v[16:19], v[136:139]
    ds_read_b64_tr_b16 a[232:233], v5 offset:20480
    v_fma_f32 v68, v68, s28, v11
    v_mfma_f32_16x16x32_bf16 v[184:187], a[212:215], v[22:25], v[184:187]
    v_exp_f32 v69, v69
    v_mfma_f32_16x16x32_bf16 v[232:235], a[212:215], v[28:31], v[232:235]
    v_exp_f32 v65, v65
    v_mfma_f32_16x16x32_bf16 a[24:27], a[212:215], v[34:37], a[24:27]
    s_waitcnt lgkmcnt(5)
    v_exp_f32 v70, v70
    v_mfma_f32_16x16x32_bf16 a[28:31], a[216:219], v[34:37], a[28:31]
    v_exp_f32 v81, v81
    v_mfma_f32_16x16x32_bf16 v[236:239], a[216:219], v[28:31], v[236:239]
    v_exp_f32 v63, v63
    v_mfma_f32_16x16x32_bf16 v[188:191], a[216:219], v[22:25], v[188:191]
    v_fma_f32 v78, v78, s28, v12
    v_cvt_pk_bf16_f32 v27, v70, v71
    v_mfma_f32_16x16x32_bf16 v[140:143], a[216:219], v[16:19], v[140:143]
    v_exp_f32 v78, v78
    v_mfma_f32_16x16x32_bf16 v[144:147], a[220:223], v[16:19], v[144:147]
    v_exp_f32 v68, v68
    v_mfma_f32_16x16x32_bf16 v[192:195], a[220:223], v[22:25], v[192:195]
    v_exp_f32 v66, v66
    v_mfma_f32_16x16x32_bf16 v[240:243], a[220:223], v[28:31], v[240:243]
    s_waitcnt vmcnt(10) lgkmcnt(0)
    v_fma_f32 v64, v64, s28, v10
    s_add_u32 m0, s22, 36864
    v_mfma_f32_16x16x32_bf16 a[32:35], a[220:223], v[34:37], a[32:35]
    s_barrier
    v_mfma_f32_16x16x32_bf16 a[36:39], a[224:227], v[34:37], a[36:39]
    ds_read_b128 a[216:219], v1 offset:12288
    v_mfma_f32_16x16x32_bf16 v[244:247], a[224:227], v[28:31], v[244:247]
    buffer_load_dwordx4 v6, s[8:11], s21 offen lds
    v_mfma_f32_16x16x32_bf16 v[196:199], a[224:227], v[22:25], v[196:199]
    s_add_u32 s21, s21, 128
    ds_read_b128 a[220:223], v0 offset:13312
    v_mfma_f32_16x16x32_bf16 v[148:151], a[224:227], v[16:19], v[148:151]
    ds_read_b128 a[212:215], v0 offset:12288
    v_mfma_f32_16x16x32_bf16 v[152:155], a[228:231], v[16:19], v[152:155]
    s_add_u32 m0, s22, 37888
    v_exp_f32 v80, v80
    v_mfma_f32_16x16x32_bf16 v[200:203], a[228:231], v[22:25], v[200:203]
    ds_read_b128 v[96:99], v103 offset:1024
    v_fma_f32 v72, v72, s28, v11
    v_mfma_f32_16x16x32_bf16 v[248:251], a[228:231], v[28:31], v[248:251]
    v_exp_f32 v74, v74
    v_mfma_f32_16x16x32_bf16 a[40:43], a[228:231], v[34:37], a[40:43]
    buffer_load_dwordx4 v6, s[8:11], s21 offen lds
    v_mfma_f32_16x16x32_bf16 a[44:47], a[232:235], v[34:37], a[44:47]
    s_add_u32 s21, s21, 128
    s_add_u32 m0, s22, 38912
    ds_read_b128 a[224:227], v1 offset:13312
    v_mfma_f32_16x16x32_bf16 v[252:255], a[232:235], v[28:31], v[252:255]
    buffer_load_dwordx4 v6, s[8:11], s21 offen lds
    v_mfma_f32_16x16x32_bf16 v[204:207], a[232:235], v[22:25], v[204:207]
    v_exp_f32 v62, v62
    v_mfma_f32_16x16x32_bf16 v[156:159], a[232:235], v[16:19], v[156:159]
    buffer_store_dwordx4 v[88:91], v6, s[16:19], s24 offen offset:0 nt
    s_nop 0
    ds_read_b128 v[88:91], v103 offset:3072
    s_waitcnt lgkmcnt(3)
    v_mfma_f32_16x16x32_bf16 v[52:55], a[212:215], a[96:99], 0
    ds_read_b128 a[228:231], v0 offset:14336
    v_cvt_pk_bf16_f32 v21, v62, v63
    v_mfma_f32_16x16x32_bf16 v[52:55], a[216:219], a[100:103], v[52:55]
    ds_read_b128 a[232:235], v1 offset:14336
    v_cvt_pk_bf16_f32 v33, v78, v79
    v_mfma_f32_16x16x32_bf16 v[52:55], a[220:223], a[104:107], v[52:55]
    v_exp_f32 v76, v76
    v_mfma_f32_16x16x32_bf16 v[60:63], a[220:223], a[128:131], 0
    v_cvt_pk_bf16_f32 v26, v68, v69
    v_cvt_pk_bf16_f32 v32, v76, v77
    v_mfma_f32_16x16x32_bf16 v[60:63], a[216:219], a[124:127], v[60:63]
    v_exp_f32 v57, v57
    v_mfma_f32_16x16x32_bf16 v[60:63], a[212:215], a[120:123], v[60:63]
    v_exp_f32 v82, v82
    v_mfma_f32_16x16x32_bf16 v[68:71], a[212:215], a[144:147], 0
    v_exp_f32 v75, v75
    v_mfma_f32_16x16x32_bf16 v[68:71], a[216:219], a[148:151], v[68:71]
    v_exp_f32 v58, v58
    v_mfma_f32_16x16x32_bf16 v[68:71], a[220:223], a[152:155], v[68:71]
    v_cvt_pk_bf16_f32 v34, v80, v81
    v_cvt_pk_bf16_f32 v29, v74, v75
    v_mfma_f32_16x16x32_bf16 v[76:79], a[220:223], a[176:179], 0
    s_add_u32 s21, s21, 12032
    v_exp_f32 v64, v64
    v_mfma_f32_16x16x32_bf16 v[76:79], a[216:219], a[172:175], v[76:79]
    v_exp_f32 v56, v56
    v_mfma_f32_16x16x32_bf16 v[76:79], a[212:215], a[168:171], v[76:79]
    s_waitcnt lgkmcnt(0)
    v_exp_f32 v72, v72
    v_mfma_f32_16x16x32_bf16 v[76:79], a[224:227], a[180:183], v[76:79]
    v_exp_f32 v67, v67
    v_mfma_f32_16x16x32_bf16 v[76:79], a[228:231], a[184:187], v[76:79]
    v_cvt_pk_bf16_f32 v22, v64, v65
    v_mfma_f32_16x16x32_bf16 v[76:79], a[232:235], a[188:191], v[76:79]
    v_exp_f32 v59, v59
    v_mfma_f32_16x16x32_bf16 v[68:71], a[232:235], a[164:167], v[68:71]
    v_cvt_pk_bf16_f32 v23, v66, v67
    v_cvt_pk_bf16_f32 v17, v58, v59
    v_mfma_f32_16x16x32_bf16 v[68:71], a[228:231], a[160:163], v[68:71]
    ds_read_b128 a[212:215], v0 offset:18432
    v_cvt_pk_bf16_f32 v16, v56, v57
    v_mfma_f32_16x16x32_bf16 v[68:71], a[224:227], a[156:159], v[68:71]
    ds_read_b128 a[216:219], v1 offset:18432
    v_mfma_f32_16x16x32_bf16 v[60:63], a[224:227], a[132:135], v[60:63]
    ds_read_b128 a[220:223], v0 offset:19456
    v_mfma_f32_16x16x32_bf16 v[60:63], a[228:231], a[136:139], v[60:63]
    ds_read_b128 v[84:87], v103 offset:2048
    v_mfma_f32_16x16x32_bf16 v[44:47], a[236:239], v[14:17], v[48:51]
    s_add_u32 s57, s24, 128
    v_exp_f32 v73, v73
    v_mfma_f32_16x16x32_bf16 v[60:63], a[232:235], a[140:143], v[60:63]
    v_exp_f32 v83, v83
    v_mfma_f32_16x16x32_bf16 v[52:55], a[232:235], a[116:119], v[52:55]
    v_mfma_f32_16x16x32_bf16 v[44:47], a[240:243], v[20:23], v[44:47]
    v_mfma_f32_16x16x32_bf16 v[52:55], a[228:231], a[112:115], v[52:55]
    v_cvt_pk_bf16_f32 v28, v72, v73
    v_cvt_pk_bf16_f32 v35, v82, v83
    v_mfma_f32_16x16x32_bf16 v[52:55], a[224:227], a[108:111], v[52:55]
    ds_read_b128 a[224:227], v1 offset:19456
    v_mfma_f32_16x16x32_bf16 v[44:47], a[244:247], v[26:29], v[44:47]
    ds_read_b128 a[232:235], v1 offset:20480
    v_mfma_f32_16x16x32_bf16 v[44:47], a[248:251], v[32:35], v[44:47]
    s_waitcnt lgkmcnt(4)
    ds_read_b128 a[228:231], v0 offset:20480
    v_mfma_f32_16x16x32_bf16 v[56:59], a[212:215], a[96:99], 0
    buffer_store_dwordx4 v[96:99], v7, s[16:19], s24 offen offset:0 nt
    s_nop 3
    v_cmp_lt_f32 vcc, s29, v44
    v_mfma_f32_16x16x32_bf16 v[56:59], a[216:219], a[100:103], v[56:59]
    s_waitcnt lgkmcnt(3)
    v_mfma_f32_16x16x32_bf16 v[56:59], a[220:223], a[104:107], v[56:59]
    buffer_store_dwordx4 v[84:87], v6, s[16:19], s57 offen offset:0 nt
    s_nop 0
    s_cbranch_vccnz L_rs_end4a
L_ret_end4a:
    v_mfma_f32_16x16x32_bf16 v[64:67], a[220:223], a[128:131], 0
    v_fma_f32 v55, v55, s28, v9
    v_fma_f32 v60, v60, s28, v10
    v_mfma_f32_16x16x32_bf16 v[64:67], a[216:219], a[124:127], v[64:67]
    v_fma_f32 v52, v52, s28, v9
    v_mfma_f32_16x16x32_bf16 v[64:67], a[212:215], a[120:123], v[64:67]
    buffer_store_dwordx4 v[88:91], v7, s[16:19], s57 offen offset:0 nt
    s_waitcnt vmcnt(10) lgkmcnt(0)
    v_mfma_f32_16x16x32_bf16 v[72:75], a[212:215], a[144:147], 0
    s_barrier
    v_mfma_f32_16x16x32_bf16 v[72:75], a[216:219], a[148:151], v[72:75]
    v_fma_f32 v61, v61, s28, v10
    v_fma_f32 v54, v54, s28, v9
    v_mfma_f32_16x16x32_bf16 v[72:75], a[220:223], a[152:155], v[72:75]
    v_exp_f32 v61, v61
    v_mfma_f32_16x16x32_bf16 v[80:83], a[220:223], a[176:179], 0
    v_mfma_f32_16x16x32_bf16 v[80:83], a[216:219], a[172:175], v[80:83]
    v_exp_f32 v54, v54
    v_mfma_f32_16x16x32_bf16 v[80:83], a[212:215], a[168:171], v[80:83]
    ds_read_b64_tr_b16 a[212:213], v2 offset:0
    v_fma_f32 v53, v53, s28, v9
    v_mfma_f32_16x16x32_bf16 v[80:83], a[224:227], a[180:183], v[80:83]
    v_exp_f32 v53, v53
    v_mfma_f32_16x16x32_bf16 v[80:83], a[228:231], a[184:187], v[80:83]
    ds_read_b64_tr_b16 a[214:215], v2 offset:6144
    v_mfma_f32_16x16x32_bf16 v[80:83], a[232:235], a[188:191], v[80:83]
    ds_read_b64_tr_b16 a[216:217], v3 offset:0
    v_mfma_f32_16x16x32_bf16 v[72:75], a[232:235], a[164:167], v[72:75]
    v_exp_f32 v55, v55
    v_mfma_f32_16x16x32_bf16 v[72:75], a[228:231], a[160:163], v[72:75]
    ds_read_b64_tr_b16 a[218:219], v3 offset:6144
    v_mfma_f32_16x16x32_bf16 v[72:75], a[224:227], a[156:159], v[72:75]
    v_exp_f32 v60, v60
    v_mfma_f32_16x16x32_bf16 v[64:67], a[224:227], a[132:135], v[64:67]
    v_exp_f32 v52, v52
    v_mfma_f32_16x16x32_bf16 v[64:67], a[228:231], a[136:139], v[64:67]
    v_mfma_f32_16x16x32_bf16 v[64:67], a[232:235], a[140:143], v[64:67]
    v_cvt_pk_bf16_f32 v19, v54, v55
    v_cvt_pk_bf16_f32 v18, v52, v53
    v_mfma_f32_16x16x32_bf16 v[56:59], a[232:235], a[116:119], v[56:59]
    ds_read_b64_tr_b16 a[220:221], v4 offset:0
    v_cvt_pk_bf16_f32 v24, v60, v61
    v_mfma_f32_16x16x32_bf16 v[56:59], a[228:231], a[112:115], v[56:59]
    ds_read_b64_tr_b16 a[222:223], v4 offset:6144
    v_mfma_f32_16x16x32_bf16 v[56:59], a[224:227], a[108:111], v[56:59]
    s_waitcnt lgkmcnt(4)
    ds_read_b64_tr_b16 a[224:225], v5 offset:0
    ds_read_b64_tr_b16 a[226:227], v5 offset:6144
    v_mfma_f32_16x16x32_bf16 v[112:115], a[212:215], v[14:17], v[112:115]
    ds_read_b64_tr_b16 a[232:233], v3 offset:1024
    v_fma_f32 v66, v66, s28, v10
    v_mfma_f32_16x16x32_bf16 v[160:163], a[212:215], v[20:23], v[160:163]
    s_add_u32 s39, s39, 12288
    ds_read_b64_tr_b16 a[230:231], v2 offset:7168
    v_fma_f32 v57, v57, s28, v9
    v_fma_f32 v63, v63, s28, v10
    v_mfma_f32_16x16x32_bf16 v[208:211], a[212:215], v[26:29], v[208:211]
    v_fma_f32 v78, v78, s28, v12
    v_fma_f32 v69, v69, s28, v11
    v_exp_f32 v69, v69
    v_mfma_f32_16x16x32_bf16 a[0:3], a[212:215], v[32:35], a[0:3]
    s_waitcnt lgkmcnt(6)
    ds_read_b64_tr_b16 a[228:229], v2 offset:1024
    v_fma_f32 v67, v67, s28, v10
    v_mfma_f32_16x16x32_bf16 a[4:7], a[216:219], v[32:35], a[4:7]
    ds_read_b64_tr_b16 a[234:235], v3 offset:7168
    v_fma_f32 v83, v83, s28, v12
    v_mfma_f32_16x16x32_bf16 v[212:215], a[216:219], v[26:29], v[212:215]
    v_exp_f32 v78, v78
    v_mfma_f32_16x16x32_bf16 v[164:167], a[216:219], v[20:23], v[164:167]
    s_waitcnt vmcnt(4)
    ds_read_b64_tr_b16 a[212:213], v4 offset:1024
    v_fma_f32 v73, v73, s28, v11
    v_mfma_f32_16x16x32_bf16 v[116:119], a[216:219], v[14:17], v[116:119]
    s_waitcnt lgkmcnt(7)
    v_exp_f32 v73, v73
    v_mfma_f32_16x16x32_bf16 v[120:123], a[220:223], v[14:17], v[120:123]
    s_barrier
    v_fma_f32 v81, v81, s28, v12
    v_mfma_f32_16x16x32_bf16 v[168:171], a[220:223], v[20:23], v[168:171]
    ds_read_b64_tr_b16 a[214:215], v4 offset:7168
    v_fma_f32 v75, v75, s28, v11
    v_mfma_f32_16x16x32_bf16 v[216:219], a[220:223], v[26:29], v[216:219]
    ds_read_b64_tr_b16 a[216:217], v5 offset:1024
    v_fma_f32 v77, v77, s28, v12
    v_mfma_f32_16x16x32_bf16 a[8:11], a[220:223], v[32:35], a[8:11]
    s_waitcnt lgkmcnt(5)
    v_exp_f32 v57, v57
    v_mfma_f32_16x16x32_bf16 a[12:15], a[224:227], v[32:35], a[12:15]
    ds_read_b64_tr_b16 a[222:223], v2 offset:8192
    v_fma_f32 v64, v64, s28, v10
    v_fma_f32 v62, v62, s28, v10
    v_mfma_f32_16x16x32_bf16 v[220:223], a[224:227], v[26:29], v[220:223]
    v_exp_f32 v67, v67
    v_mfma_f32_16x16x32_bf16 v[172:175], a[224:227], v[20:23], v[172:175]
    ds_read_b64_tr_b16 a[220:221], v2 offset:2048
    v_fma_f32 v70, v70, s28, v11
    v_mfma_f32_16x16x32_bf16 v[124:127], a[224:227], v[14:17], v[124:127]
    s_waitcnt lgkmcnt(5)
    ds_read_b64_tr_b16 a[218:219], v5 offset:7168
    v_fma_f32 v68, v68, s28, v11
    v_mfma_f32_16x16x32_bf16 v[128:131], a[228:231], v[14:17], v[128:131]
    v_exp_f32 v81, v81
    v_mfma_f32_16x16x32_bf16 v[176:179], a[228:231], v[20:23], v[176:179]
    v_fma_f32 v59, v59, s28, v9
    v_fma_f32 v80, v80, s28, v12
    v_mfma_f32_16x16x32_bf16 v[224:227], a[228:231], v[26:29], v[224:227]
    v_fma_f32 v72, v72, s28, v11
    v_exp_f32 v63, v63
    v_mfma_f32_16x16x32_bf16 a[16:19], a[228:231], v[32:35], a[16:19]
    v_fma_f32 v71, v71, s28, v11
    v_fma_f32 v79, v79, s28, v12
    v_mfma_f32_16x16x32_bf16 a[20:23], a[232:235], v[32:35], a[20:23]
    v_exp_f32 v77, v77
    v_fma_f32 v76, v76, s28, v12
    v_mfma_f32_16x16x32_bf16 v[228:231], a[232:235], v[26:29], v[228:231]
    v_exp_f32 v71, v71
    v_mfma_f32_16x16x32_bf16 v[180:183], a[232:235], v[20:23], v[180:183]
    ds_read_b64_tr_b16 a[226:227], v3 offset:8192
    v_exp_f32 v68, v68
    v_mfma_f32_16x16x32_bf16 v[132:135], a[232:235], v[14:17], v[132:135]
    s_waitcnt lgkmcnt(2)
    v_exp_f32 v83, v83
    v_mfma_f32_16x16x32_bf16 v[136:139], a[212:215], v[14:17], v[136:139]
    ds_read_b64_tr_b16 a[228:229], v4 offset:2048
    v_fma_f32 v58, v58, s28, v9
    v_mfma_f32_16x16x32_bf16 v[184:187], a[212:215], v[20:23], v[184:187]
    ds_read_b64_tr_b16 a[224:225], v3 offset:2048
    v_exp_f32 v75, v75
    v_mfma_f32_16x16x32_bf16 v[232:235], a[212:215], v[26:29], v[232:235]
    v_exp_f32 v79, v79
    v_mfma_f32_16x16x32_bf16 a[24:27], a[212:215], v[32:35], a[24:27]
    s_waitcnt lgkmcnt(3)
    ds_read_b64_tr_b16 a[230:231], v4 offset:8192
    v_fma_f32 v56, v56, s28, v9
    v_mfma_f32_16x16x32_bf16 a[28:31], a[216:219], v[32:35], a[28:31]
    v_exp_f32 v58, v58
    v_mfma_f32_16x16x32_bf16 v[236:239], a[216:219], v[26:29], v[236:239]
    v_exp_f32 v64, v64
    v_mfma_f32_16x16x32_bf16 v[188:191], a[216:219], v[20:23], v[188:191]
    ds_read_b64_tr_b16 a[234:235], v5 offset:8192
    v_exp_f32 v56, v56
    v_mfma_f32_16x16x32_bf16 v[140:143], a[216:219], v[14:17], v[140:143]
    v_exp_f32 v66, v66
    v_mfma_f32_16x16x32_bf16 v[144:147], a[220:223], v[14:17], v[144:147]
    v_exp_f32 v76, v76
    v_mfma_f32_16x16x32_bf16 v[192:195], a[220:223], v[20:23], v[192:195]
    ds_read_b64_tr_b16 a[232:233], v5 offset:2048
    v_cvt_pk_bf16_f32 v30, v68, v69
    v_mfma_f32_16x16x32_bf16 v[240:243], a[220:223], v[26:29], v[240:243]
    ds_read_b64_tr_b16 a[212:213], v2 offset:18432
    v_fma_f32 v82, v82, s28, v12
    v_mfma_f32_16x16x32_bf16 a[32:35], a[220:223], v[32:35], a[32:35]
    s_waitcnt lgkmcnt(4)
    v_fma_f32 v74, v74, s28, v11
    v_exp_f32 v59, v59
    v_mfma_f32_16x16x32_bf16 a[36:39], a[224:227], v[32:35], a[36:39]
    v_exp_f32 v62, v62
    v_mfma_f32_16x16x32_bf16 v[244:247], a[224:227], v[26:29], v[244:247]
    ds_read_b64_tr_b16 a[214:215], v2 offset:12288
    v_fma_f32 v65, v65, s28, v10
    v_mfma_f32_16x16x32_bf16 v[196:199], a[224:227], v[20:23], v[196:199]
    v_exp_f32 v80, v80
    v_mfma_f32_16x16x32_bf16 v[148:151], a[224:227], v[14:17], v[148:151]
    s_waitcnt lgkmcnt(4)
    v_exp_f32 v72, v72
    v_mfma_f32_16x16x32_bf16 v[152:155], a[228:231], v[14:17], v[152:155]
    ds_read_b64_tr_b16 a[216:217], v3 offset:18432
    v_exp_f32 v74, v74
    v_mfma_f32_16x16x32_bf16 v[200:203], a[228:231], v[20:23], v[200:203]
    ds_read_b64_tr_b16 a[218:219], v3 offset:12288
    v_cvt_pk_bf16_f32 v25, v62, v63
    v_mfma_f32_16x16x32_bf16 v[248:251], a[228:231], v[26:29], v[248:251]
    v_exp_f32 v70, v70
    v_mfma_f32_16x16x32_bf16 a[40:43], a[228:231], v[32:35], a[40:43]
    s_waitcnt lgkmcnt(4)
    v_exp_f32 v65, v65
    v_mfma_f32_16x16x32_bf16 a[44:47], a[232:235], v[32:35], a[44:47]
    v_exp_f32 v82, v82
    v_mfma_f32_16x16x32_bf16 v[252:255], a[232:235], v[26:29], v[252:255]
    v_cvt_pk_bf16_f32 v31, v70, v71
    v_cvt_pk_bf16_f32 v28, v72, v73
    v_mfma_f32_16x16x32_bf16 v[204:207], a[232:235], v[20:23], v[204:207]
    v_cvt_pk_bf16_f32 v37, v78, v79
    v_cvt_pk_bf16_f32 v22, v64, v65
    v_mfma_f32_16x16x32_bf16 v[156:159], a[232:235], v[14:17], v[156:159]
    ds_read_b64_tr_b16 a[220:221], v4 offset:18432
    v_cvt_pk_bf16_f32 v16, v56, v57
    v_cvt_pk_bf16_f32 v17, v58, v59
    v_cvt_pk_bf16_f32 v23, v66, v67
    v_cvt_pk_bf16_f32 v34, v80, v81
    v_mfma_f32_16x16x32_bf16 v[48:51], a[236:239], v[16:19], v[44:47]
    v_cvt_pk_bf16_f32 v36, v76, v77
    v_cvt_pk_bf16_f32 v29, v74, v75
    v_mfma_f32_16x16x32_bf16 v[48:51], a[240:243], v[22:25], v[48:51]
    ds_read_b64_tr_b16 a[222:223], v4 offset:12288
    v_cvt_pk_bf16_f32 v35, v82, v83
    v_mfma_f32_16x16x32_bf16 v[48:51], a[244:247], v[28:31], v[48:51]
    ds_read_b64_tr_b16 a[224:225], v5 offset:18432
    v_mfma_f32_16x16x32_bf16 v[48:51], a[248:251], v[34:37], v[48:51]
    s_waitcnt lgkmcnt(3)
    ds_read_b64_tr_b16 a[226:227], v5 offset:12288
    s_nop 5
    v_cmp_lt_f32 vcc, s29, v48
    s_nop 4
    s_cbranch_vccnz L_rs_end4b
L_ret_end4b:
    v_lshrrev_b32 v108, 11, v0
    v_rcp_f32 v102, v49
    v_and_b32 v101, 0x3ff, v0
    v_xor_b32 v108, s65, v108
    v_lshl_add_u32 v101, v108, 10, v101
    v_mov_b32 v100, v48
    v_mbcnt_lo_u32_b32 v108, -1, 0
    v_rcp_f32 v50, v50
    v_permlane32_swap_b32 v48, v100
    v_add_u32 v101, s38, v101
    v_mbcnt_hi_u32_b32 v108, -1, v108
    v_lshrrev_b32 v108, 1, v108
    v_and_b32 v108, 24, v108
    v_rcp_f32 v48, v48
    v_rcp_f32 v8, v51
    v_bfe_u32 v108, s66, v108, 8
    v_xor_b32 v101, v101, v108
    v_mfma_f32_16x16x32_bf16 v[112:115], a[212:215], v[16:19], v[112:115]
    ds_read_b64_tr_b16 a[234:235], v3 offset:13312
    v_mfma_f32_16x16x32_bf16 v[160:163], a[212:215], v[22:25], v[160:163]
    v_mfma_f32_16x16x32_bf16 v[208:211], a[212:215], v[28:31], v[208:211]
    ds_read_b64_tr_b16 a[228:229], v2 offset:19456
    v_mfma_f32_16x16x32_bf16 a[0:3], a[212:215], v[34:37], a[0:3]
    s_waitcnt lgkmcnt(6)
    v_mfma_f32_16x16x32_bf16 a[4:7], a[216:219], v[34:37], a[4:7]
    ds_read_b64_tr_b16 a[230:231], v2 offset:13312
    v_xor_b32 v94, 96, v101
    v_mfma_f32_16x16x32_bf16 v[212:215], a[216:219], v[28:31], v[212:215]
    ds_read_b64_tr_b16 a[214:215], v4 offset:13312
    v_mfma_f32_16x16x32_bf16 v[164:167], a[216:219], v[22:25], v[164:167]
    v_mfma_f32_16x16x32_bf16 v[116:119], a[216:219], v[16:19], v[116:119]
    s_waitcnt lgkmcnt(6)
    v_mfma_f32_16x16x32_bf16 v[120:123], a[220:223], v[16:19], v[120:123]
    v_xor_b32 v93, 64, v101
    v_mfma_f32_16x16x32_bf16 v[168:171], a[220:223], v[22:25], v[168:171]
    ds_read_b64_tr_b16 a[232:233], v3 offset:19456
    v_accvgpr_read_b32 v107, a3
    v_mfma_f32_16x16x32_bf16 v[216:219], a[220:223], v[28:31], v[216:219]
    v_accvgpr_read_b32 v105, a1
    v_mfma_f32_16x16x32_bf16 a[8:11], a[220:223], v[34:37], a[8:11]
    s_waitcnt lgkmcnt(4)
    ds_read_b64_tr_b16 a[216:217], v5 offset:19456
    v_accvgpr_read_b32 v110, a6
    v_mfma_f32_16x16x32_bf16 a[12:15], a[224:227], v[34:37], a[12:15]
    s_add_u32 s84, s34, 0
    ds_read_b64_tr_b16 a[212:213], v4 offset:19456
    v_mfma_f32_16x16x32_bf16 v[220:223], a[224:227], v[28:31], v[220:223]
    ds_read_b64_tr_b16 a[222:223], v2 offset:14336
    s_add_u32 s85, s34, 6144
    v_mfma_f32_16x16x32_bf16 v[172:175], a[224:227], v[22:25], v[172:175]
    ds_read_b64_tr_b16 a[218:219], v5 offset:13312
    v_mfma_f32_16x16x32_bf16 v[124:127], a[224:227], v[16:19], v[124:127]
    s_waitcnt lgkmcnt(5)
    ds_read_b64_tr_b16 a[220:221], v2 offset:20480
    v_accvgpr_read_b32 v56, a12
    v_mfma_f32_16x16x32_bf16 v[128:131], a[228:231], v[16:19], v[128:131]
    v_accvgpr_read_b32 v109, a5
    v_mfma_f32_16x16x32_bf16 v[176:179], a[228:231], v[22:25], v[176:179]
    v_subrev_u32 v103, 24576, v103
    v_accvgpr_read_b32 v57, a13
    v_mfma_f32_16x16x32_bf16 v[224:227], a[228:231], v[28:31], v[224:227]
    v_mfma_f32_16x16x32_bf16 a[16:19], a[228:231], v[34:37], a[16:19]
    v_accvgpr_read_b32 v108, a4
    ds_read_b64_tr_b16 a[226:227], v3 offset:14336
    s_add_u32 s86, s34, 12288
    v_pk_mul_f32 v[160:161], v[160:161], v[102:103] op_sel_hi:[1,0]
    v_pk_mul_f32 v[220:221], v[220:221], v[50:51] op_sel_hi:[1,0]
    v_pk_mul_f32 v[120:121], v[120:121], v[48:49] op_sel_hi:[1,0]
    v_pk_mul_f32 v[116:117], v[116:117], v[48:49] op_sel_hi:[1,0]
    v_pk_mul_f32 v[164:165], v[164:165], v[102:103] op_sel_hi:[1,0]
    v_pk_mul_f32 v[168:169], v[168:169], v[102:103] op_sel_hi:[1,0]
    v_pk_mul_f32 v[172:173], v[172:173], v[102:103] op_sel_hi:[1,0]
    v_pk_mul_f32 v[114:115], v[114:115], v[48:49] op_sel_hi:[1,0]
    v_pk_mul_f32 v[130:131], v[130:131], v[48:49] op_sel_hi:[1,0]
    v_pk_mul_f32 v[112:113], v[112:113], v[48:49] op_sel_hi:[1,0]
    v_pk_mul_f32 v[170:171], v[170:171], v[102:103] op_sel_hi:[1,0]
    v_pk_mul_f32 v[162:163], v[162:163], v[102:103] op_sel_hi:[1,0]
    v_pk_mul_f32 v[174:175], v[174:175], v[102:103] op_sel_hi:[1,0]
    v_accvgpr_read_b32 v54, a10
    s_waitcnt lgkmcnt(2)
    v_mfma_f32_16x16x32_bf16 a[20:23], a[232:235], v[34:37], a[20:23]
    v_mfma_f32_16x16x32_bf16 v[228:231], a[232:235], v[28:31], v[228:231]
    ds_read_b64_tr_b16 a[224:225], v3 offset:20480
    v_mfma_f32_16x16x32_bf16 v[180:183], a[232:235], v[22:25], v[180:183]
    v_cvt_pk_bf16_f32 v120, v120, v121
    v_mfma_f32_16x16x32_bf16 v[132:135], a[232:235], v[16:19], v[132:135]
    v_xor_b32 v92, 32, v101
    v_accvgpr_read_b32 v104, a0
    v_mfma_f32_16x16x32_bf16 v[136:139], a[212:215], v[16:19], v[136:139]
    v_cvt_pk_bf16_f32 v112, v112, v113
    v_mfma_f32_16x16x32_bf16 v[184:187], a[212:215], v[22:25], v[184:187]
    v_cvt_pk_bf16_f32 v164, v164, v165
    v_mfma_f32_16x16x32_bf16 v[232:235], a[212:215], v[28:31], v[232:235]
    ds_read_b64_tr_b16 a[228:229], v4 offset:20480
    v_cvt_pk_bf16_f32 v220, v220, v221
    v_mfma_f32_16x16x32_bf16 a[24:27], a[212:215], v[34:37], a[24:27]
    ds_read_b64_tr_b16 a[234:235], v5 offset:14336
    v_cvt_pk_bf16_f32 v168, v168, v169
    v_mfma_f32_16x16x32_bf16 a[28:31], a[216:219], v[34:37], a[28:31]
    v_mfma_f32_16x16x32_bf16 v[236:239], a[216:219], v[28:31], v[236:239]
    ds_read_b64_tr_b16 a[230:231], v4 offset:14336
    v_mfma_f32_16x16x32_bf16 v[188:191], a[216:219], v[22:25], v[188:191]
    v_accvgpr_read_b32 v52, a8
    v_mfma_f32_16x16x32_bf16 v[140:143], a[216:219], v[16:19], v[140:143]
    s_waitcnt lgkmcnt(3)
    v_cvt_pk_bf16_f32 v116, v116, v117
    v_cvt_pk_bf16_f32 v113, v114, v115
    v_mfma_f32_16x16x32_bf16 v[144:147], a[220:223], v[16:19], v[144:147]
    v_cvt_pk_bf16_f32 v160, v160, v161
    v_mfma_f32_16x16x32_bf16 v[192:195], a[220:223], v[22:25], v[192:195]
    v_cvt_pk_bf16_f32 v161, v162, v163
    v_cvt_pk_bf16_f32 v172, v172, v173
    v_mfma_f32_16x16x32_bf16 v[240:243], a[220:223], v[28:31], v[240:243]
    s_add_u32 s87, s34, 18432
    v_cvt_pk_bf16_f32 v169, v170, v171
    v_mfma_f32_16x16x32_bf16 a[32:35], a[220:223], v[34:37], a[32:35]
    ds_write2st64_b64 v101, v[112:113], v[160:161] offset0:0 offset1:12
    v_pk_mul_f32 v[118:119], v[118:119], v[48:49] op_sel_hi:[1,0]
    v_pk_mul_f32 v[126:127], v[126:127], v[48:49] op_sel_hi:[1,0]
    v_pk_mul_f32 v[122:123], v[122:123], v[48:49] op_sel_hi:[1,0]
    v_pk_mul_f32 v[124:125], v[124:125], v[48:49] op_sel_hi:[1,0]
    v_pk_mul_f32 v[166:167], v[166:167], v[102:103] op_sel_hi:[1,0]
    v_cvt_pk_bf16_f32 v121, v122, v123
    v_cvt_pk_bf16_f32 v165, v166, v167
    v_mfma_f32_16x16x32_bf16 a[36:39], a[224:227], v[34:37], a[36:39]
    v_cvt_pk_bf16_f32 v117, v118, v119
    v_cvt_pk_bf16_f32 v124, v124, v125
    v_mfma_f32_16x16x32_bf16 v[244:247], a[224:227], v[28:31], v[244:247]
    v_accvgpr_read_b32 v53, a9
    v_cvt_pk_bf16_f32 v125, v126, v127
    v_mfma_f32_16x16x32_bf16 v[196:199], a[224:227], v[22:25], v[196:199]
    ds_read_b64_tr_b16 a[232:233], v5 offset:20480
    v_cvt_pk_bf16_f32 v173, v174, v175
    v_mfma_f32_16x16x32_bf16 v[148:151], a[224:227], v[16:19], v[148:151]
    s_waitcnt lgkmcnt(2)
    ds_write2st64_b64 v92, v[116:117], v[164:165] offset0:0 offset1:12
    v_mfma_f32_16x16x32_bf16 v[152:155], a[228:231], v[16:19], v[152:155]
    ds_write2st64_b64 v93, v[120:121], v[168:169] offset0:0 offset1:12
    v_mfma_f32_16x16x32_bf16 v[200:203], a[228:231], v[22:25], v[200:203]
    ds_write2st64_b64 v94, v[124:125], v[172:173] offset0:0 offset1:12
    v_mfma_f32_16x16x32_bf16 v[248:251], a[228:231], v[28:31], v[248:251]
    ds_read_b128 v[80:83], v103 offset:0
    v_pk_mul_f32 v[208:209], v[208:209], v[50:51] op_sel_hi:[1,0]
    v_pk_mul_f32 v[216:217], v[216:217], v[50:51] op_sel_hi:[1,0]
    v_accvgpr_read_b32 v59, a15
    v_cvt_pk_bf16_f32 v208, v208, v209
    v_accvgpr_read_b32 v111, a7
    v_pk_mul_f32 v[128:129], v[128:129], v[48:49] op_sel_hi:[1,0]
    s_add_u32 s18, s34, 24576
    v_pk_mul_f32 v[214:215], v[214:215], v[50:51] op_sel_hi:[1,0]
    v_pk_mul_f32 v[224:225], v[224:225], v[50:51] op_sel_hi:[1,0]
    v_accvgpr_read_b32 v55, a11
    v_accvgpr_read_b32 v106, a2
    v_pk_mul_f32 v[186:187], v[186:187], v[102:103] op_sel_hi:[1,0]
    v_pk_mul_f32 v[52:53], v[52:53], v[8:9] op_sel_hi:[1,0]
    v_pk_mul_f32 v[218:219], v[218:219], v[50:51] op_sel_hi:[1,0]
    v_pk_mul_f32 v[210:211], v[210:211], v[50:51] op_sel_hi:[1,0]
    s_nop 1
    v_mfma_f32_16x16x32_bf16 a[40:43], a[228:231], v[34:37], a[40:43]
    s_waitcnt lgkmcnt(3)
    ds_read_b128 v[84:87], v103 offset:1024
    v_mfma_f32_16x16x32_bf16 a[44:47], a[232:235], v[34:37], a[44:47]
    v_pk_mul_f32 v[228:229], v[228:229], v[50:51] op_sel_hi:[1,0]
    v_pk_mul_f32 v[212:213], v[212:213], v[50:51] op_sel_hi:[1,0]
    v_pk_mul_f32 v[230:231], v[230:231], v[50:51] op_sel_hi:[1,0]
    v_pk_mul_f32 v[136:137], v[136:137], v[48:49] op_sel_hi:[1,0]
    s_waitcnt lgkmcnt(1)
    buffer_store_dwordx4 v[80:83], v6, s[16:19], s84 offen offset:0 nt
    v_pk_mul_f32 v[106:107], v[106:107], v[8:9] op_sel_hi:[1,0]
    v_pk_mul_f32 v[132:133], v[132:133], v[48:49] op_sel_hi:[1,0]
    v_pk_mul_f32 v[56:57], v[56:57], v[8:9] op_sel_hi:[1,0]
    v_cvt_pk_bf16_f32 v52, v52, v53
    v_pk_mul_f32 v[196:197], v[196:197], v[102:103] op_sel_hi:[1,0]
    v_pk_mul_f32 v[110:111], v[110:111], v[8:9] op_sel_hi:[1,0]
    v_pk_mul_f32 v[104:105], v[104:105], v[8:9] op_sel_hi:[1,0]
    v_pk_mul_f32 v[140:141], v[140:141], v[48:49] op_sel_hi:[1,0]
    v_pk_mul_f32 v[192:193], v[192:193], v[102:103] op_sel_hi:[1,0]
    v_pk_mul_f32 v[178:179], v[178:179], v[102:103] op_sel_hi:[1,0]
    v_pk_mul_f32 v[108:109], v[108:109], v[8:9] op_sel_hi:[1,0]
    v_cvt_pk_bf16_f32 v56, v56, v57
    v_cvt_pk_bf16_f32 v212, v212, v213
    v_cvt_pk_bf16_f32 v216, v216, v217
    v_pk_mul_f32 v[54:55], v[54:55], v[8:9] op_sel_hi:[1,0]
    ds_read_b128 v[88:91], v103 offset:6144
    v_pk_mul_f32 v[234:235], v[234:235], v[50:51] op_sel_hi:[1,0]
    v_cvt_pk_bf16_f32 v108, v108, v109
    v_cvt_pk_bf16_f32 v53, v54, v55
    v_cvt_pk_bf16_f32 v104, v104, v105
    v_mfma_f32_16x16x32_bf16 v[252:255], a[232:235], v[28:31], v[252:255]
    v_cvt_pk_bf16_f32 v209, v210, v211
    ds_read_b128 v[60:63], v103 offset:7168
    v_mfma_f32_16x16x32_bf16 v[204:207], a[232:235], v[22:25], v[204:207]
    s_waitcnt lgkmcnt(2)
    buffer_store_dwordx4 v[84:87], v7, s[16:19], s84 offen offset:0 nt
    v_cvt_pk_bf16_f32 v109, v110, v111
    v_pk_mul_f32 v[248:249], v[248:249], v[50:51] op_sel_hi:[1,0]
    v_pk_mul_f32 v[200:201], v[200:201], v[102:103] op_sel_hi:[1,0]
    v_pk_mul_f32 v[222:223], v[222:223], v[50:51] op_sel_hi:[1,0]
    v_cvt_pk_bf16_f32 v128, v128, v129
    v_cvt_pk_bf16_f32 v228, v228, v229
    v_pk_mul_f32 v[144:145], v[144:145], v[48:49] op_sel_hi:[1,0]
    v_cvt_pk_bf16_f32 v213, v214, v215
    v_cvt_pk_bf16_f32 v229, v230, v231
    v_accvgpr_read_b32 v58, a14
    v_pk_mul_f32 v[190:191], v[190:191], v[102:103] op_sel_hi:[1,0]
    v_pk_mul_f32 v[58:59], v[58:59], v[8:9] op_sel_hi:[1,0]
    v_cvt_pk_bf16_f32 v105, v106, v107
    v_pk_mul_f32 v[188:189], v[188:189], v[102:103] op_sel_hi:[1,0]
    v_pk_mul_f32 v[138:139], v[138:139], v[48:49] op_sel_hi:[1,0]
    v_pk_mul_f32 v[252:253], v[252:253], v[50:51] op_sel_hi:[1,0]
    ds_write2st64_b64 v101, v[208:209], v[104:105] offset0:24 offset1:36
    s_nop 0
    v_mfma_f32_16x16x32_bf16 v[156:159], a[232:235], v[16:19], v[156:159]
    s_waitcnt lgkmcnt(2)
    v_cvt_pk_bf16_f32 v221, v222, v223
    v_cvt_pk_bf16_f32 v140, v140, v141
    v_cvt_pk_bf16_f32 v217, v218, v219
    buffer_store_dwordx4 v[88:91], v6, s[16:19], s85 offen offset:0 nt
    ds_write2st64_b64 v92, v[212:213], v[108:109] offset0:24 offset1:36
    v_pk_mul_f32 v[236:237], v[236:237], v[50:51] op_sel_hi:[1,0]
    v_pk_mul_f32 v[202:203], v[202:203], v[102:103] op_sel_hi:[1,0]
    v_pk_mul_f32 v[142:143], v[142:143], v[48:49] op_sel_hi:[1,0]
    v_pk_mul_f32 v[176:177], v[176:177], v[102:103] op_sel_hi:[1,0]
    v_accvgpr_read_b32 v109, a21
    v_cvt_pk_bf16_f32 v57, v58, v59
    v_pk_mul_f32 v[148:149], v[148:149], v[48:49] op_sel_hi:[1,0]
    v_accvgpr_read_b32 v111, a23
    ds_write2st64_b64 v93, v[216:217], v[52:53] offset0:24 offset1:36
    ds_write2st64_b64 v94, v[220:221], v[56:57] offset0:24 offset1:36
    ds_read_b128 v[64:67], v103 offset:12288
    v_cvt_pk_bf16_f32 v148, v148, v149
    s_waitcnt lgkmcnt(4)
    buffer_store_dwordx4 v[60:63], v7, s[16:19], s85 offen offset:0 nt
    v_pk_mul_f32 v[254:255], v[254:255], v[50:51] op_sel_hi:[1,0]
    v_cvt_pk_bf16_f32 v132, v132, v133
    ds_read_b128 v[68:71], v103 offset:13312
    v_accvgpr_read_b32 v110, a22
    v_cvt_pk_bf16_f32 v188, v188, v189
    v_pk_mul_f32 v[134:135], v[134:135], v[48:49] op_sel_hi:[1,0]
    v_accvgpr_read_b32 v104, a16
    v_accvgpr_read_b32 v59, a31
    v_accvgpr_read_b32 v105, a17
    v_cvt_pk_bf16_f32 v236, v236, v237
    v_accvgpr_read_b32 v108, a20
    v_pk_mul_f32 v[104:105], v[104:105], v[8:9] op_sel_hi:[1,0]
    v_accvgpr_read_b32 v56, a28
    v_cvt_pk_bf16_f32 v133, v134, v135
    v_pk_mul_f32 v[240:241], v[240:241], v[50:51] op_sel_hi:[1,0]
    v_pk_mul_f32 v[198:199], v[198:199], v[102:103] op_sel_hi:[1,0]
    v_pk_mul_f32 v[180:181], v[180:181], v[102:103] op_sel_hi:[1,0]
    v_cvt_pk_bf16_f32 v224, v224, v225
    v_cvt_pk_bf16_f32 v136, v136, v137
    v_cvt_pk_bf16_f32 v141, v142, v143
    v_cvt_pk_bf16_f32 v129, v130, v131
    s_waitcnt lgkmcnt(1)
    buffer_store_dwordx4 v[64:67], v6, s[16:19], s86 offen offset:0 nt
    v_cvt_pk_bf16_f32 v176, v176, v177
    v_pk_mul_f32 v[184:185], v[184:185], v[102:103] op_sel_hi:[1,0]
    v_cvt_pk_bf16_f32 v177, v178, v179
    v_accvgpr_read_b32 v55, a27
    v_pk_mul_f32 v[232:233], v[232:233], v[50:51] op_sel_hi:[1,0]
    v_pk_mul_f32 v[150:151], v[150:151], v[48:49] op_sel_hi:[1,0]
    v_pk_mul_f32 v[108:109], v[108:109], v[8:9] op_sel_hi:[1,0]
    v_cvt_pk_bf16_f32 v189, v190, v191
    v_pk_mul_f32 v[244:245], v[244:245], v[50:51] op_sel_hi:[1,0]
    ds_read_b128 v[72:75], v103 offset:18432
    v_cvt_pk_bf16_f32 v144, v144, v145
    v_cvt_pk_bf16_f32 v184, v184, v185
    v_accvgpr_read_b32 v54, a26
    v_accvgpr_read_b32 v107, a19
    v_cvt_pk_bf16_f32 v180, v180, v181
    v_cvt_pk_bf16_f32 v185, v186, v187
    v_pk_mul_f32 v[154:155], v[154:155], v[48:49] op_sel_hi:[1,0]
    v_accvgpr_read_b32 v53, a25
    v_cvt_pk_bf16_f32 v200, v200, v201
    v_accvgpr_read_b32 v57, a29
    v_pk_mul_f32 v[182:183], v[182:183], v[102:103] op_sel_hi:[1,0]
    v_pk_mul_f32 v[246:247], v[246:247], v[50:51] op_sel_hi:[1,0]
    v_pk_mul_f32 v[156:157], v[156:157], v[48:49] op_sel_hi:[1,0]
    v_cvt_pk_bf16_f32 v196, v196, v197
    v_cvt_pk_bf16_f32 v108, v108, v109
    v_pk_mul_f32 v[152:153], v[152:153], v[48:49] op_sel_hi:[1,0]
    s_waitcnt lgkmcnt(1)
    buffer_store_dwordx4 v[68:71], v7, s[16:19], s86 offen offset:0 nt
    ds_read_b128 v[76:79], v103 offset:19456
    v_pk_mul_f32 v[226:227], v[226:227], v[50:51] op_sel_hi:[1,0]
    v_cvt_pk_bf16_f32 v181, v182, v183
    v_cvt_pk_bf16_f32 v244, v244, v245
    v_pk_mul_f32 v[110:111], v[110:111], v[8:9] op_sel_hi:[1,0]
    v_pk_mul_f32 v[204:205], v[204:205], v[102:103] op_sel_hi:[1,0]
    v_cvt_pk_bf16_f32 v192, v192, v193
    v_cvt_pk_bf16_f32 v225, v226, v227
    v_cvt_pk_bf16_f32 v152, v152, v153
    v_cvt_pk_bf16_f32 v137, v138, v139
    ds_write2st64_b64 v101, v[128:129], v[176:177] offset0:4 offset1:16
    v_pk_mul_f32 v[158:159], v[158:159], v[48:49] op_sel_hi:[1,0]
    v_pk_mul_f32 v[238:239], v[238:239], v[50:51] op_sel_hi:[1,0]
    v_pk_mul_f32 v[250:251], v[250:251], v[50:51] op_sel_hi:[1,0]
    v_accvgpr_read_b32 v58, a30
    v_cvt_pk_bf16_f32 v204, v204, v205
    v_cvt_pk_bf16_f32 v109, v110, v111
    s_waitcnt lgkmcnt(2)
    buffer_store_dwordx4 v[72:75], v6, s[16:19], s87 offen offset:0 nt
    v_accvgpr_read_b32 v52, a24
    ds_write2st64_b64 v92, v[132:133], v[180:181] offset0:4 offset1:16
    ds_write2st64_b64 v93, v[136:137], v[184:185] offset0:4 offset1:16
    ds_write2st64_b64 v94, v[140:141], v[188:189] offset0:4 offset1:16
    v_pk_mul_f32 v[54:55], v[54:55], v[8:9] op_sel_hi:[1,0]
    ds_read_b128 v[80:83], v103 offset:2048
    v_pk_mul_f32 v[242:243], v[242:243], v[50:51] op_sel_hi:[1,0]
    ds_read_b128 v[84:87], v103 offset:3072
    v_pk_mul_f32 v[52:53], v[52:53], v[8:9] op_sel_hi:[1,0]
    v_pk_mul_f32 v[206:207], v[206:207], v[102:103] op_sel_hi:[1,0]
    s_waitcnt lgkmcnt(5)
    buffer_store_dwordx4 v[76:79], v7, s[16:19], s87 offen offset:0 nt
    v_cvt_pk_bf16_f32 v52, v52, v53
    v_accvgpr_read_b32 v110, a38
    v_pk_mul_f32 v[56:57], v[56:57], v[8:9] op_sel_hi:[1,0]
    v_cvt_pk_bf16_f32 v232, v232, v233
    v_cvt_pk_bf16_f32 v197, v198, v199
    v_cvt_pk_bf16_f32 v53, v54, v55
    v_accvgpr_read_b32 v106, a18
    ds_read_b128 v[88:91], v103 offset:8192
    v_cvt_pk_bf16_f32 v153, v154, v155
    v_cvt_pk_bf16_f32 v56, v56, v57
    v_pk_mul_f32 v[58:59], v[58:59], v[8:9] op_sel_hi:[1,0]
    v_cvt_pk_bf16_f32 v248, v248, v249
    s_waitcnt lgkmcnt(2)
    buffer_store_dwordx4 v[80:83], v6, s[16:19], s84 offen offset:128 nt
    v_pk_mul_f32 v[106:107], v[106:107], v[8:9] op_sel_hi:[1,0]
    ds_read_b128 v[60:63], v103 offset:9216
    v_cvt_pk_bf16_f32 v104, v104, v105
    v_cvt_pk_bf16_f32 v57, v58, v59
    v_cvt_pk_bf16_f32 v105, v106, v107
    v_cvt_pk_bf16_f32 v237, v238, v239
    ds_write2st64_b64 v101, v[224:225], v[104:105] offset0:28 offset1:40
    ds_write2st64_b64 v92, v[228:229], v[108:109] offset0:28 offset1:40
    v_cvt_pk_bf16_f32 v240, v240, v241
    s_waitcnt lgkmcnt(3)
    buffer_store_dwordx4 v[84:87], v7, s[16:19], s84 offen offset:128 nt
    v_cvt_pk_bf16_f32 v233, v234, v235
    ds_write2st64_b64 v93, v[232:233], v[52:53] offset0:28 offset1:40
    v_pk_mul_f32 v[194:195], v[194:195], v[102:103] op_sel_hi:[1,0]
    ds_write2st64_b64 v94, v[236:237], v[56:57] offset0:28 offset1:40
    v_pk_mul_f32 v[146:147], v[146:147], v[48:49] op_sel_hi:[1,0]
    ds_read_b128 v[64:67], v103 offset:14336
    v_accvgpr_read_b32 v107, a35
    v_accvgpr_read_b32 v52, a40
    buffer_store_dwordx4 v[88:91], v6, s[16:19], s85 offen offset:128 nt
    v_cvt_pk_bf16_f32 v193, v194, v195
    v_accvgpr_read_b32 v105, a33
    v_accvgpr_read_b32 v104, a32
    ds_read_b128 v[68:71], v103 offset:15360
    v_cvt_pk_bf16_f32 v145, v146, v147
    v_accvgpr_read_b32 v54, a42
    v_accvgpr_read_b32 v55, a43
    v_accvgpr_read_b32 v106, a34
    ds_read_b128 v[72:75], v103 offset:20480
    v_accvgpr_read_b32 v111, a39
    v_cvt_pk_bf16_f32 v149, v150, v151
    v_accvgpr_read_b32 v56, a44
    s_waitcnt lgkmcnt(3)
    buffer_store_dwordx4 v[60:63], v7, s[16:19], s85 offen offset:128 nt
    v_cvt_pk_bf16_f32 v249, v250, v251
    v_accvgpr_read_b32 v53, a41
    v_cvt_pk_bf16_f32 v201, v202, v203
    v_accvgpr_read_b32 v57, a45
    v_pk_mul_f32 v[104:105], v[104:105], v[8:9] op_sel_hi:[1,0]
    v_pk_mul_f32 v[110:111], v[110:111], v[8:9] op_sel_hi:[1,0]
    ds_read_b128 v[76:79], v103 offset:21504
    v_accvgpr_read_b32 v109, a37
    ds_write2st64_b64 v101, v[144:145], v[192:193] offset0:8 offset1:20
    v_accvgpr_read_b32 v108, a36
    v_accvgpr_read_b32 v58, a46
    v_pk_mul_f32 v[52:53], v[52:53], v[8:9] op_sel_hi:[1,0]
    v_cvt_pk_bf16_f32 v205, v206, v207
    v_cvt_pk_bf16_f32 v241, v242, v243
    s_waitcnt lgkmcnt(2)
    buffer_store_dwordx4 v[64:67], v6, s[16:19], s86 offen offset:128 nt
    ds_write2st64_b64 v92, v[148:149], v[196:197] offset0:8 offset1:20
    v_pk_mul_f32 v[108:109], v[108:109], v[8:9] op_sel_hi:[1,0]
    v_cvt_pk_bf16_f32 v156, v156, v157
    v_cvt_pk_bf16_f32 v157, v158, v159
    v_cvt_pk_bf16_f32 v245, v246, v247
    buffer_store_dwordx4 v[68:71], v7, s[16:19], s86 offen offset:128 nt
    ds_write2st64_b64 v93, v[152:153], v[200:201] offset0:8 offset1:20
    ds_write2st64_b64 v94, v[156:157], v[204:205] offset0:8 offset1:20
    v_cvt_pk_bf16_f32 v108, v108, v109
    v_cvt_pk_bf16_f32 v109, v110, v111
    buffer_store_dwordx4 v[72:75], v6, s[16:19], s87 offen offset:128 nt
    v_cvt_pk_bf16_f32 v104, v104, v105
    v_cvt_pk_bf16_f32 v252, v252, v253
    ds_read_b128 v[80:83], v103 offset:4096
    v_accvgpr_read_b32 v59, a47
    ds_read_b128 v[84:87], v103 offset:5120
    s_waitcnt lgkmcnt(2)
    buffer_store_dwordx4 v[76:79], v7, s[16:19], s87 offen offset:128 nt
    v_pk_mul_f32 v[58:59], v[58:59], v[8:9] op_sel_hi:[1,0]
    v_cvt_pk_bf16_f32 v52, v52, v53
    v_pk_mul_f32 v[106:107], v[106:107], v[8:9] op_sel_hi:[1,0]
    s_waitcnt lgkmcnt(1)
    buffer_store_dwordx4 v[80:83], v6, s[16:19], s84 offen offset:256 nt
    v_pk_mul_f32 v[56:57], v[56:57], v[8:9] op_sel_hi:[1,0]
    v_pk_mul_f32 v[54:55], v[54:55], v[8:9] op_sel_hi:[1,0]
    ds_read_b128 v[88:91], v103 offset:10240
    v_cvt_pk_bf16_f32 v105, v106, v107
    s_waitcnt lgkmcnt(1)
    buffer_store_dwordx4 v[84:87], v7, s[16:19], s84 offen offset:256 nt
    ds_read_b128 v[60:63], v103 offset:11264
    v_cvt_pk_bf16_f32 v56, v56, v57
    ds_write2st64_b64 v101, v[240:241], v[104:105] offset0:32 offset1:44
    v_cvt_pk_bf16_f32 v53, v54, v55
    s_waitcnt lgkmcnt(2)
    buffer_store_dwordx4 v[88:91], v6, s[16:19], s85 offen offset:256 nt
    v_cvt_pk_bf16_f32 v253, v254, v255
    v_cvt_pk_bf16_f32 v57, v58, v59
    ds_write2st64_b64 v92, v[244:245], v[108:109] offset0:32 offset1:44
    ds_write2st64_b64 v93, v[248:249], v[52:53] offset0:32 offset1:44
    ds_write2st64_b64 v94, v[252:253], v[56:57] offset0:32 offset1:44
    ds_read_b128 v[64:67], v103 offset:16384
    ds_read_b128 v[68:71], v103 offset:17408
    ds_read_b128 v[72:75], v103 offset:22528
    s_waitcnt lgkmcnt(6)
    buffer_store_dwordx4 v[60:63], v7, s[16:19], s85 offen offset:256 nt
    ds_read_b128 v[76:79], v103 offset:23552
    s_waitcnt lgkmcnt(3)
    buffer_store_dwordx4 v[64:67], v6, s[16:19], s86 offen offset:256 nt
    s_waitcnt lgkmcnt(1)
    buffer_store_dwordx4 v[68:71], v7, s[16:19], s86 offen offset:256 nt
    buffer_store_dwordx4 v[72:75], v6, s[16:19], s87 offen offset:256 nt
    s_waitcnt lgkmcnt(0)
    buffer_store_dwordx4 v[76:79], v7, s[16:19], s87 offen offset:256 nt
    s_branch L_fin
L_fin:
    s_waitcnt vmcnt(0)
L_end:
    s_endpgm
L_codeend:
L_rare5_0:
    s_nop 15
    v_mbcnt_lo_u32_b32 v31, -1, 0
    v_mbcnt_hi_u32_b32 v31, -1, v31
    v_and_b32 v30, 15, v31
    v_mul_u32_u24 v30, 384, v30
    v_lshrrev_b32 v31, 4, v31
    v_lshl_add_u32 v30, v31, 4, v30
    s_add_u32 s69, s39, 0
    buffer_load_dwordx4 v[44:47], v30, s[4:7], s69 offen offset:0
    s_waitcnt vmcnt(0)
    v_mfma_f32_16x16x32_bf16 v[104:107], v[44:47], a[96:99], 0
    s_nop 7
    buffer_load_dwordx4 v[44:47], v30, s[4:7], s69 offen offset:64
    s_waitcnt vmcnt(0)
    v_mfma_f32_16x16x32_bf16 v[104:107], v[44:47], a[100:103], v[104:107]
    s_nop 7
    buffer_load_dwordx4 v[44:47], v30, s[4:7], s69 offen offset:128
    s_waitcnt vmcnt(0)
    v_mfma_f32_16x16x32_bf16 v[104:107], v[44:47], a[104:107], v[104:107]
    s_nop 7
    buffer_load_dwordx4 v[44:47], v30, s[4:7], s69 offen offset:192
    s_waitcnt vmcnt(0)
    v_mfma_f32_16x16x32_bf16 v[104:107], v[44:47], a[108:111], v[104:107]
    s_nop 7
    buffer_load_dwordx4 v[44:47], v30, s[4:7], s69 offen offset:256
    s_waitcnt vmcnt(0)
    v_mfma_f32_16x16x32_bf16 v[104:107], v[44:47], a[112:115], v[104:107]
    s_nop 7
    buffer_load_dwordx4 v[44:47], v30, s[4:7], s69 offen offset:320
    s_waitcnt vmcnt(0)
    v_mfma_f32_16x16x32_bf16 v[104:107], v[44:47], a[116:119], v[104:107]
    s_nop 7
    s_add_u32 s69, s39, 6144
    buffer_load_dwordx4 v[44:47], v30, s[4:7], s69 offen offset:0
    s_waitcnt vmcnt(0)
    v_mfma_f32_16x16x32_bf16 v[108:111], v[44:47], a[96:99], 0
    s_nop 7
    buffer_load_dwordx4 v[44:47], v30, s[4:7], s69 offen offset:64
    s_waitcnt vmcnt(0)
    v_mfma_f32_16x16x32_bf16 v[108:111], v[44:47], a[100:103], v[108:111]
    s_nop 7
    buffer_load_dwordx4 v[44:47], v30, s[4:7], s69 offen offset:128
    s_waitcnt vmcnt(0)
    v_mfma_f32_16x16x32_bf16 v[108:111], v[44:47], a[104:107], v[108:111]
    s_nop 7
    buffer_load_dwordx4 v[44:47], v30, s[4:7], s69 offen offset:192
    s_waitcnt vmcnt(0)
    v_mfma_f32_16x16x32_bf16 v[108:111], v[44:47], a[108:111], v[108:111]
    s_nop 7
    buffer_load_dwordx4 v[44:47], v30, s[4:7], s69 offen offset:256
    s_waitcnt vmcnt(0)
    v_mfma_f32_16x16x32_bf16 v[108:111], v[44:47], a[112:115], v[108:111]
    s_nop 7
    buffer_load_dwordx4 v[44:47], v30, s[4:7], s69 offen offset:320
    s_waitcnt vmcnt(0)
    v_mfma_f32_16x16x32_bf16 v[108:111], v[44:47], a[116:119], v[108:111]
    s_nop 7
    s_nop 15
    v_max3_f32 v18, v104, v105, v106
    v_max3_f32 v18, v18, v107, v108
    v_max3_f32 v18, v18, v109, v110
    v_max_f32 v18, v18, v111
    v_mov_b32 v19, v18
    s_nop 1
    v_permlane32_swap_b32 v19, v18
    v_max_f32 v18, v18, v19
    v_mov_b32 v19, v18
    s_nop 1
    v_permlane16_swap_b32 v19, v18
    v_max_f32 v18, v18, v19
    v_fma_f32 v18, v18, s28, v9
    v_max_f32 v24, 0, v18
    v_sub_f32 v9, v9, v24
    v_sub_f32 v25, 0, v24
    v_exp_f32 v25, v25
    s_nop 0
    v_mul_f32 v19, v48, v25
    v_cndmask_b32_e64 v48, v19, v48, s[60:61]
    v_cndmask_b32_e64 v48, v48, 0, s[46:47]
    v_mul_f32 v112, v112, v25
    v_mul_f32 v113, v113, v25
    v_mul_f32 v114, v114, v25
    v_mul_f32 v115, v115, v25
    v_mul_f32 v116, v116, v25
    v_mul_f32 v117, v117, v25
    v_mul_f32 v118, v118, v25
    v_mul_f32 v119, v119, v25
    v_mul_f32 v120, v120, v25
    v_mul_f32 v121, v121, v25
    v_mul_f32 v122, v122, v25
    v_mul_f32 v123, v123, v25
    v_mul_f32 v124, v124, v25
    v_mul_f32 v125, v125, v25
    v_mul_f32 v126, v126, v25
    v_mul_f32 v127, v127, v25
    v_mul_f32 v128, v128, v25
    v_mul_f32 v129, v129, v25
    v_mul_f32 v130, v130, v25
    v_mul_f32 v131, v131, v25
    v_mul_f32 v132, v132, v25
    v_mul_f32 v133, v133, v25
    v_mul_f32 v134, v134, v25
    v_mul_f32 v135, v135, v25
    v_mul_f32 v136, v136, v25
    v_mul_f32 v137, v137, v25
    v_mul_f32 v138, v138, v25
    v_mul_f32 v139, v139, v25
    v_mul_f32 v140, v140, v25
    v_mul_f32 v141, v141, v25
    v_mul_f32 v142, v142, v25
    v_mul_f32 v143, v143, v25
    v_mul_f32 v144, v144, v25
    v_mul_f32 v145, v145, v25
    v_mul_f32 v146, v146, v25
    v_mul_f32 v147, v147, v25
    v_mul_f32 v148, v148, v25
    v_mul_f32 v149, v149, v25
    v_mul_f32 v150, v150, v25
    v_mul_f32 v151, v151, v25
    v_mul_f32 v152, v152, v25
    v_mul_f32 v153, v153, v25
    v_mul_f32 v154, v154, v25
    v_mul_f32 v155, v155, v25
    v_mul_f32 v156, v156, v25
    v_mul_f32 v157, v157, v25
    v_mul_f32 v158, v158, v25
    v_mul_f32 v159, v159, v25
    v_fma_f32 v104, v104, s28, v9
    v_fma_f32 v105, v105, s28, v9
    v_exp_f32 v104, v104
    v_exp_f32 v105, v105
    s_nop 0
    v_cvt_pk_bf16_f32 v14, v104, v105
    v_fma_f32 v106, v106, s28, v9
    v_fma_f32 v107, v107, s28, v9
    v_exp_f32 v106, v106
    v_exp_f32 v107, v107
    s_nop 0
    v_cvt_pk_bf16_f32 v15, v106, v107
    v_fma_f32 v108, v108, s28, v9
    v_fma_f32 v109, v109, s28, v9
    v_exp_f32 v108, v108
    v_exp_f32 v109, v109
    s_nop 0
    v_cvt_pk_bf16_f32 v16, v108, v109
    v_fma_f32 v110, v110, s28, v9
    v_fma_f32 v111, v111, s28, v9
    v_exp_f32 v110, v110
    v_exp_f32 v111, v111
    s_nop 0
    v_cvt_pk_bf16_f32 v17, v110, v111
    s_add_u32 s69, s39, 0
    buffer_load_dwordx4 v[44:47], v30, s[4:7], s69 offen offset:0
    s_waitcnt vmcnt(0)
    v_mfma_f32_16x16x32_bf16 v[104:107], v[44:47], a[120:123], 0
    s_nop 7
    buffer_load_dwordx4 v[44:47], v30, s[4:7], s69 offen offset:64
    s_waitcnt vmcnt(0)
    v_mfma_f32_16x16x32_bf16 v[104:107], v[44:47], a[124:127], v[104:107]
    s_nop 7
    buffer_load_dwordx4 v[44:47], v30, s[4:7], s69 offen offset:128
    s_waitcnt vmcnt(0)
    v_mfma_f32_16x16x32_bf16 v[104:107], v[44:47], a[128:131], v[104:107]
    s_nop 7
    buffer_load_dwordx4 v[44:47], v30, s[4:7], s69 offen offset:192
    s_waitcnt vmcnt(0)
    v_mfma_f32_16x16x32_bf16 v[104:107], v[44:47], a[132:135], v[104:107]
    s_nop 7
    buffer_load_dwordx4 v[44:47], v30, s[4:7], s69 offen offset:256
    s_waitcnt vmcnt(0)
    v_mfma_f32_16x16x32_bf16 v[104:107], v[44:47], a[136:139], v[104:107]
    s_nop 7
    buffer_load_dwordx4 v[44:47], v30, s[4:7], s69 offen offset:320
    s_waitcnt vmcnt(0)
    v_mfma_f32_16x16x32_bf16 v[104:107], v[44:47], a[140:143], v[104:107]
    s_nop 7
    s_add_u32 s69, s39, 6144
    buffer_load_dwordx4 v[44:47], v30, s[4:7], s69 offen offset:0
    s_waitcnt vmcnt(0)
    v_mfma_f32_16x16x32_bf16 v[108:111], v[44:47], a[120:123], 0
    s_nop 7
    buffer_load_dwordx4 v[44:47], v30, s[4:7], s69 offen offset:64
    s_waitcnt vmcnt(0)
    v_mfma_f32_16x16x32_bf16 v[108:111], v[44:47], a[124:127], v[108:111]
    s_nop 7
    buffer_load_dwordx4 v[44:47], v30, s[4:7], s69 offen offset:128
    s_waitcnt vmcnt(0)
    v_mfma_f32_16x16x32_bf16 v[108:111], v[44:47], a[128:131], v[108:111]
    s_nop 7
    buffer_load_dwordx4 v[44:47], v30, s[4:7], s69 offen offset:192
    s_waitcnt vmcnt(0)
    v_mfma_f32_16x16x32_bf16 v[108:111], v[44:47], a[132:135], v[108:111]
    s_nop 7
    buffer_load_dwordx4 v[44:47], v30, s[4:7], s69 offen offset:256
    s_waitcnt vmcnt(0)
    v_mfma_f32_16x16x32_bf16 v[108:111], v[44:47], a[136:139], v[108:111]
    s_nop 7
    buffer_load_dwordx4 v[44:47], v30, s[4:7], s69 offen offset:320
    s_waitcnt vmcnt(0)
    v_mfma_f32_16x16x32_bf16 v[108:111], v[44:47], a[140:143], v[108:111]
    s_nop 7
    s_nop 15
    v_max3_f32 v18, v104, v105, v106
    v_max3_f32 v18, v18, v107, v108
    v_max3_f32 v18, v18, v109, v110
    v_max_f32 v18, v18, v111
    v_mov_b32 v19, v18
    s_nop 1
    v_permlane32_swap_b32 v19, v18
    v_max_f32 v18, v18, v19
    v_mov_b32 v19, v18
    s_nop 1
    v_permlane16_swap_b32 v19, v18
    v_max_f32 v18, v18, v19
    v_fma_f32 v18, v18, s28, v10
    v_max_f32 v24, 0, v18
    v_sub_f32 v10, v10, v24
    v_sub_f32 v25, 0, v24
    v_exp_f32 v25, v25
    s_nop 0
    v_mul_f32 v49, v49, v25
    v_mul_f32 v160, v160, v25
    v_mul_f32 v161, v161, v25
    v_mul_f32 v162, v162, v25
    v_mul_f32 v163, v163, v25
    v_mul_f32 v164, v164, v25
    v_mul_f32 v165, v165, v25
    v_mul_f32 v166, v166, v25
    v_mul_f32 v167, v167, v25
    v_mul_f32 v168, v168, v25
    v_mul_f32 v169, v169, v25
    v_mul_f32 v170, v170, v25
    v_mul_f32 v171, v171, v25
    v_mul_f32 v172, v172, v25
    v_mul_f32 v173, v173, v25
    v_mul_f32 v174, v174, v25
    v_mul_f32 v175, v175, v25
    v_mul_f32 v176, v176, v25
    v_mul_f32 v177, v177, v25
    v_mul_f32 v178, v178, v25
    v_mul_f32 v179, v179, v25
    v_mul_f32 v180, v180, v25
    v_mul_f32 v181, v181, v25
    v_mul_f32 v182, v182, v25
    v_mul_f32 v183, v183, v25
    v_mul_f32 v184, v184, v25
    v_mul_f32 v185, v185, v25
    v_mul_f32 v186, v186, v25
    v_mul_f32 v187, v187, v25
    v_mul_f32 v188, v188, v25
    v_mul_f32 v189, v189, v25
    v_mul_f32 v190, v190, v25
    v_mul_f32 v191, v191, v25
    v_mul_f32 v192, v192, v25
    v_mul_f32 v193, v193, v25
    v_mul_f32 v194, v194, v25
    v_mul_f32 v195, v195, v25
    v_mul_f32 v196, v196, v25
    v_mul_f32 v197, v197, v25
    v_mul_f32 v198, v198, v25
    v_mul_f32 v199, v199, v25
    v_mul_f32 v200, v200, v25
    v_mul_f32 v201, v201, v25
    v_mul_f32 v202, v202, v25
    v_mul_f32 v203, v203, v25
    v_mul_f32 v204, v204, v25
    v_mul_f32 v205, v205, v25
    v_mul_f32 v206, v206, v25
    v_mul_f32 v207, v207, v25
    v_fma_f32 v104, v104, s28, v10
    v_fma_f32 v105, v105, s28, v10
    v_exp_f32 v104, v104
    v_exp_f32 v105, v105
    s_nop 0
    v_cvt_pk_bf16_f32 v20, v104, v105
    v_fma_f32 v106, v106, s28, v10
    v_fma_f32 v107, v107, s28, v10
    v_exp_f32 v106, v106
    v_exp_f32 v107, v107
    s_nop 0
    v_cvt_pk_bf16_f32 v21, v106, v107
    v_fma_f32 v108, v108, s28, v10
    v_fma_f32 v109, v109, s28, v10
    v_exp_f32 v108, v108
    v_exp_f32 v109, v109
    s_nop 0
    v_cvt_pk_bf16_f32 v22, v108, v109
    v_fma_f32 v110, v110, s28, v10
    v_fma_f32 v111, v111, s28, v10
    v_exp_f32 v110, v110
    v_exp_f32 v111, v111
    s_nop 0
    v_cvt_pk_bf16_f32 v23, v110, v111
    s_add_u32 s69, s39, 0
    buffer_load_dwordx4 v[44:47], v30, s[4:7], s69 offen offset:0
    s_waitcnt vmcnt(0)
    v_mfma_f32_16x16x32_bf16 v[104:107], v[44:47], a[144:147], 0
    s_nop 7
    buffer_load_dwordx4 v[44:47], v30, s[4:7], s69 offen offset:64
    s_waitcnt vmcnt(0)
    v_mfma_f32_16x16x32_bf16 v[104:107], v[44:47], a[148:151], v[104:107]
    s_nop 7
    buffer_load_dwordx4 v[44:47], v30, s[4:7], s69 offen offset:128
    s_waitcnt vmcnt(0)
    v_mfma_f32_16x16x32_bf16 v[104:107], v[44:47], a[152:155], v[104:107]
    s_nop 7
    buffer_load_dwordx4 v[44:47], v30, s[4:7], s69 offen offset:192
    s_waitcnt vmcnt(0)
    v_mfma_f32_16x16x32_bf16 v[104:107], v[44:47], a[156:159], v[104:107]
    s_nop 7
    buffer_load_dwordx4 v[44:47], v30, s[4:7], s69 offen offset:256
    s_waitcnt vmcnt(0)
    v_mfma_f32_16x16x32_bf16 v[104:107], v[44:47], a[160:163], v[104:107]
    s_nop 7
    buffer_load_dwordx4 v[44:47], v30, s[4:7], s69 offen offset:320
    s_waitcnt vmcnt(0)
    v_mfma_f32_16x16x32_bf16 v[104:107], v[44:47], a[164:167], v[104:107]
    s_nop 7
    s_add_u32 s69, s39, 6144
    buffer_load_dwordx4 v[44:47], v30, s[4:7], s69 offen offset:0
    s_waitcnt vmcnt(0)
    v_mfma_f32_16x16x32_bf16 v[108:111], v[44:47], a[144:147], 0
    s_nop 7
    buffer_load_dwordx4 v[44:47], v30, s[4:7], s69 offen offset:64
    s_waitcnt vmcnt(0)
    v_mfma_f32_16x16x32_bf16 v[108:111], v[44:47], a[148:151], v[108:111]
    s_nop 7
    buffer_load_dwordx4 v[44:47], v30, s[4:7], s69 offen offset:128
    s_waitcnt vmcnt(0)
    v_mfma_f32_16x16x32_bf16 v[108:111], v[44:47], a[152:155], v[108:111]
    s_nop 7
    buffer_load_dwordx4 v[44:47], v30, s[4:7], s69 offen offset:192
    s_waitcnt vmcnt(0)
    v_mfma_f32_16x16x32_bf16 v[108:111], v[44:47], a[156:159], v[108:111]
    s_nop 7
    buffer_load_dwordx4 v[44:47], v30, s[4:7], s69 offen offset:256
    s_waitcnt vmcnt(0)
    v_mfma_f32_16x16x32_bf16 v[108:111], v[44:47], a[160:163], v[108:111]
    s_nop 7
    buffer_load_dwordx4 v[44:47], v30, s[4:7], s69 offen offset:320
    s_waitcnt vmcnt(0)
    v_mfma_f32_16x16x32_bf16 v[108:111], v[44:47], a[164:167], v[108:111]
    s_nop 7
    s_nop 15
    v_max3_f32 v18, v104, v105, v106
    v_max3_f32 v18, v18, v107, v108
    v_max3_f32 v18, v18, v109, v110
    v_max_f32 v18, v18, v111
    v_mov_b32 v19, v18
    s_nop 1
    v_permlane32_swap_b32 v19, v18
    v_max_f32 v18, v18, v19
    v_mov_b32 v19, v18
    s_nop 1
    v_permlane16_swap_b32 v19, v18
    v_max_f32 v18, v18, v19
    v_fma_f32 v18, v18, s28, v11
    v_max_f32 v24, 0, v18
    v_sub_f32 v11, v11, v24
    v_sub_f32 v25, 0, v24
    v_exp_f32 v25, v25
    s_nop 0
    v_mul_f32 v50, v50, v25
    v_mul_f32 v208, v208, v25
    v_mul_f32 v209, v209, v25
    v_mul_f32 v210, v210, v25
    v_mul_f32 v211, v211, v25
    v_mul_f32 v212, v212, v25
    v_mul_f32 v213, v213, v25
    v_mul_f32 v214, v214, v25
    v_mul_f32 v215, v215, v25
    v_mul_f32 v216, v216, v25
    v_mul_f32 v217, v217, v25
    v_mul_f32 v218, v218, v25
    v_mul_f32 v219, v219, v25
    v_mul_f32 v220, v220, v25
    v_mul_f32 v221, v221, v25
    v_mul_f32 v222, v222, v25
    v_mul_f32 v223, v223, v25
    v_mul_f32 v224, v224, v25
    v_mul_f32 v225, v225, v25
    v_mul_f32 v226, v226, v25
    v_mul_f32 v227, v227, v25
    v_mul_f32 v228, v228, v25
    v_mul_f32 v229, v229, v25
    v_mul_f32 v230, v230, v25
    v_mul_f32 v231, v231, v25
    v_mul_f32 v232, v232, v25
    v_mul_f32 v233, v233, v25
    v_mul_f32 v234, v234, v25
    v_mul_f32 v235, v235, v25
    v_mul_f32 v236, v236, v25
    v_mul_f32 v237, v237, v25
    v_mul_f32 v238, v238, v25
    v_mul_f32 v239, v239, v25
    v_mul_f32 v240, v240, v25
    v_mul_f32 v241, v241, v25
    v_mul_f32 v242, v242, v25
    v_mul_f32 v243, v243, v25
    v_mul_f32 v244, v244, v25
    v_mul_f32 v245, v245, v25
    v_mul_f32 v246, v246, v25
    v_mul_f32 v247, v247, v25
    v_mul_f32 v248, v248, v25
    v_mul_f32 v249, v249, v25
    v_mul_f32 v250, v250, v25
    v_mul_f32 v251, v251, v25
    v_mul_f32 v252, v252, v25
    v_mul_f32 v253, v253, v25
    v_mul_f32 v254, v254, v25
    v_mul_f32 v255, v255, v25
    v_fma_f32 v104, v104, s28, v11
    v_fma_f32 v105, v105, s28, v11
    v_exp_f32 v104, v104
    v_exp_f32 v105, v105
    s_nop 0
    v_cvt_pk_bf16_f32 v26, v104, v105
    v_fma_f32 v106, v106, s28, v11
    v_fma_f32 v107, v107, s28, v11
    v_exp_f32 v106, v106
    v_exp_f32 v107, v107
    s_nop 0
    v_cvt_pk_bf16_f32 v27, v106, v107
    v_fma_f32 v108, v108, s28, v11
    v_fma_f32 v109, v109, s28, v11
    v_exp_f32 v108, v108
    v_exp_f32 v109, v109
    s_nop 0
    v_cvt_pk_bf16_f32 v28, v108, v109
    v_fma_f32 v110, v110, s28, v11
    v_fma_f32 v111, v111, s28, v11
    v_exp_f32 v110, v110
    v_exp_f32 v111, v111
    s_nop 0
    v_cvt_pk_bf16_f32 v29, v110, v111
    s_add_u32 s69, s39, 0
    buffer_load_dwordx4 v[44:47], v30, s[4:7], s69 offen offset:0
    s_waitcnt vmcnt(0)
    v_mfma_f32_16x16x32_bf16 v[104:107], v[44:47], a[168:171], 0
    s_nop 7
    buffer_load_dwordx4 v[44:47], v30, s[4:7], s69 offen offset:64
    s_waitcnt vmcnt(0)
    v_mfma_f32_16x16x32_bf16 v[104:107], v[44:47], a[172:175], v[104:107]
    s_nop 7
    buffer_load_dwordx4 v[44:47], v30, s[4:7], s69 offen offset:128
    s_waitcnt vmcnt(0)
    v_mfma_f32_16x16x32_bf16 v[104:107], v[44:47], a[176:179], v[104:107]
    s_nop 7
    buffer_load_dwordx4 v[44:47], v30, s[4:7], s69 offen offset:192
    s_waitcnt vmcnt(0)
    v_mfma_f32_16x16x32_bf16 v[104:107], v[44:47], a[180:183], v[104:107]
    s_nop 7
    buffer_load_dwordx4 v[44:47], v30, s[4:7], s69 offen offset:256
    s_waitcnt vmcnt(0)
    v_mfma_f32_16x16x32_bf16 v[104:107], v[44:47], a[184:187], v[104:107]
    s_nop 7
    buffer_load_dwordx4 v[44:47], v30, s[4:7], s69 offen offset:320
    s_waitcnt vmcnt(0)
    v_mfma_f32_16x16x32_bf16 v[104:107], v[44:47], a[188:191], v[104:107]
    s_nop 7
    s_add_u32 s69, s39, 6144
    buffer_load_dwordx4 v[44:47], v30, s[4:7], s69 offen offset:0
    s_waitcnt vmcnt(0)
    v_mfma_f32_16x16x32_bf16 v[108:111], v[44:47], a[168:171], 0
    s_nop 7
    buffer_load_dwordx4 v[44:47], v30, s[4:7], s69 offen offset:64
    s_waitcnt vmcnt(0)
    v_mfma_f32_16x16x32_bf16 v[108:111], v[44:47], a[172:175], v[108:111]
    s_nop 7
    buffer_load_dwordx4 v[44:47], v30, s[4:7], s69 offen offset:128
    s_waitcnt vmcnt(0)
    v_mfma_f32_16x16x32_bf16 v[108:111], v[44:47], a[176:179], v[108:111]
    s_nop 7
    buffer_load_dwordx4 v[44:47], v30, s[4:7], s69 offen offset:192
    s_waitcnt vmcnt(0)
    v_mfma_f32_16x16x32_bf16 v[108:111], v[44:47], a[180:183], v[108:111]
    s_nop 7
    buffer_load_dwordx4 v[44:47], v30, s[4:7], s69 offen offset:256
    s_waitcnt vmcnt(0)
    v_mfma_f32_16x16x32_bf16 v[108:111], v[44:47], a[184:187], v[108:111]
    s_nop 7
    buffer_load_dwordx4 v[44:47], v30, s[4:7], s69 offen offset:320
    s_waitcnt vmcnt(0)
    v_mfma_f32_16x16x32_bf16 v[108:111], v[44:47], a[188:191], v[108:111]
    s_nop 7
    s_nop 15
    v_max3_f32 v18, v104, v105, v106
    v_max3_f32 v18, v18, v107, v108
    v_max3_f32 v18, v18, v109, v110
    v_max_f32 v18, v18, v111
    v_mov_b32 v19, v18
    s_nop 1
    v_permlane32_swap_b32 v19, v18
    v_max_f32 v18, v18, v19
    v_mov_b32 v19, v18
    s_nop 1
    v_permlane16_swap_b32 v19, v18
    v_max_f32 v18, v18, v19
    v_fma_f32 v18, v18, s28, v12
    v_max_f32 v24, 0, v18
    v_sub_f32 v12, v12, v24
    v_sub_f32 v25, 0, v24
    v_exp_f32 v25, v25
    s_nop 0
    v_mul_f32 v51, v51, v25
    v_accvgpr_read_b32 v19, a0
    v_mul_f32 v19, v19, v25
    v_accvgpr_write_b32 a0, v19
    v_accvgpr_read_b32 v19, a1
    v_mul_f32 v19, v19, v25
    v_accvgpr_write_b32 a1, v19
    v_accvgpr_read_b32 v19, a2
    v_mul_f32 v19, v19, v25
    v_accvgpr_write_b32 a2, v19
    v_accvgpr_read_b32 v19, a3
    v_mul_f32 v19, v19, v25
    v_accvgpr_write_b32 a3, v19
    v_accvgpr_read_b32 v19, a4
    v_mul_f32 v19, v19, v25
    v_accvgpr_write_b32 a4, v19
    v_accvgpr_read_b32 v19, a5
    v_mul_f32 v19, v19, v25
    v_accvgpr_write_b32 a5, v19
    v_accvgpr_read_b32 v19, a6
    v_mul_f32 v19, v19, v25
    v_accvgpr_write_b32 a6, v19
    v_accvgpr_read_b32 v19, a7
    v_mul_f32 v19, v19, v25
    v_accvgpr_write_b32 a7, v19
    v_accvgpr_read_b32 v19, a8
    v_mul_f32 v19, v19, v25
    v_accvgpr_write_b32 a8, v19
    v_accvgpr_read_b32 v19, a9
    v_mul_f32 v19, v19, v25
    v_accvgpr_write_b32 a9, v19
    v_accvgpr_read_b32 v19, a10
    v_mul_f32 v19, v19, v25
    v_accvgpr_write_b32 a10, v19
    v_accvgpr_read_b32 v19, a11
    v_mul_f32 v19, v19, v25
    v_accvgpr_write_b32 a11, v19
    v_accvgpr_read_b32 v19, a12
    v_mul_f32 v19, v19, v25
    v_accvgpr_write_b32 a12, v19
    v_accvgpr_read_b32 v19, a13
    v_mul_f32 v19, v19, v25
    v_accvgpr_write_b32 a13, v19
    v_accvgpr_read_b32 v19, a14
    v_mul_f32 v19, v19, v25
    v_accvgpr_write_b32 a14, v19
    v_accvgpr_read_b32 v19, a15
    v_mul_f32 v19, v19, v25
    v_accvgpr_write_b32 a15, v19
    v_accvgpr_read_b32 v19, a16
    v_mul_f32 v19, v19, v25
    v_accvgpr_write_b32 a16, v19
    v_accvgpr_read_b32 v19, a17
    v_mul_f32 v19, v19, v25
    v_accvgpr_write_b32 a17, v19
    v_accvgpr_read_b32 v19, a18
    v_mul_f32 v19, v19, v25
    v_accvgpr_write_b32 a18, v19
    v_accvgpr_read_b32 v19, a19
    v_mul_f32 v19, v19, v25
    v_accvgpr_write_b32 a19, v19
    v_accvgpr_read_b32 v19, a20
    v_mul_f32 v19, v19, v25
    v_accvgpr_write_b32 a20, v19
    v_accvgpr_read_b32 v19, a21
    v_mul_f32 v19, v19, v25
    v_accvgpr_write_b32 a21, v19
    v_accvgpr_read_b32 v19, a22
    v_mul_f32 v19, v19, v25
    v_accvgpr_write_b32 a22, v19
    v_accvgpr_read_b32 v19, a23
    v_mul_f32 v19, v19, v25
    v_accvgpr_write_b32 a23, v19
    v_accvgpr_read_b32 v19, a24
    v_mul_f32 v19, v19, v25
    v_accvgpr_write_b32 a24, v19
    v_accvgpr_read_b32 v19, a25
    v_mul_f32 v19, v19, v25
    v_accvgpr_write_b32 a25, v19
    v_accvgpr_read_b32 v19, a26
    v_mul_f32 v19, v19, v25
    v_accvgpr_write_b32 a26, v19
    v_accvgpr_read_b32 v19, a27
    v_mul_f32 v19, v19, v25
    v_accvgpr_write_b32 a27, v19
    v_accvgpr_read_b32 v19, a28
    v_mul_f32 v19, v19, v25
    v_accvgpr_write_b32 a28, v19
    v_accvgpr_read_b32 v19, a29
    v_mul_f32 v19, v19, v25
    v_accvgpr_write_b32 a29, v19
    v_accvgpr_read_b32 v19, a30
    v_mul_f32 v19, v19, v25
    v_accvgpr_write_b32 a30, v19
    v_accvgpr_read_b32 v19, a31
    v_mul_f32 v19, v19, v25
    v_accvgpr_write_b32 a31, v19
    v_accvgpr_read_b32 v19, a32
    v_mul_f32 v19, v19, v25
    v_accvgpr_write_b32 a32, v19
    v_accvgpr_read_b32 v19, a33
    v_mul_f32 v19, v19, v25
    v_accvgpr_write_b32 a33, v19
    v_accvgpr_read_b32 v19, a34
    v_mul_f32 v19, v19, v25
    v_accvgpr_write_b32 a34, v19
    v_accvgpr_read_b32 v19, a35
    v_mul_f32 v19, v19, v25
    v_accvgpr_write_b32 a35, v19
    v_accvgpr_read_b32 v19, a36
    v_mul_f32 v19, v19, v25
    v_accvgpr_write_b32 a36, v19
    v_accvgpr_read_b32 v19, a37
    v_mul_f32 v19, v19, v25
    v_accvgpr_write_b32 a37, v19
    v_accvgpr_read_b32 v19, a38
    v_mul_f32 v19, v19, v25
    v_accvgpr_write_b32 a38, v19
    v_accvgpr_read_b32 v19, a39
    v_mul_f32 v19, v19, v25
    v_accvgpr_write_b32 a39, v19
    v_accvgpr_read_b32 v19, a40
    v_mul_f32 v19, v19, v25
    v_accvgpr_write_b32 a40, v19
    v_accvgpr_read_b32 v19, a41
    v_mul_f32 v19, v19, v25
    v_accvgpr_write_b32 a41, v19
    v_accvgpr_read_b32 v19, a42
    v_mul_f32 v19, v19, v25
    v_accvgpr_write_b32 a42, v19
    v_accvgpr_read_b32 v19, a43
    v_mul_f32 v19, v19, v25
    v_accvgpr_write_b32 a43, v19
    v_accvgpr_read_b32 v19, a44
    v_mul_f32 v19, v19, v25
    v_accvgpr_write_b32 a44, v19
    v_accvgpr_read_b32 v19, a45
    v_mul_f32 v19, v19, v25
    v_accvgpr_write_b32 a45, v19
    v_accvgpr_read_b32 v19, a46
    v_mul_f32 v19, v19, v25
    v_accvgpr_write_b32 a46, v19
    v_accvgpr_read_b32 v19, a47
    v_mul_f32 v19, v19, v25
    v_accvgpr_write_b32 a47, v19
    v_fma_f32 v104, v104, s28, v12
    v_fma_f32 v105, v105, s28, v12
    v_exp_f32 v104, v104
    v_exp_f32 v105, v105
    s_nop 0
    v_cvt_pk_bf16_f32 v32, v104, v105
    v_fma_f32 v106, v106, s28, v12
    v_fma_f32 v107, v107, s28, v12
    v_exp_f32 v106, v106
    v_exp_f32 v107, v107
    s_nop 0
    v_cvt_pk_bf16_f32 v33, v106, v107
    v_fma_f32 v108, v108, s28, v12
    v_fma_f32 v109, v109, s28, v12
    v_exp_f32 v108, v108
    v_exp_f32 v109, v109
    s_nop 0
    v_cvt_pk_bf16_f32 v34, v108, v109
    v_fma_f32 v110, v110, s28, v12
    v_fma_f32 v111, v111, s28, v12
    v_exp_f32 v110, v110
    v_exp_f32 v111, v111
    s_nop 0
    v_cvt_pk_bf16_f32 v35, v110, v111
    s_add_u32 s69, s39, 0
    buffer_load_dwordx4 v[44:47], v30, s[4:7], s69 offen offset:0
    s_waitcnt vmcnt(0)
    v_mfma_f32_16x16x32_bf16 v[104:107], v[44:47], a[192:195], 0
    s_nop 7
    buffer_load_dwordx4 v[44:47], v30, s[4:7], s69 offen offset:64
    s_waitcnt vmcnt(0)
    v_mfma_f32_16x16x32_bf16 v[104:107], v[44:47], a[196:199], v[104:107]
    s_nop 7
    buffer_load_dwordx4 v[44:47], v30, s[4:7], s69 offen offset:128
    s_waitcnt vmcnt(0)
    v_mfma_f32_16x16x32_bf16 v[104:107], v[44:47], a[200:203], v[104:107]
    s_nop 7
    buffer_load_dwordx4 v[44:47], v30, s[4:7], s69 offen offset:192
    s_waitcnt vmcnt(0)
    v_mfma_f32_16x16x32_bf16 v[104:107], v[44:47], a[204:207], v[104:107]
    s_nop 7
    buffer_load_dwordx4 v[44:47], v30, s[4:7], s69 offen offset:256
    s_waitcnt vmcnt(0)
    v_mfma_f32_16x16x32_bf16 v[104:107], v[44:47], a[208:211], v[104:107]
    s_nop 7
    buffer_load_dwordx4 v[44:47], v30, s[4:7], s69 offen offset:320
    s_waitcnt vmcnt(0)
    v_mfma_f32_16x16x32_bf16 v[104:107], v[44:47], v[92:95], v[104:107]
    s_nop 7
    s_add_u32 s69, s39, 6144
    buffer_load_dwordx4 v[44:47], v30, s[4:7], s69 offen offset:0
    s_waitcnt vmcnt(0)
    v_mfma_f32_16x16x32_bf16 v[108:111], v[44:47], a[192:195], 0
    s_nop 7
    buffer_load_dwordx4 v[44:47], v30, s[4:7], s69 offen offset:64
    s_waitcnt vmcnt(0)
    v_mfma_f32_16x16x32_bf16 v[108:111], v[44:47], a[196:199], v[108:111]
    s_nop 7
    buffer_load_dwordx4 v[44:47], v30, s[4:7], s69 offen offset:128
    s_waitcnt vmcnt(0)
    v_mfma_f32_16x16x32_bf16 v[108:111], v[44:47], a[200:203], v[108:111]
    s_nop 7
    buffer_load_dwordx4 v[44:47], v30, s[4:7], s69 offen offset:192
    s_waitcnt vmcnt(0)
    v_mfma_f32_16x16x32_bf16 v[108:111], v[44:47], a[204:207], v[108:111]
    s_nop 7
    buffer_load_dwordx4 v[44:47], v30, s[4:7], s69 offen offset:256
    s_waitcnt vmcnt(0)
    v_mfma_f32_16x16x32_bf16 v[108:111], v[44:47], a[208:211], v[108:111]
    s_nop 7
    buffer_load_dwordx4 v[44:47], v30, s[4:7], s69 offen offset:320
    s_waitcnt vmcnt(0)
    v_mfma_f32_16x16x32_bf16 v[108:111], v[44:47], v[92:95], v[108:111]
    s_nop 7
    s_nop 15
    v_max3_f32 v18, v104, v105, v106
    v_max3_f32 v18, v18, v107, v108
    v_max3_f32 v18, v18, v109, v110
    v_max_f32 v18, v18, v111
    v_mov_b32 v19, v18
    s_nop 1
    v_permlane32_swap_b32 v19, v18
    v_max_f32 v18, v18, v19
    v_mov_b32 v19, v18
    s_nop 1
    v_permlane16_swap_b32 v19, v18
    v_max_f32 v18, v18, v19
    v_fma_f32 v18, v18, s28, v13
    v_max_f32 v24, 0, v18
    v_sub_f32 v13, v13, v24
    v_sub_f32 v25, 0, v24
    v_exp_f32 v25, v25
    s_nop 0
    v_mul_f32 v19, v48, v25
    v_cndmask_b32_e64 v48, v48, v19, s[60:61]
    v_accvgpr_read_b32 v19, a48
    v_mul_f32 v19, v19, v25
    v_accvgpr_write_b32 a48, v19
    v_accvgpr_read_b32 v19, a49
    v_mul_f32 v19, v19, v25
    v_accvgpr_write_b32 a49, v19
    v_accvgpr_read_b32 v19, a50
    v_mul_f32 v19, v19, v25
    v_accvgpr_write_b32 a50, v19
    v_accvgpr_read_b32 v19, a51
    v_mul_f32 v19, v19, v25
    v_accvgpr_write_b32 a51, v19
    v_accvgpr_read_b32 v19, a52
    v_mul_f32 v19, v19, v25
    v_accvgpr_write_b32 a52, v19
    v_accvgpr_read_b32 v19, a53
    v_mul_f32 v19, v19, v25
    v_accvgpr_write_b32 a53, v19
    v_accvgpr_read_b32 v19, a54
    v_mul_f32 v19, v19, v25
    v_accvgpr_write_b32 a54, v19
    v_accvgpr_read_b32 v19, a55
    v_mul_f32 v19, v19, v25
    v_accvgpr_write_b32 a55, v19
    v_accvgpr_read_b32 v19, a56
    v_mul_f32 v19, v19, v25
    v_accvgpr_write_b32 a56, v19
    v_accvgpr_read_b32 v19, a57
    v_mul_f32 v19, v19, v25
    v_accvgpr_write_b32 a57, v19
    v_accvgpr_read_b32 v19, a58
    v_mul_f32 v19, v19, v25
    v_accvgpr_write_b32 a58, v19
    v_accvgpr_read_b32 v19, a59
    v_mul_f32 v19, v19, v25
    v_accvgpr_write_b32 a59, v19
    v_accvgpr_read_b32 v19, a60
    v_mul_f32 v19, v19, v25
    v_accvgpr_write_b32 a60, v19
    v_accvgpr_read_b32 v19, a61
    v_mul_f32 v19, v19, v25
    v_accvgpr_write_b32 a61, v19
    v_accvgpr_read_b32 v19, a62
    v_mul_f32 v19, v19, v25
    v_accvgpr_write_b32 a62, v19
    v_accvgpr_read_b32 v19, a63
    v_mul_f32 v19, v19, v25
    v_accvgpr_write_b32 a63, v19
    v_accvgpr_read_b32 v19, a64
    v_mul_f32 v19, v19, v25
    v_accvgpr_write_b32 a64, v19
    v_accvgpr_read_b32 v19, a65
    v_mul_f32 v19, v19, v25
    v_accvgpr_write_b32 a65, v19
    v_accvgpr_read_b32 v19, a66
    v_mul_f32 v19, v19, v25
    v_accvgpr_write_b32 a66, v19
    v_accvgpr_read_b32 v19, a67
    v_mul_f32 v19, v19, v25
    v_accvgpr_write_b32 a67, v19
    v_accvgpr_read_b32 v19, a68
    v_mul_f32 v19, v19, v25
    v_accvgpr_write_b32 a68, v19
    v_accvgpr_read_b32 v19, a69
    v_mul_f32 v19, v19, v25
    v_accvgpr_write_b32 a69, v19
    v_accvgpr_read_b32 v19, a70
    v_mul_f32 v19, v19, v25
    v_accvgpr_write_b32 a70, v19
    v_accvgpr_read_b32 v19, a71
    v_mul_f32 v19, v19, v25
    v_accvgpr_write_b32 a71, v19
    v_accvgpr_read_b32 v19, a72
    v_mul_f32 v19, v19, v25
    v_accvgpr_write_b32 a72, v19
    v_accvgpr_read_b32 v19, a73
    v_mul_f32 v19, v19, v25
    v_accvgpr_write_b32 a73, v19
    v_accvgpr_read_b32 v19, a74
    v_mul_f32 v19, v19, v25
    v_accvgpr_write_b32 a74, v19
    v_accvgpr_read_b32 v19, a75
    v_mul_f32 v19, v19, v25
    v_accvgpr_write_b32 a75, v19
    v_accvgpr_read_b32 v19, a76
    v_mul_f32 v19, v19, v25
    v_accvgpr_write_b32 a76, v19
    v_accvgpr_read_b32 v19, a77
    v_mul_f32 v19, v19, v25
    v_accvgpr_write_b32 a77, v19
    v_accvgpr_read_b32 v19, a78
    v_mul_f32 v19, v19, v25
    v_accvgpr_write_b32 a78, v19
    v_accvgpr_read_b32 v19, a79
    v_mul_f32 v19, v19, v25
    v_accvgpr_write_b32 a79, v19
    v_accvgpr_read_b32 v19, a80
    v_mul_f32 v19, v19, v25
    v_accvgpr_write_b32 a80, v19
    v_accvgpr_read_b32 v19, a81
    v_mul_f32 v19, v19, v25
    v_accvgpr_write_b32 a81, v19
    v_accvgpr_read_b32 v19, a82
    v_mul_f32 v19, v19, v25
    v_accvgpr_write_b32 a82, v19
    v_accvgpr_read_b32 v19, a83
    v_mul_f32 v19, v19, v25
    v_accvgpr_write_b32 a83, v19
    v_accvgpr_read_b32 v19, a84
    v_mul_f32 v19, v19, v25
    v_accvgpr_write_b32 a84, v19
    v_accvgpr_read_b32 v19, a85
    v_mul_f32 v19, v19, v25
    v_accvgpr_write_b32 a85, v19
    v_accvgpr_read_b32 v19, a86
    v_mul_f32 v19, v19, v25
    v_accvgpr_write_b32 a86, v19
    v_accvgpr_read_b32 v19, a87
    v_mul_f32 v19, v19, v25
    v_accvgpr_write_b32 a87, v19
    v_accvgpr_read_b32 v19, a88
    v_mul_f32 v19, v19, v25
    v_accvgpr_write_b32 a88, v19
    v_accvgpr_read_b32 v19, a89
    v_mul_f32 v19, v19, v25
    v_accvgpr_write_b32 a89, v19
    v_accvgpr_read_b32 v19, a90
    v_mul_f32 v19, v19, v25
    v_accvgpr_write_b32 a90, v19
    v_accvgpr_read_b32 v19, a91
    v_mul_f32 v19, v19, v25
    v_accvgpr_write_b32 a91, v19
    v_accvgpr_read_b32 v19, a92
    v_mul_f32 v19, v19, v25
    v_accvgpr_write_b32 a92, v19
    v_accvgpr_read_b32 v19, a93
    v_mul_f32 v19, v19, v25
    v_accvgpr_write_b32 a93, v19
    v_accvgpr_read_b32 v19, a94
    v_mul_f32 v19, v19, v25
    v_accvgpr_write_b32 a94, v19
    v_accvgpr_read_b32 v19, a95
    v_mul_f32 v19, v19, v25
    v_accvgpr_write_b32 a95, v19
    v_fma_f32 v104, v104, s28, v13
    v_fma_f32 v105, v105, s28, v13
    v_exp_f32 v104, v104
    v_exp_f32 v105, v105
    s_nop 0
    v_cvt_pk_bf16_f32 v38, v104, v105
    v_fma_f32 v106, v106, s28, v13
    v_fma_f32 v107, v107, s28, v13
    v_exp_f32 v106, v106
    v_exp_f32 v107, v107
    s_nop 0
    v_cvt_pk_bf16_f32 v39, v106, v107
    v_fma_f32 v108, v108, s28, v13
    v_fma_f32 v109, v109, s28, v13
    v_exp_f32 v108, v108
    v_exp_f32 v109, v109
    s_nop 0
    v_cvt_pk_bf16_f32 v40, v108, v109
    v_fma_f32 v110, v110, s28, v13
    v_fma_f32 v111, v111, s28, v13
    v_exp_f32 v110, v110
    v_exp_f32 v111, v111
    s_nop 0
    v_cvt_pk_bf16_f32 v41, v110, v111
    v_mfma_f32_16x16x32_bf16 v[44:47], a[236:239], v[14:17], v[48:51]
    v_mfma_f32_16x16x32_bf16 v[44:47], a[240:243], v[20:23], v[44:47]
    v_mfma_f32_16x16x32_bf16 v[44:47], a[244:247], v[26:29], v[44:47]
    v_mfma_f32_16x16x32_bf16 v[44:47], a[248:251], v[32:35], v[44:47]
    v_mfma_f32_16x16x32_bf16 v[44:47], a[252:255], v[38:41], v[44:47]
    s_nop 15
    s_setpc_b64 s[40:41]
L_rare5_1:
    s_nop 15
    v_mbcnt_lo_u32_b32 v27, -1, 0
    v_mbcnt_hi_u32_b32 v27, -1, v27
    v_and_b32 v26, 15, v27
    v_mul_u32_u24 v26, 384, v26
    v_lshrrev_b32 v27, 4, v27
    v_lshl_add_u32 v26, v27, 4, v26
    s_add_u32 s69, s39, 0
    buffer_load_dwordx4 v[48:51], v26, s[4:7], s69 offen offset:0
    s_waitcnt vmcnt(0)
    v_mfma_f32_16x16x32_bf16 v[104:107], v[48:51], a[96:99], 0
    s_nop 7
    buffer_load_dwordx4 v[48:51], v26, s[4:7], s69 offen offset:64
    s_waitcnt vmcnt(0)
    v_mfma_f32_16x16x32_bf16 v[104:107], v[48:51], a[100:103], v[104:107]
    s_nop 7
    buffer_load_dwordx4 v[48:51], v26, s[4:7], s69 offen offset:128
    s_waitcnt vmcnt(0)
    v_mfma_f32_16x16x32_bf16 v[104:107], v[48:51], a[104:107], v[104:107]
    s_nop 7
    buffer_load_dwordx4 v[48:51], v26, s[4:7], s69 offen offset:192
    s_waitcnt vmcnt(0)
    v_mfma_f32_16x16x32_bf16 v[104:107], v[48:51], a[108:111], v[104:107]
    s_nop 7
    buffer_load_dwordx4 v[48:51], v26, s[4:7], s69 offen offset:256
    s_waitcnt vmcnt(0)
    v_mfma_f32_16x16x32_bf16 v[104:107], v[48:51], a[112:115], v[104:107]
    s_nop 7
    buffer_load_dwordx4 v[48:51], v26, s[4:7], s69 offen offset:320
    s_waitcnt vmcnt(0)
    v_mfma_f32_16x16x32_bf16 v[104:107], v[48:51], a[116:119], v[104:107]
    s_nop 7
    s_add_u32 s69, s39, 6144
    buffer_load_dwordx4 v[48:51], v26, s[4:7], s69 offen offset:0
    s_waitcnt vmcnt(0)
    v_mfma_f32_16x16x32_bf16 v[108:111], v[48:51], a[96:99], 0
    s_nop 7
    buffer_load_dwordx4 v[48:51], v26, s[4:7], s69 offen offset:64
    s_waitcnt vmcnt(0)
    v_mfma_f32_16x16x32_bf16 v[108:111], v[48:51], a[100:103], v[108:111]
    s_nop 7
    buffer_load_dwordx4 v[48:51], v26, s[4:7], s69 offen offset:128
    s_waitcnt vmcnt(0)
    v_mfma_f32_16x16x32_bf16 v[108:111], v[48:51], a[104:107], v[108:111]
    s_nop 7
    buffer_load_dwordx4 v[48:51], v26, s[4:7], s69 offen offset:192
    s_waitcnt vmcnt(0)
    v_mfma_f32_16x16x32_bf16 v[108:111], v[48:51], a[108:111], v[108:111]
    s_nop 7
    buffer_load_dwordx4 v[48:51], v26, s[4:7], s69 offen offset:256
    s_waitcnt vmcnt(0)
    v_mfma_f32_16x16x32_bf16 v[108:111], v[48:51], a[112:115], v[108:111]
    s_nop 7
    buffer_load_dwordx4 v[48:51], v26, s[4:7], s69 offen offset:320
    s_waitcnt vmcnt(0)
    v_mfma_f32_16x16x32_bf16 v[108:111], v[48:51], a[116:119], v[108:111]
    s_nop 7
    s_nop 15
    v_max3_f32 v14, v104, v105, v106
    v_max3_f32 v14, v14, v107, v108
    v_max3_f32 v14, v14, v109, v110
    v_max_f32 v14, v14, v111
    v_mov_b32 v15, v14
    s_nop 1
    v_permlane32_swap_b32 v15, v14
    v_max_f32 v14, v14, v15
    v_mov_b32 v15, v14
    s_nop 1
    v_permlane16_swap_b32 v15, v14
    v_max_f32 v14, v14, v15
    v_fma_f32 v14, v14, s28, v9
    v_max_f32 v20, 0, v14
    v_sub_f32 v9, v9, v20
    v_sub_f32 v21, 0, v20
    v_exp_f32 v21, v21
    s_nop 0
    v_mul_f32 v15, v44, v21
    v_cndmask_b32_e64 v44, v15, v44, s[60:61]
    v_cndmask_b32_e64 v44, v44, 0, s[46:47]
    v_mul_f32 v112, v112, v21
    v_mul_f32 v113, v113, v21
    v_mul_f32 v114, v114, v21
    v_mul_f32 v115, v115, v21
    v_mul_f32 v116, v116, v21
    v_mul_f32 v117, v117, v21
    v_mul_f32 v118, v118, v21
    v_mul_f32 v119, v119, v21
    v_mul_f32 v120, v120, v21
    v_mul_f32 v121, v121, v21
    v_mul_f32 v122, v122, v21
    v_mul_f32 v123, v123, v21
    v_mul_f32 v124, v124, v21
    v_mul_f32 v125, v125, v21
    v_mul_f32 v126, v126, v21
    v_mul_f32 v127, v127, v21
    v_mul_f32 v128, v128, v21
    v_mul_f32 v129, v129, v21
    v_mul_f32 v130, v130, v21
    v_mul_f32 v131, v131, v21
    v_mul_f32 v132, v132, v21
    v_mul_f32 v133, v133, v21
    v_mul_f32 v134, v134, v21
    v_mul_f32 v135, v135, v21
    v_mul_f32 v136, v136, v21
    v_mul_f32 v137, v137, v21
    v_mul_f32 v138, v138, v21
    v_mul_f32 v139, v139, v21
    v_mul_f32 v140, v140, v21
    v_mul_f32 v141, v141, v21
    v_mul_f32 v142, v142, v21
    v_mul_f32 v143, v143, v21
    v_mul_f32 v144, v144, v21
    v_mul_f32 v145, v145, v21
    v_mul_f32 v146, v146, v21
    v_mul_f32 v147, v147, v21
    v_mul_f32 v148, v148, v21
    v_mul_f32 v149, v149, v21
    v_mul_f32 v150, v150, v21
    v_mul_f32 v151, v151, v21
    v_mul_f32 v152, v152, v21
    v_mul_f32 v153, v153, v21
    v_mul_f32 v154, v154, v21
    v_mul_f32 v155, v155, v21
    v_mul_f32 v156, v156, v21
    v_mul_f32 v157, v157, v21
    v_mul_f32 v158, v158, v21
    v_mul_f32 v159, v159, v21
    v_fma_f32 v104, v104, s28, v9
    v_fma_f32 v105, v105, s28, v9
    v_exp_f32 v104, v104
    v_exp_f32 v105, v105
    s_nop 0
    v_cvt_pk_bf16_f32 v18, v104, v105
    v_fma_f32 v106, v106, s28, v9
    v_fma_f32 v107, v107, s28, v9
    v_exp_f32 v106, v106
    v_exp_f32 v107, v107
    s_nop 0
    v_cvt_pk_bf16_f32 v19, v106, v107
    v_fma_f32 v108, v108, s28, v9
    v_fma_f32 v109, v109, s28, v9
    v_exp_f32 v108, v108
    v_exp_f32 v109, v109
    s_nop 0
    v_cvt_pk_bf16_f32 v16, v108, v109
    v_fma_f32 v110, v110, s28, v9
    v_fma_f32 v111, v111, s28, v9
    v_exp_f32 v110, v110
    v_exp_f32 v111, v111
    s_nop 0
    v_cvt_pk_bf16_f32 v17, v110, v111
    s_add_u32 s69, s39, 0
    buffer_load_dwordx4 v[48:51], v26, s[4:7], s69 offen offset:0
    s_waitcnt vmcnt(0)
    v_mfma_f32_16x16x32_bf16 v[104:107], v[48:51], a[120:123], 0
    s_nop 7
    buffer_load_dwordx4 v[48:51], v26, s[4:7], s69 offen offset:64
    s_waitcnt vmcnt(0)
    v_mfma_f32_16x16x32_bf16 v[104:107], v[48:51], a[124:127], v[104:107]
    s_nop 7
    buffer_load_dwordx4 v[48:51], v26, s[4:7], s69 offen offset:128
    s_waitcnt vmcnt(0)
    v_mfma_f32_16x16x32_bf16 v[104:107], v[48:51], a[128:131], v[104:107]
    s_nop 7
    buffer_load_dwordx4 v[48:51], v26, s[4:7], s69 offen offset:192
    s_waitcnt vmcnt(0)
    v_mfma_f32_16x16x32_bf16 v[104:107], v[48:51], a[132:135], v[104:107]
    s_nop 7
    buffer_load_dwordx4 v[48:51], v26, s[4:7], s69 offen offset:256
    s_waitcnt vmcnt(0)
    v_mfma_f32_16x16x32_bf16 v[104:107], v[48:51], a[136:139], v[104:107]
    s_nop 7
    buffer_load_dwordx4 v[48:51], v26, s[4:7], s69 offen offset:320
    s_waitcnt vmcnt(0)
    v_mfma_f32_16x16x32_bf16 v[104:107], v[48:51], a[140:143], v[104:107]
    s_nop 7
    s_add_u32 s69, s39, 6144
    buffer_load_dwordx4 v[48:51], v26, s[4:7], s69 offen offset:0
    s_waitcnt vmcnt(0)
    v_mfma_f32_16x16x32_bf16 v[108:111], v[48:51], a[120:123], 0
    s_nop 7
    buffer_load_dwordx4 v[48:51], v26, s[4:7], s69 offen offset:64
    s_waitcnt vmcnt(0)
    v_mfma_f32_16x16x32_bf16 v[108:111], v[48:51], a[124:127], v[108:111]
    s_nop 7
    buffer_load_dwordx4 v[48:51], v26, s[4:7], s69 offen offset:128
    s_waitcnt vmcnt(0)
    v_mfma_f32_16x16x32_bf16 v[108:111], v[48:51], a[128:131], v[108:111]
    s_nop 7
    buffer_load_dwordx4 v[48:51], v26, s[4:7], s69 offen offset:192
    s_waitcnt vmcnt(0)
    v_mfma_f32_16x16x32_bf16 v[108:111], v[48:51], a[132:135], v[108:111]
    s_nop 7
    buffer_load_dwordx4 v[48:51], v26, s[4:7], s69 offen offset:256
    s_waitcnt vmcnt(0)
    v_mfma_f32_16x16x32_bf16 v[108:111], v[48:51], a[136:139], v[108:111]
    s_nop 7
    buffer_load_dwordx4 v[48:51], v26, s[4:7], s69 offen offset:320
    s_waitcnt vmcnt(0)
    v_mfma_f32_16x16x32_bf16 v[108:111], v[48:51], a[140:143], v[108:111]
    s_nop 7
    s_nop 15
    v_max3_f32 v14, v104, v105, v106
    v_max3_f32 v14, v14, v107, v108
    v_max3_f32 v14, v14, v109, v110
    v_max_f32 v14, v14, v111
    v_mov_b32 v15, v14
    s_nop 1
    v_permlane32_swap_b32 v15, v14
    v_max_f32 v14, v14, v15
    v_mov_b32 v15, v14
    s_nop 1
    v_permlane16_swap_b32 v15, v14
    v_max_f32 v14, v14, v15
    v_fma_f32 v14, v14, s28, v10
    v_max_f32 v20, 0, v14
    v_sub_f32 v10, v10, v20
    v_sub_f32 v21, 0, v20
    v_exp_f32 v21, v21
    s_nop 0
    v_mul_f32 v45, v45, v21
    v_mul_f32 v160, v160, v21
    v_mul_f32 v161, v161, v21
    v_mul_f32 v162, v162, v21
    v_mul_f32 v163, v163, v21
    v_mul_f32 v164, v164, v21
    v_mul_f32 v165, v165, v21
    v_mul_f32 v166, v166, v21
    v_mul_f32 v167, v167, v21
    v_mul_f32 v168, v168, v21
    v_mul_f32 v169, v169, v21
    v_mul_f32 v170, v170, v21
    v_mul_f32 v171, v171, v21
    v_mul_f32 v172, v172, v21
    v_mul_f32 v173, v173, v21
    v_mul_f32 v174, v174, v21
    v_mul_f32 v175, v175, v21
    v_mul_f32 v176, v176, v21
    v_mul_f32 v177, v177, v21
    v_mul_f32 v178, v178, v21
    v_mul_f32 v179, v179, v21
    v_mul_f32 v180, v180, v21
    v_mul_f32 v181, v181, v21
    v_mul_f32 v182, v182, v21
    v_mul_f32 v183, v183, v21
    v_mul_f32 v184, v184, v21
    v_mul_f32 v185, v185, v21
    v_mul_f32 v186, v186, v21
    v_mul_f32 v187, v187, v21
    v_mul_f32 v188, v188, v21
    v_mul_f32 v189, v189, v21
    v_mul_f32 v190, v190, v21
    v_mul_f32 v191, v191, v21
    v_mul_f32 v192, v192, v21
    v_mul_f32 v193, v193, v21
    v_mul_f32 v194, v194, v21
    v_mul_f32 v195, v195, v21
    v_mul_f32 v196, v196, v21
    v_mul_f32 v197, v197, v21
    v_mul_f32 v198, v198, v21
    v_mul_f32 v199, v199, v21
    v_mul_f32 v200, v200, v21
    v_mul_f32 v201, v201, v21
    v_mul_f32 v202, v202, v21
    v_mul_f32 v203, v203, v21
    v_mul_f32 v204, v204, v21
    v_mul_f32 v205, v205, v21
    v_mul_f32 v206, v206, v21
    v_mul_f32 v207, v207, v21
    v_fma_f32 v104, v104, s28, v10
    v_fma_f32 v105, v105, s28, v10
    v_exp_f32 v104, v104
    v_exp_f32 v105, v105
    s_nop 0
    v_cvt_pk_bf16_f32 v24, v104, v105
    v_fma_f32 v106, v106, s28, v10
    v_fma_f32 v107, v107, s28, v10
    v_exp_f32 v106, v106
    v_exp_f32 v107, v107
    s_nop 0
    v_cvt_pk_bf16_f32 v25, v106, v107
    v_fma_f32 v108, v108, s28, v10
    v_fma_f32 v109, v109, s28, v10
    v_exp_f32 v108, v108
    v_exp_f32 v109, v109
    s_nop 0
    v_cvt_pk_bf16_f32 v22, v108, v109
    v_fma_f32 v110, v110, s28, v10
    v_fma_f32 v111, v111, s28, v10
    v_exp_f32 v110, v110
    v_exp_f32 v111, v111
    s_nop 0
    v_cvt_pk_bf16_f32 v23, v110, v111
    s_add_u32 s69, s39, 0
    buffer_load_dwordx4 v[48:51], v26, s[4:7], s69 offen offset:0
    s_waitcnt vmcnt(0)
    v_mfma_f32_16x16x32_bf16 v[104:107], v[48:51], a[144:147], 0
    s_nop 7
    buffer_load_dwordx4 v[48:51], v26, s[4:7], s69 offen offset:64
    s_waitcnt vmcnt(0)
    v_mfma_f32_16x16x32_bf16 v[104:107], v[48:51], a[148:151], v[104:107]
    s_nop 7
    buffer_load_dwordx4 v[48:51], v26, s[4:7], s69 offen offset:128
    s_waitcnt vmcnt(0)
    v_mfma_f32_16x16x32_bf16 v[104:107], v[48:51], a[152:155], v[104:107]
    s_nop 7
    buffer_load_dwordx4 v[48:51], v26, s[4:7], s69 offen offset:192
    s_waitcnt vmcnt(0)
    v_mfma_f32_16x16x32_bf16 v[104:107], v[48:51], a[156:159], v[104:107]
    s_nop 7
    buffer_load_dwordx4 v[48:51], v26, s[4:7], s69 offen offset:256
    s_waitcnt vmcnt(0)
    v_mfma_f32_16x16x32_bf16 v[104:107], v[48:51], a[160:163], v[104:107]
    s_nop 7
    buffer_load_dwordx4 v[48:51], v26, s[4:7], s69 offen offset:320
    s_waitcnt vmcnt(0)
    v_mfma_f32_16x16x32_bf16 v[104:107], v[48:51], a[164:167], v[104:107]
    s_nop 7
    s_add_u32 s69, s39, 6144
    buffer_load_dwordx4 v[48:51], v26, s[4:7], s69 offen offset:0
    s_waitcnt vmcnt(0)
    v_mfma_f32_16x16x32_bf16 v[108:111], v[48:51], a[144:147], 0
    s_nop 7
    buffer_load_dwordx4 v[48:51], v26, s[4:7], s69 offen offset:64
    s_waitcnt vmcnt(0)
    v_mfma_f32_16x16x32_bf16 v[108:111], v[48:51], a[148:151], v[108:111]
    s_nop 7
    buffer_load_dwordx4 v[48:51], v26, s[4:7], s69 offen offset:128
    s_waitcnt vmcnt(0)
    v_mfma_f32_16x16x32_bf16 v[108:111], v[48:51], a[152:155], v[108:111]
    s_nop 7
    buffer_load_dwordx4 v[48:51], v26, s[4:7], s69 offen offset:192
    s_waitcnt vmcnt(0)
    v_mfma_f32_16x16x32_bf16 v[108:111], v[48:51], a[156:159], v[108:111]
    s_nop 7
    buffer_load_dwordx4 v[48:51], v26, s[4:7], s69 offen offset:256
    s_waitcnt vmcnt(0)
    v_mfma_f32_16x16x32_bf16 v[108:111], v[48:51], a[160:163], v[108:111]
    s_nop 7
    buffer_load_dwordx4 v[48:51], v26, s[4:7], s69 offen offset:320
    s_waitcnt vmcnt(0)
    v_mfma_f32_16x16x32_bf16 v[108:111], v[48:51], a[164:167], v[108:111]
    s_nop 7
    s_nop 15
    v_max3_f32 v14, v104, v105, v106
    v_max3_f32 v14, v14, v107, v108
    v_max3_f32 v14, v14, v109, v110
    v_max_f32 v14, v14, v111
    v_mov_b32 v15, v14
    s_nop 1
    v_permlane32_swap_b32 v15, v14
    v_max_f32 v14, v14, v15
    v_mov_b32 v15, v14
    s_nop 1
    v_permlane16_swap_b32 v15, v14
    v_max_f32 v14, v14, v15
    v_fma_f32 v14, v14, s28, v11
    v_max_f32 v20, 0, v14
    v_sub_f32 v11, v11, v20
    v_sub_f32 v21, 0, v20
    v_exp_f32 v21, v21
    s_nop 0
    v_mul_f32 v46, v46, v21
    v_mul_f32 v208, v208, v21
    v_mul_f32 v209, v209, v21
    v_mul_f32 v210, v210, v21
    v_mul_f32 v211, v211, v21
    v_mul_f32 v212, v212, v21
    v_mul_f32 v213, v213, v21
    v_mul_f32 v214, v214, v21
    v_mul_f32 v215, v215, v21
    v_mul_f32 v216, v216, v21
    v_mul_f32 v217, v217, v21
    v_mul_f32 v218, v218, v21
    v_mul_f32 v219, v219, v21
    v_mul_f32 v220, v220, v21
    v_mul_f32 v221, v221, v21
    v_mul_f32 v222, v222, v21
    v_mul_f32 v223, v223, v21
    v_mul_f32 v224, v224, v21
    v_mul_f32 v225, v225, v21
    v_mul_f32 v226, v226, v21
    v_mul_f32 v227, v227, v21
    v_mul_f32 v228, v228, v21
    v_mul_f32 v229, v229, v21
    v_mul_f32 v230, v230, v21
    v_mul_f32 v231, v231, v21
    v_mul_f32 v232, v232, v21
    v_mul_f32 v233, v233, v21
    v_mul_f32 v234, v234, v21
    v_mul_f32 v235, v235, v21
    v_mul_f32 v236, v236, v21
    v_mul_f32 v237, v237, v21
    v_mul_f32 v238, v238, v21
    v_mul_f32 v239, v239, v21
    v_mul_f32 v240, v240, v21
    v_mul_f32 v241, v241, v21
    v_mul_f32 v242, v242, v21
    v_mul_f32 v243, v243, v21
    v_mul_f32 v244, v244, v21
    v_mul_f32 v245, v245, v21
    v_mul_f32 v246, v246, v21
    v_mul_f32 v247, v247, v21
    v_mul_f32 v248, v248, v21
    v_mul_f32 v249, v249, v21
    v_mul_f32 v250, v250, v21
    v_mul_f32 v251, v251, v21
    v_mul_f32 v252, v252, v21
    v_mul_f32 v253, v253, v21
    v_mul_f32 v254, v254, v21
    v_mul_f32 v255, v255, v21
    v_fma_f32 v104, v104, s28, v11
    v_fma_f32 v105, v105, s28, v11
    v_exp_f32 v104, v104
    v_exp_f32 v105, v105
    s_nop 0
    v_cvt_pk_bf16_f32 v30, v104, v105
    v_fma_f32 v106, v106, s28, v11
    v_fma_f32 v107, v107, s28, v11
    v_exp_f32 v106, v106
    v_exp_f32 v107, v107
    s_nop 0
    v_cvt_pk_bf16_f32 v31, v106, v107
    v_fma_f32 v108, v108, s28, v11
    v_fma_f32 v109, v109, s28, v11
    v_exp_f32 v108, v108
    v_exp_f32 v109, v109
    s_nop 0
    v_cvt_pk_bf16_f32 v28, v108, v109
    v_fma_f32 v110, v110, s28, v11
    v_fma_f32 v111, v111, s28, v11
    v_exp_f32 v110, v110
    v_exp_f32 v111, v111
    s_nop 0
    v_cvt_pk_bf16_f32 v29, v110, v111
    s_add_u32 s69, s39, 0
    buffer_load_dwordx4 v[48:51], v26, s[4:7], s69 offen offset:0
    s_waitcnt vmcnt(0)
    v_mfma_f32_16x16x32_bf16 v[104:107], v[48:51], a[168:171], 0
    s_nop 7
    buffer_load_dwordx4 v[48:51], v26, s[4:7], s69 offen offset:64
    s_waitcnt vmcnt(0)
    v_mfma_f32_16x16x32_bf16 v[104:107], v[48:51], a[172:175], v[104:107]
    s_nop 7
    buffer_load_dwordx4 v[48:51], v26, s[4:7], s69 offen offset:128
    s_waitcnt vmcnt(0)
    v_mfma_f32_16x16x32_bf16 v[104:107], v[48:51], a[176:179], v[104:107]
    s_nop 7
    buffer_load_dwordx4 v[48:51], v26, s[4:7], s69 offen offset:192
    s_waitcnt vmcnt(0)
    v_mfma_f32_16x16x32_bf16 v[104:107], v[48:51], a[180:183], v[104:107]
    s_nop 7
    buffer_load_dwordx4 v[48:51], v26, s[4:7], s69 offen offset:256
    s_waitcnt vmcnt(0)
    v_mfma_f32_16x16x32_bf16 v[104:107], v[48:51], a[184:187], v[104:107]
    s_nop 7
    buffer_load_dwordx4 v[48:51], v26, s[4:7], s69 offen offset:320
    s_waitcnt vmcnt(0)
    v_mfma_f32_16x16x32_bf16 v[104:107], v[48:51], a[188:191], v[104:107]
    s_nop 7
    s_add_u32 s69, s39, 6144
    buffer_load_dwordx4 v[48:51], v26, s[4:7], s69 offen offset:0
    s_waitcnt vmcnt(0)
    v_mfma_f32_16x16x32_bf16 v[108:111], v[48:51], a[168:171], 0
    s_nop 7
    buffer_load_dwordx4 v[48:51], v26, s[4:7], s69 offen offset:64
    s_waitcnt vmcnt(0)
    v_mfma_f32_16x16x32_bf16 v[108:111], v[48:51], a[172:175], v[108:111]
    s_nop 7
    buffer_load_dwordx4 v[48:51], v26, s[4:7], s69 offen offset:128
    s_waitcnt vmcnt(0)
    v_mfma_f32_16x16x32_bf16 v[108:111], v[48:51], a[176:179], v[108:111]
    s_nop 7
    buffer_load_dwordx4 v[48:51], v26, s[4:7], s69 offen offset:192
    s_waitcnt vmcnt(0)
    v_mfma_f32_16x16x32_bf16 v[108:111], v[48:51], a[180:183], v[108:111]
    s_nop 7
    buffer_load_dwordx4 v[48:51], v26, s[4:7], s69 offen offset:256
    s_waitcnt vmcnt(0)
    v_mfma_f32_16x16x32_bf16 v[108:111], v[48:51], a[184:187], v[108:111]
    s_nop 7
    buffer_load_dwordx4 v[48:51], v26, s[4:7], s69 offen offset:320
    s_waitcnt vmcnt(0)
    v_mfma_f32_16x16x32_bf16 v[108:111], v[48:51], a[188:191], v[108:111]
    s_nop 7
    s_nop 15
    v_max3_f32 v14, v104, v105, v106
    v_max3_f32 v14, v14, v107, v108
    v_max3_f32 v14, v14, v109, v110
    v_max_f32 v14, v14, v111
    v_mov_b32 v15, v14
    s_nop 1
    v_permlane32_swap_b32 v15, v14
    v_max_f32 v14, v14, v15
    v_mov_b32 v15, v14
    s_nop 1
    v_permlane16_swap_b32 v15, v14
    v_max_f32 v14, v14, v15
    v_fma_f32 v14, v14, s28, v12
    v_max_f32 v20, 0, v14
    v_sub_f32 v12, v12, v20
    v_sub_f32 v21, 0, v20
    v_exp_f32 v21, v21
    s_nop 0
    v_mul_f32 v47, v47, v21
    v_accvgpr_read_b32 v15, a0
    v_mul_f32 v15, v15, v21
    v_accvgpr_write_b32 a0, v15
    v_accvgpr_read_b32 v15, a1
    v_mul_f32 v15, v15, v21
    v_accvgpr_write_b32 a1, v15
    v_accvgpr_read_b32 v15, a2
    v_mul_f32 v15, v15, v21
    v_accvgpr_write_b32 a2, v15
    v_accvgpr_read_b32 v15, a3
    v_mul_f32 v15, v15, v21
    v_accvgpr_write_b32 a3, v15
    v_accvgpr_read_b32 v15, a4
    v_mul_f32 v15, v15, v21
    v_accvgpr_write_b32 a4, v15
    v_accvgpr_read_b32 v15, a5
    v_mul_f32 v15, v15, v21
    v_accvgpr_write_b32 a5, v15
    v_accvgpr_read_b32 v15, a6
    v_mul_f32 v15, v15, v21
    v_accvgpr_write_b32 a6, v15
    v_accvgpr_read_b32 v15, a7
    v_mul_f32 v15, v15, v21
    v_accvgpr_write_b32 a7, v15
    v_accvgpr_read_b32 v15, a8
    v_mul_f32 v15, v15, v21
    v_accvgpr_write_b32 a8, v15
    v_accvgpr_read_b32 v15, a9
    v_mul_f32 v15, v15, v21
    v_accvgpr_write_b32 a9, v15
    v_accvgpr_read_b32 v15, a10
    v_mul_f32 v15, v15, v21
    v_accvgpr_write_b32 a10, v15
    v_accvgpr_read_b32 v15, a11
    v_mul_f32 v15, v15, v21
    v_accvgpr_write_b32 a11, v15
    v_accvgpr_read_b32 v15, a12
    v_mul_f32 v15, v15, v21
    v_accvgpr_write_b32 a12, v15
    v_accvgpr_read_b32 v15, a13
    v_mul_f32 v15, v15, v21
    v_accvgpr_write_b32 a13, v15
    v_accvgpr_read_b32 v15, a14
    v_mul_f32 v15, v15, v21
    v_accvgpr_write_b32 a14, v15
    v_accvgpr_read_b32 v15, a15
    v_mul_f32 v15, v15, v21
    v_accvgpr_write_b32 a15, v15
    v_accvgpr_read_b32 v15, a16
    v_mul_f32 v15, v15, v21
    v_accvgpr_write_b32 a16, v15
    v_accvgpr_read_b32 v15, a17
    v_mul_f32 v15, v15, v21
    v_accvgpr_write_b32 a17, v15
    v_accvgpr_read_b32 v15, a18
    v_mul_f32 v15, v15, v21
    v_accvgpr_write_b32 a18, v15
    v_accvgpr_read_b32 v15, a19
    v_mul_f32 v15, v15, v21
    v_accvgpr_write_b32 a19, v15
    v_accvgpr_read_b32 v15, a20
    v_mul_f32 v15, v15, v21
    v_accvgpr_write_b32 a20, v15
    v_accvgpr_read_b32 v15, a21
    v_mul_f32 v15, v15, v21
    v_accvgpr_write_b32 a21, v15
    v_accvgpr_read_b32 v15, a22
    v_mul_f32 v15, v15, v21
    v_accvgpr_write_b32 a22, v15
    v_accvgpr_read_b32 v15, a23
    v_mul_f32 v15, v15, v21
    v_accvgpr_write_b32 a23, v15
    v_accvgpr_read_b32 v15, a24
    v_mul_f32 v15, v15, v21
    v_accvgpr_write_b32 a24, v15
    v_accvgpr_read_b32 v15, a25
    v_mul_f32 v15, v15, v21
    v_accvgpr_write_b32 a25, v15
    v_accvgpr_read_b32 v15, a26
    v_mul_f32 v15, v15, v21
    v_accvgpr_write_b32 a26, v15
    v_accvgpr_read_b32 v15, a27
    v_mul_f32 v15, v15, v21
    v_accvgpr_write_b32 a27, v15
    v_accvgpr_read_b32 v15, a28
    v_mul_f32 v15, v15, v21
    v_accvgpr_write_b32 a28, v15
    v_accvgpr_read_b32 v15, a29
    v_mul_f32 v15, v15, v21
    v_accvgpr_write_b32 a29, v15
    v_accvgpr_read_b32 v15, a30
    v_mul_f32 v15, v15, v21
    v_accvgpr_write_b32 a30, v15
    v_accvgpr_read_b32 v15, a31
    v_mul_f32 v15, v15, v21
    v_accvgpr_write_b32 a31, v15
    v_accvgpr_read_b32 v15, a32
    v_mul_f32 v15, v15, v21
    v_accvgpr_write_b32 a32, v15
    v_accvgpr_read_b32 v15, a33
    v_mul_f32 v15, v15, v21
    v_accvgpr_write_b32 a33, v15
    v_accvgpr_read_b32 v15, a34
    v_mul_f32 v15, v15, v21
    v_accvgpr_write_b32 a34, v15
    v_accvgpr_read_b32 v15, a35
    v_mul_f32 v15, v15, v21
    v_accvgpr_write_b32 a35, v15
    v_accvgpr_read_b32 v15, a36
    v_mul_f32 v15, v15, v21
    v_accvgpr_write_b32 a36, v15
    v_accvgpr_read_b32 v15, a37
    v_mul_f32 v15, v15, v21
    v_accvgpr_write_b32 a37, v15
    v_accvgpr_read_b32 v15, a38
    v_mul_f32 v15, v15, v21
    v_accvgpr_write_b32 a38, v15
    v_accvgpr_read_b32 v15, a39
    v_mul_f32 v15, v15, v21
    v_accvgpr_write_b32 a39, v15
    v_accvgpr_read_b32 v15, a40
    v_mul_f32 v15, v15, v21
    v_accvgpr_write_b32 a40, v15
    v_accvgpr_read_b32 v15, a41
    v_mul_f32 v15, v15, v21
    v_accvgpr_write_b32 a41, v15
    v_accvgpr_read_b32 v15, a42
    v_mul_f32 v15, v15, v21
    v_accvgpr_write_b32 a42, v15
    v_accvgpr_read_b32 v15, a43
    v_mul_f32 v15, v15, v21
    v_accvgpr_write_b32 a43, v15
    v_accvgpr_read_b32 v15, a44
    v_mul_f32 v15, v15, v21
    v_accvgpr_write_b32 a44, v15
    v_accvgpr_read_b32 v15, a45
    v_mul_f32 v15, v15, v21
    v_accvgpr_write_b32 a45, v15
    v_accvgpr_read_b32 v15, a46
    v_mul_f32 v15, v15, v21
    v_accvgpr_write_b32 a46, v15
    v_accvgpr_read_b32 v15, a47
    v_mul_f32 v15, v15, v21
    v_accvgpr_write_b32 a47, v15
    v_fma_f32 v104, v104, s28, v12
    v_fma_f32 v105, v105, s28, v12
    v_exp_f32 v104, v104
    v_exp_f32 v105, v105
    s_nop 0
    v_cvt_pk_bf16_f32 v36, v104, v105
    v_fma_f32 v106, v106, s28, v12
    v_fma_f32 v107, v107, s28, v12
    v_exp_f32 v106, v106
    v_exp_f32 v107, v107
    s_nop 0
    v_cvt_pk_bf16_f32 v37, v106, v107
    v_fma_f32 v108, v108, s28, v12
    v_fma_f32 v109, v109, s28, v12
    v_exp_f32 v108, v108
    v_exp_f32 v109, v109
    s_nop 0
    v_cvt_pk_bf16_f32 v34, v108, v109
    v_fma_f32 v110, v110, s28, v12
    v_fma_f32 v111, v111, s28, v12
    v_exp_f32 v110, v110
    v_exp_f32 v111, v111
    s_nop 0
    v_cvt_pk_bf16_f32 v35, v110, v111
    s_add_u32 s69, s39, 0
    buffer_load_dwordx4 v[48:51], v26, s[4:7], s69 offen offset:0
    s_waitcnt vmcnt(0)
    v_mfma_f32_16x16x32_bf16 v[104:107], v[48:51], a[192:195], 0
    s_nop 7
    buffer_load_dwordx4 v[48:51], v26, s[4:7], s69 offen offset:64
    s_waitcnt vmcnt(0)
    v_mfma_f32_16x16x32_bf16 v[104:107], v[48:51], a[196:199], v[104:107]
    s_nop 7
    buffer_load_dwordx4 v[48:51], v26, s[4:7], s69 offen offset:128
    s_waitcnt vmcnt(0)
    v_mfma_f32_16x16x32_bf16 v[104:107], v[48:51], a[200:203], v[104:107]
    s_nop 7
    buffer_load_dwordx4 v[48:51], v26, s[4:7], s69 offen offset:192
    s_waitcnt vmcnt(0)
    v_mfma_f32_16x16x32_bf16 v[104:107], v[48:51], a[204:207], v[104:107]
    s_nop 7
    buffer_load_dwordx4 v[48:51], v26, s[4:7], s69 offen offset:256
    s_waitcnt vmcnt(0)
    v_mfma_f32_16x16x32_bf16 v[104:107], v[48:51], a[208:211], v[104:107]
    s_nop 7
    buffer_load_dwordx4 v[48:51], v26, s[4:7], s69 offen offset:320
    s_waitcnt vmcnt(0)
    v_mfma_f32_16x16x32_bf16 v[104:107], v[48:51], v[92:95], v[104:107]
    s_nop 7
    s_add_u32 s69, s39, 6144
    buffer_load_dwordx4 v[48:51], v26, s[4:7], s69 offen offset:0
    s_waitcnt vmcnt(0)
    v_mfma_f32_16x16x32_bf16 v[108:111], v[48:51], a[192:195], 0
    s_nop 7
    buffer_load_dwordx4 v[48:51], v26, s[4:7], s69 offen offset:64
    s_waitcnt vmcnt(0)
    v_mfma_f32_16x16x32_bf16 v[108:111], v[48:51], a[196:199], v[108:111]
    s_nop 7
    buffer_load_dwordx4 v[48:51], v26, s[4:7], s69 offen offset:128
    s_waitcnt vmcnt(0)
    v_mfma_f32_16x16x32_bf16 v[108:111], v[48:51], a[200:203], v[108:111]
    s_nop 7
    buffer_load_dwordx4 v[48:51], v26, s[4:7], s69 offen offset:192
    s_waitcnt vmcnt(0)
    v_mfma_f32_16x16x32_bf16 v[108:111], v[48:51], a[204:207], v[108:111]
    s_nop 7
    buffer_load_dwordx4 v[48:51], v26, s[4:7], s69 offen offset:256
    s_waitcnt vmcnt(0)
    v_mfma_f32_16x16x32_bf16 v[108:111], v[48:51], a[208:211], v[108:111]
    s_nop 7
    buffer_load_dwordx4 v[48:51], v26, s[4:7], s69 offen offset:320
    s_waitcnt vmcnt(0)
    v_mfma_f32_16x16x32_bf16 v[108:111], v[48:51], v[92:95], v[108:111]
    s_nop 7
    s_nop 15
    v_max3_f32 v14, v104, v105, v106
    v_max3_f32 v14, v14, v107, v108
    v_max3_f32 v14, v14, v109, v110
    v_max_f32 v14, v14, v111
    v_mov_b32 v15, v14
    s_nop 1
    v_permlane32_swap_b32 v15, v14
    v_max_f32 v14, v14, v15
    v_mov_b32 v15, v14
    s_nop 1
    v_permlane16_swap_b32 v15, v14
    v_max_f32 v14, v14, v15
    v_fma_f32 v14, v14, s28, v13
    v_max_f32 v20, 0, v14
    v_sub_f32 v13, v13, v20
    v_sub_f32 v21, 0, v20
    v_exp_f32 v21, v21
    s_nop 0
    v_mul_f32 v15, v44, v21
    v_cndmask_b32_e64 v44, v44, v15, s[60:61]
    v_accvgpr_read_b32 v15, a48
    v_mul_f32 v15, v15, v21
    v_accvgpr_write_b32 a48, v15
    v_accvgpr_read_b32 v15, a49
    v_mul_f32 v15, v15, v21
    v_accvgpr_write_b32 a49, v15
    v_accvgpr_read_b32 v15, a50
    v_mul_f32 v15, v15, v21
    v_accvgpr_write_b32 a50, v15
    v_accvgpr_read_b32 v15, a51
    v_mul_f32 v15, v15, v21
    v_accvgpr_write_b32 a51, v15
    v_accvgpr_read_b32 v15, a52
    v_mul_f32 v15, v15, v21
    v_accvgpr_write_b32 a52, v15
    v_accvgpr_read_b32 v15, a53
    v_mul_f32 v15, v15, v21
    v_accvgpr_write_b32 a53, v15
    v_accvgpr_read_b32 v15, a54
    v_mul_f32 v15, v15, v21
    v_accvgpr_write_b32 a54, v15
    v_accvgpr_read_b32 v15, a55
    v_mul_f32 v15, v15, v21
    v_accvgpr_write_b32 a55, v15
    v_accvgpr_read_b32 v15, a56
    v_mul_f32 v15, v15, v21
    v_accvgpr_write_b32 a56, v15
    v_accvgpr_read_b32 v15, a57
    v_mul_f32 v15, v15, v21
    v_accvgpr_write_b32 a57, v15
    v_accvgpr_read_b32 v15, a58
    v_mul_f32 v15, v15, v21
    v_accvgpr_write_b32 a58, v15
    v_accvgpr_read_b32 v15, a59
    v_mul_f32 v15, v15, v21
    v_accvgpr_write_b32 a59, v15
    v_accvgpr_read_b32 v15, a60
    v_mul_f32 v15, v15, v21
    v_accvgpr_write_b32 a60, v15
    v_accvgpr_read_b32 v15, a61
    v_mul_f32 v15, v15, v21
    v_accvgpr_write_b32 a61, v15
    v_accvgpr_read_b32 v15, a62
    v_mul_f32 v15, v15, v21
    v_accvgpr_write_b32 a62, v15
    v_accvgpr_read_b32 v15, a63
    v_mul_f32 v15, v15, v21
    v_accvgpr_write_b32 a63, v15
    v_accvgpr_read_b32 v15, a64
    v_mul_f32 v15, v15, v21
    v_accvgpr_write_b32 a64, v15
    v_accvgpr_read_b32 v15, a65
    v_mul_f32 v15, v15, v21
    v_accvgpr_write_b32 a65, v15
    v_accvgpr_read_b32 v15, a66
    v_mul_f32 v15, v15, v21
    v_accvgpr_write_b32 a66, v15
    v_accvgpr_read_b32 v15, a67
    v_mul_f32 v15, v15, v21
    v_accvgpr_write_b32 a67, v15
    v_accvgpr_read_b32 v15, a68
    v_mul_f32 v15, v15, v21
    v_accvgpr_write_b32 a68, v15
    v_accvgpr_read_b32 v15, a69
    v_mul_f32 v15, v15, v21
    v_accvgpr_write_b32 a69, v15
    v_accvgpr_read_b32 v15, a70
    v_mul_f32 v15, v15, v21
    v_accvgpr_write_b32 a70, v15
    v_accvgpr_read_b32 v15, a71
    v_mul_f32 v15, v15, v21
    v_accvgpr_write_b32 a71, v15
    v_accvgpr_read_b32 v15, a72
    v_mul_f32 v15, v15, v21
    v_accvgpr_write_b32 a72, v15
    v_accvgpr_read_b32 v15, a73
    v_mul_f32 v15, v15, v21
    v_accvgpr_write_b32 a73, v15
    v_accvgpr_read_b32 v15, a74
    v_mul_f32 v15, v15, v21
    v_accvgpr_write_b32 a74, v15
    v_accvgpr_read_b32 v15, a75
    v_mul_f32 v15, v15, v21
    v_accvgpr_write_b32 a75, v15
    v_accvgpr_read_b32 v15, a76
    v_mul_f32 v15, v15, v21
    v_accvgpr_write_b32 a76, v15
    v_accvgpr_read_b32 v15, a77
    v_mul_f32 v15, v15, v21
    v_accvgpr_write_b32 a77, v15
    v_accvgpr_read_b32 v15, a78
    v_mul_f32 v15, v15, v21
    v_accvgpr_write_b32 a78, v15
    v_accvgpr_read_b32 v15, a79
    v_mul_f32 v15, v15, v21
    v_accvgpr_write_b32 a79, v15
    v_accvgpr_read_b32 v15, a80
    v_mul_f32 v15, v15, v21
    v_accvgpr_write_b32 a80, v15
    v_accvgpr_read_b32 v15, a81
    v_mul_f32 v15, v15, v21
    v_accvgpr_write_b32 a81, v15
    v_accvgpr_read_b32 v15, a82
    v_mul_f32 v15, v15, v21
    v_accvgpr_write_b32 a82, v15
    v_accvgpr_read_b32 v15, a83
    v_mul_f32 v15, v15, v21
    v_accvgpr_write_b32 a83, v15
    v_accvgpr_read_b32 v15, a84
    v_mul_f32 v15, v15, v21
    v_accvgpr_write_b32 a84, v15
    v_accvgpr_read_b32 v15, a85
    v_mul_f32 v15, v15, v21
    v_accvgpr_write_b32 a85, v15
    v_accvgpr_read_b32 v15, a86
    v_mul_f32 v15, v15, v21
    v_accvgpr_write_b32 a86, v15
    v_accvgpr_read_b32 v15, a87
    v_mul_f32 v15, v15, v21
    v_accvgpr_write_b32 a87, v15
    v_accvgpr_read_b32 v15, a88
    v_mul_f32 v15, v15, v21
    v_accvgpr_write_b32 a88, v15
    v_accvgpr_read_b32 v15, a89
    v_mul_f32 v15, v15, v21
    v_accvgpr_write_b32 a89, v15
    v_accvgpr_read_b32 v15, a90
    v_mul_f32 v15, v15, v21
    v_accvgpr_write_b32 a90, v15
    v_accvgpr_read_b32 v15, a91
    v_mul_f32 v15, v15, v21
    v_accvgpr_write_b32 a91, v15
    v_accvgpr_read_b32 v15, a92
    v_mul_f32 v15, v15, v21
    v_accvgpr_write_b32 a92, v15
    v_accvgpr_read_b32 v15, a93
    v_mul_f32 v15, v15, v21
    v_accvgpr_write_b32 a93, v15
    v_accvgpr_read_b32 v15, a94
    v_mul_f32 v15, v15, v21
    v_accvgpr_write_b32 a94, v15
    v_accvgpr_read_b32 v15, a95
    v_mul_f32 v15, v15, v21
    v_accvgpr_write_b32 a95, v15
    v_fma_f32 v104, v104, s28, v13
    v_fma_f32 v105, v105, s28, v13
    v_exp_f32 v104, v104
    v_exp_f32 v105, v105
    s_nop 0
    v_cvt_pk_bf16_f32 v42, v104, v105
    v_fma_f32 v106, v106, s28, v13
    v_fma_f32 v107, v107, s28, v13
    v_exp_f32 v106, v106
    v_exp_f32 v107, v107
    s_nop 0
    v_cvt_pk_bf16_f32 v43, v106, v107
    v_fma_f32 v108, v108, s28, v13
    v_fma_f32 v109, v109, s28, v13
    v_exp_f32 v108, v108
    v_exp_f32 v109, v109
    s_nop 0
    v_cvt_pk_bf16_f32 v40, v108, v109
    v_fma_f32 v110, v110, s28, v13
    v_fma_f32 v111, v111, s28, v13
    v_exp_f32 v110, v110
    v_exp_f32 v111, v111
    s_nop 0
    v_cvt_pk_bf16_f32 v41, v110, v111
    v_mfma_f32_16x16x32_bf16 v[48:51], a[236:239], v[16:19], v[44:47]
    v_mfma_f32_16x16x32_bf16 v[48:51], a[240:243], v[22:25], v[48:51]
    v_mfma_f32_16x16x32_bf16 v[48:51], a[244:247], v[28:31], v[48:51]
    v_mfma_f32_16x16x32_bf16 v[48:51], a[248:251], v[34:37], v[48:51]
    v_mfma_f32_16x16x32_bf16 v[48:51], a[252:255], v[40:43], v[48:51]
    s_nop 15
    s_setpc_b64 s[40:41]
L_rare4_0:
    s_nop 15
    v_mbcnt_lo_u32_b32 v31, -1, 0
    v_mbcnt_hi_u32_b32 v31, -1, v31
    v_and_b32 v30, 15, v31
    v_mul_u32_u24 v30, 384, v30
    v_lshrrev_b32 v31, 4, v31
    v_lshl_add_u32 v30, v31, 4, v30
    s_add_u32 s69, s39, 0
    buffer_load_dwordx4 v[44:47], v30, s[4:7], s69 offen offset:0
    s_waitcnt vmcnt(0)
    v_mfma_f32_16x16x32_bf16 v[104:107], v[44:47], a[96:99], 0
    s_nop 7
    buffer_load_dwordx4 v[44:47], v30, s[4:7], s69 offen offset:64
    s_waitcnt vmcnt(0)
    v_mfma_f32_16x16x32_bf16 v[104:107], v[44:47], a[100:103], v[104:107]
    s_nop 7
    buffer_load_dwordx4 v[44:47], v30, s[4:7], s69 offen offset:128
    s_waitcnt vmcnt(0)
    v_mfma_f32_16x16x32_bf16 v[104:107], v[44:47], a[104:107], v[104:107]
    s_nop 7
    buffer_load_dwordx4 v[44:47], v30, s[4:7], s69 offen offset:192
    s_waitcnt vmcnt(0)
    v_mfma_f32_16x16x32_bf16 v[104:107], v[44:47], a[108:111], v[104:107]
    s_nop 7
    buffer_load_dwordx4 v[44:47], v30, s[4:7], s69 offen offset:256
    s_waitcnt vmcnt(0)
    v_mfma_f32_16x16x32_bf16 v[104:107], v[44:47], a[112:115], v[104:107]
    s_nop 7
    buffer_load_dwordx4 v[44:47], v30, s[4:7], s69 offen offset:320
    s_waitcnt vmcnt(0)
    v_mfma_f32_16x16x32_bf16 v[104:107], v[44:47], a[116:119], v[104:107]
    s_nop 7
    s_add_u32 s69, s39, 6144
    buffer_load_dwordx4 v[44:47], v30, s[4:7], s69 offen offset:0
    s_waitcnt vmcnt(0)
    v_mfma_f32_16x16x32_bf16 v[108:111], v[44:47], a[96:99], 0
    s_nop 7
    buffer_load_dwordx4 v[44:47], v30, s[4:7], s69 offen offset:64
    s_waitcnt vmcnt(0)
    v_mfma_f32_16x16x32_bf16 v[108:111], v[44:47], a[100:103], v[108:111]
    s_nop 7
    buffer_load_dwordx4 v[44:47], v30, s[4:7], s69 offen offset:128
    s_waitcnt vmcnt(0)
    v_mfma_f32_16x16x32_bf16 v[108:111], v[44:47], a[104:107], v[108:111]
    s_nop 7
    buffer_load_dwordx4 v[44:47], v30, s[4:7], s69 offen offset:192
    s_waitcnt vmcnt(0)
    v_mfma_f32_16x16x32_bf16 v[108:111], v[44:47], a[108:111], v[108:111]
    s_nop 7
    buffer_load_dwordx4 v[44:47], v30, s[4:7], s69 offen offset:256
    s_waitcnt vmcnt(0)
    v_mfma_f32_16x16x32_bf16 v[108:111], v[44:47], a[112:115], v[108:111]
    s_nop 7
    buffer_load_dwordx4 v[44:47], v30, s[4:7], s69 offen offset:320
    s_waitcnt vmcnt(0)
    v_mfma_f32_16x16x32_bf16 v[108:111], v[44:47], a[116:119], v[108:111]
    s_nop 7
    s_nop 15
    v_max3_f32 v18, v104, v105, v106
    v_max3_f32 v18, v18, v107, v108
    v_max3_f32 v18, v18, v109, v110
    v_max_f32 v18, v18, v111
    v_mov_b32 v19, v18
    s_nop 1
    v_permlane32_swap_b32 v19, v18
    v_max_f32 v18, v18, v19
    v_mov_b32 v19, v18
    s_nop 1
    v_permlane16_swap_b32 v19, v18
    v_max_f32 v18, v18, v19
    v_fma_f32 v18, v18, s28, v9
    v_max_f32 v24, 0, v18
    v_sub_f32 v9, v9, v24
    v_sub_f32 v25, 0, v24
    v_exp_f32 v25, v25
    s_nop 0
    v_mul_f32 v19, v48, v25
    v_cndmask_b32_e64 v48, v19, v48, s[60:61]
    v_cndmask_b32_e64 v48, v48, 0, s[46:47]
    v_mul_f32 v112, v112, v25
    v_mul_f32 v113, v113, v25
    v_mul_f32 v114, v114, v25
    v_mul_f32 v115, v115, v25
    v_mul_f32 v116, v116, v25
    v_mul_f32 v117, v117, v25
    v_mul_f32 v118, v118, v25
    v_mul_f32 v119, v119, v25
    v_mul_f32 v120, v120, v25
    v_mul_f32 v121, v121, v25
    v_mul_f32 v122, v122, v25
    v_mul_f32 v123, v123, v25
    v_mul_f32 v124, v124, v25
    v_mul_f32 v125, v125, v25
    v_mul_f32 v126, v126, v25
    v_mul_f32 v127, v127, v25
    v_mul_f32 v128, v128, v25
    v_mul_f32 v129, v129, v25
    v_mul_f32 v130, v130, v25
    v_mul_f32 v131, v131, v25
    v_mul_f32 v132, v132, v25
    v_mul_f32 v133, v133, v25
    v_mul_f32 v134, v134, v25
    v_mul_f32 v135, v135, v25
    v_mul_f32 v136, v136, v25
    v_mul_f32 v137, v137, v25
    v_mul_f32 v138, v138, v25
    v_mul_f32 v139, v139, v25
    v_mul_f32 v140, v140, v25
    v_mul_f32 v141, v141, v25
    v_mul_f32 v142, v142, v25
    v_mul_f32 v143, v143, v25
    v_mul_f32 v144, v144, v25
    v_mul_f32 v145, v145, v25
    v_mul_f32 v146, v146, v25
    v_mul_f32 v147, v147, v25
    v_mul_f32 v148, v148, v25
    v_mul_f32 v149, v149, v25
    v_mul_f32 v150, v150, v25
    v_mul_f32 v151, v151, v25
    v_mul_f32 v152, v152, v25
    v_mul_f32 v153, v153, v25
    v_mul_f32 v154, v154, v25
    v_mul_f32 v155, v155, v25
    v_mul_f32 v156, v156, v25
    v_mul_f32 v157, v157, v25
    v_mul_f32 v158, v158, v25
    v_mul_f32 v159, v159, v25
    v_fma_f32 v104, v104, s28, v9
    v_fma_f32 v105, v105, s28, v9
    v_exp_f32 v104, v104
    v_exp_f32 v105, v105
    s_nop 0
    v_cvt_pk_bf16_f32 v14, v104, v105
    v_fma_f32 v106, v106, s28, v9
    v_fma_f32 v107, v107, s28, v9
    v_exp_f32 v106, v106
    v_exp_f32 v107, v107
    s_nop 0
    v_cvt_pk_bf16_f32 v15, v106, v107
    v_fma_f32 v108, v108, s28, v9
    v_fma_f32 v109, v109, s28, v9
    v_exp_f32 v108, v108
    v_exp_f32 v109, v109
    s_nop 0
    v_cvt_pk_bf16_f32 v16, v108, v109
    v_fma_f32 v110, v110, s28, v9
    v_fma_f32 v111, v111, s28, v9
    v_exp_f32 v110, v110
    v_exp_f32 v111, v111
    s_nop 0
    v_cvt_pk_bf16_f32 v17, v110, v111
    s_add_u32 s69, s39, 0
    buffer_load_dwordx4 v[44:47], v30, s[4:7], s69 offen offset:0
    s_waitcnt vmcnt(0)
    v_mfma_f32_16x16x32_bf16 v[104:107], v[44:47], a[120:123], 0
    s_nop 7
    buffer_load_dwordx4 v[44:47], v30, s[4:7], s69 offen offset:64
    s_waitcnt vmcnt(0)
    v_mfma_f32_16x16x32_bf16 v[104:107], v[44:47], a[124:127], v[104:107]
    s_nop 7
    buffer_load_dwordx4 v[44:47], v30, s[4:7], s69 offen offset:128
    s_waitcnt vmcnt(0)
    v_mfma_f32_16x16x32_bf16 v[104:107], v[44:47], a[128:131], v[104:107]
    s_nop 7
    buffer_load_dwordx4 v[44:47], v30, s[4:7], s69 offen offset:192
    s_waitcnt vmcnt(0)
    v_mfma_f32_16x16x32_bf16 v[104:107], v[44:47], a[132:135], v[104:107]
    s_nop 7
    buffer_load_dwordx4 v[44:47], v30, s[4:7], s69 offen offset:256
    s_waitcnt vmcnt(0)
    v_mfma_f32_16x16x32_bf16 v[104:107], v[44:47], a[136:139], v[104:107]
    s_nop 7
    buffer_load_dwordx4 v[44:47], v30, s[4:7], s69 offen offset:320
    s_waitcnt vmcnt(0)
    v_mfma_f32_16x16x32_bf16 v[104:107], v[44:47], a[140:143], v[104:107]
    s_nop 7
    s_add_u32 s69, s39, 6144
    buffer_load_dwordx4 v[44:47], v30, s[4:7], s69 offen offset:0
    s_waitcnt vmcnt(0)
    v_mfma_f32_16x16x32_bf16 v[108:111], v[44:47], a[120:123], 0
    s_nop 7
    buffer_load_dwordx4 v[44:47], v30, s[4:7], s69 offen offset:64
    s_waitcnt vmcnt(0)
    v_mfma_f32_16x16x32_bf16 v[108:111], v[44:47], a[124:127], v[108:111]
    s_nop 7
    buffer_load_dwordx4 v[44:47], v30, s[4:7], s69 offen offset:128
    s_waitcnt vmcnt(0)
    v_mfma_f32_16x16x32_bf16 v[108:111], v[44:47], a[128:131], v[108:111]
    s_nop 7
    buffer_load_dwordx4 v[44:47], v30, s[4:7], s69 offen offset:192
    s_waitcnt vmcnt(0)
    v_mfma_f32_16x16x32_bf16 v[108:111], v[44:47], a[132:135], v[108:111]
    s_nop 7
    buffer_load_dwordx4 v[44:47], v30, s[4:7], s69 offen offset:256
    s_waitcnt vmcnt(0)
    v_mfma_f32_16x16x32_bf16 v[108:111], v[44:47], a[136:139], v[108:111]
    s_nop 7
    buffer_load_dwordx4 v[44:47], v30, s[4:7], s69 offen offset:320
    s_waitcnt vmcnt(0)
    v_mfma_f32_16x16x32_bf16 v[108:111], v[44:47], a[140:143], v[108:111]
    s_nop 7
    s_nop 15
    v_max3_f32 v18, v104, v105, v106
    v_max3_f32 v18, v18, v107, v108
    v_max3_f32 v18, v18, v109, v110
    v_max_f32 v18, v18, v111
    v_mov_b32 v19, v18
    s_nop 1
    v_permlane32_swap_b32 v19, v18
    v_max_f32 v18, v18, v19
    v_mov_b32 v19, v18
    s_nop 1
    v_permlane16_swap_b32 v19, v18
    v_max_f32 v18, v18, v19
    v_fma_f32 v18, v18, s28, v10
    v_max_f32 v24, 0, v18
    v_sub_f32 v10, v10, v24
    v_sub_f32 v25, 0, v24
    v_exp_f32 v25, v25
    s_nop 0
    v_mul_f32 v49, v49, v25
    v_mul_f32 v160, v160, v25
    v_mul_f32 v161, v161, v25
    v_mul_f32 v162, v162, v25
    v_mul_f32 v163, v163, v25
    v_mul_f32 v164, v164, v25
    v_mul_f32 v165, v165, v25
    v_mul_f32 v166, v166, v25
    v_mul_f32 v167, v167, v25
    v_mul_f32 v168, v168, v25
    v_mul_f32 v169, v169, v25
    v_mul_f32 v170, v170, v25
    v_mul_f32 v171, v171, v25
    v_mul_f32 v172, v172, v25
    v_mul_f32 v173, v173, v25
    v_mul_f32 v174, v174, v25
    v_mul_f32 v175, v175, v25
    v_mul_f32 v176, v176, v25
    v_mul_f32 v177, v177, v25
    v_mul_f32 v178, v178, v25
    v_mul_f32 v179, v179, v25
    v_mul_f32 v180, v180, v25
    v_mul_f32 v181, v181, v25
    v_mul_f32 v182, v182, v25
    v_mul_f32 v183, v183, v25
    v_mul_f32 v184, v184, v25
    v_mul_f32 v185, v185, v25
    v_mul_f32 v186, v186, v25
    v_mul_f32 v187, v187, v25
    v_mul_f32 v188, v188, v25
    v_mul_f32 v189, v189, v25
    v_mul_f32 v190, v190, v25
    v_mul_f32 v191, v191, v25
    v_mul_f32 v192, v192, v25
    v_mul_f32 v193, v193, v25
    v_mul_f32 v194, v194, v25
    v_mul_f32 v195, v195, v25
    v_mul_f32 v196, v196, v25
    v_mul_f32 v197, v197, v25
    v_mul_f32 v198, v198, v25
    v_mul_f32 v199, v199, v25
    v_mul_f32 v200, v200, v25
    v_mul_f32 v201, v201, v25
    v_mul_f32 v202, v202, v25
    v_mul_f32 v203, v203, v25
    v_mul_f32 v204, v204, v25
    v_mul_f32 v205, v205, v25
    v_mul_f32 v206, v206, v25
    v_mul_f32 v207, v207, v25
    v_fma_f32 v104, v104, s28, v10
    v_fma_f32 v105, v105, s28, v10
    v_exp_f32 v104, v104
    v_exp_f32 v105, v105
    s_nop 0
    v_cvt_pk_bf16_f32 v20, v104, v105
    v_fma_f32 v106, v106, s28, v10
    v_fma_f32 v107, v107, s28, v10
    v_exp_f32 v106, v106
    v_exp_f32 v107, v107
    s_nop 0
    v_cvt_pk_bf16_f32 v21, v106, v107
    v_fma_f32 v108, v108, s28, v10
    v_fma_f32 v109, v109, s28, v10
    v_exp_f32 v108, v108
    v_exp_f32 v109, v109
    s_nop 0
    v_cvt_pk_bf16_f32 v22, v108, v109
    v_fma_f32 v110, v110, s28, v10
    v_fma_f32 v111, v111, s28, v10
    v_exp_f32 v110, v110
    v_exp_f32 v111, v111
    s_nop 0
    v_cvt_pk_bf16_f32 v23, v110, v111
    s_add_u32 s69, s39, 0
    buffer_load_dwordx4 v[44:47], v30, s[4:7], s69 offen offset:0
    s_waitcnt vmcnt(0)
    v_mfma_f32_16x16x32_bf16 v[104:107], v[44:47], a[144:147], 0
    s_nop 7
    buffer_load_dwordx4 v[44:47], v30, s[4:7], s69 offen offset:64
    s_waitcnt vmcnt(0)
    v_mfma_f32_16x16x32_bf16 v[104:107], v[44:47], a[148:151], v[104:107]
    s_nop 7
    buffer_load_dwordx4 v[44:47], v30, s[4:7], s69 offen offset:128
    s_waitcnt vmcnt(0)
    v_mfma_f32_16x16x32_bf16 v[104:107], v[44:47], a[152:155], v[104:107]
    s_nop 7
    buffer_load_dwordx4 v[44:47], v30, s[4:7], s69 offen offset:192
    s_waitcnt vmcnt(0)
    v_mfma_f32_16x16x32_bf16 v[104:107], v[44:47], a[156:159], v[104:107]
    s_nop 7
    buffer_load_dwordx4 v[44:47], v30, s[4:7], s69 offen offset:256
    s_waitcnt vmcnt(0)
    v_mfma_f32_16x16x32_bf16 v[104:107], v[44:47], a[160:163], v[104:107]
    s_nop 7
    buffer_load_dwordx4 v[44:47], v30, s[4:7], s69 offen offset:320
    s_waitcnt vmcnt(0)
    v_mfma_f32_16x16x32_bf16 v[104:107], v[44:47], a[164:167], v[104:107]
    s_nop 7
    s_add_u32 s69, s39, 6144
    buffer_load_dwordx4 v[44:47], v30, s[4:7], s69 offen offset:0
    s_waitcnt vmcnt(0)
    v_mfma_f32_16x16x32_bf16 v[108:111], v[44:47], a[144:147], 0
    s_nop 7
    buffer_load_dwordx4 v[44:47], v30, s[4:7], s69 offen offset:64
    s_waitcnt vmcnt(0)
    v_mfma_f32_16x16x32_bf16 v[108:111], v[44:47], a[148:151], v[108:111]
    s_nop 7
    buffer_load_dwordx4 v[44:47], v30, s[4:7], s69 offen offset:128
    s_waitcnt vmcnt(0)
    v_mfma_f32_16x16x32_bf16 v[108:111], v[44:47], a[152:155], v[108:111]
    s_nop 7
    buffer_load_dwordx4 v[44:47], v30, s[4:7], s69 offen offset:192
    s_waitcnt vmcnt(0)
    v_mfma_f32_16x16x32_bf16 v[108:111], v[44:47], a[156:159], v[108:111]
    s_nop 7
    buffer_load_dwordx4 v[44:47], v30, s[4:7], s69 offen offset:256
    s_waitcnt vmcnt(0)
    v_mfma_f32_16x16x32_bf16 v[108:111], v[44:47], a[160:163], v[108:111]
    s_nop 7
    buffer_load_dwordx4 v[44:47], v30, s[4:7], s69 offen offset:320
    s_waitcnt vmcnt(0)
    v_mfma_f32_16x16x32_bf16 v[108:111], v[44:47], a[164:167], v[108:111]
    s_nop 7
    s_nop 15
    v_max3_f32 v18, v104, v105, v106
    v_max3_f32 v18, v18, v107, v108
    v_max3_f32 v18, v18, v109, v110
    v_max_f32 v18, v18, v111
    v_mov_b32 v19, v18
    s_nop 1
    v_permlane32_swap_b32 v19, v18
    v_max_f32 v18, v18, v19
    v_mov_b32 v19, v18
    s_nop 1
    v_permlane16_swap_b32 v19, v18
    v_max_f32 v18, v18, v19
    v_fma_f32 v18, v18, s28, v11
    v_max_f32 v24, 0, v18
    v_sub_f32 v11, v11, v24
    v_sub_f32 v25, 0, v24
    v_exp_f32 v25, v25
    s_nop 0
    v_mul_f32 v50, v50, v25
    v_mul_f32 v208, v208, v25
    v_mul_f32 v209, v209, v25
    v_mul_f32 v210, v210, v25
    v_mul_f32 v211, v211, v25
    v_mul_f32 v212, v212, v25
    v_mul_f32 v213, v213, v25
    v_mul_f32 v214, v214, v25
    v_mul_f32 v215, v215, v25
    v_mul_f32 v216, v216, v25
    v_mul_f32 v217, v217, v25
    v_mul_f32 v218, v218, v25
    v_mul_f32 v219, v219, v25
    v_mul_f32 v220, v220, v25
    v_mul_f32 v221, v221, v25
    v_mul_f32 v222, v222, v25
    v_mul_f32 v223, v223, v25
    v_mul_f32 v224, v224, v25
    v_mul_f32 v225, v225, v25
    v_mul_f32 v226, v226, v25
    v_mul_f32 v227, v227, v25
    v_mul_f32 v228, v228, v25
    v_mul_f32 v229, v229, v25
    v_mul_f32 v230, v230, v25
    v_mul_f32 v231, v231, v25
    v_mul_f32 v232, v232, v25
    v_mul_f32 v233, v233, v25
    v_mul_f32 v234, v234, v25
    v_mul_f32 v235, v235, v25
    v_mul_f32 v236, v236, v25
    v_mul_f32 v237, v237, v25
    v_mul_f32 v238, v238, v25
    v_mul_f32 v239, v239, v25
    v_mul_f32 v240, v240, v25
    v_mul_f32 v241, v241, v25
    v_mul_f32 v242, v242, v25
    v_mul_f32 v243, v243, v25
    v_mul_f32 v244, v244, v25
    v_mul_f32 v245, v245, v25
    v_mul_f32 v246, v246, v25
    v_mul_f32 v247, v247, v25
    v_mul_f32 v248, v248, v25
    v_mul_f32 v249, v249, v25
    v_mul_f32 v250, v250, v25
    v_mul_f32 v251, v251, v25
    v_mul_f32 v252, v252, v25
    v_mul_f32 v253, v253, v25
    v_mul_f32 v254, v254, v25
    v_mul_f32 v255, v255, v25
    v_fma_f32 v104, v104, s28, v11
    v_fma_f32 v105, v105, s28, v11
    v_exp_f32 v104, v104
    v_exp_f32 v105, v105
    s_nop 0
    v_cvt_pk_bf16_f32 v26, v104, v105
    v_fma_f32 v106, v106, s28, v11
    v_fma_f32 v107, v107, s28, v11
    v_exp_f32 v106, v106
    v_exp_f32 v107, v107
    s_nop 0
    v_cvt_pk_bf16_f32 v27, v106, v107
    v_fma_f32 v108, v108, s28, v11
    v_fma_f32 v109, v109, s28, v11
    v_exp_f32 v108, v108
    v_exp_f32 v109, v109
    s_nop 0
    v_cvt_pk_bf16_f32 v28, v108, v109
    v_fma_f32 v110, v110, s28, v11
    v_fma_f32 v111, v111, s28, v11
    v_exp_f32 v110, v110
    v_exp_f32 v111, v111
    s_nop 0
    v_cvt_pk_bf16_f32 v29, v110, v111
    s_add_u32 s69, s39, 0
    buffer_load_dwordx4 v[44:47], v30, s[4:7], s69 offen offset:0
    s_waitcnt vmcnt(0)
    v_mfma_f32_16x16x32_bf16 v[104:107], v[44:47], a[168:171], 0
    s_nop 7
    buffer_load_dwordx4 v[44:47], v30, s[4:7], s69 offen offset:64
    s_waitcnt vmcnt(0)
    v_mfma_f32_16x16x32_bf16 v[104:107], v[44:47], a[172:175], v[104:107]
    s_nop 7
    buffer_load_dwordx4 v[44:47], v30, s[4:7], s69 offen offset:128
    s_waitcnt vmcnt(0)
    v_mfma_f32_16x16x32_bf16 v[104:107], v[44:47], a[176:179], v[104:107]
    s_nop 7
    buffer_load_dwordx4 v[44:47], v30, s[4:7], s69 offen offset:192
    s_waitcnt vmcnt(0)
    v_mfma_f32_16x16x32_bf16 v[104:107], v[44:47], a[180:183], v[104:107]
    s_nop 7
    buffer_load_dwordx4 v[44:47], v30, s[4:7], s69 offen offset:256
    s_waitcnt vmcnt(0)
    v_mfma_f32_16x16x32_bf16 v[104:107], v[44:47], a[184:187], v[104:107]
    s_nop 7
    buffer_load_dwordx4 v[44:47], v30, s[4:7], s69 offen offset:320
    s_waitcnt vmcnt(0)
    v_mfma_f32_16x16x32_bf16 v[104:107], v[44:47], a[188:191], v[104:107]
    s_nop 7
    s_add_u32 s69, s39, 6144
    buffer_load_dwordx4 v[44:47], v30, s[4:7], s69 offen offset:0
    s_waitcnt vmcnt(0)
    v_mfma_f32_16x16x32_bf16 v[108:111], v[44:47], a[168:171], 0
    s_nop 7
    buffer_load_dwordx4 v[44:47], v30, s[4:7], s69 offen offset:64
    s_waitcnt vmcnt(0)
    v_mfma_f32_16x16x32_bf16 v[108:111], v[44:47], a[172:175], v[108:111]
    s_nop 7
    buffer_load_dwordx4 v[44:47], v30, s[4:7], s69 offen offset:128
    s_waitcnt vmcnt(0)
    v_mfma_f32_16x16x32_bf16 v[108:111], v[44:47], a[176:179], v[108:111]
    s_nop 7
    buffer_load_dwordx4 v[44:47], v30, s[4:7], s69 offen offset:192
    s_waitcnt vmcnt(0)
    v_mfma_f32_16x16x32_bf16 v[108:111], v[44:47], a[180:183], v[108:111]
    s_nop 7
    buffer_load_dwordx4 v[44:47], v30, s[4:7], s69 offen offset:256
    s_waitcnt vmcnt(0)
    v_mfma_f32_16x16x32_bf16 v[108:111], v[44:47], a[184:187], v[108:111]
    s_nop 7
    buffer_load_dwordx4 v[44:47], v30, s[4:7], s69 offen offset:320
    s_waitcnt vmcnt(0)
    v_mfma_f32_16x16x32_bf16 v[108:111], v[44:47], a[188:191], v[108:111]
    s_nop 7
    s_nop 15
    v_max3_f32 v18, v104, v105, v106
    v_max3_f32 v18, v18, v107, v108
    v_max3_f32 v18, v18, v109, v110
    v_max_f32 v18, v18, v111
    v_mov_b32 v19, v18
    s_nop 1
    v_permlane32_swap_b32 v19, v18
    v_max_f32 v18, v18, v19
    v_mov_b32 v19, v18
    s_nop 1
    v_permlane16_swap_b32 v19, v18
    v_max_f32 v18, v18, v19
    v_fma_f32 v18, v18, s28, v12
    v_max_f32 v24, 0, v18
    v_sub_f32 v12, v12, v24
    v_sub_f32 v25, 0, v24
    v_exp_f32 v25, v25
    s_nop 0
    v_mul_f32 v51, v51, v25
    v_accvgpr_read_b32 v19, a0
    v_mul_f32 v19, v19, v25
    v_accvgpr_write_b32 a0, v19
    v_accvgpr_read_b32 v19, a1
    v_mul_f32 v19, v19, v25
    v_accvgpr_write_b32 a1, v19
    v_accvgpr_read_b32 v19, a2
    v_mul_f32 v19, v19, v25
    v_accvgpr_write_b32 a2, v19
    v_accvgpr_read_b32 v19, a3
    v_mul_f32 v19, v19, v25
    v_accvgpr_write_b32 a3, v19
    v_accvgpr_read_b32 v19, a4
    v_mul_f32 v19, v19, v25
    v_accvgpr_write_b32 a4, v19
    v_accvgpr_read_b32 v19, a5
    v_mul_f32 v19, v19, v25
    v_accvgpr_write_b32 a5, v19
    v_accvgpr_read_b32 v19, a6
    v_mul_f32 v19, v19, v25
    v_accvgpr_write_b32 a6, v19
    v_accvgpr_read_b32 v19, a7
    v_mul_f32 v19, v19, v25
    v_accvgpr_write_b32 a7, v19
    v_accvgpr_read_b32 v19, a8
    v_mul_f32 v19, v19, v25
    v_accvgpr_write_b32 a8, v19
    v_accvgpr_read_b32 v19, a9
    v_mul_f32 v19, v19, v25
    v_accvgpr_write_b32 a9, v19
    v_accvgpr_read_b32 v19, a10
    v_mul_f32 v19, v19, v25
    v_accvgpr_write_b32 a10, v19
    v_accvgpr_read_b32 v19, a11
    v_mul_f32 v19, v19, v25
    v_accvgpr_write_b32 a11, v19
    v_accvgpr_read_b32 v19, a12
    v_mul_f32 v19, v19, v25
    v_accvgpr_write_b32 a12, v19
    v_accvgpr_read_b32 v19, a13
    v_mul_f32 v19, v19, v25
    v_accvgpr_write_b32 a13, v19
    v_accvgpr_read_b32 v19, a14
    v_mul_f32 v19, v19, v25
    v_accvgpr_write_b32 a14, v19
    v_accvgpr_read_b32 v19, a15
    v_mul_f32 v19, v19, v25
    v_accvgpr_write_b32 a15, v19
    v_accvgpr_read_b32 v19, a16
    v_mul_f32 v19, v19, v25
    v_accvgpr_write_b32 a16, v19
    v_accvgpr_read_b32 v19, a17
    v_mul_f32 v19, v19, v25
    v_accvgpr_write_b32 a17, v19
    v_accvgpr_read_b32 v19, a18
    v_mul_f32 v19, v19, v25
    v_accvgpr_write_b32 a18, v19
    v_accvgpr_read_b32 v19, a19
    v_mul_f32 v19, v19, v25
    v_accvgpr_write_b32 a19, v19
    v_accvgpr_read_b32 v19, a20
    v_mul_f32 v19, v19, v25
    v_accvgpr_write_b32 a20, v19
    v_accvgpr_read_b32 v19, a21
    v_mul_f32 v19, v19, v25
    v_accvgpr_write_b32 a21, v19
    v_accvgpr_read_b32 v19, a22
    v_mul_f32 v19, v19, v25
    v_accvgpr_write_b32 a22, v19
    v_accvgpr_read_b32 v19, a23
    v_mul_f32 v19, v19, v25
    v_accvgpr_write_b32 a23, v19
    v_accvgpr_read_b32 v19, a24
    v_mul_f32 v19, v19, v25
    v_accvgpr_write_b32 a24, v19
    v_accvgpr_read_b32 v19, a25
    v_mul_f32 v19, v19, v25
    v_accvgpr_write_b32 a25, v19
    v_accvgpr_read_b32 v19, a26
    v_mul_f32 v19, v19, v25
    v_accvgpr_write_b32 a26, v19
    v_accvgpr_read_b32 v19, a27
    v_mul_f32 v19, v19, v25
    v_accvgpr_write_b32 a27, v19
    v_accvgpr_read_b32 v19, a28
    v_mul_f32 v19, v19, v25
    v_accvgpr_write_b32 a28, v19
    v_accvgpr_read_b32 v19, a29
    v_mul_f32 v19, v19, v25
    v_accvgpr_write_b32 a29, v19
    v_accvgpr_read_b32 v19, a30
    v_mul_f32 v19, v19, v25
    v_accvgpr_write_b32 a30, v19
    v_accvgpr_read_b32 v19, a31
    v_mul_f32 v19, v19, v25
    v_accvgpr_write_b32 a31, v19
    v_accvgpr_read_b32 v19, a32
    v_mul_f32 v19, v19, v25
    v_accvgpr_write_b32 a32, v19
    v_accvgpr_read_b32 v19, a33
    v_mul_f32 v19, v19, v25
    v_accvgpr_write_b32 a33, v19
    v_accvgpr_read_b32 v19, a34
    v_mul_f32 v19, v19, v25
    v_accvgpr_write_b32 a34, v19
    v_accvgpr_read_b32 v19, a35
    v_mul_f32 v19, v19, v25
    v_accvgpr_write_b32 a35, v19
    v_accvgpr_read_b32 v19, a36
    v_mul_f32 v19, v19, v25
    v_accvgpr_write_b32 a36, v19
    v_accvgpr_read_b32 v19, a37
    v_mul_f32 v19, v19, v25
    v_accvgpr_write_b32 a37, v19
    v_accvgpr_read_b32 v19, a38
    v_mul_f32 v19, v19, v25
    v_accvgpr_write_b32 a38, v19
    v_accvgpr_read_b32 v19, a39
    v_mul_f32 v19, v19, v25
    v_accvgpr_write_b32 a39, v19
    v_accvgpr_read_b32 v19, a40
    v_mul_f32 v19, v19, v25
    v_accvgpr_write_b32 a40, v19
    v_accvgpr_read_b32 v19, a41
    v_mul_f32 v19, v19, v25
    v_accvgpr_write_b32 a41, v19
    v_accvgpr_read_b32 v19, a42
    v_mul_f32 v19, v19, v25
    v_accvgpr_write_b32 a42, v19
    v_accvgpr_read_b32 v19, a43
    v_mul_f32 v19, v19, v25
    v_accvgpr_write_b32 a43, v19
    v_accvgpr_read_b32 v19, a44
    v_mul_f32 v19, v19, v25
    v_accvgpr_write_b32 a44, v19
    v_accvgpr_read_b32 v19, a45
    v_mul_f32 v19, v19, v25
    v_accvgpr_write_b32 a45, v19
    v_accvgpr_read_b32 v19, a46
    v_mul_f32 v19, v19, v25
    v_accvgpr_write_b32 a46, v19
    v_accvgpr_read_b32 v19, a47
    v_mul_f32 v19, v19, v25
    v_accvgpr_write_b32 a47, v19
    v_fma_f32 v104, v104, s28, v12
    v_fma_f32 v105, v105, s28, v12
    v_exp_f32 v104, v104
    v_exp_f32 v105, v105
    s_nop 0
    v_cvt_pk_bf16_f32 v32, v104, v105
    v_fma_f32 v106, v106, s28, v12
    v_fma_f32 v107, v107, s28, v12
    v_exp_f32 v106, v106
    v_exp_f32 v107, v107
    s_nop 0
    v_cvt_pk_bf16_f32 v33, v106, v107
    v_fma_f32 v108, v108, s28, v12
    v_fma_f32 v109, v109, s28, v12
    v_exp_f32 v108, v108
    v_exp_f32 v109, v109
    s_nop 0
    v_cvt_pk_bf16_f32 v34, v108, v109
    v_fma_f32 v110, v110, s28, v12
    v_fma_f32 v111, v111, s28, v12
    v_exp_f32 v110, v110
    v_exp_f32 v111, v111
    s_nop 0
    v_cvt_pk_bf16_f32 v35, v110, v111
    v_mfma_f32_16x16x32_bf16 v[44:47], a[236:239], v[14:17], v[48:51]
    v_mfma_f32_16x16x32_bf16 v[44:47], a[240:243], v[20:23], v[44:47]
    v_mfma_f32_16x16x32_bf16 v[44:47], a[244:247], v[26:29], v[44:47]
    v_mfma_f32_16x16x32_bf16 v[44:47], a[248:251], v[32:35], v[44:47]
    s_nop 15
    s_setpc_b64 s[40:41]
L_rare4_1:
    s_nop 15
    v_mbcnt_lo_u32_b32 v27, -1, 0
    v_mbcnt_hi_u32_b32 v27, -1, v27
    v_and_b32 v26, 15, v27
    v_mul_u32_u24 v26, 384, v26
    v_lshrrev_b32 v27, 4, v27
    v_lshl_add_u32 v26, v27, 4, v26
    s_add_u32 s69, s39, 0
    buffer_load_dwordx4 v[48:51], v26, s[4:7], s69 offen offset:0
    s_waitcnt vmcnt(0)
    v_mfma_f32_16x16x32_bf16 v[104:107], v[48:51], a[96:99], 0
    s_nop 7
    buffer_load_dwordx4 v[48:51], v26, s[4:7], s69 offen offset:64
    s_waitcnt vmcnt(0)
    v_mfma_f32_16x16x32_bf16 v[104:107], v[48:51], a[100:103], v[104:107]
    s_nop 7
    buffer_load_dwordx4 v[48:51], v26, s[4:7], s69 offen offset:128
    s_waitcnt vmcnt(0)
    v_mfma_f32_16x16x32_bf16 v[104:107], v[48:51], a[104:107], v[104:107]
    s_nop 7
    buffer_load_dwordx4 v[48:51], v26, s[4:7], s69 offen offset:192
    s_waitcnt vmcnt(0)
    v_mfma_f32_16x16x32_bf16 v[104:107], v[48:51], a[108:111], v[104:107]
    s_nop 7
    buffer_load_dwordx4 v[48:51], v26, s[4:7], s69 offen offset:256
    s_waitcnt vmcnt(0)
    v_mfma_f32_16x16x32_bf16 v[104:107], v[48:51], a[112:115], v[104:107]
    s_nop 7
    buffer_load_dwordx4 v[48:51], v26, s[4:7], s69 offen offset:320
    s_waitcnt vmcnt(0)
    v_mfma_f32_16x16x32_bf16 v[104:107], v[48:51], a[116:119], v[104:107]
    s_nop 7
    s_add_u32 s69, s39, 6144
    buffer_load_dwordx4 v[48:51], v26, s[4:7], s69 offen offset:0
    s_waitcnt vmcnt(0)
    v_mfma_f32_16x16x32_bf16 v[108:111], v[48:51], a[96:99], 0
    s_nop 7
    buffer_load_dwordx4 v[48:51], v26, s[4:7], s69 offen offset:64
    s_waitcnt vmcnt(0)
    v_mfma_f32_16x16x32_bf16 v[108:111], v[48:51], a[100:103], v[108:111]
    s_nop 7
    buffer_load_dwordx4 v[48:51], v26, s[4:7], s69 offen offset:128
    s_waitcnt vmcnt(0)
    v_mfma_f32_16x16x32_bf16 v[108:111], v[48:51], a[104:107], v[108:111]
    s_nop 7
    buffer_load_dwordx4 v[48:51], v26, s[4:7], s69 offen offset:192
    s_waitcnt vmcnt(0)
    v_mfma_f32_16x16x32_bf16 v[108:111], v[48:51], a[108:111], v[108:111]
    s_nop 7
    buffer_load_dwordx4 v[48:51], v26, s[4:7], s69 offen offset:256
    s_waitcnt vmcnt(0)
    v_mfma_f32_16x16x32_bf16 v[108:111], v[48:51], a[112:115], v[108:111]
    s_nop 7
    buffer_load_dwordx4 v[48:51], v26, s[4:7], s69 offen offset:320
    s_waitcnt vmcnt(0)
    v_mfma_f32_16x16x32_bf16 v[108:111], v[48:51], a[116:119], v[108:111]
    s_nop 7
    s_nop 15
    v_max3_f32 v14, v104, v105, v106
    v_max3_f32 v14, v14, v107, v108
    v_max3_f32 v14, v14, v109, v110
    v_max_f32 v14, v14, v111
    v_mov_b32 v15, v14
    s_nop 1
    v_permlane32_swap_b32 v15, v14
    v_max_f32 v14, v14, v15
    v_mov_b32 v15, v14
    s_nop 1
    v_permlane16_swap_b32 v15, v14
    v_max_f32 v14, v14, v15
    v_fma_f32 v14, v14, s28, v9
    v_max_f32 v20, 0, v14
    v_sub_f32 v9, v9, v20
    v_sub_f32 v21, 0, v20
    v_exp_f32 v21, v21
    s_nop 0
    v_mul_f32 v15, v44, v21
    v_cndmask_b32_e64 v44, v15, v44, s[60:61]
    v_cndmask_b32_e64 v44, v44, 0, s[46:47]
    v_mul_f32 v112, v112, v21
    v_mul_f32 v113, v113, v21
    v_mul_f32 v114, v114, v21
    v_mul_f32 v115, v115, v21
    v_mul_f32 v116, v116, v21
    v_mul_f32 v117, v117, v21
    v_mul_f32 v118, v118, v21
    v_mul_f32 v119, v119, v21
    v_mul_f32 v120, v120, v21
    v_mul_f32 v121, v121, v21
    v_mul_f32 v122, v122, v21
    v_mul_f32 v123, v123, v21
    v_mul_f32 v124, v124, v21
    v_mul_f32 v125, v125, v21
    v_mul_f32 v126, v126, v21
    v_mul_f32 v127, v127, v21
    v_mul_f32 v128, v128, v21
    v_mul_f32 v129, v129, v21
    v_mul_f32 v130, v130, v21
    v_mul_f32 v131, v131, v21
    v_mul_f32 v132, v132, v21
    v_mul_f32 v133, v133, v21
    v_mul_f32 v134, v134, v21
    v_mul_f32 v135, v135, v21
    v_mul_f32 v136, v136, v21
    v_mul_f32 v137, v137, v21
    v_mul_f32 v138, v138, v21
    v_mul_f32 v139, v139, v21
    v_mul_f32 v140, v140, v21
    v_mul_f32 v141, v141, v21
    v_mul_f32 v142, v142, v21
    v_mul_f32 v143, v143, v21
    v_mul_f32 v144, v144, v21
    v_mul_f32 v145, v145, v21
    v_mul_f32 v146, v146, v21
    v_mul_f32 v147, v147, v21
    v_mul_f32 v148, v148, v21
    v_mul_f32 v149, v149, v21
    v_mul_f32 v150, v150, v21
    v_mul_f32 v151, v151, v21
    v_mul_f32 v152, v152, v21
    v_mul_f32 v153, v153, v21
    v_mul_f32 v154, v154, v21
    v_mul_f32 v155, v155, v21
    v_mul_f32 v156, v156, v21
    v_mul_f32 v157, v157, v21
    v_mul_f32 v158, v158, v21
    v_mul_f32 v159, v159, v21
    v_fma_f32 v104, v104, s28, v9
    v_fma_f32 v105, v105, s28, v9
    v_exp_f32 v104, v104
    v_exp_f32 v105, v105
    s_nop 0
    v_cvt_pk_bf16_f32 v18, v104, v105
    v_fma_f32 v106, v106, s28, v9
    v_fma_f32 v107, v107, s28, v9
    v_exp_f32 v106, v106
    v_exp_f32 v107, v107
    s_nop 0
    v_cvt_pk_bf16_f32 v19, v106, v107
    v_fma_f32 v108, v108, s28, v9
    v_fma_f32 v109, v109, s28, v9
    v_exp_f32 v108, v108
    v_exp_f32 v109, v109
    s_nop 0
    v_cvt_pk_bf16_f32 v16, v108, v109
    v_fma_f32 v110, v110, s28, v9
    v_fma_f32 v111, v111, s28, v9
    v_exp_f32 v110, v110
    v_exp_f32 v111, v111
    s_nop 0
    v_cvt_pk_bf16_f32 v17, v110, v111
    s_add_u32 s69, s39, 0
    buffer_load_dwordx4 v[48:51], v26, s[4:7], s69 offen offset:0
    s_waitcnt vmcnt(0)
    v_mfma_f32_16x16x32_bf16 v[104:107], v[48:51], a[120:123], 0
    s_nop 7
    buffer_load_dwordx4 v[48:51], v26, s[4:7], s69 offen offset:64
    s_waitcnt vmcnt(0)
    v_mfma_f32_16x16x32_bf16 v[104:107], v[48:51], a[124:127], v[104:107]
    s_nop 7
    buffer_load_dwordx4 v[48:51], v26, s[4:7], s69 offen offset:128
    s_waitcnt vmcnt(0)
    v_mfma_f32_16x16x32_bf16 v[104:107], v[48:51], a[128:131], v[104:107]
    s_nop 7
    buffer_load_dwordx4 v[48:51], v26, s[4:7], s69 offen offset:192
    s_waitcnt vmcnt(0)
    v_mfma_f32_16x16x32_bf16 v[104:107], v[48:51], a[132:135], v[104:107]
    s_nop 7
    buffer_load_dwordx4 v[48:51], v26, s[4:7], s69 offen offset:256
    s_waitcnt vmcnt(0)
    v_mfma_f32_16x16x32_bf16 v[104:107], v[48:51], a[136:139], v[104:107]
    s_nop 7
    buffer_load_dwordx4 v[48:51], v26, s[4:7], s69 offen offset:320
    s_waitcnt vmcnt(0)
    v_mfma_f32_16x16x32_bf16 v[104:107], v[48:51], a[140:143], v[104:107]
    s_nop 7
    s_add_u32 s69, s39, 6144
    buffer_load_dwordx4 v[48:51], v26, s[4:7], s69 offen offset:0
    s_waitcnt vmcnt(0)
    v_mfma_f32_16x16x32_bf16 v[108:111], v[48:51], a[120:123], 0
    s_nop 7
    buffer_load_dwordx4 v[48:51], v26, s[4:7], s69 offen offset:64
    s_waitcnt vmcnt(0)
    v_mfma_f32_16x16x32_bf16 v[108:111], v[48:51], a[124:127], v[108:111]
    s_nop 7
    buffer_load_dwordx4 v[48:51], v26, s[4:7], s69 offen offset:128
    s_waitcnt vmcnt(0)
    v_mfma_f32_16x16x32_bf16 v[108:111], v[48:51], a[128:131], v[108:111]
    s_nop 7
    buffer_load_dwordx4 v[48:51], v26, s[4:7], s69 offen offset:192
    s_waitcnt vmcnt(0)
    v_mfma_f32_16x16x32_bf16 v[108:111], v[48:51], a[132:135], v[108:111]
    s_nop 7
    buffer_load_dwordx4 v[48:51], v26, s[4:7], s69 offen offset:256
    s_waitcnt vmcnt(0)
    v_mfma_f32_16x16x32_bf16 v[108:111], v[48:51], a[136:139], v[108:111]
    s_nop 7
    buffer_load_dwordx4 v[48:51], v26, s[4:7], s69 offen offset:320
    s_waitcnt vmcnt(0)
    v_mfma_f32_16x16x32_bf16 v[108:111], v[48:51], a[140:143], v[108:111]
    s_nop 7
    s_nop 15
    v_max3_f32 v14, v104, v105, v106
    v_max3_f32 v14, v14, v107, v108
    v_max3_f32 v14, v14, v109, v110
    v_max_f32 v14, v14, v111
    v_mov_b32 v15, v14
    s_nop 1
    v_permlane32_swap_b32 v15, v14
    v_max_f32 v14, v14, v15
    v_mov_b32 v15, v14
    s_nop 1
    v_permlane16_swap_b32 v15, v14
    v_max_f32 v14, v14, v15
    v_fma_f32 v14, v14, s28, v10
    v_max_f32 v20, 0, v14
    v_sub_f32 v10, v10, v20
    v_sub_f32 v21, 0, v20
    v_exp_f32 v21, v21
    s_nop 0
    v_mul_f32 v45, v45, v21
    v_mul_f32 v160, v160, v21
    v_mul_f32 v161, v161, v21
    v_mul_f32 v162, v162, v21
    v_mul_f32 v163, v163, v21
    v_mul_f32 v164, v164, v21
    v_mul_f32 v165, v165, v21
    v_mul_f32 v166, v166, v21
    v_mul_f32 v167, v167, v21
    v_mul_f32 v168, v168, v21
    v_mul_f32 v169, v169, v21
    v_mul_f32 v170, v170, v21
    v_mul_f32 v171, v171, v21
    v_mul_f32 v172, v172, v21
    v_mul_f32 v173, v173, v21
    v_mul_f32 v174, v174, v21
    v_mul_f32 v175, v175, v21
    v_mul_f32 v176, v176, v21
    v_mul_f32 v177, v177, v21
    v_mul_f32 v178, v178, v21
    v_mul_f32 v179, v179, v21
    v_mul_f32 v180, v180, v21
    v_mul_f32 v181, v181, v21
    v_mul_f32 v182, v182, v21
    v_mul_f32 v183, v183, v21
    v_mul_f32 v184, v184, v21
    v_mul_f32 v185, v185, v21
    v_mul_f32 v186, v186, v21
    v_mul_f32 v187, v187, v21
    v_mul_f32 v188, v188, v21
    v_mul_f32 v189, v189, v21
    v_mul_f32 v190, v190, v21
    v_mul_f32 v191, v191, v21
    v_mul_f32 v192, v192, v21
    v_mul_f32 v193, v193, v21
    v_mul_f32 v194, v194, v21
    v_mul_f32 v195, v195, v21
    v_mul_f32 v196, v196, v21
    v_mul_f32 v197, v197, v21
    v_mul_f32 v198, v198, v21
    v_mul_f32 v199, v199, v21
    v_mul_f32 v200, v200, v21
    v_mul_f32 v201, v201, v21
    v_mul_f32 v202, v202, v21
    v_mul_f32 v203, v203, v21
    v_mul_f32 v204, v204, v21
    v_mul_f32 v205, v205, v21
    v_mul_f32 v206, v206, v21
    v_mul_f32 v207, v207, v21
    v_fma_f32 v104, v104, s28, v10
    v_fma_f32 v105, v105, s28, v10
    v_exp_f32 v104, v104
    v_exp_f32 v105, v105
    s_nop 0
    v_cvt_pk_bf16_f32 v24, v104, v105
    v_fma_f32 v106, v106, s28, v10
    v_fma_f32 v107, v107, s28, v10
    v_exp_f32 v106, v106
    v_exp_f32 v107, v107
    s_nop 0
    v_cvt_pk_bf16_f32 v25, v106, v107
    v_fma_f32 v108, v108, s28, v10
    v_fma_f32 v109, v109, s28, v10
    v_exp_f32 v108, v108
    v_exp_f32 v109, v109
    s_nop 0
    v_cvt_pk_bf16_f32 v22, v108, v109
    v_fma_f32 v110, v110, s28, v10
    v_fma_f32 v111, v111, s28, v10
    v_exp_f32 v110, v110
    v_exp_f32 v111, v111
    s_nop 0
    v_cvt_pk_bf16_f32 v23, v110, v111
    s_add_u32 s69, s39, 0
    buffer_load_dwordx4 v[48:51], v26, s[4:7], s69 offen offset:0
    s_waitcnt vmcnt(0)
    v_mfma_f32_16x16x32_bf16 v[104:107], v[48:51], a[144:147], 0
    s_nop 7
    buffer_load_dwordx4 v[48:51], v26, s[4:7], s69 offen offset:64
    s_waitcnt vmcnt(0)
    v_mfma_f32_16x16x32_bf16 v[104:107], v[48:51], a[148:151], v[104:107]
    s_nop 7
    buffer_load_dwordx4 v[48:51], v26, s[4:7], s69 offen offset:128
    s_waitcnt vmcnt(0)
    v_mfma_f32_16x16x32_bf16 v[104:107], v[48:51], a[152:155], v[104:107]
    s_nop 7
    buffer_load_dwordx4 v[48:51], v26, s[4:7], s69 offen offset:192
    s_waitcnt vmcnt(0)
    v_mfma_f32_16x16x32_bf16 v[104:107], v[48:51], a[156:159], v[104:107]
    s_nop 7
    buffer_load_dwordx4 v[48:51], v26, s[4:7], s69 offen offset:256
    s_waitcnt vmcnt(0)
    v_mfma_f32_16x16x32_bf16 v[104:107], v[48:51], a[160:163], v[104:107]
    s_nop 7
    buffer_load_dwordx4 v[48:51], v26, s[4:7], s69 offen offset:320
    s_waitcnt vmcnt(0)
    v_mfma_f32_16x16x32_bf16 v[104:107], v[48:51], a[164:167], v[104:107]
    s_nop 7
    s_add_u32 s69, s39, 6144
    buffer_load_dwordx4 v[48:51], v26, s[4:7], s69 offen offset:0
    s_waitcnt vmcnt(0)
    v_mfma_f32_16x16x32_bf16 v[108:111], v[48:51], a[144:147], 0
    s_nop 7
    buffer_load_dwordx4 v[48:51], v26, s[4:7], s69 offen offset:64
    s_waitcnt vmcnt(0)
    v_mfma_f32_16x16x32_bf16 v[108:111], v[48:51], a[148:151], v[108:111]
    s_nop 7
    buffer_load_dwordx4 v[48:51], v26, s[4:7], s69 offen offset:128
    s_waitcnt vmcnt(0)
    v_mfma_f32_16x16x32_bf16 v[108:111], v[48:51], a[152:155], v[108:111]
    s_nop 7
    buffer_load_dwordx4 v[48:51], v26, s[4:7], s69 offen offset:192
    s_waitcnt vmcnt(0)
    v_mfma_f32_16x16x32_bf16 v[108:111], v[48:51], a[156:159], v[108:111]
    s_nop 7
    buffer_load_dwordx4 v[48:51], v26, s[4:7], s69 offen offset:256
    s_waitcnt vmcnt(0)
    v_mfma_f32_16x16x32_bf16 v[108:111], v[48:51], a[160:163], v[108:111]
    s_nop 7
    buffer_load_dwordx4 v[48:51], v26, s[4:7], s69 offen offset:320
    s_waitcnt vmcnt(0)
    v_mfma_f32_16x16x32_bf16 v[108:111], v[48:51], a[164:167], v[108:111]
    s_nop 7
    s_nop 15
    v_max3_f32 v14, v104, v105, v106
    v_max3_f32 v14, v14, v107, v108
    v_max3_f32 v14, v14, v109, v110
    v_max_f32 v14, v14, v111
    v_mov_b32 v15, v14
    s_nop 1
    v_permlane32_swap_b32 v15, v14
    v_max_f32 v14, v14, v15
    v_mov_b32 v15, v14
    s_nop 1
    v_permlane16_swap_b32 v15, v14
    v_max_f32 v14, v14, v15
    v_fma_f32 v14, v14, s28, v11
    v_max_f32 v20, 0, v14
    v_sub_f32 v11, v11, v20
    v_sub_f32 v21, 0, v20
    v_exp_f32 v21, v21
    s_nop 0
    v_mul_f32 v46, v46, v21
    v_mul_f32 v208, v208, v21
    v_mul_f32 v209, v209, v21
    v_mul_f32 v210, v210, v21
    v_mul_f32 v211, v211, v21
    v_mul_f32 v212, v212, v21
    v_mul_f32 v213, v213, v21
    v_mul_f32 v214, v214, v21
    v_mul_f32 v215, v215, v21
    v_mul_f32 v216, v216, v21
    v_mul_f32 v217, v217, v21
    v_mul_f32 v218, v218, v21
    v_mul_f32 v219, v219, v21
    v_mul_f32 v220, v220, v21
    v_mul_f32 v221, v221, v21
    v_mul_f32 v222, v222, v21
    v_mul_f32 v223, v223, v21
    v_mul_f32 v224, v224, v21
    v_mul_f32 v225, v225, v21
    v_mul_f32 v226, v226, v21
    v_mul_f32 v227, v227, v21
    v_mul_f32 v228, v228, v21
    v_mul_f32 v229, v229, v21
    v_mul_f32 v230, v230, v21
    v_mul_f32 v231, v231, v21
    v_mul_f32 v232, v232, v21
    v_mul_f32 v233, v233, v21
    v_mul_f32 v234, v234, v21
    v_mul_f32 v235, v235, v21
    v_mul_f32 v236, v236, v21
    v_mul_f32 v237, v237, v21
    v_mul_f32 v238, v238, v21
    v_mul_f32 v239, v239, v21
    v_mul_f32 v240, v240, v21
    v_mul_f32 v241, v241, v21
    v_mul_f32 v242, v242, v21
    v_mul_f32 v243, v243, v21
    v_mul_f32 v244, v244, v21
    v_mul_f32 v245, v245, v21
    v_mul_f32 v246, v246, v21
    v_mul_f32 v247, v247, v21
    v_mul_f32 v248, v248, v21
    v_mul_f32 v249, v249, v21
    v_mul_f32 v250, v250, v21
    v_mul_f32 v251, v251, v21
    v_mul_f32 v252, v252, v21
    v_mul_f32 v253, v253, v21
    v_mul_f32 v254, v254, v21
    v_mul_f32 v255, v255, v21
    v_fma_f32 v104, v104, s28, v11
    v_fma_f32 v105, v105, s28, v11
    v_exp_f32 v104, v104
    v_exp_f32 v105, v105
    s_nop 0
    v_cvt_pk_bf16_f32 v30, v104, v105
    v_fma_f32 v106, v106, s28, v11
    v_fma_f32 v107, v107, s28, v11
    v_exp_f32 v106, v106
    v_exp_f32 v107, v107
    s_nop 0
    v_cvt_pk_bf16_f32 v31, v106, v107
    v_fma_f32 v108, v108, s28, v11
    v_fma_f32 v109, v109, s28, v11
    v_exp_f32 v108, v108
    v_exp_f32 v109, v109
    s_nop 0
    v_cvt_pk_bf16_f32 v28, v108, v109
    v_fma_f32 v110, v110, s28, v11
    v_fma_f32 v111, v111, s28, v11
    v_exp_f32 v110, v110
    v_exp_f32 v111, v111
    s_nop 0
    v_cvt_pk_bf16_f32 v29, v110, v111
    s_add_u32 s69, s39, 0
    buffer_load_dwordx4 v[48:51], v26, s[4:7], s69 offen offset:0
    s_waitcnt vmcnt(0)
    v_mfma_f32_16x16x32_bf16 v[104:107], v[48:51], a[168:171], 0
    s_nop 7
    buffer_load_dwordx4 v[48:51], v26, s[4:7], s69 offen offset:64
    s_waitcnt vmcnt(0)
    v_mfma_f32_16x16x32_bf16 v[104:107], v[48:51], a[172:175], v[104:107]
    s_nop 7
    buffer_load_dwordx4 v[48:51], v26, s[4:7], s69 offen offset:128
    s_waitcnt vmcnt(0)
    v_mfma_f32_16x16x32_bf16 v[104:107], v[48:51], a[176:179], v[104:107]
    s_nop 7
    buffer_load_dwordx4 v[48:51], v26, s[4:7], s69 offen offset:192
    s_waitcnt vmcnt(0)
    v_mfma_f32_16x16x32_bf16 v[104:107], v[48:51], a[180:183], v[104:107]
    s_nop 7
    buffer_load_dwordx4 v[48:51], v26, s[4:7], s69 offen offset:256
    s_waitcnt vmcnt(0)
    v_mfma_f32_16x16x32_bf16 v[104:107], v[48:51], a[184:187], v[104:107]
    s_nop 7
    buffer_load_dwordx4 v[48:51], v26, s[4:7], s69 offen offset:320
    s_waitcnt vmcnt(0)
    v_mfma_f32_16x16x32_bf16 v[104:107], v[48:51], a[188:191], v[104:107]
    s_nop 7
    s_add_u32 s69, s39, 6144
    buffer_load_dwordx4 v[48:51], v26, s[4:7], s69 offen offset:0
    s_waitcnt vmcnt(0)
    v_mfma_f32_16x16x32_bf16 v[108:111], v[48:51], a[168:171], 0
    s_nop 7
    buffer_load_dwordx4 v[48:51], v26, s[4:7], s69 offen offset:64
    s_waitcnt vmcnt(0)
    v_mfma_f32_16x16x32_bf16 v[108:111], v[48:51], a[172:175], v[108:111]
    s_nop 7
    buffer_load_dwordx4 v[48:51], v26, s[4:7], s69 offen offset:128
    s_waitcnt vmcnt(0)
    v_mfma_f32_16x16x32_bf16 v[108:111], v[48:51], a[176:179], v[108:111]
    s_nop 7
    buffer_load_dwordx4 v[48:51], v26, s[4:7], s69 offen offset:192
    s_waitcnt vmcnt(0)
    v_mfma_f32_16x16x32_bf16 v[108:111], v[48:51], a[180:183], v[108:111]
    s_nop 7
    buffer_load_dwordx4 v[48:51], v26, s[4:7], s69 offen offset:256
    s_waitcnt vmcnt(0)
    v_mfma_f32_16x16x32_bf16 v[108:111], v[48:51], a[184:187], v[108:111]
    s_nop 7
    buffer_load_dwordx4 v[48:51], v26, s[4:7], s69 offen offset:320
    s_waitcnt vmcnt(0)
    v_mfma_f32_16x16x32_bf16 v[108:111], v[48:51], a[188:191], v[108:111]
    s_nop 7
    s_nop 15
    v_max3_f32 v14, v104, v105, v106
    v_max3_f32 v14, v14, v107, v108
    v_max3_f32 v14, v14, v109, v110
    v_max_f32 v14, v14, v111
    v_mov_b32 v15, v14
    s_nop 1
    v_permlane32_swap_b32 v15, v14
    v_max_f32 v14, v14, v15
    v_mov_b32 v15, v14
    s_nop 1
    v_permlane16_swap_b32 v15, v14
    v_max_f32 v14, v14, v15
    v_fma_f32 v14, v14, s28, v12
    v_max_f32 v20, 0, v14
    v_sub_f32 v12, v12, v20
    v_sub_f32 v21, 0, v20
    v_exp_f32 v21, v21
    s_nop 0
    v_mul_f32 v47, v47, v21
    v_accvgpr_read_b32 v15, a0
    v_mul_f32 v15, v15, v21
    v_accvgpr_write_b32 a0, v15
    v_accvgpr_read_b32 v15, a1
    v_mul_f32 v15, v15, v21
    v_accvgpr_write_b32 a1, v15
    v_accvgpr_read_b32 v15, a2
    v_mul_f32 v15, v15, v21
    v_accvgpr_write_b32 a2, v15
    v_accvgpr_read_b32 v15, a3
    v_mul_f32 v15, v15, v21
    v_accvgpr_write_b32 a3, v15
    v_accvgpr_read_b32 v15, a4
    v_mul_f32 v15, v15, v21
    v_accvgpr_write_b32 a4, v15
    v_accvgpr_read_b32 v15, a5
    v_mul_f32 v15, v15, v21
    v_accvgpr_write_b32 a5, v15
    v_accvgpr_read_b32 v15, a6
    v_mul_f32 v15, v15, v21
    v_accvgpr_write_b32 a6, v15
    v_accvgpr_read_b32 v15, a7
    v_mul_f32 v15, v15, v21
    v_accvgpr_write_b32 a7, v15
    v_accvgpr_read_b32 v15, a8
    v_mul_f32 v15, v15, v21
    v_accvgpr_write_b32 a8, v15
    v_accvgpr_read_b32 v15, a9
    v_mul_f32 v15, v15, v21
    v_accvgpr_write_b32 a9, v15
    v_accvgpr_read_b32 v15, a10
    v_mul_f32 v15, v15, v21
    v_accvgpr_write_b32 a10, v15
    v_accvgpr_read_b32 v15, a11
    v_mul_f32 v15, v15, v21
    v_accvgpr_write_b32 a11, v15
    v_accvgpr_read_b32 v15, a12
    v_mul_f32 v15, v15, v21
    v_accvgpr_write_b32 a12, v15
    v_accvgpr_read_b32 v15, a13
    v_mul_f32 v15, v15, v21
    v_accvgpr_write_b32 a13, v15
    v_accvgpr_read_b32 v15, a14
    v_mul_f32 v15, v15, v21
    v_accvgpr_write_b32 a14, v15
    v_accvgpr_read_b32 v15, a15
    v_mul_f32 v15, v15, v21
    v_accvgpr_write_b32 a15, v15
    v_accvgpr_read_b32 v15, a16
    v_mul_f32 v15, v15, v21
    v_accvgpr_write_b32 a16, v15
    v_accvgpr_read_b32 v15, a17
    v_mul_f32 v15, v15, v21
    v_accvgpr_write_b32 a17, v15
    v_accvgpr_read_b32 v15, a18
    v_mul_f32 v15, v15, v21
    v_accvgpr_write_b32 a18, v15
    v_accvgpr_read_b32 v15, a19
    v_mul_f32 v15, v15, v21
    v_accvgpr_write_b32 a19, v15
    v_accvgpr_read_b32 v15, a20
    v_mul_f32 v15, v15, v21
    v_accvgpr_write_b32 a20, v15
    v_accvgpr_read_b32 v15, a21
    v_mul_f32 v15, v15, v21
    v_accvgpr_write_b32 a21, v15
    v_accvgpr_read_b32 v15, a22
    v_mul_f32 v15, v15, v21
    v_accvgpr_write_b32 a22, v15
    v_accvgpr_read_b32 v15, a23
    v_mul_f32 v15, v15, v21
    v_accvgpr_write_b32 a23, v15
    v_accvgpr_read_b32 v15, a24
    v_mul_f32 v15, v15, v21
    v_accvgpr_write_b32 a24, v15
    v_accvgpr_read_b32 v15, a25
    v_mul_f32 v15, v15, v21
    v_accvgpr_write_b32 a25, v15
    v_accvgpr_read_b32 v15, a26
    v_mul_f32 v15, v15, v21
    v_accvgpr_write_b32 a26, v15
    v_accvgpr_read_b32 v15, a27
    v_mul_f32 v15, v15, v21
    v_accvgpr_write_b32 a27, v15
    v_accvgpr_read_b32 v15, a28
    v_mul_f32 v15, v15, v21
    v_accvgpr_write_b32 a28, v15
    v_accvgpr_read_b32 v15, a29
    v_mul_f32 v15, v15, v21
    v_accvgpr_write_b32 a29, v15
    v_accvgpr_read_b32 v15, a30
    v_mul_f32 v15, v15, v21
    v_accvgpr_write_b32 a30, v15
    v_accvgpr_read_b32 v15, a31
    v_mul_f32 v15, v15, v21
    v_accvgpr_write_b32 a31, v15
    v_accvgpr_read_b32 v15, a32
    v_mul_f32 v15, v15, v21
    v_accvgpr_write_b32 a32, v15
    v_accvgpr_read_b32 v15, a33
    v_mul_f32 v15, v15, v21
    v_accvgpr_write_b32 a33, v15
    v_accvgpr_read_b32 v15, a34
    v_mul_f32 v15, v15, v21
    v_accvgpr_write_b32 a34, v15
    v_accvgpr_read_b32 v15, a35
    v_mul_f32 v15, v15, v21
    v_accvgpr_write_b32 a35, v15
    v_accvgpr_read_b32 v15, a36
    v_mul_f32 v15, v15, v21
    v_accvgpr_write_b32 a36, v15
    v_accvgpr_read_b32 v15, a37
    v_mul_f32 v15, v15, v21
    v_accvgpr_write_b32 a37, v15
    v_accvgpr_read_b32 v15, a38
    v_mul_f32 v15, v15, v21
    v_accvgpr_write_b32 a38, v15
    v_accvgpr_read_b32 v15, a39
    v_mul_f32 v15, v15, v21
    v_accvgpr_write_b32 a39, v15
    v_accvgpr_read_b32 v15, a40
    v_mul_f32 v15, v15, v21
    v_accvgpr_write_b32 a40, v15
    v_accvgpr_read_b32 v15, a41
    v_mul_f32 v15, v15, v21
    v_accvgpr_write_b32 a41, v15
    v_accvgpr_read_b32 v15, a42
    v_mul_f32 v15, v15, v21
    v_accvgpr_write_b32 a42, v15
    v_accvgpr_read_b32 v15, a43
    v_mul_f32 v15, v15, v21
    v_accvgpr_write_b32 a43, v15
    v_accvgpr_read_b32 v15, a44
    v_mul_f32 v15, v15, v21
    v_accvgpr_write_b32 a44, v15
    v_accvgpr_read_b32 v15, a45
    v_mul_f32 v15, v15, v21
    v_accvgpr_write_b32 a45, v15
    v_accvgpr_read_b32 v15, a46
    v_mul_f32 v15, v15, v21
    v_accvgpr_write_b32 a46, v15
    v_accvgpr_read_b32 v15, a47
    v_mul_f32 v15, v15, v21
    v_accvgpr_write_b32 a47, v15
    v_fma_f32 v104, v104, s28, v12
    v_fma_f32 v105, v105, s28, v12
    v_exp_f32 v104, v104
    v_exp_f32 v105, v105
    s_nop 0
    v_cvt_pk_bf16_f32 v36, v104, v105
    v_fma_f32 v106, v106, s28, v12
    v_fma_f32 v107, v107, s28, v12
    v_exp_f32 v106, v106
    v_exp_f32 v107, v107
    s_nop 0
    v_cvt_pk_bf16_f32 v37, v106, v107
    v_fma_f32 v108, v108, s28, v12
    v_fma_f32 v109, v109, s28, v12
    v_exp_f32 v108, v108
    v_exp_f32 v109, v109
    s_nop 0
    v_cvt_pk_bf16_f32 v34, v108, v109
    v_fma_f32 v110, v110, s28, v12
    v_fma_f32 v111, v111, s28, v12
    v_exp_f32 v110, v110
    v_exp_f32 v111, v111
    s_nop 0
    v_cvt_pk_bf16_f32 v35, v110, v111
    v_mfma_f32_16x16x32_bf16 v[48:51], a[236:239], v[16:19], v[44:47]
    v_mfma_f32_16x16x32_bf16 v[48:51], a[240:243], v[22:25], v[48:51]
    v_mfma_f32_16x16x32_bf16 v[48:51], a[244:247], v[28:31], v[48:51]
    v_mfma_f32_16x16x32_bf16 v[48:51], a[248:251], v[34:37], v[48:51]
    s_nop 15
    s_setpc_b64 s[40:41]
L_rs_start5b:
    s_call_b64 s[40:41], L_rare5_1
    s_branch L_ret_start5b
L_rs_loop5w0a:
    s_call_b64 s[40:41], L_rare5_0
    s_branch L_ret_loop5w0a
L_rs_loop5w0b:
    s_call_b64 s[40:41], L_rare5_1
    s_branch L_ret_loop5w0b
L_rs_loop5w1a:
    s_call_b64 s[40:41], L_rare5_0
    s_branch L_ret_loop5w1a
L_rs_loop5w1b:
    s_call_b64 s[40:41], L_rare5_1
    s_branch L_ret_loop5w1b
L_rs_end5a:
    s_call_b64 s[40:41], L_rare5_0
    s_branch L_ret_end5a
L_rs_end5b:
    s_call_b64 s[40:41], L_rare5_1
    s_branch L_ret_end5b
L_rs_start4b:
    s_call_b64 s[40:41], L_rare4_1
    s_branch L_ret_start4b
L_rs_loop4w0a:
    s_call_b64 s[40:41], L_rare4_0
    s_branch L_ret_loop4w0a
L_rs_loop4w0b:
    s_call_b64 s[40:41], L_rare4_1
    s_branch L_ret_loop4w0b
L_rs_end4a:
    s_call_b64 s[40:41], L_rare4_0
    s_branch L_ret_end4a
L_rs_end4b:
    s_call_b64 s[40:41], L_rare4_1
    s_branch L_ret_end4b
L_rs_tr54a:
    s_call_b64 s[40:41], L_rare5_0
    s_branch L_ret_tr54a
L_rs_tr54b:
    s_nop 15
    s_waitcnt vmcnt(0) lgkmcnt(0)
    s_mov_b32 s68, s14
    s_mov_b32 s14, 166723584
    v_mbcnt_lo_u32_b32 v105, -1, 0
    v_mbcnt_hi_u32_b32 v105, -1, v105
    v_and_b32 v104, 15, v105
    v_mul_u32_u24 v104, 384, v104
    v_lshrrev_b32 v105, 4, v105
    v_lshl_add_u32 v104, v105, 4, v104
    s_add_u32 s69, s34, 0
    buffer_load_dwordx4 a[96:99], v104, s[12:15], s69 offen offset:0
    buffer_load_dwordx4 a[100:103], v104, s[12:15], s69 offen offset:64
    buffer_load_dwordx4 a[104:107], v104, s[12:15], s69 offen offset:128
    buffer_load_dwordx4 a[108:111], v104, s[12:15], s69 offen offset:192
    buffer_load_dwordx4 a[112:115], v104, s[12:15], s69 offen offset:256
    buffer_load_dwordx4 a[116:119], v104, s[12:15], s69 offen offset:320
    s_add_u32 s69, s34, 6144
    buffer_load_dwordx4 a[120:123], v104, s[12:15], s69 offen offset:0
    buffer_load_dwordx4 a[124:127], v104, s[12:15], s69 offen offset:64
    buffer_load_dwordx4 a[128:131], v104, s[12:15], s69 offen offset:128
    buffer_load_dwordx4 a[132:135], v104, s[12:15], s69 offen offset:192
    buffer_load_dwordx4 a[136:139], v104, s[12:15], s69 offen offset:256
    buffer_load_dwordx4 a[140:143], v104, s[12:15], s69 offen offset:320
    s_add_u32 s69, s34, 12288
    buffer_load_dwordx4 a[144:147], v104, s[12:15], s69 offen offset:0
    buffer_load_dwordx4 a[148:151], v104, s[12:15], s69 offen offset:64
    buffer_load_dwordx4 a[152:155], v104, s[12:15], s69 offen offset:128
    buffer_load_dwordx4 a[156:159], v104, s[12:15], s69 offen offset:192
    buffer_load_dwordx4 a[160:163], v104, s[12:15], s69 offen offset:256
    buffer_load_dwordx4 a[164:167], v104, s[12:15], s69 offen offset:320
    s_add_u32 s69, s34, 18432
    buffer_load_dwordx4 a[168:171], v104, s[12:15], s69 offen offset:0
    buffer_load_dwordx4 a[172:175], v104, s[12:15], s69 offen offset:64
    buffer_load_dwordx4 a[176:179], v104, s[12:15], s69 offen offset:128
    buffer_load_dwordx4 a[180:183], v104, s[12:15], s69 offen offset:192
    buffer_load_dwordx4 a[184:187], v104, s[12:15], s69 offen offset:256
    buffer_load_dwordx4 a[188:191], v104, s[12:15], s69 offen offset:320
    s_add_u32 s69, s34, 24576
    buffer_load_dwordx4 a[192:195], v104, s[12:15], s69 offen offset:0
    buffer_load_dwordx4 a[196:199], v104, s[12:15], s69 offen offset:64
    buffer_load_dwordx4 a[200:203], v104, s[12:15], s69 offen offset:128
    buffer_load_dwordx4 a[204:207], v104, s[12:15], s69 offen offset:192
    buffer_load_dwordx4 a[208:211], v104, s[12:15], s69 offen offset:256
    buffer_load_dwordx4 v[92:95], v104, s[12:15], s69 offen offset:320
    s_waitcnt vmcnt(0)
    s_call_b64 s[40:41], L_rare5_1
    v_mbcnt_lo_u32_b32 v105, -1, 0
    v_mbcnt_hi_u32_b32 v105, -1, v105
    v_and_b32 v104, 15, v105
    v_mul_u32_u24 v104, 384, v104
    v_lshrrev_b32 v105, 4, v105
    v_lshl_add_u32 v104, v105, 4, v104
    s_add_u32 s69, s33, 0
    buffer_load_dwordx4 a[96:99], v104, s[12:15], s69 offen offset:0
    buffer_load_dwordx4 a[100:103], v104, s[12:15], s69 offen offset:64
    buffer_load_dwordx4 a[104:107], v104, s[12:15], s69 offen offset:128
    buffer_load_dwordx4 a[108:111], v104, s[12:15], s69 offen offset:192
    buffer_load_dwordx4 a[112:115], v104, s[12:15], s69 offen offset:256
    buffer_load_dwordx4 a[116:119], v104, s[12:15], s69 offen offset:320
    s_add_u32 s69, s33, 6144
    buffer_load_dwordx4 a[120:123], v104, s[12:15], s69 offen offset:0
    buffer_load_dwordx4 a[124:127], v104, s[12:15], s69 offen offset:64
    buffer_load_dwordx4 a[128:131], v104, s[12:15], s69 offen offset:128
    buffer_load_dwordx4 a[132:135], v104, s[12:15], s69 offen offset:192
    buffer_load_dwordx4 a[136:139], v104, s[12:15], s69 offen offset:256
    buffer_load_dwordx4 a[140:143], v104, s[12:15], s69 offen offset:320
    s_add_u32 s69, s33, 12288
    buffer_load_dwordx4 a[144:147], v104, s[12:15], s69 offen offset:0
    buffer_load_dwordx4 a[148:151], v104, s[12:15], s69 offen offset:64
    buffer_load_dwordx4 a[152:155], v104, s[12:15], s69 offen offset:128
    buffer_load_dwordx4 a[156:159], v104, s[12:15], s69 offen offset:192
    buffer_load_dwordx4 a[160:163], v104, s[12:15], s69 offen offset:256
    buffer_load_dwordx4 a[164:167], v104, s[12:15], s69 offen offset:320
    s_add_u32 s69, s33, 18432
    buffer_load_dwordx4 a[168:171], v104, s[12:15], s69 offen offset:0
    buffer_load_dwordx4 a[172:175], v104, s[12:15], s69 offen offset:64
    buffer_load_dwordx4 a[176:179], v104, s[12:15], s69 offen offset:128
    buffer_load_dwordx4 a[180:183], v104, s[12:15], s69 offen offset:192
    buffer_load_dwordx4 a[184:187], v104, s[12:15], s69 offen offset:256
    buffer_load_dwordx4 a[188:191], v104, s[12:15], s69 offen offset:320
    s_waitcnt vmcnt(0)
    s_mov_b32 s14, s68
    s_branch L_ret_tr54b
L_rs_tr54d:
    s_call_b64 s[40:41], L_rare4_1
    s_branch L_ret_tr54d
L_rs_tr45a:
    s_call_b64 s[40:41], L_rare4_0
    s_branch L_ret_tr45a
L_rs_tr45b:
    s_nop 15
    s_waitcnt vmcnt(0) lgkmcnt(0)
    s_mov_b32 s68, s14
    s_mov_b32 s14, 166723584
    v_mbcnt_lo_u32_b32 v105, -1, 0
    v_mbcnt_hi_u32_b32 v105, -1, v105
    v_and_b32 v104, 15, v105
    v_mul_u32_u24 v104, 384, v104
    v_lshrrev_b32 v105, 4, v105
    v_lshl_add_u32 v104, v105, 4, v104
    s_add_u32 s69, s34, 0
    buffer_load_dwordx4 a[96:99], v104, s[12:15], s69 offen offset:0
    buffer_load_dwordx4 a[100:103], v104, s[12:15], s69 offen offset:64
    buffer_load_dwordx4 a[104:107], v104, s[12:15], s69 offen offset:128
    buffer_load_dwordx4 a[108:111], v104, s[12:15], s69 offen offset:192
    buffer_load_dwordx4 a[112:115], v104, s[12:15], s69 offen offset:256
    buffer_load_dwordx4 a[116:119], v104, s[12:15], s69 offen offset:320
    s_add_u32 s69, s34, 6144
    buffer_load_dwordx4 a[120:123], v104, s[12:15], s69 offen offset:0
    buffer_load_dwordx4 a[124:127], v104, s[12:15], s69 offen offset:64
    buffer_load_dwordx4 a[128:131], v104, s[12:15], s69 offen offset:128
    buffer_load_dwordx4 a[132:135], v104, s[12:15], s69 offen offset:192
    buffer_load_dwordx4 a[136:139], v104, s[12:15], s69 offen offset:256
    buffer_load_dwordx4 a[140:143], v104, s[12:15], s69 offen offset:320
    s_add_u32 s69, s34, 12288
    buffer_load_dwordx4 a[144:147], v104, s[12:15], s69 offen offset:0
    buffer_load_dwordx4 a[148:151], v104, s[12:15], s69 offen offset:64
    buffer_load_dwordx4 a[152:155], v104, s[12:15], s69 offen offset:128
    buffer_load_dwordx4 a[156:159], v104, s[12:15], s69 offen offset:192
    buffer_load_dwordx4 a[160:163], v104, s[12:15], s69 offen offset:256
    buffer_load_dwordx4 a[164:167], v104, s[12:15], s69 offen offset:320
    s_add_u32 s69, s34, 18432
    buffer_load_dwordx4 a[168:171], v104, s[12:15], s69 offen offset:0
    buffer_load_dwordx4 a[172:175], v104, s[12:15], s69 offen offset:64
    buffer_load_dwordx4 a[176:179], v104, s[12:15], s69 offen offset:128
    buffer_load_dwordx4 a[180:183], v104, s[12:15], s69 offen offset:192
    buffer_load_dwordx4 a[184:187], v104, s[12:15], s69 offen offset:256
    buffer_load_dwordx4 a[188:191], v104, s[12:15], s69 offen offset:320
    s_waitcnt vmcnt(0)
    s_call_b64 s[40:41], L_rare4_1
    v_mbcnt_lo_u32_b32 v105, -1, 0
    v_mbcnt_hi_u32_b32 v105, -1, v105
    v_and_b32 v104, 15, v105
    v_mul_u32_u24 v104, 384, v104
    v_lshrrev_b32 v105, 4, v105
    v_lshl_add_u32 v104, v105, 4, v104
    s_add_u32 s69, s33, 0
    buffer_load_dwordx4 a[96:99], v104, s[12:15], s69 offen offset:0
    buffer_load_dwordx4 a[100:103], v104, s[12:15], s69 offen offset:64
    buffer_load_dwordx4 a[104:107], v104, s[12:15], s69 offen offset:128
    buffer_load_dwordx4 a[108:111], v104, s[12:15], s69 offen offset:192
    buffer_load_dwordx4 a[112:115], v104, s[12:15], s69 offen offset:256
    buffer_load_dwordx4 a[116:119], v104, s[12:15], s69 offen offset:320
    s_add_u32 s69, s33, 6144
    buffer_load_dwordx4 a[120:123], v104, s[12:15], s69 offen offset:0
    buffer_load_dwordx4 a[124:127], v104, s[12:15], s69 offen offset:64
    buffer_load_dwordx4 a[128:131], v104, s[12:15], s69 offen offset:128
    buffer_load_dwordx4 a[132:135], v104, s[12:15], s69 offen offset:192
    buffer_load_dwordx4 a[136:139], v104, s[12:15], s69 offen offset:256
    buffer_load_dwordx4 a[140:143], v104, s[12:15], s69 offen offset:320
    s_add_u32 s69, s33, 12288
    buffer_load_dwordx4 a[144:147], v104, s[12:15], s69 offen offset:0
    buffer_load_dwordx4 a[148:151], v104, s[12:15], s69 offen offset:64
    buffer_load_dwordx4 a[152:155], v104, s[12:15], s69 offen offset:128
    buffer_load_dwordx4 a[156:159], v104, s[12:15], s69 offen offset:192
    buffer_load_dwordx4 a[160:163], v104, s[12:15], s69 offen offset:256
    buffer_load_dwordx4 a[164:167], v104, s[12:15], s69 offen offset:320
    s_add_u32 s69, s33, 18432
    buffer_load_dwordx4 a[168:171], v104, s[12:15], s69 offen offset:0
    buffer_load_dwordx4 a[172:175], v104, s[12:15], s69 offen offset:64
    buffer_load_dwordx4 a[176:179], v104, s[12:15], s69 offen offset:128
    buffer_load_dwordx4 a[180:183], v104, s[12:15], s69 offen offset:192
    buffer_load_dwordx4 a[184:187], v104, s[12:15], s69 offen offset:256
    buffer_load_dwordx4 a[188:191], v104, s[12:15], s69 offen offset:320
    s_add_u32 s69, s33, 24576
    buffer_load_dwordx4 a[192:195], v104, s[12:15], s69 offen offset:0
    buffer_load_dwordx4 a[196:199], v104, s[12:15], s69 offen offset:64
    buffer_load_dwordx4 a[200:203], v104, s[12:15], s69 offen offset:128
    buffer_load_dwordx4 a[204:207], v104, s[12:15], s69 offen offset:192
    buffer_load_dwordx4 a[208:211], v104, s[12:15], s69 offen offset:256
    buffer_load_dwordx4 v[92:95], v104, s[12:15], s69 offen offset:320
    s_waitcnt vmcnt(0)
    s_mov_b32 s14, s68
    s_branch L_ret_tr45b
L_rs_tr45d:
    s_call_b64 s[40:41], L_rare5_1
    s_branch L_ret_tr45d
L_rs_tr44a:
    s_call_b64 s[40:41], L_rare4_0
    s_branch L_ret_tr44a
L_rs_tr44b:
    s_nop 15
    s_waitcnt vmcnt(0) lgkmcnt(0)
    s_mov_b32 s68, s14
    s_mov_b32 s14, 166723584
    v_mbcnt_lo_u32_b32 v105, -1, 0
    v_mbcnt_hi_u32_b32 v105, -1, v105
    v_and_b32 v104, 15, v105
    v_mul_u32_u24 v104, 384, v104
    v_lshrrev_b32 v105, 4, v105
    v_lshl_add_u32 v104, v105, 4, v104
    s_add_u32 s69, s34, 0
    buffer_load_dwordx4 a[96:99], v104, s[12:15], s69 offen offset:0
    buffer_load_dwordx4 a[100:103], v104, s[12:15], s69 offen offset:64
    buffer_load_dwordx4 a[104:107], v104, s[12:15], s69 offen offset:128
    buffer_load_dwordx4 a[108:111], v104, s[12:15], s69 offen offset:192
    buffer_load_dwordx4 a[112:115], v104, s[12:15], s69 offen offset:256
    buffer_load_dwordx4 a[116:119], v104, s[12:15], s69 offen offset:320
    s_add_u32 s69, s34, 6144
    buffer_load_dwordx4 a[120:123], v104, s[12:15], s69 offen offset:0
    buffer_load_dwordx4 a[124:127], v104, s[12:15], s69 offen offset:64
    buffer_load_dwordx4 a[128:131], v104, s[12:15], s69 offen offset:128
    buffer_load_dwordx4 a[132:135], v104, s[12:15], s69 offen offset:192
    buffer_load_dwordx4 a[136:139], v104, s[12:15], s69 offen offset:256
    buffer_load_dwordx4 a[140:143], v104, s[12:15], s69 offen offset:320
    s_add_u32 s69, s34, 12288
    buffer_load_dwordx4 a[144:147], v104, s[12:15], s69 offen offset:0
    buffer_load_dwordx4 a[148:151], v104, s[12:15], s69 offen offset:64
    buffer_load_dwordx4 a[152:155], v104, s[12:15], s69 offen offset:128
    buffer_load_dwordx4 a[156:159], v104, s[12:15], s69 offen offset:192
    buffer_load_dwordx4 a[160:163], v104, s[12:15], s69 offen offset:256
    buffer_load_dwordx4 a[164:167], v104, s[12:15], s69 offen offset:320
    s_add_u32 s69, s34, 18432
    buffer_load_dwordx4 a[168:171], v104, s[12:15], s69 offen offset:0
    buffer_load_dwordx4 a[172:175], v104, s[12:15], s69 offen offset:64
    buffer_load_dwordx4 a[176:179], v104, s[12:15], s69 offen offset:128
    buffer_load_dwordx4 a[180:183], v104, s[12:15], s69 offen offset:192
    buffer_load_dwordx4 a[184:187], v104, s[12:15], s69 offen offset:256
    buffer_load_dwordx4 a[188:191], v104, s[12:15], s69 offen offset:320
    s_waitcnt vmcnt(0)
    s_call_b64 s[40:41], L_rare4_1
    v_mbcnt_lo_u32_b32 v105, -1, 0
    v_mbcnt_hi_u32_b32 v105, -1, v105
    v_and_b32 v104, 15, v105
    v_mul_u32_u24 v104, 384, v104
    v_lshrrev_b32 v105, 4, v105
    v_lshl_add_u32 v104, v105, 4, v104
    s_add_u32 s69, s33, 0
    buffer_load_dwordx4 a[96:99], v104, s[12:15], s69 offen offset:0
    buffer_load_dwordx4 a[100:103], v104, s[12:15], s69 offen offset:64
    buffer_load_dwordx4 a[104:107], v104, s[12:15], s69 offen offset:128
    buffer_load_dwordx4 a[108:111], v104, s[12:15], s69 offen offset:192
    buffer_load_dwordx4 a[112:115], v104, s[12:15], s69 offen offset:256
    buffer_load_dwordx4 a[116:119], v104, s[12:15], s69 offen offset:320
    s_add_u32 s69, s33, 6144
    buffer_load_dwordx4 a[120:123], v104, s[12:15], s69 offen offset:0
    buffer_load_dwordx4 a[124:127], v104, s[12:15], s69 offen offset:64
    buffer_load_dwordx4 a[128:131], v104, s[12:15], s69 offen offset:128
    buffer_load_dwordx4 a[132:135], v104, s[12:15], s69 offen offset:192
    buffer_load_dwordx4 a[136:139], v104, s[12:15], s69 offen offset:256
    buffer_load_dwordx4 a[140:143], v104, s[12:15], s69 offen offset:320
    s_add_u32 s69, s33, 12288
    buffer_load_dwordx4 a[144:147], v104, s[12:15], s69 offen offset:0
    buffer_load_dwordx4 a[148:151], v104, s[12:15], s69 offen offset:64
    buffer_load_dwordx4 a[152:155], v104, s[12:15], s69 offen offset:128
    buffer_load_dwordx4 a[156:159], v104, s[12:15], s69 offen offset:192
    buffer_load_dwordx4 a[160:163], v104, s[12:15], s69 offen offset:256
    buffer_load_dwordx4 a[164:167], v104, s[12:15], s69 offen offset:320
    s_add_u32 s69, s33, 18432
    buffer_load_dwordx4 a[168:171], v104, s[12:15], s69 offen offset:0
    buffer_load_dwordx4 a[172:175], v104, s[12:15], s69 offen offset:64
    buffer_load_dwordx4 a[176:179], v104, s[12:15], s69 offen offset:128
    buffer_load_dwordx4 a[180:183], v104, s[12:15], s69 offen offset:192
    buffer_load_dwordx4 a[184:187], v104, s[12:15], s69 offen offset:256
    buffer_load_dwordx4 a[188:191], v104, s[12:15], s69 offen offset:320
    s_waitcnt vmcnt(0)
    s_mov_b32 s14, s68
    s_branch L_ret_tr44b
L_rs_tr44d:
    s_call_b64 s[40:41], L_rare4_1
    s_branch L_ret_tr44d
L_rs_tr55a:
    s_call_b64 s[40:41], L_rare5_0
    s_branch L_ret_tr55a
L_rs_tr55b:
    s_nop 15
    s_waitcnt vmcnt(0) lgkmcnt(0)
    s_mov_b32 s68, s14
    s_mov_b32 s14, 166723584
    v_mbcnt_lo_u32_b32 v105, -1, 0
    v_mbcnt_hi_u32_b32 v105, -1, v105
    v_and_b32 v104, 15, v105
    v_mul_u32_u24 v104, 384, v104
    v_lshrrev_b32 v105, 4, v105
    v_lshl_add_u32 v104, v105, 4, v104
    s_add_u32 s69, s34, 0
    buffer_load_dwordx4 a[96:99], v104, s[12:15], s69 offen offset:0
    buffer_load_dwordx4 a[100:103], v104, s[12:15], s69 offen offset:64
    buffer_load_dwordx4 a[104:107], v104, s[12:15], s69 offen offset:128
    buffer_load_dwordx4 a[108:111], v104, s[12:15], s69 offen offset:192
    buffer_load_dwordx4 a[112:115], v104, s[12:15], s69 offen offset:256
    buffer_load_dwordx4 a[116:119], v104, s[12:15], s69 offen offset:320
    s_add_u32 s69, s34, 6144
    buffer_load_dwordx4 a[120:123], v104, s[12:15], s69 offen offset:0
    buffer_load_dwordx4 a[124:127], v104, s[12:15], s69 offen offset:64
    buffer_load_dwordx4 a[128:131], v104, s[12:15], s69 offen offset:128
    buffer_load_dwordx4 a[132:135], v104, s[12:15], s69 offen offset:192
    buffer_load_dwordx4 a[136:139], v104, s[12:15], s69 offen offset:256
    buffer_load_dwordx4 a[140:143], v104, s[12:15], s69 offen offset:320
    s_add_u32 s69, s34, 12288
    buffer_load_dwordx4 a[144:147], v104, s[12:15], s69 offen offset:0
    buffer_load_dwordx4 a[148:151], v104, s[12:15], s69 offen offset:64
    buffer_load_dwordx4 a[152:155], v104, s[12:15], s69 offen offset:128
    buffer_load_dwordx4 a[156:159], v104, s[12:15], s69 offen offset:192
    buffer_load_dwordx4 a[160:163], v104, s[12:15], s69 offen offset:256
    buffer_load_dwordx4 a[164:167], v104, s[12:15], s69 offen offset:320
    s_add_u32 s69, s34, 18432
    buffer_load_dwordx4 a[168:171], v104, s[12:15], s69 offen offset:0
    buffer_load_dwordx4 a[172:175], v104, s[12:15], s69 offen offset:64
    buffer_load_dwordx4 a[176:179], v104, s[12:15], s69 offen offset:128
    buffer_load_dwordx4 a[180:183], v104, s[12:15], s69 offen offset:192
    buffer_load_dwordx4 a[184:187], v104, s[12:15], s69 offen offset:256
    buffer_load_dwordx4 a[188:191], v104, s[12:15], s69 offen offset:320
    s_add_u32 s69, s34, 24576
    buffer_load_dwordx4 a[192:195], v104, s[12:15], s69 offen offset:0
    buffer_load_dwordx4 a[196:199], v104, s[12:15], s69 offen offset:64
    buffer_load_dwordx4 a[200:203], v104, s[12:15], s69 offen offset:128
    buffer_load_dwordx4 a[204:207], v104, s[12:15], s69 offen offset:192
    buffer_load_dwordx4 a[208:211], v104, s[12:15], s69 offen offset:256
    buffer_load_dwordx4 v[92:95], v104, s[12:15], s69 offen offset:320
    s_waitcnt vmcnt(0)
    s_call_b64 s[40:41], L_rare5_1
    v_mbcnt_lo_u32_b32 v105, -1, 0
    v_mbcnt_hi_u32_b32 v105, -1, v105
    v_and_b32 v104, 15, v105
    v_mul_u32_u24 v104, 384, v104
    v_lshrrev_b32 v105, 4, v105
    v_lshl_add_u32 v104, v105, 4, v104
    s_add_u32 s69, s33, 0
    buffer_load_dwordx4 a[96:99], v104, s[12:15], s69 offen offset:0
    buffer_load_dwordx4 a[100:103], v104, s[12:15], s69 offen offset:64
    buffer_load_dwordx4 a[104:107], v104, s[12:15], s69 offen offset:128
    buffer_load_dwordx4 a[108:111], v104, s[12:15], s69 offen offset:192
    buffer_load_dwordx4 a[112:115], v104, s[12:15], s69 offen offset:256
    buffer_load_dwordx4 a[116:119], v104, s[12:15], s69 offen offset:320
    s_add_u32 s69, s33, 6144
    buffer_load_dwordx4 a[120:123], v104, s[12:15], s69 offen offset:0
    buffer_load_dwordx4 a[124:127], v104, s[12:15], s69 offen offset:64
    buffer_load_dwordx4 a[128:131], v104, s[12:15], s69 offen offset:128
    buffer_load_dwordx4 a[132:135], v104, s[12:15], s69 offen offset:192
    buffer_load_dwordx4 a[136:139], v104, s[12:15], s69 offen offset:256
    buffer_load_dwordx4 a[140:143], v104, s[12:15], s69 offen offset:320
    s_add_u32 s69, s33, 12288
    buffer_load_dwordx4 a[144:147], v104, s[12:15], s69 offen offset:0
    buffer_load_dwordx4 a[148:151], v104, s[12:15], s69 offen offset:64
    buffer_load_dwordx4 a[152:155], v104, s[12:15], s69 offen offset:128
    buffer_load_dwordx4 a[156:159], v104, s[12:15], s69 offen offset:192
    buffer_load_dwordx4 a[160:163], v104, s[12:15], s69 offen offset:256
    buffer_load_dwordx4 a[164:167], v104, s[12:15], s69 offen offset:320
    s_add_u32 s69, s33, 18432
    buffer_load_dwordx4 a[168:171], v104, s[12:15], s69 offen offset:0
    buffer_load_dwordx4 a[172:175], v104, s[12:15], s69 offen offset:64
    buffer_load_dwordx4 a[176:179], v104, s[12:15], s69 offen offset:128
    buffer_load_dwordx4 a[180:183], v104, s[12:15], s69 offen offset:192
    buffer_load_dwordx4 a[184:187], v104, s[12:15], s69 offen offset:256
    buffer_load_dwordx4 a[188:191], v104, s[12:15], s69 offen offset:320
    s_add_u32 s69, s33, 24576
    buffer_load_dwordx4 a[192:195], v104, s[12:15], s69 offen offset:0
    buffer_load_dwordx4 a[196:199], v104, s[12:15], s69 offen offset:64
    buffer_load_dwordx4 a[200:203], v104, s[12:15], s69 offen offset:128
    buffer_load_dwordx4 a[204:207], v104, s[12:15], s69 offen offset:192
    buffer_load_dwordx4 a[208:211], v104, s[12:15], s69 offen offset:256
    buffer_load_dwordx4 v[92:95], v104, s[12:15], s69 offen offset:320
    s_waitcnt vmcnt(0)
    s_mov_b32 s14, s68
    s_branch L_ret_tr55b
L_rs_tr55d:
    s_call_b64 s[40:41], L_rare5_1
    s_branch L_ret_tr55d
.section .rodata,"a"
.p2align 6
.amdhsa_kernel standalone__gqa_softmax__near_ridge_kernel
  .amdhsa_next_free_vgpr 512
  .amdhsa_next_free_sgpr 102
  .amdhsa_accum_offset 256
  .amdhsa_group_segment_fixed_size 0
  .amdhsa_kernarg_size 48
  .amdhsa_user_sgpr_count 2
  .amdhsa_user_sgpr_kernarg_segment_ptr 1
  .amdhsa_system_sgpr_workgroup_id_x 1
.end_amdhsa_kernel
```

```asm
; @launch grid=(256,1,1) block=(256,1,1) lds=163840
.amdgcn_target "amdgcn-amd-amdhsa--gfx950"
.text
.globl standalone__gqa_softmax__near_ridge_kernel
.p2align 8
.type standalone__gqa_softmax__near_ridge_kernel,@function
standalone__gqa_softmax__near_ridge_kernel:
    s_cmp_ge_u32 s2, 256
    s_cbranch_scc1 L_end
    s_load_dwordx4 s[84:87], s[0:1], 0
    s_load_dwordx4 s[88:91], s[0:1], 16
    v_lshrrev_b32 v110, 6, v0
    v_and_b32 v111, 63, v0
    s_getpc_b64 s[60:61]
L_pc:
    s_lshr_b32 s62, s2, 3
    v_lshl_add_u32 v53, s62, 2, v110
    v_min_u32 v52, ((L_codeend-L_pc+16383)/16384)-1, v111
    v_mul_u32_u24 v53, ((L_codeend-L_pc+16383)/16384), v53
    v_add_lshl_u32 v52, v52, v53, 7
    v_min_u32 v52, L_codeend-L_pc-4, v52
    global_load_dword v53, v52, s[60:61]
    v_readfirstlane_b32 s3, v110
    v_lshrrev_b32 v96, 3, v111
    v_mul_u32_u24 v7, 384, v96
    v_lshrrev_b32 v97, 1, v96
    v_lshlrev_b32 v97, 1, v97
    v_and_b32 v98, 7, v111
    v_xor_b32 v97, v97, v98
    v_lshl_add_u32 v7, v97, 4, v7
    s_and_b32 s65, s3, 1
    s_mul_i32 s42, s65, 80
    s_mul_i32 s43, s65, 3072
    v_xor_b32 v6, s42, v7
    v_xor_b32 v7, 80, v6
    v_add_u32 v6, s43, v6
    s_sub_u32 s43, 3072, s43
    v_add_u32 v7, s43, v7
    s_mov_b32 s28, 0x3dd53b95
    s_mov_b32 s29, 0x3e800000
    s_mov_b32 s49, 5888
    s_mov_b32 s66, 0x28301800
    s_mov_b32 s46, 0
    s_mov_b32 s47, -1
    s_and_b32 s42, s2, 7
    s_lshr_b32 s43, s2, 3
    s_mul_i32 s44, s43, 43
    s_lshr_b32 s44, s44, 7
    s_mov_b32 s39, s44
    s_mul_i32 s45, s44, 3
    s_sub_u32 s36, s43, s45
    s_lshl_b32 s42, s42, 6
    s_lshl_b32 s45, s45, 1
    s_add_u32 s42, s42, s45
    s_mul_i32 s64, s42, 196608
    s_mul_i32 s35, s42, 325632
    s_lshr_b32 s42, s44, 1
    s_mov_b32 s31, 0x5a005a0
    s_cmp_eq_u32 s42, 1
    s_cselect_b32 s31, 0x5a005a0, s31
    s_cmp_eq_u32 s42, 2
    s_cselect_b32 s31, 0x5a005a0, s31
    s_cmp_eq_u32 s42, 3
    s_cselect_b32 s31, 0x5a005a0, s31
    s_cmp_eq_u32 s42, 4
    s_cselect_b32 s31, 0x5a005a0, s31
    s_and_b32 s42, s44, 1
    s_lshl_b32 s42, s42, 4
    s_lshr_b32 s31, s31, s42
    s_and_b32 s31, s31, 0xffff
    s_cmp_eq_u32 s43, 30
    s_cselect_b32 s31, 0x120648, s31
    s_cmp_eq_u32 s43, 31
    s_cselect_b32 s31, 0x240219, s31
    s_lshr_b32 s63, s31, 16
    s_cmp_ge_u32 s43, 30
    s_cselect_b32 s36, 0, s36
    s_cselect_b32 s42, 4, 6
    s_mul_i32 s42, s42, 196608
    s_add_u32 s6, s64, s42
    s_mov_b32 s10, s6
    s_mul_i32 s22, s3, 3072
    s_mul_i32 s38, s3, 28672
    s_add_u32 s38, s38, 49152
    s_and_b32 s42, s3, 2
    s_mul_i32 s42, s42, 3072
    s_add_u32 s20, s64, s42
    s_mov_b32 s21, s20
    s_mov_b32 s14, 166723584
    s_mov_b32 s18, 0
    s_mov_b32 s67, 0
    s_mov_b32 s37, 0
    s_lshl_b32 s42, s37, 1
    s_lshr_b32 s42, s31, s42
    s_and_b32 s42, s42, 3
    s_add_u32 s42, s42, s36
    s_sub_u32 s43, s42, 3
    s_cmp_ge_u32 s42, 3
    s_cselect_b32 s42, s43, s42
    s_mul_i32 s44, s3, 5
    s_mov_b32 s32, 1
    s_lshl_b32 s43, s3, 2
    s_add_u32 s45, s43, 21
    s_cmp_eq_u32 s3, 0
    s_cselect_b32 s45, 20, s45
    s_cselect_b32 s34, 1, 0
    s_cmp_eq_u32 s42, 1
    s_cselect_b32 s44, s45, s44
    s_cselect_b32 s32, s34, s32
    s_add_u32 s45, s43, 37
    s_cmp_eq_u32 s42, 2
    s_cselect_b32 s44, s45, s44
    s_cselect_b32 s32, 0, s32
    s_mul_i32 s44, s44, 6144
    s_add_u32 s34, s35, s44
    s_waitcnt lgkmcnt(0)
    s_mov_b32 s12, s84
    s_and_b32 s13, s85, 0xffff
    s_mov_b32 s15, 0x20000
    s_mov_b32 s4, s86
    s_and_b32 s5, s87, 0xffff
    s_mov_b32 s7, 0x20000
    s_mov_b32 s8, s88
    s_and_b32 s9, s89, 0xffff
    s_mov_b32 s11, 0x20000
    s_mov_b32 s16, s90
    s_and_b32 s17, s91, 0xffff
    s_mov_b32 s19, 0x20000
    s_cmp_eq_u32 s32, 0
    s_cbranch_scc1 L_start4
L_start5:
    s_add_u32 m0, s22, 0
    s_nop 0
    buffer_load_dwordx4 v6, s[4:7], s20 offen lds
    s_add_u32 s20, s20, 128
    s_add_u32 m0, s22, 1024
    s_nop 0
    buffer_load_dwordx4 v6, s[4:7], s20 offen lds
    s_add_u32 s20, s20, 128
    s_add_u32 m0, s22, 2048
    s_nop 0
    buffer_load_dwordx4 v6, s[4:7], s20 offen lds
    s_add_u32 s20, s20, 12032
    s_add_u32 m0, s22, 12288
    s_nop 0
    buffer_load_dwordx4 v6, s[4:7], s20 offen lds
    s_add_u32 s20, s20, 128
    s_add_u32 m0, s22, 13312
    s_nop 0
    buffer_load_dwordx4 v6, s[4:7], s20 offen lds
    s_add_u32 s20, s20, 128
    s_add_u32 m0, s22, 14336
    s_nop 0
    buffer_load_dwordx4 v6, s[4:7], s20 offen lds
    s_add_u32 s20, s20, 12032
    s_add_u32 s48, s34, 0
    s_add_u32 m0, s38, 0
    s_nop 0
    buffer_load_dwordx4 v6, s[12:15], s48 offen nt lds
    s_add_u32 m0, s38, 1024
    s_nop 0
    buffer_load_dwordx4 v7, s[12:15], s48 offen nt lds
    s_add_u32 s48, s34, 128
    s_add_u32 m0, s38, 2048
    s_nop 0
    buffer_load_dwordx4 v6, s[12:15], s48 offen nt lds
    s_add_u32 m0, s38, 3072
    s_nop 0
    buffer_load_dwordx4 v7, s[12:15], s48 offen nt lds
    s_add_u32 s48, s34, 256
    s_add_u32 m0, s38, 4096
    s_nop 0
    buffer_load_dwordx4 v6, s[12:15], s48 offen nt lds
    s_add_u32 m0, s38, 5120
    s_nop 0
    buffer_load_dwordx4 v7, s[12:15], s48 offen nt lds
    s_add_u32 s48, s34, 6144
    s_add_u32 m0, s38, 6144
    s_nop 0
    buffer_load_dwordx4 v6, s[12:15], s48 offen nt lds
    s_add_u32 m0, s38, 7168
    s_nop 0
    buffer_load_dwordx4 v7, s[12:15], s48 offen nt lds
    s_add_u32 s48, s34, 6272
    s_add_u32 m0, s38, 8192
    s_nop 0
    buffer_load_dwordx4 v6, s[12:15], s48 offen nt lds
    s_add_u32 m0, s38, 9216
    s_nop 0
    buffer_load_dwordx4 v7, s[12:15], s48 offen nt lds
    s_add_u32 s48, s34, 6400
    s_add_u32 m0, s38, 10240
    s_nop 0
    buffer_load_dwordx4 v6, s[12:15], s48 offen nt lds
    s_add_u32 m0, s38, 11264
    s_nop 0
    buffer_load_dwordx4 v7, s[12:15], s48 offen nt lds
    s_add_u32 s48, s34, 12288
    s_add_u32 m0, s38, 12288
    s_nop 0
    buffer_load_dwordx4 v6, s[12:15], s48 offen nt lds
    s_add_u32 m0, s38, 13312
    s_nop 0
    buffer_load_dwordx4 v7, s[12:15], s48 offen nt lds
    s_add_u32 s48, s34, 12416
    s_add_u32 m0, s38, 14336
    s_nop 0
    buffer_load_dwordx4 v6, s[12:15], s48 offen nt lds
    s_add_u32 m0, s38, 15360
    s_nop 0
    buffer_load_dwordx4 v7, s[12:15], s48 offen nt lds
    s_add_u32 s48, s34, 12544
    s_add_u32 m0, s38, 16384
    s_nop 0
    buffer_load_dwordx4 v6, s[12:15], s48 offen nt lds
    s_add_u32 m0, s38, 17408
    s_nop 0
    buffer_load_dwordx4 v7, s[12:15], s48 offen nt lds
    v_and_b32 v96, 15, v111
    v_lshrrev_b32 v97, 4, v111
    v_lshrrev_b32 v98, 3, v96
    v_and_b32 v99, 7, v96
    v_lshlrev_b32 v0, 7, v99
    v_bfe_u32 v99, v96, 1, 2
    v_lshlrev_b32 v99, 1, v99
    v_mul_u32_u24 v100, 5, v98
    v_xor_b32 v99, v99, v100
    v_xor_b32 v99, v99, v97
    v_lshl_add_u32 v0, v99, 4, v0
    v_mul_u32_u24 v100, 3072, v98
    v_add_u32 v0, v100, v0
    v_xor_b32 v1, 64, v0
    v_lshrrev_b32 v98, 1, v97
    v_mul_u32_u24 v2, 3072, v98
    v_and_b32 v99, 1, v97
    v_bfe_u32 v100, v111, 2, 2
    v_lshl_add_u32 v96, v99, 2, v100
    v_lshl_add_u32 v2, v96, 7, v2
    v_lshrrev_b32 v96, 1, v96
    v_lshlrev_b32 v96, 1, v96
    v_mul_u32_u24 v98, 5, v98
    v_xor_b32 v96, v96, v98
    v_bfe_u32 v99, v111, 1, 1
    v_xor_b32 v96, v96, v99
    v_lshl_add_u32 v2, v96, 4, v2
    v_and_b32 v99, 1, v111
    v_lshl_add_u32 v2, v99, 3, v2
    v_add_u32 v2, 24576, v2
    v_xor_b32 v3, 32, v2
    v_xor_b32 v4, 64, v2
    v_xor_b32 v5, 96, v2
    v_lshl_add_u32 v103, v111, 4, s38
    v_and_b32 v96, 15, v111
    v_lshrrev_b32 v98, 1, v111
    v_and_or_b32 v98, v98, 16, v96
    s_mov_b32 s42, 0x22110033
    v_bfe_i32 v97, s42, v98, 1
    v_and_b32 v97, 0x3f803f80, v97
    v_accvgpr_write_b32 a240, v97
    v_accvgpr_write_b32 a241, v97
    v_accvgpr_write_b32 a242, v97
    v_accvgpr_write_b32 a243, v97
    s_mov_b32 s42, 0x44110055
    v_bfe_i32 v97, s42, v98, 1
    v_and_b32 v97, 0x3f803f80, v97
    v_accvgpr_write_b32 a244, v97
    v_accvgpr_write_b32 a245, v97
    v_accvgpr_write_b32 a246, v97
    v_accvgpr_write_b32 a247, v97
    s_mov_b32 s42, 0x88898889
    v_bfe_i32 v97, s42, v98, 1
    v_and_b32 v97, 0x3f803f80, v97
    v_accvgpr_write_b32 a248, v97
    v_accvgpr_write_b32 a249, v97
    v_accvgpr_write_b32 a250, v97
    v_accvgpr_write_b32 a251, v97
    s_mov_b32 s42, 0x50005
    v_bfe_i32 v97, s42, v98, 1
    v_and_b32 v97, 0x3f803f80, v97
    v_accvgpr_write_b32 a252, v97
    v_accvgpr_write_b32 a253, v97
    v_accvgpr_write_b32 a254, v97
    v_accvgpr_write_b32 a255, v97
    v_bfe_i32 v97, v111, 2, 1
    v_and_b32 v97, 0xaaaa, v97
    v_or_b32 v101, 0x4444, v97
    s_waitcnt vmcnt(18)
    s_barrier
    s_waitcnt vmcnt(12)
    s_add_u32 s48, s34, 18432
    s_add_u32 m0, s38, 18432
    s_nop 0
    buffer_load_dwordx4 v6, s[12:15], s48 offen nt lds
    v_lshrrev_b32 v105, 11, v0
    s_add_u32 m0, s38, 19456
    s_nop 0
    buffer_load_dwordx4 v7, s[12:15], s48 offen nt lds
    ds_read_b128 a[224:227], v0 offset:1024
    s_add_u32 s48, s34, 18560
    s_add_u32 m0, s38, 20480
    s_nop 0
    buffer_load_dwordx4 v6, s[12:15], s48 offen nt lds
    ds_read_b128 a[236:239], v1 offset:2048
    s_add_u32 m0, s38, 21504
    s_nop 0
    buffer_load_dwordx4 v7, s[12:15], s48 offen nt lds
    v_xor_b32 v105, s65, v105
    v_and_b32 v104, 0x3ff, v0
    v_lshl_add_u32 v104, v105, 10, v104
    v_add_u32 v104, s38, v104
    ds_read_b128 a[216:219], v0 offset:0
    s_add_u32 s48, s34, 18688
    s_add_u32 m0, s38, 22528
    s_nop 0
    buffer_load_dwordx4 v6, s[12:15], s48 offen nt lds
    ds_read_b128 a[232:235], v0 offset:2048
    v_xor_b32 v105, 64, v104
    ds_read_b128 a[116:119], v105 offset:4096
    ds_read_b128 a[96:99], v104 offset:0
    ds_read_b128 a[228:231], v1 offset:1024
    s_add_u32 m0, s38, 23552
    s_nop 0
    buffer_load_dwordx4 v7, s[12:15], s48 offen nt lds
    ds_read_b128 a[220:223], v1 offset:0
    ds_read_b128 a[104:107], v104 offset:2048
    v_mbcnt_lo_u32_b32 v107, -1, 0
    s_waitcnt lgkmcnt(3)
    v_mfma_f32_16x16x32_bf16 v[52:55], a[216:219], a[96:99], 0
    ds_read_b128 a[100:103], v105 offset:0
    s_waitcnt lgkmcnt(0)
    v_mfma_f32_16x16x32_bf16 v[52:55], a[220:223], a[100:103], v[52:55]
    ds_read_b128 a[112:115], v104 offset:4096
    v_mfma_f32_16x16x32_bf16 v[52:55], a[224:227], a[104:107], v[52:55]
    ds_read_b128 a[108:111], v105 offset:2048
    v_mbcnt_hi_u32_b32 v107, -1, v107
    s_waitcnt lgkmcnt(0)
    v_mfma_f32_16x16x32_bf16 v[52:55], a[228:231], a[108:111], v[52:55]
    ds_read_b128 a[216:219], v0 offset:6144
    v_mfma_f32_16x16x32_bf16 v[52:55], a[232:235], a[112:115], v[52:55]
    ds_read_b128 a[228:231], v1 offset:7168
    v_mfma_f32_16x16x32_bf16 v[52:55], a[236:239], a[116:119], v[52:55]
    s_nop 7
    v_max3_f32 v96, v52, v53, v54
    ds_read_b128 a[224:227], v0 offset:7168
    ds_read_b128 a[220:223], v1 offset:6144
    s_waitcnt lgkmcnt(3)
    v_mfma_f32_16x16x32_bf16 v[56:59], a[216:219], a[96:99], 0
    ds_read_b128 a[232:235], v0 offset:8192
    s_waitcnt lgkmcnt(1)
    v_mfma_f32_16x16x32_bf16 v[56:59], a[220:223], a[100:103], v[56:59]
    ds_read_b128 a[220:223], v1 offset:12288
    v_mfma_f32_16x16x32_bf16 v[56:59], a[224:227], a[104:107], v[56:59]
    ds_read_b128 a[216:219], v0 offset:12288
    v_mfma_f32_16x16x32_bf16 v[56:59], a[228:231], a[108:111], v[56:59]
    ds_read_b128 a[228:231], v1 offset:13312
    s_waitcnt lgkmcnt(3)
    v_mfma_f32_16x16x32_bf16 v[56:59], a[232:235], a[112:115], v[56:59]
    ds_read_b128 a[236:239], v1 offset:8192
    s_waitcnt lgkmcnt(0)
    v_mfma_f32_16x16x32_bf16 v[56:59], a[236:239], a[116:119], v[56:59]
    s_nop 7
    v_max3_f32 v96, v96, v55, v56
    v_max3_f32 v96, v96, v57, v58
    v_and_b32 v106, 15, v107
    v_max_f32 v96, v96, v59
    v_mov_b32 v97, v96
    s_nop 1
    v_permlane32_swap_b32 v97, v96
    v_max_f32 v96, v96, v97
    v_mov_b32 v97, v96
    ds_read_b128 a[224:227], v0 offset:13312
    v_lshrrev_b32 v107, 4, v107
    v_mul_u32_u24 v106, 384, v106
    v_permlane16_swap_b32 v97, v96
    v_max_f32 v96, v96, v97
    v_mul_f32_e64 v9, -s28, v96
    ds_read_b128 a[232:235], v0 offset:14336
    v_subrev_f32 v9, 0x42000000, v9
    v_fma_f32 v57, v57, s28, v9
    v_fma_f32 v52, v52, s28, v9
    v_fma_f32 v54, v54, s28, v9
    v_fma_f32 v55, v55, s28, v9
    v_exp_f32_e64 v55, v55 clamp
    v_fma_f32 v59, v59, s28, v9
    v_exp_f32_e64 v52, v52 clamp
    v_fma_f32 v53, v53, s28, v9
    v_fma_f32 v58, v58, s28, v9
    v_fma_f32 v56, v56, s28, v9
    v_exp_f32_e64 v54, v54 clamp
    ds_read_b128 a[236:239], v1 offset:14336
    v_lshl_add_u32 v106, v107, 4, v106
    v_exp_f32_e64 v53, v53 clamp
    v_exp_f32_e64 v56, v56 clamp
    v_cvt_pk_bf16_f32 v14, v52, v53
    v_exp_f32_e64 v57, v57 clamp
    v_cvt_pk_bf16_f32 v15, v54, v55
    s_waitcnt vmcnt(12)
    s_add_u32 s48, s34, 24576
    s_add_u32 m0, s38, 24576
    s_nop 0
    buffer_load_dwordx4 v6, s[12:15], s48 offen nt lds
    v_mfma_f32_16x16x32_bf16 v[52:55], a[216:219], a[96:99], 0
    s_add_u32 m0, s38, 25600
    s_nop 0
    buffer_load_dwordx4 v7, s[12:15], s48 offen nt lds
    ds_read_b128 a[128:131], v104 offset:8192
    v_mfma_f32_16x16x32_bf16 v[52:55], a[220:223], a[100:103], v[52:55]
    s_add_u32 s48, s34, 24704
    s_add_u32 m0, s38, 26624
    s_nop 0
    buffer_load_dwordx4 v6, s[12:15], s48 offen nt lds
    ds_read_b128 a[220:223], v1 offset:18432
    s_waitcnt lgkmcnt(2)
    v_mfma_f32_16x16x32_bf16 v[52:55], a[224:227], a[104:107], v[52:55]
    s_add_u32 m0, s38, 27648
    ds_read_b128 a[216:219], v0 offset:18432
    v_exp_f32_e64 v58, v58 clamp
    buffer_load_dwordx4 v7, s[12:15], s48 offen nt lds
    v_mfma_f32_16x16x32_bf16 v[52:55], a[228:231], a[108:111], v[52:55]
    v_cvt_pk_bf16_f32 v16, v56, v57
    s_add_u32 s48, s34, 24576
    v_exp_f32_e64 v59, v59 clamp
    buffer_load_dwordx4 a[208:211], v106, s[12:15], s48 offen offset:256 nt
    ds_read_b128 a[228:231], v1 offset:19456
    v_mfma_f32_16x16x32_bf16 v[52:55], a[232:235], a[112:115], v[52:55]
    ds_read_b128 a[224:227], v0 offset:19456
    ds_read_b128 a[140:143], v105 offset:10240
    v_mfma_f32_16x16x32_bf16 v[52:55], a[236:239], a[116:119], v[52:55]
    buffer_load_dwordx4 a[212:215], v106, s[12:15], s48 offen offset:320 nt
    v_cvt_pk_bf16_f32 v17, v58, v59
    ds_read_b128 a[132:135], v105 offset:8192
    s_waitcnt lgkmcnt(4)
    v_mfma_f32_16x16x32_bf16 v[56:59], a[216:219], a[96:99], 0
    ds_read_b128 a[216:219], v0 offset:0
    v_mfma_f32_16x16x32_bf16 v[56:59], a[220:223], a[100:103], v[56:59]
    ds_read_b128 a[232:235], v0 offset:20480
    s_waitcnt lgkmcnt(4)
    v_mfma_f32_16x16x32_bf16 v[56:59], a[224:227], a[104:107], v[56:59]
    ds_read_b128 a[136:139], v104 offset:10240
    v_mfma_f32_16x16x32_bf16 v[56:59], a[228:231], a[108:111], v[56:59]
    ds_read_b128 a[236:239], v1 offset:20480
    ds_read_b128 a[120:123], v104 offset:6144
    s_waitcnt lgkmcnt(3)
    v_mfma_f32_16x16x32_bf16 v[56:59], a[232:235], a[112:115], v[56:59]
    ds_read_b128 a[224:227], v0 offset:1024
    ds_read_b128 a[228:231], v1 offset:1024
    s_waitcnt lgkmcnt(3)
    v_mfma_f32_16x16x32_bf16 v[56:59], a[236:239], a[116:119], v[56:59]
    s_waitcnt lgkmcnt(2)
    ds_read_b128 a[124:127], v105 offset:6144
    v_mfma_f32_16x16x32_bf16 v[60:63], a[216:219], a[120:123], 0
    ds_read_b128 a[220:223], v1 offset:0
    s_waitcnt lgkmcnt(0)
    v_mfma_f32_16x16x32_bf16 v[60:63], a[220:223], a[124:127], v[60:63]
    ds_read_b128 a[216:219], v0 offset:6144
    v_mfma_f32_16x16x32_bf16 v[60:63], a[224:227], a[128:131], v[60:63]
    ds_read_b128 a[232:235], v0 offset:2048
    v_mfma_f32_16x16x32_bf16 v[60:63], a[228:231], a[132:135], v[60:63]
    ds_read_b128 a[236:239], v1 offset:2048
    s_waitcnt lgkmcnt(1)
    v_mfma_f32_16x16x32_bf16 v[60:63], a[232:235], a[136:139], v[60:63]
    ds_read_b128 a[220:223], v1 offset:6144
    s_waitcnt lgkmcnt(1)
    v_mfma_f32_16x16x32_bf16 v[60:63], a[236:239], a[140:143], v[60:63]
    ds_read_b128 a[224:227], v0 offset:7168
    ds_read_b128 a[228:231], v1 offset:7168
    v_mfma_f32_16x16x32_bf16 v[64:67], a[216:219], a[120:123], 0
    ds_read_b128 a[232:235], v0 offset:8192
    s_waitcnt lgkmcnt(3)
    v_mfma_f32_16x16x32_bf16 v[64:67], a[220:223], a[124:127], v[64:67]
    ds_read_b128 a[236:239], v1 offset:8192
    s_waitcnt lgkmcnt(3)
    v_mfma_f32_16x16x32_bf16 v[64:67], a[224:227], a[128:131], v[64:67]
    s_waitcnt lgkmcnt(2)
    ds_read_b128 a[216:219], v0 offset:12288
    v_mfma_f32_16x16x32_bf16 v[64:67], a[228:231], a[132:135], v[64:67]
    s_waitcnt lgkmcnt(2)
    v_max3_f32 v98, v60, v61, v62
    ds_read_b128 a[220:223], v1 offset:12288
    v_mfma_f32_16x16x32_bf16 v[64:67], a[232:235], a[136:139], v[64:67]
    ds_read_b128 a[228:231], v1 offset:13312
    s_waitcnt lgkmcnt(3)
    v_mfma_f32_16x16x32_bf16 v[64:67], a[236:239], a[140:143], v[64:67]
    s_nop 7
    v_max3_f32 v98, v98, v63, v64
    ds_read_b128 a[224:227], v0 offset:13312
    v_fma_f32 v55, v55, s28, v9
    v_max3_f32 v98, v98, v65, v66
    v_max_f32 v98, v98, v67
    v_mov_b32 v99, v98
    s_nop 1
    v_permlane32_swap_b32 v99, v98
    v_max_f32 v98, v98, v99
    v_mov_b32 v99, v98
    s_nop 1
    v_permlane16_swap_b32 v99, v98
    v_max_f32 v98, v98, v99
    v_mul_f32_e64 v10, -s28, v98
    v_subrev_f32 v10, 0x42000000, v10
    v_fma_f32 v61, v61, s28, v10
    v_fma_f32 v63, v63, s28, v10
    v_fma_f32 v62, v62, s28, v10
    v_exp_f32_e64 v62, v62 clamp
    v_exp_f32_e64 v63, v63 clamp
    v_fma_f32 v60, v60, s28, v10
    v_fma_f32 v64, v64, s28, v10
    ds_read_b128 a[232:235], v0 offset:14336
    v_fma_f32 v67, v67, s28, v10
    v_exp_f32_e64 v61, v61 clamp
    v_cvt_pk_bf16_f32 v23, v62, v63
    v_exp_f32_e64 v60, v60 clamp
    s_waitcnt vmcnt(12)
    s_add_u32 m0, s22, 24576
    s_nop 0
    buffer_load_dwordx4 v6, s[8:11], s21 offen lds
    s_add_u32 s21, s21, 128
    v_mfma_f32_16x16x32_bf16 v[44:47], a[248:251], v[14:17], 0
    s_add_u32 m0, s22, 25600
    s_nop 0
    buffer_load_dwordx4 v6, s[8:11], s21 offen lds
    v_cvt_pk_bf16_f32 v22, v60, v61
    s_add_u32 s21, s21, 128
    s_add_u32 m0, s22, 26624
    ds_read_b128 a[236:239], v1 offset:14336
    s_waitcnt lgkmcnt(1)
    v_mfma_f32_16x16x32_bf16 v[60:63], a[216:219], a[120:123], 0
    buffer_load_dwordx4 v6, s[8:11], s21 offen lds
    v_exp_f32_e64 v67, v67 clamp
    v_fma_f32 v53, v53, s28, v9
    v_fma_f32 v65, v65, s28, v10
    ds_read_b128 a[148:151], v105 offset:12288
    v_fma_f32 v66, v66, s28, v10
    v_mfma_f32_16x16x32_bf16 v[60:63], a[220:223], a[124:127], v[60:63]
    ds_read_b128 a[220:223], v1 offset:18432
    v_exp_f32_e64 v64, v64 clamp
    v_fma_f32 v52, v52, s28, v9
    v_exp_f32_e64 v65, v65 clamp
    v_mfma_f32_16x16x32_bf16 v[60:63], a[224:227], a[128:131], v[60:63]
    ds_read_b128 a[216:219], v0 offset:18432
    v_mfma_f32_16x16x32_bf16 v[60:63], a[228:231], a[132:135], v[60:63]
    ds_read_b128 a[164:167], v105 offset:16384
    v_exp_f32_e64 v66, v66 clamp
    ds_read_b128 a[156:159], v105 offset:14336
    v_mfma_f32_16x16x32_bf16 v[60:63], a[232:235], a[136:139], v[60:63]
    v_cvt_pk_bf16_f32 v24, v64, v65
    ds_read_b128 a[232:235], v0 offset:20480
    v_cvt_pk_bf16_f32 v25, v66, v67
    s_waitcnt lgkmcnt(6)
    v_mfma_f32_16x16x32_bf16 v[60:63], a[236:239], a[140:143], v[60:63]
    ds_read_b128 a[228:231], v1 offset:19456
    ds_read_b128 a[224:227], v0 offset:19456
    s_waitcnt lgkmcnt(5)
    v_mfma_f32_16x16x32_bf16 v[64:67], a[216:219], a[120:123], 0
    v_exp_f32_e64 v52, v52 clamp
    ds_read_b128 a[144:147], v104 offset:12288
    v_mfma_f32_16x16x32_bf16 v[64:67], a[220:223], a[124:127], v[64:67]
    ds_read_b128 a[236:239], v1 offset:20480
    s_waitcnt lgkmcnt(2)
    v_mfma_f32_16x16x32_bf16 v[64:67], a[224:227], a[128:131], v[64:67]
    ds_read_b128 a[224:227], v0 offset:1024
    v_mfma_f32_16x16x32_bf16 v[64:67], a[228:231], a[132:135], v[64:67]
    ds_read_b128 a[152:155], v104 offset:14336
    v_mfma_f32_16x16x32_bf16 v[64:67], a[232:235], a[136:139], v[64:67]
    ds_read_b128 a[216:219], v0 offset:0
    ds_read_b128 a[160:163], v104 offset:16384
    s_waitcnt lgkmcnt(4)
    v_mfma_f32_16x16x32_bf16 v[64:67], a[236:239], a[140:143], v[64:67]
    ds_read_b128 a[220:223], v1 offset:0
    s_waitcnt lgkmcnt(2)
    v_mfma_f32_16x16x32_bf16 v[68:71], a[216:219], a[144:147], 0
    ds_read_b128 a[228:231], v1 offset:1024
    s_waitcnt lgkmcnt(1)
    v_mfma_f32_16x16x32_bf16 v[68:71], a[220:223], a[148:151], v[68:71]
    ds_read_b128 a[232:235], v0 offset:2048
    v_mfma_f32_16x16x32_bf16 v[68:71], a[224:227], a[152:155], v[68:71]
    ds_read_b128 a[236:239], v1 offset:2048
    s_waitcnt lgkmcnt(2)
    v_mfma_f32_16x16x32_bf16 v[68:71], a[228:231], a[156:159], v[68:71]
    ds_read_b128 a[216:219], v0 offset:6144
    s_waitcnt lgkmcnt(2)
    v_mfma_f32_16x16x32_bf16 v[68:71], a[232:235], a[160:163], v[68:71]
    ds_read_b128 a[220:223], v1 offset:6144
    s_waitcnt lgkmcnt(2)
    v_mfma_f32_16x16x32_bf16 v[68:71], a[236:239], a[164:167], v[68:71]
    s_nop 7
    v_max3_f32 v96, v68, v69, v70
    ds_read_b128 a[224:227], v0 offset:7168
    s_waitcnt lgkmcnt(2)
    v_mfma_f32_16x16x32_bf16 v[72:75], a[216:219], a[144:147], 0
    ds_read_b128 a[236:239], v1 offset:8192
    s_waitcnt lgkmcnt(2)
    v_mfma_f32_16x16x32_bf16 v[72:75], a[220:223], a[148:151], v[72:75]
    ds_read_b128 a[228:231], v1 offset:7168
    ds_read_b128 a[232:235], v0 offset:8192
    v_exp_f32_e64 v55, v55 clamp
    s_waitcnt lgkmcnt(3)
    v_mfma_f32_16x16x32_bf16 v[72:75], a[224:227], a[152:155], v[72:75]
    ds_read_b128 a[216:219], v0 offset:12288
    s_waitcnt lgkmcnt(2)
    v_mfma_f32_16x16x32_bf16 v[72:75], a[228:231], a[156:159], v[72:75]
    s_waitcnt lgkmcnt(1)
    ds_read_b128 a[220:223], v1 offset:12288
    v_mfma_f32_16x16x32_bf16 v[72:75], a[232:235], a[160:163], v[72:75]
    ds_read_b128 a[224:227], v0 offset:13312
    v_mfma_f32_16x16x32_bf16 v[72:75], a[236:239], a[164:167], v[72:75]
    s_nop 7
    v_max3_f32 v96, v96, v71, v72
    v_max3_f32 v96, v96, v73, v74
    v_max_f32 v96, v96, v75
    v_mov_b32 v97, v96
    s_nop 1
    v_permlane32_swap_b32 v97, v96
    v_max_f32 v96, v96, v97
    v_mov_b32 v97, v96
    s_nop 1
    v_permlane16_swap_b32 v97, v96
    v_max_f32 v96, v96, v97
    v_mul_f32_e64 v11, -s28, v96
    v_subrev_f32 v11, 0x42000000, v11
    v_fma_f32 v70, v70, s28, v11
    ds_read_b128 a[232:235], v0 offset:14336
    v_fma_f32 v72, v72, s28, v11
    v_exp_f32_e64 v72, v72 clamp
    v_fma_f32 v69, v69, s28, v11
    v_exp_f32_e64 v69, v69 clamp
    v_fma_f32 v71, v71, s28, v11
    v_exp_f32_e64 v71, v71 clamp
    v_fma_f32 v75, v75, s28, v11
    ds_read_b128 a[228:231], v1 offset:13312
    v_fma_f32 v68, v68, s28, v11
    v_fma_f32 v73, v73, s28, v11
    v_exp_f32_e64 v68, v68 clamp
    v_fma_f32 v74, v74, s28, v11
    v_exp_f32_e64 v75, v75 clamp
    v_cvt_pk_bf16_f32 v26, v68, v69
    v_exp_f32_e64 v74, v74 clamp
    v_exp_f32_e64 v70, v70 clamp
    s_nop 0
    v_cvt_pk_bf16_f32 v27, v70, v71
    ds_read_b128 a[236:239], v1 offset:14336
    v_cvt_pk_bf16_f32 v29, v74, v75
    s_add_u32 s21, s21, 12032
    v_exp_f32_e64 v73, v73 clamp
    s_waitcnt lgkmcnt(3)
    v_mfma_f32_16x16x32_bf16 v[68:71], a[216:219], a[144:147], 0
    ds_read_b128 a[216:219], v0 offset:18432
    s_waitcnt vmcnt(9)
    s_add_u32 m0, s22, 36864
    ds_read_b128 a[168:171], v104 offset:18432
    buffer_load_dwordx4 v6, s[8:11], s21 offen lds
    s_add_u32 s21, s21, 128
    v_cvt_pk_bf16_f32 v28, v72, v73
    v_mfma_f32_16x16x32_bf16 v[68:71], a[220:223], a[148:151], v[68:71]
    s_add_u32 m0, s22, 37888
    ds_read_b128 a[188:191], v105 offset:22528
    buffer_load_dwordx4 v6, s[8:11], s21 offen lds
    s_add_u32 s21, s21, 128
    s_add_u32 m0, s22, 38912
    v_mfma_f32_16x16x32_bf16 v[68:71], a[224:227], a[152:155], v[68:71]
    buffer_load_dwordx4 v6, s[8:11], s21 offen lds
    ds_read_b128 a[220:223], v1 offset:18432
    v_fma_f32 v54, v54, s28, v9
    s_waitcnt lgkmcnt(4)
    v_mfma_f32_16x16x32_bf16 v[68:71], a[228:231], a[156:159], v[68:71]
    ds_read_b128 a[176:179], v104 offset:20480
    v_mfma_f32_16x16x32_bf16 v[68:71], a[232:235], a[160:163], v[68:71]
    ds_read_b128 a[224:227], v0 offset:19456
    v_mfma_f32_16x16x32_bf16 v[68:71], a[236:239], a[164:167], v[68:71]
    s_waitcnt lgkmcnt(5)
    ds_read_b128 a[236:239], v1 offset:20480
    ds_read_b128 a[228:231], v1 offset:19456
    v_mfma_f32_16x16x32_bf16 v[72:75], a[216:219], a[144:147], 0
    ds_read_b128 a[232:235], v0 offset:20480
    s_waitcnt lgkmcnt(5)
    v_mfma_f32_16x16x32_bf16 v[72:75], a[220:223], a[148:151], v[72:75]
    ds_read_b128 a[220:223], v1 offset:0
    s_waitcnt lgkmcnt(4)
    v_mfma_f32_16x16x32_bf16 v[72:75], a[224:227], a[152:155], v[72:75]
    ds_read_b128 a[216:219], v0 offset:0
    s_waitcnt lgkmcnt(3)
    v_mfma_f32_16x16x32_bf16 v[72:75], a[228:231], a[156:159], v[72:75]
    ds_read_b128 a[228:231], v1 offset:1024
    ds_read_b128 a[172:175], v105 offset:18432
    s_waitcnt lgkmcnt(4)
    v_mfma_f32_16x16x32_bf16 v[72:75], a[232:235], a[160:163], v[72:75]
    ds_read_b128 a[180:183], v105 offset:20480
    v_mfma_f32_16x16x32_bf16 v[72:75], a[236:239], a[164:167], v[72:75]
    ds_read_b128 a[224:227], v0 offset:1024
    s_waitcnt lgkmcnt(4)
    v_mfma_f32_16x16x32_bf16 v[76:79], a[216:219], a[168:171], 0
    ds_read_b128 a[184:187], v104 offset:22528
    ds_read_b128 a[232:235], v0 offset:2048
    s_waitcnt lgkmcnt(4)
    v_mfma_f32_16x16x32_bf16 v[76:79], a[220:223], a[172:175], v[76:79]
    ds_read_b128 a[220:223], v1 offset:6144
    s_waitcnt lgkmcnt(3)
    v_mfma_f32_16x16x32_bf16 v[76:79], a[224:227], a[176:179], v[76:79]
    ds_read_b128 a[236:239], v1 offset:2048
    v_mfma_f32_16x16x32_bf16 v[76:79], a[228:231], a[180:183], v[76:79]
    ds_read_b128 a[216:219], v0 offset:6144
    s_waitcnt lgkmcnt(3)
    v_mfma_f32_16x16x32_bf16 v[76:79], a[232:235], a[184:187], v[76:79]
    ds_read_b128 a[228:231], v1 offset:7168
    s_waitcnt lgkmcnt(2)
    v_mfma_f32_16x16x32_bf16 v[76:79], a[236:239], a[188:191], v[76:79]
    ds_read_b128 a[224:227], v0 offset:7168
    s_waitcnt lgkmcnt(2)
    v_mfma_f32_16x16x32_bf16 v[80:83], a[216:219], a[168:171], 0
    v_exp_f32_e64 v54, v54 clamp
    s_nop 3
    v_max3_f32 v98, v76, v77, v78
    ds_read_b128 a[232:235], v0 offset:8192
    v_exp_f32_e64 v53, v53 clamp
    v_mfma_f32_16x16x32_bf16 v[80:83], a[220:223], a[172:175], v[80:83]
    ds_read_b128 a[236:239], v1 offset:8192
    s_waitcnt lgkmcnt(2)
    v_mfma_f32_16x16x32_bf16 v[80:83], a[224:227], a[176:179], v[80:83]
    ds_read_b128 a[220:223], v1 offset:12288
    v_mfma_f32_16x16x32_bf16 v[80:83], a[228:231], a[180:183], v[80:83]
    v_fma_f32 v60, v60, s28, v10
    ds_read_b128 a[224:227], v0 offset:13312
    s_waitcnt lgkmcnt(3)
    v_mfma_f32_16x16x32_bf16 v[80:83], a[232:235], a[184:187], v[80:83]
    ds_read_b128 a[216:219], v0 offset:12288
    s_waitcnt lgkmcnt(3)
    v_mfma_f32_16x16x32_bf16 v[80:83], a[236:239], a[188:191], v[80:83]
    s_nop 7
    v_max3_f32 v98, v98, v79, v80
    v_max3_f32 v98, v98, v81, v82
    v_max_f32 v98, v98, v83
    ds_read_b128 a[228:231], v1 offset:13312
    v_mov_b32 v99, v98
    s_nop 1
    v_permlane32_swap_b32 v99, v98
    v_max_f32 v98, v98, v99
    v_mov_b32 v99, v98
    s_nop 1
    v_permlane16_swap_b32 v99, v98
    v_fma_f32 v61, v61, s28, v10
    v_max_f32 v98, v98, v99
    v_mul_f32_e64 v12, -s28, v98
    v_subrev_f32 v12, 0x42000000, v12
    v_fma_f32 v78, v78, s28, v12
    s_add_u32 s21, s21, 12032
    v_fma_f32 v77, v77, s28, v12
    v_fma_f32 v80, v80, s28, v12
    v_fma_f32 v62, v62, s28, v10
    v_fma_f32 v82, v82, s28, v12
    v_fma_f32 v76, v76, s28, v12
    v_exp_f32_e64 v78, v78 clamp
    v_fma_f32 v79, v79, s28, v12
    v_exp_f32_e64 v77, v77 clamp
    v_exp_f32_e64 v79, v79 clamp
    v_exp_f32_e64 v82, v82 clamp
    v_cvt_pk_bf16_f32 v35, v78, v79
    v_exp_f32_e64 v76, v76 clamp
    v_fma_f32 v63, v63, s28, v10
    v_exp_f32_e64 v60, v60 clamp
    v_cvt_pk_bf16_f32 v34, v76, v77
    v_exp_f32_e64 v62, v62 clamp
    v_fma_f32 v81, v81, s28, v12
    s_waitcnt lgkmcnt(0)
    v_mfma_f32_16x16x32_bf16 v[76:79], a[216:219], a[168:171], 0
    ds_read_b128 a[236:239], v1 offset:14336
    v_mfma_f32_16x16x32_bf16 v[76:79], a[220:223], a[172:175], v[76:79]
    ds_read_b128 a[232:235], v0 offset:14336
    v_fma_f32 v83, v83, s28, v12
    v_mfma_f32_16x16x32_bf16 v[76:79], a[224:227], a[176:179], v[76:79]
    v_exp_f32_e64 v80, v80 clamp
    ds_read_b128 a[220:223], v1 offset:18432
    v_mfma_f32_16x16x32_bf16 v[76:79], a[228:231], a[180:183], v[76:79]
    ds_read_b128 a[224:227], v0 offset:19456
    v_exp_f32_e64 v83, v83 clamp
    ds_read_b128 a[228:231], v1 offset:19456
    v_exp_f32_e64 v81, v81 clamp
    s_nop 0
    v_cvt_pk_bf16_f32 v36, v80, v81
    s_waitcnt lgkmcnt(3)
    v_mfma_f32_16x16x32_bf16 v[76:79], a[232:235], a[184:187], v[76:79]
    ds_read_b128 a[216:219], v0 offset:18432
    v_mfma_f32_16x16x32_bf16 v[76:79], a[236:239], a[188:191], v[76:79]
    v_exp_f32_e64 v63, v63 clamp
    ds_read_b128 a[236:239], v1 offset:20480
    v_cvt_pk_bf16_f32 v18, v52, v53
    v_smfmac_f32_16x16x64_bf16 v[44:47], a[240:243], v[22:29], v101
    v_cvt_pk_bf16_f32 v37, v82, v83
    ds_read_b128 a[232:235], v0 offset:20480
    s_waitcnt lgkmcnt(2)
    v_mfma_f32_16x16x32_bf16 v[80:83], a[216:219], a[168:171], 0
    ds_read_b128 a[216:219], v0 offset:0
    v_mfma_f32_16x16x32_bf16 v[80:83], a[220:223], a[172:175], v[80:83]
    ds_read_b128 a[220:223], v1 offset:0
    v_mfma_f32_16x16x32_bf16 v[80:83], a[224:227], a[176:179], v[80:83]
    ds_read_b128 a[224:227], v0 offset:1024
    s_waitcnt vmcnt(6)
    ds_read_b128 a[192:195], v104 offset:24576
    ds_read_b128 a[200:203], v104 offset:26624
    v_mfma_f32_16x16x32_bf16 v[80:83], a[228:231], a[180:183], v[80:83]
    s_waitcnt lgkmcnt(5)
    ds_read_b128 a[196:199], v105 offset:24576
    ds_read_b128 a[204:207], v105 offset:26624
    v_mfma_f32_16x16x32_bf16 v[80:83], a[232:235], a[184:187], v[80:83]
    ds_read_b128 a[232:235], v0 offset:2048
    ds_read_b128 a[228:231], v1 offset:1024
    v_mfma_f32_16x16x32_bf16 v[80:83], a[236:239], a[188:191], v[80:83]
    v_cvt_pk_bf16_f32 v19, v54, v55
    ds_read_b128 a[236:239], v1 offset:2048
    s_waitcnt lgkmcnt(6)
    v_mfma_f32_16x16x32_bf16 v[84:87], a[216:219], a[192:195], 0
    ds_read_b128 a[216:219], v0 offset:6144
    s_waitcnt lgkmcnt(5)
    v_mfma_f32_16x16x32_bf16 v[84:87], a[220:223], a[196:199], v[84:87]
    ds_read_b128 a[220:223], v1 offset:6144
    v_mfma_f32_16x16x32_bf16 v[84:87], a[224:227], a[200:203], v[84:87]
    s_waitcnt lgkmcnt(3)
    ds_read_b128 a[224:227], v0 offset:7168
    v_mfma_f32_16x16x32_bf16 v[84:87], a[228:231], a[204:207], v[84:87]
    ds_read_b128 a[228:231], v1 offset:7168
    v_mfma_f32_16x16x32_bf16 v[84:87], a[232:235], a[208:211], v[84:87]
    s_waitcnt lgkmcnt(4)
    ds_read_b128 a[232:235], v0 offset:8192
    v_mfma_f32_16x16x32_bf16 v[84:87], a[236:239], a[212:215], v[84:87]
    ds_read_b128 a[236:239], v1 offset:8192
    s_waitcnt lgkmcnt(5)
    v_mfma_f32_16x16x32_bf16 v[88:91], a[216:219], a[192:195], 0
    s_waitcnt lgkmcnt(4)
    v_mfma_f32_16x16x32_bf16 v[88:91], a[220:223], a[196:199], v[88:91]
    s_waitcnt lgkmcnt(3)
    v_mfma_f32_16x16x32_bf16 v[88:91], a[224:227], a[200:203], v[88:91]
    s_waitcnt vmcnt(63) lgkmcnt(0)
    ds_read_b128 a[216:219], v0 offset:12288
    v_mfma_f32_16x16x32_bf16 v[88:91], a[228:231], a[204:207], v[88:91]
    s_barrier
    ds_read_b128 a[220:223], v1 offset:12288
    v_mfma_f32_16x16x32_bf16 v[88:91], a[232:235], a[208:211], v[88:91]
    s_add_u32 m0, s22, 0
    ds_read_b128 a[232:235], v0 offset:14336
    buffer_load_dwordx4 v6, s[4:7], s20 offen lds
    v_mfma_f32_16x16x32_bf16 v[88:91], a[236:239], a[212:215], v[88:91]
    s_add_u32 s20, s20, 128
    s_add_u32 m0, s22, 1024
    ds_read_b128 a[224:227], v0 offset:13312
    ds_read_b128 a[228:231], v1 offset:13312
    ds_read_b128 a[236:239], v1 offset:14336
    buffer_load_dwordx4 v6, s[4:7], s20 offen lds
    v_max3_f32 v96, v84, v85, v86
    s_nop 0
    v_max3_f32 v96, v96, v87, v88
    v_max3_f32 v96, v96, v89, v90
    v_max_f32 v96, v96, v91
    v_mov_b32 v97, v96
    s_add_u32 s20, s20, 128
    s_add_u32 m0, s22, 2048
    v_permlane32_swap_b32 v97, v96
    v_max_f32 v96, v96, v97
    v_mov_b32 v97, v96
    s_nop 1
    v_permlane16_swap_b32 v97, v96
    v_max_f32 v96, v96, v97
    v_mul_f32_e64 v13, -s28, v96
    v_subrev_f32 v13, 0x42000000, v13
    v_fma_f32 v89, v89, s28, v13
    v_fma_f32 v85, v85, s28, v13
    v_fma_f32 v87, v87, s28, v13
    v_fma_f32 v84, v84, s28, v13
    v_exp_f32_e64 v84, v84 clamp
    v_fma_f32 v86, v86, s28, v13
    v_exp_f32_e64 v86, v86 clamp
    v_exp_f32_e64 v85, v85 clamp
    v_exp_f32_e64 v87, v87 clamp
    v_fma_f32 v88, v88, s28, v13
    v_cvt_pk_bf16_f32 v38, v84, v85
    v_cvt_pk_bf16_f32 v39, v86, v87
    s_waitcnt lgkmcnt(0)
    v_mfma_f32_16x16x32_bf16 v[84:87], a[216:219], a[192:195], 0
    buffer_load_dwordx4 v6, s[4:7], s20 offen lds
    ds_read_b128 a[216:219], v0 offset:18432
    v_mfma_f32_16x16x32_bf16 v[84:87], a[220:223], a[196:199], v[84:87]
    s_add_u32 s20, s20, 12032
    ds_read_b128 a[220:223], v1 offset:18432
    s_mov_b32 s39, s64
    v_mfma_f32_16x16x32_bf16 v[84:87], a[224:227], a[200:203], v[84:87]
    s_add_u32 s37, s37, 1
    s_bitcmp1_b32 s63, s37
    s_cselect_b32 s62, 4294770688, 0
    s_cselect_b32 s42, 0, 325632
    ds_read_b128 a[224:227], v0 offset:19456
    v_fma_f32 v91, v91, s28, v13
    v_mfma_f32_16x16x32_bf16 v[84:87], a[228:231], a[204:207], v[84:87]
    s_add_u32 s35, s35, s42
    s_lshl_b32 s42, s37, 1
    s_lshr_b32 s42, s31, s42
    ds_read_b128 a[228:231], v1 offset:19456
    v_mfma_f32_16x16x32_bf16 v[84:87], a[232:235], a[208:211], v[84:87]
    s_and_b32 s42, s42, 3
    v_fma_f32 v90, v90, s28, v13
    s_add_u32 s42, s42, s36
    s_sub_u32 s43, s42, 3
    ds_read_b128 a[232:235], v0 offset:20480
    v_mfma_f32_16x16x32_bf16 v[84:87], a[236:239], a[212:215], v[84:87]
    s_cmp_ge_u32 s42, 3
    ds_read_b128 a[236:239], v1 offset:20480
    s_cselect_b32 s42, s43, s42
    s_mul_i32 s44, s3, 5
    s_mov_b32 s32, 1
    s_lshl_b32 s43, s3, 2
    s_add_u32 s45, s43, 21
    s_cmp_eq_u32 s3, 0
    v_exp_f32_e64 v91, v91 clamp
    v_exp_f32_e64 v89, v89 clamp
    v_exp_f32_e64 v88, v88 clamp
    s_cselect_b32 s45, 20, s45
    s_cselect_b32 s33, 1, 0
    s_cmp_eq_u32 s42, 1
    s_cselect_b32 s44, s45, s44
    s_cselect_b32 s32, s33, s32
    s_add_u32 s45, s43, 37
    s_cmp_eq_u32 s42, 2
    s_cselect_b32 s44, s45, s44
    v_exp_f32_e64 v90, v90 clamp
    v_cvt_pk_bf16_f32 v40, v88, v89
    s_cselect_b32 s32, 0, s32
    s_mul_i32 s44, s44, 6144
    s_add_u32 s33, s35, s44
    s_mul_i32 s42, s32, 6144
    s_add_u32 s42, s42, 24576
    s_add_u32 s42, s42, s33
    s_cmp_ge_u32 s37, 6
    s_cselect_b32 s14, 0, s42
    s_add_u32 s24, s67, 256
    s_add_u32 s25, s33, 256
    v_cvt_pk_bf16_f32 v41, v90, v91
    s_add_u32 s23, s38, 4096
    s_mov_b32 s27, 0x249
    s_mov_b32 s30, 0
    s_waitcnt vmcnt(6) lgkmcnt(0)
    v_mfma_f32_16x16x32_bf16 v[88:91], a[216:219], a[192:195], 0
    s_barrier
    ds_read_b64_tr_b16 a[216:217], v2 offset:0
    ds_read_b64_tr_b16 a[218:219], v2 offset:6144
    v_mfma_f32_16x16x32_bf16 v[88:91], a[220:223], a[196:199], v[88:91]
    ds_read_b64_tr_b16 a[220:221], v3 offset:0
    ds_read_b64_tr_b16 a[222:223], v3 offset:6144
    s_add_u32 m0, s22, 12288
    s_nop 0
    buffer_load_dwordx4 v6, s[4:7], s20 offen lds
    s_add_u32 s20, s20, 128
    s_add_u32 m0, s22, 13312
    v_mfma_f32_16x16x32_bf16 v[88:91], a[224:227], a[200:203], v[88:91]
    ds_read_b64_tr_b16 a[224:225], v4 offset:0
    buffer_load_dwordx4 v6, s[4:7], s20 offen lds
    s_add_u32 s20, s20, 128
    v_mfma_f32_16x16x32_bf16 v[88:91], a[228:231], a[204:207], v[88:91]
    s_add_u32 m0, s22, 14336
    ds_read_b64_tr_b16 a[226:227], v4 offset:6144
    v_smfmac_f32_16x16x64_bf16 v[44:47], a[244:247], v[34:41], v101
    ds_read_b64_tr_b16 a[228:229], v5 offset:0
    v_mfma_f32_16x16x32_bf16 v[88:91], a[232:235], a[208:211], v[88:91]
    buffer_load_dwordx4 v6, s[4:7], s20 offen lds
    s_add_u32 s20, s20, 12032
    v_exp_f32_e64 v61, v61 clamp
    ds_read_b64_tr_b16 a[230:231], v5 offset:6144
    v_mfma_f32_16x16x32_bf16 v[88:91], a[236:239], a[212:215], v[88:91]
    s_waitcnt lgkmcnt(4)
    v_mfma_f32_16x16x32_bf16 v[112:115], a[216:219], v[14:17], 0
    v_fma_f32 v87, v87, s28, v13
    v_fma_f32 v74, v74, s28, v11
    v_mfma_f32_16x16x32_bf16 v[116:119], a[220:223], v[14:17], 0
    v_fma_f32 v57, v57, s28, v9
    v_mfma_f32_16x16x32_bf16 v[164:167], a[220:223], v[22:25], 0
    v_fma_f32 v79, v79, s28, v12
    v_add_u32 v103, 4096, v103
    v_mfma_f32_16x16x32_bf16 v[160:163], a[216:219], v[22:25], 0
    ds_read_b64_tr_b16 a[238:239], v3 offset:7168
    v_fma_f32 v90, v90, s28, v13
    v_mfma_f32_16x16x32_bf16 v[208:211], a[216:219], v[26:29], 0
    ds_read_b64_tr_b16 a[236:237], v3 offset:1024
    v_fma_f32 v82, v82, s28, v12
    v_mfma_f32_16x16x32_bf16 v[212:215], a[220:223], v[26:29], 0
    v_fma_f32 v58, v58, s28, v9
    v_fma_f32 v71, v71, s28, v11
    v_mfma_f32_16x16x32_bf16 a[4:7], a[220:223], v[34:37], 0
    ds_read_b64_tr_b16 a[232:233], v2 offset:1024
    v_mfma_f32_16x16x32_bf16 a[0:3], a[216:219], v[34:37], 0
    v_fma_f32 v69, v69, s28, v11
    v_mfma_f32_16x16x32_bf16 a[48:51], a[216:219], v[38:41], 0
    v_fma_f32 v85, v85, s28, v13
    v_mfma_f32_16x16x32_bf16 a[52:55], a[220:223], v[38:41], 0
    s_waitcnt lgkmcnt(3)
    ds_read_b64_tr_b16 a[234:235], v2 offset:7168
    v_fma_f32 v66, v66, s28, v10
    v_mfma_f32_16x16x32_bf16 a[56:59], a[224:227], v[38:41], 0
    ds_read_b64_tr_b16 a[216:217], v4 offset:1024
    v_fma_f32 v78, v78, s28, v12
    v_mfma_f32_16x16x32_bf16 a[60:63], a[228:231], v[38:41], 0
    v_exp_f32_e64 v57, v57 clamp
    v_mfma_f32_16x16x32_bf16 a[12:15], a[228:231], v[34:37], 0
    v_fma_f32 v64, v64, s28, v10
    v_fma_f32 v59, v59, s28, v9
    v_mfma_f32_16x16x32_bf16 a[8:11], a[224:227], v[34:37], 0
    v_exp_f32_e64 v66, v66 clamp
    v_mfma_f32_16x16x32_bf16 v[216:219], a[224:227], v[26:29], 0
    v_fma_f32 v67, v67, s28, v10
    v_fma_f32 v81, v81, s28, v12
    v_mfma_f32_16x16x32_bf16 v[220:223], a[228:231], v[26:29], 0
    v_fma_f32 v83, v83, s28, v12
    v_fma_f32 v68, v68, s28, v11
    v_mfma_f32_16x16x32_bf16 v[172:175], a[228:231], v[22:25], 0
    ds_read_b64_tr_b16 a[222:223], v5 offset:7168
    v_mfma_f32_16x16x32_bf16 v[168:171], a[224:227], v[22:25], 0
    ds_read_b64_tr_b16 a[220:221], v5 offset:1024
    v_fma_f32 v86, v86, s28, v13
    v_mfma_f32_16x16x32_bf16 v[120:123], a[224:227], v[14:17], 0
    ds_read_b64_tr_b16 a[218:219], v4 offset:7168
    v_fma_f32 v77, v77, s28, v12
    v_mfma_f32_16x16x32_bf16 v[124:127], a[228:231], v[14:17], 0
    s_waitcnt lgkmcnt(4)
    v_exp_f32_e64 v68, v68 clamp
    v_mfma_f32_16x16x32_bf16 v[128:131], a[232:235], v[14:17], 0
    v_fma_f32 v65, v65, s28, v10
    v_fma_f32 v76, v76, s28, v12
    v_mfma_f32_16x16x32_bf16 v[132:135], a[236:239], v[14:17], 0
    v_fma_f32 v70, v70, s28, v11
    v_mfma_f32_16x16x32_bf16 v[180:183], a[236:239], v[22:25], 0
    v_exp_f32_e64 v76, v76 clamp
    v_mfma_f32_16x16x32_bf16 v[176:179], a[232:235], v[22:25], 0
    ds_read_b64_tr_b16 a[228:229], v3 offset:2048
    v_fma_f32 v73, v73, s28, v11
    v_mfma_f32_16x16x32_bf16 v[224:227], a[232:235], v[26:29], 0
    v_fma_f32 v80, v80, s28, v12
    v_fma_f32 v72, v72, s28, v11
    v_mfma_f32_16x16x32_bf16 v[228:231], a[236:239], v[26:29], 0
    ds_read_b64_tr_b16 a[230:231], v3 offset:8192
    v_mfma_f32_16x16x32_bf16 a[20:23], a[236:239], v[34:37], 0
    v_exp_f32_e64 v79, v79 clamp
    v_mfma_f32_16x16x32_bf16 a[16:19], a[232:235], v[34:37], 0
    ds_read_b64_tr_b16 a[226:227], v2 offset:8192
    v_fma_f32 v84, v84, s28, v13
    v_mfma_f32_16x16x32_bf16 a[64:67], a[232:235], v[38:41], 0
    ds_read_b64_tr_b16 a[224:225], v2 offset:2048
    v_fma_f32 v89, v89, s28, v13
    v_mfma_f32_16x16x32_bf16 a[68:71], a[236:239], v[38:41], 0
    s_waitcnt lgkmcnt(4)
    v_exp_f32_e64 v83, v83 clamp
    v_mfma_f32_16x16x32_bf16 a[72:75], a[216:219], v[38:41], 0
    v_exp_f32_e64 v85, v85 clamp
    v_mfma_f32_16x16x32_bf16 a[76:79], a[220:223], v[38:41], 0
    ds_read_b64_tr_b16 a[234:235], v4 offset:8192
    v_fma_f32 v91, v91, s28, v13
    v_mfma_f32_16x16x32_bf16 a[28:31], a[220:223], v[34:37], 0
    v_exp_f32_e64 v78, v78 clamp
    v_mfma_f32_16x16x32_bf16 a[24:27], a[216:219], v[34:37], 0
    v_exp_f32_e64 v87, v87 clamp
    v_mfma_f32_16x16x32_bf16 v[232:235], a[216:219], v[26:29], 0
    v_exp_f32_e64 v86, v86 clamp
    v_mfma_f32_16x16x32_bf16 v[236:239], a[220:223], v[26:29], 0
    ds_read_b64_tr_b16 a[232:233], v4 offset:2048
    s_add_u32 s39, s39, 12288
    v_mfma_f32_16x16x32_bf16 v[188:191], a[220:223], v[22:25], 0
    v_exp_f32_e64 v77, v77 clamp
    v_mfma_f32_16x16x32_bf16 v[184:187], a[216:219], v[22:25], 0
    ds_read_b64_tr_b16 a[236:237], v5 offset:2048
    v_fma_f32 v75, v75, s28, v11
    v_mfma_f32_16x16x32_bf16 v[136:139], a[216:219], v[14:17], 0
    ds_read_b64_tr_b16 a[238:239], v5 offset:8192
    v_fma_f32 v56, v56, s28, v9
    v_mfma_f32_16x16x32_bf16 v[140:143], a[220:223], v[14:17], 0
    s_waitcnt lgkmcnt(4)
    v_exp_f32_e64 v70, v70 clamp
    v_mfma_f32_16x16x32_bf16 v[144:147], a[224:227], v[14:17], 0
    v_exp_f32_e64 v82, v82 clamp
    v_mfma_f32_16x16x32_bf16 v[148:151], a[228:231], v[14:17], 0
    v_exp_f32_e64 v80, v80 clamp
    v_mfma_f32_16x16x32_bf16 v[196:199], a[228:231], v[22:25], 0
    v_exp_f32_e64 v69, v69 clamp
    v_mfma_f32_16x16x32_bf16 v[192:195], a[224:227], v[22:25], 0
    v_exp_f32_e64 v72, v72 clamp
    v_mfma_f32_16x16x32_bf16 v[240:243], a[224:227], v[26:29], 0
    v_exp_f32_e64 v67, v67 clamp
    v_mfma_f32_16x16x32_bf16 v[244:247], a[228:231], v[26:29], 0
    v_exp_f32_e64 v84, v84 clamp
    v_mfma_f32_16x16x32_bf16 a[36:39], a[228:231], v[34:37], 0
    v_cvt_pk_bf16_f32 v43, v86, v87
    v_cvt_pk_bf16_f32 v33, v82, v83
    v_mfma_f32_16x16x32_bf16 a[32:35], a[224:227], v[34:37], 0
    v_exp_f32_e64 v75, v75 clamp
    v_mfma_f32_16x16x32_bf16 a[80:83], a[224:227], v[38:41], 0
    s_waitcnt vmcnt(3) lgkmcnt(0)
    v_exp_f32_e64 v90, v90 clamp
    v_mfma_f32_16x16x32_bf16 a[84:87], a[228:231], v[38:41], 0
    s_barrier
    ds_read_b128 a[216:219], v0 offset:0
    v_mfma_f32_16x16x32_bf16 a[88:91], a[232:235], v[38:41], 0
    ds_read_b128 a[220:223], v1 offset:0
    s_add_u32 m0, s22, 24576
    v_mfma_f32_16x16x32_bf16 a[92:95], a[236:239], v[38:41], 0
    ds_read_b128 a[224:227], v0 offset:1024
    v_mfma_f32_16x16x32_bf16 a[44:47], a[236:239], v[34:37], 0
    buffer_load_dwordx4 v6, s[8:11], s21 offen lds
    v_mfma_f32_16x16x32_bf16 a[40:43], a[232:235], v[34:37], 0
    v_exp_f32_e64 v91, v91 clamp
    v_mfma_f32_16x16x32_bf16 v[248:251], a[232:235], v[26:29], 0
    s_add_u32 s21, s21, 128
    v_exp_f32_e64 v71, v71 clamp
    v_mfma_f32_16x16x32_bf16 v[252:255], a[236:239], v[26:29], 0
    v_cvt_pk_bf16_f32 v30, v68, v69
    s_add_u32 m0, s22, 25600
    v_mfma_f32_16x16x32_bf16 v[204:207], a[236:239], v[22:25], 0
    buffer_load_dwordx4 v6, s[8:11], s21 offen lds
    v_mfma_f32_16x16x32_bf16 v[200:203], a[232:235], v[22:25], 0
    s_add_u32 s21, s21, 128
    s_add_u32 m0, s22, 26624
    v_cvt_pk_bf16_f32 v42, v84, v85
    v_mfma_f32_16x16x32_bf16 v[152:155], a[232:235], v[14:17], 0
    buffer_load_dwordx4 v6, s[8:11], s21 offen lds
    v_mfma_f32_16x16x32_bf16 v[156:159], a[236:239], v[14:17], 0
    s_waitcnt lgkmcnt(2)
    v_cvt_pk_bf16_f32 v22, v60, v61
    s_add_u32 s21, s21, 12032
    v_mfma_f32_16x16x32_bf16 v[52:55], a[216:219], a[96:99], 0
    s_waitcnt lgkmcnt(1)
    ds_read_b128 a[232:235], v0 offset:2048
    v_mfma_f32_16x16x32_bf16 v[52:55], a[220:223], a[100:103], v[52:55]
    s_waitcnt lgkmcnt(1)
    v_cvt_pk_bf16_f32 v23, v62, v63
    v_mfma_f32_16x16x32_bf16 v[52:55], a[224:227], a[104:107], v[52:55]
    ds_read_b128 a[236:239], v1 offset:2048
    v_cvt_pk_bf16_f32 v34, v76, v77
    v_mfma_f32_16x16x32_bf16 v[60:63], a[224:227], a[128:131], 0
    v_cvt_pk_bf16_f32 v31, v70, v71
    v_mfma_f32_16x16x32_bf16 v[60:63], a[220:223], a[124:127], v[60:63]
    s_add_u32 m0, s38, 0
    ds_read_b128 a[228:231], v1 offset:1024
    v_mfma_f32_16x16x32_bf16 v[60:63], a[216:219], a[120:123], v[60:63]
    v_cvt_pk_bf16_f32 v35, v78, v79
    v_mfma_f32_16x16x32_bf16 v[68:71], a[216:219], a[144:147], 0
    v_exp_f32_e64 v56, v56 clamp
    v_mfma_f32_16x16x32_bf16 v[68:71], a[220:223], a[148:151], v[68:71]
    v_exp_f32_e64 v64, v64 clamp
    v_mfma_f32_16x16x32_bf16 v[68:71], a[224:227], a[152:155], v[68:71]
    v_fma_f32 v88, v88, s28, v13
    v_cvt_pk_bf16_f32 v21, v66, v67
    v_mfma_f32_16x16x32_bf16 v[76:79], a[224:227], a[176:179], 0
    v_exp_f32_e64 v65, v65 clamp
    v_mfma_f32_16x16x32_bf16 v[76:79], a[220:223], a[172:175], v[76:79]
    v_exp_f32_e64 v73, v73 clamp
    v_mfma_f32_16x16x32_bf16 v[76:79], a[216:219], a[168:171], v[76:79]
    v_exp_f32_e64 v89, v89 clamp
    v_mfma_f32_16x16x32_bf16 v[84:87], a[216:219], a[192:195], 0
    buffer_load_dwordx4 v6, s[12:15], s33 offen nt lds
    v_mfma_f32_16x16x32_bf16 v[84:87], a[220:223], a[196:199], v[84:87]
    v_cvt_pk_bf16_f32 v16, v56, v57
    v_mfma_f32_16x16x32_bf16 v[84:87], a[224:227], a[200:203], v[84:87]
    s_waitcnt lgkmcnt(0)
    ds_read_b128 a[216:219], v0 offset:6144
    v_cvt_pk_bf16_f32 v41, v90, v91
    v_mfma_f32_16x16x32_bf16 v[84:87], a[228:231], a[204:207], v[84:87]
    v_exp_f32_e64 v81, v81 clamp
    v_mfma_f32_16x16x32_bf16 v[84:87], a[232:235], a[208:211], v[84:87]
    s_add_u32 m0, s38, 1024
    v_exp_f32_e64 v74, v74 clamp
    v_mfma_f32_16x16x32_bf16 v[84:87], a[236:239], a[212:215], v[84:87]
    buffer_load_dwordx4 v7, s[12:15], s33 offen nt lds
    v_mfma_f32_16x16x32_bf16 v[76:79], a[236:239], a[188:191], v[76:79]
    v_exp_f32_e64 v88, v88 clamp
    v_mfma_f32_16x16x32_bf16 v[76:79], a[232:235], a[184:187], v[76:79]
    v_exp_f32_e64 v59, v59 clamp
    v_mfma_f32_16x16x32_bf16 v[76:79], a[228:231], a[180:183], v[76:79]
    v_exp_f32_e64 v58, v58 clamp
    v_mfma_f32_16x16x32_bf16 v[68:71], a[228:231], a[156:159], v[68:71]
    v_mfma_f32_16x16x32_bf16 v[68:71], a[232:235], a[160:163], v[68:71]
    ds_read_b128 a[224:227], v0 offset:7168
    v_mfma_f32_16x16x32_bf16 v[68:71], a[236:239], a[164:167], v[68:71]
    ds_read_b128 a[220:223], v1 offset:6144
    v_mfma_f32_16x16x32_bf16 v[60:63], a[236:239], a[140:143], v[60:63]
    v_cvt_pk_bf16_f32 v20, v64, v65
    v_mfma_f32_16x16x32_bf16 v[60:63], a[232:235], a[136:139], v[60:63]
    v_mfma_f32_16x16x32_bf16 v[60:63], a[228:231], a[132:135], v[60:63]
    v_cvt_pk_bf16_f32 v40, v88, v89
    v_cvt_pk_bf16_f32 v17, v58, v59
    v_mfma_f32_16x16x32_bf16 v[52:55], a[228:231], a[108:111], v[52:55]
    s_add_u32 s59, s33, 128
    v_cvt_pk_bf16_f32 v32, v80, v81
    s_add_u32 m0, s38, 2048
    v_mfma_f32_16x16x32_bf16 v[48:51], a[248:251], v[40:43], 0
    buffer_load_dwordx4 v6, s[12:15], s59 offen nt lds
    v_mfma_f32_16x16x32_bf16 v[52:55], a[232:235], a[112:115], v[52:55]
    ds_read_b128 a[228:231], v1 offset:7168
    v_cvt_pk_bf16_f32 v29, v74, v75
    v_mfma_f32_16x16x32_bf16 v[52:55], a[236:239], a[116:119], v[52:55]
    ds_read_b128 a[236:239], v1 offset:8192
    v_cvt_pk_bf16_f32 v28, v72, v73
    v_smfmac_f32_16x16x64_bf16 v[48:51], a[240:243], v[16:23], v101
    ds_read_b128 a[232:235], v0 offset:8192
    v_smfmac_f32_16x16x64_bf16 v[48:51], a[244:247], v[28:35], v101
    s_waitcnt lgkmcnt(4)
    v_mfma_f32_16x16x32_bf16 v[56:59], a[216:219], a[96:99], 0
    s_add_u32 m0, s38, 3072
    s_waitcnt lgkmcnt(3)
    v_mfma_f32_16x16x32_bf16 v[56:59], a[220:223], a[100:103], v[56:59]
    v_mfma_f32_16x16x32_bf16 v[56:59], a[224:227], a[104:107], v[56:59]
    s_nop 1
    v_cmp_lt_f32 vcc, s29, v48
    v_mfma_f32_16x16x32_bf16 v[64:67], a[224:227], a[128:131], 0
    buffer_load_dwordx4 v7, s[12:15], s59 offen nt lds
    v_mfma_f32_16x16x32_bf16 v[64:67], a[220:223], a[124:127], v[64:67]
    v_mfma_f32_16x16x32_bf16 v[64:67], a[216:219], a[120:123], v[64:67]
    s_nop 0
    s_cbranch_vccnz L_rs_start5b
L_ret_start5b:
    v_mfma_f32_16x16x32_bf16 v[72:75], a[216:219], a[144:147], 0
    v_fma_f32 v52, v52, s28, v9
    v_fma_f32 v55, v55, s28, v9
    v_mfma_f32_16x16x32_bf16 v[72:75], a[220:223], a[148:151], v[72:75]
    v_fma_f32 v54, v54, s28, v9
    v_fma_f32 v60, v60, s28, v10
    v_mfma_f32_16x16x32_bf16 v[72:75], a[224:227], a[152:155], v[72:75]
    s_waitcnt vmcnt(13) lgkmcnt(0)
    v_fma_f32 v62, v62, s28, v10
    v_fma_f32 v61, v61, s28, v10
    v_mfma_f32_16x16x32_bf16 v[80:83], a[224:227], a[176:179], 0
    s_barrier
    v_mfma_f32_16x16x32_bf16 v[80:83], a[220:223], a[172:175], v[80:83]
    s_add_u32 m0, s22, 0
    v_exp_f32_e64 v55, v55 clamp
    v_mfma_f32_16x16x32_bf16 v[80:83], a[216:219], a[168:171], v[80:83]
    buffer_load_dwordx4 v6, s[4:7], s20 offen lds
    v_mfma_f32_16x16x32_bf16 v[88:91], a[216:219], a[192:195], 0
    ds_read_b64_tr_b16 a[216:217], v2 offset:18432
    v_fma_f32 v53, v53, s28, v9
    v_mfma_f32_16x16x32_bf16 v[88:91], a[220:223], a[196:199], v[88:91]
    s_add_u32 s20, s20, 128
    ds_read_b64_tr_b16 a[218:219], v2 offset:12288
    v_mfma_f32_16x16x32_bf16 v[88:91], a[224:227], a[200:203], v[88:91]
    s_add_u32 m0, s22, 1024
    ds_read_b64_tr_b16 a[220:221], v3 offset:18432
    v_fma_f32 v63, v63, s28, v10
    v_mfma_f32_16x16x32_bf16 v[88:91], a[228:231], a[204:207], v[88:91]
    ds_read_b64_tr_b16 a[222:223], v3 offset:12288
    v_mfma_f32_16x16x32_bf16 v[88:91], a[232:235], a[208:211], v[88:91]
    buffer_load_dwordx4 v6, s[4:7], s20 offen lds
    v_mfma_f32_16x16x32_bf16 v[88:91], a[236:239], a[212:215], v[88:91]
    s_add_u32 s20, s20, 128
    v_exp_f32_e64 v61, v61 clamp
    v_mfma_f32_16x16x32_bf16 v[80:83], a[236:239], a[188:191], v[80:83]
    s_add_u32 m0, s22, 2048
    v_exp_f32_e64 v62, v62 clamp
    v_mfma_f32_16x16x32_bf16 v[80:83], a[232:235], a[184:187], v[80:83]
    v_exp_f32_e64 v53, v53 clamp
    v_mfma_f32_16x16x32_bf16 v[80:83], a[228:231], a[180:183], v[80:83]
    buffer_load_dwordx4 v6, s[4:7], s20 offen lds
    v_mfma_f32_16x16x32_bf16 v[72:75], a[228:231], a[156:159], v[72:75]
    v_exp_f32_e64 v60, v60 clamp
    v_mfma_f32_16x16x32_bf16 v[72:75], a[232:235], a[160:163], v[72:75]
    ds_read_b64_tr_b16 a[224:225], v4 offset:18432
    v_mfma_f32_16x16x32_bf16 v[72:75], a[236:239], a[164:167], v[72:75]
    v_exp_f32_e64 v54, v54 clamp
    v_mfma_f32_16x16x32_bf16 v[64:67], a[236:239], a[140:143], v[64:67]
    v_exp_f32_e64 v52, v52 clamp
    v_mfma_f32_16x16x32_bf16 v[64:67], a[232:235], a[136:139], v[64:67]
    s_waitcnt lgkmcnt(1)
    s_add_u32 s20, s20, 12032
    ds_read_b64_tr_b16 a[226:227], v4 offset:12288
    v_mfma_f32_16x16x32_bf16 v[64:67], a[228:231], a[132:135], v[64:67]
    s_bitcmp1_b32 s3, 1
    v_exp_f32_e64 v63, v63 clamp
    v_mfma_f32_16x16x32_bf16 v[56:59], a[228:231], a[108:111], v[56:59]
    ds_read_b64_tr_b16 a[228:229], v5 offset:18432
    v_cvt_pk_bf16_f32 v15, v54, v55
    v_mfma_f32_16x16x32_bf16 v[56:59], a[232:235], a[112:115], v[56:59]
    ds_read_b64_tr_b16 a[230:231], v5 offset:12288
    v_cvt_pk_bf16_f32 v14, v52, v53
    v_mfma_f32_16x16x32_bf16 v[56:59], a[236:239], a[116:119], v[56:59]
    s_cbranch_scc1 L_loop5w1
    s_branch L_loop5w0
L_start4:
    s_add_u32 m0, s22, 0
    s_nop 0
    buffer_load_dwordx4 v6, s[4:7], s20 offen lds
    s_add_u32 s20, s20, 128
    s_add_u32 m0, s22, 1024
    s_nop 0
    buffer_load_dwordx4 v6, s[4:7], s20 offen lds
    s_add_u32 s20, s20, 128
    s_add_u32 m0, s22, 2048
    s_nop 0
    buffer_load_dwordx4 v6, s[4:7], s20 offen lds
    s_add_u32 s20, s20, 12032
    s_add_u32 m0, s22, 12288
    s_nop 0
    buffer_load_dwordx4 v6, s[4:7], s20 offen lds
    s_add_u32 s20, s20, 128
    s_add_u32 m0, s22, 13312
    s_nop 0
    buffer_load_dwordx4 v6, s[4:7], s20 offen lds
    s_add_u32 s20, s20, 128
    s_add_u32 m0, s22, 14336
    s_nop 0
    buffer_load_dwordx4 v6, s[4:7], s20 offen lds
    s_add_u32 s20, s20, 12032
    s_add_u32 s48, s34, 0
    s_add_u32 m0, s38, 0
    s_nop 0
    buffer_load_dwordx4 v6, s[12:15], s48 offen nt lds
    s_add_u32 m0, s38, 1024
    s_nop 0
    buffer_load_dwordx4 v7, s[12:15], s48 offen nt lds
    s_add_u32 s48, s34, 128
    s_add_u32 m0, s38, 2048
    s_nop 0
    buffer_load_dwordx4 v6, s[12:15], s48 offen nt lds
    s_add_u32 m0, s38, 3072
    s_nop 0
    buffer_load_dwordx4 v7, s[12:15], s48 offen nt lds
    s_add_u32 s48, s34, 256
    s_add_u32 m0, s38, 4096
    s_nop 0
    buffer_load_dwordx4 v6, s[12:15], s48 offen nt lds
    s_add_u32 m0, s38, 5120
    s_nop 0
    buffer_load_dwordx4 v7, s[12:15], s48 offen nt lds
    s_add_u32 s48, s34, 6144
    s_add_u32 m0, s38, 6144
    s_nop 0
    buffer_load_dwordx4 v6, s[12:15], s48 offen nt lds
    s_add_u32 m0, s38, 7168
    s_nop 0
    buffer_load_dwordx4 v7, s[12:15], s48 offen nt lds
    s_add_u32 s48, s34, 6272
    s_add_u32 m0, s38, 8192
    s_nop 0
    buffer_load_dwordx4 v6, s[12:15], s48 offen nt lds
    s_add_u32 m0, s38, 9216
    s_nop 0
    buffer_load_dwordx4 v7, s[12:15], s48 offen nt lds
    s_add_u32 s48, s34, 6400
    s_add_u32 m0, s38, 10240
    s_nop 0
    buffer_load_dwordx4 v6, s[12:15], s48 offen nt lds
    s_add_u32 m0, s38, 11264
    s_nop 0
    buffer_load_dwordx4 v7, s[12:15], s48 offen nt lds
    s_add_u32 s48, s34, 12288
    s_add_u32 m0, s38, 12288
    s_nop 0
    buffer_load_dwordx4 v6, s[12:15], s48 offen nt lds
    s_add_u32 m0, s38, 13312
    s_nop 0
    buffer_load_dwordx4 v7, s[12:15], s48 offen nt lds
    s_add_u32 s48, s34, 12416
    s_add_u32 m0, s38, 14336
    s_nop 0
    buffer_load_dwordx4 v6, s[12:15], s48 offen nt lds
    s_add_u32 m0, s38, 15360
    s_nop 0
    buffer_load_dwordx4 v7, s[12:15], s48 offen nt lds
    s_add_u32 s48, s34, 12544
    s_add_u32 m0, s38, 16384
    s_nop 0
    buffer_load_dwordx4 v6, s[12:15], s48 offen nt lds
    s_add_u32 m0, s38, 17408
    s_nop 0
    buffer_load_dwordx4 v7, s[12:15], s48 offen nt lds
    v_and_b32 v96, 15, v111
    v_lshrrev_b32 v97, 4, v111
    v_lshrrev_b32 v98, 3, v96
    v_and_b32 v99, 7, v96
    v_lshlrev_b32 v0, 7, v99
    v_bfe_u32 v99, v96, 1, 2
    v_lshlrev_b32 v99, 1, v99
    v_mul_u32_u24 v100, 5, v98
    v_xor_b32 v99, v99, v100
    v_xor_b32 v99, v99, v97
    v_lshl_add_u32 v0, v99, 4, v0
    v_mul_u32_u24 v100, 3072, v98
    v_add_u32 v0, v100, v0
    v_xor_b32 v1, 64, v0
    v_lshrrev_b32 v98, 1, v97
    v_mul_u32_u24 v2, 3072, v98
    v_and_b32 v99, 1, v97
    v_bfe_u32 v100, v111, 2, 2
    v_lshl_add_u32 v96, v99, 2, v100
    v_lshl_add_u32 v2, v96, 7, v2
    v_lshrrev_b32 v96, 1, v96
    v_lshlrev_b32 v96, 1, v96
    v_mul_u32_u24 v98, 5, v98
    v_xor_b32 v96, v96, v98
    v_bfe_u32 v99, v111, 1, 1
    v_xor_b32 v96, v96, v99
    v_lshl_add_u32 v2, v96, 4, v2
    v_and_b32 v99, 1, v111
    v_lshl_add_u32 v2, v99, 3, v2
    v_add_u32 v2, 24576, v2
    v_xor_b32 v3, 32, v2
    v_xor_b32 v4, 64, v2
    v_xor_b32 v5, 96, v2
    v_lshl_add_u32 v103, v111, 4, s38
    v_and_b32 v96, 15, v111
    v_lshrrev_b32 v98, 1, v111
    v_and_or_b32 v98, v98, 16, v96
    s_mov_b32 s42, 0x22110033
    v_bfe_i32 v97, s42, v98, 1
    v_and_b32 v97, 0x3f803f80, v97
    v_accvgpr_write_b32 a240, v97
    v_accvgpr_write_b32 a241, v97
    v_accvgpr_write_b32 a242, v97
    v_accvgpr_write_b32 a243, v97
    s_mov_b32 s42, 0x44110055
    v_bfe_i32 v97, s42, v98, 1
    v_and_b32 v97, 0x3f803f80, v97
    v_accvgpr_write_b32 a244, v97
    v_accvgpr_write_b32 a245, v97
    v_accvgpr_write_b32 a246, v97
    v_accvgpr_write_b32 a247, v97
    s_mov_b32 s42, 0x88898889
    v_bfe_i32 v97, s42, v98, 1
    v_and_b32 v97, 0x3f803f80, v97
    v_accvgpr_write_b32 a248, v97
    v_accvgpr_write_b32 a249, v97
    v_accvgpr_write_b32 a250, v97
    v_accvgpr_write_b32 a251, v97
    s_mov_b32 s42, 0x50005
    v_bfe_i32 v97, s42, v98, 1
    v_and_b32 v97, 0x3f803f80, v97
    v_accvgpr_write_b32 a252, v97
    v_accvgpr_write_b32 a253, v97
    v_accvgpr_write_b32 a254, v97
    v_accvgpr_write_b32 a255, v97
    v_bfe_i32 v97, v111, 2, 1
    v_and_b32 v97, 0xaaaa, v97
    v_or_b32 v101, 0x4444, v97
    s_waitcnt vmcnt(18)
    s_barrier
    s_waitcnt vmcnt(12)
    s_add_u32 s48, s34, 18432
    s_add_u32 m0, s38, 18432
    ds_read_b128 a[216:219], v0 offset:0
    buffer_load_dwordx4 v6, s[12:15], s48 offen nt lds
    v_lshrrev_b32 v105, 11, v0
    s_add_u32 m0, s38, 19456
    v_xor_b32 v105, s65, v105
    buffer_load_dwordx4 v7, s[12:15], s48 offen nt lds
    ds_read_b128 a[228:231], v1 offset:1024
    s_add_u32 s48, s34, 18560
    s_add_u32 m0, s38, 20480
    ds_read_b128 a[236:239], v1 offset:2048
    v_and_b32 v104, 0x3ff, v0
    v_lshl_add_u32 v104, v105, 10, v104
    buffer_load_dwordx4 v6, s[12:15], s48 offen nt lds
    s_add_u32 m0, s38, 21504
    ds_read_b128 a[224:227], v0 offset:1024
    buffer_load_dwordx4 v7, s[12:15], s48 offen nt lds
    v_add_u32 v104, s38, v104
    s_add_u32 s48, s34, 18688
    ds_read_b128 a[96:99], v104 offset:0
    v_xor_b32 v105, 64, v104
    s_add_u32 m0, s38, 22528
    s_nop 0
    buffer_load_dwordx4 v6, s[12:15], s48 offen nt lds
    ds_read_b128 a[220:223], v1 offset:0
    s_add_u32 m0, s38, 23552
    ds_read_b128 a[232:235], v0 offset:2048
    buffer_load_dwordx4 v7, s[12:15], s48 offen nt lds
    ds_read_b128 a[108:111], v105 offset:2048
    s_waitcnt lgkmcnt(3)
    v_mfma_f32_16x16x32_bf16 v[52:55], a[216:219], a[96:99], 0
    ds_read_b128 a[100:103], v105 offset:0
    s_waitcnt lgkmcnt(0)
    v_mfma_f32_16x16x32_bf16 v[52:55], a[220:223], a[100:103], v[52:55]
    ds_read_b128 a[104:107], v104 offset:2048
    ds_read_b128 a[112:115], v104 offset:4096
    s_waitcnt lgkmcnt(1)
    v_mfma_f32_16x16x32_bf16 v[52:55], a[224:227], a[104:107], v[52:55]
    ds_read_b128 a[116:119], v105 offset:4096
    v_mfma_f32_16x16x32_bf16 v[52:55], a[228:231], a[108:111], v[52:55]
    s_waitcnt lgkmcnt(1)
    ds_read_b128 a[220:223], v1 offset:6144
    v_mfma_f32_16x16x32_bf16 v[52:55], a[232:235], a[112:115], v[52:55]
    ds_read_b128 a[216:219], v0 offset:6144
    s_waitcnt lgkmcnt(2)
    v_mfma_f32_16x16x32_bf16 v[52:55], a[236:239], a[116:119], v[52:55]
    ds_read_b128 a[224:227], v0 offset:7168
    s_waitcnt lgkmcnt(1)
    v_mfma_f32_16x16x32_bf16 v[56:59], a[216:219], a[96:99], 0
    ds_read_b128 a[216:219], v0 offset:12288
    v_mfma_f32_16x16x32_bf16 v[56:59], a[220:223], a[100:103], v[56:59]
    ds_read_b128 a[236:239], v1 offset:8192
    ds_read_b128 a[228:231], v1 offset:7168
    s_waitcnt lgkmcnt(3)
    v_mfma_f32_16x16x32_bf16 v[56:59], a[224:227], a[104:107], v[56:59]
    ds_read_b128 a[220:223], v1 offset:12288
    s_waitcnt lgkmcnt(1)
    v_mfma_f32_16x16x32_bf16 v[56:59], a[228:231], a[108:111], v[56:59]
    ds_read_b128 a[228:231], v1 offset:13312
    v_max3_f32 v96, v52, v53, v54
    ds_read_b128 a[232:235], v0 offset:8192
    s_waitcnt lgkmcnt(0)
    v_mfma_f32_16x16x32_bf16 v[56:59], a[232:235], a[112:115], v[56:59]
    ds_read_b128 a[224:227], v0 offset:13312
    v_mfma_f32_16x16x32_bf16 v[56:59], a[236:239], a[116:119], v[56:59]
    s_nop 7
    v_max3_f32 v96, v96, v55, v56
    v_max3_f32 v96, v96, v57, v58
    v_max_f32 v96, v96, v59
    v_mov_b32 v97, v96
    ds_read_b128 a[236:239], v1 offset:14336
    s_nop 0
    v_permlane32_swap_b32 v97, v96
    v_max_f32 v96, v96, v97
    v_mov_b32 v97, v96
    s_nop 1
    v_permlane16_swap_b32 v97, v96
    v_max_f32 v96, v96, v97
    v_mul_f32_e64 v9, -s28, v96
    v_subrev_f32 v9, 0x42000000, v9
    v_fma_f32 v53, v53, s28, v9
    v_fma_f32 v55, v55, s28, v9
    v_fma_f32 v52, v52, s28, v9
    v_fma_f32 v57, v57, s28, v9
    v_fma_f32 v54, v54, s28, v9
    v_exp_f32_e64 v53, v53 clamp
    ds_read_b128 a[232:235], v0 offset:14336
    v_exp_f32_e64 v57, v57 clamp
    v_exp_f32_e64 v55, v55 clamp
    v_exp_f32_e64 v52, v52 clamp
    s_nop 0
    v_cvt_pk_bf16_f32 v14, v52, v53
    v_exp_f32_e64 v54, v54 clamp
    s_nop 0
    v_cvt_pk_bf16_f32 v15, v54, v55
    s_waitcnt vmcnt(12)
    s_add_u32 m0, s22, 24576
    s_nop 0
    buffer_load_dwordx4 v6, s[8:11], s21 offen lds
    s_add_u32 s21, s21, 128
    v_mfma_f32_16x16x32_bf16 v[52:55], a[216:219], a[96:99], 0
    s_add_u32 m0, s22, 25600
    ds_read_b128 a[128:131], v104 offset:8192
    buffer_load_dwordx4 v6, s[8:11], s21 offen lds
    v_fma_f32 v59, v59, s28, v9
    s_add_u32 s21, s21, 128
    v_mfma_f32_16x16x32_bf16 v[52:55], a[220:223], a[100:103], v[52:55]
    ds_read_b128 a[220:223], v1 offset:18432
    v_fma_f32 v56, v56, s28, v9
    s_add_u32 m0, s22, 26624
    s_nop 0
    buffer_load_dwordx4 v6, s[8:11], s21 offen lds
    s_waitcnt lgkmcnt(2)
    v_mfma_f32_16x16x32_bf16 v[52:55], a[224:227], a[104:107], v[52:55]
    ds_read_b128 a[216:219], v0 offset:18432
    v_mfma_f32_16x16x32_bf16 v[52:55], a[228:231], a[108:111], v[52:55]
    s_add_u32 s21, s21, 12032
    ds_read_b128 a[228:231], v1 offset:19456
    v_mfma_f32_16x16x32_bf16 v[52:55], a[232:235], a[112:115], v[52:55]
    v_fma_f32 v58, v58, s28, v9
    ds_read_b128 a[224:227], v0 offset:19456
    v_exp_f32_e64 v59, v59 clamp
    v_exp_f32_e64 v56, v56 clamp
    v_mfma_f32_16x16x32_bf16 v[52:55], a[236:239], a[116:119], v[52:55]
    v_exp_f32_e64 v58, v58 clamp
    s_nop 0
    v_cvt_pk_bf16_f32 v17, v58, v59
    v_cvt_pk_bf16_f32 v16, v56, v57
    ds_read_b128 a[232:235], v0 offset:20480
    ds_read_b128 a[132:135], v105 offset:8192
    s_waitcnt lgkmcnt(4)
    v_mfma_f32_16x16x32_bf16 v[56:59], a[216:219], a[96:99], 0
    ds_read_b128 a[136:139], v104 offset:10240
    v_mfma_f32_16x16x32_bf16 v[56:59], a[220:223], a[100:103], v[56:59]
    ds_read_b128 a[236:239], v1 offset:20480
    v_mfma_f32_16x16x32_bf16 v[44:47], a[248:251], v[14:17], 0
    ds_read_b128 a[124:127], v105 offset:6144
    s_waitcnt lgkmcnt(5)
    v_mfma_f32_16x16x32_bf16 v[56:59], a[224:227], a[104:107], v[56:59]
    ds_read_b128 a[220:223], v1 offset:0
    ds_read_b128 a[216:219], v0 offset:0
    v_mfma_f32_16x16x32_bf16 v[56:59], a[228:231], a[108:111], v[56:59]
    ds_read_b128 a[224:227], v0 offset:1024
    s_waitcnt lgkmcnt(7)
    v_mfma_f32_16x16x32_bf16 v[56:59], a[232:235], a[112:115], v[56:59]
    ds_read_b128 a[228:231], v1 offset:1024
    s_waitcnt lgkmcnt(5)
    v_mfma_f32_16x16x32_bf16 v[56:59], a[236:239], a[116:119], v[56:59]
    ds_read_b128 a[120:123], v104 offset:6144
    s_waitcnt lgkmcnt(0)
    v_mfma_f32_16x16x32_bf16 v[60:63], a[216:219], a[120:123], 0
    ds_read_b128 a[216:219], v0 offset:6144
    v_mfma_f32_16x16x32_bf16 v[60:63], a[220:223], a[124:127], v[60:63]
    ds_read_b128 a[236:239], v1 offset:2048
    v_mfma_f32_16x16x32_bf16 v[60:63], a[224:227], a[128:131], v[60:63]
    ds_read_b128 a[140:143], v105 offset:10240
    v_mfma_f32_16x16x32_bf16 v[60:63], a[228:231], a[132:135], v[60:63]
    ds_read_b128 a[232:235], v0 offset:2048
    s_waitcnt lgkmcnt(0)
    v_mfma_f32_16x16x32_bf16 v[60:63], a[232:235], a[136:139], v[60:63]
    ds_read_b128 a[220:223], v1 offset:6144
    v_mfma_f32_16x16x32_bf16 v[60:63], a[236:239], a[140:143], v[60:63]
    ds_read_b128 a[224:227], v0 offset:7168
    s_nop 6
    v_max3_f32 v98, v60, v61, v62
    v_mfma_f32_16x16x32_bf16 v[64:67], a[216:219], a[120:123], 0
    ds_read_b128 a[236:239], v1 offset:8192
    s_waitcnt lgkmcnt(2)
    v_mfma_f32_16x16x32_bf16 v[64:67], a[220:223], a[124:127], v[64:67]
    ds_read_b128 a[228:231], v1 offset:7168
    s_waitcnt lgkmcnt(2)
    v_mfma_f32_16x16x32_bf16 v[64:67], a[224:227], a[128:131], v[64:67]
    ds_read_b128 a[232:235], v0 offset:8192
    s_waitcnt lgkmcnt(1)
    v_mfma_f32_16x16x32_bf16 v[64:67], a[228:231], a[132:135], v[64:67]
    ds_read_b128 a[228:231], v1 offset:13312
    s_waitcnt lgkmcnt(1)
    v_mfma_f32_16x16x32_bf16 v[64:67], a[232:235], a[136:139], v[64:67]
    ds_read_b128 a[220:223], v1 offset:12288
    v_mfma_f32_16x16x32_bf16 v[64:67], a[236:239], a[140:143], v[64:67]
    s_nop 7
    v_max3_f32 v98, v98, v63, v64
    v_max3_f32 v98, v98, v65, v66
    v_max_f32 v98, v98, v67
    v_mov_b32 v99, v98
    ds_read_b128 a[216:219], v0 offset:12288
    s_nop 0
    v_permlane32_swap_b32 v99, v98
    v_max_f32 v98, v98, v99
    v_fma_f32 v53, v53, s28, v9
    v_mov_b32 v99, v98
    ds_read_b128 a[224:227], v0 offset:13312
    s_nop 0
    v_permlane16_swap_b32 v99, v98
    v_max_f32 v98, v98, v99
    v_mul_f32_e64 v10, -s28, v98
    v_subrev_f32 v10, 0x42000000, v10
    v_fma_f32 v60, v60, s28, v10
    v_fma_f32 v67, v67, s28, v10
    v_fma_f32 v62, v62, s28, v10
    ds_read_b128 a[236:239], v1 offset:14336
    v_fma_f32 v52, v52, s28, v9
    v_fma_f32 v61, v61, s28, v10
    v_fma_f32 v63, v63, s28, v10
    v_exp_f32_e64 v63, v63 clamp
    v_exp_f32_e64 v61, v61 clamp
    v_exp_f32_e64 v60, v60 clamp
    s_nop 0
    v_cvt_pk_bf16_f32 v22, v60, v61
    v_exp_f32_e64 v62, v62 clamp
    s_nop 0
    v_cvt_pk_bf16_f32 v23, v62, v63
    v_fma_f32 v66, v66, s28, v10
    s_waitcnt lgkmcnt(2)
    v_mfma_f32_16x16x32_bf16 v[60:63], a[216:219], a[120:123], 0
    v_fma_f32 v65, v65, s28, v10
    v_fma_f32 v64, v64, s28, v10
    ds_read_b128 a[232:235], v0 offset:14336
    v_mfma_f32_16x16x32_bf16 v[60:63], a[220:223], a[124:127], v[60:63]
    ds_read_b128 a[216:219], v0 offset:18432
    v_fma_f32 v54, v54, s28, v9
    v_fma_f32 v55, v55, s28, v9
    ds_read_b128 a[220:223], v1 offset:18432
    v_exp_f32_e64 v65, v65 clamp
    v_exp_f32_e64 v67, v67 clamp
    s_waitcnt vmcnt(9)
    s_add_u32 m0, s22, 36864
    ds_read_b128 a[156:159], v105 offset:14336
    buffer_load_dwordx4 v6, s[8:11], s21 offen lds
    s_add_u32 s21, s21, 128
    s_add_u32 m0, s22, 37888
    s_waitcnt lgkmcnt(4)
    v_mfma_f32_16x16x32_bf16 v[60:63], a[224:227], a[128:131], v[60:63]
    buffer_load_dwordx4 v6, s[8:11], s21 offen lds
    s_add_u32 s21, s21, 128
    s_add_u32 m0, s22, 38912
    ds_read_b128 a[164:167], v105 offset:16384
    v_mfma_f32_16x16x32_bf16 v[60:63], a[228:231], a[132:135], v[60:63]
    buffer_load_dwordx4 v6, s[8:11], s21 offen lds
    v_exp_f32_e64 v64, v64 clamp
    s_nop 0
    v_cvt_pk_bf16_f32 v24, v64, v65
    ds_read_b128 a[224:227], v0 offset:19456
    s_waitcnt lgkmcnt(3)
    v_mfma_f32_16x16x32_bf16 v[60:63], a[232:235], a[136:139], v[60:63]
    ds_read_b128 a[152:155], v104 offset:14336
    v_exp_f32_e64 v66, v66 clamp
    v_mfma_f32_16x16x32_bf16 v[60:63], a[236:239], a[140:143], v[60:63]
    v_cvt_pk_bf16_f32 v25, v66, v67
    ds_read_b128 a[228:231], v1 offset:19456
    ds_read_b128 a[148:151], v105 offset:12288
    v_mfma_f32_16x16x32_bf16 v[64:67], a[216:219], a[120:123], 0
    ds_read_b128 a[232:235], v0 offset:20480
    v_mfma_f32_16x16x32_bf16 v[64:67], a[220:223], a[124:127], v[64:67]
    ds_read_b128 a[236:239], v1 offset:20480
    s_waitcnt lgkmcnt(5)
    v_mfma_f32_16x16x32_bf16 v[64:67], a[224:227], a[128:131], v[64:67]
    ds_read_b128 a[160:163], v104 offset:16384
    s_waitcnt lgkmcnt(4)
    v_mfma_f32_16x16x32_bf16 v[64:67], a[228:231], a[132:135], v[64:67]
    ds_read_b128 a[144:147], v104 offset:12288
    ds_read_b128 a[216:219], v0 offset:0
    ds_read_b128 a[220:223], v1 offset:0
    s_waitcnt lgkmcnt(5)
    v_mfma_f32_16x16x32_bf16 v[64:67], a[232:235], a[136:139], v[64:67]
    s_waitcnt lgkmcnt(4)
    ds_read_b128 a[228:231], v1 offset:1024
    v_exp_f32_e64 v52, v52 clamp
    v_mfma_f32_16x16x32_bf16 v[64:67], a[236:239], a[140:143], v[64:67]
    ds_read_b128 a[224:227], v0 offset:1024
    s_waitcnt lgkmcnt(3)
    v_mfma_f32_16x16x32_bf16 v[68:71], a[216:219], a[144:147], 0
    s_waitcnt lgkmcnt(2)
    ds_read_b128 a[232:235], v0 offset:2048
    v_mfma_f32_16x16x32_bf16 v[68:71], a[220:223], a[148:151], v[68:71]
    ds_read_b128 a[216:219], v0 offset:6144
    s_waitcnt lgkmcnt(2)
    v_mfma_f32_16x16x32_bf16 v[68:71], a[224:227], a[152:155], v[68:71]
    ds_read_b128 a[236:239], v1 offset:2048
    v_fma_f32 v61, v61, s28, v10
    v_mfma_f32_16x16x32_bf16 v[68:71], a[228:231], a[156:159], v[68:71]
    ds_read_b128 a[220:223], v1 offset:6144
    v_exp_f32_e64 v61, v61 clamp
    s_waitcnt lgkmcnt(3)
    v_mfma_f32_16x16x32_bf16 v[68:71], a[232:235], a[160:163], v[68:71]
    ds_read_b128 a[224:227], v0 offset:7168
    s_waitcnt lgkmcnt(2)
    v_mfma_f32_16x16x32_bf16 v[68:71], a[236:239], a[164:167], v[68:71]
    ds_read_b128 a[228:231], v1 offset:7168
    v_mfma_f32_16x16x32_bf16 v[72:75], a[216:219], a[144:147], 0
    s_add_u32 s21, s21, 12032
    ds_read_b128 a[232:235], v0 offset:8192
    ds_read_b128 a[236:239], v1 offset:8192
    s_nop 2
    v_max3_f32 v96, v68, v69, v70
    s_waitcnt lgkmcnt(4)
    v_mfma_f32_16x16x32_bf16 v[72:75], a[220:223], a[148:151], v[72:75]
    ds_read_b128 a[216:219], v0 offset:12288
    s_waitcnt lgkmcnt(4)
    v_mfma_f32_16x16x32_bf16 v[72:75], a[224:227], a[152:155], v[72:75]
    ds_read_b128 a[220:223], v1 offset:12288
    v_fma_f32 v60, v60, s28, v10
    s_waitcnt lgkmcnt(4)
    v_mfma_f32_16x16x32_bf16 v[72:75], a[228:231], a[156:159], v[72:75]
    ds_read_b128 a[228:231], v1 offset:13312
    s_waitcnt lgkmcnt(4)
    v_mfma_f32_16x16x32_bf16 v[72:75], a[232:235], a[160:163], v[72:75]
    s_waitcnt lgkmcnt(3)
    ds_read_b128 a[232:235], v0 offset:14336
    v_exp_f32_e64 v53, v53 clamp
    v_mfma_f32_16x16x32_bf16 v[72:75], a[236:239], a[164:167], v[72:75]
    s_nop 7
    v_max3_f32 v96, v96, v71, v72
    v_max3_f32 v96, v96, v73, v74
    v_max_f32 v96, v96, v75
    v_mov_b32 v97, v96
    ds_read_b128 a[236:239], v1 offset:14336
    s_nop 0
    v_permlane32_swap_b32 v97, v96
    v_max_f32 v96, v96, v97
    v_mov_b32 v97, v96
    s_nop 1
    v_permlane16_swap_b32 v97, v96
    v_max_f32 v96, v96, v97
    v_mul_f32_e64 v11, -s28, v96
    v_subrev_f32 v11, 0x42000000, v11
    v_fma_f32 v70, v70, s28, v11
    v_fma_f32 v75, v75, s28, v11
    v_fma_f32 v69, v69, s28, v11
    v_exp_f32_e64 v69, v69 clamp
    v_fma_f32 v68, v68, s28, v11
    v_fma_f32 v71, v71, s28, v11
    v_exp_f32_e64 v70, v70 clamp
    v_exp_f32_e64 v71, v71 clamp
    s_nop 0
    v_cvt_pk_bf16_f32 v27, v70, v71
    v_exp_f32_e64 v68, v68 clamp
    s_nop 0
    v_cvt_pk_bf16_f32 v26, v68, v69
    s_waitcnt lgkmcnt(1)
    v_mfma_f32_16x16x32_bf16 v[68:71], a[216:219], a[144:147], 0
    v_fma_f32 v74, v74, s28, v11
    v_exp_f32_e64 v54, v54 clamp
    ds_read_b128 a[224:227], v0 offset:13312
    v_fma_f32 v73, v73, s28, v11
    v_fma_f32 v72, v72, s28, v11
    v_mfma_f32_16x16x32_bf16 v[68:71], a[220:223], a[148:151], v[68:71]
    v_exp_f32_e64 v75, v75 clamp
    ds_read_b128 a[216:219], v0 offset:18432
    s_waitcnt lgkmcnt(1)
    v_mfma_f32_16x16x32_bf16 v[68:71], a[224:227], a[152:155], v[68:71]
    ds_read_b128 a[224:227], v0 offset:19456
    v_exp_f32_e64 v72, v72 clamp
    v_mfma_f32_16x16x32_bf16 v[68:71], a[228:231], a[156:159], v[68:71]
    ds_read_b128 a[220:223], v1 offset:18432
    v_exp_f32_e64 v55, v55 clamp
    v_exp_f32_e64 v74, v74 clamp
    s_nop 0
    v_cvt_pk_bf16_f32 v29, v74, v75
    v_mfma_f32_16x16x32_bf16 v[68:71], a[232:235], a[160:163], v[68:71]
    ds_read_b128 a[232:235], v0 offset:20480
    v_exp_f32_e64 v73, v73 clamp
    v_mfma_f32_16x16x32_bf16 v[68:71], a[236:239], a[164:167], v[68:71]
    s_waitcnt lgkmcnt(3)
    ds_read_b128 a[236:239], v1 offset:20480
    v_cvt_pk_bf16_f32 v28, v72, v73
    v_mfma_f32_16x16x32_bf16 v[72:75], a[216:219], a[144:147], 0
    ds_read_b128 a[228:231], v1 offset:19456
    v_cvt_pk_bf16_f32 v18, v52, v53
    s_waitcnt lgkmcnt(3)
    v_mfma_f32_16x16x32_bf16 v[72:75], a[220:223], a[148:151], v[72:75]
    ds_read_b128 a[216:219], v0 offset:0
    v_mfma_f32_16x16x32_bf16 v[72:75], a[224:227], a[152:155], v[72:75]
    v_cvt_pk_bf16_f32 v19, v54, v55
    ds_read_b128 a[220:223], v1 offset:0
    ds_read_b128 a[224:227], v0 offset:1024
    s_waitcnt lgkmcnt(3)
    v_mfma_f32_16x16x32_bf16 v[72:75], a[228:231], a[156:159], v[72:75]
    s_waitcnt vmcnt(6)
    ds_read_b128 a[168:171], v104 offset:18432
    v_mfma_f32_16x16x32_bf16 v[72:75], a[232:235], a[160:163], v[72:75]
    ds_read_b128 a[188:191], v105 offset:22528
    ds_read_b128 a[172:175], v105 offset:18432
    ds_read_b128 a[228:231], v1 offset:1024
    ds_read_b128 a[184:187], v104 offset:22528
    ds_read_b128 a[176:179], v104 offset:20480
    v_mfma_f32_16x16x32_bf16 v[72:75], a[236:239], a[164:167], v[72:75]
    ds_read_b128 a[180:183], v105 offset:20480
    ds_read_b128 a[236:239], v1 offset:2048
    ds_read_b128 a[232:235], v0 offset:2048
    v_exp_f32_e64 v60, v60 clamp
    s_waitcnt lgkmcnt(8)
    v_mfma_f32_16x16x32_bf16 v[76:79], a[216:219], a[168:171], 0
    ds_read_b128 a[216:219], v0 offset:6144
    s_waitcnt lgkmcnt(7)
    v_mfma_f32_16x16x32_bf16 v[76:79], a[220:223], a[172:175], v[76:79]
    ds_read_b128 a[220:223], v1 offset:6144
    s_waitcnt lgkmcnt(5)
    v_mfma_f32_16x16x32_bf16 v[76:79], a[224:227], a[176:179], v[76:79]
    s_waitcnt lgkmcnt(4)
    ds_read_b128 a[224:227], v0 offset:7168
    v_mfma_f32_16x16x32_bf16 v[76:79], a[228:231], a[180:183], v[76:79]
    s_waitcnt lgkmcnt(3)
    ds_read_b128 a[228:231], v1 offset:7168
    v_mfma_f32_16x16x32_bf16 v[76:79], a[232:235], a[184:187], v[76:79]
    ds_read_b128 a[232:235], v0 offset:8192
    v_mfma_f32_16x16x32_bf16 v[76:79], a[236:239], a[188:191], v[76:79]
    ds_read_b128 a[236:239], v1 offset:8192
    s_waitcnt lgkmcnt(5)
    v_mfma_f32_16x16x32_bf16 v[80:83], a[216:219], a[168:171], 0
    s_waitcnt lgkmcnt(4)
    v_mfma_f32_16x16x32_bf16 v[80:83], a[220:223], a[172:175], v[80:83]
    s_nop 2
    v_max3_f32 v98, v76, v77, v78
    s_waitcnt lgkmcnt(3)
    v_mfma_f32_16x16x32_bf16 v[80:83], a[224:227], a[176:179], v[80:83]
    s_waitcnt lgkmcnt(2)
    v_mfma_f32_16x16x32_bf16 v[80:83], a[228:231], a[180:183], v[80:83]
    s_waitcnt vmcnt(63) lgkmcnt(0)
    s_barrier
    ds_read_b128 a[224:227], v0 offset:13312
    v_mfma_f32_16x16x32_bf16 v[80:83], a[232:235], a[184:187], v[80:83]
    s_add_u32 m0, s22, 0
    ds_read_b128 a[228:231], v1 offset:13312
    buffer_load_dwordx4 v6, s[4:7], s20 offen lds
    v_mfma_f32_16x16x32_bf16 v[80:83], a[236:239], a[188:191], v[80:83]
    s_add_u32 s20, s20, 128
    s_add_u32 m0, s22, 1024
    ds_read_b128 a[220:223], v1 offset:12288
    buffer_load_dwordx4 v6, s[4:7], s20 offen lds
    ds_read_b128 a[236:239], v1 offset:14336
    v_smfmac_f32_16x16x64_bf16 v[44:47], a[240:243], v[22:29], v101
    s_add_u32 s20, s20, 128
    s_add_u32 m0, s22, 2048
    ds_read_b128 a[216:219], v0 offset:12288
    ds_read_b128 a[232:235], v0 offset:14336
    buffer_load_dwordx4 v6, s[4:7], s20 offen lds
    v_max3_f32 v98, v98, v79, v80
    v_max3_f32 v98, v98, v81, v82
    v_max_f32 v98, v98, v83
    v_mov_b32 v99, v98
    s_add_u32 s20, s20, 12032
    s_mov_b32 s39, s64
    v_permlane32_swap_b32 v99, v98
    v_max_f32 v98, v98, v99
    v_mov_b32 v99, v98
    s_add_u32 s37, s37, 1
    s_bitcmp1_b32 s63, s37
    v_permlane16_swap_b32 v99, v98
    s_cselect_b32 s62, 4294770688, 0
    v_max_f32 v98, v98, v99
    v_mul_f32_e64 v12, -s28, v98
    v_subrev_f32 v12, 0x42000000, v12
    v_fma_f32 v78, v78, s28, v12
    v_fma_f32 v79, v79, s28, v12
    v_exp_f32_e64 v78, v78 clamp
    s_cselect_b32 s42, 0, 325632
    v_fma_f32 v76, v76, s28, v12
    s_add_u32 s35, s35, s42
    v_exp_f32_e64 v79, v79 clamp
    v_exp_f32_e64 v76, v76 clamp
    v_fma_f32 v77, v77, s28, v12
    v_cvt_pk_bf16_f32 v35, v78, v79
    v_exp_f32_e64 v77, v77 clamp
    s_lshl_b32 s42, s37, 1
    v_cvt_pk_bf16_f32 v34, v76, v77
    s_waitcnt lgkmcnt(0)
    v_mfma_f32_16x16x32_bf16 v[76:79], a[216:219], a[168:171], 0
    s_lshr_b32 s42, s31, s42
    ds_read_b128 a[216:219], v0 offset:18432
    v_fma_f32 v81, v81, s28, v12
    v_mfma_f32_16x16x32_bf16 v[76:79], a[220:223], a[172:175], v[76:79]
    s_and_b32 s42, s42, 3
    s_add_u32 s42, s42, s36
    ds_read_b128 a[220:223], v1 offset:18432
    v_mfma_f32_16x16x32_bf16 v[76:79], a[224:227], a[176:179], v[76:79]
    s_sub_u32 s43, s42, 3
    s_cmp_ge_u32 s42, 3
    ds_read_b128 a[224:227], v0 offset:19456
    v_mfma_f32_16x16x32_bf16 v[76:79], a[228:231], a[180:183], v[76:79]
    s_cselect_b32 s42, s43, s42
    s_mul_i32 s44, s3, 5
    ds_read_b128 a[228:231], v1 offset:19456
    v_mfma_f32_16x16x32_bf16 v[76:79], a[232:235], a[184:187], v[76:79]
    s_mov_b32 s32, 1
    s_lshl_b32 s43, s3, 2
    ds_read_b128 a[232:235], v0 offset:20480
    v_mfma_f32_16x16x32_bf16 v[76:79], a[236:239], a[188:191], v[76:79]
    s_add_u32 s45, s43, 21
    ds_read_b128 a[236:239], v1 offset:20480
    s_cmp_eq_u32 s3, 0
    s_cselect_b32 s45, 20, s45
    s_cselect_b32 s33, 1, 0
    s_cmp_eq_u32 s42, 1
    s_cselect_b32 s44, s45, s44
    v_fma_f32 v83, v83, s28, v12
    v_fma_f32 v80, v80, s28, v12
    s_cselect_b32 s32, s33, s32
    s_add_u32 s45, s43, 37
    s_cmp_eq_u32 s42, 2
    s_cselect_b32 s44, s45, s44
    s_cselect_b32 s32, 0, s32
    s_mul_i32 s44, s44, 6144
    v_exp_f32_e64 v81, v81 clamp
    v_exp_f32_e64 v80, v80 clamp
    v_fma_f32 v82, v82, s28, v12
    s_add_u32 s33, s35, s44
    v_exp_f32_e64 v82, v82 clamp
    s_mul_i32 s42, s32, 6144
    s_add_u32 s42, s42, 24576
    s_add_u32 s42, s42, s33
    s_cmp_ge_u32 s37, 6
    s_cselect_b32 s14, 0, s42
    v_exp_f32_e64 v83, v83 clamp
    s_add_u32 s24, s67, 6144
    v_cvt_pk_bf16_f32 v36, v80, v81
    s_add_u32 s25, s33, 6144
    v_cvt_pk_bf16_f32 v37, v82, v83
    s_add_u32 s23, s38, 6144
    s_mov_b32 s27, 0x30c30
    s_mov_b32 s89, 0xaaaaaaaa
    s_mov_b32 s30, 0
    s_waitcnt vmcnt(6) lgkmcnt(0)
    v_mfma_f32_16x16x32_bf16 v[80:83], a[216:219], a[168:171], 0
    s_barrier
    ds_read_b64_tr_b16 a[216:217], v2 offset:0
    ds_read_b64_tr_b16 a[218:219], v2 offset:6144
    s_add_u32 m0, s22, 12288
    v_mfma_f32_16x16x32_bf16 v[80:83], a[220:223], a[172:175], v[80:83]
    ds_read_b64_tr_b16 a[220:221], v3 offset:0
    ds_read_b64_tr_b16 a[222:223], v3 offset:6144
    v_mfma_f32_16x16x32_bf16 v[80:83], a[224:227], a[176:179], v[80:83]
    ds_read_b64_tr_b16 a[224:225], v4 offset:0
    buffer_load_dwordx4 v6, s[4:7], s20 offen lds
    v_mfma_f32_16x16x32_bf16 v[44:47], a[252:255], v[34:37], v[44:47]
    s_add_u32 s20, s20, 128
    ds_read_b64_tr_b16 a[226:227], v4 offset:6144
    s_add_u32 m0, s22, 13312
    s_nop 0
    buffer_load_dwordx4 v6, s[4:7], s20 offen lds
    v_mfma_f32_16x16x32_bf16 v[80:83], a[228:231], a[180:183], v[80:83]
    s_add_u32 s20, s20, 128
    s_add_u32 m0, s22, 14336
    ds_read_b64_tr_b16 a[228:229], v5 offset:0
    buffer_load_dwordx4 v6, s[4:7], s20 offen lds
    v_mfma_f32_16x16x32_bf16 v[80:83], a[232:235], a[184:187], v[80:83]
    s_add_u32 s20, s20, 12032
    ds_read_b64_tr_b16 a[230:231], v5 offset:6144
    v_mfma_f32_16x16x32_bf16 v[80:83], a[236:239], a[188:191], v[80:83]
    s_waitcnt lgkmcnt(6)
    v_mfma_f32_16x16x32_bf16 v[112:115], a[216:219], v[14:17], 0
    ds_read_b64_tr_b16 a[238:239], v3 offset:7168
    v_fma_f32 v62, v62, s28, v10
    v_mfma_f32_16x16x32_bf16 v[160:163], a[216:219], v[22:25], 0
    v_fma_f32 v79, v79, s28, v12
    v_fma_f32 v66, v66, s28, v10
    v_mfma_f32_16x16x32_bf16 v[208:211], a[216:219], v[26:29], 0
    ds_read_b64_tr_b16 a[232:233], v2 offset:1024
    v_fma_f32 v81, v81, s28, v12
    v_mfma_f32_16x16x32_bf16 a[0:3], a[216:219], v[34:37], 0
    ds_read_b64_tr_b16 a[236:237], v3 offset:1024
    s_waitcnt lgkmcnt(7)
    v_mfma_f32_16x16x32_bf16 a[4:7], a[220:223], v[34:37], 0
    s_add_u32 s39, s39, 12288
    v_exp_f32_e64 v79, v79 clamp
    v_mfma_f32_16x16x32_bf16 v[212:215], a[220:223], v[26:29], 0
    ds_read_b64_tr_b16 a[234:235], v2 offset:7168
    v_fma_f32 v82, v82, s28, v12
    v_mfma_f32_16x16x32_bf16 v[164:167], a[220:223], v[22:25], 0
    v_exp_f32_e64 v82, v82 clamp
    v_mfma_f32_16x16x32_bf16 v[116:119], a[220:223], v[14:17], 0
    ds_read_b64_tr_b16 a[216:217], v4 offset:1024
    s_waitcnt lgkmcnt(7)
    v_mfma_f32_16x16x32_bf16 v[120:123], a[224:227], v[14:17], 0
    v_fma_f32 v71, v71, s28, v11
    v_mov_b32 v39, v7
    v_mfma_f32_16x16x32_bf16 v[168:171], a[224:227], v[22:25], 0
    v_fma_f32 v70, v70, s28, v11
    v_fma_f32 v72, v72, s28, v11
    v_mfma_f32_16x16x32_bf16 v[216:219], a[224:227], v[26:29], 0
    v_mov_b32 v38, v6
    v_fma_f32 v63, v63, s28, v10
    v_mfma_f32_16x16x32_bf16 a[8:11], a[224:227], v[34:37], 0
    s_waitcnt lgkmcnt(4)
    ds_read_b64_tr_b16 a[222:223], v5 offset:7168
    v_fma_f32 v78, v78, s28, v12
    v_mfma_f32_16x16x32_bf16 a[12:15], a[228:231], v[34:37], 0
    ds_read_b64_tr_b16 a[220:221], v5 offset:1024
    v_fma_f32 v74, v74, s28, v11
    v_mfma_f32_16x16x32_bf16 v[220:223], a[228:231], v[26:29], 0
    ds_read_b64_tr_b16 a[218:219], v4 offset:7168
    v_fma_f32 v59, v59, s28, v9
    v_mfma_f32_16x16x32_bf16 v[172:175], a[228:231], v[22:25], 0
    v_fma_f32 v57, v57, s28, v9
    v_fma_f32 v58, v58, s28, v9
    v_mfma_f32_16x16x32_bf16 v[124:127], a[228:231], v[14:17], 0
    s_waitcnt lgkmcnt(4)
    v_exp_f32_e64 v63, v63 clamp
    v_mfma_f32_16x16x32_bf16 v[128:131], a[232:235], v[14:17], 0
    ds_read_b64_tr_b16 a[224:225], v2 offset:2048
    v_mov_b32 v50, 0
    v_mfma_f32_16x16x32_bf16 v[176:179], a[232:235], v[22:25], 0
    ds_read_b64_tr_b16 a[228:229], v3 offset:2048
    v_fma_f32 v83, v83, s28, v12
    v_mfma_f32_16x16x32_bf16 v[224:227], a[232:235], v[26:29], 0
    v_exp_f32_e64 v59, v59 clamp
    v_mfma_f32_16x16x32_bf16 a[16:19], a[232:235], v[34:37], 0
    ds_read_b64_tr_b16 a[232:233], v4 offset:2048
    v_fma_f32 v75, v75, s28, v11
    v_mfma_f32_16x16x32_bf16 a[20:23], a[236:239], v[34:37], 0
    ds_read_b64_tr_b16 a[234:235], v4 offset:8192
    v_fma_f32 v56, v56, s28, v9
    v_mfma_f32_16x16x32_bf16 v[228:231], a[236:239], v[26:29], 0
    ds_read_b64_tr_b16 a[226:227], v2 offset:8192
    v_mov_b32 v51, 0
    v_mfma_f32_16x16x32_bf16 v[180:183], a[236:239], v[22:25], 0
    ds_read_b64_tr_b16 a[230:231], v3 offset:8192
    v_fma_f32 v76, v76, s28, v12
    v_mfma_f32_16x16x32_bf16 v[132:135], a[236:239], v[14:17], 0
    s_waitcnt lgkmcnt(6)
    ds_read_b64_tr_b16 a[236:237], v5 offset:2048
    v_fma_f32 v80, v80, s28, v12
    v_mfma_f32_16x16x32_bf16 v[136:139], a[216:219], v[14:17], 0
    ds_read_b64_tr_b16 a[238:239], v5 offset:8192
    v_fma_f32 v67, v67, s28, v10
    v_mfma_f32_16x16x32_bf16 v[184:187], a[216:219], v[22:25], 0
    v_exp_f32_e64 v70, v70 clamp
    v_mfma_f32_16x16x32_bf16 v[232:235], a[216:219], v[26:29], 0
    v_exp_f32_e64 v83, v83 clamp
    v_mfma_f32_16x16x32_bf16 a[24:27], a[216:219], v[34:37], 0
    v_exp_f32_e64 v76, v76 clamp
    v_mfma_f32_16x16x32_bf16 a[28:31], a[220:223], v[34:37], 0
    v_exp_f32_e64 v78, v78 clamp
    v_mfma_f32_16x16x32_bf16 v[236:239], a[220:223], v[26:29], 0
    v_fma_f32 v68, v68, s28, v11
    v_fma_f32 v77, v77, s28, v12
    v_mfma_f32_16x16x32_bf16 v[188:191], a[220:223], v[22:25], 0
    v_exp_f32_e64 v58, v58 clamp
    v_mfma_f32_16x16x32_bf16 v[140:143], a[220:223], v[14:17], 0
    s_waitcnt lgkmcnt(3)
    v_exp_f32_e64 v71, v71 clamp
    v_mfma_f32_16x16x32_bf16 v[144:147], a[224:227], v[14:17], 0
    v_exp_f32_e64 v56, v56 clamp
    v_mfma_f32_16x16x32_bf16 v[192:195], a[224:227], v[22:25], 0
    v_exp_f32_e64 v77, v77 clamp
    v_mfma_f32_16x16x32_bf16 v[240:243], a[224:227], v[26:29], 0
    s_waitcnt vmcnt(3) lgkmcnt(0)
    v_exp_f32_e64 v68, v68 clamp
    v_mfma_f32_16x16x32_bf16 a[32:35], a[224:227], v[34:37], 0
    s_barrier
    v_mfma_f32_16x16x32_bf16 a[36:39], a[228:231], v[34:37], 0
    s_add_u32 m0, s22, 24576
    ds_read_b128 a[216:219], v0 offset:0
    v_fma_f32 v65, v65, s28, v10
    v_mfma_f32_16x16x32_bf16 v[244:247], a[228:231], v[26:29], 0
    ds_read_b128 a[224:227], v0 offset:1024
    buffer_load_dwordx4 v6, s[8:11], s21 offen lds
    v_mfma_f32_16x16x32_bf16 v[196:199], a[228:231], v[22:25], 0
    ds_read_b128 a[220:223], v1 offset:0
    v_fma_f32 v69, v69, s28, v11
    v_mfma_f32_16x16x32_bf16 v[148:151], a[228:231], v[14:17], 0
    s_add_u32 s21, s21, 128
    v_exp_f32_e64 v65, v65 clamp
    v_mfma_f32_16x16x32_bf16 v[152:155], a[232:235], v[14:17], 0
    s_add_u32 m0, s22, 25600
    v_exp_f32_e64 v69, v69 clamp
    v_mfma_f32_16x16x32_bf16 v[200:203], a[232:235], v[22:25], 0
    buffer_load_dwordx4 v6, s[8:11], s21 offen lds
    v_mfma_f32_16x16x32_bf16 v[248:251], a[232:235], v[26:29], 0
    s_add_u32 s21, s21, 128
    ds_read_b128 a[228:231], v1 offset:1024
    v_mfma_f32_16x16x32_bf16 a[40:43], a[232:235], v[34:37], 0
    s_add_u32 m0, s22, 26624
    ds_read_b128 a[232:235], v0 offset:2048
    v_cvt_pk_bf16_f32 v31, v70, v71
    v_mfma_f32_16x16x32_bf16 a[44:47], a[236:239], v[34:37], 0
    v_exp_f32_e64 v67, v67 clamp
    v_mfma_f32_16x16x32_bf16 v[252:255], a[236:239], v[26:29], 0
    buffer_load_dwordx4 v6, s[8:11], s21 offen lds
    v_mfma_f32_16x16x32_bf16 v[204:207], a[236:239], v[22:25], 0
    v_fma_f32 v73, v73, s28, v11
    v_cvt_pk_bf16_f32 v35, v78, v79
    v_mfma_f32_16x16x32_bf16 v[156:159], a[236:239], v[14:17], 0
    s_waitcnt lgkmcnt(3)
    v_cvt_pk_bf16_f32 v34, v76, v77
    v_cvt_pk_bf16_f32 v22, v60, v61
    v_mfma_f32_16x16x32_bf16 v[52:55], a[216:219], a[96:99], 0
    s_waitcnt lgkmcnt(2)
    v_exp_f32_e64 v75, v75 clamp
    v_mfma_f32_16x16x32_bf16 v[52:55], a[220:223], a[100:103], v[52:55]
    v_exp_f32_e64 v62, v62 clamp
    v_mfma_f32_16x16x32_bf16 v[52:55], a[224:227], a[104:107], v[52:55]
    s_add_u32 s21, s21, 12032
    v_cvt_pk_bf16_f32 v30, v68, v69
    v_cvt_pk_bf16_f32 v23, v62, v63
    v_mfma_f32_16x16x32_bf16 v[60:63], a[224:227], a[128:131], 0
    ds_read_b128 a[236:239], v1 offset:2048
    v_fma_f32 v64, v64, s28, v10
    v_mfma_f32_16x16x32_bf16 v[60:63], a[220:223], a[124:127], v[60:63]
    v_exp_f32_e64 v74, v74 clamp
    v_mfma_f32_16x16x32_bf16 v[60:63], a[216:219], a[120:123], v[60:63]
    v_exp_f32_e64 v66, v66 clamp
    v_mfma_f32_16x16x32_bf16 v[68:71], a[216:219], a[144:147], 0
    v_exp_f32_e64 v57, v57 clamp
    v_mfma_f32_16x16x32_bf16 v[68:71], a[220:223], a[148:151], v[68:71]
    v_exp_f32_e64 v72, v72 clamp
    v_mfma_f32_16x16x32_bf16 v[68:71], a[224:227], a[152:155], v[68:71]
    s_add_u32 m0, s38, 0
    v_exp_f32_e64 v80, v80 clamp
    v_mfma_f32_16x16x32_bf16 v[76:79], a[224:227], a[176:179], 0
    buffer_load_dwordx4 v6, s[12:15], s33 offen nt lds
    v_mfma_f32_16x16x32_bf16 v[76:79], a[220:223], a[172:175], v[76:79]
    ds_read_b128 a[220:223], v1 offset:6144
    s_add_u32 m0, s38, 1024
    v_mfma_f32_16x16x32_bf16 v[76:79], a[216:219], a[168:171], v[76:79]
    s_waitcnt lgkmcnt(2)
    v_exp_f32_e64 v81, v81 clamp
    v_mfma_f32_16x16x32_bf16 v[76:79], a[228:231], a[180:183], v[76:79]
    buffer_load_dwordx4 v7, s[12:15], s33 offen nt lds
    v_mfma_f32_16x16x32_bf16 v[76:79], a[232:235], a[184:187], v[76:79]
    s_waitcnt lgkmcnt(1)
    ds_read_b128 a[216:219], v0 offset:6144
    v_cvt_pk_bf16_f32 v32, v80, v81
    v_mfma_f32_16x16x32_bf16 v[76:79], a[236:239], a[188:191], v[76:79]
    ds_read_b128 a[224:227], v0 offset:7168
    v_cvt_pk_bf16_f32 v16, v56, v57
    v_mfma_f32_16x16x32_bf16 v[68:71], a[236:239], a[164:167], v[68:71]
    v_exp_f32_e64 v73, v73 clamp
    v_mfma_f32_16x16x32_bf16 v[68:71], a[232:235], a[160:163], v[68:71]
    s_add_u32 s59, s33, 128
    v_exp_f32_e64 v64, v64 clamp
    v_mfma_f32_16x16x32_bf16 v[68:71], a[228:231], a[156:159], v[68:71]
    s_add_u32 m0, s38, 2048
    v_mov_b32 v49, 0
    v_cvt_pk_bf16_f32 v33, v82, v83
    v_mfma_f32_16x16x32_bf16 v[60:63], a[228:231], a[132:135], v[60:63]
    buffer_load_dwordx4 v6, s[12:15], s59 offen nt lds
    v_mfma_f32_16x16x32_bf16 v[60:63], a[232:235], a[136:139], v[60:63]
    v_cvt_pk_bf16_f32 v21, v66, v67
    v_cvt_pk_bf16_f32 v17, v58, v59
    v_mfma_f32_16x16x32_bf16 v[60:63], a[236:239], a[140:143], v[60:63]
    v_cvt_pk_bf16_f32 v29, v74, v75
    v_mfma_f32_16x16x32_bf16 v[52:55], a[236:239], a[116:119], v[52:55]
    ds_read_b128 a[236:239], v1 offset:8192
    v_cvt_pk_bf16_f32 v20, v64, v65
    v_mfma_f32_16x16x32_bf16 v[52:55], a[232:235], a[112:115], v[52:55]
    ds_read_b128 a[232:235], v0 offset:8192
    v_mov_b32 v48, 0
    v_mfma_f32_16x16x32_bf16 v[52:55], a[228:231], a[108:111], v[52:55]
    s_add_u32 m0, s38, 3072
    ds_read_b128 a[228:231], v1 offset:7168
    v_smfmac_f32_16x16x64_bf16 v[48:51], a[240:243], v[16:23], v101
    s_waitcnt lgkmcnt(3)
    v_cvt_pk_bf16_f32 v28, v72, v73
    v_mfma_f32_16x16x32_bf16 v[56:59], a[216:219], a[96:99], 0
    buffer_load_dwordx4 v7, s[12:15], s59 offen nt lds
    v_smfmac_f32_16x16x64_bf16 v[48:51], a[244:247], v[28:35], v101
    s_add_u32 s58, s33, 256
    s_add_u32 m0, s38, 4096
    v_add_u32 v103, 6144, v103
    v_mfma_f32_16x16x32_bf16 v[56:59], a[220:223], a[100:103], v[56:59]
    buffer_load_dwordx4 v6, s[12:15], s58 offen nt lds
    v_mfma_f32_16x16x32_bf16 v[56:59], a[224:227], a[104:107], v[56:59]
    s_nop 1
    v_cmp_lt_f32 vcc, s29, v48
    v_mfma_f32_16x16x32_bf16 v[64:67], a[224:227], a[128:131], 0
    s_add_u32 m0, s38, 5120
    v_mfma_f32_16x16x32_bf16 v[64:67], a[220:223], a[124:127], v[64:67]
    buffer_load_dwordx4 v7, s[12:15], s58 offen nt lds
    v_mfma_f32_16x16x32_bf16 v[64:67], a[216:219], a[120:123], v[64:67]
    s_cbranch_vccnz L_rs_start4b
L_ret_start4b:
    v_fma_f32 v52, v52, s28, v9
    v_mfma_f32_16x16x32_bf16 v[72:75], a[216:219], a[144:147], 0
    v_fma_f32 v55, v55, s28, v9
    s_waitcnt vmcnt(15) lgkmcnt(0)
    v_mfma_f32_16x16x32_bf16 v[72:75], a[220:223], a[148:151], v[72:75]
    s_barrier
    v_mfma_f32_16x16x32_bf16 v[72:75], a[224:227], a[152:155], v[72:75]
    s_add_u32 m0, s22, 0
    v_fma_f32 v60, v60, s28, v10
    v_fma_f32 v61, v61, s28, v10
    v_mfma_f32_16x16x32_bf16 v[80:83], a[224:227], a[176:179], 0
    buffer_load_dwordx4 v6, s[4:7], s20 offen lds
    v_mfma_f32_16x16x32_bf16 v[80:83], a[220:223], a[172:175], v[80:83]
    v_exp_f32_e64 v52, v52 clamp
    v_mfma_f32_16x16x32_bf16 v[80:83], a[216:219], a[168:171], v[80:83]
    s_add_u32 s20, s20, 128
    ds_read_b64_tr_b16 a[216:217], v2 offset:18432
    v_mfma_f32_16x16x32_bf16 v[80:83], a[228:231], a[180:183], v[80:83]
    s_add_u32 m0, s22, 1024
    ds_read_b64_tr_b16 a[218:219], v2 offset:12288
    v_fma_f32 v53, v53, s28, v9
    v_mfma_f32_16x16x32_bf16 v[80:83], a[232:235], a[184:187], v[80:83]
    v_exp_f32_e64 v53, v53 clamp
    v_mfma_f32_16x16x32_bf16 v[80:83], a[236:239], a[188:191], v[80:83]
    buffer_load_dwordx4 v6, s[4:7], s20 offen lds
    v_mfma_f32_16x16x32_bf16 v[72:75], a[236:239], a[164:167], v[72:75]
    v_exp_f32_e64 v60, v60 clamp
    v_mfma_f32_16x16x32_bf16 v[72:75], a[232:235], a[160:163], v[72:75]
    s_add_u32 s20, s20, 128
    ds_read_b64_tr_b16 a[220:221], v3 offset:18432
    v_fma_f32 v54, v54, s28, v9
    v_mfma_f32_16x16x32_bf16 v[72:75], a[228:231], a[156:159], v[72:75]
    s_add_u32 m0, s22, 2048
    ds_read_b64_tr_b16 a[222:223], v3 offset:12288
    v_cvt_pk_bf16_f32 v14, v52, v53
    v_mfma_f32_16x16x32_bf16 v[64:67], a[228:231], a[132:135], v[64:67]
    buffer_load_dwordx4 v6, s[4:7], s20 offen lds
    v_mfma_f32_16x16x32_bf16 v[64:67], a[232:235], a[136:139], v[64:67]
    v_exp_f32_e64 v61, v61 clamp
    v_mfma_f32_16x16x32_bf16 v[64:67], a[236:239], a[140:143], v[64:67]
    ds_read_b64_tr_b16 a[224:225], v4 offset:18432
    v_exp_f32_e64 v55, v55 clamp
    v_mfma_f32_16x16x32_bf16 v[56:59], a[236:239], a[116:119], v[56:59]
    v_exp_f32_e64 v54, v54 clamp
    v_mfma_f32_16x16x32_bf16 v[56:59], a[232:235], a[112:115], v[56:59]
    s_add_u32 s20, s20, 12032
    ds_read_b64_tr_b16 a[226:227], v4 offset:12288
    v_cvt_pk_bf16_f32 v15, v54, v55
    v_mfma_f32_16x16x32_bf16 v[56:59], a[228:231], a[108:111], v[56:59]
    s_waitcnt lgkmcnt(4)
    ds_read_b64_tr_b16 a[228:229], v5 offset:18432
    ds_read_b64_tr_b16 a[230:231], v5 offset:12288
    s_branch L_loop4w0
    .p2align 6
L_loop5w0:
    v_mfma_f32_16x16x32_bf16 v[112:115], a[216:219], v[16:19], v[112:115]
    s_add_u32 s39, s39, 12288
    ds_read_b128 v[96:99], v103 offset:0
    v_fma_f32 v68, v68, s28, v11
    v_mfma_f32_16x16x32_bf16 v[116:119], a[220:223], v[16:19], v[116:119]
    v_fma_f32 v75, v75, s28, v11
    v_mfma_f32_16x16x32_bf16 v[164:167], a[220:223], v[20:23], v[164:167]
    ds_read_b64_tr_b16 a[236:237], v3 offset:19456
    ds_read_b64_tr_b16 a[238:239], v3 offset:13312
    v_mfma_f32_16x16x32_bf16 v[160:163], a[216:219], v[20:23], v[160:163]
    v_fma_f32 v90, v90, s28, v13
    v_mfma_f32_16x16x32_bf16 v[208:211], a[216:219], v[28:31], v[208:211]
    v_fma_f32 v59, v59, s28, v9
    v_mfma_f32_16x16x32_bf16 v[212:215], a[220:223], v[28:31], v[212:215]
    ds_read_b64_tr_b16 a[232:233], v2 offset:19456
    ds_read_b64_tr_b16 a[234:235], v2 offset:13312
    v_mfma_f32_16x16x32_bf16 a[4:7], a[220:223], v[32:35], a[4:7]
    v_fma_f32 v85, v85, s28, v13
    v_fma_f32 v67, v67, s28, v10
    v_mfma_f32_16x16x32_bf16 a[0:3], a[216:219], v[32:35], a[0:3]
    v_fma_f32 v76, v76, s28, v12
    v_mfma_f32_16x16x32_bf16 a[48:51], a[216:219], v[40:43], a[48:51]
    ds_read_b64_tr_b16 a[218:219], v4 offset:13312
    v_fma_f32 v71, v71, s28, v11
    v_fma_f32 v74, v74, s28, v11
    v_mfma_f32_16x16x32_bf16 a[52:55], a[220:223], v[40:43], a[52:55]
    s_add_u32 m0, s23, 0
    v_fma_f32 v73, v73, s28, v11
    s_waitcnt lgkmcnt(5)
    v_mfma_f32_16x16x32_bf16 a[56:59], a[224:227], v[40:43], a[56:59]
    buffer_store_dwordx4 v[96:99], v6, s[16:19], s24 offen offset:0 nt
    v_fma_f32 v87, v87, s28, v13
    v_fma_f32 v70, v70, s28, v11
    v_fma_f32 v78, v78, s28, v12
    v_mfma_f32_16x16x32_bf16 a[60:63], a[228:231], v[40:43], a[60:63]
    v_fma_f32 v77, v77, s28, v12
    v_fma_f32 v66, v66, s28, v10
    v_mfma_f32_16x16x32_bf16 a[12:15], a[228:231], v[32:35], a[12:15]
    ds_read_b64_tr_b16 a[222:223], v5 offset:13312
    v_fma_f32 v65, v65, s28, v10
    v_mfma_f32_16x16x32_bf16 a[8:11], a[224:227], v[32:35], a[8:11]
    v_fma_f32 v81, v81, s28, v12
    v_mfma_f32_16x16x32_bf16 v[216:219], a[224:227], v[28:31], v[216:219]
    ds_read_b64_tr_b16 a[216:217], v4 offset:19456
    ds_read_b64_tr_b16 a[220:221], v5 offset:19456
    v_mfma_f32_16x16x32_bf16 v[220:223], a[228:231], v[28:31], v[220:223]
    v_fma_f32 v64, v64, s28, v10
    v_mfma_f32_16x16x32_bf16 v[172:175], a[228:231], v[20:23], v[172:175]
    v_exp_f32_e64 v67, v67 clamp
    v_mfma_f32_16x16x32_bf16 v[168:171], a[224:227], v[20:23], v[168:171]
    v_fma_f32 v69, v69, s28, v11
    v_mfma_f32_16x16x32_bf16 v[120:123], a[224:227], v[16:19], v[120:123]
    buffer_load_dwordx4 v6, s[12:15], s25 offen nt lds
    v_mfma_f32_16x16x32_bf16 v[124:127], a[228:231], v[16:19], v[124:127]
    s_waitcnt lgkmcnt(3)
    v_fma_f32 v86, v86, s28, v13
    v_mfma_f32_16x16x32_bf16 v[128:131], a[232:235], v[16:19], v[128:131]
    v_mfma_f32_16x16x32_bf16 v[132:135], a[236:239], v[16:19], v[132:135]
    v_exp_f32_e64 v76, v76 clamp
    v_mfma_f32_16x16x32_bf16 v[180:183], a[236:239], v[20:23], v[180:183]
    v_fma_f32 v84, v84, s28, v13
    v_mfma_f32_16x16x32_bf16 v[176:179], a[232:235], v[20:23], v[176:179]
    v_exp_f32_e64 v85, v85 clamp
    v_mfma_f32_16x16x32_bf16 v[224:227], a[232:235], v[28:31], v[224:227]
    v_exp_f32_e64 v65, v65 clamp
    v_mfma_f32_16x16x32_bf16 v[228:231], a[236:239], v[28:31], v[228:231]
    ds_read_b64_tr_b16 a[228:229], v3 offset:20480
    ds_read_b64_tr_b16 a[226:227], v2 offset:14336
    v_mfma_f32_16x16x32_bf16 a[20:23], a[236:239], v[32:35], a[20:23]
    v_exp_f32_e64 v68, v68 clamp
    v_mfma_f32_16x16x32_bf16 a[16:19], a[232:235], v[32:35], a[16:19]
    ds_read_b64_tr_b16 a[230:231], v3 offset:14336
    ds_read_b64_tr_b16 a[224:225], v2 offset:20480
    v_mfma_f32_16x16x32_bf16 a[64:67], a[232:235], v[40:43], a[64:67]
    v_exp_f32_e64 v70, v70 clamp
    v_mfma_f32_16x16x32_bf16 a[68:71], a[236:239], v[40:43], a[68:71]
    s_waitcnt lgkmcnt(4)
    ds_read_b64_tr_b16 a[232:233], v4 offset:20480
    v_fma_f32 v58, v58, s28, v9
    v_mfma_f32_16x16x32_bf16 a[72:75], a[216:219], v[40:43], a[72:75]
    ds_read_b64_tr_b16 a[236:237], v5 offset:20480
    v_fma_f32 v89, v89, s28, v13
    v_mfma_f32_16x16x32_bf16 a[76:79], a[220:223], v[40:43], a[76:79]
    v_exp_f32_e64 v75, v75 clamp
    v_mfma_f32_16x16x32_bf16 a[28:31], a[220:223], v[32:35], a[28:31]
    v_exp_f32_e64 v87, v87 clamp
    v_mfma_f32_16x16x32_bf16 a[24:27], a[216:219], v[32:35], a[24:27]
    ds_read_b64_tr_b16 a[234:235], v4 offset:14336
    v_fma_f32 v88, v88, s28, v13
    v_mfma_f32_16x16x32_bf16 v[232:235], a[216:219], v[28:31], v[232:235]
    ds_read_b128 v[96:99], v103 offset:1024
    v_fma_f32 v57, v57, s28, v9
    v_mfma_f32_16x16x32_bf16 v[236:239], a[220:223], v[28:31], v[236:239]
    v_fma_f32 v82, v82, s28, v12
    v_fma_f32 v72, v72, s28, v11
    v_mfma_f32_16x16x32_bf16 v[188:191], a[220:223], v[20:23], v[188:191]
    ds_read_b64_tr_b16 a[238:239], v5 offset:14336
    v_fma_f32 v79, v79, s28, v12
    v_mfma_f32_16x16x32_bf16 v[184:187], a[216:219], v[20:23], v[184:187]
    v_exp_f32_e64 v58, v58 clamp
    v_mfma_f32_16x16x32_bf16 v[136:139], a[216:219], v[16:19], v[136:139]
    v_exp_f32_e64 v74, v74 clamp
    v_mfma_f32_16x16x32_bf16 v[140:143], a[220:223], v[16:19], v[140:143]
    s_waitcnt lgkmcnt(4)
    v_exp_f32_e64 v69, v69 clamp
    v_mfma_f32_16x16x32_bf16 v[144:147], a[224:227], v[16:19], v[144:147]
    v_exp_f32_e64 v71, v71 clamp
    v_mfma_f32_16x16x32_bf16 v[148:151], a[228:231], v[16:19], v[148:151]
    v_exp_f32_e64 v78, v78 clamp
    v_mfma_f32_16x16x32_bf16 v[196:199], a[228:231], v[20:23], v[196:199]
    v_exp_f32_e64 v77, v77 clamp
    v_mfma_f32_16x16x32_bf16 v[192:195], a[224:227], v[20:23], v[192:195]
    v_exp_f32_e64 v72, v72 clamp
    v_mfma_f32_16x16x32_bf16 v[240:243], a[224:227], v[28:31], v[240:243]
    v_exp_f32_e64 v64, v64 clamp
    v_mfma_f32_16x16x32_bf16 v[244:247], a[228:231], v[28:31], v[244:247]
    v_exp_f32_e64 v84, v84 clamp
    v_mfma_f32_16x16x32_bf16 a[36:39], a[228:231], v[32:35], a[36:39]
    v_exp_f32_e64 v66, v66 clamp
    v_mfma_f32_16x16x32_bf16 a[32:35], a[224:227], v[32:35], a[32:35]
    v_cvt_pk_bf16_f32 v24, v64, v65
    s_waitcnt vmcnt(12) lgkmcnt(0)
    v_mfma_f32_16x16x32_bf16 a[80:83], a[224:227], v[40:43], a[80:83]
    v_exp_f32_e64 v86, v86 clamp
    v_mfma_f32_16x16x32_bf16 a[84:87], a[228:231], v[40:43], a[84:87]
    s_barrier
    ds_read_b128 a[216:219], v0 offset:12288
    v_mfma_f32_16x16x32_bf16 a[88:91], a[232:235], v[40:43], a[88:91]
    ds_read_b128 a[220:223], v1 offset:12288
    v_mfma_f32_16x16x32_bf16 a[92:95], a[236:239], v[40:43], a[92:95]
    ds_read_b128 a[224:227], v0 offset:13312
    v_mfma_f32_16x16x32_bf16 a[44:47], a[236:239], v[32:35], a[44:47]
    s_add_u32 m0, s22, 36864
    v_exp_f32_e64 v81, v81 clamp
    v_mfma_f32_16x16x32_bf16 a[40:43], a[232:235], v[32:35], a[40:43]
    buffer_load_dwordx4 v6, s[8:11], s21 offen lds
    v_mfma_f32_16x16x32_bf16 v[248:251], a[232:235], v[28:31], v[248:251]
    s_add_u32 s21, s21, 128
    s_add_u32 m0, s22, 37888
    v_mfma_f32_16x16x32_bf16 v[252:255], a[236:239], v[28:31], v[252:255]
    buffer_load_dwordx4 v6, s[8:11], s21 offen lds
    v_mfma_f32_16x16x32_bf16 v[204:207], a[236:239], v[20:23], v[204:207]
    s_add_u32 s21, s21, 128
    v_exp_f32_e64 v79, v79 clamp
    v_mfma_f32_16x16x32_bf16 v[200:203], a[232:235], v[20:23], v[200:203]
    s_add_u32 m0, s22, 38912
    v_fma_f32 v80, v80, s28, v12
    v_cvt_pk_bf16_f32 v22, v60, v61
    v_mfma_f32_16x16x32_bf16 v[152:155], a[232:235], v[16:19], v[152:155]
    buffer_load_dwordx4 v6, s[8:11], s21 offen lds
    v_mfma_f32_16x16x32_bf16 v[156:159], a[236:239], v[16:19], v[156:159]
    s_waitcnt lgkmcnt(2)
    v_exp_f32_e64 v88, v88 clamp
    v_mfma_f32_16x16x32_bf16 v[52:55], a[216:219], a[96:99], 0
    s_waitcnt lgkmcnt(1)
    v_cvt_pk_bf16_f32 v35, v78, v79
    v_mfma_f32_16x16x32_bf16 v[52:55], a[220:223], a[100:103], v[52:55]
    s_waitcnt lgkmcnt(0)
    v_cvt_pk_bf16_f32 v27, v70, v71
    v_cvt_pk_bf16_f32 v23, v62, v63
    v_mfma_f32_16x16x32_bf16 v[52:55], a[224:227], a[104:107], v[52:55]
    v_exp_f32_e64 v89, v89 clamp
    v_mfma_f32_16x16x32_bf16 v[60:63], a[224:227], a[128:131], 0
    v_cvt_pk_bf16_f32 v26, v68, v69
    v_mfma_f32_16x16x32_bf16 v[60:63], a[220:223], a[124:127], v[60:63]
    s_add_u32 s21, s21, 12032
    ds_read_b128 a[228:231], v1 offset:13312
    v_cvt_pk_bf16_f32 v34, v76, v77
    v_mfma_f32_16x16x32_bf16 v[60:63], a[216:219], a[120:123], v[60:63]
    ds_read_b128 a[236:239], v1 offset:14336
    v_fma_f32 v83, v83, s28, v12
    v_mfma_f32_16x16x32_bf16 v[68:71], a[216:219], a[144:147], 0
    buffer_store_dwordx4 v[96:99], v7, s[16:19], s24 offen offset:0 nt
    ds_read_b128 a[232:235], v0 offset:14336
    v_cvt_pk_bf16_f32 v39, v86, v87
    v_fma_f32 v56, v56, s28, v9
    v_mfma_f32_16x16x32_bf16 v[68:71], a[220:223], a[148:151], v[68:71]
    v_cvt_pk_bf16_f32 v38, v84, v85
    v_mfma_f32_16x16x32_bf16 v[68:71], a[224:227], a[152:155], v[68:71]
    v_exp_f32_e64 v56, v56 clamp
    v_mfma_f32_16x16x32_bf16 v[76:79], a[224:227], a[176:179], 0
    v_mfma_f32_16x16x32_bf16 v[76:79], a[220:223], a[172:175], v[76:79]
    v_exp_f32_e64 v80, v80 clamp
    v_mfma_f32_16x16x32_bf16 v[76:79], a[216:219], a[168:171], v[76:79]
    v_exp_f32_e64 v59, v59 clamp
    v_mfma_f32_16x16x32_bf16 v[84:87], a[216:219], a[192:195], 0
    s_add_u32 m0, s23, 1024
    v_exp_f32_e64 v83, v83 clamp
    v_mfma_f32_16x16x32_bf16 v[84:87], a[220:223], a[196:199], v[84:87]
    v_exp_f32_e64 v82, v82 clamp
    v_mfma_f32_16x16x32_bf16 v[84:87], a[224:227], a[200:203], v[84:87]
    s_waitcnt lgkmcnt(1)
    v_exp_f32_e64 v73, v73 clamp
    v_mfma_f32_16x16x32_bf16 v[84:87], a[228:231], a[204:207], v[84:87]
    s_waitcnt lgkmcnt(0)
    v_mfma_f32_16x16x32_bf16 v[84:87], a[232:235], a[208:211], v[84:87]
    v_exp_f32_e64 v57, v57 clamp
    v_mfma_f32_16x16x32_bf16 v[84:87], a[236:239], a[212:215], v[84:87]
    ds_read_b128 a[216:219], v0 offset:18432
    v_cvt_pk_bf16_f32 v36, v80, v81
    v_mfma_f32_16x16x32_bf16 v[76:79], a[236:239], a[188:191], v[76:79]
    buffer_load_dwordx4 v7, s[12:15], s25 offen nt lds
    v_mfma_f32_16x16x32_bf16 v[76:79], a[232:235], a[184:187], v[76:79]
    v_cvt_pk_bf16_f32 v29, v74, v75
    v_cvt_pk_bf16_f32 v16, v56, v57
    v_mfma_f32_16x16x32_bf16 v[76:79], a[228:231], a[180:183], v[76:79]
    ds_read_b128 a[220:223], v1 offset:18432
    v_cvt_pk_bf16_f32 v17, v58, v59
    v_mfma_f32_16x16x32_bf16 v[68:71], a[228:231], a[156:159], v[68:71]
    v_fma_f32 v91, v91, s28, v13
    v_cvt_pk_bf16_f32 v25, v66, v67
    v_mfma_f32_16x16x32_bf16 v[68:71], a[232:235], a[160:163], v[68:71]
    v_mfma_f32_16x16x32_bf16 v[68:71], a[236:239], a[164:167], v[68:71]
    ds_read_b128 a[224:227], v0 offset:19456
    v_mfma_f32_16x16x32_bf16 v[60:63], a[236:239], a[140:143], v[60:63]
    v_exp_f32_e64 v90, v90 clamp
    v_mfma_f32_16x16x32_bf16 v[60:63], a[232:235], a[136:139], v[60:63]
    s_bitcmp1_b32 s27, 0
    v_cvt_pk_bf16_f32 v40, v88, v89
    v_cvt_pk_bf16_f32 v37, v82, v83
    v_mfma_f32_16x16x32_bf16 v[60:63], a[228:231], a[132:135], v[60:63]
    v_mfma_f32_16x16x32_bf16 v[52:55], a[228:231], a[108:111], v[52:55]
    s_cselect_b32 s26, s49, 128
    v_exp_f32_e64 v91, v91 clamp
    v_mfma_f32_16x16x32_bf16 v[44:47], a[248:251], v[14:17], v[44:47]
    ds_read_b128 a[228:231], v1 offset:19456
    v_cvt_pk_bf16_f32 v41, v90, v91
    v_mfma_f32_16x16x32_bf16 v[52:55], a[232:235], a[112:115], v[52:55]
    s_lshr_b32 s27, s27, 1
    v_cvt_pk_bf16_f32 v28, v72, v73
    v_mfma_f32_16x16x32_bf16 v[52:55], a[236:239], a[116:119], v[52:55]
    ds_read_b128 a[236:239], v1 offset:20480
    v_smfmac_f32_16x16x64_bf16 v[44:47], a[240:243], v[22:29], v101
    ds_read_b128 a[232:235], v0 offset:20480
    v_smfmac_f32_16x16x64_bf16 v[44:47], a[244:247], v[34:41], v101
    s_waitcnt lgkmcnt(4)
    v_mfma_f32_16x16x32_bf16 v[56:59], a[216:219], a[96:99], 0
    s_add_u32 s24, s24, s26
    v_mfma_f32_16x16x32_bf16 v[56:59], a[220:223], a[100:103], v[56:59]
    s_waitcnt lgkmcnt(3)
    v_mfma_f32_16x16x32_bf16 v[56:59], a[224:227], a[104:107], v[56:59]
    s_add_u32 s25, s25, s26
    s_nop 0
    v_cmp_lt_f32 vcc, s29, v44
    v_mfma_f32_16x16x32_bf16 v[64:67], a[224:227], a[128:131], 0
    ds_read_b128 v[96:99], v103 offset:2048
    v_mfma_f32_16x16x32_bf16 v[64:67], a[220:223], a[124:127], v[64:67]
    v_mfma_f32_16x16x32_bf16 v[64:67], a[216:219], a[120:123], v[64:67]
    s_nop 0
    s_cbranch_vccnz L_rs_loop5w0a
L_ret_loop5w0a:
    v_mfma_f32_16x16x32_bf16 v[72:75], a[216:219], a[144:147], 0
    v_fma_f32 v63, v63, s28, v10
    v_mfma_f32_16x16x32_bf16 v[72:75], a[220:223], a[148:151], v[72:75]
    v_fma_f32 v62, v62, s28, v10
    v_mfma_f32_16x16x32_bf16 v[72:75], a[224:227], a[152:155], v[72:75]
    s_waitcnt vmcnt(12) lgkmcnt(1)
    s_add_u32 m0, s22, 12288
    v_mfma_f32_16x16x32_bf16 v[80:83], a[224:227], a[176:179], 0
    s_barrier
    v_mfma_f32_16x16x32_bf16 v[80:83], a[220:223], a[172:175], v[80:83]
    buffer_load_dwordx4 v6, s[4:7], s20 offen lds
    v_mfma_f32_16x16x32_bf16 v[80:83], a[216:219], a[168:171], v[80:83]
    s_add_u32 s20, s20, 128
    v_fma_f32 v79, v79, s28, v12
    v_mfma_f32_16x16x32_bf16 v[88:91], a[216:219], a[192:195], 0
    s_add_u32 m0, s22, 13312
    ds_read_b64_tr_b16 a[216:217], v2 offset:0
    v_fma_f32 v52, v52, s28, v9
    v_mfma_f32_16x16x32_bf16 v[88:91], a[220:223], a[196:199], v[88:91]
    buffer_load_dwordx4 v6, s[4:7], s20 offen lds
    v_mfma_f32_16x16x32_bf16 v[88:91], a[224:227], a[200:203], v[88:91]
    s_add_u32 s20, s20, 128
    ds_read_b64_tr_b16 a[218:219], v2 offset:6144
    s_add_u32 m0, s22, 14336
    v_mfma_f32_16x16x32_bf16 v[88:91], a[228:231], a[204:207], v[88:91]
    buffer_load_dwordx4 v6, s[4:7], s20 offen lds
    v_mfma_f32_16x16x32_bf16 v[88:91], a[232:235], a[208:211], v[88:91]
    ds_read_b64_tr_b16 a[220:221], v3 offset:0
    ds_read_b64_tr_b16 a[222:223], v3 offset:6144
    v_mfma_f32_16x16x32_bf16 v[88:91], a[236:239], a[212:215], v[88:91]
    v_fma_f32 v84, v84, s28, v13
    v_mfma_f32_16x16x32_bf16 v[80:83], a[236:239], a[188:191], v[80:83]
    v_exp_f32_e64 v79, v79 clamp
    v_mfma_f32_16x16x32_bf16 v[80:83], a[232:235], a[184:187], v[80:83]
    v_exp_f32_e64 v63, v63 clamp
    v_mfma_f32_16x16x32_bf16 v[80:83], a[228:231], a[180:183], v[80:83]
    v_fma_f32 v86, v86, s28, v13
    v_mfma_f32_16x16x32_bf16 v[72:75], a[228:231], a[156:159], v[72:75]
    ds_read_b64_tr_b16 a[224:225], v4 offset:0
    ds_read_b64_tr_b16 a[226:227], v4 offset:6144
    v_mfma_f32_16x16x32_bf16 v[72:75], a[232:235], a[160:163], v[72:75]
    v_fma_f32 v77, v77, s28, v12
    v_fma_f32 v88, v88, s28, v13
    v_mfma_f32_16x16x32_bf16 v[72:75], a[236:239], a[164:167], v[72:75]
    v_fma_f32 v69, v69, s28, v11
    v_fma_f32 v87, v87, s28, v13
    v_mfma_f32_16x16x32_bf16 v[64:67], a[236:239], a[140:143], v[64:67]
    s_add_u32 s20, s20, 12032
    v_fma_f32 v61, v61, s28, v10
    v_mfma_f32_16x16x32_bf16 v[64:67], a[232:235], a[136:139], v[64:67]
    v_mfma_f32_16x16x32_bf16 v[64:67], a[228:231], a[132:135], v[64:67]
    v_fma_f32 v81, v81, s28, v12
    v_mfma_f32_16x16x32_bf16 v[56:59], a[228:231], a[108:111], v[56:59]
    ds_read_b64_tr_b16 a[228:229], v5 offset:0
    v_mfma_f32_16x16x32_bf16 v[56:59], a[232:235], a[112:115], v[56:59]
    v_fma_f32 v68, v68, s28, v11
    v_fma_f32 v80, v80, s28, v12
    v_mfma_f32_16x16x32_bf16 v[56:59], a[236:239], a[116:119], v[56:59]
    s_waitcnt lgkmcnt(3)
    v_fma_f32 v60, v60, s28, v10
    v_fma_f32 v53, v53, s28, v9
    v_mfma_f32_16x16x32_bf16 v[112:115], a[216:219], v[14:17], v[112:115]
    v_exp_f32_e64 v61, v61 clamp
    v_mfma_f32_16x16x32_bf16 v[116:119], a[220:223], v[14:17], v[116:119]
    ds_read_b64_tr_b16 a[230:231], v5 offset:6144
    v_mfma_f32_16x16x32_bf16 v[164:167], a[220:223], v[22:25], v[164:167]
    v_fma_f32 v74, v74, s28, v11
    v_fma_f32 v72, v72, s28, v11
    v_mfma_f32_16x16x32_bf16 v[160:163], a[216:219], v[22:25], v[160:163]
    v_fma_f32 v54, v54, s28, v9
    v_mfma_f32_16x16x32_bf16 v[208:211], a[216:219], v[26:29], v[208:211]
    v_exp_f32_e64 v69, v69 clamp
    v_mfma_f32_16x16x32_bf16 v[212:215], a[220:223], v[26:29], v[212:215]
    buffer_store_dwordx4 v[96:99], v6, s[16:19], s24 offen offset:0 nt
    ds_read_b64_tr_b16 a[238:239], v3 offset:7168
    v_fma_f32 v59, v59, s28, v9
    v_fma_f32 v71, v71, s28, v11
    v_mfma_f32_16x16x32_bf16 a[4:7], a[220:223], v[34:37], a[4:7]
    ds_read_b64_tr_b16 a[234:235], v2 offset:7168
    v_fma_f32 v78, v78, s28, v12
    v_mfma_f32_16x16x32_bf16 a[0:3], a[216:219], v[34:37], a[0:3]
    v_exp_f32_e64 v53, v53 clamp
    v_mfma_f32_16x16x32_bf16 a[48:51], a[216:219], v[38:41], a[48:51]
    v_fma_f32 v64, v64, s28, v10
    v_fma_f32 v66, v66, s28, v10
    v_mfma_f32_16x16x32_bf16 a[52:55], a[220:223], v[38:41], a[52:55]
    s_waitcnt lgkmcnt(3)
    ds_read_b64_tr_b16 a[236:237], v3 offset:1024
    ds_read_b64_tr_b16 a[232:233], v2 offset:1024
    v_mfma_f32_16x16x32_bf16 a[56:59], a[224:227], v[38:41], a[56:59]
    s_waitcnt lgkmcnt(4)
    v_exp_f32_e64 v71, v71 clamp
    v_mfma_f32_16x16x32_bf16 a[60:63], a[228:231], v[38:41], a[60:63]
    s_add_u32 s39, s39, 12288
    v_exp_f32_e64 v72, v72 clamp
    v_mfma_f32_16x16x32_bf16 a[12:15], a[228:231], v[34:37], a[12:15]
    s_add_u32 m0, s23, 2048
    v_mfma_f32_16x16x32_bf16 a[8:11], a[224:227], v[34:37], a[8:11]
    v_exp_f32_e64 v68, v68 clamp
    v_mfma_f32_16x16x32_bf16 v[216:219], a[224:227], v[26:29], v[216:219]
    v_fma_f32 v82, v82, s28, v12
    v_mfma_f32_16x16x32_bf16 v[220:223], a[228:231], v[26:29], v[220:223]
    ds_read_b64_tr_b16 a[220:221], v5 offset:1024
    ds_read_b64_tr_b16 a[216:217], v4 offset:1024
    v_mfma_f32_16x16x32_bf16 v[172:175], a[228:231], v[22:25], v[172:175]
    buffer_load_dwordx4 v6, s[12:15], s25 offen nt lds
    v_mfma_f32_16x16x32_bf16 v[168:171], a[224:227], v[22:25], v[168:171]
    ds_read_b64_tr_b16 a[218:219], v4 offset:7168
    v_mfma_f32_16x16x32_bf16 v[120:123], a[224:227], v[14:17], v[120:123]
    ds_read_b64_tr_b16 a[222:223], v5 offset:7168
    v_mfma_f32_16x16x32_bf16 v[124:127], a[228:231], v[14:17], v[124:127]
    s_waitcnt lgkmcnt(4)
    ds_read_b64_tr_b16 a[224:225], v2 offset:2048
    v_fma_f32 v76, v76, s28, v12
    v_mfma_f32_16x16x32_bf16 v[128:131], a[232:235], v[14:17], v[128:131]
    v_exp_f32_e64 v87, v87 clamp
    v_mfma_f32_16x16x32_bf16 v[132:135], a[236:239], v[14:17], v[132:135]
    ds_read_b64_tr_b16 a[228:229], v3 offset:2048
    v_fma_f32 v56, v56, s28, v9
    v_mfma_f32_16x16x32_bf16 v[180:183], a[236:239], v[22:25], v[180:183]
    ds_read_b128 v[96:99], v103 offset:3072
    ds_read_b64_tr_b16 a[230:231], v3 offset:8192
    v_mfma_f32_16x16x32_bf16 v[176:179], a[232:235], v[22:25], v[176:179]
    v_fma_f32 v55, v55, s28, v9
    v_fma_f32 v57, v57, s28, v9
    v_mfma_f32_16x16x32_bf16 v[224:227], a[232:235], v[26:29], v[224:227]
    v_fma_f32 v89, v89, s28, v13
    v_mfma_f32_16x16x32_bf16 v[228:231], a[236:239], v[26:29], v[228:231]
    v_exp_f32_e64 v82, v82 clamp
    v_mfma_f32_16x16x32_bf16 a[20:23], a[236:239], v[34:37], a[20:23]
    v_exp_f32_e64 v76, v76 clamp
    v_mfma_f32_16x16x32_bf16 a[16:19], a[232:235], v[34:37], a[16:19]
    v_exp_f32_e64 v57, v57 clamp
    v_mfma_f32_16x16x32_bf16 a[64:67], a[232:235], v[38:41], a[64:67]
    ds_read_b64_tr_b16 a[226:227], v2 offset:8192
    v_mfma_f32_16x16x32_bf16 a[68:71], a[236:239], v[38:41], a[68:71]
    s_waitcnt lgkmcnt(4)
    ds_read_b64_tr_b16 a[236:237], v5 offset:2048
    v_fma_f32 v91, v91, s28, v13
    v_mfma_f32_16x16x32_bf16 a[72:75], a[216:219], v[38:41], a[72:75]
    v_exp_f32_e64 v59, v59 clamp
    v_mfma_f32_16x16x32_bf16 a[76:79], a[220:223], v[38:41], a[76:79]
    ds_read_b64_tr_b16 a[232:233], v4 offset:2048
    ds_read_b64_tr_b16 a[238:239], v5 offset:8192
    v_mfma_f32_16x16x32_bf16 a[28:31], a[220:223], v[34:37], a[28:31]
    v_fma_f32 v83, v83, s28, v12
    v_fma_f32 v70, v70, s28, v11
    v_mfma_f32_16x16x32_bf16 a[24:27], a[216:219], v[34:37], a[24:27]
    v_exp_f32_e64 v70, v70 clamp
    v_mfma_f32_16x16x32_bf16 v[232:235], a[216:219], v[26:29], v[232:235]
    v_exp_f32_e64 v55, v55 clamp
    v_mfma_f32_16x16x32_bf16 v[236:239], a[220:223], v[26:29], v[236:239]
    v_exp_f32_e64 v52, v52 clamp
    v_mfma_f32_16x16x32_bf16 v[188:191], a[220:223], v[22:25], v[188:191]
    ds_read_b64_tr_b16 a[234:235], v4 offset:8192
    v_fma_f32 v73, v73, s28, v11
    v_mfma_f32_16x16x32_bf16 v[184:187], a[216:219], v[22:25], v[184:187]
    v_exp_f32_e64 v64, v64 clamp
    v_mfma_f32_16x16x32_bf16 v[136:139], a[216:219], v[14:17], v[136:139]
    v_exp_f32_e64 v60, v60 clamp
    v_mfma_f32_16x16x32_bf16 v[140:143], a[220:223], v[14:17], v[140:143]
    s_waitcnt lgkmcnt(3)
    v_exp_f32_e64 v62, v62 clamp
    v_mfma_f32_16x16x32_bf16 v[144:147], a[224:227], v[14:17], v[144:147]
    v_exp_f32_e64 v84, v84 clamp
    v_mfma_f32_16x16x32_bf16 v[148:151], a[228:231], v[14:17], v[148:151]
    v_fma_f32 v65, v65, s28, v10
    v_cvt_pk_bf16_f32 v30, v68, v69
    v_mfma_f32_16x16x32_bf16 v[196:199], a[228:231], v[22:25], v[196:199]
    v_exp_f32_e64 v78, v78 clamp
    v_mfma_f32_16x16x32_bf16 v[192:195], a[224:227], v[22:25], v[192:195]
    v_fma_f32 v58, v58, s28, v9
    v_fma_f32 v67, v67, s28, v10
    v_mfma_f32_16x16x32_bf16 v[240:243], a[224:227], v[26:29], v[240:243]
    v_exp_f32_e64 v77, v77 clamp
    v_mfma_f32_16x16x32_bf16 v[244:247], a[228:231], v[26:29], v[244:247]
    v_exp_f32_e64 v54, v54 clamp
    v_mfma_f32_16x16x32_bf16 a[36:39], a[228:231], v[34:37], a[36:39]
    v_cvt_pk_bf16_f32 v18, v52, v53
    v_fma_f32 v85, v85, s28, v13
    v_mfma_f32_16x16x32_bf16 a[32:35], a[224:227], v[34:37], a[32:35]
    s_waitcnt vmcnt(12) lgkmcnt(0)
    v_exp_f32_e64 v58, v58 clamp
    v_mfma_f32_16x16x32_bf16 a[80:83], a[224:227], v[38:41], a[80:83]
    s_add_u32 m0, s22, 24576
    v_cvt_pk_bf16_f32 v31, v70, v71
    v_fma_f32 v75, v75, s28, v11
    v_mfma_f32_16x16x32_bf16 a[84:87], a[228:231], v[38:41], a[84:87]
    s_barrier
    ds_read_b128 a[216:219], v0 offset:0
    v_mfma_f32_16x16x32_bf16 a[88:91], a[232:235], v[38:41], a[88:91]
    buffer_load_dwordx4 v6, s[8:11], s21 offen lds
    ds_read_b128 a[220:223], v1 offset:0
    v_mfma_f32_16x16x32_bf16 a[92:95], a[236:239], v[38:41], a[92:95]
    s_add_u32 s21, s21, 128
    ds_read_b128 a[224:227], v0 offset:1024
    s_add_u32 m0, s22, 25600
    v_mfma_f32_16x16x32_bf16 a[44:47], a[236:239], v[34:37], a[44:47]
    buffer_load_dwordx4 v6, s[8:11], s21 offen lds
    v_mfma_f32_16x16x32_bf16 a[40:43], a[232:235], v[34:37], a[40:43]
    s_add_u32 s21, s21, 128
    v_exp_f32_e64 v91, v91 clamp
    v_mfma_f32_16x16x32_bf16 v[248:251], a[232:235], v[26:29], v[248:251]
    s_add_u32 m0, s22, 26624
    v_add_u32 v103, 4096, v103
    v_cvt_pk_bf16_f32 v35, v78, v79
    v_mfma_f32_16x16x32_bf16 v[252:255], a[236:239], v[26:29], v[252:255]
    v_exp_f32_e64 v86, v86 clamp
    v_mfma_f32_16x16x32_bf16 v[204:207], a[236:239], v[22:25], v[204:207]
    buffer_load_dwordx4 v6, s[8:11], s21 offen lds
    v_mfma_f32_16x16x32_bf16 v[200:203], a[232:235], v[22:25], v[200:203]
    v_cvt_pk_bf16_f32 v22, v60, v61
    v_cvt_pk_bf16_f32 v19, v54, v55
    v_mfma_f32_16x16x32_bf16 v[152:155], a[232:235], v[14:17], v[152:155]
    ds_read_b128 a[228:231], v1 offset:1024
    v_cvt_pk_bf16_f32 v43, v86, v87
    v_mfma_f32_16x16x32_bf16 v[156:159], a[236:239], v[14:17], v[156:159]
    s_waitcnt lgkmcnt(3)
    ds_read_b128 a[232:235], v0 offset:2048
    v_cvt_pk_bf16_f32 v23, v62, v63
    v_mfma_f32_16x16x32_bf16 v[52:55], a[216:219], a[96:99], 0
    s_waitcnt lgkmcnt(3)
    v_exp_f32_e64 v85, v85 clamp
    v_mfma_f32_16x16x32_bf16 v[52:55], a[220:223], a[100:103], v[52:55]
    s_waitcnt lgkmcnt(2)
    v_exp_f32_e64 v83, v83 clamp
    v_mfma_f32_16x16x32_bf16 v[52:55], a[224:227], a[104:107], v[52:55]
    v_exp_f32_e64 v67, v67 clamp
    v_mfma_f32_16x16x32_bf16 v[60:63], a[224:227], a[128:131], 0
    v_exp_f32_e64 v74, v74 clamp
    v_mfma_f32_16x16x32_bf16 v[60:63], a[220:223], a[124:127], v[60:63]
    v_cvt_pk_bf16_f32 v34, v76, v77
    v_fma_f32 v90, v90, s28, v13
    v_mfma_f32_16x16x32_bf16 v[60:63], a[216:219], a[120:123], v[60:63]
    ds_read_b128 a[236:239], v1 offset:2048
    v_mfma_f32_16x16x32_bf16 v[68:71], a[216:219], a[144:147], 0
    v_cvt_pk_bf16_f32 v42, v84, v85
    s_add_u32 s21, s21, 12032
    v_mfma_f32_16x16x32_bf16 v[68:71], a[220:223], a[148:151], v[68:71]
    v_exp_f32_e64 v81, v81 clamp
    v_mfma_f32_16x16x32_bf16 v[68:71], a[224:227], a[152:155], v[68:71]
    buffer_store_dwordx4 v[96:99], v7, s[16:19], s24 offen offset:0 nt
    v_mfma_f32_16x16x32_bf16 v[76:79], a[224:227], a[176:179], 0
    v_exp_f32_e64 v56, v56 clamp
    v_mfma_f32_16x16x32_bf16 v[76:79], a[220:223], a[172:175], v[76:79]
    v_exp_f32_e64 v65, v65 clamp
    v_mfma_f32_16x16x32_bf16 v[76:79], a[216:219], a[168:171], v[76:79]
    v_cvt_pk_bf16_f32 v17, v58, v59
    v_cvt_pk_bf16_f32 v16, v56, v57
    v_mfma_f32_16x16x32_bf16 v[84:87], a[216:219], a[192:195], 0
    s_add_u32 m0, s23, 3072
    v_exp_f32_e64 v73, v73 clamp
    v_mfma_f32_16x16x32_bf16 v[84:87], a[220:223], a[196:199], v[84:87]
    v_exp_f32_e64 v90, v90 clamp
    v_mfma_f32_16x16x32_bf16 v[84:87], a[224:227], a[200:203], v[84:87]
    s_waitcnt lgkmcnt(0)
    v_cvt_pk_bf16_f32 v41, v90, v91
    v_mfma_f32_16x16x32_bf16 v[84:87], a[228:231], a[204:207], v[84:87]
    ds_read_b128 a[216:219], v0 offset:6144
    v_mfma_f32_16x16x32_bf16 v[84:87], a[232:235], a[208:211], v[84:87]
    v_exp_f32_e64 v66, v66 clamp
    v_mfma_f32_16x16x32_bf16 v[84:87], a[236:239], a[212:215], v[84:87]
    v_exp_f32_e64 v75, v75 clamp
    v_mfma_f32_16x16x32_bf16 v[76:79], a[236:239], a[188:191], v[76:79]
    buffer_load_dwordx4 v7, s[12:15], s25 offen nt lds
    v_mfma_f32_16x16x32_bf16 v[76:79], a[232:235], a[184:187], v[76:79]
    v_cvt_pk_bf16_f32 v28, v72, v73
    v_mfma_f32_16x16x32_bf16 v[76:79], a[228:231], a[180:183], v[76:79]
    v_exp_f32_e64 v80, v80 clamp
    v_mfma_f32_16x16x32_bf16 v[68:71], a[228:231], a[156:159], v[68:71]
    s_bitcmp1_b32 s27, 0
    ds_read_b128 a[224:227], v0 offset:7168
    v_cvt_pk_bf16_f32 v21, v66, v67
    v_mfma_f32_16x16x32_bf16 v[68:71], a[232:235], a[160:163], v[68:71]
    v_mfma_f32_16x16x32_bf16 v[68:71], a[236:239], a[164:167], v[68:71]
    ds_read_b128 a[220:223], v1 offset:6144
    v_cvt_pk_bf16_f32 v33, v82, v83
    v_mfma_f32_16x16x32_bf16 v[60:63], a[236:239], a[140:143], v[60:63]
    v_exp_f32_e64 v88, v88 clamp
    v_mfma_f32_16x16x32_bf16 v[60:63], a[232:235], a[136:139], v[60:63]
    v_cvt_pk_bf16_f32 v20, v64, v65
    v_cvt_pk_bf16_f32 v32, v80, v81
    v_mfma_f32_16x16x32_bf16 v[60:63], a[228:231], a[132:135], v[60:63]
    v_exp_f32_e64 v89, v89 clamp
    v_mfma_f32_16x16x32_bf16 v[52:55], a[228:231], a[108:111], v[52:55]
    v_cvt_pk_bf16_f32 v29, v74, v75
    v_mfma_f32_16x16x32_bf16 v[52:55], a[232:235], a[112:115], v[52:55]
    ds_read_b128 a[232:235], v0 offset:8192
    v_cvt_pk_bf16_f32 v40, v88, v89
    v_smfmac_f32_16x16x64_bf16 v[48:51], a[240:243], v[16:23], v101
    ds_read_b128 a[228:231], v1 offset:7168
    v_mfma_f32_16x16x32_bf16 v[52:55], a[236:239], a[116:119], v[52:55]
    ds_read_b128 a[236:239], v1 offset:8192
    v_smfmac_f32_16x16x64_bf16 v[48:51], a[244:247], v[28:35], v101
    v_mfma_f32_16x16x32_bf16 v[48:51], a[248:251], v[40:43], v[48:51]
    s_waitcnt lgkmcnt(4)
    v_mfma_f32_16x16x32_bf16 v[56:59], a[216:219], a[96:99], 0
    s_cselect_b32 s26, s49, 128
    s_lshr_b32 s27, s27, 1
    s_waitcnt lgkmcnt(3)
    v_mfma_f32_16x16x32_bf16 v[56:59], a[220:223], a[100:103], v[56:59]
    s_nop 1
    v_cmp_lt_f32 vcc, s29, v48
    v_mfma_f32_16x16x32_bf16 v[56:59], a[224:227], a[104:107], v[56:59]
    s_add_u32 s24, s24, s26
    s_add_u32 s25, s25, s26
    s_add_u32 s23, s23, 4096
    v_mfma_f32_16x16x32_bf16 v[64:67], a[224:227], a[128:131], 0
    s_cbranch_vccnz L_rs_loop5w0b
L_ret_loop5w0b:
    v_fma_f32 v55, v55, s28, v9
    v_mfma_f32_16x16x32_bf16 v[64:67], a[220:223], a[124:127], v[64:67]
    v_fma_f32 v63, v63, s28, v10
    v_fma_f32 v62, v62, s28, v10
    v_mfma_f32_16x16x32_bf16 v[64:67], a[216:219], a[120:123], v[64:67]
    v_fma_f32 v53, v53, s28, v9
    v_mfma_f32_16x16x32_bf16 v[72:75], a[216:219], a[144:147], 0
    v_exp_f32_e64 v63, v63 clamp
    v_mfma_f32_16x16x32_bf16 v[72:75], a[220:223], a[148:151], v[72:75]
    s_waitcnt vmcnt(12) lgkmcnt(0)
    s_cmp_eq_u32 s30, 5
    v_fma_f32 v54, v54, s28, v9
    v_mfma_f32_16x16x32_bf16 v[72:75], a[224:227], a[152:155], v[72:75]
    s_cselect_b32 s26, s62, 0
    s_add_u32 s20, s20, s26
    s_add_u32 m0, s22, 0
    v_mfma_f32_16x16x32_bf16 v[80:83], a[224:227], a[176:179], 0
    s_barrier
    v_mfma_f32_16x16x32_bf16 v[80:83], a[220:223], a[172:175], v[80:83]
    buffer_load_dwordx4 v6, s[4:7], s20 offen lds
    v_mfma_f32_16x16x32_bf16 v[80:83], a[216:219], a[168:171], v[80:83]
    v_fma_f32 v60, v60, s28, v10
    v_mfma_f32_16x16x32_bf16 v[88:91], a[216:219], a[192:195], 0
    s_add_u32 s20, s20, 128
    s_add_u32 m0, s22, 1024
    v_fma_f32 v61, v61, s28, v10
    v_mfma_f32_16x16x32_bf16 v[88:91], a[220:223], a[196:199], v[88:91]
    buffer_load_dwordx4 v6, s[4:7], s20 offen lds
    v_mfma_f32_16x16x32_bf16 v[88:91], a[224:227], a[200:203], v[88:91]
    s_add_u32 s20, s20, 128
    ds_read_b64_tr_b16 a[216:217], v2 offset:18432
    s_add_u32 m0, s22, 2048
    v_mfma_f32_16x16x32_bf16 v[88:91], a[228:231], a[204:207], v[88:91]
    buffer_load_dwordx4 v6, s[4:7], s20 offen lds
    v_mfma_f32_16x16x32_bf16 v[88:91], a[232:235], a[208:211], v[88:91]
    v_exp_f32_e64 v53, v53 clamp
    v_mfma_f32_16x16x32_bf16 v[88:91], a[236:239], a[212:215], v[88:91]
    s_add_u32 s20, s20, 12032
    ds_read_b64_tr_b16 a[218:219], v2 offset:12288
    ds_read_b64_tr_b16 a[220:221], v3 offset:18432
    v_mfma_f32_16x16x32_bf16 v[80:83], a[236:239], a[188:191], v[80:83]
    ds_read_b64_tr_b16 a[222:223], v3 offset:12288
    v_mfma_f32_16x16x32_bf16 v[80:83], a[232:235], a[184:187], v[80:83]
    v_exp_f32_e64 v60, v60 clamp
    v_mfma_f32_16x16x32_bf16 v[80:83], a[228:231], a[180:183], v[80:83]
    v_exp_f32_e64 v55, v55 clamp
    v_mfma_f32_16x16x32_bf16 v[72:75], a[228:231], a[156:159], v[72:75]
    v_exp_f32_e64 v54, v54 clamp
    v_mfma_f32_16x16x32_bf16 v[72:75], a[232:235], a[160:163], v[72:75]
    s_add_u32 s30, s30, 1
    ds_read_b64_tr_b16 a[224:225], v4 offset:18432
    v_fma_f32 v52, v52, s28, v9
    v_mfma_f32_16x16x32_bf16 v[72:75], a[236:239], a[164:167], v[72:75]
    v_exp_f32_e64 v62, v62 clamp
    v_mfma_f32_16x16x32_bf16 v[64:67], a[236:239], a[140:143], v[64:67]
    v_exp_f32_e64 v52, v52 clamp
    v_mfma_f32_16x16x32_bf16 v[64:67], a[232:235], a[136:139], v[64:67]
    s_cmp_lt_u32 s30, 6
    v_cvt_pk_bf16_f32 v14, v52, v53
    v_cvt_pk_bf16_f32 v15, v54, v55
    v_mfma_f32_16x16x32_bf16 v[64:67], a[228:231], a[132:135], v[64:67]
    v_exp_f32_e64 v61, v61 clamp
    v_mfma_f32_16x16x32_bf16 v[56:59], a[228:231], a[108:111], v[56:59]
    ds_read_b64_tr_b16 a[226:227], v4 offset:12288
    ds_read_b64_tr_b16 a[228:229], v5 offset:18432
    v_mfma_f32_16x16x32_bf16 v[56:59], a[232:235], a[112:115], v[56:59]
    ds_read_b64_tr_b16 a[230:231], v5 offset:12288
    s_waitcnt lgkmcnt(4)
    v_mfma_f32_16x16x32_bf16 v[56:59], a[236:239], a[116:119], v[56:59]
    s_cbranch_scc1 L_loop5w0
    s_cmp_ge_u32 s37, 6
    s_cbranch_scc1 L_end5
    s_cmp_eq_u32 s32, 0
    s_cbranch_scc1 L_tr54
    s_branch L_tr55
    .p2align 6
L_loop5w1:
    v_mfma_f32_16x16x32_bf16 v[112:115], a[216:219], v[16:19], v[112:115]
    s_add_u32 s39, s39, 12288
    ds_read_b128 v[96:99], v103 offset:0
    v_mfma_f32_16x16x32_bf16 v[116:119], a[220:223], v[16:19], v[116:119]
    v_fma_f32 v79, v79, s28, v12
    v_fma_f32 v77, v77, s28, v12
    v_mfma_f32_16x16x32_bf16 v[164:167], a[220:223], v[20:23], v[164:167]
    ds_read_b64_tr_b16 a[236:237], v3 offset:19456
    v_fma_f32 v67, v67, s28, v10
    v_mfma_f32_16x16x32_bf16 v[160:163], a[216:219], v[20:23], v[160:163]
    v_fma_f32 v70, v70, s28, v11
    v_fma_f32 v72, v72, s28, v11
    v_mfma_f32_16x16x32_bf16 v[208:211], a[216:219], v[28:31], v[208:211]
    v_fma_f32 v64, v64, s28, v10
    v_fma_f32 v88, v88, s28, v13
    v_mfma_f32_16x16x32_bf16 v[212:215], a[220:223], v[28:31], v[212:215]
    ds_read_b64_tr_b16 a[238:239], v3 offset:13312
    ds_read_b64_tr_b16 a[234:235], v2 offset:13312
    v_mfma_f32_16x16x32_bf16 a[4:7], a[220:223], v[32:35], a[4:7]
    v_fma_f32 v84, v84, s28, v13
    v_fma_f32 v68, v68, s28, v11
    v_mfma_f32_16x16x32_bf16 a[0:3], a[216:219], v[32:35], a[0:3]
    v_fma_f32 v85, v85, s28, v13
    v_mfma_f32_16x16x32_bf16 a[48:51], a[216:219], v[40:43], a[48:51]
    ds_read_b64_tr_b16 a[216:217], v4 offset:19456
    ds_read_b64_tr_b16 a[232:233], v2 offset:19456
    v_mfma_f32_16x16x32_bf16 a[52:55], a[220:223], v[40:43], a[52:55]
    s_waitcnt lgkmcnt(6)
    v_exp_f32_e64 v85, v85 clamp
    v_mfma_f32_16x16x32_bf16 a[56:59], a[224:227], v[40:43], a[56:59]
    s_waitcnt lgkmcnt(5)
    buffer_store_dwordx4 v[96:99], v6, s[16:19], s24 offen offset:0 nt
    v_fma_f32 v87, v87, s28, v13
    v_fma_f32 v81, v81, s28, v12
    v_mfma_f32_16x16x32_bf16 a[60:63], a[228:231], v[40:43], a[60:63]
    s_add_u32 m0, s23, 0
    v_fma_f32 v71, v71, s28, v11
    v_mfma_f32_16x16x32_bf16 a[12:15], a[228:231], v[32:35], a[12:15]
    v_fma_f32 v65, v65, s28, v10
    v_fma_f32 v86, v86, s28, v13
    v_mfma_f32_16x16x32_bf16 a[8:11], a[224:227], v[32:35], a[8:11]
    v_fma_f32 v73, v73, s28, v11
    v_fma_f32 v80, v80, s28, v12
    v_mfma_f32_16x16x32_bf16 v[216:219], a[224:227], v[28:31], v[216:219]
    ds_read_b64_tr_b16 a[218:219], v4 offset:13312
    v_fma_f32 v75, v75, s28, v11
    v_mfma_f32_16x16x32_bf16 v[220:223], a[228:231], v[28:31], v[220:223]
    v_exp_f32_e64 v71, v71 clamp
    v_mfma_f32_16x16x32_bf16 v[172:175], a[228:231], v[20:23], v[172:175]
    v_exp_f32_e64 v77, v77 clamp
    v_mfma_f32_16x16x32_bf16 v[168:171], a[224:227], v[20:23], v[168:171]
    buffer_load_dwordx4 v6, s[12:15], s25 offen nt lds
    v_mfma_f32_16x16x32_bf16 v[120:123], a[224:227], v[16:19], v[120:123]
    v_fma_f32 v78, v78, s28, v12
    v_fma_f32 v56, v56, s28, v9
    v_mfma_f32_16x16x32_bf16 v[124:127], a[228:231], v[16:19], v[124:127]
    s_waitcnt lgkmcnt(1)
    ds_read_b64_tr_b16 a[224:225], v2 offset:20480
    ds_read_b64_tr_b16 a[220:221], v5 offset:19456
    v_mfma_f32_16x16x32_bf16 v[128:131], a[232:235], v[16:19], v[128:131]
    ds_read_b64_tr_b16 a[222:223], v5 offset:13312
    v_fma_f32 v76, v76, s28, v12
    v_mfma_f32_16x16x32_bf16 v[132:135], a[236:239], v[16:19], v[132:135]
    v_exp_f32_e64 v84, v84 clamp
    v_mfma_f32_16x16x32_bf16 v[180:183], a[236:239], v[20:23], v[180:183]
    v_exp_f32_e64 v87, v87 clamp
    v_mfma_f32_16x16x32_bf16 v[176:179], a[232:235], v[20:23], v[176:179]
    v_fma_f32 v66, v66, s28, v10
    v_fma_f32 v58, v58, s28, v9
    v_mfma_f32_16x16x32_bf16 v[224:227], a[232:235], v[28:31], v[224:227]
    ds_read_b64_tr_b16 a[230:231], v3 offset:14336
    v_mfma_f32_16x16x32_bf16 v[228:231], a[236:239], v[28:31], v[228:231]
    v_fma_f32 v89, v89, s28, v13
    v_fma_f32 v69, v69, s28, v11
    v_mfma_f32_16x16x32_bf16 a[20:23], a[236:239], v[32:35], a[20:23]
    v_exp_f32_e64 v68, v68 clamp
    v_mfma_f32_16x16x32_bf16 a[16:19], a[232:235], v[32:35], a[16:19]
    v_exp_f32_e64 v81, v81 clamp
    v_mfma_f32_16x16x32_bf16 a[64:67], a[232:235], v[40:43], a[64:67]
    ds_read_b64_tr_b16 a[228:229], v3 offset:20480
    v_fma_f32 v91, v91, s28, v13
    v_mfma_f32_16x16x32_bf16 a[68:71], a[236:239], v[40:43], a[68:71]
    s_waitcnt lgkmcnt(3)
    ds_read_b64_tr_b16 a[226:227], v2 offset:14336
    v_mfma_f32_16x16x32_bf16 a[72:75], a[216:219], v[40:43], a[72:75]
    s_waitcnt lgkmcnt(3)
    v_exp_f32_e64 v86, v86 clamp
    v_mfma_f32_16x16x32_bf16 a[76:79], a[220:223], v[40:43], a[76:79]
    ds_read_b64_tr_b16 a[236:237], v5 offset:20480
    ds_read_b64_tr_b16 a[232:233], v4 offset:20480
    v_mfma_f32_16x16x32_bf16 a[28:31], a[220:223], v[32:35], a[28:31]
    ds_read_b64_tr_b16 a[238:239], v5 offset:14336
    ds_read_b64_tr_b16 a[234:235], v4 offset:14336
    v_mfma_f32_16x16x32_bf16 a[24:27], a[216:219], v[32:35], a[24:27]
    v_exp_f32_e64 v88, v88 clamp
    v_mfma_f32_16x16x32_bf16 v[232:235], a[216:219], v[28:31], v[232:235]
    v_exp_f32_e64 v65, v65 clamp
    v_mfma_f32_16x16x32_bf16 v[236:239], a[220:223], v[28:31], v[236:239]
    v_exp_f32_e64 v78, v78 clamp
    v_mfma_f32_16x16x32_bf16 v[188:191], a[220:223], v[20:23], v[188:191]
    v_exp_f32_e64 v79, v79 clamp
    v_mfma_f32_16x16x32_bf16 v[184:187], a[216:219], v[20:23], v[184:187]
    ds_read_b128 v[96:99], v103 offset:1024
    v_cvt_pk_bf16_f32 v38, v84, v85
    v_mfma_f32_16x16x32_bf16 v[136:139], a[216:219], v[16:19], v[136:139]
    v_exp_f32_e64 v69, v69 clamp
    v_mfma_f32_16x16x32_bf16 v[140:143], a[220:223], v[16:19], v[140:143]
    s_waitcnt lgkmcnt(5)
    v_exp_f32_e64 v89, v89 clamp
    v_mfma_f32_16x16x32_bf16 v[144:147], a[224:227], v[16:19], v[144:147]
    v_exp_f32_e64 v66, v66 clamp
    v_mfma_f32_16x16x32_bf16 v[148:151], a[228:231], v[16:19], v[148:151]
    v_exp_f32_e64 v75, v75 clamp
    v_mfma_f32_16x16x32_bf16 v[196:199], a[228:231], v[20:23], v[196:199]
    v_exp_f32_e64 v64, v64 clamp
    v_mfma_f32_16x16x32_bf16 v[192:195], a[224:227], v[20:23], v[192:195]
    s_waitcnt vmcnt(12) lgkmcnt(1)
    v_fma_f32 v82, v82, s28, v12
    s_add_u32 m0, s22, 36864
    v_mfma_f32_16x16x32_bf16 v[240:243], a[224:227], v[28:31], v[240:243]
    v_exp_f32_e64 v76, v76 clamp
    v_mfma_f32_16x16x32_bf16 v[244:247], a[228:231], v[28:31], v[244:247]
    s_barrier
    v_mfma_f32_16x16x32_bf16 a[36:39], a[228:231], v[32:35], a[36:39]
    buffer_load_dwordx4 v6, s[8:11], s21 offen lds
    v_mfma_f32_16x16x32_bf16 a[32:35], a[224:227], v[32:35], a[32:35]
    v_exp_f32_e64 v80, v80 clamp
    v_mfma_f32_16x16x32_bf16 a[80:83], a[224:227], v[40:43], a[80:83]
    s_add_u32 s21, s21, 128
    v_fma_f32 v59, v59, s28, v9
    v_fma_f32 v90, v90, s28, v13
    v_mfma_f32_16x16x32_bf16 a[84:87], a[228:231], v[40:43], a[84:87]
    ds_read_b128 a[216:219], v0 offset:12288
    v_cvt_pk_bf16_f32 v24, v64, v65
    v_mfma_f32_16x16x32_bf16 a[88:91], a[232:235], v[40:43], a[88:91]
    ds_read_b128 a[220:223], v1 offset:12288
    v_mfma_f32_16x16x32_bf16 a[92:95], a[236:239], v[40:43], a[92:95]
    ds_read_b128 a[224:227], v0 offset:13312
    v_mfma_f32_16x16x32_bf16 a[44:47], a[236:239], v[32:35], a[44:47]
    v_exp_f32_e64 v70, v70 clamp
    v_mfma_f32_16x16x32_bf16 a[40:43], a[232:235], v[32:35], a[40:43]
    v_fma_f32 v57, v57, s28, v9
    v_cvt_pk_bf16_f32 v34, v76, v77
    v_mfma_f32_16x16x32_bf16 v[248:251], a[232:235], v[28:31], v[248:251]
    s_add_u32 m0, s22, 37888
    v_mfma_f32_16x16x32_bf16 v[252:255], a[236:239], v[28:31], v[252:255]
    ds_read_b128 a[228:231], v1 offset:13312
    v_cvt_pk_bf16_f32 v39, v86, v87
    v_mfma_f32_16x16x32_bf16 v[204:207], a[236:239], v[20:23], v[204:207]
    buffer_load_dwordx4 v6, s[8:11], s21 offen lds
    v_mfma_f32_16x16x32_bf16 v[200:203], a[232:235], v[20:23], v[200:203]
    s_add_u32 s21, s21, 128
    v_cvt_pk_bf16_f32 v27, v70, v71
    s_add_u32 m0, s22, 38912
    v_mfma_f32_16x16x32_bf16 v[152:155], a[232:235], v[16:19], v[152:155]
    buffer_load_dwordx4 v6, s[8:11], s21 offen lds
    v_mfma_f32_16x16x32_bf16 v[156:159], a[236:239], v[16:19], v[156:159]
    s_waitcnt lgkmcnt(3)
    v_cvt_pk_bf16_f32 v26, v68, v69
    v_mfma_f32_16x16x32_bf16 v[52:55], a[216:219], a[96:99], 0
    s_waitcnt lgkmcnt(2)
    v_fma_f32 v83, v83, s28, v12
    v_cvt_pk_bf16_f32 v23, v62, v63
    v_mfma_f32_16x16x32_bf16 v[52:55], a[220:223], a[100:103], v[52:55]
    s_waitcnt lgkmcnt(1)
    v_cvt_pk_bf16_f32 v22, v60, v61
    v_mfma_f32_16x16x32_bf16 v[52:55], a[224:227], a[104:107], v[52:55]
    v_exp_f32_e64 v67, v67 clamp
    v_mfma_f32_16x16x32_bf16 v[60:63], a[224:227], a[128:131], 0
    ds_read_b128 a[236:239], v1 offset:14336
    v_fma_f32 v74, v74, s28, v11
    v_mfma_f32_16x16x32_bf16 v[60:63], a[220:223], a[124:127], v[60:63]
    v_exp_f32_e64 v82, v82 clamp
    v_mfma_f32_16x16x32_bf16 v[60:63], a[216:219], a[120:123], v[60:63]
    ds_read_b128 a[232:235], v0 offset:14336
    v_mfma_f32_16x16x32_bf16 v[68:71], a[216:219], a[144:147], 0
    s_add_u32 s21, s21, 12032
    v_exp_f32_e64 v59, v59 clamp
    v_mfma_f32_16x16x32_bf16 v[68:71], a[220:223], a[148:151], v[68:71]
    buffer_store_dwordx4 v[96:99], v7, s[16:19], s24 offen offset:0 nt
    v_cvt_pk_bf16_f32 v35, v78, v79
    v_exp_f32_e64 v91, v91 clamp
    v_mfma_f32_16x16x32_bf16 v[68:71], a[224:227], a[152:155], v[68:71]
    v_exp_f32_e64 v72, v72 clamp
    v_mfma_f32_16x16x32_bf16 v[76:79], a[224:227], a[176:179], 0
    v_exp_f32_e64 v56, v56 clamp
    v_mfma_f32_16x16x32_bf16 v[76:79], a[220:223], a[172:175], v[76:79]
    s_add_u32 m0, s23, 1024
    v_mfma_f32_16x16x32_bf16 v[76:79], a[216:219], a[168:171], v[76:79]
    v_exp_f32_e64 v90, v90 clamp
    v_mfma_f32_16x16x32_bf16 v[84:87], a[216:219], a[192:195], 0
    v_exp_f32_e64 v73, v73 clamp
    v_mfma_f32_16x16x32_bf16 v[84:87], a[220:223], a[196:199], v[84:87]
    v_exp_f32_e64 v58, v58 clamp
    v_mfma_f32_16x16x32_bf16 v[84:87], a[224:227], a[200:203], v[84:87]
    s_waitcnt lgkmcnt(0)
    v_exp_f32_e64 v83, v83 clamp
    v_mfma_f32_16x16x32_bf16 v[84:87], a[228:231], a[204:207], v[84:87]
    v_exp_f32_e64 v74, v74 clamp
    v_mfma_f32_16x16x32_bf16 v[84:87], a[232:235], a[208:211], v[84:87]
    v_cvt_pk_bf16_f32 v40, v88, v89
    v_cvt_pk_bf16_f32 v41, v90, v91
    v_mfma_f32_16x16x32_bf16 v[84:87], a[236:239], a[212:215], v[84:87]
    buffer_load_dwordx4 v7, s[12:15], s25 offen nt lds
    v_mfma_f32_16x16x32_bf16 v[76:79], a[236:239], a[188:191], v[76:79]
    ds_read_b128 a[216:219], v0 offset:18432
    v_cvt_pk_bf16_f32 v25, v66, v67
    v_mfma_f32_16x16x32_bf16 v[76:79], a[232:235], a[184:187], v[76:79]
    v_exp_f32_e64 v57, v57 clamp
    v_mfma_f32_16x16x32_bf16 v[76:79], a[228:231], a[180:183], v[76:79]
    ds_read_b128 v[96:99], v103 offset:2048
    v_cvt_pk_bf16_f32 v29, v74, v75
    v_mfma_f32_16x16x32_bf16 v[68:71], a[228:231], a[156:159], v[68:71]
    ds_read_b128 a[220:223], v1 offset:18432
    v_cvt_pk_bf16_f32 v16, v56, v57
    v_mfma_f32_16x16x32_bf16 v[68:71], a[232:235], a[160:163], v[68:71]
    s_bitcmp1_b32 s27, 0
    ds_read_b128 a[224:227], v0 offset:19456
    v_cvt_pk_bf16_f32 v37, v82, v83
    v_mfma_f32_16x16x32_bf16 v[68:71], a[236:239], a[164:167], v[68:71]
    v_mfma_f32_16x16x32_bf16 v[60:63], a[236:239], a[140:143], v[60:63]
    v_cvt_pk_bf16_f32 v36, v80, v81
    v_cvt_pk_bf16_f32 v17, v58, v59
    v_mfma_f32_16x16x32_bf16 v[60:63], a[232:235], a[136:139], v[60:63]
    v_mfma_f32_16x16x32_bf16 v[60:63], a[228:231], a[132:135], v[60:63]
    v_mfma_f32_16x16x32_bf16 v[52:55], a[228:231], a[108:111], v[52:55]
    v_cvt_pk_bf16_f32 v28, v72, v73
    v_mfma_f32_16x16x32_bf16 v[52:55], a[232:235], a[112:115], v[52:55]
    ds_read_b128 a[228:231], v1 offset:19456
    ds_read_b128 a[232:235], v0 offset:20480
    v_mfma_f32_16x16x32_bf16 v[52:55], a[236:239], a[116:119], v[52:55]
    ds_read_b128 a[236:239], v1 offset:20480
    s_cselect_b32 s26, s49, 128
    v_mfma_f32_16x16x32_bf16 v[44:47], a[248:251], v[14:17], v[44:47]
    s_waitcnt lgkmcnt(5)
    v_mfma_f32_16x16x32_bf16 v[56:59], a[216:219], a[96:99], 0
    v_smfmac_f32_16x16x64_bf16 v[44:47], a[240:243], v[22:29], v101
    v_smfmac_f32_16x16x64_bf16 v[44:47], a[244:247], v[34:41], v101
    s_waitcnt lgkmcnt(3)
    v_mfma_f32_16x16x32_bf16 v[56:59], a[220:223], a[100:103], v[56:59]
    v_mfma_f32_16x16x32_bf16 v[56:59], a[224:227], a[104:107], v[56:59]
    s_lshr_b32 s27, s27, 1
    s_add_u32 s24, s24, s26
    v_mfma_f32_16x16x32_bf16 v[64:67], a[224:227], a[128:131], 0
    v_mfma_f32_16x16x32_bf16 v[64:67], a[220:223], a[124:127], v[64:67]
    s_nop 0
    v_cmp_lt_f32 vcc, s29, v44
    v_mfma_f32_16x16x32_bf16 v[64:67], a[216:219], a[120:123], v[64:67]
    s_add_u32 s25, s25, s26
    s_waitcnt vmcnt(12) lgkmcnt(0)
    s_barrier
    v_mfma_f32_16x16x32_bf16 v[72:75], a[216:219], a[144:147], 0
    s_cbranch_vccnz L_rs_loop5w1a
L_ret_loop5w1a:
    v_mfma_f32_16x16x32_bf16 v[72:75], a[220:223], a[148:151], v[72:75]
    s_add_u32 m0, s22, 12288
    v_fma_f32 v60, v60, s28, v10
    v_fma_f32 v79, v79, s28, v12
    v_mfma_f32_16x16x32_bf16 v[72:75], a[224:227], a[152:155], v[72:75]
    buffer_load_dwordx4 v6, s[4:7], s20 offen lds
    v_mfma_f32_16x16x32_bf16 v[80:83], a[224:227], a[176:179], 0
    v_mfma_f32_16x16x32_bf16 v[80:83], a[220:223], a[172:175], v[80:83]
    v_fma_f32 v52, v52, s28, v9
    s_add_u32 s20, s20, 128
    v_mfma_f32_16x16x32_bf16 v[80:83], a[216:219], a[168:171], v[80:83]
    v_fma_f32 v69, v69, s28, v11
    s_add_u32 m0, s22, 13312
    v_mfma_f32_16x16x32_bf16 v[88:91], a[216:219], a[192:195], 0
    buffer_load_dwordx4 v6, s[4:7], s20 offen lds
    v_mfma_f32_16x16x32_bf16 v[88:91], a[220:223], a[196:199], v[88:91]
    ds_read_b64_tr_b16 a[216:217], v2 offset:0
    ds_read_b64_tr_b16 a[218:219], v2 offset:6144
    v_mfma_f32_16x16x32_bf16 v[88:91], a[224:227], a[200:203], v[88:91]
    v_fma_f32 v78, v78, s28, v12
    v_fma_f32 v54, v54, s28, v9
    v_mfma_f32_16x16x32_bf16 v[88:91], a[228:231], a[204:207], v[88:91]
    s_add_u32 s20, s20, 128
    v_fma_f32 v62, v62, s28, v10
    s_add_u32 m0, s22, 14336
    v_mfma_f32_16x16x32_bf16 v[88:91], a[232:235], a[208:211], v[88:91]
    ds_read_b64_tr_b16 a[220:221], v3 offset:0
    v_mfma_f32_16x16x32_bf16 v[88:91], a[236:239], a[212:215], v[88:91]
    buffer_load_dwordx4 v6, s[4:7], s20 offen lds
    v_mfma_f32_16x16x32_bf16 v[80:83], a[236:239], a[188:191], v[80:83]
    v_fma_f32 v55, v55, s28, v9
    v_fma_f32 v84, v84, s28, v13
    v_mfma_f32_16x16x32_bf16 v[80:83], a[232:235], a[184:187], v[80:83]
    v_fma_f32 v86, v86, s28, v13
    v_mfma_f32_16x16x32_bf16 v[80:83], a[228:231], a[180:183], v[80:83]
    ds_read_b64_tr_b16 a[222:223], v3 offset:6144
    v_mfma_f32_16x16x32_bf16 v[72:75], a[228:231], a[156:159], v[72:75]
    ds_read_b64_tr_b16 a[224:225], v4 offset:0
    v_fma_f32 v53, v53, s28, v9
    v_mfma_f32_16x16x32_bf16 v[72:75], a[232:235], a[160:163], v[72:75]
    v_fma_f32 v76, v76, s28, v12
    s_add_u32 s20, s20, 12032
    v_mfma_f32_16x16x32_bf16 v[72:75], a[236:239], a[164:167], v[72:75]
    v_exp_f32_e64 v62, v62 clamp
    v_mfma_f32_16x16x32_bf16 v[64:67], a[236:239], a[140:143], v[64:67]
    v_exp_f32_e64 v55, v55 clamp
    v_mfma_f32_16x16x32_bf16 v[64:67], a[232:235], a[136:139], v[64:67]
    v_fma_f32 v68, v68, s28, v11
    v_fma_f32 v83, v83, s28, v12
    v_mfma_f32_16x16x32_bf16 v[64:67], a[228:231], a[132:135], v[64:67]
    v_fma_f32 v80, v80, s28, v12
    v_mfma_f32_16x16x32_bf16 v[56:59], a[228:231], a[108:111], v[56:59]
    s_add_u32 s39, s39, 12288
    v_fma_f32 v61, v61, s28, v10
    v_fma_f32 v71, v71, s28, v11
    v_mfma_f32_16x16x32_bf16 v[56:59], a[232:235], a[112:115], v[56:59]
    ds_read_b64_tr_b16 a[226:227], v4 offset:6144
    v_fma_f32 v77, v77, s28, v12
    v_mfma_f32_16x16x32_bf16 v[56:59], a[236:239], a[116:119], v[56:59]
    s_waitcnt lgkmcnt(3)
    ds_read_b64_tr_b16 a[236:237], v3 offset:1024
    ds_read_b64_tr_b16 a[238:239], v3 offset:7168
    v_mfma_f32_16x16x32_bf16 v[112:115], a[216:219], v[14:17], v[112:115]
    s_waitcnt lgkmcnt(4)
    ds_read_b64_tr_b16 a[228:229], v5 offset:0
    v_mfma_f32_16x16x32_bf16 v[116:119], a[220:223], v[14:17], v[116:119]
    v_exp_f32_e64 v54, v54 clamp
    v_mfma_f32_16x16x32_bf16 v[164:167], a[220:223], v[22:25], v[164:167]
    s_add_u32 m0, s23, 2048
    ds_read_b64_tr_b16 a[230:231], v5 offset:6144
    ds_read_b64_tr_b16 a[232:233], v2 offset:1024
    v_mfma_f32_16x16x32_bf16 v[160:163], a[216:219], v[22:25], v[160:163]
    v_fma_f32 v73, v73, s28, v11
    v_mfma_f32_16x16x32_bf16 v[208:211], a[216:219], v[26:29], v[208:211]
    v_exp_f32_e64 v53, v53 clamp
    v_mfma_f32_16x16x32_bf16 v[212:215], a[220:223], v[26:29], v[212:215]
    v_exp_f32_e64 v69, v69 clamp
    v_mfma_f32_16x16x32_bf16 a[4:7], a[220:223], v[34:37], a[4:7]
    buffer_store_dwordx4 v[96:99], v6, s[16:19], s24 offen offset:0 nt
    v_fma_f32 v56, v56, s28, v9
    v_cvt_pk_bf16_f32 v19, v54, v55
    v_fma_f32 v70, v70, s28, v11
    v_mfma_f32_16x16x32_bf16 a[0:3], a[216:219], v[34:37], a[0:3]
    v_mfma_f32_16x16x32_bf16 a[48:51], a[216:219], v[38:41], a[48:51]
    v_fma_f32 v87, v87, s28, v13
    v_fma_f32 v85, v85, s28, v13
    v_mfma_f32_16x16x32_bf16 a[52:55], a[220:223], v[38:41], a[52:55]
    s_waitcnt lgkmcnt(2)
    ds_read_b64_tr_b16 a[234:235], v2 offset:7168
    v_fma_f32 v75, v75, s28, v11
    v_mfma_f32_16x16x32_bf16 a[56:59], a[224:227], v[38:41], a[56:59]
    ds_read_b64_tr_b16 a[222:223], v5 offset:7168
    s_waitcnt lgkmcnt(3)
    v_mfma_f32_16x16x32_bf16 a[60:63], a[228:231], v[38:41], a[60:63]
    v_fma_f32 v81, v81, s28, v12
    v_fma_f32 v65, v65, s28, v10
    v_mfma_f32_16x16x32_bf16 a[12:15], a[228:231], v[34:37], a[12:15]
    v_exp_f32_e64 v73, v73 clamp
    v_mfma_f32_16x16x32_bf16 a[8:11], a[224:227], v[34:37], a[8:11]
    v_fma_f32 v58, v58, s28, v9
    v_fma_f32 v72, v72, s28, v11
    v_mfma_f32_16x16x32_bf16 v[216:219], a[224:227], v[26:29], v[216:219]
    v_fma_f32 v67, v67, s28, v10
    v_fma_f32 v57, v57, s28, v9
    v_mfma_f32_16x16x32_bf16 v[220:223], a[228:231], v[26:29], v[220:223]
    v_exp_f32_e64 v86, v86 clamp
    v_mfma_f32_16x16x32_bf16 v[172:175], a[228:231], v[22:25], v[172:175]
    ds_read_b64_tr_b16 a[216:217], v4 offset:1024
    ds_read_b64_tr_b16 a[218:219], v4 offset:7168
    v_mfma_f32_16x16x32_bf16 v[168:171], a[224:227], v[22:25], v[168:171]
    buffer_load_dwordx4 v6, s[12:15], s25 offen nt lds
    v_mfma_f32_16x16x32_bf16 v[120:123], a[224:227], v[14:17], v[120:123]
    v_exp_f32_e64 v70, v70 clamp
    v_mfma_f32_16x16x32_bf16 v[124:127], a[228:231], v[14:17], v[124:127]
    s_waitcnt lgkmcnt(3)
    ds_read_b64_tr_b16 a[220:221], v5 offset:1024
    v_fma_f32 v89, v89, s28, v13
    v_mfma_f32_16x16x32_bf16 v[128:131], a[232:235], v[14:17], v[128:131]
    v_exp_f32_e64 v76, v76 clamp
    v_mfma_f32_16x16x32_bf16 v[132:135], a[236:239], v[14:17], v[132:135]
    v_exp_f32_e64 v61, v61 clamp
    v_mfma_f32_16x16x32_bf16 v[180:183], a[236:239], v[22:25], v[180:183]
    ds_read_b64_tr_b16 a[226:227], v2 offset:8192
    ds_read_b128 v[96:99], v103 offset:3072
    v_mfma_f32_16x16x32_bf16 v[176:179], a[232:235], v[22:25], v[176:179]
    v_exp_f32_e64 v80, v80 clamp
    v_mfma_f32_16x16x32_bf16 v[224:227], a[232:235], v[26:29], v[224:227]
    v_exp_f32_e64 v65, v65 clamp
    v_mfma_f32_16x16x32_bf16 v[228:231], a[236:239], v[26:29], v[228:231]
    v_fma_f32 v66, v66, s28, v10
    v_fma_f32 v63, v63, s28, v10
    v_mfma_f32_16x16x32_bf16 a[20:23], a[236:239], v[34:37], a[20:23]
    v_exp_f32_e64 v52, v52 clamp
    v_mfma_f32_16x16x32_bf16 a[16:19], a[232:235], v[34:37], a[16:19]
    v_exp_f32_e64 v79, v79 clamp
    v_mfma_f32_16x16x32_bf16 a[64:67], a[232:235], v[38:41], a[64:67]
    ds_read_b64_tr_b16 a[230:231], v3 offset:8192
    ds_read_b64_tr_b16 a[232:233], v4 offset:2048
    v_mfma_f32_16x16x32_bf16 a[68:71], a[236:239], v[38:41], a[68:71]
    s_waitcnt lgkmcnt(4)
    ds_read_b64_tr_b16 a[224:225], v2 offset:2048
    v_mfma_f32_16x16x32_bf16 a[72:75], a[216:219], v[38:41], a[72:75]
    ds_read_b64_tr_b16 a[228:229], v3 offset:2048
    ds_read_b64_tr_b16 a[236:237], v5 offset:2048
    v_mfma_f32_16x16x32_bf16 a[76:79], a[220:223], v[38:41], a[76:79]
    v_exp_f32_e64 v60, v60 clamp
    v_mfma_f32_16x16x32_bf16 a[28:31], a[220:223], v[34:37], a[28:31]
    v_exp_f32_e64 v87, v87 clamp
    v_mfma_f32_16x16x32_bf16 a[24:27], a[216:219], v[34:37], a[24:27]
    ds_read_b64_tr_b16 a[234:235], v4 offset:8192
    ds_read_b64_tr_b16 a[238:239], v5 offset:8192
    v_mfma_f32_16x16x32_bf16 v[232:235], a[216:219], v[26:29], v[232:235]
    v_exp_f32_e64 v84, v84 clamp
    v_mfma_f32_16x16x32_bf16 v[236:239], a[220:223], v[26:29], v[236:239]
    v_exp_f32_e64 v71, v71 clamp
    v_mfma_f32_16x16x32_bf16 v[188:191], a[220:223], v[22:25], v[188:191]
    v_fma_f32 v82, v82, s28, v12
    v_mfma_f32_16x16x32_bf16 v[184:187], a[216:219], v[22:25], v[184:187]
    v_cvt_pk_bf16_f32 v43, v86, v87
    v_mfma_f32_16x16x32_bf16 v[136:139], a[216:219], v[14:17], v[136:139]
    v_exp_f32_e64 v58, v58 clamp
    v_mfma_f32_16x16x32_bf16 v[140:143], a[220:223], v[14:17], v[140:143]
    s_waitcnt lgkmcnt(4)
    v_exp_f32_e64 v63, v63 clamp
    v_mfma_f32_16x16x32_bf16 v[144:147], a[224:227], v[14:17], v[144:147]
    s_waitcnt lgkmcnt(2)
    v_exp_f32_e64 v57, v57 clamp
    v_mfma_f32_16x16x32_bf16 v[148:151], a[228:231], v[14:17], v[148:151]
    v_exp_f32_e64 v77, v77 clamp
    v_mfma_f32_16x16x32_bf16 v[196:199], a[228:231], v[22:25], v[196:199]
    v_exp_f32_e64 v81, v81 clamp
    v_mfma_f32_16x16x32_bf16 v[192:195], a[224:227], v[22:25], v[192:195]
    s_waitcnt vmcnt(12) lgkmcnt(0)
    v_fma_f32 v59, v59, s28, v9
    v_fma_f32 v91, v91, s28, v13
    v_mfma_f32_16x16x32_bf16 v[240:243], a[224:227], v[26:29], v[240:243]
    s_add_u32 m0, s22, 24576
    v_exp_f32_e64 v59, v59 clamp
    v_mfma_f32_16x16x32_bf16 v[244:247], a[228:231], v[26:29], v[244:247]
    s_barrier
    v_mfma_f32_16x16x32_bf16 a[36:39], a[228:231], v[34:37], a[36:39]
    v_fma_f32 v88, v88, s28, v13
    v_fma_f32 v74, v74, s28, v11
    v_mfma_f32_16x16x32_bf16 a[32:35], a[224:227], v[34:37], a[32:35]
    buffer_load_dwordx4 v6, s[8:11], s21 offen lds
    v_mfma_f32_16x16x32_bf16 a[80:83], a[224:227], v[38:41], a[80:83]
    ds_read_b128 a[216:219], v0 offset:0
    v_mfma_f32_16x16x32_bf16 a[84:87], a[228:231], v[38:41], a[84:87]
    s_add_u32 s21, s21, 128
    s_add_u32 m0, s22, 25600
    ds_read_b128 a[220:223], v1 offset:0
    v_mfma_f32_16x16x32_bf16 a[88:91], a[232:235], v[38:41], a[88:91]
    buffer_load_dwordx4 v6, s[8:11], s21 offen lds
    v_mfma_f32_16x16x32_bf16 a[92:95], a[236:239], v[38:41], a[92:95]
    s_add_u32 s21, s21, 128
    ds_read_b128 a[224:227], v0 offset:1024
    s_add_u32 m0, s22, 26624
    v_mfma_f32_16x16x32_bf16 a[44:47], a[236:239], v[34:37], a[44:47]
    v_exp_f32_e64 v88, v88 clamp
    v_mfma_f32_16x16x32_bf16 a[40:43], a[232:235], v[34:37], a[40:43]
    buffer_load_dwordx4 v6, s[8:11], s21 offen lds
    v_mfma_f32_16x16x32_bf16 v[248:251], a[232:235], v[26:29], v[248:251]
    v_exp_f32_e64 v68, v68 clamp
    v_mfma_f32_16x16x32_bf16 v[252:255], a[236:239], v[26:29], v[252:255]
    v_exp_f32_e64 v91, v91 clamp
    v_mfma_f32_16x16x32_bf16 v[204:207], a[236:239], v[22:25], v[204:207]
    v_exp_f32_e64 v78, v78 clamp
    v_mfma_f32_16x16x32_bf16 v[200:203], a[232:235], v[22:25], v[200:203]
    v_exp_f32_e64 v66, v66 clamp
    v_mfma_f32_16x16x32_bf16 v[152:155], a[232:235], v[14:17], v[152:155]
    v_cvt_pk_bf16_f32 v22, v60, v61
    v_mfma_f32_16x16x32_bf16 v[156:159], a[236:239], v[14:17], v[156:159]
    s_waitcnt lgkmcnt(1)
    ds_read_b128 a[232:235], v0 offset:2048
    v_cvt_pk_bf16_f32 v18, v52, v53
    v_mfma_f32_16x16x32_bf16 v[52:55], a[216:219], a[96:99], 0
    v_cvt_pk_bf16_f32 v32, v80, v81
    v_cvt_pk_bf16_f32 v23, v62, v63
    v_mfma_f32_16x16x32_bf16 v[52:55], a[220:223], a[100:103], v[52:55]
    s_waitcnt lgkmcnt(1)
    v_cvt_pk_bf16_f32 v30, v68, v69
    v_mfma_f32_16x16x32_bf16 v[52:55], a[224:227], a[104:107], v[52:55]
    ds_read_b128 a[228:231], v1 offset:1024
    v_cvt_pk_bf16_f32 v31, v70, v71
    v_mfma_f32_16x16x32_bf16 v[60:63], a[224:227], a[128:131], 0
    v_exp_f32_e64 v56, v56 clamp
    v_mfma_f32_16x16x32_bf16 v[60:63], a[220:223], a[124:127], v[60:63]
    ds_read_b128 a[236:239], v1 offset:2048
    v_mfma_f32_16x16x32_bf16 v[60:63], a[216:219], a[120:123], v[60:63]
    s_add_u32 s21, s21, 12032
    v_exp_f32_e64 v82, v82 clamp
    v_mfma_f32_16x16x32_bf16 v[68:71], a[216:219], a[144:147], 0
    buffer_store_dwordx4 v[96:99], v7, s[16:19], s24 offen offset:0 nt
    v_cvt_pk_bf16_f32 v35, v78, v79
    v_exp_f32_e64 v85, v85 clamp
    v_mfma_f32_16x16x32_bf16 v[68:71], a[220:223], a[148:151], v[68:71]
    v_exp_f32_e64 v72, v72 clamp
    v_mfma_f32_16x16x32_bf16 v[68:71], a[224:227], a[152:155], v[68:71]
    v_cvt_pk_bf16_f32 v34, v76, v77
    v_mfma_f32_16x16x32_bf16 v[76:79], a[224:227], a[176:179], 0
    v_exp_f32_e64 v75, v75 clamp
    v_mfma_f32_16x16x32_bf16 v[76:79], a[220:223], a[172:175], v[76:79]
    s_add_u32 m0, s23, 3072
    v_exp_f32_e64 v83, v83 clamp
    v_mfma_f32_16x16x32_bf16 v[76:79], a[216:219], a[168:171], v[76:79]
    v_fma_f32 v90, v90, s28, v13
    v_cvt_pk_bf16_f32 v42, v84, v85
    v_mfma_f32_16x16x32_bf16 v[84:87], a[216:219], a[192:195], 0
    v_exp_f32_e64 v90, v90 clamp
    v_mfma_f32_16x16x32_bf16 v[84:87], a[220:223], a[196:199], v[84:87]
    v_fma_f32 v64, v64, s28, v10
    v_mfma_f32_16x16x32_bf16 v[84:87], a[224:227], a[200:203], v[84:87]
    s_waitcnt lgkmcnt(0)
    v_cvt_pk_bf16_f32 v28, v72, v73
    v_mfma_f32_16x16x32_bf16 v[84:87], a[228:231], a[204:207], v[84:87]
    v_exp_f32_e64 v74, v74 clamp
    v_mfma_f32_16x16x32_bf16 v[84:87], a[232:235], a[208:211], v[84:87]
    buffer_load_dwordx4 v7, s[12:15], s25 offen nt lds
    v_mfma_f32_16x16x32_bf16 v[84:87], a[236:239], a[212:215], v[84:87]
    v_exp_f32_e64 v67, v67 clamp
    v_mfma_f32_16x16x32_bf16 v[76:79], a[236:239], a[188:191], v[76:79]
    ds_read_b128 a[220:223], v1 offset:6144
    v_mfma_f32_16x16x32_bf16 v[76:79], a[232:235], a[184:187], v[76:79]
    v_cvt_pk_bf16_f32 v21, v66, v67
    v_mfma_f32_16x16x32_bf16 v[76:79], a[228:231], a[180:183], v[76:79]
    v_exp_f32_e64 v64, v64 clamp
    v_mfma_f32_16x16x32_bf16 v[68:71], a[228:231], a[156:159], v[68:71]
    ds_read_b128 a[216:219], v0 offset:6144
    v_cvt_pk_bf16_f32 v41, v90, v91
    v_mfma_f32_16x16x32_bf16 v[68:71], a[232:235], a[160:163], v[68:71]
    v_mfma_f32_16x16x32_bf16 v[68:71], a[236:239], a[164:167], v[68:71]
    ds_read_b128 a[224:227], v0 offset:7168
    v_mfma_f32_16x16x32_bf16 v[60:63], a[236:239], a[140:143], v[60:63]
    s_bitcmp1_b32 s27, 0
    v_cvt_pk_bf16_f32 v16, v56, v57
    v_cvt_pk_bf16_f32 v20, v64, v65
    v_mfma_f32_16x16x32_bf16 v[60:63], a[232:235], a[136:139], v[60:63]
    v_exp_f32_e64 v89, v89 clamp
    v_mfma_f32_16x16x32_bf16 v[60:63], a[228:231], a[132:135], v[60:63]
    v_cvt_pk_bf16_f32 v29, v74, v75
    v_cvt_pk_bf16_f32 v40, v88, v89
    v_mfma_f32_16x16x32_bf16 v[52:55], a[228:231], a[108:111], v[52:55]
    ds_read_b128 a[228:231], v1 offset:7168
    v_cvt_pk_bf16_f32 v33, v82, v83
    v_mfma_f32_16x16x32_bf16 v[52:55], a[232:235], a[112:115], v[52:55]
    ds_read_b128 a[232:235], v0 offset:8192
    v_cvt_pk_bf16_f32 v17, v58, v59
    v_mfma_f32_16x16x32_bf16 v[52:55], a[236:239], a[116:119], v[52:55]
    ds_read_b128 a[236:239], v1 offset:8192
    v_smfmac_f32_16x16x64_bf16 v[48:51], a[240:243], v[16:23], v101
    v_smfmac_f32_16x16x64_bf16 v[48:51], a[244:247], v[28:35], v101
    s_cselect_b32 s26, s49, 128
    s_waitcnt lgkmcnt(4)
    v_mfma_f32_16x16x32_bf16 v[56:59], a[216:219], a[96:99], 0
    v_mfma_f32_16x16x32_bf16 v[48:51], a[248:251], v[40:43], v[48:51]
    s_lshr_b32 s27, s27, 1
    v_mfma_f32_16x16x32_bf16 v[56:59], a[220:223], a[100:103], v[56:59]
    s_waitcnt lgkmcnt(3)
    v_add_u32 v103, 4096, v103
    v_mfma_f32_16x16x32_bf16 v[56:59], a[224:227], a[104:107], v[56:59]
    s_nop 2
    v_cmp_lt_f32 vcc, s29, v48
    v_mfma_f32_16x16x32_bf16 v[64:67], a[224:227], a[128:131], 0
    s_add_u32 s24, s24, s26
    s_add_u32 s25, s25, s26
    s_add_u32 s23, s23, 4096
    v_mfma_f32_16x16x32_bf16 v[64:67], a[220:223], a[124:127], v[64:67]
    s_cbranch_vccnz L_rs_loop5w1b
L_ret_loop5w1b:
    v_fma_f32 v53, v53, s28, v9
    v_mfma_f32_16x16x32_bf16 v[64:67], a[216:219], a[120:123], v[64:67]
    s_waitcnt vmcnt(12) lgkmcnt(0)
    s_barrier
    v_mfma_f32_16x16x32_bf16 v[72:75], a[216:219], a[144:147], 0
    s_cmp_eq_u32 s30, 5
    s_cselect_b32 s26, s62, 0
    v_fma_f32 v55, v55, s28, v9
    v_mfma_f32_16x16x32_bf16 v[72:75], a[220:223], a[148:151], v[72:75]
    s_add_u32 s20, s20, s26
    v_fma_f32 v52, v52, s28, v9
    s_add_u32 m0, s22, 0
    v_mfma_f32_16x16x32_bf16 v[72:75], a[224:227], a[152:155], v[72:75]
    buffer_load_dwordx4 v6, s[4:7], s20 offen lds
    v_mfma_f32_16x16x32_bf16 v[80:83], a[224:227], a[176:179], 0
    s_add_u32 s20, s20, 128
    v_fma_f32 v63, v63, s28, v10
    s_add_u32 m0, s22, 1024
    v_mfma_f32_16x16x32_bf16 v[80:83], a[220:223], a[172:175], v[80:83]
    buffer_load_dwordx4 v6, s[4:7], s20 offen lds
    v_mfma_f32_16x16x32_bf16 v[80:83], a[216:219], a[168:171], v[80:83]
    s_add_u32 s20, s20, 128
    v_exp_f32_e64 v52, v52 clamp
    v_mfma_f32_16x16x32_bf16 v[88:91], a[216:219], a[192:195], 0
    s_add_u32 m0, s22, 2048
    v_exp_f32_e64 v63, v63 clamp
    v_mfma_f32_16x16x32_bf16 v[88:91], a[220:223], a[196:199], v[88:91]
    buffer_load_dwordx4 v6, s[4:7], s20 offen lds
    v_mfma_f32_16x16x32_bf16 v[88:91], a[224:227], a[200:203], v[88:91]
    ds_read_b64_tr_b16 a[216:217], v2 offset:18432
    ds_read_b64_tr_b16 a[218:219], v2 offset:12288
    v_mfma_f32_16x16x32_bf16 v[88:91], a[228:231], a[204:207], v[88:91]
    ds_read_b64_tr_b16 a[220:221], v3 offset:18432
    v_mfma_f32_16x16x32_bf16 v[88:91], a[232:235], a[208:211], v[88:91]
    ds_read_b64_tr_b16 a[222:223], v3 offset:12288
    v_fma_f32 v61, v61, s28, v10
    v_mfma_f32_16x16x32_bf16 v[88:91], a[236:239], a[212:215], v[88:91]
    v_fma_f32 v62, v62, s28, v10
    v_mfma_f32_16x16x32_bf16 v[80:83], a[236:239], a[188:191], v[80:83]
    v_exp_f32_e64 v53, v53 clamp
    v_mfma_f32_16x16x32_bf16 v[80:83], a[232:235], a[184:187], v[80:83]
    v_exp_f32_e64 v55, v55 clamp
    v_mfma_f32_16x16x32_bf16 v[80:83], a[228:231], a[180:183], v[80:83]
    s_add_u32 s20, s20, 12032
    v_fma_f32 v54, v54, s28, v9
    v_fma_f32 v60, v60, s28, v10
    v_mfma_f32_16x16x32_bf16 v[72:75], a[228:231], a[156:159], v[72:75]
    s_add_u32 s30, s30, 1
    ds_read_b64_tr_b16 a[224:225], v4 offset:18432
    v_cvt_pk_bf16_f32 v14, v52, v53
    v_mfma_f32_16x16x32_bf16 v[72:75], a[232:235], a[160:163], v[72:75]
    ds_read_b64_tr_b16 a[226:227], v4 offset:12288
    v_mfma_f32_16x16x32_bf16 v[72:75], a[236:239], a[164:167], v[72:75]
    v_exp_f32_e64 v62, v62 clamp
    v_mfma_f32_16x16x32_bf16 v[64:67], a[236:239], a[140:143], v[64:67]
    v_exp_f32_e64 v61, v61 clamp
    v_mfma_f32_16x16x32_bf16 v[64:67], a[232:235], a[136:139], v[64:67]
    v_exp_f32_e64 v60, v60 clamp
    v_mfma_f32_16x16x32_bf16 v[64:67], a[228:231], a[132:135], v[64:67]
    s_cmp_lt_u32 s30, 6
    v_exp_f32_e64 v54, v54 clamp
    v_mfma_f32_16x16x32_bf16 v[56:59], a[228:231], a[108:111], v[56:59]
    ds_read_b64_tr_b16 a[228:229], v5 offset:18432
    v_mfma_f32_16x16x32_bf16 v[56:59], a[232:235], a[112:115], v[56:59]
    s_waitcnt lgkmcnt(3)
    ds_read_b64_tr_b16 a[230:231], v5 offset:12288
    v_cvt_pk_bf16_f32 v15, v54, v55
    v_mfma_f32_16x16x32_bf16 v[56:59], a[236:239], a[116:119], v[56:59]
    s_cbranch_scc1 L_loop5w1
    s_cmp_ge_u32 s37, 6
    s_cbranch_scc1 L_end5
    s_cmp_eq_u32 s32, 0
    s_cbranch_scc1 L_tr54
    s_branch L_tr55
L_tr54:
    v_mfma_f32_16x16x32_bf16 v[112:115], a[216:219], v[16:19], v[112:115]
    v_mfma_f32_16x16x32_bf16 v[116:119], a[220:223], v[16:19], v[116:119]
    v_fma_f32 v87, v87, s28, v13
    v_fma_f32 v81, v81, s28, v12
    v_mfma_f32_16x16x32_bf16 v[164:167], a[220:223], v[20:23], v[164:167]
    v_fma_f32 v67, v67, s28, v10
    v_fma_f32 v76, v76, s28, v12
    v_mfma_f32_16x16x32_bf16 v[160:163], a[216:219], v[20:23], v[160:163]
    ds_read_b64_tr_b16 a[236:237], v3 offset:19456
    v_mfma_f32_16x16x32_bf16 v[208:211], a[216:219], v[28:31], v[208:211]
    ds_read_b64_tr_b16 a[232:233], v2 offset:19456
    v_fma_f32 v71, v71, s28, v11
    v_mfma_f32_16x16x32_bf16 v[212:215], a[220:223], v[28:31], v[212:215]
    ds_read_b64_tr_b16 a[234:235], v2 offset:13312
    v_fma_f32 v84, v84, s28, v13
    v_mfma_f32_16x16x32_bf16 a[4:7], a[220:223], v[32:35], a[4:7]
    v_fma_f32 v68, v68, s28, v11
    v_fma_f32 v86, v86, s28, v13
    v_mfma_f32_16x16x32_bf16 a[0:3], a[216:219], v[32:35], a[0:3]
    v_exp_f32_e64 v76, v76 clamp
    v_mfma_f32_16x16x32_bf16 a[48:51], a[216:219], v[40:43], a[48:51]
    v_exp_f32_e64 v81, v81 clamp
    v_mfma_f32_16x16x32_bf16 a[52:55], a[220:223], v[40:43], a[52:55]
    s_add_u32 s39, s39, 12288
    ds_read_b64_tr_b16 a[238:239], v3 offset:13312
    s_waitcnt lgkmcnt(4)
    v_mfma_f32_16x16x32_bf16 a[56:59], a[224:227], v[40:43], a[56:59]
    ds_read_b64_tr_b16 a[216:217], v4 offset:19456
    v_fma_f32 v80, v80, s28, v12
    v_mfma_f32_16x16x32_bf16 a[60:63], a[228:231], v[40:43], a[60:63]
    v_fma_f32 v82, v82, s28, v12
    v_mfma_f32_16x16x32_bf16 a[12:15], a[228:231], v[32:35], a[12:15]
    v_fma_f32 v75, v75, s28, v11
    v_mfma_f32_16x16x32_bf16 a[8:11], a[224:227], v[32:35], a[8:11]
    ds_read_b64_tr_b16 a[218:219], v4 offset:13312
    v_fma_f32 v69, v69, s28, v11
    v_mfma_f32_16x16x32_bf16 v[216:219], a[224:227], v[28:31], v[216:219]
    v_fma_f32 v58, v58, s28, v9
    v_fma_f32 v66, v66, s28, v10
    v_mfma_f32_16x16x32_bf16 v[220:223], a[228:231], v[28:31], v[220:223]
    ds_read_b64_tr_b16 a[220:221], v5 offset:19456
    v_fma_f32 v78, v78, s28, v12
    v_mfma_f32_16x16x32_bf16 v[172:175], a[228:231], v[20:23], v[172:175]
    v_exp_f32_e64 v84, v84 clamp
    v_mfma_f32_16x16x32_bf16 v[168:171], a[224:227], v[20:23], v[168:171]
    ds_read_b64_tr_b16 a[222:223], v5 offset:13312
    v_fma_f32 v74, v74, s28, v11
    v_mfma_f32_16x16x32_bf16 v[120:123], a[224:227], v[16:19], v[120:123]
    v_fma_f32 v91, v91, s28, v13
    v_fma_f32 v72, v72, s28, v11
    v_mfma_f32_16x16x32_bf16 v[124:127], a[228:231], v[16:19], v[124:127]
    s_waitcnt lgkmcnt(4)
    v_mfma_f32_16x16x32_bf16 v[128:131], a[232:235], v[16:19], v[128:131]
    v_fma_f32 v90, v90, s28, v13
    v_fma_f32 v88, v88, s28, v13
    v_mfma_f32_16x16x32_bf16 v[132:135], a[236:239], v[16:19], v[132:135]
    v_exp_f32_e64 v91, v91 clamp
    v_mfma_f32_16x16x32_bf16 v[180:183], a[236:239], v[20:23], v[180:183]
    v_exp_f32_e64 v75, v75 clamp
    v_mfma_f32_16x16x32_bf16 v[176:179], a[232:235], v[20:23], v[176:179]
    v_exp_f32_e64 v69, v69 clamp
    v_mfma_f32_16x16x32_bf16 v[224:227], a[232:235], v[28:31], v[224:227]
    v_exp_f32_e64 v68, v68 clamp
    v_mfma_f32_16x16x32_bf16 v[228:231], a[236:239], v[28:31], v[228:231]
    v_exp_f32_e64 v82, v82 clamp
    v_mfma_f32_16x16x32_bf16 a[20:23], a[236:239], v[32:35], a[20:23]
    ds_read_b64_tr_b16 a[224:225], v2 offset:20480
    v_fma_f32 v77, v77, s28, v12
    v_mfma_f32_16x16x32_bf16 a[16:19], a[232:235], v[32:35], a[16:19]
    ds_read_b64_tr_b16 a[228:229], v3 offset:20480
    v_fma_f32 v70, v70, s28, v11
    v_mfma_f32_16x16x32_bf16 a[64:67], a[232:235], v[40:43], a[64:67]
    v_fma_f32 v85, v85, s28, v13
    v_fma_f32 v83, v83, s28, v12
    v_mfma_f32_16x16x32_bf16 a[68:71], a[236:239], v[40:43], a[68:71]
    s_waitcnt lgkmcnt(2)
    ds_read_b64_tr_b16 a[226:227], v2 offset:14336
    v_fma_f32 v65, v65, s28, v10
    v_mfma_f32_16x16x32_bf16 a[72:75], a[216:219], v[40:43], a[72:75]
    ds_read_b64_tr_b16 a[230:231], v3 offset:14336
    v_mfma_f32_16x16x32_bf16 a[76:79], a[220:223], v[40:43], a[76:79]
    ds_read_b64_tr_b16 a[238:239], v5 offset:14336
    v_mfma_f32_16x16x32_bf16 a[28:31], a[220:223], v[32:35], a[28:31]
    ds_read_b64_tr_b16 a[232:233], v4 offset:20480
    v_fma_f32 v79, v79, s28, v12
    v_mfma_f32_16x16x32_bf16 a[24:27], a[216:219], v[32:35], a[24:27]
    v_fma_f32 v73, v73, s28, v11
    v_mfma_f32_16x16x32_bf16 v[232:235], a[216:219], v[28:31], v[232:235]
    v_fma_f32 v64, v64, s28, v10
    v_mfma_f32_16x16x32_bf16 v[236:239], a[220:223], v[28:31], v[236:239]
    v_exp_f32_e64 v87, v87 clamp
    v_mfma_f32_16x16x32_bf16 v[188:191], a[220:223], v[20:23], v[188:191]
    v_exp_f32_e64 v71, v71 clamp
    v_mfma_f32_16x16x32_bf16 v[184:187], a[216:219], v[20:23], v[184:187]
    ds_read_b64_tr_b16 a[236:237], v5 offset:20480
    v_fma_f32 v59, v59, s28, v9
    v_mfma_f32_16x16x32_bf16 v[136:139], a[216:219], v[16:19], v[136:139]
    ds_read_b64_tr_b16 a[234:235], v4 offset:14336
    v_mfma_f32_16x16x32_bf16 v[140:143], a[220:223], v[16:19], v[140:143]
    s_waitcnt lgkmcnt(5)
    v_exp_f32_e64 v79, v79 clamp
    v_mfma_f32_16x16x32_bf16 v[144:147], a[224:227], v[16:19], v[144:147]
    s_waitcnt lgkmcnt(4)
    v_exp_f32_e64 v90, v90 clamp
    v_mfma_f32_16x16x32_bf16 v[148:151], a[228:231], v[16:19], v[148:151]
    v_exp_f32_e64 v86, v86 clamp
    v_mfma_f32_16x16x32_bf16 v[196:199], a[228:231], v[20:23], v[196:199]
    v_exp_f32_e64 v66, v66 clamp
    v_mfma_f32_16x16x32_bf16 v[192:195], a[224:227], v[20:23], v[192:195]
    v_exp_f32_e64 v85, v85 clamp
    v_mfma_f32_16x16x32_bf16 v[240:243], a[224:227], v[28:31], v[240:243]
    v_exp_f32_e64 v78, v78 clamp
    v_mfma_f32_16x16x32_bf16 v[244:247], a[228:231], v[28:31], v[244:247]
    v_exp_f32_e64 v83, v83 clamp
    v_mfma_f32_16x16x32_bf16 a[36:39], a[228:231], v[32:35], a[36:39]
    v_exp_f32_e64 v70, v70 clamp
    v_mfma_f32_16x16x32_bf16 a[32:35], a[224:227], v[32:35], a[32:35]
    v_cvt_pk_bf16_f32 v27, v70, v71
    v_fma_f32 v57, v57, s28, v9
    v_mfma_f32_16x16x32_bf16 a[80:83], a[224:227], v[40:43], a[80:83]
    s_waitcnt vmcnt(10) lgkmcnt(0)
    v_mfma_f32_16x16x32_bf16 a[84:87], a[228:231], v[40:43], a[84:87]
    s_barrier
    ds_read_b128 a[220:223], v1 offset:12288
    v_mfma_f32_16x16x32_bf16 a[88:91], a[232:235], v[40:43], a[88:91]
    s_add_u32 m0, s22, 36864
    ds_read_b128 a[216:219], v0 offset:12288
    v_mfma_f32_16x16x32_bf16 a[92:95], a[236:239], v[40:43], a[92:95]
    ds_read_b128 a[224:227], v0 offset:13312
    v_cvt_pk_bf16_f32 v26, v68, v69
    v_mfma_f32_16x16x32_bf16 a[44:47], a[236:239], v[32:35], a[44:47]
    buffer_load_dwordx4 v6, s[8:11], s21 offen lds
    v_mfma_f32_16x16x32_bf16 a[40:43], a[232:235], v[32:35], a[40:43]
    s_add_u32 s21, s21, 128
    ds_read_b128 a[228:231], v1 offset:13312
    s_add_u32 m0, s22, 37888
    v_mfma_f32_16x16x32_bf16 v[248:251], a[232:235], v[28:31], v[248:251]
    v_exp_f32_e64 v67, v67 clamp
    v_mfma_f32_16x16x32_bf16 v[252:255], a[236:239], v[28:31], v[252:255]
    buffer_load_dwordx4 v6, s[8:11], s21 offen lds
    v_mfma_f32_16x16x32_bf16 v[204:207], a[236:239], v[20:23], v[204:207]
    v_exp_f32_e64 v77, v77 clamp
    v_mfma_f32_16x16x32_bf16 v[200:203], a[232:235], v[20:23], v[200:203]
    s_add_u32 s21, s21, 128
    v_fma_f32 v56, v56, s28, v9
    v_cvt_pk_bf16_f32 v34, v76, v77
    v_mfma_f32_16x16x32_bf16 v[152:155], a[232:235], v[16:19], v[152:155]
    v_cvt_pk_bf16_f32 v22, v60, v61
    v_cvt_pk_bf16_f32 v25, v66, v67
    v_mfma_f32_16x16x32_bf16 v[156:159], a[236:239], v[16:19], v[156:159]
    s_add_u32 m0, s22, 38912
    v_cvt_pk_bf16_f32 v23, v62, v63
    s_waitcnt lgkmcnt(2)
    v_mfma_f32_16x16x32_bf16 v[52:55], a[216:219], a[96:99], 0
    buffer_load_dwordx4 v6, s[8:11], s21 offen lds
    v_mfma_f32_16x16x32_bf16 v[52:55], a[220:223], a[100:103], v[52:55]
    s_waitcnt lgkmcnt(1)
    v_exp_f32_e64 v58, v58 clamp
    v_mfma_f32_16x16x32_bf16 v[52:55], a[224:227], a[104:107], v[52:55]
    v_exp_f32_e64 v57, v57 clamp
    v_mfma_f32_16x16x32_bf16 v[60:63], a[224:227], a[128:131], 0
    v_exp_f32_e64 v74, v74 clamp
    v_mfma_f32_16x16x32_bf16 v[60:63], a[220:223], a[124:127], v[60:63]
    ds_read_b128 a[236:239], v1 offset:14336
    v_cvt_pk_bf16_f32 v38, v84, v85
    v_mfma_f32_16x16x32_bf16 v[60:63], a[216:219], a[120:123], v[60:63]
    ds_read_b128 a[232:235], v0 offset:14336
    v_mfma_f32_16x16x32_bf16 v[68:71], a[216:219], a[144:147], 0
    v_exp_f32_e64 v80, v80 clamp
    v_mfma_f32_16x16x32_bf16 v[68:71], a[220:223], a[148:151], v[68:71]
    v_cvt_pk_bf16_f32 v37, v82, v83
    v_cvt_pk_bf16_f32 v35, v78, v79
    v_mfma_f32_16x16x32_bf16 v[68:71], a[224:227], a[152:155], v[68:71]
    v_exp_f32_e64 v59, v59 clamp
    v_mfma_f32_16x16x32_bf16 v[76:79], a[224:227], a[176:179], 0
    v_exp_f32_e64 v64, v64 clamp
    v_mfma_f32_16x16x32_bf16 v[76:79], a[220:223], a[172:175], v[76:79]
    v_cvt_pk_bf16_f32 v39, v86, v87
    v_cvt_pk_bf16_f32 v17, v58, v59
    v_mfma_f32_16x16x32_bf16 v[76:79], a[216:219], a[168:171], v[76:79]
    v_exp_f32_e64 v72, v72 clamp
    v_mfma_f32_16x16x32_bf16 v[84:87], a[216:219], a[192:195], 0
    v_exp_f32_e64 v65, v65 clamp
    v_mfma_f32_16x16x32_bf16 v[84:87], a[220:223], a[196:199], v[84:87]
    ds_read_b128 a[216:219], v0 offset:18432
    v_mfma_f32_16x16x32_bf16 v[84:87], a[224:227], a[200:203], v[84:87]
    s_waitcnt lgkmcnt(2)
    v_mfma_f32_16x16x32_bf16 v[84:87], a[228:231], a[204:207], v[84:87]
    s_waitcnt lgkmcnt(1)
    ds_read_b128 a[224:227], v0 offset:19456
    v_mfma_f32_16x16x32_bf16 v[84:87], a[232:235], a[208:211], v[84:87]
    ds_read_b128 a[220:223], v1 offset:18432
    v_mfma_f32_16x16x32_bf16 v[84:87], a[236:239], a[212:215], v[84:87]
    v_exp_f32_e64 v88, v88 clamp
    v_mfma_f32_16x16x32_bf16 v[76:79], a[236:239], a[188:191], v[76:79]
    v_exp_f32_e64 v56, v56 clamp
    v_mfma_f32_16x16x32_bf16 v[76:79], a[232:235], a[184:187], v[76:79]
    v_exp_f32_e64 v73, v73 clamp
    v_mfma_f32_16x16x32_bf16 v[76:79], a[228:231], a[180:183], v[76:79]
    v_cvt_pk_bf16_f32 v28, v72, v73
    v_mfma_f32_16x16x32_bf16 v[68:71], a[228:231], a[156:159], v[68:71]
    v_fma_f32 v89, v89, s28, v13
    v_cvt_pk_bf16_f32 v41, v90, v91
    v_mfma_f32_16x16x32_bf16 v[68:71], a[232:235], a[160:163], v[68:71]
    v_cvt_pk_bf16_f32 v16, v56, v57
    v_cvt_pk_bf16_f32 v24, v64, v65
    v_mfma_f32_16x16x32_bf16 v[68:71], a[236:239], a[164:167], v[68:71]
    v_cvt_pk_bf16_f32 v29, v74, v75
    v_mfma_f32_16x16x32_bf16 v[60:63], a[236:239], a[140:143], v[60:63]
    v_mfma_f32_16x16x32_bf16 v[44:47], a[248:251], v[14:17], v[44:47]
    v_exp_f32_e64 v89, v89 clamp
    v_mfma_f32_16x16x32_bf16 v[60:63], a[232:235], a[136:139], v[60:63]
    v_smfmac_f32_16x16x64_bf16 v[44:47], a[240:243], v[22:29], v101
    v_cvt_pk_bf16_f32 v36, v80, v81
    v_mfma_f32_16x16x32_bf16 v[60:63], a[228:231], a[132:135], v[60:63]
    v_cvt_pk_bf16_f32 v40, v88, v89
    v_mfma_f32_16x16x32_bf16 v[52:55], a[228:231], a[108:111], v[52:55]
    s_nop 0
    v_smfmac_f32_16x16x64_bf16 v[44:47], a[244:247], v[34:41], v101
    ds_read_b128 a[228:231], v1 offset:19456
    v_mfma_f32_16x16x32_bf16 v[52:55], a[232:235], a[112:115], v[52:55]
    ds_read_b128 a[232:235], v0 offset:20480
    v_mfma_f32_16x16x32_bf16 v[52:55], a[236:239], a[116:119], v[52:55]
    s_waitcnt lgkmcnt(2)
    ds_read_b128 a[236:239], v1 offset:20480
    v_mfma_f32_16x16x32_bf16 v[56:59], a[216:219], a[96:99], 0
    s_nop 0
    v_cmp_lt_f32 vcc, s29, v44
    v_mfma_f32_16x16x32_bf16 v[56:59], a[220:223], a[100:103], v[56:59]
    s_add_u32 s21, s21, 12032
    v_mfma_f32_16x16x32_bf16 v[56:59], a[224:227], a[104:107], v[56:59]
    v_mfma_f32_16x16x32_bf16 v[64:67], a[224:227], a[128:131], 0
    s_nop 0
    s_cbranch_vccnz L_rs_tr54a
L_ret_tr54a:
    v_mfma_f32_16x16x32_bf16 v[64:67], a[220:223], a[124:127], v[64:67]
    v_fma_f32 v62, v62, s28, v10
    v_fma_f32 v63, v63, s28, v10
    v_mfma_f32_16x16x32_bf16 v[64:67], a[216:219], a[120:123], v[64:67]
    v_fma_f32 v60, v60, s28, v10
    v_mfma_f32_16x16x32_bf16 v[72:75], a[216:219], a[144:147], 0
    v_exp_f32_e64 v60, v60 clamp
    v_mfma_f32_16x16x32_bf16 v[72:75], a[220:223], a[148:151], v[72:75]
    v_fma_f32 v61, v61, s28, v10
    v_mfma_f32_16x16x32_bf16 v[72:75], a[224:227], a[152:155], v[72:75]
    s_waitcnt vmcnt(6) lgkmcnt(0)
    v_mfma_f32_16x16x32_bf16 v[80:83], a[224:227], a[176:179], 0
    s_barrier
    v_mfma_f32_16x16x32_bf16 v[80:83], a[220:223], a[172:175], v[80:83]
    v_fma_f32 v55, v55, s28, v9
    v_fma_f32 v53, v53, s28, v9
    v_mfma_f32_16x16x32_bf16 v[80:83], a[216:219], a[168:171], v[80:83]
    v_exp_f32_e64 v61, v61 clamp
    v_mfma_f32_16x16x32_bf16 v[88:91], a[216:219], a[192:195], 0
    ds_read_b64_tr_b16 a[216:217], v2 offset:0
    s_add_u32 m0, s22, 12288
    v_mfma_f32_16x16x32_bf16 v[88:91], a[220:223], a[196:199], v[88:91]
    buffer_load_dwordx4 v6, s[4:7], s20 offen lds
    v_mfma_f32_16x16x32_bf16 v[88:91], a[224:227], a[200:203], v[88:91]
    ds_read_b64_tr_b16 a[218:219], v2 offset:6144
    s_add_u32 s20, s20, 128
    v_mfma_f32_16x16x32_bf16 v[88:91], a[228:231], a[204:207], v[88:91]
    s_add_u32 m0, s22, 13312
    ds_read_b64_tr_b16 a[220:221], v3 offset:0
    v_fma_f32 v52, v52, s28, v9
    v_mfma_f32_16x16x32_bf16 v[88:91], a[232:235], a[208:211], v[88:91]
    ds_read_b64_tr_b16 a[222:223], v3 offset:6144
    v_mfma_f32_16x16x32_bf16 v[88:91], a[236:239], a[212:215], v[88:91]
    buffer_load_dwordx4 v6, s[4:7], s20 offen lds
    v_mfma_f32_16x16x32_bf16 v[80:83], a[236:239], a[188:191], v[80:83]
    s_add_u32 s20, s20, 128
    v_exp_f32_e64 v53, v53 clamp
    v_mfma_f32_16x16x32_bf16 v[80:83], a[232:235], a[184:187], v[80:83]
    s_add_u32 m0, s22, 14336
    v_exp_f32_e64 v63, v63 clamp
    v_mfma_f32_16x16x32_bf16 v[80:83], a[228:231], a[180:183], v[80:83]
    buffer_load_dwordx4 v6, s[4:7], s20 offen lds
    v_mfma_f32_16x16x32_bf16 v[72:75], a[228:231], a[156:159], v[72:75]
    v_exp_f32_e64 v55, v55 clamp
    v_mfma_f32_16x16x32_bf16 v[72:75], a[232:235], a[160:163], v[72:75]
    ds_read_b64_tr_b16 a[224:225], v4 offset:0
    v_fma_f32 v54, v54, s28, v9
    v_mfma_f32_16x16x32_bf16 v[72:75], a[236:239], a[164:167], v[72:75]
    v_exp_f32_e64 v54, v54 clamp
    v_mfma_f32_16x16x32_bf16 v[64:67], a[236:239], a[140:143], v[64:67]
    v_exp_f32_e64 v62, v62 clamp
    v_mfma_f32_16x16x32_bf16 v[64:67], a[232:235], a[136:139], v[64:67]
    ds_read_b64_tr_b16 a[226:227], v4 offset:6144
    v_mfma_f32_16x16x32_bf16 v[64:67], a[228:231], a[132:135], v[64:67]
    s_waitcnt lgkmcnt(2)
    v_exp_f32_e64 v52, v52 clamp
    v_mfma_f32_16x16x32_bf16 v[56:59], a[228:231], a[108:111], v[56:59]
    s_add_u32 s20, s20, 12032
    ds_read_b64_tr_b16 a[228:229], v5 offset:0
    v_cvt_pk_bf16_f32 v18, v52, v53
    v_mfma_f32_16x16x32_bf16 v[56:59], a[232:235], a[112:115], v[56:59]
    v_cvt_pk_bf16_f32 v19, v54, v55
    v_mfma_f32_16x16x32_bf16 v[56:59], a[236:239], a[116:119], v[56:59]
    ds_read_b64_tr_b16 a[230:231], v5 offset:6144
    v_mfma_f32_16x16x32_bf16 v[112:115], a[216:219], v[14:17], v[112:115]
    ds_read_b64_tr_b16 a[236:237], v3 offset:1024
    v_and_b32 v104, 0x3ff, v0
    v_mfma_f32_16x16x32_bf16 v[116:119], a[220:223], v[14:17], v[116:119]
    ds_read_b64_tr_b16 a[238:239], v3 offset:7168
    v_lshrrev_b32 v105, 11, v0
    v_mfma_f32_16x16x32_bf16 v[164:167], a[220:223], v[22:25], v[164:167]
    ds_read_b64_tr_b16 a[232:233], v2 offset:1024
    v_fma_f32 v80, v80, s28, v12
    v_mfma_f32_16x16x32_bf16 v[160:163], a[216:219], v[22:25], v[160:163]
    v_xor_b32 v105, s65, v105
    v_lshl_add_u32 v104, v105, 10, v104
    v_mfma_f32_16x16x32_bf16 v[208:211], a[216:219], v[26:29], v[208:211]
    v_fma_f32 v70, v70, s28, v11
    v_add_u32 v104, s38, v104
    v_mfma_f32_16x16x32_bf16 v[212:215], a[220:223], v[26:29], v[212:215]
    ds_read_b64_tr_b16 a[234:235], v2 offset:7168
    v_fma_f32 v59, v59, s28, v9
    v_mfma_f32_16x16x32_bf16 a[4:7], a[220:223], v[34:37], a[4:7]
    v_fma_f32 v74, v74, s28, v11
    v_fma_f32 v91, v91, s28, v13
    v_mfma_f32_16x16x32_bf16 a[0:3], a[216:219], v[34:37], a[0:3]
    ds_read_b128 a[152:155], v104 offset:14336
    v_xor_b32 v105, 64, v104
    v_mfma_f32_16x16x32_bf16 a[48:51], a[216:219], v[38:41], a[48:51]
    v_exp_f32_e64 v59, v59 clamp
    v_mfma_f32_16x16x32_bf16 a[52:55], a[220:223], v[38:41], a[52:55]
    s_waitcnt lgkmcnt(5)
    ds_read_b128 a[104:107], v104 offset:2048
    v_mfma_f32_16x16x32_bf16 a[56:59], a[224:227], v[38:41], a[56:59]
    ds_read_b64_tr_b16 a[222:223], v5 offset:7168
    v_fma_f32 v88, v88, s28, v13
    v_mfma_f32_16x16x32_bf16 a[60:63], a[228:231], v[38:41], a[60:63]
    ds_read_b128 a[136:139], v104 offset:10240
    v_fma_f32 v71, v71, s28, v11
    v_mfma_f32_16x16x32_bf16 a[12:15], a[228:231], v[34:37], a[12:15]
    ds_read_b128 a[148:151], v105 offset:12288
    v_fma_f32 v76, v76, s28, v12
    v_mfma_f32_16x16x32_bf16 a[8:11], a[224:227], v[34:37], a[8:11]
    ds_read_b64_tr_b16 a[218:219], v4 offset:7168
    v_mfma_f32_16x16x32_bf16 v[216:219], a[224:227], v[26:29], v[216:219]
    ds_read_b64_tr_b16 a[216:217], v4 offset:1024
    v_fma_f32 v77, v77, s28, v12
    v_mfma_f32_16x16x32_bf16 v[220:223], a[228:231], v[26:29], v[220:223]
    v_fma_f32 v83, v83, s28, v12
    v_fma_f32 v56, v56, s28, v9
    v_mfma_f32_16x16x32_bf16 v[172:175], a[228:231], v[22:25], v[172:175]
    ds_read_b64_tr_b16 a[220:221], v5 offset:1024
    v_fma_f32 v67, v67, s28, v10
    v_mfma_f32_16x16x32_bf16 v[168:171], a[224:227], v[22:25], v[168:171]
    ds_read_b128 a[176:179], v104 offset:20480
    v_fma_f32 v81, v81, s28, v12
    v_mfma_f32_16x16x32_bf16 v[120:123], a[224:227], v[14:17], v[120:123]
    ds_read_b128 a[100:103], v105 offset:0
    v_fma_f32 v73, v73, s28, v11
    v_mfma_f32_16x16x32_bf16 v[124:127], a[228:231], v[14:17], v[124:127]
    s_waitcnt lgkmcnt(8)
    ds_read_b64_tr_b16 a[224:225], v2 offset:2048
    v_fma_f32 v69, v69, s28, v11
    v_mfma_f32_16x16x32_bf16 v[128:131], a[232:235], v[14:17], v[128:131]
    v_exp_f32_e64 v80, v80 clamp
    v_mfma_f32_16x16x32_bf16 v[132:135], a[236:239], v[14:17], v[132:135]
    ds_read_b128 a[156:159], v105 offset:14336
    v_fma_f32 v64, v64, s28, v10
    v_mfma_f32_16x16x32_bf16 v[180:183], a[236:239], v[22:25], v[180:183]
    v_exp_f32_e64 v81, v81 clamp
    v_mfma_f32_16x16x32_bf16 v[176:179], a[232:235], v[22:25], v[176:179]
    ds_read_b64_tr_b16 a[230:231], v3 offset:8192
    v_fma_f32 v89, v89, s28, v13
    v_mfma_f32_16x16x32_bf16 v[224:227], a[232:235], v[26:29], v[224:227]
    ds_read_b128 a[168:171], v104 offset:18432
    v_fma_f32 v68, v68, s28, v11
    v_mfma_f32_16x16x32_bf16 v[228:231], a[236:239], v[26:29], v[228:231]
    v_exp_f32_e64 v69, v69 clamp
    v_mfma_f32_16x16x32_bf16 a[20:23], a[236:239], v[34:37], a[20:23]
    ds_read_b128 a[160:163], v104 offset:16384
    v_fma_f32 v85, v85, s28, v13
    v_mfma_f32_16x16x32_bf16 a[16:19], a[232:235], v[34:37], a[16:19]
    ds_read_b64_tr_b16 a[226:227], v2 offset:8192
    v_mfma_f32_16x16x32_bf16 a[64:67], a[232:235], v[38:41], a[64:67]
    ds_read_b64_tr_b16 a[228:229], v3 offset:2048
    v_fma_f32 v57, v57, s28, v9
    v_mfma_f32_16x16x32_bf16 a[68:71], a[236:239], v[38:41], a[68:71]
    s_waitcnt lgkmcnt(6)
    ds_read_b128 a[188:191], v105 offset:22528
    v_fma_f32 v79, v79, s28, v12
    v_mfma_f32_16x16x32_bf16 a[72:75], a[216:219], v[38:41], a[72:75]
    ds_read_b64_tr_b16 a[236:237], v5 offset:2048
    v_fma_f32 v65, v65, s28, v10
    v_mfma_f32_16x16x32_bf16 a[76:79], a[220:223], v[38:41], a[76:79]
    ds_read_b64_tr_b16 a[234:235], v4 offset:8192
    v_fma_f32 v87, v87, s28, v13
    v_mfma_f32_16x16x32_bf16 a[28:31], a[220:223], v[34:37], a[28:31]
    ds_read_b64_tr_b16 a[232:233], v4 offset:2048
    v_fma_f32 v72, v72, s28, v11
    v_mfma_f32_16x16x32_bf16 a[24:27], a[216:219], v[34:37], a[24:27]
    v_exp_f32_e64 v79, v79 clamp
    v_mfma_f32_16x16x32_bf16 v[232:235], a[216:219], v[26:29], v[232:235]
    ds_read_b64_tr_b16 a[238:239], v5 offset:8192
    v_fma_f32 v78, v78, s28, v12
    v_mfma_f32_16x16x32_bf16 v[236:239], a[220:223], v[26:29], v[236:239]
    ds_read_b128 a[180:183], v105 offset:20480
    v_fma_f32 v66, v66, s28, v10
    v_mfma_f32_16x16x32_bf16 v[188:191], a[220:223], v[22:25], v[188:191]
    ds_read_b128 a[120:123], v104 offset:6144
    v_fma_f32 v86, v86, s28, v13
    v_mfma_f32_16x16x32_bf16 v[184:187], a[216:219], v[22:25], v[184:187]
    s_add_u32 s39, s39, 12288
    v_exp_f32_e64 v88, v88 clamp
    v_mfma_f32_16x16x32_bf16 v[136:139], a[216:219], v[14:17], v[136:139]
    ds_read_b128 a[172:175], v105 offset:18432
    v_exp_f32_e64 v70, v70 clamp
    v_mfma_f32_16x16x32_bf16 v[140:143], a[220:223], v[14:17], v[140:143]
    s_waitcnt lgkmcnt(7)
    v_exp_f32_e64 v72, v72 clamp
    v_mfma_f32_16x16x32_bf16 v[144:147], a[224:227], v[14:17], v[144:147]
    ds_read_b128 a[112:115], v104 offset:4096
    v_exp_f32_e64 v87, v87 clamp
    v_mfma_f32_16x16x32_bf16 v[148:151], a[228:231], v[14:17], v[148:151]
    v_exp_f32_e64 v64, v64 clamp
    v_mfma_f32_16x16x32_bf16 v[196:199], a[228:231], v[22:25], v[196:199]
    v_exp_f32_e64 v71, v71 clamp
    v_mfma_f32_16x16x32_bf16 v[192:195], a[224:227], v[22:25], v[192:195]
    v_exp_f32_e64 v57, v57 clamp
    v_mfma_f32_16x16x32_bf16 v[240:243], a[224:227], v[26:29], v[240:243]
    ds_read_b128 a[96:99], v104 offset:0
    v_cvt_pk_bf16_f32 v32, v80, v81
    v_mfma_f32_16x16x32_bf16 v[244:247], a[228:231], v[26:29], v[244:247]
    v_exp_f32_e64 v78, v78 clamp
    v_mfma_f32_16x16x32_bf16 a[36:39], a[228:231], v[34:37], a[36:39]
    s_waitcnt vmcnt(6) lgkmcnt(3)
    s_add_u32 s21, s21, s62
    ds_read_b128 a[124:127], v105 offset:6144
    v_mfma_f32_16x16x32_bf16 a[32:35], a[224:227], v[34:37], a[32:35]
    ds_read_b128 a[128:131], v104 offset:8192
    v_fma_f32 v90, v90, s28, v13
    v_mfma_f32_16x16x32_bf16 a[80:83], a[224:227], v[38:41], a[80:83]
    v_exp_f32_e64 v68, v68 clamp
    v_mfma_f32_16x16x32_bf16 a[84:87], a[228:231], v[38:41], a[84:87]
    s_barrier
    ds_read_b128 a[216:219], v0 offset:0
    v_mfma_f32_16x16x32_bf16 a[88:91], a[232:235], v[38:41], a[88:91]
    ds_read_b128 a[220:223], v1 offset:0
    v_cvt_pk_bf16_f32 v31, v70, v71
    v_mfma_f32_16x16x32_bf16 a[92:95], a[236:239], v[38:41], a[92:95]
    ds_read_b128 a[224:227], v0 offset:1024
    v_fma_f32 v84, v84, s28, v13
    v_mfma_f32_16x16x32_bf16 a[44:47], a[236:239], v[34:37], a[44:47]
    s_add_u32 m0, s22, 24576
    ds_read_b128 a[228:231], v1 offset:1024
    buffer_load_dwordx4 v6, s[8:11], s21 offen lds
    v_mfma_f32_16x16x32_bf16 a[40:43], a[232:235], v[34:37], a[40:43]
    s_add_u32 s21, s21, 128
    s_add_u32 m0, s22, 25600
    ds_read_b128 a[144:147], v104 offset:12288
    v_mfma_f32_16x16x32_bf16 v[248:251], a[232:235], v[26:29], v[248:251]
    buffer_load_dwordx4 v6, s[8:11], s21 offen lds
    v_mfma_f32_16x16x32_bf16 v[252:255], a[236:239], v[26:29], v[252:255]
    ds_read_b128 a[184:187], v104 offset:22528
    v_cvt_pk_bf16_f32 v35, v78, v79
    v_mfma_f32_16x16x32_bf16 v[204:207], a[236:239], v[22:25], v[204:207]
    s_add_u32 s21, s21, 128
    v_exp_f32_e64 v76, v76 clamp
    v_mfma_f32_16x16x32_bf16 v[200:203], a[232:235], v[22:25], v[200:203]
    s_add_u32 m0, s22, 26624
    v_exp_f32_e64 v83, v83 clamp
    v_mfma_f32_16x16x32_bf16 v[152:155], a[232:235], v[14:17], v[152:155]
    buffer_load_dwordx4 v6, s[8:11], s21 offen lds
    v_mfma_f32_16x16x32_bf16 v[156:159], a[236:239], v[14:17], v[156:159]
    s_waitcnt lgkmcnt(5)
    ds_read_b128 a[164:167], v105 offset:16384
    v_cvt_pk_bf16_f32 v22, v60, v61
    v_mfma_f32_16x16x32_bf16 v[52:55], a[216:219], a[96:99], 0
    s_waitcnt lgkmcnt(5)
    ds_read_b128 a[232:235], v0 offset:2048
    v_cvt_pk_bf16_f32 v30, v68, v69
    v_mfma_f32_16x16x32_bf16 v[52:55], a[220:223], a[100:103], v[52:55]
    s_waitcnt lgkmcnt(5)
    ds_read_b128 a[236:239], v1 offset:2048
    v_cvt_pk_bf16_f32 v23, v62, v63
    v_mfma_f32_16x16x32_bf16 v[52:55], a[224:227], a[104:107], v[52:55]
    s_add_u32 s21, s21, 12032
    ds_read_b128 a[140:143], v105 offset:10240
    v_fma_f32 v82, v82, s28, v12
    v_mfma_f32_16x16x32_bf16 v[60:63], a[224:227], a[128:131], 0
    v_exp_f32_e64 v84, v84 clamp
    v_mfma_f32_16x16x32_bf16 v[60:63], a[220:223], a[124:127], v[60:63]
    v_exp_f32_e64 v90, v90 clamp
    v_mfma_f32_16x16x32_bf16 v[60:63], a[216:219], a[120:123], v[60:63]
    s_waitcnt lgkmcnt(4)
    ds_read_b128 a[132:135], v105 offset:8192
    v_mfma_f32_16x16x32_bf16 v[68:71], a[216:219], a[144:147], 0
    v_exp_f32_e64 v65, v65 clamp
    v_mfma_f32_16x16x32_bf16 v[68:71], a[220:223], a[148:151], v[68:71]
    v_exp_f32_e64 v77, v77 clamp
    v_mfma_f32_16x16x32_bf16 v[68:71], a[224:227], a[152:155], v[68:71]
    ds_read_b128 a[108:111], v105 offset:2048
    v_cvt_pk_bf16_f32 v34, v76, v77
    v_mfma_f32_16x16x32_bf16 v[76:79], a[224:227], a[176:179], 0
    ds_read_b128 a[116:119], v105 offset:4096
    v_exp_f32_e64 v56, v56 clamp
    v_mfma_f32_16x16x32_bf16 v[76:79], a[220:223], a[172:175], v[76:79]
    v_exp_f32_e64 v85, v85 clamp
    v_mfma_f32_16x16x32_bf16 v[76:79], a[216:219], a[168:171], v[76:79]
    v_exp_f32_e64 v89, v89 clamp
    v_mfma_f32_16x16x32_bf16 v[76:79], a[228:231], a[180:183], v[76:79]
    s_waitcnt lgkmcnt(3)
    ds_read_b128 a[220:223], v1 offset:6144
    v_fma_f32 v75, v75, s28, v11
    v_mfma_f32_16x16x32_bf16 v[76:79], a[232:235], a[184:187], v[76:79]
    ds_read_b128 a[216:219], v0 offset:6144
    v_cvt_pk_bf16_f32 v20, v64, v65
    v_mfma_f32_16x16x32_bf16 v[76:79], a[236:239], a[188:191], v[76:79]
    v_exp_f32_e64 v67, v67 clamp
    v_mfma_f32_16x16x32_bf16 v[68:71], a[236:239], a[164:167], v[68:71]
    ds_read_b128 a[224:227], v0 offset:7168
    v_fma_f32 v58, v58, s28, v9
    v_mfma_f32_16x16x32_bf16 v[68:71], a[232:235], a[160:163], v[68:71]
    v_exp_f32_e64 v73, v73 clamp
    v_mfma_f32_16x16x32_bf16 v[68:71], a[228:231], a[156:159], v[68:71]
    s_waitcnt lgkmcnt(5)
    v_exp_f32_e64 v91, v91 clamp
    v_mfma_f32_16x16x32_bf16 v[60:63], a[228:231], a[132:135], v[60:63]
    v_exp_f32_e64 v58, v58 clamp
    v_mfma_f32_16x16x32_bf16 v[60:63], a[232:235], a[136:139], v[60:63]
    v_exp_f32_e64 v66, v66 clamp
    v_mfma_f32_16x16x32_bf16 v[60:63], a[236:239], a[140:143], v[60:63]
    s_waitcnt lgkmcnt(3)
    v_cvt_pk_bf16_f32 v17, v58, v59
    v_cvt_pk_bf16_f32 v21, v66, v67
    v_mfma_f32_16x16x32_bf16 v[52:55], a[236:239], a[116:119], v[52:55]
    ds_read_b128 a[236:239], v1 offset:8192
    v_cvt_pk_bf16_f32 v16, v56, v57
    v_mfma_f32_16x16x32_bf16 v[52:55], a[232:235], a[112:115], v[52:55]
    ds_read_b128 a[232:235], v0 offset:8192
    v_mfma_f32_16x16x32_bf16 v[52:55], a[228:231], a[108:111], v[52:55]
    s_waitcnt lgkmcnt(3)
    ds_read_b128 a[228:231], v1 offset:7168
    v_cvt_pk_bf16_f32 v28, v72, v73
    v_mfma_f32_16x16x32_bf16 v[56:59], a[216:219], a[96:99], 0
    v_exp_f32_e64 v82, v82 clamp
    v_smfmac_f32_16x16x64_bf16 v[48:51], a[240:243], v[16:23], v101
    v_cvt_pk_bf16_f32 v42, v84, v85
    v_mfma_f32_16x16x32_bf16 v[56:59], a[220:223], a[100:103], v[56:59]
    s_waitcnt lgkmcnt(3)
    v_exp_f32_e64 v86, v86 clamp
    v_mfma_f32_16x16x32_bf16 v[56:59], a[224:227], a[104:107], v[56:59]
    v_exp_f32_e64 v75, v75 clamp
    v_mfma_f32_16x16x32_bf16 v[64:67], a[224:227], a[128:131], 0
    v_cvt_pk_bf16_f32 v33, v82, v83
    v_cvt_pk_bf16_f32 v40, v88, v89
    v_mfma_f32_16x16x32_bf16 v[64:67], a[220:223], a[124:127], v[64:67]
    v_exp_f32_e64 v74, v74 clamp
    v_mfma_f32_16x16x32_bf16 v[64:67], a[216:219], a[120:123], v[64:67]
    v_cvt_pk_bf16_f32 v43, v86, v87
    v_cvt_pk_bf16_f32 v29, v74, v75
    v_mfma_f32_16x16x32_bf16 v[72:75], a[216:219], a[144:147], 0
    v_cvt_pk_bf16_f32 v41, v90, v91
    v_smfmac_f32_16x16x64_bf16 v[48:51], a[244:247], v[28:35], v101
    s_waitcnt vmcnt(6) lgkmcnt(0)
    v_mfma_f32_16x16x32_bf16 v[72:75], a[220:223], a[148:151], v[72:75]
    s_barrier
    v_mfma_f32_16x16x32_bf16 v[48:51], a[248:251], v[40:43], v[48:51]
    s_nop 7
    v_cmp_lt_f32 vcc, s29, v48
    v_mfma_f32_16x16x32_bf16 v[72:75], a[224:227], a[152:155], v[72:75]
    s_nop 3
    s_cbranch_vccnz L_rs_tr54b
L_ret_tr54b:
    s_add_u32 m0, s22, 0
    v_mfma_f32_16x16x32_bf16 v[80:83], a[224:227], a[176:179], 0
    buffer_load_dwordx4 v6, s[4:7], s20 offen lds
    v_mfma_f32_16x16x32_bf16 v[80:83], a[220:223], a[172:175], v[80:83]
    s_add_u32 s20, s20, 128
    v_and_b32 v93, 0x3ff, v0
    v_mov_b32 v110, v45
    v_mfma_f32_16x16x32_bf16 v[80:83], a[216:219], a[168:171], v[80:83]
    s_add_u32 m0, s22, 1024
    ds_read_b64_tr_b16 a[216:217], v2 offset:18432
    buffer_load_dwordx4 v6, s[4:7], s20 offen lds
    v_lshrrev_b32 v108, 11, v0
    v_mfma_f32_16x16x32_bf16 v[80:83], a[228:231], a[180:183], v[80:83]
    s_add_u32 s20, s20, 128
    v_permlane16_swap_b32 v45, v110
    v_mfma_f32_16x16x32_bf16 v[80:83], a[232:235], a[184:187], v[80:83]
    s_add_u32 m0, s22, 2048
    ds_read_b64_tr_b16 a[218:219], v2 offset:12288
    buffer_load_dwordx4 v6, s[4:7], s20 offen lds
    v_xor_b32 v108, s65, v108
    v_mov_b32 v111, v46
    v_lshl_add_u32 v93, v108, 10, v93
    v_mov_b32 v109, v50
    v_permlane16_swap_b32 v46, v111
    v_add_f32 v46, v46, v111
    v_add_f32 v45, v45, v110
    v_permlane16_swap_b32 v50, v109
    v_add_u32 v93, s38, v93
    v_mbcnt_lo_u32_b32 v108, -1, 0
    v_mfma_f32_16x16x32_bf16 v[80:83], a[236:239], a[188:191], v[80:83]
    ds_read_b64_tr_b16 a[220:221], v3 offset:18432
    v_mbcnt_hi_u32_b32 v108, -1, v108
    v_lshrrev_b32 v108, 1, v108
    v_mov_b32 v110, v45
    v_mfma_f32_16x16x32_bf16 v[72:75], a[236:239], a[164:167], v[72:75]
    v_and_b32 v108, 24, v108
    v_bfe_u32 v108, s66, v108, 8
    v_xor_b32 v93, v93, v108
    v_add_f32 v50, v50, v109
    v_permlane32_swap_b32 v45, v110
    v_mov_b32 v111, v46
    v_mov_b32 v109, v50
    v_mov_b32 v108, v49
    v_mfma_f32_16x16x32_bf16 v[72:75], a[232:235], a[160:163], v[72:75]
    ds_read_b64_tr_b16 a[222:223], v3 offset:12288
    v_permlane32_swap_b32 v50, v109
    v_permlane32_swap_b32 v46, v111
    v_mfma_f32_16x16x32_bf16 v[72:75], a[228:231], a[156:159], v[72:75]
    v_permlane16_swap_b32 v49, v108
    v_mfma_f32_16x16x32_bf16 v[64:67], a[228:231], a[132:135], v[64:67]
    v_add_f32 v49, v49, v108
    v_add_f32 v50, v50, v110
    v_rcp_f32 v50, v50
    v_mfma_f32_16x16x32_bf16 v[64:67], a[232:235], a[136:139], v[64:67]
    v_add_f32 v94, v109, v46
    v_mov_b32 v108, v49
    v_mfma_f32_16x16x32_bf16 v[64:67], a[236:239], a[140:143], v[64:67]
    ds_read_b64_tr_b16 a[224:225], v4 offset:18432
    v_permlane32_swap_b32 v49, v108
    v_mfma_f32_16x16x32_bf16 v[56:59], a[236:239], a[116:119], v[56:59]
    ds_read_b64_tr_b16 a[226:227], v4 offset:12288
    v_add_f32 v92, v108, v45
    v_add_f32 v48, v49, v47
    v_rcp_f32 v94, v94
    v_add_f32 v100, v51, v111
    v_rcp_f32 v100, v100
    v_mfma_f32_16x16x32_bf16 v[56:59], a[232:235], a[112:115], v[56:59]
    s_add_u32 s20, s20, 12032
    v_rcp_f32 v92, v92
    v_mfma_f32_16x16x32_bf16 v[56:59], a[228:231], a[108:111], v[56:59]
    s_waitcnt lgkmcnt(2)
    ds_read_b64_tr_b16 a[228:229], v5 offset:18432
    ds_read_b64_tr_b16 a[230:231], v5 offset:12288
    v_rcp_f32 v48, v48
    v_mfma_f32_16x16x32_bf16 v[112:115], a[216:219], v[16:19], v[112:115]
    ds_read_b64_tr_b16 a[236:237], v3 offset:19456
    v_max3_f32 v99, v76, v77, v78
    v_mfma_f32_16x16x32_bf16 v[116:119], a[220:223], v[16:19], v[116:119]
    v_max3_f32 v98, v68, v69, v70
    v_max3_f32 v98, v98, v71, v72
    v_mfma_f32_16x16x32_bf16 v[164:167], a[220:223], v[20:23], v[164:167]
    v_max3_f32 v96, v52, v53, v54
    v_max3_f32 v97, v60, v61, v62
    v_mfma_f32_16x16x32_bf16 v[160:163], a[216:219], v[20:23], v[160:163]
    v_max3_f32 v96, v96, v55, v56
    v_max3_f32 v97, v97, v63, v64
    v_mfma_f32_16x16x32_bf16 v[208:211], a[216:219], v[28:31], v[208:211]
    s_mov_b32 s67, s34
    ds_read_b64_tr_b16 a[232:233], v2 offset:19456
    v_max3_f32 v99, v99, v79, v80
    v_mfma_f32_16x16x32_bf16 v[212:215], a[220:223], v[28:31], v[212:215]
    v_mov_b32 v39, v7
    v_max3_f32 v96, v96, v57, v58
    v_mfma_f32_16x16x32_bf16 a[4:7], a[220:223], v[32:35], a[4:7]
    s_add_u32 s18, s34, 30720
    v_max3_f32 v97, v97, v65, v66
    v_max3_f32 v98, v98, v73, v74
    v_mfma_f32_16x16x32_bf16 a[0:3], a[216:219], v[32:35], a[0:3]
    s_mov_b32 s34, s33
    ds_read_b64_tr_b16 a[234:235], v2 offset:13312
    v_max_f32 v98, v98, v75
    v_mfma_f32_16x16x32_bf16 a[48:51], a[216:219], v[40:43], a[48:51]
    ds_read_b64_tr_b16 a[238:239], v3 offset:13312
    v_max3_f32 v99, v99, v81, v82
    v_mfma_f32_16x16x32_bf16 a[52:55], a[220:223], v[40:43], a[52:55]
    s_waitcnt lgkmcnt(4)
    v_max_f32 v96, v96, v59
    v_max_f32 v97, v97, v67
    v_mfma_f32_16x16x32_bf16 a[56:59], a[224:227], v[40:43], a[56:59]
    s_add_u32 s64, s64, s62
    v_accvgpr_read_b32 v105, a1
    v_max_f32 v99, v99, v83
    v_mfma_f32_16x16x32_bf16 a[60:63], a[228:231], v[40:43], a[60:63]
    s_add_u32 s64, s64, 196608
    v_permlane32_swap_b32 v96, v97
    v_accvgpr_read_b32 v109, a49
    v_permlane32_swap_b32 v98, v99
    v_pk_mul_f32 v[160:161], v[160:161], v[92:93] op_sel_hi:[1,0]
    v_max_f32 v96, v96, v97
    v_max_f32 v98, v98, v99
    v_mfma_f32_16x16x32_bf16 a[12:15], a[228:231], v[32:35], a[12:15]
    s_mov_b32 s39, s64
    v_permlane16_swap_b32 v96, v98
    v_mfma_f32_16x16x32_bf16 a[8:11], a[224:227], v[32:35], a[8:11]
    s_add_u32 s37, s37, 1
    ds_read_b64_tr_b16 a[216:217], v4 offset:19456
    v_max_f32 v96, v96, v98
    v_mfma_f32_16x16x32_bf16 v[216:219], a[224:227], v[28:31], v[216:219]
    s_bitcmp1_b32 s63, s37
    ds_read_b64_tr_b16 a[222:223], v5 offset:13312
    v_mul_f32_e64 v9, -s28, v96
    v_mfma_f32_16x16x32_bf16 v[220:223], a[228:231], v[28:31], v[220:223]
    s_cselect_b32 s62, 4294770688, 0
    v_subrev_f32 v9, 0x42000000, v9
    v_accvgpr_read_b32 v106, a2
    v_mfma_f32_16x16x32_bf16 v[172:175], a[228:231], v[20:23], v[172:175]
    s_cselect_b32 s42, 0, 325632
    ds_read_b64_tr_b16 a[218:219], v4 offset:13312
    v_mov_b32 v11, v9
    v_mfma_f32_16x16x32_bf16 v[168:171], a[224:227], v[20:23], v[168:171]
    s_nop 0
    v_permlane16_swap_b32 v9, v11
    v_mfma_f32_16x16x32_bf16 v[120:123], a[224:227], v[16:19], v[120:123]
    s_add_u32 s35, s35, s42
    ds_read_b64_tr_b16 a[220:221], v5 offset:19456
    v_mov_b32 v10, v9
    v_mfma_f32_16x16x32_bf16 v[124:127], a[228:231], v[16:19], v[124:127]
    s_waitcnt lgkmcnt(4)
    ds_read_b64_tr_b16 a[228:229], v3 offset:20480
    v_mov_b32 v12, v11
    v_mfma_f32_16x16x32_bf16 v[128:131], a[232:235], v[16:19], v[128:131]
    s_lshl_b32 s42, s37, 1
    v_permlane32_swap_b32 v9, v10
    v_cvt_pk_bf16_f32 v160, v160, v161
    v_mfma_f32_16x16x32_bf16 v[132:135], a[236:239], v[16:19], v[132:135]
    v_mov_b32 v51, 0
    v_fma_f32 v62, v62, s28, v10
    v_accvgpr_read_b32 v110, a50
    v_mfma_f32_16x16x32_bf16 v[180:183], a[236:239], v[20:23], v[180:183]
    s_lshr_b32 s42, s31, s42
    ds_read_b64_tr_b16 a[224:225], v2 offset:20480
    v_fma_f32 v61, v61, s28, v10
    v_mfma_f32_16x16x32_bf16 v[176:179], a[232:235], v[20:23], v[176:179]
    s_and_b32 s42, s42, 3
    v_permlane32_swap_b32 v11, v12
    v_mfma_f32_16x16x32_bf16 v[224:227], a[232:235], v[28:31], v[224:227]
    s_add_u32 s42, s42, s36
    v_fma_f32 v63, v63, s28, v10
    v_fma_f32 v78, v78, s28, v12
    v_mfma_f32_16x16x32_bf16 v[228:231], a[236:239], v[28:31], v[228:231]
    s_sub_u32 s43, s42, 3
    v_fma_f32 v69, v69, s28, v11
    v_fma_f32 v66, v66, s28, v10
    v_mfma_f32_16x16x32_bf16 a[20:23], a[236:239], v[32:35], a[20:23]
    s_cmp_ge_u32 s42, 3
    ds_read_b64_tr_b16 a[230:231], v3 offset:14336
    v_fma_f32 v55, v55, s28, v9
    v_fma_f32 v65, v65, s28, v10
    v_fma_f32 v75, v75, s28, v11
    v_mfma_f32_16x16x32_bf16 a[16:19], a[232:235], v[32:35], a[16:19]
    s_cselect_b32 s42, s43, s42
    ds_read_b64_tr_b16 a[226:227], v2 offset:14336
    v_fma_f32 v68, v68, s28, v11
    v_mfma_f32_16x16x32_bf16 a[64:67], a[232:235], v[40:43], a[64:67]
    s_mul_i32 s44, s3, 5
    v_fma_f32 v53, v53, s28, v9
    v_fma_f32 v79, v79, s28, v12
    v_mfma_f32_16x16x32_bf16 a[68:71], a[236:239], v[40:43], a[68:71]
    s_waitcnt lgkmcnt(3)
    v_exp_f32_e64 v55, v55 clamp
    v_fma_f32 v72, v72, s28, v11
    v_mfma_f32_16x16x32_bf16 a[72:75], a[216:219], v[40:43], a[72:75]
    s_mov_b32 s32, 1
    v_fma_f32 v70, v70, s28, v11
    v_mov_b32 v38, v6
    v_fma_f32 v77, v77, s28, v12
    v_mfma_f32_16x16x32_bf16 a[76:79], a[220:223], v[40:43], a[76:79]
    s_lshl_b32 s43, s3, 2
    s_add_u32 s45, s43, 21
    v_accvgpr_read_b32 v104, a0
    v_fma_f32 v67, v67, s28, v10
    v_mfma_f32_16x16x32_bf16 a[28:31], a[220:223], v[32:35], a[28:31]
    s_cmp_eq_u32 s3, 0
    v_fma_f32 v81, v81, s28, v12
    v_fma_f32 v52, v52, s28, v9
    v_mfma_f32_16x16x32_bf16 a[24:27], a[216:219], v[32:35], a[24:27]
    s_cselect_b32 s45, 20, s45
    s_cselect_b32 s33, 1, 0
    ds_read_b64_tr_b16 a[232:233], v4 offset:20480
    v_mfma_f32_16x16x32_bf16 v[232:235], a[216:219], v[28:31], v[232:235]
    s_cmp_eq_u32 s42, 1
    ds_read_b64_tr_b16 a[234:235], v4 offset:14336
    v_fma_f32 v59, v59, s28, v9
    v_mfma_f32_16x16x32_bf16 v[236:239], a[220:223], v[28:31], v[236:239]
    s_cselect_b32 s44, s45, s44
    ds_read_b64_tr_b16 a[238:239], v5 offset:14336
    v_fma_f32 v54, v54, s28, v9
    v_mfma_f32_16x16x32_bf16 v[188:191], a[220:223], v[20:23], v[188:191]
    s_cselect_b32 s32, s33, s32
    v_exp_f32_e64 v66, v66 clamp
    v_mfma_f32_16x16x32_bf16 v[184:187], a[216:219], v[20:23], v[184:187]
    s_add_u32 s45, s43, 37
    ds_read_b64_tr_b16 a[236:237], v5 offset:20480
    s_cmp_eq_u32 s42, 2
    v_mfma_f32_16x16x32_bf16 v[136:139], a[216:219], v[16:19], v[136:139]
    s_cselect_b32 s44, s45, s44
    v_fma_f32 v74, v74, s28, v11
    v_fma_f32 v60, v60, s28, v10
    v_mfma_f32_16x16x32_bf16 v[140:143], a[220:223], v[16:19], v[140:143]
    s_waitcnt lgkmcnt(4)
    v_fma_f32 v57, v57, s28, v9
    s_cselect_b32 s32, 0, s32
    v_mfma_f32_16x16x32_bf16 v[144:147], a[224:227], v[16:19], v[144:147]
    s_mul_i32 s44, s44, 6144
    v_exp_f32_e64 v52, v52 clamp
    v_mfma_f32_16x16x32_bf16 v[148:151], a[228:231], v[16:19], v[148:151]
    s_add_u32 s33, s35, s44
    v_exp_f32_e64 v60, v60 clamp
    v_mfma_f32_16x16x32_bf16 v[196:199], a[228:231], v[20:23], v[196:199]
    s_mul_i32 s42, s32, 6144
    v_exp_f32_e64 v57, v57 clamp
    v_mfma_f32_16x16x32_bf16 v[192:195], a[224:227], v[20:23], v[192:195]
    s_add_u32 s42, s42, 24576
    v_fma_f32 v64, v64, s28, v10
    v_fma_f32 v83, v83, s28, v12
    v_mfma_f32_16x16x32_bf16 v[240:243], a[224:227], v[28:31], v[240:243]
    s_add_u32 s42, s42, s33
    v_exp_f32_e64 v53, v53 clamp
    v_mfma_f32_16x16x32_bf16 v[244:247], a[228:231], v[28:31], v[244:247]
    s_cmp_ge_u32 s37, 6
    v_exp_f32_e64 v64, v64 clamp
    v_mfma_f32_16x16x32_bf16 a[36:39], a[228:231], v[32:35], a[36:39]
    s_cselect_b32 s14, 0, s42
    s_add_u32 s24, s67, 6144
    v_fma_f32 v71, v71, s28, v11
    s_add_u32 s25, s33, 6144
    v_mfma_f32_16x16x32_bf16 a[32:35], a[224:227], v[32:35], a[32:35]
    s_add_u32 s23, s38, 6144
    v_exp_f32_e64 v54, v54 clamp
    v_mfma_f32_16x16x32_bf16 a[80:83], a[224:227], v[40:43], a[80:83]
    s_mov_b32 s27, 0x30c30
    v_fma_f32 v80, v80, s28, v12
    v_fma_f32 v56, v56, s28, v9
    v_mfma_f32_16x16x32_bf16 a[84:87], a[228:231], v[40:43], a[84:87]
    s_waitcnt lgkmcnt(0)
    v_exp_f32_e64 v79, v79 clamp
    v_mfma_f32_16x16x32_bf16 a[88:91], a[232:235], v[40:43], a[88:91]
    s_mov_b32 s89, 0xaaaaaaaa
    v_exp_f32_e64 v74, v74 clamp
    v_mfma_f32_16x16x32_bf16 a[92:95], a[236:239], v[40:43], a[92:95]
    s_mov_b32 s30, 0
    s_waitcnt vmcnt(6)
    v_fma_f32 v58, v58, s28, v9
    v_mfma_f32_16x16x32_bf16 a[44:47], a[236:239], v[32:35], a[44:47]
    s_barrier
    ds_read_b128 a[216:219], v0 offset:12288
    v_mfma_f32_16x16x32_bf16 a[40:43], a[232:235], v[32:35], a[40:43]
    ds_read_b128 a[220:223], v1 offset:12288
    v_exp_f32_e64 v78, v78 clamp
    v_mfma_f32_16x16x32_bf16 v[248:251], a[232:235], v[28:31], v[248:251]
    ds_read_b128 a[224:227], v0 offset:13312
    v_fma_f32 v73, v73, s28, v11
    v_mfma_f32_16x16x32_bf16 v[252:255], a[236:239], v[28:31], v[252:255]
    v_exp_f32_e64 v69, v69 clamp
    v_mfma_f32_16x16x32_bf16 v[204:207], a[236:239], v[20:23], v[204:207]
    v_exp_f32_e64 v68, v68 clamp
    v_mfma_f32_16x16x32_bf16 v[200:203], a[232:235], v[20:23], v[200:203]
    v_fma_f32 v76, v76, s28, v12
    v_exp_f32_e64 v62, v62 clamp
    v_exp_f32_e64 v61, v61 clamp
    v_exp_f32_e64 v56, v56 clamp
    v_pk_mul_f32 v[122:123], v[122:123], v[48:49] op_sel_hi:[1,0]
    v_cvt_pk_bf16_f32 v14, v52, v53
    v_pk_mul_f32 v[182:183], v[182:183], v[92:93] op_sel_hi:[1,0]
    v_cvt_pk_bf16_f32 v26, v68, v69
    v_exp_f32_e64 v63, v63 clamp
    v_cvt_pk_bf16_f32 v15, v54, v55
    v_pk_mul_f32 v[112:113], v[112:113], v[48:49] op_sel_hi:[1,0]
    v_pk_mul_f32 v[116:117], v[116:117], v[48:49] op_sel_hi:[1,0]
    v_accvgpr_read_b32 v111, a51
    v_fma_f32 v82, v82, s28, v12
    v_exp_f32_e64 v70, v70 clamp
    v_mfma_f32_16x16x32_bf16 v[152:155], a[232:235], v[16:19], v[152:155]
    s_add_u32 m0, s22, 36864
    v_cvt_pk_bf16_f32 v35, v78, v79
    v_cvt_pk_bf16_f32 v22, v60, v61
    v_mfma_f32_16x16x32_bf16 v[156:159], a[236:239], v[16:19], v[156:159]
    s_waitcnt lgkmcnt(1)
    ds_read_b128 a[236:239], v1 offset:14336
    v_cvt_pk_bf16_f32 v23, v62, v63
    v_mfma_f32_16x16x32_bf16 v[52:55], a[216:219], a[96:99], 0
    v_exp_f32_e64 v71, v71 clamp
    v_mfma_f32_16x16x32_bf16 v[52:55], a[220:223], a[100:103], v[52:55]
    s_waitcnt lgkmcnt(1)
    ds_read_b128 a[228:231], v1 offset:13312
    v_exp_f32_e64 v77, v77 clamp
    v_mfma_f32_16x16x32_bf16 v[52:55], a[224:227], a[104:107], v[52:55]
    ds_read_b128 a[232:235], v0 offset:14336
    v_cvt_pk_bf16_f32 v27, v70, v71
    v_mfma_f32_16x16x32_bf16 v[60:63], a[224:227], a[128:131], 0
    v_exp_f32_e64 v65, v65 clamp
    v_mfma_f32_16x16x32_bf16 v[60:63], a[220:223], a[124:127], v[60:63]
    v_exp_f32_e64 v73, v73 clamp
    v_mfma_f32_16x16x32_bf16 v[60:63], a[216:219], a[120:123], v[60:63]
    v_exp_f32_e64 v59, v59 clamp
    v_mfma_f32_16x16x32_bf16 v[68:71], a[216:219], a[144:147], 0
    v_exp_f32_e64 v76, v76 clamp
    v_mfma_f32_16x16x32_bf16 v[68:71], a[220:223], a[148:151], v[68:71]
    v_exp_f32_e64 v72, v72 clamp
    v_mfma_f32_16x16x32_bf16 v[68:71], a[224:227], a[152:155], v[68:71]
    v_accvgpr_read_b32 v108, a48
    v_cvt_pk_bf16_f32 v34, v76, v77
    v_mfma_f32_16x16x32_bf16 v[76:79], a[224:227], a[176:179], 0
    buffer_load_dwordx4 v6, s[8:11], s21 offen lds
    v_mfma_f32_16x16x32_bf16 v[76:79], a[220:223], a[172:175], v[76:79]
    v_exp_f32_e64 v82, v82 clamp
    v_mfma_f32_16x16x32_bf16 v[76:79], a[216:219], a[168:171], v[76:79]
    s_waitcnt lgkmcnt(1)
    ds_read_b128 a[224:227], v0 offset:19456
    v_exp_f32_e64 v80, v80 clamp
    v_mfma_f32_16x16x32_bf16 v[76:79], a[228:231], a[180:183], v[76:79]
    s_waitcnt lgkmcnt(1)
    v_exp_f32_e64 v67, v67 clamp
    v_mfma_f32_16x16x32_bf16 v[76:79], a[232:235], a[184:187], v[76:79]
    v_cvt_pk_bf16_f32 v16, v56, v57
    v_cvt_pk_bf16_f32 v116, v116, v117
    v_mfma_f32_16x16x32_bf16 v[76:79], a[236:239], a[188:191], v[76:79]
    s_add_u32 s21, s21, 128
    v_exp_f32_e64 v58, v58 clamp
    v_mfma_f32_16x16x32_bf16 v[68:71], a[236:239], a[164:167], v[68:71]
    v_exp_f32_e64 v75, v75 clamp
    v_mfma_f32_16x16x32_bf16 v[68:71], a[232:235], a[160:163], v[68:71]
    s_add_u32 m0, s22, 37888
    ds_read_b128 a[216:219], v0 offset:18432
    v_cvt_pk_bf16_f32 v28, v72, v73
    v_mfma_f32_16x16x32_bf16 v[68:71], a[228:231], a[156:159], v[68:71]
    v_exp_f32_e64 v81, v81 clamp
    v_mfma_f32_16x16x32_bf16 v[60:63], a[228:231], a[132:135], v[60:63]
    v_exp_f32_e64 v83, v83 clamp
    v_mfma_f32_16x16x32_bf16 v[60:63], a[232:235], a[136:139], v[60:63]
    v_accvgpr_read_b32 v107, a3
    v_cvt_pk_bf16_f32 v25, v66, v67
    v_fma_f32 v79, v79, s28, v12
    v_mfma_f32_16x16x32_bf16 v[60:63], a[236:239], a[140:143], v[60:63]
    buffer_load_dwordx4 v6, s[8:11], s21 offen lds
    v_mfma_f32_16x16x32_bf16 v[52:55], a[236:239], a[116:119], v[52:55]
    s_add_u32 s21, s21, 128
    ds_read_b128 a[220:223], v1 offset:18432
    v_cvt_pk_bf16_f32 v24, v64, v65
    v_cvt_pk_bf16_f32 v36, v80, v81
    v_mfma_f32_16x16x32_bf16 v[52:55], a[232:235], a[112:115], v[52:55]
    v_cvt_pk_bf16_f32 v29, v74, v75
    v_cvt_pk_bf16_f32 v112, v112, v113
    v_exp_f32_e64 v79, v79 clamp
    v_fma_f32 v78, v78, s28, v12
    v_pk_mul_f32 v[118:119], v[118:119], v[48:49] op_sel_hi:[1,0]
    v_pk_mul_f32 v[232:233], v[232:233], v[50:51] op_sel_hi:[1,0]
    v_pk_mul_f32 v[128:129], v[128:129], v[48:49] op_sel_hi:[1,0]
    v_pk_mul_f32 v[138:139], v[138:139], v[48:49] op_sel_hi:[1,0]
    v_pk_mul_f32 v[136:137], v[136:137], v[48:49] op_sel_hi:[1,0]
    v_pk_mul_f32 v[180:181], v[180:181], v[92:93] op_sel_hi:[1,0]
    v_pk_mul_f32 v[168:169], v[168:169], v[92:93] op_sel_hi:[1,0]
    v_pk_mul_f32 v[224:225], v[224:225], v[50:51] op_sel_hi:[1,0]
    v_pk_mul_f32 v[240:241], v[240:241], v[50:51] op_sel_hi:[1,0]
    v_pk_mul_f32 v[110:111], v[110:111], v[100:101] op_sel_hi:[1,0]
    v_pk_mul_f32 v[220:221], v[220:221], v[50:51] op_sel_hi:[1,0]
    v_cvt_pk_bf16_f32 v17, v58, v59
    v_pk_mul_f32 v[104:105], v[104:105], v[94:95] op_sel_hi:[1,0]
    v_pk_mul_f32 v[212:213], v[212:213], v[50:51] op_sel_hi:[1,0]
    v_pk_mul_f32 v[184:185], v[184:185], v[92:93] op_sel_hi:[1,0]
    v_pk_mul_f32 v[114:115], v[114:115], v[48:49] op_sel_hi:[1,0]
    v_pk_mul_f32 v[108:109], v[108:109], v[100:101] op_sel_hi:[1,0]
    v_pk_mul_f32 v[178:179], v[178:179], v[92:93] op_sel_hi:[1,0]
    v_pk_mul_f32 v[208:209], v[208:209], v[50:51] op_sel_hi:[1,0]
    v_pk_mul_f32 v[174:175], v[174:175], v[92:93] op_sel_hi:[1,0]
    v_pk_mul_f32 v[216:217], v[216:217], v[50:51] op_sel_hi:[1,0]
    v_pk_mul_f32 v[106:107], v[106:107], v[94:95] op_sel_hi:[1,0]
    v_pk_mul_f32 v[164:165], v[164:165], v[92:93] op_sel_hi:[1,0]
    v_pk_mul_f32 v[242:243], v[242:243], v[50:51] op_sel_hi:[1,0]
    v_cvt_pk_bf16_f32 v113, v114, v115
    v_pk_mul_f32 v[172:173], v[172:173], v[92:93] op_sel_hi:[1,0]
    v_pk_mul_f32 v[228:229], v[228:229], v[50:51] op_sel_hi:[1,0]
    v_pk_mul_f32 v[132:133], v[132:133], v[48:49] op_sel_hi:[1,0]
    v_pk_mul_f32 v[144:145], v[144:145], v[48:49] op_sel_hi:[1,0]
    v_pk_mul_f32 v[124:125], v[124:125], v[48:49] op_sel_hi:[1,0]
    v_pk_mul_f32 v[214:215], v[214:215], v[50:51] op_sel_hi:[1,0]
    v_pk_mul_f32 v[226:227], v[226:227], v[50:51] op_sel_hi:[1,0]
    v_pk_mul_f32 v[134:135], v[134:135], v[48:49] op_sel_hi:[1,0]
    v_pk_mul_f32 v[210:211], v[210:211], v[50:51] op_sel_hi:[1,0]
    v_pk_mul_f32 v[166:167], v[166:167], v[92:93] op_sel_hi:[1,0]
    v_pk_mul_f32 v[162:163], v[162:163], v[92:93] op_sel_hi:[1,0]
    v_cvt_pk_bf16_f32 v208, v208, v209
    v_cvt_pk_bf16_f32 v37, v82, v83
    v_mfma_f32_16x16x32_bf16 v[52:55], a[228:231], a[108:111], v[52:55]
    s_waitcnt lgkmcnt(0)
    v_cvt_pk_bf16_f32 v108, v108, v109
    v_fma_f32 v61, v61, s28, v10
    v_mfma_f32_16x16x32_bf16 v[56:59], a[216:219], a[96:99], 0
    ds_read_b128 a[228:231], v1 offset:19456
    v_cvt_pk_bf16_f32 v216, v216, v217
    v_mfma_f32_16x16x32_bf16 v[56:59], a[220:223], a[100:103], v[56:59]
    ds_read_b128 a[232:235], v0 offset:20480
    v_cvt_pk_bf16_f32 v168, v168, v169
    v_mfma_f32_16x16x32_bf16 v[56:59], a[224:227], a[104:107], v[56:59]
    s_add_u32 m0, s22, 38912
    ds_read_b128 a[236:239], v1 offset:20480
    v_fma_f32 v69, v69, s28, v11
    v_fma_f32 v63, v63, s28, v10
    v_cvt_pk_bf16_f32 v104, v104, v105
    v_mfma_f32_16x16x32_bf16 v[64:67], a[224:227], a[128:131], 0
    v_cvt_pk_bf16_f32 v117, v118, v119
    v_fma_f32 v52, v52, s28, v9
    v_mfma_f32_16x16x32_bf16 v[64:67], a[220:223], a[124:127], v[64:67]
    buffer_load_dwordx4 v6, s[8:11], s21 offen lds
    v_fma_f32 v70, v70, s28, v11
    v_cvt_pk_bf16_f32 v105, v106, v107
    v_mfma_f32_16x16x32_bf16 v[44:47], a[248:251], v[14:17], 0
    v_cvt_pk_bf16_f32 v209, v210, v211
    v_cvt_pk_bf16_f32 v161, v162, v163
    v_mfma_f32_16x16x32_bf16 v[64:67], a[216:219], a[120:123], v[64:67]
    v_accvgpr_read_b32 v106, a6
    v_cvt_pk_bf16_f32 v164, v164, v165
    v_mfma_f32_16x16x32_bf16 v[72:75], a[216:219], a[144:147], 0
    v_cvt_pk_bf16_f32 v212, v212, v213
    v_fma_f32 v71, v71, s28, v11
    v_mfma_f32_16x16x32_bf16 v[72:75], a[220:223], a[148:151], v[72:75]
    v_cvt_pk_bf16_f32 v232, v232, v233
    v_fma_f32 v76, v76, s28, v12
    v_cvt_pk_bf16_f32 v165, v166, v167
    v_mfma_f32_16x16x32_bf16 v[72:75], a[224:227], a[152:155], v[72:75]
    s_add_u32 s21, s21, 12032
    ds_write2st64_b64 v93, v[112:113], v[160:161] offset0:0 offset1:12
    v_mfma_f32_16x16x32_bf16 v[80:83], a[224:227], a[176:179], 0
    s_waitcnt vmcnt(6) lgkmcnt(1)
    v_exp_f32_e64 v69, v69 clamp
    v_mfma_f32_16x16x32_bf16 v[80:83], a[220:223], a[172:175], v[80:83]
    s_barrier
    v_mfma_f32_16x16x32_bf16 v[80:83], a[216:219], a[168:171], v[80:83]
    v_fma_f32 v60, v60, s28, v10
    v_exp_f32_e64 v71, v71 clamp
    v_mfma_f32_16x16x32_bf16 v[80:83], a[228:231], a[180:183], v[80:83]
    ds_read_b64_tr_b16 a[216:217], v2 offset:0
    v_cvt_pk_bf16_f32 v240, v240, v241
    v_mfma_f32_16x16x32_bf16 v[80:83], a[232:235], a[184:187], v[80:83]
    ds_write2st64_b64 v93, v[208:209], v[104:105] offset0:24 offset1:36
    v_mfma_f32_16x16x32_bf16 v[80:83], a[236:239], a[188:191], v[80:83]
    v_cvt_pk_bf16_f32 v109, v110, v111
    v_fma_f32 v68, v68, s28, v11
    v_mfma_f32_16x16x32_bf16 v[72:75], a[236:239], a[164:167], v[72:75]
    v_accvgpr_read_b32 v107, a7
    v_cvt_pk_bf16_f32 v213, v214, v215
    v_mfma_f32_16x16x32_bf16 v[72:75], a[232:235], a[160:163], v[72:75]
    s_add_u32 m0, s22, 12288
    ds_read_b64_tr_b16 a[218:219], v2 offset:6144
    v_fma_f32 v62, v62, s28, v10
    v_smfmac_f32_16x16x64_bf16 v[44:47], a[240:243], v[22:29], v101
    buffer_load_dwordx4 v6, s[4:7], s20 offen lds
    v_mfma_f32_16x16x32_bf16 v[72:75], a[228:231], a[156:159], v[72:75]
    ds_write_b64 v93, v[108:109] offset:24576
    v_xor_b32 v93, 32, v93
    v_mfma_f32_16x16x32_bf16 v[64:67], a[228:231], a[132:135], v[64:67]
    v_accvgpr_read_b32 v111, a55
    v_cvt_pk_bf16_f32 v172, v172, v173
    v_exp_f32_e64 v52, v52 clamp
    v_fma_f32 v81, v81, s28, v12
    v_mfma_f32_16x16x32_bf16 v[64:67], a[232:235], a[136:139], v[64:67]
    ds_read_b64_tr_b16 a[220:221], v3 offset:0
    v_cvt_pk_bf16_f32 v224, v224, v225
    v_mfma_f32_16x16x32_bf16 v[44:47], a[252:255], v[34:37], v[44:47]
    v_fma_f32 v53, v53, s28, v9
    v_accvgpr_read_b32 v109, a53
    v_accvgpr_read_b32 v108, a52
    v_accvgpr_read_b32 v104, a4
    v_mfma_f32_16x16x32_bf16 v[64:67], a[236:239], a[140:143], v[64:67]
    ds_read_b64_tr_b16 a[222:223], v3 offset:6144
    v_cvt_pk_bf16_f32 v228, v228, v229
    v_mfma_f32_16x16x32_bf16 v[56:59], a[236:239], a[116:119], v[56:59]
    ds_read_b64_tr_b16 a[224:225], v4 offset:0
    v_fma_f32 v80, v80, s28, v12
    v_mfma_f32_16x16x32_bf16 v[56:59], a[232:235], a[112:115], v[56:59]
    s_add_u32 s20, s20, 128
    v_fma_f32 v83, v83, s28, v12
    v_accvgpr_read_b32 v105, a5
    v_mfma_f32_16x16x32_bf16 v[56:59], a[228:231], a[108:111], v[56:59]
    s_waitcnt lgkmcnt(4)
    ds_read_b64_tr_b16 a[226:227], v4 offset:6144
    v_cvt_pk_bf16_f32 v144, v144, v145
    v_mfma_f32_16x16x32_bf16 v[112:115], a[216:219], v[14:17], 0
    ds_read_b64_tr_b16 a[234:235], v2 offset:7168
    v_exp_f32_e64 v70, v70 clamp
    v_cvt_pk_bf16_f32 v184, v184, v185
    v_subrev_u32 v103, 28672, v103
    v_pk_mul_f32 v[218:219], v[218:219], v[50:51] op_sel_hi:[1,0]
    v_pk_mul_f32 v[120:121], v[120:121], v[48:49] op_sel_hi:[1,0]
    v_pk_mul_f32 v[140:141], v[140:141], v[48:49] op_sel_hi:[1,0]
    v_pk_mul_f32 v[104:105], v[104:105], v[94:95] op_sel_hi:[1,0]
    v_pk_mul_f32 v[108:109], v[108:109], v[100:101] op_sel_hi:[1,0]
    v_cvt_pk_bf16_f32 v104, v104, v105
    v_cvt_pk_bf16_f32 v120, v120, v121
    v_mfma_f32_16x16x32_bf16 v[160:163], a[216:219], v[22:25], 0
    ds_read_b64_tr_b16 a[228:229], v5 offset:0
    v_fma_f32 v74, v74, s28, v11
    v_mfma_f32_16x16x32_bf16 v[208:211], a[216:219], v[26:29], 0
    s_add_u32 m0, s22, 13312
    ds_write2st64_b64 v93, v[116:117], v[164:165] offset0:0 offset1:12
    v_pk_mul_f32 v[106:107], v[106:107], v[94:95] op_sel_hi:[1,0]
    v_accvgpr_read_b32 v110, a54
    v_pk_mul_f32 v[110:111], v[110:111], v[100:101] op_sel_hi:[1,0]
    v_cvt_pk_bf16_f32 v108, v108, v109
    v_pk_mul_f32 v[222:223], v[222:223], v[50:51] op_sel_hi:[1,0]
    v_pk_mul_f32 v[146:147], v[146:147], v[48:49] op_sel_hi:[1,0]
    v_fma_f32 v57, v57, s28, v9
    v_fma_f32 v73, v73, s28, v11
    v_pk_mul_f32 v[192:193], v[192:193], v[92:93] op_sel_hi:[1,0]
    v_pk_mul_f32 v[170:171], v[170:171], v[92:93] op_sel_hi:[1,0]
    v_cvt_pk_bf16_f32 v105, v106, v107
    v_cvt_pk_bf16_f32 v109, v110, v111
    v_exp_f32_e64 v80, v80 clamp
    v_cvt_pk_bf16_f32 v241, v242, v243
    v_cvt_pk_bf16_f32 v180, v180, v181
    v_mfma_f32_16x16x32_bf16 a[0:3], a[216:219], v[34:37], 0
    s_waitcnt lgkmcnt(2)
    ds_write2st64_b64 v93, v[212:213], v[104:105] offset0:24 offset1:36
    v_mfma_f32_16x16x32_bf16 a[4:7], a[220:223], v[34:37], 0
    buffer_load_dwordx4 v6, s[4:7], s20 offen lds
    ds_write_b64 v93, v[108:109] offset:24576
    v_cvt_pk_bf16_f32 v121, v122, v123
    v_accvgpr_read_b32 v105, a9
    v_cvt_pk_bf16_f32 v124, v124, v125
    v_mfma_f32_16x16x32_bf16 v[212:215], a[220:223], v[26:29], 0
    ds_read_b64_tr_b16 a[230:231], v5 offset:6144
    ds_read_b64_tr_b16 a[236:237], v3 offset:1024
    v_fma_f32 v55, v55, s28, v9
    v_cvt_pk_bf16_f32 v173, v174, v175
    v_exp_f32_e64 v83, v83 clamp
    v_accvgpr_read_b32 v107, a11
    v_cvt_pk_bf16_f32 v220, v220, v221
    v_accvgpr_read_b32 v104, a8
    v_cvt_pk_bf16_f32 v217, v218, v219
    v_xor_b32 v93, 96, v93
    v_fma_f32 v82, v82, s28, v12
    v_accvgpr_read_b32 v108, a56
    v_pk_mul_f32 v[152:153], v[152:153], v[48:49] op_sel_hi:[1,0]
    v_fma_f32 v54, v54, s28, v9
    v_pk_mul_f32 v[190:191], v[190:191], v[92:93] op_sel_hi:[1,0]
    v_accvgpr_read_b32 v106, a10
    v_pk_mul_f32 v[236:237], v[236:237], v[50:51] op_sel_hi:[1,0]
    v_pk_mul_f32 v[176:177], v[176:177], v[92:93] op_sel_hi:[1,0]
    v_pk_mul_f32 v[252:253], v[252:253], v[50:51] op_sel_hi:[1,0]
    v_exp_f32_e64 v76, v76 clamp
    v_cvt_pk_bf16_f32 v128, v128, v129
    v_accvgpr_read_b32 v110, a58
    v_pk_mul_f32 v[202:203], v[202:203], v[92:93] op_sel_hi:[1,0]
    v_pk_mul_f32 v[158:159], v[158:159], v[48:49] op_sel_hi:[1,0]
    v_pk_mul_f32 v[126:127], v[126:127], v[48:49] op_sel_hi:[1,0]
    v_fma_f32 v66, v66, s28, v10
    v_pk_mul_f32 v[230:231], v[230:231], v[50:51] op_sel_hi:[1,0]
    v_accvgpr_read_b32 v111, a59
    v_pk_mul_f32 v[238:239], v[238:239], v[50:51] op_sel_hi:[1,0]
    v_pk_mul_f32 v[154:155], v[154:155], v[48:49] op_sel_hi:[1,0]
    v_cvt_pk_bf16_f32 v169, v170, v171
    v_pk_mul_f32 v[248:249], v[248:249], v[50:51] op_sel_hi:[1,0]
    v_pk_mul_f32 v[244:245], v[244:245], v[50:51] op_sel_hi:[1,0]
    v_pk_mul_f32 v[200:201], v[200:201], v[92:93] op_sel_hi:[1,0]
    v_accvgpr_read_b32 v109, a57
    v_pk_mul_f32 v[196:197], v[196:197], v[92:93] op_sel_hi:[1,0]
    v_pk_mul_f32 v[108:109], v[108:109], v[100:101] op_sel_hi:[1,0]
    v_pk_mul_f32 v[130:131], v[130:131], v[48:49] op_sel_hi:[1,0]
    v_pk_mul_f32 v[104:105], v[104:105], v[94:95] op_sel_hi:[1,0]
    v_cvt_pk_bf16_f32 v225, v226, v227
    v_exp_f32_e64 v78, v78 clamp
    v_pk_mul_f32 v[110:111], v[110:111], v[100:101] op_sel_hi:[1,0]
    v_pk_mul_f32 v[254:255], v[254:255], v[50:51] op_sel_hi:[1,0]
    v_pk_mul_f32 v[148:149], v[148:149], v[48:49] op_sel_hi:[1,0]
    v_pk_mul_f32 v[106:107], v[106:107], v[94:95] op_sel_hi:[1,0]
    v_fma_f32 v58, v58, s28, v9
    v_exp_f32_e64 v54, v54 clamp
    v_cvt_pk_bf16_f32 v108, v108, v109
    v_pk_mul_f32 v[186:187], v[186:187], v[92:93] op_sel_hi:[1,0]
    v_cvt_pk_bf16_f32 v136, v136, v137
    v_cvt_pk_bf16_f32 v176, v176, v177
    v_cvt_pk_bf16_f32 v104, v104, v105
    v_cvt_pk_bf16_f32 v200, v200, v201
    v_cvt_pk_bf16_f32 v109, v110, v111
    v_fma_f32 v56, v56, s28, v9
    v_cvt_pk_bf16_f32 v105, v106, v107
    v_mfma_f32_16x16x32_bf16 v[164:167], a[220:223], v[22:25], 0
    ds_write2st64_b64 v93, v[120:121], v[168:169] offset0:0 offset1:12
    v_cvt_pk_bf16_f32 v177, v178, v179
    v_mfma_f32_16x16x32_bf16 v[116:119], a[220:223], v[14:17], 0
    s_add_u32 s20, s20, 128
    ds_write2st64_b64 v93, v[216:217], v[104:105] offset0:24 offset1:36
    v_cvt_pk_bf16_f32 v132, v132, v133
    v_mfma_f32_16x16x32_bf16 v[120:123], a[224:227], v[14:17], 0
    ds_read_b64_tr_b16 a[216:217], v4 offset:1024
    ds_read_b64_tr_b16 a[232:233], v2 offset:1024
    v_cvt_pk_bf16_f32 v152, v152, v153
    v_cvt_pk_bf16_f32 v31, v70, v71
    v_accvgpr_read_b32 v106, a14
    v_accvgpr_read_b32 v111, a63
    v_mfma_f32_16x16x32_bf16 v[168:171], a[224:227], v[22:25], 0
    ds_write_b64 v93, v[108:109] offset:24576
    v_accvgpr_read_b32 v105, a13
    v_cvt_pk_bf16_f32 v192, v192, v193
    v_accvgpr_read_b32 v110, a62
    v_cvt_pk_bf16_f32 v129, v130, v131
    v_accvgpr_read_b32 v104, a12
    v_exp_f32_e64 v56, v56 clamp
    v_exp_f32_e64 v73, v73 clamp
    v_accvgpr_read_b32 v108, a60
    v_xor_b32 v93, 32, v93
    v_pk_mul_f32 v[104:105], v[104:105], v[94:95] op_sel_hi:[1,0]
    v_accvgpr_read_b32 v107, a15
    v_pk_mul_f32 v[234:235], v[234:235], v[50:51] op_sel_hi:[1,0]
    v_pk_mul_f32 v[142:143], v[142:143], v[48:49] op_sel_hi:[1,0]
    v_pk_mul_f32 v[246:247], v[246:247], v[50:51] op_sel_hi:[1,0]
    v_accvgpr_read_b32 v109, a61
    v_pk_mul_f32 v[150:151], v[150:151], v[48:49] op_sel_hi:[1,0]
    v_pk_mul_f32 v[110:111], v[110:111], v[100:101] op_sel_hi:[1,0]
    v_pk_mul_f32 v[108:109], v[108:109], v[100:101] op_sel_hi:[1,0]
    v_cvt_pk_bf16_f32 v252, v252, v253
    v_cvt_pk_bf16_f32 v185, v186, v187
    v_pk_mul_f32 v[106:107], v[106:107], v[94:95] op_sel_hi:[1,0]
    v_cvt_pk_bf16_f32 v125, v126, v127
    v_cvt_pk_bf16_f32 v108, v108, v109
    v_cvt_pk_bf16_f32 v148, v148, v149
    v_mfma_f32_16x16x32_bf16 v[216:219], a[224:227], v[26:29], 0
    ds_write2st64_b64 v93, v[124:125], v[172:173] offset0:0 offset1:12
    v_exp_f32_e64 v53, v53 clamp
    v_cvt_pk_bf16_f32 v109, v110, v111
    v_cvt_pk_bf16_f32 v221, v222, v223
    v_pk_mul_f32 v[194:195], v[194:195], v[92:93] op_sel_hi:[1,0]
    v_cvt_pk_bf16_f32 v104, v104, v105
    v_cvt_pk_bf16_f32 v105, v106, v107
    v_mfma_f32_16x16x32_bf16 a[8:11], a[224:227], v[34:37], 0
    s_waitcnt lgkmcnt(1)
    ds_write2st64_b64 v93, v[220:221], v[104:105] offset0:24 offset1:36
    v_cvt_pk_bf16_f32 v236, v236, v237
    v_mfma_f32_16x16x32_bf16 a[12:15], a[228:231], v[34:37], 0
    ds_write_b64 v93, v[108:109] offset:24576
    v_mov_b32 v49, 0
    v_exp_f32_e64 v74, v74 clamp
    v_xor_b32 v93, 96, v93
    v_mfma_f32_16x16x32_bf16 v[220:223], a[228:231], v[26:29], 0
    ds_read_b64_tr_b16 a[238:239], v3 offset:7168
    ds_read_b64_tr_b16 a[218:219], v4 offset:7168
    v_accvgpr_read_b32 v105, a17
    v_accvgpr_read_b32 v108, a64
    v_accvgpr_read_b32 v109, a65
    v_mfma_f32_16x16x32_bf16 v[172:175], a[228:231], v[22:25], 0
    ds_write2st64_b64 v93, v[128:129], v[176:177] offset0:4 offset1:16
    v_accvgpr_read_b32 v111, a67
    v_accvgpr_read_b32 v106, a18
    v_accvgpr_read_b32 v104, a16
    v_pk_mul_f32 v[108:109], v[108:109], v[100:101] op_sel_hi:[1,0]
    v_accvgpr_read_b32 v110, a66
    v_pk_mul_f32 v[104:105], v[104:105], v[94:95] op_sel_hi:[1,0]
    v_accvgpr_read_b32 v107, a19
    v_pk_mul_f32 v[106:107], v[106:107], v[94:95] op_sel_hi:[1,0]
    v_cvt_pk_bf16_f32 v145, v146, v147
    v_cvt_pk_bf16_f32 v108, v108, v109
    v_pk_mul_f32 v[110:111], v[110:111], v[100:101] op_sel_hi:[1,0]
    v_cvt_pk_bf16_f32 v133, v134, v135
    v_pk_mul_f32 v[188:189], v[188:189], v[92:93] op_sel_hi:[1,0]
    v_cvt_pk_bf16_f32 v109, v110, v111
    v_pk_mul_f32 v[198:199], v[198:199], v[92:93] op_sel_hi:[1,0]
    v_cvt_pk_bf16_f32 v104, v104, v105
    v_cvt_pk_bf16_f32 v105, v106, v107
    v_mfma_f32_16x16x32_bf16 v[124:127], a[228:231], v[14:17], 0
    ds_write2st64_b64 v93, v[224:225], v[104:105] offset0:28 offset1:40
    v_mfma_f32_16x16x32_bf16 v[128:131], a[232:235], v[14:17], 0
    ds_read_b64_tr_b16 a[220:221], v5 offset:1024
    ds_write_b64 v93, v[108:109] offset:26624
    v_fma_f32 v65, v65, s28, v10
    v_mfma_f32_16x16x32_bf16 v[176:179], a[232:235], v[22:25], 0
    ds_read_b128 v[84:87], v103 offset:1024
    v_xor_b32 v93, 32, v93
    v_cvt_pk_bf16_f32 v229, v230, v231
    v_fma_f32 v64, v64, s28, v10
    v_cvt_pk_bf16_f32 v201, v202, v203
    v_accvgpr_read_b32 v111, a71
    v_pk_mul_f32 v[156:157], v[156:157], v[48:49] op_sel_hi:[1,0]
    v_accvgpr_read_b32 v110, a70
    v_accvgpr_read_b32 v104, a20
    v_accvgpr_read_b32 v107, a23
    v_pk_mul_f32 v[110:111], v[110:111], v[100:101] op_sel_hi:[1,0]
    v_accvgpr_read_b32 v108, a68
    v_cvt_pk_bf16_f32 v244, v244, v245
    v_accvgpr_read_b32 v105, a21
    v_accvgpr_read_b32 v109, a69
    v_exp_f32_e64 v63, v63 clamp
    v_pk_mul_f32 v[204:205], v[204:205], v[92:93] op_sel_hi:[1,0]
    v_pk_mul_f32 v[104:105], v[104:105], v[94:95] op_sel_hi:[1,0]
    v_accvgpr_read_b32 v106, a22
    v_pk_mul_f32 v[108:109], v[108:109], v[100:101] op_sel_hi:[1,0]
    v_pk_mul_f32 v[206:207], v[206:207], v[92:93] op_sel_hi:[1,0]
    v_cvt_pk_bf16_f32 v181, v182, v183
    v_cvt_pk_bf16_f32 v237, v238, v239
    v_cvt_pk_bf16_f32 v108, v108, v109
    v_cvt_pk_bf16_f32 v18, v52, v53
    v_pk_mul_f32 v[106:107], v[106:107], v[94:95] op_sel_hi:[1,0]
    v_cvt_pk_bf16_f32 v109, v110, v111
    v_cvt_pk_bf16_f32 v233, v234, v235
    v_cvt_pk_bf16_f32 v104, v104, v105
    v_mfma_f32_16x16x32_bf16 v[224:227], a[232:235], v[26:29], 0
    ds_write2st64_b64 v93, v[132:133], v[180:181] offset0:4 offset1:16
    v_cvt_pk_bf16_f32 v105, v106, v107
    v_fma_f32 v72, v72, s28, v11
    v_cvt_pk_bf16_f32 v193, v194, v195
    v_mfma_f32_16x16x32_bf16 a[16:19], a[232:235], v[34:37], 0
    s_waitcnt lgkmcnt(1)
    ds_write2st64_b64 v93, v[228:229], v[104:105] offset0:28 offset1:40
    v_accvgpr_read_b32 v104, a24
    v_mfma_f32_16x16x32_bf16 a[20:23], a[236:239], v[34:37], 0
    ds_read_b64_tr_b16 a[224:225], v2 offset:2048
    ds_read_b64_tr_b16 a[222:223], v5 offset:7168
    v_accvgpr_read_b32 v111, a75
    v_exp_f32_e64 v66, v66 clamp
    v_cvt_pk_bf16_f32 v204, v204, v205
    v_cvt_pk_bf16_f32 v188, v188, v189
    v_mfma_f32_16x16x32_bf16 v[228:231], a[236:239], v[26:29], 0
    ds_write_b64 v93, v[108:109] offset:26624
    ds_read_b64_tr_b16 a[228:229], v3 offset:2048
    v_accvgpr_read_b32 v108, a72
    v_cvt_pk_bf16_f32 v189, v190, v191
    v_accvgpr_read_b32 v107, a27
    v_cvt_pk_bf16_f32 v140, v140, v141
    v_accvgpr_read_b32 v106, a26
    v_cvt_pk_bf16_f32 v137, v138, v139
    v_accvgpr_read_b32 v105, a25
    v_accvgpr_read_b32 v110, a74
    v_cvt_pk_bf16_f32 v149, v150, v151
    v_xor_b32 v93, 96, v93
    v_cvt_pk_bf16_f32 v248, v248, v249
    v_mfma_f32_16x16x32_bf16 v[180:183], a[236:239], v[22:25], 0
    ds_write2st64_b64 v93, v[136:137], v[184:185] offset0:4 offset1:16
    v_pk_mul_f32 v[104:105], v[104:105], v[94:95] op_sel_hi:[1,0]
    v_exp_f32_e64 v82, v82 clamp
    v_accvgpr_read_b32 v109, a73
    v_pk_mul_f32 v[110:111], v[110:111], v[100:101] op_sel_hi:[1,0]
    v_cvt_pk_bf16_f32 v156, v156, v157
    v_pk_mul_f32 v[108:109], v[108:109], v[100:101] op_sel_hi:[1,0]
    v_pk_mul_f32 v[106:107], v[106:107], v[94:95] op_sel_hi:[1,0]
    v_cvt_pk_bf16_f32 v196, v196, v197
    v_cvt_pk_bf16_f32 v253, v254, v255
    v_cvt_pk_bf16_f32 v104, v104, v105
    v_cvt_pk_bf16_f32 v105, v106, v107
    v_exp_f32_e64 v62, v62 clamp
    v_cvt_pk_bf16_f32 v108, v108, v109
    v_mfma_f32_16x16x32_bf16 v[132:135], a[236:239], v[14:17], 0
    s_add_u32 m0, s22, 14336
    ds_read_b64_tr_b16 a[226:227], v2 offset:8192
    ds_read_b64_tr_b16 a[232:233], v4 offset:2048
    ds_read_b64_tr_b16 a[234:235], v4 offset:8192
    buffer_load_dwordx4 v6, s[4:7], s20 offen lds
    ds_read_b64_tr_b16 a[236:237], v5 offset:2048
    v_mfma_f32_16x16x32_bf16 v[136:139], a[216:219], v[14:17], 0
    s_add_u32 s20, s20, 12032
    ds_write2st64_b64 v93, v[232:233], v[104:105] offset0:28 offset1:40
    v_fma_f32 v59, v59, s28, v9
    v_cvt_pk_bf16_f32 v109, v110, v111
    v_cvt_pk_bf16_f32 v33, v82, v83
    v_accvgpr_read_b32 v107, a31
    v_accvgpr_read_b32 v104, a28
    v_accvgpr_read_b32 v111, a79
    v_mfma_f32_16x16x32_bf16 v[184:187], a[216:219], v[22:25], 0
    ds_read_b128 v[96:99], v103 offset:0
    ds_read_b64_tr_b16 a[230:231], v3 offset:8192
    ds_read_b64_tr_b16 a[238:239], v5 offset:8192
    v_mfma_f32_16x16x32_bf16 v[232:235], a[216:219], v[26:29], 0
    s_add_u32 s39, s39, 12288
    ds_write_b64 v93, v[108:109] offset:26624
    v_accvgpr_read_b32 v109, a77
    v_accvgpr_read_b32 v105, a29
    v_accvgpr_read_b32 v110, a78
    v_accvgpr_read_b32 v106, a30
    v_cvt_pk_bf16_f32 v153, v154, v155
    v_cvt_pk_bf16_f32 v141, v142, v143
    v_accvgpr_read_b32 v108, a76
    v_pk_mul_f32 v[104:105], v[104:105], v[94:95] op_sel_hi:[1,0]
    v_pk_mul_f32 v[110:111], v[110:111], v[100:101] op_sel_hi:[1,0]
    v_pk_mul_f32 v[108:109], v[108:109], v[100:101] op_sel_hi:[1,0]
    v_cvt_pk_bf16_f32 v104, v104, v105
    v_pk_mul_f32 v[106:107], v[106:107], v[94:95] op_sel_hi:[1,0]
    v_xor_b32 v93, 32, v93
    v_cvt_pk_bf16_f32 v105, v106, v107
    v_exp_f32_e64 v59, v59 clamp
    v_mfma_f32_16x16x32_bf16 a[24:27], a[216:219], v[34:37], 0
    ds_write2st64_b64 v93, v[140:141], v[188:189] offset0:4 offset1:16
    ds_write2st64_b64 v93, v[236:237], v[104:105] offset0:28 offset1:40
    v_cvt_pk_bf16_f32 v108, v108, v109
    v_pk_mul_f32 v[250:251], v[250:251], v[50:51] op_sel_hi:[1,0]
    v_cvt_pk_bf16_f32 v109, v110, v111
    v_cvt_pk_bf16_f32 v205, v206, v207
    s_waitcnt vmcnt(6) lgkmcnt(3)
    v_accvgpr_read_b32 v110, a82
    v_exp_f32_e64 v68, v68 clamp
    v_mfma_f32_16x16x32_bf16 a[28:31], a[220:223], v[34:37], 0
    buffer_store_dwordx4 v[96:99], v6, s[16:19], s67 offen offset:0 nt
    s_barrier
    ds_write_b64 v93, v[108:109] offset:26624
    v_fma_f32 v67, v67, s28, v10
    v_xor_b32 v93, 96, v93
    v_accvgpr_read_b32 v111, a83
    v_cvt_pk_bf16_f32 v30, v68, v69
    v_accvgpr_read_b32 v109, a81
    v_accvgpr_read_b32 v108, a80
    v_accvgpr_read_b32 v106, a34
    v_accvgpr_read_b32 v104, a32
    v_accvgpr_read_b32 v105, a33
    v_fma_f32 v75, v75, s28, v11
    v_accvgpr_read_b32 v107, a35
    v_pk_mul_f32 v[110:111], v[110:111], v[100:101] op_sel_hi:[1,0]
    v_pk_mul_f32 v[106:107], v[106:107], v[94:95] op_sel_hi:[1,0]
    v_exp_f32_e64 v55, v55 clamp
    v_pk_mul_f32 v[108:109], v[108:109], v[100:101] op_sel_hi:[1,0]
    v_pk_mul_f32 v[104:105], v[104:105], v[94:95] op_sel_hi:[1,0]
    v_cvt_pk_bf16_f32 v108, v108, v109
    v_cvt_pk_bf16_f32 v157, v158, v159
    v_cvt_pk_bf16_f32 v197, v198, v199
    v_cvt_pk_bf16_f32 v104, v104, v105
    v_exp_f32_e64 v81, v81 clamp
    v_cvt_pk_bf16_f32 v105, v106, v107
    v_cvt_pk_bf16_f32 v109, v110, v111
    v_accvgpr_read_b32 v110, a86
    v_mfma_f32_16x16x32_bf16 v[236:239], a[220:223], v[26:29], 0
    s_add_u32 m0, s22, 24576
    ds_write2st64_b64 v93, v[144:145], v[192:193] offset0:8 offset1:20
    v_mfma_f32_16x16x32_bf16 v[188:191], a[220:223], v[22:25], 0
    ds_write2st64_b64 v93, v[240:241], v[104:105] offset0:32 offset1:44
    v_mfma_f32_16x16x32_bf16 v[140:143], a[220:223], v[14:17], 0
    ds_write_b64 v93, v[108:109] offset:0
    v_cvt_pk_bf16_f32 v245, v246, v247
    v_accvgpr_read_b32 v109, a85
    v_accvgpr_read_b32 v106, a38
    v_mfma_f32_16x16x32_bf16 v[144:147], a[224:227], v[14:17], 0
    ds_read_b128 a[220:223], v1 offset:0
    buffer_load_dwordx4 v6, s[8:11], s21 offen lds
    v_xor_b32 v93, 32, v93
    v_accvgpr_read_b32 v107, a39
    v_accvgpr_read_b32 v108, a84
    v_pk_mul_f32 v[108:109], v[108:109], v[100:101] op_sel_hi:[1,0]
    v_accvgpr_read_b32 v104, a36
    v_accvgpr_read_b32 v111, a87
    v_accvgpr_read_b32 v105, a37
    v_mfma_f32_16x16x32_bf16 v[192:195], a[224:227], v[22:25], 0
    ds_write2st64_b64 v93, v[148:149], v[196:197] offset0:8 offset1:20
    v_pk_mul_f32 v[104:105], v[104:105], v[94:95] op_sel_hi:[1,0]
    v_pk_mul_f32 v[110:111], v[110:111], v[100:101] op_sel_hi:[1,0]
    v_pk_mul_f32 v[106:107], v[106:107], v[94:95] op_sel_hi:[1,0]
    v_cvt_pk_bf16_f32 v104, v104, v105
    v_exp_f32_e64 v65, v65 clamp
    v_cvt_pk_bf16_f32 v105, v106, v107
    v_accvgpr_read_b32 v107, a43
    v_cvt_pk_bf16_f32 v108, v108, v109
    v_cvt_pk_bf16_f32 v109, v110, v111
    v_cvt_pk_bf16_f32 v19, v54, v55
    v_mfma_f32_16x16x32_bf16 v[240:243], a[224:227], v[26:29], 0
    ds_write2st64_b64 v93, v[244:245], v[104:105] offset0:32 offset1:44
    v_mfma_f32_16x16x32_bf16 a[32:35], a[224:227], v[34:37], 0
    ds_read_b128 v[96:99], v103 offset:3072
    v_accvgpr_read_b32 v110, a90
    v_mfma_f32_16x16x32_bf16 a[36:39], a[228:231], v[34:37], 0
    s_add_u32 s21, s21, 128
    ds_write_b64 v93, v[108:109] offset:0
    v_accvgpr_read_b32 v106, a42
    v_accvgpr_read_b32 v111, a91
    v_accvgpr_read_b32 v105, a41
    v_fma_f32 v77, v77, s28, v12
    v_pk_mul_f32 v[110:111], v[110:111], v[100:101] op_sel_hi:[1,0]
    v_accvgpr_read_b32 v108, a88
    v_xor_b32 v93, 96, v93
    v_mfma_f32_16x16x32_bf16 v[244:247], a[228:231], v[26:29], 0
    s_add_u32 m0, s22, 25600
    ds_read_b128 a[224:227], v0 offset:1024
    buffer_load_dwordx4 v6, s[8:11], s21 offen lds
    v_accvgpr_read_b32 v104, a40
    v_exp_f32_e64 v61, v61 clamp
    v_mfma_f32_16x16x32_bf16 v[196:199], a[228:231], v[22:25], 0
    ds_write2st64_b64 v93, v[152:153], v[200:201] offset0:8 offset1:20
    v_accvgpr_read_b32 v109, a89
    v_pk_mul_f32 v[108:109], v[108:109], v[100:101] op_sel_hi:[1,0]
    v_pk_mul_f32 v[104:105], v[104:105], v[94:95] op_sel_hi:[1,0]
    v_pk_mul_f32 v[106:107], v[106:107], v[94:95] op_sel_hi:[1,0]
    v_cvt_pk_bf16_f32 v104, v104, v105
    v_cvt_pk_bf16_f32 v108, v108, v109
    v_cvt_pk_bf16_f32 v249, v250, v251
    v_cvt_pk_bf16_f32 v105, v106, v107
    v_mfma_f32_16x16x32_bf16 v[148:151], a[228:231], v[14:17], 0
    s_add_u32 s21, s21, 128
    ds_write2st64_b64 v93, v[248:249], v[104:105] offset0:32 offset1:44
    v_mfma_f32_16x16x32_bf16 v[152:155], a[232:235], v[14:17], 0
    s_add_u32 m0, s22, 26624
    ds_read_b128 v[88:91], v103 offset:2048
    v_accvgpr_read_b32 v106, a46
    v_accvgpr_read_b32 v104, a44
    v_mfma_f32_16x16x32_bf16 v[200:203], a[232:235], v[22:25], 0
    buffer_load_dwordx4 v6, s[8:11], s21 offen lds
    ds_read_b128 a[216:219], v0 offset:0
    v_accvgpr_read_b32 v105, a45
    v_cvt_pk_bf16_f32 v109, v110, v111
    v_accvgpr_read_b32 v107, a47
    v_pk_mul_f32 v[104:105], v[104:105], v[94:95] op_sel_hi:[1,0]
    v_pk_mul_f32 v[106:107], v[106:107], v[94:95] op_sel_hi:[1,0]
    v_cvt_pk_bf16_f32 v104, v104, v105
    v_cvt_pk_bf16_f32 v105, v106, v107
    v_mfma_f32_16x16x32_bf16 v[248:251], a[232:235], v[26:29], 0
    s_add_u32 s21, s21, 12032
    ds_write_b64 v93, v[108:109] offset:0
    v_xor_b32 v93, 32, v93
    v_mfma_f32_16x16x32_bf16 a[40:43], a[232:235], v[34:37], 0
    ds_write2st64_b64 v93, v[156:157], v[204:205] offset0:8 offset1:20
    v_mfma_f32_16x16x32_bf16 a[44:47], a[236:239], v[34:37], 0
    buffer_store_dwordx4 v[84:87], v7, s[16:19], s67 offen offset:0 nt
    ds_write2st64_b64 v93, v[252:253], v[104:105] offset0:32 offset1:44
    v_mfma_f32_16x16x32_bf16 v[252:255], a[236:239], v[26:29], 0
    ds_read_b128 a[232:235], v0 offset:2048
    v_accvgpr_read_b32 v110, a94
    v_mfma_f32_16x16x32_bf16 v[204:207], a[236:239], v[22:25], 0
    v_exp_f32_e64 v77, v77 clamp
    v_mfma_f32_16x16x32_bf16 v[156:159], a[236:239], v[14:17], 0
    s_waitcnt lgkmcnt(4)
    v_exp_f32_e64 v60, v60 clamp
    v_mfma_f32_16x16x32_bf16 v[52:55], a[216:219], a[96:99], 0
    s_add_u32 s56, s67, 128
    ds_read_b128 a[228:231], v1 offset:1024
    v_cvt_pk_bf16_f32 v22, v60, v61
    v_accvgpr_read_b32 v111, a95
    v_mfma_f32_16x16x32_bf16 v[52:55], a[220:223], a[100:103], v[52:55]
    s_add_u32 s58, s33, 128
    v_exp_f32_e64 v64, v64 clamp
    v_mfma_f32_16x16x32_bf16 v[52:55], a[224:227], a[104:107], v[52:55]
    ds_read_b128 a[236:239], v1 offset:2048
    v_cvt_pk_bf16_f32 v23, v62, v63
    v_mfma_f32_16x16x32_bf16 v[60:63], a[224:227], a[128:131], 0
    s_add_u32 m0, s38, 2048
    ds_read_b128 v[84:87], v103 offset:4096
    v_accvgpr_read_b32 v109, a93
    v_mfma_f32_16x16x32_bf16 v[60:63], a[220:223], a[124:127], v[60:63]
    v_cvt_pk_bf16_f32 v34, v76, v77
    v_cvt_pk_bf16_f32 v35, v78, v79
    v_mfma_f32_16x16x32_bf16 v[60:63], a[216:219], a[120:123], v[60:63]
    buffer_load_dwordx4 v6, s[12:15], s58 offen nt lds
    v_mfma_f32_16x16x32_bf16 v[68:71], a[216:219], a[144:147], 0
    s_add_u32 m0, s38, 3072
    v_exp_f32_e64 v57, v57 clamp
    v_mfma_f32_16x16x32_bf16 v[68:71], a[220:223], a[148:151], v[68:71]
    buffer_load_dwordx4 v7, s[12:15], s58 offen nt lds
    v_mfma_f32_16x16x32_bf16 v[68:71], a[224:227], a[152:155], v[68:71]
    v_exp_f32_e64 v67, v67 clamp
    v_mfma_f32_16x16x32_bf16 v[76:79], a[224:227], a[176:179], 0
    v_exp_f32_e64 v72, v72 clamp
    v_mfma_f32_16x16x32_bf16 v[76:79], a[220:223], a[172:175], v[76:79]
    buffer_store_dwordx4 v[88:91], v6, s[16:19], s56 offen offset:0 nt
    v_accvgpr_read_b32 v108, a92
    v_pk_mul_f32 v[108:109], v[108:109], v[100:101] op_sel_hi:[1,0]
    v_pk_mul_f32 v[110:111], v[110:111], v[100:101] op_sel_hi:[1,0]
    v_cvt_pk_bf16_f32 v108, v108, v109
    v_mov_b32 v50, 0
    v_mfma_f32_16x16x32_bf16 v[76:79], a[216:219], a[168:171], v[76:79]
    s_waitcnt lgkmcnt(0)
    ds_read_b128 v[88:91], v103 offset:5120
    v_cvt_pk_bf16_f32 v16, v56, v57
    v_mfma_f32_16x16x32_bf16 v[76:79], a[228:231], a[180:183], v[76:79]
    ds_read_b128 a[220:223], v1 offset:6144
    v_cvt_pk_bf16_f32 v20, v64, v65
    v_mfma_f32_16x16x32_bf16 v[76:79], a[232:235], a[184:187], v[76:79]
    ds_read_b128 a[216:219], v0 offset:6144
    v_cvt_pk_bf16_f32 v109, v110, v111
    v_mfma_f32_16x16x32_bf16 v[76:79], a[236:239], a[188:191], v[76:79]
    v_exp_f32_e64 v58, v58 clamp
    v_mfma_f32_16x16x32_bf16 v[68:71], a[236:239], a[164:167], v[68:71]
    buffer_store_dwordx4 v[96:99], v7, s[16:19], s56 offen offset:0 nt
    ds_write_b64 v93, v[108:109] offset:0
    v_mfma_f32_16x16x32_bf16 v[68:71], a[232:235], a[160:163], v[68:71]
    s_add_u32 s57, s67, 256
    v_exp_f32_e64 v75, v75 clamp
    v_mfma_f32_16x16x32_bf16 v[68:71], a[228:231], a[156:159], v[68:71]
    s_add_u32 s59, s33, 256
    ds_read_b128 v[96:99], v103 offset:0
    v_cvt_pk_bf16_f32 v32, v80, v81
    v_mfma_f32_16x16x32_bf16 v[60:63], a[228:231], a[132:135], v[60:63]
    s_add_u32 m0, s38, 4096
    ds_read_b128 a[224:227], v0 offset:7168
    v_mfma_f32_16x16x32_bf16 v[60:63], a[232:235], a[136:139], v[60:63]
    buffer_load_dwordx4 v6, s[12:15], s59 offen nt lds
    v_mfma_f32_16x16x32_bf16 v[60:63], a[236:239], a[140:143], v[60:63]
    buffer_store_dwordx4 v[84:87], v6, s[16:19], s57 offen offset:0 nt
    s_nop 0
    ds_read_b128 v[84:87], v103 offset:1024
    v_cvt_pk_bf16_f32 v17, v58, v59
    v_cvt_pk_bf16_f32 v28, v72, v73
    v_mfma_f32_16x16x32_bf16 v[52:55], a[236:239], a[116:119], v[52:55]
    v_cvt_pk_bf16_f32 v21, v66, v67
    v_mov_b32 v48, 0
    v_mfma_f32_16x16x32_bf16 v[52:55], a[232:235], a[112:115], v[52:55]
    ds_read_b128 a[232:235], v0 offset:8192
    v_cvt_pk_bf16_f32 v29, v74, v75
    v_mfma_f32_16x16x32_bf16 v[52:55], a[228:231], a[108:111], v[52:55]
    s_waitcnt lgkmcnt(5)
    ds_read_b128 a[236:239], v1 offset:8192
    v_mfma_f32_16x16x32_bf16 v[56:59], a[216:219], a[96:99], 0
    ds_read_b128 a[228:231], v1 offset:7168
    s_add_u32 m0, s38, 5120
    v_smfmac_f32_16x16x64_bf16 v[48:51], a[240:243], v[16:23], v101
    buffer_load_dwordx4 v7, s[12:15], s59 offen nt lds
    v_smfmac_f32_16x16x64_bf16 v[48:51], a[244:247], v[28:35], v101
    s_add_u32 s56, s67, 24832
    v_add_u32 v103, 6144, v103
    v_mfma_f32_16x16x32_bf16 v[56:59], a[220:223], a[100:103], v[56:59]
    s_add_u32 m0, s38, 0
    s_waitcnt lgkmcnt(4)
    v_mfma_f32_16x16x32_bf16 v[56:59], a[224:227], a[104:107], v[56:59]
    buffer_load_dwordx4 v6, s[12:15], s33 offen nt lds
    v_mfma_f32_16x16x32_bf16 v[64:67], a[224:227], a[128:131], 0
    v_cmp_lt_f32 vcc, s29, v48
    s_add_u32 m0, s38, 1024
    v_mfma_f32_16x16x32_bf16 v[64:67], a[220:223], a[124:127], v[64:67]
    s_waitcnt lgkmcnt(3)
    buffer_load_dwordx4 v7, s[12:15], s33 offen nt lds
    v_mfma_f32_16x16x32_bf16 v[64:67], a[216:219], a[120:123], v[64:67]
    s_cbranch_vccnz L_rs_tr54d
L_ret_tr54d:
    v_mfma_f32_16x16x32_bf16 v[72:75], a[216:219], a[144:147], 0
    v_fma_f32 v53, v53, s28, v9
    v_fma_f32 v61, v61, s28, v10
    v_mfma_f32_16x16x32_bf16 v[72:75], a[220:223], a[148:151], v[72:75]
    v_fma_f32 v52, v52, s28, v9
    v_fma_f32 v60, v60, s28, v10
    v_mfma_f32_16x16x32_bf16 v[72:75], a[224:227], a[152:155], v[72:75]
    s_waitcnt vmcnt(17) lgkmcnt(0)
    v_exp_f32_e64 v53, v53 clamp
    v_mfma_f32_16x16x32_bf16 v[80:83], a[224:227], a[176:179], 0
    s_barrier
    v_mfma_f32_16x16x32_bf16 v[80:83], a[220:223], a[172:175], v[80:83]
    v_exp_f32_e64 v60, v60 clamp
    v_mfma_f32_16x16x32_bf16 v[80:83], a[216:219], a[168:171], v[80:83]
    ds_read_b64_tr_b16 a[216:217], v2 offset:18432
    v_fma_f32 v54, v54, s28, v9
    v_mfma_f32_16x16x32_bf16 v[80:83], a[228:231], a[180:183], v[80:83]
    s_add_u32 m0, s22, 0
    v_exp_f32_e64 v52, v52 clamp
    v_mfma_f32_16x16x32_bf16 v[80:83], a[232:235], a[184:187], v[80:83]
    buffer_store_dwordx4 v[88:91], v7, s[16:19], s57 offen offset:0 nt
    ds_read_b64_tr_b16 a[218:219], v2 offset:12288
    v_exp_f32_e64 v54, v54 clamp
    v_mfma_f32_16x16x32_bf16 v[80:83], a[236:239], a[188:191], v[80:83]
    ds_read_b64_tr_b16 a[220:221], v3 offset:18432
    v_fma_f32 v55, v55, s28, v9
    v_mfma_f32_16x16x32_bf16 v[72:75], a[236:239], a[164:167], v[72:75]
    buffer_load_dwordx4 v6, s[4:7], s20 offen lds
    v_mfma_f32_16x16x32_bf16 v[72:75], a[232:235], a[160:163], v[72:75]
    buffer_store_dwordx4 v[96:99], v6, s[16:19], s56 offen offset:0 nt
    ds_read_b64_tr_b16 a[222:223], v3 offset:12288
    v_exp_f32_e64 v61, v61 clamp
    v_mfma_f32_16x16x32_bf16 v[72:75], a[228:231], a[156:159], v[72:75]
    s_add_u32 s20, s20, 128
    v_exp_f32_e64 v55, v55 clamp
    v_mfma_f32_16x16x32_bf16 v[64:67], a[228:231], a[132:135], v[64:67]
    s_add_u32 m0, s22, 1024
    ds_read_b64_tr_b16 a[224:225], v4 offset:18432
    v_cvt_pk_bf16_f32 v14, v52, v53
    v_mfma_f32_16x16x32_bf16 v[64:67], a[232:235], a[136:139], v[64:67]
    buffer_load_dwordx4 v6, s[4:7], s20 offen lds
    v_mfma_f32_16x16x32_bf16 v[64:67], a[236:239], a[140:143], v[64:67]
    s_add_u32 s20, s20, 128
    s_add_u32 m0, s22, 2048
    v_cvt_pk_bf16_f32 v15, v54, v55
    v_mfma_f32_16x16x32_bf16 v[56:59], a[236:239], a[116:119], v[56:59]
    ds_read_b64_tr_b16 a[226:227], v4 offset:12288
    s_waitcnt lgkmcnt(4)
    v_mfma_f32_16x16x32_bf16 v[56:59], a[232:235], a[112:115], v[56:59]
    buffer_load_dwordx4 v6, s[4:7], s20 offen lds
    v_mfma_f32_16x16x32_bf16 v[56:59], a[228:231], a[108:111], v[56:59]
    s_add_u32 s20, s20, 12032
    ds_read_b64_tr_b16 a[228:229], v5 offset:18432
    ds_read_b64_tr_b16 a[230:231], v5 offset:12288
    buffer_store_dwordx4 v[84:87], v7, s[16:19], s56 offen offset:0 nt
    s_branch L_loop4w0
L_tr55:
    v_mfma_f32_16x16x32_bf16 v[112:115], a[216:219], v[16:19], v[112:115]
    v_fma_f32 v72, v72, s28, v11
    v_mfma_f32_16x16x32_bf16 v[116:119], a[220:223], v[16:19], v[116:119]
    v_mbcnt_lo_u32_b32 v97, -1, 0
    v_fma_f32 v67, v67, s28, v10
    v_mfma_f32_16x16x32_bf16 v[164:167], a[220:223], v[20:23], v[164:167]
    ds_read_b64_tr_b16 a[236:237], v3 offset:19456
    v_mbcnt_hi_u32_b32 v97, -1, v97
    v_mfma_f32_16x16x32_bf16 v[160:163], a[216:219], v[20:23], v[160:163]
    ds_read_b64_tr_b16 a[234:235], v2 offset:13312
    v_fma_f32 v76, v76, s28, v12
    v_mfma_f32_16x16x32_bf16 v[208:211], a[216:219], v[28:31], v[208:211]
    s_add_u32 s39, s39, 12288
    v_fma_f32 v56, v56, s28, v9
    v_and_b32 v96, 15, v97
    v_mfma_f32_16x16x32_bf16 v[212:215], a[220:223], v[28:31], v[212:215]
    ds_read_b64_tr_b16 a[238:239], v3 offset:13312
    v_fma_f32 v69, v69, s28, v11
    v_mfma_f32_16x16x32_bf16 a[4:7], a[220:223], v[32:35], a[4:7]
    v_mul_u32_u24 v96, 384, v96
    v_fma_f32 v87, v87, s28, v13
    v_mfma_f32_16x16x32_bf16 a[0:3], a[216:219], v[32:35], a[0:3]
    s_add_u32 s48, s33, 24576
    ds_read_b64_tr_b16 a[232:233], v2 offset:19456
    v_fma_f32 v77, v77, s28, v12
    v_mfma_f32_16x16x32_bf16 a[48:51], a[216:219], v[40:43], a[48:51]
    v_lshrrev_b32 v97, 4, v97
    v_fma_f32 v71, v71, s28, v11
    v_mfma_f32_16x16x32_bf16 a[52:55], a[220:223], v[40:43], a[52:55]
    s_waitcnt lgkmcnt(4)
    v_fma_f32 v58, v58, s28, v9
    v_lshl_add_u32 v96, v97, 4, v96
    v_mfma_f32_16x16x32_bf16 a[56:59], a[224:227], v[40:43], a[56:59]
    v_fma_f32 v85, v85, s28, v13
    v_mfma_f32_16x16x32_bf16 a[60:63], a[228:231], v[40:43], a[60:63]
    buffer_load_dword v97, v96, s[12:15], s48 offen offset:256
    v_mfma_f32_16x16x32_bf16 a[12:15], a[228:231], v[32:35], a[12:15]
    ds_read_b64_tr_b16 a[222:223], v5 offset:13312
    v_fma_f32 v86, v86, s28, v13
    v_mfma_f32_16x16x32_bf16 a[8:11], a[224:227], v[32:35], a[8:11]
    ds_read_b64_tr_b16 a[218:219], v4 offset:13312
    v_fma_f32 v75, v75, s28, v11
    v_mfma_f32_16x16x32_bf16 v[216:219], a[224:227], v[28:31], v[216:219]
    ds_read_b64_tr_b16 a[216:217], v4 offset:19456
    v_fma_f32 v80, v80, s28, v12
    v_mfma_f32_16x16x32_bf16 v[220:223], a[228:231], v[28:31], v[220:223]
    v_exp_f32_e64 v85, v85 clamp
    v_mfma_f32_16x16x32_bf16 v[172:175], a[228:231], v[20:23], v[172:175]
    ds_read_b64_tr_b16 a[220:221], v5 offset:19456
    v_fma_f32 v84, v84, s28, v13
    v_mfma_f32_16x16x32_bf16 v[168:171], a[224:227], v[20:23], v[168:171]
    v_fma_f32 v64, v64, s28, v10
    v_fma_f32 v68, v68, s28, v11
    v_mfma_f32_16x16x32_bf16 v[120:123], a[224:227], v[16:19], v[120:123]
    v_exp_f32_e64 v71, v71 clamp
    v_mfma_f32_16x16x32_bf16 v[124:127], a[228:231], v[16:19], v[124:127]
    s_waitcnt lgkmcnt(4)
    v_exp_f32_e64 v68, v68 clamp
    v_mfma_f32_16x16x32_bf16 v[128:131], a[232:235], v[16:19], v[128:131]
    ds_read_b64_tr_b16 a[228:229], v3 offset:20480
    v_fma_f32 v66, v66, s28, v10
    v_mfma_f32_16x16x32_bf16 v[132:135], a[236:239], v[16:19], v[132:135]
    ds_read_b64_tr_b16 a[224:225], v2 offset:20480
    v_fma_f32 v70, v70, s28, v11
    v_mfma_f32_16x16x32_bf16 v[180:183], a[236:239], v[20:23], v[180:183]
    v_fma_f32 v59, v59, s28, v9
    v_fma_f32 v88, v88, s28, v13
    v_mfma_f32_16x16x32_bf16 v[176:179], a[232:235], v[20:23], v[176:179]
    v_exp_f32_e64 v64, v64 clamp
    v_mfma_f32_16x16x32_bf16 v[224:227], a[232:235], v[28:31], v[224:227]
    v_exp_f32_e64 v58, v58 clamp
    v_mfma_f32_16x16x32_bf16 v[228:231], a[236:239], v[28:31], v[228:231]
    v_fma_f32 v65, v65, s28, v10
    v_fma_f32 v78, v78, s28, v12
    v_mfma_f32_16x16x32_bf16 a[20:23], a[236:239], v[32:35], a[20:23]
    ds_read_b64_tr_b16 a[226:227], v2 offset:14336
    v_fma_f32 v82, v82, s28, v12
    v_mfma_f32_16x16x32_bf16 a[16:19], a[232:235], v[32:35], a[16:19]
    ds_read_b64_tr_b16 a[230:231], v3 offset:14336
    v_fma_f32 v79, v79, s28, v12
    v_mfma_f32_16x16x32_bf16 a[64:67], a[232:235], v[40:43], a[64:67]
    v_exp_f32_e64 v65, v65 clamp
    v_mfma_f32_16x16x32_bf16 a[68:71], a[236:239], v[40:43], a[68:71]
    s_waitcnt lgkmcnt(4)
    v_exp_f32_e64 v86, v86 clamp
    v_mfma_f32_16x16x32_bf16 a[72:75], a[216:219], v[40:43], a[72:75]
    ds_read_b64_tr_b16 a[232:233], v4 offset:20480
    v_fma_f32 v90, v90, s28, v13
    v_mfma_f32_16x16x32_bf16 a[76:79], a[220:223], v[40:43], a[76:79]
    v_fma_f32 v81, v81, s28, v12
    v_fma_f32 v57, v57, s28, v9
    v_mfma_f32_16x16x32_bf16 a[28:31], a[220:223], v[32:35], a[28:31]
    ds_read_b64_tr_b16 a[236:237], v5 offset:20480
    v_mfma_f32_16x16x32_bf16 a[24:27], a[216:219], v[32:35], a[24:27]
    ds_read_b64_tr_b16 a[234:235], v4 offset:14336
    v_cvt_pk_bf16_f32 v24, v64, v65
    v_mfma_f32_16x16x32_bf16 v[232:235], a[216:219], v[28:31], v[232:235]
    v_exp_f32_e64 v78, v78 clamp
    v_mfma_f32_16x16x32_bf16 v[236:239], a[220:223], v[28:31], v[236:239]
    ds_read_b64_tr_b16 a[238:239], v5 offset:14336
    v_mfma_f32_16x16x32_bf16 v[188:191], a[220:223], v[20:23], v[188:191]
    v_exp_f32_e64 v88, v88 clamp
    v_mfma_f32_16x16x32_bf16 v[184:187], a[216:219], v[20:23], v[184:187]
    v_exp_f32_e64 v77, v77 clamp
    v_mfma_f32_16x16x32_bf16 v[136:139], a[216:219], v[16:19], v[136:139]
    v_exp_f32_e64 v69, v69 clamp
    v_mfma_f32_16x16x32_bf16 v[140:143], a[220:223], v[16:19], v[140:143]
    s_waitcnt lgkmcnt(4)
    v_exp_f32_e64 v79, v79 clamp
    v_mfma_f32_16x16x32_bf16 v[144:147], a[224:227], v[16:19], v[144:147]
    v_exp_f32_e64 v75, v75 clamp
    v_mfma_f32_16x16x32_bf16 v[148:151], a[228:231], v[16:19], v[148:151]
    v_exp_f32_e64 v87, v87 clamp
    v_mfma_f32_16x16x32_bf16 v[196:199], a[228:231], v[20:23], v[196:199]
    v_fma_f32 v74, v74, s28, v11
    v_cvt_pk_bf16_f32 v26, v68, v69
    v_mfma_f32_16x16x32_bf16 v[192:195], a[224:227], v[20:23], v[192:195]
    v_fma_f32 v91, v91, s28, v13
    v_cvt_pk_bf16_f32 v39, v86, v87
    v_mfma_f32_16x16x32_bf16 v[240:243], a[224:227], v[28:31], v[240:243]
    v_exp_f32_e64 v59, v59 clamp
    v_mfma_f32_16x16x32_bf16 v[244:247], a[228:231], v[28:31], v[244:247]
    v_fma_f32 v83, v83, s28, v12
    v_mfma_f32_16x16x32_bf16 a[36:39], a[228:231], v[32:35], a[36:39]
    v_mfma_f32_16x16x32_bf16 a[32:35], a[224:227], v[32:35], a[32:35]
    v_fma_f32 v73, v73, s28, v11
    v_mfma_f32_16x16x32_bf16 a[80:83], a[224:227], v[40:43], a[80:83]
    s_waitcnt vmcnt(11) lgkmcnt(0)
    v_exp_f32_e64 v76, v76 clamp
    v_mfma_f32_16x16x32_bf16 a[84:87], a[228:231], v[40:43], a[84:87]
    s_barrier
    v_mfma_f32_16x16x32_bf16 a[88:91], a[232:235], v[40:43], a[88:91]
    ds_read_b128 a[216:219], v0 offset:12288
    s_add_u32 m0, s22, 36864
    v_mfma_f32_16x16x32_bf16 a[92:95], a[236:239], v[40:43], a[92:95]
    buffer_load_dwordx4 v6, s[8:11], s21 offen lds
    v_mfma_f32_16x16x32_bf16 a[44:47], a[236:239], v[32:35], a[44:47]
    ds_read_b128 a[220:223], v1 offset:12288
    s_add_u32 s21, s21, 128
    v_mfma_f32_16x16x32_bf16 a[40:43], a[232:235], v[32:35], a[40:43]
    s_add_u32 m0, s22, 37888
    ds_read_b128 a[224:227], v0 offset:13312
    v_cvt_pk_bf16_f32 v34, v76, v77
    v_mfma_f32_16x16x32_bf16 v[248:251], a[232:235], v[28:31], v[248:251]
    buffer_load_dwordx4 v6, s[8:11], s21 offen lds
    v_mfma_f32_16x16x32_bf16 v[252:255], a[236:239], v[28:31], v[252:255]
    v_exp_f32_e64 v84, v84 clamp
    v_mfma_f32_16x16x32_bf16 v[204:207], a[236:239], v[20:23], v[204:207]
    s_add_u32 s21, s21, 128
    v_exp_f32_e64 v70, v70 clamp
    v_mfma_f32_16x16x32_bf16 v[200:203], a[232:235], v[20:23], v[200:203]
    v_cvt_pk_bf16_f32 v27, v70, v71
    v_cvt_pk_bf16_f32 v38, v84, v85
    v_mfma_f32_16x16x32_bf16 v[152:155], a[232:235], v[16:19], v[152:155]
    v_cvt_pk_bf16_f32 v23, v62, v63
    v_cvt_pk_bf16_f32 v22, v60, v61
    v_mfma_f32_16x16x32_bf16 v[156:159], a[236:239], v[16:19], v[156:159]
    s_add_u32 m0, s22, 38912
    ds_read_b128 a[228:231], v1 offset:13312
    s_waitcnt lgkmcnt(3)
    v_mfma_f32_16x16x32_bf16 v[52:55], a[216:219], a[96:99], 0
    buffer_load_dwordx4 v6, s[8:11], s21 offen lds
    v_mfma_f32_16x16x32_bf16 v[60:63], a[216:219], a[120:123], 0
    v_cvt_pk_bf16_f32 v35, v78, v79
    v_mfma_f32_16x16x32_bf16 v[68:71], a[216:219], a[144:147], 0
    v_exp_f32_e64 v80, v80 clamp
    v_mfma_f32_16x16x32_bf16 v[76:79], a[216:219], a[168:171], 0
    v_exp_f32_e64 v57, v57 clamp
    v_mfma_f32_16x16x32_bf16 v[84:87], a[216:219], a[192:195], 0
    s_waitcnt lgkmcnt(1)
    v_exp_f32_e64 v67, v67 clamp
    v_mfma_f32_16x16x32_bf16 v[52:55], a[220:223], a[100:103], v[52:55]
    v_exp_f32_e64 v56, v56 clamp
    v_mfma_f32_16x16x32_bf16 v[60:63], a[220:223], a[124:127], v[60:63]
    v_exp_f32_e64 v91, v91 clamp
    v_mfma_f32_16x16x32_bf16 v[68:71], a[220:223], a[148:151], v[68:71]
    v_fma_f32 v89, v89, s28, v13
    v_mfma_f32_16x16x32_bf16 v[76:79], a[220:223], a[172:175], v[76:79]
    v_exp_f32_e64 v89, v89 clamp
    v_mfma_f32_16x16x32_bf16 v[84:87], a[220:223], a[196:199], v[84:87]
    v_cvt_pk_bf16_f32 v40, v88, v89
    v_mfma_f32_16x16x32_bf16 v[52:55], a[224:227], a[104:107], v[52:55]
    ds_read_b128 a[232:235], v0 offset:14336
    v_mfma_f32_16x16x32_bf16 v[60:63], a[224:227], a[128:131], v[60:63]
    v_exp_f32_e64 v90, v90 clamp
    v_mfma_f32_16x16x32_bf16 v[68:71], a[224:227], a[152:155], v[68:71]
    v_cvt_pk_bf16_f32 v16, v56, v57
    v_cvt_pk_bf16_f32 v17, v58, v59
    v_mfma_f32_16x16x32_bf16 v[76:79], a[224:227], a[176:179], v[76:79]
    v_exp_f32_e64 v73, v73 clamp
    v_mfma_f32_16x16x32_bf16 v[84:87], a[224:227], a[200:203], v[84:87]
    s_waitcnt lgkmcnt(1)
    v_exp_f32_e64 v83, v83 clamp
    v_mfma_f32_16x16x32_bf16 v[52:55], a[228:231], a[108:111], v[52:55]
    v_exp_f32_e64 v72, v72 clamp
    v_mfma_f32_16x16x32_bf16 v[60:63], a[228:231], a[132:135], v[60:63]
    v_exp_f32_e64 v74, v74 clamp
    v_mfma_f32_16x16x32_bf16 v[44:47], a[248:251], v[14:17], v[44:47]
    ds_read_b128 a[236:239], v1 offset:14336
    v_mfma_f32_16x16x32_bf16 v[68:71], a[228:231], a[156:159], v[68:71]
    ds_read_b128 a[216:219], v0 offset:20480
    v_cvt_pk_bf16_f32 v41, v90, v91
    v_mfma_f32_16x16x32_bf16 v[76:79], a[228:231], a[180:183], v[76:79]
    v_exp_f32_e64 v66, v66 clamp
    v_mfma_f32_16x16x32_bf16 v[84:87], a[228:231], a[204:207], v[84:87]
    s_waitcnt lgkmcnt(2)
    v_exp_f32_e64 v81, v81 clamp
    v_mfma_f32_16x16x32_bf16 v[52:55], a[232:235], a[112:115], v[52:55]
    v_cvt_pk_bf16_f32 v25, v66, v67
    v_mfma_f32_16x16x32_bf16 v[60:63], a[232:235], a[136:139], v[60:63]
    v_cvt_pk_bf16_f32 v29, v74, v75
    v_cvt_pk_bf16_f32 v28, v72, v73
    v_mfma_f32_16x16x32_bf16 v[68:71], a[232:235], a[160:163], v[68:71]
    v_exp_f32_e64 v82, v82 clamp
    v_smfmac_f32_16x16x64_bf16 v[44:47], a[240:243], v[22:29], v101
    v_cvt_pk_bf16_f32 v36, v80, v81
    v_mfma_f32_16x16x32_bf16 v[76:79], a[232:235], a[184:187], v[76:79]
    ds_read_b128 a[228:231], v1 offset:18432
    v_cvt_pk_bf16_f32 v37, v82, v83
    v_mfma_f32_16x16x32_bf16 v[84:87], a[232:235], a[208:211], v[84:87]
    ds_read_b128 a[232:235], v0 offset:19456
    v_smfmac_f32_16x16x64_bf16 v[44:47], a[244:247], v[34:41], v101
    s_waitcnt lgkmcnt(3)
    ds_read_b128 a[220:223], v1 offset:20480
    v_mfma_f32_16x16x32_bf16 v[52:55], a[236:239], a[116:119], v[52:55]
    v_mfma_f32_16x16x32_bf16 v[60:63], a[236:239], a[140:143], v[60:63]
    ds_read_b128 a[224:227], v0 offset:18432
    s_add_u32 s21, s21, 12032
    v_mfma_f32_16x16x32_bf16 v[68:71], a[236:239], a[164:167], v[68:71]
    v_mfma_f32_16x16x32_bf16 v[76:79], a[236:239], a[188:191], v[76:79]
    v_cmp_lt_f32 vcc, s29, v44
    v_mfma_f32_16x16x32_bf16 v[84:87], a[236:239], a[212:215], v[84:87]
    s_waitcnt lgkmcnt(4)
    ds_read_b128 a[236:239], v1 offset:19456
    v_mfma_f32_16x16x32_bf16 v[56:59], a[216:219], a[112:115], 0
    v_mfma_f32_16x16x32_bf16 v[64:67], a[216:219], a[136:139], 0
    v_mfma_f32_16x16x32_bf16 v[72:75], a[216:219], a[160:163], 0
    s_cbranch_vccnz L_rs_tr55a
L_ret_tr55a:
    v_fma_f32 v54, v54, s28, v9
    v_mfma_f32_16x16x32_bf16 v[80:83], a[216:219], a[184:187], 0
    v_fma_f32 v63, v63, s28, v10
    v_mfma_f32_16x16x32_bf16 v[88:91], a[216:219], a[208:211], 0
    s_waitcnt lgkmcnt(2)
    v_exp_f32_e64 v54, v54 clamp
    v_mfma_f32_16x16x32_bf16 v[56:59], a[220:223], a[116:119], v[56:59]
    v_fma_f32 v55, v55, s28, v9
    v_fma_f32 v53, v53, s28, v9
    v_mfma_f32_16x16x32_bf16 v[64:67], a[220:223], a[140:143], v[64:67]
    v_fma_f32 v62, v62, s28, v10
    v_mfma_f32_16x16x32_bf16 v[72:75], a[220:223], a[164:167], v[72:75]
    v_exp_f32_e64 v62, v62 clamp
    v_mfma_f32_16x16x32_bf16 v[80:83], a[220:223], a[188:191], v[80:83]
    v_fma_f32 v60, v60, s28, v10
    s_waitcnt vmcnt(7) lgkmcnt(0)
    v_mfma_f32_16x16x32_bf16 v[88:91], a[220:223], a[212:215], v[88:91]
    s_barrier
    v_mfma_f32_16x16x32_bf16 v[56:59], a[224:227], a[96:99], v[56:59]
    s_add_u32 m0, s22, 12288
    ds_read_b64_tr_b16 a[216:217], v2 offset:0
    v_fma_f32 v52, v52, s28, v9
    v_mfma_f32_16x16x32_bf16 v[64:67], a[224:227], a[120:123], v[64:67]
    buffer_load_dwordx4 v6, s[4:7], s20 offen lds
    v_mfma_f32_16x16x32_bf16 v[72:75], a[224:227], a[144:147], v[72:75]
    v_exp_f32_e64 v63, v63 clamp
    v_mfma_f32_16x16x32_bf16 v[80:83], a[224:227], a[168:171], v[80:83]
    ds_read_b64_tr_b16 a[218:219], v2 offset:6144
    s_add_u32 s20, s20, 128
    v_mfma_f32_16x16x32_bf16 v[88:91], a[224:227], a[192:195], v[88:91]
    s_add_u32 m0, s22, 13312
    ds_read_b64_tr_b16 a[220:221], v3 offset:0
    v_mfma_f32_16x16x32_bf16 v[56:59], a[228:231], a[100:103], v[56:59]
    v_exp_f32_e64 v60, v60 clamp
    v_mfma_f32_16x16x32_bf16 v[64:67], a[228:231], a[124:127], v[64:67]
    buffer_load_dwordx4 v6, s[4:7], s20 offen lds
    v_mfma_f32_16x16x32_bf16 v[72:75], a[228:231], a[148:151], v[72:75]
    ds_read_b64_tr_b16 a[222:223], v3 offset:6144
    v_mfma_f32_16x16x32_bf16 v[80:83], a[228:231], a[172:175], v[80:83]
    s_add_u32 s20, s20, 128
    ds_read_b64_tr_b16 a[224:225], v4 offset:0
    v_fma_f32 v61, v61, s28, v10
    v_mfma_f32_16x16x32_bf16 v[88:91], a[228:231], a[196:199], v[88:91]
    s_add_u32 m0, s22, 14336
    ds_read_b64_tr_b16 a[226:227], v4 offset:6144
    v_mfma_f32_16x16x32_bf16 v[56:59], a[232:235], a[104:107], v[56:59]
    buffer_load_dwordx4 v6, s[4:7], s20 offen lds
    v_mfma_f32_16x16x32_bf16 v[64:67], a[232:235], a[128:131], v[64:67]
    ds_read_b64_tr_b16 a[228:229], v5 offset:0
    v_mfma_f32_16x16x32_bf16 v[72:75], a[232:235], a[152:155], v[72:75]
    v_exp_f32_e64 v55, v55 clamp
    v_mfma_f32_16x16x32_bf16 v[80:83], a[232:235], a[176:179], v[80:83]
    v_cvt_pk_bf16_f32 v19, v54, v55
    v_mfma_f32_16x16x32_bf16 v[88:91], a[232:235], a[200:203], v[88:91]
    v_exp_f32_e64 v53, v53 clamp
    v_mfma_f32_16x16x32_bf16 v[56:59], a[236:239], a[108:111], v[56:59]
    s_add_u32 s20, s20, 12032
    v_exp_f32_e64 v52, v52 clamp
    v_mfma_f32_16x16x32_bf16 v[64:67], a[236:239], a[132:135], v[64:67]
    buffer_load_dwordx4 a[208:211], v96, s[12:15], s48 offen offset:256 nt
    v_mfma_f32_16x16x32_bf16 v[72:75], a[236:239], a[156:159], v[72:75]
    buffer_load_dwordx4 a[212:215], v96, s[12:15], s48 offen offset:320 nt
    v_mfma_f32_16x16x32_bf16 v[80:83], a[236:239], a[180:183], v[80:83]
    s_waitcnt lgkmcnt(2)
    ds_read_b64_tr_b16 a[230:231], v5 offset:6144
    v_cvt_pk_bf16_f32 v18, v52, v53
    v_mfma_f32_16x16x32_bf16 v[88:91], a[236:239], a[204:207], v[88:91]
    v_exp_f32_e64 v61, v61 clamp
    v_mfma_f32_16x16x32_bf16 v[112:115], a[216:219], v[14:17], v[112:115]
    v_fma_f32 v57, v57, s28, v9
    s_nop 0
    v_fma_f32 v83, v83, s28, v12
    v_mfma_f32_16x16x32_bf16 v[116:119], a[220:223], v[14:17], v[116:119]
    ds_read_b64_tr_b16 a[236:237], v3 offset:1024
    v_fma_f32 v70, v70, s28, v11
    v_mfma_f32_16x16x32_bf16 v[164:167], a[220:223], v[22:25], v[164:167]
    v_fma_f32 v73, v73, s28, v11
    v_fma_f32 v68, v68, s28, v11
    v_fma_f32 v71, v71, s28, v11
    v_mfma_f32_16x16x32_bf16 v[160:163], a[216:219], v[22:25], v[160:163]
    v_lshrrev_b32 v105, 11, v0
    v_fma_f32 v64, v64, s28, v10
    v_mfma_f32_16x16x32_bf16 v[208:211], a[216:219], v[26:29], v[208:211]
    v_exp_f32_e64 v71, v71 clamp
    v_mfma_f32_16x16x32_bf16 v[212:215], a[220:223], v[26:29], v[212:215]
    ds_read_b64_tr_b16 a[234:235], v2 offset:7168
    v_xor_b32 v105, s65, v105
    v_mfma_f32_16x16x32_bf16 a[4:7], a[220:223], v[34:37], a[4:7]
    v_exp_f32_e64 v73, v73 clamp
    v_mfma_f32_16x16x32_bf16 a[0:3], a[216:219], v[34:37], a[0:3]
    ds_read_b64_tr_b16 a[238:239], v3 offset:7168
    v_fma_f32 v72, v72, s28, v11
    v_fma_f32 v58, v58, s28, v9
    v_mfma_f32_16x16x32_bf16 a[48:51], a[216:219], v[38:41], a[48:51]
    v_and_b32 v104, 0x3ff, v0
    v_fma_f32 v76, v76, s28, v12
    v_mfma_f32_16x16x32_bf16 a[52:55], a[220:223], v[38:41], a[52:55]
    s_waitcnt lgkmcnt(3)
    ds_read_b64_tr_b16 a[232:233], v2 offset:1024
    v_lshl_add_u32 v104, v105, 10, v104
    v_mfma_f32_16x16x32_bf16 a[56:59], a[224:227], v[38:41], a[56:59]
    v_exp_f32_e64 v64, v64 clamp
    v_mfma_f32_16x16x32_bf16 a[60:63], a[228:231], v[38:41], a[60:63]
    ds_read_b64_tr_b16 a[220:221], v5 offset:1024
    v_fma_f32 v79, v79, s28, v12
    v_mfma_f32_16x16x32_bf16 a[12:15], a[228:231], v[34:37], a[12:15]
    v_fma_f32 v82, v82, s28, v12
    v_fma_f32 v67, v67, s28, v10
    v_mfma_f32_16x16x32_bf16 a[8:11], a[224:227], v[34:37], a[8:11]
    v_fma_f32 v90, v90, s28, v13
    v_fma_f32 v59, v59, s28, v9
    v_mfma_f32_16x16x32_bf16 v[216:219], a[224:227], v[26:29], v[216:219]
    ds_read_b64_tr_b16 a[216:217], v4 offset:1024
    v_add_u32 v104, s38, v104
    v_mfma_f32_16x16x32_bf16 v[220:223], a[228:231], v[26:29], v[220:223]
    ds_read_b128 a[144:147], v104 offset:12288
    v_fma_f32 v78, v78, s28, v12
    v_mfma_f32_16x16x32_bf16 v[172:175], a[228:231], v[22:25], v[172:175]
    ds_read_b64_tr_b16 a[218:219], v4 offset:7168
    v_xor_b32 v105, 64, v104
    v_mfma_f32_16x16x32_bf16 v[168:171], a[224:227], v[22:25], v[168:171]
    ds_read_b128 a[128:131], v104 offset:8192
    v_fma_f32 v56, v56, s28, v9
    v_mfma_f32_16x16x32_bf16 v[120:123], a[224:227], v[14:17], v[120:123]
    v_exp_f32_e64 v76, v76 clamp
    v_mfma_f32_16x16x32_bf16 v[124:127], a[228:231], v[14:17], v[124:127]
    s_waitcnt lgkmcnt(5)
    ds_read_b64_tr_b16 a[222:223], v5 offset:7168
    v_fma_f32 v80, v80, s28, v12
    v_mfma_f32_16x16x32_bf16 v[128:131], a[232:235], v[14:17], v[128:131]
    v_fma_f32 v69, v69, s28, v11
    v_exp_f32_e64 v72, v72 clamp
    v_mfma_f32_16x16x32_bf16 v[132:135], a[236:239], v[14:17], v[132:135]
    ds_read_b128 a[96:99], v104 offset:0
    v_fma_f32 v65, v65, s28, v10
    v_mfma_f32_16x16x32_bf16 v[180:183], a[236:239], v[22:25], v[180:183]
    v_fma_f32 v75, v75, s28, v11
    v_fma_f32 v86, v86, s28, v13
    v_mfma_f32_16x16x32_bf16 v[176:179], a[232:235], v[22:25], v[176:179]
    v_exp_f32_e64 v80, v80 clamp
    v_mfma_f32_16x16x32_bf16 v[224:227], a[232:235], v[26:29], v[224:227]
    v_fma_f32 v77, v77, s28, v12
    v_exp_f32_e64 v90, v90 clamp
    v_mfma_f32_16x16x32_bf16 v[228:231], a[236:239], v[26:29], v[228:231]
    ds_read_b64_tr_b16 a[226:227], v2 offset:8192
    v_exp_f32_e64 v65, v65 clamp
    v_fma_f32 v91, v91, s28, v13
    v_mfma_f32_16x16x32_bf16 a[20:23], a[236:239], v[34:37], a[20:23]
    ds_read_b64_tr_b16 a[224:225], v2 offset:2048
    v_cvt_pk_bf16_f32 v20, v64, v65
    v_mfma_f32_16x16x32_bf16 a[16:19], a[232:235], v[34:37], a[16:19]
    ds_read_b64_tr_b16 a[228:229], v3 offset:2048
    v_fma_f32 v87, v87, s28, v13
    v_mfma_f32_16x16x32_bf16 a[64:67], a[232:235], v[38:41], a[64:67]
    ds_read_b64_tr_b16 a[230:231], v3 offset:8192
    v_fma_f32 v74, v74, s28, v11
    v_mfma_f32_16x16x32_bf16 a[68:71], a[236:239], v[38:41], a[68:71]
    s_waitcnt lgkmcnt(5)
    ds_read_b128 a[168:171], v104 offset:18432
    v_fma_f32 v85, v85, s28, v13
    v_mfma_f32_16x16x32_bf16 a[72:75], a[216:219], v[38:41], a[72:75]
    ds_read_b64_tr_b16 a[234:235], v4 offset:8192
    v_exp_f32_e64 v78, v78 clamp
    v_mfma_f32_16x16x32_bf16 a[76:79], a[220:223], v[38:41], a[76:79]
    ds_read_b64_tr_b16 a[232:233], v4 offset:2048
    v_exp_f32_e64 v79, v79 clamp
    v_mfma_f32_16x16x32_bf16 a[28:31], a[220:223], v[34:37], a[28:31]
    v_fma_f32 v84, v84, s28, v13
    v_exp_f32_e64 v87, v87 clamp
    v_mfma_f32_16x16x32_bf16 a[24:27], a[216:219], v[34:37], a[24:27]
    ds_read_b64_tr_b16 a[238:239], v5 offset:8192
    v_fma_f32 v81, v81, s28, v12
    v_fma_f32 v89, v89, s28, v13
    v_fma_f32 v88, v88, s28, v13
    v_mfma_f32_16x16x32_bf16 v[232:235], a[216:219], v[26:29], v[232:235]
    ds_read_b64_tr_b16 a[236:237], v5 offset:2048
    v_exp_f32_e64 v68, v68 clamp
    v_mfma_f32_16x16x32_bf16 v[236:239], a[220:223], v[26:29], v[236:239]
    ds_read_b128 a[148:151], v105 offset:12288
    v_exp_f32_e64 v77, v77 clamp
    v_mfma_f32_16x16x32_bf16 v[188:191], a[220:223], v[22:25], v[188:191]
    s_add_u32 s39, s39, 12288
    v_exp_f32_e64 v82, v82 clamp
    v_mfma_f32_16x16x32_bf16 v[184:187], a[216:219], v[22:25], v[184:187]
    v_exp_f32_e64 v85, v85 clamp
    v_mfma_f32_16x16x32_bf16 v[136:139], a[216:219], v[14:17], v[136:139]
    v_exp_f32_e64 v91, v91 clamp
    v_mfma_f32_16x16x32_bf16 v[140:143], a[220:223], v[14:17], v[140:143]
    s_waitcnt lgkmcnt(4)
    v_exp_f32_e64 v81, v81 clamp
    v_mfma_f32_16x16x32_bf16 v[144:147], a[224:227], v[14:17], v[144:147]
    ds_read_b128 a[120:123], v104 offset:6144
    v_exp_f32_e64 v84, v84 clamp
    v_mfma_f32_16x16x32_bf16 v[148:151], a[228:231], v[14:17], v[148:151]
    ds_read_b128 a[196:199], v105 offset:24576
    v_exp_f32_e64 v67, v67 clamp
    v_mfma_f32_16x16x32_bf16 v[196:199], a[228:231], v[22:25], v[196:199]
    ds_read_b128 a[108:111], v105 offset:2048
    v_cvt_pk_bf16_f32 v32, v80, v81
    v_mfma_f32_16x16x32_bf16 v[192:195], a[224:227], v[22:25], v[192:195]
    ds_read_b128 a[200:203], v104 offset:26624
    v_fma_f32 v66, v66, s28, v10
    v_mfma_f32_16x16x32_bf16 v[240:243], a[224:227], v[26:29], v[240:243]
    v_exp_f32_e64 v59, v59 clamp
    v_mfma_f32_16x16x32_bf16 v[244:247], a[228:231], v[26:29], v[244:247]
    ds_read_b128 a[132:135], v105 offset:8192
    v_exp_f32_e64 v57, v57 clamp
    v_mfma_f32_16x16x32_bf16 a[36:39], a[228:231], v[34:37], a[36:39]
    s_waitcnt vmcnt(9) lgkmcnt(5)
    v_exp_f32_e64 v56, v56 clamp
    v_mfma_f32_16x16x32_bf16 a[32:35], a[224:227], v[34:37], a[32:35]
    s_add_u32 s21, s21, s62
    ds_read_b128 a[100:103], v105 offset:0
    v_exp_f32_e64 v86, v86 clamp
    v_mfma_f32_16x16x32_bf16 a[80:83], a[224:227], v[38:41], a[80:83]
    s_add_u32 m0, s22, 24576
    ds_read_b128 a[160:163], v104 offset:16384
    v_exp_f32_e64 v75, v75 clamp
    v_mfma_f32_16x16x32_bf16 a[84:87], a[228:231], v[38:41], a[84:87]
    s_barrier
    ds_read_b128 a[216:219], v0 offset:0
    v_mfma_f32_16x16x32_bf16 a[88:91], a[232:235], v[38:41], a[88:91]
    buffer_load_dwordx4 v6, s[8:11], s21 offen lds
    v_mfma_f32_16x16x32_bf16 a[92:95], a[236:239], v[38:41], a[92:95]
    s_add_u32 s21, s21, 128
    ds_read_b128 a[156:159], v105 offset:14336
    v_exp_f32_e64 v69, v69 clamp
    v_mfma_f32_16x16x32_bf16 a[44:47], a[236:239], v[34:37], a[44:47]
    s_add_u32 m0, s22, 25600
    ds_read_b128 a[172:175], v105 offset:18432
    buffer_load_dwordx4 v6, s[8:11], s21 offen lds
    v_mfma_f32_16x16x32_bf16 a[40:43], a[232:235], v[34:37], a[40:43]
    s_add_u32 s21, s21, 128
    ds_read_b128 a[220:223], v1 offset:0
    v_cvt_pk_bf16_f32 v35, v78, v79
    v_mfma_f32_16x16x32_bf16 v[248:251], a[232:235], v[26:29], v[248:251]
    s_add_u32 m0, s22, 26624
    ds_read_b128 a[192:195], v104 offset:24576
    v_cvt_pk_bf16_f32 v34, v76, v77
    v_mfma_f32_16x16x32_bf16 v[252:255], a[236:239], v[26:29], v[252:255]
    buffer_load_dwordx4 v6, s[8:11], s21 offen lds
    ds_read_b128 a[124:127], v105 offset:6144
    v_mfma_f32_16x16x32_bf16 v[204:207], a[236:239], v[22:25], v[204:207]
    ds_read_b128 a[224:227], v0 offset:1024
    v_cvt_pk_bf16_f32 v30, v68, v69
    v_mfma_f32_16x16x32_bf16 v[200:203], a[232:235], v[22:25], v[200:203]
    v_cvt_pk_bf16_f32 v23, v62, v63
    v_exp_f32_e64 v70, v70 clamp
    v_mfma_f32_16x16x32_bf16 v[152:155], a[232:235], v[14:17], v[152:155]
    v_exp_f32_e64 v66, v66 clamp
    v_mfma_f32_16x16x32_bf16 v[156:159], a[236:239], v[14:17], v[156:159]
    s_waitcnt lgkmcnt(6)
    ds_read_b128 a[104:107], v104 offset:2048
    v_cvt_pk_bf16_f32 v22, v60, v61
    v_cvt_pk_bf16_f32 v31, v70, v71
    v_mfma_f32_16x16x32_bf16 v[52:55], a[216:219], a[96:99], 0
    ds_read_b128 a[152:155], v104 offset:14336
    v_cvt_pk_bf16_f32 v28, v72, v73
    v_mfma_f32_16x16x32_bf16 v[60:63], a[216:219], a[120:123], 0
    v_cvt_pk_bf16_f32 v43, v86, v87
    v_exp_f32_e64 v88, v88 clamp
    v_mfma_f32_16x16x32_bf16 v[68:71], a[216:219], a[144:147], 0
    ds_read_b128 a[180:183], v105 offset:20480
    v_cvt_pk_bf16_f32 v16, v56, v57
    v_mfma_f32_16x16x32_bf16 v[76:79], a[216:219], a[168:171], 0
    s_waitcnt lgkmcnt(5)
    v_cvt_pk_bf16_f32 v42, v84, v85
    v_exp_f32_e64 v58, v58 clamp
    v_mfma_f32_16x16x32_bf16 v[84:87], a[216:219], a[192:195], 0
    ds_read_b128 a[176:179], v104 offset:20480
    v_cvt_pk_bf16_f32 v41, v90, v91
    v_mfma_f32_16x16x32_bf16 v[52:55], a[220:223], a[100:103], v[52:55]
    s_waitcnt lgkmcnt(4)
    v_exp_f32_e64 v74, v74 clamp
    v_mfma_f32_16x16x32_bf16 v[60:63], a[220:223], a[124:127], v[60:63]
    v_cvt_pk_bf16_f32 v17, v58, v59
    v_exp_f32_e64 v89, v89 clamp
    v_mfma_f32_16x16x32_bf16 v[68:71], a[220:223], a[148:151], v[68:71]
    ds_read_b128 a[228:231], v1 offset:1024
    v_exp_f32_e64 v83, v83 clamp
    v_mfma_f32_16x16x32_bf16 v[76:79], a[220:223], a[172:175], v[76:79]
    s_add_u32 s21, s21, 12032
    ds_read_b128 a[140:143], v105 offset:10240
    v_cvt_pk_bf16_f32 v33, v82, v83
    v_mfma_f32_16x16x32_bf16 v[84:87], a[220:223], a[196:199], v[84:87]
    s_waitcnt lgkmcnt(4)
    ds_read_b128 a[204:207], v105 offset:26624
    v_cvt_pk_bf16_f32 v21, v66, v67
    v_mfma_f32_16x16x32_bf16 v[52:55], a[224:227], a[104:107], v[52:55]
    ds_read_b128 a[232:235], v0 offset:6144
    v_cvt_pk_bf16_f32 v29, v74, v75
    v_smfmac_f32_16x16x64_bf16 v[48:51], a[240:243], v[16:23], v101
    ds_read_b128 a[136:139], v104 offset:10240
    v_mfma_f32_16x16x32_bf16 v[60:63], a[224:227], a[128:131], v[60:63]
    ds_read_b128 a[116:119], v105 offset:4096
    v_cvt_pk_bf16_f32 v40, v88, v89
    v_smfmac_f32_16x16x64_bf16 v[48:51], a[244:247], v[28:35], v101
    ds_read_b128 a[112:115], v104 offset:4096
    v_mfma_f32_16x16x32_bf16 v[48:51], a[248:251], v[40:43], v[48:51]
    ds_read_b128 a[184:187], v104 offset:22528
    v_mfma_f32_16x16x32_bf16 v[68:71], a[224:227], a[152:155], v[68:71]
    s_waitcnt lgkmcnt(8)
    ds_read_b128 a[236:239], v1 offset:6144
    v_mfma_f32_16x16x32_bf16 v[76:79], a[224:227], a[176:179], v[76:79]
    ds_read_b128 a[188:191], v105 offset:22528
    v_mfma_f32_16x16x32_bf16 v[84:87], a[224:227], a[200:203], v[84:87]
    s_waitcnt lgkmcnt(9)
    ds_read_b128 a[164:167], v105 offset:16384
    v_cmp_lt_f32 vcc, s29, v48
    v_mfma_f32_16x16x32_bf16 v[52:55], a[228:231], a[108:111], v[52:55]
    ds_read_b128 a[220:223], v1 offset:7168
    v_mfma_f32_16x16x32_bf16 v[60:63], a[228:231], a[132:135], v[60:63]
    s_nop 0
    s_nop 0
    s_cbranch_vccnz L_rs_tr55b
L_ret_tr55b:
    v_mfma_f32_16x16x32_bf16 v[68:71], a[228:231], a[156:159], v[68:71]
    ds_read_b128 a[216:219], v0 offset:7168
    v_mov_b32 v110, v45
    v_mfma_f32_16x16x32_bf16 v[76:79], a[228:231], a[180:183], v[76:79]
    s_waitcnt lgkmcnt(8)
    v_lshrrev_b32 v108, 11, v0
    v_mfma_f32_16x16x32_bf16 v[84:87], a[228:231], a[204:207], v[84:87]
    v_xor_b32 v108, s65, v108
    v_mfma_f32_16x16x32_bf16 v[56:59], a[232:235], a[96:99], 0
    v_mov_b32 v109, v50
    v_and_b32 v93, 0x3ff, v0
    v_mfma_f32_16x16x32_bf16 v[64:67], a[232:235], a[120:123], 0
    ds_read_b128 a[224:227], v0 offset:2048
    v_mov_b32 v111, v46
    v_mfma_f32_16x16x32_bf16 v[72:75], a[232:235], a[144:147], 0
    s_nop 0
    v_permlane16_swap_b32 v46, v111
    v_mfma_f32_16x16x32_bf16 v[80:83], a[232:235], a[168:171], 0
    v_permlane16_swap_b32 v50, v109
    v_mfma_f32_16x16x32_bf16 v[88:91], a[232:235], a[192:195], 0
    s_waitcnt lgkmcnt(3)
    v_lshl_add_u32 v93, v108, 10, v93
    v_mfma_f32_16x16x32_bf16 v[56:59], a[236:239], a[100:103], v[56:59]
    v_add_f32 v50, v50, v109
    v_mbcnt_lo_u32_b32 v108, -1, 0
    v_mfma_f32_16x16x32_bf16 v[64:67], a[236:239], a[124:127], v[64:67]
    ds_read_b128 a[232:235], v0 offset:8192
    v_mfma_f32_16x16x32_bf16 v[72:75], a[236:239], a[148:151], v[72:75]
    ds_read_b128 a[228:231], v1 offset:2048
    v_mov_b32 v109, v50
    v_mfma_f32_16x16x32_bf16 v[80:83], a[236:239], a[172:175], v[80:83]
    v_permlane16_swap_b32 v45, v110
    v_mfma_f32_16x16x32_bf16 v[88:91], a[236:239], a[196:199], v[88:91]
    s_waitcnt lgkmcnt(3)
    ds_read_b128 a[236:239], v1 offset:8192
    v_mbcnt_hi_u32_b32 v108, -1, v108
    v_mfma_f32_16x16x32_bf16 v[56:59], a[216:219], a[104:107], v[56:59]
    v_permlane32_swap_b32 v50, v109
    v_mfma_f32_16x16x32_bf16 v[64:67], a[216:219], a[128:131], v[64:67]
    s_waitcnt vmcnt(3)
    v_lshrrev_b32 v108, 1, v108
    v_mfma_f32_16x16x32_bf16 v[72:75], a[216:219], a[152:155], v[72:75]
    v_add_u32 v93, s38, v93
    v_and_b32 v108, 24, v108
    v_mfma_f32_16x16x32_bf16 v[80:83], a[216:219], a[176:179], v[80:83]
    v_add_f32 v45, v45, v110
    v_add_f32 v46, v46, v111
    v_mfma_f32_16x16x32_bf16 v[88:91], a[216:219], a[200:203], v[88:91]
    v_bfe_u32 v108, s66, v108, 8
    v_xor_b32 v93, v93, v108
    v_mfma_f32_16x16x32_bf16 v[56:59], a[220:223], a[108:111], v[56:59]
    v_mov_b32 v108, v49
    v_mov_b32 v111, v46
    v_mfma_f32_16x16x32_bf16 v[64:67], a[220:223], a[132:135], v[64:67]
    v_permlane16_swap_b32 v49, v108
    v_mfma_f32_16x16x32_bf16 v[72:75], a[220:223], a[156:159], v[72:75]
    v_permlane32_swap_b32 v46, v111
    v_mfma_f32_16x16x32_bf16 v[80:83], a[220:223], a[180:183], v[80:83]
    v_add_f32 v94, v109, v46
    s_waitcnt vmcnt(8) lgkmcnt(0)
    v_mfma_f32_16x16x32_bf16 v[88:91], a[220:223], a[204:207], v[88:91]
    s_barrier
    v_mfma_f32_16x16x32_bf16 v[52:55], a[224:227], a[112:115], v[52:55]
    s_add_u32 m0, s22, 0
    ds_read_b64_tr_b16 a[216:217], v2 offset:18432
    buffer_load_dwordx4 v6, s[4:7], s20 offen lds
    v_mfma_f32_16x16x32_bf16 v[60:63], a[224:227], a[136:139], v[60:63]
    s_add_u32 s20, s20, 128
    ds_read_b64_tr_b16 a[218:219], v2 offset:12288
    s_add_u32 m0, s22, 1024
    v_mfma_f32_16x16x32_bf16 v[68:71], a[224:227], a[160:163], v[68:71]
    buffer_load_dwordx4 v6, s[4:7], s20 offen lds
    v_mfma_f32_16x16x32_bf16 v[76:79], a[224:227], a[184:187], v[76:79]
    s_add_u32 s20, s20, 128
    ds_read_b64_tr_b16 a[220:221], v3 offset:18432
    v_mfma_f32_16x16x32_bf16 v[84:87], a[224:227], a[208:211], v[84:87]
    s_add_u32 m0, s22, 2048
    ds_read_b64_tr_b16 a[222:223], v3 offset:12288
    v_mov_b32 v110, v45
    v_mfma_f32_16x16x32_bf16 v[52:55], a[228:231], a[116:119], v[52:55]
    buffer_load_dwordx4 v6, s[4:7], s20 offen lds
    v_mfma_f32_16x16x32_bf16 v[60:63], a[228:231], a[140:143], v[60:63]
    ds_read_b64_tr_b16 a[224:225], v4 offset:18432
    s_add_u32 s20, s20, 12032
    v_mfma_f32_16x16x32_bf16 v[68:71], a[228:231], a[164:167], v[68:71]
    v_add_f32 v49, v49, v108
    v_mov_b32 v108, v49
    v_mfma_f32_16x16x32_bf16 v[76:79], a[228:231], a[188:191], v[76:79]
    v_add_f32 v100, v51, v111
    v_mfma_f32_16x16x32_bf16 v[84:87], a[228:231], a[212:215], v[84:87]
    v_permlane32_swap_b32 v45, v110
    v_mfma_f32_16x16x32_bf16 v[56:59], a[232:235], a[112:115], v[56:59]
    v_permlane32_swap_b32 v49, v108
    v_mfma_f32_16x16x32_bf16 v[64:67], a[232:235], a[136:139], v[64:67]
    v_add_f32 v92, v108, v45
    v_add_f32 v48, v49, v47
    v_mfma_f32_16x16x32_bf16 v[72:75], a[232:235], a[160:163], v[72:75]
    v_rcp_f32 v48, v48
    v_mfma_f32_16x16x32_bf16 v[80:83], a[232:235], a[184:187], v[80:83]
    ds_read_b64_tr_b16 a[226:227], v4 offset:12288
    v_add_f32 v50, v50, v110
    v_mfma_f32_16x16x32_bf16 v[88:91], a[232:235], a[208:211], v[88:91]
    ds_read_b64_tr_b16 a[228:229], v5 offset:18432
    v_mfma_f32_16x16x32_bf16 v[56:59], a[236:239], a[116:119], v[56:59]
    v_rcp_f32 v50, v50
    v_mfma_f32_16x16x32_bf16 v[64:67], a[236:239], a[140:143], v[64:67]
    v_rcp_f32 v92, v92
    v_mfma_f32_16x16x32_bf16 v[72:75], a[236:239], a[164:167], v[72:75]
    ds_read_b64_tr_b16 a[230:231], v5 offset:12288
    v_mfma_f32_16x16x32_bf16 v[80:83], a[236:239], a[188:191], v[80:83]
    v_rcp_f32 v100, v100
    v_mfma_f32_16x16x32_bf16 v[88:91], a[236:239], a[212:215], v[88:91]
    s_waitcnt lgkmcnt(3)
    v_rcp_f32 v94, v94
    v_mfma_f32_16x16x32_bf16 v[112:115], a[216:219], v[16:19], v[112:115]
    s_mov_b32 s67, s34
    v_max3_f32 v99, v76, v77, v78
    v_subrev_u32 v103, 28672, v103
    v_max3_f32 v96, v52, v53, v54
    v_max3_f32 v98, v68, v69, v70
    v_mfma_f32_16x16x32_bf16 v[116:119], a[220:223], v[16:19], v[116:119]
    s_add_u32 s18, s34, 30720
    ds_read_b64_tr_b16 a[238:239], v3 offset:13312
    v_max3_f32 v98, v98, v71, v72
    v_max3_f32 v98, v98, v73, v74
    v_mfma_f32_16x16x32_bf16 v[164:167], a[220:223], v[20:23], v[164:167]
    v_max3_f32 v97, v60, v61, v62
    v_max3_f32 v96, v96, v55, v56
    v_max3_f32 v97, v97, v63, v64
    v_mfma_f32_16x16x32_bf16 v[160:163], a[216:219], v[20:23], v[160:163]
    s_mov_b32 s34, s33
    v_max3_f32 v97, v97, v65, v66
    v_max_f32 v97, v97, v67
    v_max3_f32 v96, v96, v57, v58
    v_mfma_f32_16x16x32_bf16 v[208:211], a[216:219], v[28:31], v[208:211]
    s_add_u32 s64, s64, s62
    ds_read_b64_tr_b16 a[236:237], v3 offset:19456
    v_max3_f32 v99, v99, v79, v80
    v_mfma_f32_16x16x32_bf16 v[212:215], a[220:223], v[28:31], v[212:215]
    s_add_u32 s64, s64, 196608
    ds_read_b64_tr_b16 a[232:233], v2 offset:19456
    v_max_f32 v96, v96, v59
    v_mfma_f32_16x16x32_bf16 a[4:7], a[220:223], v[32:35], a[4:7]
    v_max3_f32 v99, v99, v81, v82
    v_max_f32 v98, v98, v75
    v_max_f32 v99, v99, v83
    v_mfma_f32_16x16x32_bf16 a[0:3], a[216:219], v[32:35], a[0:3]
    s_mov_b32 s39, s64
    ds_read_b64_tr_b16 a[234:235], v2 offset:13312
    v_permlane32_swap_b32 v98, v99
    v_mfma_f32_16x16x32_bf16 a[48:51], a[216:219], v[40:43], a[48:51]
    s_add_u32 s37, s37, 1
    v_permlane32_swap_b32 v96, v97
    v_mfma_f32_16x16x32_bf16 a[52:55], a[220:223], v[40:43], a[52:55]
    s_waitcnt lgkmcnt(4)
    v_max_f32 v96, v96, v97
    v_max_f32 v98, v98, v99
    v_mfma_f32_16x16x32_bf16 a[56:59], a[224:227], v[40:43], a[56:59]
    s_bitcmp1_b32 s63, s37
    v_permlane16_swap_b32 v96, v98
    v_max_f32 v96, v96, v98
    v_mul_f32_e64 v9, -s28, v96
    v_mfma_f32_16x16x32_bf16 a[60:63], a[228:231], v[40:43], a[60:63]
    s_cselect_b32 s62, 4294770688, 0
    v_accvgpr_read_b32 v106, a2
    v_subrev_f32 v9, 0x42000000, v9
    v_mfma_f32_16x16x32_bf16 a[12:15], a[228:231], v[32:35], a[12:15]
    s_cselect_b32 s42, 0, 325632
    v_max3_f32 v96, v84, v85, v86
    v_mov_b32 v11, v9
    v_mfma_f32_16x16x32_bf16 a[8:11], a[224:227], v[32:35], a[8:11]
    s_add_u32 s35, s35, s42
    ds_read_b64_tr_b16 a[216:217], v4 offset:19456
    v_permlane16_swap_b32 v9, v11
    v_mfma_f32_16x16x32_bf16 v[216:219], a[224:227], v[28:31], v[216:219]
    s_lshl_b32 s42, s37, 1
    v_accvgpr_read_b32 v107, a3
    v_mov_b32 v12, v11
    v_mfma_f32_16x16x32_bf16 v[220:223], a[228:231], v[28:31], v[220:223]
    s_lshr_b32 s42, s31, s42
    v_permlane32_swap_b32 v11, v12
    v_mfma_f32_16x16x32_bf16 v[172:175], a[228:231], v[20:23], v[172:175]
    s_and_b32 s42, s42, 3
    ds_read_b64_tr_b16 a[218:219], v4 offset:13312
    v_mov_b32 v10, v9
    v_mfma_f32_16x16x32_bf16 v[168:171], a[224:227], v[20:23], v[168:171]
    s_add_u32 s42, s42, s36
    ds_read_b64_tr_b16 a[222:223], v5 offset:13312
    v_max3_f32 v96, v96, v87, v88
    v_accvgpr_read_b32 v110, a50
    v_mfma_f32_16x16x32_bf16 v[120:123], a[224:227], v[16:19], v[120:123]
    s_sub_u32 s43, s42, 3
    ds_read_b64_tr_b16 a[220:221], v5 offset:19456
    v_permlane32_swap_b32 v9, v10
    v_mfma_f32_16x16x32_bf16 v[124:127], a[228:231], v[16:19], v[124:127]
    s_waitcnt lgkmcnt(4)
    v_max3_f32 v96, v96, v89, v90
    v_fma_f32 v68, v68, s28, v11
    v_max_f32 v96, v96, v91
    v_mfma_f32_16x16x32_bf16 v[128:131], a[232:235], v[16:19], v[128:131]
    s_cmp_ge_u32 s42, 3
    v_fma_f32 v58, v58, s28, v9
    v_mov_b32 v97, v96
    v_mfma_f32_16x16x32_bf16 v[132:135], a[236:239], v[16:19], v[132:135]
    s_cselect_b32 s42, s43, s42
    v_permlane32_swap_b32 v97, v96
    v_mfma_f32_16x16x32_bf16 v[180:183], a[236:239], v[20:23], v[180:183]
    s_mul_i32 s44, s3, 5
    ds_read_b64_tr_b16 a[226:227], v2 offset:14336
    v_fma_f32 v57, v57, s28, v9
    v_mfma_f32_16x16x32_bf16 v[176:179], a[232:235], v[20:23], v[176:179]
    s_mov_b32 s32, 1
    v_fma_f32 v76, v76, s28, v12
    v_fma_f32 v71, v71, s28, v11
    v_mfma_f32_16x16x32_bf16 v[224:227], a[232:235], v[28:31], v[224:227]
    s_lshl_b32 s43, s3, 2
    v_max_f32 v96, v96, v97
    v_fma_f32 v60, v60, s28, v10
    v_mfma_f32_16x16x32_bf16 v[228:231], a[236:239], v[28:31], v[228:231]
    s_add_u32 s45, s43, 21
    ds_read_b64_tr_b16 a[228:229], v3 offset:20480
    v_fma_f32 v79, v79, s28, v12
    v_fma_f32 v62, v62, s28, v10
    v_mfma_f32_16x16x32_bf16 a[20:23], a[236:239], v[32:35], a[20:23]
    s_cmp_eq_u32 s3, 0
    v_mov_b32 v97, v96
    s_cselect_b32 s45, 20, s45
    v_fma_f32 v61, v61, s28, v10
    v_mfma_f32_16x16x32_bf16 a[16:19], a[232:235], v[32:35], a[16:19]
    s_cselect_b32 s33, 1, 0
    v_permlane16_swap_b32 v97, v96
    v_mfma_f32_16x16x32_bf16 a[64:67], a[232:235], v[40:43], a[64:67]
    s_cmp_eq_u32 s42, 1
    ds_read_b64_tr_b16 a[230:231], v3 offset:14336
    v_fma_f32 v53, v53, s28, v9
    v_fma_f32 v55, v55, s28, v9
    v_mfma_f32_16x16x32_bf16 a[68:71], a[236:239], v[40:43], a[68:71]
    s_waitcnt lgkmcnt(3)
    v_max_f32 v96, v96, v97
    v_fma_f32 v78, v78, s28, v12
    v_mfma_f32_16x16x32_bf16 a[72:75], a[216:219], v[40:43], a[72:75]
    s_cselect_b32 s44, s45, s44
    ds_read_b64_tr_b16 a[224:225], v2 offset:20480
    v_fma_f32 v83, v83, s28, v12
    v_mfma_f32_16x16x32_bf16 a[76:79], a[220:223], v[40:43], a[76:79]
    s_cselect_b32 s32, s33, s32
    v_mul_f32_e64 v13, -s28, v96
    v_subrev_f32 v13, 0x42000000, v13
    v_fma_f32 v52, v52, s28, v9
    v_exp_f32_e64 v62, v62 clamp
    v_mfma_f32_16x16x32_bf16 a[28:31], a[220:223], v[32:35], a[28:31]
    s_add_u32 s45, s43, 37
    ds_read_b64_tr_b16 a[234:235], v4 offset:14336
    v_fma_f32 v80, v80, s28, v12
    v_mfma_f32_16x16x32_bf16 a[24:27], a[216:219], v[32:35], a[24:27]
    s_cmp_eq_u32 s42, 2
    v_accvgpr_read_b32 v104, a0
    v_fma_f32 v90, v90, s28, v13
    v_mfma_f32_16x16x32_bf16 v[232:235], a[216:219], v[28:31], v[232:235]
    s_cselect_b32 s44, s45, s44
    v_fma_f32 v84, v84, s28, v13
    v_accvgpr_read_b32 v109, a49
    v_mfma_f32_16x16x32_bf16 v[236:239], a[220:223], v[28:31], v[236:239]
    s_cselect_b32 s32, 0, s32
    v_exp_f32_e64 v84, v84 clamp
    v_mfma_f32_16x16x32_bf16 v[188:191], a[220:223], v[20:23], v[188:191]
    s_mul_i32 s44, s44, 6144
    v_fma_f32 v59, v59, s28, v9
    v_fma_f32 v75, v75, s28, v11
    v_mfma_f32_16x16x32_bf16 v[184:187], a[216:219], v[20:23], v[184:187]
    s_add_u32 s33, s35, s44
    v_exp_f32_e64 v55, v55 clamp
    v_mfma_f32_16x16x32_bf16 v[136:139], a[216:219], v[16:19], v[136:139]
    s_mul_i32 s42, s32, 6144
    ds_read_b64_tr_b16 a[232:233], v4 offset:20480
    v_fma_f32 v91, v91, s28, v13
    v_mfma_f32_16x16x32_bf16 v[140:143], a[220:223], v[16:19], v[140:143]
    s_waitcnt lgkmcnt(2)
    v_fma_f32 v54, v54, s28, v9
    v_fma_f32 v64, v64, s28, v10
    v_mfma_f32_16x16x32_bf16 v[144:147], a[224:227], v[16:19], v[144:147]
    s_add_u32 s42, s42, 24576
    ds_read_b64_tr_b16 a[236:237], v5 offset:20480
    v_fma_f32 v67, v67, s28, v10
    v_mfma_f32_16x16x32_bf16 v[148:151], a[228:231], v[16:19], v[148:151]
    s_add_u32 s42, s42, s33
    ds_read_b64_tr_b16 a[238:239], v5 offset:14336
    v_exp_f32_e64 v71, v71 clamp
    v_mfma_f32_16x16x32_bf16 v[196:199], a[228:231], v[20:23], v[196:199]
    s_cmp_ge_u32 s37, 6
    v_fma_f32 v85, v85, s28, v13
    v_fma_f32 v69, v69, s28, v11
    v_mfma_f32_16x16x32_bf16 v[192:195], a[224:227], v[20:23], v[192:195]
    s_cselect_b32 s14, 0, s42
    v_fma_f32 v74, v74, s28, v11
    v_fma_f32 v70, v70, s28, v11
    v_fma_f32 v87, v87, s28, v13
    v_mfma_f32_16x16x32_bf16 v[240:243], a[224:227], v[28:31], v[240:243]
    s_add_u32 s24, s67, 256
    v_exp_f32_e64 v68, v68 clamp
    v_mfma_f32_16x16x32_bf16 v[244:247], a[228:231], v[28:31], v[244:247]
    s_add_u32 s25, s33, 256
    v_exp_f32_e64 v54, v54 clamp
    v_mfma_f32_16x16x32_bf16 a[36:39], a[228:231], v[32:35], a[36:39]
    s_add_u32 s23, s38, 4096
    v_fma_f32 v63, v63, s28, v10
    v_fma_f32 v86, v86, s28, v13
    v_exp_f32_e64 v69, v69 clamp
    v_exp_f32_e64 v52, v52 clamp
    v_mfma_f32_16x16x32_bf16 a[32:35], a[224:227], v[32:35], a[32:35]
    s_mov_b32 s27, 0x249
    v_fma_f32 v81, v81, s28, v12
    v_fma_f32 v56, v56, s28, v9
    v_mfma_f32_16x16x32_bf16 a[80:83], a[224:227], v[40:43], a[80:83]
    s_mov_b32 s30, 0
    v_exp_f32_e64 v53, v53 clamp
    v_cvt_pk_bf16_f32 v15, v54, v55
    v_mfma_f32_16x16x32_bf16 a[84:87], a[228:231], v[40:43], a[84:87]
    s_waitcnt vmcnt(8) lgkmcnt(0)
    v_exp_f32_e64 v70, v70 clamp
    v_mfma_f32_16x16x32_bf16 a[88:91], a[232:235], v[40:43], a[88:91]
    s_barrier
    ds_read_b128 a[220:223], v1 offset:12288
    v_cvt_pk_bf16_f32 v14, v52, v53
    v_mfma_f32_16x16x32_bf16 a[92:95], a[236:239], v[40:43], a[92:95]
    ds_read_b128 a[216:219], v0 offset:12288
    v_accvgpr_read_b32 v111, a51
    v_mfma_f32_16x16x32_bf16 a[44:47], a[236:239], v[32:35], a[44:47]
    ds_read_b128 a[224:227], v0 offset:13312
    v_exp_f32_e64 v87, v87 clamp
    v_mfma_f32_16x16x32_bf16 a[40:43], a[232:235], v[32:35], a[40:43]
    v_exp_f32_e64 v63, v63 clamp
    v_exp_f32_e64 v61, v61 clamp
    v_mfma_f32_16x16x32_bf16 v[248:251], a[232:235], v[28:31], v[248:251]
    v_exp_f32_e64 v58, v58 clamp
    v_mfma_f32_16x16x32_bf16 v[252:255], a[236:239], v[28:31], v[252:255]
    v_exp_f32_e64 v74, v74 clamp
    v_fma_f32 v77, v77, s28, v12
    v_cvt_pk_bf16_f32 v26, v68, v69
    v_fma_f32 v73, v73, s28, v11
    v_mfma_f32_16x16x32_bf16 v[204:207], a[236:239], v[20:23], v[204:207]
    ds_read_b128 a[228:231], v1 offset:13312
    v_exp_f32_e64 v85, v85 clamp
    v_mfma_f32_16x16x32_bf16 v[200:203], a[232:235], v[20:23], v[200:203]
    v_exp_f32_e64 v79, v79 clamp
    v_mfma_f32_16x16x32_bf16 v[152:155], a[232:235], v[16:19], v[152:155]
    v_exp_f32_e64 v60, v60 clamp
    v_exp_f32_e64 v76, v76 clamp
    v_mfma_f32_16x16x32_bf16 v[156:159], a[236:239], v[16:19], v[156:159]
    s_waitcnt lgkmcnt(2)
    v_cvt_pk_bf16_f32 v38, v84, v85
    v_exp_f32_e64 v80, v80 clamp
    v_mfma_f32_16x16x32_bf16 v[52:55], a[216:219], a[96:99], 0
    ds_read_b128 a[236:239], v1 offset:14336
    v_cvt_pk_bf16_f32 v27, v70, v71
    v_mfma_f32_16x16x32_bf16 v[52:55], a[220:223], a[100:103], v[52:55]
    s_waitcnt lgkmcnt(2)
    v_cvt_pk_bf16_f32 v22, v60, v61
    v_cvt_pk_bf16_f32 v23, v62, v63
    v_mfma_f32_16x16x32_bf16 v[52:55], a[224:227], a[104:107], v[52:55]
    v_exp_f32_e64 v86, v86 clamp
    v_mfma_f32_16x16x32_bf16 v[60:63], a[224:227], a[128:131], 0
    ds_read_b128 a[232:235], v0 offset:14336
    v_fma_f32 v82, v82, s28, v12
    v_mfma_f32_16x16x32_bf16 v[60:63], a[220:223], a[124:127], v[60:63]
    v_exp_f32_e64 v78, v78 clamp
    v_mfma_f32_16x16x32_bf16 v[60:63], a[216:219], a[120:123], v[60:63]
    v_exp_f32_e64 v77, v77 clamp
    v_mfma_f32_16x16x32_bf16 v[68:71], a[216:219], a[144:147], 0
    v_cvt_pk_bf16_f32 v34, v76, v77
    v_cvt_pk_bf16_f32 v35, v78, v79
    v_mfma_f32_16x16x32_bf16 v[68:71], a[220:223], a[148:151], v[68:71]
    v_exp_f32_e64 v83, v83 clamp
    v_mfma_f32_16x16x32_bf16 v[68:71], a[224:227], a[152:155], v[68:71]
    v_fma_f32 v72, v72, s28, v11
    v_cvt_pk_bf16_f32 v39, v86, v87
    v_mfma_f32_16x16x32_bf16 v[76:79], a[224:227], a[176:179], 0
    s_add_u32 m0, s22, 36864
    v_fma_f32 v89, v89, s28, v13
    v_fma_f32 v66, v66, s28, v10
    v_mfma_f32_16x16x32_bf16 v[76:79], a[220:223], a[172:175], v[76:79]
    v_exp_f32_e64 v81, v81 clamp
    v_mfma_f32_16x16x32_bf16 v[76:79], a[216:219], a[168:171], v[76:79]
    v_exp_f32_e64 v57, v57 clamp
    v_mfma_f32_16x16x32_bf16 v[84:87], a[216:219], a[192:195], 0
    v_exp_f32_e64 v59, v59 clamp
    v_mfma_f32_16x16x32_bf16 v[84:87], a[220:223], a[196:199], v[84:87]
    v_exp_f32_e64 v67, v67 clamp
    v_mfma_f32_16x16x32_bf16 v[84:87], a[224:227], a[200:203], v[84:87]
    s_waitcnt lgkmcnt(0)
    ds_read_b128 a[216:219], v0 offset:18432
    v_accvgpr_read_b32 v105, a1
    v_mfma_f32_16x16x32_bf16 v[84:87], a[228:231], a[204:207], v[84:87]
    v_exp_f32_e64 v56, v56 clamp
    v_mfma_f32_16x16x32_bf16 v[84:87], a[232:235], a[208:211], v[84:87]
    v_exp_f32_e64 v75, v75 clamp
    v_mfma_f32_16x16x32_bf16 v[84:87], a[236:239], a[212:215], v[84:87]
    v_exp_f32_e64 v82, v82 clamp
    v_fma_f32 v88, v88, s28, v13
    v_mfma_f32_16x16x32_bf16 v[76:79], a[236:239], a[188:191], v[76:79]
    v_exp_f32_e64 v89, v89 clamp
    v_mfma_f32_16x16x32_bf16 v[76:79], a[232:235], a[184:187], v[76:79]
    buffer_load_dwordx4 v6, s[8:11], s21 offen lds
    v_mfma_f32_16x16x32_bf16 v[76:79], a[228:231], a[180:183], v[76:79]
    s_add_u32 s21, s21, 128
    ds_read_b128 a[220:223], v1 offset:18432
    v_cvt_pk_bf16_f32 v16, v56, v57
    v_mfma_f32_16x16x32_bf16 v[68:71], a[228:231], a[156:159], v[68:71]
    ds_read_b128 a[224:227], v0 offset:19456
    v_fma_f32 v87, v87, s28, v13
    v_mfma_f32_16x16x32_bf16 v[68:71], a[232:235], a[160:163], v[68:71]
    v_exp_f32_e64 v66, v66 clamp
    v_mfma_f32_16x16x32_bf16 v[68:71], a[236:239], a[164:167], v[68:71]
    v_fma_f32 v85, v85, s28, v13
    v_cvt_pk_bf16_f32 v25, v66, v67
    v_mfma_f32_16x16x32_bf16 v[60:63], a[236:239], a[140:143], v[60:63]
    v_exp_f32_e64 v88, v88 clamp
    v_mfma_f32_16x16x32_bf16 v[60:63], a[232:235], a[136:139], v[60:63]
    v_exp_f32_e64 v87, v87 clamp
    v_mfma_f32_16x16x32_bf16 v[60:63], a[228:231], a[132:135], v[60:63]
    v_fma_f32 v65, v65, s28, v10
    v_cvt_pk_bf16_f32 v36, v80, v81
    v_mfma_f32_16x16x32_bf16 v[52:55], a[228:231], a[108:111], v[52:55]
    s_add_u32 m0, s22, 37888
    ds_read_b128 a[228:231], v1 offset:19456
    v_fma_f32 v84, v84, s28, v13
    v_mfma_f32_16x16x32_bf16 v[52:55], a[232:235], a[112:115], v[52:55]
    v_exp_f32_e64 v64, v64 clamp
    v_cvt_pk_bf16_f32 v37, v82, v83
    v_exp_f32_e64 v72, v72 clamp
    v_mfma_f32_16x16x32_bf16 v[52:55], a[236:239], a[116:119], v[52:55]
    s_waitcnt lgkmcnt(2)
    v_cvt_pk_bf16_f32 v17, v58, v59
    v_accvgpr_read_b32 v108, a48
    v_mfma_f32_16x16x32_bf16 v[56:59], a[216:219], a[96:99], 0
    v_exp_f32_e64 v84, v84 clamp
    v_mfma_f32_16x16x32_bf16 v[56:59], a[220:223], a[100:103], v[56:59]
    s_waitcnt lgkmcnt(1)
    v_exp_f32_e64 v65, v65 clamp
    v_mfma_f32_16x16x32_bf16 v[56:59], a[224:227], a[104:107], v[56:59]
    buffer_load_dwordx4 v6, s[8:11], s21 offen lds
    v_exp_f32_e64 v73, v73 clamp
    v_cvt_pk_bf16_f32 v24, v64, v65
    v_pk_mul_f32 v[218:219], v[218:219], v[50:51] op_sel_hi:[1,0]
    v_pk_mul_f32 v[110:111], v[110:111], v[100:101] op_sel_hi:[1,0]
    v_pk_mul_f32 v[116:117], v[116:117], v[48:49] op_sel_hi:[1,0]
    v_pk_mul_f32 v[208:209], v[208:209], v[50:51] op_sel_hi:[1,0]
    v_pk_mul_f32 v[164:165], v[164:165], v[92:93] op_sel_hi:[1,0]
    v_fma_f32 v63, v63, s28, v10
    v_cvt_pk_bf16_f32 v29, v74, v75
    v_pk_mul_f32 v[136:137], v[136:137], v[48:49] op_sel_hi:[1,0]
    v_fma_f32 v53, v53, s28, v9
    v_pk_mul_f32 v[224:225], v[224:225], v[50:51] op_sel_hi:[1,0]
    v_fma_f32 v71, v71, s28, v11
    v_pk_mul_f32 v[178:179], v[178:179], v[92:93] op_sel_hi:[1,0]
    v_pk_mul_f32 v[216:217], v[216:217], v[50:51] op_sel_hi:[1,0]
    v_pk_mul_f32 v[112:113], v[112:113], v[48:49] op_sel_hi:[1,0]
    v_pk_mul_f32 v[210:211], v[210:211], v[50:51] op_sel_hi:[1,0]
    v_pk_mul_f32 v[150:151], v[150:151], v[48:49] op_sel_hi:[1,0]
    v_pk_mul_f32 v[106:107], v[106:107], v[94:95] op_sel_hi:[1,0]
    v_pk_mul_f32 v[168:169], v[168:169], v[92:93] op_sel_hi:[1,0]
    v_pk_mul_f32 v[104:105], v[104:105], v[94:95] op_sel_hi:[1,0]
    v_pk_mul_f32 v[160:161], v[160:161], v[92:93] op_sel_hi:[1,0]
    v_pk_mul_f32 v[122:123], v[122:123], v[48:49] op_sel_hi:[1,0]
    v_cvt_pk_bf16_f32 v40, v88, v89
    v_pk_mul_f32 v[124:125], v[124:125], v[48:49] op_sel_hi:[1,0]
    v_pk_mul_f32 v[130:131], v[130:131], v[48:49] op_sel_hi:[1,0]
    v_pk_mul_f32 v[176:177], v[176:177], v[92:93] op_sel_hi:[1,0]
    v_pk_mul_f32 v[108:109], v[108:109], v[100:101] op_sel_hi:[1,0]
    v_fma_f32 v76, v76, s28, v12
    v_pk_mul_f32 v[220:221], v[220:221], v[50:51] op_sel_hi:[1,0]
    v_pk_mul_f32 v[114:115], v[114:115], v[48:49] op_sel_hi:[1,0]
    v_pk_mul_f32 v[214:215], v[214:215], v[50:51] op_sel_hi:[1,0]
    v_pk_mul_f32 v[170:171], v[170:171], v[92:93] op_sel_hi:[1,0]
    v_pk_mul_f32 v[162:163], v[162:163], v[92:93] op_sel_hi:[1,0]
    v_cvt_pk_bf16_f32 v112, v112, v113
    v_pk_mul_f32 v[190:191], v[190:191], v[92:93] op_sel_hi:[1,0]
    v_exp_f32_e64 v91, v91 clamp
    v_fma_f32 v68, v68, s28, v11
    v_mfma_f32_16x16x32_bf16 v[64:67], a[224:227], a[128:131], 0
    v_cvt_pk_bf16_f32 v160, v160, v161
    v_cvt_pk_bf16_f32 v108, v108, v109
    v_cvt_pk_bf16_f32 v28, v72, v73
    v_cvt_pk_bf16_f32 v136, v136, v137
    v_mfma_f32_16x16x32_bf16 v[64:67], a[220:223], a[124:127], v[64:67]
    ds_read_b128 a[236:239], v1 offset:20480
    v_cvt_pk_bf16_f32 v161, v162, v163
    v_mfma_f32_16x16x32_bf16 v[64:67], a[216:219], a[120:123], v[64:67]
    ds_read_b128 a[232:235], v0 offset:20480
    v_cvt_pk_bf16_f32 v208, v208, v209
    v_cvt_pk_bf16_f32 v104, v104, v105
    v_mfma_f32_16x16x32_bf16 v[72:75], a[216:219], a[144:147], 0
    v_exp_f32_e64 v90, v90 clamp
    v_mfma_f32_16x16x32_bf16 v[72:75], a[220:223], a[148:151], v[72:75]
    s_add_u32 s21, s21, 128
    v_cvt_pk_bf16_f32 v113, v114, v115
    v_cvt_pk_bf16_f32 v41, v90, v91
    v_mfma_f32_16x16x32_bf16 v[72:75], a[224:227], a[152:155], v[72:75]
    s_add_u32 m0, s22, 38912
    v_cvt_pk_bf16_f32 v109, v110, v111
    v_fma_f32 v62, v62, s28, v10
    v_cvt_pk_bf16_f32 v105, v106, v107
    v_mfma_f32_16x16x32_bf16 v[80:83], a[224:227], a[176:179], 0
    v_accvgpr_read_b32 v107, a7
    v_cvt_pk_bf16_f32 v116, v116, v117
    v_mfma_f32_16x16x32_bf16 v[80:83], a[220:223], a[172:175], v[80:83]
    buffer_load_dwordx4 v6, s[8:11], s21 offen lds
    v_fma_f32 v55, v55, s28, v9
    v_mfma_f32_16x16x32_bf16 v[80:83], a[216:219], a[168:171], v[80:83]
    v_exp_f32_e64 v71, v71 clamp
    v_accvgpr_read_b32 v106, a6
    v_mfma_f32_16x16x32_bf16 v[88:91], a[216:219], a[192:195], 0
    v_fma_f32 v77, v77, s28, v12
    v_cvt_pk_bf16_f32 v168, v168, v169
    v_mfma_f32_16x16x32_bf16 v[88:91], a[220:223], a[196:199], v[88:91]
    s_add_u32 s21, s21, 12032
    ds_write2st64_b64 v93, v[112:113], v[160:161] offset0:0 offset1:12
    v_mfma_f32_16x16x32_bf16 v[88:91], a[224:227], a[200:203], v[88:91]
    s_waitcnt vmcnt(6) lgkmcnt(1)
    v_fma_f32 v70, v70, s28, v11
    v_cvt_pk_bf16_f32 v209, v210, v211
    v_mfma_f32_16x16x32_bf16 v[44:47], a[248:251], v[14:17], 0
    v_exp_f32_e64 v62, v62 clamp
    v_mfma_f32_16x16x32_bf16 v[88:91], a[228:231], a[204:207], v[88:91]
    s_barrier
    ds_read_b64_tr_b16 a[216:217], v2 offset:0
    v_mfma_f32_16x16x32_bf16 v[88:91], a[232:235], a[208:211], v[88:91]
    v_exp_f32_e64 v85, v85 clamp
    v_mfma_f32_16x16x32_bf16 v[88:91], a[236:239], a[212:215], v[88:91]
    v_accvgpr_read_b32 v110, a54
    v_accvgpr_read_b32 v111, a55
    v_mfma_f32_16x16x32_bf16 v[80:83], a[236:239], a[188:191], v[80:83]
    s_add_u32 m0, s22, 12288
    v_cvt_pk_bf16_f32 v169, v170, v171
    v_cvt_pk_bf16_f32 v216, v216, v217
    v_mfma_f32_16x16x32_bf16 v[80:83], a[232:235], a[184:187], v[80:83]
    ds_write2st64_b64 v93, v[208:209], v[104:105] offset0:24 offset1:36
    v_mfma_f32_16x16x32_bf16 v[80:83], a[228:231], a[180:183], v[80:83]
    ds_read_b64_tr_b16 a[218:219], v2 offset:6144
    v_exp_f32_e64 v77, v77 clamp
    v_mfma_f32_16x16x32_bf16 v[72:75], a[228:231], a[156:159], v[72:75]
    v_fma_f32 v52, v52, s28, v9
    v_exp_f32_e64 v63, v63 clamp
    v_mfma_f32_16x16x32_bf16 v[72:75], a[232:235], a[160:163], v[72:75]
    ds_write_b64 v93, v[108:109] offset:24576
    v_mfma_f32_16x16x32_bf16 v[72:75], a[236:239], a[164:167], v[72:75]
    ds_read_b64_tr_b16 a[220:221], v3 offset:0
    v_fma_f32 v83, v83, s28, v12
    v_mfma_f32_16x16x32_bf16 v[64:67], a[236:239], a[140:143], v[64:67]
    v_exp_f32_e64 v68, v68 clamp
    v_exp_f32_e64 v55, v55 clamp
    v_mfma_f32_16x16x32_bf16 v[64:67], a[232:235], a[136:139], v[64:67]
    ds_read_b64_tr_b16 a[222:223], v3 offset:6144
    v_fma_f32 v69, v69, s28, v11
    v_mfma_f32_16x16x32_bf16 v[64:67], a[228:231], a[132:135], v[64:67]
    v_accvgpr_read_b32 v108, a52
    v_accvgpr_read_b32 v104, a4
    v_accvgpr_read_b32 v109, a53
    v_exp_f32_e64 v70, v70 clamp
    v_xor_b32 v93, 32, v93
    v_pk_mul_f32 v[128:129], v[128:129], v[48:49] op_sel_hi:[1,0]
    v_accvgpr_read_b32 v105, a5
    v_pk_mul_f32 v[186:187], v[186:187], v[92:93] op_sel_hi:[1,0]
    v_fma_f32 v74, v74, s28, v11
    v_pk_mul_f32 v[212:213], v[212:213], v[50:51] op_sel_hi:[1,0]
    v_pk_mul_f32 v[166:167], v[166:167], v[92:93] op_sel_hi:[1,0]
    v_cvt_pk_bf16_f32 v124, v124, v125
    v_fma_f32 v91, v91, s28, v13
    v_pk_mul_f32 v[172:173], v[172:173], v[92:93] op_sel_hi:[1,0]
    v_pk_mul_f32 v[108:109], v[108:109], v[100:101] op_sel_hi:[1,0]
    v_pk_mul_f32 v[202:203], v[202:203], v[92:93] op_sel_hi:[1,0]
    v_pk_mul_f32 v[200:201], v[200:201], v[92:93] op_sel_hi:[1,0]
    v_pk_mul_f32 v[254:255], v[254:255], v[50:51] op_sel_hi:[1,0]
    v_pk_mul_f32 v[120:121], v[120:121], v[48:49] op_sel_hi:[1,0]
    v_pk_mul_f32 v[152:153], v[152:153], v[48:49] op_sel_hi:[1,0]
    v_pk_mul_f32 v[182:183], v[182:183], v[92:93] op_sel_hi:[1,0]
    v_pk_mul_f32 v[104:105], v[104:105], v[94:95] op_sel_hi:[1,0]
    v_cvt_pk_bf16_f32 v164, v164, v165
    v_fma_f32 v75, v75, s28, v11
    v_pk_mul_f32 v[196:197], v[196:197], v[92:93] op_sel_hi:[1,0]
    v_pk_mul_f32 v[240:241], v[240:241], v[50:51] op_sel_hi:[1,0]
    v_pk_mul_f32 v[118:119], v[118:119], v[48:49] op_sel_hi:[1,0]
    v_cvt_pk_bf16_f32 v165, v166, v167
    v_cvt_pk_bf16_f32 v108, v108, v109
    v_cvt_pk_bf16_f32 v212, v212, v213
    v_fma_f32 v82, v82, s28, v12
    v_pk_mul_f32 v[244:245], v[244:245], v[50:51] op_sel_hi:[1,0]
    v_cvt_pk_bf16_f32 v220, v220, v221
    v_pk_mul_f32 v[106:107], v[106:107], v[94:95] op_sel_hi:[1,0]
    v_pk_mul_f32 v[110:111], v[110:111], v[100:101] op_sel_hi:[1,0]
    v_cvt_pk_bf16_f32 v217, v218, v219
    v_pk_mul_f32 v[236:237], v[236:237], v[50:51] op_sel_hi:[1,0]
    v_exp_f32_e64 v53, v53 clamp
    v_fma_f32 v90, v90, s28, v13
    v_cvt_pk_bf16_f32 v117, v118, v119
    v_pk_mul_f32 v[144:145], v[144:145], v[48:49] op_sel_hi:[1,0]
    v_pk_mul_f32 v[174:175], v[174:175], v[92:93] op_sel_hi:[1,0]
    v_pk_mul_f32 v[222:223], v[222:223], v[50:51] op_sel_hi:[1,0]
    v_cvt_pk_bf16_f32 v172, v172, v173
    v_cvt_pk_bf16_f32 v213, v214, v215
    v_cvt_pk_bf16_f32 v104, v104, v105
    v_mfma_f32_16x16x32_bf16 v[56:59], a[228:231], a[108:111], v[56:59]
    ds_write2st64_b64 v93, v[116:117], v[164:165] offset0:0 offset1:12
    v_cvt_pk_bf16_f32 v105, v106, v107
    v_cvt_pk_bf16_f32 v120, v120, v121
    v_mfma_f32_16x16x32_bf16 v[56:59], a[232:235], a[112:115], v[56:59]
    ds_write2st64_b64 v93, v[212:213], v[104:105] offset0:24 offset1:36
    v_cvt_pk_bf16_f32 v152, v152, v153
    v_pk_mul_f32 v[140:141], v[140:141], v[48:49] op_sel_hi:[1,0]
    v_cvt_pk_bf16_f32 v176, v176, v177
    v_accvgpr_read_b32 v106, a10
    v_mfma_f32_16x16x32_bf16 v[56:59], a[236:239], a[116:119], v[56:59]
    s_waitcnt lgkmcnt(2)
    v_fma_f32 v64, v64, s28, v10
    v_cvt_pk_bf16_f32 v109, v110, v111
    v_mfma_f32_16x16x32_bf16 v[112:115], a[216:219], v[14:17], 0
    buffer_load_dwordx4 v6, s[4:7], s20 offen lds
    ds_read_b64_tr_b16 a[224:225], v4 offset:0
    v_accvgpr_read_b32 v110, a58
    v_fma_f32 v67, v67, s28, v10
    v_mfma_f32_16x16x32_bf16 v[116:119], a[220:223], v[14:17], 0
    ds_read_b64_tr_b16 a[226:227], v4 offset:6144
    v_cvt_pk_bf16_f32 v121, v122, v123
    v_accvgpr_read_b32 v104, a8
    v_mfma_f32_16x16x32_bf16 v[164:167], a[220:223], v[22:25], 0
    ds_write_b64 v93, v[108:109] offset:24576
    v_mfma_f32_16x16x32_bf16 v[160:163], a[216:219], v[22:25], 0
    s_add_u32 s20, s20, 128
    ds_read_b64_tr_b16 a[232:233], v2 offset:1024
    v_fma_f32 v73, v73, s28, v11
    v_cvt_pk_bf16_f32 v224, v224, v225
    v_xor_b32 v93, 96, v93
    v_accvgpr_read_b32 v111, a59
    v_mfma_f32_16x16x32_bf16 v[208:211], a[216:219], v[26:29], 0
    s_add_u32 m0, s22, 13312
    v_exp_f32_e64 v69, v69 clamp
    v_smfmac_f32_16x16x64_bf16 v[44:47], a[240:243], v[22:29], v101
    ds_read_b64_tr_b16 a[228:229], v5 offset:0
    v_cvt_pk_bf16_f32 v240, v240, v241
    v_fma_f32 v60, v60, s28, v10
    v_accvgpr_read_b32 v109, a57
    v_mfma_f32_16x16x32_bf16 v[212:215], a[220:223], v[26:29], 0
    ds_write2st64_b64 v93, v[120:121], v[168:169] offset0:0 offset1:12
    v_mfma_f32_16x16x32_bf16 a[4:7], a[220:223], v[34:37], 0
    ds_read_b64_tr_b16 a[234:235], v2 offset:7168
    v_accvgpr_read_b32 v107, a11
    v_accvgpr_read_b32 v108, a56
    v_smfmac_f32_16x16x64_bf16 v[44:47], a[244:247], v[34:41], v101
    buffer_load_dwordx4 v6, s[4:7], s20 offen lds
    ds_read_b64_tr_b16 a[230:231], v5 offset:6144
    v_cvt_pk_bf16_f32 v144, v144, v145
    v_accvgpr_read_b32 v105, a9
    v_pk_mul_f32 v[238:239], v[238:239], v[50:51] op_sel_hi:[1,0]
    v_cvt_pk_bf16_f32 v200, v200, v201
    v_pk_mul_f32 v[156:157], v[156:157], v[48:49] op_sel_hi:[1,0]
    v_pk_mul_f32 v[104:105], v[104:105], v[94:95] op_sel_hi:[1,0]
    v_pk_mul_f32 v[180:181], v[180:181], v[92:93] op_sel_hi:[1,0]
    v_pk_mul_f32 v[108:109], v[108:109], v[100:101] op_sel_hi:[1,0]
    v_pk_mul_f32 v[232:233], v[232:233], v[50:51] op_sel_hi:[1,0]
    v_pk_mul_f32 v[106:107], v[106:107], v[94:95] op_sel_hi:[1,0]
    v_pk_mul_f32 v[230:231], v[230:231], v[50:51] op_sel_hi:[1,0]
    v_cvt_pk_bf16_f32 v232, v232, v233
    v_cvt_pk_bf16_f32 v108, v108, v109
    v_cvt_pk_bf16_f32 v31, v70, v71
    v_pk_mul_f32 v[252:253], v[252:253], v[50:51] op_sel_hi:[1,0]
    v_cvt_pk_bf16_f32 v104, v104, v105
    v_pk_mul_f32 v[226:227], v[226:227], v[50:51] op_sel_hi:[1,0]
    v_pk_mul_f32 v[110:111], v[110:111], v[100:101] op_sel_hi:[1,0]
    v_cvt_pk_bf16_f32 v105, v106, v107
    v_fma_f32 v86, v86, s28, v13
    v_pk_mul_f32 v[228:229], v[228:229], v[50:51] op_sel_hi:[1,0]
    v_pk_mul_f32 v[184:185], v[184:185], v[92:93] op_sel_hi:[1,0]
    v_cvt_pk_bf16_f32 v128, v128, v129
    v_cvt_pk_bf16_f32 v228, v228, v229
    v_pk_mul_f32 v[154:155], v[154:155], v[48:49] op_sel_hi:[1,0]
    v_pk_mul_f32 v[138:139], v[138:139], v[48:49] op_sel_hi:[1,0]
    v_cvt_pk_bf16_f32 v109, v110, v111
    v_cvt_pk_bf16_f32 v244, v244, v245
    v_cvt_pk_bf16_f32 v229, v230, v231
    v_mfma_f32_16x16x32_bf16 a[0:3], a[216:219], v[34:37], 0
    ds_write2st64_b64 v93, v[216:217], v[104:105] offset0:24 offset1:36
    v_cvt_pk_bf16_f32 v201, v202, v203
    v_mfma_f32_16x16x32_bf16 a[48:51], a[216:219], v[38:41], 0
    s_add_u32 s20, s20, 128
    ds_write_b64 v93, v[108:109] offset:24576
    v_fma_f32 v57, v57, s28, v9
    v_accvgpr_read_b32 v108, a60
    v_cvt_pk_bf16_f32 v236, v236, v237
    v_pk_mul_f32 v[188:189], v[188:189], v[92:93] op_sel_hi:[1,0]
    v_pk_mul_f32 v[126:127], v[126:127], v[48:49] op_sel_hi:[1,0]
    v_cvt_pk_bf16_f32 v177, v178, v179
    v_accvgpr_read_b32 v105, a13
    v_cvt_pk_bf16_f32 v140, v140, v141
    v_cvt_pk_bf16_f32 v125, v126, v127
    v_pk_mul_f32 v[142:143], v[142:143], v[48:49] op_sel_hi:[1,0]
    v_accvgpr_read_b32 v110, a62
    v_exp_f32_e64 v86, v86 clamp
    v_fma_f32 v81, v81, s28, v12
    v_mfma_f32_16x16x32_bf16 a[52:55], a[220:223], v[38:41], 0
    s_waitcnt lgkmcnt(2)
    ds_read_b64_tr_b16 a[216:217], v4 offset:1024
    v_cvt_pk_bf16_f32 v180, v180, v181
    v_mfma_f32_16x16x32_bf16 a[56:59], a[224:227], v[38:41], 0
    ds_read_b64_tr_b16 a[222:223], v5 offset:7168
    v_accvgpr_read_b32 v104, a12
    v_fma_f32 v79, v79, s28, v12
    v_accvgpr_read_b32 v109, a61
    v_xor_b32 v93, 32, v93
    v_pk_mul_f32 v[234:235], v[234:235], v[50:51] op_sel_hi:[1,0]
    v_accvgpr_read_b32 v106, a14
    v_pk_mul_f32 v[148:149], v[148:149], v[48:49] op_sel_hi:[1,0]
    v_accvgpr_read_b32 v111, a63
    v_pk_mul_f32 v[132:133], v[132:133], v[48:49] op_sel_hi:[1,0]
    v_pk_mul_f32 v[108:109], v[108:109], v[100:101] op_sel_hi:[1,0]
    v_fma_f32 v80, v80, s28, v12
    v_accvgpr_read_b32 v107, a15
    v_pk_mul_f32 v[192:193], v[192:193], v[92:93] op_sel_hi:[1,0]
    v_pk_mul_f32 v[104:105], v[104:105], v[94:95] op_sel_hi:[1,0]
    v_pk_mul_f32 v[106:107], v[106:107], v[94:95] op_sel_hi:[1,0]
    v_cvt_pk_bf16_f32 v173, v174, v175
    v_cvt_pk_bf16_f32 v129, v130, v131
    v_pk_mul_f32 v[206:207], v[206:207], v[92:93] op_sel_hi:[1,0]
    v_cvt_pk_bf16_f32 v221, v222, v223
    v_cvt_pk_bf16_f32 v108, v108, v109
    v_pk_mul_f32 v[110:111], v[110:111], v[100:101] op_sel_hi:[1,0]
    v_pk_mul_f32 v[242:243], v[242:243], v[50:51] op_sel_hi:[1,0]
    v_pk_mul_f32 v[194:195], v[194:195], v[92:93] op_sel_hi:[1,0]
    v_cvt_pk_bf16_f32 v192, v192, v193
    v_cvt_pk_bf16_f32 v184, v184, v185
    v_cvt_pk_bf16_f32 v104, v104, v105
    v_cvt_pk_bf16_f32 v43, v86, v87
    v_cvt_pk_bf16_f32 v188, v188, v189
    v_mfma_f32_16x16x32_bf16 a[60:63], a[228:231], v[38:41], 0
    v_cvt_pk_bf16_f32 v105, v106, v107
    v_cvt_pk_bf16_f32 v109, v110, v111
    v_mfma_f32_16x16x32_bf16 a[12:15], a[228:231], v[34:37], 0
    ds_read_b64_tr_b16 a[236:237], v3 offset:1024
    v_cvt_pk_bf16_f32 v241, v242, v243
    v_fma_f32 v54, v54, s28, v9
    v_mfma_f32_16x16x32_bf16 a[8:11], a[224:227], v[34:37], 0
    s_add_u32 m0, s22, 14336
    ds_write2st64_b64 v93, v[124:125], v[172:173] offset0:0 offset1:12
    v_cvt_pk_bf16_f32 v252, v252, v253
    v_mfma_f32_16x16x32_bf16 v[216:219], a[224:227], v[26:29], 0
    buffer_load_dwordx4 v6, s[4:7], s20 offen lds
    ds_write2st64_b64 v93, v[220:221], v[104:105] offset0:24 offset1:36
    v_accvgpr_read_b32 v104, a16
    v_mfma_f32_16x16x32_bf16 v[220:223], a[228:231], v[26:29], 0
    ds_write_b64 v93, v[108:109] offset:24576
    v_cvt_pk_bf16_f32 v189, v190, v191
    v_accvgpr_read_b32 v110, a66
    v_fma_f32 v66, v66, s28, v10
    v_xor_b32 v93, 96, v93
    v_accvgpr_read_b32 v105, a17
    v_fma_f32 v72, v72, s28, v11
    v_mfma_f32_16x16x32_bf16 v[172:175], a[228:231], v[22:25], 0
    s_add_u32 s20, s20, 12032
    ds_write2st64_b64 v93, v[128:129], v[176:177] offset0:4 offset1:16
    v_cvt_pk_bf16_f32 v237, v238, v239
    v_pk_mul_f32 v[204:205], v[204:205], v[92:93] op_sel_hi:[1,0]
    v_exp_f32_e64 v73, v73 clamp
    v_cvt_pk_bf16_f32 v225, v226, v227
    v_accvgpr_read_b32 v109, a65
    v_accvgpr_read_b32 v111, a67
    v_accvgpr_read_b32 v108, a64
    v_pk_mul_f32 v[104:105], v[104:105], v[94:95] op_sel_hi:[1,0]
    v_cvt_pk_bf16_f32 v132, v132, v133
    v_cvt_pk_bf16_f32 v104, v104, v105
    v_cvt_pk_bf16_f32 v137, v138, v139
    v_pk_mul_f32 v[108:109], v[108:109], v[100:101] op_sel_hi:[1,0]
    v_exp_f32_e64 v83, v83 clamp
    v_exp_f32_e64 v82, v82 clamp
    v_accvgpr_read_b32 v106, a18
    v_pk_mul_f32 v[110:111], v[110:111], v[100:101] op_sel_hi:[1,0]
    v_accvgpr_read_b32 v107, a19
    v_pk_mul_f32 v[106:107], v[106:107], v[94:95] op_sel_hi:[1,0]
    v_pk_mul_f32 v[158:159], v[158:159], v[48:49] op_sel_hi:[1,0]
    v_pk_mul_f32 v[146:147], v[146:147], v[48:49] op_sel_hi:[1,0]
    v_cvt_pk_bf16_f32 v105, v106, v107
    v_pk_mul_f32 v[134:135], v[134:135], v[48:49] op_sel_hi:[1,0]
    v_exp_f32_e64 v81, v81 clamp
    v_cvt_pk_bf16_f32 v133, v134, v135
    v_mfma_f32_16x16x32_bf16 v[168:171], a[224:227], v[22:25], 0
    ds_read_b64_tr_b16 a[238:239], v3 offset:7168
    v_cvt_pk_bf16_f32 v108, v108, v109
    v_mfma_f32_16x16x32_bf16 v[120:123], a[224:227], v[14:17], 0
    ds_write2st64_b64 v93, v[224:225], v[104:105] offset0:28 offset1:40
    v_cvt_pk_bf16_f32 v109, v110, v111
    v_cvt_pk_bf16_f32 v156, v156, v157
    v_mfma_f32_16x16x32_bf16 v[124:127], a[228:231], v[14:17], 0
    ds_write_b64 v93, v[108:109] offset:26624
    v_cvt_pk_bf16_f32 v181, v182, v183
    v_cvt_pk_bf16_f32 v148, v148, v149
    v_accvgpr_read_b32 v111, a71
    v_cvt_pk_bf16_f32 v196, v196, v197
    v_accvgpr_read_b32 v107, a23
    v_accvgpr_read_b32 v104, a20
    v_accvgpr_read_b32 v105, a21
    v_accvgpr_read_b32 v109, a69
    v_cvt_pk_bf16_f32 v233, v234, v235
    v_cvt_pk_bf16_f32 v145, v146, v147
    v_cvt_pk_bf16_f32 v253, v254, v255
    v_pk_mul_f32 v[104:105], v[104:105], v[94:95] op_sel_hi:[1,0]
    v_cvt_pk_bf16_f32 v157, v158, v159
    v_pk_mul_f32 v[248:249], v[248:249], v[50:51] op_sel_hi:[1,0]
    v_accvgpr_read_b32 v110, a70
    v_accvgpr_read_b32 v106, a22
    v_accvgpr_read_b32 v108, a68
    v_pk_mul_f32 v[106:107], v[106:107], v[94:95] op_sel_hi:[1,0]
    v_cvt_pk_bf16_f32 v104, v104, v105
    v_cvt_pk_bf16_f32 v105, v106, v107
    v_pk_mul_f32 v[108:109], v[108:109], v[100:101] op_sel_hi:[1,0]
    v_pk_mul_f32 v[110:111], v[110:111], v[100:101] op_sel_hi:[1,0]
    v_fma_f32 v61, v61, s28, v10
    v_pk_mul_f32 v[198:199], v[198:199], v[92:93] op_sel_hi:[1,0]
    v_cvt_pk_bf16_f32 v204, v204, v205
    v_pk_mul_f32 v[250:251], v[250:251], v[50:51] op_sel_hi:[1,0]
    v_cvt_pk_bf16_f32 v193, v194, v195
    v_pk_mul_f32 v[246:247], v[246:247], v[50:51] op_sel_hi:[1,0]
    v_cvt_pk_bf16_f32 v108, v108, v109
    v_xor_b32 v93, 32, v93
    v_cvt_pk_bf16_f32 v245, v246, v247
    v_accvgpr_read_b32 v107, a27
    v_cvt_pk_bf16_f32 v109, v110, v111
    v_mfma_f32_16x16x32_bf16 v[128:131], a[232:235], v[14:17], 0
    s_waitcnt lgkmcnt(1)
    ds_write2st64_b64 v93, v[132:133], v[180:181] offset0:4 offset1:16
    v_cvt_pk_bf16_f32 v185, v186, v187
    v_fma_f32 v58, v58, s28, v9
    v_mfma_f32_16x16x32_bf16 v[132:135], a[236:239], v[14:17], 0
    ds_read_b64_tr_b16 a[226:227], v2 offset:8192
    v_accvgpr_read_b32 v110, a74
    v_mfma_f32_16x16x32_bf16 v[180:183], a[236:239], v[22:25], 0
    ds_read_b128 v[96:99], v103 offset:0
    v_accvgpr_read_b32 v111, a75
    v_mfma_f32_16x16x32_bf16 v[176:179], a[232:235], v[22:25], 0
    ds_write2st64_b64 v93, v[228:229], v[104:105] offset0:28 offset1:40
    v_mfma_f32_16x16x32_bf16 v[224:227], a[232:235], v[26:29], 0
    ds_read_b64_tr_b16 a[224:225], v2 offset:2048
    ds_read_b64_tr_b16 a[218:219], v4 offset:7168
    v_mfma_f32_16x16x32_bf16 v[228:231], a[236:239], v[26:29], 0
    ds_write_b64 v93, v[108:109] offset:26624
    v_exp_f32_e64 v54, v54 clamp
    v_mfma_f32_16x16x32_bf16 a[20:23], a[236:239], v[34:37], 0
    ds_read_b64_tr_b16 a[220:221], v5 offset:1024
    v_accvgpr_read_b32 v109, a73
    v_xor_b32 v93, 96, v93
    v_exp_f32_e64 v52, v52 clamp
    v_accvgpr_read_b32 v106, a26
    v_accvgpr_read_b32 v105, a25
    v_accvgpr_read_b32 v108, a72
    v_accvgpr_read_b32 v104, a24
    v_pk_mul_f32 v[108:109], v[108:109], v[100:101] op_sel_hi:[1,0]
    v_fma_f32 v88, v88, s28, v13
    v_cvt_pk_bf16_f32 v141, v142, v143
    v_pk_mul_f32 v[110:111], v[110:111], v[100:101] op_sel_hi:[1,0]
    v_pk_mul_f32 v[104:105], v[104:105], v[94:95] op_sel_hi:[1,0]
    v_pk_mul_f32 v[106:107], v[106:107], v[94:95] op_sel_hi:[1,0]
    v_exp_f32_e64 v79, v79 clamp
    v_cvt_pk_bf16_f32 v108, v108, v109
    v_cvt_pk_bf16_f32 v104, v104, v105
    v_mfma_f32_16x16x32_bf16 a[16:19], a[232:235], v[34:37], 0
    ds_write2st64_b64 v93, v[136:137], v[184:185] offset0:4 offset1:16
    v_cvt_pk_bf16_f32 v105, v106, v107
    v_cvt_pk_bf16_f32 v109, v110, v111
    v_mfma_f32_16x16x32_bf16 a[64:67], a[232:235], v[38:41], 0
    ds_write2st64_b64 v93, v[232:233], v[104:105] offset0:28 offset1:40
    v_accvgpr_read_b32 v104, a28
    v_accvgpr_read_b32 v105, a29
    v_cvt_pk_bf16_f32 v153, v154, v155
    v_mfma_f32_16x16x32_bf16 a[68:71], a[236:239], v[38:41], 0
    s_waitcnt lgkmcnt(2)
    ds_write_b64 v93, v[108:109] offset:26624
    v_accvgpr_read_b32 v108, a76
    v_mfma_f32_16x16x32_bf16 a[72:75], a[216:219], v[38:41], 0
    ds_read_b64_tr_b16 a[228:229], v3 offset:2048
    ds_read_b64_tr_b16 a[234:235], v4 offset:8192
    v_accvgpr_read_b32 v109, a77
    v_accvgpr_read_b32 v107, a31
    v_accvgpr_read_b32 v110, a78
    v_accvgpr_read_b32 v111, a79
    v_mfma_f32_16x16x32_bf16 a[76:79], a[220:223], v[38:41], 0
    buffer_store_dwordx4 v[96:99], v6, s[16:19], s67 offen offset:0 nt
    s_nop 0
    ds_read_b128 v[96:99], v103 offset:1024
    v_pk_mul_f32 v[108:109], v[108:109], v[100:101] op_sel_hi:[1,0]
    v_pk_mul_f32 v[104:105], v[104:105], v[94:95] op_sel_hi:[1,0]
    v_accvgpr_read_b32 v106, a30
    v_pk_mul_f32 v[110:111], v[110:111], v[100:101] op_sel_hi:[1,0]
    v_xor_b32 v93, 32, v93
    v_cvt_pk_bf16_f32 v108, v108, v109
    v_cvt_pk_bf16_f32 v109, v110, v111
    v_pk_mul_f32 v[106:107], v[106:107], v[94:95] op_sel_hi:[1,0]
    v_cvt_pk_bf16_f32 v104, v104, v105
    v_accvgpr_read_b32 v110, a82
    v_cvt_pk_bf16_f32 v105, v106, v107
    v_mfma_f32_16x16x32_bf16 a[28:31], a[220:223], v[34:37], 0
    ds_write2st64_b64 v93, v[140:141], v[188:189] offset0:4 offset1:16
    v_accvgpr_read_b32 v111, a83
    v_cvt_pk_bf16_f32 v205, v206, v207
    v_exp_f32_e64 v60, v60 clamp
    v_mfma_f32_16x16x32_bf16 a[24:27], a[216:219], v[34:37], 0
    ds_read_b64_tr_b16 a[238:239], v5 offset:8192
    ds_read_b64_tr_b16 a[230:231], v3 offset:8192
    v_mfma_f32_16x16x32_bf16 v[232:235], a[216:219], v[26:29], 0
    ds_write2st64_b64 v93, v[236:237], v[104:105] offset0:28 offset1:40
    v_mfma_f32_16x16x32_bf16 v[236:239], a[220:223], v[26:29], 0
    ds_write_b64 v93, v[108:109] offset:26624
    v_accvgpr_read_b32 v105, a33
    v_accvgpr_read_b32 v107, a35
    v_accvgpr_read_b32 v104, a32
    v_accvgpr_read_b32 v108, a80
    v_accvgpr_read_b32 v106, a34
    v_cvt_pk_bf16_f32 v248, v248, v249
    v_accvgpr_read_b32 v109, a81
    v_pk_mul_f32 v[106:107], v[106:107], v[94:95] op_sel_hi:[1,0]
    v_xor_b32 v93, 96, v93
    v_pk_mul_f32 v[108:109], v[108:109], v[100:101] op_sel_hi:[1,0]
    v_pk_mul_f32 v[104:105], v[104:105], v[94:95] op_sel_hi:[1,0]
    v_pk_mul_f32 v[110:111], v[110:111], v[100:101] op_sel_hi:[1,0]
    v_cvt_pk_bf16_f32 v108, v108, v109
    v_cvt_pk_bf16_f32 v197, v198, v199
    v_cvt_pk_bf16_f32 v109, v110, v111
    v_cvt_pk_bf16_f32 v104, v104, v105
    v_mfma_f32_16x16x32_bf16 v[188:191], a[220:223], v[22:25], 0
    ds_write2st64_b64 v93, v[144:145], v[192:193] offset0:8 offset1:20
    v_cvt_pk_bf16_f32 v105, v106, v107
    v_mfma_f32_16x16x32_bf16 v[184:187], a[216:219], v[22:25], 0
    ds_read_b64_tr_b16 a[236:237], v5 offset:2048
    ds_read_b64_tr_b16 a[232:233], v4 offset:2048
    v_mfma_f32_16x16x32_bf16 v[136:139], a[216:219], v[14:17], 0
    s_add_u32 s39, s39, 12288
    ds_write2st64_b64 v93, v[240:241], v[104:105] offset0:32 offset1:44
    v_accvgpr_read_b32 v107, a39
    v_mfma_f32_16x16x32_bf16 v[140:143], a[220:223], v[14:17], 0
    ds_write_b64 v93, v[108:109] offset:0
    v_exp_f32_e64 v67, v67 clamp
    v_accvgpr_read_b32 v104, a36
    v_accvgpr_read_b32 v111, a87
    v_accvgpr_read_b32 v106, a38
    v_accvgpr_read_b32 v109, a85
    v_cvt_pk_bf16_f32 v18, v52, v53
    v_cvt_pk_bf16_f32 v249, v250, v251
    v_cvt_pk_bf16_f32 v149, v150, v151
    v_accvgpr_read_b32 v105, a37
    v_pk_mul_f32 v[106:107], v[106:107], v[94:95] op_sel_hi:[1,0]
    v_accvgpr_read_b32 v108, a84
    v_pk_mul_f32 v[108:109], v[108:109], v[100:101] op_sel_hi:[1,0]
    v_pk_mul_f32 v[104:105], v[104:105], v[94:95] op_sel_hi:[1,0]
    v_xor_b32 v93, 32, v93
    v_accvgpr_read_b32 v110, a86
    v_pk_mul_f32 v[110:111], v[110:111], v[100:101] op_sel_hi:[1,0]
    v_cvt_pk_bf16_f32 v104, v104, v105
    v_cvt_pk_bf16_f32 v108, v108, v109
    v_mfma_f32_16x16x32_bf16 v[144:147], a[224:227], v[14:17], 0
    s_waitcnt lgkmcnt(4)
    ds_write2st64_b64 v93, v[148:149], v[196:197] offset0:8 offset1:20
    v_mfma_f32_16x16x32_bf16 v[148:151], a[228:231], v[14:17], 0
    s_waitcnt vmcnt(7) lgkmcnt(2)
    v_cvt_pk_bf16_f32 v105, v106, v107
    v_cvt_pk_bf16_f32 v109, v110, v111
    v_mfma_f32_16x16x32_bf16 v[196:199], a[228:231], v[22:25], 0
    buffer_store_dwordx4 v[96:99], v7, s[16:19], s67 offen offset:0 nt
    s_barrier
    ds_write2st64_b64 v93, v[244:245], v[104:105] offset0:32 offset1:44
    v_mfma_f32_16x16x32_bf16 v[192:195], a[224:227], v[22:25], 0
    ds_write_b64 v93, v[108:109] offset:0
    v_xor_b32 v93, 96, v93
    v_exp_f32_e64 v61, v61 clamp
    v_accvgpr_read_b32 v105, a41
    v_accvgpr_read_b32 v107, a43
    v_mfma_f32_16x16x32_bf16 v[240:243], a[224:227], v[26:29], 0
    v_accvgpr_read_b32 v111, a91
    v_accvgpr_read_b32 v110, a90
    v_accvgpr_read_b32 v104, a40
    v_mfma_f32_16x16x32_bf16 v[244:247], a[228:231], v[26:29], 0
    ds_write2st64_b64 v93, v[152:153], v[200:201] offset0:8 offset1:20
    v_pk_mul_f32 v[110:111], v[110:111], v[100:101] op_sel_hi:[1,0]
    v_pk_mul_f32 v[104:105], v[104:105], v[94:95] op_sel_hi:[1,0]
    v_accvgpr_read_b32 v106, a42
    v_pk_mul_f32 v[106:107], v[106:107], v[94:95] op_sel_hi:[1,0]
    v_accvgpr_read_b32 v109, a89
    v_accvgpr_read_b32 v108, a88
    v_pk_mul_f32 v[108:109], v[108:109], v[100:101] op_sel_hi:[1,0]
    v_cvt_pk_bf16_f32 v104, v104, v105
    v_cvt_pk_bf16_f32 v108, v108, v109
    v_cvt_pk_bf16_f32 v109, v110, v111
    v_cvt_pk_bf16_f32 v105, v106, v107
    v_mfma_f32_16x16x32_bf16 a[36:39], a[228:231], v[34:37], 0
    ds_write2st64_b64 v93, v[248:249], v[104:105] offset0:32 offset1:44
    v_accvgpr_read_b32 v105, a45
    v_mfma_f32_16x16x32_bf16 a[32:35], a[224:227], v[34:37], 0
    ds_write_b64 v93, v[108:109] offset:0
    v_mfma_f32_16x16x32_bf16 a[80:83], a[224:227], v[38:41], 0
    s_add_u32 m0, s22, 24576
    v_fma_f32 v78, v78, s28, v12
    v_accvgpr_read_b32 v108, a92
    v_exp_f32_e64 v78, v78 clamp
    v_accvgpr_read_b32 v106, a46
    v_fma_f32 v56, v56, s28, v9
    v_fma_f32 v65, v65, s28, v10
    v_mfma_f32_16x16x32_bf16 a[84:87], a[228:231], v[38:41], 0
    ds_read_b128 a[216:219], v0 offset:0
    buffer_load_dwordx4 v6, s[8:11], s21 offen lds
    v_accvgpr_read_b32 v104, a44
    v_accvgpr_read_b32 v111, a95
    v_accvgpr_read_b32 v110, a94
    v_accvgpr_read_b32 v107, a47
    v_pk_mul_f32 v[110:111], v[110:111], v[100:101] op_sel_hi:[1,0]
    v_accvgpr_read_b32 v109, a93
    v_pk_mul_f32 v[106:107], v[106:107], v[94:95] op_sel_hi:[1,0]
    v_pk_mul_f32 v[108:109], v[108:109], v[100:101] op_sel_hi:[1,0]
    v_pk_mul_f32 v[104:105], v[104:105], v[94:95] op_sel_hi:[1,0]
    v_cvt_pk_bf16_f32 v19, v54, v55
    v_xor_b32 v93, 32, v93
    v_mfma_f32_16x16x32_bf16 a[88:91], a[232:235], v[38:41], 0
    ds_read_b128 a[220:223], v1 offset:0
    v_cvt_pk_bf16_f32 v104, v104, v105
    v_mfma_f32_16x16x32_bf16 a[92:95], a[236:239], v[38:41], 0
    s_add_u32 s21, s21, 128
    ds_read_b128 a[224:227], v0 offset:1024
    v_fma_f32 v89, v89, s28, v13
    v_mfma_f32_16x16x32_bf16 a[44:47], a[236:239], v[34:37], 0
    s_add_u32 m0, s22, 25600
    ds_read_b128 v[96:99], v103 offset:2048
    v_cvt_pk_bf16_f32 v105, v106, v107
    v_mfma_f32_16x16x32_bf16 a[40:43], a[232:235], v[34:37], 0
    ds_write2st64_b64 v93, v[156:157], v[204:205] offset0:8 offset1:20
    v_mfma_f32_16x16x32_bf16 v[248:251], a[232:235], v[26:29], 0
    ds_write2st64_b64 v93, v[252:253], v[104:105] offset0:32 offset1:44
    v_mfma_f32_16x16x32_bf16 v[252:255], a[236:239], v[26:29], 0
    v_exp_f32_e64 v88, v88 clamp
    v_mfma_f32_16x16x32_bf16 v[204:207], a[236:239], v[22:25], 0
    buffer_load_dwordx4 v6, s[8:11], s21 offen lds
    v_mfma_f32_16x16x32_bf16 v[200:203], a[232:235], v[22:25], 0
    v_exp_f32_e64 v76, v76 clamp
    v_mfma_f32_16x16x32_bf16 v[152:155], a[232:235], v[14:17], 0
    s_add_u32 s21, s21, 128
    v_exp_f32_e64 v72, v72 clamp
    v_mfma_f32_16x16x32_bf16 v[156:159], a[236:239], v[14:17], 0
    s_waitcnt lgkmcnt(4)
    v_cvt_pk_bf16_f32 v108, v108, v109
    v_cvt_pk_bf16_f32 v23, v62, v63
    v_mfma_f32_16x16x32_bf16 v[52:55], a[216:219], a[96:99], 0
    s_add_u32 m0, s22, 26624
    ds_read_b128 a[228:231], v1 offset:1024
    v_cvt_pk_bf16_f32 v30, v68, v69
    v_mfma_f32_16x16x32_bf16 v[52:55], a[220:223], a[100:103], v[52:55]
    s_waitcnt lgkmcnt(3)
    ds_read_b128 a[232:235], v0 offset:2048
    v_cvt_pk_bf16_f32 v22, v60, v61
    v_mfma_f32_16x16x32_bf16 v[52:55], a[224:227], a[104:107], v[52:55]
    buffer_load_dwordx4 v6, s[8:11], s21 offen lds
    v_mfma_f32_16x16x32_bf16 v[60:63], a[224:227], a[128:131], 0
    v_exp_f32_e64 v91, v91 clamp
    v_mfma_f32_16x16x32_bf16 v[60:63], a[220:223], a[124:127], v[60:63]
    s_add_u32 s21, s21, 12032
    v_exp_f32_e64 v80, v80 clamp
    v_mfma_f32_16x16x32_bf16 v[60:63], a[216:219], a[120:123], v[60:63]
    v_cvt_pk_bf16_f32 v42, v84, v85
    v_cvt_pk_bf16_f32 v35, v78, v79
    v_mfma_f32_16x16x32_bf16 v[68:71], a[216:219], a[144:147], 0
    s_add_u32 s56, s67, 128
    ds_read_b128 a[236:239], v1 offset:2048
    v_cvt_pk_bf16_f32 v109, v110, v111
    v_mfma_f32_16x16x32_bf16 v[68:71], a[220:223], a[148:151], v[68:71]
    buffer_store_dwordx4 v[96:99], v6, s[16:19], s56 offen offset:0 nt
    s_add_u32 s58, s33, 128
    v_exp_f32_e64 v56, v56 clamp
    v_cvt_pk_bf16_f32 v34, v76, v77
    v_mfma_f32_16x16x32_bf16 v[68:71], a[224:227], a[152:155], v[68:71]
    s_add_u32 m0, s38, 2048
    v_exp_f32_e64 v58, v58 clamp
    v_mfma_f32_16x16x32_bf16 v[76:79], a[224:227], a[176:179], 0
    buffer_load_dwordx4 v6, s[12:15], s58 offen nt lds
    v_mfma_f32_16x16x32_bf16 v[76:79], a[220:223], a[172:175], v[76:79]
    ds_read_b128 v[96:99], v103 offset:3072
    v_fma_f32 v59, v59, s28, v9
    v_mfma_f32_16x16x32_bf16 v[76:79], a[216:219], a[168:171], v[76:79]
    v_exp_f32_e64 v90, v90 clamp
    v_mfma_f32_16x16x32_bf16 v[84:87], a[216:219], a[192:195], 0
    v_exp_f32_e64 v65, v65 clamp
    v_mfma_f32_16x16x32_bf16 v[84:87], a[220:223], a[196:199], v[84:87]
    v_exp_f32_e64 v74, v74 clamp
    v_mfma_f32_16x16x32_bf16 v[84:87], a[224:227], a[200:203], v[84:87]
    s_waitcnt lgkmcnt(2)
    ds_write_b64 v93, v[108:109] offset:0
    v_mfma_f32_16x16x32_bf16 v[84:87], a[228:231], a[204:207], v[84:87]
    ds_read_b128 a[220:223], v1 offset:6144
    v_cvt_pk_bf16_f32 v28, v72, v73
    v_mfma_f32_16x16x32_bf16 v[84:87], a[232:235], a[208:211], v[84:87]
    s_waitcnt lgkmcnt(3)
    v_exp_f32_e64 v59, v59 clamp
    v_mfma_f32_16x16x32_bf16 v[84:87], a[236:239], a[212:215], v[84:87]
    s_add_u32 m0, s38, 3072
    v_exp_f32_e64 v75, v75 clamp
    v_mfma_f32_16x16x32_bf16 v[76:79], a[236:239], a[188:191], v[76:79]
    ds_read_b128 a[216:219], v0 offset:6144
    v_cvt_pk_bf16_f32 v32, v80, v81
    v_mfma_f32_16x16x32_bf16 v[76:79], a[232:235], a[184:187], v[76:79]
    v_exp_f32_e64 v57, v57 clamp
    v_mfma_f32_16x16x32_bf16 v[76:79], a[228:231], a[180:183], v[76:79]
    s_waitcnt lgkmcnt(3)
    ds_read_b128 a[224:227], v0 offset:7168
    buffer_load_dwordx4 v7, s[12:15], s58 offen nt lds
    v_mfma_f32_16x16x32_bf16 v[68:71], a[228:231], a[156:159], v[68:71]
    v_exp_f32_e64 v89, v89 clamp
    v_mfma_f32_16x16x32_bf16 v[68:71], a[232:235], a[160:163], v[68:71]
    buffer_store_dwordx4 v[96:99], v7, s[16:19], s56 offen offset:0 nt
    s_nop 0
    ds_read_b128 v[96:99], v103 offset:0
    v_cvt_pk_bf16_f32 v41, v90, v91
    v_cvt_pk_bf16_f32 v40, v88, v89
    v_mfma_f32_16x16x32_bf16 v[68:71], a[236:239], a[164:167], v[68:71]
    v_exp_f32_e64 v66, v66 clamp
    v_mfma_f32_16x16x32_bf16 v[48:51], a[248:251], v[40:43], 0
    v_exp_f32_e64 v64, v64 clamp
    v_mfma_f32_16x16x32_bf16 v[60:63], a[236:239], a[140:143], v[60:63]
    s_add_u32 s57, s67, 24832
    v_cvt_pk_bf16_f32 v16, v56, v57
    v_cvt_pk_bf16_f32 v33, v82, v83
    v_mfma_f32_16x16x32_bf16 v[60:63], a[232:235], a[136:139], v[60:63]
    v_cvt_pk_bf16_f32 v20, v64, v65
    v_cvt_pk_bf16_f32 v17, v58, v59
    v_mfma_f32_16x16x32_bf16 v[60:63], a[228:231], a[132:135], v[60:63]
    v_cvt_pk_bf16_f32 v29, v74, v75
    v_cvt_pk_bf16_f32 v21, v66, v67
    v_mfma_f32_16x16x32_bf16 v[52:55], a[228:231], a[108:111], v[52:55]
    ds_read_b128 a[228:231], v1 offset:7168
    v_smfmac_f32_16x16x64_bf16 v[48:51], a[240:243], v[16:23], v101
    v_smfmac_f32_16x16x64_bf16 v[48:51], a[244:247], v[28:35], v101
    v_mfma_f32_16x16x32_bf16 v[52:55], a[232:235], a[112:115], v[52:55]
    s_add_u32 m0, s38, 0
    ds_read_b128 a[232:235], v0 offset:8192
    v_mfma_f32_16x16x32_bf16 v[52:55], a[236:239], a[116:119], v[52:55]
    s_waitcnt lgkmcnt(2)
    ds_read_b128 a[236:239], v1 offset:8192
    v_mfma_f32_16x16x32_bf16 v[56:59], a[216:219], a[96:99], 0
    s_nop 0
    v_cmp_lt_f32 vcc, s29, v48
    v_mfma_f32_16x16x32_bf16 v[56:59], a[220:223], a[100:103], v[56:59]
    buffer_load_dwordx4 v6, s[12:15], s33 offen nt lds
    v_mfma_f32_16x16x32_bf16 v[56:59], a[224:227], a[104:107], v[56:59]
    buffer_store_dwordx4 v[96:99], v6, s[16:19], s57 offen offset:0 nt
    s_add_u32 m0, s38, 1024
    s_cbranch_vccnz L_rs_tr55d
L_ret_tr55d:
    ds_read_b128 v[96:99], v103 offset:1024
    v_fma_f32 v60, v60, s28, v10
    v_mfma_f32_16x16x32_bf16 v[64:67], a[224:227], a[128:131], 0
    v_fma_f32 v63, v63, s28, v10
    v_fma_f32 v52, v52, s28, v9
    v_mfma_f32_16x16x32_bf16 v[64:67], a[220:223], a[124:127], v[64:67]
    v_fma_f32 v53, v53, s28, v9
    v_add_u32 v103, 4096, v103
    v_mfma_f32_16x16x32_bf16 v[64:67], a[216:219], a[120:123], v[64:67]
    v_fma_f32 v61, v61, s28, v10
    v_mfma_f32_16x16x32_bf16 v[72:75], a[216:219], a[144:147], 0
    v_exp_f32_e64 v63, v63 clamp
    v_mfma_f32_16x16x32_bf16 v[72:75], a[220:223], a[148:151], v[72:75]
    v_exp_f32_e64 v52, v52 clamp
    v_mfma_f32_16x16x32_bf16 v[72:75], a[224:227], a[152:155], v[72:75]
    v_fma_f32 v62, v62, s28, v10
    v_fma_f32 v54, v54, s28, v9
    v_mfma_f32_16x16x32_bf16 v[80:83], a[224:227], a[176:179], 0
    v_mfma_f32_16x16x32_bf16 v[80:83], a[220:223], a[172:175], v[80:83]
    v_exp_f32_e64 v53, v53 clamp
    v_mfma_f32_16x16x32_bf16 v[80:83], a[216:219], a[168:171], v[80:83]
    v_exp_f32_e64 v62, v62 clamp
    v_mfma_f32_16x16x32_bf16 v[88:91], a[216:219], a[192:195], 0
    s_waitcnt lgkmcnt(0)
    buffer_load_dwordx4 v7, s[12:15], s33 offen nt lds
    v_mfma_f32_16x16x32_bf16 v[88:91], a[220:223], a[196:199], v[88:91]
    v_cvt_pk_bf16_f32 v14, v52, v53
    s_waitcnt vmcnt(15)
    v_mfma_f32_16x16x32_bf16 v[88:91], a[224:227], a[200:203], v[88:91]
    s_barrier
    ds_read_b64_tr_b16 a[216:217], v2 offset:18432
    v_mfma_f32_16x16x32_bf16 v[88:91], a[228:231], a[204:207], v[88:91]
    ds_read_b64_tr_b16 a[218:219], v2 offset:12288
    s_add_u32 m0, s22, 0
    v_mfma_f32_16x16x32_bf16 v[88:91], a[232:235], a[208:211], v[88:91]
    ds_read_b64_tr_b16 a[220:221], v3 offset:18432
    v_fma_f32 v55, v55, s28, v9
    v_mfma_f32_16x16x32_bf16 v[88:91], a[236:239], a[212:215], v[88:91]
    v_exp_f32_e64 v55, v55 clamp
    v_mfma_f32_16x16x32_bf16 v[80:83], a[236:239], a[188:191], v[80:83]
    ds_read_b64_tr_b16 a[222:223], v3 offset:12288
    v_mfma_f32_16x16x32_bf16 v[80:83], a[232:235], a[184:187], v[80:83]
    buffer_load_dwordx4 v6, s[4:7], s20 offen lds
    v_mfma_f32_16x16x32_bf16 v[80:83], a[228:231], a[180:183], v[80:83]
    s_add_u32 s20, s20, 128
    ds_read_b64_tr_b16 a[224:225], v4 offset:18432
    v_mfma_f32_16x16x32_bf16 v[72:75], a[228:231], a[156:159], v[72:75]
    s_add_u32 m0, s22, 1024
    v_exp_f32_e64 v60, v60 clamp
    v_mfma_f32_16x16x32_bf16 v[72:75], a[232:235], a[160:163], v[72:75]
    buffer_load_dwordx4 v6, s[4:7], s20 offen lds
    v_mfma_f32_16x16x32_bf16 v[72:75], a[236:239], a[164:167], v[72:75]
    ds_read_b64_tr_b16 a[226:227], v4 offset:12288
    v_mfma_f32_16x16x32_bf16 v[64:67], a[236:239], a[140:143], v[64:67]
    s_add_u32 s20, s20, 128
    v_exp_f32_e64 v54, v54 clamp
    v_mfma_f32_16x16x32_bf16 v[64:67], a[232:235], a[136:139], v[64:67]
    s_add_u32 m0, s22, 2048
    v_exp_f32_e64 v61, v61 clamp
    v_mfma_f32_16x16x32_bf16 v[64:67], a[228:231], a[132:135], v[64:67]
    buffer_load_dwordx4 v6, s[4:7], s20 offen lds
    v_mfma_f32_16x16x32_bf16 v[56:59], a[228:231], a[108:111], v[56:59]
    s_add_u32 s20, s20, 12032
    ds_read_b64_tr_b16 a[228:229], v5 offset:18432
    v_cvt_pk_bf16_f32 v15, v54, v55
    v_mfma_f32_16x16x32_bf16 v[56:59], a[232:235], a[112:115], v[56:59]
    s_bitcmp1_b32 s3, 1
    ds_read_b64_tr_b16 a[230:231], v5 offset:12288
    s_waitcnt lgkmcnt(4)
    v_mfma_f32_16x16x32_bf16 v[56:59], a[236:239], a[116:119], v[56:59]
    buffer_store_dwordx4 v[96:99], v7, s[16:19], s57 offen offset:0 nt
    s_cbranch_scc1 L_loop5w1
    s_branch L_loop5w0
    .p2align 6
L_loop4w0:
    v_mfma_f32_16x16x32_bf16 v[112:115], a[216:219], v[16:19], v[112:115]
    ds_read_b64_tr_b16 a[236:237], v3 offset:19456
    v_fma_f32 v71, v71, s28, v11
    v_mfma_f32_16x16x32_bf16 v[160:163], a[216:219], v[20:23], v[160:163]
    v_fma_f32 v78, v78, s28, v12
    v_fma_f32 v83, v83, s28, v12
    v_mfma_f32_16x16x32_bf16 v[208:211], a[216:219], v[28:31], v[208:211]
    ds_read_b64_tr_b16 a[232:233], v2 offset:19456
    v_exp_f32_e64 v71, v71 clamp
    v_mfma_f32_16x16x32_bf16 a[0:3], a[216:219], v[32:35], a[0:3]
    ds_read_b64_tr_b16 a[234:235], v2 offset:13312
    s_waitcnt lgkmcnt(7)
    v_mfma_f32_16x16x32_bf16 a[4:7], a[220:223], v[32:35], a[4:7]
    v_fma_f32 v79, v79, s28, v12
    v_fma_f32 v81, v81, s28, v12
    v_mfma_f32_16x16x32_bf16 v[212:215], a[220:223], v[28:31], v[212:215]
    ds_read_b64_tr_b16 a[238:239], v3 offset:13312
    v_fma_f32 v66, v66, s28, v10
    v_mfma_f32_16x16x32_bf16 v[164:167], a[220:223], v[20:23], v[164:167]
    v_fma_f32 v74, v74, s28, v11
    v_fma_f32 v68, v68, s28, v11
    v_mfma_f32_16x16x32_bf16 v[116:119], a[220:223], v[16:19], v[116:119]
    ds_read_b64_tr_b16 a[216:217], v4 offset:19456
    s_waitcnt lgkmcnt(7)
    v_mfma_f32_16x16x32_bf16 v[120:123], a[224:227], v[16:19], v[120:123]
    v_exp_f32_e64 v78, v78 clamp
    v_mfma_f32_16x16x32_bf16 v[168:171], a[224:227], v[20:23], v[168:171]
    ds_read_b64_tr_b16 a[222:223], v5 offset:13312
    v_mfma_f32_16x16x32_bf16 v[216:219], a[224:227], v[28:31], v[216:219]
    ds_read_b128 v[88:91], v103 offset:0
    v_mfma_f32_16x16x32_bf16 a[8:11], a[224:227], v[32:35], a[8:11]
    s_add_u32 s39, s39, 12288
    ds_read_b64_tr_b16 a[224:225], v2 offset:20480
    s_waitcnt lgkmcnt(6)
    v_mfma_f32_16x16x32_bf16 a[12:15], a[228:231], v[32:35], a[12:15]
    ds_read_b64_tr_b16 a[220:221], v5 offset:19456
    v_fma_f32 v75, v75, s28, v11
    v_mfma_f32_16x16x32_bf16 v[220:223], a[228:231], v[28:31], v[220:223]
    ds_read_b64_tr_b16 a[218:219], v4 offset:13312
    v_fma_f32 v67, v67, s28, v10
    v_mfma_f32_16x16x32_bf16 v[172:175], a[228:231], v[20:23], v[172:175]
    v_fma_f32 v73, v73, s28, v11
    v_fma_f32 v70, v70, s28, v11
    v_mfma_f32_16x16x32_bf16 v[124:127], a[228:231], v[16:19], v[124:127]
    s_waitcnt lgkmcnt(6)
    ds_read_b64_tr_b16 a[228:229], v3 offset:20480
    v_fma_f32 v58, v58, s28, v9
    v_mfma_f32_16x16x32_bf16 v[128:131], a[232:235], v[16:19], v[128:131]
    v_fma_f32 v59, v59, s28, v9
    v_fma_f32 v76, v76, s28, v12
    v_mfma_f32_16x16x32_bf16 v[176:179], a[232:235], v[20:23], v[176:179]
    v_exp_f32_e64 v70, v70 clamp
    v_mfma_f32_16x16x32_bf16 v[224:227], a[232:235], v[28:31], v[224:227]
    ds_read_b64_tr_b16 a[230:231], v3 offset:14336
    v_fma_f32 v64, v64, s28, v10
    v_mfma_f32_16x16x32_bf16 a[16:19], a[232:235], v[32:35], a[16:19]
    ds_read_b64_tr_b16 a[226:227], v2 offset:14336
    v_fma_f32 v72, v72, s28, v11
    v_mfma_f32_16x16x32_bf16 a[20:23], a[236:239], v[32:35], a[20:23]
    ds_read_b64_tr_b16 a[232:233], v4 offset:20480
    v_fma_f32 v82, v82, s28, v12
    v_mfma_f32_16x16x32_bf16 v[228:231], a[236:239], v[28:31], v[228:231]
    v_fma_f32 v63, v63, s28, v10
    v_mfma_f32_16x16x32_bf16 v[180:183], a[236:239], v[20:23], v[180:183]
    ds_read_b64_tr_b16 a[234:235], v4 offset:14336
    v_mfma_f32_16x16x32_bf16 v[132:135], a[236:239], v[16:19], v[132:135]
    s_waitcnt lgkmcnt(5)
    ds_read_b64_tr_b16 a[236:237], v5 offset:20480
    v_fma_f32 v69, v69, s28, v11
    v_mfma_f32_16x16x32_bf16 v[136:139], a[216:219], v[16:19], v[136:139]
    ds_read_b64_tr_b16 a[238:239], v5 offset:14336
    v_fma_f32 v56, v56, s28, v9
    v_mfma_f32_16x16x32_bf16 v[184:187], a[216:219], v[20:23], v[184:187]
    v_fma_f32 v77, v77, s28, v12
    v_fma_f32 v62, v62, s28, v10
    v_mfma_f32_16x16x32_bf16 v[232:235], a[216:219], v[28:31], v[232:235]
    v_exp_f32_e64 v76, v76 clamp
    v_mfma_f32_16x16x32_bf16 a[24:27], a[216:219], v[32:35], a[24:27]
    v_fma_f32 v65, v65, s28, v10
    v_mfma_f32_16x16x32_bf16 a[28:31], a[220:223], v[32:35], a[28:31]
    v_exp_f32_e64 v65, v65 clamp
    v_mfma_f32_16x16x32_bf16 v[236:239], a[220:223], v[28:31], v[236:239]
    v_exp_f32_e64 v68, v68 clamp
    v_mfma_f32_16x16x32_bf16 v[188:191], a[220:223], v[20:23], v[188:191]
    v_exp_f32_e64 v63, v63 clamp
    v_mfma_f32_16x16x32_bf16 v[140:143], a[220:223], v[16:19], v[140:143]
    s_waitcnt lgkmcnt(3)
    v_exp_f32_e64 v81, v81 clamp
    v_mfma_f32_16x16x32_bf16 v[144:147], a[224:227], v[16:19], v[144:147]
    v_exp_f32_e64 v77, v77 clamp
    v_mfma_f32_16x16x32_bf16 v[192:195], a[224:227], v[20:23], v[192:195]
    v_exp_f32_e64 v69, v69 clamp
    v_mfma_f32_16x16x32_bf16 v[240:243], a[224:227], v[28:31], v[240:243]
    s_waitcnt vmcnt(10) lgkmcnt(0)
    v_exp_f32_e64 v66, v66 clamp
    v_mfma_f32_16x16x32_bf16 a[32:35], a[224:227], v[32:35], a[32:35]
    s_barrier
    v_mfma_f32_16x16x32_bf16 a[36:39], a[228:231], v[32:35], a[36:39]
    s_add_u32 m0, s22, 36864
    ds_read_b128 a[216:219], v0 offset:12288
    v_cvt_pk_bf16_f32 v27, v70, v71
    v_mfma_f32_16x16x32_bf16 v[244:247], a[228:231], v[28:31], v[244:247]
    buffer_load_dwordx4 v6, s[8:11], s21 offen lds
    v_mfma_f32_16x16x32_bf16 v[196:199], a[228:231], v[20:23], v[196:199]
    ds_read_b128 a[220:223], v1 offset:12288
    v_cvt_pk_bf16_f32 v26, v68, v69
    v_mfma_f32_16x16x32_bf16 v[148:151], a[228:231], v[16:19], v[148:151]
    s_add_u32 s21, s21, 128
    s_add_u32 m0, s22, 37888
    ds_read_b128 a[224:227], v0 offset:13312
    v_mfma_f32_16x16x32_bf16 v[152:155], a[232:235], v[16:19], v[152:155]
    buffer_load_dwordx4 v6, s[8:11], s21 offen lds
    v_mfma_f32_16x16x32_bf16 v[200:203], a[232:235], v[20:23], v[200:203]
    v_exp_f32_e64 v62, v62 clamp
    v_mfma_f32_16x16x32_bf16 v[248:251], a[232:235], v[28:31], v[248:251]
    v_exp_f32_e64 v79, v79 clamp
    v_mfma_f32_16x16x32_bf16 a[40:43], a[232:235], v[32:35], a[40:43]
    s_add_u32 s21, s21, 128
    ds_read_b128 a[228:231], v1 offset:13312
    v_mfma_f32_16x16x32_bf16 a[44:47], a[236:239], v[32:35], a[44:47]
    ds_read_b128 a[232:235], v0 offset:14336
    v_cvt_pk_bf16_f32 v34, v76, v77
    v_mfma_f32_16x16x32_bf16 v[252:255], a[236:239], v[28:31], v[252:255]
    s_add_u32 m0, s22, 38912
    v_exp_f32_e64 v59, v59 clamp
    v_mfma_f32_16x16x32_bf16 v[204:207], a[236:239], v[20:23], v[204:207]
    buffer_load_dwordx4 v6, s[8:11], s21 offen lds
    v_mfma_f32_16x16x32_bf16 v[156:159], a[236:239], v[16:19], v[156:159]
    s_waitcnt lgkmcnt(4)
    v_exp_f32_e64 v74, v74 clamp
    v_mfma_f32_16x16x32_bf16 v[52:55], a[216:219], a[96:99], 0
    s_waitcnt lgkmcnt(3)
    ds_read_b128 a[236:239], v1 offset:14336
    v_cvt_pk_bf16_f32 v22, v60, v61
    v_mfma_f32_16x16x32_bf16 v[52:55], a[220:223], a[100:103], v[52:55]
    s_waitcnt lgkmcnt(3)
    v_exp_f32_e64 v73, v73 clamp
    v_mfma_f32_16x16x32_bf16 v[52:55], a[224:227], a[104:107], v[52:55]
    v_fma_f32 v57, v57, s28, v9
    v_cvt_pk_bf16_f32 v23, v62, v63
    v_mfma_f32_16x16x32_bf16 v[60:63], a[224:227], a[128:131], 0
    v_exp_f32_e64 v67, v67 clamp
    v_mfma_f32_16x16x32_bf16 v[60:63], a[220:223], a[124:127], v[60:63]
    v_exp_f32_e64 v82, v82 clamp
    v_mfma_f32_16x16x32_bf16 v[60:63], a[216:219], a[120:123], v[60:63]
    s_add_u32 s21, s21, 12032
    v_exp_f32_e64 v72, v72 clamp
    v_mfma_f32_16x16x32_bf16 v[68:71], a[216:219], a[144:147], 0
    v_exp_f32_e64 v58, v58 clamp
    v_mfma_f32_16x16x32_bf16 v[68:71], a[220:223], a[148:151], v[68:71]
    s_add_u32 m0, s23, 0
    v_exp_f32_e64 v64, v64 clamp
    v_mfma_f32_16x16x32_bf16 v[68:71], a[224:227], a[152:155], v[68:71]
    buffer_store_dwordx4 v[88:91], v38, s[16:19], s24 offen offset:0 nt
    v_fma_f32 v80, v80, s28, v12
    v_cvt_pk_bf16_f32 v28, v72, v73
    v_cvt_pk_bf16_f32 v35, v78, v79
    v_mfma_f32_16x16x32_bf16 v[76:79], a[224:227], a[176:179], 0
    v_exp_f32_e64 v57, v57 clamp
    v_mfma_f32_16x16x32_bf16 v[76:79], a[220:223], a[172:175], v[76:79]
    v_exp_f32_e64 v75, v75 clamp
    v_mfma_f32_16x16x32_bf16 v[76:79], a[216:219], a[168:171], v[76:79]
    s_waitcnt lgkmcnt(0)
    v_exp_f32_e64 v56, v56 clamp
    v_mfma_f32_16x16x32_bf16 v[76:79], a[228:231], a[180:183], v[76:79]
    ds_read_b128 a[216:219], v0 offset:18432
    v_mfma_f32_16x16x32_bf16 v[76:79], a[232:235], a[184:187], v[76:79]
    ds_read_b128 a[224:227], v0 offset:19456
    v_cvt_pk_bf16_f32 v24, v64, v65
    v_mfma_f32_16x16x32_bf16 v[76:79], a[236:239], a[188:191], v[76:79]
    v_mfma_f32_16x16x32_bf16 v[68:71], a[236:239], a[164:167], v[68:71]
    buffer_load_dwordx4 v38, s[12:15], s25 offen nt lds
    v_mfma_f32_16x16x32_bf16 v[68:71], a[232:235], a[160:163], v[68:71]
    ds_read_b128 a[220:223], v1 offset:18432
    v_mfma_f32_16x16x32_bf16 v[68:71], a[228:231], a[156:159], v[68:71]
    v_cvt_pk_bf16_f32 v16, v56, v57
    v_mfma_f32_16x16x32_bf16 v[60:63], a[228:231], a[132:135], v[60:63]
    v_exp_f32_e64 v80, v80 clamp
    v_mfma_f32_16x16x32_bf16 v[60:63], a[232:235], a[136:139], v[60:63]
    v_exp_f32_e64 v83, v83 clamp
    v_mfma_f32_16x16x32_bf16 v[60:63], a[236:239], a[140:143], v[60:63]
    v_cvt_pk_bf16_f32 v17, v58, v59
    v_cvt_pk_bf16_f32 v29, v74, v75
    v_mfma_f32_16x16x32_bf16 v[52:55], a[236:239], a[116:119], v[52:55]
    s_bitcmp1_b32 s27, 0
    ds_read_b128 a[236:239], v1 offset:20480
    v_cvt_pk_bf16_f32 v36, v80, v81
    v_mfma_f32_16x16x32_bf16 v[52:55], a[232:235], a[112:115], v[52:55]
    ds_read_b128 a[232:235], v0 offset:20480
    v_cvt_pk_bf16_f32 v25, v66, v67
    v_mfma_f32_16x16x32_bf16 v[52:55], a[228:231], a[108:111], v[52:55]
    ds_read_b128 a[228:231], v1 offset:19456
    s_cselect_b32 s26, s49, 128
    v_mfma_f32_16x16x32_bf16 v[44:47], a[248:251], v[14:17], v[44:47]
    s_bitcmp1_b32 s89, 0
    s_cselect_b32 s26, s26, 0
    s_lshr_b32 s89, s89, 1
    v_smfmac_f32_16x16x64_bf16 v[44:47], a[240:243], v[22:29], v101
    s_waitcnt lgkmcnt(4)
    v_cvt_pk_bf16_f32 v37, v82, v83
    v_mfma_f32_16x16x32_bf16 v[56:59], a[216:219], a[96:99], 0
    s_waitcnt lgkmcnt(3)
    v_mfma_f32_16x16x32_bf16 v[56:59], a[220:223], a[100:103], v[56:59]
    v_mfma_f32_16x16x32_bf16 v[44:47], a[252:255], v[34:37], v[44:47]
    s_lshr_b32 s27, s27, 1
    ds_read_b128 v[96:99], v103 offset:1024
    s_add_u32 s24, s24, s26
    v_mfma_f32_16x16x32_bf16 v[56:59], a[224:227], a[104:107], v[56:59]
    s_add_u32 s25, s25, s26
    v_mfma_f32_16x16x32_bf16 v[64:67], a[224:227], a[128:131], 0
    s_nop 1
    v_cmp_lt_f32 vcc, s29, v44
    v_mfma_f32_16x16x32_bf16 v[64:67], a[220:223], a[124:127], v[64:67]
    v_mfma_f32_16x16x32_bf16 v[64:67], a[216:219], a[120:123], v[64:67]
    s_waitcnt vmcnt(10) lgkmcnt(1)
    v_mfma_f32_16x16x32_bf16 v[72:75], a[216:219], a[144:147], 0
    s_barrier
    v_mfma_f32_16x16x32_bf16 v[72:75], a[220:223], a[148:151], v[72:75]
    s_cbranch_vccnz L_rs_loop4w0a
L_ret_loop4w0a:
    v_fma_f32 v68, v68, s28, v11
    v_mfma_f32_16x16x32_bf16 v[72:75], a[224:227], a[152:155], v[72:75]
    s_add_u32 m0, s22, 12288
    v_fma_f32 v79, v79, s28, v12
    v_fma_f32 v53, v53, s28, v9
    v_mfma_f32_16x16x32_bf16 v[80:83], a[224:227], a[176:179], 0
    buffer_load_dwordx4 v6, s[4:7], s20 offen lds
    v_mfma_f32_16x16x32_bf16 v[80:83], a[220:223], a[172:175], v[80:83]
    s_add_u32 s20, s20, 128
    v_exp_f32_e64 v53, v53 clamp
    v_mfma_f32_16x16x32_bf16 v[80:83], a[216:219], a[168:171], v[80:83]
    ds_read_b64_tr_b16 a[216:217], v2 offset:0
    v_fma_f32 v55, v55, s28, v9
    v_mfma_f32_16x16x32_bf16 v[80:83], a[228:231], a[180:183], v[80:83]
    s_add_u32 m0, s22, 13312
    ds_read_b64_tr_b16 a[218:219], v2 offset:6144
    v_fma_f32 v69, v69, s28, v11
    v_mfma_f32_16x16x32_bf16 v[80:83], a[232:235], a[184:187], v[80:83]
    buffer_load_dwordx4 v6, s[4:7], s20 offen lds
    v_mfma_f32_16x16x32_bf16 v[80:83], a[236:239], a[188:191], v[80:83]
    s_add_u32 s20, s20, 128
    v_exp_f32_e64 v79, v79 clamp
    v_mfma_f32_16x16x32_bf16 v[72:75], a[236:239], a[164:167], v[72:75]
    s_add_u32 m0, s22, 14336
    ds_read_b64_tr_b16 a[220:221], v3 offset:0
    v_mfma_f32_16x16x32_bf16 v[72:75], a[232:235], a[160:163], v[72:75]
    buffer_load_dwordx4 v6, s[4:7], s20 offen lds
    v_mfma_f32_16x16x32_bf16 v[72:75], a[228:231], a[156:159], v[72:75]
    ds_read_b64_tr_b16 a[222:223], v3 offset:6144
    v_fma_f32 v52, v52, s28, v9
    v_mfma_f32_16x16x32_bf16 v[64:67], a[228:231], a[132:135], v[64:67]
    v_exp_f32_e64 v69, v69 clamp
    v_mfma_f32_16x16x32_bf16 v[64:67], a[232:235], a[136:139], v[64:67]
    ds_read_b64_tr_b16 a[224:225], v4 offset:0
    v_mfma_f32_16x16x32_bf16 v[64:67], a[236:239], a[140:143], v[64:67]
    v_exp_f32_e64 v55, v55 clamp
    v_mfma_f32_16x16x32_bf16 v[56:59], a[236:239], a[116:119], v[56:59]
    ds_read_b64_tr_b16 a[226:227], v4 offset:6144
    v_fma_f32 v62, v62, s28, v10
    v_mfma_f32_16x16x32_bf16 v[56:59], a[232:235], a[112:115], v[56:59]
    ds_read_b64_tr_b16 a[234:235], v2 offset:7168
    v_fma_f32 v81, v81, s28, v12
    v_mfma_f32_16x16x32_bf16 v[56:59], a[228:231], a[108:111], v[56:59]
    s_waitcnt lgkmcnt(5)
    v_exp_f32_e64 v68, v68 clamp
    v_mfma_f32_16x16x32_bf16 v[112:115], a[216:219], v[14:17], v[112:115]
    v_exp_f32_e64 v52, v52 clamp
    v_mfma_f32_16x16x32_bf16 v[160:163], a[216:219], v[22:25], v[160:163]
    ds_read_b64_tr_b16 a[228:229], v5 offset:0
    v_fma_f32 v63, v63, s28, v10
    v_mfma_f32_16x16x32_bf16 v[208:211], a[216:219], v[26:29], v[208:211]
    ds_read_b64_tr_b16 a[230:231], v5 offset:6144
    v_fma_f32 v66, v66, s28, v10
    v_mfma_f32_16x16x32_bf16 a[0:3], a[216:219], v[34:37], a[0:3]
    s_waitcnt lgkmcnt(5)
    v_fma_f32 v60, v60, s28, v10
    v_fma_f32 v59, v59, s28, v9
    v_mfma_f32_16x16x32_bf16 a[4:7], a[220:223], v[34:37], a[4:7]
    buffer_store_dwordx4 v[96:99], v39, s[16:19], s24 offen offset:0 nt
    ds_read_b64_tr_b16 a[232:233], v2 offset:1024
    v_cvt_pk_bf16_f32 v18, v52, v53
    v_fma_f32 v74, v74, s28, v11
    v_mfma_f32_16x16x32_bf16 v[212:215], a[220:223], v[26:29], v[212:215]
    ds_read_b64_tr_b16 a[238:239], v3 offset:7168
    v_fma_f32 v73, v73, s28, v11
    v_mfma_f32_16x16x32_bf16 v[164:167], a[220:223], v[22:25], v[164:167]
    ds_read_b64_tr_b16 a[236:237], v3 offset:1024
    v_fma_f32 v57, v57, s28, v9
    v_mfma_f32_16x16x32_bf16 v[116:119], a[220:223], v[14:17], v[116:119]
    s_waitcnt lgkmcnt(5)
    ds_read_b64_tr_b16 a[216:217], v4 offset:1024
    v_fma_f32 v71, v71, s28, v11
    v_mfma_f32_16x16x32_bf16 v[120:123], a[224:227], v[14:17], v[120:123]
    v_fma_f32 v80, v80, s28, v12
    v_mfma_f32_16x16x32_bf16 v[168:171], a[224:227], v[22:25], v[168:171]
    s_add_u32 s20, s20, 12032
    ds_read_b64_tr_b16 a[218:219], v4 offset:7168
    v_fma_f32 v75, v75, s28, v11
    v_mfma_f32_16x16x32_bf16 v[216:219], a[224:227], v[26:29], v[216:219]
    ds_read_b64_tr_b16 a[220:221], v5 offset:1024
    v_fma_f32 v54, v54, s28, v9
    v_mfma_f32_16x16x32_bf16 a[8:11], a[224:227], v[34:37], a[8:11]
    s_waitcnt lgkmcnt(6)
    v_exp_f32_e64 v63, v63 clamp
    v_mfma_f32_16x16x32_bf16 a[12:15], a[228:231], v[34:37], a[12:15]
    s_add_u32 s39, s39, 12288
    ds_read_b64_tr_b16 a[222:223], v5 offset:7168
    v_fma_f32 v67, v67, s28, v10
    v_mfma_f32_16x16x32_bf16 v[220:223], a[228:231], v[26:29], v[220:223]
    s_add_u32 m0, s23, 1024
    v_exp_f32_e64 v75, v75 clamp
    v_mfma_f32_16x16x32_bf16 v[172:175], a[228:231], v[22:25], v[172:175]
    buffer_load_dwordx4 v39, s[12:15], s25 offen nt lds
    v_mfma_f32_16x16x32_bf16 v[124:127], a[228:231], v[14:17], v[124:127]
    s_waitcnt lgkmcnt(5)
    ds_read_b64_tr_b16 a[224:225], v2 offset:2048
    v_fma_f32 v70, v70, s28, v11
    v_mfma_f32_16x16x32_bf16 v[128:131], a[232:235], v[14:17], v[128:131]
    ds_read_b128 v[84:87], v103 offset:2048
    v_fma_f32 v61, v61, s28, v10
    v_mfma_f32_16x16x32_bf16 v[176:179], a[232:235], v[22:25], v[176:179]
    ds_read_b64_tr_b16 a[226:227], v2 offset:8192
    v_fma_f32 v65, v65, s28, v10
    v_mfma_f32_16x16x32_bf16 v[224:227], a[232:235], v[26:29], v[224:227]
    ds_read_b64_tr_b16 a[230:231], v3 offset:8192
    v_fma_f32 v64, v64, s28, v10
    v_mfma_f32_16x16x32_bf16 a[16:19], a[232:235], v[34:37], a[16:19]
    s_waitcnt lgkmcnt(6)
    ds_read_b64_tr_b16 a[232:233], v4 offset:2048
    v_fma_f32 v77, v77, s28, v12
    v_mfma_f32_16x16x32_bf16 a[20:23], a[236:239], v[34:37], a[20:23]
    s_bitcmp1_b32 s27, 0
    ds_read_b64_tr_b16 a[234:235], v4 offset:8192
    v_mfma_f32_16x16x32_bf16 v[228:231], a[236:239], v[26:29], v[228:231]
    s_cselect_b32 s26, s49, 128
    v_exp_f32_e64 v65, v65 clamp
    v_mfma_f32_16x16x32_bf16 v[180:183], a[236:239], v[22:25], v[180:183]
    ds_read_b64_tr_b16 a[228:229], v3 offset:2048
    v_fma_f32 v56, v56, s28, v9
    v_mfma_f32_16x16x32_bf16 v[132:135], a[236:239], v[14:17], v[132:135]
    ds_read_b64_tr_b16 a[238:239], v5 offset:8192
    v_mfma_f32_16x16x32_bf16 v[136:139], a[216:219], v[14:17], v[136:139]
    s_bitcmp1_b32 s89, 0
    ds_read_b64_tr_b16 a[236:237], v5 offset:2048
    v_mfma_f32_16x16x32_bf16 v[184:187], a[216:219], v[22:25], v[184:187]
    s_cselect_b32 s26, s26, 0
    v_exp_f32_e64 v73, v73 clamp
    v_mfma_f32_16x16x32_bf16 v[232:235], a[216:219], v[26:29], v[232:235]
    v_exp_f32_e64 v64, v64 clamp
    v_mfma_f32_16x16x32_bf16 a[24:27], a[216:219], v[34:37], a[24:27]
    s_waitcnt lgkmcnt(6)
    v_exp_f32_e64 v60, v60 clamp
    v_mfma_f32_16x16x32_bf16 a[28:31], a[220:223], v[34:37], a[28:31]
    s_lshr_b32 s89, s89, 1
    v_exp_f32_e64 v54, v54 clamp
    v_mfma_f32_16x16x32_bf16 v[236:239], a[220:223], v[26:29], v[236:239]
    v_exp_f32_e64 v71, v71 clamp
    v_mfma_f32_16x16x32_bf16 v[188:191], a[220:223], v[22:25], v[188:191]
    s_lshr_b32 s27, s27, 1
    v_fma_f32 v83, v83, s28, v12
    v_fma_f32 v78, v78, s28, v12
    v_mfma_f32_16x16x32_bf16 v[140:143], a[220:223], v[14:17], v[140:143]
    v_cvt_pk_bf16_f32 v19, v54, v55
    v_cvt_pk_bf16_f32 v30, v68, v69
    v_mfma_f32_16x16x32_bf16 v[144:147], a[224:227], v[14:17], v[144:147]
    s_add_u32 s24, s24, s26
    v_exp_f32_e64 v61, v61 clamp
    v_mfma_f32_16x16x32_bf16 v[192:195], a[224:227], v[22:25], v[192:195]
    s_add_u32 s25, s25, s26
    v_exp_f32_e64 v59, v59 clamp
    v_mfma_f32_16x16x32_bf16 v[240:243], a[224:227], v[26:29], v[240:243]
    s_waitcnt vmcnt(10) lgkmcnt(0)
    v_exp_f32_e64 v70, v70 clamp
    v_mfma_f32_16x16x32_bf16 a[32:35], a[224:227], v[34:37], a[32:35]
    s_barrier
    v_mfma_f32_16x16x32_bf16 a[36:39], a[228:231], v[34:37], a[36:39]
    ds_read_b128 a[216:219], v0 offset:0
    v_cvt_pk_bf16_f32 v31, v70, v71
    v_mfma_f32_16x16x32_bf16 v[244:247], a[228:231], v[26:29], v[244:247]
    s_add_u32 m0, s22, 24576
    ds_read_b128 a[220:223], v1 offset:0
    v_fma_f32 v72, v72, s28, v11
    v_mfma_f32_16x16x32_bf16 v[196:199], a[228:231], v[22:25], v[196:199]
    buffer_load_dwordx4 v6, s[8:11], s21 offen lds
    v_mfma_f32_16x16x32_bf16 v[148:151], a[228:231], v[14:17], v[148:151]
    s_add_u32 s21, s21, 128
    ds_read_b128 a[224:227], v0 offset:1024
    v_fma_f32 v82, v82, s28, v12
    v_mfma_f32_16x16x32_bf16 v[152:155], a[232:235], v[14:17], v[152:155]
    s_add_u32 m0, s22, 25600
    v_exp_f32_e64 v72, v72 clamp
    v_mfma_f32_16x16x32_bf16 v[200:203], a[232:235], v[22:25], v[200:203]
    buffer_load_dwordx4 v6, s[8:11], s21 offen lds
    v_mfma_f32_16x16x32_bf16 v[248:251], a[232:235], v[26:29], v[248:251]
    s_add_u32 s21, s21, 128
    v_exp_f32_e64 v78, v78 clamp
    v_mfma_f32_16x16x32_bf16 a[40:43], a[232:235], v[34:37], a[40:43]
    s_add_u32 m0, s22, 26624
    v_exp_f32_e64 v80, v80 clamp
    v_mfma_f32_16x16x32_bf16 a[44:47], a[236:239], v[34:37], a[44:47]
    buffer_load_dwordx4 v6, s[8:11], s21 offen lds
    v_mfma_f32_16x16x32_bf16 v[252:255], a[236:239], v[26:29], v[252:255]
    v_exp_f32_e64 v62, v62 clamp
    v_mfma_f32_16x16x32_bf16 v[204:207], a[236:239], v[22:25], v[204:207]
    v_fma_f32 v58, v58, s28, v9
    v_mfma_f32_16x16x32_bf16 v[156:159], a[236:239], v[14:17], v[156:159]
    s_waitcnt lgkmcnt(1)
    v_exp_f32_e64 v67, v67 clamp
    v_mfma_f32_16x16x32_bf16 v[52:55], a[216:219], a[96:99], 0
    ds_read_b128 a[232:235], v0 offset:2048
    v_fma_f32 v76, v76, s28, v12
    v_mfma_f32_16x16x32_bf16 v[52:55], a[220:223], a[100:103], v[52:55]
    s_waitcnt lgkmcnt(1)
    ds_read_b128 a[236:239], v1 offset:2048
    v_cvt_pk_bf16_f32 v23, v62, v63
    v_mfma_f32_16x16x32_bf16 v[52:55], a[224:227], a[104:107], v[52:55]
    ds_read_b128 a[228:231], v1 offset:1024
    v_cvt_pk_bf16_f32 v22, v60, v61
    v_mfma_f32_16x16x32_bf16 v[60:63], a[224:227], a[128:131], 0
    v_exp_f32_e64 v76, v76 clamp
    v_mfma_f32_16x16x32_bf16 v[60:63], a[220:223], a[124:127], v[60:63]
    v_exp_f32_e64 v77, v77 clamp
    v_mfma_f32_16x16x32_bf16 v[60:63], a[216:219], a[120:123], v[60:63]
    v_exp_f32_e64 v56, v56 clamp
    v_mfma_f32_16x16x32_bf16 v[68:71], a[216:219], a[144:147], 0
    buffer_store_dwordx4 v[84:87], v38, s[16:19], s24 offen offset:0 nt
    v_cvt_pk_bf16_f32 v35, v78, v79
    v_cvt_pk_bf16_f32 v28, v72, v73
    v_cvt_pk_bf16_f32 v34, v76, v77
    v_mfma_f32_16x16x32_bf16 v[68:71], a[220:223], a[148:151], v[68:71]
    v_exp_f32_e64 v58, v58 clamp
    v_mfma_f32_16x16x32_bf16 v[68:71], a[224:227], a[152:155], v[68:71]
    s_add_u32 s21, s21, 12032
    v_exp_f32_e64 v66, v66 clamp
    v_mfma_f32_16x16x32_bf16 v[76:79], a[224:227], a[176:179], 0
    v_exp_f32_e64 v81, v81 clamp
    v_mfma_f32_16x16x32_bf16 v[76:79], a[220:223], a[172:175], v[76:79]
    v_exp_f32_e64 v74, v74 clamp
    v_mfma_f32_16x16x32_bf16 v[76:79], a[216:219], a[168:171], v[76:79]
    s_waitcnt lgkmcnt(0)
    ds_read_b128 a[224:227], v0 offset:7168
    v_cvt_pk_bf16_f32 v29, v74, v75
    v_mfma_f32_16x16x32_bf16 v[76:79], a[228:231], a[180:183], v[76:79]
    s_add_u32 m0, s23, 2048
    v_cvt_pk_bf16_f32 v20, v64, v65
    v_cvt_pk_bf16_f32 v32, v80, v81
    v_mfma_f32_16x16x32_bf16 v[76:79], a[232:235], a[184:187], v[76:79]
    v_exp_f32_e64 v82, v82 clamp
    v_mfma_f32_16x16x32_bf16 v[76:79], a[236:239], a[188:191], v[76:79]
    ds_read_b128 a[220:223], v1 offset:6144
    v_mfma_f32_16x16x32_bf16 v[68:71], a[236:239], a[164:167], v[68:71]
    buffer_load_dwordx4 v38, s[12:15], s25 offen nt lds
    v_mfma_f32_16x16x32_bf16 v[68:71], a[232:235], a[160:163], v[68:71]
    ds_read_b128 a[216:219], v0 offset:6144
    v_mfma_f32_16x16x32_bf16 v[68:71], a[228:231], a[156:159], v[68:71]
    v_exp_f32_e64 v57, v57 clamp
    v_mfma_f32_16x16x32_bf16 v[60:63], a[228:231], a[132:135], v[60:63]
    v_exp_f32_e64 v83, v83 clamp
    v_mfma_f32_16x16x32_bf16 v[60:63], a[232:235], a[136:139], v[60:63]
    s_bitcmp1_b32 s27, 0
    v_cvt_pk_bf16_f32 v17, v58, v59
    v_cvt_pk_bf16_f32 v16, v56, v57
    v_mfma_f32_16x16x32_bf16 v[60:63], a[236:239], a[140:143], v[60:63]
    v_cvt_pk_bf16_f32 v21, v66, v67
    s_cselect_b32 s26, s49, 128
    v_mfma_f32_16x16x32_bf16 v[52:55], a[236:239], a[116:119], v[52:55]
    ds_read_b128 a[236:239], v1 offset:8192
    v_mfma_f32_16x16x32_bf16 v[52:55], a[232:235], a[112:115], v[52:55]
    ds_read_b128 a[232:235], v0 offset:8192
    v_cvt_pk_bf16_f32 v33, v82, v83
    v_mfma_f32_16x16x32_bf16 v[52:55], a[228:231], a[108:111], v[52:55]
    s_bitcmp1_b32 s89, 0
    ds_read_b128 a[228:231], v1 offset:7168
    v_smfmac_f32_16x16x64_bf16 v[48:51], a[240:243], v[16:23], v101
    v_smfmac_f32_16x16x64_bf16 v[48:51], a[244:247], v[28:35], v101
    s_cselect_b32 s26, s26, 0
    s_lshr_b32 s89, s89, 1
    s_waitcnt lgkmcnt(3)
    v_mfma_f32_16x16x32_bf16 v[56:59], a[216:219], a[96:99], 0
    v_swap_b32 v38, v39
    v_mfma_f32_16x16x32_bf16 v[56:59], a[220:223], a[100:103], v[56:59]
    s_lshr_b32 s27, s27, 1
    s_nop 0
    v_cmp_lt_f32 vcc, s29, v48
    v_mfma_f32_16x16x32_bf16 v[56:59], a[224:227], a[104:107], v[56:59]
    s_add_u32 s24, s24, s26
    s_add_u32 s25, s25, s26
    s_add_u32 s23, s23, 3072
    v_mfma_f32_16x16x32_bf16 v[64:67], a[224:227], a[128:131], 0
    s_cbranch_vccnz L_rs_loop4w0b
L_ret_loop4w0b:
    v_fma_f32 v53, v53, s28, v9
    v_mfma_f32_16x16x32_bf16 v[64:67], a[220:223], a[124:127], v[64:67]
    v_fma_f32 v52, v52, s28, v9
    v_fma_f32 v55, v55, s28, v9
    v_mfma_f32_16x16x32_bf16 v[64:67], a[216:219], a[120:123], v[64:67]
    v_exp_f32_e64 v55, v55 clamp
    v_mfma_f32_16x16x32_bf16 v[72:75], a[216:219], a[144:147], 0
    v_fma_f32 v61, v61, s28, v10
    s_waitcnt vmcnt(12) lgkmcnt(0)
    v_mfma_f32_16x16x32_bf16 v[72:75], a[220:223], a[148:151], v[72:75]
    s_barrier
    v_mfma_f32_16x16x32_bf16 v[72:75], a[224:227], a[152:155], v[72:75]
    s_cmp_eq_u32 s30, 5
    v_exp_f32_e64 v61, v61 clamp
    v_mfma_f32_16x16x32_bf16 v[80:83], a[224:227], a[176:179], 0
    s_cselect_b32 s26, s62, 0
    s_add_u32 s20, s20, s26
    s_add_u32 m0, s22, 0
    v_mfma_f32_16x16x32_bf16 v[80:83], a[220:223], a[172:175], v[80:83]
    buffer_load_dwordx4 v6, s[4:7], s20 offen lds
    v_mfma_f32_16x16x32_bf16 v[80:83], a[216:219], a[168:171], v[80:83]
    s_add_u32 s20, s20, 128
    ds_read_b64_tr_b16 a[216:217], v2 offset:18432
    s_add_u32 m0, s22, 1024
    v_mfma_f32_16x16x32_bf16 v[80:83], a[228:231], a[180:183], v[80:83]
    buffer_load_dwordx4 v6, s[4:7], s20 offen lds
    v_mfma_f32_16x16x32_bf16 v[80:83], a[232:235], a[184:187], v[80:83]
    s_add_u32 s20, s20, 128
    ds_read_b64_tr_b16 a[218:219], v2 offset:12288
    v_fma_f32 v60, v60, s28, v10
    v_mfma_f32_16x16x32_bf16 v[80:83], a[236:239], a[188:191], v[80:83]
    s_add_u32 m0, s22, 2048
    v_exp_f32_e64 v53, v53 clamp
    v_mfma_f32_16x16x32_bf16 v[72:75], a[236:239], a[164:167], v[72:75]
    buffer_load_dwordx4 v6, s[4:7], s20 offen lds
    v_mfma_f32_16x16x32_bf16 v[72:75], a[232:235], a[160:163], v[72:75]
    ds_read_b64_tr_b16 a[220:221], v3 offset:18432
    v_fma_f32 v54, v54, s28, v9
    v_mfma_f32_16x16x32_bf16 v[72:75], a[228:231], a[156:159], v[72:75]
    v_exp_f32_e64 v52, v52 clamp
    v_mfma_f32_16x16x32_bf16 v[64:67], a[228:231], a[132:135], v[64:67]
    s_add_u32 s20, s20, 12032
    ds_read_b64_tr_b16 a[222:223], v3 offset:12288
    v_cvt_pk_bf16_f32 v14, v52, v53
    v_mfma_f32_16x16x32_bf16 v[64:67], a[232:235], a[136:139], v[64:67]
    s_add_u32 s30, s30, 1
    v_exp_f32_e64 v54, v54 clamp
    v_mfma_f32_16x16x32_bf16 v[64:67], a[236:239], a[140:143], v[64:67]
    s_cmp_lt_u32 s30, 6
    v_exp_f32_e64 v60, v60 clamp
    v_mfma_f32_16x16x32_bf16 v[56:59], a[236:239], a[116:119], v[56:59]
    ds_read_b64_tr_b16 a[224:225], v4 offset:18432
    v_add_u32 v103, 3072, v103
    v_mfma_f32_16x16x32_bf16 v[56:59], a[232:235], a[112:115], v[56:59]
    ds_read_b64_tr_b16 a[226:227], v4 offset:12288
    v_cvt_pk_bf16_f32 v15, v54, v55
    v_mfma_f32_16x16x32_bf16 v[56:59], a[228:231], a[108:111], v[56:59]
    s_waitcnt lgkmcnt(4)
    ds_read_b64_tr_b16 a[228:229], v5 offset:18432
    ds_read_b64_tr_b16 a[230:231], v5 offset:12288
    s_cbranch_scc1 L_loop4w0
    s_cmp_ge_u32 s37, 6
    s_cbranch_scc1 L_end4
    s_cmp_eq_u32 s32, 0
    s_cbranch_scc1 L_tr44
    s_branch L_tr45
L_tr45:
    v_mfma_f32_16x16x32_bf16 v[112:115], a[216:219], v[16:19], v[112:115]
    v_mbcnt_lo_u32_b32 v107, -1, 0
    v_fma_f32 v82, v82, s28, v12
    v_mfma_f32_16x16x32_bf16 v[160:163], a[216:219], v[20:23], v[160:163]
    ds_read_b64_tr_b16 a[234:235], v2 offset:13312
    v_fma_f32 v68, v68, s28, v11
    v_mbcnt_hi_u32_b32 v107, -1, v107
    v_mfma_f32_16x16x32_bf16 v[208:211], a[216:219], v[28:31], v[208:211]
    ds_read_b64_tr_b16 a[238:239], v3 offset:13312
    v_and_b32 v106, 15, v107
    v_fma_f32 v71, v71, s28, v11
    v_fma_f32 v63, v63, s28, v10
    v_mfma_f32_16x16x32_bf16 a[0:3], a[216:219], v[32:35], a[0:3]
    s_waitcnt lgkmcnt(6)
    ds_read_b64_tr_b16 a[236:237], v3 offset:19456
    v_fma_f32 v70, v70, s28, v11
    v_mfma_f32_16x16x32_bf16 a[4:7], a[220:223], v[32:35], a[4:7]
    ds_read_b64_tr_b16 a[218:219], v4 offset:13312
    v_fma_f32 v78, v78, s28, v12
    v_mfma_f32_16x16x32_bf16 v[212:215], a[220:223], v[28:31], v[212:215]
    s_add_u32 s39, s39, 12288
    ds_read_b64_tr_b16 a[232:233], v2 offset:19456
    v_fma_f32 v62, v62, s28, v10
    v_mfma_f32_16x16x32_bf16 v[164:167], a[220:223], v[20:23], v[164:167]
    v_fma_f32 v66, v66, s28, v10
    v_mul_u32_u24 v106, 384, v106
    v_mfma_f32_16x16x32_bf16 v[116:119], a[220:223], v[16:19], v[116:119]
    s_waitcnt lgkmcnt(7)
    v_fma_f32 v81, v81, s28, v12
    v_lshrrev_b32 v107, 4, v107
    v_mfma_f32_16x16x32_bf16 v[120:123], a[224:227], v[16:19], v[120:123]
    v_exp_f32_e64 v78, v78 clamp
    v_mfma_f32_16x16x32_bf16 v[168:171], a[224:227], v[20:23], v[168:171]
    v_fma_f32 v69, v69, s28, v11
    v_fma_f32 v56, v56, s28, v9
    v_mfma_f32_16x16x32_bf16 v[216:219], a[224:227], v[28:31], v[216:219]
    s_add_u32 s48, s33, 24576
    ds_read_b64_tr_b16 a[222:223], v5 offset:13312
    v_lshl_add_u32 v106, v107, 4, v106
    v_mfma_f32_16x16x32_bf16 a[8:11], a[224:227], v[32:35], a[8:11]
    s_waitcnt lgkmcnt(5)
    v_exp_f32_e64 v82, v82 clamp
    v_mfma_f32_16x16x32_bf16 a[12:15], a[228:231], v[32:35], a[12:15]
    buffer_load_dwordx4 a[208:211], v106, s[12:15], s48 offen offset:256 nt
    v_mfma_f32_16x16x32_bf16 v[220:223], a[228:231], v[28:31], v[220:223]
    ds_read_b64_tr_b16 a[216:217], v4 offset:19456
    v_fma_f32 v79, v79, s28, v12
    v_mfma_f32_16x16x32_bf16 v[172:175], a[228:231], v[20:23], v[172:175]
    buffer_load_dwordx4 a[212:215], v106, s[12:15], s48 offen offset:320 nt
    v_mfma_f32_16x16x32_bf16 v[124:127], a[228:231], v[16:19], v[124:127]
    s_waitcnt lgkmcnt(2)
    ds_read_b64_tr_b16 a[230:231], v3 offset:14336
    v_fma_f32 v75, v75, s28, v11
    v_mfma_f32_16x16x32_bf16 v[128:131], a[232:235], v[16:19], v[128:131]
    ds_read_b64_tr_b16 a[226:227], v2 offset:14336
    v_fma_f32 v83, v83, s28, v12
    v_mfma_f32_16x16x32_bf16 v[176:179], a[232:235], v[20:23], v[176:179]
    ds_read_b64_tr_b16 a[220:221], v5 offset:19456
    v_mfma_f32_16x16x32_bf16 v[224:227], a[232:235], v[28:31], v[224:227]
    ds_read_b64_tr_b16 a[224:225], v2 offset:20480
    v_fma_f32 v76, v76, s28, v12
    v_mfma_f32_16x16x32_bf16 a[16:19], a[232:235], v[32:35], a[16:19]
    ds_read_b128 v[88:91], v103 offset:0
    v_fma_f32 v67, v67, s28, v10
    v_mfma_f32_16x16x32_bf16 a[20:23], a[236:239], v[32:35], a[20:23]
    ds_read_b64_tr_b16 a[228:229], v3 offset:20480
    ds_read_b64_tr_b16 a[232:233], v4 offset:20480
    v_mfma_f32_16x16x32_bf16 v[228:231], a[236:239], v[28:31], v[228:231]
    ds_read_b64_tr_b16 a[234:235], v4 offset:14336
    v_fma_f32 v64, v64, s28, v10
    v_mfma_f32_16x16x32_bf16 v[180:183], a[236:239], v[20:23], v[180:183]
    v_exp_f32_e64 v63, v63 clamp
    v_mfma_f32_16x16x32_bf16 v[132:135], a[236:239], v[16:19], v[132:135]
    s_waitcnt lgkmcnt(8)
    ds_read_b64_tr_b16 a[238:239], v5 offset:14336
    v_fma_f32 v58, v58, s28, v9
    v_mfma_f32_16x16x32_bf16 v[136:139], a[216:219], v[16:19], v[136:139]
    ds_read_b64_tr_b16 a[236:237], v5 offset:20480
    v_fma_f32 v59, v59, s28, v9
    v_mfma_f32_16x16x32_bf16 v[184:187], a[216:219], v[20:23], v[184:187]
    v_exp_f32_e64 v64, v64 clamp
    v_mfma_f32_16x16x32_bf16 v[232:235], a[216:219], v[28:31], v[232:235]
    v_exp_f32_e64 v70, v70 clamp
    v_mfma_f32_16x16x32_bf16 a[24:27], a[216:219], v[32:35], a[24:27]
    s_waitcnt lgkmcnt(7)
    ds_read_b128 v[96:99], v103 offset:1024
    v_fma_f32 v77, v77, s28, v12
    v_mfma_f32_16x16x32_bf16 a[28:31], a[220:223], v[32:35], a[28:31]
    v_exp_f32_e64 v75, v75 clamp
    v_mfma_f32_16x16x32_bf16 v[236:239], a[220:223], v[28:31], v[236:239]
    v_exp_f32_e64 v79, v79 clamp
    v_mfma_f32_16x16x32_bf16 v[188:191], a[220:223], v[20:23], v[188:191]
    v_exp_f32_e64 v68, v68 clamp
    v_mfma_f32_16x16x32_bf16 v[140:143], a[220:223], v[16:19], v[140:143]
    s_waitcnt lgkmcnt(3)
    v_exp_f32_e64 v71, v71 clamp
    v_mfma_f32_16x16x32_bf16 v[144:147], a[224:227], v[16:19], v[144:147]
    v_exp_f32_e64 v83, v83 clamp
    v_mfma_f32_16x16x32_bf16 v[192:195], a[224:227], v[20:23], v[192:195]
    v_exp_f32_e64 v69, v69 clamp
    v_mfma_f32_16x16x32_bf16 v[240:243], a[224:227], v[28:31], v[240:243]
    s_waitcnt vmcnt(12) lgkmcnt(1)
    v_exp_f32_e64 v76, v76 clamp
    v_mfma_f32_16x16x32_bf16 a[32:35], a[224:227], v[32:35], a[32:35]
    s_barrier
    v_mfma_f32_16x16x32_bf16 a[36:39], a[228:231], v[32:35], a[36:39]
    v_fma_f32 v57, v57, s28, v9
    v_fma_f32 v72, v72, s28, v11
    v_mfma_f32_16x16x32_bf16 v[244:247], a[228:231], v[28:31], v[244:247]
    s_add_u32 m0, s22, 36864
    ds_read_b128 a[220:223], v1 offset:12288
    v_fma_f32 v80, v80, s28, v12
    v_mfma_f32_16x16x32_bf16 v[196:199], a[228:231], v[20:23], v[196:199]
    ds_read_b128 a[216:219], v0 offset:12288
    v_cvt_pk_bf16_f32 v27, v70, v71
    v_mfma_f32_16x16x32_bf16 v[148:151], a[228:231], v[16:19], v[148:151]
    buffer_load_dwordx4 v6, s[8:11], s21 offen lds
    v_mfma_f32_16x16x32_bf16 v[152:155], a[232:235], v[16:19], v[152:155]
    v_exp_f32_e64 v59, v59 clamp
    v_mfma_f32_16x16x32_bf16 v[200:203], a[232:235], v[20:23], v[200:203]
    s_add_u32 s21, s21, 128
    ds_read_b128 a[224:227], v0 offset:13312
    s_add_u32 m0, s22, 37888
    v_mfma_f32_16x16x32_bf16 v[248:251], a[232:235], v[28:31], v[248:251]
    buffer_load_dwordx4 v6, s[8:11], s21 offen lds
    v_mfma_f32_16x16x32_bf16 a[40:43], a[232:235], v[32:35], a[40:43]
    s_add_u32 s21, s21, 128
    v_exp_f32_e64 v62, v62 clamp
    v_mfma_f32_16x16x32_bf16 a[44:47], a[236:239], v[32:35], a[44:47]
    s_add_u32 m0, s22, 38912
    ds_read_b128 v[84:87], v103 offset:2048
    v_cvt_pk_bf16_f32 v37, v82, v83
    v_mfma_f32_16x16x32_bf16 v[252:255], a[236:239], v[28:31], v[252:255]
    buffer_load_dwordx4 v6, s[8:11], s21 offen lds
    v_mfma_f32_16x16x32_bf16 v[204:207], a[236:239], v[20:23], v[204:207]
    buffer_store_dwordx4 v[88:91], v6, s[16:19], s24 offen offset:0 nt
    v_cvt_pk_bf16_f32 v23, v62, v63
    v_exp_f32_e64 v57, v57 clamp
    v_mfma_f32_16x16x32_bf16 v[156:159], a[236:239], v[16:19], v[156:159]
    s_waitcnt lgkmcnt(2)
    v_exp_f32_e64 v77, v77 clamp
    v_mfma_f32_16x16x32_bf16 v[52:55], a[216:219], a[96:99], 0
    s_add_u32 s21, s21, 12032
    v_exp_f32_e64 v58, v58 clamp
    v_mfma_f32_16x16x32_bf16 v[52:55], a[220:223], a[100:103], v[52:55]
    v_cvt_pk_bf16_f32 v22, v60, v61
    s_waitcnt lgkmcnt(1)
    v_mfma_f32_16x16x32_bf16 v[52:55], a[224:227], a[104:107], v[52:55]
    ds_read_b128 a[232:235], v0 offset:14336
    v_cvt_pk_bf16_f32 v34, v76, v77
    v_mfma_f32_16x16x32_bf16 v[60:63], a[224:227], a[128:131], 0
    ds_read_b128 a[228:231], v1 offset:13312
    v_fma_f32 v74, v74, s28, v11
    v_mfma_f32_16x16x32_bf16 v[60:63], a[220:223], a[124:127], v[60:63]
    ds_read_b128 a[236:239], v1 offset:14336
    v_cvt_pk_bf16_f32 v26, v68, v69
    v_mfma_f32_16x16x32_bf16 v[60:63], a[216:219], a[120:123], v[60:63]
    s_add_u32 m0, s38, 24576
    v_exp_f32_e64 v67, v67 clamp
    v_mfma_f32_16x16x32_bf16 v[68:71], a[216:219], a[144:147], 0
    v_exp_f32_e64 v81, v81 clamp
    v_mfma_f32_16x16x32_bf16 v[68:71], a[220:223], a[148:151], v[68:71]
    buffer_load_dwordx4 v6, s[12:15], s25 offen nt lds
    v_mfma_f32_16x16x32_bf16 v[68:71], a[224:227], a[152:155], v[68:71]
    buffer_store_dwordx4 v[96:99], v7, s[16:19], s24 offen offset:0 nt
    v_exp_f32_e64 v56, v56 clamp
    v_cvt_pk_bf16_f32 v35, v78, v79
    v_mfma_f32_16x16x32_bf16 v[76:79], a[224:227], a[176:179], 0
    v_cvt_pk_bf16_f32 v16, v56, v57
    v_cvt_pk_bf16_f32 v17, v58, v59
    v_mfma_f32_16x16x32_bf16 v[76:79], a[220:223], a[172:175], v[76:79]
    ds_read_b128 v[88:91], v103 offset:3072
    v_fma_f32 v65, v65, s28, v10
    v_mfma_f32_16x16x32_bf16 v[76:79], a[216:219], a[168:171], v[76:79]
    s_add_u32 m0, s38, 25600
    v_exp_f32_e64 v66, v66 clamp
    v_mfma_f32_16x16x32_bf16 v[44:47], a[248:251], v[14:17], v[44:47]
    s_waitcnt lgkmcnt(2)
    v_exp_f32_e64 v65, v65 clamp
    v_mfma_f32_16x16x32_bf16 v[76:79], a[228:231], a[180:183], v[76:79]
    ds_read_b128 a[220:223], v1 offset:18432
    v_fma_f32 v73, v73, s28, v11
    v_mfma_f32_16x16x32_bf16 v[76:79], a[232:235], a[184:187], v[76:79]
    s_waitcnt lgkmcnt(2)
    v_exp_f32_e64 v80, v80 clamp
    v_mfma_f32_16x16x32_bf16 v[76:79], a[236:239], a[188:191], v[76:79]
    v_exp_f32_e64 v74, v74 clamp
    v_mfma_f32_16x16x32_bf16 v[68:71], a[236:239], a[164:167], v[68:71]
    ds_read_b128 a[216:219], v0 offset:18432
    v_cvt_pk_bf16_f32 v25, v66, v67
    v_mfma_f32_16x16x32_bf16 v[68:71], a[232:235], a[160:163], v[68:71]
    ds_read_b128 a[224:227], v0 offset:19456
    v_cvt_pk_bf16_f32 v24, v64, v65
    v_mfma_f32_16x16x32_bf16 v[68:71], a[228:231], a[156:159], v[68:71]
    buffer_load_dwordx4 v7, s[12:15], s25 offen nt lds
    v_mfma_f32_16x16x32_bf16 v[60:63], a[228:231], a[132:135], v[60:63]
    v_cvt_pk_bf16_f32 v36, v80, v81
    v_mfma_f32_16x16x32_bf16 v[60:63], a[232:235], a[136:139], v[60:63]
    v_exp_f32_e64 v72, v72 clamp
    v_mfma_f32_16x16x32_bf16 v[60:63], a[236:239], a[140:143], v[60:63]
    v_exp_f32_e64 v73, v73 clamp
    v_mfma_f32_16x16x32_bf16 v[52:55], a[236:239], a[116:119], v[52:55]
    ds_read_b128 a[236:239], v1 offset:20480
    v_cvt_pk_bf16_f32 v29, v74, v75
    v_mfma_f32_16x16x32_bf16 v[52:55], a[232:235], a[112:115], v[52:55]
    ds_read_b128 a[232:235], v0 offset:20480
    v_cvt_pk_bf16_f32 v28, v72, v73
    v_mfma_f32_16x16x32_bf16 v[52:55], a[228:231], a[108:111], v[52:55]
    ds_read_b128 a[228:231], v1 offset:19456
    v_smfmac_f32_16x16x64_bf16 v[44:47], a[240:243], v[22:29], v101
    s_add_u32 s57, s24, 128
    v_mfma_f32_16x16x32_bf16 v[44:47], a[252:255], v[34:37], v[44:47]
    s_add_u32 s59, s25, 128
    s_add_u32 m0, s38, 26624
    s_waitcnt lgkmcnt(4)
    v_mfma_f32_16x16x32_bf16 v[56:59], a[216:219], a[96:99], 0
    buffer_load_dwordx4 v6, s[12:15], s59 offen nt lds
    v_mfma_f32_16x16x32_bf16 v[56:59], a[220:223], a[100:103], v[56:59]
    buffer_store_dwordx4 v[84:87], v6, s[16:19], s57 offen offset:0 nt
    s_add_u32 m0, s38, 27648
    v_cmp_lt_f32 vcc, s29, v44
    s_waitcnt lgkmcnt(3)
    v_mfma_f32_16x16x32_bf16 v[56:59], a[224:227], a[104:107], v[56:59]
    v_mfma_f32_16x16x32_bf16 v[64:67], a[224:227], a[128:131], 0
    buffer_load_dwordx4 v7, s[12:15], s59 offen nt lds
    v_mfma_f32_16x16x32_bf16 v[64:67], a[220:223], a[124:127], v[64:67]
    s_cbranch_vccnz L_rs_tr45a
L_ret_tr45a:
    v_fma_f32 v52, v52, s28, v9
    v_mfma_f32_16x16x32_bf16 v[64:67], a[216:219], a[120:123], v[64:67]
    s_waitcnt vmcnt(15) lgkmcnt(0)
    v_mfma_f32_16x16x32_bf16 v[72:75], a[216:219], a[144:147], 0
    s_barrier
    v_mfma_f32_16x16x32_bf16 v[72:75], a[220:223], a[148:151], v[72:75]
    s_add_u32 m0, s22, 12288
    v_exp_f32_e64 v52, v52 clamp
    v_mfma_f32_16x16x32_bf16 v[72:75], a[224:227], a[152:155], v[72:75]
    buffer_load_dwordx4 v6, s[4:7], s20 offen lds
    v_mfma_f32_16x16x32_bf16 v[80:83], a[224:227], a[176:179], 0
    s_add_u32 s20, s20, 128
    v_fma_f32 v55, v55, s28, v9
    s_add_u32 m0, s22, 13312
    v_mfma_f32_16x16x32_bf16 v[80:83], a[220:223], a[172:175], v[80:83]
    buffer_load_dwordx4 v6, s[4:7], s20 offen lds
    v_mfma_f32_16x16x32_bf16 v[80:83], a[216:219], a[168:171], v[80:83]
    s_add_u32 s20, s20, 128
    ds_read_b64_tr_b16 a[216:217], v2 offset:0
    v_fma_f32 v61, v61, s28, v10
    v_mfma_f32_16x16x32_bf16 v[80:83], a[228:231], a[180:183], v[80:83]
    s_add_u32 m0, s22, 14336
    ds_read_b64_tr_b16 a[218:219], v2 offset:6144
    v_fma_f32 v60, v60, s28, v10
    v_mfma_f32_16x16x32_bf16 v[80:83], a[232:235], a[184:187], v[80:83]
    buffer_load_dwordx4 v6, s[4:7], s20 offen lds
    v_mfma_f32_16x16x32_bf16 v[80:83], a[236:239], a[188:191], v[80:83]
    buffer_store_dwordx4 v[88:91], v7, s[16:19], s57 offen offset:0 nt
    v_fma_f32 v54, v54, s28, v9
    v_exp_f32_e64 v54, v54 clamp
    v_mfma_f32_16x16x32_bf16 v[72:75], a[236:239], a[164:167], v[72:75]
    ds_read_b64_tr_b16 a[220:221], v3 offset:0
    v_mfma_f32_16x16x32_bf16 v[72:75], a[232:235], a[160:163], v[72:75]
    v_exp_f32_e64 v55, v55 clamp
    v_mfma_f32_16x16x32_bf16 v[72:75], a[228:231], a[156:159], v[72:75]
    ds_read_b64_tr_b16 a[222:223], v3 offset:6144
    v_cvt_pk_bf16_f32 v19, v54, v55
    v_mfma_f32_16x16x32_bf16 v[64:67], a[228:231], a[132:135], v[64:67]
    s_add_u32 s20, s20, 12032
    ds_read_b64_tr_b16 a[224:225], v4 offset:0
    v_fma_f32 v53, v53, s28, v9
    v_mfma_f32_16x16x32_bf16 v[64:67], a[232:235], a[136:139], v[64:67]
    v_exp_f32_e64 v61, v61 clamp
    v_mfma_f32_16x16x32_bf16 v[64:67], a[236:239], a[140:143], v[64:67]
    v_exp_f32_e64 v53, v53 clamp
    v_mfma_f32_16x16x32_bf16 v[56:59], a[236:239], a[116:119], v[56:59]
    s_waitcnt lgkmcnt(3)
    v_exp_f32_e64 v60, v60 clamp
    v_mfma_f32_16x16x32_bf16 v[56:59], a[232:235], a[112:115], v[56:59]
    ds_read_b64_tr_b16 a[226:227], v4 offset:6144
    v_cvt_pk_bf16_f32 v18, v52, v53
    v_mfma_f32_16x16x32_bf16 v[56:59], a[228:231], a[108:111], v[56:59]
    ds_read_b64_tr_b16 a[228:229], v5 offset:0
    ds_read_b64_tr_b16 a[230:231], v5 offset:6144
    v_fma_f32 v73, v73, s28, v11
    v_mfma_f32_16x16x32_bf16 v[112:115], a[216:219], v[14:17], v[112:115]
    ds_read_b64_tr_b16 a[236:237], v3 offset:1024
    s_nop 2
    v_fma_f32 v56, v56, s28, v9
    v_mfma_f32_16x16x32_bf16 v[160:163], a[216:219], v[22:25], v[160:163]
    v_and_b32 v104, 0x3ff, v0
    v_fma_f32 v62, v62, s28, v10
    v_lshrrev_b32 v105, 11, v0
    v_xor_b32 v105, s65, v105
    v_mfma_f32_16x16x32_bf16 v[208:211], a[216:219], v[26:29], v[208:211]
    ds_read_b64_tr_b16 a[232:233], v2 offset:1024
    v_lshl_add_u32 v104, v105, 10, v104
    v_mfma_f32_16x16x32_bf16 a[0:3], a[216:219], v[34:37], a[0:3]
    s_waitcnt lgkmcnt(6)
    ds_read_b64_tr_b16 a[234:235], v2 offset:7168
    v_add_u32 v104, s38, v104
    v_mfma_f32_16x16x32_bf16 a[4:7], a[220:223], v[34:37], a[4:7]
    ds_read_b64_tr_b16 a[218:219], v4 offset:7168
    v_xor_b32 v105, 64, v104
    v_mfma_f32_16x16x32_bf16 v[212:215], a[220:223], v[26:29], v[212:215]
    v_fma_f32 v58, v58, s28, v9
    v_fma_f32 v83, v83, s28, v12
    v_mfma_f32_16x16x32_bf16 v[164:167], a[220:223], v[22:25], v[164:167]
    ds_read_b64_tr_b16 a[238:239], v3 offset:7168
    v_fma_f32 v67, v67, s28, v10
    v_mfma_f32_16x16x32_bf16 v[116:119], a[220:223], v[14:17], v[116:119]
    s_waitcnt lgkmcnt(7)
    ds_read_b128 a[112:115], v104 offset:4096
    v_fma_f32 v66, v66, s28, v10
    v_mfma_f32_16x16x32_bf16 v[120:123], a[224:227], v[14:17], v[120:123]
    ds_read_b128 a[164:167], v105 offset:16384
    v_fma_f32 v75, v75, s28, v11
    v_mfma_f32_16x16x32_bf16 v[168:171], a[224:227], v[22:25], v[168:171]
    ds_read_b64_tr_b16 a[216:217], v4 offset:1024
    v_fma_f32 v57, v57, s28, v9
    v_mfma_f32_16x16x32_bf16 v[216:219], a[224:227], v[26:29], v[216:219]
    s_add_u32 s39, s39, 12288
    v_exp_f32_e64 v66, v66 clamp
    v_mfma_f32_16x16x32_bf16 a[8:11], a[224:227], v[34:37], a[8:11]
    s_waitcnt lgkmcnt(7)
    ds_read_b128 a[104:107], v104 offset:2048
    v_exp_f32_e64 v67, v67 clamp
    v_mfma_f32_16x16x32_bf16 a[12:15], a[228:231], v[34:37], a[12:15]
    ds_read_b128 a[116:119], v105 offset:4096
    v_fma_f32 v72, v72, s28, v11
    v_fma_f32 v80, v80, s28, v12
    v_mfma_f32_16x16x32_bf16 v[220:223], a[228:231], v[26:29], v[220:223]
    ds_read_b64_tr_b16 a[226:227], v2 offset:8192
    v_fma_f32 v63, v63, s28, v10
    v_mfma_f32_16x16x32_bf16 v[172:175], a[228:231], v[22:25], v[172:175]
    ds_read_b128 a[176:179], v104 offset:20480
    v_fma_f32 v76, v76, s28, v12
    v_mfma_f32_16x16x32_bf16 v[124:127], a[228:231], v[14:17], v[124:127]
    s_waitcnt lgkmcnt(8)
    ds_read_b64_tr_b16 a[222:223], v5 offset:7168
    v_fma_f32 v74, v74, s28, v11
    v_mfma_f32_16x16x32_bf16 v[128:131], a[232:235], v[14:17], v[128:131]
    ds_read_b64_tr_b16 a[224:225], v2 offset:2048
    v_fma_f32 v82, v82, s28, v12
    v_mfma_f32_16x16x32_bf16 v[176:179], a[232:235], v[22:25], v[176:179]
    v_fma_f32 v70, v70, s28, v11
    v_fma_f32 v65, v65, s28, v10
    v_mfma_f32_16x16x32_bf16 v[224:227], a[232:235], v[26:29], v[224:227]
    ds_read_b64_tr_b16 a[220:221], v5 offset:1024
    v_exp_f32_e64 v83, v83 clamp
    v_mfma_f32_16x16x32_bf16 a[16:19], a[232:235], v[34:37], a[16:19]
    s_waitcnt lgkmcnt(7)
    ds_read_b64_tr_b16 a[232:233], v4 offset:2048
    v_fma_f32 v77, v77, s28, v12
    v_mfma_f32_16x16x32_bf16 a[20:23], a[236:239], v[34:37], a[20:23]
    ds_read_b64_tr_b16 a[234:235], v4 offset:8192
    v_cvt_pk_bf16_f32 v21, v66, v67
    v_mfma_f32_16x16x32_bf16 v[228:231], a[236:239], v[26:29], v[228:231]
    ds_read_b64_tr_b16 a[228:229], v3 offset:2048
    v_fma_f32 v71, v71, s28, v11
    v_mfma_f32_16x16x32_bf16 v[180:183], a[236:239], v[22:25], v[180:183]
    ds_read_b64_tr_b16 a[230:231], v3 offset:8192
    v_fma_f32 v59, v59, s28, v9
    v_mfma_f32_16x16x32_bf16 v[132:135], a[236:239], v[14:17], v[132:135]
    ds_read_b64_tr_b16 a[238:239], v5 offset:8192
    v_exp_f32_e64 v77, v77 clamp
    v_mfma_f32_16x16x32_bf16 v[136:139], a[216:219], v[14:17], v[136:139]
    ds_read_b64_tr_b16 a[236:237], v5 offset:2048
    v_exp_f32_e64 v62, v62 clamp
    v_mfma_f32_16x16x32_bf16 v[184:187], a[216:219], v[22:25], v[184:187]
    ds_read_b128 a[172:175], v105 offset:18432
    v_exp_f32_e64 v63, v63 clamp
    v_mfma_f32_16x16x32_bf16 v[232:235], a[216:219], v[26:29], v[232:235]
    ds_read_b128 a[120:123], v104 offset:6144
    v_fma_f32 v78, v78, s28, v12
    v_mfma_f32_16x16x32_bf16 a[24:27], a[216:219], v[34:37], a[24:27]
    s_waitcnt lgkmcnt(8)
    ds_read_b128 a[100:103], v105 offset:0
    v_exp_f32_e64 v65, v65 clamp
    v_mfma_f32_16x16x32_bf16 a[28:31], a[220:223], v[34:37], a[28:31]
    v_exp_f32_e64 v71, v71 clamp
    v_fma_f32 v81, v81, s28, v12
    v_mfma_f32_16x16x32_bf16 v[236:239], a[220:223], v[26:29], v[236:239]
    ds_read_b128 a[96:99], v104 offset:0
    v_exp_f32_e64 v59, v59 clamp
    v_fma_f32 v64, v64, s28, v10
    v_mfma_f32_16x16x32_bf16 v[188:191], a[220:223], v[22:25], v[188:191]
    v_fma_f32 v69, v69, s28, v11
    v_exp_f32_e64 v74, v74 clamp
    v_mfma_f32_16x16x32_bf16 v[140:143], a[220:223], v[14:17], v[140:143]
    ds_read_b128 a[124:127], v105 offset:6144
    v_exp_f32_e64 v81, v81 clamp
    v_mfma_f32_16x16x32_bf16 v[144:147], a[224:227], v[14:17], v[144:147]
    v_exp_f32_e64 v70, v70 clamp
    v_mfma_f32_16x16x32_bf16 v[192:195], a[224:227], v[22:25], v[192:195]
    s_waitcnt vmcnt(16) lgkmcnt(4)
    ds_read_b128 a[168:171], v104 offset:18432
    v_fma_f32 v68, v68, s28, v11
    v_mfma_f32_16x16x32_bf16 v[240:243], a[224:227], v[26:29], v[240:243]
    s_add_u32 s21, s21, s62
    v_exp_f32_e64 v57, v57 clamp
    v_mfma_f32_16x16x32_bf16 a[32:35], a[224:227], v[34:37], a[32:35]
    s_barrier
    ds_read_b128 a[216:219], v0 offset:0
    v_mfma_f32_16x16x32_bf16 a[36:39], a[228:231], v[34:37], a[36:39]
    s_add_u32 m0, s22, 24576
    ds_read_b128 a[128:131], v104 offset:8192
    buffer_load_dwordx4 v6, s[8:11], s21 offen lds
    v_mfma_f32_16x16x32_bf16 v[244:247], a[228:231], v[26:29], v[244:247]
    s_add_u32 s21, s21, 128
    v_exp_f32_e64 v75, v75 clamp
    v_fma_f32 v79, v79, s28, v12
    v_mfma_f32_16x16x32_bf16 v[196:199], a[228:231], v[22:25], v[196:199]
    s_add_u32 m0, s22, 25600
    ds_read_b128 a[144:147], v104 offset:12288
    buffer_load_dwordx4 v6, s[8:11], s21 offen lds
    v_mfma_f32_16x16x32_bf16 v[148:151], a[228:231], v[14:17], v[148:151]
    s_add_u32 s21, s21, 128
    ds_read_b128 a[220:223], v1 offset:0
    v_exp_f32_e64 v68, v68 clamp
    v_mfma_f32_16x16x32_bf16 v[152:155], a[232:235], v[14:17], v[152:155]
    s_add_u32 m0, s22, 26624
    ds_read_b128 a[156:159], v105 offset:14336
    v_cvt_pk_bf16_f32 v31, v70, v71
    v_exp_f32_e64 v78, v78 clamp
    v_mfma_f32_16x16x32_bf16 v[200:203], a[232:235], v[22:25], v[200:203]
    buffer_load_dwordx4 v6, s[8:11], s21 offen lds
    v_mfma_f32_16x16x32_bf16 v[248:251], a[232:235], v[26:29], v[248:251]
    s_add_u32 s21, s21, 12032
    ds_read_b128 a[148:151], v105 offset:12288
    v_exp_f32_e64 v76, v76 clamp
    v_mfma_f32_16x16x32_bf16 a[40:43], a[232:235], v[34:37], a[40:43]
    s_waitcnt vmcnt(10)
    ds_read_b128 a[192:195], v104 offset:24576
    v_exp_f32_e64 v64, v64 clamp
    v_mfma_f32_16x16x32_bf16 a[44:47], a[236:239], v[34:37], a[44:47]
    ds_read_b128 a[108:111], v105 offset:2048
    v_exp_f32_e64 v69, v69 clamp
    v_mfma_f32_16x16x32_bf16 v[252:255], a[236:239], v[26:29], v[252:255]
    v_exp_f32_e64 v73, v73 clamp
    v_exp_f32_e64 v79, v79 clamp
    v_mfma_f32_16x16x32_bf16 v[204:207], a[236:239], v[22:25], v[204:207]
    ds_read_b128 a[224:227], v0 offset:1024
    v_cvt_pk_bf16_f32 v22, v60, v61
    v_exp_f32_e64 v82, v82 clamp
    v_mfma_f32_16x16x32_bf16 v[156:159], a[236:239], v[14:17], v[156:159]
    s_waitcnt lgkmcnt(5)
    ds_read_b128 a[196:199], v105 offset:24576
    v_cvt_pk_bf16_f32 v35, v78, v79
    v_mfma_f32_16x16x32_bf16 v[52:55], a[216:219], a[96:99], 0
    s_waitcnt vmcnt(7)
    v_cvt_pk_bf16_f32 v34, v76, v77
    v_cvt_pk_bf16_f32 v30, v68, v69
    v_cvt_pk_bf16_f32 v23, v62, v63
    v_mfma_f32_16x16x32_bf16 v[60:63], a[216:219], a[120:123], 0
    ds_read_b128 a[152:155], v104 offset:14336
    v_exp_f32_e64 v58, v58 clamp
    v_mfma_f32_16x16x32_bf16 v[68:71], a[216:219], a[144:147], 0
    v_exp_f32_e64 v56, v56 clamp
    v_mfma_f32_16x16x32_bf16 v[76:79], a[216:219], a[168:171], 0
    s_waitcnt lgkmcnt(4)
    ds_read_b128 a[200:203], v104 offset:26624
    v_cvt_pk_bf16_f32 v20, v64, v65
    v_mfma_f32_16x16x32_bf16 v[84:87], a[216:219], a[192:195], 0
    ds_read_b128 a[204:207], v105 offset:26624
    v_cvt_pk_bf16_f32 v16, v56, v57
    v_mfma_f32_16x16x32_bf16 v[52:55], a[220:223], a[100:103], v[52:55]
    ds_read_b128 a[228:231], v1 offset:1024
    v_exp_f32_e64 v80, v80 clamp
    v_mfma_f32_16x16x32_bf16 v[60:63], a[220:223], a[124:127], v[60:63]
    ds_read_b128 a[160:163], v104 offset:16384
    v_cvt_pk_bf16_f32 v33, v82, v83
    v_mfma_f32_16x16x32_bf16 v[68:71], a[220:223], a[148:151], v[68:71]
    ds_read_b128 a[132:135], v105 offset:8192
    v_cvt_pk_bf16_f32 v17, v58, v59
    v_mfma_f32_16x16x32_bf16 v[76:79], a[220:223], a[172:175], v[76:79]
    ds_read_b128 a[232:235], v0 offset:6144
    v_cvt_pk_bf16_f32 v29, v74, v75
    v_smfmac_f32_16x16x64_bf16 v[48:51], a[240:243], v[16:23], v101
    s_waitcnt lgkmcnt(7)
    ds_read_b128 a[180:183], v105 offset:20480
    v_mfma_f32_16x16x32_bf16 v[84:87], a[220:223], a[196:199], v[84:87]
    v_exp_f32_e64 v72, v72 clamp
    v_mfma_f32_16x16x32_bf16 v[52:55], a[224:227], a[104:107], v[52:55]
    v_cvt_pk_bf16_f32 v32, v80, v81
    v_cvt_pk_bf16_f32 v28, v72, v73
    v_mfma_f32_16x16x32_bf16 v[60:63], a[224:227], a[128:131], v[60:63]
    ds_read_b128 a[236:239], v1 offset:6144
    v_smfmac_f32_16x16x64_bf16 v[48:51], a[244:247], v[28:35], v101
    s_waitcnt lgkmcnt(7)
    ds_read_b128 a[184:187], v104 offset:22528
    v_mfma_f32_16x16x32_bf16 v[68:71], a[224:227], a[152:155], v[68:71]
    ds_read_b128 a[136:139], v104 offset:10240
    v_mfma_f32_16x16x32_bf16 v[76:79], a[224:227], a[176:179], v[76:79]
    ds_read_b128 a[140:143], v105 offset:10240
    v_mfma_f32_16x16x32_bf16 v[84:87], a[224:227], a[200:203], v[84:87]
    s_waitcnt lgkmcnt(7)
    ds_read_b128 a[188:191], v105 offset:22528
    v_cmp_lt_f32 vcc, s29, v48
    v_mfma_f32_16x16x32_bf16 v[52:55], a[228:231], a[108:111], v[52:55]
    s_waitcnt lgkmcnt(7)
    ds_read_b128 a[216:219], v0 offset:7168
    v_mfma_f32_16x16x32_bf16 v[60:63], a[228:231], a[132:135], v[60:63]
    s_nop 0
    s_cbranch_vccnz L_rs_tr45b
L_ret_tr45b:
    v_mfma_f32_16x16x32_bf16 v[68:71], a[228:231], a[156:159], v[68:71]
    s_waitcnt lgkmcnt(6)
    v_lshrrev_b32 v108, 11, v0
    v_mov_b32 v111, v46
    v_mfma_f32_16x16x32_bf16 v[76:79], a[228:231], a[180:183], v[76:79]
    v_xor_b32 v108, s65, v108
    v_mov_b32 v109, v50
    v_mfma_f32_16x16x32_bf16 v[84:87], a[228:231], a[204:207], v[84:87]
    v_permlane16_swap_b32 v46, v111
    v_mfma_f32_16x16x32_bf16 v[56:59], a[232:235], a[96:99], 0
    ds_read_b128 a[228:231], v1 offset:2048
    v_and_b32 v93, 0x3ff, v0
    v_mfma_f32_16x16x32_bf16 v[64:67], a[232:235], a[120:123], 0
    v_mov_b32 v110, v45
    v_lshl_add_u32 v93, v108, 10, v93
    v_mfma_f32_16x16x32_bf16 v[72:75], a[232:235], a[144:147], 0
    v_permlane16_swap_b32 v45, v110
    v_mfma_f32_16x16x32_bf16 v[80:83], a[232:235], a[168:171], 0
    v_add_f32 v46, v46, v111
    v_mov_b32 v111, v46
    v_mfma_f32_16x16x32_bf16 v[88:91], a[232:235], a[192:195], 0
    s_waitcnt lgkmcnt(2)
    ds_read_b128 a[220:223], v1 offset:7168
    v_mbcnt_lo_u32_b32 v108, -1, 0
    v_mfma_f32_16x16x32_bf16 v[56:59], a[236:239], a[100:103], v[56:59]
    v_permlane16_swap_b32 v50, v109
    v_mfma_f32_16x16x32_bf16 v[64:67], a[236:239], a[124:127], v[64:67]
    ds_read_b128 a[232:235], v0 offset:8192
    v_mbcnt_hi_u32_b32 v108, -1, v108
    v_mfma_f32_16x16x32_bf16 v[72:75], a[236:239], a[148:151], v[72:75]
    v_lshrrev_b32 v108, 1, v108
    v_mfma_f32_16x16x32_bf16 v[80:83], a[236:239], a[172:175], v[80:83]
    ds_read_b128 a[224:227], v0 offset:2048
    v_add_f32 v50, v50, v109
    v_mfma_f32_16x16x32_bf16 v[88:91], a[236:239], a[196:199], v[88:91]
    s_waitcnt lgkmcnt(4)
    ds_read_b128 a[236:239], v1 offset:8192
    v_mov_b32 v109, v50
    v_mfma_f32_16x16x32_bf16 v[56:59], a[216:219], a[104:107], v[56:59]
    v_and_b32 v108, 24, v108
    v_add_f32 v45, v45, v110
    v_mfma_f32_16x16x32_bf16 v[64:67], a[216:219], a[128:131], v[64:67]
    v_mfma_f32_16x16x32_bf16 v[72:75], a[216:219], a[152:155], v[72:75]
    v_permlane32_swap_b32 v50, v109
    v_mfma_f32_16x16x32_bf16 v[80:83], a[216:219], a[176:179], v[80:83]
    s_waitcnt vmcnt(17)
    v_bfe_u32 v108, s66, v108, 8
    v_mfma_f32_16x16x32_bf16 v[88:91], a[216:219], a[200:203], v[88:91]
    s_waitcnt lgkmcnt(3)
    v_mov_b32 v110, v45
    v_add_u32 v93, s38, v93
    v_mfma_f32_16x16x32_bf16 v[56:59], a[220:223], a[108:111], v[56:59]
    v_permlane32_swap_b32 v46, v111
    v_mfma_f32_16x16x32_bf16 v[64:67], a[220:223], a[132:135], v[64:67]
    v_xor_b32 v93, v93, v108
    v_mov_b32 v108, v49
    v_mfma_f32_16x16x32_bf16 v[72:75], a[220:223], a[156:159], v[72:75]
    v_permlane32_swap_b32 v45, v110
    v_mfma_f32_16x16x32_bf16 v[80:83], a[220:223], a[180:183], v[80:83]
    v_permlane16_swap_b32 v49, v108
    v_mfma_f32_16x16x32_bf16 v[88:91], a[220:223], a[204:207], v[88:91]
    s_waitcnt vmcnt(14) lgkmcnt(0)
    s_add_u32 m0, s22, 0
    v_add_f32 v94, v109, v46
    v_mfma_f32_16x16x32_bf16 v[52:55], a[224:227], a[112:115], v[52:55]
    s_barrier
    v_mfma_f32_16x16x32_bf16 v[60:63], a[224:227], a[136:139], v[60:63]
    buffer_load_dwordx4 v6, s[4:7], s20 offen lds
    v_mfma_f32_16x16x32_bf16 v[68:71], a[224:227], a[160:163], v[68:71]
    s_add_u32 s20, s20, 128
    ds_read_b64_tr_b16 a[216:217], v2 offset:18432
    s_add_u32 m0, s22, 1024
    v_mfma_f32_16x16x32_bf16 v[76:79], a[224:227], a[184:187], v[76:79]
    buffer_load_dwordx4 v6, s[4:7], s20 offen lds
    v_mfma_f32_16x16x32_bf16 v[84:87], a[224:227], a[208:211], v[84:87]
    s_add_u32 s20, s20, 128
    s_add_u32 m0, s22, 2048
    ds_read_b64_tr_b16 a[218:219], v2 offset:12288
    v_mfma_f32_16x16x32_bf16 v[52:55], a[228:231], a[116:119], v[52:55]
    buffer_load_dwordx4 v6, s[4:7], s20 offen lds
    v_mfma_f32_16x16x32_bf16 v[60:63], a[228:231], a[140:143], v[60:63]
    v_add_f32 v49, v49, v108
    v_mov_b32 v108, v49
    v_mfma_f32_16x16x32_bf16 v[68:71], a[228:231], a[164:167], v[68:71]
    v_rcp_f32 v94, v94
    v_mfma_f32_16x16x32_bf16 v[76:79], a[228:231], a[188:191], v[76:79]
    v_permlane32_swap_b32 v49, v108
    v_mfma_f32_16x16x32_bf16 v[84:87], a[228:231], a[212:215], v[84:87]
    ds_read_b64_tr_b16 a[220:221], v3 offset:18432
    v_add_f32 v92, v108, v45
    v_mfma_f32_16x16x32_bf16 v[56:59], a[232:235], a[112:115], v[56:59]
    ds_read_b64_tr_b16 a[222:223], v3 offset:12288
    v_mfma_f32_16x16x32_bf16 v[64:67], a[232:235], a[136:139], v[64:67]
    ds_read_b64_tr_b16 a[224:225], v4 offset:18432
    v_mfma_f32_16x16x32_bf16 v[72:75], a[232:235], a[160:163], v[72:75]
    v_add_f32 v50, v50, v110
    v_mfma_f32_16x16x32_bf16 v[80:83], a[232:235], a[184:187], v[80:83]
    v_add_f32 v48, v49, v47
    v_mfma_f32_16x16x32_bf16 v[88:91], a[232:235], a[208:211], v[88:91]
    ds_read_b64_tr_b16 a[226:227], v4 offset:12288
    v_mfma_f32_16x16x32_bf16 v[56:59], a[236:239], a[116:119], v[56:59]
    v_rcp_f32 v92, v92
    v_mfma_f32_16x16x32_bf16 v[64:67], a[236:239], a[140:143], v[64:67]
    s_add_u32 s20, s20, 12032
    ds_read_b64_tr_b16 a[228:229], v5 offset:18432
    v_mfma_f32_16x16x32_bf16 v[72:75], a[236:239], a[164:167], v[72:75]
    v_rcp_f32 v48, v48
    v_mfma_f32_16x16x32_bf16 v[80:83], a[236:239], a[188:191], v[80:83]
    ds_read_b64_tr_b16 a[230:231], v5 offset:12288
    v_mfma_f32_16x16x32_bf16 v[88:91], a[236:239], a[212:215], v[88:91]
    s_waitcnt lgkmcnt(5)
    v_rcp_f32 v50, v50
    v_mfma_f32_16x16x32_bf16 v[112:115], a[216:219], v[16:19], v[112:115]
    s_mov_b32 s67, s34
    ds_read_b64_tr_b16 a[232:233], v2 offset:19456
    v_max3_f32 v97, v60, v61, v62
    v_max3_f32 v96, v52, v53, v54
    v_mfma_f32_16x16x32_bf16 v[160:163], a[216:219], v[20:23], v[160:163]
    s_add_u32 s18, s34, 24576
    v_max3_f32 v97, v97, v63, v64
    v_max3_f32 v99, v76, v77, v78
    v_mfma_f32_16x16x32_bf16 v[208:211], a[216:219], v[28:31], v[208:211]
    v_max3_f32 v99, v99, v79, v80
    v_max3_f32 v96, v96, v55, v56
    v_max3_f32 v99, v99, v81, v82
    v_max3_f32 v97, v97, v65, v66
    v_max3_f32 v98, v68, v69, v70
    v_max_f32 v97, v97, v67
    v_max3_f32 v96, v96, v57, v58
    v_mfma_f32_16x16x32_bf16 a[0:3], a[216:219], v[32:35], a[0:3]
    s_waitcnt lgkmcnt(5)
    v_max_f32 v99, v99, v83
    v_max_f32 v96, v96, v59
    v_max3_f32 v98, v98, v71, v72
    v_mfma_f32_16x16x32_bf16 a[4:7], a[220:223], v[32:35], a[4:7]
    s_mov_b32 s34, s33
    ds_read_b64_tr_b16 a[216:217], v4 offset:19456
    v_max3_f32 v98, v98, v73, v74
    v_mfma_f32_16x16x32_bf16 v[212:215], a[220:223], v[28:31], v[212:215]
    ds_read_b64_tr_b16 a[234:235], v2 offset:13312
    v_permlane32_swap_b32 v96, v97
    v_mfma_f32_16x16x32_bf16 v[164:167], a[220:223], v[20:23], v[164:167]
    s_add_u32 s64, s64, s62
    ds_read_b64_tr_b16 a[238:239], v3 offset:13312
    v_max_f32 v98, v98, v75
    v_mfma_f32_16x16x32_bf16 v[116:119], a[220:223], v[16:19], v[116:119]
    s_waitcnt lgkmcnt(4)
    ds_read_b64_tr_b16 a[218:219], v4 offset:13312
    v_max_f32 v96, v96, v97
    v_mfma_f32_16x16x32_bf16 v[120:123], a[224:227], v[16:19], v[120:123]
    s_add_u32 s64, s64, 196608
    v_permlane32_swap_b32 v98, v99
    v_max_f32 v98, v98, v99
    v_mfma_f32_16x16x32_bf16 v[168:171], a[224:227], v[20:23], v[168:171]
    s_mov_b32 s39, s64
    v_permlane16_swap_b32 v96, v98
    v_max_f32 v96, v96, v98
    v_mul_f32_e64 v9, -s28, v96
    v_mfma_f32_16x16x32_bf16 v[216:219], a[224:227], v[28:31], v[216:219]
    s_add_u32 s37, s37, 1
    ds_read_b64_tr_b16 a[236:237], v3 offset:19456
    v_max3_f32 v96, v84, v85, v86
    v_mfma_f32_16x16x32_bf16 a[8:11], a[224:227], v[32:35], a[8:11]
    s_bitcmp1_b32 s63, s37
    ds_read_b64_tr_b16 a[222:223], v5 offset:13312
    v_max3_f32 v96, v96, v87, v88
    v_subrev_f32 v9, 0x42000000, v9
    v_mfma_f32_16x16x32_bf16 a[12:15], a[228:231], v[32:35], a[12:15]
    s_cselect_b32 s62, 4294770688, 0
    ds_read_b64_tr_b16 a[220:221], v5 offset:19456
    v_mov_b32 v11, v9
    v_mfma_f32_16x16x32_bf16 v[220:223], a[228:231], v[28:31], v[220:223]
    s_cselect_b32 s42, 0, 325632
    v_permlane16_swap_b32 v9, v11
    v_mov_b32 v10, v9
    v_mfma_f32_16x16x32_bf16 v[172:175], a[228:231], v[20:23], v[172:175]
    s_add_u32 s35, s35, s42
    v_max3_f32 v96, v96, v89, v90
    v_mov_b32 v12, v11
    v_mfma_f32_16x16x32_bf16 v[124:127], a[228:231], v[16:19], v[124:127]
    s_waitcnt lgkmcnt(4)
    v_permlane32_swap_b32 v9, v10
    v_max_f32 v96, v96, v91
    v_fma_f32 v52, v52, s28, v9
    v_mfma_f32_16x16x32_bf16 v[128:131], a[232:235], v[16:19], v[128:131]
    s_lshl_b32 s42, s37, 1
    v_fma_f32 v56, v56, s28, v9
    v_permlane32_swap_b32 v11, v12
    v_fma_f32 v53, v53, s28, v9
    v_mfma_f32_16x16x32_bf16 v[176:179], a[232:235], v[20:23], v[176:179]
    s_lshr_b32 s42, s31, s42
    ds_read_b64_tr_b16 a[224:225], v2 offset:20480
    v_fma_f32 v78, v78, s28, v12
    v_mov_b32 v97, v96
    v_mfma_f32_16x16x32_bf16 v[224:227], a[232:235], v[28:31], v[224:227]
    s_and_b32 s42, s42, 3
    ds_read_b64_tr_b16 a[226:227], v2 offset:14336
    v_permlane32_swap_b32 v97, v96
    v_mfma_f32_16x16x32_bf16 a[16:19], a[232:235], v[32:35], a[16:19]
    s_waitcnt lgkmcnt(3)
    ds_read_b64_tr_b16 a[230:231], v3 offset:14336
    v_max_f32 v96, v96, v97
    v_mfma_f32_16x16x32_bf16 a[20:23], a[236:239], v[32:35], a[20:23]
    s_add_u32 s42, s42, s36
    v_exp_f32_e64 v52, v52 clamp
    v_fma_f32 v58, v58, s28, v9
    v_mov_b32 v97, v96
    s_sub_u32 s43, s42, 3
    v_fma_f32 v54, v54, s28, v9
    v_pk_mul_f32 v[164:165], v[164:165], v[92:93] op_sel_hi:[1,0]
    v_permlane16_swap_b32 v97, v96
    v_pk_mul_f32 v[114:115], v[114:115], v[48:49] op_sel_hi:[1,0]
    v_fma_f32 v68, v68, s28, v11
    v_fma_f32 v63, v63, s28, v10
    v_fma_f32 v80, v80, s28, v12
    v_mfma_f32_16x16x32_bf16 v[228:231], a[236:239], v[28:31], v[228:231]
    s_cmp_ge_u32 s42, 3
    v_fma_f32 v61, v61, s28, v10
    v_fma_f32 v59, v59, s28, v9
    v_mfma_f32_16x16x32_bf16 v[180:183], a[236:239], v[20:23], v[180:183]
    s_cselect_b32 s42, s43, s42
    ds_read_b64_tr_b16 a[232:233], v4 offset:20480
    v_max_f32 v96, v96, v97
    v_mfma_f32_16x16x32_bf16 v[132:135], a[236:239], v[16:19], v[132:135]
    s_mul_i32 s44, s3, 5
    s_mov_b32 s32, 1
    ds_read_b64_tr_b16 a[228:229], v3 offset:20480
    v_mfma_f32_16x16x32_bf16 v[136:139], a[216:219], v[16:19], v[136:139]
    s_lshl_b32 s43, s3, 2
    s_add_u32 s45, s43, 21
    ds_read_b64_tr_b16 a[238:239], v5 offset:14336
    v_fma_f32 v81, v81, s28, v12
    s_cmp_eq_u32 s3, 0
    v_mfma_f32_16x16x32_bf16 v[184:187], a[216:219], v[20:23], v[184:187]
    s_cselect_b32 s45, 20, s45
    v_fma_f32 v62, v62, s28, v10
    v_accvgpr_read_b32 v111, a7
    v_mfma_f32_16x16x32_bf16 v[232:235], a[216:219], v[28:31], v[232:235]
    s_cselect_b32 s33, 1, 0
    ds_read_b64_tr_b16 a[234:235], v4 offset:14336
    v_fma_f32 v69, v69, s28, v11
    v_mfma_f32_16x16x32_bf16 a[24:27], a[216:219], v[32:35], a[24:27]
    s_cmp_eq_u32 s42, 1
    v_fma_f32 v79, v79, s28, v12
    s_cselect_b32 s44, s45, s44
    v_exp_f32_e64 v54, v54 clamp
    v_mul_f32_e64 v13, -s28, v96
    s_waitcnt lgkmcnt(4)
    v_mfma_f32_16x16x32_bf16 a[28:31], a[220:223], v[32:35], a[28:31]
    s_cselect_b32 s32, s33, s32
    ds_read_b64_tr_b16 a[236:237], v5 offset:20480
    v_exp_f32_e64 v79, v79 clamp
    v_mfma_f32_16x16x32_bf16 v[236:239], a[220:223], v[28:31], v[236:239]
    s_add_u32 s45, s43, 37
    v_fma_f32 v55, v55, s28, v9
    s_cmp_eq_u32 s42, 2
    v_mfma_f32_16x16x32_bf16 v[188:191], a[220:223], v[20:23], v[188:191]
    s_cselect_b32 s44, s45, s44
    s_cselect_b32 s32, 0, s32
    v_fma_f32 v77, v77, s28, v12
    v_mfma_f32_16x16x32_bf16 v[140:143], a[220:223], v[16:19], v[140:143]
    s_mul_i32 s44, s44, 6144
    v_fma_f32 v70, v70, s28, v11
    v_subrev_f32 v13, 0x42000000, v13
    v_mfma_f32_16x16x32_bf16 v[144:147], a[224:227], v[16:19], v[144:147]
    s_add_u32 s33, s35, s44
    v_fma_f32 v65, v65, s28, v10
    s_mul_i32 s42, s32, 6144
    v_fma_f32 v73, v73, s28, v11
    v_mfma_f32_16x16x32_bf16 v[192:195], a[224:227], v[20:23], v[192:195]
    s_add_u32 s42, s42, 24576
    v_fma_f32 v87, v87, s28, v13
    v_fma_f32 v71, v71, s28, v11
    v_mfma_f32_16x16x32_bf16 v[240:243], a[224:227], v[28:31], v[240:243]
    s_add_u32 s42, s42, s33
    v_exp_f32_e64 v68, v68 clamp
    v_fma_f32 v91, v91, s28, v13
    v_mfma_f32_16x16x32_bf16 a[32:35], a[224:227], v[32:35], a[32:35]
    s_waitcnt lgkmcnt(1)
    v_exp_f32_e64 v63, v63 clamp
    v_mfma_f32_16x16x32_bf16 a[36:39], a[228:231], v[32:35], a[36:39]
    s_cmp_ge_u32 s37, 6
    v_exp_f32_e64 v71, v71 clamp
    s_cselect_b32 s14, 0, s42
    v_mfma_f32_16x16x32_bf16 v[244:247], a[228:231], v[28:31], v[244:247]
    s_add_u32 s24, s67, 256
    v_fma_f32 v67, v67, s28, v10
    v_exp_f32_e64 v62, v62 clamp
    v_exp_f32_e64 v61, v61 clamp
    v_pk_mul_f32 v[208:209], v[208:209], v[50:51] op_sel_hi:[1,0]
    s_add_u32 s25, s33, 256
    v_accvgpr_read_b32 v104, a0
    s_add_u32 s23, s38, 4096
    v_mfma_f32_16x16x32_bf16 v[196:199], a[228:231], v[20:23], v[196:199]
    s_mov_b32 s27, 0x249
    v_fma_f32 v86, v86, s28, v13
    s_mov_b32 s30, 0
    v_mfma_f32_16x16x32_bf16 v[148:151], a[228:231], v[16:19], v[148:151]
    s_waitcnt vmcnt(7) lgkmcnt(0)
    v_exp_f32_e64 v78, v78 clamp
    v_mfma_f32_16x16x32_bf16 v[152:155], a[232:235], v[16:19], v[152:155]
    s_barrier
    v_fma_f32 v60, v60, s28, v10
    v_exp_f32_e64 v58, v58 clamp
    v_mfma_f32_16x16x32_bf16 v[200:203], a[232:235], v[20:23], v[200:203]
    ds_read_b128 a[216:219], v0 offset:12288
    v_fma_f32 v75, v75, s28, v11
    v_fma_f32 v84, v84, s28, v13
    v_fma_f32 v57, v57, s28, v9
    v_mfma_f32_16x16x32_bf16 v[248:251], a[232:235], v[28:31], v[248:251]
    ds_read_b128 a[220:223], v1 offset:12288
    v_fma_f32 v82, v82, s28, v12
    v_mfma_f32_16x16x32_bf16 a[40:43], a[232:235], v[32:35], a[40:43]
    ds_read_b128 a[224:227], v0 offset:13312
    v_fma_f32 v76, v76, s28, v12
    v_mfma_f32_16x16x32_bf16 a[44:47], a[236:239], v[32:35], a[44:47]
    v_exp_f32_e64 v84, v84 clamp
    v_exp_f32_e64 v55, v55 clamp
    v_exp_f32_e64 v87, v87 clamp
    v_exp_f32_e64 v60, v60 clamp
    v_exp_f32_e64 v77, v77 clamp
    v_cvt_pk_bf16_f32 v15, v54, v55
    v_mfma_f32_16x16x32_bf16 v[252:255], a[236:239], v[28:31], v[252:255]
    v_exp_f32_e64 v53, v53 clamp
    v_mfma_f32_16x16x32_bf16 v[204:207], a[236:239], v[20:23], v[204:207]
    s_add_u32 m0, s22, 36864
    v_exp_f32_e64 v76, v76 clamp
    v_exp_f32_e64 v69, v69 clamp
    v_exp_f32_e64 v86, v86 clamp
    v_exp_f32_e64 v70, v70 clamp
    v_cvt_pk_bf16_f32 v14, v52, v53
    v_cvt_pk_bf16_f32 v23, v62, v63
    v_cvt_pk_bf16_f32 v35, v78, v79
    v_cvt_pk_bf16_f32 v26, v68, v69
    v_mfma_f32_16x16x32_bf16 v[156:159], a[236:239], v[16:19], v[156:159]
    s_waitcnt lgkmcnt(1)
    v_accvgpr_read_b32 v107, a3
    v_fma_f32 v72, v72, s28, v11
    v_mfma_f32_16x16x32_bf16 v[52:55], a[216:219], a[96:99], 0
    ds_read_b128 a[232:235], v0 offset:14336
    v_accvgpr_read_b32 v106, a2
    v_mfma_f32_16x16x32_bf16 v[52:55], a[220:223], a[100:103], v[52:55]
    s_waitcnt lgkmcnt(1)
    v_cvt_pk_bf16_f32 v34, v76, v77
    v_cvt_pk_bf16_f32 v22, v60, v61
    v_mfma_f32_16x16x32_bf16 v[52:55], a[224:227], a[104:107], v[52:55]
    ds_read_b128 a[228:231], v1 offset:13312
    v_cvt_pk_bf16_f32 v27, v70, v71
    v_fma_f32 v89, v89, s28, v13
    v_mfma_f32_16x16x32_bf16 v[60:63], a[224:227], a[128:131], 0
    v_fma_f32 v74, v74, s28, v11
    v_exp_f32_e64 v75, v75 clamp
    v_cvt_pk_bf16_f32 v208, v208, v209
    v_fma_f32 v85, v85, s28, v13
    v_mfma_f32_16x16x32_bf16 v[60:63], a[220:223], a[124:127], v[60:63]
    ds_read_b128 a[236:239], v1 offset:14336
    v_exp_f32_e64 v81, v81 clamp
    v_exp_f32_e64 v85, v85 clamp
    v_mfma_f32_16x16x32_bf16 v[60:63], a[216:219], a[120:123], v[60:63]
    v_exp_f32_e64 v65, v65 clamp
    v_mfma_f32_16x16x32_bf16 v[68:71], a[216:219], a[144:147], 0
    v_fma_f32 v83, v83, s28, v12
    v_cvt_pk_bf16_f32 v39, v86, v87
    v_mfma_f32_16x16x32_bf16 v[68:71], a[220:223], a[148:151], v[68:71]
    v_exp_f32_e64 v83, v83 clamp
    v_mfma_f32_16x16x32_bf16 v[68:71], a[224:227], a[152:155], v[68:71]
    v_exp_f32_e64 v67, v67 clamp
    v_mfma_f32_16x16x32_bf16 v[76:79], a[224:227], a[176:179], 0
    v_exp_f32_e64 v82, v82 clamp
    v_mfma_f32_16x16x32_bf16 v[76:79], a[220:223], a[172:175], v[76:79]
    buffer_load_dwordx4 v6, s[8:11], s21 offen lds
    v_mfma_f32_16x16x32_bf16 v[76:79], a[216:219], a[168:171], v[76:79]
    v_fma_f32 v64, v64, s28, v10
    v_cvt_pk_bf16_f32 v38, v84, v85
    v_mfma_f32_16x16x32_bf16 v[84:87], a[216:219], a[192:195], 0
    v_exp_f32_e64 v74, v74 clamp
    v_mfma_f32_16x16x32_bf16 v[84:87], a[220:223], a[196:199], v[84:87]
    ds_read_b128 a[220:223], v1 offset:18432
    v_fma_f32 v90, v90, s28, v13
    v_exp_f32_e64 v56, v56 clamp
    v_mfma_f32_16x16x32_bf16 v[84:87], a[224:227], a[200:203], v[84:87]
    s_waitcnt lgkmcnt(1)
    v_cvt_pk_bf16_f32 v164, v164, v165
    v_exp_f32_e64 v90, v90 clamp
    v_mfma_f32_16x16x32_bf16 v[84:87], a[228:231], a[204:207], v[84:87]
    ds_read_b128 a[216:219], v0 offset:18432
    v_exp_f32_e64 v80, v80 clamp
    v_mfma_f32_16x16x32_bf16 v[84:87], a[232:235], a[208:211], v[84:87]
    s_add_u32 s21, s21, 128
    v_exp_f32_e64 v57, v57 clamp
    v_mfma_f32_16x16x32_bf16 v[84:87], a[236:239], a[212:215], v[84:87]
    ds_read_b128 a[224:227], v0 offset:19456
    v_fma_f32 v88, v88, s28, v13
    v_mfma_f32_16x16x32_bf16 v[76:79], a[236:239], a[188:191], v[76:79]
    v_cvt_pk_bf16_f32 v16, v56, v57
    v_fma_f32 v66, v66, s28, v10
    v_mfma_f32_16x16x32_bf16 v[76:79], a[232:235], a[184:187], v[76:79]
    v_exp_f32_e64 v64, v64 clamp
    v_mfma_f32_16x16x32_bf16 v[76:79], a[228:231], a[180:183], v[76:79]
    v_exp_f32_e64 v88, v88 clamp
    v_mfma_f32_16x16x32_bf16 v[68:71], a[228:231], a[156:159], v[68:71]
    s_add_u32 m0, s22, 37888
    v_exp_f32_e64 v59, v59 clamp
    v_mfma_f32_16x16x32_bf16 v[68:71], a[232:235], a[160:163], v[68:71]
    buffer_load_dwordx4 v6, s[8:11], s21 offen lds
    v_mfma_f32_16x16x32_bf16 v[68:71], a[236:239], a[164:167], v[68:71]
    v_exp_f32_e64 v89, v89 clamp
    v_mfma_f32_16x16x32_bf16 v[60:63], a[236:239], a[140:143], v[60:63]
    v_exp_f32_e64 v66, v66 clamp
    v_mfma_f32_16x16x32_bf16 v[60:63], a[232:235], a[136:139], v[60:63]
    v_cvt_pk_bf16_f32 v25, v66, v67
    v_accvgpr_read_b32 v105, a1
    v_mfma_f32_16x16x32_bf16 v[60:63], a[228:231], a[132:135], v[60:63]
    v_exp_f32_e64 v91, v91 clamp
    v_mfma_f32_16x16x32_bf16 v[52:55], a[228:231], a[108:111], v[52:55]
    v_accvgpr_read_b32 v109, a5
    v_fma_f32 v70, v70, s28, v11
    v_mfma_f32_16x16x32_bf16 v[52:55], a[232:235], a[112:115], v[52:55]
    s_add_u32 s21, s21, 128
    v_cvt_pk_bf16_f32 v17, v58, v59
    v_fma_f32 v68, v68, s28, v11
    v_mfma_f32_16x16x32_bf16 v[52:55], a[236:239], a[116:119], v[52:55]
    s_waitcnt lgkmcnt(0)
    ds_read_b128 a[228:231], v1 offset:19456
    v_fma_f32 v63, v63, s28, v10
    v_mfma_f32_16x16x32_bf16 v[56:59], a[216:219], a[96:99], 0
    ds_read_b128 a[232:235], v0 offset:20480
    v_cvt_pk_bf16_f32 v37, v82, v83
    v_mfma_f32_16x16x32_bf16 v[56:59], a[220:223], a[100:103], v[56:59]
    ds_read_b128 a[236:239], v1 offset:20480
    v_exp_f32_e64 v72, v72 clamp
    v_exp_f32_e64 v73, v73 clamp
    v_pk_mul_f32 v[120:121], v[120:121], v[48:49] op_sel_hi:[1,0]
    v_pk_mul_f32 v[200:201], v[200:201], v[92:93] op_sel_hi:[1,0]
    v_pk_mul_f32 v[232:233], v[232:233], v[50:51] op_sel_hi:[1,0]
    v_pk_mul_f32 v[192:193], v[192:193], v[92:93] op_sel_hi:[1,0]
    v_pk_mul_f32 v[112:113], v[112:113], v[48:49] op_sel_hi:[1,0]
    v_pk_mul_f32 v[104:105], v[104:105], v[94:95] op_sel_hi:[1,0]
    v_pk_mul_f32 v[198:199], v[198:199], v[92:93] op_sel_hi:[1,0]
    v_pk_mul_f32 v[106:107], v[106:107], v[94:95] op_sel_hi:[1,0]
    v_pk_mul_f32 v[116:117], v[116:117], v[48:49] op_sel_hi:[1,0]
    v_cvt_pk_bf16_f32 v36, v80, v81
    v_pk_mul_f32 v[162:163], v[162:163], v[92:93] op_sel_hi:[1,0]
    v_pk_mul_f32 v[160:161], v[160:161], v[92:93] op_sel_hi:[1,0]
    v_pk_mul_f32 v[138:139], v[138:139], v[48:49] op_sel_hi:[1,0]
    v_pk_mul_f32 v[228:229], v[228:229], v[50:51] op_sel_hi:[1,0]
    v_pk_mul_f32 v[216:217], v[216:217], v[50:51] op_sel_hi:[1,0]
    v_cvt_pk_bf16_f32 v24, v64, v65
    v_pk_mul_f32 v[118:119], v[118:119], v[48:49] op_sel_hi:[1,0]
    v_pk_mul_f32 v[124:125], v[124:125], v[48:49] op_sel_hi:[1,0]
    v_pk_mul_f32 v[180:181], v[180:181], v[92:93] op_sel_hi:[1,0]
    v_pk_mul_f32 v[132:133], v[132:133], v[48:49] op_sel_hi:[1,0]
    v_cvt_pk_bf16_f32 v160, v160, v161
    v_cvt_pk_bf16_f32 v28, v72, v73
    v_mfma_f32_16x16x32_bf16 v[56:59], a[224:227], a[104:107], v[56:59]
    s_add_u32 m0, s22, 38912
    v_fma_f32 v60, v60, s28, v10
    v_accvgpr_read_b32 v108, a4
    v_mfma_f32_16x16x32_bf16 v[64:67], a[224:227], a[128:131], 0
    buffer_load_dwordx4 v6, s[8:11], s21 offen lds
    v_mfma_f32_16x16x32_bf16 v[64:67], a[220:223], a[124:127], v[64:67]
    v_cvt_pk_bf16_f32 v29, v74, v75
    v_cvt_pk_bf16_f32 v180, v180, v181
    v_mfma_f32_16x16x32_bf16 v[64:67], a[216:219], a[120:123], v[64:67]
    v_fma_f32 v61, v61, s28, v10
    v_cvt_pk_bf16_f32 v41, v90, v91
    v_mfma_f32_16x16x32_bf16 v[72:75], a[216:219], a[144:147], 0
    s_add_u32 s21, s21, 12032
    v_fma_f32 v53, v53, s28, v9
    v_exp_f32_e64 v53, v53 clamp
    v_mfma_f32_16x16x32_bf16 v[72:75], a[220:223], a[148:151], v[72:75]
    v_cvt_pk_bf16_f32 v228, v228, v229
    v_fma_f32 v84, v84, s28, v13
    v_mfma_f32_16x16x32_bf16 v[72:75], a[224:227], a[152:155], v[72:75]
    s_waitcnt vmcnt(6) lgkmcnt(0)
    v_cvt_pk_bf16_f32 v40, v88, v89
    v_fma_f32 v54, v54, s28, v9
    v_mfma_f32_16x16x32_bf16 v[80:83], a[224:227], a[176:179], 0
    v_cvt_pk_bf16_f32 v116, v116, v117
    v_cvt_pk_bf16_f32 v200, v200, v201
    v_mfma_f32_16x16x32_bf16 v[80:83], a[220:223], a[172:175], v[80:83]
    s_add_u32 m0, s22, 12288
    v_fma_f32 v69, v69, s28, v11
    v_accvgpr_read_b32 v110, a6
    v_mfma_f32_16x16x32_bf16 v[44:47], a[248:251], v[14:17], 0
    s_barrier
    v_mfma_f32_16x16x32_bf16 v[80:83], a[216:219], a[168:171], v[80:83]
    v_exp_f32_e64 v63, v63 clamp
    v_mfma_f32_16x16x32_bf16 v[88:91], a[216:219], a[192:195], 0
    v_fma_f32 v78, v78, s28, v12
    v_exp_f32_e64 v84, v84 clamp
    v_mfma_f32_16x16x32_bf16 v[88:91], a[220:223], a[196:199], v[88:91]
    v_fma_f32 v62, v62, s28, v10
    v_fma_f32 v87, v87, s28, v13
    v_mfma_f32_16x16x32_bf16 v[88:91], a[224:227], a[200:203], v[88:91]
    buffer_load_dwordx4 v6, s[4:7], s20 offen lds
    v_mfma_f32_16x16x32_bf16 v[88:91], a[228:231], a[204:207], v[88:91]
    v_exp_f32_e64 v61, v61 clamp
    v_mfma_f32_16x16x32_bf16 v[88:91], a[232:235], a[208:211], v[88:91]
    v_fma_f32 v77, v77, s28, v12
    v_cvt_pk_bf16_f32 v104, v104, v105
    v_mfma_f32_16x16x32_bf16 v[88:91], a[236:239], a[212:215], v[88:91]
    ds_read_b64_tr_b16 a[216:217], v2 offset:0
    v_cvt_pk_bf16_f32 v216, v216, v217
    v_mfma_f32_16x16x32_bf16 v[80:83], a[236:239], a[188:191], v[80:83]
    s_add_u32 s20, s20, 128
    ds_read_b64_tr_b16 a[218:219], v2 offset:6144
    v_cvt_pk_bf16_f32 v105, v106, v107
    v_exp_f32_e64 v60, v60 clamp
    v_cvt_pk_bf16_f32 v117, v118, v119
    v_pk_mul_f32 v[108:109], v[108:109], v[94:95] op_sel_hi:[1,0]
    v_cvt_pk_bf16_f32 v112, v112, v113
    v_pk_mul_f32 v[130:131], v[130:131], v[48:49] op_sel_hi:[1,0]
    v_pk_mul_f32 v[210:211], v[210:211], v[50:51] op_sel_hi:[1,0]
    v_pk_mul_f32 v[252:253], v[252:253], v[50:51] op_sel_hi:[1,0]
    v_pk_mul_f32 v[182:183], v[182:183], v[92:93] op_sel_hi:[1,0]
    v_fma_f32 v88, v88, s28, v13
    v_pk_mul_f32 v[150:151], v[150:151], v[48:49] op_sel_hi:[1,0]
    v_exp_f32_e64 v88, v88 clamp
    v_pk_mul_f32 v[126:127], v[126:127], v[48:49] op_sel_hi:[1,0]
    v_fma_f32 v52, v52, s28, v9
    v_pk_mul_f32 v[110:111], v[110:111], v[94:95] op_sel_hi:[1,0]
    v_pk_mul_f32 v[176:177], v[176:177], v[92:93] op_sel_hi:[1,0]
    v_pk_mul_f32 v[240:241], v[240:241], v[50:51] op_sel_hi:[1,0]
    v_pk_mul_f32 v[196:197], v[196:197], v[92:93] op_sel_hi:[1,0]
    v_pk_mul_f32 v[128:129], v[128:129], v[48:49] op_sel_hi:[1,0]
    v_cvt_pk_bf16_f32 v113, v114, v115
    v_cvt_pk_bf16_f32 v161, v162, v163
    v_pk_mul_f32 v[140:141], v[140:141], v[48:49] op_sel_hi:[1,0]
    v_pk_mul_f32 v[168:169], v[168:169], v[92:93] op_sel_hi:[1,0]
    v_pk_mul_f32 v[218:219], v[218:219], v[50:51] op_sel_hi:[1,0]
    v_pk_mul_f32 v[236:237], v[236:237], v[50:51] op_sel_hi:[1,0]
    v_pk_mul_f32 v[190:191], v[190:191], v[92:93] op_sel_hi:[1,0]
    v_accvgpr_read_b32 v106, a10
    v_pk_mul_f32 v[166:167], v[166:167], v[92:93] op_sel_hi:[1,0]
    v_pk_mul_f32 v[222:223], v[222:223], v[50:51] op_sel_hi:[1,0]
    v_cvt_pk_bf16_f32 v209, v210, v211
    v_pk_mul_f32 v[212:213], v[212:213], v[50:51] op_sel_hi:[1,0]
    v_pk_mul_f32 v[226:227], v[226:227], v[50:51] op_sel_hi:[1,0]
    v_pk_mul_f32 v[184:185], v[184:185], v[92:93] op_sel_hi:[1,0]
    v_cvt_pk_bf16_f32 v108, v108, v109
    v_pk_mul_f32 v[220:221], v[220:221], v[50:51] op_sel_hi:[1,0]
    v_pk_mul_f32 v[174:175], v[174:175], v[92:93] op_sel_hi:[1,0]
    v_cvt_pk_bf16_f32 v128, v128, v129
    v_fma_f32 v79, v79, s28, v12
    v_pk_mul_f32 v[230:231], v[230:231], v[50:51] op_sel_hi:[1,0]
    v_pk_mul_f32 v[178:179], v[178:179], v[92:93] op_sel_hi:[1,0]
    v_pk_mul_f32 v[224:225], v[224:225], v[50:51] op_sel_hi:[1,0]
    v_cvt_pk_bf16_f32 v168, v168, v169
    v_pk_mul_f32 v[152:153], v[152:153], v[48:49] op_sel_hi:[1,0]
    v_pk_mul_f32 v[170:171], v[170:171], v[92:93] op_sel_hi:[1,0]
    v_cvt_pk_bf16_f32 v124, v124, v125
    v_cvt_pk_bf16_f32 v212, v212, v213
    v_cvt_pk_bf16_f32 v165, v166, v167
    v_mfma_f32_16x16x32_bf16 v[80:83], a[232:235], a[184:187], v[80:83]
    ds_write2st64_b64 v93, v[112:113], v[160:161] offset0:0 offset1:12
    v_cvt_pk_bf16_f32 v109, v110, v111
    v_cvt_pk_bf16_f32 v176, v176, v177
    v_mfma_f32_16x16x32_bf16 v[80:83], a[228:231], a[180:183], v[80:83]
    ds_read_b64_tr_b16 a[220:221], v3 offset:0
    v_exp_f32_e64 v69, v69 clamp
    v_mfma_f32_16x16x32_bf16 v[72:75], a[228:231], a[156:159], v[72:75]
    s_add_u32 m0, s22, 13312
    ds_write2st64_b64 v93, v[208:209], v[104:105] offset0:24 offset1:36
    v_pk_mul_f32 v[238:239], v[238:239], v[50:51] op_sel_hi:[1,0]
    v_exp_f32_e64 v70, v70 clamp
    v_pk_mul_f32 v[134:135], v[134:135], v[48:49] op_sel_hi:[1,0]
    v_pk_mul_f32 v[136:137], v[136:137], v[48:49] op_sel_hi:[1,0]
    v_accvgpr_read_b32 v107, a11
    v_pk_mul_f32 v[250:251], v[250:251], v[50:51] op_sel_hi:[1,0]
    v_cvt_pk_bf16_f32 v224, v224, v225
    v_pk_mul_f32 v[122:123], v[122:123], v[48:49] op_sel_hi:[1,0]
    v_pk_mul_f32 v[148:149], v[148:149], v[48:49] op_sel_hi:[1,0]
    v_pk_mul_f32 v[172:173], v[172:173], v[92:93] op_sel_hi:[1,0]
    v_subrev_u32 v103, 24576, v103
    v_pk_mul_f32 v[214:215], v[214:215], v[50:51] op_sel_hi:[1,0]
    v_fma_f32 v80, v80, s28, v12
    v_cvt_pk_bf16_f32 v136, v136, v137
    v_cvt_pk_bf16_f32 v220, v220, v221
    v_pk_mul_f32 v[244:245], v[244:245], v[50:51] op_sel_hi:[1,0]
    v_pk_mul_f32 v[142:143], v[142:143], v[48:49] op_sel_hi:[1,0]
    v_pk_mul_f32 v[186:187], v[186:187], v[92:93] op_sel_hi:[1,0]
    v_cvt_pk_bf16_f32 v140, v140, v141
    v_cvt_pk_bf16_f32 v125, v126, v127
    v_cvt_pk_bf16_f32 v120, v120, v121
    v_mfma_f32_16x16x32_bf16 v[72:75], a[232:235], a[160:163], v[72:75]
    v_cvt_pk_bf16_f32 v169, v170, v171
    v_xor_b32 v93, 32, v93
    v_cvt_pk_bf16_f32 v177, v178, v179
    v_mfma_f32_16x16x32_bf16 v[72:75], a[236:239], a[164:167], v[72:75]
    v_cvt_pk_bf16_f32 v121, v122, v123
    v_cvt_pk_bf16_f32 v229, v230, v231
    v_smfmac_f32_16x16x64_bf16 v[44:47], a[240:243], v[22:29], v101
    buffer_load_dwordx4 v6, s[4:7], s20 offen lds
    v_accvgpr_read_b32 v105, a9
    v_mfma_f32_16x16x32_bf16 v[64:67], a[236:239], a[140:143], v[64:67]
    ds_read_b64_tr_b16 a[222:223], v3 offset:6144
    v_cvt_pk_bf16_f32 v129, v130, v131
    v_mfma_f32_16x16x32_bf16 v[64:67], a[232:235], a[136:139], v[64:67]
    ds_write2st64_b64 v93, v[116:117], v[164:165] offset0:0 offset1:12
    v_pk_mul_f32 v[188:189], v[188:189], v[92:93] op_sel_hi:[1,0]
    v_accvgpr_read_b32 v104, a8
    v_cvt_pk_bf16_f32 v132, v132, v133
    v_pk_mul_f32 v[104:105], v[104:105], v[94:95] op_sel_hi:[1,0]
    v_accvgpr_read_b32 v110, a14
    v_pk_mul_f32 v[144:145], v[144:145], v[48:49] op_sel_hi:[1,0]
    v_pk_mul_f32 v[106:107], v[106:107], v[94:95] op_sel_hi:[1,0]
    v_cvt_pk_bf16_f32 v133, v134, v135
    v_fma_f32 v55, v55, s28, v9
    v_pk_mul_f32 v[158:159], v[158:159], v[48:49] op_sel_hi:[1,0]
    v_cvt_pk_bf16_f32 v152, v152, v153
    v_cvt_pk_bf16_f32 v244, v244, v245
    v_cvt_pk_bf16_f32 v172, v172, v173
    v_mfma_f32_16x16x32_bf16 v[64:67], a[228:231], a[132:135], v[64:67]
    v_fma_f32 v89, v89, s28, v13
    v_cvt_pk_bf16_f32 v240, v240, v241
    v_cvt_pk_bf16_f32 v213, v214, v215
    v_mfma_f32_16x16x32_bf16 v[56:59], a[228:231], a[108:111], v[56:59]
    s_add_u32 s20, s20, 128
    v_exp_f32_e64 v68, v68 clamp
    v_mfma_f32_16x16x32_bf16 v[56:59], a[232:235], a[112:115], v[56:59]
    ds_write2st64_b64 v93, v[212:213], v[108:109] offset0:24 offset1:36
    v_mfma_f32_16x16x32_bf16 v[56:59], a[236:239], a[116:119], v[56:59]
    s_waitcnt lgkmcnt(2)
    ds_read_b64_tr_b16 a[224:225], v4 offset:0
    v_cvt_pk_bf16_f32 v173, v174, v175
    v_xor_b32 v93, 96, v93
    v_mfma_f32_16x16x32_bf16 v[112:115], a[216:219], v[14:17], 0
    ds_read_b64_tr_b16 a[226:227], v4 offset:6144
    v_accvgpr_read_b32 v108, a12
    v_mfma_f32_16x16x32_bf16 v[116:119], a[220:223], v[14:17], 0
    ds_read_b64_tr_b16 a[228:229], v5 offset:0
    v_cvt_pk_bf16_f32 v104, v104, v105
    v_exp_f32_e64 v77, v77 clamp
    v_cvt_pk_bf16_f32 v105, v106, v107
    v_mfma_f32_16x16x32_bf16 v[164:167], a[220:223], v[22:25], 0
    v_cvt_pk_bf16_f32 v217, v218, v219
    v_fma_f32 v81, v81, s28, v12
    v_cvt_pk_bf16_f32 v144, v144, v145
    v_cvt_pk_bf16_f32 v236, v236, v237
    v_fma_f32 v90, v90, s28, v13
    v_mfma_f32_16x16x32_bf16 v[160:163], a[216:219], v[22:25], 0
    ds_write2st64_b64 v93, v[120:121], v[168:169] offset0:0 offset1:12
    v_mfma_f32_16x16x32_bf16 v[208:211], a[216:219], v[26:29], 0
    ds_write2st64_b64 v93, v[216:217], v[104:105] offset0:24 offset1:36
    v_cvt_pk_bf16_f32 v141, v142, v143
    v_mfma_f32_16x16x32_bf16 v[212:215], a[220:223], v[26:29], 0
    v_accvgpr_read_b32 v111, a15
    v_fma_f32 v83, v83, s28, v12
    v_mfma_f32_16x16x32_bf16 a[4:7], a[220:223], v[34:37], 0
    ds_read_b64_tr_b16 a[230:231], v5 offset:6144
    v_exp_f32_e64 v89, v89 clamp
    v_cvt_pk_bf16_f32 v221, v222, v223
    v_accvgpr_read_b32 v109, a13
    v_pk_mul_f32 v[156:157], v[156:157], v[48:49] op_sel_hi:[1,0]
    v_accvgpr_read_b32 v105, a17
    v_xor_b32 v93, 32, v93
    v_accvgpr_read_b32 v104, a16
    v_exp_f32_e64 v54, v54 clamp
    v_pk_mul_f32 v[108:109], v[108:109], v[94:95] op_sel_hi:[1,0]
    v_pk_mul_f32 v[204:205], v[204:205], v[92:93] op_sel_hi:[1,0]
    v_pk_mul_f32 v[234:235], v[234:235], v[50:51] op_sel_hi:[1,0]
    v_accvgpr_read_b32 v107, a19
    v_cvt_pk_bf16_f32 v204, v204, v205
    v_cvt_pk_bf16_f32 v192, v192, v193
    v_fma_f32 v73, v73, s28, v11
    v_mfma_f32_16x16x32_bf16 a[0:3], a[216:219], v[34:37], 0
    ds_read_b64_tr_b16 a[238:239], v3 offset:7168
    v_fma_f32 v59, v59, s28, v9
    v_exp_f32_e64 v52, v52 clamp
    v_cvt_pk_bf16_f32 v148, v148, v149
    v_pk_mul_f32 v[246:247], v[246:247], v[50:51] op_sel_hi:[1,0]
    v_fma_f32 v76, v76, s28, v12
    v_pk_mul_f32 v[242:243], v[242:243], v[50:51] op_sel_hi:[1,0]
    v_pk_mul_f32 v[110:111], v[110:111], v[94:95] op_sel_hi:[1,0]
    v_cvt_pk_bf16_f32 v108, v108, v109
    v_pk_mul_f32 v[146:147], v[146:147], v[48:49] op_sel_hi:[1,0]
    v_cvt_pk_bf16_f32 v232, v232, v233
    v_cvt_pk_bf16_f32 v109, v110, v111
    v_mfma_f32_16x16x32_bf16 a[48:51], a[216:219], v[38:41], 0
    ds_read_b64_tr_b16 a[234:235], v2 offset:7168
    v_cvt_pk_bf16_f32 v145, v146, v147
    v_mfma_f32_16x16x32_bf16 a[52:55], a[220:223], v[38:41], 0
    s_waitcnt lgkmcnt(2)
    ds_read_b64_tr_b16 a[232:233], v2 offset:1024
    v_fma_f32 v82, v82, s28, v12
    v_mfma_f32_16x16x32_bf16 a[56:59], a[224:227], v[38:41], 0
    ds_write2st64_b64 v93, v[124:125], v[172:173] offset0:0 offset1:12
    v_accvgpr_read_b32 v106, a18
    v_cvt_pk_bf16_f32 v184, v184, v185
    v_cvt_pk_bf16_f32 v196, v196, v197
    v_exp_f32_e64 v81, v81 clamp
    v_mfma_f32_16x16x32_bf16 a[60:63], a[228:231], v[38:41], 0
    ds_write2st64_b64 v93, v[220:221], v[108:109] offset0:24 offset1:36
    v_xor_b32 v93, 96, v93
    v_pk_mul_f32 v[104:105], v[104:105], v[94:95] op_sel_hi:[1,0]
    v_cvt_pk_bf16_f32 v185, v186, v187
    v_cvt_pk_bf16_f32 v188, v188, v189
    v_cvt_pk_bf16_f32 v181, v182, v183
    v_mfma_f32_16x16x32_bf16 a[12:15], a[228:231], v[34:37], 0
    ds_read_b64_tr_b16 a[236:237], v3 offset:1024
    v_accvgpr_read_b32 v110, a22
    v_mfma_f32_16x16x32_bf16 a[8:11], a[224:227], v[34:37], 0
    ds_read_b64_tr_b16 a[216:217], v4 offset:1024
    v_accvgpr_read_b32 v109, a21
    v_accvgpr_read_b32 v108, a20
    v_fma_f32 v64, v64, s28, v10
    v_fma_f32 v86, v86, s28, v13
    v_mfma_f32_16x16x32_bf16 v[216:219], a[224:227], v[26:29], 0
    s_add_u32 m0, s22, 14336
    ds_write2st64_b64 v93, v[128:129], v[176:177] offset0:4 offset1:16
    v_pk_mul_f32 v[202:203], v[202:203], v[92:93] op_sel_hi:[1,0]
    v_pk_mul_f32 v[108:109], v[108:109], v[94:95] op_sel_hi:[1,0]
    v_cvt_pk_bf16_f32 v137, v138, v139
    v_cvt_pk_bf16_f32 v104, v104, v105
    v_pk_mul_f32 v[206:207], v[206:207], v[92:93] op_sel_hi:[1,0]
    v_cvt_pk_bf16_f32 v225, v226, v227
    v_pk_mul_f32 v[106:107], v[106:107], v[94:95] op_sel_hi:[1,0]
    v_exp_f32_e64 v80, v80 clamp
    v_cvt_pk_bf16_f32 v105, v106, v107
    v_smfmac_f32_16x16x64_bf16 v[44:47], a[244:247], v[34:41], v101
    buffer_load_dwordx4 v6, s[4:7], s20 offen lds
    ds_read_b64_tr_b16 a[222:223], v5 offset:7168
    v_mfma_f32_16x16x32_bf16 v[220:223], a[228:231], v[26:29], 0
    ds_read_b128 v[96:99], v103 offset:0
    v_accvgpr_read_b32 v106, a26
    v_cvt_pk_bf16_f32 v108, v108, v109
    v_exp_f32_e64 v79, v79 clamp
    v_cvt_pk_bf16_f32 v197, v198, v199
    v_accvgpr_read_b32 v107, a27
    v_mfma_f32_16x16x32_bf16 v[172:175], a[228:231], v[22:25], 0
    v_accvgpr_read_b32 v111, a23
    v_fma_f32 v71, v71, s28, v11
    v_mfma_f32_16x16x32_bf16 v[168:171], a[224:227], v[22:25], 0
    s_add_u32 s20, s20, 12032
    ds_write2st64_b64 v93, v[224:225], v[104:105] offset0:28 offset1:40
    v_accvgpr_read_b32 v105, a25
    v_cvt_pk_bf16_f32 v241, v242, v243
    v_pk_mul_f32 v[110:111], v[110:111], v[94:95] op_sel_hi:[1,0]
    v_pk_mul_f32 v[254:255], v[254:255], v[50:51] op_sel_hi:[1,0]
    v_pk_mul_f32 v[194:195], v[194:195], v[92:93] op_sel_hi:[1,0]
    v_cvt_pk_bf16_f32 v109, v110, v111
    v_pk_mul_f32 v[154:155], v[154:155], v[48:49] op_sel_hi:[1,0]
    v_cvt_pk_bf16_f32 v193, v194, v195
    v_pk_mul_f32 v[106:107], v[106:107], v[94:95] op_sel_hi:[1,0]
    v_cvt_pk_bf16_f32 v237, v238, v239
    v_xor_b32 v93, 32, v93
    v_mfma_f32_16x16x32_bf16 v[120:123], a[224:227], v[14:17], 0
    ds_write2st64_b64 v93, v[132:133], v[180:181] offset0:4 offset1:16
    v_mfma_f32_16x16x32_bf16 v[124:127], a[228:231], v[14:17], 0
    s_waitcnt lgkmcnt(3)
    ds_read_b64_tr_b16 a[230:231], v3 offset:8192
    v_accvgpr_read_b32 v104, a24
    v_mfma_f32_16x16x32_bf16 v[128:131], a[232:235], v[14:17], 0
    ds_read_b64_tr_b16 a[220:221], v5 offset:1024
    v_cvt_pk_bf16_f32 v233, v234, v235
    v_mfma_f32_16x16x32_bf16 v[132:135], a[236:239], v[14:17], 0
    v_exp_f32_e64 v55, v55 clamp
    v_mfma_f32_16x16x32_bf16 v[180:183], a[236:239], v[22:25], 0
    ds_write2st64_b64 v93, v[228:229], v[108:109] offset0:28 offset1:40
    v_exp_f32_e64 v87, v87 clamp
    v_accvgpr_read_b32 v109, a29
    v_mfma_f32_16x16x32_bf16 v[176:179], a[232:235], v[22:25], 0
    ds_read_b64_tr_b16 a[218:219], v4 offset:7168
    v_cvt_pk_bf16_f32 v189, v190, v191
    v_exp_f32_e64 v64, v64 clamp
    v_accvgpr_read_b32 v108, a28
    v_pk_mul_f32 v[104:105], v[104:105], v[94:95] op_sel_hi:[1,0]
    v_xor_b32 v93, 96, v93
    v_pk_mul_f32 v[248:249], v[248:249], v[50:51] op_sel_hi:[1,0]
    v_accvgpr_read_b32 v110, a30
    v_cvt_pk_bf16_f32 v205, v206, v207
    v_cvt_pk_bf16_f32 v104, v104, v105
    v_cvt_pk_bf16_f32 v149, v150, v151
    v_mfma_f32_16x16x32_bf16 v[224:227], a[232:235], v[26:29], 0
    v_exp_f32_e64 v71, v71 clamp
    v_mfma_f32_16x16x32_bf16 v[228:231], a[236:239], v[26:29], 0
    ds_write2st64_b64 v93, v[136:137], v[184:185] offset0:4 offset1:16
    v_pk_mul_f32 v[108:109], v[108:109], v[94:95] op_sel_hi:[1,0]
    v_cvt_pk_bf16_f32 v105, v106, v107
    v_accvgpr_read_b32 v107, a35
    v_fma_f32 v65, v65, s28, v10
    v_cvt_pk_bf16_f32 v32, v80, v81
    v_cvt_pk_bf16_f32 v108, v108, v109
    v_mfma_f32_16x16x32_bf16 a[20:23], a[236:239], v[34:37], 0
    s_add_u32 m0, s38, 0
    ds_write2st64_b64 v93, v[232:233], v[104:105] offset0:28 offset1:40
    v_accvgpr_read_b32 v106, a34
    v_cvt_pk_bf16_f32 v252, v252, v253
    v_accvgpr_read_b32 v111, a31
    v_mfma_f32_16x16x32_bf16 a[16:19], a[232:235], v[34:37], 0
    ds_read_b64_tr_b16 a[226:227], v2 offset:8192
    v_cvt_pk_bf16_f32 v248, v248, v249
    v_accvgpr_read_b32 v104, a32
    v_mfma_f32_16x16x32_bf16 a[64:67], a[232:235], v[38:41], 0
    s_waitcnt lgkmcnt(3)
    ds_read_b64_tr_b16 a[228:229], v3 offset:2048
    buffer_load_dwordx4 v6, s[12:15], s33 offen nt lds
    v_xor_b32 v93, 32, v93
    v_accvgpr_read_b32 v105, a33
    v_pk_mul_f32 v[106:107], v[106:107], v[94:95] op_sel_hi:[1,0]
    v_pk_mul_f32 v[104:105], v[104:105], v[94:95] op_sel_hi:[1,0]
    v_pk_mul_f32 v[110:111], v[110:111], v[94:95] op_sel_hi:[1,0]
    v_cvt_pk_bf16_f32 v245, v246, v247
    v_cvt_pk_bf16_f32 v109, v110, v111
    v_mfma_f32_16x16x32_bf16 a[68:71], a[236:239], v[38:41], 0
    buffer_store_dwordx4 v[96:99], v6, s[16:19], s67 offen offset:0 nt
    ds_write2st64_b64 v93, v[140:141], v[188:189] offset0:4 offset1:16
    v_mfma_f32_16x16x32_bf16 a[72:75], a[216:219], v[38:41], 0
    ds_read_b64_tr_b16 a[224:225], v2 offset:2048
    v_cvt_pk_bf16_f32 v153, v154, v155
    v_mfma_f32_16x16x32_bf16 a[76:79], a[220:223], v[38:41], 0
    ds_read_b128 v[96:99], v103 offset:1024
    v_accvgpr_read_b32 v111, a39
    v_cvt_pk_bf16_f32 v104, v104, v105
    v_mfma_f32_16x16x32_bf16 a[28:31], a[220:223], v[34:37], 0
    ds_write2st64_b64 v93, v[236:237], v[108:109] offset0:28 offset1:40
    v_mfma_f32_16x16x32_bf16 a[24:27], a[216:219], v[34:37], 0
    v_cvt_pk_bf16_f32 v156, v156, v157
    v_accvgpr_read_b32 v109, a37
    v_xor_b32 v93, 96, v93
    v_mfma_f32_16x16x32_bf16 v[232:235], a[216:219], v[26:29], 0
    s_add_u32 m0, s38, 1024
    ds_read_b64_tr_b16 a[236:237], v5 offset:2048
    v_cvt_pk_bf16_f32 v105, v106, v107
    v_cvt_pk_bf16_f32 v201, v202, v203
    v_accvgpr_read_b32 v108, a36
    v_mfma_f32_16x16x32_bf16 v[236:239], a[220:223], v[26:29], 0
    ds_read_b64_tr_b16 a[232:233], v4 offset:2048
    v_accvgpr_read_b32 v110, a38
    v_mfma_f32_16x16x32_bf16 v[188:191], a[220:223], v[22:25], 0
    ds_read_b64_tr_b16 a[234:235], v4 offset:8192
    v_cvt_pk_bf16_f32 v30, v68, v69
    v_mfma_f32_16x16x32_bf16 v[184:187], a[216:219], v[22:25], 0
    ds_write2st64_b64 v93, v[144:145], v[192:193] offset0:8 offset1:20
    v_mfma_f32_16x16x32_bf16 v[136:139], a[216:219], v[14:17], 0
    ds_write2st64_b64 v93, v[240:241], v[104:105] offset0:32 offset1:44
    v_pk_mul_f32 v[110:111], v[110:111], v[94:95] op_sel_hi:[1,0]
    v_pk_mul_f32 v[108:109], v[108:109], v[94:95] op_sel_hi:[1,0]
    v_xor_b32 v93, 32, v93
    v_fma_f32 v75, v75, s28, v11
    v_cvt_pk_bf16_f32 v108, v108, v109
    v_mfma_f32_16x16x32_bf16 v[140:143], a[220:223], v[14:17], 0
    s_waitcnt lgkmcnt(5)
    ds_read_b64_tr_b16 a[238:239], v5 offset:8192
    buffer_load_dwordx4 v7, s[12:15], s33 offen nt lds
    v_mfma_f32_16x16x32_bf16 v[144:147], a[224:227], v[14:17], 0
    s_add_u32 s39, s39, 12288
    ds_write2st64_b64 v93, v[148:149], v[196:197] offset0:8 offset1:20
    v_accvgpr_read_b32 v106, a42
    v_cvt_pk_bf16_f32 v109, v110, v111
    v_mfma_f32_16x16x32_bf16 v[148:151], a[228:231], v[14:17], 0
    ds_write2st64_b64 v93, v[244:245], v[108:109] offset0:32 offset1:44
    v_fma_f32 v72, v72, s28, v11
    v_mfma_f32_16x16x32_bf16 v[196:199], a[228:231], v[22:25], 0
    v_accvgpr_read_b32 v107, a43
    v_exp_f32_e64 v78, v78 clamp
    v_mfma_f32_16x16x32_bf16 v[192:195], a[224:227], v[22:25], 0
    v_accvgpr_read_b32 v104, a40
    v_accvgpr_read_b32 v105, a41
    v_cvt_pk_bf16_f32 v249, v250, v251
    v_accvgpr_read_b32 v109, a45
    v_accvgpr_read_b32 v111, a47
    v_accvgpr_read_b32 v110, a46
    v_mfma_f32_16x16x32_bf16 v[240:243], a[224:227], v[26:29], 0
    v_cvt_pk_bf16_f32 v253, v254, v255
    v_cvt_pk_bf16_f32 v157, v158, v159
    v_mfma_f32_16x16x32_bf16 v[244:247], a[228:231], v[26:29], 0
    s_waitcnt vmcnt(9) lgkmcnt(2)
    v_fma_f32 v85, v85, s28, v13
    v_accvgpr_read_b32 v108, a44
    v_mfma_f32_16x16x32_bf16 a[36:39], a[228:231], v[34:37], 0
    buffer_store_dwordx4 v[96:99], v7, s[16:19], s67 offen offset:0 nt
    s_barrier
    v_pk_mul_f32 v[104:105], v[104:105], v[94:95] op_sel_hi:[1,0]
    v_cvt_pk_bf16_f32 v18, v52, v53
    v_pk_mul_f32 v[110:111], v[110:111], v[94:95] op_sel_hi:[1,0]
    v_pk_mul_f32 v[108:109], v[108:109], v[94:95] op_sel_hi:[1,0]
    v_fma_f32 v91, v91, s28, v13
    v_cvt_pk_bf16_f32 v104, v104, v105
    v_pk_mul_f32 v[106:107], v[106:107], v[94:95] op_sel_hi:[1,0]
    v_xor_b32 v93, 96, v93
    v_cvt_pk_bf16_f32 v105, v106, v107
    v_mfma_f32_16x16x32_bf16 a[32:35], a[224:227], v[34:37], 0
    ds_write2st64_b64 v93, v[152:153], v[200:201] offset0:8 offset1:20
    v_mfma_f32_16x16x32_bf16 a[80:83], a[224:227], v[38:41], 0
    ds_read_b128 a[224:227], v0 offset:1024
    v_cvt_pk_bf16_f32 v19, v54, v55
    v_mfma_f32_16x16x32_bf16 a[84:87], a[228:231], v[38:41], 0
    v_cvt_pk_bf16_f32 v108, v108, v109
    v_exp_f32_e64 v85, v85 clamp
    v_mfma_f32_16x16x32_bf16 a[88:91], a[232:235], v[38:41], 0
    ds_write2st64_b64 v93, v[248:249], v[104:105] offset0:32 offset1:44
    v_mfma_f32_16x16x32_bf16 a[92:95], a[236:239], v[38:41], 0
    ds_read_b128 a[216:219], v0 offset:0
    v_cvt_pk_bf16_f32 v109, v110, v111
    v_mfma_f32_16x16x32_bf16 a[44:47], a[236:239], v[34:37], 0
    ds_read_b128 a[220:223], v1 offset:0
    v_xor_b32 v93, 32, v93
    v_mfma_f32_16x16x32_bf16 a[40:43], a[232:235], v[34:37], 0
    ds_write2st64_b64 v93, v[156:157], v[204:205] offset0:8 offset1:20
    v_mfma_f32_16x16x32_bf16 v[248:251], a[232:235], v[26:29], 0
    s_add_u32 m0, s22, 24576
    ds_write2st64_b64 v93, v[252:253], v[108:109] offset0:32 offset1:44
    v_mfma_f32_16x16x32_bf16 v[252:255], a[236:239], v[26:29], 0
    v_exp_f32_e64 v76, v76 clamp
    v_exp_f32_e64 v62, v62 clamp
    v_mfma_f32_16x16x32_bf16 v[204:207], a[236:239], v[22:25], 0
    buffer_load_dwordx4 v6, s[8:11], s21 offen lds
    v_fma_f32 v74, v74, s28, v11
    v_cvt_pk_bf16_f32 v31, v70, v71
    v_mfma_f32_16x16x32_bf16 v[200:203], a[232:235], v[22:25], 0
    s_add_u32 s21, s21, 128
    v_exp_f32_e64 v72, v72 clamp
    v_mfma_f32_16x16x32_bf16 v[152:155], a[232:235], v[14:17], 0
    s_add_u32 m0, s22, 25600
    ds_read_b128 a[228:231], v1 offset:1024
    v_fma_f32 v57, v57, s28, v9
    v_mfma_f32_16x16x32_bf16 v[156:159], a[236:239], v[14:17], 0
    s_waitcnt lgkmcnt(4)
    ds_read_b128 a[232:235], v0 offset:2048
    v_fma_f32 v67, v67, s28, v10
    v_mfma_f32_16x16x32_bf16 v[52:55], a[216:219], a[96:99], 0
    s_waitcnt lgkmcnt(4)
    v_cvt_pk_bf16_f32 v23, v62, v63
    v_cvt_pk_bf16_f32 v22, v60, v61
    v_mfma_f32_16x16x32_bf16 v[52:55], a[220:223], a[100:103], v[52:55]
    ds_read_b128 a[236:239], v1 offset:2048
    v_cvt_pk_bf16_f32 v34, v76, v77
    v_mfma_f32_16x16x32_bf16 v[52:55], a[224:227], a[104:107], v[52:55]
    ds_read_b128 v[96:99], v103 offset:2048
    v_cvt_pk_bf16_f32 v35, v78, v79
    v_mfma_f32_16x16x32_bf16 v[60:63], a[224:227], a[128:131], 0
    v_exp_f32_e64 v67, v67 clamp
    v_mfma_f32_16x16x32_bf16 v[60:63], a[220:223], a[124:127], v[60:63]
    buffer_load_dwordx4 v6, s[8:11], s21 offen lds
    v_mfma_f32_16x16x32_bf16 v[60:63], a[216:219], a[120:123], v[60:63]
    v_exp_f32_e64 v86, v86 clamp
    v_mfma_f32_16x16x32_bf16 v[68:71], a[216:219], a[144:147], 0
    v_exp_f32_e64 v75, v75 clamp
    v_mfma_f32_16x16x32_bf16 v[68:71], a[220:223], a[148:151], v[68:71]
    s_add_u32 s21, s21, 128
    v_fma_f32 v66, v66, s28, v10
    v_cvt_pk_bf16_f32 v43, v86, v87
    v_mfma_f32_16x16x32_bf16 v[68:71], a[224:227], a[152:155], v[68:71]
    s_add_u32 m0, s22, 26624
    v_exp_f32_e64 v66, v66 clamp
    v_mfma_f32_16x16x32_bf16 v[76:79], a[224:227], a[176:179], 0
    v_exp_f32_e64 v82, v82 clamp
    v_mfma_f32_16x16x32_bf16 v[76:79], a[220:223], a[172:175], v[76:79]
    buffer_load_dwordx4 v6, s[8:11], s21 offen lds
    v_mfma_f32_16x16x32_bf16 v[76:79], a[216:219], a[168:171], v[76:79]
    v_cvt_pk_bf16_f32 v42, v84, v85
    v_fma_f32 v58, v58, s28, v9
    v_mfma_f32_16x16x32_bf16 v[84:87], a[216:219], a[192:195], 0
    s_add_u32 s21, s21, 12032
    ds_read_b128 a[216:219], v0 offset:6144
    v_cvt_pk_bf16_f32 v40, v88, v89
    v_mfma_f32_16x16x32_bf16 v[84:87], a[220:223], a[196:199], v[84:87]
    v_exp_f32_e64 v91, v91 clamp
    v_mfma_f32_16x16x32_bf16 v[84:87], a[224:227], a[200:203], v[84:87]
    s_waitcnt lgkmcnt(1)
    v_exp_f32_e64 v90, v90 clamp
    v_mfma_f32_16x16x32_bf16 v[84:87], a[228:231], a[204:207], v[84:87]
    s_add_u32 s56, s67, 128
    v_exp_f32_e64 v83, v83 clamp
    v_mfma_f32_16x16x32_bf16 v[84:87], a[232:235], a[208:211], v[84:87]
    v_exp_f32_e64 v73, v73 clamp
    v_mfma_f32_16x16x32_bf16 v[84:87], a[236:239], a[212:215], v[84:87]
    v_exp_f32_e64 v59, v59 clamp
    v_mfma_f32_16x16x32_bf16 v[76:79], a[236:239], a[188:191], v[76:79]
    ds_read_b128 a[220:223], v1 offset:6144
    v_cvt_pk_bf16_f32 v21, v66, v67
    v_mfma_f32_16x16x32_bf16 v[76:79], a[232:235], a[184:187], v[76:79]
    s_add_u32 s58, s33, 128
    s_add_u32 m0, s38, 2048
    v_cvt_pk_bf16_f32 v41, v90, v91
    v_mfma_f32_16x16x32_bf16 v[76:79], a[228:231], a[180:183], v[76:79]
    buffer_load_dwordx4 v6, s[12:15], s58 offen nt lds
    v_mfma_f32_16x16x32_bf16 v[48:51], a[248:251], v[40:43], 0
    ds_read_b128 a[224:227], v0 offset:7168
    v_fma_f32 v56, v56, s28, v9
    v_mfma_f32_16x16x32_bf16 v[68:71], a[228:231], a[156:159], v[68:71]
    buffer_store_dwordx4 v[96:99], v6, s[16:19], s56 offen offset:0 nt
    s_nop 0
    ds_read_b128 v[96:99], v103 offset:3072
    v_exp_f32_e64 v58, v58 clamp
    v_mfma_f32_16x16x32_bf16 v[68:71], a[232:235], a[160:163], v[68:71]
    v_exp_f32_e64 v65, v65 clamp
    v_mfma_f32_16x16x32_bf16 v[68:71], a[236:239], a[164:167], v[68:71]
    v_cvt_pk_bf16_f32 v20, v64, v65
    v_cvt_pk_bf16_f32 v17, v58, v59
    v_mfma_f32_16x16x32_bf16 v[60:63], a[236:239], a[140:143], v[60:63]
    v_exp_f32_e64 v56, v56 clamp
    v_mfma_f32_16x16x32_bf16 v[60:63], a[232:235], a[136:139], v[60:63]
    v_exp_f32_e64 v57, v57 clamp
    v_mfma_f32_16x16x32_bf16 v[60:63], a[228:231], a[132:135], v[60:63]
    v_cvt_pk_bf16_f32 v28, v72, v73
    v_cvt_pk_bf16_f32 v16, v56, v57
    v_mfma_f32_16x16x32_bf16 v[52:55], a[228:231], a[108:111], v[52:55]
    v_exp_f32_e64 v74, v74 clamp
    v_mfma_f32_16x16x32_bf16 v[52:55], a[232:235], a[112:115], v[52:55]
    ds_read_b128 a[228:231], v1 offset:7168
    v_cvt_pk_bf16_f32 v33, v82, v83
    v_smfmac_f32_16x16x64_bf16 v[48:51], a[240:243], v[16:23], v101
    s_add_u32 m0, s38, 3072
    v_cvt_pk_bf16_f32 v29, v74, v75
    v_mfma_f32_16x16x32_bf16 v[52:55], a[236:239], a[116:119], v[52:55]
    s_nop 0
    v_smfmac_f32_16x16x64_bf16 v[48:51], a[244:247], v[28:35], v101
    s_waitcnt lgkmcnt(1)
    ds_read_b128 a[232:235], v0 offset:8192
    v_mfma_f32_16x16x32_bf16 v[56:59], a[216:219], a[96:99], 0
    ds_read_b128 a[236:239], v1 offset:8192
    v_add_u32 v103, 4096, v103
    v_mfma_f32_16x16x32_bf16 v[56:59], a[220:223], a[100:103], v[56:59]
    s_nop 1
    v_cmp_lt_f32 vcc, s29, v48
    v_mfma_f32_16x16x32_bf16 v[56:59], a[224:227], a[104:107], v[56:59]
    v_mfma_f32_16x16x32_bf16 v[64:67], a[224:227], a[128:131], 0
    buffer_load_dwordx4 v7, s[12:15], s58 offen nt lds
    v_mfma_f32_16x16x32_bf16 v[64:67], a[220:223], a[124:127], v[64:67]
    s_nop 0
    s_cbranch_vccnz L_rs_tr45d
L_ret_tr45d:
    v_mfma_f32_16x16x32_bf16 v[64:67], a[216:219], a[120:123], v[64:67]
    v_fma_f32 v60, v60, s28, v10
    v_mfma_f32_16x16x32_bf16 v[72:75], a[216:219], a[144:147], 0
    v_fma_f32 v52, v52, s28, v9
    v_fma_f32 v63, v63, s28, v10
    v_mfma_f32_16x16x32_bf16 v[72:75], a[220:223], a[148:151], v[72:75]
    v_fma_f32 v53, v53, s28, v9
    v_fma_f32 v54, v54, s28, v9
    v_mfma_f32_16x16x32_bf16 v[72:75], a[224:227], a[152:155], v[72:75]
    v_exp_f32_e64 v52, v52 clamp
    v_mfma_f32_16x16x32_bf16 v[80:83], a[224:227], a[176:179], 0
    v_exp_f32_e64 v63, v63 clamp
    v_mfma_f32_16x16x32_bf16 v[80:83], a[220:223], a[172:175], v[80:83]
    s_waitcnt vmcnt(13) lgkmcnt(0)
    v_exp_f32_e64 v53, v53 clamp
    v_mfma_f32_16x16x32_bf16 v[80:83], a[216:219], a[168:171], v[80:83]
    s_barrier
    v_mfma_f32_16x16x32_bf16 v[88:91], a[216:219], a[192:195], 0
    ds_read_b64_tr_b16 a[216:217], v2 offset:18432
    v_fma_f32 v55, v55, s28, v9
    v_mfma_f32_16x16x32_bf16 v[88:91], a[220:223], a[196:199], v[88:91]
    s_add_u32 m0, s22, 0
    ds_read_b64_tr_b16 a[218:219], v2 offset:12288
    v_mfma_f32_16x16x32_bf16 v[88:91], a[224:227], a[200:203], v[88:91]
    ds_read_b64_tr_b16 a[220:221], v3 offset:18432
    v_fma_f32 v62, v62, s28, v10
    v_mfma_f32_16x16x32_bf16 v[88:91], a[228:231], a[204:207], v[88:91]
    buffer_load_dwordx4 v6, s[4:7], s20 offen lds
    v_mfma_f32_16x16x32_bf16 v[88:91], a[232:235], a[208:211], v[88:91]
    v_exp_f32_e64 v54, v54 clamp
    v_mfma_f32_16x16x32_bf16 v[88:91], a[236:239], a[212:215], v[88:91]
    s_add_u32 s20, s20, 128
    ds_read_b64_tr_b16 a[222:223], v3 offset:12288
    v_cvt_pk_bf16_f32 v14, v52, v53
    v_mfma_f32_16x16x32_bf16 v[80:83], a[236:239], a[188:191], v[80:83]
    v_fma_f32 v61, v61, s28, v10
    v_mfma_f32_16x16x32_bf16 v[80:83], a[232:235], a[184:187], v[80:83]
    s_add_u32 m0, s22, 1024
    v_exp_f32_e64 v55, v55 clamp
    v_mfma_f32_16x16x32_bf16 v[80:83], a[228:231], a[180:183], v[80:83]
    buffer_load_dwordx4 v6, s[4:7], s20 offen lds
    v_mfma_f32_16x16x32_bf16 v[72:75], a[228:231], a[156:159], v[72:75]
    s_add_u32 s20, s20, 128
    v_exp_f32_e64 v61, v61 clamp
    v_mfma_f32_16x16x32_bf16 v[72:75], a[232:235], a[160:163], v[72:75]
    v_exp_f32_e64 v60, v60 clamp
    v_mfma_f32_16x16x32_bf16 v[72:75], a[236:239], a[164:167], v[72:75]
    s_add_u32 m0, s22, 2048
    ds_read_b64_tr_b16 a[224:225], v4 offset:18432
    v_mfma_f32_16x16x32_bf16 v[64:67], a[236:239], a[140:143], v[64:67]
    buffer_load_dwordx4 v6, s[4:7], s20 offen lds
    v_mfma_f32_16x16x32_bf16 v[64:67], a[232:235], a[136:139], v[64:67]
    ds_read_b64_tr_b16 a[226:227], v4 offset:12288
    v_mfma_f32_16x16x32_bf16 v[64:67], a[228:231], a[132:135], v[64:67]
    s_add_u32 s20, s20, 12032
    v_exp_f32_e64 v62, v62 clamp
    v_mfma_f32_16x16x32_bf16 v[56:59], a[228:231], a[108:111], v[56:59]
    s_waitcnt lgkmcnt(2)
    ds_read_b64_tr_b16 a[228:229], v5 offset:18432
    v_cvt_pk_bf16_f32 v15, v54, v55
    v_mfma_f32_16x16x32_bf16 v[56:59], a[232:235], a[112:115], v[56:59]
    s_bitcmp1_b32 s3, 1
    ds_read_b64_tr_b16 a[230:231], v5 offset:12288
    v_mfma_f32_16x16x32_bf16 v[56:59], a[236:239], a[116:119], v[56:59]
    buffer_store_dwordx4 v[96:99], v7, s[16:19], s56 offen offset:0 nt
    s_cbranch_scc1 L_loop5w1
    s_branch L_loop5w0
L_tr44:
    v_mfma_f32_16x16x32_bf16 v[112:115], a[216:219], v[16:19], v[112:115]
    ds_read_b64_tr_b16 a[236:237], v3 offset:19456
    v_fma_f32 v78, v78, s28, v12
    v_mfma_f32_16x16x32_bf16 v[160:163], a[216:219], v[20:23], v[160:163]
    v_fma_f32 v58, v58, s28, v9
    v_fma_f32 v63, v63, s28, v10
    v_mfma_f32_16x16x32_bf16 v[208:211], a[216:219], v[28:31], v[208:211]
    ds_read_b64_tr_b16 a[234:235], v2 offset:13312
    v_fma_f32 v65, v65, s28, v10
    v_fma_f32 v66, v66, s28, v10
    v_mfma_f32_16x16x32_bf16 a[0:3], a[216:219], v[32:35], a[0:3]
    v_fma_f32 v64, v64, s28, v10
    s_waitcnt lgkmcnt(6)
    v_mfma_f32_16x16x32_bf16 a[4:7], a[220:223], v[32:35], a[4:7]
    ds_read_b64_tr_b16 a[232:233], v2 offset:19456
    v_fma_f32 v59, v59, s28, v9
    v_mfma_f32_16x16x32_bf16 v[212:215], a[220:223], v[28:31], v[212:215]
    ds_read_b64_tr_b16 a[238:239], v3 offset:13312
    v_fma_f32 v79, v79, s28, v12
    v_mfma_f32_16x16x32_bf16 v[164:167], a[220:223], v[20:23], v[164:167]
    v_exp_f32_e64 v78, v78 clamp
    v_mfma_f32_16x16x32_bf16 v[116:119], a[220:223], v[16:19], v[116:119]
    ds_read_b64_tr_b16 a[216:217], v4 offset:19456
    s_waitcnt lgkmcnt(7)
    v_mfma_f32_16x16x32_bf16 v[120:123], a[224:227], v[16:19], v[120:123]
    v_fma_f32 v62, v62, s28, v10
    v_fma_f32 v74, v74, s28, v11
    v_mfma_f32_16x16x32_bf16 v[168:171], a[224:227], v[20:23], v[168:171]
    ds_read_b128 v[84:87], v103 offset:0
    v_mfma_f32_16x16x32_bf16 v[216:219], a[224:227], v[28:31], v[216:219]
    v_exp_f32_e64 v64, v64 clamp
    v_mfma_f32_16x16x32_bf16 a[8:11], a[224:227], v[32:35], a[8:11]
    s_waitcnt lgkmcnt(5)
    ds_read_b64_tr_b16 a[224:225], v2 offset:20480
    v_mfma_f32_16x16x32_bf16 a[12:15], a[228:231], v[32:35], a[12:15]
    v_exp_f32_e64 v59, v59 clamp
    v_mfma_f32_16x16x32_bf16 v[220:223], a[228:231], v[28:31], v[220:223]
    ds_read_b64_tr_b16 a[218:219], v4 offset:13312
    v_fma_f32 v71, v71, s28, v11
    v_mfma_f32_16x16x32_bf16 v[172:175], a[228:231], v[20:23], v[172:175]
    ds_read_b64_tr_b16 a[222:223], v5 offset:13312
    v_fma_f32 v73, v73, s28, v11
    v_mfma_f32_16x16x32_bf16 v[124:127], a[228:231], v[16:19], v[124:127]
    s_waitcnt lgkmcnt(5)
    ds_read_b64_tr_b16 a[226:227], v2 offset:14336
    v_mfma_f32_16x16x32_bf16 v[128:131], a[232:235], v[16:19], v[128:131]
    ds_read_b64_tr_b16 a[220:221], v5 offset:19456
    v_fma_f32 v83, v83, s28, v12
    v_mfma_f32_16x16x32_bf16 v[176:179], a[232:235], v[20:23], v[176:179]
    v_fma_f32 v82, v82, s28, v12
    v_mfma_f32_16x16x32_bf16 v[224:227], a[232:235], v[28:31], v[224:227]
    v_fma_f32 v68, v68, s28, v11
    v_fma_f32 v76, v76, s28, v12
    v_mfma_f32_16x16x32_bf16 a[16:19], a[232:235], v[32:35], a[16:19]
    ds_read_b64_tr_b16 a[228:229], v3 offset:20480
    v_fma_f32 v69, v69, s28, v11
    v_mfma_f32_16x16x32_bf16 a[20:23], a[236:239], v[32:35], a[20:23]
    ds_read_b64_tr_b16 a[234:235], v4 offset:14336
    v_mfma_f32_16x16x32_bf16 v[228:231], a[236:239], v[28:31], v[228:231]
    ds_read_b64_tr_b16 a[232:233], v4 offset:20480
    v_fma_f32 v81, v81, s28, v12
    v_mfma_f32_16x16x32_bf16 v[180:183], a[236:239], v[20:23], v[180:183]
    ds_read_b64_tr_b16 a[230:231], v3 offset:14336
    v_fma_f32 v72, v72, s28, v11
    v_mfma_f32_16x16x32_bf16 v[132:135], a[236:239], v[16:19], v[132:135]
    s_waitcnt lgkmcnt(7)
    ds_read_b64_tr_b16 a[236:237], v5 offset:20480
    v_fma_f32 v75, v75, s28, v11
    v_mfma_f32_16x16x32_bf16 v[136:139], a[216:219], v[16:19], v[136:139]
    ds_read_b64_tr_b16 a[238:239], v5 offset:14336
    v_fma_f32 v77, v77, s28, v12
    v_mfma_f32_16x16x32_bf16 v[184:187], a[216:219], v[20:23], v[184:187]
    v_exp_f32_e64 v79, v79 clamp
    v_mfma_f32_16x16x32_bf16 v[232:235], a[216:219], v[28:31], v[232:235]
    v_exp_f32_e64 v68, v68 clamp
    v_mfma_f32_16x16x32_bf16 a[24:27], a[216:219], v[32:35], a[24:27]
    s_waitcnt lgkmcnt(6)
    v_exp_f32_e64 v58, v58 clamp
    v_mfma_f32_16x16x32_bf16 a[28:31], a[220:223], v[32:35], a[28:31]
    v_exp_f32_e64 v81, v81 clamp
    v_mfma_f32_16x16x32_bf16 v[236:239], a[220:223], v[28:31], v[236:239]
    v_exp_f32_e64 v77, v77 clamp
    v_mfma_f32_16x16x32_bf16 v[188:191], a[220:223], v[20:23], v[188:191]
    v_exp_f32_e64 v69, v69 clamp
    v_mfma_f32_16x16x32_bf16 v[140:143], a[220:223], v[16:19], v[140:143]
    v_exp_f32_e64 v76, v76 clamp
    v_mfma_f32_16x16x32_bf16 v[144:147], a[224:227], v[16:19], v[144:147]
    s_add_u32 s39, s39, 12288
    v_fma_f32 v67, v67, s28, v10
    v_cvt_pk_bf16_f32 v26, v68, v69
    v_mfma_f32_16x16x32_bf16 v[192:195], a[224:227], v[20:23], v[192:195]
    v_exp_f32_e64 v63, v63 clamp
    v_mfma_f32_16x16x32_bf16 v[240:243], a[224:227], v[28:31], v[240:243]
    s_waitcnt vmcnt(10) lgkmcnt(0)
    v_exp_f32_e64 v66, v66 clamp
    v_mfma_f32_16x16x32_bf16 a[32:35], a[224:227], v[32:35], a[32:35]
    s_barrier
    v_mfma_f32_16x16x32_bf16 a[36:39], a[228:231], v[32:35], a[36:39]
    ds_read_b128 a[216:219], v0 offset:12288
    v_mfma_f32_16x16x32_bf16 v[244:247], a[228:231], v[28:31], v[244:247]
    s_add_u32 m0, s22, 36864
    ds_read_b128 a[220:223], v1 offset:12288
    v_fma_f32 v70, v70, s28, v11
    v_mfma_f32_16x16x32_bf16 v[196:199], a[228:231], v[20:23], v[196:199]
    ds_read_b128 a[224:227], v0 offset:13312
    v_fma_f32 v56, v56, s28, v9
    v_mfma_f32_16x16x32_bf16 v[148:151], a[228:231], v[16:19], v[148:151]
    ds_read_b128 a[228:231], v1 offset:13312
    v_mfma_f32_16x16x32_bf16 v[152:155], a[232:235], v[16:19], v[152:155]
    buffer_load_dwordx4 v6, s[8:11], s21 offen lds
    v_mfma_f32_16x16x32_bf16 v[200:203], a[232:235], v[20:23], v[200:203]
    s_add_u32 s21, s21, 128
    v_exp_f32_e64 v71, v71 clamp
    v_mfma_f32_16x16x32_bf16 v[248:251], a[232:235], v[28:31], v[248:251]
    s_add_u32 m0, s22, 37888
    v_exp_f32_e64 v70, v70 clamp
    v_mfma_f32_16x16x32_bf16 a[40:43], a[232:235], v[32:35], a[40:43]
    buffer_load_dwordx4 v6, s[8:11], s21 offen lds
    v_mfma_f32_16x16x32_bf16 a[44:47], a[236:239], v[32:35], a[44:47]
    s_add_u32 s21, s21, 128
    ds_read_b128 a[232:235], v0 offset:14336
    v_cvt_pk_bf16_f32 v27, v70, v71
    v_mfma_f32_16x16x32_bf16 v[252:255], a[236:239], v[28:31], v[252:255]
    s_add_u32 m0, s22, 38912
    v_exp_f32_e64 v62, v62 clamp
    v_mfma_f32_16x16x32_bf16 v[204:207], a[236:239], v[20:23], v[204:207]
    buffer_load_dwordx4 v6, s[8:11], s21 offen lds
    v_mfma_f32_16x16x32_bf16 v[156:159], a[236:239], v[16:19], v[156:159]
    s_waitcnt lgkmcnt(3)
    v_cvt_pk_bf16_f32 v23, v62, v63
    v_cvt_pk_bf16_f32 v35, v78, v79
    v_mfma_f32_16x16x32_bf16 v[52:55], a[216:219], a[96:99], 0
    v_mfma_f32_16x16x32_bf16 v[52:55], a[220:223], a[100:103], v[52:55]
    s_waitcnt lgkmcnt(1)
    v_exp_f32_e64 v82, v82 clamp
    v_mfma_f32_16x16x32_bf16 v[52:55], a[224:227], a[104:107], v[52:55]
    ds_read_b128 a[236:239], v1 offset:14336
    v_cvt_pk_bf16_f32 v22, v60, v61
    v_mfma_f32_16x16x32_bf16 v[60:63], a[224:227], a[128:131], 0
    v_exp_f32_e64 v74, v74 clamp
    v_mfma_f32_16x16x32_bf16 v[60:63], a[220:223], a[124:127], v[60:63]
    s_add_u32 s21, s21, 12032
    v_fma_f32 v80, v80, s28, v12
    v_cvt_pk_bf16_f32 v34, v76, v77
    v_mfma_f32_16x16x32_bf16 v[60:63], a[216:219], a[120:123], v[60:63]
    v_exp_f32_e64 v73, v73 clamp
    v_mfma_f32_16x16x32_bf16 v[68:71], a[216:219], a[144:147], 0
    v_exp_f32_e64 v75, v75 clamp
    v_mfma_f32_16x16x32_bf16 v[68:71], a[220:223], a[148:151], v[68:71]
    v_exp_f32_e64 v67, v67 clamp
    v_mfma_f32_16x16x32_bf16 v[68:71], a[224:227], a[152:155], v[68:71]
    v_exp_f32_e64 v56, v56 clamp
    v_mfma_f32_16x16x32_bf16 v[76:79], a[224:227], a[176:179], 0
    v_exp_f32_e64 v72, v72 clamp
    v_mfma_f32_16x16x32_bf16 v[76:79], a[220:223], a[172:175], v[76:79]
    v_exp_f32_e64 v65, v65 clamp
    v_mfma_f32_16x16x32_bf16 v[76:79], a[216:219], a[168:171], v[76:79]
    ds_read_b128 a[220:223], v1 offset:18432
    v_cvt_pk_bf16_f32 v25, v66, v67
    v_mfma_f32_16x16x32_bf16 v[76:79], a[228:231], a[180:183], v[76:79]
    s_waitcnt lgkmcnt(1)
    v_fma_f32 v57, v57, s28, v9
    v_cvt_pk_bf16_f32 v24, v64, v65
    v_mfma_f32_16x16x32_bf16 v[76:79], a[232:235], a[184:187], v[76:79]
    v_exp_f32_e64 v57, v57 clamp
    v_mfma_f32_16x16x32_bf16 v[76:79], a[236:239], a[188:191], v[76:79]
    v_exp_f32_e64 v83, v83 clamp
    v_mfma_f32_16x16x32_bf16 v[68:71], a[236:239], a[164:167], v[68:71]
    ds_read_b128 a[216:219], v0 offset:18432
    v_mfma_f32_16x16x32_bf16 v[68:71], a[232:235], a[160:163], v[68:71]
    ds_read_b128 v[96:99], v103 offset:2048
    v_mfma_f32_16x16x32_bf16 v[68:71], a[228:231], a[156:159], v[68:71]
    ds_read_b128 v[88:91], v103 offset:1024
    v_mfma_f32_16x16x32_bf16 v[60:63], a[228:231], a[132:135], v[60:63]
    v_cvt_pk_bf16_f32 v17, v58, v59
    v_cvt_pk_bf16_f32 v16, v56, v57
    v_mfma_f32_16x16x32_bf16 v[60:63], a[232:235], a[136:139], v[60:63]
    ds_read_b128 a[224:227], v0 offset:19456
    v_mfma_f32_16x16x32_bf16 v[60:63], a[236:239], a[140:143], v[60:63]
    v_cvt_pk_bf16_f32 v29, v74, v75
    v_mfma_f32_16x16x32_bf16 v[52:55], a[236:239], a[116:119], v[52:55]
    v_exp_f32_e64 v80, v80 clamp
    v_mfma_f32_16x16x32_bf16 v[52:55], a[232:235], a[112:115], v[52:55]
    ds_read_b128 a[232:235], v0 offset:20480
    v_cvt_pk_bf16_f32 v37, v82, v83
    v_mfma_f32_16x16x32_bf16 v[52:55], a[228:231], a[108:111], v[52:55]
    ds_read_b128 a[236:239], v1 offset:20480
    v_cvt_pk_bf16_f32 v28, v72, v73
    v_mfma_f32_16x16x32_bf16 v[44:47], a[248:251], v[14:17], v[44:47]
    ds_read_b128 a[228:231], v1 offset:19456
    v_cvt_pk_bf16_f32 v36, v80, v81
    v_smfmac_f32_16x16x64_bf16 v[44:47], a[240:243], v[22:29], v101
    s_nop 0
    v_mfma_f32_16x16x32_bf16 v[44:47], a[252:255], v[34:37], v[44:47]
    buffer_store_dwordx4 v[84:87], v6, s[16:19], s24 offen offset:0 nt
    s_nop 0
    ds_read_b128 v[84:87], v103 offset:3072
    s_add_u32 s57, s24, 128
    s_waitcnt lgkmcnt(5)
    v_mfma_f32_16x16x32_bf16 v[56:59], a[216:219], a[96:99], 0
    s_nop 1
    v_cmp_lt_f32 vcc, s29, v44
    v_mfma_f32_16x16x32_bf16 v[56:59], a[220:223], a[100:103], v[56:59]
    s_waitcnt lgkmcnt(4)
    v_mfma_f32_16x16x32_bf16 v[56:59], a[224:227], a[104:107], v[56:59]
    v_mfma_f32_16x16x32_bf16 v[64:67], a[224:227], a[128:131], 0
    s_nop 0
    s_cbranch_vccnz L_rs_tr44a
L_ret_tr44a:
    v_mfma_f32_16x16x32_bf16 v[64:67], a[220:223], a[124:127], v[64:67]
    v_fma_f32 v54, v54, s28, v9
    v_mfma_f32_16x16x32_bf16 v[64:67], a[216:219], a[120:123], v[64:67]
    s_waitcnt vmcnt(7) lgkmcnt(1)
    v_mfma_f32_16x16x32_bf16 v[72:75], a[216:219], a[144:147], 0
    s_barrier
    v_mfma_f32_16x16x32_bf16 v[72:75], a[220:223], a[148:151], v[72:75]
    buffer_store_dwordx4 v[88:91], v7, s[16:19], s24 offen offset:0 nt
    v_exp_f32_e64 v54, v54 clamp
    v_fma_f32 v60, v60, s28, v10
    v_mfma_f32_16x16x32_bf16 v[72:75], a[224:227], a[152:155], v[72:75]
    s_add_u32 m0, s22, 12288
    v_exp_f32_e64 v60, v60 clamp
    v_mfma_f32_16x16x32_bf16 v[80:83], a[224:227], a[176:179], 0
    buffer_load_dwordx4 v6, s[4:7], s20 offen lds
    v_mfma_f32_16x16x32_bf16 v[80:83], a[220:223], a[172:175], v[80:83]
    s_add_u32 s20, s20, 128
    v_fma_f32 v53, v53, s28, v9
    s_add_u32 m0, s22, 13312
    v_mfma_f32_16x16x32_bf16 v[80:83], a[216:219], a[168:171], v[80:83]
    buffer_load_dwordx4 v6, s[4:7], s20 offen lds
    v_mfma_f32_16x16x32_bf16 v[80:83], a[228:231], a[180:183], v[80:83]
    ds_read_b64_tr_b16 a[216:217], v2 offset:0
    v_mfma_f32_16x16x32_bf16 v[80:83], a[232:235], a[184:187], v[80:83]
    s_add_u32 s20, s20, 128
    ds_read_b64_tr_b16 a[218:219], v2 offset:6144
    v_mfma_f32_16x16x32_bf16 v[80:83], a[236:239], a[188:191], v[80:83]
    s_add_u32 m0, s22, 14336
    ds_read_b64_tr_b16 a[220:221], v3 offset:0
    v_fma_f32 v61, v61, s28, v10
    v_mfma_f32_16x16x32_bf16 v[72:75], a[236:239], a[164:167], v[72:75]
    buffer_load_dwordx4 v6, s[4:7], s20 offen lds
    v_mfma_f32_16x16x32_bf16 v[72:75], a[232:235], a[160:163], v[72:75]
    ds_read_b64_tr_b16 a[222:223], v3 offset:6144
    v_fma_f32 v55, v55, s28, v9
    v_mfma_f32_16x16x32_bf16 v[72:75], a[228:231], a[156:159], v[72:75]
    s_add_u32 s20, s20, 12032
    v_exp_f32_e64 v55, v55 clamp
    v_mfma_f32_16x16x32_bf16 v[64:67], a[228:231], a[132:135], v[64:67]
    v_exp_f32_e64 v61, v61 clamp
    v_mfma_f32_16x16x32_bf16 v[64:67], a[232:235], a[136:139], v[64:67]
    buffer_store_dwordx4 v[96:99], v6, s[16:19], s57 offen offset:0 nt
    ds_read_b64_tr_b16 a[224:225], v4 offset:0
    v_fma_f32 v52, v52, s28, v9
    v_cvt_pk_bf16_f32 v19, v54, v55
    v_mfma_f32_16x16x32_bf16 v[64:67], a[236:239], a[140:143], v[64:67]
    ds_read_b64_tr_b16 a[226:227], v4 offset:6144
    v_mfma_f32_16x16x32_bf16 v[56:59], a[236:239], a[116:119], v[56:59]
    v_exp_f32_e64 v52, v52 clamp
    v_mfma_f32_16x16x32_bf16 v[56:59], a[232:235], a[112:115], v[56:59]
    s_waitcnt lgkmcnt(4)
    v_exp_f32_e64 v53, v53 clamp
    v_mfma_f32_16x16x32_bf16 v[56:59], a[228:231], a[108:111], v[56:59]
    buffer_store_dwordx4 v[84:87], v7, s[16:19], s57 offen offset:0 nt
    ds_read_b64_tr_b16 a[228:229], v5 offset:0
    ds_read_b64_tr_b16 a[230:231], v5 offset:6144
    v_cvt_pk_bf16_f32 v18, v52, v53
    v_mfma_f32_16x16x32_bf16 v[112:115], a[216:219], v[14:17], v[112:115]
    ds_read_b64_tr_b16 a[236:237], v3 offset:1024
    v_fma_f32 v67, v67, s28, v10
    v_and_b32 v104, 0x3ff, v0
    v_fma_f32 v71, v71, s28, v11
    v_mfma_f32_16x16x32_bf16 v[160:163], a[216:219], v[22:25], v[160:163]
    ds_read_b64_tr_b16 a[234:235], v2 offset:7168
    v_lshrrev_b32 v105, 11, v0
    v_fma_f32 v64, v64, s28, v10
    v_mfma_f32_16x16x32_bf16 v[208:211], a[216:219], v[26:29], v[208:211]
    v_fma_f32 v83, v83, s28, v12
    v_fma_f32 v66, v66, s28, v10
    v_mfma_f32_16x16x32_bf16 a[0:3], a[216:219], v[34:37], a[0:3]
    s_waitcnt lgkmcnt(6)
    v_fma_f32 v79, v79, s28, v12
    v_fma_f32 v62, v62, s28, v10
    v_mfma_f32_16x16x32_bf16 a[4:7], a[220:223], v[34:37], a[4:7]
    ds_read_b64_tr_b16 a[238:239], v3 offset:7168
    v_fma_f32 v63, v63, s28, v10
    v_mfma_f32_16x16x32_bf16 v[212:215], a[220:223], v[26:29], v[212:215]
    ds_read_b64_tr_b16 a[232:233], v2 offset:1024
    v_xor_b32 v105, s65, v105
    v_mfma_f32_16x16x32_bf16 v[164:167], a[220:223], v[22:25], v[164:167]
    v_exp_f32_e64 v67, v67 clamp
    v_mfma_f32_16x16x32_bf16 v[116:119], a[220:223], v[14:17], v[116:119]
    s_waitcnt lgkmcnt(6)
    v_exp_f32_e64 v66, v66 clamp
    v_lshl_add_u32 v104, v105, 10, v104
    v_mfma_f32_16x16x32_bf16 v[120:123], a[224:227], v[14:17], v[120:123]
    ds_read_b64_tr_b16 a[220:221], v5 offset:1024
    v_fma_f32 v76, v76, s28, v12
    v_mfma_f32_16x16x32_bf16 v[168:171], a[224:227], v[22:25], v[168:171]
    s_add_u32 s39, s39, 12288
    v_exp_f32_e64 v62, v62 clamp
    v_mfma_f32_16x16x32_bf16 v[216:219], a[224:227], v[26:29], v[216:219]
    ds_read_b64_tr_b16 a[222:223], v5 offset:7168
    v_fma_f32 v72, v72, s28, v11
    v_mfma_f32_16x16x32_bf16 a[8:11], a[224:227], v[34:37], a[8:11]
    s_waitcnt lgkmcnt(4)
    ds_read_b64_tr_b16 a[216:217], v4 offset:1024
    v_add_u32 v104, s38, v104
    v_mfma_f32_16x16x32_bf16 a[12:15], a[228:231], v[34:37], a[12:15]
    ds_read_b128 a[176:179], v104 offset:20480
    v_fma_f32 v59, v59, s28, v9
    v_mfma_f32_16x16x32_bf16 v[220:223], a[228:231], v[26:29], v[220:223]
    ds_read_b64_tr_b16 a[218:219], v4 offset:7168
    v_xor_b32 v105, 64, v104
    v_mfma_f32_16x16x32_bf16 v[172:175], a[228:231], v[22:25], v[172:175]
    v_exp_f32_e64 v72, v72 clamp
    v_mfma_f32_16x16x32_bf16 v[124:127], a[228:231], v[14:17], v[124:127]
    s_waitcnt lgkmcnt(5)
    ds_read_b128 a[152:155], v104 offset:14336
    v_fma_f32 v58, v58, s28, v9
    v_mfma_f32_16x16x32_bf16 v[128:131], a[232:235], v[14:17], v[128:131]
    ds_read_b64_tr_b16 a[230:231], v3 offset:8192
    v_fma_f32 v70, v70, s28, v11
    v_mfma_f32_16x16x32_bf16 v[176:179], a[232:235], v[22:25], v[176:179]
    ds_read_b64_tr_b16 a[226:227], v2 offset:8192
    v_fma_f32 v75, v75, s28, v11
    v_mfma_f32_16x16x32_bf16 v[224:227], a[232:235], v[26:29], v[224:227]
    ds_read_b64_tr_b16 a[228:229], v3 offset:2048
    v_fma_f32 v68, v68, s28, v11
    v_mfma_f32_16x16x32_bf16 a[16:19], a[232:235], v[34:37], a[16:19]
    ds_read_b64_tr_b16 a[224:225], v2 offset:2048
    v_fma_f32 v80, v80, s28, v12
    v_mfma_f32_16x16x32_bf16 a[20:23], a[236:239], v[34:37], a[20:23]
    v_exp_f32_e64 v71, v71 clamp
    v_mfma_f32_16x16x32_bf16 v[228:231], a[236:239], v[26:29], v[228:231]
    ds_read_b128 a[100:103], v105 offset:0
    v_exp_f32_e64 v68, v68 clamp
    v_mfma_f32_16x16x32_bf16 v[180:183], a[236:239], v[22:25], v[180:183]
    ds_read_b64_tr_b16 a[234:235], v4 offset:8192
    v_fma_f32 v73, v73, s28, v11
    v_mfma_f32_16x16x32_bf16 v[132:135], a[236:239], v[14:17], v[132:135]
    s_waitcnt lgkmcnt(7)
    ds_read_b64_tr_b16 a[232:233], v4 offset:2048
    v_fma_f32 v82, v82, s28, v12
    v_mfma_f32_16x16x32_bf16 v[136:139], a[216:219], v[14:17], v[136:139]
    ds_read_b64_tr_b16 a[238:239], v5 offset:8192
    v_fma_f32 v78, v78, s28, v12
    v_mfma_f32_16x16x32_bf16 v[184:187], a[216:219], v[22:25], v[184:187]
    ds_read_b64_tr_b16 a[236:237], v5 offset:2048
    v_fma_f32 v69, v69, s28, v11
    v_mfma_f32_16x16x32_bf16 v[232:235], a[216:219], v[26:29], v[232:235]
    ds_read_b128 a[168:171], v104 offset:18432
    v_fma_f32 v77, v77, s28, v12
    v_mfma_f32_16x16x32_bf16 a[24:27], a[216:219], v[34:37], a[24:27]
    ds_read_b128 a[120:123], v104 offset:6144
    v_fma_f32 v81, v81, s28, v12
    v_mfma_f32_16x16x32_bf16 a[28:31], a[220:223], v[34:37], a[28:31]
    ds_read_b128 a[144:147], v104 offset:12288
    v_exp_f32_e64 v69, v69 clamp
    v_mfma_f32_16x16x32_bf16 v[236:239], a[220:223], v[26:29], v[236:239]
    v_exp_f32_e64 v78, v78 clamp
    v_mfma_f32_16x16x32_bf16 v[188:191], a[220:223], v[22:25], v[188:191]
    v_exp_f32_e64 v70, v70 clamp
    v_mfma_f32_16x16x32_bf16 v[140:143], a[220:223], v[14:17], v[140:143]
    s_waitcnt lgkmcnt(7)
    ds_read_b128 a[128:131], v104 offset:8192
    v_exp_f32_e64 v73, v73 clamp
    v_mfma_f32_16x16x32_bf16 v[144:147], a[224:227], v[14:17], v[144:147]
    ds_read_b128 a[148:151], v105 offset:12288
    v_exp_f32_e64 v81, v81 clamp
    v_mfma_f32_16x16x32_bf16 v[192:195], a[224:227], v[22:25], v[192:195]
    v_exp_f32_e64 v79, v79 clamp
    v_mfma_f32_16x16x32_bf16 v[240:243], a[224:227], v[26:29], v[240:243]
    s_waitcnt vmcnt(10) lgkmcnt(5)
    ds_read_b128 a[96:99], v104 offset:0
    v_fma_f32 v65, v65, s28, v10
    v_mfma_f32_16x16x32_bf16 a[32:35], a[224:227], v[34:37], a[32:35]
    s_barrier
    ds_read_b128 a[172:175], v105 offset:18432
    v_mfma_f32_16x16x32_bf16 a[36:39], a[228:231], v[34:37], a[36:39]
    s_add_u32 s21, s21, s62
    v_cvt_pk_bf16_f32 v31, v70, v71
    v_fma_f32 v56, v56, s28, v9
    v_mfma_f32_16x16x32_bf16 v[244:247], a[228:231], v[26:29], v[244:247]
    s_add_u32 m0, s22, 24576
    ds_read_b128 a[220:223], v1 offset:0
    buffer_load_dwordx4 v6, s[8:11], s21 offen lds
    v_mfma_f32_16x16x32_bf16 v[196:199], a[228:231], v[22:25], v[196:199]
    s_add_u32 s21, s21, 128
    ds_read_b128 a[216:219], v0 offset:0
    v_cvt_pk_bf16_f32 v30, v68, v69
    v_mfma_f32_16x16x32_bf16 v[148:151], a[228:231], v[14:17], v[148:151]
    s_add_u32 m0, s22, 25600
    ds_read_b128 a[104:107], v104 offset:2048
    buffer_load_dwordx4 v6, s[8:11], s21 offen lds
    v_mfma_f32_16x16x32_bf16 v[152:155], a[232:235], v[14:17], v[152:155]
    s_add_u32 s21, s21, 128
    v_exp_f32_e64 v77, v77 clamp
    v_mfma_f32_16x16x32_bf16 v[200:203], a[232:235], v[22:25], v[200:203]
    s_add_u32 m0, s22, 26624
    ds_read_b128 a[132:135], v105 offset:8192
    v_cvt_pk_bf16_f32 v21, v66, v67
    v_mfma_f32_16x16x32_bf16 v[248:251], a[232:235], v[26:29], v[248:251]
    v_exp_f32_e64 v63, v63 clamp
    v_mfma_f32_16x16x32_bf16 a[40:43], a[232:235], v[34:37], a[40:43]
    ds_read_b128 a[124:127], v105 offset:6144
    v_fma_f32 v57, v57, s28, v9
    v_mfma_f32_16x16x32_bf16 a[44:47], a[236:239], v[34:37], a[44:47]
    buffer_load_dwordx4 v6, s[8:11], s21 offen lds
    ds_read_b128 a[224:227], v0 offset:1024
    v_exp_f32_e64 v83, v83 clamp
    v_cvt_pk_bf16_f32 v35, v78, v79
    v_mfma_f32_16x16x32_bf16 v[252:255], a[236:239], v[26:29], v[252:255]
    ds_read_b128 a[156:159], v105 offset:14336
    v_exp_f32_e64 v76, v76 clamp
    v_mfma_f32_16x16x32_bf16 v[204:207], a[236:239], v[22:25], v[204:207]
    ds_read_b128 a[228:231], v1 offset:1024
    v_cvt_pk_bf16_f32 v22, v60, v61
    v_mfma_f32_16x16x32_bf16 v[156:159], a[236:239], v[14:17], v[156:159]
    s_waitcnt lgkmcnt(6)
    ds_read_b128 a[180:183], v105 offset:20480
    v_cvt_pk_bf16_f32 v34, v76, v77
    v_mfma_f32_16x16x32_bf16 v[52:55], a[216:219], a[96:99], 0
    ds_read_b128 a[108:111], v105 offset:2048
    v_cvt_pk_bf16_f32 v23, v62, v63
    v_mfma_f32_16x16x32_bf16 v[60:63], a[216:219], a[120:123], 0
    v_exp_f32_e64 v59, v59 clamp
    v_mfma_f32_16x16x32_bf16 v[68:71], a[216:219], a[144:147], 0
    v_exp_f32_e64 v56, v56 clamp
    v_mfma_f32_16x16x32_bf16 v[76:79], a[216:219], a[168:171], 0
    s_add_u32 s21, s21, 12032
    ds_read_b128 a[232:235], v0 offset:6144
    v_fma_f32 v74, v74, s28, v11
    v_mfma_f32_16x16x32_bf16 v[52:55], a[220:223], a[100:103], v[52:55]
    s_waitcnt lgkmcnt(6)
    v_exp_f32_e64 v57, v57 clamp
    v_mfma_f32_16x16x32_bf16 v[60:63], a[220:223], a[124:127], v[60:63]
    v_exp_f32_e64 v58, v58 clamp
    v_mfma_f32_16x16x32_bf16 v[68:71], a[220:223], a[148:151], v[68:71]
    v_exp_f32_e64 v82, v82 clamp
    v_mfma_f32_16x16x32_bf16 v[76:79], a[220:223], a[172:175], v[76:79]
    s_waitcnt lgkmcnt(4)
    ds_read_b128 a[184:187], v104 offset:22528
    v_cvt_pk_bf16_f32 v28, v72, v73
    v_mfma_f32_16x16x32_bf16 v[52:55], a[224:227], a[104:107], v[52:55]
    ds_read_b128 a[160:163], v104 offset:16384
    v_exp_f32_e64 v65, v65 clamp
    v_mfma_f32_16x16x32_bf16 v[60:63], a[224:227], a[128:131], v[60:63]
    v_exp_f32_e64 v64, v64 clamp
    v_mfma_f32_16x16x32_bf16 v[68:71], a[224:227], a[152:155], v[68:71]
    v_cvt_pk_bf16_f32 v33, v82, v83
    v_cvt_pk_bf16_f32 v17, v58, v59
    v_mfma_f32_16x16x32_bf16 v[76:79], a[224:227], a[176:179], v[76:79]
    s_waitcnt lgkmcnt(3)
    ds_read_b128 a[216:219], v0 offset:7168
    v_cvt_pk_bf16_f32 v20, v64, v65
    v_mfma_f32_16x16x32_bf16 v[52:55], a[228:231], a[108:111], v[52:55]
    ds_read_b128 a[236:239], v1 offset:6144
    v_cvt_pk_bf16_f32 v16, v56, v57
    v_mfma_f32_16x16x32_bf16 v[60:63], a[228:231], a[132:135], v[60:63]
    v_exp_f32_e64 v75, v75 clamp
    v_mfma_f32_16x16x32_bf16 v[68:71], a[228:231], a[156:159], v[68:71]
    v_exp_f32_e64 v74, v74 clamp
    v_mfma_f32_16x16x32_bf16 v[76:79], a[228:231], a[180:183], v[76:79]
    s_waitcnt lgkmcnt(4)
    ds_read_b128 a[136:139], v104 offset:10240
    v_cvt_pk_bf16_f32 v29, v74, v75
    v_mfma_f32_16x16x32_bf16 v[56:59], a[232:235], a[96:99], 0
    ds_read_b128 a[140:143], v105 offset:10240
    v_exp_f32_e64 v80, v80 clamp
    v_mfma_f32_16x16x32_bf16 v[64:67], a[232:235], a[120:123], 0
    ds_read_b128 a[220:223], v1 offset:7168
    v_cvt_pk_bf16_f32 v32, v80, v81
    v_smfmac_f32_16x16x64_bf16 v[48:51], a[240:243], v[16:23], v101
    ds_read_b128 a[228:231], v1 offset:2048
    v_smfmac_f32_16x16x64_bf16 v[48:51], a[244:247], v[28:35], v101
    ds_read_b128 a[164:167], v105 offset:16384
    v_mfma_f32_16x16x32_bf16 v[72:75], a[232:235], a[144:147], 0
    ds_read_b128 a[112:115], v104 offset:4096
    v_mfma_f32_16x16x32_bf16 v[80:83], a[232:235], a[168:171], 0
    ds_read_b128 a[116:119], v105 offset:4096
    s_waitcnt lgkmcnt(7)
    v_mfma_f32_16x16x32_bf16 v[56:59], a[236:239], a[100:103], v[56:59]
    ds_read_b128 a[188:191], v105 offset:22528
    v_cmp_lt_f32 vcc, s29, v48
    v_mfma_f32_16x16x32_bf16 v[64:67], a[236:239], a[124:127], v[64:67]
    ds_read_b128 a[224:227], v0 offset:2048
    v_mfma_f32_16x16x32_bf16 v[72:75], a[236:239], a[148:151], v[72:75]
    ds_read_b128 a[232:235], v0 offset:8192
    v_mfma_f32_16x16x32_bf16 v[80:83], a[236:239], a[172:175], v[80:83]
    s_cbranch_vccnz L_rs_tr44b
L_ret_tr44b:
    ds_read_b128 a[236:239], v1 offset:8192
    v_lshrrev_b32 v108, 11, v0
    v_mfma_f32_16x16x32_bf16 v[56:59], a[216:219], a[104:107], v[56:59]
    v_and_b32 v93, 0x3ff, v0
    v_mov_b32 v110, v45
    v_xor_b32 v108, s65, v108
    v_lshl_add_u32 v93, v108, 10, v93
    v_mfma_f32_16x16x32_bf16 v[64:67], a[216:219], a[128:131], v[64:67]
    v_mov_b32 v111, v46
    v_mbcnt_lo_u32_b32 v108, -1, 0
    v_mfma_f32_16x16x32_bf16 v[72:75], a[216:219], a[152:155], v[72:75]
    v_mbcnt_hi_u32_b32 v108, -1, v108
    v_lshrrev_b32 v108, 1, v108
    v_mfma_f32_16x16x32_bf16 v[80:83], a[216:219], a[176:179], v[80:83]
    s_waitcnt lgkmcnt(5)
    v_permlane16_swap_b32 v46, v111
    v_mfma_f32_16x16x32_bf16 v[56:59], a[220:223], a[108:111], v[56:59]
    v_add_u32 v93, s38, v93
    v_and_b32 v108, 24, v108
    v_permlane16_swap_b32 v45, v110
    v_mov_b32 v109, v50
    v_bfe_u32 v108, s66, v108, 8
    v_mfma_f32_16x16x32_bf16 v[64:67], a[220:223], a[132:135], v[64:67]
    v_add_f32 v45, v45, v110
    v_mov_b32 v110, v45
    v_mfma_f32_16x16x32_bf16 v[72:75], a[220:223], a[156:159], v[72:75]
    v_xor_b32 v93, v93, v108
    v_permlane16_swap_b32 v50, v109
    v_mfma_f32_16x16x32_bf16 v[80:83], a[220:223], a[180:183], v[80:83]
    s_waitcnt vmcnt(10) lgkmcnt(0)
    s_barrier
    v_mfma_f32_16x16x32_bf16 v[52:55], a[224:227], a[112:115], v[52:55]
    s_add_u32 m0, s22, 0
    ds_read_b64_tr_b16 a[216:217], v2 offset:18432
    buffer_load_dwordx4 v6, s[4:7], s20 offen lds
    v_mfma_f32_16x16x32_bf16 v[60:63], a[224:227], a[136:139], v[60:63]
    s_add_u32 s20, s20, 128
    v_add_f32 v50, v50, v109
    v_mov_b32 v108, v49
    v_mfma_f32_16x16x32_bf16 v[68:71], a[224:227], a[160:163], v[68:71]
    s_add_u32 m0, s22, 1024
    ds_read_b64_tr_b16 a[218:219], v2 offset:12288
    buffer_load_dwordx4 v6, s[4:7], s20 offen lds
    v_mfma_f32_16x16x32_bf16 v[76:79], a[224:227], a[184:187], v[76:79]
    s_add_u32 s20, s20, 128
    v_permlane16_swap_b32 v49, v108
    v_mfma_f32_16x16x32_bf16 v[52:55], a[228:231], a[116:119], v[52:55]
    s_add_u32 m0, s22, 2048
    ds_read_b64_tr_b16 a[220:221], v3 offset:18432
    buffer_load_dwordx4 v6, s[4:7], s20 offen lds
    v_mov_b32 v109, v50
    v_add_f32 v46, v46, v111
    v_mfma_f32_16x16x32_bf16 v[60:63], a[228:231], a[140:143], v[60:63]
    s_add_u32 s20, s20, 12032
    v_permlane32_swap_b32 v50, v109
    v_mfma_f32_16x16x32_bf16 v[68:71], a[228:231], a[164:167], v[68:71]
    ds_read_b64_tr_b16 a[222:223], v3 offset:12288
    v_add_f32 v49, v49, v108
    v_permlane32_swap_b32 v45, v110
    v_mfma_f32_16x16x32_bf16 v[76:79], a[228:231], a[188:191], v[76:79]
    v_mov_b32 v111, v46
    v_mov_b32 v108, v49
    v_add_f32 v50, v50, v110
    v_mfma_f32_16x16x32_bf16 v[56:59], a[232:235], a[112:115], v[56:59]
    v_rcp_f32 v50, v50
    v_mfma_f32_16x16x32_bf16 v[64:67], a[232:235], a[136:139], v[64:67]
    v_permlane32_swap_b32 v49, v108
    v_mfma_f32_16x16x32_bf16 v[72:75], a[232:235], a[160:163], v[72:75]
    v_add_f32 v48, v49, v47
    v_permlane32_swap_b32 v46, v111
    v_mfma_f32_16x16x32_bf16 v[80:83], a[232:235], a[184:187], v[80:83]
    ds_read_b64_tr_b16 a[224:225], v4 offset:18432
    v_add_f32 v94, v109, v46
    v_mfma_f32_16x16x32_bf16 v[56:59], a[236:239], a[116:119], v[56:59]
    ds_read_b64_tr_b16 a[226:227], v4 offset:12288
    v_add_f32 v92, v108, v45
    v_mfma_f32_16x16x32_bf16 v[64:67], a[236:239], a[140:143], v[64:67]
    s_waitcnt lgkmcnt(3)
    v_rcp_f32 v92, v92
    v_mfma_f32_16x16x32_bf16 v[72:75], a[236:239], a[164:167], v[72:75]
    ds_read_b64_tr_b16 a[228:229], v5 offset:18432
    v_rcp_f32 v94, v94
    v_mfma_f32_16x16x32_bf16 v[80:83], a[236:239], a[188:191], v[80:83]
    ds_read_b64_tr_b16 a[230:231], v5 offset:12288
    v_rcp_f32 v48, v48
    v_max3_f32 v98, v68, v69, v70
    v_max3_f32 v99, v76, v77, v78
    v_max3_f32 v96, v52, v53, v54
    v_max3_f32 v98, v98, v71, v72
    v_max3_f32 v96, v96, v55, v56
    s_nop 0
    v_max3_f32 v99, v99, v79, v80
    v_max3_f32 v98, v98, v73, v74
    v_mfma_f32_16x16x32_bf16 v[112:115], a[216:219], v[16:19], v[112:115]
    s_mov_b32 s67, s34
    v_max3_f32 v97, v60, v61, v62
    v_max3_f32 v97, v97, v63, v64
    v_mfma_f32_16x16x32_bf16 v[160:163], a[216:219], v[20:23], v[160:163]
    s_add_u32 s18, s34, 24576
    v_max3_f32 v99, v99, v81, v82
    v_max3_f32 v97, v97, v65, v66
    v_max_f32 v99, v99, v83
    v_mfma_f32_16x16x32_bf16 v[208:211], a[216:219], v[28:31], v[208:211]
    s_mov_b32 s34, s33
    v_max_f32 v98, v98, v75
    v_max3_f32 v96, v96, v57, v58
    v_mfma_f32_16x16x32_bf16 a[0:3], a[216:219], v[32:35], a[0:3]
    s_waitcnt lgkmcnt(4)
    ds_read_b64_tr_b16 a[238:239], v3 offset:13312
    v_max_f32 v96, v96, v59
    v_max_f32 v97, v97, v67
    v_mfma_f32_16x16x32_bf16 a[4:7], a[220:223], v[32:35], a[4:7]
    s_add_u32 s64, s64, s62
    ds_read_b64_tr_b16 a[232:233], v2 offset:19456
    v_permlane32_swap_b32 v96, v97
    v_mfma_f32_16x16x32_bf16 v[212:215], a[220:223], v[28:31], v[212:215]
    s_add_u32 s64, s64, 196608
    ds_read_b64_tr_b16 a[234:235], v2 offset:13312
    v_permlane32_swap_b32 v98, v99
    v_mfma_f32_16x16x32_bf16 v[164:167], a[220:223], v[20:23], v[164:167]
    s_mov_b32 s39, s64
    ds_read_b64_tr_b16 a[216:217], v4 offset:19456
    v_max_f32 v98, v98, v99
    v_mfma_f32_16x16x32_bf16 v[116:119], a[220:223], v[16:19], v[116:119]
    s_waitcnt lgkmcnt(4)
    ds_read_b64_tr_b16 a[236:237], v3 offset:19456
    v_max_f32 v96, v96, v97
    v_mfma_f32_16x16x32_bf16 v[120:123], a[224:227], v[16:19], v[120:123]
    s_add_u32 s37, s37, 1
    v_permlane16_swap_b32 v96, v98
    v_max_f32 v96, v96, v98
    v_mfma_f32_16x16x32_bf16 v[168:171], a[224:227], v[20:23], v[168:171]
    s_bitcmp1_b32 s63, s37
    ds_read_b64_tr_b16 a[218:219], v4 offset:13312
    v_mul_f32_e64 v9, -s28, v96
    v_mfma_f32_16x16x32_bf16 v[216:219], a[224:227], v[28:31], v[216:219]
    s_cselect_b32 s62, 4294770688, 0
    v_subrev_f32 v9, 0x42000000, v9
    v_mov_b32 v11, v9
    v_mfma_f32_16x16x32_bf16 a[8:11], a[224:227], v[32:35], a[8:11]
    s_cselect_b32 s42, 0, 325632
    v_permlane16_swap_b32 v9, v11
    v_mov_b32 v12, v11
    v_mfma_f32_16x16x32_bf16 a[12:15], a[228:231], v[32:35], a[12:15]
    s_add_u32 s35, s35, s42
    v_permlane32_swap_b32 v11, v12
    v_mov_b32 v10, v9
    v_mfma_f32_16x16x32_bf16 v[220:223], a[228:231], v[28:31], v[220:223]
    s_lshl_b32 s42, s37, 1
    ds_read_b64_tr_b16 a[222:223], v5 offset:13312
    v_permlane32_swap_b32 v9, v10
    v_mfma_f32_16x16x32_bf16 v[172:175], a[228:231], v[20:23], v[172:175]
    s_lshr_b32 s42, s31, s42
    ds_read_b64_tr_b16 a[220:221], v5 offset:19456
    v_fma_f32 v63, v63, s28, v10
    s_and_b32 s42, s42, 3
    v_subrev_u32 v103, 24576, v103
    v_mfma_f32_16x16x32_bf16 v[124:127], a[228:231], v[16:19], v[124:127]
    s_waitcnt lgkmcnt(4)
    ds_read_b64_tr_b16 a[226:227], v2 offset:14336
    v_fma_f32 v69, v69, s28, v11
    v_fma_f32 v77, v77, s28, v12
    v_mfma_f32_16x16x32_bf16 v[128:131], a[232:235], v[16:19], v[128:131]
    s_add_u32 s42, s42, s36
    v_exp_f32_e64 v69, v69 clamp
    v_mfma_f32_16x16x32_bf16 v[176:179], a[232:235], v[20:23], v[176:179]
    s_sub_u32 s43, s42, 3
    ds_read_b64_tr_b16 a[224:225], v2 offset:20480
    v_fma_f32 v80, v80, s28, v12
    v_mfma_f32_16x16x32_bf16 v[224:227], a[232:235], v[28:31], v[224:227]
    s_cmp_ge_u32 s42, 3
    v_accvgpr_read_b32 v104, a0
    v_mov_b32 v49, 0
    v_mfma_f32_16x16x32_bf16 a[16:19], a[232:235], v[32:35], a[16:19]
    s_waitcnt lgkmcnt(4)
    ds_read_b64_tr_b16 a[230:231], v3 offset:14336
    v_fma_f32 v74, v74, s28, v11
    v_fma_f32 v68, v68, s28, v11
    v_mfma_f32_16x16x32_bf16 a[20:23], a[236:239], v[32:35], a[20:23]
    s_cselect_b32 s42, s43, s42
    v_exp_f32_e64 v68, v68 clamp
    v_mfma_f32_16x16x32_bf16 v[228:231], a[236:239], v[28:31], v[228:231]
    s_mul_i32 s44, s3, 5
    s_mov_b32 s32, 1
    v_fma_f32 v61, v61, s28, v10
    v_mfma_f32_16x16x32_bf16 v[180:183], a[236:239], v[20:23], v[180:183]
    s_lshl_b32 s43, s3, 2
    ds_read_b64_tr_b16 a[232:233], v4 offset:20480
    v_exp_f32_e64 v63, v63 clamp
    v_mfma_f32_16x16x32_bf16 v[132:135], a[236:239], v[16:19], v[132:135]
    s_add_u32 s45, s43, 21
    v_fma_f32 v62, v62, s28, v10
    v_fma_f32 v59, v59, s28, v9
    v_mfma_f32_16x16x32_bf16 v[136:139], a[216:219], v[16:19], v[136:139]
    s_cmp_eq_u32 s3, 0
    ds_read_b64_tr_b16 a[234:235], v4 offset:14336
    v_fma_f32 v54, v54, s28, v9
    v_mfma_f32_16x16x32_bf16 v[184:187], a[216:219], v[20:23], v[184:187]
    s_cselect_b32 s45, 20, s45
    ds_read_b64_tr_b16 a[228:229], v3 offset:20480
    v_fma_f32 v67, v67, s28, v10
    v_fma_f32 v60, v60, s28, v10
    v_mfma_f32_16x16x32_bf16 v[232:235], a[216:219], v[28:31], v[232:235]
    s_cselect_b32 s33, 1, 0
    v_exp_f32_e64 v54, v54 clamp
    v_mfma_f32_16x16x32_bf16 a[24:27], a[216:219], v[32:35], a[24:27]
    s_waitcnt lgkmcnt(4)
    v_fma_f32 v53, v53, s28, v9
    v_fma_f32 v52, v52, s28, v9
    v_fma_f32 v55, v55, s28, v9
    v_mfma_f32_16x16x32_bf16 a[28:31], a[220:223], v[32:35], a[28:31]
    s_cmp_eq_u32 s42, 1
    v_fma_f32 v70, v70, s28, v11
    s_cselect_b32 s44, s45, s44
    v_mfma_f32_16x16x32_bf16 v[236:239], a[220:223], v[28:31], v[236:239]
    s_cselect_b32 s32, s33, s32
    v_exp_f32_e64 v55, v55 clamp
    v_mfma_f32_16x16x32_bf16 v[188:191], a[220:223], v[20:23], v[188:191]
    s_add_u32 s45, s43, 37
    ds_read_b64_tr_b16 a[238:239], v5 offset:14336
    v_fma_f32 v58, v58, s28, v9
    v_mfma_f32_16x16x32_bf16 v[140:143], a[220:223], v[16:19], v[140:143]
    s_cmp_eq_u32 s42, 2
    ds_read_b64_tr_b16 a[236:237], v5 offset:20480
    v_fma_f32 v78, v78, s28, v12
    v_fma_f32 v57, v57, s28, v9
    v_mfma_f32_16x16x32_bf16 v[144:147], a[224:227], v[16:19], v[144:147]
    s_cselect_b32 s44, s45, s44
    v_fma_f32 v79, v79, s28, v12
    v_fma_f32 v71, v71, s28, v11
    v_mfma_f32_16x16x32_bf16 v[192:195], a[224:227], v[20:23], v[192:195]
    s_cselect_b32 s32, 0, s32
    v_exp_f32_e64 v52, v52 clamp
    v_mfma_f32_16x16x32_bf16 v[240:243], a[224:227], v[28:31], v[240:243]
    s_mul_i32 s44, s44, 6144
    v_exp_f32_e64 v61, v61 clamp
    v_mfma_f32_16x16x32_bf16 a[32:35], a[224:227], v[32:35], a[32:35]
    s_add_u32 s33, s35, s44
    s_mul_i32 s42, s32, 6144
    v_cvt_pk_bf16_f32 v15, v54, v55
    s_waitcnt lgkmcnt(2)
    v_mfma_f32_16x16x32_bf16 a[36:39], a[228:231], v[32:35], a[36:39]
    s_add_u32 s42, s42, 24576
    s_add_u32 s42, s42, s33
    v_accvgpr_read_b32 v105, a1
    v_fma_f32 v82, v82, s28, v12
    v_mfma_f32_16x16x32_bf16 v[244:247], a[228:231], v[28:31], v[244:247]
    s_cmp_ge_u32 s37, 6
    s_cselect_b32 s14, 0, s42
    s_add_u32 s24, s67, 6144
    v_mfma_f32_16x16x32_bf16 v[196:199], a[228:231], v[20:23], v[196:199]
    s_add_u32 s25, s33, 6144
    v_fma_f32 v76, v76, s28, v12
    v_fma_f32 v66, v66, s28, v10
    s_add_u32 s23, s38, 6144
    v_mfma_f32_16x16x32_bf16 v[148:151], a[228:231], v[16:19], v[148:151]
    s_mov_b32 s27, 0x30c30
    s_mov_b32 s89, 0xaaaaaaaa
    v_exp_f32_e64 v60, v60 clamp
    v_mfma_f32_16x16x32_bf16 v[152:155], a[232:235], v[16:19], v[152:155]
    s_mov_b32 s30, 0
    v_exp_f32_e64 v53, v53 clamp
    v_mfma_f32_16x16x32_bf16 v[200:203], a[232:235], v[20:23], v[200:203]
    s_waitcnt vmcnt(8) lgkmcnt(0)
    s_barrier
    ds_read_b128 a[220:223], v1 offset:12288
    v_mfma_f32_16x16x32_bf16 v[248:251], a[232:235], v[28:31], v[248:251]
    ds_read_b128 a[216:219], v0 offset:12288
    v_exp_f32_e64 v77, v77 clamp
    v_mfma_f32_16x16x32_bf16 a[40:43], a[232:235], v[32:35], a[40:43]
    s_add_u32 m0, s22, 36864
    ds_read_b128 a[224:227], v0 offset:13312
    buffer_load_dwordx4 v6, s[8:11], s21 offen lds
    v_exp_f32_e64 v67, v67 clamp
    v_mfma_f32_16x16x32_bf16 a[44:47], a[236:239], v[32:35], a[44:47]
    s_add_u32 s21, s21, 128
    v_cvt_pk_bf16_f32 v26, v68, v69
    v_exp_f32_e64 v71, v71 clamp
    v_accvgpr_read_b32 v107, a3
    v_fma_f32 v56, v56, s28, v9
    v_exp_f32_e64 v79, v79 clamp
    v_pk_mul_f32 v[162:163], v[162:163], v[92:93] op_sel_hi:[1,0]
    v_fma_f32 v81, v81, s28, v12
    v_exp_f32_e64 v78, v78 clamp
    v_exp_f32_e64 v74, v74 clamp
    v_fma_f32 v64, v64, s28, v10
    v_accvgpr_read_b32 v111, a7
    v_cvt_pk_bf16_f32 v14, v52, v53
    v_exp_f32_e64 v59, v59 clamp
    v_mfma_f32_16x16x32_bf16 v[252:255], a[236:239], v[28:31], v[252:255]
    v_exp_f32_e64 v62, v62 clamp
    v_mfma_f32_16x16x32_bf16 v[204:207], a[236:239], v[20:23], v[204:207]
    ds_read_b128 a[232:235], v0 offset:14336
    v_exp_f32_e64 v66, v66 clamp
    v_mfma_f32_16x16x32_bf16 v[156:159], a[236:239], v[16:19], v[156:159]
    s_waitcnt lgkmcnt(2)
    ds_read_b128 a[228:231], v1 offset:13312
    v_cvt_pk_bf16_f32 v22, v60, v61
    v_mfma_f32_16x16x32_bf16 v[52:55], a[216:219], a[96:99], 0
    ds_read_b128 a[236:239], v1 offset:14336
    v_cvt_pk_bf16_f32 v23, v62, v63
    v_mfma_f32_16x16x32_bf16 v[52:55], a[220:223], a[100:103], v[52:55]
    s_waitcnt lgkmcnt(3)
    v_exp_f32_e64 v70, v70 clamp
    v_fma_f32 v73, v73, s28, v11
    v_mfma_f32_16x16x32_bf16 v[52:55], a[224:227], a[104:107], v[52:55]
    v_exp_f32_e64 v76, v76 clamp
    v_mfma_f32_16x16x32_bf16 v[60:63], a[224:227], a[128:131], 0
    v_cvt_pk_bf16_f32 v27, v70, v71
    v_fma_f32 v83, v83, s28, v12
    v_mfma_f32_16x16x32_bf16 v[60:63], a[220:223], a[124:127], v[60:63]
    v_fma_f32 v72, v72, s28, v11
    v_cvt_pk_bf16_f32 v35, v78, v79
    v_mfma_f32_16x16x32_bf16 v[60:63], a[216:219], a[120:123], v[60:63]
    s_add_u32 m0, s22, 37888
    v_exp_f32_e64 v81, v81 clamp
    v_mfma_f32_16x16x32_bf16 v[68:71], a[216:219], a[144:147], 0
    v_cvt_pk_bf16_f32 v34, v76, v77
    v_fma_f32 v75, v75, s28, v11
    v_mfma_f32_16x16x32_bf16 v[68:71], a[220:223], a[148:151], v[68:71]
    v_exp_f32_e64 v58, v58 clamp
    v_mfma_f32_16x16x32_bf16 v[68:71], a[224:227], a[152:155], v[68:71]
    v_exp_f32_e64 v56, v56 clamp
    v_mfma_f32_16x16x32_bf16 v[76:79], a[224:227], a[176:179], 0
    v_exp_f32_e64 v72, v72 clamp
    v_mfma_f32_16x16x32_bf16 v[76:79], a[220:223], a[172:175], v[76:79]
    ds_read_b128 a[224:227], v0 offset:19456
    v_fma_f32 v65, v65, s28, v10
    v_mfma_f32_16x16x32_bf16 v[76:79], a[216:219], a[168:171], v[76:79]
    s_waitcnt lgkmcnt(1)
    v_exp_f32_e64 v57, v57 clamp
    v_mfma_f32_16x16x32_bf16 v[76:79], a[228:231], a[180:183], v[76:79]
    ds_read_b128 a[216:219], v0 offset:18432
    v_exp_f32_e64 v73, v73 clamp
    v_mfma_f32_16x16x32_bf16 v[76:79], a[232:235], a[184:187], v[76:79]
    buffer_load_dwordx4 v6, s[8:11], s21 offen lds
    v_mfma_f32_16x16x32_bf16 v[76:79], a[236:239], a[188:191], v[76:79]
    ds_read_b128 a[220:223], v1 offset:18432
    v_accvgpr_read_b32 v109, a5
    v_mfma_f32_16x16x32_bf16 v[68:71], a[236:239], a[164:167], v[68:71]
    v_cvt_pk_bf16_f32 v28, v72, v73
    v_cvt_pk_bf16_f32 v16, v56, v57
    v_mfma_f32_16x16x32_bf16 v[68:71], a[232:235], a[160:163], v[68:71]
    v_exp_f32_e64 v80, v80 clamp
    v_mfma_f32_16x16x32_bf16 v[68:71], a[228:231], a[156:159], v[68:71]
    v_exp_f32_e64 v83, v83 clamp
    v_mfma_f32_16x16x32_bf16 v[60:63], a[228:231], a[132:135], v[60:63]
    v_exp_f32_e64 v64, v64 clamp
    v_mfma_f32_16x16x32_bf16 v[60:63], a[232:235], a[136:139], v[60:63]
    v_mov_b32 v51, 0
    v_cvt_pk_bf16_f32 v17, v58, v59
    v_mfma_f32_16x16x32_bf16 v[60:63], a[236:239], a[140:143], v[60:63]
    v_exp_f32_e64 v75, v75 clamp
    v_mfma_f32_16x16x32_bf16 v[52:55], a[236:239], a[116:119], v[52:55]
    s_add_u32 s21, s21, 128
    v_accvgpr_read_b32 v108, a4
    v_accvgpr_read_b32 v106, a2
    v_mfma_f32_16x16x32_bf16 v[52:55], a[232:235], a[112:115], v[52:55]
    s_add_u32 m0, s22, 38912
    v_exp_f32_e64 v65, v65 clamp
    v_mfma_f32_16x16x32_bf16 v[52:55], a[228:231], a[108:111], v[52:55]
    s_waitcnt lgkmcnt(1)
    v_exp_f32_e64 v82, v82 clamp
    v_mfma_f32_16x16x32_bf16 v[56:59], a[216:219], a[96:99], 0
    s_waitcnt lgkmcnt(0)
    ds_read_b128 a[228:231], v1 offset:19456
    v_cvt_pk_bf16_f32 v24, v64, v65
    v_mfma_f32_16x16x32_bf16 v[56:59], a[220:223], a[100:103], v[56:59]
    v_fma_f32 v76, v76, s28, v12
    v_accvgpr_read_b32 v110, a6
    v_mfma_f32_16x16x32_bf16 v[56:59], a[224:227], a[104:107], v[56:59]
    ds_read_b128 a[232:235], v0 offset:20480
    v_cvt_pk_bf16_f32 v25, v66, v67
    v_mfma_f32_16x16x32_bf16 v[64:67], a[224:227], a[128:131], 0
    buffer_load_dwordx4 v6, s[8:11], s21 offen lds
    v_mfma_f32_16x16x32_bf16 v[64:67], a[220:223], a[124:127], v[64:67]
    v_fma_f32 v70, v70, s28, v11
    v_cvt_pk_bf16_f32 v29, v74, v75
    v_mfma_f32_16x16x32_bf16 v[64:67], a[216:219], a[120:123], v[64:67]
    v_fma_f32 v68, v68, s28, v11
    v_fma_f32 v53, v53, s28, v9
    v_mfma_f32_16x16x32_bf16 v[72:75], a[216:219], a[144:147], 0
    s_add_u32 s21, s21, 12032
    ds_read_b128 a[236:239], v1 offset:20480
    v_exp_f32_e64 v68, v68 clamp
    v_fma_f32 v54, v54, s28, v9
    v_fma_f32 v61, v61, s28, v10
    v_pk_mul_f32 v[146:147], v[146:147], v[48:49] op_sel_hi:[1,0]
    v_pk_mul_f32 v[164:165], v[164:165], v[92:93] op_sel_hi:[1,0]
    v_mov_b32 v39, v7
    v_pk_mul_f32 v[148:149], v[148:149], v[48:49] op_sel_hi:[1,0]
    v_pk_mul_f32 v[174:175], v[174:175], v[92:93] op_sel_hi:[1,0]
    v_pk_mul_f32 v[150:151], v[150:151], v[48:49] op_sel_hi:[1,0]
    v_pk_mul_f32 v[154:155], v[154:155], v[48:49] op_sel_hi:[1,0]
    v_pk_mul_f32 v[124:125], v[124:125], v[48:49] op_sel_hi:[1,0]
    v_pk_mul_f32 v[104:105], v[104:105], v[94:95] op_sel_hi:[1,0]
    v_pk_mul_f32 v[136:137], v[136:137], v[48:49] op_sel_hi:[1,0]
    v_pk_mul_f32 v[108:109], v[108:109], v[94:95] op_sel_hi:[1,0]
    v_pk_mul_f32 v[186:187], v[186:187], v[92:93] op_sel_hi:[1,0]
    v_cvt_pk_bf16_f32 v37, v82, v83
    v_pk_mul_f32 v[188:189], v[188:189], v[92:93] op_sel_hi:[1,0]
    v_pk_mul_f32 v[238:239], v[238:239], v[50:51] op_sel_hi:[1,0]
    v_pk_mul_f32 v[220:221], v[220:221], v[50:51] op_sel_hi:[1,0]
    v_pk_mul_f32 v[212:213], v[212:213], v[50:51] op_sel_hi:[1,0]
    v_pk_mul_f32 v[106:107], v[106:107], v[94:95] op_sel_hi:[1,0]
    v_pk_mul_f32 v[168:169], v[168:169], v[92:93] op_sel_hi:[1,0]
    v_pk_mul_f32 v[226:227], v[226:227], v[50:51] op_sel_hi:[1,0]
    v_pk_mul_f32 v[166:167], v[166:167], v[92:93] op_sel_hi:[1,0]
    v_pk_mul_f32 v[214:215], v[214:215], v[50:51] op_sel_hi:[1,0]
    v_cvt_pk_bf16_f32 v124, v124, v125
    v_pk_mul_f32 v[118:119], v[118:119], v[48:49] op_sel_hi:[1,0]
    v_pk_mul_f32 v[218:219], v[218:219], v[50:51] op_sel_hi:[1,0]
    v_pk_mul_f32 v[240:241], v[240:241], v[50:51] op_sel_hi:[1,0]
    v_pk_mul_f32 v[110:111], v[110:111], v[94:95] op_sel_hi:[1,0]
    v_pk_mul_f32 v[112:113], v[112:113], v[48:49] op_sel_hi:[1,0]
    v_pk_mul_f32 v[116:117], v[116:117], v[48:49] op_sel_hi:[1,0]
    v_pk_mul_f32 v[114:115], v[114:115], v[48:49] op_sel_hi:[1,0]
    v_pk_mul_f32 v[200:201], v[200:201], v[92:93] op_sel_hi:[1,0]
    v_pk_mul_f32 v[176:177], v[176:177], v[92:93] op_sel_hi:[1,0]
    v_pk_mul_f32 v[210:211], v[210:211], v[50:51] op_sel_hi:[1,0]
    v_pk_mul_f32 v[234:235], v[234:235], v[50:51] op_sel_hi:[1,0]
    v_pk_mul_f32 v[160:161], v[160:161], v[92:93] op_sel_hi:[1,0]
    v_pk_mul_f32 v[216:217], v[216:217], v[50:51] op_sel_hi:[1,0]
    v_pk_mul_f32 v[208:209], v[208:209], v[50:51] op_sel_hi:[1,0]
    v_fma_f32 v62, v62, s28, v10
    v_cvt_pk_bf16_f32 v112, v112, v113
    v_mfma_f32_16x16x32_bf16 v[72:75], a[220:223], a[148:151], v[72:75]
    v_cvt_pk_bf16_f32 v36, v80, v81
    v_cvt_pk_bf16_f32 v113, v114, v115
    v_mfma_f32_16x16x32_bf16 v[72:75], a[224:227], a[152:155], v[72:75]
    s_waitcnt vmcnt(6) lgkmcnt(0)
    v_cvt_pk_bf16_f32 v104, v104, v105
    v_cvt_pk_bf16_f32 v160, v160, v161
    v_mfma_f32_16x16x32_bf16 v[80:83], a[224:227], a[176:179], 0
    v_cvt_pk_bf16_f32 v108, v108, v109
    v_cvt_pk_bf16_f32 v148, v148, v149
    v_mfma_f32_16x16x32_bf16 v[44:47], a[248:251], v[14:17], 0
    s_barrier
    v_mfma_f32_16x16x32_bf16 v[80:83], a[220:223], a[172:175], v[80:83]
    v_fma_f32 v52, v52, s28, v9
    v_cvt_pk_bf16_f32 v212, v212, v213
    v_mfma_f32_16x16x32_bf16 v[80:83], a[216:219], a[168:171], v[80:83]
    v_fma_f32 v71, v71, s28, v11
    v_exp_f32_e64 v70, v70 clamp
    v_mfma_f32_16x16x32_bf16 v[80:83], a[228:231], a[180:183], v[80:83]
    ds_read_b64_tr_b16 a[216:217], v2 offset:0
    v_cvt_pk_bf16_f32 v176, v176, v177
    v_mfma_f32_16x16x32_bf16 v[80:83], a[232:235], a[184:187], v[80:83]
    ds_read_b64_tr_b16 a[218:219], v2 offset:6144
    v_cvt_pk_bf16_f32 v105, v106, v107
    v_mfma_f32_16x16x32_bf16 v[80:83], a[236:239], a[188:191], v[80:83]
    v_cvt_pk_bf16_f32 v216, v216, v217
    v_cvt_pk_bf16_f32 v109, v110, v111
    v_cvt_pk_bf16_f32 v161, v162, v163
    v_mfma_f32_16x16x32_bf16 v[72:75], a[236:239], a[164:167], v[72:75]
    s_add_u32 m0, s22, 12288
    ds_read_b64_tr_b16 a[220:221], v3 offset:0
    v_cvt_pk_bf16_f32 v116, v116, v117
    v_mfma_f32_16x16x32_bf16 v[72:75], a[232:235], a[160:163], v[72:75]
    buffer_load_dwordx4 v6, s[4:7], s20 offen lds
    v_mfma_f32_16x16x32_bf16 v[72:75], a[228:231], a[156:159], v[72:75]
    ds_read_b64_tr_b16 a[222:223], v3 offset:6144
    v_cvt_pk_bf16_f32 v208, v208, v209
    v_fma_f32 v79, v79, s28, v12
    v_mfma_f32_16x16x32_bf16 v[64:67], a[228:231], a[132:135], v[64:67]
    ds_write2st64_b64 v93, v[112:113], v[160:161] offset0:0 offset1:12
    v_pk_mul_f32 v[236:237], v[236:237], v[50:51] op_sel_hi:[1,0]
    v_cvt_pk_bf16_f32 v209, v210, v211
    v_pk_mul_f32 v[178:179], v[178:179], v[92:93] op_sel_hi:[1,0]
    v_cvt_pk_bf16_f32 v136, v136, v137
    v_cvt_pk_bf16_f32 v200, v200, v201
    v_cvt_pk_bf16_f32 v164, v164, v165
    v_mfma_f32_16x16x32_bf16 v[64:67], a[232:235], a[136:139], v[64:67]
    ds_read_b64_tr_b16 a[224:225], v4 offset:0
    v_cvt_pk_bf16_f32 v213, v214, v215
    v_mfma_f32_16x16x32_bf16 v[64:67], a[236:239], a[140:143], v[64:67]
    ds_write2st64_b64 v93, v[208:209], v[104:105] offset0:24 offset1:36
    v_pk_mul_f32 v[158:159], v[158:159], v[48:49] op_sel_hi:[1,0]
    v_xor_b32 v93, 32, v93
    v_pk_mul_f32 v[182:183], v[182:183], v[92:93] op_sel_hi:[1,0]
    v_pk_mul_f32 v[252:253], v[252:253], v[50:51] op_sel_hi:[1,0]
    v_mov_b32 v38, v6
    v_pk_mul_f32 v[170:171], v[170:171], v[92:93] op_sel_hi:[1,0]
    v_pk_mul_f32 v[222:223], v[222:223], v[50:51] op_sel_hi:[1,0]
    v_pk_mul_f32 v[228:229], v[228:229], v[50:51] op_sel_hi:[1,0]
    v_cvt_pk_bf16_f32 v165, v166, v167
    v_accvgpr_read_b32 v110, a14
    v_fma_f32 v75, v75, s28, v11
    v_fma_f32 v69, v69, s28, v11
    v_pk_mul_f32 v[230:231], v[230:231], v[50:51] op_sel_hi:[1,0]
    v_pk_mul_f32 v[130:131], v[130:131], v[48:49] op_sel_hi:[1,0]
    v_fma_f32 v65, v65, s28, v10
    v_fma_f32 v78, v78, s28, v12
    v_pk_mul_f32 v[122:123], v[122:123], v[48:49] op_sel_hi:[1,0]
    v_pk_mul_f32 v[126:127], v[126:127], v[48:49] op_sel_hi:[1,0]
    v_fma_f32 v64, v64, s28, v10
    v_pk_mul_f32 v[232:233], v[232:233], v[50:51] op_sel_hi:[1,0]
    v_cvt_pk_bf16_f32 v228, v228, v229
    v_cvt_pk_bf16_f32 v220, v220, v221
    v_exp_f32_e64 v52, v52 clamp
    v_pk_mul_f32 v[206:207], v[206:207], v[92:93] op_sel_hi:[1,0]
    v_accvgpr_read_b32 v106, a10
    v_cvt_pk_bf16_f32 v125, v126, v127
    v_cvt_pk_bf16_f32 v117, v118, v119
    v_mfma_f32_16x16x32_bf16 v[56:59], a[236:239], a[116:119], v[56:59]
    s_add_u32 s20, s20, 128
    ds_read_b64_tr_b16 a[226:227], v4 offset:6144
    v_fma_f32 v60, v60, s28, v10
    v_exp_f32_e64 v65, v65 clamp
    v_mfma_f32_16x16x32_bf16 v[56:59], a[232:235], a[112:115], v[56:59]
    ds_read_b64_tr_b16 a[234:235], v2 offset:7168
    v_exp_f32_e64 v79, v79 clamp
    v_mfma_f32_16x16x32_bf16 v[56:59], a[228:231], a[108:111], v[56:59]
    s_waitcnt lgkmcnt(2)
    v_cvt_pk_bf16_f32 v221, v222, v223
    v_exp_f32_e64 v76, v76 clamp
    v_mfma_f32_16x16x32_bf16 v[112:115], a[216:219], v[14:17], 0
    s_add_u32 m0, s22, 13312
    ds_read_b64_tr_b16 a[236:237], v3 offset:1024
    v_fma_f32 v72, v72, s28, v11
    v_smfmac_f32_16x16x64_bf16 v[44:47], a[240:243], v[22:29], v101
    buffer_load_dwordx4 v6, s[4:7], s20 offen lds
    ds_read_b64_tr_b16 a[228:229], v5 offset:0
    v_mfma_f32_16x16x32_bf16 v[160:163], a[216:219], v[22:25], 0
    ds_write2st64_b64 v93, v[116:117], v[164:165] offset0:0 offset1:12
    v_pk_mul_f32 v[138:139], v[138:139], v[48:49] op_sel_hi:[1,0]
    v_pk_mul_f32 v[134:135], v[134:135], v[48:49] op_sel_hi:[1,0]
    v_fma_f32 v58, v58, s28, v9
    v_cvt_pk_bf16_f32 v177, v178, v179
    v_accvgpr_read_b32 v105, a9
    v_pk_mul_f32 v[196:197], v[196:197], v[92:93] op_sel_hi:[1,0]
    v_cvt_pk_bf16_f32 v236, v236, v237
    v_pk_mul_f32 v[120:121], v[120:121], v[48:49] op_sel_hi:[1,0]
    v_pk_mul_f32 v[128:129], v[128:129], v[48:49] op_sel_hi:[1,0]
    v_accvgpr_read_b32 v111, a15
    v_pk_mul_f32 v[224:225], v[224:225], v[50:51] op_sel_hi:[1,0]
    v_pk_mul_f32 v[202:203], v[202:203], v[92:93] op_sel_hi:[1,0]
    v_pk_mul_f32 v[172:173], v[172:173], v[92:93] op_sel_hi:[1,0]
    v_pk_mul_f32 v[132:133], v[132:133], v[48:49] op_sel_hi:[1,0]
    v_pk_mul_f32 v[192:193], v[192:193], v[92:93] op_sel_hi:[1,0]
    v_fma_f32 v82, v82, s28, v12
    v_cvt_pk_bf16_f32 v132, v132, v133
    v_accvgpr_read_b32 v104, a8
    v_accvgpr_read_b32 v107, a11
    v_pk_mul_f32 v[104:105], v[104:105], v[94:95] op_sel_hi:[1,0]
    v_exp_f32_e64 v62, v62 clamp
    v_exp_f32_e64 v75, v75 clamp
    v_pk_mul_f32 v[144:145], v[144:145], v[48:49] op_sel_hi:[1,0]
    v_fma_f32 v77, v77, s28, v12
    v_cvt_pk_bf16_f32 v240, v240, v241
    v_mfma_f32_16x16x32_bf16 v[208:211], a[216:219], v[26:29], 0
    ds_write2st64_b64 v93, v[212:213], v[108:109] offset0:24 offset1:36
    v_pk_mul_f32 v[180:181], v[180:181], v[92:93] op_sel_hi:[1,0]
    v_cvt_pk_bf16_f32 v188, v188, v189
    v_cvt_pk_bf16_f32 v172, v172, v173
    v_pk_mul_f32 v[110:111], v[110:111], v[94:95] op_sel_hi:[1,0]
    v_fma_f32 v74, v74, s28, v11
    v_cvt_pk_bf16_f32 v217, v218, v219
    v_pk_mul_f32 v[156:157], v[156:157], v[48:49] op_sel_hi:[1,0]
    v_cvt_pk_bf16_f32 v224, v224, v225
    v_exp_f32_e64 v71, v71 clamp
    v_mfma_f32_16x16x32_bf16 a[0:3], a[216:219], v[34:37], 0
    s_add_u32 s20, s20, 128
    ds_read_b64_tr_b16 a[230:231], v5 offset:6144
    v_accvgpr_read_b32 v109, a13
    v_cvt_pk_bf16_f32 v120, v120, v121
    v_cvt_pk_bf16_f32 v229, v230, v231
    v_accvgpr_read_b32 v108, a12
    v_pk_mul_f32 v[108:109], v[108:109], v[94:95] op_sel_hi:[1,0]
    v_xor_b32 v93, 96, v93
    v_cvt_pk_bf16_f32 v168, v168, v169
    v_cvt_pk_bf16_f32 v108, v108, v109
    v_fma_f32 v80, v80, s28, v12
    v_cvt_pk_bf16_f32 v104, v104, v105
    v_cvt_pk_bf16_f32 v225, v226, v227
    v_exp_f32_e64 v74, v74 clamp
    v_pk_mul_f32 v[190:191], v[190:191], v[92:93] op_sel_hi:[1,0]
    v_cvt_pk_bf16_f32 v173, v174, v175
    v_cvt_pk_bf16_f32 v169, v170, v171
    v_pk_mul_f32 v[106:107], v[106:107], v[94:95] op_sel_hi:[1,0]
    v_pk_mul_f32 v[142:143], v[142:143], v[48:49] op_sel_hi:[1,0]
    v_cvt_pk_bf16_f32 v109, v110, v111
    v_pk_mul_f32 v[140:141], v[140:141], v[48:49] op_sel_hi:[1,0]
    v_cvt_pk_bf16_f32 v121, v122, v123
    v_exp_f32_e64 v77, v77 clamp
    v_cvt_pk_bf16_f32 v105, v106, v107
    v_cvt_pk_bf16_f32 v232, v232, v233
    v_accvgpr_read_b32 v110, a22
    v_cvt_pk_bf16_f32 v192, v192, v193
    v_fma_f32 v57, v57, s28, v9
    v_exp_f32_e64 v80, v80 clamp
    v_mfma_f32_16x16x32_bf16 a[4:7], a[220:223], v[34:37], 0
    ds_read_b64_tr_b16 a[238:239], v3 offset:7168
    v_cvt_pk_bf16_f32 v180, v180, v181
    v_cvt_pk_bf16_f32 v181, v182, v183
    v_cvt_pk_bf16_f32 v201, v202, v203
    v_accvgpr_read_b32 v107, a19
    v_exp_f32_e64 v54, v54 clamp
    v_mfma_f32_16x16x32_bf16 v[212:215], a[220:223], v[26:29], 0
    ds_write2st64_b64 v93, v[120:121], v[168:169] offset0:0 offset1:12
    v_mfma_f32_16x16x32_bf16 v[164:167], a[220:223], v[22:25], 0
    ds_write2st64_b64 v93, v[216:217], v[104:105] offset0:24 offset1:36
    v_xor_b32 v93, 32, v93
    v_accvgpr_read_b32 v106, a18
    v_mfma_f32_16x16x32_bf16 v[116:119], a[220:223], v[14:17], 0
    s_waitcnt lgkmcnt(3)
    ds_write2st64_b64 v93, v[124:125], v[172:173] offset0:0 offset1:12
    v_cvt_pk_bf16_f32 v133, v134, v135
    v_accvgpr_read_b32 v104, a16
    v_mfma_f32_16x16x32_bf16 v[120:123], a[224:227], v[14:17], 0
    ds_write2st64_b64 v93, v[220:221], v[108:109] offset0:24 offset1:36
    v_accvgpr_read_b32 v105, a17
    v_fma_f32 v56, v56, s28, v9
    v_pk_mul_f32 v[248:249], v[248:249], v[50:51] op_sel_hi:[1,0]
    v_accvgpr_read_b32 v108, a20
    v_xor_b32 v93, 96, v93
    v_pk_mul_f32 v[194:195], v[194:195], v[92:93] op_sel_hi:[1,0]
    v_cvt_pk_bf16_f32 v196, v196, v197
    v_pk_mul_f32 v[184:185], v[184:185], v[92:93] op_sel_hi:[1,0]
    v_pk_mul_f32 v[104:105], v[104:105], v[94:95] op_sel_hi:[1,0]
    v_pk_mul_f32 v[246:247], v[246:247], v[50:51] op_sel_hi:[1,0]
    v_exp_f32_e64 v64, v64 clamp
    v_pk_mul_f32 v[244:245], v[244:245], v[50:51] op_sel_hi:[1,0]
    v_cvt_pk_bf16_f32 v104, v104, v105
    v_accvgpr_read_b32 v111, a23
    v_cvt_pk_bf16_f32 v128, v128, v129
    v_pk_mul_f32 v[110:111], v[110:111], v[94:95] op_sel_hi:[1,0]
    v_pk_mul_f32 v[152:153], v[152:153], v[48:49] op_sel_hi:[1,0]
    v_pk_mul_f32 v[106:107], v[106:107], v[94:95] op_sel_hi:[1,0]
    v_accvgpr_read_b32 v109, a21
    v_fma_f32 v73, v73, s28, v11
    v_pk_mul_f32 v[254:255], v[254:255], v[50:51] op_sel_hi:[1,0]
    v_cvt_pk_bf16_f32 v137, v138, v139
    v_cvt_pk_bf16_f32 v184, v184, v185
    v_pk_mul_f32 v[108:109], v[108:109], v[94:95] op_sel_hi:[1,0]
    v_pk_mul_f32 v[204:205], v[204:205], v[92:93] op_sel_hi:[1,0]
    v_pk_mul_f32 v[250:251], v[250:251], v[50:51] op_sel_hi:[1,0]
    v_pk_mul_f32 v[242:243], v[242:243], v[50:51] op_sel_hi:[1,0]
    v_exp_f32_e64 v69, v69 clamp
    v_cvt_pk_bf16_f32 v129, v130, v131
    v_cvt_pk_bf16_f32 v152, v152, v153
    v_mfma_f32_16x16x32_bf16 v[168:171], a[224:227], v[22:25], 0
    ds_read_b128 v[88:91], v103 offset:0
    v_fma_f32 v83, v83, s28, v12
    v_mfma_f32_16x16x32_bf16 v[216:219], a[224:227], v[26:29], 0
    s_add_u32 m0, s22, 14336
    ds_write2st64_b64 v93, v[128:129], v[176:177] offset0:4 offset1:16
    v_mfma_f32_16x16x32_bf16 a[8:11], a[224:227], v[34:37], 0
    ds_read_b64_tr_b16 a[232:233], v2 offset:1024
    v_cvt_pk_bf16_f32 v108, v108, v109
    v_mfma_f32_16x16x32_bf16 a[12:15], a[228:231], v[34:37], 0
    ds_read_b64_tr_b16 a[224:225], v2 offset:2048
    v_cvt_pk_bf16_f32 v105, v106, v107
    v_mfma_f32_16x16x32_bf16 v[220:223], a[228:231], v[26:29], 0
    ds_read_b128 v[96:99], v103 offset:1024
    v_cvt_pk_bf16_f32 v189, v190, v191
    v_cvt_pk_bf16_f32 v109, v110, v111
    v_accvgpr_read_b32 v107, a27
    v_cvt_pk_bf16_f32 v144, v144, v145
    v_fma_f32 v55, v55, s28, v9
    v_mfma_f32_16x16x32_bf16 v[44:47], a[252:255], v[34:37], v[44:47]
    buffer_load_dwordx4 v6, s[4:7], s20 offen lds
    ds_read_b64_tr_b16 a[222:223], v5 offset:7168
    v_cvt_pk_bf16_f32 v252, v252, v253
    v_cvt_pk_bf16_f32 v140, v140, v141
    v_exp_f32_e64 v57, v57 clamp
    v_mfma_f32_16x16x32_bf16 v[172:175], a[228:231], v[22:25], 0
    ds_write2st64_b64 v93, v[224:225], v[104:105] offset0:28 offset1:40
    v_exp_f32_e64 v58, v58 clamp
    v_cvt_pk_bf16_f32 v233, v234, v235
    v_cvt_pk_bf16_f32 v141, v142, v143
    v_pk_mul_f32 v[198:199], v[198:199], v[92:93] op_sel_hi:[1,0]
    v_accvgpr_read_b32 v104, a24
    v_xor_b32 v93, 32, v93
    v_accvgpr_read_b32 v106, a26
    v_accvgpr_read_b32 v111, a31
    v_accvgpr_read_b32 v110, a30
    v_cvt_pk_bf16_f32 v185, v186, v187
    v_mfma_f32_16x16x32_bf16 v[124:127], a[228:231], v[14:17], 0
    s_waitcnt lgkmcnt(3)
    ds_write2st64_b64 v93, v[132:133], v[180:181] offset0:4 offset1:16
    v_accvgpr_read_b32 v105, a25
    v_cvt_pk_bf16_f32 v31, v70, v71
    v_mfma_f32_16x16x32_bf16 v[128:131], a[232:235], v[14:17], 0
    ds_read_b64_tr_b16 a[216:217], v4 offset:1024
    v_fma_f32 v81, v81, s28, v12
    v_mfma_f32_16x16x32_bf16 v[176:179], a[232:235], v[22:25], 0
    s_add_u32 s20, s20, 12032
    ds_write2st64_b64 v93, v[228:229], v[108:109] offset0:28 offset1:40
    v_cvt_pk_bf16_f32 v248, v248, v249
    v_fma_f32 v66, v66, s28, v10
    v_exp_f32_e64 v78, v78 clamp
    v_mfma_f32_16x16x32_bf16 v[224:227], a[232:235], v[26:29], 0
    s_add_u32 m0, s38, 0
    ds_read_b64_tr_b16 a[226:227], v2 offset:8192
    v_mov_b32 v48, 0
    v_mfma_f32_16x16x32_bf16 a[16:19], a[232:235], v[34:37], 0
    buffer_load_dwordx4 v6, s[12:15], s33 offen nt lds
    ds_read_b64_tr_b16 a[218:219], v4 offset:7168
    v_accvgpr_read_b32 v108, a28
    v_cvt_pk_bf16_f32 v204, v204, v205
    v_exp_f32_e64 v53, v53 clamp
    v_cvt_pk_bf16_f32 v145, v146, v147
    v_pk_mul_f32 v[104:105], v[104:105], v[94:95] op_sel_hi:[1,0]
    v_accvgpr_read_b32 v109, a29
    v_pk_mul_f32 v[106:107], v[106:107], v[94:95] op_sel_hi:[1,0]
    v_pk_mul_f32 v[108:109], v[108:109], v[94:95] op_sel_hi:[1,0]
    v_cvt_pk_bf16_f32 v104, v104, v105
    v_cvt_pk_bf16_f32 v105, v106, v107
    v_cvt_pk_bf16_f32 v149, v150, v151
    v_pk_mul_f32 v[110:111], v[110:111], v[94:95] op_sel_hi:[1,0]
    v_xor_b32 v93, 96, v93
    v_cvt_pk_bf16_f32 v156, v156, v157
    v_cvt_pk_bf16_f32 v244, v244, v245
    v_cvt_pk_bf16_f32 v108, v108, v109
    v_mfma_f32_16x16x32_bf16 a[20:23], a[236:239], v[34:37], 0
    ds_read_b64_tr_b16 a[220:221], v5 offset:1024
    v_cvt_pk_bf16_f32 v193, v194, v195
    v_mfma_f32_16x16x32_bf16 v[228:231], a[236:239], v[26:29], 0
    buffer_store_dwordx4 v[88:91], v6, s[16:19], s67 offen offset:0 nt
    s_add_u32 m0, s38, 1024
    ds_write2st64_b64 v93, v[136:137], v[184:185] offset0:4 offset1:16
    v_mfma_f32_16x16x32_bf16 v[180:183], a[236:239], v[22:25], 0
    ds_write2st64_b64 v93, v[232:233], v[104:105] offset0:28 offset1:40
    v_mfma_f32_16x16x32_bf16 v[132:135], a[236:239], v[14:17], 0
    s_waitcnt lgkmcnt(3)
    ds_read_b64_tr_b16 a[228:229], v3 offset:2048
    v_xor_b32 v93, 32, v93
    v_mfma_f32_16x16x32_bf16 v[136:139], a[216:219], v[14:17], 0
    ds_read_b64_tr_b16 a[234:235], v4 offset:8192
    v_accvgpr_read_b32 v107, a35
    v_cvt_pk_bf16_f32 v197, v198, v199
    v_cvt_pk_bf16_f32 v109, v110, v111
    v_accvgpr_read_b32 v106, a34
    v_mfma_f32_16x16x32_bf16 v[184:187], a[216:219], v[22:25], 0
    ds_read_b64_tr_b16 a[238:239], v5 offset:8192
    v_cvt_pk_bf16_f32 v237, v238, v239
    v_mfma_f32_16x16x32_bf16 v[232:235], a[216:219], v[26:29], 0
    ds_write2st64_b64 v93, v[140:141], v[188:189] offset0:4 offset1:16
    v_accvgpr_read_b32 v104, a32
    v_exp_f32_e64 v61, v61 clamp
    v_mfma_f32_16x16x32_bf16 a[24:27], a[216:219], v[34:37], 0
    s_waitcnt lgkmcnt(5)
    ds_read_b64_tr_b16 a[230:231], v3 offset:8192
    v_accvgpr_read_b32 v105, a33
    v_exp_f32_e64 v82, v82 clamp
    v_mfma_f32_16x16x32_bf16 a[28:31], a[220:223], v[34:37], 0
    ds_write2st64_b64 v93, v[236:237], v[108:109] offset0:28 offset1:40
    v_pk_mul_f32 v[104:105], v[104:105], v[94:95] op_sel_hi:[1,0]
    v_pk_mul_f32 v[106:107], v[106:107], v[94:95] op_sel_hi:[1,0]
    v_cvt_pk_bf16_f32 v104, v104, v105
    v_mov_b32 v50, 0
    v_cvt_pk_bf16_f32 v18, v52, v53
    v_mfma_f32_16x16x32_bf16 v[236:239], a[220:223], v[26:29], 0
    ds_read_b64_tr_b16 a[236:237], v5 offset:2048
    v_accvgpr_read_b32 v111, a39
    v_cvt_pk_bf16_f32 v105, v106, v107
    v_cvt_pk_bf16_f32 v241, v242, v243
    v_mfma_f32_16x16x32_bf16 v[188:191], a[220:223], v[22:25], 0
    ds_read_b64_tr_b16 a[232:233], v4 offset:2048
    buffer_load_dwordx4 v7, s[12:15], s33 offen nt lds
    v_exp_f32_e64 v60, v60 clamp
    v_xor_b32 v93, 96, v93
    v_accvgpr_read_b32 v109, a37
    v_accvgpr_read_b32 v110, a38
    v_mfma_f32_16x16x32_bf16 v[140:143], a[220:223], v[14:17], 0
    ds_write2st64_b64 v93, v[144:145], v[192:193] offset0:8 offset1:20
    v_cvt_pk_bf16_f32 v245, v246, v247
    v_accvgpr_read_b32 v108, a36
    v_mfma_f32_16x16x32_bf16 v[144:147], a[224:227], v[14:17], 0
    ds_write2st64_b64 v93, v[240:241], v[104:105] offset0:32 offset1:44
    v_pk_mul_f32 v[110:111], v[110:111], v[94:95] op_sel_hi:[1,0]
    v_pk_mul_f32 v[108:109], v[108:109], v[94:95] op_sel_hi:[1,0]
    v_cvt_pk_bf16_f32 v20, v64, v65
    v_cvt_pk_bf16_f32 v108, v108, v109
    v_xor_b32 v93, 32, v93
    v_cvt_pk_bf16_f32 v109, v110, v111
    v_cvt_pk_bf16_f32 v249, v250, v251
    v_mfma_f32_16x16x32_bf16 v[192:195], a[224:227], v[22:25], 0
    s_add_u32 s39, s39, 12288
    ds_write2st64_b64 v93, v[148:149], v[196:197] offset0:8 offset1:20
    v_mfma_f32_16x16x32_bf16 v[240:243], a[224:227], v[26:29], 0
    s_waitcnt vmcnt(9) lgkmcnt(3)
    ds_write2st64_b64 v93, v[244:245], v[108:109] offset0:32 offset1:44
    v_mfma_f32_16x16x32_bf16 a[32:35], a[224:227], v[34:37], 0
    buffer_store_dwordx4 v[96:99], v7, s[16:19], s67 offen offset:0 nt
    s_barrier
    v_accvgpr_read_b32 v110, a46
    v_accvgpr_read_b32 v104, a40
    v_accvgpr_read_b32 v111, a47
    v_accvgpr_read_b32 v109, a45
    v_pk_mul_f32 v[110:111], v[110:111], v[94:95] op_sel_hi:[1,0]
    v_exp_f32_e64 v55, v55 clamp
    v_cvt_pk_bf16_f32 v153, v154, v155
    v_mfma_f32_16x16x32_bf16 a[36:39], a[228:231], v[34:37], 0
    s_add_u32 m0, s22, 24576
    ds_read_b128 a[216:219], v0 offset:0
    v_accvgpr_read_b32 v105, a41
    v_fma_f32 v63, v63, s28, v10
    v_cvt_pk_bf16_f32 v205, v206, v207
    v_fma_f32 v59, v59, s28, v9
    v_xor_b32 v93, 96, v93
    v_accvgpr_read_b32 v108, a44
    v_accvgpr_read_b32 v106, a42
    v_mfma_f32_16x16x32_bf16 v[244:247], a[228:231], v[26:29], 0
    ds_write2st64_b64 v93, v[152:153], v[200:201] offset0:8 offset1:20
    v_pk_mul_f32 v[108:109], v[108:109], v[94:95] op_sel_hi:[1,0]
    v_pk_mul_f32 v[104:105], v[104:105], v[94:95] op_sel_hi:[1,0]
    v_cvt_pk_bf16_f32 v253, v254, v255
    v_cvt_pk_bf16_f32 v104, v104, v105
    v_mfma_f32_16x16x32_bf16 v[196:199], a[228:231], v[22:25], 0
    ds_read_b128 a[220:223], v1 offset:0
    buffer_load_dwordx4 v6, s[8:11], s21 offen lds
    v_exp_f32_e64 v83, v83 clamp
    v_mfma_f32_16x16x32_bf16 v[148:151], a[228:231], v[14:17], 0
    v_accvgpr_read_b32 v107, a43
    v_cvt_pk_bf16_f32 v108, v108, v109
    v_mfma_f32_16x16x32_bf16 v[152:155], a[232:235], v[14:17], 0
    s_add_u32 s21, s21, 128
    ds_read_b128 a[224:227], v0 offset:1024
    v_exp_f32_e64 v63, v63 clamp
    v_cvt_pk_bf16_f32 v109, v110, v111
    v_fma_f32 v67, v67, s28, v10
    v_pk_mul_f32 v[106:107], v[106:107], v[94:95] op_sel_hi:[1,0]
    v_cvt_pk_bf16_f32 v157, v158, v159
    v_cvt_pk_bf16_f32 v105, v106, v107
    v_mfma_f32_16x16x32_bf16 v[200:203], a[232:235], v[22:25], 0
    ds_write2st64_b64 v93, v[248:249], v[104:105] offset0:32 offset1:44
    v_mfma_f32_16x16x32_bf16 v[248:251], a[232:235], v[26:29], 0
    s_add_u32 m0, s22, 25600
    v_xor_b32 v93, 32, v93
    v_exp_f32_e64 v67, v67 clamp
    v_mfma_f32_16x16x32_bf16 a[40:43], a[232:235], v[34:37], 0
    ds_write2st64_b64 v93, v[156:157], v[204:205] offset0:8 offset1:20
    v_mfma_f32_16x16x32_bf16 a[44:47], a[236:239], v[34:37], 0
    ds_write2st64_b64 v93, v[252:253], v[108:109] offset0:32 offset1:44
    v_mfma_f32_16x16x32_bf16 v[252:255], a[236:239], v[26:29], 0
    v_exp_f32_e64 v72, v72 clamp
    v_mfma_f32_16x16x32_bf16 v[204:207], a[236:239], v[22:25], 0
    v_exp_f32_e64 v73, v73 clamp
    v_mfma_f32_16x16x32_bf16 v[156:159], a[236:239], v[14:17], 0
    s_waitcnt lgkmcnt(3)
    ds_read_b128 v[84:87], v103 offset:2048
    v_cvt_pk_bf16_f32 v19, v54, v55
    v_mfma_f32_16x16x32_bf16 v[52:55], a[216:219], a[96:99], 0
    v_cvt_pk_bf16_f32 v23, v62, v63
    v_cvt_pk_bf16_f32 v22, v60, v61
    v_mfma_f32_16x16x32_bf16 v[52:55], a[220:223], a[100:103], v[52:55]
    ds_read_b128 a[228:231], v1 offset:1024
    v_cvt_pk_bf16_f32 v30, v68, v69
    v_mfma_f32_16x16x32_bf16 v[52:55], a[224:227], a[104:107], v[52:55]
    ds_read_b128 a[232:235], v0 offset:2048
    buffer_load_dwordx4 v6, s[8:11], s21 offen lds
    v_mfma_f32_16x16x32_bf16 v[60:63], a[224:227], a[128:131], 0
    s_add_u32 s21, s21, 128
    ds_read_b128 a[236:239], v1 offset:2048
    v_cvt_pk_bf16_f32 v35, v78, v79
    v_cvt_pk_bf16_f32 v28, v72, v73
    v_mfma_f32_16x16x32_bf16 v[60:63], a[220:223], a[124:127], v[60:63]
    s_add_u32 m0, s22, 26624
    ds_read_b128 v[96:99], v103 offset:4096
    v_exp_f32_e64 v66, v66 clamp
    v_mfma_f32_16x16x32_bf16 v[60:63], a[216:219], a[120:123], v[60:63]
    ds_read_b128 v[88:91], v103 offset:3072
    v_cvt_pk_bf16_f32 v34, v76, v77
    v_mfma_f32_16x16x32_bf16 v[68:71], a[216:219], a[144:147], 0
    v_exp_f32_e64 v56, v56 clamp
    v_mfma_f32_16x16x32_bf16 v[68:71], a[220:223], a[148:151], v[68:71]
    buffer_load_dwordx4 v6, s[8:11], s21 offen lds
    v_mfma_f32_16x16x32_bf16 v[68:71], a[224:227], a[152:155], v[68:71]
    v_exp_f32_e64 v81, v81 clamp
    v_mfma_f32_16x16x32_bf16 v[76:79], a[224:227], a[176:179], 0
    v_cvt_pk_bf16_f32 v16, v56, v57
    v_cvt_pk_bf16_f32 v21, v66, v67
    v_mfma_f32_16x16x32_bf16 v[76:79], a[220:223], a[172:175], v[76:79]
    s_add_u32 s21, s21, 12032
    v_exp_f32_e64 v59, v59 clamp
    v_mfma_f32_16x16x32_bf16 v[76:79], a[216:219], a[168:171], v[76:79]
    s_waitcnt lgkmcnt(3)
    v_cvt_pk_bf16_f32 v17, v58, v59
    v_cvt_pk_bf16_f32 v29, v74, v75
    v_mfma_f32_16x16x32_bf16 v[76:79], a[228:231], a[180:183], v[76:79]
    s_add_u32 s56, s67, 128
    v_cvt_pk_bf16_f32 v33, v82, v83
    v_cvt_pk_bf16_f32 v32, v80, v81
    v_smfmac_f32_16x16x64_bf16 v[48:51], a[240:243], v[16:23], v101
    s_add_u32 s58, s33, 128
    s_add_u32 m0, s38, 2048
    ds_read_b128 a[216:219], v0 offset:6144
    v_smfmac_f32_16x16x64_bf16 v[48:51], a[244:247], v[28:35], v101
    buffer_load_dwordx4 v6, s[12:15], s58 offen nt lds
    v_mfma_f32_16x16x32_bf16 v[76:79], a[232:235], a[184:187], v[76:79]
    s_add_u32 m0, s38, 3072
    ds_read_b128 a[220:223], v1 offset:6144
    s_waitcnt lgkmcnt(2)
    v_mfma_f32_16x16x32_bf16 v[76:79], a[236:239], a[188:191], v[76:79]
    buffer_load_dwordx4 v7, s[12:15], s58 offen nt lds
    v_mfma_f32_16x16x32_bf16 v[68:71], a[236:239], a[164:167], v[68:71]
    buffer_store_dwordx4 v[84:87], v6, s[16:19], s56 offen offset:0 nt
    v_mfma_f32_16x16x32_bf16 v[68:71], a[232:235], a[160:163], v[68:71]
    ds_read_b128 a[224:227], v0 offset:7168
    s_add_u32 s57, s67, 256
    v_mfma_f32_16x16x32_bf16 v[68:71], a[228:231], a[156:159], v[68:71]
    ds_read_b128 v[84:87], v103 offset:5120
    v_mfma_f32_16x16x32_bf16 v[60:63], a[228:231], a[132:135], v[60:63]
    s_add_u32 s59, s33, 256
    v_mfma_f32_16x16x32_bf16 v[60:63], a[232:235], a[136:139], v[60:63]
    v_cmp_lt_f32 vcc, s29, v48
    s_add_u32 m0, s38, 4096
    v_mfma_f32_16x16x32_bf16 v[60:63], a[236:239], a[140:143], v[60:63]
    buffer_load_dwordx4 v6, s[12:15], s59 offen nt lds
    v_mfma_f32_16x16x32_bf16 v[52:55], a[236:239], a[116:119], v[52:55]
    ds_read_b128 a[236:239], v1 offset:8192
    v_mfma_f32_16x16x32_bf16 v[52:55], a[232:235], a[112:115], v[52:55]
    ds_read_b128 a[232:235], v0 offset:8192
    v_mfma_f32_16x16x32_bf16 v[52:55], a[228:231], a[108:111], v[52:55]
    buffer_store_dwordx4 v[88:91], v7, s[16:19], s56 offen offset:0 nt
    s_add_u32 m0, s38, 5120
    ds_read_b128 a[228:231], v1 offset:7168
    s_waitcnt lgkmcnt(5)
    v_mfma_f32_16x16x32_bf16 v[56:59], a[216:219], a[96:99], 0
    v_mfma_f32_16x16x32_bf16 v[56:59], a[220:223], a[100:103], v[56:59]
    s_cbranch_vccnz L_rs_tr44d
L_ret_tr44d:
    s_waitcnt lgkmcnt(3)
    v_mfma_f32_16x16x32_bf16 v[56:59], a[224:227], a[104:107], v[56:59]
    v_add_u32 v103, 6144, v103
    v_mfma_f32_16x16x32_bf16 v[64:67], a[224:227], a[128:131], 0
    v_fma_f32 v52, v52, s28, v9
    v_fma_f32 v54, v54, s28, v9
    v_mfma_f32_16x16x32_bf16 v[64:67], a[220:223], a[124:127], v[64:67]
    v_fma_f32 v53, v53, s28, v9
    v_fma_f32 v55, v55, s28, v9
    v_mfma_f32_16x16x32_bf16 v[64:67], a[216:219], a[120:123], v[64:67]
    v_exp_f32_e64 v54, v54 clamp
    v_mfma_f32_16x16x32_bf16 v[72:75], a[216:219], a[144:147], 0
    buffer_load_dwordx4 v7, s[12:15], s59 offen nt lds
    v_mfma_f32_16x16x32_bf16 v[72:75], a[220:223], a[148:151], v[72:75]
    buffer_store_dwordx4 v[96:99], v6, s[16:19], s57 offen offset:0 nt
    v_exp_f32_e64 v52, v52 clamp
    s_waitcnt vmcnt(17) lgkmcnt(0)
    v_mfma_f32_16x16x32_bf16 v[72:75], a[224:227], a[152:155], v[72:75]
    s_barrier
    v_mfma_f32_16x16x32_bf16 v[80:83], a[224:227], a[176:179], 0
    s_add_u32 m0, s22, 0
    v_exp_f32_e64 v55, v55 clamp
    v_mfma_f32_16x16x32_bf16 v[80:83], a[220:223], a[172:175], v[80:83]
    v_exp_f32_e64 v53, v53 clamp
    v_mfma_f32_16x16x32_bf16 v[80:83], a[216:219], a[168:171], v[80:83]
    ds_read_b64_tr_b16 a[216:217], v2 offset:18432
    v_mfma_f32_16x16x32_bf16 v[80:83], a[228:231], a[180:183], v[80:83]
    buffer_load_dwordx4 v6, s[4:7], s20 offen lds
    v_mfma_f32_16x16x32_bf16 v[80:83], a[232:235], a[184:187], v[80:83]
    s_add_u32 s20, s20, 128
    ds_read_b64_tr_b16 a[218:219], v2 offset:12288
    v_mfma_f32_16x16x32_bf16 v[80:83], a[236:239], a[188:191], v[80:83]
    s_add_u32 m0, s22, 1024
    v_cvt_pk_bf16_f32 v14, v52, v53
    v_mfma_f32_16x16x32_bf16 v[72:75], a[236:239], a[164:167], v[72:75]
    buffer_load_dwordx4 v6, s[4:7], s20 offen lds
    v_mfma_f32_16x16x32_bf16 v[72:75], a[232:235], a[160:163], v[72:75]
    ds_read_b64_tr_b16 a[220:221], v3 offset:18432
    v_cvt_pk_bf16_f32 v15, v54, v55
    v_mfma_f32_16x16x32_bf16 v[72:75], a[228:231], a[156:159], v[72:75]
    s_add_u32 s20, s20, 128
    ds_read_b64_tr_b16 a[222:223], v3 offset:12288
    v_fma_f32 v60, v60, s28, v10
    v_mfma_f32_16x16x32_bf16 v[64:67], a[228:231], a[132:135], v[64:67]
    ds_read_b64_tr_b16 a[224:225], v4 offset:18432
    v_fma_f32 v61, v61, s28, v10
    v_mfma_f32_16x16x32_bf16 v[64:67], a[232:235], a[136:139], v[64:67]
    ds_read_b64_tr_b16 a[226:227], v4 offset:12288
    v_mfma_f32_16x16x32_bf16 v[64:67], a[236:239], a[140:143], v[64:67]
    s_add_u32 m0, s22, 2048
    v_exp_f32_e64 v61, v61 clamp
    v_mfma_f32_16x16x32_bf16 v[56:59], a[236:239], a[116:119], v[56:59]
    buffer_load_dwordx4 v6, s[4:7], s20 offen lds
    v_mfma_f32_16x16x32_bf16 v[56:59], a[232:235], a[112:115], v[56:59]
    s_add_u32 s20, s20, 12032
    v_exp_f32_e64 v60, v60 clamp
    v_mfma_f32_16x16x32_bf16 v[56:59], a[228:231], a[108:111], v[56:59]
    s_waitcnt lgkmcnt(4)
    ds_read_b64_tr_b16 a[228:229], v5 offset:18432
    ds_read_b64_tr_b16 a[230:231], v5 offset:12288
    buffer_store_dwordx4 v[84:87], v7, s[16:19], s57 offen offset:0 nt
    s_branch L_loop4w0
L_end5:
    v_mfma_f32_16x16x32_bf16 v[112:115], a[216:219], v[16:19], v[112:115]
    ds_read_b64_tr_b16 a[232:233], v2 offset:19456
    v_fma_f32 v75, v75, s28, v11
    v_mfma_f32_16x16x32_bf16 v[116:119], a[220:223], v[16:19], v[116:119]
    v_fma_f32 v65, v65, s28, v10
    v_fma_f32 v90, v90, s28, v13
    v_mfma_f32_16x16x32_bf16 v[164:167], a[220:223], v[20:23], v[164:167]
    v_fma_f32 v66, v66, s28, v10
    v_fma_f32 v64, v64, s28, v10
    v_mfma_f32_16x16x32_bf16 v[160:163], a[216:219], v[20:23], v[160:163]
    v_fma_f32 v80, v80, s28, v12
    v_fma_f32 v70, v70, s28, v11
    v_mfma_f32_16x16x32_bf16 v[208:211], a[216:219], v[28:31], v[208:211]
    ds_read_b64_tr_b16 a[236:237], v3 offset:19456
    v_mfma_f32_16x16x32_bf16 v[212:215], a[220:223], v[28:31], v[212:215]
    ds_read_b64_tr_b16 a[238:239], v3 offset:13312
    v_fma_f32 v81, v81, s28, v12
    v_mfma_f32_16x16x32_bf16 a[4:7], a[220:223], v[32:35], a[4:7]
    v_exp_f32_e64 v65, v65 clamp
    v_mfma_f32_16x16x32_bf16 a[0:3], a[216:219], v[32:35], a[0:3]
    v_exp_f32_e64 v75, v75 clamp
    v_mfma_f32_16x16x32_bf16 a[48:51], a[216:219], v[40:43], a[48:51]
    ds_read_b64_tr_b16 a[234:235], v2 offset:13312
    v_fma_f32 v78, v78, s28, v12
    v_mfma_f32_16x16x32_bf16 a[52:55], a[220:223], v[40:43], a[52:55]
    s_waitcnt lgkmcnt(4)
    v_exp_f32_e64 v90, v90 clamp
    v_mfma_f32_16x16x32_bf16 a[56:59], a[224:227], v[40:43], a[56:59]
    v_mfma_f32_16x16x32_bf16 a[60:63], a[228:231], v[40:43], a[60:63]
    v_fma_f32 v76, v76, s28, v12
    v_fma_f32 v58, v58, s28, v9
    v_mfma_f32_16x16x32_bf16 a[12:15], a[228:231], v[32:35], a[12:15]
    ds_read_b64_tr_b16 a[218:219], v4 offset:13312
    v_fma_f32 v71, v71, s28, v11
    v_mfma_f32_16x16x32_bf16 a[8:11], a[224:227], v[32:35], a[8:11]
    v_fma_f32 v86, v86, s28, v13
    v_fma_f32 v82, v82, s28, v12
    v_mfma_f32_16x16x32_bf16 v[216:219], a[224:227], v[28:31], v[216:219]
    ds_read_b64_tr_b16 a[220:221], v5 offset:19456
    v_fma_f32 v69, v69, s28, v11
    v_mfma_f32_16x16x32_bf16 v[220:223], a[228:231], v[28:31], v[220:223]
    ds_read_b64_tr_b16 a[216:217], v4 offset:19456
    s_add_u32 s39, s39, 12288
    v_mfma_f32_16x16x32_bf16 v[172:175], a[228:231], v[20:23], v[172:175]
    v_exp_f32_e64 v86, v86 clamp
    v_mfma_f32_16x16x32_bf16 v[168:171], a[224:227], v[20:23], v[168:171]
    v_exp_f32_e64 v70, v70 clamp
    v_mfma_f32_16x16x32_bf16 v[120:123], a[224:227], v[16:19], v[120:123]
    v_exp_f32_e64 v78, v78 clamp
    v_mfma_f32_16x16x32_bf16 v[124:127], a[228:231], v[16:19], v[124:127]
    s_waitcnt lgkmcnt(3)
    v_exp_f32_e64 v76, v76 clamp
    v_mfma_f32_16x16x32_bf16 v[128:131], a[232:235], v[16:19], v[128:131]
    ds_read_b64_tr_b16 a[222:223], v5 offset:13312
    v_mfma_f32_16x16x32_bf16 v[132:135], a[236:239], v[16:19], v[132:135]
    v_fma_f32 v68, v68, s28, v11
    v_mfma_f32_16x16x32_bf16 v[180:183], a[236:239], v[20:23], v[180:183]
    ds_read_b64_tr_b16 a[228:229], v3 offset:20480
    v_fma_f32 v56, v56, s28, v9
    v_mfma_f32_16x16x32_bf16 v[176:179], a[232:235], v[20:23], v[176:179]
    v_fma_f32 v57, v57, s28, v9
    v_mfma_f32_16x16x32_bf16 v[224:227], a[232:235], v[28:31], v[224:227]
    ds_read_b64_tr_b16 a[224:225], v2 offset:20480
    v_fma_f32 v74, v74, s28, v11
    v_mfma_f32_16x16x32_bf16 v[228:231], a[236:239], v[28:31], v[228:231]
    v_exp_f32_e64 v74, v74 clamp
    v_mfma_f32_16x16x32_bf16 a[20:23], a[236:239], v[32:35], a[20:23]
    ds_read_b64_tr_b16 a[226:227], v2 offset:14336
    v_fma_f32 v77, v77, s28, v12
    v_mfma_f32_16x16x32_bf16 a[16:19], a[232:235], v[32:35], a[16:19]
    ds_read_b64_tr_b16 a[230:231], v3 offset:14336
    v_mfma_f32_16x16x32_bf16 a[64:67], a[232:235], v[40:43], a[64:67]
    v_fma_f32 v91, v91, s28, v13
    v_fma_f32 v87, v87, s28, v13
    v_mfma_f32_16x16x32_bf16 a[68:71], a[236:239], v[40:43], a[68:71]
    s_waitcnt lgkmcnt(5)
    ds_read_b64_tr_b16 a[236:237], v5 offset:20480
    v_mfma_f32_16x16x32_bf16 a[72:75], a[216:219], v[40:43], a[72:75]
    s_waitcnt lgkmcnt(5)
    v_fma_f32 v88, v88, s28, v13
    v_fma_f32 v72, v72, s28, v11
    v_mfma_f32_16x16x32_bf16 a[76:79], a[220:223], v[40:43], a[76:79]
    ds_read_b64_tr_b16 a[238:239], v5 offset:14336
    v_mfma_f32_16x16x32_bf16 a[28:31], a[220:223], v[32:35], a[28:31]
    v_mfma_f32_16x16x32_bf16 a[24:27], a[216:219], v[32:35], a[24:27]
    v_fma_f32 v67, v67, s28, v10
    v_fma_f32 v79, v79, s28, v12
    v_mfma_f32_16x16x32_bf16 v[232:235], a[216:219], v[28:31], v[232:235]
    v_exp_f32_e64 v72, v72 clamp
    v_mfma_f32_16x16x32_bf16 v[236:239], a[220:223], v[28:31], v[236:239]
    ds_read_b64_tr_b16 a[232:233], v4 offset:20480
    v_fma_f32 v84, v84, s28, v13
    v_mfma_f32_16x16x32_bf16 v[188:191], a[220:223], v[20:23], v[188:191]
    ds_read_b64_tr_b16 a[234:235], v4 offset:14336
    v_fma_f32 v73, v73, s28, v11
    v_mfma_f32_16x16x32_bf16 v[184:187], a[216:219], v[20:23], v[184:187]
    v_mfma_f32_16x16x32_bf16 v[136:139], a[216:219], v[16:19], v[136:139]
    v_exp_f32_e64 v91, v91 clamp
    v_mfma_f32_16x16x32_bf16 v[140:143], a[220:223], v[16:19], v[140:143]
    s_waitcnt lgkmcnt(3)
    v_exp_f32_e64 v58, v58 clamp
    v_mfma_f32_16x16x32_bf16 v[144:147], a[224:227], v[16:19], v[144:147]
    v_exp_f32_e64 v82, v82 clamp
    v_mfma_f32_16x16x32_bf16 v[148:151], a[228:231], v[16:19], v[148:151]
    v_exp_f32_e64 v56, v56 clamp
    v_mfma_f32_16x16x32_bf16 v[196:199], a[228:231], v[20:23], v[196:199]
    v_exp_f32_e64 v66, v66 clamp
    v_mfma_f32_16x16x32_bf16 v[192:195], a[224:227], v[20:23], v[192:195]
    v_exp_f32_e64 v68, v68 clamp
    v_mfma_f32_16x16x32_bf16 v[240:243], a[224:227], v[28:31], v[240:243]
    v_exp_f32_e64 v87, v87 clamp
    v_mfma_f32_16x16x32_bf16 v[244:247], a[228:231], v[28:31], v[244:247]
    v_exp_f32_e64 v69, v69 clamp
    v_mfma_f32_16x16x32_bf16 a[36:39], a[228:231], v[32:35], a[36:39]
    v_exp_f32_e64 v67, v67 clamp
    v_mfma_f32_16x16x32_bf16 a[32:35], a[224:227], v[32:35], a[32:35]
    s_waitcnt vmcnt(10) lgkmcnt(0)
    v_exp_f32_e64 v88, v88 clamp
    v_mfma_f32_16x16x32_bf16 a[80:83], a[224:227], v[40:43], a[80:83]
    v_exp_f32_e64 v71, v71 clamp
    v_mfma_f32_16x16x32_bf16 a[84:87], a[228:231], v[40:43], a[84:87]
    s_barrier
    ds_read_b128 a[216:219], v0 offset:12288
    v_mfma_f32_16x16x32_bf16 a[88:91], a[232:235], v[40:43], a[88:91]
    ds_read_b128 a[220:223], v1 offset:12288
    s_add_u32 m0, s22, 36864
    v_mfma_f32_16x16x32_bf16 a[92:95], a[236:239], v[40:43], a[92:95]
    ds_read_b128 a[224:227], v0 offset:13312
    v_mfma_f32_16x16x32_bf16 a[44:47], a[236:239], v[32:35], a[44:47]
    buffer_load_dwordx4 v6, s[8:11], s21 offen lds
    v_mfma_f32_16x16x32_bf16 a[40:43], a[232:235], v[32:35], a[40:43]
    s_add_u32 s21, s21, 128
    v_exp_f32_e64 v79, v79 clamp
    v_mfma_f32_16x16x32_bf16 v[248:251], a[232:235], v[28:31], v[248:251]
    s_add_u32 m0, s22, 37888
    v_cvt_pk_bf16_f32 v27, v70, v71
    v_cvt_pk_bf16_f32 v39, v86, v87
    v_mfma_f32_16x16x32_bf16 v[252:255], a[236:239], v[28:31], v[252:255]
    buffer_load_dwordx4 v6, s[8:11], s21 offen lds
    v_mfma_f32_16x16x32_bf16 v[204:207], a[236:239], v[20:23], v[204:207]
    s_add_u32 s21, s21, 128
    ds_read_b128 a[228:231], v1 offset:13312
    s_add_u32 m0, s22, 38912
    v_mfma_f32_16x16x32_bf16 v[200:203], a[232:235], v[20:23], v[200:203]
    buffer_load_dwordx4 v6, s[8:11], s21 offen lds
    v_mfma_f32_16x16x32_bf16 v[152:155], a[232:235], v[16:19], v[152:155]
    v_cvt_pk_bf16_f32 v22, v60, v61
    v_cvt_pk_bf16_f32 v23, v62, v63
    v_mfma_f32_16x16x32_bf16 v[156:159], a[236:239], v[16:19], v[156:159]
    s_waitcnt lgkmcnt(3)
    v_exp_f32_e64 v84, v84 clamp
    v_mfma_f32_16x16x32_bf16 v[52:55], a[216:219], a[96:99], 0
    s_waitcnt lgkmcnt(2)
    v_cvt_pk_bf16_f32 v35, v78, v79
    v_mfma_f32_16x16x32_bf16 v[52:55], a[220:223], a[100:103], v[52:55]
    s_waitcnt lgkmcnt(1)
    v_fma_f32 v85, v85, s28, v13
    v_mfma_f32_16x16x32_bf16 v[52:55], a[224:227], a[104:107], v[52:55]
    v_exp_f32_e64 v77, v77 clamp
    v_mfma_f32_16x16x32_bf16 v[60:63], a[224:227], a[128:131], 0
    v_exp_f32_e64 v73, v73 clamp
    v_mfma_f32_16x16x32_bf16 v[60:63], a[220:223], a[124:127], v[60:63]
    ds_read_b128 a[232:235], v0 offset:14336
    v_fma_f32 v83, v83, s28, v12
    v_mfma_f32_16x16x32_bf16 v[60:63], a[216:219], a[120:123], v[60:63]
    v_cvt_pk_bf16_f32 v26, v68, v69
    v_fma_f32 v89, v89, s28, v13
    v_mfma_f32_16x16x32_bf16 v[68:71], a[216:219], a[144:147], 0
    ds_read_b128 a[236:239], v1 offset:14336
    v_cvt_pk_bf16_f32 v34, v76, v77
    v_mfma_f32_16x16x32_bf16 v[68:71], a[220:223], a[148:151], v[68:71]
    v_exp_f32_e64 v83, v83 clamp
    v_mfma_f32_16x16x32_bf16 v[68:71], a[224:227], a[152:155], v[68:71]
    v_mfma_f32_16x16x32_bf16 v[76:79], a[224:227], a[176:179], 0
    v_exp_f32_e64 v81, v81 clamp
    v_mfma_f32_16x16x32_bf16 v[76:79], a[220:223], a[172:175], v[76:79]
    v_exp_f32_e64 v85, v85 clamp
    v_mfma_f32_16x16x32_bf16 v[76:79], a[216:219], a[168:171], v[76:79]
    v_cvt_pk_bf16_f32 v38, v84, v85
    v_cvt_pk_bf16_f32 v37, v82, v83
    v_mfma_f32_16x16x32_bf16 v[84:87], a[216:219], a[192:195], 0
    v_exp_f32_e64 v80, v80 clamp
    v_mfma_f32_16x16x32_bf16 v[84:87], a[220:223], a[196:199], v[84:87]
    v_exp_f32_e64 v64, v64 clamp
    v_mfma_f32_16x16x32_bf16 v[84:87], a[224:227], a[200:203], v[84:87]
    s_waitcnt lgkmcnt(1)
    v_cvt_pk_bf16_f32 v41, v90, v91
    v_mfma_f32_16x16x32_bf16 v[84:87], a[228:231], a[204:207], v[84:87]
    v_mfma_f32_16x16x32_bf16 v[84:87], a[232:235], a[208:211], v[84:87]
    s_waitcnt lgkmcnt(0)
    ds_read_b128 a[216:219], v0 offset:18432
    v_mfma_f32_16x16x32_bf16 v[84:87], a[236:239], a[212:215], v[84:87]
    v_cvt_pk_bf16_f32 v28, v72, v73
    v_mfma_f32_16x16x32_bf16 v[76:79], a[236:239], a[188:191], v[76:79]
    v_exp_f32_e64 v57, v57 clamp
    v_mfma_f32_16x16x32_bf16 v[76:79], a[232:235], a[184:187], v[76:79]
    v_exp_f32_e64 v89, v89 clamp
    v_mfma_f32_16x16x32_bf16 v[76:79], a[228:231], a[180:183], v[76:79]
    v_cvt_pk_bf16_f32 v25, v66, v67
    v_mfma_f32_16x16x32_bf16 v[68:71], a[228:231], a[156:159], v[68:71]
    v_cvt_pk_bf16_f32 v16, v56, v57
    v_cvt_pk_bf16_f32 v36, v80, v81
    v_mfma_f32_16x16x32_bf16 v[68:71], a[232:235], a[160:163], v[68:71]
    ds_read_b128 a[220:223], v1 offset:18432
    v_mfma_f32_16x16x32_bf16 v[68:71], a[236:239], a[164:167], v[68:71]
    ds_read_b128 a[224:227], v0 offset:19456
    v_fma_f32 v59, v59, s28, v9
    v_mfma_f32_16x16x32_bf16 v[60:63], a[236:239], a[140:143], v[60:63]
    v_cvt_pk_bf16_f32 v40, v88, v89
    v_mfma_f32_16x16x32_bf16 v[60:63], a[232:235], a[136:139], v[60:63]
    v_cvt_pk_bf16_f32 v24, v64, v65
    v_mfma_f32_16x16x32_bf16 v[60:63], a[228:231], a[132:135], v[60:63]
    v_exp_f32_e64 v59, v59 clamp
    v_mfma_f32_16x16x32_bf16 v[52:55], a[228:231], a[108:111], v[52:55]
    v_cvt_pk_bf16_f32 v17, v58, v59
    v_mfma_f32_16x16x32_bf16 v[52:55], a[232:235], a[112:115], v[52:55]
    v_cvt_pk_bf16_f32 v29, v74, v75
    v_mfma_f32_16x16x32_bf16 v[44:47], a[248:251], v[14:17], v[44:47]
    ds_read_b128 a[232:235], v0 offset:20480
    v_mfma_f32_16x16x32_bf16 v[52:55], a[236:239], a[116:119], v[52:55]
    ds_read_b128 a[228:231], v1 offset:19456
    v_smfmac_f32_16x16x64_bf16 v[44:47], a[240:243], v[22:29], v101
    ds_read_b128 a[236:239], v1 offset:20480
    v_smfmac_f32_16x16x64_bf16 v[44:47], a[244:247], v[34:41], v101
    s_waitcnt lgkmcnt(4)
    v_mfma_f32_16x16x32_bf16 v[56:59], a[216:219], a[96:99], 0
    v_mfma_f32_16x16x32_bf16 v[56:59], a[220:223], a[100:103], v[56:59]
    s_add_u32 s21, s21, 12032
    s_waitcnt lgkmcnt(3)
    v_mfma_f32_16x16x32_bf16 v[56:59], a[224:227], a[104:107], v[56:59]
    s_nop 1
    v_cmp_lt_f32 vcc, s29, v44
    v_mfma_f32_16x16x32_bf16 v[64:67], a[224:227], a[128:131], 0
    v_mfma_f32_16x16x32_bf16 v[64:67], a[220:223], a[124:127], v[64:67]
    v_mfma_f32_16x16x32_bf16 v[64:67], a[216:219], a[120:123], v[64:67]
    v_mfma_f32_16x16x32_bf16 v[72:75], a[216:219], a[144:147], 0
    v_mfma_f32_16x16x32_bf16 v[72:75], a[220:223], a[148:151], v[72:75]
    s_cbranch_vccnz L_rs_end5a
L_ret_end5a:
    v_fma_f32 v54, v54, s28, v9
    v_mfma_f32_16x16x32_bf16 v[72:75], a[224:227], a[152:155], v[72:75]
    s_waitcnt vmcnt(6) lgkmcnt(0)
    v_fma_f32 v61, v61, s28, v10
    v_fma_f32 v53, v53, s28, v9
    v_mfma_f32_16x16x32_bf16 v[80:83], a[224:227], a[176:179], 0
    s_barrier
    v_mfma_f32_16x16x32_bf16 v[80:83], a[220:223], a[172:175], v[80:83]
    v_fma_f32 v60, v60, s28, v10
    v_mfma_f32_16x16x32_bf16 v[80:83], a[216:219], a[168:171], v[80:83]
    v_fma_f32 v62, v62, s28, v10
    v_fma_f32 v55, v55, s28, v9
    v_mfma_f32_16x16x32_bf16 v[88:91], a[216:219], a[192:195], 0
    ds_read_b64_tr_b16 a[216:217], v2 offset:0
    v_mfma_f32_16x16x32_bf16 v[88:91], a[220:223], a[196:199], v[88:91]
    ds_read_b64_tr_b16 a[218:219], v2 offset:6144
    v_fma_f32 v63, v63, s28, v10
    v_mfma_f32_16x16x32_bf16 v[88:91], a[224:227], a[200:203], v[88:91]
    v_mfma_f32_16x16x32_bf16 v[88:91], a[228:231], a[204:207], v[88:91]
    v_exp_f32_e64 v55, v55 clamp
    v_mfma_f32_16x16x32_bf16 v[88:91], a[232:235], a[208:211], v[88:91]
    ds_read_b64_tr_b16 a[220:221], v3 offset:0
    v_fma_f32 v52, v52, s28, v9
    v_mfma_f32_16x16x32_bf16 v[88:91], a[236:239], a[212:215], v[88:91]
    v_mfma_f32_16x16x32_bf16 v[80:83], a[236:239], a[188:191], v[80:83]
    v_exp_f32_e64 v63, v63 clamp
    v_mfma_f32_16x16x32_bf16 v[80:83], a[232:235], a[184:187], v[80:83]
    ds_read_b64_tr_b16 a[222:223], v3 offset:6144
    v_mfma_f32_16x16x32_bf16 v[80:83], a[228:231], a[180:183], v[80:83]
    v_exp_f32_e64 v61, v61 clamp
    v_mfma_f32_16x16x32_bf16 v[72:75], a[228:231], a[156:159], v[72:75]
    v_exp_f32_e64 v52, v52 clamp
    v_mfma_f32_16x16x32_bf16 v[72:75], a[232:235], a[160:163], v[72:75]
    v_exp_f32_e64 v53, v53 clamp
    v_mfma_f32_16x16x32_bf16 v[72:75], a[236:239], a[164:167], v[72:75]
    v_exp_f32_e64 v54, v54 clamp
    v_mfma_f32_16x16x32_bf16 v[64:67], a[236:239], a[140:143], v[64:67]
    ds_read_b64_tr_b16 a[224:225], v4 offset:0
    v_mfma_f32_16x16x32_bf16 v[64:67], a[232:235], a[136:139], v[64:67]
    v_exp_f32_e64 v60, v60 clamp
    v_mfma_f32_16x16x32_bf16 v[64:67], a[228:231], a[132:135], v[64:67]
    v_exp_f32_e64 v62, v62 clamp
    v_mfma_f32_16x16x32_bf16 v[56:59], a[228:231], a[108:111], v[56:59]
    ds_read_b64_tr_b16 a[226:227], v4 offset:6144
    v_mfma_f32_16x16x32_bf16 v[56:59], a[232:235], a[112:115], v[56:59]
    ds_read_b64_tr_b16 a[228:229], v5 offset:0
    v_cvt_pk_bf16_f32 v19, v54, v55
    v_mfma_f32_16x16x32_bf16 v[56:59], a[236:239], a[116:119], v[56:59]
    s_waitcnt lgkmcnt(3)
    ds_read_b64_tr_b16 a[230:231], v5 offset:6144
    v_cvt_pk_bf16_f32 v18, v52, v53
    v_mfma_f32_16x16x32_bf16 v[112:115], a[216:219], v[14:17], v[112:115]
    s_add_u32 s39, s39, 12288
    v_fma_f32 v86, v86, s28, v13
    v_fma_f32 v78, v78, s28, v12
    v_mfma_f32_16x16x32_bf16 v[116:119], a[220:223], v[14:17], v[116:119]
    s_waitcnt vmcnt(0)
    v_exp_f32_e64 v86, v86 clamp
    v_mfma_f32_16x16x32_bf16 v[164:167], a[220:223], v[22:25], v[164:167]
    s_barrier
    v_mfma_f32_16x16x32_bf16 v[160:163], a[216:219], v[22:25], v[160:163]
    v_exp_f32_e64 v78, v78 clamp
    v_fma_f32 v65, v65, s28, v10
    v_mfma_f32_16x16x32_bf16 v[208:211], a[216:219], v[26:29], v[208:211]
    v_fma_f32 v80, v80, s28, v12
    v_fma_f32 v81, v81, s28, v12
    v_mfma_f32_16x16x32_bf16 v[212:215], a[220:223], v[26:29], v[212:215]
    v_fma_f32 v66, v66, s28, v10
    v_fma_f32 v90, v90, s28, v13
    v_mfma_f32_16x16x32_bf16 a[4:7], a[220:223], v[34:37], a[4:7]
    ds_read_b64_tr_b16 a[234:235], v2 offset:7168
    v_fma_f32 v91, v91, s28, v13
    v_mfma_f32_16x16x32_bf16 a[0:3], a[216:219], v[34:37], a[0:3]
    ds_read_b64_tr_b16 a[232:233], v2 offset:1024
    v_fma_f32 v58, v58, s28, v9
    v_mfma_f32_16x16x32_bf16 a[48:51], a[216:219], v[38:41], a[48:51]
    v_fma_f32 v84, v84, s28, v13
    v_fma_f32 v76, v76, s28, v12
    v_mfma_f32_16x16x32_bf16 a[52:55], a[220:223], v[38:41], a[52:55]
    s_waitcnt lgkmcnt(2)
    v_fma_f32 v64, v64, s28, v10
    v_fma_f32 v89, v89, s28, v13
    v_mfma_f32_16x16x32_bf16 a[56:59], a[224:227], v[38:41], a[56:59]
    ds_read_b64_tr_b16 a[236:237], v3 offset:1024
    v_fma_f32 v85, v85, s28, v13
    v_mfma_f32_16x16x32_bf16 a[60:63], a[228:231], v[38:41], a[60:63]
    ds_read_b64_tr_b16 a[238:239], v3 offset:7168
    v_fma_f32 v87, v87, s28, v13
    v_mfma_f32_16x16x32_bf16 a[12:15], a[228:231], v[34:37], a[12:15]
    v_fma_f32 v72, v72, s28, v11
    v_fma_f32 v73, v73, s28, v11
    v_mfma_f32_16x16x32_bf16 a[8:11], a[224:227], v[34:37], a[8:11]
    v_fma_f32 v67, v67, s28, v10
    v_fma_f32 v88, v88, s28, v13
    v_exp_f32_e64 v87, v87 clamp
    v_mfma_f32_16x16x32_bf16 v[216:219], a[224:227], v[26:29], v[216:219]
    ds_read_b64_tr_b16 a[222:223], v5 offset:7168
    v_exp_f32_e64 v72, v72 clamp
    v_mfma_f32_16x16x32_bf16 v[220:223], a[228:231], v[26:29], v[220:223]
    v_exp_f32_e64 v58, v58 clamp
    v_mfma_f32_16x16x32_bf16 v[172:175], a[228:231], v[22:25], v[172:175]
    v_exp_f32_e64 v65, v65 clamp
    v_mfma_f32_16x16x32_bf16 v[168:171], a[224:227], v[22:25], v[168:171]
    ds_read_b64_tr_b16 a[216:217], v4 offset:1024
    v_exp_f32_e64 v76, v76 clamp
    v_mfma_f32_16x16x32_bf16 v[120:123], a[224:227], v[14:17], v[120:123]
    ds_read_b64_tr_b16 a[218:219], v4 offset:7168
    v_fma_f32 v75, v75, s28, v11
    v_mfma_f32_16x16x32_bf16 v[124:127], a[228:231], v[14:17], v[124:127]
    s_waitcnt lgkmcnt(4)
    v_fma_f32 v82, v82, s28, v12
    v_fma_f32 v57, v57, s28, v9
    v_mfma_f32_16x16x32_bf16 v[128:131], a[232:235], v[14:17], v[128:131]
    s_waitcnt lgkmcnt(3)
    ds_read_b64_tr_b16 a[220:221], v5 offset:1024
    v_fma_f32 v79, v79, s28, v12
    v_mfma_f32_16x16x32_bf16 v[132:135], a[236:239], v[14:17], v[132:135]
    v_exp_f32_e64 v64, v64 clamp
    v_mfma_f32_16x16x32_bf16 v[180:183], a[236:239], v[22:25], v[180:183]
    ds_read_b64_tr_b16 a[226:227], v2 offset:8192
    v_exp_f32_e64 v73, v73 clamp
    v_mfma_f32_16x16x32_bf16 v[176:179], a[232:235], v[22:25], v[176:179]
    v_fma_f32 v56, v56, s28, v9
    v_exp_f32_e64 v84, v84 clamp
    v_mfma_f32_16x16x32_bf16 v[224:227], a[232:235], v[26:29], v[224:227]
    v_exp_f32_e64 v89, v89 clamp
    v_mfma_f32_16x16x32_bf16 v[228:231], a[236:239], v[26:29], v[228:231]
    v_exp_f32_e64 v81, v81 clamp
    v_mfma_f32_16x16x32_bf16 a[20:23], a[236:239], v[34:37], a[20:23]
    v_exp_f32_e64 v82, v82 clamp
    v_mfma_f32_16x16x32_bf16 a[16:19], a[232:235], v[34:37], a[16:19]
    ds_read_b64_tr_b16 a[224:225], v2 offset:2048
    v_fma_f32 v59, v59, s28, v9
    v_mfma_f32_16x16x32_bf16 a[64:67], a[232:235], v[38:41], a[64:67]
    v_fma_f32 v77, v77, s28, v12
    v_fma_f32 v68, v68, s28, v11
    v_mfma_f32_16x16x32_bf16 a[68:71], a[236:239], v[38:41], a[68:71]
    s_waitcnt lgkmcnt(3)
    ds_read_b64_tr_b16 a[230:231], v3 offset:8192
    v_fma_f32 v70, v70, s28, v11
    v_mfma_f32_16x16x32_bf16 a[72:75], a[216:219], v[38:41], a[72:75]
    s_waitcnt lgkmcnt(3)
    ds_read_b64_tr_b16 a[228:229], v3 offset:2048
    v_exp_f32_e64 v67, v67 clamp
    v_mfma_f32_16x16x32_bf16 a[76:79], a[220:223], v[38:41], a[76:79]
    v_exp_f32_e64 v91, v91 clamp
    v_mfma_f32_16x16x32_bf16 a[28:31], a[220:223], v[34:37], a[28:31]
    ds_read_b64_tr_b16 a[238:239], v5 offset:8192
    v_fma_f32 v71, v71, s28, v11
    v_mfma_f32_16x16x32_bf16 a[24:27], a[216:219], v[34:37], a[24:27]
    v_exp_f32_e64 v68, v68 clamp
    v_mfma_f32_16x16x32_bf16 v[232:235], a[216:219], v[26:29], v[232:235]
    v_fma_f32 v74, v74, s28, v11
    v_exp_f32_e64 v59, v59 clamp
    v_mfma_f32_16x16x32_bf16 v[236:239], a[220:223], v[26:29], v[236:239]
    ds_read_b64_tr_b16 a[234:235], v4 offset:8192
    v_exp_f32_e64 v85, v85 clamp
    v_mfma_f32_16x16x32_bf16 v[188:191], a[220:223], v[22:25], v[188:191]
    ds_read_b64_tr_b16 a[232:233], v4 offset:2048
    v_fma_f32 v69, v69, s28, v11
    v_fma_f32 v83, v83, s28, v12
    v_mfma_f32_16x16x32_bf16 v[184:187], a[216:219], v[22:25], v[184:187]
    v_exp_f32_e64 v77, v77 clamp
    v_mfma_f32_16x16x32_bf16 v[136:139], a[216:219], v[14:17], v[136:139]
    v_exp_f32_e64 v69, v69 clamp
    v_mfma_f32_16x16x32_bf16 v[140:143], a[220:223], v[14:17], v[140:143]
    s_waitcnt lgkmcnt(3)
    ds_read_b64_tr_b16 a[236:237], v5 offset:2048
    v_exp_f32_e64 v80, v80 clamp
    v_mfma_f32_16x16x32_bf16 v[144:147], a[224:227], v[14:17], v[144:147]
    v_exp_f32_e64 v70, v70 clamp
    v_mfma_f32_16x16x32_bf16 v[148:151], a[228:231], v[14:17], v[148:151]
    v_exp_f32_e64 v57, v57 clamp
    v_mfma_f32_16x16x32_bf16 v[196:199], a[228:231], v[22:25], v[196:199]
    v_exp_f32_e64 v75, v75 clamp
    v_mfma_f32_16x16x32_bf16 v[192:195], a[224:227], v[22:25], v[192:195]
    v_exp_f32_e64 v83, v83 clamp
    v_mfma_f32_16x16x32_bf16 v[240:243], a[224:227], v[26:29], v[240:243]
    v_exp_f32_e64 v66, v66 clamp
    v_mfma_f32_16x16x32_bf16 v[244:247], a[228:231], v[26:29], v[244:247]
    ds_read_b64_tr_b16 a[216:217], v2 offset:18432
    v_cvt_pk_bf16_f32 v21, v66, v67
    v_mfma_f32_16x16x32_bf16 a[36:39], a[228:231], v[34:37], a[36:39]
    v_exp_f32_e64 v71, v71 clamp
    v_cvt_pk_bf16_f32 v43, v86, v87
    v_mfma_f32_16x16x32_bf16 a[32:35], a[224:227], v[34:37], a[32:35]
    v_cvt_pk_bf16_f32 v20, v64, v65
    v_exp_f32_e64 v88, v88 clamp
    v_mfma_f32_16x16x32_bf16 a[80:83], a[224:227], v[38:41], a[80:83]
    ds_read_b64_tr_b16 a[218:219], v2 offset:12288
    v_cvt_pk_bf16_f32 v32, v80, v81
    v_mfma_f32_16x16x32_bf16 a[84:87], a[228:231], v[38:41], a[84:87]
    s_waitcnt lgkmcnt(2)
    ds_read_b64_tr_b16 a[220:221], v3 offset:18432
    v_cvt_pk_bf16_f32 v42, v84, v85
    v_mfma_f32_16x16x32_bf16 a[88:91], a[232:235], v[38:41], a[88:91]
    v_exp_f32_e64 v56, v56 clamp
    v_mfma_f32_16x16x32_bf16 a[92:95], a[236:239], v[38:41], a[92:95]
    v_exp_f32_e64 v79, v79 clamp
    v_mfma_f32_16x16x32_bf16 a[44:47], a[236:239], v[34:37], a[44:47]
    v_exp_f32_e64 v74, v74 clamp
    v_mfma_f32_16x16x32_bf16 a[40:43], a[232:235], v[34:37], a[40:43]
    ds_read_b64_tr_b16 a[222:223], v3 offset:12288
    v_cvt_pk_bf16_f32 v31, v70, v71
    v_mfma_f32_16x16x32_bf16 v[248:251], a[232:235], v[26:29], v[248:251]
    ds_read_b64_tr_b16 a[224:225], v4 offset:18432
    v_cvt_pk_bf16_f32 v30, v68, v69
    v_mfma_f32_16x16x32_bf16 v[252:255], a[236:239], v[26:29], v[252:255]
    v_exp_f32_e64 v90, v90 clamp
    v_cvt_pk_bf16_f32 v40, v88, v89
    v_mfma_f32_16x16x32_bf16 v[204:207], a[236:239], v[22:25], v[204:207]
    v_cvt_pk_bf16_f32 v29, v74, v75
    v_cvt_pk_bf16_f32 v28, v72, v73
    v_mfma_f32_16x16x32_bf16 v[200:203], a[232:235], v[22:25], v[200:203]
    v_cvt_pk_bf16_f32 v22, v60, v61
    v_cvt_pk_bf16_f32 v34, v76, v77
    v_mfma_f32_16x16x32_bf16 v[152:155], a[232:235], v[14:17], v[152:155]
    v_cvt_pk_bf16_f32 v33, v82, v83
    v_cvt_pk_bf16_f32 v23, v62, v63
    v_mfma_f32_16x16x32_bf16 v[156:159], a[236:239], v[14:17], v[156:159]
    v_cvt_pk_bf16_f32 v16, v56, v57
    v_cvt_pk_bf16_f32 v17, v58, v59
    v_cvt_pk_bf16_f32 v41, v90, v91
    v_cvt_pk_bf16_f32 v35, v78, v79
    v_smfmac_f32_16x16x64_bf16 v[48:51], a[240:243], v[16:23], v101
    ds_read_b64_tr_b16 a[226:227], v4 offset:12288
    v_smfmac_f32_16x16x64_bf16 v[48:51], a[244:247], v[28:35], v101
    ds_read_b64_tr_b16 a[228:229], v5 offset:18432
    v_mfma_f32_16x16x32_bf16 v[48:51], a[248:251], v[40:43], v[48:51]
    s_waitcnt lgkmcnt(3)
    ds_read_b64_tr_b16 a[230:231], v5 offset:12288
    s_nop 5
    v_cmp_lt_f32 vcc, s29, v48
    s_nop 4
    s_cbranch_vccnz L_rs_end5b
L_ret_end5b:
    v_lshrrev_b32 v108, 11, v0
    v_and_b32 v93, 0x3ff, v0
    v_xor_b32 v108, s65, v108
    v_lshl_add_u32 v93, v108, 10, v93
    v_mbcnt_lo_u32_b32 v108, -1, 0
    v_mbcnt_hi_u32_b32 v108, -1, v108
    v_mov_b32 v111, v46
    v_lshrrev_b32 v108, 1, v108
    v_and_b32 v108, 24, v108
    v_mov_b32 v110, v45
    v_permlane16_swap_b32 v46, v111
    v_add_u32 v93, s38, v93
    v_mov_b32 v109, v50
    v_permlane16_swap_b32 v45, v110
    v_add_f32 v46, v46, v111
    v_bfe_u32 v108, s66, v108, 8
    v_xor_b32 v93, v93, v108
    v_mov_b32 v108, v49
    v_permlane16_swap_b32 v50, v109
    v_mov_b32 v111, v46
    v_permlane16_swap_b32 v49, v108
    v_add_f32 v45, v45, v110
    v_permlane32_swap_b32 v46, v111
    v_add_f32 v49, v49, v108
    v_mov_b32 v110, v45
    v_add_f32 v50, v50, v109
    v_mov_b32 v109, v50
    v_permlane32_swap_b32 v45, v110
    v_mov_b32 v108, v49
    v_permlane32_swap_b32 v50, v109
    v_add_f32 v100, v51, v111
    v_add_f32 v50, v50, v110
    v_add_f32 v94, v109, v46
    v_permlane32_swap_b32 v49, v108
    v_add_f32 v48, v49, v47
    v_rcp_f32 v94, v94
    v_add_f32 v92, v108, v45
    v_rcp_f32 v100, v100
    v_rcp_f32 v50, v50
    v_rcp_f32 v92, v92
    v_rcp_f32 v48, v48
    v_mfma_f32_16x16x32_bf16 v[112:115], a[216:219], v[16:19], v[112:115]
    v_xor_b32 v95, 32, v93
    v_mfma_f32_16x16x32_bf16 v[116:119], a[220:223], v[16:19], v[116:119]
    v_mfma_f32_16x16x32_bf16 v[164:167], a[220:223], v[20:23], v[164:167]
    v_mfma_f32_16x16x32_bf16 v[160:163], a[216:219], v[20:23], v[160:163]
    s_add_u32 s84, s34, 0
    ds_read_b64_tr_b16 a[232:233], v2 offset:19456
    v_mfma_f32_16x16x32_bf16 v[208:211], a[216:219], v[28:31], v[208:211]
    v_mfma_f32_16x16x32_bf16 v[212:215], a[220:223], v[28:31], v[212:215]
    ds_read_b64_tr_b16 a[234:235], v2 offset:13312
    v_mfma_f32_16x16x32_bf16 a[4:7], a[220:223], v[32:35], a[4:7]
    v_mfma_f32_16x16x32_bf16 a[0:3], a[216:219], v[32:35], a[0:3]
    v_subrev_u32 v103, 28672, v103
    s_add_u32 s85, s34, 6144
    v_mfma_f32_16x16x32_bf16 a[48:51], a[216:219], v[40:43], a[48:51]
    v_mfma_f32_16x16x32_bf16 a[52:55], a[220:223], v[40:43], a[52:55]
    s_waitcnt lgkmcnt(2)
    ds_read_b64_tr_b16 a[238:239], v3 offset:13312
    v_mfma_f32_16x16x32_bf16 a[56:59], a[224:227], v[40:43], a[56:59]
    ds_read_b64_tr_b16 a[236:237], v3 offset:19456
    v_mfma_f32_16x16x32_bf16 a[60:63], a[228:231], v[40:43], a[60:63]
    v_mfma_f32_16x16x32_bf16 a[12:15], a[228:231], v[32:35], a[12:15]
    ds_read_b64_tr_b16 a[222:223], v5 offset:13312
    v_mfma_f32_16x16x32_bf16 a[8:11], a[224:227], v[32:35], a[8:11]
    ds_read_b64_tr_b16 a[218:219], v4 offset:13312
    v_accvgpr_read_b32 v105, a1
    v_mfma_f32_16x16x32_bf16 v[216:219], a[224:227], v[28:31], v[216:219]
    ds_read_b64_tr_b16 a[220:221], v5 offset:19456
    v_mfma_f32_16x16x32_bf16 v[220:223], a[228:231], v[28:31], v[220:223]
    v_mfma_f32_16x16x32_bf16 v[172:175], a[228:231], v[20:23], v[172:175]
    v_mfma_f32_16x16x32_bf16 v[168:171], a[224:227], v[20:23], v[168:171]
    ds_read_b64_tr_b16 a[216:217], v4 offset:19456
    v_mfma_f32_16x16x32_bf16 v[120:123], a[224:227], v[16:19], v[120:123]
    ds_read_b64_tr_b16 a[224:225], v2 offset:20480
    v_mfma_f32_16x16x32_bf16 v[124:127], a[228:231], v[16:19], v[124:127]
    s_waitcnt lgkmcnt(6)
    ds_read_b64_tr_b16 a[226:227], v2 offset:14336
    v_mfma_f32_16x16x32_bf16 v[128:131], a[232:235], v[16:19], v[128:131]
    s_waitcnt lgkmcnt(6)
    v_accvgpr_read_b32 v107, a3
    v_mfma_f32_16x16x32_bf16 v[132:135], a[236:239], v[16:19], v[132:135]
    v_mfma_f32_16x16x32_bf16 v[180:183], a[236:239], v[20:23], v[180:183]
    s_add_u32 s86, s34, 12288
    v_accvgpr_read_b32 v52, a8
    v_accvgpr_read_b32 v56, a12
    v_mfma_f32_16x16x32_bf16 v[176:179], a[232:235], v[20:23], v[176:179]
    v_mfma_f32_16x16x32_bf16 v[224:227], a[232:235], v[28:31], v[224:227]
    v_mfma_f32_16x16x32_bf16 v[228:231], a[236:239], v[28:31], v[228:231]
    v_accvgpr_read_b32 v54, a10
    v_accvgpr_read_b32 v109, a5
    v_mfma_f32_16x16x32_bf16 a[20:23], a[236:239], v[32:35], a[20:23]
    v_mfma_f32_16x16x32_bf16 a[16:19], a[232:235], v[32:35], a[16:19]
    v_accvgpr_read_b32 v57, a13
    v_mfma_f32_16x16x32_bf16 a[64:67], a[232:235], v[40:43], a[64:67]
    v_mfma_f32_16x16x32_bf16 a[68:71], a[236:239], v[40:43], a[68:71]
    s_waitcnt lgkmcnt(0)
    v_mfma_f32_16x16x32_bf16 a[72:75], a[216:219], v[40:43], a[72:75]
    ds_read_b64_tr_b16 a[232:233], v4 offset:20480
    v_mfma_f32_16x16x32_bf16 a[76:79], a[220:223], v[40:43], a[76:79]
    s_add_u32 s87, s34, 18432
    v_mfma_f32_16x16x32_bf16 a[28:31], a[220:223], v[32:35], a[28:31]
    ds_read_b64_tr_b16 a[238:239], v5 offset:14336
    v_accvgpr_read_b32 v55, a11
    v_mfma_f32_16x16x32_bf16 a[24:27], a[216:219], v[32:35], a[24:27]
    ds_read_b64_tr_b16 a[228:229], v3 offset:20480
    v_xor_b32 v8, 64, v93
    v_mfma_f32_16x16x32_bf16 v[232:235], a[216:219], v[28:31], v[232:235]
    ds_read_b64_tr_b16 a[230:231], v3 offset:14336
    v_accvgpr_read_b32 v59, a15
    v_mfma_f32_16x16x32_bf16 v[236:239], a[220:223], v[28:31], v[236:239]
    ds_read_b64_tr_b16 a[236:237], v5 offset:20480
    v_mfma_f32_16x16x32_bf16 v[188:191], a[220:223], v[20:23], v[188:191]
    s_add_u32 s88, s34, 24576
    v_xor_b32 v102, 96, v93
    v_accvgpr_read_b32 v104, a0
    v_mfma_f32_16x16x32_bf16 v[184:187], a[216:219], v[20:23], v[184:187]
    v_mfma_f32_16x16x32_bf16 v[136:139], a[216:219], v[16:19], v[136:139]
    ds_read_b64_tr_b16 a[234:235], v4 offset:14336
    v_accvgpr_read_b32 v58, a14
    v_mfma_f32_16x16x32_bf16 v[140:143], a[220:223], v[16:19], v[140:143]
    v_accvgpr_read_b32 v106, a2
    v_accvgpr_read_b32 v53, a9
    v_accvgpr_read_b32 v110, a6
    v_pk_mul_f32 v[126:127], v[126:127], v[48:49] op_sel_hi:[1,0]
    v_pk_mul_f32 v[118:119], v[118:119], v[48:49] op_sel_hi:[1,0]
    v_pk_mul_f32 v[120:121], v[120:121], v[48:49] op_sel_hi:[1,0]
    v_pk_mul_f32 v[124:125], v[124:125], v[48:49] op_sel_hi:[1,0]
    v_pk_mul_f32 v[162:163], v[162:163], v[92:93] op_sel_hi:[1,0]
    v_pk_mul_f32 v[122:123], v[122:123], v[48:49] op_sel_hi:[1,0]
    v_pk_mul_f32 v[166:167], v[166:167], v[92:93] op_sel_hi:[1,0]
    v_pk_mul_f32 v[114:115], v[114:115], v[48:49] op_sel_hi:[1,0]
    v_pk_mul_f32 v[168:169], v[168:169], v[92:93] op_sel_hi:[1,0]
    v_pk_mul_f32 v[160:161], v[160:161], v[92:93] op_sel_hi:[1,0]
    v_pk_mul_f32 v[116:117], v[116:117], v[48:49] op_sel_hi:[1,0]
    v_pk_mul_f32 v[208:209], v[208:209], v[50:51] op_sel_hi:[1,0]
    v_pk_mul_f32 v[170:171], v[170:171], v[92:93] op_sel_hi:[1,0]
    v_pk_mul_f32 v[164:165], v[164:165], v[92:93] op_sel_hi:[1,0]
    v_pk_mul_f32 v[172:173], v[172:173], v[92:93] op_sel_hi:[1,0]
    v_pk_mul_f32 v[174:175], v[174:175], v[92:93] op_sel_hi:[1,0]
    v_pk_mul_f32 v[112:113], v[112:113], v[48:49] op_sel_hi:[1,0]
    v_cvt_pk_bf16_f32 v120, v120, v121
    v_cvt_pk_bf16_f32 v121, v122, v123
    v_mfma_f32_16x16x32_bf16 v[144:147], a[224:227], v[16:19], v[144:147]
    s_waitcnt lgkmcnt(1)
    v_cvt_pk_bf16_f32 v124, v124, v125
    v_cvt_pk_bf16_f32 v160, v160, v161
    v_mfma_f32_16x16x32_bf16 v[148:151], a[228:231], v[16:19], v[148:151]
    v_cvt_pk_bf16_f32 v164, v164, v165
    v_cvt_pk_bf16_f32 v172, v172, v173
    v_mfma_f32_16x16x32_bf16 v[196:199], a[228:231], v[20:23], v[196:199]
    v_cvt_pk_bf16_f32 v112, v112, v113
    v_cvt_pk_bf16_f32 v116, v116, v117
    v_mfma_f32_16x16x32_bf16 v[192:195], a[224:227], v[20:23], v[192:195]
    v_cvt_pk_bf16_f32 v113, v114, v115
    v_cvt_pk_bf16_f32 v117, v118, v119
    v_mfma_f32_16x16x32_bf16 v[240:243], a[224:227], v[28:31], v[240:243]
    v_cvt_pk_bf16_f32 v165, v166, v167
    v_cvt_pk_bf16_f32 v125, v126, v127
    v_mfma_f32_16x16x32_bf16 v[244:247], a[228:231], v[28:31], v[244:247]
    v_cvt_pk_bf16_f32 v173, v174, v175
    v_cvt_pk_bf16_f32 v168, v168, v169
    v_mfma_f32_16x16x32_bf16 a[36:39], a[228:231], v[32:35], a[36:39]
    s_add_u32 s18, s34, 30720
    v_cvt_pk_bf16_f32 v161, v162, v163
    v_cvt_pk_bf16_f32 v169, v170, v171
    v_mfma_f32_16x16x32_bf16 a[32:35], a[224:227], v[32:35], a[32:35]
    ds_write2st64_b64 v93, v[112:113], v[160:161] offset0:0 offset1:12
    v_mfma_f32_16x16x32_bf16 a[80:83], a[224:227], v[40:43], a[80:83]
    ds_write2st64_b64 v95, v[116:117], v[164:165] offset0:0 offset1:12
    v_mfma_f32_16x16x32_bf16 a[84:87], a[228:231], v[40:43], a[84:87]
    s_waitcnt lgkmcnt(2)
    ds_write2st64_b64 v8, v[120:121], v[168:169] offset0:0 offset1:12
    v_mfma_f32_16x16x32_bf16 a[88:91], a[232:235], v[40:43], a[88:91]
    ds_write2st64_b64 v102, v[124:125], v[172:173] offset0:0 offset1:12
    v_mfma_f32_16x16x32_bf16 a[92:95], a[236:239], v[40:43], a[92:95]
    ds_read_b128 v[60:63], v103 offset:0
    v_mfma_f32_16x16x32_bf16 a[44:47], a[236:239], v[32:35], a[44:47]
    ds_read_b128 v[64:67], v103 offset:1024
    v_pk_mul_f32 v[150:151], v[150:151], v[48:49] op_sel_hi:[1,0]
    v_pk_mul_f32 v[216:217], v[216:217], v[50:51] op_sel_hi:[1,0]
    v_pk_mul_f32 v[220:221], v[220:221], v[50:51] op_sel_hi:[1,0]
    v_pk_mul_f32 v[58:59], v[58:59], v[94:95] op_sel_hi:[1,0]
    v_pk_mul_f32 v[56:57], v[56:57], v[94:95] op_sel_hi:[1,0]
    v_pk_mul_f32 v[136:137], v[136:137], v[48:49] op_sel_hi:[1,0]
    v_pk_mul_f32 v[52:53], v[52:53], v[94:95] op_sel_hi:[1,0]
    v_pk_mul_f32 v[142:143], v[142:143], v[48:49] op_sel_hi:[1,0]
    v_pk_mul_f32 v[218:219], v[218:219], v[50:51] op_sel_hi:[1,0]
    v_pk_mul_f32 v[140:141], v[140:141], v[48:49] op_sel_hi:[1,0]
    v_cvt_pk_bf16_f32 v52, v52, v53
    v_pk_mul_f32 v[148:149], v[148:149], v[48:49] op_sel_hi:[1,0]
    v_accvgpr_read_b32 v108, a4
    v_pk_mul_f32 v[104:105], v[104:105], v[94:95] op_sel_hi:[1,0]
    v_pk_mul_f32 v[214:215], v[214:215], v[50:51] op_sel_hi:[1,0]
    v_pk_mul_f32 v[212:213], v[212:213], v[50:51] op_sel_hi:[1,0]
    v_pk_mul_f32 v[138:139], v[138:139], v[48:49] op_sel_hi:[1,0]
    v_pk_mul_f32 v[54:55], v[54:55], v[94:95] op_sel_hi:[1,0]
    v_pk_mul_f32 v[106:107], v[106:107], v[94:95] op_sel_hi:[1,0]
    v_pk_mul_f32 v[128:129], v[128:129], v[48:49] op_sel_hi:[1,0]
    v_pk_mul_f32 v[222:223], v[222:223], v[50:51] op_sel_hi:[1,0]
    s_nop 1
    v_mfma_f32_16x16x32_bf16 a[40:43], a[232:235], v[32:35], a[40:43]
    v_mfma_f32_16x16x32_bf16 v[248:251], a[232:235], v[28:31], v[248:251]
    s_waitcnt lgkmcnt(1)
    buffer_store_dwordx4 v[60:63], v6, s[16:19], s84 offen offset:0 nt
    ds_read_b128 v[68:71], v103 offset:6144
    v_cvt_pk_bf16_f32 v53, v54, v55
    v_pk_mul_f32 v[108:109], v[108:109], v[94:95] op_sel_hi:[1,0]
    v_cvt_pk_bf16_f32 v220, v220, v221
    v_pk_mul_f32 v[210:211], v[210:211], v[50:51] op_sel_hi:[1,0]
    v_pk_mul_f32 v[180:181], v[180:181], v[92:93] op_sel_hi:[1,0]
    v_pk_mul_f32 v[188:189], v[188:189], v[92:93] op_sel_hi:[1,0]
    v_cvt_pk_bf16_f32 v216, v216, v217
    s_nop 0
    v_mfma_f32_16x16x32_bf16 v[252:255], a[236:239], v[28:31], v[252:255]
    v_cvt_pk_bf16_f32 v56, v56, v57
    v_cvt_pk_bf16_f32 v108, v108, v109
    v_accvgpr_read_b32 v111, a7
    v_cvt_pk_bf16_f32 v104, v104, v105
    ds_read_b128 v[72:75], v103 offset:7168
    v_cvt_pk_bf16_f32 v221, v222, v223
    v_pk_mul_f32 v[110:111], v[110:111], v[94:95] op_sel_hi:[1,0]
    v_cvt_pk_bf16_f32 v212, v212, v213
    v_cvt_pk_bf16_f32 v213, v214, v215
    v_cvt_pk_bf16_f32 v208, v208, v209
    v_cvt_pk_bf16_f32 v105, v106, v107
    v_cvt_pk_bf16_f32 v209, v210, v211
    v_cvt_pk_bf16_f32 v57, v58, v59
    v_cvt_pk_bf16_f32 v188, v188, v189
    v_mfma_f32_16x16x32_bf16 v[204:207], a[236:239], v[20:23], v[204:207]
    s_waitcnt lgkmcnt(2)
    buffer_store_dwordx4 v[64:67], v7, s[16:19], s84 offen offset:0 nt
    v_cvt_pk_bf16_f32 v109, v110, v111
    v_cvt_pk_bf16_f32 v140, v140, v141
    ds_write2st64_b64 v93, v[208:209], v[104:105] offset0:24 offset1:36
    v_cvt_pk_bf16_f32 v136, v136, v137
    v_pk_mul_f32 v[236:237], v[236:237], v[50:51] op_sel_hi:[1,0]
    v_accvgpr_read_b32 v54, a58
    v_pk_mul_f32 v[130:131], v[130:131], v[48:49] op_sel_hi:[1,0]
    v_pk_mul_f32 v[240:241], v[240:241], v[50:51] op_sel_hi:[1,0]
    v_accvgpr_read_b32 v59, a63
    v_cvt_pk_bf16_f32 v217, v218, v219
    v_accvgpr_read_b32 v104, a48
    v_pk_mul_f32 v[226:227], v[226:227], v[50:51] op_sel_hi:[1,0]
    v_accvgpr_read_b32 v58, a62
    v_cvt_pk_bf16_f32 v128, v128, v129
    v_mfma_f32_16x16x32_bf16 v[200:203], a[232:235], v[20:23], v[200:203]
    s_waitcnt lgkmcnt(1)
    v_cvt_pk_bf16_f32 v137, v138, v139
    ds_write2st64_b64 v95, v[212:213], v[108:109] offset0:24 offset1:36
    buffer_store_dwordx4 v[68:71], v6, s[16:19], s85 offen offset:0 nt
    ds_write2st64_b64 v8, v[216:217], v[52:53] offset0:24 offset1:36
    v_pk_mul_f32 v[254:255], v[254:255], v[50:51] op_sel_hi:[1,0]
    v_pk_mul_f32 v[182:183], v[182:183], v[92:93] op_sel_hi:[1,0]
    v_pk_mul_f32 v[224:225], v[224:225], v[50:51] op_sel_hi:[1,0]
    v_accvgpr_read_b32 v53, a57
    v_accvgpr_read_b32 v108, a52
    v_mfma_f32_16x16x32_bf16 v[152:155], a[232:235], v[16:19], v[152:155]
    ds_write2st64_b64 v102, v[220:221], v[56:57] offset0:24 offset1:36
    v_cvt_pk_bf16_f32 v236, v236, v237
    v_accvgpr_read_b32 v55, a59
    v_accvgpr_read_b32 v52, a56
    v_pk_mul_f32 v[228:229], v[228:229], v[50:51] op_sel_hi:[1,0]
    v_cvt_pk_bf16_f32 v141, v142, v143
    ds_read_b128 v[76:79], v103 offset:12288
    v_accvgpr_read_b32 v57, a61
    v_pk_mul_f32 v[132:133], v[132:133], v[48:49] op_sel_hi:[1,0]
    buffer_store_dwordx4 v[72:75], v7, s[16:19], s85 offen offset:0 nt
    v_accvgpr_read_b32 v105, a49
    v_pk_mul_f32 v[244:245], v[244:245], v[50:51] op_sel_hi:[1,0]
    v_pk_mul_f32 v[238:239], v[238:239], v[50:51] op_sel_hi:[1,0]
    v_pk_mul_f32 v[234:235], v[234:235], v[50:51] op_sel_hi:[1,0]
    v_cvt_pk_bf16_f32 v224, v224, v225
    v_pk_mul_f32 v[58:59], v[58:59], v[100:101] op_sel_hi:[1,0]
    v_pk_mul_f32 v[198:199], v[198:199], v[92:93] op_sel_hi:[1,0]
    v_cvt_pk_bf16_f32 v180, v180, v181
    v_pk_mul_f32 v[230:231], v[230:231], v[50:51] op_sel_hi:[1,0]
    v_accvgpr_read_b32 v109, a53
    v_pk_mul_f32 v[52:53], v[52:53], v[100:101] op_sel_hi:[1,0]
    v_cvt_pk_bf16_f32 v129, v130, v131
    v_pk_mul_f32 v[190:191], v[190:191], v[92:93] op_sel_hi:[1,0]
    ds_read_b128 v[80:83], v103 offset:13312
    v_pk_mul_f32 v[108:109], v[108:109], v[100:101] op_sel_hi:[1,0]
    ds_read_b128 v[84:87], v103 offset:18432
    v_pk_mul_f32 v[232:233], v[232:233], v[50:51] op_sel_hi:[1,0]
    v_pk_mul_f32 v[104:105], v[104:105], v[100:101] op_sel_hi:[1,0]
    ds_read_b128 v[88:91], v103 offset:19456
    v_pk_mul_f32 v[54:55], v[54:55], v[100:101] op_sel_hi:[1,0]
    v_accvgpr_read_b32 v110, a54
    v_accvgpr_read_b32 v106, a50
    v_mfma_f32_16x16x32_bf16 v[156:159], a[236:239], v[16:19], v[156:159]
    s_waitcnt lgkmcnt(3)
    buffer_store_dwordx4 v[76:79], v6, s[16:19], s86 offen offset:0 nt
    v_pk_mul_f32 v[176:177], v[176:177], v[92:93] op_sel_hi:[1,0]
    v_accvgpr_read_b32 v111, a55
    v_accvgpr_read_b32 v107, a51
    v_cvt_pk_bf16_f32 v52, v52, v53
    v_cvt_pk_bf16_f32 v132, v132, v133
    v_pk_mul_f32 v[250:251], v[250:251], v[50:51] op_sel_hi:[1,0]
    v_cvt_pk_bf16_f32 v104, v104, v105
    v_cvt_pk_bf16_f32 v53, v54, v55
    v_accvgpr_read_b32 v56, a60
    v_pk_mul_f32 v[110:111], v[110:111], v[100:101] op_sel_hi:[1,0]
    v_pk_mul_f32 v[56:57], v[56:57], v[100:101] op_sel_hi:[1,0]
    v_cvt_pk_bf16_f32 v108, v108, v109
    v_pk_mul_f32 v[194:195], v[194:195], v[92:93] op_sel_hi:[1,0]
    v_cvt_pk_bf16_f32 v109, v110, v111
    v_cvt_pk_bf16_f32 v148, v148, v149
    v_pk_mul_f32 v[152:153], v[152:153], v[48:49] op_sel_hi:[1,0]
    v_cvt_pk_bf16_f32 v56, v56, v57
    v_cvt_pk_bf16_f32 v57, v58, v59
    v_pk_mul_f32 v[192:193], v[192:193], v[92:93] op_sel_hi:[1,0]
    v_pk_mul_f32 v[186:187], v[186:187], v[92:93] op_sel_hi:[1,0]
    v_pk_mul_f32 v[134:135], v[134:135], v[48:49] op_sel_hi:[1,0]
    v_pk_mul_f32 v[156:157], v[156:157], v[48:49] op_sel_hi:[1,0]
    v_pk_mul_f32 v[106:107], v[106:107], v[100:101] op_sel_hi:[1,0]
    v_pk_mul_f32 v[200:201], v[200:201], v[92:93] op_sel_hi:[1,0]
    s_waitcnt lgkmcnt(1)
    buffer_store_dwordx4 v[80:83], v7, s[16:19], s86 offen offset:0 nt
    v_cvt_pk_bf16_f32 v105, v106, v107
    v_pk_mul_f32 v[184:185], v[184:185], v[92:93] op_sel_hi:[1,0]
    v_cvt_pk_bf16_f32 v181, v182, v183
    v_accvgpr_read_b32 v59, a31
    v_pk_mul_f32 v[154:155], v[154:155], v[48:49] op_sel_hi:[1,0]
    ds_write_b64 v93, v[104:105] offset:24576
    v_cvt_pk_bf16_f32 v192, v192, v193
    v_accvgpr_read_b32 v107, a19
    ds_write_b64 v95, v[108:109] offset:24576
    v_cvt_pk_bf16_f32 v156, v156, v157
    v_pk_mul_f32 v[246:247], v[246:247], v[50:51] op_sel_hi:[1,0]
    v_accvgpr_read_b32 v54, a26
    v_pk_mul_f32 v[144:145], v[144:145], v[48:49] op_sel_hi:[1,0]
    v_cvt_pk_bf16_f32 v237, v238, v239
    v_accvgpr_read_b32 v106, a18
    v_cvt_pk_bf16_f32 v176, v176, v177
    v_pk_mul_f32 v[178:179], v[178:179], v[92:93] op_sel_hi:[1,0]
    v_accvgpr_read_b32 v109, a21
    v_cvt_pk_bf16_f32 v244, v244, v245
    v_cvt_pk_bf16_f32 v228, v228, v229
    buffer_store_dwordx4 v[84:87], v6, s[16:19], s87 offen offset:0 nt
    ds_write_b64 v8, v[52:53] offset:24576
    v_pk_mul_f32 v[204:205], v[204:205], v[92:93] op_sel_hi:[1,0]
    v_cvt_pk_bf16_f32 v177, v178, v179
    v_accvgpr_read_b32 v52, a24
    v_cvt_pk_bf16_f32 v232, v232, v233
    v_pk_mul_f32 v[248:249], v[248:249], v[50:51] op_sel_hi:[1,0]
    ds_write_b64 v102, v[56:57] offset:24576
    ds_read_b128 v[60:63], v103 offset:24576
    ds_read_b128 v[64:67], v103 offset:25600
    v_accvgpr_read_b32 v58, a30
    v_accvgpr_read_b32 v57, a29
    s_waitcnt lgkmcnt(4)
    buffer_store_dwordx4 v[88:91], v7, s[16:19], s87 offen offset:0 nt
    v_accvgpr_read_b32 v111, a23
    v_pk_mul_f32 v[252:253], v[252:253], v[50:51] op_sel_hi:[1,0]
    v_cvt_pk_bf16_f32 v152, v152, v153
    v_accvgpr_read_b32 v56, a28
    v_cvt_pk_bf16_f32 v189, v190, v191
    v_cvt_pk_bf16_f32 v184, v184, v185
    v_cvt_pk_bf16_f32 v133, v134, v135
    v_accvgpr_read_b32 v105, a17
    v_pk_mul_f32 v[106:107], v[106:107], v[94:95] op_sel_hi:[1,0]
    ds_write2st64_b64 v93, v[128:129], v[176:177] offset0:4 offset1:16
    v_pk_mul_f32 v[58:59], v[58:59], v[94:95] op_sel_hi:[1,0]
    v_cvt_pk_bf16_f32 v252, v252, v253
    v_cvt_pk_bf16_f32 v225, v226, v227
    v_cvt_pk_bf16_f32 v204, v204, v205
    ds_write2st64_b64 v95, v[132:133], v[180:181] offset0:4 offset1:16
    v_accvgpr_read_b32 v110, a22
    v_cvt_pk_bf16_f32 v185, v186, v187
    s_waitcnt lgkmcnt(2)
    buffer_store_dwordx4 v[60:63], v6, s[16:19], s88 offen offset:0 nt
    v_accvgpr_read_b32 v53, a25
    v_pk_mul_f32 v[56:57], v[56:57], v[94:95] op_sel_hi:[1,0]
    v_pk_mul_f32 v[196:197], v[196:197], v[92:93] op_sel_hi:[1,0]
    ds_write2st64_b64 v8, v[136:137], v[184:185] offset0:4 offset1:16
    v_pk_mul_f32 v[206:207], v[206:207], v[92:93] op_sel_hi:[1,0]
    ds_write2st64_b64 v102, v[140:141], v[188:189] offset0:4 offset1:16
    v_accvgpr_read_b32 v104, a16
    v_pk_mul_f32 v[104:105], v[104:105], v[94:95] op_sel_hi:[1,0]
    v_accvgpr_read_b32 v55, a27
    v_cvt_pk_bf16_f32 v104, v104, v105
    v_cvt_pk_bf16_f32 v233, v234, v235
    ds_read_b128 v[68:71], v103 offset:2048
    buffer_store_dwordx4 v[64:67], v7, s[16:19], s88 offen offset:0 nt
    ds_read_b128 v[72:75], v103 offset:3072
    v_cvt_pk_bf16_f32 v248, v248, v249
    v_cvt_pk_bf16_f32 v105, v106, v107
    v_cvt_pk_bf16_f32 v56, v56, v57
    v_pk_mul_f32 v[110:111], v[110:111], v[94:95] op_sel_hi:[1,0]
    v_cvt_pk_bf16_f32 v229, v230, v231
    v_pk_mul_f32 v[52:53], v[52:53], v[94:95] op_sel_hi:[1,0]
    ds_read_b128 v[76:79], v103 offset:8192
    v_cvt_pk_bf16_f32 v196, v196, v197
    v_accvgpr_read_b32 v106, a66
    ds_read_b128 v[80:83], v103 offset:9216
    v_accvgpr_read_b32 v108, a20
    v_pk_mul_f32 v[108:109], v[108:109], v[94:95] op_sel_hi:[1,0]
    ds_write2st64_b64 v93, v[224:225], v[104:105] offset0:28 offset1:40
    v_pk_mul_f32 v[54:55], v[54:55], v[94:95] op_sel_hi:[1,0]
    v_cvt_pk_bf16_f32 v108, v108, v109
    v_accvgpr_read_b32 v107, a67
    v_accvgpr_read_b32 v105, a65
    s_waitcnt lgkmcnt(4)
    buffer_store_dwordx4 v[68:71], v6, s[16:19], s84 offen offset:128 nt
    v_cvt_pk_bf16_f32 v52, v52, v53
    v_cvt_pk_bf16_f32 v144, v144, v145
    v_cvt_pk_bf16_f32 v57, v58, v59
    v_cvt_pk_bf16_f32 v53, v54, v55
    v_pk_mul_f32 v[242:243], v[242:243], v[50:51] op_sel_hi:[1,0]
    v_accvgpr_read_b32 v104, a64
    v_pk_mul_f32 v[104:105], v[104:105], v[100:101] op_sel_hi:[1,0]
    v_cvt_pk_bf16_f32 v109, v110, v111
    ds_write2st64_b64 v95, v[228:229], v[108:109] offset0:28 offset1:40
    v_accvgpr_read_b32 v108, a68
    s_waitcnt lgkmcnt(3)
    buffer_store_dwordx4 v[72:75], v7, s[16:19], s84 offen offset:128 nt
    v_accvgpr_read_b32 v109, a69
    ds_write2st64_b64 v8, v[232:233], v[52:53] offset0:28 offset1:40
    v_pk_mul_f32 v[202:203], v[202:203], v[92:93] op_sel_hi:[1,0]
    v_accvgpr_read_b32 v110, a70
    v_cvt_pk_bf16_f32 v193, v194, v195
    v_accvgpr_read_b32 v111, a71
    ds_write2st64_b64 v102, v[236:237], v[56:57] offset0:28 offset1:40
    v_pk_mul_f32 v[108:109], v[108:109], v[100:101] op_sel_hi:[1,0]
    ds_read_b128 v[84:87], v103 offset:14336
    v_accvgpr_read_b32 v53, a73
    v_accvgpr_read_b32 v59, a79
    v_pk_mul_f32 v[110:111], v[110:111], v[100:101] op_sel_hi:[1,0]
    v_accvgpr_read_b32 v57, a77
    v_accvgpr_read_b32 v54, a74
    buffer_store_dwordx4 v[76:79], v6, s[16:19], s85 offen offset:128 nt
    v_accvgpr_read_b32 v55, a75
    ds_read_b128 v[88:91], v103 offset:15360
    v_cvt_pk_bf16_f32 v108, v108, v109
    s_waitcnt lgkmcnt(4)
    buffer_store_dwordx4 v[80:83], v7, s[16:19], s85 offen offset:128 nt
    v_accvgpr_read_b32 v58, a78
    v_accvgpr_read_b32 v52, a72
    v_pk_mul_f32 v[58:59], v[58:59], v[100:101] op_sel_hi:[1,0]
    v_pk_mul_f32 v[54:55], v[54:55], v[100:101] op_sel_hi:[1,0]
    v_cvt_pk_bf16_f32 v109, v110, v111
    v_pk_mul_f32 v[146:147], v[146:147], v[48:49] op_sel_hi:[1,0]
    ds_read_b128 v[60:63], v103 offset:20480
    v_accvgpr_read_b32 v56, a76
    s_waitcnt lgkmcnt(1)
    buffer_store_dwordx4 v[84:87], v6, s[16:19], s86 offen offset:128 nt
    v_pk_mul_f32 v[52:53], v[52:53], v[100:101] op_sel_hi:[1,0]
    v_cvt_pk_bf16_f32 v249, v250, v251
    v_pk_mul_f32 v[106:107], v[106:107], v[100:101] op_sel_hi:[1,0]
    v_cvt_pk_bf16_f32 v200, v200, v201
    v_pk_mul_f32 v[56:57], v[56:57], v[100:101] op_sel_hi:[1,0]
    s_nop 0
    v_cvt_pk_bf16_f32 v56, v56, v57
    v_cvt_pk_bf16_f32 v52, v52, v53
    v_cvt_pk_bf16_f32 v104, v104, v105
    v_cvt_pk_bf16_f32 v197, v198, v199
    ds_read_b128 v[64:67], v103 offset:21504
    v_cvt_pk_bf16_f32 v205, v206, v207
    v_pk_mul_f32 v[158:159], v[158:159], v[48:49] op_sel_hi:[1,0]
    v_cvt_pk_bf16_f32 v105, v106, v107
    v_cvt_pk_bf16_f32 v149, v150, v151
    v_cvt_pk_bf16_f32 v240, v240, v241
    ds_write_b64 v93, v[104:105] offset:26624
    v_cvt_pk_bf16_f32 v53, v54, v55
    buffer_store_dwordx4 v[88:91], v7, s[16:19], s86 offen offset:128 nt
    v_accvgpr_read_b32 v111, a39
    ds_write_b64 v95, v[108:109] offset:26624
    v_accvgpr_read_b32 v105, a33
    ds_write_b64 v8, v[52:53] offset:26624
    v_accvgpr_read_b32 v106, a34
    v_cvt_pk_bf16_f32 v57, v58, v59
    v_cvt_pk_bf16_f32 v157, v158, v159
    v_accvgpr_read_b32 v52, a40
    v_cvt_pk_bf16_f32 v145, v146, v147
    v_cvt_pk_bf16_f32 v253, v254, v255
    v_accvgpr_read_b32 v59, a47
    v_cvt_pk_bf16_f32 v241, v242, v243
    v_accvgpr_read_b32 v110, a38
    v_accvgpr_read_b32 v104, a32
    ds_write_b64 v102, v[56:57] offset:26624
    s_waitcnt lgkmcnt(3)
    buffer_store_dwordx4 v[60:63], v6, s[16:19], s87 offen offset:128 nt
    v_accvgpr_read_b32 v109, a37
    v_accvgpr_read_b32 v55, a43
    v_accvgpr_read_b32 v107, a35
    v_accvgpr_read_b32 v54, a42
    v_accvgpr_read_b32 v57, a45
    v_accvgpr_read_b32 v108, a36
    ds_read_b128 v[68:71], v103 offset:26624
    v_pk_mul_f32 v[110:111], v[110:111], v[94:95] op_sel_hi:[1,0]
    v_cvt_pk_bf16_f32 v153, v154, v155
    ds_read_b128 v[72:75], v103 offset:27648
    v_accvgpr_read_b32 v58, a46
    ds_write2st64_b64 v93, v[144:145], v[192:193] offset0:8 offset1:20
    buffer_store_dwordx4 v[64:67], v7, s[16:19], s87 offen offset:128 nt
    v_accvgpr_read_b32 v53, a41
    v_pk_mul_f32 v[108:109], v[108:109], v[94:95] op_sel_hi:[1,0]
    v_pk_mul_f32 v[106:107], v[106:107], v[94:95] op_sel_hi:[1,0]
    v_cvt_pk_bf16_f32 v201, v202, v203
    ds_write2st64_b64 v95, v[148:149], v[196:197] offset0:8 offset1:20
    v_cvt_pk_bf16_f32 v108, v108, v109
    v_accvgpr_read_b32 v56, a44
    v_cvt_pk_bf16_f32 v245, v246, v247
    v_pk_mul_f32 v[104:105], v[104:105], v[94:95] op_sel_hi:[1,0]
    ds_write2st64_b64 v8, v[152:153], v[200:201] offset0:8 offset1:20
    ds_write2st64_b64 v102, v[156:157], v[204:205] offset0:8 offset1:20
    ds_read_b128 v[76:79], v103 offset:4096
    v_pk_mul_f32 v[56:57], v[56:57], v[94:95] op_sel_hi:[1,0]
    s_waitcnt lgkmcnt(4)
    buffer_store_dwordx4 v[68:71], v6, s[16:19], s88 offen offset:128 nt
    v_pk_mul_f32 v[52:53], v[52:53], v[94:95] op_sel_hi:[1,0]
    s_nop 0
    v_cvt_pk_bf16_f32 v52, v52, v53
    v_cvt_pk_bf16_f32 v104, v104, v105
    v_pk_mul_f32 v[54:55], v[54:55], v[94:95] op_sel_hi:[1,0]
    v_cvt_pk_bf16_f32 v56, v56, v57
    ds_read_b128 v[80:83], v103 offset:5120
    v_cvt_pk_bf16_f32 v105, v106, v107
    ds_read_b128 v[84:87], v103 offset:10240
    buffer_store_dwordx4 v[72:75], v7, s[16:19], s88 offen offset:128 nt
    v_cvt_pk_bf16_f32 v109, v110, v111
    ds_read_b128 v[88:91], v103 offset:11264
    ds_write2st64_b64 v93, v[240:241], v[104:105] offset0:32 offset1:44
    v_cvt_pk_bf16_f32 v53, v54, v55
    v_accvgpr_read_b32 v54, a90
    ds_write2st64_b64 v95, v[244:245], v[108:109] offset0:32 offset1:44
    v_pk_mul_f32 v[58:59], v[58:59], v[94:95] op_sel_hi:[1,0]
    v_accvgpr_read_b32 v111, a87
    ds_write2st64_b64 v8, v[248:249], v[52:53] offset0:32 offset1:44
    v_accvgpr_read_b32 v105, a81
    v_cvt_pk_bf16_f32 v57, v58, v59
    s_waitcnt lgkmcnt(4)
    buffer_store_dwordx4 v[76:79], v6, s[16:19], s84 offen offset:256 nt
    ds_write2st64_b64 v102, v[252:253], v[56:57] offset0:32 offset1:44
    buffer_store_dwordx4 v[80:83], v7, s[16:19], s84 offen offset:256 nt
    v_accvgpr_read_b32 v52, a88
    v_accvgpr_read_b32 v53, a89
    v_accvgpr_read_b32 v104, a80
    v_accvgpr_read_b32 v55, a91
    v_accvgpr_read_b32 v107, a83
    v_accvgpr_read_b32 v106, a82
    v_pk_mul_f32 v[52:53], v[52:53], v[100:101] op_sel_hi:[1,0]
    ds_read_b128 v[60:63], v103 offset:16384
    v_accvgpr_read_b32 v56, a92
    v_accvgpr_read_b32 v57, a93
    ds_read_b128 v[64:67], v103 offset:17408
    buffer_store_dwordx4 v[84:87], v6, s[16:19], s85 offen offset:256 nt
    ds_read_b128 v[68:71], v103 offset:22528
    v_pk_mul_f32 v[104:105], v[104:105], v[100:101] op_sel_hi:[1,0]
    v_accvgpr_read_b32 v109, a85
    v_pk_mul_f32 v[106:107], v[106:107], v[100:101] op_sel_hi:[1,0]
    v_accvgpr_read_b32 v108, a84
    s_waitcnt lgkmcnt(3)
    buffer_store_dwordx4 v[88:91], v7, s[16:19], s85 offen offset:256 nt
    v_pk_mul_f32 v[56:57], v[56:57], v[100:101] op_sel_hi:[1,0]
    v_accvgpr_read_b32 v110, a86
    v_cvt_pk_bf16_f32 v52, v52, v53
    v_cvt_pk_bf16_f32 v56, v56, v57
    v_pk_mul_f32 v[110:111], v[110:111], v[100:101] op_sel_hi:[1,0]
    s_waitcnt lgkmcnt(0)
    buffer_store_dwordx4 v[60:63], v6, s[16:19], s86 offen offset:256 nt
    v_cvt_pk_bf16_f32 v104, v104, v105
    v_pk_mul_f32 v[108:109], v[108:109], v[100:101] op_sel_hi:[1,0]
    v_accvgpr_read_b32 v59, a95
    v_accvgpr_read_b32 v58, a94
    v_cvt_pk_bf16_f32 v108, v108, v109
    v_pk_mul_f32 v[58:59], v[58:59], v[100:101] op_sel_hi:[1,0]
    v_cvt_pk_bf16_f32 v105, v106, v107
    ds_read_b128 v[72:75], v103 offset:23552
    ds_write_b64 v93, v[104:105] offset:0
    buffer_store_dwordx4 v[64:67], v7, s[16:19], s86 offen offset:256 nt
    v_cvt_pk_bf16_f32 v109, v110, v111
    v_pk_mul_f32 v[54:55], v[54:55], v[100:101] op_sel_hi:[1,0]
    buffer_store_dwordx4 v[68:71], v6, s[16:19], s87 offen offset:256 nt
    v_cvt_pk_bf16_f32 v53, v54, v55
    ds_write_b64 v95, v[108:109] offset:0
    ds_write_b64 v8, v[52:53] offset:0
    v_cvt_pk_bf16_f32 v57, v58, v59
    ds_write_b64 v102, v[56:57] offset:0
    ds_read_b128 v[76:79], v103 offset:0
    ds_read_b128 v[80:83], v103 offset:1024
    s_waitcnt lgkmcnt(5)
    buffer_store_dwordx4 v[72:75], v7, s[16:19], s87 offen offset:256 nt
    s_waitcnt lgkmcnt(1)
    buffer_store_dwordx4 v[76:79], v6, s[16:19], s88 offen offset:256 nt
    s_waitcnt lgkmcnt(0)
    buffer_store_dwordx4 v[80:83], v7, s[16:19], s88 offen offset:256 nt
    s_branch L_fin
L_end4:
    v_mfma_f32_16x16x32_bf16 v[112:115], a[216:219], v[16:19], v[112:115]
    v_fma_f32 v76, v76, s28, v12
    v_fma_f32 v62, v62, s28, v10
    v_fma_f32 v73, v73, s28, v11
    v_mfma_f32_16x16x32_bf16 v[160:163], a[216:219], v[20:23], v[160:163]
    ds_read_b128 v[96:99], v103 offset:1024
    v_fma_f32 v79, v79, s28, v12
    v_mfma_f32_16x16x32_bf16 v[208:211], a[216:219], v[28:31], v[208:211]
    ds_read_b64_tr_b16 a[232:233], v2 offset:19456
    v_fma_f32 v81, v81, s28, v12
    v_mfma_f32_16x16x32_bf16 a[0:3], a[216:219], v[32:35], a[0:3]
    ds_read_b64_tr_b16 a[236:237], v3 offset:19456
    s_waitcnt lgkmcnt(7)
    v_mfma_f32_16x16x32_bf16 a[4:7], a[220:223], v[32:35], a[4:7]
    ds_read_b64_tr_b16 a[234:235], v2 offset:13312
    s_add_u32 s39, s39, 12288
    v_mfma_f32_16x16x32_bf16 v[212:215], a[220:223], v[28:31], v[212:215]
    ds_read_b64_tr_b16 a[238:239], v3 offset:13312
    v_fma_f32 v68, v68, s28, v11
    v_mfma_f32_16x16x32_bf16 v[164:167], a[220:223], v[20:23], v[164:167]
    ds_read_b64_tr_b16 a[216:217], v4 offset:19456
    v_fma_f32 v70, v70, s28, v11
    v_mfma_f32_16x16x32_bf16 v[116:119], a[220:223], v[16:19], v[116:119]
    ds_read_b64_tr_b16 a[218:219], v4 offset:13312
    s_waitcnt lgkmcnt(9)
    v_mfma_f32_16x16x32_bf16 v[120:123], a[224:227], v[16:19], v[120:123]
    v_fma_f32 v59, v59, s28, v9
    v_fma_f32 v71, v71, s28, v11
    v_mfma_f32_16x16x32_bf16 v[168:171], a[224:227], v[20:23], v[168:171]
    ds_read_b64_tr_b16 a[222:223], v5 offset:13312
    v_mfma_f32_16x16x32_bf16 v[216:219], a[224:227], v[28:31], v[216:219]
    v_exp_f32_e64 v70, v70 clamp
    v_mfma_f32_16x16x32_bf16 a[8:11], a[224:227], v[32:35], a[8:11]
    s_waitcnt lgkmcnt(7)
    v_fma_f32 v74, v74, s28, v11
    v_fma_f32 v77, v77, s28, v12
    v_mfma_f32_16x16x32_bf16 a[12:15], a[228:231], v[32:35], a[12:15]
    v_exp_f32_e64 v71, v71 clamp
    v_mfma_f32_16x16x32_bf16 v[220:223], a[228:231], v[28:31], v[220:223]
    ds_read_b64_tr_b16 a[220:221], v5 offset:19456
    v_fma_f32 v56, v56, s28, v9
    v_mfma_f32_16x16x32_bf16 v[172:175], a[228:231], v[20:23], v[172:175]
    v_exp_f32_e64 v73, v73 clamp
    v_mfma_f32_16x16x32_bf16 v[124:127], a[228:231], v[16:19], v[124:127]
    s_waitcnt lgkmcnt(4)
    ds_read_b64_tr_b16 a[228:229], v3 offset:20480
    v_fma_f32 v83, v83, s28, v12
    v_mfma_f32_16x16x32_bf16 v[128:131], a[232:235], v[16:19], v[128:131]
    ds_read_b64_tr_b16 a[224:225], v2 offset:20480
    v_fma_f32 v63, v63, s28, v10
    v_mfma_f32_16x16x32_bf16 v[176:179], a[232:235], v[20:23], v[176:179]
    v_exp_f32_e64 v76, v76 clamp
    v_mfma_f32_16x16x32_bf16 v[224:227], a[232:235], v[28:31], v[224:227]
    v_fma_f32 v67, v67, s28, v10
    v_fma_f32 v78, v78, s28, v12
    v_mfma_f32_16x16x32_bf16 a[16:19], a[232:235], v[32:35], a[16:19]
    ds_read_b64_tr_b16 a[226:227], v2 offset:14336
    v_fma_f32 v72, v72, s28, v11
    v_mfma_f32_16x16x32_bf16 a[20:23], a[236:239], v[32:35], a[20:23]
    ds_read_b64_tr_b16 a[234:235], v4 offset:14336
    v_fma_f32 v80, v80, s28, v12
    v_mfma_f32_16x16x32_bf16 v[228:231], a[236:239], v[28:31], v[228:231]
    ds_read_b64_tr_b16 a[232:233], v4 offset:20480
    v_fma_f32 v69, v69, s28, v11
    v_mfma_f32_16x16x32_bf16 v[180:183], a[236:239], v[20:23], v[180:183]
    ds_read_b64_tr_b16 a[230:231], v3 offset:14336
    v_fma_f32 v58, v58, s28, v9
    v_mfma_f32_16x16x32_bf16 v[132:135], a[236:239], v[16:19], v[132:135]
    s_waitcnt lgkmcnt(6)
    ds_read_b64_tr_b16 a[238:239], v5 offset:14336
    v_fma_f32 v64, v64, s28, v10
    v_mfma_f32_16x16x32_bf16 v[136:139], a[216:219], v[16:19], v[136:139]
    ds_read_b64_tr_b16 a[236:237], v5 offset:20480
    v_fma_f32 v65, v65, s28, v10
    v_mfma_f32_16x16x32_bf16 v[184:187], a[216:219], v[20:23], v[184:187]
    v_exp_f32_e64 v79, v79 clamp
    v_mfma_f32_16x16x32_bf16 v[232:235], a[216:219], v[28:31], v[232:235]
    ds_read_b128 v[88:91], v103 offset:0
    v_mfma_f32_16x16x32_bf16 a[24:27], a[216:219], v[32:35], a[24:27]
    v_exp_f32_e64 v78, v78 clamp
    v_mfma_f32_16x16x32_bf16 a[28:31], a[220:223], v[32:35], a[28:31]
    v_exp_f32_e64 v62, v62 clamp
    v_mfma_f32_16x16x32_bf16 v[236:239], a[220:223], v[28:31], v[236:239]
    ds_read_b128 v[84:87], v103 offset:2048
    v_mfma_f32_16x16x32_bf16 v[188:191], a[220:223], v[20:23], v[188:191]
    v_exp_f32_e64 v77, v77 clamp
    v_mfma_f32_16x16x32_bf16 v[140:143], a[220:223], v[16:19], v[140:143]
    s_waitcnt lgkmcnt(5)
    v_exp_f32_e64 v59, v59 clamp
    v_mfma_f32_16x16x32_bf16 v[144:147], a[224:227], v[16:19], v[144:147]
    v_exp_f32_e64 v58, v58 clamp
    v_mfma_f32_16x16x32_bf16 v[192:195], a[224:227], v[20:23], v[192:195]
    v_exp_f32_e64 v74, v74 clamp
    v_mfma_f32_16x16x32_bf16 v[240:243], a[224:227], v[28:31], v[240:243]
    s_waitcnt vmcnt(10) lgkmcnt(2)
    v_exp_f32_e64 v65, v65 clamp
    v_mfma_f32_16x16x32_bf16 a[32:35], a[224:227], v[32:35], a[32:35]
    s_barrier
    v_mfma_f32_16x16x32_bf16 a[36:39], a[228:231], v[32:35], a[36:39]
    ds_read_b128 a[220:223], v1 offset:12288
    v_fma_f32 v82, v82, s28, v12
    v_mfma_f32_16x16x32_bf16 v[244:247], a[228:231], v[28:31], v[244:247]
    ds_read_b128 a[216:219], v0 offset:12288
    s_add_u32 m0, s22, 36864
    v_mfma_f32_16x16x32_bf16 v[196:199], a[228:231], v[20:23], v[196:199]
    buffer_load_dwordx4 v6, s[8:11], s21 offen lds
    v_mfma_f32_16x16x32_bf16 v[148:151], a[228:231], v[16:19], v[148:151]
    s_add_u32 s21, s21, 128
    ds_read_b128 a[224:227], v0 offset:13312
    v_mfma_f32_16x16x32_bf16 v[152:155], a[232:235], v[16:19], v[152:155]
    s_add_u32 m0, s22, 37888
    v_exp_f32_e64 v63, v63 clamp
    v_mfma_f32_16x16x32_bf16 v[200:203], a[232:235], v[20:23], v[200:203]
    v_exp_f32_e64 v68, v68 clamp
    v_mfma_f32_16x16x32_bf16 v[248:251], a[232:235], v[28:31], v[248:251]
    v_exp_f32_e64 v72, v72 clamp
    v_mfma_f32_16x16x32_bf16 a[40:43], a[232:235], v[32:35], a[40:43]
    buffer_load_dwordx4 v6, s[8:11], s21 offen lds
    v_mfma_f32_16x16x32_bf16 a[44:47], a[236:239], v[32:35], a[44:47]
    s_add_u32 s21, s21, 128
    ds_read_b128 a[228:231], v1 offset:13312
    s_add_u32 m0, s22, 38912
    v_mfma_f32_16x16x32_bf16 v[252:255], a[236:239], v[28:31], v[252:255]
    v_exp_f32_e64 v64, v64 clamp
    v_mfma_f32_16x16x32_bf16 v[204:207], a[236:239], v[20:23], v[204:207]
    buffer_load_dwordx4 v6, s[8:11], s21 offen lds
    v_mfma_f32_16x16x32_bf16 v[156:159], a[236:239], v[16:19], v[156:159]
    s_waitcnt lgkmcnt(2)
    ds_read_b128 a[232:235], v0 offset:14336
    v_fma_f32 v66, v66, s28, v10
    v_mfma_f32_16x16x32_bf16 v[52:55], a[216:219], a[96:99], 0
    v_exp_f32_e64 v69, v69 clamp
    v_mfma_f32_16x16x32_bf16 v[52:55], a[220:223], a[100:103], v[52:55]
    s_waitcnt lgkmcnt(2)
    v_cvt_pk_bf16_f32 v23, v62, v63
    v_cvt_pk_bf16_f32 v27, v70, v71
    v_mfma_f32_16x16x32_bf16 v[52:55], a[224:227], a[104:107], v[52:55]
    v_cvt_pk_bf16_f32 v22, v60, v61
    v_cvt_pk_bf16_f32 v26, v68, v69
    v_mfma_f32_16x16x32_bf16 v[60:63], a[224:227], a[128:131], 0
    ds_read_b128 a[236:239], v1 offset:14336
    v_mfma_f32_16x16x32_bf16 v[60:63], a[220:223], a[124:127], v[60:63]
    v_fma_f32 v75, v75, s28, v11
    v_cvt_pk_bf16_f32 v35, v78, v79
    v_mfma_f32_16x16x32_bf16 v[60:63], a[216:219], a[120:123], v[60:63]
    v_cvt_pk_bf16_f32 v17, v58, v59
    v_cvt_pk_bf16_f32 v34, v76, v77
    v_mfma_f32_16x16x32_bf16 v[68:71], a[216:219], a[144:147], 0
    v_exp_f32_e64 v82, v82 clamp
    v_mfma_f32_16x16x32_bf16 v[68:71], a[220:223], a[148:151], v[68:71]
    v_exp_f32_e64 v66, v66 clamp
    v_mfma_f32_16x16x32_bf16 v[68:71], a[224:227], a[152:155], v[68:71]
    v_cvt_pk_bf16_f32 v28, v72, v73
    v_mfma_f32_16x16x32_bf16 v[76:79], a[224:227], a[176:179], 0
    buffer_store_dwordx4 v[88:91], v6, s[16:19], s24 offen offset:0 nt
    ds_read_b128 a[224:227], v0 offset:19456
    v_exp_f32_e64 v56, v56 clamp
    v_mfma_f32_16x16x32_bf16 v[76:79], a[220:223], a[172:175], v[76:79]
    v_exp_f32_e64 v83, v83 clamp
    v_mfma_f32_16x16x32_bf16 v[76:79], a[216:219], a[168:171], v[76:79]
    s_waitcnt lgkmcnt(2)
    v_exp_f32_e64 v67, v67 clamp
    v_mfma_f32_16x16x32_bf16 v[76:79], a[228:231], a[180:183], v[76:79]
    v_exp_f32_e64 v80, v80 clamp
    v_mfma_f32_16x16x32_bf16 v[76:79], a[232:235], a[184:187], v[76:79]
    s_waitcnt lgkmcnt(1)
    v_exp_f32_e64 v81, v81 clamp
    v_mfma_f32_16x16x32_bf16 v[76:79], a[236:239], a[188:191], v[76:79]
    ds_read_b128 a[216:219], v0 offset:18432
    v_cvt_pk_bf16_f32 v37, v82, v83
    v_mfma_f32_16x16x32_bf16 v[68:71], a[236:239], a[164:167], v[68:71]
    s_add_u32 s21, s21, 12032
    v_exp_f32_e64 v75, v75 clamp
    v_mfma_f32_16x16x32_bf16 v[68:71], a[232:235], a[160:163], v[68:71]
    s_add_u32 s57, s24, 128
    v_mfma_f32_16x16x32_bf16 v[68:71], a[228:231], a[156:159], v[68:71]
    v_cvt_pk_bf16_f32 v29, v74, v75
    v_mfma_f32_16x16x32_bf16 v[60:63], a[228:231], a[132:135], v[60:63]
    v_fma_f32 v57, v57, s28, v9
    v_mfma_f32_16x16x32_bf16 v[60:63], a[232:235], a[136:139], v[60:63]
    ds_read_b128 a[220:223], v1 offset:18432
    v_cvt_pk_bf16_f32 v25, v66, v67
    v_mfma_f32_16x16x32_bf16 v[60:63], a[236:239], a[140:143], v[60:63]
    v_exp_f32_e64 v57, v57 clamp
    v_mfma_f32_16x16x32_bf16 v[52:55], a[236:239], a[116:119], v[52:55]
    ds_read_b128 v[88:91], v103 offset:3072
    v_cvt_pk_bf16_f32 v24, v64, v65
    v_mfma_f32_16x16x32_bf16 v[52:55], a[232:235], a[112:115], v[52:55]
    v_cvt_pk_bf16_f32 v36, v80, v81
    v_cvt_pk_bf16_f32 v16, v56, v57
    v_mfma_f32_16x16x32_bf16 v[52:55], a[228:231], a[108:111], v[52:55]
    ds_read_b128 a[236:239], v1 offset:20480
    v_mfma_f32_16x16x32_bf16 v[44:47], a[248:251], v[14:17], v[44:47]
    ds_read_b128 a[228:231], v1 offset:19456
    v_smfmac_f32_16x16x64_bf16 v[44:47], a[240:243], v[22:29], v101
    ds_read_b128 a[232:235], v0 offset:20480
    v_mfma_f32_16x16x32_bf16 v[44:47], a[252:255], v[34:37], v[44:47]
    buffer_store_dwordx4 v[96:99], v7, s[16:19], s24 offen offset:0 nt
    s_waitcnt lgkmcnt(5)
    v_mfma_f32_16x16x32_bf16 v[56:59], a[216:219], a[96:99], 0
    s_waitcnt lgkmcnt(4)
    v_mfma_f32_16x16x32_bf16 v[56:59], a[220:223], a[100:103], v[56:59]
    v_mfma_f32_16x16x32_bf16 v[56:59], a[224:227], a[104:107], v[56:59]
    buffer_store_dwordx4 v[84:87], v6, s[16:19], s57 offen offset:0 nt
    v_mfma_f32_16x16x32_bf16 v[64:67], a[224:227], a[128:131], 0
    v_cmp_lt_f32 vcc, s29, v44
    v_mfma_f32_16x16x32_bf16 v[64:67], a[220:223], a[124:127], v[64:67]
    v_mfma_f32_16x16x32_bf16 v[64:67], a[216:219], a[120:123], v[64:67]
    s_waitcnt vmcnt(9) lgkmcnt(0)
    v_mfma_f32_16x16x32_bf16 v[72:75], a[216:219], a[144:147], 0
    s_barrier
    v_mfma_f32_16x16x32_bf16 v[72:75], a[220:223], a[148:151], v[72:75]
    s_cbranch_vccnz L_rs_end4a
L_ret_end4a:
    v_mfma_f32_16x16x32_bf16 v[72:75], a[224:227], a[152:155], v[72:75]
    v_fma_f32 v60, v60, s28, v10
    v_mfma_f32_16x16x32_bf16 v[80:83], a[224:227], a[176:179], 0
    v_fma_f32 v55, v55, s28, v9
    v_fma_f32 v54, v54, s28, v9
    v_mfma_f32_16x16x32_bf16 v[80:83], a[220:223], a[172:175], v[80:83]
    v_exp_f32_e64 v55, v55 clamp
    v_mfma_f32_16x16x32_bf16 v[80:83], a[216:219], a[168:171], v[80:83]
    ds_read_b64_tr_b16 a[216:217], v2 offset:0
    v_mfma_f32_16x16x32_bf16 v[80:83], a[228:231], a[180:183], v[80:83]
    ds_read_b64_tr_b16 a[218:219], v2 offset:6144
    v_fma_f32 v53, v53, s28, v9
    v_mfma_f32_16x16x32_bf16 v[80:83], a[232:235], a[184:187], v[80:83]
    ds_read_b64_tr_b16 a[220:221], v3 offset:0
    v_fma_f32 v52, v52, s28, v9
    v_mfma_f32_16x16x32_bf16 v[80:83], a[236:239], a[188:191], v[80:83]
    v_exp_f32_e64 v53, v53 clamp
    v_mfma_f32_16x16x32_bf16 v[72:75], a[236:239], a[164:167], v[72:75]
    v_exp_f32_e64 v52, v52 clamp
    v_mfma_f32_16x16x32_bf16 v[72:75], a[232:235], a[160:163], v[72:75]
    v_cvt_pk_bf16_f32 v18, v52, v53
    v_mfma_f32_16x16x32_bf16 v[72:75], a[228:231], a[156:159], v[72:75]
    ds_read_b64_tr_b16 a[222:223], v3 offset:6144
    v_mfma_f32_16x16x32_bf16 v[64:67], a[228:231], a[132:135], v[64:67]
    v_exp_f32_e64 v54, v54 clamp
    v_mfma_f32_16x16x32_bf16 v[64:67], a[232:235], a[136:139], v[64:67]
    ds_read_b64_tr_b16 a[224:225], v4 offset:0
    v_fma_f32 v61, v61, s28, v10
    v_mfma_f32_16x16x32_bf16 v[64:67], a[236:239], a[140:143], v[64:67]
    v_exp_f32_e64 v60, v60 clamp
    v_mfma_f32_16x16x32_bf16 v[56:59], a[236:239], a[116:119], v[56:59]
    buffer_store_dwordx4 v[88:91], v7, s[16:19], s57 offen offset:0 nt
    v_exp_f32_e64 v61, v61 clamp
    v_cvt_pk_bf16_f32 v19, v54, v55
    v_mfma_f32_16x16x32_bf16 v[56:59], a[232:235], a[112:115], v[56:59]
    s_waitcnt lgkmcnt(2)
    ds_read_b64_tr_b16 a[226:227], v4 offset:6144
    v_mfma_f32_16x16x32_bf16 v[56:59], a[228:231], a[108:111], v[56:59]
    ds_read_b64_tr_b16 a[228:229], v5 offset:0
    ds_read_b64_tr_b16 a[230:231], v5 offset:6144
    v_fma_f32 v83, v83, s28, v12
    v_fma_f32 v73, v73, s28, v11
    v_mfma_f32_16x16x32_bf16 v[112:115], a[216:219], v[14:17], v[112:115]
    v_fma_f32 v76, v76, s28, v12
    v_fma_f32 v77, v77, s28, v12
    v_mfma_f32_16x16x32_bf16 v[160:163], a[216:219], v[22:25], v[160:163]
    s_add_u32 s39, s39, 12288
    ds_read_b64_tr_b16 a[232:233], v2 offset:1024
    v_exp_f32_e64 v76, v76 clamp
    v_mfma_f32_16x16x32_bf16 v[208:211], a[216:219], v[26:29], v[208:211]
    v_fma_f32 v58, v58, s28, v9
    v_fma_f32 v64, v64, s28, v10
    v_mfma_f32_16x16x32_bf16 a[0:3], a[216:219], v[34:37], a[0:3]
    s_waitcnt lgkmcnt(5)
    ds_read_b64_tr_b16 a[234:235], v2 offset:7168
    v_fma_f32 v65, v65, s28, v10
    v_mfma_f32_16x16x32_bf16 a[4:7], a[220:223], v[34:37], a[4:7]
    ds_read_b64_tr_b16 a[216:217], v4 offset:1024
    v_fma_f32 v79, v79, s28, v12
    v_mfma_f32_16x16x32_bf16 v[212:215], a[220:223], v[26:29], v[212:215]
    v_fma_f32 v66, v66, s28, v10
    v_fma_f32 v81, v81, s28, v12
    v_mfma_f32_16x16x32_bf16 v[164:167], a[220:223], v[22:25], v[164:167]
    s_waitcnt vmcnt(4)
    ds_read_b64_tr_b16 a[238:239], v3 offset:7168
    v_fma_f32 v63, v63, s28, v10
    v_mfma_f32_16x16x32_bf16 v[116:119], a[220:223], v[14:17], v[116:119]
    s_waitcnt lgkmcnt(6)
    v_exp_f32_e64 v65, v65 clamp
    v_mfma_f32_16x16x32_bf16 v[120:123], a[224:227], v[14:17], v[120:123]
    s_barrier
    v_fma_f32 v75, v75, s28, v11
    v_mfma_f32_16x16x32_bf16 v[168:171], a[224:227], v[22:25], v[168:171]
    ds_read_b64_tr_b16 a[236:237], v3 offset:1024
    v_fma_f32 v70, v70, s28, v11
    v_mfma_f32_16x16x32_bf16 v[216:219], a[224:227], v[26:29], v[216:219]
    v_exp_f32_e64 v66, v66 clamp
    v_fma_f32 v74, v74, s28, v11
    v_mfma_f32_16x16x32_bf16 a[8:11], a[224:227], v[34:37], a[8:11]
    s_waitcnt lgkmcnt(4)
    v_fma_f32 v71, v71, s28, v11
    v_fma_f32 v59, v59, s28, v9
    v_mfma_f32_16x16x32_bf16 a[12:15], a[228:231], v[34:37], a[12:15]
    v_fma_f32 v72, v72, s28, v11
    v_exp_f32_e64 v83, v83 clamp
    v_mfma_f32_16x16x32_bf16 v[220:223], a[228:231], v[26:29], v[220:223]
    ds_read_b64_tr_b16 a[218:219], v4 offset:7168
    v_fma_f32 v56, v56, s28, v9
    v_mfma_f32_16x16x32_bf16 v[172:175], a[228:231], v[22:25], v[172:175]
    ds_read_b64_tr_b16 a[222:223], v5 offset:7168
    v_fma_f32 v68, v68, s28, v11
    v_mfma_f32_16x16x32_bf16 v[124:127], a[228:231], v[14:17], v[124:127]
    s_waitcnt lgkmcnt(3)
    ds_read_b64_tr_b16 a[224:225], v2 offset:2048
    v_fma_f32 v82, v82, s28, v12
    v_mfma_f32_16x16x32_bf16 v[128:131], a[232:235], v[14:17], v[128:131]
    ds_read_b64_tr_b16 a[220:221], v5 offset:1024
    v_fma_f32 v80, v80, s28, v12
    v_mfma_f32_16x16x32_bf16 v[176:179], a[232:235], v[22:25], v[176:179]
    ds_read_b64_tr_b16 a[226:227], v2 offset:8192
    v_fma_f32 v67, v67, s28, v10
    v_exp_f32_e64 v68, v68 clamp
    v_mfma_f32_16x16x32_bf16 v[224:227], a[232:235], v[26:29], v[224:227]
    v_exp_f32_e64 v67, v67 clamp
    v_mfma_f32_16x16x32_bf16 a[16:19], a[232:235], v[34:37], a[16:19]
    s_waitcnt lgkmcnt(5)
    ds_read_b64_tr_b16 a[228:229], v3 offset:2048
    v_fma_f32 v62, v62, s28, v10
    v_mfma_f32_16x16x32_bf16 a[20:23], a[236:239], v[34:37], a[20:23]
    v_exp_f32_e64 v56, v56 clamp
    v_mfma_f32_16x16x32_bf16 v[228:231], a[236:239], v[26:29], v[228:231]
    v_exp_f32_e64 v79, v79 clamp
    v_mfma_f32_16x16x32_bf16 v[180:183], a[236:239], v[22:25], v[180:183]
    ds_read_b64_tr_b16 a[234:235], v4 offset:8192
    v_fma_f32 v69, v69, s28, v11
    v_mfma_f32_16x16x32_bf16 v[132:135], a[236:239], v[14:17], v[132:135]
    s_waitcnt lgkmcnt(6)
    v_exp_f32_e64 v74, v74 clamp
    v_mfma_f32_16x16x32_bf16 v[136:139], a[216:219], v[14:17], v[136:139]
    ds_read_b64_tr_b16 a[230:231], v3 offset:8192
    v_fma_f32 v78, v78, s28, v12
    v_mfma_f32_16x16x32_bf16 v[184:187], a[216:219], v[22:25], v[184:187]
    v_exp_f32_e64 v72, v72 clamp
    v_mfma_f32_16x16x32_bf16 v[232:235], a[216:219], v[26:29], v[232:235]
    ds_read_b64_tr_b16 a[232:233], v4 offset:2048
    v_exp_f32_e64 v81, v81 clamp
    v_mfma_f32_16x16x32_bf16 a[24:27], a[216:219], v[34:37], a[24:27]
    s_waitcnt lgkmcnt(4)
    v_exp_f32_e64 v69, v69 clamp
    v_mfma_f32_16x16x32_bf16 a[28:31], a[220:223], v[34:37], a[28:31]
    v_exp_f32_e64 v71, v71 clamp
    v_mfma_f32_16x16x32_bf16 v[236:239], a[220:223], v[26:29], v[236:239]
    ds_read_b64_tr_b16 a[216:217], v2 offset:18432
    v_cvt_pk_bf16_f32 v21, v66, v67
    v_exp_f32_e64 v63, v63 clamp
    v_mfma_f32_16x16x32_bf16 v[188:191], a[220:223], v[22:25], v[188:191]
    v_exp_f32_e64 v64, v64 clamp
    v_mfma_f32_16x16x32_bf16 v[140:143], a[220:223], v[14:17], v[140:143]
    v_exp_f32_e64 v78, v78 clamp
    v_mfma_f32_16x16x32_bf16 v[144:147], a[224:227], v[14:17], v[144:147]
    ds_read_b64_tr_b16 a[238:239], v5 offset:8192
    v_exp_f32_e64 v62, v62 clamp
    v_mfma_f32_16x16x32_bf16 v[192:195], a[224:227], v[22:25], v[192:195]
    v_exp_f32_e64 v82, v82 clamp
    v_mfma_f32_16x16x32_bf16 v[240:243], a[224:227], v[26:29], v[240:243]
    ds_read_b64_tr_b16 a[236:237], v5 offset:2048
    v_exp_f32_e64 v70, v70 clamp
    v_mfma_f32_16x16x32_bf16 a[32:35], a[224:227], v[34:37], a[32:35]
    s_waitcnt lgkmcnt(3)
    v_exp_f32_e64 v73, v73 clamp
    v_mfma_f32_16x16x32_bf16 a[36:39], a[228:231], v[34:37], a[36:39]
    v_exp_f32_e64 v80, v80 clamp
    v_mfma_f32_16x16x32_bf16 v[244:247], a[228:231], v[26:29], v[244:247]
    ds_read_b64_tr_b16 a[218:219], v2 offset:12288
    v_cvt_pk_bf16_f32 v30, v68, v69
    v_mfma_f32_16x16x32_bf16 v[196:199], a[228:231], v[22:25], v[196:199]
    v_cvt_pk_bf16_f32 v33, v82, v83
    v_exp_f32_e64 v75, v75 clamp
    v_mfma_f32_16x16x32_bf16 v[148:151], a[228:231], v[14:17], v[148:151]
    v_cvt_pk_bf16_f32 v20, v64, v65
    v_fma_f32 v57, v57, s28, v9
    v_mfma_f32_16x16x32_bf16 v[152:155], a[232:235], v[14:17], v[152:155]
    ds_read_b64_tr_b16 a[220:221], v3 offset:18432
    v_exp_f32_e64 v57, v57 clamp
    v_mfma_f32_16x16x32_bf16 v[200:203], a[232:235], v[22:25], v[200:203]
    ds_read_b64_tr_b16 a[222:223], v3 offset:12288
    v_cvt_pk_bf16_f32 v32, v80, v81
    v_mfma_f32_16x16x32_bf16 v[248:251], a[232:235], v[26:29], v[248:251]
    ds_read_b64_tr_b16 a[224:225], v4 offset:18432
    v_exp_f32_e64 v77, v77 clamp
    v_mfma_f32_16x16x32_bf16 a[40:43], a[232:235], v[34:37], a[40:43]
    s_waitcnt lgkmcnt(4)
    v_exp_f32_e64 v58, v58 clamp
    v_mfma_f32_16x16x32_bf16 a[44:47], a[236:239], v[34:37], a[44:47]
    v_exp_f32_e64 v59, v59 clamp
    v_mfma_f32_16x16x32_bf16 v[252:255], a[236:239], v[26:29], v[252:255]
    ds_read_b64_tr_b16 a[226:227], v4 offset:12288
    v_cvt_pk_bf16_f32 v29, v74, v75
    v_mfma_f32_16x16x32_bf16 v[204:207], a[236:239], v[22:25], v[204:207]
    v_cvt_pk_bf16_f32 v22, v60, v61
    v_cvt_pk_bf16_f32 v23, v62, v63
    v_mfma_f32_16x16x32_bf16 v[156:159], a[236:239], v[14:17], v[156:159]
    v_cvt_pk_bf16_f32 v17, v58, v59
    v_cvt_pk_bf16_f32 v16, v56, v57
    v_cvt_pk_bf16_f32 v28, v72, v73
    v_cvt_pk_bf16_f32 v31, v70, v71
    v_cvt_pk_bf16_f32 v34, v76, v77
    v_cvt_pk_bf16_f32 v35, v78, v79
    v_smfmac_f32_16x16x64_bf16 v[48:51], a[240:243], v[16:23], v101
    ds_read_b64_tr_b16 a[228:229], v5 offset:18432
    v_smfmac_f32_16x16x64_bf16 v[48:51], a[244:247], v[28:35], v101
    s_waitcnt lgkmcnt(4)
    s_nop 6
    v_cmp_lt_f32 vcc, s29, v48
    s_nop 4
    s_cbranch_vccnz L_rs_end4b
L_ret_end4b:
    ds_read_b64_tr_b16 a[230:231], v5 offset:12288
    v_mov_b32 v111, v46
    v_lshrrev_b32 v108, 11, v0
    v_and_b32 v93, 0x3ff, v0
    v_mov_b32 v109, v50
    v_mov_b32 v110, v45
    v_xor_b32 v108, s65, v108
    v_lshl_add_u32 v93, v108, 10, v93
    v_permlane16_swap_b32 v50, v109
    v_mbcnt_lo_u32_b32 v108, -1, 0
    v_add_f32 v50, v50, v109
    v_mbcnt_hi_u32_b32 v108, -1, v108
    v_lshrrev_b32 v108, 1, v108
    v_and_b32 v108, 24, v108
    v_permlane16_swap_b32 v46, v111
    v_add_u32 v93, s38, v93
    v_permlane16_swap_b32 v45, v110
    v_add_f32 v46, v46, v111
    v_add_f32 v45, v45, v110
    v_bfe_u32 v108, s66, v108, 8
    v_mov_b32 v111, v46
    v_mov_b32 v109, v50
    v_xor_b32 v93, v93, v108
    v_mov_b32 v110, v45
    v_mov_b32 v108, v49
    v_permlane32_swap_b32 v46, v111
    v_permlane32_swap_b32 v45, v110
    v_permlane16_swap_b32 v49, v108
    v_add_f32 v49, v49, v108
    v_permlane32_swap_b32 v50, v109
    v_mov_b32 v108, v49
    v_add_f32 v50, v50, v110
    v_add_f32 v94, v109, v46
    v_permlane32_swap_b32 v49, v108
    v_rcp_f32 v94, v94
    v_add_f32 v92, v108, v45
    v_add_f32 v48, v49, v47
    v_rcp_f32 v48, v48
    v_rcp_f32 v50, v50
    v_rcp_f32 v92, v92
    v_mfma_f32_16x16x32_bf16 v[112:115], a[216:219], v[16:19], v[112:115]
    ds_read_b64_tr_b16 a[238:239], v3 offset:13312
    v_mfma_f32_16x16x32_bf16 v[160:163], a[216:219], v[20:23], v[160:163]
    v_mfma_f32_16x16x32_bf16 v[208:211], a[216:219], v[28:31], v[208:211]
    ds_read_b64_tr_b16 a[232:233], v2 offset:19456
    v_mfma_f32_16x16x32_bf16 a[0:3], a[216:219], v[32:35], a[0:3]
    s_waitcnt lgkmcnt(6)
    v_mfma_f32_16x16x32_bf16 a[4:7], a[220:223], v[32:35], a[4:7]
    ds_read_b64_tr_b16 a[234:235], v2 offset:13312
    v_xor_b32 v102, 96, v93
    v_mfma_f32_16x16x32_bf16 v[212:215], a[220:223], v[28:31], v[212:215]
    ds_read_b64_tr_b16 a[218:219], v4 offset:13312
    v_mfma_f32_16x16x32_bf16 v[164:167], a[220:223], v[20:23], v[164:167]
    v_mfma_f32_16x16x32_bf16 v[116:119], a[220:223], v[16:19], v[116:119]
    s_waitcnt lgkmcnt(6)
    v_mfma_f32_16x16x32_bf16 v[120:123], a[224:227], v[16:19], v[120:123]
    v_xor_b32 v8, 64, v93
    v_mfma_f32_16x16x32_bf16 v[168:171], a[224:227], v[20:23], v[168:171]
    ds_read_b64_tr_b16 a[236:237], v3 offset:19456
    v_accvgpr_read_b32 v107, a3
    v_mfma_f32_16x16x32_bf16 v[216:219], a[224:227], v[28:31], v[216:219]
    v_accvgpr_read_b32 v105, a1
    v_mfma_f32_16x16x32_bf16 a[8:11], a[224:227], v[32:35], a[8:11]
    s_waitcnt lgkmcnt(4)
    ds_read_b64_tr_b16 a[220:221], v5 offset:19456
    v_accvgpr_read_b32 v110, a6
    v_mfma_f32_16x16x32_bf16 a[12:15], a[228:231], v[32:35], a[12:15]
    s_add_u32 s84, s34, 0
    ds_read_b64_tr_b16 a[216:217], v4 offset:19456
    v_mfma_f32_16x16x32_bf16 v[220:223], a[228:231], v[28:31], v[220:223]
    ds_read_b64_tr_b16 a[226:227], v2 offset:14336
    s_add_u32 s85, s34, 6144
    v_mfma_f32_16x16x32_bf16 v[172:175], a[228:231], v[20:23], v[172:175]
    ds_read_b64_tr_b16 a[222:223], v5 offset:13312
    v_mfma_f32_16x16x32_bf16 v[124:127], a[228:231], v[16:19], v[124:127]
    s_waitcnt lgkmcnt(5)
    ds_read_b64_tr_b16 a[224:225], v2 offset:20480
    v_accvgpr_read_b32 v56, a12
    v_mfma_f32_16x16x32_bf16 v[128:131], a[232:235], v[16:19], v[128:131]
    v_accvgpr_read_b32 v109, a5
    v_mfma_f32_16x16x32_bf16 v[176:179], a[232:235], v[20:23], v[176:179]
    v_subrev_u32 v103, 24576, v103
    v_accvgpr_read_b32 v57, a13
    v_mfma_f32_16x16x32_bf16 v[224:227], a[232:235], v[28:31], v[224:227]
    v_mfma_f32_16x16x32_bf16 a[16:19], a[232:235], v[32:35], a[16:19]
    v_accvgpr_read_b32 v108, a4
    ds_read_b64_tr_b16 a[230:231], v3 offset:14336
    s_add_u32 s86, s34, 12288
    v_pk_mul_f32 v[160:161], v[160:161], v[92:93] op_sel_hi:[1,0]
    v_pk_mul_f32 v[220:221], v[220:221], v[50:51] op_sel_hi:[1,0]
    v_pk_mul_f32 v[120:121], v[120:121], v[48:49] op_sel_hi:[1,0]
    v_pk_mul_f32 v[116:117], v[116:117], v[48:49] op_sel_hi:[1,0]
    v_pk_mul_f32 v[164:165], v[164:165], v[92:93] op_sel_hi:[1,0]
    v_pk_mul_f32 v[168:169], v[168:169], v[92:93] op_sel_hi:[1,0]
    v_pk_mul_f32 v[172:173], v[172:173], v[92:93] op_sel_hi:[1,0]
    v_pk_mul_f32 v[114:115], v[114:115], v[48:49] op_sel_hi:[1,0]
    v_pk_mul_f32 v[130:131], v[130:131], v[48:49] op_sel_hi:[1,0]
    v_pk_mul_f32 v[112:113], v[112:113], v[48:49] op_sel_hi:[1,0]
    v_pk_mul_f32 v[170:171], v[170:171], v[92:93] op_sel_hi:[1,0]
    v_pk_mul_f32 v[162:163], v[162:163], v[92:93] op_sel_hi:[1,0]
    v_pk_mul_f32 v[174:175], v[174:175], v[92:93] op_sel_hi:[1,0]
    v_accvgpr_read_b32 v54, a10
    s_waitcnt lgkmcnt(2)
    v_mfma_f32_16x16x32_bf16 a[20:23], a[236:239], v[32:35], a[20:23]
    v_mfma_f32_16x16x32_bf16 v[228:231], a[236:239], v[28:31], v[228:231]
    ds_read_b64_tr_b16 a[228:229], v3 offset:20480
    v_mfma_f32_16x16x32_bf16 v[180:183], a[236:239], v[20:23], v[180:183]
    v_cvt_pk_bf16_f32 v120, v120, v121
    v_mfma_f32_16x16x32_bf16 v[132:135], a[236:239], v[16:19], v[132:135]
    v_xor_b32 v95, 32, v93
    v_accvgpr_read_b32 v104, a0
    v_mfma_f32_16x16x32_bf16 v[136:139], a[216:219], v[16:19], v[136:139]
    v_cvt_pk_bf16_f32 v112, v112, v113
    v_mfma_f32_16x16x32_bf16 v[184:187], a[216:219], v[20:23], v[184:187]
    v_cvt_pk_bf16_f32 v164, v164, v165
    v_mfma_f32_16x16x32_bf16 v[232:235], a[216:219], v[28:31], v[232:235]
    ds_read_b64_tr_b16 a[232:233], v4 offset:20480
    v_cvt_pk_bf16_f32 v220, v220, v221
    v_mfma_f32_16x16x32_bf16 a[24:27], a[216:219], v[32:35], a[24:27]
    ds_read_b64_tr_b16 a[238:239], v5 offset:14336
    v_cvt_pk_bf16_f32 v168, v168, v169
    v_mfma_f32_16x16x32_bf16 a[28:31], a[220:223], v[32:35], a[28:31]
    v_mfma_f32_16x16x32_bf16 v[236:239], a[220:223], v[28:31], v[236:239]
    ds_read_b64_tr_b16 a[234:235], v4 offset:14336
    v_mfma_f32_16x16x32_bf16 v[188:191], a[220:223], v[20:23], v[188:191]
    v_accvgpr_read_b32 v52, a8
    v_mfma_f32_16x16x32_bf16 v[140:143], a[220:223], v[16:19], v[140:143]
    s_waitcnt lgkmcnt(3)
    v_cvt_pk_bf16_f32 v116, v116, v117
    v_cvt_pk_bf16_f32 v113, v114, v115
    v_mfma_f32_16x16x32_bf16 v[144:147], a[224:227], v[16:19], v[144:147]
    v_cvt_pk_bf16_f32 v160, v160, v161
    v_mfma_f32_16x16x32_bf16 v[192:195], a[224:227], v[20:23], v[192:195]
    v_cvt_pk_bf16_f32 v161, v162, v163
    v_cvt_pk_bf16_f32 v172, v172, v173
    v_mfma_f32_16x16x32_bf16 v[240:243], a[224:227], v[28:31], v[240:243]
    s_add_u32 s87, s34, 18432
    v_cvt_pk_bf16_f32 v169, v170, v171
    v_mfma_f32_16x16x32_bf16 a[32:35], a[224:227], v[32:35], a[32:35]
    ds_write2st64_b64 v93, v[112:113], v[160:161] offset0:0 offset1:12
    v_pk_mul_f32 v[118:119], v[118:119], v[48:49] op_sel_hi:[1,0]
    v_pk_mul_f32 v[126:127], v[126:127], v[48:49] op_sel_hi:[1,0]
    v_pk_mul_f32 v[122:123], v[122:123], v[48:49] op_sel_hi:[1,0]
    v_pk_mul_f32 v[124:125], v[124:125], v[48:49] op_sel_hi:[1,0]
    v_pk_mul_f32 v[166:167], v[166:167], v[92:93] op_sel_hi:[1,0]
    v_cvt_pk_bf16_f32 v121, v122, v123
    v_cvt_pk_bf16_f32 v165, v166, v167
    v_mfma_f32_16x16x32_bf16 a[36:39], a[228:231], v[32:35], a[36:39]
    v_cvt_pk_bf16_f32 v117, v118, v119
    v_cvt_pk_bf16_f32 v124, v124, v125
    v_mfma_f32_16x16x32_bf16 v[244:247], a[228:231], v[28:31], v[244:247]
    v_accvgpr_read_b32 v53, a9
    v_cvt_pk_bf16_f32 v125, v126, v127
    v_mfma_f32_16x16x32_bf16 v[196:199], a[228:231], v[20:23], v[196:199]
    ds_read_b64_tr_b16 a[236:237], v5 offset:20480
    v_cvt_pk_bf16_f32 v173, v174, v175
    v_mfma_f32_16x16x32_bf16 v[148:151], a[228:231], v[16:19], v[148:151]
    s_waitcnt lgkmcnt(2)
    ds_write2st64_b64 v95, v[116:117], v[164:165] offset0:0 offset1:12
    v_mfma_f32_16x16x32_bf16 v[152:155], a[232:235], v[16:19], v[152:155]
    ds_write2st64_b64 v8, v[120:121], v[168:169] offset0:0 offset1:12
    v_mfma_f32_16x16x32_bf16 v[200:203], a[232:235], v[20:23], v[200:203]
    ds_write2st64_b64 v102, v[124:125], v[172:173] offset0:0 offset1:12
    v_mfma_f32_16x16x32_bf16 v[248:251], a[232:235], v[28:31], v[248:251]
    ds_read_b128 v[80:83], v103 offset:0
    v_pk_mul_f32 v[208:209], v[208:209], v[50:51] op_sel_hi:[1,0]
    v_pk_mul_f32 v[216:217], v[216:217], v[50:51] op_sel_hi:[1,0]
    v_accvgpr_read_b32 v59, a15
    v_cvt_pk_bf16_f32 v208, v208, v209
    v_accvgpr_read_b32 v111, a7
    v_pk_mul_f32 v[128:129], v[128:129], v[48:49] op_sel_hi:[1,0]
    s_add_u32 s18, s34, 24576
    v_pk_mul_f32 v[214:215], v[214:215], v[50:51] op_sel_hi:[1,0]
    v_pk_mul_f32 v[224:225], v[224:225], v[50:51] op_sel_hi:[1,0]
    v_accvgpr_read_b32 v55, a11
    v_accvgpr_read_b32 v106, a2
    v_pk_mul_f32 v[186:187], v[186:187], v[92:93] op_sel_hi:[1,0]
    v_pk_mul_f32 v[52:53], v[52:53], v[94:95] op_sel_hi:[1,0]
    v_pk_mul_f32 v[218:219], v[218:219], v[50:51] op_sel_hi:[1,0]
    v_pk_mul_f32 v[210:211], v[210:211], v[50:51] op_sel_hi:[1,0]
    s_nop 1
    v_mfma_f32_16x16x32_bf16 a[40:43], a[232:235], v[32:35], a[40:43]
    s_waitcnt lgkmcnt(3)
    ds_read_b128 v[84:87], v103 offset:1024
    v_mfma_f32_16x16x32_bf16 a[44:47], a[236:239], v[32:35], a[44:47]
    v_pk_mul_f32 v[228:229], v[228:229], v[50:51] op_sel_hi:[1,0]
    v_pk_mul_f32 v[212:213], v[212:213], v[50:51] op_sel_hi:[1,0]
    v_pk_mul_f32 v[230:231], v[230:231], v[50:51] op_sel_hi:[1,0]
    v_pk_mul_f32 v[136:137], v[136:137], v[48:49] op_sel_hi:[1,0]
    s_waitcnt lgkmcnt(1)
    buffer_store_dwordx4 v[80:83], v6, s[16:19], s84 offen offset:0 nt
    v_pk_mul_f32 v[106:107], v[106:107], v[94:95] op_sel_hi:[1,0]
    v_pk_mul_f32 v[132:133], v[132:133], v[48:49] op_sel_hi:[1,0]
    v_pk_mul_f32 v[56:57], v[56:57], v[94:95] op_sel_hi:[1,0]
    v_cvt_pk_bf16_f32 v52, v52, v53
    v_pk_mul_f32 v[196:197], v[196:197], v[92:93] op_sel_hi:[1,0]
    v_pk_mul_f32 v[110:111], v[110:111], v[94:95] op_sel_hi:[1,0]
    v_pk_mul_f32 v[104:105], v[104:105], v[94:95] op_sel_hi:[1,0]
    v_pk_mul_f32 v[140:141], v[140:141], v[48:49] op_sel_hi:[1,0]
    v_pk_mul_f32 v[192:193], v[192:193], v[92:93] op_sel_hi:[1,0]
    v_pk_mul_f32 v[178:179], v[178:179], v[92:93] op_sel_hi:[1,0]
    v_pk_mul_f32 v[108:109], v[108:109], v[94:95] op_sel_hi:[1,0]
    v_cvt_pk_bf16_f32 v56, v56, v57
    v_cvt_pk_bf16_f32 v212, v212, v213
    v_cvt_pk_bf16_f32 v216, v216, v217
    v_pk_mul_f32 v[54:55], v[54:55], v[94:95] op_sel_hi:[1,0]
    ds_read_b128 v[88:91], v103 offset:6144
    v_pk_mul_f32 v[234:235], v[234:235], v[50:51] op_sel_hi:[1,0]
    v_cvt_pk_bf16_f32 v108, v108, v109
    v_cvt_pk_bf16_f32 v53, v54, v55
    v_cvt_pk_bf16_f32 v104, v104, v105
    v_mfma_f32_16x16x32_bf16 v[252:255], a[236:239], v[28:31], v[252:255]
    v_cvt_pk_bf16_f32 v209, v210, v211
    ds_read_b128 v[60:63], v103 offset:7168
    v_mfma_f32_16x16x32_bf16 v[204:207], a[236:239], v[20:23], v[204:207]
    s_waitcnt lgkmcnt(2)
    buffer_store_dwordx4 v[84:87], v7, s[16:19], s84 offen offset:0 nt
    v_cvt_pk_bf16_f32 v109, v110, v111
    v_pk_mul_f32 v[248:249], v[248:249], v[50:51] op_sel_hi:[1,0]
    v_pk_mul_f32 v[200:201], v[200:201], v[92:93] op_sel_hi:[1,0]
    v_pk_mul_f32 v[222:223], v[222:223], v[50:51] op_sel_hi:[1,0]
    v_cvt_pk_bf16_f32 v128, v128, v129
    v_cvt_pk_bf16_f32 v228, v228, v229
    v_pk_mul_f32 v[144:145], v[144:145], v[48:49] op_sel_hi:[1,0]
    v_cvt_pk_bf16_f32 v213, v214, v215
    v_cvt_pk_bf16_f32 v229, v230, v231
    v_accvgpr_read_b32 v58, a14
    v_pk_mul_f32 v[190:191], v[190:191], v[92:93] op_sel_hi:[1,0]
    v_pk_mul_f32 v[58:59], v[58:59], v[94:95] op_sel_hi:[1,0]
    v_cvt_pk_bf16_f32 v105, v106, v107
    v_pk_mul_f32 v[188:189], v[188:189], v[92:93] op_sel_hi:[1,0]
    v_pk_mul_f32 v[138:139], v[138:139], v[48:49] op_sel_hi:[1,0]
    v_pk_mul_f32 v[252:253], v[252:253], v[50:51] op_sel_hi:[1,0]
    ds_write2st64_b64 v93, v[208:209], v[104:105] offset0:24 offset1:36
    s_nop 0
    v_mfma_f32_16x16x32_bf16 v[156:159], a[236:239], v[16:19], v[156:159]
    s_waitcnt lgkmcnt(2)
    v_cvt_pk_bf16_f32 v221, v222, v223
    v_cvt_pk_bf16_f32 v140, v140, v141
    v_cvt_pk_bf16_f32 v217, v218, v219
    buffer_store_dwordx4 v[88:91], v6, s[16:19], s85 offen offset:0 nt
    ds_write2st64_b64 v95, v[212:213], v[108:109] offset0:24 offset1:36
    v_pk_mul_f32 v[236:237], v[236:237], v[50:51] op_sel_hi:[1,0]
    v_pk_mul_f32 v[202:203], v[202:203], v[92:93] op_sel_hi:[1,0]
    v_pk_mul_f32 v[142:143], v[142:143], v[48:49] op_sel_hi:[1,0]
    v_pk_mul_f32 v[176:177], v[176:177], v[92:93] op_sel_hi:[1,0]
    v_accvgpr_read_b32 v109, a21
    v_cvt_pk_bf16_f32 v57, v58, v59
    v_pk_mul_f32 v[148:149], v[148:149], v[48:49] op_sel_hi:[1,0]
    v_accvgpr_read_b32 v111, a23
    ds_write2st64_b64 v8, v[216:217], v[52:53] offset0:24 offset1:36
    ds_write2st64_b64 v102, v[220:221], v[56:57] offset0:24 offset1:36
    ds_read_b128 v[64:67], v103 offset:12288
    v_cvt_pk_bf16_f32 v148, v148, v149
    s_waitcnt lgkmcnt(4)
    buffer_store_dwordx4 v[60:63], v7, s[16:19], s85 offen offset:0 nt
    v_pk_mul_f32 v[254:255], v[254:255], v[50:51] op_sel_hi:[1,0]
    v_cvt_pk_bf16_f32 v132, v132, v133
    ds_read_b128 v[68:71], v103 offset:13312
    v_accvgpr_read_b32 v110, a22
    v_cvt_pk_bf16_f32 v188, v188, v189
    v_pk_mul_f32 v[134:135], v[134:135], v[48:49] op_sel_hi:[1,0]
    v_accvgpr_read_b32 v104, a16
    v_accvgpr_read_b32 v59, a31
    v_accvgpr_read_b32 v105, a17
    v_cvt_pk_bf16_f32 v236, v236, v237
    v_accvgpr_read_b32 v108, a20
    v_pk_mul_f32 v[104:105], v[104:105], v[94:95] op_sel_hi:[1,0]
    v_accvgpr_read_b32 v56, a28
    v_cvt_pk_bf16_f32 v133, v134, v135
    v_pk_mul_f32 v[240:241], v[240:241], v[50:51] op_sel_hi:[1,0]
    v_pk_mul_f32 v[198:199], v[198:199], v[92:93] op_sel_hi:[1,0]
    v_pk_mul_f32 v[180:181], v[180:181], v[92:93] op_sel_hi:[1,0]
    v_cvt_pk_bf16_f32 v224, v224, v225
    v_cvt_pk_bf16_f32 v136, v136, v137
    v_cvt_pk_bf16_f32 v141, v142, v143
    v_cvt_pk_bf16_f32 v129, v130, v131
    s_waitcnt lgkmcnt(1)
    buffer_store_dwordx4 v[64:67], v6, s[16:19], s86 offen offset:0 nt
    v_cvt_pk_bf16_f32 v176, v176, v177
    v_pk_mul_f32 v[184:185], v[184:185], v[92:93] op_sel_hi:[1,0]
    v_cvt_pk_bf16_f32 v177, v178, v179
    v_accvgpr_read_b32 v55, a27
    v_pk_mul_f32 v[232:233], v[232:233], v[50:51] op_sel_hi:[1,0]
    v_pk_mul_f32 v[150:151], v[150:151], v[48:49] op_sel_hi:[1,0]
    v_pk_mul_f32 v[108:109], v[108:109], v[94:95] op_sel_hi:[1,0]
    v_cvt_pk_bf16_f32 v189, v190, v191
    v_pk_mul_f32 v[244:245], v[244:245], v[50:51] op_sel_hi:[1,0]
    ds_read_b128 v[72:75], v103 offset:18432
    v_cvt_pk_bf16_f32 v144, v144, v145
    v_cvt_pk_bf16_f32 v184, v184, v185
    v_accvgpr_read_b32 v54, a26
    v_accvgpr_read_b32 v107, a19
    v_cvt_pk_bf16_f32 v180, v180, v181
    v_cvt_pk_bf16_f32 v185, v186, v187
    v_pk_mul_f32 v[154:155], v[154:155], v[48:49] op_sel_hi:[1,0]
    v_accvgpr_read_b32 v53, a25
    v_cvt_pk_bf16_f32 v200, v200, v201
    v_accvgpr_read_b32 v57, a29
    v_pk_mul_f32 v[182:183], v[182:183], v[92:93] op_sel_hi:[1,0]
    v_pk_mul_f32 v[246:247], v[246:247], v[50:51] op_sel_hi:[1,0]
    v_pk_mul_f32 v[156:157], v[156:157], v[48:49] op_sel_hi:[1,0]
    v_cvt_pk_bf16_f32 v196, v196, v197
    v_cvt_pk_bf16_f32 v108, v108, v109
    v_pk_mul_f32 v[152:153], v[152:153], v[48:49] op_sel_hi:[1,0]
    s_waitcnt lgkmcnt(1)
    buffer_store_dwordx4 v[68:71], v7, s[16:19], s86 offen offset:0 nt
    ds_read_b128 v[76:79], v103 offset:19456
    v_pk_mul_f32 v[226:227], v[226:227], v[50:51] op_sel_hi:[1,0]
    v_cvt_pk_bf16_f32 v181, v182, v183
    v_cvt_pk_bf16_f32 v244, v244, v245
    v_pk_mul_f32 v[110:111], v[110:111], v[94:95] op_sel_hi:[1,0]
    v_pk_mul_f32 v[204:205], v[204:205], v[92:93] op_sel_hi:[1,0]
    v_cvt_pk_bf16_f32 v192, v192, v193
    v_cvt_pk_bf16_f32 v225, v226, v227
    v_cvt_pk_bf16_f32 v152, v152, v153
    v_cvt_pk_bf16_f32 v137, v138, v139
    ds_write2st64_b64 v93, v[128:129], v[176:177] offset0:4 offset1:16
    v_pk_mul_f32 v[158:159], v[158:159], v[48:49] op_sel_hi:[1,0]
    v_pk_mul_f32 v[238:239], v[238:239], v[50:51] op_sel_hi:[1,0]
    v_pk_mul_f32 v[250:251], v[250:251], v[50:51] op_sel_hi:[1,0]
    v_accvgpr_read_b32 v58, a30
    v_cvt_pk_bf16_f32 v204, v204, v205
    v_cvt_pk_bf16_f32 v109, v110, v111
    s_waitcnt lgkmcnt(2)
    buffer_store_dwordx4 v[72:75], v6, s[16:19], s87 offen offset:0 nt
    v_accvgpr_read_b32 v52, a24
    ds_write2st64_b64 v95, v[132:133], v[180:181] offset0:4 offset1:16
    ds_write2st64_b64 v8, v[136:137], v[184:185] offset0:4 offset1:16
    ds_write2st64_b64 v102, v[140:141], v[188:189] offset0:4 offset1:16
    v_pk_mul_f32 v[54:55], v[54:55], v[94:95] op_sel_hi:[1,0]
    ds_read_b128 v[80:83], v103 offset:2048
    v_pk_mul_f32 v[242:243], v[242:243], v[50:51] op_sel_hi:[1,0]
    ds_read_b128 v[84:87], v103 offset:3072
    v_pk_mul_f32 v[52:53], v[52:53], v[94:95] op_sel_hi:[1,0]
    v_pk_mul_f32 v[206:207], v[206:207], v[92:93] op_sel_hi:[1,0]
    s_waitcnt lgkmcnt(5)
    buffer_store_dwordx4 v[76:79], v7, s[16:19], s87 offen offset:0 nt
    v_cvt_pk_bf16_f32 v52, v52, v53
    v_accvgpr_read_b32 v110, a38
    v_pk_mul_f32 v[56:57], v[56:57], v[94:95] op_sel_hi:[1,0]
    v_cvt_pk_bf16_f32 v232, v232, v233
    v_cvt_pk_bf16_f32 v197, v198, v199
    v_cvt_pk_bf16_f32 v53, v54, v55
    v_accvgpr_read_b32 v106, a18
    ds_read_b128 v[88:91], v103 offset:8192
    v_cvt_pk_bf16_f32 v153, v154, v155
    v_cvt_pk_bf16_f32 v56, v56, v57
    v_pk_mul_f32 v[58:59], v[58:59], v[94:95] op_sel_hi:[1,0]
    v_cvt_pk_bf16_f32 v248, v248, v249
    s_waitcnt lgkmcnt(2)
    buffer_store_dwordx4 v[80:83], v6, s[16:19], s84 offen offset:128 nt
    v_pk_mul_f32 v[106:107], v[106:107], v[94:95] op_sel_hi:[1,0]
    ds_read_b128 v[60:63], v103 offset:9216
    v_cvt_pk_bf16_f32 v104, v104, v105
    v_cvt_pk_bf16_f32 v57, v58, v59
    v_cvt_pk_bf16_f32 v105, v106, v107
    v_cvt_pk_bf16_f32 v237, v238, v239
    ds_write2st64_b64 v93, v[224:225], v[104:105] offset0:28 offset1:40
    ds_write2st64_b64 v95, v[228:229], v[108:109] offset0:28 offset1:40
    v_cvt_pk_bf16_f32 v240, v240, v241
    s_waitcnt lgkmcnt(3)
    buffer_store_dwordx4 v[84:87], v7, s[16:19], s84 offen offset:128 nt
    v_cvt_pk_bf16_f32 v233, v234, v235
    ds_write2st64_b64 v8, v[232:233], v[52:53] offset0:28 offset1:40
    v_pk_mul_f32 v[194:195], v[194:195], v[92:93] op_sel_hi:[1,0]
    ds_write2st64_b64 v102, v[236:237], v[56:57] offset0:28 offset1:40
    v_pk_mul_f32 v[146:147], v[146:147], v[48:49] op_sel_hi:[1,0]
    ds_read_b128 v[64:67], v103 offset:14336
    v_accvgpr_read_b32 v107, a35
    v_accvgpr_read_b32 v52, a40
    buffer_store_dwordx4 v[88:91], v6, s[16:19], s85 offen offset:128 nt
    v_cvt_pk_bf16_f32 v193, v194, v195
    v_accvgpr_read_b32 v105, a33
    v_accvgpr_read_b32 v104, a32
    ds_read_b128 v[68:71], v103 offset:15360
    v_cvt_pk_bf16_f32 v145, v146, v147
    v_accvgpr_read_b32 v54, a42
    v_accvgpr_read_b32 v55, a43
    v_accvgpr_read_b32 v106, a34
    ds_read_b128 v[72:75], v103 offset:20480
    v_accvgpr_read_b32 v111, a39
    v_cvt_pk_bf16_f32 v149, v150, v151
    v_accvgpr_read_b32 v56, a44
    s_waitcnt lgkmcnt(3)
    buffer_store_dwordx4 v[60:63], v7, s[16:19], s85 offen offset:128 nt
    v_cvt_pk_bf16_f32 v249, v250, v251
    v_accvgpr_read_b32 v53, a41
    v_cvt_pk_bf16_f32 v201, v202, v203
    v_accvgpr_read_b32 v57, a45
    v_pk_mul_f32 v[104:105], v[104:105], v[94:95] op_sel_hi:[1,0]
    v_pk_mul_f32 v[110:111], v[110:111], v[94:95] op_sel_hi:[1,0]
    ds_read_b128 v[76:79], v103 offset:21504
    v_accvgpr_read_b32 v109, a37
    ds_write2st64_b64 v93, v[144:145], v[192:193] offset0:8 offset1:20
    v_accvgpr_read_b32 v108, a36
    v_accvgpr_read_b32 v58, a46
    v_pk_mul_f32 v[52:53], v[52:53], v[94:95] op_sel_hi:[1,0]
    v_cvt_pk_bf16_f32 v205, v206, v207
    v_cvt_pk_bf16_f32 v241, v242, v243
    s_waitcnt lgkmcnt(2)
    buffer_store_dwordx4 v[64:67], v6, s[16:19], s86 offen offset:128 nt
    ds_write2st64_b64 v95, v[148:149], v[196:197] offset0:8 offset1:20
    v_pk_mul_f32 v[108:109], v[108:109], v[94:95] op_sel_hi:[1,0]
    v_cvt_pk_bf16_f32 v156, v156, v157
    v_cvt_pk_bf16_f32 v157, v158, v159
    v_cvt_pk_bf16_f32 v245, v246, v247
    buffer_store_dwordx4 v[68:71], v7, s[16:19], s86 offen offset:128 nt
    ds_write2st64_b64 v8, v[152:153], v[200:201] offset0:8 offset1:20
    ds_write2st64_b64 v102, v[156:157], v[204:205] offset0:8 offset1:20
    v_cvt_pk_bf16_f32 v108, v108, v109
    v_cvt_pk_bf16_f32 v109, v110, v111
    buffer_store_dwordx4 v[72:75], v6, s[16:19], s87 offen offset:128 nt
    v_cvt_pk_bf16_f32 v104, v104, v105
    v_cvt_pk_bf16_f32 v252, v252, v253
    ds_read_b128 v[80:83], v103 offset:4096
    v_accvgpr_read_b32 v59, a47
    ds_read_b128 v[84:87], v103 offset:5120
    s_waitcnt lgkmcnt(2)
    buffer_store_dwordx4 v[76:79], v7, s[16:19], s87 offen offset:128 nt
    v_pk_mul_f32 v[58:59], v[58:59], v[94:95] op_sel_hi:[1,0]
    v_cvt_pk_bf16_f32 v52, v52, v53
    v_pk_mul_f32 v[106:107], v[106:107], v[94:95] op_sel_hi:[1,0]
    s_waitcnt lgkmcnt(1)
    buffer_store_dwordx4 v[80:83], v6, s[16:19], s84 offen offset:256 nt
    v_pk_mul_f32 v[56:57], v[56:57], v[94:95] op_sel_hi:[1,0]
    v_pk_mul_f32 v[54:55], v[54:55], v[94:95] op_sel_hi:[1,0]
    ds_read_b128 v[88:91], v103 offset:10240
    v_cvt_pk_bf16_f32 v105, v106, v107
    s_waitcnt lgkmcnt(1)
    buffer_store_dwordx4 v[84:87], v7, s[16:19], s84 offen offset:256 nt
    ds_read_b128 v[60:63], v103 offset:11264
    v_cvt_pk_bf16_f32 v56, v56, v57
    ds_write2st64_b64 v93, v[240:241], v[104:105] offset0:32 offset1:44
    v_cvt_pk_bf16_f32 v53, v54, v55
    s_waitcnt lgkmcnt(2)
    buffer_store_dwordx4 v[88:91], v6, s[16:19], s85 offen offset:256 nt
    v_cvt_pk_bf16_f32 v253, v254, v255
    v_cvt_pk_bf16_f32 v57, v58, v59
    ds_write2st64_b64 v95, v[244:245], v[108:109] offset0:32 offset1:44
    ds_write2st64_b64 v8, v[248:249], v[52:53] offset0:32 offset1:44
    ds_write2st64_b64 v102, v[252:253], v[56:57] offset0:32 offset1:44
    ds_read_b128 v[64:67], v103 offset:16384
    ds_read_b128 v[68:71], v103 offset:17408
    ds_read_b128 v[72:75], v103 offset:22528
    s_waitcnt lgkmcnt(6)
    buffer_store_dwordx4 v[60:63], v7, s[16:19], s85 offen offset:256 nt
    ds_read_b128 v[76:79], v103 offset:23552
    s_waitcnt lgkmcnt(3)
    buffer_store_dwordx4 v[64:67], v6, s[16:19], s86 offen offset:256 nt
    s_waitcnt lgkmcnt(1)
    buffer_store_dwordx4 v[68:71], v7, s[16:19], s86 offen offset:256 nt
    buffer_store_dwordx4 v[72:75], v6, s[16:19], s87 offen offset:256 nt
    s_waitcnt lgkmcnt(0)
    buffer_store_dwordx4 v[76:79], v7, s[16:19], s87 offen offset:256 nt
    s_branch L_fin
L_fin:
    s_waitcnt vmcnt(0)
L_end:
    s_endpgm
L_codeend:
L_rare5_0:
    s_nop 15
    v_mov_b32 v104, 0
    v_mov_b32 v105, 0
    v_mov_b32 v106, 0
    v_mov_b32 v107, 0
    s_nop 1
    v_mfma_f32_16x16x32_bf16 v[104:107], a[248:251], v[14:17], v[104:107]
    v_smfmac_f32_16x16x64_bf16 v[104:107], a[240:243], v[22:29], v101
    v_smfmac_f32_16x16x64_bf16 v[104:107], a[244:247], v[34:41], v101
    s_nop 15
    v_sub_f32 v45, v45, v105
    v_sub_f32 v46, v46, v106
    v_sub_f32 v47, v47, v107
    v_mov_b32 v44, 0
    v_mov_b32 v48, 0
    v_mbcnt_lo_u32_b32 v31, -1, 0
    v_mbcnt_hi_u32_b32 v31, -1, v31
    v_and_b32 v30, 15, v31
    v_mul_u32_u24 v30, 384, v30
    v_lshrrev_b32 v31, 4, v31
    v_lshl_add_u32 v30, v31, 4, v30
    s_add_u32 s69, s39, 0
    buffer_load_dwordx4 v[92:95], v30, s[4:7], s69 offen offset:0
    s_waitcnt vmcnt(0)
    v_mfma_f32_16x16x32_bf16 v[104:107], v[92:95], a[96:99], 0
    s_nop 7
    buffer_load_dwordx4 v[92:95], v30, s[4:7], s69 offen offset:64
    s_waitcnt vmcnt(0)
    v_mfma_f32_16x16x32_bf16 v[104:107], v[92:95], a[100:103], v[104:107]
    s_nop 7
    buffer_load_dwordx4 v[92:95], v30, s[4:7], s69 offen offset:128
    s_waitcnt vmcnt(0)
    v_mfma_f32_16x16x32_bf16 v[104:107], v[92:95], a[104:107], v[104:107]
    s_nop 7
    buffer_load_dwordx4 v[92:95], v30, s[4:7], s69 offen offset:192
    s_waitcnt vmcnt(0)
    v_mfma_f32_16x16x32_bf16 v[104:107], v[92:95], a[108:111], v[104:107]
    s_nop 7
    buffer_load_dwordx4 v[92:95], v30, s[4:7], s69 offen offset:256
    s_waitcnt vmcnt(0)
    v_mfma_f32_16x16x32_bf16 v[104:107], v[92:95], a[112:115], v[104:107]
    s_nop 7
    buffer_load_dwordx4 v[92:95], v30, s[4:7], s69 offen offset:320
    s_waitcnt vmcnt(0)
    v_mfma_f32_16x16x32_bf16 v[104:107], v[92:95], a[116:119], v[104:107]
    s_nop 7
    s_add_u32 s69, s39, 6144
    buffer_load_dwordx4 v[92:95], v30, s[4:7], s69 offen offset:0
    s_waitcnt vmcnt(0)
    v_mfma_f32_16x16x32_bf16 v[108:111], v[92:95], a[96:99], 0
    s_nop 7
    buffer_load_dwordx4 v[92:95], v30, s[4:7], s69 offen offset:64
    s_waitcnt vmcnt(0)
    v_mfma_f32_16x16x32_bf16 v[108:111], v[92:95], a[100:103], v[108:111]
    s_nop 7
    buffer_load_dwordx4 v[92:95], v30, s[4:7], s69 offen offset:128
    s_waitcnt vmcnt(0)
    v_mfma_f32_16x16x32_bf16 v[108:111], v[92:95], a[104:107], v[108:111]
    s_nop 7
    buffer_load_dwordx4 v[92:95], v30, s[4:7], s69 offen offset:192
    s_waitcnt vmcnt(0)
    v_mfma_f32_16x16x32_bf16 v[108:111], v[92:95], a[108:111], v[108:111]
    s_nop 7
    buffer_load_dwordx4 v[92:95], v30, s[4:7], s69 offen offset:256
    s_waitcnt vmcnt(0)
    v_mfma_f32_16x16x32_bf16 v[108:111], v[92:95], a[112:115], v[108:111]
    s_nop 7
    buffer_load_dwordx4 v[92:95], v30, s[4:7], s69 offen offset:320
    s_waitcnt vmcnt(0)
    v_mfma_f32_16x16x32_bf16 v[108:111], v[92:95], a[116:119], v[108:111]
    s_nop 7
    s_nop 15
    v_max3_f32 v18, v104, v105, v106
    v_max3_f32 v18, v18, v107, v108
    v_max3_f32 v18, v18, v109, v110
    v_max_f32 v18, v18, v111
    v_mov_b32 v19, v18
    s_nop 1
    v_permlane32_swap_b32 v19, v18
    v_max_f32 v18, v18, v19
    v_mov_b32 v19, v18
    s_nop 1
    v_permlane16_swap_b32 v19, v18
    v_max_f32 v18, v18, v19
    v_fma_f32 v18, v18, s28, v9
    v_add_f32 v18, 0x42000000, v18
    v_max_f32 v20, 0, v18
    v_sub_f32 v9, v9, v20
    v_sub_f32 v21, 0, v20
    v_exp_f32 v21, v21
    s_nop 0
    v_mul_f32 v47, v47, v21
    v_mul_f32 v19, v49, v21
    v_cndmask_b32_e64 v49, v19, v49, s[46:47]
    v_mul_f32 v112, v112, v21
    v_mul_f32 v113, v113, v21
    v_mul_f32 v114, v114, v21
    v_mul_f32 v115, v115, v21
    v_mul_f32 v116, v116, v21
    v_mul_f32 v117, v117, v21
    v_mul_f32 v118, v118, v21
    v_mul_f32 v119, v119, v21
    v_mul_f32 v120, v120, v21
    v_mul_f32 v121, v121, v21
    v_mul_f32 v122, v122, v21
    v_mul_f32 v123, v123, v21
    v_mul_f32 v124, v124, v21
    v_mul_f32 v125, v125, v21
    v_mul_f32 v126, v126, v21
    v_mul_f32 v127, v127, v21
    v_mul_f32 v128, v128, v21
    v_mul_f32 v129, v129, v21
    v_mul_f32 v130, v130, v21
    v_mul_f32 v131, v131, v21
    v_mul_f32 v132, v132, v21
    v_mul_f32 v133, v133, v21
    v_mul_f32 v134, v134, v21
    v_mul_f32 v135, v135, v21
    v_mul_f32 v136, v136, v21
    v_mul_f32 v137, v137, v21
    v_mul_f32 v138, v138, v21
    v_mul_f32 v139, v139, v21
    v_mul_f32 v140, v140, v21
    v_mul_f32 v141, v141, v21
    v_mul_f32 v142, v142, v21
    v_mul_f32 v143, v143, v21
    v_mul_f32 v144, v144, v21
    v_mul_f32 v145, v145, v21
    v_mul_f32 v146, v146, v21
    v_mul_f32 v147, v147, v21
    v_mul_f32 v148, v148, v21
    v_mul_f32 v149, v149, v21
    v_mul_f32 v150, v150, v21
    v_mul_f32 v151, v151, v21
    v_mul_f32 v152, v152, v21
    v_mul_f32 v153, v153, v21
    v_mul_f32 v154, v154, v21
    v_mul_f32 v155, v155, v21
    v_mul_f32 v156, v156, v21
    v_mul_f32 v157, v157, v21
    v_mul_f32 v158, v158, v21
    v_mul_f32 v159, v159, v21
    v_fma_f32 v104, v104, s28, v9
    v_fma_f32 v105, v105, s28, v9
    v_exp_f32_e64 v104, v104 clamp
    v_exp_f32_e64 v105, v105 clamp
    s_nop 0
    v_cvt_pk_bf16_f32 v14, v104, v105
    v_fma_f32 v106, v106, s28, v9
    v_fma_f32 v107, v107, s28, v9
    v_exp_f32_e64 v106, v106 clamp
    v_exp_f32_e64 v107, v107 clamp
    s_nop 0
    v_cvt_pk_bf16_f32 v15, v106, v107
    v_fma_f32 v108, v108, s28, v9
    v_fma_f32 v109, v109, s28, v9
    v_exp_f32_e64 v108, v108 clamp
    v_exp_f32_e64 v109, v109 clamp
    s_nop 0
    v_cvt_pk_bf16_f32 v16, v108, v109
    v_fma_f32 v110, v110, s28, v9
    v_fma_f32 v111, v111, s28, v9
    v_exp_f32_e64 v110, v110 clamp
    v_exp_f32_e64 v111, v111 clamp
    s_nop 0
    v_cvt_pk_bf16_f32 v17, v110, v111
    s_add_u32 s69, s39, 0
    buffer_load_dwordx4 v[92:95], v30, s[4:7], s69 offen offset:0
    s_waitcnt vmcnt(0)
    v_mfma_f32_16x16x32_bf16 v[104:107], v[92:95], a[120:123], 0
    s_nop 7
    buffer_load_dwordx4 v[92:95], v30, s[4:7], s69 offen offset:64
    s_waitcnt vmcnt(0)
    v_mfma_f32_16x16x32_bf16 v[104:107], v[92:95], a[124:127], v[104:107]
    s_nop 7
    buffer_load_dwordx4 v[92:95], v30, s[4:7], s69 offen offset:128
    s_waitcnt vmcnt(0)
    v_mfma_f32_16x16x32_bf16 v[104:107], v[92:95], a[128:131], v[104:107]
    s_nop 7
    buffer_load_dwordx4 v[92:95], v30, s[4:7], s69 offen offset:192
    s_waitcnt vmcnt(0)
    v_mfma_f32_16x16x32_bf16 v[104:107], v[92:95], a[132:135], v[104:107]
    s_nop 7
    buffer_load_dwordx4 v[92:95], v30, s[4:7], s69 offen offset:256
    s_waitcnt vmcnt(0)
    v_mfma_f32_16x16x32_bf16 v[104:107], v[92:95], a[136:139], v[104:107]
    s_nop 7
    buffer_load_dwordx4 v[92:95], v30, s[4:7], s69 offen offset:320
    s_waitcnt vmcnt(0)
    v_mfma_f32_16x16x32_bf16 v[104:107], v[92:95], a[140:143], v[104:107]
    s_nop 7
    s_add_u32 s69, s39, 6144
    buffer_load_dwordx4 v[92:95], v30, s[4:7], s69 offen offset:0
    s_waitcnt vmcnt(0)
    v_mfma_f32_16x16x32_bf16 v[108:111], v[92:95], a[120:123], 0
    s_nop 7
    buffer_load_dwordx4 v[92:95], v30, s[4:7], s69 offen offset:64
    s_waitcnt vmcnt(0)
    v_mfma_f32_16x16x32_bf16 v[108:111], v[92:95], a[124:127], v[108:111]
    s_nop 7
    buffer_load_dwordx4 v[92:95], v30, s[4:7], s69 offen offset:128
    s_waitcnt vmcnt(0)
    v_mfma_f32_16x16x32_bf16 v[108:111], v[92:95], a[128:131], v[108:111]
    s_nop 7
    buffer_load_dwordx4 v[92:95], v30, s[4:7], s69 offen offset:192
    s_waitcnt vmcnt(0)
    v_mfma_f32_16x16x32_bf16 v[108:111], v[92:95], a[132:135], v[108:111]
    s_nop 7
    buffer_load_dwordx4 v[92:95], v30, s[4:7], s69 offen offset:256
    s_waitcnt vmcnt(0)
    v_mfma_f32_16x16x32_bf16 v[108:111], v[92:95], a[136:139], v[108:111]
    s_nop 7
    buffer_load_dwordx4 v[92:95], v30, s[4:7], s69 offen offset:320
    s_waitcnt vmcnt(0)
    v_mfma_f32_16x16x32_bf16 v[108:111], v[92:95], a[140:143], v[108:111]
    s_nop 7
    s_nop 15
    v_max3_f32 v18, v104, v105, v106
    v_max3_f32 v18, v18, v107, v108
    v_max3_f32 v18, v18, v109, v110
    v_max_f32 v18, v18, v111
    v_mov_b32 v19, v18
    s_nop 1
    v_permlane32_swap_b32 v19, v18
    v_max_f32 v18, v18, v19
    v_mov_b32 v19, v18
    s_nop 1
    v_permlane16_swap_b32 v19, v18
    v_max_f32 v18, v18, v19
    v_fma_f32 v18, v18, s28, v10
    v_add_f32 v18, 0x42000000, v18
    v_max_f32 v20, 0, v18
    v_sub_f32 v10, v10, v20
    v_sub_f32 v21, 0, v20
    v_exp_f32 v21, v21
    s_nop 0
    v_mul_f32 v19, v45, v21
    v_cndmask_b32_e64 v45, v19, v45, s[46:47]
    v_mul_f32 v19, v49, v21
    v_cndmask_b32_e64 v49, v49, v19, s[46:47]
    v_mul_f32 v160, v160, v21
    v_mul_f32 v161, v161, v21
    v_mul_f32 v162, v162, v21
    v_mul_f32 v163, v163, v21
    v_mul_f32 v164, v164, v21
    v_mul_f32 v165, v165, v21
    v_mul_f32 v166, v166, v21
    v_mul_f32 v167, v167, v21
    v_mul_f32 v168, v168, v21
    v_mul_f32 v169, v169, v21
    v_mul_f32 v170, v170, v21
    v_mul_f32 v171, v171, v21
    v_mul_f32 v172, v172, v21
    v_mul_f32 v173, v173, v21
    v_mul_f32 v174, v174, v21
    v_mul_f32 v175, v175, v21
    v_mul_f32 v176, v176, v21
    v_mul_f32 v177, v177, v21
    v_mul_f32 v178, v178, v21
    v_mul_f32 v179, v179, v21
    v_mul_f32 v180, v180, v21
    v_mul_f32 v181, v181, v21
    v_mul_f32 v182, v182, v21
    v_mul_f32 v183, v183, v21
    v_mul_f32 v184, v184, v21
    v_mul_f32 v185, v185, v21
    v_mul_f32 v186, v186, v21
    v_mul_f32 v187, v187, v21
    v_mul_f32 v188, v188, v21
    v_mul_f32 v189, v189, v21
    v_mul_f32 v190, v190, v21
    v_mul_f32 v191, v191, v21
    v_mul_f32 v192, v192, v21
    v_mul_f32 v193, v193, v21
    v_mul_f32 v194, v194, v21
    v_mul_f32 v195, v195, v21
    v_mul_f32 v196, v196, v21
    v_mul_f32 v197, v197, v21
    v_mul_f32 v198, v198, v21
    v_mul_f32 v199, v199, v21
    v_mul_f32 v200, v200, v21
    v_mul_f32 v201, v201, v21
    v_mul_f32 v202, v202, v21
    v_mul_f32 v203, v203, v21
    v_mul_f32 v204, v204, v21
    v_mul_f32 v205, v205, v21
    v_mul_f32 v206, v206, v21
    v_mul_f32 v207, v207, v21
    v_fma_f32 v104, v104, s28, v10
    v_fma_f32 v105, v105, s28, v10
    v_exp_f32_e64 v104, v104 clamp
    v_exp_f32_e64 v105, v105 clamp
    s_nop 0
    v_cvt_pk_bf16_f32 v22, v104, v105
    v_fma_f32 v106, v106, s28, v10
    v_fma_f32 v107, v107, s28, v10
    v_exp_f32_e64 v106, v106 clamp
    v_exp_f32_e64 v107, v107 clamp
    s_nop 0
    v_cvt_pk_bf16_f32 v23, v106, v107
    v_fma_f32 v108, v108, s28, v10
    v_fma_f32 v109, v109, s28, v10
    v_exp_f32_e64 v108, v108 clamp
    v_exp_f32_e64 v109, v109 clamp
    s_nop 0
    v_cvt_pk_bf16_f32 v24, v108, v109
    v_fma_f32 v110, v110, s28, v10
    v_fma_f32 v111, v111, s28, v10
    v_exp_f32_e64 v110, v110 clamp
    v_exp_f32_e64 v111, v111 clamp
    s_nop 0
    v_cvt_pk_bf16_f32 v25, v110, v111
    s_add_u32 s69, s39, 0
    buffer_load_dwordx4 v[92:95], v30, s[4:7], s69 offen offset:0
    s_waitcnt vmcnt(0)
    v_mfma_f32_16x16x32_bf16 v[104:107], v[92:95], a[144:147], 0
    s_nop 7
    buffer_load_dwordx4 v[92:95], v30, s[4:7], s69 offen offset:64
    s_waitcnt vmcnt(0)
    v_mfma_f32_16x16x32_bf16 v[104:107], v[92:95], a[148:151], v[104:107]
    s_nop 7
    buffer_load_dwordx4 v[92:95], v30, s[4:7], s69 offen offset:128
    s_waitcnt vmcnt(0)
    v_mfma_f32_16x16x32_bf16 v[104:107], v[92:95], a[152:155], v[104:107]
    s_nop 7
    buffer_load_dwordx4 v[92:95], v30, s[4:7], s69 offen offset:192
    s_waitcnt vmcnt(0)
    v_mfma_f32_16x16x32_bf16 v[104:107], v[92:95], a[156:159], v[104:107]
    s_nop 7
    buffer_load_dwordx4 v[92:95], v30, s[4:7], s69 offen offset:256
    s_waitcnt vmcnt(0)
    v_mfma_f32_16x16x32_bf16 v[104:107], v[92:95], a[160:163], v[104:107]
    s_nop 7
    buffer_load_dwordx4 v[92:95], v30, s[4:7], s69 offen offset:320
    s_waitcnt vmcnt(0)
    v_mfma_f32_16x16x32_bf16 v[104:107], v[92:95], a[164:167], v[104:107]
    s_nop 7
    s_add_u32 s69, s39, 6144
    buffer_load_dwordx4 v[92:95], v30, s[4:7], s69 offen offset:0
    s_waitcnt vmcnt(0)
    v_mfma_f32_16x16x32_bf16 v[108:111], v[92:95], a[144:147], 0
    s_nop 7
    buffer_load_dwordx4 v[92:95], v30, s[4:7], s69 offen offset:64
    s_waitcnt vmcnt(0)
    v_mfma_f32_16x16x32_bf16 v[108:111], v[92:95], a[148:151], v[108:111]
    s_nop 7
    buffer_load_dwordx4 v[92:95], v30, s[4:7], s69 offen offset:128
    s_waitcnt vmcnt(0)
    v_mfma_f32_16x16x32_bf16 v[108:111], v[92:95], a[152:155], v[108:111]
    s_nop 7
    buffer_load_dwordx4 v[92:95], v30, s[4:7], s69 offen offset:192
    s_waitcnt vmcnt(0)
    v_mfma_f32_16x16x32_bf16 v[108:111], v[92:95], a[156:159], v[108:111]
    s_nop 7
    buffer_load_dwordx4 v[92:95], v30, s[4:7], s69 offen offset:256
    s_waitcnt vmcnt(0)
    v_mfma_f32_16x16x32_bf16 v[108:111], v[92:95], a[160:163], v[108:111]
    s_nop 7
    buffer_load_dwordx4 v[92:95], v30, s[4:7], s69 offen offset:320
    s_waitcnt vmcnt(0)
    v_mfma_f32_16x16x32_bf16 v[108:111], v[92:95], a[164:167], v[108:111]
    s_nop 7
    s_nop 15
    v_max3_f32 v18, v104, v105, v106
    v_max3_f32 v18, v18, v107, v108
    v_max3_f32 v18, v18, v109, v110
    v_max_f32 v18, v18, v111
    v_mov_b32 v19, v18
    s_nop 1
    v_permlane32_swap_b32 v19, v18
    v_max_f32 v18, v18, v19
    v_mov_b32 v19, v18
    s_nop 1
    v_permlane16_swap_b32 v19, v18
    v_max_f32 v18, v18, v19
    v_fma_f32 v18, v18, s28, v11
    v_add_f32 v18, 0x42000000, v18
    v_max_f32 v20, 0, v18
    v_sub_f32 v11, v11, v20
    v_sub_f32 v21, 0, v20
    v_exp_f32 v21, v21
    s_nop 0
    v_mul_f32 v19, v45, v21
    v_cndmask_b32_e64 v45, v45, v19, s[46:47]
    v_mul_f32 v19, v50, v21
    v_cndmask_b32_e64 v50, v19, v50, s[46:47]
    v_mul_f32 v208, v208, v21
    v_mul_f32 v209, v209, v21
    v_mul_f32 v210, v210, v21
    v_mul_f32 v211, v211, v21
    v_mul_f32 v212, v212, v21
    v_mul_f32 v213, v213, v21
    v_mul_f32 v214, v214, v21
    v_mul_f32 v215, v215, v21
    v_mul_f32 v216, v216, v21
    v_mul_f32 v217, v217, v21
    v_mul_f32 v218, v218, v21
    v_mul_f32 v219, v219, v21
    v_mul_f32 v220, v220, v21
    v_mul_f32 v221, v221, v21
    v_mul_f32 v222, v222, v21
    v_mul_f32 v223, v223, v21
    v_mul_f32 v224, v224, v21
    v_mul_f32 v225, v225, v21
    v_mul_f32 v226, v226, v21
    v_mul_f32 v227, v227, v21
    v_mul_f32 v228, v228, v21
    v_mul_f32 v229, v229, v21
    v_mul_f32 v230, v230, v21
    v_mul_f32 v231, v231, v21
    v_mul_f32 v232, v232, v21
    v_mul_f32 v233, v233, v21
    v_mul_f32 v234, v234, v21
    v_mul_f32 v235, v235, v21
    v_mul_f32 v236, v236, v21
    v_mul_f32 v237, v237, v21
    v_mul_f32 v238, v238, v21
    v_mul_f32 v239, v239, v21
    v_mul_f32 v240, v240, v21
    v_mul_f32 v241, v241, v21
    v_mul_f32 v242, v242, v21
    v_mul_f32 v243, v243, v21
    v_mul_f32 v244, v244, v21
    v_mul_f32 v245, v245, v21
    v_mul_f32 v246, v246, v21
    v_mul_f32 v247, v247, v21
    v_mul_f32 v248, v248, v21
    v_mul_f32 v249, v249, v21
    v_mul_f32 v250, v250, v21
    v_mul_f32 v251, v251, v21
    v_mul_f32 v252, v252, v21
    v_mul_f32 v253, v253, v21
    v_mul_f32 v254, v254, v21
    v_mul_f32 v255, v255, v21
    v_fma_f32 v104, v104, s28, v11
    v_fma_f32 v105, v105, s28, v11
    v_exp_f32_e64 v104, v104 clamp
    v_exp_f32_e64 v105, v105 clamp
    s_nop 0
    v_cvt_pk_bf16_f32 v26, v104, v105
    v_fma_f32 v106, v106, s28, v11
    v_fma_f32 v107, v107, s28, v11
    v_exp_f32_e64 v106, v106 clamp
    v_exp_f32_e64 v107, v107 clamp
    s_nop 0
    v_cvt_pk_bf16_f32 v27, v106, v107
    v_fma_f32 v108, v108, s28, v11
    v_fma_f32 v109, v109, s28, v11
    v_exp_f32_e64 v108, v108 clamp
    v_exp_f32_e64 v109, v109 clamp
    s_nop 0
    v_cvt_pk_bf16_f32 v28, v108, v109
    v_fma_f32 v110, v110, s28, v11
    v_fma_f32 v111, v111, s28, v11
    v_exp_f32_e64 v110, v110 clamp
    v_exp_f32_e64 v111, v111 clamp
    s_nop 0
    v_cvt_pk_bf16_f32 v29, v110, v111
    s_add_u32 s69, s39, 0
    buffer_load_dwordx4 v[92:95], v30, s[4:7], s69 offen offset:0
    s_waitcnt vmcnt(0)
    v_mfma_f32_16x16x32_bf16 v[104:107], v[92:95], a[168:171], 0
    s_nop 7
    buffer_load_dwordx4 v[92:95], v30, s[4:7], s69 offen offset:64
    s_waitcnt vmcnt(0)
    v_mfma_f32_16x16x32_bf16 v[104:107], v[92:95], a[172:175], v[104:107]
    s_nop 7
    buffer_load_dwordx4 v[92:95], v30, s[4:7], s69 offen offset:128
    s_waitcnt vmcnt(0)
    v_mfma_f32_16x16x32_bf16 v[104:107], v[92:95], a[176:179], v[104:107]
    s_nop 7
    buffer_load_dwordx4 v[92:95], v30, s[4:7], s69 offen offset:192
    s_waitcnt vmcnt(0)
    v_mfma_f32_16x16x32_bf16 v[104:107], v[92:95], a[180:183], v[104:107]
    s_nop 7
    buffer_load_dwordx4 v[92:95], v30, s[4:7], s69 offen offset:256
    s_waitcnt vmcnt(0)
    v_mfma_f32_16x16x32_bf16 v[104:107], v[92:95], a[184:187], v[104:107]
    s_nop 7
    buffer_load_dwordx4 v[92:95], v30, s[4:7], s69 offen offset:320
    s_waitcnt vmcnt(0)
    v_mfma_f32_16x16x32_bf16 v[104:107], v[92:95], a[188:191], v[104:107]
    s_nop 7
    s_add_u32 s69, s39, 6144
    buffer_load_dwordx4 v[92:95], v30, s[4:7], s69 offen offset:0
    s_waitcnt vmcnt(0)
    v_mfma_f32_16x16x32_bf16 v[108:111], v[92:95], a[168:171], 0
    s_nop 7
    buffer_load_dwordx4 v[92:95], v30, s[4:7], s69 offen offset:64
    s_waitcnt vmcnt(0)
    v_mfma_f32_16x16x32_bf16 v[108:111], v[92:95], a[172:175], v[108:111]
    s_nop 7
    buffer_load_dwordx4 v[92:95], v30, s[4:7], s69 offen offset:128
    s_waitcnt vmcnt(0)
    v_mfma_f32_16x16x32_bf16 v[108:111], v[92:95], a[176:179], v[108:111]
    s_nop 7
    buffer_load_dwordx4 v[92:95], v30, s[4:7], s69 offen offset:192
    s_waitcnt vmcnt(0)
    v_mfma_f32_16x16x32_bf16 v[108:111], v[92:95], a[180:183], v[108:111]
    s_nop 7
    buffer_load_dwordx4 v[92:95], v30, s[4:7], s69 offen offset:256
    s_waitcnt vmcnt(0)
    v_mfma_f32_16x16x32_bf16 v[108:111], v[92:95], a[184:187], v[108:111]
    s_nop 7
    buffer_load_dwordx4 v[92:95], v30, s[4:7], s69 offen offset:320
    s_waitcnt vmcnt(0)
    v_mfma_f32_16x16x32_bf16 v[108:111], v[92:95], a[188:191], v[108:111]
    s_nop 7
    s_nop 15
    v_max3_f32 v18, v104, v105, v106
    v_max3_f32 v18, v18, v107, v108
    v_max3_f32 v18, v18, v109, v110
    v_max_f32 v18, v18, v111
    v_mov_b32 v19, v18
    s_nop 1
    v_permlane32_swap_b32 v19, v18
    v_max_f32 v18, v18, v19
    v_mov_b32 v19, v18
    s_nop 1
    v_permlane16_swap_b32 v19, v18
    v_max_f32 v18, v18, v19
    v_fma_f32 v18, v18, s28, v12
    v_add_f32 v18, 0x42000000, v18
    v_max_f32 v20, 0, v18
    v_sub_f32 v12, v12, v20
    v_sub_f32 v21, 0, v20
    v_exp_f32 v21, v21
    s_nop 0
    v_mul_f32 v19, v46, v21
    v_cndmask_b32_e64 v46, v19, v46, s[46:47]
    v_mul_f32 v19, v50, v21
    v_cndmask_b32_e64 v50, v50, v19, s[46:47]
    v_accvgpr_read_b32 v19, a0
    v_mul_f32 v19, v19, v21
    v_accvgpr_write_b32 a0, v19
    v_accvgpr_read_b32 v19, a1
    v_mul_f32 v19, v19, v21
    v_accvgpr_write_b32 a1, v19
    v_accvgpr_read_b32 v19, a2
    v_mul_f32 v19, v19, v21
    v_accvgpr_write_b32 a2, v19
    v_accvgpr_read_b32 v19, a3
    v_mul_f32 v19, v19, v21
    v_accvgpr_write_b32 a3, v19
    v_accvgpr_read_b32 v19, a4
    v_mul_f32 v19, v19, v21
    v_accvgpr_write_b32 a4, v19
    v_accvgpr_read_b32 v19, a5
    v_mul_f32 v19, v19, v21
    v_accvgpr_write_b32 a5, v19
    v_accvgpr_read_b32 v19, a6
    v_mul_f32 v19, v19, v21
    v_accvgpr_write_b32 a6, v19
    v_accvgpr_read_b32 v19, a7
    v_mul_f32 v19, v19, v21
    v_accvgpr_write_b32 a7, v19
    v_accvgpr_read_b32 v19, a8
    v_mul_f32 v19, v19, v21
    v_accvgpr_write_b32 a8, v19
    v_accvgpr_read_b32 v19, a9
    v_mul_f32 v19, v19, v21
    v_accvgpr_write_b32 a9, v19
    v_accvgpr_read_b32 v19, a10
    v_mul_f32 v19, v19, v21
    v_accvgpr_write_b32 a10, v19
    v_accvgpr_read_b32 v19, a11
    v_mul_f32 v19, v19, v21
    v_accvgpr_write_b32 a11, v19
    v_accvgpr_read_b32 v19, a12
    v_mul_f32 v19, v19, v21
    v_accvgpr_write_b32 a12, v19
    v_accvgpr_read_b32 v19, a13
    v_mul_f32 v19, v19, v21
    v_accvgpr_write_b32 a13, v19
    v_accvgpr_read_b32 v19, a14
    v_mul_f32 v19, v19, v21
    v_accvgpr_write_b32 a14, v19
    v_accvgpr_read_b32 v19, a15
    v_mul_f32 v19, v19, v21
    v_accvgpr_write_b32 a15, v19
    v_accvgpr_read_b32 v19, a16
    v_mul_f32 v19, v19, v21
    v_accvgpr_write_b32 a16, v19
    v_accvgpr_read_b32 v19, a17
    v_mul_f32 v19, v19, v21
    v_accvgpr_write_b32 a17, v19
    v_accvgpr_read_b32 v19, a18
    v_mul_f32 v19, v19, v21
    v_accvgpr_write_b32 a18, v19
    v_accvgpr_read_b32 v19, a19
    v_mul_f32 v19, v19, v21
    v_accvgpr_write_b32 a19, v19
    v_accvgpr_read_b32 v19, a20
    v_mul_f32 v19, v19, v21
    v_accvgpr_write_b32 a20, v19
    v_accvgpr_read_b32 v19, a21
    v_mul_f32 v19, v19, v21
    v_accvgpr_write_b32 a21, v19
    v_accvgpr_read_b32 v19, a22
    v_mul_f32 v19, v19, v21
    v_accvgpr_write_b32 a22, v19
    v_accvgpr_read_b32 v19, a23
    v_mul_f32 v19, v19, v21
    v_accvgpr_write_b32 a23, v19
    v_accvgpr_read_b32 v19, a24
    v_mul_f32 v19, v19, v21
    v_accvgpr_write_b32 a24, v19
    v_accvgpr_read_b32 v19, a25
    v_mul_f32 v19, v19, v21
    v_accvgpr_write_b32 a25, v19
    v_accvgpr_read_b32 v19, a26
    v_mul_f32 v19, v19, v21
    v_accvgpr_write_b32 a26, v19
    v_accvgpr_read_b32 v19, a27
    v_mul_f32 v19, v19, v21
    v_accvgpr_write_b32 a27, v19
    v_accvgpr_read_b32 v19, a28
    v_mul_f32 v19, v19, v21
    v_accvgpr_write_b32 a28, v19
    v_accvgpr_read_b32 v19, a29
    v_mul_f32 v19, v19, v21
    v_accvgpr_write_b32 a29, v19
    v_accvgpr_read_b32 v19, a30
    v_mul_f32 v19, v19, v21
    v_accvgpr_write_b32 a30, v19
    v_accvgpr_read_b32 v19, a31
    v_mul_f32 v19, v19, v21
    v_accvgpr_write_b32 a31, v19
    v_accvgpr_read_b32 v19, a32
    v_mul_f32 v19, v19, v21
    v_accvgpr_write_b32 a32, v19
    v_accvgpr_read_b32 v19, a33
    v_mul_f32 v19, v19, v21
    v_accvgpr_write_b32 a33, v19
    v_accvgpr_read_b32 v19, a34
    v_mul_f32 v19, v19, v21
    v_accvgpr_write_b32 a34, v19
    v_accvgpr_read_b32 v19, a35
    v_mul_f32 v19, v19, v21
    v_accvgpr_write_b32 a35, v19
    v_accvgpr_read_b32 v19, a36
    v_mul_f32 v19, v19, v21
    v_accvgpr_write_b32 a36, v19
    v_accvgpr_read_b32 v19, a37
    v_mul_f32 v19, v19, v21
    v_accvgpr_write_b32 a37, v19
    v_accvgpr_read_b32 v19, a38
    v_mul_f32 v19, v19, v21
    v_accvgpr_write_b32 a38, v19
    v_accvgpr_read_b32 v19, a39
    v_mul_f32 v19, v19, v21
    v_accvgpr_write_b32 a39, v19
    v_accvgpr_read_b32 v19, a40
    v_mul_f32 v19, v19, v21
    v_accvgpr_write_b32 a40, v19
    v_accvgpr_read_b32 v19, a41
    v_mul_f32 v19, v19, v21
    v_accvgpr_write_b32 a41, v19
    v_accvgpr_read_b32 v19, a42
    v_mul_f32 v19, v19, v21
    v_accvgpr_write_b32 a42, v19
    v_accvgpr_read_b32 v19, a43
    v_mul_f32 v19, v19, v21
    v_accvgpr_write_b32 a43, v19
    v_accvgpr_read_b32 v19, a44
    v_mul_f32 v19, v19, v21
    v_accvgpr_write_b32 a44, v19
    v_accvgpr_read_b32 v19, a45
    v_mul_f32 v19, v19, v21
    v_accvgpr_write_b32 a45, v19
    v_accvgpr_read_b32 v19, a46
    v_mul_f32 v19, v19, v21
    v_accvgpr_write_b32 a46, v19
    v_accvgpr_read_b32 v19, a47
    v_mul_f32 v19, v19, v21
    v_accvgpr_write_b32 a47, v19
    v_fma_f32 v104, v104, s28, v12
    v_fma_f32 v105, v105, s28, v12
    v_exp_f32_e64 v104, v104 clamp
    v_exp_f32_e64 v105, v105 clamp
    s_nop 0
    v_cvt_pk_bf16_f32 v34, v104, v105
    v_fma_f32 v106, v106, s28, v12
    v_fma_f32 v107, v107, s28, v12
    v_exp_f32_e64 v106, v106 clamp
    v_exp_f32_e64 v107, v107 clamp
    s_nop 0
    v_cvt_pk_bf16_f32 v35, v106, v107
    v_fma_f32 v108, v108, s28, v12
    v_fma_f32 v109, v109, s28, v12
    v_exp_f32_e64 v108, v108 clamp
    v_exp_f32_e64 v109, v109 clamp
    s_nop 0
    v_cvt_pk_bf16_f32 v36, v108, v109
    v_fma_f32 v110, v110, s28, v12
    v_fma_f32 v111, v111, s28, v12
    v_exp_f32_e64 v110, v110 clamp
    v_exp_f32_e64 v111, v111 clamp
    s_nop 0
    v_cvt_pk_bf16_f32 v37, v110, v111
    s_add_u32 s69, s39, 0
    buffer_load_dwordx4 v[92:95], v30, s[4:7], s69 offen offset:0
    s_waitcnt vmcnt(0)
    v_mfma_f32_16x16x32_bf16 v[104:107], v[92:95], a[192:195], 0
    s_nop 7
    buffer_load_dwordx4 v[92:95], v30, s[4:7], s69 offen offset:64
    s_waitcnt vmcnt(0)
    v_mfma_f32_16x16x32_bf16 v[104:107], v[92:95], a[196:199], v[104:107]
    s_nop 7
    buffer_load_dwordx4 v[92:95], v30, s[4:7], s69 offen offset:128
    s_waitcnt vmcnt(0)
    v_mfma_f32_16x16x32_bf16 v[104:107], v[92:95], a[200:203], v[104:107]
    s_nop 7
    buffer_load_dwordx4 v[92:95], v30, s[4:7], s69 offen offset:192
    s_waitcnt vmcnt(0)
    v_mfma_f32_16x16x32_bf16 v[104:107], v[92:95], a[204:207], v[104:107]
    s_nop 7
    buffer_load_dwordx4 v[92:95], v30, s[4:7], s69 offen offset:256
    s_waitcnt vmcnt(0)
    v_mfma_f32_16x16x32_bf16 v[104:107], v[92:95], a[208:211], v[104:107]
    s_nop 7
    buffer_load_dwordx4 v[92:95], v30, s[4:7], s69 offen offset:320
    s_waitcnt vmcnt(0)
    v_mfma_f32_16x16x32_bf16 v[104:107], v[92:95], a[212:215], v[104:107]
    s_nop 7
    s_add_u32 s69, s39, 6144
    buffer_load_dwordx4 v[92:95], v30, s[4:7], s69 offen offset:0
    s_waitcnt vmcnt(0)
    v_mfma_f32_16x16x32_bf16 v[108:111], v[92:95], a[192:195], 0
    s_nop 7
    buffer_load_dwordx4 v[92:95], v30, s[4:7], s69 offen offset:64
    s_waitcnt vmcnt(0)
    v_mfma_f32_16x16x32_bf16 v[108:111], v[92:95], a[196:199], v[108:111]
    s_nop 7
    buffer_load_dwordx4 v[92:95], v30, s[4:7], s69 offen offset:128
    s_waitcnt vmcnt(0)
    v_mfma_f32_16x16x32_bf16 v[108:111], v[92:95], a[200:203], v[108:111]
    s_nop 7
    buffer_load_dwordx4 v[92:95], v30, s[4:7], s69 offen offset:192
    s_waitcnt vmcnt(0)
    v_mfma_f32_16x16x32_bf16 v[108:111], v[92:95], a[204:207], v[108:111]
    s_nop 7
    buffer_load_dwordx4 v[92:95], v30, s[4:7], s69 offen offset:256
    s_waitcnt vmcnt(0)
    v_mfma_f32_16x16x32_bf16 v[108:111], v[92:95], a[208:211], v[108:111]
    s_nop 7
    buffer_load_dwordx4 v[92:95], v30, s[4:7], s69 offen offset:320
    s_waitcnt vmcnt(0)
    v_mfma_f32_16x16x32_bf16 v[108:111], v[92:95], a[212:215], v[108:111]
    s_nop 7
    s_nop 15
    v_max3_f32 v18, v104, v105, v106
    v_max3_f32 v18, v18, v107, v108
    v_max3_f32 v18, v18, v109, v110
    v_max_f32 v18, v18, v111
    v_mov_b32 v19, v18
    s_nop 1
    v_permlane32_swap_b32 v19, v18
    v_max_f32 v18, v18, v19
    v_mov_b32 v19, v18
    s_nop 1
    v_permlane16_swap_b32 v19, v18
    v_max_f32 v18, v18, v19
    v_fma_f32 v18, v18, s28, v13
    v_add_f32 v18, 0x42000000, v18
    v_max_f32 v20, 0, v18
    v_sub_f32 v13, v13, v20
    v_sub_f32 v21, 0, v20
    v_exp_f32 v21, v21
    s_nop 0
    v_mul_f32 v19, v46, v21
    v_cndmask_b32_e64 v46, v46, v19, s[46:47]
    v_mul_f32 v51, v51, v21
    v_accvgpr_read_b32 v19, a48
    v_mul_f32 v19, v19, v21
    v_accvgpr_write_b32 a48, v19
    v_accvgpr_read_b32 v19, a49
    v_mul_f32 v19, v19, v21
    v_accvgpr_write_b32 a49, v19
    v_accvgpr_read_b32 v19, a50
    v_mul_f32 v19, v19, v21
    v_accvgpr_write_b32 a50, v19
    v_accvgpr_read_b32 v19, a51
    v_mul_f32 v19, v19, v21
    v_accvgpr_write_b32 a51, v19
    v_accvgpr_read_b32 v19, a52
    v_mul_f32 v19, v19, v21
    v_accvgpr_write_b32 a52, v19
    v_accvgpr_read_b32 v19, a53
    v_mul_f32 v19, v19, v21
    v_accvgpr_write_b32 a53, v19
    v_accvgpr_read_b32 v19, a54
    v_mul_f32 v19, v19, v21
    v_accvgpr_write_b32 a54, v19
    v_accvgpr_read_b32 v19, a55
    v_mul_f32 v19, v19, v21
    v_accvgpr_write_b32 a55, v19
    v_accvgpr_read_b32 v19, a56
    v_mul_f32 v19, v19, v21
    v_accvgpr_write_b32 a56, v19
    v_accvgpr_read_b32 v19, a57
    v_mul_f32 v19, v19, v21
    v_accvgpr_write_b32 a57, v19
    v_accvgpr_read_b32 v19, a58
    v_mul_f32 v19, v19, v21
    v_accvgpr_write_b32 a58, v19
    v_accvgpr_read_b32 v19, a59
    v_mul_f32 v19, v19, v21
    v_accvgpr_write_b32 a59, v19
    v_accvgpr_read_b32 v19, a60
    v_mul_f32 v19, v19, v21
    v_accvgpr_write_b32 a60, v19
    v_accvgpr_read_b32 v19, a61
    v_mul_f32 v19, v19, v21
    v_accvgpr_write_b32 a61, v19
    v_accvgpr_read_b32 v19, a62
    v_mul_f32 v19, v19, v21
    v_accvgpr_write_b32 a62, v19
    v_accvgpr_read_b32 v19, a63
    v_mul_f32 v19, v19, v21
    v_accvgpr_write_b32 a63, v19
    v_accvgpr_read_b32 v19, a64
    v_mul_f32 v19, v19, v21
    v_accvgpr_write_b32 a64, v19
    v_accvgpr_read_b32 v19, a65
    v_mul_f32 v19, v19, v21
    v_accvgpr_write_b32 a65, v19
    v_accvgpr_read_b32 v19, a66
    v_mul_f32 v19, v19, v21
    v_accvgpr_write_b32 a66, v19
    v_accvgpr_read_b32 v19, a67
    v_mul_f32 v19, v19, v21
    v_accvgpr_write_b32 a67, v19
    v_accvgpr_read_b32 v19, a68
    v_mul_f32 v19, v19, v21
    v_accvgpr_write_b32 a68, v19
    v_accvgpr_read_b32 v19, a69
    v_mul_f32 v19, v19, v21
    v_accvgpr_write_b32 a69, v19
    v_accvgpr_read_b32 v19, a70
    v_mul_f32 v19, v19, v21
    v_accvgpr_write_b32 a70, v19
    v_accvgpr_read_b32 v19, a71
    v_mul_f32 v19, v19, v21
    v_accvgpr_write_b32 a71, v19
    v_accvgpr_read_b32 v19, a72
    v_mul_f32 v19, v19, v21
    v_accvgpr_write_b32 a72, v19
    v_accvgpr_read_b32 v19, a73
    v_mul_f32 v19, v19, v21
    v_accvgpr_write_b32 a73, v19
    v_accvgpr_read_b32 v19, a74
    v_mul_f32 v19, v19, v21
    v_accvgpr_write_b32 a74, v19
    v_accvgpr_read_b32 v19, a75
    v_mul_f32 v19, v19, v21
    v_accvgpr_write_b32 a75, v19
    v_accvgpr_read_b32 v19, a76
    v_mul_f32 v19, v19, v21
    v_accvgpr_write_b32 a76, v19
    v_accvgpr_read_b32 v19, a77
    v_mul_f32 v19, v19, v21
    v_accvgpr_write_b32 a77, v19
    v_accvgpr_read_b32 v19, a78
    v_mul_f32 v19, v19, v21
    v_accvgpr_write_b32 a78, v19
    v_accvgpr_read_b32 v19, a79
    v_mul_f32 v19, v19, v21
    v_accvgpr_write_b32 a79, v19
    v_accvgpr_read_b32 v19, a80
    v_mul_f32 v19, v19, v21
    v_accvgpr_write_b32 a80, v19
    v_accvgpr_read_b32 v19, a81
    v_mul_f32 v19, v19, v21
    v_accvgpr_write_b32 a81, v19
    v_accvgpr_read_b32 v19, a82
    v_mul_f32 v19, v19, v21
    v_accvgpr_write_b32 a82, v19
    v_accvgpr_read_b32 v19, a83
    v_mul_f32 v19, v19, v21
    v_accvgpr_write_b32 a83, v19
    v_accvgpr_read_b32 v19, a84
    v_mul_f32 v19, v19, v21
    v_accvgpr_write_b32 a84, v19
    v_accvgpr_read_b32 v19, a85
    v_mul_f32 v19, v19, v21
    v_accvgpr_write_b32 a85, v19
    v_accvgpr_read_b32 v19, a86
    v_mul_f32 v19, v19, v21
    v_accvgpr_write_b32 a86, v19
    v_accvgpr_read_b32 v19, a87
    v_mul_f32 v19, v19, v21
    v_accvgpr_write_b32 a87, v19
    v_accvgpr_read_b32 v19, a88
    v_mul_f32 v19, v19, v21
    v_accvgpr_write_b32 a88, v19
    v_accvgpr_read_b32 v19, a89
    v_mul_f32 v19, v19, v21
    v_accvgpr_write_b32 a89, v19
    v_accvgpr_read_b32 v19, a90
    v_mul_f32 v19, v19, v21
    v_accvgpr_write_b32 a90, v19
    v_accvgpr_read_b32 v19, a91
    v_mul_f32 v19, v19, v21
    v_accvgpr_write_b32 a91, v19
    v_accvgpr_read_b32 v19, a92
    v_mul_f32 v19, v19, v21
    v_accvgpr_write_b32 a92, v19
    v_accvgpr_read_b32 v19, a93
    v_mul_f32 v19, v19, v21
    v_accvgpr_write_b32 a93, v19
    v_accvgpr_read_b32 v19, a94
    v_mul_f32 v19, v19, v21
    v_accvgpr_write_b32 a94, v19
    v_accvgpr_read_b32 v19, a95
    v_mul_f32 v19, v19, v21
    v_accvgpr_write_b32 a95, v19
    v_fma_f32 v104, v104, s28, v13
    v_fma_f32 v105, v105, s28, v13
    v_exp_f32_e64 v104, v104 clamp
    v_exp_f32_e64 v105, v105 clamp
    s_nop 0
    v_cvt_pk_bf16_f32 v38, v104, v105
    v_fma_f32 v106, v106, s28, v13
    v_fma_f32 v107, v107, s28, v13
    v_exp_f32_e64 v106, v106 clamp
    v_exp_f32_e64 v107, v107 clamp
    s_nop 0
    v_cvt_pk_bf16_f32 v39, v106, v107
    v_fma_f32 v108, v108, s28, v13
    v_fma_f32 v109, v109, s28, v13
    v_exp_f32_e64 v108, v108 clamp
    v_exp_f32_e64 v109, v109 clamp
    s_nop 0
    v_cvt_pk_bf16_f32 v40, v108, v109
    v_fma_f32 v110, v110, s28, v13
    v_fma_f32 v111, v111, s28, v13
    v_exp_f32_e64 v110, v110 clamp
    v_exp_f32_e64 v111, v111 clamp
    s_nop 0
    v_cvt_pk_bf16_f32 v41, v110, v111
    v_mfma_f32_16x16x32_bf16 v[44:47], a[248:251], v[14:17], v[44:47]
    v_smfmac_f32_16x16x64_bf16 v[44:47], a[240:243], v[22:29], v101
    v_smfmac_f32_16x16x64_bf16 v[44:47], a[244:247], v[34:41], v101
    s_nop 15
    s_setpc_b64 s[40:41]
L_rare5_1:
    s_nop 15
    v_mov_b32 v104, 0
    v_mov_b32 v105, 0
    v_mov_b32 v106, 0
    v_mov_b32 v107, 0
    s_nop 1
    v_smfmac_f32_16x16x64_bf16 v[104:107], a[240:243], v[16:23], v101
    v_smfmac_f32_16x16x64_bf16 v[104:107], a[244:247], v[28:35], v101
    v_mfma_f32_16x16x32_bf16 v[104:107], a[248:251], v[40:43], v[104:107]
    s_nop 15
    v_sub_f32 v49, v49, v105
    v_sub_f32 v50, v50, v106
    v_sub_f32 v51, v51, v107
    v_mov_b32 v44, 0
    v_mov_b32 v48, 0
    v_mbcnt_lo_u32_b32 v27, -1, 0
    v_mbcnt_hi_u32_b32 v27, -1, v27
    v_and_b32 v26, 15, v27
    v_mul_u32_u24 v26, 384, v26
    v_lshrrev_b32 v27, 4, v27
    v_lshl_add_u32 v26, v27, 4, v26
    s_add_u32 s69, s39, 0
    buffer_load_dwordx4 v[92:95], v26, s[4:7], s69 offen offset:0
    s_waitcnt vmcnt(0)
    v_mfma_f32_16x16x32_bf16 v[104:107], v[92:95], a[96:99], 0
    s_nop 7
    buffer_load_dwordx4 v[92:95], v26, s[4:7], s69 offen offset:64
    s_waitcnt vmcnt(0)
    v_mfma_f32_16x16x32_bf16 v[104:107], v[92:95], a[100:103], v[104:107]
    s_nop 7
    buffer_load_dwordx4 v[92:95], v26, s[4:7], s69 offen offset:128
    s_waitcnt vmcnt(0)
    v_mfma_f32_16x16x32_bf16 v[104:107], v[92:95], a[104:107], v[104:107]
    s_nop 7
    buffer_load_dwordx4 v[92:95], v26, s[4:7], s69 offen offset:192
    s_waitcnt vmcnt(0)
    v_mfma_f32_16x16x32_bf16 v[104:107], v[92:95], a[108:111], v[104:107]
    s_nop 7
    buffer_load_dwordx4 v[92:95], v26, s[4:7], s69 offen offset:256
    s_waitcnt vmcnt(0)
    v_mfma_f32_16x16x32_bf16 v[104:107], v[92:95], a[112:115], v[104:107]
    s_nop 7
    buffer_load_dwordx4 v[92:95], v26, s[4:7], s69 offen offset:320
    s_waitcnt vmcnt(0)
    v_mfma_f32_16x16x32_bf16 v[104:107], v[92:95], a[116:119], v[104:107]
    s_nop 7
    s_add_u32 s69, s39, 6144
    buffer_load_dwordx4 v[92:95], v26, s[4:7], s69 offen offset:0
    s_waitcnt vmcnt(0)
    v_mfma_f32_16x16x32_bf16 v[108:111], v[92:95], a[96:99], 0
    s_nop 7
    buffer_load_dwordx4 v[92:95], v26, s[4:7], s69 offen offset:64
    s_waitcnt vmcnt(0)
    v_mfma_f32_16x16x32_bf16 v[108:111], v[92:95], a[100:103], v[108:111]
    s_nop 7
    buffer_load_dwordx4 v[92:95], v26, s[4:7], s69 offen offset:128
    s_waitcnt vmcnt(0)
    v_mfma_f32_16x16x32_bf16 v[108:111], v[92:95], a[104:107], v[108:111]
    s_nop 7
    buffer_load_dwordx4 v[92:95], v26, s[4:7], s69 offen offset:192
    s_waitcnt vmcnt(0)
    v_mfma_f32_16x16x32_bf16 v[108:111], v[92:95], a[108:111], v[108:111]
    s_nop 7
    buffer_load_dwordx4 v[92:95], v26, s[4:7], s69 offen offset:256
    s_waitcnt vmcnt(0)
    v_mfma_f32_16x16x32_bf16 v[108:111], v[92:95], a[112:115], v[108:111]
    s_nop 7
    buffer_load_dwordx4 v[92:95], v26, s[4:7], s69 offen offset:320
    s_waitcnt vmcnt(0)
    v_mfma_f32_16x16x32_bf16 v[108:111], v[92:95], a[116:119], v[108:111]
    s_nop 7
    s_nop 15
    v_max3_f32 v14, v104, v105, v106
    v_max3_f32 v14, v14, v107, v108
    v_max3_f32 v14, v14, v109, v110
    v_max_f32 v14, v14, v111
    v_mov_b32 v15, v14
    s_nop 1
    v_permlane32_swap_b32 v15, v14
    v_max_f32 v14, v14, v15
    v_mov_b32 v15, v14
    s_nop 1
    v_permlane16_swap_b32 v15, v14
    v_max_f32 v14, v14, v15
    v_fma_f32 v14, v14, s28, v9
    v_add_f32 v14, 0x42000000, v14
    v_max_f32 v24, 0, v14
    v_sub_f32 v9, v9, v24
    v_sub_f32 v25, 0, v24
    v_exp_f32 v25, v25
    s_nop 0
    v_mul_f32 v47, v47, v25
    v_mul_f32 v15, v49, v25
    v_cndmask_b32_e64 v49, v15, v49, s[46:47]
    v_mul_f32 v112, v112, v25
    v_mul_f32 v113, v113, v25
    v_mul_f32 v114, v114, v25
    v_mul_f32 v115, v115, v25
    v_mul_f32 v116, v116, v25
    v_mul_f32 v117, v117, v25
    v_mul_f32 v118, v118, v25
    v_mul_f32 v119, v119, v25
    v_mul_f32 v120, v120, v25
    v_mul_f32 v121, v121, v25
    v_mul_f32 v122, v122, v25
    v_mul_f32 v123, v123, v25
    v_mul_f32 v124, v124, v25
    v_mul_f32 v125, v125, v25
    v_mul_f32 v126, v126, v25
    v_mul_f32 v127, v127, v25
    v_mul_f32 v128, v128, v25
    v_mul_f32 v129, v129, v25
    v_mul_f32 v130, v130, v25
    v_mul_f32 v131, v131, v25
    v_mul_f32 v132, v132, v25
    v_mul_f32 v133, v133, v25
    v_mul_f32 v134, v134, v25
    v_mul_f32 v135, v135, v25
    v_mul_f32 v136, v136, v25
    v_mul_f32 v137, v137, v25
    v_mul_f32 v138, v138, v25
    v_mul_f32 v139, v139, v25
    v_mul_f32 v140, v140, v25
    v_mul_f32 v141, v141, v25
    v_mul_f32 v142, v142, v25
    v_mul_f32 v143, v143, v25
    v_mul_f32 v144, v144, v25
    v_mul_f32 v145, v145, v25
    v_mul_f32 v146, v146, v25
    v_mul_f32 v147, v147, v25
    v_mul_f32 v148, v148, v25
    v_mul_f32 v149, v149, v25
    v_mul_f32 v150, v150, v25
    v_mul_f32 v151, v151, v25
    v_mul_f32 v152, v152, v25
    v_mul_f32 v153, v153, v25
    v_mul_f32 v154, v154, v25
    v_mul_f32 v155, v155, v25
    v_mul_f32 v156, v156, v25
    v_mul_f32 v157, v157, v25
    v_mul_f32 v158, v158, v25
    v_mul_f32 v159, v159, v25
    v_fma_f32 v104, v104, s28, v9
    v_fma_f32 v105, v105, s28, v9
    v_exp_f32_e64 v104, v104 clamp
    v_exp_f32_e64 v105, v105 clamp
    s_nop 0
    v_cvt_pk_bf16_f32 v18, v104, v105
    v_fma_f32 v106, v106, s28, v9
    v_fma_f32 v107, v107, s28, v9
    v_exp_f32_e64 v106, v106 clamp
    v_exp_f32_e64 v107, v107 clamp
    s_nop 0
    v_cvt_pk_bf16_f32 v19, v106, v107
    v_fma_f32 v108, v108, s28, v9
    v_fma_f32 v109, v109, s28, v9
    v_exp_f32_e64 v108, v108 clamp
    v_exp_f32_e64 v109, v109 clamp
    s_nop 0
    v_cvt_pk_bf16_f32 v16, v108, v109
    v_fma_f32 v110, v110, s28, v9
    v_fma_f32 v111, v111, s28, v9
    v_exp_f32_e64 v110, v110 clamp
    v_exp_f32_e64 v111, v111 clamp
    s_nop 0
    v_cvt_pk_bf16_f32 v17, v110, v111
    s_add_u32 s69, s39, 0
    buffer_load_dwordx4 v[92:95], v26, s[4:7], s69 offen offset:0
    s_waitcnt vmcnt(0)
    v_mfma_f32_16x16x32_bf16 v[104:107], v[92:95], a[120:123], 0
    s_nop 7
    buffer_load_dwordx4 v[92:95], v26, s[4:7], s69 offen offset:64
    s_waitcnt vmcnt(0)
    v_mfma_f32_16x16x32_bf16 v[104:107], v[92:95], a[124:127], v[104:107]
    s_nop 7
    buffer_load_dwordx4 v[92:95], v26, s[4:7], s69 offen offset:128
    s_waitcnt vmcnt(0)
    v_mfma_f32_16x16x32_bf16 v[104:107], v[92:95], a[128:131], v[104:107]
    s_nop 7
    buffer_load_dwordx4 v[92:95], v26, s[4:7], s69 offen offset:192
    s_waitcnt vmcnt(0)
    v_mfma_f32_16x16x32_bf16 v[104:107], v[92:95], a[132:135], v[104:107]
    s_nop 7
    buffer_load_dwordx4 v[92:95], v26, s[4:7], s69 offen offset:256
    s_waitcnt vmcnt(0)
    v_mfma_f32_16x16x32_bf16 v[104:107], v[92:95], a[136:139], v[104:107]
    s_nop 7
    buffer_load_dwordx4 v[92:95], v26, s[4:7], s69 offen offset:320
    s_waitcnt vmcnt(0)
    v_mfma_f32_16x16x32_bf16 v[104:107], v[92:95], a[140:143], v[104:107]
    s_nop 7
    s_add_u32 s69, s39, 6144
    buffer_load_dwordx4 v[92:95], v26, s[4:7], s69 offen offset:0
    s_waitcnt vmcnt(0)
    v_mfma_f32_16x16x32_bf16 v[108:111], v[92:95], a[120:123], 0
    s_nop 7
    buffer_load_dwordx4 v[92:95], v26, s[4:7], s69 offen offset:64
    s_waitcnt vmcnt(0)
    v_mfma_f32_16x16x32_bf16 v[108:111], v[92:95], a[124:127], v[108:111]
    s_nop 7
    buffer_load_dwordx4 v[92:95], v26, s[4:7], s69 offen offset:128
    s_waitcnt vmcnt(0)
    v_mfma_f32_16x16x32_bf16 v[108:111], v[92:95], a[128:131], v[108:111]
    s_nop 7
    buffer_load_dwordx4 v[92:95], v26, s[4:7], s69 offen offset:192
    s_waitcnt vmcnt(0)
    v_mfma_f32_16x16x32_bf16 v[108:111], v[92:95], a[132:135], v[108:111]
    s_nop 7
    buffer_load_dwordx4 v[92:95], v26, s[4:7], s69 offen offset:256
    s_waitcnt vmcnt(0)
    v_mfma_f32_16x16x32_bf16 v[108:111], v[92:95], a[136:139], v[108:111]
    s_nop 7
    buffer_load_dwordx4 v[92:95], v26, s[4:7], s69 offen offset:320
    s_waitcnt vmcnt(0)
    v_mfma_f32_16x16x32_bf16 v[108:111], v[92:95], a[140:143], v[108:111]
    s_nop 7
    s_nop 15
    v_max3_f32 v14, v104, v105, v106
    v_max3_f32 v14, v14, v107, v108
    v_max3_f32 v14, v14, v109, v110
    v_max_f32 v14, v14, v111
    v_mov_b32 v15, v14
    s_nop 1
    v_permlane32_swap_b32 v15, v14
    v_max_f32 v14, v14, v15
    v_mov_b32 v15, v14
    s_nop 1
    v_permlane16_swap_b32 v15, v14
    v_max_f32 v14, v14, v15
    v_fma_f32 v14, v14, s28, v10
    v_add_f32 v14, 0x42000000, v14
    v_max_f32 v24, 0, v14
    v_sub_f32 v10, v10, v24
    v_sub_f32 v25, 0, v24
    v_exp_f32 v25, v25
    s_nop 0
    v_mul_f32 v15, v45, v25
    v_cndmask_b32_e64 v45, v15, v45, s[46:47]
    v_mul_f32 v15, v49, v25
    v_cndmask_b32_e64 v49, v49, v15, s[46:47]
    v_mul_f32 v160, v160, v25
    v_mul_f32 v161, v161, v25
    v_mul_f32 v162, v162, v25
    v_mul_f32 v163, v163, v25
    v_mul_f32 v164, v164, v25
    v_mul_f32 v165, v165, v25
    v_mul_f32 v166, v166, v25
    v_mul_f32 v167, v167, v25
    v_mul_f32 v168, v168, v25
    v_mul_f32 v169, v169, v25
    v_mul_f32 v170, v170, v25
    v_mul_f32 v171, v171, v25
    v_mul_f32 v172, v172, v25
    v_mul_f32 v173, v173, v25
    v_mul_f32 v174, v174, v25
    v_mul_f32 v175, v175, v25
    v_mul_f32 v176, v176, v25
    v_mul_f32 v177, v177, v25
    v_mul_f32 v178, v178, v25
    v_mul_f32 v179, v179, v25
    v_mul_f32 v180, v180, v25
    v_mul_f32 v181, v181, v25
    v_mul_f32 v182, v182, v25
    v_mul_f32 v183, v183, v25
    v_mul_f32 v184, v184, v25
    v_mul_f32 v185, v185, v25
    v_mul_f32 v186, v186, v25
    v_mul_f32 v187, v187, v25
    v_mul_f32 v188, v188, v25
    v_mul_f32 v189, v189, v25
    v_mul_f32 v190, v190, v25
    v_mul_f32 v191, v191, v25
    v_mul_f32 v192, v192, v25
    v_mul_f32 v193, v193, v25
    v_mul_f32 v194, v194, v25
    v_mul_f32 v195, v195, v25
    v_mul_f32 v196, v196, v25
    v_mul_f32 v197, v197, v25
    v_mul_f32 v198, v198, v25
    v_mul_f32 v199, v199, v25
    v_mul_f32 v200, v200, v25
    v_mul_f32 v201, v201, v25
    v_mul_f32 v202, v202, v25
    v_mul_f32 v203, v203, v25
    v_mul_f32 v204, v204, v25
    v_mul_f32 v205, v205, v25
    v_mul_f32 v206, v206, v25
    v_mul_f32 v207, v207, v25
    v_fma_f32 v104, v104, s28, v10
    v_fma_f32 v105, v105, s28, v10
    v_exp_f32_e64 v104, v104 clamp
    v_exp_f32_e64 v105, v105 clamp
    s_nop 0
    v_cvt_pk_bf16_f32 v22, v104, v105
    v_fma_f32 v106, v106, s28, v10
    v_fma_f32 v107, v107, s28, v10
    v_exp_f32_e64 v106, v106 clamp
    v_exp_f32_e64 v107, v107 clamp
    s_nop 0
    v_cvt_pk_bf16_f32 v23, v106, v107
    v_fma_f32 v108, v108, s28, v10
    v_fma_f32 v109, v109, s28, v10
    v_exp_f32_e64 v108, v108 clamp
    v_exp_f32_e64 v109, v109 clamp
    s_nop 0
    v_cvt_pk_bf16_f32 v20, v108, v109
    v_fma_f32 v110, v110, s28, v10
    v_fma_f32 v111, v111, s28, v10
    v_exp_f32_e64 v110, v110 clamp
    v_exp_f32_e64 v111, v111 clamp
    s_nop 0
    v_cvt_pk_bf16_f32 v21, v110, v111
    s_add_u32 s69, s39, 0
    buffer_load_dwordx4 v[92:95], v26, s[4:7], s69 offen offset:0
    s_waitcnt vmcnt(0)
    v_mfma_f32_16x16x32_bf16 v[104:107], v[92:95], a[144:147], 0
    s_nop 7
    buffer_load_dwordx4 v[92:95], v26, s[4:7], s69 offen offset:64
    s_waitcnt vmcnt(0)
    v_mfma_f32_16x16x32_bf16 v[104:107], v[92:95], a[148:151], v[104:107]
    s_nop 7
    buffer_load_dwordx4 v[92:95], v26, s[4:7], s69 offen offset:128
    s_waitcnt vmcnt(0)
    v_mfma_f32_16x16x32_bf16 v[104:107], v[92:95], a[152:155], v[104:107]
    s_nop 7
    buffer_load_dwordx4 v[92:95], v26, s[4:7], s69 offen offset:192
    s_waitcnt vmcnt(0)
    v_mfma_f32_16x16x32_bf16 v[104:107], v[92:95], a[156:159], v[104:107]
    s_nop 7
    buffer_load_dwordx4 v[92:95], v26, s[4:7], s69 offen offset:256
    s_waitcnt vmcnt(0)
    v_mfma_f32_16x16x32_bf16 v[104:107], v[92:95], a[160:163], v[104:107]
    s_nop 7
    buffer_load_dwordx4 v[92:95], v26, s[4:7], s69 offen offset:320
    s_waitcnt vmcnt(0)
    v_mfma_f32_16x16x32_bf16 v[104:107], v[92:95], a[164:167], v[104:107]
    s_nop 7
    s_add_u32 s69, s39, 6144
    buffer_load_dwordx4 v[92:95], v26, s[4:7], s69 offen offset:0
    s_waitcnt vmcnt(0)
    v_mfma_f32_16x16x32_bf16 v[108:111], v[92:95], a[144:147], 0
    s_nop 7
    buffer_load_dwordx4 v[92:95], v26, s[4:7], s69 offen offset:64
    s_waitcnt vmcnt(0)
    v_mfma_f32_16x16x32_bf16 v[108:111], v[92:95], a[148:151], v[108:111]
    s_nop 7
    buffer_load_dwordx4 v[92:95], v26, s[4:7], s69 offen offset:128
    s_waitcnt vmcnt(0)
    v_mfma_f32_16x16x32_bf16 v[108:111], v[92:95], a[152:155], v[108:111]
    s_nop 7
    buffer_load_dwordx4 v[92:95], v26, s[4:7], s69 offen offset:192
    s_waitcnt vmcnt(0)
    v_mfma_f32_16x16x32_bf16 v[108:111], v[92:95], a[156:159], v[108:111]
    s_nop 7
    buffer_load_dwordx4 v[92:95], v26, s[4:7], s69 offen offset:256
    s_waitcnt vmcnt(0)
    v_mfma_f32_16x16x32_bf16 v[108:111], v[92:95], a[160:163], v[108:111]
    s_nop 7
    buffer_load_dwordx4 v[92:95], v26, s[4:7], s69 offen offset:320
    s_waitcnt vmcnt(0)
    v_mfma_f32_16x16x32_bf16 v[108:111], v[92:95], a[164:167], v[108:111]
    s_nop 7
    s_nop 15
    v_max3_f32 v14, v104, v105, v106
    v_max3_f32 v14, v14, v107, v108
    v_max3_f32 v14, v14, v109, v110
    v_max_f32 v14, v14, v111
    v_mov_b32 v15, v14
    s_nop 1
    v_permlane32_swap_b32 v15, v14
    v_max_f32 v14, v14, v15
    v_mov_b32 v15, v14
    s_nop 1
    v_permlane16_swap_b32 v15, v14
    v_max_f32 v14, v14, v15
    v_fma_f32 v14, v14, s28, v11
    v_add_f32 v14, 0x42000000, v14
    v_max_f32 v24, 0, v14
    v_sub_f32 v11, v11, v24
    v_sub_f32 v25, 0, v24
    v_exp_f32 v25, v25
    s_nop 0
    v_mul_f32 v15, v45, v25
    v_cndmask_b32_e64 v45, v45, v15, s[46:47]
    v_mul_f32 v15, v50, v25
    v_cndmask_b32_e64 v50, v15, v50, s[46:47]
    v_mul_f32 v208, v208, v25
    v_mul_f32 v209, v209, v25
    v_mul_f32 v210, v210, v25
    v_mul_f32 v211, v211, v25
    v_mul_f32 v212, v212, v25
    v_mul_f32 v213, v213, v25
    v_mul_f32 v214, v214, v25
    v_mul_f32 v215, v215, v25
    v_mul_f32 v216, v216, v25
    v_mul_f32 v217, v217, v25
    v_mul_f32 v218, v218, v25
    v_mul_f32 v219, v219, v25
    v_mul_f32 v220, v220, v25
    v_mul_f32 v221, v221, v25
    v_mul_f32 v222, v222, v25
    v_mul_f32 v223, v223, v25
    v_mul_f32 v224, v224, v25
    v_mul_f32 v225, v225, v25
    v_mul_f32 v226, v226, v25
    v_mul_f32 v227, v227, v25
    v_mul_f32 v228, v228, v25
    v_mul_f32 v229, v229, v25
    v_mul_f32 v230, v230, v25
    v_mul_f32 v231, v231, v25
    v_mul_f32 v232, v232, v25
    v_mul_f32 v233, v233, v25
    v_mul_f32 v234, v234, v25
    v_mul_f32 v235, v235, v25
    v_mul_f32 v236, v236, v25
    v_mul_f32 v237, v237, v25
    v_mul_f32 v238, v238, v25
    v_mul_f32 v239, v239, v25
    v_mul_f32 v240, v240, v25
    v_mul_f32 v241, v241, v25
    v_mul_f32 v242, v242, v25
    v_mul_f32 v243, v243, v25
    v_mul_f32 v244, v244, v25
    v_mul_f32 v245, v245, v25
    v_mul_f32 v246, v246, v25
    v_mul_f32 v247, v247, v25
    v_mul_f32 v248, v248, v25
    v_mul_f32 v249, v249, v25
    v_mul_f32 v250, v250, v25
    v_mul_f32 v251, v251, v25
    v_mul_f32 v252, v252, v25
    v_mul_f32 v253, v253, v25
    v_mul_f32 v254, v254, v25
    v_mul_f32 v255, v255, v25
    v_fma_f32 v104, v104, s28, v11
    v_fma_f32 v105, v105, s28, v11
    v_exp_f32_e64 v104, v104 clamp
    v_exp_f32_e64 v105, v105 clamp
    s_nop 0
    v_cvt_pk_bf16_f32 v30, v104, v105
    v_fma_f32 v106, v106, s28, v11
    v_fma_f32 v107, v107, s28, v11
    v_exp_f32_e64 v106, v106 clamp
    v_exp_f32_e64 v107, v107 clamp
    s_nop 0
    v_cvt_pk_bf16_f32 v31, v106, v107
    v_fma_f32 v108, v108, s28, v11
    v_fma_f32 v109, v109, s28, v11
    v_exp_f32_e64 v108, v108 clamp
    v_exp_f32_e64 v109, v109 clamp
    s_nop 0
    v_cvt_pk_bf16_f32 v28, v108, v109
    v_fma_f32 v110, v110, s28, v11
    v_fma_f32 v111, v111, s28, v11
    v_exp_f32_e64 v110, v110 clamp
    v_exp_f32_e64 v111, v111 clamp
    s_nop 0
    v_cvt_pk_bf16_f32 v29, v110, v111
    s_add_u32 s69, s39, 0
    buffer_load_dwordx4 v[92:95], v26, s[4:7], s69 offen offset:0
    s_waitcnt vmcnt(0)
    v_mfma_f32_16x16x32_bf16 v[104:107], v[92:95], a[168:171], 0
    s_nop 7
    buffer_load_dwordx4 v[92:95], v26, s[4:7], s69 offen offset:64
    s_waitcnt vmcnt(0)
    v_mfma_f32_16x16x32_bf16 v[104:107], v[92:95], a[172:175], v[104:107]
    s_nop 7
    buffer_load_dwordx4 v[92:95], v26, s[4:7], s69 offen offset:128
    s_waitcnt vmcnt(0)
    v_mfma_f32_16x16x32_bf16 v[104:107], v[92:95], a[176:179], v[104:107]
    s_nop 7
    buffer_load_dwordx4 v[92:95], v26, s[4:7], s69 offen offset:192
    s_waitcnt vmcnt(0)
    v_mfma_f32_16x16x32_bf16 v[104:107], v[92:95], a[180:183], v[104:107]
    s_nop 7
    buffer_load_dwordx4 v[92:95], v26, s[4:7], s69 offen offset:256
    s_waitcnt vmcnt(0)
    v_mfma_f32_16x16x32_bf16 v[104:107], v[92:95], a[184:187], v[104:107]
    s_nop 7
    buffer_load_dwordx4 v[92:95], v26, s[4:7], s69 offen offset:320
    s_waitcnt vmcnt(0)
    v_mfma_f32_16x16x32_bf16 v[104:107], v[92:95], a[188:191], v[104:107]
    s_nop 7
    s_add_u32 s69, s39, 6144
    buffer_load_dwordx4 v[92:95], v26, s[4:7], s69 offen offset:0
    s_waitcnt vmcnt(0)
    v_mfma_f32_16x16x32_bf16 v[108:111], v[92:95], a[168:171], 0
    s_nop 7
    buffer_load_dwordx4 v[92:95], v26, s[4:7], s69 offen offset:64
    s_waitcnt vmcnt(0)
    v_mfma_f32_16x16x32_bf16 v[108:111], v[92:95], a[172:175], v[108:111]
    s_nop 7
    buffer_load_dwordx4 v[92:95], v26, s[4:7], s69 offen offset:128
    s_waitcnt vmcnt(0)
    v_mfma_f32_16x16x32_bf16 v[108:111], v[92:95], a[176:179], v[108:111]
    s_nop 7
    buffer_load_dwordx4 v[92:95], v26, s[4:7], s69 offen offset:192
    s_waitcnt vmcnt(0)
    v_mfma_f32_16x16x32_bf16 v[108:111], v[92:95], a[180:183], v[108:111]
    s_nop 7
    buffer_load_dwordx4 v[92:95], v26, s[4:7], s69 offen offset:256
    s_waitcnt vmcnt(0)
    v_mfma_f32_16x16x32_bf16 v[108:111], v[92:95], a[184:187], v[108:111]
    s_nop 7
    buffer_load_dwordx4 v[92:95], v26, s[4:7], s69 offen offset:320
    s_waitcnt vmcnt(0)
    v_mfma_f32_16x16x32_bf16 v[108:111], v[92:95], a[188:191], v[108:111]
    s_nop 7
    s_nop 15
    v_max3_f32 v14, v104, v105, v106
    v_max3_f32 v14, v14, v107, v108
    v_max3_f32 v14, v14, v109, v110
    v_max_f32 v14, v14, v111
    v_mov_b32 v15, v14
    s_nop 1
    v_permlane32_swap_b32 v15, v14
    v_max_f32 v14, v14, v15
    v_mov_b32 v15, v14
    s_nop 1
    v_permlane16_swap_b32 v15, v14
    v_max_f32 v14, v14, v15
    v_fma_f32 v14, v14, s28, v12
    v_add_f32 v14, 0x42000000, v14
    v_max_f32 v24, 0, v14
    v_sub_f32 v12, v12, v24
    v_sub_f32 v25, 0, v24
    v_exp_f32 v25, v25
    s_nop 0
    v_mul_f32 v15, v46, v25
    v_cndmask_b32_e64 v46, v15, v46, s[46:47]
    v_mul_f32 v15, v50, v25
    v_cndmask_b32_e64 v50, v50, v15, s[46:47]
    v_accvgpr_read_b32 v15, a0
    v_mul_f32 v15, v15, v25
    v_accvgpr_write_b32 a0, v15
    v_accvgpr_read_b32 v15, a1
    v_mul_f32 v15, v15, v25
    v_accvgpr_write_b32 a1, v15
    v_accvgpr_read_b32 v15, a2
    v_mul_f32 v15, v15, v25
    v_accvgpr_write_b32 a2, v15
    v_accvgpr_read_b32 v15, a3
    v_mul_f32 v15, v15, v25
    v_accvgpr_write_b32 a3, v15
    v_accvgpr_read_b32 v15, a4
    v_mul_f32 v15, v15, v25
    v_accvgpr_write_b32 a4, v15
    v_accvgpr_read_b32 v15, a5
    v_mul_f32 v15, v15, v25
    v_accvgpr_write_b32 a5, v15
    v_accvgpr_read_b32 v15, a6
    v_mul_f32 v15, v15, v25
    v_accvgpr_write_b32 a6, v15
    v_accvgpr_read_b32 v15, a7
    v_mul_f32 v15, v15, v25
    v_accvgpr_write_b32 a7, v15
    v_accvgpr_read_b32 v15, a8
    v_mul_f32 v15, v15, v25
    v_accvgpr_write_b32 a8, v15
    v_accvgpr_read_b32 v15, a9
    v_mul_f32 v15, v15, v25
    v_accvgpr_write_b32 a9, v15
    v_accvgpr_read_b32 v15, a10
    v_mul_f32 v15, v15, v25
    v_accvgpr_write_b32 a10, v15
    v_accvgpr_read_b32 v15, a11
    v_mul_f32 v15, v15, v25
    v_accvgpr_write_b32 a11, v15
    v_accvgpr_read_b32 v15, a12
    v_mul_f32 v15, v15, v25
    v_accvgpr_write_b32 a12, v15
    v_accvgpr_read_b32 v15, a13
    v_mul_f32 v15, v15, v25
    v_accvgpr_write_b32 a13, v15
    v_accvgpr_read_b32 v15, a14
    v_mul_f32 v15, v15, v25
    v_accvgpr_write_b32 a14, v15
    v_accvgpr_read_b32 v15, a15
    v_mul_f32 v15, v15, v25
    v_accvgpr_write_b32 a15, v15
    v_accvgpr_read_b32 v15, a16
    v_mul_f32 v15, v15, v25
    v_accvgpr_write_b32 a16, v15
    v_accvgpr_read_b32 v15, a17
    v_mul_f32 v15, v15, v25
    v_accvgpr_write_b32 a17, v15
    v_accvgpr_read_b32 v15, a18
    v_mul_f32 v15, v15, v25
    v_accvgpr_write_b32 a18, v15
    v_accvgpr_read_b32 v15, a19
    v_mul_f32 v15, v15, v25
    v_accvgpr_write_b32 a19, v15
    v_accvgpr_read_b32 v15, a20
    v_mul_f32 v15, v15, v25
    v_accvgpr_write_b32 a20, v15
    v_accvgpr_read_b32 v15, a21
    v_mul_f32 v15, v15, v25
    v_accvgpr_write_b32 a21, v15
    v_accvgpr_read_b32 v15, a22
    v_mul_f32 v15, v15, v25
    v_accvgpr_write_b32 a22, v15
    v_accvgpr_read_b32 v15, a23
    v_mul_f32 v15, v15, v25
    v_accvgpr_write_b32 a23, v15
    v_accvgpr_read_b32 v15, a24
    v_mul_f32 v15, v15, v25
    v_accvgpr_write_b32 a24, v15
    v_accvgpr_read_b32 v15, a25
    v_mul_f32 v15, v15, v25
    v_accvgpr_write_b32 a25, v15
    v_accvgpr_read_b32 v15, a26
    v_mul_f32 v15, v15, v25
    v_accvgpr_write_b32 a26, v15
    v_accvgpr_read_b32 v15, a27
    v_mul_f32 v15, v15, v25
    v_accvgpr_write_b32 a27, v15
    v_accvgpr_read_b32 v15, a28
    v_mul_f32 v15, v15, v25
    v_accvgpr_write_b32 a28, v15
    v_accvgpr_read_b32 v15, a29
    v_mul_f32 v15, v15, v25
    v_accvgpr_write_b32 a29, v15
    v_accvgpr_read_b32 v15, a30
    v_mul_f32 v15, v15, v25
    v_accvgpr_write_b32 a30, v15
    v_accvgpr_read_b32 v15, a31
    v_mul_f32 v15, v15, v25
    v_accvgpr_write_b32 a31, v15
    v_accvgpr_read_b32 v15, a32
    v_mul_f32 v15, v15, v25
    v_accvgpr_write_b32 a32, v15
    v_accvgpr_read_b32 v15, a33
    v_mul_f32 v15, v15, v25
    v_accvgpr_write_b32 a33, v15
    v_accvgpr_read_b32 v15, a34
    v_mul_f32 v15, v15, v25
    v_accvgpr_write_b32 a34, v15
    v_accvgpr_read_b32 v15, a35
    v_mul_f32 v15, v15, v25
    v_accvgpr_write_b32 a35, v15
    v_accvgpr_read_b32 v15, a36
    v_mul_f32 v15, v15, v25
    v_accvgpr_write_b32 a36, v15
    v_accvgpr_read_b32 v15, a37
    v_mul_f32 v15, v15, v25
    v_accvgpr_write_b32 a37, v15
    v_accvgpr_read_b32 v15, a38
    v_mul_f32 v15, v15, v25
    v_accvgpr_write_b32 a38, v15
    v_accvgpr_read_b32 v15, a39
    v_mul_f32 v15, v15, v25
    v_accvgpr_write_b32 a39, v15
    v_accvgpr_read_b32 v15, a40
    v_mul_f32 v15, v15, v25
    v_accvgpr_write_b32 a40, v15
    v_accvgpr_read_b32 v15, a41
    v_mul_f32 v15, v15, v25
    v_accvgpr_write_b32 a41, v15
    v_accvgpr_read_b32 v15, a42
    v_mul_f32 v15, v15, v25
    v_accvgpr_write_b32 a42, v15
    v_accvgpr_read_b32 v15, a43
    v_mul_f32 v15, v15, v25
    v_accvgpr_write_b32 a43, v15
    v_accvgpr_read_b32 v15, a44
    v_mul_f32 v15, v15, v25
    v_accvgpr_write_b32 a44, v15
    v_accvgpr_read_b32 v15, a45
    v_mul_f32 v15, v15, v25
    v_accvgpr_write_b32 a45, v15
    v_accvgpr_read_b32 v15, a46
    v_mul_f32 v15, v15, v25
    v_accvgpr_write_b32 a46, v15
    v_accvgpr_read_b32 v15, a47
    v_mul_f32 v15, v15, v25
    v_accvgpr_write_b32 a47, v15
    v_fma_f32 v104, v104, s28, v12
    v_fma_f32 v105, v105, s28, v12
    v_exp_f32_e64 v104, v104 clamp
    v_exp_f32_e64 v105, v105 clamp
    s_nop 0
    v_cvt_pk_bf16_f32 v34, v104, v105
    v_fma_f32 v106, v106, s28, v12
    v_fma_f32 v107, v107, s28, v12
    v_exp_f32_e64 v106, v106 clamp
    v_exp_f32_e64 v107, v107 clamp
    s_nop 0
    v_cvt_pk_bf16_f32 v35, v106, v107
    v_fma_f32 v108, v108, s28, v12
    v_fma_f32 v109, v109, s28, v12
    v_exp_f32_e64 v108, v108 clamp
    v_exp_f32_e64 v109, v109 clamp
    s_nop 0
    v_cvt_pk_bf16_f32 v32, v108, v109
    v_fma_f32 v110, v110, s28, v12
    v_fma_f32 v111, v111, s28, v12
    v_exp_f32_e64 v110, v110 clamp
    v_exp_f32_e64 v111, v111 clamp
    s_nop 0
    v_cvt_pk_bf16_f32 v33, v110, v111
    s_add_u32 s69, s39, 0
    buffer_load_dwordx4 v[92:95], v26, s[4:7], s69 offen offset:0
    s_waitcnt vmcnt(0)
    v_mfma_f32_16x16x32_bf16 v[104:107], v[92:95], a[192:195], 0
    s_nop 7
    buffer_load_dwordx4 v[92:95], v26, s[4:7], s69 offen offset:64
    s_waitcnt vmcnt(0)
    v_mfma_f32_16x16x32_bf16 v[104:107], v[92:95], a[196:199], v[104:107]
    s_nop 7
    buffer_load_dwordx4 v[92:95], v26, s[4:7], s69 offen offset:128
    s_waitcnt vmcnt(0)
    v_mfma_f32_16x16x32_bf16 v[104:107], v[92:95], a[200:203], v[104:107]
    s_nop 7
    buffer_load_dwordx4 v[92:95], v26, s[4:7], s69 offen offset:192
    s_waitcnt vmcnt(0)
    v_mfma_f32_16x16x32_bf16 v[104:107], v[92:95], a[204:207], v[104:107]
    s_nop 7
    buffer_load_dwordx4 v[92:95], v26, s[4:7], s69 offen offset:256
    s_waitcnt vmcnt(0)
    v_mfma_f32_16x16x32_bf16 v[104:107], v[92:95], a[208:211], v[104:107]
    s_nop 7
    buffer_load_dwordx4 v[92:95], v26, s[4:7], s69 offen offset:320
    s_waitcnt vmcnt(0)
    v_mfma_f32_16x16x32_bf16 v[104:107], v[92:95], a[212:215], v[104:107]
    s_nop 7
    s_add_u32 s69, s39, 6144
    buffer_load_dwordx4 v[92:95], v26, s[4:7], s69 offen offset:0
    s_waitcnt vmcnt(0)
    v_mfma_f32_16x16x32_bf16 v[108:111], v[92:95], a[192:195], 0
    s_nop 7
    buffer_load_dwordx4 v[92:95], v26, s[4:7], s69 offen offset:64
    s_waitcnt vmcnt(0)
    v_mfma_f32_16x16x32_bf16 v[108:111], v[92:95], a[196:199], v[108:111]
    s_nop 7
    buffer_load_dwordx4 v[92:95], v26, s[4:7], s69 offen offset:128
    s_waitcnt vmcnt(0)
    v_mfma_f32_16x16x32_bf16 v[108:111], v[92:95], a[200:203], v[108:111]
    s_nop 7
    buffer_load_dwordx4 v[92:95], v26, s[4:7], s69 offen offset:192
    s_waitcnt vmcnt(0)
    v_mfma_f32_16x16x32_bf16 v[108:111], v[92:95], a[204:207], v[108:111]
    s_nop 7
    buffer_load_dwordx4 v[92:95], v26, s[4:7], s69 offen offset:256
    s_waitcnt vmcnt(0)
    v_mfma_f32_16x16x32_bf16 v[108:111], v[92:95], a[208:211], v[108:111]
    s_nop 7
    buffer_load_dwordx4 v[92:95], v26, s[4:7], s69 offen offset:320
    s_waitcnt vmcnt(0)
    v_mfma_f32_16x16x32_bf16 v[108:111], v[92:95], a[212:215], v[108:111]
    s_nop 7
    s_nop 15
    v_max3_f32 v14, v104, v105, v106
    v_max3_f32 v14, v14, v107, v108
    v_max3_f32 v14, v14, v109, v110
    v_max_f32 v14, v14, v111
    v_mov_b32 v15, v14
    s_nop 1
    v_permlane32_swap_b32 v15, v14
    v_max_f32 v14, v14, v15
    v_mov_b32 v15, v14
    s_nop 1
    v_permlane16_swap_b32 v15, v14
    v_max_f32 v14, v14, v15
    v_fma_f32 v14, v14, s28, v13
    v_add_f32 v14, 0x42000000, v14
    v_max_f32 v24, 0, v14
    v_sub_f32 v13, v13, v24
    v_sub_f32 v25, 0, v24
    v_exp_f32 v25, v25
    s_nop 0
    v_mul_f32 v15, v46, v25
    v_cndmask_b32_e64 v46, v46, v15, s[46:47]
    v_mul_f32 v51, v51, v25
    v_accvgpr_read_b32 v15, a48
    v_mul_f32 v15, v15, v25
    v_accvgpr_write_b32 a48, v15
    v_accvgpr_read_b32 v15, a49
    v_mul_f32 v15, v15, v25
    v_accvgpr_write_b32 a49, v15
    v_accvgpr_read_b32 v15, a50
    v_mul_f32 v15, v15, v25
    v_accvgpr_write_b32 a50, v15
    v_accvgpr_read_b32 v15, a51
    v_mul_f32 v15, v15, v25
    v_accvgpr_write_b32 a51, v15
    v_accvgpr_read_b32 v15, a52
    v_mul_f32 v15, v15, v25
    v_accvgpr_write_b32 a52, v15
    v_accvgpr_read_b32 v15, a53
    v_mul_f32 v15, v15, v25
    v_accvgpr_write_b32 a53, v15
    v_accvgpr_read_b32 v15, a54
    v_mul_f32 v15, v15, v25
    v_accvgpr_write_b32 a54, v15
    v_accvgpr_read_b32 v15, a55
    v_mul_f32 v15, v15, v25
    v_accvgpr_write_b32 a55, v15
    v_accvgpr_read_b32 v15, a56
    v_mul_f32 v15, v15, v25
    v_accvgpr_write_b32 a56, v15
    v_accvgpr_read_b32 v15, a57
    v_mul_f32 v15, v15, v25
    v_accvgpr_write_b32 a57, v15
    v_accvgpr_read_b32 v15, a58
    v_mul_f32 v15, v15, v25
    v_accvgpr_write_b32 a58, v15
    v_accvgpr_read_b32 v15, a59
    v_mul_f32 v15, v15, v25
    v_accvgpr_write_b32 a59, v15
    v_accvgpr_read_b32 v15, a60
    v_mul_f32 v15, v15, v25
    v_accvgpr_write_b32 a60, v15
    v_accvgpr_read_b32 v15, a61
    v_mul_f32 v15, v15, v25
    v_accvgpr_write_b32 a61, v15
    v_accvgpr_read_b32 v15, a62
    v_mul_f32 v15, v15, v25
    v_accvgpr_write_b32 a62, v15
    v_accvgpr_read_b32 v15, a63
    v_mul_f32 v15, v15, v25
    v_accvgpr_write_b32 a63, v15
    v_accvgpr_read_b32 v15, a64
    v_mul_f32 v15, v15, v25
    v_accvgpr_write_b32 a64, v15
    v_accvgpr_read_b32 v15, a65
    v_mul_f32 v15, v15, v25
    v_accvgpr_write_b32 a65, v15
    v_accvgpr_read_b32 v15, a66
    v_mul_f32 v15, v15, v25
    v_accvgpr_write_b32 a66, v15
    v_accvgpr_read_b32 v15, a67
    v_mul_f32 v15, v15, v25
    v_accvgpr_write_b32 a67, v15
    v_accvgpr_read_b32 v15, a68
    v_mul_f32 v15, v15, v25
    v_accvgpr_write_b32 a68, v15
    v_accvgpr_read_b32 v15, a69
    v_mul_f32 v15, v15, v25
    v_accvgpr_write_b32 a69, v15
    v_accvgpr_read_b32 v15, a70
    v_mul_f32 v15, v15, v25
    v_accvgpr_write_b32 a70, v15
    v_accvgpr_read_b32 v15, a71
    v_mul_f32 v15, v15, v25
    v_accvgpr_write_b32 a71, v15
    v_accvgpr_read_b32 v15, a72
    v_mul_f32 v15, v15, v25
    v_accvgpr_write_b32 a72, v15
    v_accvgpr_read_b32 v15, a73
    v_mul_f32 v15, v15, v25
    v_accvgpr_write_b32 a73, v15
    v_accvgpr_read_b32 v15, a74
    v_mul_f32 v15, v15, v25
    v_accvgpr_write_b32 a74, v15
    v_accvgpr_read_b32 v15, a75
    v_mul_f32 v15, v15, v25
    v_accvgpr_write_b32 a75, v15
    v_accvgpr_read_b32 v15, a76
    v_mul_f32 v15, v15, v25
    v_accvgpr_write_b32 a76, v15
    v_accvgpr_read_b32 v15, a77
    v_mul_f32 v15, v15, v25
    v_accvgpr_write_b32 a77, v15
    v_accvgpr_read_b32 v15, a78
    v_mul_f32 v15, v15, v25
    v_accvgpr_write_b32 a78, v15
    v_accvgpr_read_b32 v15, a79
    v_mul_f32 v15, v15, v25
    v_accvgpr_write_b32 a79, v15
    v_accvgpr_read_b32 v15, a80
    v_mul_f32 v15, v15, v25
    v_accvgpr_write_b32 a80, v15
    v_accvgpr_read_b32 v15, a81
    v_mul_f32 v15, v15, v25
    v_accvgpr_write_b32 a81, v15
    v_accvgpr_read_b32 v15, a82
    v_mul_f32 v15, v15, v25
    v_accvgpr_write_b32 a82, v15
    v_accvgpr_read_b32 v15, a83
    v_mul_f32 v15, v15, v25
    v_accvgpr_write_b32 a83, v15
    v_accvgpr_read_b32 v15, a84
    v_mul_f32 v15, v15, v25
    v_accvgpr_write_b32 a84, v15
    v_accvgpr_read_b32 v15, a85
    v_mul_f32 v15, v15, v25
    v_accvgpr_write_b32 a85, v15
    v_accvgpr_read_b32 v15, a86
    v_mul_f32 v15, v15, v25
    v_accvgpr_write_b32 a86, v15
    v_accvgpr_read_b32 v15, a87
    v_mul_f32 v15, v15, v25
    v_accvgpr_write_b32 a87, v15
    v_accvgpr_read_b32 v15, a88
    v_mul_f32 v15, v15, v25
    v_accvgpr_write_b32 a88, v15
    v_accvgpr_read_b32 v15, a89
    v_mul_f32 v15, v15, v25
    v_accvgpr_write_b32 a89, v15
    v_accvgpr_read_b32 v15, a90
    v_mul_f32 v15, v15, v25
    v_accvgpr_write_b32 a90, v15
    v_accvgpr_read_b32 v15, a91
    v_mul_f32 v15, v15, v25
    v_accvgpr_write_b32 a91, v15
    v_accvgpr_read_b32 v15, a92
    v_mul_f32 v15, v15, v25
    v_accvgpr_write_b32 a92, v15
    v_accvgpr_read_b32 v15, a93
    v_mul_f32 v15, v15, v25
    v_accvgpr_write_b32 a93, v15
    v_accvgpr_read_b32 v15, a94
    v_mul_f32 v15, v15, v25
    v_accvgpr_write_b32 a94, v15
    v_accvgpr_read_b32 v15, a95
    v_mul_f32 v15, v15, v25
    v_accvgpr_write_b32 a95, v15
    v_fma_f32 v104, v104, s28, v13
    v_fma_f32 v105, v105, s28, v13
    v_exp_f32_e64 v104, v104 clamp
    v_exp_f32_e64 v105, v105 clamp
    s_nop 0
    v_cvt_pk_bf16_f32 v42, v104, v105
    v_fma_f32 v106, v106, s28, v13
    v_fma_f32 v107, v107, s28, v13
    v_exp_f32_e64 v106, v106 clamp
    v_exp_f32_e64 v107, v107 clamp
    s_nop 0
    v_cvt_pk_bf16_f32 v43, v106, v107
    v_fma_f32 v108, v108, s28, v13
    v_fma_f32 v109, v109, s28, v13
    v_exp_f32_e64 v108, v108 clamp
    v_exp_f32_e64 v109, v109 clamp
    s_nop 0
    v_cvt_pk_bf16_f32 v40, v108, v109
    v_fma_f32 v110, v110, s28, v13
    v_fma_f32 v111, v111, s28, v13
    v_exp_f32_e64 v110, v110 clamp
    v_exp_f32_e64 v111, v111 clamp
    s_nop 0
    v_cvt_pk_bf16_f32 v41, v110, v111
    v_smfmac_f32_16x16x64_bf16 v[48:51], a[240:243], v[16:23], v101
    v_smfmac_f32_16x16x64_bf16 v[48:51], a[244:247], v[28:35], v101
    v_mfma_f32_16x16x32_bf16 v[48:51], a[248:251], v[40:43], v[48:51]
    s_nop 15
    s_setpc_b64 s[40:41]
L_rare4_0:
    s_nop 15
    v_mov_b32 v104, 0
    v_mov_b32 v105, 0
    v_mov_b32 v106, 0
    v_mov_b32 v107, 0
    s_nop 1
    v_mfma_f32_16x16x32_bf16 v[104:107], a[248:251], v[14:17], v[104:107]
    v_smfmac_f32_16x16x64_bf16 v[104:107], a[240:243], v[22:29], v101
    v_mfma_f32_16x16x32_bf16 v[104:107], a[252:255], v[34:37], v[104:107]
    s_nop 15
    v_sub_f32 v45, v45, v105
    v_sub_f32 v46, v46, v106
    v_sub_f32 v47, v47, v107
    v_mov_b32 v44, 0
    v_mov_b32 v48, 0
    v_mbcnt_lo_u32_b32 v31, -1, 0
    v_mbcnt_hi_u32_b32 v31, -1, v31
    v_and_b32 v30, 15, v31
    v_mul_u32_u24 v30, 384, v30
    v_lshrrev_b32 v31, 4, v31
    v_lshl_add_u32 v30, v31, 4, v30
    s_add_u32 s69, s39, 0
    buffer_load_dwordx4 v[92:95], v30, s[4:7], s69 offen offset:0
    s_waitcnt vmcnt(0)
    v_mfma_f32_16x16x32_bf16 v[104:107], v[92:95], a[96:99], 0
    s_nop 7
    buffer_load_dwordx4 v[92:95], v30, s[4:7], s69 offen offset:64
    s_waitcnt vmcnt(0)
    v_mfma_f32_16x16x32_bf16 v[104:107], v[92:95], a[100:103], v[104:107]
    s_nop 7
    buffer_load_dwordx4 v[92:95], v30, s[4:7], s69 offen offset:128
    s_waitcnt vmcnt(0)
    v_mfma_f32_16x16x32_bf16 v[104:107], v[92:95], a[104:107], v[104:107]
    s_nop 7
    buffer_load_dwordx4 v[92:95], v30, s[4:7], s69 offen offset:192
    s_waitcnt vmcnt(0)
    v_mfma_f32_16x16x32_bf16 v[104:107], v[92:95], a[108:111], v[104:107]
    s_nop 7
    buffer_load_dwordx4 v[92:95], v30, s[4:7], s69 offen offset:256
    s_waitcnt vmcnt(0)
    v_mfma_f32_16x16x32_bf16 v[104:107], v[92:95], a[112:115], v[104:107]
    s_nop 7
    buffer_load_dwordx4 v[92:95], v30, s[4:7], s69 offen offset:320
    s_waitcnt vmcnt(0)
    v_mfma_f32_16x16x32_bf16 v[104:107], v[92:95], a[116:119], v[104:107]
    s_nop 7
    s_add_u32 s69, s39, 6144
    buffer_load_dwordx4 v[92:95], v30, s[4:7], s69 offen offset:0
    s_waitcnt vmcnt(0)
    v_mfma_f32_16x16x32_bf16 v[108:111], v[92:95], a[96:99], 0
    s_nop 7
    buffer_load_dwordx4 v[92:95], v30, s[4:7], s69 offen offset:64
    s_waitcnt vmcnt(0)
    v_mfma_f32_16x16x32_bf16 v[108:111], v[92:95], a[100:103], v[108:111]
    s_nop 7
    buffer_load_dwordx4 v[92:95], v30, s[4:7], s69 offen offset:128
    s_waitcnt vmcnt(0)
    v_mfma_f32_16x16x32_bf16 v[108:111], v[92:95], a[104:107], v[108:111]
    s_nop 7
    buffer_load_dwordx4 v[92:95], v30, s[4:7], s69 offen offset:192
    s_waitcnt vmcnt(0)
    v_mfma_f32_16x16x32_bf16 v[108:111], v[92:95], a[108:111], v[108:111]
    s_nop 7
    buffer_load_dwordx4 v[92:95], v30, s[4:7], s69 offen offset:256
    s_waitcnt vmcnt(0)
    v_mfma_f32_16x16x32_bf16 v[108:111], v[92:95], a[112:115], v[108:111]
    s_nop 7
    buffer_load_dwordx4 v[92:95], v30, s[4:7], s69 offen offset:320
    s_waitcnt vmcnt(0)
    v_mfma_f32_16x16x32_bf16 v[108:111], v[92:95], a[116:119], v[108:111]
    s_nop 7
    s_nop 15
    v_max3_f32 v18, v104, v105, v106
    v_max3_f32 v18, v18, v107, v108
    v_max3_f32 v18, v18, v109, v110
    v_max_f32 v18, v18, v111
    v_mov_b32 v19, v18
    s_nop 1
    v_permlane32_swap_b32 v19, v18
    v_max_f32 v18, v18, v19
    v_mov_b32 v19, v18
    s_nop 1
    v_permlane16_swap_b32 v19, v18
    v_max_f32 v18, v18, v19
    v_fma_f32 v18, v18, s28, v9
    v_add_f32 v18, 0x42000000, v18
    v_max_f32 v20, 0, v18
    v_sub_f32 v9, v9, v20
    v_sub_f32 v21, 0, v20
    v_exp_f32 v21, v21
    s_nop 0
    v_mul_f32 v47, v47, v21
    v_mul_f32 v19, v49, v21
    v_cndmask_b32_e64 v49, v19, v49, s[46:47]
    v_mul_f32 v112, v112, v21
    v_mul_f32 v113, v113, v21
    v_mul_f32 v114, v114, v21
    v_mul_f32 v115, v115, v21
    v_mul_f32 v116, v116, v21
    v_mul_f32 v117, v117, v21
    v_mul_f32 v118, v118, v21
    v_mul_f32 v119, v119, v21
    v_mul_f32 v120, v120, v21
    v_mul_f32 v121, v121, v21
    v_mul_f32 v122, v122, v21
    v_mul_f32 v123, v123, v21
    v_mul_f32 v124, v124, v21
    v_mul_f32 v125, v125, v21
    v_mul_f32 v126, v126, v21
    v_mul_f32 v127, v127, v21
    v_mul_f32 v128, v128, v21
    v_mul_f32 v129, v129, v21
    v_mul_f32 v130, v130, v21
    v_mul_f32 v131, v131, v21
    v_mul_f32 v132, v132, v21
    v_mul_f32 v133, v133, v21
    v_mul_f32 v134, v134, v21
    v_mul_f32 v135, v135, v21
    v_mul_f32 v136, v136, v21
    v_mul_f32 v137, v137, v21
    v_mul_f32 v138, v138, v21
    v_mul_f32 v139, v139, v21
    v_mul_f32 v140, v140, v21
    v_mul_f32 v141, v141, v21
    v_mul_f32 v142, v142, v21
    v_mul_f32 v143, v143, v21
    v_mul_f32 v144, v144, v21
    v_mul_f32 v145, v145, v21
    v_mul_f32 v146, v146, v21
    v_mul_f32 v147, v147, v21
    v_mul_f32 v148, v148, v21
    v_mul_f32 v149, v149, v21
    v_mul_f32 v150, v150, v21
    v_mul_f32 v151, v151, v21
    v_mul_f32 v152, v152, v21
    v_mul_f32 v153, v153, v21
    v_mul_f32 v154, v154, v21
    v_mul_f32 v155, v155, v21
    v_mul_f32 v156, v156, v21
    v_mul_f32 v157, v157, v21
    v_mul_f32 v158, v158, v21
    v_mul_f32 v159, v159, v21
    v_fma_f32 v104, v104, s28, v9
    v_fma_f32 v105, v105, s28, v9
    v_exp_f32_e64 v104, v104 clamp
    v_exp_f32_e64 v105, v105 clamp
    s_nop 0
    v_cvt_pk_bf16_f32 v14, v104, v105
    v_fma_f32 v106, v106, s28, v9
    v_fma_f32 v107, v107, s28, v9
    v_exp_f32_e64 v106, v106 clamp
    v_exp_f32_e64 v107, v107 clamp
    s_nop 0
    v_cvt_pk_bf16_f32 v15, v106, v107
    v_fma_f32 v108, v108, s28, v9
    v_fma_f32 v109, v109, s28, v9
    v_exp_f32_e64 v108, v108 clamp
    v_exp_f32_e64 v109, v109 clamp
    s_nop 0
    v_cvt_pk_bf16_f32 v16, v108, v109
    v_fma_f32 v110, v110, s28, v9
    v_fma_f32 v111, v111, s28, v9
    v_exp_f32_e64 v110, v110 clamp
    v_exp_f32_e64 v111, v111 clamp
    s_nop 0
    v_cvt_pk_bf16_f32 v17, v110, v111
    s_add_u32 s69, s39, 0
    buffer_load_dwordx4 v[92:95], v30, s[4:7], s69 offen offset:0
    s_waitcnt vmcnt(0)
    v_mfma_f32_16x16x32_bf16 v[104:107], v[92:95], a[120:123], 0
    s_nop 7
    buffer_load_dwordx4 v[92:95], v30, s[4:7], s69 offen offset:64
    s_waitcnt vmcnt(0)
    v_mfma_f32_16x16x32_bf16 v[104:107], v[92:95], a[124:127], v[104:107]
    s_nop 7
    buffer_load_dwordx4 v[92:95], v30, s[4:7], s69 offen offset:128
    s_waitcnt vmcnt(0)
    v_mfma_f32_16x16x32_bf16 v[104:107], v[92:95], a[128:131], v[104:107]
    s_nop 7
    buffer_load_dwordx4 v[92:95], v30, s[4:7], s69 offen offset:192
    s_waitcnt vmcnt(0)
    v_mfma_f32_16x16x32_bf16 v[104:107], v[92:95], a[132:135], v[104:107]
    s_nop 7
    buffer_load_dwordx4 v[92:95], v30, s[4:7], s69 offen offset:256
    s_waitcnt vmcnt(0)
    v_mfma_f32_16x16x32_bf16 v[104:107], v[92:95], a[136:139], v[104:107]
    s_nop 7
    buffer_load_dwordx4 v[92:95], v30, s[4:7], s69 offen offset:320
    s_waitcnt vmcnt(0)
    v_mfma_f32_16x16x32_bf16 v[104:107], v[92:95], a[140:143], v[104:107]
    s_nop 7
    s_add_u32 s69, s39, 6144
    buffer_load_dwordx4 v[92:95], v30, s[4:7], s69 offen offset:0
    s_waitcnt vmcnt(0)
    v_mfma_f32_16x16x32_bf16 v[108:111], v[92:95], a[120:123], 0
    s_nop 7
    buffer_load_dwordx4 v[92:95], v30, s[4:7], s69 offen offset:64
    s_waitcnt vmcnt(0)
    v_mfma_f32_16x16x32_bf16 v[108:111], v[92:95], a[124:127], v[108:111]
    s_nop 7
    buffer_load_dwordx4 v[92:95], v30, s[4:7], s69 offen offset:128
    s_waitcnt vmcnt(0)
    v_mfma_f32_16x16x32_bf16 v[108:111], v[92:95], a[128:131], v[108:111]
    s_nop 7
    buffer_load_dwordx4 v[92:95], v30, s[4:7], s69 offen offset:192
    s_waitcnt vmcnt(0)
    v_mfma_f32_16x16x32_bf16 v[108:111], v[92:95], a[132:135], v[108:111]
    s_nop 7
    buffer_load_dwordx4 v[92:95], v30, s[4:7], s69 offen offset:256
    s_waitcnt vmcnt(0)
    v_mfma_f32_16x16x32_bf16 v[108:111], v[92:95], a[136:139], v[108:111]
    s_nop 7
    buffer_load_dwordx4 v[92:95], v30, s[4:7], s69 offen offset:320
    s_waitcnt vmcnt(0)
    v_mfma_f32_16x16x32_bf16 v[108:111], v[92:95], a[140:143], v[108:111]
    s_nop 7
    s_nop 15
    v_max3_f32 v18, v104, v105, v106
    v_max3_f32 v18, v18, v107, v108
    v_max3_f32 v18, v18, v109, v110
    v_max_f32 v18, v18, v111
    v_mov_b32 v19, v18
    s_nop 1
    v_permlane32_swap_b32 v19, v18
    v_max_f32 v18, v18, v19
    v_mov_b32 v19, v18
    s_nop 1
    v_permlane16_swap_b32 v19, v18
    v_max_f32 v18, v18, v19
    v_fma_f32 v18, v18, s28, v10
    v_add_f32 v18, 0x42000000, v18
    v_max_f32 v20, 0, v18
    v_sub_f32 v10, v10, v20
    v_sub_f32 v21, 0, v20
    v_exp_f32 v21, v21
    s_nop 0
    v_mul_f32 v19, v45, v21
    v_cndmask_b32_e64 v45, v19, v45, s[46:47]
    v_mul_f32 v19, v49, v21
    v_cndmask_b32_e64 v49, v49, v19, s[46:47]
    v_mul_f32 v160, v160, v21
    v_mul_f32 v161, v161, v21
    v_mul_f32 v162, v162, v21
    v_mul_f32 v163, v163, v21
    v_mul_f32 v164, v164, v21
    v_mul_f32 v165, v165, v21
    v_mul_f32 v166, v166, v21
    v_mul_f32 v167, v167, v21
    v_mul_f32 v168, v168, v21
    v_mul_f32 v169, v169, v21
    v_mul_f32 v170, v170, v21
    v_mul_f32 v171, v171, v21
    v_mul_f32 v172, v172, v21
    v_mul_f32 v173, v173, v21
    v_mul_f32 v174, v174, v21
    v_mul_f32 v175, v175, v21
    v_mul_f32 v176, v176, v21
    v_mul_f32 v177, v177, v21
    v_mul_f32 v178, v178, v21
    v_mul_f32 v179, v179, v21
    v_mul_f32 v180, v180, v21
    v_mul_f32 v181, v181, v21
    v_mul_f32 v182, v182, v21
    v_mul_f32 v183, v183, v21
    v_mul_f32 v184, v184, v21
    v_mul_f32 v185, v185, v21
    v_mul_f32 v186, v186, v21
    v_mul_f32 v187, v187, v21
    v_mul_f32 v188, v188, v21
    v_mul_f32 v189, v189, v21
    v_mul_f32 v190, v190, v21
    v_mul_f32 v191, v191, v21
    v_mul_f32 v192, v192, v21
    v_mul_f32 v193, v193, v21
    v_mul_f32 v194, v194, v21
    v_mul_f32 v195, v195, v21
    v_mul_f32 v196, v196, v21
    v_mul_f32 v197, v197, v21
    v_mul_f32 v198, v198, v21
    v_mul_f32 v199, v199, v21
    v_mul_f32 v200, v200, v21
    v_mul_f32 v201, v201, v21
    v_mul_f32 v202, v202, v21
    v_mul_f32 v203, v203, v21
    v_mul_f32 v204, v204, v21
    v_mul_f32 v205, v205, v21
    v_mul_f32 v206, v206, v21
    v_mul_f32 v207, v207, v21
    v_fma_f32 v104, v104, s28, v10
    v_fma_f32 v105, v105, s28, v10
    v_exp_f32_e64 v104, v104 clamp
    v_exp_f32_e64 v105, v105 clamp
    s_nop 0
    v_cvt_pk_bf16_f32 v22, v104, v105
    v_fma_f32 v106, v106, s28, v10
    v_fma_f32 v107, v107, s28, v10
    v_exp_f32_e64 v106, v106 clamp
    v_exp_f32_e64 v107, v107 clamp
    s_nop 0
    v_cvt_pk_bf16_f32 v23, v106, v107
    v_fma_f32 v108, v108, s28, v10
    v_fma_f32 v109, v109, s28, v10
    v_exp_f32_e64 v108, v108 clamp
    v_exp_f32_e64 v109, v109 clamp
    s_nop 0
    v_cvt_pk_bf16_f32 v24, v108, v109
    v_fma_f32 v110, v110, s28, v10
    v_fma_f32 v111, v111, s28, v10
    v_exp_f32_e64 v110, v110 clamp
    v_exp_f32_e64 v111, v111 clamp
    s_nop 0
    v_cvt_pk_bf16_f32 v25, v110, v111
    s_add_u32 s69, s39, 0
    buffer_load_dwordx4 v[92:95], v30, s[4:7], s69 offen offset:0
    s_waitcnt vmcnt(0)
    v_mfma_f32_16x16x32_bf16 v[104:107], v[92:95], a[144:147], 0
    s_nop 7
    buffer_load_dwordx4 v[92:95], v30, s[4:7], s69 offen offset:64
    s_waitcnt vmcnt(0)
    v_mfma_f32_16x16x32_bf16 v[104:107], v[92:95], a[148:151], v[104:107]
    s_nop 7
    buffer_load_dwordx4 v[92:95], v30, s[4:7], s69 offen offset:128
    s_waitcnt vmcnt(0)
    v_mfma_f32_16x16x32_bf16 v[104:107], v[92:95], a[152:155], v[104:107]
    s_nop 7
    buffer_load_dwordx4 v[92:95], v30, s[4:7], s69 offen offset:192
    s_waitcnt vmcnt(0)
    v_mfma_f32_16x16x32_bf16 v[104:107], v[92:95], a[156:159], v[104:107]
    s_nop 7
    buffer_load_dwordx4 v[92:95], v30, s[4:7], s69 offen offset:256
    s_waitcnt vmcnt(0)
    v_mfma_f32_16x16x32_bf16 v[104:107], v[92:95], a[160:163], v[104:107]
    s_nop 7
    buffer_load_dwordx4 v[92:95], v30, s[4:7], s69 offen offset:320
    s_waitcnt vmcnt(0)
    v_mfma_f32_16x16x32_bf16 v[104:107], v[92:95], a[164:167], v[104:107]
    s_nop 7
    s_add_u32 s69, s39, 6144
    buffer_load_dwordx4 v[92:95], v30, s[4:7], s69 offen offset:0
    s_waitcnt vmcnt(0)
    v_mfma_f32_16x16x32_bf16 v[108:111], v[92:95], a[144:147], 0
    s_nop 7
    buffer_load_dwordx4 v[92:95], v30, s[4:7], s69 offen offset:64
    s_waitcnt vmcnt(0)
    v_mfma_f32_16x16x32_bf16 v[108:111], v[92:95], a[148:151], v[108:111]
    s_nop 7
    buffer_load_dwordx4 v[92:95], v30, s[4:7], s69 offen offset:128
    s_waitcnt vmcnt(0)
    v_mfma_f32_16x16x32_bf16 v[108:111], v[92:95], a[152:155], v[108:111]
    s_nop 7
    buffer_load_dwordx4 v[92:95], v30, s[4:7], s69 offen offset:192
    s_waitcnt vmcnt(0)
    v_mfma_f32_16x16x32_bf16 v[108:111], v[92:95], a[156:159], v[108:111]
    s_nop 7
    buffer_load_dwordx4 v[92:95], v30, s[4:7], s69 offen offset:256
    s_waitcnt vmcnt(0)
    v_mfma_f32_16x16x32_bf16 v[108:111], v[92:95], a[160:163], v[108:111]
    s_nop 7
    buffer_load_dwordx4 v[92:95], v30, s[4:7], s69 offen offset:320
    s_waitcnt vmcnt(0)
    v_mfma_f32_16x16x32_bf16 v[108:111], v[92:95], a[164:167], v[108:111]
    s_nop 7
    s_nop 15
    v_max3_f32 v18, v104, v105, v106
    v_max3_f32 v18, v18, v107, v108
    v_max3_f32 v18, v18, v109, v110
    v_max_f32 v18, v18, v111
    v_mov_b32 v19, v18
    s_nop 1
    v_permlane32_swap_b32 v19, v18
    v_max_f32 v18, v18, v19
    v_mov_b32 v19, v18
    s_nop 1
    v_permlane16_swap_b32 v19, v18
    v_max_f32 v18, v18, v19
    v_fma_f32 v18, v18, s28, v11
    v_add_f32 v18, 0x42000000, v18
    v_max_f32 v20, 0, v18
    v_sub_f32 v11, v11, v20
    v_sub_f32 v21, 0, v20
    v_exp_f32 v21, v21
    s_nop 0
    v_mul_f32 v19, v45, v21
    v_cndmask_b32_e64 v45, v45, v19, s[46:47]
    v_mul_f32 v19, v50, v21
    v_cndmask_b32_e64 v50, v19, v50, s[46:47]
    v_mul_f32 v208, v208, v21
    v_mul_f32 v209, v209, v21
    v_mul_f32 v210, v210, v21
    v_mul_f32 v211, v211, v21
    v_mul_f32 v212, v212, v21
    v_mul_f32 v213, v213, v21
    v_mul_f32 v214, v214, v21
    v_mul_f32 v215, v215, v21
    v_mul_f32 v216, v216, v21
    v_mul_f32 v217, v217, v21
    v_mul_f32 v218, v218, v21
    v_mul_f32 v219, v219, v21
    v_mul_f32 v220, v220, v21
    v_mul_f32 v221, v221, v21
    v_mul_f32 v222, v222, v21
    v_mul_f32 v223, v223, v21
    v_mul_f32 v224, v224, v21
    v_mul_f32 v225, v225, v21
    v_mul_f32 v226, v226, v21
    v_mul_f32 v227, v227, v21
    v_mul_f32 v228, v228, v21
    v_mul_f32 v229, v229, v21
    v_mul_f32 v230, v230, v21
    v_mul_f32 v231, v231, v21
    v_mul_f32 v232, v232, v21
    v_mul_f32 v233, v233, v21
    v_mul_f32 v234, v234, v21
    v_mul_f32 v235, v235, v21
    v_mul_f32 v236, v236, v21
    v_mul_f32 v237, v237, v21
    v_mul_f32 v238, v238, v21
    v_mul_f32 v239, v239, v21
    v_mul_f32 v240, v240, v21
    v_mul_f32 v241, v241, v21
    v_mul_f32 v242, v242, v21
    v_mul_f32 v243, v243, v21
    v_mul_f32 v244, v244, v21
    v_mul_f32 v245, v245, v21
    v_mul_f32 v246, v246, v21
    v_mul_f32 v247, v247, v21
    v_mul_f32 v248, v248, v21
    v_mul_f32 v249, v249, v21
    v_mul_f32 v250, v250, v21
    v_mul_f32 v251, v251, v21
    v_mul_f32 v252, v252, v21
    v_mul_f32 v253, v253, v21
    v_mul_f32 v254, v254, v21
    v_mul_f32 v255, v255, v21
    v_fma_f32 v104, v104, s28, v11
    v_fma_f32 v105, v105, s28, v11
    v_exp_f32_e64 v104, v104 clamp
    v_exp_f32_e64 v105, v105 clamp
    s_nop 0
    v_cvt_pk_bf16_f32 v26, v104, v105
    v_fma_f32 v106, v106, s28, v11
    v_fma_f32 v107, v107, s28, v11
    v_exp_f32_e64 v106, v106 clamp
    v_exp_f32_e64 v107, v107 clamp
    s_nop 0
    v_cvt_pk_bf16_f32 v27, v106, v107
    v_fma_f32 v108, v108, s28, v11
    v_fma_f32 v109, v109, s28, v11
    v_exp_f32_e64 v108, v108 clamp
    v_exp_f32_e64 v109, v109 clamp
    s_nop 0
    v_cvt_pk_bf16_f32 v28, v108, v109
    v_fma_f32 v110, v110, s28, v11
    v_fma_f32 v111, v111, s28, v11
    v_exp_f32_e64 v110, v110 clamp
    v_exp_f32_e64 v111, v111 clamp
    s_nop 0
    v_cvt_pk_bf16_f32 v29, v110, v111
    s_add_u32 s69, s39, 0
    buffer_load_dwordx4 v[92:95], v30, s[4:7], s69 offen offset:0
    s_waitcnt vmcnt(0)
    v_mfma_f32_16x16x32_bf16 v[104:107], v[92:95], a[168:171], 0
    s_nop 7
    buffer_load_dwordx4 v[92:95], v30, s[4:7], s69 offen offset:64
    s_waitcnt vmcnt(0)
    v_mfma_f32_16x16x32_bf16 v[104:107], v[92:95], a[172:175], v[104:107]
    s_nop 7
    buffer_load_dwordx4 v[92:95], v30, s[4:7], s69 offen offset:128
    s_waitcnt vmcnt(0)
    v_mfma_f32_16x16x32_bf16 v[104:107], v[92:95], a[176:179], v[104:107]
    s_nop 7
    buffer_load_dwordx4 v[92:95], v30, s[4:7], s69 offen offset:192
    s_waitcnt vmcnt(0)
    v_mfma_f32_16x16x32_bf16 v[104:107], v[92:95], a[180:183], v[104:107]
    s_nop 7
    buffer_load_dwordx4 v[92:95], v30, s[4:7], s69 offen offset:256
    s_waitcnt vmcnt(0)
    v_mfma_f32_16x16x32_bf16 v[104:107], v[92:95], a[184:187], v[104:107]
    s_nop 7
    buffer_load_dwordx4 v[92:95], v30, s[4:7], s69 offen offset:320
    s_waitcnt vmcnt(0)
    v_mfma_f32_16x16x32_bf16 v[104:107], v[92:95], a[188:191], v[104:107]
    s_nop 7
    s_add_u32 s69, s39, 6144
    buffer_load_dwordx4 v[92:95], v30, s[4:7], s69 offen offset:0
    s_waitcnt vmcnt(0)
    v_mfma_f32_16x16x32_bf16 v[108:111], v[92:95], a[168:171], 0
    s_nop 7
    buffer_load_dwordx4 v[92:95], v30, s[4:7], s69 offen offset:64
    s_waitcnt vmcnt(0)
    v_mfma_f32_16x16x32_bf16 v[108:111], v[92:95], a[172:175], v[108:111]
    s_nop 7
    buffer_load_dwordx4 v[92:95], v30, s[4:7], s69 offen offset:128
    s_waitcnt vmcnt(0)
    v_mfma_f32_16x16x32_bf16 v[108:111], v[92:95], a[176:179], v[108:111]
    s_nop 7
    buffer_load_dwordx4 v[92:95], v30, s[4:7], s69 offen offset:192
    s_waitcnt vmcnt(0)
    v_mfma_f32_16x16x32_bf16 v[108:111], v[92:95], a[180:183], v[108:111]
    s_nop 7
    buffer_load_dwordx4 v[92:95], v30, s[4:7], s69 offen offset:256
    s_waitcnt vmcnt(0)
    v_mfma_f32_16x16x32_bf16 v[108:111], v[92:95], a[184:187], v[108:111]
    s_nop 7
    buffer_load_dwordx4 v[92:95], v30, s[4:7], s69 offen offset:320
    s_waitcnt vmcnt(0)
    v_mfma_f32_16x16x32_bf16 v[108:111], v[92:95], a[188:191], v[108:111]
    s_nop 7
    s_nop 15
    v_max3_f32 v18, v104, v105, v106
    v_max3_f32 v18, v18, v107, v108
    v_max3_f32 v18, v18, v109, v110
    v_max_f32 v18, v18, v111
    v_mov_b32 v19, v18
    s_nop 1
    v_permlane32_swap_b32 v19, v18
    v_max_f32 v18, v18, v19
    v_mov_b32 v19, v18
    s_nop 1
    v_permlane16_swap_b32 v19, v18
    v_max_f32 v18, v18, v19
    v_fma_f32 v18, v18, s28, v12
    v_add_f32 v18, 0x42000000, v18
    v_max_f32 v20, 0, v18
    v_sub_f32 v12, v12, v20
    v_sub_f32 v21, 0, v20
    v_exp_f32 v21, v21
    s_nop 0
    v_mul_f32 v19, v46, v21
    v_cndmask_b32_e64 v46, v19, v46, s[46:47]
    v_mul_f32 v19, v50, v21
    v_cndmask_b32_e64 v50, v50, v19, s[46:47]
    v_accvgpr_read_b32 v19, a0
    v_mul_f32 v19, v19, v21
    v_accvgpr_write_b32 a0, v19
    v_accvgpr_read_b32 v19, a1
    v_mul_f32 v19, v19, v21
    v_accvgpr_write_b32 a1, v19
    v_accvgpr_read_b32 v19, a2
    v_mul_f32 v19, v19, v21
    v_accvgpr_write_b32 a2, v19
    v_accvgpr_read_b32 v19, a3
    v_mul_f32 v19, v19, v21
    v_accvgpr_write_b32 a3, v19
    v_accvgpr_read_b32 v19, a4
    v_mul_f32 v19, v19, v21
    v_accvgpr_write_b32 a4, v19
    v_accvgpr_read_b32 v19, a5
    v_mul_f32 v19, v19, v21
    v_accvgpr_write_b32 a5, v19
    v_accvgpr_read_b32 v19, a6
    v_mul_f32 v19, v19, v21
    v_accvgpr_write_b32 a6, v19
    v_accvgpr_read_b32 v19, a7
    v_mul_f32 v19, v19, v21
    v_accvgpr_write_b32 a7, v19
    v_accvgpr_read_b32 v19, a8
    v_mul_f32 v19, v19, v21
    v_accvgpr_write_b32 a8, v19
    v_accvgpr_read_b32 v19, a9
    v_mul_f32 v19, v19, v21
    v_accvgpr_write_b32 a9, v19
    v_accvgpr_read_b32 v19, a10
    v_mul_f32 v19, v19, v21
    v_accvgpr_write_b32 a10, v19
    v_accvgpr_read_b32 v19, a11
    v_mul_f32 v19, v19, v21
    v_accvgpr_write_b32 a11, v19
    v_accvgpr_read_b32 v19, a12
    v_mul_f32 v19, v19, v21
    v_accvgpr_write_b32 a12, v19
    v_accvgpr_read_b32 v19, a13
    v_mul_f32 v19, v19, v21
    v_accvgpr_write_b32 a13, v19
    v_accvgpr_read_b32 v19, a14
    v_mul_f32 v19, v19, v21
    v_accvgpr_write_b32 a14, v19
    v_accvgpr_read_b32 v19, a15
    v_mul_f32 v19, v19, v21
    v_accvgpr_write_b32 a15, v19
    v_accvgpr_read_b32 v19, a16
    v_mul_f32 v19, v19, v21
    v_accvgpr_write_b32 a16, v19
    v_accvgpr_read_b32 v19, a17
    v_mul_f32 v19, v19, v21
    v_accvgpr_write_b32 a17, v19
    v_accvgpr_read_b32 v19, a18
    v_mul_f32 v19, v19, v21
    v_accvgpr_write_b32 a18, v19
    v_accvgpr_read_b32 v19, a19
    v_mul_f32 v19, v19, v21
    v_accvgpr_write_b32 a19, v19
    v_accvgpr_read_b32 v19, a20
    v_mul_f32 v19, v19, v21
    v_accvgpr_write_b32 a20, v19
    v_accvgpr_read_b32 v19, a21
    v_mul_f32 v19, v19, v21
    v_accvgpr_write_b32 a21, v19
    v_accvgpr_read_b32 v19, a22
    v_mul_f32 v19, v19, v21
    v_accvgpr_write_b32 a22, v19
    v_accvgpr_read_b32 v19, a23
    v_mul_f32 v19, v19, v21
    v_accvgpr_write_b32 a23, v19
    v_accvgpr_read_b32 v19, a24
    v_mul_f32 v19, v19, v21
    v_accvgpr_write_b32 a24, v19
    v_accvgpr_read_b32 v19, a25
    v_mul_f32 v19, v19, v21
    v_accvgpr_write_b32 a25, v19
    v_accvgpr_read_b32 v19, a26
    v_mul_f32 v19, v19, v21
    v_accvgpr_write_b32 a26, v19
    v_accvgpr_read_b32 v19, a27
    v_mul_f32 v19, v19, v21
    v_accvgpr_write_b32 a27, v19
    v_accvgpr_read_b32 v19, a28
    v_mul_f32 v19, v19, v21
    v_accvgpr_write_b32 a28, v19
    v_accvgpr_read_b32 v19, a29
    v_mul_f32 v19, v19, v21
    v_accvgpr_write_b32 a29, v19
    v_accvgpr_read_b32 v19, a30
    v_mul_f32 v19, v19, v21
    v_accvgpr_write_b32 a30, v19
    v_accvgpr_read_b32 v19, a31
    v_mul_f32 v19, v19, v21
    v_accvgpr_write_b32 a31, v19
    v_accvgpr_read_b32 v19, a32
    v_mul_f32 v19, v19, v21
    v_accvgpr_write_b32 a32, v19
    v_accvgpr_read_b32 v19, a33
    v_mul_f32 v19, v19, v21
    v_accvgpr_write_b32 a33, v19
    v_accvgpr_read_b32 v19, a34
    v_mul_f32 v19, v19, v21
    v_accvgpr_write_b32 a34, v19
    v_accvgpr_read_b32 v19, a35
    v_mul_f32 v19, v19, v21
    v_accvgpr_write_b32 a35, v19
    v_accvgpr_read_b32 v19, a36
    v_mul_f32 v19, v19, v21
    v_accvgpr_write_b32 a36, v19
    v_accvgpr_read_b32 v19, a37
    v_mul_f32 v19, v19, v21
    v_accvgpr_write_b32 a37, v19
    v_accvgpr_read_b32 v19, a38
    v_mul_f32 v19, v19, v21
    v_accvgpr_write_b32 a38, v19
    v_accvgpr_read_b32 v19, a39
    v_mul_f32 v19, v19, v21
    v_accvgpr_write_b32 a39, v19
    v_accvgpr_read_b32 v19, a40
    v_mul_f32 v19, v19, v21
    v_accvgpr_write_b32 a40, v19
    v_accvgpr_read_b32 v19, a41
    v_mul_f32 v19, v19, v21
    v_accvgpr_write_b32 a41, v19
    v_accvgpr_read_b32 v19, a42
    v_mul_f32 v19, v19, v21
    v_accvgpr_write_b32 a42, v19
    v_accvgpr_read_b32 v19, a43
    v_mul_f32 v19, v19, v21
    v_accvgpr_write_b32 a43, v19
    v_accvgpr_read_b32 v19, a44
    v_mul_f32 v19, v19, v21
    v_accvgpr_write_b32 a44, v19
    v_accvgpr_read_b32 v19, a45
    v_mul_f32 v19, v19, v21
    v_accvgpr_write_b32 a45, v19
    v_accvgpr_read_b32 v19, a46
    v_mul_f32 v19, v19, v21
    v_accvgpr_write_b32 a46, v19
    v_accvgpr_read_b32 v19, a47
    v_mul_f32 v19, v19, v21
    v_accvgpr_write_b32 a47, v19
    v_fma_f32 v104, v104, s28, v12
    v_fma_f32 v105, v105, s28, v12
    v_exp_f32_e64 v104, v104 clamp
    v_exp_f32_e64 v105, v105 clamp
    s_nop 0
    v_cvt_pk_bf16_f32 v34, v104, v105
    v_fma_f32 v106, v106, s28, v12
    v_fma_f32 v107, v107, s28, v12
    v_exp_f32_e64 v106, v106 clamp
    v_exp_f32_e64 v107, v107 clamp
    s_nop 0
    v_cvt_pk_bf16_f32 v35, v106, v107
    v_fma_f32 v108, v108, s28, v12
    v_fma_f32 v109, v109, s28, v12
    v_exp_f32_e64 v108, v108 clamp
    v_exp_f32_e64 v109, v109 clamp
    s_nop 0
    v_cvt_pk_bf16_f32 v36, v108, v109
    v_fma_f32 v110, v110, s28, v12
    v_fma_f32 v111, v111, s28, v12
    v_exp_f32_e64 v110, v110 clamp
    v_exp_f32_e64 v111, v111 clamp
    s_nop 0
    v_cvt_pk_bf16_f32 v37, v110, v111
    v_mfma_f32_16x16x32_bf16 v[44:47], a[248:251], v[14:17], v[44:47]
    v_smfmac_f32_16x16x64_bf16 v[44:47], a[240:243], v[22:29], v101
    v_mfma_f32_16x16x32_bf16 v[44:47], a[252:255], v[34:37], v[44:47]
    s_nop 15
    s_setpc_b64 s[40:41]
L_rare4_1:
    s_nop 15
    v_mov_b32 v104, 0
    v_mov_b32 v105, 0
    v_mov_b32 v106, 0
    v_mov_b32 v107, 0
    s_nop 1
    v_smfmac_f32_16x16x64_bf16 v[104:107], a[240:243], v[16:23], v101
    v_smfmac_f32_16x16x64_bf16 v[104:107], a[244:247], v[28:35], v101
    s_nop 15
    v_sub_f32 v49, v49, v105
    v_sub_f32 v50, v50, v106
    v_sub_f32 v51, v51, v107
    v_mov_b32 v44, 0
    v_mov_b32 v48, 0
    v_mbcnt_lo_u32_b32 v27, -1, 0
    v_mbcnt_hi_u32_b32 v27, -1, v27
    v_and_b32 v26, 15, v27
    v_mul_u32_u24 v26, 384, v26
    v_lshrrev_b32 v27, 4, v27
    v_lshl_add_u32 v26, v27, 4, v26
    s_add_u32 s69, s39, 0
    buffer_load_dwordx4 v[92:95], v26, s[4:7], s69 offen offset:0
    s_waitcnt vmcnt(0)
    v_mfma_f32_16x16x32_bf16 v[104:107], v[92:95], a[96:99], 0
    s_nop 7
    buffer_load_dwordx4 v[92:95], v26, s[4:7], s69 offen offset:64
    s_waitcnt vmcnt(0)
    v_mfma_f32_16x16x32_bf16 v[104:107], v[92:95], a[100:103], v[104:107]
    s_nop 7
    buffer_load_dwordx4 v[92:95], v26, s[4:7], s69 offen offset:128
    s_waitcnt vmcnt(0)
    v_mfma_f32_16x16x32_bf16 v[104:107], v[92:95], a[104:107], v[104:107]
    s_nop 7
    buffer_load_dwordx4 v[92:95], v26, s[4:7], s69 offen offset:192
    s_waitcnt vmcnt(0)
    v_mfma_f32_16x16x32_bf16 v[104:107], v[92:95], a[108:111], v[104:107]
    s_nop 7
    buffer_load_dwordx4 v[92:95], v26, s[4:7], s69 offen offset:256
    s_waitcnt vmcnt(0)
    v_mfma_f32_16x16x32_bf16 v[104:107], v[92:95], a[112:115], v[104:107]
    s_nop 7
    buffer_load_dwordx4 v[92:95], v26, s[4:7], s69 offen offset:320
    s_waitcnt vmcnt(0)
    v_mfma_f32_16x16x32_bf16 v[104:107], v[92:95], a[116:119], v[104:107]
    s_nop 7
    s_add_u32 s69, s39, 6144
    buffer_load_dwordx4 v[92:95], v26, s[4:7], s69 offen offset:0
    s_waitcnt vmcnt(0)
    v_mfma_f32_16x16x32_bf16 v[108:111], v[92:95], a[96:99], 0
    s_nop 7
    buffer_load_dwordx4 v[92:95], v26, s[4:7], s69 offen offset:64
    s_waitcnt vmcnt(0)
    v_mfma_f32_16x16x32_bf16 v[108:111], v[92:95], a[100:103], v[108:111]
    s_nop 7
    buffer_load_dwordx4 v[92:95], v26, s[4:7], s69 offen offset:128
    s_waitcnt vmcnt(0)
    v_mfma_f32_16x16x32_bf16 v[108:111], v[92:95], a[104:107], v[108:111]
    s_nop 7
    buffer_load_dwordx4 v[92:95], v26, s[4:7], s69 offen offset:192
    s_waitcnt vmcnt(0)
    v_mfma_f32_16x16x32_bf16 v[108:111], v[92:95], a[108:111], v[108:111]
    s_nop 7
    buffer_load_dwordx4 v[92:95], v26, s[4:7], s69 offen offset:256
    s_waitcnt vmcnt(0)
    v_mfma_f32_16x16x32_bf16 v[108:111], v[92:95], a[112:115], v[108:111]
    s_nop 7
    buffer_load_dwordx4 v[92:95], v26, s[4:7], s69 offen offset:320
    s_waitcnt vmcnt(0)
    v_mfma_f32_16x16x32_bf16 v[108:111], v[92:95], a[116:119], v[108:111]
    s_nop 7
    s_nop 15
    v_max3_f32 v14, v104, v105, v106
    v_max3_f32 v14, v14, v107, v108
    v_max3_f32 v14, v14, v109, v110
    v_max_f32 v14, v14, v111
    v_mov_b32 v15, v14
    s_nop 1
    v_permlane32_swap_b32 v15, v14
    v_max_f32 v14, v14, v15
    v_mov_b32 v15, v14
    s_nop 1
    v_permlane16_swap_b32 v15, v14
    v_max_f32 v14, v14, v15
    v_fma_f32 v14, v14, s28, v9
    v_add_f32 v14, 0x42000000, v14
    v_max_f32 v24, 0, v14
    v_sub_f32 v9, v9, v24
    v_sub_f32 v25, 0, v24
    v_exp_f32 v25, v25
    s_nop 0
    v_mul_f32 v47, v47, v25
    v_mul_f32 v15, v49, v25
    v_cndmask_b32_e64 v49, v15, v49, s[46:47]
    v_mul_f32 v112, v112, v25
    v_mul_f32 v113, v113, v25
    v_mul_f32 v114, v114, v25
    v_mul_f32 v115, v115, v25
    v_mul_f32 v116, v116, v25
    v_mul_f32 v117, v117, v25
    v_mul_f32 v118, v118, v25
    v_mul_f32 v119, v119, v25
    v_mul_f32 v120, v120, v25
    v_mul_f32 v121, v121, v25
    v_mul_f32 v122, v122, v25
    v_mul_f32 v123, v123, v25
    v_mul_f32 v124, v124, v25
    v_mul_f32 v125, v125, v25
    v_mul_f32 v126, v126, v25
    v_mul_f32 v127, v127, v25
    v_mul_f32 v128, v128, v25
    v_mul_f32 v129, v129, v25
    v_mul_f32 v130, v130, v25
    v_mul_f32 v131, v131, v25
    v_mul_f32 v132, v132, v25
    v_mul_f32 v133, v133, v25
    v_mul_f32 v134, v134, v25
    v_mul_f32 v135, v135, v25
    v_mul_f32 v136, v136, v25
    v_mul_f32 v137, v137, v25
    v_mul_f32 v138, v138, v25
    v_mul_f32 v139, v139, v25
    v_mul_f32 v140, v140, v25
    v_mul_f32 v141, v141, v25
    v_mul_f32 v142, v142, v25
    v_mul_f32 v143, v143, v25
    v_mul_f32 v144, v144, v25
    v_mul_f32 v145, v145, v25
    v_mul_f32 v146, v146, v25
    v_mul_f32 v147, v147, v25
    v_mul_f32 v148, v148, v25
    v_mul_f32 v149, v149, v25
    v_mul_f32 v150, v150, v25
    v_mul_f32 v151, v151, v25
    v_mul_f32 v152, v152, v25
    v_mul_f32 v153, v153, v25
    v_mul_f32 v154, v154, v25
    v_mul_f32 v155, v155, v25
    v_mul_f32 v156, v156, v25
    v_mul_f32 v157, v157, v25
    v_mul_f32 v158, v158, v25
    v_mul_f32 v159, v159, v25
    v_fma_f32 v104, v104, s28, v9
    v_fma_f32 v105, v105, s28, v9
    v_exp_f32_e64 v104, v104 clamp
    v_exp_f32_e64 v105, v105 clamp
    s_nop 0
    v_cvt_pk_bf16_f32 v18, v104, v105
    v_fma_f32 v106, v106, s28, v9
    v_fma_f32 v107, v107, s28, v9
    v_exp_f32_e64 v106, v106 clamp
    v_exp_f32_e64 v107, v107 clamp
    s_nop 0
    v_cvt_pk_bf16_f32 v19, v106, v107
    v_fma_f32 v108, v108, s28, v9
    v_fma_f32 v109, v109, s28, v9
    v_exp_f32_e64 v108, v108 clamp
    v_exp_f32_e64 v109, v109 clamp
    s_nop 0
    v_cvt_pk_bf16_f32 v16, v108, v109
    v_fma_f32 v110, v110, s28, v9
    v_fma_f32 v111, v111, s28, v9
    v_exp_f32_e64 v110, v110 clamp
    v_exp_f32_e64 v111, v111 clamp
    s_nop 0
    v_cvt_pk_bf16_f32 v17, v110, v111
    s_add_u32 s69, s39, 0
    buffer_load_dwordx4 v[92:95], v26, s[4:7], s69 offen offset:0
    s_waitcnt vmcnt(0)
    v_mfma_f32_16x16x32_bf16 v[104:107], v[92:95], a[120:123], 0
    s_nop 7
    buffer_load_dwordx4 v[92:95], v26, s[4:7], s69 offen offset:64
    s_waitcnt vmcnt(0)
    v_mfma_f32_16x16x32_bf16 v[104:107], v[92:95], a[124:127], v[104:107]
    s_nop 7
    buffer_load_dwordx4 v[92:95], v26, s[4:7], s69 offen offset:128
    s_waitcnt vmcnt(0)
    v_mfma_f32_16x16x32_bf16 v[104:107], v[92:95], a[128:131], v[104:107]
    s_nop 7
    buffer_load_dwordx4 v[92:95], v26, s[4:7], s69 offen offset:192
    s_waitcnt vmcnt(0)
    v_mfma_f32_16x16x32_bf16 v[104:107], v[92:95], a[132:135], v[104:107]
    s_nop 7
    buffer_load_dwordx4 v[92:95], v26, s[4:7], s69 offen offset:256
    s_waitcnt vmcnt(0)
    v_mfma_f32_16x16x32_bf16 v[104:107], v[92:95], a[136:139], v[104:107]
    s_nop 7
    buffer_load_dwordx4 v[92:95], v26, s[4:7], s69 offen offset:320
    s_waitcnt vmcnt(0)
    v_mfma_f32_16x16x32_bf16 v[104:107], v[92:95], a[140:143], v[104:107]
    s_nop 7
    s_add_u32 s69, s39, 6144
    buffer_load_dwordx4 v[92:95], v26, s[4:7], s69 offen offset:0
    s_waitcnt vmcnt(0)
    v_mfma_f32_16x16x32_bf16 v[108:111], v[92:95], a[120:123], 0
    s_nop 7
    buffer_load_dwordx4 v[92:95], v26, s[4:7], s69 offen offset:64
    s_waitcnt vmcnt(0)
    v_mfma_f32_16x16x32_bf16 v[108:111], v[92:95], a[124:127], v[108:111]
    s_nop 7
    buffer_load_dwordx4 v[92:95], v26, s[4:7], s69 offen offset:128
    s_waitcnt vmcnt(0)
    v_mfma_f32_16x16x32_bf16 v[108:111], v[92:95], a[128:131], v[108:111]
    s_nop 7
    buffer_load_dwordx4 v[92:95], v26, s[4:7], s69 offen offset:192
    s_waitcnt vmcnt(0)
    v_mfma_f32_16x16x32_bf16 v[108:111], v[92:95], a[132:135], v[108:111]
    s_nop 7
    buffer_load_dwordx4 v[92:95], v26, s[4:7], s69 offen offset:256
    s_waitcnt vmcnt(0)
    v_mfma_f32_16x16x32_bf16 v[108:111], v[92:95], a[136:139], v[108:111]
    s_nop 7
    buffer_load_dwordx4 v[92:95], v26, s[4:7], s69 offen offset:320
    s_waitcnt vmcnt(0)
    v_mfma_f32_16x16x32_bf16 v[108:111], v[92:95], a[140:143], v[108:111]
    s_nop 7
    s_nop 15
    v_max3_f32 v14, v104, v105, v106
    v_max3_f32 v14, v14, v107, v108
    v_max3_f32 v14, v14, v109, v110
    v_max_f32 v14, v14, v111
    v_mov_b32 v15, v14
    s_nop 1
    v_permlane32_swap_b32 v15, v14
    v_max_f32 v14, v14, v15
    v_mov_b32 v15, v14
    s_nop 1
    v_permlane16_swap_b32 v15, v14
    v_max_f32 v14, v14, v15
    v_fma_f32 v14, v14, s28, v10
    v_add_f32 v14, 0x42000000, v14
    v_max_f32 v24, 0, v14
    v_sub_f32 v10, v10, v24
    v_sub_f32 v25, 0, v24
    v_exp_f32 v25, v25
    s_nop 0
    v_mul_f32 v15, v45, v25
    v_cndmask_b32_e64 v45, v15, v45, s[46:47]
    v_mul_f32 v15, v49, v25
    v_cndmask_b32_e64 v49, v49, v15, s[46:47]
    v_mul_f32 v160, v160, v25
    v_mul_f32 v161, v161, v25
    v_mul_f32 v162, v162, v25
    v_mul_f32 v163, v163, v25
    v_mul_f32 v164, v164, v25
    v_mul_f32 v165, v165, v25
    v_mul_f32 v166, v166, v25
    v_mul_f32 v167, v167, v25
    v_mul_f32 v168, v168, v25
    v_mul_f32 v169, v169, v25
    v_mul_f32 v170, v170, v25
    v_mul_f32 v171, v171, v25
    v_mul_f32 v172, v172, v25
    v_mul_f32 v173, v173, v25
    v_mul_f32 v174, v174, v25
    v_mul_f32 v175, v175, v25
    v_mul_f32 v176, v176, v25
    v_mul_f32 v177, v177, v25
    v_mul_f32 v178, v178, v25
    v_mul_f32 v179, v179, v25
    v_mul_f32 v180, v180, v25
    v_mul_f32 v181, v181, v25
    v_mul_f32 v182, v182, v25
    v_mul_f32 v183, v183, v25
    v_mul_f32 v184, v184, v25
    v_mul_f32 v185, v185, v25
    v_mul_f32 v186, v186, v25
    v_mul_f32 v187, v187, v25
    v_mul_f32 v188, v188, v25
    v_mul_f32 v189, v189, v25
    v_mul_f32 v190, v190, v25
    v_mul_f32 v191, v191, v25
    v_mul_f32 v192, v192, v25
    v_mul_f32 v193, v193, v25
    v_mul_f32 v194, v194, v25
    v_mul_f32 v195, v195, v25
    v_mul_f32 v196, v196, v25
    v_mul_f32 v197, v197, v25
    v_mul_f32 v198, v198, v25
    v_mul_f32 v199, v199, v25
    v_mul_f32 v200, v200, v25
    v_mul_f32 v201, v201, v25
    v_mul_f32 v202, v202, v25
    v_mul_f32 v203, v203, v25
    v_mul_f32 v204, v204, v25
    v_mul_f32 v205, v205, v25
    v_mul_f32 v206, v206, v25
    v_mul_f32 v207, v207, v25
    v_fma_f32 v104, v104, s28, v10
    v_fma_f32 v105, v105, s28, v10
    v_exp_f32_e64 v104, v104 clamp
    v_exp_f32_e64 v105, v105 clamp
    s_nop 0
    v_cvt_pk_bf16_f32 v22, v104, v105
    v_fma_f32 v106, v106, s28, v10
    v_fma_f32 v107, v107, s28, v10
    v_exp_f32_e64 v106, v106 clamp
    v_exp_f32_e64 v107, v107 clamp
    s_nop 0
    v_cvt_pk_bf16_f32 v23, v106, v107
    v_fma_f32 v108, v108, s28, v10
    v_fma_f32 v109, v109, s28, v10
    v_exp_f32_e64 v108, v108 clamp
    v_exp_f32_e64 v109, v109 clamp
    s_nop 0
    v_cvt_pk_bf16_f32 v20, v108, v109
    v_fma_f32 v110, v110, s28, v10
    v_fma_f32 v111, v111, s28, v10
    v_exp_f32_e64 v110, v110 clamp
    v_exp_f32_e64 v111, v111 clamp
    s_nop 0
    v_cvt_pk_bf16_f32 v21, v110, v111
    s_add_u32 s69, s39, 0
    buffer_load_dwordx4 v[92:95], v26, s[4:7], s69 offen offset:0
    s_waitcnt vmcnt(0)
    v_mfma_f32_16x16x32_bf16 v[104:107], v[92:95], a[144:147], 0
    s_nop 7
    buffer_load_dwordx4 v[92:95], v26, s[4:7], s69 offen offset:64
    s_waitcnt vmcnt(0)
    v_mfma_f32_16x16x32_bf16 v[104:107], v[92:95], a[148:151], v[104:107]
    s_nop 7
    buffer_load_dwordx4 v[92:95], v26, s[4:7], s69 offen offset:128
    s_waitcnt vmcnt(0)
    v_mfma_f32_16x16x32_bf16 v[104:107], v[92:95], a[152:155], v[104:107]
    s_nop 7
    buffer_load_dwordx4 v[92:95], v26, s[4:7], s69 offen offset:192
    s_waitcnt vmcnt(0)
    v_mfma_f32_16x16x32_bf16 v[104:107], v[92:95], a[156:159], v[104:107]
    s_nop 7
    buffer_load_dwordx4 v[92:95], v26, s[4:7], s69 offen offset:256
    s_waitcnt vmcnt(0)
    v_mfma_f32_16x16x32_bf16 v[104:107], v[92:95], a[160:163], v[104:107]
    s_nop 7
    buffer_load_dwordx4 v[92:95], v26, s[4:7], s69 offen offset:320
    s_waitcnt vmcnt(0)
    v_mfma_f32_16x16x32_bf16 v[104:107], v[92:95], a[164:167], v[104:107]
    s_nop 7
    s_add_u32 s69, s39, 6144
    buffer_load_dwordx4 v[92:95], v26, s[4:7], s69 offen offset:0
    s_waitcnt vmcnt(0)
    v_mfma_f32_16x16x32_bf16 v[108:111], v[92:95], a[144:147], 0
    s_nop 7
    buffer_load_dwordx4 v[92:95], v26, s[4:7], s69 offen offset:64
    s_waitcnt vmcnt(0)
    v_mfma_f32_16x16x32_bf16 v[108:111], v[92:95], a[148:151], v[108:111]
    s_nop 7
    buffer_load_dwordx4 v[92:95], v26, s[4:7], s69 offen offset:128
    s_waitcnt vmcnt(0)
    v_mfma_f32_16x16x32_bf16 v[108:111], v[92:95], a[152:155], v[108:111]
    s_nop 7
    buffer_load_dwordx4 v[92:95], v26, s[4:7], s69 offen offset:192
    s_waitcnt vmcnt(0)
    v_mfma_f32_16x16x32_bf16 v[108:111], v[92:95], a[156:159], v[108:111]
    s_nop 7
    buffer_load_dwordx4 v[92:95], v26, s[4:7], s69 offen offset:256
    s_waitcnt vmcnt(0)
    v_mfma_f32_16x16x32_bf16 v[108:111], v[92:95], a[160:163], v[108:111]
    s_nop 7
    buffer_load_dwordx4 v[92:95], v26, s[4:7], s69 offen offset:320
    s_waitcnt vmcnt(0)
    v_mfma_f32_16x16x32_bf16 v[108:111], v[92:95], a[164:167], v[108:111]
    s_nop 7
    s_nop 15
    v_max3_f32 v14, v104, v105, v106
    v_max3_f32 v14, v14, v107, v108
    v_max3_f32 v14, v14, v109, v110
    v_max_f32 v14, v14, v111
    v_mov_b32 v15, v14
    s_nop 1
    v_permlane32_swap_b32 v15, v14
    v_max_f32 v14, v14, v15
    v_mov_b32 v15, v14
    s_nop 1
    v_permlane16_swap_b32 v15, v14
    v_max_f32 v14, v14, v15
    v_fma_f32 v14, v14, s28, v11
    v_add_f32 v14, 0x42000000, v14
    v_max_f32 v24, 0, v14
    v_sub_f32 v11, v11, v24
    v_sub_f32 v25, 0, v24
    v_exp_f32 v25, v25
    s_nop 0
    v_mul_f32 v15, v45, v25
    v_cndmask_b32_e64 v45, v45, v15, s[46:47]
    v_mul_f32 v15, v50, v25
    v_cndmask_b32_e64 v50, v15, v50, s[46:47]
    v_mul_f32 v208, v208, v25
    v_mul_f32 v209, v209, v25
    v_mul_f32 v210, v210, v25
    v_mul_f32 v211, v211, v25
    v_mul_f32 v212, v212, v25
    v_mul_f32 v213, v213, v25
    v_mul_f32 v214, v214, v25
    v_mul_f32 v215, v215, v25
    v_mul_f32 v216, v216, v25
    v_mul_f32 v217, v217, v25
    v_mul_f32 v218, v218, v25
    v_mul_f32 v219, v219, v25
    v_mul_f32 v220, v220, v25
    v_mul_f32 v221, v221, v25
    v_mul_f32 v222, v222, v25
    v_mul_f32 v223, v223, v25
    v_mul_f32 v224, v224, v25
    v_mul_f32 v225, v225, v25
    v_mul_f32 v226, v226, v25
    v_mul_f32 v227, v227, v25
    v_mul_f32 v228, v228, v25
    v_mul_f32 v229, v229, v25
    v_mul_f32 v230, v230, v25
    v_mul_f32 v231, v231, v25
    v_mul_f32 v232, v232, v25
    v_mul_f32 v233, v233, v25
    v_mul_f32 v234, v234, v25
    v_mul_f32 v235, v235, v25
    v_mul_f32 v236, v236, v25
    v_mul_f32 v237, v237, v25
    v_mul_f32 v238, v238, v25
    v_mul_f32 v239, v239, v25
    v_mul_f32 v240, v240, v25
    v_mul_f32 v241, v241, v25
    v_mul_f32 v242, v242, v25
    v_mul_f32 v243, v243, v25
    v_mul_f32 v244, v244, v25
    v_mul_f32 v245, v245, v25
    v_mul_f32 v246, v246, v25
    v_mul_f32 v247, v247, v25
    v_mul_f32 v248, v248, v25
    v_mul_f32 v249, v249, v25
    v_mul_f32 v250, v250, v25
    v_mul_f32 v251, v251, v25
    v_mul_f32 v252, v252, v25
    v_mul_f32 v253, v253, v25
    v_mul_f32 v254, v254, v25
    v_mul_f32 v255, v255, v25
    v_fma_f32 v104, v104, s28, v11
    v_fma_f32 v105, v105, s28, v11
    v_exp_f32_e64 v104, v104 clamp
    v_exp_f32_e64 v105, v105 clamp
    s_nop 0
    v_cvt_pk_bf16_f32 v30, v104, v105
    v_fma_f32 v106, v106, s28, v11
    v_fma_f32 v107, v107, s28, v11
    v_exp_f32_e64 v106, v106 clamp
    v_exp_f32_e64 v107, v107 clamp
    s_nop 0
    v_cvt_pk_bf16_f32 v31, v106, v107
    v_fma_f32 v108, v108, s28, v11
    v_fma_f32 v109, v109, s28, v11
    v_exp_f32_e64 v108, v108 clamp
    v_exp_f32_e64 v109, v109 clamp
    s_nop 0
    v_cvt_pk_bf16_f32 v28, v108, v109
    v_fma_f32 v110, v110, s28, v11
    v_fma_f32 v111, v111, s28, v11
    v_exp_f32_e64 v110, v110 clamp
    v_exp_f32_e64 v111, v111 clamp
    s_nop 0
    v_cvt_pk_bf16_f32 v29, v110, v111
    s_add_u32 s69, s39, 0
    buffer_load_dwordx4 v[92:95], v26, s[4:7], s69 offen offset:0
    s_waitcnt vmcnt(0)
    v_mfma_f32_16x16x32_bf16 v[104:107], v[92:95], a[168:171], 0
    s_nop 7
    buffer_load_dwordx4 v[92:95], v26, s[4:7], s69 offen offset:64
    s_waitcnt vmcnt(0)
    v_mfma_f32_16x16x32_bf16 v[104:107], v[92:95], a[172:175], v[104:107]
    s_nop 7
    buffer_load_dwordx4 v[92:95], v26, s[4:7], s69 offen offset:128
    s_waitcnt vmcnt(0)
    v_mfma_f32_16x16x32_bf16 v[104:107], v[92:95], a[176:179], v[104:107]
    s_nop 7
    buffer_load_dwordx4 v[92:95], v26, s[4:7], s69 offen offset:192
    s_waitcnt vmcnt(0)
    v_mfma_f32_16x16x32_bf16 v[104:107], v[92:95], a[180:183], v[104:107]
    s_nop 7
    buffer_load_dwordx4 v[92:95], v26, s[4:7], s69 offen offset:256
    s_waitcnt vmcnt(0)
    v_mfma_f32_16x16x32_bf16 v[104:107], v[92:95], a[184:187], v[104:107]
    s_nop 7
    buffer_load_dwordx4 v[92:95], v26, s[4:7], s69 offen offset:320
    s_waitcnt vmcnt(0)
    v_mfma_f32_16x16x32_bf16 v[104:107], v[92:95], a[188:191], v[104:107]
    s_nop 7
    s_add_u32 s69, s39, 6144
    buffer_load_dwordx4 v[92:95], v26, s[4:7], s69 offen offset:0
    s_waitcnt vmcnt(0)
    v_mfma_f32_16x16x32_bf16 v[108:111], v[92:95], a[168:171], 0
    s_nop 7
    buffer_load_dwordx4 v[92:95], v26, s[4:7], s69 offen offset:64
    s_waitcnt vmcnt(0)
    v_mfma_f32_16x16x32_bf16 v[108:111], v[92:95], a[172:175], v[108:111]
    s_nop 7
    buffer_load_dwordx4 v[92:95], v26, s[4:7], s69 offen offset:128
    s_waitcnt vmcnt(0)
    v_mfma_f32_16x16x32_bf16 v[108:111], v[92:95], a[176:179], v[108:111]
    s_nop 7
    buffer_load_dwordx4 v[92:95], v26, s[4:7], s69 offen offset:192
    s_waitcnt vmcnt(0)
    v_mfma_f32_16x16x32_bf16 v[108:111], v[92:95], a[180:183], v[108:111]
    s_nop 7
    buffer_load_dwordx4 v[92:95], v26, s[4:7], s69 offen offset:256
    s_waitcnt vmcnt(0)
    v_mfma_f32_16x16x32_bf16 v[108:111], v[92:95], a[184:187], v[108:111]
    s_nop 7
    buffer_load_dwordx4 v[92:95], v26, s[4:7], s69 offen offset:320
    s_waitcnt vmcnt(0)
    v_mfma_f32_16x16x32_bf16 v[108:111], v[92:95], a[188:191], v[108:111]
    s_nop 7
    s_nop 15
    v_max3_f32 v14, v104, v105, v106
    v_max3_f32 v14, v14, v107, v108
    v_max3_f32 v14, v14, v109, v110
    v_max_f32 v14, v14, v111
    v_mov_b32 v15, v14
    s_nop 1
    v_permlane32_swap_b32 v15, v14
    v_max_f32 v14, v14, v15
    v_mov_b32 v15, v14
    s_nop 1
    v_permlane16_swap_b32 v15, v14
    v_max_f32 v14, v14, v15
    v_fma_f32 v14, v14, s28, v12
    v_add_f32 v14, 0x42000000, v14
    v_max_f32 v24, 0, v14
    v_sub_f32 v12, v12, v24
    v_sub_f32 v25, 0, v24
    v_exp_f32 v25, v25
    s_nop 0
    v_mul_f32 v15, v46, v25
    v_cndmask_b32_e64 v46, v15, v46, s[46:47]
    v_mul_f32 v15, v50, v25
    v_cndmask_b32_e64 v50, v50, v15, s[46:47]
    v_accvgpr_read_b32 v15, a0
    v_mul_f32 v15, v15, v25
    v_accvgpr_write_b32 a0, v15
    v_accvgpr_read_b32 v15, a1
    v_mul_f32 v15, v15, v25
    v_accvgpr_write_b32 a1, v15
    v_accvgpr_read_b32 v15, a2
    v_mul_f32 v15, v15, v25
    v_accvgpr_write_b32 a2, v15
    v_accvgpr_read_b32 v15, a3
    v_mul_f32 v15, v15, v25
    v_accvgpr_write_b32 a3, v15
    v_accvgpr_read_b32 v15, a4
    v_mul_f32 v15, v15, v25
    v_accvgpr_write_b32 a4, v15
    v_accvgpr_read_b32 v15, a5
    v_mul_f32 v15, v15, v25
    v_accvgpr_write_b32 a5, v15
    v_accvgpr_read_b32 v15, a6
    v_mul_f32 v15, v15, v25
    v_accvgpr_write_b32 a6, v15
    v_accvgpr_read_b32 v15, a7
    v_mul_f32 v15, v15, v25
    v_accvgpr_write_b32 a7, v15
    v_accvgpr_read_b32 v15, a8
    v_mul_f32 v15, v15, v25
    v_accvgpr_write_b32 a8, v15
    v_accvgpr_read_b32 v15, a9
    v_mul_f32 v15, v15, v25
    v_accvgpr_write_b32 a9, v15
    v_accvgpr_read_b32 v15, a10
    v_mul_f32 v15, v15, v25
    v_accvgpr_write_b32 a10, v15
    v_accvgpr_read_b32 v15, a11
    v_mul_f32 v15, v15, v25
    v_accvgpr_write_b32 a11, v15
    v_accvgpr_read_b32 v15, a12
    v_mul_f32 v15, v15, v25
    v_accvgpr_write_b32 a12, v15
    v_accvgpr_read_b32 v15, a13
    v_mul_f32 v15, v15, v25
    v_accvgpr_write_b32 a13, v15
    v_accvgpr_read_b32 v15, a14
    v_mul_f32 v15, v15, v25
    v_accvgpr_write_b32 a14, v15
    v_accvgpr_read_b32 v15, a15
    v_mul_f32 v15, v15, v25
    v_accvgpr_write_b32 a15, v15
    v_accvgpr_read_b32 v15, a16
    v_mul_f32 v15, v15, v25
    v_accvgpr_write_b32 a16, v15
    v_accvgpr_read_b32 v15, a17
    v_mul_f32 v15, v15, v25
    v_accvgpr_write_b32 a17, v15
    v_accvgpr_read_b32 v15, a18
    v_mul_f32 v15, v15, v25
    v_accvgpr_write_b32 a18, v15
    v_accvgpr_read_b32 v15, a19
    v_mul_f32 v15, v15, v25
    v_accvgpr_write_b32 a19, v15
    v_accvgpr_read_b32 v15, a20
    v_mul_f32 v15, v15, v25
    v_accvgpr_write_b32 a20, v15
    v_accvgpr_read_b32 v15, a21
    v_mul_f32 v15, v15, v25
    v_accvgpr_write_b32 a21, v15
    v_accvgpr_read_b32 v15, a22
    v_mul_f32 v15, v15, v25
    v_accvgpr_write_b32 a22, v15
    v_accvgpr_read_b32 v15, a23
    v_mul_f32 v15, v15, v25
    v_accvgpr_write_b32 a23, v15
    v_accvgpr_read_b32 v15, a24
    v_mul_f32 v15, v15, v25
    v_accvgpr_write_b32 a24, v15
    v_accvgpr_read_b32 v15, a25
    v_mul_f32 v15, v15, v25
    v_accvgpr_write_b32 a25, v15
    v_accvgpr_read_b32 v15, a26
    v_mul_f32 v15, v15, v25
    v_accvgpr_write_b32 a26, v15
    v_accvgpr_read_b32 v15, a27
    v_mul_f32 v15, v15, v25
    v_accvgpr_write_b32 a27, v15
    v_accvgpr_read_b32 v15, a28
    v_mul_f32 v15, v15, v25
    v_accvgpr_write_b32 a28, v15
    v_accvgpr_read_b32 v15, a29
    v_mul_f32 v15, v15, v25
    v_accvgpr_write_b32 a29, v15
    v_accvgpr_read_b32 v15, a30
    v_mul_f32 v15, v15, v25
    v_accvgpr_write_b32 a30, v15
    v_accvgpr_read_b32 v15, a31
    v_mul_f32 v15, v15, v25
    v_accvgpr_write_b32 a31, v15
    v_accvgpr_read_b32 v15, a32
    v_mul_f32 v15, v15, v25
    v_accvgpr_write_b32 a32, v15
    v_accvgpr_read_b32 v15, a33
    v_mul_f32 v15, v15, v25
    v_accvgpr_write_b32 a33, v15
    v_accvgpr_read_b32 v15, a34
    v_mul_f32 v15, v15, v25
    v_accvgpr_write_b32 a34, v15
    v_accvgpr_read_b32 v15, a35
    v_mul_f32 v15, v15, v25
    v_accvgpr_write_b32 a35, v15
    v_accvgpr_read_b32 v15, a36
    v_mul_f32 v15, v15, v25
    v_accvgpr_write_b32 a36, v15
    v_accvgpr_read_b32 v15, a37
    v_mul_f32 v15, v15, v25
    v_accvgpr_write_b32 a37, v15
    v_accvgpr_read_b32 v15, a38
    v_mul_f32 v15, v15, v25
    v_accvgpr_write_b32 a38, v15
    v_accvgpr_read_b32 v15, a39
    v_mul_f32 v15, v15, v25
    v_accvgpr_write_b32 a39, v15
    v_accvgpr_read_b32 v15, a40
    v_mul_f32 v15, v15, v25
    v_accvgpr_write_b32 a40, v15
    v_accvgpr_read_b32 v15, a41
    v_mul_f32 v15, v15, v25
    v_accvgpr_write_b32 a41, v15
    v_accvgpr_read_b32 v15, a42
    v_mul_f32 v15, v15, v25
    v_accvgpr_write_b32 a42, v15
    v_accvgpr_read_b32 v15, a43
    v_mul_f32 v15, v15, v25
    v_accvgpr_write_b32 a43, v15
    v_accvgpr_read_b32 v15, a44
    v_mul_f32 v15, v15, v25
    v_accvgpr_write_b32 a44, v15
    v_accvgpr_read_b32 v15, a45
    v_mul_f32 v15, v15, v25
    v_accvgpr_write_b32 a45, v15
    v_accvgpr_read_b32 v15, a46
    v_mul_f32 v15, v15, v25
    v_accvgpr_write_b32 a46, v15
    v_accvgpr_read_b32 v15, a47
    v_mul_f32 v15, v15, v25
    v_accvgpr_write_b32 a47, v15
    v_fma_f32 v104, v104, s28, v12
    v_fma_f32 v105, v105, s28, v12
    v_exp_f32_e64 v104, v104 clamp
    v_exp_f32_e64 v105, v105 clamp
    s_nop 0
    v_cvt_pk_bf16_f32 v34, v104, v105
    v_fma_f32 v106, v106, s28, v12
    v_fma_f32 v107, v107, s28, v12
    v_exp_f32_e64 v106, v106 clamp
    v_exp_f32_e64 v107, v107 clamp
    s_nop 0
    v_cvt_pk_bf16_f32 v35, v106, v107
    v_fma_f32 v108, v108, s28, v12
    v_fma_f32 v109, v109, s28, v12
    v_exp_f32_e64 v108, v108 clamp
    v_exp_f32_e64 v109, v109 clamp
    s_nop 0
    v_cvt_pk_bf16_f32 v32, v108, v109
    v_fma_f32 v110, v110, s28, v12
    v_fma_f32 v111, v111, s28, v12
    v_exp_f32_e64 v110, v110 clamp
    v_exp_f32_e64 v111, v111 clamp
    s_nop 0
    v_cvt_pk_bf16_f32 v33, v110, v111
    v_smfmac_f32_16x16x64_bf16 v[48:51], a[240:243], v[16:23], v101
    s_nop 0
    v_smfmac_f32_16x16x64_bf16 v[48:51], a[244:247], v[28:35], v101
    s_nop 15
    s_setpc_b64 s[40:41]
L_rs_start5b:
    s_call_b64 s[40:41], L_rare5_1
    s_branch L_ret_start5b
L_rs_loop5w0a:
    s_call_b64 s[40:41], L_rare5_0
    s_branch L_ret_loop5w0a
L_rs_loop5w0b:
    s_call_b64 s[40:41], L_rare5_1
    s_branch L_ret_loop5w0b
L_rs_loop5w1a:
    s_call_b64 s[40:41], L_rare5_0
    s_branch L_ret_loop5w1a
L_rs_loop5w1b:
    s_call_b64 s[40:41], L_rare5_1
    s_branch L_ret_loop5w1b
L_rs_end5a:
    s_call_b64 s[40:41], L_rare5_0
    s_branch L_ret_end5a
L_rs_end5b:
    s_call_b64 s[40:41], L_rare5_1
    s_branch L_ret_end5b
L_rs_start4b:
    s_call_b64 s[40:41], L_rare4_1
    s_branch L_ret_start4b
L_rs_loop4w0a:
    s_call_b64 s[40:41], L_rare4_0
    s_branch L_ret_loop4w0a
L_rs_loop4w0b:
    s_call_b64 s[40:41], L_rare4_1
    s_branch L_ret_loop4w0b
L_rs_end4a:
    s_call_b64 s[40:41], L_rare4_0
    s_branch L_ret_end4a
L_rs_end4b:
    s_call_b64 s[40:41], L_rare4_1
    s_branch L_ret_end4b
L_rs_tr54a:
    s_call_b64 s[40:41], L_rare5_0
    s_branch L_ret_tr54a
L_rs_tr54b:
    s_nop 15
    s_waitcnt vmcnt(0) lgkmcnt(0)
    s_mov_b32 s68, s14
    s_mov_b32 s14, 166723584
    v_mbcnt_lo_u32_b32 v105, -1, 0
    v_mbcnt_hi_u32_b32 v105, -1, v105
    v_and_b32 v104, 15, v105
    v_mul_u32_u24 v104, 384, v104
    v_lshrrev_b32 v105, 4, v105
    v_lshl_add_u32 v104, v105, 4, v104
    s_add_u32 s69, s34, 0
    buffer_load_dwordx4 a[96:99], v104, s[12:15], s69 offen offset:0
    buffer_load_dwordx4 a[100:103], v104, s[12:15], s69 offen offset:64
    buffer_load_dwordx4 a[104:107], v104, s[12:15], s69 offen offset:128
    buffer_load_dwordx4 a[108:111], v104, s[12:15], s69 offen offset:192
    buffer_load_dwordx4 a[112:115], v104, s[12:15], s69 offen offset:256
    buffer_load_dwordx4 a[116:119], v104, s[12:15], s69 offen offset:320
    s_add_u32 s69, s34, 6144
    buffer_load_dwordx4 a[120:123], v104, s[12:15], s69 offen offset:0
    buffer_load_dwordx4 a[124:127], v104, s[12:15], s69 offen offset:64
    buffer_load_dwordx4 a[128:131], v104, s[12:15], s69 offen offset:128
    buffer_load_dwordx4 a[132:135], v104, s[12:15], s69 offen offset:192
    buffer_load_dwordx4 a[136:139], v104, s[12:15], s69 offen offset:256
    buffer_load_dwordx4 a[140:143], v104, s[12:15], s69 offen offset:320
    s_add_u32 s69, s34, 12288
    buffer_load_dwordx4 a[144:147], v104, s[12:15], s69 offen offset:0
    buffer_load_dwordx4 a[148:151], v104, s[12:15], s69 offen offset:64
    buffer_load_dwordx4 a[152:155], v104, s[12:15], s69 offen offset:128
    buffer_load_dwordx4 a[156:159], v104, s[12:15], s69 offen offset:192
    buffer_load_dwordx4 a[160:163], v104, s[12:15], s69 offen offset:256
    buffer_load_dwordx4 a[164:167], v104, s[12:15], s69 offen offset:320
    s_add_u32 s69, s34, 18432
    buffer_load_dwordx4 a[168:171], v104, s[12:15], s69 offen offset:0
    buffer_load_dwordx4 a[172:175], v104, s[12:15], s69 offen offset:64
    buffer_load_dwordx4 a[176:179], v104, s[12:15], s69 offen offset:128
    buffer_load_dwordx4 a[180:183], v104, s[12:15], s69 offen offset:192
    buffer_load_dwordx4 a[184:187], v104, s[12:15], s69 offen offset:256
    buffer_load_dwordx4 a[188:191], v104, s[12:15], s69 offen offset:320
    s_add_u32 s69, s34, 24576
    buffer_load_dwordx4 a[192:195], v104, s[12:15], s69 offen offset:0
    buffer_load_dwordx4 a[196:199], v104, s[12:15], s69 offen offset:64
    buffer_load_dwordx4 a[200:203], v104, s[12:15], s69 offen offset:128
    buffer_load_dwordx4 a[204:207], v104, s[12:15], s69 offen offset:192
    buffer_load_dwordx4 a[208:211], v104, s[12:15], s69 offen offset:256
    buffer_load_dwordx4 a[212:215], v104, s[12:15], s69 offen offset:320
    s_waitcnt vmcnt(0)
    s_call_b64 s[40:41], L_rare5_1
    v_mbcnt_lo_u32_b32 v105, -1, 0
    v_mbcnt_hi_u32_b32 v105, -1, v105
    v_and_b32 v104, 15, v105
    v_mul_u32_u24 v104, 384, v104
    v_lshrrev_b32 v105, 4, v105
    v_lshl_add_u32 v104, v105, 4, v104
    s_add_u32 s69, s33, 0
    buffer_load_dwordx4 a[96:99], v104, s[12:15], s69 offen offset:0
    buffer_load_dwordx4 a[100:103], v104, s[12:15], s69 offen offset:64
    buffer_load_dwordx4 a[104:107], v104, s[12:15], s69 offen offset:128
    buffer_load_dwordx4 a[108:111], v104, s[12:15], s69 offen offset:192
    buffer_load_dwordx4 a[112:115], v104, s[12:15], s69 offen offset:256
    buffer_load_dwordx4 a[116:119], v104, s[12:15], s69 offen offset:320
    s_add_u32 s69, s33, 6144
    buffer_load_dwordx4 a[120:123], v104, s[12:15], s69 offen offset:0
    buffer_load_dwordx4 a[124:127], v104, s[12:15], s69 offen offset:64
    buffer_load_dwordx4 a[128:131], v104, s[12:15], s69 offen offset:128
    buffer_load_dwordx4 a[132:135], v104, s[12:15], s69 offen offset:192
    buffer_load_dwordx4 a[136:139], v104, s[12:15], s69 offen offset:256
    buffer_load_dwordx4 a[140:143], v104, s[12:15], s69 offen offset:320
    s_add_u32 s69, s33, 12288
    buffer_load_dwordx4 a[144:147], v104, s[12:15], s69 offen offset:0
    buffer_load_dwordx4 a[148:151], v104, s[12:15], s69 offen offset:64
    buffer_load_dwordx4 a[152:155], v104, s[12:15], s69 offen offset:128
    buffer_load_dwordx4 a[156:159], v104, s[12:15], s69 offen offset:192
    buffer_load_dwordx4 a[160:163], v104, s[12:15], s69 offen offset:256
    buffer_load_dwordx4 a[164:167], v104, s[12:15], s69 offen offset:320
    s_add_u32 s69, s33, 18432
    buffer_load_dwordx4 a[168:171], v104, s[12:15], s69 offen offset:0
    buffer_load_dwordx4 a[172:175], v104, s[12:15], s69 offen offset:64
    buffer_load_dwordx4 a[176:179], v104, s[12:15], s69 offen offset:128
    buffer_load_dwordx4 a[180:183], v104, s[12:15], s69 offen offset:192
    buffer_load_dwordx4 a[184:187], v104, s[12:15], s69 offen offset:256
    buffer_load_dwordx4 a[188:191], v104, s[12:15], s69 offen offset:320
    s_waitcnt vmcnt(0)
    s_mov_b32 s14, s68
    s_branch L_ret_tr54b
L_rs_tr54d:
    s_call_b64 s[40:41], L_rare4_1
    s_branch L_ret_tr54d
L_rs_tr45a:
    s_call_b64 s[40:41], L_rare4_0
    s_branch L_ret_tr45a
L_rs_tr45b:
    s_nop 15
    s_waitcnt vmcnt(0) lgkmcnt(0)
    s_mov_b32 s68, s14
    s_mov_b32 s14, 166723584
    v_mbcnt_lo_u32_b32 v105, -1, 0
    v_mbcnt_hi_u32_b32 v105, -1, v105
    v_and_b32 v104, 15, v105
    v_mul_u32_u24 v104, 384, v104
    v_lshrrev_b32 v105, 4, v105
    v_lshl_add_u32 v104, v105, 4, v104
    s_add_u32 s69, s34, 0
    buffer_load_dwordx4 a[96:99], v104, s[12:15], s69 offen offset:0
    buffer_load_dwordx4 a[100:103], v104, s[12:15], s69 offen offset:64
    buffer_load_dwordx4 a[104:107], v104, s[12:15], s69 offen offset:128
    buffer_load_dwordx4 a[108:111], v104, s[12:15], s69 offen offset:192
    buffer_load_dwordx4 a[112:115], v104, s[12:15], s69 offen offset:256
    buffer_load_dwordx4 a[116:119], v104, s[12:15], s69 offen offset:320
    s_add_u32 s69, s34, 6144
    buffer_load_dwordx4 a[120:123], v104, s[12:15], s69 offen offset:0
    buffer_load_dwordx4 a[124:127], v104, s[12:15], s69 offen offset:64
    buffer_load_dwordx4 a[128:131], v104, s[12:15], s69 offen offset:128
    buffer_load_dwordx4 a[132:135], v104, s[12:15], s69 offen offset:192
    buffer_load_dwordx4 a[136:139], v104, s[12:15], s69 offen offset:256
    buffer_load_dwordx4 a[140:143], v104, s[12:15], s69 offen offset:320
    s_add_u32 s69, s34, 12288
    buffer_load_dwordx4 a[144:147], v104, s[12:15], s69 offen offset:0
    buffer_load_dwordx4 a[148:151], v104, s[12:15], s69 offen offset:64
    buffer_load_dwordx4 a[152:155], v104, s[12:15], s69 offen offset:128
    buffer_load_dwordx4 a[156:159], v104, s[12:15], s69 offen offset:192
    buffer_load_dwordx4 a[160:163], v104, s[12:15], s69 offen offset:256
    buffer_load_dwordx4 a[164:167], v104, s[12:15], s69 offen offset:320
    s_add_u32 s69, s34, 18432
    buffer_load_dwordx4 a[168:171], v104, s[12:15], s69 offen offset:0
    buffer_load_dwordx4 a[172:175], v104, s[12:15], s69 offen offset:64
    buffer_load_dwordx4 a[176:179], v104, s[12:15], s69 offen offset:128
    buffer_load_dwordx4 a[180:183], v104, s[12:15], s69 offen offset:192
    buffer_load_dwordx4 a[184:187], v104, s[12:15], s69 offen offset:256
    buffer_load_dwordx4 a[188:191], v104, s[12:15], s69 offen offset:320
    s_waitcnt vmcnt(0)
    s_call_b64 s[40:41], L_rare4_1
    v_mbcnt_lo_u32_b32 v105, -1, 0
    v_mbcnt_hi_u32_b32 v105, -1, v105
    v_and_b32 v104, 15, v105
    v_mul_u32_u24 v104, 384, v104
    v_lshrrev_b32 v105, 4, v105
    v_lshl_add_u32 v104, v105, 4, v104
    s_add_u32 s69, s33, 0
    buffer_load_dwordx4 a[96:99], v104, s[12:15], s69 offen offset:0
    buffer_load_dwordx4 a[100:103], v104, s[12:15], s69 offen offset:64
    buffer_load_dwordx4 a[104:107], v104, s[12:15], s69 offen offset:128
    buffer_load_dwordx4 a[108:111], v104, s[12:15], s69 offen offset:192
    buffer_load_dwordx4 a[112:115], v104, s[12:15], s69 offen offset:256
    buffer_load_dwordx4 a[116:119], v104, s[12:15], s69 offen offset:320
    s_add_u32 s69, s33, 6144
    buffer_load_dwordx4 a[120:123], v104, s[12:15], s69 offen offset:0
    buffer_load_dwordx4 a[124:127], v104, s[12:15], s69 offen offset:64
    buffer_load_dwordx4 a[128:131], v104, s[12:15], s69 offen offset:128
    buffer_load_dwordx4 a[132:135], v104, s[12:15], s69 offen offset:192
    buffer_load_dwordx4 a[136:139], v104, s[12:15], s69 offen offset:256
    buffer_load_dwordx4 a[140:143], v104, s[12:15], s69 offen offset:320
    s_add_u32 s69, s33, 12288
    buffer_load_dwordx4 a[144:147], v104, s[12:15], s69 offen offset:0
    buffer_load_dwordx4 a[148:151], v104, s[12:15], s69 offen offset:64
    buffer_load_dwordx4 a[152:155], v104, s[12:15], s69 offen offset:128
    buffer_load_dwordx4 a[156:159], v104, s[12:15], s69 offen offset:192
    buffer_load_dwordx4 a[160:163], v104, s[12:15], s69 offen offset:256
    buffer_load_dwordx4 a[164:167], v104, s[12:15], s69 offen offset:320
    s_add_u32 s69, s33, 18432
    buffer_load_dwordx4 a[168:171], v104, s[12:15], s69 offen offset:0
    buffer_load_dwordx4 a[172:175], v104, s[12:15], s69 offen offset:64
    buffer_load_dwordx4 a[176:179], v104, s[12:15], s69 offen offset:128
    buffer_load_dwordx4 a[180:183], v104, s[12:15], s69 offen offset:192
    buffer_load_dwordx4 a[184:187], v104, s[12:15], s69 offen offset:256
    buffer_load_dwordx4 a[188:191], v104, s[12:15], s69 offen offset:320
    s_add_u32 s69, s33, 24576
    buffer_load_dwordx4 a[192:195], v104, s[12:15], s69 offen offset:0
    buffer_load_dwordx4 a[196:199], v104, s[12:15], s69 offen offset:64
    buffer_load_dwordx4 a[200:203], v104, s[12:15], s69 offen offset:128
    buffer_load_dwordx4 a[204:207], v104, s[12:15], s69 offen offset:192
    buffer_load_dwordx4 a[208:211], v104, s[12:15], s69 offen offset:256
    buffer_load_dwordx4 a[212:215], v104, s[12:15], s69 offen offset:320
    s_waitcnt vmcnt(0)
    s_mov_b32 s14, s68
    s_branch L_ret_tr45b
L_rs_tr45d:
    s_call_b64 s[40:41], L_rare5_1
    s_branch L_ret_tr45d
L_rs_tr44a:
    s_call_b64 s[40:41], L_rare4_0
    s_branch L_ret_tr44a
L_rs_tr44b:
    s_nop 15
    s_waitcnt vmcnt(0) lgkmcnt(0)
    s_mov_b32 s68, s14
    s_mov_b32 s14, 166723584
    v_mbcnt_lo_u32_b32 v105, -1, 0
    v_mbcnt_hi_u32_b32 v105, -1, v105
    v_and_b32 v104, 15, v105
    v_mul_u32_u24 v104, 384, v104
    v_lshrrev_b32 v105, 4, v105
    v_lshl_add_u32 v104, v105, 4, v104
    s_add_u32 s69, s34, 0
    buffer_load_dwordx4 a[96:99], v104, s[12:15], s69 offen offset:0
    buffer_load_dwordx4 a[100:103], v104, s[12:15], s69 offen offset:64
    buffer_load_dwordx4 a[104:107], v104, s[12:15], s69 offen offset:128
    buffer_load_dwordx4 a[108:111], v104, s[12:15], s69 offen offset:192
    buffer_load_dwordx4 a[112:115], v104, s[12:15], s69 offen offset:256
    buffer_load_dwordx4 a[116:119], v104, s[12:15], s69 offen offset:320
    s_add_u32 s69, s34, 6144
    buffer_load_dwordx4 a[120:123], v104, s[12:15], s69 offen offset:0
    buffer_load_dwordx4 a[124:127], v104, s[12:15], s69 offen offset:64
    buffer_load_dwordx4 a[128:131], v104, s[12:15], s69 offen offset:128
    buffer_load_dwordx4 a[132:135], v104, s[12:15], s69 offen offset:192
    buffer_load_dwordx4 a[136:139], v104, s[12:15], s69 offen offset:256
    buffer_load_dwordx4 a[140:143], v104, s[12:15], s69 offen offset:320
    s_add_u32 s69, s34, 12288
    buffer_load_dwordx4 a[144:147], v104, s[12:15], s69 offen offset:0
    buffer_load_dwordx4 a[148:151], v104, s[12:15], s69 offen offset:64
    buffer_load_dwordx4 a[152:155], v104, s[12:15], s69 offen offset:128
    buffer_load_dwordx4 a[156:159], v104, s[12:15], s69 offen offset:192
    buffer_load_dwordx4 a[160:163], v104, s[12:15], s69 offen offset:256
    buffer_load_dwordx4 a[164:167], v104, s[12:15], s69 offen offset:320
    s_add_u32 s69, s34, 18432
    buffer_load_dwordx4 a[168:171], v104, s[12:15], s69 offen offset:0
    buffer_load_dwordx4 a[172:175], v104, s[12:15], s69 offen offset:64
    buffer_load_dwordx4 a[176:179], v104, s[12:15], s69 offen offset:128
    buffer_load_dwordx4 a[180:183], v104, s[12:15], s69 offen offset:192
    buffer_load_dwordx4 a[184:187], v104, s[12:15], s69 offen offset:256
    buffer_load_dwordx4 a[188:191], v104, s[12:15], s69 offen offset:320
    s_waitcnt vmcnt(0)
    s_call_b64 s[40:41], L_rare4_1
    v_mbcnt_lo_u32_b32 v105, -1, 0
    v_mbcnt_hi_u32_b32 v105, -1, v105
    v_and_b32 v104, 15, v105
    v_mul_u32_u24 v104, 384, v104
    v_lshrrev_b32 v105, 4, v105
    v_lshl_add_u32 v104, v105, 4, v104
    s_add_u32 s69, s33, 0
    buffer_load_dwordx4 a[96:99], v104, s[12:15], s69 offen offset:0
    buffer_load_dwordx4 a[100:103], v104, s[12:15], s69 offen offset:64
    buffer_load_dwordx4 a[104:107], v104, s[12:15], s69 offen offset:128
    buffer_load_dwordx4 a[108:111], v104, s[12:15], s69 offen offset:192
    buffer_load_dwordx4 a[112:115], v104, s[12:15], s69 offen offset:256
    buffer_load_dwordx4 a[116:119], v104, s[12:15], s69 offen offset:320
    s_add_u32 s69, s33, 6144
    buffer_load_dwordx4 a[120:123], v104, s[12:15], s69 offen offset:0
    buffer_load_dwordx4 a[124:127], v104, s[12:15], s69 offen offset:64
    buffer_load_dwordx4 a[128:131], v104, s[12:15], s69 offen offset:128
    buffer_load_dwordx4 a[132:135], v104, s[12:15], s69 offen offset:192
    buffer_load_dwordx4 a[136:139], v104, s[12:15], s69 offen offset:256
    buffer_load_dwordx4 a[140:143], v104, s[12:15], s69 offen offset:320
    s_add_u32 s69, s33, 12288
    buffer_load_dwordx4 a[144:147], v104, s[12:15], s69 offen offset:0
    buffer_load_dwordx4 a[148:151], v104, s[12:15], s69 offen offset:64
    buffer_load_dwordx4 a[152:155], v104, s[12:15], s69 offen offset:128
    buffer_load_dwordx4 a[156:159], v104, s[12:15], s69 offen offset:192
    buffer_load_dwordx4 a[160:163], v104, s[12:15], s69 offen offset:256
    buffer_load_dwordx4 a[164:167], v104, s[12:15], s69 offen offset:320
    s_add_u32 s69, s33, 18432
    buffer_load_dwordx4 a[168:171], v104, s[12:15], s69 offen offset:0
    buffer_load_dwordx4 a[172:175], v104, s[12:15], s69 offen offset:64
    buffer_load_dwordx4 a[176:179], v104, s[12:15], s69 offen offset:128
    buffer_load_dwordx4 a[180:183], v104, s[12:15], s69 offen offset:192
    buffer_load_dwordx4 a[184:187], v104, s[12:15], s69 offen offset:256
    buffer_load_dwordx4 a[188:191], v104, s[12:15], s69 offen offset:320
    s_waitcnt vmcnt(0)
    s_mov_b32 s14, s68
    s_branch L_ret_tr44b
L_rs_tr44d:
    s_call_b64 s[40:41], L_rare4_1
    s_branch L_ret_tr44d
L_rs_tr55a:
    s_call_b64 s[40:41], L_rare5_0
    s_branch L_ret_tr55a
L_rs_tr55b:
    s_nop 15
    s_waitcnt vmcnt(0) lgkmcnt(0)
    s_mov_b32 s68, s14
    s_mov_b32 s14, 166723584
    v_mbcnt_lo_u32_b32 v105, -1, 0
    v_mbcnt_hi_u32_b32 v105, -1, v105
    v_and_b32 v104, 15, v105
    v_mul_u32_u24 v104, 384, v104
    v_lshrrev_b32 v105, 4, v105
    v_lshl_add_u32 v104, v105, 4, v104
    s_add_u32 s69, s34, 0
    buffer_load_dwordx4 a[96:99], v104, s[12:15], s69 offen offset:0
    buffer_load_dwordx4 a[100:103], v104, s[12:15], s69 offen offset:64
    buffer_load_dwordx4 a[104:107], v104, s[12:15], s69 offen offset:128
    buffer_load_dwordx4 a[108:111], v104, s[12:15], s69 offen offset:192
    buffer_load_dwordx4 a[112:115], v104, s[12:15], s69 offen offset:256
    buffer_load_dwordx4 a[116:119], v104, s[12:15], s69 offen offset:320
    s_add_u32 s69, s34, 6144
    buffer_load_dwordx4 a[120:123], v104, s[12:15], s69 offen offset:0
    buffer_load_dwordx4 a[124:127], v104, s[12:15], s69 offen offset:64
    buffer_load_dwordx4 a[128:131], v104, s[12:15], s69 offen offset:128
    buffer_load_dwordx4 a[132:135], v104, s[12:15], s69 offen offset:192
    buffer_load_dwordx4 a[136:139], v104, s[12:15], s69 offen offset:256
    buffer_load_dwordx4 a[140:143], v104, s[12:15], s69 offen offset:320
    s_add_u32 s69, s34, 12288
    buffer_load_dwordx4 a[144:147], v104, s[12:15], s69 offen offset:0
    buffer_load_dwordx4 a[148:151], v104, s[12:15], s69 offen offset:64
    buffer_load_dwordx4 a[152:155], v104, s[12:15], s69 offen offset:128
    buffer_load_dwordx4 a[156:159], v104, s[12:15], s69 offen offset:192
    buffer_load_dwordx4 a[160:163], v104, s[12:15], s69 offen offset:256
    buffer_load_dwordx4 a[164:167], v104, s[12:15], s69 offen offset:320
    s_add_u32 s69, s34, 18432
    buffer_load_dwordx4 a[168:171], v104, s[12:15], s69 offen offset:0
    buffer_load_dwordx4 a[172:175], v104, s[12:15], s69 offen offset:64
    buffer_load_dwordx4 a[176:179], v104, s[12:15], s69 offen offset:128
    buffer_load_dwordx4 a[180:183], v104, s[12:15], s69 offen offset:192
    buffer_load_dwordx4 a[184:187], v104, s[12:15], s69 offen offset:256
    buffer_load_dwordx4 a[188:191], v104, s[12:15], s69 offen offset:320
    s_add_u32 s69, s34, 24576
    buffer_load_dwordx4 a[192:195], v104, s[12:15], s69 offen offset:0
    buffer_load_dwordx4 a[196:199], v104, s[12:15], s69 offen offset:64
    buffer_load_dwordx4 a[200:203], v104, s[12:15], s69 offen offset:128
    buffer_load_dwordx4 a[204:207], v104, s[12:15], s69 offen offset:192
    buffer_load_dwordx4 a[208:211], v104, s[12:15], s69 offen offset:256
    buffer_load_dwordx4 a[212:215], v104, s[12:15], s69 offen offset:320
    s_waitcnt vmcnt(0)
    s_call_b64 s[40:41], L_rare5_1
    v_mbcnt_lo_u32_b32 v105, -1, 0
    v_mbcnt_hi_u32_b32 v105, -1, v105
    v_and_b32 v104, 15, v105
    v_mul_u32_u24 v104, 384, v104
    v_lshrrev_b32 v105, 4, v105
    v_lshl_add_u32 v104, v105, 4, v104
    s_add_u32 s69, s33, 0
    buffer_load_dwordx4 a[96:99], v104, s[12:15], s69 offen offset:0
    buffer_load_dwordx4 a[100:103], v104, s[12:15], s69 offen offset:64
    buffer_load_dwordx4 a[104:107], v104, s[12:15], s69 offen offset:128
    buffer_load_dwordx4 a[108:111], v104, s[12:15], s69 offen offset:192
    buffer_load_dwordx4 a[112:115], v104, s[12:15], s69 offen offset:256
    buffer_load_dwordx4 a[116:119], v104, s[12:15], s69 offen offset:320
    s_add_u32 s69, s33, 6144
    buffer_load_dwordx4 a[120:123], v104, s[12:15], s69 offen offset:0
    buffer_load_dwordx4 a[124:127], v104, s[12:15], s69 offen offset:64
    buffer_load_dwordx4 a[128:131], v104, s[12:15], s69 offen offset:128
    buffer_load_dwordx4 a[132:135], v104, s[12:15], s69 offen offset:192
    buffer_load_dwordx4 a[136:139], v104, s[12:15], s69 offen offset:256
    buffer_load_dwordx4 a[140:143], v104, s[12:15], s69 offen offset:320
    s_add_u32 s69, s33, 12288
    buffer_load_dwordx4 a[144:147], v104, s[12:15], s69 offen offset:0
    buffer_load_dwordx4 a[148:151], v104, s[12:15], s69 offen offset:64
    buffer_load_dwordx4 a[152:155], v104, s[12:15], s69 offen offset:128
    buffer_load_dwordx4 a[156:159], v104, s[12:15], s69 offen offset:192
    buffer_load_dwordx4 a[160:163], v104, s[12:15], s69 offen offset:256
    buffer_load_dwordx4 a[164:167], v104, s[12:15], s69 offen offset:320
    s_add_u32 s69, s33, 18432
    buffer_load_dwordx4 a[168:171], v104, s[12:15], s69 offen offset:0
    buffer_load_dwordx4 a[172:175], v104, s[12:15], s69 offen offset:64
    buffer_load_dwordx4 a[176:179], v104, s[12:15], s69 offen offset:128
    buffer_load_dwordx4 a[180:183], v104, s[12:15], s69 offen offset:192
    buffer_load_dwordx4 a[184:187], v104, s[12:15], s69 offen offset:256
    buffer_load_dwordx4 a[188:191], v104, s[12:15], s69 offen offset:320
    s_add_u32 s69, s33, 24576
    buffer_load_dwordx4 a[192:195], v104, s[12:15], s69 offen offset:0
    buffer_load_dwordx4 a[196:199], v104, s[12:15], s69 offen offset:64
    buffer_load_dwordx4 a[200:203], v104, s[12:15], s69 offen offset:128
    buffer_load_dwordx4 a[204:207], v104, s[12:15], s69 offen offset:192
    buffer_load_dwordx4 a[208:211], v104, s[12:15], s69 offen offset:256
    buffer_load_dwordx4 a[212:215], v104, s[12:15], s69 offen offset:320
    s_waitcnt vmcnt(0)
    s_mov_b32 s14, s68
    s_branch L_ret_tr55b
L_rs_tr55d:
    s_call_b64 s[40:41], L_rare5_1
    s_branch L_ret_tr55d
.section .rodata,"a"
.p2align 6
.amdhsa_kernel standalone__gqa_softmax__near_ridge_kernel
  .amdhsa_next_free_vgpr 512
  .amdhsa_next_free_sgpr 102
  .amdhsa_accum_offset 256
  .amdhsa_group_segment_fixed_size 0
  .amdhsa_kernarg_size 48
  .amdhsa_user_sgpr_count 2
  .amdhsa_user_sgpr_kernarg_segment_ptr 1
  .amdhsa_system_sgpr_workgroup_id_x 1
.end_amdhsa_kernel
```

```asm
; @launch grid=(256,1,1) block=(256,1,1) lds=163840
.amdgcn_target "amdgcn-amd-amdhsa--gfx950"
.text
.globl standalone__gqa_softmax__near_ridge_kernel
.p2align 8
.type standalone__gqa_softmax__near_ridge_kernel,@function
standalone__gqa_softmax__near_ridge_kernel:
    s_cmp_ge_u32 s2, 256
    s_cbranch_scc1 L_end
    s_load_dwordx4 s[84:87], s[0:1], 0
    s_load_dwordx4 s[88:91], s[0:1], 16
    v_lshrrev_b32 v110, 6, v0
    v_and_b32 v111, 63, v0
    s_getpc_b64 s[60:61]
L_pc:
    s_lshr_b32 s62, s2, 3
    v_lshl_add_u32 v53, s62, 2, v110
    v_min_u32 v52, ((L_codeend-L_pc+16383)/16384)-1, v111
    v_mul_u32_u24 v53, ((L_codeend-L_pc+16383)/16384), v53
    v_add_lshl_u32 v52, v52, v53, 7
    v_min_u32 v52, L_codeend-L_pc-4, v52
    global_load_dword v53, v52, s[60:61]
    v_readfirstlane_b32 s3, v110
    v_lshrrev_b32 v96, 3, v111
    v_mul_u32_u24 v7, 384, v96
    v_lshrrev_b32 v97, 1, v96
    v_lshlrev_b32 v97, 1, v97
    v_and_b32 v98, 7, v111
    v_xor_b32 v97, v97, v98
    v_lshl_add_u32 v7, v97, 4, v7
    s_and_b32 s65, s3, 1
    s_mul_i32 s42, s65, 80
    s_mul_i32 s43, s65, 3072
    v_xor_b32 v6, s42, v7
    v_xor_b32 v7, 80, v6
    v_add_u32 v6, s43, v6
    s_sub_u32 s43, 3072, s43
    v_add_u32 v7, s43, v7
    s_mov_b32 s28, 0x3dd53b95
    s_mov_b32 s29, 0x3e800000
    s_mov_b32 s49, 5888
    s_mov_b32 s66, 0x28301800
    s_mov_b32 s46, 0
    s_mov_b32 s47, -1
    s_and_b32 s42, s2, 7
    s_lshr_b32 s43, s2, 3
    s_mul_i32 s44, s43, 43
    s_lshr_b32 s44, s44, 7
    s_mov_b32 s39, s44
    s_mul_i32 s45, s44, 3
    s_sub_u32 s36, s43, s45
    s_lshl_b32 s42, s42, 6
    s_lshl_b32 s45, s45, 1
    s_add_u32 s42, s42, s45
    s_mul_i32 s64, s42, 196608
    s_mul_i32 s35, s42, 325632
    s_lshr_b32 s42, s44, 1
    s_mov_b32 s31, 0x5a005a0
    s_cmp_eq_u32 s42, 1
    s_cselect_b32 s31, 0x5a005a0, s31
    s_cmp_eq_u32 s42, 2
    s_cselect_b32 s31, 0x5a005a0, s31
    s_cmp_eq_u32 s42, 3
    s_cselect_b32 s31, 0x5a005a0, s31
    s_cmp_eq_u32 s42, 4
    s_cselect_b32 s31, 0x5a005a0, s31
    s_and_b32 s42, s44, 1
    s_lshl_b32 s42, s42, 4
    s_lshr_b32 s31, s31, s42
    s_and_b32 s31, s31, 0xffff
    s_cmp_eq_u32 s43, 30
    s_cselect_b32 s31, 0x120648, s31
    s_cmp_eq_u32 s43, 31
    s_cselect_b32 s31, 0x240219, s31
    s_lshr_b32 s63, s31, 16
    s_cmp_ge_u32 s43, 30
    s_cselect_b32 s36, 0, s36
    s_cselect_b32 s42, 4, 6
    s_mul_i32 s42, s42, 196608
    s_add_u32 s6, s64, s42
    s_mov_b32 s10, s6
    s_mul_i32 s22, s3, 3072
    s_mul_i32 s38, s3, 28672
    s_add_u32 s38, s38, 49152
    s_and_b32 s42, s3, 2
    s_mul_i32 s42, s42, 3072
    s_add_u32 s20, s64, s42
    s_mov_b32 s21, s20
    s_mov_b32 s14, 166723584
    s_mov_b32 s18, 0
    s_mov_b32 s67, 0
    s_mov_b32 s37, 0
    s_lshl_b32 s42, s37, 1
    s_lshr_b32 s42, s31, s42
    s_and_b32 s42, s42, 3
    s_add_u32 s42, s42, s36
    s_sub_u32 s43, s42, 3
    s_cmp_ge_u32 s42, 3
    s_cselect_b32 s42, s43, s42
    s_mul_i32 s44, s3, 5
    s_mov_b32 s32, 1
    s_lshl_b32 s43, s3, 2
    s_add_u32 s45, s43, 21
    s_cmp_eq_u32 s3, 0
    s_cselect_b32 s45, 20, s45
    s_cselect_b32 s34, 1, 0
    s_cmp_eq_u32 s42, 1
    s_cselect_b32 s44, s45, s44
    s_cselect_b32 s32, s34, s32
    s_add_u32 s45, s43, 37
    s_cmp_eq_u32 s42, 2
    s_cselect_b32 s44, s45, s44
    s_cselect_b32 s32, 0, s32
    s_mul_i32 s44, s44, 6144
    s_add_u32 s34, s35, s44
    s_waitcnt lgkmcnt(0)
    s_mov_b32 s12, s84
    s_and_b32 s13, s85, 0xffff
    s_mov_b32 s15, 0x20000
    s_mov_b32 s4, s86
    s_and_b32 s5, s87, 0xffff
    s_mov_b32 s7, 0x20000
    s_mov_b32 s8, s88
    s_and_b32 s9, s89, 0xffff
    s_mov_b32 s11, 0x20000
    s_mov_b32 s16, s90
    s_and_b32 s17, s91, 0xffff
    s_mov_b32 s19, 0x20000
    s_cmp_eq_u32 s32, 0
    s_cbranch_scc1 L_start4
L_start5:
    s_add_u32 m0, s22, 0
    s_nop 0
    buffer_load_dwordx4 v6, s[4:7], s20 offen lds
    s_add_u32 s20, s20, 128
    s_add_u32 m0, s22, 1024
    s_nop 0
    buffer_load_dwordx4 v6, s[4:7], s20 offen lds
    s_add_u32 s20, s20, 128
    s_add_u32 m0, s22, 2048
    s_nop 0
    buffer_load_dwordx4 v6, s[4:7], s20 offen lds
    s_add_u32 s20, s20, 12032
    s_add_u32 m0, s22, 12288
    s_nop 0
    buffer_load_dwordx4 v6, s[4:7], s20 offen lds
    s_add_u32 s20, s20, 128
    s_add_u32 m0, s22, 13312
    s_nop 0
    buffer_load_dwordx4 v6, s[4:7], s20 offen lds
    s_add_u32 s20, s20, 128
    s_add_u32 m0, s22, 14336
    s_nop 0
    buffer_load_dwordx4 v6, s[4:7], s20 offen lds
    s_add_u32 s20, s20, 12032
    s_add_u32 s48, s34, 0
    s_add_u32 m0, s38, 0
    s_nop 0
    buffer_load_dwordx4 v6, s[12:15], s48 offen nt lds
    s_add_u32 m0, s38, 1024
    s_nop 0
    buffer_load_dwordx4 v7, s[12:15], s48 offen nt lds
    s_add_u32 s48, s34, 128
    s_add_u32 m0, s38, 2048
    s_nop 0
    buffer_load_dwordx4 v6, s[12:15], s48 offen nt lds
    s_add_u32 m0, s38, 3072
    s_nop 0
    buffer_load_dwordx4 v7, s[12:15], s48 offen nt lds
    s_add_u32 s48, s34, 256
    s_add_u32 m0, s38, 4096
    s_nop 0
    buffer_load_dwordx4 v6, s[12:15], s48 offen nt lds
    s_add_u32 m0, s38, 5120
    s_nop 0
    buffer_load_dwordx4 v7, s[12:15], s48 offen nt lds
    s_add_u32 s48, s34, 6144
    s_add_u32 m0, s38, 6144
    s_nop 0
    buffer_load_dwordx4 v6, s[12:15], s48 offen nt lds
    s_add_u32 m0, s38, 7168
    s_nop 0
    buffer_load_dwordx4 v7, s[12:15], s48 offen nt lds
    s_add_u32 s48, s34, 6272
    s_add_u32 m0, s38, 8192
    s_nop 0
    buffer_load_dwordx4 v6, s[12:15], s48 offen nt lds
    s_add_u32 m0, s38, 9216
    s_nop 0
    buffer_load_dwordx4 v7, s[12:15], s48 offen nt lds
    s_add_u32 s48, s34, 6400
    s_add_u32 m0, s38, 10240
    s_nop 0
    buffer_load_dwordx4 v6, s[12:15], s48 offen nt lds
    s_add_u32 m0, s38, 11264
    s_nop 0
    buffer_load_dwordx4 v7, s[12:15], s48 offen nt lds
    s_add_u32 s48, s34, 12288
    s_add_u32 m0, s38, 12288
    s_nop 0
    buffer_load_dwordx4 v6, s[12:15], s48 offen nt lds
    s_add_u32 m0, s38, 13312
    s_nop 0
    buffer_load_dwordx4 v7, s[12:15], s48 offen nt lds
    s_add_u32 s48, s34, 12416
    s_add_u32 m0, s38, 14336
    s_nop 0
    buffer_load_dwordx4 v6, s[12:15], s48 offen nt lds
    s_add_u32 m0, s38, 15360
    s_nop 0
    buffer_load_dwordx4 v7, s[12:15], s48 offen nt lds
    s_add_u32 s48, s34, 12544
    s_add_u32 m0, s38, 16384
    s_nop 0
    buffer_load_dwordx4 v6, s[12:15], s48 offen nt lds
    s_add_u32 m0, s38, 17408
    s_nop 0
    buffer_load_dwordx4 v7, s[12:15], s48 offen nt lds
    v_and_b32 v96, 15, v111
    v_lshrrev_b32 v97, 4, v111
    v_lshrrev_b32 v98, 3, v96
    v_and_b32 v99, 7, v96
    v_lshlrev_b32 v0, 7, v99
    v_bfe_u32 v99, v96, 1, 2
    v_lshlrev_b32 v99, 1, v99
    v_mul_u32_u24 v100, 5, v98
    v_xor_b32 v99, v99, v100
    v_xor_b32 v99, v99, v97
    v_lshl_add_u32 v0, v99, 4, v0
    v_mul_u32_u24 v100, 3072, v98
    v_add_u32 v0, v100, v0
    v_xor_b32 v1, 64, v0
    v_lshrrev_b32 v98, 1, v97
    v_mul_u32_u24 v2, 3072, v98
    v_and_b32 v99, 1, v97
    v_bfe_u32 v100, v111, 2, 2
    v_lshl_add_u32 v96, v99, 2, v100
    v_lshl_add_u32 v2, v96, 7, v2
    v_lshrrev_b32 v96, 1, v96
    v_lshlrev_b32 v96, 1, v96
    v_mul_u32_u24 v98, 5, v98
    v_xor_b32 v96, v96, v98
    v_bfe_u32 v99, v111, 1, 1
    v_xor_b32 v96, v96, v99
    v_lshl_add_u32 v2, v96, 4, v2
    v_and_b32 v99, 1, v111
    v_lshl_add_u32 v2, v99, 3, v2
    v_add_u32 v2, 24576, v2
    v_xor_b32 v3, 32, v2
    v_xor_b32 v4, 64, v2
    v_xor_b32 v5, 96, v2
    v_lshl_add_u32 v103, v111, 4, s38
    v_and_b32 v96, 15, v111
    v_lshrrev_b32 v98, 1, v111
    v_and_or_b32 v98, v98, 16, v96
    s_mov_b32 s42, 0x22110033
    v_bfe_i32 v97, s42, v98, 1
    v_and_b32 v97, 0x3f803f80, v97
    v_accvgpr_write_b32 a240, v97
    v_accvgpr_write_b32 a241, v97
    v_accvgpr_write_b32 a242, v97
    v_accvgpr_write_b32 a243, v97
    s_mov_b32 s42, 0x44110055
    v_bfe_i32 v97, s42, v98, 1
    v_and_b32 v97, 0x3f803f80, v97
    v_accvgpr_write_b32 a244, v97
    v_accvgpr_write_b32 a245, v97
    v_accvgpr_write_b32 a246, v97
    v_accvgpr_write_b32 a247, v97
    s_mov_b32 s42, 0x88898889
    v_bfe_i32 v97, s42, v98, 1
    v_and_b32 v97, 0x3f803f80, v97
    v_accvgpr_write_b32 a248, v97
    v_accvgpr_write_b32 a249, v97
    v_accvgpr_write_b32 a250, v97
    v_accvgpr_write_b32 a251, v97
    s_mov_b32 s42, 0x50005
    v_bfe_i32 v97, s42, v98, 1
    v_and_b32 v97, 0x3f803f80, v97
    v_accvgpr_write_b32 a252, v97
    v_accvgpr_write_b32 a253, v97
    v_accvgpr_write_b32 a254, v97
    v_accvgpr_write_b32 a255, v97
    v_bfe_i32 v97, v111, 2, 1
    v_and_b32 v97, 0xaaaa, v97
    v_or_b32 v101, 0x4444, v97
    s_waitcnt vmcnt(18)
    s_barrier
    s_waitcnt vmcnt(12)
    s_add_u32 s48, s34, 18432
    s_add_u32 m0, s38, 18432
    s_nop 0
    buffer_load_dwordx4 v6, s[12:15], s48 offen nt lds
    s_add_u32 m0, s38, 19456
    s_nop 0
    buffer_load_dwordx4 v7, s[12:15], s48 offen nt lds
    ds_read_b128 a[216:219], v0 offset:0
    ds_read_b128 a[220:223], v1 offset:0
    v_and_b32 v104, 0x3ff, v0
    v_lshrrev_b32 v105, 11, v0
    s_add_u32 s48, s34, 18560
    s_add_u32 m0, s38, 20480
    v_xor_b32 v105, s65, v105
    buffer_load_dwordx4 v6, s[12:15], s48 offen nt lds
    v_lshl_add_u32 v104, v105, 10, v104
    s_add_u32 m0, s38, 21504
    v_add_u32 v104, s38, v104
    buffer_load_dwordx4 v7, s[12:15], s48 offen nt lds
    ds_read_b128 a[96:99], v104 offset:0
    s_add_u32 s48, s34, 18688
    v_xor_b32 v105, 64, v104
    s_add_u32 m0, s38, 22528
    v_mbcnt_lo_u32_b32 v107, -1, 0
    buffer_load_dwordx4 v6, s[12:15], s48 offen nt lds
    ds_read_b128 a[108:111], v105 offset:2048
    s_add_u32 m0, s38, 23552
    ds_read_b128 a[104:107], v104 offset:2048
    v_mbcnt_hi_u32_b32 v107, -1, v107
    buffer_load_dwordx4 v7, s[12:15], s48 offen nt lds
    ds_read_b128 a[116:119], v105 offset:4096
    ds_read_b128 a[100:103], v105 offset:0
    s_waitcnt lgkmcnt(4)
    v_mfma_f32_16x16x32_bf16 v[52:55], a[216:219], a[96:99], 0
    ds_read_b128 a[228:231], v1 offset:1024
    s_waitcnt lgkmcnt(1)
    v_mfma_f32_16x16x32_bf16 v[52:55], a[220:223], a[100:103], v[52:55]
    ds_read_b128 a[224:227], v0 offset:1024
    ds_read_b128 a[216:219], v0 offset:6144
    s_waitcnt lgkmcnt(1)
    v_mfma_f32_16x16x32_bf16 v[52:55], a[224:227], a[104:107], v[52:55]
    ds_read_b128 a[220:223], v1 offset:6144
    ds_read_b128 a[232:235], v0 offset:2048
    v_mfma_f32_16x16x32_bf16 v[52:55], a[228:231], a[108:111], v[52:55]
    ds_read_b128 a[112:115], v104 offset:4096
    s_waitcnt lgkmcnt(0)
    v_mfma_f32_16x16x32_bf16 v[52:55], a[232:235], a[112:115], v[52:55]
    ds_read_b128 a[236:239], v1 offset:2048
    s_waitcnt lgkmcnt(0)
    v_mfma_f32_16x16x32_bf16 v[52:55], a[236:239], a[116:119], v[52:55]
    v_and_b32 v106, 15, v107
    ds_read_b128 a[232:235], v0 offset:8192
    v_mfma_f32_16x16x32_bf16 v[56:59], a[216:219], a[96:99], 0
    ds_read_b128 a[224:227], v0 offset:7168
    v_mfma_f32_16x16x32_bf16 v[56:59], a[220:223], a[100:103], v[56:59]
    ds_read_b128 a[216:219], v0 offset:12288
    s_waitcnt lgkmcnt(1)
    v_mfma_f32_16x16x32_bf16 v[56:59], a[224:227], a[104:107], v[56:59]
    ds_read_b128 a[228:231], v1 offset:7168
    v_max3_f32 v96, v52, v53, v54
    s_waitcnt lgkmcnt(0)
    v_mfma_f32_16x16x32_bf16 v[56:59], a[228:231], a[108:111], v[56:59]
    ds_read_b128 a[236:239], v1 offset:8192
    v_mfma_f32_16x16x32_bf16 v[56:59], a[232:235], a[112:115], v[56:59]
    ds_read_b128 a[232:235], v0 offset:14336
    v_mul_u32_u24 v106, 384, v106
    v_lshrrev_b32 v107, 4, v107
    s_waitcnt lgkmcnt(1)
    v_mfma_f32_16x16x32_bf16 v[56:59], a[236:239], a[116:119], v[56:59]
    s_nop 7
    v_max3_f32 v96, v96, v55, v56
    v_max3_f32 v96, v96, v57, v58
    v_lshl_add_u32 v106, v107, 4, v106
    v_max_f32 v96, v96, v59
    v_mov_b32 v97, v96
    s_waitcnt vmcnt(12)
    s_add_u32 s48, s34, 24576
    s_add_u32 m0, s38, 24576
    ds_read_b128 a[228:231], v1 offset:13312
    buffer_load_dwordx4 v6, s[12:15], s48 offen nt lds
    s_add_u32 m0, s38, 25600
    s_nop 0
    buffer_load_dwordx4 v7, s[12:15], s48 offen nt lds
    v_permlane32_swap_b32 v97, v96
    v_max_f32 v96, v96, v97
    s_add_u32 s48, s34, 24704
    s_add_u32 m0, s38, 26624
    v_mov_b32 v97, v96
    buffer_load_dwordx4 v6, s[12:15], s48 offen nt lds
    s_add_u32 m0, s38, 27648
    ds_read_b128 a[220:223], v1 offset:12288
    buffer_load_dwordx4 v7, s[12:15], s48 offen nt lds
    v_permlane16_swap_b32 v97, v96
    v_max_f32 v96, v96, v97
    s_add_u32 s48, s34, 24576
    buffer_load_dwordx4 a[208:211], v106, s[12:15], s48 offen offset:256 nt
    v_mul_f32_e64 v9, -s28, v96
    v_subrev_f32 v9, 0x42000000, v9
    v_fma_f32 v53, v53, s28, v9
    v_fma_f32 v54, v54, s28, v9
    v_exp_f32_e64 v53, v53 clamp
    v_fma_f32 v52, v52, s28, v9
    v_fma_f32 v55, v55, s28, v9
    v_exp_f32_e64 v52, v52 clamp
    v_exp_f32_e64 v55, v55 clamp
    v_exp_f32_e64 v54, v54 clamp
    v_cvt_pk_bf16_f32 v14, v52, v53
    v_cvt_pk_bf16_f32 v15, v54, v55
    v_mfma_f32_16x16x32_bf16 v[52:55], a[216:219], a[96:99], 0
    buffer_load_dwordx4 a[212:215], v106, s[12:15], s48 offen offset:320 nt
    v_fma_f32 v57, v57, s28, v9
    ds_read_b128 a[236:239], v1 offset:14336
    v_fma_f32 v56, v56, s28, v9
    ds_read_b128 a[224:227], v0 offset:13312
    v_exp_f32_e64 v57, v57 clamp
    v_fma_f32 v58, v58, s28, v9
    s_waitcnt lgkmcnt(2)
    v_mfma_f32_16x16x32_bf16 v[52:55], a[220:223], a[100:103], v[52:55]
    ds_read_b128 a[140:143], v105 offset:10240
    s_waitcnt lgkmcnt(1)
    v_mfma_f32_16x16x32_bf16 v[52:55], a[224:227], a[104:107], v[52:55]
    ds_read_b128 a[216:219], v0 offset:18432
    v_mfma_f32_16x16x32_bf16 v[52:55], a[228:231], a[108:111], v[52:55]
    v_fma_f32 v59, v59, s28, v9
    ds_read_b128 a[128:131], v104 offset:8192
    ds_read_b128 a[120:123], v104 offset:6144
    v_mfma_f32_16x16x32_bf16 v[52:55], a[232:235], a[112:115], v[52:55]
    v_exp_f32_e64 v56, v56 clamp
    s_nop 0
    v_cvt_pk_bf16_f32 v16, v56, v57
    ds_read_b128 a[228:231], v1 offset:19456
    ds_read_b128 a[224:227], v0 offset:19456
    v_exp_f32_e64 v59, v59 clamp
    v_exp_f32_e64 v58, v58 clamp
    v_mfma_f32_16x16x32_bf16 v[52:55], a[236:239], a[116:119], v[52:55]
    v_cvt_pk_bf16_f32 v17, v58, v59
    ds_read_b128 a[220:223], v1 offset:18432
    ds_read_b128 a[132:135], v105 offset:8192
    s_waitcnt lgkmcnt(6)
    v_mfma_f32_16x16x32_bf16 v[56:59], a[216:219], a[96:99], 0
    ds_read_b128 a[236:239], v1 offset:20480
    s_waitcnt lgkmcnt(2)
    v_mfma_f32_16x16x32_bf16 v[56:59], a[220:223], a[100:103], v[56:59]
    ds_read_b128 a[216:219], v0 offset:0
    v_mfma_f32_16x16x32_bf16 v[56:59], a[224:227], a[104:107], v[56:59]
    ds_read_b128 a[136:139], v104 offset:10240
    ds_read_b128 a[124:127], v105 offset:6144
    ds_read_b128 a[232:235], v0 offset:20480
    v_mfma_f32_16x16x32_bf16 v[56:59], a[228:231], a[108:111], v[56:59]
    ds_read_b128 a[228:231], v1 offset:1024
    s_waitcnt lgkmcnt(1)
    v_mfma_f32_16x16x32_bf16 v[56:59], a[232:235], a[112:115], v[56:59]
    ds_read_b128 a[220:223], v1 offset:0
    v_mfma_f32_16x16x32_bf16 v[56:59], a[236:239], a[116:119], v[56:59]
    ds_read_b128 a[224:227], v0 offset:1024
    v_mfma_f32_16x16x32_bf16 v[60:63], a[216:219], a[120:123], 0
    ds_read_b128 a[216:219], v0 offset:6144
    s_waitcnt lgkmcnt(2)
    v_mfma_f32_16x16x32_bf16 v[60:63], a[220:223], a[124:127], v[60:63]
    ds_read_b128 a[232:235], v0 offset:2048
    s_waitcnt lgkmcnt(2)
    v_mfma_f32_16x16x32_bf16 v[60:63], a[224:227], a[128:131], v[60:63]
    ds_read_b128 a[236:239], v1 offset:2048
    v_mfma_f32_16x16x32_bf16 v[60:63], a[228:231], a[132:135], v[60:63]
    ds_read_b128 a[220:223], v1 offset:6144
    s_waitcnt lgkmcnt(2)
    v_mfma_f32_16x16x32_bf16 v[60:63], a[232:235], a[136:139], v[60:63]
    ds_read_b128 a[224:227], v0 offset:7168
    s_waitcnt lgkmcnt(2)
    v_mfma_f32_16x16x32_bf16 v[60:63], a[236:239], a[140:143], v[60:63]
    ds_read_b128 a[236:239], v1 offset:8192
    v_mfma_f32_16x16x32_bf16 v[64:67], a[216:219], a[120:123], 0
    s_waitcnt lgkmcnt(2)
    ds_read_b128 a[228:231], v1 offset:7168
    v_mfma_f32_16x16x32_bf16 v[64:67], a[220:223], a[124:127], v[64:67]
    ds_read_b128 a[232:235], v0 offset:8192
    s_nop 1
    v_max3_f32 v98, v60, v61, v62
    s_waitcnt lgkmcnt(3)
    v_mfma_f32_16x16x32_bf16 v[64:67], a[224:227], a[128:131], v[64:67]
    ds_read_b128 a[224:227], v0 offset:13312
    s_waitcnt lgkmcnt(2)
    v_mfma_f32_16x16x32_bf16 v[64:67], a[228:231], a[132:135], v[64:67]
    ds_read_b128 a[220:223], v1 offset:12288
    s_waitcnt lgkmcnt(2)
    v_mfma_f32_16x16x32_bf16 v[64:67], a[232:235], a[136:139], v[64:67]
    s_waitcnt vmcnt(12)
    s_add_u32 m0, s22, 24576
    ds_read_b128 a[156:159], v105 offset:14336
    buffer_load_dwordx4 v6, s[8:11], s21 offen lds
    v_mfma_f32_16x16x32_bf16 v[64:67], a[236:239], a[140:143], v[64:67]
    s_add_u32 s21, s21, 128
    ds_read_b128 a[228:231], v1 offset:13312
    s_add_u32 m0, s22, 25600
    s_nop 0
    buffer_load_dwordx4 v6, s[8:11], s21 offen lds
    v_mfma_f32_16x16x32_bf16 v[44:47], a[248:251], v[14:17], 0
    s_add_u32 s21, s21, 128
    s_add_u32 m0, s22, 26624
    v_max3_f32 v98, v98, v63, v64
    v_max3_f32 v98, v98, v65, v66
    v_max_f32 v98, v98, v67
    buffer_load_dwordx4 v6, s[8:11], s21 offen lds
    v_mov_b32 v99, v98
    s_nop 1
    v_permlane32_swap_b32 v99, v98
    v_max_f32 v98, v98, v99
    ds_read_b128 a[144:147], v104 offset:12288
    ds_read_b128 a[160:163], v104 offset:16384
    v_mov_b32 v99, v98
    s_nop 1
    v_permlane16_swap_b32 v99, v98
    v_max_f32 v98, v98, v99
    v_mul_f32_e64 v10, -s28, v98
    v_subrev_f32 v10, 0x42000000, v10
    v_fma_f32 v65, v65, s28, v10
    v_fma_f32 v64, v64, s28, v10
    v_exp_f32_e64 v64, v64 clamp
    v_exp_f32_e64 v65, v65 clamp
    v_fma_f32 v55, v55, s28, v9
    v_fma_f32 v61, v61, s28, v10
    v_fma_f32 v60, v60, s28, v10
    v_exp_f32_e64 v60, v60 clamp
    v_fma_f32 v66, v66, s28, v10
    s_add_u32 s21, s21, 12032
    v_fma_f32 v63, v63, s28, v10
    v_fma_f32 v67, v67, s28, v10
    ds_read_b128 a[236:239], v1 offset:14336
    v_fma_f32 v62, v62, s28, v10
    v_cvt_pk_bf16_f32 v24, v64, v65
    v_exp_f32_e64 v61, v61 clamp
    v_exp_f32_e64 v67, v67 clamp
    v_exp_f32_e64 v62, v62 clamp
    v_cvt_pk_bf16_f32 v22, v60, v61
    v_exp_f32_e64 v63, v63 clamp
    ds_read_b128 a[216:219], v0 offset:12288
    v_exp_f32_e64 v66, v66 clamp
    v_cvt_pk_bf16_f32 v23, v62, v63
    s_waitcnt lgkmcnt(0)
    v_mfma_f32_16x16x32_bf16 v[60:63], a[216:219], a[120:123], 0
    ds_read_b128 a[232:235], v0 offset:14336
    v_mfma_f32_16x16x32_bf16 v[60:63], a[220:223], a[124:127], v[60:63]
    ds_read_b128 a[148:151], v105 offset:12288
    v_mfma_f32_16x16x32_bf16 v[60:63], a[224:227], a[128:131], v[60:63]
    v_cvt_pk_bf16_f32 v25, v66, v67
    ds_read_b128 a[152:155], v104 offset:14336
    v_mfma_f32_16x16x32_bf16 v[60:63], a[228:231], a[132:135], v[60:63]
    ds_read_b128 a[216:219], v0 offset:18432
    ds_read_b128 a[220:223], v1 offset:18432
    s_waitcnt lgkmcnt(4)
    v_mfma_f32_16x16x32_bf16 v[60:63], a[232:235], a[136:139], v[60:63]
    v_fma_f32 v54, v54, s28, v9
    ds_read_b128 a[224:227], v0 offset:19456
    v_mfma_f32_16x16x32_bf16 v[60:63], a[236:239], a[140:143], v[60:63]
    ds_read_b128 a[232:235], v0 offset:20480
    s_waitcnt lgkmcnt(3)
    v_mfma_f32_16x16x32_bf16 v[64:67], a[216:219], a[120:123], 0
    s_waitcnt lgkmcnt(2)
    ds_read_b128 a[236:239], v1 offset:20480
    v_mfma_f32_16x16x32_bf16 v[64:67], a[220:223], a[124:127], v[64:67]
    ds_read_b128 a[228:231], v1 offset:19456
    s_waitcnt lgkmcnt(3)
    v_mfma_f32_16x16x32_bf16 v[64:67], a[224:227], a[128:131], v[64:67]
    ds_read_b128 a[220:223], v1 offset:0
    s_waitcnt lgkmcnt(1)
    v_mfma_f32_16x16x32_bf16 v[64:67], a[228:231], a[132:135], v[64:67]
    ds_read_b128 a[216:219], v0 offset:0
    v_mfma_f32_16x16x32_bf16 v[64:67], a[232:235], a[136:139], v[64:67]
    ds_read_b128 a[224:227], v0 offset:1024
    v_mfma_f32_16x16x32_bf16 v[64:67], a[236:239], a[140:143], v[64:67]
    ds_read_b128 a[228:231], v1 offset:1024
    s_waitcnt lgkmcnt(2)
    v_mfma_f32_16x16x32_bf16 v[68:71], a[216:219], a[144:147], 0
    ds_read_b128 a[236:239], v1 offset:2048
    v_mfma_f32_16x16x32_bf16 v[68:71], a[220:223], a[148:151], v[68:71]
    s_waitcnt lgkmcnt(2)
    ds_read_b128 a[164:167], v105 offset:16384
    v_mfma_f32_16x16x32_bf16 v[68:71], a[224:227], a[152:155], v[68:71]
    s_waitcnt lgkmcnt(2)
    ds_read_b128 a[216:219], v0 offset:6144
    ds_read_b128 a[232:235], v0 offset:2048
    v_fma_f32 v53, v53, s28, v9
    v_mfma_f32_16x16x32_bf16 v[68:71], a[228:231], a[156:159], v[68:71]
    ds_read_b128 a[220:223], v1 offset:6144
    s_waitcnt lgkmcnt(1)
    v_mfma_f32_16x16x32_bf16 v[68:71], a[232:235], a[160:163], v[68:71]
    ds_read_b128 a[228:231], v1 offset:7168
    v_mfma_f32_16x16x32_bf16 v[68:71], a[236:239], a[164:167], v[68:71]
    ds_read_b128 a[224:227], v0 offset:7168
    v_mfma_f32_16x16x32_bf16 v[72:75], a[216:219], a[144:147], 0
    s_waitcnt lgkmcnt(2)
    ds_read_b128 a[232:235], v0 offset:8192
    v_fma_f32 v52, v52, s28, v9
    v_mfma_f32_16x16x32_bf16 v[72:75], a[220:223], a[148:151], v[72:75]
    s_nop 1
    v_max3_f32 v96, v68, v69, v70
    v_fma_f32 v61, v61, s28, v10
    ds_read_b128 a[236:239], v1 offset:8192
    s_waitcnt lgkmcnt(2)
    v_mfma_f32_16x16x32_bf16 v[72:75], a[224:227], a[152:155], v[72:75]
    ds_read_b128 a[220:223], v1 offset:12288
    v_mfma_f32_16x16x32_bf16 v[72:75], a[228:231], a[156:159], v[72:75]
    s_waitcnt lgkmcnt(2)
    v_fma_f32 v60, v60, s28, v10
    ds_read_b128 a[216:219], v0 offset:12288
    v_mfma_f32_16x16x32_bf16 v[72:75], a[232:235], a[160:163], v[72:75]
    ds_read_b128 a[228:231], v1 offset:13312
    s_waitcnt lgkmcnt(3)
    v_mfma_f32_16x16x32_bf16 v[72:75], a[236:239], a[164:167], v[72:75]
    s_nop 7
    v_max3_f32 v96, v96, v71, v72
    s_waitcnt vmcnt(9)
    s_add_u32 m0, s22, 36864
    s_nop 0
    buffer_load_dwordx4 v6, s[8:11], s21 offen lds
    s_add_u32 s21, s21, 128
    s_add_u32 m0, s22, 37888
    v_max3_f32 v96, v96, v73, v74
    buffer_load_dwordx4 v6, s[8:11], s21 offen lds
    s_add_u32 s21, s21, 128
    v_max_f32 v96, v96, v75
    ds_read_b128 a[184:187], v104 offset:22528
    s_add_u32 m0, s22, 38912
    s_nop 0
    buffer_load_dwordx4 v6, s[8:11], s21 offen lds
    v_mov_b32 v97, v96
    s_nop 1
    v_permlane32_swap_b32 v97, v96
    v_max_f32 v96, v96, v97
    v_mov_b32 v97, v96
    s_nop 1
    v_permlane16_swap_b32 v97, v96
    v_max_f32 v96, v96, v97
    v_fma_f32 v63, v63, s28, v10
    v_mul_f32_e64 v11, -s28, v96
    v_subrev_f32 v11, 0x42000000, v11
    ds_read_b128 a[180:183], v105 offset:20480
    v_fma_f32 v70, v70, s28, v11
    v_fma_f32 v69, v69, s28, v11
    v_fma_f32 v71, v71, s28, v11
    v_fma_f32 v74, v74, s28, v11
    ds_read_b128 a[224:227], v0 offset:13312
    v_exp_f32_e64 v71, v71 clamp
    v_fma_f32 v68, v68, s28, v11
    v_fma_f32 v73, v73, s28, v11
    v_exp_f32_e64 v70, v70 clamp
    v_exp_f32_e64 v69, v69 clamp
    v_exp_f32_e64 v68, v68 clamp
    v_exp_f32_e64 v74, v74 clamp
    v_cvt_pk_bf16_f32 v26, v68, v69
    v_fma_f32 v72, v72, s28, v11
    v_fma_f32 v75, v75, s28, v11
    v_exp_f32_e64 v73, v73 clamp
    v_cvt_pk_bf16_f32 v27, v70, v71
    ds_read_b128 a[232:235], v0 offset:14336
    s_waitcnt lgkmcnt(3)
    v_mfma_f32_16x16x32_bf16 v[68:71], a[216:219], a[144:147], 0
    v_exp_f32_e64 v54, v54 clamp
    ds_read_b128 a[172:175], v105 offset:18432
    v_mfma_f32_16x16x32_bf16 v[68:71], a[220:223], a[148:151], v[68:71]
    ds_read_b128 a[236:239], v1 offset:14336
    s_waitcnt lgkmcnt(3)
    v_mfma_f32_16x16x32_bf16 v[68:71], a[224:227], a[152:155], v[68:71]
    v_exp_f32_e64 v72, v72 clamp
    v_exp_f32_e64 v75, v75 clamp
    ds_read_b128 a[220:223], v1 offset:18432
    v_mfma_f32_16x16x32_bf16 v[68:71], a[228:231], a[156:159], v[68:71]
    v_cvt_pk_bf16_f32 v29, v74, v75
    ds_read_b128 a[216:219], v0 offset:18432
    v_cvt_pk_bf16_f32 v28, v72, v73
    v_exp_f32_e64 v60, v60 clamp
    s_waitcnt lgkmcnt(4)
    v_mfma_f32_16x16x32_bf16 v[68:71], a[232:235], a[160:163], v[68:71]
    ds_read_b128 a[232:235], v0 offset:20480
    s_waitcnt lgkmcnt(3)
    v_mfma_f32_16x16x32_bf16 v[68:71], a[236:239], a[164:167], v[68:71]
    ds_read_b128 a[228:231], v1 offset:19456
    ds_read_b128 a[224:227], v0 offset:19456
    s_waitcnt lgkmcnt(3)
    v_mfma_f32_16x16x32_bf16 v[72:75], a[216:219], a[144:147], 0
    ds_read_b128 a[168:171], v104 offset:18432
    ds_read_b128 a[176:179], v104 offset:20480
    v_mfma_f32_16x16x32_bf16 v[72:75], a[220:223], a[148:151], v[72:75]
    ds_read_b128 a[236:239], v1 offset:20480
    ds_read_b128 a[216:219], v0 offset:0
    v_exp_f32_e64 v55, v55 clamp
    s_waitcnt lgkmcnt(4)
    v_mfma_f32_16x16x32_bf16 v[72:75], a[224:227], a[152:155], v[72:75]
    ds_read_b128 a[224:227], v0 offset:1024
    v_mfma_f32_16x16x32_bf16 v[72:75], a[228:231], a[156:159], v[72:75]
    ds_read_b128 a[188:191], v105 offset:22528
    v_mfma_f32_16x16x32_bf16 v[72:75], a[232:235], a[160:163], v[72:75]
    ds_read_b128 a[220:223], v1 offset:0
    s_waitcnt lgkmcnt(4)
    v_mfma_f32_16x16x32_bf16 v[72:75], a[236:239], a[164:167], v[72:75]
    s_waitcnt lgkmcnt(3)
    ds_read_b128 a[236:239], v1 offset:2048
    v_mfma_f32_16x16x32_bf16 v[76:79], a[216:219], a[168:171], 0
    ds_read_b128 a[232:235], v0 offset:2048
    v_smfmac_f32_16x16x64_bf16 v[44:47], a[240:243], v[22:29], v101
    ds_read_b128 a[228:231], v1 offset:1024
    s_waitcnt lgkmcnt(3)
    v_mfma_f32_16x16x32_bf16 v[76:79], a[220:223], a[172:175], v[76:79]
    ds_read_b128 a[216:219], v0 offset:6144
    v_mfma_f32_16x16x32_bf16 v[76:79], a[224:227], a[176:179], v[76:79]
    ds_read_b128 a[220:223], v1 offset:6144
    s_waitcnt lgkmcnt(2)
    v_mfma_f32_16x16x32_bf16 v[76:79], a[228:231], a[180:183], v[76:79]
    ds_read_b128 a[228:231], v1 offset:7168
    v_mfma_f32_16x16x32_bf16 v[76:79], a[232:235], a[184:187], v[76:79]
    ds_read_b128 a[232:235], v0 offset:8192
    v_mfma_f32_16x16x32_bf16 v[76:79], a[236:239], a[188:191], v[76:79]
    ds_read_b128 a[224:227], v0 offset:7168
    s_waitcnt lgkmcnt(4)
    v_mfma_f32_16x16x32_bf16 v[80:83], a[216:219], a[168:171], 0
    ds_read_b128 a[236:239], v1 offset:8192
    v_cvt_pk_bf16_f32 v19, v54, v55
    s_waitcnt lgkmcnt(4)
    v_mfma_f32_16x16x32_bf16 v[80:83], a[220:223], a[172:175], v[80:83]
    s_add_u32 s21, s21, 12032
    ds_read_b128 a[220:223], v1 offset:12288
    s_waitcnt lgkmcnt(2)
    v_mfma_f32_16x16x32_bf16 v[80:83], a[224:227], a[176:179], v[80:83]
    ds_read_b128 a[224:227], v0 offset:13312
    v_mfma_f32_16x16x32_bf16 v[80:83], a[228:231], a[180:183], v[80:83]
    v_max3_f32 v98, v76, v77, v78
    ds_read_b128 a[228:231], v1 offset:13312
    v_mfma_f32_16x16x32_bf16 v[80:83], a[232:235], a[184:187], v[80:83]
    s_waitcnt lgkmcnt(3)
    ds_read_b128 a[216:219], v0 offset:12288
    v_mfma_f32_16x16x32_bf16 v[80:83], a[236:239], a[188:191], v[80:83]
    v_exp_f32_e64 v53, v53 clamp
    s_nop 6
    v_max3_f32 v98, v98, v79, v80
    v_max3_f32 v98, v98, v81, v82
    v_max_f32 v98, v98, v83
    v_mov_b32 v99, v98
    s_nop 1
    v_permlane32_swap_b32 v99, v98
    v_max_f32 v98, v98, v99
    v_mov_b32 v99, v98
    s_nop 1
    v_permlane16_swap_b32 v99, v98
    v_max_f32 v98, v98, v99
    v_exp_f32_e64 v52, v52 clamp
    v_mul_f32_e64 v12, -s28, v98
    v_subrev_f32 v12, 0x42000000, v12
    v_fma_f32 v80, v80, s28, v12
    v_fma_f32 v79, v79, s28, v12
    ds_read_b128 a[232:235], v0 offset:14336
    v_exp_f32_e64 v63, v63 clamp
    v_fma_f32 v77, v77, s28, v12
    v_fma_f32 v78, v78, s28, v12
    v_fma_f32 v76, v76, s28, v12
    v_fma_f32 v81, v81, s28, v12
    v_fma_f32 v83, v83, s28, v12
    v_exp_f32_e64 v76, v76 clamp
    v_exp_f32_e64 v78, v78 clamp
    v_fma_f32 v82, v82, s28, v12
    v_exp_f32_e64 v77, v77 clamp
    s_nop 0
    v_cvt_pk_bf16_f32 v34, v76, v77
    v_exp_f32_e64 v79, v79 clamp
    v_fma_f32 v62, v62, s28, v10
    v_cvt_pk_bf16_f32 v35, v78, v79
    s_waitcnt lgkmcnt(1)
    v_mfma_f32_16x16x32_bf16 v[76:79], a[216:219], a[168:171], 0
    ds_read_b128 a[216:219], v0 offset:18432
    v_exp_f32_e64 v81, v81 clamp
    v_mfma_f32_16x16x32_bf16 v[76:79], a[220:223], a[172:175], v[76:79]
    ds_read_b128 a[236:239], v1 offset:14336
    v_mfma_f32_16x16x32_bf16 v[76:79], a[224:227], a[176:179], v[76:79]
    v_exp_f32_e64 v61, v61 clamp
    v_exp_f32_e64 v62, v62 clamp
    v_exp_f32_e64 v80, v80 clamp
    v_exp_f32_e64 v83, v83 clamp
    ds_read_b128 a[224:227], v0 offset:19456
    v_mfma_f32_16x16x32_bf16 v[76:79], a[228:231], a[180:183], v[76:79]
    s_waitcnt lgkmcnt(3)
    ds_read_b128 a[220:223], v1 offset:18432
    s_waitcnt vmcnt(6)
    ds_read_b128 a[200:203], v104 offset:26624
    v_mfma_f32_16x16x32_bf16 v[76:79], a[232:235], a[184:187], v[76:79]
    ds_read_b128 a[228:231], v1 offset:19456
    ds_read_b128 a[232:235], v0 offset:20480
    v_exp_f32_e64 v82, v82 clamp
    s_waitcnt lgkmcnt(5)
    v_mfma_f32_16x16x32_bf16 v[76:79], a[236:239], a[188:191], v[76:79]
    ds_read_b128 a[192:195], v104 offset:24576
    v_cvt_pk_bf16_f32 v37, v82, v83
    v_cvt_pk_bf16_f32 v36, v80, v81
    v_mfma_f32_16x16x32_bf16 v[80:83], a[216:219], a[168:171], 0
    ds_read_b128 a[196:199], v105 offset:24576
    ds_read_b128 a[216:219], v0 offset:0
    ds_read_b128 a[236:239], v1 offset:20480
    s_waitcnt lgkmcnt(7)
    v_mfma_f32_16x16x32_bf16 v[80:83], a[220:223], a[172:175], v[80:83]
    ds_read_b128 a[204:207], v105 offset:26624
    v_mfma_f32_16x16x32_bf16 v[80:83], a[224:227], a[176:179], v[80:83]
    s_waitcnt lgkmcnt(5)
    ds_read_b128 a[220:223], v1 offset:0
    v_mfma_f32_16x16x32_bf16 v[80:83], a[228:231], a[180:183], v[80:83]
    ds_read_b128 a[228:231], v1 offset:1024
    ds_read_b128 a[224:227], v0 offset:1024
    v_mfma_f32_16x16x32_bf16 v[80:83], a[232:235], a[184:187], v[80:83]
    ds_read_b128 a[232:235], v0 offset:2048
    s_waitcnt lgkmcnt(5)
    v_mfma_f32_16x16x32_bf16 v[80:83], a[236:239], a[188:191], v[80:83]
    ds_read_b128 a[236:239], v1 offset:2048
    v_mfma_f32_16x16x32_bf16 v[84:87], a[216:219], a[192:195], 0
    s_waitcnt lgkmcnt(4)
    v_mfma_f32_16x16x32_bf16 v[84:87], a[220:223], a[196:199], v[84:87]
    ds_read_b128 a[216:219], v0 offset:6144
    s_waitcnt lgkmcnt(3)
    v_mfma_f32_16x16x32_bf16 v[84:87], a[224:227], a[200:203], v[84:87]
    ds_read_b128 a[220:223], v1 offset:6144
    v_mfma_f32_16x16x32_bf16 v[84:87], a[228:231], a[204:207], v[84:87]
    s_waitcnt lgkmcnt(3)
    ds_read_b128 a[224:227], v0 offset:7168
    v_mfma_f32_16x16x32_bf16 v[84:87], a[232:235], a[208:211], v[84:87]
    ds_read_b128 a[228:231], v1 offset:7168
    s_waitcnt lgkmcnt(4)
    v_mfma_f32_16x16x32_bf16 v[84:87], a[236:239], a[212:215], v[84:87]
    ds_read_b128 a[236:239], v1 offset:8192
    ds_read_b128 a[232:235], v0 offset:8192
    s_waitcnt lgkmcnt(5)
    v_mfma_f32_16x16x32_bf16 v[88:91], a[216:219], a[192:195], 0
    s_waitcnt lgkmcnt(4)
    v_mfma_f32_16x16x32_bf16 v[88:91], a[220:223], a[196:199], v[88:91]
    s_waitcnt lgkmcnt(3)
    v_mfma_f32_16x16x32_bf16 v[88:91], a[224:227], a[200:203], v[88:91]
    s_waitcnt lgkmcnt(2)
    v_mfma_f32_16x16x32_bf16 v[88:91], a[228:231], a[204:207], v[88:91]
    v_max3_f32 v96, v84, v85, v86
    s_waitcnt vmcnt(63) lgkmcnt(0)
    ds_read_b128 a[216:219], v0 offset:12288
    v_mfma_f32_16x16x32_bf16 v[88:91], a[232:235], a[208:211], v[88:91]
    s_barrier
    ds_read_b128 a[228:231], v1 offset:13312
    v_mfma_f32_16x16x32_bf16 v[88:91], a[236:239], a[212:215], v[88:91]
    s_add_u32 m0, s22, 0
    ds_read_b128 a[224:227], v0 offset:13312
    buffer_load_dwordx4 v6, s[4:7], s20 offen lds
    ds_read_b128 a[236:239], v1 offset:14336
    ds_read_b128 a[220:223], v1 offset:12288
    ds_read_b128 a[232:235], v0 offset:14336
    s_nop 1
    v_max3_f32 v96, v96, v87, v88
    v_max3_f32 v96, v96, v89, v90
    v_max_f32 v96, v96, v91
    v_mov_b32 v97, v96
    s_add_u32 s20, s20, 128
    s_nop 0
    v_permlane32_swap_b32 v97, v96
    v_max_f32 v96, v96, v97
    v_mov_b32 v97, v96
    s_add_u32 m0, s22, 1024
    s_nop 0
    v_permlane16_swap_b32 v97, v96
    v_max_f32 v96, v96, v97
    v_mul_f32_e64 v13, -s28, v96
    v_subrev_f32 v13, 0x42000000, v13
    v_fma_f32 v87, v87, s28, v13
    v_fma_f32 v85, v85, s28, v13
    v_fma_f32 v86, v86, s28, v13
    v_fma_f32 v84, v84, s28, v13
    v_exp_f32_e64 v85, v85 clamp
    v_exp_f32_e64 v86, v86 clamp
    v_fma_f32 v88, v88, s28, v13
    v_exp_f32_e64 v87, v87 clamp
    v_fma_f32 v89, v89, s28, v13
    v_exp_f32_e64 v84, v84 clamp
    v_cvt_pk_bf16_f32 v39, v86, v87
    v_cvt_pk_bf16_f32 v38, v84, v85
    s_waitcnt lgkmcnt(2)
    v_mfma_f32_16x16x32_bf16 v[84:87], a[216:219], a[192:195], 0
    s_waitcnt lgkmcnt(0)
    ds_read_b128 a[216:219], v0 offset:18432
    buffer_load_dwordx4 v6, s[4:7], s20 offen lds
    s_add_u32 s20, s20, 128
    v_mfma_f32_16x16x32_bf16 v[84:87], a[220:223], a[196:199], v[84:87]
    s_add_u32 m0, s22, 2048
    ds_read_b128 a[220:223], v1 offset:18432
    buffer_load_dwordx4 v6, s[4:7], s20 offen lds
    v_mfma_f32_16x16x32_bf16 v[84:87], a[224:227], a[200:203], v[84:87]
    s_add_u32 s20, s20, 12032
    s_mov_b32 s39, s64
    s_add_u32 s37, s37, 1
    ds_read_b128 a[224:227], v0 offset:19456
    v_fma_f32 v90, v90, s28, v13
    s_bitcmp1_b32 s63, s37
    v_mfma_f32_16x16x32_bf16 v[84:87], a[228:231], a[204:207], v[84:87]
    s_cselect_b32 s62, 4294770688, 0
    s_cselect_b32 s42, 0, 325632
    s_add_u32 s35, s35, s42
    ds_read_b128 a[228:231], v1 offset:19456
    s_lshl_b32 s42, s37, 1
    s_lshr_b32 s42, s31, s42
    s_and_b32 s42, s42, 3
    v_mfma_f32_16x16x32_bf16 v[84:87], a[232:235], a[208:211], v[84:87]
    s_add_u32 s42, s42, s36
    s_sub_u32 s43, s42, 3
    ds_read_b128 a[232:235], v0 offset:20480
    s_cmp_ge_u32 s42, 3
    v_mfma_f32_16x16x32_bf16 v[84:87], a[236:239], a[212:215], v[84:87]
    s_cselect_b32 s42, s43, s42
    ds_read_b128 a[236:239], v1 offset:20480
    s_mul_i32 s44, s3, 5
    s_mov_b32 s32, 1
    s_lshl_b32 s43, s3, 2
    s_add_u32 s45, s43, 21
    s_cmp_eq_u32 s3, 0
    v_fma_f32 v91, v91, s28, v13
    s_cselect_b32 s45, 20, s45
    s_cselect_b32 s33, 1, 0
    s_cmp_eq_u32 s42, 1
    s_cselect_b32 s44, s45, s44
    s_cselect_b32 s32, s33, s32
    v_exp_f32_e64 v88, v88 clamp
    s_add_u32 s45, s43, 37
    v_exp_f32_e64 v89, v89 clamp
    s_cmp_eq_u32 s42, 2
    v_exp_f32_e64 v91, v91 clamp
    s_cselect_b32 s44, s45, s44
    s_cselect_b32 s32, 0, s32
    s_mul_i32 s44, s44, 6144
    s_add_u32 s33, s35, s44
    s_mul_i32 s42, s32, 6144
    v_exp_f32_e64 v90, v90 clamp
    s_add_u32 s42, s42, 24576
    s_add_u32 s42, s42, s33
    s_cmp_ge_u32 s37, 6
    s_cselect_b32 s14, 0, s42
    v_cvt_pk_bf16_f32 v40, v88, v89
    s_add_u32 s24, s67, 256
    s_add_u32 s25, s33, 256
    v_cvt_pk_bf16_f32 v41, v90, v91
    s_add_u32 s23, s38, 4096
    s_mov_b32 s27, 0x249
    s_mov_b32 s30, 0
    s_waitcnt vmcnt(6) lgkmcnt(0)
    v_mfma_f32_16x16x32_bf16 v[88:91], a[216:219], a[192:195], 0
    s_barrier
    ds_read_b64_tr_b16 a[216:217], v2 offset:0
    ds_read_b64_tr_b16 a[218:219], v2 offset:6144
    v_mfma_f32_16x16x32_bf16 v[88:91], a[220:223], a[196:199], v[88:91]
    s_add_u32 m0, s22, 12288
    ds_read_b64_tr_b16 a[220:221], v3 offset:0
    ds_read_b64_tr_b16 a[222:223], v3 offset:6144
    buffer_load_dwordx4 v6, s[4:7], s20 offen lds
    v_mfma_f32_16x16x32_bf16 v[88:91], a[224:227], a[200:203], v[88:91]
    ds_read_b64_tr_b16 a[224:225], v4 offset:0
    v_mfma_f32_16x16x32_bf16 v[88:91], a[228:231], a[204:207], v[88:91]
    s_add_u32 s20, s20, 128
    ds_read_b64_tr_b16 a[226:227], v4 offset:6144
    v_mfma_f32_16x16x32_bf16 v[88:91], a[232:235], a[208:211], v[88:91]
    s_add_u32 m0, s22, 13312
    s_nop 0
    buffer_load_dwordx4 v6, s[4:7], s20 offen lds
    s_add_u32 s20, s20, 128
    v_cvt_pk_bf16_f32 v18, v52, v53
    ds_read_b64_tr_b16 a[228:229], v5 offset:0
    s_add_u32 m0, s22, 14336
    v_mfma_f32_16x16x32_bf16 v[88:91], a[236:239], a[212:215], v[88:91]
    buffer_load_dwordx4 v6, s[4:7], s20 offen lds
    ds_read_b64_tr_b16 a[230:231], v5 offset:6144
    s_add_u32 s20, s20, 12032
    v_smfmac_f32_16x16x64_bf16 v[44:47], a[244:247], v[34:41], v101
    s_waitcnt lgkmcnt(4)
    v_mfma_f32_16x16x32_bf16 v[112:115], a[216:219], v[14:17], 0
    v_fma_f32 v82, v82, s28, v12
    v_mfma_f32_16x16x32_bf16 v[116:119], a[220:223], v[14:17], 0
    v_fma_f32 v87, v87, s28, v13
    v_fma_f32 v77, v77, s28, v12
    v_mfma_f32_16x16x32_bf16 v[164:167], a[220:223], v[22:25], 0
    ds_read_b64_tr_b16 a[236:237], v3 offset:1024
    v_fma_f32 v88, v88, s28, v13
    v_mfma_f32_16x16x32_bf16 v[160:163], a[216:219], v[22:25], 0
    ds_read_b64_tr_b16 a[234:235], v2 offset:7168
    v_fma_f32 v64, v64, s28, v10
    v_mfma_f32_16x16x32_bf16 v[208:211], a[216:219], v[26:29], 0
    v_fma_f32 v85, v85, s28, v13
    v_fma_f32 v83, v83, s28, v12
    v_mfma_f32_16x16x32_bf16 v[212:215], a[220:223], v[26:29], 0
    v_fma_f32 v71, v71, s28, v11
    v_mfma_f32_16x16x32_bf16 a[4:7], a[220:223], v[34:37], 0
    v_fma_f32 v69, v69, s28, v11
    v_mfma_f32_16x16x32_bf16 a[0:3], a[216:219], v[34:37], 0
    ds_read_b64_tr_b16 a[232:233], v2 offset:1024
    v_mfma_f32_16x16x32_bf16 a[48:51], a[216:219], v[38:41], 0
    ds_read_b64_tr_b16 a[238:239], v3 offset:7168
    v_fma_f32 v66, v66, s28, v10
    v_mfma_f32_16x16x32_bf16 a[52:55], a[220:223], v[38:41], 0
    s_waitcnt lgkmcnt(4)
    v_exp_f32_e64 v69, v69 clamp
    v_mfma_f32_16x16x32_bf16 a[56:59], a[224:227], v[38:41], 0
    v_exp_f32_e64 v71, v71 clamp
    v_mfma_f32_16x16x32_bf16 a[60:63], a[228:231], v[38:41], 0
    v_fma_f32 v78, v78, s28, v12
    v_mfma_f32_16x16x32_bf16 a[12:15], a[228:231], v[34:37], 0
    v_exp_f32_e64 v77, v77 clamp
    v_mfma_f32_16x16x32_bf16 a[8:11], a[224:227], v[34:37], 0
    v_fma_f32 v75, v75, s28, v11
    v_fma_f32 v70, v70, s28, v11
    v_mfma_f32_16x16x32_bf16 v[216:219], a[224:227], v[26:29], 0
    ds_read_b64_tr_b16 a[218:219], v4 offset:7168
    v_fma_f32 v57, v57, s28, v9
    v_mfma_f32_16x16x32_bf16 v[220:223], a[228:231], v[26:29], 0
    ds_read_b64_tr_b16 a[216:217], v4 offset:1024
    v_mfma_f32_16x16x32_bf16 v[172:175], a[228:231], v[22:25], 0
    v_fma_f32 v72, v72, s28, v11
    v_mfma_f32_16x16x32_bf16 v[168:171], a[224:227], v[22:25], 0
    v_fma_f32 v79, v79, s28, v12
    v_fma_f32 v73, v73, s28, v11
    v_mfma_f32_16x16x32_bf16 v[120:123], a[224:227], v[14:17], 0
    v_exp_f32_e64 v70, v70 clamp
    v_mfma_f32_16x16x32_bf16 v[124:127], a[228:231], v[14:17], 0
    s_waitcnt lgkmcnt(2)
    ds_read_b64_tr_b16 a[222:223], v5 offset:7168
    v_fma_f32 v58, v58, s28, v9
    v_mfma_f32_16x16x32_bf16 v[128:131], a[232:235], v[14:17], 0
    ds_read_b64_tr_b16 a[220:221], v5 offset:1024
    v_mfma_f32_16x16x32_bf16 v[132:135], a[236:239], v[14:17], 0
    v_fma_f32 v68, v68, s28, v11
    v_fma_f32 v91, v91, s28, v13
    v_mfma_f32_16x16x32_bf16 v[180:183], a[236:239], v[22:25], 0
    ds_read_b64_tr_b16 a[226:227], v2 offset:8192
    v_mfma_f32_16x16x32_bf16 v[176:179], a[232:235], v[22:25], 0
    ds_read_b64_tr_b16 a[230:231], v3 offset:8192
    v_fma_f32 v86, v86, s28, v13
    v_mfma_f32_16x16x32_bf16 v[224:227], a[232:235], v[26:29], 0
    v_exp_f32_e64 v64, v64 clamp
    v_mfma_f32_16x16x32_bf16 v[228:231], a[236:239], v[26:29], 0
    s_add_u32 s39, s39, 12288
    v_exp_f32_e64 v85, v85 clamp
    v_mfma_f32_16x16x32_bf16 a[20:23], a[236:239], v[34:37], 0
    ds_read_b64_tr_b16 a[228:229], v3 offset:2048
    v_mfma_f32_16x16x32_bf16 a[16:19], a[232:235], v[34:37], 0
    ds_read_b64_tr_b16 a[224:225], v2 offset:2048
    v_fma_f32 v74, v74, s28, v11
    v_mfma_f32_16x16x32_bf16 a[64:67], a[232:235], v[38:41], 0
    v_exp_f32_e64 v73, v73 clamp
    v_mfma_f32_16x16x32_bf16 a[68:71], a[236:239], v[38:41], 0
    s_waitcnt lgkmcnt(5)
    v_fma_f32 v81, v81, s28, v12
    v_fma_f32 v59, v59, s28, v9
    v_mfma_f32_16x16x32_bf16 a[72:75], a[216:219], v[38:41], 0
    s_waitcnt lgkmcnt(4)
    ds_read_b64_tr_b16 a[238:239], v5 offset:8192
    v_fma_f32 v80, v80, s28, v12
    v_mfma_f32_16x16x32_bf16 a[76:79], a[220:223], v[38:41], 0
    ds_read_b64_tr_b16 a[232:233], v4 offset:2048
    v_mfma_f32_16x16x32_bf16 a[28:31], a[220:223], v[34:37], 0
    ds_read_b64_tr_b16 a[236:237], v5 offset:2048
    v_mfma_f32_16x16x32_bf16 a[24:27], a[216:219], v[34:37], 0
    v_fma_f32 v90, v90, s28, v13
    v_fma_f32 v67, v67, s28, v10
    v_mfma_f32_16x16x32_bf16 v[232:235], a[216:219], v[26:29], 0
    ds_read_b64_tr_b16 a[234:235], v4 offset:8192
    v_fma_f32 v65, v65, s28, v10
    v_mfma_f32_16x16x32_bf16 v[236:239], a[220:223], v[26:29], 0
    v_exp_f32_e64 v72, v72 clamp
    v_mfma_f32_16x16x32_bf16 v[188:191], a[220:223], v[22:25], 0
    v_exp_f32_e64 v91, v91 clamp
    v_mfma_f32_16x16x32_bf16 v[184:187], a[216:219], v[22:25], 0
    v_exp_f32_e64 v82, v82 clamp
    v_mfma_f32_16x16x32_bf16 v[136:139], a[216:219], v[14:17], 0
    v_exp_f32_e64 v81, v81 clamp
    v_mfma_f32_16x16x32_bf16 v[140:143], a[220:223], v[14:17], 0
    s_waitcnt lgkmcnt(4)
    v_fma_f32 v84, v84, s28, v13
    v_fma_f32 v76, v76, s28, v12
    v_mfma_f32_16x16x32_bf16 v[144:147], a[224:227], v[14:17], 0
    v_exp_f32_e64 v83, v83 clamp
    v_mfma_f32_16x16x32_bf16 v[148:151], a[228:231], v[14:17], 0
    v_exp_f32_e64 v75, v75 clamp
    v_mfma_f32_16x16x32_bf16 v[196:199], a[228:231], v[22:25], 0
    v_exp_f32_e64 v68, v68 clamp
    v_mfma_f32_16x16x32_bf16 v[192:195], a[224:227], v[22:25], 0
    v_cvt_pk_bf16_f32 v33, v82, v83
    v_mfma_f32_16x16x32_bf16 v[240:243], a[224:227], v[26:29], 0
    v_exp_f32_e64 v84, v84 clamp
    v_mfma_f32_16x16x32_bf16 v[244:247], a[228:231], v[26:29], 0
    v_exp_f32_e64 v79, v79 clamp
    v_mfma_f32_16x16x32_bf16 a[36:39], a[228:231], v[34:37], 0
    v_exp_f32_e64 v78, v78 clamp
    v_mfma_f32_16x16x32_bf16 a[32:35], a[224:227], v[34:37], 0
    v_exp_f32_e64 v74, v74 clamp
    v_mfma_f32_16x16x32_bf16 a[80:83], a[224:227], v[38:41], 0
    s_waitcnt vmcnt(3) lgkmcnt(0)
    v_exp_f32_e64 v87, v87 clamp
    v_mfma_f32_16x16x32_bf16 a[84:87], a[228:231], v[38:41], 0
    s_barrier
    ds_read_b128 a[216:219], v0 offset:0
    v_mfma_f32_16x16x32_bf16 a[88:91], a[232:235], v[38:41], 0
    s_add_u32 m0, s22, 24576
    ds_read_b128 a[220:223], v1 offset:0
    v_mfma_f32_16x16x32_bf16 a[92:95], a[236:239], v[38:41], 0
    ds_read_b128 a[224:227], v0 offset:1024
    v_cvt_pk_bf16_f32 v31, v70, v71
    v_mfma_f32_16x16x32_bf16 a[44:47], a[236:239], v[34:37], 0
    buffer_load_dwordx4 v6, s[8:11], s21 offen lds
    v_mfma_f32_16x16x32_bf16 a[40:43], a[232:235], v[34:37], 0
    s_add_u32 s21, s21, 128
    v_cvt_pk_bf16_f32 v42, v84, v85
    v_mfma_f32_16x16x32_bf16 v[248:251], a[232:235], v[26:29], 0
    v_exp_f32_e64 v76, v76 clamp
    v_mfma_f32_16x16x32_bf16 v[252:255], a[236:239], v[26:29], 0
    s_add_u32 m0, s22, 25600
    ds_read_b128 a[228:231], v1 offset:1024
    v_mfma_f32_16x16x32_bf16 v[204:207], a[236:239], v[22:25], 0
    buffer_load_dwordx4 v6, s[8:11], s21 offen lds
    v_mfma_f32_16x16x32_bf16 v[200:203], a[232:235], v[22:25], 0
    s_add_u32 s21, s21, 128
    v_cvt_pk_bf16_f32 v30, v68, v69
    s_add_u32 m0, s22, 26624
    v_mfma_f32_16x16x32_bf16 v[152:155], a[232:235], v[14:17], 0
    buffer_load_dwordx4 v6, s[8:11], s21 offen lds
    v_mfma_f32_16x16x32_bf16 v[156:159], a[236:239], v[14:17], 0
    s_waitcnt lgkmcnt(3)
    v_cvt_pk_bf16_f32 v28, v72, v73
    v_cvt_pk_bf16_f32 v34, v76, v77
    v_mfma_f32_16x16x32_bf16 v[52:55], a[216:219], a[96:99], 0
    s_waitcnt lgkmcnt(2)
    ds_read_b128 a[232:235], v0 offset:2048
    v_cvt_pk_bf16_f32 v23, v62, v63
    v_mfma_f32_16x16x32_bf16 v[52:55], a[220:223], a[100:103], v[52:55]
    s_waitcnt lgkmcnt(2)
    ds_read_b128 a[236:239], v1 offset:2048
    v_mfma_f32_16x16x32_bf16 v[52:55], a[224:227], a[104:107], v[52:55]
    s_add_u32 s21, s21, 12032
    v_cvt_pk_bf16_f32 v35, v78, v79
    v_cvt_pk_bf16_f32 v22, v60, v61
    v_mfma_f32_16x16x32_bf16 v[60:63], a[224:227], a[128:131], 0
    v_exp_f32_e64 v86, v86 clamp
    v_mfma_f32_16x16x32_bf16 v[60:63], a[220:223], a[124:127], v[60:63]
    v_mfma_f32_16x16x32_bf16 v[60:63], a[216:219], a[120:123], v[60:63]
    v_exp_f32_e64 v59, v59 clamp
    v_mfma_f32_16x16x32_bf16 v[68:71], a[216:219], a[144:147], 0
    v_exp_f32_e64 v57, v57 clamp
    v_mfma_f32_16x16x32_bf16 v[68:71], a[220:223], a[148:151], v[68:71]
    v_cvt_pk_bf16_f32 v43, v86, v87
    v_mfma_f32_16x16x32_bf16 v[68:71], a[224:227], a[152:155], v[68:71]
    v_exp_f32_e64 v65, v65 clamp
    v_mfma_f32_16x16x32_bf16 v[76:79], a[224:227], a[176:179], 0
    v_mfma_f32_16x16x32_bf16 v[76:79], a[220:223], a[172:175], v[76:79]
    v_exp_f32_e64 v58, v58 clamp
    v_mfma_f32_16x16x32_bf16 v[76:79], a[216:219], a[168:171], v[76:79]
    s_add_u32 m0, s38, 0
    v_mfma_f32_16x16x32_bf16 v[84:87], a[216:219], a[192:195], 0
    v_exp_f32_e64 v67, v67 clamp
    v_mfma_f32_16x16x32_bf16 v[84:87], a[220:223], a[196:199], v[84:87]
    v_mfma_f32_16x16x32_bf16 v[84:87], a[224:227], a[200:203], v[84:87]
    s_waitcnt lgkmcnt(0)
    v_exp_f32_e64 v66, v66 clamp
    v_mfma_f32_16x16x32_bf16 v[84:87], a[228:231], a[204:207], v[84:87]
    v_exp_f32_e64 v80, v80 clamp
    v_mfma_f32_16x16x32_bf16 v[84:87], a[232:235], a[208:211], v[84:87]
    v_fma_f32 v56, v56, s28, v9
    v_fma_f32 v89, v89, s28, v13
    v_mfma_f32_16x16x32_bf16 v[84:87], a[236:239], a[212:215], v[84:87]
    ds_read_b128 a[216:219], v0 offset:6144
    v_cvt_pk_bf16_f32 v29, v74, v75
    v_mfma_f32_16x16x32_bf16 v[76:79], a[236:239], a[188:191], v[76:79]
    buffer_load_dwordx4 v6, s[12:15], s33 offen nt lds
    v_mfma_f32_16x16x32_bf16 v[76:79], a[232:235], a[184:187], v[76:79]
    v_exp_f32_e64 v56, v56 clamp
    v_mfma_f32_16x16x32_bf16 v[76:79], a[228:231], a[180:183], v[76:79]
    v_exp_f32_e64 v89, v89 clamp
    v_mfma_f32_16x16x32_bf16 v[68:71], a[228:231], a[156:159], v[68:71]
    v_exp_f32_e64 v90, v90 clamp
    v_mfma_f32_16x16x32_bf16 v[68:71], a[232:235], a[160:163], v[68:71]
    ds_read_b128 a[220:223], v1 offset:6144
    v_cvt_pk_bf16_f32 v21, v66, v67
    v_mfma_f32_16x16x32_bf16 v[68:71], a[236:239], a[164:167], v[68:71]
    s_add_u32 m0, s38, 1024
    ds_read_b128 a[224:227], v0 offset:7168
    v_cvt_pk_bf16_f32 v41, v90, v91
    v_mfma_f32_16x16x32_bf16 v[60:63], a[236:239], a[140:143], v[60:63]
    buffer_load_dwordx4 v7, s[12:15], s33 offen nt lds
    v_mfma_f32_16x16x32_bf16 v[60:63], a[232:235], a[136:139], v[60:63]
    v_exp_f32_e64 v88, v88 clamp
    v_mfma_f32_16x16x32_bf16 v[60:63], a[228:231], a[132:135], v[60:63]
    v_cvt_pk_bf16_f32 v17, v58, v59
    v_mfma_f32_16x16x32_bf16 v[52:55], a[228:231], a[108:111], v[52:55]
    v_cvt_pk_bf16_f32 v40, v88, v89
    v_cvt_pk_bf16_f32 v16, v56, v57
    v_mfma_f32_16x16x32_bf16 v[52:55], a[232:235], a[112:115], v[52:55]
    ds_read_b128 a[232:235], v0 offset:8192
    v_mfma_f32_16x16x32_bf16 v[52:55], a[236:239], a[116:119], v[52:55]
    v_cvt_pk_bf16_f32 v32, v80, v81
    v_cvt_pk_bf16_f32 v20, v64, v65
    v_mfma_f32_16x16x32_bf16 v[48:51], a[248:251], v[40:43], 0
    s_add_u32 s59, s33, 128
    s_add_u32 m0, s38, 2048
    ds_read_b128 a[228:231], v1 offset:7168
    v_smfmac_f32_16x16x64_bf16 v[48:51], a[240:243], v[16:23], v101
    ds_read_b128 a[236:239], v1 offset:8192
    v_smfmac_f32_16x16x64_bf16 v[48:51], a[244:247], v[28:35], v101
    s_waitcnt lgkmcnt(4)
    v_mfma_f32_16x16x32_bf16 v[56:59], a[216:219], a[96:99], 0
    buffer_load_dwordx4 v6, s[12:15], s59 offen nt lds
    v_mfma_f32_16x16x32_bf16 v[56:59], a[220:223], a[100:103], v[56:59]
    s_waitcnt lgkmcnt(3)
    v_mfma_f32_16x16x32_bf16 v[56:59], a[224:227], a[104:107], v[56:59]
    v_mfma_f32_16x16x32_bf16 v[64:67], a[224:227], a[128:131], 0
    s_nop 0
    v_cmp_lt_f32 vcc, s29, v48
    s_add_u32 m0, s38, 3072
    v_mfma_f32_16x16x32_bf16 v[64:67], a[220:223], a[124:127], v[64:67]
    v_add_u32 v103, 4096, v103
    v_mfma_f32_16x16x32_bf16 v[64:67], a[216:219], a[120:123], v[64:67]
    buffer_load_dwordx4 v7, s[12:15], s59 offen nt lds
    v_mfma_f32_16x16x32_bf16 v[72:75], a[216:219], a[144:147], 0
    s_cbranch_vccnz L_rs_start5b
L_ret_start5b:
    v_fma_f32 v55, v55, s28, v9
    v_mfma_f32_16x16x32_bf16 v[72:75], a[220:223], a[148:151], v[72:75]
    v_fma_f32 v52, v52, s28, v9
    v_fma_f32 v53, v53, s28, v9
    v_mfma_f32_16x16x32_bf16 v[72:75], a[224:227], a[152:155], v[72:75]
    s_waitcnt vmcnt(13) lgkmcnt(0)
    v_exp_f32_e64 v53, v53 clamp
    v_mfma_f32_16x16x32_bf16 v[80:83], a[224:227], a[176:179], 0
    s_barrier
    v_mfma_f32_16x16x32_bf16 v[80:83], a[220:223], a[172:175], v[80:83]
    v_exp_f32_e64 v52, v52 clamp
    v_mfma_f32_16x16x32_bf16 v[80:83], a[216:219], a[168:171], v[80:83]
    s_add_u32 m0, s22, 0
    v_fma_f32 v60, v60, s28, v10
    v_fma_f32 v62, v62, s28, v10
    v_mfma_f32_16x16x32_bf16 v[88:91], a[216:219], a[192:195], 0
    buffer_load_dwordx4 v6, s[4:7], s20 offen lds
    v_mfma_f32_16x16x32_bf16 v[88:91], a[220:223], a[196:199], v[88:91]
    s_add_u32 s20, s20, 128
    ds_read_b64_tr_b16 a[216:217], v2 offset:18432
    v_fma_f32 v54, v54, s28, v9
    v_mfma_f32_16x16x32_bf16 v[88:91], a[224:227], a[200:203], v[88:91]
    ds_read_b64_tr_b16 a[218:219], v2 offset:12288
    s_add_u32 m0, s22, 1024
    v_mfma_f32_16x16x32_bf16 v[88:91], a[228:231], a[204:207], v[88:91]
    buffer_load_dwordx4 v6, s[4:7], s20 offen lds
    v_mfma_f32_16x16x32_bf16 v[88:91], a[232:235], a[208:211], v[88:91]
    ds_read_b64_tr_b16 a[220:221], v3 offset:18432
    v_fma_f32 v63, v63, s28, v10
    v_mfma_f32_16x16x32_bf16 v[88:91], a[236:239], a[212:215], v[88:91]
    ds_read_b64_tr_b16 a[222:223], v3 offset:12288
    v_fma_f32 v61, v61, s28, v10
    v_mfma_f32_16x16x32_bf16 v[80:83], a[236:239], a[188:191], v[80:83]
    s_add_u32 s20, s20, 128
    s_add_u32 m0, s22, 2048
    ds_read_b64_tr_b16 a[224:225], v4 offset:18432
    v_mfma_f32_16x16x32_bf16 v[80:83], a[232:235], a[184:187], v[80:83]
    v_exp_f32_e64 v55, v55 clamp
    v_mfma_f32_16x16x32_bf16 v[80:83], a[228:231], a[180:183], v[80:83]
    buffer_load_dwordx4 v6, s[4:7], s20 offen lds
    v_mfma_f32_16x16x32_bf16 v[72:75], a[228:231], a[156:159], v[72:75]
    v_exp_f32_e64 v60, v60 clamp
    v_mfma_f32_16x16x32_bf16 v[72:75], a[232:235], a[160:163], v[72:75]
    s_add_u32 s20, s20, 12032
    ds_read_b64_tr_b16 a[226:227], v4 offset:12288
    v_cvt_pk_bf16_f32 v14, v52, v53
    v_mfma_f32_16x16x32_bf16 v[72:75], a[236:239], a[164:167], v[72:75]
    v_exp_f32_e64 v62, v62 clamp
    v_mfma_f32_16x16x32_bf16 v[64:67], a[236:239], a[140:143], v[64:67]
    v_exp_f32_e64 v63, v63 clamp
    v_mfma_f32_16x16x32_bf16 v[64:67], a[232:235], a[136:139], v[64:67]
    v_exp_f32_e64 v54, v54 clamp
    v_mfma_f32_16x16x32_bf16 v[64:67], a[228:231], a[132:135], v[64:67]
    s_bitcmp1_b32 s3, 1
    v_exp_f32_e64 v61, v61 clamp
    v_mfma_f32_16x16x32_bf16 v[56:59], a[228:231], a[108:111], v[56:59]
    s_waitcnt lgkmcnt(2)
    ds_read_b64_tr_b16 a[228:229], v5 offset:18432
    v_mfma_f32_16x16x32_bf16 v[56:59], a[232:235], a[112:115], v[56:59]
    ds_read_b64_tr_b16 a[230:231], v5 offset:12288
    v_cvt_pk_bf16_f32 v15, v54, v55
    v_mfma_f32_16x16x32_bf16 v[56:59], a[236:239], a[116:119], v[56:59]
    s_cbranch_scc1 L_loop5w1
    s_branch L_loop5w0
L_start4:
    s_add_u32 m0, s22, 0
    s_nop 0
    buffer_load_dwordx4 v6, s[4:7], s20 offen lds
    s_add_u32 s20, s20, 128
    s_add_u32 m0, s22, 1024
    s_nop 0
    buffer_load_dwordx4 v6, s[4:7], s20 offen lds
    s_add_u32 s20, s20, 128
    s_add_u32 m0, s22, 2048
    s_nop 0
    buffer_load_dwordx4 v6, s[4:7], s20 offen lds
    s_add_u32 s20, s20, 12032
    s_add_u32 m0, s22, 12288
    s_nop 0
    buffer_load_dwordx4 v6, s[4:7], s20 offen lds
    s_add_u32 s20, s20, 128
    s_add_u32 m0, s22, 13312
    s_nop 0
    buffer_load_dwordx4 v6, s[4:7], s20 offen lds
    s_add_u32 s20, s20, 128
    s_add_u32 m0, s22, 14336
    s_nop 0
    buffer_load_dwordx4 v6, s[4:7], s20 offen lds
    s_add_u32 s20, s20, 12032
    s_add_u32 s48, s34, 0
    s_add_u32 m0, s38, 0
    s_nop 0
    buffer_load_dwordx4 v6, s[12:15], s48 offen nt lds
    s_add_u32 m0, s38, 1024
    s_nop 0
    buffer_load_dwordx4 v7, s[12:15], s48 offen nt lds
    s_add_u32 s48, s34, 128
    s_add_u32 m0, s38, 2048
    s_nop 0
    buffer_load_dwordx4 v6, s[12:15], s48 offen nt lds
    s_add_u32 m0, s38, 3072
    s_nop 0
    buffer_load_dwordx4 v7, s[12:15], s48 offen nt lds
    s_add_u32 s48, s34, 256
    s_add_u32 m0, s38, 4096
    s_nop 0
    buffer_load_dwordx4 v6, s[12:15], s48 offen nt lds
    s_add_u32 m0, s38, 5120
    s_nop 0
    buffer_load_dwordx4 v7, s[12:15], s48 offen nt lds
    s_add_u32 s48, s34, 6144
    s_add_u32 m0, s38, 6144
    s_nop 0
    buffer_load_dwordx4 v6, s[12:15], s48 offen nt lds
    s_add_u32 m0, s38, 7168
    s_nop 0
    buffer_load_dwordx4 v7, s[12:15], s48 offen nt lds
    s_add_u32 s48, s34, 6272
    s_add_u32 m0, s38, 8192
    s_nop 0
    buffer_load_dwordx4 v6, s[12:15], s48 offen nt lds
    s_add_u32 m0, s38, 9216
    s_nop 0
    buffer_load_dwordx4 v7, s[12:15], s48 offen nt lds
    s_add_u32 s48, s34, 6400
    s_add_u32 m0, s38, 10240
    s_nop 0
    buffer_load_dwordx4 v6, s[12:15], s48 offen nt lds
    s_add_u32 m0, s38, 11264
    s_nop 0
    buffer_load_dwordx4 v7, s[12:15], s48 offen nt lds
    s_add_u32 s48, s34, 12288
    s_add_u32 m0, s38, 12288
    s_nop 0
    buffer_load_dwordx4 v6, s[12:15], s48 offen nt lds
    s_add_u32 m0, s38, 13312
    s_nop 0
    buffer_load_dwordx4 v7, s[12:15], s48 offen nt lds
    s_add_u32 s48, s34, 12416
    s_add_u32 m0, s38, 14336
    s_nop 0
    buffer_load_dwordx4 v6, s[12:15], s48 offen nt lds
    s_add_u32 m0, s38, 15360
    s_nop 0
    buffer_load_dwordx4 v7, s[12:15], s48 offen nt lds
    s_add_u32 s48, s34, 12544
    s_add_u32 m0, s38, 16384
    s_nop 0
    buffer_load_dwordx4 v6, s[12:15], s48 offen nt lds
    s_add_u32 m0, s38, 17408
    s_nop 0
    buffer_load_dwordx4 v7, s[12:15], s48 offen nt lds
    v_and_b32 v96, 15, v111
    v_lshrrev_b32 v97, 4, v111
    v_lshrrev_b32 v98, 3, v96
    v_and_b32 v99, 7, v96
    v_lshlrev_b32 v0, 7, v99
    v_bfe_u32 v99, v96, 1, 2
    v_lshlrev_b32 v99, 1, v99
    v_mul_u32_u24 v100, 5, v98
    v_xor_b32 v99, v99, v100
    v_xor_b32 v99, v99, v97
    v_lshl_add_u32 v0, v99, 4, v0
    v_mul_u32_u24 v100, 3072, v98
    v_add_u32 v0, v100, v0
    v_xor_b32 v1, 64, v0
    v_lshrrev_b32 v98, 1, v97
    v_mul_u32_u24 v2, 3072, v98
    v_and_b32 v99, 1, v97
    v_bfe_u32 v100, v111, 2, 2
    v_lshl_add_u32 v96, v99, 2, v100
    v_lshl_add_u32 v2, v96, 7, v2
    v_lshrrev_b32 v96, 1, v96
    v_lshlrev_b32 v96, 1, v96
    v_mul_u32_u24 v98, 5, v98
    v_xor_b32 v96, v96, v98
    v_bfe_u32 v99, v111, 1, 1
    v_xor_b32 v96, v96, v99
    v_lshl_add_u32 v2, v96, 4, v2
    v_and_b32 v99, 1, v111
    v_lshl_add_u32 v2, v99, 3, v2
    v_add_u32 v2, 24576, v2
    v_xor_b32 v3, 32, v2
    v_xor_b32 v4, 64, v2
    v_xor_b32 v5, 96, v2
    v_lshl_add_u32 v103, v111, 4, s38
    v_and_b32 v96, 15, v111
    v_lshrrev_b32 v98, 1, v111
    v_and_or_b32 v98, v98, 16, v96
    s_mov_b32 s42, 0x22110033
    v_bfe_i32 v97, s42, v98, 1
    v_and_b32 v97, 0x3f803f80, v97
    v_accvgpr_write_b32 a240, v97
    v_accvgpr_write_b32 a241, v97
    v_accvgpr_write_b32 a242, v97
    v_accvgpr_write_b32 a243, v97
    s_mov_b32 s42, 0x44110055
    v_bfe_i32 v97, s42, v98, 1
    v_and_b32 v97, 0x3f803f80, v97
    v_accvgpr_write_b32 a244, v97
    v_accvgpr_write_b32 a245, v97
    v_accvgpr_write_b32 a246, v97
    v_accvgpr_write_b32 a247, v97
    s_mov_b32 s42, 0x88898889
    v_bfe_i32 v97, s42, v98, 1
    v_and_b32 v97, 0x3f803f80, v97
    v_accvgpr_write_b32 a248, v97
    v_accvgpr_write_b32 a249, v97
    v_accvgpr_write_b32 a250, v97
    v_accvgpr_write_b32 a251, v97
    s_mov_b32 s42, 0x50005
    v_bfe_i32 v97, s42, v98, 1
    v_and_b32 v97, 0x3f803f80, v97
    v_accvgpr_write_b32 a252, v97
    v_accvgpr_write_b32 a253, v97
    v_accvgpr_write_b32 a254, v97
    v_accvgpr_write_b32 a255, v97
    v_bfe_i32 v97, v111, 2, 1
    v_and_b32 v97, 0xaaaa, v97
    v_or_b32 v101, 0x4444, v97
    s_waitcnt vmcnt(18)
    s_barrier
    s_waitcnt vmcnt(12)
    s_add_u32 s48, s34, 18432
    s_add_u32 m0, s38, 18432
    s_nop 0
    buffer_load_dwordx4 v6, s[12:15], s48 offen nt lds
    s_add_u32 m0, s38, 19456
    s_nop 0
    buffer_load_dwordx4 v7, s[12:15], s48 offen nt lds
    v_and_b32 v104, 0x3ff, v0
    v_lshrrev_b32 v105, 11, v0
    s_add_u32 s48, s34, 18560
    v_xor_b32 v105, s65, v105
    v_lshl_add_u32 v104, v105, 10, v104
    s_add_u32 m0, s38, 20480
    s_nop 0
    buffer_load_dwordx4 v6, s[12:15], s48 offen nt lds
    v_add_u32 v104, s38, v104
    ds_read_b128 a[232:235], v0 offset:2048
    s_add_u32 m0, s38, 21504
    ds_read_b128 a[96:99], v104 offset:0
    buffer_load_dwordx4 v7, s[12:15], s48 offen nt lds
    ds_read_b128 a[216:219], v0 offset:0
    s_add_u32 s48, s34, 18688
    s_add_u32 m0, s38, 22528
    v_xor_b32 v105, 64, v104
    buffer_load_dwordx4 v6, s[12:15], s48 offen nt lds
    s_add_u32 m0, s38, 23552
    ds_read_b128 a[104:107], v104 offset:2048
    ds_read_b128 a[100:103], v105 offset:0
    buffer_load_dwordx4 v7, s[12:15], s48 offen nt lds
    ds_read_b128 a[112:115], v104 offset:4096
    s_waitcnt lgkmcnt(3)
    v_mfma_f32_16x16x32_bf16 v[52:55], a[216:219], a[96:99], 0
    ds_read_b128 a[220:223], v1 offset:0
    s_waitcnt lgkmcnt(0)
    v_mfma_f32_16x16x32_bf16 v[52:55], a[220:223], a[100:103], v[52:55]
    ds_read_b128 a[108:111], v105 offset:2048
    ds_read_b128 a[224:227], v0 offset:1024
    ds_read_b128 a[228:231], v1 offset:1024
    ds_read_b128 a[116:119], v105 offset:4096
    s_waitcnt lgkmcnt(2)
    v_mfma_f32_16x16x32_bf16 v[52:55], a[224:227], a[104:107], v[52:55]
    s_waitcnt lgkmcnt(0)
    ds_read_b128 a[216:219], v0 offset:6144
    v_mfma_f32_16x16x32_bf16 v[52:55], a[228:231], a[108:111], v[52:55]
    ds_read_b128 a[236:239], v1 offset:2048
    v_mfma_f32_16x16x32_bf16 v[52:55], a[232:235], a[112:115], v[52:55]
    ds_read_b128 a[220:223], v1 offset:6144
    s_waitcnt lgkmcnt(1)
    v_mfma_f32_16x16x32_bf16 v[52:55], a[236:239], a[116:119], v[52:55]
    ds_read_b128 a[228:231], v1 offset:7168
    v_mfma_f32_16x16x32_bf16 v[56:59], a[216:219], a[96:99], 0
    s_waitcnt lgkmcnt(1)
    ds_read_b128 a[224:227], v0 offset:7168
    v_mfma_f32_16x16x32_bf16 v[56:59], a[220:223], a[100:103], v[56:59]
    ds_read_b128 a[216:219], v0 offset:12288
    s_waitcnt lgkmcnt(1)
    v_mfma_f32_16x16x32_bf16 v[56:59], a[224:227], a[104:107], v[56:59]
    ds_read_b128 a[232:235], v0 offset:8192
    v_mfma_f32_16x16x32_bf16 v[56:59], a[228:231], a[108:111], v[56:59]
    ds_read_b128 a[236:239], v1 offset:8192
    v_max3_f32 v96, v52, v53, v54
    s_waitcnt lgkmcnt(1)
    v_mfma_f32_16x16x32_bf16 v[56:59], a[232:235], a[112:115], v[56:59]
    ds_read_b128 a[224:227], v0 offset:13312
    s_waitcnt lgkmcnt(1)
    v_mfma_f32_16x16x32_bf16 v[56:59], a[236:239], a[116:119], v[56:59]
    ds_read_b128 a[228:231], v1 offset:13312
    s_nop 6
    v_max3_f32 v96, v96, v55, v56
    v_max3_f32 v96, v96, v57, v58
    v_max_f32 v96, v96, v59
    v_mov_b32 v97, v96
    s_nop 1
    v_permlane32_swap_b32 v97, v96
    v_max_f32 v96, v96, v97
    v_mov_b32 v97, v96
    s_nop 1
    v_permlane16_swap_b32 v97, v96
    ds_read_b128 a[220:223], v1 offset:12288
    v_max_f32 v96, v96, v97
    v_mul_f32_e64 v9, -s28, v96
    ds_read_b128 a[232:235], v0 offset:14336
    v_subrev_f32 v9, 0x42000000, v9
    v_fma_f32 v53, v53, s28, v9
    v_fma_f32 v52, v52, s28, v9
    v_fma_f32 v54, v54, s28, v9
    v_fma_f32 v59, v59, s28, v9
    v_exp_f32_e64 v53, v53 clamp
    v_fma_f32 v55, v55, s28, v9
    v_exp_f32_e64 v55, v55 clamp
    v_fma_f32 v57, v57, s28, v9
    v_exp_f32_e64 v52, v52 clamp
    s_nop 0
    v_cvt_pk_bf16_f32 v14, v52, v53
    v_exp_f32_e64 v54, v54 clamp
    v_fma_f32 v58, v58, s28, v9
    v_cvt_pk_bf16_f32 v15, v54, v55
    v_exp_f32_e64 v59, v59 clamp
    s_waitcnt vmcnt(12)
    s_add_u32 m0, s22, 24576
    ds_read_b128 a[236:239], v1 offset:14336
    buffer_load_dwordx4 v6, s[8:11], s21 offen lds
    s_add_u32 s21, s21, 128
    v_mfma_f32_16x16x32_bf16 v[52:55], a[216:219], a[96:99], 0
    s_add_u32 m0, s22, 25600
    ds_read_b128 a[128:131], v104 offset:8192
    buffer_load_dwordx4 v6, s[8:11], s21 offen lds
    s_add_u32 s21, s21, 128
    s_add_u32 m0, s22, 26624
    s_waitcnt lgkmcnt(2)
    v_mfma_f32_16x16x32_bf16 v[52:55], a[220:223], a[100:103], v[52:55]
    ds_read_b128 a[216:219], v0 offset:18432
    v_exp_f32_e64 v58, v58 clamp
    buffer_load_dwordx4 v6, s[8:11], s21 offen lds
    v_mfma_f32_16x16x32_bf16 v[52:55], a[224:227], a[104:107], v[52:55]
    ds_read_b128 a[224:227], v0 offset:19456
    v_mfma_f32_16x16x32_bf16 v[52:55], a[228:231], a[108:111], v[52:55]
    ds_read_b128 a[132:135], v105 offset:8192
    v_mfma_f32_16x16x32_bf16 v[52:55], a[232:235], a[112:115], v[52:55]
    ds_read_b128 a[140:143], v105 offset:10240
    v_fma_f32 v56, v56, s28, v9
    ds_read_b128 a[124:127], v105 offset:6144
    v_cvt_pk_bf16_f32 v17, v58, v59
    s_waitcnt lgkmcnt(6)
    v_mfma_f32_16x16x32_bf16 v[52:55], a[236:239], a[116:119], v[52:55]
    ds_read_b128 a[220:223], v1 offset:18432
    ds_read_b128 a[228:231], v1 offset:19456
    v_exp_f32_e64 v57, v57 clamp
    v_exp_f32_e64 v56, v56 clamp
    s_nop 0
    v_cvt_pk_bf16_f32 v16, v56, v57
    s_waitcnt lgkmcnt(6)
    v_mfma_f32_16x16x32_bf16 v[56:59], a[216:219], a[96:99], 0
    ds_read_b128 a[120:123], v104 offset:6144
    ds_read_b128 a[236:239], v1 offset:20480
    s_waitcnt lgkmcnt(3)
    v_mfma_f32_16x16x32_bf16 v[56:59], a[220:223], a[100:103], v[56:59]
    ds_read_b128 a[232:235], v0 offset:20480
    v_mfma_f32_16x16x32_bf16 v[56:59], a[224:227], a[104:107], v[56:59]
    s_waitcnt lgkmcnt(3)
    ds_read_b128 a[136:139], v104 offset:10240
    v_mfma_f32_16x16x32_bf16 v[56:59], a[228:231], a[108:111], v[56:59]
    s_add_u32 s21, s21, 12032
    ds_read_b128 a[224:227], v0 offset:1024
    s_waitcnt lgkmcnt(2)
    v_mfma_f32_16x16x32_bf16 v[56:59], a[232:235], a[112:115], v[56:59]
    ds_read_b128 a[220:223], v1 offset:0
    v_mfma_f32_16x16x32_bf16 v[56:59], a[236:239], a[116:119], v[56:59]
    ds_read_b128 a[232:235], v0 offset:2048
    ds_read_b128 a[216:219], v0 offset:0
    s_waitcnt lgkmcnt(0)
    v_mfma_f32_16x16x32_bf16 v[60:63], a[216:219], a[120:123], 0
    ds_read_b128 a[236:239], v1 offset:2048
    v_mfma_f32_16x16x32_bf16 v[60:63], a[220:223], a[124:127], v[60:63]
    ds_read_b128 a[228:231], v1 offset:1024
    v_mfma_f32_16x16x32_bf16 v[60:63], a[224:227], a[128:131], v[60:63]
    ds_read_b128 a[216:219], v0 offset:6144
    s_waitcnt lgkmcnt(1)
    v_mfma_f32_16x16x32_bf16 v[60:63], a[228:231], a[132:135], v[60:63]
    ds_read_b128 a[224:227], v0 offset:7168
    v_mfma_f32_16x16x32_bf16 v[60:63], a[232:235], a[136:139], v[60:63]
    ds_read_b128 a[220:223], v1 offset:6144
    v_mfma_f32_16x16x32_bf16 v[60:63], a[236:239], a[140:143], v[60:63]
    s_waitcnt lgkmcnt(2)
    ds_read_b128 a[236:239], v1 offset:8192
    v_mfma_f32_16x16x32_bf16 v[64:67], a[216:219], a[120:123], 0
    ds_read_b128 a[232:235], v0 offset:8192
    v_fma_f32 v54, v54, s28, v9
    s_waitcnt lgkmcnt(2)
    v_mfma_f32_16x16x32_bf16 v[64:67], a[220:223], a[124:127], v[64:67]
    ds_read_b128 a[228:231], v1 offset:7168
    v_max3_f32 v98, v60, v61, v62
    v_mfma_f32_16x16x32_bf16 v[64:67], a[224:227], a[128:131], v[64:67]
    ds_read_b128 a[216:219], v0 offset:12288
    v_fma_f32 v52, v52, s28, v9
    s_waitcnt lgkmcnt(1)
    v_mfma_f32_16x16x32_bf16 v[64:67], a[228:231], a[132:135], v[64:67]
    ds_read_b128 a[224:227], v0 offset:13312
    v_mfma_f32_16x16x32_bf16 v[64:67], a[232:235], a[136:139], v[64:67]
    ds_read_b128 a[220:223], v1 offset:12288
    v_mfma_f32_16x16x32_bf16 v[64:67], a[236:239], a[140:143], v[64:67]
    s_nop 7
    v_max3_f32 v98, v98, v63, v64
    v_max3_f32 v98, v98, v65, v66
    ds_read_b128 a[228:231], v1 offset:13312
    v_max_f32 v98, v98, v67
    v_mov_b32 v99, v98
    s_nop 1
    v_permlane32_swap_b32 v99, v98
    v_max_f32 v98, v98, v99
    v_mov_b32 v99, v98
    v_fma_f32 v53, v53, s28, v9
    s_nop 0
    v_permlane16_swap_b32 v99, v98
    ds_read_b128 a[232:235], v0 offset:14336
    v_max_f32 v98, v98, v99
    v_mul_f32_e64 v10, -s28, v98
    v_subrev_f32 v10, 0x42000000, v10
    v_fma_f32 v55, v55, s28, v9
    v_fma_f32 v67, v67, s28, v10
    v_fma_f32 v63, v63, s28, v10
    v_fma_f32 v60, v60, s28, v10
    v_fma_f32 v61, v61, s28, v10
    v_exp_f32_e64 v63, v63 clamp
    v_exp_f32_e64 v67, v67 clamp
    v_fma_f32 v62, v62, s28, v10
    v_exp_f32_e64 v61, v61 clamp
    v_exp_f32_e64 v62, v62 clamp
    v_exp_f32_e64 v60, v60 clamp
    v_cvt_pk_bf16_f32 v23, v62, v63
    v_fma_f32 v65, v65, s28, v10
    v_cvt_pk_bf16_f32 v22, v60, v61
    s_waitcnt lgkmcnt(1)
    v_mfma_f32_16x16x32_bf16 v[60:63], a[216:219], a[120:123], 0
    ds_read_b128 a[236:239], v1 offset:14336
    s_waitcnt vmcnt(9)
    s_add_u32 m0, s22, 36864
    ds_read_b128 a[144:147], v104 offset:12288
    buffer_load_dwordx4 v6, s[8:11], s21 offen lds
    s_add_u32 s21, s21, 128
    v_mfma_f32_16x16x32_bf16 v[60:63], a[220:223], a[124:127], v[60:63]
    s_add_u32 m0, s22, 37888
    ds_read_b128 a[216:219], v0 offset:18432
    buffer_load_dwordx4 v6, s[8:11], s21 offen lds
    v_fma_f32 v66, v66, s28, v10
    ds_read_b128 a[164:167], v105 offset:16384
    s_add_u32 s21, s21, 128
    v_mfma_f32_16x16x32_bf16 v[60:63], a[224:227], a[128:131], v[60:63]
    s_add_u32 m0, s22, 38912
    ds_read_b128 a[148:151], v105 offset:12288
    buffer_load_dwordx4 v6, s[8:11], s21 offen lds
    v_exp_f32_e64 v65, v65 clamp
    v_mfma_f32_16x16x32_bf16 v[60:63], a[228:231], a[132:135], v[60:63]
    ds_read_b128 a[224:227], v0 offset:19456
    v_fma_f32 v64, v64, s28, v10
    v_exp_f32_e64 v64, v64 clamp
    v_exp_f32_e64 v66, v66 clamp
    v_mfma_f32_16x16x32_bf16 v[44:47], a[248:251], v[14:17], 0
    v_exp_f32_e64 v55, v55 clamp
    v_exp_f32_e64 v54, v54 clamp
    v_cvt_pk_bf16_f32 v24, v64, v65
    ds_read_b128 a[160:163], v104 offset:16384
    s_waitcnt lgkmcnt(5)
    v_mfma_f32_16x16x32_bf16 v[60:63], a[232:235], a[136:139], v[60:63]
    v_cvt_pk_bf16_f32 v25, v66, v67
    ds_read_b128 a[232:235], v0 offset:20480
    v_mfma_f32_16x16x32_bf16 v[60:63], a[236:239], a[140:143], v[60:63]
    s_waitcnt lgkmcnt(5)
    ds_read_b128 a[220:223], v1 offset:18432
    v_mfma_f32_16x16x32_bf16 v[64:67], a[216:219], a[120:123], 0
    ds_read_b128 a[228:231], v1 offset:19456
    s_waitcnt lgkmcnt(1)
    v_mfma_f32_16x16x32_bf16 v[64:67], a[220:223], a[124:127], v[64:67]
    ds_read_b128 a[216:219], v0 offset:0
    ds_read_b128 a[156:159], v105 offset:14336
    v_fma_f32 v60, v60, s28, v10
    v_mfma_f32_16x16x32_bf16 v[64:67], a[224:227], a[128:131], v[64:67]
    s_waitcnt lgkmcnt(2)
    ds_read_b128 a[236:239], v1 offset:20480
    v_mfma_f32_16x16x32_bf16 v[64:67], a[228:231], a[132:135], v[64:67]
    ds_read_b128 a[220:223], v1 offset:0
    v_mfma_f32_16x16x32_bf16 v[64:67], a[232:235], a[136:139], v[64:67]
    ds_read_b128 a[224:227], v0 offset:1024
    s_waitcnt lgkmcnt(2)
    v_mfma_f32_16x16x32_bf16 v[64:67], a[236:239], a[140:143], v[64:67]
    ds_read_b128 a[232:235], v0 offset:2048
    v_mfma_f32_16x16x32_bf16 v[68:71], a[216:219], a[144:147], 0
    s_waitcnt lgkmcnt(2)
    ds_read_b128 a[228:231], v1 offset:1024
    v_mfma_f32_16x16x32_bf16 v[68:71], a[220:223], a[148:151], v[68:71]
    ds_read_b128 a[152:155], v104 offset:14336
    s_waitcnt lgkmcnt(0)
    v_mfma_f32_16x16x32_bf16 v[68:71], a[224:227], a[152:155], v[68:71]
    ds_read_b128 a[224:227], v0 offset:7168
    ds_read_b128 a[216:219], v0 offset:6144
    v_mfma_f32_16x16x32_bf16 v[68:71], a[228:231], a[156:159], v[68:71]
    ds_read_b128 a[236:239], v1 offset:2048
    v_mfma_f32_16x16x32_bf16 v[68:71], a[232:235], a[160:163], v[68:71]
    v_exp_f32_e64 v60, v60 clamp
    v_cvt_pk_bf16_f32 v19, v54, v55
    ds_read_b128 a[220:223], v1 offset:6144
    s_waitcnt lgkmcnt(1)
    v_mfma_f32_16x16x32_bf16 v[68:71], a[236:239], a[164:167], v[68:71]
    ds_read_b128 a[236:239], v1 offset:8192
    v_mfma_f32_16x16x32_bf16 v[72:75], a[216:219], a[144:147], 0
    ds_read_b128 a[232:235], v0 offset:8192
    s_waitcnt lgkmcnt(2)
    v_mfma_f32_16x16x32_bf16 v[72:75], a[220:223], a[148:151], v[72:75]
    ds_read_b128 a[228:231], v1 offset:7168
    v_mfma_f32_16x16x32_bf16 v[72:75], a[224:227], a[152:155], v[72:75]
    ds_read_b128 a[224:227], v0 offset:13312
    v_exp_f32_e64 v52, v52 clamp
    s_waitcnt lgkmcnt(1)
    v_mfma_f32_16x16x32_bf16 v[72:75], a[228:231], a[156:159], v[72:75]
    v_max3_f32 v96, v68, v69, v70
    v_fma_f32 v61, v61, s28, v10
    ds_read_b128 a[216:219], v0 offset:12288
    v_mfma_f32_16x16x32_bf16 v[72:75], a[232:235], a[160:163], v[72:75]
    ds_read_b128 a[232:235], v0 offset:14336
    v_mfma_f32_16x16x32_bf16 v[72:75], a[236:239], a[164:167], v[72:75]
    s_nop 7
    v_max3_f32 v96, v96, v71, v72
    v_max3_f32 v96, v96, v73, v74
    v_max_f32 v96, v96, v75
    v_mov_b32 v97, v96
    ds_read_b128 a[220:223], v1 offset:12288
    s_nop 0
    v_permlane32_swap_b32 v97, v96
    v_max_f32 v96, v96, v97
    s_add_u32 s21, s21, 12032
    v_mov_b32 v97, v96
    s_nop 1
    v_permlane16_swap_b32 v97, v96
    v_max_f32 v96, v96, v97
    v_mul_f32_e64 v11, -s28, v96
    v_subrev_f32 v11, 0x42000000, v11
    v_fma_f32 v74, v74, s28, v11
    v_fma_f32 v72, v72, s28, v11
    v_fma_f32 v68, v68, s28, v11
    v_fma_f32 v75, v75, s28, v11
    v_fma_f32 v71, v71, s28, v11
    v_fma_f32 v69, v69, s28, v11
    v_fma_f32 v70, v70, s28, v11
    v_exp_f32_e64 v69, v69 clamp
    v_exp_f32_e64 v68, v68 clamp
    v_exp_f32_e64 v70, v70 clamp
    v_exp_f32_e64 v75, v75 clamp
    v_cvt_pk_bf16_f32 v26, v68, v69
    v_exp_f32_e64 v71, v71 clamp
    ds_read_b128 a[228:231], v1 offset:13312
    v_exp_f32_e64 v53, v53 clamp
    v_cvt_pk_bf16_f32 v27, v70, v71
    v_fma_f32 v73, v73, s28, v11
    s_waitcnt lgkmcnt(1)
    v_mfma_f32_16x16x32_bf16 v[68:71], a[216:219], a[144:147], 0
    ds_read_b128 a[216:219], v0 offset:18432
    v_exp_f32_e64 v72, v72 clamp
    v_mfma_f32_16x16x32_bf16 v[68:71], a[220:223], a[148:151], v[68:71]
    ds_read_b128 a[236:239], v1 offset:14336
    v_exp_f32_e64 v73, v73 clamp
    v_exp_f32_e64 v61, v61 clamp
    v_mfma_f32_16x16x32_bf16 v[68:71], a[224:227], a[152:155], v[68:71]
    ds_read_b128 a[224:227], v0 offset:19456
    v_cvt_pk_bf16_f32 v28, v72, v73
    s_waitcnt lgkmcnt(3)
    v_mfma_f32_16x16x32_bf16 v[68:71], a[228:231], a[156:159], v[68:71]
    ds_read_b128 a[220:223], v1 offset:18432
    s_waitcnt vmcnt(6)
    v_exp_f32_e64 v74, v74 clamp
    v_mfma_f32_16x16x32_bf16 v[68:71], a[232:235], a[160:163], v[68:71]
    ds_read_b128 a[184:187], v104 offset:22528
    v_cvt_pk_bf16_f32 v29, v74, v75
    v_cvt_pk_bf16_f32 v18, v52, v53
    s_nop 0
    v_smfmac_f32_16x16x64_bf16 v[44:47], a[240:243], v[22:29], v101
    s_waitcnt lgkmcnt(3)
    ds_read_b128 a[180:183], v105 offset:20480
    ds_read_b128 a[228:231], v1 offset:19456
    v_mfma_f32_16x16x32_bf16 v[68:71], a[236:239], a[164:167], v[68:71]
    ds_read_b128 a[168:171], v104 offset:18432
    v_mfma_f32_16x16x32_bf16 v[72:75], a[216:219], a[144:147], 0
    ds_read_b128 a[176:179], v104 offset:20480
    ds_read_b128 a[236:239], v1 offset:20480
    ds_read_b128 a[232:235], v0 offset:20480
    s_waitcnt lgkmcnt(7)
    v_mfma_f32_16x16x32_bf16 v[72:75], a[220:223], a[148:151], v[72:75]
    ds_read_b128 a[220:223], v1 offset:0
    v_mfma_f32_16x16x32_bf16 v[72:75], a[224:227], a[152:155], v[72:75]
    ds_read_b128 a[216:219], v0 offset:0
    s_waitcnt lgkmcnt(6)
    v_mfma_f32_16x16x32_bf16 v[72:75], a[228:231], a[156:159], v[72:75]
    ds_read_b128 a[172:175], v105 offset:18432
    s_waitcnt lgkmcnt(3)
    v_mfma_f32_16x16x32_bf16 v[72:75], a[232:235], a[160:163], v[72:75]
    ds_read_b128 a[228:231], v1 offset:1024
    ds_read_b128 a[224:227], v0 offset:1024
    v_mfma_f32_16x16x32_bf16 v[72:75], a[236:239], a[164:167], v[72:75]
    ds_read_b128 a[232:235], v0 offset:2048
    s_waitcnt lgkmcnt(4)
    v_mfma_f32_16x16x32_bf16 v[76:79], a[216:219], a[168:171], 0
    ds_read_b128 a[236:239], v1 offset:2048
    ds_read_b128 a[188:191], v105 offset:22528
    s_waitcnt lgkmcnt(5)
    v_mfma_f32_16x16x32_bf16 v[76:79], a[220:223], a[172:175], v[76:79]
    ds_read_b128 a[216:219], v0 offset:6144
    s_waitcnt lgkmcnt(4)
    v_mfma_f32_16x16x32_bf16 v[76:79], a[224:227], a[176:179], v[76:79]
    ds_read_b128 a[220:223], v1 offset:6144
    v_mfma_f32_16x16x32_bf16 v[76:79], a[228:231], a[180:183], v[76:79]
    s_waitcnt lgkmcnt(4)
    v_mfma_f32_16x16x32_bf16 v[76:79], a[232:235], a[184:187], v[76:79]
    ds_read_b128 a[224:227], v0 offset:7168
    ds_read_b128 a[228:231], v1 offset:7168
    s_waitcnt lgkmcnt(4)
    v_mfma_f32_16x16x32_bf16 v[76:79], a[236:239], a[188:191], v[76:79]
    ds_read_b128 a[232:235], v0 offset:8192
    ds_read_b128 a[236:239], v1 offset:8192
    s_waitcnt lgkmcnt(5)
    v_mfma_f32_16x16x32_bf16 v[80:83], a[216:219], a[168:171], 0
    s_waitcnt lgkmcnt(4)
    v_mfma_f32_16x16x32_bf16 v[80:83], a[220:223], a[172:175], v[80:83]
    s_waitcnt lgkmcnt(3)
    v_mfma_f32_16x16x32_bf16 v[80:83], a[224:227], a[176:179], v[80:83]
    s_waitcnt lgkmcnt(2)
    v_max3_f32 v98, v76, v77, v78
    v_mfma_f32_16x16x32_bf16 v[80:83], a[228:231], a[180:183], v[80:83]
    s_waitcnt vmcnt(63) lgkmcnt(0)
    s_barrier
    ds_read_b128 a[216:219], v0 offset:12288
    v_mfma_f32_16x16x32_bf16 v[80:83], a[232:235], a[184:187], v[80:83]
    s_add_u32 m0, s22, 0
    ds_read_b128 a[220:223], v1 offset:12288
    buffer_load_dwordx4 v6, s[4:7], s20 offen lds
    v_mfma_f32_16x16x32_bf16 v[80:83], a[236:239], a[188:191], v[80:83]
    s_add_u32 s20, s20, 128
    s_add_u32 m0, s22, 1024
    ds_read_b128 a[224:227], v0 offset:13312
    buffer_load_dwordx4 v6, s[4:7], s20 offen lds
    ds_read_b128 a[236:239], v1 offset:14336
    ds_read_b128 a[232:235], v0 offset:14336
    ds_read_b128 a[228:231], v1 offset:13312
    s_nop 0
    v_max3_f32 v98, v98, v79, v80
    v_max3_f32 v98, v98, v81, v82
    v_max_f32 v98, v98, v83
    v_mov_b32 v99, v98
    s_add_u32 s20, s20, 128
    s_nop 0
    v_permlane32_swap_b32 v99, v98
    v_max_f32 v98, v98, v99
    v_mov_b32 v99, v98
    s_add_u32 m0, s22, 2048
    s_nop 0
    v_permlane16_swap_b32 v99, v98
    v_max_f32 v98, v98, v99
    v_mul_f32_e64 v12, -s28, v98
    v_subrev_f32 v12, 0x42000000, v12
    v_fma_f32 v78, v78, s28, v12
    v_fma_f32 v77, v77, s28, v12
    v_fma_f32 v80, v80, s28, v12
    v_exp_f32_e64 v77, v77 clamp
    v_fma_f32 v79, v79, s28, v12
    v_fma_f32 v76, v76, s28, v12
    v_exp_f32_e64 v78, v78 clamp
    v_exp_f32_e64 v76, v76 clamp
    v_fma_f32 v81, v81, s28, v12
    v_exp_f32_e64 v79, v79 clamp
    v_exp_f32_e64 v81, v81 clamp
    v_cvt_pk_bf16_f32 v34, v76, v77
    v_cvt_pk_bf16_f32 v35, v78, v79
    v_fma_f32 v82, v82, s28, v12
    s_waitcnt lgkmcnt(0)
    v_mfma_f32_16x16x32_bf16 v[76:79], a[216:219], a[168:171], 0
    buffer_load_dwordx4 v6, s[4:7], s20 offen lds
    ds_read_b128 a[216:219], v0 offset:18432
    v_mfma_f32_16x16x32_bf16 v[76:79], a[220:223], a[172:175], v[76:79]
    s_add_u32 s20, s20, 12032
    s_mov_b32 s39, s64
    s_add_u32 s37, s37, 1
    ds_read_b128 a[220:223], v1 offset:18432
    v_mfma_f32_16x16x32_bf16 v[76:79], a[224:227], a[176:179], v[76:79]
    s_bitcmp1_b32 s63, s37
    s_cselect_b32 s62, 4294770688, 0
    ds_read_b128 a[224:227], v0 offset:19456
    v_mfma_f32_16x16x32_bf16 v[76:79], a[228:231], a[180:183], v[76:79]
    s_cselect_b32 s42, 0, 325632
    s_add_u32 s35, s35, s42
    s_lshl_b32 s42, s37, 1
    ds_read_b128 a[228:231], v1 offset:19456
    v_mfma_f32_16x16x32_bf16 v[76:79], a[232:235], a[184:187], v[76:79]
    s_lshr_b32 s42, s31, s42
    s_and_b32 s42, s42, 3
    s_add_u32 s42, s42, s36
    ds_read_b128 a[232:235], v0 offset:20480
    v_mfma_f32_16x16x32_bf16 v[76:79], a[236:239], a[188:191], v[76:79]
    s_sub_u32 s43, s42, 3
    s_cmp_ge_u32 s42, 3
    ds_read_b128 a[236:239], v1 offset:20480
    s_cselect_b32 s42, s43, s42
    s_mul_i32 s44, s3, 5
    s_mov_b32 s32, 1
    s_lshl_b32 s43, s3, 2
    s_add_u32 s45, s43, 21
    s_cmp_eq_u32 s3, 0
    s_cselect_b32 s45, 20, s45
    s_cselect_b32 s33, 1, 0
    v_fma_f32 v83, v83, s28, v12
    s_cmp_eq_u32 s42, 1
    s_cselect_b32 s44, s45, s44
    s_cselect_b32 s32, s33, s32
    s_add_u32 s45, s43, 37
    s_cmp_eq_u32 s42, 2
    v_exp_f32_e64 v80, v80 clamp
    s_cselect_b32 s44, s45, s44
    s_cselect_b32 s32, 0, s32
    s_mul_i32 s44, s44, 6144
    s_add_u32 s33, s35, s44
    v_exp_f32_e64 v82, v82 clamp
    v_cvt_pk_bf16_f32 v36, v80, v81
    s_mul_i32 s42, s32, 6144
    s_add_u32 s42, s42, 24576
    v_exp_f32_e64 v83, v83 clamp
    s_add_u32 s42, s42, s33
    s_cmp_ge_u32 s37, 6
    s_cselect_b32 s14, 0, s42
    s_add_u32 s24, s67, 6144
    s_add_u32 s25, s33, 6144
    s_add_u32 s23, s38, 6144
    s_mov_b32 s27, 0x30c30
    s_mov_b32 s89, 0xaaaaaaaa
    s_mov_b32 s30, 0
    v_cvt_pk_bf16_f32 v37, v82, v83
    s_waitcnt vmcnt(6) lgkmcnt(0)
    v_mfma_f32_16x16x32_bf16 v[80:83], a[216:219], a[168:171], 0
    s_barrier
    ds_read_b64_tr_b16 a[216:217], v2 offset:0
    ds_read_b64_tr_b16 a[218:219], v2 offset:6144
    s_add_u32 m0, s22, 12288
    v_mfma_f32_16x16x32_bf16 v[80:83], a[220:223], a[172:175], v[80:83]
    ds_read_b64_tr_b16 a[220:221], v3 offset:0
    buffer_load_dwordx4 v6, s[4:7], s20 offen lds
    ds_read_b64_tr_b16 a[222:223], v3 offset:6144
    v_mfma_f32_16x16x32_bf16 v[80:83], a[224:227], a[176:179], v[80:83]
    s_add_u32 s20, s20, 128
    ds_read_b64_tr_b16 a[224:225], v4 offset:0
    v_mfma_f32_16x16x32_bf16 v[44:47], a[252:255], v[34:37], v[44:47]
    s_add_u32 m0, s22, 13312
    s_nop 0
    buffer_load_dwordx4 v6, s[4:7], s20 offen lds
    s_add_u32 s20, s20, 128
    s_add_u32 m0, s22, 14336
    ds_read_b64_tr_b16 a[226:227], v4 offset:6144
    v_mfma_f32_16x16x32_bf16 v[80:83], a[228:231], a[180:183], v[80:83]
    ds_read_b64_tr_b16 a[228:229], v5 offset:0
    v_mfma_f32_16x16x32_bf16 v[80:83], a[232:235], a[184:187], v[80:83]
    buffer_load_dwordx4 v6, s[4:7], s20 offen lds
    ds_read_b64_tr_b16 a[230:231], v5 offset:6144
    v_mfma_f32_16x16x32_bf16 v[80:83], a[236:239], a[188:191], v[80:83]
    s_add_u32 s20, s20, 12032
    s_waitcnt lgkmcnt(6)
    v_mfma_f32_16x16x32_bf16 v[112:115], a[216:219], v[14:17], 0
    ds_read_b64_tr_b16 a[234:235], v2 offset:7168
    v_fma_f32 v64, v64, s28, v10
    v_mfma_f32_16x16x32_bf16 v[160:163], a[216:219], v[22:25], 0
    v_fma_f32 v63, v63, s28, v10
    v_fma_f32 v58, v58, s28, v9
    v_fma_f32 v56, v56, s28, v9
    v_mfma_f32_16x16x32_bf16 v[208:211], a[216:219], v[26:29], 0
    v_fma_f32 v82, v82, s28, v12
    v_fma_f32 v80, v80, s28, v12
    v_mfma_f32_16x16x32_bf16 a[0:3], a[216:219], v[34:37], 0
    v_fma_f32 v81, v81, s28, v12
    s_waitcnt lgkmcnt(5)
    v_mfma_f32_16x16x32_bf16 a[4:7], a[220:223], v[34:37], 0
    v_exp_f32_e64 v63, v63 clamp
    v_mfma_f32_16x16x32_bf16 v[212:215], a[220:223], v[26:29], 0
    ds_read_b64_tr_b16 a[232:233], v2 offset:1024
    v_mov_b32 v51, 0
    v_mfma_f32_16x16x32_bf16 v[164:167], a[220:223], v[22:25], 0
    ds_read_b64_tr_b16 a[238:239], v3 offset:7168
    v_fma_f32 v74, v74, s28, v11
    v_mfma_f32_16x16x32_bf16 v[116:119], a[220:223], v[14:17], 0
    v_mov_b32 v39, v7
    s_waitcnt lgkmcnt(5)
    v_mfma_f32_16x16x32_bf16 v[120:123], a[224:227], v[14:17], 0
    ds_read_b64_tr_b16 a[236:237], v3 offset:1024
    v_fma_f32 v78, v78, s28, v12
    v_mfma_f32_16x16x32_bf16 v[168:171], a[224:227], v[22:25], 0
    ds_read_b64_tr_b16 a[216:217], v4 offset:1024
    v_fma_f32 v83, v83, s28, v12
    v_mfma_f32_16x16x32_bf16 v[216:219], a[224:227], v[26:29], 0
    ds_read_b64_tr_b16 a[222:223], v5 offset:7168
    v_fma_f32 v59, v59, s28, v9
    v_mfma_f32_16x16x32_bf16 a[8:11], a[224:227], v[34:37], 0
    s_waitcnt lgkmcnt(5)
    ds_read_b64_tr_b16 a[218:219], v4 offset:7168
    v_fma_f32 v70, v70, s28, v11
    v_mfma_f32_16x16x32_bf16 a[12:15], a[228:231], v[34:37], 0
    v_fma_f32 v62, v62, s28, v10
    v_fma_f32 v73, v73, s28, v11
    v_mfma_f32_16x16x32_bf16 v[220:223], a[228:231], v[26:29], 0
    v_fma_f32 v66, v66, s28, v10
    v_fma_f32 v72, v72, s28, v11
    v_mfma_f32_16x16x32_bf16 v[172:175], a[228:231], v[22:25], 0
    v_exp_f32_e64 v58, v58 clamp
    v_mfma_f32_16x16x32_bf16 v[124:127], a[228:231], v[14:17], 0
    s_waitcnt lgkmcnt(5)
    v_exp_f32_e64 v70, v70 clamp
    v_mfma_f32_16x16x32_bf16 v[128:131], a[232:235], v[14:17], 0
    ds_read_b64_tr_b16 a[220:221], v5 offset:1024
    v_fma_f32 v79, v79, s28, v12
    v_mfma_f32_16x16x32_bf16 v[176:179], a[232:235], v[22:25], 0
    ds_read_b64_tr_b16 a[226:227], v2 offset:8192
    v_fma_f32 v76, v76, s28, v12
    v_mfma_f32_16x16x32_bf16 v[224:227], a[232:235], v[26:29], 0
    ds_read_b64_tr_b16 a[224:225], v2 offset:2048
    v_fma_f32 v77, v77, s28, v12
    v_mfma_f32_16x16x32_bf16 a[16:19], a[232:235], v[34:37], 0
    s_waitcnt lgkmcnt(5)
    ds_read_b64_tr_b16 a[232:233], v4 offset:2048
    v_fma_f32 v71, v71, s28, v11
    v_mfma_f32_16x16x32_bf16 a[20:23], a[236:239], v[34:37], 0
    ds_read_b64_tr_b16 a[234:235], v4 offset:8192
    v_mfma_f32_16x16x32_bf16 v[228:231], a[236:239], v[26:29], 0
    s_add_u32 s39, s39, 12288
    ds_read_b64_tr_b16 a[228:229], v3 offset:2048
    v_fma_f32 v75, v75, s28, v11
    v_mfma_f32_16x16x32_bf16 v[180:183], a[236:239], v[22:25], 0
    v_exp_f32_e64 v66, v66 clamp
    v_mfma_f32_16x16x32_bf16 v[132:135], a[236:239], v[14:17], 0
    s_waitcnt lgkmcnt(6)
    ds_read_b64_tr_b16 a[230:231], v3 offset:8192
    ds_read_b64_tr_b16 a[238:239], v5 offset:8192
    v_mfma_f32_16x16x32_bf16 v[136:139], a[216:219], v[14:17], 0
    ds_read_b64_tr_b16 a[236:237], v5 offset:2048
    v_fma_f32 v65, v65, s28, v10
    v_mfma_f32_16x16x32_bf16 v[184:187], a[216:219], v[22:25], 0
    v_fma_f32 v67, v67, s28, v10
    v_mov_b32 v49, 0
    v_mfma_f32_16x16x32_bf16 v[232:235], a[216:219], v[26:29], 0
    v_exp_f32_e64 v79, v79 clamp
    v_mfma_f32_16x16x32_bf16 a[24:27], a[216:219], v[34:37], 0
    s_waitcnt lgkmcnt(7)
    v_exp_f32_e64 v62, v62 clamp
    v_mfma_f32_16x16x32_bf16 a[28:31], a[220:223], v[34:37], 0
    v_fma_f32 v69, v69, s28, v11
    v_mov_b32 v38, v6
    v_mfma_f32_16x16x32_bf16 v[236:239], a[220:223], v[26:29], 0
    v_exp_f32_e64 v77, v77 clamp
    v_mfma_f32_16x16x32_bf16 v[188:191], a[220:223], v[22:25], 0
    v_exp_f32_e64 v71, v71 clamp
    v_mfma_f32_16x16x32_bf16 v[140:143], a[220:223], v[14:17], 0
    s_waitcnt lgkmcnt(3)
    v_exp_f32_e64 v74, v74 clamp
    v_mfma_f32_16x16x32_bf16 v[144:147], a[224:227], v[14:17], 0
    v_exp_f32_e64 v69, v69 clamp
    v_mfma_f32_16x16x32_bf16 v[192:195], a[224:227], v[22:25], 0
    v_exp_f32_e64 v81, v81 clamp
    v_mfma_f32_16x16x32_bf16 v[240:243], a[224:227], v[26:29], 0
    v_fma_f32 v68, v68, s28, v11
    s_waitcnt vmcnt(3) lgkmcnt(0)
    v_mfma_f32_16x16x32_bf16 a[32:35], a[224:227], v[34:37], 0
    s_barrier
    v_mfma_f32_16x16x32_bf16 a[36:39], a[228:231], v[34:37], 0
    s_add_u32 m0, s22, 24576
    ds_read_b128 a[220:223], v1 offset:0
    v_fma_f32 v57, v57, s28, v9
    v_mfma_f32_16x16x32_bf16 v[244:247], a[228:231], v[26:29], 0
    ds_read_b128 a[216:219], v0 offset:0
    v_cvt_pk_bf16_f32 v31, v70, v71
    v_mfma_f32_16x16x32_bf16 v[196:199], a[228:231], v[22:25], 0
    buffer_load_dwordx4 v6, s[8:11], s21 offen lds
    v_mfma_f32_16x16x32_bf16 v[148:151], a[228:231], v[14:17], 0
    s_add_u32 s21, s21, 128
    ds_read_b128 a[224:227], v0 offset:1024
    v_mov_b32 v50, 0
    v_mfma_f32_16x16x32_bf16 v[152:155], a[232:235], v[14:17], 0
    v_exp_f32_e64 v76, v76 clamp
    v_mfma_f32_16x16x32_bf16 v[200:203], a[232:235], v[22:25], 0
    v_exp_f32_e64 v68, v68 clamp
    v_mfma_f32_16x16x32_bf16 v[248:251], a[232:235], v[26:29], 0
    s_add_u32 m0, s22, 25600
    v_exp_f32_e64 v78, v78 clamp
    v_mfma_f32_16x16x32_bf16 a[40:43], a[232:235], v[34:37], 0
    buffer_load_dwordx4 v6, s[8:11], s21 offen lds
    v_mfma_f32_16x16x32_bf16 a[44:47], a[236:239], v[34:37], 0
    s_add_u32 s21, s21, 128
    v_exp_f32_e64 v67, v67 clamp
    v_mfma_f32_16x16x32_bf16 v[252:255], a[236:239], v[26:29], 0
    s_add_u32 m0, s22, 26624
    v_exp_f32_e64 v59, v59 clamp
    v_mfma_f32_16x16x32_bf16 v[204:207], a[236:239], v[22:25], 0
    buffer_load_dwordx4 v6, s[8:11], s21 offen lds
    v_mfma_f32_16x16x32_bf16 v[156:159], a[236:239], v[14:17], 0
    s_waitcnt lgkmcnt(1)
    ds_read_b128 a[232:235], v0 offset:2048
    v_cvt_pk_bf16_f32 v34, v76, v77
    v_mfma_f32_16x16x32_bf16 v[52:55], a[216:219], a[96:99], 0
    s_add_u32 s21, s21, 12032
    ds_read_b128 a[236:239], v1 offset:2048
    v_cvt_pk_bf16_f32 v30, v68, v69
    v_mfma_f32_16x16x32_bf16 v[52:55], a[220:223], a[100:103], v[52:55]
    s_waitcnt lgkmcnt(2)
    ds_read_b128 a[228:231], v1 offset:1024
    v_cvt_pk_bf16_f32 v22, v60, v61
    v_mfma_f32_16x16x32_bf16 v[52:55], a[224:227], a[104:107], v[52:55]
    v_cvt_pk_bf16_f32 v23, v62, v63
    v_cvt_pk_bf16_f32 v35, v78, v79
    v_mfma_f32_16x16x32_bf16 v[60:63], a[224:227], a[128:131], 0
    v_exp_f32_e64 v75, v75 clamp
    v_mfma_f32_16x16x32_bf16 v[60:63], a[220:223], a[124:127], v[60:63]
    s_add_u32 m0, s38, 0
    v_exp_f32_e64 v64, v64 clamp
    v_mfma_f32_16x16x32_bf16 v[60:63], a[216:219], a[120:123], v[60:63]
    v_add_u32 v103, 6144, v103
    v_mov_b32 v48, 0
    v_mfma_f32_16x16x32_bf16 v[68:71], a[216:219], a[144:147], 0
    buffer_load_dwordx4 v6, s[12:15], s33 offen nt lds
    v_mfma_f32_16x16x32_bf16 v[68:71], a[220:223], a[148:151], v[68:71]
    v_exp_f32_e64 v80, v80 clamp
    v_mfma_f32_16x16x32_bf16 v[68:71], a[224:227], a[152:155], v[68:71]
    s_add_u32 m0, s38, 1024
    v_exp_f32_e64 v82, v82 clamp
    v_mfma_f32_16x16x32_bf16 v[76:79], a[224:227], a[176:179], 0
    v_exp_f32_e64 v83, v83 clamp
    v_mfma_f32_16x16x32_bf16 v[76:79], a[220:223], a[172:175], v[76:79]
    v_exp_f32_e64 v72, v72 clamp
    v_mfma_f32_16x16x32_bf16 v[76:79], a[216:219], a[168:171], v[76:79]
    s_waitcnt lgkmcnt(0)
    ds_read_b128 a[224:227], v0 offset:7168
    v_cvt_pk_bf16_f32 v33, v82, v83
    v_mfma_f32_16x16x32_bf16 v[76:79], a[228:231], a[180:183], v[76:79]
    buffer_load_dwordx4 v7, s[12:15], s33 offen nt lds
    v_mfma_f32_16x16x32_bf16 v[76:79], a[232:235], a[184:187], v[76:79]
    ds_read_b128 a[216:219], v0 offset:6144
    v_cvt_pk_bf16_f32 v32, v80, v81
    v_mfma_f32_16x16x32_bf16 v[76:79], a[236:239], a[188:191], v[76:79]
    ds_read_b128 a[220:223], v1 offset:6144
    v_cvt_pk_bf16_f32 v29, v74, v75
    v_mfma_f32_16x16x32_bf16 v[68:71], a[236:239], a[164:167], v[68:71]
    s_add_u32 s59, s33, 128
    v_exp_f32_e64 v65, v65 clamp
    v_mfma_f32_16x16x32_bf16 v[68:71], a[232:235], a[160:163], v[68:71]
    v_exp_f32_e64 v57, v57 clamp
    v_mfma_f32_16x16x32_bf16 v[68:71], a[228:231], a[156:159], v[68:71]
    v_cvt_pk_bf16_f32 v20, v64, v65
    v_cvt_pk_bf16_f32 v17, v58, v59
    v_mfma_f32_16x16x32_bf16 v[60:63], a[228:231], a[132:135], v[60:63]
    s_add_u32 m0, s38, 2048
    v_exp_f32_e64 v56, v56 clamp
    v_mfma_f32_16x16x32_bf16 v[60:63], a[232:235], a[136:139], v[60:63]
    buffer_load_dwordx4 v6, s[12:15], s59 offen nt lds
    v_mfma_f32_16x16x32_bf16 v[60:63], a[236:239], a[140:143], v[60:63]
    v_exp_f32_e64 v73, v73 clamp
    v_mfma_f32_16x16x32_bf16 v[52:55], a[236:239], a[116:119], v[52:55]
    ds_read_b128 a[236:239], v1 offset:8192
    v_cvt_pk_bf16_f32 v16, v56, v57
    v_mfma_f32_16x16x32_bf16 v[52:55], a[232:235], a[112:115], v[52:55]
    ds_read_b128 a[232:235], v0 offset:8192
    v_cvt_pk_bf16_f32 v21, v66, v67
    v_mfma_f32_16x16x32_bf16 v[52:55], a[228:231], a[108:111], v[52:55]
    s_add_u32 m0, s38, 3072
    ds_read_b128 a[228:231], v1 offset:7168
    v_cvt_pk_bf16_f32 v28, v72, v73
    v_smfmac_f32_16x16x64_bf16 v[48:51], a[240:243], v[16:23], v101
    buffer_load_dwordx4 v7, s[12:15], s59 offen nt lds
    v_smfmac_f32_16x16x64_bf16 v[48:51], a[244:247], v[28:35], v101
    s_add_u32 s58, s33, 256
    s_add_u32 m0, s38, 4096
    s_waitcnt lgkmcnt(3)
    v_mfma_f32_16x16x32_bf16 v[56:59], a[216:219], a[96:99], 0
    buffer_load_dwordx4 v6, s[12:15], s58 offen nt lds
    v_mfma_f32_16x16x32_bf16 v[56:59], a[220:223], a[100:103], v[56:59]
    s_nop 1
    v_cmp_lt_f32 vcc, s29, v48
    v_mfma_f32_16x16x32_bf16 v[56:59], a[224:227], a[104:107], v[56:59]
    s_add_u32 m0, s38, 5120
    v_mfma_f32_16x16x32_bf16 v[64:67], a[224:227], a[128:131], 0
    buffer_load_dwordx4 v7, s[12:15], s58 offen nt lds
    v_mfma_f32_16x16x32_bf16 v[64:67], a[220:223], a[124:127], v[64:67]
    s_cbranch_vccnz L_rs_start4b
L_ret_start4b:
    v_fma_f32 v61, v61, s28, v10
    v_mfma_f32_16x16x32_bf16 v[64:67], a[216:219], a[120:123], v[64:67]
    v_fma_f32 v55, v55, s28, v9
    v_fma_f32 v52, v52, s28, v9
    v_mfma_f32_16x16x32_bf16 v[72:75], a[216:219], a[144:147], 0
    v_fma_f32 v54, v54, s28, v9
    s_waitcnt vmcnt(15) lgkmcnt(0)
    v_mfma_f32_16x16x32_bf16 v[72:75], a[220:223], a[148:151], v[72:75]
    s_barrier
    v_mfma_f32_16x16x32_bf16 v[72:75], a[224:227], a[152:155], v[72:75]
    s_add_u32 m0, s22, 0
    v_exp_f32_e64 v54, v54 clamp
    v_mfma_f32_16x16x32_bf16 v[80:83], a[224:227], a[176:179], 0
    buffer_load_dwordx4 v6, s[4:7], s20 offen lds
    v_mfma_f32_16x16x32_bf16 v[80:83], a[220:223], a[172:175], v[80:83]
    v_exp_f32_e64 v61, v61 clamp
    v_mfma_f32_16x16x32_bf16 v[80:83], a[216:219], a[168:171], v[80:83]
    s_add_u32 s20, s20, 128
    ds_read_b64_tr_b16 a[216:217], v2 offset:18432
    v_fma_f32 v53, v53, s28, v9
    v_mfma_f32_16x16x32_bf16 v[80:83], a[228:231], a[180:183], v[80:83]
    v_exp_f32_e64 v55, v55 clamp
    v_mfma_f32_16x16x32_bf16 v[80:83], a[232:235], a[184:187], v[80:83]
    s_add_u32 m0, s22, 1024
    ds_read_b64_tr_b16 a[218:219], v2 offset:12288
    v_fma_f32 v60, v60, s28, v10
    v_mfma_f32_16x16x32_bf16 v[80:83], a[236:239], a[188:191], v[80:83]
    v_exp_f32_e64 v52, v52 clamp
    v_mfma_f32_16x16x32_bf16 v[72:75], a[236:239], a[164:167], v[72:75]
    buffer_load_dwordx4 v6, s[4:7], s20 offen lds
    v_mfma_f32_16x16x32_bf16 v[72:75], a[232:235], a[160:163], v[72:75]
    s_add_u32 s20, s20, 128
    v_exp_f32_e64 v60, v60 clamp
    v_mfma_f32_16x16x32_bf16 v[72:75], a[228:231], a[156:159], v[72:75]
    ds_read_b64_tr_b16 a[220:221], v3 offset:18432
    s_add_u32 m0, s22, 2048
    v_mfma_f32_16x16x32_bf16 v[64:67], a[228:231], a[132:135], v[64:67]
    ds_read_b64_tr_b16 a[222:223], v3 offset:12288
    v_mfma_f32_16x16x32_bf16 v[64:67], a[232:235], a[136:139], v[64:67]
    buffer_load_dwordx4 v6, s[4:7], s20 offen lds
    v_mfma_f32_16x16x32_bf16 v[64:67], a[236:239], a[140:143], v[64:67]
    v_exp_f32_e64 v53, v53 clamp
    v_mfma_f32_16x16x32_bf16 v[56:59], a[236:239], a[116:119], v[56:59]
    ds_read_b64_tr_b16 a[224:225], v4 offset:18432
    v_cvt_pk_bf16_f32 v15, v54, v55
    v_mfma_f32_16x16x32_bf16 v[56:59], a[232:235], a[112:115], v[56:59]
    s_add_u32 s20, s20, 12032
    ds_read_b64_tr_b16 a[226:227], v4 offset:12288
    v_cvt_pk_bf16_f32 v14, v52, v53
    v_mfma_f32_16x16x32_bf16 v[56:59], a[228:231], a[108:111], v[56:59]
    s_waitcnt lgkmcnt(4)
    ds_read_b64_tr_b16 a[228:229], v5 offset:18432
    ds_read_b64_tr_b16 a[230:231], v5 offset:12288
    s_branch L_loop4w0
    .p2align 6
L_loop5w0:
    v_mfma_f32_16x16x32_bf16 v[112:115], a[216:219], v[16:19], v[112:115]
    ds_read_b128 v[96:99], v103 offset:0
    v_mfma_f32_16x16x32_bf16 v[116:119], a[220:223], v[16:19], v[116:119]
    v_mfma_f32_16x16x32_bf16 v[164:167], a[220:223], v[20:23], v[164:167]
    ds_read_b64_tr_b16 a[238:239], v3 offset:13312
    ds_read_b64_tr_b16 a[236:237], v3 offset:19456
    v_mfma_f32_16x16x32_bf16 v[160:163], a[216:219], v[20:23], v[160:163]
    v_fma_f32 v90, v90, s28, v13
    v_fma_f32 v74, v74, s28, v11
    v_mfma_f32_16x16x32_bf16 v[208:211], a[216:219], v[28:31], v[208:211]
    ds_read_b64_tr_b16 a[234:235], v2 offset:13312
    v_mfma_f32_16x16x32_bf16 v[212:215], a[220:223], v[28:31], v[212:215]
    v_fma_f32 v70, v70, s28, v11
    v_mfma_f32_16x16x32_bf16 a[4:7], a[220:223], v[32:35], a[4:7]
    ds_read_b64_tr_b16 a[232:233], v2 offset:19456
    v_fma_f32 v72, v72, s28, v11
    v_mfma_f32_16x16x32_bf16 a[0:3], a[216:219], v[32:35], a[0:3]
    v_fma_f32 v65, v65, s28, v10
    v_fma_f32 v79, v79, s28, v12
    v_mfma_f32_16x16x32_bf16 a[48:51], a[216:219], v[40:43], a[48:51]
    v_fma_f32 v77, v77, s28, v12
    v_fma_f32 v86, v86, s28, v13
    v_mfma_f32_16x16x32_bf16 a[52:55], a[220:223], v[40:43], a[52:55]
    s_add_u32 s39, s39, 12288
    v_exp_f32_e64 v90, v90 clamp
    s_waitcnt lgkmcnt(4)
    v_mfma_f32_16x16x32_bf16 a[56:59], a[224:227], v[40:43], a[56:59]
    buffer_store_dwordx4 v[96:99], v6, s[16:19], s24 offen offset:0 nt
    v_mfma_f32_16x16x32_bf16 a[60:63], a[228:231], v[40:43], a[60:63]
    v_fma_f32 v76, v76, s28, v12
    v_fma_f32 v71, v71, s28, v11
    v_mfma_f32_16x16x32_bf16 a[12:15], a[228:231], v[32:35], a[12:15]
    ds_read_b64_tr_b16 a[220:221], v5 offset:19456
    v_fma_f32 v68, v68, s28, v11
    v_mfma_f32_16x16x32_bf16 a[8:11], a[224:227], v[32:35], a[8:11]
    v_exp_f32_e64 v71, v71 clamp
    v_mfma_f32_16x16x32_bf16 v[216:219], a[224:227], v[28:31], v[216:219]
    ds_read_b64_tr_b16 a[218:219], v4 offset:13312
    v_mfma_f32_16x16x32_bf16 v[220:223], a[228:231], v[28:31], v[220:223]
    v_fma_f32 v81, v81, s28, v12
    v_fma_f32 v64, v64, s28, v10
    v_mfma_f32_16x16x32_bf16 v[172:175], a[228:231], v[20:23], v[172:175]
    s_add_u32 m0, s23, 0
    v_fma_f32 v89, v89, s28, v13
    v_fma_f32 v84, v84, s28, v13
    v_mfma_f32_16x16x32_bf16 v[168:171], a[224:227], v[20:23], v[168:171]
    buffer_load_dwordx4 v6, s[12:15], s25 offen nt lds
    v_mfma_f32_16x16x32_bf16 v[120:123], a[224:227], v[16:19], v[120:123]
    v_fma_f32 v80, v80, s28, v12
    v_mfma_f32_16x16x32_bf16 v[124:127], a[228:231], v[16:19], v[124:127]
    s_waitcnt lgkmcnt(2)
    ds_read_b64_tr_b16 a[222:223], v5 offset:13312
    ds_read_b64_tr_b16 a[216:217], v4 offset:19456
    v_mfma_f32_16x16x32_bf16 v[128:131], a[232:235], v[16:19], v[128:131]
    v_mfma_f32_16x16x32_bf16 v[132:135], a[236:239], v[16:19], v[132:135]
    v_exp_f32_e64 v86, v86 clamp
    v_mfma_f32_16x16x32_bf16 v[180:183], a[236:239], v[20:23], v[180:183]
    v_fma_f32 v91, v91, s28, v13
    v_fma_f32 v78, v78, s28, v12
    v_mfma_f32_16x16x32_bf16 v[176:179], a[232:235], v[20:23], v[176:179]
    v_fma_f32 v69, v69, s28, v11
    v_fma_f32 v75, v75, s28, v11
    v_mfma_f32_16x16x32_bf16 v[224:227], a[232:235], v[28:31], v[224:227]
    v_exp_f32_e64 v70, v70 clamp
    v_mfma_f32_16x16x32_bf16 v[228:231], a[236:239], v[28:31], v[228:231]
    v_exp_f32_e64 v81, v81 clamp
    v_mfma_f32_16x16x32_bf16 a[20:23], a[236:239], v[32:35], a[20:23]
    ds_read_b64_tr_b16 a[224:225], v2 offset:20480
    ds_read_b64_tr_b16 a[226:227], v2 offset:14336
    v_mfma_f32_16x16x32_bf16 a[16:19], a[232:235], v[32:35], a[16:19]
    ds_read_b128 v[96:99], v103 offset:1024
    v_fma_f32 v67, v67, s28, v10
    v_mfma_f32_16x16x32_bf16 a[64:67], a[232:235], v[40:43], a[64:67]
    ds_read_b64_tr_b16 a[228:229], v3 offset:20480
    ds_read_b64_tr_b16 a[230:231], v3 offset:14336
    v_mfma_f32_16x16x32_bf16 a[68:71], a[236:239], v[40:43], a[68:71]
    s_waitcnt lgkmcnt(5)
    v_exp_f32_e64 v79, v79 clamp
    v_mfma_f32_16x16x32_bf16 a[72:75], a[216:219], v[40:43], a[72:75]
    ds_read_b64_tr_b16 a[236:237], v5 offset:20480
    v_fma_f32 v85, v85, s28, v13
    v_mfma_f32_16x16x32_bf16 a[76:79], a[220:223], v[40:43], a[76:79]
    v_fma_f32 v73, v73, s28, v11
    v_fma_f32 v56, v56, s28, v9
    v_mfma_f32_16x16x32_bf16 a[28:31], a[220:223], v[32:35], a[28:31]
    v_exp_f32_e64 v76, v76 clamp
    v_mfma_f32_16x16x32_bf16 a[24:27], a[216:219], v[32:35], a[24:27]
    ds_read_b64_tr_b16 a[232:233], v4 offset:20480
    v_mfma_f32_16x16x32_bf16 v[232:235], a[216:219], v[28:31], v[232:235]
    ds_read_b64_tr_b16 a[234:235], v4 offset:14336
    ds_read_b64_tr_b16 a[238:239], v5 offset:14336
    v_mfma_f32_16x16x32_bf16 v[236:239], a[220:223], v[28:31], v[236:239]
    v_exp_f32_e64 v73, v73 clamp
    v_mfma_f32_16x16x32_bf16 v[188:191], a[220:223], v[20:23], v[188:191]
    v_fma_f32 v87, v87, s28, v13
    v_fma_f32 v83, v83, s28, v12
    v_mfma_f32_16x16x32_bf16 v[184:187], a[216:219], v[20:23], v[184:187]
    v_exp_f32_e64 v85, v85 clamp
    v_mfma_f32_16x16x32_bf16 v[136:139], a[216:219], v[16:19], v[136:139]
    v_exp_f32_e64 v89, v89 clamp
    v_mfma_f32_16x16x32_bf16 v[140:143], a[220:223], v[16:19], v[140:143]
    s_waitcnt lgkmcnt(4)
    v_exp_f32_e64 v77, v77 clamp
    v_mfma_f32_16x16x32_bf16 v[144:147], a[224:227], v[16:19], v[144:147]
    v_mfma_f32_16x16x32_bf16 v[148:151], a[228:231], v[16:19], v[148:151]
    v_exp_f32_e64 v64, v64 clamp
    v_mfma_f32_16x16x32_bf16 v[196:199], a[228:231], v[20:23], v[196:199]
    v_exp_f32_e64 v84, v84 clamp
    v_mfma_f32_16x16x32_bf16 v[192:195], a[224:227], v[20:23], v[192:195]
    v_exp_f32_e64 v91, v91 clamp
    v_mfma_f32_16x16x32_bf16 v[240:243], a[224:227], v[28:31], v[240:243]
    v_fma_f32 v88, v88, s28, v13
    v_mfma_f32_16x16x32_bf16 v[244:247], a[228:231], v[28:31], v[244:247]
    v_exp_f32_e64 v78, v78 clamp
    v_mfma_f32_16x16x32_bf16 a[36:39], a[228:231], v[32:35], a[36:39]
    v_exp_f32_e64 v68, v68 clamp
    v_mfma_f32_16x16x32_bf16 a[32:35], a[224:227], v[32:35], a[32:35]
    s_waitcnt vmcnt(12) lgkmcnt(0)
    v_exp_f32_e64 v87, v87 clamp
    v_mfma_f32_16x16x32_bf16 a[80:83], a[224:227], v[40:43], a[80:83]
    v_exp_f32_e64 v56, v56 clamp
    v_mfma_f32_16x16x32_bf16 a[84:87], a[228:231], v[40:43], a[84:87]
    s_barrier
    ds_read_b128 a[216:219], v0 offset:12288
    v_mfma_f32_16x16x32_bf16 a[88:91], a[232:235], v[40:43], a[88:91]
    ds_read_b128 a[220:223], v1 offset:12288
    s_add_u32 m0, s22, 36864
    v_mfma_f32_16x16x32_bf16 a[92:95], a[236:239], v[40:43], a[92:95]
    ds_read_b128 a[224:227], v0 offset:13312
    v_cvt_pk_bf16_f32 v27, v70, v71
    v_mfma_f32_16x16x32_bf16 a[44:47], a[236:239], v[32:35], a[44:47]
    buffer_load_dwordx4 v6, s[8:11], s21 offen lds
    v_mfma_f32_16x16x32_bf16 a[40:43], a[232:235], v[32:35], a[40:43]
    s_add_u32 s21, s21, 128
    v_cvt_pk_bf16_f32 v38, v84, v85
    v_fma_f32 v57, v57, s28, v9
    v_mfma_f32_16x16x32_bf16 v[248:251], a[232:235], v[28:31], v[248:251]
    s_add_u32 m0, s22, 37888
    v_cvt_pk_bf16_f32 v34, v76, v77
    v_mfma_f32_16x16x32_bf16 v[252:255], a[236:239], v[28:31], v[252:255]
    buffer_load_dwordx4 v6, s[8:11], s21 offen lds
    v_mfma_f32_16x16x32_bf16 v[204:207], a[236:239], v[20:23], v[204:207]
    s_add_u32 s21, s21, 128
    ds_read_b128 a[228:231], v1 offset:13312
    s_add_u32 m0, s22, 38912
    v_mfma_f32_16x16x32_bf16 v[200:203], a[232:235], v[20:23], v[200:203]
    v_exp_f32_e64 v65, v65 clamp
    v_mfma_f32_16x16x32_bf16 v[152:155], a[232:235], v[16:19], v[152:155]
    buffer_load_dwordx4 v6, s[8:11], s21 offen lds
    v_mfma_f32_16x16x32_bf16 v[156:159], a[236:239], v[16:19], v[156:159]
    s_waitcnt lgkmcnt(3)
    v_cvt_pk_bf16_f32 v22, v60, v61
    v_cvt_pk_bf16_f32 v23, v62, v63
    v_mfma_f32_16x16x32_bf16 v[52:55], a[216:219], a[96:99], 0
    s_waitcnt lgkmcnt(2)
    v_cvt_pk_bf16_f32 v35, v78, v79
    v_cvt_pk_bf16_f32 v24, v64, v65
    v_mfma_f32_16x16x32_bf16 v[52:55], a[220:223], a[100:103], v[52:55]
    s_waitcnt lgkmcnt(1)
    ds_read_b128 a[232:235], v0 offset:14336
    v_mfma_f32_16x16x32_bf16 v[52:55], a[224:227], a[104:107], v[52:55]
    ds_read_b128 a[236:239], v1 offset:14336
    v_cvt_pk_bf16_f32 v41, v90, v91
    v_mfma_f32_16x16x32_bf16 v[60:63], a[224:227], a[128:131], 0
    v_exp_f32_e64 v69, v69 clamp
    v_mfma_f32_16x16x32_bf16 v[60:63], a[220:223], a[124:127], v[60:63]
    v_cvt_pk_bf16_f32 v26, v68, v69
    v_fma_f32 v66, v66, s28, v10
    v_mfma_f32_16x16x32_bf16 v[60:63], a[216:219], a[120:123], v[60:63]
    v_fma_f32 v82, v82, s28, v12
    v_mfma_f32_16x16x32_bf16 v[68:71], a[216:219], a[144:147], 0
    v_exp_f32_e64 v75, v75 clamp
    v_mfma_f32_16x16x32_bf16 v[68:71], a[220:223], a[148:151], v[68:71]
    buffer_store_dwordx4 v[96:99], v7, s[16:19], s24 offen offset:0 nt
    v_cvt_pk_bf16_f32 v39, v86, v87
    v_exp_f32_e64 v57, v57 clamp
    v_mfma_f32_16x16x32_bf16 v[68:71], a[224:227], a[152:155], v[68:71]
    v_exp_f32_e64 v66, v66 clamp
    v_mfma_f32_16x16x32_bf16 v[76:79], a[224:227], a[176:179], 0
    v_exp_f32_e64 v74, v74 clamp
    v_mfma_f32_16x16x32_bf16 v[76:79], a[220:223], a[172:175], v[76:79]
    v_fma_f32 v59, v59, s28, v9
    s_add_u32 s21, s21, 12032
    v_mfma_f32_16x16x32_bf16 v[76:79], a[216:219], a[168:171], v[76:79]
    v_cvt_pk_bf16_f32 v16, v56, v57
    v_mfma_f32_16x16x32_bf16 v[84:87], a[216:219], a[192:195], 0
    v_mfma_f32_16x16x32_bf16 v[84:87], a[220:223], a[196:199], v[84:87]
    v_exp_f32_e64 v88, v88 clamp
    v_mfma_f32_16x16x32_bf16 v[84:87], a[224:227], a[200:203], v[84:87]
    s_add_u32 m0, s23, 1024
    ds_read_b128 a[216:219], v0 offset:18432
    s_waitcnt lgkmcnt(1)
    v_mfma_f32_16x16x32_bf16 v[84:87], a[228:231], a[204:207], v[84:87]
    v_exp_f32_e64 v80, v80 clamp
    v_mfma_f32_16x16x32_bf16 v[84:87], a[232:235], a[208:211], v[84:87]
    v_exp_f32_e64 v67, v67 clamp
    v_mfma_f32_16x16x32_bf16 v[84:87], a[236:239], a[212:215], v[84:87]
    ds_read_b128 a[220:223], v1 offset:18432
    v_fma_f32 v58, v58, s28, v9
    v_mfma_f32_16x16x32_bf16 v[76:79], a[236:239], a[188:191], v[76:79]
    v_exp_f32_e64 v83, v83 clamp
    v_mfma_f32_16x16x32_bf16 v[76:79], a[232:235], a[184:187], v[76:79]
    buffer_load_dwordx4 v7, s[12:15], s25 offen nt lds
    v_mfma_f32_16x16x32_bf16 v[76:79], a[228:231], a[180:183], v[76:79]
    v_exp_f32_e64 v59, v59 clamp
    v_mfma_f32_16x16x32_bf16 v[68:71], a[228:231], a[156:159], v[68:71]
    s_bitcmp1_b32 s27, 0
    v_cvt_pk_bf16_f32 v40, v88, v89
    v_cvt_pk_bf16_f32 v25, v66, v67
    v_mfma_f32_16x16x32_bf16 v[68:71], a[232:235], a[160:163], v[68:71]
    s_cselect_b32 s26, s49, 128
    v_cvt_pk_bf16_f32 v29, v74, v75
    v_mfma_f32_16x16x32_bf16 v[68:71], a[236:239], a[164:167], v[68:71]
    v_exp_f32_e64 v58, v58 clamp
    v_mfma_f32_16x16x32_bf16 v[60:63], a[236:239], a[140:143], v[60:63]
    ds_read_b128 a[224:227], v0 offset:19456
    v_cvt_pk_bf16_f32 v17, v58, v59
    v_mfma_f32_16x16x32_bf16 v[60:63], a[232:235], a[136:139], v[60:63]
    s_nop 0
    v_mfma_f32_16x16x32_bf16 v[44:47], a[248:251], v[14:17], v[44:47]
    v_exp_f32_e64 v82, v82 clamp
    v_mfma_f32_16x16x32_bf16 v[60:63], a[228:231], a[132:135], v[60:63]
    s_lshr_b32 s27, s27, 1
    v_exp_f32_e64 v72, v72 clamp
    v_mfma_f32_16x16x32_bf16 v[52:55], a[228:231], a[108:111], v[52:55]
    v_cvt_pk_bf16_f32 v28, v72, v73
    v_cvt_pk_bf16_f32 v36, v80, v81
    v_mfma_f32_16x16x32_bf16 v[52:55], a[232:235], a[112:115], v[52:55]
    s_add_u32 s24, s24, s26
    ds_read_b128 a[232:235], v0 offset:20480
    v_mfma_f32_16x16x32_bf16 v[52:55], a[236:239], a[116:119], v[52:55]
    ds_read_b128 a[236:239], v1 offset:20480
    v_cvt_pk_bf16_f32 v37, v82, v83
    v_smfmac_f32_16x16x64_bf16 v[44:47], a[240:243], v[22:29], v101
    ds_read_b128 a[228:231], v1 offset:19456
    v_smfmac_f32_16x16x64_bf16 v[44:47], a[244:247], v[34:41], v101
    s_waitcnt lgkmcnt(4)
    ds_read_b128 v[96:99], v103 offset:2048
    v_mfma_f32_16x16x32_bf16 v[56:59], a[216:219], a[96:99], 0
    v_mfma_f32_16x16x32_bf16 v[56:59], a[220:223], a[100:103], v[56:59]
    s_waitcnt lgkmcnt(4)
    v_mfma_f32_16x16x32_bf16 v[56:59], a[224:227], a[104:107], v[56:59]
    s_nop 1
    v_cmp_lt_f32 vcc, s29, v44
    v_mfma_f32_16x16x32_bf16 v[64:67], a[224:227], a[128:131], 0
    v_mfma_f32_16x16x32_bf16 v[64:67], a[220:223], a[124:127], v[64:67]
    s_add_u32 s25, s25, s26
    v_mfma_f32_16x16x32_bf16 v[64:67], a[216:219], a[120:123], v[64:67]
    v_mfma_f32_16x16x32_bf16 v[72:75], a[216:219], a[144:147], 0
    s_cbranch_vccnz L_rs_loop5w0a
L_ret_loop5w0a:
    v_fma_f32 v55, v55, s28, v9
    v_mfma_f32_16x16x32_bf16 v[72:75], a[220:223], a[148:151], v[72:75]
    v_fma_f32 v52, v52, s28, v9
    v_fma_f32 v77, v77, s28, v12
    v_mfma_f32_16x16x32_bf16 v[72:75], a[224:227], a[152:155], v[72:75]
    s_waitcnt vmcnt(12) lgkmcnt(1)
    v_fma_f32 v60, v60, s28, v10
    v_mfma_f32_16x16x32_bf16 v[80:83], a[224:227], a[176:179], 0
    s_barrier
    v_mfma_f32_16x16x32_bf16 v[80:83], a[220:223], a[172:175], v[80:83]
    v_fma_f32 v79, v79, s28, v12
    s_add_u32 m0, s22, 12288
    v_mfma_f32_16x16x32_bf16 v[80:83], a[216:219], a[168:171], v[80:83]
    buffer_load_dwordx4 v6, s[4:7], s20 offen lds
    v_mfma_f32_16x16x32_bf16 v[88:91], a[216:219], a[192:195], 0
    s_add_u32 s20, s20, 128
    ds_read_b64_tr_b16 a[216:217], v2 offset:0
    s_add_u32 m0, s22, 13312
    v_mfma_f32_16x16x32_bf16 v[88:91], a[220:223], a[196:199], v[88:91]
    v_fma_f32 v86, v86, s28, v13
    v_mfma_f32_16x16x32_bf16 v[88:91], a[224:227], a[200:203], v[88:91]
    buffer_load_dwordx4 v6, s[4:7], s20 offen lds
    v_mfma_f32_16x16x32_bf16 v[88:91], a[228:231], a[204:207], v[88:91]
    v_mfma_f32_16x16x32_bf16 v[88:91], a[232:235], a[208:211], v[88:91]
    s_add_u32 s20, s20, 128
    v_fma_f32 v84, v84, s28, v13
    s_add_u32 m0, s22, 14336
    v_mfma_f32_16x16x32_bf16 v[88:91], a[236:239], a[212:215], v[88:91]
    buffer_load_dwordx4 v6, s[4:7], s20 offen lds
    v_mfma_f32_16x16x32_bf16 v[80:83], a[236:239], a[188:191], v[80:83]
    s_add_u32 s20, s20, 12032
    ds_read_b64_tr_b16 a[218:219], v2 offset:6144
    ds_read_b64_tr_b16 a[220:221], v3 offset:0
    v_mfma_f32_16x16x32_bf16 v[80:83], a[232:235], a[184:187], v[80:83]
    v_mfma_f32_16x16x32_bf16 v[80:83], a[228:231], a[180:183], v[80:83]
    ds_read_b64_tr_b16 a[222:223], v3 offset:6144
    v_mfma_f32_16x16x32_bf16 v[72:75], a[228:231], a[156:159], v[72:75]
    ds_read_b64_tr_b16 a[224:225], v4 offset:0
    v_fma_f32 v78, v78, s28, v12
    v_mfma_f32_16x16x32_bf16 v[72:75], a[232:235], a[160:163], v[72:75]
    v_exp_f32_e64 v84, v84 clamp
    v_mfma_f32_16x16x32_bf16 v[72:75], a[236:239], a[164:167], v[72:75]
    v_exp_f32_e64 v79, v79 clamp
    v_mfma_f32_16x16x32_bf16 v[64:67], a[236:239], a[140:143], v[64:67]
    v_fma_f32 v76, v76, s28, v12
    v_fma_f32 v54, v54, s28, v9
    v_mfma_f32_16x16x32_bf16 v[64:67], a[232:235], a[136:139], v[64:67]
    ds_read_b64_tr_b16 a[226:227], v4 offset:6144
    v_fma_f32 v71, v71, s28, v11
    v_mfma_f32_16x16x32_bf16 v[64:67], a[228:231], a[132:135], v[64:67]
    v_fma_f32 v68, v68, s28, v11
    v_mfma_f32_16x16x32_bf16 v[56:59], a[228:231], a[108:111], v[56:59]
    ds_read_b64_tr_b16 a[228:229], v5 offset:0
    v_mfma_f32_16x16x32_bf16 v[56:59], a[232:235], a[112:115], v[56:59]
    v_exp_f32_e64 v71, v71 clamp
    v_mfma_f32_16x16x32_bf16 v[56:59], a[236:239], a[116:119], v[56:59]
    s_waitcnt lgkmcnt(4)
    v_exp_f32_e64 v52, v52 clamp
    v_mfma_f32_16x16x32_bf16 v[112:115], a[216:219], v[14:17], v[112:115]
    s_waitcnt lgkmcnt(3)
    ds_read_b64_tr_b16 a[230:231], v5 offset:6144
    ds_read_b64_tr_b16 a[234:235], v2 offset:7168
    v_mfma_f32_16x16x32_bf16 v[116:119], a[220:223], v[14:17], v[116:119]
    v_fma_f32 v85, v85, s28, v13
    v_fma_f32 v83, v83, s28, v12
    v_mfma_f32_16x16x32_bf16 v[164:167], a[220:223], v[22:25], v[164:167]
    ds_read_b64_tr_b16 a[232:233], v2 offset:1024
    v_mfma_f32_16x16x32_bf16 v[160:163], a[216:219], v[22:25], v[160:163]
    v_fma_f32 v61, v61, s28, v10
    v_mfma_f32_16x16x32_bf16 v[208:211], a[216:219], v[26:29], v[208:211]
    v_fma_f32 v90, v90, s28, v13
    v_fma_f32 v75, v75, s28, v11
    v_mfma_f32_16x16x32_bf16 v[212:215], a[220:223], v[26:29], v[212:215]
    buffer_store_dwordx4 v[96:99], v6, s[16:19], s24 offen offset:0 nt
    s_add_u32 s39, s39, 12288
    ds_read_b64_tr_b16 a[236:237], v3 offset:1024
    v_fma_f32 v59, v59, s28, v9
    v_fma_f32 v82, v82, s28, v12
    v_mfma_f32_16x16x32_bf16 a[4:7], a[220:223], v[34:37], a[4:7]
    v_exp_f32_e64 v54, v54 clamp
    v_mfma_f32_16x16x32_bf16 a[0:3], a[216:219], v[34:37], a[0:3]
    v_fma_f32 v69, v69, s28, v11
    v_fma_f32 v67, v67, s28, v10
    v_mfma_f32_16x16x32_bf16 a[48:51], a[216:219], v[38:41], a[48:51]
    v_exp_f32_e64 v55, v55 clamp
    v_mfma_f32_16x16x32_bf16 a[52:55], a[220:223], v[38:41], a[52:55]
    s_waitcnt lgkmcnt(2)
    ds_read_b64_tr_b16 a[238:239], v3 offset:7168
    v_mfma_f32_16x16x32_bf16 a[56:59], a[224:227], v[38:41], a[56:59]
    v_fma_f32 v89, v89, s28, v13
    v_fma_f32 v63, v63, s28, v10
    v_mfma_f32_16x16x32_bf16 a[60:63], a[228:231], v[38:41], a[60:63]
    ds_read_b64_tr_b16 a[218:219], v4 offset:7168
    v_fma_f32 v62, v62, s28, v10
    v_mfma_f32_16x16x32_bf16 a[12:15], a[228:231], v[34:37], a[12:15]
    v_exp_f32_e64 v75, v75 clamp
    v_mfma_f32_16x16x32_bf16 a[8:11], a[224:227], v[34:37], a[8:11]
    v_exp_f32_e64 v68, v68 clamp
    v_mfma_f32_16x16x32_bf16 v[216:219], a[224:227], v[26:29], v[216:219]
    v_fma_f32 v57, v57, s28, v9
    v_mfma_f32_16x16x32_bf16 v[220:223], a[228:231], v[26:29], v[220:223]
    s_add_u32 m0, s23, 2048
    v_fma_f32 v53, v53, s28, v9
    v_mfma_f32_16x16x32_bf16 v[172:175], a[228:231], v[22:25], v[172:175]
    buffer_load_dwordx4 v6, s[12:15], s25 offen nt lds
    v_mfma_f32_16x16x32_bf16 v[168:171], a[224:227], v[22:25], v[168:171]
    ds_read_b64_tr_b16 a[222:223], v5 offset:7168
    ds_read_b64_tr_b16 a[216:217], v4 offset:1024
    v_mfma_f32_16x16x32_bf16 v[120:123], a[224:227], v[14:17], v[120:123]
    ds_read_b64_tr_b16 a[220:221], v5 offset:1024
    v_fma_f32 v88, v88, s28, v13
    v_mfma_f32_16x16x32_bf16 v[124:127], a[228:231], v[14:17], v[124:127]
    s_waitcnt lgkmcnt(4)
    v_fma_f32 v56, v56, s28, v9
    v_mfma_f32_16x16x32_bf16 v[128:131], a[232:235], v[14:17], v[128:131]
    v_exp_f32_e64 v53, v53 clamp
    v_mfma_f32_16x16x32_bf16 v[132:135], a[236:239], v[14:17], v[132:135]
    ds_read_b64_tr_b16 a[224:225], v2 offset:2048
    ds_read_b64_tr_b16 a[228:229], v3 offset:2048
    v_mfma_f32_16x16x32_bf16 v[180:183], a[236:239], v[22:25], v[180:183]
    v_fma_f32 v58, v58, s28, v9
    v_fma_f32 v74, v74, s28, v11
    v_mfma_f32_16x16x32_bf16 v[176:179], a[232:235], v[22:25], v[176:179]
    v_exp_f32_e64 v76, v76 clamp
    v_mfma_f32_16x16x32_bf16 v[224:227], a[232:235], v[26:29], v[224:227]
    ds_read_b128 v[96:99], v103 offset:3072
    v_fma_f32 v65, v65, s28, v10
    v_mfma_f32_16x16x32_bf16 v[228:231], a[236:239], v[26:29], v[228:231]
    v_fma_f32 v64, v64, s28, v10
    v_cvt_pk_bf16_f32 v19, v54, v55
    v_mfma_f32_16x16x32_bf16 a[20:23], a[236:239], v[34:37], a[20:23]
    v_fma_f32 v87, v87, s28, v13
    v_mfma_f32_16x16x32_bf16 a[16:19], a[232:235], v[34:37], a[16:19]
    v_exp_f32_e64 v90, v90 clamp
    v_mfma_f32_16x16x32_bf16 a[64:67], a[232:235], v[38:41], a[64:67]
    ds_read_b64_tr_b16 a[226:227], v2 offset:8192
    v_mfma_f32_16x16x32_bf16 a[68:71], a[236:239], v[38:41], a[68:71]
    s_waitcnt lgkmcnt(4)
    ds_read_b64_tr_b16 a[232:233], v4 offset:2048
    ds_read_b64_tr_b16 a[238:239], v5 offset:8192
    v_mfma_f32_16x16x32_bf16 a[72:75], a[216:219], v[38:41], a[72:75]
    ds_read_b64_tr_b16 a[230:231], v3 offset:8192
    ds_read_b64_tr_b16 a[236:237], v5 offset:2048
    v_mfma_f32_16x16x32_bf16 a[76:79], a[220:223], v[38:41], a[76:79]
    ds_read_b64_tr_b16 a[234:235], v4 offset:8192
    v_mfma_f32_16x16x32_bf16 a[28:31], a[220:223], v[34:37], a[28:31]
    v_exp_f32_e64 v85, v85 clamp
    v_mfma_f32_16x16x32_bf16 a[24:27], a[216:219], v[34:37], a[24:27]
    v_exp_f32_e64 v62, v62 clamp
    v_mfma_f32_16x16x32_bf16 v[232:235], a[216:219], v[26:29], v[232:235]
    v_fma_f32 v70, v70, s28, v11
    v_fma_f32 v73, v73, s28, v11
    v_mfma_f32_16x16x32_bf16 v[236:239], a[220:223], v[26:29], v[236:239]
    v_exp_f32_e64 v70, v70 clamp
    v_mfma_f32_16x16x32_bf16 v[188:191], a[220:223], v[22:25], v[188:191]
    v_exp_f32_e64 v69, v69 clamp
    v_mfma_f32_16x16x32_bf16 v[184:187], a[216:219], v[22:25], v[184:187]
    v_exp_f32_e64 v83, v83 clamp
    v_mfma_f32_16x16x32_bf16 v[136:139], a[216:219], v[14:17], v[136:139]
    v_exp_f32_e64 v63, v63 clamp
    v_mfma_f32_16x16x32_bf16 v[140:143], a[220:223], v[14:17], v[140:143]
    s_waitcnt lgkmcnt(3)
    v_exp_f32_e64 v86, v86 clamp
    v_mfma_f32_16x16x32_bf16 v[144:147], a[224:227], v[14:17], v[144:147]
    s_waitcnt lgkmcnt(1)
    v_exp_f32_e64 v61, v61 clamp
    v_mfma_f32_16x16x32_bf16 v[148:151], a[228:231], v[14:17], v[148:151]
    v_cvt_pk_bf16_f32 v31, v70, v71
    v_mfma_f32_16x16x32_bf16 v[196:199], a[228:231], v[22:25], v[196:199]
    v_cvt_pk_bf16_f32 v18, v52, v53
    v_fma_f32 v66, v66, s28, v10
    v_mfma_f32_16x16x32_bf16 v[192:195], a[224:227], v[22:25], v[192:195]
    s_waitcnt vmcnt(12) lgkmcnt(0)
    v_mfma_f32_16x16x32_bf16 v[240:243], a[224:227], v[26:29], v[240:243]
    v_fma_f32 v72, v72, s28, v11
    v_cvt_pk_bf16_f32 v30, v68, v69
    v_mfma_f32_16x16x32_bf16 v[244:247], a[228:231], v[26:29], v[244:247]
    v_fma_f32 v81, v81, s28, v12
    v_mfma_f32_16x16x32_bf16 a[36:39], a[228:231], v[34:37], a[36:39]
    v_exp_f32_e64 v60, v60 clamp
    v_mfma_f32_16x16x32_bf16 a[32:35], a[224:227], v[34:37], a[32:35]
    s_add_u32 m0, s22, 24576
    v_exp_f32_e64 v78, v78 clamp
    v_mfma_f32_16x16x32_bf16 a[80:83], a[224:227], v[38:41], a[80:83]
    v_exp_f32_e64 v73, v73 clamp
    v_mfma_f32_16x16x32_bf16 a[84:87], a[228:231], v[38:41], a[84:87]
    s_barrier
    ds_read_b128 a[216:219], v0 offset:0
    v_mfma_f32_16x16x32_bf16 a[88:91], a[232:235], v[38:41], a[88:91]
    buffer_load_dwordx4 v6, s[8:11], s21 offen lds
    ds_read_b128 a[220:223], v1 offset:0
    v_mfma_f32_16x16x32_bf16 a[92:95], a[236:239], v[38:41], a[92:95]
    s_add_u32 s21, s21, 128
    s_add_u32 m0, s22, 25600
    ds_read_b128 a[224:227], v0 offset:1024
    v_mfma_f32_16x16x32_bf16 a[44:47], a[236:239], v[34:37], a[44:47]
    buffer_load_dwordx4 v6, s[8:11], s21 offen lds
    v_mfma_f32_16x16x32_bf16 a[40:43], a[232:235], v[34:37], a[40:43]
    s_add_u32 s21, s21, 128
    v_exp_f32_e64 v77, v77 clamp
    v_mfma_f32_16x16x32_bf16 v[248:251], a[232:235], v[26:29], v[248:251]
    v_exp_f32_e64 v57, v57 clamp
    v_mfma_f32_16x16x32_bf16 v[252:255], a[236:239], v[26:29], v[252:255]
    s_add_u32 m0, s22, 26624
    ds_read_b128 a[228:231], v1 offset:1024
    v_mfma_f32_16x16x32_bf16 v[204:207], a[236:239], v[22:25], v[204:207]
    buffer_load_dwordx4 v6, s[8:11], s21 offen lds
    v_mfma_f32_16x16x32_bf16 v[200:203], a[232:235], v[22:25], v[200:203]
    v_cvt_pk_bf16_f32 v23, v62, v63
    v_cvt_pk_bf16_f32 v22, v60, v61
    v_mfma_f32_16x16x32_bf16 v[152:155], a[232:235], v[14:17], v[152:155]
    v_exp_f32_e64 v87, v87 clamp
    v_mfma_f32_16x16x32_bf16 v[156:159], a[236:239], v[14:17], v[156:159]
    s_waitcnt lgkmcnt(3)
    v_exp_f32_e64 v82, v82 clamp
    v_mfma_f32_16x16x32_bf16 v[52:55], a[216:219], a[96:99], 0
    s_waitcnt lgkmcnt(2)
    v_fma_f32 v91, v91, s28, v13
    v_cvt_pk_bf16_f32 v42, v84, v85
    v_mfma_f32_16x16x32_bf16 v[52:55], a[220:223], a[100:103], v[52:55]
    s_waitcnt lgkmcnt(1)
    v_fma_f32 v80, v80, s28, v12
    v_mfma_f32_16x16x32_bf16 v[52:55], a[224:227], a[104:107], v[52:55]
    ds_read_b128 a[236:239], v1 offset:2048
    v_cvt_pk_bf16_f32 v34, v76, v77
    v_mfma_f32_16x16x32_bf16 v[60:63], a[224:227], a[128:131], 0
    v_cvt_pk_bf16_f32 v35, v78, v79
    v_mfma_f32_16x16x32_bf16 v[60:63], a[220:223], a[124:127], v[60:63]
    s_add_u32 s21, s21, 12032
    ds_read_b128 a[232:235], v0 offset:2048
    v_mfma_f32_16x16x32_bf16 v[60:63], a[216:219], a[120:123], v[60:63]
    buffer_store_dwordx4 v[96:99], v7, s[16:19], s24 offen offset:0 nt
    v_cvt_pk_bf16_f32 v43, v86, v87
    v_exp_f32_e64 v66, v66 clamp
    v_mfma_f32_16x16x32_bf16 v[68:71], a[216:219], a[144:147], 0
    v_exp_f32_e64 v80, v80 clamp
    v_mfma_f32_16x16x32_bf16 v[68:71], a[220:223], a[148:151], v[68:71]
    s_add_u32 m0, s23, 3072
    v_exp_f32_e64 v81, v81 clamp
    v_mfma_f32_16x16x32_bf16 v[68:71], a[224:227], a[152:155], v[68:71]
    v_exp_f32_e64 v74, v74 clamp
    v_mfma_f32_16x16x32_bf16 v[76:79], a[224:227], a[176:179], 0
    v_exp_f32_e64 v72, v72 clamp
    v_mfma_f32_16x16x32_bf16 v[76:79], a[220:223], a[172:175], v[76:79]
    v_mfma_f32_16x16x32_bf16 v[76:79], a[216:219], a[168:171], v[76:79]
    v_cvt_pk_bf16_f32 v28, v72, v73
    v_mfma_f32_16x16x32_bf16 v[84:87], a[216:219], a[192:195], 0
    v_exp_f32_e64 v56, v56 clamp
    v_mfma_f32_16x16x32_bf16 v[84:87], a[220:223], a[196:199], v[84:87]
    ds_read_b128 a[216:219], v0 offset:6144
    v_mfma_f32_16x16x32_bf16 v[84:87], a[224:227], a[200:203], v[84:87]
    s_waitcnt lgkmcnt(1)
    v_exp_f32_e64 v59, v59 clamp
    v_mfma_f32_16x16x32_bf16 v[84:87], a[228:231], a[204:207], v[84:87]
    v_exp_f32_e64 v67, v67 clamp
    v_mfma_f32_16x16x32_bf16 v[84:87], a[232:235], a[208:211], v[84:87]
    v_exp_f32_e64 v91, v91 clamp
    v_mfma_f32_16x16x32_bf16 v[84:87], a[236:239], a[212:215], v[84:87]
    v_exp_f32_e64 v65, v65 clamp
    v_mfma_f32_16x16x32_bf16 v[76:79], a[236:239], a[188:191], v[76:79]
    buffer_load_dwordx4 v7, s[12:15], s25 offen nt lds
    v_mfma_f32_16x16x32_bf16 v[76:79], a[232:235], a[184:187], v[76:79]
    v_exp_f32_e64 v64, v64 clamp
    v_mfma_f32_16x16x32_bf16 v[76:79], a[228:231], a[180:183], v[76:79]
    v_cvt_pk_bf16_f32 v33, v82, v83
    v_cvt_pk_bf16_f32 v21, v66, v67
    v_mfma_f32_16x16x32_bf16 v[68:71], a[228:231], a[156:159], v[68:71]
    v_exp_f32_e64 v88, v88 clamp
    v_mfma_f32_16x16x32_bf16 v[68:71], a[232:235], a[160:163], v[68:71]
    v_exp_f32_e64 v58, v58 clamp
    v_mfma_f32_16x16x32_bf16 v[68:71], a[236:239], a[164:167], v[68:71]
    ds_read_b128 a[220:223], v1 offset:6144
    v_cvt_pk_bf16_f32 v17, v58, v59
    v_mfma_f32_16x16x32_bf16 v[60:63], a[236:239], a[140:143], v[60:63]
    ds_read_b128 a[224:227], v0 offset:7168
    v_mfma_f32_16x16x32_bf16 v[60:63], a[232:235], a[136:139], v[60:63]
    v_exp_f32_e64 v89, v89 clamp
    v_mfma_f32_16x16x32_bf16 v[60:63], a[228:231], a[132:135], v[60:63]
    v_cvt_pk_bf16_f32 v20, v64, v65
    v_cvt_pk_bf16_f32 v29, v74, v75
    v_mfma_f32_16x16x32_bf16 v[52:55], a[228:231], a[108:111], v[52:55]
    ds_read_b128 a[228:231], v1 offset:7168
    v_mfma_f32_16x16x32_bf16 v[52:55], a[232:235], a[112:115], v[52:55]
    ds_read_b128 a[232:235], v0 offset:8192
    v_cvt_pk_bf16_f32 v41, v90, v91
    v_mfma_f32_16x16x32_bf16 v[52:55], a[236:239], a[116:119], v[52:55]
    s_waitcnt lgkmcnt(4)
    ds_read_b128 a[236:239], v1 offset:8192
    v_cvt_pk_bf16_f32 v16, v56, v57
    v_mfma_f32_16x16x32_bf16 v[56:59], a[216:219], a[96:99], 0
    s_bitcmp1_b32 s27, 0
    v_cvt_pk_bf16_f32 v32, v80, v81
    v_cvt_pk_bf16_f32 v40, v88, v89
    v_smfmac_f32_16x16x64_bf16 v[48:51], a[240:243], v[16:23], v101
    v_smfmac_f32_16x16x64_bf16 v[48:51], a[244:247], v[28:35], v101
    v_mfma_f32_16x16x32_bf16 v[48:51], a[248:251], v[40:43], v[48:51]
    s_cselect_b32 s26, s49, 128
    s_lshr_b32 s27, s27, 1
    s_waitcnt lgkmcnt(4)
    v_mfma_f32_16x16x32_bf16 v[56:59], a[220:223], a[100:103], v[56:59]
    s_waitcnt lgkmcnt(3)
    v_mfma_f32_16x16x32_bf16 v[56:59], a[224:227], a[104:107], v[56:59]
    s_nop 1
    v_cmp_lt_f32 vcc, s29, v48
    v_mfma_f32_16x16x32_bf16 v[64:67], a[224:227], a[128:131], 0
    s_add_u32 s24, s24, s26
    s_add_u32 s25, s25, s26
    s_add_u32 s23, s23, 4096
    v_mfma_f32_16x16x32_bf16 v[64:67], a[220:223], a[124:127], v[64:67]
    s_cbranch_vccnz L_rs_loop5w0b
L_ret_loop5w0b:
    v_fma_f32 v52, v52, s28, v9
    v_mfma_f32_16x16x32_bf16 v[64:67], a[216:219], a[120:123], v[64:67]
    v_fma_f32 v60, v60, s28, v10
    v_fma_f32 v53, v53, s28, v9
    v_mfma_f32_16x16x32_bf16 v[72:75], a[216:219], a[144:147], 0
    s_waitcnt vmcnt(12) lgkmcnt(0)
    s_cmp_eq_u32 s30, 5
    s_cselect_b32 s26, s62, 0
    v_mfma_f32_16x16x32_bf16 v[72:75], a[220:223], a[148:151], v[72:75]
    s_add_u32 s20, s20, s26
    v_exp_f32_e64 v53, v53 clamp
    v_mfma_f32_16x16x32_bf16 v[72:75], a[224:227], a[152:155], v[72:75]
    s_add_u32 m0, s22, 0
    v_exp_f32_e64 v52, v52 clamp
    v_mfma_f32_16x16x32_bf16 v[80:83], a[224:227], a[176:179], 0
    s_barrier
    v_mfma_f32_16x16x32_bf16 v[80:83], a[220:223], a[172:175], v[80:83]
    buffer_load_dwordx4 v6, s[4:7], s20 offen lds
    v_mfma_f32_16x16x32_bf16 v[80:83], a[216:219], a[168:171], v[80:83]
    s_add_u32 s20, s20, 128
    s_add_u32 m0, s22, 1024
    v_fma_f32 v62, v62, s28, v10
    v_mfma_f32_16x16x32_bf16 v[88:91], a[216:219], a[192:195], 0
    buffer_load_dwordx4 v6, s[4:7], s20 offen lds
    v_mfma_f32_16x16x32_bf16 v[88:91], a[220:223], a[196:199], v[88:91]
    s_add_u32 s20, s20, 128
    v_fma_f32 v54, v54, s28, v9
    v_fma_f32 v63, v63, s28, v10
    v_mfma_f32_16x16x32_bf16 v[88:91], a[224:227], a[200:203], v[88:91]
    s_add_u32 m0, s22, 2048
    ds_read_b64_tr_b16 a[216:217], v2 offset:18432
    ds_read_b64_tr_b16 a[218:219], v2 offset:12288
    v_mfma_f32_16x16x32_bf16 v[88:91], a[228:231], a[204:207], v[88:91]
    buffer_load_dwordx4 v6, s[4:7], s20 offen lds
    v_mfma_f32_16x16x32_bf16 v[88:91], a[232:235], a[208:211], v[88:91]
    s_add_u32 s20, s20, 12032
    ds_read_b64_tr_b16 a[220:221], v3 offset:18432
    ds_read_b64_tr_b16 a[222:223], v3 offset:12288
    v_mfma_f32_16x16x32_bf16 v[88:91], a[236:239], a[212:215], v[88:91]
    s_add_u32 s30, s30, 1
    v_exp_f32_e64 v54, v54 clamp
    v_mfma_f32_16x16x32_bf16 v[80:83], a[236:239], a[188:191], v[80:83]
    v_add_u32 v103, 4096, v103
    v_fma_f32 v61, v61, s28, v10
    v_mfma_f32_16x16x32_bf16 v[80:83], a[232:235], a[184:187], v[80:83]
    s_cmp_lt_u32 s30, 6
    v_fma_f32 v55, v55, s28, v9
    v_cvt_pk_bf16_f32 v14, v52, v53
    v_mfma_f32_16x16x32_bf16 v[80:83], a[228:231], a[180:183], v[80:83]
    v_exp_f32_e64 v62, v62 clamp
    v_mfma_f32_16x16x32_bf16 v[72:75], a[228:231], a[156:159], v[72:75]
    v_exp_f32_e64 v55, v55 clamp
    v_mfma_f32_16x16x32_bf16 v[72:75], a[232:235], a[160:163], v[72:75]
    v_exp_f32_e64 v61, v61 clamp
    v_mfma_f32_16x16x32_bf16 v[72:75], a[236:239], a[164:167], v[72:75]
    v_mfma_f32_16x16x32_bf16 v[64:67], a[236:239], a[140:143], v[64:67]
    ds_read_b64_tr_b16 a[224:225], v4 offset:18432
    ds_read_b64_tr_b16 a[226:227], v4 offset:12288
    v_mfma_f32_16x16x32_bf16 v[64:67], a[232:235], a[136:139], v[64:67]
    v_exp_f32_e64 v60, v60 clamp
    v_mfma_f32_16x16x32_bf16 v[64:67], a[228:231], a[132:135], v[64:67]
    v_exp_f32_e64 v63, v63 clamp
    v_mfma_f32_16x16x32_bf16 v[56:59], a[228:231], a[108:111], v[56:59]
    ds_read_b64_tr_b16 a[228:229], v5 offset:18432
    v_cvt_pk_bf16_f32 v15, v54, v55
    v_mfma_f32_16x16x32_bf16 v[56:59], a[232:235], a[112:115], v[56:59]
    s_waitcnt lgkmcnt(3)
    ds_read_b64_tr_b16 a[230:231], v5 offset:12288
    v_mfma_f32_16x16x32_bf16 v[56:59], a[236:239], a[116:119], v[56:59]
    s_cbranch_scc1 L_loop5w0
    s_cmp_ge_u32 s37, 6
    s_cbranch_scc1 L_end5
    s_cmp_eq_u32 s32, 0
    s_cbranch_scc1 L_tr54
    s_branch L_tr55
    .p2align 6
L_loop5w1:
    v_mfma_f32_16x16x32_bf16 v[112:115], a[216:219], v[16:19], v[112:115]
    ds_read_b128 v[96:99], v103 offset:0
    v_fma_f32 v71, v71, s28, v11
    v_mfma_f32_16x16x32_bf16 v[116:119], a[220:223], v[16:19], v[116:119]
    v_fma_f32 v84, v84, s28, v13
    v_fma_f32 v81, v81, s28, v12
    v_mfma_f32_16x16x32_bf16 v[164:167], a[220:223], v[20:23], v[164:167]
    ds_read_b64_tr_b16 a[232:233], v2 offset:19456
    v_fma_f32 v76, v76, s28, v12
    v_mfma_f32_16x16x32_bf16 v[160:163], a[216:219], v[20:23], v[160:163]
    v_exp_f32_e64 v71, v71 clamp
    v_mfma_f32_16x16x32_bf16 v[208:211], a[216:219], v[28:31], v[208:211]
    v_fma_f32 v86, v86, s28, v13
    v_mfma_f32_16x16x32_bf16 v[212:215], a[220:223], v[28:31], v[212:215]
    v_fma_f32 v77, v77, s28, v12
    v_fma_f32 v88, v88, s28, v13
    v_mfma_f32_16x16x32_bf16 a[4:7], a[220:223], v[32:35], a[4:7]
    ds_read_b64_tr_b16 a[236:237], v3 offset:19456
    v_fma_f32 v83, v83, s28, v12
    v_mfma_f32_16x16x32_bf16 a[0:3], a[216:219], v[32:35], a[0:3]
    ds_read_b64_tr_b16 a[234:235], v2 offset:13312
    v_fma_f32 v65, v65, s28, v10
    v_mfma_f32_16x16x32_bf16 a[48:51], a[216:219], v[40:43], a[48:51]
    s_add_u32 s39, s39, 12288
    v_fma_f32 v57, v57, s28, v9
    v_fma_f32 v73, v73, s28, v11
    v_mfma_f32_16x16x32_bf16 a[52:55], a[220:223], v[40:43], a[52:55]
    s_waitcnt lgkmcnt(4)
    v_fma_f32 v68, v68, s28, v11
    v_fma_f32 v79, v79, s28, v12
    v_mfma_f32_16x16x32_bf16 a[56:59], a[224:227], v[40:43], a[56:59]
    s_waitcnt lgkmcnt(3)
    buffer_store_dwordx4 v[96:99], v6, s[16:19], s24 offen offset:0 nt
    ds_read_b64_tr_b16 a[220:221], v5 offset:19456
    s_add_u32 m0, s23, 0
    ds_read_b64_tr_b16 a[238:239], v3 offset:13312
    v_mfma_f32_16x16x32_bf16 a[60:63], a[228:231], v[40:43], a[60:63]
    v_exp_f32_e64 v88, v88 clamp
    v_mfma_f32_16x16x32_bf16 a[12:15], a[228:231], v[32:35], a[12:15]
    v_fma_f32 v90, v90, s28, v13
    v_fma_f32 v85, v85, s28, v13
    v_mfma_f32_16x16x32_bf16 a[8:11], a[224:227], v[32:35], a[8:11]
    v_fma_f32 v91, v91, s28, v13
    v_mfma_f32_16x16x32_bf16 v[216:219], a[224:227], v[28:31], v[216:219]
    ds_read_b64_tr_b16 a[218:219], v4 offset:13312
    v_fma_f32 v87, v87, s28, v13
    v_mfma_f32_16x16x32_bf16 v[220:223], a[228:231], v[28:31], v[220:223]
    v_exp_f32_e64 v85, v85 clamp
    v_mfma_f32_16x16x32_bf16 v[172:175], a[228:231], v[20:23], v[172:175]
    buffer_load_dwordx4 v6, s[12:15], s25 offen nt lds
    v_mfma_f32_16x16x32_bf16 v[168:171], a[224:227], v[20:23], v[168:171]
    ds_read_b64_tr_b16 a[216:217], v4 offset:19456
    v_fma_f32 v66, v66, s28, v10
    v_mfma_f32_16x16x32_bf16 v[120:123], a[224:227], v[16:19], v[120:123]
    v_exp_f32_e64 v65, v65 clamp
    v_mfma_f32_16x16x32_bf16 v[124:127], a[228:231], v[16:19], v[124:127]
    s_waitcnt lgkmcnt(4)
    ds_read_b64_tr_b16 a[224:225], v2 offset:20480
    ds_read_b64_tr_b16 a[222:223], v5 offset:13312
    v_mfma_f32_16x16x32_bf16 v[128:131], a[232:235], v[16:19], v[128:131]
    s_waitcnt lgkmcnt(4)
    v_mfma_f32_16x16x32_bf16 v[132:135], a[236:239], v[16:19], v[132:135]
    v_mfma_f32_16x16x32_bf16 v[180:183], a[236:239], v[20:23], v[180:183]
    ds_read_b64_tr_b16 a[226:227], v2 offset:14336
    v_fma_f32 v70, v70, s28, v11
    v_mfma_f32_16x16x32_bf16 v[176:179], a[232:235], v[20:23], v[176:179]
    ds_read_b64_tr_b16 a[228:229], v3 offset:20480
    v_fma_f32 v74, v74, s28, v11
    v_mfma_f32_16x16x32_bf16 v[224:227], a[232:235], v[28:31], v[224:227]
    v_exp_f32_e64 v81, v81 clamp
    v_mfma_f32_16x16x32_bf16 v[228:231], a[236:239], v[28:31], v[228:231]
    v_exp_f32_e64 v76, v76 clamp
    v_mfma_f32_16x16x32_bf16 a[20:23], a[236:239], v[32:35], a[20:23]
    v_fma_f32 v80, v80, s28, v12
    v_fma_f32 v69, v69, s28, v11
    v_mfma_f32_16x16x32_bf16 a[16:19], a[232:235], v[32:35], a[16:19]
    v_exp_f32_e64 v73, v73 clamp
    v_mfma_f32_16x16x32_bf16 a[64:67], a[232:235], v[40:43], a[64:67]
    ds_read_b64_tr_b16 a[230:231], v3 offset:14336
    ds_read_b64_tr_b16 a[232:233], v4 offset:20480
    v_mfma_f32_16x16x32_bf16 a[68:71], a[236:239], v[40:43], a[68:71]
    s_waitcnt lgkmcnt(4)
    ds_read_b64_tr_b16 a[236:237], v5 offset:20480
    ds_read_b64_tr_b16 a[238:239], v5 offset:14336
    v_mfma_f32_16x16x32_bf16 a[72:75], a[216:219], v[40:43], a[72:75]
    ds_read_b64_tr_b16 a[234:235], v4 offset:14336
    v_mfma_f32_16x16x32_bf16 a[76:79], a[220:223], v[40:43], a[76:79]
    v_fma_f32 v72, v72, s28, v11
    v_fma_f32 v67, v67, s28, v10
    v_mfma_f32_16x16x32_bf16 a[28:31], a[220:223], v[32:35], a[28:31]
    v_exp_f32_e64 v70, v70 clamp
    v_mfma_f32_16x16x32_bf16 a[24:27], a[216:219], v[32:35], a[24:27]
    v_exp_f32_e64 v67, v67 clamp
    v_mfma_f32_16x16x32_bf16 v[232:235], a[216:219], v[28:31], v[232:235]
    v_exp_f32_e64 v69, v69 clamp
    v_mfma_f32_16x16x32_bf16 v[236:239], a[220:223], v[28:31], v[236:239]
    v_exp_f32_e64 v68, v68 clamp
    v_mfma_f32_16x16x32_bf16 v[188:191], a[220:223], v[20:23], v[188:191]
    v_exp_f32_e64 v57, v57 clamp
    v_mfma_f32_16x16x32_bf16 v[184:187], a[216:219], v[20:23], v[184:187]
    v_exp_f32_e64 v84, v84 clamp
    v_mfma_f32_16x16x32_bf16 v[136:139], a[216:219], v[16:19], v[136:139]
    ds_read_b128 v[96:99], v103 offset:1024
    v_fma_f32 v56, v56, s28, v9
    v_mfma_f32_16x16x32_bf16 v[140:143], a[220:223], v[16:19], v[140:143]
    s_waitcnt lgkmcnt(2)
    v_exp_f32_e64 v86, v86 clamp
    v_mfma_f32_16x16x32_bf16 v[144:147], a[224:227], v[16:19], v[144:147]
    s_waitcnt vmcnt(12) lgkmcnt(1)
    v_exp_f32_e64 v87, v87 clamp
    v_mfma_f32_16x16x32_bf16 v[148:151], a[228:231], v[16:19], v[148:151]
    v_exp_f32_e64 v77, v77 clamp
    v_mfma_f32_16x16x32_bf16 v[196:199], a[228:231], v[20:23], v[196:199]
    v_fma_f32 v58, v58, s28, v9
    v_fma_f32 v89, v89, s28, v13
    v_mfma_f32_16x16x32_bf16 v[192:195], a[224:227], v[20:23], v[192:195]
    s_add_u32 m0, s22, 36864
    v_exp_f32_e64 v56, v56 clamp
    v_mfma_f32_16x16x32_bf16 v[240:243], a[224:227], v[28:31], v[240:243]
    v_exp_f32_e64 v89, v89 clamp
    v_mfma_f32_16x16x32_bf16 v[244:247], a[228:231], v[28:31], v[244:247]
    s_barrier
    v_mfma_f32_16x16x32_bf16 a[36:39], a[228:231], v[32:35], a[36:39]
    buffer_load_dwordx4 v6, s[8:11], s21 offen lds
    v_mfma_f32_16x16x32_bf16 a[32:35], a[224:227], v[32:35], a[32:35]
    s_add_u32 s21, s21, 128
    v_mfma_f32_16x16x32_bf16 a[80:83], a[224:227], v[40:43], a[80:83]
    ds_read_b128 a[216:219], v0 offset:12288
    v_cvt_pk_bf16_f32 v39, v86, v87
    v_mfma_f32_16x16x32_bf16 a[84:87], a[228:231], v[40:43], a[84:87]
    ds_read_b128 a[220:223], v1 offset:12288
    v_cvt_pk_bf16_f32 v27, v70, v71
    v_mfma_f32_16x16x32_bf16 a[88:91], a[232:235], v[40:43], a[88:91]
    v_fma_f32 v64, v64, s28, v10
    v_mfma_f32_16x16x32_bf16 a[92:95], a[236:239], v[40:43], a[92:95]
    ds_read_b128 a[224:227], v0 offset:13312
    v_mfma_f32_16x16x32_bf16 a[44:47], a[236:239], v[32:35], a[44:47]
    s_add_u32 m0, s22, 37888
    v_exp_f32_e64 v80, v80 clamp
    v_mfma_f32_16x16x32_bf16 a[40:43], a[232:235], v[32:35], a[40:43]
    v_cvt_pk_bf16_f32 v38, v84, v85
    v_fma_f32 v78, v78, s28, v12
    v_mfma_f32_16x16x32_bf16 v[248:251], a[232:235], v[28:31], v[248:251]
    ds_read_b128 a[228:231], v1 offset:13312
    v_cvt_pk_bf16_f32 v40, v88, v89
    v_mfma_f32_16x16x32_bf16 v[252:255], a[236:239], v[28:31], v[252:255]
    v_exp_f32_e64 v91, v91 clamp
    v_mfma_f32_16x16x32_bf16 v[204:207], a[236:239], v[20:23], v[204:207]
    buffer_load_dwordx4 v6, s[8:11], s21 offen lds
    v_mfma_f32_16x16x32_bf16 v[200:203], a[232:235], v[20:23], v[200:203]
    s_add_u32 s21, s21, 128
    v_fma_f32 v59, v59, s28, v9
    s_add_u32 m0, s22, 38912
    v_mfma_f32_16x16x32_bf16 v[152:155], a[232:235], v[16:19], v[152:155]
    buffer_load_dwordx4 v6, s[8:11], s21 offen lds
    v_mfma_f32_16x16x32_bf16 v[156:159], a[236:239], v[16:19], v[156:159]
    s_waitcnt lgkmcnt(2)
    v_cvt_pk_bf16_f32 v23, v62, v63
    v_cvt_pk_bf16_f32 v26, v68, v69
    v_mfma_f32_16x16x32_bf16 v[52:55], a[216:219], a[96:99], 0
    v_cvt_pk_bf16_f32 v34, v76, v77
    v_cvt_pk_bf16_f32 v22, v60, v61
    v_mfma_f32_16x16x32_bf16 v[52:55], a[220:223], a[100:103], v[52:55]
    s_waitcnt lgkmcnt(1)
    v_exp_f32_e64 v66, v66 clamp
    v_mfma_f32_16x16x32_bf16 v[52:55], a[224:227], a[104:107], v[52:55]
    v_exp_f32_e64 v79, v79 clamp
    v_mfma_f32_16x16x32_bf16 v[60:63], a[224:227], a[128:131], 0
    v_exp_f32_e64 v78, v78 clamp
    v_mfma_f32_16x16x32_bf16 v[60:63], a[220:223], a[124:127], v[60:63]
    ds_read_b128 a[232:235], v0 offset:14336
    v_mfma_f32_16x16x32_bf16 v[60:63], a[216:219], a[120:123], v[60:63]
    ds_read_b128 a[236:239], v1 offset:14336
    v_mfma_f32_16x16x32_bf16 v[68:71], a[216:219], a[144:147], 0
    v_cvt_pk_bf16_f32 v36, v80, v81
    v_cvt_pk_bf16_f32 v35, v78, v79
    v_mfma_f32_16x16x32_bf16 v[68:71], a[220:223], a[148:151], v[68:71]
    v_exp_f32_e64 v72, v72 clamp
    v_mfma_f32_16x16x32_bf16 v[68:71], a[224:227], a[152:155], v[68:71]
    buffer_store_dwordx4 v[96:99], v7, s[16:19], s24 offen offset:0 nt
    v_cvt_pk_bf16_f32 v28, v72, v73
    v_exp_f32_e64 v64, v64 clamp
    v_mfma_f32_16x16x32_bf16 v[76:79], a[224:227], a[176:179], 0
    v_exp_f32_e64 v83, v83 clamp
    v_mfma_f32_16x16x32_bf16 v[76:79], a[220:223], a[172:175], v[76:79]
    v_mfma_f32_16x16x32_bf16 v[76:79], a[216:219], a[168:171], v[76:79]
    v_exp_f32_e64 v59, v59 clamp
    v_mfma_f32_16x16x32_bf16 v[84:87], a[216:219], a[192:195], 0
    s_add_u32 s21, s21, 12032
    v_mfma_f32_16x16x32_bf16 v[84:87], a[220:223], a[196:199], v[84:87]
    v_exp_f32_e64 v90, v90 clamp
    v_mfma_f32_16x16x32_bf16 v[84:87], a[224:227], a[200:203], v[84:87]
    s_waitcnt lgkmcnt(0)
    v_cvt_pk_bf16_f32 v41, v90, v91
    v_fma_f32 v75, v75, s28, v11
    v_mfma_f32_16x16x32_bf16 v[84:87], a[228:231], a[204:207], v[84:87]
    v_mfma_f32_16x16x32_bf16 v[84:87], a[232:235], a[208:211], v[84:87]
    s_add_u32 m0, s23, 1024
    v_exp_f32_e64 v58, v58 clamp
    v_mfma_f32_16x16x32_bf16 v[84:87], a[236:239], a[212:215], v[84:87]
    v_fma_f32 v82, v82, s28, v12
    v_mfma_f32_16x16x32_bf16 v[76:79], a[236:239], a[188:191], v[76:79]
    buffer_load_dwordx4 v7, s[12:15], s25 offen nt lds
    v_mfma_f32_16x16x32_bf16 v[76:79], a[232:235], a[184:187], v[76:79]
    s_bitcmp1_b32 s27, 0
    ds_read_b128 a[224:227], v0 offset:19456
    v_cvt_pk_bf16_f32 v16, v56, v57
    v_mfma_f32_16x16x32_bf16 v[76:79], a[228:231], a[180:183], v[76:79]
    v_exp_f32_e64 v82, v82 clamp
    v_mfma_f32_16x16x32_bf16 v[68:71], a[228:231], a[156:159], v[68:71]
    v_exp_f32_e64 v75, v75 clamp
    v_mfma_f32_16x16x32_bf16 v[68:71], a[232:235], a[160:163], v[68:71]
    ds_read_b128 a[216:219], v0 offset:18432
    v_cvt_pk_bf16_f32 v17, v58, v59
    v_mfma_f32_16x16x32_bf16 v[68:71], a[236:239], a[164:167], v[68:71]
    v_cvt_pk_bf16_f32 v24, v64, v65
    v_cvt_pk_bf16_f32 v25, v66, v67
    v_mfma_f32_16x16x32_bf16 v[60:63], a[236:239], a[140:143], v[60:63]
    ds_read_b128 a[220:223], v1 offset:18432
    v_mfma_f32_16x16x32_bf16 v[60:63], a[232:235], a[136:139], v[60:63]
    v_exp_f32_e64 v74, v74 clamp
    v_mfma_f32_16x16x32_bf16 v[60:63], a[228:231], a[132:135], v[60:63]
    s_cselect_b32 s26, s49, 128
    v_mfma_f32_16x16x32_bf16 v[52:55], a[228:231], a[108:111], v[52:55]
    ds_read_b128 a[228:231], v1 offset:19456
    v_mfma_f32_16x16x32_bf16 v[52:55], a[232:235], a[112:115], v[52:55]
    s_lshr_b32 s27, s27, 1
    ds_read_b128 a[232:235], v0 offset:20480
    v_mfma_f32_16x16x32_bf16 v[52:55], a[236:239], a[116:119], v[52:55]
    ds_read_b128 a[236:239], v1 offset:20480
    v_cvt_pk_bf16_f32 v29, v74, v75
    v_mfma_f32_16x16x32_bf16 v[44:47], a[248:251], v[14:17], v[44:47]
    s_nop 0
    v_smfmac_f32_16x16x64_bf16 v[44:47], a[240:243], v[22:29], v101
    v_cvt_pk_bf16_f32 v37, v82, v83
    s_nop 1
    v_smfmac_f32_16x16x64_bf16 v[44:47], a[244:247], v[34:41], v101
    s_waitcnt lgkmcnt(4)
    v_mfma_f32_16x16x32_bf16 v[56:59], a[216:219], a[96:99], 0
    ds_read_b128 v[96:99], v103 offset:2048
    s_waitcnt lgkmcnt(4)
    v_mfma_f32_16x16x32_bf16 v[56:59], a[220:223], a[100:103], v[56:59]
    v_mfma_f32_16x16x32_bf16 v[56:59], a[224:227], a[104:107], v[56:59]
    v_mfma_f32_16x16x32_bf16 v[64:67], a[224:227], a[128:131], 0
    s_add_u32 s24, s24, s26
    v_mfma_f32_16x16x32_bf16 v[64:67], a[220:223], a[124:127], v[64:67]
    s_add_u32 s25, s25, s26
    v_cmp_lt_f32 vcc, s29, v44
    v_mfma_f32_16x16x32_bf16 v[64:67], a[216:219], a[120:123], v[64:67]
    s_waitcnt vmcnt(12) lgkmcnt(1)
    s_barrier
    v_mfma_f32_16x16x32_bf16 v[72:75], a[216:219], a[144:147], 0
    s_nop 0
    s_cbranch_vccnz L_rs_loop5w1a
L_ret_loop5w1a:
    v_mfma_f32_16x16x32_bf16 v[72:75], a[220:223], a[148:151], v[72:75]
    v_fma_f32 v68, v68, s28, v11
    v_fma_f32 v54, v54, s28, v9
    v_mfma_f32_16x16x32_bf16 v[72:75], a[224:227], a[152:155], v[72:75]
    s_add_u32 m0, s22, 12288
    v_fma_f32 v78, v78, s28, v12
    v_fma_f32 v70, v70, s28, v11
    v_mfma_f32_16x16x32_bf16 v[80:83], a[224:227], a[176:179], 0
    buffer_load_dwordx4 v6, s[4:7], s20 offen lds
    v_mfma_f32_16x16x32_bf16 v[80:83], a[220:223], a[172:175], v[80:83]
    v_fma_f32 v53, v53, s28, v9
    v_fma_f32 v69, v69, s28, v11
    v_mfma_f32_16x16x32_bf16 v[80:83], a[216:219], a[168:171], v[80:83]
    s_add_u32 s20, s20, 128
    v_fma_f32 v76, v76, s28, v12
    s_add_u32 m0, s22, 13312
    v_mfma_f32_16x16x32_bf16 v[88:91], a[216:219], a[192:195], 0
    buffer_load_dwordx4 v6, s[4:7], s20 offen lds
    v_mfma_f32_16x16x32_bf16 v[88:91], a[220:223], a[196:199], v[88:91]
    v_fma_f32 v60, v60, s28, v10
    s_add_u32 s20, s20, 128
    v_mfma_f32_16x16x32_bf16 v[88:91], a[224:227], a[200:203], v[88:91]
    v_mfma_f32_16x16x32_bf16 v[88:91], a[228:231], a[204:207], v[88:91]
    s_add_u32 m0, s22, 14336
    ds_read_b64_tr_b16 a[216:217], v2 offset:0
    v_mfma_f32_16x16x32_bf16 v[88:91], a[232:235], a[208:211], v[88:91]
    ds_read_b64_tr_b16 a[218:219], v2 offset:6144
    v_fma_f32 v62, v62, s28, v10
    v_mfma_f32_16x16x32_bf16 v[88:91], a[236:239], a[212:215], v[88:91]
    buffer_load_dwordx4 v6, s[4:7], s20 offen lds
    v_mfma_f32_16x16x32_bf16 v[80:83], a[236:239], a[188:191], v[80:83]
    ds_read_b64_tr_b16 a[220:221], v3 offset:0
    ds_read_b64_tr_b16 a[222:223], v3 offset:6144
    v_mfma_f32_16x16x32_bf16 v[80:83], a[232:235], a[184:187], v[80:83]
    v_exp_f32_e64 v78, v78 clamp
    v_mfma_f32_16x16x32_bf16 v[80:83], a[228:231], a[180:183], v[80:83]
    v_exp_f32_e64 v60, v60 clamp
    v_mfma_f32_16x16x32_bf16 v[72:75], a[228:231], a[156:159], v[72:75]
    v_fma_f32 v63, v63, s28, v10
    v_fma_f32 v88, v88, s28, v13
    v_mfma_f32_16x16x32_bf16 v[72:75], a[232:235], a[160:163], v[72:75]
    v_fma_f32 v86, v86, s28, v13
    v_fma_f32 v85, v85, s28, v13
    v_mfma_f32_16x16x32_bf16 v[72:75], a[236:239], a[164:167], v[72:75]
    v_fma_f32 v52, v52, s28, v9
    v_mfma_f32_16x16x32_bf16 v[64:67], a[236:239], a[140:143], v[64:67]
    ds_read_b64_tr_b16 a[224:225], v4 offset:0
    v_fma_f32 v83, v83, s28, v12
    v_mfma_f32_16x16x32_bf16 v[64:67], a[232:235], a[136:139], v[64:67]
    ds_read_b64_tr_b16 a[226:227], v4 offset:6144
    v_mfma_f32_16x16x32_bf16 v[64:67], a[228:231], a[132:135], v[64:67]
    s_add_u32 s20, s20, 12032
    v_exp_f32_e64 v53, v53 clamp
    v_mfma_f32_16x16x32_bf16 v[56:59], a[228:231], a[108:111], v[56:59]
    v_exp_f32_e64 v69, v69 clamp
    v_mfma_f32_16x16x32_bf16 v[56:59], a[232:235], a[112:115], v[56:59]
    s_add_u32 s39, s39, 12288
    ds_read_b64_tr_b16 a[228:229], v5 offset:0
    v_fma_f32 v87, v87, s28, v13
    v_mfma_f32_16x16x32_bf16 v[56:59], a[236:239], a[116:119], v[56:59]
    s_waitcnt lgkmcnt(3)
    v_exp_f32_e64 v62, v62 clamp
    v_mfma_f32_16x16x32_bf16 v[112:115], a[216:219], v[14:17], v[112:115]
    ds_read_b64_tr_b16 a[230:231], v5 offset:6144
    ds_read_b64_tr_b16 a[234:235], v2 offset:7168
    v_mfma_f32_16x16x32_bf16 v[116:119], a[220:223], v[14:17], v[116:119]
    v_exp_f32_e64 v68, v68 clamp
    v_mfma_f32_16x16x32_bf16 v[164:167], a[220:223], v[22:25], v[164:167]
    s_add_u32 m0, s23, 2048
    ds_read_b64_tr_b16 a[236:237], v3 offset:1024
    v_fma_f32 v84, v84, s28, v13
    v_mfma_f32_16x16x32_bf16 v[160:163], a[216:219], v[22:25], v[160:163]
    v_fma_f32 v67, v67, s28, v10
    v_fma_f32 v65, v65, s28, v10
    v_mfma_f32_16x16x32_bf16 v[208:211], a[216:219], v[26:29], v[208:211]
    v_exp_f32_e64 v87, v87 clamp
    v_mfma_f32_16x16x32_bf16 v[212:215], a[220:223], v[26:29], v[212:215]
    v_exp_f32_e64 v84, v84 clamp
    v_mfma_f32_16x16x32_bf16 a[4:7], a[220:223], v[34:37], a[4:7]
    buffer_store_dwordx4 v[96:99], v6, s[16:19], s24 offen offset:0 nt
    v_fma_f32 v77, v77, s28, v12
    v_exp_f32_e64 v54, v54 clamp
    v_mfma_f32_16x16x32_bf16 a[0:3], a[216:219], v[34:37], a[0:3]
    ds_read_b64_tr_b16 a[238:239], v3 offset:7168
    v_fma_f32 v79, v79, s28, v12
    v_mfma_f32_16x16x32_bf16 a[48:51], a[216:219], v[38:41], a[48:51]
    ds_read_b64_tr_b16 a[218:219], v4 offset:7168
    ds_read_b64_tr_b16 a[232:233], v2 offset:1024
    v_mfma_f32_16x16x32_bf16 a[52:55], a[220:223], v[38:41], a[52:55]
    s_waitcnt lgkmcnt(4)
    v_exp_f32_e64 v85, v85 clamp
    v_mfma_f32_16x16x32_bf16 a[56:59], a[224:227], v[38:41], a[56:59]
    v_fma_f32 v56, v56, s28, v9
    v_fma_f32 v75, v75, s28, v11
    v_mfma_f32_16x16x32_bf16 a[60:63], a[228:231], v[38:41], a[60:63]
    ds_read_b64_tr_b16 a[216:217], v4 offset:1024
    v_fma_f32 v73, v73, s28, v11
    v_mfma_f32_16x16x32_bf16 a[12:15], a[228:231], v[34:37], a[12:15]
    v_exp_f32_e64 v76, v76 clamp
    v_mfma_f32_16x16x32_bf16 a[8:11], a[224:227], v[34:37], a[8:11]
    v_exp_f32_e64 v52, v52 clamp
    v_mfma_f32_16x16x32_bf16 v[216:219], a[224:227], v[26:29], v[216:219]
    v_exp_f32_e64 v56, v56 clamp
    v_mfma_f32_16x16x32_bf16 v[220:223], a[228:231], v[26:29], v[220:223]
    buffer_load_dwordx4 v6, s[12:15], s25 offen nt lds
    v_mfma_f32_16x16x32_bf16 v[172:175], a[228:231], v[22:25], v[172:175]
    v_fma_f32 v71, v71, s28, v11
    v_fma_f32 v66, v66, s28, v10
    v_mfma_f32_16x16x32_bf16 v[168:171], a[224:227], v[22:25], v[168:171]
    ds_read_b64_tr_b16 a[220:221], v5 offset:1024
    v_mfma_f32_16x16x32_bf16 v[120:123], a[224:227], v[14:17], v[120:123]
    v_fma_f32 v91, v91, s28, v13
    v_fma_f32 v74, v74, s28, v11
    v_mfma_f32_16x16x32_bf16 v[124:127], a[228:231], v[14:17], v[124:127]
    s_waitcnt lgkmcnt(2)
    ds_read_b64_tr_b16 a[222:223], v5 offset:7168
    ds_read_b64_tr_b16 a[226:227], v2 offset:8192
    v_mfma_f32_16x16x32_bf16 v[128:131], a[232:235], v[14:17], v[128:131]
    ds_read_b64_tr_b16 a[224:225], v2 offset:2048
    v_mfma_f32_16x16x32_bf16 v[132:135], a[236:239], v[14:17], v[132:135]
    v_fma_f32 v89, v89, s28, v13
    v_mfma_f32_16x16x32_bf16 v[180:183], a[236:239], v[22:25], v[180:183]
    v_exp_f32_e64 v73, v73 clamp
    v_mfma_f32_16x16x32_bf16 v[176:179], a[232:235], v[22:25], v[176:179]
    v_exp_f32_e64 v66, v66 clamp
    v_mfma_f32_16x16x32_bf16 v[224:227], a[232:235], v[26:29], v[224:227]
    ds_read_b64_tr_b16 a[230:231], v3 offset:8192
    v_mfma_f32_16x16x32_bf16 v[228:231], a[236:239], v[26:29], v[228:231]
    ds_read_b64_tr_b16 a[228:229], v3 offset:2048
    v_fma_f32 v82, v82, s28, v12
    v_mfma_f32_16x16x32_bf16 a[20:23], a[236:239], v[34:37], a[20:23]
    v_fma_f32 v55, v55, s28, v9
    v_fma_f32 v80, v80, s28, v12
    v_mfma_f32_16x16x32_bf16 a[16:19], a[232:235], v[34:37], a[16:19]
    v_exp_f32_e64 v83, v83 clamp
    v_mfma_f32_16x16x32_bf16 a[64:67], a[232:235], v[38:41], a[64:67]
    v_exp_f32_e64 v77, v77 clamp
    v_mfma_f32_16x16x32_bf16 a[68:71], a[236:239], v[38:41], a[68:71]
    s_waitcnt lgkmcnt(3)
    ds_read_b64_tr_b16 a[238:239], v5 offset:8192
    ds_read_b64_tr_b16 a[234:235], v4 offset:8192
    v_mfma_f32_16x16x32_bf16 a[72:75], a[216:219], v[38:41], a[72:75]
    v_exp_f32_e64 v71, v71 clamp
    v_mfma_f32_16x16x32_bf16 a[76:79], a[220:223], v[38:41], a[76:79]
    ds_read_b64_tr_b16 a[236:237], v5 offset:2048
    v_fma_f32 v61, v61, s28, v10
    v_mfma_f32_16x16x32_bf16 a[28:31], a[220:223], v[34:37], a[28:31]
    ds_read_b64_tr_b16 a[232:233], v4 offset:2048
    v_mfma_f32_16x16x32_bf16 a[24:27], a[216:219], v[34:37], a[24:27]
    v_fma_f32 v81, v81, s28, v12
    v_mfma_f32_16x16x32_bf16 v[232:235], a[216:219], v[26:29], v[232:235]
    v_exp_f32_e64 v75, v75 clamp
    v_mfma_f32_16x16x32_bf16 v[236:239], a[220:223], v[26:29], v[236:239]
    v_exp_f32_e64 v55, v55 clamp
    v_mfma_f32_16x16x32_bf16 v[188:191], a[220:223], v[22:25], v[188:191]
    v_exp_f32_e64 v81, v81 clamp
    v_mfma_f32_16x16x32_bf16 v[184:187], a[216:219], v[22:25], v[184:187]
    v_fma_f32 v59, v59, s28, v9
    v_fma_f32 v90, v90, s28, v13
    v_mfma_f32_16x16x32_bf16 v[136:139], a[216:219], v[14:17], v[136:139]
    v_mfma_f32_16x16x32_bf16 v[140:143], a[220:223], v[14:17], v[140:143]
    s_waitcnt lgkmcnt(2)
    v_exp_f32_e64 v86, v86 clamp
    v_mfma_f32_16x16x32_bf16 v[144:147], a[224:227], v[14:17], v[144:147]
    v_exp_f32_e64 v59, v59 clamp
    v_mfma_f32_16x16x32_bf16 v[148:151], a[228:231], v[14:17], v[148:151]
    v_mfma_f32_16x16x32_bf16 v[196:199], a[228:231], v[22:25], v[196:199]
    ds_read_b128 v[96:99], v103 offset:3072
    v_fma_f32 v72, v72, s28, v11
    v_mfma_f32_16x16x32_bf16 v[192:195], a[224:227], v[22:25], v[192:195]
    v_exp_f32_e64 v61, v61 clamp
    v_mfma_f32_16x16x32_bf16 v[240:243], a[224:227], v[26:29], v[240:243]
    s_waitcnt vmcnt(12) lgkmcnt(1)
    v_exp_f32_e64 v63, v63 clamp
    v_mfma_f32_16x16x32_bf16 v[244:247], a[228:231], v[26:29], v[244:247]
    s_barrier
    v_mfma_f32_16x16x32_bf16 a[36:39], a[228:231], v[34:37], a[36:39]
    s_add_u32 m0, s22, 24576
    v_cvt_pk_bf16_f32 v19, v54, v55
    v_mfma_f32_16x16x32_bf16 a[32:35], a[224:227], v[34:37], a[32:35]
    buffer_load_dwordx4 v6, s[8:11], s21 offen lds
    v_mfma_f32_16x16x32_bf16 a[80:83], a[224:227], v[38:41], a[80:83]
    s_add_u32 s21, s21, 128
    ds_read_b128 a[216:219], v0 offset:0
    v_cvt_pk_bf16_f32 v42, v84, v85
    v_mfma_f32_16x16x32_bf16 a[84:87], a[228:231], v[38:41], a[84:87]
    ds_read_b128 a[220:223], v1 offset:0
    v_fma_f32 v64, v64, s28, v10
    v_mfma_f32_16x16x32_bf16 a[88:91], a[232:235], v[38:41], a[88:91]
    s_add_u32 m0, s22, 25600
    ds_read_b128 a[224:227], v0 offset:1024
    v_fma_f32 v57, v57, s28, v9
    v_mfma_f32_16x16x32_bf16 a[92:95], a[236:239], v[38:41], a[92:95]
    buffer_load_dwordx4 v6, s[8:11], s21 offen lds
    v_mfma_f32_16x16x32_bf16 a[44:47], a[236:239], v[34:37], a[44:47]
    v_exp_f32_e64 v57, v57 clamp
    v_mfma_f32_16x16x32_bf16 a[40:43], a[232:235], v[34:37], a[40:43]
    v_cvt_pk_bf16_f32 v43, v86, v87
    s_add_u32 s21, s21, 128
    v_mfma_f32_16x16x32_bf16 v[248:251], a[232:235], v[26:29], v[248:251]
    s_add_u32 m0, s22, 26624
    v_exp_f32_e64 v79, v79 clamp
    v_mfma_f32_16x16x32_bf16 v[252:255], a[236:239], v[26:29], v[252:255]
    buffer_load_dwordx4 v6, s[8:11], s21 offen lds
    v_mfma_f32_16x16x32_bf16 v[204:207], a[236:239], v[22:25], v[204:207]
    v_exp_f32_e64 v70, v70 clamp
    v_mfma_f32_16x16x32_bf16 v[200:203], a[232:235], v[22:25], v[200:203]
    v_cvt_pk_bf16_f32 v31, v70, v71
    v_cvt_pk_bf16_f32 v18, v52, v53
    v_mfma_f32_16x16x32_bf16 v[152:155], a[232:235], v[14:17], v[152:155]
    v_exp_f32_e64 v72, v72 clamp
    v_mfma_f32_16x16x32_bf16 v[156:159], a[236:239], v[14:17], v[156:159]
    s_waitcnt lgkmcnt(1)
    v_exp_f32_e64 v67, v67 clamp
    v_mfma_f32_16x16x32_bf16 v[52:55], a[216:219], a[96:99], 0
    v_fma_f32 v58, v58, s28, v9
    v_cvt_pk_bf16_f32 v22, v60, v61
    v_mfma_f32_16x16x32_bf16 v[52:55], a[220:223], a[100:103], v[52:55]
    s_add_u32 s21, s21, 12032
    ds_read_b128 a[236:239], v1 offset:2048
    s_waitcnt lgkmcnt(1)
    v_mfma_f32_16x16x32_bf16 v[52:55], a[224:227], a[104:107], v[52:55]
    v_cvt_pk_bf16_f32 v16, v56, v57
    v_cvt_pk_bf16_f32 v23, v62, v63
    v_mfma_f32_16x16x32_bf16 v[60:63], a[224:227], a[128:131], 0
    v_cvt_pk_bf16_f32 v35, v78, v79
    v_cvt_pk_bf16_f32 v34, v76, v77
    v_mfma_f32_16x16x32_bf16 v[60:63], a[220:223], a[124:127], v[60:63]
    ds_read_b128 a[228:231], v1 offset:1024
    v_mfma_f32_16x16x32_bf16 v[60:63], a[216:219], a[120:123], v[60:63]
    buffer_store_dwordx4 v[96:99], v7, s[16:19], s24 offen offset:0 nt
    ds_read_b128 a[232:235], v0 offset:2048
    v_cvt_pk_bf16_f32 v30, v68, v69
    v_mfma_f32_16x16x32_bf16 v[68:71], a[216:219], a[144:147], 0
    v_exp_f32_e64 v74, v74 clamp
    v_mfma_f32_16x16x32_bf16 v[68:71], a[220:223], a[148:151], v[68:71]
    v_exp_f32_e64 v65, v65 clamp
    v_mfma_f32_16x16x32_bf16 v[68:71], a[224:227], a[152:155], v[68:71]
    s_add_u32 m0, s23, 3072
    v_exp_f32_e64 v90, v90 clamp
    v_mfma_f32_16x16x32_bf16 v[76:79], a[224:227], a[176:179], 0
    v_mfma_f32_16x16x32_bf16 v[76:79], a[220:223], a[172:175], v[76:79]
    v_exp_f32_e64 v91, v91 clamp
    v_mfma_f32_16x16x32_bf16 v[76:79], a[216:219], a[168:171], v[76:79]
    v_exp_f32_e64 v88, v88 clamp
    v_mfma_f32_16x16x32_bf16 v[84:87], a[216:219], a[192:195], 0
    v_mfma_f32_16x16x32_bf16 v[84:87], a[220:223], a[196:199], v[84:87]
    v_mfma_f32_16x16x32_bf16 v[84:87], a[224:227], a[200:203], v[84:87]
    s_waitcnt lgkmcnt(1)
    ds_read_b128 a[224:227], v0 offset:7168
    v_cvt_pk_bf16_f32 v41, v90, v91
    v_mfma_f32_16x16x32_bf16 v[84:87], a[228:231], a[204:207], v[84:87]
    s_waitcnt lgkmcnt(1)
    ds_read_b128 a[220:223], v1 offset:6144
    v_cvt_pk_bf16_f32 v28, v72, v73
    v_mfma_f32_16x16x32_bf16 v[84:87], a[232:235], a[208:211], v[84:87]
    v_exp_f32_e64 v80, v80 clamp
    v_mfma_f32_16x16x32_bf16 v[84:87], a[236:239], a[212:215], v[84:87]
    v_exp_f32_e64 v82, v82 clamp
    v_mfma_f32_16x16x32_bf16 v[76:79], a[236:239], a[188:191], v[76:79]
    buffer_load_dwordx4 v7, s[12:15], s25 offen nt lds
    v_mfma_f32_16x16x32_bf16 v[76:79], a[232:235], a[184:187], v[76:79]
    v_exp_f32_e64 v64, v64 clamp
    v_mfma_f32_16x16x32_bf16 v[76:79], a[228:231], a[180:183], v[76:79]
    v_cvt_pk_bf16_f32 v32, v80, v81
    v_mfma_f32_16x16x32_bf16 v[68:71], a[228:231], a[156:159], v[68:71]
    ds_read_b128 a[216:219], v0 offset:6144
    v_mfma_f32_16x16x32_bf16 v[68:71], a[232:235], a[160:163], v[68:71]
    v_exp_f32_e64 v89, v89 clamp
    v_mfma_f32_16x16x32_bf16 v[68:71], a[236:239], a[164:167], v[68:71]
    s_bitcmp1_b32 s27, 0
    v_mfma_f32_16x16x32_bf16 v[60:63], a[236:239], a[140:143], v[60:63]
    v_exp_f32_e64 v58, v58 clamp
    v_mfma_f32_16x16x32_bf16 v[60:63], a[232:235], a[136:139], v[60:63]
    v_cvt_pk_bf16_f32 v17, v58, v59
    v_cvt_pk_bf16_f32 v21, v66, v67
    v_mfma_f32_16x16x32_bf16 v[60:63], a[228:231], a[132:135], v[60:63]
    v_cvt_pk_bf16_f32 v29, v74, v75
    v_cvt_pk_bf16_f32 v20, v64, v65
    v_mfma_f32_16x16x32_bf16 v[52:55], a[228:231], a[108:111], v[52:55]
    s_cselect_b32 s26, s49, 128
    ds_read_b128 a[228:231], v1 offset:7168
    v_cvt_pk_bf16_f32 v33, v82, v83
    v_mfma_f32_16x16x32_bf16 v[52:55], a[232:235], a[112:115], v[52:55]
    ds_read_b128 a[232:235], v0 offset:8192
    v_cvt_pk_bf16_f32 v40, v88, v89
    v_mfma_f32_16x16x32_bf16 v[52:55], a[236:239], a[116:119], v[52:55]
    ds_read_b128 a[236:239], v1 offset:8192
    v_smfmac_f32_16x16x64_bf16 v[48:51], a[240:243], v[16:23], v101
    s_lshr_b32 s27, s27, 1
    v_smfmac_f32_16x16x64_bf16 v[48:51], a[244:247], v[28:35], v101
    v_mfma_f32_16x16x32_bf16 v[48:51], a[248:251], v[40:43], v[48:51]
    s_add_u32 s24, s24, s26
    s_add_u32 s25, s25, s26
    s_waitcnt lgkmcnt(3)
    v_mfma_f32_16x16x32_bf16 v[56:59], a[216:219], a[96:99], 0
    v_add_u32 v103, 4096, v103
    v_mfma_f32_16x16x32_bf16 v[56:59], a[220:223], a[100:103], v[56:59]
    v_mfma_f32_16x16x32_bf16 v[56:59], a[224:227], a[104:107], v[56:59]
    s_nop 0
    v_cmp_lt_f32 vcc, s29, v48
    s_add_u32 s23, s23, 4096
    v_mfma_f32_16x16x32_bf16 v[64:67], a[224:227], a[128:131], 0
    s_nop 2
    s_cbranch_vccnz L_rs_loop5w1b
L_ret_loop5w1b:
    v_mfma_f32_16x16x32_bf16 v[64:67], a[220:223], a[124:127], v[64:67]
    v_fma_f32 v54, v54, s28, v9
    v_fma_f32 v55, v55, s28, v9
    v_mfma_f32_16x16x32_bf16 v[64:67], a[216:219], a[120:123], v[64:67]
    s_waitcnt vmcnt(12) lgkmcnt(0)
    s_cmp_eq_u32 s30, 5
    s_barrier
    v_mfma_f32_16x16x32_bf16 v[72:75], a[216:219], a[144:147], 0
    s_cselect_b32 s26, s62, 0
    s_add_u32 s20, s20, s26
    s_add_u32 m0, s22, 0
    v_mfma_f32_16x16x32_bf16 v[72:75], a[220:223], a[148:151], v[72:75]
    buffer_load_dwordx4 v6, s[4:7], s20 offen lds
    v_mfma_f32_16x16x32_bf16 v[72:75], a[224:227], a[152:155], v[72:75]
    s_add_u32 s20, s20, 128
    s_add_u32 m0, s22, 1024
    v_fma_f32 v61, v61, s28, v10
    v_mfma_f32_16x16x32_bf16 v[80:83], a[224:227], a[176:179], 0
    buffer_load_dwordx4 v6, s[4:7], s20 offen lds
    v_mfma_f32_16x16x32_bf16 v[80:83], a[220:223], a[172:175], v[80:83]
    v_fma_f32 v53, v53, s28, v9
    v_fma_f32 v63, v63, s28, v10
    v_mfma_f32_16x16x32_bf16 v[80:83], a[216:219], a[168:171], v[80:83]
    s_add_u32 s20, s20, 128
    v_exp_f32_e64 v54, v54 clamp
    v_mfma_f32_16x16x32_bf16 v[88:91], a[216:219], a[192:195], 0
    s_add_u32 m0, s22, 2048
    ds_read_b64_tr_b16 a[216:217], v2 offset:18432
    v_fma_f32 v62, v62, s28, v10
    v_mfma_f32_16x16x32_bf16 v[88:91], a[220:223], a[196:199], v[88:91]
    buffer_load_dwordx4 v6, s[4:7], s20 offen lds
    v_mfma_f32_16x16x32_bf16 v[88:91], a[224:227], a[200:203], v[88:91]
    v_exp_f32_e64 v61, v61 clamp
    v_mfma_f32_16x16x32_bf16 v[88:91], a[228:231], a[204:207], v[88:91]
    ds_read_b64_tr_b16 a[218:219], v2 offset:12288
    v_fma_f32 v60, v60, s28, v10
    v_mfma_f32_16x16x32_bf16 v[88:91], a[232:235], a[208:211], v[88:91]
    s_add_u32 s20, s20, 12032
    v_exp_f32_e64 v60, v60 clamp
    v_mfma_f32_16x16x32_bf16 v[88:91], a[236:239], a[212:215], v[88:91]
    ds_read_b64_tr_b16 a[220:221], v3 offset:18432
    ds_read_b64_tr_b16 a[222:223], v3 offset:12288
    v_mfma_f32_16x16x32_bf16 v[80:83], a[236:239], a[188:191], v[80:83]
    v_mfma_f32_16x16x32_bf16 v[80:83], a[232:235], a[184:187], v[80:83]
    v_exp_f32_e64 v63, v63 clamp
    v_mfma_f32_16x16x32_bf16 v[80:83], a[228:231], a[180:183], v[80:83]
    v_fma_f32 v52, v52, s28, v9
    v_mfma_f32_16x16x32_bf16 v[72:75], a[228:231], a[156:159], v[72:75]
    s_add_u32 s30, s30, 1
    v_exp_f32_e64 v53, v53 clamp
    v_mfma_f32_16x16x32_bf16 v[72:75], a[232:235], a[160:163], v[72:75]
    v_exp_f32_e64 v55, v55 clamp
    v_mfma_f32_16x16x32_bf16 v[72:75], a[236:239], a[164:167], v[72:75]
    v_exp_f32_e64 v62, v62 clamp
    v_mfma_f32_16x16x32_bf16 v[64:67], a[236:239], a[140:143], v[64:67]
    ds_read_b64_tr_b16 a[224:225], v4 offset:18432
    v_mfma_f32_16x16x32_bf16 v[64:67], a[232:235], a[136:139], v[64:67]
    v_exp_f32_e64 v52, v52 clamp
    v_mfma_f32_16x16x32_bf16 v[64:67], a[228:231], a[132:135], v[64:67]
    ds_read_b64_tr_b16 a[226:227], v4 offset:12288
    v_cvt_pk_bf16_f32 v15, v54, v55
    v_mfma_f32_16x16x32_bf16 v[56:59], a[228:231], a[108:111], v[56:59]
    s_waitcnt lgkmcnt(2)
    ds_read_b64_tr_b16 a[228:229], v5 offset:18432
    s_cmp_lt_u32 s30, 6
    v_mfma_f32_16x16x32_bf16 v[56:59], a[232:235], a[112:115], v[56:59]
    ds_read_b64_tr_b16 a[230:231], v5 offset:12288
    v_cvt_pk_bf16_f32 v14, v52, v53
    v_mfma_f32_16x16x32_bf16 v[56:59], a[236:239], a[116:119], v[56:59]
    s_cbranch_scc1 L_loop5w1
    s_cmp_ge_u32 s37, 6
    s_cbranch_scc1 L_end5
    s_cmp_eq_u32 s32, 0
    s_cbranch_scc1 L_tr54
    s_branch L_tr55
L_tr54:
    v_mfma_f32_16x16x32_bf16 v[112:115], a[216:219], v[16:19], v[112:115]
    v_fma_f32 v76, v76, s28, v12
    v_fma_f32 v68, v68, s28, v11
    v_mfma_f32_16x16x32_bf16 v[116:119], a[220:223], v[16:19], v[116:119]
    v_mfma_f32_16x16x32_bf16 v[164:167], a[220:223], v[20:23], v[164:167]
    v_fma_f32 v72, v72, s28, v11
    v_mfma_f32_16x16x32_bf16 v[160:163], a[216:219], v[20:23], v[160:163]
    v_fma_f32 v85, v85, s28, v13
    v_fma_f32 v73, v73, s28, v11
    v_mfma_f32_16x16x32_bf16 v[208:211], a[216:219], v[28:31], v[208:211]
    v_fma_f32 v88, v88, s28, v13
    v_fma_f32 v65, v65, s28, v10
    v_mfma_f32_16x16x32_bf16 v[212:215], a[220:223], v[28:31], v[212:215]
    ds_read_b64_tr_b16 a[234:235], v2 offset:13312
    v_fma_f32 v87, v87, s28, v13
    v_mfma_f32_16x16x32_bf16 a[4:7], a[220:223], v[32:35], a[4:7]
    s_add_u32 s39, s39, 12288
    v_mfma_f32_16x16x32_bf16 a[0:3], a[216:219], v[32:35], a[0:3]
    v_fma_f32 v89, v89, s28, v13
    v_mfma_f32_16x16x32_bf16 a[48:51], a[216:219], v[40:43], a[48:51]
    ds_read_b64_tr_b16 a[232:233], v2 offset:19456
    v_mfma_f32_16x16x32_bf16 a[52:55], a[220:223], v[40:43], a[52:55]
    s_waitcnt lgkmcnt(2)
    ds_read_b64_tr_b16 a[236:237], v3 offset:19456
    v_fma_f32 v70, v70, s28, v11
    v_mfma_f32_16x16x32_bf16 a[56:59], a[224:227], v[40:43], a[56:59]
    ds_read_b64_tr_b16 a[238:239], v3 offset:13312
    v_fma_f32 v71, v71, s28, v11
    v_mfma_f32_16x16x32_bf16 a[60:63], a[228:231], v[40:43], a[60:63]
    v_exp_f32_e64 v89, v89 clamp
    v_mfma_f32_16x16x32_bf16 a[12:15], a[228:231], v[32:35], a[12:15]
    ds_read_b64_tr_b16 a[218:219], v4 offset:13312
    v_fma_f32 v57, v57, s28, v9
    v_mfma_f32_16x16x32_bf16 a[8:11], a[224:227], v[32:35], a[8:11]
    v_fma_f32 v56, v56, s28, v9
    v_fma_f32 v80, v80, s28, v12
    v_mfma_f32_16x16x32_bf16 v[216:219], a[224:227], v[28:31], v[216:219]
    ds_read_b64_tr_b16 a[220:221], v5 offset:19456
    v_fma_f32 v59, v59, s28, v9
    v_mfma_f32_16x16x32_bf16 v[220:223], a[228:231], v[28:31], v[220:223]
    v_fma_f32 v82, v82, s28, v12
    v_mfma_f32_16x16x32_bf16 v[172:175], a[228:231], v[20:23], v[172:175]
    v_fma_f32 v66, v66, s28, v10
    v_fma_f32 v86, v86, s28, v13
    v_mfma_f32_16x16x32_bf16 v[168:171], a[224:227], v[20:23], v[168:171]
    ds_read_b64_tr_b16 a[216:217], v4 offset:19456
    v_fma_f32 v69, v69, s28, v11
    v_mfma_f32_16x16x32_bf16 v[120:123], a[224:227], v[16:19], v[120:123]
    v_fma_f32 v91, v91, s28, v13
    v_fma_f32 v58, v58, s28, v9
    v_mfma_f32_16x16x32_bf16 v[124:127], a[228:231], v[16:19], v[124:127]
    s_waitcnt lgkmcnt(4)
    v_fma_f32 v78, v78, s28, v12
    v_mfma_f32_16x16x32_bf16 v[128:131], a[232:235], v[16:19], v[128:131]
    s_waitcnt lgkmcnt(3)
    ds_read_b64_tr_b16 a[222:223], v5 offset:13312
    v_fma_f32 v77, v77, s28, v12
    v_mfma_f32_16x16x32_bf16 v[132:135], a[236:239], v[16:19], v[132:135]
    v_exp_f32_e64 v76, v76 clamp
    v_mfma_f32_16x16x32_bf16 v[180:183], a[236:239], v[20:23], v[180:183]
    v_exp_f32_e64 v65, v65 clamp
    v_mfma_f32_16x16x32_bf16 v[176:179], a[232:235], v[20:23], v[176:179]
    v_exp_f32_e64 v68, v68 clamp
    v_mfma_f32_16x16x32_bf16 v[224:227], a[232:235], v[28:31], v[224:227]
    v_exp_f32_e64 v70, v70 clamp
    v_mfma_f32_16x16x32_bf16 v[228:231], a[236:239], v[28:31], v[228:231]
    ds_read_b64_tr_b16 a[228:229], v3 offset:20480
    v_fma_f32 v67, v67, s28, v10
    v_mfma_f32_16x16x32_bf16 a[20:23], a[236:239], v[32:35], a[20:23]
    ds_read_b64_tr_b16 a[226:227], v2 offset:14336
    v_fma_f32 v79, v79, s28, v12
    v_mfma_f32_16x16x32_bf16 a[16:19], a[232:235], v[32:35], a[16:19]
    v_fma_f32 v84, v84, s28, v13
    v_mfma_f32_16x16x32_bf16 a[64:67], a[232:235], v[40:43], a[64:67]
    ds_read_b64_tr_b16 a[224:225], v2 offset:20480
    v_fma_f32 v75, v75, s28, v11
    v_mfma_f32_16x16x32_bf16 a[68:71], a[236:239], v[40:43], a[68:71]
    s_waitcnt lgkmcnt(4)
    v_exp_f32_e64 v88, v88 clamp
    v_mfma_f32_16x16x32_bf16 a[72:75], a[216:219], v[40:43], a[72:75]
    s_waitcnt lgkmcnt(3)
    ds_read_b64_tr_b16 a[230:231], v3 offset:14336
    v_fma_f32 v74, v74, s28, v11
    v_mfma_f32_16x16x32_bf16 a[76:79], a[220:223], v[40:43], a[76:79]
    v_mfma_f32_16x16x32_bf16 a[28:31], a[220:223], v[32:35], a[28:31]
    ds_read_b64_tr_b16 a[238:239], v5 offset:14336
    v_mfma_f32_16x16x32_bf16 a[24:27], a[216:219], v[32:35], a[24:27]
    ds_read_b64_tr_b16 a[236:237], v5 offset:20480
    v_mfma_f32_16x16x32_bf16 v[232:235], a[216:219], v[28:31], v[232:235]
    v_exp_f32_e64 v77, v77 clamp
    v_mfma_f32_16x16x32_bf16 v[236:239], a[220:223], v[28:31], v[236:239]
    v_exp_f32_e64 v79, v79 clamp
    v_mfma_f32_16x16x32_bf16 v[188:191], a[220:223], v[20:23], v[188:191]
    ds_read_b64_tr_b16 a[232:233], v4 offset:20480
    v_mfma_f32_16x16x32_bf16 v[184:187], a[216:219], v[20:23], v[184:187]
    ds_read_b64_tr_b16 a[234:235], v4 offset:14336
    v_fma_f32 v83, v83, s28, v12
    v_mfma_f32_16x16x32_bf16 v[136:139], a[216:219], v[16:19], v[136:139]
    v_exp_f32_e64 v87, v87 clamp
    v_mfma_f32_16x16x32_bf16 v[140:143], a[220:223], v[16:19], v[140:143]
    s_waitcnt lgkmcnt(5)
    v_exp_f32_e64 v84, v84 clamp
    v_mfma_f32_16x16x32_bf16 v[144:147], a[224:227], v[16:19], v[144:147]
    s_waitcnt lgkmcnt(4)
    v_exp_f32_e64 v71, v71 clamp
    v_mfma_f32_16x16x32_bf16 v[148:151], a[228:231], v[16:19], v[148:151]
    v_exp_f32_e64 v69, v69 clamp
    v_mfma_f32_16x16x32_bf16 v[196:199], a[228:231], v[20:23], v[196:199]
    v_exp_f32_e64 v85, v85 clamp
    v_mfma_f32_16x16x32_bf16 v[192:195], a[224:227], v[20:23], v[192:195]
    v_exp_f32_e64 v73, v73 clamp
    v_mfma_f32_16x16x32_bf16 v[240:243], a[224:227], v[28:31], v[240:243]
    v_exp_f32_e64 v59, v59 clamp
    v_mfma_f32_16x16x32_bf16 v[244:247], a[228:231], v[28:31], v[244:247]
    v_exp_f32_e64 v72, v72 clamp
    v_mfma_f32_16x16x32_bf16 a[36:39], a[228:231], v[32:35], a[36:39]
    v_exp_f32_e64 v57, v57 clamp
    v_mfma_f32_16x16x32_bf16 a[32:35], a[224:227], v[32:35], a[32:35]
    s_waitcnt vmcnt(10) lgkmcnt(0)
    v_cvt_pk_bf16_f32 v27, v70, v71
    v_mfma_f32_16x16x32_bf16 a[80:83], a[224:227], v[40:43], a[80:83]
    v_exp_f32_e64 v86, v86 clamp
    v_mfma_f32_16x16x32_bf16 a[84:87], a[228:231], v[40:43], a[84:87]
    s_barrier
    ds_read_b128 a[216:219], v0 offset:12288
    v_mfma_f32_16x16x32_bf16 a[88:91], a[232:235], v[40:43], a[88:91]
    s_add_u32 m0, s22, 36864
    ds_read_b128 a[220:223], v1 offset:12288
    v_mfma_f32_16x16x32_bf16 a[92:95], a[236:239], v[40:43], a[92:95]
    ds_read_b128 a[224:227], v0 offset:13312
    v_mfma_f32_16x16x32_bf16 a[44:47], a[236:239], v[32:35], a[44:47]
    buffer_load_dwordx4 v6, s[8:11], s21 offen lds
    v_mfma_f32_16x16x32_bf16 a[40:43], a[232:235], v[32:35], a[40:43]
    ds_read_b128 a[228:231], v1 offset:13312
    v_mfma_f32_16x16x32_bf16 v[248:251], a[232:235], v[28:31], v[248:251]
    s_add_u32 s21, s21, 128
    s_add_u32 m0, s22, 37888
    v_mfma_f32_16x16x32_bf16 v[252:255], a[236:239], v[28:31], v[252:255]
    buffer_load_dwordx4 v6, s[8:11], s21 offen lds
    v_mfma_f32_16x16x32_bf16 v[204:207], a[236:239], v[20:23], v[204:207]
    s_add_u32 s21, s21, 128
    v_cvt_pk_bf16_f32 v38, v84, v85
    v_fma_f32 v64, v64, s28, v10
    v_mfma_f32_16x16x32_bf16 v[200:203], a[232:235], v[20:23], v[200:203]
    s_add_u32 m0, s22, 38912
    v_cvt_pk_bf16_f32 v26, v68, v69
    v_fma_f32 v81, v81, s28, v12
    v_mfma_f32_16x16x32_bf16 v[152:155], a[232:235], v[16:19], v[152:155]
    buffer_load_dwordx4 v6, s[8:11], s21 offen lds
    v_mfma_f32_16x16x32_bf16 v[156:159], a[236:239], v[16:19], v[156:159]
    s_waitcnt lgkmcnt(3)
    v_exp_f32_e64 v82, v82 clamp
    v_mfma_f32_16x16x32_bf16 v[52:55], a[216:219], a[96:99], 0
    s_waitcnt lgkmcnt(2)
    v_cvt_pk_bf16_f32 v22, v60, v61
    v_cvt_pk_bf16_f32 v28, v72, v73
    v_mfma_f32_16x16x32_bf16 v[52:55], a[220:223], a[100:103], v[52:55]
    s_waitcnt lgkmcnt(1)
    ds_read_b128 a[236:239], v1 offset:14336
    v_cvt_pk_bf16_f32 v23, v62, v63
    v_mfma_f32_16x16x32_bf16 v[52:55], a[224:227], a[104:107], v[52:55]
    v_exp_f32_e64 v80, v80 clamp
    v_mfma_f32_16x16x32_bf16 v[60:63], a[224:227], a[128:131], 0
    v_exp_f32_e64 v78, v78 clamp
    v_mfma_f32_16x16x32_bf16 v[60:63], a[220:223], a[124:127], v[60:63]
    v_exp_f32_e64 v56, v56 clamp
    v_mfma_f32_16x16x32_bf16 v[60:63], a[216:219], a[120:123], v[60:63]
    ds_read_b128 a[232:235], v0 offset:14336
    v_cvt_pk_bf16_f32 v39, v86, v87
    v_mfma_f32_16x16x32_bf16 v[68:71], a[216:219], a[144:147], 0
    v_cvt_pk_bf16_f32 v35, v78, v79
    v_cvt_pk_bf16_f32 v34, v76, v77
    v_mfma_f32_16x16x32_bf16 v[68:71], a[220:223], a[148:151], v[68:71]
    v_exp_f32_e64 v64, v64 clamp
    v_mfma_f32_16x16x32_bf16 v[68:71], a[224:227], a[152:155], v[68:71]
    v_exp_f32_e64 v67, v67 clamp
    v_mfma_f32_16x16x32_bf16 v[76:79], a[224:227], a[176:179], 0
    v_cvt_pk_bf16_f32 v40, v88, v89
    v_mfma_f32_16x16x32_bf16 v[76:79], a[220:223], a[172:175], v[76:79]
    v_exp_f32_e64 v74, v74 clamp
    v_mfma_f32_16x16x32_bf16 v[76:79], a[216:219], a[168:171], v[76:79]
    v_exp_f32_e64 v75, v75 clamp
    v_mfma_f32_16x16x32_bf16 v[84:87], a[216:219], a[192:195], 0
    v_fma_f32 v90, v90, s28, v13
    v_mfma_f32_16x16x32_bf16 v[84:87], a[220:223], a[196:199], v[84:87]
    v_exp_f32_e64 v58, v58 clamp
    v_mfma_f32_16x16x32_bf16 v[84:87], a[224:227], a[200:203], v[84:87]
    s_waitcnt lgkmcnt(1)
    ds_read_b128 a[220:223], v1 offset:18432
    v_cvt_pk_bf16_f32 v29, v74, v75
    v_mfma_f32_16x16x32_bf16 v[84:87], a[228:231], a[204:207], v[84:87]
    s_waitcnt lgkmcnt(1)
    v_exp_f32_e64 v83, v83 clamp
    v_mfma_f32_16x16x32_bf16 v[84:87], a[232:235], a[208:211], v[84:87]
    v_cvt_pk_bf16_f32 v37, v82, v83
    v_mfma_f32_16x16x32_bf16 v[84:87], a[236:239], a[212:215], v[84:87]
    s_add_u32 s21, s21, 12032
    ds_read_b128 a[224:227], v0 offset:19456
    v_mfma_f32_16x16x32_bf16 v[76:79], a[236:239], a[188:191], v[76:79]
    v_exp_f32_e64 v90, v90 clamp
    v_mfma_f32_16x16x32_bf16 v[76:79], a[232:235], a[184:187], v[76:79]
    ds_read_b128 a[216:219], v0 offset:18432
    v_mfma_f32_16x16x32_bf16 v[76:79], a[228:231], a[180:183], v[76:79]
    v_exp_f32_e64 v66, v66 clamp
    v_mfma_f32_16x16x32_bf16 v[68:71], a[228:231], a[156:159], v[68:71]
    v_cvt_pk_bf16_f32 v25, v66, v67
    v_mfma_f32_16x16x32_bf16 v[68:71], a[232:235], a[160:163], v[68:71]
    v_exp_f32_e64 v81, v81 clamp
    v_mfma_f32_16x16x32_bf16 v[68:71], a[236:239], a[164:167], v[68:71]
    v_cvt_pk_bf16_f32 v16, v56, v57
    v_mfma_f32_16x16x32_bf16 v[60:63], a[236:239], a[140:143], v[60:63]
    v_cvt_pk_bf16_f32 v17, v58, v59
    v_cvt_pk_bf16_f32 v36, v80, v81
    v_mfma_f32_16x16x32_bf16 v[60:63], a[232:235], a[136:139], v[60:63]
    v_mfma_f32_16x16x32_bf16 v[60:63], a[228:231], a[132:135], v[60:63]
    v_exp_f32_e64 v91, v91 clamp
    v_mfma_f32_16x16x32_bf16 v[52:55], a[228:231], a[108:111], v[52:55]
    v_cvt_pk_bf16_f32 v24, v64, v65
    v_mfma_f32_16x16x32_bf16 v[52:55], a[232:235], a[112:115], v[52:55]
    ds_read_b128 a[228:231], v1 offset:19456
    v_cvt_pk_bf16_f32 v41, v90, v91
    v_mfma_f32_16x16x32_bf16 v[44:47], a[248:251], v[14:17], v[44:47]
    ds_read_b128 a[232:235], v0 offset:20480
    v_smfmac_f32_16x16x64_bf16 v[44:47], a[240:243], v[22:29], v101
    v_smfmac_f32_16x16x64_bf16 v[44:47], a[244:247], v[34:41], v101
    v_mfma_f32_16x16x32_bf16 v[52:55], a[236:239], a[116:119], v[52:55]
    s_waitcnt lgkmcnt(2)
    ds_read_b128 a[236:239], v1 offset:20480
    v_mfma_f32_16x16x32_bf16 v[56:59], a[216:219], a[96:99], 0
    v_mfma_f32_16x16x32_bf16 v[56:59], a[220:223], a[100:103], v[56:59]
    v_mfma_f32_16x16x32_bf16 v[56:59], a[224:227], a[104:107], v[56:59]
    s_nop 1
    v_cmp_lt_f32 vcc, s29, v44
    v_mfma_f32_16x16x32_bf16 v[64:67], a[224:227], a[128:131], 0
    v_mfma_f32_16x16x32_bf16 v[64:67], a[220:223], a[124:127], v[64:67]
    v_mfma_f32_16x16x32_bf16 v[64:67], a[216:219], a[120:123], v[64:67]
    v_mfma_f32_16x16x32_bf16 v[72:75], a[216:219], a[144:147], 0
    s_nop 0
    s_cbranch_vccnz L_rs_tr54a
L_ret_tr54a:
    v_mfma_f32_16x16x32_bf16 v[72:75], a[220:223], a[148:151], v[72:75]
    v_fma_f32 v60, v60, s28, v10
    v_fma_f32 v61, v61, s28, v10
    v_mfma_f32_16x16x32_bf16 v[72:75], a[224:227], a[152:155], v[72:75]
    v_fma_f32 v52, v52, s28, v9
    s_waitcnt vmcnt(6) lgkmcnt(0)
    v_mfma_f32_16x16x32_bf16 v[80:83], a[224:227], a[176:179], 0
    s_barrier
    v_mfma_f32_16x16x32_bf16 v[80:83], a[220:223], a[172:175], v[80:83]
    s_add_u32 m0, s22, 12288
    v_fma_f32 v63, v63, s28, v10
    v_fma_f32 v55, v55, s28, v9
    v_mfma_f32_16x16x32_bf16 v[80:83], a[216:219], a[168:171], v[80:83]
    buffer_load_dwordx4 v6, s[4:7], s20 offen lds
    v_mfma_f32_16x16x32_bf16 v[88:91], a[216:219], a[192:195], 0
    ds_read_b64_tr_b16 a[216:217], v2 offset:0
    v_fma_f32 v62, v62, s28, v10
    v_mfma_f32_16x16x32_bf16 v[88:91], a[220:223], a[196:199], v[88:91]
    s_add_u32 s20, s20, 128
    v_exp_f32_e64 v62, v62 clamp
    v_mfma_f32_16x16x32_bf16 v[88:91], a[224:227], a[200:203], v[88:91]
    ds_read_b64_tr_b16 a[218:219], v2 offset:6144
    s_add_u32 m0, s22, 13312
    v_mfma_f32_16x16x32_bf16 v[88:91], a[228:231], a[204:207], v[88:91]
    buffer_load_dwordx4 v6, s[4:7], s20 offen lds
    v_mfma_f32_16x16x32_bf16 v[88:91], a[232:235], a[208:211], v[88:91]
    v_exp_f32_e64 v52, v52 clamp
    v_mfma_f32_16x16x32_bf16 v[88:91], a[236:239], a[212:215], v[88:91]
    s_add_u32 s20, s20, 128
    ds_read_b64_tr_b16 a[220:221], v3 offset:0
    v_fma_f32 v54, v54, s28, v9
    v_mfma_f32_16x16x32_bf16 v[80:83], a[236:239], a[188:191], v[80:83]
    ds_read_b64_tr_b16 a[222:223], v3 offset:6144
    v_fma_f32 v53, v53, s28, v9
    v_mfma_f32_16x16x32_bf16 v[80:83], a[232:235], a[184:187], v[80:83]
    s_add_u32 m0, s22, 14336
    v_exp_f32_e64 v63, v63 clamp
    v_mfma_f32_16x16x32_bf16 v[80:83], a[228:231], a[180:183], v[80:83]
    buffer_load_dwordx4 v6, s[4:7], s20 offen lds
    v_mfma_f32_16x16x32_bf16 v[72:75], a[228:231], a[156:159], v[72:75]
    v_exp_f32_e64 v53, v53 clamp
    v_mfma_f32_16x16x32_bf16 v[72:75], a[232:235], a[160:163], v[72:75]
    s_add_u32 s20, s20, 12032
    v_exp_f32_e64 v55, v55 clamp
    v_mfma_f32_16x16x32_bf16 v[72:75], a[236:239], a[164:167], v[72:75]
    ds_read_b64_tr_b16 a[224:225], v4 offset:0
    v_mfma_f32_16x16x32_bf16 v[64:67], a[236:239], a[140:143], v[64:67]
    v_exp_f32_e64 v61, v61 clamp
    v_mfma_f32_16x16x32_bf16 v[64:67], a[232:235], a[136:139], v[64:67]
    ds_read_b64_tr_b16 a[226:227], v4 offset:6144
    v_cvt_pk_bf16_f32 v18, v52, v53
    v_mfma_f32_16x16x32_bf16 v[64:67], a[228:231], a[132:135], v[64:67]
    v_exp_f32_e64 v54, v54 clamp
    v_mfma_f32_16x16x32_bf16 v[56:59], a[228:231], a[108:111], v[56:59]
    ds_read_b64_tr_b16 a[228:229], v5 offset:0
    s_waitcnt lgkmcnt(3)
    v_mfma_f32_16x16x32_bf16 v[56:59], a[232:235], a[112:115], v[56:59]
    v_exp_f32_e64 v60, v60 clamp
    v_mfma_f32_16x16x32_bf16 v[56:59], a[236:239], a[116:119], v[56:59]
    ds_read_b64_tr_b16 a[230:231], v5 offset:6144
    v_cvt_pk_bf16_f32 v19, v54, v55
    v_mfma_f32_16x16x32_bf16 v[112:115], a[216:219], v[14:17], v[112:115]
    v_lshrrev_b32 v105, 11, v0
    v_fma_f32 v74, v74, s28, v11
    v_mfma_f32_16x16x32_bf16 v[116:119], a[220:223], v[14:17], v[116:119]
    v_xor_b32 v105, s65, v105
    v_and_b32 v104, 0x3ff, v0
    v_mfma_f32_16x16x32_bf16 v[164:167], a[220:223], v[22:25], v[164:167]
    ds_read_b64_tr_b16 a[236:237], v3 offset:1024
    v_fma_f32 v67, v67, s28, v10
    v_mfma_f32_16x16x32_bf16 v[160:163], a[216:219], v[22:25], v[160:163]
    v_lshl_add_u32 v104, v105, 10, v104
    v_fma_f32 v59, v59, s28, v9
    v_mfma_f32_16x16x32_bf16 v[208:211], a[216:219], v[26:29], v[208:211]
    v_fma_f32 v87, v87, s28, v13
    v_fma_f32 v68, v68, s28, v11
    v_mfma_f32_16x16x32_bf16 v[212:215], a[220:223], v[26:29], v[212:215]
    ds_read_b64_tr_b16 a[238:239], v3 offset:7168
    v_fma_f32 v83, v83, s28, v12
    v_mfma_f32_16x16x32_bf16 a[4:7], a[220:223], v[34:37], a[4:7]
    v_add_u32 v104, s38, v104
    v_fma_f32 v66, v66, s28, v10
    v_mfma_f32_16x16x32_bf16 a[0:3], a[216:219], v[34:37], a[0:3]
    ds_read_b64_tr_b16 a[232:233], v2 offset:1024
    v_fma_f32 v57, v57, s28, v9
    v_mfma_f32_16x16x32_bf16 a[48:51], a[216:219], v[38:41], a[48:51]
    v_exp_f32_e64 v83, v83 clamp
    v_mfma_f32_16x16x32_bf16 a[52:55], a[220:223], v[38:41], a[52:55]
    s_waitcnt lgkmcnt(3)
    ds_read_b64_tr_b16 a[234:235], v2 offset:7168
    v_fma_f32 v56, v56, s28, v9
    v_fma_f32 v71, v71, s28, v11
    v_mfma_f32_16x16x32_bf16 a[56:59], a[224:227], v[38:41], a[56:59]
    v_fma_f32 v90, v90, s28, v13
    v_fma_f32 v78, v78, s28, v12
    v_mfma_f32_16x16x32_bf16 a[60:63], a[228:231], v[38:41], a[60:63]
    ds_read_b64_tr_b16 a[218:219], v4 offset:7168
    v_fma_f32 v81, v81, s28, v12
    v_mfma_f32_16x16x32_bf16 a[12:15], a[228:231], v[34:37], a[12:15]
    v_exp_f32_e64 v67, v67 clamp
    v_mfma_f32_16x16x32_bf16 a[8:11], a[224:227], v[34:37], a[8:11]
    ds_read_b64_tr_b16 a[222:223], v5 offset:7168
    v_xor_b32 v105, 64, v104
    v_mfma_f32_16x16x32_bf16 v[216:219], a[224:227], v[26:29], v[216:219]
    ds_read_b64_tr_b16 a[216:217], v4 offset:1024
    v_fma_f32 v72, v72, s28, v11
    v_mfma_f32_16x16x32_bf16 v[220:223], a[228:231], v[26:29], v[220:223]
    v_exp_f32_e64 v72, v72 clamp
    v_mfma_f32_16x16x32_bf16 v[172:175], a[228:231], v[22:25], v[172:175]
    ds_read_b128 a[120:123], v104 offset:6144
    v_fma_f32 v65, v65, s28, v10
    v_mfma_f32_16x16x32_bf16 v[168:171], a[224:227], v[22:25], v[168:171]
    ds_read_b64_tr_b16 a[220:221], v5 offset:1024
    v_exp_f32_e64 v68, v68 clamp
    v_mfma_f32_16x16x32_bf16 v[120:123], a[224:227], v[14:17], v[120:123]
    ds_read_b128 a[188:191], v105 offset:22528
    v_fma_f32 v77, v77, s28, v12
    v_mfma_f32_16x16x32_bf16 v[124:127], a[228:231], v[14:17], v[124:127]
    s_waitcnt lgkmcnt(6)
    v_exp_f32_e64 v71, v71 clamp
    v_mfma_f32_16x16x32_bf16 v[128:131], a[232:235], v[14:17], v[128:131]
    ds_read_b128 a[168:171], v104 offset:18432
    v_fma_f32 v70, v70, s28, v11
    v_mfma_f32_16x16x32_bf16 v[132:135], a[236:239], v[14:17], v[132:135]
    ds_read_b64_tr_b16 a[230:231], v3 offset:8192
    v_fma_f32 v86, v86, s28, v13
    v_mfma_f32_16x16x32_bf16 v[180:183], a[236:239], v[22:25], v[180:183]
    v_exp_f32_e64 v78, v78 clamp
    v_mfma_f32_16x16x32_bf16 v[176:179], a[232:235], v[22:25], v[176:179]
    s_add_u32 s39, s39, 12288
    ds_read_b64_tr_b16 a[226:227], v2 offset:8192
    v_exp_f32_e64 v57, v57 clamp
    v_mfma_f32_16x16x32_bf16 v[224:227], a[232:235], v[26:29], v[224:227]
    v_fma_f32 v88, v88, s28, v13
    v_fma_f32 v79, v79, s28, v12
    v_mfma_f32_16x16x32_bf16 v[228:231], a[236:239], v[26:29], v[228:231]
    v_exp_f32_e64 v86, v86 clamp
    v_mfma_f32_16x16x32_bf16 a[20:23], a[236:239], v[34:37], a[20:23]
    ds_read_b64_tr_b16 a[228:229], v3 offset:2048
    v_exp_f32_e64 v87, v87 clamp
    v_mfma_f32_16x16x32_bf16 a[16:19], a[232:235], v[34:37], a[16:19]
    ds_read_b128 a[176:179], v104 offset:20480
    v_fma_f32 v73, v73, s28, v11
    v_mfma_f32_16x16x32_bf16 a[64:67], a[232:235], v[38:41], a[64:67]
    ds_read_b64_tr_b16 a[224:225], v2 offset:2048
    v_fma_f32 v85, v85, s28, v13
    v_mfma_f32_16x16x32_bf16 a[68:71], a[236:239], v[38:41], a[68:71]
    s_waitcnt lgkmcnt(6)
    v_exp_f32_e64 v70, v70 clamp
    v_mfma_f32_16x16x32_bf16 a[72:75], a[216:219], v[38:41], a[72:75]
    ds_read_b64_tr_b16 a[238:239], v5 offset:8192
    v_exp_f32_e64 v79, v79 clamp
    v_mfma_f32_16x16x32_bf16 a[76:79], a[220:223], v[38:41], a[76:79]
    ds_read_b128 a[128:131], v104 offset:8192
    v_exp_f32_e64 v81, v81 clamp
    v_mfma_f32_16x16x32_bf16 a[28:31], a[220:223], v[34:37], a[28:31]
    ds_read_b64_tr_b16 a[236:237], v5 offset:2048
    v_exp_f32_e64 v90, v90 clamp
    v_mfma_f32_16x16x32_bf16 a[24:27], a[216:219], v[34:37], a[24:27]
    ds_read_b128 a[164:167], v105 offset:16384
    v_fma_f32 v64, v64, s28, v10
    v_mfma_f32_16x16x32_bf16 v[232:235], a[216:219], v[26:29], v[232:235]
    v_exp_f32_e64 v64, v64 clamp
    v_mfma_f32_16x16x32_bf16 v[236:239], a[220:223], v[26:29], v[236:239]
    ds_read_b64_tr_b16 a[232:233], v4 offset:2048
    v_fma_f32 v80, v80, s28, v12
    v_mfma_f32_16x16x32_bf16 v[188:191], a[220:223], v[22:25], v[188:191]
    ds_read_b128 a[96:99], v104 offset:0
    v_fma_f32 v75, v75, s28, v11
    v_mfma_f32_16x16x32_bf16 v[184:187], a[216:219], v[22:25], v[184:187]
    ds_read_b64_tr_b16 a[234:235], v4 offset:8192
    v_fma_f32 v69, v69, s28, v11
    v_mfma_f32_16x16x32_bf16 v[136:139], a[216:219], v[14:17], v[136:139]
    v_exp_f32_e64 v65, v65 clamp
    v_mfma_f32_16x16x32_bf16 v[140:143], a[220:223], v[14:17], v[140:143]
    s_waitcnt lgkmcnt(6)
    ds_read_b128 a[104:107], v104 offset:2048
    v_fma_f32 v76, v76, s28, v12
    v_mfma_f32_16x16x32_bf16 v[144:147], a[224:227], v[14:17], v[144:147]
    v_exp_f32_e64 v66, v66 clamp
    v_mfma_f32_16x16x32_bf16 v[148:151], a[228:231], v[14:17], v[148:151]
    ds_read_b128 a[152:155], v104 offset:14336
    v_exp_f32_e64 v56, v56 clamp
    v_mfma_f32_16x16x32_bf16 v[196:199], a[228:231], v[22:25], v[196:199]
    ds_read_b128 a[140:143], v105 offset:10240
    v_cvt_pk_bf16_f32 v31, v70, v71
    v_mfma_f32_16x16x32_bf16 v[192:195], a[224:227], v[22:25], v[192:195]
    ds_read_b128 a[148:151], v105 offset:12288
    v_fma_f32 v84, v84, s28, v13
    v_mfma_f32_16x16x32_bf16 v[240:243], a[224:227], v[26:29], v[240:243]
    v_exp_f32_e64 v76, v76 clamp
    v_mfma_f32_16x16x32_bf16 v[244:247], a[228:231], v[26:29], v[244:247]
    v_exp_f32_e64 v77, v77 clamp
    v_mfma_f32_16x16x32_bf16 a[36:39], a[228:231], v[34:37], a[36:39]
    ds_read_b128 a[100:103], v105 offset:0
    v_exp_f32_e64 v59, v59 clamp
    v_mfma_f32_16x16x32_bf16 a[32:35], a[224:227], v[34:37], a[32:35]
    s_waitcnt vmcnt(6) lgkmcnt(5)
    ds_read_b128 a[124:127], v105 offset:6144
    v_fma_f32 v89, v89, s28, v13
    v_mfma_f32_16x16x32_bf16 a[80:83], a[224:227], v[38:41], a[80:83]
    s_add_u32 s21, s21, s62
    ds_read_b128 a[172:175], v105 offset:18432
    v_fma_f32 v58, v58, s28, v9
    v_mfma_f32_16x16x32_bf16 a[84:87], a[228:231], v[38:41], a[84:87]
    s_barrier
    ds_read_b128 a[160:163], v104 offset:16384
    v_mfma_f32_16x16x32_bf16 a[88:91], a[232:235], v[38:41], a[88:91]
    s_add_u32 m0, s22, 24576
    ds_read_b128 a[216:219], v0 offset:0
    buffer_load_dwordx4 v6, s[8:11], s21 offen lds
    v_mfma_f32_16x16x32_bf16 a[92:95], a[236:239], v[38:41], a[92:95]
    s_add_u32 s21, s21, 128
    ds_read_b128 a[220:223], v1 offset:0
    v_fma_f32 v82, v82, s28, v12
    v_mfma_f32_16x16x32_bf16 a[44:47], a[236:239], v[34:37], a[44:47]
    s_add_u32 m0, s22, 25600
    ds_read_b128 a[224:227], v0 offset:1024
    buffer_load_dwordx4 v6, s[8:11], s21 offen lds
    v_mfma_f32_16x16x32_bf16 a[40:43], a[232:235], v[34:37], a[40:43]
    v_exp_f32_e64 v84, v84 clamp
    v_mfma_f32_16x16x32_bf16 v[248:251], a[232:235], v[26:29], v[248:251]
    ds_read_b128 a[180:183], v105 offset:20480
    v_fma_f32 v91, v91, s28, v13
    v_mfma_f32_16x16x32_bf16 v[252:255], a[236:239], v[26:29], v[252:255]
    s_add_u32 s21, s21, 128
    ds_read_b128 a[144:147], v104 offset:12288
    v_exp_f32_e64 v73, v73 clamp
    v_mfma_f32_16x16x32_bf16 v[204:207], a[236:239], v[22:25], v[204:207]
    v_exp_f32_e64 v69, v69 clamp
    v_mfma_f32_16x16x32_bf16 v[200:203], a[232:235], v[22:25], v[200:203]
    s_add_u32 m0, s22, 26624
    ds_read_b128 a[184:187], v104 offset:22528
    buffer_load_dwordx4 v6, s[8:11], s21 offen lds
    v_mfma_f32_16x16x32_bf16 v[152:155], a[232:235], v[14:17], v[152:155]
    ds_read_b128 a[232:235], v0 offset:2048
    v_cvt_pk_bf16_f32 v34, v76, v77
    v_mfma_f32_16x16x32_bf16 v[156:159], a[236:239], v[14:17], v[156:159]
    s_waitcnt lgkmcnt(6)
    ds_read_b128 a[228:231], v1 offset:1024
    v_cvt_pk_bf16_f32 v30, v68, v69
    v_mfma_f32_16x16x32_bf16 v[52:55], a[216:219], a[96:99], 0
    s_waitcnt lgkmcnt(6)
    v_exp_f32_e64 v74, v74 clamp
    v_cvt_pk_bf16_f32 v20, v64, v65
    v_mfma_f32_16x16x32_bf16 v[52:55], a[220:223], a[100:103], v[52:55]
    s_waitcnt lgkmcnt(5)
    ds_read_b128 a[156:159], v105 offset:14336
    v_cvt_pk_bf16_f32 v23, v62, v63
    v_mfma_f32_16x16x32_bf16 v[52:55], a[224:227], a[104:107], v[52:55]
    v_exp_f32_e64 v82, v82 clamp
    v_cvt_pk_bf16_f32 v22, v60, v61
    v_mfma_f32_16x16x32_bf16 v[60:63], a[224:227], a[128:131], 0
    v_exp_f32_e64 v58, v58 clamp
    v_mfma_f32_16x16x32_bf16 v[60:63], a[220:223], a[124:127], v[60:63]
    ds_read_b128 a[236:239], v1 offset:2048
    v_cvt_pk_bf16_f32 v16, v56, v57
    v_mfma_f32_16x16x32_bf16 v[60:63], a[216:219], a[120:123], v[60:63]
    s_waitcnt lgkmcnt(5)
    ds_read_b128 a[132:135], v105 offset:8192
    v_exp_f32_e64 v85, v85 clamp
    v_mfma_f32_16x16x32_bf16 v[68:71], a[216:219], a[144:147], 0
    v_exp_f32_e64 v80, v80 clamp
    v_mfma_f32_16x16x32_bf16 v[68:71], a[220:223], a[148:151], v[68:71]
    ds_read_b128 a[116:119], v105 offset:4096
    v_cvt_pk_bf16_f32 v35, v78, v79
    v_mfma_f32_16x16x32_bf16 v[68:71], a[224:227], a[152:155], v[68:71]
    v_exp_f32_e64 v75, v75 clamp
    v_mfma_f32_16x16x32_bf16 v[76:79], a[224:227], a[176:179], 0
    v_exp_f32_e64 v89, v89 clamp
    v_mfma_f32_16x16x32_bf16 v[76:79], a[220:223], a[172:175], v[76:79]
    v_exp_f32_e64 v91, v91 clamp
    v_cvt_pk_bf16_f32 v28, v72, v73
    v_mfma_f32_16x16x32_bf16 v[76:79], a[216:219], a[168:171], v[76:79]
    s_waitcnt lgkmcnt(3)
    ds_read_b128 a[136:139], v104 offset:10240
    v_cvt_pk_bf16_f32 v21, v66, v67
    v_mfma_f32_16x16x32_bf16 v[76:79], a[228:231], a[180:183], v[76:79]
    ds_read_b128 a[220:223], v1 offset:6144
    v_cvt_pk_bf16_f32 v17, v58, v59
    v_mfma_f32_16x16x32_bf16 v[76:79], a[232:235], a[184:187], v[76:79]
    v_exp_f32_e64 v88, v88 clamp
    v_smfmac_f32_16x16x64_bf16 v[48:51], a[240:243], v[16:23], v101
    s_waitcnt lgkmcnt(4)
    ds_read_b128 a[112:115], v104 offset:4096
    v_mfma_f32_16x16x32_bf16 v[76:79], a[236:239], a[188:191], v[76:79]
    ds_read_b128 a[108:111], v105 offset:2048
    v_cvt_pk_bf16_f32 v33, v82, v83
    v_mfma_f32_16x16x32_bf16 v[68:71], a[236:239], a[164:167], v[68:71]
    ds_read_b128 a[216:219], v0 offset:6144
    v_cvt_pk_bf16_f32 v41, v90, v91
    v_mfma_f32_16x16x32_bf16 v[68:71], a[232:235], a[160:163], v[68:71]
    ds_read_b128 a[224:227], v0 offset:7168
    v_cvt_pk_bf16_f32 v32, v80, v81
    v_mfma_f32_16x16x32_bf16 v[68:71], a[228:231], a[156:159], v[68:71]
    s_waitcnt lgkmcnt(6)
    v_cvt_pk_bf16_f32 v29, v74, v75
    v_cvt_pk_bf16_f32 v42, v84, v85
    v_mfma_f32_16x16x32_bf16 v[60:63], a[228:231], a[132:135], v[60:63]
    v_cvt_pk_bf16_f32 v40, v88, v89
    v_cvt_pk_bf16_f32 v43, v86, v87
    v_smfmac_f32_16x16x64_bf16 v[48:51], a[244:247], v[28:35], v101
    s_nop 0
    v_mfma_f32_16x16x32_bf16 v[48:51], a[248:251], v[40:43], v[48:51]
    s_waitcnt lgkmcnt(5)
    v_mfma_f32_16x16x32_bf16 v[60:63], a[232:235], a[136:139], v[60:63]
    v_mfma_f32_16x16x32_bf16 v[60:63], a[236:239], a[140:143], v[60:63]
    s_add_u32 s21, s21, 12032
    v_mfma_f32_16x16x32_bf16 v[52:55], a[236:239], a[116:119], v[52:55]
    s_waitcnt lgkmcnt(3)
    ds_read_b128 a[236:239], v1 offset:8192
    v_mfma_f32_16x16x32_bf16 v[52:55], a[232:235], a[112:115], v[52:55]
    s_waitcnt lgkmcnt(3)
    ds_read_b128 a[232:235], v0 offset:8192
    v_cmp_lt_f32 vcc, s29, v48
    v_mfma_f32_16x16x32_bf16 v[52:55], a[228:231], a[108:111], v[52:55]
    s_waitcnt lgkmcnt(3)
    ds_read_b128 a[228:231], v1 offset:7168
    v_mfma_f32_16x16x32_bf16 v[56:59], a[216:219], a[96:99], 0
    s_nop 0
    s_cbranch_vccnz L_rs_tr54b
L_ret_tr54b:
    v_lshrrev_b32 v108, 11, v0
    v_mfma_f32_16x16x32_bf16 v[56:59], a[220:223], a[100:103], v[56:59]
    s_waitcnt lgkmcnt(3)
    v_xor_b32 v108, s65, v108
    v_mov_b32 v110, v45
    v_mfma_f32_16x16x32_bf16 v[56:59], a[224:227], a[104:107], v[56:59]
    v_and_b32 v93, 0x3ff, v0
    v_lshl_add_u32 v93, v108, 10, v93
    v_mov_b32 v111, v46
    v_mbcnt_lo_u32_b32 v108, -1, 0
    v_permlane16_swap_b32 v45, v110
    v_mov_b32 v109, v50
    v_mbcnt_hi_u32_b32 v108, -1, v108
    v_mfma_f32_16x16x32_bf16 v[64:67], a[224:227], a[128:131], 0
    v_add_f32 v45, v45, v110
    v_permlane16_swap_b32 v46, v111
    v_lshrrev_b32 v108, 1, v108
    v_mfma_f32_16x16x32_bf16 v[64:67], a[220:223], a[124:127], v[64:67]
    v_permlane16_swap_b32 v50, v109
    v_and_b32 v108, 24, v108
    v_bfe_u32 v108, s66, v108, 8
    v_add_u32 v93, s38, v93
    v_mfma_f32_16x16x32_bf16 v[64:67], a[216:219], a[120:123], v[64:67]
    v_add_f32 v46, v46, v111
    v_mov_b32 v110, v45
    v_mfma_f32_16x16x32_bf16 v[72:75], a[216:219], a[144:147], 0
    s_waitcnt vmcnt(6) lgkmcnt(0)
    s_barrier
    v_mfma_f32_16x16x32_bf16 v[72:75], a[220:223], a[148:151], v[72:75]
    s_add_u32 m0, s22, 0
    v_permlane32_swap_b32 v45, v110
    v_mfma_f32_16x16x32_bf16 v[72:75], a[224:227], a[152:155], v[72:75]
    buffer_load_dwordx4 v6, s[4:7], s20 offen lds
    v_mfma_f32_16x16x32_bf16 v[80:83], a[224:227], a[176:179], 0
    s_add_u32 s20, s20, 128
    s_add_u32 m0, s22, 1024
    v_add_f32 v50, v50, v109
    v_mfma_f32_16x16x32_bf16 v[80:83], a[220:223], a[172:175], v[80:83]
    buffer_load_dwordx4 v6, s[4:7], s20 offen lds
    v_xor_b32 v93, v93, v108
    v_mfma_f32_16x16x32_bf16 v[80:83], a[216:219], a[168:171], v[80:83]
    s_add_u32 s20, s20, 128
    ds_read_b64_tr_b16 a[216:217], v2 offset:18432
    v_mov_b32 v111, v46
    v_mfma_f32_16x16x32_bf16 v[80:83], a[228:231], a[180:183], v[80:83]
    s_add_u32 m0, s22, 2048
    ds_read_b64_tr_b16 a[218:219], v2 offset:12288
    buffer_load_dwordx4 v6, s[4:7], s20 offen lds
    v_xor_b32 v8, 64, v93
    v_xor_b32 v102, 96, v93
    v_mov_b32 v109, v50
    v_mov_b32 v108, v49
    v_mfma_f32_16x16x32_bf16 v[80:83], a[232:235], a[184:187], v[80:83]
    v_permlane32_swap_b32 v46, v111
    v_mfma_f32_16x16x32_bf16 v[80:83], a[236:239], a[188:191], v[80:83]
    ds_read_b64_tr_b16 a[220:221], v3 offset:18432
    v_permlane16_swap_b32 v49, v108
    v_add_f32 v49, v49, v108
    v_mfma_f32_16x16x32_bf16 v[72:75], a[236:239], a[164:167], v[72:75]
    ds_read_b64_tr_b16 a[222:223], v3 offset:12288
    v_permlane32_swap_b32 v50, v109
    v_mfma_f32_16x16x32_bf16 v[72:75], a[232:235], a[160:163], v[72:75]
    v_xor_b32 v95, 32, v93
    v_add_f32 v94, v109, v46
    v_mfma_f32_16x16x32_bf16 v[72:75], a[228:231], a[156:159], v[72:75]
    v_mov_b32 v108, v49
    v_add_f32 v100, v51, v111
    v_mfma_f32_16x16x32_bf16 v[64:67], a[228:231], a[132:135], v[64:67]
    s_add_u32 s20, s20, 12032
    ds_read_b64_tr_b16 a[224:225], v4 offset:18432
    v_permlane32_swap_b32 v49, v108
    v_mfma_f32_16x16x32_bf16 v[64:67], a[232:235], a[136:139], v[64:67]
    v_add_f32 v92, v108, v45
    v_rcp_f32 v100, v100
    v_mfma_f32_16x16x32_bf16 v[64:67], a[236:239], a[140:143], v[64:67]
    v_add_f32 v48, v49, v47
    v_add_f32 v50, v50, v110
    v_mfma_f32_16x16x32_bf16 v[56:59], a[236:239], a[116:119], v[56:59]
    ds_read_b64_tr_b16 a[226:227], v4 offset:12288
    v_rcp_f32 v50, v50
    v_rcp_f32 v48, v48
    v_mfma_f32_16x16x32_bf16 v[56:59], a[232:235], a[112:115], v[56:59]
    v_rcp_f32 v92, v92
    v_rcp_f32 v94, v94
    v_mfma_f32_16x16x32_bf16 v[56:59], a[228:231], a[108:111], v[56:59]
    s_waitcnt lgkmcnt(2)
    ds_read_b64_tr_b16 a[228:229], v5 offset:18432
    ds_read_b64_tr_b16 a[230:231], v5 offset:12288
    v_mfma_f32_16x16x32_bf16 v[112:115], a[216:219], v[16:19], v[112:115]
    v_max3_f32 v99, v76, v77, v78
    v_max3_f32 v97, v60, v61, v62
    v_max3_f32 v96, v52, v53, v54
    v_mfma_f32_16x16x32_bf16 v[116:119], a[220:223], v[16:19], v[116:119]
    v_max3_f32 v97, v97, v63, v64
    v_max3_f32 v98, v68, v69, v70
    v_mfma_f32_16x16x32_bf16 v[164:167], a[220:223], v[20:23], v[164:167]
    s_mov_b32 s67, s34
    v_max3_f32 v96, v96, v55, v56
    v_max3_f32 v98, v98, v71, v72
    v_max3_f32 v97, v97, v65, v66
    v_max3_f32 v99, v99, v79, v80
    v_mfma_f32_16x16x32_bf16 v[160:163], a[216:219], v[20:23], v[160:163]
    v_max3_f32 v98, v98, v73, v74
    v_max_f32 v98, v98, v75
    v_mfma_f32_16x16x32_bf16 v[208:211], a[216:219], v[28:31], v[208:211]
    s_add_u32 s18, s34, 30720
    v_max3_f32 v99, v99, v81, v82
    v_max3_f32 v96, v96, v57, v58
    v_mfma_f32_16x16x32_bf16 v[212:215], a[220:223], v[28:31], v[212:215]
    ds_read_b64_tr_b16 a[238:239], v3 offset:13312
    v_max_f32 v99, v99, v83
    v_mfma_f32_16x16x32_bf16 a[4:7], a[220:223], v[32:35], a[4:7]
    s_mov_b32 s34, s33
    v_max_f32 v96, v96, v59
    v_permlane32_swap_b32 v98, v99
    v_mfma_f32_16x16x32_bf16 a[0:3], a[216:219], v[32:35], a[0:3]
    ds_read_b64_tr_b16 a[234:235], v2 offset:13312
    v_max_f32 v97, v97, v67
    v_mfma_f32_16x16x32_bf16 a[48:51], a[216:219], v[40:43], a[48:51]
    s_add_u32 s64, s64, s62
    ds_read_b64_tr_b16 a[236:237], v3 offset:19456
    v_permlane32_swap_b32 v96, v97
    v_mfma_f32_16x16x32_bf16 a[52:55], a[220:223], v[40:43], a[52:55]
    s_waitcnt lgkmcnt(3)
    ds_read_b64_tr_b16 a[232:233], v2 offset:19456
    v_max_f32 v98, v98, v99
    v_max_f32 v96, v96, v97
    v_mfma_f32_16x16x32_bf16 a[56:59], a[224:227], v[40:43], a[56:59]
    s_nop 0
    v_permlane16_swap_b32 v96, v98
    v_mfma_f32_16x16x32_bf16 a[60:63], a[228:231], v[40:43], a[60:63]
    s_add_u32 s64, s64, 196608
    v_max_f32 v96, v96, v98
    v_mul_f32_e64 v9, -s28, v96
    v_mfma_f32_16x16x32_bf16 a[12:15], a[228:231], v[32:35], a[12:15]
    v_subrev_f32 v9, 0x42000000, v9
    v_mov_b32 v11, v9
    v_mfma_f32_16x16x32_bf16 a[8:11], a[224:227], v[32:35], a[8:11]
    s_mov_b32 s39, s64
    ds_read_b64_tr_b16 a[220:221], v5 offset:19456
    v_accvgpr_read_b32 v108, a48
    v_mfma_f32_16x16x32_bf16 v[216:219], a[224:227], v[28:31], v[216:219]
    s_add_u32 s37, s37, 1
    v_permlane16_swap_b32 v9, v11
    v_mfma_f32_16x16x32_bf16 v[220:223], a[228:231], v[28:31], v[220:223]
    s_bitcmp1_b32 s63, s37
    ds_read_b64_tr_b16 a[216:217], v4 offset:19456
    v_mov_b32 v10, v9
    v_mfma_f32_16x16x32_bf16 v[172:175], a[228:231], v[20:23], v[172:175]
    s_cselect_b32 s62, 4294770688, 0
    v_accvgpr_read_b32 v104, a0
    v_permlane32_swap_b32 v9, v10
    v_mfma_f32_16x16x32_bf16 v[168:171], a[224:227], v[20:23], v[168:171]
    v_fma_f32 v62, v62, s28, v10
    v_mov_b32 v12, v11
    v_mfma_f32_16x16x32_bf16 v[120:123], a[224:227], v[16:19], v[120:123]
    s_cselect_b32 s42, 0, 325632
    ds_read_b64_tr_b16 a[218:219], v4 offset:13312
    v_fma_f32 v54, v54, s28, v9
    v_mfma_f32_16x16x32_bf16 v[124:127], a[228:231], v[16:19], v[124:127]
    s_waitcnt lgkmcnt(3)
    ds_read_b64_tr_b16 a[222:223], v5 offset:13312
    v_fma_f32 v52, v52, s28, v9
    v_mfma_f32_16x16x32_bf16 v[128:131], a[232:235], v[16:19], v[128:131]
    s_add_u32 s35, s35, s42
    v_permlane32_swap_b32 v11, v12
    v_mfma_f32_16x16x32_bf16 v[132:135], a[236:239], v[16:19], v[132:135]
    s_lshl_b32 s42, s37, 1
    v_fma_f32 v58, v58, s28, v9
    v_fma_f32 v65, v65, s28, v10
    v_mfma_f32_16x16x32_bf16 v[180:183], a[236:239], v[20:23], v[180:183]
    s_lshr_b32 s42, s31, s42
    ds_read_b64_tr_b16 a[226:227], v2 offset:14336
    v_fma_f32 v53, v53, s28, v9
    v_mfma_f32_16x16x32_bf16 v[176:179], a[232:235], v[20:23], v[176:179]
    s_and_b32 s42, s42, 3
    ds_read_b64_tr_b16 a[230:231], v3 offset:14336
    v_fma_f32 v70, v70, s28, v11
    v_mfma_f32_16x16x32_bf16 v[224:227], a[232:235], v[28:31], v[224:227]
    s_add_u32 s42, s42, s36
    v_exp_f32_e64 v70, v70 clamp
    v_mfma_f32_16x16x32_bf16 v[228:231], a[236:239], v[28:31], v[228:231]
    s_sub_u32 s43, s42, 3
    v_fma_f32 v79, v79, s28, v12
    v_fma_f32 v71, v71, s28, v11
    v_mfma_f32_16x16x32_bf16 a[20:23], a[236:239], v[32:35], a[20:23]
    s_cmp_ge_u32 s42, 3
    ds_read_b64_tr_b16 a[228:229], v3 offset:20480
    v_fma_f32 v78, v78, s28, v12
    v_mfma_f32_16x16x32_bf16 a[16:19], a[232:235], v[32:35], a[16:19]
    s_cselect_b32 s42, s43, s42
    v_fma_f32 v61, v61, s28, v10
    v_fma_f32 v75, v75, s28, v11
    v_mfma_f32_16x16x32_bf16 a[64:67], a[232:235], v[40:43], a[64:67]
    s_mul_i32 s44, s3, 5
    ds_read_b64_tr_b16 a[224:225], v2 offset:20480
    v_fma_f32 v82, v82, s28, v12
    v_fma_f32 v59, v59, s28, v9
    v_mfma_f32_16x16x32_bf16 a[68:71], a[236:239], v[40:43], a[68:71]
    s_waitcnt lgkmcnt(4)
    v_exp_f32_e64 v65, v65 clamp
    v_accvgpr_read_b32 v111, a51
    v_mfma_f32_16x16x32_bf16 a[72:75], a[216:219], v[40:43], a[72:75]
    s_mov_b32 s32, 1
    v_fma_f32 v63, v63, s28, v10
    v_exp_f32_e64 v59, v59 clamp
    v_mfma_f32_16x16x32_bf16 a[76:79], a[220:223], v[40:43], a[76:79]
    s_lshl_b32 s43, s3, 2
    ds_read_b64_tr_b16 a[234:235], v4 offset:14336
    v_mov_b32 v51, 0
    v_mfma_f32_16x16x32_bf16 a[28:31], a[220:223], v[32:35], a[28:31]
    s_add_u32 s45, s43, 21
    v_exp_f32_e64 v54, v54 clamp
    v_mfma_f32_16x16x32_bf16 a[24:27], a[216:219], v[32:35], a[24:27]
    s_cmp_eq_u32 s3, 0
    v_exp_f32_e64 v61, v61 clamp
    v_mfma_f32_16x16x32_bf16 v[232:235], a[216:219], v[28:31], v[232:235]
    s_cselect_b32 s45, 20, s45
    v_fma_f32 v55, v55, s28, v9
    v_fma_f32 v66, v66, s28, v10
    v_fma_f32 v69, v69, s28, v11
    v_mfma_f32_16x16x32_bf16 v[236:239], a[220:223], v[28:31], v[236:239]
    s_cselect_b32 s33, 1, 0
    v_exp_f32_e64 v53, v53 clamp
    v_mfma_f32_16x16x32_bf16 v[188:191], a[220:223], v[20:23], v[188:191]
    s_cmp_eq_u32 s42, 1
    v_exp_f32_e64 v62, v62 clamp
    v_mfma_f32_16x16x32_bf16 v[184:187], a[216:219], v[20:23], v[184:187]
    s_cselect_b32 s44, s45, s44
    v_exp_f32_e64 v55, v55 clamp
    v_mfma_f32_16x16x32_bf16 v[136:139], a[216:219], v[16:19], v[136:139]
    s_cselect_b32 s32, s33, s32
    ds_read_b64_tr_b16 a[238:239], v5 offset:14336
    v_fma_f32 v60, v60, s28, v10
    v_mfma_f32_16x16x32_bf16 v[140:143], a[220:223], v[16:19], v[140:143]
    s_waitcnt lgkmcnt(2)
    ds_read_b64_tr_b16 a[236:237], v5 offset:20480
    v_fma_f32 v67, v67, s28, v10
    v_fma_f32 v76, v76, s28, v12
    v_mfma_f32_16x16x32_bf16 v[144:147], a[224:227], v[16:19], v[144:147]
    s_add_u32 s45, s43, 37
    ds_read_b64_tr_b16 a[232:233], v4 offset:20480
    v_fma_f32 v68, v68, s28, v11
    v_mfma_f32_16x16x32_bf16 v[148:151], a[228:231], v[16:19], v[148:151]
    s_cmp_eq_u32 s42, 2
    v_fma_f32 v73, v73, s28, v11
    s_cselect_b32 s44, s45, s44
    v_mfma_f32_16x16x32_bf16 v[196:199], a[228:231], v[20:23], v[196:199]
    s_cselect_b32 s32, 0, s32
    v_fma_f32 v57, v57, s28, v9
    s_mul_i32 s44, s44, 6144
    v_mfma_f32_16x16x32_bf16 v[192:195], a[224:227], v[20:23], v[192:195]
    s_add_u32 s33, s35, s44
    v_cvt_pk_bf16_f32 v15, v54, v55
    v_exp_f32_e64 v71, v71 clamp
    v_mfma_f32_16x16x32_bf16 v[240:243], a[224:227], v[28:31], v[240:243]
    s_mul_i32 s42, s32, 6144
    v_exp_f32_e64 v69, v69 clamp
    v_mfma_f32_16x16x32_bf16 v[244:247], a[228:231], v[28:31], v[244:247]
    s_add_u32 s42, s42, 24576
    v_exp_f32_e64 v52, v52 clamp
    v_mfma_f32_16x16x32_bf16 a[36:39], a[228:231], v[32:35], a[36:39]
    s_add_u32 s42, s42, s33
    v_fma_f32 v80, v80, s28, v12
    v_exp_f32_e64 v76, v76 clamp
    v_mfma_f32_16x16x32_bf16 a[32:35], a[224:227], v[32:35], a[32:35]
    s_cmp_ge_u32 s37, 6
    s_cselect_b32 s14, 0, s42
    v_cvt_pk_bf16_f32 v14, v52, v53
    s_add_u32 s24, s67, 6144
    v_mfma_f32_16x16x32_bf16 a[80:83], a[224:227], v[40:43], a[80:83]
    s_add_u32 s25, s33, 6144
    v_cvt_pk_bf16_f32 v27, v70, v71
    s_add_u32 s23, s38, 6144
    v_mfma_f32_16x16x32_bf16 a[84:87], a[228:231], v[40:43], a[84:87]
    s_waitcnt lgkmcnt(0)
    v_exp_f32_e64 v63, v63 clamp
    v_mfma_f32_16x16x32_bf16 a[88:91], a[232:235], v[40:43], a[88:91]
    s_mov_b32 s27, 0x30c30
    v_exp_f32_e64 v68, v68 clamp
    v_mfma_f32_16x16x32_bf16 a[92:95], a[236:239], v[40:43], a[92:95]
    s_mov_b32 s89, 0xaaaaaaaa
    s_mov_b32 s30, 0
    s_waitcnt vmcnt(6)
    v_mfma_f32_16x16x32_bf16 a[44:47], a[236:239], v[32:35], a[44:47]
    s_barrier
    ds_read_b128 a[220:223], v1 offset:12288
    v_fma_f32 v74, v74, s28, v11
    v_mfma_f32_16x16x32_bf16 a[40:43], a[232:235], v[32:35], a[40:43]
    s_add_u32 m0, s22, 36864
    ds_read_b128 a[216:219], v0 offset:12288
    v_exp_f32_e64 v78, v78 clamp
    v_fma_f32 v72, v72, s28, v11
    v_cvt_pk_bf16_f32 v26, v68, v69
    v_mfma_f32_16x16x32_bf16 v[248:251], a[232:235], v[28:31], v[248:251]
    ds_read_b128 a[224:227], v0 offset:13312
    v_fma_f32 v77, v77, s28, v12
    v_mfma_f32_16x16x32_bf16 v[252:255], a[236:239], v[28:31], v[252:255]
    v_exp_f32_e64 v58, v58 clamp
    v_mfma_f32_16x16x32_bf16 v[204:207], a[236:239], v[20:23], v[204:207]
    v_exp_f32_e64 v72, v72 clamp
    v_mfma_f32_16x16x32_bf16 v[200:203], a[232:235], v[20:23], v[200:203]
    v_exp_f32_e64 v73, v73 clamp
    v_accvgpr_read_b32 v110, a50
    v_mov_b32 v49, 0
    v_mfma_f32_16x16x32_bf16 v[152:155], a[232:235], v[16:19], v[152:155]
    buffer_load_dwordx4 v6, s[8:11], s21 offen lds
    v_mfma_f32_16x16x32_bf16 v[156:159], a[236:239], v[16:19], v[156:159]
    ds_read_b128 a[236:239], v1 offset:14336
    v_exp_f32_e64 v77, v77 clamp
    v_exp_f32_e64 v60, v60 clamp
    v_pk_mul_f32 v[120:121], v[120:121], v[48:49] op_sel_hi:[1,0]
    v_pk_mul_f32 v[216:217], v[216:217], v[50:51] op_sel_hi:[1,0]
    v_pk_mul_f32 v[160:161], v[160:161], v[92:93] op_sel_hi:[1,0]
    v_cvt_pk_bf16_f32 v22, v60, v61
    v_accvgpr_read_b32 v105, a1
    s_waitcnt lgkmcnt(2)
    v_mfma_f32_16x16x32_bf16 v[52:55], a[216:219], a[96:99], 0
    v_fma_f32 v56, v56, s28, v9
    v_cvt_pk_bf16_f32 v23, v62, v63
    v_mfma_f32_16x16x32_bf16 v[52:55], a[220:223], a[100:103], v[52:55]
    s_waitcnt lgkmcnt(1)
    ds_read_b128 a[228:231], v1 offset:13312
    v_fma_f32 v64, v64, s28, v10
    v_mfma_f32_16x16x32_bf16 v[52:55], a[224:227], a[104:107], v[52:55]
    ds_read_b128 a[232:235], v0 offset:14336
    v_cvt_pk_bf16_f32 v34, v76, v77
    v_mfma_f32_16x16x32_bf16 v[60:63], a[224:227], a[128:131], 0
    v_exp_f32_e64 v79, v79 clamp
    v_mfma_f32_16x16x32_bf16 v[60:63], a[220:223], a[124:127], v[60:63]
    v_exp_f32_e64 v75, v75 clamp
    v_accvgpr_read_b32 v107, a3
    v_mfma_f32_16x16x32_bf16 v[60:63], a[216:219], a[120:123], v[60:63]
    v_cvt_pk_bf16_f32 v35, v78, v79
    v_fma_f32 v81, v81, s28, v12
    v_mfma_f32_16x16x32_bf16 v[68:71], a[216:219], a[144:147], 0
    v_exp_f32_e64 v82, v82 clamp
    v_mfma_f32_16x16x32_bf16 v[68:71], a[220:223], a[148:151], v[68:71]
    s_add_u32 s21, s21, 128
    v_accvgpr_read_b32 v109, a49
    v_cvt_pk_bf16_f32 v17, v58, v59
    v_mfma_f32_16x16x32_bf16 v[68:71], a[224:227], a[152:155], v[68:71]
    s_add_u32 m0, s22, 37888
    v_cvt_pk_bf16_f32 v160, v160, v161
    v_accvgpr_read_b32 v106, a2
    v_mfma_f32_16x16x32_bf16 v[76:79], a[224:227], a[176:179], 0
    v_exp_f32_e64 v74, v74 clamp
    v_mfma_f32_16x16x32_bf16 v[76:79], a[220:223], a[172:175], v[76:79]
    v_fma_f32 v83, v83, s28, v12
    v_mov_b32 v39, v7
    v_mfma_f32_16x16x32_bf16 v[76:79], a[216:219], a[168:171], v[76:79]
    s_waitcnt lgkmcnt(1)
    v_cvt_pk_bf16_f32 v29, v74, v75
    v_exp_f32_e64 v66, v66 clamp
    v_cvt_pk_bf16_f32 v28, v72, v73
    v_mfma_f32_16x16x32_bf16 v[76:79], a[228:231], a[180:183], v[76:79]
    s_waitcnt lgkmcnt(0)
    ds_read_b128 a[224:227], v0 offset:19456
    v_exp_f32_e64 v64, v64 clamp
    v_mfma_f32_16x16x32_bf16 v[76:79], a[232:235], a[184:187], v[76:79]
    buffer_load_dwordx4 v6, s[8:11], s21 offen lds
    v_mfma_f32_16x16x32_bf16 v[76:79], a[236:239], a[188:191], v[76:79]
    ds_read_b128 a[220:223], v1 offset:18432
    v_exp_f32_e64 v80, v80 clamp
    v_mfma_f32_16x16x32_bf16 v[68:71], a[236:239], a[164:167], v[68:71]
    v_exp_f32_e64 v57, v57 clamp
    v_mfma_f32_16x16x32_bf16 v[68:71], a[232:235], a[160:163], v[68:71]
    ds_read_b128 a[216:219], v0 offset:18432
    v_exp_f32_e64 v56, v56 clamp
    v_exp_f32_e64 v67, v67 clamp
    v_pk_mul_f32 v[234:235], v[234:235], v[50:51] op_sel_hi:[1,0]
    v_pk_mul_f32 v[162:163], v[162:163], v[92:93] op_sel_hi:[1,0]
    v_pk_mul_f32 v[116:117], v[116:117], v[48:49] op_sel_hi:[1,0]
    v_pk_mul_f32 v[196:197], v[196:197], v[92:93] op_sel_hi:[1,0]
    v_pk_mul_f32 v[214:215], v[214:215], v[50:51] op_sel_hi:[1,0]
    v_pk_mul_f32 v[104:105], v[104:105], v[94:95] op_sel_hi:[1,0]
    v_pk_mul_f32 v[132:133], v[132:133], v[48:49] op_sel_hi:[1,0]
    v_pk_mul_f32 v[126:127], v[126:127], v[48:49] op_sel_hi:[1,0]
    v_pk_mul_f32 v[112:113], v[112:113], v[48:49] op_sel_hi:[1,0]
    v_pk_mul_f32 v[106:107], v[106:107], v[94:95] op_sel_hi:[1,0]
    v_pk_mul_f32 v[164:165], v[164:165], v[92:93] op_sel_hi:[1,0]
    v_pk_mul_f32 v[232:233], v[232:233], v[50:51] op_sel_hi:[1,0]
    v_pk_mul_f32 v[210:211], v[210:211], v[50:51] op_sel_hi:[1,0]
    v_pk_mul_f32 v[212:213], v[212:213], v[50:51] op_sel_hi:[1,0]
    v_pk_mul_f32 v[218:219], v[218:219], v[50:51] op_sel_hi:[1,0]
    v_pk_mul_f32 v[208:209], v[208:209], v[50:51] op_sel_hi:[1,0]
    v_pk_mul_f32 v[114:115], v[114:115], v[48:49] op_sel_hi:[1,0]
    v_pk_mul_f32 v[220:221], v[220:221], v[50:51] op_sel_hi:[1,0]
    v_pk_mul_f32 v[110:111], v[110:111], v[100:101] op_sel_hi:[1,0]
    v_pk_mul_f32 v[194:195], v[194:195], v[92:93] op_sel_hi:[1,0]
    v_pk_mul_f32 v[118:119], v[118:119], v[48:49] op_sel_hi:[1,0]
    v_pk_mul_f32 v[146:147], v[146:147], v[48:49] op_sel_hi:[1,0]
    v_pk_mul_f32 v[170:171], v[170:171], v[92:93] op_sel_hi:[1,0]
    v_pk_mul_f32 v[124:125], v[124:125], v[48:49] op_sel_hi:[1,0]
    v_pk_mul_f32 v[108:109], v[108:109], v[100:101] op_sel_hi:[1,0]
    v_cvt_pk_bf16_f32 v116, v116, v117
    v_cvt_pk_bf16_f32 v208, v208, v209
    v_mfma_f32_16x16x32_bf16 v[68:71], a[228:231], a[156:159], v[68:71]
    v_cvt_pk_bf16_f32 v216, v216, v217
    v_cvt_pk_bf16_f32 v16, v56, v57
    v_cvt_pk_bf16_f32 v232, v232, v233
    v_mfma_f32_16x16x32_bf16 v[60:63], a[228:231], a[132:135], v[60:63]
    v_cvt_pk_bf16_f32 v25, v66, v67
    v_cvt_pk_bf16_f32 v108, v108, v109
    v_mfma_f32_16x16x32_bf16 v[60:63], a[232:235], a[136:139], v[60:63]
    v_cvt_pk_bf16_f32 v132, v132, v133
    v_cvt_pk_bf16_f32 v24, v64, v65
    v_mfma_f32_16x16x32_bf16 v[60:63], a[236:239], a[140:143], v[60:63]
    v_exp_f32_e64 v83, v83 clamp
    v_mfma_f32_16x16x32_bf16 v[52:55], a[236:239], a[116:119], v[52:55]
    v_cvt_pk_bf16_f32 v104, v104, v105
    v_cvt_pk_bf16_f32 v161, v162, v163
    v_mfma_f32_16x16x32_bf16 v[52:55], a[232:235], a[112:115], v[52:55]
    s_add_u32 s21, s21, 128
    ds_read_b128 a[232:235], v0 offset:20480
    v_cvt_pk_bf16_f32 v37, v82, v83
    v_mfma_f32_16x16x32_bf16 v[52:55], a[228:231], a[108:111], v[52:55]
    s_waitcnt lgkmcnt(1)
    v_cvt_pk_bf16_f32 v212, v212, v213
    v_cvt_pk_bf16_f32 v220, v220, v221
    v_mfma_f32_16x16x32_bf16 v[56:59], a[216:219], a[96:99], 0
    ds_read_b128 a[236:239], v1 offset:20480
    v_cvt_pk_bf16_f32 v209, v210, v211
    v_mfma_f32_16x16x32_bf16 v[56:59], a[220:223], a[100:103], v[56:59]
    s_add_u32 m0, s22, 38912
    ds_read_b128 a[228:231], v1 offset:19456
    v_cvt_pk_bf16_f32 v213, v214, v215
    v_fma_f32 v61, v61, s28, v10
    v_mfma_f32_16x16x32_bf16 v[56:59], a[224:227], a[104:107], v[56:59]
    v_cvt_pk_bf16_f32 v120, v120, v121
    v_cvt_pk_bf16_f32 v105, v106, v107
    v_mfma_f32_16x16x32_bf16 v[64:67], a[224:227], a[128:131], 0
    v_accvgpr_read_b32 v107, a7
    v_fma_f32 v68, v68, s28, v11
    v_fma_f32 v60, v60, s28, v10
    v_exp_f32_e64 v81, v81 clamp
    v_pk_mul_f32 v[168:169], v[168:169], v[92:93] op_sel_hi:[1,0]
    v_cvt_pk_bf16_f32 v109, v110, v111
    v_fma_f32 v71, v71, s28, v11
    v_mfma_f32_16x16x32_bf16 v[64:67], a[220:223], a[124:127], v[64:67]
    v_cvt_pk_bf16_f32 v164, v164, v165
    v_cvt_pk_bf16_f32 v217, v218, v219
    v_mfma_f32_16x16x32_bf16 v[64:67], a[216:219], a[120:123], v[64:67]
    v_cvt_pk_bf16_f32 v112, v112, v113
    v_cvt_pk_bf16_f32 v36, v80, v81
    v_mfma_f32_16x16x32_bf16 v[72:75], a[216:219], a[144:147], 0
    buffer_load_dwordx4 v6, s[8:11], s21 offen lds
    v_mfma_f32_16x16x32_bf16 v[72:75], a[220:223], a[148:151], v[72:75]
    v_cvt_pk_bf16_f32 v113, v114, v115
    v_cvt_pk_bf16_f32 v117, v118, v119
    v_mfma_f32_16x16x32_bf16 v[72:75], a[224:227], a[152:155], v[72:75]
    v_exp_f32_e64 v60, v60 clamp
    v_mfma_f32_16x16x32_bf16 v[80:83], a[224:227], a[176:179], 0
    s_add_u32 s21, s21, 12032
    v_fma_f32 v70, v70, s28, v11
    v_fma_f32 v69, v69, s28, v11
    v_mfma_f32_16x16x32_bf16 v[80:83], a[220:223], a[172:175], v[80:83]
    s_waitcnt vmcnt(6) lgkmcnt(0)
    v_fma_f32 v54, v54, s28, v9
    v_exp_f32_e64 v71, v71 clamp
    v_mfma_f32_16x16x32_bf16 v[80:83], a[216:219], a[168:171], v[80:83]
    s_barrier
    v_mfma_f32_16x16x32_bf16 v[80:83], a[228:231], a[180:183], v[80:83]
    s_add_u32 m0, s22, 12288
    ds_read_b64_tr_b16 a[216:217], v2 offset:0
    v_cvt_pk_bf16_f32 v168, v168, v169
    v_mfma_f32_16x16x32_bf16 v[80:83], a[232:235], a[184:187], v[80:83]
    ds_read_b64_tr_b16 a[218:219], v2 offset:6144
    v_accvgpr_read_b32 v110, a54
    v_mfma_f32_16x16x32_bf16 v[80:83], a[236:239], a[188:191], v[80:83]
    ds_read_b64_tr_b16 a[220:221], v3 offset:0
    v_fma_f32 v55, v55, s28, v9
    v_mfma_f32_16x16x32_bf16 v[72:75], a[236:239], a[164:167], v[72:75]
    buffer_load_dwordx4 v6, s[4:7], s20 offen lds
    v_mfma_f32_16x16x32_bf16 v[72:75], a[232:235], a[160:163], v[72:75]
    ds_read_b64_tr_b16 a[222:223], v3 offset:6144
    v_mov_b32 v38, v6
    v_exp_f32_e64 v55, v55 clamp
    v_mfma_f32_16x16x32_bf16 v[72:75], a[228:231], a[156:159], v[72:75]
    ds_write2st64_b64 v93, v[112:113], v[160:161] offset0:0 offset1:12
    v_mfma_f32_16x16x32_bf16 v[64:67], a[228:231], a[132:135], v[64:67]
    ds_write2st64_b64 v93, v[208:209], v[104:105] offset0:24 offset1:36
    v_mfma_f32_16x16x32_bf16 v[44:47], a[248:251], v[14:17], 0
    v_fma_f32 v76, v76, s28, v12
    v_fma_f32 v82, v82, s28, v12
    v_mfma_f32_16x16x32_bf16 v[64:67], a[232:235], a[136:139], v[64:67]
    s_add_u32 s20, s20, 128
    ds_read_b64_tr_b16 a[224:225], v4 offset:0
    v_accvgpr_read_b32 v104, a4
    v_mfma_f32_16x16x32_bf16 v[64:67], a[236:239], a[140:143], v[64:67]
    v_accvgpr_read_b32 v111, a55
    v_fma_f32 v62, v62, s28, v10
    v_fma_f32 v52, v52, s28, v9
    v_accvgpr_read_b32 v105, a5
    v_fma_f32 v72, v72, s28, v11
    v_pk_mul_f32 v[224:225], v[224:225], v[50:51] op_sel_hi:[1,0]
    v_pk_mul_f32 v[176:177], v[176:177], v[92:93] op_sel_hi:[1,0]
    v_fma_f32 v53, v53, s28, v9
    v_cvt_pk_bf16_f32 v124, v124, v125
    v_fma_f32 v79, v79, s28, v12
    v_accvgpr_read_b32 v106, a6
    v_cvt_pk_bf16_f32 v224, v224, v225
    v_exp_f32_e64 v68, v68 clamp
    v_mfma_f32_16x16x32_bf16 v[56:59], a[236:239], a[116:119], v[56:59]
    ds_write_b64 v93, v[108:109] offset:24576
    v_mfma_f32_16x16x32_bf16 v[56:59], a[232:235], a[112:115], v[56:59]
    s_add_u32 m0, s22, 13312
    ds_read_b64_tr_b16 a[226:227], v4 offset:6144
    buffer_load_dwordx4 v6, s[4:7], s20 offen lds
    v_exp_f32_e64 v52, v52 clamp
    v_fma_f32 v63, v63, s28, v10
    v_fma_f32 v78, v78, s28, v12
    v_pk_mul_f32 v[148:149], v[148:149], v[48:49] op_sel_hi:[1,0]
    v_pk_mul_f32 v[244:245], v[244:245], v[50:51] op_sel_hi:[1,0]
    v_cvt_pk_bf16_f32 v176, v176, v177
    v_pk_mul_f32 v[248:249], v[248:249], v[50:51] op_sel_hi:[1,0]
    v_pk_mul_f32 v[246:247], v[246:247], v[50:51] op_sel_hi:[1,0]
    v_pk_mul_f32 v[186:187], v[186:187], v[92:93] op_sel_hi:[1,0]
    v_pk_mul_f32 v[226:227], v[226:227], v[50:51] op_sel_hi:[1,0]
    v_accvgpr_read_b32 v108, a52
    v_pk_mul_f32 v[222:223], v[222:223], v[50:51] op_sel_hi:[1,0]
    v_pk_mul_f32 v[122:123], v[122:123], v[48:49] op_sel_hi:[1,0]
    v_accvgpr_read_b32 v109, a53
    v_pk_mul_f32 v[228:229], v[228:229], v[50:51] op_sel_hi:[1,0]
    v_pk_mul_f32 v[166:167], v[166:167], v[92:93] op_sel_hi:[1,0]
    v_pk_mul_f32 v[184:185], v[184:185], v[92:93] op_sel_hi:[1,0]
    v_pk_mul_f32 v[108:109], v[108:109], v[100:101] op_sel_hi:[1,0]
    v_pk_mul_f32 v[252:253], v[252:253], v[50:51] op_sel_hi:[1,0]
    v_pk_mul_f32 v[178:179], v[178:179], v[92:93] op_sel_hi:[1,0]
    v_pk_mul_f32 v[180:181], v[180:181], v[92:93] op_sel_hi:[1,0]
    v_pk_mul_f32 v[104:105], v[104:105], v[94:95] op_sel_hi:[1,0]
    v_pk_mul_f32 v[106:107], v[106:107], v[94:95] op_sel_hi:[1,0]
    v_cvt_pk_bf16_f32 v244, v244, v245
    v_pk_mul_f32 v[128:129], v[128:129], v[48:49] op_sel_hi:[1,0]
    v_pk_mul_f32 v[156:157], v[156:157], v[48:49] op_sel_hi:[1,0]
    v_cvt_pk_bf16_f32 v165, v166, v167
    v_cvt_pk_bf16_f32 v108, v108, v109
    v_mfma_f32_16x16x32_bf16 v[56:59], a[228:231], a[108:111], v[56:59]
    s_waitcnt lgkmcnt(1)
    ds_read_b64_tr_b16 a[234:235], v2 offset:7168
    v_exp_f32_e64 v61, v61 clamp
    v_mfma_f32_16x16x32_bf16 v[112:115], a[216:219], v[14:17], 0
    ds_write2st64_b64 v95, v[116:117], v[164:165] offset0:0 offset1:12
    v_pk_mul_f32 v[110:111], v[110:111], v[100:101] op_sel_hi:[1,0]
    v_pk_mul_f32 v[174:175], v[174:175], v[92:93] op_sel_hi:[1,0]
    v_pk_mul_f32 v[198:199], v[198:199], v[92:93] op_sel_hi:[1,0]
    v_fma_f32 v77, v77, s28, v12
    v_cvt_pk_bf16_f32 v121, v122, v123
    v_pk_mul_f32 v[236:237], v[236:237], v[50:51] op_sel_hi:[1,0]
    v_cvt_pk_bf16_f32 v104, v104, v105
    v_cvt_pk_bf16_f32 v105, v106, v107
    v_cvt_pk_bf16_f32 v109, v110, v111
    v_mfma_f32_16x16x32_bf16 v[160:163], a[216:219], v[22:25], 0
    s_add_u32 s20, s20, 128
    ds_read_b64_tr_b16 a[228:229], v5 offset:0
    v_cvt_pk_bf16_f32 v128, v128, v129
    v_mfma_f32_16x16x32_bf16 v[208:211], a[216:219], v[26:29], 0
    ds_write2st64_b64 v95, v[212:213], v[104:105] offset0:24 offset1:36
    v_pk_mul_f32 v[136:137], v[136:137], v[48:49] op_sel_hi:[1,0]
    v_pk_mul_f32 v[192:193], v[192:193], v[92:93] op_sel_hi:[1,0]
    v_pk_mul_f32 v[172:173], v[172:173], v[92:93] op_sel_hi:[1,0]
    v_accvgpr_read_b32 v105, a9
    v_cvt_pk_bf16_f32 v169, v170, v171
    v_cvt_pk_bf16_f32 v172, v172, v173
    v_mfma_f32_16x16x32_bf16 a[0:3], a[216:219], v[34:37], 0
    s_add_u32 m0, s22, 14336
    ds_read_b64_tr_b16 a[230:231], v5 offset:6144
    v_cvt_pk_bf16_f32 v180, v180, v181
    v_smfmac_f32_16x16x64_bf16 v[44:47], a[240:243], v[22:29], v101
    buffer_load_dwordx4 v6, s[4:7], s20 offen lds
    ds_read_b64_tr_b16 a[216:217], v4 offset:1024
    v_mfma_f32_16x16x32_bf16 a[4:7], a[220:223], v[34:37], 0
    ds_read_b64_tr_b16 a[236:237], v3 offset:1024
    v_fma_f32 v73, v73, s28, v11
    v_mfma_f32_16x16x32_bf16 v[44:47], a[252:255], v[34:37], v[44:47]
    ds_write_b64 v95, v[108:109] offset:24576
    v_accvgpr_read_b32 v107, a11
    v_fma_f32 v57, v57, s28, v9
    v_mfma_f32_16x16x32_bf16 v[212:215], a[220:223], v[26:29], 0
    s_add_u32 s20, s20, 12032
    ds_read_b64_tr_b16 a[238:239], v3 offset:7168
    ds_read_b64_tr_b16 a[232:233], v2 offset:1024
    v_accvgpr_read_b32 v104, a8
    v_accvgpr_read_b32 v110, a58
    v_cvt_pk_bf16_f32 v236, v236, v237
    v_accvgpr_read_b32 v106, a10
    v_pk_mul_f32 v[104:105], v[104:105], v[94:95] op_sel_hi:[1,0]
    v_cvt_pk_bf16_f32 v156, v156, v157
    v_pk_mul_f32 v[254:255], v[254:255], v[50:51] op_sel_hi:[1,0]
    v_pk_mul_f32 v[138:139], v[138:139], v[48:49] op_sel_hi:[1,0]
    v_exp_f32_e64 v76, v76 clamp
    v_accvgpr_read_b32 v109, a57
    v_accvgpr_read_b32 v111, a59
    v_accvgpr_read_b32 v108, a56
    v_pk_mul_f32 v[106:107], v[106:107], v[94:95] op_sel_hi:[1,0]
    v_cvt_pk_bf16_f32 v125, v126, v127
    v_pk_mul_f32 v[150:151], v[150:151], v[48:49] op_sel_hi:[1,0]
    v_pk_mul_f32 v[240:241], v[240:241], v[50:51] op_sel_hi:[1,0]
    v_pk_mul_f32 v[204:205], v[204:205], v[92:93] op_sel_hi:[1,0]
    v_cvt_pk_bf16_f32 v245, v246, v247
    v_pk_mul_f32 v[188:189], v[188:189], v[92:93] op_sel_hi:[1,0]
    v_pk_mul_f32 v[242:243], v[242:243], v[50:51] op_sel_hi:[1,0]
    v_pk_mul_f32 v[108:109], v[108:109], v[100:101] op_sel_hi:[1,0]
    v_cvt_pk_bf16_f32 v228, v228, v229
    v_pk_mul_f32 v[110:111], v[110:111], v[100:101] op_sel_hi:[1,0]
    v_cvt_pk_bf16_f32 v108, v108, v109
    v_pk_mul_f32 v[134:135], v[134:135], v[48:49] op_sel_hi:[1,0]
    v_cvt_pk_bf16_f32 v136, v136, v137
    v_cvt_pk_bf16_f32 v173, v174, v175
    v_mfma_f32_16x16x32_bf16 v[164:167], a[220:223], v[22:25], 0
    ds_write2st64_b64 v8, v[120:121], v[168:169] offset0:0 offset1:12
    v_cvt_pk_bf16_f32 v104, v104, v105
    v_pk_mul_f32 v[154:155], v[154:155], v[48:49] op_sel_hi:[1,0]
    v_subrev_u32 v103, 28672, v103
    v_cvt_pk_bf16_f32 v105, v106, v107
    v_cvt_pk_bf16_f32 v233, v234, v235
    v_mfma_f32_16x16x32_bf16 v[116:119], a[220:223], v[14:17], 0
    s_waitcnt lgkmcnt(1)
    ds_write2st64_b64 v8, v[216:217], v[104:105] offset0:24 offset1:36
    v_cvt_pk_bf16_f32 v109, v110, v111
    v_mfma_f32_16x16x32_bf16 v[120:123], a[224:227], v[14:17], 0
    ds_write_b64 v8, v[108:109] offset:24576
    v_mfma_f32_16x16x32_bf16 v[168:171], a[224:227], v[22:25], 0
    ds_write2st64_b64 v102, v[124:125], v[172:173] offset0:0 offset1:12
    v_pk_mul_f32 v[130:131], v[130:131], v[48:49] op_sel_hi:[1,0]
    v_accvgpr_read_b32 v109, a61
    v_pk_mul_f32 v[238:239], v[238:239], v[50:51] op_sel_hi:[1,0]
    v_accvgpr_read_b32 v107, a15
    v_accvgpr_read_b32 v110, a62
    v_pk_mul_f32 v[182:183], v[182:183], v[92:93] op_sel_hi:[1,0]
    v_cvt_pk_bf16_f32 v225, v226, v227
    v_cvt_pk_bf16_f32 v237, v238, v239
    v_accvgpr_read_b32 v108, a60
    v_accvgpr_read_b32 v111, a63
    v_accvgpr_read_b32 v104, a12
    v_exp_f32_e64 v79, v79 clamp
    v_accvgpr_read_b32 v106, a14
    v_fma_f32 v83, v83, s28, v12
    v_cvt_pk_bf16_f32 v192, v192, v193
    v_pk_mul_f32 v[106:107], v[106:107], v[94:95] op_sel_hi:[1,0]
    v_pk_mul_f32 v[230:231], v[230:231], v[50:51] op_sel_hi:[1,0]
    v_accvgpr_read_b32 v105, a13
    v_cvt_pk_bf16_f32 v221, v222, v223
    v_pk_mul_f32 v[110:111], v[110:111], v[100:101] op_sel_hi:[1,0]
    v_pk_mul_f32 v[104:105], v[104:105], v[94:95] op_sel_hi:[1,0]
    v_pk_mul_f32 v[144:145], v[144:145], v[48:49] op_sel_hi:[1,0]
    v_cvt_pk_bf16_f32 v104, v104, v105
    v_cvt_pk_bf16_f32 v148, v148, v149
    v_pk_mul_f32 v[108:109], v[108:109], v[100:101] op_sel_hi:[1,0]
    v_cvt_pk_bf16_f32 v240, v240, v241
    v_exp_f32_e64 v77, v77 clamp
    v_cvt_pk_bf16_f32 v108, v108, v109
    v_fma_f32 v75, v75, s28, v11
    v_cvt_pk_bf16_f32 v177, v178, v179
    v_cvt_pk_bf16_f32 v105, v106, v107
    v_mfma_f32_16x16x32_bf16 v[216:219], a[224:227], v[26:29], 0
    ds_write2st64_b64 v102, v[220:221], v[104:105] offset0:24 offset1:36
    v_cvt_pk_bf16_f32 v129, v130, v131
    v_accvgpr_read_b32 v105, a17
    v_fma_f32 v81, v81, s28, v12
    v_pk_mul_f32 v[202:203], v[202:203], v[92:93] op_sel_hi:[1,0]
    v_accvgpr_read_b32 v104, a16
    v_cvt_pk_bf16_f32 v109, v110, v111
    v_pk_mul_f32 v[104:105], v[104:105], v[94:95] op_sel_hi:[1,0]
    v_cvt_pk_bf16_f32 v204, v204, v205
    v_accvgpr_read_b32 v106, a18
    v_mfma_f32_16x16x32_bf16 a[8:11], a[224:227], v[34:37], 0
    ds_write_b64 v102, v[108:109] offset:24576
    v_cvt_pk_bf16_f32 v133, v134, v135
    v_accvgpr_read_b32 v110, a66
    v_mfma_f32_16x16x32_bf16 a[12:15], a[228:231], v[34:37], 0
    ds_write2st64_b64 v93, v[128:129], v[176:177] offset0:4 offset1:16
    v_accvgpr_read_b32 v109, a65
    v_pk_mul_f32 v[190:191], v[190:191], v[92:93] op_sel_hi:[1,0]
    v_accvgpr_read_b32 v107, a19
    v_accvgpr_read_b32 v108, a64
    v_cvt_pk_bf16_f32 v193, v194, v195
    v_cvt_pk_bf16_f32 v104, v104, v105
    v_cvt_pk_bf16_f32 v137, v138, v139
    v_pk_mul_f32 v[106:107], v[106:107], v[94:95] op_sel_hi:[1,0]
    v_fma_f32 v56, v56, s28, v9
    v_pk_mul_f32 v[158:159], v[158:159], v[48:49] op_sel_hi:[1,0]
    v_cvt_pk_bf16_f32 v188, v188, v189
    v_pk_mul_f32 v[206:207], v[206:207], v[92:93] op_sel_hi:[1,0]
    v_cvt_pk_bf16_f32 v105, v106, v107
    v_cvt_pk_bf16_f32 v229, v230, v231
    v_fma_f32 v65, v65, s28, v10
    v_pk_mul_f32 v[108:109], v[108:109], v[100:101] op_sel_hi:[1,0]
    v_accvgpr_read_b32 v111, a67
    v_pk_mul_f32 v[110:111], v[110:111], v[100:101] op_sel_hi:[1,0]
    v_accvgpr_read_b32 v106, a22
    v_cvt_pk_bf16_f32 v108, v108, v109
    v_mfma_f32_16x16x32_bf16 v[220:223], a[228:231], v[26:29], 0
    ds_write2st64_b64 v93, v[224:225], v[104:105] offset0:28 offset1:40
    v_accvgpr_read_b32 v104, a20
    v_cvt_pk_bf16_f32 v109, v110, v111
    v_cvt_pk_bf16_f32 v241, v242, v243
    v_accvgpr_read_b32 v110, a70
    v_mfma_f32_16x16x32_bf16 v[172:175], a[228:231], v[22:25], 0
    ds_read_b128 v[84:87], v103 offset:1024
    v_accvgpr_read_b32 v107, a23
    v_accvgpr_read_b32 v105, a21
    v_fma_f32 v67, v67, s28, v10
    v_cvt_pk_bf16_f32 v181, v182, v183
    v_mfma_f32_16x16x32_bf16 v[124:127], a[228:231], v[14:17], 0
    ds_read_b64_tr_b16 a[218:219], v4 offset:7168
    ds_read_b64_tr_b16 a[224:225], v2 offset:2048
    v_exp_f32_e64 v73, v73 clamp
    v_mfma_f32_16x16x32_bf16 v[128:131], a[232:235], v[14:17], 0
    ds_write_b64 v93, v[108:109] offset:26624
    v_exp_f32_e64 v54, v54 clamp
    v_pk_mul_f32 v[250:251], v[250:251], v[50:51] op_sel_hi:[1,0]
    v_pk_mul_f32 v[104:105], v[104:105], v[94:95] op_sel_hi:[1,0]
    v_accvgpr_read_b32 v108, a68
    v_pk_mul_f32 v[140:141], v[140:141], v[48:49] op_sel_hi:[1,0]
    v_pk_mul_f32 v[152:153], v[152:153], v[48:49] op_sel_hi:[1,0]
    v_pk_mul_f32 v[142:143], v[142:143], v[48:49] op_sel_hi:[1,0]
    v_pk_mul_f32 v[106:107], v[106:107], v[94:95] op_sel_hi:[1,0]
    v_cvt_pk_bf16_f32 v196, v196, v197
    v_cvt_pk_bf16_f32 v104, v104, v105
    v_cvt_pk_bf16_f32 v105, v106, v107
    v_accvgpr_read_b32 v109, a69
    v_cvt_pk_bf16_f32 v144, v144, v145
    v_cvt_pk_bf16_f32 v184, v184, v185
    v_mfma_f32_16x16x32_bf16 v[176:179], a[232:235], v[22:25], 0
    ds_write2st64_b64 v95, v[132:133], v[180:181] offset0:4 offset1:16
    v_exp_f32_e64 v62, v62 clamp
    v_exp_f32_e64 v78, v78 clamp
    v_mfma_f32_16x16x32_bf16 v[224:227], a[232:235], v[26:29], 0
    s_add_u32 s39, s39, 12288
    ds_write2st64_b64 v95, v[228:229], v[104:105] offset0:28 offset1:40
    v_accvgpr_read_b32 v106, a26
    v_accvgpr_read_b32 v111, a71
    v_accvgpr_read_b32 v105, a25
    v_accvgpr_read_b32 v107, a27
    v_cvt_pk_bf16_f32 v185, v186, v187
    v_pk_mul_f32 v[108:109], v[108:109], v[100:101] op_sel_hi:[1,0]
    v_accvgpr_read_b32 v104, a24
    v_pk_mul_f32 v[104:105], v[104:105], v[94:95] op_sel_hi:[1,0]
    v_cvt_pk_bf16_f32 v108, v108, v109
    v_cvt_pk_bf16_f32 v104, v104, v105
    v_pk_mul_f32 v[110:111], v[110:111], v[100:101] op_sel_hi:[1,0]
    v_pk_mul_f32 v[106:107], v[106:107], v[94:95] op_sel_hi:[1,0]
    v_cvt_pk_bf16_f32 v149, v150, v151
    v_cvt_pk_bf16_f32 v140, v140, v141
    v_cvt_pk_bf16_f32 v109, v110, v111
    v_mfma_f32_16x16x32_bf16 a[16:19], a[232:235], v[34:37], 0
    ds_read_b128 v[96:99], v103 offset:0
    ds_read_b64_tr_b16 a[226:227], v2 offset:8192
    v_mfma_f32_16x16x32_bf16 a[20:23], a[236:239], v[34:37], 0
    ds_read_b64_tr_b16 a[232:233], v4 offset:2048
    ds_read_b64_tr_b16 a[222:223], v5 offset:7168
    v_accvgpr_read_b32 v111, a75
    v_mfma_f32_16x16x32_bf16 v[228:231], a[236:239], v[26:29], 0
    ds_write_b64 v95, v[108:109] offset:26624
    ds_read_b64_tr_b16 a[234:235], v4 offset:8192
    v_mfma_f32_16x16x32_bf16 v[180:183], a[236:239], v[22:25], 0
    ds_write2st64_b64 v8, v[136:137], v[184:185] offset0:4 offset1:16
    v_cvt_pk_bf16_f32 v105, v106, v107
    v_accvgpr_read_b32 v109, a73
    v_accvgpr_read_b32 v106, a30
    v_fma_f32 v80, v80, s28, v12
    v_mfma_f32_16x16x32_bf16 v[132:135], a[236:239], v[14:17], 0
    s_waitcnt lgkmcnt(7)
    ds_read_b64_tr_b16 a[238:239], v5 offset:8192
    ds_read_b64_tr_b16 a[228:229], v3 offset:2048
    v_mfma_f32_16x16x32_bf16 v[136:139], a[216:219], v[14:17], 0
    ds_read_b64_tr_b16 a[236:237], v5 offset:2048
    ds_read_b64_tr_b16 a[230:231], v3 offset:8192
    ds_read_b64_tr_b16 a[220:221], v5 offset:1024
    v_accvgpr_read_b32 v108, a72
    v_mfma_f32_16x16x32_bf16 v[184:187], a[216:219], v[22:25], 0
    ds_write2st64_b64 v8, v[232:233], v[104:105] offset0:28 offset1:40
    v_accvgpr_read_b32 v110, a74
    v_pk_mul_f32 v[108:109], v[108:109], v[100:101] op_sel_hi:[1,0]
    v_cvt_pk_bf16_f32 v252, v252, v253
    v_cvt_pk_bf16_f32 v189, v190, v191
    v_accvgpr_read_b32 v104, a28
    v_accvgpr_read_b32 v107, a31
    v_cvt_pk_bf16_f32 v197, v198, v199
    v_cvt_pk_bf16_f32 v145, v146, v147
    v_fma_f32 v74, v74, s28, v11
    v_pk_mul_f32 v[110:111], v[110:111], v[100:101] op_sel_hi:[1,0]
    v_cvt_pk_bf16_f32 v248, v248, v249
    v_pk_mul_f32 v[200:201], v[200:201], v[92:93] op_sel_hi:[1,0]
    v_cvt_pk_bf16_f32 v108, v108, v109
    v_accvgpr_read_b32 v105, a29
    v_pk_mul_f32 v[104:105], v[104:105], v[94:95] op_sel_hi:[1,0]
    v_cvt_pk_bf16_f32 v141, v142, v143
    v_cvt_pk_bf16_f32 v109, v110, v111
    v_mfma_f32_16x16x32_bf16 v[232:235], a[216:219], v[26:29], 0
    ds_write_b64 v8, v[108:109] offset:26624
    v_cvt_pk_bf16_f32 v152, v152, v153
    v_cvt_pk_bf16_f32 v104, v104, v105
    v_pk_mul_f32 v[106:107], v[106:107], v[94:95] op_sel_hi:[1,0]
    v_accvgpr_read_b32 v110, a78
    v_accvgpr_read_b32 v109, a77
    v_accvgpr_read_b32 v111, a79
    v_cvt_pk_bf16_f32 v105, v106, v107
    v_mfma_f32_16x16x32_bf16 a[24:27], a[216:219], v[34:37], 0
    s_waitcnt vmcnt(6) lgkmcnt(2)
    ds_write2st64_b64 v102, v[140:141], v[188:189] offset0:4 offset1:16
    v_exp_f32_e64 v72, v72 clamp
    v_mfma_f32_16x16x32_bf16 a[28:31], a[220:223], v[34:37], 0
    buffer_store_dwordx4 v[96:99], v6, s[16:19], s67 offen offset:0 nt
    s_barrier
    ds_write2st64_b64 v102, v[236:237], v[104:105] offset0:28 offset1:40
    v_accvgpr_read_b32 v105, a33
    v_fma_f32 v66, v66, s28, v10
    v_accvgpr_read_b32 v107, a35
    v_pk_mul_f32 v[110:111], v[110:111], v[100:101] op_sel_hi:[1,0]
    v_cvt_pk_bf16_f32 v157, v158, v159
    v_cvt_pk_bf16_f32 v253, v254, v255
    v_accvgpr_read_b32 v108, a76
    v_accvgpr_read_b32 v104, a32
    v_fma_f32 v64, v64, s28, v10
    v_pk_mul_f32 v[104:105], v[104:105], v[94:95] op_sel_hi:[1,0]
    v_pk_mul_f32 v[108:109], v[108:109], v[100:101] op_sel_hi:[1,0]
    v_cvt_pk_bf16_f32 v153, v154, v155
    v_fma_f32 v58, v58, s28, v9
    v_cvt_pk_bf16_f32 v108, v108, v109
    v_exp_f32_e64 v63, v63 clamp
    v_exp_f32_e64 v53, v53 clamp
    v_cvt_pk_bf16_f32 v109, v110, v111
    v_accvgpr_read_b32 v111, a83
    v_mfma_f32_16x16x32_bf16 v[236:239], a[220:223], v[26:29], 0
    s_add_u32 m0, s22, 24576
    ds_write_b64 v102, v[108:109] offset:26624
    v_cvt_pk_bf16_f32 v19, v54, v55
    v_cvt_pk_bf16_f32 v104, v104, v105
    v_accvgpr_read_b32 v106, a34
    v_accvgpr_read_b32 v109, a81
    v_mfma_f32_16x16x32_bf16 v[188:191], a[220:223], v[22:25], 0
    ds_write2st64_b64 v93, v[144:145], v[192:193] offset0:8 offset1:20
    v_pk_mul_f32 v[106:107], v[106:107], v[94:95] op_sel_hi:[1,0]
    v_accvgpr_read_b32 v108, a80
    v_cvt_pk_bf16_f32 v200, v200, v201
    v_cvt_pk_bf16_f32 v105, v106, v107
    v_accvgpr_read_b32 v110, a82
    v_mfma_f32_16x16x32_bf16 v[140:143], a[220:223], v[14:17], 0
    ds_write2st64_b64 v93, v[240:241], v[104:105] offset0:32 offset1:44
    v_pk_mul_f32 v[108:109], v[108:109], v[100:101] op_sel_hi:[1,0]
    v_fma_f32 v59, v59, s28, v9
    v_cvt_pk_bf16_f32 v201, v202, v203
    v_accvgpr_read_b32 v106, a38
    v_pk_mul_f32 v[110:111], v[110:111], v[100:101] op_sel_hi:[1,0]
    v_accvgpr_read_b32 v105, a37
    v_cvt_pk_bf16_f32 v108, v108, v109
    v_cvt_pk_bf16_f32 v109, v110, v111
    v_accvgpr_read_b32 v107, a39
    v_exp_f32_e64 v59, v59 clamp
    v_accvgpr_read_b32 v104, a36
    v_accvgpr_read_b32 v111, a87
    v_accvgpr_read_b32 v110, a86
    v_mfma_f32_16x16x32_bf16 v[144:147], a[224:227], v[14:17], 0
    buffer_load_dwordx4 v6, s[8:11], s21 offen lds
    ds_write_b64 v93, v[108:109] offset:0
    v_accvgpr_read_b32 v108, a84
    v_mfma_f32_16x16x32_bf16 v[192:195], a[224:227], v[22:25], 0
    s_add_u32 s21, s21, 128
    ds_write2st64_b64 v95, v[148:149], v[196:197] offset0:8 offset1:20
    v_exp_f32_e64 v69, v69 clamp
    v_pk_mul_f32 v[106:107], v[106:107], v[94:95] op_sel_hi:[1,0]
    v_pk_mul_f32 v[104:105], v[104:105], v[94:95] op_sel_hi:[1,0]
    v_exp_f32_e64 v80, v80 clamp
    v_pk_mul_f32 v[110:111], v[110:111], v[100:101] op_sel_hi:[1,0]
    v_accvgpr_read_b32 v109, a85
    v_pk_mul_f32 v[108:109], v[108:109], v[100:101] op_sel_hi:[1,0]
    v_cvt_pk_bf16_f32 v205, v206, v207
    v_cvt_pk_bf16_f32 v104, v104, v105
    v_cvt_pk_bf16_f32 v105, v106, v107
    v_mov_b32 v50, 0
    v_cvt_pk_bf16_f32 v249, v250, v251
    v_mfma_f32_16x16x32_bf16 v[240:243], a[224:227], v[26:29], 0
    ds_read_b128 a[216:219], v0 offset:0
    v_exp_f32_e64 v70, v70 clamp
    v_mfma_f32_16x16x32_bf16 a[32:35], a[224:227], v[34:37], 0
    ds_read_b128 a[224:227], v0 offset:1024
    v_cvt_pk_bf16_f32 v108, v108, v109
    v_accvgpr_read_b32 v107, a43
    v_mfma_f32_16x16x32_bf16 a[36:39], a[228:231], v[34:37], 0
    s_add_u32 m0, s22, 25600
    ds_write2st64_b64 v95, v[244:245], v[104:105] offset0:32 offset1:44
    v_mfma_f32_16x16x32_bf16 v[244:247], a[228:231], v[26:29], 0
    ds_read_b128 v[88:91], v103 offset:2048
    buffer_load_dwordx4 v6, s[8:11], s21 offen lds
    v_cvt_pk_bf16_f32 v109, v110, v111
    v_accvgpr_read_b32 v104, a40
    v_accvgpr_read_b32 v111, a91
    v_mfma_f32_16x16x32_bf16 v[196:199], a[228:231], v[22:25], 0
    buffer_store_dwordx4 v[84:87], v7, s[16:19], s67 offen offset:0 nt
    ds_write_b64 v95, v[108:109] offset:0
    v_cvt_pk_bf16_f32 v18, v52, v53
    v_accvgpr_read_b32 v106, a42
    v_accvgpr_read_b32 v108, a88
    v_accvgpr_read_b32 v110, a90
    v_pk_mul_f32 v[110:111], v[110:111], v[100:101] op_sel_hi:[1,0]
    v_accvgpr_read_b32 v105, a41
    v_pk_mul_f32 v[104:105], v[104:105], v[94:95] op_sel_hi:[1,0]
    v_pk_mul_f32 v[106:107], v[106:107], v[94:95] op_sel_hi:[1,0]
    v_cvt_pk_bf16_f32 v104, v104, v105
    v_accvgpr_read_b32 v109, a89
    v_mfma_f32_16x16x32_bf16 v[148:151], a[228:231], v[14:17], 0
    s_add_u32 s21, s21, 128
    ds_write2st64_b64 v8, v[152:153], v[200:201] offset0:8 offset1:20
    v_pk_mul_f32 v[108:109], v[108:109], v[100:101] op_sel_hi:[1,0]
    v_cvt_pk_bf16_f32 v105, v106, v107
    v_accvgpr_read_b32 v106, a46
    v_cvt_pk_bf16_f32 v30, v68, v69
    v_mfma_f32_16x16x32_bf16 v[152:155], a[232:235], v[14:17], 0
    ds_read_b128 a[220:223], v1 offset:0
    v_accvgpr_read_b32 v107, a47
    v_mfma_f32_16x16x32_bf16 v[200:203], a[232:235], v[22:25], 0
    s_add_u32 m0, s22, 26624
    ds_write2st64_b64 v8, v[248:249], v[104:105] offset0:32 offset1:44
    v_accvgpr_read_b32 v104, a44
    v_cvt_pk_bf16_f32 v108, v108, v109
    v_accvgpr_read_b32 v105, a45
    v_pk_mul_f32 v[104:105], v[104:105], v[94:95] op_sel_hi:[1,0]
    v_pk_mul_f32 v[106:107], v[106:107], v[94:95] op_sel_hi:[1,0]
    v_cvt_pk_bf16_f32 v109, v110, v111
    v_cvt_pk_bf16_f32 v104, v104, v105
    v_mfma_f32_16x16x32_bf16 v[248:251], a[232:235], v[26:29], 0
    ds_write_b64 v8, v[108:109] offset:0
    v_cvt_pk_bf16_f32 v105, v106, v107
    v_mfma_f32_16x16x32_bf16 a[40:43], a[232:235], v[34:37], 0
    buffer_load_dwordx4 v6, s[8:11], s21 offen lds
    ds_write2st64_b64 v102, v[156:157], v[204:205] offset0:8 offset1:20
    v_mfma_f32_16x16x32_bf16 a[44:47], a[236:239], v[34:37], 0
    s_add_u32 s21, s21, 12032
    ds_write2st64_b64 v102, v[252:253], v[104:105] offset0:32 offset1:44
    v_mfma_f32_16x16x32_bf16 v[252:255], a[236:239], v[26:29], 0
    v_exp_f32_e64 v65, v65 clamp
    v_mfma_f32_16x16x32_bf16 v[204:207], a[236:239], v[22:25], 0
    v_accvgpr_read_b32 v110, a94
    v_cvt_pk_bf16_f32 v22, v60, v61
    v_exp_f32_e64 v58, v58 clamp
    v_cvt_pk_bf16_f32 v35, v78, v79
    v_accvgpr_read_b32 v111, a95
    v_mfma_f32_16x16x32_bf16 v[156:159], a[236:239], v[14:17], 0
    s_waitcnt lgkmcnt(3)
    ds_read_b128 a[232:235], v0 offset:2048
    v_cvt_pk_bf16_f32 v31, v70, v71
    v_mfma_f32_16x16x32_bf16 v[52:55], a[216:219], a[96:99], 0
    ds_read_b128 a[236:239], v1 offset:2048
    v_accvgpr_read_b32 v108, a92
    v_mfma_f32_16x16x32_bf16 v[52:55], a[220:223], a[100:103], v[52:55]
    v_exp_f32_e64 v67, v67 clamp
    v_mfma_f32_16x16x32_bf16 v[52:55], a[224:227], a[104:107], v[52:55]
    s_add_u32 s56, s67, 128
    ds_read_b128 v[96:99], v103 offset:3072
    v_cvt_pk_bf16_f32 v23, v62, v63
    v_mfma_f32_16x16x32_bf16 v[60:63], a[224:227], a[128:131], 0
    s_add_u32 s58, s33, 128
    ds_read_b128 a[228:231], v1 offset:1024
    v_cvt_pk_bf16_f32 v34, v76, v77
    v_mfma_f32_16x16x32_bf16 v[60:63], a[220:223], a[124:127], v[60:63]
    s_add_u32 m0, s38, 2048
    ds_read_b128 v[84:87], v103 offset:4096
    v_cvt_pk_bf16_f32 v17, v58, v59
    v_exp_f32_e64 v66, v66 clamp
    v_mfma_f32_16x16x32_bf16 v[60:63], a[216:219], a[120:123], v[60:63]
    v_exp_f32_e64 v56, v56 clamp
    v_mfma_f32_16x16x32_bf16 v[68:71], a[216:219], a[144:147], 0
    v_exp_f32_e64 v81, v81 clamp
    v_mfma_f32_16x16x32_bf16 v[68:71], a[220:223], a[148:151], v[68:71]
    buffer_load_dwordx4 v6, s[12:15], s58 offen nt lds
    v_mfma_f32_16x16x32_bf16 v[68:71], a[224:227], a[152:155], v[68:71]
    buffer_store_dwordx4 v[88:91], v6, s[16:19], s56 offen offset:0 nt
    v_accvgpr_read_b32 v109, a93
    v_pk_mul_f32 v[110:111], v[110:111], v[100:101] op_sel_hi:[1,0]
    v_pk_mul_f32 v[108:109], v[108:109], v[100:101] op_sel_hi:[1,0]
    v_exp_f32_e64 v64, v64 clamp
    v_cvt_pk_bf16_f32 v108, v108, v109
    v_mfma_f32_16x16x32_bf16 v[76:79], a[224:227], a[176:179], 0
    v_exp_f32_e64 v74, v74 clamp
    v_cvt_pk_bf16_f32 v109, v110, v111
    v_mfma_f32_16x16x32_bf16 v[76:79], a[220:223], a[172:175], v[76:79]
    s_add_u32 m0, s38, 3072
    v_exp_f32_e64 v57, v57 clamp
    v_mfma_f32_16x16x32_bf16 v[76:79], a[216:219], a[168:171], v[76:79]
    s_waitcnt lgkmcnt(0)
    v_exp_f32_e64 v75, v75 clamp
    v_mfma_f32_16x16x32_bf16 v[76:79], a[228:231], a[180:183], v[76:79]
    ds_read_b128 v[88:91], v103 offset:5120
    v_cvt_pk_bf16_f32 v20, v64, v65
    v_mfma_f32_16x16x32_bf16 v[76:79], a[232:235], a[184:187], v[76:79]
    ds_write_b64 v102, v[108:109] offset:0
    v_mfma_f32_16x16x32_bf16 v[76:79], a[236:239], a[188:191], v[76:79]
    ds_read_b128 a[220:223], v1 offset:6144
    v_mov_b32 v48, 0
    v_mfma_f32_16x16x32_bf16 v[68:71], a[236:239], a[164:167], v[68:71]
    buffer_load_dwordx4 v7, s[12:15], s58 offen nt lds
    v_mfma_f32_16x16x32_bf16 v[68:71], a[232:235], a[160:163], v[68:71]
    v_cvt_pk_bf16_f32 v28, v72, v73
    v_cvt_pk_bf16_f32 v21, v66, v67
    v_mfma_f32_16x16x32_bf16 v[68:71], a[228:231], a[156:159], v[68:71]
    s_add_u32 s57, s67, 256
    ds_read_b128 a[216:219], v0 offset:6144
    v_cvt_pk_bf16_f32 v16, v56, v57
    v_mfma_f32_16x16x32_bf16 v[60:63], a[228:231], a[132:135], v[60:63]
    buffer_store_dwordx4 v[96:99], v7, s[16:19], s56 offen offset:0 nt
    s_add_u32 s59, s33, 256
    ds_read_b128 a[224:227], v0 offset:7168
    v_exp_f32_e64 v83, v83 clamp
    v_smfmac_f32_16x16x64_bf16 v[48:51], a[240:243], v[16:23], v101
    s_add_u32 m0, s38, 4096
    ds_read_b128 v[96:99], v103 offset:0
    v_mfma_f32_16x16x32_bf16 v[60:63], a[232:235], a[136:139], v[60:63]
    buffer_load_dwordx4 v6, s[12:15], s59 offen nt lds
    v_mfma_f32_16x16x32_bf16 v[60:63], a[236:239], a[140:143], v[60:63]
    buffer_store_dwordx4 v[84:87], v6, s[16:19], s57 offen offset:0 nt
    s_add_u32 m0, s38, 5120
    v_exp_f32_e64 v82, v82 clamp
    v_cvt_pk_bf16_f32 v29, v74, v75
    v_mfma_f32_16x16x32_bf16 v[52:55], a[236:239], a[116:119], v[52:55]
    v_cvt_pk_bf16_f32 v33, v82, v83
    v_cvt_pk_bf16_f32 v32, v80, v81
    v_mfma_f32_16x16x32_bf16 v[52:55], a[232:235], a[112:115], v[52:55]
    s_waitcnt lgkmcnt(3)
    ds_read_b128 a[236:239], v1 offset:8192
    buffer_load_dwordx4 v7, s[12:15], s59 offen nt lds
    v_mfma_f32_16x16x32_bf16 v[52:55], a[228:231], a[108:111], v[52:55]
    s_add_u32 s56, s67, 24832
    ds_read_b128 v[84:87], v103 offset:1024
    v_smfmac_f32_16x16x64_bf16 v[48:51], a[244:247], v[28:35], v101
    s_waitcnt lgkmcnt(4)
    ds_read_b128 a[232:235], v0 offset:8192
    v_mfma_f32_16x16x32_bf16 v[56:59], a[216:219], a[96:99], 0
    s_add_u32 m0, s38, 0
    ds_read_b128 a[228:231], v1 offset:7168
    v_add_u32 v103, 6144, v103
    v_mfma_f32_16x16x32_bf16 v[56:59], a[220:223], a[100:103], v[56:59]
    s_nop 0
    v_cmp_lt_f32 vcc, s29, v48
    s_waitcnt lgkmcnt(4)
    v_mfma_f32_16x16x32_bf16 v[56:59], a[224:227], a[104:107], v[56:59]
    buffer_load_dwordx4 v6, s[12:15], s33 offen nt lds
    v_mfma_f32_16x16x32_bf16 v[64:67], a[224:227], a[128:131], 0
    s_add_u32 m0, s38, 1024
    s_cbranch_vccnz L_rs_tr54d
L_ret_tr54d:
    v_mfma_f32_16x16x32_bf16 v[64:67], a[220:223], a[124:127], v[64:67]
    v_fma_f32 v60, v60, s28, v10
    v_fma_f32 v54, v54, s28, v9
    v_mfma_f32_16x16x32_bf16 v[64:67], a[216:219], a[120:123], v[64:67]
    buffer_store_dwordx4 v[88:91], v7, s[16:19], s57 offen offset:0 nt
    v_fma_f32 v53, v53, s28, v9
    v_exp_f32_e64 v60, v60 clamp
    v_mfma_f32_16x16x32_bf16 v[72:75], a[216:219], a[144:147], 0
    v_exp_f32_e64 v53, v53 clamp
    v_mfma_f32_16x16x32_bf16 v[72:75], a[220:223], a[148:151], v[72:75]
    v_fma_f32 v52, v52, s28, v9
    v_fma_f32 v61, v61, s28, v10
    v_mfma_f32_16x16x32_bf16 v[72:75], a[224:227], a[152:155], v[72:75]
    s_waitcnt lgkmcnt(1)
    buffer_load_dwordx4 v7, s[12:15], s33 offen nt lds
    v_mfma_f32_16x16x32_bf16 v[80:83], a[224:227], a[176:179], 0
    s_waitcnt vmcnt(18) lgkmcnt(0)
    v_exp_f32_e64 v61, v61 clamp
    v_mfma_f32_16x16x32_bf16 v[80:83], a[220:223], a[172:175], v[80:83]
    s_barrier
    v_mfma_f32_16x16x32_bf16 v[80:83], a[216:219], a[168:171], v[80:83]
    v_exp_f32_e64 v52, v52 clamp
    v_mfma_f32_16x16x32_bf16 v[80:83], a[228:231], a[180:183], v[80:83]
    ds_read_b64_tr_b16 a[216:217], v2 offset:18432
    v_mfma_f32_16x16x32_bf16 v[80:83], a[232:235], a[184:187], v[80:83]
    s_add_u32 m0, s22, 0
    ds_read_b64_tr_b16 a[218:219], v2 offset:12288
    v_mfma_f32_16x16x32_bf16 v[80:83], a[236:239], a[188:191], v[80:83]
    v_exp_f32_e64 v54, v54 clamp
    v_mfma_f32_16x16x32_bf16 v[72:75], a[236:239], a[164:167], v[72:75]
    buffer_load_dwordx4 v6, s[4:7], s20 offen lds
    v_mfma_f32_16x16x32_bf16 v[72:75], a[232:235], a[160:163], v[72:75]
    ds_read_b64_tr_b16 a[220:221], v3 offset:18432
    v_cvt_pk_bf16_f32 v14, v52, v53
    v_mfma_f32_16x16x32_bf16 v[72:75], a[228:231], a[156:159], v[72:75]
    s_add_u32 s20, s20, 128
    s_add_u32 m0, s22, 1024
    ds_read_b64_tr_b16 a[222:223], v3 offset:12288
    v_mfma_f32_16x16x32_bf16 v[64:67], a[228:231], a[132:135], v[64:67]
    buffer_load_dwordx4 v6, s[4:7], s20 offen lds
    v_mfma_f32_16x16x32_bf16 v[64:67], a[232:235], a[136:139], v[64:67]
    s_add_u32 s20, s20, 128
    ds_read_b64_tr_b16 a[224:225], v4 offset:18432
    v_fma_f32 v55, v55, s28, v9
    v_mfma_f32_16x16x32_bf16 v[64:67], a[236:239], a[140:143], v[64:67]
    buffer_store_dwordx4 v[96:99], v6, s[16:19], s56 offen offset:0 nt
    ds_read_b64_tr_b16 a[226:227], v4 offset:12288
    v_exp_f32_e64 v55, v55 clamp
    v_mfma_f32_16x16x32_bf16 v[56:59], a[236:239], a[116:119], v[56:59]
    s_add_u32 m0, s22, 2048
    v_cvt_pk_bf16_f32 v15, v54, v55
    s_waitcnt lgkmcnt(4)
    v_mfma_f32_16x16x32_bf16 v[56:59], a[232:235], a[112:115], v[56:59]
    buffer_load_dwordx4 v6, s[4:7], s20 offen lds
    v_mfma_f32_16x16x32_bf16 v[56:59], a[228:231], a[108:111], v[56:59]
    s_add_u32 s20, s20, 12032
    ds_read_b64_tr_b16 a[228:229], v5 offset:18432
    ds_read_b64_tr_b16 a[230:231], v5 offset:12288
    buffer_store_dwordx4 v[84:87], v7, s[16:19], s56 offen offset:0 nt
    s_branch L_loop4w0
L_tr55:
    v_mfma_f32_16x16x32_bf16 v[112:115], a[216:219], v[16:19], v[112:115]
    v_fma_f32 v64, v64, s28, v10
    v_fma_f32 v65, v65, s28, v10
    v_mfma_f32_16x16x32_bf16 v[116:119], a[220:223], v[16:19], v[116:119]
    s_add_u32 s39, s39, 12288
    v_mbcnt_lo_u32_b32 v97, -1, 0
    v_fma_f32 v68, v68, s28, v11
    v_mfma_f32_16x16x32_bf16 v[164:167], a[220:223], v[20:23], v[164:167]
    ds_read_b64_tr_b16 a[236:237], v3 offset:19456
    v_fma_f32 v56, v56, s28, v9
    v_mfma_f32_16x16x32_bf16 v[160:163], a[216:219], v[20:23], v[160:163]
    v_fma_f32 v81, v81, s28, v12
    v_mfma_f32_16x16x32_bf16 v[208:211], a[216:219], v[28:31], v[208:211]
    ds_read_b64_tr_b16 a[238:239], v3 offset:13312
    v_mbcnt_hi_u32_b32 v97, -1, v97
    v_mfma_f32_16x16x32_bf16 v[212:215], a[220:223], v[28:31], v[212:215]
    v_fma_f32 v85, v85, s28, v13
    v_fma_f32 v90, v90, s28, v13
    v_mfma_f32_16x16x32_bf16 a[4:7], a[220:223], v[32:35], a[4:7]
    v_and_b32 v96, 15, v97
    v_lshrrev_b32 v97, 4, v97
    v_mfma_f32_16x16x32_bf16 a[0:3], a[216:219], v[32:35], a[0:3]
    ds_read_b64_tr_b16 a[232:233], v2 offset:19456
    v_mul_u32_u24 v96, 384, v96
    v_mfma_f32_16x16x32_bf16 a[48:51], a[216:219], v[40:43], a[48:51]
    s_add_u32 s48, s33, 24576
    ds_read_b64_tr_b16 a[234:235], v2 offset:13312
    v_lshl_add_u32 v96, v97, 4, v96
    v_mfma_f32_16x16x32_bf16 a[52:55], a[220:223], v[40:43], a[52:55]
    s_waitcnt lgkmcnt(4)
    v_fma_f32 v83, v83, s28, v12
    v_fma_f32 v73, v73, s28, v11
    v_mfma_f32_16x16x32_bf16 a[56:59], a[224:227], v[40:43], a[56:59]
    buffer_load_dword v97, v96, s[12:15], s48 offen offset:256
    v_mfma_f32_16x16x32_bf16 a[60:63], a[228:231], v[40:43], a[60:63]
    v_exp_f32_e64 v68, v68 clamp
    v_mfma_f32_16x16x32_bf16 a[12:15], a[228:231], v[32:35], a[12:15]
    v_fma_f32 v66, v66, s28, v10
    v_fma_f32 v84, v84, s28, v13
    v_mfma_f32_16x16x32_bf16 a[8:11], a[224:227], v[32:35], a[8:11]
    v_fma_f32 v87, v87, s28, v13
    v_fma_f32 v79, v79, s28, v12
    v_mfma_f32_16x16x32_bf16 v[216:219], a[224:227], v[28:31], v[216:219]
    ds_read_b64_tr_b16 a[218:219], v4 offset:13312
    v_fma_f32 v59, v59, s28, v9
    v_mfma_f32_16x16x32_bf16 v[220:223], a[228:231], v[28:31], v[220:223]
    ds_read_b64_tr_b16 a[216:217], v4 offset:19456
    v_fma_f32 v57, v57, s28, v9
    v_mfma_f32_16x16x32_bf16 v[172:175], a[228:231], v[20:23], v[172:175]
    ds_read_b64_tr_b16 a[220:221], v5 offset:19456
    v_fma_f32 v71, v71, s28, v11
    v_mfma_f32_16x16x32_bf16 v[168:171], a[224:227], v[20:23], v[168:171]
    v_exp_f32_e64 v90, v90 clamp
    v_mfma_f32_16x16x32_bf16 v[120:123], a[224:227], v[16:19], v[120:123]
    ds_read_b64_tr_b16 a[222:223], v5 offset:13312
    v_fma_f32 v91, v91, s28, v13
    v_mfma_f32_16x16x32_bf16 v[124:127], a[228:231], v[16:19], v[124:127]
    s_waitcnt lgkmcnt(4)
    ds_read_b64_tr_b16 a[230:231], v3 offset:14336
    v_fma_f32 v78, v78, s28, v12
    v_mfma_f32_16x16x32_bf16 v[128:131], a[232:235], v[16:19], v[128:131]
    v_exp_f32_e64 v83, v83 clamp
    v_mfma_f32_16x16x32_bf16 v[132:135], a[236:239], v[16:19], v[132:135]
    ds_read_b64_tr_b16 a[228:229], v3 offset:20480
    v_fma_f32 v86, v86, s28, v13
    v_mfma_f32_16x16x32_bf16 v[180:183], a[236:239], v[20:23], v[180:183]
    ds_read_b64_tr_b16 a[224:225], v2 offset:20480
    v_mfma_f32_16x16x32_bf16 v[176:179], a[232:235], v[20:23], v[176:179]
    v_exp_f32_e64 v87, v87 clamp
    v_mfma_f32_16x16x32_bf16 v[224:227], a[232:235], v[28:31], v[224:227]
    v_exp_f32_e64 v73, v73 clamp
    v_mfma_f32_16x16x32_bf16 v[228:231], a[236:239], v[28:31], v[228:231]
    v_fma_f32 v74, v74, s28, v11
    v_mfma_f32_16x16x32_bf16 a[20:23], a[236:239], v[32:35], a[20:23]
    v_fma_f32 v88, v88, s28, v13
    v_fma_f32 v89, v89, s28, v13
    v_mfma_f32_16x16x32_bf16 a[16:19], a[232:235], v[32:35], a[16:19]
    ds_read_b64_tr_b16 a[226:227], v2 offset:14336
    v_fma_f32 v77, v77, s28, v12
    v_mfma_f32_16x16x32_bf16 a[64:67], a[232:235], v[40:43], a[64:67]
    v_exp_f32_e64 v86, v86 clamp
    v_mfma_f32_16x16x32_bf16 a[68:71], a[236:239], v[40:43], a[68:71]
    s_waitcnt lgkmcnt(3)
    v_exp_f32_e64 v71, v71 clamp
    v_mfma_f32_16x16x32_bf16 a[72:75], a[216:219], v[40:43], a[72:75]
    ds_read_b64_tr_b16 a[232:233], v4 offset:20480
    v_mfma_f32_16x16x32_bf16 a[76:79], a[220:223], v[40:43], a[76:79]
    v_exp_f32_e64 v64, v64 clamp
    v_mfma_f32_16x16x32_bf16 a[28:31], a[220:223], v[32:35], a[28:31]
    v_exp_f32_e64 v79, v79 clamp
    v_mfma_f32_16x16x32_bf16 a[24:27], a[216:219], v[32:35], a[24:27]
    ds_read_b64_tr_b16 a[238:239], v5 offset:14336
    v_fma_f32 v76, v76, s28, v12
    v_mfma_f32_16x16x32_bf16 v[232:235], a[216:219], v[28:31], v[232:235]
    v_exp_f32_e64 v77, v77 clamp
    v_mfma_f32_16x16x32_bf16 v[236:239], a[220:223], v[28:31], v[236:239]
    v_exp_f32_e64 v89, v89 clamp
    v_mfma_f32_16x16x32_bf16 v[188:191], a[220:223], v[20:23], v[188:191]
    ds_read_b64_tr_b16 a[236:237], v5 offset:20480
    v_mfma_f32_16x16x32_bf16 v[184:187], a[216:219], v[20:23], v[184:187]
    ds_read_b64_tr_b16 a[234:235], v4 offset:14336
    v_fma_f32 v70, v70, s28, v11
    v_mfma_f32_16x16x32_bf16 v[136:139], a[216:219], v[16:19], v[136:139]
    v_fma_f32 v67, v67, s28, v10
    v_fma_f32 v69, v69, s28, v11
    v_mfma_f32_16x16x32_bf16 v[140:143], a[220:223], v[16:19], v[140:143]
    s_waitcnt lgkmcnt(4)
    v_exp_f32_e64 v69, v69 clamp
    v_mfma_f32_16x16x32_bf16 v[144:147], a[224:227], v[16:19], v[144:147]
    v_exp_f32_e64 v56, v56 clamp
    v_mfma_f32_16x16x32_bf16 v[148:151], a[228:231], v[16:19], v[148:151]
    v_exp_f32_e64 v70, v70 clamp
    v_mfma_f32_16x16x32_bf16 v[196:199], a[228:231], v[20:23], v[196:199]
    v_exp_f32_e64 v74, v74 clamp
    v_mfma_f32_16x16x32_bf16 v[192:195], a[224:227], v[20:23], v[192:195]
    v_exp_f32_e64 v85, v85 clamp
    v_mfma_f32_16x16x32_bf16 v[240:243], a[224:227], v[28:31], v[240:243]
    v_exp_f32_e64 v91, v91 clamp
    v_mfma_f32_16x16x32_bf16 v[244:247], a[228:231], v[28:31], v[244:247]
    v_exp_f32_e64 v78, v78 clamp
    v_mfma_f32_16x16x32_bf16 a[36:39], a[228:231], v[32:35], a[36:39]
    v_cvt_pk_bf16_f32 v39, v86, v87
    v_fma_f32 v80, v80, s28, v12
    v_mfma_f32_16x16x32_bf16 a[32:35], a[224:227], v[32:35], a[32:35]
    v_fma_f32 v75, v75, s28, v11
    v_fma_f32 v72, v72, s28, v11
    v_mfma_f32_16x16x32_bf16 a[80:83], a[224:227], v[40:43], a[80:83]
    s_waitcnt vmcnt(11) lgkmcnt(0)
    v_exp_f32_e64 v84, v84 clamp
    v_mfma_f32_16x16x32_bf16 a[84:87], a[228:231], v[40:43], a[84:87]
    s_barrier
    v_mfma_f32_16x16x32_bf16 a[88:91], a[232:235], v[40:43], a[88:91]
    s_add_u32 m0, s22, 36864
    ds_read_b128 a[216:219], v0 offset:12288
    v_mfma_f32_16x16x32_bf16 a[92:95], a[236:239], v[40:43], a[92:95]
    v_exp_f32_e64 v76, v76 clamp
    v_mfma_f32_16x16x32_bf16 a[44:47], a[236:239], v[32:35], a[44:47]
    buffer_load_dwordx4 v6, s[8:11], s21 offen lds
    v_mfma_f32_16x16x32_bf16 a[40:43], a[232:235], v[32:35], a[40:43]
    v_cvt_pk_bf16_f32 v27, v70, v71
    v_cvt_pk_bf16_f32 v38, v84, v85
    v_mfma_f32_16x16x32_bf16 v[248:251], a[232:235], v[28:31], v[248:251]
    s_add_u32 s21, s21, 128
    ds_read_b128 a[220:223], v1 offset:12288
    v_cvt_pk_bf16_f32 v34, v76, v77
    v_mfma_f32_16x16x32_bf16 v[252:255], a[236:239], v[28:31], v[252:255]
    s_add_u32 m0, s22, 37888
    v_fma_f32 v82, v82, s28, v12
    v_mfma_f32_16x16x32_bf16 v[204:207], a[236:239], v[20:23], v[204:207]
    buffer_load_dwordx4 v6, s[8:11], s21 offen lds
    v_mfma_f32_16x16x32_bf16 v[200:203], a[232:235], v[20:23], v[200:203]
    s_add_u32 s21, s21, 128
    v_exp_f32_e64 v75, v75 clamp
    v_mfma_f32_16x16x32_bf16 v[152:155], a[232:235], v[16:19], v[152:155]
    ds_read_b128 a[228:231], v1 offset:13312
    v_cvt_pk_bf16_f32 v26, v68, v69
    v_mfma_f32_16x16x32_bf16 v[156:159], a[236:239], v[16:19], v[156:159]
    s_add_u32 m0, s22, 38912
    ds_read_b128 a[224:227], v0 offset:13312
    s_waitcnt lgkmcnt(3)
    v_mfma_f32_16x16x32_bf16 v[52:55], a[216:219], a[96:99], 0
    v_cvt_pk_bf16_f32 v22, v60, v61
    v_cvt_pk_bf16_f32 v23, v62, v63
    v_mfma_f32_16x16x32_bf16 v[60:63], a[216:219], a[120:123], 0
    buffer_load_dwordx4 v6, s[8:11], s21 offen lds
    v_mfma_f32_16x16x32_bf16 v[68:71], a[216:219], a[144:147], 0
    v_cvt_pk_bf16_f32 v35, v78, v79
    v_mfma_f32_16x16x32_bf16 v[76:79], a[216:219], a[168:171], 0
    v_exp_f32_e64 v88, v88 clamp
    v_mfma_f32_16x16x32_bf16 v[84:87], a[216:219], a[192:195], 0
    s_waitcnt lgkmcnt(2)
    v_exp_f32_e64 v82, v82 clamp
    v_mfma_f32_16x16x32_bf16 v[52:55], a[220:223], a[100:103], v[52:55]
    v_fma_f32 v58, v58, s28, v9
    v_mfma_f32_16x16x32_bf16 v[60:63], a[220:223], a[124:127], v[60:63]
    ds_read_b128 a[232:235], v0 offset:14336
    v_cvt_pk_bf16_f32 v41, v90, v91
    v_mfma_f32_16x16x32_bf16 v[68:71], a[220:223], a[148:151], v[68:71]
    ds_read_b128 a[236:239], v1 offset:14336
    v_cvt_pk_bf16_f32 v29, v74, v75
    v_mfma_f32_16x16x32_bf16 v[76:79], a[220:223], a[172:175], v[76:79]
    v_exp_f32_e64 v66, v66 clamp
    v_mfma_f32_16x16x32_bf16 v[84:87], a[220:223], a[196:199], v[84:87]
    s_waitcnt lgkmcnt(2)
    v_exp_f32_e64 v58, v58 clamp
    v_mfma_f32_16x16x32_bf16 v[52:55], a[224:227], a[104:107], v[52:55]
    v_exp_f32_e64 v67, v67 clamp
    v_mfma_f32_16x16x32_bf16 v[60:63], a[224:227], a[128:131], v[60:63]
    v_exp_f32_e64 v59, v59 clamp
    v_mfma_f32_16x16x32_bf16 v[68:71], a[224:227], a[152:155], v[68:71]
    v_exp_f32_e64 v81, v81 clamp
    v_mfma_f32_16x16x32_bf16 v[76:79], a[224:227], a[176:179], v[76:79]
    v_exp_f32_e64 v57, v57 clamp
    v_mfma_f32_16x16x32_bf16 v[84:87], a[224:227], a[200:203], v[84:87]
    v_cvt_pk_bf16_f32 v37, v82, v83
    v_cvt_pk_bf16_f32 v16, v56, v57
    v_mfma_f32_16x16x32_bf16 v[52:55], a[228:231], a[108:111], v[52:55]
    v_cvt_pk_bf16_f32 v25, v66, v67
    v_mfma_f32_16x16x32_bf16 v[60:63], a[228:231], a[132:135], v[60:63]
    ds_read_b128 a[220:223], v1 offset:20480
    v_cvt_pk_bf16_f32 v17, v58, v59
    v_mfma_f32_16x16x32_bf16 v[68:71], a[228:231], a[156:159], v[68:71]
    s_add_u32 s21, s21, 12032
    v_exp_f32_e64 v65, v65 clamp
    v_mfma_f32_16x16x32_bf16 v[76:79], a[228:231], a[180:183], v[76:79]
    v_exp_f32_e64 v72, v72 clamp
    v_mfma_f32_16x16x32_bf16 v[84:87], a[228:231], a[204:207], v[84:87]
    s_waitcnt lgkmcnt(1)
    v_cvt_pk_bf16_f32 v28, v72, v73
    v_mfma_f32_16x16x32_bf16 v[52:55], a[232:235], a[112:115], v[52:55]
    v_mfma_f32_16x16x32_bf16 v[60:63], a[232:235], a[136:139], v[60:63]
    v_cvt_pk_bf16_f32 v40, v88, v89
    v_cvt_pk_bf16_f32 v24, v64, v65
    v_mfma_f32_16x16x32_bf16 v[68:71], a[232:235], a[160:163], v[68:71]
    ds_read_b128 a[216:219], v0 offset:20480
    v_mfma_f32_16x16x32_bf16 v[44:47], a[248:251], v[14:17], v[44:47]
    v_exp_f32_e64 v80, v80 clamp
    v_mfma_f32_16x16x32_bf16 v[76:79], a[232:235], a[184:187], v[76:79]
    v_cvt_pk_bf16_f32 v36, v80, v81
    v_smfmac_f32_16x16x64_bf16 v[44:47], a[240:243], v[22:29], v101
    v_mfma_f32_16x16x32_bf16 v[84:87], a[232:235], a[208:211], v[84:87]
    ds_read_b128 a[228:231], v1 offset:18432
    v_smfmac_f32_16x16x64_bf16 v[44:47], a[244:247], v[34:41], v101
    ds_read_b128 a[224:227], v0 offset:18432
    v_mfma_f32_16x16x32_bf16 v[52:55], a[236:239], a[116:119], v[52:55]
    v_mfma_f32_16x16x32_bf16 v[60:63], a[236:239], a[140:143], v[60:63]
    ds_read_b128 a[232:235], v0 offset:19456
    v_mfma_f32_16x16x32_bf16 v[68:71], a[236:239], a[164:167], v[68:71]
    v_mfma_f32_16x16x32_bf16 v[76:79], a[236:239], a[188:191], v[76:79]
    s_nop 1
    v_cmp_lt_f32 vcc, s29, v44
    v_mfma_f32_16x16x32_bf16 v[84:87], a[236:239], a[212:215], v[84:87]
    s_waitcnt lgkmcnt(3)
    ds_read_b128 a[236:239], v1 offset:19456
    v_mfma_f32_16x16x32_bf16 v[56:59], a[216:219], a[112:115], 0
    s_nop 0
    s_cbranch_vccnz L_rs_tr55a
L_ret_tr55a:
    v_mfma_f32_16x16x32_bf16 v[64:67], a[216:219], a[136:139], 0
    v_fma_f32 v52, v52, s28, v9
    v_mfma_f32_16x16x32_bf16 v[72:75], a[216:219], a[160:163], 0
    v_fma_f32 v54, v54, s28, v9
    v_fma_f32 v53, v53, s28, v9
    v_mfma_f32_16x16x32_bf16 v[80:83], a[216:219], a[184:187], 0
    v_mfma_f32_16x16x32_bf16 v[88:91], a[216:219], a[208:211], 0
    v_fma_f32 v61, v61, s28, v10
    v_mfma_f32_16x16x32_bf16 v[56:59], a[220:223], a[116:119], v[56:59]
    v_mfma_f32_16x16x32_bf16 v[64:67], a[220:223], a[140:143], v[64:67]
    v_exp_f32_e64 v61, v61 clamp
    v_mfma_f32_16x16x32_bf16 v[72:75], a[220:223], a[164:167], v[72:75]
    v_exp_f32_e64 v52, v52 clamp
    v_mfma_f32_16x16x32_bf16 v[80:83], a[220:223], a[188:191], v[80:83]
    v_fma_f32 v60, v60, s28, v10
    s_waitcnt vmcnt(7) lgkmcnt(0)
    v_mfma_f32_16x16x32_bf16 v[88:91], a[220:223], a[212:215], v[88:91]
    s_barrier
    v_mfma_f32_16x16x32_bf16 v[56:59], a[224:227], a[96:99], v[56:59]
    v_fma_f32 v62, v62, s28, v10
    v_fma_f32 v63, v63, s28, v10
    v_mfma_f32_16x16x32_bf16 v[64:67], a[224:227], a[120:123], v[64:67]
    s_add_u32 m0, s22, 12288
    ds_read_b64_tr_b16 a[216:217], v2 offset:0
    v_fma_f32 v55, v55, s28, v9
    v_mfma_f32_16x16x32_bf16 v[72:75], a[224:227], a[144:147], v[72:75]
    ds_read_b64_tr_b16 a[218:219], v2 offset:6144
    v_mfma_f32_16x16x32_bf16 v[80:83], a[224:227], a[168:171], v[80:83]
    buffer_load_dwordx4 v6, s[4:7], s20 offen lds
    v_mfma_f32_16x16x32_bf16 v[88:91], a[224:227], a[192:195], v[88:91]
    s_add_u32 s20, s20, 128
    ds_read_b64_tr_b16 a[220:221], v3 offset:0
    s_add_u32 m0, s22, 13312
    v_mfma_f32_16x16x32_bf16 v[56:59], a[228:231], a[100:103], v[56:59]
    buffer_load_dwordx4 v6, s[4:7], s20 offen lds
    v_mfma_f32_16x16x32_bf16 v[64:67], a[228:231], a[124:127], v[64:67]
    ds_read_b64_tr_b16 a[222:223], v3 offset:6144
    s_add_u32 s20, s20, 128
    v_mfma_f32_16x16x32_bf16 v[72:75], a[228:231], a[148:151], v[72:75]
    s_add_u32 m0, s22, 14336
    v_exp_f32_e64 v63, v63 clamp
    v_mfma_f32_16x16x32_bf16 v[80:83], a[228:231], a[172:175], v[80:83]
    v_exp_f32_e64 v55, v55 clamp
    v_mfma_f32_16x16x32_bf16 v[88:91], a[228:231], a[196:199], v[88:91]
    buffer_load_dwordx4 v6, s[4:7], s20 offen lds
    v_mfma_f32_16x16x32_bf16 v[56:59], a[232:235], a[104:107], v[56:59]
    ds_read_b64_tr_b16 a[224:225], v4 offset:0
    v_mfma_f32_16x16x32_bf16 v[64:67], a[232:235], a[128:131], v[64:67]
    v_exp_f32_e64 v54, v54 clamp
    v_mfma_f32_16x16x32_bf16 v[72:75], a[232:235], a[152:155], v[72:75]
    v_exp_f32_e64 v60, v60 clamp
    v_mfma_f32_16x16x32_bf16 v[80:83], a[232:235], a[176:179], v[80:83]
    v_exp_f32_e64 v53, v53 clamp
    v_mfma_f32_16x16x32_bf16 v[88:91], a[232:235], a[200:203], v[88:91]
    ds_read_b64_tr_b16 a[226:227], v4 offset:6144
    v_cvt_pk_bf16_f32 v19, v54, v55
    v_mfma_f32_16x16x32_bf16 v[56:59], a[236:239], a[108:111], v[56:59]
    v_exp_f32_e64 v62, v62 clamp
    v_mfma_f32_16x16x32_bf16 v[64:67], a[236:239], a[132:135], v[64:67]
    ds_read_b64_tr_b16 a[228:229], v5 offset:0
    v_cvt_pk_bf16_f32 v18, v52, v53
    v_mfma_f32_16x16x32_bf16 v[72:75], a[236:239], a[156:159], v[72:75]
    s_waitcnt lgkmcnt(3)
    ds_read_b64_tr_b16 a[230:231], v5 offset:6144
    s_add_u32 s20, s20, 12032
    v_mfma_f32_16x16x32_bf16 v[80:83], a[236:239], a[180:183], v[80:83]
    buffer_load_dwordx4 a[208:211], v96, s[12:15], s48 offen offset:256 nt
    v_mfma_f32_16x16x32_bf16 v[88:91], a[236:239], a[204:207], v[88:91]
    buffer_load_dwordx4 a[212:215], v96, s[12:15], s48 offen offset:320 nt
    v_mfma_f32_16x16x32_bf16 v[112:115], a[216:219], v[14:17], v[112:115]
    v_fma_f32 v77, v77, s28, v12
    v_fma_f32 v71, v71, s28, v11
    v_mfma_f32_16x16x32_bf16 v[116:119], a[220:223], v[14:17], v[116:119]
    v_fma_f32 v86, v86, s28, v13
    v_fma_f32 v87, v87, s28, v13
    v_mfma_f32_16x16x32_bf16 v[164:167], a[220:223], v[22:25], v[164:167]
    ds_read_b64_tr_b16 a[236:237], v3 offset:1024
    v_fma_f32 v57, v57, s28, v9
    v_mfma_f32_16x16x32_bf16 v[160:163], a[216:219], v[22:25], v[160:163]
    v_exp_f32_e64 v86, v86 clamp
    v_mfma_f32_16x16x32_bf16 v[208:211], a[216:219], v[26:29], v[208:211]
    v_fma_f32 v82, v82, s28, v12
    v_exp_f32_e64 v57, v57 clamp
    v_mfma_f32_16x16x32_bf16 v[212:215], a[220:223], v[26:29], v[212:215]
    v_and_b32 v104, 0x3ff, v0
    v_fma_f32 v65, v65, s28, v10
    v_mfma_f32_16x16x32_bf16 a[4:7], a[220:223], v[34:37], a[4:7]
    ds_read_b64_tr_b16 a[238:239], v3 offset:7168
    v_fma_f32 v84, v84, s28, v13
    v_mfma_f32_16x16x32_bf16 a[0:3], a[216:219], v[34:37], a[0:3]
    v_exp_f32_e64 v82, v82 clamp
    v_mfma_f32_16x16x32_bf16 a[48:51], a[216:219], v[38:41], a[48:51]
    ds_read_b64_tr_b16 a[232:233], v2 offset:1024
    v_fma_f32 v67, v67, s28, v10
    v_mfma_f32_16x16x32_bf16 a[52:55], a[220:223], v[38:41], a[52:55]
    s_waitcnt lgkmcnt(3)
    ds_read_b64_tr_b16 a[234:235], v2 offset:7168
    v_fma_f32 v66, v66, s28, v10
    v_fma_f32 v73, v73, s28, v11
    v_mfma_f32_16x16x32_bf16 a[56:59], a[224:227], v[38:41], a[56:59]
    v_fma_f32 v81, v81, s28, v12
    v_fma_f32 v59, v59, s28, v9
    v_mfma_f32_16x16x32_bf16 a[60:63], a[228:231], v[38:41], a[60:63]
    ds_read_b64_tr_b16 a[220:221], v5 offset:1024
    v_lshrrev_b32 v105, 11, v0
    v_fma_f32 v70, v70, s28, v11
    v_mfma_f32_16x16x32_bf16 a[12:15], a[228:231], v[34:37], a[12:15]
    ds_read_b64_tr_b16 a[222:223], v5 offset:7168
    v_xor_b32 v105, s65, v105
    v_mfma_f32_16x16x32_bf16 a[8:11], a[224:227], v[34:37], a[8:11]
    v_lshl_add_u32 v104, v105, 10, v104
    v_add_u32 v104, s38, v104
    v_mfma_f32_16x16x32_bf16 v[216:219], a[224:227], v[26:29], v[216:219]
    ds_read_b64_tr_b16 a[218:219], v4 offset:7168
    v_fma_f32 v91, v91, s28, v13
    v_fma_f32 v68, v68, s28, v11
    v_mfma_f32_16x16x32_bf16 v[220:223], a[228:231], v[26:29], v[220:223]
    ds_read_b64_tr_b16 a[216:217], v4 offset:1024
    v_fma_f32 v72, v72, s28, v11
    v_mfma_f32_16x16x32_bf16 v[172:175], a[228:231], v[22:25], v[172:175]
    ds_read_b128 a[160:163], v104 offset:16384
    v_fma_f32 v75, v75, s28, v11
    v_fma_f32 v74, v74, s28, v11
    v_mfma_f32_16x16x32_bf16 v[168:171], a[224:227], v[22:25], v[168:171]
    v_exp_f32_e64 v67, v67 clamp
    v_mfma_f32_16x16x32_bf16 v[120:123], a[224:227], v[14:17], v[120:123]
    ds_read_b128 a[184:187], v104 offset:22528
    v_exp_f32_e64 v65, v65 clamp
    v_mfma_f32_16x16x32_bf16 v[124:127], a[228:231], v[14:17], v[124:127]
    s_waitcnt lgkmcnt(6)
    ds_read_b64_tr_b16 a[226:227], v2 offset:8192
    v_xor_b32 v105, 64, v104
    v_mfma_f32_16x16x32_bf16 v[128:131], a[232:235], v[14:17], v[128:131]
    ds_read_b128 a[152:155], v104 offset:14336
    v_fma_f32 v88, v88, s28, v13
    v_mfma_f32_16x16x32_bf16 v[132:135], a[236:239], v[14:17], v[132:135]
    ds_read_b64_tr_b16 a[224:225], v2 offset:2048
    v_exp_f32_e64 v77, v77 clamp
    v_mfma_f32_16x16x32_bf16 v[180:183], a[236:239], v[22:25], v[180:183]
    ds_read_b128 a[168:171], v104 offset:18432
    v_exp_f32_e64 v81, v81 clamp
    v_mfma_f32_16x16x32_bf16 v[176:179], a[232:235], v[22:25], v[176:179]
    ds_read_b64_tr_b16 a[230:231], v3 offset:8192
    v_fma_f32 v80, v80, s28, v12
    v_mfma_f32_16x16x32_bf16 v[224:227], a[232:235], v[26:29], v[224:227]
    v_exp_f32_e64 v91, v91 clamp
    v_mfma_f32_16x16x32_bf16 v[228:231], a[236:239], v[26:29], v[228:231]
    v_exp_f32_e64 v66, v66 clamp
    v_mfma_f32_16x16x32_bf16 a[20:23], a[236:239], v[34:37], a[20:23]
    ds_read_b64_tr_b16 a[228:229], v3 offset:2048
    v_fma_f32 v76, v76, s28, v12
    v_mfma_f32_16x16x32_bf16 a[16:19], a[232:235], v[34:37], a[16:19]
    v_exp_f32_e64 v80, v80 clamp
    v_mfma_f32_16x16x32_bf16 a[64:67], a[232:235], v[38:41], a[64:67]
    v_exp_f32_e64 v71, v71 clamp
    v_mfma_f32_16x16x32_bf16 a[68:71], a[236:239], v[38:41], a[68:71]
    s_waitcnt lgkmcnt(5)
    v_exp_f32_e64 v84, v84 clamp
    v_mfma_f32_16x16x32_bf16 a[72:75], a[216:219], v[38:41], a[72:75]
    v_fma_f32 v90, v90, s28, v13
    v_fma_f32 v83, v83, s28, v12
    v_mfma_f32_16x16x32_bf16 a[76:79], a[220:223], v[38:41], a[76:79]
    ds_read_b64_tr_b16 a[238:239], v5 offset:8192
    v_fma_f32 v69, v69, s28, v11
    v_mfma_f32_16x16x32_bf16 a[28:31], a[220:223], v[34:37], a[28:31]
    v_fma_f32 v79, v79, s28, v12
    v_fma_f32 v64, v64, s28, v10
    v_mfma_f32_16x16x32_bf16 a[24:27], a[216:219], v[34:37], a[24:27]
    s_add_u32 s39, s39, 12288
    ds_read_b128 a[200:203], v104 offset:26624
    v_fma_f32 v56, v56, s28, v9
    v_mfma_f32_16x16x32_bf16 v[232:235], a[216:219], v[26:29], v[232:235]
    ds_read_b64_tr_b16 a[232:233], v4 offset:2048
    v_fma_f32 v78, v78, s28, v12
    v_mfma_f32_16x16x32_bf16 v[236:239], a[220:223], v[26:29], v[236:239]
    ds_read_b64_tr_b16 a[234:235], v4 offset:8192
    v_exp_f32_e64 v68, v68 clamp
    v_mfma_f32_16x16x32_bf16 v[188:191], a[220:223], v[22:25], v[188:191]
    ds_read_b64_tr_b16 a[236:237], v5 offset:2048
    v_fma_f32 v85, v85, s28, v13
    v_mfma_f32_16x16x32_bf16 v[184:187], a[216:219], v[22:25], v[184:187]
    v_exp_f32_e64 v87, v87 clamp
    v_mfma_f32_16x16x32_bf16 v[136:139], a[216:219], v[14:17], v[136:139]
    ds_read_b128 a[192:195], v104 offset:24576
    v_cvt_pk_bf16_f32 v32, v80, v81
    v_mfma_f32_16x16x32_bf16 v[140:143], a[220:223], v[14:17], v[140:143]
    s_waitcnt lgkmcnt(6)
    v_exp_f32_e64 v64, v64 clamp
    v_mfma_f32_16x16x32_bf16 v[144:147], a[224:227], v[14:17], v[144:147]
    v_exp_f32_e64 v85, v85 clamp
    v_mfma_f32_16x16x32_bf16 v[148:151], a[228:231], v[14:17], v[148:151]
    ds_read_b128 a[100:103], v105 offset:0
    v_exp_f32_e64 v72, v72 clamp
    v_mfma_f32_16x16x32_bf16 v[196:199], a[228:231], v[22:25], v[196:199]
    v_exp_f32_e64 v76, v76 clamp
    v_mfma_f32_16x16x32_bf16 v[192:195], a[224:227], v[22:25], v[192:195]
    ds_read_b128 a[172:175], v105 offset:18432
    v_exp_f32_e64 v73, v73 clamp
    v_mfma_f32_16x16x32_bf16 v[240:243], a[224:227], v[26:29], v[240:243]
    ds_read_b128 a[148:151], v105 offset:12288
    v_exp_f32_e64 v59, v59 clamp
    v_mfma_f32_16x16x32_bf16 v[244:247], a[228:231], v[26:29], v[244:247]
    ds_read_b128 a[144:147], v104 offset:12288
    v_cvt_pk_bf16_f32 v20, v64, v65
    v_mfma_f32_16x16x32_bf16 a[36:39], a[228:231], v[34:37], a[36:39]
    ds_read_b128 a[96:99], v104 offset:0
    v_exp_f32_e64 v83, v83 clamp
    v_mfma_f32_16x16x32_bf16 a[32:35], a[224:227], v[34:37], a[32:35]
    s_waitcnt vmcnt(9) lgkmcnt(5)
    v_exp_f32_e64 v90, v90 clamp
    v_mfma_f32_16x16x32_bf16 a[80:83], a[224:227], v[38:41], a[80:83]
    s_add_u32 s21, s21, s62
    ds_read_b128 a[156:159], v105 offset:14336
    v_exp_f32_e64 v69, v69 clamp
    v_mfma_f32_16x16x32_bf16 a[84:87], a[228:231], v[38:41], a[84:87]
    s_barrier
    ds_read_b128 a[120:123], v104 offset:6144
    v_mfma_f32_16x16x32_bf16 a[88:91], a[232:235], v[38:41], a[88:91]
    s_add_u32 m0, s22, 24576
    ds_read_b128 a[216:219], v0 offset:0
    v_fma_f32 v58, v58, s28, v9
    v_mfma_f32_16x16x32_bf16 a[92:95], a[236:239], v[38:41], a[92:95]
    buffer_load_dwordx4 v6, s[8:11], s21 offen lds
    v_mfma_f32_16x16x32_bf16 a[44:47], a[236:239], v[34:37], a[44:47]
    s_add_u32 s21, s21, 128
    ds_read_b128 a[220:223], v1 offset:0
    v_cvt_pk_bf16_f32 v42, v84, v85
    v_mfma_f32_16x16x32_bf16 a[40:43], a[232:235], v[34:37], a[40:43]
    s_add_u32 m0, s22, 25600
    ds_read_b128 a[104:107], v104 offset:2048
    buffer_load_dwordx4 v6, s[8:11], s21 offen lds
    v_mfma_f32_16x16x32_bf16 v[248:251], a[232:235], v[26:29], v[248:251]
    s_add_u32 s21, s21, 128
    ds_read_b128 a[196:199], v105 offset:24576
    v_exp_f32_e64 v70, v70 clamp
    v_cvt_pk_bf16_f32 v33, v82, v83
    v_mfma_f32_16x16x32_bf16 v[252:255], a[236:239], v[26:29], v[252:255]
    s_add_u32 m0, s22, 26624
    ds_read_b128 a[124:127], v105 offset:6144
    v_cvt_pk_bf16_f32 v31, v70, v71
    v_mfma_f32_16x16x32_bf16 v[204:207], a[236:239], v[22:25], v[204:207]
    buffer_load_dwordx4 v6, s[8:11], s21 offen lds
    ds_read_b128 a[108:111], v105 offset:2048
    v_mfma_f32_16x16x32_bf16 v[200:203], a[232:235], v[22:25], v[200:203]
    ds_read_b128 a[128:131], v104 offset:8192
    v_exp_f32_e64 v88, v88 clamp
    v_mfma_f32_16x16x32_bf16 v[152:155], a[232:235], v[14:17], v[152:155]
    ds_read_b128 a[164:167], v105 offset:16384
    v_cvt_pk_bf16_f32 v23, v62, v63
    v_exp_f32_e64 v78, v78 clamp
    v_exp_f32_e64 v56, v56 clamp
    v_mfma_f32_16x16x32_bf16 v[156:159], a[236:239], v[14:17], v[156:159]
    s_waitcnt lgkmcnt(7)
    ds_read_b128 a[228:231], v1 offset:1024
    v_cvt_pk_bf16_f32 v28, v72, v73
    v_cvt_pk_bf16_f32 v22, v60, v61
    v_mfma_f32_16x16x32_bf16 v[52:55], a[216:219], a[96:99], 0
    v_fma_f32 v89, v89, s28, v13
    v_cvt_pk_bf16_f32 v30, v68, v69
    v_mfma_f32_16x16x32_bf16 v[60:63], a[216:219], a[120:123], 0
    v_exp_f32_e64 v79, v79 clamp
    v_mfma_f32_16x16x32_bf16 v[68:71], a[216:219], a[144:147], 0
    ds_read_b128 a[224:227], v0 offset:1024
    v_cvt_pk_bf16_f32 v35, v78, v79
    v_cvt_pk_bf16_f32 v34, v76, v77
    v_cvt_pk_bf16_f32 v16, v56, v57
    v_exp_f32_e64 v58, v58 clamp
    v_cvt_pk_bf16_f32 v43, v86, v87
    v_mfma_f32_16x16x32_bf16 v[76:79], a[216:219], a[168:171], 0
    v_exp_f32_e64 v89, v89 clamp
    v_mfma_f32_16x16x32_bf16 v[84:87], a[216:219], a[192:195], 0
    s_waitcnt lgkmcnt(3)
    ds_read_b128 a[176:179], v104 offset:20480
    v_cvt_pk_bf16_f32 v21, v66, v67
    v_cvt_pk_bf16_f32 v41, v90, v91
    v_mfma_f32_16x16x32_bf16 v[52:55], a[220:223], a[100:103], v[52:55]
    v_exp_f32_e64 v74, v74 clamp
    v_mfma_f32_16x16x32_bf16 v[60:63], a[220:223], a[124:127], v[60:63]
    v_exp_f32_e64 v75, v75 clamp
    v_mfma_f32_16x16x32_bf16 v[68:71], a[220:223], a[148:151], v[68:71]
    ds_read_b128 a[132:135], v105 offset:8192
    v_cvt_pk_bf16_f32 v17, v58, v59
    v_mfma_f32_16x16x32_bf16 v[76:79], a[220:223], a[172:175], v[76:79]
    ds_read_b128 a[188:191], v105 offset:22528
    v_cvt_pk_bf16_f32 v29, v74, v75
    v_smfmac_f32_16x16x64_bf16 v[48:51], a[240:243], v[16:23], v101
    s_add_u32 s21, s21, 12032
    ds_read_b128 a[180:183], v105 offset:20480
    v_mfma_f32_16x16x32_bf16 v[84:87], a[220:223], a[196:199], v[84:87]
    ds_read_b128 a[204:207], v105 offset:26624
    v_cvt_pk_bf16_f32 v40, v88, v89
    v_smfmac_f32_16x16x64_bf16 v[48:51], a[244:247], v[28:35], v101
    ds_read_b128 a[112:115], v104 offset:4096
    v_mfma_f32_16x16x32_bf16 v[48:51], a[248:251], v[40:43], v[48:51]
    s_waitcnt lgkmcnt(6)
    ds_read_b128 a[232:235], v0 offset:6144
    v_mfma_f32_16x16x32_bf16 v[52:55], a[224:227], a[104:107], v[52:55]
    ds_read_b128 a[136:139], v104 offset:10240
    v_mfma_f32_16x16x32_bf16 v[60:63], a[224:227], a[128:131], v[60:63]
    ds_read_b128 a[116:119], v105 offset:4096
    v_mfma_f32_16x16x32_bf16 v[68:71], a[224:227], a[152:155], v[68:71]
    s_waitcnt lgkmcnt(8)
    ds_read_b128 a[140:143], v105 offset:10240
    v_cmp_lt_f32 vcc, s29, v48
    v_mfma_f32_16x16x32_bf16 v[76:79], a[224:227], a[176:179], v[76:79]
    ds_read_b128 a[236:239], v1 offset:6144
    v_mfma_f32_16x16x32_bf16 v[84:87], a[224:227], a[200:203], v[84:87]
    ds_read_b128 a[224:227], v0 offset:2048
    v_mfma_f32_16x16x32_bf16 v[52:55], a[228:231], a[108:111], v[52:55]
    s_cbranch_vccnz L_rs_tr55b
L_ret_tr55b:
    s_waitcnt lgkmcnt(9)
    v_mfma_f32_16x16x32_bf16 v[60:63], a[228:231], a[132:135], v[60:63]
    v_mov_b32 v109, v50
    v_lshrrev_b32 v108, 11, v0
    v_mfma_f32_16x16x32_bf16 v[68:71], a[228:231], a[156:159], v[68:71]
    s_waitcnt lgkmcnt(7)
    v_mov_b32 v110, v45
    v_and_b32 v93, 0x3ff, v0
    v_mfma_f32_16x16x32_bf16 v[76:79], a[228:231], a[180:183], v[76:79]
    ds_read_b128 a[216:219], v0 offset:7168
    v_xor_b32 v108, s65, v108
    v_mfma_f32_16x16x32_bf16 v[84:87], a[228:231], a[204:207], v[84:87]
    s_waitcnt lgkmcnt(6)
    v_lshl_add_u32 v93, v108, 10, v93
    v_mbcnt_lo_u32_b32 v108, -1, 0
    v_mfma_f32_16x16x32_bf16 v[56:59], a[232:235], a[96:99], 0
    v_permlane16_swap_b32 v50, v109
    v_mfma_f32_16x16x32_bf16 v[64:67], a[232:235], a[120:123], 0
    v_permlane16_swap_b32 v45, v110
    v_mfma_f32_16x16x32_bf16 v[72:75], a[232:235], a[144:147], 0
    ds_read_b128 a[228:231], v1 offset:2048
    v_mbcnt_hi_u32_b32 v108, -1, v108
    v_mfma_f32_16x16x32_bf16 v[80:83], a[232:235], a[168:171], 0
    v_add_f32 v50, v50, v109
    v_add_u32 v93, s38, v93
    v_mfma_f32_16x16x32_bf16 v[88:91], a[232:235], a[192:195], 0
    s_waitcnt lgkmcnt(2)
    ds_read_b128 a[220:223], v1 offset:7168
    v_add_f32 v45, v45, v110
    v_mfma_f32_16x16x32_bf16 v[56:59], a[236:239], a[100:103], v[56:59]
    ds_read_b128 a[232:235], v0 offset:8192
    v_lshrrev_b32 v108, 1, v108
    v_mfma_f32_16x16x32_bf16 v[64:67], a[236:239], a[124:127], v[64:67]
    v_and_b32 v108, 24, v108
    v_mov_b32 v111, v46
    v_mfma_f32_16x16x32_bf16 v[72:75], a[236:239], a[148:151], v[72:75]
    s_nop 0
    v_permlane16_swap_b32 v46, v111
    v_mfma_f32_16x16x32_bf16 v[80:83], a[236:239], a[172:175], v[80:83]
    v_bfe_u32 v108, s66, v108, 8
    v_add_f32 v46, v46, v111
    v_mfma_f32_16x16x32_bf16 v[88:91], a[236:239], a[196:199], v[88:91]
    s_waitcnt lgkmcnt(3)
    ds_read_b128 a[236:239], v1 offset:8192
    v_mfma_f32_16x16x32_bf16 v[56:59], a[216:219], a[104:107], v[56:59]
    v_xor_b32 v93, v93, v108
    v_mov_b32 v111, v46
    v_mfma_f32_16x16x32_bf16 v[64:67], a[216:219], a[128:131], v[64:67]
    v_mov_b32 v110, v45
    v_mov_b32 v109, v50
    v_mfma_f32_16x16x32_bf16 v[72:75], a[216:219], a[152:155], v[72:75]
    s_nop 0
    v_permlane32_swap_b32 v50, v109
    v_mfma_f32_16x16x32_bf16 v[80:83], a[216:219], a[176:179], v[80:83]
    v_permlane32_swap_b32 v45, v110
    v_mfma_f32_16x16x32_bf16 v[88:91], a[216:219], a[200:203], v[88:91]
    s_waitcnt lgkmcnt(2)
    v_mfma_f32_16x16x32_bf16 v[56:59], a[220:223], a[108:111], v[56:59]
    s_waitcnt vmcnt(3)
    v_permlane32_swap_b32 v46, v111
    v_mov_b32 v108, v49
    v_mfma_f32_16x16x32_bf16 v[64:67], a[220:223], a[132:135], v[64:67]
    s_nop 0
    v_permlane16_swap_b32 v49, v108
    v_mfma_f32_16x16x32_bf16 v[72:75], a[220:223], a[156:159], v[72:75]
    v_add_f32 v49, v49, v108
    v_add_f32 v94, v109, v46
    v_mfma_f32_16x16x32_bf16 v[80:83], a[220:223], a[180:183], v[80:83]
    s_waitcnt vmcnt(8) lgkmcnt(0)
    s_add_u32 m0, s22, 0
    v_mfma_f32_16x16x32_bf16 v[88:91], a[220:223], a[204:207], v[88:91]
    s_barrier
    v_mfma_f32_16x16x32_bf16 v[52:55], a[224:227], a[112:115], v[52:55]
    buffer_load_dwordx4 v6, s[4:7], s20 offen lds
    v_mfma_f32_16x16x32_bf16 v[60:63], a[224:227], a[136:139], v[60:63]
    s_add_u32 s20, s20, 128
    s_add_u32 m0, s22, 1024
    ds_read_b64_tr_b16 a[216:217], v2 offset:18432
    v_mfma_f32_16x16x32_bf16 v[68:71], a[224:227], a[160:163], v[68:71]
    buffer_load_dwordx4 v6, s[4:7], s20 offen lds
    v_mfma_f32_16x16x32_bf16 v[76:79], a[224:227], a[184:187], v[76:79]
    s_add_u32 s20, s20, 128
    s_add_u32 m0, s22, 2048
    v_xor_b32 v8, 64, v93
    v_mfma_f32_16x16x32_bf16 v[84:87], a[224:227], a[208:211], v[84:87]
    buffer_load_dwordx4 v6, s[4:7], s20 offen lds
    v_mfma_f32_16x16x32_bf16 v[52:55], a[228:231], a[116:119], v[52:55]
    v_rcp_f32 v94, v94
    v_mfma_f32_16x16x32_bf16 v[60:63], a[228:231], a[140:143], v[60:63]
    ds_read_b64_tr_b16 a[218:219], v2 offset:12288
    v_xor_b32 v102, 96, v93
    v_mfma_f32_16x16x32_bf16 v[68:71], a[228:231], a[164:167], v[68:71]
    ds_read_b64_tr_b16 a[220:221], v3 offset:18432
    v_mfma_f32_16x16x32_bf16 v[76:79], a[228:231], a[188:191], v[76:79]
    ds_read_b64_tr_b16 a[222:223], v3 offset:12288
    v_mov_b32 v108, v49
    v_mfma_f32_16x16x32_bf16 v[84:87], a[228:231], a[212:215], v[84:87]
    ds_read_b64_tr_b16 a[224:225], v4 offset:18432
    v_add_f32 v50, v50, v110
    v_mfma_f32_16x16x32_bf16 v[56:59], a[232:235], a[112:115], v[56:59]
    v_permlane32_swap_b32 v49, v108
    v_mfma_f32_16x16x32_bf16 v[64:67], a[232:235], a[136:139], v[64:67]
    v_add_f32 v100, v51, v111
    v_add_f32 v48, v49, v47
    v_mfma_f32_16x16x32_bf16 v[72:75], a[232:235], a[160:163], v[72:75]
    ds_read_b64_tr_b16 a[226:227], v4 offset:12288
    v_mfma_f32_16x16x32_bf16 v[80:83], a[232:235], a[184:187], v[80:83]
    v_rcp_f32 v48, v48
    v_mfma_f32_16x16x32_bf16 v[88:91], a[232:235], a[208:211], v[88:91]
    ds_read_b64_tr_b16 a[228:229], v5 offset:18432
    v_mfma_f32_16x16x32_bf16 v[56:59], a[236:239], a[116:119], v[56:59]
    s_add_u32 s20, s20, 12032
    v_xor_b32 v95, 32, v93
    v_add_f32 v92, v108, v45
    v_mfma_f32_16x16x32_bf16 v[64:67], a[236:239], a[140:143], v[64:67]
    v_rcp_f32 v92, v92
    v_mfma_f32_16x16x32_bf16 v[72:75], a[236:239], a[164:167], v[72:75]
    ds_read_b64_tr_b16 a[230:231], v5 offset:12288
    v_mfma_f32_16x16x32_bf16 v[80:83], a[236:239], a[188:191], v[80:83]
    v_rcp_f32 v50, v50
    v_mfma_f32_16x16x32_bf16 v[88:91], a[236:239], a[212:215], v[88:91]
    s_waitcnt lgkmcnt(3)
    v_rcp_f32 v100, v100
    v_mfma_f32_16x16x32_bf16 v[112:115], a[216:219], v[16:19], v[112:115]
    s_mov_b32 s67, s34
    v_max3_f32 v98, v68, v69, v70
    v_max3_f32 v96, v52, v53, v54
    v_mfma_f32_16x16x32_bf16 v[116:119], a[220:223], v[16:19], v[116:119]
    s_add_u32 s18, s34, 30720
    v_max3_f32 v99, v76, v77, v78
    v_max3_f32 v97, v60, v61, v62
    v_mfma_f32_16x16x32_bf16 v[164:167], a[220:223], v[20:23], v[164:167]
    s_mov_b32 s34, s33
    ds_read_b64_tr_b16 a[234:235], v2 offset:13312
    v_max3_f32 v99, v99, v79, v80
    v_max3_f32 v96, v96, v55, v56
    v_max3_f32 v97, v97, v63, v64
    v_max3_f32 v98, v98, v71, v72
    v_pk_mul_f32 v[116:117], v[116:117], v[48:49] op_sel_hi:[1,0]
    v_max3_f32 v99, v99, v81, v82
    v_max3_f32 v96, v96, v57, v58
    v_max_f32 v96, v96, v59
    v_mfma_f32_16x16x32_bf16 v[160:163], a[216:219], v[20:23], v[160:163]
    s_add_u32 s64, s64, s62
    v_max_f32 v99, v99, v83
    v_max3_f32 v97, v97, v65, v66
    v_mfma_f32_16x16x32_bf16 v[208:211], a[216:219], v[28:31], v[208:211]
    v_max3_f32 v98, v98, v73, v74
    v_max_f32 v98, v98, v75
    v_mfma_f32_16x16x32_bf16 v[212:215], a[220:223], v[28:31], v[212:215]
    ds_read_b64_tr_b16 a[236:237], v3 offset:19456
    v_max_f32 v97, v97, v67
    v_mfma_f32_16x16x32_bf16 a[4:7], a[220:223], v[32:35], a[4:7]
    v_permlane32_swap_b32 v98, v99
    v_mfma_f32_16x16x32_bf16 a[0:3], a[216:219], v[32:35], a[0:3]
    ds_read_b64_tr_b16 a[232:233], v2 offset:19456
    v_max_f32 v98, v98, v99
    v_mfma_f32_16x16x32_bf16 a[48:51], a[216:219], v[40:43], a[48:51]
    s_add_u32 s64, s64, 196608
    v_permlane32_swap_b32 v96, v97
    v_max_f32 v96, v96, v97
    v_mfma_f32_16x16x32_bf16 a[52:55], a[220:223], v[40:43], a[52:55]
    s_waitcnt lgkmcnt(3)
    ds_read_b64_tr_b16 a[238:239], v3 offset:13312
    v_permlane16_swap_b32 v96, v98
    v_mfma_f32_16x16x32_bf16 a[56:59], a[224:227], v[40:43], a[56:59]
    s_mov_b32 s39, s64
    v_max_f32 v96, v96, v98
    v_mul_f32_e64 v9, -s28, v96
    v_subrev_f32 v9, 0x42000000, v9
    v_max3_f32 v96, v84, v85, v86
    v_mov_b32 v11, v9
    v_mfma_f32_16x16x32_bf16 a[60:63], a[228:231], v[40:43], a[60:63]
    s_add_u32 s37, s37, 1
    ds_read_b64_tr_b16 a[216:217], v4 offset:19456
    v_max3_f32 v96, v96, v87, v88
    v_mfma_f32_16x16x32_bf16 a[12:15], a[228:231], v[32:35], a[12:15]
    s_bitcmp1_b32 s63, s37
    v_permlane16_swap_b32 v9, v11
    v_mov_b32 v12, v11
    v_mfma_f32_16x16x32_bf16 a[8:11], a[224:227], v[32:35], a[8:11]
    s_cselect_b32 s62, 4294770688, 0
    v_permlane32_swap_b32 v11, v12
    v_mfma_f32_16x16x32_bf16 v[216:219], a[224:227], v[28:31], v[216:219]
    s_cselect_b32 s42, 0, 325632
    v_max3_f32 v96, v96, v89, v90
    v_fma_f32 v71, v71, s28, v11
    v_max_f32 v96, v96, v91
    v_mfma_f32_16x16x32_bf16 v[220:223], a[228:231], v[28:31], v[220:223]
    s_add_u32 s35, s35, s42
    ds_read_b64_tr_b16 a[220:221], v5 offset:19456
    v_mov_b32 v97, v96
    v_mfma_f32_16x16x32_bf16 v[172:175], a[228:231], v[20:23], v[172:175]
    ds_read_b64_tr_b16 a[222:223], v5 offset:13312
    v_fma_f32 v68, v68, s28, v11
    v_mov_b32 v10, v9
    v_mfma_f32_16x16x32_bf16 v[168:171], a[224:227], v[20:23], v[168:171]
    s_lshl_b32 s42, s37, 1
    v_permlane32_swap_b32 v97, v96
    v_mfma_f32_16x16x32_bf16 v[120:123], a[224:227], v[16:19], v[120:123]
    s_lshr_b32 s42, s31, s42
    v_max_f32 v96, v96, v97
    v_mov_b32 v97, v96
    v_fma_f32 v79, v79, s28, v12
    v_mfma_f32_16x16x32_bf16 v[124:127], a[228:231], v[16:19], v[124:127]
    s_waitcnt lgkmcnt(3)
    ds_read_b64_tr_b16 a[218:219], v4 offset:13312
    v_permlane16_swap_b32 v97, v96
    v_mfma_f32_16x16x32_bf16 v[128:131], a[232:235], v[16:19], v[128:131]
    s_and_b32 s42, s42, 3
    v_permlane32_swap_b32 v9, v10
    v_max_f32 v96, v96, v97
    v_fma_f32 v80, v80, s28, v12
    v_mfma_f32_16x16x32_bf16 v[132:135], a[236:239], v[16:19], v[132:135]
    s_add_u32 s42, s42, s36
    ds_read_b64_tr_b16 a[230:231], v3 offset:14336
    v_fma_f32 v76, v76, s28, v12
    v_fma_f32 v53, v53, s28, v9
    v_mfma_f32_16x16x32_bf16 v[180:183], a[236:239], v[20:23], v[180:183]
    s_sub_u32 s43, s42, 3
    v_fma_f32 v58, v58, s28, v9
    v_mul_f32_e64 v13, -s28, v96
    v_mfma_f32_16x16x32_bf16 v[176:179], a[232:235], v[20:23], v[176:179]
    s_cmp_ge_u32 s42, 3
    ds_read_b64_tr_b16 a[226:227], v2 offset:14336
    v_exp_f32_e64 v79, v79 clamp
    v_mfma_f32_16x16x32_bf16 v[224:227], a[232:235], v[28:31], v[224:227]
    s_cselect_b32 s42, s43, s42
    ds_read_b64_tr_b16 a[228:229], v3 offset:20480
    v_fma_f32 v78, v78, s28, v12
    v_mfma_f32_16x16x32_bf16 v[228:231], a[236:239], v[28:31], v[228:231]
    s_mul_i32 s44, s3, 5
    v_subrev_f32 v13, 0x42000000, v13
    v_fma_f32 v75, v75, s28, v11
    v_fma_f32 v69, v69, s28, v11
    v_mfma_f32_16x16x32_bf16 a[20:23], a[236:239], v[32:35], a[20:23]
    s_mov_b32 s32, 1
    v_fma_f32 v87, v87, s28, v13
    v_fma_f32 v72, v72, s28, v11
    v_mfma_f32_16x16x32_bf16 a[16:19], a[232:235], v[32:35], a[16:19]
    s_lshl_b32 s43, s3, 2
    v_fma_f32 v81, v81, s28, v12
    v_fma_f32 v66, v66, s28, v10
    v_mfma_f32_16x16x32_bf16 a[64:67], a[232:235], v[40:43], a[64:67]
    s_add_u32 s45, s43, 21
    v_exp_f32_e64 v78, v78 clamp
    v_mfma_f32_16x16x32_bf16 a[68:71], a[236:239], v[40:43], a[68:71]
    s_waitcnt lgkmcnt(3)
    ds_read_b64_tr_b16 a[224:225], v2 offset:20480
    v_fma_f32 v84, v84, s28, v13
    v_mfma_f32_16x16x32_bf16 a[72:75], a[216:219], v[40:43], a[72:75]
    s_cmp_eq_u32 s3, 0
    v_exp_f32_e64 v87, v87 clamp
    v_mfma_f32_16x16x32_bf16 a[76:79], a[220:223], v[40:43], a[76:79]
    s_cselect_b32 s45, 20, s45
    ds_read_b64_tr_b16 a[238:239], v5 offset:14336
    v_fma_f32 v83, v83, s28, v12
    v_accvgpr_read_b32 v104, a0
    v_fma_f32 v57, v57, s28, v9
    v_mfma_f32_16x16x32_bf16 a[28:31], a[220:223], v[32:35], a[28:31]
    s_cselect_b32 s33, 1, 0
    ds_read_b64_tr_b16 a[232:233], v4 offset:20480
    v_fma_f32 v54, v54, s28, v9
    v_mfma_f32_16x16x32_bf16 a[24:27], a[216:219], v[32:35], a[24:27]
    s_cmp_eq_u32 s42, 1
    v_exp_f32_e64 v53, v53 clamp
    v_mfma_f32_16x16x32_bf16 v[232:235], a[216:219], v[28:31], v[232:235]
    s_cselect_b32 s44, s45, s44
    v_exp_f32_e64 v83, v83 clamp
    v_fma_f32 v61, v61, s28, v10
    v_mfma_f32_16x16x32_bf16 v[236:239], a[220:223], v[28:31], v[236:239]
    s_cselect_b32 s32, s33, s32
    v_fma_f32 v77, v77, s28, v12
    v_fma_f32 v64, v64, s28, v10
    v_mfma_f32_16x16x32_bf16 v[188:191], a[220:223], v[20:23], v[188:191]
    s_add_u32 s45, s43, 37
    ds_read_b64_tr_b16 a[236:237], v5 offset:20480
    v_fma_f32 v63, v63, s28, v10
    v_mfma_f32_16x16x32_bf16 v[184:187], a[216:219], v[20:23], v[184:187]
    s_cmp_eq_u32 s42, 2
    v_fma_f32 v70, v70, s28, v11
    v_fma_f32 v90, v90, s28, v13
    v_fma_f32 v89, v89, s28, v13
    v_mfma_f32_16x16x32_bf16 v[136:139], a[216:219], v[16:19], v[136:139]
    s_cselect_b32 s44, s45, s44
    v_fma_f32 v52, v52, s28, v9
    v_fma_f32 v65, v65, s28, v10
    v_mfma_f32_16x16x32_bf16 v[140:143], a[220:223], v[16:19], v[140:143]
    s_waitcnt lgkmcnt(3)
    ds_read_b64_tr_b16 a[234:235], v4 offset:14336
    v_exp_f32_e64 v54, v54 clamp
    v_mfma_f32_16x16x32_bf16 v[144:147], a[224:227], v[16:19], v[144:147]
    s_cselect_b32 s32, 0, s32
    v_exp_f32_e64 v52, v52 clamp
    v_mfma_f32_16x16x32_bf16 v[148:151], a[228:231], v[16:19], v[148:151]
    s_mul_i32 s44, s44, 6144
    s_add_u32 s33, s35, s44
    v_fma_f32 v88, v88, s28, v13
    v_mfma_f32_16x16x32_bf16 v[196:199], a[228:231], v[20:23], v[196:199]
    s_mul_i32 s42, s32, 6144
    v_fma_f32 v82, v82, s28, v12
    v_fma_f32 v62, v62, s28, v10
    v_mfma_f32_16x16x32_bf16 v[192:195], a[224:227], v[20:23], v[192:195]
    s_add_u32 s42, s42, 24576
    s_add_u32 s42, s42, s33
    v_fma_f32 v60, v60, s28, v10
    v_mfma_f32_16x16x32_bf16 v[240:243], a[224:227], v[28:31], v[240:243]
    s_cmp_ge_u32 s37, 6
    v_exp_f32_e64 v70, v70 clamp
    v_mfma_f32_16x16x32_bf16 v[244:247], a[228:231], v[28:31], v[244:247]
    s_cselect_b32 s14, 0, s42
    v_exp_f32_e64 v62, v62 clamp
    v_mfma_f32_16x16x32_bf16 a[36:39], a[228:231], v[32:35], a[36:39]
    s_add_u32 s24, s67, 256
    v_exp_f32_e64 v76, v76 clamp
    v_mfma_f32_16x16x32_bf16 a[32:35], a[224:227], v[32:35], a[32:35]
    s_add_u32 s25, s33, 256
    v_exp_f32_e64 v77, v77 clamp
    v_mfma_f32_16x16x32_bf16 a[80:83], a[224:227], v[40:43], a[80:83]
    s_add_u32 s23, s38, 4096
    v_fma_f32 v85, v85, s28, v13
    s_mov_b32 s27, 0x249
    v_mfma_f32_16x16x32_bf16 a[84:87], a[228:231], v[40:43], a[84:87]
    s_mov_b32 s30, 0
    v_fma_f32 v55, v55, s28, v9
    s_waitcnt vmcnt(8) lgkmcnt(0)
    v_fma_f32 v73, v73, s28, v11
    v_mfma_f32_16x16x32_bf16 a[88:91], a[232:235], v[40:43], a[88:91]
    s_barrier
    ds_read_b128 a[216:219], v0 offset:12288
    v_mfma_f32_16x16x32_bf16 a[92:95], a[236:239], v[40:43], a[92:95]
    v_exp_f32_e64 v55, v55 clamp
    v_exp_f32_e64 v60, v60 clamp
    v_mfma_f32_16x16x32_bf16 a[44:47], a[236:239], v[32:35], a[44:47]
    ds_read_b128 a[220:223], v1 offset:12288
    v_cvt_pk_bf16_f32 v14, v52, v53
    v_fma_f32 v86, v86, s28, v13
    v_mfma_f32_16x16x32_bf16 a[40:43], a[232:235], v[32:35], a[40:43]
    ds_read_b128 a[224:227], v0 offset:13312
    v_fma_f32 v59, v59, s28, v9
    v_exp_f32_e64 v86, v86 clamp
    v_cvt_pk_bf16_f32 v15, v54, v55
    v_mfma_f32_16x16x32_bf16 v[248:251], a[232:235], v[28:31], v[248:251]
    v_exp_f32_e64 v61, v61 clamp
    v_mfma_f32_16x16x32_bf16 v[252:255], a[236:239], v[28:31], v[252:255]
    v_exp_f32_e64 v63, v63 clamp
    v_exp_f32_e64 v85, v85 clamp
    v_mfma_f32_16x16x32_bf16 v[204:207], a[236:239], v[20:23], v[204:207]
    v_accvgpr_read_b32 v105, a1
    v_accvgpr_read_b32 v109, a49
    v_exp_f32_e64 v71, v71 clamp
    v_mfma_f32_16x16x32_bf16 v[200:203], a[232:235], v[20:23], v[200:203]
    v_accvgpr_read_b32 v110, a50
    v_cvt_pk_bf16_f32 v39, v86, v87
    v_mfma_f32_16x16x32_bf16 v[152:155], a[232:235], v[16:19], v[152:155]
    v_exp_f32_e64 v90, v90 clamp
    v_cvt_pk_bf16_f32 v27, v70, v71
    v_mfma_f32_16x16x32_bf16 v[156:159], a[236:239], v[16:19], v[156:159]
    s_waitcnt lgkmcnt(2)
    ds_read_b128 a[236:239], v1 offset:14336
    v_cvt_pk_bf16_f32 v22, v60, v61
    v_mfma_f32_16x16x32_bf16 v[52:55], a[216:219], a[96:99], 0
    s_waitcnt lgkmcnt(2)
    v_fma_f32 v56, v56, s28, v9
    v_cvt_pk_bf16_f32 v23, v62, v63
    v_mfma_f32_16x16x32_bf16 v[52:55], a[220:223], a[100:103], v[52:55]
    s_waitcnt lgkmcnt(1)
    v_exp_f32_e64 v64, v64 clamp
    v_mfma_f32_16x16x32_bf16 v[52:55], a[224:227], a[104:107], v[52:55]
    v_exp_f32_e64 v68, v68 clamp
    v_mfma_f32_16x16x32_bf16 v[60:63], a[224:227], a[128:131], 0
    s_add_u32 m0, s22, 36864
    v_exp_f32_e64 v69, v69 clamp
    v_mfma_f32_16x16x32_bf16 v[60:63], a[220:223], a[124:127], v[60:63]
    buffer_load_dwordx4 v6, s[8:11], s21 offen lds
    v_mfma_f32_16x16x32_bf16 v[60:63], a[216:219], a[120:123], v[60:63]
    ds_read_b128 a[228:231], v1 offset:13312
    v_exp_f32_e64 v66, v66 clamp
    v_cvt_pk_bf16_f32 v26, v68, v69
    v_accvgpr_read_b32 v106, a2
    v_mfma_f32_16x16x32_bf16 v[68:71], a[216:219], a[144:147], 0
    ds_read_b128 a[232:235], v0 offset:14336
    v_cvt_pk_bf16_f32 v35, v78, v79
    v_fma_f32 v67, v67, s28, v10
    v_mfma_f32_16x16x32_bf16 v[68:71], a[220:223], a[148:151], v[68:71]
    v_exp_f32_e64 v82, v82 clamp
    v_cvt_pk_bf16_f32 v34, v76, v77
    v_mfma_f32_16x16x32_bf16 v[68:71], a[224:227], a[152:155], v[68:71]
    v_exp_f32_e64 v75, v75 clamp
    v_mfma_f32_16x16x32_bf16 v[76:79], a[224:227], a[176:179], 0
    s_add_u32 s21, s21, 128
    v_exp_f32_e64 v84, v84 clamp
    v_mfma_f32_16x16x32_bf16 v[76:79], a[220:223], a[172:175], v[76:79]
    v_cvt_pk_bf16_f32 v38, v84, v85
    v_cvt_pk_bf16_f32 v37, v82, v83
    v_fma_f32 v74, v74, s28, v11
    v_mfma_f32_16x16x32_bf16 v[76:79], a[216:219], a[168:171], v[76:79]
    v_exp_f32_e64 v59, v59 clamp
    v_mfma_f32_16x16x32_bf16 v[84:87], a[216:219], a[192:195], 0
    v_exp_f32_e64 v80, v80 clamp
    v_mfma_f32_16x16x32_bf16 v[84:87], a[220:223], a[196:199], v[84:87]
    ds_read_b128 a[216:219], v0 offset:18432
    v_accvgpr_read_b32 v111, a51
    v_mfma_f32_16x16x32_bf16 v[84:87], a[224:227], a[200:203], v[84:87]
    s_waitcnt lgkmcnt(2)
    v_exp_f32_e64 v67, v67 clamp
    v_mfma_f32_16x16x32_bf16 v[84:87], a[228:231], a[204:207], v[84:87]
    s_waitcnt lgkmcnt(1)
    ds_read_b128 a[224:227], v0 offset:19456
    v_fma_f32 v91, v91, s28, v13
    v_mfma_f32_16x16x32_bf16 v[84:87], a[232:235], a[208:211], v[84:87]
    s_add_u32 m0, s22, 37888
    v_exp_f32_e64 v56, v56 clamp
    v_mfma_f32_16x16x32_bf16 v[84:87], a[236:239], a[212:215], v[84:87]
    v_exp_f32_e64 v74, v74 clamp
    v_mfma_f32_16x16x32_bf16 v[76:79], a[236:239], a[188:191], v[76:79]
    v_exp_f32_e64 v65, v65 clamp
    v_mfma_f32_16x16x32_bf16 v[76:79], a[232:235], a[184:187], v[76:79]
    v_exp_f32_e64 v58, v58 clamp
    v_mfma_f32_16x16x32_bf16 v[76:79], a[228:231], a[180:183], v[76:79]
    v_exp_f32_e64 v57, v57 clamp
    v_mfma_f32_16x16x32_bf16 v[68:71], a[228:231], a[156:159], v[68:71]
    v_exp_f32_e64 v81, v81 clamp
    v_cvt_pk_bf16_f32 v29, v74, v75
    v_mfma_f32_16x16x32_bf16 v[68:71], a[232:235], a[160:163], v[68:71]
    v_exp_f32_e64 v88, v88 clamp
    v_mfma_f32_16x16x32_bf16 v[68:71], a[236:239], a[164:167], v[68:71]
    v_cvt_pk_bf16_f32 v16, v56, v57
    v_cvt_pk_bf16_f32 v17, v58, v59
    v_mfma_f32_16x16x32_bf16 v[60:63], a[236:239], a[140:143], v[60:63]
    ds_read_b128 a[220:223], v1 offset:18432
    v_fma_f32 v84, v84, s28, v13
    v_mfma_f32_16x16x32_bf16 v[60:63], a[232:235], a[136:139], v[60:63]
    v_exp_f32_e64 v73, v73 clamp
    v_mfma_f32_16x16x32_bf16 v[60:63], a[228:231], a[132:135], v[60:63]
    v_exp_f32_e64 v72, v72 clamp
    v_mfma_f32_16x16x32_bf16 v[52:55], a[228:231], a[108:111], v[52:55]
    v_exp_f32_e64 v89, v89 clamp
    v_cvt_pk_bf16_f32 v28, v72, v73
    v_cvt_pk_bf16_f32 v24, v64, v65
    v_cvt_pk_bf16_f32 v25, v66, v67
    v_cvt_pk_bf16_f32 v36, v80, v81
    v_pk_mul_f32 v[172:173], v[172:173], v[92:93] op_sel_hi:[1,0]
    v_pk_mul_f32 v[234:235], v[234:235], v[50:51] op_sel_hi:[1,0]
    v_pk_mul_f32 v[212:213], v[212:213], v[50:51] op_sel_hi:[1,0]
    v_pk_mul_f32 v[208:209], v[208:209], v[50:51] op_sel_hi:[1,0]
    v_pk_mul_f32 v[164:165], v[164:165], v[92:93] op_sel_hi:[1,0]
    v_pk_mul_f32 v[140:141], v[140:141], v[48:49] op_sel_hi:[1,0]
    v_pk_mul_f32 v[128:129], v[128:129], v[48:49] op_sel_hi:[1,0]
    v_pk_mul_f32 v[114:115], v[114:115], v[48:49] op_sel_hi:[1,0]
    v_pk_mul_f32 v[194:195], v[194:195], v[92:93] op_sel_hi:[1,0]
    v_exp_f32_e64 v91, v91 clamp
    v_cvt_pk_bf16_f32 v208, v208, v209
    v_mfma_f32_16x16x32_bf16 v[52:55], a[232:235], a[112:115], v[52:55]
    v_exp_f32_e64 v84, v84 clamp
    v_mfma_f32_16x16x32_bf16 v[52:55], a[236:239], a[116:119], v[52:55]
    s_waitcnt lgkmcnt(1)
    v_fma_f32 v85, v85, s28, v13
    v_accvgpr_read_b32 v108, a48
    v_mfma_f32_16x16x32_bf16 v[56:59], a[216:219], a[96:99], 0
    s_waitcnt lgkmcnt(0)
    v_cvt_pk_bf16_f32 v212, v212, v213
    v_fma_f32 v60, v60, s28, v10
    v_mfma_f32_16x16x32_bf16 v[56:59], a[220:223], a[100:103], v[56:59]
    buffer_load_dwordx4 v6, s[8:11], s21 offen lds
    v_mfma_f32_16x16x32_bf16 v[44:47], a[248:251], v[14:17], 0
    s_add_u32 s21, s21, 128
    v_cvt_pk_bf16_f32 v41, v90, v91
    v_fma_f32 v79, v79, s28, v12
    v_mfma_f32_16x16x32_bf16 v[56:59], a[224:227], a[104:107], v[56:59]
    v_fma_f32 v71, v71, s28, v11
    v_fma_f32 v68, v68, s28, v11
    v_mfma_f32_16x16x32_bf16 v[64:67], a[224:227], a[128:131], 0
    v_fma_f32 v69, v69, s28, v11
    v_cvt_pk_bf16_f32 v164, v164, v165
    v_mfma_f32_16x16x32_bf16 v[64:67], a[220:223], a[124:127], v[64:67]
    s_add_u32 m0, s22, 38912
    v_cvt_pk_bf16_f32 v172, v172, v173
    v_fma_f32 v52, v52, s28, v9
    v_mfma_f32_16x16x32_bf16 v[64:67], a[216:219], a[120:123], v[64:67]
    buffer_load_dwordx4 v6, s[8:11], s21 offen lds
    v_mfma_f32_16x16x32_bf16 v[72:75], a[216:219], a[144:147], 0
    ds_read_b128 a[232:235], v0 offset:20480
    v_accvgpr_read_b32 v107, a3
    v_mfma_f32_16x16x32_bf16 v[72:75], a[220:223], a[148:151], v[72:75]
    v_exp_f32_e64 v79, v79 clamp
    v_mfma_f32_16x16x32_bf16 v[72:75], a[224:227], a[152:155], v[72:75]
    ds_read_b128 a[236:239], v1 offset:20480
    v_fma_f32 v61, v61, s28, v10
    v_mfma_f32_16x16x32_bf16 v[80:83], a[224:227], a[176:179], 0
    ds_read_b128 a[228:231], v1 offset:19456
    v_fma_f32 v86, v86, s28, v13
    v_mfma_f32_16x16x32_bf16 v[80:83], a[220:223], a[172:175], v[80:83]
    s_add_u32 s21, s21, 12032
    v_subrev_u32 v103, 28672, v103
    v_cvt_pk_bf16_f32 v40, v88, v89
    v_fma_f32 v55, v55, s28, v9
    v_exp_f32_e64 v85, v85 clamp
    v_pk_mul_f32 v[230:231], v[230:231], v[50:51] op_sel_hi:[1,0]
    v_pk_mul_f32 v[112:113], v[112:113], v[48:49] op_sel_hi:[1,0]
    v_pk_mul_f32 v[216:217], v[216:217], v[50:51] op_sel_hi:[1,0]
    v_pk_mul_f32 v[106:107], v[106:107], v[94:95] op_sel_hi:[1,0]
    v_pk_mul_f32 v[178:179], v[178:179], v[92:93] op_sel_hi:[1,0]
    v_pk_mul_f32 v[118:119], v[118:119], v[48:49] op_sel_hi:[1,0]
    v_pk_mul_f32 v[222:223], v[222:223], v[50:51] op_sel_hi:[1,0]
    v_pk_mul_f32 v[134:135], v[134:135], v[48:49] op_sel_hi:[1,0]
    v_pk_mul_f32 v[162:163], v[162:163], v[92:93] op_sel_hi:[1,0]
    v_pk_mul_f32 v[238:239], v[238:239], v[50:51] op_sel_hi:[1,0]
    v_pk_mul_f32 v[108:109], v[108:109], v[100:101] op_sel_hi:[1,0]
    v_pk_mul_f32 v[210:211], v[210:211], v[50:51] op_sel_hi:[1,0]
    v_pk_mul_f32 v[240:241], v[240:241], v[50:51] op_sel_hi:[1,0]
    v_cvt_pk_bf16_f32 v112, v112, v113
    v_pk_mul_f32 v[160:161], v[160:161], v[92:93] op_sel_hi:[1,0]
    v_pk_mul_f32 v[224:225], v[224:225], v[50:51] op_sel_hi:[1,0]
    v_pk_mul_f32 v[174:175], v[174:175], v[92:93] op_sel_hi:[1,0]
    v_pk_mul_f32 v[248:249], v[248:249], v[50:51] op_sel_hi:[1,0]
    v_pk_mul_f32 v[110:111], v[110:111], v[100:101] op_sel_hi:[1,0]
    v_pk_mul_f32 v[220:221], v[220:221], v[50:51] op_sel_hi:[1,0]
    v_pk_mul_f32 v[124:125], v[124:125], v[48:49] op_sel_hi:[1,0]
    v_pk_mul_f32 v[122:123], v[122:123], v[48:49] op_sel_hi:[1,0]
    v_pk_mul_f32 v[104:105], v[104:105], v[94:95] op_sel_hi:[1,0]
    v_pk_mul_f32 v[226:227], v[226:227], v[50:51] op_sel_hi:[1,0]
    v_cvt_pk_bf16_f32 v104, v104, v105
    v_pk_mul_f32 v[214:215], v[214:215], v[50:51] op_sel_hi:[1,0]
    v_pk_mul_f32 v[182:183], v[182:183], v[92:93] op_sel_hi:[1,0]
    v_cvt_pk_bf16_f32 v113, v114, v115
    v_cvt_pk_bf16_f32 v160, v160, v161
    v_mfma_f32_16x16x32_bf16 v[80:83], a[216:219], a[168:171], v[80:83]
    v_fma_f32 v77, v77, s28, v12
    v_fma_f32 v54, v54, s28, v9
    v_mfma_f32_16x16x32_bf16 v[88:91], a[216:219], a[192:195], 0
    s_waitcnt vmcnt(6) lgkmcnt(0)
    v_fma_f32 v76, v76, s28, v12
    v_cvt_pk_bf16_f32 v161, v162, v163
    v_mfma_f32_16x16x32_bf16 v[88:91], a[220:223], a[196:199], v[88:91]
    s_add_u32 m0, s22, 12288
    v_exp_f32_e64 v86, v86 clamp
    v_mfma_f32_16x16x32_bf16 v[88:91], a[224:227], a[200:203], v[88:91]
    s_barrier
    v_mfma_f32_16x16x32_bf16 v[88:91], a[228:231], a[204:207], v[88:91]
    ds_read_b64_tr_b16 a[216:217], v2 offset:0
    v_cvt_pk_bf16_f32 v224, v224, v225
    v_mfma_f32_16x16x32_bf16 v[88:91], a[232:235], a[208:211], v[88:91]
    ds_write2st64_b64 v93, v[112:113], v[160:161] offset0:0 offset1:12
    v_mfma_f32_16x16x32_bf16 v[88:91], a[236:239], a[212:215], v[88:91]
    ds_read_b64_tr_b16 a[218:219], v2 offset:6144
    v_fma_f32 v87, v87, s28, v13
    v_mfma_f32_16x16x32_bf16 v[80:83], a[236:239], a[188:191], v[80:83]
    v_cvt_pk_bf16_f32 v108, v108, v109
    v_cvt_pk_bf16_f32 v105, v106, v107
    v_mfma_f32_16x16x32_bf16 v[80:83], a[232:235], a[184:187], v[80:83]
    v_cvt_pk_bf16_f32 v109, v110, v111
    v_cvt_pk_bf16_f32 v213, v214, v215
    v_mfma_f32_16x16x32_bf16 v[80:83], a[228:231], a[180:183], v[80:83]
    v_exp_f32_e64 v60, v60 clamp
    v_cvt_pk_bf16_f32 v209, v210, v211
    v_mfma_f32_16x16x32_bf16 v[72:75], a[228:231], a[156:159], v[72:75]
    ds_read_b64_tr_b16 a[220:221], v3 offset:0
    v_exp_f32_e64 v76, v76 clamp
    v_exp_f32_e64 v52, v52 clamp
    v_smfmac_f32_16x16x64_bf16 v[44:47], a[240:243], v[22:29], v101
    buffer_load_dwordx4 v6, s[4:7], s20 offen lds
    ds_read_b64_tr_b16 a[222:223], v3 offset:6144
    v_mfma_f32_16x16x32_bf16 v[72:75], a[232:235], a[160:163], v[72:75]
    ds_write2st64_b64 v93, v[208:209], v[104:105] offset0:24 offset1:36
    v_mfma_f32_16x16x32_bf16 v[72:75], a[236:239], a[164:167], v[72:75]
    ds_write_b64 v93, v[108:109] offset:24576
    v_mfma_f32_16x16x32_bf16 v[64:67], a[236:239], a[140:143], v[64:67]
    v_cvt_pk_bf16_f32 v116, v116, v117
    v_accvgpr_read_b32 v109, a53
    v_mfma_f32_16x16x32_bf16 v[64:67], a[232:235], a[136:139], v[64:67]
    v_accvgpr_read_b32 v105, a5
    v_accvgpr_read_b32 v107, a7
    v_mfma_f32_16x16x32_bf16 v[64:67], a[228:231], a[132:135], v[64:67]
    ds_read_b64_tr_b16 a[224:225], v4 offset:0
    v_accvgpr_read_b32 v111, a55
    v_mfma_f32_16x16x32_bf16 v[56:59], a[228:231], a[108:111], v[56:59]
    v_accvgpr_read_b32 v108, a52
    v_cvt_pk_bf16_f32 v173, v174, v175
    v_accvgpr_read_b32 v104, a4
    v_accvgpr_read_b32 v106, a6
    v_cvt_pk_bf16_f32 v124, v124, v125
    v_pk_mul_f32 v[120:121], v[120:121], v[48:49] op_sel_hi:[1,0]
    v_pk_mul_f32 v[106:107], v[106:107], v[94:95] op_sel_hi:[1,0]
    v_fma_f32 v63, v63, s28, v10
    v_fma_f32 v90, v90, s28, v13
    v_pk_mul_f32 v[148:149], v[148:149], v[48:49] op_sel_hi:[1,0]
    v_pk_mul_f32 v[206:207], v[206:207], v[92:93] op_sel_hi:[1,0]
    v_pk_mul_f32 v[166:167], v[166:167], v[92:93] op_sel_hi:[1,0]
    v_pk_mul_f32 v[228:229], v[228:229], v[50:51] op_sel_hi:[1,0]
    v_fma_f32 v80, v80, s28, v12
    v_pk_mul_f32 v[192:193], v[192:193], v[92:93] op_sel_hi:[1,0]
    v_pk_mul_f32 v[170:171], v[170:171], v[92:93] op_sel_hi:[1,0]
    v_pk_mul_f32 v[136:137], v[136:137], v[48:49] op_sel_hi:[1,0]
    v_pk_mul_f32 v[232:233], v[232:233], v[50:51] op_sel_hi:[1,0]
    v_cvt_pk_bf16_f32 v117, v118, v119
    v_cvt_pk_bf16_f32 v120, v120, v121
    v_pk_mul_f32 v[104:105], v[104:105], v[94:95] op_sel_hi:[1,0]
    v_pk_mul_f32 v[132:133], v[132:133], v[48:49] op_sel_hi:[1,0]
    v_cvt_pk_bf16_f32 v165, v166, v167
    v_pk_mul_f32 v[108:109], v[108:109], v[100:101] op_sel_hi:[1,0]
    v_pk_mul_f32 v[218:219], v[218:219], v[50:51] op_sel_hi:[1,0]
    v_pk_mul_f32 v[184:185], v[184:185], v[92:93] op_sel_hi:[1,0]
    v_pk_mul_f32 v[126:127], v[126:127], v[48:49] op_sel_hi:[1,0]
    v_pk_mul_f32 v[200:201], v[200:201], v[92:93] op_sel_hi:[1,0]
    v_pk_mul_f32 v[142:143], v[142:143], v[48:49] op_sel_hi:[1,0]
    v_pk_mul_f32 v[168:169], v[168:169], v[92:93] op_sel_hi:[1,0]
    v_pk_mul_f32 v[204:205], v[204:205], v[92:93] op_sel_hi:[1,0]
    v_fma_f32 v53, v53, s28, v9
    v_exp_f32_e64 v68, v68 clamp
    v_fma_f32 v66, v66, s28, v10
    v_cvt_pk_bf16_f32 v128, v128, v129
    v_cvt_pk_bf16_f32 v104, v104, v105
    v_accvgpr_read_b32 v110, a54
    v_cvt_pk_bf16_f32 v105, v106, v107
    v_fma_f32 v89, v89, s28, v13
    v_smfmac_f32_16x16x64_bf16 v[44:47], a[244:247], v[34:41], v101
    s_add_u32 s20, s20, 128
    ds_write2st64_b64 v95, v[116:117], v[164:165] offset0:0 offset1:12
    v_pk_mul_f32 v[252:253], v[252:253], v[50:51] op_sel_hi:[1,0]
    v_cvt_pk_bf16_f32 v168, v168, v169
    v_cvt_pk_bf16_f32 v148, v148, v149
    v_mfma_f32_16x16x32_bf16 v[56:59], a[232:235], a[112:115], v[56:59]
    ds_write2st64_b64 v95, v[212:213], v[104:105] offset0:24 offset1:36
    v_pk_mul_f32 v[196:197], v[196:197], v[92:93] op_sel_hi:[1,0]
    v_accvgpr_read_b32 v106, a10
    v_pk_mul_f32 v[130:131], v[130:131], v[48:49] op_sel_hi:[1,0]
    v_pk_mul_f32 v[110:111], v[110:111], v[100:101] op_sel_hi:[1,0]
    v_pk_mul_f32 v[146:147], v[146:147], v[48:49] op_sel_hi:[1,0]
    v_pk_mul_f32 v[186:187], v[186:187], v[92:93] op_sel_hi:[1,0]
    v_cvt_pk_bf16_f32 v108, v108, v109
    v_pk_mul_f32 v[254:255], v[254:255], v[50:51] op_sel_hi:[1,0]
    v_cvt_pk_bf16_f32 v184, v184, v185
    v_cvt_pk_bf16_f32 v109, v110, v111
    v_accvgpr_read_b32 v105, a9
    v_cvt_pk_bf16_f32 v196, v196, v197
    v_accvgpr_read_b32 v107, a11
    v_cvt_pk_bf16_f32 v136, v136, v137
    v_mfma_f32_16x16x32_bf16 v[56:59], a[236:239], a[116:119], v[56:59]
    s_waitcnt lgkmcnt(2)
    v_fma_f32 v73, v73, s28, v11
    v_cvt_pk_bf16_f32 v232, v232, v233
    v_mfma_f32_16x16x32_bf16 v[112:115], a[216:219], v[14:17], 0
    s_add_u32 m0, s22, 13312
    ds_write_b64 v95, v[108:109] offset:24576
    v_mfma_f32_16x16x32_bf16 v[116:119], a[220:223], v[14:17], 0
    ds_read_b64_tr_b16 a[236:237], v3 offset:1024
    v_exp_f32_e64 v80, v80 clamp
    v_mfma_f32_16x16x32_bf16 v[164:167], a[220:223], v[22:25], 0
    ds_read_b64_tr_b16 a[226:227], v4 offset:6144
    v_cvt_pk_bf16_f32 v216, v216, v217
    v_mfma_f32_16x16x32_bf16 v[160:163], a[216:219], v[22:25], 0
    ds_read_b64_tr_b16 a[228:229], v5 offset:0
    v_accvgpr_read_b32 v108, a56
    v_accvgpr_read_b32 v109, a57
    v_fma_f32 v64, v64, s28, v10
    v_cvt_pk_bf16_f32 v121, v122, v123
    v_cvt_pk_bf16_f32 v220, v220, v221
    v_accvgpr_read_b32 v104, a8
    v_pk_mul_f32 v[108:109], v[108:109], v[100:101] op_sel_hi:[1,0]
    v_pk_mul_f32 v[144:145], v[144:145], v[48:49] op_sel_hi:[1,0]
    v_pk_mul_f32 v[106:107], v[106:107], v[94:95] op_sel_hi:[1,0]
    v_pk_mul_f32 v[250:251], v[250:251], v[50:51] op_sel_hi:[1,0]
    v_exp_f32_e64 v55, v55 clamp
    v_accvgpr_read_b32 v111, a59
    v_exp_f32_e64 v69, v69 clamp
    v_pk_mul_f32 v[176:177], v[176:177], v[92:93] op_sel_hi:[1,0]
    v_pk_mul_f32 v[104:105], v[104:105], v[94:95] op_sel_hi:[1,0]
    v_pk_mul_f32 v[236:237], v[236:237], v[50:51] op_sel_hi:[1,0]
    v_cvt_pk_bf16_f32 v144, v144, v145
    v_cvt_pk_bf16_f32 v169, v170, v171
    v_exp_f32_e64 v66, v66 clamp
    v_fma_f32 v72, v72, s28, v11
    v_mfma_f32_16x16x32_bf16 v[208:211], a[216:219], v[26:29], 0
    ds_read_b64_tr_b16 a[230:231], v5 offset:6144
    v_cvt_pk_bf16_f32 v104, v104, v105
    v_cvt_pk_bf16_f32 v125, v126, v127
    v_mfma_f32_16x16x32_bf16 v[212:215], a[220:223], v[26:29], 0
    ds_read_b64_tr_b16 a[238:239], v3 offset:7168
    v_cvt_pk_bf16_f32 v217, v218, v219
    v_cvt_pk_bf16_f32 v140, v140, v141
    v_cvt_pk_bf16_f32 v108, v108, v109
    v_accvgpr_read_b32 v110, a58
    v_cvt_pk_bf16_f32 v236, v236, v237
    v_cvt_pk_bf16_f32 v105, v106, v107
    v_mfma_f32_16x16x32_bf16 a[4:7], a[220:223], v[34:37], 0
    ds_write2st64_b64 v8, v[120:121], v[168:169] offset0:0 offset1:12
    v_pk_mul_f32 v[110:111], v[110:111], v[100:101] op_sel_hi:[1,0]
    v_cvt_pk_bf16_f32 v132, v132, v133
    v_cvt_pk_bf16_f32 v109, v110, v111
    v_mfma_f32_16x16x32_bf16 a[0:3], a[216:219], v[34:37], 0
    ds_write2st64_b64 v8, v[216:217], v[104:105] offset0:24 offset1:36
    v_mfma_f32_16x16x32_bf16 a[48:51], a[216:219], v[38:41], 0
    buffer_load_dwordx4 v6, s[4:7], s20 offen lds
    ds_write_b64 v8, v[108:109] offset:24576
    v_cvt_pk_bf16_f32 v221, v222, v223
    v_mfma_f32_16x16x32_bf16 a[52:55], a[220:223], v[38:41], 0
    s_waitcnt lgkmcnt(4)
    ds_read_b64_tr_b16 a[232:233], v2 offset:1024
    v_accvgpr_read_b32 v107, a15
    v_mfma_f32_16x16x32_bf16 a[56:59], a[224:227], v[38:41], 0
    ds_read_b64_tr_b16 a[234:235], v2 offset:7168
    v_cvt_pk_bf16_f32 v176, v176, v177
    v_accvgpr_read_b32 v110, a62
    v_accvgpr_read_b32 v111, a63
    v_accvgpr_read_b32 v104, a12
    v_accvgpr_read_b32 v108, a60
    v_fma_f32 v65, v65, s28, v10
    v_accvgpr_read_b32 v106, a14
    v_accvgpr_read_b32 v109, a61
    v_cvt_pk_bf16_f32 v185, v186, v187
    v_pk_mul_f32 v[110:111], v[110:111], v[100:101] op_sel_hi:[1,0]
    v_pk_mul_f32 v[108:109], v[108:109], v[100:101] op_sel_hi:[1,0]
    v_pk_mul_f32 v[190:191], v[190:191], v[92:93] op_sel_hi:[1,0]
    v_cvt_pk_bf16_f32 v228, v228, v229
    v_accvgpr_read_b32 v105, a13
    v_mfma_f32_16x16x32_bf16 a[60:63], a[228:231], v[38:41], 0
    ds_write2st64_b64 v102, v[124:125], v[172:173] offset0:0 offset1:12
    v_pk_mul_f32 v[244:245], v[244:245], v[50:51] op_sel_hi:[1,0]
    v_pk_mul_f32 v[138:139], v[138:139], v[48:49] op_sel_hi:[1,0]
    v_pk_mul_f32 v[106:107], v[106:107], v[94:95] op_sel_hi:[1,0]
    v_pk_mul_f32 v[104:105], v[104:105], v[94:95] op_sel_hi:[1,0]
    v_pk_mul_f32 v[152:153], v[152:153], v[48:49] op_sel_hi:[1,0]
    v_cvt_pk_bf16_f32 v225, v226, v227
    v_exp_f32_e64 v54, v54 clamp
    v_pk_mul_f32 v[150:151], v[150:151], v[48:49] op_sel_hi:[1,0]
    v_cvt_pk_bf16_f32 v104, v104, v105
    v_pk_mul_f32 v[180:181], v[180:181], v[92:93] op_sel_hi:[1,0]
    v_exp_f32_e64 v77, v77 clamp
    v_cvt_pk_bf16_f32 v108, v108, v109
    v_cvt_pk_bf16_f32 v105, v106, v107
    v_mfma_f32_16x16x32_bf16 a[12:15], a[228:231], v[34:37], 0
    s_add_u32 s20, s20, 128
    ds_write2st64_b64 v102, v[220:221], v[104:105] offset0:24 offset1:36
    v_mfma_f32_16x16x32_bf16 a[8:11], a[224:227], v[34:37], 0
    ds_read_b64_tr_b16 a[220:221], v5 offset:1024
    ds_read_b64_tr_b16 a[218:219], v4 offset:7168
    v_cvt_pk_bf16_f32 v129, v130, v131
    v_cvt_pk_bf16_f32 v109, v110, v111
    v_mfma_f32_16x16x32_bf16 v[216:219], a[224:227], v[26:29], 0
    ds_write_b64 v102, v[108:109] offset:24576
    v_accvgpr_read_b32 v108, a64
    v_cvt_pk_bf16_f32 v180, v180, v181
    v_mfma_f32_16x16x32_bf16 v[220:223], a[228:231], v[26:29], 0
    ds_read_b128 v[96:99], v103 offset:0
    v_accvgpr_read_b32 v106, a18
    v_accvgpr_read_b32 v105, a17
    v_cvt_pk_bf16_f32 v177, v178, v179
    v_accvgpr_read_b32 v109, a65
    v_accvgpr_read_b32 v104, a16
    v_accvgpr_read_b32 v107, a19
    v_cvt_pk_bf16_f32 v200, v200, v201
    v_pk_mul_f32 v[106:107], v[106:107], v[94:95] op_sel_hi:[1,0]
    v_cvt_pk_bf16_f32 v244, v244, v245
    v_accvgpr_read_b32 v110, a66
    v_cvt_pk_bf16_f32 v137, v138, v139
    v_cvt_pk_bf16_f32 v30, v68, v69
    v_fma_f32 v82, v82, s28, v12
    v_pk_mul_f32 v[246:247], v[246:247], v[50:51] op_sel_hi:[1,0]
    v_fma_f32 v88, v88, s28, v13
    v_pk_mul_f32 v[108:109], v[108:109], v[100:101] op_sel_hi:[1,0]
    v_fma_f32 v91, v91, s28, v13
    v_accvgpr_read_b32 v111, a67
    v_pk_mul_f32 v[110:111], v[110:111], v[100:101] op_sel_hi:[1,0]
    v_pk_mul_f32 v[104:105], v[104:105], v[94:95] op_sel_hi:[1,0]
    v_cvt_pk_bf16_f32 v237, v238, v239
    v_cvt_pk_bf16_f32 v108, v108, v109
    v_cvt_pk_bf16_f32 v133, v134, v135
    v_cvt_pk_bf16_f32 v104, v104, v105
    v_cvt_pk_bf16_f32 v105, v106, v107
    v_mfma_f32_16x16x32_bf16 v[172:175], a[228:231], v[22:25], 0
    ds_write2st64_b64 v93, v[128:129], v[176:177] offset0:4 offset1:16
    v_mfma_f32_16x16x32_bf16 v[168:171], a[224:227], v[22:25], 0
    ds_write2st64_b64 v93, v[224:225], v[104:105] offset0:28 offset1:40
    v_cvt_pk_bf16_f32 v109, v110, v111
    v_cvt_pk_bf16_f32 v181, v182, v183
    v_accvgpr_read_b32 v104, a20
    v_pk_mul_f32 v[242:243], v[242:243], v[50:51] op_sel_hi:[1,0]
    v_pk_mul_f32 v[188:189], v[188:189], v[92:93] op_sel_hi:[1,0]
    v_accvgpr_read_b32 v105, a21
    v_fma_f32 v67, v67, s28, v10
    v_cvt_pk_bf16_f32 v192, v192, v193
    v_accvgpr_read_b32 v111, a71
    v_accvgpr_read_b32 v110, a70
    v_cvt_pk_bf16_f32 v188, v188, v189
    v_cvt_pk_bf16_f32 v145, v146, v147
    v_cvt_pk_bf16_f32 v229, v230, v231
    v_accvgpr_read_b32 v107, a23
    v_mfma_f32_16x16x32_bf16 v[120:123], a[224:227], v[14:17], 0
    ds_write_b64 v93, v[108:109] offset:26624
    v_accvgpr_read_b32 v109, a69
    v_accvgpr_read_b32 v106, a22
    v_mfma_f32_16x16x32_bf16 v[124:127], a[228:231], v[14:17], 0
    s_waitcnt lgkmcnt(3)
    ds_read_b64_tr_b16 a[216:217], v4 offset:1024
    v_fma_f32 v78, v78, s28, v12
    v_mfma_f32_16x16x32_bf16 v[128:131], a[232:235], v[14:17], 0
    ds_write2st64_b64 v95, v[132:133], v[180:181] offset0:4 offset1:16
    v_accvgpr_read_b32 v108, a68
    v_pk_mul_f32 v[154:155], v[154:155], v[48:49] op_sel_hi:[1,0]
    v_pk_mul_f32 v[104:105], v[104:105], v[94:95] op_sel_hi:[1,0]
    v_pk_mul_f32 v[198:199], v[198:199], v[92:93] op_sel_hi:[1,0]
    v_pk_mul_f32 v[108:109], v[108:109], v[100:101] op_sel_hi:[1,0]
    v_pk_mul_f32 v[110:111], v[110:111], v[100:101] op_sel_hi:[1,0]
    v_exp_f32_e64 v53, v53 clamp
    v_cvt_pk_bf16_f32 v104, v104, v105
    v_pk_mul_f32 v[106:107], v[106:107], v[94:95] op_sel_hi:[1,0]
    v_exp_f32_e64 v89, v89 clamp
    v_cvt_pk_bf16_f32 v105, v106, v107
    v_mfma_f32_16x16x32_bf16 v[132:135], a[236:239], v[14:17], 0
    ds_write2st64_b64 v95, v[228:229], v[104:105] offset0:28 offset1:40
    v_cvt_pk_bf16_f32 v108, v108, v109
    v_cvt_pk_bf16_f32 v233, v234, v235
    v_cvt_pk_bf16_f32 v109, v110, v111
    v_accvgpr_read_b32 v111, a75
    v_accvgpr_read_b32 v104, a24
    v_mfma_f32_16x16x32_bf16 v[180:183], a[236:239], v[22:25], 0
    buffer_store_dwordx4 v[96:99], v6, s[16:19], s67 offen offset:0 nt
    ds_write_b64 v95, v[108:109] offset:26624
    v_accvgpr_read_b32 v105, a25
    v_accvgpr_read_b32 v107, a27
    v_cvt_pk_bf16_f32 v204, v204, v205
    v_pk_mul_f32 v[104:105], v[104:105], v[94:95] op_sel_hi:[1,0]
    v_accvgpr_read_b32 v109, a73
    v_accvgpr_read_b32 v106, a26
    v_accvgpr_read_b32 v108, a72
    v_pk_mul_f32 v[106:107], v[106:107], v[94:95] op_sel_hi:[1,0]
    v_cvt_pk_bf16_f32 v193, v194, v195
    v_cvt_pk_bf16_f32 v240, v240, v241
    v_cvt_pk_bf16_f32 v189, v190, v191
    v_pk_mul_f32 v[108:109], v[108:109], v[100:101] op_sel_hi:[1,0]
    v_cvt_pk_bf16_f32 v241, v242, v243
    v_accvgpr_read_b32 v110, a74
    v_cvt_pk_bf16_f32 v104, v104, v105
    v_cvt_pk_bf16_f32 v18, v52, v53
    v_pk_mul_f32 v[110:111], v[110:111], v[100:101] op_sel_hi:[1,0]
    v_cvt_pk_bf16_f32 v141, v142, v143
    v_cvt_pk_bf16_f32 v108, v108, v109
    v_mfma_f32_16x16x32_bf16 v[176:179], a[232:235], v[22:25], 0
    ds_read_b64_tr_b16 a[222:223], v5 offset:7168
    v_cvt_pk_bf16_f32 v109, v110, v111
    v_cvt_pk_bf16_f32 v152, v152, v153
    v_accvgpr_read_b32 v110, a78
    v_mfma_f32_16x16x32_bf16 v[224:227], a[232:235], v[26:29], 0
    ds_write2st64_b64 v8, v[136:137], v[184:185] offset0:4 offset1:16
    v_cvt_pk_bf16_f32 v105, v106, v107
    v_mfma_f32_16x16x32_bf16 v[228:231], a[236:239], v[26:29], 0
    ds_read_b64_tr_b16 a[226:227], v2 offset:8192
    v_cvt_pk_bf16_f32 v248, v248, v249
    v_mfma_f32_16x16x32_bf16 a[20:23], a[236:239], v[34:37], 0
    ds_write2st64_b64 v8, v[232:233], v[104:105] offset0:28 offset1:40
    v_cvt_pk_bf16_f32 v19, v54, v55
    v_mfma_f32_16x16x32_bf16 a[16:19], a[232:235], v[34:37], 0
    s_add_u32 m0, s22, 14336
    ds_write_b64 v8, v[108:109] offset:26624
    v_accvgpr_read_b32 v107, a31
    v_mfma_f32_16x16x32_bf16 a[64:67], a[232:235], v[38:41], 0
    ds_read_b64_tr_b16 a[224:225], v2 offset:2048
    ds_read_b64_tr_b16 a[228:229], v3 offset:2048
    v_fma_f32 v70, v70, s28, v11
    v_fma_f32 v56, v56, s28, v9
    v_accvgpr_read_b32 v109, a77
    v_accvgpr_read_b32 v105, a29
    v_mfma_f32_16x16x32_bf16 a[68:71], a[236:239], v[38:41], 0
    s_waitcnt lgkmcnt(6)
    ds_read_b128 v[96:99], v103 offset:1024
    v_accvgpr_read_b32 v106, a30
    v_mfma_f32_16x16x32_bf16 a[72:75], a[216:219], v[38:41], 0
    ds_write2st64_b64 v102, v[140:141], v[188:189] offset0:4 offset1:16
    v_cvt_pk_bf16_f32 v252, v252, v253
    v_accvgpr_read_b32 v111, a79
    v_cvt_pk_bf16_f32 v205, v206, v207
    v_accvgpr_read_b32 v108, a76
    v_accvgpr_read_b32 v104, a28
    v_pk_mul_f32 v[108:109], v[108:109], v[100:101] op_sel_hi:[1,0]
    v_pk_mul_f32 v[104:105], v[104:105], v[94:95] op_sel_hi:[1,0]
    v_pk_mul_f32 v[106:107], v[106:107], v[94:95] op_sel_hi:[1,0]
    v_cvt_pk_bf16_f32 v104, v104, v105
    v_pk_mul_f32 v[156:157], v[156:157], v[48:49] op_sel_hi:[1,0]
    v_cvt_pk_bf16_f32 v197, v198, v199
    v_cvt_pk_bf16_f32 v108, v108, v109
    v_cvt_pk_bf16_f32 v153, v154, v155
    v_mfma_f32_16x16x32_bf16 a[76:79], a[220:223], v[38:41], 0
    ds_read_b64_tr_b16 a[234:235], v4 offset:8192
    v_cvt_pk_bf16_f32 v105, v106, v107
    v_mfma_f32_16x16x32_bf16 a[28:31], a[220:223], v[34:37], 0
    ds_write2st64_b64 v102, v[236:237], v[104:105] offset0:28 offset1:40
    v_accvgpr_read_b32 v107, a35
    v_pk_mul_f32 v[110:111], v[110:111], v[100:101] op_sel_hi:[1,0]
    v_cvt_pk_bf16_f32 v149, v150, v151
    v_pk_mul_f32 v[202:203], v[202:203], v[92:93] op_sel_hi:[1,0]
    v_cvt_pk_bf16_f32 v109, v110, v111
    v_accvgpr_read_b32 v110, a82
    v_exp_f32_e64 v65, v65 clamp
    v_accvgpr_read_b32 v104, a32
    v_mfma_f32_16x16x32_bf16 a[24:27], a[216:219], v[34:37], 0
    buffer_load_dwordx4 v6, s[4:7], s20 offen lds
    ds_read_b64_tr_b16 a[232:233], v4 offset:2048
    v_mfma_f32_16x16x32_bf16 v[232:235], a[216:219], v[26:29], 0
    ds_write_b64 v102, v[108:109] offset:26624
    v_mfma_f32_16x16x32_bf16 v[236:239], a[220:223], v[26:29], 0
    ds_read_b64_tr_b16 a[236:237], v5 offset:2048
    ds_read_b64_tr_b16 a[230:231], v3 offset:8192
    v_accvgpr_read_b32 v109, a81
    v_cvt_pk_bf16_f32 v156, v156, v157
    v_accvgpr_read_b32 v111, a83
    v_accvgpr_read_b32 v108, a80
    v_cvt_pk_bf16_f32 v249, v250, v251
    v_accvgpr_read_b32 v106, a34
    v_pk_mul_f32 v[106:107], v[106:107], v[94:95] op_sel_hi:[1,0]
    v_accvgpr_read_b32 v105, a33
    v_cvt_pk_bf16_f32 v201, v202, v203
    v_pk_mul_f32 v[104:105], v[104:105], v[94:95] op_sel_hi:[1,0]
    v_cvt_pk_bf16_f32 v253, v254, v255
    v_pk_mul_f32 v[108:109], v[108:109], v[100:101] op_sel_hi:[1,0]
    v_pk_mul_f32 v[110:111], v[110:111], v[100:101] op_sel_hi:[1,0]
    v_cvt_pk_bf16_f32 v108, v108, v109
    v_cvt_pk_bf16_f32 v104, v104, v105
    v_mfma_f32_16x16x32_bf16 v[188:191], a[220:223], v[22:25], 0
    ds_read_b64_tr_b16 a[238:239], v5 offset:8192
    v_cvt_pk_bf16_f32 v105, v106, v107
    v_mfma_f32_16x16x32_bf16 v[184:187], a[216:219], v[22:25], 0
    s_add_u32 s20, s20, 12032
    ds_write2st64_b64 v93, v[144:145], v[192:193] offset0:8 offset1:20
    v_exp_f32_e64 v91, v91 clamp
    v_cvt_pk_bf16_f32 v245, v246, v247
    v_exp_f32_e64 v88, v88 clamp
    v_exp_f32_e64 v72, v72 clamp
    v_accvgpr_read_b32 v107, a39
    v_cvt_pk_bf16_f32 v109, v110, v111
    v_mfma_f32_16x16x32_bf16 v[136:139], a[216:219], v[14:17], 0
    s_add_u32 s39, s39, 12288
    ds_write2st64_b64 v93, v[240:241], v[104:105] offset0:32 offset1:44
    v_mfma_f32_16x16x32_bf16 v[140:143], a[220:223], v[14:17], 0
    s_waitcnt lgkmcnt(3)
    ds_write_b64 v93, v[108:109] offset:0
    v_mfma_f32_16x16x32_bf16 v[144:147], a[224:227], v[14:17], 0
    ds_write2st64_b64 v95, v[148:149], v[196:197] offset0:8 offset1:20
    v_accvgpr_read_b32 v105, a37
    v_accvgpr_read_b32 v104, a36
    v_pk_mul_f32 v[104:105], v[104:105], v[94:95] op_sel_hi:[1,0]
    v_accvgpr_read_b32 v106, a38
    v_pk_mul_f32 v[106:107], v[106:107], v[94:95] op_sel_hi:[1,0]
    s_waitcnt vmcnt(7) lgkmcnt(3)
    v_accvgpr_read_b32 v109, a85
    v_accvgpr_read_b32 v111, a87
    v_cvt_pk_bf16_f32 v104, v104, v105
    v_accvgpr_read_b32 v108, a84
    v_fma_f32 v59, v59, s28, v9
    v_mfma_f32_16x16x32_bf16 v[148:151], a[228:231], v[14:17], 0
    s_barrier
    v_cvt_pk_bf16_f32 v105, v106, v107
    v_mfma_f32_16x16x32_bf16 v[196:199], a[228:231], v[22:25], 0
    s_add_u32 m0, s22, 24576
    ds_read_b128 a[216:219], v0 offset:0
    buffer_load_dwordx4 v6, s[8:11], s21 offen lds
    v_mfma_f32_16x16x32_bf16 v[192:195], a[224:227], v[22:25], 0
    buffer_store_dwordx4 v[96:99], v7, s[16:19], s67 offen offset:0 nt
    s_add_u32 s21, s21, 128
    ds_write2st64_b64 v95, v[244:245], v[104:105] offset0:32 offset1:44
    v_accvgpr_read_b32 v110, a86
    v_pk_mul_f32 v[108:109], v[108:109], v[100:101] op_sel_hi:[1,0]
    v_accvgpr_read_b32 v106, a42
    v_pk_mul_f32 v[110:111], v[110:111], v[100:101] op_sel_hi:[1,0]
    v_cvt_pk_bf16_f32 v108, v108, v109
    v_exp_f32_e64 v61, v61 clamp
    v_fma_f32 v62, v62, s28, v10
    v_cvt_pk_bf16_f32 v109, v110, v111
    v_accvgpr_read_b32 v105, a41
    v_mfma_f32_16x16x32_bf16 v[240:243], a[224:227], v[26:29], 0
    s_add_u32 m0, s22, 25600
    ds_write_b64 v95, v[108:109] offset:0
    v_accvgpr_read_b32 v104, a40
    v_accvgpr_read_b32 v111, a91
    v_accvgpr_read_b32 v107, a43
    v_pk_mul_f32 v[104:105], v[104:105], v[94:95] op_sel_hi:[1,0]
    v_accvgpr_read_b32 v110, a90
    v_accvgpr_read_b32 v108, a88
    v_mfma_f32_16x16x32_bf16 v[244:247], a[228:231], v[26:29], 0
    buffer_load_dwordx4 v6, s[8:11], s21 offen lds
    v_mfma_f32_16x16x32_bf16 a[36:39], a[228:231], v[34:37], 0
    ds_write2st64_b64 v8, v[152:153], v[200:201] offset0:8 offset1:20
    v_exp_f32_e64 v87, v87 clamp
    v_cvt_pk_bf16_f32 v104, v104, v105
    v_pk_mul_f32 v[106:107], v[106:107], v[94:95] op_sel_hi:[1,0]
    v_cvt_pk_bf16_f32 v42, v84, v85
    v_pk_mul_f32 v[158:159], v[158:159], v[48:49] op_sel_hi:[1,0]
    v_accvgpr_read_b32 v109, a89
    v_pk_mul_f32 v[110:111], v[110:111], v[100:101] op_sel_hi:[1,0]
    v_pk_mul_f32 v[108:109], v[108:109], v[100:101] op_sel_hi:[1,0]
    v_cvt_pk_bf16_f32 v105, v106, v107
    v_cvt_pk_bf16_f32 v108, v108, v109
    v_cvt_pk_bf16_f32 v109, v110, v111
    v_cvt_pk_bf16_f32 v157, v158, v159
    v_accvgpr_read_b32 v107, a47
    v_accvgpr_read_b32 v106, a46
    v_mfma_f32_16x16x32_bf16 a[32:35], a[224:227], v[34:37], 0
    v_accvgpr_read_b32 v110, a94
    v_exp_f32_e64 v62, v62 clamp
    v_mfma_f32_16x16x32_bf16 a[80:83], a[224:227], v[38:41], 0
    s_add_u32 s21, s21, 128
    ds_write2st64_b64 v8, v[248:249], v[104:105] offset0:32 offset1:44
    v_accvgpr_read_b32 v104, a44
    v_accvgpr_read_b32 v111, a95
    v_mfma_f32_16x16x32_bf16 a[84:87], a[228:231], v[38:41], 0
    s_add_u32 m0, s22, 26624
    ds_write_b64 v8, v[108:109] offset:0
    v_mfma_f32_16x16x32_bf16 a[88:91], a[232:235], v[38:41], 0
    buffer_load_dwordx4 v6, s[8:11], s21 offen lds
    ds_read_b128 a[220:223], v1 offset:0
    v_accvgpr_read_b32 v108, a92
    v_accvgpr_read_b32 v105, a45
    v_accvgpr_read_b32 v109, a93
    v_pk_mul_f32 v[108:109], v[108:109], v[100:101] op_sel_hi:[1,0]
    v_pk_mul_f32 v[104:105], v[104:105], v[94:95] op_sel_hi:[1,0]
    v_pk_mul_f32 v[106:107], v[106:107], v[94:95] op_sel_hi:[1,0]
    v_pk_mul_f32 v[110:111], v[110:111], v[100:101] op_sel_hi:[1,0]
    v_cvt_pk_bf16_f32 v104, v104, v105
    v_cvt_pk_bf16_f32 v105, v106, v107
    v_mfma_f32_16x16x32_bf16 a[92:95], a[236:239], v[38:41], 0
    ds_read_b128 v[96:99], v103 offset:2048
    v_cvt_pk_bf16_f32 v40, v88, v89
    v_mfma_f32_16x16x32_bf16 a[44:47], a[236:239], v[34:37], 0
    ds_read_b128 a[224:227], v0 offset:1024
    v_fma_f32 v75, v75, s28, v11
    v_mfma_f32_16x16x32_bf16 a[40:43], a[232:235], v[34:37], 0
    s_add_u32 s21, s21, 12032
    ds_write2st64_b64 v102, v[156:157], v[204:205] offset0:8 offset1:20
    v_mfma_f32_16x16x32_bf16 v[248:251], a[232:235], v[26:29], 0
    ds_write2st64_b64 v102, v[252:253], v[104:105] offset0:32 offset1:44
    v_mfma_f32_16x16x32_bf16 v[252:255], a[236:239], v[26:29], 0
    v_exp_f32_e64 v90, v90 clamp
    v_mfma_f32_16x16x32_bf16 v[204:207], a[236:239], v[22:25], 0
    s_add_u32 s56, s67, 128
    v_exp_f32_e64 v71, v71 clamp
    v_cvt_pk_bf16_f32 v41, v90, v91
    v_mfma_f32_16x16x32_bf16 v[200:203], a[232:235], v[22:25], 0
    s_add_u32 s58, s33, 128
    v_exp_f32_e64 v63, v63 clamp
    v_mfma_f32_16x16x32_bf16 v[152:155], a[232:235], v[14:17], 0
    s_add_u32 m0, s38, 2048
    v_cvt_pk_bf16_f32 v43, v86, v87
    v_cvt_pk_bf16_f32 v23, v62, v63
    v_mfma_f32_16x16x32_bf16 v[156:159], a[236:239], v[14:17], 0
    s_waitcnt lgkmcnt(3)
    ds_read_b128 a[228:231], v1 offset:1024
    v_exp_f32_e64 v78, v78 clamp
    v_mfma_f32_16x16x32_bf16 v[52:55], a[216:219], a[96:99], 0
    ds_read_b128 a[232:235], v0 offset:2048
    v_fma_f32 v74, v74, s28, v11
    v_mfma_f32_16x16x32_bf16 v[48:51], a[248:251], v[40:43], 0
    buffer_store_dwordx4 v[96:99], v6, s[16:19], s56 offen offset:0 nt
    v_exp_f32_e64 v59, v59 clamp
    v_fma_f32 v57, v57, s28, v9
    v_mfma_f32_16x16x32_bf16 v[52:55], a[220:223], a[100:103], v[52:55]
    s_waitcnt lgkmcnt(2)
    v_exp_f32_e64 v70, v70 clamp
    v_mfma_f32_16x16x32_bf16 v[52:55], a[224:227], a[104:107], v[52:55]
    v_cvt_pk_bf16_f32 v108, v108, v109
    v_cvt_pk_bf16_f32 v22, v60, v61
    v_cvt_pk_bf16_f32 v34, v76, v77
    v_mfma_f32_16x16x32_bf16 v[60:63], a[224:227], a[128:131], 0
    buffer_load_dwordx4 v6, s[12:15], s58 offen nt lds
    v_mfma_f32_16x16x32_bf16 v[60:63], a[220:223], a[124:127], v[60:63]
    ds_read_b128 v[96:99], v103 offset:3072
    v_cvt_pk_bf16_f32 v31, v70, v71
    v_mfma_f32_16x16x32_bf16 v[60:63], a[216:219], a[120:123], v[60:63]
    v_cvt_pk_bf16_f32 v35, v78, v79
    v_fma_f32 v81, v81, s28, v12
    v_mfma_f32_16x16x32_bf16 v[68:71], a[216:219], a[144:147], 0
    ds_read_b128 a[236:239], v1 offset:2048
    v_fma_f32 v83, v83, s28, v12
    v_mfma_f32_16x16x32_bf16 v[68:71], a[220:223], a[148:151], v[68:71]
    v_exp_f32_e64 v74, v74 clamp
    v_mfma_f32_16x16x32_bf16 v[68:71], a[224:227], a[152:155], v[68:71]
    v_exp_f32_e64 v81, v81 clamp
    v_mfma_f32_16x16x32_bf16 v[76:79], a[224:227], a[176:179], 0
    v_exp_f32_e64 v56, v56 clamp
    v_mfma_f32_16x16x32_bf16 v[76:79], a[220:223], a[172:175], v[76:79]
    v_exp_f32_e64 v57, v57 clamp
    v_mfma_f32_16x16x32_bf16 v[76:79], a[216:219], a[168:171], v[76:79]
    v_exp_f32_e64 v73, v73 clamp
    v_mfma_f32_16x16x32_bf16 v[84:87], a[216:219], a[192:195], 0
    v_exp_f32_e64 v82, v82 clamp
    v_mfma_f32_16x16x32_bf16 v[84:87], a[220:223], a[196:199], v[84:87]
    v_exp_f32_e64 v67, v67 clamp
    v_mfma_f32_16x16x32_bf16 v[84:87], a[224:227], a[200:203], v[84:87]
    s_waitcnt lgkmcnt(1)
    v_fma_f32 v58, v58, s28, v9
    v_cvt_pk_bf16_f32 v109, v110, v111
    v_mfma_f32_16x16x32_bf16 v[84:87], a[228:231], a[204:207], v[84:87]
    buffer_store_dwordx4 v[96:99], v7, s[16:19], s56 offen offset:0 nt
    ds_write_b64 v102, v[108:109] offset:0
    v_mfma_f32_16x16x32_bf16 v[84:87], a[232:235], a[208:211], v[84:87]
    s_waitcnt lgkmcnt(1)
    v_exp_f32_e64 v75, v75 clamp
    v_mfma_f32_16x16x32_bf16 v[84:87], a[236:239], a[212:215], v[84:87]
    s_add_u32 m0, s38, 3072
    v_exp_f32_e64 v58, v58 clamp
    v_mfma_f32_16x16x32_bf16 v[76:79], a[236:239], a[188:191], v[76:79]
    buffer_load_dwordx4 v7, s[12:15], s58 offen nt lds
    v_mfma_f32_16x16x32_bf16 v[76:79], a[232:235], a[184:187], v[76:79]
    v_exp_f32_e64 v83, v83 clamp
    v_mfma_f32_16x16x32_bf16 v[76:79], a[228:231], a[180:183], v[76:79]
    ds_read_b128 v[96:99], v103 offset:0
    v_exp_f32_e64 v64, v64 clamp
    v_mfma_f32_16x16x32_bf16 v[68:71], a[228:231], a[156:159], v[68:71]
    v_cvt_pk_bf16_f32 v17, v58, v59
    v_mfma_f32_16x16x32_bf16 v[68:71], a[232:235], a[160:163], v[68:71]
    ds_read_b128 a[216:219], v0 offset:6144
    v_cvt_pk_bf16_f32 v16, v56, v57
    v_mfma_f32_16x16x32_bf16 v[68:71], a[236:239], a[164:167], v[68:71]
    ds_read_b128 a[220:223], v1 offset:6144
    v_cvt_pk_bf16_f32 v33, v82, v83
    v_mfma_f32_16x16x32_bf16 v[60:63], a[236:239], a[140:143], v[60:63]
    ds_read_b128 a[224:227], v0 offset:7168
    v_mfma_f32_16x16x32_bf16 v[60:63], a[232:235], a[136:139], v[60:63]
    s_add_u32 s57, s67, 24832
    v_cvt_pk_bf16_f32 v28, v72, v73
    v_cvt_pk_bf16_f32 v29, v74, v75
    v_mfma_f32_16x16x32_bf16 v[60:63], a[228:231], a[132:135], v[60:63]
    v_cvt_pk_bf16_f32 v21, v66, v67
    v_cvt_pk_bf16_f32 v20, v64, v65
    v_mfma_f32_16x16x32_bf16 v[52:55], a[228:231], a[108:111], v[52:55]
    v_cvt_pk_bf16_f32 v32, v80, v81
    v_smfmac_f32_16x16x64_bf16 v[48:51], a[240:243], v[16:23], v101
    v_mfma_f32_16x16x32_bf16 v[52:55], a[232:235], a[112:115], v[52:55]
    s_add_u32 m0, s38, 0
    ds_read_b128 a[232:235], v0 offset:8192
    v_smfmac_f32_16x16x64_bf16 v[48:51], a[244:247], v[28:35], v101
    s_waitcnt lgkmcnt(4)
    buffer_load_dwordx4 v6, s[12:15], s33 offen nt lds
    v_mfma_f32_16x16x32_bf16 v[52:55], a[236:239], a[116:119], v[52:55]
    buffer_store_dwordx4 v[96:99], v6, s[16:19], s57 offen offset:0 nt
    s_add_u32 m0, s38, 1024
    ds_read_b128 v[96:99], v103 offset:1024
    s_waitcnt lgkmcnt(3)
    v_mfma_f32_16x16x32_bf16 v[56:59], a[216:219], a[96:99], 0
    ds_read_b128 a[236:239], v1 offset:8192
    v_cmp_lt_f32 vcc, s29, v48
    v_mfma_f32_16x16x32_bf16 v[56:59], a[220:223], a[100:103], v[56:59]
    s_waitcnt lgkmcnt(3)
    ds_read_b128 a[228:231], v1 offset:7168
    v_mfma_f32_16x16x32_bf16 v[56:59], a[224:227], a[104:107], v[56:59]
    v_mfma_f32_16x16x32_bf16 v[64:67], a[224:227], a[128:131], 0
    s_cbranch_vccnz L_rs_tr55d
L_ret_tr55d:
    v_add_u32 v103, 4096, v103
    v_mfma_f32_16x16x32_bf16 v[64:67], a[220:223], a[124:127], v[64:67]
    v_fma_f32 v53, v53, s28, v9
    v_mfma_f32_16x16x32_bf16 v[64:67], a[216:219], a[120:123], v[64:67]
    v_exp_f32_e64 v53, v53 clamp
    v_mfma_f32_16x16x32_bf16 v[72:75], a[216:219], a[144:147], 0
    v_fma_f32 v55, v55, s28, v9
    v_mfma_f32_16x16x32_bf16 v[72:75], a[220:223], a[148:151], v[72:75]
    v_fma_f32 v62, v62, s28, v10
    v_mfma_f32_16x16x32_bf16 v[72:75], a[224:227], a[152:155], v[72:75]
    v_fma_f32 v60, v60, s28, v10
    v_fma_f32 v52, v52, s28, v9
    v_mfma_f32_16x16x32_bf16 v[80:83], a[224:227], a[176:179], 0
    s_waitcnt lgkmcnt(2)
    buffer_load_dwordx4 v7, s[12:15], s33 offen nt lds
    v_mfma_f32_16x16x32_bf16 v[80:83], a[220:223], a[172:175], v[80:83]
    v_exp_f32_e64 v52, v52 clamp
    v_mfma_f32_16x16x32_bf16 v[80:83], a[216:219], a[168:171], v[80:83]
    buffer_store_dwordx4 v[96:99], v7, s[16:19], s57 offen offset:0 nt
    s_waitcnt vmcnt(16) lgkmcnt(0)
    s_barrier
    v_mfma_f32_16x16x32_bf16 v[88:91], a[216:219], a[192:195], 0
    v_exp_f32_e64 v62, v62 clamp
    v_mfma_f32_16x16x32_bf16 v[88:91], a[220:223], a[196:199], v[88:91]
    ds_read_b64_tr_b16 a[216:217], v2 offset:18432
    v_fma_f32 v61, v61, s28, v10
    v_mfma_f32_16x16x32_bf16 v[88:91], a[224:227], a[200:203], v[88:91]
    ds_read_b64_tr_b16 a[218:219], v2 offset:12288
    v_fma_f32 v54, v54, s28, v9
    v_mfma_f32_16x16x32_bf16 v[88:91], a[228:231], a[204:207], v[88:91]
    ds_read_b64_tr_b16 a[220:221], v3 offset:18432
    s_add_u32 m0, s22, 0
    v_mfma_f32_16x16x32_bf16 v[88:91], a[232:235], a[208:211], v[88:91]
    buffer_load_dwordx4 v6, s[4:7], s20 offen lds
    v_mfma_f32_16x16x32_bf16 v[88:91], a[236:239], a[212:215], v[88:91]
    ds_read_b64_tr_b16 a[222:223], v3 offset:12288
    v_fma_f32 v63, v63, s28, v10
    v_mfma_f32_16x16x32_bf16 v[80:83], a[236:239], a[188:191], v[80:83]
    v_exp_f32_e64 v54, v54 clamp
    v_mfma_f32_16x16x32_bf16 v[80:83], a[232:235], a[184:187], v[80:83]
    s_add_u32 s20, s20, 128
    v_exp_f32_e64 v60, v60 clamp
    v_mfma_f32_16x16x32_bf16 v[80:83], a[228:231], a[180:183], v[80:83]
    s_add_u32 m0, s22, 1024
    v_exp_f32_e64 v63, v63 clamp
    v_mfma_f32_16x16x32_bf16 v[72:75], a[228:231], a[156:159], v[72:75]
    buffer_load_dwordx4 v6, s[4:7], s20 offen lds
    v_mfma_f32_16x16x32_bf16 v[72:75], a[232:235], a[160:163], v[72:75]
    s_add_u32 s20, s20, 128
    v_exp_f32_e64 v61, v61 clamp
    v_mfma_f32_16x16x32_bf16 v[72:75], a[236:239], a[164:167], v[72:75]
    s_add_u32 m0, s22, 2048
    ds_read_b64_tr_b16 a[224:225], v4 offset:18432
    v_cvt_pk_bf16_f32 v14, v52, v53
    v_mfma_f32_16x16x32_bf16 v[64:67], a[236:239], a[140:143], v[64:67]
    v_exp_f32_e64 v55, v55 clamp
    v_mfma_f32_16x16x32_bf16 v[64:67], a[232:235], a[136:139], v[64:67]
    buffer_load_dwordx4 v6, s[4:7], s20 offen lds
    v_mfma_f32_16x16x32_bf16 v[64:67], a[228:231], a[132:135], v[64:67]
    s_add_u32 s20, s20, 12032
    ds_read_b64_tr_b16 a[226:227], v4 offset:12288
    v_cvt_pk_bf16_f32 v15, v54, v55
    v_mfma_f32_16x16x32_bf16 v[56:59], a[228:231], a[108:111], v[56:59]
    s_bitcmp1_b32 s3, 1
    s_waitcnt lgkmcnt(2)
    ds_read_b64_tr_b16 a[228:229], v5 offset:18432
    v_mfma_f32_16x16x32_bf16 v[56:59], a[232:235], a[112:115], v[56:59]
    ds_read_b64_tr_b16 a[230:231], v5 offset:12288
    v_mfma_f32_16x16x32_bf16 v[56:59], a[236:239], a[116:119], v[56:59]
    s_cbranch_scc1 L_loop5w1
    s_branch L_loop5w0
    .p2align 6
L_loop4w0:
    v_mfma_f32_16x16x32_bf16 v[112:115], a[216:219], v[16:19], v[112:115]
    v_fma_f32 v74, v74, s28, v11
    v_fma_f32 v63, v63, s28, v10
    v_mfma_f32_16x16x32_bf16 v[160:163], a[216:219], v[20:23], v[160:163]
    ds_read_b64_tr_b16 a[232:233], v2 offset:19456
    v_fma_f32 v75, v75, s28, v11
    v_mfma_f32_16x16x32_bf16 v[208:211], a[216:219], v[28:31], v[208:211]
    v_fma_f32 v64, v64, s28, v10
    v_fma_f32 v66, v66, s28, v10
    v_fma_f32 v81, v81, s28, v12
    v_mfma_f32_16x16x32_bf16 a[0:3], a[216:219], v[32:35], a[0:3]
    ds_read_b64_tr_b16 a[236:237], v3 offset:19456
    s_waitcnt lgkmcnt(6)
    v_mfma_f32_16x16x32_bf16 a[4:7], a[220:223], v[32:35], a[4:7]
    ds_read_b64_tr_b16 a[234:235], v2 offset:13312
    v_fma_f32 v71, v71, s28, v11
    v_mfma_f32_16x16x32_bf16 v[212:215], a[220:223], v[28:31], v[212:215]
    ds_read_b64_tr_b16 a[216:217], v4 offset:19456
    v_fma_f32 v62, v62, s28, v10
    v_mfma_f32_16x16x32_bf16 v[164:167], a[220:223], v[20:23], v[164:167]
    v_exp_f32_e64 v81, v81 clamp
    v_mfma_f32_16x16x32_bf16 v[116:119], a[220:223], v[16:19], v[116:119]
    ds_read_b64_tr_b16 a[238:239], v3 offset:13312
    s_waitcnt lgkmcnt(7)
    v_mfma_f32_16x16x32_bf16 v[120:123], a[224:227], v[16:19], v[120:123]
    v_exp_f32_e64 v71, v71 clamp
    v_mfma_f32_16x16x32_bf16 v[168:171], a[224:227], v[20:23], v[168:171]
    ds_read_b64_tr_b16 a[218:219], v4 offset:13312
    v_fma_f32 v65, v65, s28, v10
    v_mfma_f32_16x16x32_bf16 v[216:219], a[224:227], v[28:31], v[216:219]
    v_exp_f32_e64 v63, v63 clamp
    v_mfma_f32_16x16x32_bf16 a[8:11], a[224:227], v[32:35], a[8:11]
    s_waitcnt lgkmcnt(5)
    v_fma_f32 v56, v56, s28, v9
    v_mfma_f32_16x16x32_bf16 a[12:15], a[228:231], v[32:35], a[12:15]
    ds_read_b64_tr_b16 a[226:227], v2 offset:14336
    v_fma_f32 v72, v72, s28, v11
    v_mfma_f32_16x16x32_bf16 v[220:223], a[228:231], v[28:31], v[220:223]
    ds_read_b128 v[88:91], v103 offset:0
    v_fma_f32 v83, v83, s28, v12
    v_mfma_f32_16x16x32_bf16 v[172:175], a[228:231], v[20:23], v[172:175]
    ds_read_b64_tr_b16 a[222:223], v5 offset:13312
    v_fma_f32 v76, v76, s28, v12
    v_mfma_f32_16x16x32_bf16 v[124:127], a[228:231], v[16:19], v[124:127]
    s_waitcnt lgkmcnt(5)
    ds_read_b64_tr_b16 a[224:225], v2 offset:20480
    v_fma_f32 v58, v58, s28, v9
    v_mfma_f32_16x16x32_bf16 v[128:131], a[232:235], v[16:19], v[128:131]
    ds_read_b64_tr_b16 a[220:221], v5 offset:19456
    v_fma_f32 v73, v73, s28, v11
    v_mfma_f32_16x16x32_bf16 v[176:179], a[232:235], v[20:23], v[176:179]
    v_exp_f32_e64 v74, v74 clamp
    v_mfma_f32_16x16x32_bf16 v[224:227], a[232:235], v[28:31], v[224:227]
    v_exp_f32_e64 v72, v72 clamp
    v_mfma_f32_16x16x32_bf16 a[16:19], a[232:235], v[32:35], a[16:19]
    s_waitcnt lgkmcnt(5)
    ds_read_b64_tr_b16 a[228:229], v3 offset:20480
    v_fma_f32 v69, v69, s28, v11
    v_mfma_f32_16x16x32_bf16 a[20:23], a[236:239], v[32:35], a[20:23]
    ds_read_b64_tr_b16 a[230:231], v3 offset:14336
    v_fma_f32 v70, v70, s28, v11
    v_mfma_f32_16x16x32_bf16 v[228:231], a[236:239], v[28:31], v[228:231]
    ds_read_b64_tr_b16 a[234:235], v4 offset:14336
    v_mfma_f32_16x16x32_bf16 v[180:183], a[236:239], v[20:23], v[180:183]
    ds_read_b64_tr_b16 a[232:233], v4 offset:20480
    v_fma_f32 v80, v80, s28, v12
    v_mfma_f32_16x16x32_bf16 v[132:135], a[236:239], v[16:19], v[132:135]
    ds_read_b64_tr_b16 a[236:237], v5 offset:20480
    v_fma_f32 v57, v57, s28, v9
    v_mfma_f32_16x16x32_bf16 v[136:139], a[216:219], v[16:19], v[136:139]
    ds_read_b64_tr_b16 a[238:239], v5 offset:14336
    v_fma_f32 v59, v59, s28, v9
    v_mfma_f32_16x16x32_bf16 v[184:187], a[216:219], v[20:23], v[184:187]
    v_exp_f32_e64 v75, v75 clamp
    v_mfma_f32_16x16x32_bf16 v[232:235], a[216:219], v[28:31], v[232:235]
    v_exp_f32_e64 v62, v62 clamp
    v_mfma_f32_16x16x32_bf16 a[24:27], a[216:219], v[32:35], a[24:27]
    s_waitcnt lgkmcnt(6)
    v_fma_f32 v68, v68, s28, v11
    v_fma_f32 v79, v79, s28, v12
    v_mfma_f32_16x16x32_bf16 a[28:31], a[220:223], v[32:35], a[28:31]
    v_exp_f32_e64 v66, v66 clamp
    v_mfma_f32_16x16x32_bf16 v[236:239], a[220:223], v[28:31], v[236:239]
    v_exp_f32_e64 v83, v83 clamp
    v_mfma_f32_16x16x32_bf16 v[188:191], a[220:223], v[20:23], v[188:191]
    v_exp_f32_e64 v68, v68 clamp
    v_mfma_f32_16x16x32_bf16 v[140:143], a[220:223], v[16:19], v[140:143]
    v_exp_f32_e64 v56, v56 clamp
    v_mfma_f32_16x16x32_bf16 v[144:147], a[224:227], v[16:19], v[144:147]
    s_add_u32 s39, s39, 12288
    v_mfma_f32_16x16x32_bf16 v[192:195], a[224:227], v[20:23], v[192:195]
    v_exp_f32_e64 v70, v70 clamp
    v_mfma_f32_16x16x32_bf16 v[240:243], a[224:227], v[28:31], v[240:243]
    s_waitcnt vmcnt(10) lgkmcnt(0)
    s_add_u32 m0, s22, 36864
    v_mfma_f32_16x16x32_bf16 a[32:35], a[224:227], v[32:35], a[32:35]
    s_barrier
    v_mfma_f32_16x16x32_bf16 a[36:39], a[228:231], v[32:35], a[36:39]
    ds_read_b128 a[216:219], v0 offset:12288
    v_fma_f32 v82, v82, s28, v12
    v_mfma_f32_16x16x32_bf16 v[244:247], a[228:231], v[28:31], v[244:247]
    buffer_load_dwordx4 v6, s[8:11], s21 offen lds
    v_mfma_f32_16x16x32_bf16 v[196:199], a[228:231], v[20:23], v[196:199]
    ds_read_b128 a[220:223], v1 offset:12288
    v_fma_f32 v77, v77, s28, v12
    v_mfma_f32_16x16x32_bf16 v[148:151], a[228:231], v[16:19], v[148:151]
    s_add_u32 s21, s21, 128
    s_add_u32 m0, s22, 37888
    ds_read_b128 a[224:227], v0 offset:13312
    v_mfma_f32_16x16x32_bf16 v[152:155], a[232:235], v[16:19], v[152:155]
    buffer_load_dwordx4 v6, s[8:11], s21 offen lds
    v_mfma_f32_16x16x32_bf16 v[200:203], a[232:235], v[20:23], v[200:203]
    v_exp_f32_e64 v69, v69 clamp
    v_mfma_f32_16x16x32_bf16 v[248:251], a[232:235], v[28:31], v[248:251]
    s_add_u32 s21, s21, 128
    ds_read_b128 a[228:231], v1 offset:13312
    v_cvt_pk_bf16_f32 v27, v70, v71
    v_mfma_f32_16x16x32_bf16 a[40:43], a[232:235], v[32:35], a[40:43]
    v_exp_f32_e64 v80, v80 clamp
    v_mfma_f32_16x16x32_bf16 a[44:47], a[236:239], v[32:35], a[44:47]
    s_add_u32 m0, s22, 38912
    ds_read_b128 a[232:235], v0 offset:14336
    v_mfma_f32_16x16x32_bf16 v[252:255], a[236:239], v[28:31], v[252:255]
    v_exp_f32_e64 v76, v76 clamp
    v_mfma_f32_16x16x32_bf16 v[204:207], a[236:239], v[20:23], v[204:207]
    buffer_load_dwordx4 v6, s[8:11], s21 offen lds
    v_mfma_f32_16x16x32_bf16 v[156:159], a[236:239], v[16:19], v[156:159]
    s_waitcnt lgkmcnt(4)
    v_exp_f32_e64 v77, v77 clamp
    v_mfma_f32_16x16x32_bf16 v[52:55], a[216:219], a[96:99], 0
    s_waitcnt lgkmcnt(3)
    v_exp_f32_e64 v79, v79 clamp
    v_mfma_f32_16x16x32_bf16 v[52:55], a[220:223], a[100:103], v[52:55]
    s_waitcnt lgkmcnt(2)
    v_cvt_pk_bf16_f32 v23, v62, v63
    v_cvt_pk_bf16_f32 v22, v60, v61
    v_mfma_f32_16x16x32_bf16 v[52:55], a[224:227], a[104:107], v[52:55]
    v_cvt_pk_bf16_f32 v26, v68, v69
    v_fma_f32 v67, v67, s28, v10
    v_mfma_f32_16x16x32_bf16 v[60:63], a[224:227], a[128:131], 0
    ds_read_b128 a[236:239], v1 offset:14336
    v_cvt_pk_bf16_f32 v34, v76, v77
    v_mfma_f32_16x16x32_bf16 v[60:63], a[220:223], a[124:127], v[60:63]
    v_fma_f32 v78, v78, s28, v12
    v_mfma_f32_16x16x32_bf16 v[60:63], a[216:219], a[120:123], v[60:63]
    v_exp_f32_e64 v78, v78 clamp
    v_mfma_f32_16x16x32_bf16 v[68:71], a[216:219], a[144:147], 0
    v_exp_f32_e64 v73, v73 clamp
    v_mfma_f32_16x16x32_bf16 v[68:71], a[220:223], a[148:151], v[68:71]
    buffer_store_dwordx4 v[88:91], v38, s[16:19], s24 offen offset:0 nt
    v_exp_f32_e64 v82, v82 clamp
    v_cvt_pk_bf16_f32 v35, v78, v79
    v_mfma_f32_16x16x32_bf16 v[68:71], a[224:227], a[152:155], v[68:71]
    v_exp_f32_e64 v59, v59 clamp
    v_mfma_f32_16x16x32_bf16 v[76:79], a[224:227], a[176:179], 0
    v_cvt_pk_bf16_f32 v36, v80, v81
    v_mfma_f32_16x16x32_bf16 v[76:79], a[220:223], a[172:175], v[76:79]
    s_add_u32 s21, s21, 12032
    ds_read_b128 a[224:227], v0 offset:19456
    v_cvt_pk_bf16_f32 v29, v74, v75
    v_mfma_f32_16x16x32_bf16 v[76:79], a[216:219], a[168:171], v[76:79]
    s_waitcnt lgkmcnt(2)
    v_exp_f32_e64 v58, v58 clamp
    v_mfma_f32_16x16x32_bf16 v[76:79], a[228:231], a[180:183], v[76:79]
    ds_read_b128 a[220:223], v1 offset:18432
    v_mfma_f32_16x16x32_bf16 v[76:79], a[232:235], a[184:187], v[76:79]
    s_waitcnt lgkmcnt(2)
    v_exp_f32_e64 v57, v57 clamp
    v_mfma_f32_16x16x32_bf16 v[76:79], a[236:239], a[188:191], v[76:79]
    s_add_u32 m0, s23, 0
    ds_read_b128 a[216:219], v0 offset:18432
    v_cvt_pk_bf16_f32 v17, v58, v59
    v_mfma_f32_16x16x32_bf16 v[68:71], a[236:239], a[164:167], v[68:71]
    buffer_load_dwordx4 v38, s[12:15], s25 offen nt lds
    v_mfma_f32_16x16x32_bf16 v[68:71], a[232:235], a[160:163], v[68:71]
    v_exp_f32_e64 v64, v64 clamp
    v_mfma_f32_16x16x32_bf16 v[68:71], a[228:231], a[156:159], v[68:71]
    v_cvt_pk_bf16_f32 v28, v72, v73
    v_mfma_f32_16x16x32_bf16 v[60:63], a[228:231], a[132:135], v[60:63]
    v_cvt_pk_bf16_f32 v37, v82, v83
    v_cvt_pk_bf16_f32 v16, v56, v57
    v_mfma_f32_16x16x32_bf16 v[60:63], a[232:235], a[136:139], v[60:63]
    v_exp_f32_e64 v67, v67 clamp
    v_mfma_f32_16x16x32_bf16 v[60:63], a[236:239], a[140:143], v[60:63]
    v_exp_f32_e64 v65, v65 clamp
    v_mfma_f32_16x16x32_bf16 v[52:55], a[236:239], a[116:119], v[52:55]
    s_bitcmp1_b32 s27, 0
    ds_read_b128 a[236:239], v1 offset:20480
    s_cselect_b32 s26, s49, 128
    v_mfma_f32_16x16x32_bf16 v[52:55], a[232:235], a[112:115], v[52:55]
    ds_read_b128 a[232:235], v0 offset:20480
    v_cvt_pk_bf16_f32 v24, v64, v65
    v_mfma_f32_16x16x32_bf16 v[52:55], a[228:231], a[108:111], v[52:55]
    ds_read_b128 a[228:231], v1 offset:19456
    v_cvt_pk_bf16_f32 v25, v66, v67
    v_mfma_f32_16x16x32_bf16 v[44:47], a[248:251], v[14:17], v[44:47]
    s_waitcnt lgkmcnt(3)
    v_mfma_f32_16x16x32_bf16 v[56:59], a[216:219], a[96:99], 0
    ds_read_b128 v[84:87], v103 offset:2048
    v_smfmac_f32_16x16x64_bf16 v[44:47], a[240:243], v[22:29], v101
    v_mfma_f32_16x16x32_bf16 v[56:59], a[220:223], a[100:103], v[56:59]
    v_mfma_f32_16x16x32_bf16 v[44:47], a[252:255], v[34:37], v[44:47]
    v_mfma_f32_16x16x32_bf16 v[56:59], a[224:227], a[104:107], v[56:59]
    s_bitcmp1_b32 s89, 0
    s_cselect_b32 s26, s26, 0
    v_mfma_f32_16x16x32_bf16 v[64:67], a[224:227], a[128:131], 0
    s_lshr_b32 s89, s89, 1
    v_mfma_f32_16x16x32_bf16 v[64:67], a[220:223], a[124:127], v[64:67]
    s_lshr_b32 s27, s27, 1
    ds_read_b128 v[96:99], v103 offset:1024
    v_cmp_lt_f32 vcc, s29, v44
    v_mfma_f32_16x16x32_bf16 v[64:67], a[216:219], a[120:123], v[64:67]
    s_add_u32 s24, s24, s26
    s_add_u32 s25, s25, s26
    s_waitcnt vmcnt(10) lgkmcnt(2)
    v_mfma_f32_16x16x32_bf16 v[72:75], a[216:219], a[144:147], 0
    s_barrier
    v_mfma_f32_16x16x32_bf16 v[72:75], a[220:223], a[148:151], v[72:75]
    s_cbranch_vccnz L_rs_loop4w0a
L_ret_loop4w0a:
    s_add_u32 m0, s22, 12288
    v_mfma_f32_16x16x32_bf16 v[72:75], a[224:227], a[152:155], v[72:75]
    buffer_load_dwordx4 v6, s[4:7], s20 offen lds
    v_mfma_f32_16x16x32_bf16 v[80:83], a[224:227], a[176:179], 0
    v_fma_f32 v53, v53, s28, v9
    v_fma_f32 v55, v55, s28, v9
    v_mfma_f32_16x16x32_bf16 v[80:83], a[220:223], a[172:175], v[80:83]
    s_add_u32 s20, s20, 128
    v_mfma_f32_16x16x32_bf16 v[80:83], a[216:219], a[168:171], v[80:83]
    s_add_u32 m0, s22, 13312
    ds_read_b64_tr_b16 a[216:217], v2 offset:0
    v_fma_f32 v79, v79, s28, v12
    v_mfma_f32_16x16x32_bf16 v[80:83], a[228:231], a[180:183], v[80:83]
    ds_read_b64_tr_b16 a[218:219], v2 offset:6144
    v_fma_f32 v77, v77, s28, v12
    v_mfma_f32_16x16x32_bf16 v[80:83], a[232:235], a[184:187], v[80:83]
    buffer_load_dwordx4 v6, s[4:7], s20 offen lds
    v_mfma_f32_16x16x32_bf16 v[80:83], a[236:239], a[188:191], v[80:83]
    v_fma_f32 v52, v52, s28, v9
    v_fma_f32 v63, v63, s28, v10
    v_mfma_f32_16x16x32_bf16 v[72:75], a[236:239], a[164:167], v[72:75]
    s_add_u32 s20, s20, 128
    ds_read_b64_tr_b16 a[220:221], v3 offset:0
    s_add_u32 m0, s22, 14336
    v_mfma_f32_16x16x32_bf16 v[72:75], a[232:235], a[160:163], v[72:75]
    buffer_load_dwordx4 v6, s[4:7], s20 offen lds
    v_mfma_f32_16x16x32_bf16 v[72:75], a[228:231], a[156:159], v[72:75]
    ds_read_b64_tr_b16 a[222:223], v3 offset:6144
    v_fma_f32 v83, v83, s28, v12
    v_mfma_f32_16x16x32_bf16 v[64:67], a[228:231], a[132:135], v[64:67]
    v_exp_f32_e64 v53, v53 clamp
    v_mfma_f32_16x16x32_bf16 v[64:67], a[232:235], a[136:139], v[64:67]
    ds_read_b64_tr_b16 a[224:225], v4 offset:0
    v_fma_f32 v68, v68, s28, v11
    v_mfma_f32_16x16x32_bf16 v[64:67], a[236:239], a[140:143], v[64:67]
    v_fma_f32 v70, v70, s28, v11
    v_fma_f32 v76, v76, s28, v12
    v_mfma_f32_16x16x32_bf16 v[56:59], a[236:239], a[116:119], v[56:59]
    ds_read_b64_tr_b16 a[226:227], v4 offset:6144
    v_fma_f32 v73, v73, s28, v11
    v_mfma_f32_16x16x32_bf16 v[56:59], a[232:235], a[112:115], v[56:59]
    ds_read_b64_tr_b16 a[232:233], v2 offset:1024
    v_fma_f32 v61, v61, s28, v10
    v_mfma_f32_16x16x32_bf16 v[56:59], a[228:231], a[108:111], v[56:59]
    s_waitcnt lgkmcnt(5)
    v_exp_f32_e64 v52, v52 clamp
    v_mfma_f32_16x16x32_bf16 v[112:115], a[216:219], v[14:17], v[112:115]
    ds_read_b64_tr_b16 a[234:235], v2 offset:7168
    v_fma_f32 v54, v54, s28, v9
    v_mfma_f32_16x16x32_bf16 v[160:163], a[216:219], v[22:25], v[160:163]
    v_exp_f32_e64 v83, v83 clamp
    v_mfma_f32_16x16x32_bf16 v[208:211], a[216:219], v[26:29], v[208:211]
    ds_read_b64_tr_b16 a[228:229], v5 offset:0
    v_fma_f32 v82, v82, s28, v12
    v_mfma_f32_16x16x32_bf16 a[0:3], a[216:219], v[34:37], a[0:3]
    s_waitcnt lgkmcnt(5)
    ds_read_b64_tr_b16 a[230:231], v5 offset:6144
    v_fma_f32 v57, v57, s28, v9
    v_mfma_f32_16x16x32_bf16 a[4:7], a[220:223], v[34:37], a[4:7]
    buffer_store_dwordx4 v[96:99], v39, s[16:19], s24 offen offset:0 nt
    ds_read_b64_tr_b16 a[238:239], v3 offset:7168
    v_fma_f32 v62, v62, s28, v10
    v_mfma_f32_16x16x32_bf16 v[212:215], a[220:223], v[26:29], v[212:215]
    ds_read_b64_tr_b16 a[218:219], v4 offset:7168
    v_fma_f32 v69, v69, s28, v11
    v_mfma_f32_16x16x32_bf16 v[164:167], a[220:223], v[22:25], v[164:167]
    v_fma_f32 v56, v56, s28, v9
    v_fma_f32 v58, v58, s28, v9
    v_mfma_f32_16x16x32_bf16 v[116:119], a[220:223], v[14:17], v[116:119]
    s_waitcnt lgkmcnt(5)
    ds_read_b64_tr_b16 a[236:237], v3 offset:1024
    v_fma_f32 v60, v60, s28, v10
    v_mfma_f32_16x16x32_bf16 v[120:123], a[224:227], v[14:17], v[120:123]
    ds_read_b64_tr_b16 a[216:217], v4 offset:1024
    v_fma_f32 v65, v65, s28, v10
    v_mfma_f32_16x16x32_bf16 v[168:171], a[224:227], v[22:25], v[168:171]
    s_add_u32 s20, s20, 12032
    v_exp_f32_e64 v60, v60 clamp
    v_mfma_f32_16x16x32_bf16 v[216:219], a[224:227], v[26:29], v[216:219]
    s_add_u32 s39, s39, 12288
    v_exp_f32_e64 v69, v69 clamp
    v_mfma_f32_16x16x32_bf16 a[8:11], a[224:227], v[34:37], a[8:11]
    ds_read_b64_tr_b16 a[220:221], v5 offset:1024
    s_waitcnt lgkmcnt(5)
    v_mfma_f32_16x16x32_bf16 a[12:15], a[228:231], v[34:37], a[12:15]
    ds_read_b64_tr_b16 a[222:223], v5 offset:7168
    v_fma_f32 v67, v67, s28, v10
    v_mfma_f32_16x16x32_bf16 v[220:223], a[228:231], v[26:29], v[220:223]
    ds_read_b64_tr_b16 a[226:227], v2 offset:8192
    v_cvt_pk_bf16_f32 v18, v52, v53
    v_mfma_f32_16x16x32_bf16 v[172:175], a[228:231], v[22:25], v[172:175]
    s_add_u32 m0, s23, 1024
    v_exp_f32_e64 v70, v70 clamp
    v_mfma_f32_16x16x32_bf16 v[124:127], a[228:231], v[14:17], v[124:127]
    buffer_load_dwordx4 v39, s[12:15], s25 offen nt lds
    v_mfma_f32_16x16x32_bf16 v[128:131], a[232:235], v[14:17], v[128:131]
    s_bitcmp1_b32 s27, 0
    ds_read_b64_tr_b16 a[224:225], v2 offset:2048
    v_fma_f32 v59, v59, s28, v9
    v_mfma_f32_16x16x32_bf16 v[176:179], a[232:235], v[22:25], v[176:179]
    ds_read_b64_tr_b16 a[230:231], v3 offset:8192
    v_fma_f32 v71, v71, s28, v11
    v_mfma_f32_16x16x32_bf16 v[224:227], a[232:235], v[26:29], v[224:227]
    v_exp_f32_e64 v63, v63 clamp
    v_mfma_f32_16x16x32_bf16 a[16:19], a[232:235], v[34:37], a[16:19]
    s_waitcnt lgkmcnt(5)
    ds_read_b64_tr_b16 a[228:229], v3 offset:2048
    v_fma_f32 v78, v78, s28, v12
    v_mfma_f32_16x16x32_bf16 a[20:23], a[236:239], v[34:37], a[20:23]
    ds_read_b64_tr_b16 a[232:233], v4 offset:2048
    v_fma_f32 v72, v72, s28, v11
    v_mfma_f32_16x16x32_bf16 v[228:231], a[236:239], v[26:29], v[228:231]
    v_exp_f32_e64 v68, v68 clamp
    v_mfma_f32_16x16x32_bf16 v[180:183], a[236:239], v[22:25], v[180:183]
    s_cselect_b32 s26, s49, 128
    ds_read_b64_tr_b16 a[234:235], v4 offset:8192
    v_cvt_pk_bf16_f32 v30, v68, v69
    v_mfma_f32_16x16x32_bf16 v[132:135], a[236:239], v[14:17], v[132:135]
    s_bitcmp1_b32 s89, 0
    ds_read_b64_tr_b16 a[236:237], v5 offset:2048
    v_fma_f32 v81, v81, s28, v12
    v_mfma_f32_16x16x32_bf16 v[136:139], a[216:219], v[14:17], v[136:139]
    ds_read_b64_tr_b16 a[238:239], v5 offset:8192
    v_fma_f32 v74, v74, s28, v11
    v_mfma_f32_16x16x32_bf16 v[184:187], a[216:219], v[22:25], v[184:187]
    v_exp_f32_e64 v76, v76 clamp
    v_mfma_f32_16x16x32_bf16 v[232:235], a[216:219], v[26:29], v[232:235]
    v_exp_f32_e64 v67, v67 clamp
    v_mfma_f32_16x16x32_bf16 a[24:27], a[216:219], v[34:37], a[24:27]
    s_waitcnt lgkmcnt(5)
    v_exp_f32_e64 v71, v71 clamp
    v_mfma_f32_16x16x32_bf16 a[28:31], a[220:223], v[34:37], a[28:31]
    s_cselect_b32 s26, s26, 0
    v_exp_f32_e64 v55, v55 clamp
    v_mfma_f32_16x16x32_bf16 v[236:239], a[220:223], v[26:29], v[236:239]
    v_exp_f32_e64 v61, v61 clamp
    v_mfma_f32_16x16x32_bf16 v[188:191], a[220:223], v[22:25], v[188:191]
    s_lshr_b32 s89, s89, 1
    v_exp_f32_e64 v59, v59 clamp
    v_mfma_f32_16x16x32_bf16 v[140:143], a[220:223], v[14:17], v[140:143]
    s_lshr_b32 s27, s27, 1
    v_exp_f32_e64 v54, v54 clamp
    v_mfma_f32_16x16x32_bf16 v[144:147], a[224:227], v[14:17], v[144:147]
    s_add_u32 s24, s24, s26
    v_exp_f32_e64 v57, v57 clamp
    v_mfma_f32_16x16x32_bf16 v[192:195], a[224:227], v[22:25], v[192:195]
    s_add_u32 s25, s25, s26
    v_exp_f32_e64 v77, v77 clamp
    v_mfma_f32_16x16x32_bf16 v[240:243], a[224:227], v[26:29], v[240:243]
    s_waitcnt vmcnt(10) lgkmcnt(0)
    v_fma_f32 v80, v80, s28, v12
    v_mfma_f32_16x16x32_bf16 a[32:35], a[224:227], v[34:37], a[32:35]
    s_barrier
    v_mfma_f32_16x16x32_bf16 a[36:39], a[228:231], v[34:37], a[36:39]
    s_add_u32 m0, s22, 24576
    ds_read_b128 a[216:219], v0 offset:0
    v_cvt_pk_bf16_f32 v19, v54, v55
    v_mfma_f32_16x16x32_bf16 v[244:247], a[228:231], v[26:29], v[244:247]
    ds_read_b128 a[220:223], v1 offset:0
    v_cvt_pk_bf16_f32 v31, v70, v71
    v_mfma_f32_16x16x32_bf16 v[196:199], a[228:231], v[22:25], v[196:199]
    buffer_load_dwordx4 v6, s[8:11], s21 offen lds
    v_mfma_f32_16x16x32_bf16 v[148:151], a[228:231], v[14:17], v[148:151]
    s_add_u32 s21, s21, 128
    s_add_u32 m0, s22, 25600
    ds_read_b128 a[224:227], v0 offset:1024
    v_mfma_f32_16x16x32_bf16 v[152:155], a[232:235], v[14:17], v[152:155]
    buffer_load_dwordx4 v6, s[8:11], s21 offen lds
    v_mfma_f32_16x16x32_bf16 v[200:203], a[232:235], v[22:25], v[200:203]
    s_add_u32 s21, s21, 128
    v_exp_f32_e64 v72, v72 clamp
    v_mfma_f32_16x16x32_bf16 v[248:251], a[232:235], v[26:29], v[248:251]
    s_add_u32 m0, s22, 26624
    v_exp_f32_e64 v62, v62 clamp
    v_mfma_f32_16x16x32_bf16 a[40:43], a[232:235], v[34:37], a[40:43]
    v_exp_f32_e64 v56, v56 clamp
    v_mfma_f32_16x16x32_bf16 a[44:47], a[236:239], v[34:37], a[44:47]
    buffer_load_dwordx4 v6, s[8:11], s21 offen lds
    v_mfma_f32_16x16x32_bf16 v[252:255], a[236:239], v[26:29], v[252:255]
    v_exp_f32_e64 v79, v79 clamp
    v_mfma_f32_16x16x32_bf16 v[204:207], a[236:239], v[22:25], v[204:207]
    ds_read_b128 a[232:235], v0 offset:2048
    v_cvt_pk_bf16_f32 v23, v62, v63
    v_mfma_f32_16x16x32_bf16 v[156:159], a[236:239], v[14:17], v[156:159]
    s_waitcnt lgkmcnt(2)
    ds_read_b128 a[236:239], v1 offset:2048
    v_cvt_pk_bf16_f32 v22, v60, v61
    v_mfma_f32_16x16x32_bf16 v[52:55], a[216:219], a[96:99], 0
    v_exp_f32_e64 v74, v74 clamp
    v_mfma_f32_16x16x32_bf16 v[52:55], a[220:223], a[100:103], v[52:55]
    s_waitcnt lgkmcnt(2)
    v_exp_f32_e64 v78, v78 clamp
    v_mfma_f32_16x16x32_bf16 v[52:55], a[224:227], a[104:107], v[52:55]
    ds_read_b128 a[228:231], v1 offset:1024
    v_cvt_pk_bf16_f32 v35, v78, v79
    v_mfma_f32_16x16x32_bf16 v[60:63], a[224:227], a[128:131], 0
    v_exp_f32_e64 v65, v65 clamp
    v_mfma_f32_16x16x32_bf16 v[60:63], a[220:223], a[124:127], v[60:63]
    s_add_u32 s21, s21, 12032
    v_fma_f32 v66, v66, s28, v10
    v_mfma_f32_16x16x32_bf16 v[60:63], a[216:219], a[120:123], v[60:63]
    v_exp_f32_e64 v73, v73 clamp
    v_mfma_f32_16x16x32_bf16 v[68:71], a[216:219], a[144:147], 0
    v_fma_f32 v64, v64, s28, v10
    v_cvt_pk_bf16_f32 v34, v76, v77
    v_mfma_f32_16x16x32_bf16 v[68:71], a[220:223], a[148:151], v[68:71]
    buffer_store_dwordx4 v[84:87], v38, s[16:19], s24 offen offset:0 nt
    v_exp_f32_e64 v66, v66 clamp
    v_mfma_f32_16x16x32_bf16 v[68:71], a[224:227], a[152:155], v[68:71]
    v_exp_f32_e64 v64, v64 clamp
    v_mfma_f32_16x16x32_bf16 v[76:79], a[224:227], a[176:179], 0
    v_exp_f32_e64 v80, v80 clamp
    v_mfma_f32_16x16x32_bf16 v[76:79], a[220:223], a[172:175], v[76:79]
    s_add_u32 m0, s23, 2048
    v_exp_f32_e64 v58, v58 clamp
    v_mfma_f32_16x16x32_bf16 v[76:79], a[216:219], a[168:171], v[76:79]
    s_waitcnt lgkmcnt(0)
    ds_read_b128 a[216:219], v0 offset:6144
    v_cvt_pk_bf16_f32 v17, v58, v59
    v_mfma_f32_16x16x32_bf16 v[76:79], a[228:231], a[180:183], v[76:79]
    v_exp_f32_e64 v81, v81 clamp
    v_mfma_f32_16x16x32_bf16 v[76:79], a[232:235], a[184:187], v[76:79]
    buffer_load_dwordx4 v38, s[12:15], s25 offen nt lds
    v_mfma_f32_16x16x32_bf16 v[76:79], a[236:239], a[188:191], v[76:79]
    v_cvt_pk_bf16_f32 v28, v72, v73
    v_fma_f32 v75, v75, s28, v11
    v_mfma_f32_16x16x32_bf16 v[68:71], a[236:239], a[164:167], v[68:71]
    s_bitcmp1_b32 s27, 0
    ds_read_b128 a[220:223], v1 offset:6144
    s_cselect_b32 s26, s49, 128
    v_mfma_f32_16x16x32_bf16 v[68:71], a[232:235], a[160:163], v[68:71]
    ds_read_b128 a[224:227], v0 offset:7168
    v_add_u32 v103, 3072, v103
    v_mfma_f32_16x16x32_bf16 v[68:71], a[228:231], a[156:159], v[68:71]
    v_exp_f32_e64 v82, v82 clamp
    v_mfma_f32_16x16x32_bf16 v[60:63], a[228:231], a[132:135], v[60:63]
    s_bitcmp1_b32 s89, 0
    v_cvt_pk_bf16_f32 v32, v80, v81
    v_cvt_pk_bf16_f32 v33, v82, v83
    v_mfma_f32_16x16x32_bf16 v[60:63], a[232:235], a[136:139], v[60:63]
    v_exp_f32_e64 v75, v75 clamp
    v_mfma_f32_16x16x32_bf16 v[60:63], a[236:239], a[140:143], v[60:63]
    v_cvt_pk_bf16_f32 v29, v74, v75
    v_cvt_pk_bf16_f32 v16, v56, v57
    v_mfma_f32_16x16x32_bf16 v[52:55], a[236:239], a[116:119], v[52:55]
    ds_read_b128 a[236:239], v1 offset:8192
    v_cvt_pk_bf16_f32 v21, v66, v67
    v_mfma_f32_16x16x32_bf16 v[52:55], a[232:235], a[112:115], v[52:55]
    ds_read_b128 a[232:235], v0 offset:8192
    v_cvt_pk_bf16_f32 v20, v64, v65
    v_mfma_f32_16x16x32_bf16 v[52:55], a[228:231], a[108:111], v[52:55]
    ds_read_b128 a[228:231], v1 offset:7168
    v_smfmac_f32_16x16x64_bf16 v[48:51], a[240:243], v[16:23], v101
    s_cselect_b32 s26, s26, 0
    v_smfmac_f32_16x16x64_bf16 v[48:51], a[244:247], v[28:35], v101
    s_lshr_b32 s89, s89, 1
    s_lshr_b32 s27, s27, 1
    s_waitcnt lgkmcnt(4)
    v_mfma_f32_16x16x32_bf16 v[56:59], a[216:219], a[96:99], 0
    s_add_u32 s24, s24, s26
    s_add_u32 s25, s25, s26
    s_add_u32 s23, s23, 3072
    v_mfma_f32_16x16x32_bf16 v[56:59], a[220:223], a[100:103], v[56:59]
    s_waitcnt lgkmcnt(3)
    v_cmp_lt_f32 vcc, s29, v48
    v_mfma_f32_16x16x32_bf16 v[56:59], a[224:227], a[104:107], v[56:59]
    v_swap_b32 v38, v39
    v_mfma_f32_16x16x32_bf16 v[64:67], a[224:227], a[128:131], 0
    s_nop 0
    s_nop 0
    s_cbranch_vccnz L_rs_loop4w0b
L_ret_loop4w0b:
    v_fma_f32 v53, v53, s28, v9
    v_mfma_f32_16x16x32_bf16 v[64:67], a[220:223], a[124:127], v[64:67]
    v_fma_f32 v52, v52, s28, v9
    v_mfma_f32_16x16x32_bf16 v[64:67], a[216:219], a[120:123], v[64:67]
    v_fma_f32 v60, v60, s28, v10
    v_fma_f32 v61, v61, s28, v10
    v_mfma_f32_16x16x32_bf16 v[72:75], a[216:219], a[144:147], 0
    s_waitcnt vmcnt(12) lgkmcnt(0)
    s_cmp_eq_u32 s30, 5
    v_mfma_f32_16x16x32_bf16 v[72:75], a[220:223], a[148:151], v[72:75]
    s_barrier
    v_mfma_f32_16x16x32_bf16 v[72:75], a[224:227], a[152:155], v[72:75]
    s_cselect_b32 s26, s62, 0
    s_add_u32 s20, s20, s26
    s_add_u32 m0, s22, 0
    v_mfma_f32_16x16x32_bf16 v[80:83], a[224:227], a[176:179], 0
    buffer_load_dwordx4 v6, s[4:7], s20 offen lds
    v_mfma_f32_16x16x32_bf16 v[80:83], a[220:223], a[172:175], v[80:83]
    s_add_u32 s20, s20, 128
    v_exp_f32_e64 v53, v53 clamp
    v_mfma_f32_16x16x32_bf16 v[80:83], a[216:219], a[168:171], v[80:83]
    s_add_u32 m0, s22, 1024
    ds_read_b64_tr_b16 a[216:217], v2 offset:18432
    buffer_load_dwordx4 v6, s[4:7], s20 offen lds
    v_mfma_f32_16x16x32_bf16 v[80:83], a[228:231], a[180:183], v[80:83]
    ds_read_b64_tr_b16 a[218:219], v2 offset:12288
    s_add_u32 s20, s20, 128
    v_mfma_f32_16x16x32_bf16 v[80:83], a[232:235], a[184:187], v[80:83]
    s_add_u32 m0, s22, 2048
    v_exp_f32_e64 v61, v61 clamp
    v_mfma_f32_16x16x32_bf16 v[80:83], a[236:239], a[188:191], v[80:83]
    buffer_load_dwordx4 v6, s[4:7], s20 offen lds
    v_mfma_f32_16x16x32_bf16 v[72:75], a[236:239], a[164:167], v[72:75]
    v_exp_f32_e64 v60, v60 clamp
    v_mfma_f32_16x16x32_bf16 v[72:75], a[232:235], a[160:163], v[72:75]
    ds_read_b64_tr_b16 a[220:221], v3 offset:18432
    v_fma_f32 v54, v54, s28, v9
    v_mfma_f32_16x16x32_bf16 v[72:75], a[228:231], a[156:159], v[72:75]
    s_add_u32 s20, s20, 12032
    v_exp_f32_e64 v54, v54 clamp
    v_mfma_f32_16x16x32_bf16 v[64:67], a[228:231], a[132:135], v[64:67]
    ds_read_b64_tr_b16 a[222:223], v3 offset:12288
    v_fma_f32 v55, v55, s28, v9
    v_mfma_f32_16x16x32_bf16 v[64:67], a[232:235], a[136:139], v[64:67]
    v_exp_f32_e64 v55, v55 clamp
    v_mfma_f32_16x16x32_bf16 v[64:67], a[236:239], a[140:143], v[64:67]
    s_add_u32 s30, s30, 1
    v_exp_f32_e64 v52, v52 clamp
    v_mfma_f32_16x16x32_bf16 v[56:59], a[236:239], a[116:119], v[56:59]
    ds_read_b64_tr_b16 a[224:225], v4 offset:18432
    v_cvt_pk_bf16_f32 v14, v52, v53
    v_mfma_f32_16x16x32_bf16 v[56:59], a[232:235], a[112:115], v[56:59]
    s_waitcnt lgkmcnt(3)
    ds_read_b64_tr_b16 a[226:227], v4 offset:12288
    v_cvt_pk_bf16_f32 v15, v54, v55
    v_mfma_f32_16x16x32_bf16 v[56:59], a[228:231], a[108:111], v[56:59]
    s_cmp_lt_u32 s30, 6
    ds_read_b64_tr_b16 a[228:229], v5 offset:18432
    ds_read_b64_tr_b16 a[230:231], v5 offset:12288
    s_cbranch_scc1 L_loop4w0
    s_cmp_ge_u32 s37, 6
    s_cbranch_scc1 L_end4
    s_cmp_eq_u32 s32, 0
    s_cbranch_scc1 L_tr44
    s_branch L_tr45
L_tr45:
    v_mfma_f32_16x16x32_bf16 v[112:115], a[216:219], v[16:19], v[112:115]
    ds_read_b64_tr_b16 a[238:239], v3 offset:13312
    v_fma_f32 v69, v69, s28, v11
    v_mfma_f32_16x16x32_bf16 v[160:163], a[216:219], v[20:23], v[160:163]
    ds_read_b64_tr_b16 a[236:237], v3 offset:19456
    v_fma_f32 v68, v68, s28, v11
    v_mbcnt_lo_u32_b32 v107, -1, 0
    v_mfma_f32_16x16x32_bf16 v[208:211], a[216:219], v[28:31], v[208:211]
    v_fma_f32 v71, v71, s28, v11
    v_mbcnt_hi_u32_b32 v107, -1, v107
    v_mfma_f32_16x16x32_bf16 a[0:3], a[216:219], v[32:35], a[0:3]
    ds_read_b64_tr_b16 a[232:233], v2 offset:19456
    s_waitcnt lgkmcnt(7)
    v_mfma_f32_16x16x32_bf16 a[4:7], a[220:223], v[32:35], a[4:7]
    ds_read_b64_tr_b16 a[234:235], v2 offset:13312
    v_and_b32 v106, 15, v107
    v_mfma_f32_16x16x32_bf16 v[212:215], a[220:223], v[28:31], v[212:215]
    s_add_u32 s39, s39, 12288
    v_fma_f32 v63, v63, s28, v10
    v_fma_f32 v66, v66, s28, v10
    v_mfma_f32_16x16x32_bf16 v[164:167], a[220:223], v[20:23], v[164:167]
    ds_read_b64_tr_b16 a[218:219], v4 offset:13312
    v_lshrrev_b32 v107, 4, v107
    v_mfma_f32_16x16x32_bf16 v[116:119], a[220:223], v[16:19], v[116:119]
    s_add_u32 s48, s33, 24576
    v_mul_u32_u24 v106, 384, v106
    s_waitcnt lgkmcnt(7)
    v_mfma_f32_16x16x32_bf16 v[120:123], a[224:227], v[16:19], v[120:123]
    ds_read_b64_tr_b16 a[220:221], v5 offset:19456
    v_lshl_add_u32 v106, v107, 4, v106
    v_mfma_f32_16x16x32_bf16 v[168:171], a[224:227], v[20:23], v[168:171]
    ds_read_b64_tr_b16 a[222:223], v5 offset:13312
    v_fma_f32 v62, v62, s28, v10
    v_mfma_f32_16x16x32_bf16 v[216:219], a[224:227], v[28:31], v[216:219]
    buffer_load_dwordx4 a[208:211], v106, s[12:15], s48 offen offset:256 nt
    v_mfma_f32_16x16x32_bf16 a[8:11], a[224:227], v[32:35], a[8:11]
    s_waitcnt lgkmcnt(5)
    ds_read_b128 v[84:87], v103 offset:2048
    v_fma_f32 v81, v81, s28, v12
    v_mfma_f32_16x16x32_bf16 a[12:15], a[228:231], v[32:35], a[12:15]
    buffer_load_dwordx4 a[212:215], v106, s[12:15], s48 offen offset:320 nt
    v_mfma_f32_16x16x32_bf16 v[220:223], a[228:231], v[28:31], v[220:223]
    ds_read_b64_tr_b16 a[216:217], v4 offset:19456
    v_fma_f32 v79, v79, s28, v12
    v_mfma_f32_16x16x32_bf16 v[172:175], a[228:231], v[20:23], v[172:175]
    v_exp_f32_e64 v68, v68 clamp
    v_mfma_f32_16x16x32_bf16 v[124:127], a[228:231], v[16:19], v[124:127]
    s_waitcnt lgkmcnt(5)
    ds_read_b64_tr_b16 a[228:229], v3 offset:20480
    v_fma_f32 v70, v70, s28, v11
    v_mfma_f32_16x16x32_bf16 v[128:131], a[232:235], v[16:19], v[128:131]
    v_fma_f32 v80, v80, s28, v12
    v_fma_f32 v72, v72, s28, v11
    v_mfma_f32_16x16x32_bf16 v[176:179], a[232:235], v[20:23], v[176:179]
    ds_read_b64_tr_b16 a[230:231], v3 offset:14336
    v_fma_f32 v59, v59, s28, v9
    v_mfma_f32_16x16x32_bf16 v[224:227], a[232:235], v[28:31], v[224:227]
    ds_read_b64_tr_b16 a[226:227], v2 offset:14336
    v_fma_f32 v78, v78, s28, v12
    v_mfma_f32_16x16x32_bf16 a[16:19], a[232:235], v[32:35], a[16:19]
    ds_read_b64_tr_b16 a[224:225], v2 offset:20480
    v_fma_f32 v56, v56, s28, v9
    v_mfma_f32_16x16x32_bf16 a[20:23], a[236:239], v[32:35], a[20:23]
    ds_read_b64_tr_b16 a[232:233], v4 offset:20480
    v_fma_f32 v77, v77, s28, v12
    v_mfma_f32_16x16x32_bf16 v[228:231], a[236:239], v[28:31], v[228:231]
    v_exp_f32_e64 v71, v71 clamp
    v_mfma_f32_16x16x32_bf16 v[180:183], a[236:239], v[20:23], v[180:183]
    ds_read_b64_tr_b16 a[234:235], v4 offset:14336
    v_fma_f32 v57, v57, s28, v9
    v_mfma_f32_16x16x32_bf16 v[132:135], a[236:239], v[16:19], v[132:135]
    s_waitcnt lgkmcnt(6)
    ds_read_b64_tr_b16 a[236:237], v5 offset:20480
    v_fma_f32 v75, v75, s28, v11
    v_mfma_f32_16x16x32_bf16 v[136:139], a[216:219], v[16:19], v[136:139]
    v_fma_f32 v74, v74, s28, v11
    v_fma_f32 v58, v58, s28, v9
    v_mfma_f32_16x16x32_bf16 v[184:187], a[216:219], v[20:23], v[184:187]
    ds_read_b64_tr_b16 a[238:239], v5 offset:14336
    v_fma_f32 v76, v76, s28, v12
    v_mfma_f32_16x16x32_bf16 v[232:235], a[216:219], v[28:31], v[232:235]
    v_exp_f32_e64 v69, v69 clamp
    v_mfma_f32_16x16x32_bf16 a[24:27], a[216:219], v[32:35], a[24:27]
    v_exp_f32_e64 v62, v62 clamp
    v_mfma_f32_16x16x32_bf16 a[28:31], a[220:223], v[32:35], a[28:31]
    v_exp_f32_e64 v79, v79 clamp
    v_mfma_f32_16x16x32_bf16 v[236:239], a[220:223], v[28:31], v[236:239]
    ds_read_b128 v[96:99], v103 offset:1024
    v_exp_f32_e64 v58, v58 clamp
    v_mfma_f32_16x16x32_bf16 v[188:191], a[220:223], v[20:23], v[188:191]
    v_exp_f32_e64 v63, v63 clamp
    v_mfma_f32_16x16x32_bf16 v[140:143], a[220:223], v[16:19], v[140:143]
    s_waitcnt lgkmcnt(4)
    v_fma_f32 v73, v73, s28, v11
    v_exp_f32_e64 v78, v78 clamp
    v_mfma_f32_16x16x32_bf16 v[144:147], a[224:227], v[16:19], v[144:147]
    v_exp_f32_e64 v59, v59 clamp
    v_mfma_f32_16x16x32_bf16 v[192:195], a[224:227], v[20:23], v[192:195]
    v_exp_f32_e64 v73, v73 clamp
    v_mfma_f32_16x16x32_bf16 v[240:243], a[224:227], v[28:31], v[240:243]
    ds_read_b128 v[88:91], v103 offset:0
    s_waitcnt vmcnt(12) lgkmcnt(2)
    v_mfma_f32_16x16x32_bf16 a[32:35], a[224:227], v[32:35], a[32:35]
    s_barrier
    v_mfma_f32_16x16x32_bf16 a[36:39], a[228:231], v[32:35], a[36:39]
    ds_read_b128 a[220:223], v1 offset:12288
    v_fma_f32 v83, v83, s28, v12
    v_mfma_f32_16x16x32_bf16 v[244:247], a[228:231], v[28:31], v[244:247]
    s_add_u32 m0, s22, 36864
    ds_read_b128 a[216:219], v0 offset:12288
    v_fma_f32 v67, v67, s28, v10
    v_mfma_f32_16x16x32_bf16 v[196:199], a[228:231], v[20:23], v[196:199]
    buffer_load_dwordx4 v6, s[8:11], s21 offen lds
    v_mfma_f32_16x16x32_bf16 v[148:151], a[228:231], v[16:19], v[148:151]
    v_exp_f32_e64 v74, v74 clamp
    v_mfma_f32_16x16x32_bf16 v[152:155], a[232:235], v[16:19], v[152:155]
    s_add_u32 s21, s21, 128
    ds_read_b128 a[224:227], v0 offset:13312
    v_fma_f32 v82, v82, s28, v12
    v_mfma_f32_16x16x32_bf16 v[200:203], a[232:235], v[20:23], v[200:203]
    s_add_u32 m0, s22, 37888
    v_exp_f32_e64 v77, v77 clamp
    v_mfma_f32_16x16x32_bf16 v[248:251], a[232:235], v[28:31], v[248:251]
    buffer_load_dwordx4 v6, s[8:11], s21 offen lds
    v_mfma_f32_16x16x32_bf16 a[40:43], a[232:235], v[32:35], a[40:43]
    s_add_u32 s21, s21, 128
    v_exp_f32_e64 v76, v76 clamp
    v_mfma_f32_16x16x32_bf16 a[44:47], a[236:239], v[32:35], a[44:47]
    s_add_u32 m0, s22, 38912
    v_exp_f32_e64 v67, v67 clamp
    v_mfma_f32_16x16x32_bf16 v[252:255], a[236:239], v[28:31], v[252:255]
    buffer_load_dwordx4 v6, s[8:11], s21 offen lds
    v_cvt_pk_bf16_f32 v26, v68, v69
    v_mfma_f32_16x16x32_bf16 v[204:207], a[236:239], v[20:23], v[204:207]
    ds_read_b128 a[228:231], v1 offset:13312
    v_cvt_pk_bf16_f32 v23, v62, v63
    v_mfma_f32_16x16x32_bf16 v[156:159], a[236:239], v[16:19], v[156:159]
    s_waitcnt lgkmcnt(2)
    ds_read_b128 a[232:235], v0 offset:14336
    v_fma_f32 v65, v65, s28, v10
    v_mfma_f32_16x16x32_bf16 v[52:55], a[216:219], a[96:99], 0
    buffer_store_dwordx4 v[88:91], v6, s[16:19], s24 offen offset:0 nt
    ds_read_b128 a[236:239], v1 offset:14336
    v_exp_f32_e64 v75, v75 clamp
    v_mfma_f32_16x16x32_bf16 v[52:55], a[220:223], a[100:103], v[52:55]
    s_waitcnt lgkmcnt(3)
    v_cvt_pk_bf16_f32 v35, v78, v79
    v_cvt_pk_bf16_f32 v22, v60, v61
    v_mfma_f32_16x16x32_bf16 v[52:55], a[224:227], a[104:107], v[52:55]
    v_exp_f32_e64 v81, v81 clamp
    v_mfma_f32_16x16x32_bf16 v[60:63], a[224:227], a[128:131], 0
    s_add_u32 s21, s21, 12032
    v_exp_f32_e64 v65, v65 clamp
    v_mfma_f32_16x16x32_bf16 v[60:63], a[220:223], a[124:127], v[60:63]
    v_exp_f32_e64 v70, v70 clamp
    v_mfma_f32_16x16x32_bf16 v[60:63], a[216:219], a[120:123], v[60:63]
    s_add_u32 m0, s38, 24576
    v_cvt_pk_bf16_f32 v34, v76, v77
    v_cvt_pk_bf16_f32 v27, v70, v71
    v_mfma_f32_16x16x32_bf16 v[68:71], a[216:219], a[144:147], 0
    v_exp_f32_e64 v66, v66 clamp
    v_mfma_f32_16x16x32_bf16 v[68:71], a[220:223], a[148:151], v[68:71]
    buffer_load_dwordx4 v6, s[12:15], s25 offen nt lds
    v_mfma_f32_16x16x32_bf16 v[68:71], a[224:227], a[152:155], v[68:71]
    ds_read_b128 v[88:91], v103 offset:3072
    v_fma_f32 v64, v64, s28, v10
    v_mfma_f32_16x16x32_bf16 v[76:79], a[224:227], a[176:179], 0
    s_add_u32 m0, s38, 25600
    v_exp_f32_e64 v72, v72 clamp
    v_mfma_f32_16x16x32_bf16 v[76:79], a[220:223], a[172:175], v[76:79]
    v_exp_f32_e64 v64, v64 clamp
    v_mfma_f32_16x16x32_bf16 v[76:79], a[216:219], a[168:171], v[76:79]
    s_waitcnt lgkmcnt(1)
    ds_read_b128 a[224:227], v0 offset:19456
    v_mfma_f32_16x16x32_bf16 v[76:79], a[228:231], a[180:183], v[76:79]
    buffer_load_dwordx4 v7, s[12:15], s25 offen nt lds
    v_mfma_f32_16x16x32_bf16 v[76:79], a[232:235], a[184:187], v[76:79]
    v_exp_f32_e64 v57, v57 clamp
    v_mfma_f32_16x16x32_bf16 v[76:79], a[236:239], a[188:191], v[76:79]
    v_exp_f32_e64 v56, v56 clamp
    v_mfma_f32_16x16x32_bf16 v[68:71], a[236:239], a[164:167], v[68:71]
    v_cvt_pk_bf16_f32 v28, v72, v73
    v_cvt_pk_bf16_f32 v16, v56, v57
    v_mfma_f32_16x16x32_bf16 v[68:71], a[232:235], a[160:163], v[68:71]
    v_exp_f32_e64 v80, v80 clamp
    v_mfma_f32_16x16x32_bf16 v[68:71], a[228:231], a[156:159], v[68:71]
    v_exp_f32_e64 v82, v82 clamp
    v_mfma_f32_16x16x32_bf16 v[60:63], a[228:231], a[132:135], v[60:63]
    ds_read_b128 a[216:219], v0 offset:18432
    v_cvt_pk_bf16_f32 v24, v64, v65
    v_mfma_f32_16x16x32_bf16 v[60:63], a[232:235], a[136:139], v[60:63]
    ds_read_b128 a[220:223], v1 offset:18432
    v_cvt_pk_bf16_f32 v29, v74, v75
    v_mfma_f32_16x16x32_bf16 v[60:63], a[236:239], a[140:143], v[60:63]
    v_exp_f32_e64 v83, v83 clamp
    v_mfma_f32_16x16x32_bf16 v[52:55], a[236:239], a[116:119], v[52:55]
    s_add_u32 s57, s24, 128
    v_cvt_pk_bf16_f32 v25, v66, v67
    v_cvt_pk_bf16_f32 v36, v80, v81
    v_mfma_f32_16x16x32_bf16 v[52:55], a[232:235], a[112:115], v[52:55]
    ds_read_b128 a[236:239], v1 offset:20480
    v_cvt_pk_bf16_f32 v17, v58, v59
    v_mfma_f32_16x16x32_bf16 v[52:55], a[228:231], a[108:111], v[52:55]
    s_add_u32 s59, s25, 128
    s_add_u32 m0, s38, 26624
    ds_read_b128 a[232:235], v0 offset:20480
    v_mfma_f32_16x16x32_bf16 v[44:47], a[248:251], v[14:17], v[44:47]
    ds_read_b128 a[228:231], v1 offset:19456
    v_smfmac_f32_16x16x64_bf16 v[44:47], a[240:243], v[22:29], v101
    buffer_store_dwordx4 v[96:99], v7, s[16:19], s24 offen offset:0 nt
    v_cvt_pk_bf16_f32 v37, v82, v83
    s_nop 1
    v_mfma_f32_16x16x32_bf16 v[44:47], a[252:255], v[34:37], v[44:47]
    s_waitcnt lgkmcnt(4)
    v_mfma_f32_16x16x32_bf16 v[56:59], a[216:219], a[96:99], 0
    s_waitcnt lgkmcnt(3)
    v_mfma_f32_16x16x32_bf16 v[56:59], a[220:223], a[100:103], v[56:59]
    buffer_load_dwordx4 v6, s[12:15], s59 offen nt lds
    v_mfma_f32_16x16x32_bf16 v[56:59], a[224:227], a[104:107], v[56:59]
    s_nop 1
    v_cmp_lt_f32 vcc, s29, v44
    v_mfma_f32_16x16x32_bf16 v[64:67], a[224:227], a[128:131], 0
    s_add_u32 m0, s38, 27648
    v_mfma_f32_16x16x32_bf16 v[64:67], a[220:223], a[124:127], v[64:67]
    buffer_load_dwordx4 v7, s[12:15], s59 offen nt lds
    v_mfma_f32_16x16x32_bf16 v[64:67], a[216:219], a[120:123], v[64:67]
    buffer_store_dwordx4 v[84:87], v6, s[16:19], s57 offen offset:0 nt
    s_cbranch_vccnz L_rs_tr45a
L_ret_tr45a:
    s_waitcnt vmcnt(15) lgkmcnt(0)
    s_add_u32 m0, s22, 12288
    v_fma_f32 v55, v55, s28, v9
    v_mfma_f32_16x16x32_bf16 v[72:75], a[216:219], a[144:147], 0
    s_barrier
    v_mfma_f32_16x16x32_bf16 v[72:75], a[220:223], a[148:151], v[72:75]
    buffer_load_dwordx4 v6, s[4:7], s20 offen lds
    v_mfma_f32_16x16x32_bf16 v[72:75], a[224:227], a[152:155], v[72:75]
    s_add_u32 s20, s20, 128
    v_exp_f32_e64 v55, v55 clamp
    v_mfma_f32_16x16x32_bf16 v[80:83], a[224:227], a[176:179], 0
    s_add_u32 m0, s22, 13312
    v_fma_f32 v52, v52, s28, v9
    v_mfma_f32_16x16x32_bf16 v[80:83], a[220:223], a[172:175], v[80:83]
    buffer_load_dwordx4 v6, s[4:7], s20 offen lds
    v_mfma_f32_16x16x32_bf16 v[80:83], a[216:219], a[168:171], v[80:83]
    s_add_u32 s20, s20, 128
    ds_read_b64_tr_b16 a[216:217], v2 offset:0
    v_fma_f32 v53, v53, s28, v9
    v_mfma_f32_16x16x32_bf16 v[80:83], a[228:231], a[180:183], v[80:83]
    s_add_u32 m0, s22, 14336
    ds_read_b64_tr_b16 a[218:219], v2 offset:6144
    v_fma_f32 v60, v60, s28, v10
    v_mfma_f32_16x16x32_bf16 v[80:83], a[232:235], a[184:187], v[80:83]
    buffer_load_dwordx4 v6, s[4:7], s20 offen lds
    v_mfma_f32_16x16x32_bf16 v[80:83], a[236:239], a[188:191], v[80:83]
    v_exp_f32_e64 v53, v53 clamp
    v_mfma_f32_16x16x32_bf16 v[72:75], a[236:239], a[164:167], v[72:75]
    v_exp_f32_e64 v60, v60 clamp
    v_mfma_f32_16x16x32_bf16 v[72:75], a[232:235], a[160:163], v[72:75]
    buffer_store_dwordx4 v[88:91], v7, s[16:19], s57 offen offset:0 nt
    s_add_u32 s20, s20, 12032
    ds_read_b64_tr_b16 a[220:221], v3 offset:0
    v_exp_f32_e64 v52, v52 clamp
    v_mfma_f32_16x16x32_bf16 v[72:75], a[228:231], a[156:159], v[72:75]
    v_fma_f32 v54, v54, s28, v9
    v_fma_f32 v61, v61, s28, v10
    v_mfma_f32_16x16x32_bf16 v[64:67], a[228:231], a[132:135], v[64:67]
    ds_read_b64_tr_b16 a[222:223], v3 offset:6144
    v_mfma_f32_16x16x32_bf16 v[64:67], a[232:235], a[136:139], v[64:67]
    v_exp_f32_e64 v61, v61 clamp
    v_mfma_f32_16x16x32_bf16 v[64:67], a[236:239], a[140:143], v[64:67]
    ds_read_b64_tr_b16 a[224:225], v4 offset:0
    v_cvt_pk_bf16_f32 v18, v52, v53
    v_mfma_f32_16x16x32_bf16 v[56:59], a[236:239], a[116:119], v[56:59]
    v_exp_f32_e64 v54, v54 clamp
    v_mfma_f32_16x16x32_bf16 v[56:59], a[232:235], a[112:115], v[56:59]
    ds_read_b64_tr_b16 a[226:227], v4 offset:6144
    v_cvt_pk_bf16_f32 v19, v54, v55
    v_mfma_f32_16x16x32_bf16 v[56:59], a[228:231], a[108:111], v[56:59]
    s_waitcnt lgkmcnt(4)
    ds_read_b64_tr_b16 a[228:229], v5 offset:0
    ds_read_b64_tr_b16 a[230:231], v5 offset:6144
    v_mfma_f32_16x16x32_bf16 v[112:115], a[216:219], v[14:17], v[112:115]
    ds_read_b64_tr_b16 a[234:235], v2 offset:7168
    v_fma_f32 v71, v71, s28, v11
    s_nop 1
    v_fma_f32 v57, v57, s28, v9
    v_mfma_f32_16x16x32_bf16 v[160:163], a[216:219], v[22:25], v[160:163]
    ds_read_b64_tr_b16 a[236:237], v3 offset:1024
    v_fma_f32 v65, v65, s28, v10
    v_fma_f32 v79, v79, s28, v12
    v_mfma_f32_16x16x32_bf16 v[208:211], a[216:219], v[26:29], v[208:211]
    v_exp_f32_e64 v79, v79 clamp
    v_lshrrev_b32 v105, 11, v0
    v_mfma_f32_16x16x32_bf16 a[0:3], a[216:219], v[34:37], a[0:3]
    s_waitcnt lgkmcnt(6)
    v_fma_f32 v59, v59, s28, v9
    v_and_b32 v104, 0x3ff, v0
    v_mfma_f32_16x16x32_bf16 a[4:7], a[220:223], v[34:37], a[4:7]
    ds_read_b64_tr_b16 a[232:233], v2 offset:1024
    v_fma_f32 v58, v58, s28, v9
    v_mfma_f32_16x16x32_bf16 v[212:215], a[220:223], v[26:29], v[212:215]
    ds_read_b64_tr_b16 a[216:217], v4 offset:1024
    v_fma_f32 v82, v82, s28, v12
    v_mfma_f32_16x16x32_bf16 v[164:167], a[220:223], v[22:25], v[164:167]
    v_fma_f32 v62, v62, s28, v10
    v_fma_f32 v83, v83, s28, v12
    v_mfma_f32_16x16x32_bf16 v[116:119], a[220:223], v[14:17], v[116:119]
    s_waitcnt lgkmcnt(6)
    ds_read_b64_tr_b16 a[222:223], v5 offset:7168
    v_fma_f32 v80, v80, s28, v12
    v_fma_f32 v67, v67, s28, v10
    v_mfma_f32_16x16x32_bf16 v[120:123], a[224:227], v[14:17], v[120:123]
    ds_read_b64_tr_b16 a[220:221], v5 offset:1024
    v_exp_f32_e64 v80, v80 clamp
    v_mfma_f32_16x16x32_bf16 v[168:171], a[224:227], v[22:25], v[168:171]
    ds_read_b64_tr_b16 a[238:239], v3 offset:7168
    v_fma_f32 v74, v74, s28, v11
    v_mfma_f32_16x16x32_bf16 v[216:219], a[224:227], v[26:29], v[216:219]
    ds_read_b64_tr_b16 a[218:219], v4 offset:7168
    v_fma_f32 v69, v69, s28, v11
    v_mfma_f32_16x16x32_bf16 a[8:11], a[224:227], v[34:37], a[8:11]
    s_waitcnt lgkmcnt(6)
    v_fma_f32 v75, v75, s28, v11
    v_xor_b32 v105, s65, v105
    v_mfma_f32_16x16x32_bf16 a[12:15], a[228:231], v[34:37], a[12:15]
    s_add_u32 s39, s39, 12288
    v_lshl_add_u32 v104, v105, 10, v104
    v_fma_f32 v66, v66, s28, v10
    v_mfma_f32_16x16x32_bf16 v[220:223], a[228:231], v[26:29], v[220:223]
    v_fma_f32 v73, v73, s28, v11
    v_fma_f32 v76, v76, s28, v12
    v_add_u32 v104, s38, v104
    v_mfma_f32_16x16x32_bf16 v[172:175], a[228:231], v[22:25], v[172:175]
    ds_read_b64_tr_b16 a[224:225], v2 offset:2048
    v_fma_f32 v72, v72, s28, v11
    v_mfma_f32_16x16x32_bf16 v[124:127], a[228:231], v[14:17], v[124:127]
    s_waitcnt lgkmcnt(5)
    ds_read_b128 a[176:179], v104 offset:20480
    v_fma_f32 v63, v63, s28, v10
    v_mfma_f32_16x16x32_bf16 v[128:131], a[232:235], v[14:17], v[128:131]
    v_exp_f32_e64 v73, v73 clamp
    v_mfma_f32_16x16x32_bf16 v[176:179], a[232:235], v[22:25], v[176:179]
    ds_read_b64_tr_b16 a[230:231], v3 offset:8192
    v_exp_f32_e64 v57, v57 clamp
    v_mfma_f32_16x16x32_bf16 v[224:227], a[232:235], v[26:29], v[224:227]
    v_exp_f32_e64 v82, v82 clamp
    v_mfma_f32_16x16x32_bf16 a[16:19], a[232:235], v[34:37], a[16:19]
    s_waitcnt lgkmcnt(4)
    ds_read_b64_tr_b16 a[234:235], v4 offset:8192
    v_xor_b32 v105, 64, v104
    v_mfma_f32_16x16x32_bf16 a[20:23], a[236:239], v[34:37], a[20:23]
    ds_read_b64_tr_b16 a[226:227], v2 offset:8192
    v_exp_f32_e64 v59, v59 clamp
    v_mfma_f32_16x16x32_bf16 v[228:231], a[236:239], v[26:29], v[228:231]
    ds_read_b128 a[100:103], v105 offset:0
    v_fma_f32 v77, v77, s28, v12
    v_fma_f32 v70, v70, s28, v11
    v_mfma_f32_16x16x32_bf16 v[180:183], a[236:239], v[22:25], v[180:183]
    ds_read_b64_tr_b16 a[232:233], v4 offset:2048
    v_exp_f32_e64 v62, v62 clamp
    v_mfma_f32_16x16x32_bf16 v[132:135], a[236:239], v[14:17], v[132:135]
    s_waitcnt lgkmcnt(6)
    ds_read_b64_tr_b16 a[236:237], v5 offset:2048
    v_fma_f32 v56, v56, s28, v9
    v_mfma_f32_16x16x32_bf16 v[136:139], a[216:219], v[14:17], v[136:139]
    ds_read_b64_tr_b16 a[228:229], v3 offset:2048
    v_exp_f32_e64 v77, v77 clamp
    v_mfma_f32_16x16x32_bf16 v[184:187], a[216:219], v[22:25], v[184:187]
    ds_read_b64_tr_b16 a[238:239], v5 offset:8192
    v_fma_f32 v78, v78, s28, v12
    v_exp_f32_e64 v69, v69 clamp
    v_mfma_f32_16x16x32_bf16 v[232:235], a[216:219], v[26:29], v[232:235]
    ds_read_b128 a[148:151], v105 offset:12288
    v_fma_f32 v64, v64, s28, v10
    v_mfma_f32_16x16x32_bf16 a[24:27], a[216:219], v[34:37], a[24:27]
    v_exp_f32_e64 v83, v83 clamp
    v_mfma_f32_16x16x32_bf16 a[28:31], a[220:223], v[34:37], a[28:31]
    ds_read_b128 a[96:99], v104 offset:0
    v_exp_f32_e64 v72, v72 clamp
    v_mfma_f32_16x16x32_bf16 v[236:239], a[220:223], v[26:29], v[236:239]
    v_exp_f32_e64 v78, v78 clamp
    v_mfma_f32_16x16x32_bf16 v[188:191], a[220:223], v[22:25], v[188:191]
    ds_read_b128 a[168:171], v104 offset:18432
    v_fma_f32 v81, v81, s28, v12
    v_mfma_f32_16x16x32_bf16 v[140:143], a[220:223], v[14:17], v[140:143]
    s_waitcnt lgkmcnt(6)
    ds_read_b128 a[144:147], v104 offset:12288
    v_exp_f32_e64 v71, v71 clamp
    v_exp_f32_e64 v63, v63 clamp
    v_mfma_f32_16x16x32_bf16 v[144:147], a[224:227], v[14:17], v[144:147]
    ds_read_b128 a[124:127], v105 offset:6144
    v_exp_f32_e64 v64, v64 clamp
    v_mfma_f32_16x16x32_bf16 v[192:195], a[224:227], v[22:25], v[192:195]
    s_waitcnt vmcnt(16) lgkmcnt(5)
    s_add_u32 s21, s21, s62
    v_fma_f32 v68, v68, s28, v11
    v_mfma_f32_16x16x32_bf16 v[240:243], a[224:227], v[26:29], v[240:243]
    s_add_u32 m0, s22, 24576
    v_exp_f32_e64 v74, v74 clamp
    v_mfma_f32_16x16x32_bf16 a[32:35], a[224:227], v[34:37], a[32:35]
    s_barrier
    ds_read_b128 a[120:123], v104 offset:6144
    buffer_load_dwordx4 v6, s[8:11], s21 offen lds
    v_mfma_f32_16x16x32_bf16 a[36:39], a[228:231], v[34:37], a[36:39]
    s_add_u32 s21, s21, 128
    ds_read_b128 a[216:219], v0 offset:0
    v_exp_f32_e64 v76, v76 clamp
    v_mfma_f32_16x16x32_bf16 v[244:247], a[228:231], v[26:29], v[244:247]
    s_add_u32 m0, s22, 25600
    ds_read_b128 a[220:223], v1 offset:0
    buffer_load_dwordx4 v6, s[8:11], s21 offen lds
    v_mfma_f32_16x16x32_bf16 v[196:199], a[228:231], v[22:25], v[196:199]
    ds_read_b128 a[116:119], v105 offset:4096
    v_exp_f32_e64 v67, v67 clamp
    v_mfma_f32_16x16x32_bf16 v[148:151], a[228:231], v[14:17], v[148:151]
    s_add_u32 s21, s21, 128
    v_exp_f32_e64 v70, v70 clamp
    v_mfma_f32_16x16x32_bf16 v[152:155], a[232:235], v[14:17], v[152:155]
    s_add_u32 m0, s22, 26624
    ds_read_b128 a[132:135], v105 offset:8192
    buffer_load_dwordx4 v6, s[8:11], s21 offen lds
    v_exp_f32_e64 v58, v58 clamp
    v_mfma_f32_16x16x32_bf16 v[200:203], a[232:235], v[22:25], v[200:203]
    s_add_u32 s21, s21, 12032
    ds_read_b128 a[152:155], v104 offset:14336
    v_exp_f32_e64 v56, v56 clamp
    v_mfma_f32_16x16x32_bf16 v[248:251], a[232:235], v[26:29], v[248:251]
    s_waitcnt vmcnt(11)
    ds_read_b128 a[192:195], v104 offset:24576
    v_exp_f32_e64 v68, v68 clamp
    v_mfma_f32_16x16x32_bf16 a[40:43], a[232:235], v[34:37], a[40:43]
    ds_read_b128 a[224:227], v0 offset:1024
    v_cvt_pk_bf16_f32 v31, v70, v71
    v_mfma_f32_16x16x32_bf16 a[44:47], a[236:239], v[34:37], a[44:47]
    ds_read_b128 a[196:199], v105 offset:24576
    v_cvt_pk_bf16_f32 v30, v68, v69
    v_mfma_f32_16x16x32_bf16 v[252:255], a[236:239], v[26:29], v[252:255]
    ds_read_b128 a[104:107], v104 offset:2048
    v_exp_f32_e64 v65, v65 clamp
    v_mfma_f32_16x16x32_bf16 v[204:207], a[236:239], v[22:25], v[204:207]
    s_waitcnt vmcnt(8)
    ds_read_b128 a[172:175], v105 offset:18432
    v_cvt_pk_bf16_f32 v33, v82, v83
    v_cvt_pk_bf16_f32 v35, v78, v79
    v_mfma_f32_16x16x32_bf16 v[156:159], a[236:239], v[14:17], v[156:159]
    s_waitcnt lgkmcnt(7)
    ds_read_b128 a[140:143], v105 offset:10240
    v_cvt_pk_bf16_f32 v34, v76, v77
    v_mfma_f32_16x16x32_bf16 v[52:55], a[216:219], a[96:99], 0
    ds_read_b128 a[180:183], v105 offset:20480
    v_cvt_pk_bf16_f32 v23, v62, v63
    v_cvt_pk_bf16_f32 v22, v60, v61
    v_mfma_f32_16x16x32_bf16 v[60:63], a[216:219], a[120:123], 0
    ds_read_b128 a[108:111], v105 offset:2048
    v_exp_f32_e64 v75, v75 clamp
    v_mfma_f32_16x16x32_bf16 v[68:71], a[216:219], a[144:147], 0
    ds_read_b128 a[128:131], v104 offset:8192
    v_exp_f32_e64 v81, v81 clamp
    v_mfma_f32_16x16x32_bf16 v[76:79], a[216:219], a[168:171], 0
    s_waitcnt lgkmcnt(8)
    ds_read_b128 a[156:159], v105 offset:14336
    v_cvt_pk_bf16_f32 v16, v56, v57
    v_mfma_f32_16x16x32_bf16 v[84:87], a[216:219], a[192:195], 0
    v_cvt_pk_bf16_f32 v17, v58, v59
    v_cvt_pk_bf16_f32 v28, v72, v73
    v_mfma_f32_16x16x32_bf16 v[52:55], a[220:223], a[100:103], v[52:55]
    ds_read_b128 a[200:203], v104 offset:26624
    v_cvt_pk_bf16_f32 v32, v80, v81
    v_mfma_f32_16x16x32_bf16 v[60:63], a[220:223], a[124:127], v[60:63]
    ds_read_b128 a[228:231], v1 offset:1024
    v_cvt_pk_bf16_f32 v20, v64, v65
    v_mfma_f32_16x16x32_bf16 v[68:71], a[220:223], a[148:151], v[68:71]
    s_waitcnt lgkmcnt(7)
    v_exp_f32_e64 v66, v66 clamp
    v_mfma_f32_16x16x32_bf16 v[76:79], a[220:223], a[172:175], v[76:79]
    ds_read_b128 a[188:191], v105 offset:22528
    v_cvt_pk_bf16_f32 v21, v66, v67
    v_mfma_f32_16x16x32_bf16 v[84:87], a[220:223], a[196:199], v[84:87]
    ds_read_b128 a[204:207], v105 offset:26624
    v_cvt_pk_bf16_f32 v29, v74, v75
    v_smfmac_f32_16x16x64_bf16 v[48:51], a[240:243], v[16:23], v101
    ds_read_b128 a[184:187], v104 offset:22528
    v_mfma_f32_16x16x32_bf16 v[52:55], a[224:227], a[104:107], v[52:55]
    ds_read_b128 a[232:235], v0 offset:6144
    v_smfmac_f32_16x16x64_bf16 v[48:51], a[244:247], v[28:35], v101
    s_waitcnt lgkmcnt(7)
    ds_read_b128 a[164:167], v105 offset:16384
    v_mfma_f32_16x16x32_bf16 v[60:63], a[224:227], a[128:131], v[60:63]
    ds_read_b128 a[136:139], v104 offset:10240
    v_mfma_f32_16x16x32_bf16 v[68:71], a[224:227], a[152:155], v[68:71]
    ds_read_b128 a[160:163], v104 offset:16384
    v_mfma_f32_16x16x32_bf16 v[76:79], a[224:227], a[176:179], v[76:79]
    s_waitcnt lgkmcnt(8)
    ds_read_b128 a[112:115], v104 offset:4096
    v_cmp_lt_f32 vcc, s29, v48
    v_mfma_f32_16x16x32_bf16 v[84:87], a[224:227], a[200:203], v[84:87]
    s_waitcnt lgkmcnt(8)
    ds_read_b128 a[236:239], v1 offset:6144
    v_mfma_f32_16x16x32_bf16 v[52:55], a[228:231], a[108:111], v[52:55]
    s_nop 0
    s_cbranch_vccnz L_rs_tr45b
L_ret_tr45b:
    v_and_b32 v93, 0x3ff, v0
    v_mfma_f32_16x16x32_bf16 v[60:63], a[228:231], a[132:135], v[60:63]
    ds_read_b128 a[224:227], v0 offset:2048
    v_mov_b32 v111, v46
    v_mfma_f32_16x16x32_bf16 v[68:71], a[228:231], a[156:159], v[68:71]
    s_nop 0
    v_permlane16_swap_b32 v46, v111
    v_mfma_f32_16x16x32_bf16 v[76:79], a[228:231], a[180:183], v[76:79]
    s_waitcnt lgkmcnt(7)
    ds_read_b128 a[216:219], v0 offset:7168
    v_lshrrev_b32 v108, 11, v0
    v_mfma_f32_16x16x32_bf16 v[84:87], a[228:231], a[204:207], v[84:87]
    s_waitcnt lgkmcnt(7)
    v_mov_b32 v110, v45
    v_xor_b32 v108, s65, v108
    v_mfma_f32_16x16x32_bf16 v[56:59], a[232:235], a[96:99], 0
    v_mfma_f32_16x16x32_bf16 v[64:67], a[232:235], a[120:123], 0
    ds_read_b128 a[220:223], v1 offset:7168
    v_lshl_add_u32 v93, v108, 10, v93
    v_mfma_f32_16x16x32_bf16 v[72:75], a[232:235], a[144:147], 0
    ds_read_b128 a[228:231], v1 offset:2048
    v_mfma_f32_16x16x32_bf16 v[80:83], a[232:235], a[168:171], 0
    v_mbcnt_lo_u32_b32 v108, -1, 0
    v_mfma_f32_16x16x32_bf16 v[88:91], a[232:235], a[192:195], 0
    s_waitcnt lgkmcnt(4)
    v_add_u32 v93, s38, v93
    v_mbcnt_hi_u32_b32 v108, -1, v108
    v_mfma_f32_16x16x32_bf16 v[56:59], a[236:239], a[100:103], v[56:59]
    ds_read_b128 a[232:235], v0 offset:8192
    v_mov_b32 v109, v50
    v_mfma_f32_16x16x32_bf16 v[64:67], a[236:239], a[124:127], v[64:67]
    v_permlane16_swap_b32 v45, v110
    v_mfma_f32_16x16x32_bf16 v[72:75], a[236:239], a[148:151], v[72:75]
    v_add_f32 v45, v45, v110
    v_lshrrev_b32 v108, 1, v108
    v_mfma_f32_16x16x32_bf16 v[80:83], a[236:239], a[172:175], v[80:83]
    v_and_b32 v108, 24, v108
    v_mfma_f32_16x16x32_bf16 v[88:91], a[236:239], a[196:199], v[88:91]
    s_waitcnt lgkmcnt(3)
    ds_read_b128 a[236:239], v1 offset:8192
    v_mfma_f32_16x16x32_bf16 v[56:59], a[216:219], a[104:107], v[56:59]
    v_bfe_u32 v108, s66, v108, 8
    v_xor_b32 v93, v93, v108
    v_mfma_f32_16x16x32_bf16 v[64:67], a[216:219], a[128:131], v[64:67]
    v_permlane16_swap_b32 v50, v109
    v_mfma_f32_16x16x32_bf16 v[72:75], a[216:219], a[152:155], v[72:75]
    s_waitcnt vmcnt(17)
    v_add_f32 v46, v46, v111
    v_add_f32 v50, v50, v109
    v_mfma_f32_16x16x32_bf16 v[80:83], a[216:219], a[176:179], v[80:83]
    v_mov_b32 v108, v49
    v_mov_b32 v109, v50
    v_mfma_f32_16x16x32_bf16 v[88:91], a[216:219], a[200:203], v[88:91]
    s_waitcnt lgkmcnt(2)
    v_permlane16_swap_b32 v49, v108
    v_mfma_f32_16x16x32_bf16 v[56:59], a[220:223], a[108:111], v[56:59]
    v_xor_b32 v102, 96, v93
    v_mfma_f32_16x16x32_bf16 v[64:67], a[220:223], a[132:135], v[64:67]
    v_add_f32 v49, v49, v108
    v_mfma_f32_16x16x32_bf16 v[72:75], a[220:223], a[156:159], v[72:75]
    v_mov_b32 v110, v45
    v_mov_b32 v108, v49
    v_mfma_f32_16x16x32_bf16 v[80:83], a[220:223], a[180:183], v[80:83]
    s_nop 0
    v_permlane32_swap_b32 v49, v108
    v_mfma_f32_16x16x32_bf16 v[88:91], a[220:223], a[204:207], v[88:91]
    s_waitcnt vmcnt(14) lgkmcnt(0)
    s_add_u32 m0, s22, 0
    v_mfma_f32_16x16x32_bf16 v[52:55], a[224:227], a[112:115], v[52:55]
    s_barrier
    v_mfma_f32_16x16x32_bf16 v[60:63], a[224:227], a[136:139], v[60:63]
    buffer_load_dwordx4 v6, s[4:7], s20 offen lds
    v_mfma_f32_16x16x32_bf16 v[68:71], a[224:227], a[160:163], v[68:71]
    s_add_u32 s20, s20, 128
    ds_read_b64_tr_b16 a[216:217], v2 offset:18432
    s_add_u32 m0, s22, 1024
    v_mfma_f32_16x16x32_bf16 v[76:79], a[224:227], a[184:187], v[76:79]
    buffer_load_dwordx4 v6, s[4:7], s20 offen lds
    v_mfma_f32_16x16x32_bf16 v[84:87], a[224:227], a[208:211], v[84:87]
    s_add_u32 s20, s20, 128
    ds_read_b64_tr_b16 a[218:219], v2 offset:12288
    s_add_u32 m0, s22, 2048
    v_mfma_f32_16x16x32_bf16 v[52:55], a[228:231], a[116:119], v[52:55]
    buffer_load_dwordx4 v6, s[4:7], s20 offen lds
    v_mfma_f32_16x16x32_bf16 v[60:63], a[228:231], a[140:143], v[60:63]
    ds_read_b64_tr_b16 a[220:221], v3 offset:18432
    v_mov_b32 v111, v46
    v_mfma_f32_16x16x32_bf16 v[68:71], a[228:231], a[164:167], v[68:71]
    v_permlane32_swap_b32 v45, v110
    v_mfma_f32_16x16x32_bf16 v[76:79], a[228:231], a[188:191], v[76:79]
    v_add_f32 v92, v108, v45
    v_xor_b32 v95, 32, v93
    v_mfma_f32_16x16x32_bf16 v[84:87], a[228:231], a[212:215], v[84:87]
    ds_read_b64_tr_b16 a[222:223], v3 offset:12288
    v_add_f32 v48, v49, v47
    v_mfma_f32_16x16x32_bf16 v[56:59], a[232:235], a[112:115], v[56:59]
    s_add_u32 s20, s20, 12032
    v_rcp_f32 v92, v92
    v_mfma_f32_16x16x32_bf16 v[64:67], a[232:235], a[136:139], v[64:67]
    v_permlane32_swap_b32 v50, v109
    v_mfma_f32_16x16x32_bf16 v[72:75], a[232:235], a[160:163], v[72:75]
    v_rcp_f32 v48, v48
    v_mfma_f32_16x16x32_bf16 v[80:83], a[232:235], a[184:187], v[80:83]
    ds_read_b64_tr_b16 a[224:225], v4 offset:18432
    v_add_f32 v50, v50, v110
    v_mfma_f32_16x16x32_bf16 v[88:91], a[232:235], a[208:211], v[88:91]
    v_rcp_f32 v50, v50
    v_mfma_f32_16x16x32_bf16 v[56:59], a[236:239], a[116:119], v[56:59]
    v_permlane32_swap_b32 v46, v111
    v_mfma_f32_16x16x32_bf16 v[64:67], a[236:239], a[140:143], v[64:67]
    ds_read_b64_tr_b16 a[226:227], v4 offset:12288
    v_xor_b32 v8, 64, v93
    v_mfma_f32_16x16x32_bf16 v[72:75], a[236:239], a[164:167], v[72:75]
    ds_read_b64_tr_b16 a[228:229], v5 offset:18432
    v_add_f32 v94, v109, v46
    v_mfma_f32_16x16x32_bf16 v[80:83], a[236:239], a[188:191], v[80:83]
    ds_read_b64_tr_b16 a[230:231], v5 offset:12288
    s_waitcnt lgkmcnt(5)
    v_mfma_f32_16x16x32_bf16 v[88:91], a[236:239], a[212:215], v[88:91]
    v_rcp_f32 v94, v94
    v_max3_f32 v96, v52, v53, v54
    v_max3_f32 v97, v60, v61, v62
    v_max3_f32 v99, v76, v77, v78
    s_nop 0
    v_max3_f32 v99, v99, v79, v80
    v_max3_f32 v96, v96, v55, v56
    v_max3_f32 v98, v68, v69, v70
    v_mfma_f32_16x16x32_bf16 v[112:115], a[216:219], v[16:19], v[112:115]
    ds_read_b64_tr_b16 a[236:237], v3 offset:19456
    v_max3_f32 v97, v97, v63, v64
    v_mfma_f32_16x16x32_bf16 v[160:163], a[216:219], v[20:23], v[160:163]
    s_mov_b32 s67, s34
    v_max3_f32 v97, v97, v65, v66
    v_max3_f32 v96, v96, v57, v58
    v_max3_f32 v99, v99, v81, v82
    v_max_f32 v97, v97, v67
    v_mfma_f32_16x16x32_bf16 v[208:211], a[216:219], v[28:31], v[208:211]
    s_add_u32 s18, s34, 24576
    ds_read_b64_tr_b16 a[234:235], v2 offset:13312
    v_max3_f32 v98, v98, v71, v72
    v_max_f32 v96, v96, v59
    v_max3_f32 v98, v98, v73, v74
    v_max_f32 v98, v98, v75
    v_mfma_f32_16x16x32_bf16 a[0:3], a[216:219], v[32:35], a[0:3]
    s_waitcnt lgkmcnt(6)
    ds_read_b64_tr_b16 a[232:233], v2 offset:19456
    v_permlane32_swap_b32 v96, v97
    v_mfma_f32_16x16x32_bf16 a[4:7], a[220:223], v[32:35], a[4:7]
    ds_read_b64_tr_b16 a[216:217], v4 offset:19456
    v_max_f32 v99, v99, v83
    v_mfma_f32_16x16x32_bf16 v[212:215], a[220:223], v[28:31], v[212:215]
    s_mov_b32 s34, s33
    v_permlane32_swap_b32 v98, v99
    v_max_f32 v96, v96, v97
    v_max_f32 v98, v98, v99
    v_mfma_f32_16x16x32_bf16 v[164:167], a[220:223], v[20:23], v[164:167]
    s_add_u32 s64, s64, s62
    v_permlane16_swap_b32 v96, v98
    v_mfma_f32_16x16x32_bf16 v[116:119], a[220:223], v[16:19], v[116:119]
    s_waitcnt lgkmcnt(4)
    ds_read_b64_tr_b16 a[222:223], v5 offset:13312
    v_max_f32 v96, v96, v98
    v_mul_f32_e64 v9, -s28, v96
    v_mfma_f32_16x16x32_bf16 v[120:123], a[224:227], v[16:19], v[120:123]
    ds_read_b64_tr_b16 a[238:239], v3 offset:13312
    v_subrev_f32 v9, 0x42000000, v9
    v_mfma_f32_16x16x32_bf16 v[168:171], a[224:227], v[20:23], v[168:171]
    s_add_u32 s64, s64, 196608
    v_mov_b32 v11, v9
    v_max3_f32 v96, v84, v85, v86
    v_mfma_f32_16x16x32_bf16 v[216:219], a[224:227], v[28:31], v[216:219]
    s_mov_b32 s39, s64
    ds_read_b64_tr_b16 a[218:219], v4 offset:13312
    v_permlane16_swap_b32 v9, v11
    v_mov_b32 v12, v11
    v_mfma_f32_16x16x32_bf16 a[8:11], a[224:227], v[32:35], a[8:11]
    s_add_u32 s37, s37, 1
    ds_read_b64_tr_b16 a[220:221], v5 offset:19456
    v_mov_b32 v10, v9
    v_mfma_f32_16x16x32_bf16 a[12:15], a[228:231], v[32:35], a[12:15]
    s_bitcmp1_b32 s63, s37
    v_max3_f32 v96, v96, v87, v88
    v_max3_f32 v96, v96, v89, v90
    v_mfma_f32_16x16x32_bf16 v[220:223], a[228:231], v[28:31], v[220:223]
    s_cselect_b32 s62, 4294770688, 0
    v_permlane32_swap_b32 v9, v10
    v_mfma_f32_16x16x32_bf16 v[172:175], a[228:231], v[20:23], v[172:175]
    s_cselect_b32 s42, 0, 325632
    v_max_f32 v96, v96, v91
    v_fma_f32 v59, v59, s28, v9
    v_mfma_f32_16x16x32_bf16 v[124:127], a[228:231], v[16:19], v[124:127]
    s_waitcnt lgkmcnt(4)
    ds_read_b64_tr_b16 a[224:225], v2 offset:20480
    v_fma_f32 v55, v55, s28, v9
    v_permlane32_swap_b32 v11, v12
    v_mfma_f32_16x16x32_bf16 v[128:131], a[232:235], v[16:19], v[128:131]
    s_add_u32 s35, s35, s42
    ds_read_b64_tr_b16 a[228:229], v3 offset:20480
    v_mov_b32 v97, v96
    v_fma_f32 v60, v60, s28, v10
    v_mfma_f32_16x16x32_bf16 v[176:179], a[232:235], v[20:23], v[176:179]
    s_lshl_b32 s42, s37, 1
    ds_read_b64_tr_b16 a[226:227], v2 offset:14336
    v_permlane32_swap_b32 v97, v96
    v_mfma_f32_16x16x32_bf16 v[224:227], a[232:235], v[28:31], v[224:227]
    s_lshr_b32 s42, s31, s42
    ds_read_b64_tr_b16 a[230:231], v3 offset:14336
    v_fma_f32 v78, v78, s28, v12
    v_mfma_f32_16x16x32_bf16 a[16:19], a[232:235], v[32:35], a[16:19]
    s_waitcnt lgkmcnt(5)
    v_fma_f32 v71, v71, s28, v11
    v_fma_f32 v65, v65, s28, v10
    v_mfma_f32_16x16x32_bf16 a[20:23], a[236:239], v[32:35], a[20:23]
    s_and_b32 s42, s42, 3
    v_fma_f32 v54, v54, s28, v9
    v_accvgpr_read_b32 v104, a0
    v_fma_f32 v63, v63, s28, v10
    v_mfma_f32_16x16x32_bf16 v[228:231], a[236:239], v[28:31], v[228:231]
    s_add_u32 s42, s42, s36
    v_fma_f32 v70, v70, s28, v11
    v_max_f32 v96, v96, v97
    v_mfma_f32_16x16x32_bf16 v[180:183], a[236:239], v[20:23], v[180:183]
    s_sub_u32 s43, s42, 3
    v_fma_f32 v56, v56, s28, v9
    s_cmp_ge_u32 s42, 3
    v_accvgpr_read_b32 v107, a3
    v_mfma_f32_16x16x32_bf16 v[132:135], a[236:239], v[16:19], v[132:135]
    s_cselect_b32 s42, s43, s42
    v_fma_f32 v74, v74, s28, v11
    v_mov_b32 v97, v96
    v_fma_f32 v81, v81, s28, v12
    v_mfma_f32_16x16x32_bf16 v[136:139], a[216:219], v[16:19], v[136:139]
    s_mul_i32 s44, s3, 5
    ds_read_b64_tr_b16 a[232:233], v4 offset:20480
    v_fma_f32 v62, v62, s28, v10
    v_mfma_f32_16x16x32_bf16 v[184:187], a[216:219], v[20:23], v[184:187]
    s_mov_b32 s32, 1
    s_lshl_b32 s43, s3, 2
    v_fma_f32 v68, v68, s28, v11
    v_mfma_f32_16x16x32_bf16 v[232:235], a[216:219], v[28:31], v[232:235]
    s_add_u32 s45, s43, 21
    v_fma_f32 v75, v75, s28, v11
    v_fma_f32 v76, v76, s28, v12
    v_mfma_f32_16x16x32_bf16 a[24:27], a[216:219], v[32:35], a[24:27]
    s_waitcnt lgkmcnt(1)
    v_fma_f32 v61, v61, s28, v10
    v_fma_f32 v77, v77, s28, v12
    v_mfma_f32_16x16x32_bf16 a[28:31], a[220:223], v[32:35], a[28:31]
    s_cmp_eq_u32 s3, 0
    v_exp_f32_e64 v77, v77 clamp
    v_mfma_f32_16x16x32_bf16 v[236:239], a[220:223], v[28:31], v[236:239]
    s_cselect_b32 s45, 20, s45
    ds_read_b64_tr_b16 a[238:239], v5 offset:14336
    v_permlane16_swap_b32 v97, v96
    v_mfma_f32_16x16x32_bf16 v[188:191], a[220:223], v[20:23], v[188:191]
    s_cselect_b32 s33, 1, 0
    s_cmp_eq_u32 s42, 1
    v_accvgpr_read_b32 v105, a1
    v_mfma_f32_16x16x32_bf16 v[140:143], a[220:223], v[16:19], v[140:143]
    s_cselect_b32 s44, s45, s44
    s_cselect_b32 s32, s33, s32
    ds_read_b64_tr_b16 a[236:237], v5 offset:20480
    v_mfma_f32_16x16x32_bf16 v[144:147], a[224:227], v[16:19], v[144:147]
    s_add_u32 s45, s43, 37
    ds_read_b64_tr_b16 a[234:235], v4 offset:14336
    v_max_f32 v96, v96, v97
    v_exp_f32_e64 v55, v55 clamp
    v_mfma_f32_16x16x32_bf16 v[192:195], a[224:227], v[20:23], v[192:195]
    s_cmp_eq_u32 s42, 2
    s_cselect_b32 s44, s45, s44
    v_fma_f32 v79, v79, s28, v12
    v_accvgpr_read_b32 v111, a7
    v_mfma_f32_16x16x32_bf16 v[240:243], a[224:227], v[28:31], v[240:243]
    s_cselect_b32 s32, 0, s32
    v_exp_f32_e64 v62, v62 clamp
    v_mfma_f32_16x16x32_bf16 a[32:35], a[224:227], v[32:35], a[32:35]
    s_mul_i32 s44, s44, 6144
    v_exp_f32_e64 v71, v71 clamp
    v_fma_f32 v69, v69, s28, v11
    s_add_u32 s33, s35, s44
    v_mfma_f32_16x16x32_bf16 a[36:39], a[228:231], v[32:35], a[36:39]
    s_mul_i32 s42, s32, 6144
    v_mul_f32_e64 v13, -s28, v96
    s_add_u32 s42, s42, 24576
    v_fma_f32 v64, v64, s28, v10
    v_fma_f32 v73, v73, s28, v11
    v_mfma_f32_16x16x32_bf16 v[244:247], a[228:231], v[28:31], v[244:247]
    s_add_u32 s42, s42, s33
    v_fma_f32 v80, v80, s28, v12
    v_subrev_f32 v13, 0x42000000, v13
    s_cmp_ge_u32 s37, 6
    v_accvgpr_read_b32 v106, a2
    s_cselect_b32 s14, 0, s42
    v_fma_f32 v82, v82, s28, v12
    v_pk_mul_f32 v[118:119], v[118:119], v[48:49] op_sel_hi:[1,0]
    v_exp_f32_e64 v60, v60 clamp
    v_fma_f32 v83, v83, s28, v12
    s_add_u32 s24, s67, 256
    v_mfma_f32_16x16x32_bf16 v[196:199], a[228:231], v[20:23], v[196:199]
    s_add_u32 s25, s33, 256
    v_exp_f32_e64 v68, v68 clamp
    v_mfma_f32_16x16x32_bf16 v[148:151], a[228:231], v[16:19], v[148:151]
    s_add_u32 s23, s38, 4096
    s_mov_b32 s27, 0x249
    s_waitcnt lgkmcnt(0)
    v_mfma_f32_16x16x32_bf16 v[152:155], a[232:235], v[16:19], v[152:155]
    s_mov_b32 s30, 0
    v_exp_f32_e64 v82, v82 clamp
    v_mfma_f32_16x16x32_bf16 v[200:203], a[232:235], v[20:23], v[200:203]
    s_waitcnt vmcnt(7)
    v_exp_f32_e64 v63, v63 clamp
    v_mfma_f32_16x16x32_bf16 v[248:251], a[232:235], v[28:31], v[248:251]
    s_barrier
    ds_read_b128 a[216:219], v0 offset:12288
    v_mfma_f32_16x16x32_bf16 a[40:43], a[232:235], v[32:35], a[40:43]
    ds_read_b128 a[224:227], v0 offset:13312
    v_exp_f32_e64 v70, v70 clamp
    v_exp_f32_e64 v54, v54 clamp
    v_exp_f32_e64 v76, v76 clamp
    v_mfma_f32_16x16x32_bf16 a[44:47], a[236:239], v[32:35], a[44:47]
    ds_read_b128 a[220:223], v1 offset:12288
    v_exp_f32_e64 v79, v79 clamp
    v_mfma_f32_16x16x32_bf16 v[252:255], a[236:239], v[28:31], v[252:255]
    ds_read_b128 a[228:231], v1 offset:13312
    v_fma_f32 v52, v52, s28, v9
    v_mfma_f32_16x16x32_bf16 v[204:207], a[236:239], v[20:23], v[204:207]
    v_exp_f32_e64 v78, v78 clamp
    v_exp_f32_e64 v61, v61 clamp
    v_fma_f32 v53, v53, s28, v9
    v_fma_f32 v72, v72, s28, v11
    v_pk_mul_f32 v[104:105], v[104:105], v[94:95] op_sel_hi:[1,0]
    v_exp_f32_e64 v59, v59 clamp
    v_exp_f32_e64 v69, v69 clamp
    v_exp_f32_e64 v53, v53 clamp
    v_cvt_pk_bf16_f32 v23, v62, v63
    v_cvt_pk_bf16_f32 v22, v60, v61
    v_fma_f32 v86, v86, s28, v13
    v_fma_f32 v85, v85, s28, v13
    v_fma_f32 v87, v87, s28, v13
    v_pk_mul_f32 v[174:175], v[174:175], v[92:93] op_sel_hi:[1,0]
    v_exp_f32_e64 v52, v52 clamp
    v_cvt_pk_bf16_f32 v15, v54, v55
    v_fma_f32 v84, v84, s28, v13
    v_cvt_pk_bf16_f32 v26, v68, v69
    v_mfma_f32_16x16x32_bf16 v[156:159], a[236:239], v[16:19], v[156:159]
    s_waitcnt lgkmcnt(2)
    v_exp_f32_e64 v85, v85 clamp
    v_cvt_pk_bf16_f32 v14, v52, v53
    v_mfma_f32_16x16x32_bf16 v[52:55], a[216:219], a[96:99], 0
    s_waitcnt lgkmcnt(1)
    ds_read_b128 a[232:235], v0 offset:14336
    v_fma_f32 v57, v57, s28, v9
    v_mfma_f32_16x16x32_bf16 v[52:55], a[220:223], a[100:103], v[52:55]
    v_exp_f32_e64 v87, v87 clamp
    v_mfma_f32_16x16x32_bf16 v[52:55], a[224:227], a[104:107], v[52:55]
    v_exp_f32_e64 v86, v86 clamp
    v_mfma_f32_16x16x32_bf16 v[60:63], a[224:227], a[128:131], 0
    v_exp_f32_e64 v84, v84 clamp
    v_mfma_f32_16x16x32_bf16 v[60:63], a[220:223], a[124:127], v[60:63]
    v_fma_f32 v88, v88, s28, v13
    v_fma_f32 v89, v89, s28, v13
    v_cvt_pk_bf16_f32 v27, v70, v71
    v_mfma_f32_16x16x32_bf16 v[60:63], a[216:219], a[120:123], v[60:63]
    v_exp_f32_e64 v83, v83 clamp
    v_mfma_f32_16x16x32_bf16 v[68:71], a[216:219], a[144:147], 0
    v_cvt_pk_bf16_f32 v34, v76, v77
    v_cvt_pk_bf16_f32 v35, v78, v79
    v_mfma_f32_16x16x32_bf16 v[68:71], a[220:223], a[148:151], v[68:71]
    ds_read_b128 a[236:239], v1 offset:14336
    v_fma_f32 v66, v66, s28, v10
    v_cvt_pk_bf16_f32 v38, v84, v85
    v_cvt_pk_bf16_f32 v39, v86, v87
    v_mfma_f32_16x16x32_bf16 v[68:71], a[224:227], a[152:155], v[68:71]
    v_exp_f32_e64 v56, v56 clamp
    v_mfma_f32_16x16x32_bf16 v[76:79], a[224:227], a[176:179], 0
    v_exp_f32_e64 v74, v74 clamp
    v_mfma_f32_16x16x32_bf16 v[76:79], a[220:223], a[172:175], v[76:79]
    v_exp_f32_e64 v66, v66 clamp
    v_mfma_f32_16x16x32_bf16 v[76:79], a[216:219], a[168:171], v[76:79]
    v_exp_f32_e64 v57, v57 clamp
    v_mfma_f32_16x16x32_bf16 v[84:87], a[216:219], a[192:195], 0
    v_subrev_u32 v103, 24576, v103
    v_exp_f32_e64 v80, v80 clamp
    v_mfma_f32_16x16x32_bf16 v[84:87], a[220:223], a[196:199], v[84:87]
    v_exp_f32_e64 v73, v73 clamp
    v_mfma_f32_16x16x32_bf16 v[84:87], a[224:227], a[200:203], v[84:87]
    s_waitcnt lgkmcnt(1)
    ds_read_b128 a[224:227], v0 offset:19456
    v_fma_f32 v58, v58, s28, v9
    v_fma_f32 v90, v90, s28, v13
    v_mfma_f32_16x16x32_bf16 v[84:87], a[228:231], a[204:207], v[84:87]
    v_exp_f32_e64 v58, v58 clamp
    v_accvgpr_read_b32 v108, a4
    v_mfma_f32_16x16x32_bf16 v[84:87], a[232:235], a[208:211], v[84:87]
    s_waitcnt lgkmcnt(1)
    ds_read_b128 a[220:223], v1 offset:18432
    v_cvt_pk_bf16_f32 v104, v104, v105
    v_cvt_pk_bf16_f32 v37, v82, v83
    v_mfma_f32_16x16x32_bf16 v[84:87], a[236:239], a[212:215], v[84:87]
    s_add_u32 m0, s22, 36864
    v_exp_f32_e64 v75, v75 clamp
    v_accvgpr_read_b32 v110, a6
    v_mfma_f32_16x16x32_bf16 v[76:79], a[236:239], a[188:191], v[76:79]
    v_exp_f32_e64 v65, v65 clamp
    v_cvt_pk_bf16_f32 v16, v56, v57
    v_mfma_f32_16x16x32_bf16 v[76:79], a[232:235], a[184:187], v[76:79]
    v_exp_f32_e64 v90, v90 clamp
    v_mfma_f32_16x16x32_bf16 v[76:79], a[228:231], a[180:183], v[76:79]
    ds_read_b128 a[216:219], v0 offset:18432
    v_fma_f32 v91, v91, s28, v13
    v_mfma_f32_16x16x32_bf16 v[68:71], a[228:231], a[156:159], v[68:71]
    v_fma_f32 v86, v86, s28, v13
    v_fma_f32 v67, v67, s28, v10
    v_mfma_f32_16x16x32_bf16 v[68:71], a[232:235], a[160:163], v[68:71]
    v_exp_f32_e64 v64, v64 clamp
    v_mfma_f32_16x16x32_bf16 v[68:71], a[236:239], a[164:167], v[68:71]
    buffer_load_dwordx4 v6, s[8:11], s21 offen lds
    v_mfma_f32_16x16x32_bf16 v[60:63], a[236:239], a[140:143], v[60:63]
    s_add_u32 s21, s21, 128
    v_exp_f32_e64 v67, v67 clamp
    v_cvt_pk_bf16_f32 v17, v58, v59
    v_mfma_f32_16x16x32_bf16 v[60:63], a[232:235], a[136:139], v[60:63]
    v_cvt_pk_bf16_f32 v25, v66, v67
    v_cvt_pk_bf16_f32 v29, v74, v75
    v_mfma_f32_16x16x32_bf16 v[44:47], a[248:251], v[14:17], 0
    v_exp_f32_e64 v88, v88 clamp
    v_mfma_f32_16x16x32_bf16 v[60:63], a[228:231], a[132:135], v[60:63]
    s_add_u32 m0, s22, 37888
    v_exp_f32_e64 v81, v81 clamp
    v_mfma_f32_16x16x32_bf16 v[52:55], a[228:231], a[108:111], v[52:55]
    buffer_load_dwordx4 v6, s[8:11], s21 offen lds
    v_mfma_f32_16x16x32_bf16 v[52:55], a[232:235], a[112:115], v[52:55]
    v_exp_f32_e64 v72, v72 clamp
    v_mfma_f32_16x16x32_bf16 v[52:55], a[236:239], a[116:119], v[52:55]
    s_waitcnt lgkmcnt(0)
    ds_read_b128 a[236:239], v1 offset:20480
    v_accvgpr_read_b32 v109, a5
    v_mfma_f32_16x16x32_bf16 v[56:59], a[216:219], a[96:99], 0
    v_fma_f32 v76, v76, s28, v12
    v_fma_f32 v63, v63, s28, v10
    v_mfma_f32_16x16x32_bf16 v[56:59], a[220:223], a[100:103], v[56:59]
    v_fma_f32 v87, v87, s28, v13
    v_fma_f32 v68, v68, s28, v11
    v_mfma_f32_16x16x32_bf16 v[56:59], a[224:227], a[104:107], v[56:59]
    v_fma_f32 v55, v55, s28, v9
    v_fma_f32 v60, v60, s28, v10
    v_cvt_pk_bf16_f32 v36, v80, v81
    v_exp_f32_e64 v89, v89 clamp
    v_pk_mul_f32 v[160:161], v[160:161], v[92:93] op_sel_hi:[1,0]
    v_pk_mul_f32 v[172:173], v[172:173], v[92:93] op_sel_hi:[1,0]
    v_pk_mul_f32 v[162:163], v[162:163], v[92:93] op_sel_hi:[1,0]
    v_pk_mul_f32 v[218:219], v[218:219], v[50:51] op_sel_hi:[1,0]
    v_pk_mul_f32 v[108:109], v[108:109], v[94:95] op_sel_hi:[1,0]
    v_pk_mul_f32 v[144:145], v[144:145], v[48:49] op_sel_hi:[1,0]
    v_pk_mul_f32 v[142:143], v[142:143], v[48:49] op_sel_hi:[1,0]
    v_pk_mul_f32 v[226:227], v[226:227], v[50:51] op_sel_hi:[1,0]
    v_cvt_pk_bf16_f32 v40, v88, v89
    v_pk_mul_f32 v[220:221], v[220:221], v[50:51] op_sel_hi:[1,0]
    v_pk_mul_f32 v[140:141], v[140:141], v[48:49] op_sel_hi:[1,0]
    v_cvt_pk_bf16_f32 v24, v64, v65
    v_pk_mul_f32 v[176:177], v[176:177], v[92:93] op_sel_hi:[1,0]
    v_fma_f32 v54, v54, s28, v9
    v_pk_mul_f32 v[152:153], v[152:153], v[48:49] op_sel_hi:[1,0]
    v_pk_mul_f32 v[110:111], v[110:111], v[94:95] op_sel_hi:[1,0]
    v_pk_mul_f32 v[116:117], v[116:117], v[48:49] op_sel_hi:[1,0]
    v_pk_mul_f32 v[120:121], v[120:121], v[48:49] op_sel_hi:[1,0]
    v_pk_mul_f32 v[214:215], v[214:215], v[50:51] op_sel_hi:[1,0]
    v_pk_mul_f32 v[136:137], v[136:137], v[48:49] op_sel_hi:[1,0]
    v_pk_mul_f32 v[224:225], v[224:225], v[50:51] op_sel_hi:[1,0]
    v_pk_mul_f32 v[188:189], v[188:189], v[92:93] op_sel_hi:[1,0]
    v_pk_mul_f32 v[240:241], v[240:241], v[50:51] op_sel_hi:[1,0]
    v_pk_mul_f32 v[216:217], v[216:217], v[50:51] op_sel_hi:[1,0]
    v_pk_mul_f32 v[184:185], v[184:185], v[92:93] op_sel_hi:[1,0]
    v_pk_mul_f32 v[170:171], v[170:171], v[92:93] op_sel_hi:[1,0]
    v_cvt_pk_bf16_f32 v108, v108, v109
    v_pk_mul_f32 v[150:151], v[150:151], v[48:49] op_sel_hi:[1,0]
    v_pk_mul_f32 v[128:129], v[128:129], v[48:49] op_sel_hi:[1,0]
    v_cvt_pk_bf16_f32 v28, v72, v73
    v_pk_mul_f32 v[122:123], v[122:123], v[48:49] op_sel_hi:[1,0]
    v_pk_mul_f32 v[168:169], v[168:169], v[92:93] op_sel_hi:[1,0]
    v_pk_mul_f32 v[210:211], v[210:211], v[50:51] op_sel_hi:[1,0]
    v_pk_mul_f32 v[134:135], v[134:135], v[48:49] op_sel_hi:[1,0]
    v_pk_mul_f32 v[130:131], v[130:131], v[48:49] op_sel_hi:[1,0]
    v_pk_mul_f32 v[124:125], v[124:125], v[48:49] op_sel_hi:[1,0]
    v_pk_mul_f32 v[166:167], v[166:167], v[92:93] op_sel_hi:[1,0]
    v_pk_mul_f32 v[212:213], v[212:213], v[50:51] op_sel_hi:[1,0]
    v_cvt_pk_bf16_f32 v109, v110, v111
    v_pk_mul_f32 v[200:201], v[200:201], v[92:93] op_sel_hi:[1,0]
    v_cvt_pk_bf16_f32 v120, v120, v121
    v_pk_mul_f32 v[106:107], v[106:107], v[94:95] op_sel_hi:[1,0]
    v_pk_mul_f32 v[232:233], v[232:233], v[50:51] op_sel_hi:[1,0]
    v_pk_mul_f32 v[222:223], v[222:223], v[50:51] op_sel_hi:[1,0]
    v_fma_f32 v78, v78, s28, v12
    v_cvt_pk_bf16_f32 v140, v140, v141
    v_fma_f32 v52, v52, s28, v9
    v_cvt_pk_bf16_f32 v168, v168, v169
    v_pk_mul_f32 v[164:165], v[164:165], v[92:93] op_sel_hi:[1,0]
    v_pk_mul_f32 v[126:127], v[126:127], v[48:49] op_sel_hi:[1,0]
    v_pk_mul_f32 v[208:209], v[208:209], v[50:51] op_sel_hi:[1,0]
    v_pk_mul_f32 v[112:113], v[112:113], v[48:49] op_sel_hi:[1,0]
    v_pk_mul_f32 v[180:181], v[180:181], v[92:93] op_sel_hi:[1,0]
    v_exp_f32_e64 v76, v76 clamp
    v_exp_f32_e64 v91, v91 clamp
    v_pk_mul_f32 v[114:115], v[114:115], v[48:49] op_sel_hi:[1,0]
    v_pk_mul_f32 v[148:149], v[148:149], v[48:49] op_sel_hi:[1,0]
    v_cvt_pk_bf16_f32 v160, v160, v161
    v_cvt_pk_bf16_f32 v41, v90, v91
    v_mfma_f32_16x16x32_bf16 v[64:67], a[224:227], a[128:131], 0
    v_cvt_pk_bf16_f32 v220, v220, v221
    v_fma_f32 v61, v61, s28, v10
    v_cvt_pk_bf16_f32 v180, v180, v181
    v_mfma_f32_16x16x32_bf16 v[64:67], a[220:223], a[124:127], v[64:67]
    s_add_u32 s21, s21, 128
    ds_read_b128 a[232:235], v0 offset:20480
    v_cvt_pk_bf16_f32 v161, v162, v163
    v_mfma_f32_16x16x32_bf16 v[64:67], a[216:219], a[120:123], v[64:67]
    ds_read_b128 a[228:231], v1 offset:19456
    v_fma_f32 v53, v53, s28, v9
    v_cvt_pk_bf16_f32 v116, v116, v117
    v_mfma_f32_16x16x32_bf16 v[72:75], a[216:219], a[144:147], 0
    v_cvt_pk_bf16_f32 v172, v172, v173
    v_cvt_pk_bf16_f32 v216, v216, v217
    v_mfma_f32_16x16x32_bf16 v[72:75], a[220:223], a[148:151], v[72:75]
    v_fma_f32 v77, v77, s28, v12
    v_cvt_pk_bf16_f32 v152, v152, v153
    v_mfma_f32_16x16x32_bf16 v[72:75], a[224:227], a[152:155], v[72:75]
    v_fma_f32 v71, v71, s28, v11
    v_cvt_pk_bf16_f32 v169, v170, v171
    v_mfma_f32_16x16x32_bf16 v[80:83], a[224:227], a[176:179], 0
    v_cvt_pk_bf16_f32 v105, v106, v107
    v_cvt_pk_bf16_f32 v128, v128, v129
    v_mfma_f32_16x16x32_bf16 v[80:83], a[220:223], a[172:175], v[80:83]
    s_add_u32 m0, s22, 38912
    v_cvt_pk_bf16_f32 v129, v130, v131
    v_fma_f32 v62, v62, s28, v10
    v_smfmac_f32_16x16x64_bf16 v[44:47], a[240:243], v[22:29], v101
    buffer_load_dwordx4 v6, s[8:11], s21 offen lds
    v_mfma_f32_16x16x32_bf16 v[80:83], a[216:219], a[168:171], v[80:83]
    s_add_u32 s21, s21, 12032
    v_cvt_pk_bf16_f32 v164, v164, v165
    v_cvt_pk_bf16_f32 v208, v208, v209
    v_accvgpr_read_b32 v111, a15
    v_mfma_f32_16x16x32_bf16 v[88:91], a[216:219], a[192:195], 0
    v_exp_f32_e64 v54, v54 clamp
    v_cvt_pk_bf16_f32 v224, v224, v225
    v_mfma_f32_16x16x32_bf16 v[88:91], a[220:223], a[196:199], v[88:91]
    v_cvt_pk_bf16_f32 v165, v166, v167
    v_cvt_pk_bf16_f32 v144, v144, v145
    v_mfma_f32_16x16x32_bf16 v[88:91], a[224:227], a[200:203], v[88:91]
    s_waitcnt vmcnt(6) lgkmcnt(0)
    v_cvt_pk_bf16_f32 v124, v124, v125
    v_cvt_pk_bf16_f32 v232, v232, v233
    v_mfma_f32_16x16x32_bf16 v[88:91], a[228:231], a[204:207], v[88:91]
    v_cvt_pk_bf16_f32 v212, v212, v213
    v_cvt_pk_bf16_f32 v188, v188, v189
    v_mfma_f32_16x16x32_bf16 v[88:91], a[232:235], a[208:211], v[88:91]
    s_barrier
    v_mfma_f32_16x16x32_bf16 v[88:91], a[236:239], a[212:215], v[88:91]
    ds_read_b64_tr_b16 a[216:217], v2 offset:0
    v_cvt_pk_bf16_f32 v112, v112, v113
    v_cvt_pk_bf16_f32 v209, v210, v211
    v_mfma_f32_16x16x32_bf16 v[80:83], a[236:239], a[188:191], v[80:83]
    ds_read_b64_tr_b16 a[218:219], v2 offset:6144
    v_exp_f32_e64 v71, v71 clamp
    v_cvt_pk_bf16_f32 v225, v226, v227
    v_mfma_f32_16x16x32_bf16 v[80:83], a[232:235], a[184:187], v[80:83]
    ds_read_b64_tr_b16 a[220:221], v3 offset:0
    v_cvt_pk_bf16_f32 v176, v176, v177
    v_mfma_f32_16x16x32_bf16 v[80:83], a[228:231], a[180:183], v[80:83]
    v_exp_f32_e64 v55, v55 clamp
    v_mfma_f32_16x16x32_bf16 v[72:75], a[228:231], a[156:159], v[72:75]
    v_exp_f32_e64 v53, v53 clamp
    v_cvt_pk_bf16_f32 v113, v114, v115
    v_fma_f32 v79, v79, s28, v12
    v_mfma_f32_16x16x32_bf16 v[72:75], a[232:235], a[160:163], v[72:75]
    ds_write2st64_b64 v93, v[112:113], v[160:161] offset0:0 offset1:12
    v_mfma_f32_16x16x32_bf16 v[72:75], a[236:239], a[164:167], v[72:75]
    ds_read_b64_tr_b16 a[222:223], v3 offset:6144
    v_fma_f32 v84, v84, s28, v13
    v_cvt_pk_bf16_f32 v141, v142, v143
    v_mfma_f32_16x16x32_bf16 v[64:67], a[236:239], a[140:143], v[64:67]
    ds_read_b64_tr_b16 a[224:225], v4 offset:0
    v_cvt_pk_bf16_f32 v117, v118, v119
    v_fma_f32 v69, v69, s28, v11
    v_accvgpr_read_b32 v107, a11
    v_mfma_f32_16x16x32_bf16 v[64:67], a[232:235], a[136:139], v[64:67]
    s_add_u32 m0, s22, 12288
    ds_write2st64_b64 v93, v[208:209], v[104:105] offset0:24 offset1:36
    v_pk_mul_f32 v[236:237], v[236:237], v[50:51] op_sel_hi:[1,0]
    v_accvgpr_read_b32 v110, a14
    v_pk_mul_f32 v[206:207], v[206:207], v[92:93] op_sel_hi:[1,0]
    v_cvt_pk_bf16_f32 v184, v184, v185
    v_cvt_pk_bf16_f32 v213, v214, v215
    v_pk_mul_f32 v[178:179], v[178:179], v[92:93] op_sel_hi:[1,0]
    v_cvt_pk_bf16_f32 v217, v218, v219
    v_accvgpr_read_b32 v105, a9
    v_pk_mul_f32 v[192:193], v[192:193], v[92:93] op_sel_hi:[1,0]
    v_pk_mul_f32 v[156:157], v[156:157], v[48:49] op_sel_hi:[1,0]
    v_pk_mul_f32 v[228:229], v[228:229], v[50:51] op_sel_hi:[1,0]
    v_pk_mul_f32 v[194:195], v[194:195], v[92:93] op_sel_hi:[1,0]
    v_accvgpr_read_b32 v104, a8
    v_pk_mul_f32 v[196:197], v[196:197], v[92:93] op_sel_hi:[1,0]
    v_pk_mul_f32 v[242:243], v[242:243], v[50:51] op_sel_hi:[1,0]
    v_pk_mul_f32 v[146:147], v[146:147], v[48:49] op_sel_hi:[1,0]
    v_accvgpr_read_b32 v106, a10
    v_pk_mul_f32 v[186:187], v[186:187], v[92:93] op_sel_hi:[1,0]
    v_pk_mul_f32 v[248:249], v[248:249], v[50:51] op_sel_hi:[1,0]
    v_cvt_pk_bf16_f32 v221, v222, v223
    v_pk_mul_f32 v[238:239], v[238:239], v[50:51] op_sel_hi:[1,0]
    v_pk_mul_f32 v[182:183], v[182:183], v[92:93] op_sel_hi:[1,0]
    v_cvt_pk_bf16_f32 v240, v240, v241
    v_fma_f32 v81, v81, s28, v12
    v_mfma_f32_16x16x32_bf16 v[64:67], a[228:231], a[132:135], v[64:67]
    v_cvt_pk_bf16_f32 v125, v126, v127
    v_exp_f32_e64 v63, v63 clamp
    v_mfma_f32_16x16x32_bf16 v[56:59], a[228:231], a[108:111], v[56:59]
    buffer_load_dwordx4 v6, s[4:7], s20 offen lds
    ds_write2st64_b64 v95, v[116:117], v[164:165] offset0:0 offset1:12
    v_mfma_f32_16x16x32_bf16 v[56:59], a[232:235], a[112:115], v[56:59]
    ds_write2st64_b64 v95, v[212:213], v[108:109] offset0:24 offset1:36
    v_pk_mul_f32 v[252:253], v[252:253], v[50:51] op_sel_hi:[1,0]
    v_accvgpr_read_b32 v108, a12
    v_fma_f32 v91, v91, s28, v13
    v_pk_mul_f32 v[132:133], v[132:133], v[48:49] op_sel_hi:[1,0]
    v_pk_mul_f32 v[138:139], v[138:139], v[48:49] op_sel_hi:[1,0]
    v_accvgpr_read_b32 v109, a13
    v_fma_f32 v66, v66, s28, v10
    v_exp_f32_e64 v77, v77 clamp
    v_pk_mul_f32 v[108:109], v[108:109], v[94:95] op_sel_hi:[1,0]
    v_pk_mul_f32 v[254:255], v[254:255], v[50:51] op_sel_hi:[1,0]
    v_pk_mul_f32 v[110:111], v[110:111], v[94:95] op_sel_hi:[1,0]
    v_pk_mul_f32 v[104:105], v[104:105], v[94:95] op_sel_hi:[1,0]
    v_pk_mul_f32 v[244:245], v[244:245], v[50:51] op_sel_hi:[1,0]
    v_cvt_pk_bf16_f32 v145, v146, v147
    v_fma_f32 v64, v64, s28, v10
    v_pk_mul_f32 v[204:205], v[204:205], v[92:93] op_sel_hi:[1,0]
    v_cvt_pk_bf16_f32 v181, v182, v183
    v_exp_f32_e64 v52, v52 clamp
    v_cvt_pk_bf16_f32 v104, v104, v105
    v_cvt_pk_bf16_f32 v121, v122, v123
    v_pk_mul_f32 v[230:231], v[230:231], v[50:51] op_sel_hi:[1,0]
    v_cvt_pk_bf16_f32 v108, v108, v109
    v_cvt_pk_bf16_f32 v132, v132, v133
    v_mfma_f32_16x16x32_bf16 v[56:59], a[236:239], a[116:119], v[56:59]
    s_waitcnt lgkmcnt(1)
    ds_read_b64_tr_b16 a[234:235], v2 offset:7168
    v_fma_f32 v82, v82, s28, v12
    v_mfma_f32_16x16x32_bf16 v[112:115], a[216:219], v[14:17], 0
    ds_read_b64_tr_b16 a[226:227], v4 offset:6144
    v_exp_f32_e64 v68, v68 clamp
    v_mfma_f32_16x16x32_bf16 v[116:119], a[220:223], v[14:17], 0
    s_add_u32 s20, s20, 128
    ds_write2st64_b64 v8, v[120:121], v[168:169] offset0:0 offset1:12
    v_pk_mul_f32 v[106:107], v[106:107], v[94:95] op_sel_hi:[1,0]
    v_fma_f32 v90, v90, s28, v13
    v_fma_f32 v72, v72, s28, v11
    v_mfma_f32_16x16x32_bf16 v[164:167], a[220:223], v[22:25], 0
    s_add_u32 m0, s22, 13312
    ds_read_b64_tr_b16 a[228:229], v5 offset:0
    v_exp_f32_e64 v69, v69 clamp
    v_fma_f32 v70, v70, s28, v11
    v_smfmac_f32_16x16x64_bf16 v[44:47], a[244:247], v[34:41], v101
    buffer_load_dwordx4 v6, s[4:7], s20 offen lds
    ds_read_b64_tr_b16 a[230:231], v5 offset:6144
    v_cvt_pk_bf16_f32 v105, v106, v107
    v_mfma_f32_16x16x32_bf16 v[160:163], a[216:219], v[22:25], 0
    ds_write2st64_b64 v8, v[216:217], v[104:105] offset0:24 offset1:36
    v_pk_mul_f32 v[198:199], v[198:199], v[92:93] op_sel_hi:[1,0]
    v_cvt_pk_bf16_f32 v156, v156, v157
    v_pk_mul_f32 v[246:247], v[246:247], v[50:51] op_sel_hi:[1,0]
    v_cvt_pk_bf16_f32 v252, v252, v253
    v_cvt_pk_bf16_f32 v148, v148, v149
    v_cvt_pk_bf16_f32 v228, v228, v229
    v_accvgpr_read_b32 v104, a16
    v_mfma_f32_16x16x32_bf16 v[208:211], a[216:219], v[26:29], 0
    ds_read_b64_tr_b16 a[232:233], v2 offset:1024
    v_cvt_pk_bf16_f32 v196, v196, v197
    v_fma_f32 v58, v58, s28, v9
    v_accvgpr_read_b32 v106, a18
    v_accvgpr_read_b32 v107, a19
    v_mfma_f32_16x16x32_bf16 v[212:215], a[220:223], v[26:29], 0
    s_add_u32 s20, s20, 128
    v_cvt_pk_bf16_f32 v173, v174, v175
    v_cvt_pk_bf16_f32 v197, v198, v199
    v_accvgpr_read_b32 v105, a17
    v_mfma_f32_16x16x32_bf16 a[4:7], a[220:223], v[34:37], 0
    ds_read_b64_tr_b16 a[238:239], v3 offset:7168
    v_cvt_pk_bf16_f32 v177, v178, v179
    v_mfma_f32_16x16x32_bf16 a[0:3], a[216:219], v[34:37], 0
    ds_write2st64_b64 v102, v[124:125], v[172:173] offset0:0 offset1:12
    v_pk_mul_f32 v[104:105], v[104:105], v[94:95] op_sel_hi:[1,0]
    v_pk_mul_f32 v[190:191], v[190:191], v[92:93] op_sel_hi:[1,0]
    v_cvt_pk_bf16_f32 v109, v110, v111
    v_pk_mul_f32 v[106:107], v[106:107], v[94:95] op_sel_hi:[1,0]
    v_accvgpr_read_b32 v110, a22
    v_cvt_pk_bf16_f32 v192, v192, v193
    v_mfma_f32_16x16x32_bf16 a[48:51], a[216:219], v[38:41], 0
    ds_write2st64_b64 v102, v[220:221], v[108:109] offset0:24 offset1:36
    v_cvt_pk_bf16_f32 v229, v230, v231
    v_mfma_f32_16x16x32_bf16 a[52:55], a[220:223], v[38:41], 0
    s_waitcnt lgkmcnt(4)
    v_cvt_pk_bf16_f32 v30, v68, v69
    v_accvgpr_read_b32 v108, a20
    v_mfma_f32_16x16x32_bf16 a[56:59], a[224:227], v[38:41], 0
    ds_read_b64_tr_b16 a[236:237], v3 offset:1024
    v_cvt_pk_bf16_f32 v189, v190, v191
    v_accvgpr_read_b32 v109, a21
    v_mfma_f32_16x16x32_bf16 a[60:63], a[228:231], v[38:41], 0
    ds_read_b64_tr_b16 a[222:223], v5 offset:7168
    v_fma_f32 v88, v88, s28, v13
    v_mfma_f32_16x16x32_bf16 a[12:15], a[228:231], v[34:37], 0
    s_add_u32 m0, s22, 14336
    ds_read_b128 v[96:99], v103 offset:0
    buffer_load_dwordx4 v6, s[4:7], s20 offen lds
    v_cvt_pk_bf16_f32 v104, v104, v105
    v_cvt_pk_bf16_f32 v133, v134, v135
    v_pk_mul_f32 v[108:109], v[108:109], v[94:95] op_sel_hi:[1,0]
    v_fma_f32 v67, v67, s28, v10
    v_cvt_pk_bf16_f32 v244, v244, v245
    v_accvgpr_read_b32 v111, a23
    v_pk_mul_f32 v[202:203], v[202:203], v[92:93] op_sel_hi:[1,0]
    v_cvt_pk_bf16_f32 v193, v194, v195
    v_cvt_pk_bf16_f32 v105, v106, v107
    v_mfma_f32_16x16x32_bf16 a[8:11], a[224:227], v[34:37], 0
    v_cvt_pk_bf16_f32 v149, v150, v151
    v_fma_f32 v85, v85, s28, v13
    v_mfma_f32_16x16x32_bf16 v[216:219], a[224:227], v[26:29], 0
    s_add_u32 s20, s20, 12032
    ds_write2st64_b64 v93, v[128:129], v[176:177] offset0:4 offset1:16
    v_mfma_f32_16x16x32_bf16 v[220:223], a[228:231], v[26:29], 0
    ds_write2st64_b64 v93, v[224:225], v[104:105] offset0:28 offset1:40
    v_pk_mul_f32 v[110:111], v[110:111], v[94:95] op_sel_hi:[1,0]
    v_cvt_pk_bf16_f32 v108, v108, v109
    v_exp_f32_e64 v66, v66 clamp
    v_exp_f32_e64 v70, v70 clamp
    v_mfma_f32_16x16x32_bf16 v[172:175], a[228:231], v[22:25], 0
    s_add_u32 m0, s38, 0
    ds_write2st64_b64 v95, v[132:133], v[180:181] offset0:4 offset1:16
    v_cvt_pk_bf16_f32 v109, v110, v111
    v_mfma_f32_16x16x32_bf16 v[168:171], a[224:227], v[22:25], 0
    v_cvt_pk_bf16_f32 v136, v136, v137
    v_accvgpr_read_b32 v104, a24
    v_mfma_f32_16x16x32_bf16 v[120:123], a[224:227], v[14:17], 0
    ds_read_b64_tr_b16 a[216:217], v4 offset:1024
    v_fma_f32 v83, v83, s28, v12
    v_accvgpr_read_b32 v105, a25
    v_cvt_pk_bf16_f32 v204, v204, v205
    v_mfma_f32_16x16x32_bf16 v[124:127], a[228:231], v[14:17], 0
    s_waitcnt lgkmcnt(4)
    ds_write2st64_b64 v95, v[228:229], v[108:109] offset0:28 offset1:40
    v_mfma_f32_16x16x32_bf16 v[128:131], a[232:235], v[14:17], 0
    ds_read_b64_tr_b16 a[226:227], v2 offset:8192
    v_cvt_pk_bf16_f32 v200, v200, v201
    v_mfma_f32_16x16x32_bf16 v[132:135], a[236:239], v[14:17], 0
    ds_read_b64_tr_b16 a[220:221], v5 offset:1024
    v_accvgpr_read_b32 v106, a26
    v_mfma_f32_16x16x32_bf16 v[180:183], a[236:239], v[22:25], 0
    ds_read_b64_tr_b16 a[224:225], v2 offset:2048
    v_cvt_pk_bf16_f32 v185, v186, v187
    v_mfma_f32_16x16x32_bf16 v[176:179], a[232:235], v[22:25], 0
    ds_read_b64_tr_b16 a[230:231], v3 offset:8192
    v_cvt_pk_bf16_f32 v236, v236, v237
    v_mfma_f32_16x16x32_bf16 v[224:227], a[232:235], v[26:29], 0
    ds_read_b64_tr_b16 a[218:219], v4 offset:7168
    v_accvgpr_read_b32 v107, a27
    v_mfma_f32_16x16x32_bf16 v[228:231], a[236:239], v[26:29], 0
    ds_read_b64_tr_b16 a[228:229], v3 offset:2048
    buffer_load_dwordx4 v6, s[12:15], s33 offen nt lds
    v_accvgpr_read_b32 v111, a31
    v_cvt_pk_bf16_f32 v31, v70, v71
    v_accvgpr_read_b32 v109, a29
    v_cvt_pk_bf16_f32 v201, v202, v203
    v_accvgpr_read_b32 v110, a30
    v_pk_mul_f32 v[154:155], v[154:155], v[48:49] op_sel_hi:[1,0]
    v_cvt_pk_bf16_f32 v137, v138, v139
    v_pk_mul_f32 v[110:111], v[110:111], v[94:95] op_sel_hi:[1,0]
    v_accvgpr_read_b32 v108, a28
    v_exp_f32_e64 v61, v61 clamp
    v_fma_f32 v80, v80, s28, v12
    v_fma_f32 v73, v73, s28, v11
    v_pk_mul_f32 v[234:235], v[234:235], v[50:51] op_sel_hi:[1,0]
    v_pk_mul_f32 v[104:105], v[104:105], v[94:95] op_sel_hi:[1,0]
    v_exp_f32_e64 v79, v79 clamp
    v_pk_mul_f32 v[106:107], v[106:107], v[94:95] op_sel_hi:[1,0]
    v_pk_mul_f32 v[108:109], v[108:109], v[94:95] op_sel_hi:[1,0]
    v_fma_f32 v59, v59, s28, v9
    v_cvt_pk_bf16_f32 v18, v52, v53
    v_cvt_pk_bf16_f32 v108, v108, v109
    v_cvt_pk_bf16_f32 v104, v104, v105
    v_cvt_pk_bf16_f32 v105, v106, v107
    v_fma_f32 v57, v57, s28, v9
    v_cvt_pk_bf16_f32 v237, v238, v239
    v_mfma_f32_16x16x32_bf16 a[20:23], a[236:239], v[34:37], 0
    buffer_store_dwordx4 v[96:99], v6, s[16:19], s67 offen offset:0 nt
    v_cvt_pk_bf16_f32 v248, v248, v249
    v_accvgpr_read_b32 v107, a35
    v_cvt_pk_bf16_f32 v109, v110, v111
    v_mfma_f32_16x16x32_bf16 a[16:19], a[232:235], v[34:37], 0
    ds_write2st64_b64 v8, v[136:137], v[184:185] offset0:4 offset1:16
    v_mfma_f32_16x16x32_bf16 a[64:67], a[232:235], v[38:41], 0
    ds_read_b128 v[96:99], v103 offset:1024
    v_cvt_pk_bf16_f32 v233, v234, v235
    v_mfma_f32_16x16x32_bf16 a[68:71], a[236:239], v[38:41], 0
    s_waitcnt lgkmcnt(2)
    ds_write2st64_b64 v8, v[232:233], v[104:105] offset0:28 offset1:40
    v_mfma_f32_16x16x32_bf16 a[72:75], a[216:219], v[38:41], 0
    ds_read_b64_tr_b16 a[232:233], v4 offset:2048
    v_cvt_pk_bf16_f32 v205, v206, v207
    v_accvgpr_read_b32 v110, a38
    v_mfma_f32_16x16x32_bf16 a[76:79], a[220:223], v[38:41], 0
    v_accvgpr_read_b32 v105, a33
    v_exp_f32_e64 v87, v87 clamp
    v_mfma_f32_16x16x32_bf16 a[28:31], a[220:223], v[34:37], 0
    ds_read_b64_tr_b16 a[236:237], v5 offset:2048
    v_exp_f32_e64 v67, v67 clamp
    v_mfma_f32_16x16x32_bf16 a[24:27], a[216:219], v[34:37], 0
    ds_write2st64_b64 v102, v[140:141], v[188:189] offset0:4 offset1:16
    v_mfma_f32_16x16x32_bf16 v[232:235], a[216:219], v[26:29], 0
    s_add_u32 m0, s38, 1024
    ds_write2st64_b64 v102, v[236:237], v[108:109] offset0:28 offset1:40
    v_accvgpr_read_b32 v106, a34
    v_mfma_f32_16x16x32_bf16 v[236:239], a[220:223], v[26:29], 0
    s_waitcnt lgkmcnt(5)
    ds_read_b64_tr_b16 a[238:239], v5 offset:8192
    buffer_load_dwordx4 v7, s[12:15], s33 offen nt lds
    v_accvgpr_read_b32 v111, a39
    v_accvgpr_read_b32 v109, a37
    v_accvgpr_read_b32 v104, a32
    v_pk_mul_f32 v[250:251], v[250:251], v[50:51] op_sel_hi:[1,0]
    v_accvgpr_read_b32 v108, a36
    v_cvt_pk_bf16_f32 v253, v254, v255
    v_pk_mul_f32 v[158:159], v[158:159], v[48:49] op_sel_hi:[1,0]
    v_pk_mul_f32 v[106:107], v[106:107], v[94:95] op_sel_hi:[1,0]
    v_pk_mul_f32 v[108:109], v[108:109], v[94:95] op_sel_hi:[1,0]
    v_pk_mul_f32 v[110:111], v[110:111], v[94:95] op_sel_hi:[1,0]
    v_pk_mul_f32 v[104:105], v[104:105], v[94:95] op_sel_hi:[1,0]
    v_cvt_pk_bf16_f32 v108, v108, v109
    v_cvt_pk_bf16_f32 v241, v242, v243
    v_mfma_f32_16x16x32_bf16 v[188:191], a[220:223], v[22:25], 0
    ds_read_b64_tr_b16 a[234:235], v4 offset:8192
    v_cvt_pk_bf16_f32 v104, v104, v105
    v_cvt_pk_bf16_f32 v105, v106, v107
    v_cvt_pk_bf16_f32 v245, v246, v247
    v_cvt_pk_bf16_f32 v153, v154, v155
    v_mfma_f32_16x16x32_bf16 v[184:187], a[216:219], v[22:25], 0
    s_add_u32 s39, s39, 12288
    v_cvt_pk_bf16_f32 v109, v110, v111
    v_cvt_pk_bf16_f32 v157, v158, v159
    v_mfma_f32_16x16x32_bf16 v[136:139], a[216:219], v[14:17], 0
    ds_write2st64_b64 v93, v[144:145], v[192:193] offset0:8 offset1:20
    v_mfma_f32_16x16x32_bf16 v[140:143], a[220:223], v[14:17], 0
    ds_write2st64_b64 v93, v[240:241], v[104:105] offset0:32 offset1:44
    v_mfma_f32_16x16x32_bf16 v[144:147], a[224:227], v[14:17], 0
    ds_write2st64_b64 v95, v[148:149], v[196:197] offset0:8 offset1:20
    v_exp_f32_e64 v88, v88 clamp
    v_mfma_f32_16x16x32_bf16 v[148:151], a[228:231], v[14:17], 0
    ds_write2st64_b64 v95, v[244:245], v[108:109] offset0:32 offset1:44
    v_mfma_f32_16x16x32_bf16 v[196:199], a[228:231], v[22:25], 0
    v_accvgpr_read_b32 v109, a45
    v_accvgpr_read_b32 v111, a47
    v_mfma_f32_16x16x32_bf16 v[192:195], a[224:227], v[22:25], 0
    s_waitcnt vmcnt(9) lgkmcnt(4)
    v_accvgpr_read_b32 v105, a41
    v_accvgpr_read_b32 v110, a46
    v_mfma_f32_16x16x32_bf16 v[240:243], a[224:227], v[26:29], 0
    buffer_store_dwordx4 v[96:99], v7, s[16:19], s67 offen offset:0 nt
    s_barrier
    ds_write2st64_b64 v8, v[152:153], v[200:201] offset0:8 offset1:20
    v_cvt_pk_bf16_f32 v249, v250, v251
    v_mfma_f32_16x16x32_bf16 v[244:247], a[228:231], v[26:29], 0
    ds_read_b128 a[216:219], v0 offset:0
    v_exp_f32_e64 v60, v60 clamp
    v_mfma_f32_16x16x32_bf16 a[36:39], a[228:231], v[34:37], 0
    v_accvgpr_read_b32 v108, a44
    v_accvgpr_read_b32 v104, a40
    v_fma_f32 v65, v65, s28, v10
    v_accvgpr_read_b32 v106, a42
    v_accvgpr_read_b32 v107, a43
    v_exp_f32_e64 v85, v85 clamp
    v_fma_f32 v56, v56, s28, v9
    v_pk_mul_f32 v[106:107], v[106:107], v[94:95] op_sel_hi:[1,0]
    v_pk_mul_f32 v[104:105], v[104:105], v[94:95] op_sel_hi:[1,0]
    v_pk_mul_f32 v[110:111], v[110:111], v[94:95] op_sel_hi:[1,0]
    v_pk_mul_f32 v[108:109], v[108:109], v[94:95] op_sel_hi:[1,0]
    v_exp_f32_e64 v62, v62 clamp
    v_cvt_pk_bf16_f32 v19, v54, v55
    v_mfma_f32_16x16x32_bf16 a[32:35], a[224:227], v[34:37], 0
    ds_read_b128 a[220:223], v1 offset:0
    v_fma_f32 v89, v89, s28, v13
    v_mfma_f32_16x16x32_bf16 a[80:83], a[224:227], v[38:41], 0
    v_cvt_pk_bf16_f32 v104, v104, v105
    v_exp_f32_e64 v73, v73 clamp
    v_mfma_f32_16x16x32_bf16 a[84:87], a[228:231], v[38:41], 0
    ds_read_b128 a[224:227], v0 offset:1024
    v_cvt_pk_bf16_f32 v105, v106, v107
    v_mfma_f32_16x16x32_bf16 a[88:91], a[232:235], v[38:41], 0
    ds_write2st64_b64 v8, v[248:249], v[104:105] offset0:32 offset1:44
    v_mfma_f32_16x16x32_bf16 a[92:95], a[236:239], v[38:41], 0
    v_cvt_pk_bf16_f32 v108, v108, v109
    v_cvt_pk_bf16_f32 v109, v110, v111
    v_mfma_f32_16x16x32_bf16 a[44:47], a[236:239], v[34:37], 0
    v_exp_f32_e64 v78, v78 clamp
    v_mfma_f32_16x16x32_bf16 a[40:43], a[232:235], v[34:37], 0
    ds_write2st64_b64 v102, v[156:157], v[204:205] offset0:8 offset1:20
    v_mfma_f32_16x16x32_bf16 v[248:251], a[232:235], v[26:29], 0
    ds_write2st64_b64 v102, v[252:253], v[108:109] offset0:32 offset1:44
    v_mfma_f32_16x16x32_bf16 v[252:255], a[236:239], v[26:29], 0
    v_exp_f32_e64 v80, v80 clamp
    v_mfma_f32_16x16x32_bf16 v[204:207], a[236:239], v[22:25], 0
    v_exp_f32_e64 v86, v86 clamp
    v_mfma_f32_16x16x32_bf16 v[200:203], a[232:235], v[22:25], 0
    s_add_u32 m0, s22, 24576
    v_exp_f32_e64 v90, v90 clamp
    v_mfma_f32_16x16x32_bf16 v[152:155], a[232:235], v[14:17], 0
    ds_read_b128 a[228:231], v1 offset:1024
    v_cvt_pk_bf16_f32 v22, v60, v61
    v_mfma_f32_16x16x32_bf16 v[156:159], a[236:239], v[14:17], 0
    s_waitcnt lgkmcnt(3)
    v_exp_f32_e64 v65, v65 clamp
    v_mfma_f32_16x16x32_bf16 v[52:55], a[216:219], a[96:99], 0
    v_exp_f32_e64 v59, v59 clamp
    v_mfma_f32_16x16x32_bf16 v[52:55], a[220:223], a[100:103], v[52:55]
    ds_read_b128 v[96:99], v103 offset:2048
    v_cvt_pk_bf16_f32 v23, v62, v63
    v_mfma_f32_16x16x32_bf16 v[52:55], a[224:227], a[104:107], v[52:55]
    buffer_load_dwordx4 v6, s[8:11], s21 offen lds
    v_mfma_f32_16x16x32_bf16 v[60:63], a[224:227], a[128:131], 0
    s_add_u32 s21, s21, 128
    ds_read_b128 a[236:239], v1 offset:2048
    v_cvt_pk_bf16_f32 v35, v78, v79
    v_mfma_f32_16x16x32_bf16 v[60:63], a[220:223], a[124:127], v[60:63]
    s_add_u32 m0, s22, 25600
    v_cvt_pk_bf16_f32 v43, v86, v87
    v_cvt_pk_bf16_f32 v21, v66, v67
    v_mfma_f32_16x16x32_bf16 v[60:63], a[216:219], a[120:123], v[60:63]
    ds_read_b128 a[232:235], v0 offset:2048
    v_cvt_pk_bf16_f32 v34, v76, v77
    v_mfma_f32_16x16x32_bf16 v[68:71], a[216:219], a[144:147], 0
    buffer_load_dwordx4 v6, s[8:11], s21 offen lds
    v_mfma_f32_16x16x32_bf16 v[68:71], a[220:223], a[148:151], v[68:71]
    s_add_u32 s21, s21, 128
    v_exp_f32_e64 v64, v64 clamp
    v_mfma_f32_16x16x32_bf16 v[68:71], a[224:227], a[152:155], v[68:71]
    s_add_u32 m0, s22, 26624
    v_exp_f32_e64 v82, v82 clamp
    v_mfma_f32_16x16x32_bf16 v[76:79], a[224:227], a[176:179], 0
    v_exp_f32_e64 v89, v89 clamp
    v_fma_f32 v74, v74, s28, v11
    v_mfma_f32_16x16x32_bf16 v[76:79], a[220:223], a[172:175], v[76:79]
    v_exp_f32_e64 v84, v84 clamp
    v_mfma_f32_16x16x32_bf16 v[76:79], a[216:219], a[168:171], v[76:79]
    v_cvt_pk_bf16_f32 v40, v88, v89
    v_cvt_pk_bf16_f32 v42, v84, v85
    v_mfma_f32_16x16x32_bf16 v[84:87], a[216:219], a[192:195], 0
    v_exp_f32_e64 v58, v58 clamp
    v_mfma_f32_16x16x32_bf16 v[84:87], a[220:223], a[196:199], v[84:87]
    v_exp_f32_e64 v91, v91 clamp
    v_mfma_f32_16x16x32_bf16 v[84:87], a[224:227], a[200:203], v[84:87]
    s_waitcnt lgkmcnt(1)
    v_exp_f32_e64 v56, v56 clamp
    v_mfma_f32_16x16x32_bf16 v[84:87], a[228:231], a[204:207], v[84:87]
    s_waitcnt lgkmcnt(0)
    v_exp_f32_e64 v83, v83 clamp
    v_mfma_f32_16x16x32_bf16 v[84:87], a[232:235], a[208:211], v[84:87]
    ds_read_b128 a[220:223], v1 offset:6144
    v_cvt_pk_bf16_f32 v41, v90, v91
    v_mfma_f32_16x16x32_bf16 v[84:87], a[236:239], a[212:215], v[84:87]
    v_exp_f32_e64 v81, v81 clamp
    v_mfma_f32_16x16x32_bf16 v[76:79], a[236:239], a[188:191], v[76:79]
    ds_read_b128 a[216:219], v0 offset:6144
    v_fma_f32 v75, v75, s28, v11
    v_mfma_f32_16x16x32_bf16 v[48:51], a[248:251], v[40:43], 0
    buffer_load_dwordx4 v6, s[8:11], s21 offen lds
    v_mfma_f32_16x16x32_bf16 v[76:79], a[232:235], a[184:187], v[76:79]
    v_cvt_pk_bf16_f32 v17, v58, v59
    s_add_u32 s21, s21, 12032
    v_mfma_f32_16x16x32_bf16 v[76:79], a[228:231], a[180:183], v[76:79]
    s_add_u32 s56, s67, 128
    v_exp_f32_e64 v74, v74 clamp
    v_mfma_f32_16x16x32_bf16 v[68:71], a[228:231], a[156:159], v[68:71]
    v_exp_f32_e64 v75, v75 clamp
    v_mfma_f32_16x16x32_bf16 v[68:71], a[232:235], a[160:163], v[68:71]
    s_add_u32 s58, s33, 128
    ds_read_b128 a[224:227], v0 offset:7168
    v_cvt_pk_bf16_f32 v32, v80, v81
    v_mfma_f32_16x16x32_bf16 v[68:71], a[236:239], a[164:167], v[68:71]
    v_exp_f32_e64 v57, v57 clamp
    v_mfma_f32_16x16x32_bf16 v[60:63], a[236:239], a[140:143], v[60:63]
    v_cvt_pk_bf16_f32 v16, v56, v57
    v_cvt_pk_bf16_f32 v20, v64, v65
    v_mfma_f32_16x16x32_bf16 v[60:63], a[232:235], a[136:139], v[60:63]
    buffer_store_dwordx4 v[96:99], v6, s[16:19], s56 offen offset:0 nt
    s_add_u32 m0, s38, 2048
    v_cvt_pk_bf16_f32 v29, v74, v75
    v_exp_f32_e64 v72, v72 clamp
    v_mfma_f32_16x16x32_bf16 v[60:63], a[228:231], a[132:135], v[60:63]
    v_cvt_pk_bf16_f32 v33, v82, v83
    v_cvt_pk_bf16_f32 v28, v72, v73
    v_smfmac_f32_16x16x64_bf16 v[48:51], a[240:243], v[16:23], v101
    buffer_load_dwordx4 v6, s[12:15], s58 offen nt lds
    v_smfmac_f32_16x16x64_bf16 v[48:51], a[244:247], v[28:35], v101
    ds_read_b128 v[96:99], v103 offset:3072
    v_mfma_f32_16x16x32_bf16 v[52:55], a[228:231], a[108:111], v[52:55]
    ds_read_b128 a[228:231], v1 offset:7168
    v_mfma_f32_16x16x32_bf16 v[52:55], a[232:235], a[112:115], v[52:55]
    s_add_u32 m0, s38, 3072
    ds_read_b128 a[232:235], v0 offset:8192
    v_mfma_f32_16x16x32_bf16 v[52:55], a[236:239], a[116:119], v[52:55]
    s_nop 0
    v_cmp_lt_f32 vcc, s29, v48
    s_waitcnt lgkmcnt(3)
    v_mfma_f32_16x16x32_bf16 v[56:59], a[216:219], a[96:99], 0
    ds_read_b128 a[236:239], v1 offset:8192
    v_add_u32 v103, 4096, v103
    v_mfma_f32_16x16x32_bf16 v[56:59], a[220:223], a[100:103], v[56:59]
    s_cbranch_vccnz L_rs_tr45d
L_ret_tr45d:
    v_fma_f32 v61, v61, s28, v10
    v_mfma_f32_16x16x32_bf16 v[56:59], a[224:227], a[104:107], v[56:59]
    v_fma_f32 v63, v63, s28, v10
    v_fma_f32 v54, v54, s28, v9
    v_mfma_f32_16x16x32_bf16 v[64:67], a[224:227], a[128:131], 0
    v_fma_f32 v60, v60, s28, v10
    v_fma_f32 v52, v52, s28, v9
    v_mfma_f32_16x16x32_bf16 v[64:67], a[220:223], a[124:127], v[64:67]
    v_exp_f32_e64 v52, v52 clamp
    v_mfma_f32_16x16x32_bf16 v[64:67], a[216:219], a[120:123], v[64:67]
    v_exp_f32_e64 v61, v61 clamp
    v_mfma_f32_16x16x32_bf16 v[72:75], a[216:219], a[144:147], 0
    v_exp_f32_e64 v63, v63 clamp
    v_mfma_f32_16x16x32_bf16 v[72:75], a[220:223], a[148:151], v[72:75]
    s_waitcnt lgkmcnt(2)
    buffer_load_dwordx4 v7, s[12:15], s58 offen nt lds
    v_mfma_f32_16x16x32_bf16 v[72:75], a[224:227], a[152:155], v[72:75]
    v_exp_f32_e64 v60, v60 clamp
    v_mfma_f32_16x16x32_bf16 v[80:83], a[224:227], a[176:179], 0
    v_fma_f32 v62, v62, s28, v10
    s_waitcnt vmcnt(13) lgkmcnt(0)
    v_mfma_f32_16x16x32_bf16 v[80:83], a[220:223], a[172:175], v[80:83]
    s_barrier
    v_mfma_f32_16x16x32_bf16 v[80:83], a[216:219], a[168:171], v[80:83]
    v_fma_f32 v55, v55, s28, v9
    v_mfma_f32_16x16x32_bf16 v[88:91], a[216:219], a[192:195], 0
    ds_read_b64_tr_b16 a[216:217], v2 offset:18432
    v_mfma_f32_16x16x32_bf16 v[88:91], a[220:223], a[196:199], v[88:91]
    ds_read_b64_tr_b16 a[218:219], v2 offset:12288
    s_add_u32 m0, s22, 0
    v_mfma_f32_16x16x32_bf16 v[88:91], a[224:227], a[200:203], v[88:91]
    v_fma_f32 v53, v53, s28, v9
    v_mfma_f32_16x16x32_bf16 v[88:91], a[228:231], a[204:207], v[88:91]
    ds_read_b64_tr_b16 a[220:221], v3 offset:18432
    v_mfma_f32_16x16x32_bf16 v[88:91], a[232:235], a[208:211], v[88:91]
    buffer_load_dwordx4 v6, s[4:7], s20 offen lds
    v_mfma_f32_16x16x32_bf16 v[88:91], a[236:239], a[212:215], v[88:91]
    ds_read_b64_tr_b16 a[222:223], v3 offset:12288
    v_mfma_f32_16x16x32_bf16 v[80:83], a[236:239], a[188:191], v[80:83]
    v_exp_f32_e64 v53, v53 clamp
    v_mfma_f32_16x16x32_bf16 v[80:83], a[232:235], a[184:187], v[80:83]
    v_exp_f32_e64 v62, v62 clamp
    v_mfma_f32_16x16x32_bf16 v[80:83], a[228:231], a[180:183], v[80:83]
    v_exp_f32_e64 v54, v54 clamp
    v_mfma_f32_16x16x32_bf16 v[72:75], a[228:231], a[156:159], v[72:75]
    s_add_u32 s20, s20, 128
    ds_read_b64_tr_b16 a[224:225], v4 offset:18432
    v_cvt_pk_bf16_f32 v14, v52, v53
    v_mfma_f32_16x16x32_bf16 v[72:75], a[232:235], a[160:163], v[72:75]
    s_add_u32 m0, s22, 1024
    v_exp_f32_e64 v55, v55 clamp
    v_mfma_f32_16x16x32_bf16 v[72:75], a[236:239], a[164:167], v[72:75]
    buffer_load_dwordx4 v6, s[4:7], s20 offen lds
    v_mfma_f32_16x16x32_bf16 v[64:67], a[236:239], a[140:143], v[64:67]
    s_add_u32 s20, s20, 128
    s_add_u32 m0, s22, 2048
    v_cvt_pk_bf16_f32 v15, v54, v55
    v_mfma_f32_16x16x32_bf16 v[64:67], a[232:235], a[136:139], v[64:67]
    ds_read_b64_tr_b16 a[226:227], v4 offset:12288
    v_mfma_f32_16x16x32_bf16 v[64:67], a[228:231], a[132:135], v[64:67]
    buffer_load_dwordx4 v6, s[4:7], s20 offen lds
    v_mfma_f32_16x16x32_bf16 v[56:59], a[228:231], a[108:111], v[56:59]
    s_add_u32 s20, s20, 12032
    s_bitcmp1_b32 s3, 1
    ds_read_b64_tr_b16 a[228:229], v5 offset:18432
    v_mfma_f32_16x16x32_bf16 v[56:59], a[232:235], a[112:115], v[56:59]
    s_waitcnt lgkmcnt(3)
    ds_read_b64_tr_b16 a[230:231], v5 offset:12288
    v_mfma_f32_16x16x32_bf16 v[56:59], a[236:239], a[116:119], v[56:59]
    buffer_store_dwordx4 v[96:99], v7, s[16:19], s56 offen offset:0 nt
    s_cbranch_scc1 L_loop5w1
    s_branch L_loop5w0
L_tr44:
    v_mfma_f32_16x16x32_bf16 v[112:115], a[216:219], v[16:19], v[112:115]
    ds_read_b64_tr_b16 a[238:239], v3 offset:13312
    v_mfma_f32_16x16x32_bf16 v[160:163], a[216:219], v[20:23], v[160:163]
    ds_read_b64_tr_b16 a[236:237], v3 offset:19456
    v_fma_f32 v77, v77, s28, v12
    v_fma_f32 v68, v68, s28, v11
    v_mfma_f32_16x16x32_bf16 v[208:211], a[216:219], v[28:31], v[208:211]
    ds_read_b64_tr_b16 a[232:233], v2 offset:19456
    v_fma_f32 v71, v71, s28, v11
    v_mfma_f32_16x16x32_bf16 a[0:3], a[216:219], v[32:35], a[0:3]
    ds_read_b64_tr_b16 a[234:235], v2 offset:13312
    s_waitcnt lgkmcnt(8)
    v_mfma_f32_16x16x32_bf16 a[4:7], a[220:223], v[32:35], a[4:7]
    v_exp_f32_e64 v68, v68 clamp
    v_mfma_f32_16x16x32_bf16 v[212:215], a[220:223], v[28:31], v[212:215]
    v_fma_f32 v58, v58, s28, v9
    v_fma_f32 v79, v79, s28, v12
    v_mfma_f32_16x16x32_bf16 v[164:167], a[220:223], v[20:23], v[164:167]
    v_exp_f32_e64 v79, v79 clamp
    v_mfma_f32_16x16x32_bf16 v[116:119], a[220:223], v[16:19], v[116:119]
    v_fma_f32 v80, v80, s28, v12
    s_waitcnt lgkmcnt(6)
    v_mfma_f32_16x16x32_bf16 v[120:123], a[224:227], v[16:19], v[120:123]
    v_exp_f32_e64 v80, v80 clamp
    v_mfma_f32_16x16x32_bf16 v[168:171], a[224:227], v[20:23], v[168:171]
    ds_read_b64_tr_b16 a[218:219], v4 offset:13312
    v_fma_f32 v76, v76, s28, v12
    v_mfma_f32_16x16x32_bf16 v[216:219], a[224:227], v[28:31], v[216:219]
    v_fma_f32 v82, v82, s28, v12
    v_fma_f32 v74, v74, s28, v11
    v_mfma_f32_16x16x32_bf16 a[8:11], a[224:227], v[32:35], a[8:11]
    s_waitcnt lgkmcnt(3)
    ds_read_b64_tr_b16 a[222:223], v5 offset:13312
    v_fma_f32 v75, v75, s28, v11
    v_mfma_f32_16x16x32_bf16 a[12:15], a[228:231], v[32:35], a[12:15]
    ds_read_b64_tr_b16 a[216:217], v4 offset:19456
    v_fma_f32 v78, v78, s28, v12
    v_mfma_f32_16x16x32_bf16 v[220:223], a[228:231], v[28:31], v[220:223]
    ds_read_b64_tr_b16 a[226:227], v2 offset:14336
    v_fma_f32 v66, v66, s28, v10
    v_mfma_f32_16x16x32_bf16 v[172:175], a[228:231], v[20:23], v[172:175]
    v_fma_f32 v57, v57, s28, v9
    v_fma_f32 v63, v63, s28, v10
    v_mfma_f32_16x16x32_bf16 v[124:127], a[228:231], v[16:19], v[124:127]
    s_waitcnt lgkmcnt(4)
    ds_read_b64_tr_b16 a[228:229], v3 offset:20480
    v_fma_f32 v62, v62, s28, v10
    v_mfma_f32_16x16x32_bf16 v[128:131], a[232:235], v[16:19], v[128:131]
    ds_read_b64_tr_b16 a[224:225], v2 offset:20480
    v_fma_f32 v73, v73, s28, v11
    v_mfma_f32_16x16x32_bf16 v[176:179], a[232:235], v[20:23], v[176:179]
    ds_read_b64_tr_b16 a[220:221], v5 offset:19456
    v_fma_f32 v69, v69, s28, v11
    v_mfma_f32_16x16x32_bf16 v[224:227], a[232:235], v[28:31], v[224:227]
    ds_read_b64_tr_b16 a[230:231], v3 offset:14336
    v_fma_f32 v83, v83, s28, v12
    v_mfma_f32_16x16x32_bf16 a[16:19], a[232:235], v[32:35], a[16:19]
    ds_read_b64_tr_b16 a[232:233], v4 offset:20480
    v_mfma_f32_16x16x32_bf16 a[20:23], a[236:239], v[32:35], a[20:23]
    s_add_u32 s39, s39, 12288
    ds_read_b128 v[84:87], v103 offset:0
    v_mfma_f32_16x16x32_bf16 v[228:231], a[236:239], v[28:31], v[228:231]
    v_fma_f32 v67, v67, s28, v10
    v_fma_f32 v72, v72, s28, v11
    v_mfma_f32_16x16x32_bf16 v[180:183], a[236:239], v[20:23], v[180:183]
    ds_read_b64_tr_b16 a[234:235], v4 offset:14336
    v_mfma_f32_16x16x32_bf16 v[132:135], a[236:239], v[16:19], v[132:135]
    s_waitcnt lgkmcnt(7)
    ds_read_b64_tr_b16 a[238:239], v5 offset:14336
    v_fma_f32 v70, v70, s28, v11
    v_mfma_f32_16x16x32_bf16 v[136:139], a[216:219], v[16:19], v[136:139]
    ds_read_b64_tr_b16 a[236:237], v5 offset:20480
    v_mfma_f32_16x16x32_bf16 v[184:187], a[216:219], v[20:23], v[184:187]
    v_exp_f32_e64 v63, v63 clamp
    v_mfma_f32_16x16x32_bf16 v[232:235], a[216:219], v[28:31], v[232:235]
    v_exp_f32_e64 v82, v82 clamp
    v_mfma_f32_16x16x32_bf16 a[24:27], a[216:219], v[32:35], a[24:27]
    s_waitcnt lgkmcnt(6)
    v_exp_f32_e64 v70, v70 clamp
    v_mfma_f32_16x16x32_bf16 a[28:31], a[220:223], v[32:35], a[28:31]
    v_exp_f32_e64 v67, v67 clamp
    v_mfma_f32_16x16x32_bf16 v[236:239], a[220:223], v[28:31], v[236:239]
    v_exp_f32_e64 v83, v83 clamp
    v_mfma_f32_16x16x32_bf16 v[188:191], a[220:223], v[20:23], v[188:191]
    v_exp_f32_e64 v71, v71 clamp
    v_mfma_f32_16x16x32_bf16 v[140:143], a[220:223], v[16:19], v[140:143]
    v_exp_f32_e64 v78, v78 clamp
    v_mfma_f32_16x16x32_bf16 v[144:147], a[224:227], v[16:19], v[144:147]
    v_exp_f32_e64 v77, v77 clamp
    v_mfma_f32_16x16x32_bf16 v[192:195], a[224:227], v[20:23], v[192:195]
    v_exp_f32_e64 v69, v69 clamp
    v_mfma_f32_16x16x32_bf16 v[240:243], a[224:227], v[28:31], v[240:243]
    s_waitcnt vmcnt(10) lgkmcnt(0)
    ds_read_b128 v[88:91], v103 offset:1024
    v_cvt_pk_bf16_f32 v27, v70, v71
    v_mfma_f32_16x16x32_bf16 a[32:35], a[224:227], v[32:35], a[32:35]
    s_barrier
    v_mfma_f32_16x16x32_bf16 a[36:39], a[228:231], v[32:35], a[36:39]
    ds_read_b128 a[220:223], v1 offset:12288
    v_mfma_f32_16x16x32_bf16 v[244:247], a[228:231], v[28:31], v[244:247]
    s_add_u32 m0, s22, 36864
    ds_read_b128 a[216:219], v0 offset:12288
    v_fma_f32 v65, v65, s28, v10
    v_mfma_f32_16x16x32_bf16 v[196:199], a[228:231], v[20:23], v[196:199]
    buffer_load_dwordx4 v6, s[8:11], s21 offen lds
    v_mfma_f32_16x16x32_bf16 v[148:151], a[228:231], v[16:19], v[148:151]
    ds_read_b128 a[224:227], v0 offset:13312
    v_fma_f32 v64, v64, s28, v10
    v_mfma_f32_16x16x32_bf16 v[152:155], a[232:235], v[16:19], v[152:155]
    s_add_u32 s21, s21, 128
    v_exp_f32_e64 v72, v72 clamp
    v_mfma_f32_16x16x32_bf16 v[200:203], a[232:235], v[20:23], v[200:203]
    v_fma_f32 v81, v81, s28, v12
    v_cvt_pk_bf16_f32 v26, v68, v69
    v_mfma_f32_16x16x32_bf16 v[248:251], a[232:235], v[28:31], v[248:251]
    s_add_u32 m0, s22, 37888
    v_exp_f32_e64 v76, v76 clamp
    v_mfma_f32_16x16x32_bf16 a[40:43], a[232:235], v[32:35], a[40:43]
    buffer_load_dwordx4 v6, s[8:11], s21 offen lds
    v_mfma_f32_16x16x32_bf16 a[44:47], a[236:239], v[32:35], a[44:47]
    s_add_u32 s21, s21, 128
    s_add_u32 m0, s22, 38912
    ds_read_b128 a[232:235], v0 offset:14336
    v_mfma_f32_16x16x32_bf16 v[252:255], a[236:239], v[28:31], v[252:255]
    v_exp_f32_e64 v81, v81 clamp
    v_mfma_f32_16x16x32_bf16 v[204:207], a[236:239], v[20:23], v[204:207]
    buffer_load_dwordx4 v6, s[8:11], s21 offen lds
    v_mfma_f32_16x16x32_bf16 v[156:159], a[236:239], v[16:19], v[156:159]
    s_waitcnt lgkmcnt(2)
    ds_read_b128 a[228:231], v1 offset:13312
    v_cvt_pk_bf16_f32 v34, v76, v77
    v_mfma_f32_16x16x32_bf16 v[52:55], a[216:219], a[96:99], 0
    v_exp_f32_e64 v62, v62 clamp
    v_mfma_f32_16x16x32_bf16 v[52:55], a[220:223], a[100:103], v[52:55]
    s_waitcnt lgkmcnt(2)
    ds_read_b128 a[236:239], v1 offset:14336
    v_cvt_pk_bf16_f32 v22, v60, v61
    v_mfma_f32_16x16x32_bf16 v[52:55], a[224:227], a[104:107], v[52:55]
    v_cvt_pk_bf16_f32 v23, v62, v63
    v_fma_f32 v56, v56, s28, v9
    v_mfma_f32_16x16x32_bf16 v[60:63], a[224:227], a[128:131], 0
    v_cvt_pk_bf16_f32 v36, v80, v81
    v_mfma_f32_16x16x32_bf16 v[60:63], a[220:223], a[124:127], v[60:63]
    v_mfma_f32_16x16x32_bf16 v[60:63], a[216:219], a[120:123], v[60:63]
    v_exp_f32_e64 v73, v73 clamp
    v_mfma_f32_16x16x32_bf16 v[68:71], a[216:219], a[144:147], 0
    v_exp_f32_e64 v74, v74 clamp
    v_mfma_f32_16x16x32_bf16 v[68:71], a[220:223], a[148:151], v[68:71]
    v_exp_f32_e64 v75, v75 clamp
    v_mfma_f32_16x16x32_bf16 v[68:71], a[224:227], a[152:155], v[68:71]
    v_cvt_pk_bf16_f32 v35, v78, v79
    v_mfma_f32_16x16x32_bf16 v[76:79], a[224:227], a[176:179], 0
    v_exp_f32_e64 v66, v66 clamp
    v_mfma_f32_16x16x32_bf16 v[76:79], a[220:223], a[172:175], v[76:79]
    v_exp_f32_e64 v65, v65 clamp
    v_mfma_f32_16x16x32_bf16 v[76:79], a[216:219], a[168:171], v[76:79]
    s_waitcnt lgkmcnt(0)
    v_exp_f32_e64 v64, v64 clamp
    v_mfma_f32_16x16x32_bf16 v[76:79], a[228:231], a[180:183], v[76:79]
    v_cvt_pk_bf16_f32 v28, v72, v73
    v_mfma_f32_16x16x32_bf16 v[76:79], a[232:235], a[184:187], v[76:79]
    v_exp_f32_e64 v56, v56 clamp
    v_mfma_f32_16x16x32_bf16 v[76:79], a[236:239], a[188:191], v[76:79]
    ds_read_b128 a[220:223], v1 offset:18432
    v_fma_f32 v59, v59, s28, v9
    v_mfma_f32_16x16x32_bf16 v[68:71], a[236:239], a[164:167], v[68:71]
    ds_read_b128 a[216:219], v0 offset:18432
    v_cvt_pk_bf16_f32 v24, v64, v65
    v_mfma_f32_16x16x32_bf16 v[68:71], a[232:235], a[160:163], v[68:71]
    v_exp_f32_e64 v57, v57 clamp
    v_mfma_f32_16x16x32_bf16 v[68:71], a[228:231], a[156:159], v[68:71]
    v_exp_f32_e64 v59, v59 clamp
    v_mfma_f32_16x16x32_bf16 v[60:63], a[228:231], a[132:135], v[60:63]
    v_exp_f32_e64 v58, v58 clamp
    v_mfma_f32_16x16x32_bf16 v[60:63], a[232:235], a[136:139], v[60:63]
    s_add_u32 s21, s21, 12032
    ds_read_b128 a[224:227], v0 offset:19456
    v_cvt_pk_bf16_f32 v16, v56, v57
    v_mfma_f32_16x16x32_bf16 v[60:63], a[236:239], a[140:143], v[60:63]
    v_cvt_pk_bf16_f32 v17, v58, v59
    v_mfma_f32_16x16x32_bf16 v[52:55], a[236:239], a[116:119], v[52:55]
    v_cvt_pk_bf16_f32 v25, v66, v67
    v_mfma_f32_16x16x32_bf16 v[52:55], a[232:235], a[112:115], v[52:55]
    ds_read_b128 a[232:235], v0 offset:20480
    v_cvt_pk_bf16_f32 v29, v74, v75
    v_mfma_f32_16x16x32_bf16 v[44:47], a[248:251], v[14:17], v[44:47]
    ds_read_b128 v[96:99], v103 offset:2048
    v_cvt_pk_bf16_f32 v37, v82, v83
    v_mfma_f32_16x16x32_bf16 v[52:55], a[228:231], a[108:111], v[52:55]
    ds_read_b128 a[236:239], v1 offset:20480
    v_smfmac_f32_16x16x64_bf16 v[44:47], a[240:243], v[22:29], v101
    ds_read_b128 a[228:231], v1 offset:19456
    v_mfma_f32_16x16x32_bf16 v[44:47], a[252:255], v[34:37], v[44:47]
    s_add_u32 s57, s24, 128
    s_waitcnt lgkmcnt(5)
    v_mfma_f32_16x16x32_bf16 v[56:59], a[216:219], a[96:99], 0
    buffer_store_dwordx4 v[84:87], v6, s[16:19], s24 offen offset:0 nt
    s_nop 3
    v_cmp_lt_f32 vcc, s29, v44
    v_mfma_f32_16x16x32_bf16 v[56:59], a[220:223], a[100:103], v[56:59]
    s_waitcnt lgkmcnt(4)
    ds_read_b128 v[84:87], v103 offset:3072
    v_mfma_f32_16x16x32_bf16 v[56:59], a[224:227], a[104:107], v[56:59]
    s_nop 0
    s_cbranch_vccnz L_rs_tr44a
L_ret_tr44a:
    v_mfma_f32_16x16x32_bf16 v[64:67], a[224:227], a[128:131], 0
    v_mfma_f32_16x16x32_bf16 v[64:67], a[220:223], a[124:127], v[64:67]
    v_fma_f32 v60, v60, s28, v10
    v_fma_f32 v52, v52, s28, v9
    v_mfma_f32_16x16x32_bf16 v[64:67], a[216:219], a[120:123], v[64:67]
    v_exp_f32_e64 v52, v52 clamp
    v_mfma_f32_16x16x32_bf16 v[72:75], a[216:219], a[144:147], 0
    buffer_store_dwordx4 v[88:91], v7, s[16:19], s24 offen offset:0 nt
    s_waitcnt vmcnt(8) lgkmcnt(1)
    s_barrier
    v_fma_f32 v53, v53, s28, v9
    v_mfma_f32_16x16x32_bf16 v[72:75], a[220:223], a[148:151], v[72:75]
    s_add_u32 m0, s22, 12288
    v_fma_f32 v54, v54, s28, v9
    v_fma_f32 v55, v55, s28, v9
    v_mfma_f32_16x16x32_bf16 v[72:75], a[224:227], a[152:155], v[72:75]
    buffer_load_dwordx4 v6, s[4:7], s20 offen lds
    v_mfma_f32_16x16x32_bf16 v[80:83], a[224:227], a[176:179], 0
    s_add_u32 s20, s20, 128
    v_fma_f32 v61, v61, s28, v10
    s_add_u32 m0, s22, 13312
    v_mfma_f32_16x16x32_bf16 v[80:83], a[220:223], a[172:175], v[80:83]
    buffer_load_dwordx4 v6, s[4:7], s20 offen lds
    v_mfma_f32_16x16x32_bf16 v[80:83], a[216:219], a[168:171], v[80:83]
    ds_read_b64_tr_b16 a[216:217], v2 offset:0
    s_add_u32 s20, s20, 128
    v_mfma_f32_16x16x32_bf16 v[80:83], a[228:231], a[180:183], v[80:83]
    ds_read_b64_tr_b16 a[218:219], v2 offset:6144
    v_mfma_f32_16x16x32_bf16 v[80:83], a[232:235], a[184:187], v[80:83]
    v_mfma_f32_16x16x32_bf16 v[80:83], a[236:239], a[188:191], v[80:83]
    ds_read_b64_tr_b16 a[220:221], v3 offset:0
    s_add_u32 m0, s22, 14336
    v_mfma_f32_16x16x32_bf16 v[72:75], a[236:239], a[164:167], v[72:75]
    buffer_load_dwordx4 v6, s[4:7], s20 offen lds
    v_mfma_f32_16x16x32_bf16 v[72:75], a[232:235], a[160:163], v[72:75]
    s_add_u32 s20, s20, 12032
    v_exp_f32_e64 v53, v53 clamp
    v_mfma_f32_16x16x32_bf16 v[72:75], a[228:231], a[156:159], v[72:75]
    buffer_store_dwordx4 v[96:99], v6, s[16:19], s57 offen offset:0 nt
    ds_read_b64_tr_b16 a[222:223], v3 offset:6144
    v_exp_f32_e64 v55, v55 clamp
    v_mfma_f32_16x16x32_bf16 v[64:67], a[228:231], a[132:135], v[64:67]
    v_exp_f32_e64 v54, v54 clamp
    v_mfma_f32_16x16x32_bf16 v[64:67], a[232:235], a[136:139], v[64:67]
    ds_read_b64_tr_b16 a[224:225], v4 offset:0
    v_cvt_pk_bf16_f32 v18, v52, v53
    v_mfma_f32_16x16x32_bf16 v[64:67], a[236:239], a[140:143], v[64:67]
    v_exp_f32_e64 v61, v61 clamp
    v_mfma_f32_16x16x32_bf16 v[56:59], a[236:239], a[116:119], v[56:59]
    v_exp_f32_e64 v60, v60 clamp
    v_mfma_f32_16x16x32_bf16 v[56:59], a[232:235], a[112:115], v[56:59]
    s_waitcnt lgkmcnt(3)
    ds_read_b64_tr_b16 a[226:227], v4 offset:6144
    v_cvt_pk_bf16_f32 v19, v54, v55
    v_mfma_f32_16x16x32_bf16 v[56:59], a[228:231], a[108:111], v[56:59]
    buffer_store_dwordx4 v[84:87], v7, s[16:19], s57 offen offset:0 nt
    ds_read_b64_tr_b16 a[228:229], v5 offset:0
    ds_read_b64_tr_b16 a[230:231], v5 offset:6144
    v_mfma_f32_16x16x32_bf16 v[112:115], a[216:219], v[14:17], v[112:115]
    ds_read_b64_tr_b16 a[234:235], v2 offset:7168
    v_fma_f32 v62, v62, s28, v10
    v_lshrrev_b32 v105, 11, v0
    v_mfma_f32_16x16x32_bf16 v[160:163], a[216:219], v[22:25], v[160:163]
    v_xor_b32 v105, s65, v105
    v_fma_f32 v65, v65, s28, v10
    v_fma_f32 v59, v59, s28, v9
    v_fma_f32 v83, v83, s28, v12
    v_mfma_f32_16x16x32_bf16 v[208:211], a[216:219], v[26:29], v[208:211]
    ds_read_b64_tr_b16 a[238:239], v3 offset:7168
    v_fma_f32 v75, v75, s28, v11
    v_mfma_f32_16x16x32_bf16 a[0:3], a[216:219], v[34:37], a[0:3]
    s_waitcnt lgkmcnt(6)
    ds_read_b64_tr_b16 a[236:237], v3 offset:1024
    v_fma_f32 v72, v72, s28, v11
    v_mfma_f32_16x16x32_bf16 a[4:7], a[220:223], v[34:37], a[4:7]
    ds_read_b64_tr_b16 a[232:233], v2 offset:1024
    v_and_b32 v104, 0x3ff, v0
    v_mfma_f32_16x16x32_bf16 v[212:215], a[220:223], v[26:29], v[212:215]
    v_exp_f32_e64 v72, v72 clamp
    v_mfma_f32_16x16x32_bf16 v[164:167], a[220:223], v[22:25], v[164:167]
    ds_read_b64_tr_b16 a[218:219], v4 offset:7168
    v_fma_f32 v82, v82, s28, v12
    v_mfma_f32_16x16x32_bf16 v[116:119], a[220:223], v[14:17], v[116:119]
    s_waitcnt lgkmcnt(7)
    ds_read_b64_tr_b16 a[220:221], v5 offset:1024
    v_lshl_add_u32 v104, v105, 10, v104
    v_mfma_f32_16x16x32_bf16 v[120:123], a[224:227], v[14:17], v[120:123]
    v_exp_f32_e64 v65, v65 clamp
    v_mfma_f32_16x16x32_bf16 v[168:171], a[224:227], v[22:25], v[168:171]
    ds_read_b64_tr_b16 a[216:217], v4 offset:1024
    v_add_u32 v104, s38, v104
    v_mfma_f32_16x16x32_bf16 v[216:219], a[224:227], v[26:29], v[216:219]
    v_fma_f32 v76, v76, s28, v12
    v_fma_f32 v63, v63, s28, v10
    v_fma_f32 v64, v64, s28, v10
    v_mfma_f32_16x16x32_bf16 a[8:11], a[224:227], v[34:37], a[8:11]
    s_waitcnt lgkmcnt(6)
    v_exp_f32_e64 v63, v63 clamp
    v_mfma_f32_16x16x32_bf16 a[12:15], a[228:231], v[34:37], a[12:15]
    ds_read_b64_tr_b16 a[226:227], v2 offset:8192
    v_exp_f32_e64 v75, v75 clamp
    v_xor_b32 v105, 64, v104
    v_fma_f32 v56, v56, s28, v9
    v_mfma_f32_16x16x32_bf16 v[220:223], a[228:231], v[26:29], v[220:223]
    ds_read_b128 a[144:147], v104 offset:12288
    v_fma_f32 v74, v74, s28, v11
    v_mfma_f32_16x16x32_bf16 v[172:175], a[228:231], v[22:25], v[172:175]
    ds_read_b64_tr_b16 a[224:225], v2 offset:2048
    v_fma_f32 v80, v80, s28, v12
    v_mfma_f32_16x16x32_bf16 v[124:127], a[228:231], v[14:17], v[124:127]
    s_waitcnt lgkmcnt(5)
    ds_read_b64_tr_b16 a[222:223], v5 offset:7168
    v_fma_f32 v66, v66, s28, v10
    v_mfma_f32_16x16x32_bf16 v[128:131], a[232:235], v[14:17], v[128:131]
    v_exp_f32_e64 v62, v62 clamp
    v_mfma_f32_16x16x32_bf16 v[176:179], a[232:235], v[22:25], v[176:179]
    ds_read_b128 a[100:103], v105 offset:0
    v_fma_f32 v57, v57, s28, v9
    v_mfma_f32_16x16x32_bf16 v[224:227], a[232:235], v[26:29], v[224:227]
    ds_read_b64_tr_b16 a[228:229], v3 offset:2048
    v_fma_f32 v78, v78, s28, v12
    v_mfma_f32_16x16x32_bf16 a[16:19], a[232:235], v[34:37], a[16:19]
    s_add_u32 s39, s39, 12288
    ds_read_b128 a[168:171], v104 offset:18432
    v_fma_f32 v67, v67, s28, v10
    v_mfma_f32_16x16x32_bf16 a[20:23], a[236:239], v[34:37], a[20:23]
    ds_read_b64_tr_b16 a[232:233], v4 offset:2048
    v_fma_f32 v79, v79, s28, v12
    v_mfma_f32_16x16x32_bf16 v[228:231], a[236:239], v[26:29], v[228:231]
    v_exp_f32_e64 v74, v74 clamp
    v_mfma_f32_16x16x32_bf16 v[180:183], a[236:239], v[22:25], v[180:183]
    ds_read_b64_tr_b16 a[230:231], v3 offset:8192
    v_fma_f32 v58, v58, s28, v9
    v_mfma_f32_16x16x32_bf16 v[132:135], a[236:239], v[14:17], v[132:135]
    s_waitcnt lgkmcnt(7)
    ds_read_b64_tr_b16 a[234:235], v4 offset:8192
    v_fma_f32 v73, v73, s28, v11
    v_mfma_f32_16x16x32_bf16 v[136:139], a[216:219], v[14:17], v[136:139]
    ds_read_b64_tr_b16 a[236:237], v5 offset:2048
    v_fma_f32 v71, v71, s28, v11
    v_mfma_f32_16x16x32_bf16 v[184:187], a[216:219], v[22:25], v[184:187]
    ds_read_b64_tr_b16 a[238:239], v5 offset:8192
    v_fma_f32 v77, v77, s28, v12
    v_mfma_f32_16x16x32_bf16 v[232:235], a[216:219], v[26:29], v[232:235]
    v_exp_f32_e64 v57, v57 clamp
    v_mfma_f32_16x16x32_bf16 a[24:27], a[216:219], v[34:37], a[24:27]
    s_waitcnt lgkmcnt(7)
    v_exp_f32_e64 v67, v67 clamp
    v_mfma_f32_16x16x32_bf16 a[28:31], a[220:223], v[34:37], a[28:31]
    ds_read_b128 a[124:127], v105 offset:6144
    v_exp_f32_e64 v66, v66 clamp
    v_mfma_f32_16x16x32_bf16 v[236:239], a[220:223], v[26:29], v[236:239]
    ds_read_b128 a[104:107], v104 offset:2048
    v_fma_f32 v69, v69, s28, v11
    v_mfma_f32_16x16x32_bf16 v[188:191], a[220:223], v[22:25], v[188:191]
    ds_read_b128 a[116:119], v105 offset:4096
    v_exp_f32_e64 v69, v69 clamp
    v_mfma_f32_16x16x32_bf16 v[140:143], a[220:223], v[14:17], v[140:143]
    ds_read_b128 a[120:123], v104 offset:6144
    v_exp_f32_e64 v80, v80 clamp
    v_mfma_f32_16x16x32_bf16 v[144:147], a[224:227], v[14:17], v[144:147]
    ds_read_b128 a[148:151], v105 offset:12288
    v_exp_f32_e64 v71, v71 clamp
    v_exp_f32_e64 v78, v78 clamp
    v_exp_f32_e64 v59, v59 clamp
    v_mfma_f32_16x16x32_bf16 v[192:195], a[224:227], v[22:25], v[192:195]
    s_waitcnt vmcnt(10) lgkmcnt(5)
    ds_read_b128 a[132:135], v105 offset:8192
    v_exp_f32_e64 v58, v58 clamp
    v_mfma_f32_16x16x32_bf16 v[240:243], a[224:227], v[26:29], v[240:243]
    s_add_u32 s21, s21, s62
    v_exp_f32_e64 v73, v73 clamp
    v_mfma_f32_16x16x32_bf16 a[32:35], a[224:227], v[34:37], a[32:35]
    s_barrier
    v_mfma_f32_16x16x32_bf16 a[36:39], a[228:231], v[34:37], a[36:39]
    s_add_u32 m0, s22, 24576
    ds_read_b128 a[216:219], v0 offset:0
    buffer_load_dwordx4 v6, s[8:11], s21 offen lds
    v_mfma_f32_16x16x32_bf16 v[244:247], a[228:231], v[26:29], v[244:247]
    s_add_u32 s21, s21, 128
    v_exp_f32_e64 v77, v77 clamp
    v_mfma_f32_16x16x32_bf16 v[196:199], a[228:231], v[22:25], v[196:199]
    s_add_u32 m0, s22, 25600
    ds_read_b128 a[96:99], v104 offset:0
    v_fma_f32 v68, v68, s28, v11
    v_mfma_f32_16x16x32_bf16 v[148:151], a[228:231], v[14:17], v[148:151]
    buffer_load_dwordx4 v6, s[8:11], s21 offen lds
    ds_read_b128 a[220:223], v1 offset:0
    v_mfma_f32_16x16x32_bf16 v[152:155], a[232:235], v[14:17], v[152:155]
    s_add_u32 s21, s21, 128
    ds_read_b128 a[172:175], v105 offset:18432
    v_exp_f32_e64 v79, v79 clamp
    v_mfma_f32_16x16x32_bf16 v[200:203], a[232:235], v[22:25], v[200:203]
    s_add_u32 m0, s22, 26624
    ds_read_b128 a[152:155], v104 offset:14336
    v_fma_f32 v81, v81, s28, v12
    v_mfma_f32_16x16x32_bf16 v[248:251], a[232:235], v[26:29], v[248:251]
    buffer_load_dwordx4 v6, s[8:11], s21 offen lds
    ds_read_b128 a[180:183], v105 offset:20480
    v_fma_f32 v70, v70, s28, v11
    v_mfma_f32_16x16x32_bf16 a[40:43], a[232:235], v[34:37], a[40:43]
    v_exp_f32_e64 v56, v56 clamp
    v_mfma_f32_16x16x32_bf16 a[44:47], a[236:239], v[34:37], a[44:47]
    ds_read_b128 a[224:227], v0 offset:1024
    v_exp_f32_e64 v70, v70 clamp
    v_mfma_f32_16x16x32_bf16 v[252:255], a[236:239], v[26:29], v[252:255]
    ds_read_b128 a[128:131], v104 offset:8192
    v_cvt_pk_bf16_f32 v21, v66, v67
    v_mfma_f32_16x16x32_bf16 v[204:207], a[236:239], v[22:25], v[204:207]
    ds_read_b128 a[176:179], v104 offset:20480
    v_cvt_pk_bf16_f32 v22, v60, v61
    v_exp_f32_e64 v83, v83 clamp
    v_exp_f32_e64 v76, v76 clamp
    v_mfma_f32_16x16x32_bf16 v[156:159], a[236:239], v[14:17], v[156:159]
    s_waitcnt lgkmcnt(6)
    ds_read_b128 a[108:111], v105 offset:2048
    v_cvt_pk_bf16_f32 v23, v62, v63
    v_mfma_f32_16x16x32_bf16 v[52:55], a[216:219], a[96:99], 0
    v_exp_f32_e64 v68, v68 clamp
    v_exp_f32_e64 v64, v64 clamp
    v_cvt_pk_bf16_f32 v31, v70, v71
    v_cvt_pk_bf16_f32 v30, v68, v69
    v_mfma_f32_16x16x32_bf16 v[60:63], a[216:219], a[120:123], 0
    v_cvt_pk_bf16_f32 v35, v78, v79
    v_cvt_pk_bf16_f32 v16, v56, v57
    v_mfma_f32_16x16x32_bf16 v[68:71], a[216:219], a[144:147], 0
    v_cvt_pk_bf16_f32 v17, v58, v59
    v_cvt_pk_bf16_f32 v34, v76, v77
    v_mfma_f32_16x16x32_bf16 v[76:79], a[216:219], a[168:171], 0
    ds_read_b128 a[140:143], v105 offset:10240
    v_exp_f32_e64 v82, v82 clamp
    v_mfma_f32_16x16x32_bf16 v[52:55], a[220:223], a[100:103], v[52:55]
    ds_read_b128 a[228:231], v1 offset:1024
    v_exp_f32_e64 v81, v81 clamp
    v_mfma_f32_16x16x32_bf16 v[60:63], a[220:223], a[124:127], v[60:63]
    ds_read_b128 a[156:159], v105 offset:14336
    v_cvt_pk_bf16_f32 v33, v82, v83
    v_mfma_f32_16x16x32_bf16 v[68:71], a[220:223], a[148:151], v[68:71]
    s_waitcnt lgkmcnt(4)
    ds_read_b128 a[188:191], v105 offset:22528
    v_cvt_pk_bf16_f32 v20, v64, v65
    v_mfma_f32_16x16x32_bf16 v[76:79], a[220:223], a[172:175], v[76:79]
    ds_read_b128 a[232:235], v0 offset:6144
    v_cvt_pk_bf16_f32 v28, v72, v73
    v_mfma_f32_16x16x32_bf16 v[52:55], a[224:227], a[104:107], v[52:55]
    ds_read_b128 a[112:115], v104 offset:4096
    v_cvt_pk_bf16_f32 v29, v74, v75
    v_mfma_f32_16x16x32_bf16 v[60:63], a[224:227], a[128:131], v[60:63]
    ds_read_b128 a[236:239], v1 offset:6144
    v_cvt_pk_bf16_f32 v32, v80, v81
    v_smfmac_f32_16x16x64_bf16 v[48:51], a[240:243], v[16:23], v101
    ds_read_b128 a[136:139], v104 offset:10240
    v_smfmac_f32_16x16x64_bf16 v[48:51], a[244:247], v[28:35], v101
    ds_read_b128 a[184:187], v104 offset:22528
    v_mfma_f32_16x16x32_bf16 v[68:71], a[224:227], a[152:155], v[68:71]
    ds_read_b128 a[220:223], v1 offset:7168
    v_mfma_f32_16x16x32_bf16 v[76:79], a[224:227], a[176:179], v[76:79]
    ds_read_b128 a[164:167], v105 offset:16384
    s_waitcnt lgkmcnt(9)
    v_mfma_f32_16x16x32_bf16 v[52:55], a[228:231], a[108:111], v[52:55]
    ds_read_b128 a[160:163], v104 offset:16384
    v_cmp_lt_f32 vcc, s29, v48
    v_mfma_f32_16x16x32_bf16 v[60:63], a[228:231], a[132:135], v[60:63]
    s_add_u32 s21, s21, 12032
    ds_read_b128 a[216:219], v0 offset:7168
    s_waitcnt lgkmcnt(10)
    v_mfma_f32_16x16x32_bf16 v[68:71], a[228:231], a[156:159], v[68:71]
    s_cbranch_vccnz L_rs_tr44b
L_ret_tr44b:
    v_lshrrev_b32 v108, 11, v0
    v_mfma_f32_16x16x32_bf16 v[76:79], a[228:231], a[180:183], v[76:79]
    s_waitcnt lgkmcnt(8)
    v_and_b32 v93, 0x3ff, v0
    v_mov_b32 v109, v50
    v_mfma_f32_16x16x32_bf16 v[56:59], a[232:235], a[96:99], 0
    v_xor_b32 v108, s65, v108
    v_lshl_add_u32 v93, v108, 10, v93
    v_mfma_f32_16x16x32_bf16 v[64:67], a[232:235], a[120:123], 0
    ds_read_b128 a[228:231], v1 offset:2048
    v_mbcnt_lo_u32_b32 v108, -1, 0
    v_mfma_f32_16x16x32_bf16 v[72:75], a[232:235], a[144:147], 0
    v_add_u32 v93, s38, v93
    v_mbcnt_hi_u32_b32 v108, -1, v108
    v_mfma_f32_16x16x32_bf16 v[80:83], a[232:235], a[168:171], 0
    s_waitcnt lgkmcnt(5)
    ds_read_b128 a[232:235], v0 offset:8192
    v_lshrrev_b32 v108, 1, v108
    v_mfma_f32_16x16x32_bf16 v[56:59], a[236:239], a[100:103], v[56:59]
    v_mov_b32 v110, v45
    v_mov_b32 v111, v46
    v_mfma_f32_16x16x32_bf16 v[64:67], a[236:239], a[124:127], v[64:67]
    v_permlane16_swap_b32 v45, v110
    v_mfma_f32_16x16x32_bf16 v[72:75], a[236:239], a[148:151], v[72:75]
    ds_read_b128 a[224:227], v0 offset:2048
    v_and_b32 v108, 24, v108
    v_mfma_f32_16x16x32_bf16 v[80:83], a[236:239], a[172:175], v[80:83]
    s_waitcnt lgkmcnt(3)
    ds_read_b128 a[236:239], v1 offset:8192
    v_bfe_u32 v108, s66, v108, 8
    v_xor_b32 v93, v93, v108
    v_mfma_f32_16x16x32_bf16 v[56:59], a[216:219], a[104:107], v[56:59]
    v_permlane16_swap_b32 v50, v109
    v_mfma_f32_16x16x32_bf16 v[64:67], a[216:219], a[128:131], v[64:67]
    v_xor_b32 v95, 32, v93
    v_add_f32 v45, v45, v110
    v_mov_b32 v108, v49
    v_add_f32 v50, v50, v109
    v_mfma_f32_16x16x32_bf16 v[72:75], a[216:219], a[152:155], v[72:75]
    v_permlane16_swap_b32 v49, v108
    v_mfma_f32_16x16x32_bf16 v[80:83], a[216:219], a[176:179], v[80:83]
    v_xor_b32 v8, 64, v93
    v_permlane16_swap_b32 v46, v111
    v_mov_b32 v110, v45
    v_mfma_f32_16x16x32_bf16 v[56:59], a[220:223], a[108:111], v[56:59]
    v_mov_b32 v109, v50
    v_add_f32 v49, v49, v108
    v_mfma_f32_16x16x32_bf16 v[64:67], a[220:223], a[132:135], v[64:67]
    v_permlane32_swap_b32 v50, v109
    v_permlane32_swap_b32 v45, v110
    v_mfma_f32_16x16x32_bf16 v[72:75], a[220:223], a[156:159], v[72:75]
    v_add_f32 v46, v46, v111
    v_mov_b32 v108, v49
    v_mfma_f32_16x16x32_bf16 v[80:83], a[220:223], a[180:183], v[80:83]
    s_waitcnt vmcnt(10) lgkmcnt(0)
    s_barrier
    s_add_u32 m0, s22, 0
    v_mfma_f32_16x16x32_bf16 v[52:55], a[224:227], a[112:115], v[52:55]
    buffer_load_dwordx4 v6, s[4:7], s20 offen lds
    v_mfma_f32_16x16x32_bf16 v[60:63], a[224:227], a[136:139], v[60:63]
    s_add_u32 s20, s20, 128
    s_add_u32 m0, s22, 1024
    ds_read_b64_tr_b16 a[216:217], v2 offset:18432
    v_mfma_f32_16x16x32_bf16 v[68:71], a[224:227], a[160:163], v[68:71]
    buffer_load_dwordx4 v6, s[4:7], s20 offen lds
    v_mfma_f32_16x16x32_bf16 v[76:79], a[224:227], a[184:187], v[76:79]
    s_add_u32 s20, s20, 128
    ds_read_b64_tr_b16 a[218:219], v2 offset:12288
    v_mov_b32 v111, v46
    v_mfma_f32_16x16x32_bf16 v[52:55], a[228:231], a[116:119], v[52:55]
    s_add_u32 m0, s22, 2048
    v_permlane32_swap_b32 v49, v108
    v_mfma_f32_16x16x32_bf16 v[60:63], a[228:231], a[140:143], v[60:63]
    buffer_load_dwordx4 v6, s[4:7], s20 offen lds
    v_mfma_f32_16x16x32_bf16 v[68:71], a[228:231], a[164:167], v[68:71]
    ds_read_b64_tr_b16 a[220:221], v3 offset:18432
    v_add_f32 v50, v50, v110
    v_mfma_f32_16x16x32_bf16 v[76:79], a[228:231], a[188:191], v[76:79]
    v_rcp_f32 v50, v50
    v_mfma_f32_16x16x32_bf16 v[56:59], a[232:235], a[112:115], v[56:59]
    s_add_u32 s20, s20, 12032
    ds_read_b64_tr_b16 a[222:223], v3 offset:12288
    v_add_f32 v92, v108, v45
    v_mfma_f32_16x16x32_bf16 v[64:67], a[232:235], a[136:139], v[64:67]
    ds_read_b64_tr_b16 a[224:225], v4 offset:18432
    v_permlane32_swap_b32 v46, v111
    v_mfma_f32_16x16x32_bf16 v[72:75], a[232:235], a[160:163], v[72:75]
    ds_read_b64_tr_b16 a[226:227], v4 offset:12288
    v_xor_b32 v102, 96, v93
    v_mfma_f32_16x16x32_bf16 v[80:83], a[232:235], a[184:187], v[80:83]
    ds_read_b64_tr_b16 a[228:229], v5 offset:18432
    v_add_f32 v48, v49, v47
    v_mfma_f32_16x16x32_bf16 v[56:59], a[236:239], a[116:119], v[56:59]
    v_rcp_f32 v48, v48
    v_mfma_f32_16x16x32_bf16 v[64:67], a[236:239], a[140:143], v[64:67]
    ds_read_b64_tr_b16 a[230:231], v5 offset:12288
    v_add_f32 v94, v109, v46
    v_mfma_f32_16x16x32_bf16 v[72:75], a[236:239], a[164:167], v[72:75]
    s_waitcnt lgkmcnt(6)
    v_rcp_f32 v94, v94
    v_mfma_f32_16x16x32_bf16 v[80:83], a[236:239], a[188:191], v[80:83]
    v_rcp_f32 v92, v92
    v_max3_f32 v97, v60, v61, v62
    v_max3_f32 v98, v68, v69, v70
    v_max3_f32 v99, v76, v77, v78
    v_max3_f32 v97, v97, v63, v64
    v_max3_f32 v98, v98, v71, v72
    v_mfma_f32_16x16x32_bf16 v[112:115], a[216:219], v[16:19], v[112:115]
    v_max3_f32 v96, v52, v53, v54
    v_max3_f32 v98, v98, v73, v74
    v_mfma_f32_16x16x32_bf16 v[160:163], a[216:219], v[20:23], v[160:163]
    s_mov_b32 s67, s34
    ds_read_b64_tr_b16 a[238:239], v3 offset:13312
    v_max3_f32 v99, v99, v79, v80
    v_max3_f32 v99, v99, v81, v82
    v_max_f32 v98, v98, v75
    v_mfma_f32_16x16x32_bf16 v[208:211], a[216:219], v[28:31], v[208:211]
    s_add_u32 s18, s34, 24576
    v_mov_b32 v49, 0
    v_max_f32 v99, v99, v83
    v_max3_f32 v96, v96, v55, v56
    v_mfma_f32_16x16x32_bf16 a[0:3], a[216:219], v[32:35], a[0:3]
    s_waitcnt lgkmcnt(5)
    ds_read_b64_tr_b16 a[236:237], v3 offset:19456
    v_max3_f32 v96, v96, v57, v58
    v_mfma_f32_16x16x32_bf16 a[4:7], a[220:223], v[32:35], a[4:7]
    s_mov_b32 s34, s33
    v_permlane32_swap_b32 v98, v99
    v_mfma_f32_16x16x32_bf16 v[212:215], a[220:223], v[28:31], v[212:215]
    s_add_u32 s64, s64, s62
    ds_read_b64_tr_b16 a[232:233], v2 offset:19456
    v_max3_f32 v97, v97, v65, v66
    v_mfma_f32_16x16x32_bf16 v[164:167], a[220:223], v[20:23], v[164:167]
    s_add_u32 s64, s64, 196608
    ds_read_b64_tr_b16 a[234:235], v2 offset:13312
    v_max_f32 v98, v98, v99
    v_mfma_f32_16x16x32_bf16 v[116:119], a[220:223], v[16:19], v[116:119]
    s_waitcnt lgkmcnt(4)
    ds_read_b64_tr_b16 a[220:221], v5 offset:19456
    v_max_f32 v97, v97, v67
    v_mfma_f32_16x16x32_bf16 v[120:123], a[224:227], v[16:19], v[120:123]
    s_mov_b32 s39, s64
    v_max_f32 v96, v96, v59
    v_accvgpr_read_b32 v107, a3
    v_mfma_f32_16x16x32_bf16 v[168:171], a[224:227], v[20:23], v[168:171]
    s_add_u32 s37, s37, 1
    v_permlane32_swap_b32 v96, v97
    v_mfma_f32_16x16x32_bf16 v[216:219], a[224:227], v[28:31], v[216:219]
    s_bitcmp1_b32 s63, s37
    v_accvgpr_read_b32 v104, a0
    v_max_f32 v96, v96, v97
    v_mfma_f32_16x16x32_bf16 a[8:11], a[224:227], v[32:35], a[8:11]
    s_cselect_b32 s62, 4294770688, 0
    ds_read_b64_tr_b16 a[224:225], v2 offset:20480
    v_permlane16_swap_b32 v96, v98
    v_mfma_f32_16x16x32_bf16 a[12:15], a[228:231], v[32:35], a[12:15]
    s_cselect_b32 s42, 0, 325632
    ds_read_b64_tr_b16 a[222:223], v5 offset:13312
    v_accvgpr_read_b32 v111, a7
    v_mfma_f32_16x16x32_bf16 v[220:223], a[228:231], v[28:31], v[220:223]
    s_add_u32 s35, s35, s42
    ds_read_b64_tr_b16 a[218:219], v4 offset:13312
    v_max_f32 v96, v96, v98
    v_mfma_f32_16x16x32_bf16 v[172:175], a[228:231], v[20:23], v[172:175]
    s_lshl_b32 s42, s37, 1
    ds_read_b64_tr_b16 a[216:217], v4 offset:19456
    v_mul_f32_e64 v9, -s28, v96
    v_subrev_f32 v9, 0x42000000, v9
    v_mfma_f32_16x16x32_bf16 v[124:127], a[228:231], v[16:19], v[124:127]
    s_lshr_b32 s42, s31, s42
    ds_read_b64_tr_b16 a[228:229], v3 offset:20480
    v_mov_b32 v11, v9
    s_waitcnt lgkmcnt(6)
    v_mfma_f32_16x16x32_bf16 v[128:131], a[232:235], v[16:19], v[128:131]
    s_and_b32 s42, s42, 3
    v_permlane16_swap_b32 v9, v11
    v_mfma_f32_16x16x32_bf16 v[176:179], a[232:235], v[20:23], v[176:179]
    s_add_u32 s42, s42, s36
    v_accvgpr_read_b32 v106, a2
    v_mov_b32 v10, v9
    v_mfma_f32_16x16x32_bf16 v[224:227], a[232:235], v[28:31], v[224:227]
    s_sub_u32 s43, s42, 3
    v_mov_b32 v12, v11
    v_permlane32_swap_b32 v9, v10
    v_mfma_f32_16x16x32_bf16 a[16:19], a[232:235], v[32:35], a[16:19]
    s_cmp_ge_u32 s42, 3
    v_permlane32_swap_b32 v11, v12
    v_mfma_f32_16x16x32_bf16 a[20:23], a[236:239], v[32:35], a[20:23]
    s_cselect_b32 s42, s43, s42
    v_fma_f32 v75, v75, s28, v11
    v_fma_f32 v79, v79, s28, v12
    v_mfma_f32_16x16x32_bf16 v[228:231], a[236:239], v[28:31], v[228:231]
    s_mul_i32 s44, s3, 5
    ds_read_b64_tr_b16 a[230:231], v3 offset:14336
    v_fma_f32 v62, v62, s28, v10
    v_fma_f32 v71, v71, s28, v11
    v_mfma_f32_16x16x32_bf16 v[180:183], a[236:239], v[20:23], v[180:183]
    s_mov_b32 s32, 1
    ds_read_b64_tr_b16 a[232:233], v4 offset:20480
    v_fma_f32 v53, v53, s28, v9
    v_mfma_f32_16x16x32_bf16 v[132:135], a[236:239], v[16:19], v[132:135]
    s_waitcnt lgkmcnt(3)
    ds_read_b64_tr_b16 a[226:227], v2 offset:14336
    s_lshl_b32 s43, s3, 2
    v_fma_f32 v55, v55, s28, v9
    v_mfma_f32_16x16x32_bf16 v[136:139], a[216:219], v[16:19], v[136:139]
    s_add_u32 s45, s43, 21
    ds_read_b64_tr_b16 a[236:237], v5 offset:20480
    v_fma_f32 v60, v60, s28, v10
    v_mfma_f32_16x16x32_bf16 v[184:187], a[216:219], v[20:23], v[184:187]
    s_cmp_eq_u32 s3, 0
    ds_read_b64_tr_b16 a[234:235], v4 offset:14336
    v_fma_f32 v70, v70, s28, v11
    v_mfma_f32_16x16x32_bf16 v[232:235], a[216:219], v[28:31], v[232:235]
    s_cselect_b32 s45, 20, s45
    v_fma_f32 v61, v61, s28, v10
    s_cselect_b32 s33, 1, 0
    v_mfma_f32_16x16x32_bf16 a[24:27], a[216:219], v[32:35], a[24:27]
    s_cmp_eq_u32 s42, 1
    v_fma_f32 v58, v58, s28, v9
    v_fma_f32 v69, v69, s28, v11
    v_fma_f32 v77, v77, s28, v12
    v_fma_f32 v52, v52, s28, v9
    s_cselect_b32 s44, s45, s44
    v_fma_f32 v68, v68, s28, v11
    v_pk_mul_f32 v[116:117], v[116:117], v[48:49] op_sel_hi:[1,0]
    v_exp_f32_e64 v55, v55 clamp
    v_fma_f32 v80, v80, s28, v12
    v_pk_mul_f32 v[106:107], v[106:107], v[94:95] op_sel_hi:[1,0]
    v_fma_f32 v73, v73, s28, v11
    v_fma_f32 v78, v78, s28, v12
    v_mfma_f32_16x16x32_bf16 a[28:31], a[220:223], v[32:35], a[28:31]
    s_cselect_b32 s32, s33, s32
    v_fma_f32 v82, v82, s28, v12
    v_fma_f32 v66, v66, s28, v10
    v_fma_f32 v72, v72, s28, v11
    v_mfma_f32_16x16x32_bf16 v[236:239], a[220:223], v[28:31], v[236:239]
    s_add_u32 s45, s43, 37
    v_fma_f32 v63, v63, s28, v10
    v_exp_f32_e64 v61, v61 clamp
    v_exp_f32_e64 v53, v53 clamp
    v_mfma_f32_16x16x32_bf16 v[188:191], a[220:223], v[20:23], v[188:191]
    s_cmp_eq_u32 s42, 2
    v_exp_f32_e64 v79, v79 clamp
    v_mfma_f32_16x16x32_bf16 v[140:143], a[220:223], v[16:19], v[140:143]
    s_waitcnt lgkmcnt(0)
    v_exp_f32_e64 v71, v71 clamp
    v_mfma_f32_16x16x32_bf16 v[144:147], a[224:227], v[16:19], v[144:147]
    s_cselect_b32 s44, s45, s44
    ds_read_b64_tr_b16 a[238:239], v5 offset:14336
    v_fma_f32 v65, v65, s28, v10
    v_mfma_f32_16x16x32_bf16 v[192:195], a[224:227], v[20:23], v[192:195]
    s_cselect_b32 s32, 0, s32
    v_fma_f32 v74, v74, s28, v11
    v_fma_f32 v57, v57, s28, v9
    v_mfma_f32_16x16x32_bf16 v[240:243], a[224:227], v[28:31], v[240:243]
    s_mul_i32 s44, s44, 6144
    s_add_u32 s33, s35, s44
    v_fma_f32 v76, v76, s28, v12
    v_mfma_f32_16x16x32_bf16 a[32:35], a[224:227], v[32:35], a[32:35]
    s_mul_i32 s42, s32, 6144
    v_exp_f32_e64 v58, v58 clamp
    v_mfma_f32_16x16x32_bf16 a[36:39], a[228:231], v[32:35], a[36:39]
    s_add_u32 s42, s42, 24576
    v_exp_f32_e64 v68, v68 clamp
    v_mfma_f32_16x16x32_bf16 v[244:247], a[228:231], v[28:31], v[244:247]
    s_add_u32 s42, s42, s33
    v_fma_f32 v67, v67, s28, v10
    s_cmp_ge_u32 s37, 6
    v_mfma_f32_16x16x32_bf16 v[196:199], a[228:231], v[20:23], v[196:199]
    s_cselect_b32 s14, 0, s42
    v_exp_f32_e64 v77, v77 clamp
    v_accvgpr_read_b32 v108, a4
    v_mfma_f32_16x16x32_bf16 v[148:151], a[228:231], v[16:19], v[148:151]
    s_add_u32 s24, s67, 6144
    v_fma_f32 v64, v64, s28, v10
    s_add_u32 s25, s33, 6144
    v_mfma_f32_16x16x32_bf16 v[152:155], a[232:235], v[16:19], v[152:155]
    s_add_u32 s23, s38, 6144
    s_mov_b32 s27, 0x30c30
    s_mov_b32 s89, 0xaaaaaaaa
    v_mfma_f32_16x16x32_bf16 v[200:203], a[232:235], v[20:23], v[200:203]
    s_mov_b32 s30, 0
    v_subrev_u32 v103, 24576, v103
    s_waitcnt vmcnt(8) lgkmcnt(0)
    v_mfma_f32_16x16x32_bf16 v[248:251], a[232:235], v[28:31], v[248:251]
    s_barrier
    ds_read_b128 a[216:219], v0 offset:12288
    v_mfma_f32_16x16x32_bf16 a[40:43], a[232:235], v[32:35], a[40:43]
    ds_read_b128 a[220:223], v1 offset:12288
    v_cvt_pk_bf16_f32 v116, v116, v117
    v_mfma_f32_16x16x32_bf16 a[44:47], a[236:239], v[32:35], a[44:47]
    ds_read_b128 a[224:227], v0 offset:13312
    v_fma_f32 v54, v54, s28, v9
    v_exp_f32_e64 v52, v52 clamp
    v_exp_f32_e64 v78, v78 clamp
    v_mfma_f32_16x16x32_bf16 v[252:255], a[236:239], v[28:31], v[252:255]
    v_exp_f32_e64 v69, v69 clamp
    v_mfma_f32_16x16x32_bf16 v[204:207], a[236:239], v[20:23], v[204:207]
    v_cvt_pk_bf16_f32 v14, v52, v53
    v_exp_f32_e64 v54, v54 clamp
    v_exp_f32_e64 v62, v62 clamp
    v_exp_f32_e64 v74, v74 clamp
    v_cvt_pk_bf16_f32 v15, v54, v55
    v_exp_f32_e64 v60, v60 clamp
    v_pk_mul_f32 v[140:141], v[140:141], v[48:49] op_sel_hi:[1,0]
    v_pk_mul_f32 v[164:165], v[164:165], v[92:93] op_sel_hi:[1,0]
    v_pk_mul_f32 v[124:125], v[124:125], v[48:49] op_sel_hi:[1,0]
    v_exp_f32_e64 v63, v63 clamp
    v_cvt_pk_bf16_f32 v22, v60, v61
    v_exp_f32_e64 v73, v73 clamp
    v_mfma_f32_16x16x32_bf16 v[156:159], a[236:239], v[16:19], v[156:159]
    s_waitcnt lgkmcnt(2)
    v_exp_f32_e64 v76, v76 clamp
    v_mfma_f32_16x16x32_bf16 v[52:55], a[216:219], a[96:99], 0
    s_waitcnt lgkmcnt(1)
    v_exp_f32_e64 v70, v70 clamp
    v_mfma_f32_16x16x32_bf16 v[52:55], a[220:223], a[100:103], v[52:55]
    s_waitcnt lgkmcnt(0)
    ds_read_b128 a[236:239], v1 offset:14336
    v_fma_f32 v83, v83, s28, v12
    v_mfma_f32_16x16x32_bf16 v[52:55], a[224:227], a[104:107], v[52:55]
    ds_read_b128 a[228:231], v1 offset:13312
    v_cvt_pk_bf16_f32 v26, v68, v69
    v_cvt_pk_bf16_f32 v23, v62, v63
    v_mfma_f32_16x16x32_bf16 v[60:63], a[224:227], a[128:131], 0
    ds_read_b128 a[232:235], v0 offset:14336
    v_mov_b32 v38, v6
    v_cvt_pk_bf16_f32 v27, v70, v71
    v_cvt_pk_bf16_f32 v35, v78, v79
    v_mfma_f32_16x16x32_bf16 v[60:63], a[220:223], a[124:127], v[60:63]
    v_fma_f32 v56, v56, s28, v9
    v_exp_f32_e64 v82, v82 clamp
    v_mfma_f32_16x16x32_bf16 v[60:63], a[216:219], a[120:123], v[60:63]
    v_exp_f32_e64 v72, v72 clamp
    v_mfma_f32_16x16x32_bf16 v[68:71], a[216:219], a[144:147], 0
    v_fma_f32 v59, v59, s28, v9
    v_cvt_pk_bf16_f32 v140, v140, v141
    v_mfma_f32_16x16x32_bf16 v[68:71], a[220:223], a[148:151], v[68:71]
    v_exp_f32_e64 v66, v66 clamp
    v_mfma_f32_16x16x32_bf16 v[68:71], a[224:227], a[152:155], v[68:71]
    v_exp_f32_e64 v57, v57 clamp
    v_cvt_pk_bf16_f32 v34, v76, v77
    v_mfma_f32_16x16x32_bf16 v[76:79], a[224:227], a[176:179], 0
    v_exp_f32_e64 v83, v83 clamp
    v_mfma_f32_16x16x32_bf16 v[76:79], a[220:223], a[172:175], v[76:79]
    s_add_u32 m0, s22, 36864
    v_mov_b32 v39, v7
    v_accvgpr_read_b32 v109, a5
    v_mfma_f32_16x16x32_bf16 v[76:79], a[216:219], a[168:171], v[76:79]
    s_waitcnt lgkmcnt(1)
    v_fma_f32 v81, v81, s28, v12
    v_accvgpr_read_b32 v110, a6
    v_mfma_f32_16x16x32_bf16 v[76:79], a[228:231], a[180:183], v[76:79]
    s_waitcnt lgkmcnt(0)
    v_exp_f32_e64 v81, v81 clamp
    v_mfma_f32_16x16x32_bf16 v[76:79], a[232:235], a[184:187], v[76:79]
    buffer_load_dwordx4 v6, s[8:11], s21 offen lds
    v_mfma_f32_16x16x32_bf16 v[76:79], a[236:239], a[188:191], v[76:79]
    v_exp_f32_e64 v56, v56 clamp
    v_mfma_f32_16x16x32_bf16 v[68:71], a[236:239], a[164:167], v[68:71]
    v_exp_f32_e64 v80, v80 clamp
    v_cvt_pk_bf16_f32 v28, v72, v73
    v_mfma_f32_16x16x32_bf16 v[68:71], a[232:235], a[160:163], v[68:71]
    ds_read_b128 a[216:219], v0 offset:18432
    v_cvt_pk_bf16_f32 v36, v80, v81
    v_mfma_f32_16x16x32_bf16 v[68:71], a[228:231], a[156:159], v[68:71]
    s_add_u32 s21, s21, 128
    v_accvgpr_read_b32 v105, a1
    v_fma_f32 v76, v76, s28, v12
    v_exp_f32_e64 v75, v75 clamp
    v_mfma_f32_16x16x32_bf16 v[60:63], a[228:231], a[132:135], v[60:63]
    v_exp_f32_e64 v76, v76 clamp
    v_mfma_f32_16x16x32_bf16 v[60:63], a[232:235], a[136:139], v[60:63]
    v_cvt_pk_bf16_f32 v29, v74, v75
    v_exp_f32_e64 v59, v59 clamp
    v_mfma_f32_16x16x32_bf16 v[60:63], a[236:239], a[140:143], v[60:63]
    s_add_u32 m0, s22, 37888
    v_mov_b32 v51, 0
    v_cvt_pk_bf16_f32 v164, v164, v165
    v_mfma_f32_16x16x32_bf16 v[52:55], a[236:239], a[116:119], v[52:55]
    ds_read_b128 a[224:227], v0 offset:19456
    v_cvt_pk_bf16_f32 v124, v124, v125
    v_mfma_f32_16x16x32_bf16 v[52:55], a[232:235], a[112:115], v[52:55]
    ds_read_b128 a[220:223], v1 offset:18432
    buffer_load_dwordx4 v6, s[8:11], s21 offen lds
    v_exp_f32_e64 v65, v65 clamp
    v_pk_mul_f32 v[110:111], v[110:111], v[94:95] op_sel_hi:[1,0]
    v_pk_mul_f32 v[126:127], v[126:127], v[48:49] op_sel_hi:[1,0]
    v_pk_mul_f32 v[240:241], v[240:241], v[50:51] op_sel_hi:[1,0]
    v_pk_mul_f32 v[172:173], v[172:173], v[92:93] op_sel_hi:[1,0]
    v_pk_mul_f32 v[120:121], v[120:121], v[48:49] op_sel_hi:[1,0]
    v_pk_mul_f32 v[216:217], v[216:217], v[50:51] op_sel_hi:[1,0]
    v_pk_mul_f32 v[128:129], v[128:129], v[48:49] op_sel_hi:[1,0]
    v_pk_mul_f32 v[250:251], v[250:251], v[50:51] op_sel_hi:[1,0]
    v_fma_f32 v69, v69, s28, v11
    v_pk_mul_f32 v[104:105], v[104:105], v[94:95] op_sel_hi:[1,0]
    v_exp_f32_e64 v64, v64 clamp
    v_pk_mul_f32 v[200:201], v[200:201], v[92:93] op_sel_hi:[1,0]
    v_pk_mul_f32 v[108:109], v[108:109], v[94:95] op_sel_hi:[1,0]
    v_pk_mul_f32 v[248:249], v[248:249], v[50:51] op_sel_hi:[1,0]
    v_pk_mul_f32 v[132:133], v[132:133], v[48:49] op_sel_hi:[1,0]
    v_pk_mul_f32 v[210:211], v[210:211], v[50:51] op_sel_hi:[1,0]
    v_pk_mul_f32 v[222:223], v[222:223], v[50:51] op_sel_hi:[1,0]
    v_pk_mul_f32 v[224:225], v[224:225], v[50:51] op_sel_hi:[1,0]
    v_pk_mul_f32 v[162:163], v[162:163], v[92:93] op_sel_hi:[1,0]
    v_pk_mul_f32 v[188:189], v[188:189], v[92:93] op_sel_hi:[1,0]
    v_exp_f32_e64 v67, v67 clamp
    v_pk_mul_f32 v[114:115], v[114:115], v[48:49] op_sel_hi:[1,0]
    v_pk_mul_f32 v[174:175], v[174:175], v[92:93] op_sel_hi:[1,0]
    v_pk_mul_f32 v[226:227], v[226:227], v[50:51] op_sel_hi:[1,0]
    v_pk_mul_f32 v[160:161], v[160:161], v[92:93] op_sel_hi:[1,0]
    v_pk_mul_f32 v[182:183], v[182:183], v[92:93] op_sel_hi:[1,0]
    v_pk_mul_f32 v[152:153], v[152:153], v[48:49] op_sel_hi:[1,0]
    v_pk_mul_f32 v[170:171], v[170:171], v[92:93] op_sel_hi:[1,0]
    v_pk_mul_f32 v[212:213], v[212:213], v[50:51] op_sel_hi:[1,0]
    v_pk_mul_f32 v[190:191], v[190:191], v[92:93] op_sel_hi:[1,0]
    v_pk_mul_f32 v[150:151], v[150:151], v[48:49] op_sel_hi:[1,0]
    v_pk_mul_f32 v[118:119], v[118:119], v[48:49] op_sel_hi:[1,0]
    v_cvt_pk_bf16_f32 v160, v160, v161
    v_pk_mul_f32 v[244:245], v[244:245], v[50:51] op_sel_hi:[1,0]
    v_pk_mul_f32 v[144:145], v[144:145], v[48:49] op_sel_hi:[1,0]
    v_pk_mul_f32 v[192:193], v[192:193], v[92:93] op_sel_hi:[1,0]
    v_pk_mul_f32 v[148:149], v[148:149], v[48:49] op_sel_hi:[1,0]
    v_pk_mul_f32 v[142:143], v[142:143], v[48:49] op_sel_hi:[1,0]
    v_cvt_pk_bf16_f32 v25, v66, v67
    v_fma_f32 v71, v71, s28, v11
    v_pk_mul_f32 v[178:179], v[178:179], v[92:93] op_sel_hi:[1,0]
    v_pk_mul_f32 v[252:253], v[252:253], v[50:51] op_sel_hi:[1,0]
    v_cvt_pk_bf16_f32 v24, v64, v65
    v_cvt_pk_bf16_f32 v161, v162, v163
    v_pk_mul_f32 v[176:177], v[176:177], v[92:93] op_sel_hi:[1,0]
    v_pk_mul_f32 v[232:233], v[232:233], v[50:51] op_sel_hi:[1,0]
    v_pk_mul_f32 v[242:243], v[242:243], v[50:51] op_sel_hi:[1,0]
    v_pk_mul_f32 v[208:209], v[208:209], v[50:51] op_sel_hi:[1,0]
    v_pk_mul_f32 v[220:221], v[220:221], v[50:51] op_sel_hi:[1,0]
    v_pk_mul_f32 v[166:167], v[166:167], v[92:93] op_sel_hi:[1,0]
    v_cvt_pk_bf16_f32 v16, v56, v57
    v_pk_mul_f32 v[218:219], v[218:219], v[50:51] op_sel_hi:[1,0]
    v_pk_mul_f32 v[122:123], v[122:123], v[48:49] op_sel_hi:[1,0]
    v_pk_mul_f32 v[238:239], v[238:239], v[50:51] op_sel_hi:[1,0]
    v_cvt_pk_bf16_f32 v108, v108, v109
    v_pk_mul_f32 v[168:169], v[168:169], v[92:93] op_sel_hi:[1,0]
    v_pk_mul_f32 v[214:215], v[214:215], v[50:51] op_sel_hi:[1,0]
    v_cvt_pk_bf16_f32 v117, v118, v119
    v_pk_mul_f32 v[112:113], v[112:113], v[48:49] op_sel_hi:[1,0]
    v_pk_mul_f32 v[180:181], v[180:181], v[92:93] op_sel_hi:[1,0]
    v_fma_f32 v61, v61, s28, v10
    v_cvt_pk_bf16_f32 v37, v82, v83
    v_mfma_f32_16x16x32_bf16 v[52:55], a[228:231], a[108:111], v[52:55]
    s_waitcnt lgkmcnt(0)
    v_cvt_pk_bf16_f32 v17, v58, v59
    v_cvt_pk_bf16_f32 v109, v110, v111
    v_mfma_f32_16x16x32_bf16 v[56:59], a[216:219], a[96:99], 0
    s_add_u32 s21, s21, 128
    ds_read_b128 a[236:239], v1 offset:20480
    v_cvt_pk_bf16_f32 v144, v144, v145
    v_mfma_f32_16x16x32_bf16 v[56:59], a[220:223], a[100:103], v[56:59]
    ds_read_b128 a[228:231], v1 offset:19456
    v_cvt_pk_bf16_f32 v192, v192, v193
    v_mfma_f32_16x16x32_bf16 v[56:59], a[224:227], a[104:107], v[56:59]
    ds_read_b128 a[232:235], v0 offset:20480
    v_cvt_pk_bf16_f32 v212, v212, v213
    v_mfma_f32_16x16x32_bf16 v[64:67], a[224:227], a[128:131], 0
    v_cvt_pk_bf16_f32 v104, v104, v105
    v_cvt_pk_bf16_f32 v224, v224, v225
    v_mfma_f32_16x16x32_bf16 v[64:67], a[220:223], a[124:127], v[64:67]
    v_cvt_pk_bf16_f32 v180, v180, v181
    v_fma_f32 v60, v60, s28, v10
    v_mfma_f32_16x16x32_bf16 v[64:67], a[216:219], a[120:123], v[64:67]
    s_add_u32 m0, s22, 38912
    v_cvt_pk_bf16_f32 v105, v106, v107
    v_cvt_pk_bf16_f32 v208, v208, v209
    v_mfma_f32_16x16x32_bf16 v[72:75], a[216:219], a[144:147], 0
    v_fma_f32 v55, v55, s28, v9
    v_accvgpr_read_b32 v110, a14
    v_fma_f32 v68, v68, s28, v11
    v_fma_f32 v63, v63, s28, v10
    v_mfma_f32_16x16x32_bf16 v[72:75], a[220:223], a[148:151], v[72:75]
    v_cvt_pk_bf16_f32 v112, v112, v113
    v_fma_f32 v78, v78, s28, v12
    v_mfma_f32_16x16x32_bf16 v[72:75], a[224:227], a[152:155], v[72:75]
    buffer_load_dwordx4 v6, s[8:11], s21 offen lds
    v_mfma_f32_16x16x32_bf16 v[80:83], a[224:227], a[176:179], 0
    s_add_u32 s21, s21, 12032
    v_cvt_pk_bf16_f32 v120, v120, v121
    v_exp_f32_e64 v60, v60 clamp
    v_mfma_f32_16x16x32_bf16 v[80:83], a[220:223], a[172:175], v[80:83]
    v_cvt_pk_bf16_f32 v176, v176, v177
    v_cvt_pk_bf16_f32 v113, v114, v115
    v_mfma_f32_16x16x32_bf16 v[80:83], a[216:219], a[168:171], v[80:83]
    s_waitcnt vmcnt(6) lgkmcnt(0)
    v_cvt_pk_bf16_f32 v188, v188, v189
    v_fma_f32 v70, v70, s28, v11
    v_mfma_f32_16x16x32_bf16 v[80:83], a[228:231], a[180:183], v[80:83]
    s_barrier
    ds_write2st64_b64 v93, v[112:113], v[160:161] offset0:0 offset1:12
    v_cvt_pk_bf16_f32 v200, v200, v201
    v_cvt_pk_bf16_f32 v248, v248, v249
    v_cvt_pk_bf16_f32 v168, v168, v169
    v_cvt_pk_bf16_f32 v209, v210, v211
    v_mfma_f32_16x16x32_bf16 v[80:83], a[232:235], a[184:187], v[80:83]
    ds_write2st64_b64 v93, v[208:209], v[104:105] offset0:24 offset1:36
    v_mfma_f32_16x16x32_bf16 v[80:83], a[236:239], a[188:191], v[80:83]
    v_cvt_pk_bf16_f32 v148, v148, v149
    v_cvt_pk_bf16_f32 v220, v220, v221
    v_mfma_f32_16x16x32_bf16 v[72:75], a[236:239], a[164:167], v[72:75]
    ds_read_b64_tr_b16 a[216:217], v2 offset:0
    v_cvt_pk_bf16_f32 v232, v232, v233
    v_mfma_f32_16x16x32_bf16 v[44:47], a[248:251], v[14:17], 0
    ds_read_b64_tr_b16 a[218:219], v2 offset:6144
    v_cvt_pk_bf16_f32 v121, v122, v123
    v_mfma_f32_16x16x32_bf16 v[72:75], a[232:235], a[160:163], v[72:75]
    v_cvt_pk_bf16_f32 v177, v178, v179
    v_cvt_pk_bf16_f32 v165, v166, v167
    v_mfma_f32_16x16x32_bf16 v[72:75], a[228:231], a[156:159], v[72:75]
    v_fma_f32 v52, v52, s28, v9
    v_cvt_pk_bf16_f32 v216, v216, v217
    v_mfma_f32_16x16x32_bf16 v[64:67], a[228:231], a[132:135], v[64:67]
    s_add_u32 m0, s22, 12288
    ds_read_b64_tr_b16 a[220:221], v3 offset:0
    v_cvt_pk_bf16_f32 v217, v218, v219
    v_mfma_f32_16x16x32_bf16 v[64:67], a[232:235], a[136:139], v[64:67]
    ds_read_b64_tr_b16 a[222:223], v3 offset:6144
    buffer_load_dwordx4 v6, s[4:7], s20 offen lds
    v_mfma_f32_16x16x32_bf16 v[64:67], a[236:239], a[140:143], v[64:67]
    ds_write2st64_b64 v95, v[116:117], v[164:165] offset0:0 offset1:12
    v_cvt_pk_bf16_f32 v169, v170, v171
    v_mfma_f32_16x16x32_bf16 v[56:59], a[236:239], a[116:119], v[56:59]
    ds_read_b64_tr_b16 a[238:239], v3 offset:7168
    v_accvgpr_read_b32 v105, a9
    v_cvt_pk_bf16_f32 v141, v142, v143
    v_cvt_pk_bf16_f32 v181, v182, v183
    v_accvgpr_read_b32 v106, a10
    v_accvgpr_read_b32 v104, a8
    v_pk_mul_f32 v[236:237], v[236:237], v[50:51] op_sel_hi:[1,0]
    v_cvt_pk_bf16_f32 v225, v226, v227
    v_exp_f32_e64 v68, v68 clamp
    v_cvt_pk_bf16_f32 v172, v172, v173
    v_fma_f32 v64, v64, s28, v10
    v_pk_mul_f32 v[134:135], v[134:135], v[48:49] op_sel_hi:[1,0]
    v_pk_mul_f32 v[204:205], v[204:205], v[92:93] op_sel_hi:[1,0]
    v_pk_mul_f32 v[202:203], v[202:203], v[92:93] op_sel_hi:[1,0]
    v_cvt_pk_bf16_f32 v213, v214, v215
    v_exp_f32_e64 v64, v64 clamp
    v_mfma_f32_16x16x32_bf16 v[56:59], a[232:235], a[112:115], v[56:59]
    s_add_u32 s20, s20, 128
    ds_read_b64_tr_b16 a[224:225], v4 offset:0
    v_exp_f32_e64 v78, v78 clamp
    v_accvgpr_read_b32 v107, a11
    v_mfma_f32_16x16x32_bf16 v[56:59], a[228:231], a[108:111], v[56:59]
    ds_write2st64_b64 v95, v[212:213], v[108:109] offset0:24 offset1:36
    v_fma_f32 v53, v53, s28, v9
    v_pk_mul_f32 v[230:231], v[230:231], v[50:51] op_sel_hi:[1,0]
    v_pk_mul_f32 v[136:137], v[136:137], v[48:49] op_sel_hi:[1,0]
    v_pk_mul_f32 v[106:107], v[106:107], v[94:95] op_sel_hi:[1,0]
    v_pk_mul_f32 v[196:197], v[196:197], v[92:93] op_sel_hi:[1,0]
    v_pk_mul_f32 v[104:105], v[104:105], v[94:95] op_sel_hi:[1,0]
    v_exp_f32_e64 v71, v71 clamp
    v_accvgpr_read_b32 v111, a15
    v_cvt_pk_bf16_f32 v104, v104, v105
    v_accvgpr_read_b32 v109, a13
    v_smfmac_f32_16x16x64_bf16 v[44:47], a[240:243], v[22:29], v101
    s_waitcnt lgkmcnt(2)
    ds_read_b64_tr_b16 a[236:237], v3 offset:1024
    v_exp_f32_e64 v70, v70 clamp
    v_fma_f32 v77, v77, s28, v12
    v_mfma_f32_16x16x32_bf16 v[112:115], a[216:219], v[14:17], 0
    ds_write2st64_b64 v8, v[120:121], v[168:169] offset0:0 offset1:12
    v_exp_f32_e64 v69, v69 clamp
    v_pk_mul_f32 v[138:139], v[138:139], v[48:49] op_sel_hi:[1,0]
    v_pk_mul_f32 v[184:185], v[184:185], v[92:93] op_sel_hi:[1,0]
    v_fma_f32 v72, v72, s28, v11
    v_pk_mul_f32 v[130:131], v[130:131], v[48:49] op_sel_hi:[1,0]
    v_pk_mul_f32 v[246:247], v[246:247], v[50:51] op_sel_hi:[1,0]
    v_fma_f32 v54, v54, s28, v9
    v_accvgpr_read_b32 v108, a12
    v_fma_f32 v79, v79, s28, v12
    v_cvt_pk_bf16_f32 v125, v126, v127
    v_pk_mul_f32 v[110:111], v[110:111], v[94:95] op_sel_hi:[1,0]
    v_cvt_pk_bf16_f32 v240, v240, v241
    v_cvt_pk_bf16_f32 v105, v106, v107
    v_accvgpr_read_b32 v107, a19
    v_exp_f32_e64 v53, v53 clamp
    v_cvt_pk_bf16_f32 v128, v128, v129
    v_cvt_pk_bf16_f32 v152, v152, v153
    v_pk_mul_f32 v[194:195], v[194:195], v[92:93] op_sel_hi:[1,0]
    v_pk_mul_f32 v[108:109], v[108:109], v[94:95] op_sel_hi:[1,0]
    v_fma_f32 v66, v66, s28, v10
    v_cvt_pk_bf16_f32 v173, v174, v175
    v_fma_f32 v74, v74, s28, v11
    v_exp_f32_e64 v54, v54 clamp
    v_mfma_f32_16x16x32_bf16 v[160:163], a[216:219], v[22:25], 0
    ds_read_b64_tr_b16 a[226:227], v4 offset:6144
    v_fma_f32 v62, v62, s28, v10
    v_mfma_f32_16x16x32_bf16 v[208:211], a[216:219], v[26:29], 0
    ds_read_b64_tr_b16 a[228:229], v5 offset:0
    v_exp_f32_e64 v63, v63 clamp
    v_cvt_pk_bf16_f32 v184, v184, v185
    v_cvt_pk_bf16_f32 v132, v132, v133
    v_accvgpr_read_b32 v106, a18
    v_cvt_pk_bf16_f32 v241, v242, v243
    v_mfma_f32_16x16x32_bf16 a[0:3], a[216:219], v[34:37], 0
    s_add_u32 m0, s22, 13312
    ds_read_b64_tr_b16 a[230:231], v5 offset:6144
    v_exp_f32_e64 v55, v55 clamp
    v_cvt_pk_bf16_f32 v108, v108, v109
    v_cvt_pk_bf16_f32 v129, v130, v131
    v_mfma_f32_16x16x32_bf16 a[4:7], a[220:223], v[34:37], 0
    ds_write2st64_b64 v8, v[216:217], v[104:105] offset0:24 offset1:36
    v_cvt_pk_bf16_f32 v136, v136, v137
    v_pk_mul_f32 v[234:235], v[234:235], v[50:51] op_sel_hi:[1,0]
    v_accvgpr_read_b32 v105, a17
    v_fma_f32 v75, v75, s28, v11
    v_accvgpr_read_b32 v104, a16
    v_pk_mul_f32 v[106:107], v[106:107], v[94:95] op_sel_hi:[1,0]
    v_cvt_pk_bf16_f32 v201, v202, v203
    v_pk_mul_f32 v[104:105], v[104:105], v[94:95] op_sel_hi:[1,0]
    v_pk_mul_f32 v[154:155], v[154:155], v[48:49] op_sel_hi:[1,0]
    v_cvt_pk_bf16_f32 v189, v190, v191
    v_pk_mul_f32 v[228:229], v[228:229], v[50:51] op_sel_hi:[1,0]
    v_pk_mul_f32 v[156:157], v[156:157], v[48:49] op_sel_hi:[1,0]
    v_cvt_pk_bf16_f32 v109, v110, v111
    v_cvt_pk_bf16_f32 v104, v104, v105
    v_pk_mul_f32 v[254:255], v[254:255], v[50:51] op_sel_hi:[1,0]
    v_exp_f32_e64 v79, v79 clamp
    v_cvt_pk_bf16_f32 v228, v228, v229
    v_fma_f32 v65, v65, s28, v10
    v_mfma_f32_16x16x32_bf16 v[212:215], a[220:223], v[26:29], 0
    ds_write2st64_b64 v102, v[124:125], v[172:173] offset0:0 offset1:12
    v_cvt_pk_bf16_f32 v105, v106, v107
    v_mfma_f32_16x16x32_bf16 v[164:167], a[220:223], v[22:25], 0
    ds_read_b64_tr_b16 a[234:235], v2 offset:7168
    v_accvgpr_read_b32 v106, a26
    v_mfma_f32_16x16x32_bf16 v[116:119], a[220:223], v[14:17], 0
    s_waitcnt lgkmcnt(3)
    ds_read_b64_tr_b16 a[222:223], v5 offset:7168
    v_accvgpr_read_b32 v110, a22
    v_cvt_pk_bf16_f32 v221, v222, v223
    v_mfma_f32_16x16x32_bf16 v[120:123], a[224:227], v[14:17], 0
    buffer_load_dwordx4 v6, s[4:7], s20 offen lds
    ds_read_b128 v[88:91], v103 offset:0
    v_cvt_pk_bf16_f32 v137, v138, v139
    v_mfma_f32_16x16x32_bf16 v[168:171], a[224:227], v[22:25], 0
    ds_read_b64_tr_b16 a[232:233], v2 offset:1024
    v_cvt_pk_bf16_f32 v31, v70, v71
    v_mfma_f32_16x16x32_bf16 v[216:219], a[224:227], v[26:29], 0
    ds_write2st64_b64 v102, v[220:221], v[108:109] offset0:24 offset1:36
    v_cvt_pk_bf16_f32 v236, v236, v237
    v_cvt_pk_bf16_f32 v252, v252, v253
    v_mfma_f32_16x16x32_bf16 a[8:11], a[224:227], v[34:37], 0
    ds_write2st64_b64 v93, v[128:129], v[176:177] offset0:4 offset1:16
    v_pk_mul_f32 v[146:147], v[146:147], v[48:49] op_sel_hi:[1,0]
    v_accvgpr_read_b32 v107, a27
    v_cvt_pk_bf16_f32 v133, v134, v135
    v_mfma_f32_16x16x32_bf16 a[12:15], a[228:231], v[34:37], 0
    ds_read_b128 v[96:99], v103 offset:1024
    v_exp_f32_e64 v77, v77 clamp
    v_accvgpr_read_b32 v111, a23
    v_fma_f32 v83, v83, s28, v12
    v_cvt_pk_bf16_f32 v229, v230, v231
    v_accvgpr_read_b32 v108, a20
    v_mfma_f32_16x16x32_bf16 v[44:47], a[252:255], v[34:37], v[44:47]
    ds_read_b64_tr_b16 a[218:219], v4 offset:7168
    v_fma_f32 v82, v82, s28, v12
    v_mfma_f32_16x16x32_bf16 v[220:223], a[228:231], v[26:29], 0
    ds_write2st64_b64 v93, v[224:225], v[104:105] offset0:28 offset1:40
    v_accvgpr_read_b32 v105, a25
    v_pk_mul_f32 v[186:187], v[186:187], v[92:93] op_sel_hi:[1,0]
    v_accvgpr_read_b32 v104, a24
    v_pk_mul_f32 v[198:199], v[198:199], v[92:93] op_sel_hi:[1,0]
    v_accvgpr_read_b32 v109, a21
    v_fma_f32 v67, v67, s28, v10
    v_cvt_pk_bf16_f32 v149, v150, v151
    v_pk_mul_f32 v[104:105], v[104:105], v[94:95] op_sel_hi:[1,0]
    v_fma_f32 v73, v73, s28, v11
    v_pk_mul_f32 v[110:111], v[110:111], v[94:95] op_sel_hi:[1,0]
    v_pk_mul_f32 v[108:109], v[108:109], v[94:95] op_sel_hi:[1,0]
    v_cvt_pk_bf16_f32 v145, v146, v147
    v_cvt_pk_bf16_f32 v233, v234, v235
    v_mfma_f32_16x16x32_bf16 v[172:175], a[228:231], v[22:25], 0
    s_add_u32 s20, s20, 128
    ds_read_b64_tr_b16 a[216:217], v4 offset:1024
    v_cvt_pk_bf16_f32 v196, v196, v197
    v_mfma_f32_16x16x32_bf16 v[124:127], a[228:231], v[14:17], 0
    s_waitcnt lgkmcnt(4)
    v_cvt_pk_bf16_f32 v108, v108, v109
    v_cvt_pk_bf16_f32 v237, v238, v239
    v_mfma_f32_16x16x32_bf16 v[128:131], a[232:235], v[14:17], 0
    ds_write2st64_b64 v95, v[132:133], v[180:181] offset0:4 offset1:16
    v_fma_f32 v56, v56, s28, v9
    v_cvt_pk_bf16_f32 v109, v110, v111
    v_mfma_f32_16x16x32_bf16 v[176:179], a[232:235], v[22:25], 0
    ds_write2st64_b64 v95, v[228:229], v[108:109] offset0:28 offset1:40
    v_mfma_f32_16x16x32_bf16 v[224:227], a[232:235], v[26:29], 0
    s_add_u32 m0, s22, 14336
    ds_read_b64_tr_b16 a[224:225], v2 offset:2048
    buffer_load_dwordx4 v6, s[4:7], s20 offen lds
    v_cvt_pk_bf16_f32 v197, v198, v199
    v_cvt_pk_bf16_f32 v185, v186, v187
    v_pk_mul_f32 v[106:107], v[106:107], v[94:95] op_sel_hi:[1,0]
    v_accvgpr_read_b32 v108, a28
    v_accvgpr_read_b32 v110, a30
    v_mfma_f32_16x16x32_bf16 a[16:19], a[232:235], v[34:37], 0
    ds_write2st64_b64 v8, v[136:137], v[184:185] offset0:4 offset1:16
    v_mfma_f32_16x16x32_bf16 a[20:23], a[236:239], v[34:37], 0
    ds_read_b64_tr_b16 a[220:221], v5 offset:1024
    v_cvt_pk_bf16_f32 v104, v104, v105
    v_cvt_pk_bf16_f32 v249, v250, v251
    v_cvt_pk_bf16_f32 v193, v194, v195
    v_cvt_pk_bf16_f32 v153, v154, v155
    v_mfma_f32_16x16x32_bf16 v[228:231], a[236:239], v[26:29], 0
    s_add_u32 s20, s20, 12032
    ds_read_b64_tr_b16 a[230:231], v3 offset:8192
    v_cvt_pk_bf16_f32 v105, v106, v107
    v_accvgpr_read_b32 v107, a35
    v_accvgpr_read_b32 v109, a29
    v_mfma_f32_16x16x32_bf16 v[180:183], a[236:239], v[22:25], 0
    s_add_u32 m0, s38, 0
    ds_read_b64_tr_b16 a[226:227], v2 offset:8192
    buffer_load_dwordx4 v6, s[12:15], s33 offen nt lds
    v_mfma_f32_16x16x32_bf16 v[132:135], a[236:239], v[14:17], 0
    s_waitcnt lgkmcnt(5)
    ds_read_b64_tr_b16 a[232:233], v4 offset:2048
    ds_read_b64_tr_b16 a[236:237], v5 offset:2048
    v_cvt_pk_bf16_f32 v253, v254, v255
    v_mfma_f32_16x16x32_bf16 v[136:139], a[216:219], v[14:17], 0
    ds_write2st64_b64 v8, v[232:233], v[104:105] offset0:28 offset1:40
    v_mfma_f32_16x16x32_bf16 v[184:187], a[216:219], v[22:25], 0
    buffer_store_dwordx4 v[88:91], v6, s[16:19], s67 offen offset:0 nt
    s_add_u32 m0, s38, 1024
    ds_read_b64_tr_b16 a[228:229], v3 offset:2048
    ds_read_b64_tr_b16 a[234:235], v4 offset:8192
    v_accvgpr_read_b32 v106, a34
    v_pk_mul_f32 v[158:159], v[158:159], v[48:49] op_sel_hi:[1,0]
    v_cvt_pk_bf16_f32 v244, v244, v245
    v_pk_mul_f32 v[108:109], v[108:109], v[94:95] op_sel_hi:[1,0]
    v_accvgpr_read_b32 v111, a31
    v_pk_mul_f32 v[110:111], v[110:111], v[94:95] op_sel_hi:[1,0]
    v_exp_f32_e64 v61, v61 clamp
    v_accvgpr_read_b32 v104, a32
    v_mfma_f32_16x16x32_bf16 v[232:235], a[216:219], v[26:29], 0
    ds_read_b64_tr_b16 a[238:239], v5 offset:8192
    v_accvgpr_read_b32 v105, a33
    v_cvt_pk_bf16_f32 v108, v108, v109
    v_exp_f32_e64 v52, v52 clamp
    v_pk_mul_f32 v[104:105], v[104:105], v[94:95] op_sel_hi:[1,0]
    v_pk_mul_f32 v[106:107], v[106:107], v[94:95] op_sel_hi:[1,0]
    v_cvt_pk_bf16_f32 v245, v246, v247
    v_cvt_pk_bf16_f32 v109, v110, v111
    v_fma_f32 v81, v81, s28, v12
    v_fma_f32 v57, v57, s28, v9
    v_mfma_f32_16x16x32_bf16 a[24:27], a[216:219], v[34:37], 0
    s_waitcnt lgkmcnt(4)
    ds_write2st64_b64 v102, v[140:141], v[188:189] offset0:4 offset1:16
    v_mfma_f32_16x16x32_bf16 a[28:31], a[220:223], v[34:37], 0
    buffer_load_dwordx4 v7, s[12:15], s33 offen nt lds
    ds_write2st64_b64 v102, v[236:237], v[108:109] offset0:28 offset1:40
    v_mfma_f32_16x16x32_bf16 v[236:239], a[220:223], v[26:29], 0
    v_accvgpr_read_b32 v109, a37
    v_cvt_pk_bf16_f32 v104, v104, v105
    v_mfma_f32_16x16x32_bf16 v[188:191], a[220:223], v[22:25], 0
    s_add_u32 s39, s39, 12288
    ds_write2st64_b64 v93, v[144:145], v[192:193] offset0:8 offset1:20
    v_mfma_f32_16x16x32_bf16 v[140:143], a[220:223], v[14:17], 0
    v_cvt_pk_bf16_f32 v105, v106, v107
    v_cvt_pk_bf16_f32 v204, v204, v205
    v_mfma_f32_16x16x32_bf16 v[144:147], a[224:227], v[14:17], 0
    s_waitcnt vmcnt(9) lgkmcnt(3)
    ds_write2st64_b64 v93, v[240:241], v[104:105] offset0:32 offset1:44
    v_mfma_f32_16x16x32_bf16 v[192:195], a[224:227], v[22:25], 0
    buffer_store_dwordx4 v[96:99], v7, s[16:19], s67 offen offset:0 nt
    s_barrier
    v_accvgpr_read_b32 v110, a38
    v_cvt_pk_bf16_f32 v30, v68, v69
    v_accvgpr_read_b32 v108, a36
    v_accvgpr_read_b32 v111, a39
    v_pk_mul_f32 v[206:207], v[206:207], v[92:93] op_sel_hi:[1,0]
    v_accvgpr_read_b32 v106, a42
    v_pk_mul_f32 v[108:109], v[108:109], v[94:95] op_sel_hi:[1,0]
    v_cvt_pk_bf16_f32 v18, v52, v53
    v_pk_mul_f32 v[110:111], v[110:111], v[94:95] op_sel_hi:[1,0]
    v_cvt_pk_bf16_f32 v108, v108, v109
    v_cvt_pk_bf16_f32 v156, v156, v157
    v_accvgpr_read_b32 v105, a41
    v_mfma_f32_16x16x32_bf16 v[240:243], a[224:227], v[26:29], 0
    ds_write2st64_b64 v95, v[148:149], v[196:197] offset0:8 offset1:20
    v_cvt_pk_bf16_f32 v109, v110, v111
    v_accvgpr_read_b32 v111, a47
    v_mfma_f32_16x16x32_bf16 a[32:35], a[224:227], v[34:37], 0
    ds_read_b128 a[216:219], v0 offset:0
    v_fma_f32 v80, v80, s28, v12
    v_accvgpr_read_b32 v107, a43
    v_accvgpr_read_b32 v110, a46
    v_mfma_f32_16x16x32_bf16 a[36:39], a[228:231], v[34:37], 0
    ds_write2st64_b64 v95, v[244:245], v[108:109] offset0:32 offset1:44
    v_cvt_pk_bf16_f32 v157, v158, v159
    v_mfma_f32_16x16x32_bf16 v[244:247], a[228:231], v[26:29], 0
    ds_write2st64_b64 v8, v[152:153], v[200:201] offset0:8 offset1:20
    v_accvgpr_read_b32 v108, a44
    v_pk_mul_f32 v[106:107], v[106:107], v[94:95] op_sel_hi:[1,0]
    v_accvgpr_read_b32 v104, a40
    v_exp_f32_e64 v75, v75 clamp
    v_accvgpr_read_b32 v109, a45
    v_pk_mul_f32 v[108:109], v[108:109], v[94:95] op_sel_hi:[1,0]
    v_pk_mul_f32 v[110:111], v[110:111], v[94:95] op_sel_hi:[1,0]
    v_pk_mul_f32 v[104:105], v[104:105], v[94:95] op_sel_hi:[1,0]
    v_exp_f32_e64 v62, v62 clamp
    v_cvt_pk_bf16_f32 v108, v108, v109
    v_mfma_f32_16x16x32_bf16 v[196:199], a[228:231], v[22:25], 0
    ds_read_b128 a[224:227], v0 offset:1024
    v_cvt_pk_bf16_f32 v104, v104, v105
    v_cvt_pk_bf16_f32 v105, v106, v107
    v_mfma_f32_16x16x32_bf16 v[148:151], a[228:231], v[14:17], 0
    s_add_u32 m0, s22, 24576
    ds_read_b128 a[220:223], v1 offset:0
    v_fma_f32 v58, v58, s28, v9
    v_mfma_f32_16x16x32_bf16 v[152:155], a[232:235], v[14:17], 0
    ds_write2st64_b64 v8, v[248:249], v[104:105] offset0:32 offset1:44
    v_mfma_f32_16x16x32_bf16 v[200:203], a[232:235], v[22:25], 0
    v_cvt_pk_bf16_f32 v205, v206, v207
    v_cvt_pk_bf16_f32 v109, v110, v111
    v_mfma_f32_16x16x32_bf16 v[248:251], a[232:235], v[26:29], 0
    ds_write2st64_b64 v102, v[156:157], v[204:205] offset0:8 offset1:20
    v_mfma_f32_16x16x32_bf16 a[40:43], a[232:235], v[34:37], 0
    buffer_load_dwordx4 v6, s[8:11], s21 offen lds
    ds_read_b128 v[84:87], v103 offset:2048
    v_mfma_f32_16x16x32_bf16 a[44:47], a[236:239], v[34:37], 0
    ds_write2st64_b64 v102, v[252:253], v[108:109] offset0:32 offset1:44
    v_cvt_pk_bf16_f32 v34, v76, v77
    v_mfma_f32_16x16x32_bf16 v[252:255], a[236:239], v[26:29], 0
    s_add_u32 s21, s21, 128
    v_exp_f32_e64 v82, v82 clamp
    v_mfma_f32_16x16x32_bf16 v[204:207], a[236:239], v[22:25], 0
    v_exp_f32_e64 v81, v81 clamp
    v_mfma_f32_16x16x32_bf16 v[156:159], a[236:239], v[14:17], 0
    s_waitcnt lgkmcnt(3)
    ds_read_b128 a[236:239], v1 offset:2048
    v_cvt_pk_bf16_f32 v19, v54, v55
    v_mfma_f32_16x16x32_bf16 v[52:55], a[216:219], a[96:99], 0
    ds_read_b128 a[228:231], v1 offset:1024
    v_cvt_pk_bf16_f32 v23, v62, v63
    v_mfma_f32_16x16x32_bf16 v[52:55], a[220:223], a[100:103], v[52:55]
    v_mov_b32 v48, 0
    v_cvt_pk_bf16_f32 v22, v60, v61
    v_mfma_f32_16x16x32_bf16 v[52:55], a[224:227], a[104:107], v[52:55]
    ds_read_b128 a[232:235], v0 offset:2048
    v_mov_b32 v50, 0
    v_mfma_f32_16x16x32_bf16 v[60:63], a[224:227], a[128:131], 0
    s_add_u32 m0, s22, 25600
    v_exp_f32_e64 v67, v67 clamp
    v_mfma_f32_16x16x32_bf16 v[60:63], a[220:223], a[124:127], v[60:63]
    v_exp_f32_e64 v74, v74 clamp
    v_mfma_f32_16x16x32_bf16 v[60:63], a[216:219], a[120:123], v[60:63]
    buffer_load_dwordx4 v6, s[8:11], s21 offen lds
    v_cvt_pk_bf16_f32 v35, v78, v79
    v_mfma_f32_16x16x32_bf16 v[68:71], a[216:219], a[144:147], 0
    v_exp_f32_e64 v56, v56 clamp
    v_mfma_f32_16x16x32_bf16 v[68:71], a[220:223], a[148:151], v[68:71]
    s_add_u32 s21, s21, 128
    ds_read_b128 v[88:91], v103 offset:3072
    v_fma_f32 v59, v59, s28, v9
    v_mfma_f32_16x16x32_bf16 v[68:71], a[224:227], a[152:155], v[68:71]
    s_add_u32 m0, s22, 26624
    v_exp_f32_e64 v66, v66 clamp
    v_mfma_f32_16x16x32_bf16 v[76:79], a[224:227], a[176:179], 0
    ds_read_b128 v[96:99], v103 offset:4096
    v_exp_f32_e64 v58, v58 clamp
    v_mfma_f32_16x16x32_bf16 v[76:79], a[220:223], a[172:175], v[76:79]
    buffer_load_dwordx4 v6, s[8:11], s21 offen lds
    v_mfma_f32_16x16x32_bf16 v[76:79], a[216:219], a[168:171], v[76:79]
    s_waitcnt lgkmcnt(3)
    v_exp_f32_e64 v83, v83 clamp
    v_mfma_f32_16x16x32_bf16 v[76:79], a[228:231], a[180:183], v[76:79]
    s_waitcnt lgkmcnt(2)
    v_exp_f32_e64 v65, v65 clamp
    v_mfma_f32_16x16x32_bf16 v[76:79], a[232:235], a[184:187], v[76:79]
    v_exp_f32_e64 v59, v59 clamp
    v_mfma_f32_16x16x32_bf16 v[76:79], a[236:239], a[188:191], v[76:79]
    s_add_u32 s21, s21, 12032
    ds_read_b128 a[216:219], v0 offset:6144
    v_cvt_pk_bf16_f32 v33, v82, v83
    v_mfma_f32_16x16x32_bf16 v[68:71], a[236:239], a[164:167], v[68:71]
    v_exp_f32_e64 v73, v73 clamp
    v_mfma_f32_16x16x32_bf16 v[68:71], a[232:235], a[160:163], v[68:71]
    s_add_u32 s56, s67, 128
    ds_read_b128 a[220:223], v1 offset:6144
    v_cvt_pk_bf16_f32 v21, v66, v67
    v_mfma_f32_16x16x32_bf16 v[68:71], a[228:231], a[156:159], v[68:71]
    buffer_store_dwordx4 v[84:87], v6, s[16:19], s56 offen offset:0 nt
    v_cvt_pk_bf16_f32 v29, v74, v75
    v_cvt_pk_bf16_f32 v17, v58, v59
    v_exp_f32_e64 v57, v57 clamp
    v_mfma_f32_16x16x32_bf16 v[60:63], a[228:231], a[132:135], v[60:63]
    s_add_u32 s58, s33, 128
    ds_read_b128 a[224:227], v0 offset:7168
    v_mfma_f32_16x16x32_bf16 v[60:63], a[232:235], a[136:139], v[60:63]
    s_add_u32 m0, s38, 2048
    v_cvt_pk_bf16_f32 v20, v64, v65
    v_exp_f32_e64 v72, v72 clamp
    v_mfma_f32_16x16x32_bf16 v[60:63], a[236:239], a[140:143], v[60:63]
    v_cvt_pk_bf16_f32 v16, v56, v57
    v_cvt_pk_bf16_f32 v28, v72, v73
    v_mfma_f32_16x16x32_bf16 v[52:55], a[236:239], a[116:119], v[52:55]
    buffer_load_dwordx4 v6, s[12:15], s58 offen nt lds
    v_smfmac_f32_16x16x64_bf16 v[48:51], a[240:243], v[16:23], v101
    s_add_u32 m0, s38, 3072
    ds_read_b128 a[236:239], v1 offset:8192
    v_mfma_f32_16x16x32_bf16 v[52:55], a[232:235], a[112:115], v[52:55]
    v_exp_f32_e64 v80, v80 clamp
    v_mfma_f32_16x16x32_bf16 v[52:55], a[228:231], a[108:111], v[52:55]
    s_waitcnt lgkmcnt(2)
    ds_read_b128 v[84:87], v103 offset:5120
    v_cvt_pk_bf16_f32 v32, v80, v81
    v_mfma_f32_16x16x32_bf16 v[56:59], a[216:219], a[96:99], 0
    buffer_load_dwordx4 v7, s[12:15], s58 offen nt lds
    v_smfmac_f32_16x16x64_bf16 v[48:51], a[244:247], v[28:35], v101
    s_add_u32 s57, s67, 256
    ds_read_b128 a[232:235], v0 offset:8192
    v_mfma_f32_16x16x32_bf16 v[56:59], a[220:223], a[100:103], v[56:59]
    s_add_u32 s59, s33, 256
    ds_read_b128 a[228:231], v1 offset:7168
    s_waitcnt lgkmcnt(4)
    v_mfma_f32_16x16x32_bf16 v[56:59], a[224:227], a[104:107], v[56:59]
    s_add_u32 m0, s38, 4096
    v_cmp_lt_f32 vcc, s29, v48
    v_add_u32 v103, 6144, v103
    v_mfma_f32_16x16x32_bf16 v[64:67], a[224:227], a[128:131], 0
    buffer_load_dwordx4 v6, s[12:15], s59 offen nt lds
    v_mfma_f32_16x16x32_bf16 v[64:67], a[220:223], a[124:127], v[64:67]
    s_add_u32 m0, s38, 5120
    s_cbranch_vccnz L_rs_tr44d
L_ret_tr44d:
    v_mfma_f32_16x16x32_bf16 v[64:67], a[216:219], a[120:123], v[64:67]
    v_fma_f32 v53, v53, s28, v9
    v_fma_f32 v54, v54, s28, v9
    v_mfma_f32_16x16x32_bf16 v[72:75], a[216:219], a[144:147], 0
    v_fma_f32 v55, v55, s28, v9
    v_fma_f32 v60, v60, s28, v10
    v_mfma_f32_16x16x32_bf16 v[72:75], a[220:223], a[148:151], v[72:75]
    v_exp_f32_e64 v53, v53 clamp
    v_mfma_f32_16x16x32_bf16 v[72:75], a[224:227], a[152:155], v[72:75]
    s_waitcnt lgkmcnt(2)
    buffer_load_dwordx4 v7, s[12:15], s59 offen nt lds
    v_mfma_f32_16x16x32_bf16 v[80:83], a[224:227], a[176:179], 0
    v_exp_f32_e64 v60, v60 clamp
    v_mfma_f32_16x16x32_bf16 v[80:83], a[220:223], a[172:175], v[80:83]
    buffer_store_dwordx4 v[88:91], v7, s[16:19], s56 offen offset:0 nt
    s_waitcnt vmcnt(16) lgkmcnt(0)
    s_barrier
    v_fma_f32 v52, v52, s28, v9
    v_mfma_f32_16x16x32_bf16 v[80:83], a[216:219], a[168:171], v[80:83]
    s_add_u32 m0, s22, 0
    v_exp_f32_e64 v55, v55 clamp
    v_mfma_f32_16x16x32_bf16 v[80:83], a[228:231], a[180:183], v[80:83]
    buffer_load_dwordx4 v6, s[4:7], s20 offen lds
    v_mfma_f32_16x16x32_bf16 v[80:83], a[232:235], a[184:187], v[80:83]
    ds_read_b64_tr_b16 a[216:217], v2 offset:18432
    s_add_u32 s20, s20, 128
    v_mfma_f32_16x16x32_bf16 v[80:83], a[236:239], a[188:191], v[80:83]
    ds_read_b64_tr_b16 a[218:219], v2 offset:12288
    v_mfma_f32_16x16x32_bf16 v[72:75], a[236:239], a[164:167], v[72:75]
    s_add_u32 m0, s22, 1024
    v_exp_f32_e64 v54, v54 clamp
    v_mfma_f32_16x16x32_bf16 v[72:75], a[232:235], a[160:163], v[72:75]
    ds_read_b64_tr_b16 a[220:221], v3 offset:18432
    v_fma_f32 v61, v61, s28, v10
    v_mfma_f32_16x16x32_bf16 v[72:75], a[228:231], a[156:159], v[72:75]
    buffer_load_dwordx4 v6, s[4:7], s20 offen lds
    v_mfma_f32_16x16x32_bf16 v[64:67], a[228:231], a[132:135], v[64:67]
    buffer_store_dwordx4 v[96:99], v6, s[16:19], s57 offen offset:0 nt
    s_add_u32 s20, s20, 128
    ds_read_b64_tr_b16 a[222:223], v3 offset:12288
    v_exp_f32_e64 v52, v52 clamp
    v_mfma_f32_16x16x32_bf16 v[64:67], a[232:235], a[136:139], v[64:67]
    s_add_u32 m0, s22, 2048
    v_exp_f32_e64 v61, v61 clamp
    v_mfma_f32_16x16x32_bf16 v[64:67], a[236:239], a[140:143], v[64:67]
    buffer_load_dwordx4 v6, s[4:7], s20 offen lds
    v_mfma_f32_16x16x32_bf16 v[56:59], a[236:239], a[116:119], v[56:59]
    ds_read_b64_tr_b16 a[224:225], v4 offset:18432
    v_cvt_pk_bf16_f32 v15, v54, v55
    v_mfma_f32_16x16x32_bf16 v[56:59], a[232:235], a[112:115], v[56:59]
    s_add_u32 s20, s20, 12032
    ds_read_b64_tr_b16 a[226:227], v4 offset:12288
    v_cvt_pk_bf16_f32 v14, v52, v53
    v_mfma_f32_16x16x32_bf16 v[56:59], a[228:231], a[108:111], v[56:59]
    s_waitcnt lgkmcnt(4)
    ds_read_b64_tr_b16 a[228:229], v5 offset:18432
    ds_read_b64_tr_b16 a[230:231], v5 offset:12288
    buffer_store_dwordx4 v[84:87], v7, s[16:19], s57 offen offset:0 nt
    s_branch L_loop4w0
L_end5:
    v_mfma_f32_16x16x32_bf16 v[112:115], a[216:219], v[16:19], v[112:115]
    v_fma_f32 v79, v79, s28, v12
    v_fma_f32 v76, v76, s28, v12
    v_mfma_f32_16x16x32_bf16 v[116:119], a[220:223], v[16:19], v[116:119]
    v_fma_f32 v87, v87, s28, v13
    v_fma_f32 v68, v68, s28, v11
    v_mfma_f32_16x16x32_bf16 v[164:167], a[220:223], v[20:23], v[164:167]
    v_fma_f32 v86, v86, s28, v13
    v_fma_f32 v78, v78, s28, v12
    v_mfma_f32_16x16x32_bf16 v[160:163], a[216:219], v[20:23], v[160:163]
    ds_read_b64_tr_b16 a[234:235], v2 offset:13312
    v_fma_f32 v71, v71, s28, v11
    v_mfma_f32_16x16x32_bf16 v[208:211], a[216:219], v[28:31], v[208:211]
    v_fma_f32 v77, v77, s28, v12
    v_fma_f32 v73, v73, s28, v11
    v_mfma_f32_16x16x32_bf16 v[212:215], a[220:223], v[28:31], v[212:215]
    ds_read_b64_tr_b16 a[232:233], v2 offset:19456
    v_mfma_f32_16x16x32_bf16 a[4:7], a[220:223], v[32:35], a[4:7]
    v_fma_f32 v82, v82, s28, v12
    v_fma_f32 v59, v59, s28, v9
    v_mfma_f32_16x16x32_bf16 a[0:3], a[216:219], v[32:35], a[0:3]
    ds_read_b64_tr_b16 a[236:237], v3 offset:19456
    v_fma_f32 v65, v65, s28, v10
    v_mfma_f32_16x16x32_bf16 a[48:51], a[216:219], v[40:43], a[48:51]
    s_add_u32 s39, s39, 12288
    ds_read_b64_tr_b16 a[238:239], v3 offset:13312
    v_fma_f32 v84, v84, s28, v13
    v_mfma_f32_16x16x32_bf16 a[52:55], a[220:223], v[40:43], a[52:55]
    s_waitcnt lgkmcnt(4)
    v_exp_f32_e64 v86, v86 clamp
    v_mfma_f32_16x16x32_bf16 a[56:59], a[224:227], v[40:43], a[56:59]
    v_fma_f32 v56, v56, s28, v9
    v_mfma_f32_16x16x32_bf16 a[60:63], a[228:231], v[40:43], a[60:63]
    v_mfma_f32_16x16x32_bf16 a[12:15], a[228:231], v[32:35], a[12:15]
    ds_read_b64_tr_b16 a[218:219], v4 offset:13312
    v_mfma_f32_16x16x32_bf16 a[8:11], a[224:227], v[32:35], a[8:11]
    v_fma_f32 v69, v69, s28, v11
    v_mfma_f32_16x16x32_bf16 v[216:219], a[224:227], v[28:31], v[216:219]
    ds_read_b64_tr_b16 a[222:223], v5 offset:13312
    v_fma_f32 v75, v75, s28, v11
    v_mfma_f32_16x16x32_bf16 v[220:223], a[228:231], v[28:31], v[220:223]
    ds_read_b64_tr_b16 a[216:217], v4 offset:19456
    v_fma_f32 v64, v64, s28, v10
    v_mfma_f32_16x16x32_bf16 v[172:175], a[228:231], v[20:23], v[172:175]
    v_fma_f32 v80, v80, s28, v12
    v_fma_f32 v70, v70, s28, v11
    v_mfma_f32_16x16x32_bf16 v[168:171], a[224:227], v[20:23], v[168:171]
    v_exp_f32_e64 v64, v64 clamp
    v_mfma_f32_16x16x32_bf16 v[120:123], a[224:227], v[16:19], v[120:123]
    ds_read_b64_tr_b16 a[220:221], v5 offset:19456
    v_mfma_f32_16x16x32_bf16 v[124:127], a[228:231], v[16:19], v[124:127]
    s_waitcnt lgkmcnt(4)
    v_exp_f32_e64 v69, v69 clamp
    v_mfma_f32_16x16x32_bf16 v[128:131], a[232:235], v[16:19], v[128:131]
    v_exp_f32_e64 v75, v75 clamp
    v_mfma_f32_16x16x32_bf16 v[132:135], a[236:239], v[16:19], v[132:135]
    v_fma_f32 v67, v67, s28, v10
    v_fma_f32 v66, v66, s28, v10
    v_mfma_f32_16x16x32_bf16 v[180:183], a[236:239], v[20:23], v[180:183]
    ds_read_b64_tr_b16 a[228:229], v3 offset:20480
    v_fma_f32 v81, v81, s28, v12
    v_mfma_f32_16x16x32_bf16 v[176:179], a[232:235], v[20:23], v[176:179]
    ds_read_b64_tr_b16 a[230:231], v3 offset:14336
    v_mfma_f32_16x16x32_bf16 v[224:227], a[232:235], v[28:31], v[224:227]
    ds_read_b64_tr_b16 a[226:227], v2 offset:14336
    v_mfma_f32_16x16x32_bf16 v[228:231], a[236:239], v[28:31], v[228:231]
    v_exp_f32_e64 v67, v67 clamp
    v_mfma_f32_16x16x32_bf16 a[20:23], a[236:239], v[32:35], a[20:23]
    v_fma_f32 v72, v72, s28, v11
    v_fma_f32 v88, v88, s28, v13
    v_mfma_f32_16x16x32_bf16 a[16:19], a[232:235], v[32:35], a[16:19]
    ds_read_b64_tr_b16 a[224:225], v2 offset:20480
    v_mfma_f32_16x16x32_bf16 a[64:67], a[232:235], v[40:43], a[64:67]
    v_exp_f32_e64 v82, v82 clamp
    v_mfma_f32_16x16x32_bf16 a[68:71], a[236:239], v[40:43], a[68:71]
    s_waitcnt lgkmcnt(4)
    v_exp_f32_e64 v78, v78 clamp
    v_mfma_f32_16x16x32_bf16 a[72:75], a[216:219], v[40:43], a[72:75]
    v_exp_f32_e64 v87, v87 clamp
    v_mfma_f32_16x16x32_bf16 a[76:79], a[220:223], v[40:43], a[76:79]
    v_exp_f32_e64 v68, v68 clamp
    v_mfma_f32_16x16x32_bf16 a[28:31], a[220:223], v[32:35], a[28:31]
    ds_read_b64_tr_b16 a[232:233], v4 offset:20480
    v_mfma_f32_16x16x32_bf16 a[24:27], a[216:219], v[32:35], a[24:27]
    ds_read_b64_tr_b16 a[236:237], v5 offset:20480
    v_fma_f32 v74, v74, s28, v11
    v_mfma_f32_16x16x32_bf16 v[232:235], a[216:219], v[28:31], v[232:235]
    v_exp_f32_e64 v76, v76 clamp
    v_mfma_f32_16x16x32_bf16 v[236:239], a[220:223], v[28:31], v[236:239]
    ds_read_b64_tr_b16 a[234:235], v4 offset:14336
    v_fma_f32 v83, v83, s28, v12
    v_mfma_f32_16x16x32_bf16 v[188:191], a[220:223], v[20:23], v[188:191]
    ds_read_b64_tr_b16 a[238:239], v5 offset:14336
    v_fma_f32 v89, v89, s28, v13
    v_mfma_f32_16x16x32_bf16 v[184:187], a[216:219], v[20:23], v[184:187]
    v_exp_f32_e64 v77, v77 clamp
    v_mfma_f32_16x16x32_bf16 v[136:139], a[216:219], v[16:19], v[136:139]
    v_exp_f32_e64 v80, v80 clamp
    v_mfma_f32_16x16x32_bf16 v[140:143], a[220:223], v[16:19], v[140:143]
    s_waitcnt lgkmcnt(4)
    v_exp_f32_e64 v79, v79 clamp
    v_mfma_f32_16x16x32_bf16 v[144:147], a[224:227], v[16:19], v[144:147]
    v_fma_f32 v85, v85, s28, v13
    v_fma_f32 v57, v57, s28, v9
    v_mfma_f32_16x16x32_bf16 v[148:151], a[228:231], v[16:19], v[148:151]
    v_fma_f32 v90, v90, s28, v13
    v_mfma_f32_16x16x32_bf16 v[196:199], a[228:231], v[20:23], v[196:199]
    v_exp_f32_e64 v81, v81 clamp
    v_mfma_f32_16x16x32_bf16 v[192:195], a[224:227], v[20:23], v[192:195]
    v_exp_f32_e64 v70, v70 clamp
    v_mfma_f32_16x16x32_bf16 v[240:243], a[224:227], v[28:31], v[240:243]
    v_exp_f32_e64 v85, v85 clamp
    v_mfma_f32_16x16x32_bf16 v[244:247], a[228:231], v[28:31], v[244:247]
    v_exp_f32_e64 v73, v73 clamp
    v_mfma_f32_16x16x32_bf16 a[36:39], a[228:231], v[32:35], a[36:39]
    v_exp_f32_e64 v72, v72 clamp
    v_mfma_f32_16x16x32_bf16 a[32:35], a[224:227], v[32:35], a[32:35]
    s_waitcnt vmcnt(10) lgkmcnt(0)
    v_exp_f32_e64 v57, v57 clamp
    v_mfma_f32_16x16x32_bf16 a[80:83], a[224:227], v[40:43], a[80:83]
    v_exp_f32_e64 v71, v71 clamp
    v_mfma_f32_16x16x32_bf16 a[84:87], a[228:231], v[40:43], a[84:87]
    s_barrier
    ds_read_b128 a[220:223], v1 offset:12288
    v_mfma_f32_16x16x32_bf16 a[88:91], a[232:235], v[40:43], a[88:91]
    ds_read_b128 a[216:219], v0 offset:12288
    v_cvt_pk_bf16_f32 v26, v68, v69
    v_mfma_f32_16x16x32_bf16 a[92:95], a[236:239], v[40:43], a[92:95]
    s_add_u32 m0, s22, 36864
    ds_read_b128 a[224:227], v0 offset:13312
    v_mfma_f32_16x16x32_bf16 a[44:47], a[236:239], v[32:35], a[44:47]
    buffer_load_dwordx4 v6, s[8:11], s21 offen lds
    v_mfma_f32_16x16x32_bf16 a[40:43], a[232:235], v[32:35], a[40:43]
    v_cvt_pk_bf16_f32 v39, v86, v87
    s_add_u32 s21, s21, 128
    v_mfma_f32_16x16x32_bf16 v[248:251], a[232:235], v[28:31], v[248:251]
    s_add_u32 m0, s22, 37888
    v_cvt_pk_bf16_f32 v27, v70, v71
    v_cvt_pk_bf16_f32 v34, v76, v77
    v_mfma_f32_16x16x32_bf16 v[252:255], a[236:239], v[28:31], v[252:255]
    v_exp_f32_e64 v65, v65 clamp
    v_mfma_f32_16x16x32_bf16 v[204:207], a[236:239], v[20:23], v[204:207]
    buffer_load_dwordx4 v6, s[8:11], s21 offen lds
    v_mfma_f32_16x16x32_bf16 v[200:203], a[232:235], v[20:23], v[200:203]
    v_cvt_pk_bf16_f32 v22, v60, v61
    s_add_u32 s21, s21, 128
    v_mfma_f32_16x16x32_bf16 v[152:155], a[232:235], v[16:19], v[152:155]
    s_add_u32 m0, s22, 38912
    ds_read_b128 a[228:231], v1 offset:13312
    v_mfma_f32_16x16x32_bf16 v[156:159], a[236:239], v[16:19], v[156:159]
    v_cvt_pk_bf16_f32 v35, v78, v79
    s_waitcnt lgkmcnt(2)
    v_mfma_f32_16x16x32_bf16 v[52:55], a[216:219], a[96:99], 0
    buffer_load_dwordx4 v6, s[8:11], s21 offen lds
    v_mfma_f32_16x16x32_bf16 v[52:55], a[220:223], a[100:103], v[52:55]
    s_waitcnt lgkmcnt(1)
    v_cvt_pk_bf16_f32 v23, v62, v63
    v_mfma_f32_16x16x32_bf16 v[52:55], a[224:227], a[104:107], v[52:55]
    v_exp_f32_e64 v56, v56 clamp
    v_mfma_f32_16x16x32_bf16 v[60:63], a[224:227], a[128:131], 0
    v_fma_f32 v91, v91, s28, v13
    v_mfma_f32_16x16x32_bf16 v[60:63], a[220:223], a[124:127], v[60:63]
    v_exp_f32_e64 v84, v84 clamp
    v_mfma_f32_16x16x32_bf16 v[60:63], a[216:219], a[120:123], v[60:63]
    ds_read_b128 a[232:235], v0 offset:14336
    v_cvt_pk_bf16_f32 v38, v84, v85
    v_mfma_f32_16x16x32_bf16 v[68:71], a[216:219], a[144:147], 0
    ds_read_b128 a[236:239], v1 offset:14336
    v_mfma_f32_16x16x32_bf16 v[68:71], a[220:223], a[148:151], v[68:71]
    v_exp_f32_e64 v88, v88 clamp
    v_mfma_f32_16x16x32_bf16 v[68:71], a[224:227], a[152:155], v[68:71]
    v_exp_f32_e64 v74, v74 clamp
    v_mfma_f32_16x16x32_bf16 v[76:79], a[224:227], a[176:179], 0
    v_exp_f32_e64 v59, v59 clamp
    v_mfma_f32_16x16x32_bf16 v[76:79], a[220:223], a[172:175], v[76:79]
    v_exp_f32_e64 v66, v66 clamp
    v_mfma_f32_16x16x32_bf16 v[76:79], a[216:219], a[168:171], v[76:79]
    v_mfma_f32_16x16x32_bf16 v[84:87], a[216:219], a[192:195], 0
    v_mfma_f32_16x16x32_bf16 v[84:87], a[220:223], a[196:199], v[84:87]
    v_exp_f32_e64 v89, v89 clamp
    v_mfma_f32_16x16x32_bf16 v[84:87], a[224:227], a[200:203], v[84:87]
    s_waitcnt lgkmcnt(2)
    v_mfma_f32_16x16x32_bf16 v[84:87], a[228:231], a[204:207], v[84:87]
    s_waitcnt lgkmcnt(1)
    ds_read_b128 a[216:219], v0 offset:18432
    v_cvt_pk_bf16_f32 v29, v74, v75
    v_mfma_f32_16x16x32_bf16 v[84:87], a[232:235], a[208:211], v[84:87]
    s_waitcnt lgkmcnt(1)
    v_exp_f32_e64 v90, v90 clamp
    v_mfma_f32_16x16x32_bf16 v[84:87], a[236:239], a[212:215], v[84:87]
    s_add_u32 s21, s21, 12032
    v_exp_f32_e64 v91, v91 clamp
    v_mfma_f32_16x16x32_bf16 v[76:79], a[236:239], a[188:191], v[76:79]
    ds_read_b128 a[220:223], v1 offset:18432
    v_fma_f32 v58, v58, s28, v9
    v_mfma_f32_16x16x32_bf16 v[76:79], a[232:235], a[184:187], v[76:79]
    v_cvt_pk_bf16_f32 v16, v56, v57
    v_cvt_pk_bf16_f32 v41, v90, v91
    v_mfma_f32_16x16x32_bf16 v[76:79], a[228:231], a[180:183], v[76:79]
    v_mfma_f32_16x16x32_bf16 v[68:71], a[228:231], a[156:159], v[68:71]
    v_exp_f32_e64 v58, v58 clamp
    v_mfma_f32_16x16x32_bf16 v[68:71], a[232:235], a[160:163], v[68:71]
    ds_read_b128 a[224:227], v0 offset:19456
    v_mfma_f32_16x16x32_bf16 v[68:71], a[236:239], a[164:167], v[68:71]
    v_cvt_pk_bf16_f32 v17, v58, v59
    v_cvt_pk_bf16_f32 v25, v66, v67
    v_mfma_f32_16x16x32_bf16 v[60:63], a[236:239], a[140:143], v[60:63]
    v_cvt_pk_bf16_f32 v40, v88, v89
    v_cvt_pk_bf16_f32 v24, v64, v65
    v_mfma_f32_16x16x32_bf16 v[60:63], a[232:235], a[136:139], v[60:63]
    v_mfma_f32_16x16x32_bf16 v[60:63], a[228:231], a[132:135], v[60:63]
    v_mfma_f32_16x16x32_bf16 v[52:55], a[228:231], a[108:111], v[52:55]
    v_exp_f32_e64 v83, v83 clamp
    v_mfma_f32_16x16x32_bf16 v[52:55], a[232:235], a[112:115], v[52:55]
    ds_read_b128 a[228:231], v1 offset:19456
    v_cvt_pk_bf16_f32 v36, v80, v81
    v_mfma_f32_16x16x32_bf16 v[52:55], a[236:239], a[116:119], v[52:55]
    s_waitcnt lgkmcnt(2)
    v_mfma_f32_16x16x32_bf16 v[56:59], a[216:219], a[96:99], 0
    ds_read_b128 a[236:239], v1 offset:20480
    v_mfma_f32_16x16x32_bf16 v[56:59], a[220:223], a[100:103], v[56:59]
    ds_read_b128 a[232:235], v0 offset:20480
    v_cvt_pk_bf16_f32 v28, v72, v73
    v_mfma_f32_16x16x32_bf16 v[44:47], a[248:251], v[14:17], v[44:47]
    v_cvt_pk_bf16_f32 v37, v82, v83
    v_smfmac_f32_16x16x64_bf16 v[44:47], a[240:243], v[22:29], v101
    s_nop 0
    v_smfmac_f32_16x16x64_bf16 v[44:47], a[244:247], v[34:41], v101
    s_waitcnt lgkmcnt(3)
    v_mfma_f32_16x16x32_bf16 v[56:59], a[224:227], a[104:107], v[56:59]
    v_mfma_f32_16x16x32_bf16 v[64:67], a[224:227], a[128:131], 0
    v_mfma_f32_16x16x32_bf16 v[64:67], a[220:223], a[124:127], v[64:67]
    v_mfma_f32_16x16x32_bf16 v[64:67], a[216:219], a[120:123], v[64:67]
    v_mfma_f32_16x16x32_bf16 v[72:75], a[216:219], a[144:147], 0
    v_mfma_f32_16x16x32_bf16 v[72:75], a[220:223], a[148:151], v[72:75]
    v_mfma_f32_16x16x32_bf16 v[72:75], a[224:227], a[152:155], v[72:75]
    v_cmp_lt_f32 vcc, s29, v44
    s_waitcnt vmcnt(6) lgkmcnt(0)
    v_mfma_f32_16x16x32_bf16 v[80:83], a[224:227], a[176:179], 0
    s_barrier
    v_mfma_f32_16x16x32_bf16 v[80:83], a[220:223], a[172:175], v[80:83]
    v_mfma_f32_16x16x32_bf16 v[80:83], a[216:219], a[168:171], v[80:83]
    s_cbranch_vccnz L_rs_end5a
L_ret_end5a:
    v_mfma_f32_16x16x32_bf16 v[88:91], a[216:219], a[192:195], 0
    ds_read_b64_tr_b16 a[216:217], v2 offset:0
    v_fma_f32 v55, v55, s28, v9
    v_mfma_f32_16x16x32_bf16 v[88:91], a[220:223], a[196:199], v[88:91]
    ds_read_b64_tr_b16 a[218:219], v2 offset:6144
    v_mfma_f32_16x16x32_bf16 v[88:91], a[224:227], a[200:203], v[88:91]
    v_fma_f32 v62, v62, s28, v10
    v_fma_f32 v53, v53, s28, v9
    v_mfma_f32_16x16x32_bf16 v[88:91], a[228:231], a[204:207], v[88:91]
    v_fma_f32 v61, v61, s28, v10
    v_fma_f32 v54, v54, s28, v9
    v_mfma_f32_16x16x32_bf16 v[88:91], a[232:235], a[208:211], v[88:91]
    ds_read_b64_tr_b16 a[220:221], v3 offset:0
    v_fma_f32 v52, v52, s28, v9
    v_mfma_f32_16x16x32_bf16 v[88:91], a[236:239], a[212:215], v[88:91]
    ds_read_b64_tr_b16 a[222:223], v3 offset:6144
    v_mfma_f32_16x16x32_bf16 v[80:83], a[236:239], a[188:191], v[80:83]
    v_exp_f32_e64 v62, v62 clamp
    v_mfma_f32_16x16x32_bf16 v[80:83], a[232:235], a[184:187], v[80:83]
    ds_read_b64_tr_b16 a[224:225], v4 offset:0
    v_fma_f32 v60, v60, s28, v10
    v_mfma_f32_16x16x32_bf16 v[80:83], a[228:231], a[180:183], v[80:83]
    v_exp_f32_e64 v54, v54 clamp
    v_mfma_f32_16x16x32_bf16 v[72:75], a[228:231], a[156:159], v[72:75]
    v_exp_f32_e64 v55, v55 clamp
    v_mfma_f32_16x16x32_bf16 v[72:75], a[232:235], a[160:163], v[72:75]
    v_exp_f32_e64 v52, v52 clamp
    v_mfma_f32_16x16x32_bf16 v[72:75], a[236:239], a[164:167], v[72:75]
    v_exp_f32_e64 v53, v53 clamp
    v_mfma_f32_16x16x32_bf16 v[64:67], a[236:239], a[140:143], v[64:67]
    ds_read_b64_tr_b16 a[226:227], v4 offset:6144
    v_fma_f32 v63, v63, s28, v10
    v_mfma_f32_16x16x32_bf16 v[64:67], a[232:235], a[136:139], v[64:67]
    v_exp_f32_e64 v60, v60 clamp
    v_mfma_f32_16x16x32_bf16 v[64:67], a[228:231], a[132:135], v[64:67]
    v_exp_f32_e64 v61, v61 clamp
    v_mfma_f32_16x16x32_bf16 v[56:59], a[228:231], a[108:111], v[56:59]
    v_exp_f32_e64 v63, v63 clamp
    v_mfma_f32_16x16x32_bf16 v[56:59], a[232:235], a[112:115], v[56:59]
    ds_read_b64_tr_b16 a[228:229], v5 offset:0
    v_cvt_pk_bf16_f32 v19, v54, v55
    v_mfma_f32_16x16x32_bf16 v[56:59], a[236:239], a[116:119], v[56:59]
    s_waitcnt lgkmcnt(2)
    ds_read_b64_tr_b16 a[230:231], v5 offset:6144
    v_cvt_pk_bf16_f32 v18, v52, v53
    v_mfma_f32_16x16x32_bf16 v[112:115], a[216:219], v[14:17], v[112:115]
    v_fma_f32 v74, v74, s28, v11
    v_fma_f32 v83, v83, s28, v12
    v_mfma_f32_16x16x32_bf16 v[116:119], a[220:223], v[14:17], v[116:119]
    ds_read_b64_tr_b16 a[234:235], v2 offset:7168
    v_fma_f32 v71, v71, s28, v11
    v_mfma_f32_16x16x32_bf16 v[164:167], a[220:223], v[22:25], v[164:167]
    s_add_u32 s39, s39, 12288
    ds_read_b64_tr_b16 a[238:239], v3 offset:7168
    v_fma_f32 v75, v75, s28, v11
    v_mfma_f32_16x16x32_bf16 v[160:163], a[216:219], v[22:25], v[160:163]
    v_fma_f32 v86, v86, s28, v13
    v_fma_f32 v76, v76, s28, v12
    v_mfma_f32_16x16x32_bf16 v[208:211], a[216:219], v[26:29], v[208:211]
    ds_read_b64_tr_b16 a[232:233], v2 offset:1024
    v_fma_f32 v65, v65, s28, v10
    v_mfma_f32_16x16x32_bf16 v[212:215], a[220:223], v[26:29], v[212:215]
    v_exp_f32_e64 v71, v71 clamp
    v_mfma_f32_16x16x32_bf16 a[4:7], a[220:223], v[34:37], a[4:7]
    v_fma_f32 v91, v91, s28, v13
    v_fma_f32 v58, v58, s28, v9
    v_mfma_f32_16x16x32_bf16 a[0:3], a[216:219], v[34:37], a[0:3]
    ds_read_b64_tr_b16 a[236:237], v3 offset:1024
    v_fma_f32 v59, v59, s28, v9
    v_mfma_f32_16x16x32_bf16 a[48:51], a[216:219], v[38:41], a[48:51]
    v_fma_f32 v72, v72, s28, v11
    v_fma_f32 v85, v85, s28, v13
    v_mfma_f32_16x16x32_bf16 a[52:55], a[220:223], v[38:41], a[52:55]
    s_waitcnt lgkmcnt(4)
    v_fma_f32 v90, v90, s28, v13
    v_fma_f32 v73, v73, s28, v11
    v_mfma_f32_16x16x32_bf16 a[56:59], a[224:227], v[38:41], a[56:59]
    v_exp_f32_e64 v72, v72 clamp
    v_mfma_f32_16x16x32_bf16 a[60:63], a[228:231], v[38:41], a[60:63]
    s_waitcnt vmcnt(0)
    v_exp_f32_e64 v76, v76 clamp
    v_mfma_f32_16x16x32_bf16 a[12:15], a[228:231], v[34:37], a[12:15]
    ds_read_b64_tr_b16 a[216:217], v4 offset:1024
    v_fma_f32 v68, v68, s28, v11
    v_mfma_f32_16x16x32_bf16 a[8:11], a[224:227], v[34:37], a[8:11]
    ds_read_b64_tr_b16 a[222:223], v5 offset:7168
    v_fma_f32 v67, v67, s28, v10
    v_mfma_f32_16x16x32_bf16 v[216:219], a[224:227], v[26:29], v[216:219]
    s_barrier
    v_mfma_f32_16x16x32_bf16 v[220:223], a[228:231], v[26:29], v[220:223]
    v_exp_f32_e64 v90, v90 clamp
    v_mfma_f32_16x16x32_bf16 v[172:175], a[228:231], v[22:25], v[172:175]
    ds_read_b64_tr_b16 a[218:219], v4 offset:7168
    v_fma_f32 v84, v84, s28, v13
    v_mfma_f32_16x16x32_bf16 v[168:171], a[224:227], v[22:25], v[168:171]
    ds_read_b64_tr_b16 a[220:221], v5 offset:1024
    v_fma_f32 v88, v88, s28, v13
    v_mfma_f32_16x16x32_bf16 v[120:123], a[224:227], v[14:17], v[120:123]
    v_exp_f32_e64 v68, v68 clamp
    v_mfma_f32_16x16x32_bf16 v[124:127], a[228:231], v[14:17], v[124:127]
    s_waitcnt lgkmcnt(4)
    v_exp_f32_e64 v83, v83 clamp
    v_mfma_f32_16x16x32_bf16 v[128:131], a[232:235], v[14:17], v[128:131]
    v_exp_f32_e64 v85, v85 clamp
    v_fma_f32 v70, v70, s28, v11
    v_mfma_f32_16x16x32_bf16 v[132:135], a[236:239], v[14:17], v[132:135]
    v_fma_f32 v80, v80, s28, v12
    v_fma_f32 v77, v77, s28, v12
    v_mfma_f32_16x16x32_bf16 v[180:183], a[236:239], v[22:25], v[180:183]
    v_exp_f32_e64 v91, v91 clamp
    v_mfma_f32_16x16x32_bf16 v[176:179], a[232:235], v[22:25], v[176:179]
    v_fma_f32 v81, v81, s28, v12
    v_fma_f32 v79, v79, s28, v12
    v_mfma_f32_16x16x32_bf16 v[224:227], a[232:235], v[26:29], v[224:227]
    ds_read_b64_tr_b16 a[230:231], v3 offset:8192
    v_fma_f32 v64, v64, s28, v10
    v_fma_f32 v66, v66, s28, v10
    v_mfma_f32_16x16x32_bf16 v[228:231], a[236:239], v[26:29], v[228:231]
    ds_read_b64_tr_b16 a[226:227], v2 offset:8192
    v_fma_f32 v87, v87, s28, v13
    v_mfma_f32_16x16x32_bf16 a[20:23], a[236:239], v[34:37], a[20:23]
    ds_read_b64_tr_b16 a[224:225], v2 offset:2048
    v_exp_f32_e64 v80, v80 clamp
    v_mfma_f32_16x16x32_bf16 a[16:19], a[232:235], v[34:37], a[16:19]
    v_exp_f32_e64 v87, v87 clamp
    v_mfma_f32_16x16x32_bf16 a[64:67], a[232:235], v[38:41], a[64:67]
    ds_read_b64_tr_b16 a[232:233], v4 offset:2048
    v_fma_f32 v89, v89, s28, v13
    v_mfma_f32_16x16x32_bf16 a[68:71], a[236:239], v[38:41], a[68:71]
    s_waitcnt lgkmcnt(4)
    v_exp_f32_e64 v65, v65 clamp
    v_mfma_f32_16x16x32_bf16 a[72:75], a[216:219], v[38:41], a[72:75]
    v_exp_f32_e64 v70, v70 clamp
    v_mfma_f32_16x16x32_bf16 a[76:79], a[220:223], v[38:41], a[76:79]
    ds_read_b64_tr_b16 a[228:229], v3 offset:2048
    v_exp_f32_e64 v67, v67 clamp
    v_mfma_f32_16x16x32_bf16 a[28:31], a[220:223], v[34:37], a[28:31]
    v_exp_f32_e64 v84, v84 clamp
    v_fma_f32 v57, v57, s28, v9
    v_mfma_f32_16x16x32_bf16 a[24:27], a[216:219], v[34:37], a[24:27]
    ds_read_b64_tr_b16 a[236:237], v5 offset:2048
    v_fma_f32 v69, v69, s28, v11
    v_mfma_f32_16x16x32_bf16 v[232:235], a[216:219], v[26:29], v[232:235]
    v_exp_f32_e64 v69, v69 clamp
    v_mfma_f32_16x16x32_bf16 v[236:239], a[220:223], v[26:29], v[236:239]
    v_exp_f32_e64 v74, v74 clamp
    v_mfma_f32_16x16x32_bf16 v[188:191], a[220:223], v[22:25], v[188:191]
    ds_read_b64_tr_b16 a[238:239], v5 offset:8192
    v_exp_f32_e64 v86, v86 clamp
    v_mfma_f32_16x16x32_bf16 v[184:187], a[216:219], v[22:25], v[184:187]
    v_exp_f32_e64 v89, v89 clamp
    v_mfma_f32_16x16x32_bf16 v[136:139], a[216:219], v[14:17], v[136:139]
    v_exp_f32_e64 v77, v77 clamp
    v_mfma_f32_16x16x32_bf16 v[140:143], a[220:223], v[14:17], v[140:143]
    s_waitcnt lgkmcnt(3)
    ds_read_b64_tr_b16 a[234:235], v4 offset:8192
    v_exp_f32_e64 v58, v58 clamp
    v_mfma_f32_16x16x32_bf16 v[144:147], a[224:227], v[14:17], v[144:147]
    s_waitcnt lgkmcnt(3)
    v_exp_f32_e64 v66, v66 clamp
    v_fma_f32 v82, v82, s28, v12
    v_mfma_f32_16x16x32_bf16 v[148:151], a[228:231], v[14:17], v[148:151]
    v_exp_f32_e64 v81, v81 clamp
    v_mfma_f32_16x16x32_bf16 v[196:199], a[228:231], v[22:25], v[196:199]
    v_fma_f32 v56, v56, s28, v9
    v_exp_f32_e64 v64, v64 clamp
    v_mfma_f32_16x16x32_bf16 v[192:195], a[224:227], v[22:25], v[192:195]
    v_exp_f32_e64 v73, v73 clamp
    v_mfma_f32_16x16x32_bf16 v[240:243], a[224:227], v[26:29], v[240:243]
    ds_read_b64_tr_b16 a[216:217], v2 offset:18432
    v_exp_f32_e64 v82, v82 clamp
    v_mfma_f32_16x16x32_bf16 v[244:247], a[228:231], v[26:29], v[244:247]
    v_exp_f32_e64 v75, v75 clamp
    v_mfma_f32_16x16x32_bf16 a[36:39], a[228:231], v[34:37], a[36:39]
    ds_read_b64_tr_b16 a[218:219], v2 offset:12288
    v_cvt_pk_bf16_f32 v33, v82, v83
    v_mfma_f32_16x16x32_bf16 a[32:35], a[224:227], v[34:37], a[32:35]
    v_cvt_pk_bf16_f32 v43, v86, v87
    v_cvt_pk_bf16_f32 v21, v66, v67
    v_mfma_f32_16x16x32_bf16 a[80:83], a[224:227], v[38:41], a[80:83]
    v_cvt_pk_bf16_f32 v31, v70, v71
    v_exp_f32_e64 v79, v79 clamp
    v_mfma_f32_16x16x32_bf16 a[84:87], a[228:231], v[38:41], a[84:87]
    s_waitcnt lgkmcnt(2)
    ds_read_b64_tr_b16 a[220:221], v3 offset:18432
    v_exp_f32_e64 v59, v59 clamp
    v_mfma_f32_16x16x32_bf16 a[88:91], a[232:235], v[38:41], a[88:91]
    v_cvt_pk_bf16_f32 v20, v64, v65
    v_cvt_pk_bf16_f32 v42, v84, v85
    v_mfma_f32_16x16x32_bf16 a[92:95], a[236:239], v[38:41], a[92:95]
    v_exp_f32_e64 v56, v56 clamp
    v_mfma_f32_16x16x32_bf16 a[44:47], a[236:239], v[34:37], a[44:47]
    v_fma_f32 v78, v78, s28, v12
    v_exp_f32_e64 v88, v88 clamp
    v_mfma_f32_16x16x32_bf16 a[40:43], a[232:235], v[34:37], a[40:43]
    ds_read_b64_tr_b16 a[222:223], v3 offset:12288
    v_cvt_pk_bf16_f32 v32, v80, v81
    v_mfma_f32_16x16x32_bf16 v[248:251], a[232:235], v[26:29], v[248:251]
    v_exp_f32_e64 v57, v57 clamp
    v_mfma_f32_16x16x32_bf16 v[252:255], a[236:239], v[26:29], v[252:255]
    ds_read_b64_tr_b16 a[224:225], v4 offset:18432
    v_cvt_pk_bf16_f32 v28, v72, v73
    v_mfma_f32_16x16x32_bf16 v[204:207], a[236:239], v[22:25], v[204:207]
    v_exp_f32_e64 v78, v78 clamp
    v_mfma_f32_16x16x32_bf16 v[200:203], a[232:235], v[22:25], v[200:203]
    v_cvt_pk_bf16_f32 v34, v76, v77
    v_cvt_pk_bf16_f32 v29, v74, v75
    v_mfma_f32_16x16x32_bf16 v[152:155], a[232:235], v[14:17], v[152:155]
    v_cvt_pk_bf16_f32 v23, v62, v63
    v_cvt_pk_bf16_f32 v22, v60, v61
    v_cvt_pk_bf16_f32 v30, v68, v69
    v_mfma_f32_16x16x32_bf16 v[156:159], a[236:239], v[14:17], v[156:159]
    v_cvt_pk_bf16_f32 v16, v56, v57
    v_cvt_pk_bf16_f32 v17, v58, v59
    v_cvt_pk_bf16_f32 v35, v78, v79
    v_cvt_pk_bf16_f32 v41, v90, v91
    v_smfmac_f32_16x16x64_bf16 v[48:51], a[240:243], v[16:23], v101
    ds_read_b64_tr_b16 a[226:227], v4 offset:12288
    v_cvt_pk_bf16_f32 v40, v88, v89
    v_smfmac_f32_16x16x64_bf16 v[48:51], a[244:247], v[28:35], v101
    ds_read_b64_tr_b16 a[228:229], v5 offset:18432
    v_mfma_f32_16x16x32_bf16 v[48:51], a[248:251], v[40:43], v[48:51]
    s_waitcnt lgkmcnt(3)
    ds_read_b64_tr_b16 a[230:231], v5 offset:12288
    s_nop 5
    v_cmp_lt_f32 vcc, s29, v48
    s_nop 4
    s_cbranch_vccnz L_rs_end5b
L_ret_end5b:
    v_lshrrev_b32 v108, 11, v0
    v_and_b32 v93, 0x3ff, v0
    v_xor_b32 v108, s65, v108
    v_lshl_add_u32 v93, v108, 10, v93
    v_add_u32 v93, s38, v93
    v_mbcnt_lo_u32_b32 v108, -1, 0
    v_mbcnt_hi_u32_b32 v108, -1, v108
    v_lshrrev_b32 v108, 1, v108
    v_and_b32 v108, 24, v108
    v_bfe_u32 v108, s66, v108, 8
    v_xor_b32 v93, v93, v108
    v_xor_b32 v102, 96, v93
    v_xor_b32 v95, 32, v93
    v_xor_b32 v8, 64, v93
    v_mov_b32 v111, v46
    v_mov_b32 v108, v49
    v_mov_b32 v109, v50
    s_nop 1
    v_permlane16_swap_b32 v50, v109
    v_mov_b32 v110, v45
    s_add_u32 s84, s34, 0
    v_mfma_f32_16x16x32_bf16 v[112:115], a[216:219], v[16:19], v[112:115]
    v_permlane16_swap_b32 v49, v108
    v_permlane16_swap_b32 v45, v110
    v_mfma_f32_16x16x32_bf16 v[160:163], a[216:219], v[20:23], v[160:163]
    s_add_u32 s85, s34, 6144
    v_add_f32 v45, v45, v110
    s_waitcnt lgkmcnt(4)
    v_mfma_f32_16x16x32_bf16 v[116:119], a[220:223], v[16:19], v[116:119]
    ds_read_b64_tr_b16 a[238:239], v3 offset:13312
    v_add_f32 v49, v49, v108
    v_mov_b32 v108, v49
    v_add_f32 v50, v50, v109
    v_mfma_f32_16x16x32_bf16 v[164:167], a[220:223], v[20:23], v[164:167]
    v_permlane16_swap_b32 v46, v111
    v_add_f32 v46, v46, v111
    v_permlane32_swap_b32 v49, v108
    s_waitcnt lgkmcnt(3)
    v_mfma_f32_16x16x32_bf16 v[120:123], a[224:227], v[16:19], v[120:123]
    ds_read_b64_tr_b16 a[234:235], v2 offset:13312
    v_mov_b32 v109, v50
    v_mfma_f32_16x16x32_bf16 v[168:171], a[224:227], v[20:23], v[168:171]
    s_waitcnt lgkmcnt(2)
    ds_read_b64_tr_b16 a[232:233], v2 offset:19456
    s_add_u32 s86, s34, 12288
    v_mfma_f32_16x16x32_bf16 v[124:127], a[228:231], v[16:19], v[124:127]
    v_mov_b32 v111, v46
    v_mov_b32 v110, v45
    v_mfma_f32_16x16x32_bf16 v[172:175], a[228:231], v[20:23], v[172:175]
    v_subrev_u32 v103, 28672, v103
    v_add_f32 v48, v49, v47
    v_mfma_f32_16x16x32_bf16 v[208:211], a[216:219], v[28:31], v[208:211]
    v_permlane32_swap_b32 v45, v110
    v_mfma_f32_16x16x32_bf16 a[0:3], a[216:219], v[32:35], a[0:3]
    v_permlane32_swap_b32 v50, v109
    v_mfma_f32_16x16x32_bf16 v[212:215], a[220:223], v[28:31], v[212:215]
    s_add_u32 s87, s34, 18432
    ds_read_b64_tr_b16 a[236:237], v3 offset:19456
    v_mfma_f32_16x16x32_bf16 a[4:7], a[220:223], v[32:35], a[4:7]
    v_add_f32 v50, v50, v110
    v_add_f32 v92, v108, v45
    v_mfma_f32_16x16x32_bf16 v[216:219], a[224:227], v[28:31], v[216:219]
    v_mfma_f32_16x16x32_bf16 a[8:11], a[224:227], v[32:35], a[8:11]
    v_permlane32_swap_b32 v46, v111
    v_mfma_f32_16x16x32_bf16 v[220:223], a[228:231], v[28:31], v[220:223]
    v_rcp_f32 v92, v92
    v_mfma_f32_16x16x32_bf16 a[12:15], a[228:231], v[32:35], a[12:15]
    v_rcp_f32 v50, v50
    v_rcp_f32 v48, v48
    s_nop 0
    v_pk_mul_f32 v[116:117], v[116:117], v[48:49] op_sel_hi:[1,0]
    v_pk_mul_f32 v[126:127], v[126:127], v[48:49] op_sel_hi:[1,0]
    v_pk_mul_f32 v[120:121], v[120:121], v[48:49] op_sel_hi:[1,0]
    v_pk_mul_f32 v[118:119], v[118:119], v[48:49] op_sel_hi:[1,0]
    v_pk_mul_f32 v[122:123], v[122:123], v[48:49] op_sel_hi:[1,0]
    v_pk_mul_f32 v[160:161], v[160:161], v[92:93] op_sel_hi:[1,0]
    v_pk_mul_f32 v[166:167], v[166:167], v[92:93] op_sel_hi:[1,0]
    v_pk_mul_f32 v[114:115], v[114:115], v[48:49] op_sel_hi:[1,0]
    v_pk_mul_f32 v[164:165], v[164:165], v[92:93] op_sel_hi:[1,0]
    v_cvt_pk_bf16_f32 v160, v160, v161
    v_pk_mul_f32 v[170:171], v[170:171], v[92:93] op_sel_hi:[1,0]
    v_pk_mul_f32 v[174:175], v[174:175], v[92:93] op_sel_hi:[1,0]
    v_pk_mul_f32 v[112:113], v[112:113], v[48:49] op_sel_hi:[1,0]
    v_pk_mul_f32 v[124:125], v[124:125], v[48:49] op_sel_hi:[1,0]
    v_pk_mul_f32 v[172:173], v[172:173], v[92:93] op_sel_hi:[1,0]
    v_pk_mul_f32 v[168:169], v[168:169], v[92:93] op_sel_hi:[1,0]
    v_cvt_pk_bf16_f32 v172, v172, v173
    v_cvt_pk_bf16_f32 v124, v124, v125
    v_cvt_pk_bf16_f32 v116, v116, v117
    v_cvt_pk_bf16_f32 v117, v118, v119
    v_cvt_pk_bf16_f32 v112, v112, v113
    v_pk_mul_f32 v[162:163], v[162:163], v[92:93] op_sel_hi:[1,0]
    v_cvt_pk_bf16_f32 v168, v168, v169
    v_cvt_pk_bf16_f32 v120, v120, v121
    v_cvt_pk_bf16_f32 v164, v164, v165
    v_cvt_pk_bf16_f32 v169, v170, v171
    v_cvt_pk_bf16_f32 v165, v166, v167
    v_cvt_pk_bf16_f32 v161, v162, v163
    v_cvt_pk_bf16_f32 v173, v174, v175
    v_cvt_pk_bf16_f32 v121, v122, v123
    v_cvt_pk_bf16_f32 v125, v126, v127
    v_cvt_pk_bf16_f32 v113, v114, v115
    ds_write2st64_b64 v93, v[112:113], v[160:161] offset0:0 offset1:12
    ds_write2st64_b64 v95, v[116:117], v[164:165] offset0:0 offset1:12
    ds_write2st64_b64 v8, v[120:121], v[168:169] offset0:0 offset1:12
    ds_write2st64_b64 v102, v[124:125], v[172:173] offset0:0 offset1:12
    ds_read_b128 v[60:63], v103 offset:0
    v_accvgpr_read_b32 v107, a3
    v_accvgpr_read_b32 v104, a0
    v_accvgpr_read_b32 v108, a4
    v_add_f32 v94, v109, v46
    v_pk_mul_f32 v[212:213], v[212:213], v[50:51] op_sel_hi:[1,0]
    s_add_u32 s88, s34, 24576
    v_pk_mul_f32 v[210:211], v[210:211], v[50:51] op_sel_hi:[1,0]
    v_accvgpr_read_b32 v55, a11
    v_add_f32 v100, v51, v111
    v_accvgpr_read_b32 v105, a1
    v_accvgpr_read_b32 v109, a5
    v_rcp_f32 v94, v94
    v_accvgpr_read_b32 v110, a6
    v_accvgpr_read_b32 v52, a8
    s_add_u32 s18, s34, 30720
    v_pk_mul_f32 v[214:215], v[214:215], v[50:51] op_sel_hi:[1,0]
    v_accvgpr_read_b32 v53, a9
    v_accvgpr_read_b32 v57, a13
    v_pk_mul_f32 v[108:109], v[108:109], v[94:95] op_sel_hi:[1,0]
    v_pk_mul_f32 v[218:219], v[218:219], v[50:51] op_sel_hi:[1,0]
    v_accvgpr_read_b32 v56, a12
    v_accvgpr_read_b32 v111, a7
    v_pk_mul_f32 v[52:53], v[52:53], v[94:95] op_sel_hi:[1,0]
    v_pk_mul_f32 v[56:57], v[56:57], v[94:95] op_sel_hi:[1,0]
    v_pk_mul_f32 v[220:221], v[220:221], v[50:51] op_sel_hi:[1,0]
    v_cvt_pk_bf16_f32 v56, v56, v57
    v_pk_mul_f32 v[208:209], v[208:209], v[50:51] op_sel_hi:[1,0]
    ds_read_b128 v[64:67], v103 offset:1024
    v_pk_mul_f32 v[216:217], v[216:217], v[50:51] op_sel_hi:[1,0]
    v_rcp_f32 v100, v100
    s_waitcnt lgkmcnt(1)
    buffer_store_dwordx4 v[60:63], v6, s[16:19], s84 offen offset:0 nt
    v_accvgpr_read_b32 v106, a2
    v_cvt_pk_bf16_f32 v208, v208, v209
    v_cvt_pk_bf16_f32 v212, v212, v213
    v_mfma_f32_16x16x32_bf16 a[48:51], a[216:219], v[40:43], a[48:51]
    v_accvgpr_read_b32 v59, a15
    v_cvt_pk_bf16_f32 v209, v210, v211
    ds_read_b128 v[68:71], v103 offset:6144
    v_mfma_f32_16x16x32_bf16 a[52:55], a[220:223], v[40:43], a[52:55]
    v_accvgpr_read_b32 v54, a10
    v_accvgpr_read_b32 v58, a14
    ds_read_b64_tr_b16 a[220:221], v5 offset:19456
    v_cvt_pk_bf16_f32 v220, v220, v221
    v_pk_mul_f32 v[222:223], v[222:223], v[50:51] op_sel_hi:[1,0]
    v_pk_mul_f32 v[110:111], v[110:111], v[94:95] op_sel_hi:[1,0]
    ds_read_b64_tr_b16 a[218:219], v4 offset:13312
    v_cvt_pk_bf16_f32 v108, v108, v109
    v_mfma_f32_16x16x32_bf16 a[56:59], a[224:227], v[40:43], a[56:59]
    s_waitcnt lgkmcnt(3)
    ds_read_b128 v[72:75], v103 offset:7168
    buffer_store_dwordx4 v[64:67], v7, s[16:19], s84 offen offset:0 nt
    ds_read_b64_tr_b16 a[216:217], v4 offset:19456
    v_cvt_pk_bf16_f32 v216, v216, v217
    v_pk_mul_f32 v[54:55], v[54:55], v[94:95] op_sel_hi:[1,0]
    v_cvt_pk_bf16_f32 v52, v52, v53
    v_pk_mul_f32 v[106:107], v[106:107], v[94:95] op_sel_hi:[1,0]
    v_pk_mul_f32 v[104:105], v[104:105], v[94:95] op_sel_hi:[1,0]
    s_nop 1
    v_mfma_f32_16x16x32_bf16 a[60:63], a[228:231], v[40:43], a[60:63]
    v_cvt_pk_bf16_f32 v104, v104, v105
    v_cvt_pk_bf16_f32 v53, v54, v55
    v_cvt_pk_bf16_f32 v105, v106, v107
    v_cvt_pk_bf16_f32 v213, v214, v215
    v_pk_mul_f32 v[58:59], v[58:59], v[94:95] op_sel_hi:[1,0]
    ds_write2st64_b64 v93, v[208:209], v[104:105] offset0:24 offset1:36
    v_accvgpr_read_b32 v55, a59
    v_mfma_f32_16x16x32_bf16 v[128:131], a[232:235], v[16:19], v[128:131]
    s_waitcnt lgkmcnt(3)
    v_cvt_pk_bf16_f32 v57, v58, v59
    v_cvt_pk_bf16_f32 v109, v110, v111
    buffer_store_dwordx4 v[68:71], v6, s[16:19], s85 offen offset:0 nt
    ds_write2st64_b64 v95, v[212:213], v[108:109] offset0:24 offset1:36
    v_cvt_pk_bf16_f32 v217, v218, v219
    v_accvgpr_read_b32 v111, a55
    v_mfma_f32_16x16x32_bf16 v[176:179], a[232:235], v[20:23], v[176:179]
    v_cvt_pk_bf16_f32 v221, v222, v223
    ds_write2st64_b64 v8, v[216:217], v[52:53] offset0:24 offset1:36
    v_mfma_f32_16x16x32_bf16 v[132:135], a[236:239], v[16:19], v[132:135]
    ds_write2st64_b64 v102, v[220:221], v[56:57] offset0:24 offset1:36
    v_mfma_f32_16x16x32_bf16 v[180:183], a[236:239], v[20:23], v[180:183]
    s_waitcnt lgkmcnt(3)
    ds_read_b128 v[76:79], v103 offset:12288
    ds_read_b64_tr_b16 a[222:223], v5 offset:13312
    buffer_store_dwordx4 v[72:75], v7, s[16:19], s85 offen offset:0 nt
    v_pk_mul_f32 v[176:177], v[176:177], v[92:93] op_sel_hi:[1,0]
    v_pk_mul_f32 v[128:129], v[128:129], v[48:49] op_sel_hi:[1,0]
    v_accvgpr_read_b32 v52, a56
    s_nop 0
    v_pk_mul_f32 v[180:181], v[180:181], v[92:93] op_sel_hi:[1,0]
    v_accvgpr_read_b32 v109, a53
    v_pk_mul_f32 v[178:179], v[178:179], v[92:93] op_sel_hi:[1,0]
    v_accvgpr_read_b32 v58, a62
    v_pk_mul_f32 v[130:131], v[130:131], v[48:49] op_sel_hi:[1,0]
    v_pk_mul_f32 v[132:133], v[132:133], v[48:49] op_sel_hi:[1,0]
    v_accvgpr_read_b32 v104, a48
    v_cvt_pk_bf16_f32 v128, v128, v129
    v_cvt_pk_bf16_f32 v176, v176, v177
    v_mfma_f32_16x16x32_bf16 v[136:139], a[216:219], v[16:19], v[136:139]
    v_accvgpr_read_b32 v110, a54
    v_accvgpr_read_b32 v107, a51
    ds_read_b128 v[80:83], v103 offset:13312
    v_mfma_f32_16x16x32_bf16 v[184:187], a[216:219], v[20:23], v[184:187]
    v_cvt_pk_bf16_f32 v177, v178, v179
    v_accvgpr_read_b32 v106, a50
    v_accvgpr_read_b32 v53, a57
    v_accvgpr_read_b32 v105, a49
    s_waitcnt lgkmcnt(2)
    buffer_store_dwordx4 v[76:79], v6, s[16:19], s86 offen offset:0 nt
    ds_read_b128 v[84:87], v103 offset:18432
    v_accvgpr_read_b32 v59, a63
    s_waitcnt lgkmcnt(2)
    v_mfma_f32_16x16x32_bf16 v[140:143], a[220:223], v[16:19], v[140:143]
    ds_read_b64_tr_b16 a[228:229], v3 offset:20480
    ds_read_b64_tr_b16 a[226:227], v2 offset:14336
    v_accvgpr_read_b32 v108, a52
    v_mfma_f32_16x16x32_bf16 v[188:191], a[220:223], v[20:23], v[188:191]
    v_accvgpr_read_b32 v57, a61
    v_accvgpr_read_b32 v54, a58
    v_pk_mul_f32 v[52:53], v[52:53], v[100:101] op_sel_hi:[1,0]
    v_pk_mul_f32 v[106:107], v[106:107], v[100:101] op_sel_hi:[1,0]
    v_pk_mul_f32 v[134:135], v[134:135], v[48:49] op_sel_hi:[1,0]
    v_pk_mul_f32 v[108:109], v[108:109], v[100:101] op_sel_hi:[1,0]
    v_pk_mul_f32 v[138:139], v[138:139], v[48:49] op_sel_hi:[1,0]
    v_pk_mul_f32 v[142:143], v[142:143], v[48:49] op_sel_hi:[1,0]
    v_cvt_pk_bf16_f32 v52, v52, v53
    v_pk_mul_f32 v[186:187], v[186:187], v[92:93] op_sel_hi:[1,0]
    v_cvt_pk_bf16_f32 v108, v108, v109
    v_accvgpr_read_b32 v56, a60
    v_pk_mul_f32 v[140:141], v[140:141], v[48:49] op_sel_hi:[1,0]
    v_pk_mul_f32 v[110:111], v[110:111], v[100:101] op_sel_hi:[1,0]
    v_pk_mul_f32 v[184:185], v[184:185], v[92:93] op_sel_hi:[1,0]
    s_waitcnt lgkmcnt(3)
    buffer_store_dwordx4 v[80:83], v7, s[16:19], s86 offen offset:0 nt
    v_pk_mul_f32 v[54:55], v[54:55], v[100:101] op_sel_hi:[1,0]
    v_cvt_pk_bf16_f32 v132, v132, v133
    v_pk_mul_f32 v[136:137], v[136:137], v[48:49] op_sel_hi:[1,0]
    v_pk_mul_f32 v[104:105], v[104:105], v[100:101] op_sel_hi:[1,0]
    v_cvt_pk_bf16_f32 v140, v140, v141
    v_pk_mul_f32 v[56:57], v[56:57], v[100:101] op_sel_hi:[1,0]
    v_cvt_pk_bf16_f32 v133, v134, v135
    v_cvt_pk_bf16_f32 v104, v104, v105
    ds_read_b128 v[88:91], v103 offset:19456
    v_pk_mul_f32 v[188:189], v[188:189], v[92:93] op_sel_hi:[1,0]
    v_cvt_pk_bf16_f32 v105, v106, v107
    v_cvt_pk_bf16_f32 v56, v56, v57
    v_cvt_pk_bf16_f32 v109, v110, v111
    v_mfma_f32_16x16x32_bf16 v[224:227], a[232:235], v[28:31], v[224:227]
    ds_write_b64 v93, v[104:105] offset:24576
    v_cvt_pk_bf16_f32 v129, v130, v131
    v_cvt_pk_bf16_f32 v180, v180, v181
    v_mfma_f32_16x16x32_bf16 a[16:19], a[232:235], v[32:35], a[16:19]
    s_waitcnt lgkmcnt(2)
    v_cvt_pk_bf16_f32 v136, v136, v137
    ds_write_b64 v95, v[108:109] offset:24576
    buffer_store_dwordx4 v[84:87], v6, s[16:19], s87 offen offset:0 nt
    v_cvt_pk_bf16_f32 v53, v54, v55
    v_pk_mul_f32 v[58:59], v[58:59], v[100:101] op_sel_hi:[1,0]
    v_cvt_pk_bf16_f32 v184, v184, v185
    v_cvt_pk_bf16_f32 v57, v58, v59
    v_pk_mul_f32 v[182:183], v[182:183], v[92:93] op_sel_hi:[1,0]
    v_cvt_pk_bf16_f32 v188, v188, v189
    v_accvgpr_read_b32 v104, a16
    v_mfma_f32_16x16x32_bf16 v[228:231], a[236:239], v[28:31], v[228:231]
    ds_write_b64 v8, v[52:53] offset:24576
    ds_write_b64 v102, v[56:57] offset:24576
    v_cvt_pk_bf16_f32 v137, v138, v139
    v_accvgpr_read_b32 v105, a17
    v_accvgpr_read_b32 v106, a18
    v_pk_mul_f32 v[190:191], v[190:191], v[92:93] op_sel_hi:[1,0]
    s_nop 1
    v_mfma_f32_16x16x32_bf16 a[20:23], a[236:239], v[32:35], a[20:23]
    s_waitcnt lgkmcnt(3)
    ds_read_b128 v[60:63], v103 offset:24576
    buffer_store_dwordx4 v[88:91], v7, s[16:19], s87 offen offset:0 nt
    v_cvt_pk_bf16_f32 v141, v142, v143
    v_mfma_f32_16x16x32_bf16 v[232:235], a[216:219], v[28:31], v[232:235]
    ds_read_b128 v[64:67], v103 offset:25600
    v_cvt_pk_bf16_f32 v181, v182, v183
    v_mfma_f32_16x16x32_bf16 a[24:27], a[216:219], v[32:35], a[24:27]
    ds_write2st64_b64 v93, v[128:129], v[176:177] offset0:4 offset1:16
    ds_read_b64_tr_b16 a[224:225], v2 offset:20480
    v_cvt_pk_bf16_f32 v189, v190, v191
    ds_write2st64_b64 v95, v[132:133], v[180:181] offset0:4 offset1:16
    v_cvt_pk_bf16_f32 v185, v186, v187
    v_accvgpr_read_b32 v110, a22
    s_waitcnt lgkmcnt(4)
    buffer_store_dwordx4 v[60:63], v6, s[16:19], s88 offen offset:0 nt
    v_accvgpr_read_b32 v108, a20
    ds_write2st64_b64 v8, v[136:137], v[184:185] offset0:4 offset1:16
    v_accvgpr_read_b32 v53, a25
    v_accvgpr_read_b32 v55, a27
    v_accvgpr_read_b32 v52, a24
    v_mfma_f32_16x16x32_bf16 v[236:239], a[220:223], v[28:31], v[236:239]
    v_accvgpr_read_b32 v54, a26
    ds_write2st64_b64 v102, v[140:141], v[188:189] offset0:4 offset1:16
    v_pk_mul_f32 v[52:53], v[52:53], v[94:95] op_sel_hi:[1,0]
    v_accvgpr_read_b32 v107, a19
    s_nop 0
    v_mfma_f32_16x16x32_bf16 a[28:31], a[220:223], v[32:35], a[28:31]
    s_waitcnt lgkmcnt(2)
    ds_read_b128 v[68:71], v103 offset:2048
    buffer_store_dwordx4 v[64:67], v7, s[16:19], s88 offen offset:0 nt
    v_pk_mul_f32 v[224:225], v[224:225], v[50:51] op_sel_hi:[1,0]
    v_cvt_pk_bf16_f32 v52, v52, v53
    v_pk_mul_f32 v[236:237], v[236:237], v[50:51] op_sel_hi:[1,0]
    s_nop 1
    v_mfma_f32_16x16x32_bf16 a[64:67], a[232:235], v[40:43], a[64:67]
    v_accvgpr_read_b32 v109, a21
    ds_read_b128 v[72:75], v103 offset:3072
    v_accvgpr_read_b32 v111, a23
    v_accvgpr_read_b32 v59, a31
    v_accvgpr_read_b32 v56, a28
    ds_read_b64_tr_b16 a[230:231], v3 offset:14336
    v_cvt_pk_bf16_f32 v224, v224, v225
    v_pk_mul_f32 v[108:109], v[108:109], v[94:95] op_sel_hi:[1,0]
    v_pk_mul_f32 v[226:227], v[226:227], v[50:51] op_sel_hi:[1,0]
    v_pk_mul_f32 v[110:111], v[110:111], v[94:95] op_sel_hi:[1,0]
    v_pk_mul_f32 v[230:231], v[230:231], v[50:51] op_sel_hi:[1,0]
    v_pk_mul_f32 v[232:233], v[232:233], v[50:51] op_sel_hi:[1,0]
    v_pk_mul_f32 v[104:105], v[104:105], v[94:95] op_sel_hi:[1,0]
    v_pk_mul_f32 v[228:229], v[228:229], v[50:51] op_sel_hi:[1,0]
    s_waitcnt lgkmcnt(2)
    buffer_store_dwordx4 v[68:71], v6, s[16:19], s84 offen offset:128 nt
    v_cvt_pk_bf16_f32 v108, v108, v109
    v_cvt_pk_bf16_f32 v104, v104, v105
    v_mfma_f32_16x16x32_bf16 a[68:71], a[236:239], v[40:43], a[68:71]
    ds_read_b128 v[76:79], v103 offset:8192
    v_cvt_pk_bf16_f32 v109, v110, v111
    v_cvt_pk_bf16_f32 v236, v236, v237
    v_cvt_pk_bf16_f32 v228, v228, v229
    v_cvt_pk_bf16_f32 v232, v232, v233
    v_pk_mul_f32 v[106:107], v[106:107], v[94:95] op_sel_hi:[1,0]
    v_pk_mul_f32 v[234:235], v[234:235], v[50:51] op_sel_hi:[1,0]
    v_accvgpr_read_b32 v58, a30
    v_cvt_pk_bf16_f32 v233, v234, v235
    v_pk_mul_f32 v[54:55], v[54:55], v[94:95] op_sel_hi:[1,0]
    ds_read_b128 v[80:83], v103 offset:9216
    v_accvgpr_read_b32 v57, a29
    v_mfma_f32_16x16x32_bf16 a[72:75], a[216:219], v[40:43], a[72:75]
    v_cvt_pk_bf16_f32 v225, v226, v227
    ds_read_b64_tr_b16 a[232:233], v4 offset:20480
    v_cvt_pk_bf16_f32 v53, v54, v55
    v_pk_mul_f32 v[58:59], v[58:59], v[94:95] op_sel_hi:[1,0]
    v_cvt_pk_bf16_f32 v229, v230, v231
    v_pk_mul_f32 v[56:57], v[56:57], v[94:95] op_sel_hi:[1,0]
    s_waitcnt lgkmcnt(3)
    buffer_store_dwordx4 v[72:75], v7, s[16:19], s84 offen offset:128 nt
    v_cvt_pk_bf16_f32 v105, v106, v107
    v_pk_mul_f32 v[238:239], v[238:239], v[50:51] op_sel_hi:[1,0]
    ds_write2st64_b64 v93, v[224:225], v[104:105] offset0:28 offset1:40
    v_cvt_pk_bf16_f32 v237, v238, v239
    v_mfma_f32_16x16x32_bf16 a[76:79], a[220:223], v[40:43], a[76:79]
    ds_write2st64_b64 v95, v[228:229], v[108:109] offset0:28 offset1:40
    v_mfma_f32_16x16x32_bf16 v[144:147], a[224:227], v[16:19], v[144:147]
    s_waitcnt lgkmcnt(4)
    ds_write2st64_b64 v8, v[232:233], v[52:53] offset0:28 offset1:40
    buffer_store_dwordx4 v[76:79], v6, s[16:19], s85 offen offset:128 nt
    v_accvgpr_read_b32 v105, a65
    v_accvgpr_read_b32 v54, a74
    v_cvt_pk_bf16_f32 v56, v56, v57
    v_accvgpr_read_b32 v104, a64
    v_accvgpr_read_b32 v106, a66
    ds_read_b64_tr_b16 a[234:235], v4 offset:14336
    v_pk_mul_f32 v[144:145], v[144:145], v[48:49] op_sel_hi:[1,0]
    v_cvt_pk_bf16_f32 v57, v58, v59
    v_accvgpr_read_b32 v107, a67
    v_mfma_f32_16x16x32_bf16 v[192:195], a[224:227], v[20:23], v[192:195]
    ds_write2st64_b64 v102, v[236:237], v[56:57] offset0:28 offset1:40
    v_accvgpr_read_b32 v52, a72
    v_accvgpr_read_b32 v110, a70
    v_accvgpr_read_b32 v59, a79
    v_cvt_pk_bf16_f32 v144, v144, v145
    v_mfma_f32_16x16x32_bf16 v[148:151], a[228:231], v[16:19], v[148:151]
    s_waitcnt lgkmcnt(2)
    ds_read_b128 v[84:87], v103 offset:14336
    buffer_store_dwordx4 v[80:83], v7, s[16:19], s85 offen offset:128 nt
    v_accvgpr_read_b32 v111, a71
    v_pk_mul_f32 v[104:105], v[104:105], v[100:101] op_sel_hi:[1,0]
    s_nop 1
    v_mfma_f32_16x16x32_bf16 v[196:199], a[228:231], v[20:23], v[196:199]
    ds_read_b64_tr_b16 a[236:237], v5 offset:20480
    ds_read_b64_tr_b16 a[238:239], v5 offset:14336
    v_pk_mul_f32 v[106:107], v[106:107], v[100:101] op_sel_hi:[1,0]
    s_waitcnt lgkmcnt(4)
    s_nop 0
    v_mfma_f32_16x16x32_bf16 v[152:155], a[232:235], v[16:19], v[152:155]
    v_pk_mul_f32 v[148:149], v[148:149], v[48:49] op_sel_hi:[1,0]
    ds_read_b128 v[88:91], v103 offset:15360
    v_accvgpr_read_b32 v109, a69
    v_cvt_pk_bf16_f32 v148, v148, v149
    v_accvgpr_read_b32 v58, a78
    v_accvgpr_read_b32 v55, a75
    s_waitcnt lgkmcnt(3)
    buffer_store_dwordx4 v[84:87], v6, s[16:19], s86 offen offset:128 nt
    v_mfma_f32_16x16x32_bf16 v[200:203], a[232:235], v[20:23], v[200:203]
    v_accvgpr_read_b32 v108, a68
    v_pk_mul_f32 v[110:111], v[110:111], v[100:101] op_sel_hi:[1,0]
    v_pk_mul_f32 v[196:197], v[196:197], v[92:93] op_sel_hi:[1,0]
    v_accvgpr_read_b32 v56, a76
    ds_read_b128 v[60:63], v103 offset:20480
    v_pk_mul_f32 v[150:151], v[150:151], v[48:49] op_sel_hi:[1,0]
    v_pk_mul_f32 v[194:195], v[194:195], v[92:93] op_sel_hi:[1,0]
    v_pk_mul_f32 v[152:153], v[152:153], v[48:49] op_sel_hi:[1,0]
    v_pk_mul_f32 v[200:201], v[200:201], v[92:93] op_sel_hi:[1,0]
    v_cvt_pk_bf16_f32 v104, v104, v105
    v_accvgpr_read_b32 v53, a73
    v_accvgpr_read_b32 v57, a77
    v_pk_mul_f32 v[52:53], v[52:53], v[100:101] op_sel_hi:[1,0]
    v_pk_mul_f32 v[58:59], v[58:59], v[100:101] op_sel_hi:[1,0]
    v_pk_mul_f32 v[108:109], v[108:109], v[100:101] op_sel_hi:[1,0]
    v_cvt_pk_bf16_f32 v149, v150, v151
    s_waitcnt lgkmcnt(1)
    v_mfma_f32_16x16x32_bf16 v[156:159], a[236:239], v[16:19], v[156:159]
    buffer_store_dwordx4 v[88:91], v7, s[16:19], s86 offen offset:128 nt
    v_pk_mul_f32 v[54:55], v[54:55], v[100:101] op_sel_hi:[1,0]
    v_pk_mul_f32 v[146:147], v[146:147], v[48:49] op_sel_hi:[1,0]
    v_cvt_pk_bf16_f32 v108, v108, v109
    v_cvt_pk_bf16_f32 v52, v52, v53
    v_pk_mul_f32 v[202:203], v[202:203], v[92:93] op_sel_hi:[1,0]
    v_cvt_pk_bf16_f32 v109, v110, v111
    v_pk_mul_f32 v[56:57], v[56:57], v[100:101] op_sel_hi:[1,0]
    v_pk_mul_f32 v[156:157], v[156:157], v[48:49] op_sel_hi:[1,0]
    v_cvt_pk_bf16_f32 v196, v196, v197
    v_pk_mul_f32 v[192:193], v[192:193], v[92:93] op_sel_hi:[1,0]
    v_cvt_pk_bf16_f32 v156, v156, v157
    v_cvt_pk_bf16_f32 v145, v146, v147
    v_cvt_pk_bf16_f32 v105, v106, v107
    v_cvt_pk_bf16_f32 v200, v200, v201
    v_pk_mul_f32 v[154:155], v[154:155], v[48:49] op_sel_hi:[1,0]
    v_pk_mul_f32 v[198:199], v[198:199], v[92:93] op_sel_hi:[1,0]
    v_cvt_pk_bf16_f32 v56, v56, v57
    ds_read_b128 v[64:67], v103 offset:21504
    v_mfma_f32_16x16x32_bf16 v[204:207], a[236:239], v[20:23], v[204:207]
    ds_write_b64 v93, v[104:105] offset:26624
    v_cvt_pk_bf16_f32 v53, v54, v55
    v_mfma_f32_16x16x32_bf16 v[240:243], a[224:227], v[28:31], v[240:243]
    s_waitcnt lgkmcnt(2)
    buffer_store_dwordx4 v[60:63], v6, s[16:19], s87 offen offset:128 nt
    ds_write_b64 v95, v[108:109] offset:26624
    v_cvt_pk_bf16_f32 v192, v192, v193
    v_mfma_f32_16x16x32_bf16 a[32:35], a[224:227], v[32:35], a[32:35]
    ds_write_b64 v8, v[52:53] offset:26624
    v_cvt_pk_bf16_f32 v57, v58, v59
    v_pk_mul_f32 v[158:159], v[158:159], v[48:49] op_sel_hi:[1,0]
    v_pk_mul_f32 v[204:205], v[204:205], v[92:93] op_sel_hi:[1,0]
    ds_write_b64 v102, v[56:57] offset:26624
    ds_read_b128 v[68:71], v103 offset:26624
    v_pk_mul_f32 v[206:207], v[206:207], v[92:93] op_sel_hi:[1,0]
    v_cvt_pk_bf16_f32 v157, v158, v159
    v_cvt_pk_bf16_f32 v204, v204, v205
    v_cvt_pk_bf16_f32 v197, v198, v199
    v_mfma_f32_16x16x32_bf16 v[244:247], a[228:231], v[28:31], v[244:247]
    s_waitcnt lgkmcnt(5)
    v_cvt_pk_bf16_f32 v193, v194, v195
    buffer_store_dwordx4 v[64:67], v7, s[16:19], s87 offen offset:128 nt
    ds_read_b128 v[72:75], v103 offset:27648
    v_accvgpr_read_b32 v105, a33
    v_cvt_pk_bf16_f32 v205, v206, v207
    v_cvt_pk_bf16_f32 v152, v152, v153
    v_cvt_pk_bf16_f32 v201, v202, v203
    v_mfma_f32_16x16x32_bf16 a[36:39], a[228:231], v[32:35], a[36:39]
    ds_write2st64_b64 v93, v[144:145], v[192:193] offset0:8 offset1:20
    v_pk_mul_f32 v[244:245], v[244:245], v[50:51] op_sel_hi:[1,0]
    v_cvt_pk_bf16_f32 v153, v154, v155
    v_accvgpr_read_b32 v104, a32
    v_pk_mul_f32 v[240:241], v[240:241], v[50:51] op_sel_hi:[1,0]
    v_pk_mul_f32 v[242:243], v[242:243], v[50:51] op_sel_hi:[1,0]
    s_nop 1
    v_mfma_f32_16x16x32_bf16 v[248:251], a[232:235], v[28:31], v[248:251]
    s_waitcnt lgkmcnt(2)
    buffer_store_dwordx4 v[68:71], v6, s[16:19], s88 offen offset:128 nt
    ds_write2st64_b64 v95, v[148:149], v[196:197] offset0:8 offset1:20
    v_mfma_f32_16x16x32_bf16 a[40:43], a[232:235], v[32:35], a[40:43]
    ds_write2st64_b64 v8, v[152:153], v[200:201] offset0:8 offset1:20
    v_mfma_f32_16x16x32_bf16 v[252:255], a[236:239], v[28:31], v[252:255]
    ds_write2st64_b64 v102, v[156:157], v[204:205] offset0:8 offset1:20
    ds_read_b128 v[76:79], v103 offset:4096
    s_nop 5
    v_pk_mul_f32 v[252:253], v[252:253], v[50:51] op_sel_hi:[1,0]
    v_pk_mul_f32 v[246:247], v[246:247], v[50:51] op_sel_hi:[1,0]
    s_waitcnt lgkmcnt(4)
    buffer_store_dwordx4 v[72:75], v7, s[16:19], s88 offen offset:128 nt
    v_mfma_f32_16x16x32_bf16 a[44:47], a[236:239], v[32:35], a[44:47]
    v_accvgpr_read_b32 v111, a39
    v_accvgpr_read_b32 v109, a37
    ds_read_b128 v[80:83], v103 offset:5120
    v_mfma_f32_16x16x32_bf16 a[80:83], a[224:227], v[40:43], a[80:83]
    v_pk_mul_f32 v[248:249], v[248:249], v[50:51] op_sel_hi:[1,0]
    v_pk_mul_f32 v[250:251], v[250:251], v[50:51] op_sel_hi:[1,0]
    v_cvt_pk_bf16_f32 v240, v240, v241
    v_accvgpr_read_b32 v53, a41
    v_accvgpr_read_b32 v108, a36
    v_accvgpr_read_b32 v110, a38
    v_pk_mul_f32 v[104:105], v[104:105], v[94:95] op_sel_hi:[1,0]
    v_cvt_pk_bf16_f32 v248, v248, v249
    v_cvt_pk_bf16_f32 v252, v252, v253
    v_accvgpr_read_b32 v106, a34
    v_pk_mul_f32 v[108:109], v[108:109], v[94:95] op_sel_hi:[1,0]
    s_waitcnt lgkmcnt(1)
    buffer_store_dwordx4 v[76:79], v6, s[16:19], s84 offen offset:256 nt
    v_accvgpr_read_b32 v56, a44
    v_accvgpr_read_b32 v107, a35
    v_accvgpr_read_b32 v59, a47
    v_cvt_pk_bf16_f32 v241, v242, v243
    v_pk_mul_f32 v[110:111], v[110:111], v[94:95] op_sel_hi:[1,0]
    v_accvgpr_read_b32 v54, a42
    v_pk_mul_f32 v[106:107], v[106:107], v[94:95] op_sel_hi:[1,0]
    v_accvgpr_read_b32 v57, a45
    v_accvgpr_read_b32 v52, a40
    v_cvt_pk_bf16_f32 v104, v104, v105
    ds_read_b128 v[84:87], v103 offset:10240
    v_pk_mul_f32 v[254:255], v[254:255], v[50:51] op_sel_hi:[1,0]
    v_accvgpr_read_b32 v55, a43
    v_cvt_pk_bf16_f32 v244, v244, v245
    v_pk_mul_f32 v[54:55], v[54:55], v[94:95] op_sel_hi:[1,0]
    v_cvt_pk_bf16_f32 v108, v108, v109
    v_cvt_pk_bf16_f32 v109, v110, v111
    v_pk_mul_f32 v[52:53], v[52:53], v[94:95] op_sel_hi:[1,0]
    v_cvt_pk_bf16_f32 v105, v106, v107
    v_cvt_pk_bf16_f32 v245, v246, v247
    v_mfma_f32_16x16x32_bf16 a[84:87], a[228:231], v[40:43], a[84:87]
    s_waitcnt lgkmcnt(1)
    v_accvgpr_read_b32 v58, a46
    v_cvt_pk_bf16_f32 v52, v52, v53
    ds_read_b128 v[88:91], v103 offset:11264
    buffer_store_dwordx4 v[80:83], v7, s[16:19], s84 offen offset:256 nt
    v_pk_mul_f32 v[56:57], v[56:57], v[94:95] op_sel_hi:[1,0]
    ds_write2st64_b64 v93, v[240:241], v[104:105] offset0:32 offset1:44
    s_nop 0
    v_mfma_f32_16x16x32_bf16 a[88:91], a[232:235], v[40:43], a[88:91]
    v_accvgpr_read_b32 v105, a81
    v_cvt_pk_bf16_f32 v56, v56, v57
    v_cvt_pk_bf16_f32 v53, v54, v55
    v_accvgpr_read_b32 v106, a82
    v_accvgpr_read_b32 v104, a80
    v_pk_mul_f32 v[58:59], v[58:59], v[94:95] op_sel_hi:[1,0]
    v_accvgpr_read_b32 v107, a83
    v_cvt_pk_bf16_f32 v249, v250, v251
    v_cvt_pk_bf16_f32 v253, v254, v255
    v_pk_mul_f32 v[106:107], v[106:107], v[100:101] op_sel_hi:[1,0]
    ds_write2st64_b64 v95, v[244:245], v[108:109] offset0:32 offset1:44
    v_accvgpr_read_b32 v109, a85
    s_waitcnt lgkmcnt(3)
    buffer_store_dwordx4 v[84:87], v6, s[16:19], s85 offen offset:256 nt
    ds_write2st64_b64 v8, v[248:249], v[52:53] offset0:32 offset1:44
    v_cvt_pk_bf16_f32 v57, v58, v59
    v_pk_mul_f32 v[104:105], v[104:105], v[100:101] op_sel_hi:[1,0]
    v_accvgpr_read_b32 v108, a84
    ds_write2st64_b64 v102, v[252:253], v[56:57] offset0:32 offset1:44
    ds_read_b128 v[60:63], v103 offset:16384
    v_accvgpr_read_b32 v111, a87
    ds_read_b128 v[64:67], v103 offset:17408
    ds_read_b128 v[68:71], v103 offset:22528
    v_accvgpr_read_b32 v110, a86
    v_mfma_f32_16x16x32_bf16 a[92:95], a[236:239], v[40:43], a[92:95]
    s_waitcnt lgkmcnt(6)
    ds_read_b128 v[72:75], v103 offset:23552
    buffer_store_dwordx4 v[88:91], v7, s[16:19], s85 offen offset:256 nt
    v_accvgpr_read_b32 v55, a91
    s_waitcnt lgkmcnt(3)
    buffer_store_dwordx4 v[60:63], v6, s[16:19], s86 offen offset:256 nt
    v_cvt_pk_bf16_f32 v104, v104, v105
    s_nop 0
    v_accvgpr_read_b32 v56, a92
    v_cvt_pk_bf16_f32 v105, v106, v107
    v_accvgpr_read_b32 v58, a94
    v_accvgpr_read_b32 v54, a90
    v_accvgpr_read_b32 v59, a95
    v_accvgpr_read_b32 v52, a88
    ds_write_b64 v93, v[104:105] offset:0
    v_pk_mul_f32 v[108:109], v[108:109], v[100:101] op_sel_hi:[1,0]
    v_accvgpr_read_b32 v57, a93
    v_cvt_pk_bf16_f32 v108, v108, v109
    v_accvgpr_read_b32 v53, a89
    s_waitcnt lgkmcnt(1)
    buffer_store_dwordx4 v[64:67], v7, s[16:19], s86 offen offset:256 nt
    v_pk_mul_f32 v[58:59], v[58:59], v[100:101] op_sel_hi:[1,0]
    v_pk_mul_f32 v[52:53], v[52:53], v[100:101] op_sel_hi:[1,0]
    v_pk_mul_f32 v[56:57], v[56:57], v[100:101] op_sel_hi:[1,0]
    s_nop 0
    v_cvt_pk_bf16_f32 v56, v56, v57
    v_cvt_pk_bf16_f32 v52, v52, v53
    v_pk_mul_f32 v[110:111], v[110:111], v[100:101] op_sel_hi:[1,0]
    v_pk_mul_f32 v[54:55], v[54:55], v[100:101] op_sel_hi:[1,0]
    buffer_store_dwordx4 v[68:71], v6, s[16:19], s87 offen offset:256 nt
    v_cvt_pk_bf16_f32 v109, v110, v111
    v_cvt_pk_bf16_f32 v53, v54, v55
    ds_write_b64 v95, v[108:109] offset:0
    ds_write_b64 v8, v[52:53] offset:0
    v_cvt_pk_bf16_f32 v57, v58, v59
    ds_write_b64 v102, v[56:57] offset:0
    ds_read_b128 v[76:79], v103 offset:0
    ds_read_b128 v[80:83], v103 offset:1024
    buffer_store_dwordx4 v[72:75], v7, s[16:19], s87 offen offset:256 nt
    s_waitcnt lgkmcnt(1)
    buffer_store_dwordx4 v[76:79], v6, s[16:19], s88 offen offset:256 nt
    s_waitcnt lgkmcnt(0)
    buffer_store_dwordx4 v[80:83], v7, s[16:19], s88 offen offset:256 nt
    s_branch L_fin
L_end4:
    v_mfma_f32_16x16x32_bf16 v[112:115], a[216:219], v[16:19], v[112:115]
    s_add_u32 s39, s39, 12288
    ds_read_b64_tr_b16 a[234:235], v2 offset:13312
    v_fma_f32 v64, v64, s28, v10
    v_mfma_f32_16x16x32_bf16 v[160:163], a[216:219], v[20:23], v[160:163]
    v_fma_f32 v68, v68, s28, v11
    v_fma_f32 v72, v72, s28, v11
    v_mfma_f32_16x16x32_bf16 v[208:211], a[216:219], v[28:31], v[208:211]
    v_fma_f32 v70, v70, s28, v11
    v_fma_f32 v62, v62, s28, v10
    v_mfma_f32_16x16x32_bf16 a[0:3], a[216:219], v[32:35], a[0:3]
    ds_read_b64_tr_b16 a[238:239], v3 offset:13312
    v_fma_f32 v82, v82, s28, v12
    s_waitcnt lgkmcnt(6)
    v_mfma_f32_16x16x32_bf16 a[4:7], a[220:223], v[32:35], a[4:7]
    ds_read_b64_tr_b16 a[232:233], v2 offset:19456
    v_fma_f32 v57, v57, s28, v9
    v_mfma_f32_16x16x32_bf16 v[212:215], a[220:223], v[28:31], v[212:215]
    v_exp_f32_e64 v72, v72 clamp
    v_mfma_f32_16x16x32_bf16 v[164:167], a[220:223], v[20:23], v[164:167]
    ds_read_b64_tr_b16 a[218:219], v4 offset:13312
    v_fma_f32 v56, v56, s28, v9
    v_mfma_f32_16x16x32_bf16 v[116:119], a[220:223], v[16:19], v[116:119]
    ds_read_b64_tr_b16 a[220:221], v5 offset:19456
    s_waitcnt lgkmcnt(7)
    v_mfma_f32_16x16x32_bf16 v[120:123], a[224:227], v[16:19], v[120:123]
    ds_read_b64_tr_b16 a[236:237], v3 offset:19456
    v_fma_f32 v73, v73, s28, v11
    v_mfma_f32_16x16x32_bf16 v[168:171], a[224:227], v[20:23], v[168:171]
    v_exp_f32_e64 v70, v70 clamp
    v_mfma_f32_16x16x32_bf16 v[216:219], a[224:227], v[28:31], v[216:219]
    v_fma_f32 v65, v65, s28, v10
    v_fma_f32 v78, v78, s28, v12
    v_mfma_f32_16x16x32_bf16 a[8:11], a[224:227], v[32:35], a[8:11]
    s_waitcnt lgkmcnt(5)
    ds_read_b64_tr_b16 a[224:225], v2 offset:20480
    v_fma_f32 v59, v59, s28, v9
    v_mfma_f32_16x16x32_bf16 a[12:15], a[228:231], v[32:35], a[12:15]
    ds_read_b64_tr_b16 a[222:223], v5 offset:13312
    v_mfma_f32_16x16x32_bf16 v[220:223], a[228:231], v[28:31], v[220:223]
    ds_read_b64_tr_b16 a[216:217], v4 offset:19456
    v_fma_f32 v66, v66, s28, v10
    v_mfma_f32_16x16x32_bf16 v[172:175], a[228:231], v[20:23], v[172:175]
    ds_read_b64_tr_b16 a[226:227], v2 offset:14336
    v_mfma_f32_16x16x32_bf16 v[124:127], a[228:231], v[16:19], v[124:127]
    s_waitcnt lgkmcnt(7)
    v_exp_f32_e64 v78, v78 clamp
    v_mfma_f32_16x16x32_bf16 v[128:131], a[232:235], v[16:19], v[128:131]
    v_exp_f32_e64 v68, v68 clamp
    v_mfma_f32_16x16x32_bf16 v[176:179], a[232:235], v[20:23], v[176:179]
    v_exp_f32_e64 v64, v64 clamp
    v_mfma_f32_16x16x32_bf16 v[224:227], a[232:235], v[28:31], v[224:227]
    ds_read_b64_tr_b16 a[230:231], v3 offset:14336
    v_fma_f32 v83, v83, s28, v12
    v_mfma_f32_16x16x32_bf16 a[16:19], a[232:235], v[32:35], a[16:19]
    s_waitcnt lgkmcnt(5)
    ds_read_b128 v[96:99], v103 offset:1024
    v_fma_f32 v80, v80, s28, v12
    v_mfma_f32_16x16x32_bf16 a[20:23], a[236:239], v[32:35], a[20:23]
    ds_read_b64_tr_b16 a[232:233], v4 offset:20480
    v_fma_f32 v77, v77, s28, v12
    v_mfma_f32_16x16x32_bf16 v[228:231], a[236:239], v[28:31], v[228:231]
    ds_read_b64_tr_b16 a[234:235], v4 offset:14336
    v_fma_f32 v69, v69, s28, v11
    v_mfma_f32_16x16x32_bf16 v[180:183], a[236:239], v[20:23], v[180:183]
    ds_read_b64_tr_b16 a[228:229], v3 offset:20480
    v_fma_f32 v74, v74, s28, v11
    v_mfma_f32_16x16x32_bf16 v[132:135], a[236:239], v[16:19], v[132:135]
    s_waitcnt lgkmcnt(6)
    ds_read_b64_tr_b16 a[238:239], v5 offset:14336
    v_fma_f32 v63, v63, s28, v10
    v_mfma_f32_16x16x32_bf16 v[136:139], a[216:219], v[16:19], v[136:139]
    ds_read_b64_tr_b16 a[236:237], v5 offset:20480
    v_fma_f32 v76, v76, s28, v12
    v_mfma_f32_16x16x32_bf16 v[184:187], a[216:219], v[20:23], v[184:187]
    v_exp_f32_e64 v73, v73 clamp
    v_mfma_f32_16x16x32_bf16 v[232:235], a[216:219], v[28:31], v[232:235]
    v_exp_f32_e64 v69, v69 clamp
    v_mfma_f32_16x16x32_bf16 a[24:27], a[216:219], v[32:35], a[24:27]
    v_exp_f32_e64 v57, v57 clamp
    v_mfma_f32_16x16x32_bf16 a[28:31], a[220:223], v[32:35], a[28:31]
    v_exp_f32_e64 v66, v66 clamp
    v_mfma_f32_16x16x32_bf16 v[236:239], a[220:223], v[28:31], v[236:239]
    ds_read_b128 v[88:91], v103 offset:0
    v_mfma_f32_16x16x32_bf16 v[188:191], a[220:223], v[20:23], v[188:191]
    v_exp_f32_e64 v62, v62 clamp
    v_mfma_f32_16x16x32_bf16 v[140:143], a[220:223], v[16:19], v[140:143]
    s_waitcnt lgkmcnt(4)
    v_exp_f32_e64 v77, v77 clamp
    v_mfma_f32_16x16x32_bf16 v[144:147], a[224:227], v[16:19], v[144:147]
    ds_read_b128 v[84:87], v103 offset:2048
    v_fma_f32 v67, v67, s28, v10
    v_mfma_f32_16x16x32_bf16 v[192:195], a[224:227], v[20:23], v[192:195]
    v_exp_f32_e64 v74, v74 clamp
    v_mfma_f32_16x16x32_bf16 v[240:243], a[224:227], v[28:31], v[240:243]
    s_waitcnt vmcnt(10) lgkmcnt(2)
    v_cvt_pk_bf16_f32 v26, v68, v69
    v_fma_f32 v58, v58, s28, v9
    v_mfma_f32_16x16x32_bf16 a[32:35], a[224:227], v[32:35], a[32:35]
    s_barrier
    v_mfma_f32_16x16x32_bf16 a[36:39], a[228:231], v[32:35], a[36:39]
    ds_read_b128 a[224:227], v0 offset:13312
    v_fma_f32 v75, v75, s28, v11
    v_mfma_f32_16x16x32_bf16 v[244:247], a[228:231], v[28:31], v[244:247]
    ds_read_b128 a[216:219], v0 offset:12288
    v_fma_f32 v71, v71, s28, v11
    v_mfma_f32_16x16x32_bf16 v[196:199], a[228:231], v[20:23], v[196:199]
    s_add_u32 m0, s22, 36864
    ds_read_b128 a[220:223], v1 offset:12288
    v_mfma_f32_16x16x32_bf16 v[148:151], a[228:231], v[16:19], v[148:151]
    buffer_load_dwordx4 v6, s[8:11], s21 offen lds
    v_mfma_f32_16x16x32_bf16 v[152:155], a[232:235], v[16:19], v[152:155]
    s_add_u32 s21, s21, 128
    v_exp_f32_e64 v71, v71 clamp
    v_mfma_f32_16x16x32_bf16 v[200:203], a[232:235], v[20:23], v[200:203]
    s_add_u32 m0, s22, 37888
    v_exp_f32_e64 v76, v76 clamp
    v_mfma_f32_16x16x32_bf16 v[248:251], a[232:235], v[28:31], v[248:251]
    buffer_load_dwordx4 v6, s[8:11], s21 offen lds
    v_mfma_f32_16x16x32_bf16 a[40:43], a[232:235], v[32:35], a[40:43]
    v_exp_f32_e64 v63, v63 clamp
    v_mfma_f32_16x16x32_bf16 a[44:47], a[236:239], v[32:35], a[44:47]
    s_add_u32 s21, s21, 128
    ds_read_b128 a[232:235], v0 offset:14336
    v_cvt_pk_bf16_f32 v34, v76, v77
    v_mfma_f32_16x16x32_bf16 v[252:255], a[236:239], v[28:31], v[252:255]
    s_add_u32 m0, s22, 38912
    v_fma_f32 v79, v79, s28, v12
    v_mfma_f32_16x16x32_bf16 v[204:207], a[236:239], v[20:23], v[204:207]
    buffer_load_dwordx4 v6, s[8:11], s21 offen lds
    v_mfma_f32_16x16x32_bf16 v[156:159], a[236:239], v[16:19], v[156:159]
    s_waitcnt lgkmcnt(2)
    v_cvt_pk_bf16_f32 v22, v60, v61
    v_cvt_pk_bf16_f32 v27, v70, v71
    v_mfma_f32_16x16x32_bf16 v[52:55], a[216:219], a[96:99], 0
    s_waitcnt lgkmcnt(1)
    ds_read_b128 a[228:231], v1 offset:13312
    v_mfma_f32_16x16x32_bf16 v[52:55], a[220:223], a[100:103], v[52:55]
    v_exp_f32_e64 v79, v79 clamp
    v_mfma_f32_16x16x32_bf16 v[52:55], a[224:227], a[104:107], v[52:55]
    ds_read_b128 a[236:239], v1 offset:14336
    v_cvt_pk_bf16_f32 v23, v62, v63
    v_mfma_f32_16x16x32_bf16 v[60:63], a[224:227], a[128:131], 0
    v_exp_f32_e64 v56, v56 clamp
    v_mfma_f32_16x16x32_bf16 v[60:63], a[220:223], a[124:127], v[60:63]
    v_exp_f32_e64 v59, v59 clamp
    v_mfma_f32_16x16x32_bf16 v[60:63], a[216:219], a[120:123], v[60:63]
    v_cvt_pk_bf16_f32 v35, v78, v79
    v_mfma_f32_16x16x32_bf16 v[68:71], a[216:219], a[144:147], 0
    s_add_u32 s21, s21, 12032
    v_exp_f32_e64 v58, v58 clamp
    v_mfma_f32_16x16x32_bf16 v[68:71], a[220:223], a[148:151], v[68:71]
    v_exp_f32_e64 v82, v82 clamp
    v_mfma_f32_16x16x32_bf16 v[68:71], a[224:227], a[152:155], v[68:71]
    v_fma_f32 v81, v81, s28, v12
    v_cvt_pk_bf16_f32 v17, v58, v59
    v_mfma_f32_16x16x32_bf16 v[76:79], a[224:227], a[176:179], 0
    v_exp_f32_e64 v67, v67 clamp
    v_mfma_f32_16x16x32_bf16 v[76:79], a[220:223], a[172:175], v[76:79]
    v_exp_f32_e64 v83, v83 clamp
    v_mfma_f32_16x16x32_bf16 v[76:79], a[216:219], a[168:171], v[76:79]
    s_waitcnt lgkmcnt(1)
    v_exp_f32_e64 v75, v75 clamp
    v_mfma_f32_16x16x32_bf16 v[76:79], a[228:231], a[180:183], v[76:79]
    ds_read_b128 a[220:223], v1 offset:18432
    v_mfma_f32_16x16x32_bf16 v[76:79], a[232:235], a[184:187], v[76:79]
    s_waitcnt lgkmcnt(1)
    v_exp_f32_e64 v81, v81 clamp
    v_mfma_f32_16x16x32_bf16 v[76:79], a[236:239], a[188:191], v[76:79]
    v_exp_f32_e64 v80, v80 clamp
    v_mfma_f32_16x16x32_bf16 v[68:71], a[236:239], a[164:167], v[68:71]
    ds_read_b128 a[216:219], v0 offset:18432
    v_cvt_pk_bf16_f32 v16, v56, v57
    v_mfma_f32_16x16x32_bf16 v[68:71], a[232:235], a[160:163], v[68:71]
    v_cvt_pk_bf16_f32 v36, v80, v81
    v_cvt_pk_bf16_f32 v29, v74, v75
    v_mfma_f32_16x16x32_bf16 v[68:71], a[228:231], a[156:159], v[68:71]
    v_cvt_pk_bf16_f32 v25, v66, v67
    v_mfma_f32_16x16x32_bf16 v[60:63], a[228:231], a[132:135], v[60:63]
    v_cvt_pk_bf16_f32 v28, v72, v73
    v_cvt_pk_bf16_f32 v37, v82, v83
    v_mfma_f32_16x16x32_bf16 v[60:63], a[232:235], a[136:139], v[60:63]
    s_add_u32 s57, s24, 128
    ds_read_b128 a[224:227], v0 offset:19456
    v_mfma_f32_16x16x32_bf16 v[60:63], a[236:239], a[140:143], v[60:63]
    v_exp_f32_e64 v65, v65 clamp
    v_mfma_f32_16x16x32_bf16 v[52:55], a[236:239], a[116:119], v[52:55]
    v_mfma_f32_16x16x32_bf16 v[52:55], a[232:235], a[112:115], v[52:55]
    ds_read_b128 a[232:235], v0 offset:20480
    v_mfma_f32_16x16x32_bf16 v[52:55], a[228:231], a[108:111], v[52:55]
    ds_read_b128 a[228:231], v1 offset:19456
    v_cvt_pk_bf16_f32 v24, v64, v65
    v_mfma_f32_16x16x32_bf16 v[44:47], a[248:251], v[14:17], v[44:47]
    ds_read_b128 a[236:239], v1 offset:20480
    v_smfmac_f32_16x16x64_bf16 v[44:47], a[240:243], v[22:29], v101
    v_mfma_f32_16x16x32_bf16 v[44:47], a[252:255], v[34:37], v[44:47]
    s_waitcnt lgkmcnt(4)
    v_mfma_f32_16x16x32_bf16 v[56:59], a[216:219], a[96:99], 0
    buffer_store_dwordx4 v[88:91], v6, s[16:19], s24 offen offset:0 nt
    s_nop 0
    ds_read_b128 v[88:91], v103 offset:3072
    v_mfma_f32_16x16x32_bf16 v[56:59], a[220:223], a[100:103], v[56:59]
    s_waitcnt lgkmcnt(4)
    v_mfma_f32_16x16x32_bf16 v[56:59], a[224:227], a[104:107], v[56:59]
    v_mfma_f32_16x16x32_bf16 v[64:67], a[224:227], a[128:131], 0
    v_mfma_f32_16x16x32_bf16 v[64:67], a[220:223], a[124:127], v[64:67]
    v_cmp_lt_f32 vcc, s29, v44
    v_mfma_f32_16x16x32_bf16 v[64:67], a[216:219], a[120:123], v[64:67]
    s_waitcnt vmcnt(7) lgkmcnt(1)
    v_mfma_f32_16x16x32_bf16 v[72:75], a[216:219], a[144:147], 0
    s_barrier
    v_mfma_f32_16x16x32_bf16 v[72:75], a[220:223], a[148:151], v[72:75]
    s_cbranch_vccnz L_rs_end4a
L_ret_end4a:
    v_fma_f32 v60, v60, s28, v10
    v_mfma_f32_16x16x32_bf16 v[72:75], a[224:227], a[152:155], v[72:75]
    v_exp_f32_e64 v60, v60 clamp
    v_mfma_f32_16x16x32_bf16 v[80:83], a[224:227], a[176:179], 0
    v_fma_f32 v61, v61, s28, v10
    v_fma_f32 v55, v55, s28, v9
    v_mfma_f32_16x16x32_bf16 v[80:83], a[220:223], a[172:175], v[80:83]
    v_mfma_f32_16x16x32_bf16 v[80:83], a[216:219], a[168:171], v[80:83]
    v_fma_f32 v52, v52, s28, v9
    v_fma_f32 v53, v53, s28, v9
    v_mfma_f32_16x16x32_bf16 v[80:83], a[228:231], a[180:183], v[80:83]
    ds_read_b64_tr_b16 a[216:217], v2 offset:0
    v_mfma_f32_16x16x32_bf16 v[80:83], a[232:235], a[184:187], v[80:83]
    ds_read_b64_tr_b16 a[218:219], v2 offset:6144
    v_fma_f32 v54, v54, s28, v9
    v_mfma_f32_16x16x32_bf16 v[80:83], a[236:239], a[188:191], v[80:83]
    v_mfma_f32_16x16x32_bf16 v[72:75], a[236:239], a[164:167], v[72:75]
    v_exp_f32_e64 v55, v55 clamp
    v_mfma_f32_16x16x32_bf16 v[72:75], a[232:235], a[160:163], v[72:75]
    v_exp_f32_e64 v53, v53 clamp
    v_mfma_f32_16x16x32_bf16 v[72:75], a[228:231], a[156:159], v[72:75]
    ds_read_b64_tr_b16 a[220:221], v3 offset:0
    v_mfma_f32_16x16x32_bf16 v[64:67], a[228:231], a[132:135], v[64:67]
    buffer_store_dwordx4 v[96:99], v7, s[16:19], s24 offen offset:0 nt
    ds_read_b64_tr_b16 a[222:223], v3 offset:6144
    v_exp_f32_e64 v52, v52 clamp
    v_mfma_f32_16x16x32_bf16 v[64:67], a[232:235], a[136:139], v[64:67]
    v_exp_f32_e64 v61, v61 clamp
    v_mfma_f32_16x16x32_bf16 v[64:67], a[236:239], a[140:143], v[64:67]
    buffer_store_dwordx4 v[84:87], v6, s[16:19], s57 offen offset:0 nt
    v_exp_f32_e64 v54, v54 clamp
    s_waitcnt lgkmcnt(2)
    v_mfma_f32_16x16x32_bf16 v[56:59], a[236:239], a[116:119], v[56:59]
    ds_read_b64_tr_b16 a[224:225], v4 offset:0
    v_mfma_f32_16x16x32_bf16 v[56:59], a[232:235], a[112:115], v[56:59]
    ds_read_b64_tr_b16 a[226:227], v4 offset:6144
    v_cvt_pk_bf16_f32 v18, v52, v53
    v_mfma_f32_16x16x32_bf16 v[56:59], a[228:231], a[108:111], v[56:59]
    buffer_store_dwordx4 v[88:91], v7, s[16:19], s57 offen offset:0 nt
    ds_read_b64_tr_b16 a[228:229], v5 offset:0
    ds_read_b64_tr_b16 a[230:231], v5 offset:6144
    v_cvt_pk_bf16_f32 v19, v54, v55
    v_mfma_f32_16x16x32_bf16 v[112:115], a[216:219], v[14:17], v[112:115]
    s_add_u32 s39, s39, 12288
    ds_read_b64_tr_b16 a[232:233], v2 offset:1024
    v_fma_f32 v77, v77, s28, v12
    v_fma_f32 v71, v71, s28, v11
    v_mfma_f32_16x16x32_bf16 v[160:163], a[216:219], v[22:25], v[160:163]
    ds_read_b64_tr_b16 a[238:239], v3 offset:7168
    v_fma_f32 v81, v81, s28, v12
    v_mfma_f32_16x16x32_bf16 v[208:211], a[216:219], v[26:29], v[208:211]
    s_waitcnt vmcnt(4)
    ds_read_b64_tr_b16 a[236:237], v3 offset:1024
    v_exp_f32_e64 v81, v81 clamp
    v_fma_f32 v69, v69, s28, v11
    v_mfma_f32_16x16x32_bf16 a[0:3], a[216:219], v[34:37], a[0:3]
    s_waitcnt lgkmcnt(7)
    ds_read_b64_tr_b16 a[234:235], v2 offset:7168
    v_fma_f32 v64, v64, s28, v10
    v_mfma_f32_16x16x32_bf16 a[4:7], a[220:223], v[34:37], a[4:7]
    s_barrier
    v_fma_f32 v83, v83, s28, v12
    v_mfma_f32_16x16x32_bf16 v[212:215], a[220:223], v[26:29], v[212:215]
    v_exp_f32_e64 v71, v71 clamp
    v_fma_f32 v65, v65, s28, v10
    v_mfma_f32_16x16x32_bf16 v[164:167], a[220:223], v[22:25], v[164:167]
    v_fma_f32 v80, v80, s28, v12
    v_exp_f32_e64 v69, v69 clamp
    v_mfma_f32_16x16x32_bf16 v[116:119], a[220:223], v[14:17], v[116:119]
    s_waitcnt lgkmcnt(6)
    ds_read_b64_tr_b16 a[222:223], v5 offset:7168
    v_fma_f32 v66, v66, s28, v10
    v_mfma_f32_16x16x32_bf16 v[120:123], a[224:227], v[14:17], v[120:123]
    ds_read_b64_tr_b16 a[218:219], v4 offset:7168
    v_fma_f32 v67, v67, s28, v10
    v_mfma_f32_16x16x32_bf16 v[168:171], a[224:227], v[22:25], v[168:171]
    v_exp_f32_e64 v80, v80 clamp
    v_mfma_f32_16x16x32_bf16 v[216:219], a[224:227], v[26:29], v[216:219]
    v_fma_f32 v78, v78, s28, v12
    v_fma_f32 v68, v68, s28, v11
    v_mfma_f32_16x16x32_bf16 a[8:11], a[224:227], v[34:37], a[8:11]
    s_waitcnt lgkmcnt(3)
    v_exp_f32_e64 v68, v68 clamp
    v_mfma_f32_16x16x32_bf16 a[12:15], a[228:231], v[34:37], a[12:15]
    v_fma_f32 v56, v56, s28, v9
    v_fma_f32 v59, v59, s28, v9
    v_mfma_f32_16x16x32_bf16 v[220:223], a[228:231], v[26:29], v[220:223]
    ds_read_b64_tr_b16 a[220:221], v5 offset:1024
    v_fma_f32 v76, v76, s28, v12
    v_mfma_f32_16x16x32_bf16 v[172:175], a[228:231], v[22:25], v[172:175]
    ds_read_b64_tr_b16 a[216:217], v4 offset:1024
    v_exp_f32_e64 v77, v77 clamp
    v_mfma_f32_16x16x32_bf16 v[124:127], a[228:231], v[14:17], v[124:127]
    s_waitcnt lgkmcnt(4)
    v_fma_f32 v70, v70, s28, v11
    v_fma_f32 v73, v73, s28, v11
    v_mfma_f32_16x16x32_bf16 v[128:131], a[232:235], v[14:17], v[128:131]
    ds_read_b64_tr_b16 a[226:227], v2 offset:8192
    v_fma_f32 v57, v57, s28, v9
    v_mfma_f32_16x16x32_bf16 v[176:179], a[232:235], v[22:25], v[176:179]
    v_fma_f32 v58, v58, s28, v9
    v_exp_f32_e64 v76, v76 clamp
    v_mfma_f32_16x16x32_bf16 v[224:227], a[232:235], v[26:29], v[224:227]
    ds_read_b64_tr_b16 a[228:229], v3 offset:2048
    v_fma_f32 v74, v74, s28, v11
    v_mfma_f32_16x16x32_bf16 a[16:19], a[232:235], v[34:37], a[16:19]
    v_exp_f32_e64 v70, v70 clamp
    v_mfma_f32_16x16x32_bf16 a[20:23], a[236:239], v[34:37], a[20:23]
    v_cvt_pk_bf16_f32 v30, v68, v69
    v_fma_f32 v72, v72, s28, v11
    v_mfma_f32_16x16x32_bf16 v[228:231], a[236:239], v[26:29], v[228:231]
    ds_read_b64_tr_b16 a[224:225], v2 offset:2048
    v_fma_f32 v79, v79, s28, v12
    v_mfma_f32_16x16x32_bf16 v[180:183], a[236:239], v[22:25], v[180:183]
    ds_read_b64_tr_b16 a[230:231], v3 offset:8192
    v_fma_f32 v62, v62, s28, v10
    v_exp_f32_e64 v67, v67 clamp
    v_mfma_f32_16x16x32_bf16 v[132:135], a[236:239], v[14:17], v[132:135]
    s_waitcnt lgkmcnt(4)
    ds_read_b64_tr_b16 a[234:235], v4 offset:8192
    v_exp_f32_e64 v74, v74 clamp
    v_mfma_f32_16x16x32_bf16 v[136:139], a[216:219], v[14:17], v[136:139]
    v_exp_f32_e64 v65, v65 clamp
    v_mfma_f32_16x16x32_bf16 v[184:187], a[216:219], v[22:25], v[184:187]
    ds_read_b64_tr_b16 a[236:237], v5 offset:2048
    v_exp_f32_e64 v64, v64 clamp
    v_mfma_f32_16x16x32_bf16 v[232:235], a[216:219], v[26:29], v[232:235]
    v_fma_f32 v82, v82, s28, v12
    v_exp_f32_e64 v83, v83 clamp
    v_mfma_f32_16x16x32_bf16 a[24:27], a[216:219], v[34:37], a[24:27]
    ds_read_b64_tr_b16 a[216:217], v2 offset:18432
    v_exp_f32_e64 v59, v59 clamp
    v_mfma_f32_16x16x32_bf16 a[28:31], a[220:223], v[34:37], a[28:31]
    v_exp_f32_e64 v78, v78 clamp
    v_mfma_f32_16x16x32_bf16 v[236:239], a[220:223], v[26:29], v[236:239]
    ds_read_b64_tr_b16 a[232:233], v4 offset:2048
    v_fma_f32 v75, v75, s28, v11
    v_mfma_f32_16x16x32_bf16 v[188:191], a[220:223], v[22:25], v[188:191]
    v_exp_f32_e64 v79, v79 clamp
    v_mfma_f32_16x16x32_bf16 v[140:143], a[220:223], v[14:17], v[140:143]
    s_waitcnt lgkmcnt(4)
    ds_read_b64_tr_b16 a[238:239], v5 offset:8192
    v_exp_f32_e64 v56, v56 clamp
    v_mfma_f32_16x16x32_bf16 v[144:147], a[224:227], v[14:17], v[144:147]
    v_exp_f32_e64 v82, v82 clamp
    v_mfma_f32_16x16x32_bf16 v[192:195], a[224:227], v[22:25], v[192:195]
    v_exp_f32_e64 v66, v66 clamp
    v_mfma_f32_16x16x32_bf16 v[240:243], a[224:227], v[26:29], v[240:243]
    v_exp_f32_e64 v62, v62 clamp
    v_mfma_f32_16x16x32_bf16 a[32:35], a[224:227], v[34:37], a[32:35]
    v_exp_f32_e64 v73, v73 clamp
    v_mfma_f32_16x16x32_bf16 a[36:39], a[228:231], v[34:37], a[36:39]
    v_exp_f32_e64 v75, v75 clamp
    v_mfma_f32_16x16x32_bf16 v[244:247], a[228:231], v[26:29], v[244:247]
    v_exp_f32_e64 v72, v72 clamp
    v_mfma_f32_16x16x32_bf16 v[196:199], a[228:231], v[22:25], v[196:199]
    ds_read_b64_tr_b16 a[218:219], v2 offset:12288
    v_cvt_pk_bf16_f32 v20, v64, v65
    v_mfma_f32_16x16x32_bf16 v[148:151], a[228:231], v[14:17], v[148:151]
    s_waitcnt lgkmcnt(2)
    ds_read_b64_tr_b16 a[220:221], v3 offset:18432
    v_cvt_pk_bf16_f32 v32, v80, v81
    v_mfma_f32_16x16x32_bf16 v[152:155], a[232:235], v[14:17], v[152:155]
    v_fma_f32 v63, v63, s28, v10
    v_cvt_pk_bf16_f32 v31, v70, v71
    v_mfma_f32_16x16x32_bf16 v[200:203], a[232:235], v[22:25], v[200:203]
    v_exp_f32_e64 v63, v63 clamp
    v_mfma_f32_16x16x32_bf16 v[248:251], a[232:235], v[26:29], v[248:251]
    v_exp_f32_e64 v58, v58 clamp
    v_mfma_f32_16x16x32_bf16 a[40:43], a[232:235], v[34:37], a[40:43]
    s_waitcnt lgkmcnt(2)
    ds_read_b64_tr_b16 a[222:223], v3 offset:12288
    v_cvt_pk_bf16_f32 v33, v82, v83
    v_mfma_f32_16x16x32_bf16 a[44:47], a[236:239], v[34:37], a[44:47]
    v_exp_f32_e64 v57, v57 clamp
    v_mfma_f32_16x16x32_bf16 v[252:255], a[236:239], v[26:29], v[252:255]
    ds_read_b64_tr_b16 a[224:225], v4 offset:18432
    v_cvt_pk_bf16_f32 v21, v66, v67
    v_mfma_f32_16x16x32_bf16 v[204:207], a[236:239], v[22:25], v[204:207]
    v_cvt_pk_bf16_f32 v28, v72, v73
    v_cvt_pk_bf16_f32 v23, v62, v63
    v_mfma_f32_16x16x32_bf16 v[156:159], a[236:239], v[14:17], v[156:159]
    v_cvt_pk_bf16_f32 v22, v60, v61
    v_cvt_pk_bf16_f32 v34, v76, v77
    v_cvt_pk_bf16_f32 v17, v58, v59
    v_cvt_pk_bf16_f32 v16, v56, v57
    v_cvt_pk_bf16_f32 v29, v74, v75
    v_cvt_pk_bf16_f32 v35, v78, v79
    v_smfmac_f32_16x16x64_bf16 v[48:51], a[240:243], v[16:23], v101
    ds_read_b64_tr_b16 a[226:227], v4 offset:12288
    v_smfmac_f32_16x16x64_bf16 v[48:51], a[244:247], v[28:35], v101
    s_waitcnt lgkmcnt(3)
    ds_read_b64_tr_b16 a[228:229], v5 offset:18432
    ds_read_b64_tr_b16 a[230:231], v5 offset:12288
    s_nop 4
    v_cmp_lt_f32 vcc, s29, v48
    s_nop 4
    s_cbranch_vccnz L_rs_end4b
L_ret_end4b:
    v_lshrrev_b32 v108, 11, v0
    v_xor_b32 v108, s65, v108
    v_and_b32 v93, 0x3ff, v0
    v_lshl_add_u32 v93, v108, 10, v93
    v_mbcnt_lo_u32_b32 v108, -1, 0
    v_add_u32 v93, s38, v93
    v_mbcnt_hi_u32_b32 v108, -1, v108
    v_lshrrev_b32 v108, 1, v108
    v_and_b32 v108, 24, v108
    v_bfe_u32 v108, s66, v108, 8
    v_xor_b32 v93, v93, v108
    v_xor_b32 v102, 96, v93
    v_xor_b32 v8, 64, v93
    v_xor_b32 v95, 32, v93
    v_mov_b32 v109, v50
    v_mov_b32 v110, v45
    v_mov_b32 v108, v49
    v_mfma_f32_16x16x32_bf16 v[112:115], a[216:219], v[16:19], v[112:115]
    s_add_u32 s84, s34, 0
    v_permlane16_swap_b32 v50, v109
    v_permlane16_swap_b32 v49, v108
    v_mov_b32 v111, v46
    v_add_f32 v49, v49, v108
    v_add_f32 v50, v50, v109
    v_mov_b32 v109, v50
    s_add_u32 s85, s34, 6144
    v_mfma_f32_16x16x32_bf16 v[160:163], a[216:219], v[20:23], v[160:163]
    ds_read_b64_tr_b16 a[236:237], v3 offset:19456
    v_permlane16_swap_b32 v46, v111
    v_mov_b32 v108, v49
    s_waitcnt lgkmcnt(5)
    v_mfma_f32_16x16x32_bf16 v[116:119], a[220:223], v[16:19], v[116:119]
    s_add_u32 s86, s34, 12288
    ds_read_b64_tr_b16 a[238:239], v3 offset:13312
    v_permlane32_swap_b32 v50, v109
    v_add_f32 v46, v46, v111
    v_permlane16_swap_b32 v45, v110
    v_mfma_f32_16x16x32_bf16 v[164:167], a[220:223], v[20:23], v[164:167]
    s_waitcnt lgkmcnt(4)
    v_mfma_f32_16x16x32_bf16 v[120:123], a[224:227], v[16:19], v[120:123]
    v_mfma_f32_16x16x32_bf16 v[168:171], a[224:227], v[20:23], v[168:171]
    s_waitcnt lgkmcnt(2)
    ds_read_b64_tr_b16 a[232:233], v2 offset:19456
    v_mfma_f32_16x16x32_bf16 v[124:127], a[228:231], v[16:19], v[124:127]
    v_permlane32_swap_b32 v49, v108
    v_mfma_f32_16x16x32_bf16 v[172:175], a[228:231], v[20:23], v[172:175]
    ds_read_b64_tr_b16 a[234:235], v2 offset:13312
    v_mfma_f32_16x16x32_bf16 v[208:211], a[216:219], v[28:31], v[208:211]
    v_add_f32 v45, v45, v110
    v_subrev_u32 v103, 24576, v103
    v_mfma_f32_16x16x32_bf16 a[0:3], a[216:219], v[32:35], a[0:3]
    v_mov_b32 v110, v45
    v_mov_b32 v111, v46
    v_mfma_f32_16x16x32_bf16 v[212:215], a[220:223], v[28:31], v[212:215]
    v_permlane32_swap_b32 v45, v110
    v_mfma_f32_16x16x32_bf16 a[4:7], a[220:223], v[32:35], a[4:7]
    v_add_f32 v48, v49, v47
    v_add_f32 v92, v108, v45
    v_mfma_f32_16x16x32_bf16 v[216:219], a[224:227], v[28:31], v[216:219]
    v_rcp_f32 v48, v48
    v_mfma_f32_16x16x32_bf16 a[8:11], a[224:227], v[32:35], a[8:11]
    v_accvgpr_read_b32 v104, a0
    v_mfma_f32_16x16x32_bf16 v[220:223], a[228:231], v[28:31], v[220:223]
    ds_read_b64_tr_b16 a[226:227], v2 offset:14336
    v_mfma_f32_16x16x32_bf16 a[12:15], a[228:231], v[32:35], a[12:15]
    v_rcp_f32 v92, v92
    v_pk_mul_f32 v[120:121], v[120:121], v[48:49] op_sel_hi:[1,0]
    v_pk_mul_f32 v[118:119], v[118:119], v[48:49] op_sel_hi:[1,0]
    v_pk_mul_f32 v[116:117], v[116:117], v[48:49] op_sel_hi:[1,0]
    v_pk_mul_f32 v[164:165], v[164:165], v[92:93] op_sel_hi:[1,0]
    v_pk_mul_f32 v[112:113], v[112:113], v[48:49] op_sel_hi:[1,0]
    v_cvt_pk_bf16_f32 v164, v164, v165
    v_pk_mul_f32 v[174:175], v[174:175], v[92:93] op_sel_hi:[1,0]
    v_pk_mul_f32 v[168:169], v[168:169], v[92:93] op_sel_hi:[1,0]
    v_pk_mul_f32 v[160:161], v[160:161], v[92:93] op_sel_hi:[1,0]
    v_pk_mul_f32 v[162:163], v[162:163], v[92:93] op_sel_hi:[1,0]
    v_cvt_pk_bf16_f32 v120, v120, v121
    v_pk_mul_f32 v[170:171], v[170:171], v[92:93] op_sel_hi:[1,0]
    v_pk_mul_f32 v[124:125], v[124:125], v[48:49] op_sel_hi:[1,0]
    v_pk_mul_f32 v[126:127], v[126:127], v[48:49] op_sel_hi:[1,0]
    v_cvt_pk_bf16_f32 v116, v116, v117
    v_cvt_pk_bf16_f32 v168, v168, v169
    v_cvt_pk_bf16_f32 v124, v124, v125
    v_pk_mul_f32 v[166:167], v[166:167], v[92:93] op_sel_hi:[1,0]
    v_pk_mul_f32 v[172:173], v[172:173], v[92:93] op_sel_hi:[1,0]
    v_pk_mul_f32 v[114:115], v[114:115], v[48:49] op_sel_hi:[1,0]
    v_pk_mul_f32 v[122:123], v[122:123], v[48:49] op_sel_hi:[1,0]
    v_cvt_pk_bf16_f32 v172, v172, v173
    v_cvt_pk_bf16_f32 v169, v170, v171
    v_cvt_pk_bf16_f32 v112, v112, v113
    v_cvt_pk_bf16_f32 v165, v166, v167
    v_cvt_pk_bf16_f32 v125, v126, v127
    v_cvt_pk_bf16_f32 v160, v160, v161
    v_cvt_pk_bf16_f32 v117, v118, v119
    v_cvt_pk_bf16_f32 v121, v122, v123
    v_cvt_pk_bf16_f32 v161, v162, v163
    v_cvt_pk_bf16_f32 v113, v114, v115
    v_cvt_pk_bf16_f32 v173, v174, v175
    ds_write2st64_b64 v93, v[112:113], v[160:161] offset0:0 offset1:12
    ds_write2st64_b64 v95, v[116:117], v[164:165] offset0:0 offset1:12
    ds_write2st64_b64 v8, v[120:121], v[168:169] offset0:0 offset1:12
    ds_write2st64_b64 v102, v[124:125], v[172:173] offset0:0 offset1:12
    ds_read_b128 v[80:83], v103 offset:0
    s_add_u32 s87, s34, 18432
    s_waitcnt lgkmcnt(5)
    v_mfma_f32_16x16x32_bf16 v[128:131], a[232:235], v[16:19], v[128:131]
    ds_read_b64_tr_b16 a[218:219], v4 offset:13312
    ds_read_b128 v[84:87], v103 offset:1024
    v_mfma_f32_16x16x32_bf16 v[176:179], a[232:235], v[20:23], v[176:179]
    ds_read_b128 v[88:91], v103 offset:6144
    s_add_u32 s18, s34, 24576
    v_mfma_f32_16x16x32_bf16 v[132:135], a[236:239], v[16:19], v[132:135]
    v_accvgpr_read_b32 v54, a10
    v_accvgpr_read_b32 v52, a8
    v_accvgpr_read_b32 v108, a4
    v_permlane32_swap_b32 v46, v111
    v_accvgpr_read_b32 v58, a14
    v_accvgpr_read_b32 v53, a9
    v_accvgpr_read_b32 v56, a12
    ds_read_b64_tr_b16 a[220:221], v5 offset:19456
    ds_read_b64_tr_b16 a[216:217], v4 offset:19456
    v_accvgpr_read_b32 v107, a3
    v_add_f32 v50, v50, v110
    v_add_f32 v94, v109, v46
    v_rcp_f32 v50, v50
    v_accvgpr_read_b32 v105, a1
    v_pk_mul_f32 v[214:215], v[214:215], v[50:51] op_sel_hi:[1,0]
    v_accvgpr_read_b32 v57, a13
    v_pk_mul_f32 v[208:209], v[208:209], v[50:51] op_sel_hi:[1,0]
    v_pk_mul_f32 v[212:213], v[212:213], v[50:51] op_sel_hi:[1,0]
    v_accvgpr_read_b32 v109, a5
    v_accvgpr_read_b32 v106, a2
    s_waitcnt lgkmcnt(5)
    buffer_store_dwordx4 v[80:83], v6, s[16:19], s84 offen offset:0 nt
    v_cvt_pk_bf16_f32 v208, v208, v209
    v_rcp_f32 v94, v94
    v_accvgpr_read_b32 v55, a11
    v_pk_mul_f32 v[220:221], v[220:221], v[50:51] op_sel_hi:[1,0]
    v_pk_mul_f32 v[56:57], v[56:57], v[94:95] op_sel_hi:[1,0]
    v_pk_mul_f32 v[54:55], v[54:55], v[94:95] op_sel_hi:[1,0]
    v_pk_mul_f32 v[52:53], v[52:53], v[94:95] op_sel_hi:[1,0]
    v_pk_mul_f32 v[210:211], v[210:211], v[50:51] op_sel_hi:[1,0]
    v_pk_mul_f32 v[104:105], v[104:105], v[94:95] op_sel_hi:[1,0]
    v_pk_mul_f32 v[108:109], v[108:109], v[94:95] op_sel_hi:[1,0]
    v_pk_mul_f32 v[218:219], v[218:219], v[50:51] op_sel_hi:[1,0]
    v_pk_mul_f32 v[134:135], v[134:135], v[48:49] op_sel_hi:[1,0]
    v_cvt_pk_bf16_f32 v52, v52, v53
    v_pk_mul_f32 v[222:223], v[222:223], v[50:51] op_sel_hi:[1,0]
    v_pk_mul_f32 v[106:107], v[106:107], v[94:95] op_sel_hi:[1,0]
    v_pk_mul_f32 v[130:131], v[130:131], v[48:49] op_sel_hi:[1,0]
    v_accvgpr_read_b32 v110, a6
    v_pk_mul_f32 v[216:217], v[216:217], v[50:51] op_sel_hi:[1,0]
    v_cvt_pk_bf16_f32 v212, v212, v213
    v_accvgpr_read_b32 v59, a15
    v_mfma_f32_16x16x32_bf16 v[180:183], a[236:239], v[20:23], v[180:183]
    s_waitcnt lgkmcnt(0)
    ds_read_b64_tr_b16 a[230:231], v3 offset:14336
    ds_read_b64_tr_b16 a[222:223], v5 offset:13312
    v_cvt_pk_bf16_f32 v220, v220, v221
    v_mfma_f32_16x16x32_bf16 v[136:139], a[216:219], v[16:19], v[136:139]
    v_cvt_pk_bf16_f32 v216, v216, v217
    buffer_store_dwordx4 v[84:87], v7, s[16:19], s84 offen offset:0 nt
    ds_read_b128 v[60:63], v103 offset:7168
    v_cvt_pk_bf16_f32 v221, v222, v223
    v_accvgpr_read_b32 v111, a7
    v_pk_mul_f32 v[128:129], v[128:129], v[48:49] op_sel_hi:[1,0]
    v_cvt_pk_bf16_f32 v104, v104, v105
    v_cvt_pk_bf16_f32 v56, v56, v57
    v_cvt_pk_bf16_f32 v105, v106, v107
    v_pk_mul_f32 v[180:181], v[180:181], v[92:93] op_sel_hi:[1,0]
    v_cvt_pk_bf16_f32 v108, v108, v109
    v_cvt_pk_bf16_f32 v209, v210, v211
    v_pk_mul_f32 v[132:133], v[132:133], v[48:49] op_sel_hi:[1,0]
    v_pk_mul_f32 v[110:111], v[110:111], v[94:95] op_sel_hi:[1,0]
    v_cvt_pk_bf16_f32 v53, v54, v55
    v_cvt_pk_bf16_f32 v217, v218, v219
    v_pk_mul_f32 v[58:59], v[58:59], v[94:95] op_sel_hi:[1,0]
    s_nop 0
    v_cvt_pk_bf16_f32 v57, v58, v59
    v_cvt_pk_bf16_f32 v213, v214, v215
    v_mfma_f32_16x16x32_bf16 v[184:187], a[216:219], v[20:23], v[184:187]
    ds_read_b64_tr_b16 a[228:229], v3 offset:20480
    ds_write2st64_b64 v93, v[208:209], v[104:105] offset0:24 offset1:36
    v_cvt_pk_bf16_f32 v132, v132, v133
    v_cvt_pk_bf16_f32 v109, v110, v111
    s_waitcnt lgkmcnt(3)
    v_mfma_f32_16x16x32_bf16 v[140:143], a[220:223], v[16:19], v[140:143]
    buffer_store_dwordx4 v[88:91], v6, s[16:19], s85 offen offset:0 nt
    ds_write2st64_b64 v95, v[212:213], v[108:109] offset0:24 offset1:36
    v_mfma_f32_16x16x32_bf16 v[188:191], a[220:223], v[20:23], v[188:191]
    ds_write2st64_b64 v8, v[216:217], v[52:53] offset0:24 offset1:36
    v_pk_mul_f32 v[136:137], v[136:137], v[48:49] op_sel_hi:[1,0]
    v_pk_mul_f32 v[176:177], v[176:177], v[92:93] op_sel_hi:[1,0]
    s_nop 1
    v_mfma_f32_16x16x32_bf16 v[224:227], a[232:235], v[28:31], v[224:227]
    ds_write2st64_b64 v102, v[220:221], v[56:57] offset0:24 offset1:36
    v_cvt_pk_bf16_f32 v176, v176, v177
    v_mfma_f32_16x16x32_bf16 a[16:19], a[232:235], v[32:35], a[16:19]
    ds_read_b128 v[64:67], v103 offset:12288
    v_mfma_f32_16x16x32_bf16 v[228:231], a[236:239], v[28:31], v[228:231]
    s_waitcnt lgkmcnt(4)
    buffer_store_dwordx4 v[60:63], v7, s[16:19], s85 offen offset:0 nt
    v_pk_mul_f32 v[184:185], v[184:185], v[92:93] op_sel_hi:[1,0]
    v_cvt_pk_bf16_f32 v128, v128, v129
    v_cvt_pk_bf16_f32 v180, v180, v181
    v_pk_mul_f32 v[188:189], v[188:189], v[92:93] op_sel_hi:[1,0]
    ds_read_b128 v[68:71], v103 offset:13312
    s_nop 0
    v_mfma_f32_16x16x32_bf16 a[20:23], a[236:239], v[32:35], a[20:23]
    ds_read_b64_tr_b16 a[224:225], v2 offset:20480
    ds_read_b64_tr_b16 a[232:233], v4 offset:20480
    ds_read_b64_tr_b16 a[238:239], v5 offset:14336
    v_mfma_f32_16x16x32_bf16 v[232:235], a[216:219], v[28:31], v[232:235]
    s_nop 7
    v_pk_mul_f32 v[234:235], v[234:235], v[50:51] op_sel_hi:[1,0]
    v_accvgpr_read_b32 v105, a17
    v_pk_mul_f32 v[228:229], v[228:229], v[50:51] op_sel_hi:[1,0]
    v_accvgpr_read_b32 v108, a20
    v_pk_mul_f32 v[226:227], v[226:227], v[50:51] op_sel_hi:[1,0]
    v_accvgpr_read_b32 v107, a19
    s_waitcnt lgkmcnt(4)
    buffer_store_dwordx4 v[64:67], v6, s[16:19], s86 offen offset:0 nt
    ds_read_b64_tr_b16 a[234:235], v4 offset:14336
    v_cvt_pk_bf16_f32 v228, v228, v229
    v_pk_mul_f32 v[182:183], v[182:183], v[92:93] op_sel_hi:[1,0]
    v_pk_mul_f32 v[142:143], v[142:143], v[48:49] op_sel_hi:[1,0]
    ds_read_b64_tr_b16 a[236:237], v5 offset:20480
    v_pk_mul_f32 v[224:225], v[224:225], v[50:51] op_sel_hi:[1,0]
    v_pk_mul_f32 v[178:179], v[178:179], v[92:93] op_sel_hi:[1,0]
    v_pk_mul_f32 v[186:187], v[186:187], v[92:93] op_sel_hi:[1,0]
    v_accvgpr_read_b32 v106, a18
    v_pk_mul_f32 v[140:141], v[140:141], v[48:49] op_sel_hi:[1,0]
    s_nop 0
    v_cvt_pk_bf16_f32 v140, v140, v141
    v_cvt_pk_bf16_f32 v188, v188, v189
    v_cvt_pk_bf16_f32 v129, v130, v131
    v_mfma_f32_16x16x32_bf16 a[24:27], a[216:219], v[32:35], a[24:27]
    v_cvt_pk_bf16_f32 v184, v184, v185
    ds_read_b128 v[72:75], v103 offset:18432
    v_cvt_pk_bf16_f32 v181, v182, v183
    v_cvt_pk_bf16_f32 v177, v178, v179
    ds_read_b128 v[76:79], v103 offset:19456
    v_mfma_f32_16x16x32_bf16 v[236:239], a[220:223], v[28:31], v[236:239]
    s_waitcnt lgkmcnt(4)
    buffer_store_dwordx4 v[68:71], v7, s[16:19], s86 offen offset:0 nt
    ds_write2st64_b64 v93, v[128:129], v[176:177] offset0:4 offset1:16
    v_accvgpr_read_b32 v109, a21
    v_cvt_pk_bf16_f32 v133, v134, v135
    v_pk_mul_f32 v[190:191], v[190:191], v[92:93] op_sel_hi:[1,0]
    v_pk_mul_f32 v[138:139], v[138:139], v[48:49] op_sel_hi:[1,0]
    v_cvt_pk_bf16_f32 v136, v136, v137
    v_pk_mul_f32 v[230:231], v[230:231], v[50:51] op_sel_hi:[1,0]
    v_pk_mul_f32 v[236:237], v[236:237], v[50:51] op_sel_hi:[1,0]
    v_cvt_pk_bf16_f32 v189, v190, v191
    v_cvt_pk_bf16_f32 v229, v230, v231
    v_accvgpr_read_b32 v110, a22
    v_cvt_pk_bf16_f32 v141, v142, v143
    v_accvgpr_read_b32 v104, a16
    v_pk_mul_f32 v[232:233], v[232:233], v[50:51] op_sel_hi:[1,0]
    s_nop 1
    v_mfma_f32_16x16x32_bf16 a[28:31], a[220:223], v[32:35], a[28:31]
    ds_write2st64_b64 v95, v[132:133], v[180:181] offset0:4 offset1:16
    v_mfma_f32_16x16x32_bf16 v[144:147], a[224:227], v[16:19], v[144:147]
    s_waitcnt lgkmcnt(3)
    buffer_store_dwordx4 v[72:75], v6, s[16:19], s87 offen offset:0 nt
    v_cvt_pk_bf16_f32 v224, v224, v225
    v_accvgpr_read_b32 v53, a25
    v_cvt_pk_bf16_f32 v137, v138, v139
    v_pk_mul_f32 v[104:105], v[104:105], v[94:95] op_sel_hi:[1,0]
    v_cvt_pk_bf16_f32 v185, v186, v187
    v_accvgpr_read_b32 v57, a29
    ds_write2st64_b64 v8, v[136:137], v[184:185] offset0:4 offset1:16
    v_accvgpr_read_b32 v54, a26
    v_mfma_f32_16x16x32_bf16 v[192:195], a[224:227], v[20:23], v[192:195]
    ds_write2st64_b64 v102, v[140:141], v[188:189] offset0:4 offset1:16
    v_pk_mul_f32 v[108:109], v[108:109], v[94:95] op_sel_hi:[1,0]
    v_cvt_pk_bf16_f32 v104, v104, v105
    s_nop 0
    v_mfma_f32_16x16x32_bf16 v[148:151], a[228:231], v[16:19], v[148:151]
    s_waitcnt lgkmcnt(2)
    ds_read_b128 v[80:83], v103 offset:2048
    buffer_store_dwordx4 v[76:79], v7, s[16:19], s87 offen offset:0 nt
    v_accvgpr_read_b32 v52, a24
    v_mfma_f32_16x16x32_bf16 v[196:199], a[228:231], v[20:23], v[196:199]
    v_pk_mul_f32 v[106:107], v[106:107], v[94:95] op_sel_hi:[1,0]
    v_pk_mul_f32 v[192:193], v[192:193], v[92:93] op_sel_hi:[1,0]
    v_pk_mul_f32 v[194:195], v[194:195], v[92:93] op_sel_hi:[1,0]
    v_pk_mul_f32 v[52:53], v[52:53], v[94:95] op_sel_hi:[1,0]
    v_cvt_pk_bf16_f32 v236, v236, v237
    v_pk_mul_f32 v[238:239], v[238:239], v[50:51] op_sel_hi:[1,0]
    v_accvgpr_read_b32 v56, a28
    v_cvt_pk_bf16_f32 v105, v106, v107
    v_accvgpr_read_b32 v111, a23
    v_accvgpr_read_b32 v58, a30
    ds_read_b128 v[84:87], v103 offset:3072
    v_mfma_f32_16x16x32_bf16 v[152:155], a[232:235], v[16:19], v[152:155]
    ds_read_b128 v[88:91], v103 offset:8192
    v_accvgpr_read_b32 v59, a31
    v_cvt_pk_bf16_f32 v232, v232, v233
    s_waitcnt lgkmcnt(2)
    buffer_store_dwordx4 v[80:83], v6, s[16:19], s84 offen offset:128 nt
    v_pk_mul_f32 v[146:147], v[146:147], v[48:49] op_sel_hi:[1,0]
    s_nop 1
    v_mfma_f32_16x16x32_bf16 v[200:203], a[232:235], v[20:23], v[200:203]
    v_cvt_pk_bf16_f32 v237, v238, v239
    v_accvgpr_read_b32 v55, a27
    v_cvt_pk_bf16_f32 v108, v108, v109
    v_cvt_pk_bf16_f32 v52, v52, v53
    v_pk_mul_f32 v[144:145], v[144:145], v[48:49] op_sel_hi:[1,0]
    v_pk_mul_f32 v[110:111], v[110:111], v[94:95] op_sel_hi:[1,0]
    v_pk_mul_f32 v[56:57], v[56:57], v[94:95] op_sel_hi:[1,0]
    v_pk_mul_f32 v[148:149], v[148:149], v[48:49] op_sel_hi:[1,0]
    v_pk_mul_f32 v[58:59], v[58:59], v[94:95] op_sel_hi:[1,0]
    v_cvt_pk_bf16_f32 v225, v226, v227
    ds_read_b128 v[60:63], v103 offset:9216
    v_cvt_pk_bf16_f32 v233, v234, v235
    v_pk_mul_f32 v[198:199], v[198:199], v[92:93] op_sel_hi:[1,0]
    v_pk_mul_f32 v[54:55], v[54:55], v[94:95] op_sel_hi:[1,0]
    v_pk_mul_f32 v[196:197], v[196:197], v[92:93] op_sel_hi:[1,0]
    v_cvt_pk_bf16_f32 v56, v56, v57
    v_cvt_pk_bf16_f32 v144, v144, v145
    v_cvt_pk_bf16_f32 v109, v110, v111
    v_mfma_f32_16x16x32_bf16 v[156:159], a[236:239], v[16:19], v[156:159]
    s_waitcnt lgkmcnt(2)
    buffer_store_dwordx4 v[84:87], v7, s[16:19], s84 offen offset:128 nt
    v_cvt_pk_bf16_f32 v192, v192, v193
    ds_write2st64_b64 v93, v[224:225], v[104:105] offset0:28 offset1:40
    v_mfma_f32_16x16x32_bf16 v[204:207], a[236:239], v[20:23], v[204:207]
    ds_write2st64_b64 v95, v[228:229], v[108:109] offset0:28 offset1:40
    v_mfma_f32_16x16x32_bf16 v[240:243], a[224:227], v[28:31], v[240:243]
    s_waitcnt lgkmcnt(3)
    v_cvt_pk_bf16_f32 v53, v54, v55
    ds_write2st64_b64 v8, v[232:233], v[52:53] offset0:28 offset1:40
    buffer_store_dwordx4 v[88:91], v6, s[16:19], s85 offen offset:128 nt
    v_pk_mul_f32 v[200:201], v[200:201], v[92:93] op_sel_hi:[1,0]
    v_cvt_pk_bf16_f32 v148, v148, v149
    v_pk_mul_f32 v[154:155], v[154:155], v[48:49] op_sel_hi:[1,0]
    v_pk_mul_f32 v[206:207], v[206:207], v[92:93] op_sel_hi:[1,0]
    v_cvt_pk_bf16_f32 v57, v58, v59
    s_nop 0
    v_mfma_f32_16x16x32_bf16 a[32:35], a[224:227], v[32:35], a[32:35]
    ds_write2st64_b64 v102, v[236:237], v[56:57] offset0:28 offset1:40
    v_pk_mul_f32 v[150:151], v[150:151], v[48:49] op_sel_hi:[1,0]
    v_pk_mul_f32 v[242:243], v[242:243], v[50:51] op_sel_hi:[1,0]
    s_nop 1
    v_mfma_f32_16x16x32_bf16 v[244:247], a[228:231], v[28:31], v[244:247]
    s_waitcnt lgkmcnt(2)
    v_cvt_pk_bf16_f32 v193, v194, v195
    ds_read_b128 v[64:67], v103 offset:14336
    v_pk_mul_f32 v[158:159], v[158:159], v[48:49] op_sel_hi:[1,0]
    buffer_store_dwordx4 v[60:63], v7, s[16:19], s85 offen offset:128 nt
    v_cvt_pk_bf16_f32 v145, v146, v147
    v_accvgpr_read_b32 v105, a33
    v_mfma_f32_16x16x32_bf16 a[36:39], a[228:231], v[32:35], a[36:39]
    ds_read_b128 v[68:71], v103 offset:15360
    v_cvt_pk_bf16_f32 v200, v200, v201
    v_accvgpr_read_b32 v104, a32
    v_cvt_pk_bf16_f32 v196, v196, v197
    v_pk_mul_f32 v[104:105], v[104:105], v[94:95] op_sel_hi:[1,0]
    v_pk_mul_f32 v[240:241], v[240:241], v[50:51] op_sel_hi:[1,0]
    s_nop 1
    v_mfma_f32_16x16x32_bf16 v[248:251], a[232:235], v[28:31], v[248:251]
    v_cvt_pk_bf16_f32 v240, v240, v241
    ds_read_b128 v[72:75], v103 offset:20480
    v_cvt_pk_bf16_f32 v197, v198, v199
    v_pk_mul_f32 v[202:203], v[202:203], v[92:93] op_sel_hi:[1,0]
    v_pk_mul_f32 v[156:157], v[156:157], v[48:49] op_sel_hi:[1,0]
    s_nop 0
    v_cvt_pk_bf16_f32 v156, v156, v157
    s_nop 0
    v_pk_mul_f32 v[250:251], v[250:251], v[50:51] op_sel_hi:[1,0]
    v_pk_mul_f32 v[152:153], v[152:153], v[48:49] op_sel_hi:[1,0]
    v_cvt_pk_bf16_f32 v157, v158, v159
    s_waitcnt lgkmcnt(2)
    buffer_store_dwordx4 v[64:67], v6, s[16:19], s86 offen offset:128 nt
    ds_read_b128 v[76:79], v103 offset:21504
    v_mfma_f32_16x16x32_bf16 a[40:43], a[232:235], v[32:35], a[40:43]
    v_accvgpr_read_b32 v108, a36
    v_accvgpr_read_b32 v111, a39
    ds_write2st64_b64 v93, v[144:145], v[192:193] offset0:8 offset1:20
    v_cvt_pk_bf16_f32 v152, v152, v153
    v_accvgpr_read_b32 v106, a34
    v_pk_mul_f32 v[248:249], v[248:249], v[50:51] op_sel_hi:[1,0]
    s_nop 1
    v_mfma_f32_16x16x32_bf16 v[252:255], a[236:239], v[28:31], v[252:255]
    s_waitcnt lgkmcnt(3)
    v_pk_mul_f32 v[244:245], v[244:245], v[50:51] op_sel_hi:[1,0]
    buffer_store_dwordx4 v[68:71], v7, s[16:19], s86 offen offset:128 nt
    v_cvt_pk_bf16_f32 v201, v202, v203
    v_accvgpr_read_b32 v53, a41
    v_cvt_pk_bf16_f32 v153, v154, v155
    v_pk_mul_f32 v[204:205], v[204:205], v[92:93] op_sel_hi:[1,0]
    v_cvt_pk_bf16_f32 v149, v150, v151
    ds_write2st64_b64 v95, v[148:149], v[196:197] offset0:8 offset1:20
    v_accvgpr_read_b32 v54, a42
    v_cvt_pk_bf16_f32 v204, v204, v205
    v_cvt_pk_bf16_f32 v104, v104, v105
    v_accvgpr_read_b32 v52, a40
    v_accvgpr_read_b32 v109, a37
    ds_write2st64_b64 v8, v[152:153], v[200:201] offset0:8 offset1:20
    v_pk_mul_f32 v[252:253], v[252:253], v[50:51] op_sel_hi:[1,0]
    v_cvt_pk_bf16_f32 v241, v242, v243
    s_waitcnt lgkmcnt(2)
    buffer_store_dwordx4 v[72:75], v6, s[16:19], s87 offen offset:128 nt
    v_pk_mul_f32 v[254:255], v[254:255], v[50:51] op_sel_hi:[1,0]
    v_pk_mul_f32 v[52:53], v[52:53], v[94:95] op_sel_hi:[1,0]
    s_nop 1
    v_mfma_f32_16x16x32_bf16 a[44:47], a[236:239], v[32:35], a[44:47]
    v_cvt_pk_bf16_f32 v205, v206, v207
    ds_write2st64_b64 v102, v[156:157], v[204:205] offset0:8 offset1:20
    v_cvt_pk_bf16_f32 v244, v244, v245
    v_pk_mul_f32 v[108:109], v[108:109], v[94:95] op_sel_hi:[1,0]
    v_accvgpr_read_b32 v107, a35
    v_pk_mul_f32 v[246:247], v[246:247], v[50:51] op_sel_hi:[1,0]
    s_nop 1
    v_accvgpr_read_b32 v56, a44
    v_accvgpr_read_b32 v55, a43
    ds_read_b128 v[80:83], v103 offset:4096
    v_cvt_pk_bf16_f32 v108, v108, v109
    ds_read_b128 v[84:87], v103 offset:5120
    buffer_store_dwordx4 v[76:79], v7, s[16:19], s87 offen offset:128 nt
    v_accvgpr_read_b32 v59, a47
    s_waitcnt lgkmcnt(1)
    buffer_store_dwordx4 v[80:83], v6, s[16:19], s84 offen offset:256 nt
    v_accvgpr_read_b32 v57, a45
    v_pk_mul_f32 v[56:57], v[56:57], v[94:95] op_sel_hi:[1,0]
    v_pk_mul_f32 v[106:107], v[106:107], v[94:95] op_sel_hi:[1,0]
    v_accvgpr_read_b32 v58, a46
    v_cvt_pk_bf16_f32 v56, v56, v57
    ds_read_b128 v[88:91], v103 offset:10240
    ds_read_b128 v[60:63], v103 offset:11264
    v_cvt_pk_bf16_f32 v245, v246, v247
    v_pk_mul_f32 v[58:59], v[58:59], v[94:95] op_sel_hi:[1,0]
    v_pk_mul_f32 v[54:55], v[54:55], v[94:95] op_sel_hi:[1,0]
    v_cvt_pk_bf16_f32 v248, v248, v249
    v_accvgpr_read_b32 v110, a38
    v_cvt_pk_bf16_f32 v52, v52, v53
    s_waitcnt lgkmcnt(2)
    buffer_store_dwordx4 v[84:87], v7, s[16:19], s84 offen offset:256 nt
    v_cvt_pk_bf16_f32 v53, v54, v55
    v_cvt_pk_bf16_f32 v105, v106, v107
    v_pk_mul_f32 v[110:111], v[110:111], v[94:95] op_sel_hi:[1,0]
    ds_write2st64_b64 v93, v[240:241], v[104:105] offset0:32 offset1:44
    v_cvt_pk_bf16_f32 v109, v110, v111
    s_waitcnt lgkmcnt(1)
    buffer_store_dwordx4 v[88:91], v6, s[16:19], s85 offen offset:256 nt
    v_cvt_pk_bf16_f32 v249, v250, v251
    v_cvt_pk_bf16_f32 v57, v58, v59
    v_cvt_pk_bf16_f32 v252, v252, v253
    v_cvt_pk_bf16_f32 v253, v254, v255
    ds_write2st64_b64 v95, v[244:245], v[108:109] offset0:32 offset1:44
    ds_write2st64_b64 v8, v[248:249], v[52:53] offset0:32 offset1:44
    ds_write2st64_b64 v102, v[252:253], v[56:57] offset0:32 offset1:44
    ds_read_b128 v[64:67], v103 offset:16384
    ds_read_b128 v[68:71], v103 offset:17408
    ds_read_b128 v[72:75], v103 offset:22528
    ds_read_b128 v[76:79], v103 offset:23552
    buffer_store_dwordx4 v[60:63], v7, s[16:19], s85 offen offset:256 nt
    s_waitcnt lgkmcnt(3)
    buffer_store_dwordx4 v[64:67], v6, s[16:19], s86 offen offset:256 nt
    s_waitcnt lgkmcnt(0)
    buffer_store_dwordx4 v[68:71], v7, s[16:19], s86 offen offset:256 nt
    buffer_store_dwordx4 v[72:75], v6, s[16:19], s87 offen offset:256 nt
    buffer_store_dwordx4 v[76:79], v7, s[16:19], s87 offen offset:256 nt
    s_branch L_fin
L_fin:
    s_waitcnt vmcnt(0)
L_end:
    s_endpgm
L_codeend:
L_rare5_0:
    s_nop 15
    v_mov_b32 v104, 0
    v_mov_b32 v105, 0
    v_mov_b32 v106, 0
    v_mov_b32 v107, 0
    s_nop 1
    v_mfma_f32_16x16x32_bf16 v[104:107], a[248:251], v[14:17], v[104:107]
    v_smfmac_f32_16x16x64_bf16 v[104:107], a[240:243], v[22:29], v101
    v_smfmac_f32_16x16x64_bf16 v[104:107], a[244:247], v[34:41], v101
    s_nop 15
    v_sub_f32 v45, v45, v105
    v_sub_f32 v46, v46, v106
    v_sub_f32 v47, v47, v107
    v_mov_b32 v44, 0
    v_mov_b32 v48, 0
    v_mbcnt_lo_u32_b32 v31, -1, 0
    v_mbcnt_hi_u32_b32 v31, -1, v31
    v_and_b32 v30, 15, v31
    v_mul_u32_u24 v30, 384, v30
    v_lshrrev_b32 v31, 4, v31
    v_lshl_add_u32 v30, v31, 4, v30
    s_add_u32 s69, s39, 0
    buffer_load_dwordx4 v[92:95], v30, s[4:7], s69 offen offset:0
    s_waitcnt vmcnt(0)
    v_mfma_f32_16x16x32_bf16 v[104:107], v[92:95], a[96:99], 0
    s_nop 7
    buffer_load_dwordx4 v[92:95], v30, s[4:7], s69 offen offset:64
    s_waitcnt vmcnt(0)
    v_mfma_f32_16x16x32_bf16 v[104:107], v[92:95], a[100:103], v[104:107]
    s_nop 7
    buffer_load_dwordx4 v[92:95], v30, s[4:7], s69 offen offset:128
    s_waitcnt vmcnt(0)
    v_mfma_f32_16x16x32_bf16 v[104:107], v[92:95], a[104:107], v[104:107]
    s_nop 7
    buffer_load_dwordx4 v[92:95], v30, s[4:7], s69 offen offset:192
    s_waitcnt vmcnt(0)
    v_mfma_f32_16x16x32_bf16 v[104:107], v[92:95], a[108:111], v[104:107]
    s_nop 7
    buffer_load_dwordx4 v[92:95], v30, s[4:7], s69 offen offset:256
    s_waitcnt vmcnt(0)
    v_mfma_f32_16x16x32_bf16 v[104:107], v[92:95], a[112:115], v[104:107]
    s_nop 7
    buffer_load_dwordx4 v[92:95], v30, s[4:7], s69 offen offset:320
    s_waitcnt vmcnt(0)
    v_mfma_f32_16x16x32_bf16 v[104:107], v[92:95], a[116:119], v[104:107]
    s_nop 7
    s_add_u32 s69, s39, 6144
    buffer_load_dwordx4 v[92:95], v30, s[4:7], s69 offen offset:0
    s_waitcnt vmcnt(0)
    v_mfma_f32_16x16x32_bf16 v[108:111], v[92:95], a[96:99], 0
    s_nop 7
    buffer_load_dwordx4 v[92:95], v30, s[4:7], s69 offen offset:64
    s_waitcnt vmcnt(0)
    v_mfma_f32_16x16x32_bf16 v[108:111], v[92:95], a[100:103], v[108:111]
    s_nop 7
    buffer_load_dwordx4 v[92:95], v30, s[4:7], s69 offen offset:128
    s_waitcnt vmcnt(0)
    v_mfma_f32_16x16x32_bf16 v[108:111], v[92:95], a[104:107], v[108:111]
    s_nop 7
    buffer_load_dwordx4 v[92:95], v30, s[4:7], s69 offen offset:192
    s_waitcnt vmcnt(0)
    v_mfma_f32_16x16x32_bf16 v[108:111], v[92:95], a[108:111], v[108:111]
    s_nop 7
    buffer_load_dwordx4 v[92:95], v30, s[4:7], s69 offen offset:256
    s_waitcnt vmcnt(0)
    v_mfma_f32_16x16x32_bf16 v[108:111], v[92:95], a[112:115], v[108:111]
    s_nop 7
    buffer_load_dwordx4 v[92:95], v30, s[4:7], s69 offen offset:320
    s_waitcnt vmcnt(0)
    v_mfma_f32_16x16x32_bf16 v[108:111], v[92:95], a[116:119], v[108:111]
    s_nop 7
    s_nop 15
    v_max3_f32 v18, v104, v105, v106
    v_max3_f32 v18, v18, v107, v108
    v_max3_f32 v18, v18, v109, v110
    v_max_f32 v18, v18, v111
    v_mov_b32 v19, v18
    s_nop 1
    v_permlane32_swap_b32 v19, v18
    v_max_f32 v18, v18, v19
    v_mov_b32 v19, v18
    s_nop 1
    v_permlane16_swap_b32 v19, v18
    v_max_f32 v18, v18, v19
    v_fma_f32 v18, v18, s28, v9
    v_add_f32 v18, 0x42000000, v18
    v_max_f32 v20, 0, v18
    v_sub_f32 v9, v9, v20
    v_sub_f32 v21, 0, v20
    v_exp_f32 v21, v21
    s_nop 0
    v_mul_f32 v47, v47, v21
    v_mul_f32 v19, v49, v21
    v_cndmask_b32_e64 v49, v19, v49, s[46:47]
    v_mul_f32 v112, v112, v21
    v_mul_f32 v113, v113, v21
    v_mul_f32 v114, v114, v21
    v_mul_f32 v115, v115, v21
    v_mul_f32 v116, v116, v21
    v_mul_f32 v117, v117, v21
    v_mul_f32 v118, v118, v21
    v_mul_f32 v119, v119, v21
    v_mul_f32 v120, v120, v21
    v_mul_f32 v121, v121, v21
    v_mul_f32 v122, v122, v21
    v_mul_f32 v123, v123, v21
    v_mul_f32 v124, v124, v21
    v_mul_f32 v125, v125, v21
    v_mul_f32 v126, v126, v21
    v_mul_f32 v127, v127, v21
    v_mul_f32 v128, v128, v21
    v_mul_f32 v129, v129, v21
    v_mul_f32 v130, v130, v21
    v_mul_f32 v131, v131, v21
    v_mul_f32 v132, v132, v21
    v_mul_f32 v133, v133, v21
    v_mul_f32 v134, v134, v21
    v_mul_f32 v135, v135, v21
    v_mul_f32 v136, v136, v21
    v_mul_f32 v137, v137, v21
    v_mul_f32 v138, v138, v21
    v_mul_f32 v139, v139, v21
    v_mul_f32 v140, v140, v21
    v_mul_f32 v141, v141, v21
    v_mul_f32 v142, v142, v21
    v_mul_f32 v143, v143, v21
    v_mul_f32 v144, v144, v21
    v_mul_f32 v145, v145, v21
    v_mul_f32 v146, v146, v21
    v_mul_f32 v147, v147, v21
    v_mul_f32 v148, v148, v21
    v_mul_f32 v149, v149, v21
    v_mul_f32 v150, v150, v21
    v_mul_f32 v151, v151, v21
    v_mul_f32 v152, v152, v21
    v_mul_f32 v153, v153, v21
    v_mul_f32 v154, v154, v21
    v_mul_f32 v155, v155, v21
    v_mul_f32 v156, v156, v21
    v_mul_f32 v157, v157, v21
    v_mul_f32 v158, v158, v21
    v_mul_f32 v159, v159, v21
    v_fma_f32 v104, v104, s28, v9
    v_fma_f32 v105, v105, s28, v9
    v_exp_f32_e64 v104, v104 clamp
    v_exp_f32_e64 v105, v105 clamp
    s_nop 0
    v_cvt_pk_bf16_f32 v14, v104, v105
    v_fma_f32 v106, v106, s28, v9
    v_fma_f32 v107, v107, s28, v9
    v_exp_f32_e64 v106, v106 clamp
    v_exp_f32_e64 v107, v107 clamp
    s_nop 0
    v_cvt_pk_bf16_f32 v15, v106, v107
    v_fma_f32 v108, v108, s28, v9
    v_fma_f32 v109, v109, s28, v9
    v_exp_f32_e64 v108, v108 clamp
    v_exp_f32_e64 v109, v109 clamp
    s_nop 0
    v_cvt_pk_bf16_f32 v16, v108, v109
    v_fma_f32 v110, v110, s28, v9
    v_fma_f32 v111, v111, s28, v9
    v_exp_f32_e64 v110, v110 clamp
    v_exp_f32_e64 v111, v111 clamp
    s_nop 0
    v_cvt_pk_bf16_f32 v17, v110, v111
    s_add_u32 s69, s39, 0
    buffer_load_dwordx4 v[92:95], v30, s[4:7], s69 offen offset:0
    s_waitcnt vmcnt(0)
    v_mfma_f32_16x16x32_bf16 v[104:107], v[92:95], a[120:123], 0
    s_nop 7
    buffer_load_dwordx4 v[92:95], v30, s[4:7], s69 offen offset:64
    s_waitcnt vmcnt(0)
    v_mfma_f32_16x16x32_bf16 v[104:107], v[92:95], a[124:127], v[104:107]
    s_nop 7
    buffer_load_dwordx4 v[92:95], v30, s[4:7], s69 offen offset:128
    s_waitcnt vmcnt(0)
    v_mfma_f32_16x16x32_bf16 v[104:107], v[92:95], a[128:131], v[104:107]
    s_nop 7
    buffer_load_dwordx4 v[92:95], v30, s[4:7], s69 offen offset:192
    s_waitcnt vmcnt(0)
    v_mfma_f32_16x16x32_bf16 v[104:107], v[92:95], a[132:135], v[104:107]
    s_nop 7
    buffer_load_dwordx4 v[92:95], v30, s[4:7], s69 offen offset:256
    s_waitcnt vmcnt(0)
    v_mfma_f32_16x16x32_bf16 v[104:107], v[92:95], a[136:139], v[104:107]
    s_nop 7
    buffer_load_dwordx4 v[92:95], v30, s[4:7], s69 offen offset:320
    s_waitcnt vmcnt(0)
    v_mfma_f32_16x16x32_bf16 v[104:107], v[92:95], a[140:143], v[104:107]
    s_nop 7
    s_add_u32 s69, s39, 6144
    buffer_load_dwordx4 v[92:95], v30, s[4:7], s69 offen offset:0
    s_waitcnt vmcnt(0)
    v_mfma_f32_16x16x32_bf16 v[108:111], v[92:95], a[120:123], 0
    s_nop 7
    buffer_load_dwordx4 v[92:95], v30, s[4:7], s69 offen offset:64
    s_waitcnt vmcnt(0)
    v_mfma_f32_16x16x32_bf16 v[108:111], v[92:95], a[124:127], v[108:111]
    s_nop 7
    buffer_load_dwordx4 v[92:95], v30, s[4:7], s69 offen offset:128
    s_waitcnt vmcnt(0)
    v_mfma_f32_16x16x32_bf16 v[108:111], v[92:95], a[128:131], v[108:111]
    s_nop 7
    buffer_load_dwordx4 v[92:95], v30, s[4:7], s69 offen offset:192
    s_waitcnt vmcnt(0)
    v_mfma_f32_16x16x32_bf16 v[108:111], v[92:95], a[132:135], v[108:111]
    s_nop 7
    buffer_load_dwordx4 v[92:95], v30, s[4:7], s69 offen offset:256
    s_waitcnt vmcnt(0)
    v_mfma_f32_16x16x32_bf16 v[108:111], v[92:95], a[136:139], v[108:111]
    s_nop 7
    buffer_load_dwordx4 v[92:95], v30, s[4:7], s69 offen offset:320
    s_waitcnt vmcnt(0)
    v_mfma_f32_16x16x32_bf16 v[108:111], v[92:95], a[140:143], v[108:111]
    s_nop 7
    s_nop 15
    v_max3_f32 v18, v104, v105, v106
    v_max3_f32 v18, v18, v107, v108
    v_max3_f32 v18, v18, v109, v110
    v_max_f32 v18, v18, v111
    v_mov_b32 v19, v18
    s_nop 1
    v_permlane32_swap_b32 v19, v18
    v_max_f32 v18, v18, v19
    v_mov_b32 v19, v18
    s_nop 1
    v_permlane16_swap_b32 v19, v18
    v_max_f32 v18, v18, v19
    v_fma_f32 v18, v18, s28, v10
    v_add_f32 v18, 0x42000000, v18
    v_max_f32 v20, 0, v18
    v_sub_f32 v10, v10, v20
    v_sub_f32 v21, 0, v20
    v_exp_f32 v21, v21
    s_nop 0
    v_mul_f32 v19, v45, v21
    v_cndmask_b32_e64 v45, v19, v45, s[46:47]
    v_mul_f32 v19, v49, v21
    v_cndmask_b32_e64 v49, v49, v19, s[46:47]
    v_mul_f32 v160, v160, v21
    v_mul_f32 v161, v161, v21
    v_mul_f32 v162, v162, v21
    v_mul_f32 v163, v163, v21
    v_mul_f32 v164, v164, v21
    v_mul_f32 v165, v165, v21
    v_mul_f32 v166, v166, v21
    v_mul_f32 v167, v167, v21
    v_mul_f32 v168, v168, v21
    v_mul_f32 v169, v169, v21
    v_mul_f32 v170, v170, v21
    v_mul_f32 v171, v171, v21
    v_mul_f32 v172, v172, v21
    v_mul_f32 v173, v173, v21
    v_mul_f32 v174, v174, v21
    v_mul_f32 v175, v175, v21
    v_mul_f32 v176, v176, v21
    v_mul_f32 v177, v177, v21
    v_mul_f32 v178, v178, v21
    v_mul_f32 v179, v179, v21
    v_mul_f32 v180, v180, v21
    v_mul_f32 v181, v181, v21
    v_mul_f32 v182, v182, v21
    v_mul_f32 v183, v183, v21
    v_mul_f32 v184, v184, v21
    v_mul_f32 v185, v185, v21
    v_mul_f32 v186, v186, v21
    v_mul_f32 v187, v187, v21
    v_mul_f32 v188, v188, v21
    v_mul_f32 v189, v189, v21
    v_mul_f32 v190, v190, v21
    v_mul_f32 v191, v191, v21
    v_mul_f32 v192, v192, v21
    v_mul_f32 v193, v193, v21
    v_mul_f32 v194, v194, v21
    v_mul_f32 v195, v195, v21
    v_mul_f32 v196, v196, v21
    v_mul_f32 v197, v197, v21
    v_mul_f32 v198, v198, v21
    v_mul_f32 v199, v199, v21
    v_mul_f32 v200, v200, v21
    v_mul_f32 v201, v201, v21
    v_mul_f32 v202, v202, v21
    v_mul_f32 v203, v203, v21
    v_mul_f32 v204, v204, v21
    v_mul_f32 v205, v205, v21
    v_mul_f32 v206, v206, v21
    v_mul_f32 v207, v207, v21
    v_fma_f32 v104, v104, s28, v10
    v_fma_f32 v105, v105, s28, v10
    v_exp_f32_e64 v104, v104 clamp
    v_exp_f32_e64 v105, v105 clamp
    s_nop 0
    v_cvt_pk_bf16_f32 v22, v104, v105
    v_fma_f32 v106, v106, s28, v10
    v_fma_f32 v107, v107, s28, v10
    v_exp_f32_e64 v106, v106 clamp
    v_exp_f32_e64 v107, v107 clamp
    s_nop 0
    v_cvt_pk_bf16_f32 v23, v106, v107
    v_fma_f32 v108, v108, s28, v10
    v_fma_f32 v109, v109, s28, v10
    v_exp_f32_e64 v108, v108 clamp
    v_exp_f32_e64 v109, v109 clamp
    s_nop 0
    v_cvt_pk_bf16_f32 v24, v108, v109
    v_fma_f32 v110, v110, s28, v10
    v_fma_f32 v111, v111, s28, v10
    v_exp_f32_e64 v110, v110 clamp
    v_exp_f32_e64 v111, v111 clamp
    s_nop 0
    v_cvt_pk_bf16_f32 v25, v110, v111
    s_add_u32 s69, s39, 0
    buffer_load_dwordx4 v[92:95], v30, s[4:7], s69 offen offset:0
    s_waitcnt vmcnt(0)
    v_mfma_f32_16x16x32_bf16 v[104:107], v[92:95], a[144:147], 0
    s_nop 7
    buffer_load_dwordx4 v[92:95], v30, s[4:7], s69 offen offset:64
    s_waitcnt vmcnt(0)
    v_mfma_f32_16x16x32_bf16 v[104:107], v[92:95], a[148:151], v[104:107]
    s_nop 7
    buffer_load_dwordx4 v[92:95], v30, s[4:7], s69 offen offset:128
    s_waitcnt vmcnt(0)
    v_mfma_f32_16x16x32_bf16 v[104:107], v[92:95], a[152:155], v[104:107]
    s_nop 7
    buffer_load_dwordx4 v[92:95], v30, s[4:7], s69 offen offset:192
    s_waitcnt vmcnt(0)
    v_mfma_f32_16x16x32_bf16 v[104:107], v[92:95], a[156:159], v[104:107]
    s_nop 7
    buffer_load_dwordx4 v[92:95], v30, s[4:7], s69 offen offset:256
    s_waitcnt vmcnt(0)
    v_mfma_f32_16x16x32_bf16 v[104:107], v[92:95], a[160:163], v[104:107]
    s_nop 7
    buffer_load_dwordx4 v[92:95], v30, s[4:7], s69 offen offset:320
    s_waitcnt vmcnt(0)
    v_mfma_f32_16x16x32_bf16 v[104:107], v[92:95], a[164:167], v[104:107]
    s_nop 7
    s_add_u32 s69, s39, 6144
    buffer_load_dwordx4 v[92:95], v30, s[4:7], s69 offen offset:0
    s_waitcnt vmcnt(0)
    v_mfma_f32_16x16x32_bf16 v[108:111], v[92:95], a[144:147], 0
    s_nop 7
    buffer_load_dwordx4 v[92:95], v30, s[4:7], s69 offen offset:64
    s_waitcnt vmcnt(0)
    v_mfma_f32_16x16x32_bf16 v[108:111], v[92:95], a[148:151], v[108:111]
    s_nop 7
    buffer_load_dwordx4 v[92:95], v30, s[4:7], s69 offen offset:128
    s_waitcnt vmcnt(0)
    v_mfma_f32_16x16x32_bf16 v[108:111], v[92:95], a[152:155], v[108:111]
    s_nop 7
    buffer_load_dwordx4 v[92:95], v30, s[4:7], s69 offen offset:192
    s_waitcnt vmcnt(0)
    v_mfma_f32_16x16x32_bf16 v[108:111], v[92:95], a[156:159], v[108:111]
    s_nop 7
    buffer_load_dwordx4 v[92:95], v30, s[4:7], s69 offen offset:256
    s_waitcnt vmcnt(0)
    v_mfma_f32_16x16x32_bf16 v[108:111], v[92:95], a[160:163], v[108:111]
    s_nop 7
    buffer_load_dwordx4 v[92:95], v30, s[4:7], s69 offen offset:320
    s_waitcnt vmcnt(0)
    v_mfma_f32_16x16x32_bf16 v[108:111], v[92:95], a[164:167], v[108:111]
    s_nop 7
    s_nop 15
    v_max3_f32 v18, v104, v105, v106
    v_max3_f32 v18, v18, v107, v108
    v_max3_f32 v18, v18, v109, v110
    v_max_f32 v18, v18, v111
    v_mov_b32 v19, v18
    s_nop 1
    v_permlane32_swap_b32 v19, v18
    v_max_f32 v18, v18, v19
    v_mov_b32 v19, v18
    s_nop 1
    v_permlane16_swap_b32 v19, v18
    v_max_f32 v18, v18, v19
    v_fma_f32 v18, v18, s28, v11
    v_add_f32 v18, 0x42000000, v18
    v_max_f32 v20, 0, v18
    v_sub_f32 v11, v11, v20
    v_sub_f32 v21, 0, v20
    v_exp_f32 v21, v21
    s_nop 0
    v_mul_f32 v19, v45, v21
    v_cndmask_b32_e64 v45, v45, v19, s[46:47]
    v_mul_f32 v19, v50, v21
    v_cndmask_b32_e64 v50, v19, v50, s[46:47]
    v_mul_f32 v208, v208, v21
    v_mul_f32 v209, v209, v21
    v_mul_f32 v210, v210, v21
    v_mul_f32 v211, v211, v21
    v_mul_f32 v212, v212, v21
    v_mul_f32 v213, v213, v21
    v_mul_f32 v214, v214, v21
    v_mul_f32 v215, v215, v21
    v_mul_f32 v216, v216, v21
    v_mul_f32 v217, v217, v21
    v_mul_f32 v218, v218, v21
    v_mul_f32 v219, v219, v21
    v_mul_f32 v220, v220, v21
    v_mul_f32 v221, v221, v21
    v_mul_f32 v222, v222, v21
    v_mul_f32 v223, v223, v21
    v_mul_f32 v224, v224, v21
    v_mul_f32 v225, v225, v21
    v_mul_f32 v226, v226, v21
    v_mul_f32 v227, v227, v21
    v_mul_f32 v228, v228, v21
    v_mul_f32 v229, v229, v21
    v_mul_f32 v230, v230, v21
    v_mul_f32 v231, v231, v21
    v_mul_f32 v232, v232, v21
    v_mul_f32 v233, v233, v21
    v_mul_f32 v234, v234, v21
    v_mul_f32 v235, v235, v21
    v_mul_f32 v236, v236, v21
    v_mul_f32 v237, v237, v21
    v_mul_f32 v238, v238, v21
    v_mul_f32 v239, v239, v21
    v_mul_f32 v240, v240, v21
    v_mul_f32 v241, v241, v21
    v_mul_f32 v242, v242, v21
    v_mul_f32 v243, v243, v21
    v_mul_f32 v244, v244, v21
    v_mul_f32 v245, v245, v21
    v_mul_f32 v246, v246, v21
    v_mul_f32 v247, v247, v21
    v_mul_f32 v248, v248, v21
    v_mul_f32 v249, v249, v21
    v_mul_f32 v250, v250, v21
    v_mul_f32 v251, v251, v21
    v_mul_f32 v252, v252, v21
    v_mul_f32 v253, v253, v21
    v_mul_f32 v254, v254, v21
    v_mul_f32 v255, v255, v21
    v_fma_f32 v104, v104, s28, v11
    v_fma_f32 v105, v105, s28, v11
    v_exp_f32_e64 v104, v104 clamp
    v_exp_f32_e64 v105, v105 clamp
    s_nop 0
    v_cvt_pk_bf16_f32 v26, v104, v105
    v_fma_f32 v106, v106, s28, v11
    v_fma_f32 v107, v107, s28, v11
    v_exp_f32_e64 v106, v106 clamp
    v_exp_f32_e64 v107, v107 clamp
    s_nop 0
    v_cvt_pk_bf16_f32 v27, v106, v107
    v_fma_f32 v108, v108, s28, v11
    v_fma_f32 v109, v109, s28, v11
    v_exp_f32_e64 v108, v108 clamp
    v_exp_f32_e64 v109, v109 clamp
    s_nop 0
    v_cvt_pk_bf16_f32 v28, v108, v109
    v_fma_f32 v110, v110, s28, v11
    v_fma_f32 v111, v111, s28, v11
    v_exp_f32_e64 v110, v110 clamp
    v_exp_f32_e64 v111, v111 clamp
    s_nop 0
    v_cvt_pk_bf16_f32 v29, v110, v111
    s_add_u32 s69, s39, 0
    buffer_load_dwordx4 v[92:95], v30, s[4:7], s69 offen offset:0
    s_waitcnt vmcnt(0)
    v_mfma_f32_16x16x32_bf16 v[104:107], v[92:95], a[168:171], 0
    s_nop 7
    buffer_load_dwordx4 v[92:95], v30, s[4:7], s69 offen offset:64
    s_waitcnt vmcnt(0)
    v_mfma_f32_16x16x32_bf16 v[104:107], v[92:95], a[172:175], v[104:107]
    s_nop 7
    buffer_load_dwordx4 v[92:95], v30, s[4:7], s69 offen offset:128
    s_waitcnt vmcnt(0)
    v_mfma_f32_16x16x32_bf16 v[104:107], v[92:95], a[176:179], v[104:107]
    s_nop 7
    buffer_load_dwordx4 v[92:95], v30, s[4:7], s69 offen offset:192
    s_waitcnt vmcnt(0)
    v_mfma_f32_16x16x32_bf16 v[104:107], v[92:95], a[180:183], v[104:107]
    s_nop 7
    buffer_load_dwordx4 v[92:95], v30, s[4:7], s69 offen offset:256
    s_waitcnt vmcnt(0)
    v_mfma_f32_16x16x32_bf16 v[104:107], v[92:95], a[184:187], v[104:107]
    s_nop 7
    buffer_load_dwordx4 v[92:95], v30, s[4:7], s69 offen offset:320
    s_waitcnt vmcnt(0)
    v_mfma_f32_16x16x32_bf16 v[104:107], v[92:95], a[188:191], v[104:107]
    s_nop 7
    s_add_u32 s69, s39, 6144
    buffer_load_dwordx4 v[92:95], v30, s[4:7], s69 offen offset:0
    s_waitcnt vmcnt(0)
    v_mfma_f32_16x16x32_bf16 v[108:111], v[92:95], a[168:171], 0
    s_nop 7
    buffer_load_dwordx4 v[92:95], v30, s[4:7], s69 offen offset:64
    s_waitcnt vmcnt(0)
    v_mfma_f32_16x16x32_bf16 v[108:111], v[92:95], a[172:175], v[108:111]
    s_nop 7
    buffer_load_dwordx4 v[92:95], v30, s[4:7], s69 offen offset:128
    s_waitcnt vmcnt(0)
    v_mfma_f32_16x16x32_bf16 v[108:111], v[92:95], a[176:179], v[108:111]
    s_nop 7
    buffer_load_dwordx4 v[92:95], v30, s[4:7], s69 offen offset:192
    s_waitcnt vmcnt(0)
    v_mfma_f32_16x16x32_bf16 v[108:111], v[92:95], a[180:183], v[108:111]
    s_nop 7
    buffer_load_dwordx4 v[92:95], v30, s[4:7], s69 offen offset:256
    s_waitcnt vmcnt(0)
    v_mfma_f32_16x16x32_bf16 v[108:111], v[92:95], a[184:187], v[108:111]
    s_nop 7
    buffer_load_dwordx4 v[92:95], v30, s[4:7], s69 offen offset:320
    s_waitcnt vmcnt(0)
    v_mfma_f32_16x16x32_bf16 v[108:111], v[92:95], a[188:191], v[108:111]
    s_nop 7
    s_nop 15
    v_max3_f32 v18, v104, v105, v106
    v_max3_f32 v18, v18, v107, v108
    v_max3_f32 v18, v18, v109, v110
    v_max_f32 v18, v18, v111
    v_mov_b32 v19, v18
    s_nop 1
    v_permlane32_swap_b32 v19, v18
    v_max_f32 v18, v18, v19
    v_mov_b32 v19, v18
    s_nop 1
    v_permlane16_swap_b32 v19, v18
    v_max_f32 v18, v18, v19
    v_fma_f32 v18, v18, s28, v12
    v_add_f32 v18, 0x42000000, v18
    v_max_f32 v20, 0, v18
    v_sub_f32 v12, v12, v20
    v_sub_f32 v21, 0, v20
    v_exp_f32 v21, v21
    s_nop 0
    v_mul_f32 v19, v46, v21
    v_cndmask_b32_e64 v46, v19, v46, s[46:47]
    v_mul_f32 v19, v50, v21
    v_cndmask_b32_e64 v50, v50, v19, s[46:47]
    v_accvgpr_read_b32 v19, a0
    v_mul_f32 v19, v19, v21
    v_accvgpr_write_b32 a0, v19
    v_accvgpr_read_b32 v19, a1
    v_mul_f32 v19, v19, v21
    v_accvgpr_write_b32 a1, v19
    v_accvgpr_read_b32 v19, a2
    v_mul_f32 v19, v19, v21
    v_accvgpr_write_b32 a2, v19
    v_accvgpr_read_b32 v19, a3
    v_mul_f32 v19, v19, v21
    v_accvgpr_write_b32 a3, v19
    v_accvgpr_read_b32 v19, a4
    v_mul_f32 v19, v19, v21
    v_accvgpr_write_b32 a4, v19
    v_accvgpr_read_b32 v19, a5
    v_mul_f32 v19, v19, v21
    v_accvgpr_write_b32 a5, v19
    v_accvgpr_read_b32 v19, a6
    v_mul_f32 v19, v19, v21
    v_accvgpr_write_b32 a6, v19
    v_accvgpr_read_b32 v19, a7
    v_mul_f32 v19, v19, v21
    v_accvgpr_write_b32 a7, v19
    v_accvgpr_read_b32 v19, a8
    v_mul_f32 v19, v19, v21
    v_accvgpr_write_b32 a8, v19
    v_accvgpr_read_b32 v19, a9
    v_mul_f32 v19, v19, v21
    v_accvgpr_write_b32 a9, v19
    v_accvgpr_read_b32 v19, a10
    v_mul_f32 v19, v19, v21
    v_accvgpr_write_b32 a10, v19
    v_accvgpr_read_b32 v19, a11
    v_mul_f32 v19, v19, v21
    v_accvgpr_write_b32 a11, v19
    v_accvgpr_read_b32 v19, a12
    v_mul_f32 v19, v19, v21
    v_accvgpr_write_b32 a12, v19
    v_accvgpr_read_b32 v19, a13
    v_mul_f32 v19, v19, v21
    v_accvgpr_write_b32 a13, v19
    v_accvgpr_read_b32 v19, a14
    v_mul_f32 v19, v19, v21
    v_accvgpr_write_b32 a14, v19
    v_accvgpr_read_b32 v19, a15
    v_mul_f32 v19, v19, v21
    v_accvgpr_write_b32 a15, v19
    v_accvgpr_read_b32 v19, a16
    v_mul_f32 v19, v19, v21
    v_accvgpr_write_b32 a16, v19
    v_accvgpr_read_b32 v19, a17
    v_mul_f32 v19, v19, v21
    v_accvgpr_write_b32 a17, v19
    v_accvgpr_read_b32 v19, a18
    v_mul_f32 v19, v19, v21
    v_accvgpr_write_b32 a18, v19
    v_accvgpr_read_b32 v19, a19
    v_mul_f32 v19, v19, v21
    v_accvgpr_write_b32 a19, v19
    v_accvgpr_read_b32 v19, a20
    v_mul_f32 v19, v19, v21
    v_accvgpr_write_b32 a20, v19
    v_accvgpr_read_b32 v19, a21
    v_mul_f32 v19, v19, v21
    v_accvgpr_write_b32 a21, v19
    v_accvgpr_read_b32 v19, a22
    v_mul_f32 v19, v19, v21
    v_accvgpr_write_b32 a22, v19
    v_accvgpr_read_b32 v19, a23
    v_mul_f32 v19, v19, v21
    v_accvgpr_write_b32 a23, v19
    v_accvgpr_read_b32 v19, a24
    v_mul_f32 v19, v19, v21
    v_accvgpr_write_b32 a24, v19
    v_accvgpr_read_b32 v19, a25
    v_mul_f32 v19, v19, v21
    v_accvgpr_write_b32 a25, v19
    v_accvgpr_read_b32 v19, a26
    v_mul_f32 v19, v19, v21
    v_accvgpr_write_b32 a26, v19
    v_accvgpr_read_b32 v19, a27
    v_mul_f32 v19, v19, v21
    v_accvgpr_write_b32 a27, v19
    v_accvgpr_read_b32 v19, a28
    v_mul_f32 v19, v19, v21
    v_accvgpr_write_b32 a28, v19
    v_accvgpr_read_b32 v19, a29
    v_mul_f32 v19, v19, v21
    v_accvgpr_write_b32 a29, v19
    v_accvgpr_read_b32 v19, a30
    v_mul_f32 v19, v19, v21
    v_accvgpr_write_b32 a30, v19
    v_accvgpr_read_b32 v19, a31
    v_mul_f32 v19, v19, v21
    v_accvgpr_write_b32 a31, v19
    v_accvgpr_read_b32 v19, a32
    v_mul_f32 v19, v19, v21
    v_accvgpr_write_b32 a32, v19
    v_accvgpr_read_b32 v19, a33
    v_mul_f32 v19, v19, v21
    v_accvgpr_write_b32 a33, v19
    v_accvgpr_read_b32 v19, a34
    v_mul_f32 v19, v19, v21
    v_accvgpr_write_b32 a34, v19
    v_accvgpr_read_b32 v19, a35
    v_mul_f32 v19, v19, v21
    v_accvgpr_write_b32 a35, v19
    v_accvgpr_read_b32 v19, a36
    v_mul_f32 v19, v19, v21
    v_accvgpr_write_b32 a36, v19
    v_accvgpr_read_b32 v19, a37
    v_mul_f32 v19, v19, v21
    v_accvgpr_write_b32 a37, v19
    v_accvgpr_read_b32 v19, a38
    v_mul_f32 v19, v19, v21
    v_accvgpr_write_b32 a38, v19
    v_accvgpr_read_b32 v19, a39
    v_mul_f32 v19, v19, v21
    v_accvgpr_write_b32 a39, v19
    v_accvgpr_read_b32 v19, a40
    v_mul_f32 v19, v19, v21
    v_accvgpr_write_b32 a40, v19
    v_accvgpr_read_b32 v19, a41
    v_mul_f32 v19, v19, v21
    v_accvgpr_write_b32 a41, v19
    v_accvgpr_read_b32 v19, a42
    v_mul_f32 v19, v19, v21
    v_accvgpr_write_b32 a42, v19
    v_accvgpr_read_b32 v19, a43
    v_mul_f32 v19, v19, v21
    v_accvgpr_write_b32 a43, v19
    v_accvgpr_read_b32 v19, a44
    v_mul_f32 v19, v19, v21
    v_accvgpr_write_b32 a44, v19
    v_accvgpr_read_b32 v19, a45
    v_mul_f32 v19, v19, v21
    v_accvgpr_write_b32 a45, v19
    v_accvgpr_read_b32 v19, a46
    v_mul_f32 v19, v19, v21
    v_accvgpr_write_b32 a46, v19
    v_accvgpr_read_b32 v19, a47
    v_mul_f32 v19, v19, v21
    v_accvgpr_write_b32 a47, v19
    v_fma_f32 v104, v104, s28, v12
    v_fma_f32 v105, v105, s28, v12
    v_exp_f32_e64 v104, v104 clamp
    v_exp_f32_e64 v105, v105 clamp
    s_nop 0
    v_cvt_pk_bf16_f32 v34, v104, v105
    v_fma_f32 v106, v106, s28, v12
    v_fma_f32 v107, v107, s28, v12
    v_exp_f32_e64 v106, v106 clamp
    v_exp_f32_e64 v107, v107 clamp
    s_nop 0
    v_cvt_pk_bf16_f32 v35, v106, v107
    v_fma_f32 v108, v108, s28, v12
    v_fma_f32 v109, v109, s28, v12
    v_exp_f32_e64 v108, v108 clamp
    v_exp_f32_e64 v109, v109 clamp
    s_nop 0
    v_cvt_pk_bf16_f32 v36, v108, v109
    v_fma_f32 v110, v110, s28, v12
    v_fma_f32 v111, v111, s28, v12
    v_exp_f32_e64 v110, v110 clamp
    v_exp_f32_e64 v111, v111 clamp
    s_nop 0
    v_cvt_pk_bf16_f32 v37, v110, v111
    s_add_u32 s69, s39, 0
    buffer_load_dwordx4 v[92:95], v30, s[4:7], s69 offen offset:0
    s_waitcnt vmcnt(0)
    v_mfma_f32_16x16x32_bf16 v[104:107], v[92:95], a[192:195], 0
    s_nop 7
    buffer_load_dwordx4 v[92:95], v30, s[4:7], s69 offen offset:64
    s_waitcnt vmcnt(0)
    v_mfma_f32_16x16x32_bf16 v[104:107], v[92:95], a[196:199], v[104:107]
    s_nop 7
    buffer_load_dwordx4 v[92:95], v30, s[4:7], s69 offen offset:128
    s_waitcnt vmcnt(0)
    v_mfma_f32_16x16x32_bf16 v[104:107], v[92:95], a[200:203], v[104:107]
    s_nop 7
    buffer_load_dwordx4 v[92:95], v30, s[4:7], s69 offen offset:192
    s_waitcnt vmcnt(0)
    v_mfma_f32_16x16x32_bf16 v[104:107], v[92:95], a[204:207], v[104:107]
    s_nop 7
    buffer_load_dwordx4 v[92:95], v30, s[4:7], s69 offen offset:256
    s_waitcnt vmcnt(0)
    v_mfma_f32_16x16x32_bf16 v[104:107], v[92:95], a[208:211], v[104:107]
    s_nop 7
    buffer_load_dwordx4 v[92:95], v30, s[4:7], s69 offen offset:320
    s_waitcnt vmcnt(0)
    v_mfma_f32_16x16x32_bf16 v[104:107], v[92:95], a[212:215], v[104:107]
    s_nop 7
    s_add_u32 s69, s39, 6144
    buffer_load_dwordx4 v[92:95], v30, s[4:7], s69 offen offset:0
    s_waitcnt vmcnt(0)
    v_mfma_f32_16x16x32_bf16 v[108:111], v[92:95], a[192:195], 0
    s_nop 7
    buffer_load_dwordx4 v[92:95], v30, s[4:7], s69 offen offset:64
    s_waitcnt vmcnt(0)
    v_mfma_f32_16x16x32_bf16 v[108:111], v[92:95], a[196:199], v[108:111]
    s_nop 7
    buffer_load_dwordx4 v[92:95], v30, s[4:7], s69 offen offset:128
    s_waitcnt vmcnt(0)
    v_mfma_f32_16x16x32_bf16 v[108:111], v[92:95], a[200:203], v[108:111]
    s_nop 7
    buffer_load_dwordx4 v[92:95], v30, s[4:7], s69 offen offset:192
    s_waitcnt vmcnt(0)
    v_mfma_f32_16x16x32_bf16 v[108:111], v[92:95], a[204:207], v[108:111]
    s_nop 7
    buffer_load_dwordx4 v[92:95], v30, s[4:7], s69 offen offset:256
    s_waitcnt vmcnt(0)
    v_mfma_f32_16x16x32_bf16 v[108:111], v[92:95], a[208:211], v[108:111]
    s_nop 7
    buffer_load_dwordx4 v[92:95], v30, s[4:7], s69 offen offset:320
    s_waitcnt vmcnt(0)
    v_mfma_f32_16x16x32_bf16 v[108:111], v[92:95], a[212:215], v[108:111]
    s_nop 7
    s_nop 15
    v_max3_f32 v18, v104, v105, v106
    v_max3_f32 v18, v18, v107, v108
    v_max3_f32 v18, v18, v109, v110
    v_max_f32 v18, v18, v111
    v_mov_b32 v19, v18
    s_nop 1
    v_permlane32_swap_b32 v19, v18
    v_max_f32 v18, v18, v19
    v_mov_b32 v19, v18
    s_nop 1
    v_permlane16_swap_b32 v19, v18
    v_max_f32 v18, v18, v19
    v_fma_f32 v18, v18, s28, v13
    v_add_f32 v18, 0x42000000, v18
    v_max_f32 v20, 0, v18
    v_sub_f32 v13, v13, v20
    v_sub_f32 v21, 0, v20
    v_exp_f32 v21, v21
    s_nop 0
    v_mul_f32 v19, v46, v21
    v_cndmask_b32_e64 v46, v46, v19, s[46:47]
    v_mul_f32 v51, v51, v21
    v_accvgpr_read_b32 v19, a48
    v_mul_f32 v19, v19, v21
    v_accvgpr_write_b32 a48, v19
    v_accvgpr_read_b32 v19, a49
    v_mul_f32 v19, v19, v21
    v_accvgpr_write_b32 a49, v19
    v_accvgpr_read_b32 v19, a50
    v_mul_f32 v19, v19, v21
    v_accvgpr_write_b32 a50, v19
    v_accvgpr_read_b32 v19, a51
    v_mul_f32 v19, v19, v21
    v_accvgpr_write_b32 a51, v19
    v_accvgpr_read_b32 v19, a52
    v_mul_f32 v19, v19, v21
    v_accvgpr_write_b32 a52, v19
    v_accvgpr_read_b32 v19, a53
    v_mul_f32 v19, v19, v21
    v_accvgpr_write_b32 a53, v19
    v_accvgpr_read_b32 v19, a54
    v_mul_f32 v19, v19, v21
    v_accvgpr_write_b32 a54, v19
    v_accvgpr_read_b32 v19, a55
    v_mul_f32 v19, v19, v21
    v_accvgpr_write_b32 a55, v19
    v_accvgpr_read_b32 v19, a56
    v_mul_f32 v19, v19, v21
    v_accvgpr_write_b32 a56, v19
    v_accvgpr_read_b32 v19, a57
    v_mul_f32 v19, v19, v21
    v_accvgpr_write_b32 a57, v19
    v_accvgpr_read_b32 v19, a58
    v_mul_f32 v19, v19, v21
    v_accvgpr_write_b32 a58, v19
    v_accvgpr_read_b32 v19, a59
    v_mul_f32 v19, v19, v21
    v_accvgpr_write_b32 a59, v19
    v_accvgpr_read_b32 v19, a60
    v_mul_f32 v19, v19, v21
    v_accvgpr_write_b32 a60, v19
    v_accvgpr_read_b32 v19, a61
    v_mul_f32 v19, v19, v21
    v_accvgpr_write_b32 a61, v19
    v_accvgpr_read_b32 v19, a62
    v_mul_f32 v19, v19, v21
    v_accvgpr_write_b32 a62, v19
    v_accvgpr_read_b32 v19, a63
    v_mul_f32 v19, v19, v21
    v_accvgpr_write_b32 a63, v19
    v_accvgpr_read_b32 v19, a64
    v_mul_f32 v19, v19, v21
    v_accvgpr_write_b32 a64, v19
    v_accvgpr_read_b32 v19, a65
    v_mul_f32 v19, v19, v21
    v_accvgpr_write_b32 a65, v19
    v_accvgpr_read_b32 v19, a66
    v_mul_f32 v19, v19, v21
    v_accvgpr_write_b32 a66, v19
    v_accvgpr_read_b32 v19, a67
    v_mul_f32 v19, v19, v21
    v_accvgpr_write_b32 a67, v19
    v_accvgpr_read_b32 v19, a68
    v_mul_f32 v19, v19, v21
    v_accvgpr_write_b32 a68, v19
    v_accvgpr_read_b32 v19, a69
    v_mul_f32 v19, v19, v21
    v_accvgpr_write_b32 a69, v19
    v_accvgpr_read_b32 v19, a70
    v_mul_f32 v19, v19, v21
    v_accvgpr_write_b32 a70, v19
    v_accvgpr_read_b32 v19, a71
    v_mul_f32 v19, v19, v21
    v_accvgpr_write_b32 a71, v19
    v_accvgpr_read_b32 v19, a72
    v_mul_f32 v19, v19, v21
    v_accvgpr_write_b32 a72, v19
    v_accvgpr_read_b32 v19, a73
    v_mul_f32 v19, v19, v21
    v_accvgpr_write_b32 a73, v19
    v_accvgpr_read_b32 v19, a74
    v_mul_f32 v19, v19, v21
    v_accvgpr_write_b32 a74, v19
    v_accvgpr_read_b32 v19, a75
    v_mul_f32 v19, v19, v21
    v_accvgpr_write_b32 a75, v19
    v_accvgpr_read_b32 v19, a76
    v_mul_f32 v19, v19, v21
    v_accvgpr_write_b32 a76, v19
    v_accvgpr_read_b32 v19, a77
    v_mul_f32 v19, v19, v21
    v_accvgpr_write_b32 a77, v19
    v_accvgpr_read_b32 v19, a78
    v_mul_f32 v19, v19, v21
    v_accvgpr_write_b32 a78, v19
    v_accvgpr_read_b32 v19, a79
    v_mul_f32 v19, v19, v21
    v_accvgpr_write_b32 a79, v19
    v_accvgpr_read_b32 v19, a80
    v_mul_f32 v19, v19, v21
    v_accvgpr_write_b32 a80, v19
    v_accvgpr_read_b32 v19, a81
    v_mul_f32 v19, v19, v21
    v_accvgpr_write_b32 a81, v19
    v_accvgpr_read_b32 v19, a82
    v_mul_f32 v19, v19, v21
    v_accvgpr_write_b32 a82, v19
    v_accvgpr_read_b32 v19, a83
    v_mul_f32 v19, v19, v21
    v_accvgpr_write_b32 a83, v19
    v_accvgpr_read_b32 v19, a84
    v_mul_f32 v19, v19, v21
    v_accvgpr_write_b32 a84, v19
    v_accvgpr_read_b32 v19, a85
    v_mul_f32 v19, v19, v21
    v_accvgpr_write_b32 a85, v19
    v_accvgpr_read_b32 v19, a86
    v_mul_f32 v19, v19, v21
    v_accvgpr_write_b32 a86, v19
    v_accvgpr_read_b32 v19, a87
    v_mul_f32 v19, v19, v21
    v_accvgpr_write_b32 a87, v19
    v_accvgpr_read_b32 v19, a88
    v_mul_f32 v19, v19, v21
    v_accvgpr_write_b32 a88, v19
    v_accvgpr_read_b32 v19, a89
    v_mul_f32 v19, v19, v21
    v_accvgpr_write_b32 a89, v19
    v_accvgpr_read_b32 v19, a90
    v_mul_f32 v19, v19, v21
    v_accvgpr_write_b32 a90, v19
    v_accvgpr_read_b32 v19, a91
    v_mul_f32 v19, v19, v21
    v_accvgpr_write_b32 a91, v19
    v_accvgpr_read_b32 v19, a92
    v_mul_f32 v19, v19, v21
    v_accvgpr_write_b32 a92, v19
    v_accvgpr_read_b32 v19, a93
    v_mul_f32 v19, v19, v21
    v_accvgpr_write_b32 a93, v19
    v_accvgpr_read_b32 v19, a94
    v_mul_f32 v19, v19, v21
    v_accvgpr_write_b32 a94, v19
    v_accvgpr_read_b32 v19, a95
    v_mul_f32 v19, v19, v21
    v_accvgpr_write_b32 a95, v19
    v_fma_f32 v104, v104, s28, v13
    v_fma_f32 v105, v105, s28, v13
    v_exp_f32_e64 v104, v104 clamp
    v_exp_f32_e64 v105, v105 clamp
    s_nop 0
    v_cvt_pk_bf16_f32 v38, v104, v105
    v_fma_f32 v106, v106, s28, v13
    v_fma_f32 v107, v107, s28, v13
    v_exp_f32_e64 v106, v106 clamp
    v_exp_f32_e64 v107, v107 clamp
    s_nop 0
    v_cvt_pk_bf16_f32 v39, v106, v107
    v_fma_f32 v108, v108, s28, v13
    v_fma_f32 v109, v109, s28, v13
    v_exp_f32_e64 v108, v108 clamp
    v_exp_f32_e64 v109, v109 clamp
    s_nop 0
    v_cvt_pk_bf16_f32 v40, v108, v109
    v_fma_f32 v110, v110, s28, v13
    v_fma_f32 v111, v111, s28, v13
    v_exp_f32_e64 v110, v110 clamp
    v_exp_f32_e64 v111, v111 clamp
    s_nop 0
    v_cvt_pk_bf16_f32 v41, v110, v111
    v_mfma_f32_16x16x32_bf16 v[44:47], a[248:251], v[14:17], v[44:47]
    v_smfmac_f32_16x16x64_bf16 v[44:47], a[240:243], v[22:29], v101
    v_smfmac_f32_16x16x64_bf16 v[44:47], a[244:247], v[34:41], v101
    s_nop 15
    s_setpc_b64 s[40:41]
L_rare5_1:
    s_nop 15
    v_mov_b32 v104, 0
    v_mov_b32 v105, 0
    v_mov_b32 v106, 0
    v_mov_b32 v107, 0
    s_nop 1
    v_smfmac_f32_16x16x64_bf16 v[104:107], a[240:243], v[16:23], v101
    v_smfmac_f32_16x16x64_bf16 v[104:107], a[244:247], v[28:35], v101
    v_mfma_f32_16x16x32_bf16 v[104:107], a[248:251], v[40:43], v[104:107]
    s_nop 15
    v_sub_f32 v49, v49, v105
    v_sub_f32 v50, v50, v106
    v_sub_f32 v51, v51, v107
    v_mov_b32 v44, 0
    v_mov_b32 v48, 0
    v_mbcnt_lo_u32_b32 v27, -1, 0
    v_mbcnt_hi_u32_b32 v27, -1, v27
    v_and_b32 v26, 15, v27
    v_mul_u32_u24 v26, 384, v26
    v_lshrrev_b32 v27, 4, v27
    v_lshl_add_u32 v26, v27, 4, v26
    s_add_u32 s69, s39, 0
    buffer_load_dwordx4 v[92:95], v26, s[4:7], s69 offen offset:0
    s_waitcnt vmcnt(0)
    v_mfma_f32_16x16x32_bf16 v[104:107], v[92:95], a[96:99], 0
    s_nop 7
    buffer_load_dwordx4 v[92:95], v26, s[4:7], s69 offen offset:64
    s_waitcnt vmcnt(0)
    v_mfma_f32_16x16x32_bf16 v[104:107], v[92:95], a[100:103], v[104:107]
    s_nop 7
    buffer_load_dwordx4 v[92:95], v26, s[4:7], s69 offen offset:128
    s_waitcnt vmcnt(0)
    v_mfma_f32_16x16x32_bf16 v[104:107], v[92:95], a[104:107], v[104:107]
    s_nop 7
    buffer_load_dwordx4 v[92:95], v26, s[4:7], s69 offen offset:192
    s_waitcnt vmcnt(0)
    v_mfma_f32_16x16x32_bf16 v[104:107], v[92:95], a[108:111], v[104:107]
    s_nop 7
    buffer_load_dwordx4 v[92:95], v26, s[4:7], s69 offen offset:256
    s_waitcnt vmcnt(0)
    v_mfma_f32_16x16x32_bf16 v[104:107], v[92:95], a[112:115], v[104:107]
    s_nop 7
    buffer_load_dwordx4 v[92:95], v26, s[4:7], s69 offen offset:320
    s_waitcnt vmcnt(0)
    v_mfma_f32_16x16x32_bf16 v[104:107], v[92:95], a[116:119], v[104:107]
    s_nop 7
    s_add_u32 s69, s39, 6144
    buffer_load_dwordx4 v[92:95], v26, s[4:7], s69 offen offset:0
    s_waitcnt vmcnt(0)
    v_mfma_f32_16x16x32_bf16 v[108:111], v[92:95], a[96:99], 0
    s_nop 7
    buffer_load_dwordx4 v[92:95], v26, s[4:7], s69 offen offset:64
    s_waitcnt vmcnt(0)
    v_mfma_f32_16x16x32_bf16 v[108:111], v[92:95], a[100:103], v[108:111]
    s_nop 7
    buffer_load_dwordx4 v[92:95], v26, s[4:7], s69 offen offset:128
    s_waitcnt vmcnt(0)
    v_mfma_f32_16x16x32_bf16 v[108:111], v[92:95], a[104:107], v[108:111]
    s_nop 7
    buffer_load_dwordx4 v[92:95], v26, s[4:7], s69 offen offset:192
    s_waitcnt vmcnt(0)
    v_mfma_f32_16x16x32_bf16 v[108:111], v[92:95], a[108:111], v[108:111]
    s_nop 7
    buffer_load_dwordx4 v[92:95], v26, s[4:7], s69 offen offset:256
    s_waitcnt vmcnt(0)
    v_mfma_f32_16x16x32_bf16 v[108:111], v[92:95], a[112:115], v[108:111]
    s_nop 7
    buffer_load_dwordx4 v[92:95], v26, s[4:7], s69 offen offset:320
    s_waitcnt vmcnt(0)
    v_mfma_f32_16x16x32_bf16 v[108:111], v[92:95], a[116:119], v[108:111]
    s_nop 7
    s_nop 15
    v_max3_f32 v14, v104, v105, v106
    v_max3_f32 v14, v14, v107, v108
    v_max3_f32 v14, v14, v109, v110
    v_max_f32 v14, v14, v111
    v_mov_b32 v15, v14
    s_nop 1
    v_permlane32_swap_b32 v15, v14
    v_max_f32 v14, v14, v15
    v_mov_b32 v15, v14
    s_nop 1
    v_permlane16_swap_b32 v15, v14
    v_max_f32 v14, v14, v15
    v_fma_f32 v14, v14, s28, v9
    v_add_f32 v14, 0x42000000, v14
    v_max_f32 v24, 0, v14
    v_sub_f32 v9, v9, v24
    v_sub_f32 v25, 0, v24
    v_exp_f32 v25, v25
    s_nop 0
    v_mul_f32 v47, v47, v25
    v_mul_f32 v15, v49, v25
    v_cndmask_b32_e64 v49, v15, v49, s[46:47]
    v_mul_f32 v112, v112, v25
    v_mul_f32 v113, v113, v25
    v_mul_f32 v114, v114, v25
    v_mul_f32 v115, v115, v25
    v_mul_f32 v116, v116, v25
    v_mul_f32 v117, v117, v25
    v_mul_f32 v118, v118, v25
    v_mul_f32 v119, v119, v25
    v_mul_f32 v120, v120, v25
    v_mul_f32 v121, v121, v25
    v_mul_f32 v122, v122, v25
    v_mul_f32 v123, v123, v25
    v_mul_f32 v124, v124, v25
    v_mul_f32 v125, v125, v25
    v_mul_f32 v126, v126, v25
    v_mul_f32 v127, v127, v25
    v_mul_f32 v128, v128, v25
    v_mul_f32 v129, v129, v25
    v_mul_f32 v130, v130, v25
    v_mul_f32 v131, v131, v25
    v_mul_f32 v132, v132, v25
    v_mul_f32 v133, v133, v25
    v_mul_f32 v134, v134, v25
    v_mul_f32 v135, v135, v25
    v_mul_f32 v136, v136, v25
    v_mul_f32 v137, v137, v25
    v_mul_f32 v138, v138, v25
    v_mul_f32 v139, v139, v25
    v_mul_f32 v140, v140, v25
    v_mul_f32 v141, v141, v25
    v_mul_f32 v142, v142, v25
    v_mul_f32 v143, v143, v25
    v_mul_f32 v144, v144, v25
    v_mul_f32 v145, v145, v25
    v_mul_f32 v146, v146, v25
    v_mul_f32 v147, v147, v25
    v_mul_f32 v148, v148, v25
    v_mul_f32 v149, v149, v25
    v_mul_f32 v150, v150, v25
    v_mul_f32 v151, v151, v25
    v_mul_f32 v152, v152, v25
    v_mul_f32 v153, v153, v25
    v_mul_f32 v154, v154, v25
    v_mul_f32 v155, v155, v25
    v_mul_f32 v156, v156, v25
    v_mul_f32 v157, v157, v25
    v_mul_f32 v158, v158, v25
    v_mul_f32 v159, v159, v25
    v_fma_f32 v104, v104, s28, v9
    v_fma_f32 v105, v105, s28, v9
    v_exp_f32_e64 v104, v104 clamp
    v_exp_f32_e64 v105, v105 clamp
    s_nop 0
    v_cvt_pk_bf16_f32 v18, v104, v105
    v_fma_f32 v106, v106, s28, v9
    v_fma_f32 v107, v107, s28, v9
    v_exp_f32_e64 v106, v106 clamp
    v_exp_f32_e64 v107, v107 clamp
    s_nop 0
    v_cvt_pk_bf16_f32 v19, v106, v107
    v_fma_f32 v108, v108, s28, v9
    v_fma_f32 v109, v109, s28, v9
    v_exp_f32_e64 v108, v108 clamp
    v_exp_f32_e64 v109, v109 clamp
    s_nop 0
    v_cvt_pk_bf16_f32 v16, v108, v109
    v_fma_f32 v110, v110, s28, v9
    v_fma_f32 v111, v111, s28, v9
    v_exp_f32_e64 v110, v110 clamp
    v_exp_f32_e64 v111, v111 clamp
    s_nop 0
    v_cvt_pk_bf16_f32 v17, v110, v111
    s_add_u32 s69, s39, 0
    buffer_load_dwordx4 v[92:95], v26, s[4:7], s69 offen offset:0
    s_waitcnt vmcnt(0)
    v_mfma_f32_16x16x32_bf16 v[104:107], v[92:95], a[120:123], 0
    s_nop 7
    buffer_load_dwordx4 v[92:95], v26, s[4:7], s69 offen offset:64
    s_waitcnt vmcnt(0)
    v_mfma_f32_16x16x32_bf16 v[104:107], v[92:95], a[124:127], v[104:107]
    s_nop 7
    buffer_load_dwordx4 v[92:95], v26, s[4:7], s69 offen offset:128
    s_waitcnt vmcnt(0)
    v_mfma_f32_16x16x32_bf16 v[104:107], v[92:95], a[128:131], v[104:107]
    s_nop 7
    buffer_load_dwordx4 v[92:95], v26, s[4:7], s69 offen offset:192
    s_waitcnt vmcnt(0)
    v_mfma_f32_16x16x32_bf16 v[104:107], v[92:95], a[132:135], v[104:107]
    s_nop 7
    buffer_load_dwordx4 v[92:95], v26, s[4:7], s69 offen offset:256
    s_waitcnt vmcnt(0)
    v_mfma_f32_16x16x32_bf16 v[104:107], v[92:95], a[136:139], v[104:107]
    s_nop 7
    buffer_load_dwordx4 v[92:95], v26, s[4:7], s69 offen offset:320
    s_waitcnt vmcnt(0)
    v_mfma_f32_16x16x32_bf16 v[104:107], v[92:95], a[140:143], v[104:107]
    s_nop 7
    s_add_u32 s69, s39, 6144
    buffer_load_dwordx4 v[92:95], v26, s[4:7], s69 offen offset:0
    s_waitcnt vmcnt(0)
    v_mfma_f32_16x16x32_bf16 v[108:111], v[92:95], a[120:123], 0
    s_nop 7
    buffer_load_dwordx4 v[92:95], v26, s[4:7], s69 offen offset:64
    s_waitcnt vmcnt(0)
    v_mfma_f32_16x16x32_bf16 v[108:111], v[92:95], a[124:127], v[108:111]
    s_nop 7
    buffer_load_dwordx4 v[92:95], v26, s[4:7], s69 offen offset:128
    s_waitcnt vmcnt(0)
    v_mfma_f32_16x16x32_bf16 v[108:111], v[92:95], a[128:131], v[108:111]
    s_nop 7
    buffer_load_dwordx4 v[92:95], v26, s[4:7], s69 offen offset:192
    s_waitcnt vmcnt(0)
    v_mfma_f32_16x16x32_bf16 v[108:111], v[92:95], a[132:135], v[108:111]
    s_nop 7
    buffer_load_dwordx4 v[92:95], v26, s[4:7], s69 offen offset:256
    s_waitcnt vmcnt(0)
    v_mfma_f32_16x16x32_bf16 v[108:111], v[92:95], a[136:139], v[108:111]
    s_nop 7
    buffer_load_dwordx4 v[92:95], v26, s[4:7], s69 offen offset:320
    s_waitcnt vmcnt(0)
    v_mfma_f32_16x16x32_bf16 v[108:111], v[92:95], a[140:143], v[108:111]
    s_nop 7
    s_nop 15
    v_max3_f32 v14, v104, v105, v106
    v_max3_f32 v14, v14, v107, v108
    v_max3_f32 v14, v14, v109, v110
    v_max_f32 v14, v14, v111
    v_mov_b32 v15, v14
    s_nop 1
    v_permlane32_swap_b32 v15, v14
    v_max_f32 v14, v14, v15
    v_mov_b32 v15, v14
    s_nop 1
    v_permlane16_swap_b32 v15, v14
    v_max_f32 v14, v14, v15
    v_fma_f32 v14, v14, s28, v10
    v_add_f32 v14, 0x42000000, v14
    v_max_f32 v24, 0, v14
    v_sub_f32 v10, v10, v24
    v_sub_f32 v25, 0, v24
    v_exp_f32 v25, v25
    s_nop 0
    v_mul_f32 v15, v45, v25
    v_cndmask_b32_e64 v45, v15, v45, s[46:47]
    v_mul_f32 v15, v49, v25
    v_cndmask_b32_e64 v49, v49, v15, s[46:47]
    v_mul_f32 v160, v160, v25
    v_mul_f32 v161, v161, v25
    v_mul_f32 v162, v162, v25
    v_mul_f32 v163, v163, v25
    v_mul_f32 v164, v164, v25
    v_mul_f32 v165, v165, v25
    v_mul_f32 v166, v166, v25
    v_mul_f32 v167, v167, v25
    v_mul_f32 v168, v168, v25
    v_mul_f32 v169, v169, v25
    v_mul_f32 v170, v170, v25
    v_mul_f32 v171, v171, v25
    v_mul_f32 v172, v172, v25
    v_mul_f32 v173, v173, v25
    v_mul_f32 v174, v174, v25
    v_mul_f32 v175, v175, v25
    v_mul_f32 v176, v176, v25
    v_mul_f32 v177, v177, v25
    v_mul_f32 v178, v178, v25
    v_mul_f32 v179, v179, v25
    v_mul_f32 v180, v180, v25
    v_mul_f32 v181, v181, v25
    v_mul_f32 v182, v182, v25
    v_mul_f32 v183, v183, v25
    v_mul_f32 v184, v184, v25
    v_mul_f32 v185, v185, v25
    v_mul_f32 v186, v186, v25
    v_mul_f32 v187, v187, v25
    v_mul_f32 v188, v188, v25
    v_mul_f32 v189, v189, v25
    v_mul_f32 v190, v190, v25
    v_mul_f32 v191, v191, v25
    v_mul_f32 v192, v192, v25
    v_mul_f32 v193, v193, v25
    v_mul_f32 v194, v194, v25
    v_mul_f32 v195, v195, v25
    v_mul_f32 v196, v196, v25
    v_mul_f32 v197, v197, v25
    v_mul_f32 v198, v198, v25
    v_mul_f32 v199, v199, v25
    v_mul_f32 v200, v200, v25
    v_mul_f32 v201, v201, v25
    v_mul_f32 v202, v202, v25
    v_mul_f32 v203, v203, v25
    v_mul_f32 v204, v204, v25
    v_mul_f32 v205, v205, v25
    v_mul_f32 v206, v206, v25
    v_mul_f32 v207, v207, v25
    v_fma_f32 v104, v104, s28, v10
    v_fma_f32 v105, v105, s28, v10
    v_exp_f32_e64 v104, v104 clamp
    v_exp_f32_e64 v105, v105 clamp
    s_nop 0
    v_cvt_pk_bf16_f32 v22, v104, v105
    v_fma_f32 v106, v106, s28, v10
    v_fma_f32 v107, v107, s28, v10
    v_exp_f32_e64 v106, v106 clamp
    v_exp_f32_e64 v107, v107 clamp
    s_nop 0
    v_cvt_pk_bf16_f32 v23, v106, v107
    v_fma_f32 v108, v108, s28, v10
    v_fma_f32 v109, v109, s28, v10
    v_exp_f32_e64 v108, v108 clamp
    v_exp_f32_e64 v109, v109 clamp
    s_nop 0
    v_cvt_pk_bf16_f32 v20, v108, v109
    v_fma_f32 v110, v110, s28, v10
    v_fma_f32 v111, v111, s28, v10
    v_exp_f32_e64 v110, v110 clamp
    v_exp_f32_e64 v111, v111 clamp
    s_nop 0
    v_cvt_pk_bf16_f32 v21, v110, v111
    s_add_u32 s69, s39, 0
    buffer_load_dwordx4 v[92:95], v26, s[4:7], s69 offen offset:0
    s_waitcnt vmcnt(0)
    v_mfma_f32_16x16x32_bf16 v[104:107], v[92:95], a[144:147], 0
    s_nop 7
    buffer_load_dwordx4 v[92:95], v26, s[4:7], s69 offen offset:64
    s_waitcnt vmcnt(0)
    v_mfma_f32_16x16x32_bf16 v[104:107], v[92:95], a[148:151], v[104:107]
    s_nop 7
    buffer_load_dwordx4 v[92:95], v26, s[4:7], s69 offen offset:128
    s_waitcnt vmcnt(0)
    v_mfma_f32_16x16x32_bf16 v[104:107], v[92:95], a[152:155], v[104:107]
    s_nop 7
    buffer_load_dwordx4 v[92:95], v26, s[4:7], s69 offen offset:192
    s_waitcnt vmcnt(0)
    v_mfma_f32_16x16x32_bf16 v[104:107], v[92:95], a[156:159], v[104:107]
    s_nop 7
    buffer_load_dwordx4 v[92:95], v26, s[4:7], s69 offen offset:256
    s_waitcnt vmcnt(0)
    v_mfma_f32_16x16x32_bf16 v[104:107], v[92:95], a[160:163], v[104:107]
    s_nop 7
    buffer_load_dwordx4 v[92:95], v26, s[4:7], s69 offen offset:320
    s_waitcnt vmcnt(0)
    v_mfma_f32_16x16x32_bf16 v[104:107], v[92:95], a[164:167], v[104:107]
    s_nop 7
    s_add_u32 s69, s39, 6144
    buffer_load_dwordx4 v[92:95], v26, s[4:7], s69 offen offset:0
    s_waitcnt vmcnt(0)
    v_mfma_f32_16x16x32_bf16 v[108:111], v[92:95], a[144:147], 0
    s_nop 7
    buffer_load_dwordx4 v[92:95], v26, s[4:7], s69 offen offset:64
    s_waitcnt vmcnt(0)
    v_mfma_f32_16x16x32_bf16 v[108:111], v[92:95], a[148:151], v[108:111]
    s_nop 7
    buffer_load_dwordx4 v[92:95], v26, s[4:7], s69 offen offset:128
    s_waitcnt vmcnt(0)
    v_mfma_f32_16x16x32_bf16 v[108:111], v[92:95], a[152:155], v[108:111]
    s_nop 7
    buffer_load_dwordx4 v[92:95], v26, s[4:7], s69 offen offset:192
    s_waitcnt vmcnt(0)
    v_mfma_f32_16x16x32_bf16 v[108:111], v[92:95], a[156:159], v[108:111]
    s_nop 7
    buffer_load_dwordx4 v[92:95], v26, s[4:7], s69 offen offset:256
    s_waitcnt vmcnt(0)
    v_mfma_f32_16x16x32_bf16 v[108:111], v[92:95], a[160:163], v[108:111]
    s_nop 7
    buffer_load_dwordx4 v[92:95], v26, s[4:7], s69 offen offset:320
    s_waitcnt vmcnt(0)
    v_mfma_f32_16x16x32_bf16 v[108:111], v[92:95], a[164:167], v[108:111]
    s_nop 7
    s_nop 15
    v_max3_f32 v14, v104, v105, v106
    v_max3_f32 v14, v14, v107, v108
    v_max3_f32 v14, v14, v109, v110
    v_max_f32 v14, v14, v111
    v_mov_b32 v15, v14
    s_nop 1
    v_permlane32_swap_b32 v15, v14
    v_max_f32 v14, v14, v15
    v_mov_b32 v15, v14
    s_nop 1
    v_permlane16_swap_b32 v15, v14
    v_max_f32 v14, v14, v15
    v_fma_f32 v14, v14, s28, v11
    v_add_f32 v14, 0x42000000, v14
    v_max_f32 v24, 0, v14
    v_sub_f32 v11, v11, v24
    v_sub_f32 v25, 0, v24
    v_exp_f32 v25, v25
    s_nop 0
    v_mul_f32 v15, v45, v25
    v_cndmask_b32_e64 v45, v45, v15, s[46:47]
    v_mul_f32 v15, v50, v25
    v_cndmask_b32_e64 v50, v15, v50, s[46:47]
    v_mul_f32 v208, v208, v25
    v_mul_f32 v209, v209, v25
    v_mul_f32 v210, v210, v25
    v_mul_f32 v211, v211, v25
    v_mul_f32 v212, v212, v25
    v_mul_f32 v213, v213, v25
    v_mul_f32 v214, v214, v25
    v_mul_f32 v215, v215, v25
    v_mul_f32 v216, v216, v25
    v_mul_f32 v217, v217, v25
    v_mul_f32 v218, v218, v25
    v_mul_f32 v219, v219, v25
    v_mul_f32 v220, v220, v25
    v_mul_f32 v221, v221, v25
    v_mul_f32 v222, v222, v25
    v_mul_f32 v223, v223, v25
    v_mul_f32 v224, v224, v25
    v_mul_f32 v225, v225, v25
    v_mul_f32 v226, v226, v25
    v_mul_f32 v227, v227, v25
    v_mul_f32 v228, v228, v25
    v_mul_f32 v229, v229, v25
    v_mul_f32 v230, v230, v25
    v_mul_f32 v231, v231, v25
    v_mul_f32 v232, v232, v25
    v_mul_f32 v233, v233, v25
    v_mul_f32 v234, v234, v25
    v_mul_f32 v235, v235, v25
    v_mul_f32 v236, v236, v25
    v_mul_f32 v237, v237, v25
    v_mul_f32 v238, v238, v25
    v_mul_f32 v239, v239, v25
    v_mul_f32 v240, v240, v25
    v_mul_f32 v241, v241, v25
    v_mul_f32 v242, v242, v25
    v_mul_f32 v243, v243, v25
    v_mul_f32 v244, v244, v25
    v_mul_f32 v245, v245, v25
    v_mul_f32 v246, v246, v25
    v_mul_f32 v247, v247, v25
    v_mul_f32 v248, v248, v25
    v_mul_f32 v249, v249, v25
    v_mul_f32 v250, v250, v25
    v_mul_f32 v251, v251, v25
    v_mul_f32 v252, v252, v25
    v_mul_f32 v253, v253, v25
    v_mul_f32 v254, v254, v25
    v_mul_f32 v255, v255, v25
    v_fma_f32 v104, v104, s28, v11
    v_fma_f32 v105, v105, s28, v11
    v_exp_f32_e64 v104, v104 clamp
    v_exp_f32_e64 v105, v105 clamp
    s_nop 0
    v_cvt_pk_bf16_f32 v30, v104, v105
    v_fma_f32 v106, v106, s28, v11
    v_fma_f32 v107, v107, s28, v11
    v_exp_f32_e64 v106, v106 clamp
    v_exp_f32_e64 v107, v107 clamp
    s_nop 0
    v_cvt_pk_bf16_f32 v31, v106, v107
    v_fma_f32 v108, v108, s28, v11
    v_fma_f32 v109, v109, s28, v11
    v_exp_f32_e64 v108, v108 clamp
    v_exp_f32_e64 v109, v109 clamp
    s_nop 0
    v_cvt_pk_bf16_f32 v28, v108, v109
    v_fma_f32 v110, v110, s28, v11
    v_fma_f32 v111, v111, s28, v11
    v_exp_f32_e64 v110, v110 clamp
    v_exp_f32_e64 v111, v111 clamp
    s_nop 0
    v_cvt_pk_bf16_f32 v29, v110, v111
    s_add_u32 s69, s39, 0
    buffer_load_dwordx4 v[92:95], v26, s[4:7], s69 offen offset:0
    s_waitcnt vmcnt(0)
    v_mfma_f32_16x16x32_bf16 v[104:107], v[92:95], a[168:171], 0
    s_nop 7
    buffer_load_dwordx4 v[92:95], v26, s[4:7], s69 offen offset:64
    s_waitcnt vmcnt(0)
    v_mfma_f32_16x16x32_bf16 v[104:107], v[92:95], a[172:175], v[104:107]
    s_nop 7
    buffer_load_dwordx4 v[92:95], v26, s[4:7], s69 offen offset:128
    s_waitcnt vmcnt(0)
    v_mfma_f32_16x16x32_bf16 v[104:107], v[92:95], a[176:179], v[104:107]
    s_nop 7
    buffer_load_dwordx4 v[92:95], v26, s[4:7], s69 offen offset:192
    s_waitcnt vmcnt(0)
    v_mfma_f32_16x16x32_bf16 v[104:107], v[92:95], a[180:183], v[104:107]
    s_nop 7
    buffer_load_dwordx4 v[92:95], v26, s[4:7], s69 offen offset:256
    s_waitcnt vmcnt(0)
    v_mfma_f32_16x16x32_bf16 v[104:107], v[92:95], a[184:187], v[104:107]
    s_nop 7
    buffer_load_dwordx4 v[92:95], v26, s[4:7], s69 offen offset:320
    s_waitcnt vmcnt(0)
    v_mfma_f32_16x16x32_bf16 v[104:107], v[92:95], a[188:191], v[104:107]
    s_nop 7
    s_add_u32 s69, s39, 6144
    buffer_load_dwordx4 v[92:95], v26, s[4:7], s69 offen offset:0
    s_waitcnt vmcnt(0)
    v_mfma_f32_16x16x32_bf16 v[108:111], v[92:95], a[168:171], 0
    s_nop 7
    buffer_load_dwordx4 v[92:95], v26, s[4:7], s69 offen offset:64
    s_waitcnt vmcnt(0)
    v_mfma_f32_16x16x32_bf16 v[108:111], v[92:95], a[172:175], v[108:111]
    s_nop 7
    buffer_load_dwordx4 v[92:95], v26, s[4:7], s69 offen offset:128
    s_waitcnt vmcnt(0)
    v_mfma_f32_16x16x32_bf16 v[108:111], v[92:95], a[176:179], v[108:111]
    s_nop 7
    buffer_load_dwordx4 v[92:95], v26, s[4:7], s69 offen offset:192
    s_waitcnt vmcnt(0)
    v_mfma_f32_16x16x32_bf16 v[108:111], v[92:95], a[180:183], v[108:111]
    s_nop 7
    buffer_load_dwordx4 v[92:95], v26, s[4:7], s69 offen offset:256
    s_waitcnt vmcnt(0)
    v_mfma_f32_16x16x32_bf16 v[108:111], v[92:95], a[184:187], v[108:111]
    s_nop 7
    buffer_load_dwordx4 v[92:95], v26, s[4:7], s69 offen offset:320
    s_waitcnt vmcnt(0)
    v_mfma_f32_16x16x32_bf16 v[108:111], v[92:95], a[188:191], v[108:111]
    s_nop 7
    s_nop 15
    v_max3_f32 v14, v104, v105, v106
    v_max3_f32 v14, v14, v107, v108
    v_max3_f32 v14, v14, v109, v110
    v_max_f32 v14, v14, v111
    v_mov_b32 v15, v14
    s_nop 1
    v_permlane32_swap_b32 v15, v14
    v_max_f32 v14, v14, v15
    v_mov_b32 v15, v14
    s_nop 1
    v_permlane16_swap_b32 v15, v14
    v_max_f32 v14, v14, v15
    v_fma_f32 v14, v14, s28, v12
    v_add_f32 v14, 0x42000000, v14
    v_max_f32 v24, 0, v14
    v_sub_f32 v12, v12, v24
    v_sub_f32 v25, 0, v24
    v_exp_f32 v25, v25
    s_nop 0
    v_mul_f32 v15, v46, v25
    v_cndmask_b32_e64 v46, v15, v46, s[46:47]
    v_mul_f32 v15, v50, v25
    v_cndmask_b32_e64 v50, v50, v15, s[46:47]
    v_accvgpr_read_b32 v15, a0
    v_mul_f32 v15, v15, v25
    v_accvgpr_write_b32 a0, v15
    v_accvgpr_read_b32 v15, a1
    v_mul_f32 v15, v15, v25
    v_accvgpr_write_b32 a1, v15
    v_accvgpr_read_b32 v15, a2
    v_mul_f32 v15, v15, v25
    v_accvgpr_write_b32 a2, v15
    v_accvgpr_read_b32 v15, a3
    v_mul_f32 v15, v15, v25
    v_accvgpr_write_b32 a3, v15
    v_accvgpr_read_b32 v15, a4
    v_mul_f32 v15, v15, v25
    v_accvgpr_write_b32 a4, v15
    v_accvgpr_read_b32 v15, a5
    v_mul_f32 v15, v15, v25
    v_accvgpr_write_b32 a5, v15
    v_accvgpr_read_b32 v15, a6
    v_mul_f32 v15, v15, v25
    v_accvgpr_write_b32 a6, v15
    v_accvgpr_read_b32 v15, a7
    v_mul_f32 v15, v15, v25
    v_accvgpr_write_b32 a7, v15
    v_accvgpr_read_b32 v15, a8
    v_mul_f32 v15, v15, v25
    v_accvgpr_write_b32 a8, v15
    v_accvgpr_read_b32 v15, a9
    v_mul_f32 v15, v15, v25
    v_accvgpr_write_b32 a9, v15
    v_accvgpr_read_b32 v15, a10
    v_mul_f32 v15, v15, v25
    v_accvgpr_write_b32 a10, v15
    v_accvgpr_read_b32 v15, a11
    v_mul_f32 v15, v15, v25
    v_accvgpr_write_b32 a11, v15
    v_accvgpr_read_b32 v15, a12
    v_mul_f32 v15, v15, v25
    v_accvgpr_write_b32 a12, v15
    v_accvgpr_read_b32 v15, a13
    v_mul_f32 v15, v15, v25
    v_accvgpr_write_b32 a13, v15
    v_accvgpr_read_b32 v15, a14
    v_mul_f32 v15, v15, v25
    v_accvgpr_write_b32 a14, v15
    v_accvgpr_read_b32 v15, a15
    v_mul_f32 v15, v15, v25
    v_accvgpr_write_b32 a15, v15
    v_accvgpr_read_b32 v15, a16
    v_mul_f32 v15, v15, v25
    v_accvgpr_write_b32 a16, v15
    v_accvgpr_read_b32 v15, a17
    v_mul_f32 v15, v15, v25
    v_accvgpr_write_b32 a17, v15
    v_accvgpr_read_b32 v15, a18
    v_mul_f32 v15, v15, v25
    v_accvgpr_write_b32 a18, v15
    v_accvgpr_read_b32 v15, a19
    v_mul_f32 v15, v15, v25
    v_accvgpr_write_b32 a19, v15
    v_accvgpr_read_b32 v15, a20
    v_mul_f32 v15, v15, v25
    v_accvgpr_write_b32 a20, v15
    v_accvgpr_read_b32 v15, a21
    v_mul_f32 v15, v15, v25
    v_accvgpr_write_b32 a21, v15
    v_accvgpr_read_b32 v15, a22
    v_mul_f32 v15, v15, v25
    v_accvgpr_write_b32 a22, v15
    v_accvgpr_read_b32 v15, a23
    v_mul_f32 v15, v15, v25
    v_accvgpr_write_b32 a23, v15
    v_accvgpr_read_b32 v15, a24
    v_mul_f32 v15, v15, v25
    v_accvgpr_write_b32 a24, v15
    v_accvgpr_read_b32 v15, a25
    v_mul_f32 v15, v15, v25
    v_accvgpr_write_b32 a25, v15
    v_accvgpr_read_b32 v15, a26
    v_mul_f32 v15, v15, v25
    v_accvgpr_write_b32 a26, v15
    v_accvgpr_read_b32 v15, a27
    v_mul_f32 v15, v15, v25
    v_accvgpr_write_b32 a27, v15
    v_accvgpr_read_b32 v15, a28
    v_mul_f32 v15, v15, v25
    v_accvgpr_write_b32 a28, v15
    v_accvgpr_read_b32 v15, a29
    v_mul_f32 v15, v15, v25
    v_accvgpr_write_b32 a29, v15
    v_accvgpr_read_b32 v15, a30
    v_mul_f32 v15, v15, v25
    v_accvgpr_write_b32 a30, v15
    v_accvgpr_read_b32 v15, a31
    v_mul_f32 v15, v15, v25
    v_accvgpr_write_b32 a31, v15
    v_accvgpr_read_b32 v15, a32
    v_mul_f32 v15, v15, v25
    v_accvgpr_write_b32 a32, v15
    v_accvgpr_read_b32 v15, a33
    v_mul_f32 v15, v15, v25
    v_accvgpr_write_b32 a33, v15
    v_accvgpr_read_b32 v15, a34
    v_mul_f32 v15, v15, v25
    v_accvgpr_write_b32 a34, v15
    v_accvgpr_read_b32 v15, a35
    v_mul_f32 v15, v15, v25
    v_accvgpr_write_b32 a35, v15
    v_accvgpr_read_b32 v15, a36
    v_mul_f32 v15, v15, v25
    v_accvgpr_write_b32 a36, v15
    v_accvgpr_read_b32 v15, a37
    v_mul_f32 v15, v15, v25
    v_accvgpr_write_b32 a37, v15
    v_accvgpr_read_b32 v15, a38
    v_mul_f32 v15, v15, v25
    v_accvgpr_write_b32 a38, v15
    v_accvgpr_read_b32 v15, a39
    v_mul_f32 v15, v15, v25
    v_accvgpr_write_b32 a39, v15
    v_accvgpr_read_b32 v15, a40
    v_mul_f32 v15, v15, v25
    v_accvgpr_write_b32 a40, v15
    v_accvgpr_read_b32 v15, a41
    v_mul_f32 v15, v15, v25
    v_accvgpr_write_b32 a41, v15
    v_accvgpr_read_b32 v15, a42
    v_mul_f32 v15, v15, v25
    v_accvgpr_write_b32 a42, v15
    v_accvgpr_read_b32 v15, a43
    v_mul_f32 v15, v15, v25
    v_accvgpr_write_b32 a43, v15
    v_accvgpr_read_b32 v15, a44
    v_mul_f32 v15, v15, v25
    v_accvgpr_write_b32 a44, v15
    v_accvgpr_read_b32 v15, a45
    v_mul_f32 v15, v15, v25
    v_accvgpr_write_b32 a45, v15
    v_accvgpr_read_b32 v15, a46
    v_mul_f32 v15, v15, v25
    v_accvgpr_write_b32 a46, v15
    v_accvgpr_read_b32 v15, a47
    v_mul_f32 v15, v15, v25
    v_accvgpr_write_b32 a47, v15
    v_fma_f32 v104, v104, s28, v12
    v_fma_f32 v105, v105, s28, v12
    v_exp_f32_e64 v104, v104 clamp
    v_exp_f32_e64 v105, v105 clamp
    s_nop 0
    v_cvt_pk_bf16_f32 v34, v104, v105
    v_fma_f32 v106, v106, s28, v12
    v_fma_f32 v107, v107, s28, v12
    v_exp_f32_e64 v106, v106 clamp
    v_exp_f32_e64 v107, v107 clamp
    s_nop 0
    v_cvt_pk_bf16_f32 v35, v106, v107
    v_fma_f32 v108, v108, s28, v12
    v_fma_f32 v109, v109, s28, v12
    v_exp_f32_e64 v108, v108 clamp
    v_exp_f32_e64 v109, v109 clamp
    s_nop 0
    v_cvt_pk_bf16_f32 v32, v108, v109
    v_fma_f32 v110, v110, s28, v12
    v_fma_f32 v111, v111, s28, v12
    v_exp_f32_e64 v110, v110 clamp
    v_exp_f32_e64 v111, v111 clamp
    s_nop 0
    v_cvt_pk_bf16_f32 v33, v110, v111
    s_add_u32 s69, s39, 0
    buffer_load_dwordx4 v[92:95], v26, s[4:7], s69 offen offset:0
    s_waitcnt vmcnt(0)
    v_mfma_f32_16x16x32_bf16 v[104:107], v[92:95], a[192:195], 0
    s_nop 7
    buffer_load_dwordx4 v[92:95], v26, s[4:7], s69 offen offset:64
    s_waitcnt vmcnt(0)
    v_mfma_f32_16x16x32_bf16 v[104:107], v[92:95], a[196:199], v[104:107]
    s_nop 7
    buffer_load_dwordx4 v[92:95], v26, s[4:7], s69 offen offset:128
    s_waitcnt vmcnt(0)
    v_mfma_f32_16x16x32_bf16 v[104:107], v[92:95], a[200:203], v[104:107]
    s_nop 7
    buffer_load_dwordx4 v[92:95], v26, s[4:7], s69 offen offset:192
    s_waitcnt vmcnt(0)
    v_mfma_f32_16x16x32_bf16 v[104:107], v[92:95], a[204:207], v[104:107]
    s_nop 7
    buffer_load_dwordx4 v[92:95], v26, s[4:7], s69 offen offset:256
    s_waitcnt vmcnt(0)
    v_mfma_f32_16x16x32_bf16 v[104:107], v[92:95], a[208:211], v[104:107]
    s_nop 7
    buffer_load_dwordx4 v[92:95], v26, s[4:7], s69 offen offset:320
    s_waitcnt vmcnt(0)
    v_mfma_f32_16x16x32_bf16 v[104:107], v[92:95], a[212:215], v[104:107]
    s_nop 7
    s_add_u32 s69, s39, 6144
    buffer_load_dwordx4 v[92:95], v26, s[4:7], s69 offen offset:0
    s_waitcnt vmcnt(0)
    v_mfma_f32_16x16x32_bf16 v[108:111], v[92:95], a[192:195], 0
    s_nop 7
    buffer_load_dwordx4 v[92:95], v26, s[4:7], s69 offen offset:64
    s_waitcnt vmcnt(0)
    v_mfma_f32_16x16x32_bf16 v[108:111], v[92:95], a[196:199], v[108:111]
    s_nop 7
    buffer_load_dwordx4 v[92:95], v26, s[4:7], s69 offen offset:128
    s_waitcnt vmcnt(0)
    v_mfma_f32_16x16x32_bf16 v[108:111], v[92:95], a[200:203], v[108:111]
    s_nop 7
    buffer_load_dwordx4 v[92:95], v26, s[4:7], s69 offen offset:192
    s_waitcnt vmcnt(0)
    v_mfma_f32_16x16x32_bf16 v[108:111], v[92:95], a[204:207], v[108:111]
    s_nop 7
    buffer_load_dwordx4 v[92:95], v26, s[4:7], s69 offen offset:256
    s_waitcnt vmcnt(0)
    v_mfma_f32_16x16x32_bf16 v[108:111], v[92:95], a[208:211], v[108:111]
    s_nop 7
    buffer_load_dwordx4 v[92:95], v26, s[4:7], s69 offen offset:320
    s_waitcnt vmcnt(0)
    v_mfma_f32_16x16x32_bf16 v[108:111], v[92:95], a[212:215], v[108:111]
    s_nop 7
    s_nop 15
    v_max3_f32 v14, v104, v105, v106
    v_max3_f32 v14, v14, v107, v108
    v_max3_f32 v14, v14, v109, v110
    v_max_f32 v14, v14, v111
    v_mov_b32 v15, v14
    s_nop 1
    v_permlane32_swap_b32 v15, v14
    v_max_f32 v14, v14, v15
    v_mov_b32 v15, v14
    s_nop 1
    v_permlane16_swap_b32 v15, v14
    v_max_f32 v14, v14, v15
    v_fma_f32 v14, v14, s28, v13
    v_add_f32 v14, 0x42000000, v14
    v_max_f32 v24, 0, v14
    v_sub_f32 v13, v13, v24
    v_sub_f32 v25, 0, v24
    v_exp_f32 v25, v25
    s_nop 0
    v_mul_f32 v15, v46, v25
    v_cndmask_b32_e64 v46, v46, v15, s[46:47]
    v_mul_f32 v51, v51, v25
    v_accvgpr_read_b32 v15, a48
    v_mul_f32 v15, v15, v25
    v_accvgpr_write_b32 a48, v15
    v_accvgpr_read_b32 v15, a49
    v_mul_f32 v15, v15, v25
    v_accvgpr_write_b32 a49, v15
    v_accvgpr_read_b32 v15, a50
    v_mul_f32 v15, v15, v25
    v_accvgpr_write_b32 a50, v15
    v_accvgpr_read_b32 v15, a51
    v_mul_f32 v15, v15, v25
    v_accvgpr_write_b32 a51, v15
    v_accvgpr_read_b32 v15, a52
    v_mul_f32 v15, v15, v25
    v_accvgpr_write_b32 a52, v15
    v_accvgpr_read_b32 v15, a53
    v_mul_f32 v15, v15, v25
    v_accvgpr_write_b32 a53, v15
    v_accvgpr_read_b32 v15, a54
    v_mul_f32 v15, v15, v25
    v_accvgpr_write_b32 a54, v15
    v_accvgpr_read_b32 v15, a55
    v_mul_f32 v15, v15, v25
    v_accvgpr_write_b32 a55, v15
    v_accvgpr_read_b32 v15, a56
    v_mul_f32 v15, v15, v25
    v_accvgpr_write_b32 a56, v15
    v_accvgpr_read_b32 v15, a57
    v_mul_f32 v15, v15, v25
    v_accvgpr_write_b32 a57, v15
    v_accvgpr_read_b32 v15, a58
    v_mul_f32 v15, v15, v25
    v_accvgpr_write_b32 a58, v15
    v_accvgpr_read_b32 v15, a59
    v_mul_f32 v15, v15, v25
    v_accvgpr_write_b32 a59, v15
    v_accvgpr_read_b32 v15, a60
    v_mul_f32 v15, v15, v25
    v_accvgpr_write_b32 a60, v15
    v_accvgpr_read_b32 v15, a61
    v_mul_f32 v15, v15, v25
    v_accvgpr_write_b32 a61, v15
    v_accvgpr_read_b32 v15, a62
    v_mul_f32 v15, v15, v25
    v_accvgpr_write_b32 a62, v15
    v_accvgpr_read_b32 v15, a63
    v_mul_f32 v15, v15, v25
    v_accvgpr_write_b32 a63, v15
    v_accvgpr_read_b32 v15, a64
    v_mul_f32 v15, v15, v25
    v_accvgpr_write_b32 a64, v15
    v_accvgpr_read_b32 v15, a65
    v_mul_f32 v15, v15, v25
    v_accvgpr_write_b32 a65, v15
    v_accvgpr_read_b32 v15, a66
    v_mul_f32 v15, v15, v25
    v_accvgpr_write_b32 a66, v15
    v_accvgpr_read_b32 v15, a67
    v_mul_f32 v15, v15, v25
    v_accvgpr_write_b32 a67, v15
    v_accvgpr_read_b32 v15, a68
    v_mul_f32 v15, v15, v25
    v_accvgpr_write_b32 a68, v15
    v_accvgpr_read_b32 v15, a69
    v_mul_f32 v15, v15, v25
    v_accvgpr_write_b32 a69, v15
    v_accvgpr_read_b32 v15, a70
    v_mul_f32 v15, v15, v25
    v_accvgpr_write_b32 a70, v15
    v_accvgpr_read_b32 v15, a71
    v_mul_f32 v15, v15, v25
    v_accvgpr_write_b32 a71, v15
    v_accvgpr_read_b32 v15, a72
    v_mul_f32 v15, v15, v25
    v_accvgpr_write_b32 a72, v15
    v_accvgpr_read_b32 v15, a73
    v_mul_f32 v15, v15, v25
    v_accvgpr_write_b32 a73, v15
    v_accvgpr_read_b32 v15, a74
    v_mul_f32 v15, v15, v25
    v_accvgpr_write_b32 a74, v15
    v_accvgpr_read_b32 v15, a75
    v_mul_f32 v15, v15, v25
    v_accvgpr_write_b32 a75, v15
    v_accvgpr_read_b32 v15, a76
    v_mul_f32 v15, v15, v25
    v_accvgpr_write_b32 a76, v15
    v_accvgpr_read_b32 v15, a77
    v_mul_f32 v15, v15, v25
    v_accvgpr_write_b32 a77, v15
    v_accvgpr_read_b32 v15, a78
    v_mul_f32 v15, v15, v25
    v_accvgpr_write_b32 a78, v15
    v_accvgpr_read_b32 v15, a79
    v_mul_f32 v15, v15, v25
    v_accvgpr_write_b32 a79, v15
    v_accvgpr_read_b32 v15, a80
    v_mul_f32 v15, v15, v25
    v_accvgpr_write_b32 a80, v15
    v_accvgpr_read_b32 v15, a81
    v_mul_f32 v15, v15, v25
    v_accvgpr_write_b32 a81, v15
    v_accvgpr_read_b32 v15, a82
    v_mul_f32 v15, v15, v25
    v_accvgpr_write_b32 a82, v15
    v_accvgpr_read_b32 v15, a83
    v_mul_f32 v15, v15, v25
    v_accvgpr_write_b32 a83, v15
    v_accvgpr_read_b32 v15, a84
    v_mul_f32 v15, v15, v25
    v_accvgpr_write_b32 a84, v15
    v_accvgpr_read_b32 v15, a85
    v_mul_f32 v15, v15, v25
    v_accvgpr_write_b32 a85, v15
    v_accvgpr_read_b32 v15, a86
    v_mul_f32 v15, v15, v25
    v_accvgpr_write_b32 a86, v15
    v_accvgpr_read_b32 v15, a87
    v_mul_f32 v15, v15, v25
    v_accvgpr_write_b32 a87, v15
    v_accvgpr_read_b32 v15, a88
    v_mul_f32 v15, v15, v25
    v_accvgpr_write_b32 a88, v15
    v_accvgpr_read_b32 v15, a89
    v_mul_f32 v15, v15, v25
    v_accvgpr_write_b32 a89, v15
    v_accvgpr_read_b32 v15, a90
    v_mul_f32 v15, v15, v25
    v_accvgpr_write_b32 a90, v15
    v_accvgpr_read_b32 v15, a91
    v_mul_f32 v15, v15, v25
    v_accvgpr_write_b32 a91, v15
    v_accvgpr_read_b32 v15, a92
    v_mul_f32 v15, v15, v25
    v_accvgpr_write_b32 a92, v15
    v_accvgpr_read_b32 v15, a93
    v_mul_f32 v15, v15, v25
    v_accvgpr_write_b32 a93, v15
    v_accvgpr_read_b32 v15, a94
    v_mul_f32 v15, v15, v25
    v_accvgpr_write_b32 a94, v15
    v_accvgpr_read_b32 v15, a95
    v_mul_f32 v15, v15, v25
    v_accvgpr_write_b32 a95, v15
    v_fma_f32 v104, v104, s28, v13
    v_fma_f32 v105, v105, s28, v13
    v_exp_f32_e64 v104, v104 clamp
    v_exp_f32_e64 v105, v105 clamp
    s_nop 0
    v_cvt_pk_bf16_f32 v42, v104, v105
    v_fma_f32 v106, v106, s28, v13
    v_fma_f32 v107, v107, s28, v13
    v_exp_f32_e64 v106, v106 clamp
    v_exp_f32_e64 v107, v107 clamp
    s_nop 0
    v_cvt_pk_bf16_f32 v43, v106, v107
    v_fma_f32 v108, v108, s28, v13
    v_fma_f32 v109, v109, s28, v13
    v_exp_f32_e64 v108, v108 clamp
    v_exp_f32_e64 v109, v109 clamp
    s_nop 0
    v_cvt_pk_bf16_f32 v40, v108, v109
    v_fma_f32 v110, v110, s28, v13
    v_fma_f32 v111, v111, s28, v13
    v_exp_f32_e64 v110, v110 clamp
    v_exp_f32_e64 v111, v111 clamp
    s_nop 0
    v_cvt_pk_bf16_f32 v41, v110, v111
    v_smfmac_f32_16x16x64_bf16 v[48:51], a[240:243], v[16:23], v101
    v_smfmac_f32_16x16x64_bf16 v[48:51], a[244:247], v[28:35], v101
    v_mfma_f32_16x16x32_bf16 v[48:51], a[248:251], v[40:43], v[48:51]
    s_nop 15
    s_setpc_b64 s[40:41]
L_rare4_0:
    s_nop 15
    v_mov_b32 v104, 0
    v_mov_b32 v105, 0
    v_mov_b32 v106, 0
    v_mov_b32 v107, 0
    s_nop 1
    v_mfma_f32_16x16x32_bf16 v[104:107], a[248:251], v[14:17], v[104:107]
    v_smfmac_f32_16x16x64_bf16 v[104:107], a[240:243], v[22:29], v101
    v_mfma_f32_16x16x32_bf16 v[104:107], a[252:255], v[34:37], v[104:107]
    s_nop 15
    v_sub_f32 v45, v45, v105
    v_sub_f32 v46, v46, v106
    v_sub_f32 v47, v47, v107
    v_mov_b32 v44, 0
    v_mov_b32 v48, 0
    v_mbcnt_lo_u32_b32 v31, -1, 0
    v_mbcnt_hi_u32_b32 v31, -1, v31
    v_and_b32 v30, 15, v31
    v_mul_u32_u24 v30, 384, v30
    v_lshrrev_b32 v31, 4, v31
    v_lshl_add_u32 v30, v31, 4, v30
    s_add_u32 s69, s39, 0
    buffer_load_dwordx4 v[92:95], v30, s[4:7], s69 offen offset:0
    s_waitcnt vmcnt(0)
    v_mfma_f32_16x16x32_bf16 v[104:107], v[92:95], a[96:99], 0
    s_nop 7
    buffer_load_dwordx4 v[92:95], v30, s[4:7], s69 offen offset:64
    s_waitcnt vmcnt(0)
    v_mfma_f32_16x16x32_bf16 v[104:107], v[92:95], a[100:103], v[104:107]
    s_nop 7
    buffer_load_dwordx4 v[92:95], v30, s[4:7], s69 offen offset:128
    s_waitcnt vmcnt(0)
    v_mfma_f32_16x16x32_bf16 v[104:107], v[92:95], a[104:107], v[104:107]
    s_nop 7
    buffer_load_dwordx4 v[92:95], v30, s[4:7], s69 offen offset:192
    s_waitcnt vmcnt(0)
    v_mfma_f32_16x16x32_bf16 v[104:107], v[92:95], a[108:111], v[104:107]
    s_nop 7
    buffer_load_dwordx4 v[92:95], v30, s[4:7], s69 offen offset:256
    s_waitcnt vmcnt(0)
    v_mfma_f32_16x16x32_bf16 v[104:107], v[92:95], a[112:115], v[104:107]
    s_nop 7
    buffer_load_dwordx4 v[92:95], v30, s[4:7], s69 offen offset:320
    s_waitcnt vmcnt(0)
    v_mfma_f32_16x16x32_bf16 v[104:107], v[92:95], a[116:119], v[104:107]
    s_nop 7
    s_add_u32 s69, s39, 6144
    buffer_load_dwordx4 v[92:95], v30, s[4:7], s69 offen offset:0
    s_waitcnt vmcnt(0)
    v_mfma_f32_16x16x32_bf16 v[108:111], v[92:95], a[96:99], 0
    s_nop 7
    buffer_load_dwordx4 v[92:95], v30, s[4:7], s69 offen offset:64
    s_waitcnt vmcnt(0)
    v_mfma_f32_16x16x32_bf16 v[108:111], v[92:95], a[100:103], v[108:111]
    s_nop 7
    buffer_load_dwordx4 v[92:95], v30, s[4:7], s69 offen offset:128
    s_waitcnt vmcnt(0)
    v_mfma_f32_16x16x32_bf16 v[108:111], v[92:95], a[104:107], v[108:111]
    s_nop 7
    buffer_load_dwordx4 v[92:95], v30, s[4:7], s69 offen offset:192
    s_waitcnt vmcnt(0)
    v_mfma_f32_16x16x32_bf16 v[108:111], v[92:95], a[108:111], v[108:111]
    s_nop 7
    buffer_load_dwordx4 v[92:95], v30, s[4:7], s69 offen offset:256
    s_waitcnt vmcnt(0)
    v_mfma_f32_16x16x32_bf16 v[108:111], v[92:95], a[112:115], v[108:111]
    s_nop 7
    buffer_load_dwordx4 v[92:95], v30, s[4:7], s69 offen offset:320
    s_waitcnt vmcnt(0)
    v_mfma_f32_16x16x32_bf16 v[108:111], v[92:95], a[116:119], v[108:111]
    s_nop 7
    s_nop 15
    v_max3_f32 v18, v104, v105, v106
    v_max3_f32 v18, v18, v107, v108
    v_max3_f32 v18, v18, v109, v110
    v_max_f32 v18, v18, v111
    v_mov_b32 v19, v18
    s_nop 1
    v_permlane32_swap_b32 v19, v18
    v_max_f32 v18, v18, v19
    v_mov_b32 v19, v18
    s_nop 1
    v_permlane16_swap_b32 v19, v18
    v_max_f32 v18, v18, v19
    v_fma_f32 v18, v18, s28, v9
    v_add_f32 v18, 0x42000000, v18
    v_max_f32 v20, 0, v18
    v_sub_f32 v9, v9, v20
    v_sub_f32 v21, 0, v20
    v_exp_f32 v21, v21
    s_nop 0
    v_mul_f32 v47, v47, v21
    v_mul_f32 v19, v49, v21
    v_cndmask_b32_e64 v49, v19, v49, s[46:47]
    v_mul_f32 v112, v112, v21
    v_mul_f32 v113, v113, v21
    v_mul_f32 v114, v114, v21
    v_mul_f32 v115, v115, v21
    v_mul_f32 v116, v116, v21
    v_mul_f32 v117, v117, v21
    v_mul_f32 v118, v118, v21
    v_mul_f32 v119, v119, v21
    v_mul_f32 v120, v120, v21
    v_mul_f32 v121, v121, v21
    v_mul_f32 v122, v122, v21
    v_mul_f32 v123, v123, v21
    v_mul_f32 v124, v124, v21
    v_mul_f32 v125, v125, v21
    v_mul_f32 v126, v126, v21
    v_mul_f32 v127, v127, v21
    v_mul_f32 v128, v128, v21
    v_mul_f32 v129, v129, v21
    v_mul_f32 v130, v130, v21
    v_mul_f32 v131, v131, v21
    v_mul_f32 v132, v132, v21
    v_mul_f32 v133, v133, v21
    v_mul_f32 v134, v134, v21
    v_mul_f32 v135, v135, v21
    v_mul_f32 v136, v136, v21
    v_mul_f32 v137, v137, v21
    v_mul_f32 v138, v138, v21
    v_mul_f32 v139, v139, v21
    v_mul_f32 v140, v140, v21
    v_mul_f32 v141, v141, v21
    v_mul_f32 v142, v142, v21
    v_mul_f32 v143, v143, v21
    v_mul_f32 v144, v144, v21
    v_mul_f32 v145, v145, v21
    v_mul_f32 v146, v146, v21
    v_mul_f32 v147, v147, v21
    v_mul_f32 v148, v148, v21
    v_mul_f32 v149, v149, v21
    v_mul_f32 v150, v150, v21
    v_mul_f32 v151, v151, v21
    v_mul_f32 v152, v152, v21
    v_mul_f32 v153, v153, v21
    v_mul_f32 v154, v154, v21
    v_mul_f32 v155, v155, v21
    v_mul_f32 v156, v156, v21
    v_mul_f32 v157, v157, v21
    v_mul_f32 v158, v158, v21
    v_mul_f32 v159, v159, v21
    v_fma_f32 v104, v104, s28, v9
    v_fma_f32 v105, v105, s28, v9
    v_exp_f32_e64 v104, v104 clamp
    v_exp_f32_e64 v105, v105 clamp
    s_nop 0
    v_cvt_pk_bf16_f32 v14, v104, v105
    v_fma_f32 v106, v106, s28, v9
    v_fma_f32 v107, v107, s28, v9
    v_exp_f32_e64 v106, v106 clamp
    v_exp_f32_e64 v107, v107 clamp
    s_nop 0
    v_cvt_pk_bf16_f32 v15, v106, v107
    v_fma_f32 v108, v108, s28, v9
    v_fma_f32 v109, v109, s28, v9
    v_exp_f32_e64 v108, v108 clamp
    v_exp_f32_e64 v109, v109 clamp
    s_nop 0
    v_cvt_pk_bf16_f32 v16, v108, v109
    v_fma_f32 v110, v110, s28, v9
    v_fma_f32 v111, v111, s28, v9
    v_exp_f32_e64 v110, v110 clamp
    v_exp_f32_e64 v111, v111 clamp
    s_nop 0
    v_cvt_pk_bf16_f32 v17, v110, v111
    s_add_u32 s69, s39, 0
    buffer_load_dwordx4 v[92:95], v30, s[4:7], s69 offen offset:0
    s_waitcnt vmcnt(0)
    v_mfma_f32_16x16x32_bf16 v[104:107], v[92:95], a[120:123], 0
    s_nop 7
    buffer_load_dwordx4 v[92:95], v30, s[4:7], s69 offen offset:64
    s_waitcnt vmcnt(0)
    v_mfma_f32_16x16x32_bf16 v[104:107], v[92:95], a[124:127], v[104:107]
    s_nop 7
    buffer_load_dwordx4 v[92:95], v30, s[4:7], s69 offen offset:128
    s_waitcnt vmcnt(0)
    v_mfma_f32_16x16x32_bf16 v[104:107], v[92:95], a[128:131], v[104:107]
    s_nop 7
    buffer_load_dwordx4 v[92:95], v30, s[4:7], s69 offen offset:192
    s_waitcnt vmcnt(0)
    v_mfma_f32_16x16x32_bf16 v[104:107], v[92:95], a[132:135], v[104:107]
    s_nop 7
    buffer_load_dwordx4 v[92:95], v30, s[4:7], s69 offen offset:256
    s_waitcnt vmcnt(0)
    v_mfma_f32_16x16x32_bf16 v[104:107], v[92:95], a[136:139], v[104:107]
    s_nop 7
    buffer_load_dwordx4 v[92:95], v30, s[4:7], s69 offen offset:320
    s_waitcnt vmcnt(0)
    v_mfma_f32_16x16x32_bf16 v[104:107], v[92:95], a[140:143], v[104:107]
    s_nop 7
    s_add_u32 s69, s39, 6144
    buffer_load_dwordx4 v[92:95], v30, s[4:7], s69 offen offset:0
    s_waitcnt vmcnt(0)
    v_mfma_f32_16x16x32_bf16 v[108:111], v[92:95], a[120:123], 0
    s_nop 7
    buffer_load_dwordx4 v[92:95], v30, s[4:7], s69 offen offset:64
    s_waitcnt vmcnt(0)
    v_mfma_f32_16x16x32_bf16 v[108:111], v[92:95], a[124:127], v[108:111]
    s_nop 7
    buffer_load_dwordx4 v[92:95], v30, s[4:7], s69 offen offset:128
    s_waitcnt vmcnt(0)
    v_mfma_f32_16x16x32_bf16 v[108:111], v[92:95], a[128:131], v[108:111]
    s_nop 7
    buffer_load_dwordx4 v[92:95], v30, s[4:7], s69 offen offset:192
    s_waitcnt vmcnt(0)
    v_mfma_f32_16x16x32_bf16 v[108:111], v[92:95], a[132:135], v[108:111]
    s_nop 7
    buffer_load_dwordx4 v[92:95], v30, s[4:7], s69 offen offset:256
    s_waitcnt vmcnt(0)
    v_mfma_f32_16x16x32_bf16 v[108:111], v[92:95], a[136:139], v[108:111]
    s_nop 7
    buffer_load_dwordx4 v[92:95], v30, s[4:7], s69 offen offset:320
    s_waitcnt vmcnt(0)
    v_mfma_f32_16x16x32_bf16 v[108:111], v[92:95], a[140:143], v[108:111]
    s_nop 7
    s_nop 15
    v_max3_f32 v18, v104, v105, v106
    v_max3_f32 v18, v18, v107, v108
    v_max3_f32 v18, v18, v109, v110
    v_max_f32 v18, v18, v111
    v_mov_b32 v19, v18
    s_nop 1
    v_permlane32_swap_b32 v19, v18
    v_max_f32 v18, v18, v19
    v_mov_b32 v19, v18
    s_nop 1
    v_permlane16_swap_b32 v19, v18
    v_max_f32 v18, v18, v19
    v_fma_f32 v18, v18, s28, v10
    v_add_f32 v18, 0x42000000, v18
    v_max_f32 v20, 0, v18
    v_sub_f32 v10, v10, v20
    v_sub_f32 v21, 0, v20
    v_exp_f32 v21, v21
    s_nop 0
    v_mul_f32 v19, v45, v21
    v_cndmask_b32_e64 v45, v19, v45, s[46:47]
    v_mul_f32 v19, v49, v21
    v_cndmask_b32_e64 v49, v49, v19, s[46:47]
    v_mul_f32 v160, v160, v21
    v_mul_f32 v161, v161, v21
    v_mul_f32 v162, v162, v21
    v_mul_f32 v163, v163, v21
    v_mul_f32 v164, v164, v21
    v_mul_f32 v165, v165, v21
    v_mul_f32 v166, v166, v21
    v_mul_f32 v167, v167, v21
    v_mul_f32 v168, v168, v21
    v_mul_f32 v169, v169, v21
    v_mul_f32 v170, v170, v21
    v_mul_f32 v171, v171, v21
    v_mul_f32 v172, v172, v21
    v_mul_f32 v173, v173, v21
    v_mul_f32 v174, v174, v21
    v_mul_f32 v175, v175, v21
    v_mul_f32 v176, v176, v21
    v_mul_f32 v177, v177, v21
    v_mul_f32 v178, v178, v21
    v_mul_f32 v179, v179, v21
    v_mul_f32 v180, v180, v21
    v_mul_f32 v181, v181, v21
    v_mul_f32 v182, v182, v21
    v_mul_f32 v183, v183, v21
    v_mul_f32 v184, v184, v21
    v_mul_f32 v185, v185, v21
    v_mul_f32 v186, v186, v21
    v_mul_f32 v187, v187, v21
    v_mul_f32 v188, v188, v21
    v_mul_f32 v189, v189, v21
    v_mul_f32 v190, v190, v21
    v_mul_f32 v191, v191, v21
    v_mul_f32 v192, v192, v21
    v_mul_f32 v193, v193, v21
    v_mul_f32 v194, v194, v21
    v_mul_f32 v195, v195, v21
    v_mul_f32 v196, v196, v21
    v_mul_f32 v197, v197, v21
    v_mul_f32 v198, v198, v21
    v_mul_f32 v199, v199, v21
    v_mul_f32 v200, v200, v21
    v_mul_f32 v201, v201, v21
    v_mul_f32 v202, v202, v21
    v_mul_f32 v203, v203, v21
    v_mul_f32 v204, v204, v21
    v_mul_f32 v205, v205, v21
    v_mul_f32 v206, v206, v21
    v_mul_f32 v207, v207, v21
    v_fma_f32 v104, v104, s28, v10
    v_fma_f32 v105, v105, s28, v10
    v_exp_f32_e64 v104, v104 clamp
    v_exp_f32_e64 v105, v105 clamp
    s_nop 0
    v_cvt_pk_bf16_f32 v22, v104, v105
    v_fma_f32 v106, v106, s28, v10
    v_fma_f32 v107, v107, s28, v10
    v_exp_f32_e64 v106, v106 clamp
    v_exp_f32_e64 v107, v107 clamp
    s_nop 0
    v_cvt_pk_bf16_f32 v23, v106, v107
    v_fma_f32 v108, v108, s28, v10
    v_fma_f32 v109, v109, s28, v10
    v_exp_f32_e64 v108, v108 clamp
    v_exp_f32_e64 v109, v109 clamp
    s_nop 0
    v_cvt_pk_bf16_f32 v24, v108, v109
    v_fma_f32 v110, v110, s28, v10
    v_fma_f32 v111, v111, s28, v10
    v_exp_f32_e64 v110, v110 clamp
    v_exp_f32_e64 v111, v111 clamp
    s_nop 0
    v_cvt_pk_bf16_f32 v25, v110, v111
    s_add_u32 s69, s39, 0
    buffer_load_dwordx4 v[92:95], v30, s[4:7], s69 offen offset:0
    s_waitcnt vmcnt(0)
    v_mfma_f32_16x16x32_bf16 v[104:107], v[92:95], a[144:147], 0
    s_nop 7
    buffer_load_dwordx4 v[92:95], v30, s[4:7], s69 offen offset:64
    s_waitcnt vmcnt(0)
    v_mfma_f32_16x16x32_bf16 v[104:107], v[92:95], a[148:151], v[104:107]
    s_nop 7
    buffer_load_dwordx4 v[92:95], v30, s[4:7], s69 offen offset:128
    s_waitcnt vmcnt(0)
    v_mfma_f32_16x16x32_bf16 v[104:107], v[92:95], a[152:155], v[104:107]
    s_nop 7
    buffer_load_dwordx4 v[92:95], v30, s[4:7], s69 offen offset:192
    s_waitcnt vmcnt(0)
    v_mfma_f32_16x16x32_bf16 v[104:107], v[92:95], a[156:159], v[104:107]
    s_nop 7
    buffer_load_dwordx4 v[92:95], v30, s[4:7], s69 offen offset:256
    s_waitcnt vmcnt(0)
    v_mfma_f32_16x16x32_bf16 v[104:107], v[92:95], a[160:163], v[104:107]
    s_nop 7
    buffer_load_dwordx4 v[92:95], v30, s[4:7], s69 offen offset:320
    s_waitcnt vmcnt(0)
    v_mfma_f32_16x16x32_bf16 v[104:107], v[92:95], a[164:167], v[104:107]
    s_nop 7
    s_add_u32 s69, s39, 6144
    buffer_load_dwordx4 v[92:95], v30, s[4:7], s69 offen offset:0
    s_waitcnt vmcnt(0)
    v_mfma_f32_16x16x32_bf16 v[108:111], v[92:95], a[144:147], 0
    s_nop 7
    buffer_load_dwordx4 v[92:95], v30, s[4:7], s69 offen offset:64
    s_waitcnt vmcnt(0)
    v_mfma_f32_16x16x32_bf16 v[108:111], v[92:95], a[148:151], v[108:111]
    s_nop 7
    buffer_load_dwordx4 v[92:95], v30, s[4:7], s69 offen offset:128
    s_waitcnt vmcnt(0)
    v_mfma_f32_16x16x32_bf16 v[108:111], v[92:95], a[152:155], v[108:111]
    s_nop 7
    buffer_load_dwordx4 v[92:95], v30, s[4:7], s69 offen offset:192
    s_waitcnt vmcnt(0)
    v_mfma_f32_16x16x32_bf16 v[108:111], v[92:95], a[156:159], v[108:111]
    s_nop 7
    buffer_load_dwordx4 v[92:95], v30, s[4:7], s69 offen offset:256
    s_waitcnt vmcnt(0)
    v_mfma_f32_16x16x32_bf16 v[108:111], v[92:95], a[160:163], v[108:111]
    s_nop 7
    buffer_load_dwordx4 v[92:95], v30, s[4:7], s69 offen offset:320
    s_waitcnt vmcnt(0)
    v_mfma_f32_16x16x32_bf16 v[108:111], v[92:95], a[164:167], v[108:111]
    s_nop 7
    s_nop 15
    v_max3_f32 v18, v104, v105, v106
    v_max3_f32 v18, v18, v107, v108
    v_max3_f32 v18, v18, v109, v110
    v_max_f32 v18, v18, v111
    v_mov_b32 v19, v18
    s_nop 1
    v_permlane32_swap_b32 v19, v18
    v_max_f32 v18, v18, v19
    v_mov_b32 v19, v18
    s_nop 1
    v_permlane16_swap_b32 v19, v18
    v_max_f32 v18, v18, v19
    v_fma_f32 v18, v18, s28, v11
    v_add_f32 v18, 0x42000000, v18
    v_max_f32 v20, 0, v18
    v_sub_f32 v11, v11, v20
    v_sub_f32 v21, 0, v20
    v_exp_f32 v21, v21
    s_nop 0
    v_mul_f32 v19, v45, v21
    v_cndmask_b32_e64 v45, v45, v19, s[46:47]
    v_mul_f32 v19, v50, v21
    v_cndmask_b32_e64 v50, v19, v50, s[46:47]
    v_mul_f32 v208, v208, v21
    v_mul_f32 v209, v209, v21
    v_mul_f32 v210, v210, v21
    v_mul_f32 v211, v211, v21
    v_mul_f32 v212, v212, v21
    v_mul_f32 v213, v213, v21
    v_mul_f32 v214, v214, v21
    v_mul_f32 v215, v215, v21
    v_mul_f32 v216, v216, v21
    v_mul_f32 v217, v217, v21
    v_mul_f32 v218, v218, v21
    v_mul_f32 v219, v219, v21
    v_mul_f32 v220, v220, v21
    v_mul_f32 v221, v221, v21
    v_mul_f32 v222, v222, v21
    v_mul_f32 v223, v223, v21
    v_mul_f32 v224, v224, v21
    v_mul_f32 v225, v225, v21
    v_mul_f32 v226, v226, v21
    v_mul_f32 v227, v227, v21
    v_mul_f32 v228, v228, v21
    v_mul_f32 v229, v229, v21
    v_mul_f32 v230, v230, v21
    v_mul_f32 v231, v231, v21
    v_mul_f32 v232, v232, v21
    v_mul_f32 v233, v233, v21
    v_mul_f32 v234, v234, v21
    v_mul_f32 v235, v235, v21
    v_mul_f32 v236, v236, v21
    v_mul_f32 v237, v237, v21
    v_mul_f32 v238, v238, v21
    v_mul_f32 v239, v239, v21
    v_mul_f32 v240, v240, v21
    v_mul_f32 v241, v241, v21
    v_mul_f32 v242, v242, v21
    v_mul_f32 v243, v243, v21
    v_mul_f32 v244, v244, v21
    v_mul_f32 v245, v245, v21
    v_mul_f32 v246, v246, v21
    v_mul_f32 v247, v247, v21
    v_mul_f32 v248, v248, v21
    v_mul_f32 v249, v249, v21
    v_mul_f32 v250, v250, v21
    v_mul_f32 v251, v251, v21
    v_mul_f32 v252, v252, v21
    v_mul_f32 v253, v253, v21
    v_mul_f32 v254, v254, v21
    v_mul_f32 v255, v255, v21
    v_fma_f32 v104, v104, s28, v11
    v_fma_f32 v105, v105, s28, v11
    v_exp_f32_e64 v104, v104 clamp
    v_exp_f32_e64 v105, v105 clamp
    s_nop 0
    v_cvt_pk_bf16_f32 v26, v104, v105
    v_fma_f32 v106, v106, s28, v11
    v_fma_f32 v107, v107, s28, v11
    v_exp_f32_e64 v106, v106 clamp
    v_exp_f32_e64 v107, v107 clamp
    s_nop 0
    v_cvt_pk_bf16_f32 v27, v106, v107
    v_fma_f32 v108, v108, s28, v11
    v_fma_f32 v109, v109, s28, v11
    v_exp_f32_e64 v108, v108 clamp
    v_exp_f32_e64 v109, v109 clamp
    s_nop 0
    v_cvt_pk_bf16_f32 v28, v108, v109
    v_fma_f32 v110, v110, s28, v11
    v_fma_f32 v111, v111, s28, v11
    v_exp_f32_e64 v110, v110 clamp
    v_exp_f32_e64 v111, v111 clamp
    s_nop 0
    v_cvt_pk_bf16_f32 v29, v110, v111
    s_add_u32 s69, s39, 0
    buffer_load_dwordx4 v[92:95], v30, s[4:7], s69 offen offset:0
    s_waitcnt vmcnt(0)
    v_mfma_f32_16x16x32_bf16 v[104:107], v[92:95], a[168:171], 0
    s_nop 7
    buffer_load_dwordx4 v[92:95], v30, s[4:7], s69 offen offset:64
    s_waitcnt vmcnt(0)
    v_mfma_f32_16x16x32_bf16 v[104:107], v[92:95], a[172:175], v[104:107]
    s_nop 7
    buffer_load_dwordx4 v[92:95], v30, s[4:7], s69 offen offset:128
    s_waitcnt vmcnt(0)
    v_mfma_f32_16x16x32_bf16 v[104:107], v[92:95], a[176:179], v[104:107]
    s_nop 7
    buffer_load_dwordx4 v[92:95], v30, s[4:7], s69 offen offset:192
    s_waitcnt vmcnt(0)
    v_mfma_f32_16x16x32_bf16 v[104:107], v[92:95], a[180:183], v[104:107]
    s_nop 7
    buffer_load_dwordx4 v[92:95], v30, s[4:7], s69 offen offset:256
    s_waitcnt vmcnt(0)
    v_mfma_f32_16x16x32_bf16 v[104:107], v[92:95], a[184:187], v[104:107]
    s_nop 7
    buffer_load_dwordx4 v[92:95], v30, s[4:7], s69 offen offset:320
    s_waitcnt vmcnt(0)
    v_mfma_f32_16x16x32_bf16 v[104:107], v[92:95], a[188:191], v[104:107]
    s_nop 7
    s_add_u32 s69, s39, 6144
    buffer_load_dwordx4 v[92:95], v30, s[4:7], s69 offen offset:0
    s_waitcnt vmcnt(0)
    v_mfma_f32_16x16x32_bf16 v[108:111], v[92:95], a[168:171], 0
    s_nop 7
    buffer_load_dwordx4 v[92:95], v30, s[4:7], s69 offen offset:64
    s_waitcnt vmcnt(0)
    v_mfma_f32_16x16x32_bf16 v[108:111], v[92:95], a[172:175], v[108:111]
    s_nop 7
    buffer_load_dwordx4 v[92:95], v30, s[4:7], s69 offen offset:128
    s_waitcnt vmcnt(0)
    v_mfma_f32_16x16x32_bf16 v[108:111], v[92:95], a[176:179], v[108:111]
    s_nop 7
    buffer_load_dwordx4 v[92:95], v30, s[4:7], s69 offen offset:192
    s_waitcnt vmcnt(0)
    v_mfma_f32_16x16x32_bf16 v[108:111], v[92:95], a[180:183], v[108:111]
    s_nop 7
    buffer_load_dwordx4 v[92:95], v30, s[4:7], s69 offen offset:256
    s_waitcnt vmcnt(0)
    v_mfma_f32_16x16x32_bf16 v[108:111], v[92:95], a[184:187], v[108:111]
    s_nop 7
    buffer_load_dwordx4 v[92:95], v30, s[4:7], s69 offen offset:320
    s_waitcnt vmcnt(0)
    v_mfma_f32_16x16x32_bf16 v[108:111], v[92:95], a[188:191], v[108:111]
    s_nop 7
    s_nop 15
    v_max3_f32 v18, v104, v105, v106
    v_max3_f32 v18, v18, v107, v108
    v_max3_f32 v18, v18, v109, v110
    v_max_f32 v18, v18, v111
    v_mov_b32 v19, v18
    s_nop 1
    v_permlane32_swap_b32 v19, v18
    v_max_f32 v18, v18, v19
    v_mov_b32 v19, v18
    s_nop 1
    v_permlane16_swap_b32 v19, v18
    v_max_f32 v18, v18, v19
    v_fma_f32 v18, v18, s28, v12
    v_add_f32 v18, 0x42000000, v18
    v_max_f32 v20, 0, v18
    v_sub_f32 v12, v12, v20
    v_sub_f32 v21, 0, v20
    v_exp_f32 v21, v21
    s_nop 0
    v_mul_f32 v19, v46, v21
    v_cndmask_b32_e64 v46, v19, v46, s[46:47]
    v_mul_f32 v19, v50, v21
    v_cndmask_b32_e64 v50, v50, v19, s[46:47]
    v_accvgpr_read_b32 v19, a0
    v_mul_f32 v19, v19, v21
    v_accvgpr_write_b32 a0, v19
    v_accvgpr_read_b32 v19, a1
    v_mul_f32 v19, v19, v21
    v_accvgpr_write_b32 a1, v19
    v_accvgpr_read_b32 v19, a2
    v_mul_f32 v19, v19, v21
    v_accvgpr_write_b32 a2, v19
    v_accvgpr_read_b32 v19, a3
    v_mul_f32 v19, v19, v21
    v_accvgpr_write_b32 a3, v19
    v_accvgpr_read_b32 v19, a4
    v_mul_f32 v19, v19, v21
    v_accvgpr_write_b32 a4, v19
    v_accvgpr_read_b32 v19, a5
    v_mul_f32 v19, v19, v21
    v_accvgpr_write_b32 a5, v19
    v_accvgpr_read_b32 v19, a6
    v_mul_f32 v19, v19, v21
    v_accvgpr_write_b32 a6, v19
    v_accvgpr_read_b32 v19, a7
    v_mul_f32 v19, v19, v21
    v_accvgpr_write_b32 a7, v19
    v_accvgpr_read_b32 v19, a8
    v_mul_f32 v19, v19, v21
    v_accvgpr_write_b32 a8, v19
    v_accvgpr_read_b32 v19, a9
    v_mul_f32 v19, v19, v21
    v_accvgpr_write_b32 a9, v19
    v_accvgpr_read_b32 v19, a10
    v_mul_f32 v19, v19, v21
    v_accvgpr_write_b32 a10, v19
    v_accvgpr_read_b32 v19, a11
    v_mul_f32 v19, v19, v21
    v_accvgpr_write_b32 a11, v19
    v_accvgpr_read_b32 v19, a12
    v_mul_f32 v19, v19, v21
    v_accvgpr_write_b32 a12, v19
    v_accvgpr_read_b32 v19, a13
    v_mul_f32 v19, v19, v21
    v_accvgpr_write_b32 a13, v19
    v_accvgpr_read_b32 v19, a14
    v_mul_f32 v19, v19, v21
    v_accvgpr_write_b32 a14, v19
    v_accvgpr_read_b32 v19, a15
    v_mul_f32 v19, v19, v21
    v_accvgpr_write_b32 a15, v19
    v_accvgpr_read_b32 v19, a16
    v_mul_f32 v19, v19, v21
    v_accvgpr_write_b32 a16, v19
    v_accvgpr_read_b32 v19, a17
    v_mul_f32 v19, v19, v21
    v_accvgpr_write_b32 a17, v19
    v_accvgpr_read_b32 v19, a18
    v_mul_f32 v19, v19, v21
    v_accvgpr_write_b32 a18, v19
    v_accvgpr_read_b32 v19, a19
    v_mul_f32 v19, v19, v21
    v_accvgpr_write_b32 a19, v19
    v_accvgpr_read_b32 v19, a20
    v_mul_f32 v19, v19, v21
    v_accvgpr_write_b32 a20, v19
    v_accvgpr_read_b32 v19, a21
    v_mul_f32 v19, v19, v21
    v_accvgpr_write_b32 a21, v19
    v_accvgpr_read_b32 v19, a22
    v_mul_f32 v19, v19, v21
    v_accvgpr_write_b32 a22, v19
    v_accvgpr_read_b32 v19, a23
    v_mul_f32 v19, v19, v21
    v_accvgpr_write_b32 a23, v19
    v_accvgpr_read_b32 v19, a24
    v_mul_f32 v19, v19, v21
    v_accvgpr_write_b32 a24, v19
    v_accvgpr_read_b32 v19, a25
    v_mul_f32 v19, v19, v21
    v_accvgpr_write_b32 a25, v19
    v_accvgpr_read_b32 v19, a26
    v_mul_f32 v19, v19, v21
    v_accvgpr_write_b32 a26, v19
    v_accvgpr_read_b32 v19, a27
    v_mul_f32 v19, v19, v21
    v_accvgpr_write_b32 a27, v19
    v_accvgpr_read_b32 v19, a28
    v_mul_f32 v19, v19, v21
    v_accvgpr_write_b32 a28, v19
    v_accvgpr_read_b32 v19, a29
    v_mul_f32 v19, v19, v21
    v_accvgpr_write_b32 a29, v19
    v_accvgpr_read_b32 v19, a30
    v_mul_f32 v19, v19, v21
    v_accvgpr_write_b32 a30, v19
    v_accvgpr_read_b32 v19, a31
    v_mul_f32 v19, v19, v21
    v_accvgpr_write_b32 a31, v19
    v_accvgpr_read_b32 v19, a32
    v_mul_f32 v19, v19, v21
    v_accvgpr_write_b32 a32, v19
    v_accvgpr_read_b32 v19, a33
    v_mul_f32 v19, v19, v21
    v_accvgpr_write_b32 a33, v19
    v_accvgpr_read_b32 v19, a34
    v_mul_f32 v19, v19, v21
    v_accvgpr_write_b32 a34, v19
    v_accvgpr_read_b32 v19, a35
    v_mul_f32 v19, v19, v21
    v_accvgpr_write_b32 a35, v19
    v_accvgpr_read_b32 v19, a36
    v_mul_f32 v19, v19, v21
    v_accvgpr_write_b32 a36, v19
    v_accvgpr_read_b32 v19, a37
    v_mul_f32 v19, v19, v21
    v_accvgpr_write_b32 a37, v19
    v_accvgpr_read_b32 v19, a38
    v_mul_f32 v19, v19, v21
    v_accvgpr_write_b32 a38, v19
    v_accvgpr_read_b32 v19, a39
    v_mul_f32 v19, v19, v21
    v_accvgpr_write_b32 a39, v19
    v_accvgpr_read_b32 v19, a40
    v_mul_f32 v19, v19, v21
    v_accvgpr_write_b32 a40, v19
    v_accvgpr_read_b32 v19, a41
    v_mul_f32 v19, v19, v21
    v_accvgpr_write_b32 a41, v19
    v_accvgpr_read_b32 v19, a42
    v_mul_f32 v19, v19, v21
    v_accvgpr_write_b32 a42, v19
    v_accvgpr_read_b32 v19, a43
    v_mul_f32 v19, v19, v21
    v_accvgpr_write_b32 a43, v19
    v_accvgpr_read_b32 v19, a44
    v_mul_f32 v19, v19, v21
    v_accvgpr_write_b32 a44, v19
    v_accvgpr_read_b32 v19, a45
    v_mul_f32 v19, v19, v21
    v_accvgpr_write_b32 a45, v19
    v_accvgpr_read_b32 v19, a46
    v_mul_f32 v19, v19, v21
    v_accvgpr_write_b32 a46, v19
    v_accvgpr_read_b32 v19, a47
    v_mul_f32 v19, v19, v21
    v_accvgpr_write_b32 a47, v19
    v_fma_f32 v104, v104, s28, v12
    v_fma_f32 v105, v105, s28, v12
    v_exp_f32_e64 v104, v104 clamp
    v_exp_f32_e64 v105, v105 clamp
    s_nop 0
    v_cvt_pk_bf16_f32 v34, v104, v105
    v_fma_f32 v106, v106, s28, v12
    v_fma_f32 v107, v107, s28, v12
    v_exp_f32_e64 v106, v106 clamp
    v_exp_f32_e64 v107, v107 clamp
    s_nop 0
    v_cvt_pk_bf16_f32 v35, v106, v107
    v_fma_f32 v108, v108, s28, v12
    v_fma_f32 v109, v109, s28, v12
    v_exp_f32_e64 v108, v108 clamp
    v_exp_f32_e64 v109, v109 clamp
    s_nop 0
    v_cvt_pk_bf16_f32 v36, v108, v109
    v_fma_f32 v110, v110, s28, v12
    v_fma_f32 v111, v111, s28, v12
    v_exp_f32_e64 v110, v110 clamp
    v_exp_f32_e64 v111, v111 clamp
    s_nop 0
    v_cvt_pk_bf16_f32 v37, v110, v111
    v_mfma_f32_16x16x32_bf16 v[44:47], a[248:251], v[14:17], v[44:47]
    v_smfmac_f32_16x16x64_bf16 v[44:47], a[240:243], v[22:29], v101
    v_mfma_f32_16x16x32_bf16 v[44:47], a[252:255], v[34:37], v[44:47]
    s_nop 15
    s_setpc_b64 s[40:41]
L_rare4_1:
    s_nop 15
    v_mov_b32 v104, 0
    v_mov_b32 v105, 0
    v_mov_b32 v106, 0
    v_mov_b32 v107, 0
    s_nop 1
    v_smfmac_f32_16x16x64_bf16 v[104:107], a[240:243], v[16:23], v101
    v_smfmac_f32_16x16x64_bf16 v[104:107], a[244:247], v[28:35], v101
    s_nop 15
    v_sub_f32 v49, v49, v105
    v_sub_f32 v50, v50, v106
    v_sub_f32 v51, v51, v107
    v_mov_b32 v44, 0
    v_mov_b32 v48, 0
    v_mbcnt_lo_u32_b32 v27, -1, 0
    v_mbcnt_hi_u32_b32 v27, -1, v27
    v_and_b32 v26, 15, v27
    v_mul_u32_u24 v26, 384, v26
    v_lshrrev_b32 v27, 4, v27
    v_lshl_add_u32 v26, v27, 4, v26
    s_add_u32 s69, s39, 0
    buffer_load_dwordx4 v[92:95], v26, s[4:7], s69 offen offset:0
    s_waitcnt vmcnt(0)
    v_mfma_f32_16x16x32_bf16 v[104:107], v[92:95], a[96:99], 0
    s_nop 7
    buffer_load_dwordx4 v[92:95], v26, s[4:7], s69 offen offset:64
    s_waitcnt vmcnt(0)
    v_mfma_f32_16x16x32_bf16 v[104:107], v[92:95], a[100:103], v[104:107]
    s_nop 7
    buffer_load_dwordx4 v[92:95], v26, s[4:7], s69 offen offset:128
    s_waitcnt vmcnt(0)
    v_mfma_f32_16x16x32_bf16 v[104:107], v[92:95], a[104:107], v[104:107]
    s_nop 7
    buffer_load_dwordx4 v[92:95], v26, s[4:7], s69 offen offset:192
    s_waitcnt vmcnt(0)
    v_mfma_f32_16x16x32_bf16 v[104:107], v[92:95], a[108:111], v[104:107]
    s_nop 7
    buffer_load_dwordx4 v[92:95], v26, s[4:7], s69 offen offset:256
    s_waitcnt vmcnt(0)
    v_mfma_f32_16x16x32_bf16 v[104:107], v[92:95], a[112:115], v[104:107]
    s_nop 7
    buffer_load_dwordx4 v[92:95], v26, s[4:7], s69 offen offset:320
    s_waitcnt vmcnt(0)
    v_mfma_f32_16x16x32_bf16 v[104:107], v[92:95], a[116:119], v[104:107]
    s_nop 7
    s_add_u32 s69, s39, 6144
    buffer_load_dwordx4 v[92:95], v26, s[4:7], s69 offen offset:0
    s_waitcnt vmcnt(0)
    v_mfma_f32_16x16x32_bf16 v[108:111], v[92:95], a[96:99], 0
    s_nop 7
    buffer_load_dwordx4 v[92:95], v26, s[4:7], s69 offen offset:64
    s_waitcnt vmcnt(0)
    v_mfma_f32_16x16x32_bf16 v[108:111], v[92:95], a[100:103], v[108:111]
    s_nop 7
    buffer_load_dwordx4 v[92:95], v26, s[4:7], s69 offen offset:128
    s_waitcnt vmcnt(0)
    v_mfma_f32_16x16x32_bf16 v[108:111], v[92:95], a[104:107], v[108:111]
    s_nop 7
    buffer_load_dwordx4 v[92:95], v26, s[4:7], s69 offen offset:192
    s_waitcnt vmcnt(0)
    v_mfma_f32_16x16x32_bf16 v[108:111], v[92:95], a[108:111], v[108:111]
    s_nop 7
    buffer_load_dwordx4 v[92:95], v26, s[4:7], s69 offen offset:256
    s_waitcnt vmcnt(0)
    v_mfma_f32_16x16x32_bf16 v[108:111], v[92:95], a[112:115], v[108:111]
    s_nop 7
    buffer_load_dwordx4 v[92:95], v26, s[4:7], s69 offen offset:320
    s_waitcnt vmcnt(0)
    v_mfma_f32_16x16x32_bf16 v[108:111], v[92:95], a[116:119], v[108:111]
    s_nop 7
    s_nop 15
    v_max3_f32 v14, v104, v105, v106
    v_max3_f32 v14, v14, v107, v108
    v_max3_f32 v14, v14, v109, v110
    v_max_f32 v14, v14, v111
    v_mov_b32 v15, v14
    s_nop 1
    v_permlane32_swap_b32 v15, v14
    v_max_f32 v14, v14, v15
    v_mov_b32 v15, v14
    s_nop 1
    v_permlane16_swap_b32 v15, v14
    v_max_f32 v14, v14, v15
    v_fma_f32 v14, v14, s28, v9
    v_add_f32 v14, 0x42000000, v14
    v_max_f32 v24, 0, v14
    v_sub_f32 v9, v9, v24
    v_sub_f32 v25, 0, v24
    v_exp_f32 v25, v25
    s_nop 0
    v_mul_f32 v47, v47, v25
    v_mul_f32 v15, v49, v25
    v_cndmask_b32_e64 v49, v15, v49, s[46:47]
    v_mul_f32 v112, v112, v25
    v_mul_f32 v113, v113, v25
    v_mul_f32 v114, v114, v25
    v_mul_f32 v115, v115, v25
    v_mul_f32 v116, v116, v25
    v_mul_f32 v117, v117, v25
    v_mul_f32 v118, v118, v25
    v_mul_f32 v119, v119, v25
    v_mul_f32 v120, v120, v25
    v_mul_f32 v121, v121, v25
    v_mul_f32 v122, v122, v25
    v_mul_f32 v123, v123, v25
    v_mul_f32 v124, v124, v25
    v_mul_f32 v125, v125, v25
    v_mul_f32 v126, v126, v25
    v_mul_f32 v127, v127, v25
    v_mul_f32 v128, v128, v25
    v_mul_f32 v129, v129, v25
    v_mul_f32 v130, v130, v25
    v_mul_f32 v131, v131, v25
    v_mul_f32 v132, v132, v25
    v_mul_f32 v133, v133, v25
    v_mul_f32 v134, v134, v25
    v_mul_f32 v135, v135, v25
    v_mul_f32 v136, v136, v25
    v_mul_f32 v137, v137, v25
    v_mul_f32 v138, v138, v25
    v_mul_f32 v139, v139, v25
    v_mul_f32 v140, v140, v25
    v_mul_f32 v141, v141, v25
    v_mul_f32 v142, v142, v25
    v_mul_f32 v143, v143, v25
    v_mul_f32 v144, v144, v25
    v_mul_f32 v145, v145, v25
    v_mul_f32 v146, v146, v25
    v_mul_f32 v147, v147, v25
    v_mul_f32 v148, v148, v25
    v_mul_f32 v149, v149, v25
    v_mul_f32 v150, v150, v25
    v_mul_f32 v151, v151, v25
    v_mul_f32 v152, v152, v25
    v_mul_f32 v153, v153, v25
    v_mul_f32 v154, v154, v25
    v_mul_f32 v155, v155, v25
    v_mul_f32 v156, v156, v25
    v_mul_f32 v157, v157, v25
    v_mul_f32 v158, v158, v25
    v_mul_f32 v159, v159, v25
    v_fma_f32 v104, v104, s28, v9
    v_fma_f32 v105, v105, s28, v9
    v_exp_f32_e64 v104, v104 clamp
    v_exp_f32_e64 v105, v105 clamp
    s_nop 0
    v_cvt_pk_bf16_f32 v18, v104, v105
    v_fma_f32 v106, v106, s28, v9
    v_fma_f32 v107, v107, s28, v9
    v_exp_f32_e64 v106, v106 clamp
    v_exp_f32_e64 v107, v107 clamp
    s_nop 0
    v_cvt_pk_bf16_f32 v19, v106, v107
    v_fma_f32 v108, v108, s28, v9
    v_fma_f32 v109, v109, s28, v9
    v_exp_f32_e64 v108, v108 clamp
    v_exp_f32_e64 v109, v109 clamp
    s_nop 0
    v_cvt_pk_bf16_f32 v16, v108, v109
    v_fma_f32 v110, v110, s28, v9
    v_fma_f32 v111, v111, s28, v9
    v_exp_f32_e64 v110, v110 clamp
    v_exp_f32_e64 v111, v111 clamp
    s_nop 0
    v_cvt_pk_bf16_f32 v17, v110, v111
    s_add_u32 s69, s39, 0
    buffer_load_dwordx4 v[92:95], v26, s[4:7], s69 offen offset:0
    s_waitcnt vmcnt(0)
    v_mfma_f32_16x16x32_bf16 v[104:107], v[92:95], a[120:123], 0
    s_nop 7
    buffer_load_dwordx4 v[92:95], v26, s[4:7], s69 offen offset:64
    s_waitcnt vmcnt(0)
    v_mfma_f32_16x16x32_bf16 v[104:107], v[92:95], a[124:127], v[104:107]
    s_nop 7
    buffer_load_dwordx4 v[92:95], v26, s[4:7], s69 offen offset:128
    s_waitcnt vmcnt(0)
    v_mfma_f32_16x16x32_bf16 v[104:107], v[92:95], a[128:131], v[104:107]
    s_nop 7
    buffer_load_dwordx4 v[92:95], v26, s[4:7], s69 offen offset:192
    s_waitcnt vmcnt(0)
    v_mfma_f32_16x16x32_bf16 v[104:107], v[92:95], a[132:135], v[104:107]
    s_nop 7
    buffer_load_dwordx4 v[92:95], v26, s[4:7], s69 offen offset:256
    s_waitcnt vmcnt(0)
    v_mfma_f32_16x16x32_bf16 v[104:107], v[92:95], a[136:139], v[104:107]
    s_nop 7
    buffer_load_dwordx4 v[92:95], v26, s[4:7], s69 offen offset:320
    s_waitcnt vmcnt(0)
    v_mfma_f32_16x16x32_bf16 v[104:107], v[92:95], a[140:143], v[104:107]
    s_nop 7
    s_add_u32 s69, s39, 6144
    buffer_load_dwordx4 v[92:95], v26, s[4:7], s69 offen offset:0
    s_waitcnt vmcnt(0)
    v_mfma_f32_16x16x32_bf16 v[108:111], v[92:95], a[120:123], 0
    s_nop 7
    buffer_load_dwordx4 v[92:95], v26, s[4:7], s69 offen offset:64
    s_waitcnt vmcnt(0)
    v_mfma_f32_16x16x32_bf16 v[108:111], v[92:95], a[124:127], v[108:111]
    s_nop 7
    buffer_load_dwordx4 v[92:95], v26, s[4:7], s69 offen offset:128
    s_waitcnt vmcnt(0)
    v_mfma_f32_16x16x32_bf16 v[108:111], v[92:95], a[128:131], v[108:111]
    s_nop 7
    buffer_load_dwordx4 v[92:95], v26, s[4:7], s69 offen offset:192
    s_waitcnt vmcnt(0)
    v_mfma_f32_16x16x32_bf16 v[108:111], v[92:95], a[132:135], v[108:111]
    s_nop 7
    buffer_load_dwordx4 v[92:95], v26, s[4:7], s69 offen offset:256
    s_waitcnt vmcnt(0)
    v_mfma_f32_16x16x32_bf16 v[108:111], v[92:95], a[136:139], v[108:111]
    s_nop 7
    buffer_load_dwordx4 v[92:95], v26, s[4:7], s69 offen offset:320
    s_waitcnt vmcnt(0)
    v_mfma_f32_16x16x32_bf16 v[108:111], v[92:95], a[140:143], v[108:111]
    s_nop 7
    s_nop 15
    v_max3_f32 v14, v104, v105, v106
    v_max3_f32 v14, v14, v107, v108
    v_max3_f32 v14, v14, v109, v110
    v_max_f32 v14, v14, v111
    v_mov_b32 v15, v14
    s_nop 1
    v_permlane32_swap_b32 v15, v14
    v_max_f32 v14, v14, v15
    v_mov_b32 v15, v14
    s_nop 1
    v_permlane16_swap_b32 v15, v14
    v_max_f32 v14, v14, v15
    v_fma_f32 v14, v14, s28, v10
    v_add_f32 v14, 0x42000000, v14
    v_max_f32 v24, 0, v14
    v_sub_f32 v10, v10, v24
    v_sub_f32 v25, 0, v24
    v_exp_f32 v25, v25
    s_nop 0
    v_mul_f32 v15, v45, v25
    v_cndmask_b32_e64 v45, v15, v45, s[46:47]
    v_mul_f32 v15, v49, v25
    v_cndmask_b32_e64 v49, v49, v15, s[46:47]
    v_mul_f32 v160, v160, v25
    v_mul_f32 v161, v161, v25
    v_mul_f32 v162, v162, v25
    v_mul_f32 v163, v163, v25
    v_mul_f32 v164, v164, v25
    v_mul_f32 v165, v165, v25
    v_mul_f32 v166, v166, v25
    v_mul_f32 v167, v167, v25
    v_mul_f32 v168, v168, v25
    v_mul_f32 v169, v169, v25
    v_mul_f32 v170, v170, v25
    v_mul_f32 v171, v171, v25
    v_mul_f32 v172, v172, v25
    v_mul_f32 v173, v173, v25
    v_mul_f32 v174, v174, v25
    v_mul_f32 v175, v175, v25
    v_mul_f32 v176, v176, v25
    v_mul_f32 v177, v177, v25
    v_mul_f32 v178, v178, v25
    v_mul_f32 v179, v179, v25
    v_mul_f32 v180, v180, v25
    v_mul_f32 v181, v181, v25
    v_mul_f32 v182, v182, v25
    v_mul_f32 v183, v183, v25
    v_mul_f32 v184, v184, v25
    v_mul_f32 v185, v185, v25
    v_mul_f32 v186, v186, v25
    v_mul_f32 v187, v187, v25
    v_mul_f32 v188, v188, v25
    v_mul_f32 v189, v189, v25
    v_mul_f32 v190, v190, v25
    v_mul_f32 v191, v191, v25
    v_mul_f32 v192, v192, v25
    v_mul_f32 v193, v193, v25
    v_mul_f32 v194, v194, v25
    v_mul_f32 v195, v195, v25
    v_mul_f32 v196, v196, v25
    v_mul_f32 v197, v197, v25
    v_mul_f32 v198, v198, v25
    v_mul_f32 v199, v199, v25
    v_mul_f32 v200, v200, v25
    v_mul_f32 v201, v201, v25
    v_mul_f32 v202, v202, v25
    v_mul_f32 v203, v203, v25
    v_mul_f32 v204, v204, v25
    v_mul_f32 v205, v205, v25
    v_mul_f32 v206, v206, v25
    v_mul_f32 v207, v207, v25
    v_fma_f32 v104, v104, s28, v10
    v_fma_f32 v105, v105, s28, v10
    v_exp_f32_e64 v104, v104 clamp
    v_exp_f32_e64 v105, v105 clamp
    s_nop 0
    v_cvt_pk_bf16_f32 v22, v104, v105
    v_fma_f32 v106, v106, s28, v10
    v_fma_f32 v107, v107, s28, v10
    v_exp_f32_e64 v106, v106 clamp
    v_exp_f32_e64 v107, v107 clamp
    s_nop 0
    v_cvt_pk_bf16_f32 v23, v106, v107
    v_fma_f32 v108, v108, s28, v10
    v_fma_f32 v109, v109, s28, v10
    v_exp_f32_e64 v108, v108 clamp
    v_exp_f32_e64 v109, v109 clamp
    s_nop 0
    v_cvt_pk_bf16_f32 v20, v108, v109
    v_fma_f32 v110, v110, s28, v10
    v_fma_f32 v111, v111, s28, v10
    v_exp_f32_e64 v110, v110 clamp
    v_exp_f32_e64 v111, v111 clamp
    s_nop 0
    v_cvt_pk_bf16_f32 v21, v110, v111
    s_add_u32 s69, s39, 0
    buffer_load_dwordx4 v[92:95], v26, s[4:7], s69 offen offset:0
    s_waitcnt vmcnt(0)
    v_mfma_f32_16x16x32_bf16 v[104:107], v[92:95], a[144:147], 0
    s_nop 7
    buffer_load_dwordx4 v[92:95], v26, s[4:7], s69 offen offset:64
    s_waitcnt vmcnt(0)
    v_mfma_f32_16x16x32_bf16 v[104:107], v[92:95], a[148:151], v[104:107]
    s_nop 7
    buffer_load_dwordx4 v[92:95], v26, s[4:7], s69 offen offset:128
    s_waitcnt vmcnt(0)
    v_mfma_f32_16x16x32_bf16 v[104:107], v[92:95], a[152:155], v[104:107]
    s_nop 7
    buffer_load_dwordx4 v[92:95], v26, s[4:7], s69 offen offset:192
    s_waitcnt vmcnt(0)
    v_mfma_f32_16x16x32_bf16 v[104:107], v[92:95], a[156:159], v[104:107]
    s_nop 7
    buffer_load_dwordx4 v[92:95], v26, s[4:7], s69 offen offset:256
    s_waitcnt vmcnt(0)
    v_mfma_f32_16x16x32_bf16 v[104:107], v[92:95], a[160:163], v[104:107]
    s_nop 7
    buffer_load_dwordx4 v[92:95], v26, s[4:7], s69 offen offset:320
    s_waitcnt vmcnt(0)
    v_mfma_f32_16x16x32_bf16 v[104:107], v[92:95], a[164:167], v[104:107]
    s_nop 7
    s_add_u32 s69, s39, 6144
    buffer_load_dwordx4 v[92:95], v26, s[4:7], s69 offen offset:0
    s_waitcnt vmcnt(0)
    v_mfma_f32_16x16x32_bf16 v[108:111], v[92:95], a[144:147], 0
    s_nop 7
    buffer_load_dwordx4 v[92:95], v26, s[4:7], s69 offen offset:64
    s_waitcnt vmcnt(0)
    v_mfma_f32_16x16x32_bf16 v[108:111], v[92:95], a[148:151], v[108:111]
    s_nop 7
    buffer_load_dwordx4 v[92:95], v26, s[4:7], s69 offen offset:128
    s_waitcnt vmcnt(0)
    v_mfma_f32_16x16x32_bf16 v[108:111], v[92:95], a[152:155], v[108:111]
    s_nop 7
    buffer_load_dwordx4 v[92:95], v26, s[4:7], s69 offen offset:192
    s_waitcnt vmcnt(0)
    v_mfma_f32_16x16x32_bf16 v[108:111], v[92:95], a[156:159], v[108:111]
    s_nop 7
    buffer_load_dwordx4 v[92:95], v26, s[4:7], s69 offen offset:256
    s_waitcnt vmcnt(0)
    v_mfma_f32_16x16x32_bf16 v[108:111], v[92:95], a[160:163], v[108:111]
    s_nop 7
    buffer_load_dwordx4 v[92:95], v26, s[4:7], s69 offen offset:320
    s_waitcnt vmcnt(0)
    v_mfma_f32_16x16x32_bf16 v[108:111], v[92:95], a[164:167], v[108:111]
    s_nop 7
    s_nop 15
    v_max3_f32 v14, v104, v105, v106
    v_max3_f32 v14, v14, v107, v108
    v_max3_f32 v14, v14, v109, v110
    v_max_f32 v14, v14, v111
    v_mov_b32 v15, v14
    s_nop 1
    v_permlane32_swap_b32 v15, v14
    v_max_f32 v14, v14, v15
    v_mov_b32 v15, v14
    s_nop 1
    v_permlane16_swap_b32 v15, v14
    v_max_f32 v14, v14, v15
    v_fma_f32 v14, v14, s28, v11
    v_add_f32 v14, 0x42000000, v14
    v_max_f32 v24, 0, v14
    v_sub_f32 v11, v11, v24
    v_sub_f32 v25, 0, v24
    v_exp_f32 v25, v25
    s_nop 0
    v_mul_f32 v15, v45, v25
    v_cndmask_b32_e64 v45, v45, v15, s[46:47]
    v_mul_f32 v15, v50, v25
    v_cndmask_b32_e64 v50, v15, v50, s[46:47]
    v_mul_f32 v208, v208, v25
    v_mul_f32 v209, v209, v25
    v_mul_f32 v210, v210, v25
    v_mul_f32 v211, v211, v25
    v_mul_f32 v212, v212, v25
    v_mul_f32 v213, v213, v25
    v_mul_f32 v214, v214, v25
    v_mul_f32 v215, v215, v25
    v_mul_f32 v216, v216, v25
    v_mul_f32 v217, v217, v25
    v_mul_f32 v218, v218, v25
    v_mul_f32 v219, v219, v25
    v_mul_f32 v220, v220, v25
    v_mul_f32 v221, v221, v25
    v_mul_f32 v222, v222, v25
    v_mul_f32 v223, v223, v25
    v_mul_f32 v224, v224, v25
    v_mul_f32 v225, v225, v25
    v_mul_f32 v226, v226, v25
    v_mul_f32 v227, v227, v25
    v_mul_f32 v228, v228, v25
    v_mul_f32 v229, v229, v25
    v_mul_f32 v230, v230, v25
    v_mul_f32 v231, v231, v25
    v_mul_f32 v232, v232, v25
    v_mul_f32 v233, v233, v25
    v_mul_f32 v234, v234, v25
    v_mul_f32 v235, v235, v25
    v_mul_f32 v236, v236, v25
    v_mul_f32 v237, v237, v25
    v_mul_f32 v238, v238, v25
    v_mul_f32 v239, v239, v25
    v_mul_f32 v240, v240, v25
    v_mul_f32 v241, v241, v25
    v_mul_f32 v242, v242, v25
    v_mul_f32 v243, v243, v25
    v_mul_f32 v244, v244, v25
    v_mul_f32 v245, v245, v25
    v_mul_f32 v246, v246, v25
    v_mul_f32 v247, v247, v25
    v_mul_f32 v248, v248, v25
    v_mul_f32 v249, v249, v25
    v_mul_f32 v250, v250, v25
    v_mul_f32 v251, v251, v25
    v_mul_f32 v252, v252, v25
    v_mul_f32 v253, v253, v25
    v_mul_f32 v254, v254, v25
    v_mul_f32 v255, v255, v25
    v_fma_f32 v104, v104, s28, v11
    v_fma_f32 v105, v105, s28, v11
    v_exp_f32_e64 v104, v104 clamp
    v_exp_f32_e64 v105, v105 clamp
    s_nop 0
    v_cvt_pk_bf16_f32 v30, v104, v105
    v_fma_f32 v106, v106, s28, v11
    v_fma_f32 v107, v107, s28, v11
    v_exp_f32_e64 v106, v106 clamp
    v_exp_f32_e64 v107, v107 clamp
    s_nop 0
    v_cvt_pk_bf16_f32 v31, v106, v107
    v_fma_f32 v108, v108, s28, v11
    v_fma_f32 v109, v109, s28, v11
    v_exp_f32_e64 v108, v108 clamp
    v_exp_f32_e64 v109, v109 clamp
    s_nop 0
    v_cvt_pk_bf16_f32 v28, v108, v109
    v_fma_f32 v110, v110, s28, v11
    v_fma_f32 v111, v111, s28, v11
    v_exp_f32_e64 v110, v110 clamp
    v_exp_f32_e64 v111, v111 clamp
    s_nop 0
    v_cvt_pk_bf16_f32 v29, v110, v111
    s_add_u32 s69, s39, 0
    buffer_load_dwordx4 v[92:95], v26, s[4:7], s69 offen offset:0
    s_waitcnt vmcnt(0)
    v_mfma_f32_16x16x32_bf16 v[104:107], v[92:95], a[168:171], 0
    s_nop 7
    buffer_load_dwordx4 v[92:95], v26, s[4:7], s69 offen offset:64
    s_waitcnt vmcnt(0)
    v_mfma_f32_16x16x32_bf16 v[104:107], v[92:95], a[172:175], v[104:107]
    s_nop 7
    buffer_load_dwordx4 v[92:95], v26, s[4:7], s69 offen offset:128
    s_waitcnt vmcnt(0)
    v_mfma_f32_16x16x32_bf16 v[104:107], v[92:95], a[176:179], v[104:107]
    s_nop 7
    buffer_load_dwordx4 v[92:95], v26, s[4:7], s69 offen offset:192
    s_waitcnt vmcnt(0)
    v_mfma_f32_16x16x32_bf16 v[104:107], v[92:95], a[180:183], v[104:107]
    s_nop 7
    buffer_load_dwordx4 v[92:95], v26, s[4:7], s69 offen offset:256
    s_waitcnt vmcnt(0)
    v_mfma_f32_16x16x32_bf16 v[104:107], v[92:95], a[184:187], v[104:107]
    s_nop 7
    buffer_load_dwordx4 v[92:95], v26, s[4:7], s69 offen offset:320
    s_waitcnt vmcnt(0)
    v_mfma_f32_16x16x32_bf16 v[104:107], v[92:95], a[188:191], v[104:107]
    s_nop 7
    s_add_u32 s69, s39, 6144
    buffer_load_dwordx4 v[92:95], v26, s[4:7], s69 offen offset:0
    s_waitcnt vmcnt(0)
    v_mfma_f32_16x16x32_bf16 v[108:111], v[92:95], a[168:171], 0
    s_nop 7
    buffer_load_dwordx4 v[92:95], v26, s[4:7], s69 offen offset:64
    s_waitcnt vmcnt(0)
    v_mfma_f32_16x16x32_bf16 v[108:111], v[92:95], a[172:175], v[108:111]
    s_nop 7
    buffer_load_dwordx4 v[92:95], v26, s[4:7], s69 offen offset:128
    s_waitcnt vmcnt(0)
    v_mfma_f32_16x16x32_bf16 v[108:111], v[92:95], a[176:179], v[108:111]
    s_nop 7
    buffer_load_dwordx4 v[92:95], v26, s[4:7], s69 offen offset:192
    s_waitcnt vmcnt(0)
    v_mfma_f32_16x16x32_bf16 v[108:111], v[92:95], a[180:183], v[108:111]
    s_nop 7
    buffer_load_dwordx4 v[92:95], v26, s[4:7], s69 offen offset:256
    s_waitcnt vmcnt(0)
    v_mfma_f32_16x16x32_bf16 v[108:111], v[92:95], a[184:187], v[108:111]
    s_nop 7
    buffer_load_dwordx4 v[92:95], v26, s[4:7], s69 offen offset:320
    s_waitcnt vmcnt(0)
    v_mfma_f32_16x16x32_bf16 v[108:111], v[92:95], a[188:191], v[108:111]
    s_nop 7
    s_nop 15
    v_max3_f32 v14, v104, v105, v106
    v_max3_f32 v14, v14, v107, v108
    v_max3_f32 v14, v14, v109, v110
    v_max_f32 v14, v14, v111
    v_mov_b32 v15, v14
    s_nop 1
    v_permlane32_swap_b32 v15, v14
    v_max_f32 v14, v14, v15
    v_mov_b32 v15, v14
    s_nop 1
    v_permlane16_swap_b32 v15, v14
    v_max_f32 v14, v14, v15
    v_fma_f32 v14, v14, s28, v12
    v_add_f32 v14, 0x42000000, v14
    v_max_f32 v24, 0, v14
    v_sub_f32 v12, v12, v24
    v_sub_f32 v25, 0, v24
    v_exp_f32 v25, v25
    s_nop 0
    v_mul_f32 v15, v46, v25
    v_cndmask_b32_e64 v46, v15, v46, s[46:47]
    v_mul_f32 v15, v50, v25
    v_cndmask_b32_e64 v50, v50, v15, s[46:47]
    v_accvgpr_read_b32 v15, a0
    v_mul_f32 v15, v15, v25
    v_accvgpr_write_b32 a0, v15
    v_accvgpr_read_b32 v15, a1
    v_mul_f32 v15, v15, v25
    v_accvgpr_write_b32 a1, v15
    v_accvgpr_read_b32 v15, a2
    v_mul_f32 v15, v15, v25
    v_accvgpr_write_b32 a2, v15
    v_accvgpr_read_b32 v15, a3
    v_mul_f32 v15, v15, v25
    v_accvgpr_write_b32 a3, v15
    v_accvgpr_read_b32 v15, a4
    v_mul_f32 v15, v15, v25
    v_accvgpr_write_b32 a4, v15
    v_accvgpr_read_b32 v15, a5
    v_mul_f32 v15, v15, v25
    v_accvgpr_write_b32 a5, v15
    v_accvgpr_read_b32 v15, a6
    v_mul_f32 v15, v15, v25
    v_accvgpr_write_b32 a6, v15
    v_accvgpr_read_b32 v15, a7
    v_mul_f32 v15, v15, v25
    v_accvgpr_write_b32 a7, v15
    v_accvgpr_read_b32 v15, a8
    v_mul_f32 v15, v15, v25
    v_accvgpr_write_b32 a8, v15
    v_accvgpr_read_b32 v15, a9
    v_mul_f32 v15, v15, v25
    v_accvgpr_write_b32 a9, v15
    v_accvgpr_read_b32 v15, a10
    v_mul_f32 v15, v15, v25
    v_accvgpr_write_b32 a10, v15
    v_accvgpr_read_b32 v15, a11
    v_mul_f32 v15, v15, v25
    v_accvgpr_write_b32 a11, v15
    v_accvgpr_read_b32 v15, a12
    v_mul_f32 v15, v15, v25
    v_accvgpr_write_b32 a12, v15
    v_accvgpr_read_b32 v15, a13
    v_mul_f32 v15, v15, v25
    v_accvgpr_write_b32 a13, v15
    v_accvgpr_read_b32 v15, a14
    v_mul_f32 v15, v15, v25
    v_accvgpr_write_b32 a14, v15
    v_accvgpr_read_b32 v15, a15
    v_mul_f32 v15, v15, v25
    v_accvgpr_write_b32 a15, v15
    v_accvgpr_read_b32 v15, a16
    v_mul_f32 v15, v15, v25
    v_accvgpr_write_b32 a16, v15
    v_accvgpr_read_b32 v15, a17
    v_mul_f32 v15, v15, v25
    v_accvgpr_write_b32 a17, v15
    v_accvgpr_read_b32 v15, a18
    v_mul_f32 v15, v15, v25
    v_accvgpr_write_b32 a18, v15
    v_accvgpr_read_b32 v15, a19
    v_mul_f32 v15, v15, v25
    v_accvgpr_write_b32 a19, v15
    v_accvgpr_read_b32 v15, a20
    v_mul_f32 v15, v15, v25
    v_accvgpr_write_b32 a20, v15
    v_accvgpr_read_b32 v15, a21
    v_mul_f32 v15, v15, v25
    v_accvgpr_write_b32 a21, v15
    v_accvgpr_read_b32 v15, a22
    v_mul_f32 v15, v15, v25
    v_accvgpr_write_b32 a22, v15
    v_accvgpr_read_b32 v15, a23
    v_mul_f32 v15, v15, v25
    v_accvgpr_write_b32 a23, v15
    v_accvgpr_read_b32 v15, a24
    v_mul_f32 v15, v15, v25
    v_accvgpr_write_b32 a24, v15
    v_accvgpr_read_b32 v15, a25
    v_mul_f32 v15, v15, v25
    v_accvgpr_write_b32 a25, v15
    v_accvgpr_read_b32 v15, a26
    v_mul_f32 v15, v15, v25
    v_accvgpr_write_b32 a26, v15
    v_accvgpr_read_b32 v15, a27
    v_mul_f32 v15, v15, v25
    v_accvgpr_write_b32 a27, v15
    v_accvgpr_read_b32 v15, a28
    v_mul_f32 v15, v15, v25
    v_accvgpr_write_b32 a28, v15
    v_accvgpr_read_b32 v15, a29
    v_mul_f32 v15, v15, v25
    v_accvgpr_write_b32 a29, v15
    v_accvgpr_read_b32 v15, a30
    v_mul_f32 v15, v15, v25
    v_accvgpr_write_b32 a30, v15
    v_accvgpr_read_b32 v15, a31
    v_mul_f32 v15, v15, v25
    v_accvgpr_write_b32 a31, v15
    v_accvgpr_read_b32 v15, a32
    v_mul_f32 v15, v15, v25
    v_accvgpr_write_b32 a32, v15
    v_accvgpr_read_b32 v15, a33
    v_mul_f32 v15, v15, v25
    v_accvgpr_write_b32 a33, v15
    v_accvgpr_read_b32 v15, a34
    v_mul_f32 v15, v15, v25
    v_accvgpr_write_b32 a34, v15
    v_accvgpr_read_b32 v15, a35
    v_mul_f32 v15, v15, v25
    v_accvgpr_write_b32 a35, v15
    v_accvgpr_read_b32 v15, a36
    v_mul_f32 v15, v15, v25
    v_accvgpr_write_b32 a36, v15
    v_accvgpr_read_b32 v15, a37
    v_mul_f32 v15, v15, v25
    v_accvgpr_write_b32 a37, v15
    v_accvgpr_read_b32 v15, a38
    v_mul_f32 v15, v15, v25
    v_accvgpr_write_b32 a38, v15
    v_accvgpr_read_b32 v15, a39
    v_mul_f32 v15, v15, v25
    v_accvgpr_write_b32 a39, v15
    v_accvgpr_read_b32 v15, a40
    v_mul_f32 v15, v15, v25
    v_accvgpr_write_b32 a40, v15
    v_accvgpr_read_b32 v15, a41
    v_mul_f32 v15, v15, v25
    v_accvgpr_write_b32 a41, v15
    v_accvgpr_read_b32 v15, a42
    v_mul_f32 v15, v15, v25
    v_accvgpr_write_b32 a42, v15
    v_accvgpr_read_b32 v15, a43
    v_mul_f32 v15, v15, v25
    v_accvgpr_write_b32 a43, v15
    v_accvgpr_read_b32 v15, a44
    v_mul_f32 v15, v15, v25
    v_accvgpr_write_b32 a44, v15
    v_accvgpr_read_b32 v15, a45
    v_mul_f32 v15, v15, v25
    v_accvgpr_write_b32 a45, v15
    v_accvgpr_read_b32 v15, a46
    v_mul_f32 v15, v15, v25
    v_accvgpr_write_b32 a46, v15
    v_accvgpr_read_b32 v15, a47
    v_mul_f32 v15, v15, v25
    v_accvgpr_write_b32 a47, v15
    v_fma_f32 v104, v104, s28, v12
    v_fma_f32 v105, v105, s28, v12
    v_exp_f32_e64 v104, v104 clamp
    v_exp_f32_e64 v105, v105 clamp
    s_nop 0
    v_cvt_pk_bf16_f32 v34, v104, v105
    v_fma_f32 v106, v106, s28, v12
    v_fma_f32 v107, v107, s28, v12
    v_exp_f32_e64 v106, v106 clamp
    v_exp_f32_e64 v107, v107 clamp
    s_nop 0
    v_cvt_pk_bf16_f32 v35, v106, v107
    v_fma_f32 v108, v108, s28, v12
    v_fma_f32 v109, v109, s28, v12
    v_exp_f32_e64 v108, v108 clamp
    v_exp_f32_e64 v109, v109 clamp
    s_nop 0
    v_cvt_pk_bf16_f32 v32, v108, v109
    v_fma_f32 v110, v110, s28, v12
    v_fma_f32 v111, v111, s28, v12
    v_exp_f32_e64 v110, v110 clamp
    v_exp_f32_e64 v111, v111 clamp
    s_nop 0
    v_cvt_pk_bf16_f32 v33, v110, v111
    v_smfmac_f32_16x16x64_bf16 v[48:51], a[240:243], v[16:23], v101
    s_nop 0
    v_smfmac_f32_16x16x64_bf16 v[48:51], a[244:247], v[28:35], v101
    s_nop 15
    s_setpc_b64 s[40:41]
L_rs_start5b:
    s_call_b64 s[40:41], L_rare5_1
    s_branch L_ret_start5b
L_rs_loop5w0a:
    s_call_b64 s[40:41], L_rare5_0
    s_branch L_ret_loop5w0a
L_rs_loop5w0b:
    s_call_b64 s[40:41], L_rare5_1
    s_branch L_ret_loop5w0b
L_rs_loop5w1a:
    s_call_b64 s[40:41], L_rare5_0
    s_branch L_ret_loop5w1a
L_rs_loop5w1b:
    s_call_b64 s[40:41], L_rare5_1
    s_branch L_ret_loop5w1b
L_rs_end5a:
    s_call_b64 s[40:41], L_rare5_0
    s_branch L_ret_end5a
L_rs_end5b:
    s_call_b64 s[40:41], L_rare5_1
    s_branch L_ret_end5b
L_rs_start4b:
    s_call_b64 s[40:41], L_rare4_1
    s_branch L_ret_start4b
L_rs_loop4w0a:
    s_call_b64 s[40:41], L_rare4_0
    s_branch L_ret_loop4w0a
L_rs_loop4w0b:
    s_call_b64 s[40:41], L_rare4_1
    s_branch L_ret_loop4w0b
L_rs_end4a:
    s_call_b64 s[40:41], L_rare4_0
    s_branch L_ret_end4a
L_rs_end4b:
    s_call_b64 s[40:41], L_rare4_1
    s_branch L_ret_end4b
L_rs_tr54a:
    s_call_b64 s[40:41], L_rare5_0
    s_branch L_ret_tr54a
L_rs_tr54b:
    s_nop 15
    s_waitcnt vmcnt(0) lgkmcnt(0)
    s_mov_b32 s68, s14
    s_mov_b32 s14, 166723584
    v_mbcnt_lo_u32_b32 v105, -1, 0
    v_mbcnt_hi_u32_b32 v105, -1, v105
    v_and_b32 v104, 15, v105
    v_mul_u32_u24 v104, 384, v104
    v_lshrrev_b32 v105, 4, v105
    v_lshl_add_u32 v104, v105, 4, v104
    s_add_u32 s69, s34, 0
    buffer_load_dwordx4 a[96:99], v104, s[12:15], s69 offen offset:0
    buffer_load_dwordx4 a[100:103], v104, s[12:15], s69 offen offset:64
    buffer_load_dwordx4 a[104:107], v104, s[12:15], s69 offen offset:128
    buffer_load_dwordx4 a[108:111], v104, s[12:15], s69 offen offset:192
    buffer_load_dwordx4 a[112:115], v104, s[12:15], s69 offen offset:256
    buffer_load_dwordx4 a[116:119], v104, s[12:15], s69 offen offset:320
    s_add_u32 s69, s34, 6144
    buffer_load_dwordx4 a[120:123], v104, s[12:15], s69 offen offset:0
    buffer_load_dwordx4 a[124:127], v104, s[12:15], s69 offen offset:64
    buffer_load_dwordx4 a[128:131], v104, s[12:15], s69 offen offset:128
    buffer_load_dwordx4 a[132:135], v104, s[12:15], s69 offen offset:192
    buffer_load_dwordx4 a[136:139], v104, s[12:15], s69 offen offset:256
    buffer_load_dwordx4 a[140:143], v104, s[12:15], s69 offen offset:320
    s_add_u32 s69, s34, 12288
    buffer_load_dwordx4 a[144:147], v104, s[12:15], s69 offen offset:0
    buffer_load_dwordx4 a[148:151], v104, s[12:15], s69 offen offset:64
    buffer_load_dwordx4 a[152:155], v104, s[12:15], s69 offen offset:128
    buffer_load_dwordx4 a[156:159], v104, s[12:15], s69 offen offset:192
    buffer_load_dwordx4 a[160:163], v104, s[12:15], s69 offen offset:256
    buffer_load_dwordx4 a[164:167], v104, s[12:15], s69 offen offset:320
    s_add_u32 s69, s34, 18432
    buffer_load_dwordx4 a[168:171], v104, s[12:15], s69 offen offset:0
    buffer_load_dwordx4 a[172:175], v104, s[12:15], s69 offen offset:64
    buffer_load_dwordx4 a[176:179], v104, s[12:15], s69 offen offset:128
    buffer_load_dwordx4 a[180:183], v104, s[12:15], s69 offen offset:192
    buffer_load_dwordx4 a[184:187], v104, s[12:15], s69 offen offset:256
    buffer_load_dwordx4 a[188:191], v104, s[12:15], s69 offen offset:320
    s_add_u32 s69, s34, 24576
    buffer_load_dwordx4 a[192:195], v104, s[12:15], s69 offen offset:0
    buffer_load_dwordx4 a[196:199], v104, s[12:15], s69 offen offset:64
    buffer_load_dwordx4 a[200:203], v104, s[12:15], s69 offen offset:128
    buffer_load_dwordx4 a[204:207], v104, s[12:15], s69 offen offset:192
    buffer_load_dwordx4 a[208:211], v104, s[12:15], s69 offen offset:256
    buffer_load_dwordx4 a[212:215], v104, s[12:15], s69 offen offset:320
    s_waitcnt vmcnt(0)
    s_call_b64 s[40:41], L_rare5_1
    v_mbcnt_lo_u32_b32 v105, -1, 0
    v_mbcnt_hi_u32_b32 v105, -1, v105
    v_and_b32 v104, 15, v105
    v_mul_u32_u24 v104, 384, v104
    v_lshrrev_b32 v105, 4, v105
    v_lshl_add_u32 v104, v105, 4, v104
    s_add_u32 s69, s33, 0
    buffer_load_dwordx4 a[96:99], v104, s[12:15], s69 offen offset:0
    buffer_load_dwordx4 a[100:103], v104, s[12:15], s69 offen offset:64
    buffer_load_dwordx4 a[104:107], v104, s[12:15], s69 offen offset:128
    buffer_load_dwordx4 a[108:111], v104, s[12:15], s69 offen offset:192
    buffer_load_dwordx4 a[112:115], v104, s[12:15], s69 offen offset:256
    buffer_load_dwordx4 a[116:119], v104, s[12:15], s69 offen offset:320
    s_add_u32 s69, s33, 6144
    buffer_load_dwordx4 a[120:123], v104, s[12:15], s69 offen offset:0
    buffer_load_dwordx4 a[124:127], v104, s[12:15], s69 offen offset:64
    buffer_load_dwordx4 a[128:131], v104, s[12:15], s69 offen offset:128
    buffer_load_dwordx4 a[132:135], v104, s[12:15], s69 offen offset:192
    buffer_load_dwordx4 a[136:139], v104, s[12:15], s69 offen offset:256
    buffer_load_dwordx4 a[140:143], v104, s[12:15], s69 offen offset:320
    s_add_u32 s69, s33, 12288
    buffer_load_dwordx4 a[144:147], v104, s[12:15], s69 offen offset:0
    buffer_load_dwordx4 a[148:151], v104, s[12:15], s69 offen offset:64
    buffer_load_dwordx4 a[152:155], v104, s[12:15], s69 offen offset:128
    buffer_load_dwordx4 a[156:159], v104, s[12:15], s69 offen offset:192
    buffer_load_dwordx4 a[160:163], v104, s[12:15], s69 offen offset:256
    buffer_load_dwordx4 a[164:167], v104, s[12:15], s69 offen offset:320
    s_add_u32 s69, s33, 18432
    buffer_load_dwordx4 a[168:171], v104, s[12:15], s69 offen offset:0
    buffer_load_dwordx4 a[172:175], v104, s[12:15], s69 offen offset:64
    buffer_load_dwordx4 a[176:179], v104, s[12:15], s69 offen offset:128
    buffer_load_dwordx4 a[180:183], v104, s[12:15], s69 offen offset:192
    buffer_load_dwordx4 a[184:187], v104, s[12:15], s69 offen offset:256
    buffer_load_dwordx4 a[188:191], v104, s[12:15], s69 offen offset:320
    s_waitcnt vmcnt(0)
    s_mov_b32 s14, s68
    s_branch L_ret_tr54b
L_rs_tr54d:
    s_call_b64 s[40:41], L_rare4_1
    s_branch L_ret_tr54d
L_rs_tr45a:
    s_call_b64 s[40:41], L_rare4_0
    s_branch L_ret_tr45a
L_rs_tr45b:
    s_nop 15
    s_waitcnt vmcnt(0) lgkmcnt(0)
    s_mov_b32 s68, s14
    s_mov_b32 s14, 166723584
    v_mbcnt_lo_u32_b32 v105, -1, 0
    v_mbcnt_hi_u32_b32 v105, -1, v105
    v_and_b32 v104, 15, v105
    v_mul_u32_u24 v104, 384, v104
    v_lshrrev_b32 v105, 4, v105
    v_lshl_add_u32 v104, v105, 4, v104
    s_add_u32 s69, s34, 0
    buffer_load_dwordx4 a[96:99], v104, s[12:15], s69 offen offset:0
    buffer_load_dwordx4 a[100:103], v104, s[12:15], s69 offen offset:64
    buffer_load_dwordx4 a[104:107], v104, s[12:15], s69 offen offset:128
    buffer_load_dwordx4 a[108:111], v104, s[12:15], s69 offen offset:192
    buffer_load_dwordx4 a[112:115], v104, s[12:15], s69 offen offset:256
    buffer_load_dwordx4 a[116:119], v104, s[12:15], s69 offen offset:320
    s_add_u32 s69, s34, 6144
    buffer_load_dwordx4 a[120:123], v104, s[12:15], s69 offen offset:0
    buffer_load_dwordx4 a[124:127], v104, s[12:15], s69 offen offset:64
    buffer_load_dwordx4 a[128:131], v104, s[12:15], s69 offen offset:128
    buffer_load_dwordx4 a[132:135], v104, s[12:15], s69 offen offset:192
    buffer_load_dwordx4 a[136:139], v104, s[12:15], s69 offen offset:256
    buffer_load_dwordx4 a[140:143], v104, s[12:15], s69 offen offset:320
    s_add_u32 s69, s34, 12288
    buffer_load_dwordx4 a[144:147], v104, s[12:15], s69 offen offset:0
    buffer_load_dwordx4 a[148:151], v104, s[12:15], s69 offen offset:64
    buffer_load_dwordx4 a[152:155], v104, s[12:15], s69 offen offset:128
    buffer_load_dwordx4 a[156:159], v104, s[12:15], s69 offen offset:192
    buffer_load_dwordx4 a[160:163], v104, s[12:15], s69 offen offset:256
    buffer_load_dwordx4 a[164:167], v104, s[12:15], s69 offen offset:320
    s_add_u32 s69, s34, 18432
    buffer_load_dwordx4 a[168:171], v104, s[12:15], s69 offen offset:0
    buffer_load_dwordx4 a[172:175], v104, s[12:15], s69 offen offset:64
    buffer_load_dwordx4 a[176:179], v104, s[12:15], s69 offen offset:128
    buffer_load_dwordx4 a[180:183], v104, s[12:15], s69 offen offset:192
    buffer_load_dwordx4 a[184:187], v104, s[12:15], s69 offen offset:256
    buffer_load_dwordx4 a[188:191], v104, s[12:15], s69 offen offset:320
    s_waitcnt vmcnt(0)
    s_call_b64 s[40:41], L_rare4_1
    v_mbcnt_lo_u32_b32 v105, -1, 0
    v_mbcnt_hi_u32_b32 v105, -1, v105
    v_and_b32 v104, 15, v105
    v_mul_u32_u24 v104, 384, v104
    v_lshrrev_b32 v105, 4, v105
    v_lshl_add_u32 v104, v105, 4, v104
    s_add_u32 s69, s33, 0
    buffer_load_dwordx4 a[96:99], v104, s[12:15], s69 offen offset:0
    buffer_load_dwordx4 a[100:103], v104, s[12:15], s69 offen offset:64
    buffer_load_dwordx4 a[104:107], v104, s[12:15], s69 offen offset:128
    buffer_load_dwordx4 a[108:111], v104, s[12:15], s69 offen offset:192
    buffer_load_dwordx4 a[112:115], v104, s[12:15], s69 offen offset:256
    buffer_load_dwordx4 a[116:119], v104, s[12:15], s69 offen offset:320
    s_add_u32 s69, s33, 6144
    buffer_load_dwordx4 a[120:123], v104, s[12:15], s69 offen offset:0
    buffer_load_dwordx4 a[124:127], v104, s[12:15], s69 offen offset:64
    buffer_load_dwordx4 a[128:131], v104, s[12:15], s69 offen offset:128
    buffer_load_dwordx4 a[132:135], v104, s[12:15], s69 offen offset:192
    buffer_load_dwordx4 a[136:139], v104, s[12:15], s69 offen offset:256
    buffer_load_dwordx4 a[140:143], v104, s[12:15], s69 offen offset:320
    s_add_u32 s69, s33, 12288
    buffer_load_dwordx4 a[144:147], v104, s[12:15], s69 offen offset:0
    buffer_load_dwordx4 a[148:151], v104, s[12:15], s69 offen offset:64
    buffer_load_dwordx4 a[152:155], v104, s[12:15], s69 offen offset:128
    buffer_load_dwordx4 a[156:159], v104, s[12:15], s69 offen offset:192
    buffer_load_dwordx4 a[160:163], v104, s[12:15], s69 offen offset:256
    buffer_load_dwordx4 a[164:167], v104, s[12:15], s69 offen offset:320
    s_add_u32 s69, s33, 18432
    buffer_load_dwordx4 a[168:171], v104, s[12:15], s69 offen offset:0
    buffer_load_dwordx4 a[172:175], v104, s[12:15], s69 offen offset:64
    buffer_load_dwordx4 a[176:179], v104, s[12:15], s69 offen offset:128
    buffer_load_dwordx4 a[180:183], v104, s[12:15], s69 offen offset:192
    buffer_load_dwordx4 a[184:187], v104, s[12:15], s69 offen offset:256
    buffer_load_dwordx4 a[188:191], v104, s[12:15], s69 offen offset:320
    s_add_u32 s69, s33, 24576
    buffer_load_dwordx4 a[192:195], v104, s[12:15], s69 offen offset:0
    buffer_load_dwordx4 a[196:199], v104, s[12:15], s69 offen offset:64
    buffer_load_dwordx4 a[200:203], v104, s[12:15], s69 offen offset:128
    buffer_load_dwordx4 a[204:207], v104, s[12:15], s69 offen offset:192
    buffer_load_dwordx4 a[208:211], v104, s[12:15], s69 offen offset:256
    buffer_load_dwordx4 a[212:215], v104, s[12:15], s69 offen offset:320
    s_waitcnt vmcnt(0)
    s_mov_b32 s14, s68
    s_branch L_ret_tr45b
L_rs_tr45d:
    s_call_b64 s[40:41], L_rare5_1
    s_branch L_ret_tr45d
L_rs_tr44a:
    s_call_b64 s[40:41], L_rare4_0
    s_branch L_ret_tr44a
L_rs_tr44b:
    s_nop 15
    s_waitcnt vmcnt(0) lgkmcnt(0)
    s_mov_b32 s68, s14
    s_mov_b32 s14, 166723584
    v_mbcnt_lo_u32_b32 v105, -1, 0
    v_mbcnt_hi_u32_b32 v105, -1, v105
    v_and_b32 v104, 15, v105
    v_mul_u32_u24 v104, 384, v104
    v_lshrrev_b32 v105, 4, v105
    v_lshl_add_u32 v104, v105, 4, v104
    s_add_u32 s69, s34, 0
    buffer_load_dwordx4 a[96:99], v104, s[12:15], s69 offen offset:0
    buffer_load_dwordx4 a[100:103], v104, s[12:15], s69 offen offset:64
    buffer_load_dwordx4 a[104:107], v104, s[12:15], s69 offen offset:128
    buffer_load_dwordx4 a[108:111], v104, s[12:15], s69 offen offset:192
    buffer_load_dwordx4 a[112:115], v104, s[12:15], s69 offen offset:256
    buffer_load_dwordx4 a[116:119], v104, s[12:15], s69 offen offset:320
    s_add_u32 s69, s34, 6144
    buffer_load_dwordx4 a[120:123], v104, s[12:15], s69 offen offset:0
    buffer_load_dwordx4 a[124:127], v104, s[12:15], s69 offen offset:64
    buffer_load_dwordx4 a[128:131], v104, s[12:15], s69 offen offset:128
    buffer_load_dwordx4 a[132:135], v104, s[12:15], s69 offen offset:192
    buffer_load_dwordx4 a[136:139], v104, s[12:15], s69 offen offset:256
    buffer_load_dwordx4 a[140:143], v104, s[12:15], s69 offen offset:320
    s_add_u32 s69, s34, 12288
    buffer_load_dwordx4 a[144:147], v104, s[12:15], s69 offen offset:0
    buffer_load_dwordx4 a[148:151], v104, s[12:15], s69 offen offset:64
    buffer_load_dwordx4 a[152:155], v104, s[12:15], s69 offen offset:128
    buffer_load_dwordx4 a[156:159], v104, s[12:15], s69 offen offset:192
    buffer_load_dwordx4 a[160:163], v104, s[12:15], s69 offen offset:256
    buffer_load_dwordx4 a[164:167], v104, s[12:15], s69 offen offset:320
    s_add_u32 s69, s34, 18432
    buffer_load_dwordx4 a[168:171], v104, s[12:15], s69 offen offset:0
    buffer_load_dwordx4 a[172:175], v104, s[12:15], s69 offen offset:64
    buffer_load_dwordx4 a[176:179], v104, s[12:15], s69 offen offset:128
    buffer_load_dwordx4 a[180:183], v104, s[12:15], s69 offen offset:192
    buffer_load_dwordx4 a[184:187], v104, s[12:15], s69 offen offset:256
    buffer_load_dwordx4 a[188:191], v104, s[12:15], s69 offen offset:320
    s_waitcnt vmcnt(0)
    s_call_b64 s[40:41], L_rare4_1
    v_mbcnt_lo_u32_b32 v105, -1, 0
    v_mbcnt_hi_u32_b32 v105, -1, v105
    v_and_b32 v104, 15, v105
    v_mul_u32_u24 v104, 384, v104
    v_lshrrev_b32 v105, 4, v105
    v_lshl_add_u32 v104, v105, 4, v104
    s_add_u32 s69, s33, 0
    buffer_load_dwordx4 a[96:99], v104, s[12:15], s69 offen offset:0
    buffer_load_dwordx4 a[100:103], v104, s[12:15], s69 offen offset:64
    buffer_load_dwordx4 a[104:107], v104, s[12:15], s69 offen offset:128
    buffer_load_dwordx4 a[108:111], v104, s[12:15], s69 offen offset:192
    buffer_load_dwordx4 a[112:115], v104, s[12:15], s69 offen offset:256
    buffer_load_dwordx4 a[116:119], v104, s[12:15], s69 offen offset:320
    s_add_u32 s69, s33, 6144
    buffer_load_dwordx4 a[120:123], v104, s[12:15], s69 offen offset:0
    buffer_load_dwordx4 a[124:127], v104, s[12:15], s69 offen offset:64
    buffer_load_dwordx4 a[128:131], v104, s[12:15], s69 offen offset:128
    buffer_load_dwordx4 a[132:135], v104, s[12:15], s69 offen offset:192
    buffer_load_dwordx4 a[136:139], v104, s[12:15], s69 offen offset:256
    buffer_load_dwordx4 a[140:143], v104, s[12:15], s69 offen offset:320
    s_add_u32 s69, s33, 12288
    buffer_load_dwordx4 a[144:147], v104, s[12:15], s69 offen offset:0
    buffer_load_dwordx4 a[148:151], v104, s[12:15], s69 offen offset:64
    buffer_load_dwordx4 a[152:155], v104, s[12:15], s69 offen offset:128
    buffer_load_dwordx4 a[156:159], v104, s[12:15], s69 offen offset:192
    buffer_load_dwordx4 a[160:163], v104, s[12:15], s69 offen offset:256
    buffer_load_dwordx4 a[164:167], v104, s[12:15], s69 offen offset:320
    s_add_u32 s69, s33, 18432
    buffer_load_dwordx4 a[168:171], v104, s[12:15], s69 offen offset:0
    buffer_load_dwordx4 a[172:175], v104, s[12:15], s69 offen offset:64
    buffer_load_dwordx4 a[176:179], v104, s[12:15], s69 offen offset:128
    buffer_load_dwordx4 a[180:183], v104, s[12:15], s69 offen offset:192
    buffer_load_dwordx4 a[184:187], v104, s[12:15], s69 offen offset:256
    buffer_load_dwordx4 a[188:191], v104, s[12:15], s69 offen offset:320
    s_waitcnt vmcnt(0)
    s_mov_b32 s14, s68
    s_branch L_ret_tr44b
L_rs_tr44d:
    s_call_b64 s[40:41], L_rare4_1
    s_branch L_ret_tr44d
L_rs_tr55a:
    s_call_b64 s[40:41], L_rare5_0
    s_branch L_ret_tr55a
L_rs_tr55b:
    s_nop 15
    s_waitcnt vmcnt(0) lgkmcnt(0)
    s_mov_b32 s68, s14
    s_mov_b32 s14, 166723584
    v_mbcnt_lo_u32_b32 v105, -1, 0
    v_mbcnt_hi_u32_b32 v105, -1, v105
    v_and_b32 v104, 15, v105
    v_mul_u32_u24 v104, 384, v104
    v_lshrrev_b32 v105, 4, v105
    v_lshl_add_u32 v104, v105, 4, v104
    s_add_u32 s69, s34, 0
    buffer_load_dwordx4 a[96:99], v104, s[12:15], s69 offen offset:0
    buffer_load_dwordx4 a[100:103], v104, s[12:15], s69 offen offset:64
    buffer_load_dwordx4 a[104:107], v104, s[12:15], s69 offen offset:128
    buffer_load_dwordx4 a[108:111], v104, s[12:15], s69 offen offset:192
    buffer_load_dwordx4 a[112:115], v104, s[12:15], s69 offen offset:256
    buffer_load_dwordx4 a[116:119], v104, s[12:15], s69 offen offset:320
    s_add_u32 s69, s34, 6144
    buffer_load_dwordx4 a[120:123], v104, s[12:15], s69 offen offset:0
    buffer_load_dwordx4 a[124:127], v104, s[12:15], s69 offen offset:64
    buffer_load_dwordx4 a[128:131], v104, s[12:15], s69 offen offset:128
    buffer_load_dwordx4 a[132:135], v104, s[12:15], s69 offen offset:192
    buffer_load_dwordx4 a[136:139], v104, s[12:15], s69 offen offset:256
    buffer_load_dwordx4 a[140:143], v104, s[12:15], s69 offen offset:320
    s_add_u32 s69, s34, 12288
    buffer_load_dwordx4 a[144:147], v104, s[12:15], s69 offen offset:0
    buffer_load_dwordx4 a[148:151], v104, s[12:15], s69 offen offset:64
    buffer_load_dwordx4 a[152:155], v104, s[12:15], s69 offen offset:128
    buffer_load_dwordx4 a[156:159], v104, s[12:15], s69 offen offset:192
    buffer_load_dwordx4 a[160:163], v104, s[12:15], s69 offen offset:256
    buffer_load_dwordx4 a[164:167], v104, s[12:15], s69 offen offset:320
    s_add_u32 s69, s34, 18432
    buffer_load_dwordx4 a[168:171], v104, s[12:15], s69 offen offset:0
    buffer_load_dwordx4 a[172:175], v104, s[12:15], s69 offen offset:64
    buffer_load_dwordx4 a[176:179], v104, s[12:15], s69 offen offset:128
    buffer_load_dwordx4 a[180:183], v104, s[12:15], s69 offen offset:192
    buffer_load_dwordx4 a[184:187], v104, s[12:15], s69 offen offset:256
    buffer_load_dwordx4 a[188:191], v104, s[12:15], s69 offen offset:320
    s_add_u32 s69, s34, 24576
    buffer_load_dwordx4 a[192:195], v104, s[12:15], s69 offen offset:0
    buffer_load_dwordx4 a[196:199], v104, s[12:15], s69 offen offset:64
    buffer_load_dwordx4 a[200:203], v104, s[12:15], s69 offen offset:128
    buffer_load_dwordx4 a[204:207], v104, s[12:15], s69 offen offset:192
    buffer_load_dwordx4 a[208:211], v104, s[12:15], s69 offen offset:256
    buffer_load_dwordx4 a[212:215], v104, s[12:15], s69 offen offset:320
    s_waitcnt vmcnt(0)
    s_call_b64 s[40:41], L_rare5_1
    v_mbcnt_lo_u32_b32 v105, -1, 0
    v_mbcnt_hi_u32_b32 v105, -1, v105
    v_and_b32 v104, 15, v105
    v_mul_u32_u24 v104, 384, v104
    v_lshrrev_b32 v105, 4, v105
    v_lshl_add_u32 v104, v105, 4, v104
    s_add_u32 s69, s33, 0
    buffer_load_dwordx4 a[96:99], v104, s[12:15], s69 offen offset:0
    buffer_load_dwordx4 a[100:103], v104, s[12:15], s69 offen offset:64
    buffer_load_dwordx4 a[104:107], v104, s[12:15], s69 offen offset:128
    buffer_load_dwordx4 a[108:111], v104, s[12:15], s69 offen offset:192
    buffer_load_dwordx4 a[112:115], v104, s[12:15], s69 offen offset:256
    buffer_load_dwordx4 a[116:119], v104, s[12:15], s69 offen offset:320
    s_add_u32 s69, s33, 6144
    buffer_load_dwordx4 a[120:123], v104, s[12:15], s69 offen offset:0
    buffer_load_dwordx4 a[124:127], v104, s[12:15], s69 offen offset:64
    buffer_load_dwordx4 a[128:131], v104, s[12:15], s69 offen offset:128
    buffer_load_dwordx4 a[132:135], v104, s[12:15], s69 offen offset:192
    buffer_load_dwordx4 a[136:139], v104, s[12:15], s69 offen offset:256
    buffer_load_dwordx4 a[140:143], v104, s[12:15], s69 offen offset:320
    s_add_u32 s69, s33, 12288
    buffer_load_dwordx4 a[144:147], v104, s[12:15], s69 offen offset:0
    buffer_load_dwordx4 a[148:151], v104, s[12:15], s69 offen offset:64
    buffer_load_dwordx4 a[152:155], v104, s[12:15], s69 offen offset:128
    buffer_load_dwordx4 a[156:159], v104, s[12:15], s69 offen offset:192
    buffer_load_dwordx4 a[160:163], v104, s[12:15], s69 offen offset:256
    buffer_load_dwordx4 a[164:167], v104, s[12:15], s69 offen offset:320
    s_add_u32 s69, s33, 18432
    buffer_load_dwordx4 a[168:171], v104, s[12:15], s69 offen offset:0
    buffer_load_dwordx4 a[172:175], v104, s[12:15], s69 offen offset:64
    buffer_load_dwordx4 a[176:179], v104, s[12:15], s69 offen offset:128
    buffer_load_dwordx4 a[180:183], v104, s[12:15], s69 offen offset:192
    buffer_load_dwordx4 a[184:187], v104, s[12:15], s69 offen offset:256
    buffer_load_dwordx4 a[188:191], v104, s[12:15], s69 offen offset:320
    s_add_u32 s69, s33, 24576
    buffer_load_dwordx4 a[192:195], v104, s[12:15], s69 offen offset:0
    buffer_load_dwordx4 a[196:199], v104, s[12:15], s69 offen offset:64
    buffer_load_dwordx4 a[200:203], v104, s[12:15], s69 offen offset:128
    buffer_load_dwordx4 a[204:207], v104, s[12:15], s69 offen offset:192
    buffer_load_dwordx4 a[208:211], v104, s[12:15], s69 offen offset:256
    buffer_load_dwordx4 a[212:215], v104, s[12:15], s69 offen offset:320
    s_waitcnt vmcnt(0)
    s_mov_b32 s14, s68
    s_branch L_ret_tr55b
L_rs_tr55d:
    s_call_b64 s[40:41], L_rare5_1
    s_branch L_ret_tr55d
.section .rodata,"a"
.p2align 6
.amdhsa_kernel standalone__gqa_softmax__near_ridge_kernel
  .amdhsa_next_free_vgpr 512
  .amdhsa_next_free_sgpr 102
  .amdhsa_accum_offset 256
  .amdhsa_group_segment_fixed_size 0
  .amdhsa_kernarg_size 48
  .amdhsa_user_sgpr_count 2
  .amdhsa_user_sgpr_kernarg_segment_ptr 1
  .amdhsa_system_sgpr_workgroup_id_x 1
.end_amdhsa_kernel
```
